```python
import torch

def _softmax(x, axis=-1):
    return torch.softmax(x, dim=axis)

def _gelu(x):
    return torch.nn.functional.gelu(x, approximate='tanh')

def _silu(x):
    return torch.nn.functional.silu(x)

def _sigmoid(x):
    return torch.sigmoid(x)

def _layernorm(x, axis=-1, eps=1e-05):
    m = x.mean(dim=axis, keepdim=True)
    v = x.var(dim=axis, keepdim=True, unbiased=False)
    return (x - m) / torch.sqrt(v + eps)

def _scatter_add(tgt, idx, src, axis=0):
    return tgt.clone().index_add_(axis, idx, src)

def _segment_sum(src, seg, n):
    out = torch.zeros((n,) + src.shape[1:], dtype=src.dtype)
    return out.index_add_(0, seg, src)

def _pad(x, pw):
    flat = tuple((v for pair in reversed(pw) for v in pair))
    return torch.nn.functional.pad(x, flat)
kernel_name = 'concat_heads__memory_aug_recurrent_mem_tr__ssm_conv_s4d__prompt'

def setup_inputs():

    _w = lambda a: (lambda t: t.to(torch.bfloat16) if t.is_floating_point() else t)(torch.as_tensor(a))

    def _A_setup():
        B, S, Dm = (1, 2048, 576)
        H, Dh = (32, 128)
        M, seg = (8, 32)
        seg = min(seg, S)
        S = S // seg * seg
        return {'x': _w((lambda *s: torch.randn(*s, dtype=torch.bfloat16) * 0.05)(B, S, Dm)), 'mem0': _w((lambda *s: torch.randn(*s, dtype=torch.bfloat16) * 0.4)(B, M, Dm)), 'Wq': _w((lambda *s: torch.randn(*s, dtype=torch.bfloat16) * 6.4)(Dm, H, Dh) * Dm ** (-0.5)), 'Wk': _w((lambda *s: torch.randn(*s, dtype=torch.bfloat16) * 6.4)(Dm, H, Dh) * Dm ** (-0.5)), 'Wv': _w((lambda *s: torch.randn(*s, dtype=torch.bfloat16) * 0.4)(Dm, H, Dh) * Dm ** (-0.5)), 'Wo': _w((lambda *s: torch.randn(*s, dtype=torch.bfloat16) * 0.4)(H, Dh, Dm) * (H * Dh) ** (-0.5)), 'seg_len': seg}
    _A_in = _A_setup()

    def _B_setup():
        Bsz, L, D, N = (1, 2048, 576, 128)
        return {'u': _w((lambda *s: torch.randn(*s, dtype=torch.bfloat16) * 0.05)(Bsz, L, D)), 'log_A_real': _w((lambda *s: torch.randn(*s, dtype=torch.bfloat16) * 3.2)(D, N) * 0.5), 'A_imag': _w((lambda *s: torch.randn(*s, dtype=torch.bfloat16) * 0.05)(D, N) * 3.14), 'C_real': _w((lambda *s: torch.randn(*s, dtype=torch.bfloat16) * 0.4)(D, N) / N ** 0.5), 'C_imag': _w((lambda *s: torch.randn(*s, dtype=torch.bfloat16) * 0.4)(D, N) / N ** 0.5), 'log_dt': _w((lambda *s: torch.randn(*s, dtype=torch.bfloat16) * 0.05)(D) * 0.5 - 4.0), 'D_skip': _w((lambda *s: torch.randn(*s, dtype=torch.bfloat16) * 0.05)(D))}
    _B_in = _B_setup()
    return {'A_x': _A_in['x'], 'A_mem0': _A_in['mem0'], 'A_Wq': _A_in['Wq'], 'A_Wk': _A_in['Wk'], 'A_Wv': _A_in['Wv'], 'A_Wo': _A_in['Wo'], 'A_seg_len': _A_in['seg_len'], 'B_u': _B_in['u'], 'B_log_A_real': _B_in['log_A_real'], 'B_A_imag': _B_in['A_imag'], 'B_C_real': _B_in['C_real'], 'B_C_imag': _B_in['C_imag'], 'B_log_dt': _B_in['log_dt'], 'B_D_skip': _B_in['D_skip']}

def reference(A_x, A_mem0, A_Wq, A_Wk, A_Wv, A_Wo, A_seg_len, B_u, B_log_A_real, B_A_imag, B_C_real, B_C_imag, B_log_dt, B_D_skip):

    def _A_ref(x, mem0, Wq, Wk, Wv, Wo, seg_len):
        B, S, Dm = x.shape
        H, Dh = (Wq.shape[1], Wq.shape[2])
        M = mem0.shape[1]
        scale = Dh ** (-0.5)
        n_seg = S // seg_len
        L = M + seg_len
        idx = torch.arange(L)
        mask = (idx[:, None] < M) | (idx[:, None] >= idx[None, :])
        mem = mem0
        outs = []
        for s in range(n_seg):
            xs = x[:, s * seg_len:(s + 1) * seg_len, :].clone()
            h = torch.concatenate([mem, xs], axis=1)
            q = torch.einsum('btd,dhe->bhte', h, Wq)
            k = torch.einsum('btd,dhe->bhte', h, Wk)
            v = torch.einsum('btd,dhe->bhte', h, Wv)
            scores = torch.einsum('bhqe,bhke->bhqk', q, k) * scale
            scores = torch.where(mask[None, None], scores, -1000000000.0)
            p = _softmax(scores, axis=-1)
            o = torch.einsum('bhqk,bhke->bhqe', p, v)
            o = torch.einsum('bhte,hed->btd', o, Wo)
            mem = o[:, :M, :].clone()
            outs.append(o[:, M:, :])
        return torch.concatenate(outs, axis=1)

    def _B_ref(u, log_A_real, A_imag, C_real, C_imag, log_dt, D_skip):
        L = u.shape[1]
        dt = torch.exp(log_dt)
        A = -torch.exp(log_A_real) + 1j * A_imag
        C = (C_real + 1j * C_imag) * dt[:, None]
        pos = (lambda x, dt: x.to(dt))(torch.arange(L), log_dt.dtype)
        P = torch.exp((A * dt[:, None])[:, :, None] * pos[None, None, :])
        K = 2.0 * torch.einsum('dn,dnl->dl', C, P).real
        L2 = 2 * L
        u_t = (lambda x, *d: x.permute(*d))(u, 0, 2, 1)
        Kf = (lambda x, *a, **k: torch.fft.rfft(x.float(), *a, **k))(K, L2)
        Uf = (lambda x, *a, **k: torch.fft.rfft(x.float(), *a, **k))(u_t, L2)
        y = (lambda x, *a, **k: torch.fft.irfft(x, *a, **k).to(torch.bfloat16))(Uf * Kf[None, :, :], L2)[:, :, :L]
        y = (lambda x, *d: x.permute(*d))(y, 0, 2, 1)
        return y + u * D_skip[None, None, :]
    a = _A_ref(A_x, A_mem0, A_Wq, A_Wk, A_Wv, A_Wo, A_seg_len)
    b = _B_ref(B_u, B_log_A_real, B_A_imag, B_C_real, B_C_imag, B_log_dt, B_D_skip)
    return torch.concatenate([a, b], axis=-1)
```

```asm
; @launch grid=(256,1,1) block=(256,1,1) lds=163840
.amdgcn_target "amdgcn-amd-amdhsa--gfx950"
.text
.globl concat_heads__memory_aug_recurrent_mem_tr__ssm_conv_s4d__prompt_kernel
.p2align 8
.type concat_heads__memory_aug_recurrent_mem_tr__ssm_conv_s4d__prompt_kernel,@function
concat_heads__memory_aug_recurrent_mem_tr__ssm_conv_s4d__prompt_kernel:
    s_cmp_ge_u32 s2, 256
    s_cbranch_scc1 L_exit
    s_load_dwordx4 s[80:83], s[0:1], 120
    s_load_dwordx16 s[48:63], s[0:1], 0
    s_memrealtime s[90:91]
    v_lshrrev_b32 v1, 6, v0
    s_nop 0
    v_readfirstlane_b32 s32, v1
    s_waitcnt lgkmcnt(0)
    s_mov_b32 s4, s82
    s_mov_b32 s5, s83
    s_mov_b32 s6, 268435456
    s_mov_b32 s7, 0x20000
    s_mov_b32 s84, s80
    s_mov_b32 s85, s81
    s_mov_b32 s86, 256
    s_mov_b32 s87, 0x20000
    s_cmp_lg_u32 s32, 0
    s_cbranch_scc1 L_nod0
L_nod0:
    s_cmp_lg_u32 s32, 3
    s_cbranch_scc1 L_nowarm
    s_getpc_b64 s[44:45]
L_pcw:
    v_and_b32 v1, 63, v0
    v_lshlrev_b32 v1, 7, v1
    v_min_u32 v2, L_exit-L_pcw, v1
    global_load_dword v210, v2, s[44:45]
    v_add_u32 v1, 8192, v1
    v_min_u32 v2, L_exit-L_pcw, v1
    global_load_dword v211, v2, s[44:45]
    v_add_u32 v1, 8192, v1
    v_min_u32 v2, L_exit-L_pcw, v1
    global_load_dword v212, v2, s[44:45]
    v_add_u32 v1, 8192, v1
    v_min_u32 v2, L_exit-L_pcw, v1
    global_load_dword v213, v2, s[44:45]
    v_add_u32 v1, 8192, v1
    v_min_u32 v2, L_exit-L_pcw, v1
    global_load_dword v214, v2, s[44:45]
    v_add_u32 v1, 8192, v1
    v_min_u32 v2, L_exit-L_pcw, v1
    global_load_dword v215, v2, s[44:45]
    v_add_u32 v1, 8192, v1
    v_min_u32 v2, L_exit-L_pcw, v1
    global_load_dword v216, v2, s[44:45]
    v_add_u32 v1, 8192, v1
L_nowarm:
    s_lshl_b32 s90, s90, 8
    s_or_b32 s90, s90, 1
    v_mov_b32 v200, s90
    v_mov_b32 v201, 0
    s_cmp_lg_u32 s32, 0
    s_cbranch_scc1 L_nn
    s_mov_b64 exec, 1
    buffer_atomic_cmpswap v[200:201], off, s[84:87], 0 offset:0 sc0
    s_mov_b64 exec, -1
L_nn:
    s_getreg_b32 s3, hwreg(HW_REG_XCC_ID)
    s_and_b32 s3, s3, 15
    s_cmp_lg_u32 s3, 0
    s_cbranch_scc1 L_h0
    s_mov_b32 s37, 128
    v_mov_b32 v250, 1
    v_mov_b32 v251, 163832
    v_cmp_eq_u32 vcc, 0, v0
    s_nop 0
    s_and_saveexec_b64 s[38:39], vcc
    s_cbranch_execz tk1
    buffer_atomic_add v250, off, s[84:87], s37 sc0
    s_waitcnt vmcnt(0)
    ds_write_b32 v251, v250
    s_waitcnt lgkmcnt(0)
tk1:
    s_mov_b64 exec, -1
    s_barrier
    ds_read_b32 v252, v251
    s_waitcnt lgkmcnt(0)
    v_readfirstlane_b32 s12, v252
    s_barrier
    s_nop 3
    s_waitcnt vmcnt(0)
    v_mov_b32 v251, 163832
    s_cmp_lg_u32 s32, 0
    s_cbranch_scc1 L_nn2
    v_mov_b32 v201, s90
    v_cmp_eq_u32 vcc, 0, v200
    s_nop 1
    v_cndmask_b32 v200, v200, v201, vcc
    s_mov_b64 exec, 1
    ds_write_b32 v251, v200 offset:4
    s_mov_b64 exec, -1
    s_waitcnt lgkmcnt(0)
L_nn2:
    s_barrier
    ds_read_b32 v252, v251 offset:4
    s_waitcnt lgkmcnt(0)
    v_readfirstlane_b32 s95, v252
    s_nop 1
    s_cmp_lt_u32 s12, 32
    s_cbranch_scc1 L_chain
    s_branch L_xf2
L_h0:
    s_mov_b32 s37, 24
    v_mov_b32 v250, 1
    v_mov_b32 v251, 163832
    v_cmp_eq_u32 vcc, 0, v0
    s_nop 0
    s_and_saveexec_b64 s[38:39], vcc
    s_cbranch_execz tk2
    buffer_atomic_add v250, off, s[84:87], s37 sc0
    s_waitcnt vmcnt(0)
    ds_write_b32 v251, v250
    s_waitcnt lgkmcnt(0)
tk2:
    s_mov_b64 exec, -1
    s_barrier
    ds_read_b32 v252, v251
    s_waitcnt lgkmcnt(0)
    v_readfirstlane_b32 s33, v252
    s_barrier
    s_nop 3
    s_waitcnt vmcnt(0)
    v_mov_b32 v251, 163832
    s_cmp_lg_u32 s32, 0
    s_cbranch_scc1 L_nn3
    v_mov_b32 v201, s90
    v_cmp_eq_u32 vcc, 0, v200
    s_nop 1
    v_cndmask_b32 v200, v200, v201, vcc
    s_mov_b64 exec, 1
    ds_write_b32 v251, v200 offset:4
    s_mov_b64 exec, -1
    s_waitcnt lgkmcnt(0)
L_nn3:
    s_barrier
    ds_read_b32 v252, v251 offset:4
    s_waitcnt lgkmcnt(0)
    v_readfirstlane_b32 s95, v252
    s_nop 1
    s_branch L_xf
L_xf2:
    s_nop 1
    s_mov_b32 s37, 24
    v_mov_b32 v250, 1
    v_mov_b32 v251, 163832
    v_cmp_eq_u32 vcc, 0, v0
    s_nop 0
    s_and_saveexec_b64 s[38:39], vcc
    s_cbranch_execz tk3
    buffer_atomic_add v250, off, s[84:87], s37 sc0
    s_waitcnt vmcnt(0)
    ds_write_b32 v251, v250
    s_waitcnt lgkmcnt(0)
tk3:
    s_mov_b64 exec, -1
    s_barrier
    ds_read_b32 v252, v251
    s_waitcnt lgkmcnt(0)
    v_readfirstlane_b32 s33, v252
    s_barrier
    s_nop 3
L_xf:
    s_cmp_ge_u32 s33, 224
    s_cbranch_scc1 L_helper
    s_and_b32 s34, s33, 31
    s_lshr_b32 s35, s33, 5
    s_lshl_b32 s36, s35, 2
    s_add_u32 s36, s36, s32
    s_cmp_ge_u32 s36, 27
    s_cbranch_scc1 L_xf_skip
    s_mul_i32 s40, s34, 9
    s_add_u32 s16, s40, s36
    s_add_u32 s16, s16, 288
    s_cmp_ge_u32 s36, 9
    s_cselect_b32 s41, 279, 0
    s_add_u32 s16, s16, s41
    s_add_u32 s41, s40, s36
    s_sub_u32 s41, s41, 18
    s_cmp_ge_u32 s36, 18
    s_cselect_b32 s16, s41, s16
    s_call_b64 s[46:47], L_xform
L_xf_skip:
    s_lshl_b32 s40, s34, 6
    s_lshl_b32 s41, s35, 2
    s_add_u32 s40, s40, s41
    s_add_u32 s40, s40, 125833216
    s_waitcnt vmcnt(0)
    s_barrier
    v_mov_b32 v250, s95
    v_cmp_eq_u32 vcc, 0, v0
    s_nop 0
    s_and_saveexec_b64 s[38:39], vcc
    s_cbranch_execz fs4
    buffer_store_dword v250, off, s[4:7], s40 sc1
fs4:
    s_mov_b64 exec, -1
    s_branch L_xf2
L_chain:
    s_load_dwordx8 s[48:55], s[0:1], 8
    s_load_dwordx2 s[56:57], s[0:1], 40
    s_waitcnt lgkmcnt(0)
    v_lshrrev_b32 v77, 6, v0
    s_nop 0
    v_readfirstlane_b32 s13, v77
    v_lshlrev_b32 v65, 4, v0
    s_mov_b64 s[8:9], s[56:57]
    s_mov_b32 s10, 4718592
    s_mov_b32 s11, 0x20000
    v_bfe_u32 v77, v65, 4, 6
    s_mul_i32 s96, s13, 36864
    s_add_u32 s96, s96, 16384
    v_lshlrev_b32 v70, 4, v77
    v_add_u32 v70, s96, v70
    v_mov_b32 v68, 0x05040100
    v_mov_b32 v69, 0x07060302
    v_lshrrev_b32 v66, 5, v77
    v_lshlrev_b32 v66, 3, v66
    v_bfe_u32 v78, v77, 4, 1
    v_add_u32 v66, v66, v78
    v_xor_b32 v67, 1, v66
    v_mul_u32_u24 v66, 1152, v66
    v_mul_u32_u24 v67, 1152, v67
    v_mov_b32 v71, v66
    v_bfe_u32 v78, v77, 3, 1
    v_lshlrev_b32 v79, 5, v78
    v_lshl_add_u32 v71, v78, 2, v71
    v_and_b32 v78, 3, v77
    v_lshl_add_u32 v79, v78, 3, v79
    v_bfe_u32 v78, v77, 2, 1
    v_lshl_add_u32 v79, v78, 2, v79
    v_add_u32 v66, v66, v79
    v_add_u32 v67, v67, v79
    v_bfe_u32 v78, v77, 1, 2
    v_lshl_add_u32 v71, v78, 3, v71
    v_and_b32 v78, 1, v77
    v_lshl_add_u32 v71, v78, 1, v71
    s_mul_i32 s40, s12, 147456
    s_mul_i32 s41, s13, 288
    s_add_u32 s40, s40, s41
    s_xor_b32 s41, s13, 0
    s_mul_i32 s41, s41, 36864
    s_add_u32 s64, s41, s40
    s_xor_b32 s41, s13, 1
    s_mul_i32 s41, s41, 36864
    s_add_u32 s65, s41, s40
    s_xor_b32 s41, s13, 2
    s_mul_i32 s41, s41, 36864
    s_add_u32 s66, s41, s40
    s_xor_b32 s41, s13, 3
    s_mul_i32 s41, s41, 36864
    s_add_u32 s67, s41, s40
    s_add_u32 s97, s64, 128
    buffer_load_dword v0, v66, s[8:11], s97 offen offset:0
    buffer_load_dword v1, v66, s[8:11], s97 offen offset:2304
    buffer_load_dword v2, v67, s[8:11], s97 offen offset:64
    buffer_load_dword v3, v67, s[8:11], s97 offen offset:2368
    s_add_u32 s97, s64, 4736
    buffer_load_dword v4, v66, s[8:11], s97 offen offset:0
    buffer_load_dword v5, v66, s[8:11], s97 offen offset:2304
    buffer_load_dword v6, v67, s[8:11], s97 offen offset:64
    buffer_load_dword v7, v67, s[8:11], s97 offen offset:2368
    s_add_u32 s97, s64, 18560
    buffer_load_dword v8, v66, s[8:11], s97 offen offset:0
    buffer_load_dword v9, v66, s[8:11], s97 offen offset:2304
    buffer_load_dword v10, v67, s[8:11], s97 offen offset:64
    buffer_load_dword v11, v67, s[8:11], s97 offen offset:2368
    s_add_u32 s97, s64, 23168
    buffer_load_dword v12, v66, s[8:11], s97 offen offset:0
    buffer_load_dword v13, v66, s[8:11], s97 offen offset:2304
    buffer_load_dword v14, v67, s[8:11], s97 offen offset:64
    buffer_load_dword v15, v67, s[8:11], s97 offen offset:2368
    s_add_u32 s97, s65, 128
    buffer_load_dword v16, v66, s[8:11], s97 offen offset:0
    buffer_load_dword v17, v66, s[8:11], s97 offen offset:2304
    buffer_load_dword v18, v66, s[8:11], s97 offen offset:64
    buffer_load_dword v19, v66, s[8:11], s97 offen offset:2368
    s_add_u32 s97, s65, 4736
    buffer_load_dword v20, v66, s[8:11], s97 offen offset:0
    buffer_load_dword v21, v66, s[8:11], s97 offen offset:2304
    buffer_load_dword v22, v66, s[8:11], s97 offen offset:64
    buffer_load_dword v23, v66, s[8:11], s97 offen offset:2368
    s_add_u32 s97, s65, 18560
    buffer_load_dword v24, v66, s[8:11], s97 offen offset:0
    buffer_load_dword v25, v66, s[8:11], s97 offen offset:2304
    buffer_load_dword v26, v66, s[8:11], s97 offen offset:64
    buffer_load_dword v27, v66, s[8:11], s97 offen offset:2368
    s_add_u32 s97, s65, 23168
    buffer_load_dword v28, v66, s[8:11], s97 offen offset:0
    buffer_load_dword v29, v66, s[8:11], s97 offen offset:2304
    buffer_load_dword v30, v66, s[8:11], s97 offen offset:64
    buffer_load_dword v31, v66, s[8:11], s97 offen offset:2368
    s_add_u32 s97, s66, 128
    buffer_load_dword v32, v66, s[8:11], s97 offen offset:0
    buffer_load_dword v33, v66, s[8:11], s97 offen offset:2304
    buffer_load_dword v34, v66, s[8:11], s97 offen offset:64
    buffer_load_dword v35, v66, s[8:11], s97 offen offset:2368
    s_add_u32 s97, s66, 4736
    buffer_load_dword v36, v66, s[8:11], s97 offen offset:0
    buffer_load_dword v37, v66, s[8:11], s97 offen offset:2304
    buffer_load_dword v38, v66, s[8:11], s97 offen offset:64
    buffer_load_dword v39, v66, s[8:11], s97 offen offset:2368
    s_add_u32 s97, s66, 18560
    buffer_load_dword v40, v66, s[8:11], s97 offen offset:0
    buffer_load_dword v41, v66, s[8:11], s97 offen offset:2304
    buffer_load_dword v42, v66, s[8:11], s97 offen offset:64
    buffer_load_dword v43, v66, s[8:11], s97 offen offset:2368
    s_add_u32 s97, s66, 23168
    buffer_load_dword v44, v66, s[8:11], s97 offen offset:0
    buffer_load_dword v45, v66, s[8:11], s97 offen offset:2304
    buffer_load_dword v46, v66, s[8:11], s97 offen offset:64
    buffer_load_dword v47, v66, s[8:11], s97 offen offset:2368
    s_add_u32 s97, s67, 128
    buffer_load_dword v48, v66, s[8:11], s97 offen offset:0
    buffer_load_dword v49, v66, s[8:11], s97 offen offset:2304
    buffer_load_dword v50, v66, s[8:11], s97 offen offset:64
    buffer_load_dword v51, v66, s[8:11], s97 offen offset:2368
    s_add_u32 s97, s67, 4736
    buffer_load_dword v52, v66, s[8:11], s97 offen offset:0
    buffer_load_dword v53, v66, s[8:11], s97 offen offset:2304
    buffer_load_dword v54, v66, s[8:11], s97 offen offset:64
    buffer_load_dword v55, v66, s[8:11], s97 offen offset:2368
    s_add_u32 s97, s67, 18560
    buffer_load_dword v56, v66, s[8:11], s97 offen offset:0
    buffer_load_dword v57, v66, s[8:11], s97 offen offset:2304
    buffer_load_dword v58, v66, s[8:11], s97 offen offset:64
    buffer_load_dword v59, v66, s[8:11], s97 offen offset:2368
    s_add_u32 s97, s67, 23168
    buffer_load_dword v60, v66, s[8:11], s97 offen offset:0
    buffer_load_dword v61, v66, s[8:11], s97 offen offset:2304
    buffer_load_dword v62, v66, s[8:11], s97 offen offset:64
    buffer_load_dword v63, v66, s[8:11], s97 offen offset:2368
    s_waitcnt vmcnt(0)
    v_perm_b32 v80, v1, v0, v68
    v_perm_b32 v81, v3, v2, v68
    v_perm_b32 v82, v5, v4, v68
    v_perm_b32 v83, v7, v6, v68
    v_perm_b32 v84, v9, v8, v68
    v_perm_b32 v85, v11, v10, v68
    v_perm_b32 v86, v13, v12, v68
    v_perm_b32 v87, v15, v14, v68
    ds_write_b128 v70, v[80:83] offset:20480
    ds_write_b128 v70, v[84:87] offset:21504
    v_perm_b32 v88, v1, v0, v69
    v_perm_b32 v89, v3, v2, v69
    v_perm_b32 v90, v5, v4, v69
    v_perm_b32 v91, v7, v6, v69
    v_perm_b32 v92, v9, v8, v69
    v_perm_b32 v93, v11, v10, v69
    v_perm_b32 v94, v13, v12, v69
    v_perm_b32 v95, v15, v14, v69
    ds_write_b128 v70, v[88:91] offset:22528
    ds_write_b128 v70, v[92:95] offset:23552
    s_waitcnt lgkmcnt(0)
    v_perm_b32 v80, v17, v16, v68
    v_perm_b32 v81, v19, v18, v68
    v_perm_b32 v82, v21, v20, v68
    v_perm_b32 v83, v23, v22, v68
    v_perm_b32 v84, v25, v24, v68
    v_perm_b32 v85, v27, v26, v68
    v_perm_b32 v86, v29, v28, v68
    v_perm_b32 v87, v31, v30, v68
    ds_write_b128 v70, v[80:83] offset:24576
    ds_write_b128 v70, v[84:87] offset:25600
    v_perm_b32 v88, v17, v16, v69
    v_perm_b32 v89, v19, v18, v69
    v_perm_b32 v90, v21, v20, v69
    v_perm_b32 v91, v23, v22, v69
    v_perm_b32 v92, v25, v24, v69
    v_perm_b32 v93, v27, v26, v69
    v_perm_b32 v94, v29, v28, v69
    v_perm_b32 v95, v31, v30, v69
    ds_write_b128 v70, v[88:91] offset:26624
    ds_write_b128 v70, v[92:95] offset:27648
    s_waitcnt lgkmcnt(0)
    v_perm_b32 v80, v33, v32, v68
    v_perm_b32 v81, v35, v34, v68
    v_perm_b32 v82, v37, v36, v68
    v_perm_b32 v83, v39, v38, v68
    v_perm_b32 v84, v41, v40, v68
    v_perm_b32 v85, v43, v42, v68
    v_perm_b32 v86, v45, v44, v68
    v_perm_b32 v87, v47, v46, v68
    ds_write_b128 v70, v[80:83] offset:28672
    ds_write_b128 v70, v[84:87] offset:29696
    v_perm_b32 v88, v33, v32, v69
    v_perm_b32 v89, v35, v34, v69
    v_perm_b32 v90, v37, v36, v69
    v_perm_b32 v91, v39, v38, v69
    v_perm_b32 v92, v41, v40, v69
    v_perm_b32 v93, v43, v42, v69
    v_perm_b32 v94, v45, v44, v69
    v_perm_b32 v95, v47, v46, v69
    ds_write_b128 v70, v[88:91] offset:30720
    ds_write_b128 v70, v[92:95] offset:31744
    s_waitcnt lgkmcnt(0)
    v_perm_b32 v80, v49, v48, v68
    v_perm_b32 v81, v51, v50, v68
    v_perm_b32 v82, v53, v52, v68
    v_perm_b32 v83, v55, v54, v68
    v_perm_b32 v84, v57, v56, v68
    v_perm_b32 v85, v59, v58, v68
    v_perm_b32 v86, v61, v60, v68
    v_perm_b32 v87, v63, v62, v68
    ds_write_b128 v70, v[80:83] offset:32768
    ds_write_b128 v70, v[84:87] offset:33792
    v_perm_b32 v88, v49, v48, v69
    v_perm_b32 v89, v51, v50, v69
    v_perm_b32 v90, v53, v52, v69
    v_perm_b32 v91, v55, v54, v69
    v_perm_b32 v92, v57, v56, v69
    v_perm_b32 v93, v59, v58, v69
    v_perm_b32 v94, v61, v60, v69
    v_perm_b32 v95, v63, v62, v69
    ds_write_b128 v70, v[88:91] offset:34816
    ds_write_b128 v70, v[92:95] offset:35840
    s_waitcnt lgkmcnt(0)
    s_add_u32 s97, s64, 0
    buffer_load_dword v0, v66, s[8:11], s97 offen offset:0
    buffer_load_dword v1, v66, s[8:11], s97 offen offset:2304
    buffer_load_dword v2, v67, s[8:11], s97 offen offset:64
    buffer_load_dword v3, v67, s[8:11], s97 offen offset:2368
    s_add_u32 s97, s64, 4608
    buffer_load_dword v4, v66, s[8:11], s97 offen offset:0
    buffer_load_dword v5, v66, s[8:11], s97 offen offset:2304
    buffer_load_dword v6, v67, s[8:11], s97 offen offset:64
    buffer_load_dword v7, v67, s[8:11], s97 offen offset:2368
    s_add_u32 s97, s64, 18432
    buffer_load_dword v8, v66, s[8:11], s97 offen offset:0
    buffer_load_dword v9, v66, s[8:11], s97 offen offset:2304
    buffer_load_dword v10, v67, s[8:11], s97 offen offset:64
    buffer_load_dword v11, v67, s[8:11], s97 offen offset:2368
    s_add_u32 s97, s64, 23040
    buffer_load_dword v12, v66, s[8:11], s97 offen offset:0
    buffer_load_dword v13, v66, s[8:11], s97 offen offset:2304
    buffer_load_dword v14, v67, s[8:11], s97 offen offset:64
    buffer_load_dword v15, v67, s[8:11], s97 offen offset:2368
    s_add_u32 s97, s65, 0
    buffer_load_dword v16, v66, s[8:11], s97 offen offset:0
    buffer_load_dword v17, v66, s[8:11], s97 offen offset:2304
    buffer_load_dword v18, v66, s[8:11], s97 offen offset:64
    buffer_load_dword v19, v66, s[8:11], s97 offen offset:2368
    s_add_u32 s97, s65, 4608
    buffer_load_dword v20, v66, s[8:11], s97 offen offset:0
    buffer_load_dword v21, v66, s[8:11], s97 offen offset:2304
    buffer_load_dword v22, v66, s[8:11], s97 offen offset:64
    buffer_load_dword v23, v66, s[8:11], s97 offen offset:2368
    s_add_u32 s97, s65, 18432
    buffer_load_dword v24, v66, s[8:11], s97 offen offset:0
    buffer_load_dword v25, v66, s[8:11], s97 offen offset:2304
    buffer_load_dword v26, v66, s[8:11], s97 offen offset:64
    buffer_load_dword v27, v66, s[8:11], s97 offen offset:2368
    s_add_u32 s97, s65, 23040
    buffer_load_dword v28, v66, s[8:11], s97 offen offset:0
    buffer_load_dword v29, v66, s[8:11], s97 offen offset:2304
    buffer_load_dword v30, v66, s[8:11], s97 offen offset:64
    buffer_load_dword v31, v66, s[8:11], s97 offen offset:2368
    s_add_u32 s97, s66, 0
    buffer_load_dword v32, v66, s[8:11], s97 offen offset:0
    buffer_load_dword v33, v66, s[8:11], s97 offen offset:2304
    buffer_load_dword v34, v66, s[8:11], s97 offen offset:64
    buffer_load_dword v35, v66, s[8:11], s97 offen offset:2368
    s_add_u32 s97, s66, 4608
    buffer_load_dword v36, v66, s[8:11], s97 offen offset:0
    buffer_load_dword v37, v66, s[8:11], s97 offen offset:2304
    buffer_load_dword v38, v66, s[8:11], s97 offen offset:64
    buffer_load_dword v39, v66, s[8:11], s97 offen offset:2368
    s_add_u32 s97, s66, 18432
    buffer_load_dword v40, v66, s[8:11], s97 offen offset:0
    buffer_load_dword v41, v66, s[8:11], s97 offen offset:2304
    buffer_load_dword v42, v66, s[8:11], s97 offen offset:64
    buffer_load_dword v43, v66, s[8:11], s97 offen offset:2368
    s_add_u32 s97, s66, 23040
    buffer_load_dword v44, v66, s[8:11], s97 offen offset:0
    buffer_load_dword v45, v66, s[8:11], s97 offen offset:2304
    buffer_load_dword v46, v66, s[8:11], s97 offen offset:64
    buffer_load_dword v47, v66, s[8:11], s97 offen offset:2368
    s_add_u32 s97, s67, 0
    buffer_load_dword v48, v66, s[8:11], s97 offen offset:0
    buffer_load_dword v49, v66, s[8:11], s97 offen offset:2304
    buffer_load_dword v50, v66, s[8:11], s97 offen offset:64
    buffer_load_dword v51, v66, s[8:11], s97 offen offset:2368
    s_add_u32 s97, s67, 4608
    buffer_load_dword v52, v66, s[8:11], s97 offen offset:0
    buffer_load_dword v53, v66, s[8:11], s97 offen offset:2304
    buffer_load_dword v54, v66, s[8:11], s97 offen offset:64
    buffer_load_dword v55, v66, s[8:11], s97 offen offset:2368
    s_add_u32 s97, s67, 18432
    buffer_load_dword v56, v66, s[8:11], s97 offen offset:0
    buffer_load_dword v57, v66, s[8:11], s97 offen offset:2304
    buffer_load_dword v58, v66, s[8:11], s97 offen offset:64
    buffer_load_dword v59, v66, s[8:11], s97 offen offset:2368
    s_add_u32 s97, s67, 23040
    buffer_load_dword v60, v66, s[8:11], s97 offen offset:0
    buffer_load_dword v61, v66, s[8:11], s97 offen offset:2304
    buffer_load_dword v62, v66, s[8:11], s97 offen offset:64
    buffer_load_dword v63, v66, s[8:11], s97 offen offset:2368
    s_waitcnt vmcnt(0)
    v_perm_b32 v80, v1, v0, v68
    v_perm_b32 v81, v3, v2, v68
    v_perm_b32 v82, v5, v4, v68
    v_perm_b32 v83, v7, v6, v68
    v_perm_b32 v84, v9, v8, v68
    v_perm_b32 v85, v11, v10, v68
    v_perm_b32 v86, v13, v12, v68
    v_perm_b32 v87, v15, v14, v68
    v_perm_b32 v112, v1, v0, v69
    v_perm_b32 v113, v3, v2, v69
    v_perm_b32 v114, v5, v4, v69
    v_perm_b32 v115, v7, v6, v69
    v_perm_b32 v116, v9, v8, v69
    v_perm_b32 v117, v11, v10, v69
    v_perm_b32 v118, v13, v12, v69
    v_perm_b32 v119, v15, v14, v69
    v_perm_b32 v88, v17, v16, v68
    v_perm_b32 v89, v19, v18, v68
    v_perm_b32 v90, v21, v20, v68
    v_perm_b32 v91, v23, v22, v68
    v_perm_b32 v92, v25, v24, v68
    v_perm_b32 v93, v27, v26, v68
    v_perm_b32 v94, v29, v28, v68
    v_perm_b32 v95, v31, v30, v68
    v_perm_b32 v120, v17, v16, v69
    v_perm_b32 v121, v19, v18, v69
    v_perm_b32 v122, v21, v20, v69
    v_perm_b32 v123, v23, v22, v69
    v_perm_b32 v124, v25, v24, v69
    v_perm_b32 v125, v27, v26, v69
    v_perm_b32 v126, v29, v28, v69
    v_perm_b32 v127, v31, v30, v69
    v_perm_b32 v96, v33, v32, v68
    v_perm_b32 v97, v35, v34, v68
    v_perm_b32 v98, v37, v36, v68
    v_perm_b32 v99, v39, v38, v68
    v_perm_b32 v100, v41, v40, v68
    v_perm_b32 v101, v43, v42, v68
    v_perm_b32 v102, v45, v44, v68
    v_perm_b32 v103, v47, v46, v68
    v_perm_b32 v128, v33, v32, v69
    v_perm_b32 v129, v35, v34, v69
    v_perm_b32 v130, v37, v36, v69
    v_perm_b32 v131, v39, v38, v69
    v_perm_b32 v132, v41, v40, v69
    v_perm_b32 v133, v43, v42, v69
    v_perm_b32 v134, v45, v44, v69
    v_perm_b32 v135, v47, v46, v69
    v_perm_b32 v104, v49, v48, v68
    v_perm_b32 v105, v51, v50, v68
    v_perm_b32 v106, v53, v52, v68
    v_perm_b32 v107, v55, v54, v68
    v_perm_b32 v108, v57, v56, v68
    v_perm_b32 v109, v59, v58, v68
    v_perm_b32 v110, v61, v60, v68
    v_perm_b32 v111, v63, v62, v68
    v_perm_b32 v136, v49, v48, v69
    v_perm_b32 v137, v51, v50, v69
    v_perm_b32 v138, v53, v52, v69
    v_perm_b32 v139, v55, v54, v69
    v_perm_b32 v140, v57, v56, v69
    v_perm_b32 v141, v59, v58, v69
    v_perm_b32 v142, v61, v60, v69
    v_perm_b32 v143, v63, v62, v69
    s_add_u32 s97, s64, 256
    buffer_load_ushort v0, v71, s[8:11], s97 offen offset:0
    buffer_load_ushort v1, v71, s[8:11], s97 offen offset:2304
    s_add_u32 s97, s64, 4864
    buffer_load_ushort v4, v71, s[8:11], s97 offen offset:0
    buffer_load_ushort v5, v71, s[8:11], s97 offen offset:2304
    s_add_u32 s97, s64, 18688
    buffer_load_ushort v8, v71, s[8:11], s97 offen offset:0
    buffer_load_ushort v9, v71, s[8:11], s97 offen offset:2304
    s_add_u32 s97, s64, 23296
    buffer_load_ushort v12, v71, s[8:11], s97 offen offset:0
    buffer_load_ushort v13, v71, s[8:11], s97 offen offset:2304
    s_add_u32 s97, s65, 256
    buffer_load_ushort v2, v71, s[8:11], s97 offen offset:0
    buffer_load_ushort v3, v71, s[8:11], s97 offen offset:2304
    s_add_u32 s97, s65, 4864
    buffer_load_ushort v6, v71, s[8:11], s97 offen offset:0
    buffer_load_ushort v7, v71, s[8:11], s97 offen offset:2304
    s_add_u32 s97, s65, 18688
    buffer_load_ushort v10, v71, s[8:11], s97 offen offset:0
    buffer_load_ushort v11, v71, s[8:11], s97 offen offset:2304
    s_add_u32 s97, s65, 23296
    buffer_load_ushort v14, v71, s[8:11], s97 offen offset:0
    buffer_load_ushort v15, v71, s[8:11], s97 offen offset:2304
    s_add_u32 s97, s66, 256
    buffer_load_ushort v16, v71, s[8:11], s97 offen offset:0
    buffer_load_ushort v17, v71, s[8:11], s97 offen offset:2304
    s_add_u32 s97, s66, 4864
    buffer_load_ushort v20, v71, s[8:11], s97 offen offset:0
    buffer_load_ushort v21, v71, s[8:11], s97 offen offset:2304
    s_add_u32 s97, s66, 18688
    buffer_load_ushort v24, v71, s[8:11], s97 offen offset:0
    buffer_load_ushort v25, v71, s[8:11], s97 offen offset:2304
    s_add_u32 s97, s66, 23296
    buffer_load_ushort v28, v71, s[8:11], s97 offen offset:0
    buffer_load_ushort v29, v71, s[8:11], s97 offen offset:2304
    s_add_u32 s97, s67, 256
    buffer_load_ushort v18, v71, s[8:11], s97 offen offset:0
    buffer_load_ushort v19, v71, s[8:11], s97 offen offset:2304
    s_add_u32 s97, s67, 4864
    buffer_load_ushort v22, v71, s[8:11], s97 offen offset:0
    buffer_load_ushort v23, v71, s[8:11], s97 offen offset:2304
    s_add_u32 s97, s67, 18688
    buffer_load_ushort v26, v71, s[8:11], s97 offen offset:0
    buffer_load_ushort v27, v71, s[8:11], s97 offen offset:2304
    s_add_u32 s97, s67, 23296
    buffer_load_ushort v30, v71, s[8:11], s97 offen offset:0
    buffer_load_ushort v31, v71, s[8:11], s97 offen offset:2304
    s_waitcnt vmcnt(0)
    v_lshl_or_b32 v144, v1, 16, v0
    v_lshl_or_b32 v145, v3, 16, v2
    v_lshl_or_b32 v146, v5, 16, v4
    v_lshl_or_b32 v147, v7, 16, v6
    v_lshl_or_b32 v148, v9, 16, v8
    v_lshl_or_b32 v149, v11, 16, v10
    v_lshl_or_b32 v150, v13, 16, v12
    v_lshl_or_b32 v151, v15, 16, v14
    v_lshl_or_b32 v152, v17, 16, v16
    v_lshl_or_b32 v153, v19, 16, v18
    v_lshl_or_b32 v154, v21, 16, v20
    v_lshl_or_b32 v155, v23, 16, v22
    v_lshl_or_b32 v156, v25, 16, v24
    v_lshl_or_b32 v157, v27, 16, v26
    v_lshl_or_b32 v158, v29, 16, v28
    v_lshl_or_b32 v159, v31, 16, v30
    s_nop 1
    v_bfe_u32 v60, v65, 4, 6
    v_and_b32 v61, 15, v60
    v_lshrrev_b32 v62, 4, v60
    v_mov_b32 v64, 0x4444
    v_mov_b32 v77, 0xeeee
    v_cmp_lt_u32 vcc, 7, v61
    s_nop 1
    v_cndmask_b32 v64, v64, v77, vcc
    v_xor_b32 v66, 1024, v65
    v_xor_b32 v67, 2048, v65
    v_xor_b32 v68, 3072, v65
    v_and_b32 v69, 511, v65
    s_mul_i32 s96, s13, 36864
    s_add_u32 s96, s96, 16384
    v_lshlrev_b32 v70, 4, v60
    v_add_u32 v70, s96, v70
    v_lshrrev_b32 v79, 1, v69
    s_lshl_b32 s96, s13, 8
    s_add_u32 s96, s96, 14336
    s_lshl_b32 s33, s13, 10
    s_add_u32 s97, s33, 8192
    v_mov_b32 v77, s97
    v_mov_b32 v78, s96
    v_cmp_lt_u32 vcc, 31, v60
    s_nop 1
    v_cndmask_b32 v71, v77, v78, vcc
    v_add_u32 v71, v71, v79
    v_and_b32 v77, 7, v61
    v_lshrrev_b32 v78, 3, v61
    v_lshlrev_b32 v74, 4, v77
    v_lshl_add_u32 v73, v62, 7, v74
    v_lshl_add_u32 v73, v78, 3, v73
    s_lshl_b32 s96, s13, 9
    v_add_u32 v73, s96, v73
    v_lshl_add_u32 v74, v78, 14, v74
    v_lshl_add_u32 v74, v62, 15, v74
    s_lshl_b32 s96, s13, 17
    v_add_u32 v74, s96, v74
    v_bfe_u32 v77, v61, 2, 1
    v_and_b32 v78, 3, v61
    v_bfe_u32 v79, v61, 1, 2
    s_cmp_lt_u32 s13, 2
    s_cselect_b64 vcc, -1, 0
    v_cndmask_b32 v77, 0, v77, vcc
    v_cndmask_b32 v78, v79, v78, vcc
    v_lshlrev_b32 v75, 7, v77
    v_lshl_add_u32 v75, v62, 4, v75
    v_lshl_add_u32 v75, v78, 2, v75
    v_lshlrev_b32 v58, 1, v77
    v_lshl_add_u32 v58, v78, 2, v58
    s_bfe_u32 s97, s12, 0x10001
    s_lshl_b32 s68, s97, 6
    s_lshl_b32 s97, s97, 2
    v_add_u32 v59, s97, v62
    s_bfe_u32 s96, s12, 0x10002
    s_and_b32 s40, s12, 1
    s_lshl_b32 s96, s96, 1
    s_add_u32 s96, s96, s40
    s_lshr_b32 s97, s12, 3
    s_lshl_b32 s98, s13, 2
    s_add_u32 s98, s98, s97
    s_lshl_b32 s98, s98, 2
    s_add_u32 s98, s98, s96
    s_lshl_b32 s98, s98, 8
    s_lshl_b32 s99, s13, 2
    s_add_u32 s99, s99, s96
    s_lshl_b32 s99, s99, 4
    s_lshl_b32 s41, s97, 1
    s_add_u32 s41, s41, s40
    s_lshl_b32 s41, s41, 7
    s_add_u32 s41, s41, 8192
    s_lshl_b32 s40, s40, 1
    s_add_u32 s40, s40, 128
    s_cmp_lt_u32 s13, 2
    s_cselect_b32 s98, s98, s41
    s_cselect_b32 s99, s99, s40
    s_cselect_b32 s32, 1, 0
    s_add_u32 s68, s68, s98
    s_mul_i32 s97, s97, 144
    s_add_u32 s99, s99, s97
    v_add_u32 v58, s99, v58
    s_and_b32 s97, s12, 4
    s_or_b32 s97, s97, s13
    s_cmp_eq_u32 s97, 2
    s_cselect_b32 s32, 2, s32
    s_cmp_lg_u32 s32, 0
    s_cselect_b64 s[34:35], -1, 0
    s_cbranch_scc0 cf_init_done
    s_mov_b32 s8, s48
    s_mov_b32 s9, s49
    s_mov_b32 s10, 9216
    s_mov_b32 s11, 0x20000
    v_mov_b32 v4, 1
    v_mov_b32 v5, 1
    v_mov_b32 v6, 1
    v_mov_b32 v7, 1
    s_lshl_b32 s96, s12, 14
    s_add_u32 s96, s96, 68157440
    s_add_u32 s97, s96, 0
    buffer_store_dwordx4 v[4:7], v65, s[4:7], s97 offen
    s_add_u32 s97, s96, 4096
    buffer_store_dwordx4 v[4:7], v65, s[4:7], s97 offen
    s_add_u32 s97, s96, 8192
    buffer_store_dwordx4 v[4:7], v65, s[4:7], s97 offen
    s_add_u32 s97, s96, 12288
    buffer_store_dwordx4 v[4:7], v65, s[4:7], s97 offen
    v_mul_u32_u24 v77, 1152, v59
    v_lshl_add_u32 v77, v58, 1, v77
    buffer_load_dword v72, v77, s[8:11], 0 offen
    s_add_u32 s96, s68, 67108864
    v_and_b32 v79, 12, v75
    v_cmp_eq_u32 vcc, 0, v79
    s_nop 1
    v_cndmask_b32 v79, 0, 1, vcc
    s_waitcnt vmcnt(0)
    v_bfi_b32 v1, v79, 0, v72
    buffer_store_dword v1, v75, s[4:7], s96 offen
    s_cmp_lg_u32 s32, 2
    s_cbranch_scc1 cf_init_done
    buffer_store_dword v1, v75, s[4:7], s96 offen offset:1024
    buffer_store_dword v1, v75, s[4:7], s96 offen offset:2048
    buffer_store_dword v1, v75, s[4:7], s96 offen offset:3072
cf_init_done:
    s_cmp_eq_u32 s13, 3
    s_cselect_b32 s96, 0, -1
    v_and_b32 v75, s96, v75
    v_mov_b32 v50, 0x3f80
    v_mov_b32 v51, 0x3f800000
    v_and_b32 v77, 1, v62
    v_lshlrev_b32 v77, 2, v77
    v_sub_u32 v77, v61, v77
    v_and_b32 v78, 3, v61
    v_lshlrev_b32 v78, 2, v78
    v_lshrrev_b32 v79, 2, v61
    v_add_u32 v78, v78, v79
    v_cmp_eq_u32 vcc, 0, v77
    s_nop 1
    v_cndmask_b32 v8, 0, v50, vcc
    v_cmp_eq_u32 vcc, 1, v77
    s_nop 1
    v_cndmask_b32 v8, v8, v51, vcc
    v_cmp_eq_u32 vcc, 0, v78
    s_nop 1
    v_cndmask_b32 v12, 0, v50, vcc
    v_cmp_eq_u32 vcc, 1, v78
    s_nop 1
    v_cndmask_b32 v12, v12, v51, vcc
    v_cmp_eq_u32 vcc, 2, v77
    s_nop 1
    v_cndmask_b32 v9, 0, v50, vcc
    v_cmp_eq_u32 vcc, 3, v77
    s_nop 1
    v_cndmask_b32 v9, v9, v51, vcc
    v_cmp_eq_u32 vcc, 2, v78
    s_nop 1
    v_cndmask_b32 v13, 0, v50, vcc
    v_cmp_eq_u32 vcc, 3, v78
    s_nop 1
    v_cndmask_b32 v13, v13, v51, vcc
    v_cmp_eq_u32 vcc, 8, v77
    s_nop 1
    v_cndmask_b32 v10, 0, v50, vcc
    v_cmp_eq_u32 vcc, 9, v77
    s_nop 1
    v_cndmask_b32 v10, v10, v51, vcc
    v_cmp_eq_u32 vcc, 4, v78
    s_nop 1
    v_cndmask_b32 v14, 0, v50, vcc
    v_cmp_eq_u32 vcc, 5, v78
    s_nop 1
    v_cndmask_b32 v14, v14, v51, vcc
    v_cmp_eq_u32 vcc, 10, v77
    s_nop 1
    v_cndmask_b32 v11, 0, v50, vcc
    v_cmp_eq_u32 vcc, 11, v77
    s_nop 1
    v_cndmask_b32 v11, v11, v51, vcc
    v_cmp_eq_u32 vcc, 6, v78
    s_nop 1
    v_cndmask_b32 v15, 0, v50, vcc
    v_cmp_eq_u32 vcc, 7, v78
    s_nop 1
    v_cndmask_b32 v15, v15, v51, vcc
    v_lshlrev_b32 v77, 4, v61
    ds_write_b128 v69, v[8:11] offset:15360
    ds_write_b128 v77, v[12:15] offset:15872
    s_mul_i32 s40, s12, 147456
    s_add_u32 s40, s40, 100663296
    s_xor_b32 s41, s13, 0
    s_lshl_b32 s41, s41, 14
    s_add_u32 s64, s41, s40
    s_xor_b32 s41, s13, 1
    s_lshl_b32 s41, s41, 14
    s_add_u32 s65, s41, s40
    s_xor_b32 s41, s13, 2
    s_lshl_b32 s41, s41, 14
    s_add_u32 s66, s41, s40
    s_xor_b32 s41, s13, 3
    s_lshl_b32 s41, s41, 14
    s_add_u32 s67, s41, s40
    s_mul_i32 s42, s12, 163840
    s_add_u32 s42, s42, 117440512
    s_mul_i32 s43, s13, 36864
    s_add_u32 s43, s43, 16384
    s_lshl_b32 s89, s12, 6
    s_add_u32 s89, s89, 125833216
    v_mbcnt_lo_u32_b32 v40, -1, 0
    v_mbcnt_hi_u32_b32 v40, -1, v40
    v_min_u32 v40, 4, v40
    v_lshlrev_b32 v40, 2, v40
    s_mov_b32 s88, 4194304
fw5:
    buffer_load_dword v41, v40, s[4:7], s89 offen offset:0 sc1
    s_sub_u32 s88, s88, 1
    s_cbranch_scc1 fw5x
    s_waitcnt vmcnt(0)
    v_cmp_ne_u32 vcc, s95, v41
    s_cbranch_vccz fw5x
    s_sleep 1
    s_branch fw5
fw5x:
    s_add_u32 s41, s64, 4718592
    buffer_load_dwordx4 a[96:99], v65, s[4:7], s41 offen
    s_add_u32 s41, s64, 4722688
    buffer_load_dwordx4 a[100:103], v65, s[4:7], s41 offen
    s_add_u32 s41, s64, 4726784
    buffer_load_dwordx4 a[104:107], v65, s[4:7], s41 offen
    s_add_u32 s41, s64, 4730880
    buffer_load_dwordx4 a[108:111], v65, s[4:7], s41 offen
    s_add_u32 s41, s65, 4718592
    buffer_load_dwordx4 a[112:115], v65, s[4:7], s41 offen
    s_add_u32 s41, s65, 4722688
    buffer_load_dwordx4 a[116:119], v65, s[4:7], s41 offen
    s_add_u32 s41, s65, 4726784
    buffer_load_dwordx4 a[120:123], v65, s[4:7], s41 offen
    s_add_u32 s41, s65, 4730880
    buffer_load_dwordx4 a[124:127], v65, s[4:7], s41 offen
    s_add_u32 s41, s66, 4718592
    buffer_load_dwordx4 a[128:131], v65, s[4:7], s41 offen
    s_add_u32 s41, s66, 4722688
    buffer_load_dwordx4 a[132:135], v65, s[4:7], s41 offen
    s_add_u32 s41, s66, 4726784
    buffer_load_dwordx4 a[136:139], v65, s[4:7], s41 offen
    s_add_u32 s41, s66, 4730880
    buffer_load_dwordx4 a[140:143], v65, s[4:7], s41 offen
    s_add_u32 s41, s67, 4718592
    buffer_load_dwordx4 a[144:147], v65, s[4:7], s41 offen
    s_add_u32 s41, s67, 4722688
    buffer_load_dwordx4 a[148:151], v65, s[4:7], s41 offen
    s_add_u32 s41, s67, 4726784
    s_add_u32 m0, s43, 12288
    s_nop 0
    buffer_load_dwordx4 v65, s[4:7], s41 offen  lds
    s_add_u32 s41, s67, 4730880
    s_add_u32 m0, s43, 13312
    s_nop 0
    buffer_load_dwordx4 v65, s[4:7], s41 offen  lds
    s_add_u32 s41, s64, 4784128
    buffer_load_dwordx4 a[152:155], v65, s[4:7], s41 offen
    s_add_u32 s41, s64, 4788224
    buffer_load_dwordx4 a[156:159], v65, s[4:7], s41 offen
    s_add_u32 s41, s64, 4792320
    buffer_load_dwordx4 a[160:163], v65, s[4:7], s41 offen
    s_add_u32 s41, s64, 4796416
    buffer_load_dwordx4 a[164:167], v65, s[4:7], s41 offen
    s_add_u32 s41, s65, 4784128
    s_add_u32 m0, s43, 16384
    s_nop 0
    buffer_load_dwordx4 v65, s[4:7], s41 offen  lds
    s_add_u32 s41, s65, 4788224
    s_add_u32 m0, s43, 17408
    s_nop 0
    buffer_load_dwordx4 v65, s[4:7], s41 offen  lds
    s_add_u32 s41, s65, 4792320
    buffer_load_dwordx4 a[168:171], v65, s[4:7], s41 offen
    s_add_u32 s41, s65, 4796416
    buffer_load_dwordx4 a[172:175], v65, s[4:7], s41 offen
    s_add_u32 s41, s66, 4784128
    buffer_load_dwordx4 a[176:179], v65, s[4:7], s41 offen
    s_add_u32 s41, s66, 4788224
    buffer_load_dwordx4 a[180:183], v65, s[4:7], s41 offen
    s_add_u32 s41, s66, 4792320
    buffer_load_dwordx4 a[184:187], v65, s[4:7], s41 offen
    s_add_u32 s41, s66, 4796416
    buffer_load_dwordx4 a[188:191], v65, s[4:7], s41 offen
    s_add_u32 s41, s67, 4784128
    s_add_u32 m0, s43, 18432
    s_nop 0
    buffer_load_dwordx4 v65, s[4:7], s41 offen  lds
    s_add_u32 s41, s67, 4788224
    s_add_u32 m0, s43, 19456
    s_nop 0
    buffer_load_dwordx4 v65, s[4:7], s41 offen  lds
    s_add_u32 s41, s67, 4792320
    buffer_load_dwordx4 a[192:195], v65, s[4:7], s41 offen
    s_add_u32 s41, s67, 4796416
    buffer_load_dwordx4 a[196:199], v65, s[4:7], s41 offen
    s_add_u32 s41, s40, 4849664
    buffer_load_dwordx4 a[200:203], v65, s[4:7], s41 offen
    s_add_u32 s41, s40, 4853760
    buffer_load_dwordx4 a[204:207], v65, s[4:7], s41 offen
    s_add_u32 s41, s40, 4857856
    buffer_load_dwordx4 a[208:211], v65, s[4:7], s41 offen
    s_add_u32 s41, s40, 4861952
    buffer_load_dwordx4 a[212:215], v65, s[4:7], s41 offen
    s_add_u32 s41, s64, 9437184
    buffer_load_dwordx4 a[216:219], v65, s[4:7], s41 offen
    s_add_u32 s41, s64, 9441280
    buffer_load_dwordx4 a[220:223], v65, s[4:7], s41 offen
    s_add_u32 s41, s64, 9445376
    s_add_u32 m0, s43, 8192
    s_nop 0
    buffer_load_dwordx4 v65, s[4:7], s41 offen  lds
    s_add_u32 s41, s64, 9449472
    s_add_u32 m0, s43, 9216
    s_nop 0
    buffer_load_dwordx4 v65, s[4:7], s41 offen  lds
    s_add_u32 s41, s65, 9437184
    buffer_load_dwordx4 a[224:227], v65, s[4:7], s41 offen
    s_add_u32 s41, s65, 9441280
    buffer_load_dwordx4 a[228:231], v65, s[4:7], s41 offen
    s_add_u32 s41, s65, 9445376
    buffer_load_dwordx4 a[232:235], v65, s[4:7], s41 offen
    s_add_u32 s41, s65, 9449472
    buffer_load_dwordx4 a[236:239], v65, s[4:7], s41 offen
    s_add_u32 s41, s66, 9437184
    buffer_load_dwordx4 a[240:243], v65, s[4:7], s41 offen
    s_add_u32 s41, s66, 9441280
    buffer_load_dwordx4 a[244:247], v65, s[4:7], s41 offen
    s_add_u32 s41, s66, 9445376
    buffer_load_dwordx4 a[248:251], v65, s[4:7], s41 offen
    s_add_u32 s41, s66, 9449472
    buffer_load_dwordx4 a[252:255], v65, s[4:7], s41 offen
    s_add_u32 s41, s67, 9437184
    buffer_load_dwordx4 v[160:163], v65, s[4:7], s41 offen
    s_add_u32 s41, s67, 9441280
    buffer_load_dwordx4 v[164:167], v65, s[4:7], s41 offen
    s_add_u32 s41, s67, 9445376
    buffer_load_dwordx4 v[168:171], v65, s[4:7], s41 offen
    s_add_u32 s41, s67, 9449472
    buffer_load_dwordx4 v[172:175], v65, s[4:7], s41 offen
    s_add_u32 s41, s64, 9502720
    buffer_load_dwordx4 v[176:179], v65, s[4:7], s41 offen
    s_add_u32 s41, s64, 9506816
    buffer_load_dwordx4 v[180:183], v65, s[4:7], s41 offen
    s_add_u32 s41, s64, 9510912
    buffer_load_dwordx4 v[184:187], v65, s[4:7], s41 offen
    s_add_u32 s41, s64, 9515008
    buffer_load_dwordx4 v[188:191], v65, s[4:7], s41 offen
    s_add_u32 s41, s65, 9502720
    buffer_load_dwordx4 v[192:195], v65, s[4:7], s41 offen
    s_add_u32 s41, s65, 9506816
    buffer_load_dwordx4 v[196:199], v65, s[4:7], s41 offen
    s_add_u32 s41, s65, 9510912
    buffer_load_dwordx4 v[200:203], v65, s[4:7], s41 offen
    s_add_u32 s41, s65, 9515008
    buffer_load_dwordx4 v[204:207], v65, s[4:7], s41 offen
    s_add_u32 s41, s66, 9502720
    buffer_load_dwordx4 v[208:211], v65, s[4:7], s41 offen
    s_add_u32 s41, s66, 9506816
    buffer_load_dwordx4 v[212:215], v65, s[4:7], s41 offen
    s_add_u32 s41, s66, 9510912
    buffer_load_dwordx4 v[216:219], v65, s[4:7], s41 offen
    s_add_u32 s41, s66, 9515008
    buffer_load_dwordx4 v[220:223], v65, s[4:7], s41 offen
    s_add_u32 s41, s67, 9502720
    buffer_load_dwordx4 v[224:227], v65, s[4:7], s41 offen
    s_add_u32 s41, s67, 9506816
    buffer_load_dwordx4 v[228:231], v65, s[4:7], s41 offen
    s_add_u32 s41, s67, 9510912
    buffer_load_dwordx4 v[232:235], v65, s[4:7], s41 offen
    s_add_u32 s41, s67, 9515008
    buffer_load_dwordx4 v[236:239], v65, s[4:7], s41 offen
    s_add_u32 s41, s40, 9568256
    buffer_load_dwordx4 v[240:243], v65, s[4:7], s41 offen
    s_add_u32 s41, s40, 9572352
    buffer_load_dwordx4 v[244:247], v65, s[4:7], s41 offen
    s_add_u32 s41, s40, 9576448
    buffer_load_dwordx4 v[248:251], v65, s[4:7], s41 offen
    s_add_u32 s41, s40, 9580544
    buffer_load_dwordx4 v[252:255], v65, s[4:7], s41 offen
    s_lshl_b32 s89, s12, 6
    s_add_u32 s89, s89, 125833216
    v_mbcnt_lo_u32_b32 v40, -1, 0
    v_mbcnt_hi_u32_b32 v40, -1, v40
    v_min_u32 v40, 2, v40
    v_lshlrev_b32 v40, 2, v40
    s_mov_b32 s88, 4194304
fw6:
    buffer_load_dword v41, v40, s[4:7], s89 offen offset:16 sc1
    s_sub_u32 s88, s88, 1
    s_cbranch_scc1 fw6x
    s_waitcnt vmcnt(0)
    v_cmp_ne_u32 vcc, s95, v41
    s_cbranch_vccz fw6x
    s_sleep 1
    s_branch fw6
fw6x:
    s_add_u32 s41, s64, 0
    s_add_u32 m0, s43, 0
    s_nop 0
    buffer_load_dwordx4 v65, s[4:7], s41 offen  lds
    s_add_u32 s41, s64, 4096
    s_add_u32 m0, s43, 1024
    s_nop 0
    buffer_load_dwordx4 v65, s[4:7], s41 offen  lds
    s_add_u32 s41, s64, 8192
    s_add_u32 m0, s43, 2048
    s_nop 0
    buffer_load_dwordx4 v65, s[4:7], s41 offen  lds
    s_add_u32 s41, s64, 12288
    s_add_u32 m0, s43, 3072
    s_nop 0
    buffer_load_dwordx4 v65, s[4:7], s41 offen  lds
    s_add_u32 s41, s65, 0
    s_add_u32 m0, s43, 4096
    s_nop 0
    buffer_load_dwordx4 v65, s[4:7], s41 offen  lds
    s_add_u32 s41, s65, 4096
    s_add_u32 m0, s43, 5120
    s_nop 0
    buffer_load_dwordx4 v65, s[4:7], s41 offen  lds
    s_add_u32 s41, s65, 8192
    s_add_u32 m0, s43, 6144
    s_nop 0
    buffer_load_dwordx4 v65, s[4:7], s41 offen  lds
    s_add_u32 s41, s65, 12288
    s_add_u32 m0, s43, 7168
    s_nop 0
    buffer_load_dwordx4 v65, s[4:7], s41 offen  lds
    s_add_u32 s41, s66, 0
    buffer_load_dwordx4 a[0:3], v65, s[4:7], s41 offen
    s_add_u32 s41, s66, 4096
    buffer_load_dwordx4 a[4:7], v65, s[4:7], s41 offen
    s_add_u32 s41, s66, 8192
    s_add_u32 m0, s43, 10240
    s_nop 0
    buffer_load_dwordx4 v65, s[4:7], s41 offen  lds
    s_add_u32 s41, s66, 12288
    s_add_u32 m0, s43, 11264
    s_nop 0
    buffer_load_dwordx4 v65, s[4:7], s41 offen  lds
    s_add_u32 s41, s67, 0
    buffer_load_dwordx4 a[8:11], v65, s[4:7], s41 offen
    s_add_u32 s41, s67, 4096
    buffer_load_dwordx4 a[12:15], v65, s[4:7], s41 offen
    s_add_u32 s41, s67, 8192
    s_add_u32 m0, s43, 14336
    s_nop 0
    buffer_load_dwordx4 v65, s[4:7], s41 offen  lds
    s_add_u32 s41, s67, 12288
    s_add_u32 m0, s43, 15360
    s_nop 0
    buffer_load_dwordx4 v65, s[4:7], s41 offen  lds
    s_add_u32 s41, s64, 65536
    buffer_load_dwordx4 a[16:19], v65, s[4:7], s41 offen
    s_add_u32 s41, s64, 69632
    buffer_load_dwordx4 a[20:23], v65, s[4:7], s41 offen
    s_add_u32 s41, s64, 73728
    buffer_load_dwordx4 a[24:27], v65, s[4:7], s41 offen
    s_add_u32 s41, s64, 77824
    buffer_load_dwordx4 a[28:31], v65, s[4:7], s41 offen
    s_add_u32 s41, s65, 65536
    buffer_load_dwordx4 a[32:35], v65, s[4:7], s41 offen
    s_add_u32 s41, s65, 69632
    buffer_load_dwordx4 a[36:39], v65, s[4:7], s41 offen
    s_add_u32 s41, s65, 73728
    buffer_load_dwordx4 a[40:43], v65, s[4:7], s41 offen
    s_add_u32 s41, s65, 77824
    buffer_load_dwordx4 a[44:47], v65, s[4:7], s41 offen
    s_add_u32 s41, s66, 65536
    buffer_load_dwordx4 a[48:51], v65, s[4:7], s41 offen
    s_add_u32 s41, s66, 69632
    buffer_load_dwordx4 a[52:55], v65, s[4:7], s41 offen
    s_add_u32 s41, s66, 73728
    buffer_load_dwordx4 a[56:59], v65, s[4:7], s41 offen
    s_add_u32 s41, s66, 77824
    buffer_load_dwordx4 a[60:63], v65, s[4:7], s41 offen
    s_add_u32 s41, s67, 65536
    buffer_load_dwordx4 a[64:67], v65, s[4:7], s41 offen
    s_add_u32 s41, s67, 69632
    buffer_load_dwordx4 a[68:71], v65, s[4:7], s41 offen
    s_add_u32 s41, s67, 73728
    buffer_load_dwordx4 a[72:75], v65, s[4:7], s41 offen
    s_add_u32 s41, s67, 77824
    buffer_load_dwordx4 a[76:79], v65, s[4:7], s41 offen
    s_add_u32 s41, s40, 131072
    buffer_load_dwordx4 a[80:83], v65, s[4:7], s41 offen
    s_add_u32 s41, s40, 135168
    buffer_load_dwordx4 a[84:87], v65, s[4:7], s41 offen
    s_add_u32 s41, s40, 139264
    buffer_load_dwordx4 a[88:91], v65, s[4:7], s41 offen
    s_add_u32 s41, s40, 143360
    buffer_load_dwordx4 a[92:95], v65, s[4:7], s41 offen
    s_waitcnt vmcnt(0) lgkmcnt(0)
    s_barrier
    v_mov_b32 v2, 1
    s_cmp_lg_u32 s13, 0
    s_cbranch_scc1 cf_noarr
    s_mov_b64 exec, 1
    buffer_atomic_add v2, off, s[84:87], 0 offset:132
    s_mov_b32 s40, 131072
    s_mov_b32 s42, 2
cf_startpoll:
    buffer_load_dword v3, off, s[84:87], 0 offset:132 sc1
    s_sub_u32 s40, s40, 1
    s_cbranch_scc1 cf_decide
    s_waitcnt vmcnt(0)
    v_readfirstlane_b32 s41, v3
    s_nop 1
    s_cmp_lt_u32 s41, 32
    s_cbranch_scc1 cf_startpoll
    s_mov_b32 s42, 1
cf_decide:
    v_mov_b32 v4, s42
    v_mov_b32 v5, 0
    buffer_atomic_cmpswap v[4:5], off, s[84:87], 0 offset:28 sc0
    s_waitcnt vmcnt(0)
    v_mov_b32 v5, s42
    v_cmp_eq_u32 vcc, 0, v4
    s_nop 1
    v_cndmask_b32 v4, v4, v5, vcc
    v_mov_b32 v5, 16192
    ds_write_b32 v5, v4
    s_waitcnt lgkmcnt(0)
    s_mov_b64 exec, -1
cf_noarr:
    s_barrier
    v_mov_b32 v5, 16192
    ds_read_b32 v4, v5
    s_waitcnt lgkmcnt(0)
    v_readfirstlane_b32 s41, v4
    s_nop 1
    s_cmp_eq_u32 s41, 1
    s_cbranch_scc1 cf_run
    v_lshrrev_b32 v0, 4, v65
    s_mov_b32 s32, s13
    s_load_dwordx16 s[48:63], s[0:1], 0
    s_waitcnt lgkmcnt(0)
    s_branch L_xf2
cf_run:
    s_mov_b32 m0, 16128
    s_mov_b32 s44, 0x3e0293ee
    s_mov_b32 s45, s44
    s_or_b32 s66, s44, 0x80000000
    s_mov_b32 s48, 0x3f003f00
    s_mov_b32 s49, 0
    s_mov_b32 s50, 0x3f803f80
    s_mov_b32 s51, 0x3f803f80
    s_mov_b32 s52, 512
    s_mov_b32 s53, 1024
    s_mov_b32 s54, 1536
    s_mov_b32 s30, 0
    s_cmp_lg_u32 s32, 0
    s_cselect_b32 s71, s13, 3
    s_mov_b32 s14, 67108864
    s_mov_b32 s15, 67112960
    s_mov_b32 s16, 67117056
    s_add_u32 s17, s68, 67108864
    s_mov_b32 s69, 0
    s_mov_b32 s70, 0
    s_lshl_b32 s26, s12, 14
    s_add_u32 s26, s26, 0
    s_mul_i32 s40, s13, 3072
    s_add_u32 s24, s26, s40
    s_lshl_b32 s40, s12, 14
    s_add_u32 s40, s40, 68157440
    s_add_u32 s18, s40, 0
    s_add_u32 s19, s40, 4096
    s_add_u32 s20, s40, 8192
    s_add_u32 s21, s40, 12288
    s_lshr_b32 s40, s12, 3
    s_lshl_b32 s40, s40, 12
    s_and_b32 s41, s12, 7
    s_lshl_b32 s41, s41, 7
    s_add_u32 s40, s40, s41
    s_add_u32 s22, s40, 68157440
    s_add_u32 s23, s22, 1024
    s_add_u32 s25, s22, 2048
    s_mov_b32 s56, -65528
    s_lshl_b32 s96, s12, 7
    s_add_u32 s29, s96, 125845504
    s_add_u32 s96, s96, 125829120
    s_add_u32 s28, s68, 138412032
    s_cmp_eq_u32 s13, 3
    s_cselect_b64 s[100:101], 1, 0
    s_cselect_b64 s[36:37], 1, s[34:35]
    s_cselect_b32 s93, 64, 0
    s_cselect_b32 s28, s29, s28
    s_cselect_b32 s27, 0, 9216
    s_mov_b64 exec, s[100:101]
    v_mov_b32 v72, s95
    s_mov_b64 exec, -1
    s_add_u32 s55, s68, 138992640
    s_mov_b32 s40, 2
    s_sub_u32 s41, s40, 1
    s_lshr_b32 s41, s41, 4
    s_lshl_b32 s41, s41, 2
    s_add_u32 s41, s41, s96
    s_mov_b32 s31, 4194304
cf_kv0:
    buffer_load_dword v77, off, s[4:7], s41 offset:16 sc1
    buffer_load_dword v78, off, s[4:7], s41 offset:32 sc1
    s_waitcnt vmcnt(0)
    v_subrev_u32 v77, s95, v77
    v_subrev_u32 v78, s95, v78
    v_cmp_lt_u32 vcc, 64, v77
    s_nop 1
    v_cndmask_b32 v77, v77, 0, vcc
    v_cmp_lt_u32 vcc, 64, v78
    s_nop 1
    v_cndmask_b32 v78, v78, 0, vcc
    v_min_u32 v77, v77, v78
    s_nop 0
    v_readfirstlane_b32 s97, v77
    s_sub_u32 s31, s31, 1
    s_cbranch_scc1 cf_kv0_x
    s_cmp_le_u32 s40, s97
    s_cbranch_scc1 cf_kv0_x
    s_sleep 4
    s_branch cf_kv0
cf_kv0_x:
    s_add_u32 s40, s26, 0
    v_lshlrev_b32 v78, 2, v65
    buffer_load_dword v76, v78, s[4:7], s40 offen sc1
    s_add_u32 s40, s26, 524288
    v_lshlrev_b32 v78, 2, v65
    buffer_load_dword v76, v78, s[4:7], s40 offen sc1
    v_mov_b64 v[0:1], 0
    v_mov_b64 v[2:3], 0
    v_mov_b64 v[4:5], 0
    v_mov_b64 v[6:7], 0
    v_mov_b64 v[8:9], 0
    v_mov_b64 v[10:11], 0
    v_mov_b64 v[12:13], 0
    v_mov_b64 v[14:15], 0
    v_mov_b64 v[16:17], 0
    v_mov_b64 v[18:19], 0
    v_mov_b64 v[20:21], 0
    v_mov_b64 v[22:23], 0
    v_mov_b32 v60, 1
    v_mov_b32 v56, 1
    ds_read_b128 v[40:43], v70 offset:0
    ds_read_b128 v[44:47], v70 offset:1024
    ds_read_b128 v[48:51], v70 offset:2048
    ds_read_b128 v[52:55], v70 offset:3072
    ds_read_b128 v[24:27], v70 offset:4096
    ds_read_b128 v[28:31], v70 offset:5120
    ds_read_b128 v[32:35], v70 offset:6144
    ds_read_b128 v[36:39], v70 offset:7168
cf_loop:
    s_add_u32 s40, s30, 3
    s_min_u32 s40, s40, 64
    s_cmp_le_u32 s40, s97
    s_cbranch_scc0 cf_kvwait
cf_kvok:
    s_mov_b32 s31, 1048576
    s_mov_b32 s69, s70
    s_waitcnt lgkmcnt(0)
cf_cA:
    buffer_load_dwordx4 v[60:63], v65, s[4:7], s14 offen offset:0 nt
    buffer_load_dwordx4 v[56:59], v66, s[4:7], s14 offen offset:0 nt
    v_bitop3_b32 v77, v60, v56, s70 bitop3:0x7e
    v_and_b32 v77, 1, v77
    v_cmp_ne_u32 vcc, 0, v77
    s_cbranch_vccz cf_goA
    v_bitop3_b32 v77, v60, v56, s70 bitop3:0x7e
    v_and_b32 v77, 1, v77
    v_cmp_ne_u32 vcc, 0, v77
    s_cbranch_vccz cf_goA
    v_bitop3_b32 v77, v60, v56, s70 bitop3:0x7e
    v_and_b32 v77, 1, v77
    v_cmp_ne_u32 vcc, 0, v77
    s_cbranch_vccz cf_goA
    v_bitop3_b32 v77, v60, v56, s70 bitop3:0x7e
    v_and_b32 v77, 1, v77
    v_cmp_ne_u32 vcc, 0, v77
    s_cbranch_vccz cf_goA
    buffer_load_dwordx4 v[60:63], v65, s[4:7], s14 offen offset:0 nt
    buffer_load_dwordx4 v[56:59], v66, s[4:7], s14 offen offset:0 nt
    v_bitop3_b32 v77, v60, v56, s70 bitop3:0x7e
    v_and_b32 v77, 1, v77
    v_cmp_ne_u32 vcc, 0, v77
    s_cbranch_vccz cf_goA
    v_bitop3_b32 v77, v60, v56, s70 bitop3:0x7e
    v_and_b32 v77, 1, v77
    v_cmp_ne_u32 vcc, 0, v77
    s_cbranch_vccz cf_goA
    v_bitop3_b32 v77, v60, v56, s70 bitop3:0x7e
    v_and_b32 v77, 1, v77
    v_cmp_ne_u32 vcc, 0, v77
    s_cbranch_vccz cf_goA
    v_bitop3_b32 v77, v60, v56, s70 bitop3:0x7e
    v_and_b32 v77, 1, v77
    v_cmp_ne_u32 vcc, 0, v77
    s_cbranch_vccz cf_goA
    buffer_load_dwordx4 v[60:63], v65, s[4:7], s14 offen offset:0 nt
    buffer_load_dwordx4 v[56:59], v66, s[4:7], s14 offen offset:0 nt
    v_bitop3_b32 v77, v60, v56, s70 bitop3:0x7e
    v_and_b32 v77, 1, v77
    v_cmp_ne_u32 vcc, 0, v77
    s_cbranch_vccz cf_goA
    v_bitop3_b32 v77, v60, v56, s70 bitop3:0x7e
    v_and_b32 v77, 1, v77
    v_cmp_ne_u32 vcc, 0, v77
    s_cbranch_vccz cf_goA
    v_bitop3_b32 v77, v60, v56, s70 bitop3:0x7e
    v_and_b32 v77, 1, v77
    v_cmp_ne_u32 vcc, 0, v77
    s_cbranch_vccz cf_goA
    v_bitop3_b32 v77, v60, v56, s70 bitop3:0x7e
    v_and_b32 v77, 1, v77
    v_cmp_ne_u32 vcc, 0, v77
    s_cbranch_vccz cf_goA
    buffer_load_dwordx4 v[60:63], v65, s[4:7], s14 offen offset:0 nt
    buffer_load_dwordx4 v[56:59], v66, s[4:7], s14 offen offset:0 nt
    v_bitop3_b32 v77, v60, v56, s70 bitop3:0x7e
    v_and_b32 v77, 1, v77
    v_cmp_ne_u32 vcc, 0, v77
    s_cbranch_vccz cf_goA
    v_bitop3_b32 v77, v60, v56, s70 bitop3:0x7e
    v_and_b32 v77, 1, v77
    v_cmp_ne_u32 vcc, 0, v77
    s_cbranch_vccz cf_goA
    v_bitop3_b32 v77, v60, v56, s70 bitop3:0x7e
    v_and_b32 v77, 1, v77
    v_cmp_ne_u32 vcc, 0, v77
    s_cbranch_vccz cf_goA
    v_bitop3_b32 v77, v60, v56, s70 bitop3:0x7e
    v_and_b32 v77, 1, v77
    v_cmp_ne_u32 vcc, 0, v77
    s_cbranch_vccz cf_goA
    s_sub_u32 s31, s31, 64
    s_cbranch_scc0 cf_cA
cf_goA:
    ds_write_b128 v65, v[60:63] offset:0
    v_smfmac_f32_16x16x64_bf16 v[0:3], v[60:63], v[40:47], v64
    v_smfmac_f32_16x16x64_bf16 v[4:7], v[60:63], v[48:55], v64
    buffer_load_dwordx4 v[40:43], v65, s[4:7], s15 offen offset:0 nt
    v_smfmac_f32_16x16x64_bf16 v[0:3], v[56:59], v[24:31], v64
    v_smfmac_f32_16x16x64_bf16 v[4:7], v[56:59], v[32:39], v64
    ds_read_b128 v[24:27], v70 offset:8192
    v_smfmac_f32_16x16x64_bf16 v[8:11], v[60:63], a[96:103], v64
    ds_read_b128 v[28:31], v70 offset:9216
    v_smfmac_f32_16x16x64_bf16 v[12:15], v[60:63], a[104:111], v64
    ds_read_b128 v[32:35], v70 offset:10240
    s_waitcnt lgkmcnt(3)
    s_barrier
    ds_read_b128 v[48:51], v67 offset:0
    v_smfmac_f32_16x16x64_bf16 v[8:11], v[56:59], a[112:119], v64
    ds_read_b128 v[36:39], v70 offset:11264
    v_smfmac_f32_16x16x64_bf16 v[12:15], v[56:59], a[120:127], v64
    ds_read_b128 v[52:55], v68 offset:0
    v_smfmac_f32_16x16x64_bf16 v[16:19], v[60:63], a[216:223], v64
    buffer_load_dwordx4 v[40:43], v65, s[4:7], s15 offen offset:0 nt
    s_waitcnt lgkmcnt(4)
    v_smfmac_f32_16x16x64_bf16 v[20:23], v[60:63], v[24:31], v64
    ds_read_b128 v[24:27], v70 offset:12288
    s_waitcnt lgkmcnt(3)
    v_smfmac_f32_16x16x64_bf16 v[0:3], v[48:51], a[0:7], v64
    ds_read_b128 v[28:31], v70 offset:13312
    s_waitcnt lgkmcnt(3)
    v_smfmac_f32_16x16x64_bf16 v[4:7], v[48:51], v[32:39], v64
    ds_read_b128 v[32:35], v70 offset:14336
    v_smfmac_f32_16x16x64_bf16 v[8:11], v[48:51], a[128:135], v64
    ds_read_b128 v[36:39], v70 offset:15360
    v_smfmac_f32_16x16x64_bf16 v[12:15], v[48:51], a[136:143], v64
    v_smfmac_f32_16x16x64_bf16 v[16:19], v[56:59], a[224:231], v64
    v_smfmac_f32_16x16x64_bf16 v[20:23], v[56:59], a[232:239], v64
    s_waitcnt lgkmcnt(2)
    s_waitcnt vmcnt(1)
    v_and_b32 v77, 1, v40
    v_smfmac_f32_16x16x64_bf16 v[12:15], v[52:55], v[24:31], v64
    ds_write_b128 v65, v[40:43] offset:4096
    v_smfmac_f32_16x16x64_bf16 v[0:3], v[52:55], a[8:15], v64
    s_waitcnt lgkmcnt(1)
    v_cmp_ne_u32 vcc, s70, v77
    v_smfmac_f32_16x16x64_bf16 v[4:7], v[52:55], v[32:39], v64
    buffer_load_dwordx4 v[60:63], v65, s[4:7], s16 offen offset:0 nt
    v_smfmac_f32_16x16x64_bf16 v[8:11], v[52:55], a[144:151], v64
    s_cbranch_vccnz cf_spinB
cf_backB:
    v_smfmac_f32_16x16x64_bf16 v[16:19], v[40:43], v[176:183], v64
    s_waitcnt lgkmcnt(0)
    s_barrier
    ds_read_b128 v[44:47], v66 offset:4096
    v_smfmac_f32_16x16x64_bf16 v[12:15], v[40:43], a[160:167], v64
    ds_read_b128 v[32:35], v70 offset:16384
    buffer_load_dwordx4 v[24:27], v65, s[4:7], s24 offen offset:0 sc1
    v_smfmac_f32_16x16x64_bf16 v[0:3], v[40:43], a[16:23], v64
    ds_read_b128 v[36:39], v70 offset:17408
    v_smfmac_f32_16x16x64_bf16 v[8:11], v[40:43], a[152:159], v64
    ds_read_b128 v[48:51], v67 offset:4096
    v_smfmac_f32_16x16x64_bf16 v[4:7], v[40:43], a[24:31], v64
    ds_read_b128 v[52:55], v68 offset:4096
    v_smfmac_f32_16x16x64_bf16 v[20:23], v[40:43], v[184:191], v64
    buffer_load_dwordx4 v[28:31], v65, s[4:7], s24 offen offset:1024 sc1
    s_waitcnt lgkmcnt(4)
    v_smfmac_f32_16x16x64_bf16 v[0:3], v[44:47], a[32:39], v64
    ds_read_b128 v[56:59], v69 offset:15360
    s_waitcnt lgkmcnt(3)
    v_smfmac_f32_16x16x64_bf16 v[8:11], v[44:47], v[32:39], v64
    ds_read_b128 v[32:35], v70 offset:18432
    v_smfmac_f32_16x16x64_bf16 v[4:7], v[44:47], a[40:47], v64
    ds_read_b128 v[36:39], v70 offset:19456
    s_add_u32 s40, s26, 1048576
    v_lshlrev_b32 v78, 2, v65
    v_smfmac_f32_16x16x64_bf16 v[12:15], v[44:47], a[168:175], v64
    buffer_load_dwordx4 v[42:45], v65, s[4:7], s24 offen offset:3072 sc1
    s_waitcnt lgkmcnt(3)
    v_smfmac_f32_16x16x64_bf16 v[0:3], v[48:51], a[48:55], v64
    v_smfmac_f32_16x16x64_bf16 v[8:11], v[48:51], a[176:183], v64
    v_smfmac_f32_16x16x64_bf16 v[0:3], v[52:55], a[64:71], v64
    s_waitcnt lgkmcnt(0)
    v_smfmac_f32_16x16x64_bf16 v[8:11], v[52:55], v[32:39], v64
    buffer_load_dwordx4 v[34:37], v65, s[4:7], s24 offen offset:2048 sc1
    v_smfmac_f32_16x16x64_bf16 v[4:7], v[48:51], a[56:63], v64
    v_smfmac_f32_16x16x64_bf16 v[4:7], v[52:55], a[72:79], v64
    s_waitcnt vmcnt(4)
    v_and_b32 v77, 1, v60
    v_smfmac_f32_16x16x64_bf16 v[12:15], v[48:51], a[184:191], v64
    v_cmp_ne_u32 vcc, s70, v77
    v_smfmac_f32_16x16x64_bf16 v[12:15], v[52:55], a[192:199], v64
    s_cbranch_vccnz cf_spin8
cf_back8:
    v_smfmac_f32_16x16x64_bf16 v[0:3], v[60:63], a[80:87], v64
    s_nop 1
    v_lshrrev_b32 v77, 1, v69
    v_smfmac_f32_16x16x64_bf16 v[8:11], v[60:63], a[200:207], v64
    buffer_load_dword v76, v78, s[4:7], s40 offen sc1
    s_nop 1
    v_smfmac_f32_16x16x64_bf16 v[4:7], v[60:63], a[88:95], v64
    s_nop 1
    v_cvt_pk_bf16_f32 v0, v0, v1
    v_smfmac_f32_16x16x64_bf16 v[12:15], v[60:63], a[208:215], v64
    s_nop 1
    v_cvt_pk_bf16_f32 v1, v2, v3
    v_cvt_pk_bf16_f32 v2, v8, v9
    v_cvt_pk_bf16_f32 v3, v10, v11
    v_cvt_pk_bf16_f32 v4, v4, v5
    v_cvt_pk_bf16_f32 v5, v6, v7
    v_mfma_f32_16x16x32_bf16 v[8:11], v[0:3], v[56:59], 0
    v_cvt_pk_bf16_f32 v6, v12, v13
    v_cvt_pk_bf16_f32 v7, v14, v15
    s_nop 1
    v_mfma_f32_16x16x32_bf16 v[12:15], v[4:7], v[56:59], 0
    ds_read_b128 v[56:59], v66 offset:4096
    s_nop 1
    v_smfmac_f32_16x16x64_bf16 v[16:19], v[48:51], v[208:215], v64
    s_waitcnt vmcnt(3)
    s_nop 1
    s_nop 0
    v_cvt_pk_bf16_f32 v0, v8, v12
    v_cvt_pk_bf16_f32 v1, v9, v13
    v_cvt_pk_bf16_f32 v2, v10, v14
    v_cvt_pk_bf16_f32 v3, v11, v15
    s_nop 1
    v_mfma_f32_16x16x32_bf16 v[12:15], v[0:3], v[0:3], 0
    s_nop 2
    v_mfma_f32_16x16x32_bf16 v[4:7], v[24:27], v[0:3], 0
    ds_read_b128 v[24:27], v67 offset:0
    s_nop 1
    v_mfma_f32_16x16x32_bf16 v[8:11], v[28:31], v[0:3], 0
    s_nop 0
    v_mov_b32_dpp v12, v14 row_ror:8 row_mask:0xf bank_mask:0xc
    v_mov_b32_dpp v13, v15 row_ror:8 row_mask:0xf bank_mask:0xc
    v_smfmac_f32_16x16x64_bf16 v[20:23], v[48:51], v[216:223], v64
    ds_write_b64 v71, v[12:13]
    ds_read_b128 v[48:51], v68 offset:0
    s_nop 1
    v_mov_b32_dpp v4, v8 row_ror:8 row_mask:0xf bank_mask:0xc
    v_mov_b32_dpp v5, v9 row_ror:8 row_mask:0xf bank_mask:0xc
    v_mov_b32_dpp v6, v10 row_ror:8 row_mask:0xf bank_mask:0xc
    v_mov_b32_dpp v7, v11 row_ror:8 row_mask:0xf bank_mask:0xc
    v_smfmac_f32_16x16x64_bf16 v[16:19], v[52:55], v[224:231], v64
    ds_write_b128 v65, v[4:7] offset:8192
    v_smfmac_f32_16x16x64_bf16 v[20:23], v[52:55], v[232:239], v64
    s_waitcnt lgkmcnt(3)
    v_smfmac_f32_16x16x64_bf16 v[16:19], v[24:27], a[240:247], v64
    v_smfmac_f32_16x16x64_bf16 v[20:23], v[24:27], a[248:255], v64
    v_smfmac_f32_16x16x64_bf16 v[16:19], v[60:63], v[240:247], v64
    s_waitcnt lgkmcnt(0)
    s_barrier
    ds_read_b128 v[8:11], v66 offset:8192
    v_smfmac_f32_16x16x64_bf16 v[20:23], v[60:63], v[248:255], v64
    ds_read_b128 v[12:15], v67 offset:8192
    ds_read_b128 v[0:3], v68 offset:8192
    ds_read_b64 v[24:25], v77 offset:14336
    v_smfmac_f32_16x16x64_bf16 v[16:19], v[56:59], v[192:199], v64
    ds_read_b64 v[26:27], v77 offset:14592
    ds_read_b64 v[28:29], v77 offset:14848
    ds_read_b64 v[30:31], v77 offset:15104
    v_smfmac_f32_16x16x64_bf16 v[20:23], v[56:59], v[200:207], v64
    s_waitcnt vmcnt(1)
    v_smfmac_f32_16x16x64_bf16 v[16:19], v[48:51], v[160:167], v64
    s_mov_b64 exec, s[36:37]
    buffer_store_dword v72, v75, s[4:7], s28 offen sc1
    s_mov_b64 exec, -1
    v_smfmac_f32_16x16x64_bf16 v[20:23], v[48:51], v[168:175], v64
    ds_read_b128 v[56:59], v70 offset:22528
    ds_read_b128 v[60:63], v70 offset:23552
    s_cmp_lt_u32 s97, s93
    s_cbranch_scc1 cf_kvasync
cf_kvasync_x:
    s_waitcnt lgkmcnt(8)
    v_pk_add_f32 v[4:5], v[4:5], v[8:9]
    v_pk_add_f32 v[6:7], v[6:7], v[10:11]
    s_waitcnt lgkmcnt(6)
    v_pk_add_f32 v[12:13], v[12:13], v[0:1]
    v_pk_add_f32 v[14:15], v[14:15], v[2:3]
    v_pk_add_f32 v[4:5], v[4:5], v[12:13]
    v_pk_add_f32 v[6:7], v[6:7], v[14:15]
    s_waitcnt lgkmcnt(2)
    v_pk_add_f32 v[24:25], v[24:25], v[26:27]
    v_pk_add_f32 v[28:29], v[28:29], v[30:31]
    v_max3_f32 v77, v4, v5, v6
    v_pk_add_f32 v[24:25], v[24:25], v[28:29]
    v_max_f32 v77, v77, v7
    v_max3_f32 v77, v77, v24, v25
    v_cvt_pk_bf16_f32 v32, v16, v17
    v_cvt_pk_bf16_f32 v38, v18, v19
    v_max_f32_dpp v77, v77, v77 row_ror:8 row_mask:0xf bank_mask:0xf
    v_mov_b32 v78, v77
    v_cvt_pk_bf16_f32 v40, v20, v21
    v_cvt_pk_bf16_f32 v46, v22, v23
    v_permlane32_swap_b32 v77, v78
    v_max_f32 v77, v77, v78
    v_mov_b32 v78, v77
    v_mov_b32 v11, 0
    v_mov_b32 v15, 0
    v_permlane16_swap_b32 v77, v78
    v_max_f32 v77, v77, v78
    v_mul_f32 v8, s66, v77
    v_pk_fma_f32 v[4:5], v[4:5], s[44:45], v[8:9] op_sel_hi:[1,1,0]
    v_pk_fma_f32 v[6:7], v[6:7], s[44:45], v[8:9] op_sel_hi:[1,1,0]
    v_pk_fma_f32 v[24:25], v[24:25], s[44:45], v[8:9] op_sel_hi:[1,1,0]
    v_exp_f32 v4, v4
    v_exp_f32 v5, v5
    v_exp_f32 v6, v6
    v_exp_f32 v7, v7
    v_exp_f32 v24, v24
    v_exp_f32 v25, v25
    v_cvt_pk_bf16_f32 v12, v4, v5
    v_cvt_pk_bf16_f32 v13, v6, v7
    v_cvt_pk_bf16_f32 v10, v24, v25
    v_cvt_pk_bf16_f32 v14, v24, v25
    v_bitop3_b32 v77, v73, -9, s52 bitop3:0x6a
    v_mfma_f32_16x16x32_bf16 v[4:7], v[32:35], v[10:13], 0
    ds_read_b128 v[48:51], v70 offset:20480
    v_mov_b64 v[0:1], s[48:49]
    v_mov_b64 v[2:3], s[50:51]
    v_mfma_f32_16x16x32_bf16 v[24:27], v[36:39], v[12:15], 0
    ds_read_b128 v[52:55], v70 offset:21504
    v_bitop3_b32 v78, v73, -9, s53 bitop3:0x6a
    v_bitop3_b32 v79, v73, -9, s54 bitop3:0x6a
    v_mfma_f32_16x16x32_bf16 v[28:31], v[0:3], v[10:13], 0
    ds_read_b128 v[32:35], v70 offset:24576
    v_mov_b64 v[0:1], 0
    v_mov_b64 v[2:3], 0
    v_mfma_f32_16x16x32_bf16 v[16:19], v[40:43], v[10:13], 0
    ds_read_b128 v[36:39], v70 offset:25600
    v_mov_b64 v[8:9], 0
    s_nop 0
    v_mfma_f32_16x16x32_bf16 v[20:23], v[44:47], v[12:15], 0
    ds_read_b128 v[40:43], v70 offset:26624
    ds_read_b128 v[44:47], v70 offset:27648
    v_add_f32_dpp v4, v24, v4 row_ror:8 row_mask:0xf bank_mask:0xf
    v_add_f32_dpp v5, v25, v5 row_ror:8 row_mask:0xf bank_mask:0xf
    v_add_f32_dpp v6, v26, v6 row_ror:8 row_mask:0xf bank_mask:0xf
    v_add_f32_dpp v7, v27, v7 row_ror:8 row_mask:0xf bank_mask:0xf
    v_add_f32_dpp v29, v28, v28 row_ror:8 row_mask:0xf bank_mask:0xf
    v_rcp_f32 v28, v29
    v_add_f32_dpp v4, v16, v20 row_ror:8 row_mask:0xf bank_mask:0xc
    v_add_f32_dpp v5, v17, v21 row_ror:8 row_mask:0xf bank_mask:0xc
    v_add_f32_dpp v6, v18, v22 row_ror:8 row_mask:0xf bank_mask:0xc
    v_add_f32_dpp v7, v19, v23 row_ror:8 row_mask:0xf bank_mask:0xc
    v_pk_mul_f32 v[4:5], v[4:5], v[28:29] op_sel_hi:[1,0]
    v_pk_mul_f32 v[6:7], v[6:7], v[28:29] op_sel_hi:[1,0]
    v_cvt_pk_bf16_f32 v4, v4, v5
    v_cvt_pk_bf16_f32 v5, v6, v7
    ds_write_b64 v73, v[4:5] offset:12288
    v_mov_b32_dpp v6, v4 row_ror:8 row_mask:0xf bank_mask:0xf
    v_mov_b32_dpp v7, v5 row_ror:8 row_mask:0xf bank_mask:0xf
    v_mov_b64 v[10:11], 0
    s_waitcnt lgkmcnt(5)
    v_mov_b64 v[12:13], 0
    v_smfmac_f32_16x16x64_bf16 v[0:3], v[4:7], v[48:55], v64
    v_mov_b64 v[14:15], 0
    v_mov_b32 v52, v78
    v_smfmac_f32_16x16x64_bf16 v[8:11], v[4:7], v[80:87], v64
    v_mov_b64 v[24:25], 0
    v_mov_b64 v[26:27], 0
    v_smfmac_f32_16x16x64_bf16 v[12:15], v[4:7], v[112:119], v64
    s_waitcnt lgkmcnt(0)
    v_mov_b32_dpp v52, v79 quad_perm:[0,1,2,3] row_mask:0xf bank_mask:0xc
    v_xor_b32 v48, 1024, v52
    s_barrier
    ds_read_b128 v[16:19], v77 offset:12288
    v_smfmac_f32_16x16x64_bf16 v[24:27], v[4:7], v[56:63], v64
    ds_read_b128 v[20:23], v78 offset:12288
    ds_read_b128 v[28:31], v79 offset:12288
    ds_read_b128 v[52:55], v52 offset:12288
    ds_read_b128 v[48:51], v48 offset:12288
    v_mov_b64 v[4:5], 0
    v_mov_b64 v[6:7], 0
    s_waitcnt lgkmcnt(4)
    v_smfmac_f32_16x16x64_bf16 v[8:11], v[16:19], v[88:95], v64
    ds_read_b128 v[56:59], v70 offset:28672
    v_smfmac_f32_16x16x64_bf16 v[12:15], v[16:19], v[120:127], v64
    ds_read_b128 v[60:63], v70 offset:29696
    s_waitcnt lgkmcnt(5)
    v_smfmac_f32_16x16x64_bf16 v[8:11], v[20:23], v[96:103], v64
    v_bfe_u32 v77, v74, 16, 1
    v_smfmac_f32_16x16x64_bf16 v[12:15], v[20:23], v[128:135], v64
    s_waitcnt lgkmcnt(4)
    v_mad_i32_i24 v77, v77, s56, v74
    v_smfmac_f32_16x16x64_bf16 v[8:11], v[28:31], v[104:111], v64
    s_nop 2
    v_smfmac_f32_16x16x64_bf16 v[12:15], v[28:31], v[136:143], v64
    s_waitcnt lgkmcnt(2)
    s_nop 1
    v_smfmac_f32_16x16x64_bf16 v[4:7], v[48:51], v[144:151], v64
    v_cvt_pk_bf16_f32 v8, v8, v9
    v_cvt_pk_bf16_f32 v9, v10, v11
    v_and_or_b32 v8, v8, -2, s69
    s_nop 0
    v_cvt_pk_bf16_f32 v10, v12, v13
    v_cvt_pk_bf16_f32 v11, v14, v15
    v_smfmac_f32_16x16x64_bf16 v[4:7], v[52:55], v[152:159], v64
    buffer_store_dwordx4 v[8:11], v74, s[4:7], s22 offen
    ds_read_b128 v[48:51], v70 offset:30720
    v_smfmac_f32_16x16x64_bf16 v[0:3], v[16:19], v[32:39], v64
    ds_read_b128 v[52:55], v70 offset:31744
    s_add_u32 s30, s30, 1
    s_waitcnt lgkmcnt(2)
    v_smfmac_f32_16x16x64_bf16 v[24:27], v[16:19], v[40:47], v64
    ds_read_b128 v[32:35], v70 offset:32768
    v_cvt_pk_bf16_f32 v4, v4, v5
    v_cvt_pk_bf16_f32 v5, v6, v7
    v_and_or_b32 v4, v4, -2, s69
    v_smfmac_f32_16x16x64_bf16 v[0:3], v[20:23], v[56:63], v64
    buffer_store_dwordx2 v[4:5], v77, s[4:7], s25 offen
    ds_read_b128 v[36:39], v70 offset:33792
    s_xor_b32 s70, s70, 1
    ds_read_b128 v[40:43], v70 offset:34816
    s_waitcnt lgkmcnt(3)
    v_smfmac_f32_16x16x64_bf16 v[24:27], v[20:23], v[48:55], v64
    ds_read_b128 v[44:47], v70 offset:35840
    s_cmp_eq_u32 s30, 63
    s_cselect_b32 s57, 7, s71
    s_waitcnt lgkmcnt(2)
    v_smfmac_f32_16x16x64_bf16 v[0:3], v[28:31], v[32:39], v64
    s_cmp_lg_u32 s57, 0
    s_waitcnt lgkmcnt(0)
    s_nop 0
    v_smfmac_f32_16x16x64_bf16 v[24:27], v[28:31], v[40:47], v64
    s_nop 3
    v_cvt_pk_bf16_f32 v0, v0, v1
    v_cvt_pk_bf16_f32 v1, v2, v3
    v_and_or_b32 v0, v0, -2, s69
    s_nop 0
    v_cvt_pk_bf16_f32 v2, v24, v25
    v_cvt_pk_bf16_f32 v3, v26, v27
    buffer_store_dwordx4 v[0:3], v74, s[4:7], s23 offen
    s_cbranch_scc1 cf_e1
    s_nop 0
    s_nop 2
    v_mov_b32 v79, v79
    s_nop 2
    v_mov_b32 v79, v79
    s_nop 2
    v_mov_b32 v79, v79
    s_nop 2
    v_mov_b32 v79, v79
    s_nop 2
    v_mov_b32 v79, v79
    s_nop 2
    v_mov_b32 v79, v79
    s_nop 2
    v_mov_b32 v79, v79
    s_nop 2
    v_mov_b32 v79, v79
    buffer_load_dwordx4 v[8:11], v65, s[4:7], s18 offen nt
    buffer_load_dwordx4 v[12:15], v65, s[4:7], s19 offen nt
    buffer_load_dwordx4 v[16:19], v65, s[4:7], s20 offen nt
    buffer_load_dwordx4 v[20:23], v65, s[4:7], s21 offen nt
    v_and_b32 v77, 255, v69
    ds_read_b128 v[4:7], v77 offset:15872
    ds_read_b128 v[40:43], v70 offset:0
    ds_read_b128 v[44:47], v70 offset:1024
    ds_read_b128 v[48:51], v70 offset:2048
    ds_read_b128 v[52:55], v70 offset:3072
    ds_read_b128 v[24:27], v70 offset:4096
    ds_read_b128 v[28:31], v70 offset:5120
    ds_read_b128 v[32:35], v70 offset:6144
    ds_read_b128 v[36:39], v70 offset:7168
    s_mov_b32 s31, 65536
    s_add_u32 s24, s24, 524288
    s_add_u32 s26, s26, 524288
    s_add_u32 s28, s28, s27
    v_mov_b32 v60, s69
    v_mov_b32 v56, s69
    v_and_b32 v79, 12, v75
    v_cmp_eq_u32 vcc, 0, v79
    s_nop 1
    v_cndmask_b32 v79, 0, 1, vcc
    s_waitcnt lgkmcnt(0)
    s_waitcnt vmcnt(3)
    v_xor_b32 v77, s69, v8
    v_mfma_f32_16x16x32_bf16 v[0:3], v[4:7], v[8:11], 0
    s_waitcnt vmcnt(2)
    v_bitop3_b32 v77, v77, v12, s69 bitop3:0xf6
    v_mfma_f32_16x16x32_bf16 v[0:3], v[4:7], v[12:15], v[0:3]
    s_waitcnt vmcnt(1)
    v_bitop3_b32 v77, v77, v16, s69 bitop3:0xf6
    v_mfma_f32_16x16x32_bf16 v[0:3], v[4:7], v[16:19], v[0:3]
    s_waitcnt vmcnt(0)
    v_bitop3_b32 v77, v77, v20, s69 bitop3:0xf6
    v_mfma_f32_16x16x32_bf16 v[0:3], v[4:7], v[20:23], v[0:3]
    v_and_b32 v77, 1, v77
    v_cmp_ne_u32 vcc, 0, v77
    s_nop 0
    s_cmp_eq_u64 vcc, 0
    s_cselect_b64 s[42:43], -1, 0
    s_nop 2
    v_add_f32_dpp v0, v0, v0 row_ror:8 row_mask:0xf bank_mask:0xf
    v_add_f32_dpp v1, v1, v1 row_ror:8 row_mask:0xf bank_mask:0xf
    s_mov_b64 exec, s[42:43]
    v_cvt_pk_bf16_f32 v72, v0, v1
    v_bfi_b32 v72, v79, s70, v72
    buffer_store_dword v72, v75, s[4:7], s17 offen offset:0
    s_mov_b64 exec, -1
    s_cbranch_scc0 cf_f0_retry
cf_f0_go:
    v_mov_b64 v[0:1], 0
    v_mov_b64 v[2:3], 0
    v_mov_b64 v[4:5], 0
    v_mov_b64 v[6:7], 0
    v_mov_b64 v[8:9], 0
    v_mov_b64 v[10:11], 0
    v_mov_b64 v[12:13], 0
    v_mov_b64 v[14:15], 0
    v_mov_b64 v[16:17], 0
    v_mov_b64 v[18:19], 0
    v_mov_b64 v[20:21], 0
    v_mov_b64 v[22:23], 0
    s_nop 2
    v_mov_b32 v79, v79
    s_nop 2
    v_mov_b32 v79, v79
    s_branch cf_loop
cf_e1:
    s_cmp_lg_u32 s57, 2
    s_cbranch_scc1 cf_f1
    s_nop 2
    v_mov_b32 v79, v79
    s_nop 2
    v_mov_b32 v79, v79
    s_nop 2
    v_mov_b32 v79, v79
    s_nop 2
    v_mov_b32 v79, v79
    s_nop 2
    v_mov_b32 v79, v79
    s_nop 2
    v_mov_b32 v79, v79
    s_nop 2
    v_mov_b32 v79, v79
    s_nop 2
    v_mov_b32 v79, v79
    s_nop 2
    v_mov_b32 v79, v79
    s_nop 2
    v_mov_b32 v79, v79
    s_nop 2
    v_mov_b32 v79, v79
    s_nop 2
    v_mov_b32 v79, v79
    buffer_load_dwordx4 v[8:11], v65, s[4:7], s18 offen nt
    buffer_load_dwordx4 v[12:15], v65, s[4:7], s19 offen nt
    buffer_load_dwordx4 v[16:19], v65, s[4:7], s20 offen nt
    buffer_load_dwordx4 v[20:23], v65, s[4:7], s21 offen nt
    v_and_b32 v77, 255, v69
    ds_read_b128 v[4:7], v77 offset:15872
    ds_read_b128 v[40:43], v70 offset:0
    ds_read_b128 v[44:47], v70 offset:1024
    ds_read_b128 v[48:51], v70 offset:2048
    ds_read_b128 v[52:55], v70 offset:3072
    ds_read_b128 v[24:27], v70 offset:4096
    ds_read_b128 v[28:31], v70 offset:5120
    ds_read_b128 v[32:35], v70 offset:6144
    ds_read_b128 v[36:39], v70 offset:7168
    s_mov_b32 s31, 65536
    s_add_u32 s24, s24, 524288
    s_add_u32 s26, s26, 524288
    s_add_u32 s28, s28, s27
    v_mov_b32 v60, s69
    v_mov_b32 v56, s69
    v_and_b32 v79, 12, v75
    v_cmp_eq_u32 vcc, 0, v79
    s_nop 1
    v_cndmask_b32 v79, 0, 1, vcc
    s_waitcnt lgkmcnt(0)
    s_waitcnt vmcnt(3)
    v_xor_b32 v77, s69, v8
    v_bitop3_b32 v77, v77, v10, s69 bitop3:0xf6
    v_mfma_f32_16x16x32_bf16 v[0:3], v[4:7], v[8:11], 0
    s_waitcnt vmcnt(2)
    v_bitop3_b32 v77, v77, v12, s69 bitop3:0xf6
    v_bitop3_b32 v77, v77, v14, s69 bitop3:0xf6
    v_mfma_f32_16x16x32_bf16 v[0:3], v[4:7], v[12:15], v[0:3]
    s_waitcnt vmcnt(1)
    v_bitop3_b32 v77, v77, v16, s69 bitop3:0xf6
    v_bitop3_b32 v77, v77, v18, s69 bitop3:0xf6
    v_mfma_f32_16x16x32_bf16 v[0:3], v[4:7], v[16:19], v[0:3]
    s_waitcnt vmcnt(0)
    v_bitop3_b32 v77, v77, v20, s69 bitop3:0xf6
    v_bitop3_b32 v77, v77, v22, s69 bitop3:0xf6
    v_mfma_f32_16x16x32_bf16 v[0:3], v[4:7], v[20:23], v[0:3]
    v_and_b32 v77, 1, v77
    v_cmp_ne_u32 vcc, 0, v77
    s_nop 0
    s_cmp_eq_u64 vcc, 0
    s_cselect_b64 s[42:43], -1, 0
    s_nop 2
    v_add_f32 v2, v0, v1
    s_nop 1
    v_add_f32_dpp v2, v2, v2 row_ror:8 row_mask:0xf bank_mask:0xf
    s_nop 1
    v_mov_b32_dpp v0, v2 quad_perm:[0,0,2,2] row_mask:0xf bank_mask:0xf
    v_mov_b32_dpp v1, v2 quad_perm:[1,1,3,3] row_mask:0xf bank_mask:0xf
    s_mov_b64 exec, s[42:43]
    v_cvt_pk_bf16_f32 v72, v0, v1
    v_bfi_b32 v72, v79, s70, v72
    buffer_store_dword v72, v75, s[4:7], s17 offen offset:0
    buffer_store_dword v72, v75, s[4:7], s17 offen offset:1024
    buffer_store_dword v72, v75, s[4:7], s17 offen offset:2048
    buffer_store_dword v72, v75, s[4:7], s17 offen offset:3072
    s_mov_b64 exec, -1
    s_cbranch_scc0 cf_f2_retry
cf_f2_go:
    v_mov_b64 v[0:1], 0
    v_mov_b64 v[2:3], 0
    v_mov_b64 v[4:5], 0
    v_mov_b64 v[6:7], 0
    v_mov_b64 v[8:9], 0
    v_mov_b64 v[10:11], 0
    v_mov_b64 v[12:13], 0
    v_mov_b64 v[14:15], 0
    v_mov_b64 v[16:17], 0
    v_mov_b64 v[18:19], 0
    v_mov_b64 v[20:21], 0
    v_mov_b64 v[22:23], 0
    s_branch cf_loop
cf_f1:
    s_cmp_eq_u32 s30, 63
    s_cbranch_scc1 cf_last
    s_cmp_lg_u32 s32, 1
    s_cbranch_scc1 cf_f3
    v_and_b32 v77, 255, v69
    ds_read_b128 v[4:7], v77 offset:15872
    ds_read_b128 v[40:43], v70 offset:0
    ds_read_b128 v[44:47], v70 offset:1024
    ds_read_b128 v[48:51], v70 offset:2048
    ds_read_b128 v[52:55], v70 offset:3072
    ds_read_b128 v[24:27], v70 offset:4096
    ds_read_b128 v[28:31], v70 offset:5120
    ds_read_b128 v[32:35], v70 offset:6144
    ds_read_b128 v[36:39], v70 offset:7168
    s_mov_b32 s31, 65536
    s_add_u32 s24, s24, 524288
    s_add_u32 s26, s26, 524288
    s_add_u32 s28, s28, s27
    v_mov_b32 v60, s69
    v_mov_b32 v56, s69
    v_and_b32 v79, 12, v75
    v_cmp_eq_u32 vcc, 0, v79
    s_nop 1
    v_cndmask_b32 v79, 0, 1, vcc
    s_nop 2
    v_mov_b32 v79, v79
    s_nop 2
    v_mov_b32 v79, v79
    s_nop 2
    v_mov_b32 v79, v79
    s_nop 2
    v_mov_b32 v79, v79
    s_nop 2
    v_mov_b32 v79, v79
    s_nop 2
    v_mov_b32 v79, v79
    s_nop 2
    v_mov_b32 v79, v79
    s_nop 2
    v_mov_b32 v79, v79
    s_nop 2
    v_mov_b32 v79, v79
    s_nop 2
    v_mov_b32 v79, v79
    s_nop 2
    v_mov_b32 v79, v79
    s_nop 2
    v_mov_b32 v79, v79
    s_nop 2
    v_mov_b32 v79, v79
    s_nop 2
    v_mov_b32 v79, v79
    s_waitcnt vmcnt(0)
    buffer_load_dwordx4 v[8:11], v65, s[4:7], s18 offen nt
    buffer_load_dwordx4 v[12:15], v65, s[4:7], s19 offen nt
    buffer_load_dwordx4 v[16:19], v65, s[4:7], s20 offen nt
    buffer_load_dwordx4 v[20:23], v65, s[4:7], s21 offen nt
    s_nop 2
    v_mov_b32 v79, v79
    s_nop 2
    v_mov_b32 v79, v79
    s_nop 2
    v_mov_b32 v79, v79
    s_nop 2
    v_mov_b32 v79, v79
    s_nop 2
    v_mov_b32 v79, v79
    s_nop 2
    v_mov_b32 v79, v79
    s_nop 2
    v_mov_b32 v79, v79
    s_nop 2
    v_mov_b32 v79, v79
    s_nop 2
    v_mov_b32 v79, v79
    s_nop 2
    v_mov_b32 v79, v79
    s_nop 2
    v_mov_b32 v79, v79
    s_nop 2
    v_mov_b32 v79, v79
    buffer_load_dwordx4 v[60:63], v65, s[4:7], s14 offen offset:0 nt
    buffer_load_dwordx4 v[56:59], v66, s[4:7], s14 offen offset:0 nt
    s_waitcnt lgkmcnt(0)
    s_waitcnt vmcnt(5)
    v_xor_b32 v77, s69, v8
    v_mfma_f32_16x16x32_bf16 v[0:3], v[4:7], v[8:11], 0
    s_waitcnt vmcnt(4)
    v_bitop3_b32 v77, v77, v12, s69 bitop3:0xf6
    v_mfma_f32_16x16x32_bf16 v[0:3], v[4:7], v[12:15], v[0:3]
    s_waitcnt vmcnt(3)
    v_bitop3_b32 v77, v77, v16, s69 bitop3:0xf6
    v_mfma_f32_16x16x32_bf16 v[0:3], v[4:7], v[16:19], v[0:3]
    s_waitcnt vmcnt(2)
    v_bitop3_b32 v77, v77, v20, s69 bitop3:0xf6
    v_mfma_f32_16x16x32_bf16 v[0:3], v[4:7], v[20:23], v[0:3]
    v_and_b32 v77, 1, v77
    v_cmp_ne_u32 vcc, 0, v77
    buffer_load_dwordx4 v[60:63], v65, s[4:7], s14 offen offset:0 nt
    buffer_load_dwordx4 v[56:59], v66, s[4:7], s14 offen offset:0 nt
    s_cmp_eq_u64 vcc, 0
    s_cselect_b64 s[42:43], -1, 0
    s_nop 1
    v_add_f32_dpp v0, v0, v0 row_ror:8 row_mask:0xf bank_mask:0xf
    v_add_f32_dpp v1, v1, v1 row_ror:8 row_mask:0xf bank_mask:0xf
    s_mov_b64 exec, s[42:43]
    v_cvt_pk_bf16_f32 v72, v0, v1
    v_bfi_b32 v72, v79, s70, v72
    buffer_store_dword v72, v75, s[4:7], s17 offen offset:0
    s_mov_b64 exec, -1
    s_cbranch_scc0 cf_f1_retry
cf_f1_go:
    v_mov_b64 v[0:1], 0
    v_mov_b64 v[2:3], 0
    v_mov_b64 v[4:5], 0
    v_mov_b64 v[6:7], 0
    v_mov_b64 v[8:9], 0
    v_mov_b64 v[10:11], 0
    v_mov_b64 v[12:13], 0
    v_mov_b64 v[14:15], 0
    v_mov_b64 v[16:17], 0
    v_mov_b64 v[18:19], 0
    v_mov_b64 v[20:21], 0
    v_mov_b64 v[22:23], 0
    s_branch cf_loop
cf_f3:
    v_and_b32 v77, 255, v69
    ds_read_b128 v[4:7], v77 offset:15872
    ds_read_b128 v[40:43], v70 offset:0
    ds_read_b128 v[44:47], v70 offset:1024
    ds_read_b128 v[48:51], v70 offset:2048
    ds_read_b128 v[52:55], v70 offset:3072
    ds_read_b128 v[24:27], v70 offset:4096
    ds_read_b128 v[28:31], v70 offset:5120
    ds_read_b128 v[32:35], v70 offset:6144
    ds_read_b128 v[36:39], v70 offset:7168
    s_mov_b32 s31, 65536
    s_add_u32 s24, s24, 524288
    s_add_u32 s26, s26, 524288
    s_add_u32 s28, s28, s27
    v_mov_b32 v60, s69
    v_mov_b32 v56, s69
    v_and_b32 v79, 12, v75
    v_cmp_eq_u32 vcc, 0, v79
    s_nop 1
    v_cndmask_b32 v79, 0, 1, vcc
    v_add_u32 v72, 1, v72
    s_waitcnt lgkmcnt(0)
    v_mov_b64 v[0:1], 0
    v_mov_b64 v[2:3], 0
    v_mov_b64 v[4:5], 0
    v_mov_b64 v[6:7], 0
    v_mov_b64 v[8:9], 0
    v_mov_b64 v[10:11], 0
    v_mov_b64 v[12:13], 0
    v_mov_b64 v[14:15], 0
    v_mov_b64 v[16:17], 0
    v_mov_b64 v[18:19], 0
    v_mov_b64 v[20:21], 0
    v_mov_b64 v[22:23], 0
    s_nop 2
    v_mov_b32 v79, v79
    s_nop 2
    v_mov_b32 v79, v79
    s_nop 2
    v_mov_b32 v79, v79
    s_nop 2
    v_mov_b32 v79, v79
    s_nop 2
    v_mov_b32 v79, v79
    s_nop 2
    v_mov_b32 v79, v79
    s_nop 2
    v_mov_b32 v79, v79
    s_nop 2
    v_mov_b32 v79, v79
    s_nop 2
    v_mov_b32 v79, v79
    s_nop 2
    v_mov_b32 v79, v79
    s_nop 2
    v_mov_b32 v79, v79
    s_nop 2
    v_mov_b32 v79, v79
    s_nop 2
    v_mov_b32 v79, v79
    s_nop 2
    v_mov_b32 v79, v79
    s_nop 2
    v_mov_b32 v79, v79
    s_nop 2
    v_mov_b32 v79, v79
    s_nop 2
    v_mov_b32 v79, v79
    s_nop 2
    v_mov_b32 v79, v79
    s_nop 2
    v_mov_b32 v79, v79
    s_nop 2
    v_mov_b32 v79, v79
    s_nop 2
    v_mov_b32 v79, v79
    s_nop 2
    v_mov_b32 v79, v79
    s_nop 0
    v_mov_b32 v79, v79
    s_branch cf_loop
cf_f0_retry:
cf_f0_spin:
    s_nop 0
    buffer_load_dwordx4 v[8:11], v65, s[4:7], s18 offen nt
    buffer_load_dwordx4 v[12:15], v65, s[4:7], s19 offen nt
    buffer_load_dwordx4 v[16:19], v65, s[4:7], s20 offen nt
    buffer_load_dwordx4 v[20:23], v65, s[4:7], s21 offen nt
    s_nop 2
    v_mov_b32 v79, v79
    s_nop 2
    v_mov_b32 v79, v79
    s_nop 2
    v_mov_b32 v79, v79
    s_nop 2
    v_mov_b32 v79, v79
    s_nop 2
    v_mov_b32 v79, v79
    s_nop 2
    v_mov_b32 v79, v79
    buffer_load_dwordx4 v[60:63], v65, s[4:7], s14 offen offset:0 nt
    buffer_load_dwordx4 v[56:59], v66, s[4:7], s14 offen offset:0 nt
    s_waitcnt vmcnt(5)
    v_xor_b32 v77, s69, v8
    v_mfma_f32_16x16x32_bf16 v[0:3], v[4:7], v[8:11], 0
    s_waitcnt vmcnt(4)
    v_bitop3_b32 v77, v77, v12, s69 bitop3:0xf6
    v_mfma_f32_16x16x32_bf16 v[0:3], v[4:7], v[12:15], v[0:3]
    s_waitcnt vmcnt(3)
    v_bitop3_b32 v77, v77, v16, s69 bitop3:0xf6
    v_mfma_f32_16x16x32_bf16 v[0:3], v[4:7], v[16:19], v[0:3]
    s_waitcnt vmcnt(2)
    v_bitop3_b32 v77, v77, v20, s69 bitop3:0xf6
    v_mfma_f32_16x16x32_bf16 v[0:3], v[4:7], v[20:23], v[0:3]
    v_and_b32 v77, 1, v77
    v_cmp_ne_u32 vcc, 0, v77
    buffer_load_dwordx4 v[60:63], v65, s[4:7], s14 offen offset:0 nt
    buffer_load_dwordx4 v[56:59], v66, s[4:7], s14 offen offset:0 nt
    s_cmp_eq_u64 vcc, 0
    s_cselect_b64 s[42:43], -1, 0
    s_nop 1
    v_add_f32_dpp v0, v0, v0 row_ror:8 row_mask:0xf bank_mask:0xf
    v_add_f32_dpp v1, v1, v1 row_ror:8 row_mask:0xf bank_mask:0xf
    s_mov_b64 exec, s[42:43]
    v_cvt_pk_bf16_f32 v72, v0, v1
    v_bfi_b32 v72, v79, s70, v72
    buffer_store_dword v72, v75, s[4:7], s17 offen offset:0
    s_mov_b64 exec, -1
    s_cbranch_scc1 cf_f0_rx
    s_sub_u32 s31, s31, 1
    s_cbranch_scc0 cf_f0_spin
cf_f0_rx:
    v_mov_b64 v[0:1], 0
    v_mov_b64 v[2:3], 0
    v_mov_b64 v[4:5], 0
    v_mov_b64 v[6:7], 0
    v_mov_b64 v[8:9], 0
    v_mov_b64 v[10:11], 0
    v_mov_b64 v[12:13], 0
    v_mov_b64 v[14:15], 0
    v_mov_b64 v[16:17], 0
    v_mov_b64 v[18:19], 0
    v_mov_b64 v[20:21], 0
    v_mov_b64 v[22:23], 0
    s_branch cf_loop
cf_f1_retry:
cf_f1_spin:
    s_nop 0
    buffer_load_dwordx4 v[8:11], v65, s[4:7], s18 offen nt
    buffer_load_dwordx4 v[12:15], v65, s[4:7], s19 offen nt
    buffer_load_dwordx4 v[16:19], v65, s[4:7], s20 offen nt
    buffer_load_dwordx4 v[20:23], v65, s[4:7], s21 offen nt
    s_nop 2
    v_mov_b32 v79, v79
    s_nop 2
    v_mov_b32 v79, v79
    s_nop 2
    v_mov_b32 v79, v79
    s_nop 2
    v_mov_b32 v79, v79
    s_nop 2
    v_mov_b32 v79, v79
    s_nop 2
    v_mov_b32 v79, v79
    buffer_load_dwordx4 v[60:63], v65, s[4:7], s14 offen offset:0 nt
    buffer_load_dwordx4 v[56:59], v66, s[4:7], s14 offen offset:0 nt
    s_waitcnt vmcnt(5)
    v_xor_b32 v77, s69, v8
    v_mfma_f32_16x16x32_bf16 v[0:3], v[4:7], v[8:11], 0
    s_waitcnt vmcnt(4)
    v_bitop3_b32 v77, v77, v12, s69 bitop3:0xf6
    v_mfma_f32_16x16x32_bf16 v[0:3], v[4:7], v[12:15], v[0:3]
    s_waitcnt vmcnt(3)
    v_bitop3_b32 v77, v77, v16, s69 bitop3:0xf6
    v_mfma_f32_16x16x32_bf16 v[0:3], v[4:7], v[16:19], v[0:3]
    s_waitcnt vmcnt(2)
    v_bitop3_b32 v77, v77, v20, s69 bitop3:0xf6
    v_mfma_f32_16x16x32_bf16 v[0:3], v[4:7], v[20:23], v[0:3]
    v_and_b32 v77, 1, v77
    v_cmp_ne_u32 vcc, 0, v77
    buffer_load_dwordx4 v[60:63], v65, s[4:7], s14 offen offset:0 nt
    buffer_load_dwordx4 v[56:59], v66, s[4:7], s14 offen offset:0 nt
    s_cmp_eq_u64 vcc, 0
    s_cselect_b64 s[42:43], -1, 0
    s_nop 1
    v_add_f32_dpp v0, v0, v0 row_ror:8 row_mask:0xf bank_mask:0xf
    v_add_f32_dpp v1, v1, v1 row_ror:8 row_mask:0xf bank_mask:0xf
    s_mov_b64 exec, s[42:43]
    v_cvt_pk_bf16_f32 v72, v0, v1
    v_bfi_b32 v72, v79, s70, v72
    buffer_store_dword v72, v75, s[4:7], s17 offen offset:0
    s_mov_b64 exec, -1
    s_cbranch_scc1 cf_f1_rx
    s_sub_u32 s31, s31, 1
    s_cbranch_scc0 cf_f1_spin
cf_f1_rx:
    v_mov_b64 v[0:1], 0
    v_mov_b64 v[2:3], 0
    v_mov_b64 v[4:5], 0
    v_mov_b64 v[6:7], 0
    v_mov_b64 v[8:9], 0
    v_mov_b64 v[10:11], 0
    v_mov_b64 v[12:13], 0
    v_mov_b64 v[14:15], 0
    v_mov_b64 v[16:17], 0
    v_mov_b64 v[18:19], 0
    v_mov_b64 v[20:21], 0
    v_mov_b64 v[22:23], 0
    s_branch cf_loop
cf_f2_retry:
cf_f2_spin:
    s_nop 0
    buffer_load_dwordx4 v[8:11], v65, s[4:7], s18 offen nt
    buffer_load_dwordx4 v[12:15], v65, s[4:7], s19 offen nt
    buffer_load_dwordx4 v[16:19], v65, s[4:7], s20 offen nt
    buffer_load_dwordx4 v[20:23], v65, s[4:7], s21 offen nt
    s_nop 2
    v_mov_b32 v79, v79
    s_nop 2
    v_mov_b32 v79, v79
    s_nop 2
    v_mov_b32 v79, v79
    s_nop 2
    v_mov_b32 v79, v79
    s_nop 2
    v_mov_b32 v79, v79
    s_nop 2
    v_mov_b32 v79, v79
    buffer_load_dwordx4 v[60:63], v65, s[4:7], s14 offen offset:0 nt
    buffer_load_dwordx4 v[56:59], v66, s[4:7], s14 offen offset:0 nt
    s_waitcnt vmcnt(5)
    v_xor_b32 v77, s69, v8
    v_bitop3_b32 v77, v77, v10, s69 bitop3:0xf6
    v_mfma_f32_16x16x32_bf16 v[0:3], v[4:7], v[8:11], 0
    s_waitcnt vmcnt(4)
    v_bitop3_b32 v77, v77, v12, s69 bitop3:0xf6
    v_bitop3_b32 v77, v77, v14, s69 bitop3:0xf6
    v_mfma_f32_16x16x32_bf16 v[0:3], v[4:7], v[12:15], v[0:3]
    s_waitcnt vmcnt(3)
    v_bitop3_b32 v77, v77, v16, s69 bitop3:0xf6
    v_bitop3_b32 v77, v77, v18, s69 bitop3:0xf6
    v_mfma_f32_16x16x32_bf16 v[0:3], v[4:7], v[16:19], v[0:3]
    s_waitcnt vmcnt(2)
    v_bitop3_b32 v77, v77, v20, s69 bitop3:0xf6
    v_bitop3_b32 v77, v77, v22, s69 bitop3:0xf6
    v_mfma_f32_16x16x32_bf16 v[0:3], v[4:7], v[20:23], v[0:3]
    v_and_b32 v77, 1, v77
    v_cmp_ne_u32 vcc, 0, v77
    buffer_load_dwordx4 v[60:63], v65, s[4:7], s14 offen offset:0 nt
    buffer_load_dwordx4 v[56:59], v66, s[4:7], s14 offen offset:0 nt
    s_cmp_eq_u64 vcc, 0
    s_cselect_b64 s[42:43], -1, 0
    s_nop 1
    v_add_f32 v2, v0, v1
    s_nop 1
    v_add_f32_dpp v2, v2, v2 row_ror:8 row_mask:0xf bank_mask:0xf
    s_nop 1
    v_mov_b32_dpp v0, v2 quad_perm:[0,0,2,2] row_mask:0xf bank_mask:0xf
    v_mov_b32_dpp v1, v2 quad_perm:[1,1,3,3] row_mask:0xf bank_mask:0xf
    s_mov_b64 exec, s[42:43]
    v_cvt_pk_bf16_f32 v72, v0, v1
    v_bfi_b32 v72, v79, s70, v72
    buffer_store_dword v72, v75, s[4:7], s17 offen offset:0
    buffer_store_dword v72, v75, s[4:7], s17 offen offset:1024
    buffer_store_dword v72, v75, s[4:7], s17 offen offset:2048
    buffer_store_dword v72, v75, s[4:7], s17 offen offset:3072
    s_mov_b64 exec, -1
    s_cbranch_scc1 cf_f2_rx
    s_sub_u32 s31, s31, 1
    s_cbranch_scc0 cf_f2_spin
cf_f2_rx:
    v_mov_b64 v[0:1], 0
    v_mov_b64 v[2:3], 0
    v_mov_b64 v[4:5], 0
    v_mov_b64 v[6:7], 0
    v_mov_b64 v[8:9], 0
    v_mov_b64 v[10:11], 0
    v_mov_b64 v[12:13], 0
    v_mov_b64 v[14:15], 0
    v_mov_b64 v[16:17], 0
    v_mov_b64 v[18:19], 0
    v_mov_b64 v[20:21], 0
    v_mov_b64 v[22:23], 0
    s_branch cf_loop
cf_l1_retry:
cf_l1_spin:
    s_nop 0
    buffer_load_dwordx4 v[8:11], v65, s[4:7], s18 offen nt
    buffer_load_dwordx4 v[12:15], v65, s[4:7], s19 offen nt
    buffer_load_dwordx4 v[16:19], v65, s[4:7], s20 offen nt
    buffer_load_dwordx4 v[20:23], v65, s[4:7], s21 offen nt
    s_waitcnt vmcnt(3)
    v_xor_b32 v77, s69, v8
    v_mfma_f32_16x16x32_bf16 v[0:3], v[4:7], v[8:11], 0
    s_waitcnt vmcnt(2)
    v_bitop3_b32 v77, v77, v12, s69 bitop3:0xf6
    v_mfma_f32_16x16x32_bf16 v[0:3], v[4:7], v[12:15], v[0:3]
    s_waitcnt vmcnt(1)
    v_bitop3_b32 v77, v77, v16, s69 bitop3:0xf6
    v_mfma_f32_16x16x32_bf16 v[0:3], v[4:7], v[16:19], v[0:3]
    s_waitcnt vmcnt(0)
    v_bitop3_b32 v77, v77, v20, s69 bitop3:0xf6
    v_mfma_f32_16x16x32_bf16 v[0:3], v[4:7], v[20:23], v[0:3]
    v_and_b32 v77, 1, v77
    v_cmp_ne_u32 vcc, 0, v77
    s_nop 0
    s_cmp_eq_u64 vcc, 0
    s_cselect_b64 s[42:43], -1, 0
    s_nop 2
    v_add_f32_dpp v0, v0, v0 row_ror:8 row_mask:0xf bank_mask:0xf
    v_add_f32_dpp v1, v1, v1 row_ror:8 row_mask:0xf bank_mask:0xf
    s_mov_b64 exec, s[42:43]
    v_cvt_pk_bf16_f32 v72, v0, v1
    buffer_store_dword v72, v75, s[4:7], s55 offen sc1
    s_mov_b64 exec, -1
    s_cbranch_scc1 cf_l1_rx
    s_sub_u32 s31, s31, 1
    s_cbranch_scc0 cf_l1_spin
cf_l1_rx:
    s_branch cf_l1_go
cf_l2_retry:
cf_l2_spin:
    buffer_load_dwordx4 v[8:11], v65, s[4:7], s18 offen nt
    buffer_load_dwordx4 v[12:15], v65, s[4:7], s19 offen nt
    buffer_load_dwordx4 v[16:19], v65, s[4:7], s20 offen nt
    buffer_load_dwordx4 v[20:23], v65, s[4:7], s21 offen nt
    s_waitcnt vmcnt(3)
    v_xor_b32 v77, s69, v8
    v_bitop3_b32 v77, v77, v10, s69 bitop3:0xf6
    v_mfma_f32_16x16x32_bf16 v[0:3], v[4:7], v[8:11], 0
    s_waitcnt vmcnt(2)
    v_bitop3_b32 v77, v77, v12, s69 bitop3:0xf6
    v_bitop3_b32 v77, v77, v14, s69 bitop3:0xf6
    v_mfma_f32_16x16x32_bf16 v[0:3], v[4:7], v[12:15], v[0:3]
    s_waitcnt vmcnt(1)
    v_bitop3_b32 v77, v77, v16, s69 bitop3:0xf6
    v_bitop3_b32 v77, v77, v18, s69 bitop3:0xf6
    v_mfma_f32_16x16x32_bf16 v[0:3], v[4:7], v[16:19], v[0:3]
    s_waitcnt vmcnt(0)
    v_bitop3_b32 v77, v77, v20, s69 bitop3:0xf6
    v_bitop3_b32 v77, v77, v22, s69 bitop3:0xf6
    v_mfma_f32_16x16x32_bf16 v[0:3], v[4:7], v[20:23], v[0:3]
    v_and_b32 v77, 1, v77
    v_cmp_ne_u32 vcc, 0, v77
    s_nop 0
    s_cmp_eq_u64 vcc, 0
    s_cselect_b64 s[42:43], -1, 0
    s_nop 2
    v_add_f32 v2, v0, v1
    s_nop 1
    v_add_f32_dpp v2, v2, v2 row_ror:8 row_mask:0xf bank_mask:0xf
    s_nop 1
    v_mov_b32_dpp v0, v2 quad_perm:[0,0,2,2] row_mask:0xf bank_mask:0xf
    v_mov_b32_dpp v1, v2 quad_perm:[1,1,3,3] row_mask:0xf bank_mask:0xf
    s_mov_b64 exec, s[42:43]
    v_cvt_pk_bf16_f32 v72, v0, v1
    buffer_store_dword v72, v75, s[4:7], s55 offen sc1
    s_mov_b64 exec, -1
    s_cbranch_scc1 cf_l2_rx
    s_sub_u32 s31, s31, 1
    s_cbranch_scc0 cf_l2_spin
cf_l2_rx:
    s_branch cf_l2_go
cf_spinB:
    buffer_load_dwordx4 v[40:43], v65, s[4:7], s15 offen nt
cf_spinB_l:
    v_and_b32 v77, 1, v40
    v_cmp_ne_u32 vcc, s70, v77
    s_cbranch_vccz cf_spinB_x
    s_nop 1
    v_and_b32 v77, 1, v40
    v_cmp_ne_u32 vcc, s70, v77
    s_cbranch_vccz cf_spinB_x
    s_nop 1
    v_and_b32 v77, 1, v40
    v_cmp_ne_u32 vcc, s70, v77
    s_cbranch_vccz cf_spinB_x
    s_nop 1
    buffer_load_dwordx4 v[40:43], v65, s[4:7], s15 offen nt
    s_sub_u32 s31, s31, 16
    s_cbranch_scc0 cf_spinB_l
cf_spinB_x:
    ds_write_b128 v65, v[40:43] offset:4096
    s_waitcnt lgkmcnt(0)
    s_branch cf_backB
cf_spin8:
    buffer_load_dwordx4 v[60:63], v65, s[4:7], s16 offen nt
cf_spin8_l:
    v_and_b32 v77, 1, v60
    v_cmp_ne_u32 vcc, s70, v77
    s_cbranch_vccz cf_spin8_x
    s_nop 1
    v_and_b32 v77, 1, v60
    v_cmp_ne_u32 vcc, s70, v77
    s_cbranch_vccz cf_spin8_x
    s_nop 1
    v_and_b32 v77, 1, v60
    v_cmp_ne_u32 vcc, s70, v77
    s_cbranch_vccz cf_spin8_x
    s_nop 1
    buffer_load_dwordx4 v[60:63], v65, s[4:7], s16 offen nt
    s_sub_u32 s31, s31, 16
    s_cbranch_scc0 cf_spin8_l
cf_spin8_x:
    s_branch cf_back8
cf_kvasync:
    v_bfe_u32 v78, v65, 2, 8
    s_mov_b64 exec, 0xffff
    buffer_load_dword v78, s[4:7], s96 offen sc1 lds
    s_mov_b64 exec, -1
    s_branch cf_kvasync_x
cf_kvwait:
    s_sub_u32 s41, s40, 1
    s_lshr_b32 s41, s41, 4
    s_lshl_b32 s41, s41, 2
    s_add_u32 s41, s41, 16128
    v_mov_b32 v79, s41
    ds_read_b32 v77, v79 offset:16
    ds_read_b32 v78, v79 offset:32
    s_waitcnt lgkmcnt(0)
    v_subrev_u32 v77, s95, v77
    v_subrev_u32 v78, s95, v78
    v_cmp_lt_u32 vcc, 64, v77
    s_nop 1
    v_cndmask_b32 v77, v77, 0, vcc
    v_cmp_lt_u32 vcc, 64, v78
    s_nop 1
    v_cndmask_b32 v78, v78, 0, vcc
    v_min_u32 v77, v77, v78
    s_nop 0
    v_readfirstlane_b32 s97, v77
    s_nop 0
    s_cmp_le_u32 s40, s97
    s_cbranch_scc1 cf_kvw_x
    s_sub_u32 s41, s40, 1
    s_lshr_b32 s41, s41, 4
    s_lshl_b32 s41, s41, 2
    s_add_u32 s41, s41, s96
    s_mov_b32 s31, 4194304
cf_kvw:
    buffer_load_dword v77, off, s[4:7], s41 offset:16 sc1
    buffer_load_dword v78, off, s[4:7], s41 offset:32 sc1
    s_waitcnt vmcnt(0)
    v_subrev_u32 v77, s95, v77
    v_subrev_u32 v78, s95, v78
    v_cmp_lt_u32 vcc, 64, v77
    s_nop 1
    v_cndmask_b32 v77, v77, 0, vcc
    v_cmp_lt_u32 vcc, 64, v78
    s_nop 1
    v_cndmask_b32 v78, v78, 0, vcc
    v_min_u32 v77, v77, v78
    s_nop 0
    v_readfirstlane_b32 s97, v77
    s_sub_u32 s31, s31, 1
    s_cbranch_scc1 cf_kvw_x
    s_cmp_le_u32 s40, s97
    s_cbranch_scc1 cf_kvw_x
    s_sleep 4
    s_branch cf_kvw
cf_kvw_x:
    s_branch cf_kvok
cf_last:
    s_cmp_lg_u32 s32, 1
    s_cbranch_scc1 cf_last2
    s_nop 2
    v_mov_b32 v79, v79
    s_nop 2
    v_mov_b32 v79, v79
    s_nop 2
    v_mov_b32 v79, v79
    s_nop 2
    v_mov_b32 v79, v79
    s_nop 2
    v_mov_b32 v79, v79
    s_nop 2
    v_mov_b32 v79, v79
    s_nop 2
    v_mov_b32 v79, v79
    s_nop 2
    v_mov_b32 v79, v79
    s_nop 2
    v_mov_b32 v79, v79
    s_nop 2
    v_mov_b32 v79, v79
    s_nop 2
    v_mov_b32 v79, v79
    s_nop 2
    v_mov_b32 v79, v79
    s_nop 2
    v_mov_b32 v79, v79
    s_nop 2
    v_mov_b32 v79, v79
    buffer_load_dwordx4 v[8:11], v65, s[4:7], s18 offen nt
    buffer_load_dwordx4 v[12:15], v65, s[4:7], s19 offen nt
    buffer_load_dwordx4 v[16:19], v65, s[4:7], s20 offen nt
    buffer_load_dwordx4 v[20:23], v65, s[4:7], s21 offen nt
    v_and_b32 v77, 255, v69
    ds_read_b128 v[4:7], v77 offset:15872
    ds_read_b128 v[40:43], v70 offset:0
    ds_read_b128 v[44:47], v70 offset:1024
    ds_read_b128 v[48:51], v70 offset:2048
    ds_read_b128 v[52:55], v70 offset:3072
    ds_read_b128 v[24:27], v70 offset:4096
    ds_read_b128 v[28:31], v70 offset:5120
    ds_read_b128 v[32:35], v70 offset:6144
    ds_read_b128 v[36:39], v70 offset:7168
    s_mov_b32 s31, 65536
    s_add_u32 s24, s24, 524288
    s_add_u32 s26, s26, 524288
    s_add_u32 s28, s28, s27
    v_mov_b32 v60, s69
    v_mov_b32 v56, s69
    v_and_b32 v79, 12, v75
    v_cmp_eq_u32 vcc, 0, v79
    s_nop 1
    v_cndmask_b32 v79, 0, 1, vcc
    s_waitcnt lgkmcnt(0)
    s_waitcnt vmcnt(3)
    v_xor_b32 v77, s69, v8
    v_mfma_f32_16x16x32_bf16 v[0:3], v[4:7], v[8:11], 0
    s_waitcnt vmcnt(2)
    v_bitop3_b32 v77, v77, v12, s69 bitop3:0xf6
    v_mfma_f32_16x16x32_bf16 v[0:3], v[4:7], v[12:15], v[0:3]
    s_waitcnt vmcnt(1)
    v_bitop3_b32 v77, v77, v16, s69 bitop3:0xf6
    v_mfma_f32_16x16x32_bf16 v[0:3], v[4:7], v[16:19], v[0:3]
    s_waitcnt vmcnt(0)
    v_bitop3_b32 v77, v77, v20, s69 bitop3:0xf6
    v_mfma_f32_16x16x32_bf16 v[0:3], v[4:7], v[20:23], v[0:3]
    v_and_b32 v77, 1, v77
    v_cmp_ne_u32 vcc, 0, v77
    s_nop 0
    s_cmp_eq_u64 vcc, 0
    s_cselect_b64 s[42:43], -1, 0
    s_nop 2
    v_add_f32_dpp v0, v0, v0 row_ror:8 row_mask:0xf bank_mask:0xf
    v_add_f32_dpp v1, v1, v1 row_ror:8 row_mask:0xf bank_mask:0xf
    s_mov_b64 exec, s[42:43]
    v_cvt_pk_bf16_f32 v72, v0, v1
    buffer_store_dword v72, v75, s[4:7], s55 offen sc1
    s_mov_b64 exec, -1
    s_cbranch_scc0 cf_l1_retry
cf_l1_go:
    s_branch cf_fin
cf_last2:
    s_cmp_lg_u32 s32, 2
    s_cbranch_scc1 cf_fin
    s_nop 2
    v_mov_b32 v79, v79
    s_nop 2
    v_mov_b32 v79, v79
    s_nop 2
    v_mov_b32 v79, v79
    s_nop 2
    v_mov_b32 v79, v79
    s_nop 2
    v_mov_b32 v79, v79
    s_nop 2
    v_mov_b32 v79, v79
    s_nop 2
    v_mov_b32 v79, v79
    s_nop 2
    v_mov_b32 v79, v79
    s_nop 2
    v_mov_b32 v79, v79
    s_nop 2
    v_mov_b32 v79, v79
    s_nop 2
    v_mov_b32 v79, v79
    s_nop 2
    v_mov_b32 v79, v79
    s_nop 2
    v_mov_b32 v79, v79
    s_nop 2
    v_mov_b32 v79, v79
    buffer_load_dwordx4 v[8:11], v65, s[4:7], s18 offen nt
    buffer_load_dwordx4 v[12:15], v65, s[4:7], s19 offen nt
    buffer_load_dwordx4 v[16:19], v65, s[4:7], s20 offen nt
    buffer_load_dwordx4 v[20:23], v65, s[4:7], s21 offen nt
    v_and_b32 v77, 255, v69
    ds_read_b128 v[4:7], v77 offset:15872
    ds_read_b128 v[40:43], v70 offset:0
    ds_read_b128 v[44:47], v70 offset:1024
    ds_read_b128 v[48:51], v70 offset:2048
    ds_read_b128 v[52:55], v70 offset:3072
    ds_read_b128 v[24:27], v70 offset:4096
    ds_read_b128 v[28:31], v70 offset:5120
    ds_read_b128 v[32:35], v70 offset:6144
    ds_read_b128 v[36:39], v70 offset:7168
    s_mov_b32 s31, 65536
    s_add_u32 s24, s24, 524288
    s_add_u32 s26, s26, 524288
    s_add_u32 s28, s28, s27
    v_mov_b32 v60, s69
    v_mov_b32 v56, s69
    v_and_b32 v79, 12, v75
    v_cmp_eq_u32 vcc, 0, v79
    s_nop 1
    v_cndmask_b32 v79, 0, 1, vcc
    s_waitcnt lgkmcnt(0)
    s_waitcnt vmcnt(3)
    v_xor_b32 v77, s69, v8
    v_bitop3_b32 v77, v77, v10, s69 bitop3:0xf6
    v_mfma_f32_16x16x32_bf16 v[0:3], v[4:7], v[8:11], 0
    s_waitcnt vmcnt(2)
    v_bitop3_b32 v77, v77, v12, s69 bitop3:0xf6
    v_bitop3_b32 v77, v77, v14, s69 bitop3:0xf6
    v_mfma_f32_16x16x32_bf16 v[0:3], v[4:7], v[12:15], v[0:3]
    s_waitcnt vmcnt(1)
    v_bitop3_b32 v77, v77, v16, s69 bitop3:0xf6
    v_bitop3_b32 v77, v77, v18, s69 bitop3:0xf6
    v_mfma_f32_16x16x32_bf16 v[0:3], v[4:7], v[16:19], v[0:3]
    s_waitcnt vmcnt(0)
    v_bitop3_b32 v77, v77, v20, s69 bitop3:0xf6
    v_bitop3_b32 v77, v77, v22, s69 bitop3:0xf6
    v_mfma_f32_16x16x32_bf16 v[0:3], v[4:7], v[20:23], v[0:3]
    v_and_b32 v77, 1, v77
    v_cmp_ne_u32 vcc, 0, v77
    s_nop 0
    s_cmp_eq_u64 vcc, 0
    s_cselect_b64 s[42:43], -1, 0
    s_nop 2
    v_add_f32 v2, v0, v1
    s_nop 1
    v_add_f32_dpp v2, v2, v2 row_ror:8 row_mask:0xf bank_mask:0xf
    s_nop 1
    v_mov_b32_dpp v0, v2 quad_perm:[0,0,2,2] row_mask:0xf bank_mask:0xf
    v_mov_b32_dpp v1, v2 quad_perm:[1,1,3,3] row_mask:0xf bank_mask:0xf
    s_mov_b64 exec, s[42:43]
    v_cvt_pk_bf16_f32 v72, v0, v1
    buffer_store_dword v72, v75, s[4:7], s55 offen sc1
    s_mov_b64 exec, -1
    s_cbranch_scc0 cf_l2_retry
cf_l2_go:
    s_branch cf_fin
cf_fin:
    s_add_u32 s40, s95, 64
    v_mov_b32 v78, s40
    s_waitcnt vmcnt(0)
    s_barrier
    s_mov_b64 exec, s[100:101]
    buffer_store_dword v78, off, s[4:7], s29 sc1
    s_mov_b64 exec, -1
cf_end:
    s_endpgm
L_chain_safe:
    s_load_dwordx8 s[48:55], s[0:1], 8
    s_load_dwordx2 s[56:57], s[0:1], 40
    s_waitcnt lgkmcnt(0)
    v_lshrrev_b32 v77, 6, v0
    s_nop 0
    v_readfirstlane_b32 s13, v77
    v_lshlrev_b32 v65, 4, v0
    s_mov_b64 s[8:9], s[56:57]
    s_mov_b32 s10, 4718592
    s_mov_b32 s11, 0x20000
    v_bfe_u32 v77, v65, 4, 6
    s_mul_i32 s96, s13, 36864
    s_add_u32 s96, s96, 16384
    v_lshlrev_b32 v70, 4, v77
    v_add_u32 v70, s96, v70
    v_mov_b32 v68, 0x05040100
    v_mov_b32 v69, 0x07060302
    v_lshrrev_b32 v66, 5, v77
    v_lshlrev_b32 v66, 3, v66
    v_bfe_u32 v78, v77, 4, 1
    v_add_u32 v66, v66, v78
    v_xor_b32 v67, 1, v66
    v_mul_u32_u24 v66, 1152, v66
    v_mul_u32_u24 v67, 1152, v67
    v_mov_b32 v71, v66
    v_bfe_u32 v78, v77, 3, 1
    v_lshlrev_b32 v79, 5, v78
    v_lshl_add_u32 v71, v78, 2, v71
    v_and_b32 v78, 3, v77
    v_lshl_add_u32 v79, v78, 3, v79
    v_bfe_u32 v78, v77, 2, 1
    v_lshl_add_u32 v79, v78, 2, v79
    v_add_u32 v66, v66, v79
    v_add_u32 v67, v67, v79
    v_bfe_u32 v78, v77, 1, 2
    v_lshl_add_u32 v71, v78, 3, v71
    v_and_b32 v78, 1, v77
    v_lshl_add_u32 v71, v78, 1, v71
    s_mul_i32 s40, s12, 147456
    s_mul_i32 s41, s13, 288
    s_add_u32 s40, s40, s41
    s_xor_b32 s41, s13, 0
    s_mul_i32 s41, s41, 36864
    s_add_u32 s64, s41, s40
    s_xor_b32 s41, s13, 1
    s_mul_i32 s41, s41, 36864
    s_add_u32 s65, s41, s40
    s_xor_b32 s41, s13, 2
    s_mul_i32 s41, s41, 36864
    s_add_u32 s66, s41, s40
    s_xor_b32 s41, s13, 3
    s_mul_i32 s41, s41, 36864
    s_add_u32 s67, s41, s40
    s_add_u32 s97, s64, 128
    buffer_load_dword v0, v66, s[8:11], s97 offen offset:0
    buffer_load_dword v1, v66, s[8:11], s97 offen offset:2304
    buffer_load_dword v2, v67, s[8:11], s97 offen offset:64
    buffer_load_dword v3, v67, s[8:11], s97 offen offset:2368
    s_add_u32 s97, s64, 4736
    buffer_load_dword v4, v66, s[8:11], s97 offen offset:0
    buffer_load_dword v5, v66, s[8:11], s97 offen offset:2304
    buffer_load_dword v6, v67, s[8:11], s97 offen offset:64
    buffer_load_dword v7, v67, s[8:11], s97 offen offset:2368
    s_add_u32 s97, s64, 18560
    buffer_load_dword v8, v66, s[8:11], s97 offen offset:0
    buffer_load_dword v9, v66, s[8:11], s97 offen offset:2304
    buffer_load_dword v10, v67, s[8:11], s97 offen offset:64
    buffer_load_dword v11, v67, s[8:11], s97 offen offset:2368
    s_add_u32 s97, s64, 23168
    buffer_load_dword v12, v66, s[8:11], s97 offen offset:0
    buffer_load_dword v13, v66, s[8:11], s97 offen offset:2304
    buffer_load_dword v14, v67, s[8:11], s97 offen offset:64
    buffer_load_dword v15, v67, s[8:11], s97 offen offset:2368
    s_add_u32 s97, s65, 128
    buffer_load_dword v16, v66, s[8:11], s97 offen offset:0
    buffer_load_dword v17, v66, s[8:11], s97 offen offset:2304
    buffer_load_dword v18, v66, s[8:11], s97 offen offset:64
    buffer_load_dword v19, v66, s[8:11], s97 offen offset:2368
    s_add_u32 s97, s65, 4736
    buffer_load_dword v20, v66, s[8:11], s97 offen offset:0
    buffer_load_dword v21, v66, s[8:11], s97 offen offset:2304
    buffer_load_dword v22, v66, s[8:11], s97 offen offset:64
    buffer_load_dword v23, v66, s[8:11], s97 offen offset:2368
    s_add_u32 s97, s65, 18560
    buffer_load_dword v24, v66, s[8:11], s97 offen offset:0
    buffer_load_dword v25, v66, s[8:11], s97 offen offset:2304
    buffer_load_dword v26, v66, s[8:11], s97 offen offset:64
    buffer_load_dword v27, v66, s[8:11], s97 offen offset:2368
    s_add_u32 s97, s65, 23168
    buffer_load_dword v28, v66, s[8:11], s97 offen offset:0
    buffer_load_dword v29, v66, s[8:11], s97 offen offset:2304
    buffer_load_dword v30, v66, s[8:11], s97 offen offset:64
    buffer_load_dword v31, v66, s[8:11], s97 offen offset:2368
    s_add_u32 s97, s66, 128
    buffer_load_dword v32, v66, s[8:11], s97 offen offset:0
    buffer_load_dword v33, v66, s[8:11], s97 offen offset:2304
    buffer_load_dword v34, v66, s[8:11], s97 offen offset:64
    buffer_load_dword v35, v66, s[8:11], s97 offen offset:2368
    s_add_u32 s97, s66, 4736
    buffer_load_dword v36, v66, s[8:11], s97 offen offset:0
    buffer_load_dword v37, v66, s[8:11], s97 offen offset:2304
    buffer_load_dword v38, v66, s[8:11], s97 offen offset:64
    buffer_load_dword v39, v66, s[8:11], s97 offen offset:2368
    s_add_u32 s97, s66, 18560
    buffer_load_dword v40, v66, s[8:11], s97 offen offset:0
    buffer_load_dword v41, v66, s[8:11], s97 offen offset:2304
    buffer_load_dword v42, v66, s[8:11], s97 offen offset:64
    buffer_load_dword v43, v66, s[8:11], s97 offen offset:2368
    s_add_u32 s97, s66, 23168
    buffer_load_dword v44, v66, s[8:11], s97 offen offset:0
    buffer_load_dword v45, v66, s[8:11], s97 offen offset:2304
    buffer_load_dword v46, v66, s[8:11], s97 offen offset:64
    buffer_load_dword v47, v66, s[8:11], s97 offen offset:2368
    s_add_u32 s97, s67, 128
    buffer_load_dword v48, v66, s[8:11], s97 offen offset:0
    buffer_load_dword v49, v66, s[8:11], s97 offen offset:2304
    buffer_load_dword v50, v66, s[8:11], s97 offen offset:64
    buffer_load_dword v51, v66, s[8:11], s97 offen offset:2368
    s_add_u32 s97, s67, 4736
    buffer_load_dword v52, v66, s[8:11], s97 offen offset:0
    buffer_load_dword v53, v66, s[8:11], s97 offen offset:2304
    buffer_load_dword v54, v66, s[8:11], s97 offen offset:64
    buffer_load_dword v55, v66, s[8:11], s97 offen offset:2368
    s_add_u32 s97, s67, 18560
    buffer_load_dword v56, v66, s[8:11], s97 offen offset:0
    buffer_load_dword v57, v66, s[8:11], s97 offen offset:2304
    buffer_load_dword v58, v66, s[8:11], s97 offen offset:64
    buffer_load_dword v59, v66, s[8:11], s97 offen offset:2368
    s_add_u32 s97, s67, 23168
    buffer_load_dword v60, v66, s[8:11], s97 offen offset:0
    buffer_load_dword v61, v66, s[8:11], s97 offen offset:2304
    buffer_load_dword v62, v66, s[8:11], s97 offen offset:64
    buffer_load_dword v63, v66, s[8:11], s97 offen offset:2368
    s_waitcnt vmcnt(0)
    v_perm_b32 v80, v1, v0, v68
    v_perm_b32 v81, v3, v2, v68
    v_perm_b32 v82, v5, v4, v68
    v_perm_b32 v83, v7, v6, v68
    v_perm_b32 v84, v9, v8, v68
    v_perm_b32 v85, v11, v10, v68
    v_perm_b32 v86, v13, v12, v68
    v_perm_b32 v87, v15, v14, v68
    ds_write_b128 v70, v[80:83] offset:20480
    ds_write_b128 v70, v[84:87] offset:21504
    v_perm_b32 v88, v1, v0, v69
    v_perm_b32 v89, v3, v2, v69
    v_perm_b32 v90, v5, v4, v69
    v_perm_b32 v91, v7, v6, v69
    v_perm_b32 v92, v9, v8, v69
    v_perm_b32 v93, v11, v10, v69
    v_perm_b32 v94, v13, v12, v69
    v_perm_b32 v95, v15, v14, v69
    ds_write_b128 v70, v[88:91] offset:22528
    ds_write_b128 v70, v[92:95] offset:23552
    s_waitcnt lgkmcnt(0)
    v_perm_b32 v80, v17, v16, v68
    v_perm_b32 v81, v19, v18, v68
    v_perm_b32 v82, v21, v20, v68
    v_perm_b32 v83, v23, v22, v68
    v_perm_b32 v84, v25, v24, v68
    v_perm_b32 v85, v27, v26, v68
    v_perm_b32 v86, v29, v28, v68
    v_perm_b32 v87, v31, v30, v68
    ds_write_b128 v70, v[80:83] offset:24576
    ds_write_b128 v70, v[84:87] offset:25600
    v_perm_b32 v88, v17, v16, v69
    v_perm_b32 v89, v19, v18, v69
    v_perm_b32 v90, v21, v20, v69
    v_perm_b32 v91, v23, v22, v69
    v_perm_b32 v92, v25, v24, v69
    v_perm_b32 v93, v27, v26, v69
    v_perm_b32 v94, v29, v28, v69
    v_perm_b32 v95, v31, v30, v69
    ds_write_b128 v70, v[88:91] offset:26624
    ds_write_b128 v70, v[92:95] offset:27648
    s_waitcnt lgkmcnt(0)
    v_perm_b32 v80, v33, v32, v68
    v_perm_b32 v81, v35, v34, v68
    v_perm_b32 v82, v37, v36, v68
    v_perm_b32 v83, v39, v38, v68
    v_perm_b32 v84, v41, v40, v68
    v_perm_b32 v85, v43, v42, v68
    v_perm_b32 v86, v45, v44, v68
    v_perm_b32 v87, v47, v46, v68
    ds_write_b128 v70, v[80:83] offset:28672
    ds_write_b128 v70, v[84:87] offset:29696
    v_perm_b32 v88, v33, v32, v69
    v_perm_b32 v89, v35, v34, v69
    v_perm_b32 v90, v37, v36, v69
    v_perm_b32 v91, v39, v38, v69
    v_perm_b32 v92, v41, v40, v69
    v_perm_b32 v93, v43, v42, v69
    v_perm_b32 v94, v45, v44, v69
    v_perm_b32 v95, v47, v46, v69
    ds_write_b128 v70, v[88:91] offset:30720
    ds_write_b128 v70, v[92:95] offset:31744
    s_waitcnt lgkmcnt(0)
    v_perm_b32 v80, v49, v48, v68
    v_perm_b32 v81, v51, v50, v68
    v_perm_b32 v82, v53, v52, v68
    v_perm_b32 v83, v55, v54, v68
    v_perm_b32 v84, v57, v56, v68
    v_perm_b32 v85, v59, v58, v68
    v_perm_b32 v86, v61, v60, v68
    v_perm_b32 v87, v63, v62, v68
    ds_write_b128 v70, v[80:83] offset:32768
    ds_write_b128 v70, v[84:87] offset:33792
    v_perm_b32 v88, v49, v48, v69
    v_perm_b32 v89, v51, v50, v69
    v_perm_b32 v90, v53, v52, v69
    v_perm_b32 v91, v55, v54, v69
    v_perm_b32 v92, v57, v56, v69
    v_perm_b32 v93, v59, v58, v69
    v_perm_b32 v94, v61, v60, v69
    v_perm_b32 v95, v63, v62, v69
    ds_write_b128 v70, v[88:91] offset:34816
    ds_write_b128 v70, v[92:95] offset:35840
    s_waitcnt lgkmcnt(0)
    s_add_u32 s97, s64, 0
    buffer_load_dword v0, v66, s[8:11], s97 offen offset:0
    buffer_load_dword v1, v66, s[8:11], s97 offen offset:2304
    buffer_load_dword v2, v67, s[8:11], s97 offen offset:64
    buffer_load_dword v3, v67, s[8:11], s97 offen offset:2368
    s_add_u32 s97, s64, 4608
    buffer_load_dword v4, v66, s[8:11], s97 offen offset:0
    buffer_load_dword v5, v66, s[8:11], s97 offen offset:2304
    buffer_load_dword v6, v67, s[8:11], s97 offen offset:64
    buffer_load_dword v7, v67, s[8:11], s97 offen offset:2368
    s_add_u32 s97, s64, 18432
    buffer_load_dword v8, v66, s[8:11], s97 offen offset:0
    buffer_load_dword v9, v66, s[8:11], s97 offen offset:2304
    buffer_load_dword v10, v67, s[8:11], s97 offen offset:64
    buffer_load_dword v11, v67, s[8:11], s97 offen offset:2368
    s_add_u32 s97, s64, 23040
    buffer_load_dword v12, v66, s[8:11], s97 offen offset:0
    buffer_load_dword v13, v66, s[8:11], s97 offen offset:2304
    buffer_load_dword v14, v67, s[8:11], s97 offen offset:64
    buffer_load_dword v15, v67, s[8:11], s97 offen offset:2368
    s_add_u32 s97, s65, 0
    buffer_load_dword v16, v66, s[8:11], s97 offen offset:0
    buffer_load_dword v17, v66, s[8:11], s97 offen offset:2304
    buffer_load_dword v18, v66, s[8:11], s97 offen offset:64
    buffer_load_dword v19, v66, s[8:11], s97 offen offset:2368
    s_add_u32 s97, s65, 4608
    buffer_load_dword v20, v66, s[8:11], s97 offen offset:0
    buffer_load_dword v21, v66, s[8:11], s97 offen offset:2304
    buffer_load_dword v22, v66, s[8:11], s97 offen offset:64
    buffer_load_dword v23, v66, s[8:11], s97 offen offset:2368
    s_add_u32 s97, s65, 18432
    buffer_load_dword v24, v66, s[8:11], s97 offen offset:0
    buffer_load_dword v25, v66, s[8:11], s97 offen offset:2304
    buffer_load_dword v26, v66, s[8:11], s97 offen offset:64
    buffer_load_dword v27, v66, s[8:11], s97 offen offset:2368
    s_add_u32 s97, s65, 23040
    buffer_load_dword v28, v66, s[8:11], s97 offen offset:0
    buffer_load_dword v29, v66, s[8:11], s97 offen offset:2304
    buffer_load_dword v30, v66, s[8:11], s97 offen offset:64
    buffer_load_dword v31, v66, s[8:11], s97 offen offset:2368
    s_add_u32 s97, s66, 0
    buffer_load_dword v32, v66, s[8:11], s97 offen offset:0
    buffer_load_dword v33, v66, s[8:11], s97 offen offset:2304
    buffer_load_dword v34, v66, s[8:11], s97 offen offset:64
    buffer_load_dword v35, v66, s[8:11], s97 offen offset:2368
    s_add_u32 s97, s66, 4608
    buffer_load_dword v36, v66, s[8:11], s97 offen offset:0
    buffer_load_dword v37, v66, s[8:11], s97 offen offset:2304
    buffer_load_dword v38, v66, s[8:11], s97 offen offset:64
    buffer_load_dword v39, v66, s[8:11], s97 offen offset:2368
    s_add_u32 s97, s66, 18432
    buffer_load_dword v40, v66, s[8:11], s97 offen offset:0
    buffer_load_dword v41, v66, s[8:11], s97 offen offset:2304
    buffer_load_dword v42, v66, s[8:11], s97 offen offset:64
    buffer_load_dword v43, v66, s[8:11], s97 offen offset:2368
    s_add_u32 s97, s66, 23040
    buffer_load_dword v44, v66, s[8:11], s97 offen offset:0
    buffer_load_dword v45, v66, s[8:11], s97 offen offset:2304
    buffer_load_dword v46, v66, s[8:11], s97 offen offset:64
    buffer_load_dword v47, v66, s[8:11], s97 offen offset:2368
    s_add_u32 s97, s67, 0
    buffer_load_dword v48, v66, s[8:11], s97 offen offset:0
    buffer_load_dword v49, v66, s[8:11], s97 offen offset:2304
    buffer_load_dword v50, v66, s[8:11], s97 offen offset:64
    buffer_load_dword v51, v66, s[8:11], s97 offen offset:2368
    s_add_u32 s97, s67, 4608
    buffer_load_dword v52, v66, s[8:11], s97 offen offset:0
    buffer_load_dword v53, v66, s[8:11], s97 offen offset:2304
    buffer_load_dword v54, v66, s[8:11], s97 offen offset:64
    buffer_load_dword v55, v66, s[8:11], s97 offen offset:2368
    s_add_u32 s97, s67, 18432
    buffer_load_dword v56, v66, s[8:11], s97 offen offset:0
    buffer_load_dword v57, v66, s[8:11], s97 offen offset:2304
    buffer_load_dword v58, v66, s[8:11], s97 offen offset:64
    buffer_load_dword v59, v66, s[8:11], s97 offen offset:2368
    s_add_u32 s97, s67, 23040
    buffer_load_dword v60, v66, s[8:11], s97 offen offset:0
    buffer_load_dword v61, v66, s[8:11], s97 offen offset:2304
    buffer_load_dword v62, v66, s[8:11], s97 offen offset:64
    buffer_load_dword v63, v66, s[8:11], s97 offen offset:2368
    s_waitcnt vmcnt(0)
    v_perm_b32 v80, v1, v0, v68
    v_perm_b32 v81, v3, v2, v68
    v_perm_b32 v82, v5, v4, v68
    v_perm_b32 v83, v7, v6, v68
    v_perm_b32 v84, v9, v8, v68
    v_perm_b32 v85, v11, v10, v68
    v_perm_b32 v86, v13, v12, v68
    v_perm_b32 v87, v15, v14, v68
    v_perm_b32 v112, v1, v0, v69
    v_perm_b32 v113, v3, v2, v69
    v_perm_b32 v114, v5, v4, v69
    v_perm_b32 v115, v7, v6, v69
    v_perm_b32 v116, v9, v8, v69
    v_perm_b32 v117, v11, v10, v69
    v_perm_b32 v118, v13, v12, v69
    v_perm_b32 v119, v15, v14, v69
    v_perm_b32 v88, v17, v16, v68
    v_perm_b32 v89, v19, v18, v68
    v_perm_b32 v90, v21, v20, v68
    v_perm_b32 v91, v23, v22, v68
    v_perm_b32 v92, v25, v24, v68
    v_perm_b32 v93, v27, v26, v68
    v_perm_b32 v94, v29, v28, v68
    v_perm_b32 v95, v31, v30, v68
    v_perm_b32 v120, v17, v16, v69
    v_perm_b32 v121, v19, v18, v69
    v_perm_b32 v122, v21, v20, v69
    v_perm_b32 v123, v23, v22, v69
    v_perm_b32 v124, v25, v24, v69
    v_perm_b32 v125, v27, v26, v69
    v_perm_b32 v126, v29, v28, v69
    v_perm_b32 v127, v31, v30, v69
    v_perm_b32 v96, v33, v32, v68
    v_perm_b32 v97, v35, v34, v68
    v_perm_b32 v98, v37, v36, v68
    v_perm_b32 v99, v39, v38, v68
    v_perm_b32 v100, v41, v40, v68
    v_perm_b32 v101, v43, v42, v68
    v_perm_b32 v102, v45, v44, v68
    v_perm_b32 v103, v47, v46, v68
    v_perm_b32 v128, v33, v32, v69
    v_perm_b32 v129, v35, v34, v69
    v_perm_b32 v130, v37, v36, v69
    v_perm_b32 v131, v39, v38, v69
    v_perm_b32 v132, v41, v40, v69
    v_perm_b32 v133, v43, v42, v69
    v_perm_b32 v134, v45, v44, v69
    v_perm_b32 v135, v47, v46, v69
    v_perm_b32 v104, v49, v48, v68
    v_perm_b32 v105, v51, v50, v68
    v_perm_b32 v106, v53, v52, v68
    v_perm_b32 v107, v55, v54, v68
    v_perm_b32 v108, v57, v56, v68
    v_perm_b32 v109, v59, v58, v68
    v_perm_b32 v110, v61, v60, v68
    v_perm_b32 v111, v63, v62, v68
    v_perm_b32 v136, v49, v48, v69
    v_perm_b32 v137, v51, v50, v69
    v_perm_b32 v138, v53, v52, v69
    v_perm_b32 v139, v55, v54, v69
    v_perm_b32 v140, v57, v56, v69
    v_perm_b32 v141, v59, v58, v69
    v_perm_b32 v142, v61, v60, v69
    v_perm_b32 v143, v63, v62, v69
    s_add_u32 s97, s64, 256
    buffer_load_ushort v0, v71, s[8:11], s97 offen offset:0
    buffer_load_ushort v1, v71, s[8:11], s97 offen offset:2304
    s_add_u32 s97, s64, 4864
    buffer_load_ushort v4, v71, s[8:11], s97 offen offset:0
    buffer_load_ushort v5, v71, s[8:11], s97 offen offset:2304
    s_add_u32 s97, s64, 18688
    buffer_load_ushort v8, v71, s[8:11], s97 offen offset:0
    buffer_load_ushort v9, v71, s[8:11], s97 offen offset:2304
    s_add_u32 s97, s64, 23296
    buffer_load_ushort v12, v71, s[8:11], s97 offen offset:0
    buffer_load_ushort v13, v71, s[8:11], s97 offen offset:2304
    s_add_u32 s97, s65, 256
    buffer_load_ushort v2, v71, s[8:11], s97 offen offset:0
    buffer_load_ushort v3, v71, s[8:11], s97 offen offset:2304
    s_add_u32 s97, s65, 4864
    buffer_load_ushort v6, v71, s[8:11], s97 offen offset:0
    buffer_load_ushort v7, v71, s[8:11], s97 offen offset:2304
    s_add_u32 s97, s65, 18688
    buffer_load_ushort v10, v71, s[8:11], s97 offen offset:0
    buffer_load_ushort v11, v71, s[8:11], s97 offen offset:2304
    s_add_u32 s97, s65, 23296
    buffer_load_ushort v14, v71, s[8:11], s97 offen offset:0
    buffer_load_ushort v15, v71, s[8:11], s97 offen offset:2304
    s_add_u32 s97, s66, 256
    buffer_load_ushort v16, v71, s[8:11], s97 offen offset:0
    buffer_load_ushort v17, v71, s[8:11], s97 offen offset:2304
    s_add_u32 s97, s66, 4864
    buffer_load_ushort v20, v71, s[8:11], s97 offen offset:0
    buffer_load_ushort v21, v71, s[8:11], s97 offen offset:2304
    s_add_u32 s97, s66, 18688
    buffer_load_ushort v24, v71, s[8:11], s97 offen offset:0
    buffer_load_ushort v25, v71, s[8:11], s97 offen offset:2304
    s_add_u32 s97, s66, 23296
    buffer_load_ushort v28, v71, s[8:11], s97 offen offset:0
    buffer_load_ushort v29, v71, s[8:11], s97 offen offset:2304
    s_add_u32 s97, s67, 256
    buffer_load_ushort v18, v71, s[8:11], s97 offen offset:0
    buffer_load_ushort v19, v71, s[8:11], s97 offen offset:2304
    s_add_u32 s97, s67, 4864
    buffer_load_ushort v22, v71, s[8:11], s97 offen offset:0
    buffer_load_ushort v23, v71, s[8:11], s97 offen offset:2304
    s_add_u32 s97, s67, 18688
    buffer_load_ushort v26, v71, s[8:11], s97 offen offset:0
    buffer_load_ushort v27, v71, s[8:11], s97 offen offset:2304
    s_add_u32 s97, s67, 23296
    buffer_load_ushort v30, v71, s[8:11], s97 offen offset:0
    buffer_load_ushort v31, v71, s[8:11], s97 offen offset:2304
    s_waitcnt vmcnt(0)
    v_lshl_or_b32 v144, v1, 16, v0
    v_lshl_or_b32 v145, v3, 16, v2
    v_lshl_or_b32 v146, v5, 16, v4
    v_lshl_or_b32 v147, v7, 16, v6
    v_lshl_or_b32 v148, v9, 16, v8
    v_lshl_or_b32 v149, v11, 16, v10
    v_lshl_or_b32 v150, v13, 16, v12
    v_lshl_or_b32 v151, v15, 16, v14
    v_lshl_or_b32 v152, v17, 16, v16
    v_lshl_or_b32 v153, v19, 16, v18
    v_lshl_or_b32 v154, v21, 16, v20
    v_lshl_or_b32 v155, v23, 16, v22
    v_lshl_or_b32 v156, v25, 16, v24
    v_lshl_or_b32 v157, v27, 16, v26
    v_lshl_or_b32 v158, v29, 16, v28
    v_lshl_or_b32 v159, v31, 16, v30
    s_nop 1
    v_bfe_u32 v60, v65, 4, 6
    v_and_b32 v61, 15, v60
    v_lshrrev_b32 v62, 4, v60
    v_mov_b32 v64, 0x4444
    v_mov_b32 v77, 0xeeee
    v_cmp_lt_u32 vcc, 7, v61
    s_nop 1
    v_cndmask_b32 v64, v64, v77, vcc
    v_xor_b32 v66, 1024, v65
    v_xor_b32 v67, 2048, v65
    v_xor_b32 v68, 3072, v65
    v_and_b32 v69, 511, v65
    s_mul_i32 s96, s13, 36864
    s_add_u32 s96, s96, 16384
    v_lshlrev_b32 v70, 4, v60
    v_add_u32 v70, s96, v70
    v_lshrrev_b32 v79, 1, v69
    s_lshl_b32 s96, s13, 8
    s_add_u32 s96, s96, 14336
    s_lshl_b32 s33, s13, 10
    s_add_u32 s97, s33, 8192
    v_mov_b32 v77, s97
    v_mov_b32 v78, s96
    v_cmp_lt_u32 vcc, 31, v60
    s_nop 1
    v_cndmask_b32 v71, v77, v78, vcc
    v_add_u32 v71, v71, v79
    v_and_b32 v77, 7, v61
    v_lshrrev_b32 v78, 3, v61
    v_lshlrev_b32 v74, 4, v77
    v_lshl_add_u32 v73, v62, 7, v74
    v_lshl_add_u32 v73, v78, 3, v73
    s_lshl_b32 s96, s13, 9
    v_add_u32 v73, s96, v73
    v_lshl_add_u32 v74, v78, 14, v74
    v_lshl_add_u32 v74, v62, 15, v74
    s_lshl_b32 s96, s13, 17
    v_add_u32 v74, s96, v74
    v_bfe_u32 v77, v61, 2, 1
    v_and_b32 v78, 3, v61
    v_bfe_u32 v79, v61, 1, 2
    s_cmp_lt_u32 s13, 2
    s_cselect_b64 vcc, -1, 0
    v_cndmask_b32 v77, 0, v77, vcc
    v_cndmask_b32 v78, v79, v78, vcc
    v_lshlrev_b32 v75, 7, v77
    v_lshl_add_u32 v75, v62, 4, v75
    v_lshl_add_u32 v75, v78, 2, v75
    v_lshlrev_b32 v58, 1, v77
    v_lshl_add_u32 v58, v78, 2, v58
    s_bfe_u32 s97, s12, 0x10001
    s_lshl_b32 s68, s97, 6
    s_lshl_b32 s97, s97, 2
    v_add_u32 v59, s97, v62
    s_bfe_u32 s96, s12, 0x10002
    s_and_b32 s40, s12, 1
    s_lshl_b32 s96, s96, 1
    s_add_u32 s96, s96, s40
    s_lshr_b32 s97, s12, 3
    s_lshl_b32 s98, s13, 2
    s_add_u32 s98, s98, s97
    s_lshl_b32 s98, s98, 2
    s_add_u32 s98, s98, s96
    s_lshl_b32 s98, s98, 8
    s_lshl_b32 s99, s13, 2
    s_add_u32 s99, s99, s96
    s_lshl_b32 s99, s99, 4
    s_lshl_b32 s41, s97, 1
    s_add_u32 s41, s41, s40
    s_lshl_b32 s41, s41, 7
    s_add_u32 s41, s41, 8192
    s_lshl_b32 s40, s40, 1
    s_add_u32 s40, s40, 128
    s_cmp_lt_u32 s13, 2
    s_cselect_b32 s98, s98, s41
    s_cselect_b32 s99, s99, s40
    s_cselect_b32 s32, 1, 0
    s_add_u32 s68, s68, s98
    s_mul_i32 s97, s97, 144
    s_add_u32 s99, s99, s97
    v_add_u32 v58, s99, v58
    s_and_b32 s97, s12, 4
    s_or_b32 s97, s97, s13
    s_cmp_eq_u32 s97, 2
    s_cselect_b32 s32, 2, s32
    s_cmp_lg_u32 s32, 0
    s_cselect_b64 s[34:35], -1, 0
    s_cbranch_scc0 cs_init_done
    s_mov_b32 s8, s48
    s_mov_b32 s9, s49
    s_mov_b32 s10, 9216
    s_mov_b32 s11, 0x20000
    v_mov_b32 v4, 1
    v_mov_b32 v5, 1
    v_mov_b32 v6, 1
    v_mov_b32 v7, 1
    s_lshl_b32 s96, s12, 14
    s_add_u32 s96, s96, 68681728
    s_add_u32 s97, s96, 0
    buffer_store_dwordx4 v[4:7], v65, s[4:7], s97 offen sc1
    s_add_u32 s97, s96, 4096
    buffer_store_dwordx4 v[4:7], v65, s[4:7], s97 offen sc1
    s_add_u32 s97, s96, 8192
    buffer_store_dwordx4 v[4:7], v65, s[4:7], s97 offen sc1
    s_add_u32 s97, s96, 12288
    buffer_store_dwordx4 v[4:7], v65, s[4:7], s97 offen sc1
    v_mul_u32_u24 v77, 1152, v59
    v_lshl_add_u32 v77, v58, 1, v77
    buffer_load_dword v72, v77, s[8:11], 0 offen
    s_add_u32 s96, s68, 67633152
    v_and_b32 v79, 12, v75
    v_cmp_eq_u32 vcc, 0, v79
    s_nop 1
    v_cndmask_b32 v79, 0, 1, vcc
    s_waitcnt vmcnt(0)
    v_bfi_b32 v1, v79, 0, v72
    buffer_store_dword v1, v75, s[4:7], s96 offen sc1
    s_cmp_lg_u32 s32, 2
    s_cbranch_scc1 cs_init_done
    buffer_store_dword v1, v75, s[4:7], s96 offen offset:1024 sc1
    buffer_store_dword v1, v75, s[4:7], s96 offen offset:2048 sc1
    buffer_store_dword v1, v75, s[4:7], s96 offen offset:3072 sc1
cs_init_done:
    s_cmp_eq_u32 s13, 3
    s_cselect_b32 s96, 0, -1
    v_and_b32 v75, s96, v75
    v_mov_b32 v50, 0x3f80
    v_mov_b32 v51, 0x3f800000
    v_and_b32 v77, 1, v62
    v_lshlrev_b32 v77, 2, v77
    v_sub_u32 v77, v61, v77
    v_and_b32 v78, 3, v61
    v_lshlrev_b32 v78, 2, v78
    v_lshrrev_b32 v79, 2, v61
    v_add_u32 v78, v78, v79
    v_cmp_eq_u32 vcc, 0, v77
    s_nop 1
    v_cndmask_b32 v8, 0, v50, vcc
    v_cmp_eq_u32 vcc, 1, v77
    s_nop 1
    v_cndmask_b32 v8, v8, v51, vcc
    v_cmp_eq_u32 vcc, 0, v78
    s_nop 1
    v_cndmask_b32 v12, 0, v50, vcc
    v_cmp_eq_u32 vcc, 1, v78
    s_nop 1
    v_cndmask_b32 v12, v12, v51, vcc
    v_cmp_eq_u32 vcc, 2, v77
    s_nop 1
    v_cndmask_b32 v9, 0, v50, vcc
    v_cmp_eq_u32 vcc, 3, v77
    s_nop 1
    v_cndmask_b32 v9, v9, v51, vcc
    v_cmp_eq_u32 vcc, 2, v78
    s_nop 1
    v_cndmask_b32 v13, 0, v50, vcc
    v_cmp_eq_u32 vcc, 3, v78
    s_nop 1
    v_cndmask_b32 v13, v13, v51, vcc
    v_cmp_eq_u32 vcc, 8, v77
    s_nop 1
    v_cndmask_b32 v10, 0, v50, vcc
    v_cmp_eq_u32 vcc, 9, v77
    s_nop 1
    v_cndmask_b32 v10, v10, v51, vcc
    v_cmp_eq_u32 vcc, 4, v78
    s_nop 1
    v_cndmask_b32 v14, 0, v50, vcc
    v_cmp_eq_u32 vcc, 5, v78
    s_nop 1
    v_cndmask_b32 v14, v14, v51, vcc
    v_cmp_eq_u32 vcc, 10, v77
    s_nop 1
    v_cndmask_b32 v11, 0, v50, vcc
    v_cmp_eq_u32 vcc, 11, v77
    s_nop 1
    v_cndmask_b32 v11, v11, v51, vcc
    v_cmp_eq_u32 vcc, 6, v78
    s_nop 1
    v_cndmask_b32 v15, 0, v50, vcc
    v_cmp_eq_u32 vcc, 7, v78
    s_nop 1
    v_cndmask_b32 v15, v15, v51, vcc
    v_lshlrev_b32 v77, 4, v61
    ds_write_b128 v69, v[8:11] offset:15360
    ds_write_b128 v77, v[12:15] offset:15872
    s_mul_i32 s40, s12, 147456
    s_add_u32 s40, s40, 100663296
    s_xor_b32 s41, s13, 0
    s_lshl_b32 s41, s41, 14
    s_add_u32 s64, s41, s40
    s_xor_b32 s41, s13, 1
    s_lshl_b32 s41, s41, 14
    s_add_u32 s65, s41, s40
    s_xor_b32 s41, s13, 2
    s_lshl_b32 s41, s41, 14
    s_add_u32 s66, s41, s40
    s_xor_b32 s41, s13, 3
    s_lshl_b32 s41, s41, 14
    s_add_u32 s67, s41, s40
    s_mul_i32 s42, s12, 163840
    s_add_u32 s42, s42, 117440512
    s_mul_i32 s43, s13, 36864
    s_add_u32 s43, s43, 16384
    s_lshl_b32 s89, s12, 6
    s_add_u32 s89, s89, 125833216
    v_mbcnt_lo_u32_b32 v40, -1, 0
    v_mbcnt_hi_u32_b32 v40, -1, v40
    v_min_u32 v40, 4, v40
    v_lshlrev_b32 v40, 2, v40
    s_mov_b32 s88, 4194304
fw7:
    buffer_load_dword v41, v40, s[4:7], s89 offen offset:0 sc1
    s_sub_u32 s88, s88, 1
    s_cbranch_scc1 fw7x
    s_waitcnt vmcnt(0)
    v_cmp_ne_u32 vcc, s95, v41
    s_cbranch_vccz fw7x
    s_sleep 1
    s_branch fw7
fw7x:
    s_add_u32 s41, s64, 4718592
    buffer_load_dwordx4 a[96:99], v65, s[4:7], s41 offen sc1
    s_add_u32 s41, s64, 4722688
    buffer_load_dwordx4 a[100:103], v65, s[4:7], s41 offen sc1
    s_add_u32 s41, s64, 4726784
    buffer_load_dwordx4 a[104:107], v65, s[4:7], s41 offen sc1
    s_add_u32 s41, s64, 4730880
    buffer_load_dwordx4 a[108:111], v65, s[4:7], s41 offen sc1
    s_add_u32 s41, s65, 4718592
    buffer_load_dwordx4 a[112:115], v65, s[4:7], s41 offen sc1
    s_add_u32 s41, s65, 4722688
    buffer_load_dwordx4 a[116:119], v65, s[4:7], s41 offen sc1
    s_add_u32 s41, s65, 4726784
    buffer_load_dwordx4 a[120:123], v65, s[4:7], s41 offen sc1
    s_add_u32 s41, s65, 4730880
    buffer_load_dwordx4 a[124:127], v65, s[4:7], s41 offen sc1
    s_add_u32 s41, s66, 4718592
    buffer_load_dwordx4 a[128:131], v65, s[4:7], s41 offen sc1
    s_add_u32 s41, s66, 4722688
    buffer_load_dwordx4 a[132:135], v65, s[4:7], s41 offen sc1
    s_add_u32 s41, s66, 4726784
    buffer_load_dwordx4 a[136:139], v65, s[4:7], s41 offen sc1
    s_add_u32 s41, s66, 4730880
    buffer_load_dwordx4 a[140:143], v65, s[4:7], s41 offen sc1
    s_add_u32 s41, s67, 4718592
    buffer_load_dwordx4 a[144:147], v65, s[4:7], s41 offen sc1
    s_add_u32 s41, s67, 4722688
    buffer_load_dwordx4 a[148:151], v65, s[4:7], s41 offen sc1
    s_add_u32 s41, s67, 4726784
    s_add_u32 m0, s43, 12288
    s_nop 0
    buffer_load_dwordx4 v65, s[4:7], s41 offen sc1 lds
    s_add_u32 s41, s67, 4730880
    s_add_u32 m0, s43, 13312
    s_nop 0
    buffer_load_dwordx4 v65, s[4:7], s41 offen sc1 lds
    s_add_u32 s41, s64, 4784128
    buffer_load_dwordx4 a[152:155], v65, s[4:7], s41 offen sc1
    s_add_u32 s41, s64, 4788224
    buffer_load_dwordx4 a[156:159], v65, s[4:7], s41 offen sc1
    s_add_u32 s41, s64, 4792320
    buffer_load_dwordx4 a[160:163], v65, s[4:7], s41 offen sc1
    s_add_u32 s41, s64, 4796416
    buffer_load_dwordx4 a[164:167], v65, s[4:7], s41 offen sc1
    s_add_u32 s41, s65, 4784128
    s_add_u32 m0, s43, 16384
    s_nop 0
    buffer_load_dwordx4 v65, s[4:7], s41 offen sc1 lds
    s_add_u32 s41, s65, 4788224
    s_add_u32 m0, s43, 17408
    s_nop 0
    buffer_load_dwordx4 v65, s[4:7], s41 offen sc1 lds
    s_add_u32 s41, s65, 4792320
    buffer_load_dwordx4 a[168:171], v65, s[4:7], s41 offen sc1
    s_add_u32 s41, s65, 4796416
    buffer_load_dwordx4 a[172:175], v65, s[4:7], s41 offen sc1
    s_add_u32 s41, s66, 4784128
    buffer_load_dwordx4 a[176:179], v65, s[4:7], s41 offen sc1
    s_add_u32 s41, s66, 4788224
    buffer_load_dwordx4 a[180:183], v65, s[4:7], s41 offen sc1
    s_add_u32 s41, s66, 4792320
    buffer_load_dwordx4 a[184:187], v65, s[4:7], s41 offen sc1
    s_add_u32 s41, s66, 4796416
    buffer_load_dwordx4 a[188:191], v65, s[4:7], s41 offen sc1
    s_add_u32 s41, s67, 4784128
    s_add_u32 m0, s43, 18432
    s_nop 0
    buffer_load_dwordx4 v65, s[4:7], s41 offen sc1 lds
    s_add_u32 s41, s67, 4788224
    s_add_u32 m0, s43, 19456
    s_nop 0
    buffer_load_dwordx4 v65, s[4:7], s41 offen sc1 lds
    s_add_u32 s41, s67, 4792320
    buffer_load_dwordx4 a[192:195], v65, s[4:7], s41 offen sc1
    s_add_u32 s41, s67, 4796416
    buffer_load_dwordx4 a[196:199], v65, s[4:7], s41 offen sc1
    s_add_u32 s41, s40, 4849664
    buffer_load_dwordx4 a[200:203], v65, s[4:7], s41 offen sc1
    s_add_u32 s41, s40, 4853760
    buffer_load_dwordx4 a[204:207], v65, s[4:7], s41 offen sc1
    s_add_u32 s41, s40, 4857856
    buffer_load_dwordx4 a[208:211], v65, s[4:7], s41 offen sc1
    s_add_u32 s41, s40, 4861952
    buffer_load_dwordx4 a[212:215], v65, s[4:7], s41 offen sc1
    s_add_u32 s41, s64, 9437184
    buffer_load_dwordx4 a[216:219], v65, s[4:7], s41 offen sc1
    s_add_u32 s41, s64, 9441280
    buffer_load_dwordx4 a[220:223], v65, s[4:7], s41 offen sc1
    s_add_u32 s41, s64, 9445376
    s_add_u32 m0, s43, 8192
    s_nop 0
    buffer_load_dwordx4 v65, s[4:7], s41 offen sc1 lds
    s_add_u32 s41, s64, 9449472
    s_add_u32 m0, s43, 9216
    s_nop 0
    buffer_load_dwordx4 v65, s[4:7], s41 offen sc1 lds
    s_add_u32 s41, s65, 9437184
    buffer_load_dwordx4 a[224:227], v65, s[4:7], s41 offen sc1
    s_add_u32 s41, s65, 9441280
    buffer_load_dwordx4 a[228:231], v65, s[4:7], s41 offen sc1
    s_add_u32 s41, s65, 9445376
    buffer_load_dwordx4 a[232:235], v65, s[4:7], s41 offen sc1
    s_add_u32 s41, s65, 9449472
    buffer_load_dwordx4 a[236:239], v65, s[4:7], s41 offen sc1
    s_add_u32 s41, s66, 9437184
    buffer_load_dwordx4 a[240:243], v65, s[4:7], s41 offen sc1
    s_add_u32 s41, s66, 9441280
    buffer_load_dwordx4 a[244:247], v65, s[4:7], s41 offen sc1
    s_add_u32 s41, s66, 9445376
    buffer_load_dwordx4 a[248:251], v65, s[4:7], s41 offen sc1
    s_add_u32 s41, s66, 9449472
    buffer_load_dwordx4 a[252:255], v65, s[4:7], s41 offen sc1
    s_add_u32 s41, s67, 9437184
    buffer_load_dwordx4 v[160:163], v65, s[4:7], s41 offen sc1
    s_add_u32 s41, s67, 9441280
    buffer_load_dwordx4 v[164:167], v65, s[4:7], s41 offen sc1
    s_add_u32 s41, s67, 9445376
    buffer_load_dwordx4 v[168:171], v65, s[4:7], s41 offen sc1
    s_add_u32 s41, s67, 9449472
    buffer_load_dwordx4 v[172:175], v65, s[4:7], s41 offen sc1
    s_add_u32 s41, s64, 9502720
    buffer_load_dwordx4 v[176:179], v65, s[4:7], s41 offen sc1
    s_add_u32 s41, s64, 9506816
    buffer_load_dwordx4 v[180:183], v65, s[4:7], s41 offen sc1
    s_add_u32 s41, s64, 9510912
    buffer_load_dwordx4 v[184:187], v65, s[4:7], s41 offen sc1
    s_add_u32 s41, s64, 9515008
    buffer_load_dwordx4 v[188:191], v65, s[4:7], s41 offen sc1
    s_add_u32 s41, s65, 9502720
    buffer_load_dwordx4 v[192:195], v65, s[4:7], s41 offen sc1
    s_add_u32 s41, s65, 9506816
    buffer_load_dwordx4 v[196:199], v65, s[4:7], s41 offen sc1
    s_add_u32 s41, s65, 9510912
    buffer_load_dwordx4 v[200:203], v65, s[4:7], s41 offen sc1
    s_add_u32 s41, s65, 9515008
    buffer_load_dwordx4 v[204:207], v65, s[4:7], s41 offen sc1
    s_add_u32 s41, s66, 9502720
    buffer_load_dwordx4 v[208:211], v65, s[4:7], s41 offen sc1
    s_add_u32 s41, s66, 9506816
    buffer_load_dwordx4 v[212:215], v65, s[4:7], s41 offen sc1
    s_add_u32 s41, s66, 9510912
    buffer_load_dwordx4 v[216:219], v65, s[4:7], s41 offen sc1
    s_add_u32 s41, s66, 9515008
    buffer_load_dwordx4 v[220:223], v65, s[4:7], s41 offen sc1
    s_add_u32 s41, s67, 9502720
    buffer_load_dwordx4 v[224:227], v65, s[4:7], s41 offen sc1
    s_add_u32 s41, s67, 9506816
    buffer_load_dwordx4 v[228:231], v65, s[4:7], s41 offen sc1
    s_add_u32 s41, s67, 9510912
    buffer_load_dwordx4 v[232:235], v65, s[4:7], s41 offen sc1
    s_add_u32 s41, s67, 9515008
    buffer_load_dwordx4 v[236:239], v65, s[4:7], s41 offen sc1
    s_add_u32 s41, s40, 9568256
    buffer_load_dwordx4 v[240:243], v65, s[4:7], s41 offen sc1
    s_add_u32 s41, s40, 9572352
    buffer_load_dwordx4 v[244:247], v65, s[4:7], s41 offen sc1
    s_add_u32 s41, s40, 9576448
    buffer_load_dwordx4 v[248:251], v65, s[4:7], s41 offen sc1
    s_add_u32 s41, s40, 9580544
    buffer_load_dwordx4 v[252:255], v65, s[4:7], s41 offen sc1
    s_lshl_b32 s89, s12, 6
    s_add_u32 s89, s89, 125833216
    v_mbcnt_lo_u32_b32 v40, -1, 0
    v_mbcnt_hi_u32_b32 v40, -1, v40
    v_min_u32 v40, 2, v40
    v_lshlrev_b32 v40, 2, v40
    s_mov_b32 s88, 4194304
fw8:
    buffer_load_dword v41, v40, s[4:7], s89 offen offset:16 sc1
    s_sub_u32 s88, s88, 1
    s_cbranch_scc1 fw8x
    s_waitcnt vmcnt(0)
    v_cmp_ne_u32 vcc, s95, v41
    s_cbranch_vccz fw8x
    s_sleep 1
    s_branch fw8
fw8x:
    s_add_u32 s41, s64, 0
    s_add_u32 m0, s43, 0
    s_nop 0
    buffer_load_dwordx4 v65, s[4:7], s41 offen sc1 lds
    s_add_u32 s41, s64, 4096
    s_add_u32 m0, s43, 1024
    s_nop 0
    buffer_load_dwordx4 v65, s[4:7], s41 offen sc1 lds
    s_add_u32 s41, s64, 8192
    s_add_u32 m0, s43, 2048
    s_nop 0
    buffer_load_dwordx4 v65, s[4:7], s41 offen sc1 lds
    s_add_u32 s41, s64, 12288
    s_add_u32 m0, s43, 3072
    s_nop 0
    buffer_load_dwordx4 v65, s[4:7], s41 offen sc1 lds
    s_add_u32 s41, s65, 0
    s_add_u32 m0, s43, 4096
    s_nop 0
    buffer_load_dwordx4 v65, s[4:7], s41 offen sc1 lds
    s_add_u32 s41, s65, 4096
    s_add_u32 m0, s43, 5120
    s_nop 0
    buffer_load_dwordx4 v65, s[4:7], s41 offen sc1 lds
    s_add_u32 s41, s65, 8192
    s_add_u32 m0, s43, 6144
    s_nop 0
    buffer_load_dwordx4 v65, s[4:7], s41 offen sc1 lds
    s_add_u32 s41, s65, 12288
    s_add_u32 m0, s43, 7168
    s_nop 0
    buffer_load_dwordx4 v65, s[4:7], s41 offen sc1 lds
    s_add_u32 s41, s66, 0
    buffer_load_dwordx4 a[0:3], v65, s[4:7], s41 offen sc1
    s_add_u32 s41, s66, 4096
    buffer_load_dwordx4 a[4:7], v65, s[4:7], s41 offen sc1
    s_add_u32 s41, s66, 8192
    s_add_u32 m0, s43, 10240
    s_nop 0
    buffer_load_dwordx4 v65, s[4:7], s41 offen sc1 lds
    s_add_u32 s41, s66, 12288
    s_add_u32 m0, s43, 11264
    s_nop 0
    buffer_load_dwordx4 v65, s[4:7], s41 offen sc1 lds
    s_add_u32 s41, s67, 0
    buffer_load_dwordx4 a[8:11], v65, s[4:7], s41 offen sc1
    s_add_u32 s41, s67, 4096
    buffer_load_dwordx4 a[12:15], v65, s[4:7], s41 offen sc1
    s_add_u32 s41, s67, 8192
    s_add_u32 m0, s43, 14336
    s_nop 0
    buffer_load_dwordx4 v65, s[4:7], s41 offen sc1 lds
    s_add_u32 s41, s67, 12288
    s_add_u32 m0, s43, 15360
    s_nop 0
    buffer_load_dwordx4 v65, s[4:7], s41 offen sc1 lds
    s_add_u32 s41, s64, 65536
    buffer_load_dwordx4 a[16:19], v65, s[4:7], s41 offen sc1
    s_add_u32 s41, s64, 69632
    buffer_load_dwordx4 a[20:23], v65, s[4:7], s41 offen sc1
    s_add_u32 s41, s64, 73728
    buffer_load_dwordx4 a[24:27], v65, s[4:7], s41 offen sc1
    s_add_u32 s41, s64, 77824
    buffer_load_dwordx4 a[28:31], v65, s[4:7], s41 offen sc1
    s_add_u32 s41, s65, 65536
    buffer_load_dwordx4 a[32:35], v65, s[4:7], s41 offen sc1
    s_add_u32 s41, s65, 69632
    buffer_load_dwordx4 a[36:39], v65, s[4:7], s41 offen sc1
    s_add_u32 s41, s65, 73728
    buffer_load_dwordx4 a[40:43], v65, s[4:7], s41 offen sc1
    s_add_u32 s41, s65, 77824
    buffer_load_dwordx4 a[44:47], v65, s[4:7], s41 offen sc1
    s_add_u32 s41, s66, 65536
    buffer_load_dwordx4 a[48:51], v65, s[4:7], s41 offen sc1
    s_add_u32 s41, s66, 69632
    buffer_load_dwordx4 a[52:55], v65, s[4:7], s41 offen sc1
    s_add_u32 s41, s66, 73728
    buffer_load_dwordx4 a[56:59], v65, s[4:7], s41 offen sc1
    s_add_u32 s41, s66, 77824
    buffer_load_dwordx4 a[60:63], v65, s[4:7], s41 offen sc1
    s_add_u32 s41, s67, 65536
    buffer_load_dwordx4 a[64:67], v65, s[4:7], s41 offen sc1
    s_add_u32 s41, s67, 69632
    buffer_load_dwordx4 a[68:71], v65, s[4:7], s41 offen sc1
    s_add_u32 s41, s67, 73728
    buffer_load_dwordx4 a[72:75], v65, s[4:7], s41 offen sc1
    s_add_u32 s41, s67, 77824
    buffer_load_dwordx4 a[76:79], v65, s[4:7], s41 offen sc1
    s_add_u32 s41, s40, 131072
    buffer_load_dwordx4 a[80:83], v65, s[4:7], s41 offen sc1
    s_add_u32 s41, s40, 135168
    buffer_load_dwordx4 a[84:87], v65, s[4:7], s41 offen sc1
    s_add_u32 s41, s40, 139264
    buffer_load_dwordx4 a[88:91], v65, s[4:7], s41 offen sc1
    s_add_u32 s41, s40, 143360
    buffer_load_dwordx4 a[92:95], v65, s[4:7], s41 offen sc1
    s_waitcnt vmcnt(0) lgkmcnt(0)
    s_barrier
    v_mov_b32 v2, 1
    s_cmp_lg_u32 s13, 0
    s_cbranch_scc1 cs_noarr
    s_mov_b64 exec, 1
    buffer_atomic_add v2, off, s[84:87], 0 offset:212
    s_mov_b32 s40, 16777216
    s_mov_b32 s42, 2
cs_startpoll:
    buffer_load_dword v3, off, s[84:87], 0 offset:212 sc1
    s_sub_u32 s40, s40, 1
    s_cbranch_scc1 cs_decide
    s_waitcnt vmcnt(0)
    v_readfirstlane_b32 s41, v3
    s_nop 1
    s_cmp_lt_u32 s41, 32
    s_cbranch_scc1 cs_startpoll
    s_mov_b32 s42, 1
cs_decide:
    s_mov_b64 exec, -1
cs_noarr:
    s_barrier
    s_mov_b32 m0, 16128
    s_mov_b32 s44, 0x3e0293ee
    s_mov_b32 s45, s44
    s_or_b32 s66, s44, 0x80000000
    s_mov_b32 s48, 0x3f003f00
    s_mov_b32 s49, 0
    s_mov_b32 s50, 0x3f803f80
    s_mov_b32 s51, 0x3f803f80
    s_mov_b32 s52, 512
    s_mov_b32 s53, 1024
    s_mov_b32 s54, 1536
    s_mov_b32 s30, 0
    s_cmp_lg_u32 s32, 0
    s_cselect_b32 s71, s13, 3
    s_mov_b32 s14, 67633152
    s_mov_b32 s15, 67637248
    s_mov_b32 s16, 67641344
    s_add_u32 s17, s68, 67633152
    s_mov_b32 s69, 0
    s_mov_b32 s70, 0
    s_lshl_b32 s26, s12, 14
    s_add_u32 s26, s26, 0
    s_mul_i32 s40, s13, 3072
    s_add_u32 s24, s26, s40
    s_lshl_b32 s40, s12, 14
    s_add_u32 s40, s40, 68681728
    s_add_u32 s18, s40, 0
    s_add_u32 s19, s40, 4096
    s_add_u32 s20, s40, 8192
    s_add_u32 s21, s40, 12288
    s_lshr_b32 s40, s12, 3
    s_lshl_b32 s40, s40, 12
    s_and_b32 s41, s12, 7
    s_lshl_b32 s41, s41, 7
    s_add_u32 s40, s40, s41
    s_add_u32 s22, s40, 68681728
    s_add_u32 s23, s22, 1024
    s_add_u32 s25, s22, 2048
    s_mov_b32 s56, -65528
    s_lshl_b32 s96, s12, 7
    s_add_u32 s29, s96, 125845504
    s_add_u32 s96, s96, 125829120
    s_add_u32 s28, s68, 138412032
    s_cmp_eq_u32 s13, 3
    s_cselect_b64 s[100:101], 1, 0
    s_cselect_b64 s[36:37], 1, s[34:35]
    s_cselect_b32 s93, 64, 0
    s_cselect_b32 s28, s29, s28
    s_cselect_b32 s27, 0, 9216
    s_mov_b64 exec, s[100:101]
    v_mov_b32 v72, s95
    s_mov_b64 exec, -1
    s_add_u32 s55, s68, 138992640
    s_mov_b32 s40, 2
    s_sub_u32 s41, s40, 1
    s_lshr_b32 s41, s41, 4
    s_lshl_b32 s41, s41, 2
    s_add_u32 s41, s41, s96
    s_mov_b32 s31, 4194304
cs_kv0:
    buffer_load_dword v77, off, s[4:7], s41 offset:16 sc1
    buffer_load_dword v78, off, s[4:7], s41 offset:32 sc1
    s_waitcnt vmcnt(0)
    v_subrev_u32 v77, s95, v77
    v_subrev_u32 v78, s95, v78
    v_cmp_lt_u32 vcc, 64, v77
    s_nop 1
    v_cndmask_b32 v77, v77, 0, vcc
    v_cmp_lt_u32 vcc, 64, v78
    s_nop 1
    v_cndmask_b32 v78, v78, 0, vcc
    v_min_u32 v77, v77, v78
    s_nop 0
    v_readfirstlane_b32 s97, v77
    s_sub_u32 s31, s31, 1
    s_cbranch_scc1 cs_kv0_x
    s_cmp_le_u32 s40, s97
    s_cbranch_scc1 cs_kv0_x
    s_sleep 4
    s_branch cs_kv0
cs_kv0_x:
    s_add_u32 s40, s26, 0
    v_lshlrev_b32 v78, 2, v65
    buffer_load_dword v76, v78, s[4:7], s40 offen sc1
    s_add_u32 s40, s26, 524288
    v_lshlrev_b32 v78, 2, v65
    buffer_load_dword v76, v78, s[4:7], s40 offen sc1
    v_mov_b64 v[0:1], 0
    v_mov_b64 v[2:3], 0
    v_mov_b64 v[4:5], 0
    v_mov_b64 v[6:7], 0
    v_mov_b64 v[8:9], 0
    v_mov_b64 v[10:11], 0
    v_mov_b64 v[12:13], 0
    v_mov_b64 v[14:15], 0
    v_mov_b64 v[16:17], 0
    v_mov_b64 v[18:19], 0
    v_mov_b64 v[20:21], 0
    v_mov_b64 v[22:23], 0
    v_mov_b32 v60, 1
    v_mov_b32 v56, 1
    ds_read_b128 v[40:43], v70 offset:0
    ds_read_b128 v[44:47], v70 offset:1024
    ds_read_b128 v[48:51], v70 offset:2048
    ds_read_b128 v[52:55], v70 offset:3072
    ds_read_b128 v[24:27], v70 offset:4096
    ds_read_b128 v[28:31], v70 offset:5120
    ds_read_b128 v[32:35], v70 offset:6144
    ds_read_b128 v[36:39], v70 offset:7168
cs_loop:
    s_add_u32 s40, s30, 3
    s_min_u32 s40, s40, 64
    s_cmp_le_u32 s40, s97
    s_cbranch_scc0 cs_kvwait
cs_kvok:
    s_mov_b32 s31, 1048576
    s_mov_b32 s69, s70
    s_waitcnt lgkmcnt(0)
cs_cA:
    buffer_load_dwordx4 v[60:63], v65, s[4:7], s14 offen offset:0 sc1
    buffer_load_dwordx4 v[56:59], v66, s[4:7], s14 offen offset:0 sc1
    v_bitop3_b32 v77, v60, v56, s70 bitop3:0x7e
    v_and_b32 v77, 1, v77
    v_cmp_ne_u32 vcc, 0, v77
    s_cbranch_vccz cs_goA
    s_nop 15
    s_nop 15
    s_nop 7
    v_bitop3_b32 v77, v60, v56, s70 bitop3:0x7e
    v_and_b32 v77, 1, v77
    v_cmp_ne_u32 vcc, 0, v77
    s_cbranch_vccz cs_goA
    s_nop 15
    s_nop 15
    s_nop 7
    v_bitop3_b32 v77, v60, v56, s70 bitop3:0x7e
    v_and_b32 v77, 1, v77
    v_cmp_ne_u32 vcc, 0, v77
    s_cbranch_vccz cs_goA
    s_nop 15
    s_nop 15
    s_nop 7
    v_bitop3_b32 v77, v60, v56, s70 bitop3:0x7e
    v_and_b32 v77, 1, v77
    v_cmp_ne_u32 vcc, 0, v77
    s_cbranch_vccz cs_goA
    s_nop 15
    s_nop 15
    s_nop 7
    buffer_load_dwordx4 v[60:63], v65, s[4:7], s14 offen offset:0 sc1
    buffer_load_dwordx4 v[56:59], v66, s[4:7], s14 offen offset:0 sc1
    v_bitop3_b32 v77, v60, v56, s70 bitop3:0x7e
    v_and_b32 v77, 1, v77
    v_cmp_ne_u32 vcc, 0, v77
    s_cbranch_vccz cs_goA
    s_nop 15
    s_nop 15
    s_nop 7
    v_bitop3_b32 v77, v60, v56, s70 bitop3:0x7e
    v_and_b32 v77, 1, v77
    v_cmp_ne_u32 vcc, 0, v77
    s_cbranch_vccz cs_goA
    s_nop 15
    s_nop 15
    s_nop 7
    v_bitop3_b32 v77, v60, v56, s70 bitop3:0x7e
    v_and_b32 v77, 1, v77
    v_cmp_ne_u32 vcc, 0, v77
    s_cbranch_vccz cs_goA
    s_nop 15
    s_nop 15
    s_nop 7
    v_bitop3_b32 v77, v60, v56, s70 bitop3:0x7e
    v_and_b32 v77, 1, v77
    v_cmp_ne_u32 vcc, 0, v77
    s_cbranch_vccz cs_goA
    s_nop 15
    s_nop 15
    s_nop 7
    buffer_load_dwordx4 v[60:63], v65, s[4:7], s14 offen offset:0 sc1
    buffer_load_dwordx4 v[56:59], v66, s[4:7], s14 offen offset:0 sc1
    v_bitop3_b32 v77, v60, v56, s70 bitop3:0x7e
    v_and_b32 v77, 1, v77
    v_cmp_ne_u32 vcc, 0, v77
    s_cbranch_vccz cs_goA
    s_nop 15
    s_nop 15
    s_nop 7
    v_bitop3_b32 v77, v60, v56, s70 bitop3:0x7e
    v_and_b32 v77, 1, v77
    v_cmp_ne_u32 vcc, 0, v77
    s_cbranch_vccz cs_goA
    s_nop 15
    s_nop 15
    s_nop 7
    v_bitop3_b32 v77, v60, v56, s70 bitop3:0x7e
    v_and_b32 v77, 1, v77
    v_cmp_ne_u32 vcc, 0, v77
    s_cbranch_vccz cs_goA
    s_nop 15
    s_nop 15
    s_nop 7
    v_bitop3_b32 v77, v60, v56, s70 bitop3:0x7e
    v_and_b32 v77, 1, v77
    v_cmp_ne_u32 vcc, 0, v77
    s_cbranch_vccz cs_goA
    s_nop 15
    s_nop 15
    s_nop 7
    buffer_load_dwordx4 v[60:63], v65, s[4:7], s14 offen offset:0 sc1
    buffer_load_dwordx4 v[56:59], v66, s[4:7], s14 offen offset:0 sc1
    v_bitop3_b32 v77, v60, v56, s70 bitop3:0x7e
    v_and_b32 v77, 1, v77
    v_cmp_ne_u32 vcc, 0, v77
    s_cbranch_vccz cs_goA
    s_nop 15
    s_nop 15
    s_nop 7
    v_bitop3_b32 v77, v60, v56, s70 bitop3:0x7e
    v_and_b32 v77, 1, v77
    v_cmp_ne_u32 vcc, 0, v77
    s_cbranch_vccz cs_goA
    s_nop 15
    s_nop 15
    s_nop 7
    v_bitop3_b32 v77, v60, v56, s70 bitop3:0x7e
    v_and_b32 v77, 1, v77
    v_cmp_ne_u32 vcc, 0, v77
    s_cbranch_vccz cs_goA
    s_nop 15
    s_nop 15
    s_nop 7
    v_bitop3_b32 v77, v60, v56, s70 bitop3:0x7e
    v_and_b32 v77, 1, v77
    v_cmp_ne_u32 vcc, 0, v77
    s_cbranch_vccz cs_goA
    s_nop 15
    s_nop 15
    s_nop 7
    s_sub_u32 s31, s31, 64
    s_cbranch_scc0 cs_cA
cs_goA:
    ds_write_b128 v65, v[60:63] offset:0
    v_smfmac_f32_16x16x64_bf16 v[0:3], v[60:63], v[40:47], v64
    v_smfmac_f32_16x16x64_bf16 v[4:7], v[60:63], v[48:55], v64
    buffer_load_dwordx4 v[40:43], v65, s[4:7], s15 offen offset:0 sc1
    v_smfmac_f32_16x16x64_bf16 v[0:3], v[56:59], v[24:31], v64
    v_smfmac_f32_16x16x64_bf16 v[4:7], v[56:59], v[32:39], v64
    ds_read_b128 v[24:27], v70 offset:8192
    v_smfmac_f32_16x16x64_bf16 v[8:11], v[60:63], a[96:103], v64
    ds_read_b128 v[28:31], v70 offset:9216
    v_smfmac_f32_16x16x64_bf16 v[12:15], v[60:63], a[104:111], v64
    ds_read_b128 v[32:35], v70 offset:10240
    s_waitcnt lgkmcnt(3)
    s_barrier
    ds_read_b128 v[48:51], v67 offset:0
    v_smfmac_f32_16x16x64_bf16 v[8:11], v[56:59], a[112:119], v64
    ds_read_b128 v[36:39], v70 offset:11264
    v_smfmac_f32_16x16x64_bf16 v[12:15], v[56:59], a[120:127], v64
    ds_read_b128 v[52:55], v68 offset:0
    v_smfmac_f32_16x16x64_bf16 v[16:19], v[60:63], a[216:223], v64
    buffer_load_dwordx4 v[40:43], v65, s[4:7], s15 offen offset:0 sc1
    s_waitcnt lgkmcnt(4)
    v_smfmac_f32_16x16x64_bf16 v[20:23], v[60:63], v[24:31], v64
    ds_read_b128 v[24:27], v70 offset:12288
    s_waitcnt lgkmcnt(3)
    v_smfmac_f32_16x16x64_bf16 v[0:3], v[48:51], a[0:7], v64
    ds_read_b128 v[28:31], v70 offset:13312
    s_waitcnt lgkmcnt(3)
    v_smfmac_f32_16x16x64_bf16 v[4:7], v[48:51], v[32:39], v64
    ds_read_b128 v[32:35], v70 offset:14336
    v_smfmac_f32_16x16x64_bf16 v[8:11], v[48:51], a[128:135], v64
    ds_read_b128 v[36:39], v70 offset:15360
    v_smfmac_f32_16x16x64_bf16 v[12:15], v[48:51], a[136:143], v64
    v_smfmac_f32_16x16x64_bf16 v[16:19], v[56:59], a[224:231], v64
    v_smfmac_f32_16x16x64_bf16 v[20:23], v[56:59], a[232:239], v64
    s_waitcnt lgkmcnt(2)
    s_waitcnt vmcnt(1)
    v_and_b32 v77, 1, v40
    v_smfmac_f32_16x16x64_bf16 v[12:15], v[52:55], v[24:31], v64
    ds_write_b128 v65, v[40:43] offset:4096
    v_smfmac_f32_16x16x64_bf16 v[0:3], v[52:55], a[8:15], v64
    s_waitcnt lgkmcnt(1)
    v_cmp_ne_u32 vcc, s70, v77
    v_smfmac_f32_16x16x64_bf16 v[4:7], v[52:55], v[32:39], v64
    buffer_load_dwordx4 v[60:63], v65, s[4:7], s16 offen offset:0 sc1
    v_smfmac_f32_16x16x64_bf16 v[8:11], v[52:55], a[144:151], v64
    s_cbranch_vccnz cs_spinB
cs_backB:
    v_smfmac_f32_16x16x64_bf16 v[16:19], v[40:43], v[176:183], v64
    s_waitcnt lgkmcnt(0)
    s_barrier
    ds_read_b128 v[44:47], v66 offset:4096
    v_smfmac_f32_16x16x64_bf16 v[12:15], v[40:43], a[160:167], v64
    ds_read_b128 v[32:35], v70 offset:16384
    buffer_load_dwordx4 v[24:27], v65, s[4:7], s24 offen offset:0 sc1
    v_smfmac_f32_16x16x64_bf16 v[0:3], v[40:43], a[16:23], v64
    ds_read_b128 v[36:39], v70 offset:17408
    v_smfmac_f32_16x16x64_bf16 v[8:11], v[40:43], a[152:159], v64
    ds_read_b128 v[48:51], v67 offset:4096
    v_smfmac_f32_16x16x64_bf16 v[4:7], v[40:43], a[24:31], v64
    ds_read_b128 v[52:55], v68 offset:4096
    v_smfmac_f32_16x16x64_bf16 v[20:23], v[40:43], v[184:191], v64
    buffer_load_dwordx4 v[28:31], v65, s[4:7], s24 offen offset:1024 sc1
    s_waitcnt lgkmcnt(4)
    v_smfmac_f32_16x16x64_bf16 v[0:3], v[44:47], a[32:39], v64
    ds_read_b128 v[56:59], v69 offset:15360
    s_waitcnt lgkmcnt(3)
    v_smfmac_f32_16x16x64_bf16 v[8:11], v[44:47], v[32:39], v64
    ds_read_b128 v[32:35], v70 offset:18432
    v_smfmac_f32_16x16x64_bf16 v[4:7], v[44:47], a[40:47], v64
    ds_read_b128 v[36:39], v70 offset:19456
    s_add_u32 s40, s26, 1048576
    v_lshlrev_b32 v78, 2, v65
    v_smfmac_f32_16x16x64_bf16 v[12:15], v[44:47], a[168:175], v64
    buffer_load_dwordx4 v[42:45], v65, s[4:7], s24 offen offset:3072 sc1
    s_waitcnt lgkmcnt(3)
    v_smfmac_f32_16x16x64_bf16 v[0:3], v[48:51], a[48:55], v64
    v_smfmac_f32_16x16x64_bf16 v[8:11], v[48:51], a[176:183], v64
    v_smfmac_f32_16x16x64_bf16 v[0:3], v[52:55], a[64:71], v64
    s_waitcnt lgkmcnt(0)
    v_smfmac_f32_16x16x64_bf16 v[8:11], v[52:55], v[32:39], v64
    buffer_load_dwordx4 v[34:37], v65, s[4:7], s24 offen offset:2048 sc1
    v_smfmac_f32_16x16x64_bf16 v[4:7], v[48:51], a[56:63], v64
    v_smfmac_f32_16x16x64_bf16 v[4:7], v[52:55], a[72:79], v64
    s_waitcnt vmcnt(4)
    v_and_b32 v77, 1, v60
    v_smfmac_f32_16x16x64_bf16 v[12:15], v[48:51], a[184:191], v64
    v_cmp_ne_u32 vcc, s70, v77
    v_smfmac_f32_16x16x64_bf16 v[12:15], v[52:55], a[192:199], v64
    s_cbranch_vccnz cs_spin8
cs_back8:
    v_smfmac_f32_16x16x64_bf16 v[0:3], v[60:63], a[80:87], v64
    s_nop 1
    v_lshrrev_b32 v77, 1, v69
    v_smfmac_f32_16x16x64_bf16 v[8:11], v[60:63], a[200:207], v64
    buffer_load_dword v76, v78, s[4:7], s40 offen sc1
    s_nop 1
    v_smfmac_f32_16x16x64_bf16 v[4:7], v[60:63], a[88:95], v64
    s_nop 1
    v_cvt_pk_bf16_f32 v0, v0, v1
    v_smfmac_f32_16x16x64_bf16 v[12:15], v[60:63], a[208:215], v64
    s_nop 1
    v_cvt_pk_bf16_f32 v1, v2, v3
    v_cvt_pk_bf16_f32 v2, v8, v9
    v_cvt_pk_bf16_f32 v3, v10, v11
    v_cvt_pk_bf16_f32 v4, v4, v5
    v_cvt_pk_bf16_f32 v5, v6, v7
    v_mfma_f32_16x16x32_bf16 v[8:11], v[0:3], v[56:59], 0
    v_cvt_pk_bf16_f32 v6, v12, v13
    v_cvt_pk_bf16_f32 v7, v14, v15
    s_nop 1
    v_mfma_f32_16x16x32_bf16 v[12:15], v[4:7], v[56:59], 0
    ds_read_b128 v[56:59], v66 offset:4096
    s_nop 1
    v_smfmac_f32_16x16x64_bf16 v[16:19], v[48:51], v[208:215], v64
    s_waitcnt vmcnt(3)
    s_nop 1
    s_nop 0
    v_cvt_pk_bf16_f32 v0, v8, v12
    v_cvt_pk_bf16_f32 v1, v9, v13
    v_cvt_pk_bf16_f32 v2, v10, v14
    v_cvt_pk_bf16_f32 v3, v11, v15
    s_nop 1
    v_mfma_f32_16x16x32_bf16 v[12:15], v[0:3], v[0:3], 0
    s_nop 2
    v_mfma_f32_16x16x32_bf16 v[4:7], v[24:27], v[0:3], 0
    ds_read_b128 v[24:27], v67 offset:0
    s_nop 1
    v_mfma_f32_16x16x32_bf16 v[8:11], v[28:31], v[0:3], 0
    s_nop 0
    v_mov_b32_dpp v12, v14 row_ror:8 row_mask:0xf bank_mask:0xc
    v_mov_b32_dpp v13, v15 row_ror:8 row_mask:0xf bank_mask:0xc
    v_smfmac_f32_16x16x64_bf16 v[20:23], v[48:51], v[216:223], v64
    ds_write_b64 v71, v[12:13]
    ds_read_b128 v[48:51], v68 offset:0
    s_nop 1
    v_mov_b32_dpp v4, v8 row_ror:8 row_mask:0xf bank_mask:0xc
    v_mov_b32_dpp v5, v9 row_ror:8 row_mask:0xf bank_mask:0xc
    v_mov_b32_dpp v6, v10 row_ror:8 row_mask:0xf bank_mask:0xc
    v_mov_b32_dpp v7, v11 row_ror:8 row_mask:0xf bank_mask:0xc
    v_smfmac_f32_16x16x64_bf16 v[16:19], v[52:55], v[224:231], v64
    ds_write_b128 v65, v[4:7] offset:8192
    v_smfmac_f32_16x16x64_bf16 v[20:23], v[52:55], v[232:239], v64
    s_waitcnt lgkmcnt(3)
    v_smfmac_f32_16x16x64_bf16 v[16:19], v[24:27], a[240:247], v64
    v_smfmac_f32_16x16x64_bf16 v[20:23], v[24:27], a[248:255], v64
    v_smfmac_f32_16x16x64_bf16 v[16:19], v[60:63], v[240:247], v64
    s_waitcnt lgkmcnt(0)
    s_barrier
    ds_read_b128 v[8:11], v66 offset:8192
    v_smfmac_f32_16x16x64_bf16 v[20:23], v[60:63], v[248:255], v64
    ds_read_b128 v[12:15], v67 offset:8192
    ds_read_b128 v[0:3], v68 offset:8192
    ds_read_b64 v[24:25], v77 offset:14336
    v_smfmac_f32_16x16x64_bf16 v[16:19], v[56:59], v[192:199], v64
    ds_read_b64 v[26:27], v77 offset:14592
    ds_read_b64 v[28:29], v77 offset:14848
    ds_read_b64 v[30:31], v77 offset:15104
    v_smfmac_f32_16x16x64_bf16 v[20:23], v[56:59], v[200:207], v64
    s_waitcnt vmcnt(1)
    v_smfmac_f32_16x16x64_bf16 v[16:19], v[48:51], v[160:167], v64
    s_mov_b64 exec, s[36:37]
    buffer_store_dword v72, v75, s[4:7], s28 offen sc1
    s_mov_b64 exec, -1
    v_smfmac_f32_16x16x64_bf16 v[20:23], v[48:51], v[168:175], v64
    ds_read_b128 v[56:59], v70 offset:22528
    ds_read_b128 v[60:63], v70 offset:23552
    s_cmp_lt_u32 s97, s93
    s_cbranch_scc1 cs_kvasync
cs_kvasync_x:
    s_waitcnt lgkmcnt(8)
    v_pk_add_f32 v[4:5], v[4:5], v[8:9]
    v_pk_add_f32 v[6:7], v[6:7], v[10:11]
    s_waitcnt lgkmcnt(6)
    v_pk_add_f32 v[12:13], v[12:13], v[0:1]
    v_pk_add_f32 v[14:15], v[14:15], v[2:3]
    v_pk_add_f32 v[4:5], v[4:5], v[12:13]
    v_pk_add_f32 v[6:7], v[6:7], v[14:15]
    s_waitcnt lgkmcnt(2)
    v_pk_add_f32 v[24:25], v[24:25], v[26:27]
    v_pk_add_f32 v[28:29], v[28:29], v[30:31]
    v_max3_f32 v77, v4, v5, v6
    v_pk_add_f32 v[24:25], v[24:25], v[28:29]
    v_max_f32 v77, v77, v7
    v_max3_f32 v77, v77, v24, v25
    v_cvt_pk_bf16_f32 v32, v16, v17
    v_cvt_pk_bf16_f32 v38, v18, v19
    v_max_f32_dpp v77, v77, v77 row_ror:8 row_mask:0xf bank_mask:0xf
    v_mov_b32 v78, v77
    v_cvt_pk_bf16_f32 v40, v20, v21
    v_cvt_pk_bf16_f32 v46, v22, v23
    v_permlane32_swap_b32 v77, v78
    v_max_f32 v77, v77, v78
    v_mov_b32 v78, v77
    v_mov_b32 v11, 0
    v_mov_b32 v15, 0
    v_permlane16_swap_b32 v77, v78
    v_max_f32 v77, v77, v78
    v_mul_f32 v8, s66, v77
    v_pk_fma_f32 v[4:5], v[4:5], s[44:45], v[8:9] op_sel_hi:[1,1,0]
    v_pk_fma_f32 v[6:7], v[6:7], s[44:45], v[8:9] op_sel_hi:[1,1,0]
    v_pk_fma_f32 v[24:25], v[24:25], s[44:45], v[8:9] op_sel_hi:[1,1,0]
    v_exp_f32 v4, v4
    v_exp_f32 v5, v5
    v_exp_f32 v6, v6
    v_exp_f32 v7, v7
    v_exp_f32 v24, v24
    v_exp_f32 v25, v25
    v_cvt_pk_bf16_f32 v12, v4, v5
    v_cvt_pk_bf16_f32 v13, v6, v7
    v_cvt_pk_bf16_f32 v10, v24, v25
    v_cvt_pk_bf16_f32 v14, v24, v25
    v_bitop3_b32 v77, v73, -9, s52 bitop3:0x6a
    v_mfma_f32_16x16x32_bf16 v[4:7], v[32:35], v[10:13], 0
    ds_read_b128 v[48:51], v70 offset:20480
    v_mov_b64 v[0:1], s[48:49]
    v_mov_b64 v[2:3], s[50:51]
    v_mfma_f32_16x16x32_bf16 v[24:27], v[36:39], v[12:15], 0
    ds_read_b128 v[52:55], v70 offset:21504
    v_bitop3_b32 v78, v73, -9, s53 bitop3:0x6a
    v_bitop3_b32 v79, v73, -9, s54 bitop3:0x6a
    v_mfma_f32_16x16x32_bf16 v[28:31], v[0:3], v[10:13], 0
    ds_read_b128 v[32:35], v70 offset:24576
    v_mov_b64 v[0:1], 0
    v_mov_b64 v[2:3], 0
    v_mfma_f32_16x16x32_bf16 v[16:19], v[40:43], v[10:13], 0
    ds_read_b128 v[36:39], v70 offset:25600
    v_mov_b64 v[8:9], 0
    s_nop 0
    v_mfma_f32_16x16x32_bf16 v[20:23], v[44:47], v[12:15], 0
    ds_read_b128 v[40:43], v70 offset:26624
    ds_read_b128 v[44:47], v70 offset:27648
    v_add_f32_dpp v4, v24, v4 row_ror:8 row_mask:0xf bank_mask:0xf
    v_add_f32_dpp v5, v25, v5 row_ror:8 row_mask:0xf bank_mask:0xf
    v_add_f32_dpp v6, v26, v6 row_ror:8 row_mask:0xf bank_mask:0xf
    v_add_f32_dpp v7, v27, v7 row_ror:8 row_mask:0xf bank_mask:0xf
    v_add_f32_dpp v29, v28, v28 row_ror:8 row_mask:0xf bank_mask:0xf
    v_rcp_f32 v28, v29
    v_add_f32_dpp v4, v16, v20 row_ror:8 row_mask:0xf bank_mask:0xc
    v_add_f32_dpp v5, v17, v21 row_ror:8 row_mask:0xf bank_mask:0xc
    v_add_f32_dpp v6, v18, v22 row_ror:8 row_mask:0xf bank_mask:0xc
    v_add_f32_dpp v7, v19, v23 row_ror:8 row_mask:0xf bank_mask:0xc
    v_pk_mul_f32 v[4:5], v[4:5], v[28:29] op_sel_hi:[1,0]
    v_pk_mul_f32 v[6:7], v[6:7], v[28:29] op_sel_hi:[1,0]
    v_cvt_pk_bf16_f32 v4, v4, v5
    v_cvt_pk_bf16_f32 v5, v6, v7
    ds_write_b64 v73, v[4:5] offset:12288
    v_mov_b32_dpp v6, v4 row_ror:8 row_mask:0xf bank_mask:0xf
    v_mov_b32_dpp v7, v5 row_ror:8 row_mask:0xf bank_mask:0xf
    v_mov_b64 v[10:11], 0
    s_waitcnt lgkmcnt(5)
    v_mov_b64 v[12:13], 0
    v_smfmac_f32_16x16x64_bf16 v[0:3], v[4:7], v[48:55], v64
    v_mov_b64 v[14:15], 0
    v_mov_b32 v52, v78
    v_smfmac_f32_16x16x64_bf16 v[8:11], v[4:7], v[80:87], v64
    v_mov_b64 v[24:25], 0
    v_mov_b64 v[26:27], 0
    v_smfmac_f32_16x16x64_bf16 v[12:15], v[4:7], v[112:119], v64
    s_waitcnt lgkmcnt(0)
    v_mov_b32_dpp v52, v79 quad_perm:[0,1,2,3] row_mask:0xf bank_mask:0xc
    v_xor_b32 v48, 1024, v52
    s_barrier
    ds_read_b128 v[16:19], v77 offset:12288
    v_smfmac_f32_16x16x64_bf16 v[24:27], v[4:7], v[56:63], v64
    ds_read_b128 v[20:23], v78 offset:12288
    ds_read_b128 v[28:31], v79 offset:12288
    ds_read_b128 v[52:55], v52 offset:12288
    ds_read_b128 v[48:51], v48 offset:12288
    v_mov_b64 v[4:5], 0
    v_mov_b64 v[6:7], 0
    s_waitcnt lgkmcnt(4)
    v_smfmac_f32_16x16x64_bf16 v[8:11], v[16:19], v[88:95], v64
    ds_read_b128 v[56:59], v70 offset:28672
    v_smfmac_f32_16x16x64_bf16 v[12:15], v[16:19], v[120:127], v64
    ds_read_b128 v[60:63], v70 offset:29696
    s_waitcnt lgkmcnt(5)
    v_smfmac_f32_16x16x64_bf16 v[8:11], v[20:23], v[96:103], v64
    v_bfe_u32 v77, v74, 16, 1
    v_smfmac_f32_16x16x64_bf16 v[12:15], v[20:23], v[128:135], v64
    s_waitcnt lgkmcnt(4)
    v_mad_i32_i24 v77, v77, s56, v74
    v_smfmac_f32_16x16x64_bf16 v[8:11], v[28:31], v[104:111], v64
    s_nop 2
    v_smfmac_f32_16x16x64_bf16 v[12:15], v[28:31], v[136:143], v64
    s_waitcnt lgkmcnt(2)
    s_nop 1
    v_smfmac_f32_16x16x64_bf16 v[4:7], v[48:51], v[144:151], v64
    v_cvt_pk_bf16_f32 v8, v8, v9
    v_cvt_pk_bf16_f32 v9, v10, v11
    v_and_or_b32 v8, v8, -2, s69
    s_nop 0
    v_cvt_pk_bf16_f32 v10, v12, v13
    v_cvt_pk_bf16_f32 v11, v14, v15
    v_smfmac_f32_16x16x64_bf16 v[4:7], v[52:55], v[152:159], v64
    buffer_store_dwordx4 v[8:11], v74, s[4:7], s22 offen sc1
    ds_read_b128 v[48:51], v70 offset:30720
    v_smfmac_f32_16x16x64_bf16 v[0:3], v[16:19], v[32:39], v64
    ds_read_b128 v[52:55], v70 offset:31744
    s_add_u32 s30, s30, 1
    s_waitcnt lgkmcnt(2)
    v_smfmac_f32_16x16x64_bf16 v[24:27], v[16:19], v[40:47], v64
    ds_read_b128 v[32:35], v70 offset:32768
    v_cvt_pk_bf16_f32 v4, v4, v5
    v_cvt_pk_bf16_f32 v5, v6, v7
    v_and_or_b32 v4, v4, -2, s69
    v_smfmac_f32_16x16x64_bf16 v[0:3], v[20:23], v[56:63], v64
    buffer_store_dwordx2 v[4:5], v77, s[4:7], s25 offen sc1
    ds_read_b128 v[36:39], v70 offset:33792
    s_xor_b32 s70, s70, 1
    ds_read_b128 v[40:43], v70 offset:34816
    s_waitcnt lgkmcnt(3)
    v_smfmac_f32_16x16x64_bf16 v[24:27], v[20:23], v[48:55], v64
    ds_read_b128 v[44:47], v70 offset:35840
    s_cmp_eq_u32 s30, 63
    s_cselect_b32 s57, 7, s71
    s_waitcnt lgkmcnt(2)
    v_smfmac_f32_16x16x64_bf16 v[0:3], v[28:31], v[32:39], v64
    s_cmp_lg_u32 s57, 0
    s_waitcnt lgkmcnt(0)
    s_nop 0
    v_smfmac_f32_16x16x64_bf16 v[24:27], v[28:31], v[40:47], v64
    s_nop 3
    v_cvt_pk_bf16_f32 v0, v0, v1
    v_cvt_pk_bf16_f32 v1, v2, v3
    v_and_or_b32 v0, v0, -2, s69
    s_nop 0
    v_cvt_pk_bf16_f32 v2, v24, v25
    v_cvt_pk_bf16_f32 v3, v26, v27
    buffer_store_dwordx4 v[0:3], v74, s[4:7], s23 offen sc1
    s_cbranch_scc1 cs_e1
    s_nop 0
    s_nop 2
    v_mov_b32 v79, v79
    s_nop 2
    v_mov_b32 v79, v79
    s_nop 2
    v_mov_b32 v79, v79
    s_nop 2
    v_mov_b32 v79, v79
    s_nop 2
    v_mov_b32 v79, v79
    s_nop 2
    v_mov_b32 v79, v79
    s_nop 2
    v_mov_b32 v79, v79
    s_nop 2
    v_mov_b32 v79, v79
    s_nop 2
    v_mov_b32 v79, v79
    s_nop 2
    v_mov_b32 v79, v79
    s_nop 2
    v_mov_b32 v79, v79
    s_nop 2
    v_mov_b32 v79, v79
    s_nop 2
    v_mov_b32 v79, v79
    s_nop 2
    v_mov_b32 v79, v79
    s_nop 2
    v_mov_b32 v79, v79
    s_nop 2
    v_mov_b32 v79, v79
    s_nop 2
    v_mov_b32 v79, v79
    s_nop 2
    v_mov_b32 v79, v79
    s_nop 2
    v_mov_b32 v79, v79
    s_nop 2
    v_mov_b32 v79, v79
    s_nop 2
    v_mov_b32 v79, v79
    s_nop 2
    v_mov_b32 v79, v79
    s_nop 2
    v_mov_b32 v79, v79
    s_nop 2
    v_mov_b32 v79, v79
    s_nop 2
    v_mov_b32 v79, v79
    s_nop 2
    v_mov_b32 v79, v79
    s_nop 2
    v_mov_b32 v79, v79
    s_nop 2
    v_mov_b32 v79, v79
    s_nop 2
    v_mov_b32 v79, v79
    s_nop 2
    v_mov_b32 v79, v79
    s_nop 2
    v_mov_b32 v79, v79
    s_nop 2
    v_mov_b32 v79, v79
    s_nop 2
    v_mov_b32 v79, v79
    s_nop 2
    v_mov_b32 v79, v79
    s_nop 2
    v_mov_b32 v79, v79
    s_nop 2
    v_mov_b32 v79, v79
    s_nop 2
    v_mov_b32 v79, v79
    s_nop 0
    v_mov_b32 v79, v79
    buffer_load_dwordx4 v[8:11], v65, s[4:7], s18 offen sc1
    buffer_load_dwordx4 v[12:15], v65, s[4:7], s19 offen sc1
    buffer_load_dwordx4 v[16:19], v65, s[4:7], s20 offen sc1
    buffer_load_dwordx4 v[20:23], v65, s[4:7], s21 offen sc1
    v_and_b32 v77, 255, v69
    ds_read_b128 v[4:7], v77 offset:15872
    ds_read_b128 v[40:43], v70 offset:0
    ds_read_b128 v[44:47], v70 offset:1024
    ds_read_b128 v[48:51], v70 offset:2048
    ds_read_b128 v[52:55], v70 offset:3072
    ds_read_b128 v[24:27], v70 offset:4096
    ds_read_b128 v[28:31], v70 offset:5120
    ds_read_b128 v[32:35], v70 offset:6144
    ds_read_b128 v[36:39], v70 offset:7168
    s_mov_b32 s31, 65536
    s_add_u32 s24, s24, 524288
    s_add_u32 s26, s26, 524288
    s_add_u32 s28, s28, s27
    v_mov_b32 v60, s69
    v_mov_b32 v56, s69
    v_and_b32 v79, 12, v75
    v_cmp_eq_u32 vcc, 0, v79
    s_nop 1
    v_cndmask_b32 v79, 0, 1, vcc
    s_waitcnt lgkmcnt(0)
    s_waitcnt vmcnt(3)
    v_xor_b32 v77, s69, v8
    v_mfma_f32_16x16x32_bf16 v[0:3], v[4:7], v[8:11], 0
    s_waitcnt vmcnt(2)
    v_bitop3_b32 v77, v77, v12, s69 bitop3:0xf6
    v_mfma_f32_16x16x32_bf16 v[0:3], v[4:7], v[12:15], v[0:3]
    s_waitcnt vmcnt(1)
    v_bitop3_b32 v77, v77, v16, s69 bitop3:0xf6
    v_mfma_f32_16x16x32_bf16 v[0:3], v[4:7], v[16:19], v[0:3]
    s_waitcnt vmcnt(0)
    v_bitop3_b32 v77, v77, v20, s69 bitop3:0xf6
    v_mfma_f32_16x16x32_bf16 v[0:3], v[4:7], v[20:23], v[0:3]
    v_and_b32 v77, 1, v77
    v_cmp_ne_u32 vcc, 0, v77
    s_nop 0
    s_cmp_eq_u64 vcc, 0
    s_cselect_b64 s[42:43], -1, 0
    s_nop 2
    v_add_f32_dpp v0, v0, v0 row_ror:8 row_mask:0xf bank_mask:0xf
    v_add_f32_dpp v1, v1, v1 row_ror:8 row_mask:0xf bank_mask:0xf
    s_mov_b64 exec, s[42:43]
    v_cvt_pk_bf16_f32 v72, v0, v1
    v_bfi_b32 v72, v79, s70, v72
    buffer_store_dword v72, v75, s[4:7], s17 offen offset:0 sc1
    s_mov_b64 exec, -1
    s_cbranch_scc0 cs_f0_retry
cs_f0_go:
    v_mov_b64 v[0:1], 0
    v_mov_b64 v[2:3], 0
    v_mov_b64 v[4:5], 0
    v_mov_b64 v[6:7], 0
    v_mov_b64 v[8:9], 0
    v_mov_b64 v[10:11], 0
    v_mov_b64 v[12:13], 0
    v_mov_b64 v[14:15], 0
    v_mov_b64 v[16:17], 0
    v_mov_b64 v[18:19], 0
    v_mov_b64 v[20:21], 0
    v_mov_b64 v[22:23], 0
    s_nop 2
    v_mov_b32 v79, v79
    s_nop 2
    v_mov_b32 v79, v79
    s_nop 2
    v_mov_b32 v79, v79
    s_nop 2
    v_mov_b32 v79, v79
    s_nop 2
    v_mov_b32 v79, v79
    s_nop 2
    v_mov_b32 v79, v79
    s_nop 2
    v_mov_b32 v79, v79
    s_nop 2
    v_mov_b32 v79, v79
    s_nop 2
    v_mov_b32 v79, v79
    s_nop 2
    v_mov_b32 v79, v79
    s_nop 2
    v_mov_b32 v79, v79
    s_nop 2
    v_mov_b32 v79, v79
    s_nop 2
    v_mov_b32 v79, v79
    s_nop 2
    v_mov_b32 v79, v79
    s_nop 2
    v_mov_b32 v79, v79
    s_nop 2
    v_mov_b32 v79, v79
    s_nop 2
    v_mov_b32 v79, v79
    s_nop 2
    v_mov_b32 v79, v79
    s_nop 2
    v_mov_b32 v79, v79
    s_nop 2
    v_mov_b32 v79, v79
    s_nop 2
    v_mov_b32 v79, v79
    s_nop 2
    v_mov_b32 v79, v79
    s_nop 2
    v_mov_b32 v79, v79
    s_nop 2
    v_mov_b32 v79, v79
    s_nop 2
    v_mov_b32 v79, v79
    s_branch cs_loop
cs_e1:
    s_cmp_lg_u32 s57, 2
    s_cbranch_scc1 cs_f1
    s_nop 2
    v_mov_b32 v79, v79
    s_nop 2
    v_mov_b32 v79, v79
    s_nop 2
    v_mov_b32 v79, v79
    s_nop 2
    v_mov_b32 v79, v79
    s_nop 2
    v_mov_b32 v79, v79
    s_nop 2
    v_mov_b32 v79, v79
    s_nop 2
    v_mov_b32 v79, v79
    s_nop 2
    v_mov_b32 v79, v79
    s_nop 2
    v_mov_b32 v79, v79
    s_nop 2
    v_mov_b32 v79, v79
    s_nop 2
    v_mov_b32 v79, v79
    s_nop 2
    v_mov_b32 v79, v79
    s_nop 2
    v_mov_b32 v79, v79
    s_nop 2
    v_mov_b32 v79, v79
    s_nop 2
    v_mov_b32 v79, v79
    s_nop 2
    v_mov_b32 v79, v79
    s_nop 2
    v_mov_b32 v79, v79
    s_nop 2
    v_mov_b32 v79, v79
    s_nop 2
    v_mov_b32 v79, v79
    s_nop 2
    v_mov_b32 v79, v79
    s_nop 2
    v_mov_b32 v79, v79
    s_nop 2
    v_mov_b32 v79, v79
    s_nop 2
    v_mov_b32 v79, v79
    s_nop 2
    v_mov_b32 v79, v79
    s_nop 2
    v_mov_b32 v79, v79
    s_nop 2
    v_mov_b32 v79, v79
    s_nop 2
    v_mov_b32 v79, v79
    s_nop 2
    v_mov_b32 v79, v79
    s_nop 2
    v_mov_b32 v79, v79
    s_nop 2
    v_mov_b32 v79, v79
    s_nop 2
    v_mov_b32 v79, v79
    s_nop 2
    v_mov_b32 v79, v79
    s_nop 2
    v_mov_b32 v79, v79
    s_nop 2
    v_mov_b32 v79, v79
    s_nop 2
    v_mov_b32 v79, v79
    s_nop 2
    v_mov_b32 v79, v79
    s_nop 2
    v_mov_b32 v79, v79
    s_nop 0
    v_mov_b32 v79, v79
    buffer_load_dwordx4 v[8:11], v65, s[4:7], s18 offen sc1
    buffer_load_dwordx4 v[12:15], v65, s[4:7], s19 offen sc1
    buffer_load_dwordx4 v[16:19], v65, s[4:7], s20 offen sc1
    buffer_load_dwordx4 v[20:23], v65, s[4:7], s21 offen sc1
    v_and_b32 v77, 255, v69
    ds_read_b128 v[4:7], v77 offset:15872
    ds_read_b128 v[40:43], v70 offset:0
    ds_read_b128 v[44:47], v70 offset:1024
    ds_read_b128 v[48:51], v70 offset:2048
    ds_read_b128 v[52:55], v70 offset:3072
    ds_read_b128 v[24:27], v70 offset:4096
    ds_read_b128 v[28:31], v70 offset:5120
    ds_read_b128 v[32:35], v70 offset:6144
    ds_read_b128 v[36:39], v70 offset:7168
    s_mov_b32 s31, 65536
    s_add_u32 s24, s24, 524288
    s_add_u32 s26, s26, 524288
    s_add_u32 s28, s28, s27
    v_mov_b32 v60, s69
    v_mov_b32 v56, s69
    v_and_b32 v79, 12, v75
    v_cmp_eq_u32 vcc, 0, v79
    s_nop 1
    v_cndmask_b32 v79, 0, 1, vcc
    s_waitcnt lgkmcnt(0)
    s_waitcnt vmcnt(3)
    v_xor_b32 v77, s69, v8
    v_bitop3_b32 v77, v77, v10, s69 bitop3:0xf6
    v_mfma_f32_16x16x32_bf16 v[0:3], v[4:7], v[8:11], 0
    s_waitcnt vmcnt(2)
    v_bitop3_b32 v77, v77, v12, s69 bitop3:0xf6
    v_bitop3_b32 v77, v77, v14, s69 bitop3:0xf6
    v_mfma_f32_16x16x32_bf16 v[0:3], v[4:7], v[12:15], v[0:3]
    s_waitcnt vmcnt(1)
    v_bitop3_b32 v77, v77, v16, s69 bitop3:0xf6
    v_bitop3_b32 v77, v77, v18, s69 bitop3:0xf6
    v_mfma_f32_16x16x32_bf16 v[0:3], v[4:7], v[16:19], v[0:3]
    s_waitcnt vmcnt(0)
    v_bitop3_b32 v77, v77, v20, s69 bitop3:0xf6
    v_bitop3_b32 v77, v77, v22, s69 bitop3:0xf6
    v_mfma_f32_16x16x32_bf16 v[0:3], v[4:7], v[20:23], v[0:3]
    v_and_b32 v77, 1, v77
    v_cmp_ne_u32 vcc, 0, v77
    s_nop 0
    s_cmp_eq_u64 vcc, 0
    s_cselect_b64 s[42:43], -1, 0
    s_nop 2
    v_add_f32 v2, v0, v1
    s_nop 1
    v_add_f32_dpp v2, v2, v2 row_ror:8 row_mask:0xf bank_mask:0xf
    s_nop 1
    v_mov_b32_dpp v0, v2 quad_perm:[0,0,2,2] row_mask:0xf bank_mask:0xf
    v_mov_b32_dpp v1, v2 quad_perm:[1,1,3,3] row_mask:0xf bank_mask:0xf
    s_mov_b64 exec, s[42:43]
    v_cvt_pk_bf16_f32 v72, v0, v1
    v_bfi_b32 v72, v79, s70, v72
    buffer_store_dword v72, v75, s[4:7], s17 offen offset:0 sc1
    buffer_store_dword v72, v75, s[4:7], s17 offen offset:1024 sc1
    buffer_store_dword v72, v75, s[4:7], s17 offen offset:2048 sc1
    buffer_store_dword v72, v75, s[4:7], s17 offen offset:3072 sc1
    s_mov_b64 exec, -1
    s_cbranch_scc0 cs_f2_retry
cs_f2_go:
    v_mov_b64 v[0:1], 0
    v_mov_b64 v[2:3], 0
    v_mov_b64 v[4:5], 0
    v_mov_b64 v[6:7], 0
    v_mov_b64 v[8:9], 0
    v_mov_b64 v[10:11], 0
    v_mov_b64 v[12:13], 0
    v_mov_b64 v[14:15], 0
    v_mov_b64 v[16:17], 0
    v_mov_b64 v[18:19], 0
    v_mov_b64 v[20:21], 0
    v_mov_b64 v[22:23], 0
    s_nop 2
    v_mov_b32 v79, v79
    s_nop 2
    v_mov_b32 v79, v79
    s_nop 2
    v_mov_b32 v79, v79
    s_nop 2
    v_mov_b32 v79, v79
    s_nop 2
    v_mov_b32 v79, v79
    s_nop 2
    v_mov_b32 v79, v79
    s_nop 2
    v_mov_b32 v79, v79
    s_nop 2
    v_mov_b32 v79, v79
    s_nop 2
    v_mov_b32 v79, v79
    s_nop 2
    v_mov_b32 v79, v79
    s_nop 2
    v_mov_b32 v79, v79
    s_nop 2
    v_mov_b32 v79, v79
    s_nop 2
    v_mov_b32 v79, v79
    s_nop 2
    v_mov_b32 v79, v79
    s_nop 2
    v_mov_b32 v79, v79
    s_nop 2
    v_mov_b32 v79, v79
    s_nop 2
    v_mov_b32 v79, v79
    s_nop 2
    v_mov_b32 v79, v79
    s_nop 2
    v_mov_b32 v79, v79
    s_nop 2
    v_mov_b32 v79, v79
    s_nop 2
    v_mov_b32 v79, v79
    s_nop 2
    v_mov_b32 v79, v79
    s_nop 2
    v_mov_b32 v79, v79
    s_nop 2
    v_mov_b32 v79, v79
    s_nop 2
    v_mov_b32 v79, v79
    s_branch cs_loop
cs_f1:
    s_cmp_eq_u32 s30, 63
    s_cbranch_scc1 cs_last
    s_cmp_lg_u32 s32, 1
    s_cbranch_scc1 cs_f3
    v_and_b32 v77, 255, v69
    ds_read_b128 v[4:7], v77 offset:15872
    ds_read_b128 v[40:43], v70 offset:0
    ds_read_b128 v[44:47], v70 offset:1024
    ds_read_b128 v[48:51], v70 offset:2048
    ds_read_b128 v[52:55], v70 offset:3072
    ds_read_b128 v[24:27], v70 offset:4096
    ds_read_b128 v[28:31], v70 offset:5120
    ds_read_b128 v[32:35], v70 offset:6144
    ds_read_b128 v[36:39], v70 offset:7168
    s_mov_b32 s31, 65536
    s_add_u32 s24, s24, 524288
    s_add_u32 s26, s26, 524288
    s_add_u32 s28, s28, s27
    v_mov_b32 v60, s69
    v_mov_b32 v56, s69
    v_and_b32 v79, 12, v75
    v_cmp_eq_u32 vcc, 0, v79
    s_nop 1
    v_cndmask_b32 v79, 0, 1, vcc
    s_nop 2
    v_mov_b32 v79, v79
    s_nop 2
    v_mov_b32 v79, v79
    s_nop 2
    v_mov_b32 v79, v79
    s_nop 2
    v_mov_b32 v79, v79
    s_nop 2
    v_mov_b32 v79, v79
    s_nop 2
    v_mov_b32 v79, v79
    s_nop 2
    v_mov_b32 v79, v79
    s_nop 2
    v_mov_b32 v79, v79
    s_nop 2
    v_mov_b32 v79, v79
    s_nop 2
    v_mov_b32 v79, v79
    s_nop 2
    v_mov_b32 v79, v79
    s_nop 2
    v_mov_b32 v79, v79
    s_nop 2
    v_mov_b32 v79, v79
    s_nop 2
    v_mov_b32 v79, v79
    s_nop 2
    v_mov_b32 v79, v79
    s_nop 2
    v_mov_b32 v79, v79
    s_nop 2
    v_mov_b32 v79, v79
    s_nop 2
    v_mov_b32 v79, v79
    s_nop 2
    v_mov_b32 v79, v79
    s_nop 2
    v_mov_b32 v79, v79
    s_nop 2
    v_mov_b32 v79, v79
    s_nop 2
    v_mov_b32 v79, v79
    s_nop 2
    v_mov_b32 v79, v79
    s_nop 2
    v_mov_b32 v79, v79
    s_nop 2
    v_mov_b32 v79, v79
    s_nop 2
    v_mov_b32 v79, v79
    s_nop 2
    v_mov_b32 v79, v79
    s_nop 2
    v_mov_b32 v79, v79
    s_nop 2
    v_mov_b32 v79, v79
    s_nop 2
    v_mov_b32 v79, v79
    s_nop 2
    v_mov_b32 v79, v79
    s_nop 2
    v_mov_b32 v79, v79
    s_nop 2
    v_mov_b32 v79, v79
    s_nop 2
    v_mov_b32 v79, v79
    s_nop 2
    v_mov_b32 v79, v79
    s_nop 2
    v_mov_b32 v79, v79
    s_nop 2
    v_mov_b32 v79, v79
    s_nop 0
    v_mov_b32 v79, v79
    s_waitcnt vmcnt(0)
    buffer_load_dwordx4 v[8:11], v65, s[4:7], s18 offen sc1
    buffer_load_dwordx4 v[12:15], v65, s[4:7], s19 offen sc1
    buffer_load_dwordx4 v[16:19], v65, s[4:7], s20 offen sc1
    buffer_load_dwordx4 v[20:23], v65, s[4:7], s21 offen sc1
    s_nop 2
    v_mov_b32 v79, v79
    s_nop 2
    v_mov_b32 v79, v79
    s_nop 2
    v_mov_b32 v79, v79
    s_nop 2
    v_mov_b32 v79, v79
    s_nop 2
    v_mov_b32 v79, v79
    s_nop 2
    v_mov_b32 v79, v79
    s_nop 2
    v_mov_b32 v79, v79
    s_nop 2
    v_mov_b32 v79, v79
    s_nop 2
    v_mov_b32 v79, v79
    s_nop 2
    v_mov_b32 v79, v79
    s_nop 2
    v_mov_b32 v79, v79
    s_nop 2
    v_mov_b32 v79, v79
    buffer_load_dwordx4 v[60:63], v65, s[4:7], s14 offen offset:0 sc1
    buffer_load_dwordx4 v[56:59], v66, s[4:7], s14 offen offset:0 sc1
    s_waitcnt lgkmcnt(0)
    s_waitcnt vmcnt(5)
    v_xor_b32 v77, s69, v8
    v_mfma_f32_16x16x32_bf16 v[0:3], v[4:7], v[8:11], 0
    s_waitcnt vmcnt(4)
    v_bitop3_b32 v77, v77, v12, s69 bitop3:0xf6
    v_mfma_f32_16x16x32_bf16 v[0:3], v[4:7], v[12:15], v[0:3]
    s_waitcnt vmcnt(3)
    v_bitop3_b32 v77, v77, v16, s69 bitop3:0xf6
    v_mfma_f32_16x16x32_bf16 v[0:3], v[4:7], v[16:19], v[0:3]
    s_waitcnt vmcnt(2)
    v_bitop3_b32 v77, v77, v20, s69 bitop3:0xf6
    v_mfma_f32_16x16x32_bf16 v[0:3], v[4:7], v[20:23], v[0:3]
    v_and_b32 v77, 1, v77
    v_cmp_ne_u32 vcc, 0, v77
    buffer_load_dwordx4 v[60:63], v65, s[4:7], s14 offen offset:0 sc1
    buffer_load_dwordx4 v[56:59], v66, s[4:7], s14 offen offset:0 sc1
    s_cmp_eq_u64 vcc, 0
    s_cselect_b64 s[42:43], -1, 0
    s_nop 1
    v_add_f32_dpp v0, v0, v0 row_ror:8 row_mask:0xf bank_mask:0xf
    v_add_f32_dpp v1, v1, v1 row_ror:8 row_mask:0xf bank_mask:0xf
    s_mov_b64 exec, s[42:43]
    v_cvt_pk_bf16_f32 v72, v0, v1
    v_bfi_b32 v72, v79, s70, v72
    buffer_store_dword v72, v75, s[4:7], s17 offen offset:0 sc1
    s_mov_b64 exec, -1
    s_cbranch_scc0 cs_f1_retry
cs_f1_go:
    v_mov_b64 v[0:1], 0
    v_mov_b64 v[2:3], 0
    v_mov_b64 v[4:5], 0
    v_mov_b64 v[6:7], 0
    v_mov_b64 v[8:9], 0
    v_mov_b64 v[10:11], 0
    v_mov_b64 v[12:13], 0
    v_mov_b64 v[14:15], 0
    v_mov_b64 v[16:17], 0
    v_mov_b64 v[18:19], 0
    v_mov_b64 v[20:21], 0
    v_mov_b64 v[22:23], 0
    s_nop 2
    v_mov_b32 v79, v79
    s_nop 2
    v_mov_b32 v79, v79
    s_nop 2
    v_mov_b32 v79, v79
    s_nop 2
    v_mov_b32 v79, v79
    s_nop 2
    v_mov_b32 v79, v79
    s_nop 2
    v_mov_b32 v79, v79
    s_nop 2
    v_mov_b32 v79, v79
    s_nop 2
    v_mov_b32 v79, v79
    s_nop 2
    v_mov_b32 v79, v79
    s_nop 2
    v_mov_b32 v79, v79
    s_nop 2
    v_mov_b32 v79, v79
    s_nop 2
    v_mov_b32 v79, v79
    s_nop 2
    v_mov_b32 v79, v79
    s_nop 2
    v_mov_b32 v79, v79
    s_nop 2
    v_mov_b32 v79, v79
    s_nop 2
    v_mov_b32 v79, v79
    s_nop 2
    v_mov_b32 v79, v79
    s_nop 2
    v_mov_b32 v79, v79
    s_nop 2
    v_mov_b32 v79, v79
    s_nop 2
    v_mov_b32 v79, v79
    s_nop 2
    v_mov_b32 v79, v79
    s_nop 2
    v_mov_b32 v79, v79
    s_nop 2
    v_mov_b32 v79, v79
    s_nop 2
    v_mov_b32 v79, v79
    s_nop 2
    v_mov_b32 v79, v79
    s_branch cs_loop
cs_f3:
    v_and_b32 v77, 255, v69
    ds_read_b128 v[4:7], v77 offset:15872
    ds_read_b128 v[40:43], v70 offset:0
    ds_read_b128 v[44:47], v70 offset:1024
    ds_read_b128 v[48:51], v70 offset:2048
    ds_read_b128 v[52:55], v70 offset:3072
    ds_read_b128 v[24:27], v70 offset:4096
    ds_read_b128 v[28:31], v70 offset:5120
    ds_read_b128 v[32:35], v70 offset:6144
    ds_read_b128 v[36:39], v70 offset:7168
    s_mov_b32 s31, 65536
    s_add_u32 s24, s24, 524288
    s_add_u32 s26, s26, 524288
    s_add_u32 s28, s28, s27
    v_mov_b32 v60, s69
    v_mov_b32 v56, s69
    v_and_b32 v79, 12, v75
    v_cmp_eq_u32 vcc, 0, v79
    s_nop 1
    v_cndmask_b32 v79, 0, 1, vcc
    v_add_u32 v72, 1, v72
    s_waitcnt lgkmcnt(0)
    v_mov_b64 v[0:1], 0
    v_mov_b64 v[2:3], 0
    v_mov_b64 v[4:5], 0
    v_mov_b64 v[6:7], 0
    v_mov_b64 v[8:9], 0
    v_mov_b64 v[10:11], 0
    v_mov_b64 v[12:13], 0
    v_mov_b64 v[14:15], 0
    v_mov_b64 v[16:17], 0
    v_mov_b64 v[18:19], 0
    v_mov_b64 v[20:21], 0
    v_mov_b64 v[22:23], 0
    s_nop 2
    v_mov_b32 v79, v79
    s_nop 2
    v_mov_b32 v79, v79
    s_nop 2
    v_mov_b32 v79, v79
    s_nop 2
    v_mov_b32 v79, v79
    s_nop 2
    v_mov_b32 v79, v79
    s_nop 2
    v_mov_b32 v79, v79
    s_nop 2
    v_mov_b32 v79, v79
    s_nop 2
    v_mov_b32 v79, v79
    s_nop 2
    v_mov_b32 v79, v79
    s_nop 2
    v_mov_b32 v79, v79
    s_nop 2
    v_mov_b32 v79, v79
    s_nop 2
    v_mov_b32 v79, v79
    s_nop 2
    v_mov_b32 v79, v79
    s_nop 2
    v_mov_b32 v79, v79
    s_nop 2
    v_mov_b32 v79, v79
    s_nop 2
    v_mov_b32 v79, v79
    s_nop 2
    v_mov_b32 v79, v79
    s_nop 2
    v_mov_b32 v79, v79
    s_nop 2
    v_mov_b32 v79, v79
    s_nop 2
    v_mov_b32 v79, v79
    s_nop 2
    v_mov_b32 v79, v79
    s_nop 2
    v_mov_b32 v79, v79
    s_nop 2
    v_mov_b32 v79, v79
    s_nop 2
    v_mov_b32 v79, v79
    s_nop 2
    v_mov_b32 v79, v79
    s_nop 2
    v_mov_b32 v79, v79
    s_nop 2
    v_mov_b32 v79, v79
    s_nop 2
    v_mov_b32 v79, v79
    s_nop 2
    v_mov_b32 v79, v79
    s_nop 2
    v_mov_b32 v79, v79
    s_nop 2
    v_mov_b32 v79, v79
    s_nop 2
    v_mov_b32 v79, v79
    s_nop 2
    v_mov_b32 v79, v79
    s_nop 2
    v_mov_b32 v79, v79
    s_nop 2
    v_mov_b32 v79, v79
    s_nop 2
    v_mov_b32 v79, v79
    s_nop 2
    v_mov_b32 v79, v79
    s_nop 2
    v_mov_b32 v79, v79
    s_nop 2
    v_mov_b32 v79, v79
    s_nop 2
    v_mov_b32 v79, v79
    s_nop 2
    v_mov_b32 v79, v79
    s_nop 2
    v_mov_b32 v79, v79
    s_nop 2
    v_mov_b32 v79, v79
    s_nop 2
    v_mov_b32 v79, v79
    s_nop 2
    v_mov_b32 v79, v79
    s_nop 2
    v_mov_b32 v79, v79
    s_nop 2
    v_mov_b32 v79, v79
    s_nop 2
    v_mov_b32 v79, v79
    s_nop 2
    v_mov_b32 v79, v79
    s_nop 2
    v_mov_b32 v79, v79
    s_nop 2
    v_mov_b32 v79, v79
    s_nop 2
    v_mov_b32 v79, v79
    s_nop 2
    v_mov_b32 v79, v79
    s_nop 2
    v_mov_b32 v79, v79
    s_nop 2
    v_mov_b32 v79, v79
    s_nop 2
    v_mov_b32 v79, v79
    s_nop 2
    v_mov_b32 v79, v79
    s_nop 2
    v_mov_b32 v79, v79
    s_nop 2
    v_mov_b32 v79, v79
    s_nop 2
    v_mov_b32 v79, v79
    s_nop 2
    v_mov_b32 v79, v79
    s_nop 2
    v_mov_b32 v79, v79
    s_nop 2
    v_mov_b32 v79, v79
    s_nop 2
    v_mov_b32 v79, v79
    s_nop 2
    v_mov_b32 v79, v79
    s_nop 2
    v_mov_b32 v79, v79
    s_nop 2
    v_mov_b32 v79, v79
    s_nop 2
    v_mov_b32 v79, v79
    s_nop 2
    v_mov_b32 v79, v79
    s_nop 2
    v_mov_b32 v79, v79
    s_nop 2
    v_mov_b32 v79, v79
    s_nop 2
    v_mov_b32 v79, v79
    s_nop 2
    v_mov_b32 v79, v79
    s_nop 2
    v_mov_b32 v79, v79
    s_nop 2
    v_mov_b32 v79, v79
    s_branch cs_loop
cs_f0_retry:
cs_f0_spin:
    s_nop 0
    buffer_load_dwordx4 v[8:11], v65, s[4:7], s18 offen sc1
    buffer_load_dwordx4 v[12:15], v65, s[4:7], s19 offen sc1
    buffer_load_dwordx4 v[16:19], v65, s[4:7], s20 offen sc1
    buffer_load_dwordx4 v[20:23], v65, s[4:7], s21 offen sc1
    s_nop 2
    v_mov_b32 v79, v79
    s_nop 2
    v_mov_b32 v79, v79
    s_nop 2
    v_mov_b32 v79, v79
    s_nop 2
    v_mov_b32 v79, v79
    s_nop 2
    v_mov_b32 v79, v79
    s_nop 2
    v_mov_b32 v79, v79
    buffer_load_dwordx4 v[60:63], v65, s[4:7], s14 offen offset:0 sc1
    buffer_load_dwordx4 v[56:59], v66, s[4:7], s14 offen offset:0 sc1
    s_waitcnt vmcnt(5)
    v_xor_b32 v77, s69, v8
    v_mfma_f32_16x16x32_bf16 v[0:3], v[4:7], v[8:11], 0
    s_waitcnt vmcnt(4)
    v_bitop3_b32 v77, v77, v12, s69 bitop3:0xf6
    v_mfma_f32_16x16x32_bf16 v[0:3], v[4:7], v[12:15], v[0:3]
    s_waitcnt vmcnt(3)
    v_bitop3_b32 v77, v77, v16, s69 bitop3:0xf6
    v_mfma_f32_16x16x32_bf16 v[0:3], v[4:7], v[16:19], v[0:3]
    s_waitcnt vmcnt(2)
    v_bitop3_b32 v77, v77, v20, s69 bitop3:0xf6
    v_mfma_f32_16x16x32_bf16 v[0:3], v[4:7], v[20:23], v[0:3]
    v_and_b32 v77, 1, v77
    v_cmp_ne_u32 vcc, 0, v77
    buffer_load_dwordx4 v[60:63], v65, s[4:7], s14 offen offset:0 sc1
    buffer_load_dwordx4 v[56:59], v66, s[4:7], s14 offen offset:0 sc1
    s_cmp_eq_u64 vcc, 0
    s_cselect_b64 s[42:43], -1, 0
    s_nop 1
    v_add_f32_dpp v0, v0, v0 row_ror:8 row_mask:0xf bank_mask:0xf
    v_add_f32_dpp v1, v1, v1 row_ror:8 row_mask:0xf bank_mask:0xf
    s_mov_b64 exec, s[42:43]
    v_cvt_pk_bf16_f32 v72, v0, v1
    v_bfi_b32 v72, v79, s70, v72
    buffer_store_dword v72, v75, s[4:7], s17 offen offset:0 sc1
    s_mov_b64 exec, -1
    s_cbranch_scc1 cs_f0_rx
    s_sub_u32 s31, s31, 1
    s_cbranch_scc0 cs_f0_spin
cs_f0_rx:
    v_mov_b64 v[0:1], 0
    v_mov_b64 v[2:3], 0
    v_mov_b64 v[4:5], 0
    v_mov_b64 v[6:7], 0
    v_mov_b64 v[8:9], 0
    v_mov_b64 v[10:11], 0
    v_mov_b64 v[12:13], 0
    v_mov_b64 v[14:15], 0
    v_mov_b64 v[16:17], 0
    v_mov_b64 v[18:19], 0
    v_mov_b64 v[20:21], 0
    v_mov_b64 v[22:23], 0
    s_branch cs_loop
cs_f1_retry:
cs_f1_spin:
    s_nop 0
    buffer_load_dwordx4 v[8:11], v65, s[4:7], s18 offen sc1
    buffer_load_dwordx4 v[12:15], v65, s[4:7], s19 offen sc1
    buffer_load_dwordx4 v[16:19], v65, s[4:7], s20 offen sc1
    buffer_load_dwordx4 v[20:23], v65, s[4:7], s21 offen sc1
    s_nop 2
    v_mov_b32 v79, v79
    s_nop 2
    v_mov_b32 v79, v79
    s_nop 2
    v_mov_b32 v79, v79
    s_nop 2
    v_mov_b32 v79, v79
    s_nop 2
    v_mov_b32 v79, v79
    s_nop 2
    v_mov_b32 v79, v79
    buffer_load_dwordx4 v[60:63], v65, s[4:7], s14 offen offset:0 sc1
    buffer_load_dwordx4 v[56:59], v66, s[4:7], s14 offen offset:0 sc1
    s_waitcnt vmcnt(5)
    v_xor_b32 v77, s69, v8
    v_mfma_f32_16x16x32_bf16 v[0:3], v[4:7], v[8:11], 0
    s_waitcnt vmcnt(4)
    v_bitop3_b32 v77, v77, v12, s69 bitop3:0xf6
    v_mfma_f32_16x16x32_bf16 v[0:3], v[4:7], v[12:15], v[0:3]
    s_waitcnt vmcnt(3)
    v_bitop3_b32 v77, v77, v16, s69 bitop3:0xf6
    v_mfma_f32_16x16x32_bf16 v[0:3], v[4:7], v[16:19], v[0:3]
    s_waitcnt vmcnt(2)
    v_bitop3_b32 v77, v77, v20, s69 bitop3:0xf6
    v_mfma_f32_16x16x32_bf16 v[0:3], v[4:7], v[20:23], v[0:3]
    v_and_b32 v77, 1, v77
    v_cmp_ne_u32 vcc, 0, v77
    buffer_load_dwordx4 v[60:63], v65, s[4:7], s14 offen offset:0 sc1
    buffer_load_dwordx4 v[56:59], v66, s[4:7], s14 offen offset:0 sc1
    s_cmp_eq_u64 vcc, 0
    s_cselect_b64 s[42:43], -1, 0
    s_nop 1
    v_add_f32_dpp v0, v0, v0 row_ror:8 row_mask:0xf bank_mask:0xf
    v_add_f32_dpp v1, v1, v1 row_ror:8 row_mask:0xf bank_mask:0xf
    s_mov_b64 exec, s[42:43]
    v_cvt_pk_bf16_f32 v72, v0, v1
    v_bfi_b32 v72, v79, s70, v72
    buffer_store_dword v72, v75, s[4:7], s17 offen offset:0 sc1
    s_mov_b64 exec, -1
    s_cbranch_scc1 cs_f1_rx
    s_sub_u32 s31, s31, 1
    s_cbranch_scc0 cs_f1_spin
cs_f1_rx:
    v_mov_b64 v[0:1], 0
    v_mov_b64 v[2:3], 0
    v_mov_b64 v[4:5], 0
    v_mov_b64 v[6:7], 0
    v_mov_b64 v[8:9], 0
    v_mov_b64 v[10:11], 0
    v_mov_b64 v[12:13], 0
    v_mov_b64 v[14:15], 0
    v_mov_b64 v[16:17], 0
    v_mov_b64 v[18:19], 0
    v_mov_b64 v[20:21], 0
    v_mov_b64 v[22:23], 0
    s_branch cs_loop
cs_f2_retry:
cs_f2_spin:
    s_nop 0
    buffer_load_dwordx4 v[8:11], v65, s[4:7], s18 offen sc1
    buffer_load_dwordx4 v[12:15], v65, s[4:7], s19 offen sc1
    buffer_load_dwordx4 v[16:19], v65, s[4:7], s20 offen sc1
    buffer_load_dwordx4 v[20:23], v65, s[4:7], s21 offen sc1
    s_nop 2
    v_mov_b32 v79, v79
    s_nop 2
    v_mov_b32 v79, v79
    s_nop 2
    v_mov_b32 v79, v79
    s_nop 2
    v_mov_b32 v79, v79
    s_nop 2
    v_mov_b32 v79, v79
    s_nop 2
    v_mov_b32 v79, v79
    buffer_load_dwordx4 v[60:63], v65, s[4:7], s14 offen offset:0 sc1
    buffer_load_dwordx4 v[56:59], v66, s[4:7], s14 offen offset:0 sc1
    s_waitcnt vmcnt(5)
    v_xor_b32 v77, s69, v8
    v_bitop3_b32 v77, v77, v10, s69 bitop3:0xf6
    v_mfma_f32_16x16x32_bf16 v[0:3], v[4:7], v[8:11], 0
    s_waitcnt vmcnt(4)
    v_bitop3_b32 v77, v77, v12, s69 bitop3:0xf6
    v_bitop3_b32 v77, v77, v14, s69 bitop3:0xf6
    v_mfma_f32_16x16x32_bf16 v[0:3], v[4:7], v[12:15], v[0:3]
    s_waitcnt vmcnt(3)
    v_bitop3_b32 v77, v77, v16, s69 bitop3:0xf6
    v_bitop3_b32 v77, v77, v18, s69 bitop3:0xf6
    v_mfma_f32_16x16x32_bf16 v[0:3], v[4:7], v[16:19], v[0:3]
    s_waitcnt vmcnt(2)
    v_bitop3_b32 v77, v77, v20, s69 bitop3:0xf6
    v_bitop3_b32 v77, v77, v22, s69 bitop3:0xf6
    v_mfma_f32_16x16x32_bf16 v[0:3], v[4:7], v[20:23], v[0:3]
    v_and_b32 v77, 1, v77
    v_cmp_ne_u32 vcc, 0, v77
    buffer_load_dwordx4 v[60:63], v65, s[4:7], s14 offen offset:0 sc1
    buffer_load_dwordx4 v[56:59], v66, s[4:7], s14 offen offset:0 sc1
    s_cmp_eq_u64 vcc, 0
    s_cselect_b64 s[42:43], -1, 0
    s_nop 1
    v_add_f32 v2, v0, v1
    s_nop 1
    v_add_f32_dpp v2, v2, v2 row_ror:8 row_mask:0xf bank_mask:0xf
    s_nop 1
    v_mov_b32_dpp v0, v2 quad_perm:[0,0,2,2] row_mask:0xf bank_mask:0xf
    v_mov_b32_dpp v1, v2 quad_perm:[1,1,3,3] row_mask:0xf bank_mask:0xf
    s_mov_b64 exec, s[42:43]
    v_cvt_pk_bf16_f32 v72, v0, v1
    v_bfi_b32 v72, v79, s70, v72
    buffer_store_dword v72, v75, s[4:7], s17 offen offset:0 sc1
    buffer_store_dword v72, v75, s[4:7], s17 offen offset:1024 sc1
    buffer_store_dword v72, v75, s[4:7], s17 offen offset:2048 sc1
    buffer_store_dword v72, v75, s[4:7], s17 offen offset:3072 sc1
    s_mov_b64 exec, -1
    s_cbranch_scc1 cs_f2_rx
    s_sub_u32 s31, s31, 1
    s_cbranch_scc0 cs_f2_spin
cs_f2_rx:
    v_mov_b64 v[0:1], 0
    v_mov_b64 v[2:3], 0
    v_mov_b64 v[4:5], 0
    v_mov_b64 v[6:7], 0
    v_mov_b64 v[8:9], 0
    v_mov_b64 v[10:11], 0
    v_mov_b64 v[12:13], 0
    v_mov_b64 v[14:15], 0
    v_mov_b64 v[16:17], 0
    v_mov_b64 v[18:19], 0
    v_mov_b64 v[20:21], 0
    v_mov_b64 v[22:23], 0
    s_branch cs_loop
cs_l1_retry:
cs_l1_spin:
    s_nop 0
    buffer_load_dwordx4 v[8:11], v65, s[4:7], s18 offen sc1
    buffer_load_dwordx4 v[12:15], v65, s[4:7], s19 offen sc1
    buffer_load_dwordx4 v[16:19], v65, s[4:7], s20 offen sc1
    buffer_load_dwordx4 v[20:23], v65, s[4:7], s21 offen sc1
    s_waitcnt vmcnt(3)
    v_xor_b32 v77, s69, v8
    v_mfma_f32_16x16x32_bf16 v[0:3], v[4:7], v[8:11], 0
    s_waitcnt vmcnt(2)
    v_bitop3_b32 v77, v77, v12, s69 bitop3:0xf6
    v_mfma_f32_16x16x32_bf16 v[0:3], v[4:7], v[12:15], v[0:3]
    s_waitcnt vmcnt(1)
    v_bitop3_b32 v77, v77, v16, s69 bitop3:0xf6
    v_mfma_f32_16x16x32_bf16 v[0:3], v[4:7], v[16:19], v[0:3]
    s_waitcnt vmcnt(0)
    v_bitop3_b32 v77, v77, v20, s69 bitop3:0xf6
    v_mfma_f32_16x16x32_bf16 v[0:3], v[4:7], v[20:23], v[0:3]
    v_and_b32 v77, 1, v77
    v_cmp_ne_u32 vcc, 0, v77
    s_nop 0
    s_cmp_eq_u64 vcc, 0
    s_cselect_b64 s[42:43], -1, 0
    s_nop 2
    v_add_f32_dpp v0, v0, v0 row_ror:8 row_mask:0xf bank_mask:0xf
    v_add_f32_dpp v1, v1, v1 row_ror:8 row_mask:0xf bank_mask:0xf
    s_mov_b64 exec, s[42:43]
    v_cvt_pk_bf16_f32 v72, v0, v1
    buffer_store_dword v72, v75, s[4:7], s55 offen sc1
    s_mov_b64 exec, -1
    s_cbranch_scc1 cs_l1_rx
    s_sub_u32 s31, s31, 1
    s_cbranch_scc0 cs_l1_spin
cs_l1_rx:
    s_branch cs_l1_go
cs_l2_retry:
cs_l2_spin:
    buffer_load_dwordx4 v[8:11], v65, s[4:7], s18 offen sc1
    buffer_load_dwordx4 v[12:15], v65, s[4:7], s19 offen sc1
    buffer_load_dwordx4 v[16:19], v65, s[4:7], s20 offen sc1
    buffer_load_dwordx4 v[20:23], v65, s[4:7], s21 offen sc1
    s_waitcnt vmcnt(3)
    v_xor_b32 v77, s69, v8
    v_bitop3_b32 v77, v77, v10, s69 bitop3:0xf6
    v_mfma_f32_16x16x32_bf16 v[0:3], v[4:7], v[8:11], 0
    s_waitcnt vmcnt(2)
    v_bitop3_b32 v77, v77, v12, s69 bitop3:0xf6
    v_bitop3_b32 v77, v77, v14, s69 bitop3:0xf6
    v_mfma_f32_16x16x32_bf16 v[0:3], v[4:7], v[12:15], v[0:3]
    s_waitcnt vmcnt(1)
    v_bitop3_b32 v77, v77, v16, s69 bitop3:0xf6
    v_bitop3_b32 v77, v77, v18, s69 bitop3:0xf6
    v_mfma_f32_16x16x32_bf16 v[0:3], v[4:7], v[16:19], v[0:3]
    s_waitcnt vmcnt(0)
    v_bitop3_b32 v77, v77, v20, s69 bitop3:0xf6
    v_bitop3_b32 v77, v77, v22, s69 bitop3:0xf6
    v_mfma_f32_16x16x32_bf16 v[0:3], v[4:7], v[20:23], v[0:3]
    v_and_b32 v77, 1, v77
    v_cmp_ne_u32 vcc, 0, v77
    s_nop 0
    s_cmp_eq_u64 vcc, 0
    s_cselect_b64 s[42:43], -1, 0
    s_nop 2
    v_add_f32 v2, v0, v1
    s_nop 1
    v_add_f32_dpp v2, v2, v2 row_ror:8 row_mask:0xf bank_mask:0xf
    s_nop 1
    v_mov_b32_dpp v0, v2 quad_perm:[0,0,2,2] row_mask:0xf bank_mask:0xf
    v_mov_b32_dpp v1, v2 quad_perm:[1,1,3,3] row_mask:0xf bank_mask:0xf
    s_mov_b64 exec, s[42:43]
    v_cvt_pk_bf16_f32 v72, v0, v1
    buffer_store_dword v72, v75, s[4:7], s55 offen sc1
    s_mov_b64 exec, -1
    s_cbranch_scc1 cs_l2_rx
    s_sub_u32 s31, s31, 1
    s_cbranch_scc0 cs_l2_spin
cs_l2_rx:
    s_branch cs_l2_go
cs_spinB:
    buffer_load_dwordx4 v[40:43], v65, s[4:7], s15 offen sc1
cs_spinB_l:
    v_and_b32 v77, 1, v40
    v_cmp_ne_u32 vcc, s70, v77
    s_cbranch_vccz cs_spinB_x
    s_nop 15
    s_nop 15
    s_nop 15
    s_nop 11
    v_and_b32 v77, 1, v40
    v_cmp_ne_u32 vcc, s70, v77
    s_cbranch_vccz cs_spinB_x
    s_nop 15
    s_nop 15
    s_nop 15
    s_nop 11
    v_and_b32 v77, 1, v40
    v_cmp_ne_u32 vcc, s70, v77
    s_cbranch_vccz cs_spinB_x
    s_nop 15
    s_nop 15
    s_nop 15
    s_nop 11
    buffer_load_dwordx4 v[40:43], v65, s[4:7], s15 offen sc1
    s_sub_u32 s31, s31, 16
    s_cbranch_scc0 cs_spinB_l
cs_spinB_x:
    ds_write_b128 v65, v[40:43] offset:4096
    s_waitcnt lgkmcnt(0)
    s_branch cs_backB
cs_spin8:
    buffer_load_dwordx4 v[60:63], v65, s[4:7], s16 offen sc1
cs_spin8_l:
    v_and_b32 v77, 1, v60
    v_cmp_ne_u32 vcc, s70, v77
    s_cbranch_vccz cs_spin8_x
    s_nop 15
    s_nop 15
    s_nop 15
    s_nop 11
    v_and_b32 v77, 1, v60
    v_cmp_ne_u32 vcc, s70, v77
    s_cbranch_vccz cs_spin8_x
    s_nop 15
    s_nop 15
    s_nop 15
    s_nop 11
    v_and_b32 v77, 1, v60
    v_cmp_ne_u32 vcc, s70, v77
    s_cbranch_vccz cs_spin8_x
    s_nop 15
    s_nop 15
    s_nop 15
    s_nop 11
    buffer_load_dwordx4 v[60:63], v65, s[4:7], s16 offen sc1
    s_sub_u32 s31, s31, 16
    s_cbranch_scc0 cs_spin8_l
cs_spin8_x:
    s_branch cs_back8
cs_kvasync:
    v_bfe_u32 v78, v65, 2, 8
    s_mov_b64 exec, 0xffff
    buffer_load_dword v78, s[4:7], s96 offen sc1 lds
    s_mov_b64 exec, -1
    s_branch cs_kvasync_x
cs_kvwait:
    s_sub_u32 s41, s40, 1
    s_lshr_b32 s41, s41, 4
    s_lshl_b32 s41, s41, 2
    s_add_u32 s41, s41, 16128
    v_mov_b32 v79, s41
    ds_read_b32 v77, v79 offset:16
    ds_read_b32 v78, v79 offset:32
    s_waitcnt lgkmcnt(0)
    v_subrev_u32 v77, s95, v77
    v_subrev_u32 v78, s95, v78
    v_cmp_lt_u32 vcc, 64, v77
    s_nop 1
    v_cndmask_b32 v77, v77, 0, vcc
    v_cmp_lt_u32 vcc, 64, v78
    s_nop 1
    v_cndmask_b32 v78, v78, 0, vcc
    v_min_u32 v77, v77, v78
    s_nop 0
    v_readfirstlane_b32 s97, v77
    s_nop 0
    s_cmp_le_u32 s40, s97
    s_cbranch_scc1 cs_kvw_x
    s_sub_u32 s41, s40, 1
    s_lshr_b32 s41, s41, 4
    s_lshl_b32 s41, s41, 2
    s_add_u32 s41, s41, s96
    s_mov_b32 s31, 4194304
cs_kvw:
    buffer_load_dword v77, off, s[4:7], s41 offset:16 sc1
    buffer_load_dword v78, off, s[4:7], s41 offset:32 sc1
    s_waitcnt vmcnt(0)
    v_subrev_u32 v77, s95, v77
    v_subrev_u32 v78, s95, v78
    v_cmp_lt_u32 vcc, 64, v77
    s_nop 1
    v_cndmask_b32 v77, v77, 0, vcc
    v_cmp_lt_u32 vcc, 64, v78
    s_nop 1
    v_cndmask_b32 v78, v78, 0, vcc
    v_min_u32 v77, v77, v78
    s_nop 0
    v_readfirstlane_b32 s97, v77
    s_sub_u32 s31, s31, 1
    s_cbranch_scc1 cs_kvw_x
    s_cmp_le_u32 s40, s97
    s_cbranch_scc1 cs_kvw_x
    s_sleep 4
    s_branch cs_kvw
cs_kvw_x:
    s_branch cs_kvok
cs_last:
    s_cmp_lg_u32 s32, 1
    s_cbranch_scc1 cs_last2
    s_nop 2
    v_mov_b32 v79, v79
    s_nop 2
    v_mov_b32 v79, v79
    s_nop 2
    v_mov_b32 v79, v79
    s_nop 2
    v_mov_b32 v79, v79
    s_nop 2
    v_mov_b32 v79, v79
    s_nop 2
    v_mov_b32 v79, v79
    s_nop 2
    v_mov_b32 v79, v79
    s_nop 2
    v_mov_b32 v79, v79
    s_nop 2
    v_mov_b32 v79, v79
    s_nop 2
    v_mov_b32 v79, v79
    s_nop 2
    v_mov_b32 v79, v79
    s_nop 2
    v_mov_b32 v79, v79
    s_nop 2
    v_mov_b32 v79, v79
    s_nop 2
    v_mov_b32 v79, v79
    s_nop 2
    v_mov_b32 v79, v79
    s_nop 2
    v_mov_b32 v79, v79
    s_nop 2
    v_mov_b32 v79, v79
    s_nop 2
    v_mov_b32 v79, v79
    s_nop 2
    v_mov_b32 v79, v79
    s_nop 2
    v_mov_b32 v79, v79
    s_nop 2
    v_mov_b32 v79, v79
    s_nop 2
    v_mov_b32 v79, v79
    s_nop 2
    v_mov_b32 v79, v79
    s_nop 2
    v_mov_b32 v79, v79
    s_nop 2
    v_mov_b32 v79, v79
    s_nop 2
    v_mov_b32 v79, v79
    s_nop 2
    v_mov_b32 v79, v79
    s_nop 2
    v_mov_b32 v79, v79
    s_nop 2
    v_mov_b32 v79, v79
    s_nop 2
    v_mov_b32 v79, v79
    s_nop 2
    v_mov_b32 v79, v79
    s_nop 2
    v_mov_b32 v79, v79
    s_nop 2
    v_mov_b32 v79, v79
    s_nop 2
    v_mov_b32 v79, v79
    s_nop 2
    v_mov_b32 v79, v79
    s_nop 2
    v_mov_b32 v79, v79
    s_nop 2
    v_mov_b32 v79, v79
    s_nop 0
    v_mov_b32 v79, v79
    buffer_load_dwordx4 v[8:11], v65, s[4:7], s18 offen sc1
    buffer_load_dwordx4 v[12:15], v65, s[4:7], s19 offen sc1
    buffer_load_dwordx4 v[16:19], v65, s[4:7], s20 offen sc1
    buffer_load_dwordx4 v[20:23], v65, s[4:7], s21 offen sc1
    v_and_b32 v77, 255, v69
    ds_read_b128 v[4:7], v77 offset:15872
    ds_read_b128 v[40:43], v70 offset:0
    ds_read_b128 v[44:47], v70 offset:1024
    ds_read_b128 v[48:51], v70 offset:2048
    ds_read_b128 v[52:55], v70 offset:3072
    ds_read_b128 v[24:27], v70 offset:4096
    ds_read_b128 v[28:31], v70 offset:5120
    ds_read_b128 v[32:35], v70 offset:6144
    ds_read_b128 v[36:39], v70 offset:7168
    s_mov_b32 s31, 65536
    s_add_u32 s24, s24, 524288
    s_add_u32 s26, s26, 524288
    s_add_u32 s28, s28, s27
    v_mov_b32 v60, s69
    v_mov_b32 v56, s69
    v_and_b32 v79, 12, v75
    v_cmp_eq_u32 vcc, 0, v79
    s_nop 1
    v_cndmask_b32 v79, 0, 1, vcc
    s_waitcnt lgkmcnt(0)
    s_waitcnt vmcnt(3)
    v_xor_b32 v77, s69, v8
    v_mfma_f32_16x16x32_bf16 v[0:3], v[4:7], v[8:11], 0
    s_waitcnt vmcnt(2)
    v_bitop3_b32 v77, v77, v12, s69 bitop3:0xf6
    v_mfma_f32_16x16x32_bf16 v[0:3], v[4:7], v[12:15], v[0:3]
    s_waitcnt vmcnt(1)
    v_bitop3_b32 v77, v77, v16, s69 bitop3:0xf6
    v_mfma_f32_16x16x32_bf16 v[0:3], v[4:7], v[16:19], v[0:3]
    s_waitcnt vmcnt(0)
    v_bitop3_b32 v77, v77, v20, s69 bitop3:0xf6
    v_mfma_f32_16x16x32_bf16 v[0:3], v[4:7], v[20:23], v[0:3]
    v_and_b32 v77, 1, v77
    v_cmp_ne_u32 vcc, 0, v77
    s_nop 0
    s_cmp_eq_u64 vcc, 0
    s_cselect_b64 s[42:43], -1, 0
    s_nop 2
    v_add_f32_dpp v0, v0, v0 row_ror:8 row_mask:0xf bank_mask:0xf
    v_add_f32_dpp v1, v1, v1 row_ror:8 row_mask:0xf bank_mask:0xf
    s_mov_b64 exec, s[42:43]
    v_cvt_pk_bf16_f32 v72, v0, v1
    buffer_store_dword v72, v75, s[4:7], s55 offen sc1
    s_mov_b64 exec, -1
    s_cbranch_scc0 cs_l1_retry
cs_l1_go:
    s_branch cs_fin
cs_last2:
    s_cmp_lg_u32 s32, 2
    s_cbranch_scc1 cs_fin
    s_nop 2
    v_mov_b32 v79, v79
    s_nop 2
    v_mov_b32 v79, v79
    s_nop 2
    v_mov_b32 v79, v79
    s_nop 2
    v_mov_b32 v79, v79
    s_nop 2
    v_mov_b32 v79, v79
    s_nop 2
    v_mov_b32 v79, v79
    s_nop 2
    v_mov_b32 v79, v79
    s_nop 2
    v_mov_b32 v79, v79
    s_nop 2
    v_mov_b32 v79, v79
    s_nop 2
    v_mov_b32 v79, v79
    s_nop 2
    v_mov_b32 v79, v79
    s_nop 2
    v_mov_b32 v79, v79
    s_nop 2
    v_mov_b32 v79, v79
    s_nop 2
    v_mov_b32 v79, v79
    s_nop 2
    v_mov_b32 v79, v79
    s_nop 2
    v_mov_b32 v79, v79
    s_nop 2
    v_mov_b32 v79, v79
    s_nop 2
    v_mov_b32 v79, v79
    s_nop 2
    v_mov_b32 v79, v79
    s_nop 2
    v_mov_b32 v79, v79
    s_nop 2
    v_mov_b32 v79, v79
    s_nop 2
    v_mov_b32 v79, v79
    s_nop 2
    v_mov_b32 v79, v79
    s_nop 2
    v_mov_b32 v79, v79
    s_nop 2
    v_mov_b32 v79, v79
    s_nop 2
    v_mov_b32 v79, v79
    s_nop 2
    v_mov_b32 v79, v79
    s_nop 2
    v_mov_b32 v79, v79
    s_nop 2
    v_mov_b32 v79, v79
    s_nop 2
    v_mov_b32 v79, v79
    s_nop 2
    v_mov_b32 v79, v79
    s_nop 2
    v_mov_b32 v79, v79
    s_nop 2
    v_mov_b32 v79, v79
    s_nop 2
    v_mov_b32 v79, v79
    s_nop 2
    v_mov_b32 v79, v79
    s_nop 2
    v_mov_b32 v79, v79
    s_nop 2
    v_mov_b32 v79, v79
    s_nop 0
    v_mov_b32 v79, v79
    buffer_load_dwordx4 v[8:11], v65, s[4:7], s18 offen sc1
    buffer_load_dwordx4 v[12:15], v65, s[4:7], s19 offen sc1
    buffer_load_dwordx4 v[16:19], v65, s[4:7], s20 offen sc1
    buffer_load_dwordx4 v[20:23], v65, s[4:7], s21 offen sc1
    v_and_b32 v77, 255, v69
    ds_read_b128 v[4:7], v77 offset:15872
    ds_read_b128 v[40:43], v70 offset:0
    ds_read_b128 v[44:47], v70 offset:1024
    ds_read_b128 v[48:51], v70 offset:2048
    ds_read_b128 v[52:55], v70 offset:3072
    ds_read_b128 v[24:27], v70 offset:4096
    ds_read_b128 v[28:31], v70 offset:5120
    ds_read_b128 v[32:35], v70 offset:6144
    ds_read_b128 v[36:39], v70 offset:7168
    s_mov_b32 s31, 65536
    s_add_u32 s24, s24, 524288
    s_add_u32 s26, s26, 524288
    s_add_u32 s28, s28, s27
    v_mov_b32 v60, s69
    v_mov_b32 v56, s69
    v_and_b32 v79, 12, v75
    v_cmp_eq_u32 vcc, 0, v79
    s_nop 1
    v_cndmask_b32 v79, 0, 1, vcc
    s_waitcnt lgkmcnt(0)
    s_waitcnt vmcnt(3)
    v_xor_b32 v77, s69, v8
    v_bitop3_b32 v77, v77, v10, s69 bitop3:0xf6
    v_mfma_f32_16x16x32_bf16 v[0:3], v[4:7], v[8:11], 0
    s_waitcnt vmcnt(2)
    v_bitop3_b32 v77, v77, v12, s69 bitop3:0xf6
    v_bitop3_b32 v77, v77, v14, s69 bitop3:0xf6
    v_mfma_f32_16x16x32_bf16 v[0:3], v[4:7], v[12:15], v[0:3]
    s_waitcnt vmcnt(1)
    v_bitop3_b32 v77, v77, v16, s69 bitop3:0xf6
    v_bitop3_b32 v77, v77, v18, s69 bitop3:0xf6
    v_mfma_f32_16x16x32_bf16 v[0:3], v[4:7], v[16:19], v[0:3]
    s_waitcnt vmcnt(0)
    v_bitop3_b32 v77, v77, v20, s69 bitop3:0xf6
    v_bitop3_b32 v77, v77, v22, s69 bitop3:0xf6
    v_mfma_f32_16x16x32_bf16 v[0:3], v[4:7], v[20:23], v[0:3]
    v_and_b32 v77, 1, v77
    v_cmp_ne_u32 vcc, 0, v77
    s_nop 0
    s_cmp_eq_u64 vcc, 0
    s_cselect_b64 s[42:43], -1, 0
    s_nop 2
    v_add_f32 v2, v0, v1
    s_nop 1
    v_add_f32_dpp v2, v2, v2 row_ror:8 row_mask:0xf bank_mask:0xf
    s_nop 1
    v_mov_b32_dpp v0, v2 quad_perm:[0,0,2,2] row_mask:0xf bank_mask:0xf
    v_mov_b32_dpp v1, v2 quad_perm:[1,1,3,3] row_mask:0xf bank_mask:0xf
    s_mov_b64 exec, s[42:43]
    v_cvt_pk_bf16_f32 v72, v0, v1
    buffer_store_dword v72, v75, s[4:7], s55 offen sc1
    s_mov_b64 exec, -1
    s_cbranch_scc0 cs_l2_retry
cs_l2_go:
    s_branch cs_fin
cs_fin:
    s_add_u32 s40, s95, 64
    v_mov_b32 v78, s40
    s_waitcnt vmcnt(0)
    s_barrier
    s_mov_b64 exec, s[100:101]
    buffer_store_dword v78, off, s[4:7], s29 sc1
    s_mov_b64 exec, -1
cs_end:
    s_endpgm
WL_I0:
    buffer_load_dwordx4 v[0:3], v64, s[8:11], s96 offen
    s_add_u32 s96, s96, s97
    buffer_load_dwordx4 v[4:7], v64, s[8:11], s96 offen
    s_add_u32 s96, s96, s97
    buffer_load_dwordx4 v[8:11], v64, s[8:11], s96 offen
    s_add_u32 s96, s96, s97
    buffer_load_dwordx4 v[12:15], v64, s[8:11], s96 offen
    s_add_u32 s96, s96, s98
    buffer_load_dwordx4 v[16:19], v64, s[8:11], s96 offen
    s_add_u32 s96, s96, s97
    buffer_load_dwordx4 v[20:23], v64, s[8:11], s96 offen
    s_add_u32 s96, s96, s97
    buffer_load_dwordx4 v[24:27], v64, s[8:11], s96 offen
    s_add_u32 s96, s96, s97
    buffer_load_dwordx4 v[28:31], v64, s[8:11], s96 offen
    s_setpc_b64 s[46:47]
WL_Q0:
    v_perm_b32 v72, v4, v0, v70
    v_perm_b32 v73, v12, v8, v70
    v_perm_b32 v74, v20, v16, v70
    v_perm_b32 v75, v28, v24, v70
    ds_write_b128 v66, v[72:75]
    v_xor_b32 v66, 16, v66
    v_perm_b32 v76, v5, v1, v70
    v_perm_b32 v77, v13, v9, v70
    v_perm_b32 v78, v21, v17, v70
    v_perm_b32 v79, v29, v25, v70
    ds_write_b128 v66, v[76:79]
    v_xor_b32 v66, 48, v66
    v_perm_b32 v72, v6, v2, v70
    v_perm_b32 v73, v14, v10, v70
    v_perm_b32 v74, v22, v18, v70
    v_perm_b32 v75, v30, v26, v70
    ds_write_b128 v66, v[72:75]
    v_xor_b32 v66, 16, v66
    v_perm_b32 v76, v7, v3, v70
    v_perm_b32 v77, v15, v11, v70
    v_perm_b32 v78, v23, v19, v70
    v_perm_b32 v79, v31, v27, v70
    ds_write_b128 v66, v[76:79]
    v_xor_b32 v66, 48, v66
    s_waitcnt lgkmcnt(0)
    s_setpc_b64 s[46:47]
WL_O0_0:
    v_perm_b32 v72, v4, v0, v68
    v_perm_b32 v73, v5, v1, v68
    v_perm_b32 v74, v12, v8, v68
    v_perm_b32 v75, v13, v9, v68
    ds_write_b128 v66, v[72:75]
    v_xor_b32 v66, 16, v66
    v_perm_b32 v76, v6, v2, v68
    v_perm_b32 v77, v7, v3, v68
    v_perm_b32 v78, v14, v10, v68
    v_perm_b32 v79, v15, v11, v68
    ds_write_b128 v66, v[76:79]
    v_xor_b32 v66, 48, v66
    v_perm_b32 v72, v4, v0, v69
    v_perm_b32 v73, v5, v1, v69
    v_perm_b32 v74, v12, v8, v69
    v_perm_b32 v75, v13, v9, v69
    ds_write_b128 v66, v[72:75]
    v_xor_b32 v66, 16, v66
    v_perm_b32 v76, v6, v2, v69
    v_perm_b32 v77, v7, v3, v69
    v_perm_b32 v78, v14, v10, v69
    v_perm_b32 v79, v15, v11, v69
    ds_write_b128 v66, v[76:79]
    v_xor_b32 v66, 48, v66
    s_waitcnt lgkmcnt(0)
    s_setpc_b64 s[46:47]
WL_O0_1:
    v_perm_b32 v72, v20, v16, v68
    v_perm_b32 v73, v21, v17, v68
    v_perm_b32 v74, v28, v24, v68
    v_perm_b32 v75, v29, v25, v68
    ds_write_b128 v66, v[72:75]
    v_xor_b32 v66, 16, v66
    v_perm_b32 v76, v22, v18, v68
    v_perm_b32 v77, v23, v19, v68
    v_perm_b32 v78, v30, v26, v68
    v_perm_b32 v79, v31, v27, v68
    ds_write_b128 v66, v[76:79]
    v_xor_b32 v66, 48, v66
    v_perm_b32 v72, v20, v16, v69
    v_perm_b32 v73, v21, v17, v69
    v_perm_b32 v74, v28, v24, v69
    v_perm_b32 v75, v29, v25, v69
    ds_write_b128 v66, v[72:75]
    v_xor_b32 v66, 16, v66
    v_perm_b32 v76, v22, v18, v69
    v_perm_b32 v77, v23, v19, v69
    v_perm_b32 v78, v30, v26, v69
    v_perm_b32 v79, v31, v27, v69
    ds_write_b128 v66, v[76:79]
    v_xor_b32 v66, 48, v66
    s_waitcnt lgkmcnt(0)
    s_setpc_b64 s[46:47]
WL_I1:
    buffer_load_dwordx4 v[32:35], v64, s[8:11], s96 offen
    s_add_u32 s96, s96, s97
    buffer_load_dwordx4 v[36:39], v64, s[8:11], s96 offen
    s_add_u32 s96, s96, s97
    buffer_load_dwordx4 v[40:43], v64, s[8:11], s96 offen
    s_add_u32 s96, s96, s97
    buffer_load_dwordx4 v[44:47], v64, s[8:11], s96 offen
    s_add_u32 s96, s96, s98
    buffer_load_dwordx4 v[48:51], v64, s[8:11], s96 offen
    s_add_u32 s96, s96, s97
    buffer_load_dwordx4 v[52:55], v64, s[8:11], s96 offen
    s_add_u32 s96, s96, s97
    buffer_load_dwordx4 v[56:59], v64, s[8:11], s96 offen
    s_add_u32 s96, s96, s97
    buffer_load_dwordx4 v[60:63], v64, s[8:11], s96 offen
    s_setpc_b64 s[46:47]
WL_Q1:
    v_perm_b32 v72, v36, v32, v70
    v_perm_b32 v73, v44, v40, v70
    v_perm_b32 v74, v52, v48, v70
    v_perm_b32 v75, v60, v56, v70
    ds_write_b128 v66, v[72:75]
    v_xor_b32 v66, 16, v66
    v_perm_b32 v76, v37, v33, v70
    v_perm_b32 v77, v45, v41, v70
    v_perm_b32 v78, v53, v49, v70
    v_perm_b32 v79, v61, v57, v70
    ds_write_b128 v66, v[76:79]
    v_xor_b32 v66, 48, v66
    v_perm_b32 v72, v38, v34, v70
    v_perm_b32 v73, v46, v42, v70
    v_perm_b32 v74, v54, v50, v70
    v_perm_b32 v75, v62, v58, v70
    ds_write_b128 v66, v[72:75]
    v_xor_b32 v66, 16, v66
    v_perm_b32 v76, v39, v35, v70
    v_perm_b32 v77, v47, v43, v70
    v_perm_b32 v78, v55, v51, v70
    v_perm_b32 v79, v63, v59, v70
    ds_write_b128 v66, v[76:79]
    v_xor_b32 v66, 48, v66
    s_waitcnt lgkmcnt(0)
    s_setpc_b64 s[46:47]
WL_O1_0:
    v_perm_b32 v72, v36, v32, v68
    v_perm_b32 v73, v37, v33, v68
    v_perm_b32 v74, v44, v40, v68
    v_perm_b32 v75, v45, v41, v68
    ds_write_b128 v66, v[72:75]
    v_xor_b32 v66, 16, v66
    v_perm_b32 v76, v38, v34, v68
    v_perm_b32 v77, v39, v35, v68
    v_perm_b32 v78, v46, v42, v68
    v_perm_b32 v79, v47, v43, v68
    ds_write_b128 v66, v[76:79]
    v_xor_b32 v66, 48, v66
    v_perm_b32 v72, v36, v32, v69
    v_perm_b32 v73, v37, v33, v69
    v_perm_b32 v74, v44, v40, v69
    v_perm_b32 v75, v45, v41, v69
    ds_write_b128 v66, v[72:75]
    v_xor_b32 v66, 16, v66
    v_perm_b32 v76, v38, v34, v69
    v_perm_b32 v77, v39, v35, v69
    v_perm_b32 v78, v46, v42, v69
    v_perm_b32 v79, v47, v43, v69
    ds_write_b128 v66, v[76:79]
    v_xor_b32 v66, 48, v66
    s_waitcnt lgkmcnt(0)
    s_setpc_b64 s[46:47]
WL_O1_1:
    v_perm_b32 v72, v52, v48, v68
    v_perm_b32 v73, v53, v49, v68
    v_perm_b32 v74, v60, v56, v68
    v_perm_b32 v75, v61, v57, v68
    ds_write_b128 v66, v[72:75]
    v_xor_b32 v66, 16, v66
    v_perm_b32 v76, v54, v50, v68
    v_perm_b32 v77, v55, v51, v68
    v_perm_b32 v78, v62, v58, v68
    v_perm_b32 v79, v63, v59, v68
    ds_write_b128 v66, v[76:79]
    v_xor_b32 v66, 48, v66
    v_perm_b32 v72, v52, v48, v69
    v_perm_b32 v73, v53, v49, v69
    v_perm_b32 v74, v60, v56, v69
    v_perm_b32 v75, v61, v57, v69
    ds_write_b128 v66, v[72:75]
    v_xor_b32 v66, 16, v66
    v_perm_b32 v76, v54, v50, v69
    v_perm_b32 v77, v55, v51, v69
    v_perm_b32 v78, v62, v58, v69
    v_perm_b32 v79, v63, v59, v69
    ds_write_b128 v66, v[76:79]
    v_xor_b32 v66, 48, v66
    s_waitcnt lgkmcnt(0)
    s_setpc_b64 s[46:47]
WL_I2:
    buffer_load_dwordx4 v[80:83], v64, s[8:11], s96 offen
    s_add_u32 s96, s96, s97
    buffer_load_dwordx4 v[84:87], v64, s[8:11], s96 offen
    s_add_u32 s96, s96, s97
    buffer_load_dwordx4 v[88:91], v64, s[8:11], s96 offen
    s_add_u32 s96, s96, s97
    buffer_load_dwordx4 v[92:95], v64, s[8:11], s96 offen
    s_add_u32 s96, s96, s98
    buffer_load_dwordx4 v[96:99], v64, s[8:11], s96 offen
    s_add_u32 s96, s96, s97
    buffer_load_dwordx4 v[100:103], v64, s[8:11], s96 offen
    s_add_u32 s96, s96, s97
    buffer_load_dwordx4 v[104:107], v64, s[8:11], s96 offen
    s_add_u32 s96, s96, s97
    buffer_load_dwordx4 v[108:111], v64, s[8:11], s96 offen
    s_setpc_b64 s[46:47]
WL_Q2:
    v_perm_b32 v72, v84, v80, v70
    v_perm_b32 v73, v92, v88, v70
    v_perm_b32 v74, v100, v96, v70
    v_perm_b32 v75, v108, v104, v70
    ds_write_b128 v66, v[72:75]
    v_xor_b32 v66, 16, v66
    v_perm_b32 v76, v85, v81, v70
    v_perm_b32 v77, v93, v89, v70
    v_perm_b32 v78, v101, v97, v70
    v_perm_b32 v79, v109, v105, v70
    ds_write_b128 v66, v[76:79]
    v_xor_b32 v66, 48, v66
    v_perm_b32 v72, v86, v82, v70
    v_perm_b32 v73, v94, v90, v70
    v_perm_b32 v74, v102, v98, v70
    v_perm_b32 v75, v110, v106, v70
    ds_write_b128 v66, v[72:75]
    v_xor_b32 v66, 16, v66
    v_perm_b32 v76, v87, v83, v70
    v_perm_b32 v77, v95, v91, v70
    v_perm_b32 v78, v103, v99, v70
    v_perm_b32 v79, v111, v107, v70
    ds_write_b128 v66, v[76:79]
    v_xor_b32 v66, 48, v66
    s_waitcnt lgkmcnt(0)
    s_setpc_b64 s[46:47]
WL_I3:
    buffer_load_dwordx4 v[112:115], v64, s[8:11], s96 offen
    s_add_u32 s96, s96, s97
    buffer_load_dwordx4 v[116:119], v64, s[8:11], s96 offen
    s_add_u32 s96, s96, s97
    buffer_load_dwordx4 v[120:123], v64, s[8:11], s96 offen
    s_add_u32 s96, s96, s97
    buffer_load_dwordx4 v[124:127], v64, s[8:11], s96 offen
    s_add_u32 s96, s96, s98
    buffer_load_dwordx4 v[128:131], v64, s[8:11], s96 offen
    s_add_u32 s96, s96, s97
    buffer_load_dwordx4 v[132:135], v64, s[8:11], s96 offen
    s_add_u32 s96, s96, s97
    buffer_load_dwordx4 v[136:139], v64, s[8:11], s96 offen
    s_add_u32 s96, s96, s97
    buffer_load_dwordx4 v[140:143], v64, s[8:11], s96 offen
    s_setpc_b64 s[46:47]
WL_Q3:
    v_perm_b32 v72, v116, v112, v70
    v_perm_b32 v73, v124, v120, v70
    v_perm_b32 v74, v132, v128, v70
    v_perm_b32 v75, v140, v136, v70
    ds_write_b128 v66, v[72:75]
    v_xor_b32 v66, 16, v66
    v_perm_b32 v76, v117, v113, v70
    v_perm_b32 v77, v125, v121, v70
    v_perm_b32 v78, v133, v129, v70
    v_perm_b32 v79, v141, v137, v70
    ds_write_b128 v66, v[76:79]
    v_xor_b32 v66, 48, v66
    v_perm_b32 v72, v118, v114, v70
    v_perm_b32 v73, v126, v122, v70
    v_perm_b32 v74, v134, v130, v70
    v_perm_b32 v75, v142, v138, v70
    ds_write_b128 v66, v[72:75]
    v_xor_b32 v66, 16, v66
    v_perm_b32 v76, v119, v115, v70
    v_perm_b32 v77, v127, v123, v70
    v_perm_b32 v78, v135, v131, v70
    v_perm_b32 v79, v143, v139, v70
    ds_write_b128 v66, v[76:79]
    v_xor_b32 v66, 48, v66
    s_waitcnt lgkmcnt(0)
    s_setpc_b64 s[46:47]
L_xform:
    v_and_b32 v1, 63, v0
    v_and_b32 v2, 15, v1
    v_lshrrev_b32 v3, 4, v1
    v_mov_b32 v7, 0x05040100
    v_mov_b32 v8, 0x07060302
    v_lshrrev_b32 v9, 6, v0
    v_lshlrev_b32 v9, 14, v9
    v_lshlrev_b32 v10, 4, v1
    v_add_u32 v11, v9, v10
    s_mov_b32 s10, 4718592
    s_mov_b32 s11, 0x20000
    s_cmp_ge_u32 s16, 864
    s_cbranch_scc1 xf_wo
    s_mul_hi_u32 s17, s16, 0x1c71c71d
    s_mul_i32 s18, s17, 9
    s_sub_u32 s18, s16, s18
    s_lshr_b32 s19, s17, 5
    s_cmp_eq_u32 s19, 1
    s_cselect_b64 s[8:9], s[54:55], s[52:53]
    s_cmp_eq_u32 s19, 2
    s_cselect_b64 s[8:9], s[56:57], s[8:9]
    s_and_b32 s17, s17, 31
    s_lshl_b32 s17, s17, 8
    v_lshlrev_b32 v4, 3, v3
    v_lshrrev_b32 v6, 1, v3
    v_mul_u32_u24 v6, 128, v6
    s_cmp_eq_u32 s18, 8
    s_cselect_b32 s20, 1, 0
    v_mad_u32_u24 v4, v6, s20, v4
    v_lshlrev_b32 v4, 13, v4
    v_lshl_add_u32 v4, v2, 4, v4
    s_and_b32 s19, s18, 3
    s_mul_i32 s19, s19, 144
    s_lshr_b32 s21, s18, 2
    s_lshl_b32 s21, s21, 6
    s_add_u32 s19, s19, s21
    s_cmp_eq_u32 s18, 8
    s_cselect_b32 s19, 128, s19
    s_cselect_b32 s21, 288, 32
    s_lshl_b32 s21, s21, 13
    s_lshl_b32 s19, s19, 13
    s_add_u32 s17, s17, s19
    s_add_u32 s21, s21, s17
    s_add_u32 s19, s17, 0
    buffer_load_dwordx4 v[12:15], v4, s[8:11], s19 offen
    s_add_u32 s19, s17, 8192
    buffer_load_dwordx4 v[16:19], v4, s[8:11], s19 offen
    s_add_u32 s19, s17, 16384
    buffer_load_dwordx4 v[20:23], v4, s[8:11], s19 offen
    s_add_u32 s19, s17, 24576
    buffer_load_dwordx4 v[24:27], v4, s[8:11], s19 offen
    s_add_u32 s19, s17, 32768
    buffer_load_dwordx4 v[28:31], v4, s[8:11], s19 offen
    s_add_u32 s19, s17, 40960
    buffer_load_dwordx4 v[32:35], v4, s[8:11], s19 offen
    s_add_u32 s19, s17, 49152
    buffer_load_dwordx4 v[36:39], v4, s[8:11], s19 offen
    s_add_u32 s19, s17, 57344
    buffer_load_dwordx4 v[40:43], v4, s[8:11], s19 offen
    s_add_u32 s19, s21, 0
    buffer_load_dwordx4 v[44:47], v4, s[8:11], s19 offen
    s_add_u32 s19, s21, 8192
    buffer_load_dwordx4 v[48:51], v4, s[8:11], s19 offen
    s_add_u32 s19, s21, 16384
    buffer_load_dwordx4 v[52:55], v4, s[8:11], s19 offen
    s_add_u32 s19, s21, 24576
    buffer_load_dwordx4 v[56:59], v4, s[8:11], s19 offen
    s_add_u32 s19, s21, 32768
    buffer_load_dwordx4 v[60:63], v4, s[8:11], s19 offen
    s_add_u32 s19, s21, 40960
    buffer_load_dwordx4 v[64:67], v4, s[8:11], s19 offen
    s_add_u32 s19, s21, 49152
    buffer_load_dwordx4 v[68:71], v4, s[8:11], s19 offen
    s_add_u32 s19, s21, 57344
    buffer_load_dwordx4 v[72:75], v4, s[8:11], s19 offen
    v_lshrrev_b32 v6, 2, v2
    v_lshlrev_b32 v5, 10, v6
    v_lshl_add_u32 v5, v3, 8, v5
    v_and_b32 v6, 3, v2
    v_lshl_add_u32 v5, v6, 6, v5
    v_add_u32 v5, v5, v9
    s_lshl_b32 s17, s16, 14
    s_add_u32 s17, s17, 100663296
    s_waitcnt vmcnt(0)
    s_add_u32 s19, s17, 0
    v_perm_b32 v76, v16, v12, v7
    v_perm_b32 v77, v24, v20, v7
    v_perm_b32 v78, v32, v28, v7
    v_perm_b32 v79, v40, v36, v7
    ds_write_b128 v5, v[76:79] offset:0
    v_perm_b32 v80, v17, v13, v7
    v_perm_b32 v81, v25, v21, v7
    v_perm_b32 v82, v33, v29, v7
    v_perm_b32 v83, v41, v37, v7
    ds_write_b128 v5, v[80:83] offset:16
    v_perm_b32 v84, v18, v14, v7
    v_perm_b32 v85, v26, v22, v7
    v_perm_b32 v86, v34, v30, v7
    v_perm_b32 v87, v42, v38, v7
    ds_write_b128 v5, v[84:87] offset:32
    v_perm_b32 v88, v19, v15, v7
    v_perm_b32 v89, v27, v23, v7
    v_perm_b32 v90, v35, v31, v7
    v_perm_b32 v91, v43, v39, v7
    ds_write_b128 v5, v[88:91] offset:48
    s_add_u32 s19, s17, 4096
    v_perm_b32 v92, v48, v44, v7
    v_perm_b32 v93, v56, v52, v7
    v_perm_b32 v94, v64, v60, v7
    v_perm_b32 v95, v72, v68, v7
    ds_write_b128 v5, v[92:95] offset:4096
    v_perm_b32 v96, v49, v45, v7
    v_perm_b32 v97, v57, v53, v7
    v_perm_b32 v98, v65, v61, v7
    v_perm_b32 v99, v73, v69, v7
    ds_write_b128 v5, v[96:99] offset:4112
    v_perm_b32 v100, v50, v46, v7
    v_perm_b32 v101, v58, v54, v7
    v_perm_b32 v102, v66, v62, v7
    v_perm_b32 v103, v74, v70, v7
    ds_write_b128 v5, v[100:103] offset:4128
    v_perm_b32 v104, v51, v47, v7
    v_perm_b32 v105, v59, v55, v7
    v_perm_b32 v106, v67, v63, v7
    v_perm_b32 v107, v75, v71, v7
    ds_write_b128 v5, v[104:107] offset:4144
    s_add_u32 s19, s17, 8192
    v_perm_b32 v108, v16, v12, v8
    v_perm_b32 v109, v24, v20, v8
    v_perm_b32 v110, v32, v28, v8
    v_perm_b32 v111, v40, v36, v8
    ds_write_b128 v5, v[108:111] offset:8192
    v_perm_b32 v112, v17, v13, v8
    v_perm_b32 v113, v25, v21, v8
    v_perm_b32 v114, v33, v29, v8
    v_perm_b32 v115, v41, v37, v8
    ds_write_b128 v5, v[112:115] offset:8208
    v_perm_b32 v116, v18, v14, v8
    v_perm_b32 v117, v26, v22, v8
    v_perm_b32 v118, v34, v30, v8
    v_perm_b32 v119, v42, v38, v8
    ds_write_b128 v5, v[116:119] offset:8224
    v_perm_b32 v120, v19, v15, v8
    v_perm_b32 v121, v27, v23, v8
    v_perm_b32 v122, v35, v31, v8
    v_perm_b32 v123, v43, v39, v8
    ds_write_b128 v5, v[120:123] offset:8240
    s_add_u32 s19, s17, 12288
    v_perm_b32 v124, v48, v44, v8
    v_perm_b32 v125, v56, v52, v8
    v_perm_b32 v126, v64, v60, v8
    v_perm_b32 v127, v72, v68, v8
    ds_write_b128 v5, v[124:127] offset:12288
    v_perm_b32 v128, v49, v45, v8
    v_perm_b32 v129, v57, v53, v8
    v_perm_b32 v130, v65, v61, v8
    v_perm_b32 v131, v73, v69, v8
    ds_write_b128 v5, v[128:131] offset:12304
    v_perm_b32 v132, v50, v46, v8
    v_perm_b32 v133, v58, v54, v8
    v_perm_b32 v134, v66, v62, v8
    v_perm_b32 v135, v74, v70, v8
    ds_write_b128 v5, v[132:135] offset:12320
    v_perm_b32 v136, v51, v47, v8
    v_perm_b32 v137, v59, v55, v8
    v_perm_b32 v138, v67, v63, v8
    v_perm_b32 v139, v75, v71, v8
    ds_write_b128 v5, v[136:139] offset:12336
    s_waitcnt lgkmcnt(0)
    ds_read_b128 v[76:79], v11 offset:0
    ds_read_b128 v[80:83], v11 offset:1024
    ds_read_b128 v[84:87], v11 offset:2048
    ds_read_b128 v[88:91], v11 offset:3072
    ds_read_b128 v[92:95], v11 offset:4096
    ds_read_b128 v[96:99], v11 offset:5120
    ds_read_b128 v[100:103], v11 offset:6144
    ds_read_b128 v[104:107], v11 offset:7168
    ds_read_b128 v[108:111], v11 offset:8192
    ds_read_b128 v[112:115], v11 offset:9216
    ds_read_b128 v[116:119], v11 offset:10240
    ds_read_b128 v[120:123], v11 offset:11264
    ds_read_b128 v[124:127], v11 offset:12288
    ds_read_b128 v[128:131], v11 offset:13312
    ds_read_b128 v[132:135], v11 offset:14336
    ds_read_b128 v[136:139], v11 offset:15360
    s_add_u32 s19, s17, 0
    s_waitcnt lgkmcnt(15)
    buffer_store_dwordx4 v[76:79], v10, s[4:7], s19 offen sc1
    s_add_u32 s19, s17, 1024
    s_waitcnt lgkmcnt(14)
    buffer_store_dwordx4 v[80:83], v10, s[4:7], s19 offen sc1
    s_add_u32 s19, s17, 2048
    s_waitcnt lgkmcnt(13)
    buffer_store_dwordx4 v[84:87], v10, s[4:7], s19 offen sc1
    s_add_u32 s19, s17, 3072
    s_waitcnt lgkmcnt(12)
    buffer_store_dwordx4 v[88:91], v10, s[4:7], s19 offen sc1
    s_add_u32 s19, s17, 4096
    s_waitcnt lgkmcnt(11)
    buffer_store_dwordx4 v[92:95], v10, s[4:7], s19 offen sc1
    s_add_u32 s19, s17, 5120
    s_waitcnt lgkmcnt(10)
    buffer_store_dwordx4 v[96:99], v10, s[4:7], s19 offen sc1
    s_add_u32 s19, s17, 6144
    s_waitcnt lgkmcnt(9)
    buffer_store_dwordx4 v[100:103], v10, s[4:7], s19 offen sc1
    s_add_u32 s19, s17, 7168
    s_waitcnt lgkmcnt(8)
    buffer_store_dwordx4 v[104:107], v10, s[4:7], s19 offen sc1
    s_add_u32 s19, s17, 8192
    s_waitcnt lgkmcnt(7)
    buffer_store_dwordx4 v[108:111], v10, s[4:7], s19 offen sc1
    s_add_u32 s19, s17, 9216
    s_waitcnt lgkmcnt(6)
    buffer_store_dwordx4 v[112:115], v10, s[4:7], s19 offen sc1
    s_add_u32 s19, s17, 10240
    s_waitcnt lgkmcnt(5)
    buffer_store_dwordx4 v[116:119], v10, s[4:7], s19 offen sc1
    s_add_u32 s19, s17, 11264
    s_waitcnt lgkmcnt(4)
    buffer_store_dwordx4 v[120:123], v10, s[4:7], s19 offen sc1
    s_add_u32 s19, s17, 12288
    s_waitcnt lgkmcnt(3)
    buffer_store_dwordx4 v[124:127], v10, s[4:7], s19 offen sc1
    s_add_u32 s19, s17, 13312
    s_waitcnt lgkmcnt(2)
    buffer_store_dwordx4 v[128:131], v10, s[4:7], s19 offen sc1
    s_add_u32 s19, s17, 14336
    s_waitcnt lgkmcnt(1)
    buffer_store_dwordx4 v[132:135], v10, s[4:7], s19 offen sc1
    s_add_u32 s19, s17, 15360
    s_waitcnt lgkmcnt(0)
    buffer_store_dwordx4 v[136:139], v10, s[4:7], s19 offen sc1
    s_branch xf_done
xf_wo:
    s_mov_b64 s[8:9], s[58:59]
    s_cmp_ge_u32 s16, 1376
    s_cbranch_scc1 xf_s
    s_sub_u32 s17, s16, 864
    s_and_b32 s18, s17, 3
    s_bfe_u32 s19, s17, 0x20002
    s_lshr_b32 s17, s17, 4
    v_mul_u32_u24 v4, 4608, v3
    v_lshl_add_u32 v4, v2, 4, v4
    s_lshl_b32 s20, s17, 2
    s_add_u32 s20, s20, s18
    s_mul_i32 s20, s20, 36864
    s_mul_i32 s21, s19, 288
    s_add_u32 s20, s20, s21
    s_add_u32 s21, s20, 0
    buffer_load_dwordx4 v[12:15], v4, s[8:11], s21 offen
    s_add_u32 s21, s20, 1152
    buffer_load_dwordx4 v[16:19], v4, s[8:11], s21 offen
    s_add_u32 s21, s20, 2304
    buffer_load_dwordx4 v[20:23], v4, s[8:11], s21 offen
    s_add_u32 s21, s20, 3456
    buffer_load_dwordx4 v[24:27], v4, s[8:11], s21 offen
    s_add_u32 s21, s20, 18432
    buffer_load_dwordx4 v[28:31], v4, s[8:11], s21 offen
    s_add_u32 s21, s20, 19584
    buffer_load_dwordx4 v[32:35], v4, s[8:11], s21 offen
    s_add_u32 s21, s20, 20736
    buffer_load_dwordx4 v[36:39], v4, s[8:11], s21 offen
    s_add_u32 s21, s20, 21888
    buffer_load_dwordx4 v[40:43], v4, s[8:11], s21 offen
    v_lshrrev_b32 v6, 2, v2
    v_lshlrev_b32 v5, 11, v6
    v_lshl_add_u32 v5, v3, 8, v5
    v_and_b32 v6, 3, v2
    v_lshl_add_u32 v5, v6, 6, v5
    v_add_u32 v5, v5, v9
    s_mul_i32 s20, s17, 18
    s_add_u32 s20, s20, s18
    s_lshl_b32 s20, s20, 13
    s_lshl_b32 s21, s19, 10
    s_add_u32 s20, s20, s21
    s_add_u32 s20, s20, 117440512
    s_add_u32 s21, s20, 4096
    s_waitcnt vmcnt(0)
    v_perm_b32 v76, v16, v12, v7
    v_perm_b32 v77, v17, v13, v7
    v_perm_b32 v78, v24, v20, v7
    v_perm_b32 v79, v25, v21, v7
    ds_write_b128 v5, v[76:79] offset:0
    v_perm_b32 v80, v18, v14, v7
    v_perm_b32 v81, v19, v15, v7
    v_perm_b32 v82, v26, v22, v7
    v_perm_b32 v83, v27, v23, v7
    ds_write_b128 v5, v[80:83] offset:16
    v_perm_b32 v84, v16, v12, v8
    v_perm_b32 v85, v17, v13, v8
    v_perm_b32 v86, v24, v20, v8
    v_perm_b32 v87, v25, v21, v8
    ds_write_b128 v5, v[84:87] offset:32
    v_perm_b32 v88, v18, v14, v8
    v_perm_b32 v89, v19, v15, v8
    v_perm_b32 v90, v26, v22, v8
    v_perm_b32 v91, v27, v23, v8
    ds_write_b128 v5, v[88:91] offset:48
    v_perm_b32 v92, v32, v28, v7
    v_perm_b32 v93, v33, v29, v7
    v_perm_b32 v94, v40, v36, v7
    v_perm_b32 v95, v41, v37, v7
    ds_write_b128 v5, v[92:95] offset:1024
    v_perm_b32 v96, v34, v30, v7
    v_perm_b32 v97, v35, v31, v7
    v_perm_b32 v98, v42, v38, v7
    v_perm_b32 v99, v43, v39, v7
    ds_write_b128 v5, v[96:99] offset:1040
    v_perm_b32 v100, v32, v28, v8
    v_perm_b32 v101, v33, v29, v8
    v_perm_b32 v102, v40, v36, v8
    v_perm_b32 v103, v41, v37, v8
    ds_write_b128 v5, v[100:103] offset:1056
    v_perm_b32 v104, v34, v30, v8
    v_perm_b32 v105, v35, v31, v8
    v_perm_b32 v106, v42, v38, v8
    v_perm_b32 v107, v43, v39, v8
    ds_write_b128 v5, v[104:107] offset:1072
    s_waitcnt lgkmcnt(0)
    ds_read_b128 v[76:79], v11 offset:0
    ds_read_b128 v[80:83], v11 offset:1024
    ds_read_b128 v[84:87], v11 offset:2048
    ds_read_b128 v[88:91], v11 offset:3072
    ds_read_b128 v[92:95], v11 offset:4096
    ds_read_b128 v[96:99], v11 offset:5120
    ds_read_b128 v[100:103], v11 offset:6144
    ds_read_b128 v[104:107], v11 offset:7168
    s_add_u32 s19, s20, 0
    s_waitcnt lgkmcnt(7)
    buffer_store_dwordx4 v[76:79], v10, s[4:7], s19 offen sc1
    s_add_u32 s19, s20, 4096
    s_waitcnt lgkmcnt(6)
    buffer_store_dwordx4 v[80:83], v10, s[4:7], s19 offen sc1
    s_add_u32 s19, s20, 32768
    s_waitcnt lgkmcnt(5)
    buffer_store_dwordx4 v[84:87], v10, s[4:7], s19 offen sc1
    s_add_u32 s19, s20, 36864
    s_waitcnt lgkmcnt(4)
    buffer_store_dwordx4 v[88:91], v10, s[4:7], s19 offen sc1
    s_add_u32 s19, s20, 65536
    s_waitcnt lgkmcnt(3)
    buffer_store_dwordx4 v[92:95], v10, s[4:7], s19 offen sc1
    s_add_u32 s19, s20, 69632
    s_waitcnt lgkmcnt(2)
    buffer_store_dwordx4 v[96:99], v10, s[4:7], s19 offen sc1
    s_add_u32 s19, s20, 98304
    s_waitcnt lgkmcnt(1)
    buffer_store_dwordx4 v[100:103], v10, s[4:7], s19 offen sc1
    s_add_u32 s19, s20, 102400
    s_waitcnt lgkmcnt(0)
    buffer_store_dwordx4 v[104:107], v10, s[4:7], s19 offen sc1
    s_branch xf_done
xf_s:
    s_cmp_ge_u32 s16, 1504
    s_cbranch_scc1 xf_f
    s_sub_u32 s17, s16, 1376
    s_and_b32 s19, s17, 3
    s_lshr_b32 s17, s17, 2
    v_mul_u32_u24 v4, 4608, v3
    v_lshl_add_u32 v4, v2, 1, v4
    s_mul_i32 s20, s17, 147456
    s_mul_i32 s21, s19, 288
    s_add_u32 s20, s20, s21
    s_add_u32 s21, s20, 256
    buffer_load_ushort v12, v4, s[8:11], s21 offen
    s_add_u32 s21, s20, 1408
    buffer_load_ushort v13, v4, s[8:11], s21 offen
    s_add_u32 s21, s20, 37120
    buffer_load_ushort v14, v4, s[8:11], s21 offen
    s_add_u32 s21, s20, 38272
    buffer_load_ushort v15, v4, s[8:11], s21 offen
    s_add_u32 s21, s20, 2560
    buffer_load_ushort v16, v4, s[8:11], s21 offen
    s_add_u32 s21, s20, 3712
    buffer_load_ushort v17, v4, s[8:11], s21 offen
    s_add_u32 s21, s20, 39424
    buffer_load_ushort v18, v4, s[8:11], s21 offen
    s_add_u32 s21, s20, 40576
    buffer_load_ushort v19, v4, s[8:11], s21 offen
    s_add_u32 s21, s20, 18688
    buffer_load_ushort v20, v4, s[8:11], s21 offen
    s_add_u32 s21, s20, 19840
    buffer_load_ushort v21, v4, s[8:11], s21 offen
    s_add_u32 s21, s20, 55552
    buffer_load_ushort v22, v4, s[8:11], s21 offen
    s_add_u32 s21, s20, 56704
    buffer_load_ushort v23, v4, s[8:11], s21 offen
    s_add_u32 s21, s20, 20992
    buffer_load_ushort v24, v4, s[8:11], s21 offen
    s_add_u32 s21, s20, 22144
    buffer_load_ushort v25, v4, s[8:11], s21 offen
    s_add_u32 s21, s20, 57856
    buffer_load_ushort v26, v4, s[8:11], s21 offen
    s_add_u32 s21, s20, 59008
    buffer_load_ushort v27, v4, s[8:11], s21 offen
    s_add_u32 s21, s20, 73984
    buffer_load_ushort v28, v4, s[8:11], s21 offen
    s_add_u32 s21, s20, 75136
    buffer_load_ushort v29, v4, s[8:11], s21 offen
    s_add_u32 s21, s20, 110848
    buffer_load_ushort v30, v4, s[8:11], s21 offen
    s_add_u32 s21, s20, 112000
    buffer_load_ushort v31, v4, s[8:11], s21 offen
    s_add_u32 s21, s20, 76288
    buffer_load_ushort v32, v4, s[8:11], s21 offen
    s_add_u32 s21, s20, 77440
    buffer_load_ushort v33, v4, s[8:11], s21 offen
    s_add_u32 s21, s20, 113152
    buffer_load_ushort v34, v4, s[8:11], s21 offen
    s_add_u32 s21, s20, 114304
    buffer_load_ushort v35, v4, s[8:11], s21 offen
    s_add_u32 s21, s20, 92416
    buffer_load_ushort v36, v4, s[8:11], s21 offen
    s_add_u32 s21, s20, 93568
    buffer_load_ushort v37, v4, s[8:11], s21 offen
    s_add_u32 s21, s20, 129280
    buffer_load_ushort v38, v4, s[8:11], s21 offen
    s_add_u32 s21, s20, 130432
    buffer_load_ushort v39, v4, s[8:11], s21 offen
    s_add_u32 s21, s20, 94720
    buffer_load_ushort v40, v4, s[8:11], s21 offen
    s_add_u32 s21, s20, 95872
    buffer_load_ushort v41, v4, s[8:11], s21 offen
    s_add_u32 s21, s20, 131584
    buffer_load_ushort v42, v4, s[8:11], s21 offen
    s_add_u32 s21, s20, 132736
    buffer_load_ushort v43, v4, s[8:11], s21 offen
    v_lshlrev_b32 v5, 4, v1
    s_mul_i32 s20, s17, 18
    s_add_u32 s20, s20, 16
    s_lshl_b32 s20, s20, 13
    s_lshl_b32 s21, s19, 10
    s_add_u32 s20, s20, s21
    s_add_u32 s20, s20, 117440512
    s_waitcnt vmcnt(0)
    v_lshl_or_b32 v76, v13, 16, v12
    v_lshl_or_b32 v77, v15, 16, v14
    v_lshl_or_b32 v78, v17, 16, v16
    v_lshl_or_b32 v79, v19, 16, v18
    s_add_u32 s21, s20, 0
    buffer_store_dwordx4 v[76:79], v5, s[4:7], s21 offen sc1
    v_lshl_or_b32 v80, v21, 16, v20
    v_lshl_or_b32 v81, v23, 16, v22
    v_lshl_or_b32 v82, v25, 16, v24
    v_lshl_or_b32 v83, v27, 16, v26
    s_add_u32 s21, s20, 4096
    buffer_store_dwordx4 v[80:83], v5, s[4:7], s21 offen sc1
    v_lshl_or_b32 v84, v29, 16, v28
    v_lshl_or_b32 v85, v31, 16, v30
    v_lshl_or_b32 v86, v33, 16, v32
    v_lshl_or_b32 v87, v35, 16, v34
    s_add_u32 s21, s20, 8192
    buffer_store_dwordx4 v[84:87], v5, s[4:7], s21 offen sc1
    v_lshl_or_b32 v88, v37, 16, v36
    v_lshl_or_b32 v89, v39, 16, v38
    v_lshl_or_b32 v90, v41, 16, v40
    v_lshl_or_b32 v91, v43, 16, v42
    s_add_u32 s21, s20, 12288
    buffer_store_dwordx4 v[88:91], v5, s[4:7], s21 offen sc1
    s_branch xf_done
xf_f:
    s_sub_u32 s17, s16, 1504
    s_and_b32 s18, s17, 127
    s_lshr_b32 s17, s17, 7
    s_lshl_b32 s19, s17, 4
    v_add_u32 v6, s19, v2
    v_mul_u32_u24 v4, 9216, v3
    v_lshl_add_u32 v4, v6, 4, v4
    v_lshrrev_b32 v5, 2, v2
    v_lshlrev_b32 v5, 11, v5
    v_lshl_add_u32 v5, v3, 8, v5
    v_and_b32 v1, 3, v6
    v_lshl_add_u32 v5, v1, 6, v5
    v_add_u32 v5, v5, v9
    v_cmp_gt_u32 vcc, 72, v6
    s_nop 0
    s_mov_b64 exec, vcc
    s_mul_i32 s20, s18, 36864
    s_add_u32 s21, s20, 0
    buffer_load_dwordx4 v[12:15], v4, s[8:11], s21 offen
    s_add_u32 s21, s20, 1152
    buffer_load_dwordx4 v[16:19], v4, s[8:11], s21 offen
    s_add_u32 s21, s20, 2304
    buffer_load_dwordx4 v[20:23], v4, s[8:11], s21 offen
    s_add_u32 s21, s20, 3456
    buffer_load_dwordx4 v[24:27], v4, s[8:11], s21 offen
    s_add_u32 s21, s20, 4608
    buffer_load_dwordx4 v[28:31], v4, s[8:11], s21 offen
    s_add_u32 s21, s20, 5760
    buffer_load_dwordx4 v[32:35], v4, s[8:11], s21 offen
    s_add_u32 s21, s20, 6912
    buffer_load_dwordx4 v[36:39], v4, s[8:11], s21 offen
    s_add_u32 s21, s20, 8064
    buffer_load_dwordx4 v[40:43], v4, s[8:11], s21 offen
    s_lshl_b32 s20, s18, 11
    s_add_u32 s20, s20, 130023424
    s_waitcnt vmcnt(0)
    v_perm_b32 v76, v16, v12, v7
    v_perm_b32 v77, v24, v20, v7
    v_perm_b32 v78, v32, v28, v7
    v_perm_b32 v79, v40, v36, v7
    ds_write_b128 v5, v[76:79] offset:0
    v_perm_b32 v80, v17, v13, v7
    v_perm_b32 v81, v25, v21, v7
    v_perm_b32 v82, v33, v29, v7
    v_perm_b32 v83, v41, v37, v7
    ds_write_b128 v5, v[80:83] offset:16
    v_perm_b32 v84, v18, v14, v7
    v_perm_b32 v85, v26, v22, v7
    v_perm_b32 v86, v34, v30, v7
    v_perm_b32 v87, v42, v38, v7
    ds_write_b128 v5, v[84:87] offset:32
    v_perm_b32 v88, v19, v15, v7
    v_perm_b32 v89, v27, v23, v7
    v_perm_b32 v90, v35, v31, v7
    v_perm_b32 v91, v43, v39, v7
    ds_write_b128 v5, v[88:91] offset:48
    v_perm_b32 v92, v16, v12, v8
    v_perm_b32 v93, v24, v20, v8
    v_perm_b32 v94, v32, v28, v8
    v_perm_b32 v95, v40, v36, v8
    ds_write_b128 v5, v[92:95] offset:1024
    v_perm_b32 v96, v17, v13, v8
    v_perm_b32 v97, v25, v21, v8
    v_perm_b32 v98, v33, v29, v8
    v_perm_b32 v99, v41, v37, v8
    ds_write_b128 v5, v[96:99] offset:1040
    v_perm_b32 v100, v18, v14, v8
    v_perm_b32 v101, v26, v22, v8
    v_perm_b32 v102, v34, v30, v8
    v_perm_b32 v103, v42, v38, v8
    ds_write_b128 v5, v[100:103] offset:1056
    v_perm_b32 v104, v19, v15, v8
    v_perm_b32 v105, v27, v23, v8
    v_perm_b32 v106, v35, v31, v8
    v_perm_b32 v107, v43, v39, v8
    ds_write_b128 v5, v[104:107] offset:1072
    s_mov_b64 exec, -1
    s_lshl_b32 s21, s17, 20
    s_add_u32 s20, s20, s21
    s_waitcnt lgkmcnt(0)
    ds_read_b128 v[76:79], v11 offset:0
    ds_read_b128 v[80:83], v11 offset:1024
    ds_read_b128 v[84:87], v11 offset:2048
    ds_read_b128 v[88:91], v11 offset:3072
    ds_read_b128 v[92:95], v11 offset:4096
    ds_read_b128 v[96:99], v11 offset:5120
    ds_read_b128 v[100:103], v11 offset:6144
    ds_read_b128 v[104:107], v11 offset:7168
    s_add_u32 s19, s20, 0
    s_waitcnt lgkmcnt(7)
    buffer_store_dwordx4 v[76:79], v10, s[4:7], s19 offen sc1
    s_add_u32 s19, s20, 1024
    s_waitcnt lgkmcnt(6)
    buffer_store_dwordx4 v[80:83], v10, s[4:7], s19 offen sc1
    s_add_u32 s19, s20, 262144
    s_waitcnt lgkmcnt(5)
    buffer_store_dwordx4 v[84:87], v10, s[4:7], s19 offen sc1
    s_add_u32 s19, s20, 263168
    s_waitcnt lgkmcnt(4)
    buffer_store_dwordx4 v[88:91], v10, s[4:7], s19 offen sc1
    s_add_u32 s19, s20, 524288
    s_waitcnt lgkmcnt(3)
    buffer_store_dwordx4 v[92:95], v10, s[4:7], s19 offen sc1
    s_add_u32 s19, s20, 525312
    s_waitcnt lgkmcnt(2)
    buffer_store_dwordx4 v[96:99], v10, s[4:7], s19 offen sc1
    s_add_u32 s19, s20, 786432
    s_waitcnt lgkmcnt(1)
    buffer_store_dwordx4 v[100:103], v10, s[4:7], s19 offen sc1
    s_add_u32 s19, s20, 787456
    s_waitcnt lgkmcnt(0)
    buffer_store_dwordx4 v[104:107], v10, s[4:7], s19 offen sc1
xf_done:
    s_nop 1
    s_setpc_b64 s[46:47]
L_helper:
    s_load_dwordx16 s[64:79], s[0:1], 64
    s_waitcnt lgkmcnt(0)
L_qkv_next:
    s_mov_b32 s37, 4
    v_mov_b32 v250, 1
    v_mov_b32 v251, 163832
    v_cmp_eq_u32 vcc, 0, v0
    s_nop 0
    s_and_saveexec_b64 s[38:39], vcc
    s_cbranch_execz tk9
    buffer_atomic_add v250, off, s[84:87], s37 sc0
    s_waitcnt vmcnt(0)
    ds_write_b32 v251, v250
    s_waitcnt lgkmcnt(0)
tk9:
    s_mov_b64 exec, -1
    s_barrier
    ds_read_b32 v252, v251
    s_waitcnt lgkmcnt(0)
    v_readfirstlane_b32 s36, v252
    s_barrier
    s_nop 3
    s_cmp_lg_u32 s36, 192
    s_cbranch_scc1 L_norelay
    s_cmp_lg_u32 s32, 0
    s_cbranch_scc1 L_exit
    v_and_b32 v3, 31, v0
    v_lshlrev_b32 v3, 7, v3
    s_mov_b32 s17, 0
    s_mov_b32 s23, 125845504
    s_mov_b32 s24, 125853696
    s_mov_b32 s21, 16777216
rl_rwait:
    buffer_load_dword v4, v3, s[4:7], s23 offen sc1
    s_waitcnt vmcnt(0)
    v_subrev_u32 v4, s95, v4
    v_cmp_lt_u32 vcc, 64, v4
    s_nop 1
    v_cndmask_b32 v4, v4, 0, vcc
    s_nop 1
    v_min_u32_dpp v4, v4, v4 row_ror:1 row_mask:0xf bank_mask:0xf
    s_nop 1
    v_min_u32_dpp v4, v4, v4 row_ror:2 row_mask:0xf bank_mask:0xf
    s_nop 1
    v_min_u32_dpp v4, v4, v4 row_ror:4 row_mask:0xf bank_mask:0xf
    s_nop 1
    v_min_u32_dpp v4, v4, v4 row_ror:8 row_mask:0xf bank_mask:0xf
    s_nop 0
    v_readlane_b32 s16, v4, 0
    v_readlane_b32 s22, v4, 16
    s_nop 0
    s_min_u32 s16, s16, s22
    s_sub_u32 s21, s21, 1
    s_cbranch_scc1 rl_x
    s_cmp_gt_u32 s16, s17
    s_cbranch_scc1 rl_rpub
    s_sleep 2
    s_branch rl_rwait
rl_rpub:
    s_mov_b32 s17, s16
    s_add_u32 s22, s16, s95
    v_mov_b32 v4, s22
    s_mov_b64 exec, 1
    buffer_store_dword v4, off, s[4:7], s24 sc1
    s_mov_b64 exec, -1
    s_cmp_lt_u32 s16, 64
    s_cbranch_scc1 rl_rwait
rl_x:
    s_endpgm
L_norelay:
    s_cmp_ge_u32 s36, 192
    s_cbranch_scc1 L_ssm_next
    s_and_b32 s17, s36, 15
    s_lshl_b32 s17, s17, 1
    s_lshr_b32 s36, s36, 4
    s_and_b32 s16, s36, 1
    s_add_u32 s16, s16, 1
    s_lshr_b32 s19, s36, 1
    s_and_b32 s37, s36, 3
    s_cmp_ge_u32 s36, 8
    s_cselect_b32 s16, 0, s16
    s_cselect_b32 s19, s37, s19
    s_lshl_b32 s19, s19, 4
    v_lshrrev_b32 v4, 6, v0
    s_nop 0
    v_readfirstlane_b32 s18, v4
    v_lshlrev_b32 v7, 4, v0
    s_lshl_b32 s21, s16, 5
    s_add_u32 s21, s21, s17
    s_mul_i32 s21, s21, 147456
    s_add_u32 s21, s21, 100663296
    v_and_b32 v4, 63, v0
    v_and_b32 v5, 15, v4
    v_lshrrev_b32 v3, 4, v4
    v_lshrrev_b32 v2, 2, v5
    v_xor_b32 v3, v3, v2
    v_lshl_add_u32 v3, v5, 2, v3
    v_lshlrev_b32 v1, 4, v3
    v_lshrrev_b32 v5, 2, v4
    v_lshrrev_b32 v3, 4, v4
    v_and_b32 v4, 3, v4
    v_xor_b32 v4, v4, v3
    v_lshlrev_b32 v3, 3, v3
    v_and_b32 v5, 3, v5
    v_add_u32 v3, v3, v5
    v_mul_u32_u24 v2, 1152, v3
    v_lshl_add_u32 v2, v4, 4, v2
    v_lshrrev_b32 v4, 1, v4
    v_lshl_add_u32 v6, v4, 8, v2
    s_mov_b32 s8, s48
    s_mov_b32 s9, s49
    s_mov_b32 s10, 2359296
    s_mov_b32 s11, 0x20000
    s_lshr_b32 s22, s18, 1
    s_mul_i32 s24, s22, 4608
    s_mul_i32 s25, s22, 18432
    s_and_b32 s22, s18, 1
    s_mul_i32 s23, s22, 576
    s_add_u32 s24, s24, s23
    s_lshl_b32 s23, s22, 10
    s_add_u32 s30, s25, s23
    s_lshl_b32 s23, s22, 13
    s_add_u32 s25, s25, s23
    s_mul_i32 s22, s19, 36864
    s_add_u32 s24, s24, s22
    s_add_u32 s20, s19, 16
    s_lshl_b32 s22, s19, 5
    s_add_u32 s22, s22, s17
    s_lshl_b32 s26, s22, 14
    s_mul_i32 s23, s18, 3072
    s_add_u32 s26, s26, s23
    s_lshl_b32 s23, s16, 11
    s_add_u32 s26, s26, s23
    s_add_u32 s26, s26, -2048
    s_lshl_b32 s22, s22, 13
    s_add_u32 s22, s22, 33554432
    s_cmp_eq_u32 s16, 0
    s_cselect_b32 s26, s22, s26
    s_cselect_b32 s12, 4096, 64
    s_cselect_b32 s13, 1, 2
    s_max_u32 s12, s12, 1024
    s_lshl_b32 s13, s13, 18
    s_lshl_b32 s29, s17, 7
    s_lshl_b32 s22, s16, 4
    s_add_u32 s29, s29, s22
    s_lshr_b32 s22, s19, 2
    s_add_u32 s29, s29, s22
    s_add_u32 s29, s29, 125829120
    s_mov_b32 s27, 0
    s_add_u32 s23, s27, s25
    s_add_u32 s31, s27, s30
    s_add_u32 m0, s23, 0
    s_nop 0
    buffer_load_dwordx4 v2, s[8:11], s24 offen offset:0 lds
    s_add_u32 m0, s23, 960
    s_nop 0
    buffer_load_dwordx4 v2, s[8:11], s24 offen offset:64 lds
    s_add_u32 m0, s23, 1920
    s_nop 0
    buffer_load_dwordx4 v2, s[8:11], s24 offen offset:128 lds
    s_add_u32 m0, s23, 2880
    s_nop 0
    buffer_load_dwordx4 v2, s[8:11], s24 offen offset:192 lds
    s_add_u32 m0, s23, 3808
    s_nop 0
    buffer_load_dwordx4 v2, s[8:11], s24 offen offset:288 lds
    s_add_u32 m0, s23, 4768
    s_nop 0
    buffer_load_dwordx4 v2, s[8:11], s24 offen offset:352 lds
    s_add_u32 m0, s23, 5728
    s_nop 0
    buffer_load_dwordx4 v2, s[8:11], s24 offen offset:416 lds
    s_add_u32 m0, s23, 6688
    s_nop 0
    buffer_load_dwordx4 v2, s[8:11], s24 offen offset:480 lds
    s_add_u32 m0, s31, 16128
    s_nop 0
    buffer_load_dwordx4 v6, s[8:11], s24 offen offset:256 lds
    s_add_u32 s24, s24, 36864
    s_lshl_b32 s89, s17, 6
    s_add_u32 s89, s89, 125833216
    v_mbcnt_lo_u32_b32 v16, -1, 0
    v_mbcnt_hi_u32_b32 v16, -1, v16
    v_min_u32 v16, 6, v16
    v_lshlrev_b32 v16, 2, v16
    s_mov_b32 s88, 4194304
fw10:
    buffer_load_dword v17, v16, s[4:7], s89 offen offset:0 sc1
    s_sub_u32 s88, s88, 1
    s_cbranch_scc1 fw10x
    s_waitcnt vmcnt(0)
    v_cmp_ne_u32 vcc, s95, v17
    s_cbranch_vccz fw10x
    s_sleep 1
    s_branch fw10
fw10x:
    s_nop 1
    v_mbcnt_lo_u32_b32 v16, -1, 0
    v_mbcnt_hi_u32_b32 v16, -1, v16
    v_min_u32 v16, 6, v16
    v_lshlrev_b32 v16, 2, v16
    s_mov_b32 s88, 4194304
fw11:
    buffer_load_dword v17, v16, s[4:7], s89 offen offset:64 sc1
    s_sub_u32 s88, s88, 1
    s_cbranch_scc1 fw11x
    s_waitcnt vmcnt(0)
    v_cmp_ne_u32 vcc, s95, v17
    s_cbranch_vccz fw11x
    s_sleep 1
    s_branch fw11
fw11x:
    s_add_u32 s22, s21, 0
    buffer_load_dwordx4 v[64:67], v7, s[4:7], s22 offen sc1
    s_add_u32 s22, s22, 147456
    buffer_load_dwordx4 a[0:3], v7, s[4:7], s22 offen sc1
    s_add_u32 s22, s21, 8192
    buffer_load_dwordx4 v[136:139], v7, s[4:7], s22 offen sc1
    s_add_u32 s22, s22, 147456
    buffer_load_dwordx4 a[72:75], v7, s[4:7], s22 offen sc1
    s_add_u32 s22, s21, 4096
    buffer_load_dwordx4 v[68:71], v7, s[4:7], s22 offen sc1
    s_add_u32 s22, s22, 147456
    buffer_load_dwordx4 a[4:7], v7, s[4:7], s22 offen sc1
    s_add_u32 s22, s21, 12288
    buffer_load_dwordx4 v[140:143], v7, s[4:7], s22 offen sc1
    s_add_u32 s22, s22, 147456
    buffer_load_dwordx4 a[76:79], v7, s[4:7], s22 offen sc1
    s_add_u32 s22, s21, 65536
    buffer_load_dwordx4 v[72:75], v7, s[4:7], s22 offen sc1
    s_add_u32 s22, s22, 147456
    buffer_load_dwordx4 a[8:11], v7, s[4:7], s22 offen sc1
    s_add_u32 s22, s21, 73728
    buffer_load_dwordx4 v[144:147], v7, s[4:7], s22 offen sc1
    s_add_u32 s22, s22, 147456
    buffer_load_dwordx4 a[80:83], v7, s[4:7], s22 offen sc1
    s_add_u32 s22, s21, 69632
    buffer_load_dwordx4 v[76:79], v7, s[4:7], s22 offen sc1
    s_add_u32 s22, s22, 147456
    buffer_load_dwordx4 a[12:15], v7, s[4:7], s22 offen sc1
    s_add_u32 s22, s21, 77824
    buffer_load_dwordx4 v[148:151], v7, s[4:7], s22 offen sc1
    s_add_u32 s22, s22, 147456
    buffer_load_dwordx4 a[84:87], v7, s[4:7], s22 offen sc1
    s_add_u32 s22, s21, 16384
    buffer_load_dwordx4 v[80:83], v7, s[4:7], s22 offen sc1
    s_add_u32 s22, s22, 147456
    buffer_load_dwordx4 a[16:19], v7, s[4:7], s22 offen sc1
    s_add_u32 s22, s21, 24576
    buffer_load_dwordx4 v[152:155], v7, s[4:7], s22 offen sc1
    s_add_u32 s22, s22, 147456
    buffer_load_dwordx4 a[88:91], v7, s[4:7], s22 offen sc1
    s_add_u32 s22, s21, 20480
    buffer_load_dwordx4 v[84:87], v7, s[4:7], s22 offen sc1
    s_add_u32 s22, s22, 147456
    buffer_load_dwordx4 a[20:23], v7, s[4:7], s22 offen sc1
    s_add_u32 s22, s21, 28672
    buffer_load_dwordx4 v[156:159], v7, s[4:7], s22 offen sc1
    s_add_u32 s22, s22, 147456
    buffer_load_dwordx4 a[92:95], v7, s[4:7], s22 offen sc1
    s_add_u32 s22, s21, 81920
    buffer_load_dwordx4 v[88:91], v7, s[4:7], s22 offen sc1
    s_add_u32 s22, s22, 147456
    buffer_load_dwordx4 a[24:27], v7, s[4:7], s22 offen sc1
    s_add_u32 s22, s21, 90112
    buffer_load_dwordx4 v[160:163], v7, s[4:7], s22 offen sc1
    s_add_u32 s22, s22, 147456
    buffer_load_dwordx4 a[96:99], v7, s[4:7], s22 offen sc1
    s_add_u32 s22, s21, 86016
    buffer_load_dwordx4 v[92:95], v7, s[4:7], s22 offen sc1
    s_add_u32 s22, s22, 147456
    buffer_load_dwordx4 a[28:31], v7, s[4:7], s22 offen sc1
    s_add_u32 s22, s21, 94208
    buffer_load_dwordx4 v[164:167], v7, s[4:7], s22 offen sc1
    s_add_u32 s22, s22, 147456
    buffer_load_dwordx4 a[100:103], v7, s[4:7], s22 offen sc1
    s_add_u32 s22, s21, 32768
    buffer_load_dwordx4 v[96:99], v7, s[4:7], s22 offen sc1
    s_add_u32 s22, s22, 147456
    buffer_load_dwordx4 a[32:35], v7, s[4:7], s22 offen sc1
    s_add_u32 s22, s21, 40960
    buffer_load_dwordx4 v[168:171], v7, s[4:7], s22 offen sc1
    s_add_u32 s22, s22, 147456
    buffer_load_dwordx4 a[104:107], v7, s[4:7], s22 offen sc1
    s_add_u32 s22, s21, 36864
    buffer_load_dwordx4 v[100:103], v7, s[4:7], s22 offen sc1
    s_add_u32 s22, s22, 147456
    buffer_load_dwordx4 a[36:39], v7, s[4:7], s22 offen sc1
    s_add_u32 s22, s21, 45056
    buffer_load_dwordx4 v[172:175], v7, s[4:7], s22 offen sc1
    s_add_u32 s22, s22, 147456
    buffer_load_dwordx4 a[108:111], v7, s[4:7], s22 offen sc1
    s_add_u32 s22, s21, 98304
    buffer_load_dwordx4 v[104:107], v7, s[4:7], s22 offen sc1
    s_add_u32 s22, s22, 147456
    buffer_load_dwordx4 a[40:43], v7, s[4:7], s22 offen sc1
    s_add_u32 s22, s21, 106496
    buffer_load_dwordx4 v[176:179], v7, s[4:7], s22 offen sc1
    s_add_u32 s22, s22, 147456
    buffer_load_dwordx4 a[112:115], v7, s[4:7], s22 offen sc1
    s_add_u32 s22, s21, 102400
    buffer_load_dwordx4 v[108:111], v7, s[4:7], s22 offen sc1
    s_add_u32 s22, s22, 147456
    buffer_load_dwordx4 a[44:47], v7, s[4:7], s22 offen sc1
    s_add_u32 s22, s21, 110592
    buffer_load_dwordx4 v[180:183], v7, s[4:7], s22 offen sc1
    s_add_u32 s22, s22, 147456
    buffer_load_dwordx4 a[116:119], v7, s[4:7], s22 offen sc1
    s_add_u32 s22, s21, 49152
    buffer_load_dwordx4 v[112:115], v7, s[4:7], s22 offen sc1
    s_add_u32 s22, s22, 147456
    buffer_load_dwordx4 a[48:51], v7, s[4:7], s22 offen sc1
    s_add_u32 s22, s21, 57344
    buffer_load_dwordx4 v[184:187], v7, s[4:7], s22 offen sc1
    s_add_u32 s22, s22, 147456
    buffer_load_dwordx4 a[120:123], v7, s[4:7], s22 offen sc1
    s_waitcnt vmcnt(30)
    s_add_u32 s22, s21, 53248
    buffer_load_dwordx4 v[116:119], v7, s[4:7], s22 offen sc1
    s_add_u32 s22, s22, 147456
    buffer_load_dwordx4 a[52:55], v7, s[4:7], s22 offen sc1
    s_add_u32 s22, s21, 61440
    buffer_load_dwordx4 v[188:191], v7, s[4:7], s22 offen sc1
    s_add_u32 s22, s22, 147456
    buffer_load_dwordx4 a[124:127], v7, s[4:7], s22 offen sc1
    s_add_u32 s22, s21, 114688
    buffer_load_dwordx4 v[120:123], v7, s[4:7], s22 offen sc1
    s_add_u32 s22, s22, 147456
    buffer_load_dwordx4 a[56:59], v7, s[4:7], s22 offen sc1
    s_add_u32 s22, s21, 122880
    buffer_load_dwordx4 v[192:195], v7, s[4:7], s22 offen sc1
    s_add_u32 s22, s22, 147456
    buffer_load_dwordx4 a[128:131], v7, s[4:7], s22 offen sc1
    s_add_u32 s22, s21, 118784
    buffer_load_dwordx4 v[124:127], v7, s[4:7], s22 offen sc1
    s_add_u32 s22, s22, 147456
    buffer_load_dwordx4 a[60:63], v7, s[4:7], s22 offen sc1
    s_add_u32 s22, s21, 126976
    buffer_load_dwordx4 v[196:199], v7, s[4:7], s22 offen sc1
    s_add_u32 s22, s22, 147456
    buffer_load_dwordx4 a[132:135], v7, s[4:7], s22 offen sc1
    s_add_u32 s22, s21, 131072
    buffer_load_dwordx4 v[128:131], v7, s[4:7], s22 offen sc1
    s_add_u32 s22, s22, 147456
    buffer_load_dwordx4 a[64:67], v7, s[4:7], s22 offen sc1
    s_add_u32 s22, s21, 139264
    buffer_load_dwordx4 v[200:203], v7, s[4:7], s22 offen sc1
    s_add_u32 s22, s22, 147456
    buffer_load_dwordx4 a[136:139], v7, s[4:7], s22 offen sc1
    s_add_u32 s22, s21, 135168
    buffer_load_dwordx4 v[132:135], v7, s[4:7], s22 offen sc1
    s_add_u32 s22, s22, 147456
    buffer_load_dwordx4 a[68:71], v7, s[4:7], s22 offen sc1
    s_add_u32 s22, s21, 143360
    buffer_load_dwordx4 v[204:207], v7, s[4:7], s22 offen sc1
    s_add_u32 s22, s22, 147456
    buffer_load_dwordx4 a[140:143], v7, s[4:7], s22 offen sc1
    s_mov_b32 s27, 36864
    s_add_u32 s23, s27, s25
    s_add_u32 s31, s27, s30
    s_add_u32 m0, s23, 0
    s_nop 0
    buffer_load_dwordx4 v2, s[8:11], s24 offen offset:0 lds
    s_add_u32 m0, s23, 960
    s_nop 0
    buffer_load_dwordx4 v2, s[8:11], s24 offen offset:64 lds
    s_add_u32 m0, s23, 1920
    s_nop 0
    buffer_load_dwordx4 v2, s[8:11], s24 offen offset:128 lds
    s_add_u32 m0, s23, 2880
    s_nop 0
    buffer_load_dwordx4 v2, s[8:11], s24 offen offset:192 lds
    s_add_u32 m0, s23, 3808
    s_nop 0
    buffer_load_dwordx4 v2, s[8:11], s24 offen offset:288 lds
    s_add_u32 m0, s23, 4768
    s_nop 0
    buffer_load_dwordx4 v2, s[8:11], s24 offen offset:352 lds
    s_add_u32 m0, s23, 5728
    s_nop 0
    buffer_load_dwordx4 v2, s[8:11], s24 offen offset:416 lds
    s_add_u32 m0, s23, 6688
    s_nop 0
    buffer_load_dwordx4 v2, s[8:11], s24 offen offset:480 lds
    s_add_u32 m0, s31, 16128
    s_nop 0
    buffer_load_dwordx4 v6, s[8:11], s24 offen offset:256 lds
    s_add_u32 s24, s24, 36864
    s_waitcnt vmcnt(9)
    s_mov_b32 s27, 0
    s_cmp_eq_u32 s18, 0
    s_cselect_b32 s34, 1, 0
    s_mov_b32 s35, 0
    s_cmp_eq_u32 s16, 2
    s_cbranch_scc1 qk_vloop
qk_loop:
    s_barrier
    v_add_u32 v3, s27, v1
    ds_read_b128 v[32:35], v3 offset:0
    ds_read_b128 v[36:39], v3 offset:18432
    ds_read_b128 v[40:43], v3 offset:1024
    ds_read_b128 v[44:47], v3 offset:19456
    ds_read_b128 v[48:51], v3 offset:2048
    ds_read_b128 v[52:55], v3 offset:20480
    s_sub_u32 s22, s19, 1
    s_max_i32 s22, s22, 0
    s_add_u32 s23, s22, s95
    v_mov_b32 v4, s23
    s_mov_b64 exec, s[34:35]
    buffer_store_dword v4, off, s[4:7], s29 sc1
    buffer_store_dword v4, off, s[4:7], s29 offset:128 sc1
    s_mov_b64 exec, -1
    s_add_u32 s22, s27, 73728
    s_sub_u32 s21, s22, 110592
    s_cselect_b32 s22, s22, s21
    ds_read_b128 v[56:59], v3 offset:3072
    ds_read_b128 v[60:63], v3 offset:21504
    s_add_u32 s23, s22, s25
    s_add_u32 s31, s22, s30
    s_add_u32 m0, s23, 0
    s_nop 0
    buffer_load_dwordx4 v2, s[8:11], s24 offen offset:0 lds
    s_waitcnt lgkmcnt(6)
    v_mfma_f32_16x16x32_bf16 v[208:211], v[64:67], v[32:35], 0
    v_mfma_f32_16x16x32_bf16 v[212:215], v[136:139], v[32:35], 0
    v_mfma_f32_16x16x32_bf16 v[216:219], v[64:67], v[36:39], 0
    v_mfma_f32_16x16x32_bf16 v[220:223], v[136:139], v[36:39], 0
    v_mfma_f32_16x16x32_bf16 v[224:227], a[0:3], v[32:35], 0
    v_mfma_f32_16x16x32_bf16 v[228:231], a[72:75], v[32:35], 0
    v_mfma_f32_16x16x32_bf16 v[232:235], a[0:3], v[36:39], 0
    v_mfma_f32_16x16x32_bf16 v[236:239], a[72:75], v[36:39], 0
    ds_read_b128 v[32:35], v3 offset:4096
    ds_read_b128 v[36:39], v3 offset:22528
    s_add_u32 m0, s23, 960
    s_nop 0
    buffer_load_dwordx4 v2, s[8:11], s24 offen offset:64 lds
    s_waitcnt lgkmcnt(6)
    v_mfma_f32_16x16x32_bf16 v[208:211], v[68:71], v[40:43], v[208:211]
    v_mfma_f32_16x16x32_bf16 v[212:215], v[140:143], v[40:43], v[212:215]
    v_mfma_f32_16x16x32_bf16 v[216:219], v[68:71], v[44:47], v[216:219]
    v_mfma_f32_16x16x32_bf16 v[220:223], v[140:143], v[44:47], v[220:223]
    v_mfma_f32_16x16x32_bf16 v[224:227], a[4:7], v[40:43], v[224:227]
    v_mfma_f32_16x16x32_bf16 v[228:231], a[76:79], v[40:43], v[228:231]
    v_mfma_f32_16x16x32_bf16 v[232:235], a[4:7], v[44:47], v[232:235]
    v_mfma_f32_16x16x32_bf16 v[236:239], a[76:79], v[44:47], v[236:239]
    ds_read_b128 v[40:43], v3 offset:5120
    ds_read_b128 v[44:47], v3 offset:23552
    s_add_u32 m0, s23, 1920
    s_nop 0
    buffer_load_dwordx4 v2, s[8:11], s24 offen offset:128 lds
    s_waitcnt lgkmcnt(6)
    v_mfma_f32_16x16x32_bf16 v[208:211], v[72:75], v[48:51], v[208:211]
    v_mfma_f32_16x16x32_bf16 v[212:215], v[144:147], v[48:51], v[212:215]
    v_mfma_f32_16x16x32_bf16 v[216:219], v[72:75], v[52:55], v[216:219]
    v_mfma_f32_16x16x32_bf16 v[220:223], v[144:147], v[52:55], v[220:223]
    v_mfma_f32_16x16x32_bf16 v[224:227], a[8:11], v[48:51], v[224:227]
    v_mfma_f32_16x16x32_bf16 v[228:231], a[80:83], v[48:51], v[228:231]
    v_mfma_f32_16x16x32_bf16 v[232:235], a[8:11], v[52:55], v[232:235]
    v_mfma_f32_16x16x32_bf16 v[236:239], a[80:83], v[52:55], v[236:239]
    ds_read_b128 v[48:51], v3 offset:6144
    ds_read_b128 v[52:55], v3 offset:24576
    s_add_u32 m0, s23, 2880
    s_nop 0
    buffer_load_dwordx4 v2, s[8:11], s24 offen offset:192 lds
    s_waitcnt lgkmcnt(6)
    v_mfma_f32_16x16x32_bf16 v[208:211], v[76:79], v[56:59], v[208:211]
    v_mfma_f32_16x16x32_bf16 v[212:215], v[148:151], v[56:59], v[212:215]
    v_mfma_f32_16x16x32_bf16 v[216:219], v[76:79], v[60:63], v[216:219]
    v_mfma_f32_16x16x32_bf16 v[220:223], v[148:151], v[60:63], v[220:223]
    v_mfma_f32_16x16x32_bf16 v[224:227], a[12:15], v[56:59], v[224:227]
    v_mfma_f32_16x16x32_bf16 v[228:231], a[84:87], v[56:59], v[228:231]
    v_mfma_f32_16x16x32_bf16 v[232:235], a[12:15], v[60:63], v[232:235]
    v_mfma_f32_16x16x32_bf16 v[236:239], a[84:87], v[60:63], v[236:239]
    ds_read_b128 v[56:59], v3 offset:7168
    ds_read_b128 v[60:63], v3 offset:25600
    s_add_u32 m0, s23, 3808
    s_nop 0
    buffer_load_dwordx4 v2, s[8:11], s24 offen offset:288 lds
    s_waitcnt lgkmcnt(6)
    v_mfma_f32_16x16x32_bf16 v[208:211], v[80:83], v[32:35], v[208:211]
    v_mfma_f32_16x16x32_bf16 v[212:215], v[152:155], v[32:35], v[212:215]
    v_mfma_f32_16x16x32_bf16 v[216:219], v[80:83], v[36:39], v[216:219]
    v_mfma_f32_16x16x32_bf16 v[220:223], v[152:155], v[36:39], v[220:223]
    v_mfma_f32_16x16x32_bf16 v[224:227], a[16:19], v[32:35], v[224:227]
    v_mfma_f32_16x16x32_bf16 v[228:231], a[88:91], v[32:35], v[228:231]
    v_mfma_f32_16x16x32_bf16 v[232:235], a[16:19], v[36:39], v[232:235]
    v_mfma_f32_16x16x32_bf16 v[236:239], a[88:91], v[36:39], v[236:239]
    ds_read_b128 v[32:35], v3 offset:8192
    ds_read_b128 v[36:39], v3 offset:26624
    s_add_u32 m0, s23, 4768
    s_nop 0
    buffer_load_dwordx4 v2, s[8:11], s24 offen offset:352 lds
    s_waitcnt lgkmcnt(6)
    v_mfma_f32_16x16x32_bf16 v[208:211], v[84:87], v[40:43], v[208:211]
    v_mfma_f32_16x16x32_bf16 v[212:215], v[156:159], v[40:43], v[212:215]
    v_mfma_f32_16x16x32_bf16 v[216:219], v[84:87], v[44:47], v[216:219]
    v_mfma_f32_16x16x32_bf16 v[220:223], v[156:159], v[44:47], v[220:223]
    v_mfma_f32_16x16x32_bf16 v[224:227], a[20:23], v[40:43], v[224:227]
    v_mfma_f32_16x16x32_bf16 v[228:231], a[92:95], v[40:43], v[228:231]
    v_mfma_f32_16x16x32_bf16 v[232:235], a[20:23], v[44:47], v[232:235]
    v_mfma_f32_16x16x32_bf16 v[236:239], a[92:95], v[44:47], v[236:239]
    ds_read_b128 v[40:43], v3 offset:9216
    ds_read_b128 v[44:47], v3 offset:27648
    s_add_u32 m0, s23, 5728
    s_nop 0
    buffer_load_dwordx4 v2, s[8:11], s24 offen offset:416 lds
    s_waitcnt lgkmcnt(6)
    v_mfma_f32_16x16x32_bf16 v[208:211], v[88:91], v[48:51], v[208:211]
    v_mfma_f32_16x16x32_bf16 v[212:215], v[160:163], v[48:51], v[212:215]
    v_mfma_f32_16x16x32_bf16 v[216:219], v[88:91], v[52:55], v[216:219]
    v_mfma_f32_16x16x32_bf16 v[220:223], v[160:163], v[52:55], v[220:223]
    v_mfma_f32_16x16x32_bf16 v[224:227], a[24:27], v[48:51], v[224:227]
    v_mfma_f32_16x16x32_bf16 v[228:231], a[96:99], v[48:51], v[228:231]
    v_mfma_f32_16x16x32_bf16 v[232:235], a[24:27], v[52:55], v[232:235]
    v_mfma_f32_16x16x32_bf16 v[236:239], a[96:99], v[52:55], v[236:239]
    ds_read_b128 v[48:51], v3 offset:10240
    ds_read_b128 v[52:55], v3 offset:28672
    s_add_u32 m0, s23, 6688
    s_nop 0
    buffer_load_dwordx4 v2, s[8:11], s24 offen offset:480 lds
    s_waitcnt lgkmcnt(6)
    v_mfma_f32_16x16x32_bf16 v[208:211], v[92:95], v[56:59], v[208:211]
    v_mfma_f32_16x16x32_bf16 v[212:215], v[164:167], v[56:59], v[212:215]
    v_mfma_f32_16x16x32_bf16 v[216:219], v[92:95], v[60:63], v[216:219]
    v_mfma_f32_16x16x32_bf16 v[220:223], v[164:167], v[60:63], v[220:223]
    v_mfma_f32_16x16x32_bf16 v[224:227], a[28:31], v[56:59], v[224:227]
    v_mfma_f32_16x16x32_bf16 v[228:231], a[100:103], v[56:59], v[228:231]
    v_mfma_f32_16x16x32_bf16 v[232:235], a[28:31], v[60:63], v[232:235]
    v_mfma_f32_16x16x32_bf16 v[236:239], a[100:103], v[60:63], v[236:239]
    ds_read_b128 v[56:59], v3 offset:11264
    ds_read_b128 v[60:63], v3 offset:29696
    s_add_u32 m0, s31, 16128
    s_nop 0
    buffer_load_dwordx4 v6, s[8:11], s24 offen offset:256 lds
    s_add_u32 s24, s24, 36864
    s_waitcnt lgkmcnt(6)
    v_mfma_f32_16x16x32_bf16 v[208:211], v[96:99], v[32:35], v[208:211]
    v_mfma_f32_16x16x32_bf16 v[212:215], v[168:171], v[32:35], v[212:215]
    v_mfma_f32_16x16x32_bf16 v[216:219], v[96:99], v[36:39], v[216:219]
    v_mfma_f32_16x16x32_bf16 v[220:223], v[168:171], v[36:39], v[220:223]
    v_mfma_f32_16x16x32_bf16 v[224:227], a[32:35], v[32:35], v[224:227]
    v_mfma_f32_16x16x32_bf16 v[228:231], a[104:107], v[32:35], v[228:231]
    v_mfma_f32_16x16x32_bf16 v[232:235], a[32:35], v[36:39], v[232:235]
    v_mfma_f32_16x16x32_bf16 v[236:239], a[104:107], v[36:39], v[236:239]
    ds_read_b128 v[32:35], v3 offset:12288
    ds_read_b128 v[36:39], v3 offset:30720
    s_waitcnt lgkmcnt(6)
    v_mfma_f32_16x16x32_bf16 v[208:211], v[100:103], v[40:43], v[208:211]
    v_mfma_f32_16x16x32_bf16 v[212:215], v[172:175], v[40:43], v[212:215]
    v_mfma_f32_16x16x32_bf16 v[216:219], v[100:103], v[44:47], v[216:219]
    v_mfma_f32_16x16x32_bf16 v[220:223], v[172:175], v[44:47], v[220:223]
    v_mfma_f32_16x16x32_bf16 v[224:227], a[36:39], v[40:43], v[224:227]
    v_mfma_f32_16x16x32_bf16 v[228:231], a[108:111], v[40:43], v[228:231]
    v_mfma_f32_16x16x32_bf16 v[232:235], a[36:39], v[44:47], v[232:235]
    v_mfma_f32_16x16x32_bf16 v[236:239], a[108:111], v[44:47], v[236:239]
    ds_read_b128 v[40:43], v3 offset:13312
    ds_read_b128 v[44:47], v3 offset:31744
    s_waitcnt lgkmcnt(6)
    v_mfma_f32_16x16x32_bf16 v[208:211], v[104:107], v[48:51], v[208:211]
    v_mfma_f32_16x16x32_bf16 v[212:215], v[176:179], v[48:51], v[212:215]
    v_mfma_f32_16x16x32_bf16 v[216:219], v[104:107], v[52:55], v[216:219]
    v_mfma_f32_16x16x32_bf16 v[220:223], v[176:179], v[52:55], v[220:223]
    v_mfma_f32_16x16x32_bf16 v[224:227], a[40:43], v[48:51], v[224:227]
    v_mfma_f32_16x16x32_bf16 v[228:231], a[112:115], v[48:51], v[228:231]
    v_mfma_f32_16x16x32_bf16 v[232:235], a[40:43], v[52:55], v[232:235]
    v_mfma_f32_16x16x32_bf16 v[236:239], a[112:115], v[52:55], v[236:239]
    ds_read_b128 v[48:51], v3 offset:14336
    ds_read_b128 v[52:55], v3 offset:32768
    s_waitcnt lgkmcnt(6)
    v_mfma_f32_16x16x32_bf16 v[208:211], v[108:111], v[56:59], v[208:211]
    v_mfma_f32_16x16x32_bf16 v[212:215], v[180:183], v[56:59], v[212:215]
    v_mfma_f32_16x16x32_bf16 v[216:219], v[108:111], v[60:63], v[216:219]
    v_mfma_f32_16x16x32_bf16 v[220:223], v[180:183], v[60:63], v[220:223]
    v_mfma_f32_16x16x32_bf16 v[224:227], a[44:47], v[56:59], v[224:227]
    v_mfma_f32_16x16x32_bf16 v[228:231], a[116:119], v[56:59], v[228:231]
    v_mfma_f32_16x16x32_bf16 v[232:235], a[44:47], v[60:63], v[232:235]
    v_mfma_f32_16x16x32_bf16 v[236:239], a[116:119], v[60:63], v[236:239]
    ds_read_b128 v[56:59], v3 offset:15360
    ds_read_b128 v[60:63], v3 offset:33792
    s_waitcnt lgkmcnt(6)
    v_mfma_f32_16x16x32_bf16 v[208:211], v[112:115], v[32:35], v[208:211]
    v_mfma_f32_16x16x32_bf16 v[212:215], v[184:187], v[32:35], v[212:215]
    v_mfma_f32_16x16x32_bf16 v[216:219], v[112:115], v[36:39], v[216:219]
    v_mfma_f32_16x16x32_bf16 v[220:223], v[184:187], v[36:39], v[220:223]
    v_mfma_f32_16x16x32_bf16 v[224:227], a[48:51], v[32:35], v[224:227]
    v_mfma_f32_16x16x32_bf16 v[228:231], a[120:123], v[32:35], v[228:231]
    v_mfma_f32_16x16x32_bf16 v[232:235], a[48:51], v[36:39], v[232:235]
    v_mfma_f32_16x16x32_bf16 v[236:239], a[120:123], v[36:39], v[236:239]
    ds_read_b128 v[32:35], v3 offset:16384
    ds_read_b128 v[36:39], v3 offset:34816
    s_waitcnt lgkmcnt(6)
    v_mfma_f32_16x16x32_bf16 v[208:211], v[116:119], v[40:43], v[208:211]
    v_mfma_f32_16x16x32_bf16 v[212:215], v[188:191], v[40:43], v[212:215]
    v_mfma_f32_16x16x32_bf16 v[216:219], v[116:119], v[44:47], v[216:219]
    v_mfma_f32_16x16x32_bf16 v[220:223], v[188:191], v[44:47], v[220:223]
    v_mfma_f32_16x16x32_bf16 v[224:227], a[52:55], v[40:43], v[224:227]
    v_mfma_f32_16x16x32_bf16 v[228:231], a[124:127], v[40:43], v[228:231]
    v_mfma_f32_16x16x32_bf16 v[232:235], a[52:55], v[44:47], v[232:235]
    v_mfma_f32_16x16x32_bf16 v[236:239], a[124:127], v[44:47], v[236:239]
    ds_read_b128 v[40:43], v3 offset:17408
    ds_read_b128 v[44:47], v3 offset:35840
    s_waitcnt lgkmcnt(6)
    v_mfma_f32_16x16x32_bf16 v[208:211], v[120:123], v[48:51], v[208:211]
    v_mfma_f32_16x16x32_bf16 v[212:215], v[192:195], v[48:51], v[212:215]
    v_mfma_f32_16x16x32_bf16 v[216:219], v[120:123], v[52:55], v[216:219]
    v_mfma_f32_16x16x32_bf16 v[220:223], v[192:195], v[52:55], v[220:223]
    v_mfma_f32_16x16x32_bf16 v[224:227], a[56:59], v[48:51], v[224:227]
    v_mfma_f32_16x16x32_bf16 v[228:231], a[128:131], v[48:51], v[228:231]
    v_mfma_f32_16x16x32_bf16 v[232:235], a[56:59], v[52:55], v[232:235]
    v_mfma_f32_16x16x32_bf16 v[236:239], a[128:131], v[52:55], v[236:239]
    s_waitcnt lgkmcnt(4)
    v_mfma_f32_16x16x32_bf16 v[208:211], v[124:127], v[56:59], v[208:211]
    v_mfma_f32_16x16x32_bf16 v[212:215], v[196:199], v[56:59], v[212:215]
    v_mfma_f32_16x16x32_bf16 v[216:219], v[124:127], v[60:63], v[216:219]
    v_mfma_f32_16x16x32_bf16 v[220:223], v[196:199], v[60:63], v[220:223]
    v_mfma_f32_16x16x32_bf16 v[224:227], a[60:63], v[56:59], v[224:227]
    v_mfma_f32_16x16x32_bf16 v[228:231], a[132:135], v[56:59], v[228:231]
    v_mfma_f32_16x16x32_bf16 v[232:235], a[60:63], v[60:63], v[232:235]
    v_mfma_f32_16x16x32_bf16 v[236:239], a[132:135], v[60:63], v[236:239]
    s_waitcnt lgkmcnt(2)
    v_mfma_f32_16x16x32_bf16 v[208:211], v[128:131], v[32:35], v[208:211]
    v_mfma_f32_16x16x32_bf16 v[212:215], v[200:203], v[32:35], v[212:215]
    v_mfma_f32_16x16x32_bf16 v[216:219], v[128:131], v[36:39], v[216:219]
    v_mfma_f32_16x16x32_bf16 v[220:223], v[200:203], v[36:39], v[220:223]
    v_mfma_f32_16x16x32_bf16 v[224:227], a[64:67], v[32:35], v[224:227]
    v_mfma_f32_16x16x32_bf16 v[228:231], a[136:139], v[32:35], v[228:231]
    v_mfma_f32_16x16x32_bf16 v[232:235], a[64:67], v[36:39], v[232:235]
    v_mfma_f32_16x16x32_bf16 v[236:239], a[136:139], v[36:39], v[236:239]
    s_waitcnt lgkmcnt(0)
    v_mfma_f32_16x16x32_bf16 v[208:211], v[132:135], v[40:43], v[208:211]
    v_mfma_f32_16x16x32_bf16 v[212:215], v[204:207], v[40:43], v[212:215]
    v_mfma_f32_16x16x32_bf16 v[216:219], v[132:135], v[44:47], v[216:219]
    v_mfma_f32_16x16x32_bf16 v[220:223], v[204:207], v[44:47], v[220:223]
    v_mfma_f32_16x16x32_bf16 v[224:227], a[68:71], v[40:43], v[224:227]
    v_mfma_f32_16x16x32_bf16 v[228:231], a[140:143], v[40:43], v[228:231]
    v_mfma_f32_16x16x32_bf16 v[232:235], a[68:71], v[44:47], v[232:235]
    v_mfma_f32_16x16x32_bf16 v[236:239], a[140:143], v[44:47], v[236:239]
    s_waitcnt vmcnt(0)
    s_nop 0
    v_cvt_pk_bf16_f32 v8, v208, v212
    v_cvt_pk_bf16_f32 v9, v209, v213
    v_cvt_pk_bf16_f32 v10, v210, v214
    v_cvt_pk_bf16_f32 v11, v211, v215
    s_lshr_b32 s22, s13, 5
    s_mul_i32 s22, s22, 0
    s_add_u32 s28, s26, s22
    buffer_store_dwordx4 v[8:11], v7, s[4:7], s28 offen sc1
    v_cvt_pk_bf16_f32 v12, v216, v220
    v_cvt_pk_bf16_f32 v13, v217, v221
    v_cvt_pk_bf16_f32 v14, v218, v222
    v_cvt_pk_bf16_f32 v15, v219, v223
    s_lshr_b32 s22, s13, 5
    s_mul_i32 s22, s22, 0
    s_add_u32 s28, s26, s22
    s_add_u32 s28, s28, s12
    buffer_store_dwordx4 v[12:15], v7, s[4:7], s28 offen sc1
    v_cvt_pk_bf16_f32 v16, v224, v228
    v_cvt_pk_bf16_f32 v17, v225, v229
    v_cvt_pk_bf16_f32 v18, v226, v230
    v_cvt_pk_bf16_f32 v19, v227, v231
    s_lshr_b32 s22, s13, 5
    s_mul_i32 s22, s22, 1
    s_add_u32 s28, s26, s22
    buffer_store_dwordx4 v[16:19], v7, s[4:7], s28 offen sc1
    v_cvt_pk_bf16_f32 v20, v232, v236
    v_cvt_pk_bf16_f32 v21, v233, v237
    v_cvt_pk_bf16_f32 v22, v234, v238
    v_cvt_pk_bf16_f32 v23, v235, v239
    s_lshr_b32 s22, s13, 5
    s_mul_i32 s22, s22, 1
    s_add_u32 s28, s26, s22
    s_add_u32 s28, s28, s12
    buffer_store_dwordx4 v[20:23], v7, s[4:7], s28 offen sc1
    s_add_u32 s26, s26, s13
    s_add_u32 s27, s27, 36864
    s_cmp_eq_u32 s27, 110592
    s_cselect_b32 s27, 0, s27
    s_add_u32 s19, s19, 1
    s_cmp_lt_u32 s19, s20
    s_cbranch_scc1 qk_loop
    s_branch qk_done
qk_vloop:
    s_barrier
    v_add_u32 v3, s27, v1
    ds_read_b128 v[32:35], v3 offset:0
    ds_read_b128 v[36:39], v3 offset:18432
    ds_read_b128 v[40:43], v3 offset:1024
    ds_read_b128 v[44:47], v3 offset:19456
    ds_read_b128 v[48:51], v3 offset:2048
    ds_read_b128 v[52:55], v3 offset:20480
    s_sub_u32 s22, s19, 1
    s_max_i32 s22, s22, 0
    s_add_u32 s23, s22, s95
    v_mov_b32 v4, s23
    s_mov_b64 exec, s[34:35]
    buffer_store_dword v4, off, s[4:7], s29 sc1
    buffer_store_dword v4, off, s[4:7], s29 offset:128 sc1
    s_mov_b64 exec, -1
    s_add_u32 s22, s27, 73728
    s_sub_u32 s21, s22, 110592
    s_cselect_b32 s22, s22, s21
    ds_read_b128 v[56:59], v3 offset:3072
    ds_read_b128 v[60:63], v3 offset:21504
    s_add_u32 s23, s22, s25
    s_add_u32 s31, s22, s30
    s_add_u32 m0, s23, 0
    s_nop 0
    buffer_load_dwordx4 v2, s[8:11], s24 offen offset:0 lds
    s_waitcnt lgkmcnt(6)
    v_mfma_f32_16x16x32_bf16 v[208:211], v[32:35], v[64:67], 0
    v_mfma_f32_16x16x32_bf16 v[212:215], v[32:35], v[136:139], 0
    v_mfma_f32_16x16x32_bf16 v[216:219], v[36:39], v[64:67], 0
    v_mfma_f32_16x16x32_bf16 v[220:223], v[36:39], v[136:139], 0
    v_mfma_f32_16x16x32_bf16 v[224:227], v[32:35], a[0:3], 0
    v_mfma_f32_16x16x32_bf16 v[228:231], v[32:35], a[72:75], 0
    v_mfma_f32_16x16x32_bf16 v[232:235], v[36:39], a[0:3], 0
    v_mfma_f32_16x16x32_bf16 v[236:239], v[36:39], a[72:75], 0
    ds_read_b128 v[32:35], v3 offset:4096
    ds_read_b128 v[36:39], v3 offset:22528
    s_add_u32 m0, s23, 960
    s_nop 0
    buffer_load_dwordx4 v2, s[8:11], s24 offen offset:64 lds
    s_waitcnt lgkmcnt(6)
    v_mfma_f32_16x16x32_bf16 v[208:211], v[40:43], v[68:71], v[208:211]
    v_mfma_f32_16x16x32_bf16 v[212:215], v[40:43], v[140:143], v[212:215]
    v_mfma_f32_16x16x32_bf16 v[216:219], v[44:47], v[68:71], v[216:219]
    v_mfma_f32_16x16x32_bf16 v[220:223], v[44:47], v[140:143], v[220:223]
    v_mfma_f32_16x16x32_bf16 v[224:227], v[40:43], a[4:7], v[224:227]
    v_mfma_f32_16x16x32_bf16 v[228:231], v[40:43], a[76:79], v[228:231]
    v_mfma_f32_16x16x32_bf16 v[232:235], v[44:47], a[4:7], v[232:235]
    v_mfma_f32_16x16x32_bf16 v[236:239], v[44:47], a[76:79], v[236:239]
    ds_read_b128 v[40:43], v3 offset:5120
    ds_read_b128 v[44:47], v3 offset:23552
    s_add_u32 m0, s23, 1920
    s_nop 0
    buffer_load_dwordx4 v2, s[8:11], s24 offen offset:128 lds
    s_waitcnt lgkmcnt(6)
    v_mfma_f32_16x16x32_bf16 v[208:211], v[48:51], v[72:75], v[208:211]
    v_mfma_f32_16x16x32_bf16 v[212:215], v[48:51], v[144:147], v[212:215]
    v_mfma_f32_16x16x32_bf16 v[216:219], v[52:55], v[72:75], v[216:219]
    v_mfma_f32_16x16x32_bf16 v[220:223], v[52:55], v[144:147], v[220:223]
    v_mfma_f32_16x16x32_bf16 v[224:227], v[48:51], a[8:11], v[224:227]
    v_mfma_f32_16x16x32_bf16 v[228:231], v[48:51], a[80:83], v[228:231]
    v_mfma_f32_16x16x32_bf16 v[232:235], v[52:55], a[8:11], v[232:235]
    v_mfma_f32_16x16x32_bf16 v[236:239], v[52:55], a[80:83], v[236:239]
    ds_read_b128 v[48:51], v3 offset:6144
    ds_read_b128 v[52:55], v3 offset:24576
    s_add_u32 m0, s23, 2880
    s_nop 0
    buffer_load_dwordx4 v2, s[8:11], s24 offen offset:192 lds
    s_waitcnt lgkmcnt(6)
    v_mfma_f32_16x16x32_bf16 v[208:211], v[56:59], v[76:79], v[208:211]
    v_mfma_f32_16x16x32_bf16 v[212:215], v[56:59], v[148:151], v[212:215]
    v_mfma_f32_16x16x32_bf16 v[216:219], v[60:63], v[76:79], v[216:219]
    v_mfma_f32_16x16x32_bf16 v[220:223], v[60:63], v[148:151], v[220:223]
    v_mfma_f32_16x16x32_bf16 v[224:227], v[56:59], a[12:15], v[224:227]
    v_mfma_f32_16x16x32_bf16 v[228:231], v[56:59], a[84:87], v[228:231]
    v_mfma_f32_16x16x32_bf16 v[232:235], v[60:63], a[12:15], v[232:235]
    v_mfma_f32_16x16x32_bf16 v[236:239], v[60:63], a[84:87], v[236:239]
    ds_read_b128 v[56:59], v3 offset:7168
    ds_read_b128 v[60:63], v3 offset:25600
    s_add_u32 m0, s23, 3808
    s_nop 0
    buffer_load_dwordx4 v2, s[8:11], s24 offen offset:288 lds
    s_waitcnt lgkmcnt(6)
    v_mfma_f32_16x16x32_bf16 v[208:211], v[32:35], v[80:83], v[208:211]
    v_mfma_f32_16x16x32_bf16 v[212:215], v[32:35], v[152:155], v[212:215]
    v_mfma_f32_16x16x32_bf16 v[216:219], v[36:39], v[80:83], v[216:219]
    v_mfma_f32_16x16x32_bf16 v[220:223], v[36:39], v[152:155], v[220:223]
    v_mfma_f32_16x16x32_bf16 v[224:227], v[32:35], a[16:19], v[224:227]
    v_mfma_f32_16x16x32_bf16 v[228:231], v[32:35], a[88:91], v[228:231]
    v_mfma_f32_16x16x32_bf16 v[232:235], v[36:39], a[16:19], v[232:235]
    v_mfma_f32_16x16x32_bf16 v[236:239], v[36:39], a[88:91], v[236:239]
    ds_read_b128 v[32:35], v3 offset:8192
    ds_read_b128 v[36:39], v3 offset:26624
    s_add_u32 m0, s23, 4768
    s_nop 0
    buffer_load_dwordx4 v2, s[8:11], s24 offen offset:352 lds
    s_waitcnt lgkmcnt(6)
    v_mfma_f32_16x16x32_bf16 v[208:211], v[40:43], v[84:87], v[208:211]
    v_mfma_f32_16x16x32_bf16 v[212:215], v[40:43], v[156:159], v[212:215]
    v_mfma_f32_16x16x32_bf16 v[216:219], v[44:47], v[84:87], v[216:219]
    v_mfma_f32_16x16x32_bf16 v[220:223], v[44:47], v[156:159], v[220:223]
    v_mfma_f32_16x16x32_bf16 v[224:227], v[40:43], a[20:23], v[224:227]
    v_mfma_f32_16x16x32_bf16 v[228:231], v[40:43], a[92:95], v[228:231]
    v_mfma_f32_16x16x32_bf16 v[232:235], v[44:47], a[20:23], v[232:235]
    v_mfma_f32_16x16x32_bf16 v[236:239], v[44:47], a[92:95], v[236:239]
    ds_read_b128 v[40:43], v3 offset:9216
    ds_read_b128 v[44:47], v3 offset:27648
    s_add_u32 m0, s23, 5728
    s_nop 0
    buffer_load_dwordx4 v2, s[8:11], s24 offen offset:416 lds
    s_waitcnt lgkmcnt(6)
    v_mfma_f32_16x16x32_bf16 v[208:211], v[48:51], v[88:91], v[208:211]
    v_mfma_f32_16x16x32_bf16 v[212:215], v[48:51], v[160:163], v[212:215]
    v_mfma_f32_16x16x32_bf16 v[216:219], v[52:55], v[88:91], v[216:219]
    v_mfma_f32_16x16x32_bf16 v[220:223], v[52:55], v[160:163], v[220:223]
    v_mfma_f32_16x16x32_bf16 v[224:227], v[48:51], a[24:27], v[224:227]
    v_mfma_f32_16x16x32_bf16 v[228:231], v[48:51], a[96:99], v[228:231]
    v_mfma_f32_16x16x32_bf16 v[232:235], v[52:55], a[24:27], v[232:235]
    v_mfma_f32_16x16x32_bf16 v[236:239], v[52:55], a[96:99], v[236:239]
    ds_read_b128 v[48:51], v3 offset:10240
    ds_read_b128 v[52:55], v3 offset:28672
    s_add_u32 m0, s23, 6688
    s_nop 0
    buffer_load_dwordx4 v2, s[8:11], s24 offen offset:480 lds
    s_waitcnt lgkmcnt(6)
    v_mfma_f32_16x16x32_bf16 v[208:211], v[56:59], v[92:95], v[208:211]
    v_mfma_f32_16x16x32_bf16 v[212:215], v[56:59], v[164:167], v[212:215]
    v_mfma_f32_16x16x32_bf16 v[216:219], v[60:63], v[92:95], v[216:219]
    v_mfma_f32_16x16x32_bf16 v[220:223], v[60:63], v[164:167], v[220:223]
    v_mfma_f32_16x16x32_bf16 v[224:227], v[56:59], a[28:31], v[224:227]
    v_mfma_f32_16x16x32_bf16 v[228:231], v[56:59], a[100:103], v[228:231]
    v_mfma_f32_16x16x32_bf16 v[232:235], v[60:63], a[28:31], v[232:235]
    v_mfma_f32_16x16x32_bf16 v[236:239], v[60:63], a[100:103], v[236:239]
    ds_read_b128 v[56:59], v3 offset:11264
    ds_read_b128 v[60:63], v3 offset:29696
    s_add_u32 m0, s31, 16128
    s_nop 0
    buffer_load_dwordx4 v6, s[8:11], s24 offen offset:256 lds
    s_add_u32 s24, s24, 36864
    s_waitcnt lgkmcnt(6)
    v_mfma_f32_16x16x32_bf16 v[208:211], v[32:35], v[96:99], v[208:211]
    v_mfma_f32_16x16x32_bf16 v[212:215], v[32:35], v[168:171], v[212:215]
    v_mfma_f32_16x16x32_bf16 v[216:219], v[36:39], v[96:99], v[216:219]
    v_mfma_f32_16x16x32_bf16 v[220:223], v[36:39], v[168:171], v[220:223]
    v_mfma_f32_16x16x32_bf16 v[224:227], v[32:35], a[32:35], v[224:227]
    v_mfma_f32_16x16x32_bf16 v[228:231], v[32:35], a[104:107], v[228:231]
    v_mfma_f32_16x16x32_bf16 v[232:235], v[36:39], a[32:35], v[232:235]
    v_mfma_f32_16x16x32_bf16 v[236:239], v[36:39], a[104:107], v[236:239]
    ds_read_b128 v[32:35], v3 offset:12288
    ds_read_b128 v[36:39], v3 offset:30720
    s_waitcnt lgkmcnt(6)
    v_mfma_f32_16x16x32_bf16 v[208:211], v[40:43], v[100:103], v[208:211]
    v_mfma_f32_16x16x32_bf16 v[212:215], v[40:43], v[172:175], v[212:215]
    v_mfma_f32_16x16x32_bf16 v[216:219], v[44:47], v[100:103], v[216:219]
    v_mfma_f32_16x16x32_bf16 v[220:223], v[44:47], v[172:175], v[220:223]
    v_mfma_f32_16x16x32_bf16 v[224:227], v[40:43], a[36:39], v[224:227]
    v_mfma_f32_16x16x32_bf16 v[228:231], v[40:43], a[108:111], v[228:231]
    v_mfma_f32_16x16x32_bf16 v[232:235], v[44:47], a[36:39], v[232:235]
    v_mfma_f32_16x16x32_bf16 v[236:239], v[44:47], a[108:111], v[236:239]
    ds_read_b128 v[40:43], v3 offset:13312
    ds_read_b128 v[44:47], v3 offset:31744
    s_waitcnt lgkmcnt(6)
    v_mfma_f32_16x16x32_bf16 v[208:211], v[48:51], v[104:107], v[208:211]
    v_mfma_f32_16x16x32_bf16 v[212:215], v[48:51], v[176:179], v[212:215]
    v_mfma_f32_16x16x32_bf16 v[216:219], v[52:55], v[104:107], v[216:219]
    v_mfma_f32_16x16x32_bf16 v[220:223], v[52:55], v[176:179], v[220:223]
    v_mfma_f32_16x16x32_bf16 v[224:227], v[48:51], a[40:43], v[224:227]
    v_mfma_f32_16x16x32_bf16 v[228:231], v[48:51], a[112:115], v[228:231]
    v_mfma_f32_16x16x32_bf16 v[232:235], v[52:55], a[40:43], v[232:235]
    v_mfma_f32_16x16x32_bf16 v[236:239], v[52:55], a[112:115], v[236:239]
    ds_read_b128 v[48:51], v3 offset:14336
    ds_read_b128 v[52:55], v3 offset:32768
    s_waitcnt lgkmcnt(6)
    v_mfma_f32_16x16x32_bf16 v[208:211], v[56:59], v[108:111], v[208:211]
    v_mfma_f32_16x16x32_bf16 v[212:215], v[56:59], v[180:183], v[212:215]
    v_mfma_f32_16x16x32_bf16 v[216:219], v[60:63], v[108:111], v[216:219]
    v_mfma_f32_16x16x32_bf16 v[220:223], v[60:63], v[180:183], v[220:223]
    v_mfma_f32_16x16x32_bf16 v[224:227], v[56:59], a[44:47], v[224:227]
    v_mfma_f32_16x16x32_bf16 v[228:231], v[56:59], a[116:119], v[228:231]
    v_mfma_f32_16x16x32_bf16 v[232:235], v[60:63], a[44:47], v[232:235]
    v_mfma_f32_16x16x32_bf16 v[236:239], v[60:63], a[116:119], v[236:239]
    ds_read_b128 v[56:59], v3 offset:15360
    ds_read_b128 v[60:63], v3 offset:33792
    s_waitcnt lgkmcnt(6)
    v_mfma_f32_16x16x32_bf16 v[208:211], v[32:35], v[112:115], v[208:211]
    v_mfma_f32_16x16x32_bf16 v[212:215], v[32:35], v[184:187], v[212:215]
    v_mfma_f32_16x16x32_bf16 v[216:219], v[36:39], v[112:115], v[216:219]
    v_mfma_f32_16x16x32_bf16 v[220:223], v[36:39], v[184:187], v[220:223]
    v_mfma_f32_16x16x32_bf16 v[224:227], v[32:35], a[48:51], v[224:227]
    v_mfma_f32_16x16x32_bf16 v[228:231], v[32:35], a[120:123], v[228:231]
    v_mfma_f32_16x16x32_bf16 v[232:235], v[36:39], a[48:51], v[232:235]
    v_mfma_f32_16x16x32_bf16 v[236:239], v[36:39], a[120:123], v[236:239]
    ds_read_b128 v[32:35], v3 offset:16384
    ds_read_b128 v[36:39], v3 offset:34816
    s_waitcnt lgkmcnt(6)
    v_mfma_f32_16x16x32_bf16 v[208:211], v[40:43], v[116:119], v[208:211]
    v_mfma_f32_16x16x32_bf16 v[212:215], v[40:43], v[188:191], v[212:215]
    v_mfma_f32_16x16x32_bf16 v[216:219], v[44:47], v[116:119], v[216:219]
    v_mfma_f32_16x16x32_bf16 v[220:223], v[44:47], v[188:191], v[220:223]
    v_mfma_f32_16x16x32_bf16 v[224:227], v[40:43], a[52:55], v[224:227]
    v_mfma_f32_16x16x32_bf16 v[228:231], v[40:43], a[124:127], v[228:231]
    v_mfma_f32_16x16x32_bf16 v[232:235], v[44:47], a[52:55], v[232:235]
    v_mfma_f32_16x16x32_bf16 v[236:239], v[44:47], a[124:127], v[236:239]
    ds_read_b128 v[40:43], v3 offset:17408
    ds_read_b128 v[44:47], v3 offset:35840
    s_waitcnt lgkmcnt(6)
    v_mfma_f32_16x16x32_bf16 v[208:211], v[48:51], v[120:123], v[208:211]
    v_mfma_f32_16x16x32_bf16 v[212:215], v[48:51], v[192:195], v[212:215]
    v_mfma_f32_16x16x32_bf16 v[216:219], v[52:55], v[120:123], v[216:219]
    v_mfma_f32_16x16x32_bf16 v[220:223], v[52:55], v[192:195], v[220:223]
    v_mfma_f32_16x16x32_bf16 v[224:227], v[48:51], a[56:59], v[224:227]
    v_mfma_f32_16x16x32_bf16 v[228:231], v[48:51], a[128:131], v[228:231]
    v_mfma_f32_16x16x32_bf16 v[232:235], v[52:55], a[56:59], v[232:235]
    v_mfma_f32_16x16x32_bf16 v[236:239], v[52:55], a[128:131], v[236:239]
    s_waitcnt lgkmcnt(4)
    v_mfma_f32_16x16x32_bf16 v[208:211], v[56:59], v[124:127], v[208:211]
    v_mfma_f32_16x16x32_bf16 v[212:215], v[56:59], v[196:199], v[212:215]
    v_mfma_f32_16x16x32_bf16 v[216:219], v[60:63], v[124:127], v[216:219]
    v_mfma_f32_16x16x32_bf16 v[220:223], v[60:63], v[196:199], v[220:223]
    v_mfma_f32_16x16x32_bf16 v[224:227], v[56:59], a[60:63], v[224:227]
    v_mfma_f32_16x16x32_bf16 v[228:231], v[56:59], a[132:135], v[228:231]
    v_mfma_f32_16x16x32_bf16 v[232:235], v[60:63], a[60:63], v[232:235]
    v_mfma_f32_16x16x32_bf16 v[236:239], v[60:63], a[132:135], v[236:239]
    s_waitcnt lgkmcnt(2)
    v_mfma_f32_16x16x32_bf16 v[208:211], v[32:35], v[128:131], v[208:211]
    v_mfma_f32_16x16x32_bf16 v[212:215], v[32:35], v[200:203], v[212:215]
    v_mfma_f32_16x16x32_bf16 v[216:219], v[36:39], v[128:131], v[216:219]
    v_mfma_f32_16x16x32_bf16 v[220:223], v[36:39], v[200:203], v[220:223]
    v_mfma_f32_16x16x32_bf16 v[224:227], v[32:35], a[64:67], v[224:227]
    v_mfma_f32_16x16x32_bf16 v[228:231], v[32:35], a[136:139], v[228:231]
    v_mfma_f32_16x16x32_bf16 v[232:235], v[36:39], a[64:67], v[232:235]
    v_mfma_f32_16x16x32_bf16 v[236:239], v[36:39], a[136:139], v[236:239]
    s_waitcnt lgkmcnt(0)
    v_mfma_f32_16x16x32_bf16 v[208:211], v[40:43], v[132:135], v[208:211]
    v_mfma_f32_16x16x32_bf16 v[212:215], v[40:43], v[204:207], v[212:215]
    v_mfma_f32_16x16x32_bf16 v[216:219], v[44:47], v[132:135], v[216:219]
    v_mfma_f32_16x16x32_bf16 v[220:223], v[44:47], v[204:207], v[220:223]
    v_mfma_f32_16x16x32_bf16 v[224:227], v[40:43], a[68:71], v[224:227]
    v_mfma_f32_16x16x32_bf16 v[228:231], v[40:43], a[140:143], v[228:231]
    v_mfma_f32_16x16x32_bf16 v[232:235], v[44:47], a[68:71], v[232:235]
    v_mfma_f32_16x16x32_bf16 v[236:239], v[44:47], a[140:143], v[236:239]
    s_waitcnt vmcnt(0)
    v_cvt_pk_bf16_f32 v8, v208, v209
    v_cvt_pk_bf16_f32 v9, v210, v211
    v_cvt_pk_bf16_f32 v10, v216, v217
    v_cvt_pk_bf16_f32 v11, v218, v219
    s_lshr_b32 s22, s13, 5
    s_mul_i32 s22, s22, 0
    s_add_u32 s28, s26, s22
    buffer_store_dwordx4 v[8:11], v7, s[4:7], s28 offen sc1
    v_cvt_pk_bf16_f32 v12, v212, v213
    v_cvt_pk_bf16_f32 v13, v214, v215
    v_cvt_pk_bf16_f32 v14, v220, v221
    v_cvt_pk_bf16_f32 v15, v222, v223
    s_lshr_b32 s22, s13, 5
    s_mul_i32 s22, s22, 0
    s_add_u32 s28, s26, s22
    s_add_u32 s28, s28, s12
    buffer_store_dwordx4 v[12:15], v7, s[4:7], s28 offen sc1
    v_cvt_pk_bf16_f32 v16, v224, v225
    v_cvt_pk_bf16_f32 v17, v226, v227
    v_cvt_pk_bf16_f32 v18, v232, v233
    v_cvt_pk_bf16_f32 v19, v234, v235
    s_lshr_b32 s22, s13, 5
    s_mul_i32 s22, s22, 1
    s_add_u32 s28, s26, s22
    buffer_store_dwordx4 v[16:19], v7, s[4:7], s28 offen sc1
    v_cvt_pk_bf16_f32 v20, v228, v229
    v_cvt_pk_bf16_f32 v21, v230, v231
    v_cvt_pk_bf16_f32 v22, v236, v237
    v_cvt_pk_bf16_f32 v23, v238, v239
    s_lshr_b32 s22, s13, 5
    s_mul_i32 s22, s22, 1
    s_add_u32 s28, s26, s22
    s_add_u32 s28, s28, s12
    buffer_store_dwordx4 v[20:23], v7, s[4:7], s28 offen sc1
    s_add_u32 s26, s26, s13
    s_add_u32 s27, s27, 36864
    s_cmp_eq_u32 s27, 110592
    s_cselect_b32 s27, 0, s27
    s_add_u32 s19, s19, 1
    s_cmp_lt_u32 s19, s20
    s_cbranch_scc1 qk_vloop
qk_done:
    s_waitcnt vmcnt(0)
    s_barrier
    s_add_u32 s23, s19, s95
    v_mov_b32 v4, s23
    s_mov_b64 exec, s[34:35]
    buffer_store_dword v4, off, s[4:7], s29 sc1
    buffer_store_dword v4, off, s[4:7], s29 offset:128 sc1
    s_mov_b64 exec, -1
    s_cmp_eq_u32 s16, 0
    s_cbranch_scc1 L_qkv_next
    s_cmp_lg_u32 s19, 16
    s_cbranch_scc1 L_qkv_next
    v_and_b32 v4, 63, v0
    v_and_b32 v2, 7, v4
    v_lshrrev_b32 v5, 4, v4
    v_lshlrev_b32 v2, 4, v2
    v_lshrrev_b32 v3, 1, v5
    v_lshl_add_u32 v2, v3, 8, v2
    v_and_b32 v3, 1, v5
    v_lshl_add_u32 v2, v3, 3, v2
    s_lshl_b32 s27, s17, 2
    s_or_b32 s27, s27, s18
    s_lshl_b32 s27, s27, 2
    s_or_b32 s27, s27, s16
    v_and_b32 v3, 31, v4
    v_lshlrev_b32 v3, 7, v3
    s_mov_b32 s28, 0
    v_bfe_u32 v240, v4, 3, 1
    v_lshrrev_b32 v241, 5, v4
    v_and_b32 v242, 0xdff, v7
    s_cmp_eq_u32 s16, 2
    s_cbranch_scc1 mk_isv
    v_mov_b32 v241, v240
    v_or_b32 v242, 128, v7
mk_isv:
    v_lshlrev_b32 v241, 17, v241
    v_mul_u32_u24 v240, 9216, v240
    s_mov_b32 s19, 0
    s_mov_b32 s24, 138412032
    s_lshl_b32 s26, s17, 12
    s_mov_b32 s21, 69206016
    s_cmp_eq_u32 s16, 2
    s_cselect_b32 s21, 77594624, s21
    s_add_u32 s26, s26, s21
    s_lshl_b32 s29, s17, 7
    s_lshl_b32 s21, s16, 2
    s_add_u32 s29, s29, s21
    s_add_u32 s29, s29, 125829164
mk_loop:
    s_add_u32 s22, s19, s95
    s_add_u32 s22, s22, 1
    s_cmp_lg_u32 s18, 0
    s_cbranch_scc1 mk_go
    s_cmp_lt_u32 s19, s28
    s_cbranch_scc1 mk_go
    s_mov_b32 s23, 125853696
    s_mov_b32 s21, 4194304
mk_wait:
    buffer_load_dword v4, off, s[4:7], s23 sc1
    s_sub_u32 s21, s21, 1
    s_cbranch_scc1 mk_go
    s_waitcnt vmcnt(0)
    v_readfirstlane_b32 s28, v4
    s_nop 0
    s_sub_u32 s28, s28, s95
    s_cmp_gt_u32 s28, 64
    s_cselect_b32 s28, 0, s28
    s_cmp_lt_u32 s19, s28
    s_cbranch_scc1 mk_go
    s_sleep 2
    s_branch mk_wait
mk_go:
    s_add_u32 s21, s19, 1
    s_cmp_lt_u32 s21, s28
    s_cselect_b32 s21, 1, 0
    v_mov_b32 v4, s21
    v_mov_b32 v5, 163824
    s_mov_b64 exec, s[34:35]
    ds_write_b32 v5, v4
    s_mov_b64 exec, -1
    s_waitcnt lgkmcnt(0)
    s_barrier
    ds_read_b32 v4, v5
    s_waitcnt lgkmcnt(0)
    v_readfirstlane_b32 s30, v4
    v_mul_u32_u24 v5, v4, v240
    v_add_u32 v5, v5, v2
    v_mul_lo_u32 v1, v4, v241
    v_add_u32 v1, v1, v242
    s_add_u32 s21, s24, 4096
    s_add_u32 s23, s24, 8192
    buffer_load_dwordx2 v[24:25], v5, s[4:7], s24 offen offset:0 sc1
    buffer_load_dwordx2 v[26:27], v5, s[4:7], s24 offen offset:128 sc1
    buffer_load_dwordx2 v[28:29], v5, s[4:7], s24 offen offset:512 sc1
    buffer_load_dwordx2 v[30:31], v5, s[4:7], s24 offen offset:640 sc1
    buffer_load_dwordx2 v[32:33], v5, s[4:7], s21 offen offset:0 sc1
    buffer_load_dwordx2 v[34:35], v5, s[4:7], s21 offen offset:128 sc1
    buffer_load_dwordx2 v[36:37], v5, s[4:7], s21 offen offset:512 sc1
    buffer_load_dwordx2 v[38:39], v5, s[4:7], s21 offen offset:640 sc1
    buffer_load_dwordx2 v[40:41], v5, s[4:7], s24 offen offset:1024 sc1
    buffer_load_dwordx2 v[42:43], v5, s[4:7], s24 offen offset:1152 sc1
    buffer_load_dwordx2 v[44:45], v5, s[4:7], s24 offen offset:1536 sc1
    buffer_load_dwordx2 v[46:47], v5, s[4:7], s24 offen offset:1664 sc1
    buffer_load_dwordx2 v[48:49], v5, s[4:7], s21 offen offset:1024 sc1
    buffer_load_dwordx2 v[50:51], v5, s[4:7], s21 offen offset:1152 sc1
    buffer_load_dwordx2 v[52:53], v5, s[4:7], s21 offen offset:1536 sc1
    buffer_load_dwordx2 v[54:55], v5, s[4:7], s21 offen offset:1664 sc1
    buffer_load_dwordx2 v[56:57], v5, s[4:7], s24 offen offset:2048 sc1
    buffer_load_dwordx2 v[58:59], v5, s[4:7], s24 offen offset:2176 sc1
    buffer_load_dwordx2 v[60:61], v5, s[4:7], s24 offen offset:2560 sc1
    buffer_load_dwordx2 v[62:63], v5, s[4:7], s24 offen offset:2688 sc1
    buffer_load_dwordx2 v[208:209], v5, s[4:7], s21 offen offset:2048 sc1
    buffer_load_dwordx2 v[210:211], v5, s[4:7], s21 offen offset:2176 sc1
    buffer_load_dwordx2 v[212:213], v5, s[4:7], s21 offen offset:2560 sc1
    buffer_load_dwordx2 v[214:215], v5, s[4:7], s21 offen offset:2688 sc1
    buffer_load_dwordx2 v[216:217], v5, s[4:7], s24 offen offset:3072 sc1
    buffer_load_dwordx2 v[218:219], v5, s[4:7], s24 offen offset:3200 sc1
    buffer_load_dwordx2 v[220:221], v5, s[4:7], s24 offen offset:3584 sc1
    buffer_load_dwordx2 v[222:223], v5, s[4:7], s24 offen offset:3712 sc1
    buffer_load_dwordx2 v[224:225], v5, s[4:7], s21 offen offset:3072 sc1
    buffer_load_dwordx2 v[226:227], v5, s[4:7], s21 offen offset:3200 sc1
    buffer_load_dwordx2 v[228:229], v5, s[4:7], s21 offen offset:3584 sc1
    buffer_load_dwordx2 v[230:231], v5, s[4:7], s21 offen offset:3712 sc1
    buffer_load_dwordx2 v[232:233], v5, s[4:7], s23 offen offset:0 sc1
    buffer_load_dwordx2 v[234:235], v5, s[4:7], s23 offen offset:128 sc1
    buffer_load_dwordx2 v[236:237], v5, s[4:7], s23 offen offset:512 sc1
    buffer_load_dwordx2 v[238:239], v5, s[4:7], s23 offen offset:640 sc1
    s_add_u32 s24, s24, 8192
    s_mul_i32 s21, s30, 9216
    s_add_u32 s24, s24, 1024
    s_add_u32 s24, s24, s21
    s_add_u32 s22, s22, s30
    s_cmp_eq_u32 s16, 2
    s_cbranch_scc1 mk_v
    s_waitcnt vmcnt(34)
    v_swap_b32 v25, v26
    s_nop 1
    v_mfma_f32_16x16x32_bf16 v[8:11], v[64:67], v[24:27], 0
    v_mfma_f32_16x16x32_bf16 v[12:15], v[136:139], v[24:27], 0
    v_mfma_f32_16x16x32_bf16 v[16:19], a[0:3], v[24:27], 0
    v_mfma_f32_16x16x32_bf16 v[20:23], a[72:75], v[24:27], 0
    s_waitcnt vmcnt(32)
    v_swap_b32 v29, v30
    s_nop 1
    v_mfma_f32_16x16x32_bf16 v[8:11], v[68:71], v[28:31], v[8:11]
    v_mfma_f32_16x16x32_bf16 v[12:15], v[140:143], v[28:31], v[12:15]
    v_mfma_f32_16x16x32_bf16 v[16:19], a[4:7], v[28:31], v[16:19]
    v_mfma_f32_16x16x32_bf16 v[20:23], a[76:79], v[28:31], v[20:23]
    s_waitcnt vmcnt(30)
    v_swap_b32 v33, v34
    s_nop 1
    v_mfma_f32_16x16x32_bf16 v[8:11], v[72:75], v[32:35], v[8:11]
    v_mfma_f32_16x16x32_bf16 v[12:15], v[144:147], v[32:35], v[12:15]
    v_mfma_f32_16x16x32_bf16 v[16:19], a[8:11], v[32:35], v[16:19]
    v_mfma_f32_16x16x32_bf16 v[20:23], a[80:83], v[32:35], v[20:23]
    s_waitcnt vmcnt(28)
    v_swap_b32 v37, v38
    s_nop 1
    v_mfma_f32_16x16x32_bf16 v[8:11], v[76:79], v[36:39], v[8:11]
    v_mfma_f32_16x16x32_bf16 v[12:15], v[148:151], v[36:39], v[12:15]
    v_mfma_f32_16x16x32_bf16 v[16:19], a[12:15], v[36:39], v[16:19]
    v_mfma_f32_16x16x32_bf16 v[20:23], a[84:87], v[36:39], v[20:23]
    s_waitcnt vmcnt(26)
    v_swap_b32 v41, v42
    s_nop 1
    v_mfma_f32_16x16x32_bf16 v[8:11], v[80:83], v[40:43], v[8:11]
    v_mfma_f32_16x16x32_bf16 v[12:15], v[152:155], v[40:43], v[12:15]
    v_mfma_f32_16x16x32_bf16 v[16:19], a[16:19], v[40:43], v[16:19]
    v_mfma_f32_16x16x32_bf16 v[20:23], a[88:91], v[40:43], v[20:23]
    s_waitcnt vmcnt(24)
    v_swap_b32 v45, v46
    s_nop 1
    v_mfma_f32_16x16x32_bf16 v[8:11], v[84:87], v[44:47], v[8:11]
    v_mfma_f32_16x16x32_bf16 v[12:15], v[156:159], v[44:47], v[12:15]
    v_mfma_f32_16x16x32_bf16 v[16:19], a[20:23], v[44:47], v[16:19]
    v_mfma_f32_16x16x32_bf16 v[20:23], a[92:95], v[44:47], v[20:23]
    s_waitcnt vmcnt(22)
    v_swap_b32 v49, v50
    s_nop 1
    v_mfma_f32_16x16x32_bf16 v[8:11], v[88:91], v[48:51], v[8:11]
    v_mfma_f32_16x16x32_bf16 v[12:15], v[160:163], v[48:51], v[12:15]
    v_mfma_f32_16x16x32_bf16 v[16:19], a[24:27], v[48:51], v[16:19]
    v_mfma_f32_16x16x32_bf16 v[20:23], a[96:99], v[48:51], v[20:23]
    s_waitcnt vmcnt(20)
    v_swap_b32 v53, v54
    s_nop 1
    v_mfma_f32_16x16x32_bf16 v[8:11], v[92:95], v[52:55], v[8:11]
    v_mfma_f32_16x16x32_bf16 v[12:15], v[164:167], v[52:55], v[12:15]
    v_mfma_f32_16x16x32_bf16 v[16:19], a[28:31], v[52:55], v[16:19]
    v_mfma_f32_16x16x32_bf16 v[20:23], a[100:103], v[52:55], v[20:23]
    s_waitcnt vmcnt(18)
    v_swap_b32 v57, v58
    s_nop 1
    v_mfma_f32_16x16x32_bf16 v[8:11], v[96:99], v[56:59], v[8:11]
    v_mfma_f32_16x16x32_bf16 v[12:15], v[168:171], v[56:59], v[12:15]
    v_mfma_f32_16x16x32_bf16 v[16:19], a[32:35], v[56:59], v[16:19]
    v_mfma_f32_16x16x32_bf16 v[20:23], a[104:107], v[56:59], v[20:23]
    s_waitcnt vmcnt(16)
    v_swap_b32 v61, v62
    s_nop 1
    v_mfma_f32_16x16x32_bf16 v[8:11], v[100:103], v[60:63], v[8:11]
    v_mfma_f32_16x16x32_bf16 v[12:15], v[172:175], v[60:63], v[12:15]
    v_mfma_f32_16x16x32_bf16 v[16:19], a[36:39], v[60:63], v[16:19]
    v_mfma_f32_16x16x32_bf16 v[20:23], a[108:111], v[60:63], v[20:23]
    s_waitcnt vmcnt(14)
    v_swap_b32 v209, v210
    s_nop 1
    v_mfma_f32_16x16x32_bf16 v[8:11], v[104:107], v[208:211], v[8:11]
    v_mfma_f32_16x16x32_bf16 v[12:15], v[176:179], v[208:211], v[12:15]
    v_mfma_f32_16x16x32_bf16 v[16:19], a[40:43], v[208:211], v[16:19]
    v_mfma_f32_16x16x32_bf16 v[20:23], a[112:115], v[208:211], v[20:23]
    s_waitcnt vmcnt(12)
    v_swap_b32 v213, v214
    s_nop 1
    v_mfma_f32_16x16x32_bf16 v[8:11], v[108:111], v[212:215], v[8:11]
    v_mfma_f32_16x16x32_bf16 v[12:15], v[180:183], v[212:215], v[12:15]
    v_mfma_f32_16x16x32_bf16 v[16:19], a[44:47], v[212:215], v[16:19]
    v_mfma_f32_16x16x32_bf16 v[20:23], a[116:119], v[212:215], v[20:23]
    s_waitcnt vmcnt(10)
    v_swap_b32 v217, v218
    s_nop 1
    v_mfma_f32_16x16x32_bf16 v[8:11], v[112:115], v[216:219], v[8:11]
    v_mfma_f32_16x16x32_bf16 v[12:15], v[184:187], v[216:219], v[12:15]
    v_mfma_f32_16x16x32_bf16 v[16:19], a[48:51], v[216:219], v[16:19]
    v_mfma_f32_16x16x32_bf16 v[20:23], a[120:123], v[216:219], v[20:23]
    s_waitcnt vmcnt(8)
    v_swap_b32 v221, v222
    s_nop 1
    v_mfma_f32_16x16x32_bf16 v[8:11], v[116:119], v[220:223], v[8:11]
    v_mfma_f32_16x16x32_bf16 v[12:15], v[188:191], v[220:223], v[12:15]
    v_mfma_f32_16x16x32_bf16 v[16:19], a[52:55], v[220:223], v[16:19]
    v_mfma_f32_16x16x32_bf16 v[20:23], a[124:127], v[220:223], v[20:23]
    s_waitcnt vmcnt(6)
    v_swap_b32 v225, v226
    s_nop 1
    v_mfma_f32_16x16x32_bf16 v[8:11], v[120:123], v[224:227], v[8:11]
    v_mfma_f32_16x16x32_bf16 v[12:15], v[192:195], v[224:227], v[12:15]
    v_mfma_f32_16x16x32_bf16 v[16:19], a[56:59], v[224:227], v[16:19]
    v_mfma_f32_16x16x32_bf16 v[20:23], a[128:131], v[224:227], v[20:23]
    s_waitcnt vmcnt(4)
    v_swap_b32 v229, v230
    s_nop 1
    v_mfma_f32_16x16x32_bf16 v[8:11], v[124:127], v[228:231], v[8:11]
    v_mfma_f32_16x16x32_bf16 v[12:15], v[196:199], v[228:231], v[12:15]
    v_mfma_f32_16x16x32_bf16 v[16:19], a[60:63], v[228:231], v[16:19]
    v_mfma_f32_16x16x32_bf16 v[20:23], a[132:135], v[228:231], v[20:23]
    s_waitcnt vmcnt(2)
    v_swap_b32 v233, v234
    s_nop 1
    v_mfma_f32_16x16x32_bf16 v[8:11], v[128:131], v[232:235], v[8:11]
    v_mfma_f32_16x16x32_bf16 v[12:15], v[200:203], v[232:235], v[12:15]
    v_mfma_f32_16x16x32_bf16 v[16:19], a[64:67], v[232:235], v[16:19]
    v_mfma_f32_16x16x32_bf16 v[20:23], a[136:139], v[232:235], v[20:23]
    s_waitcnt vmcnt(0)
    v_swap_b32 v237, v238
    s_nop 1
    v_mfma_f32_16x16x32_bf16 v[8:11], v[132:135], v[236:239], v[8:11]
    v_mfma_f32_16x16x32_bf16 v[12:15], v[204:207], v[236:239], v[12:15]
    v_mfma_f32_16x16x32_bf16 v[16:19], a[68:71], v[236:239], v[16:19]
    v_mfma_f32_16x16x32_bf16 v[20:23], a[140:143], v[236:239], v[20:23]
    s_nop 5
    v_cvt_pk_bf16_f32 v24, v8, v12
    v_cvt_pk_bf16_f32 v25, v9, v13
    v_cvt_pk_bf16_f32 v26, v10, v14
    v_cvt_pk_bf16_f32 v27, v11, v15
    v_cvt_pk_bf16_f32 v28, v16, v20
    v_cvt_pk_bf16_f32 v29, v17, v21
    v_cvt_pk_bf16_f32 v30, v18, v22
    v_cvt_pk_bf16_f32 v31, v19, v23
    s_nop 1
    s_branch mk_st
mk_v:
    s_waitcnt vmcnt(34)
    v_swap_b32 v25, v26
    s_nop 1
    v_mfma_f32_16x16x32_bf16 v[8:11], v[24:27], v[64:67], 0
    v_mfma_f32_16x16x32_bf16 v[12:15], v[24:27], v[136:139], 0
    v_mfma_f32_16x16x32_bf16 v[16:19], v[24:27], a[0:3], 0
    v_mfma_f32_16x16x32_bf16 v[20:23], v[24:27], a[72:75], 0
    s_waitcnt vmcnt(32)
    v_swap_b32 v29, v30
    s_nop 1
    v_mfma_f32_16x16x32_bf16 v[8:11], v[28:31], v[68:71], v[8:11]
    v_mfma_f32_16x16x32_bf16 v[12:15], v[28:31], v[140:143], v[12:15]
    v_mfma_f32_16x16x32_bf16 v[16:19], v[28:31], a[4:7], v[16:19]
    v_mfma_f32_16x16x32_bf16 v[20:23], v[28:31], a[76:79], v[20:23]
    s_waitcnt vmcnt(30)
    v_swap_b32 v33, v34
    s_nop 1
    v_mfma_f32_16x16x32_bf16 v[8:11], v[32:35], v[72:75], v[8:11]
    v_mfma_f32_16x16x32_bf16 v[12:15], v[32:35], v[144:147], v[12:15]
    v_mfma_f32_16x16x32_bf16 v[16:19], v[32:35], a[8:11], v[16:19]
    v_mfma_f32_16x16x32_bf16 v[20:23], v[32:35], a[80:83], v[20:23]
    s_waitcnt vmcnt(28)
    v_swap_b32 v37, v38
    s_nop 1
    v_mfma_f32_16x16x32_bf16 v[8:11], v[36:39], v[76:79], v[8:11]
    v_mfma_f32_16x16x32_bf16 v[12:15], v[36:39], v[148:151], v[12:15]
    v_mfma_f32_16x16x32_bf16 v[16:19], v[36:39], a[12:15], v[16:19]
    v_mfma_f32_16x16x32_bf16 v[20:23], v[36:39], a[84:87], v[20:23]
    s_waitcnt vmcnt(26)
    v_swap_b32 v41, v42
    s_nop 1
    v_mfma_f32_16x16x32_bf16 v[8:11], v[40:43], v[80:83], v[8:11]
    v_mfma_f32_16x16x32_bf16 v[12:15], v[40:43], v[152:155], v[12:15]
    v_mfma_f32_16x16x32_bf16 v[16:19], v[40:43], a[16:19], v[16:19]
    v_mfma_f32_16x16x32_bf16 v[20:23], v[40:43], a[88:91], v[20:23]
    s_waitcnt vmcnt(24)
    v_swap_b32 v45, v46
    s_nop 1
    v_mfma_f32_16x16x32_bf16 v[8:11], v[44:47], v[84:87], v[8:11]
    v_mfma_f32_16x16x32_bf16 v[12:15], v[44:47], v[156:159], v[12:15]
    v_mfma_f32_16x16x32_bf16 v[16:19], v[44:47], a[20:23], v[16:19]
    v_mfma_f32_16x16x32_bf16 v[20:23], v[44:47], a[92:95], v[20:23]
    s_waitcnt vmcnt(22)
    v_swap_b32 v49, v50
    s_nop 1
    v_mfma_f32_16x16x32_bf16 v[8:11], v[48:51], v[88:91], v[8:11]
    v_mfma_f32_16x16x32_bf16 v[12:15], v[48:51], v[160:163], v[12:15]
    v_mfma_f32_16x16x32_bf16 v[16:19], v[48:51], a[24:27], v[16:19]
    v_mfma_f32_16x16x32_bf16 v[20:23], v[48:51], a[96:99], v[20:23]
    s_waitcnt vmcnt(20)
    v_swap_b32 v53, v54
    s_nop 1
    v_mfma_f32_16x16x32_bf16 v[8:11], v[52:55], v[92:95], v[8:11]
    v_mfma_f32_16x16x32_bf16 v[12:15], v[52:55], v[164:167], v[12:15]
    v_mfma_f32_16x16x32_bf16 v[16:19], v[52:55], a[28:31], v[16:19]
    v_mfma_f32_16x16x32_bf16 v[20:23], v[52:55], a[100:103], v[20:23]
    s_waitcnt vmcnt(18)
    v_swap_b32 v57, v58
    s_nop 1
    v_mfma_f32_16x16x32_bf16 v[8:11], v[56:59], v[96:99], v[8:11]
    v_mfma_f32_16x16x32_bf16 v[12:15], v[56:59], v[168:171], v[12:15]
    v_mfma_f32_16x16x32_bf16 v[16:19], v[56:59], a[32:35], v[16:19]
    v_mfma_f32_16x16x32_bf16 v[20:23], v[56:59], a[104:107], v[20:23]
    s_waitcnt vmcnt(16)
    v_swap_b32 v61, v62
    s_nop 1
    v_mfma_f32_16x16x32_bf16 v[8:11], v[60:63], v[100:103], v[8:11]
    v_mfma_f32_16x16x32_bf16 v[12:15], v[60:63], v[172:175], v[12:15]
    v_mfma_f32_16x16x32_bf16 v[16:19], v[60:63], a[36:39], v[16:19]
    v_mfma_f32_16x16x32_bf16 v[20:23], v[60:63], a[108:111], v[20:23]
    s_waitcnt vmcnt(14)
    v_swap_b32 v209, v210
    s_nop 1
    v_mfma_f32_16x16x32_bf16 v[8:11], v[208:211], v[104:107], v[8:11]
    v_mfma_f32_16x16x32_bf16 v[12:15], v[208:211], v[176:179], v[12:15]
    v_mfma_f32_16x16x32_bf16 v[16:19], v[208:211], a[40:43], v[16:19]
    v_mfma_f32_16x16x32_bf16 v[20:23], v[208:211], a[112:115], v[20:23]
    s_waitcnt vmcnt(12)
    v_swap_b32 v213, v214
    s_nop 1
    v_mfma_f32_16x16x32_bf16 v[8:11], v[212:215], v[108:111], v[8:11]
    v_mfma_f32_16x16x32_bf16 v[12:15], v[212:215], v[180:183], v[12:15]
    v_mfma_f32_16x16x32_bf16 v[16:19], v[212:215], a[44:47], v[16:19]
    v_mfma_f32_16x16x32_bf16 v[20:23], v[212:215], a[116:119], v[20:23]
    s_waitcnt vmcnt(10)
    v_swap_b32 v217, v218
    s_nop 1
    v_mfma_f32_16x16x32_bf16 v[8:11], v[216:219], v[112:115], v[8:11]
    v_mfma_f32_16x16x32_bf16 v[12:15], v[216:219], v[184:187], v[12:15]
    v_mfma_f32_16x16x32_bf16 v[16:19], v[216:219], a[48:51], v[16:19]
    v_mfma_f32_16x16x32_bf16 v[20:23], v[216:219], a[120:123], v[20:23]
    s_waitcnt vmcnt(8)
    v_swap_b32 v221, v222
    s_nop 1
    v_mfma_f32_16x16x32_bf16 v[8:11], v[220:223], v[116:119], v[8:11]
    v_mfma_f32_16x16x32_bf16 v[12:15], v[220:223], v[188:191], v[12:15]
    v_mfma_f32_16x16x32_bf16 v[16:19], v[220:223], a[52:55], v[16:19]
    v_mfma_f32_16x16x32_bf16 v[20:23], v[220:223], a[124:127], v[20:23]
    s_waitcnt vmcnt(6)
    v_swap_b32 v225, v226
    s_nop 1
    v_mfma_f32_16x16x32_bf16 v[8:11], v[224:227], v[120:123], v[8:11]
    v_mfma_f32_16x16x32_bf16 v[12:15], v[224:227], v[192:195], v[12:15]
    v_mfma_f32_16x16x32_bf16 v[16:19], v[224:227], a[56:59], v[16:19]
    v_mfma_f32_16x16x32_bf16 v[20:23], v[224:227], a[128:131], v[20:23]
    s_waitcnt vmcnt(4)
    v_swap_b32 v229, v230
    s_nop 1
    v_mfma_f32_16x16x32_bf16 v[8:11], v[228:231], v[124:127], v[8:11]
    v_mfma_f32_16x16x32_bf16 v[12:15], v[228:231], v[196:199], v[12:15]
    v_mfma_f32_16x16x32_bf16 v[16:19], v[228:231], a[60:63], v[16:19]
    v_mfma_f32_16x16x32_bf16 v[20:23], v[228:231], a[132:135], v[20:23]
    s_waitcnt vmcnt(2)
    v_swap_b32 v233, v234
    s_nop 1
    v_mfma_f32_16x16x32_bf16 v[8:11], v[232:235], v[128:131], v[8:11]
    v_mfma_f32_16x16x32_bf16 v[12:15], v[232:235], v[200:203], v[12:15]
    v_mfma_f32_16x16x32_bf16 v[16:19], v[232:235], a[64:67], v[16:19]
    v_mfma_f32_16x16x32_bf16 v[20:23], v[232:235], a[136:139], v[20:23]
    s_waitcnt vmcnt(0)
    v_swap_b32 v237, v238
    s_nop 1
    v_mfma_f32_16x16x32_bf16 v[8:11], v[236:239], v[132:135], v[8:11]
    v_mfma_f32_16x16x32_bf16 v[12:15], v[236:239], v[204:207], v[12:15]
    v_mfma_f32_16x16x32_bf16 v[16:19], v[236:239], a[68:71], v[16:19]
    v_mfma_f32_16x16x32_bf16 v[20:23], v[236:239], a[140:143], v[20:23]
    s_nop 4
    v_pk_mul_f32 v[8:9], v[8:9], 0.5 op_sel_hi:[1,0]
    v_pk_mul_f32 v[10:11], v[10:11], 0.5 op_sel_hi:[1,0]
    v_pk_mul_f32 v[12:13], v[12:13], 0.5 op_sel_hi:[1,0]
    v_pk_mul_f32 v[14:15], v[14:15], 0.5 op_sel_hi:[1,0]
    v_pk_mul_f32 v[16:17], v[16:17], 0.5 op_sel_hi:[1,0]
    v_pk_mul_f32 v[18:19], v[18:19], 0.5 op_sel_hi:[1,0]
    v_pk_mul_f32 v[20:21], v[20:21], 0.5 op_sel_hi:[1,0]
    v_pk_mul_f32 v[22:23], v[22:23], 0.5 op_sel_hi:[1,0]
    v_cvt_pk_bf16_f32 v24, v8, v9
    v_cvt_pk_bf16_f32 v25, v10, v11
    v_cvt_pk_bf16_f32 v26, v12, v13
    v_cvt_pk_bf16_f32 v27, v14, v15
    v_cvt_pk_bf16_f32 v28, v16, v17
    v_cvt_pk_bf16_f32 v29, v18, v19
    v_cvt_pk_bf16_f32 v30, v20, v21
    v_cvt_pk_bf16_f32 v31, v22, v23
mk_st:
    s_nop 1
    s_add_u32 s21, s26, 4096
    buffer_store_dwordx4 v[24:27], v1, s[4:7], s26 offen sc1
    buffer_store_dwordx4 v[28:31], v1, s[4:7], s21 offen sc1
    s_waitcnt vmcnt(0)
    s_barrier
    v_mov_b32 v4, s22
    s_mov_b64 exec, s[34:35]
    buffer_store_dword v4, off, s[4:7], s29 sc1
    buffer_store_dword v4, off, s[4:7], s29 offset:128 sc1
    s_mov_b64 exec, -1
    s_add_u32 s21, s30, 1
    s_add_u32 s19, s19, s21
    s_lshl_b32 s21, s21, 17
    s_add_u32 s26, s26, s21
    s_cmp_lt_u32 s19, 64
    s_cbranch_scc1 mk_loop
    s_endpgm
L_ssm_next:
    s_mov_b32 s37, 8
    v_mov_b32 v250, 1
    v_mov_b32 v251, 163832
    v_cmp_eq_u32 vcc, 0, v0
    s_nop 0
    s_and_saveexec_b64 s[38:39], vcc
    s_cbranch_execz tk12
    buffer_atomic_add v250, off, s[84:87], s37 sc0
    s_waitcnt vmcnt(0)
    ds_write_b32 v251, v250
    s_waitcnt lgkmcnt(0)
tk12:
    s_mov_b64 exec, -1
    s_barrier
    ds_read_b32 v252, v251
    s_waitcnt lgkmcnt(0)
    v_readfirstlane_b32 s20, v252
    s_barrier
    s_nop 3
    s_cmp_ge_u32 s20, 144
    s_cbranch_scc1 L_wf_next
    s_lshl_b32 s20, s20, 2
    v_lshrrev_b32 v5, 6, v0
    s_nop 0
    v_readfirstlane_b32 s21, v5
    v_and_b32 v1, 63, v0
    v_and_b32 v2, 15, v1
    v_lshrrev_b32 v3, 4, v1
    v_lshlrev_b32 v4, 14, v5
    s_mov_b32 s8, s62
    s_mov_b32 s9, s63
    s_mov_b32 s10, 2359296
    s_mov_b32 s11, 0x20000
    s_mov_b32 s16, s76
    s_mov_b32 s17, s77
    s_mov_b32 s18, 4718592
    s_mov_b32 s19, 0x20000
    v_mul_u32_u24 v5, 9216, v0
    s_lshl_b32 s22, s20, 1
    s_add_u32 s23, s22, 0
    buffer_load_dwordx2 v[8:9], v5, s[8:11], s23 offen
    s_add_u32 s23, s22, 1152
    buffer_load_dwordx2 v[10:11], v5, s[8:11], s23 offen
    s_add_u32 s23, s22, 2304
    buffer_load_dwordx2 v[12:13], v5, s[8:11], s23 offen
    s_add_u32 s23, s22, 3456
    buffer_load_dwordx2 v[14:15], v5, s[8:11], s23 offen
    s_add_u32 s23, s22, 4608
    buffer_load_dwordx2 v[16:17], v5, s[8:11], s23 offen
    s_add_u32 s23, s22, 5760
    buffer_load_dwordx2 v[18:19], v5, s[8:11], s23 offen
    s_add_u32 s23, s22, 6912
    buffer_load_dwordx2 v[20:21], v5, s[8:11], s23 offen
    s_add_u32 s23, s22, 8064
    buffer_load_dwordx2 v[22:23], v5, s[8:11], s23 offen
    s_add_u32 s22, s20, s21
    s_lshl_b32 s23, s22, 8
    v_lshlrev_b32 v6, 3, v2
    v_lshl_add_u32 v6, v3, 1, v6
    s_mov_b32 s12, s64
    s_mov_b32 s13, s65
    s_mov_b32 s14, 147456
    s_mov_b32 s15, 0x20000
    buffer_load_ushort v24, v6, s[12:15], s23 offen offset:0
    buffer_load_ushort v28, v6, s[12:15], s23 offen offset:128
    s_mov_b32 s12, s66
    s_mov_b32 s13, s67
    s_mov_b32 s14, 147456
    s_mov_b32 s15, 0x20000
    buffer_load_ushort v25, v6, s[12:15], s23 offen offset:0
    buffer_load_ushort v29, v6, s[12:15], s23 offen offset:128
    s_mov_b32 s12, s68
    s_mov_b32 s13, s69
    s_mov_b32 s14, 147456
    s_mov_b32 s15, 0x20000
    buffer_load_ushort v26, v6, s[12:15], s23 offen offset:0
    buffer_load_ushort v30, v6, s[12:15], s23 offen offset:128
    s_mov_b32 s12, s70
    s_mov_b32 s13, s71
    s_mov_b32 s14, 147456
    s_mov_b32 s15, 0x20000
    buffer_load_ushort v27, v6, s[12:15], s23 offen offset:0
    buffer_load_ushort v31, v6, s[12:15], s23 offen offset:128
    s_mov_b32 s12, s72
    s_mov_b32 s13, s73
    s_mov_b32 s14, 1152
    s_mov_b32 s15, 0x20000
    s_lshl_b32 s23, s22, 1
    buffer_load_ushort v32, off, s[12:15], s23
    s_mov_b32 s26, 0x3fb8aa3b
    s_mov_b32 s27, 0x3e22f983
    v_mov_b32 v34, 0
    v_mov_b32 v35, 0
    v_lshl_add_u32 v6, v1, 3, v4
    ds_write_b64 v6, v[34:35] offset:0
    s_waitcnt vmcnt(0)
    v_mov_b32 v36, 0x05040100
    v_mov_b32 v37, 0x07060302
    v_lshlrev_b32 v6, 4, v0
    v_perm_b32 v40, v10, v8, v36
    v_perm_b32 v41, v14, v12, v36
    v_perm_b32 v42, v18, v16, v36
    v_perm_b32 v43, v22, v20, v36
    ds_write_b128 v6, v[40:43] offset:512
    s_nop 1
    v_perm_b32 v40, v10, v8, v37
    v_perm_b32 v41, v14, v12, v37
    v_perm_b32 v42, v18, v16, v37
    v_perm_b32 v43, v22, v20, v37
    ds_write_b128 v6, v[40:43] offset:16896
    s_nop 1
    v_perm_b32 v40, v11, v9, v36
    v_perm_b32 v41, v15, v13, v36
    v_perm_b32 v42, v19, v17, v36
    v_perm_b32 v43, v23, v21, v36
    ds_write_b128 v6, v[40:43] offset:33280
    s_nop 1
    v_perm_b32 v40, v11, v9, v37
    v_perm_b32 v41, v15, v13, v37
    v_perm_b32 v42, v19, v17, v37
    v_perm_b32 v43, v23, v21, v37
    ds_write_b128 v6, v[40:43] offset:49664
    s_nop 1
    v_lshlrev_b32 v32, 16, v32
    v_mul_f32 v32, s26, v32
    v_exp_f32 v32, v32
    s_nop 0
    v_cvt_pk_bf16_f32 v32, v32, v32
    v_and_b32 v32, 0xffff0000, v32
    v_add_f32 v33, v32, v32
    v_lshlrev_b32 v24, 16, v24
    v_mul_f32 v24, s26, v24
    v_exp_f32 v24, v24
    s_nop 0
    v_cvt_pk_bf16_f32 v24, v24, v24
    v_and_b32 v24, 0xffff0000, v24
    v_mul_f32 v24, v24, v32
    v_mul_f32 v24, s26, v24
    v_sub_f32 v24, 0, v24
    v_lshlrev_b32 v25, 16, v25
    v_mul_f32 v25, v25, v32
    v_mul_f32 v25, s27, v25
    v_lshlrev_b32 v26, 16, v26
    v_mul_f32 v26, v26, v33
    v_lshlrev_b32 v27, 16, v27
    v_mul_f32 v27, v27, v33
    v_lshlrev_b32 v28, 16, v28
    v_mul_f32 v28, s26, v28
    v_exp_f32 v28, v28
    s_nop 0
    v_cvt_pk_bf16_f32 v28, v28, v28
    v_and_b32 v28, 0xffff0000, v28
    v_mul_f32 v28, v28, v32
    v_mul_f32 v28, s26, v28
    v_sub_f32 v28, 0, v28
    v_lshlrev_b32 v29, 16, v29
    v_mul_f32 v29, v29, v32
    v_mul_f32 v29, s27, v29
    v_lshlrev_b32 v30, 16, v30
    v_mul_f32 v30, v30, v33
    v_lshlrev_b32 v31, 16, v31
    v_mul_f32 v31, v31, v33
    v_cvt_f32_u32 v47, v2
    v_mul_f32 v44, 0x41800000, v47
    v_and_b32 v5, 7, v2
    v_add_u32 v5, 8, v5
    v_cvt_f32_u32 v5, v5
    v_mul_f32 v45, 0x42000000, v5
    v_mul_f32 v6, 0x42800000, v5
    v_cmp_lt_u32 vcc, 7, v2
    s_nop 1
    v_cndmask_b32 v45, v45, v6, vcc
    v_add_f32 v5, 0x41000000, v47
    v_mul_f32 v46, 0x43000000, v5
    v_mov_b32 v48, 0
    v_mov_b32 v49, 0
    v_mov_b32 v50, 0
    v_mov_b32 v51, 0
    v_mov_b32 v52, 0
    v_mov_b32 v53, 0
    v_mov_b32 v54, 0
    v_mov_b32 v55, 0
    v_mov_b32 v56, 0
    v_mov_b32 v57, 0
    v_mov_b32 v58, 0
    v_mov_b32 v59, 0
    v_mov_b32 v60, 0
    v_mov_b32 v61, 0
    v_mov_b32 v62, 0
    v_mov_b32 v63, 0
    v_mov_b32_dpp v64, v24 row_newbcast:0 row_mask:0xf bank_mask:0xf
    v_mov_b32_dpp v65, v25 row_newbcast:0 row_mask:0xf bank_mask:0xf
    v_mov_b32_dpp v66, v26 row_newbcast:0 row_mask:0xf bank_mask:0xf
    v_mov_b32_dpp v67, v27 row_newbcast:0 row_mask:0xf bank_mask:0xf
    v_mul_f32 v82, v64, v47
    v_mul_f32 v83, v65, v47
    v_exp_f32 v82, v82
    v_fract_f32 v83, v83
    v_cos_f32 v74, v83
    v_sin_f32 v75, v83
    v_mul_f32 v74, v74, v82
    v_mul_f32 v75, v75, v82
    v_mul_f32 v84, v75, v75
    v_add_f32 v85, v74, v74
    v_fma_f32 v76, v74, v74, -v84
    v_mul_f32 v77, v85, v75
    v_mul_f32 v84, v77, v77
    v_add_f32 v85, v76, v76
    v_fma_f32 v78, v76, v76, -v84
    v_mul_f32 v79, v85, v77
    v_mul_f32 v84, v79, v79
    v_add_f32 v85, v78, v78
    v_fma_f32 v80, v78, v78, -v84
    v_mul_f32 v81, v85, v79
    v_mul_f32 v82, v64, v44
    v_mul_f32 v83, v65, v44
    v_exp_f32 v82, v82
    v_fract_f32 v83, v83
    v_cos_f32 v68, v83
    v_sin_f32 v69, v83
    v_mul_f32 v68, v68, v82
    v_mul_f32 v69, v69, v82
    v_mul_f32 v84, v67, v69
    v_mul_f32 v85, v67, v68
    v_fma_f32 v68, v66, v68, -v84
    v_fma_f32 v69, -v66, v69, -v85
    v_mul_f32 v82, v64, v45
    v_mul_f32 v83, v65, v45
    v_exp_f32 v82, v82
    v_fract_f32 v83, v83
    v_cos_f32 v70, v83
    v_sin_f32 v71, v83
    v_mul_f32 v70, v70, v82
    v_mul_f32 v71, v71, v82
    v_mul_f32 v84, v67, v71
    v_mul_f32 v85, v67, v70
    v_fma_f32 v70, v66, v70, -v84
    v_fma_f32 v71, -v66, v71, -v85
    v_mul_f32 v82, v64, v46
    v_mul_f32 v83, v65, v46
    v_exp_f32 v82, v82
    v_fract_f32 v83, v83
    v_cos_f32 v72, v83
    v_sin_f32 v73, v83
    v_mul_f32 v72, v72, v82
    v_mul_f32 v73, v73, v82
    v_mul_f32 v84, v67, v73
    v_mul_f32 v85, v67, v72
    v_fma_f32 v72, v66, v72, -v84
    v_fma_f32 v73, -v66, v73, -v85
    v_mfma_f32_16x16x4_f32 v[48:51], v68, v74, v[48:51]
    v_mfma_f32_16x16x4_f32 v[52:55], v70, v76, v[52:55]
    v_mfma_f32_16x16x4_f32 v[56:59], v70, v78, v[56:59]
    v_mfma_f32_16x16x4_f32 v[60:63], v72, v80, v[60:63]
    v_mfma_f32_16x16x4_f32 v[48:51], v69, v75, v[48:51]
    v_mfma_f32_16x16x4_f32 v[52:55], v71, v77, v[52:55]
    v_mfma_f32_16x16x4_f32 v[56:59], v71, v79, v[56:59]
    v_mfma_f32_16x16x4_f32 v[60:63], v73, v81, v[60:63]
    v_mov_b32_dpp v64, v24 row_newbcast:1 row_mask:0xf bank_mask:0xf
    v_mov_b32_dpp v65, v25 row_newbcast:1 row_mask:0xf bank_mask:0xf
    v_mov_b32_dpp v66, v26 row_newbcast:1 row_mask:0xf bank_mask:0xf
    v_mov_b32_dpp v67, v27 row_newbcast:1 row_mask:0xf bank_mask:0xf
    v_mul_f32 v82, v64, v47
    v_mul_f32 v83, v65, v47
    v_exp_f32 v82, v82
    v_fract_f32 v83, v83
    v_cos_f32 v74, v83
    v_sin_f32 v75, v83
    v_mul_f32 v74, v74, v82
    v_mul_f32 v75, v75, v82
    v_mul_f32 v84, v75, v75
    v_add_f32 v85, v74, v74
    v_fma_f32 v76, v74, v74, -v84
    v_mul_f32 v77, v85, v75
    v_mul_f32 v84, v77, v77
    v_add_f32 v85, v76, v76
    v_fma_f32 v78, v76, v76, -v84
    v_mul_f32 v79, v85, v77
    v_mul_f32 v84, v79, v79
    v_add_f32 v85, v78, v78
    v_fma_f32 v80, v78, v78, -v84
    v_mul_f32 v81, v85, v79
    v_mul_f32 v82, v64, v44
    v_mul_f32 v83, v65, v44
    v_exp_f32 v82, v82
    v_fract_f32 v83, v83
    v_cos_f32 v68, v83
    v_sin_f32 v69, v83
    v_mul_f32 v68, v68, v82
    v_mul_f32 v69, v69, v82
    v_mul_f32 v84, v67, v69
    v_mul_f32 v85, v67, v68
    v_fma_f32 v68, v66, v68, -v84
    v_fma_f32 v69, -v66, v69, -v85
    v_mul_f32 v82, v64, v45
    v_mul_f32 v83, v65, v45
    v_exp_f32 v82, v82
    v_fract_f32 v83, v83
    v_cos_f32 v70, v83
    v_sin_f32 v71, v83
    v_mul_f32 v70, v70, v82
    v_mul_f32 v71, v71, v82
    v_mul_f32 v84, v67, v71
    v_mul_f32 v85, v67, v70
    v_fma_f32 v70, v66, v70, -v84
    v_fma_f32 v71, -v66, v71, -v85
    v_mul_f32 v82, v64, v46
    v_mul_f32 v83, v65, v46
    v_exp_f32 v82, v82
    v_fract_f32 v83, v83
    v_cos_f32 v72, v83
    v_sin_f32 v73, v83
    v_mul_f32 v72, v72, v82
    v_mul_f32 v73, v73, v82
    v_mul_f32 v84, v67, v73
    v_mul_f32 v85, v67, v72
    v_fma_f32 v72, v66, v72, -v84
    v_fma_f32 v73, -v66, v73, -v85
    v_mfma_f32_16x16x4_f32 v[48:51], v68, v74, v[48:51]
    v_mfma_f32_16x16x4_f32 v[52:55], v70, v76, v[52:55]
    v_mfma_f32_16x16x4_f32 v[56:59], v70, v78, v[56:59]
    v_mfma_f32_16x16x4_f32 v[60:63], v72, v80, v[60:63]
    v_mfma_f32_16x16x4_f32 v[48:51], v69, v75, v[48:51]
    v_mfma_f32_16x16x4_f32 v[52:55], v71, v77, v[52:55]
    v_mfma_f32_16x16x4_f32 v[56:59], v71, v79, v[56:59]
    v_mfma_f32_16x16x4_f32 v[60:63], v73, v81, v[60:63]
    v_mov_b32_dpp v64, v24 row_newbcast:2 row_mask:0xf bank_mask:0xf
    v_mov_b32_dpp v65, v25 row_newbcast:2 row_mask:0xf bank_mask:0xf
    v_mov_b32_dpp v66, v26 row_newbcast:2 row_mask:0xf bank_mask:0xf
    v_mov_b32_dpp v67, v27 row_newbcast:2 row_mask:0xf bank_mask:0xf
    v_mul_f32 v82, v64, v47
    v_mul_f32 v83, v65, v47
    v_exp_f32 v82, v82
    v_fract_f32 v83, v83
    v_cos_f32 v74, v83
    v_sin_f32 v75, v83
    v_mul_f32 v74, v74, v82
    v_mul_f32 v75, v75, v82
    v_mul_f32 v84, v75, v75
    v_add_f32 v85, v74, v74
    v_fma_f32 v76, v74, v74, -v84
    v_mul_f32 v77, v85, v75
    v_mul_f32 v84, v77, v77
    v_add_f32 v85, v76, v76
    v_fma_f32 v78, v76, v76, -v84
    v_mul_f32 v79, v85, v77
    v_mul_f32 v84, v79, v79
    v_add_f32 v85, v78, v78
    v_fma_f32 v80, v78, v78, -v84
    v_mul_f32 v81, v85, v79
    v_mul_f32 v82, v64, v44
    v_mul_f32 v83, v65, v44
    v_exp_f32 v82, v82
    v_fract_f32 v83, v83
    v_cos_f32 v68, v83
    v_sin_f32 v69, v83
    v_mul_f32 v68, v68, v82
    v_mul_f32 v69, v69, v82
    v_mul_f32 v84, v67, v69
    v_mul_f32 v85, v67, v68
    v_fma_f32 v68, v66, v68, -v84
    v_fma_f32 v69, -v66, v69, -v85
    v_mul_f32 v82, v64, v45
    v_mul_f32 v83, v65, v45
    v_exp_f32 v82, v82
    v_fract_f32 v83, v83
    v_cos_f32 v70, v83
    v_sin_f32 v71, v83
    v_mul_f32 v70, v70, v82
    v_mul_f32 v71, v71, v82
    v_mul_f32 v84, v67, v71
    v_mul_f32 v85, v67, v70
    v_fma_f32 v70, v66, v70, -v84
    v_fma_f32 v71, -v66, v71, -v85
    v_mul_f32 v82, v64, v46
    v_mul_f32 v83, v65, v46
    v_exp_f32 v82, v82
    v_fract_f32 v83, v83
    v_cos_f32 v72, v83
    v_sin_f32 v73, v83
    v_mul_f32 v72, v72, v82
    v_mul_f32 v73, v73, v82
    v_mul_f32 v84, v67, v73
    v_mul_f32 v85, v67, v72
    v_fma_f32 v72, v66, v72, -v84
    v_fma_f32 v73, -v66, v73, -v85
    v_mfma_f32_16x16x4_f32 v[48:51], v68, v74, v[48:51]
    v_mfma_f32_16x16x4_f32 v[52:55], v70, v76, v[52:55]
    v_mfma_f32_16x16x4_f32 v[56:59], v70, v78, v[56:59]
    v_mfma_f32_16x16x4_f32 v[60:63], v72, v80, v[60:63]
    v_mfma_f32_16x16x4_f32 v[48:51], v69, v75, v[48:51]
    v_mfma_f32_16x16x4_f32 v[52:55], v71, v77, v[52:55]
    v_mfma_f32_16x16x4_f32 v[56:59], v71, v79, v[56:59]
    v_mfma_f32_16x16x4_f32 v[60:63], v73, v81, v[60:63]
    v_mov_b32_dpp v64, v24 row_newbcast:3 row_mask:0xf bank_mask:0xf
    v_mov_b32_dpp v65, v25 row_newbcast:3 row_mask:0xf bank_mask:0xf
    v_mov_b32_dpp v66, v26 row_newbcast:3 row_mask:0xf bank_mask:0xf
    v_mov_b32_dpp v67, v27 row_newbcast:3 row_mask:0xf bank_mask:0xf
    v_mul_f32 v82, v64, v47
    v_mul_f32 v83, v65, v47
    v_exp_f32 v82, v82
    v_fract_f32 v83, v83
    v_cos_f32 v74, v83
    v_sin_f32 v75, v83
    v_mul_f32 v74, v74, v82
    v_mul_f32 v75, v75, v82
    v_mul_f32 v84, v75, v75
    v_add_f32 v85, v74, v74
    v_fma_f32 v76, v74, v74, -v84
    v_mul_f32 v77, v85, v75
    v_mul_f32 v84, v77, v77
    v_add_f32 v85, v76, v76
    v_fma_f32 v78, v76, v76, -v84
    v_mul_f32 v79, v85, v77
    v_mul_f32 v84, v79, v79
    v_add_f32 v85, v78, v78
    v_fma_f32 v80, v78, v78, -v84
    v_mul_f32 v81, v85, v79
    v_mul_f32 v82, v64, v44
    v_mul_f32 v83, v65, v44
    v_exp_f32 v82, v82
    v_fract_f32 v83, v83
    v_cos_f32 v68, v83
    v_sin_f32 v69, v83
    v_mul_f32 v68, v68, v82
    v_mul_f32 v69, v69, v82
    v_mul_f32 v84, v67, v69
    v_mul_f32 v85, v67, v68
    v_fma_f32 v68, v66, v68, -v84
    v_fma_f32 v69, -v66, v69, -v85
    v_mul_f32 v82, v64, v45
    v_mul_f32 v83, v65, v45
    v_exp_f32 v82, v82
    v_fract_f32 v83, v83
    v_cos_f32 v70, v83
    v_sin_f32 v71, v83
    v_mul_f32 v70, v70, v82
    v_mul_f32 v71, v71, v82
    v_mul_f32 v84, v67, v71
    v_mul_f32 v85, v67, v70
    v_fma_f32 v70, v66, v70, -v84
    v_fma_f32 v71, -v66, v71, -v85
    v_mul_f32 v82, v64, v46
    v_mul_f32 v83, v65, v46
    v_exp_f32 v82, v82
    v_fract_f32 v83, v83
    v_cos_f32 v72, v83
    v_sin_f32 v73, v83
    v_mul_f32 v72, v72, v82
    v_mul_f32 v73, v73, v82
    v_mul_f32 v84, v67, v73
    v_mul_f32 v85, v67, v72
    v_fma_f32 v72, v66, v72, -v84
    v_fma_f32 v73, -v66, v73, -v85
    v_mfma_f32_16x16x4_f32 v[48:51], v68, v74, v[48:51]
    v_mfma_f32_16x16x4_f32 v[52:55], v70, v76, v[52:55]
    v_mfma_f32_16x16x4_f32 v[56:59], v70, v78, v[56:59]
    v_mfma_f32_16x16x4_f32 v[60:63], v72, v80, v[60:63]
    v_mfma_f32_16x16x4_f32 v[48:51], v69, v75, v[48:51]
    v_mfma_f32_16x16x4_f32 v[52:55], v71, v77, v[52:55]
    v_mfma_f32_16x16x4_f32 v[56:59], v71, v79, v[56:59]
    v_mfma_f32_16x16x4_f32 v[60:63], v73, v81, v[60:63]
    v_mov_b32_dpp v64, v24 row_newbcast:4 row_mask:0xf bank_mask:0xf
    v_mov_b32_dpp v65, v25 row_newbcast:4 row_mask:0xf bank_mask:0xf
    v_mov_b32_dpp v66, v26 row_newbcast:4 row_mask:0xf bank_mask:0xf
    v_mov_b32_dpp v67, v27 row_newbcast:4 row_mask:0xf bank_mask:0xf
    v_mul_f32 v82, v64, v47
    v_mul_f32 v83, v65, v47
    v_exp_f32 v82, v82
    v_fract_f32 v83, v83
    v_cos_f32 v74, v83
    v_sin_f32 v75, v83
    v_mul_f32 v74, v74, v82
    v_mul_f32 v75, v75, v82
    v_mul_f32 v84, v75, v75
    v_add_f32 v85, v74, v74
    v_fma_f32 v76, v74, v74, -v84
    v_mul_f32 v77, v85, v75
    v_mul_f32 v84, v77, v77
    v_add_f32 v85, v76, v76
    v_fma_f32 v78, v76, v76, -v84
    v_mul_f32 v79, v85, v77
    v_mul_f32 v84, v79, v79
    v_add_f32 v85, v78, v78
    v_fma_f32 v80, v78, v78, -v84
    v_mul_f32 v81, v85, v79
    v_mul_f32 v82, v64, v44
    v_mul_f32 v83, v65, v44
    v_exp_f32 v82, v82
    v_fract_f32 v83, v83
    v_cos_f32 v68, v83
    v_sin_f32 v69, v83
    v_mul_f32 v68, v68, v82
    v_mul_f32 v69, v69, v82
    v_mul_f32 v84, v67, v69
    v_mul_f32 v85, v67, v68
    v_fma_f32 v68, v66, v68, -v84
    v_fma_f32 v69, -v66, v69, -v85
    v_mul_f32 v82, v64, v45
    v_mul_f32 v83, v65, v45
    v_exp_f32 v82, v82
    v_fract_f32 v83, v83
    v_cos_f32 v70, v83
    v_sin_f32 v71, v83
    v_mul_f32 v70, v70, v82
    v_mul_f32 v71, v71, v82
    v_mul_f32 v84, v67, v71
    v_mul_f32 v85, v67, v70
    v_fma_f32 v70, v66, v70, -v84
    v_fma_f32 v71, -v66, v71, -v85
    v_mul_f32 v82, v64, v46
    v_mul_f32 v83, v65, v46
    v_exp_f32 v82, v82
    v_fract_f32 v83, v83
    v_cos_f32 v72, v83
    v_sin_f32 v73, v83
    v_mul_f32 v72, v72, v82
    v_mul_f32 v73, v73, v82
    v_mul_f32 v84, v67, v73
    v_mul_f32 v85, v67, v72
    v_fma_f32 v72, v66, v72, -v84
    v_fma_f32 v73, -v66, v73, -v85
    v_mfma_f32_16x16x4_f32 v[48:51], v68, v74, v[48:51]
    v_mfma_f32_16x16x4_f32 v[52:55], v70, v76, v[52:55]
    v_mfma_f32_16x16x4_f32 v[56:59], v70, v78, v[56:59]
    v_mfma_f32_16x16x4_f32 v[60:63], v72, v80, v[60:63]
    v_mfma_f32_16x16x4_f32 v[48:51], v69, v75, v[48:51]
    v_mfma_f32_16x16x4_f32 v[52:55], v71, v77, v[52:55]
    v_mfma_f32_16x16x4_f32 v[56:59], v71, v79, v[56:59]
    v_mfma_f32_16x16x4_f32 v[60:63], v73, v81, v[60:63]
    v_mov_b32_dpp v64, v24 row_newbcast:5 row_mask:0xf bank_mask:0xf
    v_mov_b32_dpp v65, v25 row_newbcast:5 row_mask:0xf bank_mask:0xf
    v_mov_b32_dpp v66, v26 row_newbcast:5 row_mask:0xf bank_mask:0xf
    v_mov_b32_dpp v67, v27 row_newbcast:5 row_mask:0xf bank_mask:0xf
    v_mul_f32 v82, v64, v47
    v_mul_f32 v83, v65, v47
    v_exp_f32 v82, v82
    v_fract_f32 v83, v83
    v_cos_f32 v74, v83
    v_sin_f32 v75, v83
    v_mul_f32 v74, v74, v82
    v_mul_f32 v75, v75, v82
    v_mul_f32 v84, v75, v75
    v_add_f32 v85, v74, v74
    v_fma_f32 v76, v74, v74, -v84
    v_mul_f32 v77, v85, v75
    v_mul_f32 v84, v77, v77
    v_add_f32 v85, v76, v76
    v_fma_f32 v78, v76, v76, -v84
    v_mul_f32 v79, v85, v77
    v_mul_f32 v84, v79, v79
    v_add_f32 v85, v78, v78
    v_fma_f32 v80, v78, v78, -v84
    v_mul_f32 v81, v85, v79
    v_mul_f32 v82, v64, v44
    v_mul_f32 v83, v65, v44
    v_exp_f32 v82, v82
    v_fract_f32 v83, v83
    v_cos_f32 v68, v83
    v_sin_f32 v69, v83
    v_mul_f32 v68, v68, v82
    v_mul_f32 v69, v69, v82
    v_mul_f32 v84, v67, v69
    v_mul_f32 v85, v67, v68
    v_fma_f32 v68, v66, v68, -v84
    v_fma_f32 v69, -v66, v69, -v85
    v_mul_f32 v82, v64, v45
    v_mul_f32 v83, v65, v45
    v_exp_f32 v82, v82
    v_fract_f32 v83, v83
    v_cos_f32 v70, v83
    v_sin_f32 v71, v83
    v_mul_f32 v70, v70, v82
    v_mul_f32 v71, v71, v82
    v_mul_f32 v84, v67, v71
    v_mul_f32 v85, v67, v70
    v_fma_f32 v70, v66, v70, -v84
    v_fma_f32 v71, -v66, v71, -v85
    v_mul_f32 v82, v64, v46
    v_mul_f32 v83, v65, v46
    v_exp_f32 v82, v82
    v_fract_f32 v83, v83
    v_cos_f32 v72, v83
    v_sin_f32 v73, v83
    v_mul_f32 v72, v72, v82
    v_mul_f32 v73, v73, v82
    v_mul_f32 v84, v67, v73
    v_mul_f32 v85, v67, v72
    v_fma_f32 v72, v66, v72, -v84
    v_fma_f32 v73, -v66, v73, -v85
    v_mfma_f32_16x16x4_f32 v[48:51], v68, v74, v[48:51]
    v_mfma_f32_16x16x4_f32 v[52:55], v70, v76, v[52:55]
    v_mfma_f32_16x16x4_f32 v[56:59], v70, v78, v[56:59]
    v_mfma_f32_16x16x4_f32 v[60:63], v72, v80, v[60:63]
    v_mfma_f32_16x16x4_f32 v[48:51], v69, v75, v[48:51]
    v_mfma_f32_16x16x4_f32 v[52:55], v71, v77, v[52:55]
    v_mfma_f32_16x16x4_f32 v[56:59], v71, v79, v[56:59]
    v_mfma_f32_16x16x4_f32 v[60:63], v73, v81, v[60:63]
    v_mov_b32_dpp v64, v24 row_newbcast:6 row_mask:0xf bank_mask:0xf
    v_mov_b32_dpp v65, v25 row_newbcast:6 row_mask:0xf bank_mask:0xf
    v_mov_b32_dpp v66, v26 row_newbcast:6 row_mask:0xf bank_mask:0xf
    v_mov_b32_dpp v67, v27 row_newbcast:6 row_mask:0xf bank_mask:0xf
    v_mul_f32 v82, v64, v47
    v_mul_f32 v83, v65, v47
    v_exp_f32 v82, v82
    v_fract_f32 v83, v83
    v_cos_f32 v74, v83
    v_sin_f32 v75, v83
    v_mul_f32 v74, v74, v82
    v_mul_f32 v75, v75, v82
    v_mul_f32 v84, v75, v75
    v_add_f32 v85, v74, v74
    v_fma_f32 v76, v74, v74, -v84
    v_mul_f32 v77, v85, v75
    v_mul_f32 v84, v77, v77
    v_add_f32 v85, v76, v76
    v_fma_f32 v78, v76, v76, -v84
    v_mul_f32 v79, v85, v77
    v_mul_f32 v84, v79, v79
    v_add_f32 v85, v78, v78
    v_fma_f32 v80, v78, v78, -v84
    v_mul_f32 v81, v85, v79
    v_mul_f32 v82, v64, v44
    v_mul_f32 v83, v65, v44
    v_exp_f32 v82, v82
    v_fract_f32 v83, v83
    v_cos_f32 v68, v83
    v_sin_f32 v69, v83
    v_mul_f32 v68, v68, v82
    v_mul_f32 v69, v69, v82
    v_mul_f32 v84, v67, v69
    v_mul_f32 v85, v67, v68
    v_fma_f32 v68, v66, v68, -v84
    v_fma_f32 v69, -v66, v69, -v85
    v_mul_f32 v82, v64, v45
    v_mul_f32 v83, v65, v45
    v_exp_f32 v82, v82
    v_fract_f32 v83, v83
    v_cos_f32 v70, v83
    v_sin_f32 v71, v83
    v_mul_f32 v70, v70, v82
    v_mul_f32 v71, v71, v82
    v_mul_f32 v84, v67, v71
    v_mul_f32 v85, v67, v70
    v_fma_f32 v70, v66, v70, -v84
    v_fma_f32 v71, -v66, v71, -v85
    v_mul_f32 v82, v64, v46
    v_mul_f32 v83, v65, v46
    v_exp_f32 v82, v82
    v_fract_f32 v83, v83
    v_cos_f32 v72, v83
    v_sin_f32 v73, v83
    v_mul_f32 v72, v72, v82
    v_mul_f32 v73, v73, v82
    v_mul_f32 v84, v67, v73
    v_mul_f32 v85, v67, v72
    v_fma_f32 v72, v66, v72, -v84
    v_fma_f32 v73, -v66, v73, -v85
    v_mfma_f32_16x16x4_f32 v[48:51], v68, v74, v[48:51]
    v_mfma_f32_16x16x4_f32 v[52:55], v70, v76, v[52:55]
    v_mfma_f32_16x16x4_f32 v[56:59], v70, v78, v[56:59]
    v_mfma_f32_16x16x4_f32 v[60:63], v72, v80, v[60:63]
    v_mfma_f32_16x16x4_f32 v[48:51], v69, v75, v[48:51]
    v_mfma_f32_16x16x4_f32 v[52:55], v71, v77, v[52:55]
    v_mfma_f32_16x16x4_f32 v[56:59], v71, v79, v[56:59]
    v_mfma_f32_16x16x4_f32 v[60:63], v73, v81, v[60:63]
    v_mov_b32_dpp v64, v24 row_newbcast:7 row_mask:0xf bank_mask:0xf
    v_mov_b32_dpp v65, v25 row_newbcast:7 row_mask:0xf bank_mask:0xf
    v_mov_b32_dpp v66, v26 row_newbcast:7 row_mask:0xf bank_mask:0xf
    v_mov_b32_dpp v67, v27 row_newbcast:7 row_mask:0xf bank_mask:0xf
    v_mul_f32 v82, v64, v47
    v_mul_f32 v83, v65, v47
    v_exp_f32 v82, v82
    v_fract_f32 v83, v83
    v_cos_f32 v74, v83
    v_sin_f32 v75, v83
    v_mul_f32 v74, v74, v82
    v_mul_f32 v75, v75, v82
    v_mul_f32 v84, v75, v75
    v_add_f32 v85, v74, v74
    v_fma_f32 v76, v74, v74, -v84
    v_mul_f32 v77, v85, v75
    v_mul_f32 v84, v77, v77
    v_add_f32 v85, v76, v76
    v_fma_f32 v78, v76, v76, -v84
    v_mul_f32 v79, v85, v77
    v_mul_f32 v84, v79, v79
    v_add_f32 v85, v78, v78
    v_fma_f32 v80, v78, v78, -v84
    v_mul_f32 v81, v85, v79
    v_mul_f32 v82, v64, v44
    v_mul_f32 v83, v65, v44
    v_exp_f32 v82, v82
    v_fract_f32 v83, v83
    v_cos_f32 v68, v83
    v_sin_f32 v69, v83
    v_mul_f32 v68, v68, v82
    v_mul_f32 v69, v69, v82
    v_mul_f32 v84, v67, v69
    v_mul_f32 v85, v67, v68
    v_fma_f32 v68, v66, v68, -v84
    v_fma_f32 v69, -v66, v69, -v85
    v_mul_f32 v82, v64, v45
    v_mul_f32 v83, v65, v45
    v_exp_f32 v82, v82
    v_fract_f32 v83, v83
    v_cos_f32 v70, v83
    v_sin_f32 v71, v83
    v_mul_f32 v70, v70, v82
    v_mul_f32 v71, v71, v82
    v_mul_f32 v84, v67, v71
    v_mul_f32 v85, v67, v70
    v_fma_f32 v70, v66, v70, -v84
    v_fma_f32 v71, -v66, v71, -v85
    v_mul_f32 v82, v64, v46
    v_mul_f32 v83, v65, v46
    v_exp_f32 v82, v82
    v_fract_f32 v83, v83
    v_cos_f32 v72, v83
    v_sin_f32 v73, v83
    v_mul_f32 v72, v72, v82
    v_mul_f32 v73, v73, v82
    v_mul_f32 v84, v67, v73
    v_mul_f32 v85, v67, v72
    v_fma_f32 v72, v66, v72, -v84
    v_fma_f32 v73, -v66, v73, -v85
    v_mfma_f32_16x16x4_f32 v[48:51], v68, v74, v[48:51]
    v_mfma_f32_16x16x4_f32 v[52:55], v70, v76, v[52:55]
    v_mfma_f32_16x16x4_f32 v[56:59], v70, v78, v[56:59]
    v_mfma_f32_16x16x4_f32 v[60:63], v72, v80, v[60:63]
    v_mfma_f32_16x16x4_f32 v[48:51], v69, v75, v[48:51]
    v_mfma_f32_16x16x4_f32 v[52:55], v71, v77, v[52:55]
    v_mfma_f32_16x16x4_f32 v[56:59], v71, v79, v[56:59]
    v_mfma_f32_16x16x4_f32 v[60:63], v73, v81, v[60:63]
    v_mov_b32_dpp v64, v24 row_newbcast:8 row_mask:0xf bank_mask:0xf
    v_mov_b32_dpp v65, v25 row_newbcast:8 row_mask:0xf bank_mask:0xf
    v_mov_b32_dpp v66, v26 row_newbcast:8 row_mask:0xf bank_mask:0xf
    v_mov_b32_dpp v67, v27 row_newbcast:8 row_mask:0xf bank_mask:0xf
    v_mul_f32 v82, v64, v47
    v_mul_f32 v83, v65, v47
    v_exp_f32 v82, v82
    v_fract_f32 v83, v83
    v_cos_f32 v74, v83
    v_sin_f32 v75, v83
    v_mul_f32 v74, v74, v82
    v_mul_f32 v75, v75, v82
    v_mul_f32 v84, v75, v75
    v_add_f32 v85, v74, v74
    v_fma_f32 v76, v74, v74, -v84
    v_mul_f32 v77, v85, v75
    v_mul_f32 v84, v77, v77
    v_add_f32 v85, v76, v76
    v_fma_f32 v78, v76, v76, -v84
    v_mul_f32 v79, v85, v77
    v_mul_f32 v84, v79, v79
    v_add_f32 v85, v78, v78
    v_fma_f32 v80, v78, v78, -v84
    v_mul_f32 v81, v85, v79
    v_mul_f32 v82, v64, v44
    v_mul_f32 v83, v65, v44
    v_exp_f32 v82, v82
    v_fract_f32 v83, v83
    v_cos_f32 v68, v83
    v_sin_f32 v69, v83
    v_mul_f32 v68, v68, v82
    v_mul_f32 v69, v69, v82
    v_mul_f32 v84, v67, v69
    v_mul_f32 v85, v67, v68
    v_fma_f32 v68, v66, v68, -v84
    v_fma_f32 v69, -v66, v69, -v85
    v_mul_f32 v82, v64, v45
    v_mul_f32 v83, v65, v45
    v_exp_f32 v82, v82
    v_fract_f32 v83, v83
    v_cos_f32 v70, v83
    v_sin_f32 v71, v83
    v_mul_f32 v70, v70, v82
    v_mul_f32 v71, v71, v82
    v_mul_f32 v84, v67, v71
    v_mul_f32 v85, v67, v70
    v_fma_f32 v70, v66, v70, -v84
    v_fma_f32 v71, -v66, v71, -v85
    v_mul_f32 v82, v64, v46
    v_mul_f32 v83, v65, v46
    v_exp_f32 v82, v82
    v_fract_f32 v83, v83
    v_cos_f32 v72, v83
    v_sin_f32 v73, v83
    v_mul_f32 v72, v72, v82
    v_mul_f32 v73, v73, v82
    v_mul_f32 v84, v67, v73
    v_mul_f32 v85, v67, v72
    v_fma_f32 v72, v66, v72, -v84
    v_fma_f32 v73, -v66, v73, -v85
    v_mfma_f32_16x16x4_f32 v[48:51], v68, v74, v[48:51]
    v_mfma_f32_16x16x4_f32 v[52:55], v70, v76, v[52:55]
    v_mfma_f32_16x16x4_f32 v[56:59], v70, v78, v[56:59]
    v_mfma_f32_16x16x4_f32 v[60:63], v72, v80, v[60:63]
    v_mfma_f32_16x16x4_f32 v[48:51], v69, v75, v[48:51]
    v_mfma_f32_16x16x4_f32 v[52:55], v71, v77, v[52:55]
    v_mfma_f32_16x16x4_f32 v[56:59], v71, v79, v[56:59]
    v_mfma_f32_16x16x4_f32 v[60:63], v73, v81, v[60:63]
    v_mov_b32_dpp v64, v24 row_newbcast:9 row_mask:0xf bank_mask:0xf
    v_mov_b32_dpp v65, v25 row_newbcast:9 row_mask:0xf bank_mask:0xf
    v_mov_b32_dpp v66, v26 row_newbcast:9 row_mask:0xf bank_mask:0xf
    v_mov_b32_dpp v67, v27 row_newbcast:9 row_mask:0xf bank_mask:0xf
    v_mul_f32 v82, v64, v47
    v_mul_f32 v83, v65, v47
    v_exp_f32 v82, v82
    v_fract_f32 v83, v83
    v_cos_f32 v74, v83
    v_sin_f32 v75, v83
    v_mul_f32 v74, v74, v82
    v_mul_f32 v75, v75, v82
    v_mul_f32 v84, v75, v75
    v_add_f32 v85, v74, v74
    v_fma_f32 v76, v74, v74, -v84
    v_mul_f32 v77, v85, v75
    v_mul_f32 v84, v77, v77
    v_add_f32 v85, v76, v76
    v_fma_f32 v78, v76, v76, -v84
    v_mul_f32 v79, v85, v77
    v_mul_f32 v84, v79, v79
    v_add_f32 v85, v78, v78
    v_fma_f32 v80, v78, v78, -v84
    v_mul_f32 v81, v85, v79
    v_mul_f32 v82, v64, v44
    v_mul_f32 v83, v65, v44
    v_exp_f32 v82, v82
    v_fract_f32 v83, v83
    v_cos_f32 v68, v83
    v_sin_f32 v69, v83
    v_mul_f32 v68, v68, v82
    v_mul_f32 v69, v69, v82
    v_mul_f32 v84, v67, v69
    v_mul_f32 v85, v67, v68
    v_fma_f32 v68, v66, v68, -v84
    v_fma_f32 v69, -v66, v69, -v85
    v_mul_f32 v82, v64, v45
    v_mul_f32 v83, v65, v45
    v_exp_f32 v82, v82
    v_fract_f32 v83, v83
    v_cos_f32 v70, v83
    v_sin_f32 v71, v83
    v_mul_f32 v70, v70, v82
    v_mul_f32 v71, v71, v82
    v_mul_f32 v84, v67, v71
    v_mul_f32 v85, v67, v70
    v_fma_f32 v70, v66, v70, -v84
    v_fma_f32 v71, -v66, v71, -v85
    v_mul_f32 v82, v64, v46
    v_mul_f32 v83, v65, v46
    v_exp_f32 v82, v82
    v_fract_f32 v83, v83
    v_cos_f32 v72, v83
    v_sin_f32 v73, v83
    v_mul_f32 v72, v72, v82
    v_mul_f32 v73, v73, v82
    v_mul_f32 v84, v67, v73
    v_mul_f32 v85, v67, v72
    v_fma_f32 v72, v66, v72, -v84
    v_fma_f32 v73, -v66, v73, -v85
    v_mfma_f32_16x16x4_f32 v[48:51], v68, v74, v[48:51]
    v_mfma_f32_16x16x4_f32 v[52:55], v70, v76, v[52:55]
    v_mfma_f32_16x16x4_f32 v[56:59], v70, v78, v[56:59]
    v_mfma_f32_16x16x4_f32 v[60:63], v72, v80, v[60:63]
    v_mfma_f32_16x16x4_f32 v[48:51], v69, v75, v[48:51]
    v_mfma_f32_16x16x4_f32 v[52:55], v71, v77, v[52:55]
    v_mfma_f32_16x16x4_f32 v[56:59], v71, v79, v[56:59]
    v_mfma_f32_16x16x4_f32 v[60:63], v73, v81, v[60:63]
    v_mov_b32_dpp v64, v24 row_newbcast:10 row_mask:0xf bank_mask:0xf
    v_mov_b32_dpp v65, v25 row_newbcast:10 row_mask:0xf bank_mask:0xf
    v_mov_b32_dpp v66, v26 row_newbcast:10 row_mask:0xf bank_mask:0xf
    v_mov_b32_dpp v67, v27 row_newbcast:10 row_mask:0xf bank_mask:0xf
    v_mul_f32 v82, v64, v47
    v_mul_f32 v83, v65, v47
    v_exp_f32 v82, v82
    v_fract_f32 v83, v83
    v_cos_f32 v74, v83
    v_sin_f32 v75, v83
    v_mul_f32 v74, v74, v82
    v_mul_f32 v75, v75, v82
    v_mul_f32 v84, v75, v75
    v_add_f32 v85, v74, v74
    v_fma_f32 v76, v74, v74, -v84
    v_mul_f32 v77, v85, v75
    v_mul_f32 v84, v77, v77
    v_add_f32 v85, v76, v76
    v_fma_f32 v78, v76, v76, -v84
    v_mul_f32 v79, v85, v77
    v_mul_f32 v84, v79, v79
    v_add_f32 v85, v78, v78
    v_fma_f32 v80, v78, v78, -v84
    v_mul_f32 v81, v85, v79
    v_mul_f32 v82, v64, v44
    v_mul_f32 v83, v65, v44
    v_exp_f32 v82, v82
    v_fract_f32 v83, v83
    v_cos_f32 v68, v83
    v_sin_f32 v69, v83
    v_mul_f32 v68, v68, v82
    v_mul_f32 v69, v69, v82
    v_mul_f32 v84, v67, v69
    v_mul_f32 v85, v67, v68
    v_fma_f32 v68, v66, v68, -v84
    v_fma_f32 v69, -v66, v69, -v85
    v_mul_f32 v82, v64, v45
    v_mul_f32 v83, v65, v45
    v_exp_f32 v82, v82
    v_fract_f32 v83, v83
    v_cos_f32 v70, v83
    v_sin_f32 v71, v83
    v_mul_f32 v70, v70, v82
    v_mul_f32 v71, v71, v82
    v_mul_f32 v84, v67, v71
    v_mul_f32 v85, v67, v70
    v_fma_f32 v70, v66, v70, -v84
    v_fma_f32 v71, -v66, v71, -v85
    v_mul_f32 v82, v64, v46
    v_mul_f32 v83, v65, v46
    v_exp_f32 v82, v82
    v_fract_f32 v83, v83
    v_cos_f32 v72, v83
    v_sin_f32 v73, v83
    v_mul_f32 v72, v72, v82
    v_mul_f32 v73, v73, v82
    v_mul_f32 v84, v67, v73
    v_mul_f32 v85, v67, v72
    v_fma_f32 v72, v66, v72, -v84
    v_fma_f32 v73, -v66, v73, -v85
    v_mfma_f32_16x16x4_f32 v[48:51], v68, v74, v[48:51]
    v_mfma_f32_16x16x4_f32 v[52:55], v70, v76, v[52:55]
    v_mfma_f32_16x16x4_f32 v[56:59], v70, v78, v[56:59]
    v_mfma_f32_16x16x4_f32 v[60:63], v72, v80, v[60:63]
    v_mfma_f32_16x16x4_f32 v[48:51], v69, v75, v[48:51]
    v_mfma_f32_16x16x4_f32 v[52:55], v71, v77, v[52:55]
    v_mfma_f32_16x16x4_f32 v[56:59], v71, v79, v[56:59]
    v_mfma_f32_16x16x4_f32 v[60:63], v73, v81, v[60:63]
    v_mov_b32_dpp v64, v24 row_newbcast:11 row_mask:0xf bank_mask:0xf
    v_mov_b32_dpp v65, v25 row_newbcast:11 row_mask:0xf bank_mask:0xf
    v_mov_b32_dpp v66, v26 row_newbcast:11 row_mask:0xf bank_mask:0xf
    v_mov_b32_dpp v67, v27 row_newbcast:11 row_mask:0xf bank_mask:0xf
    v_mul_f32 v82, v64, v47
    v_mul_f32 v83, v65, v47
    v_exp_f32 v82, v82
    v_fract_f32 v83, v83
    v_cos_f32 v74, v83
    v_sin_f32 v75, v83
    v_mul_f32 v74, v74, v82
    v_mul_f32 v75, v75, v82
    v_mul_f32 v84, v75, v75
    v_add_f32 v85, v74, v74
    v_fma_f32 v76, v74, v74, -v84
    v_mul_f32 v77, v85, v75
    v_mul_f32 v84, v77, v77
    v_add_f32 v85, v76, v76
    v_fma_f32 v78, v76, v76, -v84
    v_mul_f32 v79, v85, v77
    v_mul_f32 v84, v79, v79
    v_add_f32 v85, v78, v78
    v_fma_f32 v80, v78, v78, -v84
    v_mul_f32 v81, v85, v79
    v_mul_f32 v82, v64, v44
    v_mul_f32 v83, v65, v44
    v_exp_f32 v82, v82
    v_fract_f32 v83, v83
    v_cos_f32 v68, v83
    v_sin_f32 v69, v83
    v_mul_f32 v68, v68, v82
    v_mul_f32 v69, v69, v82
    v_mul_f32 v84, v67, v69
    v_mul_f32 v85, v67, v68
    v_fma_f32 v68, v66, v68, -v84
    v_fma_f32 v69, -v66, v69, -v85
    v_mul_f32 v82, v64, v45
    v_mul_f32 v83, v65, v45
    v_exp_f32 v82, v82
    v_fract_f32 v83, v83
    v_cos_f32 v70, v83
    v_sin_f32 v71, v83
    v_mul_f32 v70, v70, v82
    v_mul_f32 v71, v71, v82
    v_mul_f32 v84, v67, v71
    v_mul_f32 v85, v67, v70
    v_fma_f32 v70, v66, v70, -v84
    v_fma_f32 v71, -v66, v71, -v85
    v_mul_f32 v82, v64, v46
    v_mul_f32 v83, v65, v46
    v_exp_f32 v82, v82
    v_fract_f32 v83, v83
    v_cos_f32 v72, v83
    v_sin_f32 v73, v83
    v_mul_f32 v72, v72, v82
    v_mul_f32 v73, v73, v82
    v_mul_f32 v84, v67, v73
    v_mul_f32 v85, v67, v72
    v_fma_f32 v72, v66, v72, -v84
    v_fma_f32 v73, -v66, v73, -v85
    v_mfma_f32_16x16x4_f32 v[48:51], v68, v74, v[48:51]
    v_mfma_f32_16x16x4_f32 v[52:55], v70, v76, v[52:55]
    v_mfma_f32_16x16x4_f32 v[56:59], v70, v78, v[56:59]
    v_mfma_f32_16x16x4_f32 v[60:63], v72, v80, v[60:63]
    v_mfma_f32_16x16x4_f32 v[48:51], v69, v75, v[48:51]
    v_mfma_f32_16x16x4_f32 v[52:55], v71, v77, v[52:55]
    v_mfma_f32_16x16x4_f32 v[56:59], v71, v79, v[56:59]
    v_mfma_f32_16x16x4_f32 v[60:63], v73, v81, v[60:63]
    v_mov_b32_dpp v64, v24 row_newbcast:12 row_mask:0xf bank_mask:0xf
    v_mov_b32_dpp v65, v25 row_newbcast:12 row_mask:0xf bank_mask:0xf
    v_mov_b32_dpp v66, v26 row_newbcast:12 row_mask:0xf bank_mask:0xf
    v_mov_b32_dpp v67, v27 row_newbcast:12 row_mask:0xf bank_mask:0xf
    v_mul_f32 v82, v64, v47
    v_mul_f32 v83, v65, v47
    v_exp_f32 v82, v82
    v_fract_f32 v83, v83
    v_cos_f32 v74, v83
    v_sin_f32 v75, v83
    v_mul_f32 v74, v74, v82
    v_mul_f32 v75, v75, v82
    v_mul_f32 v84, v75, v75
    v_add_f32 v85, v74, v74
    v_fma_f32 v76, v74, v74, -v84
    v_mul_f32 v77, v85, v75
    v_mul_f32 v84, v77, v77
    v_add_f32 v85, v76, v76
    v_fma_f32 v78, v76, v76, -v84
    v_mul_f32 v79, v85, v77
    v_mul_f32 v84, v79, v79
    v_add_f32 v85, v78, v78
    v_fma_f32 v80, v78, v78, -v84
    v_mul_f32 v81, v85, v79
    v_mul_f32 v82, v64, v44
    v_mul_f32 v83, v65, v44
    v_exp_f32 v82, v82
    v_fract_f32 v83, v83
    v_cos_f32 v68, v83
    v_sin_f32 v69, v83
    v_mul_f32 v68, v68, v82
    v_mul_f32 v69, v69, v82
    v_mul_f32 v84, v67, v69
    v_mul_f32 v85, v67, v68
    v_fma_f32 v68, v66, v68, -v84
    v_fma_f32 v69, -v66, v69, -v85
    v_mul_f32 v82, v64, v45
    v_mul_f32 v83, v65, v45
    v_exp_f32 v82, v82
    v_fract_f32 v83, v83
    v_cos_f32 v70, v83
    v_sin_f32 v71, v83
    v_mul_f32 v70, v70, v82
    v_mul_f32 v71, v71, v82
    v_mul_f32 v84, v67, v71
    v_mul_f32 v85, v67, v70
    v_fma_f32 v70, v66, v70, -v84
    v_fma_f32 v71, -v66, v71, -v85
    v_mul_f32 v82, v64, v46
    v_mul_f32 v83, v65, v46
    v_exp_f32 v82, v82
    v_fract_f32 v83, v83
    v_cos_f32 v72, v83
    v_sin_f32 v73, v83
    v_mul_f32 v72, v72, v82
    v_mul_f32 v73, v73, v82
    v_mul_f32 v84, v67, v73
    v_mul_f32 v85, v67, v72
    v_fma_f32 v72, v66, v72, -v84
    v_fma_f32 v73, -v66, v73, -v85
    v_mfma_f32_16x16x4_f32 v[48:51], v68, v74, v[48:51]
    v_mfma_f32_16x16x4_f32 v[52:55], v70, v76, v[52:55]
    v_mfma_f32_16x16x4_f32 v[56:59], v70, v78, v[56:59]
    v_mfma_f32_16x16x4_f32 v[60:63], v72, v80, v[60:63]
    v_mfma_f32_16x16x4_f32 v[48:51], v69, v75, v[48:51]
    v_mfma_f32_16x16x4_f32 v[52:55], v71, v77, v[52:55]
    v_mfma_f32_16x16x4_f32 v[56:59], v71, v79, v[56:59]
    v_mfma_f32_16x16x4_f32 v[60:63], v73, v81, v[60:63]
    v_mov_b32_dpp v64, v24 row_newbcast:13 row_mask:0xf bank_mask:0xf
    v_mov_b32_dpp v65, v25 row_newbcast:13 row_mask:0xf bank_mask:0xf
    v_mov_b32_dpp v66, v26 row_newbcast:13 row_mask:0xf bank_mask:0xf
    v_mov_b32_dpp v67, v27 row_newbcast:13 row_mask:0xf bank_mask:0xf
    v_mul_f32 v82, v64, v47
    v_mul_f32 v83, v65, v47
    v_exp_f32 v82, v82
    v_fract_f32 v83, v83
    v_cos_f32 v74, v83
    v_sin_f32 v75, v83
    v_mul_f32 v74, v74, v82
    v_mul_f32 v75, v75, v82
    v_mul_f32 v84, v75, v75
    v_add_f32 v85, v74, v74
    v_fma_f32 v76, v74, v74, -v84
    v_mul_f32 v77, v85, v75
    v_mul_f32 v84, v77, v77
    v_add_f32 v85, v76, v76
    v_fma_f32 v78, v76, v76, -v84
    v_mul_f32 v79, v85, v77
    v_mul_f32 v84, v79, v79
    v_add_f32 v85, v78, v78
    v_fma_f32 v80, v78, v78, -v84
    v_mul_f32 v81, v85, v79
    v_mul_f32 v82, v64, v44
    v_mul_f32 v83, v65, v44
    v_exp_f32 v82, v82
    v_fract_f32 v83, v83
    v_cos_f32 v68, v83
    v_sin_f32 v69, v83
    v_mul_f32 v68, v68, v82
    v_mul_f32 v69, v69, v82
    v_mul_f32 v84, v67, v69
    v_mul_f32 v85, v67, v68
    v_fma_f32 v68, v66, v68, -v84
    v_fma_f32 v69, -v66, v69, -v85
    v_mul_f32 v82, v64, v45
    v_mul_f32 v83, v65, v45
    v_exp_f32 v82, v82
    v_fract_f32 v83, v83
    v_cos_f32 v70, v83
    v_sin_f32 v71, v83
    v_mul_f32 v70, v70, v82
    v_mul_f32 v71, v71, v82
    v_mul_f32 v84, v67, v71
    v_mul_f32 v85, v67, v70
    v_fma_f32 v70, v66, v70, -v84
    v_fma_f32 v71, -v66, v71, -v85
    v_mul_f32 v82, v64, v46
    v_mul_f32 v83, v65, v46
    v_exp_f32 v82, v82
    v_fract_f32 v83, v83
    v_cos_f32 v72, v83
    v_sin_f32 v73, v83
    v_mul_f32 v72, v72, v82
    v_mul_f32 v73, v73, v82
    v_mul_f32 v84, v67, v73
    v_mul_f32 v85, v67, v72
    v_fma_f32 v72, v66, v72, -v84
    v_fma_f32 v73, -v66, v73, -v85
    v_mfma_f32_16x16x4_f32 v[48:51], v68, v74, v[48:51]
    v_mfma_f32_16x16x4_f32 v[52:55], v70, v76, v[52:55]
    v_mfma_f32_16x16x4_f32 v[56:59], v70, v78, v[56:59]
    v_mfma_f32_16x16x4_f32 v[60:63], v72, v80, v[60:63]
    v_mfma_f32_16x16x4_f32 v[48:51], v69, v75, v[48:51]
    v_mfma_f32_16x16x4_f32 v[52:55], v71, v77, v[52:55]
    v_mfma_f32_16x16x4_f32 v[56:59], v71, v79, v[56:59]
    v_mfma_f32_16x16x4_f32 v[60:63], v73, v81, v[60:63]
    v_mov_b32_dpp v64, v24 row_newbcast:14 row_mask:0xf bank_mask:0xf
    v_mov_b32_dpp v65, v25 row_newbcast:14 row_mask:0xf bank_mask:0xf
    v_mov_b32_dpp v66, v26 row_newbcast:14 row_mask:0xf bank_mask:0xf
    v_mov_b32_dpp v67, v27 row_newbcast:14 row_mask:0xf bank_mask:0xf
    v_mul_f32 v82, v64, v47
    v_mul_f32 v83, v65, v47
    v_exp_f32 v82, v82
    v_fract_f32 v83, v83
    v_cos_f32 v74, v83
    v_sin_f32 v75, v83
    v_mul_f32 v74, v74, v82
    v_mul_f32 v75, v75, v82
    v_mul_f32 v84, v75, v75
    v_add_f32 v85, v74, v74
    v_fma_f32 v76, v74, v74, -v84
    v_mul_f32 v77, v85, v75
    v_mul_f32 v84, v77, v77
    v_add_f32 v85, v76, v76
    v_fma_f32 v78, v76, v76, -v84
    v_mul_f32 v79, v85, v77
    v_mul_f32 v84, v79, v79
    v_add_f32 v85, v78, v78
    v_fma_f32 v80, v78, v78, -v84
    v_mul_f32 v81, v85, v79
    v_mul_f32 v82, v64, v44
    v_mul_f32 v83, v65, v44
    v_exp_f32 v82, v82
    v_fract_f32 v83, v83
    v_cos_f32 v68, v83
    v_sin_f32 v69, v83
    v_mul_f32 v68, v68, v82
    v_mul_f32 v69, v69, v82
    v_mul_f32 v84, v67, v69
    v_mul_f32 v85, v67, v68
    v_fma_f32 v68, v66, v68, -v84
    v_fma_f32 v69, -v66, v69, -v85
    v_mul_f32 v82, v64, v45
    v_mul_f32 v83, v65, v45
    v_exp_f32 v82, v82
    v_fract_f32 v83, v83
    v_cos_f32 v70, v83
    v_sin_f32 v71, v83
    v_mul_f32 v70, v70, v82
    v_mul_f32 v71, v71, v82
    v_mul_f32 v84, v67, v71
    v_mul_f32 v85, v67, v70
    v_fma_f32 v70, v66, v70, -v84
    v_fma_f32 v71, -v66, v71, -v85
    v_mul_f32 v82, v64, v46
    v_mul_f32 v83, v65, v46
    v_exp_f32 v82, v82
    v_fract_f32 v83, v83
    v_cos_f32 v72, v83
    v_sin_f32 v73, v83
    v_mul_f32 v72, v72, v82
    v_mul_f32 v73, v73, v82
    v_mul_f32 v84, v67, v73
    v_mul_f32 v85, v67, v72
    v_fma_f32 v72, v66, v72, -v84
    v_fma_f32 v73, -v66, v73, -v85
    v_mfma_f32_16x16x4_f32 v[48:51], v68, v74, v[48:51]
    v_mfma_f32_16x16x4_f32 v[52:55], v70, v76, v[52:55]
    v_mfma_f32_16x16x4_f32 v[56:59], v70, v78, v[56:59]
    v_mfma_f32_16x16x4_f32 v[60:63], v72, v80, v[60:63]
    v_mfma_f32_16x16x4_f32 v[48:51], v69, v75, v[48:51]
    v_mfma_f32_16x16x4_f32 v[52:55], v71, v77, v[52:55]
    v_mfma_f32_16x16x4_f32 v[56:59], v71, v79, v[56:59]
    v_mfma_f32_16x16x4_f32 v[60:63], v73, v81, v[60:63]
    v_mov_b32_dpp v64, v24 row_newbcast:15 row_mask:0xf bank_mask:0xf
    v_mov_b32_dpp v65, v25 row_newbcast:15 row_mask:0xf bank_mask:0xf
    v_mov_b32_dpp v66, v26 row_newbcast:15 row_mask:0xf bank_mask:0xf
    v_mov_b32_dpp v67, v27 row_newbcast:15 row_mask:0xf bank_mask:0xf
    v_mul_f32 v82, v64, v47
    v_mul_f32 v83, v65, v47
    v_exp_f32 v82, v82
    v_fract_f32 v83, v83
    v_cos_f32 v74, v83
    v_sin_f32 v75, v83
    v_mul_f32 v74, v74, v82
    v_mul_f32 v75, v75, v82
    v_mul_f32 v84, v75, v75
    v_add_f32 v85, v74, v74
    v_fma_f32 v76, v74, v74, -v84
    v_mul_f32 v77, v85, v75
    v_mul_f32 v84, v77, v77
    v_add_f32 v85, v76, v76
    v_fma_f32 v78, v76, v76, -v84
    v_mul_f32 v79, v85, v77
    v_mul_f32 v84, v79, v79
    v_add_f32 v85, v78, v78
    v_fma_f32 v80, v78, v78, -v84
    v_mul_f32 v81, v85, v79
    v_mul_f32 v82, v64, v44
    v_mul_f32 v83, v65, v44
    v_exp_f32 v82, v82
    v_fract_f32 v83, v83
    v_cos_f32 v68, v83
    v_sin_f32 v69, v83
    v_mul_f32 v68, v68, v82
    v_mul_f32 v69, v69, v82
    v_mul_f32 v84, v67, v69
    v_mul_f32 v85, v67, v68
    v_fma_f32 v68, v66, v68, -v84
    v_fma_f32 v69, -v66, v69, -v85
    v_mul_f32 v82, v64, v45
    v_mul_f32 v83, v65, v45
    v_exp_f32 v82, v82
    v_fract_f32 v83, v83
    v_cos_f32 v70, v83
    v_sin_f32 v71, v83
    v_mul_f32 v70, v70, v82
    v_mul_f32 v71, v71, v82
    v_mul_f32 v84, v67, v71
    v_mul_f32 v85, v67, v70
    v_fma_f32 v70, v66, v70, -v84
    v_fma_f32 v71, -v66, v71, -v85
    v_mul_f32 v82, v64, v46
    v_mul_f32 v83, v65, v46
    v_exp_f32 v82, v82
    v_fract_f32 v83, v83
    v_cos_f32 v72, v83
    v_sin_f32 v73, v83
    v_mul_f32 v72, v72, v82
    v_mul_f32 v73, v73, v82
    v_mul_f32 v84, v67, v73
    v_mul_f32 v85, v67, v72
    v_fma_f32 v72, v66, v72, -v84
    v_fma_f32 v73, -v66, v73, -v85
    v_mfma_f32_16x16x4_f32 v[48:51], v68, v74, v[48:51]
    v_mfma_f32_16x16x4_f32 v[52:55], v70, v76, v[52:55]
    v_mfma_f32_16x16x4_f32 v[56:59], v70, v78, v[56:59]
    v_mfma_f32_16x16x4_f32 v[60:63], v72, v80, v[60:63]
    v_mfma_f32_16x16x4_f32 v[48:51], v69, v75, v[48:51]
    v_mfma_f32_16x16x4_f32 v[52:55], v71, v77, v[52:55]
    v_mfma_f32_16x16x4_f32 v[56:59], v71, v79, v[56:59]
    v_mfma_f32_16x16x4_f32 v[60:63], v73, v81, v[60:63]
    v_mov_b32_dpp v64, v28 row_newbcast:0 row_mask:0xf bank_mask:0xf
    v_mov_b32_dpp v65, v29 row_newbcast:0 row_mask:0xf bank_mask:0xf
    v_mov_b32_dpp v66, v30 row_newbcast:0 row_mask:0xf bank_mask:0xf
    v_mov_b32_dpp v67, v31 row_newbcast:0 row_mask:0xf bank_mask:0xf
    v_mul_f32 v82, v64, v47
    v_mul_f32 v83, v65, v47
    v_exp_f32 v82, v82
    v_fract_f32 v83, v83
    v_cos_f32 v74, v83
    v_sin_f32 v75, v83
    v_mul_f32 v74, v74, v82
    v_mul_f32 v75, v75, v82
    v_mul_f32 v84, v75, v75
    v_add_f32 v85, v74, v74
    v_fma_f32 v76, v74, v74, -v84
    v_mul_f32 v77, v85, v75
    v_mul_f32 v84, v77, v77
    v_add_f32 v85, v76, v76
    v_fma_f32 v78, v76, v76, -v84
    v_mul_f32 v79, v85, v77
    v_mul_f32 v84, v79, v79
    v_add_f32 v85, v78, v78
    v_fma_f32 v80, v78, v78, -v84
    v_mul_f32 v81, v85, v79
    v_mul_f32 v82, v64, v44
    v_mul_f32 v83, v65, v44
    v_exp_f32 v82, v82
    v_fract_f32 v83, v83
    v_cos_f32 v68, v83
    v_sin_f32 v69, v83
    v_mul_f32 v68, v68, v82
    v_mul_f32 v69, v69, v82
    v_mul_f32 v84, v67, v69
    v_mul_f32 v85, v67, v68
    v_fma_f32 v68, v66, v68, -v84
    v_fma_f32 v69, -v66, v69, -v85
    v_mul_f32 v82, v64, v45
    v_mul_f32 v83, v65, v45
    v_exp_f32 v82, v82
    v_fract_f32 v83, v83
    v_cos_f32 v70, v83
    v_sin_f32 v71, v83
    v_mul_f32 v70, v70, v82
    v_mul_f32 v71, v71, v82
    v_mul_f32 v84, v67, v71
    v_mul_f32 v85, v67, v70
    v_fma_f32 v70, v66, v70, -v84
    v_fma_f32 v71, -v66, v71, -v85
    v_mul_f32 v82, v64, v46
    v_mul_f32 v83, v65, v46
    v_exp_f32 v82, v82
    v_fract_f32 v83, v83
    v_cos_f32 v72, v83
    v_sin_f32 v73, v83
    v_mul_f32 v72, v72, v82
    v_mul_f32 v73, v73, v82
    v_mul_f32 v84, v67, v73
    v_mul_f32 v85, v67, v72
    v_fma_f32 v72, v66, v72, -v84
    v_fma_f32 v73, -v66, v73, -v85
    v_mfma_f32_16x16x4_f32 v[48:51], v68, v74, v[48:51]
    v_mfma_f32_16x16x4_f32 v[52:55], v70, v76, v[52:55]
    v_mfma_f32_16x16x4_f32 v[56:59], v70, v78, v[56:59]
    v_mfma_f32_16x16x4_f32 v[60:63], v72, v80, v[60:63]
    v_mfma_f32_16x16x4_f32 v[48:51], v69, v75, v[48:51]
    v_mfma_f32_16x16x4_f32 v[52:55], v71, v77, v[52:55]
    v_mfma_f32_16x16x4_f32 v[56:59], v71, v79, v[56:59]
    v_mfma_f32_16x16x4_f32 v[60:63], v73, v81, v[60:63]
    v_mov_b32_dpp v64, v28 row_newbcast:1 row_mask:0xf bank_mask:0xf
    v_mov_b32_dpp v65, v29 row_newbcast:1 row_mask:0xf bank_mask:0xf
    v_mov_b32_dpp v66, v30 row_newbcast:1 row_mask:0xf bank_mask:0xf
    v_mov_b32_dpp v67, v31 row_newbcast:1 row_mask:0xf bank_mask:0xf
    v_mul_f32 v82, v64, v47
    v_mul_f32 v83, v65, v47
    v_exp_f32 v82, v82
    v_fract_f32 v83, v83
    v_cos_f32 v74, v83
    v_sin_f32 v75, v83
    v_mul_f32 v74, v74, v82
    v_mul_f32 v75, v75, v82
    v_mul_f32 v84, v75, v75
    v_add_f32 v85, v74, v74
    v_fma_f32 v76, v74, v74, -v84
    v_mul_f32 v77, v85, v75
    v_mul_f32 v84, v77, v77
    v_add_f32 v85, v76, v76
    v_fma_f32 v78, v76, v76, -v84
    v_mul_f32 v79, v85, v77
    v_mul_f32 v84, v79, v79
    v_add_f32 v85, v78, v78
    v_fma_f32 v80, v78, v78, -v84
    v_mul_f32 v81, v85, v79
    v_mul_f32 v82, v64, v44
    v_mul_f32 v83, v65, v44
    v_exp_f32 v82, v82
    v_fract_f32 v83, v83
    v_cos_f32 v68, v83
    v_sin_f32 v69, v83
    v_mul_f32 v68, v68, v82
    v_mul_f32 v69, v69, v82
    v_mul_f32 v84, v67, v69
    v_mul_f32 v85, v67, v68
    v_fma_f32 v68, v66, v68, -v84
    v_fma_f32 v69, -v66, v69, -v85
    v_mul_f32 v82, v64, v45
    v_mul_f32 v83, v65, v45
    v_exp_f32 v82, v82
    v_fract_f32 v83, v83
    v_cos_f32 v70, v83
    v_sin_f32 v71, v83
    v_mul_f32 v70, v70, v82
    v_mul_f32 v71, v71, v82
    v_mul_f32 v84, v67, v71
    v_mul_f32 v85, v67, v70
    v_fma_f32 v70, v66, v70, -v84
    v_fma_f32 v71, -v66, v71, -v85
    v_mul_f32 v82, v64, v46
    v_mul_f32 v83, v65, v46
    v_exp_f32 v82, v82
    v_fract_f32 v83, v83
    v_cos_f32 v72, v83
    v_sin_f32 v73, v83
    v_mul_f32 v72, v72, v82
    v_mul_f32 v73, v73, v82
    v_mul_f32 v84, v67, v73
    v_mul_f32 v85, v67, v72
    v_fma_f32 v72, v66, v72, -v84
    v_fma_f32 v73, -v66, v73, -v85
    v_mfma_f32_16x16x4_f32 v[48:51], v68, v74, v[48:51]
    v_mfma_f32_16x16x4_f32 v[52:55], v70, v76, v[52:55]
    v_mfma_f32_16x16x4_f32 v[56:59], v70, v78, v[56:59]
    v_mfma_f32_16x16x4_f32 v[60:63], v72, v80, v[60:63]
    v_mfma_f32_16x16x4_f32 v[48:51], v69, v75, v[48:51]
    v_mfma_f32_16x16x4_f32 v[52:55], v71, v77, v[52:55]
    v_mfma_f32_16x16x4_f32 v[56:59], v71, v79, v[56:59]
    v_mfma_f32_16x16x4_f32 v[60:63], v73, v81, v[60:63]
    v_mov_b32_dpp v64, v28 row_newbcast:2 row_mask:0xf bank_mask:0xf
    v_mov_b32_dpp v65, v29 row_newbcast:2 row_mask:0xf bank_mask:0xf
    v_mov_b32_dpp v66, v30 row_newbcast:2 row_mask:0xf bank_mask:0xf
    v_mov_b32_dpp v67, v31 row_newbcast:2 row_mask:0xf bank_mask:0xf
    v_mul_f32 v82, v64, v47
    v_mul_f32 v83, v65, v47
    v_exp_f32 v82, v82
    v_fract_f32 v83, v83
    v_cos_f32 v74, v83
    v_sin_f32 v75, v83
    v_mul_f32 v74, v74, v82
    v_mul_f32 v75, v75, v82
    v_mul_f32 v84, v75, v75
    v_add_f32 v85, v74, v74
    v_fma_f32 v76, v74, v74, -v84
    v_mul_f32 v77, v85, v75
    v_mul_f32 v84, v77, v77
    v_add_f32 v85, v76, v76
    v_fma_f32 v78, v76, v76, -v84
    v_mul_f32 v79, v85, v77
    v_mul_f32 v84, v79, v79
    v_add_f32 v85, v78, v78
    v_fma_f32 v80, v78, v78, -v84
    v_mul_f32 v81, v85, v79
    v_mul_f32 v82, v64, v44
    v_mul_f32 v83, v65, v44
    v_exp_f32 v82, v82
    v_fract_f32 v83, v83
    v_cos_f32 v68, v83
    v_sin_f32 v69, v83
    v_mul_f32 v68, v68, v82
    v_mul_f32 v69, v69, v82
    v_mul_f32 v84, v67, v69
    v_mul_f32 v85, v67, v68
    v_fma_f32 v68, v66, v68, -v84
    v_fma_f32 v69, -v66, v69, -v85
    v_mul_f32 v82, v64, v45
    v_mul_f32 v83, v65, v45
    v_exp_f32 v82, v82
    v_fract_f32 v83, v83
    v_cos_f32 v70, v83
    v_sin_f32 v71, v83
    v_mul_f32 v70, v70, v82
    v_mul_f32 v71, v71, v82
    v_mul_f32 v84, v67, v71
    v_mul_f32 v85, v67, v70
    v_fma_f32 v70, v66, v70, -v84
    v_fma_f32 v71, -v66, v71, -v85
    v_mul_f32 v82, v64, v46
    v_mul_f32 v83, v65, v46
    v_exp_f32 v82, v82
    v_fract_f32 v83, v83
    v_cos_f32 v72, v83
    v_sin_f32 v73, v83
    v_mul_f32 v72, v72, v82
    v_mul_f32 v73, v73, v82
    v_mul_f32 v84, v67, v73
    v_mul_f32 v85, v67, v72
    v_fma_f32 v72, v66, v72, -v84
    v_fma_f32 v73, -v66, v73, -v85
    v_mfma_f32_16x16x4_f32 v[48:51], v68, v74, v[48:51]
    v_mfma_f32_16x16x4_f32 v[52:55], v70, v76, v[52:55]
    v_mfma_f32_16x16x4_f32 v[56:59], v70, v78, v[56:59]
    v_mfma_f32_16x16x4_f32 v[60:63], v72, v80, v[60:63]
    v_mfma_f32_16x16x4_f32 v[48:51], v69, v75, v[48:51]
    v_mfma_f32_16x16x4_f32 v[52:55], v71, v77, v[52:55]
    v_mfma_f32_16x16x4_f32 v[56:59], v71, v79, v[56:59]
    v_mfma_f32_16x16x4_f32 v[60:63], v73, v81, v[60:63]
    v_mov_b32_dpp v64, v28 row_newbcast:3 row_mask:0xf bank_mask:0xf
    v_mov_b32_dpp v65, v29 row_newbcast:3 row_mask:0xf bank_mask:0xf
    v_mov_b32_dpp v66, v30 row_newbcast:3 row_mask:0xf bank_mask:0xf
    v_mov_b32_dpp v67, v31 row_newbcast:3 row_mask:0xf bank_mask:0xf
    v_mul_f32 v82, v64, v47
    v_mul_f32 v83, v65, v47
    v_exp_f32 v82, v82
    v_fract_f32 v83, v83
    v_cos_f32 v74, v83
    v_sin_f32 v75, v83
    v_mul_f32 v74, v74, v82
    v_mul_f32 v75, v75, v82
    v_mul_f32 v84, v75, v75
    v_add_f32 v85, v74, v74
    v_fma_f32 v76, v74, v74, -v84
    v_mul_f32 v77, v85, v75
    v_mul_f32 v84, v77, v77
    v_add_f32 v85, v76, v76
    v_fma_f32 v78, v76, v76, -v84
    v_mul_f32 v79, v85, v77
    v_mul_f32 v84, v79, v79
    v_add_f32 v85, v78, v78
    v_fma_f32 v80, v78, v78, -v84
    v_mul_f32 v81, v85, v79
    v_mul_f32 v82, v64, v44
    v_mul_f32 v83, v65, v44
    v_exp_f32 v82, v82
    v_fract_f32 v83, v83
    v_cos_f32 v68, v83
    v_sin_f32 v69, v83
    v_mul_f32 v68, v68, v82
    v_mul_f32 v69, v69, v82
    v_mul_f32 v84, v67, v69
    v_mul_f32 v85, v67, v68
    v_fma_f32 v68, v66, v68, -v84
    v_fma_f32 v69, -v66, v69, -v85
    v_mul_f32 v82, v64, v45
    v_mul_f32 v83, v65, v45
    v_exp_f32 v82, v82
    v_fract_f32 v83, v83
    v_cos_f32 v70, v83
    v_sin_f32 v71, v83
    v_mul_f32 v70, v70, v82
    v_mul_f32 v71, v71, v82
    v_mul_f32 v84, v67, v71
    v_mul_f32 v85, v67, v70
    v_fma_f32 v70, v66, v70, -v84
    v_fma_f32 v71, -v66, v71, -v85
    v_mul_f32 v82, v64, v46
    v_mul_f32 v83, v65, v46
    v_exp_f32 v82, v82
    v_fract_f32 v83, v83
    v_cos_f32 v72, v83
    v_sin_f32 v73, v83
    v_mul_f32 v72, v72, v82
    v_mul_f32 v73, v73, v82
    v_mul_f32 v84, v67, v73
    v_mul_f32 v85, v67, v72
    v_fma_f32 v72, v66, v72, -v84
    v_fma_f32 v73, -v66, v73, -v85
    v_mfma_f32_16x16x4_f32 v[48:51], v68, v74, v[48:51]
    v_mfma_f32_16x16x4_f32 v[52:55], v70, v76, v[52:55]
    v_mfma_f32_16x16x4_f32 v[56:59], v70, v78, v[56:59]
    v_mfma_f32_16x16x4_f32 v[60:63], v72, v80, v[60:63]
    v_mfma_f32_16x16x4_f32 v[48:51], v69, v75, v[48:51]
    v_mfma_f32_16x16x4_f32 v[52:55], v71, v77, v[52:55]
    v_mfma_f32_16x16x4_f32 v[56:59], v71, v79, v[56:59]
    v_mfma_f32_16x16x4_f32 v[60:63], v73, v81, v[60:63]
    v_mov_b32_dpp v64, v28 row_newbcast:4 row_mask:0xf bank_mask:0xf
    v_mov_b32_dpp v65, v29 row_newbcast:4 row_mask:0xf bank_mask:0xf
    v_mov_b32_dpp v66, v30 row_newbcast:4 row_mask:0xf bank_mask:0xf
    v_mov_b32_dpp v67, v31 row_newbcast:4 row_mask:0xf bank_mask:0xf
    v_mul_f32 v82, v64, v47
    v_mul_f32 v83, v65, v47
    v_exp_f32 v82, v82
    v_fract_f32 v83, v83
    v_cos_f32 v74, v83
    v_sin_f32 v75, v83
    v_mul_f32 v74, v74, v82
    v_mul_f32 v75, v75, v82
    v_mul_f32 v84, v75, v75
    v_add_f32 v85, v74, v74
    v_fma_f32 v76, v74, v74, -v84
    v_mul_f32 v77, v85, v75
    v_mul_f32 v84, v77, v77
    v_add_f32 v85, v76, v76
    v_fma_f32 v78, v76, v76, -v84
    v_mul_f32 v79, v85, v77
    v_mul_f32 v84, v79, v79
    v_add_f32 v85, v78, v78
    v_fma_f32 v80, v78, v78, -v84
    v_mul_f32 v81, v85, v79
    v_mul_f32 v82, v64, v44
    v_mul_f32 v83, v65, v44
    v_exp_f32 v82, v82
    v_fract_f32 v83, v83
    v_cos_f32 v68, v83
    v_sin_f32 v69, v83
    v_mul_f32 v68, v68, v82
    v_mul_f32 v69, v69, v82
    v_mul_f32 v84, v67, v69
    v_mul_f32 v85, v67, v68
    v_fma_f32 v68, v66, v68, -v84
    v_fma_f32 v69, -v66, v69, -v85
    v_mul_f32 v82, v64, v45
    v_mul_f32 v83, v65, v45
    v_exp_f32 v82, v82
    v_fract_f32 v83, v83
    v_cos_f32 v70, v83
    v_sin_f32 v71, v83
    v_mul_f32 v70, v70, v82
    v_mul_f32 v71, v71, v82
    v_mul_f32 v84, v67, v71
    v_mul_f32 v85, v67, v70
    v_fma_f32 v70, v66, v70, -v84
    v_fma_f32 v71, -v66, v71, -v85
    v_mul_f32 v82, v64, v46
    v_mul_f32 v83, v65, v46
    v_exp_f32 v82, v82
    v_fract_f32 v83, v83
    v_cos_f32 v72, v83
    v_sin_f32 v73, v83
    v_mul_f32 v72, v72, v82
    v_mul_f32 v73, v73, v82
    v_mul_f32 v84, v67, v73
    v_mul_f32 v85, v67, v72
    v_fma_f32 v72, v66, v72, -v84
    v_fma_f32 v73, -v66, v73, -v85
    v_mfma_f32_16x16x4_f32 v[48:51], v68, v74, v[48:51]
    v_mfma_f32_16x16x4_f32 v[52:55], v70, v76, v[52:55]
    v_mfma_f32_16x16x4_f32 v[56:59], v70, v78, v[56:59]
    v_mfma_f32_16x16x4_f32 v[60:63], v72, v80, v[60:63]
    v_mfma_f32_16x16x4_f32 v[48:51], v69, v75, v[48:51]
    v_mfma_f32_16x16x4_f32 v[52:55], v71, v77, v[52:55]
    v_mfma_f32_16x16x4_f32 v[56:59], v71, v79, v[56:59]
    v_mfma_f32_16x16x4_f32 v[60:63], v73, v81, v[60:63]
    v_mov_b32_dpp v64, v28 row_newbcast:5 row_mask:0xf bank_mask:0xf
    v_mov_b32_dpp v65, v29 row_newbcast:5 row_mask:0xf bank_mask:0xf
    v_mov_b32_dpp v66, v30 row_newbcast:5 row_mask:0xf bank_mask:0xf
    v_mov_b32_dpp v67, v31 row_newbcast:5 row_mask:0xf bank_mask:0xf
    v_mul_f32 v82, v64, v47
    v_mul_f32 v83, v65, v47
    v_exp_f32 v82, v82
    v_fract_f32 v83, v83
    v_cos_f32 v74, v83
    v_sin_f32 v75, v83
    v_mul_f32 v74, v74, v82
    v_mul_f32 v75, v75, v82
    v_mul_f32 v84, v75, v75
    v_add_f32 v85, v74, v74
    v_fma_f32 v76, v74, v74, -v84
    v_mul_f32 v77, v85, v75
    v_mul_f32 v84, v77, v77
    v_add_f32 v85, v76, v76
    v_fma_f32 v78, v76, v76, -v84
    v_mul_f32 v79, v85, v77
    v_mul_f32 v84, v79, v79
    v_add_f32 v85, v78, v78
    v_fma_f32 v80, v78, v78, -v84
    v_mul_f32 v81, v85, v79
    v_mul_f32 v82, v64, v44
    v_mul_f32 v83, v65, v44
    v_exp_f32 v82, v82
    v_fract_f32 v83, v83
    v_cos_f32 v68, v83
    v_sin_f32 v69, v83
    v_mul_f32 v68, v68, v82
    v_mul_f32 v69, v69, v82
    v_mul_f32 v84, v67, v69
    v_mul_f32 v85, v67, v68
    v_fma_f32 v68, v66, v68, -v84
    v_fma_f32 v69, -v66, v69, -v85
    v_mul_f32 v82, v64, v45
    v_mul_f32 v83, v65, v45
    v_exp_f32 v82, v82
    v_fract_f32 v83, v83
    v_cos_f32 v70, v83
    v_sin_f32 v71, v83
    v_mul_f32 v70, v70, v82
    v_mul_f32 v71, v71, v82
    v_mul_f32 v84, v67, v71
    v_mul_f32 v85, v67, v70
    v_fma_f32 v70, v66, v70, -v84
    v_fma_f32 v71, -v66, v71, -v85
    v_mul_f32 v82, v64, v46
    v_mul_f32 v83, v65, v46
    v_exp_f32 v82, v82
    v_fract_f32 v83, v83
    v_cos_f32 v72, v83
    v_sin_f32 v73, v83
    v_mul_f32 v72, v72, v82
    v_mul_f32 v73, v73, v82
    v_mul_f32 v84, v67, v73
    v_mul_f32 v85, v67, v72
    v_fma_f32 v72, v66, v72, -v84
    v_fma_f32 v73, -v66, v73, -v85
    v_mfma_f32_16x16x4_f32 v[48:51], v68, v74, v[48:51]
    v_mfma_f32_16x16x4_f32 v[52:55], v70, v76, v[52:55]
    v_mfma_f32_16x16x4_f32 v[56:59], v70, v78, v[56:59]
    v_mfma_f32_16x16x4_f32 v[60:63], v72, v80, v[60:63]
    v_mfma_f32_16x16x4_f32 v[48:51], v69, v75, v[48:51]
    v_mfma_f32_16x16x4_f32 v[52:55], v71, v77, v[52:55]
    v_mfma_f32_16x16x4_f32 v[56:59], v71, v79, v[56:59]
    v_mfma_f32_16x16x4_f32 v[60:63], v73, v81, v[60:63]
    v_mov_b32_dpp v64, v28 row_newbcast:6 row_mask:0xf bank_mask:0xf
    v_mov_b32_dpp v65, v29 row_newbcast:6 row_mask:0xf bank_mask:0xf
    v_mov_b32_dpp v66, v30 row_newbcast:6 row_mask:0xf bank_mask:0xf
    v_mov_b32_dpp v67, v31 row_newbcast:6 row_mask:0xf bank_mask:0xf
    v_mul_f32 v82, v64, v47
    v_mul_f32 v83, v65, v47
    v_exp_f32 v82, v82
    v_fract_f32 v83, v83
    v_cos_f32 v74, v83
    v_sin_f32 v75, v83
    v_mul_f32 v74, v74, v82
    v_mul_f32 v75, v75, v82
    v_mul_f32 v84, v75, v75
    v_add_f32 v85, v74, v74
    v_fma_f32 v76, v74, v74, -v84
    v_mul_f32 v77, v85, v75
    v_mul_f32 v84, v77, v77
    v_add_f32 v85, v76, v76
    v_fma_f32 v78, v76, v76, -v84
    v_mul_f32 v79, v85, v77
    v_mul_f32 v84, v79, v79
    v_add_f32 v85, v78, v78
    v_fma_f32 v80, v78, v78, -v84
    v_mul_f32 v81, v85, v79
    v_mul_f32 v82, v64, v44
    v_mul_f32 v83, v65, v44
    v_exp_f32 v82, v82
    v_fract_f32 v83, v83
    v_cos_f32 v68, v83
    v_sin_f32 v69, v83
    v_mul_f32 v68, v68, v82
    v_mul_f32 v69, v69, v82
    v_mul_f32 v84, v67, v69
    v_mul_f32 v85, v67, v68
    v_fma_f32 v68, v66, v68, -v84
    v_fma_f32 v69, -v66, v69, -v85
    v_mul_f32 v82, v64, v45
    v_mul_f32 v83, v65, v45
    v_exp_f32 v82, v82
    v_fract_f32 v83, v83
    v_cos_f32 v70, v83
    v_sin_f32 v71, v83
    v_mul_f32 v70, v70, v82
    v_mul_f32 v71, v71, v82
    v_mul_f32 v84, v67, v71
    v_mul_f32 v85, v67, v70
    v_fma_f32 v70, v66, v70, -v84
    v_fma_f32 v71, -v66, v71, -v85
    v_mul_f32 v82, v64, v46
    v_mul_f32 v83, v65, v46
    v_exp_f32 v82, v82
    v_fract_f32 v83, v83
    v_cos_f32 v72, v83
    v_sin_f32 v73, v83
    v_mul_f32 v72, v72, v82
    v_mul_f32 v73, v73, v82
    v_mul_f32 v84, v67, v73
    v_mul_f32 v85, v67, v72
    v_fma_f32 v72, v66, v72, -v84
    v_fma_f32 v73, -v66, v73, -v85
    v_mfma_f32_16x16x4_f32 v[48:51], v68, v74, v[48:51]
    v_mfma_f32_16x16x4_f32 v[52:55], v70, v76, v[52:55]
    v_mfma_f32_16x16x4_f32 v[56:59], v70, v78, v[56:59]
    v_mfma_f32_16x16x4_f32 v[60:63], v72, v80, v[60:63]
    v_mfma_f32_16x16x4_f32 v[48:51], v69, v75, v[48:51]
    v_mfma_f32_16x16x4_f32 v[52:55], v71, v77, v[52:55]
    v_mfma_f32_16x16x4_f32 v[56:59], v71, v79, v[56:59]
    v_mfma_f32_16x16x4_f32 v[60:63], v73, v81, v[60:63]
    v_mov_b32_dpp v64, v28 row_newbcast:7 row_mask:0xf bank_mask:0xf
    v_mov_b32_dpp v65, v29 row_newbcast:7 row_mask:0xf bank_mask:0xf
    v_mov_b32_dpp v66, v30 row_newbcast:7 row_mask:0xf bank_mask:0xf
    v_mov_b32_dpp v67, v31 row_newbcast:7 row_mask:0xf bank_mask:0xf
    v_mul_f32 v82, v64, v47
    v_mul_f32 v83, v65, v47
    v_exp_f32 v82, v82
    v_fract_f32 v83, v83
    v_cos_f32 v74, v83
    v_sin_f32 v75, v83
    v_mul_f32 v74, v74, v82
    v_mul_f32 v75, v75, v82
    v_mul_f32 v84, v75, v75
    v_add_f32 v85, v74, v74
    v_fma_f32 v76, v74, v74, -v84
    v_mul_f32 v77, v85, v75
    v_mul_f32 v84, v77, v77
    v_add_f32 v85, v76, v76
    v_fma_f32 v78, v76, v76, -v84
    v_mul_f32 v79, v85, v77
    v_mul_f32 v84, v79, v79
    v_add_f32 v85, v78, v78
    v_fma_f32 v80, v78, v78, -v84
    v_mul_f32 v81, v85, v79
    v_mul_f32 v82, v64, v44
    v_mul_f32 v83, v65, v44
    v_exp_f32 v82, v82
    v_fract_f32 v83, v83
    v_cos_f32 v68, v83
    v_sin_f32 v69, v83
    v_mul_f32 v68, v68, v82
    v_mul_f32 v69, v69, v82
    v_mul_f32 v84, v67, v69
    v_mul_f32 v85, v67, v68
    v_fma_f32 v68, v66, v68, -v84
    v_fma_f32 v69, -v66, v69, -v85
    v_mul_f32 v82, v64, v45
    v_mul_f32 v83, v65, v45
    v_exp_f32 v82, v82
    v_fract_f32 v83, v83
    v_cos_f32 v70, v83
    v_sin_f32 v71, v83
    v_mul_f32 v70, v70, v82
    v_mul_f32 v71, v71, v82
    v_mul_f32 v84, v67, v71
    v_mul_f32 v85, v67, v70
    v_fma_f32 v70, v66, v70, -v84
    v_fma_f32 v71, -v66, v71, -v85
    v_mul_f32 v82, v64, v46
    v_mul_f32 v83, v65, v46
    v_exp_f32 v82, v82
    v_fract_f32 v83, v83
    v_cos_f32 v72, v83
    v_sin_f32 v73, v83
    v_mul_f32 v72, v72, v82
    v_mul_f32 v73, v73, v82
    v_mul_f32 v84, v67, v73
    v_mul_f32 v85, v67, v72
    v_fma_f32 v72, v66, v72, -v84
    v_fma_f32 v73, -v66, v73, -v85
    v_mfma_f32_16x16x4_f32 v[48:51], v68, v74, v[48:51]
    v_mfma_f32_16x16x4_f32 v[52:55], v70, v76, v[52:55]
    v_mfma_f32_16x16x4_f32 v[56:59], v70, v78, v[56:59]
    v_mfma_f32_16x16x4_f32 v[60:63], v72, v80, v[60:63]
    v_mfma_f32_16x16x4_f32 v[48:51], v69, v75, v[48:51]
    v_mfma_f32_16x16x4_f32 v[52:55], v71, v77, v[52:55]
    v_mfma_f32_16x16x4_f32 v[56:59], v71, v79, v[56:59]
    v_mfma_f32_16x16x4_f32 v[60:63], v73, v81, v[60:63]
    v_mov_b32_dpp v64, v28 row_newbcast:8 row_mask:0xf bank_mask:0xf
    v_mov_b32_dpp v65, v29 row_newbcast:8 row_mask:0xf bank_mask:0xf
    v_mov_b32_dpp v66, v30 row_newbcast:8 row_mask:0xf bank_mask:0xf
    v_mov_b32_dpp v67, v31 row_newbcast:8 row_mask:0xf bank_mask:0xf
    v_mul_f32 v82, v64, v47
    v_mul_f32 v83, v65, v47
    v_exp_f32 v82, v82
    v_fract_f32 v83, v83
    v_cos_f32 v74, v83
    v_sin_f32 v75, v83
    v_mul_f32 v74, v74, v82
    v_mul_f32 v75, v75, v82
    v_mul_f32 v84, v75, v75
    v_add_f32 v85, v74, v74
    v_fma_f32 v76, v74, v74, -v84
    v_mul_f32 v77, v85, v75
    v_mul_f32 v84, v77, v77
    v_add_f32 v85, v76, v76
    v_fma_f32 v78, v76, v76, -v84
    v_mul_f32 v79, v85, v77
    v_mul_f32 v84, v79, v79
    v_add_f32 v85, v78, v78
    v_fma_f32 v80, v78, v78, -v84
    v_mul_f32 v81, v85, v79
    v_mul_f32 v82, v64, v44
    v_mul_f32 v83, v65, v44
    v_exp_f32 v82, v82
    v_fract_f32 v83, v83
    v_cos_f32 v68, v83
    v_sin_f32 v69, v83
    v_mul_f32 v68, v68, v82
    v_mul_f32 v69, v69, v82
    v_mul_f32 v84, v67, v69
    v_mul_f32 v85, v67, v68
    v_fma_f32 v68, v66, v68, -v84
    v_fma_f32 v69, -v66, v69, -v85
    v_mul_f32 v82, v64, v45
    v_mul_f32 v83, v65, v45
    v_exp_f32 v82, v82
    v_fract_f32 v83, v83
    v_cos_f32 v70, v83
    v_sin_f32 v71, v83
    v_mul_f32 v70, v70, v82
    v_mul_f32 v71, v71, v82
    v_mul_f32 v84, v67, v71
    v_mul_f32 v85, v67, v70
    v_fma_f32 v70, v66, v70, -v84
    v_fma_f32 v71, -v66, v71, -v85
    v_mul_f32 v82, v64, v46
    v_mul_f32 v83, v65, v46
    v_exp_f32 v82, v82
    v_fract_f32 v83, v83
    v_cos_f32 v72, v83
    v_sin_f32 v73, v83
    v_mul_f32 v72, v72, v82
    v_mul_f32 v73, v73, v82
    v_mul_f32 v84, v67, v73
    v_mul_f32 v85, v67, v72
    v_fma_f32 v72, v66, v72, -v84
    v_fma_f32 v73, -v66, v73, -v85
    v_mfma_f32_16x16x4_f32 v[48:51], v68, v74, v[48:51]
    v_mfma_f32_16x16x4_f32 v[52:55], v70, v76, v[52:55]
    v_mfma_f32_16x16x4_f32 v[56:59], v70, v78, v[56:59]
    v_mfma_f32_16x16x4_f32 v[60:63], v72, v80, v[60:63]
    v_mfma_f32_16x16x4_f32 v[48:51], v69, v75, v[48:51]
    v_mfma_f32_16x16x4_f32 v[52:55], v71, v77, v[52:55]
    v_mfma_f32_16x16x4_f32 v[56:59], v71, v79, v[56:59]
    v_mfma_f32_16x16x4_f32 v[60:63], v73, v81, v[60:63]
    v_mov_b32_dpp v64, v28 row_newbcast:9 row_mask:0xf bank_mask:0xf
    v_mov_b32_dpp v65, v29 row_newbcast:9 row_mask:0xf bank_mask:0xf
    v_mov_b32_dpp v66, v30 row_newbcast:9 row_mask:0xf bank_mask:0xf
    v_mov_b32_dpp v67, v31 row_newbcast:9 row_mask:0xf bank_mask:0xf
    v_mul_f32 v82, v64, v47
    v_mul_f32 v83, v65, v47
    v_exp_f32 v82, v82
    v_fract_f32 v83, v83
    v_cos_f32 v74, v83
    v_sin_f32 v75, v83
    v_mul_f32 v74, v74, v82
    v_mul_f32 v75, v75, v82
    v_mul_f32 v84, v75, v75
    v_add_f32 v85, v74, v74
    v_fma_f32 v76, v74, v74, -v84
    v_mul_f32 v77, v85, v75
    v_mul_f32 v84, v77, v77
    v_add_f32 v85, v76, v76
    v_fma_f32 v78, v76, v76, -v84
    v_mul_f32 v79, v85, v77
    v_mul_f32 v84, v79, v79
    v_add_f32 v85, v78, v78
    v_fma_f32 v80, v78, v78, -v84
    v_mul_f32 v81, v85, v79
    v_mul_f32 v82, v64, v44
    v_mul_f32 v83, v65, v44
    v_exp_f32 v82, v82
    v_fract_f32 v83, v83
    v_cos_f32 v68, v83
    v_sin_f32 v69, v83
    v_mul_f32 v68, v68, v82
    v_mul_f32 v69, v69, v82
    v_mul_f32 v84, v67, v69
    v_mul_f32 v85, v67, v68
    v_fma_f32 v68, v66, v68, -v84
    v_fma_f32 v69, -v66, v69, -v85
    v_mul_f32 v82, v64, v45
    v_mul_f32 v83, v65, v45
    v_exp_f32 v82, v82
    v_fract_f32 v83, v83
    v_cos_f32 v70, v83
    v_sin_f32 v71, v83
    v_mul_f32 v70, v70, v82
    v_mul_f32 v71, v71, v82
    v_mul_f32 v84, v67, v71
    v_mul_f32 v85, v67, v70
    v_fma_f32 v70, v66, v70, -v84
    v_fma_f32 v71, -v66, v71, -v85
    v_mul_f32 v82, v64, v46
    v_mul_f32 v83, v65, v46
    v_exp_f32 v82, v82
    v_fract_f32 v83, v83
    v_cos_f32 v72, v83
    v_sin_f32 v73, v83
    v_mul_f32 v72, v72, v82
    v_mul_f32 v73, v73, v82
    v_mul_f32 v84, v67, v73
    v_mul_f32 v85, v67, v72
    v_fma_f32 v72, v66, v72, -v84
    v_fma_f32 v73, -v66, v73, -v85
    v_mfma_f32_16x16x4_f32 v[48:51], v68, v74, v[48:51]
    v_mfma_f32_16x16x4_f32 v[52:55], v70, v76, v[52:55]
    v_mfma_f32_16x16x4_f32 v[56:59], v70, v78, v[56:59]
    v_mfma_f32_16x16x4_f32 v[60:63], v72, v80, v[60:63]
    v_mfma_f32_16x16x4_f32 v[48:51], v69, v75, v[48:51]
    v_mfma_f32_16x16x4_f32 v[52:55], v71, v77, v[52:55]
    v_mfma_f32_16x16x4_f32 v[56:59], v71, v79, v[56:59]
    v_mfma_f32_16x16x4_f32 v[60:63], v73, v81, v[60:63]
    v_mov_b32_dpp v64, v28 row_newbcast:10 row_mask:0xf bank_mask:0xf
    v_mov_b32_dpp v65, v29 row_newbcast:10 row_mask:0xf bank_mask:0xf
    v_mov_b32_dpp v66, v30 row_newbcast:10 row_mask:0xf bank_mask:0xf
    v_mov_b32_dpp v67, v31 row_newbcast:10 row_mask:0xf bank_mask:0xf
    v_mul_f32 v82, v64, v47
    v_mul_f32 v83, v65, v47
    v_exp_f32 v82, v82
    v_fract_f32 v83, v83
    v_cos_f32 v74, v83
    v_sin_f32 v75, v83
    v_mul_f32 v74, v74, v82
    v_mul_f32 v75, v75, v82
    v_mul_f32 v84, v75, v75
    v_add_f32 v85, v74, v74
    v_fma_f32 v76, v74, v74, -v84
    v_mul_f32 v77, v85, v75
    v_mul_f32 v84, v77, v77
    v_add_f32 v85, v76, v76
    v_fma_f32 v78, v76, v76, -v84
    v_mul_f32 v79, v85, v77
    v_mul_f32 v84, v79, v79
    v_add_f32 v85, v78, v78
    v_fma_f32 v80, v78, v78, -v84
    v_mul_f32 v81, v85, v79
    v_mul_f32 v82, v64, v44
    v_mul_f32 v83, v65, v44
    v_exp_f32 v82, v82
    v_fract_f32 v83, v83
    v_cos_f32 v68, v83
    v_sin_f32 v69, v83
    v_mul_f32 v68, v68, v82
    v_mul_f32 v69, v69, v82
    v_mul_f32 v84, v67, v69
    v_mul_f32 v85, v67, v68
    v_fma_f32 v68, v66, v68, -v84
    v_fma_f32 v69, -v66, v69, -v85
    v_mul_f32 v82, v64, v45
    v_mul_f32 v83, v65, v45
    v_exp_f32 v82, v82
    v_fract_f32 v83, v83
    v_cos_f32 v70, v83
    v_sin_f32 v71, v83
    v_mul_f32 v70, v70, v82
    v_mul_f32 v71, v71, v82
    v_mul_f32 v84, v67, v71
    v_mul_f32 v85, v67, v70
    v_fma_f32 v70, v66, v70, -v84
    v_fma_f32 v71, -v66, v71, -v85
    v_mul_f32 v82, v64, v46
    v_mul_f32 v83, v65, v46
    v_exp_f32 v82, v82
    v_fract_f32 v83, v83
    v_cos_f32 v72, v83
    v_sin_f32 v73, v83
    v_mul_f32 v72, v72, v82
    v_mul_f32 v73, v73, v82
    v_mul_f32 v84, v67, v73
    v_mul_f32 v85, v67, v72
    v_fma_f32 v72, v66, v72, -v84
    v_fma_f32 v73, -v66, v73, -v85
    v_mfma_f32_16x16x4_f32 v[48:51], v68, v74, v[48:51]
    v_mfma_f32_16x16x4_f32 v[52:55], v70, v76, v[52:55]
    v_mfma_f32_16x16x4_f32 v[56:59], v70, v78, v[56:59]
    v_mfma_f32_16x16x4_f32 v[60:63], v72, v80, v[60:63]
    v_mfma_f32_16x16x4_f32 v[48:51], v69, v75, v[48:51]
    v_mfma_f32_16x16x4_f32 v[52:55], v71, v77, v[52:55]
    v_mfma_f32_16x16x4_f32 v[56:59], v71, v79, v[56:59]
    v_mfma_f32_16x16x4_f32 v[60:63], v73, v81, v[60:63]
    v_mov_b32_dpp v64, v28 row_newbcast:11 row_mask:0xf bank_mask:0xf
    v_mov_b32_dpp v65, v29 row_newbcast:11 row_mask:0xf bank_mask:0xf
    v_mov_b32_dpp v66, v30 row_newbcast:11 row_mask:0xf bank_mask:0xf
    v_mov_b32_dpp v67, v31 row_newbcast:11 row_mask:0xf bank_mask:0xf
    v_mul_f32 v82, v64, v47
    v_mul_f32 v83, v65, v47
    v_exp_f32 v82, v82
    v_fract_f32 v83, v83
    v_cos_f32 v74, v83
    v_sin_f32 v75, v83
    v_mul_f32 v74, v74, v82
    v_mul_f32 v75, v75, v82
    v_mul_f32 v84, v75, v75
    v_add_f32 v85, v74, v74
    v_fma_f32 v76, v74, v74, -v84
    v_mul_f32 v77, v85, v75
    v_mul_f32 v84, v77, v77
    v_add_f32 v85, v76, v76
    v_fma_f32 v78, v76, v76, -v84
    v_mul_f32 v79, v85, v77
    v_mul_f32 v84, v79, v79
    v_add_f32 v85, v78, v78
    v_fma_f32 v80, v78, v78, -v84
    v_mul_f32 v81, v85, v79
    v_mul_f32 v82, v64, v44
    v_mul_f32 v83, v65, v44
    v_exp_f32 v82, v82
    v_fract_f32 v83, v83
    v_cos_f32 v68, v83
    v_sin_f32 v69, v83
    v_mul_f32 v68, v68, v82
    v_mul_f32 v69, v69, v82
    v_mul_f32 v84, v67, v69
    v_mul_f32 v85, v67, v68
    v_fma_f32 v68, v66, v68, -v84
    v_fma_f32 v69, -v66, v69, -v85
    v_mul_f32 v82, v64, v45
    v_mul_f32 v83, v65, v45
    v_exp_f32 v82, v82
    v_fract_f32 v83, v83
    v_cos_f32 v70, v83
    v_sin_f32 v71, v83
    v_mul_f32 v70, v70, v82
    v_mul_f32 v71, v71, v82
    v_mul_f32 v84, v67, v71
    v_mul_f32 v85, v67, v70
    v_fma_f32 v70, v66, v70, -v84
    v_fma_f32 v71, -v66, v71, -v85
    v_mul_f32 v82, v64, v46
    v_mul_f32 v83, v65, v46
    v_exp_f32 v82, v82
    v_fract_f32 v83, v83
    v_cos_f32 v72, v83
    v_sin_f32 v73, v83
    v_mul_f32 v72, v72, v82
    v_mul_f32 v73, v73, v82
    v_mul_f32 v84, v67, v73
    v_mul_f32 v85, v67, v72
    v_fma_f32 v72, v66, v72, -v84
    v_fma_f32 v73, -v66, v73, -v85
    v_mfma_f32_16x16x4_f32 v[48:51], v68, v74, v[48:51]
    v_mfma_f32_16x16x4_f32 v[52:55], v70, v76, v[52:55]
    v_mfma_f32_16x16x4_f32 v[56:59], v70, v78, v[56:59]
    v_mfma_f32_16x16x4_f32 v[60:63], v72, v80, v[60:63]
    v_mfma_f32_16x16x4_f32 v[48:51], v69, v75, v[48:51]
    v_mfma_f32_16x16x4_f32 v[52:55], v71, v77, v[52:55]
    v_mfma_f32_16x16x4_f32 v[56:59], v71, v79, v[56:59]
    v_mfma_f32_16x16x4_f32 v[60:63], v73, v81, v[60:63]
    v_mov_b32_dpp v64, v28 row_newbcast:12 row_mask:0xf bank_mask:0xf
    v_mov_b32_dpp v65, v29 row_newbcast:12 row_mask:0xf bank_mask:0xf
    v_mov_b32_dpp v66, v30 row_newbcast:12 row_mask:0xf bank_mask:0xf
    v_mov_b32_dpp v67, v31 row_newbcast:12 row_mask:0xf bank_mask:0xf
    v_mul_f32 v82, v64, v47
    v_mul_f32 v83, v65, v47
    v_exp_f32 v82, v82
    v_fract_f32 v83, v83
    v_cos_f32 v74, v83
    v_sin_f32 v75, v83
    v_mul_f32 v74, v74, v82
    v_mul_f32 v75, v75, v82
    v_mul_f32 v84, v75, v75
    v_add_f32 v85, v74, v74
    v_fma_f32 v76, v74, v74, -v84
    v_mul_f32 v77, v85, v75
    v_mul_f32 v84, v77, v77
    v_add_f32 v85, v76, v76
    v_fma_f32 v78, v76, v76, -v84
    v_mul_f32 v79, v85, v77
    v_mul_f32 v84, v79, v79
    v_add_f32 v85, v78, v78
    v_fma_f32 v80, v78, v78, -v84
    v_mul_f32 v81, v85, v79
    v_mul_f32 v82, v64, v44
    v_mul_f32 v83, v65, v44
    v_exp_f32 v82, v82
    v_fract_f32 v83, v83
    v_cos_f32 v68, v83
    v_sin_f32 v69, v83
    v_mul_f32 v68, v68, v82
    v_mul_f32 v69, v69, v82
    v_mul_f32 v84, v67, v69
    v_mul_f32 v85, v67, v68
    v_fma_f32 v68, v66, v68, -v84
    v_fma_f32 v69, -v66, v69, -v85
    v_mul_f32 v82, v64, v45
    v_mul_f32 v83, v65, v45
    v_exp_f32 v82, v82
    v_fract_f32 v83, v83
    v_cos_f32 v70, v83
    v_sin_f32 v71, v83
    v_mul_f32 v70, v70, v82
    v_mul_f32 v71, v71, v82
    v_mul_f32 v84, v67, v71
    v_mul_f32 v85, v67, v70
    v_fma_f32 v70, v66, v70, -v84
    v_fma_f32 v71, -v66, v71, -v85
    v_mul_f32 v82, v64, v46
    v_mul_f32 v83, v65, v46
    v_exp_f32 v82, v82
    v_fract_f32 v83, v83
    v_cos_f32 v72, v83
    v_sin_f32 v73, v83
    v_mul_f32 v72, v72, v82
    v_mul_f32 v73, v73, v82
    v_mul_f32 v84, v67, v73
    v_mul_f32 v85, v67, v72
    v_fma_f32 v72, v66, v72, -v84
    v_fma_f32 v73, -v66, v73, -v85
    v_mfma_f32_16x16x4_f32 v[48:51], v68, v74, v[48:51]
    v_mfma_f32_16x16x4_f32 v[52:55], v70, v76, v[52:55]
    v_mfma_f32_16x16x4_f32 v[56:59], v70, v78, v[56:59]
    v_mfma_f32_16x16x4_f32 v[60:63], v72, v80, v[60:63]
    v_mfma_f32_16x16x4_f32 v[48:51], v69, v75, v[48:51]
    v_mfma_f32_16x16x4_f32 v[52:55], v71, v77, v[52:55]
    v_mfma_f32_16x16x4_f32 v[56:59], v71, v79, v[56:59]
    v_mfma_f32_16x16x4_f32 v[60:63], v73, v81, v[60:63]
    v_mov_b32_dpp v64, v28 row_newbcast:13 row_mask:0xf bank_mask:0xf
    v_mov_b32_dpp v65, v29 row_newbcast:13 row_mask:0xf bank_mask:0xf
    v_mov_b32_dpp v66, v30 row_newbcast:13 row_mask:0xf bank_mask:0xf
    v_mov_b32_dpp v67, v31 row_newbcast:13 row_mask:0xf bank_mask:0xf
    v_mul_f32 v82, v64, v47
    v_mul_f32 v83, v65, v47
    v_exp_f32 v82, v82
    v_fract_f32 v83, v83
    v_cos_f32 v74, v83
    v_sin_f32 v75, v83
    v_mul_f32 v74, v74, v82
    v_mul_f32 v75, v75, v82
    v_mul_f32 v84, v75, v75
    v_add_f32 v85, v74, v74
    v_fma_f32 v76, v74, v74, -v84
    v_mul_f32 v77, v85, v75
    v_mul_f32 v84, v77, v77
    v_add_f32 v85, v76, v76
    v_fma_f32 v78, v76, v76, -v84
    v_mul_f32 v79, v85, v77
    v_mul_f32 v84, v79, v79
    v_add_f32 v85, v78, v78
    v_fma_f32 v80, v78, v78, -v84
    v_mul_f32 v81, v85, v79
    v_mul_f32 v82, v64, v44
    v_mul_f32 v83, v65, v44
    v_exp_f32 v82, v82
    v_fract_f32 v83, v83
    v_cos_f32 v68, v83
    v_sin_f32 v69, v83
    v_mul_f32 v68, v68, v82
    v_mul_f32 v69, v69, v82
    v_mul_f32 v84, v67, v69
    v_mul_f32 v85, v67, v68
    v_fma_f32 v68, v66, v68, -v84
    v_fma_f32 v69, -v66, v69, -v85
    v_mul_f32 v82, v64, v45
    v_mul_f32 v83, v65, v45
    v_exp_f32 v82, v82
    v_fract_f32 v83, v83
    v_cos_f32 v70, v83
    v_sin_f32 v71, v83
    v_mul_f32 v70, v70, v82
    v_mul_f32 v71, v71, v82
    v_mul_f32 v84, v67, v71
    v_mul_f32 v85, v67, v70
    v_fma_f32 v70, v66, v70, -v84
    v_fma_f32 v71, -v66, v71, -v85
    v_mul_f32 v82, v64, v46
    v_mul_f32 v83, v65, v46
    v_exp_f32 v82, v82
    v_fract_f32 v83, v83
    v_cos_f32 v72, v83
    v_sin_f32 v73, v83
    v_mul_f32 v72, v72, v82
    v_mul_f32 v73, v73, v82
    v_mul_f32 v84, v67, v73
    v_mul_f32 v85, v67, v72
    v_fma_f32 v72, v66, v72, -v84
    v_fma_f32 v73, -v66, v73, -v85
    v_mfma_f32_16x16x4_f32 v[48:51], v68, v74, v[48:51]
    v_mfma_f32_16x16x4_f32 v[52:55], v70, v76, v[52:55]
    v_mfma_f32_16x16x4_f32 v[56:59], v70, v78, v[56:59]
    v_mfma_f32_16x16x4_f32 v[60:63], v72, v80, v[60:63]
    v_mfma_f32_16x16x4_f32 v[48:51], v69, v75, v[48:51]
    v_mfma_f32_16x16x4_f32 v[52:55], v71, v77, v[52:55]
    v_mfma_f32_16x16x4_f32 v[56:59], v71, v79, v[56:59]
    v_mfma_f32_16x16x4_f32 v[60:63], v73, v81, v[60:63]
    v_mov_b32_dpp v64, v28 row_newbcast:14 row_mask:0xf bank_mask:0xf
    v_mov_b32_dpp v65, v29 row_newbcast:14 row_mask:0xf bank_mask:0xf
    v_mov_b32_dpp v66, v30 row_newbcast:14 row_mask:0xf bank_mask:0xf
    v_mov_b32_dpp v67, v31 row_newbcast:14 row_mask:0xf bank_mask:0xf
    v_mul_f32 v82, v64, v47
    v_mul_f32 v83, v65, v47
    v_exp_f32 v82, v82
    v_fract_f32 v83, v83
    v_cos_f32 v74, v83
    v_sin_f32 v75, v83
    v_mul_f32 v74, v74, v82
    v_mul_f32 v75, v75, v82
    v_mul_f32 v84, v75, v75
    v_add_f32 v85, v74, v74
    v_fma_f32 v76, v74, v74, -v84
    v_mul_f32 v77, v85, v75
    v_mul_f32 v84, v77, v77
    v_add_f32 v85, v76, v76
    v_fma_f32 v78, v76, v76, -v84
    v_mul_f32 v79, v85, v77
    v_mul_f32 v84, v79, v79
    v_add_f32 v85, v78, v78
    v_fma_f32 v80, v78, v78, -v84
    v_mul_f32 v81, v85, v79
    v_mul_f32 v82, v64, v44
    v_mul_f32 v83, v65, v44
    v_exp_f32 v82, v82
    v_fract_f32 v83, v83
    v_cos_f32 v68, v83
    v_sin_f32 v69, v83
    v_mul_f32 v68, v68, v82
    v_mul_f32 v69, v69, v82
    v_mul_f32 v84, v67, v69
    v_mul_f32 v85, v67, v68
    v_fma_f32 v68, v66, v68, -v84
    v_fma_f32 v69, -v66, v69, -v85
    v_mul_f32 v82, v64, v45
    v_mul_f32 v83, v65, v45
    v_exp_f32 v82, v82
    v_fract_f32 v83, v83
    v_cos_f32 v70, v83
    v_sin_f32 v71, v83
    v_mul_f32 v70, v70, v82
    v_mul_f32 v71, v71, v82
    v_mul_f32 v84, v67, v71
    v_mul_f32 v85, v67, v70
    v_fma_f32 v70, v66, v70, -v84
    v_fma_f32 v71, -v66, v71, -v85
    v_mul_f32 v82, v64, v46
    v_mul_f32 v83, v65, v46
    v_exp_f32 v82, v82
    v_fract_f32 v83, v83
    v_cos_f32 v72, v83
    v_sin_f32 v73, v83
    v_mul_f32 v72, v72, v82
    v_mul_f32 v73, v73, v82
    v_mul_f32 v84, v67, v73
    v_mul_f32 v85, v67, v72
    v_fma_f32 v72, v66, v72, -v84
    v_fma_f32 v73, -v66, v73, -v85
    v_mfma_f32_16x16x4_f32 v[48:51], v68, v74, v[48:51]
    v_mfma_f32_16x16x4_f32 v[52:55], v70, v76, v[52:55]
    v_mfma_f32_16x16x4_f32 v[56:59], v70, v78, v[56:59]
    v_mfma_f32_16x16x4_f32 v[60:63], v72, v80, v[60:63]
    v_mfma_f32_16x16x4_f32 v[48:51], v69, v75, v[48:51]
    v_mfma_f32_16x16x4_f32 v[52:55], v71, v77, v[52:55]
    v_mfma_f32_16x16x4_f32 v[56:59], v71, v79, v[56:59]
    v_mfma_f32_16x16x4_f32 v[60:63], v73, v81, v[60:63]
    v_mov_b32_dpp v64, v28 row_newbcast:15 row_mask:0xf bank_mask:0xf
    v_mov_b32_dpp v65, v29 row_newbcast:15 row_mask:0xf bank_mask:0xf
    v_mov_b32_dpp v66, v30 row_newbcast:15 row_mask:0xf bank_mask:0xf
    v_mov_b32_dpp v67, v31 row_newbcast:15 row_mask:0xf bank_mask:0xf
    v_mul_f32 v82, v64, v47
    v_mul_f32 v83, v65, v47
    v_exp_f32 v82, v82
    v_fract_f32 v83, v83
    v_cos_f32 v74, v83
    v_sin_f32 v75, v83
    v_mul_f32 v74, v74, v82
    v_mul_f32 v75, v75, v82
    v_mul_f32 v84, v75, v75
    v_add_f32 v85, v74, v74
    v_fma_f32 v76, v74, v74, -v84
    v_mul_f32 v77, v85, v75
    v_mul_f32 v84, v77, v77
    v_add_f32 v85, v76, v76
    v_fma_f32 v78, v76, v76, -v84
    v_mul_f32 v79, v85, v77
    v_mul_f32 v84, v79, v79
    v_add_f32 v85, v78, v78
    v_fma_f32 v80, v78, v78, -v84
    v_mul_f32 v81, v85, v79
    v_mul_f32 v82, v64, v44
    v_mul_f32 v83, v65, v44
    v_exp_f32 v82, v82
    v_fract_f32 v83, v83
    v_cos_f32 v68, v83
    v_sin_f32 v69, v83
    v_mul_f32 v68, v68, v82
    v_mul_f32 v69, v69, v82
    v_mul_f32 v84, v67, v69
    v_mul_f32 v85, v67, v68
    v_fma_f32 v68, v66, v68, -v84
    v_fma_f32 v69, -v66, v69, -v85
    v_mul_f32 v82, v64, v45
    v_mul_f32 v83, v65, v45
    v_exp_f32 v82, v82
    v_fract_f32 v83, v83
    v_cos_f32 v70, v83
    v_sin_f32 v71, v83
    v_mul_f32 v70, v70, v82
    v_mul_f32 v71, v71, v82
    v_mul_f32 v84, v67, v71
    v_mul_f32 v85, v67, v70
    v_fma_f32 v70, v66, v70, -v84
    v_fma_f32 v71, -v66, v71, -v85
    v_mul_f32 v82, v64, v46
    v_mul_f32 v83, v65, v46
    v_exp_f32 v82, v82
    v_fract_f32 v83, v83
    v_cos_f32 v72, v83
    v_sin_f32 v73, v83
    v_mul_f32 v72, v72, v82
    v_mul_f32 v73, v73, v82
    v_mul_f32 v84, v67, v73
    v_mul_f32 v85, v67, v72
    v_fma_f32 v72, v66, v72, -v84
    v_fma_f32 v73, -v66, v73, -v85
    v_mfma_f32_16x16x4_f32 v[48:51], v68, v74, v[48:51]
    v_mfma_f32_16x16x4_f32 v[52:55], v70, v76, v[52:55]
    v_mfma_f32_16x16x4_f32 v[56:59], v70, v78, v[56:59]
    v_mfma_f32_16x16x4_f32 v[60:63], v72, v80, v[60:63]
    v_mfma_f32_16x16x4_f32 v[48:51], v69, v75, v[48:51]
    v_mfma_f32_16x16x4_f32 v[52:55], v71, v77, v[52:55]
    v_mfma_f32_16x16x4_f32 v[56:59], v71, v79, v[56:59]
    v_mfma_f32_16x16x4_f32 v[60:63], v73, v81, v[60:63]
    v_lshlrev_b32 v5, 8, v3
    v_lshl_add_u32 v5, v2, 2, v5
    v_add_u32 v5, v5, v4
    s_nop 5
    ds_write_b32 v5, v48 offset:4608
    ds_write_b32 v5, v49 offset:4672
    ds_write_b32 v5, v50 offset:4736
    ds_write_b32 v5, v51 offset:4800
    v_cmp_gt_u32 vcc, 2, v3
    s_nop 0
    s_mov_b64 exec, vcc
    ds_write_b32 v5, v52 offset:5632
    ds_write_b32 v5, v53 offset:5696
    ds_write_b32 v5, v54 offset:5760
    ds_write_b32 v5, v55 offset:5824
    ds_write_b32 v5, v60 offset:6656
    ds_write_b32 v5, v61 offset:6720
    ds_write_b32 v5, v62 offset:6784
    ds_write_b32 v5, v63 offset:6848
    s_not_b64 exec, exec
    ds_write_b32 v5, v56 offset:5632
    ds_write_b32 v5, v57 offset:5696
    ds_write_b32 v5, v58 offset:5760
    ds_write_b32 v5, v59 offset:5824
    s_mov_b32 exec_lo, 0
    s_mov_b32 exec_hi, 3
    v_cmp_eq_u32 vcc, 0, v2
    s_nop 1
    v_cndmask_b32 v6, 0, v60, vcc
    ds_write_b32 v5, v6 offset:6656
    s_mov_b64 exec, -1
    s_waitcnt lgkmcnt(0)
    v_lshlrev_b32 v7, 1, v1
    v_sub_u32 v7, 2065, v7
    v_lshl_add_u32 v64, v1, 2, v4
    v_mov_b32 v65, 641
    s_mov_b32 s25, 17
ss_exp:
    v_subrev_u32 v66, 0, v7
    v_cvt_f32_u32 v70, v66
    v_cvt_pk_bf16_f32 v70, v70, v70
    v_and_b32 v70, 0xffff, v70
    v_subrev_u32 v70, 0x4280, v70
    v_cmp_gt_u32 vcc, 256, v66
    s_nop 1
    v_cndmask_b32 v70, v70, v66, vcc
    v_cmp_gt_u32 vcc, 2048, v66
    s_nop 1
    v_cndmask_b32 v70, v65, v70, vcc
    v_lshl_add_u32 v70, v70, 2, v4
    ds_read_b32 v74, v70 offset:4608
    v_subrev_u32 v67, 1, v7
    v_cvt_f32_u32 v71, v67
    v_cvt_pk_bf16_f32 v71, v71, v71
    v_and_b32 v71, 0xffff, v71
    v_subrev_u32 v71, 0x4280, v71
    v_cmp_gt_u32 vcc, 256, v67
    s_nop 1
    v_cndmask_b32 v71, v71, v67, vcc
    v_cmp_gt_u32 vcc, 2048, v67
    s_nop 1
    v_cndmask_b32 v71, v65, v71, vcc
    v_lshl_add_u32 v71, v71, 2, v4
    ds_read_b32 v75, v71 offset:4608
    v_subrev_u32 v68, 2, v7
    v_cvt_f32_u32 v72, v68
    v_cvt_pk_bf16_f32 v72, v72, v72
    v_and_b32 v72, 0xffff, v72
    v_subrev_u32 v72, 0x4280, v72
    v_cmp_gt_u32 vcc, 256, v68
    s_nop 1
    v_cndmask_b32 v72, v72, v68, vcc
    v_cmp_gt_u32 vcc, 2048, v68
    s_nop 1
    v_cndmask_b32 v72, v65, v72, vcc
    v_lshl_add_u32 v72, v72, 2, v4
    ds_read_b32 v76, v72 offset:4608
    s_waitcnt lgkmcnt(0)
    v_cvt_pk_bf16_f32 v78, v75, v76
    v_cvt_pk_bf16_f32 v79, v74, v75
    ds_write_b32 v64, v78 offset:7424
    ds_write_b32 v64, v79 offset:11776
    v_subrev_u32 v7, 128, v7
    v_add_u32 v64, 256, v64
    s_sub_u32 s25, s25, 1
    s_cmp_lg_u32 s25, 0
    s_cbranch_scc1 ss_exp
    s_waitcnt lgkmcnt(0)
    s_barrier
    v_and_b32 v5, 1, v2
    v_mul_u32_u24 v64, 4352, v5
    v_sub_u32 v5, v5, v2
    v_lshl_add_u32 v5, v3, 3, v5
    v_lshl_add_u32 v64, v5, 1, v64
    v_add_u32 v64, 11520, v64
    v_add_u32 v64, v64, v4
    v_lshlrev_b32 v65, 5, v2
    v_lshl_add_u32 v65, v3, 4, v65
    v_add_u32 v65, 480, v65
    v_add_u32 v65, v65, v4
    v_mov_b32 v96, 0
    v_mov_b32 v97, 0
    v_mov_b32 v98, 0
    v_mov_b32 v99, 0
    v_mov_b32 v100, 0
    v_mov_b32 v101, 0
    v_mov_b32 v102, 0
    v_mov_b32 v103, 0
    v_mov_b32 v104, 0
    v_mov_b32 v105, 0
    v_mov_b32 v106, 0
    v_mov_b32 v107, 0
    v_mov_b32 v108, 0
    v_mov_b32 v109, 0
    v_mov_b32 v110, 0
    v_mov_b32 v111, 0
    v_mov_b32 v112, 0
    v_mov_b32 v113, 0
    v_mov_b32 v114, 0
    v_mov_b32 v115, 0
    v_mov_b32 v116, 0
    v_mov_b32 v117, 0
    v_mov_b32 v118, 0
    v_mov_b32 v119, 0
    v_mov_b32 v120, 0
    v_mov_b32 v121, 0
    v_mov_b32 v122, 0
    v_mov_b32 v123, 0
    v_mov_b32 v124, 0
    v_mov_b32 v125, 0
    v_mov_b32 v126, 0
    v_mov_b32 v127, 0
    s_mov_b32 s25, 8
ss_cv0:
    ds_read2_b32 v[68:69], v64 offset0:0 offset1:1
    ds_read2_b32 v[70:71], v64 offset0:2 offset1:3
    ds_read_b128 v[128:131], v65 offset:0
    ds_read_b128 v[132:135], v65 offset:512
    ds_read_b128 v[136:139], v65 offset:1024
    ds_read_b128 v[140:143], v65 offset:1536
    ds_read_b128 v[144:147], v65 offset:2048
    ds_read_b128 v[148:151], v65 offset:2560
    ds_read_b128 v[152:155], v65 offset:3072
    ds_read_b128 v[156:159], v65 offset:3584
    v_subrev_u32 v64, 64, v64
    v_subrev_u32 v65, 64, v65
    s_waitcnt lgkmcnt(7)
    v_mfma_f32_16x16x32_bf16 v[96:99], v[68:71], v[128:131], v[96:99]
    s_waitcnt lgkmcnt(6)
    v_mfma_f32_16x16x32_bf16 v[100:103], v[68:71], v[132:135], v[100:103]
    s_waitcnt lgkmcnt(5)
    v_mfma_f32_16x16x32_bf16 v[104:107], v[68:71], v[136:139], v[104:107]
    s_waitcnt lgkmcnt(4)
    v_mfma_f32_16x16x32_bf16 v[108:111], v[68:71], v[140:143], v[108:111]
    s_waitcnt lgkmcnt(3)
    v_mfma_f32_16x16x32_bf16 v[112:115], v[68:71], v[144:147], v[112:115]
    s_waitcnt lgkmcnt(2)
    v_mfma_f32_16x16x32_bf16 v[116:119], v[68:71], v[148:151], v[116:119]
    s_waitcnt lgkmcnt(1)
    v_mfma_f32_16x16x32_bf16 v[120:123], v[68:71], v[152:155], v[120:123]
    s_waitcnt lgkmcnt(0)
    v_mfma_f32_16x16x32_bf16 v[124:127], v[68:71], v[156:159], v[124:127]
    s_sub_u32 s25, s25, 1
    s_cmp_lg_u32 s25, 0
    s_cbranch_scc1 ss_cv0
    v_add_u32 v65, 512, v65
    s_mov_b32 s25, 8
ss_cv1:
    ds_read2_b32 v[68:69], v64 offset0:0 offset1:1
    ds_read2_b32 v[70:71], v64 offset0:2 offset1:3
    ds_read_b128 v[132:135], v65 offset:0
    ds_read_b128 v[136:139], v65 offset:512
    ds_read_b128 v[140:143], v65 offset:1024
    ds_read_b128 v[144:147], v65 offset:1536
    ds_read_b128 v[148:151], v65 offset:2048
    ds_read_b128 v[152:155], v65 offset:2560
    ds_read_b128 v[156:159], v65 offset:3072
    v_subrev_u32 v64, 64, v64
    v_subrev_u32 v65, 64, v65
    s_waitcnt lgkmcnt(6)
    v_mfma_f32_16x16x32_bf16 v[100:103], v[68:71], v[132:135], v[100:103]
    s_waitcnt lgkmcnt(5)
    v_mfma_f32_16x16x32_bf16 v[104:107], v[68:71], v[136:139], v[104:107]
    s_waitcnt lgkmcnt(4)
    v_mfma_f32_16x16x32_bf16 v[108:111], v[68:71], v[140:143], v[108:111]
    s_waitcnt lgkmcnt(3)
    v_mfma_f32_16x16x32_bf16 v[112:115], v[68:71], v[144:147], v[112:115]
    s_waitcnt lgkmcnt(2)
    v_mfma_f32_16x16x32_bf16 v[116:119], v[68:71], v[148:151], v[116:119]
    s_waitcnt lgkmcnt(1)
    v_mfma_f32_16x16x32_bf16 v[120:123], v[68:71], v[152:155], v[120:123]
    s_waitcnt lgkmcnt(0)
    v_mfma_f32_16x16x32_bf16 v[124:127], v[68:71], v[156:159], v[124:127]
    s_sub_u32 s25, s25, 1
    s_cmp_lg_u32 s25, 0
    s_cbranch_scc1 ss_cv1
    v_add_u32 v65, 512, v65
    s_mov_b32 s25, 8
ss_cv2:
    ds_read2_b32 v[68:69], v64 offset0:0 offset1:1
    ds_read2_b32 v[70:71], v64 offset0:2 offset1:3
    ds_read_b128 v[136:139], v65 offset:0
    ds_read_b128 v[140:143], v65 offset:512
    ds_read_b128 v[144:147], v65 offset:1024
    ds_read_b128 v[148:151], v65 offset:1536
    ds_read_b128 v[152:155], v65 offset:2048
    ds_read_b128 v[156:159], v65 offset:2560
    v_subrev_u32 v64, 64, v64
    v_subrev_u32 v65, 64, v65
    s_waitcnt lgkmcnt(5)
    v_mfma_f32_16x16x32_bf16 v[104:107], v[68:71], v[136:139], v[104:107]
    s_waitcnt lgkmcnt(4)
    v_mfma_f32_16x16x32_bf16 v[108:111], v[68:71], v[140:143], v[108:111]
    s_waitcnt lgkmcnt(3)
    v_mfma_f32_16x16x32_bf16 v[112:115], v[68:71], v[144:147], v[112:115]
    s_waitcnt lgkmcnt(2)
    v_mfma_f32_16x16x32_bf16 v[116:119], v[68:71], v[148:151], v[116:119]
    s_waitcnt lgkmcnt(1)
    v_mfma_f32_16x16x32_bf16 v[120:123], v[68:71], v[152:155], v[120:123]
    s_waitcnt lgkmcnt(0)
    v_mfma_f32_16x16x32_bf16 v[124:127], v[68:71], v[156:159], v[124:127]
    s_sub_u32 s25, s25, 1
    s_cmp_lg_u32 s25, 0
    s_cbranch_scc1 ss_cv2
    v_add_u32 v65, 512, v65
    s_mov_b32 s25, 8
ss_cv3:
    ds_read2_b32 v[68:69], v64 offset0:0 offset1:1
    ds_read2_b32 v[70:71], v64 offset0:2 offset1:3
    ds_read_b128 v[140:143], v65 offset:0
    ds_read_b128 v[144:147], v65 offset:512
    ds_read_b128 v[148:151], v65 offset:1024
    ds_read_b128 v[152:155], v65 offset:1536
    ds_read_b128 v[156:159], v65 offset:2048
    v_subrev_u32 v64, 64, v64
    v_subrev_u32 v65, 64, v65
    s_waitcnt lgkmcnt(4)
    v_mfma_f32_16x16x32_bf16 v[108:111], v[68:71], v[140:143], v[108:111]
    s_waitcnt lgkmcnt(3)
    v_mfma_f32_16x16x32_bf16 v[112:115], v[68:71], v[144:147], v[112:115]
    s_waitcnt lgkmcnt(2)
    v_mfma_f32_16x16x32_bf16 v[116:119], v[68:71], v[148:151], v[116:119]
    s_waitcnt lgkmcnt(1)
    v_mfma_f32_16x16x32_bf16 v[120:123], v[68:71], v[152:155], v[120:123]
    s_waitcnt lgkmcnt(0)
    v_mfma_f32_16x16x32_bf16 v[124:127], v[68:71], v[156:159], v[124:127]
    s_sub_u32 s25, s25, 1
    s_cmp_lg_u32 s25, 0
    s_cbranch_scc1 ss_cv3
    v_add_u32 v65, 512, v65
    s_mov_b32 s25, 8
ss_cv4:
    ds_read2_b32 v[68:69], v64 offset0:0 offset1:1
    ds_read2_b32 v[70:71], v64 offset0:2 offset1:3
    ds_read_b128 v[144:147], v65 offset:0
    ds_read_b128 v[148:151], v65 offset:512
    ds_read_b128 v[152:155], v65 offset:1024
    ds_read_b128 v[156:159], v65 offset:1536
    v_subrev_u32 v64, 64, v64
    v_subrev_u32 v65, 64, v65
    s_waitcnt lgkmcnt(3)
    v_mfma_f32_16x16x32_bf16 v[112:115], v[68:71], v[144:147], v[112:115]
    s_waitcnt lgkmcnt(2)
    v_mfma_f32_16x16x32_bf16 v[116:119], v[68:71], v[148:151], v[116:119]
    s_waitcnt lgkmcnt(1)
    v_mfma_f32_16x16x32_bf16 v[120:123], v[68:71], v[152:155], v[120:123]
    s_waitcnt lgkmcnt(0)
    v_mfma_f32_16x16x32_bf16 v[124:127], v[68:71], v[156:159], v[124:127]
    s_sub_u32 s25, s25, 1
    s_cmp_lg_u32 s25, 0
    s_cbranch_scc1 ss_cv4
    v_add_u32 v65, 512, v65
    s_mov_b32 s25, 8
ss_cv5:
    ds_read2_b32 v[68:69], v64 offset0:0 offset1:1
    ds_read2_b32 v[70:71], v64 offset0:2 offset1:3
    ds_read_b128 v[148:151], v65 offset:0
    ds_read_b128 v[152:155], v65 offset:512
    ds_read_b128 v[156:159], v65 offset:1024
    v_subrev_u32 v64, 64, v64
    v_subrev_u32 v65, 64, v65
    s_waitcnt lgkmcnt(2)
    v_mfma_f32_16x16x32_bf16 v[116:119], v[68:71], v[148:151], v[116:119]
    s_waitcnt lgkmcnt(1)
    v_mfma_f32_16x16x32_bf16 v[120:123], v[68:71], v[152:155], v[120:123]
    s_waitcnt lgkmcnt(0)
    v_mfma_f32_16x16x32_bf16 v[124:127], v[68:71], v[156:159], v[124:127]
    s_sub_u32 s25, s25, 1
    s_cmp_lg_u32 s25, 0
    s_cbranch_scc1 ss_cv5
    v_add_u32 v65, 512, v65
    s_mov_b32 s25, 8
ss_cv6:
    ds_read2_b32 v[68:69], v64 offset0:0 offset1:1
    ds_read2_b32 v[70:71], v64 offset0:2 offset1:3
    ds_read_b128 v[152:155], v65 offset:0
    ds_read_b128 v[156:159], v65 offset:512
    v_subrev_u32 v64, 64, v64
    v_subrev_u32 v65, 64, v65
    s_waitcnt lgkmcnt(1)
    v_mfma_f32_16x16x32_bf16 v[120:123], v[68:71], v[152:155], v[120:123]
    s_waitcnt lgkmcnt(0)
    v_mfma_f32_16x16x32_bf16 v[124:127], v[68:71], v[156:159], v[124:127]
    s_sub_u32 s25, s25, 1
    s_cmp_lg_u32 s25, 0
    s_cbranch_scc1 ss_cv6
    v_add_u32 v65, 512, v65
    s_mov_b32 s25, 8
ss_cv7:
    ds_read2_b32 v[68:69], v64 offset0:0 offset1:1
    ds_read2_b32 v[70:71], v64 offset0:2 offset1:3
    ds_read_b128 v[156:159], v65 offset:0
    v_subrev_u32 v64, 64, v64
    v_subrev_u32 v65, 64, v65
    s_waitcnt lgkmcnt(0)
    v_mfma_f32_16x16x32_bf16 v[124:127], v[68:71], v[156:159], v[124:127]
    s_sub_u32 s25, s25, 1
    s_cmp_lg_u32 s25, 0
    s_cbranch_scc1 ss_cv7
    v_add_u32 v65, 512, v65
    s_nop 3
    v_lshlrev_b32 v5, 6, v2
    v_lshl_add_u32 v5, v3, 4, v5
    v_add_u32 v5, v5, v4
    ds_write_b128 v5, v[96:99] offset:7424
    ds_write_b128 v5, v[100:103] offset:8448
    ds_write_b128 v5, v[104:107] offset:9472
    ds_write_b128 v5, v[108:111] offset:10496
    ds_write_b128 v5, v[112:115] offset:11520
    ds_write_b128 v5, v[116:119] offset:12544
    ds_write_b128 v5, v[120:123] offset:13568
    ds_write_b128 v5, v[124:127] offset:14592
    s_mov_b32 s12, s74
    s_mov_b32 s13, s75
    s_mov_b32 s14, 1152
    s_mov_b32 s15, 0x20000
    s_lshl_b32 s23, s20, 1
    buffer_load_dwordx2 v[24:25], off, s[12:15], s23
    s_waitcnt vmcnt(0) lgkmcnt(0)
    s_barrier
    v_lshlrev_b32 v26, 16, v24
    v_and_b32 v27, 0xffff0000, v24
    v_lshlrev_b32 v28, 16, v25
    v_and_b32 v29, 0xffff0000, v25
    v_lshlrev_b32 v5, 5, v0
    ds_read_b128 v[64:67], v5 offset:7424
    ds_read_b128 v[68:71], v5 offset:7440
    ds_read_b128 v[72:75], v5 offset:23808
    ds_read_b128 v[76:79], v5 offset:23824
    ds_read_b128 v[80:83], v5 offset:40192
    ds_read_b128 v[84:87], v5 offset:40208
    ds_read_b128 v[88:91], v5 offset:56576
    ds_read_b128 v[92:95], v5 offset:56592
    s_waitcnt lgkmcnt(0)
    v_mul_u32_u24 v5, 18432, v0
    s_lshl_b32 s22, s20, 1
    s_add_u32 s22, s22, 1152
    v_lshlrev_b32 v6, 16, v8
    v_fmac_f32 v64, v6, v26
    v_and_b32 v6, 0xffff0000, v8
    v_fmac_f32 v72, v6, v27
    v_lshlrev_b32 v6, 16, v9
    v_fmac_f32 v80, v6, v28
    v_and_b32 v6, 0xffff0000, v9
    v_fmac_f32 v88, v6, v29
    v_cvt_pk_bf16_f32 v8, v64, v72
    v_cvt_pk_bf16_f32 v9, v80, v88
    s_add_u32 s23, s22, 0
    buffer_store_dwordx2 v[8:9], v5, s[16:19], s23 offen
    v_lshlrev_b32 v6, 16, v10
    v_fmac_f32 v65, v6, v26
    v_and_b32 v6, 0xffff0000, v10
    v_fmac_f32 v73, v6, v27
    v_lshlrev_b32 v6, 16, v11
    v_fmac_f32 v81, v6, v28
    v_and_b32 v6, 0xffff0000, v11
    v_fmac_f32 v89, v6, v29
    v_cvt_pk_bf16_f32 v10, v65, v73
    v_cvt_pk_bf16_f32 v11, v81, v89
    s_add_u32 s23, s22, 2304
    buffer_store_dwordx2 v[10:11], v5, s[16:19], s23 offen
    v_lshlrev_b32 v6, 16, v12
    v_fmac_f32 v66, v6, v26
    v_and_b32 v6, 0xffff0000, v12
    v_fmac_f32 v74, v6, v27
    v_lshlrev_b32 v6, 16, v13
    v_fmac_f32 v82, v6, v28
    v_and_b32 v6, 0xffff0000, v13
    v_fmac_f32 v90, v6, v29
    v_cvt_pk_bf16_f32 v12, v66, v74
    v_cvt_pk_bf16_f32 v13, v82, v90
    s_add_u32 s23, s22, 4608
    buffer_store_dwordx2 v[12:13], v5, s[16:19], s23 offen
    v_lshlrev_b32 v6, 16, v14
    v_fmac_f32 v67, v6, v26
    v_and_b32 v6, 0xffff0000, v14
    v_fmac_f32 v75, v6, v27
    v_lshlrev_b32 v6, 16, v15
    v_fmac_f32 v83, v6, v28
    v_and_b32 v6, 0xffff0000, v15
    v_fmac_f32 v91, v6, v29
    v_cvt_pk_bf16_f32 v14, v67, v75
    v_cvt_pk_bf16_f32 v15, v83, v91
    s_add_u32 s23, s22, 6912
    buffer_store_dwordx2 v[14:15], v5, s[16:19], s23 offen
    v_lshlrev_b32 v6, 16, v16
    v_fmac_f32 v68, v6, v26
    v_and_b32 v6, 0xffff0000, v16
    v_fmac_f32 v76, v6, v27
    v_lshlrev_b32 v6, 16, v17
    v_fmac_f32 v84, v6, v28
    v_and_b32 v6, 0xffff0000, v17
    v_fmac_f32 v92, v6, v29
    v_cvt_pk_bf16_f32 v16, v68, v76
    v_cvt_pk_bf16_f32 v17, v84, v92
    s_add_u32 s23, s22, 9216
    buffer_store_dwordx2 v[16:17], v5, s[16:19], s23 offen
    v_lshlrev_b32 v6, 16, v18
    v_fmac_f32 v69, v6, v26
    v_and_b32 v6, 0xffff0000, v18
    v_fmac_f32 v77, v6, v27
    v_lshlrev_b32 v6, 16, v19
    v_fmac_f32 v85, v6, v28
    v_and_b32 v6, 0xffff0000, v19
    v_fmac_f32 v93, v6, v29
    v_cvt_pk_bf16_f32 v18, v69, v77
    v_cvt_pk_bf16_f32 v19, v85, v93
    s_add_u32 s23, s22, 11520
    buffer_store_dwordx2 v[18:19], v5, s[16:19], s23 offen
    v_lshlrev_b32 v6, 16, v20
    v_fmac_f32 v70, v6, v26
    v_and_b32 v6, 0xffff0000, v20
    v_fmac_f32 v78, v6, v27
    v_lshlrev_b32 v6, 16, v21
    v_fmac_f32 v86, v6, v28
    v_and_b32 v6, 0xffff0000, v21
    v_fmac_f32 v94, v6, v29
    v_cvt_pk_bf16_f32 v20, v70, v78
    v_cvt_pk_bf16_f32 v21, v86, v94
    s_add_u32 s23, s22, 13824
    buffer_store_dwordx2 v[20:21], v5, s[16:19], s23 offen
    v_lshlrev_b32 v6, 16, v22
    v_fmac_f32 v71, v6, v26
    v_and_b32 v6, 0xffff0000, v22
    v_fmac_f32 v79, v6, v27
    v_lshlrev_b32 v6, 16, v23
    v_fmac_f32 v87, v6, v28
    v_and_b32 v6, 0xffff0000, v23
    v_fmac_f32 v95, v6, v29
    v_cvt_pk_bf16_f32 v22, v71, v79
    v_cvt_pk_bf16_f32 v23, v87, v95
    s_add_u32 s23, s22, 16128
    buffer_store_dwordx2 v[22:23], v5, s[16:19], s23 offen
    s_branch L_ssm_next
L_wf_next:
    s_mov_b32 s37, 20
    v_mov_b32 v250, 1
    v_mov_b32 v251, 163832
    v_cmp_eq_u32 vcc, 0, v0
    s_nop 0
    s_and_saveexec_b64 s[38:39], vcc
    s_cbranch_execz tk13
    buffer_atomic_add v250, off, s[84:87], s37 sc0
    s_waitcnt vmcnt(0)
    ds_write_b32 v251, v250
    s_waitcnt lgkmcnt(0)
tk13:
    s_mov_b64 exec, -1
    s_barrier
    ds_read_b32 v252, v251
    s_waitcnt lgkmcnt(0)
    v_readfirstlane_b32 s33, v252
    s_barrier
    s_nop 3
    s_cmp_ge_u32 s33, 160
    s_cbranch_scc1 L_phase2
    s_lshl_b32 s16, s33, 2
    s_add_u32 s16, s16, s32
    s_add_u32 s16, s16, 1504
    s_call_b64 s[46:47], L_xform
    s_lshl_b32 s40, s33, 2
    s_add_u32 s40, s40, 125841408
    s_waitcnt vmcnt(0)
    s_barrier
    v_mov_b32 v250, s95
    v_cmp_eq_u32 vcc, 0, v0
    s_nop 0
    s_and_saveexec_b64 s[38:39], vcc
    s_cbranch_execz fs14
    buffer_store_dword v250, off, s[4:7], s40 sc1
fs14:
    s_mov_b64 exec, -1
    s_branch L_wf_next
L_phase2:
    s_mov_b32 s40, 524288
mc2_w:
    buffer_load_dword v250, off, s[84:87], 0 offset:28 sc1
    s_waitcnt vmcnt(0)
    v_readfirstlane_b32 s41, v250
    s_nop 0
    s_cmp_lg_u32 s41, 0
    s_cbranch_scc1 mc2_known
    s_sub_u32 s40, s40, 1
    s_cbranch_scc1 mc2_force
    s_sleep 2
    s_branch mc2_w
mc2_force:
    v_mov_b32 v250, 2
    v_mov_b32 v251, 0
    s_mov_b64 exec, 1
    buffer_atomic_cmpswap v[250:251], off, s[84:87], 0 offset:28
    s_mov_b64 exec, -1
    s_waitcnt vmcnt(0)
    s_mov_b32 s40, 524288
    s_branch mc2_w
mc2_known:
    s_cmp_eq_u32 s41, 1
    s_cbranch_scc1 L_phase2b
    s_mov_b32 s37, 208
    v_mov_b32 v250, 1
    v_mov_b32 v251, 163832
    v_cmp_eq_u32 vcc, 0, v0
    s_nop 0
    s_and_saveexec_b64 s[38:39], vcc
    s_cbranch_execz tk15
    buffer_atomic_add v250, off, s[84:87], s37 sc0
    s_waitcnt vmcnt(0)
    ds_write_b32 v251, v250
    s_waitcnt lgkmcnt(0)
tk15:
    s_mov_b64 exec, -1
    s_barrier
    ds_read_b32 v252, v251
    s_waitcnt lgkmcnt(0)
    v_readfirstlane_b32 s12, v252
    s_barrier
    s_nop 3
    s_cmp_lt_u32 s12, 32
    s_cbranch_scc1 L_chain_safe
L_phase2b:
    s_mov_b32 s8, s76
    s_mov_b32 s9, s77
    s_mov_b32 s10, 4718592
    s_mov_b32 s11, 0x20000
    s_mov_b32 s37, 12
    v_mov_b32 v250, 1
    v_mov_b32 v251, 163832
    v_cmp_eq_u32 vcc, 0, v0
    s_nop 0
    s_and_saveexec_b64 s[38:39], vcc
    s_cbranch_execz tk16
    buffer_atomic_add v250, off, s[84:87], s37 sc0
    s_waitcnt vmcnt(0)
    ds_write_b32 v251, v250
    s_waitcnt lgkmcnt(0)
tk16:
    s_mov_b64 exec, -1
    s_barrier
    ds_read_b32 v252, v251
    s_waitcnt lgkmcnt(0)
    v_readfirstlane_b32 s36, v252
    s_barrier
    s_nop 3
    s_mul_hi_u32 s37, s36, 0x55555556
    s_mul_i32 s40, s37, 3
    s_sub_u32 s33, s36, s37
    s_mul_hi_u32 s41, s33, 0x0e38e38f
    s_mul_i32 s41, s41, 18
    s_sub_u32 s33, s33, s41
    s_cmp_lg_u32 s40, s36
    s_cbranch_scc1 L_op_start
L_att_next:
    s_mov_b32 s37, 16
    v_mov_b32 v250, 1
    v_mov_b32 v251, 163832
    v_cmp_eq_u32 vcc, 0, v0
    s_nop 0
    s_and_saveexec_b64 s[38:39], vcc
    s_cbranch_execz tk17
    buffer_atomic_add v250, off, s[84:87], s37 sc0
    s_waitcnt vmcnt(0)
    ds_write_b32 v251, v250
    s_waitcnt lgkmcnt(0)
tk17:
    s_mov_b64 exec, -1
    s_barrier
    ds_read_b32 v252, v251
    s_waitcnt lgkmcnt(0)
    v_readfirstlane_b32 s34, v252
    s_barrier
    s_nop 3
    s_cmp_ge_u32 s34, 512
    s_cbranch_scc1 L_op_start
    s_lshr_b32 s16, s34, 3
    s_and_b32 s17, s34, 7
    s_lshl_b32 s17, s17, 2
    s_add_u32 s17, s17, s32
    s_lshl_b32 s36, s17, 7
    s_add_u32 s36, s36, 125829120
    s_add_u32 s41, s16, s95
    s_add_u32 s41, s41, 1
    v_and_b32 v1, 3, v0
    v_min_u32 v1, 2, v1
    v_lshlrev_b32 v2, 4, v1
    s_lshr_b32 s37, s16, 4
    s_lshl_b32 s37, s37, 2
    v_add_u32 v2, s37, v2
    s_mov_b32 s40, 4194304
L_aw1:
    buffer_load_dword v3, v2, s[4:7], s36 offen sc1
    s_sub_u32 s40, s40, 1
    s_cbranch_scc1 L_aw1_go
    s_waitcnt vmcnt(0)
    v_subrev_u32 v3, s41, v3
    v_cmp_lt_u32 vcc, 64, v3
    s_cbranch_vccz L_aw1_go
    s_sleep 4
    s_branch L_aw1
L_aw1_go:
    v_and_b32 v5, 63, v0
    v_lshlrev_b32 v1, 4, v5
    v_and_b32 v2, 511, v1
    v_or_b32 v3, 128, v1
    v_lshrrev_b32 v4, 4, v5
    v_bfe_u32 v6, v5, 2, 2
    v_sub_u32 v4, v6, v4
    v_lshlrev_b32 v4, 3, v4
    v_and_b32 v6, 3, v5
    v_add_u32 v4, v4, v6
    v_mov_b32 v6, 0xf149f2ca
    s_mov_b32 s22, 0x3e0293ee
    s_lshl_b32 s18, s16, 5
    s_add_u32 s18, s18, s17
    s_lshl_b32 s19, s18, 13
    s_add_u32 s20, s19, 33554432
    buffer_load_dwordx4 v[8:11], v1, s[4:7], s20 offen offset:0 sc1
    s_add_u32 s20, s19, 33554432
    buffer_load_dwordx4 v[12:15], v1, s[4:7], s20 offen offset:1024 sc1
    s_add_u32 s20, s19, 33554432
    buffer_load_dwordx4 v[16:19], v1, s[4:7], s20 offen offset:2048 sc1
    s_add_u32 s20, s19, 33554432
    buffer_load_dwordx4 v[20:23], v1, s[4:7], s20 offen offset:3072 sc1
    s_add_u32 s20, s19, 33558528
    buffer_load_dwordx4 v[24:27], v1, s[4:7], s20 offen offset:0 sc1
    s_add_u32 s20, s19, 33558528
    buffer_load_dwordx4 v[28:31], v1, s[4:7], s20 offen offset:1024 sc1
    s_add_u32 s20, s19, 33558528
    buffer_load_dwordx4 v[32:35], v1, s[4:7], s20 offen offset:2048 sc1
    s_add_u32 s20, s19, 33558528
    buffer_load_dwordx4 v[36:39], v1, s[4:7], s20 offen offset:3072 sc1
    s_lshl_b32 s21, s18, 14
    s_add_u32 s20, s21, 0
    buffer_load_dwordx4 v[40:43], v1, s[4:7], s20 offen offset:0 sc1
    s_add_u32 s20, s21, 4096
    buffer_load_dwordx4 v[44:47], v1, s[4:7], s20 offen offset:0 sc1
    s_add_u32 s20, s21, 8192
    buffer_load_dwordx4 v[48:51], v1, s[4:7], s20 offen offset:0 sc1
    s_add_u32 s20, s21, 12288
    buffer_load_dwordx4 v[52:55], v1, s[4:7], s20 offen offset:0 sc1
    s_add_u32 s20, s21, 0
    buffer_load_dwordx4 v[56:59], v1, s[4:7], s20 offen offset:1024 sc1
    s_add_u32 s20, s21, 4096
    buffer_load_dwordx4 v[60:63], v1, s[4:7], s20 offen offset:1024 sc1
    s_add_u32 s20, s21, 8192
    buffer_load_dwordx4 v[64:67], v1, s[4:7], s20 offen offset:1024 sc1
    s_add_u32 s20, s21, 12288
    buffer_load_dwordx4 v[68:71], v1, s[4:7], s20 offen offset:1024 sc1
    s_add_u32 s20, s21, 0
    buffer_load_dwordx4 v[88:91], v1, s[4:7], s20 offen offset:2048 sc1
    s_add_u32 s20, s21, 4096
    buffer_load_dwordx4 v[92:95], v1, s[4:7], s20 offen offset:2048 sc1
    s_add_u32 s20, s21, 8192
    buffer_load_dwordx4 v[96:99], v1, s[4:7], s20 offen offset:2048 sc1
    s_add_u32 s20, s21, 12288
    buffer_load_dwordx4 v[100:103], v1, s[4:7], s20 offen offset:2048 sc1
    s_add_u32 s20, s21, 0
    buffer_load_dwordx4 v[104:107], v1, s[4:7], s20 offen offset:3072 sc1
    s_add_u32 s20, s21, 4096
    buffer_load_dwordx4 v[108:111], v1, s[4:7], s20 offen offset:3072 sc1
    s_add_u32 s20, s21, 8192
    buffer_load_dwordx4 v[112:115], v1, s[4:7], s20 offen offset:3072 sc1
    s_add_u32 s20, s21, 12288
    buffer_load_dwordx4 v[116:119], v1, s[4:7], s20 offen offset:3072 sc1
    v_mov_b32 v172, 0x3f803f80
    v_mov_b32 v173, 0x3f803f80
    v_mov_b32 v174, 0x3f803f80
    v_mov_b32 v175, 0x3f803f80
    v_mov_b32 v176, 0x3f003f00
    v_mov_b32 v177, 0x3f003f00
    s_waitcnt vmcnt(8)
    v_mfma_f32_16x16x32_bf16 v[136:139], v[40:43], v[8:11], 0
    v_mfma_f32_16x16x32_bf16 v[140:143], v[56:59], v[8:11], 0
    v_mfma_f32_16x16x32_bf16 v[148:151], v[40:43], v[24:27], 0
    v_mfma_f32_16x16x32_bf16 v[152:155], v[56:59], v[24:27], 0
    v_mfma_f32_16x16x32_bf16 v[136:139], v[44:47], v[12:15], v[136:139]
    v_mfma_f32_16x16x32_bf16 v[140:143], v[60:63], v[12:15], v[140:143]
    v_mfma_f32_16x16x32_bf16 v[148:151], v[44:47], v[28:31], v[148:151]
    v_mfma_f32_16x16x32_bf16 v[152:155], v[60:63], v[28:31], v[152:155]
    v_mfma_f32_16x16x32_bf16 v[136:139], v[48:51], v[16:19], v[136:139]
    v_mfma_f32_16x16x32_bf16 v[140:143], v[64:67], v[16:19], v[140:143]
    v_mfma_f32_16x16x32_bf16 v[148:151], v[48:51], v[32:35], v[148:151]
    v_mfma_f32_16x16x32_bf16 v[152:155], v[64:67], v[32:35], v[152:155]
    v_mfma_f32_16x16x32_bf16 v[136:139], v[52:55], v[20:23], v[136:139]
    v_mfma_f32_16x16x32_bf16 v[140:143], v[68:71], v[20:23], v[140:143]
    v_mfma_f32_16x16x32_bf16 v[148:151], v[52:55], v[36:39], v[148:151]
    v_mfma_f32_16x16x32_bf16 v[152:155], v[68:71], v[36:39], v[152:155]
    v_cmp_le_i32 vcc, 0, v4
    s_nop 3
    v_cndmask_b32 v136, v6, v136, vcc
    v_cmp_le_i32 vcc, 1, v4
    s_nop 1
    v_cndmask_b32 v137, v6, v137, vcc
    v_cmp_le_i32 vcc, 2, v4
    s_nop 1
    v_cndmask_b32 v138, v6, v138, vcc
    v_cmp_le_i32 vcc, 3, v4
    s_nop 1
    v_cndmask_b32 v139, v6, v139, vcc
    v_cmp_le_i32 vcc, 4, v4
    s_nop 1
    v_cndmask_b32 v140, v6, v140, vcc
    v_cmp_le_i32 vcc, 5, v4
    s_nop 1
    v_cndmask_b32 v141, v6, v141, vcc
    v_cmp_le_i32 vcc, 6, v4
    s_nop 1
    v_cndmask_b32 v142, v6, v142, vcc
    v_cmp_le_i32 vcc, 7, v4
    s_nop 1
    v_cndmask_b32 v143, v6, v143, vcc
    v_cmp_le_i32 vcc, -4, v4
    s_nop 1
    v_cndmask_b32 v148, v6, v148, vcc
    v_cmp_le_i32 vcc, -3, v4
    s_nop 1
    v_cndmask_b32 v149, v6, v149, vcc
    v_cmp_le_i32 vcc, -2, v4
    s_nop 1
    v_cndmask_b32 v150, v6, v150, vcc
    v_cmp_le_i32 vcc, -1, v4
    s_nop 1
    v_cndmask_b32 v151, v6, v151, vcc
    v_cmp_le_i32 vcc, 0, v4
    s_nop 1
    v_cndmask_b32 v152, v6, v152, vcc
    v_cmp_le_i32 vcc, 1, v4
    s_nop 1
    v_cndmask_b32 v153, v6, v153, vcc
    v_cmp_le_i32 vcc, 2, v4
    s_nop 1
    v_cndmask_b32 v154, v6, v154, vcc
    v_cmp_le_i32 vcc, 3, v4
    s_nop 1
    v_cndmask_b32 v155, v6, v155, vcc
    s_nop 1
    v_and_b32 v198, 1, v0
    v_lshlrev_b32 v198, 2, v198
    v_add_u32 v198, 48, v198
    s_nop 1
    s_mov_b32 s88, 65536
    s_mov_b32 s89, 125853696
cw18:
    buffer_load_dword v199, off, s[4:7], s89 sc1
    s_waitcnt vmcnt(0)
    v_readfirstlane_b32 s42, v199
    s_nop 0
    s_sub_u32 s42, s42, s95
    s_cmp_gt_u32 s42, 64
    s_cselect_b32 s42, 0, s42
    s_add_u32 s42, s42, 1
    s_cmp_ge_u32 s42, s16
    s_cbranch_scc1 cw18x
    s_sub_u32 s88, s88, 1
    s_cbranch_scc1 cw18x
    s_sub_u32 s42, s16, s42
    s_min_u32 s42, s42, 6
cw18s:
    s_sleep 24
    s_sub_u32 s42, s42, 1
    s_cmp_lg_u32 s42, 0
    s_cbranch_scc1 cw18s
    s_branch cw18
cw18x:
    s_mov_b32 s40, 4194304
L_aw2:
    buffer_load_dword v199, v198, s[4:7], s36 offen sc1
    s_sub_u32 s40, s40, 1
    s_cbranch_scc1 L_aw2_go
    s_waitcnt vmcnt(0)
    v_subrev_u32 v199, s41, v199
    v_cmp_lt_u32 vcc, 64, v199
    s_cbranch_vccz L_aw2_go
    s_sleep 4
    s_branch L_aw2
L_aw2_go:
    s_lshl_b32 s20, s18, 12
    s_add_u32 s20, s20, 69206016
    buffer_load_dwordx4 v[72:75], v3, s[4:7], s20 offen offset:0 sc1
    buffer_load_dwordx4 v[76:79], v3, s[4:7], s20 offen offset:1024 sc1
    buffer_load_dwordx4 v[80:83], v3, s[4:7], s20 offen offset:2048 sc1
    buffer_load_dwordx4 v[84:87], v3, s[4:7], s20 offen offset:3072 sc1
    s_lshl_b32 s20, s18, 12
    s_add_u32 s20, s20, 77594624
    buffer_load_dwordx4 v[120:123], v2, s[4:7], s20 offen offset:0 sc1
    buffer_load_dwordx4 v[124:127], v2, s[4:7], s20 offen offset:1024 sc1
    buffer_load_dwordx4 v[128:131], v2, s[4:7], s20 offen offset:2048 sc1
    buffer_load_dwordx4 v[132:135], v2, s[4:7], s20 offen offset:3072 sc1
    s_waitcnt vmcnt(4)
    v_mfma_f32_16x16x32_bf16 v[144:147], v[72:75], v[8:11], 0
    v_mfma_f32_16x16x32_bf16 v[156:159], v[72:75], v[24:27], 0
    v_mfma_f32_16x16x32_bf16 v[144:147], v[76:79], v[12:15], v[144:147]
    v_mfma_f32_16x16x32_bf16 v[156:159], v[76:79], v[28:31], v[156:159]
    v_mfma_f32_16x16x32_bf16 v[144:147], v[80:83], v[16:19], v[144:147]
    v_mfma_f32_16x16x32_bf16 v[156:159], v[80:83], v[32:35], v[156:159]
    v_mfma_f32_16x16x32_bf16 v[144:147], v[84:87], v[20:23], v[144:147]
    v_mfma_f32_16x16x32_bf16 v[156:159], v[84:87], v[36:39], v[156:159]
    v_max3_f32 v196, v136, v137, v138
    v_max3_f32 v197, v139, v140, v141
    v_max3_f32 v196, v196, v142, v143
    s_nop 3
    v_max3_f32 v197, v197, v144, v145
    v_max3_f32 v196, v196, v146, v147
    v_max_f32 v196, v196, v197
    v_mov_b32 v197, v196
    s_nop 1
    v_permlane32_swap_b32 v196, v197
    v_max_f32 v196, v196, v197
    v_mov_b32 v197, v196
    s_nop 1
    v_permlane16_swap_b32 v196, v197
    v_max_f32 v196, v196, v197
    v_mul_f32 v196, s22, v196
    v_sub_f32 v196, 0, v196
    v_fma_f32 v136, v136, s22, v196
    v_fma_f32 v137, v137, s22, v196
    v_fma_f32 v138, v138, s22, v196
    v_fma_f32 v139, v139, s22, v196
    v_fma_f32 v140, v140, s22, v196
    v_fma_f32 v141, v141, s22, v196
    v_fma_f32 v142, v142, s22, v196
    v_fma_f32 v143, v143, s22, v196
    v_fma_f32 v144, v144, s22, v196
    v_fma_f32 v145, v145, s22, v196
    v_fma_f32 v146, v146, s22, v196
    v_fma_f32 v147, v147, s22, v196
    v_exp_f32 v136, v136
    v_exp_f32 v137, v137
    v_exp_f32 v138, v138
    v_exp_f32 v139, v139
    v_exp_f32 v140, v140
    v_exp_f32 v141, v141
    v_exp_f32 v142, v142
    v_exp_f32 v143, v143
    v_exp_f32 v144, v144
    v_exp_f32 v145, v145
    v_exp_f32 v146, v146
    v_exp_f32 v147, v147
    v_cvt_pk_bf16_f32 v160, v136, v137
    v_cvt_pk_bf16_f32 v161, v138, v139
    v_cvt_pk_bf16_f32 v162, v140, v141
    v_cvt_pk_bf16_f32 v163, v142, v143
    v_cvt_pk_bf16_f32 v164, v144, v145
    v_cvt_pk_bf16_f32 v165, v146, v147
    v_max3_f32 v196, v148, v149, v150
    v_max3_f32 v197, v151, v152, v153
    v_max3_f32 v196, v196, v154, v155
    v_max3_f32 v197, v197, v156, v157
    v_max3_f32 v196, v196, v158, v159
    v_max_f32 v196, v196, v197
    v_mov_b32 v197, v196
    s_nop 1
    v_permlane32_swap_b32 v196, v197
    v_max_f32 v196, v196, v197
    v_mov_b32 v197, v196
    s_nop 1
    v_permlane16_swap_b32 v196, v197
    v_max_f32 v196, v196, v197
    v_mul_f32 v196, s22, v196
    v_sub_f32 v196, 0, v196
    v_fma_f32 v148, v148, s22, v196
    v_fma_f32 v149, v149, s22, v196
    v_fma_f32 v150, v150, s22, v196
    v_fma_f32 v151, v151, s22, v196
    v_fma_f32 v152, v152, s22, v196
    v_fma_f32 v153, v153, s22, v196
    v_fma_f32 v154, v154, s22, v196
    v_fma_f32 v155, v155, s22, v196
    v_fma_f32 v156, v156, s22, v196
    v_fma_f32 v157, v157, s22, v196
    v_fma_f32 v158, v158, s22, v196
    v_fma_f32 v159, v159, s22, v196
    v_exp_f32 v148, v148
    v_exp_f32 v149, v149
    v_exp_f32 v150, v150
    v_exp_f32 v151, v151
    v_exp_f32 v152, v152
    v_exp_f32 v153, v153
    v_exp_f32 v154, v154
    v_exp_f32 v155, v155
    v_exp_f32 v156, v156
    v_exp_f32 v157, v157
    v_exp_f32 v158, v158
    v_exp_f32 v159, v159
    v_cvt_pk_bf16_f32 v166, v148, v149
    v_cvt_pk_bf16_f32 v167, v150, v151
    v_cvt_pk_bf16_f32 v168, v152, v153
    v_cvt_pk_bf16_f32 v169, v154, v155
    v_cvt_pk_bf16_f32 v170, v156, v157
    v_cvt_pk_bf16_f32 v171, v158, v159
    v_mfma_f32_16x16x32_bf16 v[180:183], v[172:175], v[160:163], 0
    v_mfma_f32_16x16x32_bf16 v[184:187], v[172:175], v[166:169], 0
    s_nop 4
    v_mfma_f32_16x16x16_bf16 v[180:183], v[176:177], v[164:165], v[180:183]
    v_mfma_f32_16x16x16_bf16 v[184:187], v[176:177], v[170:171], v[184:187]
    s_nop 6
    v_rcp_f32 v180, v180
    v_rcp_f32 v184, v184
    s_waitcnt vmcnt(0)
    s_lshl_b32 s18, s16, 18
    s_lshl_b32 s19, s17, 12
    s_add_u32 s18, s18, s19
    s_add_u32 s18, s18, 50331648
    s_add_u32 s19, s18, 131072
    v_mfma_f32_16x16x32_bf16 v[8:11], v[88:91], v[160:163], 0
    v_mfma_f32_16x16x32_bf16 v[12:15], v[104:107], v[160:163], 0
    v_mfma_f32_16x16x32_bf16 v[16:19], v[88:91], v[166:169], 0
    v_mfma_f32_16x16x32_bf16 v[20:23], v[104:107], v[166:169], 0
    v_mfma_f32_16x16x32_bf16 v[24:27], v[92:95], v[160:163], 0
    v_mfma_f32_16x16x32_bf16 v[28:31], v[108:111], v[160:163], 0
    v_mfma_f32_16x16x32_bf16 v[32:35], v[92:95], v[166:169], 0
    v_mfma_f32_16x16x32_bf16 v[36:39], v[108:111], v[166:169], 0
    v_mfma_f32_16x16x32_bf16 v[40:43], v[96:99], v[160:163], 0
    v_mfma_f32_16x16x32_bf16 v[44:47], v[112:115], v[160:163], 0
    v_mfma_f32_16x16x32_bf16 v[48:51], v[96:99], v[166:169], 0
    v_mfma_f32_16x16x32_bf16 v[52:55], v[112:115], v[166:169], 0
    v_mfma_f32_16x16x32_bf16 v[56:59], v[100:103], v[160:163], 0
    v_mfma_f32_16x16x32_bf16 v[60:63], v[116:119], v[160:163], 0
    v_mfma_f32_16x16x32_bf16 v[64:67], v[100:103], v[166:169], 0
    v_mfma_f32_16x16x32_bf16 v[68:71], v[116:119], v[166:169], 0
    v_mfma_f32_16x16x16_bf16 v[8:11], v[120:121], v[164:165], v[8:11]
    v_mfma_f32_16x16x16_bf16 v[12:15], v[122:123], v[164:165], v[12:15]
    v_mfma_f32_16x16x16_bf16 v[16:19], v[120:121], v[170:171], v[16:19]
    v_mfma_f32_16x16x16_bf16 v[20:23], v[122:123], v[170:171], v[20:23]
    v_mfma_f32_16x16x16_bf16 v[24:27], v[124:125], v[164:165], v[24:27]
    v_mfma_f32_16x16x16_bf16 v[28:31], v[126:127], v[164:165], v[28:31]
    v_mfma_f32_16x16x16_bf16 v[32:35], v[124:125], v[170:171], v[32:35]
    v_mfma_f32_16x16x16_bf16 v[36:39], v[126:127], v[170:171], v[36:39]
    v_mfma_f32_16x16x16_bf16 v[40:43], v[128:129], v[164:165], v[40:43]
    v_mfma_f32_16x16x16_bf16 v[44:47], v[130:131], v[164:165], v[44:47]
    v_mfma_f32_16x16x16_bf16 v[48:51], v[128:129], v[170:171], v[48:51]
    v_mfma_f32_16x16x16_bf16 v[52:55], v[130:131], v[170:171], v[52:55]
    v_mfma_f32_16x16x16_bf16 v[56:59], v[132:133], v[164:165], v[56:59]
    v_mfma_f32_16x16x16_bf16 v[60:63], v[134:135], v[164:165], v[60:63]
    v_mfma_f32_16x16x16_bf16 v[64:67], v[132:133], v[170:171], v[64:67]
    v_mfma_f32_16x16x16_bf16 v[68:71], v[134:135], v[170:171], v[68:71]
    v_mul_f32 v8, v8, v180
    v_mul_f32 v12, v12, v180
    v_mul_f32 v9, v9, v180
    v_mul_f32 v13, v13, v180
    v_mul_f32 v10, v10, v180
    v_mul_f32 v14, v14, v180
    v_mul_f32 v11, v11, v180
    v_mul_f32 v15, v15, v180
    v_cvt_pk_bf16_f32 v8, v8, v12
    v_cvt_pk_bf16_f32 v9, v9, v13
    v_cvt_pk_bf16_f32 v10, v10, v14
    v_cvt_pk_bf16_f32 v11, v11, v15
    buffer_store_dwordx4 v[8:11], v1, s[4:7], s18 offen offset:0 sc1
    v_mul_f32 v16, v16, v184
    v_mul_f32 v20, v20, v184
    v_mul_f32 v17, v17, v184
    v_mul_f32 v21, v21, v184
    v_mul_f32 v18, v18, v184
    v_mul_f32 v22, v22, v184
    v_mul_f32 v19, v19, v184
    v_mul_f32 v23, v23, v184
    v_cvt_pk_bf16_f32 v16, v16, v20
    v_cvt_pk_bf16_f32 v17, v17, v21
    v_cvt_pk_bf16_f32 v18, v18, v22
    v_cvt_pk_bf16_f32 v19, v19, v23
    buffer_store_dwordx4 v[16:19], v1, s[4:7], s19 offen offset:0 sc1
    v_mul_f32 v24, v24, v180
    v_mul_f32 v28, v28, v180
    v_mul_f32 v25, v25, v180
    v_mul_f32 v29, v29, v180
    v_mul_f32 v26, v26, v180
    v_mul_f32 v30, v30, v180
    v_mul_f32 v27, v27, v180
    v_mul_f32 v31, v31, v180
    v_cvt_pk_bf16_f32 v24, v24, v28
    v_cvt_pk_bf16_f32 v25, v25, v29
    v_cvt_pk_bf16_f32 v26, v26, v30
    v_cvt_pk_bf16_f32 v27, v27, v31
    buffer_store_dwordx4 v[24:27], v1, s[4:7], s18 offen offset:1024 sc1
    v_mul_f32 v32, v32, v184
    v_mul_f32 v36, v36, v184
    v_mul_f32 v33, v33, v184
    v_mul_f32 v37, v37, v184
    v_mul_f32 v34, v34, v184
    v_mul_f32 v38, v38, v184
    v_mul_f32 v35, v35, v184
    v_mul_f32 v39, v39, v184
    v_cvt_pk_bf16_f32 v32, v32, v36
    v_cvt_pk_bf16_f32 v33, v33, v37
    v_cvt_pk_bf16_f32 v34, v34, v38
    v_cvt_pk_bf16_f32 v35, v35, v39
    buffer_store_dwordx4 v[32:35], v1, s[4:7], s19 offen offset:1024 sc1
    v_mul_f32 v40, v40, v180
    v_mul_f32 v44, v44, v180
    v_mul_f32 v41, v41, v180
    v_mul_f32 v45, v45, v180
    v_mul_f32 v42, v42, v180
    v_mul_f32 v46, v46, v180
    v_mul_f32 v43, v43, v180
    v_mul_f32 v47, v47, v180
    v_cvt_pk_bf16_f32 v40, v40, v44
    v_cvt_pk_bf16_f32 v41, v41, v45
    v_cvt_pk_bf16_f32 v42, v42, v46
    v_cvt_pk_bf16_f32 v43, v43, v47
    buffer_store_dwordx4 v[40:43], v1, s[4:7], s18 offen offset:2048 sc1
    v_mul_f32 v48, v48, v184
    v_mul_f32 v52, v52, v184
    v_mul_f32 v49, v49, v184
    v_mul_f32 v53, v53, v184
    v_mul_f32 v50, v50, v184
    v_mul_f32 v54, v54, v184
    v_mul_f32 v51, v51, v184
    v_mul_f32 v55, v55, v184
    v_cvt_pk_bf16_f32 v48, v48, v52
    v_cvt_pk_bf16_f32 v49, v49, v53
    v_cvt_pk_bf16_f32 v50, v50, v54
    v_cvt_pk_bf16_f32 v51, v51, v55
    buffer_store_dwordx4 v[48:51], v1, s[4:7], s19 offen offset:2048 sc1
    v_mul_f32 v56, v56, v180
    v_mul_f32 v60, v60, v180
    v_mul_f32 v57, v57, v180
    v_mul_f32 v61, v61, v180
    v_mul_f32 v58, v58, v180
    v_mul_f32 v62, v62, v180
    v_mul_f32 v59, v59, v180
    v_mul_f32 v63, v63, v180
    v_cvt_pk_bf16_f32 v56, v56, v60
    v_cvt_pk_bf16_f32 v57, v57, v61
    v_cvt_pk_bf16_f32 v58, v58, v62
    v_cvt_pk_bf16_f32 v59, v59, v63
    buffer_store_dwordx4 v[56:59], v1, s[4:7], s18 offen offset:3072 sc1
    v_mul_f32 v64, v64, v184
    v_mul_f32 v68, v68, v184
    v_mul_f32 v65, v65, v184
    v_mul_f32 v69, v69, v184
    v_mul_f32 v66, v66, v184
    v_mul_f32 v70, v70, v184
    v_mul_f32 v67, v67, v184
    v_mul_f32 v71, v71, v184
    v_cvt_pk_bf16_f32 v64, v64, v68
    v_cvt_pk_bf16_f32 v65, v65, v69
    v_cvt_pk_bf16_f32 v66, v66, v70
    v_cvt_pk_bf16_f32 v67, v67, v71
    buffer_store_dwordx4 v[64:67], v1, s[4:7], s19 offen offset:3072 sc1
    s_lshr_b32 s40, s34, 1
    s_lshl_b32 s40, s40, 7
    s_and_b32 s41, s34, 1
    s_lshl_b32 s41, s41, 2
    s_add_u32 s40, s40, s41
    s_add_u32 s40, s40, 125894656
    s_waitcnt vmcnt(0)
    s_barrier
    v_mov_b32 v250, s95
    v_cmp_eq_u32 vcc, 0, v0
    s_nop 0
    s_and_saveexec_b64 s[38:39], vcc
    s_cbranch_execz fs19
    buffer_store_dword v250, off, s[4:7], s40 sc1
fs19:
    s_mov_b64 exec, -1
    s_branch L_att_next
L_op_start:
    s_lshl_b32 s35, s33, 2
    s_add_u32 s35, s35, 136
    s_mov_b32 s37, s35
    v_mov_b32 v250, 1
    v_mov_b32 v251, 163832
    v_cmp_eq_u32 vcc, 0, v0
    s_nop 0
    s_and_saveexec_b64 s[38:39], vcc
    s_cbranch_execz tk20
    buffer_atomic_add v250, off, s[84:87], s37 sc0
    s_waitcnt vmcnt(0)
    ds_write_b32 v251, v250
    s_waitcnt lgkmcnt(0)
tk20:
    s_mov_b64 exec, -1
    s_barrier
    ds_read_b32 v252, v251
    s_waitcnt lgkmcnt(0)
    v_readfirstlane_b32 s16, v252
    s_barrier
    s_nop 3
    s_cmp_ge_u32 s16, 128
    s_cbranch_scc1 L_op_nextcb
    s_lshr_b32 s89, s33, 2
    s_lshl_b32 s89, s89, 7
    s_add_u32 s89, s89, 125841408
    v_mbcnt_lo_u32_b32 v2, -1, 0
    v_mbcnt_hi_u32_b32 v2, -1, v2
    v_min_u32 v2, 31, v2
    v_lshlrev_b32 v2, 2, v2
    s_mov_b32 s88, 4194304
fw21:
    buffer_load_dword v3, v2, s[4:7], s89 offen offset:0 sc1
    s_sub_u32 s88, s88, 1
    s_cbranch_scc1 fw21x
    s_waitcnt vmcnt(0)
    v_cmp_ne_u32 vcc, s95, v3
    s_cbranch_vccz fw21x
    s_sleep 4
    s_branch fw21
fw21x:
    v_and_b32 v1, 63, v0
    v_lshlrev_b32 v1, 4, v1
    s_lshl_b32 s18, s33, 18
    s_lshl_b32 s19, s32, 16
    s_add_u32 s18, s18, s19
    s_add_u32 s18, s18, 130023424
    buffer_load_dwordx4 a[0:3], v1, s[4:7], s18 offen offset:0 sc1
    buffer_load_dwordx4 a[4:7], v1, s[4:7], s18 offen offset:1024 sc1
    buffer_load_dwordx4 a[8:11], v1, s[4:7], s18 offen offset:2048 sc1
    buffer_load_dwordx4 a[12:15], v1, s[4:7], s18 offen offset:3072 sc1
    s_add_u32 s18, s18, 4096
    buffer_load_dwordx4 a[16:19], v1, s[4:7], s18 offen offset:0 sc1
    buffer_load_dwordx4 a[20:23], v1, s[4:7], s18 offen offset:1024 sc1
    buffer_load_dwordx4 a[24:27], v1, s[4:7], s18 offen offset:2048 sc1
    buffer_load_dwordx4 a[28:31], v1, s[4:7], s18 offen offset:3072 sc1
    s_add_u32 s18, s18, 4096
    buffer_load_dwordx4 a[32:35], v1, s[4:7], s18 offen offset:0 sc1
    buffer_load_dwordx4 a[36:39], v1, s[4:7], s18 offen offset:1024 sc1
    buffer_load_dwordx4 a[40:43], v1, s[4:7], s18 offen offset:2048 sc1
    buffer_load_dwordx4 a[44:47], v1, s[4:7], s18 offen offset:3072 sc1
    s_add_u32 s18, s18, 4096
    buffer_load_dwordx4 a[48:51], v1, s[4:7], s18 offen offset:0 sc1
    buffer_load_dwordx4 a[52:55], v1, s[4:7], s18 offen offset:1024 sc1
    buffer_load_dwordx4 a[56:59], v1, s[4:7], s18 offen offset:2048 sc1
    buffer_load_dwordx4 a[60:63], v1, s[4:7], s18 offen offset:3072 sc1
    s_add_u32 s18, s18, 4096
    buffer_load_dwordx4 a[64:67], v1, s[4:7], s18 offen offset:0 sc1
    buffer_load_dwordx4 a[68:71], v1, s[4:7], s18 offen offset:1024 sc1
    buffer_load_dwordx4 a[72:75], v1, s[4:7], s18 offen offset:2048 sc1
    buffer_load_dwordx4 a[76:79], v1, s[4:7], s18 offen offset:3072 sc1
    s_add_u32 s18, s18, 4096
    buffer_load_dwordx4 a[80:83], v1, s[4:7], s18 offen offset:0 sc1
    buffer_load_dwordx4 a[84:87], v1, s[4:7], s18 offen offset:1024 sc1
    buffer_load_dwordx4 a[88:91], v1, s[4:7], s18 offen offset:2048 sc1
    buffer_load_dwordx4 a[92:95], v1, s[4:7], s18 offen offset:3072 sc1
    s_add_u32 s18, s18, 4096
    buffer_load_dwordx4 a[96:99], v1, s[4:7], s18 offen offset:0 sc1
    buffer_load_dwordx4 a[100:103], v1, s[4:7], s18 offen offset:1024 sc1
    buffer_load_dwordx4 a[104:107], v1, s[4:7], s18 offen offset:2048 sc1
    buffer_load_dwordx4 a[108:111], v1, s[4:7], s18 offen offset:3072 sc1
    s_add_u32 s18, s18, 4096
    buffer_load_dwordx4 a[112:115], v1, s[4:7], s18 offen offset:0 sc1
    buffer_load_dwordx4 a[116:119], v1, s[4:7], s18 offen offset:1024 sc1
    buffer_load_dwordx4 a[120:123], v1, s[4:7], s18 offen offset:2048 sc1
    buffer_load_dwordx4 a[124:127], v1, s[4:7], s18 offen offset:3072 sc1
    s_add_u32 s18, s18, 4096
    buffer_load_dwordx4 a[128:131], v1, s[4:7], s18 offen offset:0 sc1
    buffer_load_dwordx4 a[132:135], v1, s[4:7], s18 offen offset:1024 sc1
    buffer_load_dwordx4 a[136:139], v1, s[4:7], s18 offen offset:2048 sc1
    buffer_load_dwordx4 a[140:143], v1, s[4:7], s18 offen offset:3072 sc1
    s_add_u32 s18, s18, 4096
    buffer_load_dwordx4 a[144:147], v1, s[4:7], s18 offen offset:0 sc1
    buffer_load_dwordx4 a[148:151], v1, s[4:7], s18 offen offset:1024 sc1
    buffer_load_dwordx4 a[152:155], v1, s[4:7], s18 offen offset:2048 sc1
    buffer_load_dwordx4 a[156:159], v1, s[4:7], s18 offen offset:3072 sc1
    s_add_u32 s18, s18, 4096
    buffer_load_dwordx4 a[160:163], v1, s[4:7], s18 offen offset:0 sc1
    s_waitcnt vmcnt(20)
    buffer_load_dwordx4 a[164:167], v1, s[4:7], s18 offen offset:1024 sc1
    buffer_load_dwordx4 a[168:171], v1, s[4:7], s18 offen offset:2048 sc1
    buffer_load_dwordx4 a[172:175], v1, s[4:7], s18 offen offset:3072 sc1
    s_add_u32 s18, s18, 4096
    buffer_load_dwordx4 a[176:179], v1, s[4:7], s18 offen offset:0 sc1
    buffer_load_dwordx4 a[180:183], v1, s[4:7], s18 offen offset:1024 sc1
    buffer_load_dwordx4 a[184:187], v1, s[4:7], s18 offen offset:2048 sc1
    buffer_load_dwordx4 a[188:191], v1, s[4:7], s18 offen offset:3072 sc1
    s_add_u32 s18, s18, 4096
    buffer_load_dwordx4 a[192:195], v1, s[4:7], s18 offen offset:0 sc1
    buffer_load_dwordx4 a[196:199], v1, s[4:7], s18 offen offset:1024 sc1
    buffer_load_dwordx4 a[200:203], v1, s[4:7], s18 offen offset:2048 sc1
    buffer_load_dwordx4 a[204:207], v1, s[4:7], s18 offen offset:3072 sc1
    s_add_u32 s18, s18, 4096
    buffer_load_dwordx4 a[208:211], v1, s[4:7], s18 offen offset:0 sc1
    buffer_load_dwordx4 a[212:215], v1, s[4:7], s18 offen offset:1024 sc1
    buffer_load_dwordx4 a[216:219], v1, s[4:7], s18 offen offset:2048 sc1
    buffer_load_dwordx4 a[220:223], v1, s[4:7], s18 offen offset:3072 sc1
    s_add_u32 s18, s18, 4096
    buffer_load_dwordx4 a[224:227], v1, s[4:7], s18 offen offset:0 sc1
    buffer_load_dwordx4 a[228:231], v1, s[4:7], s18 offen offset:1024 sc1
    buffer_load_dwordx4 a[232:235], v1, s[4:7], s18 offen offset:2048 sc1
    buffer_load_dwordx4 a[236:239], v1, s[4:7], s18 offen offset:3072 sc1
    s_add_u32 s18, s18, 4096
    buffer_load_dwordx4 a[240:243], v1, s[4:7], s18 offen offset:0 sc1
    buffer_load_dwordx4 a[244:247], v1, s[4:7], s18 offen offset:1024 sc1
    buffer_load_dwordx4 a[248:251], v1, s[4:7], s18 offen offset:2048 sc1
    buffer_load_dwordx4 a[252:255], v1, s[4:7], s18 offen offset:3072 sc1
    s_waitcnt vmcnt(0)
L_op_seg:
    s_lshr_b32 s43, s16, 1
    s_add_u32 s43, s43, 2
    s_min_u32 s43, s43, 65
    s_lshl_b32 s94, s33, 7
    s_add_u32 s94, s94, s16
    s_mov_b32 s88, 65536
    s_mov_b32 s89, 125853696
cw22:
    buffer_load_dword v3, off, s[4:7], s89 sc1
    s_waitcnt vmcnt(0)
    v_readfirstlane_b32 s42, v3
    s_nop 0
    s_sub_u32 s42, s42, s95
    s_cmp_gt_u32 s42, 64
    s_cselect_b32 s42, 0, s42
    s_add_u32 s42, s42, 1
    s_cmp_ge_u32 s42, s43
    s_cbranch_scc1 cw22x
    s_sub_u32 s88, s88, 1
    s_cbranch_scc1 cw22x
    s_sub_u32 s42, s43, s42
    s_min_u32 s42, s42, 6
cw22s:
    s_sleep 24
    s_sub_u32 s42, s42, 1
    s_cmp_lg_u32 s42, 0
    s_cbranch_scc1 cw22s
    s_branch cw22
cw22x:
    s_lshr_b32 s89, s16, 1
    s_lshl_b32 s89, s89, 2
    s_add_u32 s89, s89, s32
    s_lshl_b32 s89, s89, 7
    s_add_u32 s89, s89, 125894656
    v_mbcnt_lo_u32_b32 v2, -1, 0
    v_mbcnt_hi_u32_b32 v2, -1, v2
    v_min_u32 v2, 1, v2
    v_lshlrev_b32 v2, 2, v2
    s_mov_b32 s88, 4194304
fw23:
    buffer_load_dword v3, v2, s[4:7], s89 offen offset:0 sc1
    s_sub_u32 s88, s88, 1
    s_cbranch_scc1 fw23x
    s_waitcnt vmcnt(0)
    v_cmp_ne_u32 vcc, s95, v3
    s_cbranch_vccz fw23x
    s_sleep 6
    s_branch fw23
fw23x:
    s_lshl_b32 s18, s16, 17
    s_lshl_b32 s19, s32, 15
    s_add_u32 s18, s18, s19
    s_add_u32 s18, s18, 50331648
    buffer_load_dwordx4 v[32:35], v1, s[4:7], s18 offen offset:0 sc1
    buffer_load_dwordx4 v[36:39], v1, s[4:7], s18 offen offset:1024 sc1
    buffer_load_dwordx4 v[40:43], v1, s[4:7], s18 offen offset:2048 sc1
    buffer_load_dwordx4 v[44:47], v1, s[4:7], s18 offen offset:3072 sc1
    s_add_u32 s18, s18, 4096
    buffer_load_dwordx4 v[48:51], v1, s[4:7], s18 offen offset:0 sc1
    buffer_load_dwordx4 v[52:55], v1, s[4:7], s18 offen offset:1024 sc1
    buffer_load_dwordx4 v[56:59], v1, s[4:7], s18 offen offset:2048 sc1
    buffer_load_dwordx4 v[60:63], v1, s[4:7], s18 offen offset:3072 sc1
    s_add_u32 s18, s18, 4096
    buffer_load_dwordx4 v[64:67], v1, s[4:7], s18 offen offset:0 sc1
    buffer_load_dwordx4 v[68:71], v1, s[4:7], s18 offen offset:1024 sc1
    buffer_load_dwordx4 v[72:75], v1, s[4:7], s18 offen offset:2048 sc1
    buffer_load_dwordx4 v[76:79], v1, s[4:7], s18 offen offset:3072 sc1
    s_add_u32 s18, s18, 4096
    buffer_load_dwordx4 v[80:83], v1, s[4:7], s18 offen offset:0 sc1
    buffer_load_dwordx4 v[84:87], v1, s[4:7], s18 offen offset:1024 sc1
    buffer_load_dwordx4 v[88:91], v1, s[4:7], s18 offen offset:2048 sc1
    buffer_load_dwordx4 v[92:95], v1, s[4:7], s18 offen offset:3072 sc1
    s_add_u32 s18, s18, 4096
    buffer_load_dwordx4 v[96:99], v1, s[4:7], s18 offen offset:0 sc1
    buffer_load_dwordx4 v[100:103], v1, s[4:7], s18 offen offset:1024 sc1
    buffer_load_dwordx4 v[104:107], v1, s[4:7], s18 offen offset:2048 sc1
    buffer_load_dwordx4 v[108:111], v1, s[4:7], s18 offen offset:3072 sc1
    s_add_u32 s18, s18, 4096
    buffer_load_dwordx4 v[112:115], v1, s[4:7], s18 offen offset:0 sc1
    buffer_load_dwordx4 v[116:119], v1, s[4:7], s18 offen offset:1024 sc1
    buffer_load_dwordx4 v[120:123], v1, s[4:7], s18 offen offset:2048 sc1
    buffer_load_dwordx4 v[124:127], v1, s[4:7], s18 offen offset:3072 sc1
    s_add_u32 s18, s18, 4096
    buffer_load_dwordx4 v[128:131], v1, s[4:7], s18 offen offset:0 sc1
    buffer_load_dwordx4 v[132:135], v1, s[4:7], s18 offen offset:1024 sc1
    buffer_load_dwordx4 v[136:139], v1, s[4:7], s18 offen offset:2048 sc1
    buffer_load_dwordx4 v[140:143], v1, s[4:7], s18 offen offset:3072 sc1
    s_add_u32 s18, s18, 4096
    buffer_load_dwordx4 v[144:147], v1, s[4:7], s18 offen offset:0 sc1
    buffer_load_dwordx4 v[148:151], v1, s[4:7], s18 offen offset:1024 sc1
    buffer_load_dwordx4 v[152:155], v1, s[4:7], s18 offen offset:2048 sc1
    buffer_load_dwordx4 v[156:159], v1, s[4:7], s18 offen offset:3072 sc1
    v_lshlrev_b32 v2, 4, v0
    v_and_b32 v3, 3072, v2
    v_lshl_add_u32 v2, v3, 1, v1
    s_waitcnt vmcnt(31)
    v_mfma_f32_16x16x32_bf16 v[8:11], a[0:3], v[32:35], 0
    v_mfma_f32_16x16x32_bf16 v[12:15], a[4:7], v[32:35], 0
    s_waitcnt vmcnt(30)
    v_mfma_f32_16x16x32_bf16 v[8:11], a[8:11], v[36:39], v[8:11]
    v_mfma_f32_16x16x32_bf16 v[12:15], a[12:15], v[36:39], v[12:15]
    s_waitcnt vmcnt(29)
    v_mfma_f32_16x16x32_bf16 v[8:11], a[16:19], v[40:43], v[8:11]
    v_mfma_f32_16x16x32_bf16 v[12:15], a[20:23], v[40:43], v[12:15]
    s_waitcnt vmcnt(28)
    v_mfma_f32_16x16x32_bf16 v[8:11], a[24:27], v[44:47], v[8:11]
    v_mfma_f32_16x16x32_bf16 v[12:15], a[28:31], v[44:47], v[12:15]
    s_waitcnt vmcnt(27)
    v_mfma_f32_16x16x32_bf16 v[8:11], a[32:35], v[48:51], v[8:11]
    v_mfma_f32_16x16x32_bf16 v[12:15], a[36:39], v[48:51], v[12:15]
    s_waitcnt vmcnt(26)
    v_mfma_f32_16x16x32_bf16 v[8:11], a[40:43], v[52:55], v[8:11]
    v_mfma_f32_16x16x32_bf16 v[12:15], a[44:47], v[52:55], v[12:15]
    s_waitcnt vmcnt(25)
    v_mfma_f32_16x16x32_bf16 v[8:11], a[48:51], v[56:59], v[8:11]
    v_mfma_f32_16x16x32_bf16 v[12:15], a[52:55], v[56:59], v[12:15]
    s_waitcnt vmcnt(24)
    v_mfma_f32_16x16x32_bf16 v[8:11], a[56:59], v[60:63], v[8:11]
    v_mfma_f32_16x16x32_bf16 v[12:15], a[60:63], v[60:63], v[12:15]
    s_waitcnt vmcnt(23)
    v_mfma_f32_16x16x32_bf16 v[8:11], a[64:67], v[64:67], v[8:11]
    v_mfma_f32_16x16x32_bf16 v[12:15], a[68:71], v[64:67], v[12:15]
    s_waitcnt vmcnt(22)
    v_mfma_f32_16x16x32_bf16 v[8:11], a[72:75], v[68:71], v[8:11]
    v_mfma_f32_16x16x32_bf16 v[12:15], a[76:79], v[68:71], v[12:15]
    s_waitcnt vmcnt(21)
    v_mfma_f32_16x16x32_bf16 v[8:11], a[80:83], v[72:75], v[8:11]
    v_mfma_f32_16x16x32_bf16 v[12:15], a[84:87], v[72:75], v[12:15]
    s_waitcnt vmcnt(20)
    v_mfma_f32_16x16x32_bf16 v[8:11], a[88:91], v[76:79], v[8:11]
    v_mfma_f32_16x16x32_bf16 v[12:15], a[92:95], v[76:79], v[12:15]
    s_waitcnt vmcnt(19)
    v_mfma_f32_16x16x32_bf16 v[8:11], a[96:99], v[80:83], v[8:11]
    v_mfma_f32_16x16x32_bf16 v[12:15], a[100:103], v[80:83], v[12:15]
    s_waitcnt vmcnt(18)
    v_mfma_f32_16x16x32_bf16 v[8:11], a[104:107], v[84:87], v[8:11]
    v_mfma_f32_16x16x32_bf16 v[12:15], a[108:111], v[84:87], v[12:15]
    s_waitcnt vmcnt(17)
    v_mfma_f32_16x16x32_bf16 v[8:11], a[112:115], v[88:91], v[8:11]
    v_mfma_f32_16x16x32_bf16 v[12:15], a[116:119], v[88:91], v[12:15]
    s_waitcnt vmcnt(16)
    v_mfma_f32_16x16x32_bf16 v[8:11], a[120:123], v[92:95], v[8:11]
    v_mfma_f32_16x16x32_bf16 v[12:15], a[124:127], v[92:95], v[12:15]
    s_waitcnt vmcnt(15)
    v_mfma_f32_16x16x32_bf16 v[8:11], a[128:131], v[96:99], v[8:11]
    v_mfma_f32_16x16x32_bf16 v[12:15], a[132:135], v[96:99], v[12:15]
    s_waitcnt vmcnt(14)
    v_mfma_f32_16x16x32_bf16 v[8:11], a[136:139], v[100:103], v[8:11]
    v_mfma_f32_16x16x32_bf16 v[12:15], a[140:143], v[100:103], v[12:15]
    s_waitcnt vmcnt(13)
    v_mfma_f32_16x16x32_bf16 v[8:11], a[144:147], v[104:107], v[8:11]
    v_mfma_f32_16x16x32_bf16 v[12:15], a[148:151], v[104:107], v[12:15]
    s_waitcnt vmcnt(12)
    v_mfma_f32_16x16x32_bf16 v[8:11], a[152:155], v[108:111], v[8:11]
    v_mfma_f32_16x16x32_bf16 v[12:15], a[156:159], v[108:111], v[12:15]
    s_waitcnt vmcnt(11)
    v_mfma_f32_16x16x32_bf16 v[8:11], a[160:163], v[112:115], v[8:11]
    v_mfma_f32_16x16x32_bf16 v[12:15], a[164:167], v[112:115], v[12:15]
    s_waitcnt vmcnt(10)
    v_mfma_f32_16x16x32_bf16 v[8:11], a[168:171], v[116:119], v[8:11]
    v_mfma_f32_16x16x32_bf16 v[12:15], a[172:175], v[116:119], v[12:15]
    s_waitcnt vmcnt(9)
    v_mfma_f32_16x16x32_bf16 v[8:11], a[176:179], v[120:123], v[8:11]
    v_mfma_f32_16x16x32_bf16 v[12:15], a[180:183], v[120:123], v[12:15]
    s_waitcnt vmcnt(8)
    v_mfma_f32_16x16x32_bf16 v[8:11], a[184:187], v[124:127], v[8:11]
    v_mfma_f32_16x16x32_bf16 v[12:15], a[188:191], v[124:127], v[12:15]
    s_waitcnt vmcnt(7)
    v_mfma_f32_16x16x32_bf16 v[8:11], a[192:195], v[128:131], v[8:11]
    v_mfma_f32_16x16x32_bf16 v[12:15], a[196:199], v[128:131], v[12:15]
    s_waitcnt vmcnt(6)
    v_mfma_f32_16x16x32_bf16 v[8:11], a[200:203], v[132:135], v[8:11]
    v_mfma_f32_16x16x32_bf16 v[12:15], a[204:207], v[132:135], v[12:15]
    s_waitcnt vmcnt(5)
    v_mfma_f32_16x16x32_bf16 v[8:11], a[208:211], v[136:139], v[8:11]
    v_mfma_f32_16x16x32_bf16 v[12:15], a[212:215], v[136:139], v[12:15]
    s_waitcnt vmcnt(4)
    v_mfma_f32_16x16x32_bf16 v[8:11], a[216:219], v[140:143], v[8:11]
    v_mfma_f32_16x16x32_bf16 v[12:15], a[220:223], v[140:143], v[12:15]
    s_waitcnt vmcnt(3)
    v_mfma_f32_16x16x32_bf16 v[8:11], a[224:227], v[144:147], v[8:11]
    v_mfma_f32_16x16x32_bf16 v[12:15], a[228:231], v[144:147], v[12:15]
    s_waitcnt vmcnt(2)
    v_mfma_f32_16x16x32_bf16 v[8:11], a[232:235], v[148:151], v[8:11]
    v_mfma_f32_16x16x32_bf16 v[12:15], a[236:239], v[148:151], v[12:15]
    s_waitcnt vmcnt(1)
    v_mfma_f32_16x16x32_bf16 v[8:11], a[240:243], v[152:155], v[8:11]
    v_mfma_f32_16x16x32_bf16 v[12:15], a[244:247], v[152:155], v[12:15]
    s_waitcnt vmcnt(0)
    v_mfma_f32_16x16x32_bf16 v[8:11], a[248:251], v[156:159], v[8:11]
    v_mfma_f32_16x16x32_bf16 v[12:15], a[252:255], v[156:159], v[12:15]
    s_nop 6
    ds_write_b128 v2, v[8:11] offset:0
    ds_write_b128 v2, v[12:15] offset:1024
    s_waitcnt lgkmcnt(0)
    s_barrier
    s_cmp_lg_u32 s32, 0
    s_cbranch_scc1 os_skip
    ds_read_b128 v[40:43], v1 offset:2048
    ds_read_b128 v[44:47], v1 offset:3072
    ds_read_b128 v[48:51], v1 offset:4096
    ds_read_b128 v[52:55], v1 offset:5120
    ds_read_b128 v[56:59], v1 offset:6144
    ds_read_b128 v[60:63], v1 offset:7168
    v_lshrrev_b32 v3, 4, v1
    v_bfe_u32 v4, v3, 2, 2
    v_lshlrev_b32 v4, 3, v4
    v_and_b32 v2, 3, v3
    v_add_u32 v4, v4, v2
    v_mul_u32_u24 v4, 2304, v4
    v_lshrrev_b32 v3, 4, v3
    v_lshl_add_u32 v4, v3, 4, v4
    s_lshr_b32 s18, s16, 1
    s_lshl_b32 s18, s18, 3
    s_and_b32 s19, s16, 1
    s_add_u32 s18, s18, s19
    s_mul_i32 s18, s18, 9216
    s_lshl_b32 s19, s33, 6
    s_add_u32 s18, s18, s19
    s_waitcnt lgkmcnt(0)
    v_pk_add_f32 v[8:9], v[8:9], v[40:41]
    v_pk_add_f32 v[48:49], v[48:49], v[56:57]
    v_pk_add_f32 v[8:9], v[8:9], v[48:49]
    v_pk_add_f32 v[10:11], v[10:11], v[42:43]
    v_pk_add_f32 v[50:51], v[50:51], v[58:59]
    v_pk_add_f32 v[10:11], v[10:11], v[50:51]
    v_pk_add_f32 v[12:13], v[12:13], v[44:45]
    v_pk_add_f32 v[52:53], v[52:53], v[60:61]
    v_pk_add_f32 v[12:13], v[12:13], v[52:53]
    v_pk_add_f32 v[14:15], v[14:15], v[46:47]
    v_pk_add_f32 v[54:55], v[54:55], v[62:63]
    v_pk_add_f32 v[14:15], v[14:15], v[54:55]
    v_cvt_pk_bf16_f32 v32, v8, v12
    v_cvt_pk_bf16_f32 v33, v9, v13
    v_cvt_pk_bf16_f32 v34, v10, v14
    v_cvt_pk_bf16_f32 v35, v11, v15
    buffer_store_dwordx4 v[32:35], v4, s[8:11], s18 offen
os_skip:
    s_nop 1
    s_cmp_ge_u32 s16, 124
    s_cbranch_scc1 L_op_nextcb
    s_mov_b32 s37, s35
    v_mov_b32 v250, 1
    v_mov_b32 v251, 163832
    v_cmp_eq_u32 vcc, 0, v0
    s_nop 0
    s_and_saveexec_b64 s[38:39], vcc
    s_cbranch_execz tk24
    buffer_atomic_add v250, off, s[84:87], s37 sc0
    s_waitcnt vmcnt(0)
    ds_write_b32 v251, v250
    s_waitcnt lgkmcnt(0)
tk24:
    s_mov_b64 exec, -1
    s_barrier
    ds_read_b32 v252, v251
    s_waitcnt lgkmcnt(0)
    v_readfirstlane_b32 s16, v252
    s_barrier
    s_nop 3
    s_cmp_lt_u32 s16, 128
    s_cbranch_scc1 L_op_seg
L_op_nextcb:
    v_and_b32 v1, 63, v0
    v_min_u32 v1, 17, v1
    v_lshlrev_b32 v2, 2, v1
    buffer_load_dword v3, v2, s[84:87], 0 offen offset:136 sc1
    s_waitcnt vmcnt(0)
    v_cmp_gt_u32 vcc, 128, v3
    s_nop 0
    s_ff1_i32_b64 s40, vcc
    v_mov_b32 v250, s40
    v_mov_b32 v251, 163832
    s_cmp_lg_u32 s32, 0
    s_cbranch_scc1 L_op_nw
    ds_write_b32 v251, v250
    s_waitcnt lgkmcnt(0)
L_op_nw:
    s_barrier
    ds_read_b32 v252, v251
    s_waitcnt lgkmcnt(0)
    v_readfirstlane_b32 s33, v252
    s_barrier
    s_nop 1
    s_cmp_lt_u32 s33, 18
    s_cbranch_scc1 L_op_start
L_exit:
    s_endpgm
.section .rodata,"a"
.p2align 6
.amdhsa_kernel concat_heads__memory_aug_recurrent_mem_tr__ssm_conv_s4d__prompt_kernel
  .amdhsa_next_free_vgpr 512
  .amdhsa_next_free_sgpr 102
  .amdhsa_accum_offset 256
  .amdhsa_group_segment_fixed_size 0
  .amdhsa_kernarg_size 136
  .amdhsa_user_sgpr_count 2
  .amdhsa_user_sgpr_kernarg_segment_ptr 1
  .amdhsa_system_sgpr_workgroup_id_x 1
.end_amdhsa_kernel
.text
```

```asm
; @launch grid=(256,1,1) block=(256,1,1) lds=163840
.amdgcn_target "amdgcn-amd-amdhsa--gfx950"
.text
.globl concat_heads__memory_aug_recurrent_mem_tr__ssm_conv_s4d__prompt_kernel
.p2align 8
.type concat_heads__memory_aug_recurrent_mem_tr__ssm_conv_s4d__prompt_kernel,@function
concat_heads__memory_aug_recurrent_mem_tr__ssm_conv_s4d__prompt_kernel:
    s_cmp_ge_u32 s2, 256
    s_cbranch_scc1 L_exit
    s_load_dwordx4 s[80:83], s[0:1], 120
    s_load_dwordx16 s[48:63], s[0:1], 0
    s_memrealtime s[90:91]
    v_lshrrev_b32 v1, 6, v0
    s_nop 0
    v_readfirstlane_b32 s32, v1
    s_waitcnt lgkmcnt(0)
    s_mov_b32 s4, s82
    s_mov_b32 s5, s83
    s_mov_b32 s6, 268435456
    s_mov_b32 s7, 0x20000
    s_mov_b32 s84, s80
    s_mov_b32 s85, s81
    s_mov_b32 s86, 256
    s_mov_b32 s87, 0x20000
    s_cmp_lg_u32 s32, 0
    s_cbranch_scc1 L_nod0
L_nod0:
    s_cmp_lg_u32 s32, 3
    s_cbranch_scc1 L_nowarm
    s_getpc_b64 s[44:45]
L_pcw:
    v_and_b32 v1, 63, v0
    v_lshlrev_b32 v1, 7, v1
    v_min_u32 v2, L_exit-L_pcw, v1
    global_load_dword v210, v2, s[44:45]
    v_add_u32 v1, 8192, v1
    v_min_u32 v2, L_exit-L_pcw, v1
    global_load_dword v211, v2, s[44:45]
    v_add_u32 v1, 8192, v1
    v_min_u32 v2, L_exit-L_pcw, v1
    global_load_dword v212, v2, s[44:45]
    v_add_u32 v1, 8192, v1
    v_min_u32 v2, L_exit-L_pcw, v1
    global_load_dword v213, v2, s[44:45]
    v_add_u32 v1, 8192, v1
    v_min_u32 v2, L_exit-L_pcw, v1
    global_load_dword v214, v2, s[44:45]
    v_add_u32 v1, 8192, v1
    v_min_u32 v2, L_exit-L_pcw, v1
    global_load_dword v215, v2, s[44:45]
    v_add_u32 v1, 8192, v1
    v_min_u32 v2, L_exit-L_pcw, v1
    global_load_dword v216, v2, s[44:45]
    v_add_u32 v1, 8192, v1
    v_min_u32 v2, L_exit-L_pcw, v1
    global_load_dword v217, v2, s[44:45]
    v_add_u32 v1, 8192, v1
L_nowarm:
    s_getreg_b32 s3, hwreg(HW_REG_XCC_ID)
    s_and_b32 s3, s3, 15
    s_cmp_lg_u32 s3, 0
    s_cbranch_scc1 L_helper
    s_mov_b32 s37, 128
    v_mov_b32 v250, 1
    v_mov_b32 v251, 163832
    v_cmp_eq_u32 vcc, 0, v0
    s_nop 0
    s_and_saveexec_b64 s[38:39], vcc
    s_cbranch_execz tk1
    buffer_atomic_add v250, off, s[84:87], s37 sc0
    s_waitcnt vmcnt(0)
    ds_write_b32 v251, v250
    s_waitcnt lgkmcnt(0)
tk1:
    s_mov_b64 exec, -1
    s_barrier
    ds_read_b32 v252, v251
    s_waitcnt lgkmcnt(0)
    v_readfirstlane_b32 s12, v252
    s_barrier
    s_nop 3
    s_cmp_ge_u32 s12, 32
    s_cbranch_scc1 L_helper
L_chain:
    s_load_dwordx8 s[48:55], s[0:1], 8
    s_load_dwordx2 s[56:57], s[0:1], 40
    s_waitcnt lgkmcnt(0)
    v_lshrrev_b32 v77, 6, v0
    s_nop 0
    v_readfirstlane_b32 s13, v77
    v_lshlrev_b32 v65, 4, v0
    v_and_b32 v48, 63, v0
    s_mov_b32 s10, 4718592
    s_mov_b32 s11, 0x20000
    v_lshrrev_b32 v49, 3, v48
    v_mul_u32_u24 v18, 1152, v49
    v_and_b32 v49, 7, v48
    v_lshl_add_u32 v18, v49, 4, v18
    s_mul_i32 s40, s12, 147456
    s_mul_i32 s41, s13, 288
    s_add_u32 s40, s40, s41
    s_xor_b32 s41, s13, 0
    s_mul_i32 s41, s41, 36864
    s_add_u32 s60, s41, s40
    s_xor_b32 s41, s13, 1
    s_mul_i32 s41, s41, 36864
    s_add_u32 s61, s41, s40
    s_xor_b32 s41, s13, 2
    s_mul_i32 s41, s41, 36864
    s_add_u32 s62, s41, s40
    s_xor_b32 s41, s13, 3
    s_mul_i32 s41, s41, 36864
    s_add_u32 s63, s41, s40
    s_lshl_b32 s43, s13, 12
    s_mov_b64 s[8:9], s[56:57]
    s_add_u32 m0, s43, 0
    s_add_u32 s41, s60, 0
    buffer_load_dwordx4 v18, s[8:11], s41 offen offset:0 lds
    s_add_u32 s41, s60, 8192
    buffer_load_dwordx4 v18, s[8:11], s41 offen offset:1024 lds
    s_add_u32 s41, s60, 16384
    buffer_load_dwordx4 v18, s[8:11], s41 offen offset:2048 lds
    s_add_u32 s41, s60, 24576
    buffer_load_dwordx4 v18, s[8:11], s41 offen offset:3072 lds
    s_add_u32 m0, s43, 36864
    s_add_u32 s41, s61, 0
    buffer_load_dwordx4 v18, s[8:11], s41 offen offset:0 lds
    s_add_u32 s41, s61, 8192
    buffer_load_dwordx4 v18, s[8:11], s41 offen offset:1024 lds
    s_add_u32 s41, s61, 16384
    buffer_load_dwordx4 v18, s[8:11], s41 offen offset:2048 lds
    s_add_u32 s41, s61, 24576
    buffer_load_dwordx4 v18, s[8:11], s41 offen offset:3072 lds
    s_add_u32 m0, s43, 73728
    s_add_u32 s41, s62, 0
    buffer_load_dwordx4 v18, s[8:11], s41 offen offset:0 lds
    s_add_u32 s41, s62, 8192
    buffer_load_dwordx4 v18, s[8:11], s41 offen offset:1024 lds
    s_add_u32 s41, s62, 16384
    buffer_load_dwordx4 v18, s[8:11], s41 offen offset:2048 lds
    s_add_u32 s41, s62, 24576
    buffer_load_dwordx4 v18, s[8:11], s41 offen offset:3072 lds
    s_add_u32 m0, s43, 110592
    s_add_u32 s41, s63, 0
    buffer_load_dwordx4 v18, s[8:11], s41 offen offset:0 lds
    s_add_u32 s41, s63, 8192
    buffer_load_dwordx4 v18, s[8:11], s41 offen offset:1024 lds
    s_add_u32 s41, s63, 16384
    buffer_load_dwordx4 v18, s[8:11], s41 offen offset:2048 lds
    s_add_u32 s41, s63, 24576
    buffer_load_dwordx4 v18, s[8:11], s41 offen offset:3072 lds
    v_lshrrev_b32 v49, 1, v48
    v_mul_u32_u24 v19, 1152, v49
    v_and_b32 v49, 1, v48
    v_lshl_add_u32 v19, v49, 4, v19
    v_lshrrev_b32 v49, 4, v48
    v_lshlrev_b32 v50, 2, v49
    v_and_b32 v51, 15, v48
    v_xor_b32 v51, v51, v50
    v_lshlrev_b32 v51, 4, v51
    v_lshl_add_u32 v16, v49, 15, v51
    v_lshrrev_b32 v50, 1, v49
    v_lshl_add_u32 v17, v50, 16, v51
    v_and_b32 v50, 1, v49
    v_lshl_add_u32 v17, v50, 13, v17
    s_lshl_b32 s40, s12, 8
    s_mul_i32 s58, s13, 1179648
    s_add_u32 s58, s58, s40
    s_lshr_b32 s41, s13, 1
    s_mul_i32 s59, s41, 2359296
    s_and_b32 s41, s13, 1
    s_lshl_b32 s41, s41, 14
    s_add_u32 s59, s59, s41
    s_add_u32 s59, s59, s40
    s_add_u32 s59, s59, 1048576
    v_bfe_u32 v50, v48, 2, 2
    v_xor_b32 v51, s13, v50
    v_lshlrev_b32 v20, 6, v51
    v_and_b32 v51, 3, v48
    v_lshl_add_u32 v20, v51, 4, v20
    v_lshrrev_b32 v23, 2, v48
    v_lshl_add_u32 v20, v23, 8, v20
    s_xor_b32 s41, s43, 0
    v_add_u32 v24, s41, v20
    s_xor_b32 s41, s43, 4096
    v_add_u32 v25, s41, v20
    s_xor_b32 s41, s43, 8192
    v_add_u32 v26, s41, v20
    s_xor_b32 s41, s43, 12288
    v_add_u32 v27, s41, v20
    v_and_b32 v23, 1, v50
    v_lshl_add_u32 v23, v49, 2, v23
    v_lshrrev_b32 v50, 1, v50
    v_lshlrev_b32 v21, 7, v23
    v_lshl_add_u32 v21, v50, 6, v21
    v_lshl_add_u32 v21, v51, 4, v21
    v_add_u32 v21, s43, v21
    v_lshlrev_b32 v22, 9, v50
    v_xor_b32 v22, v22, v21
    v_lshlrev_b32 v23, 5, v23
    v_lshl_add_u32 v23, v50, 10, v23
    v_lshl_add_u32 v23, v51, 3, v23
    v_add_u32 v23, s43, v23
    v_bfe_u32 v60, v65, 4, 6
    v_and_b32 v61, 15, v60
    v_lshrrev_b32 v62, 4, v60
    v_mov_b32 v64, 0x4444
    v_mov_b32 v77, 0xeeee
    v_cmp_lt_u32 vcc, 7, v61
    s_nop 1
    v_cndmask_b32 v64, v64, v77, vcc
    v_xor_b32 v66, 1024, v65
    v_xor_b32 v67, 2048, v65
    v_xor_b32 v68, 3072, v65
    v_and_b32 v69, 511, v65
    s_mul_i32 s96, s13, 36864
    s_add_u32 s96, s96, 16384
    v_lshlrev_b32 v70, 4, v60
    v_add_u32 v70, s96, v70
    v_lshrrev_b32 v79, 1, v69
    s_lshl_b32 s96, s13, 8
    s_add_u32 s96, s96, 14336
    s_lshl_b32 s33, s13, 10
    s_add_u32 s97, s33, 8192
    v_mov_b32 v77, s97
    v_mov_b32 v78, s96
    v_cmp_lt_u32 vcc, 31, v60
    s_nop 1
    v_cndmask_b32 v71, v77, v78, vcc
    v_add_u32 v71, v71, v79
    v_and_b32 v77, 7, v61
    v_lshrrev_b32 v78, 3, v61
    v_lshlrev_b32 v74, 4, v77
    v_lshl_add_u32 v73, v62, 7, v74
    v_lshl_add_u32 v73, v78, 3, v73
    s_lshl_b32 s96, s13, 9
    v_add_u32 v73, s96, v73
    v_lshl_add_u32 v74, v78, 14, v74
    v_lshl_add_u32 v74, v62, 15, v74
    s_lshl_b32 s96, s13, 17
    v_add_u32 v74, s96, v74
    v_bfe_u32 v77, v61, 2, 1
    v_and_b32 v78, 3, v61
    v_bfe_u32 v79, v61, 1, 2
    s_cmp_lt_u32 s13, 2
    s_cselect_b64 vcc, -1, 0
    v_cndmask_b32 v77, 0, v77, vcc
    v_cndmask_b32 v78, v79, v78, vcc
    v_lshlrev_b32 v75, 7, v77
    v_lshl_add_u32 v75, v62, 4, v75
    v_lshl_add_u32 v75, v78, 2, v75
    v_lshl_add_u32 v58, v77, 3, v78
    v_lshlrev_b32 v79, 1, v78
    v_cndmask_b32 v58, v79, v58, vcc
    s_bfe_u32 s97, s12, 0x10001
    s_lshl_b32 s68, s97, 6
    s_lshl_b32 s97, s97, 2
    v_add_u32 v59, s97, v62
    s_bfe_u32 s96, s12, 0x10002
    s_and_b32 s40, s12, 1
    s_lshl_b32 s96, s96, 1
    s_add_u32 s96, s96, s40
    s_lshr_b32 s97, s12, 3
    s_lshl_b32 s98, s13, 2
    s_add_u32 s98, s98, s97
    s_lshl_b32 s98, s98, 2
    s_add_u32 s98, s98, s96
    s_lshl_b32 s98, s98, 8
    s_lshl_b32 s99, s13, 2
    s_add_u32 s99, s99, s96
    s_lshl_b32 s99, s99, 4
    s_lshl_b32 s41, s97, 1
    s_add_u32 s41, s41, s40
    s_lshl_b32 s41, s41, 7
    s_add_u32 s41, s41, 8192
    s_lshl_b32 s40, s40, 3
    s_add_u32 s40, s40, 128
    s_cmp_lt_u32 s13, 2
    s_cselect_b32 s98, s98, s41
    s_cselect_b32 s99, s99, s40
    s_cselect_b32 s32, 1, 0
    s_add_u32 s68, s68, s98
    s_mul_i32 s97, s97, 144
    s_add_u32 s99, s99, s97
    v_add_u32 v58, s99, v58
    s_and_b32 s97, s12, 4
    s_or_b32 s97, s97, s13
    s_cmp_eq_u32 s97, 2
    s_cselect_b32 s32, 2, s32
    s_mov_b32 s8, s48
    s_mov_b32 s9, s49
    s_mov_b32 s10, 9216
    s_cmp_lt_u32 s13, 2
    s_cselect_b32 s96, 8, 2
    v_mul_u32_u24 v77, 1152, v59
    v_lshl_add_u32 v77, v58, 1, v77
    buffer_load_ushort v72, v77, s[8:11], 0 offen
    buffer_load_ushort v76, v77, s[8:11], s96 offen
    s_mov_b32 s10, 4718592
    v_mov_b32 v78, v21
    v_mov_b32 v79, v22
    s_waitcnt vmcnt(12) lgkmcnt(0)
    s_barrier
    s_mov_b64 s[8:9], s[56:57]
    s_add_u32 m0, s43, 147456
    s_add_u32 m0, s43, 147200
    s_nop 0
    buffer_load_dwordx4 v19, s[8:11], s60 offen offset:256 lds
    s_add_u32 m0, s43, 148224
    s_nop 0
    buffer_load_dwordx4 v19, s[8:11], s61 offen offset:256 lds
    s_add_u32 m0, s43, 149248
    s_nop 0
    buffer_load_dwordx4 v19, s[8:11], s62 offen offset:256 lds
    s_add_u32 m0, s43, 150272
    s_nop 0
    buffer_load_dwordx4 v19, s[8:11], s63 offen offset:256 lds
    v_add_u32 v77, 0, v79
    ds_read_b64_tr_b16 v[80:81], v77 offset:0
    ds_read_b64_tr_b16 v[82:83], v77 offset:256
    ds_read_b64_tr_b16 v[84:85], v77 offset:2048
    ds_read_b64_tr_b16 v[86:87], v77 offset:2304
    ds_read_b64_tr_b16 v[112:113], v77 offset:8
    ds_read_b64_tr_b16 v[114:115], v77 offset:264
    ds_read_b64_tr_b16 v[116:117], v77 offset:2056
    ds_read_b64_tr_b16 v[118:119], v77 offset:2312
    s_waitcnt vmcnt(12) lgkmcnt(0)
    s_barrier
    s_mov_b64 s[8:9], s[52:53]
    s_add_u32 m0, s43, 0
    s_add_u32 s41, s58, 0
    buffer_load_dwordx4 v16, s[8:11], s41 offen offset:0 lds
    s_add_u32 s41, s58, 15360
    buffer_load_dwordx4 v16, s[8:11], s41 offen offset:1024 lds
    s_add_u32 s41, s58, 129024
    buffer_load_dwordx4 v16, s[8:11], s41 offen offset:2048 lds
    s_add_u32 s41, s58, 144384
    buffer_load_dwordx4 v16, s[8:11], s41 offen offset:3072 lds
    v_add_u32 v77, 36864, v78
    ds_read_b64_tr_b16 v[88:89], v77 offset:0
    ds_read_b64_tr_b16 v[90:91], v77 offset:256
    ds_read_b64_tr_b16 v[92:93], v77 offset:2048
    ds_read_b64_tr_b16 v[94:95], v77 offset:2304
    ds_read_b64_tr_b16 v[120:121], v77 offset:8
    ds_read_b64_tr_b16 v[122:123], v77 offset:264
    ds_read_b64_tr_b16 v[124:125], v77 offset:2056
    ds_read_b64_tr_b16 v[126:127], v77 offset:2312
    s_waitcnt vmcnt(12) lgkmcnt(0)
    s_barrier
    s_add_u32 m0, s43, 36864
    s_add_u32 s41, s58, 8192
    buffer_load_dwordx4 v16, s[8:11], s41 offen offset:0 lds
    s_add_u32 s41, s58, 23552
    buffer_load_dwordx4 v16, s[8:11], s41 offen offset:1024 lds
    s_add_u32 s41, s58, 137216
    buffer_load_dwordx4 v16, s[8:11], s41 offen offset:2048 lds
    s_add_u32 s41, s58, 152576
    buffer_load_dwordx4 v16, s[8:11], s41 offen offset:3072 lds
    v_add_u32 v77, 73728, v78
    ds_read_b64_tr_b16 v[96:97], v77 offset:0
    ds_read_b64_tr_b16 v[98:99], v77 offset:256
    ds_read_b64_tr_b16 v[100:101], v77 offset:2048
    ds_read_b64_tr_b16 v[102:103], v77 offset:2304
    ds_read_b64_tr_b16 v[128:129], v77 offset:8
    ds_read_b64_tr_b16 v[130:131], v77 offset:264
    ds_read_b64_tr_b16 v[132:133], v77 offset:2056
    ds_read_b64_tr_b16 v[134:135], v77 offset:2312
    s_waitcnt vmcnt(12) lgkmcnt(0)
    s_barrier
    s_add_u32 m0, s43, 73728
    s_add_u32 s41, s58, 262144
    buffer_load_dwordx4 v16, s[8:11], s41 offen offset:0 lds
    s_add_u32 s41, s58, 277504
    buffer_load_dwordx4 v16, s[8:11], s41 offen offset:1024 lds
    s_add_u32 s41, s58, 391168
    buffer_load_dwordx4 v16, s[8:11], s41 offen offset:2048 lds
    s_add_u32 s41, s58, 406528
    buffer_load_dwordx4 v16, s[8:11], s41 offen offset:3072 lds
    v_add_u32 v77, 110592, v78
    ds_read_b64_tr_b16 v[104:105], v77 offset:0
    ds_read_b64_tr_b16 v[106:107], v77 offset:256
    ds_read_b64_tr_b16 v[108:109], v77 offset:2048
    ds_read_b64_tr_b16 v[110:111], v77 offset:2304
    ds_read_b64_tr_b16 v[136:137], v77 offset:8
    ds_read_b64_tr_b16 v[138:139], v77 offset:264
    ds_read_b64_tr_b16 v[140:141], v77 offset:2056
    ds_read_b64_tr_b16 v[142:143], v77 offset:2312
    s_waitcnt vmcnt(12) lgkmcnt(0)
    s_barrier
    s_add_u32 m0, s43, 110592
    s_add_u32 s41, s58, 270336
    buffer_load_dwordx4 v16, s[8:11], s41 offen offset:0 lds
    s_add_u32 s41, s58, 285696
    buffer_load_dwordx4 v16, s[8:11], s41 offen offset:1024 lds
    s_add_u32 s41, s58, 399360
    buffer_load_dwordx4 v16, s[8:11], s41 offen offset:2048 lds
    s_add_u32 s41, s58, 414720
    buffer_load_dwordx4 v16, s[8:11], s41 offen offset:3072 lds
    v_add_u32 v77, 147456, v23
    ds_read_b64_tr_b16 v[144:145], v77 offset:0
    ds_read_b64_tr_b16 v[146:147], v77 offset:64
    ds_read_b64_tr_b16 v[148:149], v77 offset:512
    ds_read_b64_tr_b16 v[150:151], v77 offset:576
    ds_read_b64_tr_b16 v[152:153], v77 offset:2048
    ds_read_b64_tr_b16 v[154:155], v77 offset:2112
    ds_read_b64_tr_b16 v[156:157], v77 offset:2560
    ds_read_b64_tr_b16 v[158:159], v77 offset:2624
    s_waitcnt vmcnt(12) lgkmcnt(0)
    s_barrier
    s_add_u32 m0, s43, 147456
    s_add_u32 s41, s58, 524288
    buffer_load_dwordx4 v16, s[8:11], s41 offen offset:0 lds
    s_add_u32 s41, s58, 539648
    buffer_load_dwordx4 v16, s[8:11], s41 offen offset:1024 lds
    s_add_u32 s41, s58, 653312
    buffer_load_dwordx4 v16, s[8:11], s41 offen offset:2048 lds
    s_add_u32 s41, s58, 668672
    buffer_load_dwordx4 v16, s[8:11], s41 offen offset:3072 lds
    s_cmp_eq_u32 s32, 0
    s_cbranch_scc1 cf_init_done
    v_mov_b32 v52, 1
    v_mov_b32 v53, 1
    v_mov_b32 v54, 1
    v_mov_b32 v55, 1
    v_mov_b32 v56, 0
    v_lshl_or_b32 v72, v76, 16, v72
    s_lshl_b32 s96, s12, 14
    s_add_u32 s96, s96, 68157440
    s_add_u32 s97, s96, 0
    buffer_store_dwordx4 v[52:55], v65, s[4:7], s97 offen
    s_add_u32 s97, s96, 4096
    buffer_store_dwordx4 v[52:55], v65, s[4:7], s97 offen
    s_add_u32 s97, s96, 8192
    buffer_store_dwordx4 v[52:55], v65, s[4:7], s97 offen
    s_add_u32 s97, s96, 12288
    buffer_store_dwordx4 v[52:55], v65, s[4:7], s97 offen
    s_add_u32 s96, s68, 67108864
    s_add_u32 s97, s96, 16384
    buffer_store_dword v56, v75, s[4:7], s96 offen offset:0
    buffer_store_dword v72, v75, s[4:7], s97 offen offset:0
    s_cmp_lg_u32 s32, 2
    s_cbranch_scc1 cf_init_done
    buffer_store_dword v56, v75, s[4:7], s96 offen offset:1024
    buffer_store_dword v72, v75, s[4:7], s97 offen offset:1024
    buffer_store_dword v56, v75, s[4:7], s96 offen offset:2048
    buffer_store_dword v72, v75, s[4:7], s97 offen offset:2048
    buffer_store_dword v56, v75, s[4:7], s96 offen offset:3072
    buffer_store_dword v72, v75, s[4:7], s97 offen offset:3072
cf_init_done:
    v_add_u32 v28, 0, v24
    v_add_u32 v29, 0, v25
    v_add_u32 v30, 0, v26
    v_add_u32 v31, 0, v27
    ds_read_b64_tr_b16 a[96:97], v28 offset:0
    ds_read_b64_tr_b16 a[104:105], v28 offset:8
    ds_read_b64_tr_b16 a[112:113], v29 offset:0
    ds_read_b64_tr_b16 a[120:121], v29 offset:8
    ds_read_b64_tr_b16 a[128:129], v30 offset:0
    ds_read_b64_tr_b16 a[136:137], v30 offset:8
    ds_read_b64_tr_b16 a[144:145], v31 offset:0
    ds_read_b64_tr_b16 v[32:33], v31 offset:8
    s_waitcnt vmcnt(12) lgkmcnt(0)
    s_barrier
    s_add_u32 m0, s43, 0
    s_add_u32 s41, s58, 532480
    buffer_load_dwordx4 v16, s[8:11], s41 offen offset:0 lds
    s_add_u32 s41, s58, 547840
    buffer_load_dwordx4 v16, s[8:11], s41 offen offset:1024 lds
    s_add_u32 s41, s58, 661504
    buffer_load_dwordx4 v16, s[8:11], s41 offen offset:2048 lds
    s_add_u32 s41, s58, 676864
    buffer_load_dwordx4 v16, s[8:11], s41 offen offset:3072 lds
    ds_write_b64 v70, v[32:33] offset:12288
    v_add_u32 v28, 36864, v24
    v_add_u32 v29, 36864, v25
    v_add_u32 v30, 36864, v26
    v_add_u32 v31, 36864, v27
    ds_read_b64_tr_b16 a[98:99], v28 offset:0
    ds_read_b64_tr_b16 a[106:107], v28 offset:8
    ds_read_b64_tr_b16 a[114:115], v29 offset:0
    ds_read_b64_tr_b16 a[122:123], v29 offset:8
    ds_read_b64_tr_b16 a[130:131], v30 offset:0
    ds_read_b64_tr_b16 a[138:139], v30 offset:8
    ds_read_b64_tr_b16 a[146:147], v31 offset:0
    ds_read_b64_tr_b16 v[0:1], v31 offset:8
    s_waitcnt vmcnt(12) lgkmcnt(0)
    s_barrier
    s_add_u32 m0, s43, 36864
    s_add_u32 s41, s58, 786432
    buffer_load_dwordx4 v16, s[8:11], s41 offen offset:0 lds
    s_add_u32 s41, s58, 801792
    buffer_load_dwordx4 v16, s[8:11], s41 offen offset:1024 lds
    s_add_u32 s41, s58, 915456
    buffer_load_dwordx4 v16, s[8:11], s41 offen offset:2048 lds
    s_add_u32 s41, s58, 930816
    buffer_load_dwordx4 v16, s[8:11], s41 offen offset:3072 lds
    ds_write_b64 v70, v[0:1] offset:12296
    v_add_u32 v28, 73728, v24
    v_add_u32 v29, 73728, v25
    v_add_u32 v30, 73728, v26
    v_add_u32 v31, 73728, v27
    ds_read_b64_tr_b16 a[100:101], v28 offset:0
    ds_read_b64_tr_b16 a[108:109], v28 offset:8
    ds_read_b64_tr_b16 a[116:117], v29 offset:0
    ds_read_b64_tr_b16 a[124:125], v29 offset:8
    ds_read_b64_tr_b16 a[132:133], v30 offset:0
    ds_read_b64_tr_b16 a[140:141], v30 offset:8
    ds_read_b64_tr_b16 a[148:149], v31 offset:0
    ds_read_b64_tr_b16 v[32:33], v31 offset:8
    s_waitcnt vmcnt(12) lgkmcnt(0)
    s_barrier
    s_add_u32 m0, s43, 73728
    s_add_u32 s41, s58, 794624
    buffer_load_dwordx4 v16, s[8:11], s41 offen offset:0 lds
    s_add_u32 s41, s58, 809984
    buffer_load_dwordx4 v16, s[8:11], s41 offen offset:1024 lds
    s_add_u32 s41, s58, 923648
    buffer_load_dwordx4 v16, s[8:11], s41 offen offset:2048 lds
    s_add_u32 s41, s58, 939008
    buffer_load_dwordx4 v16, s[8:11], s41 offen offset:3072 lds
    ds_write_b64 v70, v[32:33] offset:13312
    v_add_u32 v28, 110592, v24
    v_add_u32 v29, 110592, v25
    v_add_u32 v30, 110592, v26
    v_add_u32 v31, 110592, v27
    ds_read_b64_tr_b16 a[102:103], v28 offset:0
    ds_read_b64_tr_b16 a[110:111], v28 offset:8
    ds_read_b64_tr_b16 a[118:119], v29 offset:0
    ds_read_b64_tr_b16 a[126:127], v29 offset:8
    ds_read_b64_tr_b16 a[134:135], v30 offset:0
    ds_read_b64_tr_b16 a[142:143], v30 offset:8
    ds_read_b64_tr_b16 a[150:151], v31 offset:0
    ds_read_b64_tr_b16 v[0:1], v31 offset:8
    s_waitcnt vmcnt(12) lgkmcnt(0)
    s_barrier
    s_add_u32 m0, s43, 110592
    s_add_u32 s41, s59, 0
    buffer_load_dwordx4 v17, s[8:11], s41 offen offset:0 lds
    s_add_u32 s41, s59, 31744
    buffer_load_dwordx4 v17, s[8:11], s41 offen offset:1024 lds
    s_add_u32 s41, s59, 1177600
    buffer_load_dwordx4 v17, s[8:11], s41 offen offset:2048 lds
    s_add_u32 s41, s59, 1209344
    buffer_load_dwordx4 v17, s[8:11], s41 offen offset:3072 lds
    ds_write_b64 v70, v[0:1] offset:13320
    v_add_u32 v28, 147456, v24
    v_add_u32 v29, 147456, v25
    v_add_u32 v30, 147456, v26
    v_add_u32 v31, 147456, v27
    ds_read_b64_tr_b16 a[152:153], v28 offset:0
    ds_read_b64_tr_b16 a[160:161], v28 offset:8
    ds_read_b64_tr_b16 v[32:33], v29 offset:0
    ds_read_b64_tr_b16 a[168:169], v29 offset:8
    ds_read_b64_tr_b16 a[176:177], v30 offset:0
    ds_read_b64_tr_b16 a[184:185], v30 offset:8
    ds_read_b64_tr_b16 v[34:35], v31 offset:0
    ds_read_b64_tr_b16 a[192:193], v31 offset:8
    s_waitcnt vmcnt(12) lgkmcnt(0)
    s_barrier
    s_mov_b64 s[8:9], s[50:51]
    s_add_u32 m0, s43, 147456
    s_add_u32 s41, s58, 0
    buffer_load_dwordx4 v16, s[8:11], s41 offen offset:0 lds
    s_add_u32 s41, s58, 15360
    buffer_load_dwordx4 v16, s[8:11], s41 offen offset:1024 lds
    s_add_u32 s41, s58, 129024
    buffer_load_dwordx4 v16, s[8:11], s41 offen offset:2048 lds
    s_add_u32 s41, s58, 144384
    buffer_load_dwordx4 v16, s[8:11], s41 offen offset:3072 lds
    ds_write_b64 v70, v[32:33] offset:16384
    ds_write_b64 v70, v[34:35] offset:18432
    v_add_u32 v28, 0, v24
    v_add_u32 v29, 0, v25
    v_add_u32 v30, 0, v26
    v_add_u32 v31, 0, v27
    ds_read_b64_tr_b16 a[154:155], v28 offset:0
    ds_read_b64_tr_b16 a[162:163], v28 offset:8
    ds_read_b64_tr_b16 v[0:1], v29 offset:0
    ds_read_b64_tr_b16 a[170:171], v29 offset:8
    ds_read_b64_tr_b16 a[178:179], v30 offset:0
    ds_read_b64_tr_b16 a[186:187], v30 offset:8
    ds_read_b64_tr_b16 v[2:3], v31 offset:0
    ds_read_b64_tr_b16 a[194:195], v31 offset:8
    s_waitcnt vmcnt(12) lgkmcnt(0)
    s_barrier
    s_add_u32 m0, s43, 0
    s_add_u32 s41, s58, 8192
    buffer_load_dwordx4 v16, s[8:11], s41 offen offset:0 lds
    s_add_u32 s41, s58, 23552
    buffer_load_dwordx4 v16, s[8:11], s41 offen offset:1024 lds
    s_add_u32 s41, s58, 137216
    buffer_load_dwordx4 v16, s[8:11], s41 offen offset:2048 lds
    s_add_u32 s41, s58, 152576
    buffer_load_dwordx4 v16, s[8:11], s41 offen offset:3072 lds
    ds_write_b64 v70, v[0:1] offset:16392
    ds_write_b64 v70, v[2:3] offset:18440
    v_add_u32 v28, 36864, v24
    v_add_u32 v29, 36864, v25
    v_add_u32 v30, 36864, v26
    v_add_u32 v31, 36864, v27
    ds_read_b64_tr_b16 a[156:157], v28 offset:0
    ds_read_b64_tr_b16 a[164:165], v28 offset:8
    ds_read_b64_tr_b16 v[32:33], v29 offset:0
    ds_read_b64_tr_b16 a[172:173], v29 offset:8
    ds_read_b64_tr_b16 a[180:181], v30 offset:0
    ds_read_b64_tr_b16 a[188:189], v30 offset:8
    ds_read_b64_tr_b16 v[34:35], v31 offset:0
    ds_read_b64_tr_b16 a[196:197], v31 offset:8
    s_waitcnt vmcnt(12) lgkmcnt(0)
    s_barrier
    s_add_u32 m0, s43, 36864
    s_add_u32 s41, s58, 262144
    buffer_load_dwordx4 v16, s[8:11], s41 offen offset:0 lds
    s_add_u32 s41, s58, 277504
    buffer_load_dwordx4 v16, s[8:11], s41 offen offset:1024 lds
    s_add_u32 s41, s58, 391168
    buffer_load_dwordx4 v16, s[8:11], s41 offen offset:2048 lds
    s_add_u32 s41, s58, 406528
    buffer_load_dwordx4 v16, s[8:11], s41 offen offset:3072 lds
    ds_write_b64 v70, v[32:33] offset:17408
    ds_write_b64 v70, v[34:35] offset:19456
    v_add_u32 v28, 73728, v24
    v_add_u32 v29, 73728, v25
    v_add_u32 v30, 73728, v26
    v_add_u32 v31, 73728, v27
    ds_read_b64_tr_b16 a[158:159], v28 offset:0
    ds_read_b64_tr_b16 a[166:167], v28 offset:8
    ds_read_b64_tr_b16 v[0:1], v29 offset:0
    ds_read_b64_tr_b16 a[174:175], v29 offset:8
    ds_read_b64_tr_b16 a[182:183], v30 offset:0
    ds_read_b64_tr_b16 a[190:191], v30 offset:8
    ds_read_b64_tr_b16 v[2:3], v31 offset:0
    ds_read_b64_tr_b16 a[198:199], v31 offset:8
    s_waitcnt vmcnt(12) lgkmcnt(0)
    s_barrier
    s_add_u32 m0, s43, 73728
    s_add_u32 s41, s58, 270336
    buffer_load_dwordx4 v16, s[8:11], s41 offen offset:0 lds
    s_add_u32 s41, s58, 285696
    buffer_load_dwordx4 v16, s[8:11], s41 offen offset:1024 lds
    s_add_u32 s41, s58, 399360
    buffer_load_dwordx4 v16, s[8:11], s41 offen offset:2048 lds
    s_add_u32 s41, s58, 414720
    buffer_load_dwordx4 v16, s[8:11], s41 offen offset:3072 lds
    ds_write_b64 v70, v[0:1] offset:17416
    ds_write_b64 v70, v[2:3] offset:19464
    v_add_u32 v77, 110592, v20
    ds_read_b64_tr_b16 a[200:201], v77 offset:0
    ds_read_b64_tr_b16 a[202:203], v77 offset:4096
    ds_read_b64_tr_b16 a[204:205], v77 offset:8192
    ds_read_b64_tr_b16 a[206:207], v77 offset:12288
    ds_read_b64_tr_b16 a[208:209], v77 offset:8
    ds_read_b64_tr_b16 a[210:211], v77 offset:4104
    ds_read_b64_tr_b16 a[212:213], v77 offset:8200
    ds_read_b64_tr_b16 a[214:215], v77 offset:12296
    s_waitcnt vmcnt(12) lgkmcnt(0)
    s_barrier
    s_add_u32 m0, s43, 110592
    s_add_u32 s41, s58, 524288
    buffer_load_dwordx4 v16, s[8:11], s41 offen offset:0 lds
    s_add_u32 s41, s58, 539648
    buffer_load_dwordx4 v16, s[8:11], s41 offen offset:1024 lds
    s_add_u32 s41, s58, 653312
    buffer_load_dwordx4 v16, s[8:11], s41 offen offset:2048 lds
    s_add_u32 s41, s58, 668672
    buffer_load_dwordx4 v16, s[8:11], s41 offen offset:3072 lds
    v_add_u32 v28, 147456, v24
    v_add_u32 v29, 147456, v25
    v_add_u32 v30, 147456, v26
    v_add_u32 v31, 147456, v27
    ds_read_b64_tr_b16 v[0:1], v28 offset:0
    ds_read_b64_tr_b16 v[2:3], v28 offset:8
    ds_read_b64_tr_b16 v[4:5], v29 offset:0
    ds_read_b64_tr_b16 v[6:7], v29 offset:8
    ds_read_b64_tr_b16 a[0:1], v30 offset:0
    ds_read_b64_tr_b16 v[8:9], v30 offset:8
    ds_read_b64_tr_b16 a[8:9], v31 offset:0
    ds_read_b64_tr_b16 v[10:11], v31 offset:8
    s_waitcnt vmcnt(12) lgkmcnt(0)
    s_barrier
    s_add_u32 m0, s43, 147456
    s_add_u32 s41, s58, 532480
    buffer_load_dwordx4 v16, s[8:11], s41 offen offset:0 lds
    s_add_u32 s41, s58, 547840
    buffer_load_dwordx4 v16, s[8:11], s41 offen offset:1024 lds
    s_add_u32 s41, s58, 661504
    buffer_load_dwordx4 v16, s[8:11], s41 offen offset:2048 lds
    s_add_u32 s41, s58, 676864
    buffer_load_dwordx4 v16, s[8:11], s41 offen offset:3072 lds
    ds_write_b64 v70, v[0:1] offset:0
    ds_write_b64 v70, v[2:3] offset:2048
    ds_write_b64 v70, v[4:5] offset:4096
    ds_write_b64 v70, v[6:7] offset:6144
    ds_write_b64 v70, v[8:9] offset:10240
    ds_write_b64 v70, v[10:11] offset:14336
    v_add_u32 v28, 0, v24
    v_add_u32 v29, 0, v25
    v_add_u32 v30, 0, v26
    v_add_u32 v31, 0, v27
    ds_read_b64_tr_b16 v[32:33], v28 offset:0
    ds_read_b64_tr_b16 v[34:35], v28 offset:8
    ds_read_b64_tr_b16 v[36:37], v29 offset:0
    ds_read_b64_tr_b16 v[38:39], v29 offset:8
    ds_read_b64_tr_b16 a[2:3], v30 offset:0
    ds_read_b64_tr_b16 v[40:41], v30 offset:8
    ds_read_b64_tr_b16 a[10:11], v31 offset:0
    ds_read_b64_tr_b16 v[42:43], v31 offset:8
    s_waitcnt vmcnt(12) lgkmcnt(0)
    s_barrier
    s_add_u32 m0, s43, 0
    s_add_u32 s41, s58, 786432
    buffer_load_dwordx4 v16, s[8:11], s41 offen offset:0 lds
    s_add_u32 s41, s58, 801792
    buffer_load_dwordx4 v16, s[8:11], s41 offen offset:1024 lds
    s_add_u32 s41, s58, 915456
    buffer_load_dwordx4 v16, s[8:11], s41 offen offset:2048 lds
    s_add_u32 s41, s58, 930816
    buffer_load_dwordx4 v16, s[8:11], s41 offen offset:3072 lds
    ds_write_b64 v70, v[32:33] offset:8
    ds_write_b64 v70, v[34:35] offset:2056
    ds_write_b64 v70, v[36:37] offset:4104
    ds_write_b64 v70, v[38:39] offset:6152
    ds_write_b64 v70, v[40:41] offset:10248
    ds_write_b64 v70, v[42:43] offset:14344
    v_add_u32 v28, 36864, v24
    v_add_u32 v29, 36864, v25
    v_add_u32 v30, 36864, v26
    v_add_u32 v31, 36864, v27
    ds_read_b64_tr_b16 v[0:1], v28 offset:0
    ds_read_b64_tr_b16 v[2:3], v28 offset:8
    ds_read_b64_tr_b16 v[4:5], v29 offset:0
    ds_read_b64_tr_b16 v[6:7], v29 offset:8
    ds_read_b64_tr_b16 a[4:5], v30 offset:0
    ds_read_b64_tr_b16 v[8:9], v30 offset:8
    ds_read_b64_tr_b16 a[12:13], v31 offset:0
    ds_read_b64_tr_b16 v[10:11], v31 offset:8
    s_waitcnt vmcnt(12) lgkmcnt(0)
    s_barrier
    s_add_u32 m0, s43, 36864
    s_add_u32 s41, s58, 794624
    buffer_load_dwordx4 v16, s[8:11], s41 offen offset:0 lds
    s_add_u32 s41, s58, 809984
    buffer_load_dwordx4 v16, s[8:11], s41 offen offset:1024 lds
    s_add_u32 s41, s58, 923648
    buffer_load_dwordx4 v16, s[8:11], s41 offen offset:2048 lds
    s_add_u32 s41, s58, 939008
    buffer_load_dwordx4 v16, s[8:11], s41 offen offset:3072 lds
    ds_write_b64 v70, v[0:1] offset:1024
    ds_write_b64 v70, v[2:3] offset:3072
    ds_write_b64 v70, v[4:5] offset:5120
    ds_write_b64 v70, v[6:7] offset:7168
    ds_write_b64 v70, v[8:9] offset:11264
    ds_write_b64 v70, v[10:11] offset:15360
    v_add_u32 v28, 73728, v24
    v_add_u32 v29, 73728, v25
    v_add_u32 v30, 73728, v26
    v_add_u32 v31, 73728, v27
    ds_read_b64_tr_b16 v[32:33], v28 offset:0
    ds_read_b64_tr_b16 v[34:35], v28 offset:8
    ds_read_b64_tr_b16 v[36:37], v29 offset:0
    ds_read_b64_tr_b16 v[38:39], v29 offset:8
    ds_read_b64_tr_b16 a[6:7], v30 offset:0
    ds_read_b64_tr_b16 v[40:41], v30 offset:8
    ds_read_b64_tr_b16 a[14:15], v31 offset:0
    ds_read_b64_tr_b16 v[42:43], v31 offset:8
    s_waitcnt vmcnt(12) lgkmcnt(0)
    s_barrier
    s_add_u32 m0, s43, 73728
    s_add_u32 s41, s59, 0
    buffer_load_dwordx4 v17, s[8:11], s41 offen offset:0 lds
    s_add_u32 s41, s59, 31744
    buffer_load_dwordx4 v17, s[8:11], s41 offen offset:1024 lds
    s_add_u32 s41, s59, 1177600
    buffer_load_dwordx4 v17, s[8:11], s41 offen offset:2048 lds
    s_add_u32 s41, s59, 1209344
    buffer_load_dwordx4 v17, s[8:11], s41 offen offset:3072 lds
    ds_write_b64 v70, v[32:33] offset:1032
    ds_write_b64 v70, v[34:35] offset:3080
    ds_write_b64 v70, v[36:37] offset:5128
    ds_write_b64 v70, v[38:39] offset:7176
    ds_write_b64 v70, v[40:41] offset:11272
    ds_write_b64 v70, v[42:43] offset:15368
    v_add_u32 v28, 110592, v24
    v_add_u32 v29, 110592, v25
    v_add_u32 v30, 110592, v26
    v_add_u32 v31, 110592, v27
    ds_read_b64_tr_b16 a[16:17], v28 offset:0
    ds_read_b64_tr_b16 a[24:25], v28 offset:8
    ds_read_b64_tr_b16 a[32:33], v29 offset:0
    ds_read_b64_tr_b16 a[40:41], v29 offset:8
    ds_read_b64_tr_b16 a[48:49], v30 offset:0
    ds_read_b64_tr_b16 a[56:57], v30 offset:8
    ds_read_b64_tr_b16 a[64:65], v31 offset:0
    ds_read_b64_tr_b16 a[72:73], v31 offset:8
    s_waitcnt vmcnt(12) lgkmcnt(0)
    s_barrier
    s_mov_b64 s[8:9], s[54:55]
    s_add_u32 m0, s43, 110592
    s_add_u32 s41, s58, 0
    buffer_load_dwordx4 v16, s[8:11], s41 offen offset:0 lds
    s_add_u32 s41, s58, 15360
    buffer_load_dwordx4 v16, s[8:11], s41 offen offset:1024 lds
    s_add_u32 s41, s58, 129024
    buffer_load_dwordx4 v16, s[8:11], s41 offen offset:2048 lds
    s_add_u32 s41, s58, 144384
    buffer_load_dwordx4 v16, s[8:11], s41 offen offset:3072 lds
    v_add_u32 v28, 147456, v24
    v_add_u32 v29, 147456, v25
    v_add_u32 v30, 147456, v26
    v_add_u32 v31, 147456, v27
    ds_read_b64_tr_b16 a[18:19], v28 offset:0
    ds_read_b64_tr_b16 a[26:27], v28 offset:8
    ds_read_b64_tr_b16 a[34:35], v29 offset:0
    ds_read_b64_tr_b16 a[42:43], v29 offset:8
    ds_read_b64_tr_b16 a[50:51], v30 offset:0
    ds_read_b64_tr_b16 a[58:59], v30 offset:8
    ds_read_b64_tr_b16 a[66:67], v31 offset:0
    ds_read_b64_tr_b16 a[74:75], v31 offset:8
    s_waitcnt vmcnt(12) lgkmcnt(0)
    s_barrier
    s_add_u32 m0, s43, 147456
    s_add_u32 s41, s58, 8192
    buffer_load_dwordx4 v16, s[8:11], s41 offen offset:0 lds
    s_add_u32 s41, s58, 23552
    buffer_load_dwordx4 v16, s[8:11], s41 offen offset:1024 lds
    s_add_u32 s41, s58, 137216
    buffer_load_dwordx4 v16, s[8:11], s41 offen offset:2048 lds
    s_add_u32 s41, s58, 152576
    buffer_load_dwordx4 v16, s[8:11], s41 offen offset:3072 lds
    v_add_u32 v28, 0, v24
    v_add_u32 v29, 0, v25
    v_add_u32 v30, 0, v26
    v_add_u32 v31, 0, v27
    ds_read_b64_tr_b16 a[20:21], v28 offset:0
    ds_read_b64_tr_b16 a[28:29], v28 offset:8
    ds_read_b64_tr_b16 a[36:37], v29 offset:0
    ds_read_b64_tr_b16 a[44:45], v29 offset:8
    ds_read_b64_tr_b16 a[52:53], v30 offset:0
    ds_read_b64_tr_b16 a[60:61], v30 offset:8
    ds_read_b64_tr_b16 a[68:69], v31 offset:0
    ds_read_b64_tr_b16 a[76:77], v31 offset:8
    s_waitcnt vmcnt(12) lgkmcnt(0)
    s_barrier
    s_add_u32 m0, s43, 0
    s_add_u32 s41, s58, 262144
    buffer_load_dwordx4 v16, s[8:11], s41 offen offset:0 lds
    s_add_u32 s41, s58, 277504
    buffer_load_dwordx4 v16, s[8:11], s41 offen offset:1024 lds
    s_add_u32 s41, s58, 391168
    buffer_load_dwordx4 v16, s[8:11], s41 offen offset:2048 lds
    s_add_u32 s41, s58, 406528
    buffer_load_dwordx4 v16, s[8:11], s41 offen offset:3072 lds
    v_add_u32 v28, 36864, v24
    v_add_u32 v29, 36864, v25
    v_add_u32 v30, 36864, v26
    v_add_u32 v31, 36864, v27
    ds_read_b64_tr_b16 a[22:23], v28 offset:0
    ds_read_b64_tr_b16 a[30:31], v28 offset:8
    ds_read_b64_tr_b16 a[38:39], v29 offset:0
    ds_read_b64_tr_b16 a[46:47], v29 offset:8
    ds_read_b64_tr_b16 a[54:55], v30 offset:0
    ds_read_b64_tr_b16 a[62:63], v30 offset:8
    ds_read_b64_tr_b16 a[70:71], v31 offset:0
    ds_read_b64_tr_b16 a[78:79], v31 offset:8
    s_waitcnt vmcnt(12) lgkmcnt(0)
    s_barrier
    s_add_u32 m0, s43, 36864
    s_add_u32 s41, s58, 270336
    buffer_load_dwordx4 v16, s[8:11], s41 offen offset:0 lds
    s_add_u32 s41, s58, 285696
    buffer_load_dwordx4 v16, s[8:11], s41 offen offset:1024 lds
    s_add_u32 s41, s58, 399360
    buffer_load_dwordx4 v16, s[8:11], s41 offen offset:2048 lds
    s_add_u32 s41, s58, 414720
    buffer_load_dwordx4 v16, s[8:11], s41 offen offset:3072 lds
    v_add_u32 v77, 73728, v20
    ds_read_b64_tr_b16 a[80:81], v77 offset:0
    ds_read_b64_tr_b16 a[82:83], v77 offset:4096
    ds_read_b64_tr_b16 a[84:85], v77 offset:8192
    ds_read_b64_tr_b16 a[86:87], v77 offset:12288
    ds_read_b64_tr_b16 a[88:89], v77 offset:8
    ds_read_b64_tr_b16 a[90:91], v77 offset:4104
    ds_read_b64_tr_b16 a[92:93], v77 offset:8200
    ds_read_b64_tr_b16 a[94:95], v77 offset:12296
    s_waitcnt vmcnt(12) lgkmcnt(0)
    s_barrier
    s_add_u32 m0, s43, 73728
    s_add_u32 s41, s58, 524288
    buffer_load_dwordx4 v16, s[8:11], s41 offen offset:0 lds
    s_add_u32 s41, s58, 539648
    buffer_load_dwordx4 v16, s[8:11], s41 offen offset:1024 lds
    s_add_u32 s41, s58, 653312
    buffer_load_dwordx4 v16, s[8:11], s41 offen offset:2048 lds
    s_add_u32 s41, s58, 668672
    buffer_load_dwordx4 v16, s[8:11], s41 offen offset:3072 lds
    v_add_u32 v28, 110592, v24
    v_add_u32 v29, 110592, v25
    v_add_u32 v30, 110592, v26
    v_add_u32 v31, 110592, v27
    ds_read_b64_tr_b16 a[216:217], v28 offset:0
    ds_read_b64_tr_b16 v[32:33], v28 offset:8
    ds_read_b64_tr_b16 a[224:225], v29 offset:0
    ds_read_b64_tr_b16 a[232:233], v29 offset:8
    ds_read_b64_tr_b16 a[240:241], v30 offset:0
    ds_read_b64_tr_b16 a[248:249], v30 offset:8
    ds_read_b64_tr_b16 v[160:161], v31 offset:0
    ds_read_b64_tr_b16 v[168:169], v31 offset:8
    s_waitcnt vmcnt(12) lgkmcnt(0)
    s_barrier
    s_add_u32 m0, s43, 110592
    s_add_u32 s41, s58, 532480
    buffer_load_dwordx4 v16, s[8:11], s41 offen offset:0 lds
    s_add_u32 s41, s58, 547840
    buffer_load_dwordx4 v16, s[8:11], s41 offen offset:1024 lds
    s_add_u32 s41, s58, 661504
    buffer_load_dwordx4 v16, s[8:11], s41 offen offset:2048 lds
    s_add_u32 s41, s58, 676864
    buffer_load_dwordx4 v16, s[8:11], s41 offen offset:3072 lds
    ds_write_b64 v70, v[32:33] offset:8192
    v_add_u32 v28, 147456, v24
    v_add_u32 v29, 147456, v25
    v_add_u32 v30, 147456, v26
    v_add_u32 v31, 147456, v27
    ds_read_b64_tr_b16 a[218:219], v28 offset:0
    ds_read_b64_tr_b16 v[0:1], v28 offset:8
    ds_read_b64_tr_b16 a[226:227], v29 offset:0
    ds_read_b64_tr_b16 a[234:235], v29 offset:8
    ds_read_b64_tr_b16 a[242:243], v30 offset:0
    ds_read_b64_tr_b16 a[250:251], v30 offset:8
    ds_read_b64_tr_b16 v[162:163], v31 offset:0
    ds_read_b64_tr_b16 v[170:171], v31 offset:8
    s_waitcnt vmcnt(12) lgkmcnt(0)
    s_barrier
    s_add_u32 m0, s43, 147456
    s_add_u32 s41, s58, 786432
    buffer_load_dwordx4 v16, s[8:11], s41 offen offset:0 lds
    s_add_u32 s41, s58, 801792
    buffer_load_dwordx4 v16, s[8:11], s41 offen offset:1024 lds
    s_add_u32 s41, s58, 915456
    buffer_load_dwordx4 v16, s[8:11], s41 offen offset:2048 lds
    s_add_u32 s41, s58, 930816
    buffer_load_dwordx4 v16, s[8:11], s41 offen offset:3072 lds
    ds_write_b64 v70, v[0:1] offset:8200
    v_add_u32 v28, 0, v24
    v_add_u32 v29, 0, v25
    v_add_u32 v30, 0, v26
    v_add_u32 v31, 0, v27
    ds_read_b64_tr_b16 a[220:221], v28 offset:0
    ds_read_b64_tr_b16 v[32:33], v28 offset:8
    ds_read_b64_tr_b16 a[228:229], v29 offset:0
    ds_read_b64_tr_b16 a[236:237], v29 offset:8
    ds_read_b64_tr_b16 a[244:245], v30 offset:0
    ds_read_b64_tr_b16 a[252:253], v30 offset:8
    ds_read_b64_tr_b16 v[164:165], v31 offset:0
    ds_read_b64_tr_b16 v[172:173], v31 offset:8
    s_waitcnt vmcnt(12) lgkmcnt(0)
    s_barrier
    s_add_u32 m0, s43, 0
    s_add_u32 s41, s58, 794624
    buffer_load_dwordx4 v16, s[8:11], s41 offen offset:0 lds
    s_add_u32 s41, s58, 809984
    buffer_load_dwordx4 v16, s[8:11], s41 offen offset:1024 lds
    s_add_u32 s41, s58, 923648
    buffer_load_dwordx4 v16, s[8:11], s41 offen offset:2048 lds
    s_add_u32 s41, s58, 939008
    buffer_load_dwordx4 v16, s[8:11], s41 offen offset:3072 lds
    ds_write_b64 v70, v[32:33] offset:9216
    v_add_u32 v28, 36864, v24
    v_add_u32 v29, 36864, v25
    v_add_u32 v30, 36864, v26
    v_add_u32 v31, 36864, v27
    ds_read_b64_tr_b16 a[222:223], v28 offset:0
    ds_read_b64_tr_b16 v[0:1], v28 offset:8
    ds_read_b64_tr_b16 a[230:231], v29 offset:0
    ds_read_b64_tr_b16 a[238:239], v29 offset:8
    ds_read_b64_tr_b16 a[246:247], v30 offset:0
    ds_read_b64_tr_b16 a[254:255], v30 offset:8
    ds_read_b64_tr_b16 v[166:167], v31 offset:0
    ds_read_b64_tr_b16 v[174:175], v31 offset:8
    s_waitcnt vmcnt(12) lgkmcnt(0)
    s_barrier
    s_add_u32 m0, s43, 36864
    s_add_u32 s41, s59, 0
    buffer_load_dwordx4 v17, s[8:11], s41 offen offset:0 lds
    s_add_u32 s41, s59, 31744
    buffer_load_dwordx4 v17, s[8:11], s41 offen offset:1024 lds
    s_add_u32 s41, s59, 1177600
    buffer_load_dwordx4 v17, s[8:11], s41 offen offset:2048 lds
    s_add_u32 s41, s59, 1209344
    buffer_load_dwordx4 v17, s[8:11], s41 offen offset:3072 lds
    ds_write_b64 v70, v[0:1] offset:9224
    v_add_u32 v28, 73728, v24
    v_add_u32 v29, 73728, v25
    v_add_u32 v30, 73728, v26
    v_add_u32 v31, 73728, v27
    ds_read_b64_tr_b16 v[176:177], v28 offset:0
    ds_read_b64_tr_b16 v[184:185], v28 offset:8
    ds_read_b64_tr_b16 v[192:193], v29 offset:0
    ds_read_b64_tr_b16 v[200:201], v29 offset:8
    ds_read_b64_tr_b16 v[208:209], v30 offset:0
    ds_read_b64_tr_b16 v[216:217], v30 offset:8
    ds_read_b64_tr_b16 v[224:225], v31 offset:0
    ds_read_b64_tr_b16 v[232:233], v31 offset:8
    s_waitcnt vmcnt(12) lgkmcnt(0)
    s_barrier
    s_mov_b64 s[8:9], s[56:57]
    s_add_u32 m0, s43, 73728
    s_add_u32 s41, s60, 128
    buffer_load_dwordx4 v18, s[8:11], s41 offen offset:0 lds
    s_add_u32 s41, s60, 8320
    buffer_load_dwordx4 v18, s[8:11], s41 offen offset:1024 lds
    s_add_u32 s41, s60, 16512
    buffer_load_dwordx4 v18, s[8:11], s41 offen offset:2048 lds
    s_add_u32 s41, s60, 24704
    buffer_load_dwordx4 v18, s[8:11], s41 offen offset:3072 lds
    v_add_u32 v28, 110592, v24
    v_add_u32 v29, 110592, v25
    v_add_u32 v30, 110592, v26
    v_add_u32 v31, 110592, v27
    ds_read_b64_tr_b16 v[178:179], v28 offset:0
    ds_read_b64_tr_b16 v[186:187], v28 offset:8
    ds_read_b64_tr_b16 v[194:195], v29 offset:0
    ds_read_b64_tr_b16 v[202:203], v29 offset:8
    ds_read_b64_tr_b16 v[210:211], v30 offset:0
    ds_read_b64_tr_b16 v[218:219], v30 offset:8
    ds_read_b64_tr_b16 v[226:227], v31 offset:0
    ds_read_b64_tr_b16 v[234:235], v31 offset:8
    s_waitcnt vmcnt(12) lgkmcnt(0)
    s_barrier
    s_add_u32 m0, s43, 110592
    s_add_u32 s41, s61, 128
    buffer_load_dwordx4 v18, s[8:11], s41 offen offset:0 lds
    s_add_u32 s41, s61, 8320
    buffer_load_dwordx4 v18, s[8:11], s41 offen offset:1024 lds
    s_add_u32 s41, s61, 16512
    buffer_load_dwordx4 v18, s[8:11], s41 offen offset:2048 lds
    s_add_u32 s41, s61, 24704
    buffer_load_dwordx4 v18, s[8:11], s41 offen offset:3072 lds
    v_add_u32 v28, 147456, v24
    v_add_u32 v29, 147456, v25
    v_add_u32 v30, 147456, v26
    v_add_u32 v31, 147456, v27
    ds_read_b64_tr_b16 v[180:181], v28 offset:0
    ds_read_b64_tr_b16 v[188:189], v28 offset:8
    ds_read_b64_tr_b16 v[196:197], v29 offset:0
    ds_read_b64_tr_b16 v[204:205], v29 offset:8
    ds_read_b64_tr_b16 v[212:213], v30 offset:0
    ds_read_b64_tr_b16 v[220:221], v30 offset:8
    ds_read_b64_tr_b16 v[228:229], v31 offset:0
    ds_read_b64_tr_b16 v[236:237], v31 offset:8
    s_waitcnt vmcnt(12) lgkmcnt(0)
    s_barrier
    s_add_u32 m0, s43, 147456
    s_add_u32 s41, s62, 128
    buffer_load_dwordx4 v18, s[8:11], s41 offen offset:0 lds
    s_add_u32 s41, s62, 8320
    buffer_load_dwordx4 v18, s[8:11], s41 offen offset:1024 lds
    s_add_u32 s41, s62, 16512
    buffer_load_dwordx4 v18, s[8:11], s41 offen offset:2048 lds
    s_add_u32 s41, s62, 24704
    buffer_load_dwordx4 v18, s[8:11], s41 offen offset:3072 lds
    v_add_u32 v28, 0, v24
    v_add_u32 v29, 0, v25
    v_add_u32 v30, 0, v26
    v_add_u32 v31, 0, v27
    ds_read_b64_tr_b16 v[182:183], v28 offset:0
    ds_read_b64_tr_b16 v[190:191], v28 offset:8
    ds_read_b64_tr_b16 v[198:199], v29 offset:0
    ds_read_b64_tr_b16 v[206:207], v29 offset:8
    ds_read_b64_tr_b16 v[214:215], v30 offset:0
    ds_read_b64_tr_b16 v[222:223], v30 offset:8
    ds_read_b64_tr_b16 v[230:231], v31 offset:0
    ds_read_b64_tr_b16 v[238:239], v31 offset:8
    s_waitcnt vmcnt(12) lgkmcnt(0)
    s_barrier
    s_add_u32 m0, s43, 0
    s_add_u32 s41, s63, 128
    buffer_load_dwordx4 v18, s[8:11], s41 offen offset:0 lds
    s_add_u32 s41, s63, 8320
    buffer_load_dwordx4 v18, s[8:11], s41 offen offset:1024 lds
    s_add_u32 s41, s63, 16512
    buffer_load_dwordx4 v18, s[8:11], s41 offen offset:2048 lds
    s_add_u32 s41, s63, 24704
    buffer_load_dwordx4 v18, s[8:11], s41 offen offset:3072 lds
    v_add_u32 v77, 36864, v20
    ds_read_b64_tr_b16 v[240:241], v77 offset:0
    ds_read_b64_tr_b16 v[242:243], v77 offset:4096
    ds_read_b64_tr_b16 v[244:245], v77 offset:8192
    ds_read_b64_tr_b16 v[246:247], v77 offset:12288
    ds_read_b64_tr_b16 v[248:249], v77 offset:8
    ds_read_b64_tr_b16 v[250:251], v77 offset:4104
    ds_read_b64_tr_b16 v[252:253], v77 offset:8200
    ds_read_b64_tr_b16 v[254:255], v77 offset:12296
    s_waitcnt vmcnt(12) lgkmcnt(0)
    s_barrier
    v_add_u32 v77, 73728, v79
    s_waitcnt lgkmcnt(0)
    ds_read_b64_tr_b16 v[0:1], v77 offset:0
    ds_read_b64_tr_b16 v[2:3], v77 offset:256
    ds_read_b64_tr_b16 v[4:5], v77 offset:2048
    ds_read_b64_tr_b16 v[6:7], v77 offset:2304
    ds_read_b64_tr_b16 v[8:9], v77 offset:8
    ds_read_b64_tr_b16 v[10:11], v77 offset:264
    ds_read_b64_tr_b16 v[12:13], v77 offset:2056
    ds_read_b64_tr_b16 v[14:15], v77 offset:2312
    s_waitcnt vmcnt(8) lgkmcnt(0)
    s_barrier
    v_add_u32 v77, 110592, v78
    ds_read_b64_tr_b16 v[16:17], v77 offset:0
    ds_read_b64_tr_b16 v[18:19], v77 offset:256
    ds_read_b64_tr_b16 v[20:21], v77 offset:2048
    ds_read_b64_tr_b16 v[22:23], v77 offset:2304
    ds_read_b64_tr_b16 v[24:25], v77 offset:8
    ds_read_b64_tr_b16 v[26:27], v77 offset:264
    ds_read_b64_tr_b16 v[28:29], v77 offset:2056
    ds_read_b64_tr_b16 v[30:31], v77 offset:2312
    s_waitcnt vmcnt(4) lgkmcnt(0)
    s_barrier
    v_add_u32 v77, 147456, v78
    ds_read_b64_tr_b16 v[32:33], v77 offset:0
    ds_read_b64_tr_b16 v[34:35], v77 offset:256
    ds_read_b64_tr_b16 v[36:37], v77 offset:2048
    ds_read_b64_tr_b16 v[38:39], v77 offset:2304
    ds_read_b64_tr_b16 v[40:41], v77 offset:8
    ds_read_b64_tr_b16 v[42:43], v77 offset:264
    ds_read_b64_tr_b16 v[44:45], v77 offset:2056
    ds_read_b64_tr_b16 v[46:47], v77 offset:2312
    s_waitcnt vmcnt(0) lgkmcnt(0)
    s_barrier
    v_add_u32 v77, 0, v78
    ds_read_b64_tr_b16 v[48:49], v77 offset:0
    ds_read_b64_tr_b16 v[50:51], v77 offset:256
    ds_read_b64_tr_b16 v[52:53], v77 offset:2048
    ds_read_b64_tr_b16 v[54:55], v77 offset:2304
    ds_read_b64_tr_b16 v[56:57], v77 offset:8
    ds_read_b64_tr_b16 v[58:59], v77 offset:264
    ds_read_b64_tr_b16 v[60:61], v77 offset:2056
    ds_read_b64_tr_b16 v[62:63], v77 offset:2312
    s_waitcnt lgkmcnt(0)
    s_barrier
    ds_write_b128 v70, v[0:3] offset:20480
    ds_write_b128 v70, v[4:7] offset:21504
    ds_write_b128 v70, v[8:11] offset:22528
    ds_write_b128 v70, v[12:15] offset:23552
    ds_write_b128 v70, v[16:19] offset:24576
    ds_write_b128 v70, v[20:23] offset:25600
    ds_write_b128 v70, v[24:27] offset:26624
    ds_write_b128 v70, v[28:31] offset:27648
    ds_write_b128 v70, v[32:35] offset:28672
    ds_write_b128 v70, v[36:39] offset:29696
    ds_write_b128 v70, v[40:43] offset:30720
    ds_write_b128 v70, v[44:47] offset:31744
    ds_write_b128 v70, v[48:51] offset:32768
    ds_write_b128 v70, v[52:55] offset:33792
    ds_write_b128 v70, v[56:59] offset:34816
    ds_write_b128 v70, v[60:63] offset:35840
    s_waitcnt lgkmcnt(0)
    v_bfe_u32 v60, v65, 4, 6
    v_and_b32 v61, 15, v60
    v_lshrrev_b32 v62, 4, v60
    v_mov_b32 v50, 0x3f80
    v_mov_b32 v51, 0x3f800000
    v_and_b32 v77, 1, v62
    v_lshlrev_b32 v77, 2, v77
    v_sub_u32 v77, v61, v77
    v_and_b32 v78, 3, v61
    v_lshlrev_b32 v78, 2, v78
    v_lshrrev_b32 v79, 2, v61
    v_add_u32 v78, v78, v79
    v_cmp_eq_u32 vcc, 0, v77
    s_nop 1
    v_cndmask_b32 v8, 0, v50, vcc
    v_cmp_eq_u32 vcc, 1, v77
    s_nop 1
    v_cndmask_b32 v8, v8, v51, vcc
    v_cmp_eq_u32 vcc, 0, v78
    s_nop 1
    v_cndmask_b32 v12, 0, v50, vcc
    v_cmp_eq_u32 vcc, 1, v78
    s_nop 1
    v_cndmask_b32 v12, v12, v51, vcc
    v_cmp_eq_u32 vcc, 2, v77
    s_nop 1
    v_cndmask_b32 v9, 0, v50, vcc
    v_cmp_eq_u32 vcc, 3, v77
    s_nop 1
    v_cndmask_b32 v9, v9, v51, vcc
    v_cmp_eq_u32 vcc, 2, v78
    s_nop 1
    v_cndmask_b32 v13, 0, v50, vcc
    v_cmp_eq_u32 vcc, 3, v78
    s_nop 1
    v_cndmask_b32 v13, v13, v51, vcc
    v_cmp_eq_u32 vcc, 8, v77
    s_nop 1
    v_cndmask_b32 v10, 0, v50, vcc
    v_cmp_eq_u32 vcc, 9, v77
    s_nop 1
    v_cndmask_b32 v10, v10, v51, vcc
    v_cmp_eq_u32 vcc, 4, v78
    s_nop 1
    v_cndmask_b32 v14, 0, v50, vcc
    v_cmp_eq_u32 vcc, 5, v78
    s_nop 1
    v_cndmask_b32 v14, v14, v51, vcc
    v_cmp_eq_u32 vcc, 10, v77
    s_nop 1
    v_cndmask_b32 v11, 0, v50, vcc
    v_cmp_eq_u32 vcc, 11, v77
    s_nop 1
    v_cndmask_b32 v11, v11, v51, vcc
    v_cmp_eq_u32 vcc, 6, v78
    s_nop 1
    v_cndmask_b32 v15, 0, v50, vcc
    v_cmp_eq_u32 vcc, 7, v78
    s_nop 1
    v_cndmask_b32 v15, v15, v51, vcc
    v_lshlrev_b32 v77, 4, v61
    ds_write_b128 v69, v[8:11] offset:15360
    ds_write_b128 v77, v[12:15] offset:15872
    s_waitcnt vmcnt(0) lgkmcnt(0)
    s_mov_b32 s88, 4194304
gn2:
    buffer_load_dword v2, off, s[84:87], 0 offset:216 sc1
    s_waitcnt vmcnt(0)
    v_readfirstlane_b32 s95, v2
    s_sub_u32 s88, s88, 1
    s_cbranch_scc1 gn2x
    s_cmp_eq_u32 s95, 0
    s_cbranch_scc1 gn2
gn2x:
    s_barrier
    v_mov_b32 v2, 1
    s_cmp_lg_u32 s13, 0
    s_cbranch_scc1 cf_noarr
    s_mov_b64 exec, 1
    buffer_atomic_add v2, off, s[84:87], 0 offset:132
    s_mov_b32 s40, 131072
    s_mov_b32 s42, 2
cf_startpoll:
    buffer_load_dword v3, off, s[84:87], 0 offset:132 sc1
    s_sub_u32 s40, s40, 1
    s_cbranch_scc1 cf_decide
    s_waitcnt vmcnt(0)
    v_readfirstlane_b32 s41, v3
    s_nop 1
    s_cmp_lt_u32 s41, 32
    s_cbranch_scc1 cf_startpoll
    s_mov_b32 s42, 1
cf_decide:
    v_mov_b32 v4, s42
    v_mov_b32 v5, 0
    buffer_atomic_cmpswap v[4:5], off, s[84:87], 0 offset:28 sc0
    s_waitcnt vmcnt(0)
    v_mov_b32 v5, s42
    v_cmp_eq_u32 vcc, 0, v4
    s_nop 1
    v_cndmask_b32 v4, v4, v5, vcc
    v_mov_b32 v5, 16192
    ds_write_b32 v5, v4
    s_waitcnt lgkmcnt(0)
    s_mov_b64 exec, -1
cf_noarr:
    s_barrier
    v_mov_b32 v5, 16192
    ds_read_b32 v4, v5
    s_waitcnt lgkmcnt(0)
    v_readfirstlane_b32 s41, v4
    s_nop 1
    s_cmp_eq_u32 s41, 1
    s_cbranch_scc1 cf_run
    v_lshrrev_b32 v0, 4, v65
    s_mov_b32 s32, s13
    s_load_dwordx16 s[48:63], s[0:1], 0
    s_waitcnt lgkmcnt(0)
    s_branch L_helper
cf_run:
    s_mov_b32 m0, 16128
    s_mov_b32 s44, 0x3e0293ee
    s_mov_b32 s45, s44
    s_or_b32 s66, s44, 0x80000000
    s_mov_b32 s48, 0x3f003f00
    s_mov_b32 s49, 0
    s_mov_b32 s50, 0x3f803f80
    s_mov_b32 s51, 0x3f803f80
    s_mov_b32 s52, 512
    s_mov_b32 s53, 1024
    s_mov_b32 s54, 1536
    s_mov_b32 s30, 0
    s_cmp_lg_u32 s32, 0
    s_cselect_b32 s71, s13, 3
    s_mov_b32 s14, 67125248
    s_mov_b32 s15, 67129344
    s_mov_b32 s16, 67133440
    s_mov_b32 s36, 0
    s_add_u32 s17, s68, 67108864
    s_mov_b32 s69, 0
    s_mov_b32 s70, 0
    s_lshl_b32 s26, s12, 14
    s_add_u32 s26, s26, 0
    s_mul_i32 s40, s13, 3072
    s_add_u32 s24, s26, s40
    s_lshl_b32 s40, s12, 14
    s_add_u32 s40, s40, 68157440
    s_add_u32 s18, s40, 0
    s_add_u32 s19, s40, 4096
    s_add_u32 s20, s40, 8192
    s_add_u32 s21, s40, 12288
    s_lshr_b32 s40, s12, 3
    s_lshl_b32 s40, s40, 12
    s_and_b32 s41, s12, 7
    s_lshl_b32 s41, s41, 7
    s_add_u32 s40, s40, s41
    s_add_u32 s22, s40, 68157440
    s_add_u32 s23, s22, 1024
    s_add_u32 s25, s22, 2048
    s_mov_b32 s56, -65528
    s_lshl_b32 s96, s12, 7
    s_add_u32 s29, s96, 125845504
    s_add_u32 s96, s96, 125829120
    s_cmp_lg_u32 s32, 0
    s_cselect_b64 s[38:39], -1, 0
    s_add_u32 s55, s68, 138412032
    s_cmp_eq_u32 s13, 3
    s_cselect_b64 s[100:101], 1, 0
    s_cselect_b64 s[38:39], 1, s[38:39]
    s_cselect_b32 s93, 64, 0
    s_cselect_b32 s55, s29, s55
    s_cselect_b32 s57, 0, 9216
    s_mov_b64 exec, s[100:101]
    v_mov_b32 v72, s95
    s_mov_b64 exec, -1
    s_mov_b32 s34, 0xff00ff00
    s_mov_b32 s35, 0xff00ff00
    s_lshl_b32 s28, s12, 12
    s_add_u32 s28, s28, 7602176
    s_add_u32 s27, s28, 77594624
    s_add_u32 s28, s28, 69206016
    s_mov_b32 s37, s93
    s_mov_b32 s40, 3
    v_bfe_u32 v78, v65, 2, 5
    s_mov_b32 s31, 4194304
cf_kv0:
    buffer_load_dword v77, v78, s[4:7], s96 offen offset:16 sc1
    s_waitcnt vmcnt(0)
    v_subrev_u32 v77, s95, v77
    v_cmp_lt_u32 vcc, 16, v77
    s_nop 1
    v_cndmask_b32 v77, v77, 0, vcc
    v_bfe_u32 v79, v78, 2, 2
    v_lshl_add_u32 v77, v77, 2, v79
    s_nop 1
    v_min_u32_dpp v77, v77, v77 row_ror:1 row_mask:0xf bank_mask:0xf
    s_nop 1
    v_min_u32_dpp v77, v77, v77 row_ror:2 row_mask:0xf bank_mask:0xf
    s_nop 1
    v_min_u32_dpp v77, v77, v77 row_ror:4 row_mask:0xf bank_mask:0xf
    s_nop 0
    v_readfirstlane_b32 s97, v77
    s_sub_u32 s31, s31, 1
    s_cbranch_scc1 cf_kv0_x
    s_cmp_le_u32 s40, s97
    s_cbranch_scc1 cf_kv0_x
    s_sleep 2
    s_branch cf_kv0
cf_kv0_x:
    s_add_u32 s40, s26, 0
    v_lshlrev_b32 v78, 2, v65
    buffer_load_dword v76, v78, s[4:7], s40 offen sc1
    s_add_u32 s40, s26, 524288
    v_lshlrev_b32 v78, 2, v65
    buffer_load_dword v76, v78, s[4:7], s40 offen sc1
    v_mov_b64 v[0:1], 0
    v_mov_b64 v[2:3], 0
    v_mov_b64 v[4:5], 0
    v_mov_b64 v[6:7], 0
    v_mov_b64 v[8:9], 0
    v_mov_b64 v[10:11], 0
    v_mov_b64 v[12:13], 0
    v_mov_b64 v[14:15], 0
    v_mov_b64 v[16:17], 0
    v_mov_b64 v[18:19], 0
    v_mov_b64 v[20:21], 0
    v_mov_b64 v[22:23], 0
    ds_read_b128 v[40:43], v70 offset:0
    ds_read_b128 v[44:47], v70 offset:1024
    ds_read_b128 v[48:51], v70 offset:2048
    ds_read_b128 v[52:55], v70 offset:3072
    ds_read_b128 v[24:27], v70 offset:4096
    ds_read_b128 v[28:31], v70 offset:5120
    ds_read_b128 v[32:35], v70 offset:6144
    ds_read_b128 v[36:39], v70 offset:7168
    buffer_load_dwordx4 v[60:63], v65, s[4:7], s14 offen offset:0 nt
    buffer_load_dwordx4 v[56:59], v66, s[4:7], s14 offen offset:0 nt
    s_mov_b32 s31, 1048576
    s_waitcnt vmcnt(0) lgkmcnt(0)
    s_branch cf_goA
cf_loop:
    s_add_u32 s40, s30, 3
    s_min_u32 s40, s40, 64
    s_cmp_le_u32 s40, s97
    s_cbranch_scc0 cf_kvwait
cf_kvok:
    s_mov_b32 s31, 1048576
    s_mov_b32 s69, s70
    s_waitcnt lgkmcnt(0)
cf_cA:
    buffer_load_dwordx4 v[60:63], v65, s[4:7], s14 offen offset:0 nt
    buffer_load_dwordx4 v[56:59], v66, s[4:7], s14 offen offset:0 nt
    v_bitop3_b32 v77, v60, v56, s70 bitop3:0x7e
    v_and_b32 v77, 1, v77
    v_cmp_ne_u32 vcc, 0, v77
    s_cbranch_vccz cf_goA
    v_bitop3_b32 v77, v60, v56, s70 bitop3:0x7e
    v_and_b32 v77, 1, v77
    v_cmp_ne_u32 vcc, 0, v77
    s_cbranch_vccz cf_goA
    v_bitop3_b32 v77, v60, v56, s70 bitop3:0x7e
    v_and_b32 v77, 1, v77
    v_cmp_ne_u32 vcc, 0, v77
    s_cbranch_vccz cf_goA
    v_bitop3_b32 v77, v60, v56, s70 bitop3:0x7e
    v_and_b32 v77, 1, v77
    v_cmp_ne_u32 vcc, 0, v77
    s_cbranch_vccz cf_goA
    buffer_load_dwordx4 v[60:63], v65, s[4:7], s14 offen offset:0 nt
    buffer_load_dwordx4 v[56:59], v66, s[4:7], s14 offen offset:0 nt
    v_bitop3_b32 v77, v60, v56, s70 bitop3:0x7e
    v_and_b32 v77, 1, v77
    v_cmp_ne_u32 vcc, 0, v77
    s_cbranch_vccz cf_goA
    v_bitop3_b32 v77, v60, v56, s70 bitop3:0x7e
    v_and_b32 v77, 1, v77
    v_cmp_ne_u32 vcc, 0, v77
    s_cbranch_vccz cf_goA
    v_bitop3_b32 v77, v60, v56, s70 bitop3:0x7e
    v_and_b32 v77, 1, v77
    v_cmp_ne_u32 vcc, 0, v77
    s_cbranch_vccz cf_goA
    v_bitop3_b32 v77, v60, v56, s70 bitop3:0x7e
    v_and_b32 v77, 1, v77
    v_cmp_ne_u32 vcc, 0, v77
    s_cbranch_vccz cf_goA
    buffer_load_dwordx4 v[60:63], v65, s[4:7], s14 offen offset:0 nt
    buffer_load_dwordx4 v[56:59], v66, s[4:7], s14 offen offset:0 nt
    v_bitop3_b32 v77, v60, v56, s70 bitop3:0x7e
    v_and_b32 v77, 1, v77
    v_cmp_ne_u32 vcc, 0, v77
    s_cbranch_vccz cf_goA
    v_bitop3_b32 v77, v60, v56, s70 bitop3:0x7e
    v_and_b32 v77, 1, v77
    v_cmp_ne_u32 vcc, 0, v77
    s_cbranch_vccz cf_goA
    v_bitop3_b32 v77, v60, v56, s70 bitop3:0x7e
    v_and_b32 v77, 1, v77
    v_cmp_ne_u32 vcc, 0, v77
    s_cbranch_vccz cf_goA
    v_bitop3_b32 v77, v60, v56, s70 bitop3:0x7e
    v_and_b32 v77, 1, v77
    v_cmp_ne_u32 vcc, 0, v77
    s_cbranch_vccz cf_goA
    buffer_load_dwordx4 v[60:63], v65, s[4:7], s14 offen offset:0 nt
    buffer_load_dwordx4 v[56:59], v66, s[4:7], s14 offen offset:0 nt
    v_bitop3_b32 v77, v60, v56, s70 bitop3:0x7e
    v_and_b32 v77, 1, v77
    v_cmp_ne_u32 vcc, 0, v77
    s_cbranch_vccz cf_goA
    v_bitop3_b32 v77, v60, v56, s70 bitop3:0x7e
    v_and_b32 v77, 1, v77
    v_cmp_ne_u32 vcc, 0, v77
    s_cbranch_vccz cf_goA
    v_bitop3_b32 v77, v60, v56, s70 bitop3:0x7e
    v_and_b32 v77, 1, v77
    v_cmp_ne_u32 vcc, 0, v77
    s_cbranch_vccz cf_goA
    v_bitop3_b32 v77, v60, v56, s70 bitop3:0x7e
    v_and_b32 v77, 1, v77
    v_cmp_ne_u32 vcc, 0, v77
    s_cbranch_vccz cf_goA
    s_sub_u32 s31, s31, 64
    s_cbranch_scc0 cf_cA
cf_goA:
    ds_write_b128 v65, v[60:63] offset:0
    v_smfmac_f32_16x16x64_bf16 v[0:3], v[60:63], v[40:47], v64
    v_smfmac_f32_16x16x64_bf16 v[4:7], v[60:63], v[48:55], v64
    buffer_load_dwordx4 v[40:43], v65, s[4:7], s15 offen offset:0 nt
    v_smfmac_f32_16x16x64_bf16 v[0:3], v[56:59], v[24:31], v64
    v_smfmac_f32_16x16x64_bf16 v[4:7], v[56:59], v[32:39], v64
    ds_read_b128 v[24:27], v70 offset:8192
    v_smfmac_f32_16x16x64_bf16 v[8:11], v[60:63], a[96:103], v64
    ds_read_b128 v[28:31], v70 offset:9216
    v_smfmac_f32_16x16x64_bf16 v[12:15], v[60:63], a[104:111], v64
    ds_read_b128 v[32:35], v70 offset:10240
    s_waitcnt lgkmcnt(3)
    s_barrier
    ds_read_b128 v[48:51], v67 offset:0
    v_smfmac_f32_16x16x64_bf16 v[8:11], v[56:59], a[112:119], v64
    ds_read_b128 v[36:39], v70 offset:11264
    v_smfmac_f32_16x16x64_bf16 v[12:15], v[56:59], a[120:127], v64
    ds_read_b128 v[52:55], v68 offset:0
    v_smfmac_f32_16x16x64_bf16 v[16:19], v[60:63], a[216:223], v64
    buffer_load_dwordx4 v[40:43], v65, s[4:7], s15 offen offset:0 nt
    s_waitcnt lgkmcnt(4)
    v_smfmac_f32_16x16x64_bf16 v[20:23], v[60:63], v[24:31], v64
    ds_read_b128 v[24:27], v70 offset:12288
    s_waitcnt lgkmcnt(3)
    v_smfmac_f32_16x16x64_bf16 v[0:3], v[48:51], a[0:7], v64
    ds_read_b128 v[28:31], v70 offset:13312
    s_waitcnt lgkmcnt(3)
    v_smfmac_f32_16x16x64_bf16 v[4:7], v[48:51], v[32:39], v64
    ds_read_b128 v[32:35], v70 offset:14336
    v_smfmac_f32_16x16x64_bf16 v[8:11], v[48:51], a[128:135], v64
    ds_read_b128 v[36:39], v70 offset:15360
    v_smfmac_f32_16x16x64_bf16 v[12:15], v[48:51], a[136:143], v64
    v_smfmac_f32_16x16x64_bf16 v[16:19], v[56:59], a[224:231], v64
    v_smfmac_f32_16x16x64_bf16 v[20:23], v[56:59], a[232:239], v64
    s_waitcnt lgkmcnt(2)
    s_waitcnt vmcnt(1)
    v_and_b32 v77, s36, v40
    v_smfmac_f32_16x16x64_bf16 v[12:15], v[52:55], v[24:31], v64
    ds_write_b128 v65, v[40:43] offset:4096
    v_smfmac_f32_16x16x64_bf16 v[0:3], v[52:55], a[8:15], v64
    s_waitcnt lgkmcnt(1)
    v_cmp_ne_u32 vcc, s70, v77
    v_smfmac_f32_16x16x64_bf16 v[4:7], v[52:55], v[32:39], v64
    buffer_load_dwordx4 v[60:63], v65, s[4:7], s16 offen offset:0 nt
    v_smfmac_f32_16x16x64_bf16 v[8:11], v[52:55], a[144:151], v64
    s_cbranch_vccnz cf_spinB
cf_backB:
    v_smfmac_f32_16x16x64_bf16 v[16:19], v[40:43], v[176:183], v64
    s_waitcnt lgkmcnt(0)
    s_barrier
    ds_read_b128 v[44:47], v66 offset:4096
    v_smfmac_f32_16x16x64_bf16 v[12:15], v[40:43], a[160:167], v64
    ds_read_b128 v[32:35], v70 offset:16384
    buffer_load_dwordx4 v[24:27], v65, s[4:7], s24 offen offset:0 sc1
    v_smfmac_f32_16x16x64_bf16 v[0:3], v[40:43], a[16:23], v64
    ds_read_b128 v[36:39], v70 offset:17408
    v_smfmac_f32_16x16x64_bf16 v[8:11], v[40:43], a[152:159], v64
    ds_read_b128 v[48:51], v67 offset:4096
    v_smfmac_f32_16x16x64_bf16 v[4:7], v[40:43], a[24:31], v64
    ds_read_b128 v[52:55], v68 offset:4096
    v_smfmac_f32_16x16x64_bf16 v[20:23], v[40:43], v[184:191], v64
    buffer_load_dwordx4 v[28:31], v65, s[4:7], s24 offen offset:1024 sc1
    s_waitcnt lgkmcnt(4)
    v_smfmac_f32_16x16x64_bf16 v[0:3], v[44:47], a[32:39], v64
    ds_read_b128 v[56:59], v69 offset:15360
    s_waitcnt lgkmcnt(3)
    v_smfmac_f32_16x16x64_bf16 v[8:11], v[44:47], v[32:39], v64
    ds_read_b128 v[32:35], v70 offset:18432
    v_smfmac_f32_16x16x64_bf16 v[4:7], v[44:47], a[40:47], v64
    ds_read_b128 v[36:39], v70 offset:19456
    s_add_u32 s40, s26, 1048576
    v_lshlrev_b32 v78, 2, v65
    v_smfmac_f32_16x16x64_bf16 v[12:15], v[44:47], a[168:175], v64
    buffer_load_dwordx4 v[42:45], v65, s[4:7], s24 offen offset:3072 sc1
    s_waitcnt lgkmcnt(3)
    v_smfmac_f32_16x16x64_bf16 v[0:3], v[48:51], a[48:55], v64
    v_smfmac_f32_16x16x64_bf16 v[8:11], v[48:51], a[176:183], v64
    v_smfmac_f32_16x16x64_bf16 v[0:3], v[52:55], a[64:71], v64
    s_waitcnt lgkmcnt(0)
    v_smfmac_f32_16x16x64_bf16 v[8:11], v[52:55], v[32:39], v64
    buffer_load_dwordx4 v[34:37], v65, s[4:7], s24 offen offset:2048 sc1
    v_smfmac_f32_16x16x64_bf16 v[4:7], v[48:51], a[56:63], v64
    v_smfmac_f32_16x16x64_bf16 v[4:7], v[52:55], a[72:79], v64
    s_waitcnt vmcnt(4)
    v_and_b32 v77, s36, v60
    v_smfmac_f32_16x16x64_bf16 v[12:15], v[48:51], a[184:191], v64
    v_cmp_ne_u32 vcc, s70, v77
    v_smfmac_f32_16x16x64_bf16 v[12:15], v[52:55], a[192:199], v64
    s_cbranch_vccnz cf_spin8
cf_back8:
    v_smfmac_f32_16x16x64_bf16 v[0:3], v[60:63], a[80:87], v64
    s_nop 1
    v_lshrrev_b32 v77, 1, v69
    v_smfmac_f32_16x16x64_bf16 v[8:11], v[60:63], a[200:207], v64
    buffer_load_dword v76, v78, s[4:7], s40 offen sc1
    s_nop 1
    v_smfmac_f32_16x16x64_bf16 v[4:7], v[60:63], a[88:95], v64
    s_nop 1
    v_cvt_pk_bf16_f32 v0, v0, v1
    v_smfmac_f32_16x16x64_bf16 v[12:15], v[60:63], a[208:215], v64
    s_nop 1
    v_cvt_pk_bf16_f32 v1, v2, v3
    v_cvt_pk_bf16_f32 v2, v8, v9
    v_cvt_pk_bf16_f32 v3, v10, v11
    v_cvt_pk_bf16_f32 v4, v4, v5
    v_cvt_pk_bf16_f32 v5, v6, v7
    v_mfma_f32_16x16x32_bf16 v[8:11], v[0:3], v[56:59], 0
    v_cvt_pk_bf16_f32 v6, v12, v13
    v_cvt_pk_bf16_f32 v7, v14, v15
    s_nop 1
    v_mfma_f32_16x16x32_bf16 v[12:15], v[4:7], v[56:59], 0
    ds_read_b128 v[56:59], v66 offset:4096
    s_nop 1
    v_smfmac_f32_16x16x64_bf16 v[16:19], v[48:51], v[208:215], v64
    s_waitcnt vmcnt(3)
    s_nop 0
    v_cvt_pk_bf16_f32 v0, v8, v9
    v_cvt_pk_bf16_f32 v1, v10, v11
    v_cvt_pk_bf16_f32 v2, v12, v13
    v_cvt_pk_bf16_f32 v3, v14, v15
    s_nop 1
    v_mfma_f32_16x16x32_bf16 v[12:15], v[0:3], v[0:3], 0
    s_nop 2
    v_mfma_f32_16x16x32_bf16 v[4:7], v[24:27], v[0:3], 0
    ds_read_b128 v[24:27], v67 offset:0
    s_nop 1
    v_mfma_f32_16x16x32_bf16 v[8:11], v[28:31], v[0:3], 0
    s_nop 0
    v_mov_b32_dpp v12, v14 row_ror:8 row_mask:0xf bank_mask:0xc
    v_mov_b32_dpp v13, v15 row_ror:8 row_mask:0xf bank_mask:0xc
    v_smfmac_f32_16x16x64_bf16 v[20:23], v[48:51], v[216:223], v64
    ds_write_b64 v71, v[12:13]
    ds_read_b128 v[48:51], v68 offset:0
    s_nop 1
    v_mov_b32_dpp v4, v8 row_ror:8 row_mask:0xf bank_mask:0xc
    v_mov_b32_dpp v5, v9 row_ror:8 row_mask:0xf bank_mask:0xc
    v_mov_b32_dpp v6, v10 row_ror:8 row_mask:0xf bank_mask:0xc
    v_mov_b32_dpp v7, v11 row_ror:8 row_mask:0xf bank_mask:0xc
    v_smfmac_f32_16x16x64_bf16 v[16:19], v[52:55], v[224:231], v64
    ds_write_b128 v65, v[4:7] offset:8192
    v_smfmac_f32_16x16x64_bf16 v[20:23], v[52:55], v[232:239], v64
    s_waitcnt lgkmcnt(3)
    v_smfmac_f32_16x16x64_bf16 v[16:19], v[24:27], a[240:247], v64
    s_waitcnt vmcnt(1)
    s_cmp_ge_u32 s30, 58
    v_smfmac_f32_16x16x64_bf16 v[20:23], v[24:27], a[248:255], v64
    s_cbranch_scc1 cf_pubk
cf_pubk_x:
    v_smfmac_f32_16x16x64_bf16 v[16:19], v[60:63], v[240:247], v64
    s_waitcnt lgkmcnt(0)
    s_barrier
    ds_read_b128 v[8:11], v66 offset:8192
    v_smfmac_f32_16x16x64_bf16 v[20:23], v[60:63], v[248:255], v64
    ds_read_b128 v[12:15], v67 offset:8192
    ds_read_b128 v[0:3], v68 offset:8192
    ds_read_b64 v[24:25], v77 offset:14336
    v_smfmac_f32_16x16x64_bf16 v[16:19], v[56:59], v[192:199], v64
    ds_read_b64 v[26:27], v77 offset:14592
    ds_read_b64 v[28:29], v77 offset:14848
    ds_read_b64 v[30:31], v77 offset:15104
    v_smfmac_f32_16x16x64_bf16 v[20:23], v[56:59], v[200:207], v64
    s_cmp_lg_u32 s37, 0
    v_smfmac_f32_16x16x64_bf16 v[16:19], v[48:51], v[160:167], v64
    s_mov_b64 exec, s[38:39]
    buffer_store_dword v72, v75, s[4:7], s55 offen sc1
    s_mov_b64 exec, -1
    v_smfmac_f32_16x16x64_bf16 v[20:23], v[48:51], v[168:175], v64
    s_cbranch_scc1 cf_rare
cf_rare_x:
    ds_read_b128 v[56:59], v70 offset:22528
    ds_read_b128 v[60:63], v70 offset:23552
    s_cmp_ge_u32 s30, 58
    s_waitcnt lgkmcnt(8)
    v_pk_add_f32 v[4:5], v[4:5], v[8:9]
    v_pk_add_f32 v[6:7], v[6:7], v[10:11]
    s_waitcnt lgkmcnt(6)
    v_pk_add_f32 v[12:13], v[12:13], v[0:1]
    v_pk_add_f32 v[14:15], v[14:15], v[2:3]
    v_pk_add_f32 v[4:5], v[4:5], v[12:13]
    v_pk_add_f32 v[6:7], v[6:7], v[14:15]
    s_waitcnt lgkmcnt(2)
    v_pk_add_f32 v[24:25], v[24:25], v[26:27]
    v_pk_add_f32 v[28:29], v[28:29], v[30:31]
    v_max3_f32 v77, v4, v5, v6
    v_pk_add_f32 v[24:25], v[24:25], v[28:29]
    v_max_f32 v77, v77, v7
    v_max3_f32 v77, v77, v24, v25
    v_cvt_pk_bf16_f32 v38, v16, v17
    v_cvt_pk_bf16_f32 v39, v18, v19
    v_max_f32_dpp v77, v77, v77 row_ror:8 row_mask:0xf bank_mask:0xf
    v_mov_b32 v78, v77
    v_cvt_pk_bf16_f32 v40, v20, v21
    v_cvt_pk_bf16_f32 v41, v22, v23
    v_permlane32_swap_b32 v77, v78
    v_max_f32 v77, v77, v78
    v_mov_b32 v78, v77
    v_mov_b32 v11, 0
    v_mov_b32 v32, v38
    v_permlane16_swap_b32 v77, v78
    v_max_f32 v77, v77, v78
    v_mul_f32 v8, s66, v77
    v_pk_fma_f32 v[4:5], v[4:5], s[44:45], v[8:9] op_sel_hi:[1,1,0]
    v_pk_fma_f32 v[6:7], v[6:7], s[44:45], v[8:9] op_sel_hi:[1,1,0]
    v_pk_fma_f32 v[24:25], v[24:25], s[44:45], v[8:9] op_sel_hi:[1,1,0]
    v_exp_f32 v4, v4
    v_exp_f32 v5, v5
    v_exp_f32 v6, v6
    v_exp_f32 v7, v7
    v_exp_f32 v24, v24
    v_exp_f32 v25, v25
    v_cvt_pk_bf16_f32 v12, v4, v5
    v_cvt_pk_bf16_f32 v13, v6, v7
    v_cvt_pk_bf16_f32 v10, v24, v25
    v_cvt_pk_bf16_f32 v15, v24, v25
    v_mov_b32 v14, 0
    v_mfma_f32_16x16x32_bf16 v[4:7], v[32:35], v[10:13], 0
    s_cbranch_scc1 cf_pubv
cf_pubv_x:
    v_mov_b64 v[0:1], s[48:49]
    v_mov_b64 v[2:3], s[50:51]
    v_mfma_f32_16x16x32_bf16 v[24:27], v[36:39], v[12:15], 0
    ds_read_b128 v[48:51], v70 offset:20480
    v_mov_b32 v47, v41
    v_bitop3_b32 v77, v73, -9, s52 bitop3:0x6a
    v_mfma_f32_16x16x32_bf16 v[28:31], v[0:3], v[10:13], 0
    ds_read_b128 v[52:55], v70 offset:21504
    v_mov_b64 v[0:1], 0
    v_mov_b64 v[2:3], 0
    v_mfma_f32_16x16x32_bf16 v[16:19], v[40:43], v[10:13], 0
    ds_read_b128 v[32:35], v70 offset:24576
    v_bitop3_b32 v78, v73, -9, s53 bitop3:0x6a
    v_bitop3_b32 v79, v73, -9, s54 bitop3:0x6a
    v_mfma_f32_16x16x32_bf16 v[20:23], v[44:47], v[12:15], 0
    ds_read_b128 v[36:39], v70 offset:25600
    v_add_f32_dpp v4, v24, v4 row_ror:8 row_mask:0xf bank_mask:0xf
    v_add_f32_dpp v5, v25, v5 row_ror:8 row_mask:0xf bank_mask:0xf
    v_add_f32_dpp v6, v26, v6 row_ror:8 row_mask:0xf bank_mask:0xf
    v_add_f32_dpp v7, v27, v7 row_ror:8 row_mask:0xf bank_mask:0xf
    v_add_f32_dpp v29, v28, v28 row_ror:8 row_mask:0xf bank_mask:0xf
    v_rcp_f32 v28, v29
    s_nop 0
    v_add_f32_dpp v4, v16, v20 row_ror:8 row_mask:0xf bank_mask:0xc
    v_add_f32_dpp v5, v17, v21 row_ror:8 row_mask:0xf bank_mask:0xc
    v_add_f32_dpp v6, v18, v22 row_ror:8 row_mask:0xf bank_mask:0xc
    v_add_f32_dpp v7, v19, v23 row_ror:8 row_mask:0xf bank_mask:0xc
    v_pk_mul_f32 v[4:5], v[4:5], v[28:29] op_sel_hi:[1,0]
    v_pk_mul_f32 v[6:7], v[6:7], v[28:29] op_sel_hi:[1,0]
    v_cvt_pk_bf16_f32 v4, v4, v5
    v_cvt_pk_bf16_f32 v5, v6, v7
    ds_write_b64 v73, v[4:5] offset:12288
    v_mov_b32_dpp v6, v4 row_ror:8 row_mask:0xf bank_mask:0xf
    v_mov_b32_dpp v7, v5 row_ror:8 row_mask:0xf bank_mask:0xf
    v_mov_b64 v[8:9], 0
    v_mov_b64 v[10:11], 0
    s_waitcnt lgkmcnt(3)
    v_smfmac_f32_16x16x64_bf16 v[0:3], v[4:7], v[48:55], v64
    ds_read_b128 v[40:43], v70 offset:26624
    v_mov_b64 v[12:13], 0
    v_mov_b64 v[14:15], 0
    v_mov_b32 v52, v78
    v_smfmac_f32_16x16x64_bf16 v[8:11], v[4:7], v[80:87], v64
    ds_read_b128 v[44:47], v70 offset:27648
    v_mov_b64 v[24:25], 0
    v_mov_b64 v[26:27], 0
    v_smfmac_f32_16x16x64_bf16 v[12:15], v[4:7], v[112:119], v64
    s_waitcnt lgkmcnt(2)
    v_mov_b32_dpp v52, v79 quad_perm:[0,1,2,3] row_mask:0xf bank_mask:0xc
    v_xor_b32 v48, 1024, v52
    s_barrier
    ds_read_b128 v[16:19], v77 offset:12288
    v_smfmac_f32_16x16x64_bf16 v[24:27], v[4:7], v[56:63], v64
    ds_read_b128 v[20:23], v78 offset:12288
    ds_read_b128 v[28:31], v79 offset:12288
    ds_read_b128 v[52:55], v52 offset:12288
    ds_read_b128 v[48:51], v48 offset:12288
    v_mov_b64 v[4:5], 0
    v_mov_b64 v[6:7], 0
    s_waitcnt lgkmcnt(4)
    v_smfmac_f32_16x16x64_bf16 v[8:11], v[16:19], v[88:95], v64
    ds_read_b128 v[56:59], v70 offset:28672
    v_smfmac_f32_16x16x64_bf16 v[12:15], v[16:19], v[120:127], v64
    ds_read_b128 v[60:63], v70 offset:29696
    s_waitcnt lgkmcnt(5)
    v_smfmac_f32_16x16x64_bf16 v[8:11], v[20:23], v[96:103], v64
    v_bfe_u32 v77, v74, 16, 1
    v_smfmac_f32_16x16x64_bf16 v[12:15], v[20:23], v[128:135], v64
    s_waitcnt lgkmcnt(4)
    v_mad_i32_i24 v77, v77, s56, v74
    v_smfmac_f32_16x16x64_bf16 v[8:11], v[28:31], v[104:111], v64
    s_nop 2
    v_smfmac_f32_16x16x64_bf16 v[12:15], v[28:31], v[136:143], v64
    s_waitcnt lgkmcnt(2)
    s_nop 1
    v_smfmac_f32_16x16x64_bf16 v[4:7], v[48:51], v[144:151], v64
    v_cvt_pk_bf16_f32 v8, v8, v9
    v_cvt_pk_bf16_f32 v9, v10, v11
    v_and_or_b32 v8, v8, -2, s69
    s_nop 0
    v_cvt_pk_bf16_f32 v10, v12, v13
    v_cvt_pk_bf16_f32 v11, v14, v15
    v_smfmac_f32_16x16x64_bf16 v[4:7], v[52:55], v[152:159], v64
    buffer_store_dwordx4 v[8:11], v74, s[4:7], s22 offen
    ds_read_b128 v[48:51], v70 offset:30720
    v_smfmac_f32_16x16x64_bf16 v[0:3], v[16:19], v[32:39], v64
    ds_read_b128 v[52:55], v70 offset:31744
    s_add_u32 s30, s30, 1
    s_waitcnt lgkmcnt(2)
    v_smfmac_f32_16x16x64_bf16 v[24:27], v[16:19], v[40:47], v64
    ds_read_b128 v[32:35], v70 offset:32768
    v_cvt_pk_bf16_f32 v4, v4, v5
    v_cvt_pk_bf16_f32 v5, v6, v7
    v_and_or_b32 v4, v4, -2, s69
    v_smfmac_f32_16x16x64_bf16 v[0:3], v[20:23], v[56:63], v64
    buffer_store_dwordx2 v[4:5], v77, s[4:7], s25 offen
    ds_read_b128 v[36:39], v70 offset:33792
    s_xor_b32 s70, s70, 1
    ds_read_b128 v[40:43], v70 offset:34816
    s_waitcnt lgkmcnt(3)
    v_smfmac_f32_16x16x64_bf16 v[24:27], v[20:23], v[48:55], v64
    ds_read_b128 v[44:47], v70 offset:35840
    s_waitcnt lgkmcnt(2)
    v_smfmac_f32_16x16x64_bf16 v[0:3], v[28:31], v[32:39], v64
    s_cmp_lg_u32 s71, 0
    s_waitcnt lgkmcnt(0)
    s_nop 0
    v_smfmac_f32_16x16x64_bf16 v[24:27], v[28:31], v[40:47], v64
    s_nop 3
    v_cvt_pk_bf16_f32 v0, v0, v1
    v_cvt_pk_bf16_f32 v1, v2, v3
    v_and_or_b32 v0, v0, -2, s69
    s_nop 0
    v_cvt_pk_bf16_f32 v2, v24, v25
    v_cvt_pk_bf16_f32 v3, v26, v27
    buffer_store_dwordx4 v[0:3], v74, s[4:7], s23 offen
    s_cbranch_scc1 cf_e1
    s_nop 0
    s_nop 2
    v_mov_b32 v79, v79
    s_nop 2
    v_mov_b32 v79, v79
    s_nop 2
    v_mov_b32 v79, v79
    s_nop 2
    v_mov_b32 v79, v79
    s_nop 2
    v_mov_b32 v79, v79
    s_nop 2
    v_mov_b32 v79, v79
    s_nop 2
    v_mov_b32 v79, v79
    s_nop 2
    v_mov_b32 v79, v79
    s_nop 2
    v_mov_b32 v79, v79
    s_nop 2
    v_mov_b32 v79, v79
    s_nop 2
    v_mov_b32 v79, v79
    s_nop 2
    v_mov_b32 v79, v79
    buffer_load_dwordx4 v[8:11], v65, s[4:7], s18 offen nt
    buffer_load_dwordx4 v[12:15], v65, s[4:7], s19 offen nt
    buffer_load_dwordx4 v[16:19], v65, s[4:7], s20 offen nt
    buffer_load_dwordx4 v[20:23], v65, s[4:7], s21 offen nt
    v_and_b32 v77, 255, v69
    ds_read_b128 v[4:7], v77 offset:15872
    ds_read_b128 v[40:43], v70 offset:0
    ds_read_b128 v[44:47], v70 offset:1024
    ds_read_b128 v[48:51], v70 offset:2048
    ds_read_b128 v[52:55], v70 offset:3072
    ds_read_b128 v[24:27], v70 offset:4096
    ds_read_b128 v[28:31], v70 offset:5120
    ds_read_b128 v[32:35], v70 offset:6144
    ds_read_b128 v[36:39], v70 offset:7168
    s_mov_b32 s31, 65536
    s_add_u32 s24, s24, 524288
    s_add_u32 s26, s26, 524288
    s_add_u32 s55, s55, s57
    s_cmp_lt_u32 s97, s93
    s_cselect_b32 s37, 1, 0
    s_cmp_eq_u32 s30, 63
    s_cselect_b32 s37, 1, s37
    s_mov_b32 s14, 67108864
    s_mov_b32 s15, 67112960
    s_mov_b32 s16, 67117056
    s_mov_b32 s36, 1
    v_mov_b32 v60, s69
    v_mov_b32 v56, s69
    v_and_b32 v79, 12, v75
    v_cmp_eq_u32 vcc, 0, v79
    s_nop 1
    v_cndmask_b32 v79, 0, 1, vcc
    s_waitcnt lgkmcnt(0)
    s_waitcnt vmcnt(3)
    v_xor_b32 v77, s69, v8
    v_mfma_f32_16x16x32_bf16 v[0:3], v[4:7], v[8:11], 0
    s_waitcnt vmcnt(2)
    v_bitop3_b32 v77, v77, v12, s69 bitop3:0xf6
    v_mfma_f32_16x16x32_bf16 v[0:3], v[4:7], v[12:15], v[0:3]
    s_waitcnt vmcnt(1)
    v_bitop3_b32 v77, v77, v16, s69 bitop3:0xf6
    v_mfma_f32_16x16x32_bf16 v[0:3], v[4:7], v[16:19], v[0:3]
    s_waitcnt vmcnt(0)
    v_bitop3_b32 v77, v77, v20, s69 bitop3:0xf6
    v_mfma_f32_16x16x32_bf16 v[0:3], v[4:7], v[20:23], v[0:3]
    v_and_b32 v77, 1, v77
    v_cmp_ne_u32 vcc, 0, v77
    s_nop 0
    s_cmp_eq_u64 vcc, 0
    s_cselect_b64 s[42:43], -1, 0
    s_nop 2
    v_add_f32_dpp v0, v0, v0 row_ror:8 row_mask:0xf bank_mask:0xf
    v_add_f32_dpp v1, v1, v1 row_ror:8 row_mask:0xf bank_mask:0xf
    s_mov_b64 exec, s[42:43]
    v_cvt_pk_bf16_f32 v72, v0, v1
    v_bfi_b32 v72, v79, s70, v72
    buffer_store_dword v72, v75, s[4:7], s17 offen offset:0
    s_mov_b64 exec, -1
    s_cbranch_scc0 cf_f0_retry
cf_f0_go:
    v_mov_b64 v[0:1], 0
    v_mov_b64 v[2:3], 0
    v_mov_b64 v[4:5], 0
    v_mov_b64 v[6:7], 0
    v_mov_b64 v[8:9], 0
    v_mov_b64 v[10:11], 0
    v_mov_b64 v[12:13], 0
    v_mov_b64 v[14:15], 0
    v_mov_b64 v[16:17], 0
    v_mov_b64 v[18:19], 0
    v_mov_b64 v[20:21], 0
    v_mov_b64 v[22:23], 0
    s_nop 2
    v_mov_b32 v79, v79
    s_nop 2
    v_mov_b32 v79, v79
    s_branch cf_loop
cf_e1:
    s_cmp_lg_u32 s71, 2
    s_cbranch_scc1 cf_f1
    s_nop 2
    v_mov_b32 v79, v79
    s_nop 2
    v_mov_b32 v79, v79
    s_nop 2
    v_mov_b32 v79, v79
    s_nop 2
    v_mov_b32 v79, v79
    s_nop 2
    v_mov_b32 v79, v79
    s_nop 2
    v_mov_b32 v79, v79
    s_nop 2
    v_mov_b32 v79, v79
    s_nop 2
    v_mov_b32 v79, v79
    s_nop 2
    v_mov_b32 v79, v79
    s_nop 2
    v_mov_b32 v79, v79
    s_nop 2
    v_mov_b32 v79, v79
    s_nop 2
    v_mov_b32 v79, v79
    s_nop 2
    v_mov_b32 v79, v79
    s_nop 2
    v_mov_b32 v79, v79
    s_nop 2
    v_mov_b32 v79, v79
    s_nop 2
    v_mov_b32 v79, v79
    buffer_load_dwordx4 v[8:11], v65, s[4:7], s18 offen nt
    buffer_load_dwordx4 v[12:15], v65, s[4:7], s19 offen nt
    buffer_load_dwordx4 v[16:19], v65, s[4:7], s20 offen nt
    buffer_load_dwordx4 v[20:23], v65, s[4:7], s21 offen nt
    v_and_b32 v77, 255, v69
    ds_read_b128 v[4:7], v77 offset:15872
    ds_read_b128 v[40:43], v70 offset:0
    ds_read_b128 v[44:47], v70 offset:1024
    ds_read_b128 v[48:51], v70 offset:2048
    ds_read_b128 v[52:55], v70 offset:3072
    ds_read_b128 v[24:27], v70 offset:4096
    ds_read_b128 v[28:31], v70 offset:5120
    ds_read_b128 v[32:35], v70 offset:6144
    ds_read_b128 v[36:39], v70 offset:7168
    s_mov_b32 s31, 65536
    s_add_u32 s24, s24, 524288
    s_add_u32 s26, s26, 524288
    s_add_u32 s55, s55, s57
    s_cmp_lt_u32 s97, s93
    s_cselect_b32 s37, 1, 0
    s_cmp_eq_u32 s30, 63
    s_cselect_b32 s37, 1, s37
    s_mov_b32 s14, 67108864
    s_mov_b32 s15, 67112960
    s_mov_b32 s16, 67117056
    s_mov_b32 s36, 1
    v_mov_b32 v60, s69
    v_mov_b32 v56, s69
    v_and_b32 v79, 12, v75
    v_cmp_eq_u32 vcc, 0, v79
    s_nop 1
    v_cndmask_b32 v79, 0, 1, vcc
    s_waitcnt lgkmcnt(0)
    s_waitcnt vmcnt(3)
    v_xor_b32 v77, s69, v8
    v_bitop3_b32 v77, v77, v10, s69 bitop3:0xf6
    v_mfma_f32_16x16x32_bf16 v[0:3], v[4:7], v[8:11], 0
    s_waitcnt vmcnt(2)
    v_bitop3_b32 v77, v77, v12, s69 bitop3:0xf6
    v_bitop3_b32 v77, v77, v14, s69 bitop3:0xf6
    v_mfma_f32_16x16x32_bf16 v[0:3], v[4:7], v[12:15], v[0:3]
    s_waitcnt vmcnt(1)
    v_bitop3_b32 v77, v77, v16, s69 bitop3:0xf6
    v_bitop3_b32 v77, v77, v18, s69 bitop3:0xf6
    v_mfma_f32_16x16x32_bf16 v[0:3], v[4:7], v[16:19], v[0:3]
    s_waitcnt vmcnt(0)
    v_bitop3_b32 v77, v77, v20, s69 bitop3:0xf6
    v_bitop3_b32 v77, v77, v22, s69 bitop3:0xf6
    v_mfma_f32_16x16x32_bf16 v[0:3], v[4:7], v[20:23], v[0:3]
    v_and_b32 v77, 1, v77
    v_cmp_ne_u32 vcc, 0, v77
    s_nop 0
    s_cmp_eq_u64 vcc, 0
    s_cselect_b64 s[42:43], -1, 0
    s_nop 2
    v_add_f32 v2, v0, v1
    s_nop 1
    v_add_f32_dpp v2, v2, v2 row_ror:8 row_mask:0xf bank_mask:0xf
    s_nop 1
    v_mov_b32_dpp v0, v2 quad_perm:[0,0,2,2] row_mask:0xf bank_mask:0xf
    v_mov_b32_dpp v1, v2 quad_perm:[1,1,3,3] row_mask:0xf bank_mask:0xf
    s_mov_b64 exec, s[42:43]
    v_cvt_pk_bf16_f32 v72, v0, v1
    v_bfi_b32 v72, v79, s70, v72
    buffer_store_dword v72, v75, s[4:7], s17 offen offset:0
    buffer_store_dword v72, v75, s[4:7], s17 offen offset:1024
    buffer_store_dword v72, v75, s[4:7], s17 offen offset:2048
    buffer_store_dword v72, v75, s[4:7], s17 offen offset:3072
    s_mov_b64 exec, -1
    s_cbranch_scc0 cf_f2_retry
cf_f2_go:
    v_mov_b64 v[0:1], 0
    v_mov_b64 v[2:3], 0
    v_mov_b64 v[4:5], 0
    v_mov_b64 v[6:7], 0
    v_mov_b64 v[8:9], 0
    v_mov_b64 v[10:11], 0
    v_mov_b64 v[12:13], 0
    v_mov_b64 v[14:15], 0
    v_mov_b64 v[16:17], 0
    v_mov_b64 v[18:19], 0
    v_mov_b64 v[20:21], 0
    v_mov_b64 v[22:23], 0
    s_branch cf_loop
cf_f1:
    s_cmp_lg_u32 s32, 1
    s_cbranch_scc1 cf_f3
    v_and_b32 v77, 255, v69
    ds_read_b128 v[4:7], v77 offset:15872
    ds_read_b128 v[40:43], v70 offset:0
    ds_read_b128 v[44:47], v70 offset:1024
    ds_read_b128 v[48:51], v70 offset:2048
    ds_read_b128 v[52:55], v70 offset:3072
    ds_read_b128 v[24:27], v70 offset:4096
    ds_read_b128 v[28:31], v70 offset:5120
    ds_read_b128 v[32:35], v70 offset:6144
    ds_read_b128 v[36:39], v70 offset:7168
    s_mov_b32 s31, 65536
    s_add_u32 s24, s24, 524288
    s_add_u32 s26, s26, 524288
    s_add_u32 s55, s55, s57
    s_cmp_lt_u32 s97, s93
    s_cselect_b32 s37, 1, 0
    s_cmp_eq_u32 s30, 63
    s_cselect_b32 s37, 1, s37
    s_mov_b32 s14, 67108864
    s_mov_b32 s15, 67112960
    s_mov_b32 s16, 67117056
    s_mov_b32 s36, 1
    v_mov_b32 v60, s69
    v_mov_b32 v56, s69
    v_and_b32 v79, 12, v75
    v_cmp_eq_u32 vcc, 0, v79
    s_nop 1
    v_cndmask_b32 v79, 0, 1, vcc
    s_nop 2
    v_mov_b32 v79, v79
    s_nop 2
    v_mov_b32 v79, v79
    s_nop 2
    v_mov_b32 v79, v79
    s_nop 2
    v_mov_b32 v79, v79
    s_nop 2
    v_mov_b32 v79, v79
    s_nop 2
    v_mov_b32 v79, v79
    s_nop 2
    v_mov_b32 v79, v79
    s_nop 2
    v_mov_b32 v79, v79
    s_nop 2
    v_mov_b32 v79, v79
    s_nop 2
    v_mov_b32 v79, v79
    s_nop 2
    v_mov_b32 v79, v79
    s_nop 2
    v_mov_b32 v79, v79
    s_nop 2
    v_mov_b32 v79, v79
    s_nop 2
    v_mov_b32 v79, v79
    s_nop 2
    v_mov_b32 v79, v79
    s_nop 2
    v_mov_b32 v79, v79
    s_waitcnt vmcnt(0)
    buffer_load_dwordx4 v[8:11], v65, s[4:7], s18 offen nt
    buffer_load_dwordx4 v[12:15], v65, s[4:7], s19 offen nt
    buffer_load_dwordx4 v[16:19], v65, s[4:7], s20 offen nt
    buffer_load_dwordx4 v[20:23], v65, s[4:7], s21 offen nt
    s_nop 2
    v_mov_b32 v79, v79
    s_nop 2
    v_mov_b32 v79, v79
    s_nop 2
    v_mov_b32 v79, v79
    s_nop 2
    v_mov_b32 v79, v79
    s_nop 2
    v_mov_b32 v79, v79
    s_nop 2
    v_mov_b32 v79, v79
    s_nop 2
    v_mov_b32 v79, v79
    s_nop 2
    v_mov_b32 v79, v79
    s_nop 2
    v_mov_b32 v79, v79
    s_nop 2
    v_mov_b32 v79, v79
    s_nop 2
    v_mov_b32 v79, v79
    s_nop 2
    v_mov_b32 v79, v79
    buffer_load_dwordx4 v[60:63], v65, s[4:7], s14 offen offset:0 nt
    buffer_load_dwordx4 v[56:59], v66, s[4:7], s14 offen offset:0 nt
    s_waitcnt lgkmcnt(0)
    s_waitcnt vmcnt(5)
    v_xor_b32 v77, s69, v8
    v_mfma_f32_16x16x32_bf16 v[0:3], v[4:7], v[8:11], 0
    s_waitcnt vmcnt(4)
    v_bitop3_b32 v77, v77, v12, s69 bitop3:0xf6
    v_mfma_f32_16x16x32_bf16 v[0:3], v[4:7], v[12:15], v[0:3]
    s_waitcnt vmcnt(3)
    v_bitop3_b32 v77, v77, v16, s69 bitop3:0xf6
    v_mfma_f32_16x16x32_bf16 v[0:3], v[4:7], v[16:19], v[0:3]
    s_waitcnt vmcnt(2)
    v_bitop3_b32 v77, v77, v20, s69 bitop3:0xf6
    v_mfma_f32_16x16x32_bf16 v[0:3], v[4:7], v[20:23], v[0:3]
    v_and_b32 v77, 1, v77
    v_cmp_ne_u32 vcc, 0, v77
    buffer_load_dwordx4 v[60:63], v65, s[4:7], s14 offen offset:0 nt
    buffer_load_dwordx4 v[56:59], v66, s[4:7], s14 offen offset:0 nt
    s_cmp_eq_u64 vcc, 0
    s_cselect_b64 s[42:43], -1, 0
    s_nop 1
    v_add_f32_dpp v0, v0, v0 row_ror:8 row_mask:0xf bank_mask:0xf
    v_add_f32_dpp v1, v1, v1 row_ror:8 row_mask:0xf bank_mask:0xf
    s_mov_b64 exec, s[42:43]
    v_cvt_pk_bf16_f32 v72, v0, v1
    v_bfi_b32 v72, v79, s70, v72
    buffer_store_dword v72, v75, s[4:7], s17 offen offset:0
    s_mov_b64 exec, -1
    s_cbranch_scc0 cf_f1_retry
cf_f1_go:
    v_mov_b64 v[0:1], 0
    v_mov_b64 v[2:3], 0
    v_mov_b64 v[4:5], 0
    v_mov_b64 v[6:7], 0
    v_mov_b64 v[8:9], 0
    v_mov_b64 v[10:11], 0
    v_mov_b64 v[12:13], 0
    v_mov_b64 v[14:15], 0
    v_mov_b64 v[16:17], 0
    v_mov_b64 v[18:19], 0
    v_mov_b64 v[20:21], 0
    v_mov_b64 v[22:23], 0
    s_branch cf_loop
cf_f3:
    v_and_b32 v77, 255, v69
    ds_read_b128 v[4:7], v77 offset:15872
    ds_read_b128 v[40:43], v70 offset:0
    ds_read_b128 v[44:47], v70 offset:1024
    ds_read_b128 v[48:51], v70 offset:2048
    ds_read_b128 v[52:55], v70 offset:3072
    ds_read_b128 v[24:27], v70 offset:4096
    ds_read_b128 v[28:31], v70 offset:5120
    ds_read_b128 v[32:35], v70 offset:6144
    ds_read_b128 v[36:39], v70 offset:7168
    s_mov_b32 s31, 65536
    s_add_u32 s24, s24, 524288
    s_add_u32 s26, s26, 524288
    s_add_u32 s55, s55, s57
    s_cmp_lt_u32 s97, s93
    s_cselect_b32 s37, 1, 0
    s_cmp_eq_u32 s30, 63
    s_cselect_b32 s37, 1, s37
    s_mov_b32 s14, 67108864
    s_mov_b32 s15, 67112960
    s_mov_b32 s16, 67117056
    s_mov_b32 s36, 1
    v_mov_b32 v60, s69
    v_mov_b32 v56, s69
    v_and_b32 v79, 12, v75
    v_cmp_eq_u32 vcc, 0, v79
    s_nop 1
    v_cndmask_b32 v79, 0, 1, vcc
    v_add_u32 v72, 1, v72
    s_waitcnt lgkmcnt(0)
    v_mov_b64 v[0:1], 0
    v_mov_b64 v[2:3], 0
    v_mov_b64 v[4:5], 0
    v_mov_b64 v[6:7], 0
    v_mov_b64 v[8:9], 0
    v_mov_b64 v[10:11], 0
    v_mov_b64 v[12:13], 0
    v_mov_b64 v[14:15], 0
    v_mov_b64 v[16:17], 0
    v_mov_b64 v[18:19], 0
    v_mov_b64 v[20:21], 0
    v_mov_b64 v[22:23], 0
    s_nop 2
    v_mov_b32 v79, v79
    s_nop 2
    v_mov_b32 v79, v79
    s_nop 2
    v_mov_b32 v79, v79
    s_nop 2
    v_mov_b32 v79, v79
    s_nop 2
    v_mov_b32 v79, v79
    s_nop 2
    v_mov_b32 v79, v79
    s_nop 2
    v_mov_b32 v79, v79
    s_nop 2
    v_mov_b32 v79, v79
    s_nop 2
    v_mov_b32 v79, v79
    s_nop 2
    v_mov_b32 v79, v79
    s_nop 2
    v_mov_b32 v79, v79
    s_nop 2
    v_mov_b32 v79, v79
    s_nop 2
    v_mov_b32 v79, v79
    s_nop 2
    v_mov_b32 v79, v79
    s_nop 2
    v_mov_b32 v79, v79
    s_nop 2
    v_mov_b32 v79, v79
    s_nop 2
    v_mov_b32 v79, v79
    s_nop 2
    v_mov_b32 v79, v79
    s_nop 2
    v_mov_b32 v79, v79
    s_nop 2
    v_mov_b32 v79, v79
    s_nop 2
    v_mov_b32 v79, v79
    s_nop 2
    v_mov_b32 v79, v79
    s_nop 2
    v_mov_b32 v79, v79
    s_nop 2
    v_mov_b32 v79, v79
    s_nop 2
    v_mov_b32 v79, v79
    s_nop 2
    v_mov_b32 v79, v79
    s_waitcnt vmcnt(0)
    s_branch cf_loop
cf_f0_retry:
cf_f0_spin:
    buffer_load_dwordx4 v[8:11], v65, s[4:7], s18 offen nt
    buffer_load_dwordx4 v[12:15], v65, s[4:7], s19 offen nt
    buffer_load_dwordx4 v[16:19], v65, s[4:7], s20 offen nt
    buffer_load_dwordx4 v[20:23], v65, s[4:7], s21 offen nt
    s_nop 2
    v_mov_b32 v79, v79
    s_nop 2
    v_mov_b32 v79, v79
    s_nop 2
    v_mov_b32 v79, v79
    s_nop 2
    v_mov_b32 v79, v79
    s_nop 2
    v_mov_b32 v79, v79
    s_nop 2
    v_mov_b32 v79, v79
    buffer_load_dwordx4 v[60:63], v65, s[4:7], s14 offen offset:0 nt
    buffer_load_dwordx4 v[56:59], v66, s[4:7], s14 offen offset:0 nt
    s_waitcnt vmcnt(5)
    v_xor_b32 v77, s69, v8
    v_mfma_f32_16x16x32_bf16 v[0:3], v[4:7], v[8:11], 0
    s_waitcnt vmcnt(4)
    v_bitop3_b32 v77, v77, v12, s69 bitop3:0xf6
    v_mfma_f32_16x16x32_bf16 v[0:3], v[4:7], v[12:15], v[0:3]
    s_waitcnt vmcnt(3)
    v_bitop3_b32 v77, v77, v16, s69 bitop3:0xf6
    v_mfma_f32_16x16x32_bf16 v[0:3], v[4:7], v[16:19], v[0:3]
    s_waitcnt vmcnt(2)
    v_bitop3_b32 v77, v77, v20, s69 bitop3:0xf6
    v_mfma_f32_16x16x32_bf16 v[0:3], v[4:7], v[20:23], v[0:3]
    v_and_b32 v77, 1, v77
    v_cmp_ne_u32 vcc, 0, v77
    buffer_load_dwordx4 v[60:63], v65, s[4:7], s14 offen offset:0 nt
    buffer_load_dwordx4 v[56:59], v66, s[4:7], s14 offen offset:0 nt
    s_cmp_eq_u64 vcc, 0
    s_cselect_b64 s[42:43], -1, 0
    s_nop 1
    v_add_f32_dpp v0, v0, v0 row_ror:8 row_mask:0xf bank_mask:0xf
    v_add_f32_dpp v1, v1, v1 row_ror:8 row_mask:0xf bank_mask:0xf
    s_mov_b64 exec, s[42:43]
    v_cvt_pk_bf16_f32 v72, v0, v1
    v_bfi_b32 v72, v79, s70, v72
    buffer_store_dword v72, v75, s[4:7], s17 offen offset:0
    s_mov_b64 exec, -1
    s_cbranch_scc1 cf_f0_rx
    s_sub_u32 s31, s31, 1
    s_cbranch_scc0 cf_f0_spin
cf_f0_rx:
    v_mov_b64 v[0:1], 0
    v_mov_b64 v[2:3], 0
    v_mov_b64 v[4:5], 0
    v_mov_b64 v[6:7], 0
    v_mov_b64 v[8:9], 0
    v_mov_b64 v[10:11], 0
    v_mov_b64 v[12:13], 0
    v_mov_b64 v[14:15], 0
    v_mov_b64 v[16:17], 0
    v_mov_b64 v[18:19], 0
    v_mov_b64 v[20:21], 0
    v_mov_b64 v[22:23], 0
    s_branch cf_loop
cf_f1_retry:
cf_f1_spin:
    s_nop 0
    buffer_load_dwordx4 v[8:11], v65, s[4:7], s18 offen nt
    buffer_load_dwordx4 v[12:15], v65, s[4:7], s19 offen nt
    buffer_load_dwordx4 v[16:19], v65, s[4:7], s20 offen nt
    buffer_load_dwordx4 v[20:23], v65, s[4:7], s21 offen nt
    s_nop 2
    v_mov_b32 v79, v79
    s_nop 2
    v_mov_b32 v79, v79
    s_nop 2
    v_mov_b32 v79, v79
    s_nop 2
    v_mov_b32 v79, v79
    s_nop 2
    v_mov_b32 v79, v79
    s_nop 2
    v_mov_b32 v79, v79
    buffer_load_dwordx4 v[60:63], v65, s[4:7], s14 offen offset:0 nt
    buffer_load_dwordx4 v[56:59], v66, s[4:7], s14 offen offset:0 nt
    s_waitcnt vmcnt(5)
    v_xor_b32 v77, s69, v8
    v_mfma_f32_16x16x32_bf16 v[0:3], v[4:7], v[8:11], 0
    s_waitcnt vmcnt(4)
    v_bitop3_b32 v77, v77, v12, s69 bitop3:0xf6
    v_mfma_f32_16x16x32_bf16 v[0:3], v[4:7], v[12:15], v[0:3]
    s_waitcnt vmcnt(3)
    v_bitop3_b32 v77, v77, v16, s69 bitop3:0xf6
    v_mfma_f32_16x16x32_bf16 v[0:3], v[4:7], v[16:19], v[0:3]
    s_waitcnt vmcnt(2)
    v_bitop3_b32 v77, v77, v20, s69 bitop3:0xf6
    v_mfma_f32_16x16x32_bf16 v[0:3], v[4:7], v[20:23], v[0:3]
    v_and_b32 v77, 1, v77
    v_cmp_ne_u32 vcc, 0, v77
    buffer_load_dwordx4 v[60:63], v65, s[4:7], s14 offen offset:0 nt
    buffer_load_dwordx4 v[56:59], v66, s[4:7], s14 offen offset:0 nt
    s_cmp_eq_u64 vcc, 0
    s_cselect_b64 s[42:43], -1, 0
    s_nop 1
    v_add_f32_dpp v0, v0, v0 row_ror:8 row_mask:0xf bank_mask:0xf
    v_add_f32_dpp v1, v1, v1 row_ror:8 row_mask:0xf bank_mask:0xf
    s_mov_b64 exec, s[42:43]
    v_cvt_pk_bf16_f32 v72, v0, v1
    v_bfi_b32 v72, v79, s70, v72
    buffer_store_dword v72, v75, s[4:7], s17 offen offset:0
    s_mov_b64 exec, -1
    s_cbranch_scc1 cf_f1_rx
    s_sub_u32 s31, s31, 1
    s_cbranch_scc0 cf_f1_spin
cf_f1_rx:
    v_mov_b64 v[0:1], 0
    v_mov_b64 v[2:3], 0
    v_mov_b64 v[4:5], 0
    v_mov_b64 v[6:7], 0
    v_mov_b64 v[8:9], 0
    v_mov_b64 v[10:11], 0
    v_mov_b64 v[12:13], 0
    v_mov_b64 v[14:15], 0
    v_mov_b64 v[16:17], 0
    v_mov_b64 v[18:19], 0
    v_mov_b64 v[20:21], 0
    v_mov_b64 v[22:23], 0
    s_branch cf_loop
cf_f2_retry:
cf_f2_spin:
    s_nop 0
    buffer_load_dwordx4 v[8:11], v65, s[4:7], s18 offen nt
    buffer_load_dwordx4 v[12:15], v65, s[4:7], s19 offen nt
    buffer_load_dwordx4 v[16:19], v65, s[4:7], s20 offen nt
    buffer_load_dwordx4 v[20:23], v65, s[4:7], s21 offen nt
    s_nop 2
    v_mov_b32 v79, v79
    s_nop 2
    v_mov_b32 v79, v79
    s_nop 2
    v_mov_b32 v79, v79
    s_nop 2
    v_mov_b32 v79, v79
    s_nop 2
    v_mov_b32 v79, v79
    s_nop 2
    v_mov_b32 v79, v79
    buffer_load_dwordx4 v[60:63], v65, s[4:7], s14 offen offset:0 nt
    buffer_load_dwordx4 v[56:59], v66, s[4:7], s14 offen offset:0 nt
    s_waitcnt vmcnt(5)
    v_xor_b32 v77, s69, v8
    v_bitop3_b32 v77, v77, v10, s69 bitop3:0xf6
    v_mfma_f32_16x16x32_bf16 v[0:3], v[4:7], v[8:11], 0
    s_waitcnt vmcnt(4)
    v_bitop3_b32 v77, v77, v12, s69 bitop3:0xf6
    v_bitop3_b32 v77, v77, v14, s69 bitop3:0xf6
    v_mfma_f32_16x16x32_bf16 v[0:3], v[4:7], v[12:15], v[0:3]
    s_waitcnt vmcnt(3)
    v_bitop3_b32 v77, v77, v16, s69 bitop3:0xf6
    v_bitop3_b32 v77, v77, v18, s69 bitop3:0xf6
    v_mfma_f32_16x16x32_bf16 v[0:3], v[4:7], v[16:19], v[0:3]
    s_waitcnt vmcnt(2)
    v_bitop3_b32 v77, v77, v20, s69 bitop3:0xf6
    v_bitop3_b32 v77, v77, v22, s69 bitop3:0xf6
    v_mfma_f32_16x16x32_bf16 v[0:3], v[4:7], v[20:23], v[0:3]
    v_and_b32 v77, 1, v77
    v_cmp_ne_u32 vcc, 0, v77
    buffer_load_dwordx4 v[60:63], v65, s[4:7], s14 offen offset:0 nt
    buffer_load_dwordx4 v[56:59], v66, s[4:7], s14 offen offset:0 nt
    s_cmp_eq_u64 vcc, 0
    s_cselect_b64 s[42:43], -1, 0
    s_nop 1
    v_add_f32 v2, v0, v1
    s_nop 1
    v_add_f32_dpp v2, v2, v2 row_ror:8 row_mask:0xf bank_mask:0xf
    s_nop 1
    v_mov_b32_dpp v0, v2 quad_perm:[0,0,2,2] row_mask:0xf bank_mask:0xf
    v_mov_b32_dpp v1, v2 quad_perm:[1,1,3,3] row_mask:0xf bank_mask:0xf
    s_mov_b64 exec, s[42:43]
    v_cvt_pk_bf16_f32 v72, v0, v1
    v_bfi_b32 v72, v79, s70, v72
    buffer_store_dword v72, v75, s[4:7], s17 offen offset:0
    buffer_store_dword v72, v75, s[4:7], s17 offen offset:1024
    buffer_store_dword v72, v75, s[4:7], s17 offen offset:2048
    buffer_store_dword v72, v75, s[4:7], s17 offen offset:3072
    s_mov_b64 exec, -1
    s_cbranch_scc1 cf_f2_rx
    s_sub_u32 s31, s31, 1
    s_cbranch_scc0 cf_f2_spin
cf_f2_rx:
    v_mov_b64 v[0:1], 0
    v_mov_b64 v[2:3], 0
    v_mov_b64 v[4:5], 0
    v_mov_b64 v[6:7], 0
    v_mov_b64 v[8:9], 0
    v_mov_b64 v[10:11], 0
    v_mov_b64 v[12:13], 0
    v_mov_b64 v[14:15], 0
    v_mov_b64 v[16:17], 0
    v_mov_b64 v[18:19], 0
    v_mov_b64 v[20:21], 0
    v_mov_b64 v[22:23], 0
    s_branch cf_loop
cf_spinB:
    buffer_load_dwordx4 v[40:43], v65, s[4:7], s15 offen nt
cf_spinB_l:
    v_and_b32 v77, s36, v40
    v_cmp_ne_u32 vcc, s70, v77
    s_cbranch_vccz cf_spinB_x
    s_nop 1
    v_and_b32 v77, s36, v40
    v_cmp_ne_u32 vcc, s70, v77
    s_cbranch_vccz cf_spinB_x
    s_nop 1
    v_and_b32 v77, s36, v40
    v_cmp_ne_u32 vcc, s70, v77
    s_cbranch_vccz cf_spinB_x
    s_nop 1
    buffer_load_dwordx4 v[40:43], v65, s[4:7], s15 offen nt
    s_sub_u32 s31, s31, 16
    s_cbranch_scc0 cf_spinB_l
cf_spinB_x:
    ds_write_b128 v65, v[40:43] offset:4096
    s_waitcnt lgkmcnt(0)
    s_branch cf_backB
cf_spin8:
    buffer_load_dwordx4 v[60:63], v65, s[4:7], s16 offen nt
cf_spin8_l:
    v_and_b32 v77, s36, v60
    v_cmp_ne_u32 vcc, s70, v77
    s_cbranch_vccz cf_spin8_x
    s_nop 1
    v_and_b32 v77, s36, v60
    v_cmp_ne_u32 vcc, s70, v77
    s_cbranch_vccz cf_spin8_x
    s_nop 1
    v_and_b32 v77, s36, v60
    v_cmp_ne_u32 vcc, s70, v77
    s_cbranch_vccz cf_spin8_x
    s_nop 1
    buffer_load_dwordx4 v[60:63], v65, s[4:7], s16 offen nt
    s_sub_u32 s31, s31, 16
    s_cbranch_scc0 cf_spin8_l
cf_spin8_x:
    s_branch cf_back8
cf_pubk:
    s_mov_b64 exec, s[34:35]
    buffer_store_dwordx4 v[0:3], v65, s[4:7], s28 offen sc1
    s_mov_b64 exec, -1
    s_add_u32 s28, s28, 131072
    s_branch cf_pubk_x
cf_pubv:
    buffer_store_dwordx4 v[38:41], v65, s[4:7], s27 offen sc1
    s_add_u32 s27, s27, 131072
    s_branch cf_pubv_x
cf_rare:
    s_cmp_eq_u32 s30, 63
    s_cbranch_scc1 cf_last
    v_bfe_u32 v78, v65, 2, 8
    s_mov_b64 exec, 0xffff
    buffer_load_dword v78, s[4:7], s96 offen sc1 lds
    s_mov_b64 exec, -1
    s_branch cf_rare_x
cf_kvwait:
    v_bfe_u32 v78, v65, 2, 5
    ds_read_b32 v77, v78 offset:16144
    s_waitcnt lgkmcnt(0)
    v_subrev_u32 v77, s95, v77
    v_cmp_lt_u32 vcc, 16, v77
    s_nop 1
    v_cndmask_b32 v77, v77, 0, vcc
    v_bfe_u32 v79, v78, 2, 2
    v_lshl_add_u32 v77, v77, 2, v79
    s_nop 1
    v_min_u32_dpp v77, v77, v77 row_ror:1 row_mask:0xf bank_mask:0xf
    s_nop 1
    v_min_u32_dpp v77, v77, v77 row_ror:2 row_mask:0xf bank_mask:0xf
    s_nop 1
    v_min_u32_dpp v77, v77, v77 row_ror:4 row_mask:0xf bank_mask:0xf
    s_nop 0
    v_readfirstlane_b32 s97, v77
    s_nop 0
    s_cmp_le_u32 s40, s97
    s_cbranch_scc1 cf_kvw_x
    v_bfe_u32 v78, v65, 2, 5
    s_mov_b32 s31, 4194304
cf_kvw:
    buffer_load_dword v77, v78, s[4:7], s96 offen offset:16 sc1
    s_waitcnt vmcnt(0)
    v_subrev_u32 v77, s95, v77
    v_cmp_lt_u32 vcc, 16, v77
    s_nop 1
    v_cndmask_b32 v77, v77, 0, vcc
    v_bfe_u32 v79, v78, 2, 2
    v_lshl_add_u32 v77, v77, 2, v79
    s_nop 1
    v_min_u32_dpp v77, v77, v77 row_ror:1 row_mask:0xf bank_mask:0xf
    s_nop 1
    v_min_u32_dpp v77, v77, v77 row_ror:2 row_mask:0xf bank_mask:0xf
    s_nop 1
    v_min_u32_dpp v77, v77, v77 row_ror:4 row_mask:0xf bank_mask:0xf
    s_nop 0
    v_readfirstlane_b32 s97, v77
    s_sub_u32 s31, s31, 1
    s_cbranch_scc1 cf_kvw_x
    s_cmp_le_u32 s40, s97
    s_cbranch_scc1 cf_kvw_x
    s_sleep 2
    s_branch cf_kvw
cf_kvw_x:
    s_branch cf_kvok
cf_last:
    s_nop 7
    v_cvt_pk_bf16_f32 v38, v16, v17
    v_cvt_pk_bf16_f32 v39, v18, v19
    v_cvt_pk_bf16_f32 v40, v20, v21
    v_cvt_pk_bf16_f32 v41, v22, v23
    buffer_store_dwordx4 v[38:41], v65, s[4:7], s27 offen sc1
    s_add_u32 s40, s95, 64
    v_mov_b32 v78, s40
    s_waitcnt vmcnt(0)
    s_barrier
    s_mov_b64 exec, s[100:101]
    buffer_store_dword v78, off, s[4:7], s29 sc1
    s_mov_b64 exec, -1
cf_end:
    s_endpgm
L_chain_safe:
    s_load_dwordx8 s[48:55], s[0:1], 8
    s_load_dwordx2 s[56:57], s[0:1], 40
    s_waitcnt lgkmcnt(0)
    v_lshrrev_b32 v77, 6, v0
    s_nop 0
    v_readfirstlane_b32 s13, v77
    v_lshlrev_b32 v65, 4, v0
    v_and_b32 v48, 63, v0
    s_mov_b32 s10, 4718592
    s_mov_b32 s11, 0x20000
    v_lshrrev_b32 v49, 3, v48
    v_mul_u32_u24 v18, 1152, v49
    v_and_b32 v49, 7, v48
    v_lshl_add_u32 v18, v49, 4, v18
    s_mul_i32 s40, s12, 147456
    s_mul_i32 s41, s13, 288
    s_add_u32 s40, s40, s41
    s_xor_b32 s41, s13, 0
    s_mul_i32 s41, s41, 36864
    s_add_u32 s60, s41, s40
    s_xor_b32 s41, s13, 1
    s_mul_i32 s41, s41, 36864
    s_add_u32 s61, s41, s40
    s_xor_b32 s41, s13, 2
    s_mul_i32 s41, s41, 36864
    s_add_u32 s62, s41, s40
    s_xor_b32 s41, s13, 3
    s_mul_i32 s41, s41, 36864
    s_add_u32 s63, s41, s40
    s_lshl_b32 s43, s13, 12
    s_mov_b64 s[8:9], s[56:57]
    s_add_u32 m0, s43, 0
    s_add_u32 s41, s60, 0
    buffer_load_dwordx4 v18, s[8:11], s41 offen offset:0 lds
    s_add_u32 s41, s60, 8192
    buffer_load_dwordx4 v18, s[8:11], s41 offen offset:1024 lds
    s_add_u32 s41, s60, 16384
    buffer_load_dwordx4 v18, s[8:11], s41 offen offset:2048 lds
    s_add_u32 s41, s60, 24576
    buffer_load_dwordx4 v18, s[8:11], s41 offen offset:3072 lds
    s_add_u32 m0, s43, 36864
    s_add_u32 s41, s61, 0
    buffer_load_dwordx4 v18, s[8:11], s41 offen offset:0 lds
    s_add_u32 s41, s61, 8192
    buffer_load_dwordx4 v18, s[8:11], s41 offen offset:1024 lds
    s_add_u32 s41, s61, 16384
    buffer_load_dwordx4 v18, s[8:11], s41 offen offset:2048 lds
    s_add_u32 s41, s61, 24576
    buffer_load_dwordx4 v18, s[8:11], s41 offen offset:3072 lds
    s_add_u32 m0, s43, 73728
    s_add_u32 s41, s62, 0
    buffer_load_dwordx4 v18, s[8:11], s41 offen offset:0 lds
    s_add_u32 s41, s62, 8192
    buffer_load_dwordx4 v18, s[8:11], s41 offen offset:1024 lds
    s_add_u32 s41, s62, 16384
    buffer_load_dwordx4 v18, s[8:11], s41 offen offset:2048 lds
    s_add_u32 s41, s62, 24576
    buffer_load_dwordx4 v18, s[8:11], s41 offen offset:3072 lds
    s_add_u32 m0, s43, 110592
    s_add_u32 s41, s63, 0
    buffer_load_dwordx4 v18, s[8:11], s41 offen offset:0 lds
    s_add_u32 s41, s63, 8192
    buffer_load_dwordx4 v18, s[8:11], s41 offen offset:1024 lds
    s_add_u32 s41, s63, 16384
    buffer_load_dwordx4 v18, s[8:11], s41 offen offset:2048 lds
    s_add_u32 s41, s63, 24576
    buffer_load_dwordx4 v18, s[8:11], s41 offen offset:3072 lds
    v_lshrrev_b32 v49, 1, v48
    v_mul_u32_u24 v19, 1152, v49
    v_and_b32 v49, 1, v48
    v_lshl_add_u32 v19, v49, 4, v19
    v_lshrrev_b32 v49, 4, v48
    v_lshlrev_b32 v50, 2, v49
    v_and_b32 v51, 15, v48
    v_xor_b32 v51, v51, v50
    v_lshlrev_b32 v51, 4, v51
    v_lshl_add_u32 v16, v49, 15, v51
    v_lshrrev_b32 v50, 1, v49
    v_lshl_add_u32 v17, v50, 16, v51
    v_and_b32 v50, 1, v49
    v_lshl_add_u32 v17, v50, 13, v17
    s_lshl_b32 s40, s12, 8
    s_mul_i32 s58, s13, 1179648
    s_add_u32 s58, s58, s40
    s_lshr_b32 s41, s13, 1
    s_mul_i32 s59, s41, 2359296
    s_and_b32 s41, s13, 1
    s_lshl_b32 s41, s41, 14
    s_add_u32 s59, s59, s41
    s_add_u32 s59, s59, s40
    s_add_u32 s59, s59, 1048576
    v_bfe_u32 v50, v48, 2, 2
    v_xor_b32 v51, s13, v50
    v_lshlrev_b32 v20, 6, v51
    v_and_b32 v51, 3, v48
    v_lshl_add_u32 v20, v51, 4, v20
    v_lshrrev_b32 v23, 2, v48
    v_lshl_add_u32 v20, v23, 8, v20
    s_xor_b32 s41, s43, 0
    v_add_u32 v24, s41, v20
    s_xor_b32 s41, s43, 4096
    v_add_u32 v25, s41, v20
    s_xor_b32 s41, s43, 8192
    v_add_u32 v26, s41, v20
    s_xor_b32 s41, s43, 12288
    v_add_u32 v27, s41, v20
    v_and_b32 v23, 1, v50
    v_lshl_add_u32 v23, v49, 2, v23
    v_lshrrev_b32 v50, 1, v50
    v_lshlrev_b32 v21, 7, v23
    v_lshl_add_u32 v21, v50, 6, v21
    v_lshl_add_u32 v21, v51, 4, v21
    v_add_u32 v21, s43, v21
    v_lshlrev_b32 v22, 9, v50
    v_xor_b32 v22, v22, v21
    v_lshlrev_b32 v23, 5, v23
    v_lshl_add_u32 v23, v50, 10, v23
    v_lshl_add_u32 v23, v51, 3, v23
    v_add_u32 v23, s43, v23
    v_bfe_u32 v60, v65, 4, 6
    v_and_b32 v61, 15, v60
    v_lshrrev_b32 v62, 4, v60
    v_mov_b32 v64, 0x4444
    v_mov_b32 v77, 0xeeee
    v_cmp_lt_u32 vcc, 7, v61
    s_nop 1
    v_cndmask_b32 v64, v64, v77, vcc
    v_xor_b32 v66, 1024, v65
    v_xor_b32 v67, 2048, v65
    v_xor_b32 v68, 3072, v65
    v_and_b32 v69, 511, v65
    s_mul_i32 s96, s13, 36864
    s_add_u32 s96, s96, 16384
    v_lshlrev_b32 v70, 4, v60
    v_add_u32 v70, s96, v70
    v_lshrrev_b32 v79, 1, v69
    s_lshl_b32 s96, s13, 8
    s_add_u32 s96, s96, 14336
    s_lshl_b32 s33, s13, 10
    s_add_u32 s97, s33, 8192
    v_mov_b32 v77, s97
    v_mov_b32 v78, s96
    v_cmp_lt_u32 vcc, 31, v60
    s_nop 1
    v_cndmask_b32 v71, v77, v78, vcc
    v_add_u32 v71, v71, v79
    v_and_b32 v77, 7, v61
    v_lshrrev_b32 v78, 3, v61
    v_lshlrev_b32 v74, 4, v77
    v_lshl_add_u32 v73, v62, 7, v74
    v_lshl_add_u32 v73, v78, 3, v73
    s_lshl_b32 s96, s13, 9
    v_add_u32 v73, s96, v73
    v_lshl_add_u32 v74, v78, 14, v74
    v_lshl_add_u32 v74, v62, 15, v74
    s_lshl_b32 s96, s13, 17
    v_add_u32 v74, s96, v74
    v_bfe_u32 v77, v61, 2, 1
    v_and_b32 v78, 3, v61
    v_bfe_u32 v79, v61, 1, 2
    s_cmp_lt_u32 s13, 2
    s_cselect_b64 vcc, -1, 0
    v_cndmask_b32 v77, 0, v77, vcc
    v_cndmask_b32 v78, v79, v78, vcc
    v_lshlrev_b32 v75, 7, v77
    v_lshl_add_u32 v75, v62, 4, v75
    v_lshl_add_u32 v75, v78, 2, v75
    v_lshl_add_u32 v58, v77, 3, v78
    v_lshlrev_b32 v79, 1, v78
    v_cndmask_b32 v58, v79, v58, vcc
    s_bfe_u32 s97, s12, 0x10001
    s_lshl_b32 s68, s97, 6
    s_lshl_b32 s97, s97, 2
    v_add_u32 v59, s97, v62
    s_bfe_u32 s96, s12, 0x10002
    s_and_b32 s40, s12, 1
    s_lshl_b32 s96, s96, 1
    s_add_u32 s96, s96, s40
    s_lshr_b32 s97, s12, 3
    s_lshl_b32 s98, s13, 2
    s_add_u32 s98, s98, s97
    s_lshl_b32 s98, s98, 2
    s_add_u32 s98, s98, s96
    s_lshl_b32 s98, s98, 8
    s_lshl_b32 s99, s13, 2
    s_add_u32 s99, s99, s96
    s_lshl_b32 s99, s99, 4
    s_lshl_b32 s41, s97, 1
    s_add_u32 s41, s41, s40
    s_lshl_b32 s41, s41, 7
    s_add_u32 s41, s41, 8192
    s_lshl_b32 s40, s40, 3
    s_add_u32 s40, s40, 128
    s_cmp_lt_u32 s13, 2
    s_cselect_b32 s98, s98, s41
    s_cselect_b32 s99, s99, s40
    s_cselect_b32 s32, 1, 0
    s_add_u32 s68, s68, s98
    s_mul_i32 s97, s97, 144
    s_add_u32 s99, s99, s97
    v_add_u32 v58, s99, v58
    s_and_b32 s97, s12, 4
    s_or_b32 s97, s97, s13
    s_cmp_eq_u32 s97, 2
    s_cselect_b32 s32, 2, s32
    s_mov_b32 s8, s48
    s_mov_b32 s9, s49
    s_mov_b32 s10, 9216
    s_cmp_lt_u32 s13, 2
    s_cselect_b32 s96, 8, 2
    v_mul_u32_u24 v77, 1152, v59
    v_lshl_add_u32 v77, v58, 1, v77
    buffer_load_ushort v72, v77, s[8:11], 0 offen
    buffer_load_ushort v76, v77, s[8:11], s96 offen
    s_mov_b32 s10, 4718592
    v_mov_b32 v78, v21
    v_mov_b32 v79, v22
    s_waitcnt vmcnt(12) lgkmcnt(0)
    s_barrier
    s_mov_b64 s[8:9], s[56:57]
    s_add_u32 m0, s43, 147456
    s_add_u32 m0, s43, 147200
    s_nop 0
    buffer_load_dwordx4 v19, s[8:11], s60 offen offset:256 lds
    s_add_u32 m0, s43, 148224
    s_nop 0
    buffer_load_dwordx4 v19, s[8:11], s61 offen offset:256 lds
    s_add_u32 m0, s43, 149248
    s_nop 0
    buffer_load_dwordx4 v19, s[8:11], s62 offen offset:256 lds
    s_add_u32 m0, s43, 150272
    s_nop 0
    buffer_load_dwordx4 v19, s[8:11], s63 offen offset:256 lds
    v_add_u32 v77, 0, v79
    ds_read_b64_tr_b16 v[80:81], v77 offset:0
    ds_read_b64_tr_b16 v[82:83], v77 offset:256
    ds_read_b64_tr_b16 v[84:85], v77 offset:2048
    ds_read_b64_tr_b16 v[86:87], v77 offset:2304
    ds_read_b64_tr_b16 v[112:113], v77 offset:8
    ds_read_b64_tr_b16 v[114:115], v77 offset:264
    ds_read_b64_tr_b16 v[116:117], v77 offset:2056
    ds_read_b64_tr_b16 v[118:119], v77 offset:2312
    s_waitcnt vmcnt(12) lgkmcnt(0)
    s_barrier
    s_mov_b64 s[8:9], s[52:53]
    s_add_u32 m0, s43, 0
    s_add_u32 s41, s58, 0
    buffer_load_dwordx4 v16, s[8:11], s41 offen offset:0 lds
    s_add_u32 s41, s58, 15360
    buffer_load_dwordx4 v16, s[8:11], s41 offen offset:1024 lds
    s_add_u32 s41, s58, 129024
    buffer_load_dwordx4 v16, s[8:11], s41 offen offset:2048 lds
    s_add_u32 s41, s58, 144384
    buffer_load_dwordx4 v16, s[8:11], s41 offen offset:3072 lds
    v_add_u32 v77, 36864, v78
    ds_read_b64_tr_b16 v[88:89], v77 offset:0
    ds_read_b64_tr_b16 v[90:91], v77 offset:256
    ds_read_b64_tr_b16 v[92:93], v77 offset:2048
    ds_read_b64_tr_b16 v[94:95], v77 offset:2304
    ds_read_b64_tr_b16 v[120:121], v77 offset:8
    ds_read_b64_tr_b16 v[122:123], v77 offset:264
    ds_read_b64_tr_b16 v[124:125], v77 offset:2056
    ds_read_b64_tr_b16 v[126:127], v77 offset:2312
    s_waitcnt vmcnt(12) lgkmcnt(0)
    s_barrier
    s_add_u32 m0, s43, 36864
    s_add_u32 s41, s58, 8192
    buffer_load_dwordx4 v16, s[8:11], s41 offen offset:0 lds
    s_add_u32 s41, s58, 23552
    buffer_load_dwordx4 v16, s[8:11], s41 offen offset:1024 lds
    s_add_u32 s41, s58, 137216
    buffer_load_dwordx4 v16, s[8:11], s41 offen offset:2048 lds
    s_add_u32 s41, s58, 152576
    buffer_load_dwordx4 v16, s[8:11], s41 offen offset:3072 lds
    v_add_u32 v77, 73728, v78
    ds_read_b64_tr_b16 v[96:97], v77 offset:0
    ds_read_b64_tr_b16 v[98:99], v77 offset:256
    ds_read_b64_tr_b16 v[100:101], v77 offset:2048
    ds_read_b64_tr_b16 v[102:103], v77 offset:2304
    ds_read_b64_tr_b16 v[128:129], v77 offset:8
    ds_read_b64_tr_b16 v[130:131], v77 offset:264
    ds_read_b64_tr_b16 v[132:133], v77 offset:2056
    ds_read_b64_tr_b16 v[134:135], v77 offset:2312
    s_waitcnt vmcnt(12) lgkmcnt(0)
    s_barrier
    s_add_u32 m0, s43, 73728
    s_add_u32 s41, s58, 262144
    buffer_load_dwordx4 v16, s[8:11], s41 offen offset:0 lds
    s_add_u32 s41, s58, 277504
    buffer_load_dwordx4 v16, s[8:11], s41 offen offset:1024 lds
    s_add_u32 s41, s58, 391168
    buffer_load_dwordx4 v16, s[8:11], s41 offen offset:2048 lds
    s_add_u32 s41, s58, 406528
    buffer_load_dwordx4 v16, s[8:11], s41 offen offset:3072 lds
    v_add_u32 v77, 110592, v78
    ds_read_b64_tr_b16 v[104:105], v77 offset:0
    ds_read_b64_tr_b16 v[106:107], v77 offset:256
    ds_read_b64_tr_b16 v[108:109], v77 offset:2048
    ds_read_b64_tr_b16 v[110:111], v77 offset:2304
    ds_read_b64_tr_b16 v[136:137], v77 offset:8
    ds_read_b64_tr_b16 v[138:139], v77 offset:264
    ds_read_b64_tr_b16 v[140:141], v77 offset:2056
    ds_read_b64_tr_b16 v[142:143], v77 offset:2312
    s_waitcnt vmcnt(12) lgkmcnt(0)
    s_barrier
    s_add_u32 m0, s43, 110592
    s_add_u32 s41, s58, 270336
    buffer_load_dwordx4 v16, s[8:11], s41 offen offset:0 lds
    s_add_u32 s41, s58, 285696
    buffer_load_dwordx4 v16, s[8:11], s41 offen offset:1024 lds
    s_add_u32 s41, s58, 399360
    buffer_load_dwordx4 v16, s[8:11], s41 offen offset:2048 lds
    s_add_u32 s41, s58, 414720
    buffer_load_dwordx4 v16, s[8:11], s41 offen offset:3072 lds
    v_add_u32 v77, 147456, v23
    ds_read_b64_tr_b16 v[144:145], v77 offset:0
    ds_read_b64_tr_b16 v[146:147], v77 offset:64
    ds_read_b64_tr_b16 v[148:149], v77 offset:512
    ds_read_b64_tr_b16 v[150:151], v77 offset:576
    ds_read_b64_tr_b16 v[152:153], v77 offset:2048
    ds_read_b64_tr_b16 v[154:155], v77 offset:2112
    ds_read_b64_tr_b16 v[156:157], v77 offset:2560
    ds_read_b64_tr_b16 v[158:159], v77 offset:2624
    s_waitcnt vmcnt(12) lgkmcnt(0)
    s_barrier
    s_add_u32 m0, s43, 147456
    s_add_u32 s41, s58, 524288
    buffer_load_dwordx4 v16, s[8:11], s41 offen offset:0 lds
    s_add_u32 s41, s58, 539648
    buffer_load_dwordx4 v16, s[8:11], s41 offen offset:1024 lds
    s_add_u32 s41, s58, 653312
    buffer_load_dwordx4 v16, s[8:11], s41 offen offset:2048 lds
    s_add_u32 s41, s58, 668672
    buffer_load_dwordx4 v16, s[8:11], s41 offen offset:3072 lds
    s_cmp_eq_u32 s32, 0
    s_cbranch_scc1 cs_init_done
    v_mov_b32 v52, 1
    v_mov_b32 v53, 1
    v_mov_b32 v54, 1
    v_mov_b32 v55, 1
    v_mov_b32 v56, 0
    v_lshl_or_b32 v72, v76, 16, v72
    s_lshl_b32 s96, s12, 14
    s_add_u32 s96, s96, 68681728
    s_add_u32 s97, s96, 0
    buffer_store_dwordx4 v[52:55], v65, s[4:7], s97 offen sc1
    s_add_u32 s97, s96, 4096
    buffer_store_dwordx4 v[52:55], v65, s[4:7], s97 offen sc1
    s_add_u32 s97, s96, 8192
    buffer_store_dwordx4 v[52:55], v65, s[4:7], s97 offen sc1
    s_add_u32 s97, s96, 12288
    buffer_store_dwordx4 v[52:55], v65, s[4:7], s97 offen sc1
    s_add_u32 s96, s68, 67633152
    s_add_u32 s97, s96, 16384
    buffer_store_dword v56, v75, s[4:7], s96 offen offset:0 sc1
    buffer_store_dword v72, v75, s[4:7], s97 offen offset:0 sc1
    s_cmp_lg_u32 s32, 2
    s_cbranch_scc1 cs_init_done
    buffer_store_dword v56, v75, s[4:7], s96 offen offset:1024 sc1
    buffer_store_dword v72, v75, s[4:7], s97 offen offset:1024 sc1
    buffer_store_dword v56, v75, s[4:7], s96 offen offset:2048 sc1
    buffer_store_dword v72, v75, s[4:7], s97 offen offset:2048 sc1
    buffer_store_dword v56, v75, s[4:7], s96 offen offset:3072 sc1
    buffer_store_dword v72, v75, s[4:7], s97 offen offset:3072 sc1
cs_init_done:
    v_add_u32 v28, 0, v24
    v_add_u32 v29, 0, v25
    v_add_u32 v30, 0, v26
    v_add_u32 v31, 0, v27
    ds_read_b64_tr_b16 a[96:97], v28 offset:0
    ds_read_b64_tr_b16 a[104:105], v28 offset:8
    ds_read_b64_tr_b16 a[112:113], v29 offset:0
    ds_read_b64_tr_b16 a[120:121], v29 offset:8
    ds_read_b64_tr_b16 a[128:129], v30 offset:0
    ds_read_b64_tr_b16 a[136:137], v30 offset:8
    ds_read_b64_tr_b16 a[144:145], v31 offset:0
    ds_read_b64_tr_b16 v[32:33], v31 offset:8
    s_waitcnt vmcnt(12) lgkmcnt(0)
    s_barrier
    s_add_u32 m0, s43, 0
    s_add_u32 s41, s58, 532480
    buffer_load_dwordx4 v16, s[8:11], s41 offen offset:0 lds
    s_add_u32 s41, s58, 547840
    buffer_load_dwordx4 v16, s[8:11], s41 offen offset:1024 lds
    s_add_u32 s41, s58, 661504
    buffer_load_dwordx4 v16, s[8:11], s41 offen offset:2048 lds
    s_add_u32 s41, s58, 676864
    buffer_load_dwordx4 v16, s[8:11], s41 offen offset:3072 lds
    ds_write_b64 v70, v[32:33] offset:12288
    v_add_u32 v28, 36864, v24
    v_add_u32 v29, 36864, v25
    v_add_u32 v30, 36864, v26
    v_add_u32 v31, 36864, v27
    ds_read_b64_tr_b16 a[98:99], v28 offset:0
    ds_read_b64_tr_b16 a[106:107], v28 offset:8
    ds_read_b64_tr_b16 a[114:115], v29 offset:0
    ds_read_b64_tr_b16 a[122:123], v29 offset:8
    ds_read_b64_tr_b16 a[130:131], v30 offset:0
    ds_read_b64_tr_b16 a[138:139], v30 offset:8
    ds_read_b64_tr_b16 a[146:147], v31 offset:0
    ds_read_b64_tr_b16 v[0:1], v31 offset:8
    s_waitcnt vmcnt(12) lgkmcnt(0)
    s_barrier
    s_add_u32 m0, s43, 36864
    s_add_u32 s41, s58, 786432
    buffer_load_dwordx4 v16, s[8:11], s41 offen offset:0 lds
    s_add_u32 s41, s58, 801792
    buffer_load_dwordx4 v16, s[8:11], s41 offen offset:1024 lds
    s_add_u32 s41, s58, 915456
    buffer_load_dwordx4 v16, s[8:11], s41 offen offset:2048 lds
    s_add_u32 s41, s58, 930816
    buffer_load_dwordx4 v16, s[8:11], s41 offen offset:3072 lds
    ds_write_b64 v70, v[0:1] offset:12296
    v_add_u32 v28, 73728, v24
    v_add_u32 v29, 73728, v25
    v_add_u32 v30, 73728, v26
    v_add_u32 v31, 73728, v27
    ds_read_b64_tr_b16 a[100:101], v28 offset:0
    ds_read_b64_tr_b16 a[108:109], v28 offset:8
    ds_read_b64_tr_b16 a[116:117], v29 offset:0
    ds_read_b64_tr_b16 a[124:125], v29 offset:8
    ds_read_b64_tr_b16 a[132:133], v30 offset:0
    ds_read_b64_tr_b16 a[140:141], v30 offset:8
    ds_read_b64_tr_b16 a[148:149], v31 offset:0
    ds_read_b64_tr_b16 v[32:33], v31 offset:8
    s_waitcnt vmcnt(12) lgkmcnt(0)
    s_barrier
    s_add_u32 m0, s43, 73728
    s_add_u32 s41, s58, 794624
    buffer_load_dwordx4 v16, s[8:11], s41 offen offset:0 lds
    s_add_u32 s41, s58, 809984
    buffer_load_dwordx4 v16, s[8:11], s41 offen offset:1024 lds
    s_add_u32 s41, s58, 923648
    buffer_load_dwordx4 v16, s[8:11], s41 offen offset:2048 lds
    s_add_u32 s41, s58, 939008
    buffer_load_dwordx4 v16, s[8:11], s41 offen offset:3072 lds
    ds_write_b64 v70, v[32:33] offset:13312
    v_add_u32 v28, 110592, v24
    v_add_u32 v29, 110592, v25
    v_add_u32 v30, 110592, v26
    v_add_u32 v31, 110592, v27
    ds_read_b64_tr_b16 a[102:103], v28 offset:0
    ds_read_b64_tr_b16 a[110:111], v28 offset:8
    ds_read_b64_tr_b16 a[118:119], v29 offset:0
    ds_read_b64_tr_b16 a[126:127], v29 offset:8
    ds_read_b64_tr_b16 a[134:135], v30 offset:0
    ds_read_b64_tr_b16 a[142:143], v30 offset:8
    ds_read_b64_tr_b16 a[150:151], v31 offset:0
    ds_read_b64_tr_b16 v[0:1], v31 offset:8
    s_waitcnt vmcnt(12) lgkmcnt(0)
    s_barrier
    s_add_u32 m0, s43, 110592
    s_add_u32 s41, s59, 0
    buffer_load_dwordx4 v17, s[8:11], s41 offen offset:0 lds
    s_add_u32 s41, s59, 31744
    buffer_load_dwordx4 v17, s[8:11], s41 offen offset:1024 lds
    s_add_u32 s41, s59, 1177600
    buffer_load_dwordx4 v17, s[8:11], s41 offen offset:2048 lds
    s_add_u32 s41, s59, 1209344
    buffer_load_dwordx4 v17, s[8:11], s41 offen offset:3072 lds
    ds_write_b64 v70, v[0:1] offset:13320
    v_add_u32 v28, 147456, v24
    v_add_u32 v29, 147456, v25
    v_add_u32 v30, 147456, v26
    v_add_u32 v31, 147456, v27
    ds_read_b64_tr_b16 a[152:153], v28 offset:0
    ds_read_b64_tr_b16 a[160:161], v28 offset:8
    ds_read_b64_tr_b16 v[32:33], v29 offset:0
    ds_read_b64_tr_b16 a[168:169], v29 offset:8
    ds_read_b64_tr_b16 a[176:177], v30 offset:0
    ds_read_b64_tr_b16 a[184:185], v30 offset:8
    ds_read_b64_tr_b16 v[34:35], v31 offset:0
    ds_read_b64_tr_b16 a[192:193], v31 offset:8
    s_waitcnt vmcnt(12) lgkmcnt(0)
    s_barrier
    s_mov_b64 s[8:9], s[50:51]
    s_add_u32 m0, s43, 147456
    s_add_u32 s41, s58, 0
    buffer_load_dwordx4 v16, s[8:11], s41 offen offset:0 lds
    s_add_u32 s41, s58, 15360
    buffer_load_dwordx4 v16, s[8:11], s41 offen offset:1024 lds
    s_add_u32 s41, s58, 129024
    buffer_load_dwordx4 v16, s[8:11], s41 offen offset:2048 lds
    s_add_u32 s41, s58, 144384
    buffer_load_dwordx4 v16, s[8:11], s41 offen offset:3072 lds
    ds_write_b64 v70, v[32:33] offset:16384
    ds_write_b64 v70, v[34:35] offset:18432
    v_add_u32 v28, 0, v24
    v_add_u32 v29, 0, v25
    v_add_u32 v30, 0, v26
    v_add_u32 v31, 0, v27
    ds_read_b64_tr_b16 a[154:155], v28 offset:0
    ds_read_b64_tr_b16 a[162:163], v28 offset:8
    ds_read_b64_tr_b16 v[0:1], v29 offset:0
    ds_read_b64_tr_b16 a[170:171], v29 offset:8
    ds_read_b64_tr_b16 a[178:179], v30 offset:0
    ds_read_b64_tr_b16 a[186:187], v30 offset:8
    ds_read_b64_tr_b16 v[2:3], v31 offset:0
    ds_read_b64_tr_b16 a[194:195], v31 offset:8
    s_waitcnt vmcnt(12) lgkmcnt(0)
    s_barrier
    s_add_u32 m0, s43, 0
    s_add_u32 s41, s58, 8192
    buffer_load_dwordx4 v16, s[8:11], s41 offen offset:0 lds
    s_add_u32 s41, s58, 23552
    buffer_load_dwordx4 v16, s[8:11], s41 offen offset:1024 lds
    s_add_u32 s41, s58, 137216
    buffer_load_dwordx4 v16, s[8:11], s41 offen offset:2048 lds
    s_add_u32 s41, s58, 152576
    buffer_load_dwordx4 v16, s[8:11], s41 offen offset:3072 lds
    ds_write_b64 v70, v[0:1] offset:16392
    ds_write_b64 v70, v[2:3] offset:18440
    v_add_u32 v28, 36864, v24
    v_add_u32 v29, 36864, v25
    v_add_u32 v30, 36864, v26
    v_add_u32 v31, 36864, v27
    ds_read_b64_tr_b16 a[156:157], v28 offset:0
    ds_read_b64_tr_b16 a[164:165], v28 offset:8
    ds_read_b64_tr_b16 v[32:33], v29 offset:0
    ds_read_b64_tr_b16 a[172:173], v29 offset:8
    ds_read_b64_tr_b16 a[180:181], v30 offset:0
    ds_read_b64_tr_b16 a[188:189], v30 offset:8
    ds_read_b64_tr_b16 v[34:35], v31 offset:0
    ds_read_b64_tr_b16 a[196:197], v31 offset:8
    s_waitcnt vmcnt(12) lgkmcnt(0)
    s_barrier
    s_add_u32 m0, s43, 36864
    s_add_u32 s41, s58, 262144
    buffer_load_dwordx4 v16, s[8:11], s41 offen offset:0 lds
    s_add_u32 s41, s58, 277504
    buffer_load_dwordx4 v16, s[8:11], s41 offen offset:1024 lds
    s_add_u32 s41, s58, 391168
    buffer_load_dwordx4 v16, s[8:11], s41 offen offset:2048 lds
    s_add_u32 s41, s58, 406528
    buffer_load_dwordx4 v16, s[8:11], s41 offen offset:3072 lds
    ds_write_b64 v70, v[32:33] offset:17408
    ds_write_b64 v70, v[34:35] offset:19456
    v_add_u32 v28, 73728, v24
    v_add_u32 v29, 73728, v25
    v_add_u32 v30, 73728, v26
    v_add_u32 v31, 73728, v27
    ds_read_b64_tr_b16 a[158:159], v28 offset:0
    ds_read_b64_tr_b16 a[166:167], v28 offset:8
    ds_read_b64_tr_b16 v[0:1], v29 offset:0
    ds_read_b64_tr_b16 a[174:175], v29 offset:8
    ds_read_b64_tr_b16 a[182:183], v30 offset:0
    ds_read_b64_tr_b16 a[190:191], v30 offset:8
    ds_read_b64_tr_b16 v[2:3], v31 offset:0
    ds_read_b64_tr_b16 a[198:199], v31 offset:8
    s_waitcnt vmcnt(12) lgkmcnt(0)
    s_barrier
    s_add_u32 m0, s43, 73728
    s_add_u32 s41, s58, 270336
    buffer_load_dwordx4 v16, s[8:11], s41 offen offset:0 lds
    s_add_u32 s41, s58, 285696
    buffer_load_dwordx4 v16, s[8:11], s41 offen offset:1024 lds
    s_add_u32 s41, s58, 399360
    buffer_load_dwordx4 v16, s[8:11], s41 offen offset:2048 lds
    s_add_u32 s41, s58, 414720
    buffer_load_dwordx4 v16, s[8:11], s41 offen offset:3072 lds
    ds_write_b64 v70, v[0:1] offset:17416
    ds_write_b64 v70, v[2:3] offset:19464
    v_add_u32 v77, 110592, v20
    ds_read_b64_tr_b16 a[200:201], v77 offset:0
    ds_read_b64_tr_b16 a[202:203], v77 offset:4096
    ds_read_b64_tr_b16 a[204:205], v77 offset:8192
    ds_read_b64_tr_b16 a[206:207], v77 offset:12288
    ds_read_b64_tr_b16 a[208:209], v77 offset:8
    ds_read_b64_tr_b16 a[210:211], v77 offset:4104
    ds_read_b64_tr_b16 a[212:213], v77 offset:8200
    ds_read_b64_tr_b16 a[214:215], v77 offset:12296
    s_waitcnt vmcnt(12) lgkmcnt(0)
    s_barrier
    s_add_u32 m0, s43, 110592
    s_add_u32 s41, s58, 524288
    buffer_load_dwordx4 v16, s[8:11], s41 offen offset:0 lds
    s_add_u32 s41, s58, 539648
    buffer_load_dwordx4 v16, s[8:11], s41 offen offset:1024 lds
    s_add_u32 s41, s58, 653312
    buffer_load_dwordx4 v16, s[8:11], s41 offen offset:2048 lds
    s_add_u32 s41, s58, 668672
    buffer_load_dwordx4 v16, s[8:11], s41 offen offset:3072 lds
    v_add_u32 v28, 147456, v24
    v_add_u32 v29, 147456, v25
    v_add_u32 v30, 147456, v26
    v_add_u32 v31, 147456, v27
    ds_read_b64_tr_b16 v[0:1], v28 offset:0
    ds_read_b64_tr_b16 v[2:3], v28 offset:8
    ds_read_b64_tr_b16 v[4:5], v29 offset:0
    ds_read_b64_tr_b16 v[6:7], v29 offset:8
    ds_read_b64_tr_b16 a[0:1], v30 offset:0
    ds_read_b64_tr_b16 v[8:9], v30 offset:8
    ds_read_b64_tr_b16 a[8:9], v31 offset:0
    ds_read_b64_tr_b16 v[10:11], v31 offset:8
    s_waitcnt vmcnt(12) lgkmcnt(0)
    s_barrier
    s_add_u32 m0, s43, 147456
    s_add_u32 s41, s58, 532480
    buffer_load_dwordx4 v16, s[8:11], s41 offen offset:0 lds
    s_add_u32 s41, s58, 547840
    buffer_load_dwordx4 v16, s[8:11], s41 offen offset:1024 lds
    s_add_u32 s41, s58, 661504
    buffer_load_dwordx4 v16, s[8:11], s41 offen offset:2048 lds
    s_add_u32 s41, s58, 676864
    buffer_load_dwordx4 v16, s[8:11], s41 offen offset:3072 lds
    ds_write_b64 v70, v[0:1] offset:0
    ds_write_b64 v70, v[2:3] offset:2048
    ds_write_b64 v70, v[4:5] offset:4096
    ds_write_b64 v70, v[6:7] offset:6144
    ds_write_b64 v70, v[8:9] offset:10240
    ds_write_b64 v70, v[10:11] offset:14336
    v_add_u32 v28, 0, v24
    v_add_u32 v29, 0, v25
    v_add_u32 v30, 0, v26
    v_add_u32 v31, 0, v27
    ds_read_b64_tr_b16 v[32:33], v28 offset:0
    ds_read_b64_tr_b16 v[34:35], v28 offset:8
    ds_read_b64_tr_b16 v[36:37], v29 offset:0
    ds_read_b64_tr_b16 v[38:39], v29 offset:8
    ds_read_b64_tr_b16 a[2:3], v30 offset:0
    ds_read_b64_tr_b16 v[40:41], v30 offset:8
    ds_read_b64_tr_b16 a[10:11], v31 offset:0
    ds_read_b64_tr_b16 v[42:43], v31 offset:8
    s_waitcnt vmcnt(12) lgkmcnt(0)
    s_barrier
    s_add_u32 m0, s43, 0
    s_add_u32 s41, s58, 786432
    buffer_load_dwordx4 v16, s[8:11], s41 offen offset:0 lds
    s_add_u32 s41, s58, 801792
    buffer_load_dwordx4 v16, s[8:11], s41 offen offset:1024 lds
    s_add_u32 s41, s58, 915456
    buffer_load_dwordx4 v16, s[8:11], s41 offen offset:2048 lds
    s_add_u32 s41, s58, 930816
    buffer_load_dwordx4 v16, s[8:11], s41 offen offset:3072 lds
    ds_write_b64 v70, v[32:33] offset:8
    ds_write_b64 v70, v[34:35] offset:2056
    ds_write_b64 v70, v[36:37] offset:4104
    ds_write_b64 v70, v[38:39] offset:6152
    ds_write_b64 v70, v[40:41] offset:10248
    ds_write_b64 v70, v[42:43] offset:14344
    v_add_u32 v28, 36864, v24
    v_add_u32 v29, 36864, v25
    v_add_u32 v30, 36864, v26
    v_add_u32 v31, 36864, v27
    ds_read_b64_tr_b16 v[0:1], v28 offset:0
    ds_read_b64_tr_b16 v[2:3], v28 offset:8
    ds_read_b64_tr_b16 v[4:5], v29 offset:0
    ds_read_b64_tr_b16 v[6:7], v29 offset:8
    ds_read_b64_tr_b16 a[4:5], v30 offset:0
    ds_read_b64_tr_b16 v[8:9], v30 offset:8
    ds_read_b64_tr_b16 a[12:13], v31 offset:0
    ds_read_b64_tr_b16 v[10:11], v31 offset:8
    s_waitcnt vmcnt(12) lgkmcnt(0)
    s_barrier
    s_add_u32 m0, s43, 36864
    s_add_u32 s41, s58, 794624
    buffer_load_dwordx4 v16, s[8:11], s41 offen offset:0 lds
    s_add_u32 s41, s58, 809984
    buffer_load_dwordx4 v16, s[8:11], s41 offen offset:1024 lds
    s_add_u32 s41, s58, 923648
    buffer_load_dwordx4 v16, s[8:11], s41 offen offset:2048 lds
    s_add_u32 s41, s58, 939008
    buffer_load_dwordx4 v16, s[8:11], s41 offen offset:3072 lds
    ds_write_b64 v70, v[0:1] offset:1024
    ds_write_b64 v70, v[2:3] offset:3072
    ds_write_b64 v70, v[4:5] offset:5120
    ds_write_b64 v70, v[6:7] offset:7168
    ds_write_b64 v70, v[8:9] offset:11264
    ds_write_b64 v70, v[10:11] offset:15360
    v_add_u32 v28, 73728, v24
    v_add_u32 v29, 73728, v25
    v_add_u32 v30, 73728, v26
    v_add_u32 v31, 73728, v27
    ds_read_b64_tr_b16 v[32:33], v28 offset:0
    ds_read_b64_tr_b16 v[34:35], v28 offset:8
    ds_read_b64_tr_b16 v[36:37], v29 offset:0
    ds_read_b64_tr_b16 v[38:39], v29 offset:8
    ds_read_b64_tr_b16 a[6:7], v30 offset:0
    ds_read_b64_tr_b16 v[40:41], v30 offset:8
    ds_read_b64_tr_b16 a[14:15], v31 offset:0
    ds_read_b64_tr_b16 v[42:43], v31 offset:8
    s_waitcnt vmcnt(12) lgkmcnt(0)
    s_barrier
    s_add_u32 m0, s43, 73728
    s_add_u32 s41, s59, 0
    buffer_load_dwordx4 v17, s[8:11], s41 offen offset:0 lds
    s_add_u32 s41, s59, 31744
    buffer_load_dwordx4 v17, s[8:11], s41 offen offset:1024 lds
    s_add_u32 s41, s59, 1177600
    buffer_load_dwordx4 v17, s[8:11], s41 offen offset:2048 lds
    s_add_u32 s41, s59, 1209344
    buffer_load_dwordx4 v17, s[8:11], s41 offen offset:3072 lds
    ds_write_b64 v70, v[32:33] offset:1032
    ds_write_b64 v70, v[34:35] offset:3080
    ds_write_b64 v70, v[36:37] offset:5128
    ds_write_b64 v70, v[38:39] offset:7176
    ds_write_b64 v70, v[40:41] offset:11272
    ds_write_b64 v70, v[42:43] offset:15368
    v_add_u32 v28, 110592, v24
    v_add_u32 v29, 110592, v25
    v_add_u32 v30, 110592, v26
    v_add_u32 v31, 110592, v27
    ds_read_b64_tr_b16 a[16:17], v28 offset:0
    ds_read_b64_tr_b16 a[24:25], v28 offset:8
    ds_read_b64_tr_b16 a[32:33], v29 offset:0
    ds_read_b64_tr_b16 a[40:41], v29 offset:8
    ds_read_b64_tr_b16 a[48:49], v30 offset:0
    ds_read_b64_tr_b16 a[56:57], v30 offset:8
    ds_read_b64_tr_b16 a[64:65], v31 offset:0
    ds_read_b64_tr_b16 a[72:73], v31 offset:8
    s_waitcnt vmcnt(12) lgkmcnt(0)
    s_barrier
    s_mov_b64 s[8:9], s[54:55]
    s_add_u32 m0, s43, 110592
    s_add_u32 s41, s58, 0
    buffer_load_dwordx4 v16, s[8:11], s41 offen offset:0 lds
    s_add_u32 s41, s58, 15360
    buffer_load_dwordx4 v16, s[8:11], s41 offen offset:1024 lds
    s_add_u32 s41, s58, 129024
    buffer_load_dwordx4 v16, s[8:11], s41 offen offset:2048 lds
    s_add_u32 s41, s58, 144384
    buffer_load_dwordx4 v16, s[8:11], s41 offen offset:3072 lds
    v_add_u32 v28, 147456, v24
    v_add_u32 v29, 147456, v25
    v_add_u32 v30, 147456, v26
    v_add_u32 v31, 147456, v27
    ds_read_b64_tr_b16 a[18:19], v28 offset:0
    ds_read_b64_tr_b16 a[26:27], v28 offset:8
    ds_read_b64_tr_b16 a[34:35], v29 offset:0
    ds_read_b64_tr_b16 a[42:43], v29 offset:8
    ds_read_b64_tr_b16 a[50:51], v30 offset:0
    ds_read_b64_tr_b16 a[58:59], v30 offset:8
    ds_read_b64_tr_b16 a[66:67], v31 offset:0
    ds_read_b64_tr_b16 a[74:75], v31 offset:8
    s_waitcnt vmcnt(12) lgkmcnt(0)
    s_barrier
    s_add_u32 m0, s43, 147456
    s_add_u32 s41, s58, 8192
    buffer_load_dwordx4 v16, s[8:11], s41 offen offset:0 lds
    s_add_u32 s41, s58, 23552
    buffer_load_dwordx4 v16, s[8:11], s41 offen offset:1024 lds
    s_add_u32 s41, s58, 137216
    buffer_load_dwordx4 v16, s[8:11], s41 offen offset:2048 lds
    s_add_u32 s41, s58, 152576
    buffer_load_dwordx4 v16, s[8:11], s41 offen offset:3072 lds
    v_add_u32 v28, 0, v24
    v_add_u32 v29, 0, v25
    v_add_u32 v30, 0, v26
    v_add_u32 v31, 0, v27
    ds_read_b64_tr_b16 a[20:21], v28 offset:0
    ds_read_b64_tr_b16 a[28:29], v28 offset:8
    ds_read_b64_tr_b16 a[36:37], v29 offset:0
    ds_read_b64_tr_b16 a[44:45], v29 offset:8
    ds_read_b64_tr_b16 a[52:53], v30 offset:0
    ds_read_b64_tr_b16 a[60:61], v30 offset:8
    ds_read_b64_tr_b16 a[68:69], v31 offset:0
    ds_read_b64_tr_b16 a[76:77], v31 offset:8
    s_waitcnt vmcnt(12) lgkmcnt(0)
    s_barrier
    s_add_u32 m0, s43, 0
    s_add_u32 s41, s58, 262144
    buffer_load_dwordx4 v16, s[8:11], s41 offen offset:0 lds
    s_add_u32 s41, s58, 277504
    buffer_load_dwordx4 v16, s[8:11], s41 offen offset:1024 lds
    s_add_u32 s41, s58, 391168
    buffer_load_dwordx4 v16, s[8:11], s41 offen offset:2048 lds
    s_add_u32 s41, s58, 406528
    buffer_load_dwordx4 v16, s[8:11], s41 offen offset:3072 lds
    v_add_u32 v28, 36864, v24
    v_add_u32 v29, 36864, v25
    v_add_u32 v30, 36864, v26
    v_add_u32 v31, 36864, v27
    ds_read_b64_tr_b16 a[22:23], v28 offset:0
    ds_read_b64_tr_b16 a[30:31], v28 offset:8
    ds_read_b64_tr_b16 a[38:39], v29 offset:0
    ds_read_b64_tr_b16 a[46:47], v29 offset:8
    ds_read_b64_tr_b16 a[54:55], v30 offset:0
    ds_read_b64_tr_b16 a[62:63], v30 offset:8
    ds_read_b64_tr_b16 a[70:71], v31 offset:0
    ds_read_b64_tr_b16 a[78:79], v31 offset:8
    s_waitcnt vmcnt(12) lgkmcnt(0)
    s_barrier
    s_add_u32 m0, s43, 36864
    s_add_u32 s41, s58, 270336
    buffer_load_dwordx4 v16, s[8:11], s41 offen offset:0 lds
    s_add_u32 s41, s58, 285696
    buffer_load_dwordx4 v16, s[8:11], s41 offen offset:1024 lds
    s_add_u32 s41, s58, 399360
    buffer_load_dwordx4 v16, s[8:11], s41 offen offset:2048 lds
    s_add_u32 s41, s58, 414720
    buffer_load_dwordx4 v16, s[8:11], s41 offen offset:3072 lds
    v_add_u32 v77, 73728, v20
    ds_read_b64_tr_b16 a[80:81], v77 offset:0
    ds_read_b64_tr_b16 a[82:83], v77 offset:4096
    ds_read_b64_tr_b16 a[84:85], v77 offset:8192
    ds_read_b64_tr_b16 a[86:87], v77 offset:12288
    ds_read_b64_tr_b16 a[88:89], v77 offset:8
    ds_read_b64_tr_b16 a[90:91], v77 offset:4104
    ds_read_b64_tr_b16 a[92:93], v77 offset:8200
    ds_read_b64_tr_b16 a[94:95], v77 offset:12296
    s_waitcnt vmcnt(12) lgkmcnt(0)
    s_barrier
    s_add_u32 m0, s43, 73728
    s_add_u32 s41, s58, 524288
    buffer_load_dwordx4 v16, s[8:11], s41 offen offset:0 lds
    s_add_u32 s41, s58, 539648
    buffer_load_dwordx4 v16, s[8:11], s41 offen offset:1024 lds
    s_add_u32 s41, s58, 653312
    buffer_load_dwordx4 v16, s[8:11], s41 offen offset:2048 lds
    s_add_u32 s41, s58, 668672
    buffer_load_dwordx4 v16, s[8:11], s41 offen offset:3072 lds
    v_add_u32 v28, 110592, v24
    v_add_u32 v29, 110592, v25
    v_add_u32 v30, 110592, v26
    v_add_u32 v31, 110592, v27
    ds_read_b64_tr_b16 a[216:217], v28 offset:0
    ds_read_b64_tr_b16 v[32:33], v28 offset:8
    ds_read_b64_tr_b16 a[224:225], v29 offset:0
    ds_read_b64_tr_b16 a[232:233], v29 offset:8
    ds_read_b64_tr_b16 a[240:241], v30 offset:0
    ds_read_b64_tr_b16 a[248:249], v30 offset:8
    ds_read_b64_tr_b16 v[160:161], v31 offset:0
    ds_read_b64_tr_b16 v[168:169], v31 offset:8
    s_waitcnt vmcnt(12) lgkmcnt(0)
    s_barrier
    s_add_u32 m0, s43, 110592
    s_add_u32 s41, s58, 532480
    buffer_load_dwordx4 v16, s[8:11], s41 offen offset:0 lds
    s_add_u32 s41, s58, 547840
    buffer_load_dwordx4 v16, s[8:11], s41 offen offset:1024 lds
    s_add_u32 s41, s58, 661504
    buffer_load_dwordx4 v16, s[8:11], s41 offen offset:2048 lds
    s_add_u32 s41, s58, 676864
    buffer_load_dwordx4 v16, s[8:11], s41 offen offset:3072 lds
    ds_write_b64 v70, v[32:33] offset:8192
    v_add_u32 v28, 147456, v24
    v_add_u32 v29, 147456, v25
    v_add_u32 v30, 147456, v26
    v_add_u32 v31, 147456, v27
    ds_read_b64_tr_b16 a[218:219], v28 offset:0
    ds_read_b64_tr_b16 v[0:1], v28 offset:8
    ds_read_b64_tr_b16 a[226:227], v29 offset:0
    ds_read_b64_tr_b16 a[234:235], v29 offset:8
    ds_read_b64_tr_b16 a[242:243], v30 offset:0
    ds_read_b64_tr_b16 a[250:251], v30 offset:8
    ds_read_b64_tr_b16 v[162:163], v31 offset:0
    ds_read_b64_tr_b16 v[170:171], v31 offset:8
    s_waitcnt vmcnt(12) lgkmcnt(0)
    s_barrier
    s_add_u32 m0, s43, 147456
    s_add_u32 s41, s58, 786432
    buffer_load_dwordx4 v16, s[8:11], s41 offen offset:0 lds
    s_add_u32 s41, s58, 801792
    buffer_load_dwordx4 v16, s[8:11], s41 offen offset:1024 lds
    s_add_u32 s41, s58, 915456
    buffer_load_dwordx4 v16, s[8:11], s41 offen offset:2048 lds
    s_add_u32 s41, s58, 930816
    buffer_load_dwordx4 v16, s[8:11], s41 offen offset:3072 lds
    ds_write_b64 v70, v[0:1] offset:8200
    v_add_u32 v28, 0, v24
    v_add_u32 v29, 0, v25
    v_add_u32 v30, 0, v26
    v_add_u32 v31, 0, v27
    ds_read_b64_tr_b16 a[220:221], v28 offset:0
    ds_read_b64_tr_b16 v[32:33], v28 offset:8
    ds_read_b64_tr_b16 a[228:229], v29 offset:0
    ds_read_b64_tr_b16 a[236:237], v29 offset:8
    ds_read_b64_tr_b16 a[244:245], v30 offset:0
    ds_read_b64_tr_b16 a[252:253], v30 offset:8
    ds_read_b64_tr_b16 v[164:165], v31 offset:0
    ds_read_b64_tr_b16 v[172:173], v31 offset:8
    s_waitcnt vmcnt(12) lgkmcnt(0)
    s_barrier
    s_add_u32 m0, s43, 0
    s_add_u32 s41, s58, 794624
    buffer_load_dwordx4 v16, s[8:11], s41 offen offset:0 lds
    s_add_u32 s41, s58, 809984
    buffer_load_dwordx4 v16, s[8:11], s41 offen offset:1024 lds
    s_add_u32 s41, s58, 923648
    buffer_load_dwordx4 v16, s[8:11], s41 offen offset:2048 lds
    s_add_u32 s41, s58, 939008
    buffer_load_dwordx4 v16, s[8:11], s41 offen offset:3072 lds
    ds_write_b64 v70, v[32:33] offset:9216
    v_add_u32 v28, 36864, v24
    v_add_u32 v29, 36864, v25
    v_add_u32 v30, 36864, v26
    v_add_u32 v31, 36864, v27
    ds_read_b64_tr_b16 a[222:223], v28 offset:0
    ds_read_b64_tr_b16 v[0:1], v28 offset:8
    ds_read_b64_tr_b16 a[230:231], v29 offset:0
    ds_read_b64_tr_b16 a[238:239], v29 offset:8
    ds_read_b64_tr_b16 a[246:247], v30 offset:0
    ds_read_b64_tr_b16 a[254:255], v30 offset:8
    ds_read_b64_tr_b16 v[166:167], v31 offset:0
    ds_read_b64_tr_b16 v[174:175], v31 offset:8
    s_waitcnt vmcnt(12) lgkmcnt(0)
    s_barrier
    s_add_u32 m0, s43, 36864
    s_add_u32 s41, s59, 0
    buffer_load_dwordx4 v17, s[8:11], s41 offen offset:0 lds
    s_add_u32 s41, s59, 31744
    buffer_load_dwordx4 v17, s[8:11], s41 offen offset:1024 lds
    s_add_u32 s41, s59, 1177600
    buffer_load_dwordx4 v17, s[8:11], s41 offen offset:2048 lds
    s_add_u32 s41, s59, 1209344
    buffer_load_dwordx4 v17, s[8:11], s41 offen offset:3072 lds
    ds_write_b64 v70, v[0:1] offset:9224
    v_add_u32 v28, 73728, v24
    v_add_u32 v29, 73728, v25
    v_add_u32 v30, 73728, v26
    v_add_u32 v31, 73728, v27
    ds_read_b64_tr_b16 v[176:177], v28 offset:0
    ds_read_b64_tr_b16 v[184:185], v28 offset:8
    ds_read_b64_tr_b16 v[192:193], v29 offset:0
    ds_read_b64_tr_b16 v[200:201], v29 offset:8
    ds_read_b64_tr_b16 v[208:209], v30 offset:0
    ds_read_b64_tr_b16 v[216:217], v30 offset:8
    ds_read_b64_tr_b16 v[224:225], v31 offset:0
    ds_read_b64_tr_b16 v[232:233], v31 offset:8
    s_waitcnt vmcnt(12) lgkmcnt(0)
    s_barrier
    s_mov_b64 s[8:9], s[56:57]
    s_add_u32 m0, s43, 73728
    s_add_u32 s41, s60, 128
    buffer_load_dwordx4 v18, s[8:11], s41 offen offset:0 lds
    s_add_u32 s41, s60, 8320
    buffer_load_dwordx4 v18, s[8:11], s41 offen offset:1024 lds
    s_add_u32 s41, s60, 16512
    buffer_load_dwordx4 v18, s[8:11], s41 offen offset:2048 lds
    s_add_u32 s41, s60, 24704
    buffer_load_dwordx4 v18, s[8:11], s41 offen offset:3072 lds
    v_add_u32 v28, 110592, v24
    v_add_u32 v29, 110592, v25
    v_add_u32 v30, 110592, v26
    v_add_u32 v31, 110592, v27
    ds_read_b64_tr_b16 v[178:179], v28 offset:0
    ds_read_b64_tr_b16 v[186:187], v28 offset:8
    ds_read_b64_tr_b16 v[194:195], v29 offset:0
    ds_read_b64_tr_b16 v[202:203], v29 offset:8
    ds_read_b64_tr_b16 v[210:211], v30 offset:0
    ds_read_b64_tr_b16 v[218:219], v30 offset:8
    ds_read_b64_tr_b16 v[226:227], v31 offset:0
    ds_read_b64_tr_b16 v[234:235], v31 offset:8
    s_waitcnt vmcnt(12) lgkmcnt(0)
    s_barrier
    s_add_u32 m0, s43, 110592
    s_add_u32 s41, s61, 128
    buffer_load_dwordx4 v18, s[8:11], s41 offen offset:0 lds
    s_add_u32 s41, s61, 8320
    buffer_load_dwordx4 v18, s[8:11], s41 offen offset:1024 lds
    s_add_u32 s41, s61, 16512
    buffer_load_dwordx4 v18, s[8:11], s41 offen offset:2048 lds
    s_add_u32 s41, s61, 24704
    buffer_load_dwordx4 v18, s[8:11], s41 offen offset:3072 lds
    v_add_u32 v28, 147456, v24
    v_add_u32 v29, 147456, v25
    v_add_u32 v30, 147456, v26
    v_add_u32 v31, 147456, v27
    ds_read_b64_tr_b16 v[180:181], v28 offset:0
    ds_read_b64_tr_b16 v[188:189], v28 offset:8
    ds_read_b64_tr_b16 v[196:197], v29 offset:0
    ds_read_b64_tr_b16 v[204:205], v29 offset:8
    ds_read_b64_tr_b16 v[212:213], v30 offset:0
    ds_read_b64_tr_b16 v[220:221], v30 offset:8
    ds_read_b64_tr_b16 v[228:229], v31 offset:0
    ds_read_b64_tr_b16 v[236:237], v31 offset:8
    s_waitcnt vmcnt(12) lgkmcnt(0)
    s_barrier
    s_add_u32 m0, s43, 147456
    s_add_u32 s41, s62, 128
    buffer_load_dwordx4 v18, s[8:11], s41 offen offset:0 lds
    s_add_u32 s41, s62, 8320
    buffer_load_dwordx4 v18, s[8:11], s41 offen offset:1024 lds
    s_add_u32 s41, s62, 16512
    buffer_load_dwordx4 v18, s[8:11], s41 offen offset:2048 lds
    s_add_u32 s41, s62, 24704
    buffer_load_dwordx4 v18, s[8:11], s41 offen offset:3072 lds
    v_add_u32 v28, 0, v24
    v_add_u32 v29, 0, v25
    v_add_u32 v30, 0, v26
    v_add_u32 v31, 0, v27
    ds_read_b64_tr_b16 v[182:183], v28 offset:0
    ds_read_b64_tr_b16 v[190:191], v28 offset:8
    ds_read_b64_tr_b16 v[198:199], v29 offset:0
    ds_read_b64_tr_b16 v[206:207], v29 offset:8
    ds_read_b64_tr_b16 v[214:215], v30 offset:0
    ds_read_b64_tr_b16 v[222:223], v30 offset:8
    ds_read_b64_tr_b16 v[230:231], v31 offset:0
    ds_read_b64_tr_b16 v[238:239], v31 offset:8
    s_waitcnt vmcnt(12) lgkmcnt(0)
    s_barrier
    s_add_u32 m0, s43, 0
    s_add_u32 s41, s63, 128
    buffer_load_dwordx4 v18, s[8:11], s41 offen offset:0 lds
    s_add_u32 s41, s63, 8320
    buffer_load_dwordx4 v18, s[8:11], s41 offen offset:1024 lds
    s_add_u32 s41, s63, 16512
    buffer_load_dwordx4 v18, s[8:11], s41 offen offset:2048 lds
    s_add_u32 s41, s63, 24704
    buffer_load_dwordx4 v18, s[8:11], s41 offen offset:3072 lds
    v_add_u32 v77, 36864, v20
    ds_read_b64_tr_b16 v[240:241], v77 offset:0
    ds_read_b64_tr_b16 v[242:243], v77 offset:4096
    ds_read_b64_tr_b16 v[244:245], v77 offset:8192
    ds_read_b64_tr_b16 v[246:247], v77 offset:12288
    ds_read_b64_tr_b16 v[248:249], v77 offset:8
    ds_read_b64_tr_b16 v[250:251], v77 offset:4104
    ds_read_b64_tr_b16 v[252:253], v77 offset:8200
    ds_read_b64_tr_b16 v[254:255], v77 offset:12296
    s_waitcnt vmcnt(12) lgkmcnt(0)
    s_barrier
    v_add_u32 v77, 73728, v79
    s_waitcnt lgkmcnt(0)
    ds_read_b64_tr_b16 v[0:1], v77 offset:0
    ds_read_b64_tr_b16 v[2:3], v77 offset:256
    ds_read_b64_tr_b16 v[4:5], v77 offset:2048
    ds_read_b64_tr_b16 v[6:7], v77 offset:2304
    ds_read_b64_tr_b16 v[8:9], v77 offset:8
    ds_read_b64_tr_b16 v[10:11], v77 offset:264
    ds_read_b64_tr_b16 v[12:13], v77 offset:2056
    ds_read_b64_tr_b16 v[14:15], v77 offset:2312
    s_waitcnt vmcnt(8) lgkmcnt(0)
    s_barrier
    v_add_u32 v77, 110592, v78
    ds_read_b64_tr_b16 v[16:17], v77 offset:0
    ds_read_b64_tr_b16 v[18:19], v77 offset:256
    ds_read_b64_tr_b16 v[20:21], v77 offset:2048
    ds_read_b64_tr_b16 v[22:23], v77 offset:2304
    ds_read_b64_tr_b16 v[24:25], v77 offset:8
    ds_read_b64_tr_b16 v[26:27], v77 offset:264
    ds_read_b64_tr_b16 v[28:29], v77 offset:2056
    ds_read_b64_tr_b16 v[30:31], v77 offset:2312
    s_waitcnt vmcnt(4) lgkmcnt(0)
    s_barrier
    v_add_u32 v77, 147456, v78
    ds_read_b64_tr_b16 v[32:33], v77 offset:0
    ds_read_b64_tr_b16 v[34:35], v77 offset:256
    ds_read_b64_tr_b16 v[36:37], v77 offset:2048
    ds_read_b64_tr_b16 v[38:39], v77 offset:2304
    ds_read_b64_tr_b16 v[40:41], v77 offset:8
    ds_read_b64_tr_b16 v[42:43], v77 offset:264
    ds_read_b64_tr_b16 v[44:45], v77 offset:2056
    ds_read_b64_tr_b16 v[46:47], v77 offset:2312
    s_waitcnt vmcnt(0) lgkmcnt(0)
    s_barrier
    v_add_u32 v77, 0, v78
    ds_read_b64_tr_b16 v[48:49], v77 offset:0
    ds_read_b64_tr_b16 v[50:51], v77 offset:256
    ds_read_b64_tr_b16 v[52:53], v77 offset:2048
    ds_read_b64_tr_b16 v[54:55], v77 offset:2304
    ds_read_b64_tr_b16 v[56:57], v77 offset:8
    ds_read_b64_tr_b16 v[58:59], v77 offset:264
    ds_read_b64_tr_b16 v[60:61], v77 offset:2056
    ds_read_b64_tr_b16 v[62:63], v77 offset:2312
    s_waitcnt lgkmcnt(0)
    s_barrier
    ds_write_b128 v70, v[0:3] offset:20480
    ds_write_b128 v70, v[4:7] offset:21504
    ds_write_b128 v70, v[8:11] offset:22528
    ds_write_b128 v70, v[12:15] offset:23552
    ds_write_b128 v70, v[16:19] offset:24576
    ds_write_b128 v70, v[20:23] offset:25600
    ds_write_b128 v70, v[24:27] offset:26624
    ds_write_b128 v70, v[28:31] offset:27648
    ds_write_b128 v70, v[32:35] offset:28672
    ds_write_b128 v70, v[36:39] offset:29696
    ds_write_b128 v70, v[40:43] offset:30720
    ds_write_b128 v70, v[44:47] offset:31744
    ds_write_b128 v70, v[48:51] offset:32768
    ds_write_b128 v70, v[52:55] offset:33792
    ds_write_b128 v70, v[56:59] offset:34816
    ds_write_b128 v70, v[60:63] offset:35840
    s_waitcnt lgkmcnt(0)
    v_bfe_u32 v60, v65, 4, 6
    v_and_b32 v61, 15, v60
    v_lshrrev_b32 v62, 4, v60
    v_mov_b32 v50, 0x3f80
    v_mov_b32 v51, 0x3f800000
    v_and_b32 v77, 1, v62
    v_lshlrev_b32 v77, 2, v77
    v_sub_u32 v77, v61, v77
    v_and_b32 v78, 3, v61
    v_lshlrev_b32 v78, 2, v78
    v_lshrrev_b32 v79, 2, v61
    v_add_u32 v78, v78, v79
    v_cmp_eq_u32 vcc, 0, v77
    s_nop 1
    v_cndmask_b32 v8, 0, v50, vcc
    v_cmp_eq_u32 vcc, 1, v77
    s_nop 1
    v_cndmask_b32 v8, v8, v51, vcc
    v_cmp_eq_u32 vcc, 0, v78
    s_nop 1
    v_cndmask_b32 v12, 0, v50, vcc
    v_cmp_eq_u32 vcc, 1, v78
    s_nop 1
    v_cndmask_b32 v12, v12, v51, vcc
    v_cmp_eq_u32 vcc, 2, v77
    s_nop 1
    v_cndmask_b32 v9, 0, v50, vcc
    v_cmp_eq_u32 vcc, 3, v77
    s_nop 1
    v_cndmask_b32 v9, v9, v51, vcc
    v_cmp_eq_u32 vcc, 2, v78
    s_nop 1
    v_cndmask_b32 v13, 0, v50, vcc
    v_cmp_eq_u32 vcc, 3, v78
    s_nop 1
    v_cndmask_b32 v13, v13, v51, vcc
    v_cmp_eq_u32 vcc, 8, v77
    s_nop 1
    v_cndmask_b32 v10, 0, v50, vcc
    v_cmp_eq_u32 vcc, 9, v77
    s_nop 1
    v_cndmask_b32 v10, v10, v51, vcc
    v_cmp_eq_u32 vcc, 4, v78
    s_nop 1
    v_cndmask_b32 v14, 0, v50, vcc
    v_cmp_eq_u32 vcc, 5, v78
    s_nop 1
    v_cndmask_b32 v14, v14, v51, vcc
    v_cmp_eq_u32 vcc, 10, v77
    s_nop 1
    v_cndmask_b32 v11, 0, v50, vcc
    v_cmp_eq_u32 vcc, 11, v77
    s_nop 1
    v_cndmask_b32 v11, v11, v51, vcc
    v_cmp_eq_u32 vcc, 6, v78
    s_nop 1
    v_cndmask_b32 v15, 0, v50, vcc
    v_cmp_eq_u32 vcc, 7, v78
    s_nop 1
    v_cndmask_b32 v15, v15, v51, vcc
    v_lshlrev_b32 v77, 4, v61
    ds_write_b128 v69, v[8:11] offset:15360
    ds_write_b128 v77, v[12:15] offset:15872
    s_waitcnt vmcnt(0) lgkmcnt(0)
    s_mov_b32 s88, 4194304
gn3:
    buffer_load_dword v2, off, s[84:87], 0 offset:216 sc1
    s_waitcnt vmcnt(0)
    v_readfirstlane_b32 s95, v2
    s_sub_u32 s88, s88, 1
    s_cbranch_scc1 gn3x
    s_cmp_eq_u32 s95, 0
    s_cbranch_scc1 gn3
gn3x:
    s_barrier
    v_mov_b32 v2, 1
    s_cmp_lg_u32 s13, 0
    s_cbranch_scc1 cs_noarr
    s_mov_b64 exec, 1
    buffer_atomic_add v2, off, s[84:87], 0 offset:212
    s_mov_b32 s40, 16777216
    s_mov_b32 s42, 2
cs_startpoll:
    buffer_load_dword v3, off, s[84:87], 0 offset:212 sc1
    s_sub_u32 s40, s40, 1
    s_cbranch_scc1 cs_decide
    s_waitcnt vmcnt(0)
    v_readfirstlane_b32 s41, v3
    s_nop 1
    s_cmp_lt_u32 s41, 32
    s_cbranch_scc1 cs_startpoll
    s_mov_b32 s42, 1
cs_decide:
    s_mov_b64 exec, -1
cs_noarr:
    s_barrier
    s_mov_b32 m0, 16128
    s_mov_b32 s44, 0x3e0293ee
    s_mov_b32 s45, s44
    s_or_b32 s66, s44, 0x80000000
    s_mov_b32 s48, 0x3f003f00
    s_mov_b32 s49, 0
    s_mov_b32 s50, 0x3f803f80
    s_mov_b32 s51, 0x3f803f80
    s_mov_b32 s52, 512
    s_mov_b32 s53, 1024
    s_mov_b32 s54, 1536
    s_mov_b32 s30, 0
    s_cmp_lg_u32 s32, 0
    s_cselect_b32 s71, s13, 3
    s_mov_b32 s14, 67649536
    s_mov_b32 s15, 67653632
    s_mov_b32 s16, 67657728
    s_mov_b32 s36, 0
    s_add_u32 s17, s68, 67633152
    s_mov_b32 s69, 0
    s_mov_b32 s70, 0
    s_lshl_b32 s26, s12, 14
    s_add_u32 s26, s26, 0
    s_mul_i32 s40, s13, 3072
    s_add_u32 s24, s26, s40
    s_lshl_b32 s40, s12, 14
    s_add_u32 s40, s40, 68681728
    s_add_u32 s18, s40, 0
    s_add_u32 s19, s40, 4096
    s_add_u32 s20, s40, 8192
    s_add_u32 s21, s40, 12288
    s_lshr_b32 s40, s12, 3
    s_lshl_b32 s40, s40, 12
    s_and_b32 s41, s12, 7
    s_lshl_b32 s41, s41, 7
    s_add_u32 s40, s40, s41
    s_add_u32 s22, s40, 68681728
    s_add_u32 s23, s22, 1024
    s_add_u32 s25, s22, 2048
    s_mov_b32 s56, -65528
    s_lshl_b32 s96, s12, 7
    s_add_u32 s29, s96, 125845504
    s_add_u32 s96, s96, 125829120
    s_cmp_lg_u32 s32, 0
    s_cselect_b64 s[38:39], -1, 0
    s_add_u32 s55, s68, 138412032
    s_cmp_eq_u32 s13, 3
    s_cselect_b64 s[100:101], 1, 0
    s_cselect_b64 s[38:39], 1, s[38:39]
    s_cselect_b32 s93, 64, 0
    s_cselect_b32 s55, s29, s55
    s_cselect_b32 s57, 0, 9216
    s_mov_b64 exec, s[100:101]
    v_mov_b32 v72, s95
    s_mov_b64 exec, -1
    s_mov_b32 s34, 0xff00ff00
    s_mov_b32 s35, 0xff00ff00
    s_lshl_b32 s28, s12, 12
    s_add_u32 s28, s28, 7602176
    s_add_u32 s27, s28, 77594624
    s_add_u32 s28, s28, 69206016
    s_mov_b32 s37, s93
    s_mov_b32 s40, 3
    v_bfe_u32 v78, v65, 2, 5
    s_mov_b32 s31, 4194304
cs_kv0:
    buffer_load_dword v77, v78, s[4:7], s96 offen offset:16 sc1
    s_waitcnt vmcnt(0)
    v_subrev_u32 v77, s95, v77
    v_cmp_lt_u32 vcc, 16, v77
    s_nop 1
    v_cndmask_b32 v77, v77, 0, vcc
    v_bfe_u32 v79, v78, 2, 2
    v_lshl_add_u32 v77, v77, 2, v79
    s_nop 1
    v_min_u32_dpp v77, v77, v77 row_ror:1 row_mask:0xf bank_mask:0xf
    s_nop 1
    v_min_u32_dpp v77, v77, v77 row_ror:2 row_mask:0xf bank_mask:0xf
    s_nop 1
    v_min_u32_dpp v77, v77, v77 row_ror:4 row_mask:0xf bank_mask:0xf
    s_nop 0
    v_readfirstlane_b32 s97, v77
    s_sub_u32 s31, s31, 1
    s_cbranch_scc1 cs_kv0_x
    s_cmp_le_u32 s40, s97
    s_cbranch_scc1 cs_kv0_x
    s_sleep 2
    s_branch cs_kv0
cs_kv0_x:
    s_add_u32 s40, s26, 0
    v_lshlrev_b32 v78, 2, v65
    buffer_load_dword v76, v78, s[4:7], s40 offen sc1
    s_add_u32 s40, s26, 524288
    v_lshlrev_b32 v78, 2, v65
    buffer_load_dword v76, v78, s[4:7], s40 offen sc1
    v_mov_b64 v[0:1], 0
    v_mov_b64 v[2:3], 0
    v_mov_b64 v[4:5], 0
    v_mov_b64 v[6:7], 0
    v_mov_b64 v[8:9], 0
    v_mov_b64 v[10:11], 0
    v_mov_b64 v[12:13], 0
    v_mov_b64 v[14:15], 0
    v_mov_b64 v[16:17], 0
    v_mov_b64 v[18:19], 0
    v_mov_b64 v[20:21], 0
    v_mov_b64 v[22:23], 0
    ds_read_b128 v[40:43], v70 offset:0
    ds_read_b128 v[44:47], v70 offset:1024
    ds_read_b128 v[48:51], v70 offset:2048
    ds_read_b128 v[52:55], v70 offset:3072
    ds_read_b128 v[24:27], v70 offset:4096
    ds_read_b128 v[28:31], v70 offset:5120
    ds_read_b128 v[32:35], v70 offset:6144
    ds_read_b128 v[36:39], v70 offset:7168
    buffer_load_dwordx4 v[60:63], v65, s[4:7], s14 offen offset:0 sc1
    buffer_load_dwordx4 v[56:59], v66, s[4:7], s14 offen offset:0 sc1
    s_mov_b32 s31, 1048576
    s_waitcnt vmcnt(0) lgkmcnt(0)
    s_branch cs_goA
cs_loop:
    s_add_u32 s40, s30, 3
    s_min_u32 s40, s40, 64
    s_cmp_le_u32 s40, s97
    s_cbranch_scc0 cs_kvwait
cs_kvok:
    s_mov_b32 s31, 1048576
    s_mov_b32 s69, s70
    s_waitcnt lgkmcnt(0)
cs_cA:
    buffer_load_dwordx4 v[60:63], v65, s[4:7], s14 offen offset:0 sc1
    buffer_load_dwordx4 v[56:59], v66, s[4:7], s14 offen offset:0 sc1
    v_bitop3_b32 v77, v60, v56, s70 bitop3:0x7e
    v_and_b32 v77, 1, v77
    v_cmp_ne_u32 vcc, 0, v77
    s_cbranch_vccz cs_goA
    s_nop 15
    s_nop 15
    s_nop 7
    v_bitop3_b32 v77, v60, v56, s70 bitop3:0x7e
    v_and_b32 v77, 1, v77
    v_cmp_ne_u32 vcc, 0, v77
    s_cbranch_vccz cs_goA
    s_nop 15
    s_nop 15
    s_nop 7
    v_bitop3_b32 v77, v60, v56, s70 bitop3:0x7e
    v_and_b32 v77, 1, v77
    v_cmp_ne_u32 vcc, 0, v77
    s_cbranch_vccz cs_goA
    s_nop 15
    s_nop 15
    s_nop 7
    v_bitop3_b32 v77, v60, v56, s70 bitop3:0x7e
    v_and_b32 v77, 1, v77
    v_cmp_ne_u32 vcc, 0, v77
    s_cbranch_vccz cs_goA
    s_nop 15
    s_nop 15
    s_nop 7
    buffer_load_dwordx4 v[60:63], v65, s[4:7], s14 offen offset:0 sc1
    buffer_load_dwordx4 v[56:59], v66, s[4:7], s14 offen offset:0 sc1
    v_bitop3_b32 v77, v60, v56, s70 bitop3:0x7e
    v_and_b32 v77, 1, v77
    v_cmp_ne_u32 vcc, 0, v77
    s_cbranch_vccz cs_goA
    s_nop 15
    s_nop 15
    s_nop 7
    v_bitop3_b32 v77, v60, v56, s70 bitop3:0x7e
    v_and_b32 v77, 1, v77
    v_cmp_ne_u32 vcc, 0, v77
    s_cbranch_vccz cs_goA
    s_nop 15
    s_nop 15
    s_nop 7
    v_bitop3_b32 v77, v60, v56, s70 bitop3:0x7e
    v_and_b32 v77, 1, v77
    v_cmp_ne_u32 vcc, 0, v77
    s_cbranch_vccz cs_goA
    s_nop 15
    s_nop 15
    s_nop 7
    v_bitop3_b32 v77, v60, v56, s70 bitop3:0x7e
    v_and_b32 v77, 1, v77
    v_cmp_ne_u32 vcc, 0, v77
    s_cbranch_vccz cs_goA
    s_nop 15
    s_nop 15
    s_nop 7
    buffer_load_dwordx4 v[60:63], v65, s[4:7], s14 offen offset:0 sc1
    buffer_load_dwordx4 v[56:59], v66, s[4:7], s14 offen offset:0 sc1
    v_bitop3_b32 v77, v60, v56, s70 bitop3:0x7e
    v_and_b32 v77, 1, v77
    v_cmp_ne_u32 vcc, 0, v77
    s_cbranch_vccz cs_goA
    s_nop 15
    s_nop 15
    s_nop 7
    v_bitop3_b32 v77, v60, v56, s70 bitop3:0x7e
    v_and_b32 v77, 1, v77
    v_cmp_ne_u32 vcc, 0, v77
    s_cbranch_vccz cs_goA
    s_nop 15
    s_nop 15
    s_nop 7
    v_bitop3_b32 v77, v60, v56, s70 bitop3:0x7e
    v_and_b32 v77, 1, v77
    v_cmp_ne_u32 vcc, 0, v77
    s_cbranch_vccz cs_goA
    s_nop 15
    s_nop 15
    s_nop 7
    v_bitop3_b32 v77, v60, v56, s70 bitop3:0x7e
    v_and_b32 v77, 1, v77
    v_cmp_ne_u32 vcc, 0, v77
    s_cbranch_vccz cs_goA
    s_nop 15
    s_nop 15
    s_nop 7
    buffer_load_dwordx4 v[60:63], v65, s[4:7], s14 offen offset:0 sc1
    buffer_load_dwordx4 v[56:59], v66, s[4:7], s14 offen offset:0 sc1
    v_bitop3_b32 v77, v60, v56, s70 bitop3:0x7e
    v_and_b32 v77, 1, v77
    v_cmp_ne_u32 vcc, 0, v77
    s_cbranch_vccz cs_goA
    s_nop 15
    s_nop 15
    s_nop 7
    v_bitop3_b32 v77, v60, v56, s70 bitop3:0x7e
    v_and_b32 v77, 1, v77
    v_cmp_ne_u32 vcc, 0, v77
    s_cbranch_vccz cs_goA
    s_nop 15
    s_nop 15
    s_nop 7
    v_bitop3_b32 v77, v60, v56, s70 bitop3:0x7e
    v_and_b32 v77, 1, v77
    v_cmp_ne_u32 vcc, 0, v77
    s_cbranch_vccz cs_goA
    s_nop 15
    s_nop 15
    s_nop 7
    v_bitop3_b32 v77, v60, v56, s70 bitop3:0x7e
    v_and_b32 v77, 1, v77
    v_cmp_ne_u32 vcc, 0, v77
    s_cbranch_vccz cs_goA
    s_nop 15
    s_nop 15
    s_nop 7
    s_sub_u32 s31, s31, 64
    s_cbranch_scc0 cs_cA
cs_goA:
    ds_write_b128 v65, v[60:63] offset:0
    v_smfmac_f32_16x16x64_bf16 v[0:3], v[60:63], v[40:47], v64
    v_smfmac_f32_16x16x64_bf16 v[4:7], v[60:63], v[48:55], v64
    buffer_load_dwordx4 v[40:43], v65, s[4:7], s15 offen offset:0 sc1
    v_smfmac_f32_16x16x64_bf16 v[0:3], v[56:59], v[24:31], v64
    v_smfmac_f32_16x16x64_bf16 v[4:7], v[56:59], v[32:39], v64
    ds_read_b128 v[24:27], v70 offset:8192
    v_smfmac_f32_16x16x64_bf16 v[8:11], v[60:63], a[96:103], v64
    ds_read_b128 v[28:31], v70 offset:9216
    v_smfmac_f32_16x16x64_bf16 v[12:15], v[60:63], a[104:111], v64
    ds_read_b128 v[32:35], v70 offset:10240
    s_waitcnt lgkmcnt(3)
    s_barrier
    ds_read_b128 v[48:51], v67 offset:0
    v_smfmac_f32_16x16x64_bf16 v[8:11], v[56:59], a[112:119], v64
    ds_read_b128 v[36:39], v70 offset:11264
    v_smfmac_f32_16x16x64_bf16 v[12:15], v[56:59], a[120:127], v64
    ds_read_b128 v[52:55], v68 offset:0
    v_smfmac_f32_16x16x64_bf16 v[16:19], v[60:63], a[216:223], v64
    buffer_load_dwordx4 v[40:43], v65, s[4:7], s15 offen offset:0 sc1
    s_waitcnt lgkmcnt(4)
    v_smfmac_f32_16x16x64_bf16 v[20:23], v[60:63], v[24:31], v64
    ds_read_b128 v[24:27], v70 offset:12288
    s_waitcnt lgkmcnt(3)
    v_smfmac_f32_16x16x64_bf16 v[0:3], v[48:51], a[0:7], v64
    ds_read_b128 v[28:31], v70 offset:13312
    s_waitcnt lgkmcnt(3)
    v_smfmac_f32_16x16x64_bf16 v[4:7], v[48:51], v[32:39], v64
    ds_read_b128 v[32:35], v70 offset:14336
    v_smfmac_f32_16x16x64_bf16 v[8:11], v[48:51], a[128:135], v64
    ds_read_b128 v[36:39], v70 offset:15360
    v_smfmac_f32_16x16x64_bf16 v[12:15], v[48:51], a[136:143], v64
    v_smfmac_f32_16x16x64_bf16 v[16:19], v[56:59], a[224:231], v64
    v_smfmac_f32_16x16x64_bf16 v[20:23], v[56:59], a[232:239], v64
    s_waitcnt lgkmcnt(2)
    s_waitcnt vmcnt(1)
    v_and_b32 v77, s36, v40
    v_smfmac_f32_16x16x64_bf16 v[12:15], v[52:55], v[24:31], v64
    ds_write_b128 v65, v[40:43] offset:4096
    v_smfmac_f32_16x16x64_bf16 v[0:3], v[52:55], a[8:15], v64
    s_waitcnt lgkmcnt(1)
    v_cmp_ne_u32 vcc, s70, v77
    v_smfmac_f32_16x16x64_bf16 v[4:7], v[52:55], v[32:39], v64
    buffer_load_dwordx4 v[60:63], v65, s[4:7], s16 offen offset:0 sc1
    v_smfmac_f32_16x16x64_bf16 v[8:11], v[52:55], a[144:151], v64
    s_cbranch_vccnz cs_spinB
cs_backB:
    v_smfmac_f32_16x16x64_bf16 v[16:19], v[40:43], v[176:183], v64
    s_waitcnt lgkmcnt(0)
    s_barrier
    ds_read_b128 v[44:47], v66 offset:4096
    v_smfmac_f32_16x16x64_bf16 v[12:15], v[40:43], a[160:167], v64
    ds_read_b128 v[32:35], v70 offset:16384
    buffer_load_dwordx4 v[24:27], v65, s[4:7], s24 offen offset:0 sc1
    v_smfmac_f32_16x16x64_bf16 v[0:3], v[40:43], a[16:23], v64
    ds_read_b128 v[36:39], v70 offset:17408
    v_smfmac_f32_16x16x64_bf16 v[8:11], v[40:43], a[152:159], v64
    ds_read_b128 v[48:51], v67 offset:4096
    v_smfmac_f32_16x16x64_bf16 v[4:7], v[40:43], a[24:31], v64
    ds_read_b128 v[52:55], v68 offset:4096
    v_smfmac_f32_16x16x64_bf16 v[20:23], v[40:43], v[184:191], v64
    buffer_load_dwordx4 v[28:31], v65, s[4:7], s24 offen offset:1024 sc1
    s_waitcnt lgkmcnt(4)
    v_smfmac_f32_16x16x64_bf16 v[0:3], v[44:47], a[32:39], v64
    ds_read_b128 v[56:59], v69 offset:15360
    s_waitcnt lgkmcnt(3)
    v_smfmac_f32_16x16x64_bf16 v[8:11], v[44:47], v[32:39], v64
    ds_read_b128 v[32:35], v70 offset:18432
    v_smfmac_f32_16x16x64_bf16 v[4:7], v[44:47], a[40:47], v64
    ds_read_b128 v[36:39], v70 offset:19456
    s_add_u32 s40, s26, 1048576
    v_lshlrev_b32 v78, 2, v65
    v_smfmac_f32_16x16x64_bf16 v[12:15], v[44:47], a[168:175], v64
    buffer_load_dwordx4 v[42:45], v65, s[4:7], s24 offen offset:3072 sc1
    s_waitcnt lgkmcnt(3)
    v_smfmac_f32_16x16x64_bf16 v[0:3], v[48:51], a[48:55], v64
    v_smfmac_f32_16x16x64_bf16 v[8:11], v[48:51], a[176:183], v64
    v_smfmac_f32_16x16x64_bf16 v[0:3], v[52:55], a[64:71], v64
    s_waitcnt lgkmcnt(0)
    v_smfmac_f32_16x16x64_bf16 v[8:11], v[52:55], v[32:39], v64
    buffer_load_dwordx4 v[34:37], v65, s[4:7], s24 offen offset:2048 sc1
    v_smfmac_f32_16x16x64_bf16 v[4:7], v[48:51], a[56:63], v64
    v_smfmac_f32_16x16x64_bf16 v[4:7], v[52:55], a[72:79], v64
    s_waitcnt vmcnt(4)
    v_and_b32 v77, s36, v60
    v_smfmac_f32_16x16x64_bf16 v[12:15], v[48:51], a[184:191], v64
    v_cmp_ne_u32 vcc, s70, v77
    v_smfmac_f32_16x16x64_bf16 v[12:15], v[52:55], a[192:199], v64
    s_cbranch_vccnz cs_spin8
cs_back8:
    v_smfmac_f32_16x16x64_bf16 v[0:3], v[60:63], a[80:87], v64
    s_nop 1
    v_lshrrev_b32 v77, 1, v69
    v_smfmac_f32_16x16x64_bf16 v[8:11], v[60:63], a[200:207], v64
    buffer_load_dword v76, v78, s[4:7], s40 offen sc1
    s_nop 1
    v_smfmac_f32_16x16x64_bf16 v[4:7], v[60:63], a[88:95], v64
    s_nop 1
    v_cvt_pk_bf16_f32 v0, v0, v1
    v_smfmac_f32_16x16x64_bf16 v[12:15], v[60:63], a[208:215], v64
    s_nop 1
    v_cvt_pk_bf16_f32 v1, v2, v3
    v_cvt_pk_bf16_f32 v2, v8, v9
    v_cvt_pk_bf16_f32 v3, v10, v11
    v_cvt_pk_bf16_f32 v4, v4, v5
    v_cvt_pk_bf16_f32 v5, v6, v7
    v_mfma_f32_16x16x32_bf16 v[8:11], v[0:3], v[56:59], 0
    v_cvt_pk_bf16_f32 v6, v12, v13
    v_cvt_pk_bf16_f32 v7, v14, v15
    s_nop 1
    v_mfma_f32_16x16x32_bf16 v[12:15], v[4:7], v[56:59], 0
    ds_read_b128 v[56:59], v66 offset:4096
    s_nop 1
    v_smfmac_f32_16x16x64_bf16 v[16:19], v[48:51], v[208:215], v64
    s_waitcnt vmcnt(3)
    s_nop 0
    v_cvt_pk_bf16_f32 v0, v8, v9
    v_cvt_pk_bf16_f32 v1, v10, v11
    v_cvt_pk_bf16_f32 v2, v12, v13
    v_cvt_pk_bf16_f32 v3, v14, v15
    s_nop 1
    v_mfma_f32_16x16x32_bf16 v[12:15], v[0:3], v[0:3], 0
    s_nop 2
    v_mfma_f32_16x16x32_bf16 v[4:7], v[24:27], v[0:3], 0
    ds_read_b128 v[24:27], v67 offset:0
    s_nop 1
    v_mfma_f32_16x16x32_bf16 v[8:11], v[28:31], v[0:3], 0
    s_nop 0
    v_mov_b32_dpp v12, v14 row_ror:8 row_mask:0xf bank_mask:0xc
    v_mov_b32_dpp v13, v15 row_ror:8 row_mask:0xf bank_mask:0xc
    v_smfmac_f32_16x16x64_bf16 v[20:23], v[48:51], v[216:223], v64
    ds_write_b64 v71, v[12:13]
    ds_read_b128 v[48:51], v68 offset:0
    s_nop 1
    v_mov_b32_dpp v4, v8 row_ror:8 row_mask:0xf bank_mask:0xc
    v_mov_b32_dpp v5, v9 row_ror:8 row_mask:0xf bank_mask:0xc
    v_mov_b32_dpp v6, v10 row_ror:8 row_mask:0xf bank_mask:0xc
    v_mov_b32_dpp v7, v11 row_ror:8 row_mask:0xf bank_mask:0xc
    v_smfmac_f32_16x16x64_bf16 v[16:19], v[52:55], v[224:231], v64
    ds_write_b128 v65, v[4:7] offset:8192
    v_smfmac_f32_16x16x64_bf16 v[20:23], v[52:55], v[232:239], v64
    s_waitcnt lgkmcnt(3)
    v_smfmac_f32_16x16x64_bf16 v[16:19], v[24:27], a[240:247], v64
    s_waitcnt vmcnt(1)
    s_cmp_ge_u32 s30, 58
    v_smfmac_f32_16x16x64_bf16 v[20:23], v[24:27], a[248:255], v64
    s_cbranch_scc1 cs_pubk
cs_pubk_x:
    v_smfmac_f32_16x16x64_bf16 v[16:19], v[60:63], v[240:247], v64
    s_waitcnt lgkmcnt(0)
    s_barrier
    ds_read_b128 v[8:11], v66 offset:8192
    v_smfmac_f32_16x16x64_bf16 v[20:23], v[60:63], v[248:255], v64
    ds_read_b128 v[12:15], v67 offset:8192
    ds_read_b128 v[0:3], v68 offset:8192
    ds_read_b64 v[24:25], v77 offset:14336
    v_smfmac_f32_16x16x64_bf16 v[16:19], v[56:59], v[192:199], v64
    ds_read_b64 v[26:27], v77 offset:14592
    ds_read_b64 v[28:29], v77 offset:14848
    ds_read_b64 v[30:31], v77 offset:15104
    v_smfmac_f32_16x16x64_bf16 v[20:23], v[56:59], v[200:207], v64
    s_cmp_lg_u32 s37, 0
    v_smfmac_f32_16x16x64_bf16 v[16:19], v[48:51], v[160:167], v64
    s_mov_b64 exec, s[38:39]
    buffer_store_dword v72, v75, s[4:7], s55 offen sc1
    s_mov_b64 exec, -1
    v_smfmac_f32_16x16x64_bf16 v[20:23], v[48:51], v[168:175], v64
    s_cbranch_scc1 cs_rare
cs_rare_x:
    ds_read_b128 v[56:59], v70 offset:22528
    ds_read_b128 v[60:63], v70 offset:23552
    s_cmp_ge_u32 s30, 58
    s_waitcnt lgkmcnt(8)
    v_pk_add_f32 v[4:5], v[4:5], v[8:9]
    v_pk_add_f32 v[6:7], v[6:7], v[10:11]
    s_waitcnt lgkmcnt(6)
    v_pk_add_f32 v[12:13], v[12:13], v[0:1]
    v_pk_add_f32 v[14:15], v[14:15], v[2:3]
    v_pk_add_f32 v[4:5], v[4:5], v[12:13]
    v_pk_add_f32 v[6:7], v[6:7], v[14:15]
    s_waitcnt lgkmcnt(2)
    v_pk_add_f32 v[24:25], v[24:25], v[26:27]
    v_pk_add_f32 v[28:29], v[28:29], v[30:31]
    v_max3_f32 v77, v4, v5, v6
    v_pk_add_f32 v[24:25], v[24:25], v[28:29]
    v_max_f32 v77, v77, v7
    v_max3_f32 v77, v77, v24, v25
    v_cvt_pk_bf16_f32 v38, v16, v17
    v_cvt_pk_bf16_f32 v39, v18, v19
    v_max_f32_dpp v77, v77, v77 row_ror:8 row_mask:0xf bank_mask:0xf
    v_mov_b32 v78, v77
    v_cvt_pk_bf16_f32 v40, v20, v21
    v_cvt_pk_bf16_f32 v41, v22, v23
    v_permlane32_swap_b32 v77, v78
    v_max_f32 v77, v77, v78
    v_mov_b32 v78, v77
    v_mov_b32 v11, 0
    v_mov_b32 v32, v38
    v_permlane16_swap_b32 v77, v78
    v_max_f32 v77, v77, v78
    v_mul_f32 v8, s66, v77
    v_pk_fma_f32 v[4:5], v[4:5], s[44:45], v[8:9] op_sel_hi:[1,1,0]
    v_pk_fma_f32 v[6:7], v[6:7], s[44:45], v[8:9] op_sel_hi:[1,1,0]
    v_pk_fma_f32 v[24:25], v[24:25], s[44:45], v[8:9] op_sel_hi:[1,1,0]
    v_exp_f32 v4, v4
    v_exp_f32 v5, v5
    v_exp_f32 v6, v6
    v_exp_f32 v7, v7
    v_exp_f32 v24, v24
    v_exp_f32 v25, v25
    v_cvt_pk_bf16_f32 v12, v4, v5
    v_cvt_pk_bf16_f32 v13, v6, v7
    v_cvt_pk_bf16_f32 v10, v24, v25
    v_cvt_pk_bf16_f32 v15, v24, v25
    v_mov_b32 v14, 0
    v_mfma_f32_16x16x32_bf16 v[4:7], v[32:35], v[10:13], 0
    s_cbranch_scc1 cs_pubv
cs_pubv_x:
    v_mov_b64 v[0:1], s[48:49]
    v_mov_b64 v[2:3], s[50:51]
    v_mfma_f32_16x16x32_bf16 v[24:27], v[36:39], v[12:15], 0
    ds_read_b128 v[48:51], v70 offset:20480
    v_mov_b32 v47, v41
    v_bitop3_b32 v77, v73, -9, s52 bitop3:0x6a
    v_mfma_f32_16x16x32_bf16 v[28:31], v[0:3], v[10:13], 0
    ds_read_b128 v[52:55], v70 offset:21504
    v_mov_b64 v[0:1], 0
    v_mov_b64 v[2:3], 0
    v_mfma_f32_16x16x32_bf16 v[16:19], v[40:43], v[10:13], 0
    ds_read_b128 v[32:35], v70 offset:24576
    v_bitop3_b32 v78, v73, -9, s53 bitop3:0x6a
    v_bitop3_b32 v79, v73, -9, s54 bitop3:0x6a
    v_mfma_f32_16x16x32_bf16 v[20:23], v[44:47], v[12:15], 0
    ds_read_b128 v[36:39], v70 offset:25600
    v_add_f32_dpp v4, v24, v4 row_ror:8 row_mask:0xf bank_mask:0xf
    v_add_f32_dpp v5, v25, v5 row_ror:8 row_mask:0xf bank_mask:0xf
    v_add_f32_dpp v6, v26, v6 row_ror:8 row_mask:0xf bank_mask:0xf
    v_add_f32_dpp v7, v27, v7 row_ror:8 row_mask:0xf bank_mask:0xf
    v_add_f32_dpp v29, v28, v28 row_ror:8 row_mask:0xf bank_mask:0xf
    v_rcp_f32 v28, v29
    s_nop 0
    v_add_f32_dpp v4, v16, v20 row_ror:8 row_mask:0xf bank_mask:0xc
    v_add_f32_dpp v5, v17, v21 row_ror:8 row_mask:0xf bank_mask:0xc
    v_add_f32_dpp v6, v18, v22 row_ror:8 row_mask:0xf bank_mask:0xc
    v_add_f32_dpp v7, v19, v23 row_ror:8 row_mask:0xf bank_mask:0xc
    v_pk_mul_f32 v[4:5], v[4:5], v[28:29] op_sel_hi:[1,0]
    v_pk_mul_f32 v[6:7], v[6:7], v[28:29] op_sel_hi:[1,0]
    v_cvt_pk_bf16_f32 v4, v4, v5
    v_cvt_pk_bf16_f32 v5, v6, v7
    ds_write_b64 v73, v[4:5] offset:12288
    v_mov_b32_dpp v6, v4 row_ror:8 row_mask:0xf bank_mask:0xf
    v_mov_b32_dpp v7, v5 row_ror:8 row_mask:0xf bank_mask:0xf
    v_mov_b64 v[8:9], 0
    v_mov_b64 v[10:11], 0
    s_waitcnt lgkmcnt(3)
    v_smfmac_f32_16x16x64_bf16 v[0:3], v[4:7], v[48:55], v64
    ds_read_b128 v[40:43], v70 offset:26624
    v_mov_b64 v[12:13], 0
    v_mov_b64 v[14:15], 0
    v_mov_b32 v52, v78
    v_smfmac_f32_16x16x64_bf16 v[8:11], v[4:7], v[80:87], v64
    ds_read_b128 v[44:47], v70 offset:27648
    v_mov_b64 v[24:25], 0
    v_mov_b64 v[26:27], 0
    v_smfmac_f32_16x16x64_bf16 v[12:15], v[4:7], v[112:119], v64
    s_waitcnt lgkmcnt(2)
    v_mov_b32_dpp v52, v79 quad_perm:[0,1,2,3] row_mask:0xf bank_mask:0xc
    v_xor_b32 v48, 1024, v52
    s_barrier
    ds_read_b128 v[16:19], v77 offset:12288
    v_smfmac_f32_16x16x64_bf16 v[24:27], v[4:7], v[56:63], v64
    ds_read_b128 v[20:23], v78 offset:12288
    ds_read_b128 v[28:31], v79 offset:12288
    ds_read_b128 v[52:55], v52 offset:12288
    ds_read_b128 v[48:51], v48 offset:12288
    v_mov_b64 v[4:5], 0
    v_mov_b64 v[6:7], 0
    s_waitcnt lgkmcnt(4)
    v_smfmac_f32_16x16x64_bf16 v[8:11], v[16:19], v[88:95], v64
    ds_read_b128 v[56:59], v70 offset:28672
    v_smfmac_f32_16x16x64_bf16 v[12:15], v[16:19], v[120:127], v64
    ds_read_b128 v[60:63], v70 offset:29696
    s_waitcnt lgkmcnt(5)
    v_smfmac_f32_16x16x64_bf16 v[8:11], v[20:23], v[96:103], v64
    v_bfe_u32 v77, v74, 16, 1
    v_smfmac_f32_16x16x64_bf16 v[12:15], v[20:23], v[128:135], v64
    s_waitcnt lgkmcnt(4)
    v_mad_i32_i24 v77, v77, s56, v74
    v_smfmac_f32_16x16x64_bf16 v[8:11], v[28:31], v[104:111], v64
    s_nop 2
    v_smfmac_f32_16x16x64_bf16 v[12:15], v[28:31], v[136:143], v64
    s_waitcnt lgkmcnt(2)
    s_nop 1
    v_smfmac_f32_16x16x64_bf16 v[4:7], v[48:51], v[144:151], v64
    v_cvt_pk_bf16_f32 v8, v8, v9
    v_cvt_pk_bf16_f32 v9, v10, v11
    v_and_or_b32 v8, v8, -2, s69
    s_nop 0
    v_cvt_pk_bf16_f32 v10, v12, v13
    v_cvt_pk_bf16_f32 v11, v14, v15
    v_smfmac_f32_16x16x64_bf16 v[4:7], v[52:55], v[152:159], v64
    buffer_store_dwordx4 v[8:11], v74, s[4:7], s22 offen sc1
    ds_read_b128 v[48:51], v70 offset:30720
    v_smfmac_f32_16x16x64_bf16 v[0:3], v[16:19], v[32:39], v64
    ds_read_b128 v[52:55], v70 offset:31744
    s_add_u32 s30, s30, 1
    s_waitcnt lgkmcnt(2)
    v_smfmac_f32_16x16x64_bf16 v[24:27], v[16:19], v[40:47], v64
    ds_read_b128 v[32:35], v70 offset:32768
    v_cvt_pk_bf16_f32 v4, v4, v5
    v_cvt_pk_bf16_f32 v5, v6, v7
    v_and_or_b32 v4, v4, -2, s69
    v_smfmac_f32_16x16x64_bf16 v[0:3], v[20:23], v[56:63], v64
    buffer_store_dwordx2 v[4:5], v77, s[4:7], s25 offen sc1
    ds_read_b128 v[36:39], v70 offset:33792
    s_xor_b32 s70, s70, 1
    ds_read_b128 v[40:43], v70 offset:34816
    s_waitcnt lgkmcnt(3)
    v_smfmac_f32_16x16x64_bf16 v[24:27], v[20:23], v[48:55], v64
    ds_read_b128 v[44:47], v70 offset:35840
    s_waitcnt lgkmcnt(2)
    v_smfmac_f32_16x16x64_bf16 v[0:3], v[28:31], v[32:39], v64
    s_cmp_lg_u32 s71, 0
    s_waitcnt lgkmcnt(0)
    s_nop 0
    v_smfmac_f32_16x16x64_bf16 v[24:27], v[28:31], v[40:47], v64
    s_nop 3
    v_cvt_pk_bf16_f32 v0, v0, v1
    v_cvt_pk_bf16_f32 v1, v2, v3
    v_and_or_b32 v0, v0, -2, s69
    s_nop 0
    v_cvt_pk_bf16_f32 v2, v24, v25
    v_cvt_pk_bf16_f32 v3, v26, v27
    buffer_store_dwordx4 v[0:3], v74, s[4:7], s23 offen sc1
    s_cbranch_scc1 cs_e1
    s_nop 0
    s_nop 2
    v_mov_b32 v79, v79
    s_nop 2
    v_mov_b32 v79, v79
    s_nop 2
    v_mov_b32 v79, v79
    s_nop 2
    v_mov_b32 v79, v79
    s_nop 2
    v_mov_b32 v79, v79
    s_nop 2
    v_mov_b32 v79, v79
    s_nop 2
    v_mov_b32 v79, v79
    s_nop 2
    v_mov_b32 v79, v79
    s_nop 2
    v_mov_b32 v79, v79
    s_nop 2
    v_mov_b32 v79, v79
    s_nop 2
    v_mov_b32 v79, v79
    s_nop 2
    v_mov_b32 v79, v79
    s_nop 2
    v_mov_b32 v79, v79
    s_nop 2
    v_mov_b32 v79, v79
    s_nop 2
    v_mov_b32 v79, v79
    s_nop 2
    v_mov_b32 v79, v79
    s_nop 2
    v_mov_b32 v79, v79
    s_nop 2
    v_mov_b32 v79, v79
    s_nop 2
    v_mov_b32 v79, v79
    s_nop 2
    v_mov_b32 v79, v79
    s_nop 2
    v_mov_b32 v79, v79
    s_nop 2
    v_mov_b32 v79, v79
    s_nop 2
    v_mov_b32 v79, v79
    s_nop 2
    v_mov_b32 v79, v79
    s_nop 2
    v_mov_b32 v79, v79
    s_nop 2
    v_mov_b32 v79, v79
    s_nop 2
    v_mov_b32 v79, v79
    s_nop 2
    v_mov_b32 v79, v79
    s_nop 2
    v_mov_b32 v79, v79
    s_nop 2
    v_mov_b32 v79, v79
    s_nop 2
    v_mov_b32 v79, v79
    s_nop 2
    v_mov_b32 v79, v79
    s_nop 2
    v_mov_b32 v79, v79
    s_nop 2
    v_mov_b32 v79, v79
    s_nop 2
    v_mov_b32 v79, v79
    s_nop 2
    v_mov_b32 v79, v79
    s_nop 2
    v_mov_b32 v79, v79
    s_nop 0
    v_mov_b32 v79, v79
    buffer_load_dwordx4 v[8:11], v65, s[4:7], s18 offen sc1
    buffer_load_dwordx4 v[12:15], v65, s[4:7], s19 offen sc1
    buffer_load_dwordx4 v[16:19], v65, s[4:7], s20 offen sc1
    buffer_load_dwordx4 v[20:23], v65, s[4:7], s21 offen sc1
    v_and_b32 v77, 255, v69
    ds_read_b128 v[4:7], v77 offset:15872
    ds_read_b128 v[40:43], v70 offset:0
    ds_read_b128 v[44:47], v70 offset:1024
    ds_read_b128 v[48:51], v70 offset:2048
    ds_read_b128 v[52:55], v70 offset:3072
    ds_read_b128 v[24:27], v70 offset:4096
    ds_read_b128 v[28:31], v70 offset:5120
    ds_read_b128 v[32:35], v70 offset:6144
    ds_read_b128 v[36:39], v70 offset:7168
    s_mov_b32 s31, 65536
    s_add_u32 s24, s24, 524288
    s_add_u32 s26, s26, 524288
    s_add_u32 s55, s55, s57
    s_cmp_lt_u32 s97, s93
    s_cselect_b32 s37, 1, 0
    s_cmp_eq_u32 s30, 63
    s_cselect_b32 s37, 1, s37
    s_mov_b32 s14, 67633152
    s_mov_b32 s15, 67637248
    s_mov_b32 s16, 67641344
    s_mov_b32 s36, 1
    v_mov_b32 v60, s69
    v_mov_b32 v56, s69
    v_and_b32 v79, 12, v75
    v_cmp_eq_u32 vcc, 0, v79
    s_nop 1
    v_cndmask_b32 v79, 0, 1, vcc
    s_waitcnt lgkmcnt(0)
    s_waitcnt vmcnt(3)
    v_xor_b32 v77, s69, v8
    v_mfma_f32_16x16x32_bf16 v[0:3], v[4:7], v[8:11], 0
    s_waitcnt vmcnt(2)
    v_bitop3_b32 v77, v77, v12, s69 bitop3:0xf6
    v_mfma_f32_16x16x32_bf16 v[0:3], v[4:7], v[12:15], v[0:3]
    s_waitcnt vmcnt(1)
    v_bitop3_b32 v77, v77, v16, s69 bitop3:0xf6
    v_mfma_f32_16x16x32_bf16 v[0:3], v[4:7], v[16:19], v[0:3]
    s_waitcnt vmcnt(0)
    v_bitop3_b32 v77, v77, v20, s69 bitop3:0xf6
    v_mfma_f32_16x16x32_bf16 v[0:3], v[4:7], v[20:23], v[0:3]
    v_and_b32 v77, 1, v77
    v_cmp_ne_u32 vcc, 0, v77
    s_nop 0
    s_cmp_eq_u64 vcc, 0
    s_cselect_b64 s[42:43], -1, 0
    s_nop 2
    v_add_f32_dpp v0, v0, v0 row_ror:8 row_mask:0xf bank_mask:0xf
    v_add_f32_dpp v1, v1, v1 row_ror:8 row_mask:0xf bank_mask:0xf
    s_mov_b64 exec, s[42:43]
    v_cvt_pk_bf16_f32 v72, v0, v1
    v_bfi_b32 v72, v79, s70, v72
    buffer_store_dword v72, v75, s[4:7], s17 offen offset:0 sc1
    s_mov_b64 exec, -1
    s_cbranch_scc0 cs_f0_retry
cs_f0_go:
    v_mov_b64 v[0:1], 0
    v_mov_b64 v[2:3], 0
    v_mov_b64 v[4:5], 0
    v_mov_b64 v[6:7], 0
    v_mov_b64 v[8:9], 0
    v_mov_b64 v[10:11], 0
    v_mov_b64 v[12:13], 0
    v_mov_b64 v[14:15], 0
    v_mov_b64 v[16:17], 0
    v_mov_b64 v[18:19], 0
    v_mov_b64 v[20:21], 0
    v_mov_b64 v[22:23], 0
    s_nop 2
    v_mov_b32 v79, v79
    s_nop 2
    v_mov_b32 v79, v79
    s_nop 2
    v_mov_b32 v79, v79
    s_nop 2
    v_mov_b32 v79, v79
    s_nop 2
    v_mov_b32 v79, v79
    s_nop 2
    v_mov_b32 v79, v79
    s_nop 2
    v_mov_b32 v79, v79
    s_nop 2
    v_mov_b32 v79, v79
    s_nop 2
    v_mov_b32 v79, v79
    s_nop 2
    v_mov_b32 v79, v79
    s_nop 2
    v_mov_b32 v79, v79
    s_nop 2
    v_mov_b32 v79, v79
    s_nop 2
    v_mov_b32 v79, v79
    s_nop 2
    v_mov_b32 v79, v79
    s_nop 2
    v_mov_b32 v79, v79
    s_nop 2
    v_mov_b32 v79, v79
    s_nop 2
    v_mov_b32 v79, v79
    s_nop 2
    v_mov_b32 v79, v79
    s_nop 2
    v_mov_b32 v79, v79
    s_nop 2
    v_mov_b32 v79, v79
    s_nop 2
    v_mov_b32 v79, v79
    s_nop 2
    v_mov_b32 v79, v79
    s_nop 2
    v_mov_b32 v79, v79
    s_nop 2
    v_mov_b32 v79, v79
    s_nop 2
    v_mov_b32 v79, v79
    s_branch cs_loop
cs_e1:
    s_cmp_lg_u32 s71, 2
    s_cbranch_scc1 cs_f1
    s_nop 2
    v_mov_b32 v79, v79
    s_nop 2
    v_mov_b32 v79, v79
    s_nop 2
    v_mov_b32 v79, v79
    s_nop 2
    v_mov_b32 v79, v79
    s_nop 2
    v_mov_b32 v79, v79
    s_nop 2
    v_mov_b32 v79, v79
    s_nop 2
    v_mov_b32 v79, v79
    s_nop 2
    v_mov_b32 v79, v79
    s_nop 2
    v_mov_b32 v79, v79
    s_nop 2
    v_mov_b32 v79, v79
    s_nop 2
    v_mov_b32 v79, v79
    s_nop 2
    v_mov_b32 v79, v79
    s_nop 2
    v_mov_b32 v79, v79
    s_nop 2
    v_mov_b32 v79, v79
    s_nop 2
    v_mov_b32 v79, v79
    s_nop 2
    v_mov_b32 v79, v79
    s_nop 2
    v_mov_b32 v79, v79
    s_nop 2
    v_mov_b32 v79, v79
    s_nop 2
    v_mov_b32 v79, v79
    s_nop 2
    v_mov_b32 v79, v79
    s_nop 2
    v_mov_b32 v79, v79
    s_nop 2
    v_mov_b32 v79, v79
    s_nop 2
    v_mov_b32 v79, v79
    s_nop 2
    v_mov_b32 v79, v79
    s_nop 2
    v_mov_b32 v79, v79
    s_nop 2
    v_mov_b32 v79, v79
    s_nop 2
    v_mov_b32 v79, v79
    s_nop 2
    v_mov_b32 v79, v79
    s_nop 2
    v_mov_b32 v79, v79
    s_nop 2
    v_mov_b32 v79, v79
    s_nop 2
    v_mov_b32 v79, v79
    s_nop 2
    v_mov_b32 v79, v79
    s_nop 2
    v_mov_b32 v79, v79
    s_nop 2
    v_mov_b32 v79, v79
    s_nop 2
    v_mov_b32 v79, v79
    s_nop 2
    v_mov_b32 v79, v79
    s_nop 2
    v_mov_b32 v79, v79
    s_nop 0
    v_mov_b32 v79, v79
    buffer_load_dwordx4 v[8:11], v65, s[4:7], s18 offen sc1
    buffer_load_dwordx4 v[12:15], v65, s[4:7], s19 offen sc1
    buffer_load_dwordx4 v[16:19], v65, s[4:7], s20 offen sc1
    buffer_load_dwordx4 v[20:23], v65, s[4:7], s21 offen sc1
    v_and_b32 v77, 255, v69
    ds_read_b128 v[4:7], v77 offset:15872
    ds_read_b128 v[40:43], v70 offset:0
    ds_read_b128 v[44:47], v70 offset:1024
    ds_read_b128 v[48:51], v70 offset:2048
    ds_read_b128 v[52:55], v70 offset:3072
    ds_read_b128 v[24:27], v70 offset:4096
    ds_read_b128 v[28:31], v70 offset:5120
    ds_read_b128 v[32:35], v70 offset:6144
    ds_read_b128 v[36:39], v70 offset:7168
    s_mov_b32 s31, 65536
    s_add_u32 s24, s24, 524288
    s_add_u32 s26, s26, 524288
    s_add_u32 s55, s55, s57
    s_cmp_lt_u32 s97, s93
    s_cselect_b32 s37, 1, 0
    s_cmp_eq_u32 s30, 63
    s_cselect_b32 s37, 1, s37
    s_mov_b32 s14, 67633152
    s_mov_b32 s15, 67637248
    s_mov_b32 s16, 67641344
    s_mov_b32 s36, 1
    v_mov_b32 v60, s69
    v_mov_b32 v56, s69
    v_and_b32 v79, 12, v75
    v_cmp_eq_u32 vcc, 0, v79
    s_nop 1
    v_cndmask_b32 v79, 0, 1, vcc
    s_waitcnt lgkmcnt(0)
    s_waitcnt vmcnt(3)
    v_xor_b32 v77, s69, v8
    v_bitop3_b32 v77, v77, v10, s69 bitop3:0xf6
    v_mfma_f32_16x16x32_bf16 v[0:3], v[4:7], v[8:11], 0
    s_waitcnt vmcnt(2)
    v_bitop3_b32 v77, v77, v12, s69 bitop3:0xf6
    v_bitop3_b32 v77, v77, v14, s69 bitop3:0xf6
    v_mfma_f32_16x16x32_bf16 v[0:3], v[4:7], v[12:15], v[0:3]
    s_waitcnt vmcnt(1)
    v_bitop3_b32 v77, v77, v16, s69 bitop3:0xf6
    v_bitop3_b32 v77, v77, v18, s69 bitop3:0xf6
    v_mfma_f32_16x16x32_bf16 v[0:3], v[4:7], v[16:19], v[0:3]
    s_waitcnt vmcnt(0)
    v_bitop3_b32 v77, v77, v20, s69 bitop3:0xf6
    v_bitop3_b32 v77, v77, v22, s69 bitop3:0xf6
    v_mfma_f32_16x16x32_bf16 v[0:3], v[4:7], v[20:23], v[0:3]
    v_and_b32 v77, 1, v77
    v_cmp_ne_u32 vcc, 0, v77
    s_nop 0
    s_cmp_eq_u64 vcc, 0
    s_cselect_b64 s[42:43], -1, 0
    s_nop 2
    v_add_f32 v2, v0, v1
    s_nop 1
    v_add_f32_dpp v2, v2, v2 row_ror:8 row_mask:0xf bank_mask:0xf
    s_nop 1
    v_mov_b32_dpp v0, v2 quad_perm:[0,0,2,2] row_mask:0xf bank_mask:0xf
    v_mov_b32_dpp v1, v2 quad_perm:[1,1,3,3] row_mask:0xf bank_mask:0xf
    s_mov_b64 exec, s[42:43]
    v_cvt_pk_bf16_f32 v72, v0, v1
    v_bfi_b32 v72, v79, s70, v72
    buffer_store_dword v72, v75, s[4:7], s17 offen offset:0 sc1
    buffer_store_dword v72, v75, s[4:7], s17 offen offset:1024 sc1
    buffer_store_dword v72, v75, s[4:7], s17 offen offset:2048 sc1
    buffer_store_dword v72, v75, s[4:7], s17 offen offset:3072 sc1
    s_mov_b64 exec, -1
    s_cbranch_scc0 cs_f2_retry
cs_f2_go:
    v_mov_b64 v[0:1], 0
    v_mov_b64 v[2:3], 0
    v_mov_b64 v[4:5], 0
    v_mov_b64 v[6:7], 0
    v_mov_b64 v[8:9], 0
    v_mov_b64 v[10:11], 0
    v_mov_b64 v[12:13], 0
    v_mov_b64 v[14:15], 0
    v_mov_b64 v[16:17], 0
    v_mov_b64 v[18:19], 0
    v_mov_b64 v[20:21], 0
    v_mov_b64 v[22:23], 0
    s_nop 2
    v_mov_b32 v79, v79
    s_nop 2
    v_mov_b32 v79, v79
    s_nop 2
    v_mov_b32 v79, v79
    s_nop 2
    v_mov_b32 v79, v79
    s_nop 2
    v_mov_b32 v79, v79
    s_nop 2
    v_mov_b32 v79, v79
    s_nop 2
    v_mov_b32 v79, v79
    s_nop 2
    v_mov_b32 v79, v79
    s_nop 2
    v_mov_b32 v79, v79
    s_nop 2
    v_mov_b32 v79, v79
    s_nop 2
    v_mov_b32 v79, v79
    s_nop 2
    v_mov_b32 v79, v79
    s_nop 2
    v_mov_b32 v79, v79
    s_nop 2
    v_mov_b32 v79, v79
    s_nop 2
    v_mov_b32 v79, v79
    s_nop 2
    v_mov_b32 v79, v79
    s_nop 2
    v_mov_b32 v79, v79
    s_nop 2
    v_mov_b32 v79, v79
    s_nop 2
    v_mov_b32 v79, v79
    s_nop 2
    v_mov_b32 v79, v79
    s_nop 2
    v_mov_b32 v79, v79
    s_nop 2
    v_mov_b32 v79, v79
    s_nop 2
    v_mov_b32 v79, v79
    s_nop 2
    v_mov_b32 v79, v79
    s_nop 2
    v_mov_b32 v79, v79
    s_branch cs_loop
cs_f1:
    s_cmp_lg_u32 s32, 1
    s_cbranch_scc1 cs_f3
    v_and_b32 v77, 255, v69
    ds_read_b128 v[4:7], v77 offset:15872
    ds_read_b128 v[40:43], v70 offset:0
    ds_read_b128 v[44:47], v70 offset:1024
    ds_read_b128 v[48:51], v70 offset:2048
    ds_read_b128 v[52:55], v70 offset:3072
    ds_read_b128 v[24:27], v70 offset:4096
    ds_read_b128 v[28:31], v70 offset:5120
    ds_read_b128 v[32:35], v70 offset:6144
    ds_read_b128 v[36:39], v70 offset:7168
    s_mov_b32 s31, 65536
    s_add_u32 s24, s24, 524288
    s_add_u32 s26, s26, 524288
    s_add_u32 s55, s55, s57
    s_cmp_lt_u32 s97, s93
    s_cselect_b32 s37, 1, 0
    s_cmp_eq_u32 s30, 63
    s_cselect_b32 s37, 1, s37
    s_mov_b32 s14, 67633152
    s_mov_b32 s15, 67637248
    s_mov_b32 s16, 67641344
    s_mov_b32 s36, 1
    v_mov_b32 v60, s69
    v_mov_b32 v56, s69
    v_and_b32 v79, 12, v75
    v_cmp_eq_u32 vcc, 0, v79
    s_nop 1
    v_cndmask_b32 v79, 0, 1, vcc
    s_nop 2
    v_mov_b32 v79, v79
    s_nop 2
    v_mov_b32 v79, v79
    s_nop 2
    v_mov_b32 v79, v79
    s_nop 2
    v_mov_b32 v79, v79
    s_nop 2
    v_mov_b32 v79, v79
    s_nop 2
    v_mov_b32 v79, v79
    s_nop 2
    v_mov_b32 v79, v79
    s_nop 2
    v_mov_b32 v79, v79
    s_nop 2
    v_mov_b32 v79, v79
    s_nop 2
    v_mov_b32 v79, v79
    s_nop 2
    v_mov_b32 v79, v79
    s_nop 2
    v_mov_b32 v79, v79
    s_nop 2
    v_mov_b32 v79, v79
    s_nop 2
    v_mov_b32 v79, v79
    s_nop 2
    v_mov_b32 v79, v79
    s_nop 2
    v_mov_b32 v79, v79
    s_nop 2
    v_mov_b32 v79, v79
    s_nop 2
    v_mov_b32 v79, v79
    s_nop 2
    v_mov_b32 v79, v79
    s_nop 2
    v_mov_b32 v79, v79
    s_nop 2
    v_mov_b32 v79, v79
    s_nop 2
    v_mov_b32 v79, v79
    s_nop 2
    v_mov_b32 v79, v79
    s_nop 2
    v_mov_b32 v79, v79
    s_nop 2
    v_mov_b32 v79, v79
    s_nop 2
    v_mov_b32 v79, v79
    s_nop 2
    v_mov_b32 v79, v79
    s_nop 2
    v_mov_b32 v79, v79
    s_nop 2
    v_mov_b32 v79, v79
    s_nop 2
    v_mov_b32 v79, v79
    s_nop 2
    v_mov_b32 v79, v79
    s_nop 2
    v_mov_b32 v79, v79
    s_nop 2
    v_mov_b32 v79, v79
    s_nop 2
    v_mov_b32 v79, v79
    s_nop 2
    v_mov_b32 v79, v79
    s_nop 2
    v_mov_b32 v79, v79
    s_nop 2
    v_mov_b32 v79, v79
    s_nop 0
    v_mov_b32 v79, v79
    s_waitcnt vmcnt(0)
    buffer_load_dwordx4 v[8:11], v65, s[4:7], s18 offen sc1
    buffer_load_dwordx4 v[12:15], v65, s[4:7], s19 offen sc1
    buffer_load_dwordx4 v[16:19], v65, s[4:7], s20 offen sc1
    buffer_load_dwordx4 v[20:23], v65, s[4:7], s21 offen sc1
    s_nop 2
    v_mov_b32 v79, v79
    s_nop 2
    v_mov_b32 v79, v79
    s_nop 2
    v_mov_b32 v79, v79
    s_nop 2
    v_mov_b32 v79, v79
    s_nop 2
    v_mov_b32 v79, v79
    s_nop 2
    v_mov_b32 v79, v79
    s_nop 2
    v_mov_b32 v79, v79
    s_nop 2
    v_mov_b32 v79, v79
    s_nop 2
    v_mov_b32 v79, v79
    s_nop 2
    v_mov_b32 v79, v79
    s_nop 2
    v_mov_b32 v79, v79
    s_nop 2
    v_mov_b32 v79, v79
    buffer_load_dwordx4 v[60:63], v65, s[4:7], s14 offen offset:0 sc1
    buffer_load_dwordx4 v[56:59], v66, s[4:7], s14 offen offset:0 sc1
    s_waitcnt lgkmcnt(0)
    s_waitcnt vmcnt(5)
    v_xor_b32 v77, s69, v8
    v_mfma_f32_16x16x32_bf16 v[0:3], v[4:7], v[8:11], 0
    s_waitcnt vmcnt(4)
    v_bitop3_b32 v77, v77, v12, s69 bitop3:0xf6
    v_mfma_f32_16x16x32_bf16 v[0:3], v[4:7], v[12:15], v[0:3]
    s_waitcnt vmcnt(3)
    v_bitop3_b32 v77, v77, v16, s69 bitop3:0xf6
    v_mfma_f32_16x16x32_bf16 v[0:3], v[4:7], v[16:19], v[0:3]
    s_waitcnt vmcnt(2)
    v_bitop3_b32 v77, v77, v20, s69 bitop3:0xf6
    v_mfma_f32_16x16x32_bf16 v[0:3], v[4:7], v[20:23], v[0:3]
    v_and_b32 v77, 1, v77
    v_cmp_ne_u32 vcc, 0, v77
    buffer_load_dwordx4 v[60:63], v65, s[4:7], s14 offen offset:0 sc1
    buffer_load_dwordx4 v[56:59], v66, s[4:7], s14 offen offset:0 sc1
    s_cmp_eq_u64 vcc, 0
    s_cselect_b64 s[42:43], -1, 0
    s_nop 1
    v_add_f32_dpp v0, v0, v0 row_ror:8 row_mask:0xf bank_mask:0xf
    v_add_f32_dpp v1, v1, v1 row_ror:8 row_mask:0xf bank_mask:0xf
    s_mov_b64 exec, s[42:43]
    v_cvt_pk_bf16_f32 v72, v0, v1
    v_bfi_b32 v72, v79, s70, v72
    buffer_store_dword v72, v75, s[4:7], s17 offen offset:0 sc1
    s_mov_b64 exec, -1
    s_cbranch_scc0 cs_f1_retry
cs_f1_go:
    v_mov_b64 v[0:1], 0
    v_mov_b64 v[2:3], 0
    v_mov_b64 v[4:5], 0
    v_mov_b64 v[6:7], 0
    v_mov_b64 v[8:9], 0
    v_mov_b64 v[10:11], 0
    v_mov_b64 v[12:13], 0
    v_mov_b64 v[14:15], 0
    v_mov_b64 v[16:17], 0
    v_mov_b64 v[18:19], 0
    v_mov_b64 v[20:21], 0
    v_mov_b64 v[22:23], 0
    s_nop 2
    v_mov_b32 v79, v79
    s_nop 2
    v_mov_b32 v79, v79
    s_nop 2
    v_mov_b32 v79, v79
    s_nop 2
    v_mov_b32 v79, v79
    s_nop 2
    v_mov_b32 v79, v79
    s_nop 2
    v_mov_b32 v79, v79
    s_nop 2
    v_mov_b32 v79, v79
    s_nop 2
    v_mov_b32 v79, v79
    s_nop 2
    v_mov_b32 v79, v79
    s_nop 2
    v_mov_b32 v79, v79
    s_nop 2
    v_mov_b32 v79, v79
    s_nop 2
    v_mov_b32 v79, v79
    s_nop 2
    v_mov_b32 v79, v79
    s_nop 2
    v_mov_b32 v79, v79
    s_nop 2
    v_mov_b32 v79, v79
    s_nop 2
    v_mov_b32 v79, v79
    s_nop 2
    v_mov_b32 v79, v79
    s_nop 2
    v_mov_b32 v79, v79
    s_nop 2
    v_mov_b32 v79, v79
    s_nop 2
    v_mov_b32 v79, v79
    s_nop 2
    v_mov_b32 v79, v79
    s_nop 2
    v_mov_b32 v79, v79
    s_nop 2
    v_mov_b32 v79, v79
    s_nop 2
    v_mov_b32 v79, v79
    s_nop 2
    v_mov_b32 v79, v79
    s_branch cs_loop
cs_f3:
    v_and_b32 v77, 255, v69
    ds_read_b128 v[4:7], v77 offset:15872
    ds_read_b128 v[40:43], v70 offset:0
    ds_read_b128 v[44:47], v70 offset:1024
    ds_read_b128 v[48:51], v70 offset:2048
    ds_read_b128 v[52:55], v70 offset:3072
    ds_read_b128 v[24:27], v70 offset:4096
    ds_read_b128 v[28:31], v70 offset:5120
    ds_read_b128 v[32:35], v70 offset:6144
    ds_read_b128 v[36:39], v70 offset:7168
    s_mov_b32 s31, 65536
    s_add_u32 s24, s24, 524288
    s_add_u32 s26, s26, 524288
    s_add_u32 s55, s55, s57
    s_cmp_lt_u32 s97, s93
    s_cselect_b32 s37, 1, 0
    s_cmp_eq_u32 s30, 63
    s_cselect_b32 s37, 1, s37
    s_mov_b32 s14, 67633152
    s_mov_b32 s15, 67637248
    s_mov_b32 s16, 67641344
    s_mov_b32 s36, 1
    v_mov_b32 v60, s69
    v_mov_b32 v56, s69
    v_and_b32 v79, 12, v75
    v_cmp_eq_u32 vcc, 0, v79
    s_nop 1
    v_cndmask_b32 v79, 0, 1, vcc
    v_add_u32 v72, 1, v72
    s_waitcnt lgkmcnt(0)
    v_mov_b64 v[0:1], 0
    v_mov_b64 v[2:3], 0
    v_mov_b64 v[4:5], 0
    v_mov_b64 v[6:7], 0
    v_mov_b64 v[8:9], 0
    v_mov_b64 v[10:11], 0
    v_mov_b64 v[12:13], 0
    v_mov_b64 v[14:15], 0
    v_mov_b64 v[16:17], 0
    v_mov_b64 v[18:19], 0
    v_mov_b64 v[20:21], 0
    v_mov_b64 v[22:23], 0
    s_nop 2
    v_mov_b32 v79, v79
    s_nop 2
    v_mov_b32 v79, v79
    s_nop 2
    v_mov_b32 v79, v79
    s_nop 2
    v_mov_b32 v79, v79
    s_nop 2
    v_mov_b32 v79, v79
    s_nop 2
    v_mov_b32 v79, v79
    s_nop 2
    v_mov_b32 v79, v79
    s_nop 2
    v_mov_b32 v79, v79
    s_nop 2
    v_mov_b32 v79, v79
    s_nop 2
    v_mov_b32 v79, v79
    s_nop 2
    v_mov_b32 v79, v79
    s_nop 2
    v_mov_b32 v79, v79
    s_nop 2
    v_mov_b32 v79, v79
    s_nop 2
    v_mov_b32 v79, v79
    s_nop 2
    v_mov_b32 v79, v79
    s_nop 2
    v_mov_b32 v79, v79
    s_nop 2
    v_mov_b32 v79, v79
    s_nop 2
    v_mov_b32 v79, v79
    s_nop 2
    v_mov_b32 v79, v79
    s_nop 2
    v_mov_b32 v79, v79
    s_nop 2
    v_mov_b32 v79, v79
    s_nop 2
    v_mov_b32 v79, v79
    s_nop 2
    v_mov_b32 v79, v79
    s_nop 2
    v_mov_b32 v79, v79
    s_nop 2
    v_mov_b32 v79, v79
    s_nop 2
    v_mov_b32 v79, v79
    s_nop 2
    v_mov_b32 v79, v79
    s_nop 2
    v_mov_b32 v79, v79
    s_nop 2
    v_mov_b32 v79, v79
    s_nop 2
    v_mov_b32 v79, v79
    s_nop 2
    v_mov_b32 v79, v79
    s_nop 2
    v_mov_b32 v79, v79
    s_nop 2
    v_mov_b32 v79, v79
    s_nop 2
    v_mov_b32 v79, v79
    s_nop 2
    v_mov_b32 v79, v79
    s_nop 2
    v_mov_b32 v79, v79
    s_nop 2
    v_mov_b32 v79, v79
    s_nop 2
    v_mov_b32 v79, v79
    s_nop 2
    v_mov_b32 v79, v79
    s_nop 2
    v_mov_b32 v79, v79
    s_nop 2
    v_mov_b32 v79, v79
    s_nop 2
    v_mov_b32 v79, v79
    s_nop 2
    v_mov_b32 v79, v79
    s_nop 2
    v_mov_b32 v79, v79
    s_nop 2
    v_mov_b32 v79, v79
    s_nop 2
    v_mov_b32 v79, v79
    s_nop 2
    v_mov_b32 v79, v79
    s_nop 2
    v_mov_b32 v79, v79
    s_nop 2
    v_mov_b32 v79, v79
    s_nop 2
    v_mov_b32 v79, v79
    s_nop 2
    v_mov_b32 v79, v79
    s_nop 2
    v_mov_b32 v79, v79
    s_nop 2
    v_mov_b32 v79, v79
    s_nop 2
    v_mov_b32 v79, v79
    s_nop 2
    v_mov_b32 v79, v79
    s_nop 2
    v_mov_b32 v79, v79
    s_nop 2
    v_mov_b32 v79, v79
    s_nop 2
    v_mov_b32 v79, v79
    s_nop 2
    v_mov_b32 v79, v79
    s_nop 2
    v_mov_b32 v79, v79
    s_nop 2
    v_mov_b32 v79, v79
    s_nop 2
    v_mov_b32 v79, v79
    s_nop 2
    v_mov_b32 v79, v79
    s_nop 2
    v_mov_b32 v79, v79
    s_nop 2
    v_mov_b32 v79, v79
    s_nop 2
    v_mov_b32 v79, v79
    s_nop 2
    v_mov_b32 v79, v79
    s_nop 2
    v_mov_b32 v79, v79
    s_nop 2
    v_mov_b32 v79, v79
    s_nop 2
    v_mov_b32 v79, v79
    s_nop 2
    v_mov_b32 v79, v79
    s_nop 2
    v_mov_b32 v79, v79
    s_nop 2
    v_mov_b32 v79, v79
    s_nop 2
    v_mov_b32 v79, v79
    s_nop 2
    v_mov_b32 v79, v79
    s_waitcnt vmcnt(0)
    s_branch cs_loop
cs_f0_retry:
cs_f0_spin:
    buffer_load_dwordx4 v[8:11], v65, s[4:7], s18 offen sc1
    buffer_load_dwordx4 v[12:15], v65, s[4:7], s19 offen sc1
    buffer_load_dwordx4 v[16:19], v65, s[4:7], s20 offen sc1
    buffer_load_dwordx4 v[20:23], v65, s[4:7], s21 offen sc1
    s_nop 2
    v_mov_b32 v79, v79
    s_nop 2
    v_mov_b32 v79, v79
    s_nop 2
    v_mov_b32 v79, v79
    s_nop 2
    v_mov_b32 v79, v79
    s_nop 2
    v_mov_b32 v79, v79
    s_nop 2
    v_mov_b32 v79, v79
    buffer_load_dwordx4 v[60:63], v65, s[4:7], s14 offen offset:0 sc1
    buffer_load_dwordx4 v[56:59], v66, s[4:7], s14 offen offset:0 sc1
    s_waitcnt vmcnt(5)
    v_xor_b32 v77, s69, v8
    v_mfma_f32_16x16x32_bf16 v[0:3], v[4:7], v[8:11], 0
    s_waitcnt vmcnt(4)
    v_bitop3_b32 v77, v77, v12, s69 bitop3:0xf6
    v_mfma_f32_16x16x32_bf16 v[0:3], v[4:7], v[12:15], v[0:3]
    s_waitcnt vmcnt(3)
    v_bitop3_b32 v77, v77, v16, s69 bitop3:0xf6
    v_mfma_f32_16x16x32_bf16 v[0:3], v[4:7], v[16:19], v[0:3]
    s_waitcnt vmcnt(2)
    v_bitop3_b32 v77, v77, v20, s69 bitop3:0xf6
    v_mfma_f32_16x16x32_bf16 v[0:3], v[4:7], v[20:23], v[0:3]
    v_and_b32 v77, 1, v77
    v_cmp_ne_u32 vcc, 0, v77
    buffer_load_dwordx4 v[60:63], v65, s[4:7], s14 offen offset:0 sc1
    buffer_load_dwordx4 v[56:59], v66, s[4:7], s14 offen offset:0 sc1
    s_cmp_eq_u64 vcc, 0
    s_cselect_b64 s[42:43], -1, 0
    s_nop 1
    v_add_f32_dpp v0, v0, v0 row_ror:8 row_mask:0xf bank_mask:0xf
    v_add_f32_dpp v1, v1, v1 row_ror:8 row_mask:0xf bank_mask:0xf
    s_mov_b64 exec, s[42:43]
    v_cvt_pk_bf16_f32 v72, v0, v1
    v_bfi_b32 v72, v79, s70, v72
    buffer_store_dword v72, v75, s[4:7], s17 offen offset:0 sc1
    s_mov_b64 exec, -1
    s_cbranch_scc1 cs_f0_rx
    s_sub_u32 s31, s31, 1
    s_cbranch_scc0 cs_f0_spin
cs_f0_rx:
    v_mov_b64 v[0:1], 0
    v_mov_b64 v[2:3], 0
    v_mov_b64 v[4:5], 0
    v_mov_b64 v[6:7], 0
    v_mov_b64 v[8:9], 0
    v_mov_b64 v[10:11], 0
    v_mov_b64 v[12:13], 0
    v_mov_b64 v[14:15], 0
    v_mov_b64 v[16:17], 0
    v_mov_b64 v[18:19], 0
    v_mov_b64 v[20:21], 0
    v_mov_b64 v[22:23], 0
    s_branch cs_loop
cs_f1_retry:
cs_f1_spin:
    s_nop 0
    buffer_load_dwordx4 v[8:11], v65, s[4:7], s18 offen sc1
    buffer_load_dwordx4 v[12:15], v65, s[4:7], s19 offen sc1
    buffer_load_dwordx4 v[16:19], v65, s[4:7], s20 offen sc1
    buffer_load_dwordx4 v[20:23], v65, s[4:7], s21 offen sc1
    s_nop 2
    v_mov_b32 v79, v79
    s_nop 2
    v_mov_b32 v79, v79
    s_nop 2
    v_mov_b32 v79, v79
    s_nop 2
    v_mov_b32 v79, v79
    s_nop 2
    v_mov_b32 v79, v79
    s_nop 2
    v_mov_b32 v79, v79
    buffer_load_dwordx4 v[60:63], v65, s[4:7], s14 offen offset:0 sc1
    buffer_load_dwordx4 v[56:59], v66, s[4:7], s14 offen offset:0 sc1
    s_waitcnt vmcnt(5)
    v_xor_b32 v77, s69, v8
    v_mfma_f32_16x16x32_bf16 v[0:3], v[4:7], v[8:11], 0
    s_waitcnt vmcnt(4)
    v_bitop3_b32 v77, v77, v12, s69 bitop3:0xf6
    v_mfma_f32_16x16x32_bf16 v[0:3], v[4:7], v[12:15], v[0:3]
    s_waitcnt vmcnt(3)
    v_bitop3_b32 v77, v77, v16, s69 bitop3:0xf6
    v_mfma_f32_16x16x32_bf16 v[0:3], v[4:7], v[16:19], v[0:3]
    s_waitcnt vmcnt(2)
    v_bitop3_b32 v77, v77, v20, s69 bitop3:0xf6
    v_mfma_f32_16x16x32_bf16 v[0:3], v[4:7], v[20:23], v[0:3]
    v_and_b32 v77, 1, v77
    v_cmp_ne_u32 vcc, 0, v77
    buffer_load_dwordx4 v[60:63], v65, s[4:7], s14 offen offset:0 sc1
    buffer_load_dwordx4 v[56:59], v66, s[4:7], s14 offen offset:0 sc1
    s_cmp_eq_u64 vcc, 0
    s_cselect_b64 s[42:43], -1, 0
    s_nop 1
    v_add_f32_dpp v0, v0, v0 row_ror:8 row_mask:0xf bank_mask:0xf
    v_add_f32_dpp v1, v1, v1 row_ror:8 row_mask:0xf bank_mask:0xf
    s_mov_b64 exec, s[42:43]
    v_cvt_pk_bf16_f32 v72, v0, v1
    v_bfi_b32 v72, v79, s70, v72
    buffer_store_dword v72, v75, s[4:7], s17 offen offset:0 sc1
    s_mov_b64 exec, -1
    s_cbranch_scc1 cs_f1_rx
    s_sub_u32 s31, s31, 1
    s_cbranch_scc0 cs_f1_spin
cs_f1_rx:
    v_mov_b64 v[0:1], 0
    v_mov_b64 v[2:3], 0
    v_mov_b64 v[4:5], 0
    v_mov_b64 v[6:7], 0
    v_mov_b64 v[8:9], 0
    v_mov_b64 v[10:11], 0
    v_mov_b64 v[12:13], 0
    v_mov_b64 v[14:15], 0
    v_mov_b64 v[16:17], 0
    v_mov_b64 v[18:19], 0
    v_mov_b64 v[20:21], 0
    v_mov_b64 v[22:23], 0
    s_branch cs_loop
cs_f2_retry:
cs_f2_spin:
    s_nop 0
    buffer_load_dwordx4 v[8:11], v65, s[4:7], s18 offen sc1
    buffer_load_dwordx4 v[12:15], v65, s[4:7], s19 offen sc1
    buffer_load_dwordx4 v[16:19], v65, s[4:7], s20 offen sc1
    buffer_load_dwordx4 v[20:23], v65, s[4:7], s21 offen sc1
    s_nop 2
    v_mov_b32 v79, v79
    s_nop 2
    v_mov_b32 v79, v79
    s_nop 2
    v_mov_b32 v79, v79
    s_nop 2
    v_mov_b32 v79, v79
    s_nop 2
    v_mov_b32 v79, v79
    s_nop 2
    v_mov_b32 v79, v79
    buffer_load_dwordx4 v[60:63], v65, s[4:7], s14 offen offset:0 sc1
    buffer_load_dwordx4 v[56:59], v66, s[4:7], s14 offen offset:0 sc1
    s_waitcnt vmcnt(5)
    v_xor_b32 v77, s69, v8
    v_bitop3_b32 v77, v77, v10, s69 bitop3:0xf6
    v_mfma_f32_16x16x32_bf16 v[0:3], v[4:7], v[8:11], 0
    s_waitcnt vmcnt(4)
    v_bitop3_b32 v77, v77, v12, s69 bitop3:0xf6
    v_bitop3_b32 v77, v77, v14, s69 bitop3:0xf6
    v_mfma_f32_16x16x32_bf16 v[0:3], v[4:7], v[12:15], v[0:3]
    s_waitcnt vmcnt(3)
    v_bitop3_b32 v77, v77, v16, s69 bitop3:0xf6
    v_bitop3_b32 v77, v77, v18, s69 bitop3:0xf6
    v_mfma_f32_16x16x32_bf16 v[0:3], v[4:7], v[16:19], v[0:3]
    s_waitcnt vmcnt(2)
    v_bitop3_b32 v77, v77, v20, s69 bitop3:0xf6
    v_bitop3_b32 v77, v77, v22, s69 bitop3:0xf6
    v_mfma_f32_16x16x32_bf16 v[0:3], v[4:7], v[20:23], v[0:3]
    v_and_b32 v77, 1, v77
    v_cmp_ne_u32 vcc, 0, v77
    buffer_load_dwordx4 v[60:63], v65, s[4:7], s14 offen offset:0 sc1
    buffer_load_dwordx4 v[56:59], v66, s[4:7], s14 offen offset:0 sc1
    s_cmp_eq_u64 vcc, 0
    s_cselect_b64 s[42:43], -1, 0
    s_nop 1
    v_add_f32 v2, v0, v1
    s_nop 1
    v_add_f32_dpp v2, v2, v2 row_ror:8 row_mask:0xf bank_mask:0xf
    s_nop 1
    v_mov_b32_dpp v0, v2 quad_perm:[0,0,2,2] row_mask:0xf bank_mask:0xf
    v_mov_b32_dpp v1, v2 quad_perm:[1,1,3,3] row_mask:0xf bank_mask:0xf
    s_mov_b64 exec, s[42:43]
    v_cvt_pk_bf16_f32 v72, v0, v1
    v_bfi_b32 v72, v79, s70, v72
    buffer_store_dword v72, v75, s[4:7], s17 offen offset:0 sc1
    buffer_store_dword v72, v75, s[4:7], s17 offen offset:1024 sc1
    buffer_store_dword v72, v75, s[4:7], s17 offen offset:2048 sc1
    buffer_store_dword v72, v75, s[4:7], s17 offen offset:3072 sc1
    s_mov_b64 exec, -1
    s_cbranch_scc1 cs_f2_rx
    s_sub_u32 s31, s31, 1
    s_cbranch_scc0 cs_f2_spin
cs_f2_rx:
    v_mov_b64 v[0:1], 0
    v_mov_b64 v[2:3], 0
    v_mov_b64 v[4:5], 0
    v_mov_b64 v[6:7], 0
    v_mov_b64 v[8:9], 0
    v_mov_b64 v[10:11], 0
    v_mov_b64 v[12:13], 0
    v_mov_b64 v[14:15], 0
    v_mov_b64 v[16:17], 0
    v_mov_b64 v[18:19], 0
    v_mov_b64 v[20:21], 0
    v_mov_b64 v[22:23], 0
    s_branch cs_loop
cs_spinB:
    buffer_load_dwordx4 v[40:43], v65, s[4:7], s15 offen sc1
cs_spinB_l:
    v_and_b32 v77, s36, v40
    v_cmp_ne_u32 vcc, s70, v77
    s_cbranch_vccz cs_spinB_x
    s_nop 15
    s_nop 15
    s_nop 15
    s_nop 11
    v_and_b32 v77, s36, v40
    v_cmp_ne_u32 vcc, s70, v77
    s_cbranch_vccz cs_spinB_x
    s_nop 15
    s_nop 15
    s_nop 15
    s_nop 11
    v_and_b32 v77, s36, v40
    v_cmp_ne_u32 vcc, s70, v77
    s_cbranch_vccz cs_spinB_x
    s_nop 15
    s_nop 15
    s_nop 15
    s_nop 11
    buffer_load_dwordx4 v[40:43], v65, s[4:7], s15 offen sc1
    s_sub_u32 s31, s31, 16
    s_cbranch_scc0 cs_spinB_l
cs_spinB_x:
    ds_write_b128 v65, v[40:43] offset:4096
    s_waitcnt lgkmcnt(0)
    s_branch cs_backB
cs_spin8:
    buffer_load_dwordx4 v[60:63], v65, s[4:7], s16 offen sc1
cs_spin8_l:
    v_and_b32 v77, s36, v60
    v_cmp_ne_u32 vcc, s70, v77
    s_cbranch_vccz cs_spin8_x
    s_nop 15
    s_nop 15
    s_nop 15
    s_nop 11
    v_and_b32 v77, s36, v60
    v_cmp_ne_u32 vcc, s70, v77
    s_cbranch_vccz cs_spin8_x
    s_nop 15
    s_nop 15
    s_nop 15
    s_nop 11
    v_and_b32 v77, s36, v60
    v_cmp_ne_u32 vcc, s70, v77
    s_cbranch_vccz cs_spin8_x
    s_nop 15
    s_nop 15
    s_nop 15
    s_nop 11
    buffer_load_dwordx4 v[60:63], v65, s[4:7], s16 offen sc1
    s_sub_u32 s31, s31, 16
    s_cbranch_scc0 cs_spin8_l
cs_spin8_x:
    s_branch cs_back8
cs_pubk:
    s_mov_b64 exec, s[34:35]
    buffer_store_dwordx4 v[0:3], v65, s[4:7], s28 offen sc1
    s_mov_b64 exec, -1
    s_add_u32 s28, s28, 131072
    s_branch cs_pubk_x
cs_pubv:
    buffer_store_dwordx4 v[38:41], v65, s[4:7], s27 offen sc1
    s_add_u32 s27, s27, 131072
    s_branch cs_pubv_x
cs_rare:
    s_cmp_eq_u32 s30, 63
    s_cbranch_scc1 cs_last
    v_bfe_u32 v78, v65, 2, 8
    s_mov_b64 exec, 0xffff
    buffer_load_dword v78, s[4:7], s96 offen sc1 lds
    s_mov_b64 exec, -1
    s_branch cs_rare_x
cs_kvwait:
    v_bfe_u32 v78, v65, 2, 5
    ds_read_b32 v77, v78 offset:16144
    s_waitcnt lgkmcnt(0)
    v_subrev_u32 v77, s95, v77
    v_cmp_lt_u32 vcc, 16, v77
    s_nop 1
    v_cndmask_b32 v77, v77, 0, vcc
    v_bfe_u32 v79, v78, 2, 2
    v_lshl_add_u32 v77, v77, 2, v79
    s_nop 1
    v_min_u32_dpp v77, v77, v77 row_ror:1 row_mask:0xf bank_mask:0xf
    s_nop 1
    v_min_u32_dpp v77, v77, v77 row_ror:2 row_mask:0xf bank_mask:0xf
    s_nop 1
    v_min_u32_dpp v77, v77, v77 row_ror:4 row_mask:0xf bank_mask:0xf
    s_nop 0
    v_readfirstlane_b32 s97, v77
    s_nop 0
    s_cmp_le_u32 s40, s97
    s_cbranch_scc1 cs_kvw_x
    v_bfe_u32 v78, v65, 2, 5
    s_mov_b32 s31, 4194304
cs_kvw:
    buffer_load_dword v77, v78, s[4:7], s96 offen offset:16 sc1
    s_waitcnt vmcnt(0)
    v_subrev_u32 v77, s95, v77
    v_cmp_lt_u32 vcc, 16, v77
    s_nop 1
    v_cndmask_b32 v77, v77, 0, vcc
    v_bfe_u32 v79, v78, 2, 2
    v_lshl_add_u32 v77, v77, 2, v79
    s_nop 1
    v_min_u32_dpp v77, v77, v77 row_ror:1 row_mask:0xf bank_mask:0xf
    s_nop 1
    v_min_u32_dpp v77, v77, v77 row_ror:2 row_mask:0xf bank_mask:0xf
    s_nop 1
    v_min_u32_dpp v77, v77, v77 row_ror:4 row_mask:0xf bank_mask:0xf
    s_nop 0
    v_readfirstlane_b32 s97, v77
    s_sub_u32 s31, s31, 1
    s_cbranch_scc1 cs_kvw_x
    s_cmp_le_u32 s40, s97
    s_cbranch_scc1 cs_kvw_x
    s_sleep 2
    s_branch cs_kvw
cs_kvw_x:
    s_branch cs_kvok
cs_last:
    s_nop 7
    v_cvt_pk_bf16_f32 v38, v16, v17
    v_cvt_pk_bf16_f32 v39, v18, v19
    v_cvt_pk_bf16_f32 v40, v20, v21
    v_cvt_pk_bf16_f32 v41, v22, v23
    buffer_store_dwordx4 v[38:41], v65, s[4:7], s27 offen sc1
    s_add_u32 s40, s95, 64
    v_mov_b32 v78, s40
    s_waitcnt vmcnt(0)
    s_barrier
    s_mov_b64 exec, s[100:101]
    buffer_store_dword v78, off, s[4:7], s29 sc1
    s_mov_b64 exec, -1
cs_end:
    s_endpgm
L_xform:
    v_and_b32 v1, 63, v0
    v_and_b32 v2, 15, v1
    v_lshrrev_b32 v3, 4, v1
    v_mov_b32 v7, 0x05040100
    v_mov_b32 v8, 0x07060302
    v_lshrrev_b32 v9, 6, v0
    v_lshlrev_b32 v9, 14, v9
    v_lshlrev_b32 v10, 4, v1
    v_add_u32 v11, v9, v10
    s_mov_b32 s10, 4718592
    s_mov_b32 s11, 0x20000
    s_mov_b64 s[8:9], s[58:59]
xf_f:
    s_sub_u32 s17, s16, 1504
    s_and_b32 s18, s17, 127
    s_lshr_b32 s17, s17, 7
    s_lshl_b32 s19, s17, 4
    v_add_u32 v6, s19, v2
    v_mul_u32_u24 v4, 9216, v3
    v_lshl_add_u32 v4, v6, 4, v4
    v_lshrrev_b32 v5, 2, v2
    v_lshlrev_b32 v5, 11, v5
    v_lshl_add_u32 v5, v3, 8, v5
    v_and_b32 v1, 3, v6
    v_lshl_add_u32 v5, v1, 6, v5
    v_add_u32 v5, v5, v9
    v_cmp_gt_u32 vcc, 72, v6
    s_nop 0
    s_mov_b64 exec, vcc
    s_mul_i32 s20, s18, 36864
    s_add_u32 s21, s20, 0
    buffer_load_dwordx4 v[12:15], v4, s[8:11], s21 offen
    s_add_u32 s21, s20, 1152
    buffer_load_dwordx4 v[16:19], v4, s[8:11], s21 offen
    s_add_u32 s21, s20, 2304
    buffer_load_dwordx4 v[20:23], v4, s[8:11], s21 offen
    s_add_u32 s21, s20, 3456
    buffer_load_dwordx4 v[24:27], v4, s[8:11], s21 offen
    s_add_u32 s21, s20, 4608
    buffer_load_dwordx4 v[28:31], v4, s[8:11], s21 offen
    s_add_u32 s21, s20, 5760
    buffer_load_dwordx4 v[32:35], v4, s[8:11], s21 offen
    s_add_u32 s21, s20, 6912
    buffer_load_dwordx4 v[36:39], v4, s[8:11], s21 offen
    s_add_u32 s21, s20, 8064
    buffer_load_dwordx4 v[40:43], v4, s[8:11], s21 offen
    s_lshl_b32 s20, s18, 11
    s_add_u32 s20, s20, 130023424
    s_waitcnt vmcnt(0)
    v_perm_b32 v76, v16, v12, v7
    v_perm_b32 v77, v24, v20, v7
    v_perm_b32 v78, v32, v28, v7
    v_perm_b32 v79, v40, v36, v7
    ds_write_b128 v5, v[76:79] offset:0
    v_perm_b32 v80, v17, v13, v7
    v_perm_b32 v81, v25, v21, v7
    v_perm_b32 v82, v33, v29, v7
    v_perm_b32 v83, v41, v37, v7
    ds_write_b128 v5, v[80:83] offset:16
    v_perm_b32 v84, v18, v14, v7
    v_perm_b32 v85, v26, v22, v7
    v_perm_b32 v86, v34, v30, v7
    v_perm_b32 v87, v42, v38, v7
    ds_write_b128 v5, v[84:87] offset:32
    v_perm_b32 v88, v19, v15, v7
    v_perm_b32 v89, v27, v23, v7
    v_perm_b32 v90, v35, v31, v7
    v_perm_b32 v91, v43, v39, v7
    ds_write_b128 v5, v[88:91] offset:48
    v_perm_b32 v92, v16, v12, v8
    v_perm_b32 v93, v24, v20, v8
    v_perm_b32 v94, v32, v28, v8
    v_perm_b32 v95, v40, v36, v8
    ds_write_b128 v5, v[92:95] offset:1024
    v_perm_b32 v96, v17, v13, v8
    v_perm_b32 v97, v25, v21, v8
    v_perm_b32 v98, v33, v29, v8
    v_perm_b32 v99, v41, v37, v8
    ds_write_b128 v5, v[96:99] offset:1040
    v_perm_b32 v100, v18, v14, v8
    v_perm_b32 v101, v26, v22, v8
    v_perm_b32 v102, v34, v30, v8
    v_perm_b32 v103, v42, v38, v8
    ds_write_b128 v5, v[100:103] offset:1056
    v_perm_b32 v104, v19, v15, v8
    v_perm_b32 v105, v27, v23, v8
    v_perm_b32 v106, v35, v31, v8
    v_perm_b32 v107, v43, v39, v8
    ds_write_b128 v5, v[104:107] offset:1072
    s_mov_b64 exec, -1
    s_lshl_b32 s21, s17, 20
    s_add_u32 s20, s20, s21
    s_waitcnt lgkmcnt(0)
    ds_read_b128 v[76:79], v11 offset:0
    ds_read_b128 v[80:83], v11 offset:1024
    ds_read_b128 v[84:87], v11 offset:2048
    ds_read_b128 v[88:91], v11 offset:3072
    ds_read_b128 v[92:95], v11 offset:4096
    ds_read_b128 v[96:99], v11 offset:5120
    ds_read_b128 v[100:103], v11 offset:6144
    ds_read_b128 v[104:107], v11 offset:7168
    s_add_u32 s19, s20, 0
    s_waitcnt lgkmcnt(7)
    buffer_store_dwordx4 v[76:79], v10, s[4:7], s19 offen sc1
    s_add_u32 s19, s20, 1024
    s_waitcnt lgkmcnt(6)
    buffer_store_dwordx4 v[80:83], v10, s[4:7], s19 offen sc1
    s_add_u32 s19, s20, 262144
    s_waitcnt lgkmcnt(5)
    buffer_store_dwordx4 v[84:87], v10, s[4:7], s19 offen sc1
    s_add_u32 s19, s20, 263168
    s_waitcnt lgkmcnt(4)
    buffer_store_dwordx4 v[88:91], v10, s[4:7], s19 offen sc1
    s_add_u32 s19, s20, 524288
    s_waitcnt lgkmcnt(3)
    buffer_store_dwordx4 v[92:95], v10, s[4:7], s19 offen sc1
    s_add_u32 s19, s20, 525312
    s_waitcnt lgkmcnt(2)
    buffer_store_dwordx4 v[96:99], v10, s[4:7], s19 offen sc1
    s_add_u32 s19, s20, 786432
    s_waitcnt lgkmcnt(1)
    buffer_store_dwordx4 v[100:103], v10, s[4:7], s19 offen sc1
    s_add_u32 s19, s20, 787456
    s_waitcnt lgkmcnt(0)
    buffer_store_dwordx4 v[104:107], v10, s[4:7], s19 offen sc1
xf_done:
    s_nop 1
    s_setpc_b64 s[46:47]
L_helper:
    s_load_dwordx16 s[64:79], s[0:1], 64
    s_waitcnt lgkmcnt(0)
L_qkv_next:
    s_mov_b32 s37, 4
    v_mov_b32 v250, 1
    v_mov_b32 v251, 163832
    v_cmp_eq_u32 vcc, 0, v0
    s_nop 0
    s_and_saveexec_b64 s[38:39], vcc
    s_cbranch_execz tk4
    buffer_atomic_add v250, off, s[84:87], s37 sc0
    s_waitcnt vmcnt(0)
    ds_write_b32 v251, v250
    s_waitcnt lgkmcnt(0)
tk4:
    s_mov_b64 exec, -1
    s_barrier
    ds_read_b32 v252, v251
    s_waitcnt lgkmcnt(0)
    v_readfirstlane_b32 s36, v252
    s_barrier
    s_nop 3
    s_or_b32 s37, s36, s32
    s_cbranch_scc1 L_non
    s_memrealtime s[90:91]
    s_waitcnt lgkmcnt(0)
    s_lshl_b32 s90, s90, 8
    s_or_b32 s90, s90, 1
    v_mov_b32 v250, s90
    s_mov_b64 exec, 1
    buffer_store_dword v250, off, s[84:87], 0 offset:216 sc1
    s_mov_b64 exec, -1
L_non:
    s_cmp_lt_u32 s36, 192
    s_cbranch_scc1 L_qkv
    s_mov_b32 s88, 4194304
gn5:
    buffer_load_dword v250, off, s[84:87], 0 offset:216 sc1
    s_waitcnt vmcnt(0)
    v_readfirstlane_b32 s95, v250
    s_sub_u32 s88, s88, 1
    s_cbranch_scc1 gn5x
    s_cmp_eq_u32 s95, 0
    s_cbranch_scc1 gn5
gn5x:
    s_cmp_lg_u32 s36, 192
    s_cbranch_scc1 L_ssm_next
    s_cmp_lg_u32 s32, 0
    s_cbranch_scc1 L_exit
    v_and_b32 v3, 31, v0
    v_lshlrev_b32 v3, 7, v3
    s_mov_b32 s17, 0
    s_mov_b32 s23, 125845504
    s_mov_b32 s24, 125853696
    s_mov_b32 s21, 16777216
rl_rwait:
    buffer_load_dword v4, v3, s[4:7], s23 offen sc1
    s_waitcnt vmcnt(0)
    v_subrev_u32 v4, s95, v4
    v_cmp_lt_u32 vcc, 64, v4
    s_nop 1
    v_cndmask_b32 v4, v4, 0, vcc
    s_nop 1
    v_min_u32_dpp v4, v4, v4 row_ror:1 row_mask:0xf bank_mask:0xf
    s_nop 1
    v_min_u32_dpp v4, v4, v4 row_ror:2 row_mask:0xf bank_mask:0xf
    s_nop 1
    v_min_u32_dpp v4, v4, v4 row_ror:4 row_mask:0xf bank_mask:0xf
    s_nop 1
    v_min_u32_dpp v4, v4, v4 row_ror:8 row_mask:0xf bank_mask:0xf
    s_nop 0
    v_readlane_b32 s16, v4, 0
    v_readlane_b32 s22, v4, 16
    s_nop 0
    s_min_u32 s16, s16, s22
    s_sub_u32 s21, s21, 1
    s_cbranch_scc1 rl_x
    s_cmp_gt_u32 s16, s17
    s_cbranch_scc1 rl_rpub
    s_sleep 2
    s_branch rl_rwait
rl_rpub:
    s_mov_b32 s17, s16
    s_add_u32 s22, s16, s95
    v_mov_b32 v4, s22
    s_mov_b64 exec, 1
    buffer_store_dword v4, off, s[4:7], s24 sc1
    s_mov_b64 exec, -1
    s_cmp_lt_u32 s16, 64
    s_cbranch_scc1 rl_rwait
rl_x:
    s_endpgm
L_qkv:
    s_and_b32 s17, s36, 15
    s_lshl_b32 s17, s17, 1
    s_lshr_b32 s36, s36, 4
    s_and_b32 s16, s36, 1
    s_add_u32 s16, s16, 1
    s_lshr_b32 s19, s36, 1
    s_and_b32 s37, s36, 3
    s_cmp_ge_u32 s36, 8
    s_cselect_b32 s16, 0, s16
    s_cselect_b32 s19, s37, s19
    v_lshrrev_b32 v4, 6, v0
    s_nop 0
    v_readfirstlane_b32 s18, v4
    v_lshlrev_b32 v7, 4, v0
    s_cmp_eq_u32 s16, 1
    s_cselect_b64 s[12:13], s[54:55], s[52:53]
    s_cmp_eq_u32 s16, 2
    s_cselect_b64 s[12:13], s[56:57], s[12:13]
    s_mov_b32 s14, 4718592
    s_mov_b32 s15, 0x20000
    v_bfe_u32 v4, v0, 5, 1
    v_lshlrev_b32 v5, 2, v4
    v_and_b32 v8, 31, v0
    v_xor_b32 v8, v8, v5
    v_lshlrev_b32 v8, 4, v8
    v_lshl_add_u32 v8, v4, 13, v8
    v_xor_b32 v9, 128, v8
    s_lshl_b32 s21, s17, 8
    s_lshl_b32 s42, s18, 16
    s_add_u32 s42, s42, s21
    s_lshr_b32 s22, s18, 1
    s_mul_i32 s43, s22, 1048576
    s_add_u32 s43, s43, s42
    s_lshl_b32 s44, s18, 12
    s_barrier
    s_add_u32 m0, s44, 73728
    s_add_u32 s22, s42, 0
    buffer_load_dwordx4 v8, s[12:15], s22 offen offset:0 lds
    s_add_u32 s22, s42, 15360
    buffer_load_dwordx4 v9, s[12:15], s22 offen offset:1024 lds
    s_add_u32 s22, s42, 30720
    buffer_load_dwordx4 v8, s[12:15], s22 offen offset:2048 lds
    s_add_u32 s22, s42, 46080
    buffer_load_dwordx4 v9, s[12:15], s22 offen offset:3072 lds
    s_add_u32 m0, s44, 90112
    s_add_u32 s22, s42, 262144
    buffer_load_dwordx4 v8, s[12:15], s22 offen offset:0 lds
    s_add_u32 s22, s42, 277504
    buffer_load_dwordx4 v9, s[12:15], s22 offen offset:1024 lds
    s_add_u32 s22, s42, 292864
    buffer_load_dwordx4 v8, s[12:15], s22 offen offset:2048 lds
    s_add_u32 s22, s42, 308224
    buffer_load_dwordx4 v9, s[12:15], s22 offen offset:3072 lds
    s_add_u32 m0, s44, 106496
    s_add_u32 s22, s42, 524288
    buffer_load_dwordx4 v8, s[12:15], s22 offen offset:0 lds
    s_add_u32 s22, s42, 539648
    buffer_load_dwordx4 v9, s[12:15], s22 offen offset:1024 lds
    s_add_u32 s22, s42, 555008
    buffer_load_dwordx4 v8, s[12:15], s22 offen offset:2048 lds
    s_add_u32 s22, s42, 570368
    buffer_load_dwordx4 v9, s[12:15], s22 offen offset:3072 lds
    s_add_u32 m0, s44, 122880
    s_add_u32 s22, s42, 786432
    buffer_load_dwordx4 v8, s[12:15], s22 offen offset:0 lds
    s_add_u32 s22, s42, 801792
    buffer_load_dwordx4 v9, s[12:15], s22 offen offset:1024 lds
    s_add_u32 s22, s42, 817152
    buffer_load_dwordx4 v8, s[12:15], s22 offen offset:2048 lds
    s_add_u32 s22, s42, 832512
    buffer_load_dwordx4 v9, s[12:15], s22 offen offset:3072 lds
    v_bfe_u32 v4, v0, 2, 2
    v_xor_b32 v5, s18, v4
    v_lshlrev_b32 v10, 6, v5
    v_lshl_add_u32 v10, v4, 9, v10
    v_and_b32 v4, 3, v0
    v_lshl_add_u32 v10, v4, 4, v10
    v_bfe_u32 v4, v0, 4, 2
    v_lshl_add_u32 v10, v4, 12, v10
    v_add_u32 v10, 73728, v10
    v_add_u32 v11, 49152, v10
    v_and_b32 v4, 63, v0
    v_and_b32 v5, 15, v4
    v_lshrrev_b32 v3, 4, v4
    v_lshrrev_b32 v2, 2, v5
    v_xor_b32 v3, v3, v2
    v_lshl_add_u32 v3, v5, 2, v3
    v_lshlrev_b32 v1, 4, v3
    v_lshrrev_b32 v5, 2, v4
    v_lshrrev_b32 v3, 4, v4
    v_and_b32 v4, 3, v4
    v_xor_b32 v4, v4, v3
    v_lshlrev_b32 v3, 3, v3
    v_and_b32 v5, 3, v5
    v_add_u32 v3, v3, v5
    v_mul_u32_u24 v2, 1152, v3
    v_lshl_add_u32 v2, v4, 4, v2
    v_lshrrev_b32 v4, 1, v4
    v_lshl_add_u32 v6, v4, 8, v2
    s_mov_b32 s8, s48
    s_mov_b32 s9, s49
    s_mov_b32 s10, 2359296
    s_mov_b32 s11, 0x20000
    s_lshr_b32 s22, s18, 1
    s_mul_i32 s24, s22, 4608
    s_mul_i32 s25, s22, 18432
    s_and_b32 s22, s18, 1
    s_mul_i32 s23, s22, 576
    s_add_u32 s24, s24, s23
    s_lshl_b32 s23, s22, 10
    s_add_u32 s30, s25, s23
    s_lshl_b32 s23, s22, 13
    s_add_u32 s25, s25, s23
    s_mul_i32 s22, s19, 36864
    s_add_u32 s24, s24, s22
    s_mov_b32 s20, 64
    s_lshl_b32 s22, s19, 5
    s_add_u32 s22, s22, s17
    s_lshl_b32 s26, s22, 14
    s_mul_i32 s23, s18, 3072
    s_add_u32 s26, s26, s23
    s_lshl_b32 s23, s16, 11
    s_add_u32 s26, s26, s23
    s_add_u32 s26, s26, -2048
    s_lshl_b32 s22, s22, 13
    s_add_u32 s22, s22, 33554432
    s_cmp_eq_u32 s16, 0
    s_cselect_b32 s26, s22, s26
    s_cselect_b32 s40, 4096, 64
    s_cselect_b32 s41, 1, 2
    s_max_u32 s40, s40, 1024
    s_lshl_b32 s41, s41, 18
    s_lshl_b32 s29, s17, 7
    s_lshl_b32 s22, s16, 4
    s_add_u32 s29, s29, s22
    s_lshl_b32 s22, s19, 2
    s_add_u32 s29, s29, s22
    s_add_u32 s29, s29, 125829120
    s_mov_b32 s27, 0
    s_add_u32 s23, s27, s25
    s_add_u32 s31, s27, s30
    s_add_u32 m0, s23, 0
    s_nop 0
    buffer_load_dwordx4 v2, s[8:11], s24 offen offset:0 lds
    s_add_u32 m0, s23, 960
    s_nop 0
    buffer_load_dwordx4 v2, s[8:11], s24 offen offset:64 lds
    s_add_u32 m0, s23, 1920
    s_nop 0
    buffer_load_dwordx4 v2, s[8:11], s24 offen offset:128 lds
    s_add_u32 m0, s23, 2880
    s_nop 0
    buffer_load_dwordx4 v2, s[8:11], s24 offen offset:192 lds
    s_add_u32 m0, s23, 3808
    s_nop 0
    buffer_load_dwordx4 v2, s[8:11], s24 offen offset:288 lds
    s_add_u32 m0, s23, 4768
    s_nop 0
    buffer_load_dwordx4 v2, s[8:11], s24 offen offset:352 lds
    s_add_u32 m0, s23, 5728
    s_nop 0
    buffer_load_dwordx4 v2, s[8:11], s24 offen offset:416 lds
    s_add_u32 m0, s23, 6688
    s_nop 0
    buffer_load_dwordx4 v2, s[8:11], s24 offen offset:480 lds
    s_add_u32 m0, s31, 16128
    s_nop 0
    buffer_load_dwordx4 v6, s[8:11], s24 offen offset:256 lds
    s_add_u32 s24, s24, 147456
    s_waitcnt vmcnt(21) lgkmcnt(0)
    s_barrier
    s_add_u32 m0, s44, 139264
    s_add_u32 s22, s42, 1179648
    buffer_load_dwordx4 v8, s[12:15], s22 offen offset:0 lds
    s_add_u32 s22, s42, 1195008
    buffer_load_dwordx4 v9, s[12:15], s22 offen offset:1024 lds
    s_add_u32 s22, s42, 1210368
    buffer_load_dwordx4 v8, s[12:15], s22 offen offset:2048 lds
    s_add_u32 s22, s42, 1225728
    buffer_load_dwordx4 v9, s[12:15], s22 offen offset:3072 lds
    ds_read_b64_tr_b16 v[64:65], v10 offset:0
    ds_read_b64_tr_b16 v[66:67], v10 offset:2048
    ds_read_b64_tr_b16 v[136:137], v10 offset:8
    ds_read_b64_tr_b16 v[138:139], v10 offset:2056
    ds_read_b64_tr_b16 a[0:1], v10 offset:256
    ds_read_b64_tr_b16 a[2:3], v10 offset:2304
    ds_read_b64_tr_b16 a[72:73], v10 offset:264
    ds_read_b64_tr_b16 a[74:75], v10 offset:2312
    s_waitcnt vmcnt(21) lgkmcnt(0)
    s_barrier
    s_add_u32 m0, s44, 73728
    s_add_u32 s22, s42, 1441792
    buffer_load_dwordx4 v8, s[12:15], s22 offen offset:0 lds
    s_add_u32 s22, s42, 1457152
    buffer_load_dwordx4 v9, s[12:15], s22 offen offset:1024 lds
    s_add_u32 s22, s42, 1472512
    buffer_load_dwordx4 v8, s[12:15], s22 offen offset:2048 lds
    s_add_u32 s22, s42, 1487872
    buffer_load_dwordx4 v9, s[12:15], s22 offen offset:3072 lds
    ds_read_b64_tr_b16 v[68:69], v10 offset:16384
    ds_read_b64_tr_b16 v[70:71], v10 offset:18432
    ds_read_b64_tr_b16 v[140:141], v10 offset:16392
    ds_read_b64_tr_b16 v[142:143], v10 offset:18440
    ds_read_b64_tr_b16 a[4:5], v10 offset:16640
    ds_read_b64_tr_b16 a[6:7], v10 offset:18688
    ds_read_b64_tr_b16 a[76:77], v10 offset:16648
    ds_read_b64_tr_b16 a[78:79], v10 offset:18696
    s_waitcnt vmcnt(21) lgkmcnt(0)
    s_barrier
    s_add_u32 m0, s44, 90112
    s_add_u32 s22, s42, 1703936
    buffer_load_dwordx4 v8, s[12:15], s22 offen offset:0 lds
    s_add_u32 s22, s42, 1719296
    buffer_load_dwordx4 v9, s[12:15], s22 offen offset:1024 lds
    s_add_u32 s22, s42, 1734656
    buffer_load_dwordx4 v8, s[12:15], s22 offen offset:2048 lds
    s_add_u32 s22, s42, 1750016
    buffer_load_dwordx4 v9, s[12:15], s22 offen offset:3072 lds
    ds_read_b64_tr_b16 v[72:73], v10 offset:32768
    ds_read_b64_tr_b16 v[74:75], v10 offset:34816
    ds_read_b64_tr_b16 v[144:145], v10 offset:32776
    ds_read_b64_tr_b16 v[146:147], v10 offset:34824
    ds_read_b64_tr_b16 a[8:9], v10 offset:33024
    ds_read_b64_tr_b16 a[10:11], v10 offset:35072
    ds_read_b64_tr_b16 a[80:81], v10 offset:33032
    ds_read_b64_tr_b16 a[82:83], v10 offset:35080
    s_waitcnt vmcnt(21) lgkmcnt(0)
    s_barrier
    s_add_u32 m0, s44, 106496
    s_add_u32 s22, s42, 1966080
    buffer_load_dwordx4 v8, s[12:15], s22 offen offset:0 lds
    s_add_u32 s22, s42, 1981440
    buffer_load_dwordx4 v9, s[12:15], s22 offen offset:1024 lds
    s_add_u32 s22, s42, 1996800
    buffer_load_dwordx4 v8, s[12:15], s22 offen offset:2048 lds
    s_add_u32 s22, s42, 2012160
    buffer_load_dwordx4 v9, s[12:15], s22 offen offset:3072 lds
    ds_read_b64_tr_b16 v[76:77], v11 offset:0
    ds_read_b64_tr_b16 v[78:79], v11 offset:2048
    ds_read_b64_tr_b16 v[148:149], v11 offset:8
    ds_read_b64_tr_b16 v[150:151], v11 offset:2056
    ds_read_b64_tr_b16 a[12:13], v11 offset:256
    ds_read_b64_tr_b16 a[14:15], v11 offset:2304
    ds_read_b64_tr_b16 a[84:85], v11 offset:264
    ds_read_b64_tr_b16 a[86:87], v11 offset:2312
    s_waitcnt vmcnt(12) lgkmcnt(0)
    s_barrier
    s_add_u32 m0, s44, 122880
    s_add_u32 s22, s42, 2359296
    buffer_load_dwordx4 v8, s[12:15], s22 offen offset:0 lds
    s_add_u32 s22, s42, 2374656
    buffer_load_dwordx4 v9, s[12:15], s22 offen offset:1024 lds
    s_add_u32 s22, s42, 2390016
    buffer_load_dwordx4 v8, s[12:15], s22 offen offset:2048 lds
    s_add_u32 s22, s42, 2405376
    buffer_load_dwordx4 v9, s[12:15], s22 offen offset:3072 lds
    ds_read_b64_tr_b16 v[80:81], v11 offset:16384
    ds_read_b64_tr_b16 v[82:83], v11 offset:18432
    ds_read_b64_tr_b16 v[152:153], v11 offset:16392
    ds_read_b64_tr_b16 v[154:155], v11 offset:18440
    ds_read_b64_tr_b16 a[16:17], v11 offset:16640
    ds_read_b64_tr_b16 a[18:19], v11 offset:18688
    ds_read_b64_tr_b16 a[88:89], v11 offset:16648
    ds_read_b64_tr_b16 a[90:91], v11 offset:18696
    s_waitcnt vmcnt(12) lgkmcnt(0)
    s_barrier
    s_add_u32 m0, s44, 139264
    s_add_u32 s22, s42, 2621440
    buffer_load_dwordx4 v8, s[12:15], s22 offen offset:0 lds
    s_add_u32 s22, s42, 2636800
    buffer_load_dwordx4 v9, s[12:15], s22 offen offset:1024 lds
    s_add_u32 s22, s42, 2652160
    buffer_load_dwordx4 v8, s[12:15], s22 offen offset:2048 lds
    s_add_u32 s22, s42, 2667520
    buffer_load_dwordx4 v9, s[12:15], s22 offen offset:3072 lds
    ds_read_b64_tr_b16 v[84:85], v10 offset:0
    ds_read_b64_tr_b16 v[86:87], v10 offset:2048
    ds_read_b64_tr_b16 v[156:157], v10 offset:8
    ds_read_b64_tr_b16 v[158:159], v10 offset:2056
    ds_read_b64_tr_b16 a[20:21], v10 offset:256
    ds_read_b64_tr_b16 a[22:23], v10 offset:2304
    ds_read_b64_tr_b16 a[92:93], v10 offset:264
    ds_read_b64_tr_b16 a[94:95], v10 offset:2312
    s_waitcnt vmcnt(12) lgkmcnt(0)
    s_barrier
    s_add_u32 m0, s44, 73728
    s_add_u32 s22, s42, 2883584
    buffer_load_dwordx4 v8, s[12:15], s22 offen offset:0 lds
    s_add_u32 s22, s42, 2898944
    buffer_load_dwordx4 v9, s[12:15], s22 offen offset:1024 lds
    s_add_u32 s22, s42, 2914304
    buffer_load_dwordx4 v8, s[12:15], s22 offen offset:2048 lds
    s_add_u32 s22, s42, 2929664
    buffer_load_dwordx4 v9, s[12:15], s22 offen offset:3072 lds
    ds_read_b64_tr_b16 v[88:89], v10 offset:16384
    ds_read_b64_tr_b16 v[90:91], v10 offset:18432
    ds_read_b64_tr_b16 v[160:161], v10 offset:16392
    ds_read_b64_tr_b16 v[162:163], v10 offset:18440
    ds_read_b64_tr_b16 a[24:25], v10 offset:16640
    ds_read_b64_tr_b16 a[26:27], v10 offset:18688
    ds_read_b64_tr_b16 a[96:97], v10 offset:16648
    ds_read_b64_tr_b16 a[98:99], v10 offset:18696
    s_waitcnt vmcnt(12) lgkmcnt(0)
    s_barrier
    s_add_u32 m0, s44, 90112
    s_add_u32 s22, s42, 3145728
    buffer_load_dwordx4 v8, s[12:15], s22 offen offset:0 lds
    s_add_u32 s22, s42, 3161088
    buffer_load_dwordx4 v9, s[12:15], s22 offen offset:1024 lds
    s_add_u32 s22, s42, 3176448
    buffer_load_dwordx4 v8, s[12:15], s22 offen offset:2048 lds
    s_add_u32 s22, s42, 3191808
    buffer_load_dwordx4 v9, s[12:15], s22 offen offset:3072 lds
    ds_read_b64_tr_b16 v[92:93], v10 offset:32768
    ds_read_b64_tr_b16 v[94:95], v10 offset:34816
    ds_read_b64_tr_b16 v[164:165], v10 offset:32776
    ds_read_b64_tr_b16 v[166:167], v10 offset:34824
    ds_read_b64_tr_b16 a[28:29], v10 offset:33024
    ds_read_b64_tr_b16 a[30:31], v10 offset:35072
    ds_read_b64_tr_b16 a[100:101], v10 offset:33032
    ds_read_b64_tr_b16 a[102:103], v10 offset:35080
    s_waitcnt vmcnt(12) lgkmcnt(0)
    s_barrier
    s_add_u32 m0, s44, 106496
    s_add_u32 s22, s42, 3538944
    buffer_load_dwordx4 v8, s[12:15], s22 offen offset:0 lds
    s_add_u32 s22, s42, 3554304
    buffer_load_dwordx4 v9, s[12:15], s22 offen offset:1024 lds
    s_add_u32 s22, s42, 3569664
    buffer_load_dwordx4 v8, s[12:15], s22 offen offset:2048 lds
    s_add_u32 s22, s42, 3585024
    buffer_load_dwordx4 v9, s[12:15], s22 offen offset:3072 lds
    ds_read_b64_tr_b16 v[96:97], v11 offset:0
    ds_read_b64_tr_b16 v[98:99], v11 offset:2048
    ds_read_b64_tr_b16 v[168:169], v11 offset:8
    ds_read_b64_tr_b16 v[170:171], v11 offset:2056
    ds_read_b64_tr_b16 a[32:33], v11 offset:256
    ds_read_b64_tr_b16 a[34:35], v11 offset:2304
    ds_read_b64_tr_b16 a[104:105], v11 offset:264
    ds_read_b64_tr_b16 a[106:107], v11 offset:2312
    s_waitcnt vmcnt(12) lgkmcnt(0)
    s_barrier
    s_add_u32 m0, s44, 122880
    s_add_u32 s22, s42, 3801088
    buffer_load_dwordx4 v8, s[12:15], s22 offen offset:0 lds
    s_add_u32 s22, s42, 3816448
    buffer_load_dwordx4 v9, s[12:15], s22 offen offset:1024 lds
    s_add_u32 s22, s42, 3831808
    buffer_load_dwordx4 v8, s[12:15], s22 offen offset:2048 lds
    s_add_u32 s22, s42, 3847168
    buffer_load_dwordx4 v9, s[12:15], s22 offen offset:3072 lds
    ds_read_b64_tr_b16 v[100:101], v11 offset:16384
    ds_read_b64_tr_b16 v[102:103], v11 offset:18432
    ds_read_b64_tr_b16 v[172:173], v11 offset:16392
    ds_read_b64_tr_b16 v[174:175], v11 offset:18440
    ds_read_b64_tr_b16 a[36:37], v11 offset:16640
    ds_read_b64_tr_b16 a[38:39], v11 offset:18688
    ds_read_b64_tr_b16 a[108:109], v11 offset:16648
    ds_read_b64_tr_b16 a[110:111], v11 offset:18696
    s_waitcnt vmcnt(12) lgkmcnt(0)
    s_barrier
    s_add_u32 m0, s44, 139264
    s_add_u32 s22, s42, 4063232
    buffer_load_dwordx4 v8, s[12:15], s22 offen offset:0 lds
    s_add_u32 s22, s42, 4078592
    buffer_load_dwordx4 v9, s[12:15], s22 offen offset:1024 lds
    s_add_u32 s22, s42, 4093952
    buffer_load_dwordx4 v8, s[12:15], s22 offen offset:2048 lds
    s_add_u32 s22, s42, 4109312
    buffer_load_dwordx4 v9, s[12:15], s22 offen offset:3072 lds
    ds_read_b64_tr_b16 v[104:105], v10 offset:0
    ds_read_b64_tr_b16 v[106:107], v10 offset:2048
    ds_read_b64_tr_b16 v[176:177], v10 offset:8
    ds_read_b64_tr_b16 v[178:179], v10 offset:2056
    ds_read_b64_tr_b16 a[40:41], v10 offset:256
    ds_read_b64_tr_b16 a[42:43], v10 offset:2304
    ds_read_b64_tr_b16 a[112:113], v10 offset:264
    ds_read_b64_tr_b16 a[114:115], v10 offset:2312
    s_waitcnt vmcnt(12) lgkmcnt(0)
    s_barrier
    s_add_u32 m0, s44, 73728
    s_add_u32 s22, s42, 4325376
    buffer_load_dwordx4 v8, s[12:15], s22 offen offset:0 lds
    s_add_u32 s22, s42, 4340736
    buffer_load_dwordx4 v9, s[12:15], s22 offen offset:1024 lds
    s_add_u32 s22, s42, 4356096
    buffer_load_dwordx4 v8, s[12:15], s22 offen offset:2048 lds
    s_add_u32 s22, s42, 4371456
    buffer_load_dwordx4 v9, s[12:15], s22 offen offset:3072 lds
    ds_read_b64_tr_b16 v[108:109], v10 offset:16384
    ds_read_b64_tr_b16 v[110:111], v10 offset:18432
    ds_read_b64_tr_b16 v[180:181], v10 offset:16392
    ds_read_b64_tr_b16 v[182:183], v10 offset:18440
    ds_read_b64_tr_b16 a[44:45], v10 offset:16640
    ds_read_b64_tr_b16 a[46:47], v10 offset:18688
    ds_read_b64_tr_b16 a[116:117], v10 offset:16648
    ds_read_b64_tr_b16 a[118:119], v10 offset:18696
    s_waitcnt vmcnt(12) lgkmcnt(0)
    s_barrier
    s_add_u32 m0, s44, 90112
    s_add_u32 s22, s43, 1048576
    buffer_load_dwordx4 v8, s[12:15], s22 offen offset:0 lds
    s_add_u32 s22, s43, 1063936
    buffer_load_dwordx4 v9, s[12:15], s22 offen offset:1024 lds
    s_add_u32 s22, s43, 1079296
    buffer_load_dwordx4 v8, s[12:15], s22 offen offset:2048 lds
    s_add_u32 s22, s43, 1094656
    buffer_load_dwordx4 v9, s[12:15], s22 offen offset:3072 lds
    ds_read_b64_tr_b16 v[112:113], v10 offset:32768
    ds_read_b64_tr_b16 v[114:115], v10 offset:34816
    ds_read_b64_tr_b16 v[184:185], v10 offset:32776
    ds_read_b64_tr_b16 v[186:187], v10 offset:34824
    ds_read_b64_tr_b16 a[48:49], v10 offset:33024
    ds_read_b64_tr_b16 a[50:51], v10 offset:35072
    ds_read_b64_tr_b16 a[120:121], v10 offset:33032
    ds_read_b64_tr_b16 a[122:123], v10 offset:35080
    s_waitcnt vmcnt(12) lgkmcnt(0)
    s_barrier
    s_add_u32 m0, s44, 106496
    s_add_u32 s22, s43, 3407872
    buffer_load_dwordx4 v8, s[12:15], s22 offen offset:0 lds
    s_add_u32 s22, s43, 3423232
    buffer_load_dwordx4 v9, s[12:15], s22 offen offset:1024 lds
    s_add_u32 s22, s43, 3438592
    buffer_load_dwordx4 v8, s[12:15], s22 offen offset:2048 lds
    s_add_u32 s22, s43, 3453952
    buffer_load_dwordx4 v9, s[12:15], s22 offen offset:3072 lds
    ds_read_b64_tr_b16 v[116:117], v11 offset:0
    ds_read_b64_tr_b16 v[118:119], v11 offset:2048
    ds_read_b64_tr_b16 v[188:189], v11 offset:8
    ds_read_b64_tr_b16 v[190:191], v11 offset:2056
    ds_read_b64_tr_b16 a[52:53], v11 offset:256
    ds_read_b64_tr_b16 a[54:55], v11 offset:2304
    ds_read_b64_tr_b16 a[124:125], v11 offset:264
    ds_read_b64_tr_b16 a[126:127], v11 offset:2312
    s_waitcnt vmcnt(12) lgkmcnt(0)
    s_barrier
    s_mov_b32 s27, 36864
    s_add_u32 s23, s27, s25
    s_add_u32 s31, s27, s30
    s_add_u32 m0, s23, 0
    s_nop 0
    buffer_load_dwordx4 v2, s[8:11], s24 offen offset:0 lds
    s_add_u32 m0, s23, 960
    s_nop 0
    buffer_load_dwordx4 v2, s[8:11], s24 offen offset:64 lds
    s_add_u32 m0, s23, 1920
    s_nop 0
    buffer_load_dwordx4 v2, s[8:11], s24 offen offset:128 lds
    s_add_u32 m0, s23, 2880
    s_nop 0
    buffer_load_dwordx4 v2, s[8:11], s24 offen offset:192 lds
    s_add_u32 m0, s23, 3808
    s_nop 0
    buffer_load_dwordx4 v2, s[8:11], s24 offen offset:288 lds
    s_add_u32 m0, s23, 4768
    s_nop 0
    buffer_load_dwordx4 v2, s[8:11], s24 offen offset:352 lds
    s_add_u32 m0, s23, 5728
    s_nop 0
    buffer_load_dwordx4 v2, s[8:11], s24 offen offset:416 lds
    s_add_u32 m0, s23, 6688
    s_nop 0
    buffer_load_dwordx4 v2, s[8:11], s24 offen offset:480 lds
    s_add_u32 m0, s31, 16128
    s_nop 0
    buffer_load_dwordx4 v6, s[8:11], s24 offen offset:256 lds
    s_add_u32 s24, s24, 147456
    ds_read_b64_tr_b16 v[120:121], v11 offset:16384
    ds_read_b64_tr_b16 v[122:123], v11 offset:18432
    ds_read_b64_tr_b16 v[192:193], v11 offset:16392
    ds_read_b64_tr_b16 v[194:195], v11 offset:18440
    ds_read_b64_tr_b16 a[56:57], v11 offset:16640
    ds_read_b64_tr_b16 a[58:59], v11 offset:18688
    ds_read_b64_tr_b16 a[128:129], v11 offset:16648
    ds_read_b64_tr_b16 a[130:131], v11 offset:18696
    s_waitcnt vmcnt(17) lgkmcnt(0)
    s_barrier
    ds_read_b64_tr_b16 v[124:125], v10 offset:0
    ds_read_b64_tr_b16 v[126:127], v10 offset:2048
    ds_read_b64_tr_b16 v[196:197], v10 offset:8
    ds_read_b64_tr_b16 v[198:199], v10 offset:2056
    ds_read_b64_tr_b16 a[60:61], v10 offset:256
    ds_read_b64_tr_b16 a[62:63], v10 offset:2304
    ds_read_b64_tr_b16 a[132:133], v10 offset:264
    ds_read_b64_tr_b16 a[134:135], v10 offset:2312
    s_waitcnt vmcnt(13) lgkmcnt(0)
    s_barrier
    ds_read_b64_tr_b16 v[128:129], v10 offset:16384
    ds_read_b64_tr_b16 v[130:131], v10 offset:18432
    ds_read_b64_tr_b16 v[200:201], v10 offset:16392
    ds_read_b64_tr_b16 v[202:203], v10 offset:18440
    ds_read_b64_tr_b16 a[64:65], v10 offset:16640
    ds_read_b64_tr_b16 a[66:67], v10 offset:18688
    ds_read_b64_tr_b16 a[136:137], v10 offset:16648
    ds_read_b64_tr_b16 a[138:139], v10 offset:18696
    s_waitcnt vmcnt(9) lgkmcnt(0)
    s_barrier
    ds_read_b64_tr_b16 v[132:133], v10 offset:32768
    ds_read_b64_tr_b16 v[134:135], v10 offset:34816
    ds_read_b64_tr_b16 v[204:205], v10 offset:32776
    ds_read_b64_tr_b16 v[206:207], v10 offset:34824
    ds_read_b64_tr_b16 a[68:69], v10 offset:33024
    ds_read_b64_tr_b16 a[70:71], v10 offset:35072
    ds_read_b64_tr_b16 a[140:141], v10 offset:33032
    ds_read_b64_tr_b16 a[142:143], v10 offset:35080
    s_mov_b32 s88, 4194304
gn6:
    buffer_load_dword v250, off, s[84:87], 0 offset:216 sc1
    s_waitcnt vmcnt(0)
    v_readfirstlane_b32 s95, v250
    s_sub_u32 s88, s88, 1
    s_cbranch_scc1 gn6x
    s_cmp_eq_u32 s95, 0
    s_cbranch_scc1 gn6
gn6x:
    s_waitcnt lgkmcnt(0)
    s_mov_b32 s45, 0
    s_mov_b32 s27, 0
    s_cmp_eq_u32 s18, 0
    s_cselect_b32 s34, 1, 0
    s_mov_b32 s35, 0
    s_cmp_eq_u32 s16, 2
    s_cbranch_scc1 qk_vloop
qk_loop:
    s_barrier
    v_add_u32 v3, s27, v1
    ds_read_b128 v[32:35], v3 offset:0
    ds_read_b128 v[36:39], v3 offset:18432
    ds_read_b128 v[40:43], v3 offset:1024
    ds_read_b128 v[44:47], v3 offset:19456
    ds_read_b128 v[48:51], v3 offset:2048
    ds_read_b128 v[52:55], v3 offset:20480
    s_add_u32 s23, s45, s95
    v_mov_b32 v4, s23
    s_mov_b64 exec, s[34:35]
    buffer_store_dword v4, off, s[4:7], s29 sc1
    buffer_store_dword v4, off, s[4:7], s29 offset:128 sc1
    s_mov_b64 exec, -1
    s_add_u32 s22, s27, 73728
    s_sub_u32 s21, s22, 110592
    s_cselect_b32 s22, s22, s21
    ds_read_b128 v[56:59], v3 offset:3072
    ds_read_b128 v[60:63], v3 offset:21504
    s_add_u32 s23, s22, s25
    s_add_u32 s31, s22, s30
    s_add_u32 m0, s23, 0
    s_nop 0
    buffer_load_dwordx4 v2, s[8:11], s24 offen offset:0 lds
    s_waitcnt lgkmcnt(6)
    v_mfma_f32_16x16x32_bf16 v[208:211], v[64:67], v[32:35], 0
    v_mfma_f32_16x16x32_bf16 v[212:215], v[136:139], v[32:35], 0
    v_mfma_f32_16x16x32_bf16 v[216:219], v[64:67], v[36:39], 0
    v_mfma_f32_16x16x32_bf16 v[220:223], v[136:139], v[36:39], 0
    v_mfma_f32_16x16x32_bf16 v[224:227], a[0:3], v[32:35], 0
    v_mfma_f32_16x16x32_bf16 v[228:231], a[72:75], v[32:35], 0
    v_mfma_f32_16x16x32_bf16 v[232:235], a[0:3], v[36:39], 0
    v_mfma_f32_16x16x32_bf16 v[236:239], a[72:75], v[36:39], 0
    ds_read_b128 v[32:35], v3 offset:4096
    ds_read_b128 v[36:39], v3 offset:22528
    s_add_u32 m0, s23, 960
    s_nop 0
    buffer_load_dwordx4 v2, s[8:11], s24 offen offset:64 lds
    s_waitcnt lgkmcnt(6)
    v_mfma_f32_16x16x32_bf16 v[208:211], v[68:71], v[40:43], v[208:211]
    v_mfma_f32_16x16x32_bf16 v[212:215], v[140:143], v[40:43], v[212:215]
    v_mfma_f32_16x16x32_bf16 v[216:219], v[68:71], v[44:47], v[216:219]
    v_mfma_f32_16x16x32_bf16 v[220:223], v[140:143], v[44:47], v[220:223]
    v_mfma_f32_16x16x32_bf16 v[224:227], a[4:7], v[40:43], v[224:227]
    v_mfma_f32_16x16x32_bf16 v[228:231], a[76:79], v[40:43], v[228:231]
    v_mfma_f32_16x16x32_bf16 v[232:235], a[4:7], v[44:47], v[232:235]
    v_mfma_f32_16x16x32_bf16 v[236:239], a[76:79], v[44:47], v[236:239]
    ds_read_b128 v[40:43], v3 offset:5120
    ds_read_b128 v[44:47], v3 offset:23552
    s_add_u32 m0, s23, 1920
    s_nop 0
    buffer_load_dwordx4 v2, s[8:11], s24 offen offset:128 lds
    s_waitcnt lgkmcnt(6)
    v_mfma_f32_16x16x32_bf16 v[208:211], v[72:75], v[48:51], v[208:211]
    v_mfma_f32_16x16x32_bf16 v[212:215], v[144:147], v[48:51], v[212:215]
    v_mfma_f32_16x16x32_bf16 v[216:219], v[72:75], v[52:55], v[216:219]
    v_mfma_f32_16x16x32_bf16 v[220:223], v[144:147], v[52:55], v[220:223]
    v_mfma_f32_16x16x32_bf16 v[224:227], a[8:11], v[48:51], v[224:227]
    v_mfma_f32_16x16x32_bf16 v[228:231], a[80:83], v[48:51], v[228:231]
    v_mfma_f32_16x16x32_bf16 v[232:235], a[8:11], v[52:55], v[232:235]
    v_mfma_f32_16x16x32_bf16 v[236:239], a[80:83], v[52:55], v[236:239]
    ds_read_b128 v[48:51], v3 offset:6144
    ds_read_b128 v[52:55], v3 offset:24576
    s_add_u32 m0, s23, 2880
    s_nop 0
    buffer_load_dwordx4 v2, s[8:11], s24 offen offset:192 lds
    s_waitcnt lgkmcnt(6)
    v_mfma_f32_16x16x32_bf16 v[208:211], v[76:79], v[56:59], v[208:211]
    v_mfma_f32_16x16x32_bf16 v[212:215], v[148:151], v[56:59], v[212:215]
    v_mfma_f32_16x16x32_bf16 v[216:219], v[76:79], v[60:63], v[216:219]
    v_mfma_f32_16x16x32_bf16 v[220:223], v[148:151], v[60:63], v[220:223]
    v_mfma_f32_16x16x32_bf16 v[224:227], a[12:15], v[56:59], v[224:227]
    v_mfma_f32_16x16x32_bf16 v[228:231], a[84:87], v[56:59], v[228:231]
    v_mfma_f32_16x16x32_bf16 v[232:235], a[12:15], v[60:63], v[232:235]
    v_mfma_f32_16x16x32_bf16 v[236:239], a[84:87], v[60:63], v[236:239]
    ds_read_b128 v[56:59], v3 offset:7168
    ds_read_b128 v[60:63], v3 offset:25600
    s_add_u32 m0, s23, 3808
    s_nop 0
    buffer_load_dwordx4 v2, s[8:11], s24 offen offset:288 lds
    s_waitcnt lgkmcnt(6)
    v_mfma_f32_16x16x32_bf16 v[208:211], v[80:83], v[32:35], v[208:211]
    v_mfma_f32_16x16x32_bf16 v[212:215], v[152:155], v[32:35], v[212:215]
    v_mfma_f32_16x16x32_bf16 v[216:219], v[80:83], v[36:39], v[216:219]
    v_mfma_f32_16x16x32_bf16 v[220:223], v[152:155], v[36:39], v[220:223]
    v_mfma_f32_16x16x32_bf16 v[224:227], a[16:19], v[32:35], v[224:227]
    v_mfma_f32_16x16x32_bf16 v[228:231], a[88:91], v[32:35], v[228:231]
    v_mfma_f32_16x16x32_bf16 v[232:235], a[16:19], v[36:39], v[232:235]
    v_mfma_f32_16x16x32_bf16 v[236:239], a[88:91], v[36:39], v[236:239]
    ds_read_b128 v[32:35], v3 offset:8192
    ds_read_b128 v[36:39], v3 offset:26624
    s_add_u32 m0, s23, 4768
    s_nop 0
    buffer_load_dwordx4 v2, s[8:11], s24 offen offset:352 lds
    s_waitcnt lgkmcnt(6)
    v_mfma_f32_16x16x32_bf16 v[208:211], v[84:87], v[40:43], v[208:211]
    v_mfma_f32_16x16x32_bf16 v[212:215], v[156:159], v[40:43], v[212:215]
    v_mfma_f32_16x16x32_bf16 v[216:219], v[84:87], v[44:47], v[216:219]
    v_mfma_f32_16x16x32_bf16 v[220:223], v[156:159], v[44:47], v[220:223]
    v_mfma_f32_16x16x32_bf16 v[224:227], a[20:23], v[40:43], v[224:227]
    v_mfma_f32_16x16x32_bf16 v[228:231], a[92:95], v[40:43], v[228:231]
    v_mfma_f32_16x16x32_bf16 v[232:235], a[20:23], v[44:47], v[232:235]
    v_mfma_f32_16x16x32_bf16 v[236:239], a[92:95], v[44:47], v[236:239]
    ds_read_b128 v[40:43], v3 offset:9216
    ds_read_b128 v[44:47], v3 offset:27648
    s_add_u32 m0, s23, 5728
    s_nop 0
    buffer_load_dwordx4 v2, s[8:11], s24 offen offset:416 lds
    s_waitcnt lgkmcnt(6)
    v_mfma_f32_16x16x32_bf16 v[208:211], v[88:91], v[48:51], v[208:211]
    v_mfma_f32_16x16x32_bf16 v[212:215], v[160:163], v[48:51], v[212:215]
    v_mfma_f32_16x16x32_bf16 v[216:219], v[88:91], v[52:55], v[216:219]
    v_mfma_f32_16x16x32_bf16 v[220:223], v[160:163], v[52:55], v[220:223]
    v_mfma_f32_16x16x32_bf16 v[224:227], a[24:27], v[48:51], v[224:227]
    v_mfma_f32_16x16x32_bf16 v[228:231], a[96:99], v[48:51], v[228:231]
    v_mfma_f32_16x16x32_bf16 v[232:235], a[24:27], v[52:55], v[232:235]
    v_mfma_f32_16x16x32_bf16 v[236:239], a[96:99], v[52:55], v[236:239]
    ds_read_b128 v[48:51], v3 offset:10240
    ds_read_b128 v[52:55], v3 offset:28672
    s_add_u32 m0, s23, 6688
    s_nop 0
    buffer_load_dwordx4 v2, s[8:11], s24 offen offset:480 lds
    s_waitcnt lgkmcnt(6)
    v_mfma_f32_16x16x32_bf16 v[208:211], v[92:95], v[56:59], v[208:211]
    v_mfma_f32_16x16x32_bf16 v[212:215], v[164:167], v[56:59], v[212:215]
    v_mfma_f32_16x16x32_bf16 v[216:219], v[92:95], v[60:63], v[216:219]
    v_mfma_f32_16x16x32_bf16 v[220:223], v[164:167], v[60:63], v[220:223]
    v_mfma_f32_16x16x32_bf16 v[224:227], a[28:31], v[56:59], v[224:227]
    v_mfma_f32_16x16x32_bf16 v[228:231], a[100:103], v[56:59], v[228:231]
    v_mfma_f32_16x16x32_bf16 v[232:235], a[28:31], v[60:63], v[232:235]
    v_mfma_f32_16x16x32_bf16 v[236:239], a[100:103], v[60:63], v[236:239]
    ds_read_b128 v[56:59], v3 offset:11264
    ds_read_b128 v[60:63], v3 offset:29696
    s_add_u32 m0, s31, 16128
    s_nop 0
    buffer_load_dwordx4 v6, s[8:11], s24 offen offset:256 lds
    s_add_u32 s24, s24, 147456
    s_waitcnt lgkmcnt(6)
    v_mfma_f32_16x16x32_bf16 v[208:211], v[96:99], v[32:35], v[208:211]
    v_mfma_f32_16x16x32_bf16 v[212:215], v[168:171], v[32:35], v[212:215]
    v_mfma_f32_16x16x32_bf16 v[216:219], v[96:99], v[36:39], v[216:219]
    v_mfma_f32_16x16x32_bf16 v[220:223], v[168:171], v[36:39], v[220:223]
    v_mfma_f32_16x16x32_bf16 v[224:227], a[32:35], v[32:35], v[224:227]
    v_mfma_f32_16x16x32_bf16 v[228:231], a[104:107], v[32:35], v[228:231]
    v_mfma_f32_16x16x32_bf16 v[232:235], a[32:35], v[36:39], v[232:235]
    v_mfma_f32_16x16x32_bf16 v[236:239], a[104:107], v[36:39], v[236:239]
    ds_read_b128 v[32:35], v3 offset:12288
    ds_read_b128 v[36:39], v3 offset:30720
    s_waitcnt lgkmcnt(6)
    v_mfma_f32_16x16x32_bf16 v[208:211], v[100:103], v[40:43], v[208:211]
    v_mfma_f32_16x16x32_bf16 v[212:215], v[172:175], v[40:43], v[212:215]
    v_mfma_f32_16x16x32_bf16 v[216:219], v[100:103], v[44:47], v[216:219]
    v_mfma_f32_16x16x32_bf16 v[220:223], v[172:175], v[44:47], v[220:223]
    v_mfma_f32_16x16x32_bf16 v[224:227], a[36:39], v[40:43], v[224:227]
    v_mfma_f32_16x16x32_bf16 v[228:231], a[108:111], v[40:43], v[228:231]
    v_mfma_f32_16x16x32_bf16 v[232:235], a[36:39], v[44:47], v[232:235]
    v_mfma_f32_16x16x32_bf16 v[236:239], a[108:111], v[44:47], v[236:239]
    ds_read_b128 v[40:43], v3 offset:13312
    ds_read_b128 v[44:47], v3 offset:31744
    s_waitcnt lgkmcnt(6)
    v_mfma_f32_16x16x32_bf16 v[208:211], v[104:107], v[48:51], v[208:211]
    v_mfma_f32_16x16x32_bf16 v[212:215], v[176:179], v[48:51], v[212:215]
    v_mfma_f32_16x16x32_bf16 v[216:219], v[104:107], v[52:55], v[216:219]
    v_mfma_f32_16x16x32_bf16 v[220:223], v[176:179], v[52:55], v[220:223]
    v_mfma_f32_16x16x32_bf16 v[224:227], a[40:43], v[48:51], v[224:227]
    v_mfma_f32_16x16x32_bf16 v[228:231], a[112:115], v[48:51], v[228:231]
    v_mfma_f32_16x16x32_bf16 v[232:235], a[40:43], v[52:55], v[232:235]
    v_mfma_f32_16x16x32_bf16 v[236:239], a[112:115], v[52:55], v[236:239]
    ds_read_b128 v[48:51], v3 offset:14336
    ds_read_b128 v[52:55], v3 offset:32768
    s_waitcnt lgkmcnt(6)
    v_mfma_f32_16x16x32_bf16 v[208:211], v[108:111], v[56:59], v[208:211]
    v_mfma_f32_16x16x32_bf16 v[212:215], v[180:183], v[56:59], v[212:215]
    v_mfma_f32_16x16x32_bf16 v[216:219], v[108:111], v[60:63], v[216:219]
    v_mfma_f32_16x16x32_bf16 v[220:223], v[180:183], v[60:63], v[220:223]
    v_mfma_f32_16x16x32_bf16 v[224:227], a[44:47], v[56:59], v[224:227]
    v_mfma_f32_16x16x32_bf16 v[228:231], a[116:119], v[56:59], v[228:231]
    v_mfma_f32_16x16x32_bf16 v[232:235], a[44:47], v[60:63], v[232:235]
    v_mfma_f32_16x16x32_bf16 v[236:239], a[116:119], v[60:63], v[236:239]
    ds_read_b128 v[56:59], v3 offset:15360
    ds_read_b128 v[60:63], v3 offset:33792
    s_waitcnt lgkmcnt(6)
    v_mfma_f32_16x16x32_bf16 v[208:211], v[112:115], v[32:35], v[208:211]
    v_mfma_f32_16x16x32_bf16 v[212:215], v[184:187], v[32:35], v[212:215]
    v_mfma_f32_16x16x32_bf16 v[216:219], v[112:115], v[36:39], v[216:219]
    v_mfma_f32_16x16x32_bf16 v[220:223], v[184:187], v[36:39], v[220:223]
    v_mfma_f32_16x16x32_bf16 v[224:227], a[48:51], v[32:35], v[224:227]
    v_mfma_f32_16x16x32_bf16 v[228:231], a[120:123], v[32:35], v[228:231]
    v_mfma_f32_16x16x32_bf16 v[232:235], a[48:51], v[36:39], v[232:235]
    v_mfma_f32_16x16x32_bf16 v[236:239], a[120:123], v[36:39], v[236:239]
    ds_read_b128 v[32:35], v3 offset:16384
    ds_read_b128 v[36:39], v3 offset:34816
    s_waitcnt lgkmcnt(6)
    v_mfma_f32_16x16x32_bf16 v[208:211], v[116:119], v[40:43], v[208:211]
    v_mfma_f32_16x16x32_bf16 v[212:215], v[188:191], v[40:43], v[212:215]
    v_mfma_f32_16x16x32_bf16 v[216:219], v[116:119], v[44:47], v[216:219]
    v_mfma_f32_16x16x32_bf16 v[220:223], v[188:191], v[44:47], v[220:223]
    v_mfma_f32_16x16x32_bf16 v[224:227], a[52:55], v[40:43], v[224:227]
    v_mfma_f32_16x16x32_bf16 v[228:231], a[124:127], v[40:43], v[228:231]
    v_mfma_f32_16x16x32_bf16 v[232:235], a[52:55], v[44:47], v[232:235]
    v_mfma_f32_16x16x32_bf16 v[236:239], a[124:127], v[44:47], v[236:239]
    ds_read_b128 v[40:43], v3 offset:17408
    ds_read_b128 v[44:47], v3 offset:35840
    s_waitcnt lgkmcnt(6)
    v_mfma_f32_16x16x32_bf16 v[208:211], v[120:123], v[48:51], v[208:211]
    v_mfma_f32_16x16x32_bf16 v[212:215], v[192:195], v[48:51], v[212:215]
    v_mfma_f32_16x16x32_bf16 v[216:219], v[120:123], v[52:55], v[216:219]
    v_mfma_f32_16x16x32_bf16 v[220:223], v[192:195], v[52:55], v[220:223]
    v_mfma_f32_16x16x32_bf16 v[224:227], a[56:59], v[48:51], v[224:227]
    v_mfma_f32_16x16x32_bf16 v[228:231], a[128:131], v[48:51], v[228:231]
    v_mfma_f32_16x16x32_bf16 v[232:235], a[56:59], v[52:55], v[232:235]
    v_mfma_f32_16x16x32_bf16 v[236:239], a[128:131], v[52:55], v[236:239]
    s_waitcnt lgkmcnt(4)
    v_mfma_f32_16x16x32_bf16 v[208:211], v[124:127], v[56:59], v[208:211]
    v_mfma_f32_16x16x32_bf16 v[212:215], v[196:199], v[56:59], v[212:215]
    v_mfma_f32_16x16x32_bf16 v[216:219], v[124:127], v[60:63], v[216:219]
    v_mfma_f32_16x16x32_bf16 v[220:223], v[196:199], v[60:63], v[220:223]
    v_mfma_f32_16x16x32_bf16 v[224:227], a[60:63], v[56:59], v[224:227]
    v_mfma_f32_16x16x32_bf16 v[228:231], a[132:135], v[56:59], v[228:231]
    v_mfma_f32_16x16x32_bf16 v[232:235], a[60:63], v[60:63], v[232:235]
    v_mfma_f32_16x16x32_bf16 v[236:239], a[132:135], v[60:63], v[236:239]
    s_waitcnt lgkmcnt(2)
    v_mfma_f32_16x16x32_bf16 v[208:211], v[128:131], v[32:35], v[208:211]
    v_mfma_f32_16x16x32_bf16 v[212:215], v[200:203], v[32:35], v[212:215]
    v_mfma_f32_16x16x32_bf16 v[216:219], v[128:131], v[36:39], v[216:219]
    v_mfma_f32_16x16x32_bf16 v[220:223], v[200:203], v[36:39], v[220:223]
    v_mfma_f32_16x16x32_bf16 v[224:227], a[64:67], v[32:35], v[224:227]
    v_mfma_f32_16x16x32_bf16 v[228:231], a[136:139], v[32:35], v[228:231]
    v_mfma_f32_16x16x32_bf16 v[232:235], a[64:67], v[36:39], v[232:235]
    v_mfma_f32_16x16x32_bf16 v[236:239], a[136:139], v[36:39], v[236:239]
    s_waitcnt lgkmcnt(0)
    v_mfma_f32_16x16x32_bf16 v[208:211], v[132:135], v[40:43], v[208:211]
    v_mfma_f32_16x16x32_bf16 v[212:215], v[204:207], v[40:43], v[212:215]
    v_mfma_f32_16x16x32_bf16 v[216:219], v[132:135], v[44:47], v[216:219]
    v_mfma_f32_16x16x32_bf16 v[220:223], v[204:207], v[44:47], v[220:223]
    v_mfma_f32_16x16x32_bf16 v[224:227], a[68:71], v[40:43], v[224:227]
    v_mfma_f32_16x16x32_bf16 v[228:231], a[140:143], v[40:43], v[228:231]
    v_mfma_f32_16x16x32_bf16 v[232:235], a[68:71], v[44:47], v[232:235]
    v_mfma_f32_16x16x32_bf16 v[236:239], a[140:143], v[44:47], v[236:239]
    s_waitcnt vmcnt(0)
    v_cvt_pk_bf16_f32 v8, v208, v209
    v_cvt_pk_bf16_f32 v9, v210, v211
    v_cvt_pk_bf16_f32 v10, v212, v213
    v_cvt_pk_bf16_f32 v11, v214, v215
    s_lshr_b32 s22, s41, 5
    s_mul_i32 s22, s22, 0
    s_add_u32 s28, s26, s22
    buffer_store_dwordx4 v[8:11], v7, s[4:7], s28 offen sc1
    v_cvt_pk_bf16_f32 v12, v216, v217
    v_cvt_pk_bf16_f32 v13, v218, v219
    v_cvt_pk_bf16_f32 v14, v220, v221
    v_cvt_pk_bf16_f32 v15, v222, v223
    s_lshr_b32 s22, s41, 5
    s_mul_i32 s22, s22, 0
    s_add_u32 s28, s26, s22
    s_add_u32 s28, s28, s40
    buffer_store_dwordx4 v[12:15], v7, s[4:7], s28 offen sc1
    v_cvt_pk_bf16_f32 v16, v224, v225
    v_cvt_pk_bf16_f32 v17, v226, v227
    v_cvt_pk_bf16_f32 v18, v228, v229
    v_cvt_pk_bf16_f32 v19, v230, v231
    s_lshr_b32 s22, s41, 5
    s_mul_i32 s22, s22, 1
    s_add_u32 s28, s26, s22
    buffer_store_dwordx4 v[16:19], v7, s[4:7], s28 offen sc1
    v_cvt_pk_bf16_f32 v20, v232, v233
    v_cvt_pk_bf16_f32 v21, v234, v235
    v_cvt_pk_bf16_f32 v22, v236, v237
    v_cvt_pk_bf16_f32 v23, v238, v239
    s_lshr_b32 s22, s41, 5
    s_mul_i32 s22, s22, 1
    s_add_u32 s28, s26, s22
    s_add_u32 s28, s28, s40
    buffer_store_dwordx4 v[20:23], v7, s[4:7], s28 offen sc1
    s_lshl_b32 s22, s41, 2
    s_add_u32 s26, s26, s22
    s_lshr_b32 s45, s19, 2
    s_cbranch_scc1 qk_loop_nf
    s_waitcnt vmcnt(0)
    s_mov_b32 s45, 1
qk_loop_nf:
    s_add_u32 s27, s27, 36864
    s_cmp_eq_u32 s27, 110592
    s_cselect_b32 s27, 0, s27
    s_add_u32 s19, s19, 4
    s_cmp_lt_u32 s19, s20
    s_cbranch_scc1 qk_loop
    s_branch qk_done
qk_vloop:
    s_barrier
    v_add_u32 v3, s27, v1
    ds_read_b128 v[32:35], v3 offset:0
    ds_read_b128 v[36:39], v3 offset:18432
    ds_read_b128 v[40:43], v3 offset:1024
    ds_read_b128 v[44:47], v3 offset:19456
    ds_read_b128 v[48:51], v3 offset:2048
    ds_read_b128 v[52:55], v3 offset:20480
    s_add_u32 s23, s45, s95
    v_mov_b32 v4, s23
    s_mov_b64 exec, s[34:35]
    buffer_store_dword v4, off, s[4:7], s29 sc1
    buffer_store_dword v4, off, s[4:7], s29 offset:128 sc1
    s_mov_b64 exec, -1
    s_add_u32 s22, s27, 73728
    s_sub_u32 s21, s22, 110592
    s_cselect_b32 s22, s22, s21
    ds_read_b128 v[56:59], v3 offset:3072
    ds_read_b128 v[60:63], v3 offset:21504
    s_add_u32 s23, s22, s25
    s_add_u32 s31, s22, s30
    s_add_u32 m0, s23, 0
    s_nop 0
    buffer_load_dwordx4 v2, s[8:11], s24 offen offset:0 lds
    s_waitcnt lgkmcnt(6)
    v_mfma_f32_16x16x32_bf16 v[208:211], v[32:35], v[64:67], 0
    v_mfma_f32_16x16x32_bf16 v[212:215], v[32:35], v[136:139], 0
    v_mfma_f32_16x16x32_bf16 v[216:219], v[36:39], v[64:67], 0
    v_mfma_f32_16x16x32_bf16 v[220:223], v[36:39], v[136:139], 0
    v_mfma_f32_16x16x32_bf16 v[224:227], v[32:35], a[0:3], 0
    v_mfma_f32_16x16x32_bf16 v[228:231], v[32:35], a[72:75], 0
    v_mfma_f32_16x16x32_bf16 v[232:235], v[36:39], a[0:3], 0
    v_mfma_f32_16x16x32_bf16 v[236:239], v[36:39], a[72:75], 0
    ds_read_b128 v[32:35], v3 offset:4096
    ds_read_b128 v[36:39], v3 offset:22528
    s_add_u32 m0, s23, 960
    s_nop 0
    buffer_load_dwordx4 v2, s[8:11], s24 offen offset:64 lds
    s_waitcnt lgkmcnt(6)
    v_mfma_f32_16x16x32_bf16 v[208:211], v[40:43], v[68:71], v[208:211]
    v_mfma_f32_16x16x32_bf16 v[212:215], v[40:43], v[140:143], v[212:215]
    v_mfma_f32_16x16x32_bf16 v[216:219], v[44:47], v[68:71], v[216:219]
    v_mfma_f32_16x16x32_bf16 v[220:223], v[44:47], v[140:143], v[220:223]
    v_mfma_f32_16x16x32_bf16 v[224:227], v[40:43], a[4:7], v[224:227]
    v_mfma_f32_16x16x32_bf16 v[228:231], v[40:43], a[76:79], v[228:231]
    v_mfma_f32_16x16x32_bf16 v[232:235], v[44:47], a[4:7], v[232:235]
    v_mfma_f32_16x16x32_bf16 v[236:239], v[44:47], a[76:79], v[236:239]
    ds_read_b128 v[40:43], v3 offset:5120
    ds_read_b128 v[44:47], v3 offset:23552
    s_add_u32 m0, s23, 1920
    s_nop 0
    buffer_load_dwordx4 v2, s[8:11], s24 offen offset:128 lds
    s_waitcnt lgkmcnt(6)
    v_mfma_f32_16x16x32_bf16 v[208:211], v[48:51], v[72:75], v[208:211]
    v_mfma_f32_16x16x32_bf16 v[212:215], v[48:51], v[144:147], v[212:215]
    v_mfma_f32_16x16x32_bf16 v[216:219], v[52:55], v[72:75], v[216:219]
    v_mfma_f32_16x16x32_bf16 v[220:223], v[52:55], v[144:147], v[220:223]
    v_mfma_f32_16x16x32_bf16 v[224:227], v[48:51], a[8:11], v[224:227]
    v_mfma_f32_16x16x32_bf16 v[228:231], v[48:51], a[80:83], v[228:231]
    v_mfma_f32_16x16x32_bf16 v[232:235], v[52:55], a[8:11], v[232:235]
    v_mfma_f32_16x16x32_bf16 v[236:239], v[52:55], a[80:83], v[236:239]
    ds_read_b128 v[48:51], v3 offset:6144
    ds_read_b128 v[52:55], v3 offset:24576
    s_add_u32 m0, s23, 2880
    s_nop 0
    buffer_load_dwordx4 v2, s[8:11], s24 offen offset:192 lds
    s_waitcnt lgkmcnt(6)
    v_mfma_f32_16x16x32_bf16 v[208:211], v[56:59], v[76:79], v[208:211]
    v_mfma_f32_16x16x32_bf16 v[212:215], v[56:59], v[148:151], v[212:215]
    v_mfma_f32_16x16x32_bf16 v[216:219], v[60:63], v[76:79], v[216:219]
    v_mfma_f32_16x16x32_bf16 v[220:223], v[60:63], v[148:151], v[220:223]
    v_mfma_f32_16x16x32_bf16 v[224:227], v[56:59], a[12:15], v[224:227]
    v_mfma_f32_16x16x32_bf16 v[228:231], v[56:59], a[84:87], v[228:231]
    v_mfma_f32_16x16x32_bf16 v[232:235], v[60:63], a[12:15], v[232:235]
    v_mfma_f32_16x16x32_bf16 v[236:239], v[60:63], a[84:87], v[236:239]
    ds_read_b128 v[56:59], v3 offset:7168
    ds_read_b128 v[60:63], v3 offset:25600
    s_add_u32 m0, s23, 3808
    s_nop 0
    buffer_load_dwordx4 v2, s[8:11], s24 offen offset:288 lds
    s_waitcnt lgkmcnt(6)
    v_mfma_f32_16x16x32_bf16 v[208:211], v[32:35], v[80:83], v[208:211]
    v_mfma_f32_16x16x32_bf16 v[212:215], v[32:35], v[152:155], v[212:215]
    v_mfma_f32_16x16x32_bf16 v[216:219], v[36:39], v[80:83], v[216:219]
    v_mfma_f32_16x16x32_bf16 v[220:223], v[36:39], v[152:155], v[220:223]
    v_mfma_f32_16x16x32_bf16 v[224:227], v[32:35], a[16:19], v[224:227]
    v_mfma_f32_16x16x32_bf16 v[228:231], v[32:35], a[88:91], v[228:231]
    v_mfma_f32_16x16x32_bf16 v[232:235], v[36:39], a[16:19], v[232:235]
    v_mfma_f32_16x16x32_bf16 v[236:239], v[36:39], a[88:91], v[236:239]
    ds_read_b128 v[32:35], v3 offset:8192
    ds_read_b128 v[36:39], v3 offset:26624
    s_add_u32 m0, s23, 4768
    s_nop 0
    buffer_load_dwordx4 v2, s[8:11], s24 offen offset:352 lds
    s_waitcnt lgkmcnt(6)
    v_mfma_f32_16x16x32_bf16 v[208:211], v[40:43], v[84:87], v[208:211]
    v_mfma_f32_16x16x32_bf16 v[212:215], v[40:43], v[156:159], v[212:215]
    v_mfma_f32_16x16x32_bf16 v[216:219], v[44:47], v[84:87], v[216:219]
    v_mfma_f32_16x16x32_bf16 v[220:223], v[44:47], v[156:159], v[220:223]
    v_mfma_f32_16x16x32_bf16 v[224:227], v[40:43], a[20:23], v[224:227]
    v_mfma_f32_16x16x32_bf16 v[228:231], v[40:43], a[92:95], v[228:231]
    v_mfma_f32_16x16x32_bf16 v[232:235], v[44:47], a[20:23], v[232:235]
    v_mfma_f32_16x16x32_bf16 v[236:239], v[44:47], a[92:95], v[236:239]
    ds_read_b128 v[40:43], v3 offset:9216
    ds_read_b128 v[44:47], v3 offset:27648
    s_add_u32 m0, s23, 5728
    s_nop 0
    buffer_load_dwordx4 v2, s[8:11], s24 offen offset:416 lds
    s_waitcnt lgkmcnt(6)
    v_mfma_f32_16x16x32_bf16 v[208:211], v[48:51], v[88:91], v[208:211]
    v_mfma_f32_16x16x32_bf16 v[212:215], v[48:51], v[160:163], v[212:215]
    v_mfma_f32_16x16x32_bf16 v[216:219], v[52:55], v[88:91], v[216:219]
    v_mfma_f32_16x16x32_bf16 v[220:223], v[52:55], v[160:163], v[220:223]
    v_mfma_f32_16x16x32_bf16 v[224:227], v[48:51], a[24:27], v[224:227]
    v_mfma_f32_16x16x32_bf16 v[228:231], v[48:51], a[96:99], v[228:231]
    v_mfma_f32_16x16x32_bf16 v[232:235], v[52:55], a[24:27], v[232:235]
    v_mfma_f32_16x16x32_bf16 v[236:239], v[52:55], a[96:99], v[236:239]
    ds_read_b128 v[48:51], v3 offset:10240
    ds_read_b128 v[52:55], v3 offset:28672
    s_add_u32 m0, s23, 6688
    s_nop 0
    buffer_load_dwordx4 v2, s[8:11], s24 offen offset:480 lds
    s_waitcnt lgkmcnt(6)
    v_mfma_f32_16x16x32_bf16 v[208:211], v[56:59], v[92:95], v[208:211]
    v_mfma_f32_16x16x32_bf16 v[212:215], v[56:59], v[164:167], v[212:215]
    v_mfma_f32_16x16x32_bf16 v[216:219], v[60:63], v[92:95], v[216:219]
    v_mfma_f32_16x16x32_bf16 v[220:223], v[60:63], v[164:167], v[220:223]
    v_mfma_f32_16x16x32_bf16 v[224:227], v[56:59], a[28:31], v[224:227]
    v_mfma_f32_16x16x32_bf16 v[228:231], v[56:59], a[100:103], v[228:231]
    v_mfma_f32_16x16x32_bf16 v[232:235], v[60:63], a[28:31], v[232:235]
    v_mfma_f32_16x16x32_bf16 v[236:239], v[60:63], a[100:103], v[236:239]
    ds_read_b128 v[56:59], v3 offset:11264
    ds_read_b128 v[60:63], v3 offset:29696
    s_add_u32 m0, s31, 16128
    s_nop 0
    buffer_load_dwordx4 v6, s[8:11], s24 offen offset:256 lds
    s_add_u32 s24, s24, 147456
    s_waitcnt lgkmcnt(6)
    v_mfma_f32_16x16x32_bf16 v[208:211], v[32:35], v[96:99], v[208:211]
    v_mfma_f32_16x16x32_bf16 v[212:215], v[32:35], v[168:171], v[212:215]
    v_mfma_f32_16x16x32_bf16 v[216:219], v[36:39], v[96:99], v[216:219]
    v_mfma_f32_16x16x32_bf16 v[220:223], v[36:39], v[168:171], v[220:223]
    v_mfma_f32_16x16x32_bf16 v[224:227], v[32:35], a[32:35], v[224:227]
    v_mfma_f32_16x16x32_bf16 v[228:231], v[32:35], a[104:107], v[228:231]
    v_mfma_f32_16x16x32_bf16 v[232:235], v[36:39], a[32:35], v[232:235]
    v_mfma_f32_16x16x32_bf16 v[236:239], v[36:39], a[104:107], v[236:239]
    ds_read_b128 v[32:35], v3 offset:12288
    ds_read_b128 v[36:39], v3 offset:30720
    s_waitcnt lgkmcnt(6)
    v_mfma_f32_16x16x32_bf16 v[208:211], v[40:43], v[100:103], v[208:211]
    v_mfma_f32_16x16x32_bf16 v[212:215], v[40:43], v[172:175], v[212:215]
    v_mfma_f32_16x16x32_bf16 v[216:219], v[44:47], v[100:103], v[216:219]
    v_mfma_f32_16x16x32_bf16 v[220:223], v[44:47], v[172:175], v[220:223]
    v_mfma_f32_16x16x32_bf16 v[224:227], v[40:43], a[36:39], v[224:227]
    v_mfma_f32_16x16x32_bf16 v[228:231], v[40:43], a[108:111], v[228:231]
    v_mfma_f32_16x16x32_bf16 v[232:235], v[44:47], a[36:39], v[232:235]
    v_mfma_f32_16x16x32_bf16 v[236:239], v[44:47], a[108:111], v[236:239]
    ds_read_b128 v[40:43], v3 offset:13312
    ds_read_b128 v[44:47], v3 offset:31744
    s_waitcnt lgkmcnt(6)
    v_mfma_f32_16x16x32_bf16 v[208:211], v[48:51], v[104:107], v[208:211]
    v_mfma_f32_16x16x32_bf16 v[212:215], v[48:51], v[176:179], v[212:215]
    v_mfma_f32_16x16x32_bf16 v[216:219], v[52:55], v[104:107], v[216:219]
    v_mfma_f32_16x16x32_bf16 v[220:223], v[52:55], v[176:179], v[220:223]
    v_mfma_f32_16x16x32_bf16 v[224:227], v[48:51], a[40:43], v[224:227]
    v_mfma_f32_16x16x32_bf16 v[228:231], v[48:51], a[112:115], v[228:231]
    v_mfma_f32_16x16x32_bf16 v[232:235], v[52:55], a[40:43], v[232:235]
    v_mfma_f32_16x16x32_bf16 v[236:239], v[52:55], a[112:115], v[236:239]
    ds_read_b128 v[48:51], v3 offset:14336
    ds_read_b128 v[52:55], v3 offset:32768
    s_waitcnt lgkmcnt(6)
    v_mfma_f32_16x16x32_bf16 v[208:211], v[56:59], v[108:111], v[208:211]
    v_mfma_f32_16x16x32_bf16 v[212:215], v[56:59], v[180:183], v[212:215]
    v_mfma_f32_16x16x32_bf16 v[216:219], v[60:63], v[108:111], v[216:219]
    v_mfma_f32_16x16x32_bf16 v[220:223], v[60:63], v[180:183], v[220:223]
    v_mfma_f32_16x16x32_bf16 v[224:227], v[56:59], a[44:47], v[224:227]
    v_mfma_f32_16x16x32_bf16 v[228:231], v[56:59], a[116:119], v[228:231]
    v_mfma_f32_16x16x32_bf16 v[232:235], v[60:63], a[44:47], v[232:235]
    v_mfma_f32_16x16x32_bf16 v[236:239], v[60:63], a[116:119], v[236:239]
    ds_read_b128 v[56:59], v3 offset:15360
    ds_read_b128 v[60:63], v3 offset:33792
    s_waitcnt lgkmcnt(6)
    v_mfma_f32_16x16x32_bf16 v[208:211], v[32:35], v[112:115], v[208:211]
    v_mfma_f32_16x16x32_bf16 v[212:215], v[32:35], v[184:187], v[212:215]
    v_mfma_f32_16x16x32_bf16 v[216:219], v[36:39], v[112:115], v[216:219]
    v_mfma_f32_16x16x32_bf16 v[220:223], v[36:39], v[184:187], v[220:223]
    v_mfma_f32_16x16x32_bf16 v[224:227], v[32:35], a[48:51], v[224:227]
    v_mfma_f32_16x16x32_bf16 v[228:231], v[32:35], a[120:123], v[228:231]
    v_mfma_f32_16x16x32_bf16 v[232:235], v[36:39], a[48:51], v[232:235]
    v_mfma_f32_16x16x32_bf16 v[236:239], v[36:39], a[120:123], v[236:239]
    ds_read_b128 v[32:35], v3 offset:16384
    ds_read_b128 v[36:39], v3 offset:34816
    s_waitcnt lgkmcnt(6)
    v_mfma_f32_16x16x32_bf16 v[208:211], v[40:43], v[116:119], v[208:211]
    v_mfma_f32_16x16x32_bf16 v[212:215], v[40:43], v[188:191], v[212:215]
    v_mfma_f32_16x16x32_bf16 v[216:219], v[44:47], v[116:119], v[216:219]
    v_mfma_f32_16x16x32_bf16 v[220:223], v[44:47], v[188:191], v[220:223]
    v_mfma_f32_16x16x32_bf16 v[224:227], v[40:43], a[52:55], v[224:227]
    v_mfma_f32_16x16x32_bf16 v[228:231], v[40:43], a[124:127], v[228:231]
    v_mfma_f32_16x16x32_bf16 v[232:235], v[44:47], a[52:55], v[232:235]
    v_mfma_f32_16x16x32_bf16 v[236:239], v[44:47], a[124:127], v[236:239]
    ds_read_b128 v[40:43], v3 offset:17408
    ds_read_b128 v[44:47], v3 offset:35840
    s_waitcnt lgkmcnt(6)
    v_mfma_f32_16x16x32_bf16 v[208:211], v[48:51], v[120:123], v[208:211]
    v_mfma_f32_16x16x32_bf16 v[212:215], v[48:51], v[192:195], v[212:215]
    v_mfma_f32_16x16x32_bf16 v[216:219], v[52:55], v[120:123], v[216:219]
    v_mfma_f32_16x16x32_bf16 v[220:223], v[52:55], v[192:195], v[220:223]
    v_mfma_f32_16x16x32_bf16 v[224:227], v[48:51], a[56:59], v[224:227]
    v_mfma_f32_16x16x32_bf16 v[228:231], v[48:51], a[128:131], v[228:231]
    v_mfma_f32_16x16x32_bf16 v[232:235], v[52:55], a[56:59], v[232:235]
    v_mfma_f32_16x16x32_bf16 v[236:239], v[52:55], a[128:131], v[236:239]
    s_waitcnt lgkmcnt(4)
    v_mfma_f32_16x16x32_bf16 v[208:211], v[56:59], v[124:127], v[208:211]
    v_mfma_f32_16x16x32_bf16 v[212:215], v[56:59], v[196:199], v[212:215]
    v_mfma_f32_16x16x32_bf16 v[216:219], v[60:63], v[124:127], v[216:219]
    v_mfma_f32_16x16x32_bf16 v[220:223], v[60:63], v[196:199], v[220:223]
    v_mfma_f32_16x16x32_bf16 v[224:227], v[56:59], a[60:63], v[224:227]
    v_mfma_f32_16x16x32_bf16 v[228:231], v[56:59], a[132:135], v[228:231]
    v_mfma_f32_16x16x32_bf16 v[232:235], v[60:63], a[60:63], v[232:235]
    v_mfma_f32_16x16x32_bf16 v[236:239], v[60:63], a[132:135], v[236:239]
    s_waitcnt lgkmcnt(2)
    v_mfma_f32_16x16x32_bf16 v[208:211], v[32:35], v[128:131], v[208:211]
    v_mfma_f32_16x16x32_bf16 v[212:215], v[32:35], v[200:203], v[212:215]
    v_mfma_f32_16x16x32_bf16 v[216:219], v[36:39], v[128:131], v[216:219]
    v_mfma_f32_16x16x32_bf16 v[220:223], v[36:39], v[200:203], v[220:223]
    v_mfma_f32_16x16x32_bf16 v[224:227], v[32:35], a[64:67], v[224:227]
    v_mfma_f32_16x16x32_bf16 v[228:231], v[32:35], a[136:139], v[228:231]
    v_mfma_f32_16x16x32_bf16 v[232:235], v[36:39], a[64:67], v[232:235]
    v_mfma_f32_16x16x32_bf16 v[236:239], v[36:39], a[136:139], v[236:239]
    s_waitcnt lgkmcnt(0)
    v_mfma_f32_16x16x32_bf16 v[208:211], v[40:43], v[132:135], v[208:211]
    v_mfma_f32_16x16x32_bf16 v[212:215], v[40:43], v[204:207], v[212:215]
    v_mfma_f32_16x16x32_bf16 v[216:219], v[44:47], v[132:135], v[216:219]
    v_mfma_f32_16x16x32_bf16 v[220:223], v[44:47], v[204:207], v[220:223]
    v_mfma_f32_16x16x32_bf16 v[224:227], v[40:43], a[68:71], v[224:227]
    v_mfma_f32_16x16x32_bf16 v[228:231], v[40:43], a[140:143], v[228:231]
    v_mfma_f32_16x16x32_bf16 v[232:235], v[44:47], a[68:71], v[232:235]
    v_mfma_f32_16x16x32_bf16 v[236:239], v[44:47], a[140:143], v[236:239]
    s_waitcnt vmcnt(0)
    v_cvt_pk_bf16_f32 v8, v208, v209
    v_cvt_pk_bf16_f32 v9, v210, v211
    v_cvt_pk_bf16_f32 v10, v216, v217
    v_cvt_pk_bf16_f32 v11, v218, v219
    s_lshr_b32 s22, s41, 5
    s_mul_i32 s22, s22, 0
    s_add_u32 s28, s26, s22
    buffer_store_dwordx4 v[8:11], v7, s[4:7], s28 offen sc1
    v_cvt_pk_bf16_f32 v12, v212, v213
    v_cvt_pk_bf16_f32 v13, v214, v215
    v_cvt_pk_bf16_f32 v14, v220, v221
    v_cvt_pk_bf16_f32 v15, v222, v223
    s_lshr_b32 s22, s41, 5
    s_mul_i32 s22, s22, 0
    s_add_u32 s28, s26, s22
    s_add_u32 s28, s28, s40
    buffer_store_dwordx4 v[12:15], v7, s[4:7], s28 offen sc1
    v_cvt_pk_bf16_f32 v16, v224, v225
    v_cvt_pk_bf16_f32 v17, v226, v227
    v_cvt_pk_bf16_f32 v18, v232, v233
    v_cvt_pk_bf16_f32 v19, v234, v235
    s_lshr_b32 s22, s41, 5
    s_mul_i32 s22, s22, 1
    s_add_u32 s28, s26, s22
    buffer_store_dwordx4 v[16:19], v7, s[4:7], s28 offen sc1
    v_cvt_pk_bf16_f32 v20, v228, v229
    v_cvt_pk_bf16_f32 v21, v230, v231
    v_cvt_pk_bf16_f32 v22, v236, v237
    v_cvt_pk_bf16_f32 v23, v238, v239
    s_lshr_b32 s22, s41, 5
    s_mul_i32 s22, s22, 1
    s_add_u32 s28, s26, s22
    s_add_u32 s28, s28, s40
    buffer_store_dwordx4 v[20:23], v7, s[4:7], s28 offen sc1
    s_lshl_b32 s22, s41, 2
    s_add_u32 s26, s26, s22
    s_lshr_b32 s45, s19, 2
    s_cbranch_scc1 qk_vloop_nf
    s_waitcnt vmcnt(0)
    s_mov_b32 s45, 1
qk_vloop_nf:
    s_add_u32 s27, s27, 36864
    s_cmp_eq_u32 s27, 110592
    s_cselect_b32 s27, 0, s27
    s_add_u32 s19, s19, 4
    s_cmp_lt_u32 s19, s20
    s_cbranch_scc1 qk_vloop
qk_done:
    s_waitcnt vmcnt(0)
    s_barrier
    s_mov_b32 s45, 16
    s_add_u32 s23, s45, s95
    v_mov_b32 v4, s23
    s_mov_b64 exec, s[34:35]
    buffer_store_dword v4, off, s[4:7], s29 sc1
    buffer_store_dword v4, off, s[4:7], s29 offset:128 sc1
    s_mov_b64 exec, -1
    s_cmp_eq_u32 s16, 0
    s_cbranch_scc1 L_qkv_next
    s_cmp_lg_u32 s19, 64
    s_cbranch_scc1 L_qkv_next
    v_and_b32 v4, 63, v0
    v_and_b32 v2, 7, v4
    v_lshrrev_b32 v5, 4, v4
    v_lshl_add_u32 v2, v5, 3, v2
    v_lshlrev_b32 v2, 4, v2
    v_bfe_u32 v3, v4, 3, 1
    v_mul_u32_u24 v5, 9216, v3
    v_add_u32 v2, v2, v5
    v_mov_b32 v240, 0x05040100
    v_mov_b32 v241, 0x07060302
    v_lshrrev_b32 v5, 5, v4
    v_and_b32 v1, 0xdff, v7
    s_cmp_eq_u32 s16, 2
    s_cbranch_scc1 mk_isv
    v_mov_b32 v5, v3
    v_or_b32 v1, 128, v7
mk_isv:
    v_lshl_add_u32 v1, v5, 17, v1
    s_mov_b32 s28, 0
    s_mov_b32 s19, 2
    s_mov_b32 s24, 138412032
    s_lshl_b32 s26, s17, 12
    s_mov_b32 s21, 69206016
    s_cmp_eq_u32 s16, 2
    s_cselect_b32 s21, 77594624, s21
    s_add_u32 s26, s26, s21
    s_lshl_b32 s29, s17, 7
    s_lshl_b32 s21, s16, 2
    s_add_u32 s29, s29, s21
    s_add_u32 s29, s29, 125829164
mk_loop:
    s_cmp_lg_u32 s18, 0
    s_cbranch_scc1 mk_go
    s_cmp_le_u32 s19, s28
    s_cbranch_scc1 mk_go
    s_mov_b32 s23, 125853696
    s_mov_b32 s21, 4194304
mk_wait:
    buffer_load_dword v4, off, s[4:7], s23 sc1
    s_sub_u32 s21, s21, 1
    s_cbranch_scc1 mk_go
    s_waitcnt vmcnt(0)
    v_readfirstlane_b32 s28, v4
    s_nop 0
    s_sub_u32 s28, s28, s95
    s_cmp_gt_u32 s28, 64
    s_cselect_b32 s28, 0, s28
    s_cmp_le_u32 s19, s28
    s_cbranch_scc1 mk_go
    s_sleep 4
    s_branch mk_wait
mk_go:
    s_barrier
    s_add_u32 s21, s24, 4096
    s_add_u32 s23, s24, 8192
    buffer_load_dwordx4 v[24:27], v2, s[4:7], s24 offen offset:0 sc1
    buffer_load_dwordx4 v[28:31], v2, s[4:7], s24 offen offset:512 sc1
    buffer_load_dwordx4 v[32:35], v2, s[4:7], s21 offen offset:0 sc1
    buffer_load_dwordx4 v[36:39], v2, s[4:7], s21 offen offset:512 sc1
    buffer_load_dwordx4 v[40:43], v2, s[4:7], s24 offen offset:1024 sc1
    buffer_load_dwordx4 v[44:47], v2, s[4:7], s24 offen offset:1536 sc1
    buffer_load_dwordx4 v[48:51], v2, s[4:7], s21 offen offset:1024 sc1
    buffer_load_dwordx4 v[52:55], v2, s[4:7], s21 offen offset:1536 sc1
    buffer_load_dwordx4 v[56:59], v2, s[4:7], s24 offen offset:2048 sc1
    buffer_load_dwordx4 v[60:63], v2, s[4:7], s24 offen offset:2560 sc1
    buffer_load_dwordx4 v[208:211], v2, s[4:7], s21 offen offset:2048 sc1
    buffer_load_dwordx4 v[212:215], v2, s[4:7], s21 offen offset:2560 sc1
    buffer_load_dwordx4 v[216:219], v2, s[4:7], s24 offen offset:3072 sc1
    buffer_load_dwordx4 v[220:223], v2, s[4:7], s24 offen offset:3584 sc1
    buffer_load_dwordx4 v[224:227], v2, s[4:7], s21 offen offset:3072 sc1
    buffer_load_dwordx4 v[228:231], v2, s[4:7], s21 offen offset:3584 sc1
    buffer_load_dwordx4 v[232:235], v2, s[4:7], s23 offen offset:0 sc1
    buffer_load_dwordx4 v[236:239], v2, s[4:7], s23 offen offset:512 sc1
    s_add_u32 s24, s24, 18432
    s_cmp_eq_u32 s16, 2
    s_cbranch_scc1 mk_v
    s_waitcnt vmcnt(17)
    v_perm_b32 v244, v25, v24, v240
    v_perm_b32 v245, v27, v26, v240
    v_perm_b32 v246, v25, v24, v241
    v_perm_b32 v247, v27, v26, v241
    s_waitcnt vmcnt(16)
    v_perm_b32 v248, v29, v28, v240
    v_perm_b32 v249, v31, v30, v240
    v_perm_b32 v250, v29, v28, v241
    v_perm_b32 v251, v31, v30, v241
    v_mfma_f32_16x16x32_bf16 v[8:11], v[64:67], v[244:247], 0
    v_mfma_f32_16x16x32_bf16 v[12:15], v[136:139], v[244:247], 0
    v_mfma_f32_16x16x32_bf16 v[16:19], a[0:3], v[244:247], 0
    v_mfma_f32_16x16x32_bf16 v[20:23], a[72:75], v[244:247], 0
    s_waitcnt vmcnt(15)
    v_perm_b32 v244, v33, v32, v240
    v_perm_b32 v245, v35, v34, v240
    v_perm_b32 v246, v33, v32, v241
    v_perm_b32 v247, v35, v34, v241
    v_mfma_f32_16x16x32_bf16 v[8:11], v[68:71], v[248:251], v[8:11]
    v_mfma_f32_16x16x32_bf16 v[12:15], v[140:143], v[248:251], v[12:15]
    v_mfma_f32_16x16x32_bf16 v[16:19], a[4:7], v[248:251], v[16:19]
    v_mfma_f32_16x16x32_bf16 v[20:23], a[76:79], v[248:251], v[20:23]
    s_waitcnt vmcnt(14)
    v_perm_b32 v248, v37, v36, v240
    v_perm_b32 v249, v39, v38, v240
    v_perm_b32 v250, v37, v36, v241
    v_perm_b32 v251, v39, v38, v241
    v_mfma_f32_16x16x32_bf16 v[8:11], v[72:75], v[244:247], v[8:11]
    v_mfma_f32_16x16x32_bf16 v[12:15], v[144:147], v[244:247], v[12:15]
    v_mfma_f32_16x16x32_bf16 v[16:19], a[8:11], v[244:247], v[16:19]
    v_mfma_f32_16x16x32_bf16 v[20:23], a[80:83], v[244:247], v[20:23]
    s_waitcnt vmcnt(13)
    v_perm_b32 v244, v41, v40, v240
    v_perm_b32 v245, v43, v42, v240
    v_perm_b32 v246, v41, v40, v241
    v_perm_b32 v247, v43, v42, v241
    v_mfma_f32_16x16x32_bf16 v[8:11], v[76:79], v[248:251], v[8:11]
    v_mfma_f32_16x16x32_bf16 v[12:15], v[148:151], v[248:251], v[12:15]
    v_mfma_f32_16x16x32_bf16 v[16:19], a[12:15], v[248:251], v[16:19]
    v_mfma_f32_16x16x32_bf16 v[20:23], a[84:87], v[248:251], v[20:23]
    s_waitcnt vmcnt(12)
    v_perm_b32 v248, v45, v44, v240
    v_perm_b32 v249, v47, v46, v240
    v_perm_b32 v250, v45, v44, v241
    v_perm_b32 v251, v47, v46, v241
    v_mfma_f32_16x16x32_bf16 v[8:11], v[80:83], v[244:247], v[8:11]
    v_mfma_f32_16x16x32_bf16 v[12:15], v[152:155], v[244:247], v[12:15]
    v_mfma_f32_16x16x32_bf16 v[16:19], a[16:19], v[244:247], v[16:19]
    v_mfma_f32_16x16x32_bf16 v[20:23], a[88:91], v[244:247], v[20:23]
    s_waitcnt vmcnt(11)
    v_perm_b32 v244, v49, v48, v240
    v_perm_b32 v245, v51, v50, v240
    v_perm_b32 v246, v49, v48, v241
    v_perm_b32 v247, v51, v50, v241
    v_mfma_f32_16x16x32_bf16 v[8:11], v[84:87], v[248:251], v[8:11]
    v_mfma_f32_16x16x32_bf16 v[12:15], v[156:159], v[248:251], v[12:15]
    v_mfma_f32_16x16x32_bf16 v[16:19], a[20:23], v[248:251], v[16:19]
    v_mfma_f32_16x16x32_bf16 v[20:23], a[92:95], v[248:251], v[20:23]
    s_waitcnt vmcnt(10)
    v_perm_b32 v248, v53, v52, v240
    v_perm_b32 v249, v55, v54, v240
    v_perm_b32 v250, v53, v52, v241
    v_perm_b32 v251, v55, v54, v241
    v_mfma_f32_16x16x32_bf16 v[8:11], v[88:91], v[244:247], v[8:11]
    v_mfma_f32_16x16x32_bf16 v[12:15], v[160:163], v[244:247], v[12:15]
    v_mfma_f32_16x16x32_bf16 v[16:19], a[24:27], v[244:247], v[16:19]
    v_mfma_f32_16x16x32_bf16 v[20:23], a[96:99], v[244:247], v[20:23]
    s_waitcnt vmcnt(9)
    v_perm_b32 v244, v57, v56, v240
    v_perm_b32 v245, v59, v58, v240
    v_perm_b32 v246, v57, v56, v241
    v_perm_b32 v247, v59, v58, v241
    v_mfma_f32_16x16x32_bf16 v[8:11], v[92:95], v[248:251], v[8:11]
    v_mfma_f32_16x16x32_bf16 v[12:15], v[164:167], v[248:251], v[12:15]
    v_mfma_f32_16x16x32_bf16 v[16:19], a[28:31], v[248:251], v[16:19]
    v_mfma_f32_16x16x32_bf16 v[20:23], a[100:103], v[248:251], v[20:23]
    s_waitcnt vmcnt(8)
    v_perm_b32 v248, v61, v60, v240
    v_perm_b32 v249, v63, v62, v240
    v_perm_b32 v250, v61, v60, v241
    v_perm_b32 v251, v63, v62, v241
    v_mfma_f32_16x16x32_bf16 v[8:11], v[96:99], v[244:247], v[8:11]
    v_mfma_f32_16x16x32_bf16 v[12:15], v[168:171], v[244:247], v[12:15]
    v_mfma_f32_16x16x32_bf16 v[16:19], a[32:35], v[244:247], v[16:19]
    v_mfma_f32_16x16x32_bf16 v[20:23], a[104:107], v[244:247], v[20:23]
    s_waitcnt vmcnt(7)
    v_perm_b32 v244, v209, v208, v240
    v_perm_b32 v245, v211, v210, v240
    v_perm_b32 v246, v209, v208, v241
    v_perm_b32 v247, v211, v210, v241
    v_mfma_f32_16x16x32_bf16 v[8:11], v[100:103], v[248:251], v[8:11]
    v_mfma_f32_16x16x32_bf16 v[12:15], v[172:175], v[248:251], v[12:15]
    v_mfma_f32_16x16x32_bf16 v[16:19], a[36:39], v[248:251], v[16:19]
    v_mfma_f32_16x16x32_bf16 v[20:23], a[108:111], v[248:251], v[20:23]
    s_waitcnt vmcnt(6)
    v_perm_b32 v248, v213, v212, v240
    v_perm_b32 v249, v215, v214, v240
    v_perm_b32 v250, v213, v212, v241
    v_perm_b32 v251, v215, v214, v241
    v_mfma_f32_16x16x32_bf16 v[8:11], v[104:107], v[244:247], v[8:11]
    v_mfma_f32_16x16x32_bf16 v[12:15], v[176:179], v[244:247], v[12:15]
    v_mfma_f32_16x16x32_bf16 v[16:19], a[40:43], v[244:247], v[16:19]
    v_mfma_f32_16x16x32_bf16 v[20:23], a[112:115], v[244:247], v[20:23]
    s_waitcnt vmcnt(5)
    v_perm_b32 v244, v217, v216, v240
    v_perm_b32 v245, v219, v218, v240
    v_perm_b32 v246, v217, v216, v241
    v_perm_b32 v247, v219, v218, v241
    v_mfma_f32_16x16x32_bf16 v[8:11], v[108:111], v[248:251], v[8:11]
    v_mfma_f32_16x16x32_bf16 v[12:15], v[180:183], v[248:251], v[12:15]
    v_mfma_f32_16x16x32_bf16 v[16:19], a[44:47], v[248:251], v[16:19]
    v_mfma_f32_16x16x32_bf16 v[20:23], a[116:119], v[248:251], v[20:23]
    s_waitcnt vmcnt(4)
    v_perm_b32 v248, v221, v220, v240
    v_perm_b32 v249, v223, v222, v240
    v_perm_b32 v250, v221, v220, v241
    v_perm_b32 v251, v223, v222, v241
    v_mfma_f32_16x16x32_bf16 v[8:11], v[112:115], v[244:247], v[8:11]
    v_mfma_f32_16x16x32_bf16 v[12:15], v[184:187], v[244:247], v[12:15]
    v_mfma_f32_16x16x32_bf16 v[16:19], a[48:51], v[244:247], v[16:19]
    v_mfma_f32_16x16x32_bf16 v[20:23], a[120:123], v[244:247], v[20:23]
    s_waitcnt vmcnt(3)
    v_perm_b32 v244, v225, v224, v240
    v_perm_b32 v245, v227, v226, v240
    v_perm_b32 v246, v225, v224, v241
    v_perm_b32 v247, v227, v226, v241
    v_mfma_f32_16x16x32_bf16 v[8:11], v[116:119], v[248:251], v[8:11]
    v_mfma_f32_16x16x32_bf16 v[12:15], v[188:191], v[248:251], v[12:15]
    v_mfma_f32_16x16x32_bf16 v[16:19], a[52:55], v[248:251], v[16:19]
    v_mfma_f32_16x16x32_bf16 v[20:23], a[124:127], v[248:251], v[20:23]
    s_waitcnt vmcnt(2)
    v_perm_b32 v248, v229, v228, v240
    v_perm_b32 v249, v231, v230, v240
    v_perm_b32 v250, v229, v228, v241
    v_perm_b32 v251, v231, v230, v241
    v_mfma_f32_16x16x32_bf16 v[8:11], v[120:123], v[244:247], v[8:11]
    v_mfma_f32_16x16x32_bf16 v[12:15], v[192:195], v[244:247], v[12:15]
    v_mfma_f32_16x16x32_bf16 v[16:19], a[56:59], v[244:247], v[16:19]
    v_mfma_f32_16x16x32_bf16 v[20:23], a[128:131], v[244:247], v[20:23]
    s_waitcnt vmcnt(1)
    v_mfma_f32_16x16x32_bf16 v[8:11], v[124:127], v[248:251], v[8:11]
    v_mfma_f32_16x16x32_bf16 v[12:15], v[196:199], v[248:251], v[12:15]
    v_mfma_f32_16x16x32_bf16 v[16:19], a[60:63], v[248:251], v[16:19]
    v_mfma_f32_16x16x32_bf16 v[20:23], a[132:135], v[248:251], v[20:23]
    s_waitcnt vmcnt(0)
    v_mfma_f32_16x16x32_bf16 v[8:11], v[128:131], v[232:235], v[8:11]
    v_mfma_f32_16x16x32_bf16 v[12:15], v[200:203], v[232:235], v[12:15]
    v_mfma_f32_16x16x32_bf16 v[16:19], a[64:67], v[232:235], v[16:19]
    v_mfma_f32_16x16x32_bf16 v[20:23], a[136:139], v[232:235], v[20:23]
    v_mfma_f32_16x16x32_bf16 v[8:11], v[132:135], v[236:239], v[8:11]
    v_mfma_f32_16x16x32_bf16 v[12:15], v[204:207], v[236:239], v[12:15]
    v_mfma_f32_16x16x32_bf16 v[16:19], a[68:71], v[236:239], v[16:19]
    v_mfma_f32_16x16x32_bf16 v[20:23], a[140:143], v[236:239], v[20:23]
    s_nop 7
    s_branch mk_st
mk_v:
    s_waitcnt vmcnt(17)
    v_perm_b32 v244, v25, v24, v240
    v_perm_b32 v245, v27, v26, v240
    v_perm_b32 v246, v25, v24, v241
    v_perm_b32 v247, v27, v26, v241
    s_waitcnt vmcnt(16)
    v_perm_b32 v248, v29, v28, v240
    v_perm_b32 v249, v31, v30, v240
    v_perm_b32 v250, v29, v28, v241
    v_perm_b32 v251, v31, v30, v241
    v_mfma_f32_16x16x32_bf16 v[8:11], v[244:247], v[64:67], 0
    v_mfma_f32_16x16x32_bf16 v[12:15], v[244:247], v[136:139], 0
    v_mfma_f32_16x16x32_bf16 v[16:19], v[244:247], a[0:3], 0
    v_mfma_f32_16x16x32_bf16 v[20:23], v[244:247], a[72:75], 0
    s_waitcnt vmcnt(15)
    v_perm_b32 v244, v33, v32, v240
    v_perm_b32 v245, v35, v34, v240
    v_perm_b32 v246, v33, v32, v241
    v_perm_b32 v247, v35, v34, v241
    v_mfma_f32_16x16x32_bf16 v[8:11], v[248:251], v[68:71], v[8:11]
    v_mfma_f32_16x16x32_bf16 v[12:15], v[248:251], v[140:143], v[12:15]
    v_mfma_f32_16x16x32_bf16 v[16:19], v[248:251], a[4:7], v[16:19]
    v_mfma_f32_16x16x32_bf16 v[20:23], v[248:251], a[76:79], v[20:23]
    s_waitcnt vmcnt(14)
    v_perm_b32 v248, v37, v36, v240
    v_perm_b32 v249, v39, v38, v240
    v_perm_b32 v250, v37, v36, v241
    v_perm_b32 v251, v39, v38, v241
    v_mfma_f32_16x16x32_bf16 v[8:11], v[244:247], v[72:75], v[8:11]
    v_mfma_f32_16x16x32_bf16 v[12:15], v[244:247], v[144:147], v[12:15]
    v_mfma_f32_16x16x32_bf16 v[16:19], v[244:247], a[8:11], v[16:19]
    v_mfma_f32_16x16x32_bf16 v[20:23], v[244:247], a[80:83], v[20:23]
    s_waitcnt vmcnt(13)
    v_perm_b32 v244, v41, v40, v240
    v_perm_b32 v245, v43, v42, v240
    v_perm_b32 v246, v41, v40, v241
    v_perm_b32 v247, v43, v42, v241
    v_mfma_f32_16x16x32_bf16 v[8:11], v[248:251], v[76:79], v[8:11]
    v_mfma_f32_16x16x32_bf16 v[12:15], v[248:251], v[148:151], v[12:15]
    v_mfma_f32_16x16x32_bf16 v[16:19], v[248:251], a[12:15], v[16:19]
    v_mfma_f32_16x16x32_bf16 v[20:23], v[248:251], a[84:87], v[20:23]
    s_waitcnt vmcnt(12)
    v_perm_b32 v248, v45, v44, v240
    v_perm_b32 v249, v47, v46, v240
    v_perm_b32 v250, v45, v44, v241
    v_perm_b32 v251, v47, v46, v241
    v_mfma_f32_16x16x32_bf16 v[8:11], v[244:247], v[80:83], v[8:11]
    v_mfma_f32_16x16x32_bf16 v[12:15], v[244:247], v[152:155], v[12:15]
    v_mfma_f32_16x16x32_bf16 v[16:19], v[244:247], a[16:19], v[16:19]
    v_mfma_f32_16x16x32_bf16 v[20:23], v[244:247], a[88:91], v[20:23]
    s_waitcnt vmcnt(11)
    v_perm_b32 v244, v49, v48, v240
    v_perm_b32 v245, v51, v50, v240
    v_perm_b32 v246, v49, v48, v241
    v_perm_b32 v247, v51, v50, v241
    v_mfma_f32_16x16x32_bf16 v[8:11], v[248:251], v[84:87], v[8:11]
    v_mfma_f32_16x16x32_bf16 v[12:15], v[248:251], v[156:159], v[12:15]
    v_mfma_f32_16x16x32_bf16 v[16:19], v[248:251], a[20:23], v[16:19]
    v_mfma_f32_16x16x32_bf16 v[20:23], v[248:251], a[92:95], v[20:23]
    s_waitcnt vmcnt(10)
    v_perm_b32 v248, v53, v52, v240
    v_perm_b32 v249, v55, v54, v240
    v_perm_b32 v250, v53, v52, v241
    v_perm_b32 v251, v55, v54, v241
    v_mfma_f32_16x16x32_bf16 v[8:11], v[244:247], v[88:91], v[8:11]
    v_mfma_f32_16x16x32_bf16 v[12:15], v[244:247], v[160:163], v[12:15]
    v_mfma_f32_16x16x32_bf16 v[16:19], v[244:247], a[24:27], v[16:19]
    v_mfma_f32_16x16x32_bf16 v[20:23], v[244:247], a[96:99], v[20:23]
    s_waitcnt vmcnt(9)
    v_perm_b32 v244, v57, v56, v240
    v_perm_b32 v245, v59, v58, v240
    v_perm_b32 v246, v57, v56, v241
    v_perm_b32 v247, v59, v58, v241
    v_mfma_f32_16x16x32_bf16 v[8:11], v[248:251], v[92:95], v[8:11]
    v_mfma_f32_16x16x32_bf16 v[12:15], v[248:251], v[164:167], v[12:15]
    v_mfma_f32_16x16x32_bf16 v[16:19], v[248:251], a[28:31], v[16:19]
    v_mfma_f32_16x16x32_bf16 v[20:23], v[248:251], a[100:103], v[20:23]
    s_waitcnt vmcnt(8)
    v_perm_b32 v248, v61, v60, v240
    v_perm_b32 v249, v63, v62, v240
    v_perm_b32 v250, v61, v60, v241
    v_perm_b32 v251, v63, v62, v241
    v_mfma_f32_16x16x32_bf16 v[8:11], v[244:247], v[96:99], v[8:11]
    v_mfma_f32_16x16x32_bf16 v[12:15], v[244:247], v[168:171], v[12:15]
    v_mfma_f32_16x16x32_bf16 v[16:19], v[244:247], a[32:35], v[16:19]
    v_mfma_f32_16x16x32_bf16 v[20:23], v[244:247], a[104:107], v[20:23]
    s_waitcnt vmcnt(7)
    v_perm_b32 v244, v209, v208, v240
    v_perm_b32 v245, v211, v210, v240
    v_perm_b32 v246, v209, v208, v241
    v_perm_b32 v247, v211, v210, v241
    v_mfma_f32_16x16x32_bf16 v[8:11], v[248:251], v[100:103], v[8:11]
    v_mfma_f32_16x16x32_bf16 v[12:15], v[248:251], v[172:175], v[12:15]
    v_mfma_f32_16x16x32_bf16 v[16:19], v[248:251], a[36:39], v[16:19]
    v_mfma_f32_16x16x32_bf16 v[20:23], v[248:251], a[108:111], v[20:23]
    s_waitcnt vmcnt(6)
    v_perm_b32 v248, v213, v212, v240
    v_perm_b32 v249, v215, v214, v240
    v_perm_b32 v250, v213, v212, v241
    v_perm_b32 v251, v215, v214, v241
    v_mfma_f32_16x16x32_bf16 v[8:11], v[244:247], v[104:107], v[8:11]
    v_mfma_f32_16x16x32_bf16 v[12:15], v[244:247], v[176:179], v[12:15]
    v_mfma_f32_16x16x32_bf16 v[16:19], v[244:247], a[40:43], v[16:19]
    v_mfma_f32_16x16x32_bf16 v[20:23], v[244:247], a[112:115], v[20:23]
    s_waitcnt vmcnt(5)
    v_perm_b32 v244, v217, v216, v240
    v_perm_b32 v245, v219, v218, v240
    v_perm_b32 v246, v217, v216, v241
    v_perm_b32 v247, v219, v218, v241
    v_mfma_f32_16x16x32_bf16 v[8:11], v[248:251], v[108:111], v[8:11]
    v_mfma_f32_16x16x32_bf16 v[12:15], v[248:251], v[180:183], v[12:15]
    v_mfma_f32_16x16x32_bf16 v[16:19], v[248:251], a[44:47], v[16:19]
    v_mfma_f32_16x16x32_bf16 v[20:23], v[248:251], a[116:119], v[20:23]
    s_waitcnt vmcnt(4)
    v_perm_b32 v248, v221, v220, v240
    v_perm_b32 v249, v223, v222, v240
    v_perm_b32 v250, v221, v220, v241
    v_perm_b32 v251, v223, v222, v241
    v_mfma_f32_16x16x32_bf16 v[8:11], v[244:247], v[112:115], v[8:11]
    v_mfma_f32_16x16x32_bf16 v[12:15], v[244:247], v[184:187], v[12:15]
    v_mfma_f32_16x16x32_bf16 v[16:19], v[244:247], a[48:51], v[16:19]
    v_mfma_f32_16x16x32_bf16 v[20:23], v[244:247], a[120:123], v[20:23]
    s_waitcnt vmcnt(3)
    v_perm_b32 v244, v225, v224, v240
    v_perm_b32 v245, v227, v226, v240
    v_perm_b32 v246, v225, v224, v241
    v_perm_b32 v247, v227, v226, v241
    v_mfma_f32_16x16x32_bf16 v[8:11], v[248:251], v[116:119], v[8:11]
    v_mfma_f32_16x16x32_bf16 v[12:15], v[248:251], v[188:191], v[12:15]
    v_mfma_f32_16x16x32_bf16 v[16:19], v[248:251], a[52:55], v[16:19]
    v_mfma_f32_16x16x32_bf16 v[20:23], v[248:251], a[124:127], v[20:23]
    s_waitcnt vmcnt(2)
    v_perm_b32 v248, v229, v228, v240
    v_perm_b32 v249, v231, v230, v240
    v_perm_b32 v250, v229, v228, v241
    v_perm_b32 v251, v231, v230, v241
    v_mfma_f32_16x16x32_bf16 v[8:11], v[244:247], v[120:123], v[8:11]
    v_mfma_f32_16x16x32_bf16 v[12:15], v[244:247], v[192:195], v[12:15]
    v_mfma_f32_16x16x32_bf16 v[16:19], v[244:247], a[56:59], v[16:19]
    v_mfma_f32_16x16x32_bf16 v[20:23], v[244:247], a[128:131], v[20:23]
    s_waitcnt vmcnt(1)
    v_mfma_f32_16x16x32_bf16 v[8:11], v[248:251], v[124:127], v[8:11]
    v_mfma_f32_16x16x32_bf16 v[12:15], v[248:251], v[196:199], v[12:15]
    v_mfma_f32_16x16x32_bf16 v[16:19], v[248:251], a[60:63], v[16:19]
    v_mfma_f32_16x16x32_bf16 v[20:23], v[248:251], a[132:135], v[20:23]
    s_waitcnt vmcnt(0)
    v_mfma_f32_16x16x32_bf16 v[8:11], v[232:235], v[128:131], v[8:11]
    v_mfma_f32_16x16x32_bf16 v[12:15], v[232:235], v[200:203], v[12:15]
    v_mfma_f32_16x16x32_bf16 v[16:19], v[232:235], a[64:67], v[16:19]
    v_mfma_f32_16x16x32_bf16 v[20:23], v[232:235], a[136:139], v[20:23]
    v_mfma_f32_16x16x32_bf16 v[8:11], v[236:239], v[132:135], v[8:11]
    v_mfma_f32_16x16x32_bf16 v[12:15], v[236:239], v[204:207], v[12:15]
    v_mfma_f32_16x16x32_bf16 v[16:19], v[236:239], a[68:71], v[16:19]
    v_mfma_f32_16x16x32_bf16 v[20:23], v[236:239], a[140:143], v[20:23]
    s_nop 4
    v_pk_mul_f32 v[8:9], v[8:9], 0.5 op_sel_hi:[1,0]
    v_pk_mul_f32 v[10:11], v[10:11], 0.5 op_sel_hi:[1,0]
    v_pk_mul_f32 v[12:13], v[12:13], 0.5 op_sel_hi:[1,0]
    v_pk_mul_f32 v[14:15], v[14:15], 0.5 op_sel_hi:[1,0]
    v_pk_mul_f32 v[16:17], v[16:17], 0.5 op_sel_hi:[1,0]
    v_pk_mul_f32 v[18:19], v[18:19], 0.5 op_sel_hi:[1,0]
    v_pk_mul_f32 v[20:21], v[20:21], 0.5 op_sel_hi:[1,0]
    v_pk_mul_f32 v[22:23], v[22:23], 0.5 op_sel_hi:[1,0]
mk_st:
    s_nop 1
    v_cvt_pk_bf16_f32 v24, v8, v9
    v_cvt_pk_bf16_f32 v25, v10, v11
    v_cvt_pk_bf16_f32 v26, v12, v13
    v_cvt_pk_bf16_f32 v27, v14, v15
    v_cvt_pk_bf16_f32 v28, v16, v17
    v_cvt_pk_bf16_f32 v29, v18, v19
    v_cvt_pk_bf16_f32 v30, v20, v21
    v_cvt_pk_bf16_f32 v31, v22, v23
    s_add_u32 s21, s26, 4096
    buffer_store_dwordx4 v[24:27], v1, s[4:7], s26 offen sc1
    buffer_store_dwordx4 v[28:31], v1, s[4:7], s21 offen sc1
    s_add_u32 s22, s19, s95
    s_waitcnt vmcnt(0)
    s_barrier
    v_mov_b32 v4, s22
    s_mov_b64 exec, s[34:35]
    buffer_store_dword v4, off, s[4:7], s29 sc1
    buffer_store_dword v4, off, s[4:7], s29 offset:128 sc1
    s_mov_b64 exec, -1
    s_add_u32 s19, s19, 2
    s_add_u32 s26, s26, 262144
    s_cmp_le_u32 s19, 58
    s_cbranch_scc1 mk_loop
    s_endpgm
L_ssm_next:
    s_mov_b32 s37, 8
    v_mov_b32 v250, 1
    v_mov_b32 v251, 163832
    v_cmp_eq_u32 vcc, 0, v0
    s_nop 0
    s_and_saveexec_b64 s[38:39], vcc
    s_cbranch_execz tk7
    buffer_atomic_add v250, off, s[84:87], s37 sc0
    s_waitcnt vmcnt(0)
    ds_write_b32 v251, v250
    s_waitcnt lgkmcnt(0)
tk7:
    s_mov_b64 exec, -1
    s_barrier
    ds_read_b32 v252, v251
    s_waitcnt lgkmcnt(0)
    v_readfirstlane_b32 s20, v252
    s_barrier
    s_nop 3
    s_cmp_ge_u32 s20, 144
    s_cbranch_scc1 L_wf_next
    s_lshl_b32 s20, s20, 2
    v_lshrrev_b32 v5, 6, v0
    s_nop 0
    v_readfirstlane_b32 s21, v5
    v_and_b32 v1, 63, v0
    v_and_b32 v2, 15, v1
    v_lshrrev_b32 v3, 4, v1
    v_lshlrev_b32 v4, 14, v5
    s_mov_b32 s8, s62
    s_mov_b32 s9, s63
    s_mov_b32 s10, 2359296
    s_mov_b32 s11, 0x20000
    s_mov_b32 s16, s76
    s_mov_b32 s17, s77
    s_mov_b32 s18, 4718592
    s_mov_b32 s19, 0x20000
    v_mul_u32_u24 v5, 9216, v0
    s_lshl_b32 s22, s20, 1
    s_add_u32 s23, s22, 0
    buffer_load_dwordx2 v[8:9], v5, s[8:11], s23 offen
    s_add_u32 s23, s22, 1152
    buffer_load_dwordx2 v[10:11], v5, s[8:11], s23 offen
    s_add_u32 s23, s22, 2304
    buffer_load_dwordx2 v[12:13], v5, s[8:11], s23 offen
    s_add_u32 s23, s22, 3456
    buffer_load_dwordx2 v[14:15], v5, s[8:11], s23 offen
    s_add_u32 s23, s22, 4608
    buffer_load_dwordx2 v[16:17], v5, s[8:11], s23 offen
    s_add_u32 s23, s22, 5760
    buffer_load_dwordx2 v[18:19], v5, s[8:11], s23 offen
    s_add_u32 s23, s22, 6912
    buffer_load_dwordx2 v[20:21], v5, s[8:11], s23 offen
    s_add_u32 s23, s22, 8064
    buffer_load_dwordx2 v[22:23], v5, s[8:11], s23 offen
    s_add_u32 s22, s20, s21
    s_lshl_b32 s23, s22, 8
    v_lshlrev_b32 v6, 3, v2
    v_lshl_add_u32 v6, v3, 1, v6
    s_mov_b32 s12, s64
    s_mov_b32 s13, s65
    s_mov_b32 s14, 147456
    s_mov_b32 s15, 0x20000
    buffer_load_ushort v24, v6, s[12:15], s23 offen offset:0
    buffer_load_ushort v28, v6, s[12:15], s23 offen offset:128
    s_mov_b32 s12, s66
    s_mov_b32 s13, s67
    s_mov_b32 s14, 147456
    s_mov_b32 s15, 0x20000
    buffer_load_ushort v25, v6, s[12:15], s23 offen offset:0
    buffer_load_ushort v29, v6, s[12:15], s23 offen offset:128
    s_mov_b32 s12, s68
    s_mov_b32 s13, s69
    s_mov_b32 s14, 147456
    s_mov_b32 s15, 0x20000
    buffer_load_ushort v26, v6, s[12:15], s23 offen offset:0
    buffer_load_ushort v30, v6, s[12:15], s23 offen offset:128
    s_mov_b32 s12, s70
    s_mov_b32 s13, s71
    s_mov_b32 s14, 147456
    s_mov_b32 s15, 0x20000
    buffer_load_ushort v27, v6, s[12:15], s23 offen offset:0
    buffer_load_ushort v31, v6, s[12:15], s23 offen offset:128
    s_mov_b32 s12, s72
    s_mov_b32 s13, s73
    s_mov_b32 s14, 1152
    s_mov_b32 s15, 0x20000
    s_lshl_b32 s23, s22, 1
    buffer_load_ushort v32, off, s[12:15], s23
    s_mov_b32 s26, 0x3fb8aa3b
    s_mov_b32 s27, 0x3e22f983
    v_mov_b32 v34, 0
    v_mov_b32 v35, 0
    v_lshl_add_u32 v6, v1, 3, v4
    ds_write_b64 v6, v[34:35] offset:0
    s_waitcnt vmcnt(0)
    v_mov_b32 v36, 0x05040100
    v_mov_b32 v37, 0x07060302
    v_lshlrev_b32 v6, 4, v0
    v_perm_b32 v40, v10, v8, v36
    v_perm_b32 v41, v14, v12, v36
    v_perm_b32 v42, v18, v16, v36
    v_perm_b32 v43, v22, v20, v36
    ds_write_b128 v6, v[40:43] offset:512
    s_nop 1
    v_perm_b32 v40, v10, v8, v37
    v_perm_b32 v41, v14, v12, v37
    v_perm_b32 v42, v18, v16, v37
    v_perm_b32 v43, v22, v20, v37
    ds_write_b128 v6, v[40:43] offset:16896
    s_nop 1
    v_perm_b32 v40, v11, v9, v36
    v_perm_b32 v41, v15, v13, v36
    v_perm_b32 v42, v19, v17, v36
    v_perm_b32 v43, v23, v21, v36
    ds_write_b128 v6, v[40:43] offset:33280
    s_nop 1
    v_perm_b32 v40, v11, v9, v37
    v_perm_b32 v41, v15, v13, v37
    v_perm_b32 v42, v19, v17, v37
    v_perm_b32 v43, v23, v21, v37
    ds_write_b128 v6, v[40:43] offset:49664
    s_nop 1
    v_lshlrev_b32 v32, 16, v32
    v_mul_f32 v32, s26, v32
    v_exp_f32 v32, v32
    s_nop 0
    v_cvt_pk_bf16_f32 v32, v32, v32
    v_and_b32 v32, 0xffff0000, v32
    v_add_f32 v33, v32, v32
    v_lshlrev_b32 v24, 16, v24
    v_mul_f32 v24, s26, v24
    v_exp_f32 v24, v24
    s_nop 0
    v_cvt_pk_bf16_f32 v24, v24, v24
    v_and_b32 v24, 0xffff0000, v24
    v_mul_f32 v24, v24, v32
    v_mul_f32 v24, s26, v24
    v_sub_f32 v24, 0, v24
    v_lshlrev_b32 v25, 16, v25
    v_mul_f32 v25, v25, v32
    v_mul_f32 v25, s27, v25
    v_lshlrev_b32 v26, 16, v26
    v_mul_f32 v26, v26, v33
    v_lshlrev_b32 v27, 16, v27
    v_mul_f32 v27, v27, v33
    v_lshlrev_b32 v28, 16, v28
    v_mul_f32 v28, s26, v28
    v_exp_f32 v28, v28
    s_nop 0
    v_cvt_pk_bf16_f32 v28, v28, v28
    v_and_b32 v28, 0xffff0000, v28
    v_mul_f32 v28, v28, v32
    v_mul_f32 v28, s26, v28
    v_sub_f32 v28, 0, v28
    v_lshlrev_b32 v29, 16, v29
    v_mul_f32 v29, v29, v32
    v_mul_f32 v29, s27, v29
    v_lshlrev_b32 v30, 16, v30
    v_mul_f32 v30, v30, v33
    v_lshlrev_b32 v31, 16, v31
    v_mul_f32 v31, v31, v33
    v_cvt_f32_u32 v47, v2
    v_mul_f32 v44, 0x41800000, v47
    v_and_b32 v5, 7, v2
    v_add_u32 v5, 8, v5
    v_cvt_f32_u32 v5, v5
    v_mul_f32 v45, 0x42000000, v5
    v_mul_f32 v6, 0x42800000, v5
    v_cmp_lt_u32 vcc, 7, v2
    s_nop 1
    v_cndmask_b32 v45, v45, v6, vcc
    v_add_f32 v5, 0x41000000, v47
    v_mul_f32 v46, 0x43000000, v5
    v_mov_b32 v48, 0
    v_mov_b32 v49, 0
    v_mov_b32 v50, 0
    v_mov_b32 v51, 0
    v_mov_b32 v52, 0
    v_mov_b32 v53, 0
    v_mov_b32 v54, 0
    v_mov_b32 v55, 0
    v_mov_b32 v56, 0
    v_mov_b32 v57, 0
    v_mov_b32 v58, 0
    v_mov_b32 v59, 0
    v_mov_b32 v60, 0
    v_mov_b32 v61, 0
    v_mov_b32 v62, 0
    v_mov_b32 v63, 0
    v_mov_b32_dpp v64, v24 row_newbcast:0 row_mask:0xf bank_mask:0xf
    v_mov_b32_dpp v65, v25 row_newbcast:0 row_mask:0xf bank_mask:0xf
    v_mov_b32_dpp v66, v26 row_newbcast:0 row_mask:0xf bank_mask:0xf
    v_mov_b32_dpp v67, v27 row_newbcast:0 row_mask:0xf bank_mask:0xf
    v_mul_f32 v82, v64, v47
    v_mul_f32 v83, v65, v47
    v_exp_f32 v82, v82
    v_fract_f32 v83, v83
    v_cos_f32 v74, v83
    v_sin_f32 v75, v83
    v_mul_f32 v74, v74, v82
    v_mul_f32 v75, v75, v82
    v_mul_f32 v84, v75, v75
    v_add_f32 v85, v74, v74
    v_fma_f32 v76, v74, v74, -v84
    v_mul_f32 v77, v85, v75
    v_mul_f32 v84, v77, v77
    v_add_f32 v85, v76, v76
    v_fma_f32 v78, v76, v76, -v84
    v_mul_f32 v79, v85, v77
    v_mul_f32 v84, v79, v79
    v_add_f32 v85, v78, v78
    v_fma_f32 v80, v78, v78, -v84
    v_mul_f32 v81, v85, v79
    v_mul_f32 v82, v64, v44
    v_mul_f32 v83, v65, v44
    v_exp_f32 v82, v82
    v_fract_f32 v83, v83
    v_cos_f32 v68, v83
    v_sin_f32 v69, v83
    v_mul_f32 v68, v68, v82
    v_mul_f32 v69, v69, v82
    v_mul_f32 v84, v67, v69
    v_mul_f32 v85, v67, v68
    v_fma_f32 v68, v66, v68, -v84
    v_fma_f32 v69, -v66, v69, -v85
    v_mul_f32 v82, v64, v45
    v_mul_f32 v83, v65, v45
    v_exp_f32 v82, v82
    v_fract_f32 v83, v83
    v_cos_f32 v70, v83
    v_sin_f32 v71, v83
    v_mul_f32 v70, v70, v82
    v_mul_f32 v71, v71, v82
    v_mul_f32 v84, v67, v71
    v_mul_f32 v85, v67, v70
    v_fma_f32 v70, v66, v70, -v84
    v_fma_f32 v71, -v66, v71, -v85
    v_mul_f32 v82, v64, v46
    v_mul_f32 v83, v65, v46
    v_exp_f32 v82, v82
    v_fract_f32 v83, v83
    v_cos_f32 v72, v83
    v_sin_f32 v73, v83
    v_mul_f32 v72, v72, v82
    v_mul_f32 v73, v73, v82
    v_mul_f32 v84, v67, v73
    v_mul_f32 v85, v67, v72
    v_fma_f32 v72, v66, v72, -v84
    v_fma_f32 v73, -v66, v73, -v85
    v_mfma_f32_16x16x4_f32 v[48:51], v68, v74, v[48:51]
    v_mfma_f32_16x16x4_f32 v[52:55], v70, v76, v[52:55]
    v_mfma_f32_16x16x4_f32 v[56:59], v70, v78, v[56:59]
    v_mfma_f32_16x16x4_f32 v[60:63], v72, v80, v[60:63]
    v_mfma_f32_16x16x4_f32 v[48:51], v69, v75, v[48:51]
    v_mfma_f32_16x16x4_f32 v[52:55], v71, v77, v[52:55]
    v_mfma_f32_16x16x4_f32 v[56:59], v71, v79, v[56:59]
    v_mfma_f32_16x16x4_f32 v[60:63], v73, v81, v[60:63]
    v_mov_b32_dpp v64, v24 row_newbcast:1 row_mask:0xf bank_mask:0xf
    v_mov_b32_dpp v65, v25 row_newbcast:1 row_mask:0xf bank_mask:0xf
    v_mov_b32_dpp v66, v26 row_newbcast:1 row_mask:0xf bank_mask:0xf
    v_mov_b32_dpp v67, v27 row_newbcast:1 row_mask:0xf bank_mask:0xf
    v_mul_f32 v82, v64, v47
    v_mul_f32 v83, v65, v47
    v_exp_f32 v82, v82
    v_fract_f32 v83, v83
    v_cos_f32 v74, v83
    v_sin_f32 v75, v83
    v_mul_f32 v74, v74, v82
    v_mul_f32 v75, v75, v82
    v_mul_f32 v84, v75, v75
    v_add_f32 v85, v74, v74
    v_fma_f32 v76, v74, v74, -v84
    v_mul_f32 v77, v85, v75
    v_mul_f32 v84, v77, v77
    v_add_f32 v85, v76, v76
    v_fma_f32 v78, v76, v76, -v84
    v_mul_f32 v79, v85, v77
    v_mul_f32 v84, v79, v79
    v_add_f32 v85, v78, v78
    v_fma_f32 v80, v78, v78, -v84
    v_mul_f32 v81, v85, v79
    v_mul_f32 v82, v64, v44
    v_mul_f32 v83, v65, v44
    v_exp_f32 v82, v82
    v_fract_f32 v83, v83
    v_cos_f32 v68, v83
    v_sin_f32 v69, v83
    v_mul_f32 v68, v68, v82
    v_mul_f32 v69, v69, v82
    v_mul_f32 v84, v67, v69
    v_mul_f32 v85, v67, v68
    v_fma_f32 v68, v66, v68, -v84
    v_fma_f32 v69, -v66, v69, -v85
    v_mul_f32 v82, v64, v45
    v_mul_f32 v83, v65, v45
    v_exp_f32 v82, v82
    v_fract_f32 v83, v83
    v_cos_f32 v70, v83
    v_sin_f32 v71, v83
    v_mul_f32 v70, v70, v82
    v_mul_f32 v71, v71, v82
    v_mul_f32 v84, v67, v71
    v_mul_f32 v85, v67, v70
    v_fma_f32 v70, v66, v70, -v84
    v_fma_f32 v71, -v66, v71, -v85
    v_mul_f32 v82, v64, v46
    v_mul_f32 v83, v65, v46
    v_exp_f32 v82, v82
    v_fract_f32 v83, v83
    v_cos_f32 v72, v83
    v_sin_f32 v73, v83
    v_mul_f32 v72, v72, v82
    v_mul_f32 v73, v73, v82
    v_mul_f32 v84, v67, v73
    v_mul_f32 v85, v67, v72
    v_fma_f32 v72, v66, v72, -v84
    v_fma_f32 v73, -v66, v73, -v85
    v_mfma_f32_16x16x4_f32 v[48:51], v68, v74, v[48:51]
    v_mfma_f32_16x16x4_f32 v[52:55], v70, v76, v[52:55]
    v_mfma_f32_16x16x4_f32 v[56:59], v70, v78, v[56:59]
    v_mfma_f32_16x16x4_f32 v[60:63], v72, v80, v[60:63]
    v_mfma_f32_16x16x4_f32 v[48:51], v69, v75, v[48:51]
    v_mfma_f32_16x16x4_f32 v[52:55], v71, v77, v[52:55]
    v_mfma_f32_16x16x4_f32 v[56:59], v71, v79, v[56:59]
    v_mfma_f32_16x16x4_f32 v[60:63], v73, v81, v[60:63]
    v_mov_b32_dpp v64, v24 row_newbcast:2 row_mask:0xf bank_mask:0xf
    v_mov_b32_dpp v65, v25 row_newbcast:2 row_mask:0xf bank_mask:0xf
    v_mov_b32_dpp v66, v26 row_newbcast:2 row_mask:0xf bank_mask:0xf
    v_mov_b32_dpp v67, v27 row_newbcast:2 row_mask:0xf bank_mask:0xf
    v_mul_f32 v82, v64, v47
    v_mul_f32 v83, v65, v47
    v_exp_f32 v82, v82
    v_fract_f32 v83, v83
    v_cos_f32 v74, v83
    v_sin_f32 v75, v83
    v_mul_f32 v74, v74, v82
    v_mul_f32 v75, v75, v82
    v_mul_f32 v84, v75, v75
    v_add_f32 v85, v74, v74
    v_fma_f32 v76, v74, v74, -v84
    v_mul_f32 v77, v85, v75
    v_mul_f32 v84, v77, v77
    v_add_f32 v85, v76, v76
    v_fma_f32 v78, v76, v76, -v84
    v_mul_f32 v79, v85, v77
    v_mul_f32 v84, v79, v79
    v_add_f32 v85, v78, v78
    v_fma_f32 v80, v78, v78, -v84
    v_mul_f32 v81, v85, v79
    v_mul_f32 v82, v64, v44
    v_mul_f32 v83, v65, v44
    v_exp_f32 v82, v82
    v_fract_f32 v83, v83
    v_cos_f32 v68, v83
    v_sin_f32 v69, v83
    v_mul_f32 v68, v68, v82
    v_mul_f32 v69, v69, v82
    v_mul_f32 v84, v67, v69
    v_mul_f32 v85, v67, v68
    v_fma_f32 v68, v66, v68, -v84
    v_fma_f32 v69, -v66, v69, -v85
    v_mul_f32 v82, v64, v45
    v_mul_f32 v83, v65, v45
    v_exp_f32 v82, v82
    v_fract_f32 v83, v83
    v_cos_f32 v70, v83
    v_sin_f32 v71, v83
    v_mul_f32 v70, v70, v82
    v_mul_f32 v71, v71, v82
    v_mul_f32 v84, v67, v71
    v_mul_f32 v85, v67, v70
    v_fma_f32 v70, v66, v70, -v84
    v_fma_f32 v71, -v66, v71, -v85
    v_mul_f32 v82, v64, v46
    v_mul_f32 v83, v65, v46
    v_exp_f32 v82, v82
    v_fract_f32 v83, v83
    v_cos_f32 v72, v83
    v_sin_f32 v73, v83
    v_mul_f32 v72, v72, v82
    v_mul_f32 v73, v73, v82
    v_mul_f32 v84, v67, v73
    v_mul_f32 v85, v67, v72
    v_fma_f32 v72, v66, v72, -v84
    v_fma_f32 v73, -v66, v73, -v85
    v_mfma_f32_16x16x4_f32 v[48:51], v68, v74, v[48:51]
    v_mfma_f32_16x16x4_f32 v[52:55], v70, v76, v[52:55]
    v_mfma_f32_16x16x4_f32 v[56:59], v70, v78, v[56:59]
    v_mfma_f32_16x16x4_f32 v[60:63], v72, v80, v[60:63]
    v_mfma_f32_16x16x4_f32 v[48:51], v69, v75, v[48:51]
    v_mfma_f32_16x16x4_f32 v[52:55], v71, v77, v[52:55]
    v_mfma_f32_16x16x4_f32 v[56:59], v71, v79, v[56:59]
    v_mfma_f32_16x16x4_f32 v[60:63], v73, v81, v[60:63]
    v_mov_b32_dpp v64, v24 row_newbcast:3 row_mask:0xf bank_mask:0xf
    v_mov_b32_dpp v65, v25 row_newbcast:3 row_mask:0xf bank_mask:0xf
    v_mov_b32_dpp v66, v26 row_newbcast:3 row_mask:0xf bank_mask:0xf
    v_mov_b32_dpp v67, v27 row_newbcast:3 row_mask:0xf bank_mask:0xf
    v_mul_f32 v82, v64, v47
    v_mul_f32 v83, v65, v47
    v_exp_f32 v82, v82
    v_fract_f32 v83, v83
    v_cos_f32 v74, v83
    v_sin_f32 v75, v83
    v_mul_f32 v74, v74, v82
    v_mul_f32 v75, v75, v82
    v_mul_f32 v84, v75, v75
    v_add_f32 v85, v74, v74
    v_fma_f32 v76, v74, v74, -v84
    v_mul_f32 v77, v85, v75
    v_mul_f32 v84, v77, v77
    v_add_f32 v85, v76, v76
    v_fma_f32 v78, v76, v76, -v84
    v_mul_f32 v79, v85, v77
    v_mul_f32 v84, v79, v79
    v_add_f32 v85, v78, v78
    v_fma_f32 v80, v78, v78, -v84
    v_mul_f32 v81, v85, v79
    v_mul_f32 v82, v64, v44
    v_mul_f32 v83, v65, v44
    v_exp_f32 v82, v82
    v_fract_f32 v83, v83
    v_cos_f32 v68, v83
    v_sin_f32 v69, v83
    v_mul_f32 v68, v68, v82
    v_mul_f32 v69, v69, v82
    v_mul_f32 v84, v67, v69
    v_mul_f32 v85, v67, v68
    v_fma_f32 v68, v66, v68, -v84
    v_fma_f32 v69, -v66, v69, -v85
    v_mul_f32 v82, v64, v45
    v_mul_f32 v83, v65, v45
    v_exp_f32 v82, v82
    v_fract_f32 v83, v83
    v_cos_f32 v70, v83
    v_sin_f32 v71, v83
    v_mul_f32 v70, v70, v82
    v_mul_f32 v71, v71, v82
    v_mul_f32 v84, v67, v71
    v_mul_f32 v85, v67, v70
    v_fma_f32 v70, v66, v70, -v84
    v_fma_f32 v71, -v66, v71, -v85
    v_mul_f32 v82, v64, v46
    v_mul_f32 v83, v65, v46
    v_exp_f32 v82, v82
    v_fract_f32 v83, v83
    v_cos_f32 v72, v83
    v_sin_f32 v73, v83
    v_mul_f32 v72, v72, v82
    v_mul_f32 v73, v73, v82
    v_mul_f32 v84, v67, v73
    v_mul_f32 v85, v67, v72
    v_fma_f32 v72, v66, v72, -v84
    v_fma_f32 v73, -v66, v73, -v85
    v_mfma_f32_16x16x4_f32 v[48:51], v68, v74, v[48:51]
    v_mfma_f32_16x16x4_f32 v[52:55], v70, v76, v[52:55]
    v_mfma_f32_16x16x4_f32 v[56:59], v70, v78, v[56:59]
    v_mfma_f32_16x16x4_f32 v[60:63], v72, v80, v[60:63]
    v_mfma_f32_16x16x4_f32 v[48:51], v69, v75, v[48:51]
    v_mfma_f32_16x16x4_f32 v[52:55], v71, v77, v[52:55]
    v_mfma_f32_16x16x4_f32 v[56:59], v71, v79, v[56:59]
    v_mfma_f32_16x16x4_f32 v[60:63], v73, v81, v[60:63]
    v_mov_b32_dpp v64, v24 row_newbcast:4 row_mask:0xf bank_mask:0xf
    v_mov_b32_dpp v65, v25 row_newbcast:4 row_mask:0xf bank_mask:0xf
    v_mov_b32_dpp v66, v26 row_newbcast:4 row_mask:0xf bank_mask:0xf
    v_mov_b32_dpp v67, v27 row_newbcast:4 row_mask:0xf bank_mask:0xf
    v_mul_f32 v82, v64, v47
    v_mul_f32 v83, v65, v47
    v_exp_f32 v82, v82
    v_fract_f32 v83, v83
    v_cos_f32 v74, v83
    v_sin_f32 v75, v83
    v_mul_f32 v74, v74, v82
    v_mul_f32 v75, v75, v82
    v_mul_f32 v84, v75, v75
    v_add_f32 v85, v74, v74
    v_fma_f32 v76, v74, v74, -v84
    v_mul_f32 v77, v85, v75
    v_mul_f32 v84, v77, v77
    v_add_f32 v85, v76, v76
    v_fma_f32 v78, v76, v76, -v84
    v_mul_f32 v79, v85, v77
    v_mul_f32 v84, v79, v79
    v_add_f32 v85, v78, v78
    v_fma_f32 v80, v78, v78, -v84
    v_mul_f32 v81, v85, v79
    v_mul_f32 v82, v64, v44
    v_mul_f32 v83, v65, v44
    v_exp_f32 v82, v82
    v_fract_f32 v83, v83
    v_cos_f32 v68, v83
    v_sin_f32 v69, v83
    v_mul_f32 v68, v68, v82
    v_mul_f32 v69, v69, v82
    v_mul_f32 v84, v67, v69
    v_mul_f32 v85, v67, v68
    v_fma_f32 v68, v66, v68, -v84
    v_fma_f32 v69, -v66, v69, -v85
    v_mul_f32 v82, v64, v45
    v_mul_f32 v83, v65, v45
    v_exp_f32 v82, v82
    v_fract_f32 v83, v83
    v_cos_f32 v70, v83
    v_sin_f32 v71, v83
    v_mul_f32 v70, v70, v82
    v_mul_f32 v71, v71, v82
    v_mul_f32 v84, v67, v71
    v_mul_f32 v85, v67, v70
    v_fma_f32 v70, v66, v70, -v84
    v_fma_f32 v71, -v66, v71, -v85
    v_mul_f32 v82, v64, v46
    v_mul_f32 v83, v65, v46
    v_exp_f32 v82, v82
    v_fract_f32 v83, v83
    v_cos_f32 v72, v83
    v_sin_f32 v73, v83
    v_mul_f32 v72, v72, v82
    v_mul_f32 v73, v73, v82
    v_mul_f32 v84, v67, v73
    v_mul_f32 v85, v67, v72
    v_fma_f32 v72, v66, v72, -v84
    v_fma_f32 v73, -v66, v73, -v85
    v_mfma_f32_16x16x4_f32 v[48:51], v68, v74, v[48:51]
    v_mfma_f32_16x16x4_f32 v[52:55], v70, v76, v[52:55]
    v_mfma_f32_16x16x4_f32 v[56:59], v70, v78, v[56:59]
    v_mfma_f32_16x16x4_f32 v[60:63], v72, v80, v[60:63]
    v_mfma_f32_16x16x4_f32 v[48:51], v69, v75, v[48:51]
    v_mfma_f32_16x16x4_f32 v[52:55], v71, v77, v[52:55]
    v_mfma_f32_16x16x4_f32 v[56:59], v71, v79, v[56:59]
    v_mfma_f32_16x16x4_f32 v[60:63], v73, v81, v[60:63]
    v_mov_b32_dpp v64, v24 row_newbcast:5 row_mask:0xf bank_mask:0xf
    v_mov_b32_dpp v65, v25 row_newbcast:5 row_mask:0xf bank_mask:0xf
    v_mov_b32_dpp v66, v26 row_newbcast:5 row_mask:0xf bank_mask:0xf
    v_mov_b32_dpp v67, v27 row_newbcast:5 row_mask:0xf bank_mask:0xf
    v_mul_f32 v82, v64, v47
    v_mul_f32 v83, v65, v47
    v_exp_f32 v82, v82
    v_fract_f32 v83, v83
    v_cos_f32 v74, v83
    v_sin_f32 v75, v83
    v_mul_f32 v74, v74, v82
    v_mul_f32 v75, v75, v82
    v_mul_f32 v84, v75, v75
    v_add_f32 v85, v74, v74
    v_fma_f32 v76, v74, v74, -v84
    v_mul_f32 v77, v85, v75
    v_mul_f32 v84, v77, v77
    v_add_f32 v85, v76, v76
    v_fma_f32 v78, v76, v76, -v84
    v_mul_f32 v79, v85, v77
    v_mul_f32 v84, v79, v79
    v_add_f32 v85, v78, v78
    v_fma_f32 v80, v78, v78, -v84
    v_mul_f32 v81, v85, v79
    v_mul_f32 v82, v64, v44
    v_mul_f32 v83, v65, v44
    v_exp_f32 v82, v82
    v_fract_f32 v83, v83
    v_cos_f32 v68, v83
    v_sin_f32 v69, v83
    v_mul_f32 v68, v68, v82
    v_mul_f32 v69, v69, v82
    v_mul_f32 v84, v67, v69
    v_mul_f32 v85, v67, v68
    v_fma_f32 v68, v66, v68, -v84
    v_fma_f32 v69, -v66, v69, -v85
    v_mul_f32 v82, v64, v45
    v_mul_f32 v83, v65, v45
    v_exp_f32 v82, v82
    v_fract_f32 v83, v83
    v_cos_f32 v70, v83
    v_sin_f32 v71, v83
    v_mul_f32 v70, v70, v82
    v_mul_f32 v71, v71, v82
    v_mul_f32 v84, v67, v71
    v_mul_f32 v85, v67, v70
    v_fma_f32 v70, v66, v70, -v84
    v_fma_f32 v71, -v66, v71, -v85
    v_mul_f32 v82, v64, v46
    v_mul_f32 v83, v65, v46
    v_exp_f32 v82, v82
    v_fract_f32 v83, v83
    v_cos_f32 v72, v83
    v_sin_f32 v73, v83
    v_mul_f32 v72, v72, v82
    v_mul_f32 v73, v73, v82
    v_mul_f32 v84, v67, v73
    v_mul_f32 v85, v67, v72
    v_fma_f32 v72, v66, v72, -v84
    v_fma_f32 v73, -v66, v73, -v85
    v_mfma_f32_16x16x4_f32 v[48:51], v68, v74, v[48:51]
    v_mfma_f32_16x16x4_f32 v[52:55], v70, v76, v[52:55]
    v_mfma_f32_16x16x4_f32 v[56:59], v70, v78, v[56:59]
    v_mfma_f32_16x16x4_f32 v[60:63], v72, v80, v[60:63]
    v_mfma_f32_16x16x4_f32 v[48:51], v69, v75, v[48:51]
    v_mfma_f32_16x16x4_f32 v[52:55], v71, v77, v[52:55]
    v_mfma_f32_16x16x4_f32 v[56:59], v71, v79, v[56:59]
    v_mfma_f32_16x16x4_f32 v[60:63], v73, v81, v[60:63]
    v_mov_b32_dpp v64, v24 row_newbcast:6 row_mask:0xf bank_mask:0xf
    v_mov_b32_dpp v65, v25 row_newbcast:6 row_mask:0xf bank_mask:0xf
    v_mov_b32_dpp v66, v26 row_newbcast:6 row_mask:0xf bank_mask:0xf
    v_mov_b32_dpp v67, v27 row_newbcast:6 row_mask:0xf bank_mask:0xf
    v_mul_f32 v82, v64, v47
    v_mul_f32 v83, v65, v47
    v_exp_f32 v82, v82
    v_fract_f32 v83, v83
    v_cos_f32 v74, v83
    v_sin_f32 v75, v83
    v_mul_f32 v74, v74, v82
    v_mul_f32 v75, v75, v82
    v_mul_f32 v84, v75, v75
    v_add_f32 v85, v74, v74
    v_fma_f32 v76, v74, v74, -v84
    v_mul_f32 v77, v85, v75
    v_mul_f32 v84, v77, v77
    v_add_f32 v85, v76, v76
    v_fma_f32 v78, v76, v76, -v84
    v_mul_f32 v79, v85, v77
    v_mul_f32 v84, v79, v79
    v_add_f32 v85, v78, v78
    v_fma_f32 v80, v78, v78, -v84
    v_mul_f32 v81, v85, v79
    v_mul_f32 v82, v64, v44
    v_mul_f32 v83, v65, v44
    v_exp_f32 v82, v82
    v_fract_f32 v83, v83
    v_cos_f32 v68, v83
    v_sin_f32 v69, v83
    v_mul_f32 v68, v68, v82
    v_mul_f32 v69, v69, v82
    v_mul_f32 v84, v67, v69
    v_mul_f32 v85, v67, v68
    v_fma_f32 v68, v66, v68, -v84
    v_fma_f32 v69, -v66, v69, -v85
    v_mul_f32 v82, v64, v45
    v_mul_f32 v83, v65, v45
    v_exp_f32 v82, v82
    v_fract_f32 v83, v83
    v_cos_f32 v70, v83
    v_sin_f32 v71, v83
    v_mul_f32 v70, v70, v82
    v_mul_f32 v71, v71, v82
    v_mul_f32 v84, v67, v71
    v_mul_f32 v85, v67, v70
    v_fma_f32 v70, v66, v70, -v84
    v_fma_f32 v71, -v66, v71, -v85
    v_mul_f32 v82, v64, v46
    v_mul_f32 v83, v65, v46
    v_exp_f32 v82, v82
    v_fract_f32 v83, v83
    v_cos_f32 v72, v83
    v_sin_f32 v73, v83
    v_mul_f32 v72, v72, v82
    v_mul_f32 v73, v73, v82
    v_mul_f32 v84, v67, v73
    v_mul_f32 v85, v67, v72
    v_fma_f32 v72, v66, v72, -v84
    v_fma_f32 v73, -v66, v73, -v85
    v_mfma_f32_16x16x4_f32 v[48:51], v68, v74, v[48:51]
    v_mfma_f32_16x16x4_f32 v[52:55], v70, v76, v[52:55]
    v_mfma_f32_16x16x4_f32 v[56:59], v70, v78, v[56:59]
    v_mfma_f32_16x16x4_f32 v[60:63], v72, v80, v[60:63]
    v_mfma_f32_16x16x4_f32 v[48:51], v69, v75, v[48:51]
    v_mfma_f32_16x16x4_f32 v[52:55], v71, v77, v[52:55]
    v_mfma_f32_16x16x4_f32 v[56:59], v71, v79, v[56:59]
    v_mfma_f32_16x16x4_f32 v[60:63], v73, v81, v[60:63]
    v_mov_b32_dpp v64, v24 row_newbcast:7 row_mask:0xf bank_mask:0xf
    v_mov_b32_dpp v65, v25 row_newbcast:7 row_mask:0xf bank_mask:0xf
    v_mov_b32_dpp v66, v26 row_newbcast:7 row_mask:0xf bank_mask:0xf
    v_mov_b32_dpp v67, v27 row_newbcast:7 row_mask:0xf bank_mask:0xf
    v_mul_f32 v82, v64, v47
    v_mul_f32 v83, v65, v47
    v_exp_f32 v82, v82
    v_fract_f32 v83, v83
    v_cos_f32 v74, v83
    v_sin_f32 v75, v83
    v_mul_f32 v74, v74, v82
    v_mul_f32 v75, v75, v82
    v_mul_f32 v84, v75, v75
    v_add_f32 v85, v74, v74
    v_fma_f32 v76, v74, v74, -v84
    v_mul_f32 v77, v85, v75
    v_mul_f32 v84, v77, v77
    v_add_f32 v85, v76, v76
    v_fma_f32 v78, v76, v76, -v84
    v_mul_f32 v79, v85, v77
    v_mul_f32 v84, v79, v79
    v_add_f32 v85, v78, v78
    v_fma_f32 v80, v78, v78, -v84
    v_mul_f32 v81, v85, v79
    v_mul_f32 v82, v64, v44
    v_mul_f32 v83, v65, v44
    v_exp_f32 v82, v82
    v_fract_f32 v83, v83
    v_cos_f32 v68, v83
    v_sin_f32 v69, v83
    v_mul_f32 v68, v68, v82
    v_mul_f32 v69, v69, v82
    v_mul_f32 v84, v67, v69
    v_mul_f32 v85, v67, v68
    v_fma_f32 v68, v66, v68, -v84
    v_fma_f32 v69, -v66, v69, -v85
    v_mul_f32 v82, v64, v45
    v_mul_f32 v83, v65, v45
    v_exp_f32 v82, v82
    v_fract_f32 v83, v83
    v_cos_f32 v70, v83
    v_sin_f32 v71, v83
    v_mul_f32 v70, v70, v82
    v_mul_f32 v71, v71, v82
    v_mul_f32 v84, v67, v71
    v_mul_f32 v85, v67, v70
    v_fma_f32 v70, v66, v70, -v84
    v_fma_f32 v71, -v66, v71, -v85
    v_mul_f32 v82, v64, v46
    v_mul_f32 v83, v65, v46
    v_exp_f32 v82, v82
    v_fract_f32 v83, v83
    v_cos_f32 v72, v83
    v_sin_f32 v73, v83
    v_mul_f32 v72, v72, v82
    v_mul_f32 v73, v73, v82
    v_mul_f32 v84, v67, v73
    v_mul_f32 v85, v67, v72
    v_fma_f32 v72, v66, v72, -v84
    v_fma_f32 v73, -v66, v73, -v85
    v_mfma_f32_16x16x4_f32 v[48:51], v68, v74, v[48:51]
    v_mfma_f32_16x16x4_f32 v[52:55], v70, v76, v[52:55]
    v_mfma_f32_16x16x4_f32 v[56:59], v70, v78, v[56:59]
    v_mfma_f32_16x16x4_f32 v[60:63], v72, v80, v[60:63]
    v_mfma_f32_16x16x4_f32 v[48:51], v69, v75, v[48:51]
    v_mfma_f32_16x16x4_f32 v[52:55], v71, v77, v[52:55]
    v_mfma_f32_16x16x4_f32 v[56:59], v71, v79, v[56:59]
    v_mfma_f32_16x16x4_f32 v[60:63], v73, v81, v[60:63]
    v_mov_b32_dpp v64, v24 row_newbcast:8 row_mask:0xf bank_mask:0xf
    v_mov_b32_dpp v65, v25 row_newbcast:8 row_mask:0xf bank_mask:0xf
    v_mov_b32_dpp v66, v26 row_newbcast:8 row_mask:0xf bank_mask:0xf
    v_mov_b32_dpp v67, v27 row_newbcast:8 row_mask:0xf bank_mask:0xf
    v_mul_f32 v82, v64, v47
    v_mul_f32 v83, v65, v47
    v_exp_f32 v82, v82
    v_fract_f32 v83, v83
    v_cos_f32 v74, v83
    v_sin_f32 v75, v83
    v_mul_f32 v74, v74, v82
    v_mul_f32 v75, v75, v82
    v_mul_f32 v84, v75, v75
    v_add_f32 v85, v74, v74
    v_fma_f32 v76, v74, v74, -v84
    v_mul_f32 v77, v85, v75
    v_mul_f32 v84, v77, v77
    v_add_f32 v85, v76, v76
    v_fma_f32 v78, v76, v76, -v84
    v_mul_f32 v79, v85, v77
    v_mul_f32 v84, v79, v79
    v_add_f32 v85, v78, v78
    v_fma_f32 v80, v78, v78, -v84
    v_mul_f32 v81, v85, v79
    v_mul_f32 v82, v64, v44
    v_mul_f32 v83, v65, v44
    v_exp_f32 v82, v82
    v_fract_f32 v83, v83
    v_cos_f32 v68, v83
    v_sin_f32 v69, v83
    v_mul_f32 v68, v68, v82
    v_mul_f32 v69, v69, v82
    v_mul_f32 v84, v67, v69
    v_mul_f32 v85, v67, v68
    v_fma_f32 v68, v66, v68, -v84
    v_fma_f32 v69, -v66, v69, -v85
    v_mul_f32 v82, v64, v45
    v_mul_f32 v83, v65, v45
    v_exp_f32 v82, v82
    v_fract_f32 v83, v83
    v_cos_f32 v70, v83
    v_sin_f32 v71, v83
    v_mul_f32 v70, v70, v82
    v_mul_f32 v71, v71, v82
    v_mul_f32 v84, v67, v71
    v_mul_f32 v85, v67, v70
    v_fma_f32 v70, v66, v70, -v84
    v_fma_f32 v71, -v66, v71, -v85
    v_mul_f32 v82, v64, v46
    v_mul_f32 v83, v65, v46
    v_exp_f32 v82, v82
    v_fract_f32 v83, v83
    v_cos_f32 v72, v83
    v_sin_f32 v73, v83
    v_mul_f32 v72, v72, v82
    v_mul_f32 v73, v73, v82
    v_mul_f32 v84, v67, v73
    v_mul_f32 v85, v67, v72
    v_fma_f32 v72, v66, v72, -v84
    v_fma_f32 v73, -v66, v73, -v85
    v_mfma_f32_16x16x4_f32 v[48:51], v68, v74, v[48:51]
    v_mfma_f32_16x16x4_f32 v[52:55], v70, v76, v[52:55]
    v_mfma_f32_16x16x4_f32 v[56:59], v70, v78, v[56:59]
    v_mfma_f32_16x16x4_f32 v[60:63], v72, v80, v[60:63]
    v_mfma_f32_16x16x4_f32 v[48:51], v69, v75, v[48:51]
    v_mfma_f32_16x16x4_f32 v[52:55], v71, v77, v[52:55]
    v_mfma_f32_16x16x4_f32 v[56:59], v71, v79, v[56:59]
    v_mfma_f32_16x16x4_f32 v[60:63], v73, v81, v[60:63]
    v_mov_b32_dpp v64, v24 row_newbcast:9 row_mask:0xf bank_mask:0xf
    v_mov_b32_dpp v65, v25 row_newbcast:9 row_mask:0xf bank_mask:0xf
    v_mov_b32_dpp v66, v26 row_newbcast:9 row_mask:0xf bank_mask:0xf
    v_mov_b32_dpp v67, v27 row_newbcast:9 row_mask:0xf bank_mask:0xf
    v_mul_f32 v82, v64, v47
    v_mul_f32 v83, v65, v47
    v_exp_f32 v82, v82
    v_fract_f32 v83, v83
    v_cos_f32 v74, v83
    v_sin_f32 v75, v83
    v_mul_f32 v74, v74, v82
    v_mul_f32 v75, v75, v82
    v_mul_f32 v84, v75, v75
    v_add_f32 v85, v74, v74
    v_fma_f32 v76, v74, v74, -v84
    v_mul_f32 v77, v85, v75
    v_mul_f32 v84, v77, v77
    v_add_f32 v85, v76, v76
    v_fma_f32 v78, v76, v76, -v84
    v_mul_f32 v79, v85, v77
    v_mul_f32 v84, v79, v79
    v_add_f32 v85, v78, v78
    v_fma_f32 v80, v78, v78, -v84
    v_mul_f32 v81, v85, v79
    v_mul_f32 v82, v64, v44
    v_mul_f32 v83, v65, v44
    v_exp_f32 v82, v82
    v_fract_f32 v83, v83
    v_cos_f32 v68, v83
    v_sin_f32 v69, v83
    v_mul_f32 v68, v68, v82
    v_mul_f32 v69, v69, v82
    v_mul_f32 v84, v67, v69
    v_mul_f32 v85, v67, v68
    v_fma_f32 v68, v66, v68, -v84
    v_fma_f32 v69, -v66, v69, -v85
    v_mul_f32 v82, v64, v45
    v_mul_f32 v83, v65, v45
    v_exp_f32 v82, v82
    v_fract_f32 v83, v83
    v_cos_f32 v70, v83
    v_sin_f32 v71, v83
    v_mul_f32 v70, v70, v82
    v_mul_f32 v71, v71, v82
    v_mul_f32 v84, v67, v71
    v_mul_f32 v85, v67, v70
    v_fma_f32 v70, v66, v70, -v84
    v_fma_f32 v71, -v66, v71, -v85
    v_mul_f32 v82, v64, v46
    v_mul_f32 v83, v65, v46
    v_exp_f32 v82, v82
    v_fract_f32 v83, v83
    v_cos_f32 v72, v83
    v_sin_f32 v73, v83
    v_mul_f32 v72, v72, v82
    v_mul_f32 v73, v73, v82
    v_mul_f32 v84, v67, v73
    v_mul_f32 v85, v67, v72
    v_fma_f32 v72, v66, v72, -v84
    v_fma_f32 v73, -v66, v73, -v85
    v_mfma_f32_16x16x4_f32 v[48:51], v68, v74, v[48:51]
    v_mfma_f32_16x16x4_f32 v[52:55], v70, v76, v[52:55]
    v_mfma_f32_16x16x4_f32 v[56:59], v70, v78, v[56:59]
    v_mfma_f32_16x16x4_f32 v[60:63], v72, v80, v[60:63]
    v_mfma_f32_16x16x4_f32 v[48:51], v69, v75, v[48:51]
    v_mfma_f32_16x16x4_f32 v[52:55], v71, v77, v[52:55]
    v_mfma_f32_16x16x4_f32 v[56:59], v71, v79, v[56:59]
    v_mfma_f32_16x16x4_f32 v[60:63], v73, v81, v[60:63]
    v_mov_b32_dpp v64, v24 row_newbcast:10 row_mask:0xf bank_mask:0xf
    v_mov_b32_dpp v65, v25 row_newbcast:10 row_mask:0xf bank_mask:0xf
    v_mov_b32_dpp v66, v26 row_newbcast:10 row_mask:0xf bank_mask:0xf
    v_mov_b32_dpp v67, v27 row_newbcast:10 row_mask:0xf bank_mask:0xf
    v_mul_f32 v82, v64, v47
    v_mul_f32 v83, v65, v47
    v_exp_f32 v82, v82
    v_fract_f32 v83, v83
    v_cos_f32 v74, v83
    v_sin_f32 v75, v83
    v_mul_f32 v74, v74, v82
    v_mul_f32 v75, v75, v82
    v_mul_f32 v84, v75, v75
    v_add_f32 v85, v74, v74
    v_fma_f32 v76, v74, v74, -v84
    v_mul_f32 v77, v85, v75
    v_mul_f32 v84, v77, v77
    v_add_f32 v85, v76, v76
    v_fma_f32 v78, v76, v76, -v84
    v_mul_f32 v79, v85, v77
    v_mul_f32 v84, v79, v79
    v_add_f32 v85, v78, v78
    v_fma_f32 v80, v78, v78, -v84
    v_mul_f32 v81, v85, v79
    v_mul_f32 v82, v64, v44
    v_mul_f32 v83, v65, v44
    v_exp_f32 v82, v82
    v_fract_f32 v83, v83
    v_cos_f32 v68, v83
    v_sin_f32 v69, v83
    v_mul_f32 v68, v68, v82
    v_mul_f32 v69, v69, v82
    v_mul_f32 v84, v67, v69
    v_mul_f32 v85, v67, v68
    v_fma_f32 v68, v66, v68, -v84
    v_fma_f32 v69, -v66, v69, -v85
    v_mul_f32 v82, v64, v45
    v_mul_f32 v83, v65, v45
    v_exp_f32 v82, v82
    v_fract_f32 v83, v83
    v_cos_f32 v70, v83
    v_sin_f32 v71, v83
    v_mul_f32 v70, v70, v82
    v_mul_f32 v71, v71, v82
    v_mul_f32 v84, v67, v71
    v_mul_f32 v85, v67, v70
    v_fma_f32 v70, v66, v70, -v84
    v_fma_f32 v71, -v66, v71, -v85
    v_mul_f32 v82, v64, v46
    v_mul_f32 v83, v65, v46
    v_exp_f32 v82, v82
    v_fract_f32 v83, v83
    v_cos_f32 v72, v83
    v_sin_f32 v73, v83
    v_mul_f32 v72, v72, v82
    v_mul_f32 v73, v73, v82
    v_mul_f32 v84, v67, v73
    v_mul_f32 v85, v67, v72
    v_fma_f32 v72, v66, v72, -v84
    v_fma_f32 v73, -v66, v73, -v85
    v_mfma_f32_16x16x4_f32 v[48:51], v68, v74, v[48:51]
    v_mfma_f32_16x16x4_f32 v[52:55], v70, v76, v[52:55]
    v_mfma_f32_16x16x4_f32 v[56:59], v70, v78, v[56:59]
    v_mfma_f32_16x16x4_f32 v[60:63], v72, v80, v[60:63]
    v_mfma_f32_16x16x4_f32 v[48:51], v69, v75, v[48:51]
    v_mfma_f32_16x16x4_f32 v[52:55], v71, v77, v[52:55]
    v_mfma_f32_16x16x4_f32 v[56:59], v71, v79, v[56:59]
    v_mfma_f32_16x16x4_f32 v[60:63], v73, v81, v[60:63]
    v_mov_b32_dpp v64, v24 row_newbcast:11 row_mask:0xf bank_mask:0xf
    v_mov_b32_dpp v65, v25 row_newbcast:11 row_mask:0xf bank_mask:0xf
    v_mov_b32_dpp v66, v26 row_newbcast:11 row_mask:0xf bank_mask:0xf
    v_mov_b32_dpp v67, v27 row_newbcast:11 row_mask:0xf bank_mask:0xf
    v_mul_f32 v82, v64, v47
    v_mul_f32 v83, v65, v47
    v_exp_f32 v82, v82
    v_fract_f32 v83, v83
    v_cos_f32 v74, v83
    v_sin_f32 v75, v83
    v_mul_f32 v74, v74, v82
    v_mul_f32 v75, v75, v82
    v_mul_f32 v84, v75, v75
    v_add_f32 v85, v74, v74
    v_fma_f32 v76, v74, v74, -v84
    v_mul_f32 v77, v85, v75
    v_mul_f32 v84, v77, v77
    v_add_f32 v85, v76, v76
    v_fma_f32 v78, v76, v76, -v84
    v_mul_f32 v79, v85, v77
    v_mul_f32 v84, v79, v79
    v_add_f32 v85, v78, v78
    v_fma_f32 v80, v78, v78, -v84
    v_mul_f32 v81, v85, v79
    v_mul_f32 v82, v64, v44
    v_mul_f32 v83, v65, v44
    v_exp_f32 v82, v82
    v_fract_f32 v83, v83
    v_cos_f32 v68, v83
    v_sin_f32 v69, v83
    v_mul_f32 v68, v68, v82
    v_mul_f32 v69, v69, v82
    v_mul_f32 v84, v67, v69
    v_mul_f32 v85, v67, v68
    v_fma_f32 v68, v66, v68, -v84
    v_fma_f32 v69, -v66, v69, -v85
    v_mul_f32 v82, v64, v45
    v_mul_f32 v83, v65, v45
    v_exp_f32 v82, v82
    v_fract_f32 v83, v83
    v_cos_f32 v70, v83
    v_sin_f32 v71, v83
    v_mul_f32 v70, v70, v82
    v_mul_f32 v71, v71, v82
    v_mul_f32 v84, v67, v71
    v_mul_f32 v85, v67, v70
    v_fma_f32 v70, v66, v70, -v84
    v_fma_f32 v71, -v66, v71, -v85
    v_mul_f32 v82, v64, v46
    v_mul_f32 v83, v65, v46
    v_exp_f32 v82, v82
    v_fract_f32 v83, v83
    v_cos_f32 v72, v83
    v_sin_f32 v73, v83
    v_mul_f32 v72, v72, v82
    v_mul_f32 v73, v73, v82
    v_mul_f32 v84, v67, v73
    v_mul_f32 v85, v67, v72
    v_fma_f32 v72, v66, v72, -v84
    v_fma_f32 v73, -v66, v73, -v85
    v_mfma_f32_16x16x4_f32 v[48:51], v68, v74, v[48:51]
    v_mfma_f32_16x16x4_f32 v[52:55], v70, v76, v[52:55]
    v_mfma_f32_16x16x4_f32 v[56:59], v70, v78, v[56:59]
    v_mfma_f32_16x16x4_f32 v[60:63], v72, v80, v[60:63]
    v_mfma_f32_16x16x4_f32 v[48:51], v69, v75, v[48:51]
    v_mfma_f32_16x16x4_f32 v[52:55], v71, v77, v[52:55]
    v_mfma_f32_16x16x4_f32 v[56:59], v71, v79, v[56:59]
    v_mfma_f32_16x16x4_f32 v[60:63], v73, v81, v[60:63]
    v_mov_b32_dpp v64, v24 row_newbcast:12 row_mask:0xf bank_mask:0xf
    v_mov_b32_dpp v65, v25 row_newbcast:12 row_mask:0xf bank_mask:0xf
    v_mov_b32_dpp v66, v26 row_newbcast:12 row_mask:0xf bank_mask:0xf
    v_mov_b32_dpp v67, v27 row_newbcast:12 row_mask:0xf bank_mask:0xf
    v_mul_f32 v82, v64, v47
    v_mul_f32 v83, v65, v47
    v_exp_f32 v82, v82
    v_fract_f32 v83, v83
    v_cos_f32 v74, v83
    v_sin_f32 v75, v83
    v_mul_f32 v74, v74, v82
    v_mul_f32 v75, v75, v82
    v_mul_f32 v84, v75, v75
    v_add_f32 v85, v74, v74
    v_fma_f32 v76, v74, v74, -v84
    v_mul_f32 v77, v85, v75
    v_mul_f32 v84, v77, v77
    v_add_f32 v85, v76, v76
    v_fma_f32 v78, v76, v76, -v84
    v_mul_f32 v79, v85, v77
    v_mul_f32 v84, v79, v79
    v_add_f32 v85, v78, v78
    v_fma_f32 v80, v78, v78, -v84
    v_mul_f32 v81, v85, v79
    v_mul_f32 v82, v64, v44
    v_mul_f32 v83, v65, v44
    v_exp_f32 v82, v82
    v_fract_f32 v83, v83
    v_cos_f32 v68, v83
    v_sin_f32 v69, v83
    v_mul_f32 v68, v68, v82
    v_mul_f32 v69, v69, v82
    v_mul_f32 v84, v67, v69
    v_mul_f32 v85, v67, v68
    v_fma_f32 v68, v66, v68, -v84
    v_fma_f32 v69, -v66, v69, -v85
    v_mul_f32 v82, v64, v45
    v_mul_f32 v83, v65, v45
    v_exp_f32 v82, v82
    v_fract_f32 v83, v83
    v_cos_f32 v70, v83
    v_sin_f32 v71, v83
    v_mul_f32 v70, v70, v82
    v_mul_f32 v71, v71, v82
    v_mul_f32 v84, v67, v71
    v_mul_f32 v85, v67, v70
    v_fma_f32 v70, v66, v70, -v84
    v_fma_f32 v71, -v66, v71, -v85
    v_mul_f32 v82, v64, v46
    v_mul_f32 v83, v65, v46
    v_exp_f32 v82, v82
    v_fract_f32 v83, v83
    v_cos_f32 v72, v83
    v_sin_f32 v73, v83
    v_mul_f32 v72, v72, v82
    v_mul_f32 v73, v73, v82
    v_mul_f32 v84, v67, v73
    v_mul_f32 v85, v67, v72
    v_fma_f32 v72, v66, v72, -v84
    v_fma_f32 v73, -v66, v73, -v85
    v_mfma_f32_16x16x4_f32 v[48:51], v68, v74, v[48:51]
    v_mfma_f32_16x16x4_f32 v[52:55], v70, v76, v[52:55]
    v_mfma_f32_16x16x4_f32 v[56:59], v70, v78, v[56:59]
    v_mfma_f32_16x16x4_f32 v[60:63], v72, v80, v[60:63]
    v_mfma_f32_16x16x4_f32 v[48:51], v69, v75, v[48:51]
    v_mfma_f32_16x16x4_f32 v[52:55], v71, v77, v[52:55]
    v_mfma_f32_16x16x4_f32 v[56:59], v71, v79, v[56:59]
    v_mfma_f32_16x16x4_f32 v[60:63], v73, v81, v[60:63]
    v_mov_b32_dpp v64, v24 row_newbcast:13 row_mask:0xf bank_mask:0xf
    v_mov_b32_dpp v65, v25 row_newbcast:13 row_mask:0xf bank_mask:0xf
    v_mov_b32_dpp v66, v26 row_newbcast:13 row_mask:0xf bank_mask:0xf
    v_mov_b32_dpp v67, v27 row_newbcast:13 row_mask:0xf bank_mask:0xf
    v_mul_f32 v82, v64, v47
    v_mul_f32 v83, v65, v47
    v_exp_f32 v82, v82
    v_fract_f32 v83, v83
    v_cos_f32 v74, v83
    v_sin_f32 v75, v83
    v_mul_f32 v74, v74, v82
    v_mul_f32 v75, v75, v82
    v_mul_f32 v84, v75, v75
    v_add_f32 v85, v74, v74
    v_fma_f32 v76, v74, v74, -v84
    v_mul_f32 v77, v85, v75
    v_mul_f32 v84, v77, v77
    v_add_f32 v85, v76, v76
    v_fma_f32 v78, v76, v76, -v84
    v_mul_f32 v79, v85, v77
    v_mul_f32 v84, v79, v79
    v_add_f32 v85, v78, v78
    v_fma_f32 v80, v78, v78, -v84
    v_mul_f32 v81, v85, v79
    v_mul_f32 v82, v64, v44
    v_mul_f32 v83, v65, v44
    v_exp_f32 v82, v82
    v_fract_f32 v83, v83
    v_cos_f32 v68, v83
    v_sin_f32 v69, v83
    v_mul_f32 v68, v68, v82
    v_mul_f32 v69, v69, v82
    v_mul_f32 v84, v67, v69
    v_mul_f32 v85, v67, v68
    v_fma_f32 v68, v66, v68, -v84
    v_fma_f32 v69, -v66, v69, -v85
    v_mul_f32 v82, v64, v45
    v_mul_f32 v83, v65, v45
    v_exp_f32 v82, v82
    v_fract_f32 v83, v83
    v_cos_f32 v70, v83
    v_sin_f32 v71, v83
    v_mul_f32 v70, v70, v82
    v_mul_f32 v71, v71, v82
    v_mul_f32 v84, v67, v71
    v_mul_f32 v85, v67, v70
    v_fma_f32 v70, v66, v70, -v84
    v_fma_f32 v71, -v66, v71, -v85
    v_mul_f32 v82, v64, v46
    v_mul_f32 v83, v65, v46
    v_exp_f32 v82, v82
    v_fract_f32 v83, v83
    v_cos_f32 v72, v83
    v_sin_f32 v73, v83
    v_mul_f32 v72, v72, v82
    v_mul_f32 v73, v73, v82
    v_mul_f32 v84, v67, v73
    v_mul_f32 v85, v67, v72
    v_fma_f32 v72, v66, v72, -v84
    v_fma_f32 v73, -v66, v73, -v85
    v_mfma_f32_16x16x4_f32 v[48:51], v68, v74, v[48:51]
    v_mfma_f32_16x16x4_f32 v[52:55], v70, v76, v[52:55]
    v_mfma_f32_16x16x4_f32 v[56:59], v70, v78, v[56:59]
    v_mfma_f32_16x16x4_f32 v[60:63], v72, v80, v[60:63]
    v_mfma_f32_16x16x4_f32 v[48:51], v69, v75, v[48:51]
    v_mfma_f32_16x16x4_f32 v[52:55], v71, v77, v[52:55]
    v_mfma_f32_16x16x4_f32 v[56:59], v71, v79, v[56:59]
    v_mfma_f32_16x16x4_f32 v[60:63], v73, v81, v[60:63]
    v_mov_b32_dpp v64, v24 row_newbcast:14 row_mask:0xf bank_mask:0xf
    v_mov_b32_dpp v65, v25 row_newbcast:14 row_mask:0xf bank_mask:0xf
    v_mov_b32_dpp v66, v26 row_newbcast:14 row_mask:0xf bank_mask:0xf
    v_mov_b32_dpp v67, v27 row_newbcast:14 row_mask:0xf bank_mask:0xf
    v_mul_f32 v82, v64, v47
    v_mul_f32 v83, v65, v47
    v_exp_f32 v82, v82
    v_fract_f32 v83, v83
    v_cos_f32 v74, v83
    v_sin_f32 v75, v83
    v_mul_f32 v74, v74, v82
    v_mul_f32 v75, v75, v82
    v_mul_f32 v84, v75, v75
    v_add_f32 v85, v74, v74
    v_fma_f32 v76, v74, v74, -v84
    v_mul_f32 v77, v85, v75
    v_mul_f32 v84, v77, v77
    v_add_f32 v85, v76, v76
    v_fma_f32 v78, v76, v76, -v84
    v_mul_f32 v79, v85, v77
    v_mul_f32 v84, v79, v79
    v_add_f32 v85, v78, v78
    v_fma_f32 v80, v78, v78, -v84
    v_mul_f32 v81, v85, v79
    v_mul_f32 v82, v64, v44
    v_mul_f32 v83, v65, v44
    v_exp_f32 v82, v82
    v_fract_f32 v83, v83
    v_cos_f32 v68, v83
    v_sin_f32 v69, v83
    v_mul_f32 v68, v68, v82
    v_mul_f32 v69, v69, v82
    v_mul_f32 v84, v67, v69
    v_mul_f32 v85, v67, v68
    v_fma_f32 v68, v66, v68, -v84
    v_fma_f32 v69, -v66, v69, -v85
    v_mul_f32 v82, v64, v45
    v_mul_f32 v83, v65, v45
    v_exp_f32 v82, v82
    v_fract_f32 v83, v83
    v_cos_f32 v70, v83
    v_sin_f32 v71, v83
    v_mul_f32 v70, v70, v82
    v_mul_f32 v71, v71, v82
    v_mul_f32 v84, v67, v71
    v_mul_f32 v85, v67, v70
    v_fma_f32 v70, v66, v70, -v84
    v_fma_f32 v71, -v66, v71, -v85
    v_mul_f32 v82, v64, v46
    v_mul_f32 v83, v65, v46
    v_exp_f32 v82, v82
    v_fract_f32 v83, v83
    v_cos_f32 v72, v83
    v_sin_f32 v73, v83
    v_mul_f32 v72, v72, v82
    v_mul_f32 v73, v73, v82
    v_mul_f32 v84, v67, v73
    v_mul_f32 v85, v67, v72
    v_fma_f32 v72, v66, v72, -v84
    v_fma_f32 v73, -v66, v73, -v85
    v_mfma_f32_16x16x4_f32 v[48:51], v68, v74, v[48:51]
    v_mfma_f32_16x16x4_f32 v[52:55], v70, v76, v[52:55]
    v_mfma_f32_16x16x4_f32 v[56:59], v70, v78, v[56:59]
    v_mfma_f32_16x16x4_f32 v[60:63], v72, v80, v[60:63]
    v_mfma_f32_16x16x4_f32 v[48:51], v69, v75, v[48:51]
    v_mfma_f32_16x16x4_f32 v[52:55], v71, v77, v[52:55]
    v_mfma_f32_16x16x4_f32 v[56:59], v71, v79, v[56:59]
    v_mfma_f32_16x16x4_f32 v[60:63], v73, v81, v[60:63]
    v_mov_b32_dpp v64, v24 row_newbcast:15 row_mask:0xf bank_mask:0xf
    v_mov_b32_dpp v65, v25 row_newbcast:15 row_mask:0xf bank_mask:0xf
    v_mov_b32_dpp v66, v26 row_newbcast:15 row_mask:0xf bank_mask:0xf
    v_mov_b32_dpp v67, v27 row_newbcast:15 row_mask:0xf bank_mask:0xf
    v_mul_f32 v82, v64, v47
    v_mul_f32 v83, v65, v47
    v_exp_f32 v82, v82
    v_fract_f32 v83, v83
    v_cos_f32 v74, v83
    v_sin_f32 v75, v83
    v_mul_f32 v74, v74, v82
    v_mul_f32 v75, v75, v82
    v_mul_f32 v84, v75, v75
    v_add_f32 v85, v74, v74
    v_fma_f32 v76, v74, v74, -v84
    v_mul_f32 v77, v85, v75
    v_mul_f32 v84, v77, v77
    v_add_f32 v85, v76, v76
    v_fma_f32 v78, v76, v76, -v84
    v_mul_f32 v79, v85, v77
    v_mul_f32 v84, v79, v79
    v_add_f32 v85, v78, v78
    v_fma_f32 v80, v78, v78, -v84
    v_mul_f32 v81, v85, v79
    v_mul_f32 v82, v64, v44
    v_mul_f32 v83, v65, v44
    v_exp_f32 v82, v82
    v_fract_f32 v83, v83
    v_cos_f32 v68, v83
    v_sin_f32 v69, v83
    v_mul_f32 v68, v68, v82
    v_mul_f32 v69, v69, v82
    v_mul_f32 v84, v67, v69
    v_mul_f32 v85, v67, v68
    v_fma_f32 v68, v66, v68, -v84
    v_fma_f32 v69, -v66, v69, -v85
    v_mul_f32 v82, v64, v45
    v_mul_f32 v83, v65, v45
    v_exp_f32 v82, v82
    v_fract_f32 v83, v83
    v_cos_f32 v70, v83
    v_sin_f32 v71, v83
    v_mul_f32 v70, v70, v82
    v_mul_f32 v71, v71, v82
    v_mul_f32 v84, v67, v71
    v_mul_f32 v85, v67, v70
    v_fma_f32 v70, v66, v70, -v84
    v_fma_f32 v71, -v66, v71, -v85
    v_mul_f32 v82, v64, v46
    v_mul_f32 v83, v65, v46
    v_exp_f32 v82, v82
    v_fract_f32 v83, v83
    v_cos_f32 v72, v83
    v_sin_f32 v73, v83
    v_mul_f32 v72, v72, v82
    v_mul_f32 v73, v73, v82
    v_mul_f32 v84, v67, v73
    v_mul_f32 v85, v67, v72
    v_fma_f32 v72, v66, v72, -v84
    v_fma_f32 v73, -v66, v73, -v85
    v_mfma_f32_16x16x4_f32 v[48:51], v68, v74, v[48:51]
    v_mfma_f32_16x16x4_f32 v[52:55], v70, v76, v[52:55]
    v_mfma_f32_16x16x4_f32 v[56:59], v70, v78, v[56:59]
    v_mfma_f32_16x16x4_f32 v[60:63], v72, v80, v[60:63]
    v_mfma_f32_16x16x4_f32 v[48:51], v69, v75, v[48:51]
    v_mfma_f32_16x16x4_f32 v[52:55], v71, v77, v[52:55]
    v_mfma_f32_16x16x4_f32 v[56:59], v71, v79, v[56:59]
    v_mfma_f32_16x16x4_f32 v[60:63], v73, v81, v[60:63]
    v_mov_b32_dpp v64, v28 row_newbcast:0 row_mask:0xf bank_mask:0xf
    v_mov_b32_dpp v65, v29 row_newbcast:0 row_mask:0xf bank_mask:0xf
    v_mov_b32_dpp v66, v30 row_newbcast:0 row_mask:0xf bank_mask:0xf
    v_mov_b32_dpp v67, v31 row_newbcast:0 row_mask:0xf bank_mask:0xf
    v_mul_f32 v82, v64, v47
    v_mul_f32 v83, v65, v47
    v_exp_f32 v82, v82
    v_fract_f32 v83, v83
    v_cos_f32 v74, v83
    v_sin_f32 v75, v83
    v_mul_f32 v74, v74, v82
    v_mul_f32 v75, v75, v82
    v_mul_f32 v84, v75, v75
    v_add_f32 v85, v74, v74
    v_fma_f32 v76, v74, v74, -v84
    v_mul_f32 v77, v85, v75
    v_mul_f32 v84, v77, v77
    v_add_f32 v85, v76, v76
    v_fma_f32 v78, v76, v76, -v84
    v_mul_f32 v79, v85, v77
    v_mul_f32 v84, v79, v79
    v_add_f32 v85, v78, v78
    v_fma_f32 v80, v78, v78, -v84
    v_mul_f32 v81, v85, v79
    v_mul_f32 v82, v64, v44
    v_mul_f32 v83, v65, v44
    v_exp_f32 v82, v82
    v_fract_f32 v83, v83
    v_cos_f32 v68, v83
    v_sin_f32 v69, v83
    v_mul_f32 v68, v68, v82
    v_mul_f32 v69, v69, v82
    v_mul_f32 v84, v67, v69
    v_mul_f32 v85, v67, v68
    v_fma_f32 v68, v66, v68, -v84
    v_fma_f32 v69, -v66, v69, -v85
    v_mul_f32 v82, v64, v45
    v_mul_f32 v83, v65, v45
    v_exp_f32 v82, v82
    v_fract_f32 v83, v83
    v_cos_f32 v70, v83
    v_sin_f32 v71, v83
    v_mul_f32 v70, v70, v82
    v_mul_f32 v71, v71, v82
    v_mul_f32 v84, v67, v71
    v_mul_f32 v85, v67, v70
    v_fma_f32 v70, v66, v70, -v84
    v_fma_f32 v71, -v66, v71, -v85
    v_mul_f32 v82, v64, v46
    v_mul_f32 v83, v65, v46
    v_exp_f32 v82, v82
    v_fract_f32 v83, v83
    v_cos_f32 v72, v83
    v_sin_f32 v73, v83
    v_mul_f32 v72, v72, v82
    v_mul_f32 v73, v73, v82
    v_mul_f32 v84, v67, v73
    v_mul_f32 v85, v67, v72
    v_fma_f32 v72, v66, v72, -v84
    v_fma_f32 v73, -v66, v73, -v85
    v_mfma_f32_16x16x4_f32 v[48:51], v68, v74, v[48:51]
    v_mfma_f32_16x16x4_f32 v[52:55], v70, v76, v[52:55]
    v_mfma_f32_16x16x4_f32 v[56:59], v70, v78, v[56:59]
    v_mfma_f32_16x16x4_f32 v[60:63], v72, v80, v[60:63]
    v_mfma_f32_16x16x4_f32 v[48:51], v69, v75, v[48:51]
    v_mfma_f32_16x16x4_f32 v[52:55], v71, v77, v[52:55]
    v_mfma_f32_16x16x4_f32 v[56:59], v71, v79, v[56:59]
    v_mfma_f32_16x16x4_f32 v[60:63], v73, v81, v[60:63]
    v_mov_b32_dpp v64, v28 row_newbcast:1 row_mask:0xf bank_mask:0xf
    v_mov_b32_dpp v65, v29 row_newbcast:1 row_mask:0xf bank_mask:0xf
    v_mov_b32_dpp v66, v30 row_newbcast:1 row_mask:0xf bank_mask:0xf
    v_mov_b32_dpp v67, v31 row_newbcast:1 row_mask:0xf bank_mask:0xf
    v_mul_f32 v82, v64, v47
    v_mul_f32 v83, v65, v47
    v_exp_f32 v82, v82
    v_fract_f32 v83, v83
    v_cos_f32 v74, v83
    v_sin_f32 v75, v83
    v_mul_f32 v74, v74, v82
    v_mul_f32 v75, v75, v82
    v_mul_f32 v84, v75, v75
    v_add_f32 v85, v74, v74
    v_fma_f32 v76, v74, v74, -v84
    v_mul_f32 v77, v85, v75
    v_mul_f32 v84, v77, v77
    v_add_f32 v85, v76, v76
    v_fma_f32 v78, v76, v76, -v84
    v_mul_f32 v79, v85, v77
    v_mul_f32 v84, v79, v79
    v_add_f32 v85, v78, v78
    v_fma_f32 v80, v78, v78, -v84
    v_mul_f32 v81, v85, v79
    v_mul_f32 v82, v64, v44
    v_mul_f32 v83, v65, v44
    v_exp_f32 v82, v82
    v_fract_f32 v83, v83
    v_cos_f32 v68, v83
    v_sin_f32 v69, v83
    v_mul_f32 v68, v68, v82
    v_mul_f32 v69, v69, v82
    v_mul_f32 v84, v67, v69
    v_mul_f32 v85, v67, v68
    v_fma_f32 v68, v66, v68, -v84
    v_fma_f32 v69, -v66, v69, -v85
    v_mul_f32 v82, v64, v45
    v_mul_f32 v83, v65, v45
    v_exp_f32 v82, v82
    v_fract_f32 v83, v83
    v_cos_f32 v70, v83
    v_sin_f32 v71, v83
    v_mul_f32 v70, v70, v82
    v_mul_f32 v71, v71, v82
    v_mul_f32 v84, v67, v71
    v_mul_f32 v85, v67, v70
    v_fma_f32 v70, v66, v70, -v84
    v_fma_f32 v71, -v66, v71, -v85
    v_mul_f32 v82, v64, v46
    v_mul_f32 v83, v65, v46
    v_exp_f32 v82, v82
    v_fract_f32 v83, v83
    v_cos_f32 v72, v83
    v_sin_f32 v73, v83
    v_mul_f32 v72, v72, v82
    v_mul_f32 v73, v73, v82
    v_mul_f32 v84, v67, v73
    v_mul_f32 v85, v67, v72
    v_fma_f32 v72, v66, v72, -v84
    v_fma_f32 v73, -v66, v73, -v85
    v_mfma_f32_16x16x4_f32 v[48:51], v68, v74, v[48:51]
    v_mfma_f32_16x16x4_f32 v[52:55], v70, v76, v[52:55]
    v_mfma_f32_16x16x4_f32 v[56:59], v70, v78, v[56:59]
    v_mfma_f32_16x16x4_f32 v[60:63], v72, v80, v[60:63]
    v_mfma_f32_16x16x4_f32 v[48:51], v69, v75, v[48:51]
    v_mfma_f32_16x16x4_f32 v[52:55], v71, v77, v[52:55]
    v_mfma_f32_16x16x4_f32 v[56:59], v71, v79, v[56:59]
    v_mfma_f32_16x16x4_f32 v[60:63], v73, v81, v[60:63]
    v_mov_b32_dpp v64, v28 row_newbcast:2 row_mask:0xf bank_mask:0xf
    v_mov_b32_dpp v65, v29 row_newbcast:2 row_mask:0xf bank_mask:0xf
    v_mov_b32_dpp v66, v30 row_newbcast:2 row_mask:0xf bank_mask:0xf
    v_mov_b32_dpp v67, v31 row_newbcast:2 row_mask:0xf bank_mask:0xf
    v_mul_f32 v82, v64, v47
    v_mul_f32 v83, v65, v47
    v_exp_f32 v82, v82
    v_fract_f32 v83, v83
    v_cos_f32 v74, v83
    v_sin_f32 v75, v83
    v_mul_f32 v74, v74, v82
    v_mul_f32 v75, v75, v82
    v_mul_f32 v84, v75, v75
    v_add_f32 v85, v74, v74
    v_fma_f32 v76, v74, v74, -v84
    v_mul_f32 v77, v85, v75
    v_mul_f32 v84, v77, v77
    v_add_f32 v85, v76, v76
    v_fma_f32 v78, v76, v76, -v84
    v_mul_f32 v79, v85, v77
    v_mul_f32 v84, v79, v79
    v_add_f32 v85, v78, v78
    v_fma_f32 v80, v78, v78, -v84
    v_mul_f32 v81, v85, v79
    v_mul_f32 v82, v64, v44
    v_mul_f32 v83, v65, v44
    v_exp_f32 v82, v82
    v_fract_f32 v83, v83
    v_cos_f32 v68, v83
    v_sin_f32 v69, v83
    v_mul_f32 v68, v68, v82
    v_mul_f32 v69, v69, v82
    v_mul_f32 v84, v67, v69
    v_mul_f32 v85, v67, v68
    v_fma_f32 v68, v66, v68, -v84
    v_fma_f32 v69, -v66, v69, -v85
    v_mul_f32 v82, v64, v45
    v_mul_f32 v83, v65, v45
    v_exp_f32 v82, v82
    v_fract_f32 v83, v83
    v_cos_f32 v70, v83
    v_sin_f32 v71, v83
    v_mul_f32 v70, v70, v82
    v_mul_f32 v71, v71, v82
    v_mul_f32 v84, v67, v71
    v_mul_f32 v85, v67, v70
    v_fma_f32 v70, v66, v70, -v84
    v_fma_f32 v71, -v66, v71, -v85
    v_mul_f32 v82, v64, v46
    v_mul_f32 v83, v65, v46
    v_exp_f32 v82, v82
    v_fract_f32 v83, v83
    v_cos_f32 v72, v83
    v_sin_f32 v73, v83
    v_mul_f32 v72, v72, v82
    v_mul_f32 v73, v73, v82
    v_mul_f32 v84, v67, v73
    v_mul_f32 v85, v67, v72
    v_fma_f32 v72, v66, v72, -v84
    v_fma_f32 v73, -v66, v73, -v85
    v_mfma_f32_16x16x4_f32 v[48:51], v68, v74, v[48:51]
    v_mfma_f32_16x16x4_f32 v[52:55], v70, v76, v[52:55]
    v_mfma_f32_16x16x4_f32 v[56:59], v70, v78, v[56:59]
    v_mfma_f32_16x16x4_f32 v[60:63], v72, v80, v[60:63]
    v_mfma_f32_16x16x4_f32 v[48:51], v69, v75, v[48:51]
    v_mfma_f32_16x16x4_f32 v[52:55], v71, v77, v[52:55]
    v_mfma_f32_16x16x4_f32 v[56:59], v71, v79, v[56:59]
    v_mfma_f32_16x16x4_f32 v[60:63], v73, v81, v[60:63]
    v_mov_b32_dpp v64, v28 row_newbcast:3 row_mask:0xf bank_mask:0xf
    v_mov_b32_dpp v65, v29 row_newbcast:3 row_mask:0xf bank_mask:0xf
    v_mov_b32_dpp v66, v30 row_newbcast:3 row_mask:0xf bank_mask:0xf
    v_mov_b32_dpp v67, v31 row_newbcast:3 row_mask:0xf bank_mask:0xf
    v_mul_f32 v82, v64, v47
    v_mul_f32 v83, v65, v47
    v_exp_f32 v82, v82
    v_fract_f32 v83, v83
    v_cos_f32 v74, v83
    v_sin_f32 v75, v83
    v_mul_f32 v74, v74, v82
    v_mul_f32 v75, v75, v82
    v_mul_f32 v84, v75, v75
    v_add_f32 v85, v74, v74
    v_fma_f32 v76, v74, v74, -v84
    v_mul_f32 v77, v85, v75
    v_mul_f32 v84, v77, v77
    v_add_f32 v85, v76, v76
    v_fma_f32 v78, v76, v76, -v84
    v_mul_f32 v79, v85, v77
    v_mul_f32 v84, v79, v79
    v_add_f32 v85, v78, v78
    v_fma_f32 v80, v78, v78, -v84
    v_mul_f32 v81, v85, v79
    v_mul_f32 v82, v64, v44
    v_mul_f32 v83, v65, v44
    v_exp_f32 v82, v82
    v_fract_f32 v83, v83
    v_cos_f32 v68, v83
    v_sin_f32 v69, v83
    v_mul_f32 v68, v68, v82
    v_mul_f32 v69, v69, v82
    v_mul_f32 v84, v67, v69
    v_mul_f32 v85, v67, v68
    v_fma_f32 v68, v66, v68, -v84
    v_fma_f32 v69, -v66, v69, -v85
    v_mul_f32 v82, v64, v45
    v_mul_f32 v83, v65, v45
    v_exp_f32 v82, v82
    v_fract_f32 v83, v83
    v_cos_f32 v70, v83
    v_sin_f32 v71, v83
    v_mul_f32 v70, v70, v82
    v_mul_f32 v71, v71, v82
    v_mul_f32 v84, v67, v71
    v_mul_f32 v85, v67, v70
    v_fma_f32 v70, v66, v70, -v84
    v_fma_f32 v71, -v66, v71, -v85
    v_mul_f32 v82, v64, v46
    v_mul_f32 v83, v65, v46
    v_exp_f32 v82, v82
    v_fract_f32 v83, v83
    v_cos_f32 v72, v83
    v_sin_f32 v73, v83
    v_mul_f32 v72, v72, v82
    v_mul_f32 v73, v73, v82
    v_mul_f32 v84, v67, v73
    v_mul_f32 v85, v67, v72
    v_fma_f32 v72, v66, v72, -v84
    v_fma_f32 v73, -v66, v73, -v85
    v_mfma_f32_16x16x4_f32 v[48:51], v68, v74, v[48:51]
    v_mfma_f32_16x16x4_f32 v[52:55], v70, v76, v[52:55]
    v_mfma_f32_16x16x4_f32 v[56:59], v70, v78, v[56:59]
    v_mfma_f32_16x16x4_f32 v[60:63], v72, v80, v[60:63]
    v_mfma_f32_16x16x4_f32 v[48:51], v69, v75, v[48:51]
    v_mfma_f32_16x16x4_f32 v[52:55], v71, v77, v[52:55]
    v_mfma_f32_16x16x4_f32 v[56:59], v71, v79, v[56:59]
    v_mfma_f32_16x16x4_f32 v[60:63], v73, v81, v[60:63]
    v_mov_b32_dpp v64, v28 row_newbcast:4 row_mask:0xf bank_mask:0xf
    v_mov_b32_dpp v65, v29 row_newbcast:4 row_mask:0xf bank_mask:0xf
    v_mov_b32_dpp v66, v30 row_newbcast:4 row_mask:0xf bank_mask:0xf
    v_mov_b32_dpp v67, v31 row_newbcast:4 row_mask:0xf bank_mask:0xf
    v_mul_f32 v82, v64, v47
    v_mul_f32 v83, v65, v47
    v_exp_f32 v82, v82
    v_fract_f32 v83, v83
    v_cos_f32 v74, v83
    v_sin_f32 v75, v83
    v_mul_f32 v74, v74, v82
    v_mul_f32 v75, v75, v82
    v_mul_f32 v84, v75, v75
    v_add_f32 v85, v74, v74
    v_fma_f32 v76, v74, v74, -v84
    v_mul_f32 v77, v85, v75
    v_mul_f32 v84, v77, v77
    v_add_f32 v85, v76, v76
    v_fma_f32 v78, v76, v76, -v84
    v_mul_f32 v79, v85, v77
    v_mul_f32 v84, v79, v79
    v_add_f32 v85, v78, v78
    v_fma_f32 v80, v78, v78, -v84
    v_mul_f32 v81, v85, v79
    v_mul_f32 v82, v64, v44
    v_mul_f32 v83, v65, v44
    v_exp_f32 v82, v82
    v_fract_f32 v83, v83
    v_cos_f32 v68, v83
    v_sin_f32 v69, v83
    v_mul_f32 v68, v68, v82
    v_mul_f32 v69, v69, v82
    v_mul_f32 v84, v67, v69
    v_mul_f32 v85, v67, v68
    v_fma_f32 v68, v66, v68, -v84
    v_fma_f32 v69, -v66, v69, -v85
    v_mul_f32 v82, v64, v45
    v_mul_f32 v83, v65, v45
    v_exp_f32 v82, v82
    v_fract_f32 v83, v83
    v_cos_f32 v70, v83
    v_sin_f32 v71, v83
    v_mul_f32 v70, v70, v82
    v_mul_f32 v71, v71, v82
    v_mul_f32 v84, v67, v71
    v_mul_f32 v85, v67, v70
    v_fma_f32 v70, v66, v70, -v84
    v_fma_f32 v71, -v66, v71, -v85
    v_mul_f32 v82, v64, v46
    v_mul_f32 v83, v65, v46
    v_exp_f32 v82, v82
    v_fract_f32 v83, v83
    v_cos_f32 v72, v83
    v_sin_f32 v73, v83
    v_mul_f32 v72, v72, v82
    v_mul_f32 v73, v73, v82
    v_mul_f32 v84, v67, v73
    v_mul_f32 v85, v67, v72
    v_fma_f32 v72, v66, v72, -v84
    v_fma_f32 v73, -v66, v73, -v85
    v_mfma_f32_16x16x4_f32 v[48:51], v68, v74, v[48:51]
    v_mfma_f32_16x16x4_f32 v[52:55], v70, v76, v[52:55]
    v_mfma_f32_16x16x4_f32 v[56:59], v70, v78, v[56:59]
    v_mfma_f32_16x16x4_f32 v[60:63], v72, v80, v[60:63]
    v_mfma_f32_16x16x4_f32 v[48:51], v69, v75, v[48:51]
    v_mfma_f32_16x16x4_f32 v[52:55], v71, v77, v[52:55]
    v_mfma_f32_16x16x4_f32 v[56:59], v71, v79, v[56:59]
    v_mfma_f32_16x16x4_f32 v[60:63], v73, v81, v[60:63]
    v_mov_b32_dpp v64, v28 row_newbcast:5 row_mask:0xf bank_mask:0xf
    v_mov_b32_dpp v65, v29 row_newbcast:5 row_mask:0xf bank_mask:0xf
    v_mov_b32_dpp v66, v30 row_newbcast:5 row_mask:0xf bank_mask:0xf
    v_mov_b32_dpp v67, v31 row_newbcast:5 row_mask:0xf bank_mask:0xf
    v_mul_f32 v82, v64, v47
    v_mul_f32 v83, v65, v47
    v_exp_f32 v82, v82
    v_fract_f32 v83, v83
    v_cos_f32 v74, v83
    v_sin_f32 v75, v83
    v_mul_f32 v74, v74, v82
    v_mul_f32 v75, v75, v82
    v_mul_f32 v84, v75, v75
    v_add_f32 v85, v74, v74
    v_fma_f32 v76, v74, v74, -v84
    v_mul_f32 v77, v85, v75
    v_mul_f32 v84, v77, v77
    v_add_f32 v85, v76, v76
    v_fma_f32 v78, v76, v76, -v84
    v_mul_f32 v79, v85, v77
    v_mul_f32 v84, v79, v79
    v_add_f32 v85, v78, v78
    v_fma_f32 v80, v78, v78, -v84
    v_mul_f32 v81, v85, v79
    v_mul_f32 v82, v64, v44
    v_mul_f32 v83, v65, v44
    v_exp_f32 v82, v82
    v_fract_f32 v83, v83
    v_cos_f32 v68, v83
    v_sin_f32 v69, v83
    v_mul_f32 v68, v68, v82
    v_mul_f32 v69, v69, v82
    v_mul_f32 v84, v67, v69
    v_mul_f32 v85, v67, v68
    v_fma_f32 v68, v66, v68, -v84
    v_fma_f32 v69, -v66, v69, -v85
    v_mul_f32 v82, v64, v45
    v_mul_f32 v83, v65, v45
    v_exp_f32 v82, v82
    v_fract_f32 v83, v83
    v_cos_f32 v70, v83
    v_sin_f32 v71, v83
    v_mul_f32 v70, v70, v82
    v_mul_f32 v71, v71, v82
    v_mul_f32 v84, v67, v71
    v_mul_f32 v85, v67, v70
    v_fma_f32 v70, v66, v70, -v84
    v_fma_f32 v71, -v66, v71, -v85
    v_mul_f32 v82, v64, v46
    v_mul_f32 v83, v65, v46
    v_exp_f32 v82, v82
    v_fract_f32 v83, v83
    v_cos_f32 v72, v83
    v_sin_f32 v73, v83
    v_mul_f32 v72, v72, v82
    v_mul_f32 v73, v73, v82
    v_mul_f32 v84, v67, v73
    v_mul_f32 v85, v67, v72
    v_fma_f32 v72, v66, v72, -v84
    v_fma_f32 v73, -v66, v73, -v85
    v_mfma_f32_16x16x4_f32 v[48:51], v68, v74, v[48:51]
    v_mfma_f32_16x16x4_f32 v[52:55], v70, v76, v[52:55]
    v_mfma_f32_16x16x4_f32 v[56:59], v70, v78, v[56:59]
    v_mfma_f32_16x16x4_f32 v[60:63], v72, v80, v[60:63]
    v_mfma_f32_16x16x4_f32 v[48:51], v69, v75, v[48:51]
    v_mfma_f32_16x16x4_f32 v[52:55], v71, v77, v[52:55]
    v_mfma_f32_16x16x4_f32 v[56:59], v71, v79, v[56:59]
    v_mfma_f32_16x16x4_f32 v[60:63], v73, v81, v[60:63]
    v_mov_b32_dpp v64, v28 row_newbcast:6 row_mask:0xf bank_mask:0xf
    v_mov_b32_dpp v65, v29 row_newbcast:6 row_mask:0xf bank_mask:0xf
    v_mov_b32_dpp v66, v30 row_newbcast:6 row_mask:0xf bank_mask:0xf
    v_mov_b32_dpp v67, v31 row_newbcast:6 row_mask:0xf bank_mask:0xf
    v_mul_f32 v82, v64, v47
    v_mul_f32 v83, v65, v47
    v_exp_f32 v82, v82
    v_fract_f32 v83, v83
    v_cos_f32 v74, v83
    v_sin_f32 v75, v83
    v_mul_f32 v74, v74, v82
    v_mul_f32 v75, v75, v82
    v_mul_f32 v84, v75, v75
    v_add_f32 v85, v74, v74
    v_fma_f32 v76, v74, v74, -v84
    v_mul_f32 v77, v85, v75
    v_mul_f32 v84, v77, v77
    v_add_f32 v85, v76, v76
    v_fma_f32 v78, v76, v76, -v84
    v_mul_f32 v79, v85, v77
    v_mul_f32 v84, v79, v79
    v_add_f32 v85, v78, v78
    v_fma_f32 v80, v78, v78, -v84
    v_mul_f32 v81, v85, v79
    v_mul_f32 v82, v64, v44
    v_mul_f32 v83, v65, v44
    v_exp_f32 v82, v82
    v_fract_f32 v83, v83
    v_cos_f32 v68, v83
    v_sin_f32 v69, v83
    v_mul_f32 v68, v68, v82
    v_mul_f32 v69, v69, v82
    v_mul_f32 v84, v67, v69
    v_mul_f32 v85, v67, v68
    v_fma_f32 v68, v66, v68, -v84
    v_fma_f32 v69, -v66, v69, -v85
    v_mul_f32 v82, v64, v45
    v_mul_f32 v83, v65, v45
    v_exp_f32 v82, v82
    v_fract_f32 v83, v83
    v_cos_f32 v70, v83
    v_sin_f32 v71, v83
    v_mul_f32 v70, v70, v82
    v_mul_f32 v71, v71, v82
    v_mul_f32 v84, v67, v71
    v_mul_f32 v85, v67, v70
    v_fma_f32 v70, v66, v70, -v84
    v_fma_f32 v71, -v66, v71, -v85
    v_mul_f32 v82, v64, v46
    v_mul_f32 v83, v65, v46
    v_exp_f32 v82, v82
    v_fract_f32 v83, v83
    v_cos_f32 v72, v83
    v_sin_f32 v73, v83
    v_mul_f32 v72, v72, v82
    v_mul_f32 v73, v73, v82
    v_mul_f32 v84, v67, v73
    v_mul_f32 v85, v67, v72
    v_fma_f32 v72, v66, v72, -v84
    v_fma_f32 v73, -v66, v73, -v85
    v_mfma_f32_16x16x4_f32 v[48:51], v68, v74, v[48:51]
    v_mfma_f32_16x16x4_f32 v[52:55], v70, v76, v[52:55]
    v_mfma_f32_16x16x4_f32 v[56:59], v70, v78, v[56:59]
    v_mfma_f32_16x16x4_f32 v[60:63], v72, v80, v[60:63]
    v_mfma_f32_16x16x4_f32 v[48:51], v69, v75, v[48:51]
    v_mfma_f32_16x16x4_f32 v[52:55], v71, v77, v[52:55]
    v_mfma_f32_16x16x4_f32 v[56:59], v71, v79, v[56:59]
    v_mfma_f32_16x16x4_f32 v[60:63], v73, v81, v[60:63]
    v_mov_b32_dpp v64, v28 row_newbcast:7 row_mask:0xf bank_mask:0xf
    v_mov_b32_dpp v65, v29 row_newbcast:7 row_mask:0xf bank_mask:0xf
    v_mov_b32_dpp v66, v30 row_newbcast:7 row_mask:0xf bank_mask:0xf
    v_mov_b32_dpp v67, v31 row_newbcast:7 row_mask:0xf bank_mask:0xf
    v_mul_f32 v82, v64, v47
    v_mul_f32 v83, v65, v47
    v_exp_f32 v82, v82
    v_fract_f32 v83, v83
    v_cos_f32 v74, v83
    v_sin_f32 v75, v83
    v_mul_f32 v74, v74, v82
    v_mul_f32 v75, v75, v82
    v_mul_f32 v84, v75, v75
    v_add_f32 v85, v74, v74
    v_fma_f32 v76, v74, v74, -v84
    v_mul_f32 v77, v85, v75
    v_mul_f32 v84, v77, v77
    v_add_f32 v85, v76, v76
    v_fma_f32 v78, v76, v76, -v84
    v_mul_f32 v79, v85, v77
    v_mul_f32 v84, v79, v79
    v_add_f32 v85, v78, v78
    v_fma_f32 v80, v78, v78, -v84
    v_mul_f32 v81, v85, v79
    v_mul_f32 v82, v64, v44
    v_mul_f32 v83, v65, v44
    v_exp_f32 v82, v82
    v_fract_f32 v83, v83
    v_cos_f32 v68, v83
    v_sin_f32 v69, v83
    v_mul_f32 v68, v68, v82
    v_mul_f32 v69, v69, v82
    v_mul_f32 v84, v67, v69
    v_mul_f32 v85, v67, v68
    v_fma_f32 v68, v66, v68, -v84
    v_fma_f32 v69, -v66, v69, -v85
    v_mul_f32 v82, v64, v45
    v_mul_f32 v83, v65, v45
    v_exp_f32 v82, v82
    v_fract_f32 v83, v83
    v_cos_f32 v70, v83
    v_sin_f32 v71, v83
    v_mul_f32 v70, v70, v82
    v_mul_f32 v71, v71, v82
    v_mul_f32 v84, v67, v71
    v_mul_f32 v85, v67, v70
    v_fma_f32 v70, v66, v70, -v84
    v_fma_f32 v71, -v66, v71, -v85
    v_mul_f32 v82, v64, v46
    v_mul_f32 v83, v65, v46
    v_exp_f32 v82, v82
    v_fract_f32 v83, v83
    v_cos_f32 v72, v83
    v_sin_f32 v73, v83
    v_mul_f32 v72, v72, v82
    v_mul_f32 v73, v73, v82
    v_mul_f32 v84, v67, v73
    v_mul_f32 v85, v67, v72
    v_fma_f32 v72, v66, v72, -v84
    v_fma_f32 v73, -v66, v73, -v85
    v_mfma_f32_16x16x4_f32 v[48:51], v68, v74, v[48:51]
    v_mfma_f32_16x16x4_f32 v[52:55], v70, v76, v[52:55]
    v_mfma_f32_16x16x4_f32 v[56:59], v70, v78, v[56:59]
    v_mfma_f32_16x16x4_f32 v[60:63], v72, v80, v[60:63]
    v_mfma_f32_16x16x4_f32 v[48:51], v69, v75, v[48:51]
    v_mfma_f32_16x16x4_f32 v[52:55], v71, v77, v[52:55]
    v_mfma_f32_16x16x4_f32 v[56:59], v71, v79, v[56:59]
    v_mfma_f32_16x16x4_f32 v[60:63], v73, v81, v[60:63]
    v_mov_b32_dpp v64, v28 row_newbcast:8 row_mask:0xf bank_mask:0xf
    v_mov_b32_dpp v65, v29 row_newbcast:8 row_mask:0xf bank_mask:0xf
    v_mov_b32_dpp v66, v30 row_newbcast:8 row_mask:0xf bank_mask:0xf
    v_mov_b32_dpp v67, v31 row_newbcast:8 row_mask:0xf bank_mask:0xf
    v_mul_f32 v82, v64, v47
    v_mul_f32 v83, v65, v47
    v_exp_f32 v82, v82
    v_fract_f32 v83, v83
    v_cos_f32 v74, v83
    v_sin_f32 v75, v83
    v_mul_f32 v74, v74, v82
    v_mul_f32 v75, v75, v82
    v_mul_f32 v84, v75, v75
    v_add_f32 v85, v74, v74
    v_fma_f32 v76, v74, v74, -v84
    v_mul_f32 v77, v85, v75
    v_mul_f32 v84, v77, v77
    v_add_f32 v85, v76, v76
    v_fma_f32 v78, v76, v76, -v84
    v_mul_f32 v79, v85, v77
    v_mul_f32 v84, v79, v79
    v_add_f32 v85, v78, v78
    v_fma_f32 v80, v78, v78, -v84
    v_mul_f32 v81, v85, v79
    v_mul_f32 v82, v64, v44
    v_mul_f32 v83, v65, v44
    v_exp_f32 v82, v82
    v_fract_f32 v83, v83
    v_cos_f32 v68, v83
    v_sin_f32 v69, v83
    v_mul_f32 v68, v68, v82
    v_mul_f32 v69, v69, v82
    v_mul_f32 v84, v67, v69
    v_mul_f32 v85, v67, v68
    v_fma_f32 v68, v66, v68, -v84
    v_fma_f32 v69, -v66, v69, -v85
    v_mul_f32 v82, v64, v45
    v_mul_f32 v83, v65, v45
    v_exp_f32 v82, v82
    v_fract_f32 v83, v83
    v_cos_f32 v70, v83
    v_sin_f32 v71, v83
    v_mul_f32 v70, v70, v82
    v_mul_f32 v71, v71, v82
    v_mul_f32 v84, v67, v71
    v_mul_f32 v85, v67, v70
    v_fma_f32 v70, v66, v70, -v84
    v_fma_f32 v71, -v66, v71, -v85
    v_mul_f32 v82, v64, v46
    v_mul_f32 v83, v65, v46
    v_exp_f32 v82, v82
    v_fract_f32 v83, v83
    v_cos_f32 v72, v83
    v_sin_f32 v73, v83
    v_mul_f32 v72, v72, v82
    v_mul_f32 v73, v73, v82
    v_mul_f32 v84, v67, v73
    v_mul_f32 v85, v67, v72
    v_fma_f32 v72, v66, v72, -v84
    v_fma_f32 v73, -v66, v73, -v85
    v_mfma_f32_16x16x4_f32 v[48:51], v68, v74, v[48:51]
    v_mfma_f32_16x16x4_f32 v[52:55], v70, v76, v[52:55]
    v_mfma_f32_16x16x4_f32 v[56:59], v70, v78, v[56:59]
    v_mfma_f32_16x16x4_f32 v[60:63], v72, v80, v[60:63]
    v_mfma_f32_16x16x4_f32 v[48:51], v69, v75, v[48:51]
    v_mfma_f32_16x16x4_f32 v[52:55], v71, v77, v[52:55]
    v_mfma_f32_16x16x4_f32 v[56:59], v71, v79, v[56:59]
    v_mfma_f32_16x16x4_f32 v[60:63], v73, v81, v[60:63]
    v_mov_b32_dpp v64, v28 row_newbcast:9 row_mask:0xf bank_mask:0xf
    v_mov_b32_dpp v65, v29 row_newbcast:9 row_mask:0xf bank_mask:0xf
    v_mov_b32_dpp v66, v30 row_newbcast:9 row_mask:0xf bank_mask:0xf
    v_mov_b32_dpp v67, v31 row_newbcast:9 row_mask:0xf bank_mask:0xf
    v_mul_f32 v82, v64, v47
    v_mul_f32 v83, v65, v47
    v_exp_f32 v82, v82
    v_fract_f32 v83, v83
    v_cos_f32 v74, v83
    v_sin_f32 v75, v83
    v_mul_f32 v74, v74, v82
    v_mul_f32 v75, v75, v82
    v_mul_f32 v84, v75, v75
    v_add_f32 v85, v74, v74
    v_fma_f32 v76, v74, v74, -v84
    v_mul_f32 v77, v85, v75
    v_mul_f32 v84, v77, v77
    v_add_f32 v85, v76, v76
    v_fma_f32 v78, v76, v76, -v84
    v_mul_f32 v79, v85, v77
    v_mul_f32 v84, v79, v79
    v_add_f32 v85, v78, v78
    v_fma_f32 v80, v78, v78, -v84
    v_mul_f32 v81, v85, v79
    v_mul_f32 v82, v64, v44
    v_mul_f32 v83, v65, v44
    v_exp_f32 v82, v82
    v_fract_f32 v83, v83
    v_cos_f32 v68, v83
    v_sin_f32 v69, v83
    v_mul_f32 v68, v68, v82
    v_mul_f32 v69, v69, v82
    v_mul_f32 v84, v67, v69
    v_mul_f32 v85, v67, v68
    v_fma_f32 v68, v66, v68, -v84
    v_fma_f32 v69, -v66, v69, -v85
    v_mul_f32 v82, v64, v45
    v_mul_f32 v83, v65, v45
    v_exp_f32 v82, v82
    v_fract_f32 v83, v83
    v_cos_f32 v70, v83
    v_sin_f32 v71, v83
    v_mul_f32 v70, v70, v82
    v_mul_f32 v71, v71, v82
    v_mul_f32 v84, v67, v71
    v_mul_f32 v85, v67, v70
    v_fma_f32 v70, v66, v70, -v84
    v_fma_f32 v71, -v66, v71, -v85
    v_mul_f32 v82, v64, v46
    v_mul_f32 v83, v65, v46
    v_exp_f32 v82, v82
    v_fract_f32 v83, v83
    v_cos_f32 v72, v83
    v_sin_f32 v73, v83
    v_mul_f32 v72, v72, v82
    v_mul_f32 v73, v73, v82
    v_mul_f32 v84, v67, v73
    v_mul_f32 v85, v67, v72
    v_fma_f32 v72, v66, v72, -v84
    v_fma_f32 v73, -v66, v73, -v85
    v_mfma_f32_16x16x4_f32 v[48:51], v68, v74, v[48:51]
    v_mfma_f32_16x16x4_f32 v[52:55], v70, v76, v[52:55]
    v_mfma_f32_16x16x4_f32 v[56:59], v70, v78, v[56:59]
    v_mfma_f32_16x16x4_f32 v[60:63], v72, v80, v[60:63]
    v_mfma_f32_16x16x4_f32 v[48:51], v69, v75, v[48:51]
    v_mfma_f32_16x16x4_f32 v[52:55], v71, v77, v[52:55]
    v_mfma_f32_16x16x4_f32 v[56:59], v71, v79, v[56:59]
    v_mfma_f32_16x16x4_f32 v[60:63], v73, v81, v[60:63]
    v_mov_b32_dpp v64, v28 row_newbcast:10 row_mask:0xf bank_mask:0xf
    v_mov_b32_dpp v65, v29 row_newbcast:10 row_mask:0xf bank_mask:0xf
    v_mov_b32_dpp v66, v30 row_newbcast:10 row_mask:0xf bank_mask:0xf
    v_mov_b32_dpp v67, v31 row_newbcast:10 row_mask:0xf bank_mask:0xf
    v_mul_f32 v82, v64, v47
    v_mul_f32 v83, v65, v47
    v_exp_f32 v82, v82
    v_fract_f32 v83, v83
    v_cos_f32 v74, v83
    v_sin_f32 v75, v83
    v_mul_f32 v74, v74, v82
    v_mul_f32 v75, v75, v82
    v_mul_f32 v84, v75, v75
    v_add_f32 v85, v74, v74
    v_fma_f32 v76, v74, v74, -v84
    v_mul_f32 v77, v85, v75
    v_mul_f32 v84, v77, v77
    v_add_f32 v85, v76, v76
    v_fma_f32 v78, v76, v76, -v84
    v_mul_f32 v79, v85, v77
    v_mul_f32 v84, v79, v79
    v_add_f32 v85, v78, v78
    v_fma_f32 v80, v78, v78, -v84
    v_mul_f32 v81, v85, v79
    v_mul_f32 v82, v64, v44
    v_mul_f32 v83, v65, v44
    v_exp_f32 v82, v82
    v_fract_f32 v83, v83
    v_cos_f32 v68, v83
    v_sin_f32 v69, v83
    v_mul_f32 v68, v68, v82
    v_mul_f32 v69, v69, v82
    v_mul_f32 v84, v67, v69
    v_mul_f32 v85, v67, v68
    v_fma_f32 v68, v66, v68, -v84
    v_fma_f32 v69, -v66, v69, -v85
    v_mul_f32 v82, v64, v45
    v_mul_f32 v83, v65, v45
    v_exp_f32 v82, v82
    v_fract_f32 v83, v83
    v_cos_f32 v70, v83
    v_sin_f32 v71, v83
    v_mul_f32 v70, v70, v82
    v_mul_f32 v71, v71, v82
    v_mul_f32 v84, v67, v71
    v_mul_f32 v85, v67, v70
    v_fma_f32 v70, v66, v70, -v84
    v_fma_f32 v71, -v66, v71, -v85
    v_mul_f32 v82, v64, v46
    v_mul_f32 v83, v65, v46
    v_exp_f32 v82, v82
    v_fract_f32 v83, v83
    v_cos_f32 v72, v83
    v_sin_f32 v73, v83
    v_mul_f32 v72, v72, v82
    v_mul_f32 v73, v73, v82
    v_mul_f32 v84, v67, v73
    v_mul_f32 v85, v67, v72
    v_fma_f32 v72, v66, v72, -v84
    v_fma_f32 v73, -v66, v73, -v85
    v_mfma_f32_16x16x4_f32 v[48:51], v68, v74, v[48:51]
    v_mfma_f32_16x16x4_f32 v[52:55], v70, v76, v[52:55]
    v_mfma_f32_16x16x4_f32 v[56:59], v70, v78, v[56:59]
    v_mfma_f32_16x16x4_f32 v[60:63], v72, v80, v[60:63]
    v_mfma_f32_16x16x4_f32 v[48:51], v69, v75, v[48:51]
    v_mfma_f32_16x16x4_f32 v[52:55], v71, v77, v[52:55]
    v_mfma_f32_16x16x4_f32 v[56:59], v71, v79, v[56:59]
    v_mfma_f32_16x16x4_f32 v[60:63], v73, v81, v[60:63]
    v_mov_b32_dpp v64, v28 row_newbcast:11 row_mask:0xf bank_mask:0xf
    v_mov_b32_dpp v65, v29 row_newbcast:11 row_mask:0xf bank_mask:0xf
    v_mov_b32_dpp v66, v30 row_newbcast:11 row_mask:0xf bank_mask:0xf
    v_mov_b32_dpp v67, v31 row_newbcast:11 row_mask:0xf bank_mask:0xf
    v_mul_f32 v82, v64, v47
    v_mul_f32 v83, v65, v47
    v_exp_f32 v82, v82
    v_fract_f32 v83, v83
    v_cos_f32 v74, v83
    v_sin_f32 v75, v83
    v_mul_f32 v74, v74, v82
    v_mul_f32 v75, v75, v82
    v_mul_f32 v84, v75, v75
    v_add_f32 v85, v74, v74
    v_fma_f32 v76, v74, v74, -v84
    v_mul_f32 v77, v85, v75
    v_mul_f32 v84, v77, v77
    v_add_f32 v85, v76, v76
    v_fma_f32 v78, v76, v76, -v84
    v_mul_f32 v79, v85, v77
    v_mul_f32 v84, v79, v79
    v_add_f32 v85, v78, v78
    v_fma_f32 v80, v78, v78, -v84
    v_mul_f32 v81, v85, v79
    v_mul_f32 v82, v64, v44
    v_mul_f32 v83, v65, v44
    v_exp_f32 v82, v82
    v_fract_f32 v83, v83
    v_cos_f32 v68, v83
    v_sin_f32 v69, v83
    v_mul_f32 v68, v68, v82
    v_mul_f32 v69, v69, v82
    v_mul_f32 v84, v67, v69
    v_mul_f32 v85, v67, v68
    v_fma_f32 v68, v66, v68, -v84
    v_fma_f32 v69, -v66, v69, -v85
    v_mul_f32 v82, v64, v45
    v_mul_f32 v83, v65, v45
    v_exp_f32 v82, v82
    v_fract_f32 v83, v83
    v_cos_f32 v70, v83
    v_sin_f32 v71, v83
    v_mul_f32 v70, v70, v82
    v_mul_f32 v71, v71, v82
    v_mul_f32 v84, v67, v71
    v_mul_f32 v85, v67, v70
    v_fma_f32 v70, v66, v70, -v84
    v_fma_f32 v71, -v66, v71, -v85
    v_mul_f32 v82, v64, v46
    v_mul_f32 v83, v65, v46
    v_exp_f32 v82, v82
    v_fract_f32 v83, v83
    v_cos_f32 v72, v83
    v_sin_f32 v73, v83
    v_mul_f32 v72, v72, v82
    v_mul_f32 v73, v73, v82
    v_mul_f32 v84, v67, v73
    v_mul_f32 v85, v67, v72
    v_fma_f32 v72, v66, v72, -v84
    v_fma_f32 v73, -v66, v73, -v85
    v_mfma_f32_16x16x4_f32 v[48:51], v68, v74, v[48:51]
    v_mfma_f32_16x16x4_f32 v[52:55], v70, v76, v[52:55]
    v_mfma_f32_16x16x4_f32 v[56:59], v70, v78, v[56:59]
    v_mfma_f32_16x16x4_f32 v[60:63], v72, v80, v[60:63]
    v_mfma_f32_16x16x4_f32 v[48:51], v69, v75, v[48:51]
    v_mfma_f32_16x16x4_f32 v[52:55], v71, v77, v[52:55]
    v_mfma_f32_16x16x4_f32 v[56:59], v71, v79, v[56:59]
    v_mfma_f32_16x16x4_f32 v[60:63], v73, v81, v[60:63]
    v_mov_b32_dpp v64, v28 row_newbcast:12 row_mask:0xf bank_mask:0xf
    v_mov_b32_dpp v65, v29 row_newbcast:12 row_mask:0xf bank_mask:0xf
    v_mov_b32_dpp v66, v30 row_newbcast:12 row_mask:0xf bank_mask:0xf
    v_mov_b32_dpp v67, v31 row_newbcast:12 row_mask:0xf bank_mask:0xf
    v_mul_f32 v82, v64, v47
    v_mul_f32 v83, v65, v47
    v_exp_f32 v82, v82
    v_fract_f32 v83, v83
    v_cos_f32 v74, v83
    v_sin_f32 v75, v83
    v_mul_f32 v74, v74, v82
    v_mul_f32 v75, v75, v82
    v_mul_f32 v84, v75, v75
    v_add_f32 v85, v74, v74
    v_fma_f32 v76, v74, v74, -v84
    v_mul_f32 v77, v85, v75
    v_mul_f32 v84, v77, v77
    v_add_f32 v85, v76, v76
    v_fma_f32 v78, v76, v76, -v84
    v_mul_f32 v79, v85, v77
    v_mul_f32 v84, v79, v79
    v_add_f32 v85, v78, v78
    v_fma_f32 v80, v78, v78, -v84
    v_mul_f32 v81, v85, v79
    v_mul_f32 v82, v64, v44
    v_mul_f32 v83, v65, v44
    v_exp_f32 v82, v82
    v_fract_f32 v83, v83
    v_cos_f32 v68, v83
    v_sin_f32 v69, v83
    v_mul_f32 v68, v68, v82
    v_mul_f32 v69, v69, v82
    v_mul_f32 v84, v67, v69
    v_mul_f32 v85, v67, v68
    v_fma_f32 v68, v66, v68, -v84
    v_fma_f32 v69, -v66, v69, -v85
    v_mul_f32 v82, v64, v45
    v_mul_f32 v83, v65, v45
    v_exp_f32 v82, v82
    v_fract_f32 v83, v83
    v_cos_f32 v70, v83
    v_sin_f32 v71, v83
    v_mul_f32 v70, v70, v82
    v_mul_f32 v71, v71, v82
    v_mul_f32 v84, v67, v71
    v_mul_f32 v85, v67, v70
    v_fma_f32 v70, v66, v70, -v84
    v_fma_f32 v71, -v66, v71, -v85
    v_mul_f32 v82, v64, v46
    v_mul_f32 v83, v65, v46
    v_exp_f32 v82, v82
    v_fract_f32 v83, v83
    v_cos_f32 v72, v83
    v_sin_f32 v73, v83
    v_mul_f32 v72, v72, v82
    v_mul_f32 v73, v73, v82
    v_mul_f32 v84, v67, v73
    v_mul_f32 v85, v67, v72
    v_fma_f32 v72, v66, v72, -v84
    v_fma_f32 v73, -v66, v73, -v85
    v_mfma_f32_16x16x4_f32 v[48:51], v68, v74, v[48:51]
    v_mfma_f32_16x16x4_f32 v[52:55], v70, v76, v[52:55]
    v_mfma_f32_16x16x4_f32 v[56:59], v70, v78, v[56:59]
    v_mfma_f32_16x16x4_f32 v[60:63], v72, v80, v[60:63]
    v_mfma_f32_16x16x4_f32 v[48:51], v69, v75, v[48:51]
    v_mfma_f32_16x16x4_f32 v[52:55], v71, v77, v[52:55]
    v_mfma_f32_16x16x4_f32 v[56:59], v71, v79, v[56:59]
    v_mfma_f32_16x16x4_f32 v[60:63], v73, v81, v[60:63]
    v_mov_b32_dpp v64, v28 row_newbcast:13 row_mask:0xf bank_mask:0xf
    v_mov_b32_dpp v65, v29 row_newbcast:13 row_mask:0xf bank_mask:0xf
    v_mov_b32_dpp v66, v30 row_newbcast:13 row_mask:0xf bank_mask:0xf
    v_mov_b32_dpp v67, v31 row_newbcast:13 row_mask:0xf bank_mask:0xf
    v_mul_f32 v82, v64, v47
    v_mul_f32 v83, v65, v47
    v_exp_f32 v82, v82
    v_fract_f32 v83, v83
    v_cos_f32 v74, v83
    v_sin_f32 v75, v83
    v_mul_f32 v74, v74, v82
    v_mul_f32 v75, v75, v82
    v_mul_f32 v84, v75, v75
    v_add_f32 v85, v74, v74
    v_fma_f32 v76, v74, v74, -v84
    v_mul_f32 v77, v85, v75
    v_mul_f32 v84, v77, v77
    v_add_f32 v85, v76, v76
    v_fma_f32 v78, v76, v76, -v84
    v_mul_f32 v79, v85, v77
    v_mul_f32 v84, v79, v79
    v_add_f32 v85, v78, v78
    v_fma_f32 v80, v78, v78, -v84
    v_mul_f32 v81, v85, v79
    v_mul_f32 v82, v64, v44
    v_mul_f32 v83, v65, v44
    v_exp_f32 v82, v82
    v_fract_f32 v83, v83
    v_cos_f32 v68, v83
    v_sin_f32 v69, v83
    v_mul_f32 v68, v68, v82
    v_mul_f32 v69, v69, v82
    v_mul_f32 v84, v67, v69
    v_mul_f32 v85, v67, v68
    v_fma_f32 v68, v66, v68, -v84
    v_fma_f32 v69, -v66, v69, -v85
    v_mul_f32 v82, v64, v45
    v_mul_f32 v83, v65, v45
    v_exp_f32 v82, v82
    v_fract_f32 v83, v83
    v_cos_f32 v70, v83
    v_sin_f32 v71, v83
    v_mul_f32 v70, v70, v82
    v_mul_f32 v71, v71, v82
    v_mul_f32 v84, v67, v71
    v_mul_f32 v85, v67, v70
    v_fma_f32 v70, v66, v70, -v84
    v_fma_f32 v71, -v66, v71, -v85
    v_mul_f32 v82, v64, v46
    v_mul_f32 v83, v65, v46
    v_exp_f32 v82, v82
    v_fract_f32 v83, v83
    v_cos_f32 v72, v83
    v_sin_f32 v73, v83
    v_mul_f32 v72, v72, v82
    v_mul_f32 v73, v73, v82
    v_mul_f32 v84, v67, v73
    v_mul_f32 v85, v67, v72
    v_fma_f32 v72, v66, v72, -v84
    v_fma_f32 v73, -v66, v73, -v85
    v_mfma_f32_16x16x4_f32 v[48:51], v68, v74, v[48:51]
    v_mfma_f32_16x16x4_f32 v[52:55], v70, v76, v[52:55]
    v_mfma_f32_16x16x4_f32 v[56:59], v70, v78, v[56:59]
    v_mfma_f32_16x16x4_f32 v[60:63], v72, v80, v[60:63]
    v_mfma_f32_16x16x4_f32 v[48:51], v69, v75, v[48:51]
    v_mfma_f32_16x16x4_f32 v[52:55], v71, v77, v[52:55]
    v_mfma_f32_16x16x4_f32 v[56:59], v71, v79, v[56:59]
    v_mfma_f32_16x16x4_f32 v[60:63], v73, v81, v[60:63]
    v_mov_b32_dpp v64, v28 row_newbcast:14 row_mask:0xf bank_mask:0xf
    v_mov_b32_dpp v65, v29 row_newbcast:14 row_mask:0xf bank_mask:0xf
    v_mov_b32_dpp v66, v30 row_newbcast:14 row_mask:0xf bank_mask:0xf
    v_mov_b32_dpp v67, v31 row_newbcast:14 row_mask:0xf bank_mask:0xf
    v_mul_f32 v82, v64, v47
    v_mul_f32 v83, v65, v47
    v_exp_f32 v82, v82
    v_fract_f32 v83, v83
    v_cos_f32 v74, v83
    v_sin_f32 v75, v83
    v_mul_f32 v74, v74, v82
    v_mul_f32 v75, v75, v82
    v_mul_f32 v84, v75, v75
    v_add_f32 v85, v74, v74
    v_fma_f32 v76, v74, v74, -v84
    v_mul_f32 v77, v85, v75
    v_mul_f32 v84, v77, v77
    v_add_f32 v85, v76, v76
    v_fma_f32 v78, v76, v76, -v84
    v_mul_f32 v79, v85, v77
    v_mul_f32 v84, v79, v79
    v_add_f32 v85, v78, v78
    v_fma_f32 v80, v78, v78, -v84
    v_mul_f32 v81, v85, v79
    v_mul_f32 v82, v64, v44
    v_mul_f32 v83, v65, v44
    v_exp_f32 v82, v82
    v_fract_f32 v83, v83
    v_cos_f32 v68, v83
    v_sin_f32 v69, v83
    v_mul_f32 v68, v68, v82
    v_mul_f32 v69, v69, v82
    v_mul_f32 v84, v67, v69
    v_mul_f32 v85, v67, v68
    v_fma_f32 v68, v66, v68, -v84
    v_fma_f32 v69, -v66, v69, -v85
    v_mul_f32 v82, v64, v45
    v_mul_f32 v83, v65, v45
    v_exp_f32 v82, v82
    v_fract_f32 v83, v83
    v_cos_f32 v70, v83
    v_sin_f32 v71, v83
    v_mul_f32 v70, v70, v82
    v_mul_f32 v71, v71, v82
    v_mul_f32 v84, v67, v71
    v_mul_f32 v85, v67, v70
    v_fma_f32 v70, v66, v70, -v84
    v_fma_f32 v71, -v66, v71, -v85
    v_mul_f32 v82, v64, v46
    v_mul_f32 v83, v65, v46
    v_exp_f32 v82, v82
    v_fract_f32 v83, v83
    v_cos_f32 v72, v83
    v_sin_f32 v73, v83
    v_mul_f32 v72, v72, v82
    v_mul_f32 v73, v73, v82
    v_mul_f32 v84, v67, v73
    v_mul_f32 v85, v67, v72
    v_fma_f32 v72, v66, v72, -v84
    v_fma_f32 v73, -v66, v73, -v85
    v_mfma_f32_16x16x4_f32 v[48:51], v68, v74, v[48:51]
    v_mfma_f32_16x16x4_f32 v[52:55], v70, v76, v[52:55]
    v_mfma_f32_16x16x4_f32 v[56:59], v70, v78, v[56:59]
    v_mfma_f32_16x16x4_f32 v[60:63], v72, v80, v[60:63]
    v_mfma_f32_16x16x4_f32 v[48:51], v69, v75, v[48:51]
    v_mfma_f32_16x16x4_f32 v[52:55], v71, v77, v[52:55]
    v_mfma_f32_16x16x4_f32 v[56:59], v71, v79, v[56:59]
    v_mfma_f32_16x16x4_f32 v[60:63], v73, v81, v[60:63]
    v_mov_b32_dpp v64, v28 row_newbcast:15 row_mask:0xf bank_mask:0xf
    v_mov_b32_dpp v65, v29 row_newbcast:15 row_mask:0xf bank_mask:0xf
    v_mov_b32_dpp v66, v30 row_newbcast:15 row_mask:0xf bank_mask:0xf
    v_mov_b32_dpp v67, v31 row_newbcast:15 row_mask:0xf bank_mask:0xf
    v_mul_f32 v82, v64, v47
    v_mul_f32 v83, v65, v47
    v_exp_f32 v82, v82
    v_fract_f32 v83, v83
    v_cos_f32 v74, v83
    v_sin_f32 v75, v83
    v_mul_f32 v74, v74, v82
    v_mul_f32 v75, v75, v82
    v_mul_f32 v84, v75, v75
    v_add_f32 v85, v74, v74
    v_fma_f32 v76, v74, v74, -v84
    v_mul_f32 v77, v85, v75
    v_mul_f32 v84, v77, v77
    v_add_f32 v85, v76, v76
    v_fma_f32 v78, v76, v76, -v84
    v_mul_f32 v79, v85, v77
    v_mul_f32 v84, v79, v79
    v_add_f32 v85, v78, v78
    v_fma_f32 v80, v78, v78, -v84
    v_mul_f32 v81, v85, v79
    v_mul_f32 v82, v64, v44
    v_mul_f32 v83, v65, v44
    v_exp_f32 v82, v82
    v_fract_f32 v83, v83
    v_cos_f32 v68, v83
    v_sin_f32 v69, v83
    v_mul_f32 v68, v68, v82
    v_mul_f32 v69, v69, v82
    v_mul_f32 v84, v67, v69
    v_mul_f32 v85, v67, v68
    v_fma_f32 v68, v66, v68, -v84
    v_fma_f32 v69, -v66, v69, -v85
    v_mul_f32 v82, v64, v45
    v_mul_f32 v83, v65, v45
    v_exp_f32 v82, v82
    v_fract_f32 v83, v83
    v_cos_f32 v70, v83
    v_sin_f32 v71, v83
    v_mul_f32 v70, v70, v82
    v_mul_f32 v71, v71, v82
    v_mul_f32 v84, v67, v71
    v_mul_f32 v85, v67, v70
    v_fma_f32 v70, v66, v70, -v84
    v_fma_f32 v71, -v66, v71, -v85
    v_mul_f32 v82, v64, v46
    v_mul_f32 v83, v65, v46
    v_exp_f32 v82, v82
    v_fract_f32 v83, v83
    v_cos_f32 v72, v83
    v_sin_f32 v73, v83
    v_mul_f32 v72, v72, v82
    v_mul_f32 v73, v73, v82
    v_mul_f32 v84, v67, v73
    v_mul_f32 v85, v67, v72
    v_fma_f32 v72, v66, v72, -v84
    v_fma_f32 v73, -v66, v73, -v85
    v_mfma_f32_16x16x4_f32 v[48:51], v68, v74, v[48:51]
    v_mfma_f32_16x16x4_f32 v[52:55], v70, v76, v[52:55]
    v_mfma_f32_16x16x4_f32 v[56:59], v70, v78, v[56:59]
    v_mfma_f32_16x16x4_f32 v[60:63], v72, v80, v[60:63]
    v_mfma_f32_16x16x4_f32 v[48:51], v69, v75, v[48:51]
    v_mfma_f32_16x16x4_f32 v[52:55], v71, v77, v[52:55]
    v_mfma_f32_16x16x4_f32 v[56:59], v71, v79, v[56:59]
    v_mfma_f32_16x16x4_f32 v[60:63], v73, v81, v[60:63]
    v_lshlrev_b32 v5, 8, v3
    v_lshl_add_u32 v5, v2, 2, v5
    v_add_u32 v5, v5, v4
    s_nop 5
    ds_write_b32 v5, v48 offset:4608
    ds_write_b32 v5, v49 offset:4672
    ds_write_b32 v5, v50 offset:4736
    ds_write_b32 v5, v51 offset:4800
    v_cmp_gt_u32 vcc, 2, v3
    s_nop 0
    s_mov_b64 exec, vcc
    ds_write_b32 v5, v52 offset:5632
    ds_write_b32 v5, v53 offset:5696
    ds_write_b32 v5, v54 offset:5760
    ds_write_b32 v5, v55 offset:5824
    ds_write_b32 v5, v60 offset:6656
    ds_write_b32 v5, v61 offset:6720
    ds_write_b32 v5, v62 offset:6784
    ds_write_b32 v5, v63 offset:6848
    s_not_b64 exec, exec
    ds_write_b32 v5, v56 offset:5632
    ds_write_b32 v5, v57 offset:5696
    ds_write_b32 v5, v58 offset:5760
    ds_write_b32 v5, v59 offset:5824
    s_mov_b32 exec_lo, 0
    s_mov_b32 exec_hi, 3
    v_cmp_eq_u32 vcc, 0, v2
    s_nop 1
    v_cndmask_b32 v6, 0, v60, vcc
    ds_write_b32 v5, v6 offset:6656
    s_mov_b64 exec, -1
    s_waitcnt lgkmcnt(0)
    v_lshlrev_b32 v7, 1, v1
    v_sub_u32 v7, 2065, v7
    v_lshl_add_u32 v64, v1, 2, v4
    v_mov_b32 v65, 641
    s_mov_b32 s25, 17
ss_exp:
    v_subrev_u32 v66, 0, v7
    v_cvt_f32_u32 v70, v66
    v_cvt_pk_bf16_f32 v70, v70, v70
    v_and_b32 v70, 0xffff, v70
    v_subrev_u32 v70, 0x4280, v70
    v_cmp_gt_u32 vcc, 256, v66
    s_nop 1
    v_cndmask_b32 v70, v70, v66, vcc
    v_cmp_gt_u32 vcc, 2048, v66
    s_nop 1
    v_cndmask_b32 v70, v65, v70, vcc
    v_lshl_add_u32 v70, v70, 2, v4
    ds_read_b32 v74, v70 offset:4608
    v_subrev_u32 v67, 1, v7
    v_cvt_f32_u32 v71, v67
    v_cvt_pk_bf16_f32 v71, v71, v71
    v_and_b32 v71, 0xffff, v71
    v_subrev_u32 v71, 0x4280, v71
    v_cmp_gt_u32 vcc, 256, v67
    s_nop 1
    v_cndmask_b32 v71, v71, v67, vcc
    v_cmp_gt_u32 vcc, 2048, v67
    s_nop 1
    v_cndmask_b32 v71, v65, v71, vcc
    v_lshl_add_u32 v71, v71, 2, v4
    ds_read_b32 v75, v71 offset:4608
    v_subrev_u32 v68, 2, v7
    v_cvt_f32_u32 v72, v68
    v_cvt_pk_bf16_f32 v72, v72, v72
    v_and_b32 v72, 0xffff, v72
    v_subrev_u32 v72, 0x4280, v72
    v_cmp_gt_u32 vcc, 256, v68
    s_nop 1
    v_cndmask_b32 v72, v72, v68, vcc
    v_cmp_gt_u32 vcc, 2048, v68
    s_nop 1
    v_cndmask_b32 v72, v65, v72, vcc
    v_lshl_add_u32 v72, v72, 2, v4
    ds_read_b32 v76, v72 offset:4608
    s_waitcnt lgkmcnt(0)
    v_cvt_pk_bf16_f32 v78, v75, v76
    v_cvt_pk_bf16_f32 v79, v74, v75
    ds_write_b32 v64, v78 offset:7424
    ds_write_b32 v64, v79 offset:11776
    v_subrev_u32 v7, 128, v7
    v_add_u32 v64, 256, v64
    s_sub_u32 s25, s25, 1
    s_cmp_lg_u32 s25, 0
    s_cbranch_scc1 ss_exp
    s_waitcnt lgkmcnt(0)
    s_barrier
    v_and_b32 v5, 1, v2
    v_mul_u32_u24 v64, 4352, v5
    v_sub_u32 v5, v5, v2
    v_lshl_add_u32 v5, v3, 3, v5
    v_lshl_add_u32 v64, v5, 1, v64
    v_add_u32 v64, 11520, v64
    v_add_u32 v64, v64, v4
    v_lshlrev_b32 v65, 5, v2
    v_lshl_add_u32 v65, v3, 4, v65
    v_add_u32 v65, 480, v65
    v_add_u32 v65, v65, v4
    v_mov_b32 v96, 0
    v_mov_b32 v97, 0
    v_mov_b32 v98, 0
    v_mov_b32 v99, 0
    v_mov_b32 v100, 0
    v_mov_b32 v101, 0
    v_mov_b32 v102, 0
    v_mov_b32 v103, 0
    v_mov_b32 v104, 0
    v_mov_b32 v105, 0
    v_mov_b32 v106, 0
    v_mov_b32 v107, 0
    v_mov_b32 v108, 0
    v_mov_b32 v109, 0
    v_mov_b32 v110, 0
    v_mov_b32 v111, 0
    v_mov_b32 v112, 0
    v_mov_b32 v113, 0
    v_mov_b32 v114, 0
    v_mov_b32 v115, 0
    v_mov_b32 v116, 0
    v_mov_b32 v117, 0
    v_mov_b32 v118, 0
    v_mov_b32 v119, 0
    v_mov_b32 v120, 0
    v_mov_b32 v121, 0
    v_mov_b32 v122, 0
    v_mov_b32 v123, 0
    v_mov_b32 v124, 0
    v_mov_b32 v125, 0
    v_mov_b32 v126, 0
    v_mov_b32 v127, 0
    s_mov_b32 s25, 8
ss_cv0:
    ds_read2_b32 v[68:69], v64 offset0:0 offset1:1
    ds_read2_b32 v[70:71], v64 offset0:2 offset1:3
    ds_read_b128 v[128:131], v65 offset:0
    ds_read_b128 v[132:135], v65 offset:512
    ds_read_b128 v[136:139], v65 offset:1024
    ds_read_b128 v[140:143], v65 offset:1536
    ds_read_b128 v[144:147], v65 offset:2048
    ds_read_b128 v[148:151], v65 offset:2560
    ds_read_b128 v[152:155], v65 offset:3072
    ds_read_b128 v[156:159], v65 offset:3584
    v_subrev_u32 v64, 64, v64
    v_subrev_u32 v65, 64, v65
    s_waitcnt lgkmcnt(7)
    v_mfma_f32_16x16x32_bf16 v[96:99], v[68:71], v[128:131], v[96:99]
    s_waitcnt lgkmcnt(6)
    v_mfma_f32_16x16x32_bf16 v[100:103], v[68:71], v[132:135], v[100:103]
    s_waitcnt lgkmcnt(5)
    v_mfma_f32_16x16x32_bf16 v[104:107], v[68:71], v[136:139], v[104:107]
    s_waitcnt lgkmcnt(4)
    v_mfma_f32_16x16x32_bf16 v[108:111], v[68:71], v[140:143], v[108:111]
    s_waitcnt lgkmcnt(3)
    v_mfma_f32_16x16x32_bf16 v[112:115], v[68:71], v[144:147], v[112:115]
    s_waitcnt lgkmcnt(2)
    v_mfma_f32_16x16x32_bf16 v[116:119], v[68:71], v[148:151], v[116:119]
    s_waitcnt lgkmcnt(1)
    v_mfma_f32_16x16x32_bf16 v[120:123], v[68:71], v[152:155], v[120:123]
    s_waitcnt lgkmcnt(0)
    v_mfma_f32_16x16x32_bf16 v[124:127], v[68:71], v[156:159], v[124:127]
    s_sub_u32 s25, s25, 1
    s_cmp_lg_u32 s25, 0
    s_cbranch_scc1 ss_cv0
    v_add_u32 v65, 512, v65
    s_mov_b32 s25, 8
ss_cv1:
    ds_read2_b32 v[68:69], v64 offset0:0 offset1:1
    ds_read2_b32 v[70:71], v64 offset0:2 offset1:3
    ds_read_b128 v[132:135], v65 offset:0
    ds_read_b128 v[136:139], v65 offset:512
    ds_read_b128 v[140:143], v65 offset:1024
    ds_read_b128 v[144:147], v65 offset:1536
    ds_read_b128 v[148:151], v65 offset:2048
    ds_read_b128 v[152:155], v65 offset:2560
    ds_read_b128 v[156:159], v65 offset:3072
    v_subrev_u32 v64, 64, v64
    v_subrev_u32 v65, 64, v65
    s_waitcnt lgkmcnt(6)
    v_mfma_f32_16x16x32_bf16 v[100:103], v[68:71], v[132:135], v[100:103]
    s_waitcnt lgkmcnt(5)
    v_mfma_f32_16x16x32_bf16 v[104:107], v[68:71], v[136:139], v[104:107]
    s_waitcnt lgkmcnt(4)
    v_mfma_f32_16x16x32_bf16 v[108:111], v[68:71], v[140:143], v[108:111]
    s_waitcnt lgkmcnt(3)
    v_mfma_f32_16x16x32_bf16 v[112:115], v[68:71], v[144:147], v[112:115]
    s_waitcnt lgkmcnt(2)
    v_mfma_f32_16x16x32_bf16 v[116:119], v[68:71], v[148:151], v[116:119]
    s_waitcnt lgkmcnt(1)
    v_mfma_f32_16x16x32_bf16 v[120:123], v[68:71], v[152:155], v[120:123]
    s_waitcnt lgkmcnt(0)
    v_mfma_f32_16x16x32_bf16 v[124:127], v[68:71], v[156:159], v[124:127]
    s_sub_u32 s25, s25, 1
    s_cmp_lg_u32 s25, 0
    s_cbranch_scc1 ss_cv1
    v_add_u32 v65, 512, v65
    s_mov_b32 s25, 8
ss_cv2:
    ds_read2_b32 v[68:69], v64 offset0:0 offset1:1
    ds_read2_b32 v[70:71], v64 offset0:2 offset1:3
    ds_read_b128 v[136:139], v65 offset:0
    ds_read_b128 v[140:143], v65 offset:512
    ds_read_b128 v[144:147], v65 offset:1024
    ds_read_b128 v[148:151], v65 offset:1536
    ds_read_b128 v[152:155], v65 offset:2048
    ds_read_b128 v[156:159], v65 offset:2560
    v_subrev_u32 v64, 64, v64
    v_subrev_u32 v65, 64, v65
    s_waitcnt lgkmcnt(5)
    v_mfma_f32_16x16x32_bf16 v[104:107], v[68:71], v[136:139], v[104:107]
    s_waitcnt lgkmcnt(4)
    v_mfma_f32_16x16x32_bf16 v[108:111], v[68:71], v[140:143], v[108:111]
    s_waitcnt lgkmcnt(3)
    v_mfma_f32_16x16x32_bf16 v[112:115], v[68:71], v[144:147], v[112:115]
    s_waitcnt lgkmcnt(2)
    v_mfma_f32_16x16x32_bf16 v[116:119], v[68:71], v[148:151], v[116:119]
    s_waitcnt lgkmcnt(1)
    v_mfma_f32_16x16x32_bf16 v[120:123], v[68:71], v[152:155], v[120:123]
    s_waitcnt lgkmcnt(0)
    v_mfma_f32_16x16x32_bf16 v[124:127], v[68:71], v[156:159], v[124:127]
    s_sub_u32 s25, s25, 1
    s_cmp_lg_u32 s25, 0
    s_cbranch_scc1 ss_cv2
    v_add_u32 v65, 512, v65
    s_mov_b32 s25, 8
ss_cv3:
    ds_read2_b32 v[68:69], v64 offset0:0 offset1:1
    ds_read2_b32 v[70:71], v64 offset0:2 offset1:3
    ds_read_b128 v[140:143], v65 offset:0
    ds_read_b128 v[144:147], v65 offset:512
    ds_read_b128 v[148:151], v65 offset:1024
    ds_read_b128 v[152:155], v65 offset:1536
    ds_read_b128 v[156:159], v65 offset:2048
    v_subrev_u32 v64, 64, v64
    v_subrev_u32 v65, 64, v65
    s_waitcnt lgkmcnt(4)
    v_mfma_f32_16x16x32_bf16 v[108:111], v[68:71], v[140:143], v[108:111]
    s_waitcnt lgkmcnt(3)
    v_mfma_f32_16x16x32_bf16 v[112:115], v[68:71], v[144:147], v[112:115]
    s_waitcnt lgkmcnt(2)
    v_mfma_f32_16x16x32_bf16 v[116:119], v[68:71], v[148:151], v[116:119]
    s_waitcnt lgkmcnt(1)
    v_mfma_f32_16x16x32_bf16 v[120:123], v[68:71], v[152:155], v[120:123]
    s_waitcnt lgkmcnt(0)
    v_mfma_f32_16x16x32_bf16 v[124:127], v[68:71], v[156:159], v[124:127]
    s_sub_u32 s25, s25, 1
    s_cmp_lg_u32 s25, 0
    s_cbranch_scc1 ss_cv3
    v_add_u32 v65, 512, v65
    s_mov_b32 s25, 8
ss_cv4:
    ds_read2_b32 v[68:69], v64 offset0:0 offset1:1
    ds_read2_b32 v[70:71], v64 offset0:2 offset1:3
    ds_read_b128 v[144:147], v65 offset:0
    ds_read_b128 v[148:151], v65 offset:512
    ds_read_b128 v[152:155], v65 offset:1024
    ds_read_b128 v[156:159], v65 offset:1536
    v_subrev_u32 v64, 64, v64
    v_subrev_u32 v65, 64, v65
    s_waitcnt lgkmcnt(3)
    v_mfma_f32_16x16x32_bf16 v[112:115], v[68:71], v[144:147], v[112:115]
    s_waitcnt lgkmcnt(2)
    v_mfma_f32_16x16x32_bf16 v[116:119], v[68:71], v[148:151], v[116:119]
    s_waitcnt lgkmcnt(1)
    v_mfma_f32_16x16x32_bf16 v[120:123], v[68:71], v[152:155], v[120:123]
    s_waitcnt lgkmcnt(0)
    v_mfma_f32_16x16x32_bf16 v[124:127], v[68:71], v[156:159], v[124:127]
    s_sub_u32 s25, s25, 1
    s_cmp_lg_u32 s25, 0
    s_cbranch_scc1 ss_cv4
    v_add_u32 v65, 512, v65
    s_mov_b32 s25, 8
ss_cv5:
    ds_read2_b32 v[68:69], v64 offset0:0 offset1:1
    ds_read2_b32 v[70:71], v64 offset0:2 offset1:3
    ds_read_b128 v[148:151], v65 offset:0
    ds_read_b128 v[152:155], v65 offset:512
    ds_read_b128 v[156:159], v65 offset:1024
    v_subrev_u32 v64, 64, v64
    v_subrev_u32 v65, 64, v65
    s_waitcnt lgkmcnt(2)
    v_mfma_f32_16x16x32_bf16 v[116:119], v[68:71], v[148:151], v[116:119]
    s_waitcnt lgkmcnt(1)
    v_mfma_f32_16x16x32_bf16 v[120:123], v[68:71], v[152:155], v[120:123]
    s_waitcnt lgkmcnt(0)
    v_mfma_f32_16x16x32_bf16 v[124:127], v[68:71], v[156:159], v[124:127]
    s_sub_u32 s25, s25, 1
    s_cmp_lg_u32 s25, 0
    s_cbranch_scc1 ss_cv5
    v_add_u32 v65, 512, v65
    s_mov_b32 s25, 8
ss_cv6:
    ds_read2_b32 v[68:69], v64 offset0:0 offset1:1
    ds_read2_b32 v[70:71], v64 offset0:2 offset1:3
    ds_read_b128 v[152:155], v65 offset:0
    ds_read_b128 v[156:159], v65 offset:512
    v_subrev_u32 v64, 64, v64
    v_subrev_u32 v65, 64, v65
    s_waitcnt lgkmcnt(1)
    v_mfma_f32_16x16x32_bf16 v[120:123], v[68:71], v[152:155], v[120:123]
    s_waitcnt lgkmcnt(0)
    v_mfma_f32_16x16x32_bf16 v[124:127], v[68:71], v[156:159], v[124:127]
    s_sub_u32 s25, s25, 1
    s_cmp_lg_u32 s25, 0
    s_cbranch_scc1 ss_cv6
    v_add_u32 v65, 512, v65
    s_mov_b32 s25, 8
ss_cv7:
    ds_read2_b32 v[68:69], v64 offset0:0 offset1:1
    ds_read2_b32 v[70:71], v64 offset0:2 offset1:3
    ds_read_b128 v[156:159], v65 offset:0
    v_subrev_u32 v64, 64, v64
    v_subrev_u32 v65, 64, v65
    s_waitcnt lgkmcnt(0)
    v_mfma_f32_16x16x32_bf16 v[124:127], v[68:71], v[156:159], v[124:127]
    s_sub_u32 s25, s25, 1
    s_cmp_lg_u32 s25, 0
    s_cbranch_scc1 ss_cv7
    v_add_u32 v65, 512, v65
    s_nop 3
    v_lshlrev_b32 v5, 6, v2
    v_lshl_add_u32 v5, v3, 4, v5
    v_add_u32 v5, v5, v4
    ds_write_b128 v5, v[96:99] offset:7424
    ds_write_b128 v5, v[100:103] offset:8448
    ds_write_b128 v5, v[104:107] offset:9472
    ds_write_b128 v5, v[108:111] offset:10496
    ds_write_b128 v5, v[112:115] offset:11520
    ds_write_b128 v5, v[116:119] offset:12544
    ds_write_b128 v5, v[120:123] offset:13568
    ds_write_b128 v5, v[124:127] offset:14592
    s_mov_b32 s12, s74
    s_mov_b32 s13, s75
    s_mov_b32 s14, 1152
    s_mov_b32 s15, 0x20000
    s_lshl_b32 s23, s20, 1
    buffer_load_dwordx2 v[24:25], off, s[12:15], s23
    s_waitcnt vmcnt(0) lgkmcnt(0)
    s_barrier
    v_lshlrev_b32 v26, 16, v24
    v_and_b32 v27, 0xffff0000, v24
    v_lshlrev_b32 v28, 16, v25
    v_and_b32 v29, 0xffff0000, v25
    v_lshlrev_b32 v5, 5, v0
    ds_read_b128 v[64:67], v5 offset:7424
    ds_read_b128 v[68:71], v5 offset:7440
    ds_read_b128 v[72:75], v5 offset:23808
    ds_read_b128 v[76:79], v5 offset:23824
    ds_read_b128 v[80:83], v5 offset:40192
    ds_read_b128 v[84:87], v5 offset:40208
    ds_read_b128 v[88:91], v5 offset:56576
    ds_read_b128 v[92:95], v5 offset:56592
    s_waitcnt lgkmcnt(0)
    v_mul_u32_u24 v5, 18432, v0
    s_lshl_b32 s22, s20, 1
    s_add_u32 s22, s22, 1152
    v_lshlrev_b32 v6, 16, v8
    v_fmac_f32 v64, v6, v26
    v_and_b32 v6, 0xffff0000, v8
    v_fmac_f32 v72, v6, v27
    v_lshlrev_b32 v6, 16, v9
    v_fmac_f32 v80, v6, v28
    v_and_b32 v6, 0xffff0000, v9
    v_fmac_f32 v88, v6, v29
    v_cvt_pk_bf16_f32 v8, v64, v72
    v_cvt_pk_bf16_f32 v9, v80, v88
    s_add_u32 s23, s22, 0
    buffer_store_dwordx2 v[8:9], v5, s[16:19], s23 offen
    v_lshlrev_b32 v6, 16, v10
    v_fmac_f32 v65, v6, v26
    v_and_b32 v6, 0xffff0000, v10
    v_fmac_f32 v73, v6, v27
    v_lshlrev_b32 v6, 16, v11
    v_fmac_f32 v81, v6, v28
    v_and_b32 v6, 0xffff0000, v11
    v_fmac_f32 v89, v6, v29
    v_cvt_pk_bf16_f32 v10, v65, v73
    v_cvt_pk_bf16_f32 v11, v81, v89
    s_add_u32 s23, s22, 2304
    buffer_store_dwordx2 v[10:11], v5, s[16:19], s23 offen
    v_lshlrev_b32 v6, 16, v12
    v_fmac_f32 v66, v6, v26
    v_and_b32 v6, 0xffff0000, v12
    v_fmac_f32 v74, v6, v27
    v_lshlrev_b32 v6, 16, v13
    v_fmac_f32 v82, v6, v28
    v_and_b32 v6, 0xffff0000, v13
    v_fmac_f32 v90, v6, v29
    v_cvt_pk_bf16_f32 v12, v66, v74
    v_cvt_pk_bf16_f32 v13, v82, v90
    s_add_u32 s23, s22, 4608
    buffer_store_dwordx2 v[12:13], v5, s[16:19], s23 offen
    v_lshlrev_b32 v6, 16, v14
    v_fmac_f32 v67, v6, v26
    v_and_b32 v6, 0xffff0000, v14
    v_fmac_f32 v75, v6, v27
    v_lshlrev_b32 v6, 16, v15
    v_fmac_f32 v83, v6, v28
    v_and_b32 v6, 0xffff0000, v15
    v_fmac_f32 v91, v6, v29
    v_cvt_pk_bf16_f32 v14, v67, v75
    v_cvt_pk_bf16_f32 v15, v83, v91
    s_add_u32 s23, s22, 6912
    buffer_store_dwordx2 v[14:15], v5, s[16:19], s23 offen
    v_lshlrev_b32 v6, 16, v16
    v_fmac_f32 v68, v6, v26
    v_and_b32 v6, 0xffff0000, v16
    v_fmac_f32 v76, v6, v27
    v_lshlrev_b32 v6, 16, v17
    v_fmac_f32 v84, v6, v28
    v_and_b32 v6, 0xffff0000, v17
    v_fmac_f32 v92, v6, v29
    v_cvt_pk_bf16_f32 v16, v68, v76
    v_cvt_pk_bf16_f32 v17, v84, v92
    s_add_u32 s23, s22, 9216
    buffer_store_dwordx2 v[16:17], v5, s[16:19], s23 offen
    v_lshlrev_b32 v6, 16, v18
    v_fmac_f32 v69, v6, v26
    v_and_b32 v6, 0xffff0000, v18
    v_fmac_f32 v77, v6, v27
    v_lshlrev_b32 v6, 16, v19
    v_fmac_f32 v85, v6, v28
    v_and_b32 v6, 0xffff0000, v19
    v_fmac_f32 v93, v6, v29
    v_cvt_pk_bf16_f32 v18, v69, v77
    v_cvt_pk_bf16_f32 v19, v85, v93
    s_add_u32 s23, s22, 11520
    buffer_store_dwordx2 v[18:19], v5, s[16:19], s23 offen
    v_lshlrev_b32 v6, 16, v20
    v_fmac_f32 v70, v6, v26
    v_and_b32 v6, 0xffff0000, v20
    v_fmac_f32 v78, v6, v27
    v_lshlrev_b32 v6, 16, v21
    v_fmac_f32 v86, v6, v28
    v_and_b32 v6, 0xffff0000, v21
    v_fmac_f32 v94, v6, v29
    v_cvt_pk_bf16_f32 v20, v70, v78
    v_cvt_pk_bf16_f32 v21, v86, v94
    s_add_u32 s23, s22, 13824
    buffer_store_dwordx2 v[20:21], v5, s[16:19], s23 offen
    v_lshlrev_b32 v6, 16, v22
    v_fmac_f32 v71, v6, v26
    v_and_b32 v6, 0xffff0000, v22
    v_fmac_f32 v79, v6, v27
    v_lshlrev_b32 v6, 16, v23
    v_fmac_f32 v87, v6, v28
    v_and_b32 v6, 0xffff0000, v23
    v_fmac_f32 v95, v6, v29
    v_cvt_pk_bf16_f32 v22, v71, v79
    v_cvt_pk_bf16_f32 v23, v87, v95
    s_add_u32 s23, s22, 16128
    buffer_store_dwordx2 v[22:23], v5, s[16:19], s23 offen
    s_branch L_ssm_next
L_wf_next:
    s_mov_b32 s37, 20
    v_mov_b32 v250, 1
    v_mov_b32 v251, 163832
    v_cmp_eq_u32 vcc, 0, v0
    s_nop 0
    s_and_saveexec_b64 s[38:39], vcc
    s_cbranch_execz tk8
    buffer_atomic_add v250, off, s[84:87], s37 sc0
    s_waitcnt vmcnt(0)
    ds_write_b32 v251, v250
    s_waitcnt lgkmcnt(0)
tk8:
    s_mov_b64 exec, -1
    s_barrier
    ds_read_b32 v252, v251
    s_waitcnt lgkmcnt(0)
    v_readfirstlane_b32 s33, v252
    s_barrier
    s_nop 3
    s_cmp_ge_u32 s33, 160
    s_cbranch_scc1 L_phase2
    s_lshl_b32 s16, s33, 2
    s_add_u32 s16, s16, s32
    s_add_u32 s16, s16, 1504
    s_call_b64 s[46:47], L_xform
    s_lshl_b32 s40, s33, 2
    s_add_u32 s40, s40, 125841408
    s_waitcnt vmcnt(0)
    s_barrier
    v_mov_b32 v250, s95
    v_cmp_eq_u32 vcc, 0, v0
    s_nop 0
    s_and_saveexec_b64 s[38:39], vcc
    s_cbranch_execz fs9
    buffer_store_dword v250, off, s[4:7], s40 sc1
fs9:
    s_mov_b64 exec, -1
    s_branch L_wf_next
L_phase2:
    s_mov_b32 s40, 524288
mc2_w:
    buffer_load_dword v250, off, s[84:87], 0 offset:28 sc1
    s_waitcnt vmcnt(0)
    v_readfirstlane_b32 s41, v250
    s_nop 0
    s_cmp_lg_u32 s41, 0
    s_cbranch_scc1 mc2_known
    s_sub_u32 s40, s40, 1
    s_cbranch_scc1 mc2_force
    s_sleep 2
    s_branch mc2_w
mc2_force:
    v_mov_b32 v250, 2
    v_mov_b32 v251, 0
    s_mov_b64 exec, 1
    buffer_atomic_cmpswap v[250:251], off, s[84:87], 0 offset:28
    s_mov_b64 exec, -1
    s_waitcnt vmcnt(0)
    s_mov_b32 s40, 524288
    s_branch mc2_w
mc2_known:
    s_cmp_eq_u32 s41, 1
    s_cbranch_scc1 L_phase2b
    s_mov_b32 s37, 208
    v_mov_b32 v250, 1
    v_mov_b32 v251, 163832
    v_cmp_eq_u32 vcc, 0, v0
    s_nop 0
    s_and_saveexec_b64 s[38:39], vcc
    s_cbranch_execz tk10
    buffer_atomic_add v250, off, s[84:87], s37 sc0
    s_waitcnt vmcnt(0)
    ds_write_b32 v251, v250
    s_waitcnt lgkmcnt(0)
tk10:
    s_mov_b64 exec, -1
    s_barrier
    ds_read_b32 v252, v251
    s_waitcnt lgkmcnt(0)
    v_readfirstlane_b32 s12, v252
    s_barrier
    s_nop 3
    s_cmp_lt_u32 s12, 32
    s_cbranch_scc1 L_chain_safe
L_phase2b:
    s_mov_b32 s8, s76
    s_mov_b32 s9, s77
    s_mov_b32 s10, 4718592
    s_mov_b32 s11, 0x20000
    s_mov_b32 s37, 12
    v_mov_b32 v250, 1
    v_mov_b32 v251, 163832
    v_cmp_eq_u32 vcc, 0, v0
    s_nop 0
    s_and_saveexec_b64 s[38:39], vcc
    s_cbranch_execz tk11
    buffer_atomic_add v250, off, s[84:87], s37 sc0
    s_waitcnt vmcnt(0)
    ds_write_b32 v251, v250
    s_waitcnt lgkmcnt(0)
tk11:
    s_mov_b64 exec, -1
    s_barrier
    ds_read_b32 v252, v251
    s_waitcnt lgkmcnt(0)
    v_readfirstlane_b32 s36, v252
    s_barrier
    s_nop 3
    s_mul_hi_u32 s37, s36, 0x55555556
    s_mul_i32 s40, s37, 3
    s_sub_u32 s33, s36, s37
    s_mul_hi_u32 s41, s33, 0x0e38e38f
    s_mul_i32 s41, s41, 18
    s_sub_u32 s33, s33, s41
    s_cmp_lg_u32 s40, s36
    s_cbranch_scc1 L_op_start
L_att_next:
    s_mov_b32 s37, 16
    v_mov_b32 v250, 1
    v_mov_b32 v251, 163832
    v_cmp_eq_u32 vcc, 0, v0
    s_nop 0
    s_and_saveexec_b64 s[38:39], vcc
    s_cbranch_execz tk12
    buffer_atomic_add v250, off, s[84:87], s37 sc0
    s_waitcnt vmcnt(0)
    ds_write_b32 v251, v250
    s_waitcnt lgkmcnt(0)
tk12:
    s_mov_b64 exec, -1
    s_barrier
    ds_read_b32 v252, v251
    s_waitcnt lgkmcnt(0)
    v_readfirstlane_b32 s34, v252
    s_barrier
    s_nop 3
    s_cmp_ge_u32 s34, 512
    s_cbranch_scc1 L_op_start
    s_lshr_b32 s16, s34, 3
    s_and_b32 s17, s34, 7
    s_lshl_b32 s17, s17, 2
    s_add_u32 s17, s17, s32
    s_lshl_b32 s36, s17, 7
    s_add_u32 s36, s36, 125829120
    s_lshr_b32 s41, s16, 2
    s_add_u32 s41, s41, s95
    s_add_u32 s41, s41, 1
    v_and_b32 v1, 3, v0
    v_min_u32 v1, 2, v1
    v_lshlrev_b32 v2, 4, v1
    s_and_b32 s37, s16, 3
    s_lshl_b32 s37, s37, 2
    v_add_u32 v2, s37, v2
    s_mov_b32 s40, 4194304
L_aw1:
    buffer_load_dword v3, v2, s[4:7], s36 offen sc1
    s_sub_u32 s40, s40, 1
    s_cbranch_scc1 L_aw1_go
    s_waitcnt vmcnt(0)
    v_subrev_u32 v3, s41, v3
    v_cmp_lt_u32 vcc, 64, v3
    s_cbranch_vccz L_aw1_go
    s_sleep 4
    s_branch L_aw1
L_aw1_go:
    v_and_b32 v5, 63, v0
    v_lshlrev_b32 v1, 4, v5
    s_cmp_ge_u32 s16, 58
    s_cselect_b32 s18, -1, 511
    v_and_b32 v2, s18, v1
    v_or_b32 v3, 128, v1
    v_lshrrev_b32 v4, 4, v5
    v_bfe_u32 v6, v5, 2, 2
    v_sub_u32 v4, v6, v4
    v_lshlrev_b32 v4, 3, v4
    v_and_b32 v6, 3, v5
    v_add_u32 v4, v4, v6
    v_mov_b32 v6, 0xf149f2ca
    s_mov_b32 s22, 0x3e0293ee
    s_lshl_b32 s18, s16, 5
    s_add_u32 s18, s18, s17
    s_lshl_b32 s19, s18, 13
    s_add_u32 s20, s19, 33554432
    buffer_load_dwordx4 v[8:11], v1, s[4:7], s20 offen offset:0 sc1
    s_add_u32 s20, s19, 33554432
    buffer_load_dwordx4 v[12:15], v1, s[4:7], s20 offen offset:1024 sc1
    s_add_u32 s20, s19, 33554432
    buffer_load_dwordx4 v[16:19], v1, s[4:7], s20 offen offset:2048 sc1
    s_add_u32 s20, s19, 33554432
    buffer_load_dwordx4 v[20:23], v1, s[4:7], s20 offen offset:3072 sc1
    s_add_u32 s20, s19, 33558528
    buffer_load_dwordx4 v[24:27], v1, s[4:7], s20 offen offset:0 sc1
    s_add_u32 s20, s19, 33558528
    buffer_load_dwordx4 v[28:31], v1, s[4:7], s20 offen offset:1024 sc1
    s_add_u32 s20, s19, 33558528
    buffer_load_dwordx4 v[32:35], v1, s[4:7], s20 offen offset:2048 sc1
    s_add_u32 s20, s19, 33558528
    buffer_load_dwordx4 v[36:39], v1, s[4:7], s20 offen offset:3072 sc1
    s_lshl_b32 s21, s18, 14
    s_add_u32 s20, s21, 0
    buffer_load_dwordx4 v[40:43], v1, s[4:7], s20 offen offset:0 sc1
    s_add_u32 s20, s21, 4096
    buffer_load_dwordx4 v[44:47], v1, s[4:7], s20 offen offset:0 sc1
    s_add_u32 s20, s21, 8192
    buffer_load_dwordx4 v[48:51], v1, s[4:7], s20 offen offset:0 sc1
    s_add_u32 s20, s21, 12288
    buffer_load_dwordx4 v[52:55], v1, s[4:7], s20 offen offset:0 sc1
    s_add_u32 s20, s21, 0
    buffer_load_dwordx4 v[56:59], v1, s[4:7], s20 offen offset:1024 sc1
    s_add_u32 s20, s21, 4096
    buffer_load_dwordx4 v[60:63], v1, s[4:7], s20 offen offset:1024 sc1
    s_add_u32 s20, s21, 8192
    buffer_load_dwordx4 v[64:67], v1, s[4:7], s20 offen offset:1024 sc1
    s_add_u32 s20, s21, 12288
    buffer_load_dwordx4 v[68:71], v1, s[4:7], s20 offen offset:1024 sc1
    s_add_u32 s20, s21, 0
    buffer_load_dwordx4 v[88:91], v1, s[4:7], s20 offen offset:2048 sc1
    s_add_u32 s20, s21, 4096
    buffer_load_dwordx4 v[92:95], v1, s[4:7], s20 offen offset:2048 sc1
    s_add_u32 s20, s21, 8192
    buffer_load_dwordx4 v[96:99], v1, s[4:7], s20 offen offset:2048 sc1
    s_add_u32 s20, s21, 12288
    buffer_load_dwordx4 v[100:103], v1, s[4:7], s20 offen offset:2048 sc1
    s_add_u32 s20, s21, 0
    buffer_load_dwordx4 v[104:107], v1, s[4:7], s20 offen offset:3072 sc1
    s_add_u32 s20, s21, 4096
    buffer_load_dwordx4 v[108:111], v1, s[4:7], s20 offen offset:3072 sc1
    s_add_u32 s20, s21, 8192
    buffer_load_dwordx4 v[112:115], v1, s[4:7], s20 offen offset:3072 sc1
    s_add_u32 s20, s21, 12288
    buffer_load_dwordx4 v[116:119], v1, s[4:7], s20 offen offset:3072 sc1
    v_mov_b32 v172, 0x3f803f80
    v_mov_b32 v173, 0x3f803f80
    v_mov_b32 v174, 0x3f803f80
    v_mov_b32 v175, 0x3f803f80
    v_mov_b32 v176, 0x3f003f00
    v_mov_b32 v177, 0x3f003f00
    s_waitcnt vmcnt(8)
    v_mfma_f32_16x16x32_bf16 v[136:139], v[40:43], v[8:11], 0
    v_mfma_f32_16x16x32_bf16 v[140:143], v[56:59], v[8:11], 0
    v_mfma_f32_16x16x32_bf16 v[148:151], v[40:43], v[24:27], 0
    v_mfma_f32_16x16x32_bf16 v[152:155], v[56:59], v[24:27], 0
    v_mfma_f32_16x16x32_bf16 v[136:139], v[44:47], v[12:15], v[136:139]
    v_mfma_f32_16x16x32_bf16 v[140:143], v[60:63], v[12:15], v[140:143]
    v_mfma_f32_16x16x32_bf16 v[148:151], v[44:47], v[28:31], v[148:151]
    v_mfma_f32_16x16x32_bf16 v[152:155], v[60:63], v[28:31], v[152:155]
    v_mfma_f32_16x16x32_bf16 v[136:139], v[48:51], v[16:19], v[136:139]
    v_mfma_f32_16x16x32_bf16 v[140:143], v[64:67], v[16:19], v[140:143]
    v_mfma_f32_16x16x32_bf16 v[148:151], v[48:51], v[32:35], v[148:151]
    v_mfma_f32_16x16x32_bf16 v[152:155], v[64:67], v[32:35], v[152:155]
    v_mfma_f32_16x16x32_bf16 v[136:139], v[52:55], v[20:23], v[136:139]
    v_mfma_f32_16x16x32_bf16 v[140:143], v[68:71], v[20:23], v[140:143]
    v_mfma_f32_16x16x32_bf16 v[148:151], v[52:55], v[36:39], v[148:151]
    v_mfma_f32_16x16x32_bf16 v[152:155], v[68:71], v[36:39], v[152:155]
    v_cmp_le_i32 vcc, 0, v4
    s_nop 3
    v_cndmask_b32 v136, v6, v136, vcc
    v_cmp_le_i32 vcc, 1, v4
    s_nop 1
    v_cndmask_b32 v137, v6, v137, vcc
    v_cmp_le_i32 vcc, 2, v4
    s_nop 1
    v_cndmask_b32 v138, v6, v138, vcc
    v_cmp_le_i32 vcc, 3, v4
    s_nop 1
    v_cndmask_b32 v139, v6, v139, vcc
    v_cmp_le_i32 vcc, 4, v4
    s_nop 1
    v_cndmask_b32 v140, v6, v140, vcc
    v_cmp_le_i32 vcc, 5, v4
    s_nop 1
    v_cndmask_b32 v141, v6, v141, vcc
    v_cmp_le_i32 vcc, 6, v4
    s_nop 1
    v_cndmask_b32 v142, v6, v142, vcc
    v_cmp_le_i32 vcc, 7, v4
    s_nop 1
    v_cndmask_b32 v143, v6, v143, vcc
    v_cmp_le_i32 vcc, -4, v4
    s_nop 1
    v_cndmask_b32 v148, v6, v148, vcc
    v_cmp_le_i32 vcc, -3, v4
    s_nop 1
    v_cndmask_b32 v149, v6, v149, vcc
    v_cmp_le_i32 vcc, -2, v4
    s_nop 1
    v_cndmask_b32 v150, v6, v150, vcc
    v_cmp_le_i32 vcc, -1, v4
    s_nop 1
    v_cndmask_b32 v151, v6, v151, vcc
    v_cmp_le_i32 vcc, 0, v4
    s_nop 1
    v_cndmask_b32 v152, v6, v152, vcc
    v_cmp_le_i32 vcc, 1, v4
    s_nop 1
    v_cndmask_b32 v153, v6, v153, vcc
    v_cmp_le_i32 vcc, 2, v4
    s_nop 1
    v_cndmask_b32 v154, v6, v154, vcc
    v_cmp_le_i32 vcc, 3, v4
    s_nop 1
    v_cndmask_b32 v155, v6, v155, vcc
    s_nop 1
    v_and_b32 v198, 1, v0
    v_lshlrev_b32 v198, 2, v198
    v_add_u32 v198, 48, v198
    s_add_u32 s41, s16, s95
    s_add_u32 s41, s41, 1
    s_cmp_lt_u32 s16, 58
    s_cbranch_scc1 L_amk
    v_mov_b32 v198, 16384
L_amk:
    s_nop 1
    s_mov_b32 s88, 65536
    s_mov_b32 s89, 125853696
cw13:
    buffer_load_dword v199, off, s[4:7], s89 sc1
    s_waitcnt vmcnt(0)
    v_readfirstlane_b32 s42, v199
    s_nop 0
    s_sub_u32 s42, s42, s95
    s_cmp_gt_u32 s42, 64
    s_cselect_b32 s42, 0, s42
    s_add_u32 s42, s42, 1
    s_cmp_ge_u32 s42, s16
    s_cbranch_scc1 cw13x
    s_sub_u32 s88, s88, 1
    s_cbranch_scc1 cw13x
    s_sub_u32 s42, s16, s42
    s_min_u32 s42, s42, 6
cw13s:
    s_sleep 24
    s_sub_u32 s42, s42, 1
    s_cmp_lg_u32 s42, 0
    s_cbranch_scc1 cw13s
    s_branch cw13
cw13x:
    s_mov_b32 s40, 4194304
L_aw2:
    buffer_load_dword v199, v198, s[4:7], s36 offen sc1
    s_sub_u32 s40, s40, 1
    s_cbranch_scc1 L_aw2_go
    s_waitcnt vmcnt(0)
    v_subrev_u32 v199, s41, v199
    v_cmp_lt_u32 vcc, 64, v199
    s_cbranch_vccz L_aw2_go
    s_sleep 4
    s_branch L_aw2
L_aw2_go:
    s_lshl_b32 s20, s18, 12
    s_add_u32 s20, s20, 69206016
    buffer_load_dwordx4 v[72:75], v3, s[4:7], s20 offen offset:0 sc1
    buffer_load_dwordx4 v[76:79], v3, s[4:7], s20 offen offset:1024 sc1
    buffer_load_dwordx4 v[80:83], v3, s[4:7], s20 offen offset:2048 sc1
    buffer_load_dwordx4 v[84:87], v3, s[4:7], s20 offen offset:3072 sc1
    s_lshl_b32 s20, s18, 12
    s_add_u32 s20, s20, 77594624
    buffer_load_dwordx4 v[120:123], v2, s[4:7], s20 offen offset:0 sc1
    buffer_load_dwordx4 v[124:127], v2, s[4:7], s20 offen offset:1024 sc1
    buffer_load_dwordx4 v[128:131], v2, s[4:7], s20 offen offset:2048 sc1
    buffer_load_dwordx4 v[132:135], v2, s[4:7], s20 offen offset:3072 sc1
    s_waitcnt vmcnt(4)
    v_mfma_f32_16x16x32_bf16 v[144:147], v[72:75], v[8:11], 0
    v_mfma_f32_16x16x32_bf16 v[156:159], v[72:75], v[24:27], 0
    v_mfma_f32_16x16x32_bf16 v[144:147], v[76:79], v[12:15], v[144:147]
    v_mfma_f32_16x16x32_bf16 v[156:159], v[76:79], v[28:31], v[156:159]
    v_mfma_f32_16x16x32_bf16 v[144:147], v[80:83], v[16:19], v[144:147]
    v_mfma_f32_16x16x32_bf16 v[156:159], v[80:83], v[32:35], v[156:159]
    v_mfma_f32_16x16x32_bf16 v[144:147], v[84:87], v[20:23], v[144:147]
    v_mfma_f32_16x16x32_bf16 v[156:159], v[84:87], v[36:39], v[156:159]
    v_max3_f32 v196, v136, v137, v138
    v_max3_f32 v197, v139, v140, v141
    v_max3_f32 v196, v196, v142, v143
    s_nop 3
    v_max3_f32 v197, v197, v144, v145
    v_max3_f32 v196, v196, v146, v147
    v_max_f32 v196, v196, v197
    v_mov_b32 v197, v196
    s_nop 1
    v_permlane32_swap_b32 v196, v197
    v_max_f32 v196, v196, v197
    v_mov_b32 v197, v196
    s_nop 1
    v_permlane16_swap_b32 v196, v197
    v_max_f32 v196, v196, v197
    v_mul_f32 v196, s22, v196
    v_sub_f32 v196, 0, v196
    v_fma_f32 v136, v136, s22, v196
    v_fma_f32 v137, v137, s22, v196
    v_fma_f32 v138, v138, s22, v196
    v_fma_f32 v139, v139, s22, v196
    v_fma_f32 v140, v140, s22, v196
    v_fma_f32 v141, v141, s22, v196
    v_fma_f32 v142, v142, s22, v196
    v_fma_f32 v143, v143, s22, v196
    v_fma_f32 v144, v144, s22, v196
    v_fma_f32 v145, v145, s22, v196
    v_fma_f32 v146, v146, s22, v196
    v_fma_f32 v147, v147, s22, v196
    v_exp_f32 v136, v136
    v_exp_f32 v137, v137
    v_exp_f32 v138, v138
    v_exp_f32 v139, v139
    v_exp_f32 v140, v140
    v_exp_f32 v141, v141
    v_exp_f32 v142, v142
    v_exp_f32 v143, v143
    v_exp_f32 v144, v144
    v_exp_f32 v145, v145
    v_exp_f32 v146, v146
    v_exp_f32 v147, v147
    v_cvt_pk_bf16_f32 v160, v136, v137
    v_cvt_pk_bf16_f32 v161, v138, v139
    v_cvt_pk_bf16_f32 v162, v140, v141
    v_cvt_pk_bf16_f32 v163, v142, v143
    v_cvt_pk_bf16_f32 v164, v144, v145
    v_cvt_pk_bf16_f32 v165, v146, v147
    v_max3_f32 v196, v148, v149, v150
    v_max3_f32 v197, v151, v152, v153
    v_max3_f32 v196, v196, v154, v155
    v_max3_f32 v197, v197, v156, v157
    v_max3_f32 v196, v196, v158, v159
    v_max_f32 v196, v196, v197
    v_mov_b32 v197, v196
    s_nop 1
    v_permlane32_swap_b32 v196, v197
    v_max_f32 v196, v196, v197
    v_mov_b32 v197, v196
    s_nop 1
    v_permlane16_swap_b32 v196, v197
    v_max_f32 v196, v196, v197
    v_mul_f32 v196, s22, v196
    v_sub_f32 v196, 0, v196
    v_fma_f32 v148, v148, s22, v196
    v_fma_f32 v149, v149, s22, v196
    v_fma_f32 v150, v150, s22, v196
    v_fma_f32 v151, v151, s22, v196
    v_fma_f32 v152, v152, s22, v196
    v_fma_f32 v153, v153, s22, v196
    v_fma_f32 v154, v154, s22, v196
    v_fma_f32 v155, v155, s22, v196
    v_fma_f32 v156, v156, s22, v196
    v_fma_f32 v157, v157, s22, v196
    v_fma_f32 v158, v158, s22, v196
    v_fma_f32 v159, v159, s22, v196
    v_exp_f32 v148, v148
    v_exp_f32 v149, v149
    v_exp_f32 v150, v150
    v_exp_f32 v151, v151
    v_exp_f32 v152, v152
    v_exp_f32 v153, v153
    v_exp_f32 v154, v154
    v_exp_f32 v155, v155
    v_exp_f32 v156, v156
    v_exp_f32 v157, v157
    v_exp_f32 v158, v158
    v_exp_f32 v159, v159
    v_cvt_pk_bf16_f32 v166, v148, v149
    v_cvt_pk_bf16_f32 v167, v150, v151
    v_cvt_pk_bf16_f32 v168, v152, v153
    v_cvt_pk_bf16_f32 v169, v154, v155
    v_cvt_pk_bf16_f32 v170, v156, v157
    v_cvt_pk_bf16_f32 v171, v158, v159
    v_mfma_f32_16x16x32_bf16 v[180:183], v[172:175], v[160:163], 0
    v_mfma_f32_16x16x32_bf16 v[184:187], v[172:175], v[166:169], 0
    s_nop 4
    v_mfma_f32_16x16x16_bf16 v[180:183], v[176:177], v[164:165], v[180:183]
    v_mfma_f32_16x16x16_bf16 v[184:187], v[176:177], v[170:171], v[184:187]
    s_nop 6
    v_rcp_f32 v180, v180
    v_rcp_f32 v184, v184
    s_waitcnt vmcnt(0)
    s_lshl_b32 s18, s16, 18
    s_lshl_b32 s19, s17, 12
    s_add_u32 s18, s18, s19
    s_add_u32 s18, s18, 50331648
    s_add_u32 s19, s18, 131072
    v_mfma_f32_16x16x32_bf16 v[8:11], v[88:91], v[160:163], 0
    v_mfma_f32_16x16x32_bf16 v[12:15], v[104:107], v[160:163], 0
    v_mfma_f32_16x16x32_bf16 v[16:19], v[88:91], v[166:169], 0
    v_mfma_f32_16x16x32_bf16 v[20:23], v[104:107], v[166:169], 0
    v_mfma_f32_16x16x32_bf16 v[24:27], v[92:95], v[160:163], 0
    v_mfma_f32_16x16x32_bf16 v[28:31], v[108:111], v[160:163], 0
    v_mfma_f32_16x16x32_bf16 v[32:35], v[92:95], v[166:169], 0
    v_mfma_f32_16x16x32_bf16 v[36:39], v[108:111], v[166:169], 0
    v_mfma_f32_16x16x32_bf16 v[40:43], v[96:99], v[160:163], 0
    v_mfma_f32_16x16x32_bf16 v[44:47], v[112:115], v[160:163], 0
    v_mfma_f32_16x16x32_bf16 v[48:51], v[96:99], v[166:169], 0
    v_mfma_f32_16x16x32_bf16 v[52:55], v[112:115], v[166:169], 0
    v_mfma_f32_16x16x32_bf16 v[56:59], v[100:103], v[160:163], 0
    v_mfma_f32_16x16x32_bf16 v[60:63], v[116:119], v[160:163], 0
    v_mfma_f32_16x16x32_bf16 v[64:67], v[100:103], v[166:169], 0
    v_mfma_f32_16x16x32_bf16 v[68:71], v[116:119], v[166:169], 0
    v_mfma_f32_16x16x16_bf16 v[8:11], v[120:121], v[164:165], v[8:11]
    v_mfma_f32_16x16x16_bf16 v[12:15], v[122:123], v[164:165], v[12:15]
    v_mfma_f32_16x16x16_bf16 v[16:19], v[120:121], v[170:171], v[16:19]
    v_mfma_f32_16x16x16_bf16 v[20:23], v[122:123], v[170:171], v[20:23]
    v_mfma_f32_16x16x16_bf16 v[24:27], v[124:125], v[164:165], v[24:27]
    v_mfma_f32_16x16x16_bf16 v[28:31], v[126:127], v[164:165], v[28:31]
    v_mfma_f32_16x16x16_bf16 v[32:35], v[124:125], v[170:171], v[32:35]
    v_mfma_f32_16x16x16_bf16 v[36:39], v[126:127], v[170:171], v[36:39]
    v_mfma_f32_16x16x16_bf16 v[40:43], v[128:129], v[164:165], v[40:43]
    v_mfma_f32_16x16x16_bf16 v[44:47], v[130:131], v[164:165], v[44:47]
    v_mfma_f32_16x16x16_bf16 v[48:51], v[128:129], v[170:171], v[48:51]
    v_mfma_f32_16x16x16_bf16 v[52:55], v[130:131], v[170:171], v[52:55]
    v_mfma_f32_16x16x16_bf16 v[56:59], v[132:133], v[164:165], v[56:59]
    v_mfma_f32_16x16x16_bf16 v[60:63], v[134:135], v[164:165], v[60:63]
    v_mfma_f32_16x16x16_bf16 v[64:67], v[132:133], v[170:171], v[64:67]
    v_mfma_f32_16x16x16_bf16 v[68:71], v[134:135], v[170:171], v[68:71]
    v_mul_f32 v8, v8, v180
    v_mul_f32 v12, v12, v180
    v_mul_f32 v9, v9, v180
    v_mul_f32 v13, v13, v180
    v_mul_f32 v10, v10, v180
    v_mul_f32 v14, v14, v180
    v_mul_f32 v11, v11, v180
    v_mul_f32 v15, v15, v180
    v_cvt_pk_bf16_f32 v8, v8, v9
    v_cvt_pk_bf16_f32 v9, v10, v11
    v_cvt_pk_bf16_f32 v10, v12, v13
    v_cvt_pk_bf16_f32 v11, v14, v15
    buffer_store_dwordx4 v[8:11], v1, s[4:7], s18 offen offset:0 sc1
    v_mul_f32 v16, v16, v184
    v_mul_f32 v20, v20, v184
    v_mul_f32 v17, v17, v184
    v_mul_f32 v21, v21, v184
    v_mul_f32 v18, v18, v184
    v_mul_f32 v22, v22, v184
    v_mul_f32 v19, v19, v184
    v_mul_f32 v23, v23, v184
    v_cvt_pk_bf16_f32 v16, v16, v17
    v_cvt_pk_bf16_f32 v17, v18, v19
    v_cvt_pk_bf16_f32 v18, v20, v21
    v_cvt_pk_bf16_f32 v19, v22, v23
    buffer_store_dwordx4 v[16:19], v1, s[4:7], s19 offen offset:0 sc1
    v_mul_f32 v24, v24, v180
    v_mul_f32 v28, v28, v180
    v_mul_f32 v25, v25, v180
    v_mul_f32 v29, v29, v180
    v_mul_f32 v26, v26, v180
    v_mul_f32 v30, v30, v180
    v_mul_f32 v27, v27, v180
    v_mul_f32 v31, v31, v180
    v_cvt_pk_bf16_f32 v24, v24, v25
    v_cvt_pk_bf16_f32 v25, v26, v27
    v_cvt_pk_bf16_f32 v26, v28, v29
    v_cvt_pk_bf16_f32 v27, v30, v31
    buffer_store_dwordx4 v[24:27], v1, s[4:7], s18 offen offset:1024 sc1
    v_mul_f32 v32, v32, v184
    v_mul_f32 v36, v36, v184
    v_mul_f32 v33, v33, v184
    v_mul_f32 v37, v37, v184
    v_mul_f32 v34, v34, v184
    v_mul_f32 v38, v38, v184
    v_mul_f32 v35, v35, v184
    v_mul_f32 v39, v39, v184
    v_cvt_pk_bf16_f32 v32, v32, v33
    v_cvt_pk_bf16_f32 v33, v34, v35
    v_cvt_pk_bf16_f32 v34, v36, v37
    v_cvt_pk_bf16_f32 v35, v38, v39
    buffer_store_dwordx4 v[32:35], v1, s[4:7], s19 offen offset:1024 sc1
    v_mul_f32 v40, v40, v180
    v_mul_f32 v44, v44, v180
    v_mul_f32 v41, v41, v180
    v_mul_f32 v45, v45, v180
    v_mul_f32 v42, v42, v180
    v_mul_f32 v46, v46, v180
    v_mul_f32 v43, v43, v180
    v_mul_f32 v47, v47, v180
    v_cvt_pk_bf16_f32 v40, v40, v41
    v_cvt_pk_bf16_f32 v41, v42, v43
    v_cvt_pk_bf16_f32 v42, v44, v45
    v_cvt_pk_bf16_f32 v43, v46, v47
    buffer_store_dwordx4 v[40:43], v1, s[4:7], s18 offen offset:2048 sc1
    v_mul_f32 v48, v48, v184
    v_mul_f32 v52, v52, v184
    v_mul_f32 v49, v49, v184
    v_mul_f32 v53, v53, v184
    v_mul_f32 v50, v50, v184
    v_mul_f32 v54, v54, v184
    v_mul_f32 v51, v51, v184
    v_mul_f32 v55, v55, v184
    v_cvt_pk_bf16_f32 v48, v48, v49
    v_cvt_pk_bf16_f32 v49, v50, v51
    v_cvt_pk_bf16_f32 v50, v52, v53
    v_cvt_pk_bf16_f32 v51, v54, v55
    buffer_store_dwordx4 v[48:51], v1, s[4:7], s19 offen offset:2048 sc1
    v_mul_f32 v56, v56, v180
    v_mul_f32 v60, v60, v180
    v_mul_f32 v57, v57, v180
    v_mul_f32 v61, v61, v180
    v_mul_f32 v58, v58, v180
    v_mul_f32 v62, v62, v180
    v_mul_f32 v59, v59, v180
    v_mul_f32 v63, v63, v180
    v_cvt_pk_bf16_f32 v56, v56, v57
    v_cvt_pk_bf16_f32 v57, v58, v59
    v_cvt_pk_bf16_f32 v58, v60, v61
    v_cvt_pk_bf16_f32 v59, v62, v63
    buffer_store_dwordx4 v[56:59], v1, s[4:7], s18 offen offset:3072 sc1
    v_mul_f32 v64, v64, v184
    v_mul_f32 v68, v68, v184
    v_mul_f32 v65, v65, v184
    v_mul_f32 v69, v69, v184
    v_mul_f32 v66, v66, v184
    v_mul_f32 v70, v70, v184
    v_mul_f32 v67, v67, v184
    v_mul_f32 v71, v71, v184
    v_cvt_pk_bf16_f32 v64, v64, v65
    v_cvt_pk_bf16_f32 v65, v66, v67
    v_cvt_pk_bf16_f32 v66, v68, v69
    v_cvt_pk_bf16_f32 v67, v70, v71
    buffer_store_dwordx4 v[64:67], v1, s[4:7], s19 offen offset:3072 sc1
    s_lshr_b32 s40, s34, 1
    s_lshl_b32 s40, s40, 7
    s_and_b32 s41, s34, 1
    s_lshl_b32 s41, s41, 2
    s_add_u32 s40, s40, s41
    s_add_u32 s40, s40, 125894656
    s_waitcnt vmcnt(0)
    s_barrier
    v_mov_b32 v250, s95
    v_cmp_eq_u32 vcc, 0, v0
    s_nop 0
    s_and_saveexec_b64 s[38:39], vcc
    s_cbranch_execz fs14
    buffer_store_dword v250, off, s[4:7], s40 sc1
fs14:
    s_mov_b64 exec, -1
    s_branch L_att_next
L_op_start:
    s_lshl_b32 s35, s33, 2
    s_add_u32 s35, s35, 136
    s_mov_b32 s37, s35
    v_mov_b32 v250, 1
    v_mov_b32 v251, 163832
    v_cmp_eq_u32 vcc, 0, v0
    s_nop 0
    s_and_saveexec_b64 s[38:39], vcc
    s_cbranch_execz tk15
    buffer_atomic_add v250, off, s[84:87], s37 sc0
    s_waitcnt vmcnt(0)
    ds_write_b32 v251, v250
    s_waitcnt lgkmcnt(0)
tk15:
    s_mov_b64 exec, -1
    s_barrier
    ds_read_b32 v252, v251
    s_waitcnt lgkmcnt(0)
    v_readfirstlane_b32 s16, v252
    s_barrier
    s_nop 3
    s_cmp_ge_u32 s16, 128
    s_cbranch_scc1 L_op_nextcb
    s_lshr_b32 s89, s33, 2
    s_lshl_b32 s89, s89, 7
    s_add_u32 s89, s89, 125841408
    v_mbcnt_lo_u32_b32 v2, -1, 0
    v_mbcnt_hi_u32_b32 v2, -1, v2
    v_min_u32 v2, 31, v2
    v_lshlrev_b32 v2, 2, v2
    s_mov_b32 s88, 4194304
fw16:
    buffer_load_dword v3, v2, s[4:7], s89 offen offset:0 sc1
    s_sub_u32 s88, s88, 1
    s_cbranch_scc1 fw16x
    s_waitcnt vmcnt(0)
    v_cmp_ne_u32 vcc, s95, v3
    s_cbranch_vccz fw16x
    s_sleep 4
    s_branch fw16
fw16x:
    v_and_b32 v1, 63, v0
    v_lshlrev_b32 v1, 4, v1
    s_lshl_b32 s18, s33, 18
    s_lshl_b32 s19, s32, 16
    s_add_u32 s18, s18, s19
    s_add_u32 s18, s18, 130023424
    buffer_load_dwordx4 a[0:3], v1, s[4:7], s18 offen offset:0 sc1
    buffer_load_dwordx4 a[4:7], v1, s[4:7], s18 offen offset:1024 sc1
    buffer_load_dwordx4 a[8:11], v1, s[4:7], s18 offen offset:2048 sc1
    buffer_load_dwordx4 a[12:15], v1, s[4:7], s18 offen offset:3072 sc1
    s_add_u32 s18, s18, 4096
    buffer_load_dwordx4 a[16:19], v1, s[4:7], s18 offen offset:0 sc1
    buffer_load_dwordx4 a[20:23], v1, s[4:7], s18 offen offset:1024 sc1
    buffer_load_dwordx4 a[24:27], v1, s[4:7], s18 offen offset:2048 sc1
    buffer_load_dwordx4 a[28:31], v1, s[4:7], s18 offen offset:3072 sc1
    s_add_u32 s18, s18, 4096
    buffer_load_dwordx4 a[32:35], v1, s[4:7], s18 offen offset:0 sc1
    buffer_load_dwordx4 a[36:39], v1, s[4:7], s18 offen offset:1024 sc1
    buffer_load_dwordx4 a[40:43], v1, s[4:7], s18 offen offset:2048 sc1
    buffer_load_dwordx4 a[44:47], v1, s[4:7], s18 offen offset:3072 sc1
    s_add_u32 s18, s18, 4096
    buffer_load_dwordx4 a[48:51], v1, s[4:7], s18 offen offset:0 sc1
    buffer_load_dwordx4 a[52:55], v1, s[4:7], s18 offen offset:1024 sc1
    buffer_load_dwordx4 a[56:59], v1, s[4:7], s18 offen offset:2048 sc1
    buffer_load_dwordx4 a[60:63], v1, s[4:7], s18 offen offset:3072 sc1
    s_add_u32 s18, s18, 4096
    buffer_load_dwordx4 a[64:67], v1, s[4:7], s18 offen offset:0 sc1
    buffer_load_dwordx4 a[68:71], v1, s[4:7], s18 offen offset:1024 sc1
    buffer_load_dwordx4 a[72:75], v1, s[4:7], s18 offen offset:2048 sc1
    buffer_load_dwordx4 a[76:79], v1, s[4:7], s18 offen offset:3072 sc1
    s_add_u32 s18, s18, 4096
    buffer_load_dwordx4 a[80:83], v1, s[4:7], s18 offen offset:0 sc1
    buffer_load_dwordx4 a[84:87], v1, s[4:7], s18 offen offset:1024 sc1
    buffer_load_dwordx4 a[88:91], v1, s[4:7], s18 offen offset:2048 sc1
    buffer_load_dwordx4 a[92:95], v1, s[4:7], s18 offen offset:3072 sc1
    s_add_u32 s18, s18, 4096
    buffer_load_dwordx4 a[96:99], v1, s[4:7], s18 offen offset:0 sc1
    buffer_load_dwordx4 a[100:103], v1, s[4:7], s18 offen offset:1024 sc1
    buffer_load_dwordx4 a[104:107], v1, s[4:7], s18 offen offset:2048 sc1
    buffer_load_dwordx4 a[108:111], v1, s[4:7], s18 offen offset:3072 sc1
    s_add_u32 s18, s18, 4096
    buffer_load_dwordx4 a[112:115], v1, s[4:7], s18 offen offset:0 sc1
    buffer_load_dwordx4 a[116:119], v1, s[4:7], s18 offen offset:1024 sc1
    buffer_load_dwordx4 a[120:123], v1, s[4:7], s18 offen offset:2048 sc1
    buffer_load_dwordx4 a[124:127], v1, s[4:7], s18 offen offset:3072 sc1
    s_add_u32 s18, s18, 4096
    buffer_load_dwordx4 a[128:131], v1, s[4:7], s18 offen offset:0 sc1
    buffer_load_dwordx4 a[132:135], v1, s[4:7], s18 offen offset:1024 sc1
    buffer_load_dwordx4 a[136:139], v1, s[4:7], s18 offen offset:2048 sc1
    buffer_load_dwordx4 a[140:143], v1, s[4:7], s18 offen offset:3072 sc1
    s_add_u32 s18, s18, 4096
    buffer_load_dwordx4 a[144:147], v1, s[4:7], s18 offen offset:0 sc1
    buffer_load_dwordx4 a[148:151], v1, s[4:7], s18 offen offset:1024 sc1
    buffer_load_dwordx4 a[152:155], v1, s[4:7], s18 offen offset:2048 sc1
    buffer_load_dwordx4 a[156:159], v1, s[4:7], s18 offen offset:3072 sc1
    s_add_u32 s18, s18, 4096
    buffer_load_dwordx4 a[160:163], v1, s[4:7], s18 offen offset:0 sc1
    s_waitcnt vmcnt(20)
    buffer_load_dwordx4 a[164:167], v1, s[4:7], s18 offen offset:1024 sc1
    buffer_load_dwordx4 a[168:171], v1, s[4:7], s18 offen offset:2048 sc1
    buffer_load_dwordx4 a[172:175], v1, s[4:7], s18 offen offset:3072 sc1
    s_add_u32 s18, s18, 4096
    buffer_load_dwordx4 a[176:179], v1, s[4:7], s18 offen offset:0 sc1
    buffer_load_dwordx4 a[180:183], v1, s[4:7], s18 offen offset:1024 sc1
    buffer_load_dwordx4 a[184:187], v1, s[4:7], s18 offen offset:2048 sc1
    buffer_load_dwordx4 a[188:191], v1, s[4:7], s18 offen offset:3072 sc1
    s_add_u32 s18, s18, 4096
    buffer_load_dwordx4 a[192:195], v1, s[4:7], s18 offen offset:0 sc1
    buffer_load_dwordx4 a[196:199], v1, s[4:7], s18 offen offset:1024 sc1
    buffer_load_dwordx4 a[200:203], v1, s[4:7], s18 offen offset:2048 sc1
    buffer_load_dwordx4 a[204:207], v1, s[4:7], s18 offen offset:3072 sc1
    s_add_u32 s18, s18, 4096
    buffer_load_dwordx4 a[208:211], v1, s[4:7], s18 offen offset:0 sc1
    buffer_load_dwordx4 a[212:215], v1, s[4:7], s18 offen offset:1024 sc1
    buffer_load_dwordx4 a[216:219], v1, s[4:7], s18 offen offset:2048 sc1
    buffer_load_dwordx4 a[220:223], v1, s[4:7], s18 offen offset:3072 sc1
    s_add_u32 s18, s18, 4096
    buffer_load_dwordx4 a[224:227], v1, s[4:7], s18 offen offset:0 sc1
    buffer_load_dwordx4 a[228:231], v1, s[4:7], s18 offen offset:1024 sc1
    buffer_load_dwordx4 a[232:235], v1, s[4:7], s18 offen offset:2048 sc1
    buffer_load_dwordx4 a[236:239], v1, s[4:7], s18 offen offset:3072 sc1
    s_add_u32 s18, s18, 4096
    buffer_load_dwordx4 a[240:243], v1, s[4:7], s18 offen offset:0 sc1
    buffer_load_dwordx4 a[244:247], v1, s[4:7], s18 offen offset:1024 sc1
    buffer_load_dwordx4 a[248:251], v1, s[4:7], s18 offen offset:2048 sc1
    buffer_load_dwordx4 a[252:255], v1, s[4:7], s18 offen offset:3072 sc1
    s_waitcnt vmcnt(0)
L_op_seg:
    s_lshr_b32 s43, s16, 1
    s_add_u32 s43, s43, 2
    s_min_u32 s43, s43, 65
    s_lshl_b32 s94, s33, 7
    s_add_u32 s94, s94, s16
    s_mov_b32 s88, 65536
    s_mov_b32 s89, 125853696
cw17:
    buffer_load_dword v3, off, s[4:7], s89 sc1
    s_waitcnt vmcnt(0)
    v_readfirstlane_b32 s42, v3
    s_nop 0
    s_sub_u32 s42, s42, s95
    s_cmp_gt_u32 s42, 64
    s_cselect_b32 s42, 0, s42
    s_add_u32 s42, s42, 1
    s_cmp_ge_u32 s42, s43
    s_cbranch_scc1 cw17x
    s_sub_u32 s88, s88, 1
    s_cbranch_scc1 cw17x
    s_sub_u32 s42, s43, s42
    s_min_u32 s42, s42, 6
cw17s:
    s_sleep 24
    s_sub_u32 s42, s42, 1
    s_cmp_lg_u32 s42, 0
    s_cbranch_scc1 cw17s
    s_branch cw17
cw17x:
    s_lshr_b32 s89, s16, 1
    s_lshl_b32 s89, s89, 2
    s_add_u32 s89, s89, s32
    s_lshl_b32 s89, s89, 7
    s_add_u32 s89, s89, 125894656
    v_mbcnt_lo_u32_b32 v2, -1, 0
    v_mbcnt_hi_u32_b32 v2, -1, v2
    v_min_u32 v2, 1, v2
    v_lshlrev_b32 v2, 2, v2
    s_mov_b32 s88, 4194304
fw18:
    buffer_load_dword v3, v2, s[4:7], s89 offen offset:0 sc1
    s_sub_u32 s88, s88, 1
    s_cbranch_scc1 fw18x
    s_waitcnt vmcnt(0)
    v_cmp_ne_u32 vcc, s95, v3
    s_cbranch_vccz fw18x
    s_sleep 6
    s_branch fw18
fw18x:
    s_lshl_b32 s18, s16, 17
    s_lshl_b32 s19, s32, 15
    s_add_u32 s18, s18, s19
    s_add_u32 s18, s18, 50331648
    buffer_load_dwordx4 v[32:35], v1, s[4:7], s18 offen offset:0 sc1
    buffer_load_dwordx4 v[36:39], v1, s[4:7], s18 offen offset:1024 sc1
    buffer_load_dwordx4 v[40:43], v1, s[4:7], s18 offen offset:2048 sc1
    buffer_load_dwordx4 v[44:47], v1, s[4:7], s18 offen offset:3072 sc1
    s_add_u32 s18, s18, 4096
    buffer_load_dwordx4 v[48:51], v1, s[4:7], s18 offen offset:0 sc1
    buffer_load_dwordx4 v[52:55], v1, s[4:7], s18 offen offset:1024 sc1
    buffer_load_dwordx4 v[56:59], v1, s[4:7], s18 offen offset:2048 sc1
    buffer_load_dwordx4 v[60:63], v1, s[4:7], s18 offen offset:3072 sc1
    s_add_u32 s18, s18, 4096
    buffer_load_dwordx4 v[64:67], v1, s[4:7], s18 offen offset:0 sc1
    buffer_load_dwordx4 v[68:71], v1, s[4:7], s18 offen offset:1024 sc1
    buffer_load_dwordx4 v[72:75], v1, s[4:7], s18 offen offset:2048 sc1
    buffer_load_dwordx4 v[76:79], v1, s[4:7], s18 offen offset:3072 sc1
    s_add_u32 s18, s18, 4096
    buffer_load_dwordx4 v[80:83], v1, s[4:7], s18 offen offset:0 sc1
    buffer_load_dwordx4 v[84:87], v1, s[4:7], s18 offen offset:1024 sc1
    buffer_load_dwordx4 v[88:91], v1, s[4:7], s18 offen offset:2048 sc1
    buffer_load_dwordx4 v[92:95], v1, s[4:7], s18 offen offset:3072 sc1
    s_add_u32 s18, s18, 4096
    buffer_load_dwordx4 v[96:99], v1, s[4:7], s18 offen offset:0 sc1
    buffer_load_dwordx4 v[100:103], v1, s[4:7], s18 offen offset:1024 sc1
    buffer_load_dwordx4 v[104:107], v1, s[4:7], s18 offen offset:2048 sc1
    buffer_load_dwordx4 v[108:111], v1, s[4:7], s18 offen offset:3072 sc1
    s_add_u32 s18, s18, 4096
    buffer_load_dwordx4 v[112:115], v1, s[4:7], s18 offen offset:0 sc1
    buffer_load_dwordx4 v[116:119], v1, s[4:7], s18 offen offset:1024 sc1
    buffer_load_dwordx4 v[120:123], v1, s[4:7], s18 offen offset:2048 sc1
    buffer_load_dwordx4 v[124:127], v1, s[4:7], s18 offen offset:3072 sc1
    s_add_u32 s18, s18, 4096
    buffer_load_dwordx4 v[128:131], v1, s[4:7], s18 offen offset:0 sc1
    buffer_load_dwordx4 v[132:135], v1, s[4:7], s18 offen offset:1024 sc1
    buffer_load_dwordx4 v[136:139], v1, s[4:7], s18 offen offset:2048 sc1
    buffer_load_dwordx4 v[140:143], v1, s[4:7], s18 offen offset:3072 sc1
    s_add_u32 s18, s18, 4096
    buffer_load_dwordx4 v[144:147], v1, s[4:7], s18 offen offset:0 sc1
    buffer_load_dwordx4 v[148:151], v1, s[4:7], s18 offen offset:1024 sc1
    buffer_load_dwordx4 v[152:155], v1, s[4:7], s18 offen offset:2048 sc1
    buffer_load_dwordx4 v[156:159], v1, s[4:7], s18 offen offset:3072 sc1
    v_lshlrev_b32 v2, 4, v0
    v_and_b32 v3, 3072, v2
    v_lshl_add_u32 v2, v3, 1, v1
    s_waitcnt vmcnt(31)
    v_mfma_f32_16x16x32_bf16 v[8:11], a[0:3], v[32:35], 0
    v_mfma_f32_16x16x32_bf16 v[12:15], a[4:7], v[32:35], 0
    s_waitcnt vmcnt(30)
    v_mfma_f32_16x16x32_bf16 v[8:11], a[8:11], v[36:39], v[8:11]
    v_mfma_f32_16x16x32_bf16 v[12:15], a[12:15], v[36:39], v[12:15]
    s_waitcnt vmcnt(29)
    v_mfma_f32_16x16x32_bf16 v[8:11], a[16:19], v[40:43], v[8:11]
    v_mfma_f32_16x16x32_bf16 v[12:15], a[20:23], v[40:43], v[12:15]
    s_waitcnt vmcnt(28)
    v_mfma_f32_16x16x32_bf16 v[8:11], a[24:27], v[44:47], v[8:11]
    v_mfma_f32_16x16x32_bf16 v[12:15], a[28:31], v[44:47], v[12:15]
    s_waitcnt vmcnt(27)
    v_mfma_f32_16x16x32_bf16 v[8:11], a[32:35], v[48:51], v[8:11]
    v_mfma_f32_16x16x32_bf16 v[12:15], a[36:39], v[48:51], v[12:15]
    s_waitcnt vmcnt(26)
    v_mfma_f32_16x16x32_bf16 v[8:11], a[40:43], v[52:55], v[8:11]
    v_mfma_f32_16x16x32_bf16 v[12:15], a[44:47], v[52:55], v[12:15]
    s_waitcnt vmcnt(25)
    v_mfma_f32_16x16x32_bf16 v[8:11], a[48:51], v[56:59], v[8:11]
    v_mfma_f32_16x16x32_bf16 v[12:15], a[52:55], v[56:59], v[12:15]
    s_waitcnt vmcnt(24)
    v_mfma_f32_16x16x32_bf16 v[8:11], a[56:59], v[60:63], v[8:11]
    v_mfma_f32_16x16x32_bf16 v[12:15], a[60:63], v[60:63], v[12:15]
    s_waitcnt vmcnt(23)
    v_mfma_f32_16x16x32_bf16 v[8:11], a[64:67], v[64:67], v[8:11]
    v_mfma_f32_16x16x32_bf16 v[12:15], a[68:71], v[64:67], v[12:15]
    s_waitcnt vmcnt(22)
    v_mfma_f32_16x16x32_bf16 v[8:11], a[72:75], v[68:71], v[8:11]
    v_mfma_f32_16x16x32_bf16 v[12:15], a[76:79], v[68:71], v[12:15]
    s_waitcnt vmcnt(21)
    v_mfma_f32_16x16x32_bf16 v[8:11], a[80:83], v[72:75], v[8:11]
    v_mfma_f32_16x16x32_bf16 v[12:15], a[84:87], v[72:75], v[12:15]
    s_waitcnt vmcnt(20)
    v_mfma_f32_16x16x32_bf16 v[8:11], a[88:91], v[76:79], v[8:11]
    v_mfma_f32_16x16x32_bf16 v[12:15], a[92:95], v[76:79], v[12:15]
    s_waitcnt vmcnt(19)
    v_mfma_f32_16x16x32_bf16 v[8:11], a[96:99], v[80:83], v[8:11]
    v_mfma_f32_16x16x32_bf16 v[12:15], a[100:103], v[80:83], v[12:15]
    s_waitcnt vmcnt(18)
    v_mfma_f32_16x16x32_bf16 v[8:11], a[104:107], v[84:87], v[8:11]
    v_mfma_f32_16x16x32_bf16 v[12:15], a[108:111], v[84:87], v[12:15]
    s_waitcnt vmcnt(17)
    v_mfma_f32_16x16x32_bf16 v[8:11], a[112:115], v[88:91], v[8:11]
    v_mfma_f32_16x16x32_bf16 v[12:15], a[116:119], v[88:91], v[12:15]
    s_waitcnt vmcnt(16)
    v_mfma_f32_16x16x32_bf16 v[8:11], a[120:123], v[92:95], v[8:11]
    v_mfma_f32_16x16x32_bf16 v[12:15], a[124:127], v[92:95], v[12:15]
    s_waitcnt vmcnt(15)
    v_mfma_f32_16x16x32_bf16 v[8:11], a[128:131], v[96:99], v[8:11]
    v_mfma_f32_16x16x32_bf16 v[12:15], a[132:135], v[96:99], v[12:15]
    s_waitcnt vmcnt(14)
    v_mfma_f32_16x16x32_bf16 v[8:11], a[136:139], v[100:103], v[8:11]
    v_mfma_f32_16x16x32_bf16 v[12:15], a[140:143], v[100:103], v[12:15]
    s_waitcnt vmcnt(13)
    v_mfma_f32_16x16x32_bf16 v[8:11], a[144:147], v[104:107], v[8:11]
    v_mfma_f32_16x16x32_bf16 v[12:15], a[148:151], v[104:107], v[12:15]
    s_waitcnt vmcnt(12)
    v_mfma_f32_16x16x32_bf16 v[8:11], a[152:155], v[108:111], v[8:11]
    v_mfma_f32_16x16x32_bf16 v[12:15], a[156:159], v[108:111], v[12:15]
    s_waitcnt vmcnt(11)
    v_mfma_f32_16x16x32_bf16 v[8:11], a[160:163], v[112:115], v[8:11]
    v_mfma_f32_16x16x32_bf16 v[12:15], a[164:167], v[112:115], v[12:15]
    s_waitcnt vmcnt(10)
    v_mfma_f32_16x16x32_bf16 v[8:11], a[168:171], v[116:119], v[8:11]
    v_mfma_f32_16x16x32_bf16 v[12:15], a[172:175], v[116:119], v[12:15]
    s_waitcnt vmcnt(9)
    v_mfma_f32_16x16x32_bf16 v[8:11], a[176:179], v[120:123], v[8:11]
    v_mfma_f32_16x16x32_bf16 v[12:15], a[180:183], v[120:123], v[12:15]
    s_waitcnt vmcnt(8)
    v_mfma_f32_16x16x32_bf16 v[8:11], a[184:187], v[124:127], v[8:11]
    v_mfma_f32_16x16x32_bf16 v[12:15], a[188:191], v[124:127], v[12:15]
    s_waitcnt vmcnt(7)
    v_mfma_f32_16x16x32_bf16 v[8:11], a[192:195], v[128:131], v[8:11]
    v_mfma_f32_16x16x32_bf16 v[12:15], a[196:199], v[128:131], v[12:15]
    s_waitcnt vmcnt(6)
    v_mfma_f32_16x16x32_bf16 v[8:11], a[200:203], v[132:135], v[8:11]
    v_mfma_f32_16x16x32_bf16 v[12:15], a[204:207], v[132:135], v[12:15]
    s_waitcnt vmcnt(5)
    v_mfma_f32_16x16x32_bf16 v[8:11], a[208:211], v[136:139], v[8:11]
    v_mfma_f32_16x16x32_bf16 v[12:15], a[212:215], v[136:139], v[12:15]
    s_waitcnt vmcnt(4)
    v_mfma_f32_16x16x32_bf16 v[8:11], a[216:219], v[140:143], v[8:11]
    v_mfma_f32_16x16x32_bf16 v[12:15], a[220:223], v[140:143], v[12:15]
    s_waitcnt vmcnt(3)
    v_mfma_f32_16x16x32_bf16 v[8:11], a[224:227], v[144:147], v[8:11]
    v_mfma_f32_16x16x32_bf16 v[12:15], a[228:231], v[144:147], v[12:15]
    s_waitcnt vmcnt(2)
    v_mfma_f32_16x16x32_bf16 v[8:11], a[232:235], v[148:151], v[8:11]
    v_mfma_f32_16x16x32_bf16 v[12:15], a[236:239], v[148:151], v[12:15]
    s_waitcnt vmcnt(1)
    v_mfma_f32_16x16x32_bf16 v[8:11], a[240:243], v[152:155], v[8:11]
    v_mfma_f32_16x16x32_bf16 v[12:15], a[244:247], v[152:155], v[12:15]
    s_waitcnt vmcnt(0)
    v_mfma_f32_16x16x32_bf16 v[8:11], a[248:251], v[156:159], v[8:11]
    v_mfma_f32_16x16x32_bf16 v[12:15], a[252:255], v[156:159], v[12:15]
    s_nop 6
    ds_write_b128 v2, v[8:11] offset:0
    ds_write_b128 v2, v[12:15] offset:1024
    s_waitcnt lgkmcnt(0)
    s_barrier
    s_cmp_lg_u32 s32, 0
    s_cbranch_scc1 os_skip
    ds_read_b128 v[40:43], v1 offset:2048
    ds_read_b128 v[44:47], v1 offset:3072
    ds_read_b128 v[48:51], v1 offset:4096
    ds_read_b128 v[52:55], v1 offset:5120
    ds_read_b128 v[56:59], v1 offset:6144
    ds_read_b128 v[60:63], v1 offset:7168
    v_lshrrev_b32 v3, 4, v1
    v_bfe_u32 v4, v3, 2, 2
    v_lshlrev_b32 v4, 3, v4
    v_and_b32 v2, 3, v3
    v_add_u32 v4, v4, v2
    v_mul_u32_u24 v4, 2304, v4
    v_lshrrev_b32 v3, 4, v3
    v_lshl_add_u32 v4, v3, 4, v4
    s_lshr_b32 s18, s16, 1
    s_lshl_b32 s18, s18, 3
    s_and_b32 s19, s16, 1
    s_add_u32 s18, s18, s19
    s_mul_i32 s18, s18, 9216
    s_lshl_b32 s19, s33, 6
    s_add_u32 s18, s18, s19
    s_waitcnt lgkmcnt(0)
    v_pk_add_f32 v[8:9], v[8:9], v[40:41]
    v_pk_add_f32 v[48:49], v[48:49], v[56:57]
    v_pk_add_f32 v[8:9], v[8:9], v[48:49]
    v_pk_add_f32 v[10:11], v[10:11], v[42:43]
    v_pk_add_f32 v[50:51], v[50:51], v[58:59]
    v_pk_add_f32 v[10:11], v[10:11], v[50:51]
    v_pk_add_f32 v[12:13], v[12:13], v[44:45]
    v_pk_add_f32 v[52:53], v[52:53], v[60:61]
    v_pk_add_f32 v[12:13], v[12:13], v[52:53]
    v_pk_add_f32 v[14:15], v[14:15], v[46:47]
    v_pk_add_f32 v[54:55], v[54:55], v[62:63]
    v_pk_add_f32 v[14:15], v[14:15], v[54:55]
    v_cvt_pk_bf16_f32 v32, v8, v12
    v_cvt_pk_bf16_f32 v33, v9, v13
    v_cvt_pk_bf16_f32 v34, v10, v14
    v_cvt_pk_bf16_f32 v35, v11, v15
    buffer_store_dwordx4 v[32:35], v4, s[8:11], s18 offen
os_skip:
    s_nop 1
    s_cmp_ge_u32 s16, 124
    s_cbranch_scc1 L_op_nextcb
    s_mov_b32 s37, s35
    v_mov_b32 v250, 1
    v_mov_b32 v251, 163832
    v_cmp_eq_u32 vcc, 0, v0
    s_nop 0
    s_and_saveexec_b64 s[38:39], vcc
    s_cbranch_execz tk19
    buffer_atomic_add v250, off, s[84:87], s37 sc0
    s_waitcnt vmcnt(0)
    ds_write_b32 v251, v250
    s_waitcnt lgkmcnt(0)
tk19:
    s_mov_b64 exec, -1
    s_barrier
    ds_read_b32 v252, v251
    s_waitcnt lgkmcnt(0)
    v_readfirstlane_b32 s16, v252
    s_barrier
    s_nop 3
    s_cmp_lt_u32 s16, 128
    s_cbranch_scc1 L_op_seg
L_op_nextcb:
    v_and_b32 v1, 63, v0
    v_min_u32 v1, 17, v1
    v_lshlrev_b32 v2, 2, v1
    buffer_load_dword v3, v2, s[84:87], 0 offen offset:136 sc1
    s_waitcnt vmcnt(0)
    v_cmp_gt_u32 vcc, 128, v3
    s_nop 0
    s_ff1_i32_b64 s40, vcc
    v_mov_b32 v250, s40
    v_mov_b32 v251, 163832
    s_cmp_lg_u32 s32, 0
    s_cbranch_scc1 L_op_nw
    ds_write_b32 v251, v250
    s_waitcnt lgkmcnt(0)
L_op_nw:
    s_barrier
    ds_read_b32 v252, v251
    s_waitcnt lgkmcnt(0)
    v_readfirstlane_b32 s33, v252
    s_barrier
    s_nop 1
    s_cmp_lt_u32 s33, 18
    s_cbranch_scc1 L_op_start
L_exit:
    s_endpgm
.section .rodata,"a"
.p2align 6
.amdhsa_kernel concat_heads__memory_aug_recurrent_mem_tr__ssm_conv_s4d__prompt_kernel
  .amdhsa_next_free_vgpr 512
  .amdhsa_next_free_sgpr 102
  .amdhsa_accum_offset 256
  .amdhsa_group_segment_fixed_size 0
  .amdhsa_kernarg_size 136
  .amdhsa_user_sgpr_count 2
  .amdhsa_user_sgpr_kernarg_segment_ptr 1
  .amdhsa_system_sgpr_workgroup_id_x 1
.end_amdhsa_kernel
.text
```

```asm
; @launch grid=(256,1,1) block=(256,1,1) lds=163840
.amdgcn_target "amdgcn-amd-amdhsa--gfx950"
.text
.globl concat_heads__memory_aug_recurrent_mem_tr__ssm_conv_s4d__prompt_kernel
.p2align 8
.type concat_heads__memory_aug_recurrent_mem_tr__ssm_conv_s4d__prompt_kernel,@function
concat_heads__memory_aug_recurrent_mem_tr__ssm_conv_s4d__prompt_kernel:
    s_cmp_ge_u32 s2, 256
    s_cbranch_scc1 L_exit
    s_load_dwordx4 s[80:83], s[0:1], 120
    s_load_dwordx16 s[48:63], s[0:1], 0
    s_memrealtime s[90:91]
    v_lshrrev_b32 v1, 6, v0
    s_nop 0
    v_readfirstlane_b32 s32, v1
    s_waitcnt lgkmcnt(0)
    s_mov_b32 s4, s82
    s_mov_b32 s5, s83
    s_mov_b32 s6, 268435456
    s_mov_b32 s7, 0x20000
    s_mov_b32 s84, s80
    s_mov_b32 s85, s81
    s_mov_b32 s86, 256
    s_mov_b32 s87, 0x20000
    s_cmp_lg_u32 s32, 0
    s_cbranch_scc1 L_nod0
L_nod0:
    s_cmp_lg_u32 s32, 3
    s_cbranch_scc1 L_nowarm
    s_getpc_b64 s[44:45]
L_pcw:
    v_and_b32 v1, 63, v0
    v_lshlrev_b32 v1, 7, v1
    v_min_u32 v2, L_exit-L_pcw, v1
    global_load_dword v210, v2, s[44:45]
    v_add_u32 v1, 8192, v1
    v_min_u32 v2, L_exit-L_pcw, v1
    global_load_dword v211, v2, s[44:45]
    v_add_u32 v1, 8192, v1
    v_min_u32 v2, L_exit-L_pcw, v1
    global_load_dword v212, v2, s[44:45]
    v_add_u32 v1, 8192, v1
    v_min_u32 v2, L_exit-L_pcw, v1
    global_load_dword v213, v2, s[44:45]
    v_add_u32 v1, 8192, v1
    v_min_u32 v2, L_exit-L_pcw, v1
    global_load_dword v214, v2, s[44:45]
    v_add_u32 v1, 8192, v1
    v_min_u32 v2, L_exit-L_pcw, v1
    global_load_dword v215, v2, s[44:45]
    v_add_u32 v1, 8192, v1
    v_min_u32 v2, L_exit-L_pcw, v1
    global_load_dword v216, v2, s[44:45]
    v_add_u32 v1, 8192, v1
    v_min_u32 v2, L_exit-L_pcw, v1
    global_load_dword v217, v2, s[44:45]
    v_add_u32 v1, 8192, v1
L_nowarm:
    s_getreg_b32 s3, hwreg(HW_REG_XCC_ID)
    s_and_b32 s3, s3, 15
    s_cmp_lg_u32 s3, 0
    s_cbranch_scc1 L_helper
    s_mov_b32 s37, 128
    v_mov_b32 v250, 1
    v_mov_b32 v251, 163832
    v_cmp_eq_u32 vcc, 0, v0
    s_nop 0
    s_and_saveexec_b64 s[38:39], vcc
    s_cbranch_execz tk1
    buffer_atomic_add v250, off, s[84:87], s37 sc0
    s_waitcnt vmcnt(0)
    ds_write_b32 v251, v250
    s_waitcnt lgkmcnt(0)
tk1:
    s_mov_b64 exec, -1
    s_barrier
    ds_read_b32 v252, v251
    s_waitcnt lgkmcnt(0)
    v_readfirstlane_b32 s12, v252
    s_barrier
    s_nop 3
    s_cmp_ge_u32 s12, 32
    s_cbranch_scc1 L_helper
L_chain:
    s_load_dwordx8 s[48:55], s[0:1], 8
    s_load_dwordx2 s[56:57], s[0:1], 40
    s_waitcnt lgkmcnt(0)
    v_lshrrev_b32 v77, 6, v0
    s_nop 0
    v_readfirstlane_b32 s13, v77
    v_lshlrev_b32 v65, 4, v0
    v_and_b32 v48, 63, v0
    s_mov_b32 s10, 4718592
    s_mov_b32 s11, 0x20000
    v_lshrrev_b32 v49, 3, v48
    v_mul_u32_u24 v18, 1152, v49
    v_and_b32 v49, 7, v48
    v_lshl_add_u32 v18, v49, 4, v18
    s_mul_i32 s40, s12, 147456
    s_lshl_b32 s41, s13, 8
    s_add_u32 s40, s40, s41
    s_xor_b32 s41, s13, 0
    s_mul_i32 s41, s41, 36864
    s_add_u32 s60, s41, s40
    s_xor_b32 s41, s13, 1
    s_mul_i32 s41, s41, 36864
    s_add_u32 s61, s41, s40
    s_xor_b32 s41, s13, 2
    s_mul_i32 s41, s41, 36864
    s_add_u32 s62, s41, s40
    s_xor_b32 s41, s13, 3
    s_mul_i32 s41, s41, 36864
    s_add_u32 s63, s41, s40
    s_lshl_b32 s43, s13, 12
    s_mov_b64 s[8:9], s[56:57]
    s_add_u32 m0, s43, 0
    s_add_u32 s41, s60, 0
    buffer_load_dwordx4 v18, s[8:11], s41 offen offset:0 nt lds
    s_add_u32 s41, s60, 8192
    buffer_load_dwordx4 v18, s[8:11], s41 offen offset:1024 nt lds
    s_add_u32 s41, s60, 16384
    buffer_load_dwordx4 v18, s[8:11], s41 offen offset:2048 nt lds
    s_add_u32 s41, s60, 24576
    buffer_load_dwordx4 v18, s[8:11], s41 offen offset:3072 nt lds
    s_add_u32 m0, s43, 36864
    s_add_u32 s41, s61, 0
    buffer_load_dwordx4 v18, s[8:11], s41 offen offset:0 nt lds
    s_add_u32 s41, s61, 8192
    buffer_load_dwordx4 v18, s[8:11], s41 offen offset:1024 nt lds
    s_add_u32 s41, s61, 16384
    buffer_load_dwordx4 v18, s[8:11], s41 offen offset:2048 nt lds
    s_add_u32 s41, s61, 24576
    buffer_load_dwordx4 v18, s[8:11], s41 offen offset:3072 nt lds
    s_add_u32 m0, s43, 73728
    s_add_u32 s41, s62, 0
    buffer_load_dwordx4 v18, s[8:11], s41 offen offset:0 nt lds
    s_add_u32 s41, s62, 8192
    buffer_load_dwordx4 v18, s[8:11], s41 offen offset:1024 nt lds
    s_add_u32 s41, s62, 16384
    buffer_load_dwordx4 v18, s[8:11], s41 offen offset:2048 nt lds
    s_add_u32 s41, s62, 24576
    buffer_load_dwordx4 v18, s[8:11], s41 offen offset:3072 nt lds
    s_add_u32 m0, s43, 110592
    s_add_u32 s41, s63, 0
    buffer_load_dwordx4 v18, s[8:11], s41 offen offset:0 nt lds
    s_add_u32 s41, s63, 8192
    buffer_load_dwordx4 v18, s[8:11], s41 offen offset:1024 nt lds
    s_add_u32 s41, s63, 16384
    buffer_load_dwordx4 v18, s[8:11], s41 offen offset:2048 nt lds
    s_add_u32 s41, s63, 24576
    buffer_load_dwordx4 v18, s[8:11], s41 offen offset:3072 nt lds
    v_lshrrev_b32 v49, 1, v48
    v_mul_u32_u24 v19, 1152, v49
    v_and_b32 v49, 1, v48
    v_lshl_add_u32 v19, v49, 4, v19
    s_mul_i32 s41, s13, 224
    s_sub_u32 s41, 1024, s41
    v_add_u32 v19, s41, v19
    v_lshrrev_b32 v49, 4, v48
    v_lshlrev_b32 v50, 2, v49
    v_and_b32 v51, 15, v48
    v_xor_b32 v51, v51, v50
    v_lshlrev_b32 v51, 4, v51
    v_lshl_add_u32 v16, v49, 15, v51
    v_lshrrev_b32 v50, 1, v49
    v_lshl_add_u32 v17, v50, 16, v51
    v_and_b32 v50, 1, v49
    v_lshl_add_u32 v17, v50, 13, v17
    s_lshl_b32 s40, s12, 8
    s_mul_i32 s58, s13, 1048576
    s_add_u32 s58, s58, s40
    s_lshr_b32 s41, s13, 1
    s_mul_i32 s59, s41, 262144
    s_and_b32 s41, s13, 1
    s_lshl_b32 s41, s41, 14
    s_add_u32 s59, s59, s41
    s_add_u32 s59, s59, s40
    s_add_u32 s59, s59, 4194304
    v_bfe_u32 v50, v48, 2, 2
    v_xor_b32 v51, s13, v50
    v_lshlrev_b32 v20, 6, v51
    v_and_b32 v51, 3, v48
    v_lshl_add_u32 v20, v51, 4, v20
    v_lshrrev_b32 v23, 2, v48
    v_lshl_add_u32 v20, v23, 8, v20
    s_xor_b32 s41, s43, 0
    v_add_u32 v24, s41, v20
    s_xor_b32 s41, s43, 4096
    v_add_u32 v25, s41, v20
    s_xor_b32 s41, s43, 8192
    v_add_u32 v26, s41, v20
    s_xor_b32 s41, s43, 12288
    v_add_u32 v27, s41, v20
    v_and_b32 v23, 1, v50
    v_lshl_add_u32 v23, v49, 2, v23
    v_lshrrev_b32 v50, 1, v50
    v_lshlrev_b32 v21, 7, v23
    v_lshl_add_u32 v21, v50, 6, v21
    v_lshl_add_u32 v21, v51, 4, v21
    v_add_u32 v21, s43, v21
    v_lshlrev_b32 v22, 9, v50
    v_xor_b32 v22, v22, v21
    v_lshlrev_b32 v23, 5, v23
    v_lshl_add_u32 v23, v50, 10, v23
    v_lshl_add_u32 v23, v51, 3, v23
    v_add_u32 v23, s43, v23
    v_bfe_u32 v60, v65, 4, 6
    v_and_b32 v61, 15, v60
    v_lshrrev_b32 v62, 4, v60
    v_mov_b32 v64, 0x4444
    v_mov_b32 v77, 0xeeee
    v_cmp_lt_u32 vcc, 7, v61
    s_nop 1
    v_cndmask_b32 v64, v64, v77, vcc
    v_xor_b32 v66, 1024, v65
    v_xor_b32 v67, 2048, v65
    v_xor_b32 v68, 3072, v65
    v_and_b32 v69, 511, v65
    s_mul_i32 s96, s13, 36864
    s_add_u32 s96, s96, 16384
    v_lshlrev_b32 v70, 4, v60
    v_add_u32 v70, s96, v70
    v_lshrrev_b32 v79, 1, v69
    s_lshl_b32 s96, s13, 8
    s_add_u32 s96, s96, 14336
    s_lshl_b32 s33, s13, 10
    s_add_u32 s97, s33, 8192
    v_mov_b32 v77, s97
    v_mov_b32 v78, s96
    v_cmp_lt_u32 vcc, 31, v60
    s_nop 1
    v_cndmask_b32 v71, v77, v78, vcc
    v_add_u32 v71, v71, v79
    v_and_b32 v77, 7, v61
    v_lshrrev_b32 v78, 3, v61
    v_lshlrev_b32 v74, 4, v77
    v_lshl_add_u32 v73, v62, 7, v74
    v_lshl_add_u32 v73, v78, 3, v73
    s_lshl_b32 s96, s13, 9
    v_add_u32 v73, s96, v73
    v_lshl_add_u32 v74, v78, 14, v74
    v_lshl_add_u32 v74, v62, 15, v74
    s_lshl_b32 s96, s13, 17
    v_add_u32 v74, s96, v74
    v_bfe_u32 v77, v61, 2, 1
    v_and_b32 v78, 3, v61
    v_bfe_u32 v79, v61, 1, 2
    s_cmp_lt_u32 s13, 2
    s_cselect_b64 vcc, -1, 0
    v_cndmask_b32 v77, 0, v77, vcc
    v_cndmask_b32 v78, v79, v78, vcc
    v_lshlrev_b32 v75, 7, v77
    v_lshl_add_u32 v75, v62, 4, v75
    v_lshl_add_u32 v75, v78, 2, v75
    v_lshl_add_u32 v58, v77, 3, v78
    v_lshlrev_b32 v79, 1, v78
    v_cndmask_b32 v58, v79, v58, vcc
    s_bfe_u32 s97, s12, 0x10001
    s_lshl_b32 s68, s97, 6
    s_lshl_b32 s97, s97, 2
    v_add_u32 v59, s97, v62
    s_bfe_u32 s96, s12, 0x10002
    s_and_b32 s40, s12, 1
    s_lshl_b32 s96, s96, 1
    s_add_u32 s96, s96, s40
    s_lshr_b32 s97, s12, 3
    s_lshl_b32 s98, s13, 2
    s_add_u32 s98, s98, s97
    s_lshl_b32 s98, s98, 2
    s_add_u32 s98, s98, s96
    s_lshl_b32 s98, s98, 8
    s_lshl_b32 s99, s13, 2
    s_add_u32 s99, s99, s96
    s_lshl_b32 s99, s99, 4
    s_lshl_b32 s41, s97, 1
    s_add_u32 s41, s41, s40
    s_lshl_b32 s41, s41, 7
    s_add_u32 s41, s41, 8192
    s_lshl_b32 s40, s40, 3
    s_add_u32 s40, s40, 512
    s_cmp_lt_u32 s13, 2
    s_cselect_b32 s96, 7, 4
    s_cselect_b32 s98, s98, s41
    s_cselect_b32 s99, s99, s40
    s_cselect_b32 s32, 1, 0
    s_add_u32 s68, s68, s98
    s_lshl_b32 s97, s97, s96
    s_add_u32 s99, s99, s97
    v_add_u32 v58, s99, v58
    s_and_b32 s97, s12, 4
    s_or_b32 s97, s97, s13
    s_cmp_eq_u32 s97, 2
    s_cselect_b32 s32, 2, s32
    s_mov_b32 s8, s48
    s_mov_b32 s9, s49
    s_mov_b32 s10, 9216
    s_cmp_lt_u32 s13, 2
    s_cselect_b32 s96, 8, 2
    v_mul_u32_u24 v77, 1152, v59
    v_lshl_add_u32 v77, v58, 1, v77
    buffer_load_ushort v72, v77, s[8:11], 0 offen
    buffer_load_ushort v76, v77, s[8:11], s96 offen
    s_mov_b32 s10, 4718592
    s_waitcnt vmcnt(12) lgkmcnt(0)
    s_barrier
    s_mov_b64 s[8:9], s[56:57]
    s_add_u32 m0, s43, 147456
    s_add_u32 m0, s43, 147456
    s_nop 0
    buffer_load_dwordx4 v19, s[8:11], s60 offen offset:0 nt lds
    s_add_u32 m0, s43, 148480
    s_nop 0
    buffer_load_dwordx4 v19, s[8:11], s61 offen offset:0 nt lds
    s_add_u32 m0, s43, 149504
    s_nop 0
    buffer_load_dwordx4 v19, s[8:11], s62 offen offset:0 nt lds
    s_add_u32 m0, s43, 150528
    s_nop 0
    buffer_load_dwordx4 v19, s[8:11], s63 offen offset:0 nt lds
    v_mov_b32 v78, v21
    v_mov_b32 v79, v22
    v_add_u32 v77, 0, v79
    ds_read_b64_tr_b16 v[80:81], v77 offset:0
    ds_read_b64_tr_b16 v[82:83], v77 offset:256
    ds_read_b64_tr_b16 v[84:85], v77 offset:2048
    ds_read_b64_tr_b16 v[86:87], v77 offset:2304
    ds_read_b64_tr_b16 v[112:113], v77 offset:8
    ds_read_b64_tr_b16 v[114:115], v77 offset:264
    ds_read_b64_tr_b16 v[116:117], v77 offset:2056
    ds_read_b64_tr_b16 v[118:119], v77 offset:2312
    s_waitcnt vmcnt(12) lgkmcnt(0)
    s_barrier
    s_mov_b64 s[8:9], s[52:53]
    s_add_u32 m0, s43, 0
    s_add_u32 s41, s58, 0
    buffer_load_dwordx4 v16, s[8:11], s41 offen offset:0 nt lds
    s_add_u32 s41, s58, 15360
    buffer_load_dwordx4 v16, s[8:11], s41 offen offset:1024 nt lds
    s_add_u32 s41, s58, 129024
    buffer_load_dwordx4 v16, s[8:11], s41 offen offset:2048 nt lds
    s_add_u32 s41, s58, 144384
    buffer_load_dwordx4 v16, s[8:11], s41 offen offset:3072 nt lds
    v_add_u32 v77, 36864, v78
    ds_read_b64_tr_b16 v[88:89], v77 offset:0
    ds_read_b64_tr_b16 v[90:91], v77 offset:256
    ds_read_b64_tr_b16 v[92:93], v77 offset:2048
    ds_read_b64_tr_b16 v[94:95], v77 offset:2304
    ds_read_b64_tr_b16 v[120:121], v77 offset:8
    ds_read_b64_tr_b16 v[122:123], v77 offset:264
    ds_read_b64_tr_b16 v[124:125], v77 offset:2056
    ds_read_b64_tr_b16 v[126:127], v77 offset:2312
    s_waitcnt vmcnt(12) lgkmcnt(0)
    s_barrier
    s_add_u32 m0, s43, 36864
    s_add_u32 s41, s58, 8192
    buffer_load_dwordx4 v16, s[8:11], s41 offen offset:0 nt lds
    s_add_u32 s41, s58, 23552
    buffer_load_dwordx4 v16, s[8:11], s41 offen offset:1024 nt lds
    s_add_u32 s41, s58, 137216
    buffer_load_dwordx4 v16, s[8:11], s41 offen offset:2048 nt lds
    s_add_u32 s41, s58, 152576
    buffer_load_dwordx4 v16, s[8:11], s41 offen offset:3072 nt lds
    v_add_u32 v77, 73728, v78
    ds_read_b64_tr_b16 v[96:97], v77 offset:0
    ds_read_b64_tr_b16 v[98:99], v77 offset:256
    ds_read_b64_tr_b16 v[100:101], v77 offset:2048
    ds_read_b64_tr_b16 v[102:103], v77 offset:2304
    ds_read_b64_tr_b16 v[128:129], v77 offset:8
    ds_read_b64_tr_b16 v[130:131], v77 offset:264
    ds_read_b64_tr_b16 v[132:133], v77 offset:2056
    ds_read_b64_tr_b16 v[134:135], v77 offset:2312
    s_waitcnt vmcnt(12) lgkmcnt(0)
    s_barrier
    s_add_u32 m0, s43, 73728
    s_add_u32 s41, s58, 262144
    buffer_load_dwordx4 v16, s[8:11], s41 offen offset:0 nt lds
    s_add_u32 s41, s58, 277504
    buffer_load_dwordx4 v16, s[8:11], s41 offen offset:1024 nt lds
    s_add_u32 s41, s58, 391168
    buffer_load_dwordx4 v16, s[8:11], s41 offen offset:2048 nt lds
    s_add_u32 s41, s58, 406528
    buffer_load_dwordx4 v16, s[8:11], s41 offen offset:3072 nt lds
    v_add_u32 v77, 110592, v78
    ds_read_b64_tr_b16 v[104:105], v77 offset:0
    ds_read_b64_tr_b16 v[106:107], v77 offset:256
    ds_read_b64_tr_b16 v[108:109], v77 offset:2048
    ds_read_b64_tr_b16 v[110:111], v77 offset:2304
    ds_read_b64_tr_b16 v[136:137], v77 offset:8
    ds_read_b64_tr_b16 v[138:139], v77 offset:264
    ds_read_b64_tr_b16 v[140:141], v77 offset:2056
    ds_read_b64_tr_b16 v[142:143], v77 offset:2312
    s_waitcnt vmcnt(12) lgkmcnt(0)
    s_barrier
    s_add_u32 m0, s43, 110592
    s_add_u32 s41, s58, 270336
    buffer_load_dwordx4 v16, s[8:11], s41 offen offset:0 nt lds
    s_add_u32 s41, s58, 285696
    buffer_load_dwordx4 v16, s[8:11], s41 offen offset:1024 nt lds
    s_add_u32 s41, s58, 399360
    buffer_load_dwordx4 v16, s[8:11], s41 offen offset:2048 nt lds
    s_add_u32 s41, s58, 414720
    buffer_load_dwordx4 v16, s[8:11], s41 offen offset:3072 nt lds
    v_add_u32 v77, 147456, v23
    ds_read_b64_tr_b16 v[144:145], v77 offset:0
    ds_read_b64_tr_b16 v[146:147], v77 offset:64
    ds_read_b64_tr_b16 v[148:149], v77 offset:512
    ds_read_b64_tr_b16 v[150:151], v77 offset:576
    ds_read_b64_tr_b16 v[152:153], v77 offset:2048
    ds_read_b64_tr_b16 v[154:155], v77 offset:2112
    ds_read_b64_tr_b16 v[156:157], v77 offset:2560
    ds_read_b64_tr_b16 v[158:159], v77 offset:2624
    s_waitcnt vmcnt(12) lgkmcnt(0)
    s_barrier
    s_add_u32 m0, s43, 147456
    s_add_u32 s41, s58, 524288
    buffer_load_dwordx4 v16, s[8:11], s41 offen offset:0 nt lds
    s_add_u32 s41, s58, 539648
    buffer_load_dwordx4 v16, s[8:11], s41 offen offset:1024 nt lds
    s_add_u32 s41, s58, 653312
    buffer_load_dwordx4 v16, s[8:11], s41 offen offset:2048 nt lds
    s_add_u32 s41, s58, 668672
    buffer_load_dwordx4 v16, s[8:11], s41 offen offset:3072 nt lds
    s_cmp_eq_u32 s32, 0
    s_cbranch_scc1 cf_init_done
    v_mov_b32 v52, 1
    v_mov_b32 v53, 1
    v_mov_b32 v54, 1
    v_mov_b32 v55, 1
    v_mov_b32 v56, 0
    v_lshl_or_b32 v72, v76, 16, v72
    s_lshl_b32 s96, s12, 14
    s_add_u32 s96, s96, 68157440
    s_add_u32 s97, s96, 0
    buffer_store_dwordx4 v[52:55], v65, s[4:7], s97 offen
    buffer_load_dwordx4 v[60:63], v65, s[4:7], s97 offen sc1
    s_add_u32 s97, s96, 4096
    buffer_store_dwordx4 v[52:55], v65, s[4:7], s97 offen
    buffer_load_dwordx4 v[60:63], v65, s[4:7], s97 offen sc1
    s_add_u32 s97, s96, 8192
    buffer_store_dwordx4 v[52:55], v65, s[4:7], s97 offen
    buffer_load_dwordx4 v[60:63], v65, s[4:7], s97 offen sc1
    s_add_u32 s97, s96, 12288
    buffer_store_dwordx4 v[52:55], v65, s[4:7], s97 offen
    buffer_load_dwordx4 v[60:63], v65, s[4:7], s97 offen sc1
    s_add_u32 s96, s68, 67108864
    s_add_u32 s97, s96, 16384
    buffer_store_dword v56, v75, s[4:7], s96 offen offset:0
    buffer_store_dword v72, v75, s[4:7], s97 offen offset:0
    buffer_load_dword v60, v75, s[4:7], s96 offen offset:0 sc1
    buffer_load_dword v60, v75, s[4:7], s97 offen offset:0 sc1
    s_cmp_lg_u32 s32, 2
    s_cbranch_scc1 cf_init_done
    buffer_store_dword v56, v75, s[4:7], s96 offen offset:1024
    buffer_store_dword v72, v75, s[4:7], s97 offen offset:1024
    buffer_load_dword v60, v75, s[4:7], s96 offen offset:1024 sc1
    buffer_load_dword v60, v75, s[4:7], s97 offen offset:1024 sc1
    buffer_store_dword v56, v75, s[4:7], s96 offen offset:2048
    buffer_store_dword v72, v75, s[4:7], s97 offen offset:2048
    buffer_load_dword v60, v75, s[4:7], s96 offen offset:2048 sc1
    buffer_load_dword v60, v75, s[4:7], s97 offen offset:2048 sc1
    buffer_store_dword v56, v75, s[4:7], s96 offen offset:3072
    buffer_store_dword v72, v75, s[4:7], s97 offen offset:3072
    buffer_load_dword v60, v75, s[4:7], s96 offen offset:3072 sc1
    buffer_load_dword v60, v75, s[4:7], s97 offen offset:3072 sc1
cf_init_done:
    v_add_u32 v28, 0, v24
    v_add_u32 v29, 0, v25
    v_add_u32 v30, 0, v26
    v_add_u32 v31, 0, v27
    ds_read_b64_tr_b16 a[96:97], v28 offset:0
    ds_read_b64_tr_b16 a[104:105], v28 offset:8
    ds_read_b64_tr_b16 a[112:113], v29 offset:0
    ds_read_b64_tr_b16 a[120:121], v29 offset:8
    ds_read_b64_tr_b16 a[128:129], v30 offset:0
    ds_read_b64_tr_b16 a[136:137], v30 offset:8
    ds_read_b64_tr_b16 a[144:145], v31 offset:0
    ds_read_b64_tr_b16 v[32:33], v31 offset:8
    s_waitcnt vmcnt(12) lgkmcnt(0)
    s_barrier
    s_add_u32 m0, s43, 0
    s_add_u32 s41, s58, 532480
    buffer_load_dwordx4 v16, s[8:11], s41 offen offset:0 nt lds
    s_add_u32 s41, s58, 547840
    buffer_load_dwordx4 v16, s[8:11], s41 offen offset:1024 nt lds
    s_add_u32 s41, s58, 661504
    buffer_load_dwordx4 v16, s[8:11], s41 offen offset:2048 nt lds
    s_add_u32 s41, s58, 676864
    buffer_load_dwordx4 v16, s[8:11], s41 offen offset:3072 nt lds
    ds_write_b64 v70, v[32:33] offset:12288
    v_add_u32 v28, 36864, v24
    v_add_u32 v29, 36864, v25
    v_add_u32 v30, 36864, v26
    v_add_u32 v31, 36864, v27
    ds_read_b64_tr_b16 a[98:99], v28 offset:0
    ds_read_b64_tr_b16 a[106:107], v28 offset:8
    ds_read_b64_tr_b16 a[114:115], v29 offset:0
    ds_read_b64_tr_b16 a[122:123], v29 offset:8
    ds_read_b64_tr_b16 a[130:131], v30 offset:0
    ds_read_b64_tr_b16 a[138:139], v30 offset:8
    ds_read_b64_tr_b16 a[146:147], v31 offset:0
    ds_read_b64_tr_b16 v[0:1], v31 offset:8
    s_waitcnt vmcnt(12) lgkmcnt(0)
    s_barrier
    s_add_u32 m0, s43, 36864
    s_add_u32 s41, s58, 786432
    buffer_load_dwordx4 v16, s[8:11], s41 offen offset:0 nt lds
    s_add_u32 s41, s58, 801792
    buffer_load_dwordx4 v16, s[8:11], s41 offen offset:1024 nt lds
    s_add_u32 s41, s58, 915456
    buffer_load_dwordx4 v16, s[8:11], s41 offen offset:2048 nt lds
    s_add_u32 s41, s58, 930816
    buffer_load_dwordx4 v16, s[8:11], s41 offen offset:3072 nt lds
    ds_write_b64 v70, v[0:1] offset:12296
    v_add_u32 v28, 73728, v24
    v_add_u32 v29, 73728, v25
    v_add_u32 v30, 73728, v26
    v_add_u32 v31, 73728, v27
    ds_read_b64_tr_b16 a[100:101], v28 offset:0
    ds_read_b64_tr_b16 a[108:109], v28 offset:8
    ds_read_b64_tr_b16 a[116:117], v29 offset:0
    ds_read_b64_tr_b16 a[124:125], v29 offset:8
    ds_read_b64_tr_b16 a[132:133], v30 offset:0
    ds_read_b64_tr_b16 a[140:141], v30 offset:8
    ds_read_b64_tr_b16 a[148:149], v31 offset:0
    ds_read_b64_tr_b16 v[32:33], v31 offset:8
    s_waitcnt vmcnt(12) lgkmcnt(0)
    s_barrier
    s_add_u32 m0, s43, 73728
    s_add_u32 s41, s58, 794624
    buffer_load_dwordx4 v16, s[8:11], s41 offen offset:0 nt lds
    s_add_u32 s41, s58, 809984
    buffer_load_dwordx4 v16, s[8:11], s41 offen offset:1024 nt lds
    s_add_u32 s41, s58, 923648
    buffer_load_dwordx4 v16, s[8:11], s41 offen offset:2048 nt lds
    s_add_u32 s41, s58, 939008
    buffer_load_dwordx4 v16, s[8:11], s41 offen offset:3072 nt lds
    ds_write_b64 v70, v[32:33] offset:13312
    v_add_u32 v28, 110592, v24
    v_add_u32 v29, 110592, v25
    v_add_u32 v30, 110592, v26
    v_add_u32 v31, 110592, v27
    ds_read_b64_tr_b16 a[102:103], v28 offset:0
    ds_read_b64_tr_b16 a[110:111], v28 offset:8
    ds_read_b64_tr_b16 a[118:119], v29 offset:0
    ds_read_b64_tr_b16 a[126:127], v29 offset:8
    ds_read_b64_tr_b16 a[134:135], v30 offset:0
    ds_read_b64_tr_b16 a[142:143], v30 offset:8
    ds_read_b64_tr_b16 a[150:151], v31 offset:0
    ds_read_b64_tr_b16 v[0:1], v31 offset:8
    s_waitcnt vmcnt(12) lgkmcnt(0)
    s_barrier
    s_add_u32 m0, s43, 110592
    s_add_u32 s41, s59, 0
    buffer_load_dwordx4 v17, s[8:11], s41 offen offset:0 nt lds
    s_add_u32 s41, s59, 31744
    buffer_load_dwordx4 v17, s[8:11], s41 offen offset:1024 nt lds
    s_add_u32 s41, s59, 129024
    buffer_load_dwordx4 v17, s[8:11], s41 offen offset:2048 nt lds
    s_add_u32 s41, s59, 160768
    buffer_load_dwordx4 v17, s[8:11], s41 offen offset:3072 nt lds
    ds_write_b64 v70, v[0:1] offset:13320
    v_add_u32 v28, 147456, v24
    v_add_u32 v29, 147456, v25
    v_add_u32 v30, 147456, v26
    v_add_u32 v31, 147456, v27
    ds_read_b64_tr_b16 a[152:153], v28 offset:0
    ds_read_b64_tr_b16 a[160:161], v28 offset:8
    ds_read_b64_tr_b16 v[32:33], v29 offset:0
    ds_read_b64_tr_b16 a[168:169], v29 offset:8
    ds_read_b64_tr_b16 a[176:177], v30 offset:0
    ds_read_b64_tr_b16 a[184:185], v30 offset:8
    ds_read_b64_tr_b16 v[34:35], v31 offset:0
    ds_read_b64_tr_b16 a[192:193], v31 offset:8
    s_waitcnt vmcnt(12) lgkmcnt(0)
    s_barrier
    s_mov_b64 s[8:9], s[50:51]
    s_add_u32 m0, s43, 147456
    s_add_u32 s41, s58, 0
    buffer_load_dwordx4 v16, s[8:11], s41 offen offset:0 nt lds
    s_add_u32 s41, s58, 15360
    buffer_load_dwordx4 v16, s[8:11], s41 offen offset:1024 nt lds
    s_add_u32 s41, s58, 129024
    buffer_load_dwordx4 v16, s[8:11], s41 offen offset:2048 nt lds
    s_add_u32 s41, s58, 144384
    buffer_load_dwordx4 v16, s[8:11], s41 offen offset:3072 nt lds
    s_cmp_lg_u32 s13, 0
    s_cbranch_scc1 cf_ma
    v_mov_b32 v54, 1
    s_mov_b64 exec, 1
    buffer_atomic_add v54, off, s[84:87], 0 offset:132
    s_mov_b64 exec, -1
cf_ma:
    ds_write_b64 v70, v[32:33] offset:16384
    ds_write_b64 v70, v[34:35] offset:18432
    v_add_u32 v28, 0, v24
    v_add_u32 v29, 0, v25
    v_add_u32 v30, 0, v26
    v_add_u32 v31, 0, v27
    ds_read_b64_tr_b16 a[154:155], v28 offset:0
    ds_read_b64_tr_b16 a[162:163], v28 offset:8
    ds_read_b64_tr_b16 v[0:1], v29 offset:0
    ds_read_b64_tr_b16 a[170:171], v29 offset:8
    ds_read_b64_tr_b16 a[178:179], v30 offset:0
    ds_read_b64_tr_b16 a[186:187], v30 offset:8
    ds_read_b64_tr_b16 v[2:3], v31 offset:0
    ds_read_b64_tr_b16 a[194:195], v31 offset:8
    s_waitcnt vmcnt(12) lgkmcnt(0)
    s_barrier
    s_add_u32 m0, s43, 0
    s_add_u32 s41, s58, 8192
    buffer_load_dwordx4 v16, s[8:11], s41 offen offset:0 nt lds
    s_add_u32 s41, s58, 23552
    buffer_load_dwordx4 v16, s[8:11], s41 offen offset:1024 nt lds
    s_add_u32 s41, s58, 137216
    buffer_load_dwordx4 v16, s[8:11], s41 offen offset:2048 nt lds
    s_add_u32 s41, s58, 152576
    buffer_load_dwordx4 v16, s[8:11], s41 offen offset:3072 nt lds
    ds_write_b64 v70, v[0:1] offset:16392
    ds_write_b64 v70, v[2:3] offset:18440
    v_add_u32 v28, 36864, v24
    v_add_u32 v29, 36864, v25
    v_add_u32 v30, 36864, v26
    v_add_u32 v31, 36864, v27
    ds_read_b64_tr_b16 a[156:157], v28 offset:0
    ds_read_b64_tr_b16 a[164:165], v28 offset:8
    ds_read_b64_tr_b16 v[32:33], v29 offset:0
    ds_read_b64_tr_b16 a[172:173], v29 offset:8
    ds_read_b64_tr_b16 a[180:181], v30 offset:0
    ds_read_b64_tr_b16 a[188:189], v30 offset:8
    ds_read_b64_tr_b16 v[34:35], v31 offset:0
    ds_read_b64_tr_b16 a[196:197], v31 offset:8
    s_waitcnt vmcnt(12) lgkmcnt(0)
    s_barrier
    s_add_u32 m0, s43, 36864
    s_add_u32 s41, s58, 262144
    buffer_load_dwordx4 v16, s[8:11], s41 offen offset:0 nt lds
    s_add_u32 s41, s58, 277504
    buffer_load_dwordx4 v16, s[8:11], s41 offen offset:1024 nt lds
    s_add_u32 s41, s58, 391168
    buffer_load_dwordx4 v16, s[8:11], s41 offen offset:2048 nt lds
    s_add_u32 s41, s58, 406528
    buffer_load_dwordx4 v16, s[8:11], s41 offen offset:3072 nt lds
    ds_write_b64 v70, v[32:33] offset:17408
    ds_write_b64 v70, v[34:35] offset:19456
    v_add_u32 v28, 73728, v24
    v_add_u32 v29, 73728, v25
    v_add_u32 v30, 73728, v26
    v_add_u32 v31, 73728, v27
    ds_read_b64_tr_b16 a[158:159], v28 offset:0
    ds_read_b64_tr_b16 a[166:167], v28 offset:8
    ds_read_b64_tr_b16 v[0:1], v29 offset:0
    ds_read_b64_tr_b16 a[174:175], v29 offset:8
    ds_read_b64_tr_b16 a[182:183], v30 offset:0
    ds_read_b64_tr_b16 a[190:191], v30 offset:8
    ds_read_b64_tr_b16 v[2:3], v31 offset:0
    ds_read_b64_tr_b16 a[198:199], v31 offset:8
    s_waitcnt vmcnt(12) lgkmcnt(0)
    s_barrier
    s_add_u32 m0, s43, 73728
    s_add_u32 s41, s58, 270336
    buffer_load_dwordx4 v16, s[8:11], s41 offen offset:0 nt lds
    s_add_u32 s41, s58, 285696
    buffer_load_dwordx4 v16, s[8:11], s41 offen offset:1024 nt lds
    s_add_u32 s41, s58, 399360
    buffer_load_dwordx4 v16, s[8:11], s41 offen offset:2048 nt lds
    s_add_u32 s41, s58, 414720
    buffer_load_dwordx4 v16, s[8:11], s41 offen offset:3072 nt lds
    ds_write_b64 v70, v[0:1] offset:17416
    ds_write_b64 v70, v[2:3] offset:19464
    v_add_u32 v77, 110592, v20
    ds_read_b64_tr_b16 a[200:201], v77 offset:0
    ds_read_b64_tr_b16 a[202:203], v77 offset:4096
    ds_read_b64_tr_b16 a[204:205], v77 offset:8192
    ds_read_b64_tr_b16 a[206:207], v77 offset:12288
    ds_read_b64_tr_b16 a[208:209], v77 offset:8
    ds_read_b64_tr_b16 a[210:211], v77 offset:4104
    ds_read_b64_tr_b16 a[212:213], v77 offset:8200
    ds_read_b64_tr_b16 a[214:215], v77 offset:12296
    s_waitcnt vmcnt(12) lgkmcnt(0)
    s_barrier
    s_add_u32 m0, s43, 110592
    s_add_u32 s41, s58, 524288
    buffer_load_dwordx4 v16, s[8:11], s41 offen offset:0 nt lds
    s_add_u32 s41, s58, 539648
    buffer_load_dwordx4 v16, s[8:11], s41 offen offset:1024 nt lds
    s_add_u32 s41, s58, 653312
    buffer_load_dwordx4 v16, s[8:11], s41 offen offset:2048 nt lds
    s_add_u32 s41, s58, 668672
    buffer_load_dwordx4 v16, s[8:11], s41 offen offset:3072 nt lds
    v_add_u32 v28, 147456, v24
    v_add_u32 v29, 147456, v25
    v_add_u32 v30, 147456, v26
    v_add_u32 v31, 147456, v27
    ds_read_b64_tr_b16 v[0:1], v28 offset:0
    ds_read_b64_tr_b16 v[2:3], v28 offset:8
    ds_read_b64_tr_b16 v[4:5], v29 offset:0
    ds_read_b64_tr_b16 v[6:7], v29 offset:8
    ds_read_b64_tr_b16 a[0:1], v30 offset:0
    ds_read_b64_tr_b16 v[8:9], v30 offset:8
    ds_read_b64_tr_b16 a[8:9], v31 offset:0
    ds_read_b64_tr_b16 v[10:11], v31 offset:8
    s_waitcnt vmcnt(12) lgkmcnt(0)
    s_barrier
    s_add_u32 m0, s43, 147456
    s_add_u32 s41, s58, 532480
    buffer_load_dwordx4 v16, s[8:11], s41 offen offset:0 nt lds
    s_add_u32 s41, s58, 547840
    buffer_load_dwordx4 v16, s[8:11], s41 offen offset:1024 nt lds
    s_add_u32 s41, s58, 661504
    buffer_load_dwordx4 v16, s[8:11], s41 offen offset:2048 nt lds
    s_add_u32 s41, s58, 676864
    buffer_load_dwordx4 v16, s[8:11], s41 offen offset:3072 nt lds
    ds_write_b64 v70, v[0:1] offset:0
    ds_write_b64 v70, v[2:3] offset:2048
    ds_write_b64 v70, v[4:5] offset:4096
    ds_write_b64 v70, v[6:7] offset:6144
    ds_write_b64 v70, v[8:9] offset:10240
    ds_write_b64 v70, v[10:11] offset:14336
    v_add_u32 v28, 0, v24
    v_add_u32 v29, 0, v25
    v_add_u32 v30, 0, v26
    v_add_u32 v31, 0, v27
    ds_read_b64_tr_b16 v[32:33], v28 offset:0
    ds_read_b64_tr_b16 v[34:35], v28 offset:8
    ds_read_b64_tr_b16 v[36:37], v29 offset:0
    ds_read_b64_tr_b16 v[38:39], v29 offset:8
    ds_read_b64_tr_b16 a[2:3], v30 offset:0
    ds_read_b64_tr_b16 v[40:41], v30 offset:8
    ds_read_b64_tr_b16 a[10:11], v31 offset:0
    ds_read_b64_tr_b16 v[42:43], v31 offset:8
    s_waitcnt vmcnt(12) lgkmcnt(0)
    s_barrier
    s_add_u32 m0, s43, 0
    s_add_u32 s41, s58, 786432
    buffer_load_dwordx4 v16, s[8:11], s41 offen offset:0 nt lds
    s_add_u32 s41, s58, 801792
    buffer_load_dwordx4 v16, s[8:11], s41 offen offset:1024 nt lds
    s_add_u32 s41, s58, 915456
    buffer_load_dwordx4 v16, s[8:11], s41 offen offset:2048 nt lds
    s_add_u32 s41, s58, 930816
    buffer_load_dwordx4 v16, s[8:11], s41 offen offset:3072 nt lds
    ds_write_b64 v70, v[32:33] offset:8
    ds_write_b64 v70, v[34:35] offset:2056
    ds_write_b64 v70, v[36:37] offset:4104
    ds_write_b64 v70, v[38:39] offset:6152
    ds_write_b64 v70, v[40:41] offset:10248
    ds_write_b64 v70, v[42:43] offset:14344
    v_add_u32 v28, 36864, v24
    v_add_u32 v29, 36864, v25
    v_add_u32 v30, 36864, v26
    v_add_u32 v31, 36864, v27
    ds_read_b64_tr_b16 v[0:1], v28 offset:0
    ds_read_b64_tr_b16 v[2:3], v28 offset:8
    ds_read_b64_tr_b16 v[4:5], v29 offset:0
    ds_read_b64_tr_b16 v[6:7], v29 offset:8
    ds_read_b64_tr_b16 a[4:5], v30 offset:0
    ds_read_b64_tr_b16 v[8:9], v30 offset:8
    ds_read_b64_tr_b16 a[12:13], v31 offset:0
    ds_read_b64_tr_b16 v[10:11], v31 offset:8
    s_waitcnt vmcnt(12) lgkmcnt(0)
    s_barrier
    s_add_u32 m0, s43, 36864
    s_add_u32 s41, s58, 794624
    buffer_load_dwordx4 v16, s[8:11], s41 offen offset:0 nt lds
    s_add_u32 s41, s58, 809984
    buffer_load_dwordx4 v16, s[8:11], s41 offen offset:1024 nt lds
    s_add_u32 s41, s58, 923648
    buffer_load_dwordx4 v16, s[8:11], s41 offen offset:2048 nt lds
    s_add_u32 s41, s58, 939008
    buffer_load_dwordx4 v16, s[8:11], s41 offen offset:3072 nt lds
    ds_write_b64 v70, v[0:1] offset:1024
    ds_write_b64 v70, v[2:3] offset:3072
    ds_write_b64 v70, v[4:5] offset:5120
    ds_write_b64 v70, v[6:7] offset:7168
    ds_write_b64 v70, v[8:9] offset:11264
    ds_write_b64 v70, v[10:11] offset:15360
    v_add_u32 v28, 73728, v24
    v_add_u32 v29, 73728, v25
    v_add_u32 v30, 73728, v26
    v_add_u32 v31, 73728, v27
    ds_read_b64_tr_b16 v[32:33], v28 offset:0
    ds_read_b64_tr_b16 v[34:35], v28 offset:8
    ds_read_b64_tr_b16 v[36:37], v29 offset:0
    ds_read_b64_tr_b16 v[38:39], v29 offset:8
    ds_read_b64_tr_b16 a[6:7], v30 offset:0
    ds_read_b64_tr_b16 v[40:41], v30 offset:8
    ds_read_b64_tr_b16 a[14:15], v31 offset:0
    ds_read_b64_tr_b16 v[42:43], v31 offset:8
    s_waitcnt vmcnt(12) lgkmcnt(0)
    s_barrier
    s_add_u32 m0, s43, 73728
    s_add_u32 s41, s59, 0
    buffer_load_dwordx4 v17, s[8:11], s41 offen offset:0 nt lds
    s_add_u32 s41, s59, 31744
    buffer_load_dwordx4 v17, s[8:11], s41 offen offset:1024 nt lds
    s_add_u32 s41, s59, 129024
    buffer_load_dwordx4 v17, s[8:11], s41 offen offset:2048 nt lds
    s_add_u32 s41, s59, 160768
    buffer_load_dwordx4 v17, s[8:11], s41 offen offset:3072 nt lds
    ds_write_b64 v70, v[32:33] offset:1032
    ds_write_b64 v70, v[34:35] offset:3080
    ds_write_b64 v70, v[36:37] offset:5128
    ds_write_b64 v70, v[38:39] offset:7176
    ds_write_b64 v70, v[40:41] offset:11272
    ds_write_b64 v70, v[42:43] offset:15368
    v_add_u32 v28, 110592, v24
    v_add_u32 v29, 110592, v25
    v_add_u32 v30, 110592, v26
    v_add_u32 v31, 110592, v27
    ds_read_b64_tr_b16 a[16:17], v28 offset:0
    ds_read_b64_tr_b16 a[24:25], v28 offset:8
    ds_read_b64_tr_b16 a[32:33], v29 offset:0
    ds_read_b64_tr_b16 a[40:41], v29 offset:8
    ds_read_b64_tr_b16 a[48:49], v30 offset:0
    ds_read_b64_tr_b16 a[56:57], v30 offset:8
    ds_read_b64_tr_b16 a[64:65], v31 offset:0
    ds_read_b64_tr_b16 a[72:73], v31 offset:8
    s_waitcnt vmcnt(12) lgkmcnt(0)
    s_barrier
    s_mov_b64 s[8:9], s[54:55]
    s_add_u32 m0, s43, 110592
    s_add_u32 s41, s58, 0
    buffer_load_dwordx4 v16, s[8:11], s41 offen offset:0 nt lds
    s_add_u32 s41, s58, 15360
    buffer_load_dwordx4 v16, s[8:11], s41 offen offset:1024 nt lds
    s_add_u32 s41, s58, 129024
    buffer_load_dwordx4 v16, s[8:11], s41 offen offset:2048 nt lds
    s_add_u32 s41, s58, 144384
    buffer_load_dwordx4 v16, s[8:11], s41 offen offset:3072 nt lds
    v_add_u32 v28, 147456, v24
    v_add_u32 v29, 147456, v25
    v_add_u32 v30, 147456, v26
    v_add_u32 v31, 147456, v27
    ds_read_b64_tr_b16 a[18:19], v28 offset:0
    ds_read_b64_tr_b16 a[26:27], v28 offset:8
    ds_read_b64_tr_b16 a[34:35], v29 offset:0
    ds_read_b64_tr_b16 a[42:43], v29 offset:8
    ds_read_b64_tr_b16 a[50:51], v30 offset:0
    ds_read_b64_tr_b16 a[58:59], v30 offset:8
    ds_read_b64_tr_b16 a[66:67], v31 offset:0
    ds_read_b64_tr_b16 a[74:75], v31 offset:8
    s_waitcnt vmcnt(12) lgkmcnt(0)
    s_barrier
    s_add_u32 m0, s43, 147456
    s_add_u32 s41, s58, 8192
    buffer_load_dwordx4 v16, s[8:11], s41 offen offset:0 nt lds
    s_add_u32 s41, s58, 23552
    buffer_load_dwordx4 v16, s[8:11], s41 offen offset:1024 nt lds
    s_add_u32 s41, s58, 137216
    buffer_load_dwordx4 v16, s[8:11], s41 offen offset:2048 nt lds
    s_add_u32 s41, s58, 152576
    buffer_load_dwordx4 v16, s[8:11], s41 offen offset:3072 nt lds
    v_add_u32 v28, 0, v24
    v_add_u32 v29, 0, v25
    v_add_u32 v30, 0, v26
    v_add_u32 v31, 0, v27
    ds_read_b64_tr_b16 a[20:21], v28 offset:0
    ds_read_b64_tr_b16 a[28:29], v28 offset:8
    ds_read_b64_tr_b16 a[36:37], v29 offset:0
    ds_read_b64_tr_b16 a[44:45], v29 offset:8
    ds_read_b64_tr_b16 a[52:53], v30 offset:0
    ds_read_b64_tr_b16 a[60:61], v30 offset:8
    ds_read_b64_tr_b16 a[68:69], v31 offset:0
    ds_read_b64_tr_b16 a[76:77], v31 offset:8
    s_waitcnt vmcnt(12) lgkmcnt(0)
    s_barrier
    s_add_u32 m0, s43, 0
    s_add_u32 s41, s58, 262144
    buffer_load_dwordx4 v16, s[8:11], s41 offen offset:0 nt lds
    s_add_u32 s41, s58, 277504
    buffer_load_dwordx4 v16, s[8:11], s41 offen offset:1024 nt lds
    s_add_u32 s41, s58, 391168
    buffer_load_dwordx4 v16, s[8:11], s41 offen offset:2048 nt lds
    s_add_u32 s41, s58, 406528
    buffer_load_dwordx4 v16, s[8:11], s41 offen offset:3072 nt lds
    v_add_u32 v28, 36864, v24
    v_add_u32 v29, 36864, v25
    v_add_u32 v30, 36864, v26
    v_add_u32 v31, 36864, v27
    ds_read_b64_tr_b16 a[22:23], v28 offset:0
    ds_read_b64_tr_b16 a[30:31], v28 offset:8
    ds_read_b64_tr_b16 a[38:39], v29 offset:0
    ds_read_b64_tr_b16 a[46:47], v29 offset:8
    ds_read_b64_tr_b16 a[54:55], v30 offset:0
    ds_read_b64_tr_b16 a[62:63], v30 offset:8
    ds_read_b64_tr_b16 a[70:71], v31 offset:0
    ds_read_b64_tr_b16 a[78:79], v31 offset:8
    s_waitcnt vmcnt(12) lgkmcnt(0)
    s_barrier
    s_add_u32 m0, s43, 36864
    s_add_u32 s41, s58, 270336
    buffer_load_dwordx4 v16, s[8:11], s41 offen offset:0 nt lds
    s_add_u32 s41, s58, 285696
    buffer_load_dwordx4 v16, s[8:11], s41 offen offset:1024 nt lds
    s_add_u32 s41, s58, 399360
    buffer_load_dwordx4 v16, s[8:11], s41 offen offset:2048 nt lds
    s_add_u32 s41, s58, 414720
    buffer_load_dwordx4 v16, s[8:11], s41 offen offset:3072 nt lds
    s_lshl_b32 s26, s12, 14
    s_add_u32 s26, s26, 0
    s_mul_i32 s40, s13, 3072
    s_add_u32 s24, s26, s40
    s_lshl_b32 s96, s12, 7
    s_add_u32 s29, s96, 125845504
    s_add_u32 s96, s96, 125829120
    v_bfe_u32 v78, v65, 2, 5
    buffer_load_dword v54, off, s[84:87], 0 offset:132 sc1
    buffer_load_dword v55, off, s[84:87], 0 offset:216 sc1
    buffer_load_dword v56, v78, s[4:7], s96 offen offset:16 sc1
    v_add_u32 v77, 73728, v20
    ds_read_b64_tr_b16 a[80:81], v77 offset:0
    ds_read_b64_tr_b16 a[82:83], v77 offset:4096
    ds_read_b64_tr_b16 a[84:85], v77 offset:8192
    ds_read_b64_tr_b16 a[86:87], v77 offset:12288
    ds_read_b64_tr_b16 a[88:89], v77 offset:8
    ds_read_b64_tr_b16 a[90:91], v77 offset:4104
    ds_read_b64_tr_b16 a[92:93], v77 offset:8200
    ds_read_b64_tr_b16 a[94:95], v77 offset:12296
    s_waitcnt vmcnt(12) lgkmcnt(0)
    s_barrier
    s_add_u32 m0, s43, 73728
    s_add_u32 s41, s58, 524288
    buffer_load_dwordx4 v16, s[8:11], s41 offen offset:0 nt lds
    s_add_u32 s41, s58, 539648
    buffer_load_dwordx4 v16, s[8:11], s41 offen offset:1024 nt lds
    s_add_u32 s41, s58, 653312
    buffer_load_dwordx4 v16, s[8:11], s41 offen offset:2048 nt lds
    s_add_u32 s41, s58, 668672
    buffer_load_dwordx4 v16, s[8:11], s41 offen offset:3072 nt lds
    v_add_u32 v28, 110592, v24
    v_add_u32 v29, 110592, v25
    v_add_u32 v30, 110592, v26
    v_add_u32 v31, 110592, v27
    ds_read_b64_tr_b16 a[216:217], v28 offset:0
    ds_read_b64_tr_b16 v[32:33], v28 offset:8
    ds_read_b64_tr_b16 a[224:225], v29 offset:0
    ds_read_b64_tr_b16 a[232:233], v29 offset:8
    ds_read_b64_tr_b16 a[240:241], v30 offset:0
    ds_read_b64_tr_b16 a[248:249], v30 offset:8
    ds_read_b64_tr_b16 v[160:161], v31 offset:0
    ds_read_b64_tr_b16 v[168:169], v31 offset:8
    s_waitcnt vmcnt(12) lgkmcnt(0)
    s_barrier
    s_add_u32 m0, s43, 110592
    s_add_u32 s41, s58, 532480
    buffer_load_dwordx4 v16, s[8:11], s41 offen offset:0 nt lds
    s_add_u32 s41, s58, 547840
    buffer_load_dwordx4 v16, s[8:11], s41 offen offset:1024 nt lds
    s_add_u32 s41, s58, 661504
    buffer_load_dwordx4 v16, s[8:11], s41 offen offset:2048 nt lds
    s_add_u32 s41, s58, 676864
    buffer_load_dwordx4 v16, s[8:11], s41 offen offset:3072 nt lds
    ds_write_b64 v70, v[32:33] offset:8192
    v_add_u32 v28, 147456, v24
    v_add_u32 v29, 147456, v25
    v_add_u32 v30, 147456, v26
    v_add_u32 v31, 147456, v27
    ds_read_b64_tr_b16 a[218:219], v28 offset:0
    ds_read_b64_tr_b16 v[0:1], v28 offset:8
    ds_read_b64_tr_b16 a[226:227], v29 offset:0
    ds_read_b64_tr_b16 a[234:235], v29 offset:8
    ds_read_b64_tr_b16 a[242:243], v30 offset:0
    ds_read_b64_tr_b16 a[250:251], v30 offset:8
    ds_read_b64_tr_b16 v[162:163], v31 offset:0
    ds_read_b64_tr_b16 v[170:171], v31 offset:8
    s_waitcnt vmcnt(12) lgkmcnt(0)
    s_barrier
    s_add_u32 m0, s43, 147456
    s_add_u32 s41, s58, 786432
    buffer_load_dwordx4 v16, s[8:11], s41 offen offset:0 nt lds
    s_add_u32 s41, s58, 801792
    buffer_load_dwordx4 v16, s[8:11], s41 offen offset:1024 nt lds
    s_add_u32 s41, s58, 915456
    buffer_load_dwordx4 v16, s[8:11], s41 offen offset:2048 nt lds
    s_add_u32 s41, s58, 930816
    buffer_load_dwordx4 v16, s[8:11], s41 offen offset:3072 nt lds
    ds_write_b64 v70, v[0:1] offset:8200
    v_add_u32 v28, 0, v24
    v_add_u32 v29, 0, v25
    v_add_u32 v30, 0, v26
    v_add_u32 v31, 0, v27
    ds_read_b64_tr_b16 a[220:221], v28 offset:0
    ds_read_b64_tr_b16 v[32:33], v28 offset:8
    ds_read_b64_tr_b16 a[228:229], v29 offset:0
    ds_read_b64_tr_b16 a[236:237], v29 offset:8
    ds_read_b64_tr_b16 a[244:245], v30 offset:0
    ds_read_b64_tr_b16 a[252:253], v30 offset:8
    ds_read_b64_tr_b16 v[164:165], v31 offset:0
    ds_read_b64_tr_b16 v[172:173], v31 offset:8
    s_waitcnt vmcnt(12) lgkmcnt(0)
    s_barrier
    s_add_u32 m0, s43, 0
    s_add_u32 s41, s58, 794624
    buffer_load_dwordx4 v16, s[8:11], s41 offen offset:0 nt lds
    s_add_u32 s41, s58, 809984
    buffer_load_dwordx4 v16, s[8:11], s41 offen offset:1024 nt lds
    s_add_u32 s41, s58, 923648
    buffer_load_dwordx4 v16, s[8:11], s41 offen offset:2048 nt lds
    s_add_u32 s41, s58, 939008
    buffer_load_dwordx4 v16, s[8:11], s41 offen offset:3072 nt lds
    ds_write_b64 v70, v[32:33] offset:9216
    v_add_u32 v28, 36864, v24
    v_add_u32 v29, 36864, v25
    v_add_u32 v30, 36864, v26
    v_add_u32 v31, 36864, v27
    ds_read_b64_tr_b16 a[222:223], v28 offset:0
    ds_read_b64_tr_b16 v[0:1], v28 offset:8
    ds_read_b64_tr_b16 a[230:231], v29 offset:0
    ds_read_b64_tr_b16 a[238:239], v29 offset:8
    ds_read_b64_tr_b16 a[246:247], v30 offset:0
    ds_read_b64_tr_b16 a[254:255], v30 offset:8
    ds_read_b64_tr_b16 v[166:167], v31 offset:0
    ds_read_b64_tr_b16 v[174:175], v31 offset:8
    s_waitcnt vmcnt(12) lgkmcnt(0)
    s_barrier
    s_add_u32 m0, s43, 36864
    s_add_u32 s41, s59, 0
    buffer_load_dwordx4 v17, s[8:11], s41 offen offset:0 nt lds
    s_add_u32 s41, s59, 31744
    buffer_load_dwordx4 v17, s[8:11], s41 offen offset:1024 nt lds
    s_add_u32 s41, s59, 129024
    buffer_load_dwordx4 v17, s[8:11], s41 offen offset:2048 nt lds
    s_add_u32 s41, s59, 160768
    buffer_load_dwordx4 v17, s[8:11], s41 offen offset:3072 nt lds
    v_readfirstlane_b32 s94, v54
    v_readfirstlane_b32 s95, v55
    v_mov_b32 v77, v56
    s_nop 0
    v_subrev_u32 v77, s95, v77
    v_cmp_lt_u32 vcc, 16, v77
    s_nop 1
    v_cndmask_b32 v77, v77, 0, vcc
    v_bfe_u32 v79, v78, 2, 2
    v_lshl_add_u32 v77, v77, 2, v79
    s_nop 1
    v_min_u32_dpp v77, v77, v77 row_ror:1 row_mask:0xf bank_mask:0xf
    s_nop 1
    v_min_u32_dpp v77, v77, v77 row_ror:2 row_mask:0xf bank_mask:0xf
    s_nop 1
    v_min_u32_dpp v77, v77, v77 row_ror:4 row_mask:0xf bank_mask:0xf
    s_nop 0
    v_readfirstlane_b32 s97, v77
    s_cmp_eq_u32 s95, 0
    s_cselect_b32 s97, 0, s97
    s_cmp_lt_u32 s97, 3
    s_cbranch_scc1 cf_mb
    s_add_u32 s40, s26, 0
    v_lshlrev_b32 v78, 2, v65
    buffer_load_dword v58, v78, s[4:7], s40 offen sc1
    s_add_u32 s40, s26, 524288
    v_lshlrev_b32 v78, 2, v65
    buffer_load_dword v58, v78, s[4:7], s40 offen sc1
cf_mb:
    s_cmp_lt_u32 s94, 32
    s_cbranch_scc1 cf_mc
    s_cmp_lg_u32 s13, 0
    s_cbranch_scc1 cf_mc
    v_mov_b32 v76, 1
    v_mov_b32 v77, 0
    s_mov_b64 exec, 1
    buffer_atomic_cmpswap v[76:77], off, s[84:87], 0 offset:28 sc0
    s_mov_b64 exec, -1
cf_mc:
    s_nop 1
    ds_write_b64 v70, v[0:1] offset:9224
    v_add_u32 v28, 73728, v24
    v_add_u32 v29, 73728, v25
    v_add_u32 v30, 73728, v26
    v_add_u32 v31, 73728, v27
    ds_read_b64_tr_b16 v[176:177], v28 offset:0
    ds_read_b64_tr_b16 v[184:185], v28 offset:8
    ds_read_b64_tr_b16 v[192:193], v29 offset:0
    ds_read_b64_tr_b16 v[200:201], v29 offset:8
    ds_read_b64_tr_b16 v[208:209], v30 offset:0
    ds_read_b64_tr_b16 v[216:217], v30 offset:8
    ds_read_b64_tr_b16 v[224:225], v31 offset:0
    ds_read_b64_tr_b16 v[232:233], v31 offset:8
    s_waitcnt vmcnt(12) lgkmcnt(0)
    s_barrier
    s_mov_b64 s[8:9], s[56:57]
    s_add_u32 m0, s43, 73728
    s_add_u32 s41, s60, 128
    buffer_load_dwordx4 v18, s[8:11], s41 offen offset:0 nt lds
    s_add_u32 s41, s60, 8320
    buffer_load_dwordx4 v18, s[8:11], s41 offen offset:1024 nt lds
    s_add_u32 s41, s60, 16512
    buffer_load_dwordx4 v18, s[8:11], s41 offen offset:2048 nt lds
    s_add_u32 s41, s60, 24704
    buffer_load_dwordx4 v18, s[8:11], s41 offen offset:3072 nt lds
    v_add_u32 v28, 110592, v24
    v_add_u32 v29, 110592, v25
    v_add_u32 v30, 110592, v26
    v_add_u32 v31, 110592, v27
    ds_read_b64_tr_b16 v[178:179], v28 offset:0
    ds_read_b64_tr_b16 v[186:187], v28 offset:8
    ds_read_b64_tr_b16 v[194:195], v29 offset:0
    ds_read_b64_tr_b16 v[202:203], v29 offset:8
    ds_read_b64_tr_b16 v[210:211], v30 offset:0
    ds_read_b64_tr_b16 v[218:219], v30 offset:8
    ds_read_b64_tr_b16 v[226:227], v31 offset:0
    ds_read_b64_tr_b16 v[234:235], v31 offset:8
    s_waitcnt vmcnt(12) lgkmcnt(0)
    s_barrier
    s_add_u32 m0, s43, 110592
    s_add_u32 s41, s61, 128
    buffer_load_dwordx4 v18, s[8:11], s41 offen offset:0 nt lds
    s_add_u32 s41, s61, 8320
    buffer_load_dwordx4 v18, s[8:11], s41 offen offset:1024 nt lds
    s_add_u32 s41, s61, 16512
    buffer_load_dwordx4 v18, s[8:11], s41 offen offset:2048 nt lds
    s_add_u32 s41, s61, 24704
    buffer_load_dwordx4 v18, s[8:11], s41 offen offset:3072 nt lds
    v_add_u32 v28, 147456, v24
    v_add_u32 v29, 147456, v25
    v_add_u32 v30, 147456, v26
    v_add_u32 v31, 147456, v27
    ds_read_b64_tr_b16 v[180:181], v28 offset:0
    ds_read_b64_tr_b16 v[188:189], v28 offset:8
    ds_read_b64_tr_b16 v[196:197], v29 offset:0
    ds_read_b64_tr_b16 v[204:205], v29 offset:8
    ds_read_b64_tr_b16 v[212:213], v30 offset:0
    ds_read_b64_tr_b16 v[220:221], v30 offset:8
    ds_read_b64_tr_b16 v[228:229], v31 offset:0
    ds_read_b64_tr_b16 v[236:237], v31 offset:8
    s_waitcnt vmcnt(12) lgkmcnt(0)
    s_barrier
    s_add_u32 m0, s43, 147456
    s_add_u32 s41, s62, 128
    buffer_load_dwordx4 v18, s[8:11], s41 offen offset:0 nt lds
    s_add_u32 s41, s62, 8320
    buffer_load_dwordx4 v18, s[8:11], s41 offen offset:1024 nt lds
    s_add_u32 s41, s62, 16512
    buffer_load_dwordx4 v18, s[8:11], s41 offen offset:2048 nt lds
    s_add_u32 s41, s62, 24704
    buffer_load_dwordx4 v18, s[8:11], s41 offen offset:3072 nt lds
    v_add_u32 v28, 0, v24
    v_add_u32 v29, 0, v25
    v_add_u32 v30, 0, v26
    v_add_u32 v31, 0, v27
    ds_read_b64_tr_b16 v[182:183], v28 offset:0
    ds_read_b64_tr_b16 v[190:191], v28 offset:8
    ds_read_b64_tr_b16 v[198:199], v29 offset:0
    ds_read_b64_tr_b16 v[206:207], v29 offset:8
    ds_read_b64_tr_b16 v[214:215], v30 offset:0
    ds_read_b64_tr_b16 v[222:223], v30 offset:8
    ds_read_b64_tr_b16 v[230:231], v31 offset:0
    ds_read_b64_tr_b16 v[238:239], v31 offset:8
    s_waitcnt vmcnt(12) lgkmcnt(0)
    s_barrier
    s_add_u32 m0, s43, 0
    s_add_u32 s41, s63, 128
    buffer_load_dwordx4 v18, s[8:11], s41 offen offset:0 nt lds
    s_add_u32 s41, s63, 8320
    buffer_load_dwordx4 v18, s[8:11], s41 offen offset:1024 nt lds
    s_add_u32 s41, s63, 16512
    buffer_load_dwordx4 v18, s[8:11], s41 offen offset:2048 nt lds
    s_add_u32 s41, s63, 24704
    buffer_load_dwordx4 v18, s[8:11], s41 offen offset:3072 nt lds
    v_mov_b32 v78, v21
    v_mov_b32 v79, v22
    v_add_u32 v77, 36864, v20
    ds_read_b64_tr_b16 v[240:241], v77 offset:0
    ds_read_b64_tr_b16 v[242:243], v77 offset:4096
    ds_read_b64_tr_b16 v[244:245], v77 offset:8192
    ds_read_b64_tr_b16 v[246:247], v77 offset:12288
    ds_read_b64_tr_b16 v[248:249], v77 offset:8
    ds_read_b64_tr_b16 v[250:251], v77 offset:4104
    ds_read_b64_tr_b16 v[252:253], v77 offset:8200
    ds_read_b64_tr_b16 v[254:255], v77 offset:12296
    s_waitcnt vmcnt(12) lgkmcnt(0)
    s_barrier
    v_add_u32 v77, 73728, v79
    s_waitcnt lgkmcnt(0)
    ds_read_b64_tr_b16 v[0:1], v77 offset:0
    ds_read_b64_tr_b16 v[2:3], v77 offset:256
    ds_read_b64_tr_b16 v[4:5], v77 offset:2048
    ds_read_b64_tr_b16 v[6:7], v77 offset:2304
    ds_read_b64_tr_b16 v[8:9], v77 offset:8
    ds_read_b64_tr_b16 v[10:11], v77 offset:264
    ds_read_b64_tr_b16 v[12:13], v77 offset:2056
    ds_read_b64_tr_b16 v[14:15], v77 offset:2312
    s_waitcnt vmcnt(8) lgkmcnt(0)
    s_barrier
    v_add_u32 v77, 110592, v78
    ds_read_b64_tr_b16 v[16:17], v77 offset:0
    ds_read_b64_tr_b16 v[18:19], v77 offset:256
    ds_read_b64_tr_b16 v[20:21], v77 offset:2048
    ds_read_b64_tr_b16 v[22:23], v77 offset:2304
    ds_read_b64_tr_b16 v[24:25], v77 offset:8
    ds_read_b64_tr_b16 v[26:27], v77 offset:264
    ds_read_b64_tr_b16 v[28:29], v77 offset:2056
    ds_read_b64_tr_b16 v[30:31], v77 offset:2312
    s_waitcnt vmcnt(4) lgkmcnt(0)
    s_barrier
    v_add_u32 v77, 147456, v78
    ds_read_b64_tr_b16 v[32:33], v77 offset:0
    ds_read_b64_tr_b16 v[34:35], v77 offset:256
    ds_read_b64_tr_b16 v[36:37], v77 offset:2048
    ds_read_b64_tr_b16 v[38:39], v77 offset:2304
    ds_read_b64_tr_b16 v[40:41], v77 offset:8
    ds_read_b64_tr_b16 v[42:43], v77 offset:264
    ds_read_b64_tr_b16 v[44:45], v77 offset:2056
    ds_read_b64_tr_b16 v[46:47], v77 offset:2312
    s_waitcnt vmcnt(0) lgkmcnt(0)
    s_barrier
    v_add_u32 v77, 0, v78
    ds_read_b64_tr_b16 v[48:49], v77 offset:0
    ds_read_b64_tr_b16 v[50:51], v77 offset:256
    ds_read_b64_tr_b16 v[52:53], v77 offset:2048
    ds_read_b64_tr_b16 v[54:55], v77 offset:2304
    ds_read_b64_tr_b16 v[56:57], v77 offset:8
    ds_read_b64_tr_b16 v[58:59], v77 offset:264
    ds_read_b64_tr_b16 v[60:61], v77 offset:2056
    ds_read_b64_tr_b16 v[62:63], v77 offset:2312
    s_waitcnt lgkmcnt(0)
    s_barrier
    ds_write_b128 v70, v[0:3] offset:20480
    ds_write_b128 v70, v[4:7] offset:21504
    ds_write_b128 v70, v[8:11] offset:22528
    ds_write_b128 v70, v[12:15] offset:23552
    ds_write_b128 v70, v[16:19] offset:24576
    ds_write_b128 v70, v[20:23] offset:25600
    ds_write_b128 v70, v[24:27] offset:26624
    ds_write_b128 v70, v[28:31] offset:27648
    ds_write_b128 v70, v[32:35] offset:28672
    ds_write_b128 v70, v[36:39] offset:29696
    ds_write_b128 v70, v[40:43] offset:30720
    ds_write_b128 v70, v[44:47] offset:31744
    ds_write_b128 v70, v[48:51] offset:32768
    ds_write_b128 v70, v[52:55] offset:33792
    ds_write_b128 v70, v[56:59] offset:34816
    ds_write_b128 v70, v[60:63] offset:35840
    s_waitcnt lgkmcnt(0)
    v_bfe_u32 v60, v65, 4, 6
    v_and_b32 v61, 15, v60
    v_lshrrev_b32 v62, 4, v60
    v_mov_b32 v50, 0x3f80
    v_mov_b32 v51, 0x3f800000
    v_and_b32 v77, 1, v62
    v_lshlrev_b32 v77, 2, v77
    v_sub_u32 v77, v61, v77
    v_and_b32 v78, 3, v61
    v_lshlrev_b32 v78, 2, v78
    v_lshrrev_b32 v79, 2, v61
    v_add_u32 v78, v78, v79
    v_cmp_eq_u32 vcc, 0, v77
    s_nop 1
    v_cndmask_b32 v8, 0, v50, vcc
    v_cmp_eq_u32 vcc, 1, v77
    s_nop 1
    v_cndmask_b32 v8, v8, v51, vcc
    v_cmp_eq_u32 vcc, 0, v78
    s_nop 1
    v_cndmask_b32 v12, 0, v50, vcc
    v_cmp_eq_u32 vcc, 1, v78
    s_nop 1
    v_cndmask_b32 v12, v12, v51, vcc
    v_cmp_eq_u32 vcc, 2, v77
    s_nop 1
    v_cndmask_b32 v9, 0, v50, vcc
    v_cmp_eq_u32 vcc, 3, v77
    s_nop 1
    v_cndmask_b32 v9, v9, v51, vcc
    v_cmp_eq_u32 vcc, 2, v78
    s_nop 1
    v_cndmask_b32 v13, 0, v50, vcc
    v_cmp_eq_u32 vcc, 3, v78
    s_nop 1
    v_cndmask_b32 v13, v13, v51, vcc
    v_cmp_eq_u32 vcc, 8, v77
    s_nop 1
    v_cndmask_b32 v10, 0, v50, vcc
    v_cmp_eq_u32 vcc, 9, v77
    s_nop 1
    v_cndmask_b32 v10, v10, v51, vcc
    v_cmp_eq_u32 vcc, 4, v78
    s_nop 1
    v_cndmask_b32 v14, 0, v50, vcc
    v_cmp_eq_u32 vcc, 5, v78
    s_nop 1
    v_cndmask_b32 v14, v14, v51, vcc
    v_cmp_eq_u32 vcc, 10, v77
    s_nop 1
    v_cndmask_b32 v11, 0, v50, vcc
    v_cmp_eq_u32 vcc, 11, v77
    s_nop 1
    v_cndmask_b32 v11, v11, v51, vcc
    v_cmp_eq_u32 vcc, 6, v78
    s_nop 1
    v_cndmask_b32 v15, 0, v50, vcc
    v_cmp_eq_u32 vcc, 7, v78
    s_nop 1
    v_cndmask_b32 v15, v15, v51, vcc
    v_lshlrev_b32 v77, 4, v61
    ds_write_b128 v69, v[8:11] offset:15360
    ds_write_b128 v77, v[12:15] offset:15872
    s_waitcnt vmcnt(0) lgkmcnt(0)
    s_cmp_lg_u32 s95, 0
    s_cbranch_scc1 cf_hn
    s_mov_b32 s88, 4194304
gn2:
    buffer_load_dword v2, off, s[84:87], 0 offset:216 sc1
    s_waitcnt vmcnt(0)
    v_readfirstlane_b32 s95, v2
    s_sub_u32 s88, s88, 1
    s_cbranch_scc1 gn2x
    s_cmp_eq_u32 s95, 0
    s_cbranch_scc1 gn2
gn2x:
cf_hn:
    v_mov_b32 v2, 1
    s_cmp_lg_u32 s13, 0
    s_cbranch_scc1 cf_noarr
    s_mov_b64 exec, 1
    s_mov_b32 s42, 1
    v_mov_b32 v4, v76
    s_cmp_ge_u32 s94, 32
    s_cbranch_scc1 cf_have
    s_mov_b32 s40, 131072
    s_mov_b32 s42, 2
cf_startpoll:
    buffer_load_dword v3, off, s[84:87], 0 offset:132 sc1
    s_sub_u32 s40, s40, 1
    s_cbranch_scc1 cf_decide
    s_waitcnt vmcnt(0)
    v_readfirstlane_b32 s41, v3
    s_nop 1
    s_cmp_lt_u32 s41, 32
    s_cbranch_scc1 cf_startpoll
    s_mov_b32 s42, 1
cf_decide:
    v_mov_b32 v4, s42
    v_mov_b32 v5, 0
    buffer_atomic_cmpswap v[4:5], off, s[84:87], 0 offset:28 sc0
    s_waitcnt vmcnt(0)
cf_have:
    v_mov_b32 v5, s42
    v_cmp_eq_u32 vcc, 0, v4
    s_nop 1
    v_cndmask_b32 v4, v4, v5, vcc
    v_mov_b32 v5, 16192
    ds_write_b32 v5, v4
    s_waitcnt lgkmcnt(0)
    s_mov_b64 exec, -1
cf_noarr:
    s_barrier
    v_mov_b32 v5, 16192
    ds_read_b32 v4, v5
    s_waitcnt lgkmcnt(0)
    v_readfirstlane_b32 s41, v4
    s_nop 1
    s_cmp_eq_u32 s41, 1
    s_cbranch_scc1 cf_run
    v_lshrrev_b32 v0, 4, v65
    s_mov_b32 s32, s13
    s_load_dwordx16 s[48:63], s[0:1], 0
    s_waitcnt lgkmcnt(0)
    s_branch L_helper
cf_run:
    s_mov_b32 m0, 16128
    s_mov_b32 s44, 0x3e0293ee
    s_mov_b32 s45, s44
    s_or_b32 s66, s44, 0x80000000
    s_mov_b32 s48, 0x3f003f00
    s_mov_b32 s49, 0
    s_mov_b32 s50, 0x3f803f80
    s_mov_b32 s51, 0x3f803f80
    s_mov_b32 s52, 512
    s_mov_b32 s53, 1024
    s_mov_b32 s54, 1536
    s_mov_b32 s30, 0
    s_cmp_lg_u32 s32, 0
    s_cselect_b32 s71, s13, 3
    s_mov_b32 s14, 67125248
    s_mov_b32 s15, 67129344
    s_mov_b32 s16, 67133440
    s_mov_b32 s36, 0
    s_add_u32 s17, s68, 67108864
    s_mov_b32 s69, 0
    s_mov_b32 s70, 0
    s_lshl_b32 s26, s12, 14
    s_add_u32 s26, s26, 0
    s_mul_i32 s40, s13, 3072
    s_add_u32 s24, s26, s40
    s_lshl_b32 s96, s12, 7
    s_add_u32 s29, s96, 125845504
    s_add_u32 s96, s96, 125829120
    s_lshl_b32 s40, s12, 14
    s_add_u32 s40, s40, 68157440
    s_add_u32 s18, s40, 0
    s_add_u32 s19, s40, 4096
    s_add_u32 s20, s40, 8192
    s_add_u32 s21, s40, 12288
    s_lshr_b32 s40, s12, 3
    s_lshl_b32 s40, s40, 12
    s_and_b32 s41, s12, 7
    s_lshl_b32 s41, s41, 7
    s_add_u32 s40, s40, s41
    s_add_u32 s22, s40, 68157440
    s_add_u32 s23, s22, 1024
    s_add_u32 s25, s22, 2048
    s_mov_b32 s56, -65528
    s_cmp_lg_u32 s32, 0
    s_cselect_b64 s[38:39], -1, 0
    s_add_u32 s55, s68, 138412032
    s_cmp_eq_u32 s13, 3
    s_cselect_b64 s[100:101], 1, 0
    s_cselect_b64 s[38:39], 1, s[38:39]
    s_cselect_b32 s93, 64, 0
    s_cselect_b32 s55, s29, s55
    s_cselect_b32 s57, 0, 9216
    s_mov_b64 exec, s[100:101]
    v_mov_b32 v72, s95
    s_mov_b64 exec, -1
    s_mov_b32 s34, 0xff00ff00
    s_mov_b32 s35, 0xff00ff00
    s_lshl_b32 s28, s12, 12
    s_add_u32 s28, s28, 7602176
    s_add_u32 s27, s28, 77594624
    s_add_u32 s28, s28, 69206016
    s_mov_b32 s37, s93
    s_cmp_ge_u32 s97, 3
    s_cbranch_scc1 cf_kvdone
    s_mov_b32 s40, 3
    v_bfe_u32 v78, v65, 2, 5
    s_mov_b32 s31, 4194304
cf_kv0:
    buffer_load_dword v77, v78, s[4:7], s96 offen offset:16 sc1
    s_waitcnt vmcnt(0)
    v_subrev_u32 v77, s95, v77
    v_cmp_lt_u32 vcc, 16, v77
    s_nop 1
    v_cndmask_b32 v77, v77, 0, vcc
    v_bfe_u32 v79, v78, 2, 2
    v_lshl_add_u32 v77, v77, 2, v79
    s_nop 1
    v_min_u32_dpp v77, v77, v77 row_ror:1 row_mask:0xf bank_mask:0xf
    s_nop 1
    v_min_u32_dpp v77, v77, v77 row_ror:2 row_mask:0xf bank_mask:0xf
    s_nop 1
    v_min_u32_dpp v77, v77, v77 row_ror:4 row_mask:0xf bank_mask:0xf
    s_nop 0
    v_readfirstlane_b32 s97, v77
    s_sub_u32 s31, s31, 1
    s_cbranch_scc1 cf_kv0_x
    s_cmp_le_u32 s40, s97
    s_cbranch_scc1 cf_kv0_x
    s_sleep 2
    s_branch cf_kv0
cf_kv0_x:
    s_add_u32 s40, s26, 0
    v_lshlrev_b32 v78, 2, v65
    buffer_load_dword v76, v78, s[4:7], s40 offen sc1
    s_add_u32 s40, s26, 524288
    v_lshlrev_b32 v78, 2, v65
    buffer_load_dword v76, v78, s[4:7], s40 offen sc1
cf_kvdone:
    v_mov_b64 v[0:1], 0
    v_mov_b64 v[2:3], 0
    v_mov_b64 v[4:5], 0
    v_mov_b64 v[6:7], 0
    v_mov_b64 v[8:9], 0
    v_mov_b64 v[10:11], 0
    v_mov_b64 v[12:13], 0
    v_mov_b64 v[14:15], 0
    v_mov_b64 v[16:17], 0
    v_mov_b64 v[18:19], 0
    v_mov_b64 v[20:21], 0
    v_mov_b64 v[22:23], 0
    ds_read_b128 v[40:43], v70 offset:0
    ds_read_b128 v[44:47], v70 offset:1024
    ds_read_b128 v[48:51], v70 offset:2048
    ds_read_b128 v[52:55], v70 offset:3072
    ds_read_b128 v[24:27], v70 offset:4096
    ds_read_b128 v[28:31], v70 offset:5120
    ds_read_b128 v[32:35], v70 offset:6144
    ds_read_b128 v[36:39], v70 offset:7168
    buffer_load_dwordx4 v[60:63], v65, s[4:7], s14 offen offset:0 nt
    buffer_load_dwordx4 v[56:59], v66, s[4:7], s14 offen offset:0 nt
    s_mov_b32 s31, 1048576
    s_waitcnt vmcnt(0) lgkmcnt(0)
    s_branch cf_goA
cf_loop:
    s_add_u32 s40, s30, 3
    s_min_u32 s40, s40, 64
    s_cmp_le_u32 s40, s97
    s_cbranch_scc0 cf_kvwait
cf_kvok:
    s_mov_b32 s31, 1048576
    s_mov_b32 s69, s70
    s_waitcnt lgkmcnt(0)
cf_cA:
    buffer_load_dwordx4 v[60:63], v65, s[4:7], s14 offen offset:0 nt
    buffer_load_dwordx4 v[56:59], v66, s[4:7], s14 offen offset:0 nt
    v_bitop3_b32 v77, v60, v56, s70 bitop3:0x7e
    v_and_b32 v77, 1, v77
    v_cmp_ne_u32 vcc, 0, v77
    s_cbranch_vccz cf_goA
    v_bitop3_b32 v77, v60, v56, s70 bitop3:0x7e
    v_and_b32 v77, 1, v77
    v_cmp_ne_u32 vcc, 0, v77
    s_cbranch_vccz cf_goA
    v_bitop3_b32 v77, v60, v56, s70 bitop3:0x7e
    v_and_b32 v77, 1, v77
    v_cmp_ne_u32 vcc, 0, v77
    s_cbranch_vccz cf_goA
    v_bitop3_b32 v77, v60, v56, s70 bitop3:0x7e
    v_and_b32 v77, 1, v77
    v_cmp_ne_u32 vcc, 0, v77
    s_cbranch_vccz cf_goA
    buffer_load_dwordx4 v[60:63], v65, s[4:7], s14 offen offset:0 nt
    buffer_load_dwordx4 v[56:59], v66, s[4:7], s14 offen offset:0 nt
    v_bitop3_b32 v77, v60, v56, s70 bitop3:0x7e
    v_and_b32 v77, 1, v77
    v_cmp_ne_u32 vcc, 0, v77
    s_cbranch_vccz cf_goA
    v_bitop3_b32 v77, v60, v56, s70 bitop3:0x7e
    v_and_b32 v77, 1, v77
    v_cmp_ne_u32 vcc, 0, v77
    s_cbranch_vccz cf_goA
    v_bitop3_b32 v77, v60, v56, s70 bitop3:0x7e
    v_and_b32 v77, 1, v77
    v_cmp_ne_u32 vcc, 0, v77
    s_cbranch_vccz cf_goA
    v_bitop3_b32 v77, v60, v56, s70 bitop3:0x7e
    v_and_b32 v77, 1, v77
    v_cmp_ne_u32 vcc, 0, v77
    s_cbranch_vccz cf_goA
    buffer_load_dwordx4 v[60:63], v65, s[4:7], s14 offen offset:0 nt
    buffer_load_dwordx4 v[56:59], v66, s[4:7], s14 offen offset:0 nt
    v_bitop3_b32 v77, v60, v56, s70 bitop3:0x7e
    v_and_b32 v77, 1, v77
    v_cmp_ne_u32 vcc, 0, v77
    s_cbranch_vccz cf_goA
    v_bitop3_b32 v77, v60, v56, s70 bitop3:0x7e
    v_and_b32 v77, 1, v77
    v_cmp_ne_u32 vcc, 0, v77
    s_cbranch_vccz cf_goA
    v_bitop3_b32 v77, v60, v56, s70 bitop3:0x7e
    v_and_b32 v77, 1, v77
    v_cmp_ne_u32 vcc, 0, v77
    s_cbranch_vccz cf_goA
    v_bitop3_b32 v77, v60, v56, s70 bitop3:0x7e
    v_and_b32 v77, 1, v77
    v_cmp_ne_u32 vcc, 0, v77
    s_cbranch_vccz cf_goA
    buffer_load_dwordx4 v[60:63], v65, s[4:7], s14 offen offset:0 nt
    buffer_load_dwordx4 v[56:59], v66, s[4:7], s14 offen offset:0 nt
    v_bitop3_b32 v77, v60, v56, s70 bitop3:0x7e
    v_and_b32 v77, 1, v77
    v_cmp_ne_u32 vcc, 0, v77
    s_cbranch_vccz cf_goA
    v_bitop3_b32 v77, v60, v56, s70 bitop3:0x7e
    v_and_b32 v77, 1, v77
    v_cmp_ne_u32 vcc, 0, v77
    s_cbranch_vccz cf_goA
    v_bitop3_b32 v77, v60, v56, s70 bitop3:0x7e
    v_and_b32 v77, 1, v77
    v_cmp_ne_u32 vcc, 0, v77
    s_cbranch_vccz cf_goA
    v_bitop3_b32 v77, v60, v56, s70 bitop3:0x7e
    v_and_b32 v77, 1, v77
    v_cmp_ne_u32 vcc, 0, v77
    s_cbranch_vccz cf_goA
    s_sub_u32 s31, s31, 64
    s_cbranch_scc0 cf_cA
cf_goA:
    ds_write_b128 v65, v[60:63] offset:0
    v_smfmac_f32_16x16x64_bf16 v[0:3], v[60:63], v[40:47], v64
    v_smfmac_f32_16x16x64_bf16 v[4:7], v[60:63], v[48:55], v64
    buffer_load_dwordx4 v[40:43], v65, s[4:7], s15 offen offset:0 nt
    v_smfmac_f32_16x16x64_bf16 v[0:3], v[56:59], v[24:31], v64
    v_smfmac_f32_16x16x64_bf16 v[4:7], v[56:59], v[32:39], v64
    ds_read_b128 v[24:27], v70 offset:8192
    v_smfmac_f32_16x16x64_bf16 v[8:11], v[60:63], a[96:103], v64
    ds_read_b128 v[28:31], v70 offset:9216
    v_smfmac_f32_16x16x64_bf16 v[12:15], v[60:63], a[104:111], v64
    ds_read_b128 v[32:35], v70 offset:10240
    s_waitcnt lgkmcnt(3)
    s_barrier
    ds_read_b128 v[48:51], v67 offset:0
    v_smfmac_f32_16x16x64_bf16 v[8:11], v[56:59], a[112:119], v64
    ds_read_b128 v[36:39], v70 offset:11264
    v_smfmac_f32_16x16x64_bf16 v[12:15], v[56:59], a[120:127], v64
    ds_read_b128 v[52:55], v68 offset:0
    v_smfmac_f32_16x16x64_bf16 v[16:19], v[60:63], a[216:223], v64
    buffer_load_dwordx4 v[40:43], v65, s[4:7], s15 offen offset:0 nt
    s_waitcnt lgkmcnt(4)
    v_smfmac_f32_16x16x64_bf16 v[20:23], v[60:63], v[24:31], v64
    ds_read_b128 v[24:27], v70 offset:12288
    s_waitcnt lgkmcnt(3)
    v_smfmac_f32_16x16x64_bf16 v[0:3], v[48:51], a[0:7], v64
    ds_read_b128 v[28:31], v70 offset:13312
    s_waitcnt lgkmcnt(3)
    v_smfmac_f32_16x16x64_bf16 v[4:7], v[48:51], v[32:39], v64
    ds_read_b128 v[32:35], v70 offset:14336
    v_smfmac_f32_16x16x64_bf16 v[8:11], v[48:51], a[128:135], v64
    ds_read_b128 v[36:39], v70 offset:15360
    v_smfmac_f32_16x16x64_bf16 v[12:15], v[48:51], a[136:143], v64
    v_smfmac_f32_16x16x64_bf16 v[16:19], v[56:59], a[224:231], v64
    v_smfmac_f32_16x16x64_bf16 v[20:23], v[56:59], a[232:239], v64
    s_waitcnt lgkmcnt(2)
    s_waitcnt vmcnt(1)
    v_and_b32 v77, s36, v40
    v_smfmac_f32_16x16x64_bf16 v[12:15], v[52:55], v[24:31], v64
    ds_write_b128 v65, v[40:43] offset:4096
    v_smfmac_f32_16x16x64_bf16 v[0:3], v[52:55], a[8:15], v64
    s_waitcnt lgkmcnt(1)
    v_cmp_ne_u32 vcc, s70, v77
    v_smfmac_f32_16x16x64_bf16 v[4:7], v[52:55], v[32:39], v64
    buffer_load_dwordx4 v[60:63], v65, s[4:7], s16 offen offset:0 nt
    v_smfmac_f32_16x16x64_bf16 v[8:11], v[52:55], a[144:151], v64
    s_cbranch_vccnz cf_spinB
cf_backB:
    v_smfmac_f32_16x16x64_bf16 v[16:19], v[40:43], v[176:183], v64
    s_waitcnt lgkmcnt(0)
    s_barrier
    ds_read_b128 v[44:47], v66 offset:4096
    v_smfmac_f32_16x16x64_bf16 v[12:15], v[40:43], a[160:167], v64
    ds_read_b128 v[32:35], v70 offset:16384
    buffer_load_dwordx4 v[24:27], v65, s[4:7], s24 offen offset:0 sc1
    v_smfmac_f32_16x16x64_bf16 v[0:3], v[40:43], a[16:23], v64
    ds_read_b128 v[36:39], v70 offset:17408
    v_smfmac_f32_16x16x64_bf16 v[8:11], v[40:43], a[152:159], v64
    ds_read_b128 v[48:51], v67 offset:4096
    v_smfmac_f32_16x16x64_bf16 v[4:7], v[40:43], a[24:31], v64
    ds_read_b128 v[52:55], v68 offset:4096
    v_smfmac_f32_16x16x64_bf16 v[20:23], v[40:43], v[184:191], v64
    buffer_load_dwordx4 v[28:31], v65, s[4:7], s24 offen offset:1024 sc1
    s_waitcnt lgkmcnt(4)
    v_smfmac_f32_16x16x64_bf16 v[0:3], v[44:47], a[32:39], v64
    ds_read_b128 v[56:59], v69 offset:15360
    s_waitcnt lgkmcnt(3)
    v_smfmac_f32_16x16x64_bf16 v[8:11], v[44:47], v[32:39], v64
    ds_read_b128 v[32:35], v70 offset:18432
    v_smfmac_f32_16x16x64_bf16 v[4:7], v[44:47], a[40:47], v64
    ds_read_b128 v[36:39], v70 offset:19456
    s_add_u32 s40, s26, 1048576
    v_lshlrev_b32 v78, 2, v65
    v_smfmac_f32_16x16x64_bf16 v[12:15], v[44:47], a[168:175], v64
    buffer_load_dwordx4 v[42:45], v65, s[4:7], s24 offen offset:3072 sc1
    s_waitcnt lgkmcnt(3)
    v_smfmac_f32_16x16x64_bf16 v[0:3], v[48:51], a[48:55], v64
    v_smfmac_f32_16x16x64_bf16 v[8:11], v[48:51], a[176:183], v64
    v_smfmac_f32_16x16x64_bf16 v[0:3], v[52:55], a[64:71], v64
    s_waitcnt lgkmcnt(0)
    v_smfmac_f32_16x16x64_bf16 v[8:11], v[52:55], v[32:39], v64
    buffer_load_dwordx4 v[34:37], v65, s[4:7], s24 offen offset:2048 sc1
    v_smfmac_f32_16x16x64_bf16 v[4:7], v[48:51], a[56:63], v64
    v_smfmac_f32_16x16x64_bf16 v[4:7], v[52:55], a[72:79], v64
    s_waitcnt vmcnt(4)
    v_and_b32 v77, s36, v60
    v_smfmac_f32_16x16x64_bf16 v[12:15], v[48:51], a[184:191], v64
    v_cmp_ne_u32 vcc, s70, v77
    v_smfmac_f32_16x16x64_bf16 v[12:15], v[52:55], a[192:199], v64
    s_cbranch_vccnz cf_spin8
cf_back8:
    v_smfmac_f32_16x16x64_bf16 v[0:3], v[60:63], a[80:87], v64
    s_nop 1
    v_lshrrev_b32 v77, 1, v69
    v_smfmac_f32_16x16x64_bf16 v[8:11], v[60:63], a[200:207], v64
    buffer_load_dword v76, v78, s[4:7], s40 offen sc1
    s_nop 1
    v_smfmac_f32_16x16x64_bf16 v[4:7], v[60:63], a[88:95], v64
    s_nop 1
    v_cvt_pk_bf16_f32 v0, v0, v1
    v_smfmac_f32_16x16x64_bf16 v[12:15], v[60:63], a[208:215], v64
    s_nop 1
    v_cvt_pk_bf16_f32 v1, v2, v3
    v_cvt_pk_bf16_f32 v2, v8, v9
    v_cvt_pk_bf16_f32 v3, v10, v11
    v_cvt_pk_bf16_f32 v4, v4, v5
    v_cvt_pk_bf16_f32 v5, v6, v7
    v_mfma_f32_16x16x32_bf16 v[8:11], v[0:3], v[56:59], 0
    v_cvt_pk_bf16_f32 v6, v12, v13
    v_cvt_pk_bf16_f32 v7, v14, v15
    s_nop 1
    v_mfma_f32_16x16x32_bf16 v[12:15], v[4:7], v[56:59], 0
    ds_read_b128 v[56:59], v66 offset:4096
    s_nop 1
    v_smfmac_f32_16x16x64_bf16 v[16:19], v[48:51], v[208:215], v64
    s_waitcnt vmcnt(3)
    s_nop 0
    v_cvt_pk_bf16_f32 v0, v8, v9
    v_cvt_pk_bf16_f32 v1, v10, v11
    v_cvt_pk_bf16_f32 v2, v12, v13
    v_cvt_pk_bf16_f32 v3, v14, v15
    s_nop 1
    v_mfma_f32_16x16x32_bf16 v[12:15], v[0:3], v[0:3], 0
    s_nop 2
    v_mfma_f32_16x16x32_bf16 v[4:7], v[24:27], v[0:3], 0
    ds_read_b128 v[24:27], v67 offset:0
    s_nop 1
    v_mfma_f32_16x16x32_bf16 v[8:11], v[28:31], v[0:3], 0
    s_nop 0
    v_mov_b32_dpp v12, v14 row_ror:8 row_mask:0xf bank_mask:0xc
    v_mov_b32_dpp v13, v15 row_ror:8 row_mask:0xf bank_mask:0xc
    v_smfmac_f32_16x16x64_bf16 v[20:23], v[48:51], v[216:223], v64
    ds_write_b64 v71, v[12:13]
    ds_read_b128 v[48:51], v68 offset:0
    s_nop 1
    v_mov_b32_dpp v4, v8 row_ror:8 row_mask:0xf bank_mask:0xc
    v_mov_b32_dpp v5, v9 row_ror:8 row_mask:0xf bank_mask:0xc
    v_mov_b32_dpp v6, v10 row_ror:8 row_mask:0xf bank_mask:0xc
    v_mov_b32_dpp v7, v11 row_ror:8 row_mask:0xf bank_mask:0xc
    v_smfmac_f32_16x16x64_bf16 v[16:19], v[52:55], v[224:231], v64
    ds_write_b128 v65, v[4:7] offset:8192
    v_smfmac_f32_16x16x64_bf16 v[20:23], v[52:55], v[232:239], v64
    s_waitcnt lgkmcnt(3)
    v_smfmac_f32_16x16x64_bf16 v[16:19], v[24:27], a[240:247], v64
    s_waitcnt vmcnt(1)
    s_cmp_ge_u32 s30, 58
    v_smfmac_f32_16x16x64_bf16 v[20:23], v[24:27], a[248:255], v64
    s_cbranch_scc1 cf_pubk
cf_pubk_x:
    v_smfmac_f32_16x16x64_bf16 v[16:19], v[60:63], v[240:247], v64
    s_waitcnt lgkmcnt(0)
    s_barrier
    ds_read_b128 v[8:11], v66 offset:8192
    v_smfmac_f32_16x16x64_bf16 v[20:23], v[60:63], v[248:255], v64
    ds_read_b128 v[12:15], v67 offset:8192
    ds_read_b128 v[0:3], v68 offset:8192
    ds_read_b64 v[24:25], v77 offset:14336
    v_smfmac_f32_16x16x64_bf16 v[16:19], v[56:59], v[192:199], v64
    ds_read_b64 v[26:27], v77 offset:14592
    ds_read_b64 v[28:29], v77 offset:14848
    ds_read_b64 v[30:31], v77 offset:15104
    v_smfmac_f32_16x16x64_bf16 v[20:23], v[56:59], v[200:207], v64
    s_cmp_lg_u32 s37, 0
    v_smfmac_f32_16x16x64_bf16 v[16:19], v[48:51], v[160:167], v64
    s_mov_b64 exec, s[38:39]
    buffer_store_dword v72, v75, s[4:7], s55 offen sc1
    s_mov_b64 exec, -1
    v_smfmac_f32_16x16x64_bf16 v[20:23], v[48:51], v[168:175], v64
    s_cbranch_scc1 cf_rare
cf_rare_x:
    ds_read_b128 v[56:59], v70 offset:22528
    ds_read_b128 v[60:63], v70 offset:23552
    s_cmp_ge_u32 s30, 58
    s_waitcnt lgkmcnt(8)
    v_pk_add_f32 v[4:5], v[4:5], v[8:9]
    v_pk_add_f32 v[6:7], v[6:7], v[10:11]
    s_waitcnt lgkmcnt(6)
    v_pk_add_f32 v[12:13], v[12:13], v[0:1]
    v_pk_add_f32 v[14:15], v[14:15], v[2:3]
    v_pk_add_f32 v[4:5], v[4:5], v[12:13]
    v_pk_add_f32 v[6:7], v[6:7], v[14:15]
    s_waitcnt lgkmcnt(2)
    v_pk_add_f32 v[24:25], v[24:25], v[26:27]
    v_pk_add_f32 v[28:29], v[28:29], v[30:31]
    v_max3_f32 v77, v4, v5, v6
    v_pk_add_f32 v[24:25], v[24:25], v[28:29]
    v_max_f32 v77, v77, v7
    v_max3_f32 v77, v77, v24, v25
    v_cvt_pk_bf16_f32 v38, v16, v17
    v_cvt_pk_bf16_f32 v39, v18, v19
    v_max_f32_dpp v77, v77, v77 row_ror:8 row_mask:0xf bank_mask:0xf
    v_mov_b32 v78, v77
    v_cvt_pk_bf16_f32 v40, v20, v21
    v_cvt_pk_bf16_f32 v41, v22, v23
    v_permlane32_swap_b32 v77, v78
    v_max_f32 v77, v77, v78
    v_mov_b32 v78, v77
    v_mov_b32 v11, 0
    v_mov_b32 v32, v38
    v_permlane16_swap_b32 v77, v78
    v_max_f32 v77, v77, v78
    v_mul_f32 v8, s66, v77
    v_pk_fma_f32 v[4:5], v[4:5], s[44:45], v[8:9] op_sel_hi:[1,1,0]
    v_pk_fma_f32 v[6:7], v[6:7], s[44:45], v[8:9] op_sel_hi:[1,1,0]
    v_pk_fma_f32 v[24:25], v[24:25], s[44:45], v[8:9] op_sel_hi:[1,1,0]
    v_exp_f32 v4, v4
    v_exp_f32 v5, v5
    v_exp_f32 v6, v6
    v_exp_f32 v7, v7
    v_exp_f32 v24, v24
    v_exp_f32 v25, v25
    v_cvt_pk_bf16_f32 v12, v4, v5
    v_cvt_pk_bf16_f32 v13, v6, v7
    v_cvt_pk_bf16_f32 v10, v24, v25
    v_cvt_pk_bf16_f32 v15, v24, v25
    v_mov_b32 v14, 0
    v_mfma_f32_16x16x32_bf16 v[4:7], v[32:35], v[10:13], 0
    s_cbranch_scc1 cf_pubv
cf_pubv_x:
    v_mov_b64 v[0:1], s[48:49]
    v_mov_b64 v[2:3], s[50:51]
    v_mfma_f32_16x16x32_bf16 v[24:27], v[36:39], v[12:15], 0
    ds_read_b128 v[48:51], v70 offset:20480
    v_mov_b32 v47, v41
    v_bitop3_b32 v77, v73, -9, s52 bitop3:0x6a
    v_mfma_f32_16x16x32_bf16 v[28:31], v[0:3], v[10:13], 0
    ds_read_b128 v[52:55], v70 offset:21504
    v_mov_b64 v[0:1], 0
    v_mov_b64 v[2:3], 0
    v_mfma_f32_16x16x32_bf16 v[16:19], v[40:43], v[10:13], 0
    ds_read_b128 v[32:35], v70 offset:24576
    v_bitop3_b32 v78, v73, -9, s53 bitop3:0x6a
    v_bitop3_b32 v79, v73, -9, s54 bitop3:0x6a
    v_mfma_f32_16x16x32_bf16 v[20:23], v[44:47], v[12:15], 0
    ds_read_b128 v[36:39], v70 offset:25600
    v_add_f32_dpp v4, v24, v4 row_ror:8 row_mask:0xf bank_mask:0xf
    v_add_f32_dpp v5, v25, v5 row_ror:8 row_mask:0xf bank_mask:0xf
    v_add_f32_dpp v6, v26, v6 row_ror:8 row_mask:0xf bank_mask:0xf
    v_add_f32_dpp v7, v27, v7 row_ror:8 row_mask:0xf bank_mask:0xf
    v_add_f32_dpp v29, v28, v28 row_ror:8 row_mask:0xf bank_mask:0xf
    v_rcp_f32 v28, v29
    s_nop 0
    v_add_f32_dpp v4, v16, v20 row_ror:8 row_mask:0xf bank_mask:0xc
    v_add_f32_dpp v5, v17, v21 row_ror:8 row_mask:0xf bank_mask:0xc
    v_add_f32_dpp v6, v18, v22 row_ror:8 row_mask:0xf bank_mask:0xc
    v_add_f32_dpp v7, v19, v23 row_ror:8 row_mask:0xf bank_mask:0xc
    v_pk_mul_f32 v[4:5], v[4:5], v[28:29] op_sel_hi:[1,0]
    v_pk_mul_f32 v[6:7], v[6:7], v[28:29] op_sel_hi:[1,0]
    v_cvt_pk_bf16_f32 v4, v4, v5
    v_cvt_pk_bf16_f32 v5, v6, v7
    ds_write_b64 v73, v[4:5] offset:12288
    v_mov_b32_dpp v6, v4 row_ror:8 row_mask:0xf bank_mask:0xf
    v_mov_b32_dpp v7, v5 row_ror:8 row_mask:0xf bank_mask:0xf
    v_mov_b64 v[8:9], 0
    v_mov_b64 v[10:11], 0
    s_waitcnt lgkmcnt(3)
    v_smfmac_f32_16x16x64_bf16 v[0:3], v[4:7], v[48:55], v64
    ds_read_b128 v[40:43], v70 offset:26624
    v_mov_b64 v[12:13], 0
    v_mov_b64 v[14:15], 0
    v_mov_b32 v52, v78
    v_smfmac_f32_16x16x64_bf16 v[8:11], v[4:7], v[80:87], v64
    ds_read_b128 v[44:47], v70 offset:27648
    v_mov_b64 v[24:25], 0
    v_mov_b64 v[26:27], 0
    v_smfmac_f32_16x16x64_bf16 v[12:15], v[4:7], v[112:119], v64
    s_waitcnt lgkmcnt(2)
    v_mov_b32_dpp v52, v79 quad_perm:[0,1,2,3] row_mask:0xf bank_mask:0xc
    v_xor_b32 v48, 1024, v52
    s_barrier
    ds_read_b128 v[16:19], v77 offset:12288
    v_smfmac_f32_16x16x64_bf16 v[24:27], v[4:7], v[56:63], v64
    ds_read_b128 v[20:23], v78 offset:12288
    ds_read_b128 v[28:31], v79 offset:12288
    ds_read_b128 v[52:55], v52 offset:12288
    ds_read_b128 v[48:51], v48 offset:12288
    v_mov_b64 v[4:5], 0
    v_mov_b64 v[6:7], 0
    s_waitcnt lgkmcnt(4)
    v_smfmac_f32_16x16x64_bf16 v[8:11], v[16:19], v[88:95], v64
    ds_read_b128 v[56:59], v70 offset:28672
    v_smfmac_f32_16x16x64_bf16 v[12:15], v[16:19], v[120:127], v64
    ds_read_b128 v[60:63], v70 offset:29696
    s_waitcnt lgkmcnt(5)
    v_smfmac_f32_16x16x64_bf16 v[8:11], v[20:23], v[96:103], v64
    v_bfe_u32 v77, v74, 16, 1
    v_smfmac_f32_16x16x64_bf16 v[12:15], v[20:23], v[128:135], v64
    s_waitcnt lgkmcnt(4)
    v_mad_i32_i24 v77, v77, s56, v74
    v_smfmac_f32_16x16x64_bf16 v[8:11], v[28:31], v[104:111], v64
    s_nop 2
    v_smfmac_f32_16x16x64_bf16 v[12:15], v[28:31], v[136:143], v64
    s_waitcnt lgkmcnt(2)
    s_nop 1
    v_smfmac_f32_16x16x64_bf16 v[4:7], v[48:51], v[144:151], v64
    v_cvt_pk_bf16_f32 v8, v8, v9
    v_cvt_pk_bf16_f32 v9, v10, v11
    v_and_or_b32 v8, v8, -2, s69
    s_nop 0
    v_cvt_pk_bf16_f32 v10, v12, v13
    v_cvt_pk_bf16_f32 v11, v14, v15
    v_smfmac_f32_16x16x64_bf16 v[4:7], v[52:55], v[152:159], v64
    buffer_store_dwordx4 v[8:11], v74, s[4:7], s22 offen
    ds_read_b128 v[48:51], v70 offset:30720
    v_smfmac_f32_16x16x64_bf16 v[0:3], v[16:19], v[32:39], v64
    ds_read_b128 v[52:55], v70 offset:31744
    s_add_u32 s30, s30, 1
    s_waitcnt lgkmcnt(2)
    v_smfmac_f32_16x16x64_bf16 v[24:27], v[16:19], v[40:47], v64
    ds_read_b128 v[32:35], v70 offset:32768
    v_cvt_pk_bf16_f32 v4, v4, v5
    v_cvt_pk_bf16_f32 v5, v6, v7
    v_and_or_b32 v4, v4, -2, s69
    v_smfmac_f32_16x16x64_bf16 v[0:3], v[20:23], v[56:63], v64
    buffer_store_dwordx2 v[4:5], v77, s[4:7], s25 offen
    ds_read_b128 v[36:39], v70 offset:33792
    s_xor_b32 s70, s70, 1
    ds_read_b128 v[40:43], v70 offset:34816
    s_waitcnt lgkmcnt(3)
    v_smfmac_f32_16x16x64_bf16 v[24:27], v[20:23], v[48:55], v64
    ds_read_b128 v[44:47], v70 offset:35840
    s_waitcnt lgkmcnt(2)
    v_smfmac_f32_16x16x64_bf16 v[0:3], v[28:31], v[32:39], v64
    s_cmp_lg_u32 s71, 0
    s_waitcnt lgkmcnt(0)
    s_nop 0
    v_smfmac_f32_16x16x64_bf16 v[24:27], v[28:31], v[40:47], v64
    s_nop 3
    v_cvt_pk_bf16_f32 v0, v0, v1
    v_cvt_pk_bf16_f32 v1, v2, v3
    v_and_or_b32 v0, v0, -2, s69
    s_nop 0
    v_cvt_pk_bf16_f32 v2, v24, v25
    v_cvt_pk_bf16_f32 v3, v26, v27
    buffer_store_dwordx4 v[0:3], v74, s[4:7], s23 offen
    s_cbranch_scc1 cf_e1
    s_nop 0
    s_nop 2
    v_mov_b32 v79, v79
    s_nop 2
    v_mov_b32 v79, v79
    s_nop 2
    v_mov_b32 v79, v79
    s_nop 2
    v_mov_b32 v79, v79
    s_nop 2
    v_mov_b32 v79, v79
    s_nop 2
    v_mov_b32 v79, v79
    s_nop 2
    v_mov_b32 v79, v79
    s_nop 2
    v_mov_b32 v79, v79
    s_nop 2
    v_mov_b32 v79, v79
    s_nop 2
    v_mov_b32 v79, v79
    s_nop 2
    v_mov_b32 v79, v79
    s_nop 2
    v_mov_b32 v79, v79
    buffer_load_dwordx4 v[8:11], v65, s[4:7], s18 offen nt
    buffer_load_dwordx4 v[12:15], v65, s[4:7], s19 offen nt
    buffer_load_dwordx4 v[16:19], v65, s[4:7], s20 offen nt
    buffer_load_dwordx4 v[20:23], v65, s[4:7], s21 offen nt
    v_and_b32 v77, 255, v69
    ds_read_b128 v[4:7], v77 offset:15872
    ds_read_b128 v[40:43], v70 offset:0
    ds_read_b128 v[44:47], v70 offset:1024
    ds_read_b128 v[48:51], v70 offset:2048
    ds_read_b128 v[52:55], v70 offset:3072
    ds_read_b128 v[24:27], v70 offset:4096
    ds_read_b128 v[28:31], v70 offset:5120
    ds_read_b128 v[32:35], v70 offset:6144
    ds_read_b128 v[36:39], v70 offset:7168
    s_mov_b32 s31, 65536
    s_add_u32 s24, s24, 524288
    s_add_u32 s26, s26, 524288
    s_add_u32 s55, s55, s57
    s_cmp_lt_u32 s97, s93
    s_cselect_b32 s37, 1, 0
    s_cmp_eq_u32 s30, 63
    s_cselect_b32 s37, 1, s37
    s_mov_b32 s14, 67108864
    s_mov_b32 s15, 67112960
    s_mov_b32 s16, 67117056
    s_mov_b32 s36, 1
    v_mov_b32 v60, s69
    v_mov_b32 v56, s69
    v_and_b32 v79, 12, v75
    v_cmp_eq_u32 vcc, 0, v79
    s_nop 1
    v_cndmask_b32 v79, 0, 1, vcc
    s_waitcnt lgkmcnt(0)
    s_waitcnt vmcnt(3)
    v_xor_b32 v77, s69, v8
    v_mfma_f32_16x16x32_bf16 v[0:3], v[4:7], v[8:11], 0
    s_waitcnt vmcnt(2)
    v_bitop3_b32 v77, v77, v12, s69 bitop3:0xf6
    v_mfma_f32_16x16x32_bf16 v[0:3], v[4:7], v[12:15], v[0:3]
    s_waitcnt vmcnt(1)
    v_bitop3_b32 v77, v77, v16, s69 bitop3:0xf6
    v_mfma_f32_16x16x32_bf16 v[0:3], v[4:7], v[16:19], v[0:3]
    s_waitcnt vmcnt(0)
    v_bitop3_b32 v77, v77, v20, s69 bitop3:0xf6
    v_mfma_f32_16x16x32_bf16 v[0:3], v[4:7], v[20:23], v[0:3]
    v_and_b32 v77, 1, v77
    v_cmp_ne_u32 vcc, 0, v77
    s_nop 0
    s_cmp_eq_u64 vcc, 0
    s_cselect_b64 s[42:43], -1, 0
    s_nop 2
    v_add_f32_dpp v0, v0, v0 row_ror:8 row_mask:0xf bank_mask:0xf
    v_add_f32_dpp v1, v1, v1 row_ror:8 row_mask:0xf bank_mask:0xf
    s_mov_b64 exec, s[42:43]
    v_cvt_pk_bf16_f32 v72, v0, v1
    v_bfi_b32 v72, v79, s70, v72
    buffer_store_dword v72, v75, s[4:7], s17 offen offset:0
    s_mov_b64 exec, -1
    s_cbranch_scc0 cf_f0_retry
cf_f0_go:
    v_mov_b64 v[0:1], 0
    v_mov_b64 v[2:3], 0
    v_mov_b64 v[4:5], 0
    v_mov_b64 v[6:7], 0
    v_mov_b64 v[8:9], 0
    v_mov_b64 v[10:11], 0
    v_mov_b64 v[12:13], 0
    v_mov_b64 v[14:15], 0
    v_mov_b64 v[16:17], 0
    v_mov_b64 v[18:19], 0
    v_mov_b64 v[20:21], 0
    v_mov_b64 v[22:23], 0
    s_nop 2
    v_mov_b32 v79, v79
    s_nop 2
    v_mov_b32 v79, v79
    s_branch cf_loop
cf_e1:
    s_cmp_lg_u32 s71, 2
    s_cbranch_scc1 cf_f1
    s_nop 2
    v_mov_b32 v79, v79
    s_nop 2
    v_mov_b32 v79, v79
    s_nop 2
    v_mov_b32 v79, v79
    s_nop 2
    v_mov_b32 v79, v79
    s_nop 2
    v_mov_b32 v79, v79
    s_nop 2
    v_mov_b32 v79, v79
    s_nop 2
    v_mov_b32 v79, v79
    s_nop 2
    v_mov_b32 v79, v79
    s_nop 2
    v_mov_b32 v79, v79
    s_nop 2
    v_mov_b32 v79, v79
    s_nop 2
    v_mov_b32 v79, v79
    s_nop 2
    v_mov_b32 v79, v79
    s_nop 2
    v_mov_b32 v79, v79
    s_nop 2
    v_mov_b32 v79, v79
    s_nop 2
    v_mov_b32 v79, v79
    s_nop 2
    v_mov_b32 v79, v79
    buffer_load_dwordx4 v[8:11], v65, s[4:7], s18 offen nt
    buffer_load_dwordx4 v[12:15], v65, s[4:7], s19 offen nt
    buffer_load_dwordx4 v[16:19], v65, s[4:7], s20 offen nt
    buffer_load_dwordx4 v[20:23], v65, s[4:7], s21 offen nt
    v_and_b32 v77, 255, v69
    ds_read_b128 v[4:7], v77 offset:15872
    ds_read_b128 v[40:43], v70 offset:0
    ds_read_b128 v[44:47], v70 offset:1024
    ds_read_b128 v[48:51], v70 offset:2048
    ds_read_b128 v[52:55], v70 offset:3072
    ds_read_b128 v[24:27], v70 offset:4096
    ds_read_b128 v[28:31], v70 offset:5120
    ds_read_b128 v[32:35], v70 offset:6144
    ds_read_b128 v[36:39], v70 offset:7168
    s_mov_b32 s31, 65536
    s_add_u32 s24, s24, 524288
    s_add_u32 s26, s26, 524288
    s_add_u32 s55, s55, s57
    s_cmp_lt_u32 s97, s93
    s_cselect_b32 s37, 1, 0
    s_cmp_eq_u32 s30, 63
    s_cselect_b32 s37, 1, s37
    s_mov_b32 s14, 67108864
    s_mov_b32 s15, 67112960
    s_mov_b32 s16, 67117056
    s_mov_b32 s36, 1
    v_mov_b32 v60, s69
    v_mov_b32 v56, s69
    v_and_b32 v79, 12, v75
    v_cmp_eq_u32 vcc, 0, v79
    s_nop 1
    v_cndmask_b32 v79, 0, 1, vcc
    s_waitcnt lgkmcnt(0)
    s_waitcnt vmcnt(3)
    v_xor_b32 v77, s69, v8
    v_bitop3_b32 v77, v77, v10, s69 bitop3:0xf6
    v_mfma_f32_16x16x32_bf16 v[0:3], v[4:7], v[8:11], 0
    s_waitcnt vmcnt(2)
    v_bitop3_b32 v77, v77, v12, s69 bitop3:0xf6
    v_bitop3_b32 v77, v77, v14, s69 bitop3:0xf6
    v_mfma_f32_16x16x32_bf16 v[0:3], v[4:7], v[12:15], v[0:3]
    s_waitcnt vmcnt(1)
    v_bitop3_b32 v77, v77, v16, s69 bitop3:0xf6
    v_bitop3_b32 v77, v77, v18, s69 bitop3:0xf6
    v_mfma_f32_16x16x32_bf16 v[0:3], v[4:7], v[16:19], v[0:3]
    s_waitcnt vmcnt(0)
    v_bitop3_b32 v77, v77, v20, s69 bitop3:0xf6
    v_bitop3_b32 v77, v77, v22, s69 bitop3:0xf6
    v_mfma_f32_16x16x32_bf16 v[0:3], v[4:7], v[20:23], v[0:3]
    v_and_b32 v77, 1, v77
    v_cmp_ne_u32 vcc, 0, v77
    s_nop 0
    s_cmp_eq_u64 vcc, 0
    s_cselect_b64 s[42:43], -1, 0
    s_nop 2
    v_add_f32 v2, v0, v1
    s_nop 1
    v_add_f32_dpp v2, v2, v2 row_ror:8 row_mask:0xf bank_mask:0xf
    s_nop 1
    v_mov_b32_dpp v0, v2 quad_perm:[0,0,2,2] row_mask:0xf bank_mask:0xf
    v_mov_b32_dpp v1, v2 quad_perm:[1,1,3,3] row_mask:0xf bank_mask:0xf
    s_mov_b64 exec, s[42:43]
    v_cvt_pk_bf16_f32 v72, v0, v1
    v_bfi_b32 v72, v79, s70, v72
    buffer_store_dword v72, v75, s[4:7], s17 offen offset:0
    buffer_store_dword v72, v75, s[4:7], s17 offen offset:1024
    buffer_store_dword v72, v75, s[4:7], s17 offen offset:2048
    buffer_store_dword v72, v75, s[4:7], s17 offen offset:3072
    s_mov_b64 exec, -1
    s_cbranch_scc0 cf_f2_retry
cf_f2_go:
    v_mov_b64 v[0:1], 0
    v_mov_b64 v[2:3], 0
    v_mov_b64 v[4:5], 0
    v_mov_b64 v[6:7], 0
    v_mov_b64 v[8:9], 0
    v_mov_b64 v[10:11], 0
    v_mov_b64 v[12:13], 0
    v_mov_b64 v[14:15], 0
    v_mov_b64 v[16:17], 0
    v_mov_b64 v[18:19], 0
    v_mov_b64 v[20:21], 0
    v_mov_b64 v[22:23], 0
    s_branch cf_loop
cf_f1:
    s_cmp_lg_u32 s32, 1
    s_cbranch_scc1 cf_f3
    v_and_b32 v77, 255, v69
    ds_read_b128 v[4:7], v77 offset:15872
    ds_read_b128 v[40:43], v70 offset:0
    ds_read_b128 v[44:47], v70 offset:1024
    ds_read_b128 v[48:51], v70 offset:2048
    ds_read_b128 v[52:55], v70 offset:3072
    ds_read_b128 v[24:27], v70 offset:4096
    ds_read_b128 v[28:31], v70 offset:5120
    ds_read_b128 v[32:35], v70 offset:6144
    ds_read_b128 v[36:39], v70 offset:7168
    s_mov_b32 s31, 65536
    s_add_u32 s24, s24, 524288
    s_add_u32 s26, s26, 524288
    s_add_u32 s55, s55, s57
    s_cmp_lt_u32 s97, s93
    s_cselect_b32 s37, 1, 0
    s_cmp_eq_u32 s30, 63
    s_cselect_b32 s37, 1, s37
    s_mov_b32 s14, 67108864
    s_mov_b32 s15, 67112960
    s_mov_b32 s16, 67117056
    s_mov_b32 s36, 1
    v_mov_b32 v60, s69
    v_mov_b32 v56, s69
    v_and_b32 v79, 12, v75
    v_cmp_eq_u32 vcc, 0, v79
    s_nop 1
    v_cndmask_b32 v79, 0, 1, vcc
    s_nop 2
    v_mov_b32 v79, v79
    s_nop 2
    v_mov_b32 v79, v79
    s_nop 2
    v_mov_b32 v79, v79
    s_nop 2
    v_mov_b32 v79, v79
    s_nop 2
    v_mov_b32 v79, v79
    s_nop 2
    v_mov_b32 v79, v79
    s_nop 2
    v_mov_b32 v79, v79
    s_nop 2
    v_mov_b32 v79, v79
    s_nop 2
    v_mov_b32 v79, v79
    s_nop 2
    v_mov_b32 v79, v79
    s_nop 2
    v_mov_b32 v79, v79
    s_nop 2
    v_mov_b32 v79, v79
    s_nop 2
    v_mov_b32 v79, v79
    s_nop 2
    v_mov_b32 v79, v79
    s_nop 2
    v_mov_b32 v79, v79
    s_nop 2
    v_mov_b32 v79, v79
    s_waitcnt vmcnt(0)
    buffer_load_dwordx4 v[8:11], v65, s[4:7], s18 offen nt
    buffer_load_dwordx4 v[12:15], v65, s[4:7], s19 offen nt
    buffer_load_dwordx4 v[16:19], v65, s[4:7], s20 offen nt
    buffer_load_dwordx4 v[20:23], v65, s[4:7], s21 offen nt
    s_nop 2
    v_mov_b32 v79, v79
    s_nop 2
    v_mov_b32 v79, v79
    s_nop 2
    v_mov_b32 v79, v79
    s_nop 2
    v_mov_b32 v79, v79
    s_nop 2
    v_mov_b32 v79, v79
    s_nop 2
    v_mov_b32 v79, v79
    s_nop 2
    v_mov_b32 v79, v79
    s_nop 2
    v_mov_b32 v79, v79
    s_nop 2
    v_mov_b32 v79, v79
    s_nop 2
    v_mov_b32 v79, v79
    s_nop 2
    v_mov_b32 v79, v79
    s_nop 2
    v_mov_b32 v79, v79
    buffer_load_dwordx4 v[60:63], v65, s[4:7], s14 offen offset:0 nt
    buffer_load_dwordx4 v[56:59], v66, s[4:7], s14 offen offset:0 nt
    s_waitcnt lgkmcnt(0)
    s_waitcnt vmcnt(5)
    v_xor_b32 v77, s69, v8
    v_mfma_f32_16x16x32_bf16 v[0:3], v[4:7], v[8:11], 0
    s_waitcnt vmcnt(4)
    v_bitop3_b32 v77, v77, v12, s69 bitop3:0xf6
    v_mfma_f32_16x16x32_bf16 v[0:3], v[4:7], v[12:15], v[0:3]
    s_waitcnt vmcnt(3)
    v_bitop3_b32 v77, v77, v16, s69 bitop3:0xf6
    v_mfma_f32_16x16x32_bf16 v[0:3], v[4:7], v[16:19], v[0:3]
    s_waitcnt vmcnt(2)
    v_bitop3_b32 v77, v77, v20, s69 bitop3:0xf6
    v_mfma_f32_16x16x32_bf16 v[0:3], v[4:7], v[20:23], v[0:3]
    v_and_b32 v77, 1, v77
    v_cmp_ne_u32 vcc, 0, v77
    buffer_load_dwordx4 v[60:63], v65, s[4:7], s14 offen offset:0 nt
    buffer_load_dwordx4 v[56:59], v66, s[4:7], s14 offen offset:0 nt
    s_cmp_eq_u64 vcc, 0
    s_cselect_b64 s[42:43], -1, 0
    s_nop 1
    v_add_f32_dpp v0, v0, v0 row_ror:8 row_mask:0xf bank_mask:0xf
    v_add_f32_dpp v1, v1, v1 row_ror:8 row_mask:0xf bank_mask:0xf
    s_mov_b64 exec, s[42:43]
    v_cvt_pk_bf16_f32 v72, v0, v1
    v_bfi_b32 v72, v79, s70, v72
    buffer_store_dword v72, v75, s[4:7], s17 offen offset:0
    s_mov_b64 exec, -1
    s_cbranch_scc0 cf_f1_retry
cf_f1_go:
    v_mov_b64 v[0:1], 0
    v_mov_b64 v[2:3], 0
    v_mov_b64 v[4:5], 0
    v_mov_b64 v[6:7], 0
    v_mov_b64 v[8:9], 0
    v_mov_b64 v[10:11], 0
    v_mov_b64 v[12:13], 0
    v_mov_b64 v[14:15], 0
    v_mov_b64 v[16:17], 0
    v_mov_b64 v[18:19], 0
    v_mov_b64 v[20:21], 0
    v_mov_b64 v[22:23], 0
    s_branch cf_loop
cf_f3:
    v_and_b32 v77, 255, v69
    ds_read_b128 v[4:7], v77 offset:15872
    ds_read_b128 v[40:43], v70 offset:0
    ds_read_b128 v[44:47], v70 offset:1024
    ds_read_b128 v[48:51], v70 offset:2048
    ds_read_b128 v[52:55], v70 offset:3072
    ds_read_b128 v[24:27], v70 offset:4096
    ds_read_b128 v[28:31], v70 offset:5120
    ds_read_b128 v[32:35], v70 offset:6144
    ds_read_b128 v[36:39], v70 offset:7168
    s_mov_b32 s31, 65536
    s_add_u32 s24, s24, 524288
    s_add_u32 s26, s26, 524288
    s_add_u32 s55, s55, s57
    s_cmp_lt_u32 s97, s93
    s_cselect_b32 s37, 1, 0
    s_cmp_eq_u32 s30, 63
    s_cselect_b32 s37, 1, s37
    s_mov_b32 s14, 67108864
    s_mov_b32 s15, 67112960
    s_mov_b32 s16, 67117056
    s_mov_b32 s36, 1
    v_mov_b32 v60, s69
    v_mov_b32 v56, s69
    v_and_b32 v79, 12, v75
    v_cmp_eq_u32 vcc, 0, v79
    s_nop 1
    v_cndmask_b32 v79, 0, 1, vcc
    v_add_u32 v72, 1, v72
    s_waitcnt lgkmcnt(0)
    v_mov_b64 v[0:1], 0
    v_mov_b64 v[2:3], 0
    v_mov_b64 v[4:5], 0
    v_mov_b64 v[6:7], 0
    v_mov_b64 v[8:9], 0
    v_mov_b64 v[10:11], 0
    v_mov_b64 v[12:13], 0
    v_mov_b64 v[14:15], 0
    v_mov_b64 v[16:17], 0
    v_mov_b64 v[18:19], 0
    v_mov_b64 v[20:21], 0
    v_mov_b64 v[22:23], 0
    s_nop 2
    v_mov_b32 v79, v79
    s_nop 2
    v_mov_b32 v79, v79
    s_nop 2
    v_mov_b32 v79, v79
    s_nop 2
    v_mov_b32 v79, v79
    s_nop 2
    v_mov_b32 v79, v79
    s_nop 2
    v_mov_b32 v79, v79
    s_nop 2
    v_mov_b32 v79, v79
    s_nop 2
    v_mov_b32 v79, v79
    s_nop 2
    v_mov_b32 v79, v79
    s_nop 2
    v_mov_b32 v79, v79
    s_nop 2
    v_mov_b32 v79, v79
    s_nop 2
    v_mov_b32 v79, v79
    s_nop 2
    v_mov_b32 v79, v79
    s_nop 2
    v_mov_b32 v79, v79
    s_nop 2
    v_mov_b32 v79, v79
    s_nop 2
    v_mov_b32 v79, v79
    s_nop 2
    v_mov_b32 v79, v79
    s_nop 2
    v_mov_b32 v79, v79
    s_nop 2
    v_mov_b32 v79, v79
    s_nop 2
    v_mov_b32 v79, v79
    s_nop 2
    v_mov_b32 v79, v79
    s_nop 2
    v_mov_b32 v79, v79
    s_nop 2
    v_mov_b32 v79, v79
    s_nop 2
    v_mov_b32 v79, v79
    s_nop 2
    v_mov_b32 v79, v79
    s_nop 2
    v_mov_b32 v79, v79
    s_waitcnt vmcnt(0)
    s_branch cf_loop
cf_f0_retry:
cf_f0_spin:
    buffer_load_dwordx4 v[8:11], v65, s[4:7], s18 offen nt
    buffer_load_dwordx4 v[12:15], v65, s[4:7], s19 offen nt
    buffer_load_dwordx4 v[16:19], v65, s[4:7], s20 offen nt
    buffer_load_dwordx4 v[20:23], v65, s[4:7], s21 offen nt
    s_nop 2
    v_mov_b32 v79, v79
    s_nop 2
    v_mov_b32 v79, v79
    s_nop 2
    v_mov_b32 v79, v79
    s_nop 2
    v_mov_b32 v79, v79
    s_nop 2
    v_mov_b32 v79, v79
    s_nop 2
    v_mov_b32 v79, v79
    buffer_load_dwordx4 v[60:63], v65, s[4:7], s14 offen offset:0 nt
    buffer_load_dwordx4 v[56:59], v66, s[4:7], s14 offen offset:0 nt
    s_waitcnt vmcnt(5)
    v_xor_b32 v77, s69, v8
    v_mfma_f32_16x16x32_bf16 v[0:3], v[4:7], v[8:11], 0
    s_waitcnt vmcnt(4)
    v_bitop3_b32 v77, v77, v12, s69 bitop3:0xf6
    v_mfma_f32_16x16x32_bf16 v[0:3], v[4:7], v[12:15], v[0:3]
    s_waitcnt vmcnt(3)
    v_bitop3_b32 v77, v77, v16, s69 bitop3:0xf6
    v_mfma_f32_16x16x32_bf16 v[0:3], v[4:7], v[16:19], v[0:3]
    s_waitcnt vmcnt(2)
    v_bitop3_b32 v77, v77, v20, s69 bitop3:0xf6
    v_mfma_f32_16x16x32_bf16 v[0:3], v[4:7], v[20:23], v[0:3]
    v_and_b32 v77, 1, v77
    v_cmp_ne_u32 vcc, 0, v77
    buffer_load_dwordx4 v[60:63], v65, s[4:7], s14 offen offset:0 nt
    buffer_load_dwordx4 v[56:59], v66, s[4:7], s14 offen offset:0 nt
    s_cmp_eq_u64 vcc, 0
    s_cselect_b64 s[42:43], -1, 0
    s_nop 1
    v_add_f32_dpp v0, v0, v0 row_ror:8 row_mask:0xf bank_mask:0xf
    v_add_f32_dpp v1, v1, v1 row_ror:8 row_mask:0xf bank_mask:0xf
    s_mov_b64 exec, s[42:43]
    v_cvt_pk_bf16_f32 v72, v0, v1
    v_bfi_b32 v72, v79, s70, v72
    buffer_store_dword v72, v75, s[4:7], s17 offen offset:0
    s_mov_b64 exec, -1
    s_cbranch_scc1 cf_f0_rx
    s_sub_u32 s31, s31, 1
    s_cbranch_scc0 cf_f0_spin
cf_f0_rx:
    v_mov_b64 v[0:1], 0
    v_mov_b64 v[2:3], 0
    v_mov_b64 v[4:5], 0
    v_mov_b64 v[6:7], 0
    v_mov_b64 v[8:9], 0
    v_mov_b64 v[10:11], 0
    v_mov_b64 v[12:13], 0
    v_mov_b64 v[14:15], 0
    v_mov_b64 v[16:17], 0
    v_mov_b64 v[18:19], 0
    v_mov_b64 v[20:21], 0
    v_mov_b64 v[22:23], 0
    s_branch cf_loop
cf_f1_retry:
cf_f1_spin:
    s_nop 0
    buffer_load_dwordx4 v[8:11], v65, s[4:7], s18 offen nt
    buffer_load_dwordx4 v[12:15], v65, s[4:7], s19 offen nt
    buffer_load_dwordx4 v[16:19], v65, s[4:7], s20 offen nt
    buffer_load_dwordx4 v[20:23], v65, s[4:7], s21 offen nt
    s_nop 2
    v_mov_b32 v79, v79
    s_nop 2
    v_mov_b32 v79, v79
    s_nop 2
    v_mov_b32 v79, v79
    s_nop 2
    v_mov_b32 v79, v79
    s_nop 2
    v_mov_b32 v79, v79
    s_nop 2
    v_mov_b32 v79, v79
    buffer_load_dwordx4 v[60:63], v65, s[4:7], s14 offen offset:0 nt
    buffer_load_dwordx4 v[56:59], v66, s[4:7], s14 offen offset:0 nt
    s_waitcnt vmcnt(5)
    v_xor_b32 v77, s69, v8
    v_mfma_f32_16x16x32_bf16 v[0:3], v[4:7], v[8:11], 0
    s_waitcnt vmcnt(4)
    v_bitop3_b32 v77, v77, v12, s69 bitop3:0xf6
    v_mfma_f32_16x16x32_bf16 v[0:3], v[4:7], v[12:15], v[0:3]
    s_waitcnt vmcnt(3)
    v_bitop3_b32 v77, v77, v16, s69 bitop3:0xf6
    v_mfma_f32_16x16x32_bf16 v[0:3], v[4:7], v[16:19], v[0:3]
    s_waitcnt vmcnt(2)
    v_bitop3_b32 v77, v77, v20, s69 bitop3:0xf6
    v_mfma_f32_16x16x32_bf16 v[0:3], v[4:7], v[20:23], v[0:3]
    v_and_b32 v77, 1, v77
    v_cmp_ne_u32 vcc, 0, v77
    buffer_load_dwordx4 v[60:63], v65, s[4:7], s14 offen offset:0 nt
    buffer_load_dwordx4 v[56:59], v66, s[4:7], s14 offen offset:0 nt
    s_cmp_eq_u64 vcc, 0
    s_cselect_b64 s[42:43], -1, 0
    s_nop 1
    v_add_f32_dpp v0, v0, v0 row_ror:8 row_mask:0xf bank_mask:0xf
    v_add_f32_dpp v1, v1, v1 row_ror:8 row_mask:0xf bank_mask:0xf
    s_mov_b64 exec, s[42:43]
    v_cvt_pk_bf16_f32 v72, v0, v1
    v_bfi_b32 v72, v79, s70, v72
    buffer_store_dword v72, v75, s[4:7], s17 offen offset:0
    s_mov_b64 exec, -1
    s_cbranch_scc1 cf_f1_rx
    s_sub_u32 s31, s31, 1
    s_cbranch_scc0 cf_f1_spin
cf_f1_rx:
    v_mov_b64 v[0:1], 0
    v_mov_b64 v[2:3], 0
    v_mov_b64 v[4:5], 0
    v_mov_b64 v[6:7], 0
    v_mov_b64 v[8:9], 0
    v_mov_b64 v[10:11], 0
    v_mov_b64 v[12:13], 0
    v_mov_b64 v[14:15], 0
    v_mov_b64 v[16:17], 0
    v_mov_b64 v[18:19], 0
    v_mov_b64 v[20:21], 0
    v_mov_b64 v[22:23], 0
    s_branch cf_loop
cf_f2_retry:
cf_f2_spin:
    s_nop 0
    buffer_load_dwordx4 v[8:11], v65, s[4:7], s18 offen nt
    buffer_load_dwordx4 v[12:15], v65, s[4:7], s19 offen nt
    buffer_load_dwordx4 v[16:19], v65, s[4:7], s20 offen nt
    buffer_load_dwordx4 v[20:23], v65, s[4:7], s21 offen nt
    s_nop 2
    v_mov_b32 v79, v79
    s_nop 2
    v_mov_b32 v79, v79
    s_nop 2
    v_mov_b32 v79, v79
    s_nop 2
    v_mov_b32 v79, v79
    s_nop 2
    v_mov_b32 v79, v79
    s_nop 2
    v_mov_b32 v79, v79
    buffer_load_dwordx4 v[60:63], v65, s[4:7], s14 offen offset:0 nt
    buffer_load_dwordx4 v[56:59], v66, s[4:7], s14 offen offset:0 nt
    s_waitcnt vmcnt(5)
    v_xor_b32 v77, s69, v8
    v_bitop3_b32 v77, v77, v10, s69 bitop3:0xf6
    v_mfma_f32_16x16x32_bf16 v[0:3], v[4:7], v[8:11], 0
    s_waitcnt vmcnt(4)
    v_bitop3_b32 v77, v77, v12, s69 bitop3:0xf6
    v_bitop3_b32 v77, v77, v14, s69 bitop3:0xf6
    v_mfma_f32_16x16x32_bf16 v[0:3], v[4:7], v[12:15], v[0:3]
    s_waitcnt vmcnt(3)
    v_bitop3_b32 v77, v77, v16, s69 bitop3:0xf6
    v_bitop3_b32 v77, v77, v18, s69 bitop3:0xf6
    v_mfma_f32_16x16x32_bf16 v[0:3], v[4:7], v[16:19], v[0:3]
    s_waitcnt vmcnt(2)
    v_bitop3_b32 v77, v77, v20, s69 bitop3:0xf6
    v_bitop3_b32 v77, v77, v22, s69 bitop3:0xf6
    v_mfma_f32_16x16x32_bf16 v[0:3], v[4:7], v[20:23], v[0:3]
    v_and_b32 v77, 1, v77
    v_cmp_ne_u32 vcc, 0, v77
    buffer_load_dwordx4 v[60:63], v65, s[4:7], s14 offen offset:0 nt
    buffer_load_dwordx4 v[56:59], v66, s[4:7], s14 offen offset:0 nt
    s_cmp_eq_u64 vcc, 0
    s_cselect_b64 s[42:43], -1, 0
    s_nop 1
    v_add_f32 v2, v0, v1
    s_nop 1
    v_add_f32_dpp v2, v2, v2 row_ror:8 row_mask:0xf bank_mask:0xf
    s_nop 1
    v_mov_b32_dpp v0, v2 quad_perm:[0,0,2,2] row_mask:0xf bank_mask:0xf
    v_mov_b32_dpp v1, v2 quad_perm:[1,1,3,3] row_mask:0xf bank_mask:0xf
    s_mov_b64 exec, s[42:43]
    v_cvt_pk_bf16_f32 v72, v0, v1
    v_bfi_b32 v72, v79, s70, v72
    buffer_store_dword v72, v75, s[4:7], s17 offen offset:0
    buffer_store_dword v72, v75, s[4:7], s17 offen offset:1024
    buffer_store_dword v72, v75, s[4:7], s17 offen offset:2048
    buffer_store_dword v72, v75, s[4:7], s17 offen offset:3072
    s_mov_b64 exec, -1
    s_cbranch_scc1 cf_f2_rx
    s_sub_u32 s31, s31, 1
    s_cbranch_scc0 cf_f2_spin
cf_f2_rx:
    v_mov_b64 v[0:1], 0
    v_mov_b64 v[2:3], 0
    v_mov_b64 v[4:5], 0
    v_mov_b64 v[6:7], 0
    v_mov_b64 v[8:9], 0
    v_mov_b64 v[10:11], 0
    v_mov_b64 v[12:13], 0
    v_mov_b64 v[14:15], 0
    v_mov_b64 v[16:17], 0
    v_mov_b64 v[18:19], 0
    v_mov_b64 v[20:21], 0
    v_mov_b64 v[22:23], 0
    s_branch cf_loop
cf_spinB:
    buffer_load_dwordx4 v[40:43], v65, s[4:7], s15 offen nt
cf_spinB_l:
    v_and_b32 v77, s36, v40
    v_cmp_ne_u32 vcc, s70, v77
    s_cbranch_vccz cf_spinB_x
    s_nop 1
    v_and_b32 v77, s36, v40
    v_cmp_ne_u32 vcc, s70, v77
    s_cbranch_vccz cf_spinB_x
    s_nop 1
    v_and_b32 v77, s36, v40
    v_cmp_ne_u32 vcc, s70, v77
    s_cbranch_vccz cf_spinB_x
    s_nop 1
    buffer_load_dwordx4 v[40:43], v65, s[4:7], s15 offen nt
    s_sub_u32 s31, s31, 16
    s_cbranch_scc0 cf_spinB_l
cf_spinB_x:
    ds_write_b128 v65, v[40:43] offset:4096
    s_waitcnt lgkmcnt(0)
    s_branch cf_backB
cf_spin8:
    buffer_load_dwordx4 v[60:63], v65, s[4:7], s16 offen nt
cf_spin8_l:
    v_and_b32 v77, s36, v60
    v_cmp_ne_u32 vcc, s70, v77
    s_cbranch_vccz cf_spin8_x
    s_nop 1
    v_and_b32 v77, s36, v60
    v_cmp_ne_u32 vcc, s70, v77
    s_cbranch_vccz cf_spin8_x
    s_nop 1
    v_and_b32 v77, s36, v60
    v_cmp_ne_u32 vcc, s70, v77
    s_cbranch_vccz cf_spin8_x
    s_nop 1
    buffer_load_dwordx4 v[60:63], v65, s[4:7], s16 offen nt
    s_sub_u32 s31, s31, 16
    s_cbranch_scc0 cf_spin8_l
cf_spin8_x:
    s_branch cf_back8
cf_pubk:
    s_mov_b64 exec, s[34:35]
    buffer_store_dwordx4 v[0:3], v65, s[4:7], s28 offen sc1
    s_mov_b64 exec, -1
    s_add_u32 s28, s28, 131072
    s_branch cf_pubk_x
cf_pubv:
    buffer_store_dwordx4 v[38:41], v65, s[4:7], s27 offen sc1
    s_add_u32 s27, s27, 131072
    s_branch cf_pubv_x
cf_rare:
    s_cmp_eq_u32 s30, 63
    s_cbranch_scc1 cf_last
    v_bfe_u32 v78, v65, 2, 8
    s_mov_b64 exec, 0xffff
    buffer_load_dword v78, s[4:7], s96 offen sc1 lds
    s_mov_b64 exec, -1
    s_branch cf_rare_x
cf_kvwait:
    v_bfe_u32 v78, v65, 2, 5
    ds_read_b32 v77, v78 offset:16144
    s_waitcnt lgkmcnt(0)
    v_subrev_u32 v77, s95, v77
    v_cmp_lt_u32 vcc, 16, v77
    s_nop 1
    v_cndmask_b32 v77, v77, 0, vcc
    v_bfe_u32 v79, v78, 2, 2
    v_lshl_add_u32 v77, v77, 2, v79
    s_nop 1
    v_min_u32_dpp v77, v77, v77 row_ror:1 row_mask:0xf bank_mask:0xf
    s_nop 1
    v_min_u32_dpp v77, v77, v77 row_ror:2 row_mask:0xf bank_mask:0xf
    s_nop 1
    v_min_u32_dpp v77, v77, v77 row_ror:4 row_mask:0xf bank_mask:0xf
    s_nop 0
    v_readfirstlane_b32 s97, v77
    s_nop 0
    s_cmp_le_u32 s40, s97
    s_cbranch_scc1 cf_kvw_x
    v_bfe_u32 v78, v65, 2, 5
    s_mov_b32 s31, 4194304
cf_kvw:
    buffer_load_dword v77, v78, s[4:7], s96 offen offset:16 sc1
    s_waitcnt vmcnt(0)
    v_subrev_u32 v77, s95, v77
    v_cmp_lt_u32 vcc, 16, v77
    s_nop 1
    v_cndmask_b32 v77, v77, 0, vcc
    v_bfe_u32 v79, v78, 2, 2
    v_lshl_add_u32 v77, v77, 2, v79
    s_nop 1
    v_min_u32_dpp v77, v77, v77 row_ror:1 row_mask:0xf bank_mask:0xf
    s_nop 1
    v_min_u32_dpp v77, v77, v77 row_ror:2 row_mask:0xf bank_mask:0xf
    s_nop 1
    v_min_u32_dpp v77, v77, v77 row_ror:4 row_mask:0xf bank_mask:0xf
    s_nop 0
    v_readfirstlane_b32 s97, v77
    s_sub_u32 s31, s31, 1
    s_cbranch_scc1 cf_kvw_x
    s_cmp_le_u32 s40, s97
    s_cbranch_scc1 cf_kvw_x
    s_sleep 2
    s_branch cf_kvw
cf_kvw_x:
    s_branch cf_kvok
cf_last:
    s_nop 7
    v_cvt_pk_bf16_f32 v38, v16, v17
    v_cvt_pk_bf16_f32 v39, v18, v19
    v_cvt_pk_bf16_f32 v40, v20, v21
    v_cvt_pk_bf16_f32 v41, v22, v23
    buffer_store_dwordx4 v[38:41], v65, s[4:7], s27 offen sc1
    s_add_u32 s40, s95, 64
    v_mov_b32 v78, s40
    s_waitcnt vmcnt(0)
    s_barrier
    s_mov_b64 exec, s[100:101]
    buffer_store_dword v78, off, s[4:7], s29 sc1
    s_mov_b64 exec, -1
cf_end:
    s_endpgm
L_chain_safe:
    s_load_dwordx8 s[48:55], s[0:1], 8
    s_load_dwordx2 s[56:57], s[0:1], 40
    s_waitcnt lgkmcnt(0)
    v_lshrrev_b32 v77, 6, v0
    s_nop 0
    v_readfirstlane_b32 s13, v77
    v_lshlrev_b32 v65, 4, v0
    v_and_b32 v48, 63, v0
    s_mov_b32 s10, 4718592
    s_mov_b32 s11, 0x20000
    v_lshrrev_b32 v49, 3, v48
    v_mul_u32_u24 v18, 1152, v49
    v_and_b32 v49, 7, v48
    v_lshl_add_u32 v18, v49, 4, v18
    s_mul_i32 s40, s12, 147456
    s_lshl_b32 s41, s13, 8
    s_add_u32 s40, s40, s41
    s_xor_b32 s41, s13, 0
    s_mul_i32 s41, s41, 36864
    s_add_u32 s60, s41, s40
    s_xor_b32 s41, s13, 1
    s_mul_i32 s41, s41, 36864
    s_add_u32 s61, s41, s40
    s_xor_b32 s41, s13, 2
    s_mul_i32 s41, s41, 36864
    s_add_u32 s62, s41, s40
    s_xor_b32 s41, s13, 3
    s_mul_i32 s41, s41, 36864
    s_add_u32 s63, s41, s40
    s_lshl_b32 s43, s13, 12
    s_mov_b64 s[8:9], s[56:57]
    s_add_u32 m0, s43, 0
    s_add_u32 s41, s60, 0
    buffer_load_dwordx4 v18, s[8:11], s41 offen offset:0 nt lds
    s_add_u32 s41, s60, 8192
    buffer_load_dwordx4 v18, s[8:11], s41 offen offset:1024 nt lds
    s_add_u32 s41, s60, 16384
    buffer_load_dwordx4 v18, s[8:11], s41 offen offset:2048 nt lds
    s_add_u32 s41, s60, 24576
    buffer_load_dwordx4 v18, s[8:11], s41 offen offset:3072 nt lds
    s_add_u32 m0, s43, 36864
    s_add_u32 s41, s61, 0
    buffer_load_dwordx4 v18, s[8:11], s41 offen offset:0 nt lds
    s_add_u32 s41, s61, 8192
    buffer_load_dwordx4 v18, s[8:11], s41 offen offset:1024 nt lds
    s_add_u32 s41, s61, 16384
    buffer_load_dwordx4 v18, s[8:11], s41 offen offset:2048 nt lds
    s_add_u32 s41, s61, 24576
    buffer_load_dwordx4 v18, s[8:11], s41 offen offset:3072 nt lds
    s_add_u32 m0, s43, 73728
    s_add_u32 s41, s62, 0
    buffer_load_dwordx4 v18, s[8:11], s41 offen offset:0 nt lds
    s_add_u32 s41, s62, 8192
    buffer_load_dwordx4 v18, s[8:11], s41 offen offset:1024 nt lds
    s_add_u32 s41, s62, 16384
    buffer_load_dwordx4 v18, s[8:11], s41 offen offset:2048 nt lds
    s_add_u32 s41, s62, 24576
    buffer_load_dwordx4 v18, s[8:11], s41 offen offset:3072 nt lds
    s_add_u32 m0, s43, 110592
    s_add_u32 s41, s63, 0
    buffer_load_dwordx4 v18, s[8:11], s41 offen offset:0 nt lds
    s_add_u32 s41, s63, 8192
    buffer_load_dwordx4 v18, s[8:11], s41 offen offset:1024 nt lds
    s_add_u32 s41, s63, 16384
    buffer_load_dwordx4 v18, s[8:11], s41 offen offset:2048 nt lds
    s_add_u32 s41, s63, 24576
    buffer_load_dwordx4 v18, s[8:11], s41 offen offset:3072 nt lds
    v_lshrrev_b32 v49, 1, v48
    v_mul_u32_u24 v19, 1152, v49
    v_and_b32 v49, 1, v48
    v_lshl_add_u32 v19, v49, 4, v19
    s_mul_i32 s41, s13, 224
    s_sub_u32 s41, 1024, s41
    v_add_u32 v19, s41, v19
    v_lshrrev_b32 v49, 4, v48
    v_lshlrev_b32 v50, 2, v49
    v_and_b32 v51, 15, v48
    v_xor_b32 v51, v51, v50
    v_lshlrev_b32 v51, 4, v51
    v_lshl_add_u32 v16, v49, 15, v51
    v_lshrrev_b32 v50, 1, v49
    v_lshl_add_u32 v17, v50, 16, v51
    v_and_b32 v50, 1, v49
    v_lshl_add_u32 v17, v50, 13, v17
    s_lshl_b32 s40, s12, 8
    s_mul_i32 s58, s13, 1048576
    s_add_u32 s58, s58, s40
    s_lshr_b32 s41, s13, 1
    s_mul_i32 s59, s41, 262144
    s_and_b32 s41, s13, 1
    s_lshl_b32 s41, s41, 14
    s_add_u32 s59, s59, s41
    s_add_u32 s59, s59, s40
    s_add_u32 s59, s59, 4194304
    v_bfe_u32 v50, v48, 2, 2
    v_xor_b32 v51, s13, v50
    v_lshlrev_b32 v20, 6, v51
    v_and_b32 v51, 3, v48
    v_lshl_add_u32 v20, v51, 4, v20
    v_lshrrev_b32 v23, 2, v48
    v_lshl_add_u32 v20, v23, 8, v20
    s_xor_b32 s41, s43, 0
    v_add_u32 v24, s41, v20
    s_xor_b32 s41, s43, 4096
    v_add_u32 v25, s41, v20
    s_xor_b32 s41, s43, 8192
    v_add_u32 v26, s41, v20
    s_xor_b32 s41, s43, 12288
    v_add_u32 v27, s41, v20
    v_and_b32 v23, 1, v50
    v_lshl_add_u32 v23, v49, 2, v23
    v_lshrrev_b32 v50, 1, v50
    v_lshlrev_b32 v21, 7, v23
    v_lshl_add_u32 v21, v50, 6, v21
    v_lshl_add_u32 v21, v51, 4, v21
    v_add_u32 v21, s43, v21
    v_lshlrev_b32 v22, 9, v50
    v_xor_b32 v22, v22, v21
    v_lshlrev_b32 v23, 5, v23
    v_lshl_add_u32 v23, v50, 10, v23
    v_lshl_add_u32 v23, v51, 3, v23
    v_add_u32 v23, s43, v23
    v_bfe_u32 v60, v65, 4, 6
    v_and_b32 v61, 15, v60
    v_lshrrev_b32 v62, 4, v60
    v_mov_b32 v64, 0x4444
    v_mov_b32 v77, 0xeeee
    v_cmp_lt_u32 vcc, 7, v61
    s_nop 1
    v_cndmask_b32 v64, v64, v77, vcc
    v_xor_b32 v66, 1024, v65
    v_xor_b32 v67, 2048, v65
    v_xor_b32 v68, 3072, v65
    v_and_b32 v69, 511, v65
    s_mul_i32 s96, s13, 36864
    s_add_u32 s96, s96, 16384
    v_lshlrev_b32 v70, 4, v60
    v_add_u32 v70, s96, v70
    v_lshrrev_b32 v79, 1, v69
    s_lshl_b32 s96, s13, 8
    s_add_u32 s96, s96, 14336
    s_lshl_b32 s33, s13, 10
    s_add_u32 s97, s33, 8192
    v_mov_b32 v77, s97
    v_mov_b32 v78, s96
    v_cmp_lt_u32 vcc, 31, v60
    s_nop 1
    v_cndmask_b32 v71, v77, v78, vcc
    v_add_u32 v71, v71, v79
    v_and_b32 v77, 7, v61
    v_lshrrev_b32 v78, 3, v61
    v_lshlrev_b32 v74, 4, v77
    v_lshl_add_u32 v73, v62, 7, v74
    v_lshl_add_u32 v73, v78, 3, v73
    s_lshl_b32 s96, s13, 9
    v_add_u32 v73, s96, v73
    v_lshl_add_u32 v74, v78, 14, v74
    v_lshl_add_u32 v74, v62, 15, v74
    s_lshl_b32 s96, s13, 17
    v_add_u32 v74, s96, v74
    v_bfe_u32 v77, v61, 2, 1
    v_and_b32 v78, 3, v61
    v_bfe_u32 v79, v61, 1, 2
    s_cmp_lt_u32 s13, 2
    s_cselect_b64 vcc, -1, 0
    v_cndmask_b32 v77, 0, v77, vcc
    v_cndmask_b32 v78, v79, v78, vcc
    v_lshlrev_b32 v75, 7, v77
    v_lshl_add_u32 v75, v62, 4, v75
    v_lshl_add_u32 v75, v78, 2, v75
    v_lshl_add_u32 v58, v77, 3, v78
    v_lshlrev_b32 v79, 1, v78
    v_cndmask_b32 v58, v79, v58, vcc
    s_bfe_u32 s97, s12, 0x10001
    s_lshl_b32 s68, s97, 6
    s_lshl_b32 s97, s97, 2
    v_add_u32 v59, s97, v62
    s_bfe_u32 s96, s12, 0x10002
    s_and_b32 s40, s12, 1
    s_lshl_b32 s96, s96, 1
    s_add_u32 s96, s96, s40
    s_lshr_b32 s97, s12, 3
    s_lshl_b32 s98, s13, 2
    s_add_u32 s98, s98, s97
    s_lshl_b32 s98, s98, 2
    s_add_u32 s98, s98, s96
    s_lshl_b32 s98, s98, 8
    s_lshl_b32 s99, s13, 2
    s_add_u32 s99, s99, s96
    s_lshl_b32 s99, s99, 4
    s_lshl_b32 s41, s97, 1
    s_add_u32 s41, s41, s40
    s_lshl_b32 s41, s41, 7
    s_add_u32 s41, s41, 8192
    s_lshl_b32 s40, s40, 3
    s_add_u32 s40, s40, 512
    s_cmp_lt_u32 s13, 2
    s_cselect_b32 s96, 7, 4
    s_cselect_b32 s98, s98, s41
    s_cselect_b32 s99, s99, s40
    s_cselect_b32 s32, 1, 0
    s_add_u32 s68, s68, s98
    s_lshl_b32 s97, s97, s96
    s_add_u32 s99, s99, s97
    v_add_u32 v58, s99, v58
    s_and_b32 s97, s12, 4
    s_or_b32 s97, s97, s13
    s_cmp_eq_u32 s97, 2
    s_cselect_b32 s32, 2, s32
    s_mov_b32 s8, s48
    s_mov_b32 s9, s49
    s_mov_b32 s10, 9216
    s_cmp_lt_u32 s13, 2
    s_cselect_b32 s96, 8, 2
    v_mul_u32_u24 v77, 1152, v59
    v_lshl_add_u32 v77, v58, 1, v77
    buffer_load_ushort v72, v77, s[8:11], 0 offen
    buffer_load_ushort v76, v77, s[8:11], s96 offen
    s_mov_b32 s10, 4718592
    s_waitcnt vmcnt(12) lgkmcnt(0)
    s_barrier
    s_mov_b64 s[8:9], s[56:57]
    s_add_u32 m0, s43, 147456
    s_add_u32 m0, s43, 147456
    s_nop 0
    buffer_load_dwordx4 v19, s[8:11], s60 offen offset:0 nt lds
    s_add_u32 m0, s43, 148480
    s_nop 0
    buffer_load_dwordx4 v19, s[8:11], s61 offen offset:0 nt lds
    s_add_u32 m0, s43, 149504
    s_nop 0
    buffer_load_dwordx4 v19, s[8:11], s62 offen offset:0 nt lds
    s_add_u32 m0, s43, 150528
    s_nop 0
    buffer_load_dwordx4 v19, s[8:11], s63 offen offset:0 nt lds
    v_mov_b32 v78, v21
    v_mov_b32 v79, v22
    v_add_u32 v77, 0, v79
    ds_read_b64_tr_b16 v[80:81], v77 offset:0
    ds_read_b64_tr_b16 v[82:83], v77 offset:256
    ds_read_b64_tr_b16 v[84:85], v77 offset:2048
    ds_read_b64_tr_b16 v[86:87], v77 offset:2304
    ds_read_b64_tr_b16 v[112:113], v77 offset:8
    ds_read_b64_tr_b16 v[114:115], v77 offset:264
    ds_read_b64_tr_b16 v[116:117], v77 offset:2056
    ds_read_b64_tr_b16 v[118:119], v77 offset:2312
    s_waitcnt vmcnt(12) lgkmcnt(0)
    s_barrier
    s_mov_b64 s[8:9], s[52:53]
    s_add_u32 m0, s43, 0
    s_add_u32 s41, s58, 0
    buffer_load_dwordx4 v16, s[8:11], s41 offen offset:0 nt lds
    s_add_u32 s41, s58, 15360
    buffer_load_dwordx4 v16, s[8:11], s41 offen offset:1024 nt lds
    s_add_u32 s41, s58, 129024
    buffer_load_dwordx4 v16, s[8:11], s41 offen offset:2048 nt lds
    s_add_u32 s41, s58, 144384
    buffer_load_dwordx4 v16, s[8:11], s41 offen offset:3072 nt lds
    v_add_u32 v77, 36864, v78
    ds_read_b64_tr_b16 v[88:89], v77 offset:0
    ds_read_b64_tr_b16 v[90:91], v77 offset:256
    ds_read_b64_tr_b16 v[92:93], v77 offset:2048
    ds_read_b64_tr_b16 v[94:95], v77 offset:2304
    ds_read_b64_tr_b16 v[120:121], v77 offset:8
    ds_read_b64_tr_b16 v[122:123], v77 offset:264
    ds_read_b64_tr_b16 v[124:125], v77 offset:2056
    ds_read_b64_tr_b16 v[126:127], v77 offset:2312
    s_waitcnt vmcnt(12) lgkmcnt(0)
    s_barrier
    s_add_u32 m0, s43, 36864
    s_add_u32 s41, s58, 8192
    buffer_load_dwordx4 v16, s[8:11], s41 offen offset:0 nt lds
    s_add_u32 s41, s58, 23552
    buffer_load_dwordx4 v16, s[8:11], s41 offen offset:1024 nt lds
    s_add_u32 s41, s58, 137216
    buffer_load_dwordx4 v16, s[8:11], s41 offen offset:2048 nt lds
    s_add_u32 s41, s58, 152576
    buffer_load_dwordx4 v16, s[8:11], s41 offen offset:3072 nt lds
    v_add_u32 v77, 73728, v78
    ds_read_b64_tr_b16 v[96:97], v77 offset:0
    ds_read_b64_tr_b16 v[98:99], v77 offset:256
    ds_read_b64_tr_b16 v[100:101], v77 offset:2048
    ds_read_b64_tr_b16 v[102:103], v77 offset:2304
    ds_read_b64_tr_b16 v[128:129], v77 offset:8
    ds_read_b64_tr_b16 v[130:131], v77 offset:264
    ds_read_b64_tr_b16 v[132:133], v77 offset:2056
    ds_read_b64_tr_b16 v[134:135], v77 offset:2312
    s_waitcnt vmcnt(12) lgkmcnt(0)
    s_barrier
    s_add_u32 m0, s43, 73728
    s_add_u32 s41, s58, 262144
    buffer_load_dwordx4 v16, s[8:11], s41 offen offset:0 nt lds
    s_add_u32 s41, s58, 277504
    buffer_load_dwordx4 v16, s[8:11], s41 offen offset:1024 nt lds
    s_add_u32 s41, s58, 391168
    buffer_load_dwordx4 v16, s[8:11], s41 offen offset:2048 nt lds
    s_add_u32 s41, s58, 406528
    buffer_load_dwordx4 v16, s[8:11], s41 offen offset:3072 nt lds
    v_add_u32 v77, 110592, v78
    ds_read_b64_tr_b16 v[104:105], v77 offset:0
    ds_read_b64_tr_b16 v[106:107], v77 offset:256
    ds_read_b64_tr_b16 v[108:109], v77 offset:2048
    ds_read_b64_tr_b16 v[110:111], v77 offset:2304
    ds_read_b64_tr_b16 v[136:137], v77 offset:8
    ds_read_b64_tr_b16 v[138:139], v77 offset:264
    ds_read_b64_tr_b16 v[140:141], v77 offset:2056
    ds_read_b64_tr_b16 v[142:143], v77 offset:2312
    s_waitcnt vmcnt(12) lgkmcnt(0)
    s_barrier
    s_add_u32 m0, s43, 110592
    s_add_u32 s41, s58, 270336
    buffer_load_dwordx4 v16, s[8:11], s41 offen offset:0 nt lds
    s_add_u32 s41, s58, 285696
    buffer_load_dwordx4 v16, s[8:11], s41 offen offset:1024 nt lds
    s_add_u32 s41, s58, 399360
    buffer_load_dwordx4 v16, s[8:11], s41 offen offset:2048 nt lds
    s_add_u32 s41, s58, 414720
    buffer_load_dwordx4 v16, s[8:11], s41 offen offset:3072 nt lds
    v_add_u32 v77, 147456, v23
    ds_read_b64_tr_b16 v[144:145], v77 offset:0
    ds_read_b64_tr_b16 v[146:147], v77 offset:64
    ds_read_b64_tr_b16 v[148:149], v77 offset:512
    ds_read_b64_tr_b16 v[150:151], v77 offset:576
    ds_read_b64_tr_b16 v[152:153], v77 offset:2048
    ds_read_b64_tr_b16 v[154:155], v77 offset:2112
    ds_read_b64_tr_b16 v[156:157], v77 offset:2560
    ds_read_b64_tr_b16 v[158:159], v77 offset:2624
    s_waitcnt vmcnt(12) lgkmcnt(0)
    s_barrier
    s_add_u32 m0, s43, 147456
    s_add_u32 s41, s58, 524288
    buffer_load_dwordx4 v16, s[8:11], s41 offen offset:0 nt lds
    s_add_u32 s41, s58, 539648
    buffer_load_dwordx4 v16, s[8:11], s41 offen offset:1024 nt lds
    s_add_u32 s41, s58, 653312
    buffer_load_dwordx4 v16, s[8:11], s41 offen offset:2048 nt lds
    s_add_u32 s41, s58, 668672
    buffer_load_dwordx4 v16, s[8:11], s41 offen offset:3072 nt lds
    s_cmp_eq_u32 s32, 0
    s_cbranch_scc1 cs_init_done
    v_mov_b32 v52, 1
    v_mov_b32 v53, 1
    v_mov_b32 v54, 1
    v_mov_b32 v55, 1
    v_mov_b32 v56, 0
    v_lshl_or_b32 v72, v76, 16, v72
    s_lshl_b32 s96, s12, 14
    s_add_u32 s96, s96, 68681728
    s_add_u32 s97, s96, 0
    buffer_store_dwordx4 v[52:55], v65, s[4:7], s97 offen sc1
    s_add_u32 s97, s96, 4096
    buffer_store_dwordx4 v[52:55], v65, s[4:7], s97 offen sc1
    s_add_u32 s97, s96, 8192
    buffer_store_dwordx4 v[52:55], v65, s[4:7], s97 offen sc1
    s_add_u32 s97, s96, 12288
    buffer_store_dwordx4 v[52:55], v65, s[4:7], s97 offen sc1
    s_add_u32 s96, s68, 67633152
    s_add_u32 s97, s96, 16384
    buffer_store_dword v56, v75, s[4:7], s96 offen offset:0 sc1
    buffer_store_dword v72, v75, s[4:7], s97 offen offset:0 sc1
    s_cmp_lg_u32 s32, 2
    s_cbranch_scc1 cs_init_done
    buffer_store_dword v56, v75, s[4:7], s96 offen offset:1024 sc1
    buffer_store_dword v72, v75, s[4:7], s97 offen offset:1024 sc1
    buffer_store_dword v56, v75, s[4:7], s96 offen offset:2048 sc1
    buffer_store_dword v72, v75, s[4:7], s97 offen offset:2048 sc1
    buffer_store_dword v56, v75, s[4:7], s96 offen offset:3072 sc1
    buffer_store_dword v72, v75, s[4:7], s97 offen offset:3072 sc1
cs_init_done:
    v_add_u32 v28, 0, v24
    v_add_u32 v29, 0, v25
    v_add_u32 v30, 0, v26
    v_add_u32 v31, 0, v27
    ds_read_b64_tr_b16 a[96:97], v28 offset:0
    ds_read_b64_tr_b16 a[104:105], v28 offset:8
    ds_read_b64_tr_b16 a[112:113], v29 offset:0
    ds_read_b64_tr_b16 a[120:121], v29 offset:8
    ds_read_b64_tr_b16 a[128:129], v30 offset:0
    ds_read_b64_tr_b16 a[136:137], v30 offset:8
    ds_read_b64_tr_b16 a[144:145], v31 offset:0
    ds_read_b64_tr_b16 v[32:33], v31 offset:8
    s_waitcnt vmcnt(12) lgkmcnt(0)
    s_barrier
    s_add_u32 m0, s43, 0
    s_add_u32 s41, s58, 532480
    buffer_load_dwordx4 v16, s[8:11], s41 offen offset:0 nt lds
    s_add_u32 s41, s58, 547840
    buffer_load_dwordx4 v16, s[8:11], s41 offen offset:1024 nt lds
    s_add_u32 s41, s58, 661504
    buffer_load_dwordx4 v16, s[8:11], s41 offen offset:2048 nt lds
    s_add_u32 s41, s58, 676864
    buffer_load_dwordx4 v16, s[8:11], s41 offen offset:3072 nt lds
    ds_write_b64 v70, v[32:33] offset:12288
    v_add_u32 v28, 36864, v24
    v_add_u32 v29, 36864, v25
    v_add_u32 v30, 36864, v26
    v_add_u32 v31, 36864, v27
    ds_read_b64_tr_b16 a[98:99], v28 offset:0
    ds_read_b64_tr_b16 a[106:107], v28 offset:8
    ds_read_b64_tr_b16 a[114:115], v29 offset:0
    ds_read_b64_tr_b16 a[122:123], v29 offset:8
    ds_read_b64_tr_b16 a[130:131], v30 offset:0
    ds_read_b64_tr_b16 a[138:139], v30 offset:8
    ds_read_b64_tr_b16 a[146:147], v31 offset:0
    ds_read_b64_tr_b16 v[0:1], v31 offset:8
    s_waitcnt vmcnt(12) lgkmcnt(0)
    s_barrier
    s_add_u32 m0, s43, 36864
    s_add_u32 s41, s58, 786432
    buffer_load_dwordx4 v16, s[8:11], s41 offen offset:0 nt lds
    s_add_u32 s41, s58, 801792
    buffer_load_dwordx4 v16, s[8:11], s41 offen offset:1024 nt lds
    s_add_u32 s41, s58, 915456
    buffer_load_dwordx4 v16, s[8:11], s41 offen offset:2048 nt lds
    s_add_u32 s41, s58, 930816
    buffer_load_dwordx4 v16, s[8:11], s41 offen offset:3072 nt lds
    ds_write_b64 v70, v[0:1] offset:12296
    v_add_u32 v28, 73728, v24
    v_add_u32 v29, 73728, v25
    v_add_u32 v30, 73728, v26
    v_add_u32 v31, 73728, v27
    ds_read_b64_tr_b16 a[100:101], v28 offset:0
    ds_read_b64_tr_b16 a[108:109], v28 offset:8
    ds_read_b64_tr_b16 a[116:117], v29 offset:0
    ds_read_b64_tr_b16 a[124:125], v29 offset:8
    ds_read_b64_tr_b16 a[132:133], v30 offset:0
    ds_read_b64_tr_b16 a[140:141], v30 offset:8
    ds_read_b64_tr_b16 a[148:149], v31 offset:0
    ds_read_b64_tr_b16 v[32:33], v31 offset:8
    s_waitcnt vmcnt(12) lgkmcnt(0)
    s_barrier
    s_add_u32 m0, s43, 73728
    s_add_u32 s41, s58, 794624
    buffer_load_dwordx4 v16, s[8:11], s41 offen offset:0 nt lds
    s_add_u32 s41, s58, 809984
    buffer_load_dwordx4 v16, s[8:11], s41 offen offset:1024 nt lds
    s_add_u32 s41, s58, 923648
    buffer_load_dwordx4 v16, s[8:11], s41 offen offset:2048 nt lds
    s_add_u32 s41, s58, 939008
    buffer_load_dwordx4 v16, s[8:11], s41 offen offset:3072 nt lds
    ds_write_b64 v70, v[32:33] offset:13312
    v_add_u32 v28, 110592, v24
    v_add_u32 v29, 110592, v25
    v_add_u32 v30, 110592, v26
    v_add_u32 v31, 110592, v27
    ds_read_b64_tr_b16 a[102:103], v28 offset:0
    ds_read_b64_tr_b16 a[110:111], v28 offset:8
    ds_read_b64_tr_b16 a[118:119], v29 offset:0
    ds_read_b64_tr_b16 a[126:127], v29 offset:8
    ds_read_b64_tr_b16 a[134:135], v30 offset:0
    ds_read_b64_tr_b16 a[142:143], v30 offset:8
    ds_read_b64_tr_b16 a[150:151], v31 offset:0
    ds_read_b64_tr_b16 v[0:1], v31 offset:8
    s_waitcnt vmcnt(12) lgkmcnt(0)
    s_barrier
    s_add_u32 m0, s43, 110592
    s_add_u32 s41, s59, 0
    buffer_load_dwordx4 v17, s[8:11], s41 offen offset:0 nt lds
    s_add_u32 s41, s59, 31744
    buffer_load_dwordx4 v17, s[8:11], s41 offen offset:1024 nt lds
    s_add_u32 s41, s59, 129024
    buffer_load_dwordx4 v17, s[8:11], s41 offen offset:2048 nt lds
    s_add_u32 s41, s59, 160768
    buffer_load_dwordx4 v17, s[8:11], s41 offen offset:3072 nt lds
    ds_write_b64 v70, v[0:1] offset:13320
    v_add_u32 v28, 147456, v24
    v_add_u32 v29, 147456, v25
    v_add_u32 v30, 147456, v26
    v_add_u32 v31, 147456, v27
    ds_read_b64_tr_b16 a[152:153], v28 offset:0
    ds_read_b64_tr_b16 a[160:161], v28 offset:8
    ds_read_b64_tr_b16 v[32:33], v29 offset:0
    ds_read_b64_tr_b16 a[168:169], v29 offset:8
    ds_read_b64_tr_b16 a[176:177], v30 offset:0
    ds_read_b64_tr_b16 a[184:185], v30 offset:8
    ds_read_b64_tr_b16 v[34:35], v31 offset:0
    ds_read_b64_tr_b16 a[192:193], v31 offset:8
    s_waitcnt vmcnt(12) lgkmcnt(0)
    s_barrier
    s_mov_b64 s[8:9], s[50:51]
    s_add_u32 m0, s43, 147456
    s_add_u32 s41, s58, 0
    buffer_load_dwordx4 v16, s[8:11], s41 offen offset:0 nt lds
    s_add_u32 s41, s58, 15360
    buffer_load_dwordx4 v16, s[8:11], s41 offen offset:1024 nt lds
    s_add_u32 s41, s58, 129024
    buffer_load_dwordx4 v16, s[8:11], s41 offen offset:2048 nt lds
    s_add_u32 s41, s58, 144384
    buffer_load_dwordx4 v16, s[8:11], s41 offen offset:3072 nt lds
    ds_write_b64 v70, v[32:33] offset:16384
    ds_write_b64 v70, v[34:35] offset:18432
    v_add_u32 v28, 0, v24
    v_add_u32 v29, 0, v25
    v_add_u32 v30, 0, v26
    v_add_u32 v31, 0, v27
    ds_read_b64_tr_b16 a[154:155], v28 offset:0
    ds_read_b64_tr_b16 a[162:163], v28 offset:8
    ds_read_b64_tr_b16 v[0:1], v29 offset:0
    ds_read_b64_tr_b16 a[170:171], v29 offset:8
    ds_read_b64_tr_b16 a[178:179], v30 offset:0
    ds_read_b64_tr_b16 a[186:187], v30 offset:8
    ds_read_b64_tr_b16 v[2:3], v31 offset:0
    ds_read_b64_tr_b16 a[194:195], v31 offset:8
    s_waitcnt vmcnt(12) lgkmcnt(0)
    s_barrier
    s_add_u32 m0, s43, 0
    s_add_u32 s41, s58, 8192
    buffer_load_dwordx4 v16, s[8:11], s41 offen offset:0 nt lds
    s_add_u32 s41, s58, 23552
    buffer_load_dwordx4 v16, s[8:11], s41 offen offset:1024 nt lds
    s_add_u32 s41, s58, 137216
    buffer_load_dwordx4 v16, s[8:11], s41 offen offset:2048 nt lds
    s_add_u32 s41, s58, 152576
    buffer_load_dwordx4 v16, s[8:11], s41 offen offset:3072 nt lds
    ds_write_b64 v70, v[0:1] offset:16392
    ds_write_b64 v70, v[2:3] offset:18440
    v_add_u32 v28, 36864, v24
    v_add_u32 v29, 36864, v25
    v_add_u32 v30, 36864, v26
    v_add_u32 v31, 36864, v27
    ds_read_b64_tr_b16 a[156:157], v28 offset:0
    ds_read_b64_tr_b16 a[164:165], v28 offset:8
    ds_read_b64_tr_b16 v[32:33], v29 offset:0
    ds_read_b64_tr_b16 a[172:173], v29 offset:8
    ds_read_b64_tr_b16 a[180:181], v30 offset:0
    ds_read_b64_tr_b16 a[188:189], v30 offset:8
    ds_read_b64_tr_b16 v[34:35], v31 offset:0
    ds_read_b64_tr_b16 a[196:197], v31 offset:8
    s_waitcnt vmcnt(12) lgkmcnt(0)
    s_barrier
    s_add_u32 m0, s43, 36864
    s_add_u32 s41, s58, 262144
    buffer_load_dwordx4 v16, s[8:11], s41 offen offset:0 nt lds
    s_add_u32 s41, s58, 277504
    buffer_load_dwordx4 v16, s[8:11], s41 offen offset:1024 nt lds
    s_add_u32 s41, s58, 391168
    buffer_load_dwordx4 v16, s[8:11], s41 offen offset:2048 nt lds
    s_add_u32 s41, s58, 406528
    buffer_load_dwordx4 v16, s[8:11], s41 offen offset:3072 nt lds
    ds_write_b64 v70, v[32:33] offset:17408
    ds_write_b64 v70, v[34:35] offset:19456
    v_add_u32 v28, 73728, v24
    v_add_u32 v29, 73728, v25
    v_add_u32 v30, 73728, v26
    v_add_u32 v31, 73728, v27
    ds_read_b64_tr_b16 a[158:159], v28 offset:0
    ds_read_b64_tr_b16 a[166:167], v28 offset:8
    ds_read_b64_tr_b16 v[0:1], v29 offset:0
    ds_read_b64_tr_b16 a[174:175], v29 offset:8
    ds_read_b64_tr_b16 a[182:183], v30 offset:0
    ds_read_b64_tr_b16 a[190:191], v30 offset:8
    ds_read_b64_tr_b16 v[2:3], v31 offset:0
    ds_read_b64_tr_b16 a[198:199], v31 offset:8
    s_waitcnt vmcnt(12) lgkmcnt(0)
    s_barrier
    s_add_u32 m0, s43, 73728
    s_add_u32 s41, s58, 270336
    buffer_load_dwordx4 v16, s[8:11], s41 offen offset:0 nt lds
    s_add_u32 s41, s58, 285696
    buffer_load_dwordx4 v16, s[8:11], s41 offen offset:1024 nt lds
    s_add_u32 s41, s58, 399360
    buffer_load_dwordx4 v16, s[8:11], s41 offen offset:2048 nt lds
    s_add_u32 s41, s58, 414720
    buffer_load_dwordx4 v16, s[8:11], s41 offen offset:3072 nt lds
    ds_write_b64 v70, v[0:1] offset:17416
    ds_write_b64 v70, v[2:3] offset:19464
    v_add_u32 v77, 110592, v20
    ds_read_b64_tr_b16 a[200:201], v77 offset:0
    ds_read_b64_tr_b16 a[202:203], v77 offset:4096
    ds_read_b64_tr_b16 a[204:205], v77 offset:8192
    ds_read_b64_tr_b16 a[206:207], v77 offset:12288
    ds_read_b64_tr_b16 a[208:209], v77 offset:8
    ds_read_b64_tr_b16 a[210:211], v77 offset:4104
    ds_read_b64_tr_b16 a[212:213], v77 offset:8200
    ds_read_b64_tr_b16 a[214:215], v77 offset:12296
    s_waitcnt vmcnt(12) lgkmcnt(0)
    s_barrier
    s_add_u32 m0, s43, 110592
    s_add_u32 s41, s58, 524288
    buffer_load_dwordx4 v16, s[8:11], s41 offen offset:0 nt lds
    s_add_u32 s41, s58, 539648
    buffer_load_dwordx4 v16, s[8:11], s41 offen offset:1024 nt lds
    s_add_u32 s41, s58, 653312
    buffer_load_dwordx4 v16, s[8:11], s41 offen offset:2048 nt lds
    s_add_u32 s41, s58, 668672
    buffer_load_dwordx4 v16, s[8:11], s41 offen offset:3072 nt lds
    v_add_u32 v28, 147456, v24
    v_add_u32 v29, 147456, v25
    v_add_u32 v30, 147456, v26
    v_add_u32 v31, 147456, v27
    ds_read_b64_tr_b16 v[0:1], v28 offset:0
    ds_read_b64_tr_b16 v[2:3], v28 offset:8
    ds_read_b64_tr_b16 v[4:5], v29 offset:0
    ds_read_b64_tr_b16 v[6:7], v29 offset:8
    ds_read_b64_tr_b16 a[0:1], v30 offset:0
    ds_read_b64_tr_b16 v[8:9], v30 offset:8
    ds_read_b64_tr_b16 a[8:9], v31 offset:0
    ds_read_b64_tr_b16 v[10:11], v31 offset:8
    s_waitcnt vmcnt(12) lgkmcnt(0)
    s_barrier
    s_add_u32 m0, s43, 147456
    s_add_u32 s41, s58, 532480
    buffer_load_dwordx4 v16, s[8:11], s41 offen offset:0 nt lds
    s_add_u32 s41, s58, 547840
    buffer_load_dwordx4 v16, s[8:11], s41 offen offset:1024 nt lds
    s_add_u32 s41, s58, 661504
    buffer_load_dwordx4 v16, s[8:11], s41 offen offset:2048 nt lds
    s_add_u32 s41, s58, 676864
    buffer_load_dwordx4 v16, s[8:11], s41 offen offset:3072 nt lds
    ds_write_b64 v70, v[0:1] offset:0
    ds_write_b64 v70, v[2:3] offset:2048
    ds_write_b64 v70, v[4:5] offset:4096
    ds_write_b64 v70, v[6:7] offset:6144
    ds_write_b64 v70, v[8:9] offset:10240
    ds_write_b64 v70, v[10:11] offset:14336
    v_add_u32 v28, 0, v24
    v_add_u32 v29, 0, v25
    v_add_u32 v30, 0, v26
    v_add_u32 v31, 0, v27
    ds_read_b64_tr_b16 v[32:33], v28 offset:0
    ds_read_b64_tr_b16 v[34:35], v28 offset:8
    ds_read_b64_tr_b16 v[36:37], v29 offset:0
    ds_read_b64_tr_b16 v[38:39], v29 offset:8
    ds_read_b64_tr_b16 a[2:3], v30 offset:0
    ds_read_b64_tr_b16 v[40:41], v30 offset:8
    ds_read_b64_tr_b16 a[10:11], v31 offset:0
    ds_read_b64_tr_b16 v[42:43], v31 offset:8
    s_waitcnt vmcnt(12) lgkmcnt(0)
    s_barrier
    s_add_u32 m0, s43, 0
    s_add_u32 s41, s58, 786432
    buffer_load_dwordx4 v16, s[8:11], s41 offen offset:0 nt lds
    s_add_u32 s41, s58, 801792
    buffer_load_dwordx4 v16, s[8:11], s41 offen offset:1024 nt lds
    s_add_u32 s41, s58, 915456
    buffer_load_dwordx4 v16, s[8:11], s41 offen offset:2048 nt lds
    s_add_u32 s41, s58, 930816
    buffer_load_dwordx4 v16, s[8:11], s41 offen offset:3072 nt lds
    ds_write_b64 v70, v[32:33] offset:8
    ds_write_b64 v70, v[34:35] offset:2056
    ds_write_b64 v70, v[36:37] offset:4104
    ds_write_b64 v70, v[38:39] offset:6152
    ds_write_b64 v70, v[40:41] offset:10248
    ds_write_b64 v70, v[42:43] offset:14344
    v_add_u32 v28, 36864, v24
    v_add_u32 v29, 36864, v25
    v_add_u32 v30, 36864, v26
    v_add_u32 v31, 36864, v27
    ds_read_b64_tr_b16 v[0:1], v28 offset:0
    ds_read_b64_tr_b16 v[2:3], v28 offset:8
    ds_read_b64_tr_b16 v[4:5], v29 offset:0
    ds_read_b64_tr_b16 v[6:7], v29 offset:8
    ds_read_b64_tr_b16 a[4:5], v30 offset:0
    ds_read_b64_tr_b16 v[8:9], v30 offset:8
    ds_read_b64_tr_b16 a[12:13], v31 offset:0
    ds_read_b64_tr_b16 v[10:11], v31 offset:8
    s_waitcnt vmcnt(12) lgkmcnt(0)
    s_barrier
    s_add_u32 m0, s43, 36864
    s_add_u32 s41, s58, 794624
    buffer_load_dwordx4 v16, s[8:11], s41 offen offset:0 nt lds
    s_add_u32 s41, s58, 809984
    buffer_load_dwordx4 v16, s[8:11], s41 offen offset:1024 nt lds
    s_add_u32 s41, s58, 923648
    buffer_load_dwordx4 v16, s[8:11], s41 offen offset:2048 nt lds
    s_add_u32 s41, s58, 939008
    buffer_load_dwordx4 v16, s[8:11], s41 offen offset:3072 nt lds
    ds_write_b64 v70, v[0:1] offset:1024
    ds_write_b64 v70, v[2:3] offset:3072
    ds_write_b64 v70, v[4:5] offset:5120
    ds_write_b64 v70, v[6:7] offset:7168
    ds_write_b64 v70, v[8:9] offset:11264
    ds_write_b64 v70, v[10:11] offset:15360
    v_add_u32 v28, 73728, v24
    v_add_u32 v29, 73728, v25
    v_add_u32 v30, 73728, v26
    v_add_u32 v31, 73728, v27
    ds_read_b64_tr_b16 v[32:33], v28 offset:0
    ds_read_b64_tr_b16 v[34:35], v28 offset:8
    ds_read_b64_tr_b16 v[36:37], v29 offset:0
    ds_read_b64_tr_b16 v[38:39], v29 offset:8
    ds_read_b64_tr_b16 a[6:7], v30 offset:0
    ds_read_b64_tr_b16 v[40:41], v30 offset:8
    ds_read_b64_tr_b16 a[14:15], v31 offset:0
    ds_read_b64_tr_b16 v[42:43], v31 offset:8
    s_waitcnt vmcnt(12) lgkmcnt(0)
    s_barrier
    s_add_u32 m0, s43, 73728
    s_add_u32 s41, s59, 0
    buffer_load_dwordx4 v17, s[8:11], s41 offen offset:0 nt lds
    s_add_u32 s41, s59, 31744
    buffer_load_dwordx4 v17, s[8:11], s41 offen offset:1024 nt lds
    s_add_u32 s41, s59, 129024
    buffer_load_dwordx4 v17, s[8:11], s41 offen offset:2048 nt lds
    s_add_u32 s41, s59, 160768
    buffer_load_dwordx4 v17, s[8:11], s41 offen offset:3072 nt lds
    ds_write_b64 v70, v[32:33] offset:1032
    ds_write_b64 v70, v[34:35] offset:3080
    ds_write_b64 v70, v[36:37] offset:5128
    ds_write_b64 v70, v[38:39] offset:7176
    ds_write_b64 v70, v[40:41] offset:11272
    ds_write_b64 v70, v[42:43] offset:15368
    v_add_u32 v28, 110592, v24
    v_add_u32 v29, 110592, v25
    v_add_u32 v30, 110592, v26
    v_add_u32 v31, 110592, v27
    ds_read_b64_tr_b16 a[16:17], v28 offset:0
    ds_read_b64_tr_b16 a[24:25], v28 offset:8
    ds_read_b64_tr_b16 a[32:33], v29 offset:0
    ds_read_b64_tr_b16 a[40:41], v29 offset:8
    ds_read_b64_tr_b16 a[48:49], v30 offset:0
    ds_read_b64_tr_b16 a[56:57], v30 offset:8
    ds_read_b64_tr_b16 a[64:65], v31 offset:0
    ds_read_b64_tr_b16 a[72:73], v31 offset:8
    s_waitcnt vmcnt(12) lgkmcnt(0)
    s_barrier
    s_mov_b64 s[8:9], s[54:55]
    s_add_u32 m0, s43, 110592
    s_add_u32 s41, s58, 0
    buffer_load_dwordx4 v16, s[8:11], s41 offen offset:0 nt lds
    s_add_u32 s41, s58, 15360
    buffer_load_dwordx4 v16, s[8:11], s41 offen offset:1024 nt lds
    s_add_u32 s41, s58, 129024
    buffer_load_dwordx4 v16, s[8:11], s41 offen offset:2048 nt lds
    s_add_u32 s41, s58, 144384
    buffer_load_dwordx4 v16, s[8:11], s41 offen offset:3072 nt lds
    v_add_u32 v28, 147456, v24
    v_add_u32 v29, 147456, v25
    v_add_u32 v30, 147456, v26
    v_add_u32 v31, 147456, v27
    ds_read_b64_tr_b16 a[18:19], v28 offset:0
    ds_read_b64_tr_b16 a[26:27], v28 offset:8
    ds_read_b64_tr_b16 a[34:35], v29 offset:0
    ds_read_b64_tr_b16 a[42:43], v29 offset:8
    ds_read_b64_tr_b16 a[50:51], v30 offset:0
    ds_read_b64_tr_b16 a[58:59], v30 offset:8
    ds_read_b64_tr_b16 a[66:67], v31 offset:0
    ds_read_b64_tr_b16 a[74:75], v31 offset:8
    s_waitcnt vmcnt(12) lgkmcnt(0)
    s_barrier
    s_add_u32 m0, s43, 147456
    s_add_u32 s41, s58, 8192
    buffer_load_dwordx4 v16, s[8:11], s41 offen offset:0 nt lds
    s_add_u32 s41, s58, 23552
    buffer_load_dwordx4 v16, s[8:11], s41 offen offset:1024 nt lds
    s_add_u32 s41, s58, 137216
    buffer_load_dwordx4 v16, s[8:11], s41 offen offset:2048 nt lds
    s_add_u32 s41, s58, 152576
    buffer_load_dwordx4 v16, s[8:11], s41 offen offset:3072 nt lds
    v_add_u32 v28, 0, v24
    v_add_u32 v29, 0, v25
    v_add_u32 v30, 0, v26
    v_add_u32 v31, 0, v27
    ds_read_b64_tr_b16 a[20:21], v28 offset:0
    ds_read_b64_tr_b16 a[28:29], v28 offset:8
    ds_read_b64_tr_b16 a[36:37], v29 offset:0
    ds_read_b64_tr_b16 a[44:45], v29 offset:8
    ds_read_b64_tr_b16 a[52:53], v30 offset:0
    ds_read_b64_tr_b16 a[60:61], v30 offset:8
    ds_read_b64_tr_b16 a[68:69], v31 offset:0
    ds_read_b64_tr_b16 a[76:77], v31 offset:8
    s_waitcnt vmcnt(12) lgkmcnt(0)
    s_barrier
    s_add_u32 m0, s43, 0
    s_add_u32 s41, s58, 262144
    buffer_load_dwordx4 v16, s[8:11], s41 offen offset:0 nt lds
    s_add_u32 s41, s58, 277504
    buffer_load_dwordx4 v16, s[8:11], s41 offen offset:1024 nt lds
    s_add_u32 s41, s58, 391168
    buffer_load_dwordx4 v16, s[8:11], s41 offen offset:2048 nt lds
    s_add_u32 s41, s58, 406528
    buffer_load_dwordx4 v16, s[8:11], s41 offen offset:3072 nt lds
    v_add_u32 v28, 36864, v24
    v_add_u32 v29, 36864, v25
    v_add_u32 v30, 36864, v26
    v_add_u32 v31, 36864, v27
    ds_read_b64_tr_b16 a[22:23], v28 offset:0
    ds_read_b64_tr_b16 a[30:31], v28 offset:8
    ds_read_b64_tr_b16 a[38:39], v29 offset:0
    ds_read_b64_tr_b16 a[46:47], v29 offset:8
    ds_read_b64_tr_b16 a[54:55], v30 offset:0
    ds_read_b64_tr_b16 a[62:63], v30 offset:8
    ds_read_b64_tr_b16 a[70:71], v31 offset:0
    ds_read_b64_tr_b16 a[78:79], v31 offset:8
    s_waitcnt vmcnt(12) lgkmcnt(0)
    s_barrier
    s_add_u32 m0, s43, 36864
    s_add_u32 s41, s58, 270336
    buffer_load_dwordx4 v16, s[8:11], s41 offen offset:0 nt lds
    s_add_u32 s41, s58, 285696
    buffer_load_dwordx4 v16, s[8:11], s41 offen offset:1024 nt lds
    s_add_u32 s41, s58, 399360
    buffer_load_dwordx4 v16, s[8:11], s41 offen offset:2048 nt lds
    s_add_u32 s41, s58, 414720
    buffer_load_dwordx4 v16, s[8:11], s41 offen offset:3072 nt lds
    v_add_u32 v77, 73728, v20
    ds_read_b64_tr_b16 a[80:81], v77 offset:0
    ds_read_b64_tr_b16 a[82:83], v77 offset:4096
    ds_read_b64_tr_b16 a[84:85], v77 offset:8192
    ds_read_b64_tr_b16 a[86:87], v77 offset:12288
    ds_read_b64_tr_b16 a[88:89], v77 offset:8
    ds_read_b64_tr_b16 a[90:91], v77 offset:4104
    ds_read_b64_tr_b16 a[92:93], v77 offset:8200
    ds_read_b64_tr_b16 a[94:95], v77 offset:12296
    s_waitcnt vmcnt(12) lgkmcnt(0)
    s_barrier
    s_add_u32 m0, s43, 73728
    s_add_u32 s41, s58, 524288
    buffer_load_dwordx4 v16, s[8:11], s41 offen offset:0 nt lds
    s_add_u32 s41, s58, 539648
    buffer_load_dwordx4 v16, s[8:11], s41 offen offset:1024 nt lds
    s_add_u32 s41, s58, 653312
    buffer_load_dwordx4 v16, s[8:11], s41 offen offset:2048 nt lds
    s_add_u32 s41, s58, 668672
    buffer_load_dwordx4 v16, s[8:11], s41 offen offset:3072 nt lds
    v_add_u32 v28, 110592, v24
    v_add_u32 v29, 110592, v25
    v_add_u32 v30, 110592, v26
    v_add_u32 v31, 110592, v27
    ds_read_b64_tr_b16 a[216:217], v28 offset:0
    ds_read_b64_tr_b16 v[32:33], v28 offset:8
    ds_read_b64_tr_b16 a[224:225], v29 offset:0
    ds_read_b64_tr_b16 a[232:233], v29 offset:8
    ds_read_b64_tr_b16 a[240:241], v30 offset:0
    ds_read_b64_tr_b16 a[248:249], v30 offset:8
    ds_read_b64_tr_b16 v[160:161], v31 offset:0
    ds_read_b64_tr_b16 v[168:169], v31 offset:8
    s_waitcnt vmcnt(12) lgkmcnt(0)
    s_barrier
    s_add_u32 m0, s43, 110592
    s_add_u32 s41, s58, 532480
    buffer_load_dwordx4 v16, s[8:11], s41 offen offset:0 nt lds
    s_add_u32 s41, s58, 547840
    buffer_load_dwordx4 v16, s[8:11], s41 offen offset:1024 nt lds
    s_add_u32 s41, s58, 661504
    buffer_load_dwordx4 v16, s[8:11], s41 offen offset:2048 nt lds
    s_add_u32 s41, s58, 676864
    buffer_load_dwordx4 v16, s[8:11], s41 offen offset:3072 nt lds
    ds_write_b64 v70, v[32:33] offset:8192
    v_add_u32 v28, 147456, v24
    v_add_u32 v29, 147456, v25
    v_add_u32 v30, 147456, v26
    v_add_u32 v31, 147456, v27
    ds_read_b64_tr_b16 a[218:219], v28 offset:0
    ds_read_b64_tr_b16 v[0:1], v28 offset:8
    ds_read_b64_tr_b16 a[226:227], v29 offset:0
    ds_read_b64_tr_b16 a[234:235], v29 offset:8
    ds_read_b64_tr_b16 a[242:243], v30 offset:0
    ds_read_b64_tr_b16 a[250:251], v30 offset:8
    ds_read_b64_tr_b16 v[162:163], v31 offset:0
    ds_read_b64_tr_b16 v[170:171], v31 offset:8
    s_waitcnt vmcnt(12) lgkmcnt(0)
    s_barrier
    s_add_u32 m0, s43, 147456
    s_add_u32 s41, s58, 786432
    buffer_load_dwordx4 v16, s[8:11], s41 offen offset:0 nt lds
    s_add_u32 s41, s58, 801792
    buffer_load_dwordx4 v16, s[8:11], s41 offen offset:1024 nt lds
    s_add_u32 s41, s58, 915456
    buffer_load_dwordx4 v16, s[8:11], s41 offen offset:2048 nt lds
    s_add_u32 s41, s58, 930816
    buffer_load_dwordx4 v16, s[8:11], s41 offen offset:3072 nt lds
    ds_write_b64 v70, v[0:1] offset:8200
    v_add_u32 v28, 0, v24
    v_add_u32 v29, 0, v25
    v_add_u32 v30, 0, v26
    v_add_u32 v31, 0, v27
    ds_read_b64_tr_b16 a[220:221], v28 offset:0
    ds_read_b64_tr_b16 v[32:33], v28 offset:8
    ds_read_b64_tr_b16 a[228:229], v29 offset:0
    ds_read_b64_tr_b16 a[236:237], v29 offset:8
    ds_read_b64_tr_b16 a[244:245], v30 offset:0
    ds_read_b64_tr_b16 a[252:253], v30 offset:8
    ds_read_b64_tr_b16 v[164:165], v31 offset:0
    ds_read_b64_tr_b16 v[172:173], v31 offset:8
    s_waitcnt vmcnt(12) lgkmcnt(0)
    s_barrier
    s_add_u32 m0, s43, 0
    s_add_u32 s41, s58, 794624
    buffer_load_dwordx4 v16, s[8:11], s41 offen offset:0 nt lds
    s_add_u32 s41, s58, 809984
    buffer_load_dwordx4 v16, s[8:11], s41 offen offset:1024 nt lds
    s_add_u32 s41, s58, 923648
    buffer_load_dwordx4 v16, s[8:11], s41 offen offset:2048 nt lds
    s_add_u32 s41, s58, 939008
    buffer_load_dwordx4 v16, s[8:11], s41 offen offset:3072 nt lds
    ds_write_b64 v70, v[32:33] offset:9216
    v_add_u32 v28, 36864, v24
    v_add_u32 v29, 36864, v25
    v_add_u32 v30, 36864, v26
    v_add_u32 v31, 36864, v27
    ds_read_b64_tr_b16 a[222:223], v28 offset:0
    ds_read_b64_tr_b16 v[0:1], v28 offset:8
    ds_read_b64_tr_b16 a[230:231], v29 offset:0
    ds_read_b64_tr_b16 a[238:239], v29 offset:8
    ds_read_b64_tr_b16 a[246:247], v30 offset:0
    ds_read_b64_tr_b16 a[254:255], v30 offset:8
    ds_read_b64_tr_b16 v[166:167], v31 offset:0
    ds_read_b64_tr_b16 v[174:175], v31 offset:8
    s_waitcnt vmcnt(12) lgkmcnt(0)
    s_barrier
    s_add_u32 m0, s43, 36864
    s_add_u32 s41, s59, 0
    buffer_load_dwordx4 v17, s[8:11], s41 offen offset:0 nt lds
    s_add_u32 s41, s59, 31744
    buffer_load_dwordx4 v17, s[8:11], s41 offen offset:1024 nt lds
    s_add_u32 s41, s59, 129024
    buffer_load_dwordx4 v17, s[8:11], s41 offen offset:2048 nt lds
    s_add_u32 s41, s59, 160768
    buffer_load_dwordx4 v17, s[8:11], s41 offen offset:3072 nt lds
    ds_write_b64 v70, v[0:1] offset:9224
    v_add_u32 v28, 73728, v24
    v_add_u32 v29, 73728, v25
    v_add_u32 v30, 73728, v26
    v_add_u32 v31, 73728, v27
    ds_read_b64_tr_b16 v[176:177], v28 offset:0
    ds_read_b64_tr_b16 v[184:185], v28 offset:8
    ds_read_b64_tr_b16 v[192:193], v29 offset:0
    ds_read_b64_tr_b16 v[200:201], v29 offset:8
    ds_read_b64_tr_b16 v[208:209], v30 offset:0
    ds_read_b64_tr_b16 v[216:217], v30 offset:8
    ds_read_b64_tr_b16 v[224:225], v31 offset:0
    ds_read_b64_tr_b16 v[232:233], v31 offset:8
    s_waitcnt vmcnt(12) lgkmcnt(0)
    s_barrier
    s_mov_b64 s[8:9], s[56:57]
    s_add_u32 m0, s43, 73728
    s_add_u32 s41, s60, 128
    buffer_load_dwordx4 v18, s[8:11], s41 offen offset:0 nt lds
    s_add_u32 s41, s60, 8320
    buffer_load_dwordx4 v18, s[8:11], s41 offen offset:1024 nt lds
    s_add_u32 s41, s60, 16512
    buffer_load_dwordx4 v18, s[8:11], s41 offen offset:2048 nt lds
    s_add_u32 s41, s60, 24704
    buffer_load_dwordx4 v18, s[8:11], s41 offen offset:3072 nt lds
    v_add_u32 v28, 110592, v24
    v_add_u32 v29, 110592, v25
    v_add_u32 v30, 110592, v26
    v_add_u32 v31, 110592, v27
    ds_read_b64_tr_b16 v[178:179], v28 offset:0
    ds_read_b64_tr_b16 v[186:187], v28 offset:8
    ds_read_b64_tr_b16 v[194:195], v29 offset:0
    ds_read_b64_tr_b16 v[202:203], v29 offset:8
    ds_read_b64_tr_b16 v[210:211], v30 offset:0
    ds_read_b64_tr_b16 v[218:219], v30 offset:8
    ds_read_b64_tr_b16 v[226:227], v31 offset:0
    ds_read_b64_tr_b16 v[234:235], v31 offset:8
    s_waitcnt vmcnt(12) lgkmcnt(0)
    s_barrier
    s_add_u32 m0, s43, 110592
    s_add_u32 s41, s61, 128
    buffer_load_dwordx4 v18, s[8:11], s41 offen offset:0 nt lds
    s_add_u32 s41, s61, 8320
    buffer_load_dwordx4 v18, s[8:11], s41 offen offset:1024 nt lds
    s_add_u32 s41, s61, 16512
    buffer_load_dwordx4 v18, s[8:11], s41 offen offset:2048 nt lds
    s_add_u32 s41, s61, 24704
    buffer_load_dwordx4 v18, s[8:11], s41 offen offset:3072 nt lds
    v_add_u32 v28, 147456, v24
    v_add_u32 v29, 147456, v25
    v_add_u32 v30, 147456, v26
    v_add_u32 v31, 147456, v27
    ds_read_b64_tr_b16 v[180:181], v28 offset:0
    ds_read_b64_tr_b16 v[188:189], v28 offset:8
    ds_read_b64_tr_b16 v[196:197], v29 offset:0
    ds_read_b64_tr_b16 v[204:205], v29 offset:8
    ds_read_b64_tr_b16 v[212:213], v30 offset:0
    ds_read_b64_tr_b16 v[220:221], v30 offset:8
    ds_read_b64_tr_b16 v[228:229], v31 offset:0
    ds_read_b64_tr_b16 v[236:237], v31 offset:8
    s_waitcnt vmcnt(12) lgkmcnt(0)
    s_barrier
    s_add_u32 m0, s43, 147456
    s_add_u32 s41, s62, 128
    buffer_load_dwordx4 v18, s[8:11], s41 offen offset:0 nt lds
    s_add_u32 s41, s62, 8320
    buffer_load_dwordx4 v18, s[8:11], s41 offen offset:1024 nt lds
    s_add_u32 s41, s62, 16512
    buffer_load_dwordx4 v18, s[8:11], s41 offen offset:2048 nt lds
    s_add_u32 s41, s62, 24704
    buffer_load_dwordx4 v18, s[8:11], s41 offen offset:3072 nt lds
    v_add_u32 v28, 0, v24
    v_add_u32 v29, 0, v25
    v_add_u32 v30, 0, v26
    v_add_u32 v31, 0, v27
    ds_read_b64_tr_b16 v[182:183], v28 offset:0
    ds_read_b64_tr_b16 v[190:191], v28 offset:8
    ds_read_b64_tr_b16 v[198:199], v29 offset:0
    ds_read_b64_tr_b16 v[206:207], v29 offset:8
    ds_read_b64_tr_b16 v[214:215], v30 offset:0
    ds_read_b64_tr_b16 v[222:223], v30 offset:8
    ds_read_b64_tr_b16 v[230:231], v31 offset:0
    ds_read_b64_tr_b16 v[238:239], v31 offset:8
    s_waitcnt vmcnt(12) lgkmcnt(0)
    s_barrier
    s_add_u32 m0, s43, 0
    s_add_u32 s41, s63, 128
    buffer_load_dwordx4 v18, s[8:11], s41 offen offset:0 nt lds
    s_add_u32 s41, s63, 8320
    buffer_load_dwordx4 v18, s[8:11], s41 offen offset:1024 nt lds
    s_add_u32 s41, s63, 16512
    buffer_load_dwordx4 v18, s[8:11], s41 offen offset:2048 nt lds
    s_add_u32 s41, s63, 24704
    buffer_load_dwordx4 v18, s[8:11], s41 offen offset:3072 nt lds
    v_mov_b32 v78, v21
    v_mov_b32 v79, v22
    v_add_u32 v77, 36864, v20
    ds_read_b64_tr_b16 v[240:241], v77 offset:0
    ds_read_b64_tr_b16 v[242:243], v77 offset:4096
    ds_read_b64_tr_b16 v[244:245], v77 offset:8192
    ds_read_b64_tr_b16 v[246:247], v77 offset:12288
    ds_read_b64_tr_b16 v[248:249], v77 offset:8
    ds_read_b64_tr_b16 v[250:251], v77 offset:4104
    ds_read_b64_tr_b16 v[252:253], v77 offset:8200
    ds_read_b64_tr_b16 v[254:255], v77 offset:12296
    s_waitcnt vmcnt(12) lgkmcnt(0)
    s_barrier
    v_add_u32 v77, 73728, v79
    s_waitcnt lgkmcnt(0)
    ds_read_b64_tr_b16 v[0:1], v77 offset:0
    ds_read_b64_tr_b16 v[2:3], v77 offset:256
    ds_read_b64_tr_b16 v[4:5], v77 offset:2048
    ds_read_b64_tr_b16 v[6:7], v77 offset:2304
    ds_read_b64_tr_b16 v[8:9], v77 offset:8
    ds_read_b64_tr_b16 v[10:11], v77 offset:264
    ds_read_b64_tr_b16 v[12:13], v77 offset:2056
    ds_read_b64_tr_b16 v[14:15], v77 offset:2312
    s_waitcnt vmcnt(8) lgkmcnt(0)
    s_barrier
    v_add_u32 v77, 110592, v78
    ds_read_b64_tr_b16 v[16:17], v77 offset:0
    ds_read_b64_tr_b16 v[18:19], v77 offset:256
    ds_read_b64_tr_b16 v[20:21], v77 offset:2048
    ds_read_b64_tr_b16 v[22:23], v77 offset:2304
    ds_read_b64_tr_b16 v[24:25], v77 offset:8
    ds_read_b64_tr_b16 v[26:27], v77 offset:264
    ds_read_b64_tr_b16 v[28:29], v77 offset:2056
    ds_read_b64_tr_b16 v[30:31], v77 offset:2312
    s_waitcnt vmcnt(4) lgkmcnt(0)
    s_barrier
    v_add_u32 v77, 147456, v78
    ds_read_b64_tr_b16 v[32:33], v77 offset:0
    ds_read_b64_tr_b16 v[34:35], v77 offset:256
    ds_read_b64_tr_b16 v[36:37], v77 offset:2048
    ds_read_b64_tr_b16 v[38:39], v77 offset:2304
    ds_read_b64_tr_b16 v[40:41], v77 offset:8
    ds_read_b64_tr_b16 v[42:43], v77 offset:264
    ds_read_b64_tr_b16 v[44:45], v77 offset:2056
    ds_read_b64_tr_b16 v[46:47], v77 offset:2312
    s_waitcnt vmcnt(0) lgkmcnt(0)
    s_barrier
    v_add_u32 v77, 0, v78
    ds_read_b64_tr_b16 v[48:49], v77 offset:0
    ds_read_b64_tr_b16 v[50:51], v77 offset:256
    ds_read_b64_tr_b16 v[52:53], v77 offset:2048
    ds_read_b64_tr_b16 v[54:55], v77 offset:2304
    ds_read_b64_tr_b16 v[56:57], v77 offset:8
    ds_read_b64_tr_b16 v[58:59], v77 offset:264
    ds_read_b64_tr_b16 v[60:61], v77 offset:2056
    ds_read_b64_tr_b16 v[62:63], v77 offset:2312
    s_waitcnt lgkmcnt(0)
    s_barrier
    ds_write_b128 v70, v[0:3] offset:20480
    ds_write_b128 v70, v[4:7] offset:21504
    ds_write_b128 v70, v[8:11] offset:22528
    ds_write_b128 v70, v[12:15] offset:23552
    ds_write_b128 v70, v[16:19] offset:24576
    ds_write_b128 v70, v[20:23] offset:25600
    ds_write_b128 v70, v[24:27] offset:26624
    ds_write_b128 v70, v[28:31] offset:27648
    ds_write_b128 v70, v[32:35] offset:28672
    ds_write_b128 v70, v[36:39] offset:29696
    ds_write_b128 v70, v[40:43] offset:30720
    ds_write_b128 v70, v[44:47] offset:31744
    ds_write_b128 v70, v[48:51] offset:32768
    ds_write_b128 v70, v[52:55] offset:33792
    ds_write_b128 v70, v[56:59] offset:34816
    ds_write_b128 v70, v[60:63] offset:35840
    s_waitcnt lgkmcnt(0)
    v_bfe_u32 v60, v65, 4, 6
    v_and_b32 v61, 15, v60
    v_lshrrev_b32 v62, 4, v60
    v_mov_b32 v50, 0x3f80
    v_mov_b32 v51, 0x3f800000
    v_and_b32 v77, 1, v62
    v_lshlrev_b32 v77, 2, v77
    v_sub_u32 v77, v61, v77
    v_and_b32 v78, 3, v61
    v_lshlrev_b32 v78, 2, v78
    v_lshrrev_b32 v79, 2, v61
    v_add_u32 v78, v78, v79
    v_cmp_eq_u32 vcc, 0, v77
    s_nop 1
    v_cndmask_b32 v8, 0, v50, vcc
    v_cmp_eq_u32 vcc, 1, v77
    s_nop 1
    v_cndmask_b32 v8, v8, v51, vcc
    v_cmp_eq_u32 vcc, 0, v78
    s_nop 1
    v_cndmask_b32 v12, 0, v50, vcc
    v_cmp_eq_u32 vcc, 1, v78
    s_nop 1
    v_cndmask_b32 v12, v12, v51, vcc
    v_cmp_eq_u32 vcc, 2, v77
    s_nop 1
    v_cndmask_b32 v9, 0, v50, vcc
    v_cmp_eq_u32 vcc, 3, v77
    s_nop 1
    v_cndmask_b32 v9, v9, v51, vcc
    v_cmp_eq_u32 vcc, 2, v78
    s_nop 1
    v_cndmask_b32 v13, 0, v50, vcc
    v_cmp_eq_u32 vcc, 3, v78
    s_nop 1
    v_cndmask_b32 v13, v13, v51, vcc
    v_cmp_eq_u32 vcc, 8, v77
    s_nop 1
    v_cndmask_b32 v10, 0, v50, vcc
    v_cmp_eq_u32 vcc, 9, v77
    s_nop 1
    v_cndmask_b32 v10, v10, v51, vcc
    v_cmp_eq_u32 vcc, 4, v78
    s_nop 1
    v_cndmask_b32 v14, 0, v50, vcc
    v_cmp_eq_u32 vcc, 5, v78
    s_nop 1
    v_cndmask_b32 v14, v14, v51, vcc
    v_cmp_eq_u32 vcc, 10, v77
    s_nop 1
    v_cndmask_b32 v11, 0, v50, vcc
    v_cmp_eq_u32 vcc, 11, v77
    s_nop 1
    v_cndmask_b32 v11, v11, v51, vcc
    v_cmp_eq_u32 vcc, 6, v78
    s_nop 1
    v_cndmask_b32 v15, 0, v50, vcc
    v_cmp_eq_u32 vcc, 7, v78
    s_nop 1
    v_cndmask_b32 v15, v15, v51, vcc
    v_lshlrev_b32 v77, 4, v61
    ds_write_b128 v69, v[8:11] offset:15360
    ds_write_b128 v77, v[12:15] offset:15872
    s_waitcnt vmcnt(0) lgkmcnt(0)
    s_barrier
    v_mov_b32 v2, 1
    s_cmp_lg_u32 s13, 0
    s_cbranch_scc1 cs_noarr
    s_mov_b64 exec, 1
    buffer_atomic_add v2, off, s[84:87], 0 offset:212
    s_mov_b32 s40, 16777216
    s_mov_b32 s42, 2
cs_startpoll:
    buffer_load_dword v3, off, s[84:87], 0 offset:212 sc1
    s_sub_u32 s40, s40, 1
    s_cbranch_scc1 cs_decide
    s_waitcnt vmcnt(0)
    v_readfirstlane_b32 s41, v3
    s_nop 1
    s_cmp_lt_u32 s41, 32
    s_cbranch_scc1 cs_startpoll
    s_mov_b32 s42, 1
cs_decide:
    s_mov_b64 exec, -1
cs_noarr:
    s_barrier
    s_mov_b32 m0, 16128
    s_mov_b32 s44, 0x3e0293ee
    s_mov_b32 s45, s44
    s_or_b32 s66, s44, 0x80000000
    s_mov_b32 s48, 0x3f003f00
    s_mov_b32 s49, 0
    s_mov_b32 s50, 0x3f803f80
    s_mov_b32 s51, 0x3f803f80
    s_mov_b32 s52, 512
    s_mov_b32 s53, 1024
    s_mov_b32 s54, 1536
    s_mov_b32 s30, 0
    s_cmp_lg_u32 s32, 0
    s_cselect_b32 s71, s13, 3
    s_mov_b32 s14, 67649536
    s_mov_b32 s15, 67653632
    s_mov_b32 s16, 67657728
    s_mov_b32 s36, 0
    s_add_u32 s17, s68, 67633152
    s_mov_b32 s69, 0
    s_mov_b32 s70, 0
    s_lshl_b32 s26, s12, 14
    s_add_u32 s26, s26, 0
    s_mul_i32 s40, s13, 3072
    s_add_u32 s24, s26, s40
    s_lshl_b32 s96, s12, 7
    s_add_u32 s29, s96, 125845504
    s_add_u32 s96, s96, 125829120
    s_lshl_b32 s40, s12, 14
    s_add_u32 s40, s40, 68681728
    s_add_u32 s18, s40, 0
    s_add_u32 s19, s40, 4096
    s_add_u32 s20, s40, 8192
    s_add_u32 s21, s40, 12288
    s_lshr_b32 s40, s12, 3
    s_lshl_b32 s40, s40, 12
    s_and_b32 s41, s12, 7
    s_lshl_b32 s41, s41, 7
    s_add_u32 s40, s40, s41
    s_add_u32 s22, s40, 68681728
    s_add_u32 s23, s22, 1024
    s_add_u32 s25, s22, 2048
    s_mov_b32 s56, -65528
    s_cmp_lg_u32 s32, 0
    s_cselect_b64 s[38:39], -1, 0
    s_add_u32 s55, s68, 138412032
    s_cmp_eq_u32 s13, 3
    s_cselect_b64 s[100:101], 1, 0
    s_cselect_b64 s[38:39], 1, s[38:39]
    s_cselect_b32 s93, 64, 0
    s_cselect_b32 s55, s29, s55
    s_cselect_b32 s57, 0, 9216
    s_mov_b64 exec, s[100:101]
    v_mov_b32 v72, s95
    s_mov_b64 exec, -1
    s_mov_b32 s34, 0xff00ff00
    s_mov_b32 s35, 0xff00ff00
    s_lshl_b32 s28, s12, 12
    s_add_u32 s28, s28, 7602176
    s_add_u32 s27, s28, 77594624
    s_add_u32 s28, s28, 69206016
    s_mov_b32 s37, s93
    s_mov_b32 s40, 3
    v_bfe_u32 v78, v65, 2, 5
    s_mov_b32 s31, 4194304
cs_kv0:
    buffer_load_dword v77, v78, s[4:7], s96 offen offset:16 sc1
    s_waitcnt vmcnt(0)
    v_subrev_u32 v77, s95, v77
    v_cmp_lt_u32 vcc, 16, v77
    s_nop 1
    v_cndmask_b32 v77, v77, 0, vcc
    v_bfe_u32 v79, v78, 2, 2
    v_lshl_add_u32 v77, v77, 2, v79
    s_nop 1
    v_min_u32_dpp v77, v77, v77 row_ror:1 row_mask:0xf bank_mask:0xf
    s_nop 1
    v_min_u32_dpp v77, v77, v77 row_ror:2 row_mask:0xf bank_mask:0xf
    s_nop 1
    v_min_u32_dpp v77, v77, v77 row_ror:4 row_mask:0xf bank_mask:0xf
    s_nop 0
    v_readfirstlane_b32 s97, v77
    s_sub_u32 s31, s31, 1
    s_cbranch_scc1 cs_kv0_x
    s_cmp_le_u32 s40, s97
    s_cbranch_scc1 cs_kv0_x
    s_sleep 2
    s_branch cs_kv0
cs_kv0_x:
    s_add_u32 s40, s26, 0
    v_lshlrev_b32 v78, 2, v65
    buffer_load_dword v76, v78, s[4:7], s40 offen sc1
    s_add_u32 s40, s26, 524288
    v_lshlrev_b32 v78, 2, v65
    buffer_load_dword v76, v78, s[4:7], s40 offen sc1
cs_kvdone:
    v_mov_b64 v[0:1], 0
    v_mov_b64 v[2:3], 0
    v_mov_b64 v[4:5], 0
    v_mov_b64 v[6:7], 0
    v_mov_b64 v[8:9], 0
    v_mov_b64 v[10:11], 0
    v_mov_b64 v[12:13], 0
    v_mov_b64 v[14:15], 0
    v_mov_b64 v[16:17], 0
    v_mov_b64 v[18:19], 0
    v_mov_b64 v[20:21], 0
    v_mov_b64 v[22:23], 0
    ds_read_b128 v[40:43], v70 offset:0
    ds_read_b128 v[44:47], v70 offset:1024
    ds_read_b128 v[48:51], v70 offset:2048
    ds_read_b128 v[52:55], v70 offset:3072
    ds_read_b128 v[24:27], v70 offset:4096
    ds_read_b128 v[28:31], v70 offset:5120
    ds_read_b128 v[32:35], v70 offset:6144
    ds_read_b128 v[36:39], v70 offset:7168
    buffer_load_dwordx4 v[60:63], v65, s[4:7], s14 offen offset:0 sc1
    buffer_load_dwordx4 v[56:59], v66, s[4:7], s14 offen offset:0 sc1
    s_mov_b32 s31, 1048576
    s_waitcnt vmcnt(0) lgkmcnt(0)
    s_branch cs_goA
cs_loop:
    s_add_u32 s40, s30, 3
    s_min_u32 s40, s40, 64
    s_cmp_le_u32 s40, s97
    s_cbranch_scc0 cs_kvwait
cs_kvok:
    s_mov_b32 s31, 1048576
    s_mov_b32 s69, s70
    s_waitcnt lgkmcnt(0)
cs_cA:
    buffer_load_dwordx4 v[60:63], v65, s[4:7], s14 offen offset:0 sc1
    buffer_load_dwordx4 v[56:59], v66, s[4:7], s14 offen offset:0 sc1
    v_bitop3_b32 v77, v60, v56, s70 bitop3:0x7e
    v_and_b32 v77, 1, v77
    v_cmp_ne_u32 vcc, 0, v77
    s_cbranch_vccz cs_goA
    s_nop 15
    s_nop 15
    s_nop 7
    v_bitop3_b32 v77, v60, v56, s70 bitop3:0x7e
    v_and_b32 v77, 1, v77
    v_cmp_ne_u32 vcc, 0, v77
    s_cbranch_vccz cs_goA
    s_nop 15
    s_nop 15
    s_nop 7
    v_bitop3_b32 v77, v60, v56, s70 bitop3:0x7e
    v_and_b32 v77, 1, v77
    v_cmp_ne_u32 vcc, 0, v77
    s_cbranch_vccz cs_goA
    s_nop 15
    s_nop 15
    s_nop 7
    v_bitop3_b32 v77, v60, v56, s70 bitop3:0x7e
    v_and_b32 v77, 1, v77
    v_cmp_ne_u32 vcc, 0, v77
    s_cbranch_vccz cs_goA
    s_nop 15
    s_nop 15
    s_nop 7
    buffer_load_dwordx4 v[60:63], v65, s[4:7], s14 offen offset:0 sc1
    buffer_load_dwordx4 v[56:59], v66, s[4:7], s14 offen offset:0 sc1
    v_bitop3_b32 v77, v60, v56, s70 bitop3:0x7e
    v_and_b32 v77, 1, v77
    v_cmp_ne_u32 vcc, 0, v77
    s_cbranch_vccz cs_goA
    s_nop 15
    s_nop 15
    s_nop 7
    v_bitop3_b32 v77, v60, v56, s70 bitop3:0x7e
    v_and_b32 v77, 1, v77
    v_cmp_ne_u32 vcc, 0, v77
    s_cbranch_vccz cs_goA
    s_nop 15
    s_nop 15
    s_nop 7
    v_bitop3_b32 v77, v60, v56, s70 bitop3:0x7e
    v_and_b32 v77, 1, v77
    v_cmp_ne_u32 vcc, 0, v77
    s_cbranch_vccz cs_goA
    s_nop 15
    s_nop 15
    s_nop 7
    v_bitop3_b32 v77, v60, v56, s70 bitop3:0x7e
    v_and_b32 v77, 1, v77
    v_cmp_ne_u32 vcc, 0, v77
    s_cbranch_vccz cs_goA
    s_nop 15
    s_nop 15
    s_nop 7
    buffer_load_dwordx4 v[60:63], v65, s[4:7], s14 offen offset:0 sc1
    buffer_load_dwordx4 v[56:59], v66, s[4:7], s14 offen offset:0 sc1
    v_bitop3_b32 v77, v60, v56, s70 bitop3:0x7e
    v_and_b32 v77, 1, v77
    v_cmp_ne_u32 vcc, 0, v77
    s_cbranch_vccz cs_goA
    s_nop 15
    s_nop 15
    s_nop 7
    v_bitop3_b32 v77, v60, v56, s70 bitop3:0x7e
    v_and_b32 v77, 1, v77
    v_cmp_ne_u32 vcc, 0, v77
    s_cbranch_vccz cs_goA
    s_nop 15
    s_nop 15
    s_nop 7
    v_bitop3_b32 v77, v60, v56, s70 bitop3:0x7e
    v_and_b32 v77, 1, v77
    v_cmp_ne_u32 vcc, 0, v77
    s_cbranch_vccz cs_goA
    s_nop 15
    s_nop 15
    s_nop 7
    v_bitop3_b32 v77, v60, v56, s70 bitop3:0x7e
    v_and_b32 v77, 1, v77
    v_cmp_ne_u32 vcc, 0, v77
    s_cbranch_vccz cs_goA
    s_nop 15
    s_nop 15
    s_nop 7
    buffer_load_dwordx4 v[60:63], v65, s[4:7], s14 offen offset:0 sc1
    buffer_load_dwordx4 v[56:59], v66, s[4:7], s14 offen offset:0 sc1
    v_bitop3_b32 v77, v60, v56, s70 bitop3:0x7e
    v_and_b32 v77, 1, v77
    v_cmp_ne_u32 vcc, 0, v77
    s_cbranch_vccz cs_goA
    s_nop 15
    s_nop 15
    s_nop 7
    v_bitop3_b32 v77, v60, v56, s70 bitop3:0x7e
    v_and_b32 v77, 1, v77
    v_cmp_ne_u32 vcc, 0, v77
    s_cbranch_vccz cs_goA
    s_nop 15
    s_nop 15
    s_nop 7
    v_bitop3_b32 v77, v60, v56, s70 bitop3:0x7e
    v_and_b32 v77, 1, v77
    v_cmp_ne_u32 vcc, 0, v77
    s_cbranch_vccz cs_goA
    s_nop 15
    s_nop 15
    s_nop 7
    v_bitop3_b32 v77, v60, v56, s70 bitop3:0x7e
    v_and_b32 v77, 1, v77
    v_cmp_ne_u32 vcc, 0, v77
    s_cbranch_vccz cs_goA
    s_nop 15
    s_nop 15
    s_nop 7
    s_sub_u32 s31, s31, 64
    s_cbranch_scc0 cs_cA
cs_goA:
    ds_write_b128 v65, v[60:63] offset:0
    v_smfmac_f32_16x16x64_bf16 v[0:3], v[60:63], v[40:47], v64
    v_smfmac_f32_16x16x64_bf16 v[4:7], v[60:63], v[48:55], v64
    buffer_load_dwordx4 v[40:43], v65, s[4:7], s15 offen offset:0 sc1
    v_smfmac_f32_16x16x64_bf16 v[0:3], v[56:59], v[24:31], v64
    v_smfmac_f32_16x16x64_bf16 v[4:7], v[56:59], v[32:39], v64
    ds_read_b128 v[24:27], v70 offset:8192
    v_smfmac_f32_16x16x64_bf16 v[8:11], v[60:63], a[96:103], v64
    ds_read_b128 v[28:31], v70 offset:9216
    v_smfmac_f32_16x16x64_bf16 v[12:15], v[60:63], a[104:111], v64
    ds_read_b128 v[32:35], v70 offset:10240
    s_waitcnt lgkmcnt(3)
    s_barrier
    ds_read_b128 v[48:51], v67 offset:0
    v_smfmac_f32_16x16x64_bf16 v[8:11], v[56:59], a[112:119], v64
    ds_read_b128 v[36:39], v70 offset:11264
    v_smfmac_f32_16x16x64_bf16 v[12:15], v[56:59], a[120:127], v64
    ds_read_b128 v[52:55], v68 offset:0
    v_smfmac_f32_16x16x64_bf16 v[16:19], v[60:63], a[216:223], v64
    buffer_load_dwordx4 v[40:43], v65, s[4:7], s15 offen offset:0 sc1
    s_waitcnt lgkmcnt(4)
    v_smfmac_f32_16x16x64_bf16 v[20:23], v[60:63], v[24:31], v64
    ds_read_b128 v[24:27], v70 offset:12288
    s_waitcnt lgkmcnt(3)
    v_smfmac_f32_16x16x64_bf16 v[0:3], v[48:51], a[0:7], v64
    ds_read_b128 v[28:31], v70 offset:13312
    s_waitcnt lgkmcnt(3)
    v_smfmac_f32_16x16x64_bf16 v[4:7], v[48:51], v[32:39], v64
    ds_read_b128 v[32:35], v70 offset:14336
    v_smfmac_f32_16x16x64_bf16 v[8:11], v[48:51], a[128:135], v64
    ds_read_b128 v[36:39], v70 offset:15360
    v_smfmac_f32_16x16x64_bf16 v[12:15], v[48:51], a[136:143], v64
    v_smfmac_f32_16x16x64_bf16 v[16:19], v[56:59], a[224:231], v64
    v_smfmac_f32_16x16x64_bf16 v[20:23], v[56:59], a[232:239], v64
    s_waitcnt lgkmcnt(2)
    s_waitcnt vmcnt(1)
    v_and_b32 v77, s36, v40
    v_smfmac_f32_16x16x64_bf16 v[12:15], v[52:55], v[24:31], v64
    ds_write_b128 v65, v[40:43] offset:4096
    v_smfmac_f32_16x16x64_bf16 v[0:3], v[52:55], a[8:15], v64
    s_waitcnt lgkmcnt(1)
    v_cmp_ne_u32 vcc, s70, v77
    v_smfmac_f32_16x16x64_bf16 v[4:7], v[52:55], v[32:39], v64
    buffer_load_dwordx4 v[60:63], v65, s[4:7], s16 offen offset:0 sc1
    v_smfmac_f32_16x16x64_bf16 v[8:11], v[52:55], a[144:151], v64
    s_cbranch_vccnz cs_spinB
cs_backB:
    v_smfmac_f32_16x16x64_bf16 v[16:19], v[40:43], v[176:183], v64
    s_waitcnt lgkmcnt(0)
    s_barrier
    ds_read_b128 v[44:47], v66 offset:4096
    v_smfmac_f32_16x16x64_bf16 v[12:15], v[40:43], a[160:167], v64
    ds_read_b128 v[32:35], v70 offset:16384
    buffer_load_dwordx4 v[24:27], v65, s[4:7], s24 offen offset:0 sc1
    v_smfmac_f32_16x16x64_bf16 v[0:3], v[40:43], a[16:23], v64
    ds_read_b128 v[36:39], v70 offset:17408
    v_smfmac_f32_16x16x64_bf16 v[8:11], v[40:43], a[152:159], v64
    ds_read_b128 v[48:51], v67 offset:4096
    v_smfmac_f32_16x16x64_bf16 v[4:7], v[40:43], a[24:31], v64
    ds_read_b128 v[52:55], v68 offset:4096
    v_smfmac_f32_16x16x64_bf16 v[20:23], v[40:43], v[184:191], v64
    buffer_load_dwordx4 v[28:31], v65, s[4:7], s24 offen offset:1024 sc1
    s_waitcnt lgkmcnt(4)
    v_smfmac_f32_16x16x64_bf16 v[0:3], v[44:47], a[32:39], v64
    ds_read_b128 v[56:59], v69 offset:15360
    s_waitcnt lgkmcnt(3)
    v_smfmac_f32_16x16x64_bf16 v[8:11], v[44:47], v[32:39], v64
    ds_read_b128 v[32:35], v70 offset:18432
    v_smfmac_f32_16x16x64_bf16 v[4:7], v[44:47], a[40:47], v64
    ds_read_b128 v[36:39], v70 offset:19456
    s_add_u32 s40, s26, 1048576
    v_lshlrev_b32 v78, 2, v65
    v_smfmac_f32_16x16x64_bf16 v[12:15], v[44:47], a[168:175], v64
    buffer_load_dwordx4 v[42:45], v65, s[4:7], s24 offen offset:3072 sc1
    s_waitcnt lgkmcnt(3)
    v_smfmac_f32_16x16x64_bf16 v[0:3], v[48:51], a[48:55], v64
    v_smfmac_f32_16x16x64_bf16 v[8:11], v[48:51], a[176:183], v64
    v_smfmac_f32_16x16x64_bf16 v[0:3], v[52:55], a[64:71], v64
    s_waitcnt lgkmcnt(0)
    v_smfmac_f32_16x16x64_bf16 v[8:11], v[52:55], v[32:39], v64
    buffer_load_dwordx4 v[34:37], v65, s[4:7], s24 offen offset:2048 sc1
    v_smfmac_f32_16x16x64_bf16 v[4:7], v[48:51], a[56:63], v64
    v_smfmac_f32_16x16x64_bf16 v[4:7], v[52:55], a[72:79], v64
    s_waitcnt vmcnt(4)
    v_and_b32 v77, s36, v60
    v_smfmac_f32_16x16x64_bf16 v[12:15], v[48:51], a[184:191], v64
    v_cmp_ne_u32 vcc, s70, v77
    v_smfmac_f32_16x16x64_bf16 v[12:15], v[52:55], a[192:199], v64
    s_cbranch_vccnz cs_spin8
cs_back8:
    v_smfmac_f32_16x16x64_bf16 v[0:3], v[60:63], a[80:87], v64
    s_nop 1
    v_lshrrev_b32 v77, 1, v69
    v_smfmac_f32_16x16x64_bf16 v[8:11], v[60:63], a[200:207], v64
    buffer_load_dword v76, v78, s[4:7], s40 offen sc1
    s_nop 1
    v_smfmac_f32_16x16x64_bf16 v[4:7], v[60:63], a[88:95], v64
    s_nop 1
    v_cvt_pk_bf16_f32 v0, v0, v1
    v_smfmac_f32_16x16x64_bf16 v[12:15], v[60:63], a[208:215], v64
    s_nop 1
    v_cvt_pk_bf16_f32 v1, v2, v3
    v_cvt_pk_bf16_f32 v2, v8, v9
    v_cvt_pk_bf16_f32 v3, v10, v11
    v_cvt_pk_bf16_f32 v4, v4, v5
    v_cvt_pk_bf16_f32 v5, v6, v7
    v_mfma_f32_16x16x32_bf16 v[8:11], v[0:3], v[56:59], 0
    v_cvt_pk_bf16_f32 v6, v12, v13
    v_cvt_pk_bf16_f32 v7, v14, v15
    s_nop 1
    v_mfma_f32_16x16x32_bf16 v[12:15], v[4:7], v[56:59], 0
    ds_read_b128 v[56:59], v66 offset:4096
    s_nop 1
    v_smfmac_f32_16x16x64_bf16 v[16:19], v[48:51], v[208:215], v64
    s_waitcnt vmcnt(3)
    s_nop 0
    v_cvt_pk_bf16_f32 v0, v8, v9
    v_cvt_pk_bf16_f32 v1, v10, v11
    v_cvt_pk_bf16_f32 v2, v12, v13
    v_cvt_pk_bf16_f32 v3, v14, v15
    s_nop 1
    v_mfma_f32_16x16x32_bf16 v[12:15], v[0:3], v[0:3], 0
    s_nop 2
    v_mfma_f32_16x16x32_bf16 v[4:7], v[24:27], v[0:3], 0
    ds_read_b128 v[24:27], v67 offset:0
    s_nop 1
    v_mfma_f32_16x16x32_bf16 v[8:11], v[28:31], v[0:3], 0
    s_nop 0
    v_mov_b32_dpp v12, v14 row_ror:8 row_mask:0xf bank_mask:0xc
    v_mov_b32_dpp v13, v15 row_ror:8 row_mask:0xf bank_mask:0xc
    v_smfmac_f32_16x16x64_bf16 v[20:23], v[48:51], v[216:223], v64
    ds_write_b64 v71, v[12:13]
    ds_read_b128 v[48:51], v68 offset:0
    s_nop 1
    v_mov_b32_dpp v4, v8 row_ror:8 row_mask:0xf bank_mask:0xc
    v_mov_b32_dpp v5, v9 row_ror:8 row_mask:0xf bank_mask:0xc
    v_mov_b32_dpp v6, v10 row_ror:8 row_mask:0xf bank_mask:0xc
    v_mov_b32_dpp v7, v11 row_ror:8 row_mask:0xf bank_mask:0xc
    v_smfmac_f32_16x16x64_bf16 v[16:19], v[52:55], v[224:231], v64
    ds_write_b128 v65, v[4:7] offset:8192
    v_smfmac_f32_16x16x64_bf16 v[20:23], v[52:55], v[232:239], v64
    s_waitcnt lgkmcnt(3)
    v_smfmac_f32_16x16x64_bf16 v[16:19], v[24:27], a[240:247], v64
    s_waitcnt vmcnt(1)
    s_cmp_ge_u32 s30, 58
    v_smfmac_f32_16x16x64_bf16 v[20:23], v[24:27], a[248:255], v64
    s_cbranch_scc1 cs_pubk
cs_pubk_x:
    v_smfmac_f32_16x16x64_bf16 v[16:19], v[60:63], v[240:247], v64
    s_waitcnt lgkmcnt(0)
    s_barrier
    ds_read_b128 v[8:11], v66 offset:8192
    v_smfmac_f32_16x16x64_bf16 v[20:23], v[60:63], v[248:255], v64
    ds_read_b128 v[12:15], v67 offset:8192
    ds_read_b128 v[0:3], v68 offset:8192
    ds_read_b64 v[24:25], v77 offset:14336
    v_smfmac_f32_16x16x64_bf16 v[16:19], v[56:59], v[192:199], v64
    ds_read_b64 v[26:27], v77 offset:14592
    ds_read_b64 v[28:29], v77 offset:14848
    ds_read_b64 v[30:31], v77 offset:15104
    v_smfmac_f32_16x16x64_bf16 v[20:23], v[56:59], v[200:207], v64
    s_cmp_lg_u32 s37, 0
    v_smfmac_f32_16x16x64_bf16 v[16:19], v[48:51], v[160:167], v64
    s_mov_b64 exec, s[38:39]
    buffer_store_dword v72, v75, s[4:7], s55 offen sc1
    s_mov_b64 exec, -1
    v_smfmac_f32_16x16x64_bf16 v[20:23], v[48:51], v[168:175], v64
    s_cbranch_scc1 cs_rare
cs_rare_x:
    ds_read_b128 v[56:59], v70 offset:22528
    ds_read_b128 v[60:63], v70 offset:23552
    s_cmp_ge_u32 s30, 58
    s_waitcnt lgkmcnt(8)
    v_pk_add_f32 v[4:5], v[4:5], v[8:9]
    v_pk_add_f32 v[6:7], v[6:7], v[10:11]
    s_waitcnt lgkmcnt(6)
    v_pk_add_f32 v[12:13], v[12:13], v[0:1]
    v_pk_add_f32 v[14:15], v[14:15], v[2:3]
    v_pk_add_f32 v[4:5], v[4:5], v[12:13]
    v_pk_add_f32 v[6:7], v[6:7], v[14:15]
    s_waitcnt lgkmcnt(2)
    v_pk_add_f32 v[24:25], v[24:25], v[26:27]
    v_pk_add_f32 v[28:29], v[28:29], v[30:31]
    v_max3_f32 v77, v4, v5, v6
    v_pk_add_f32 v[24:25], v[24:25], v[28:29]
    v_max_f32 v77, v77, v7
    v_max3_f32 v77, v77, v24, v25
    v_cvt_pk_bf16_f32 v38, v16, v17
    v_cvt_pk_bf16_f32 v39, v18, v19
    v_max_f32_dpp v77, v77, v77 row_ror:8 row_mask:0xf bank_mask:0xf
    v_mov_b32 v78, v77
    v_cvt_pk_bf16_f32 v40, v20, v21
    v_cvt_pk_bf16_f32 v41, v22, v23
    v_permlane32_swap_b32 v77, v78
    v_max_f32 v77, v77, v78
    v_mov_b32 v78, v77
    v_mov_b32 v11, 0
    v_mov_b32 v32, v38
    v_permlane16_swap_b32 v77, v78
    v_max_f32 v77, v77, v78
    v_mul_f32 v8, s66, v77
    v_pk_fma_f32 v[4:5], v[4:5], s[44:45], v[8:9] op_sel_hi:[1,1,0]
    v_pk_fma_f32 v[6:7], v[6:7], s[44:45], v[8:9] op_sel_hi:[1,1,0]
    v_pk_fma_f32 v[24:25], v[24:25], s[44:45], v[8:9] op_sel_hi:[1,1,0]
    v_exp_f32 v4, v4
    v_exp_f32 v5, v5
    v_exp_f32 v6, v6
    v_exp_f32 v7, v7
    v_exp_f32 v24, v24
    v_exp_f32 v25, v25
    v_cvt_pk_bf16_f32 v12, v4, v5
    v_cvt_pk_bf16_f32 v13, v6, v7
    v_cvt_pk_bf16_f32 v10, v24, v25
    v_cvt_pk_bf16_f32 v15, v24, v25
    v_mov_b32 v14, 0
    v_mfma_f32_16x16x32_bf16 v[4:7], v[32:35], v[10:13], 0
    s_cbranch_scc1 cs_pubv
cs_pubv_x:
    v_mov_b64 v[0:1], s[48:49]
    v_mov_b64 v[2:3], s[50:51]
    v_mfma_f32_16x16x32_bf16 v[24:27], v[36:39], v[12:15], 0
    ds_read_b128 v[48:51], v70 offset:20480
    v_mov_b32 v47, v41
    v_bitop3_b32 v77, v73, -9, s52 bitop3:0x6a
    v_mfma_f32_16x16x32_bf16 v[28:31], v[0:3], v[10:13], 0
    ds_read_b128 v[52:55], v70 offset:21504
    v_mov_b64 v[0:1], 0
    v_mov_b64 v[2:3], 0
    v_mfma_f32_16x16x32_bf16 v[16:19], v[40:43], v[10:13], 0
    ds_read_b128 v[32:35], v70 offset:24576
    v_bitop3_b32 v78, v73, -9, s53 bitop3:0x6a
    v_bitop3_b32 v79, v73, -9, s54 bitop3:0x6a
    v_mfma_f32_16x16x32_bf16 v[20:23], v[44:47], v[12:15], 0
    ds_read_b128 v[36:39], v70 offset:25600
    v_add_f32_dpp v4, v24, v4 row_ror:8 row_mask:0xf bank_mask:0xf
    v_add_f32_dpp v5, v25, v5 row_ror:8 row_mask:0xf bank_mask:0xf
    v_add_f32_dpp v6, v26, v6 row_ror:8 row_mask:0xf bank_mask:0xf
    v_add_f32_dpp v7, v27, v7 row_ror:8 row_mask:0xf bank_mask:0xf
    v_add_f32_dpp v29, v28, v28 row_ror:8 row_mask:0xf bank_mask:0xf
    v_rcp_f32 v28, v29
    s_nop 0
    v_add_f32_dpp v4, v16, v20 row_ror:8 row_mask:0xf bank_mask:0xc
    v_add_f32_dpp v5, v17, v21 row_ror:8 row_mask:0xf bank_mask:0xc
    v_add_f32_dpp v6, v18, v22 row_ror:8 row_mask:0xf bank_mask:0xc
    v_add_f32_dpp v7, v19, v23 row_ror:8 row_mask:0xf bank_mask:0xc
    v_pk_mul_f32 v[4:5], v[4:5], v[28:29] op_sel_hi:[1,0]
    v_pk_mul_f32 v[6:7], v[6:7], v[28:29] op_sel_hi:[1,0]
    v_cvt_pk_bf16_f32 v4, v4, v5
    v_cvt_pk_bf16_f32 v5, v6, v7
    ds_write_b64 v73, v[4:5] offset:12288
    v_mov_b32_dpp v6, v4 row_ror:8 row_mask:0xf bank_mask:0xf
    v_mov_b32_dpp v7, v5 row_ror:8 row_mask:0xf bank_mask:0xf
    v_mov_b64 v[8:9], 0
    v_mov_b64 v[10:11], 0
    s_waitcnt lgkmcnt(3)
    v_smfmac_f32_16x16x64_bf16 v[0:3], v[4:7], v[48:55], v64
    ds_read_b128 v[40:43], v70 offset:26624
    v_mov_b64 v[12:13], 0
    v_mov_b64 v[14:15], 0
    v_mov_b32 v52, v78
    v_smfmac_f32_16x16x64_bf16 v[8:11], v[4:7], v[80:87], v64
    ds_read_b128 v[44:47], v70 offset:27648
    v_mov_b64 v[24:25], 0
    v_mov_b64 v[26:27], 0
    v_smfmac_f32_16x16x64_bf16 v[12:15], v[4:7], v[112:119], v64
    s_waitcnt lgkmcnt(2)
    v_mov_b32_dpp v52, v79 quad_perm:[0,1,2,3] row_mask:0xf bank_mask:0xc
    v_xor_b32 v48, 1024, v52
    s_barrier
    ds_read_b128 v[16:19], v77 offset:12288
    v_smfmac_f32_16x16x64_bf16 v[24:27], v[4:7], v[56:63], v64
    ds_read_b128 v[20:23], v78 offset:12288
    ds_read_b128 v[28:31], v79 offset:12288
    ds_read_b128 v[52:55], v52 offset:12288
    ds_read_b128 v[48:51], v48 offset:12288
    v_mov_b64 v[4:5], 0
    v_mov_b64 v[6:7], 0
    s_waitcnt lgkmcnt(4)
    v_smfmac_f32_16x16x64_bf16 v[8:11], v[16:19], v[88:95], v64
    ds_read_b128 v[56:59], v70 offset:28672
    v_smfmac_f32_16x16x64_bf16 v[12:15], v[16:19], v[120:127], v64
    ds_read_b128 v[60:63], v70 offset:29696
    s_waitcnt lgkmcnt(5)
    v_smfmac_f32_16x16x64_bf16 v[8:11], v[20:23], v[96:103], v64
    v_bfe_u32 v77, v74, 16, 1
    v_smfmac_f32_16x16x64_bf16 v[12:15], v[20:23], v[128:135], v64
    s_waitcnt lgkmcnt(4)
    v_mad_i32_i24 v77, v77, s56, v74
    v_smfmac_f32_16x16x64_bf16 v[8:11], v[28:31], v[104:111], v64
    s_nop 2
    v_smfmac_f32_16x16x64_bf16 v[12:15], v[28:31], v[136:143], v64
    s_waitcnt lgkmcnt(2)
    s_nop 1
    v_smfmac_f32_16x16x64_bf16 v[4:7], v[48:51], v[144:151], v64
    v_cvt_pk_bf16_f32 v8, v8, v9
    v_cvt_pk_bf16_f32 v9, v10, v11
    v_and_or_b32 v8, v8, -2, s69
    s_nop 0
    v_cvt_pk_bf16_f32 v10, v12, v13
    v_cvt_pk_bf16_f32 v11, v14, v15
    v_smfmac_f32_16x16x64_bf16 v[4:7], v[52:55], v[152:159], v64
    buffer_store_dwordx4 v[8:11], v74, s[4:7], s22 offen sc1
    ds_read_b128 v[48:51], v70 offset:30720
    v_smfmac_f32_16x16x64_bf16 v[0:3], v[16:19], v[32:39], v64
    ds_read_b128 v[52:55], v70 offset:31744
    s_add_u32 s30, s30, 1
    s_waitcnt lgkmcnt(2)
    v_smfmac_f32_16x16x64_bf16 v[24:27], v[16:19], v[40:47], v64
    ds_read_b128 v[32:35], v70 offset:32768
    v_cvt_pk_bf16_f32 v4, v4, v5
    v_cvt_pk_bf16_f32 v5, v6, v7
    v_and_or_b32 v4, v4, -2, s69
    v_smfmac_f32_16x16x64_bf16 v[0:3], v[20:23], v[56:63], v64
    buffer_store_dwordx2 v[4:5], v77, s[4:7], s25 offen sc1
    ds_read_b128 v[36:39], v70 offset:33792
    s_xor_b32 s70, s70, 1
    ds_read_b128 v[40:43], v70 offset:34816
    s_waitcnt lgkmcnt(3)
    v_smfmac_f32_16x16x64_bf16 v[24:27], v[20:23], v[48:55], v64
    ds_read_b128 v[44:47], v70 offset:35840
    s_waitcnt lgkmcnt(2)
    v_smfmac_f32_16x16x64_bf16 v[0:3], v[28:31], v[32:39], v64
    s_cmp_lg_u32 s71, 0
    s_waitcnt lgkmcnt(0)
    s_nop 0
    v_smfmac_f32_16x16x64_bf16 v[24:27], v[28:31], v[40:47], v64
    s_nop 3
    v_cvt_pk_bf16_f32 v0, v0, v1
    v_cvt_pk_bf16_f32 v1, v2, v3
    v_and_or_b32 v0, v0, -2, s69
    s_nop 0
    v_cvt_pk_bf16_f32 v2, v24, v25
    v_cvt_pk_bf16_f32 v3, v26, v27
    buffer_store_dwordx4 v[0:3], v74, s[4:7], s23 offen sc1
    s_cbranch_scc1 cs_e1
    s_nop 0
    s_nop 2
    v_mov_b32 v79, v79
    s_nop 2
    v_mov_b32 v79, v79
    s_nop 2
    v_mov_b32 v79, v79
    s_nop 2
    v_mov_b32 v79, v79
    s_nop 2
    v_mov_b32 v79, v79
    s_nop 2
    v_mov_b32 v79, v79
    s_nop 2
    v_mov_b32 v79, v79
    s_nop 2
    v_mov_b32 v79, v79
    s_nop 2
    v_mov_b32 v79, v79
    s_nop 2
    v_mov_b32 v79, v79
    s_nop 2
    v_mov_b32 v79, v79
    s_nop 2
    v_mov_b32 v79, v79
    s_nop 2
    v_mov_b32 v79, v79
    s_nop 2
    v_mov_b32 v79, v79
    s_nop 2
    v_mov_b32 v79, v79
    s_nop 2
    v_mov_b32 v79, v79
    s_nop 2
    v_mov_b32 v79, v79
    s_nop 2
    v_mov_b32 v79, v79
    s_nop 2
    v_mov_b32 v79, v79
    s_nop 2
    v_mov_b32 v79, v79
    s_nop 2
    v_mov_b32 v79, v79
    s_nop 2
    v_mov_b32 v79, v79
    s_nop 2
    v_mov_b32 v79, v79
    s_nop 2
    v_mov_b32 v79, v79
    s_nop 2
    v_mov_b32 v79, v79
    s_nop 2
    v_mov_b32 v79, v79
    s_nop 2
    v_mov_b32 v79, v79
    s_nop 2
    v_mov_b32 v79, v79
    s_nop 2
    v_mov_b32 v79, v79
    s_nop 2
    v_mov_b32 v79, v79
    s_nop 2
    v_mov_b32 v79, v79
    s_nop 2
    v_mov_b32 v79, v79
    s_nop 2
    v_mov_b32 v79, v79
    s_nop 2
    v_mov_b32 v79, v79
    s_nop 2
    v_mov_b32 v79, v79
    s_nop 2
    v_mov_b32 v79, v79
    s_nop 2
    v_mov_b32 v79, v79
    s_nop 0
    v_mov_b32 v79, v79
    buffer_load_dwordx4 v[8:11], v65, s[4:7], s18 offen sc1
    buffer_load_dwordx4 v[12:15], v65, s[4:7], s19 offen sc1
    buffer_load_dwordx4 v[16:19], v65, s[4:7], s20 offen sc1
    buffer_load_dwordx4 v[20:23], v65, s[4:7], s21 offen sc1
    v_and_b32 v77, 255, v69
    ds_read_b128 v[4:7], v77 offset:15872
    ds_read_b128 v[40:43], v70 offset:0
    ds_read_b128 v[44:47], v70 offset:1024
    ds_read_b128 v[48:51], v70 offset:2048
    ds_read_b128 v[52:55], v70 offset:3072
    ds_read_b128 v[24:27], v70 offset:4096
    ds_read_b128 v[28:31], v70 offset:5120
    ds_read_b128 v[32:35], v70 offset:6144
    ds_read_b128 v[36:39], v70 offset:7168
    s_mov_b32 s31, 65536
    s_add_u32 s24, s24, 524288
    s_add_u32 s26, s26, 524288
    s_add_u32 s55, s55, s57
    s_cmp_lt_u32 s97, s93
    s_cselect_b32 s37, 1, 0
    s_cmp_eq_u32 s30, 63
    s_cselect_b32 s37, 1, s37
    s_mov_b32 s14, 67633152
    s_mov_b32 s15, 67637248
    s_mov_b32 s16, 67641344
    s_mov_b32 s36, 1
    v_mov_b32 v60, s69
    v_mov_b32 v56, s69
    v_and_b32 v79, 12, v75
    v_cmp_eq_u32 vcc, 0, v79
    s_nop 1
    v_cndmask_b32 v79, 0, 1, vcc
    s_waitcnt lgkmcnt(0)
    s_waitcnt vmcnt(3)
    v_xor_b32 v77, s69, v8
    v_mfma_f32_16x16x32_bf16 v[0:3], v[4:7], v[8:11], 0
    s_waitcnt vmcnt(2)
    v_bitop3_b32 v77, v77, v12, s69 bitop3:0xf6
    v_mfma_f32_16x16x32_bf16 v[0:3], v[4:7], v[12:15], v[0:3]
    s_waitcnt vmcnt(1)
    v_bitop3_b32 v77, v77, v16, s69 bitop3:0xf6
    v_mfma_f32_16x16x32_bf16 v[0:3], v[4:7], v[16:19], v[0:3]
    s_waitcnt vmcnt(0)
    v_bitop3_b32 v77, v77, v20, s69 bitop3:0xf6
    v_mfma_f32_16x16x32_bf16 v[0:3], v[4:7], v[20:23], v[0:3]
    v_and_b32 v77, 1, v77
    v_cmp_ne_u32 vcc, 0, v77
    s_nop 0
    s_cmp_eq_u64 vcc, 0
    s_cselect_b64 s[42:43], -1, 0
    s_nop 2
    v_add_f32_dpp v0, v0, v0 row_ror:8 row_mask:0xf bank_mask:0xf
    v_add_f32_dpp v1, v1, v1 row_ror:8 row_mask:0xf bank_mask:0xf
    s_mov_b64 exec, s[42:43]
    v_cvt_pk_bf16_f32 v72, v0, v1
    v_bfi_b32 v72, v79, s70, v72
    buffer_store_dword v72, v75, s[4:7], s17 offen offset:0 sc1
    s_mov_b64 exec, -1
    s_cbranch_scc0 cs_f0_retry
cs_f0_go:
    v_mov_b64 v[0:1], 0
    v_mov_b64 v[2:3], 0
    v_mov_b64 v[4:5], 0
    v_mov_b64 v[6:7], 0
    v_mov_b64 v[8:9], 0
    v_mov_b64 v[10:11], 0
    v_mov_b64 v[12:13], 0
    v_mov_b64 v[14:15], 0
    v_mov_b64 v[16:17], 0
    v_mov_b64 v[18:19], 0
    v_mov_b64 v[20:21], 0
    v_mov_b64 v[22:23], 0
    s_nop 2
    v_mov_b32 v79, v79
    s_nop 2
    v_mov_b32 v79, v79
    s_nop 2
    v_mov_b32 v79, v79
    s_nop 2
    v_mov_b32 v79, v79
    s_nop 2
    v_mov_b32 v79, v79
    s_nop 2
    v_mov_b32 v79, v79
    s_nop 2
    v_mov_b32 v79, v79
    s_nop 2
    v_mov_b32 v79, v79
    s_nop 2
    v_mov_b32 v79, v79
    s_nop 2
    v_mov_b32 v79, v79
    s_nop 2
    v_mov_b32 v79, v79
    s_nop 2
    v_mov_b32 v79, v79
    s_nop 2
    v_mov_b32 v79, v79
    s_nop 2
    v_mov_b32 v79, v79
    s_nop 2
    v_mov_b32 v79, v79
    s_nop 2
    v_mov_b32 v79, v79
    s_nop 2
    v_mov_b32 v79, v79
    s_nop 2
    v_mov_b32 v79, v79
    s_nop 2
    v_mov_b32 v79, v79
    s_nop 2
    v_mov_b32 v79, v79
    s_nop 2
    v_mov_b32 v79, v79
    s_nop 2
    v_mov_b32 v79, v79
    s_nop 2
    v_mov_b32 v79, v79
    s_nop 2
    v_mov_b32 v79, v79
    s_nop 2
    v_mov_b32 v79, v79
    s_branch cs_loop
cs_e1:
    s_cmp_lg_u32 s71, 2
    s_cbranch_scc1 cs_f1
    s_nop 2
    v_mov_b32 v79, v79
    s_nop 2
    v_mov_b32 v79, v79
    s_nop 2
    v_mov_b32 v79, v79
    s_nop 2
    v_mov_b32 v79, v79
    s_nop 2
    v_mov_b32 v79, v79
    s_nop 2
    v_mov_b32 v79, v79
    s_nop 2
    v_mov_b32 v79, v79
    s_nop 2
    v_mov_b32 v79, v79
    s_nop 2
    v_mov_b32 v79, v79
    s_nop 2
    v_mov_b32 v79, v79
    s_nop 2
    v_mov_b32 v79, v79
    s_nop 2
    v_mov_b32 v79, v79
    s_nop 2
    v_mov_b32 v79, v79
    s_nop 2
    v_mov_b32 v79, v79
    s_nop 2
    v_mov_b32 v79, v79
    s_nop 2
    v_mov_b32 v79, v79
    s_nop 2
    v_mov_b32 v79, v79
    s_nop 2
    v_mov_b32 v79, v79
    s_nop 2
    v_mov_b32 v79, v79
    s_nop 2
    v_mov_b32 v79, v79
    s_nop 2
    v_mov_b32 v79, v79
    s_nop 2
    v_mov_b32 v79, v79
    s_nop 2
    v_mov_b32 v79, v79
    s_nop 2
    v_mov_b32 v79, v79
    s_nop 2
    v_mov_b32 v79, v79
    s_nop 2
    v_mov_b32 v79, v79
    s_nop 2
    v_mov_b32 v79, v79
    s_nop 2
    v_mov_b32 v79, v79
    s_nop 2
    v_mov_b32 v79, v79
    s_nop 2
    v_mov_b32 v79, v79
    s_nop 2
    v_mov_b32 v79, v79
    s_nop 2
    v_mov_b32 v79, v79
    s_nop 2
    v_mov_b32 v79, v79
    s_nop 2
    v_mov_b32 v79, v79
    s_nop 2
    v_mov_b32 v79, v79
    s_nop 2
    v_mov_b32 v79, v79
    s_nop 2
    v_mov_b32 v79, v79
    s_nop 0
    v_mov_b32 v79, v79
    buffer_load_dwordx4 v[8:11], v65, s[4:7], s18 offen sc1
    buffer_load_dwordx4 v[12:15], v65, s[4:7], s19 offen sc1
    buffer_load_dwordx4 v[16:19], v65, s[4:7], s20 offen sc1
    buffer_load_dwordx4 v[20:23], v65, s[4:7], s21 offen sc1
    v_and_b32 v77, 255, v69
    ds_read_b128 v[4:7], v77 offset:15872
    ds_read_b128 v[40:43], v70 offset:0
    ds_read_b128 v[44:47], v70 offset:1024
    ds_read_b128 v[48:51], v70 offset:2048
    ds_read_b128 v[52:55], v70 offset:3072
    ds_read_b128 v[24:27], v70 offset:4096
    ds_read_b128 v[28:31], v70 offset:5120
    ds_read_b128 v[32:35], v70 offset:6144
    ds_read_b128 v[36:39], v70 offset:7168
    s_mov_b32 s31, 65536
    s_add_u32 s24, s24, 524288
    s_add_u32 s26, s26, 524288
    s_add_u32 s55, s55, s57
    s_cmp_lt_u32 s97, s93
    s_cselect_b32 s37, 1, 0
    s_cmp_eq_u32 s30, 63
    s_cselect_b32 s37, 1, s37
    s_mov_b32 s14, 67633152
    s_mov_b32 s15, 67637248
    s_mov_b32 s16, 67641344
    s_mov_b32 s36, 1
    v_mov_b32 v60, s69
    v_mov_b32 v56, s69
    v_and_b32 v79, 12, v75
    v_cmp_eq_u32 vcc, 0, v79
    s_nop 1
    v_cndmask_b32 v79, 0, 1, vcc
    s_waitcnt lgkmcnt(0)
    s_waitcnt vmcnt(3)
    v_xor_b32 v77, s69, v8
    v_bitop3_b32 v77, v77, v10, s69 bitop3:0xf6
    v_mfma_f32_16x16x32_bf16 v[0:3], v[4:7], v[8:11], 0
    s_waitcnt vmcnt(2)
    v_bitop3_b32 v77, v77, v12, s69 bitop3:0xf6
    v_bitop3_b32 v77, v77, v14, s69 bitop3:0xf6
    v_mfma_f32_16x16x32_bf16 v[0:3], v[4:7], v[12:15], v[0:3]
    s_waitcnt vmcnt(1)
    v_bitop3_b32 v77, v77, v16, s69 bitop3:0xf6
    v_bitop3_b32 v77, v77, v18, s69 bitop3:0xf6
    v_mfma_f32_16x16x32_bf16 v[0:3], v[4:7], v[16:19], v[0:3]
    s_waitcnt vmcnt(0)
    v_bitop3_b32 v77, v77, v20, s69 bitop3:0xf6
    v_bitop3_b32 v77, v77, v22, s69 bitop3:0xf6
    v_mfma_f32_16x16x32_bf16 v[0:3], v[4:7], v[20:23], v[0:3]
    v_and_b32 v77, 1, v77
    v_cmp_ne_u32 vcc, 0, v77
    s_nop 0
    s_cmp_eq_u64 vcc, 0
    s_cselect_b64 s[42:43], -1, 0
    s_nop 2
    v_add_f32 v2, v0, v1
    s_nop 1
    v_add_f32_dpp v2, v2, v2 row_ror:8 row_mask:0xf bank_mask:0xf
    s_nop 1
    v_mov_b32_dpp v0, v2 quad_perm:[0,0,2,2] row_mask:0xf bank_mask:0xf
    v_mov_b32_dpp v1, v2 quad_perm:[1,1,3,3] row_mask:0xf bank_mask:0xf
    s_mov_b64 exec, s[42:43]
    v_cvt_pk_bf16_f32 v72, v0, v1
    v_bfi_b32 v72, v79, s70, v72
    buffer_store_dword v72, v75, s[4:7], s17 offen offset:0 sc1
    buffer_store_dword v72, v75, s[4:7], s17 offen offset:1024 sc1
    buffer_store_dword v72, v75, s[4:7], s17 offen offset:2048 sc1
    buffer_store_dword v72, v75, s[4:7], s17 offen offset:3072 sc1
    s_mov_b64 exec, -1
    s_cbranch_scc0 cs_f2_retry
cs_f2_go:
    v_mov_b64 v[0:1], 0
    v_mov_b64 v[2:3], 0
    v_mov_b64 v[4:5], 0
    v_mov_b64 v[6:7], 0
    v_mov_b64 v[8:9], 0
    v_mov_b64 v[10:11], 0
    v_mov_b64 v[12:13], 0
    v_mov_b64 v[14:15], 0
    v_mov_b64 v[16:17], 0
    v_mov_b64 v[18:19], 0
    v_mov_b64 v[20:21], 0
    v_mov_b64 v[22:23], 0
    s_nop 2
    v_mov_b32 v79, v79
    s_nop 2
    v_mov_b32 v79, v79
    s_nop 2
    v_mov_b32 v79, v79
    s_nop 2
    v_mov_b32 v79, v79
    s_nop 2
    v_mov_b32 v79, v79
    s_nop 2
    v_mov_b32 v79, v79
    s_nop 2
    v_mov_b32 v79, v79
    s_nop 2
    v_mov_b32 v79, v79
    s_nop 2
    v_mov_b32 v79, v79
    s_nop 2
    v_mov_b32 v79, v79
    s_nop 2
    v_mov_b32 v79, v79
    s_nop 2
    v_mov_b32 v79, v79
    s_nop 2
    v_mov_b32 v79, v79
    s_nop 2
    v_mov_b32 v79, v79
    s_nop 2
    v_mov_b32 v79, v79
    s_nop 2
    v_mov_b32 v79, v79
    s_nop 2
    v_mov_b32 v79, v79
    s_nop 2
    v_mov_b32 v79, v79
    s_nop 2
    v_mov_b32 v79, v79
    s_nop 2
    v_mov_b32 v79, v79
    s_nop 2
    v_mov_b32 v79, v79
    s_nop 2
    v_mov_b32 v79, v79
    s_nop 2
    v_mov_b32 v79, v79
    s_nop 2
    v_mov_b32 v79, v79
    s_nop 2
    v_mov_b32 v79, v79
    s_branch cs_loop
cs_f1:
    s_cmp_lg_u32 s32, 1
    s_cbranch_scc1 cs_f3
    v_and_b32 v77, 255, v69
    ds_read_b128 v[4:7], v77 offset:15872
    ds_read_b128 v[40:43], v70 offset:0
    ds_read_b128 v[44:47], v70 offset:1024
    ds_read_b128 v[48:51], v70 offset:2048
    ds_read_b128 v[52:55], v70 offset:3072
    ds_read_b128 v[24:27], v70 offset:4096
    ds_read_b128 v[28:31], v70 offset:5120
    ds_read_b128 v[32:35], v70 offset:6144
    ds_read_b128 v[36:39], v70 offset:7168
    s_mov_b32 s31, 65536
    s_add_u32 s24, s24, 524288
    s_add_u32 s26, s26, 524288
    s_add_u32 s55, s55, s57
    s_cmp_lt_u32 s97, s93
    s_cselect_b32 s37, 1, 0
    s_cmp_eq_u32 s30, 63
    s_cselect_b32 s37, 1, s37
    s_mov_b32 s14, 67633152
    s_mov_b32 s15, 67637248
    s_mov_b32 s16, 67641344
    s_mov_b32 s36, 1
    v_mov_b32 v60, s69
    v_mov_b32 v56, s69
    v_and_b32 v79, 12, v75
    v_cmp_eq_u32 vcc, 0, v79
    s_nop 1
    v_cndmask_b32 v79, 0, 1, vcc
    s_nop 2
    v_mov_b32 v79, v79
    s_nop 2
    v_mov_b32 v79, v79
    s_nop 2
    v_mov_b32 v79, v79
    s_nop 2
    v_mov_b32 v79, v79
    s_nop 2
    v_mov_b32 v79, v79
    s_nop 2
    v_mov_b32 v79, v79
    s_nop 2
    v_mov_b32 v79, v79
    s_nop 2
    v_mov_b32 v79, v79
    s_nop 2
    v_mov_b32 v79, v79
    s_nop 2
    v_mov_b32 v79, v79
    s_nop 2
    v_mov_b32 v79, v79
    s_nop 2
    v_mov_b32 v79, v79
    s_nop 2
    v_mov_b32 v79, v79
    s_nop 2
    v_mov_b32 v79, v79
    s_nop 2
    v_mov_b32 v79, v79
    s_nop 2
    v_mov_b32 v79, v79
    s_nop 2
    v_mov_b32 v79, v79
    s_nop 2
    v_mov_b32 v79, v79
    s_nop 2
    v_mov_b32 v79, v79
    s_nop 2
    v_mov_b32 v79, v79
    s_nop 2
    v_mov_b32 v79, v79
    s_nop 2
    v_mov_b32 v79, v79
    s_nop 2
    v_mov_b32 v79, v79
    s_nop 2
    v_mov_b32 v79, v79
    s_nop 2
    v_mov_b32 v79, v79
    s_nop 2
    v_mov_b32 v79, v79
    s_nop 2
    v_mov_b32 v79, v79
    s_nop 2
    v_mov_b32 v79, v79
    s_nop 2
    v_mov_b32 v79, v79
    s_nop 2
    v_mov_b32 v79, v79
    s_nop 2
    v_mov_b32 v79, v79
    s_nop 2
    v_mov_b32 v79, v79
    s_nop 2
    v_mov_b32 v79, v79
    s_nop 2
    v_mov_b32 v79, v79
    s_nop 2
    v_mov_b32 v79, v79
    s_nop 2
    v_mov_b32 v79, v79
    s_nop 2
    v_mov_b32 v79, v79
    s_nop 0
    v_mov_b32 v79, v79
    s_waitcnt vmcnt(0)
    buffer_load_dwordx4 v[8:11], v65, s[4:7], s18 offen sc1
    buffer_load_dwordx4 v[12:15], v65, s[4:7], s19 offen sc1
    buffer_load_dwordx4 v[16:19], v65, s[4:7], s20 offen sc1
    buffer_load_dwordx4 v[20:23], v65, s[4:7], s21 offen sc1
    s_nop 2
    v_mov_b32 v79, v79
    s_nop 2
    v_mov_b32 v79, v79
    s_nop 2
    v_mov_b32 v79, v79
    s_nop 2
    v_mov_b32 v79, v79
    s_nop 2
    v_mov_b32 v79, v79
    s_nop 2
    v_mov_b32 v79, v79
    s_nop 2
    v_mov_b32 v79, v79
    s_nop 2
    v_mov_b32 v79, v79
    s_nop 2
    v_mov_b32 v79, v79
    s_nop 2
    v_mov_b32 v79, v79
    s_nop 2
    v_mov_b32 v79, v79
    s_nop 2
    v_mov_b32 v79, v79
    buffer_load_dwordx4 v[60:63], v65, s[4:7], s14 offen offset:0 sc1
    buffer_load_dwordx4 v[56:59], v66, s[4:7], s14 offen offset:0 sc1
    s_waitcnt lgkmcnt(0)
    s_waitcnt vmcnt(5)
    v_xor_b32 v77, s69, v8
    v_mfma_f32_16x16x32_bf16 v[0:3], v[4:7], v[8:11], 0
    s_waitcnt vmcnt(4)
    v_bitop3_b32 v77, v77, v12, s69 bitop3:0xf6
    v_mfma_f32_16x16x32_bf16 v[0:3], v[4:7], v[12:15], v[0:3]
    s_waitcnt vmcnt(3)
    v_bitop3_b32 v77, v77, v16, s69 bitop3:0xf6
    v_mfma_f32_16x16x32_bf16 v[0:3], v[4:7], v[16:19], v[0:3]
    s_waitcnt vmcnt(2)
    v_bitop3_b32 v77, v77, v20, s69 bitop3:0xf6
    v_mfma_f32_16x16x32_bf16 v[0:3], v[4:7], v[20:23], v[0:3]
    v_and_b32 v77, 1, v77
    v_cmp_ne_u32 vcc, 0, v77
    buffer_load_dwordx4 v[60:63], v65, s[4:7], s14 offen offset:0 sc1
    buffer_load_dwordx4 v[56:59], v66, s[4:7], s14 offen offset:0 sc1
    s_cmp_eq_u64 vcc, 0
    s_cselect_b64 s[42:43], -1, 0
    s_nop 1
    v_add_f32_dpp v0, v0, v0 row_ror:8 row_mask:0xf bank_mask:0xf
    v_add_f32_dpp v1, v1, v1 row_ror:8 row_mask:0xf bank_mask:0xf
    s_mov_b64 exec, s[42:43]
    v_cvt_pk_bf16_f32 v72, v0, v1
    v_bfi_b32 v72, v79, s70, v72
    buffer_store_dword v72, v75, s[4:7], s17 offen offset:0 sc1
    s_mov_b64 exec, -1
    s_cbranch_scc0 cs_f1_retry
cs_f1_go:
    v_mov_b64 v[0:1], 0
    v_mov_b64 v[2:3], 0
    v_mov_b64 v[4:5], 0
    v_mov_b64 v[6:7], 0
    v_mov_b64 v[8:9], 0
    v_mov_b64 v[10:11], 0
    v_mov_b64 v[12:13], 0
    v_mov_b64 v[14:15], 0
    v_mov_b64 v[16:17], 0
    v_mov_b64 v[18:19], 0
    v_mov_b64 v[20:21], 0
    v_mov_b64 v[22:23], 0
    s_nop 2
    v_mov_b32 v79, v79
    s_nop 2
    v_mov_b32 v79, v79
    s_nop 2
    v_mov_b32 v79, v79
    s_nop 2
    v_mov_b32 v79, v79
    s_nop 2
    v_mov_b32 v79, v79
    s_nop 2
    v_mov_b32 v79, v79
    s_nop 2
    v_mov_b32 v79, v79
    s_nop 2
    v_mov_b32 v79, v79
    s_nop 2
    v_mov_b32 v79, v79
    s_nop 2
    v_mov_b32 v79, v79
    s_nop 2
    v_mov_b32 v79, v79
    s_nop 2
    v_mov_b32 v79, v79
    s_nop 2
    v_mov_b32 v79, v79
    s_nop 2
    v_mov_b32 v79, v79
    s_nop 2
    v_mov_b32 v79, v79
    s_nop 2
    v_mov_b32 v79, v79
    s_nop 2
    v_mov_b32 v79, v79
    s_nop 2
    v_mov_b32 v79, v79
    s_nop 2
    v_mov_b32 v79, v79
    s_nop 2
    v_mov_b32 v79, v79
    s_nop 2
    v_mov_b32 v79, v79
    s_nop 2
    v_mov_b32 v79, v79
    s_nop 2
    v_mov_b32 v79, v79
    s_nop 2
    v_mov_b32 v79, v79
    s_nop 2
    v_mov_b32 v79, v79
    s_branch cs_loop
cs_f3:
    v_and_b32 v77, 255, v69
    ds_read_b128 v[4:7], v77 offset:15872
    ds_read_b128 v[40:43], v70 offset:0
    ds_read_b128 v[44:47], v70 offset:1024
    ds_read_b128 v[48:51], v70 offset:2048
    ds_read_b128 v[52:55], v70 offset:3072
    ds_read_b128 v[24:27], v70 offset:4096
    ds_read_b128 v[28:31], v70 offset:5120
    ds_read_b128 v[32:35], v70 offset:6144
    ds_read_b128 v[36:39], v70 offset:7168
    s_mov_b32 s31, 65536
    s_add_u32 s24, s24, 524288
    s_add_u32 s26, s26, 524288
    s_add_u32 s55, s55, s57
    s_cmp_lt_u32 s97, s93
    s_cselect_b32 s37, 1, 0
    s_cmp_eq_u32 s30, 63
    s_cselect_b32 s37, 1, s37
    s_mov_b32 s14, 67633152
    s_mov_b32 s15, 67637248
    s_mov_b32 s16, 67641344
    s_mov_b32 s36, 1
    v_mov_b32 v60, s69
    v_mov_b32 v56, s69
    v_and_b32 v79, 12, v75
    v_cmp_eq_u32 vcc, 0, v79
    s_nop 1
    v_cndmask_b32 v79, 0, 1, vcc
    v_add_u32 v72, 1, v72
    s_waitcnt lgkmcnt(0)
    v_mov_b64 v[0:1], 0
    v_mov_b64 v[2:3], 0
    v_mov_b64 v[4:5], 0
    v_mov_b64 v[6:7], 0
    v_mov_b64 v[8:9], 0
    v_mov_b64 v[10:11], 0
    v_mov_b64 v[12:13], 0
    v_mov_b64 v[14:15], 0
    v_mov_b64 v[16:17], 0
    v_mov_b64 v[18:19], 0
    v_mov_b64 v[20:21], 0
    v_mov_b64 v[22:23], 0
    s_nop 2
    v_mov_b32 v79, v79
    s_nop 2
    v_mov_b32 v79, v79
    s_nop 2
    v_mov_b32 v79, v79
    s_nop 2
    v_mov_b32 v79, v79
    s_nop 2
    v_mov_b32 v79, v79
    s_nop 2
    v_mov_b32 v79, v79
    s_nop 2
    v_mov_b32 v79, v79
    s_nop 2
    v_mov_b32 v79, v79
    s_nop 2
    v_mov_b32 v79, v79
    s_nop 2
    v_mov_b32 v79, v79
    s_nop 2
    v_mov_b32 v79, v79
    s_nop 2
    v_mov_b32 v79, v79
    s_nop 2
    v_mov_b32 v79, v79
    s_nop 2
    v_mov_b32 v79, v79
    s_nop 2
    v_mov_b32 v79, v79
    s_nop 2
    v_mov_b32 v79, v79
    s_nop 2
    v_mov_b32 v79, v79
    s_nop 2
    v_mov_b32 v79, v79
    s_nop 2
    v_mov_b32 v79, v79
    s_nop 2
    v_mov_b32 v79, v79
    s_nop 2
    v_mov_b32 v79, v79
    s_nop 2
    v_mov_b32 v79, v79
    s_nop 2
    v_mov_b32 v79, v79
    s_nop 2
    v_mov_b32 v79, v79
    s_nop 2
    v_mov_b32 v79, v79
    s_nop 2
    v_mov_b32 v79, v79
    s_nop 2
    v_mov_b32 v79, v79
    s_nop 2
    v_mov_b32 v79, v79
    s_nop 2
    v_mov_b32 v79, v79
    s_nop 2
    v_mov_b32 v79, v79
    s_nop 2
    v_mov_b32 v79, v79
    s_nop 2
    v_mov_b32 v79, v79
    s_nop 2
    v_mov_b32 v79, v79
    s_nop 2
    v_mov_b32 v79, v79
    s_nop 2
    v_mov_b32 v79, v79
    s_nop 2
    v_mov_b32 v79, v79
    s_nop 2
    v_mov_b32 v79, v79
    s_nop 2
    v_mov_b32 v79, v79
    s_nop 2
    v_mov_b32 v79, v79
    s_nop 2
    v_mov_b32 v79, v79
    s_nop 2
    v_mov_b32 v79, v79
    s_nop 2
    v_mov_b32 v79, v79
    s_nop 2
    v_mov_b32 v79, v79
    s_nop 2
    v_mov_b32 v79, v79
    s_nop 2
    v_mov_b32 v79, v79
    s_nop 2
    v_mov_b32 v79, v79
    s_nop 2
    v_mov_b32 v79, v79
    s_nop 2
    v_mov_b32 v79, v79
    s_nop 2
    v_mov_b32 v79, v79
    s_nop 2
    v_mov_b32 v79, v79
    s_nop 2
    v_mov_b32 v79, v79
    s_nop 2
    v_mov_b32 v79, v79
    s_nop 2
    v_mov_b32 v79, v79
    s_nop 2
    v_mov_b32 v79, v79
    s_nop 2
    v_mov_b32 v79, v79
    s_nop 2
    v_mov_b32 v79, v79
    s_nop 2
    v_mov_b32 v79, v79
    s_nop 2
    v_mov_b32 v79, v79
    s_nop 2
    v_mov_b32 v79, v79
    s_nop 2
    v_mov_b32 v79, v79
    s_nop 2
    v_mov_b32 v79, v79
    s_nop 2
    v_mov_b32 v79, v79
    s_nop 2
    v_mov_b32 v79, v79
    s_nop 2
    v_mov_b32 v79, v79
    s_nop 2
    v_mov_b32 v79, v79
    s_nop 2
    v_mov_b32 v79, v79
    s_nop 2
    v_mov_b32 v79, v79
    s_nop 2
    v_mov_b32 v79, v79
    s_nop 2
    v_mov_b32 v79, v79
    s_nop 2
    v_mov_b32 v79, v79
    s_nop 2
    v_mov_b32 v79, v79
    s_nop 2
    v_mov_b32 v79, v79
    s_nop 2
    v_mov_b32 v79, v79
    s_nop 2
    v_mov_b32 v79, v79
    s_nop 2
    v_mov_b32 v79, v79
    s_waitcnt vmcnt(0)
    s_branch cs_loop
cs_f0_retry:
cs_f0_spin:
    buffer_load_dwordx4 v[8:11], v65, s[4:7], s18 offen sc1
    buffer_load_dwordx4 v[12:15], v65, s[4:7], s19 offen sc1
    buffer_load_dwordx4 v[16:19], v65, s[4:7], s20 offen sc1
    buffer_load_dwordx4 v[20:23], v65, s[4:7], s21 offen sc1
    s_nop 2
    v_mov_b32 v79, v79
    s_nop 2
    v_mov_b32 v79, v79
    s_nop 2
    v_mov_b32 v79, v79
    s_nop 2
    v_mov_b32 v79, v79
    s_nop 2
    v_mov_b32 v79, v79
    s_nop 2
    v_mov_b32 v79, v79
    buffer_load_dwordx4 v[60:63], v65, s[4:7], s14 offen offset:0 sc1
    buffer_load_dwordx4 v[56:59], v66, s[4:7], s14 offen offset:0 sc1
    s_waitcnt vmcnt(5)
    v_xor_b32 v77, s69, v8
    v_mfma_f32_16x16x32_bf16 v[0:3], v[4:7], v[8:11], 0
    s_waitcnt vmcnt(4)
    v_bitop3_b32 v77, v77, v12, s69 bitop3:0xf6
    v_mfma_f32_16x16x32_bf16 v[0:3], v[4:7], v[12:15], v[0:3]
    s_waitcnt vmcnt(3)
    v_bitop3_b32 v77, v77, v16, s69 bitop3:0xf6
    v_mfma_f32_16x16x32_bf16 v[0:3], v[4:7], v[16:19], v[0:3]
    s_waitcnt vmcnt(2)
    v_bitop3_b32 v77, v77, v20, s69 bitop3:0xf6
    v_mfma_f32_16x16x32_bf16 v[0:3], v[4:7], v[20:23], v[0:3]
    v_and_b32 v77, 1, v77
    v_cmp_ne_u32 vcc, 0, v77
    buffer_load_dwordx4 v[60:63], v65, s[4:7], s14 offen offset:0 sc1
    buffer_load_dwordx4 v[56:59], v66, s[4:7], s14 offen offset:0 sc1
    s_cmp_eq_u64 vcc, 0
    s_cselect_b64 s[42:43], -1, 0
    s_nop 1
    v_add_f32_dpp v0, v0, v0 row_ror:8 row_mask:0xf bank_mask:0xf
    v_add_f32_dpp v1, v1, v1 row_ror:8 row_mask:0xf bank_mask:0xf
    s_mov_b64 exec, s[42:43]
    v_cvt_pk_bf16_f32 v72, v0, v1
    v_bfi_b32 v72, v79, s70, v72
    buffer_store_dword v72, v75, s[4:7], s17 offen offset:0 sc1
    s_mov_b64 exec, -1
    s_cbranch_scc1 cs_f0_rx
    s_sub_u32 s31, s31, 1
    s_cbranch_scc0 cs_f0_spin
cs_f0_rx:
    v_mov_b64 v[0:1], 0
    v_mov_b64 v[2:3], 0
    v_mov_b64 v[4:5], 0
    v_mov_b64 v[6:7], 0
    v_mov_b64 v[8:9], 0
    v_mov_b64 v[10:11], 0
    v_mov_b64 v[12:13], 0
    v_mov_b64 v[14:15], 0
    v_mov_b64 v[16:17], 0
    v_mov_b64 v[18:19], 0
    v_mov_b64 v[20:21], 0
    v_mov_b64 v[22:23], 0
    s_branch cs_loop
cs_f1_retry:
cs_f1_spin:
    s_nop 0
    buffer_load_dwordx4 v[8:11], v65, s[4:7], s18 offen sc1
    buffer_load_dwordx4 v[12:15], v65, s[4:7], s19 offen sc1
    buffer_load_dwordx4 v[16:19], v65, s[4:7], s20 offen sc1
    buffer_load_dwordx4 v[20:23], v65, s[4:7], s21 offen sc1
    s_nop 2
    v_mov_b32 v79, v79
    s_nop 2
    v_mov_b32 v79, v79
    s_nop 2
    v_mov_b32 v79, v79
    s_nop 2
    v_mov_b32 v79, v79
    s_nop 2
    v_mov_b32 v79, v79
    s_nop 2
    v_mov_b32 v79, v79
    buffer_load_dwordx4 v[60:63], v65, s[4:7], s14 offen offset:0 sc1
    buffer_load_dwordx4 v[56:59], v66, s[4:7], s14 offen offset:0 sc1
    s_waitcnt vmcnt(5)
    v_xor_b32 v77, s69, v8
    v_mfma_f32_16x16x32_bf16 v[0:3], v[4:7], v[8:11], 0
    s_waitcnt vmcnt(4)
    v_bitop3_b32 v77, v77, v12, s69 bitop3:0xf6
    v_mfma_f32_16x16x32_bf16 v[0:3], v[4:7], v[12:15], v[0:3]
    s_waitcnt vmcnt(3)
    v_bitop3_b32 v77, v77, v16, s69 bitop3:0xf6
    v_mfma_f32_16x16x32_bf16 v[0:3], v[4:7], v[16:19], v[0:3]
    s_waitcnt vmcnt(2)
    v_bitop3_b32 v77, v77, v20, s69 bitop3:0xf6
    v_mfma_f32_16x16x32_bf16 v[0:3], v[4:7], v[20:23], v[0:3]
    v_and_b32 v77, 1, v77
    v_cmp_ne_u32 vcc, 0, v77
    buffer_load_dwordx4 v[60:63], v65, s[4:7], s14 offen offset:0 sc1
    buffer_load_dwordx4 v[56:59], v66, s[4:7], s14 offen offset:0 sc1
    s_cmp_eq_u64 vcc, 0
    s_cselect_b64 s[42:43], -1, 0
    s_nop 1
    v_add_f32_dpp v0, v0, v0 row_ror:8 row_mask:0xf bank_mask:0xf
    v_add_f32_dpp v1, v1, v1 row_ror:8 row_mask:0xf bank_mask:0xf
    s_mov_b64 exec, s[42:43]
    v_cvt_pk_bf16_f32 v72, v0, v1
    v_bfi_b32 v72, v79, s70, v72
    buffer_store_dword v72, v75, s[4:7], s17 offen offset:0 sc1
    s_mov_b64 exec, -1
    s_cbranch_scc1 cs_f1_rx
    s_sub_u32 s31, s31, 1
    s_cbranch_scc0 cs_f1_spin
cs_f1_rx:
    v_mov_b64 v[0:1], 0
    v_mov_b64 v[2:3], 0
    v_mov_b64 v[4:5], 0
    v_mov_b64 v[6:7], 0
    v_mov_b64 v[8:9], 0
    v_mov_b64 v[10:11], 0
    v_mov_b64 v[12:13], 0
    v_mov_b64 v[14:15], 0
    v_mov_b64 v[16:17], 0
    v_mov_b64 v[18:19], 0
    v_mov_b64 v[20:21], 0
    v_mov_b64 v[22:23], 0
    s_branch cs_loop
cs_f2_retry:
cs_f2_spin:
    s_nop 0
    buffer_load_dwordx4 v[8:11], v65, s[4:7], s18 offen sc1
    buffer_load_dwordx4 v[12:15], v65, s[4:7], s19 offen sc1
    buffer_load_dwordx4 v[16:19], v65, s[4:7], s20 offen sc1
    buffer_load_dwordx4 v[20:23], v65, s[4:7], s21 offen sc1
    s_nop 2
    v_mov_b32 v79, v79
    s_nop 2
    v_mov_b32 v79, v79
    s_nop 2
    v_mov_b32 v79, v79
    s_nop 2
    v_mov_b32 v79, v79
    s_nop 2
    v_mov_b32 v79, v79
    s_nop 2
    v_mov_b32 v79, v79
    buffer_load_dwordx4 v[60:63], v65, s[4:7], s14 offen offset:0 sc1
    buffer_load_dwordx4 v[56:59], v66, s[4:7], s14 offen offset:0 sc1
    s_waitcnt vmcnt(5)
    v_xor_b32 v77, s69, v8
    v_bitop3_b32 v77, v77, v10, s69 bitop3:0xf6
    v_mfma_f32_16x16x32_bf16 v[0:3], v[4:7], v[8:11], 0
    s_waitcnt vmcnt(4)
    v_bitop3_b32 v77, v77, v12, s69 bitop3:0xf6
    v_bitop3_b32 v77, v77, v14, s69 bitop3:0xf6
    v_mfma_f32_16x16x32_bf16 v[0:3], v[4:7], v[12:15], v[0:3]
    s_waitcnt vmcnt(3)
    v_bitop3_b32 v77, v77, v16, s69 bitop3:0xf6
    v_bitop3_b32 v77, v77, v18, s69 bitop3:0xf6
    v_mfma_f32_16x16x32_bf16 v[0:3], v[4:7], v[16:19], v[0:3]
    s_waitcnt vmcnt(2)
    v_bitop3_b32 v77, v77, v20, s69 bitop3:0xf6
    v_bitop3_b32 v77, v77, v22, s69 bitop3:0xf6
    v_mfma_f32_16x16x32_bf16 v[0:3], v[4:7], v[20:23], v[0:3]
    v_and_b32 v77, 1, v77
    v_cmp_ne_u32 vcc, 0, v77
    buffer_load_dwordx4 v[60:63], v65, s[4:7], s14 offen offset:0 sc1
    buffer_load_dwordx4 v[56:59], v66, s[4:7], s14 offen offset:0 sc1
    s_cmp_eq_u64 vcc, 0
    s_cselect_b64 s[42:43], -1, 0
    s_nop 1
    v_add_f32 v2, v0, v1
    s_nop 1
    v_add_f32_dpp v2, v2, v2 row_ror:8 row_mask:0xf bank_mask:0xf
    s_nop 1
    v_mov_b32_dpp v0, v2 quad_perm:[0,0,2,2] row_mask:0xf bank_mask:0xf
    v_mov_b32_dpp v1, v2 quad_perm:[1,1,3,3] row_mask:0xf bank_mask:0xf
    s_mov_b64 exec, s[42:43]
    v_cvt_pk_bf16_f32 v72, v0, v1
    v_bfi_b32 v72, v79, s70, v72
    buffer_store_dword v72, v75, s[4:7], s17 offen offset:0 sc1
    buffer_store_dword v72, v75, s[4:7], s17 offen offset:1024 sc1
    buffer_store_dword v72, v75, s[4:7], s17 offen offset:2048 sc1
    buffer_store_dword v72, v75, s[4:7], s17 offen offset:3072 sc1
    s_mov_b64 exec, -1
    s_cbranch_scc1 cs_f2_rx
    s_sub_u32 s31, s31, 1
    s_cbranch_scc0 cs_f2_spin
cs_f2_rx:
    v_mov_b64 v[0:1], 0
    v_mov_b64 v[2:3], 0
    v_mov_b64 v[4:5], 0
    v_mov_b64 v[6:7], 0
    v_mov_b64 v[8:9], 0
    v_mov_b64 v[10:11], 0
    v_mov_b64 v[12:13], 0
    v_mov_b64 v[14:15], 0
    v_mov_b64 v[16:17], 0
    v_mov_b64 v[18:19], 0
    v_mov_b64 v[20:21], 0
    v_mov_b64 v[22:23], 0
    s_branch cs_loop
cs_spinB:
    buffer_load_dwordx4 v[40:43], v65, s[4:7], s15 offen sc1
cs_spinB_l:
    v_and_b32 v77, s36, v40
    v_cmp_ne_u32 vcc, s70, v77
    s_cbranch_vccz cs_spinB_x
    s_nop 15
    s_nop 15
    s_nop 15
    s_nop 11
    v_and_b32 v77, s36, v40
    v_cmp_ne_u32 vcc, s70, v77
    s_cbranch_vccz cs_spinB_x
    s_nop 15
    s_nop 15
    s_nop 15
    s_nop 11
    v_and_b32 v77, s36, v40
    v_cmp_ne_u32 vcc, s70, v77
    s_cbranch_vccz cs_spinB_x
    s_nop 15
    s_nop 15
    s_nop 15
    s_nop 11
    buffer_load_dwordx4 v[40:43], v65, s[4:7], s15 offen sc1
    s_sub_u32 s31, s31, 16
    s_cbranch_scc0 cs_spinB_l
cs_spinB_x:
    ds_write_b128 v65, v[40:43] offset:4096
    s_waitcnt lgkmcnt(0)
    s_branch cs_backB
cs_spin8:
    buffer_load_dwordx4 v[60:63], v65, s[4:7], s16 offen sc1
cs_spin8_l:
    v_and_b32 v77, s36, v60
    v_cmp_ne_u32 vcc, s70, v77
    s_cbranch_vccz cs_spin8_x
    s_nop 15
    s_nop 15
    s_nop 15
    s_nop 11
    v_and_b32 v77, s36, v60
    v_cmp_ne_u32 vcc, s70, v77
    s_cbranch_vccz cs_spin8_x
    s_nop 15
    s_nop 15
    s_nop 15
    s_nop 11
    v_and_b32 v77, s36, v60
    v_cmp_ne_u32 vcc, s70, v77
    s_cbranch_vccz cs_spin8_x
    s_nop 15
    s_nop 15
    s_nop 15
    s_nop 11
    buffer_load_dwordx4 v[60:63], v65, s[4:7], s16 offen sc1
    s_sub_u32 s31, s31, 16
    s_cbranch_scc0 cs_spin8_l
cs_spin8_x:
    s_branch cs_back8
cs_pubk:
    s_mov_b64 exec, s[34:35]
    buffer_store_dwordx4 v[0:3], v65, s[4:7], s28 offen sc1
    s_mov_b64 exec, -1
    s_add_u32 s28, s28, 131072
    s_branch cs_pubk_x
cs_pubv:
    buffer_store_dwordx4 v[38:41], v65, s[4:7], s27 offen sc1
    s_add_u32 s27, s27, 131072
    s_branch cs_pubv_x
cs_rare:
    s_cmp_eq_u32 s30, 63
    s_cbranch_scc1 cs_last
    v_bfe_u32 v78, v65, 2, 8
    s_mov_b64 exec, 0xffff
    buffer_load_dword v78, s[4:7], s96 offen sc1 lds
    s_mov_b64 exec, -1
    s_branch cs_rare_x
cs_kvwait:
    v_bfe_u32 v78, v65, 2, 5
    ds_read_b32 v77, v78 offset:16144
    s_waitcnt lgkmcnt(0)
    v_subrev_u32 v77, s95, v77
    v_cmp_lt_u32 vcc, 16, v77
    s_nop 1
    v_cndmask_b32 v77, v77, 0, vcc
    v_bfe_u32 v79, v78, 2, 2
    v_lshl_add_u32 v77, v77, 2, v79
    s_nop 1
    v_min_u32_dpp v77, v77, v77 row_ror:1 row_mask:0xf bank_mask:0xf
    s_nop 1
    v_min_u32_dpp v77, v77, v77 row_ror:2 row_mask:0xf bank_mask:0xf
    s_nop 1
    v_min_u32_dpp v77, v77, v77 row_ror:4 row_mask:0xf bank_mask:0xf
    s_nop 0
    v_readfirstlane_b32 s97, v77
    s_nop 0
    s_cmp_le_u32 s40, s97
    s_cbranch_scc1 cs_kvw_x
    v_bfe_u32 v78, v65, 2, 5
    s_mov_b32 s31, 4194304
cs_kvw:
    buffer_load_dword v77, v78, s[4:7], s96 offen offset:16 sc1
    s_waitcnt vmcnt(0)
    v_subrev_u32 v77, s95, v77
    v_cmp_lt_u32 vcc, 16, v77
    s_nop 1
    v_cndmask_b32 v77, v77, 0, vcc
    v_bfe_u32 v79, v78, 2, 2
    v_lshl_add_u32 v77, v77, 2, v79
    s_nop 1
    v_min_u32_dpp v77, v77, v77 row_ror:1 row_mask:0xf bank_mask:0xf
    s_nop 1
    v_min_u32_dpp v77, v77, v77 row_ror:2 row_mask:0xf bank_mask:0xf
    s_nop 1
    v_min_u32_dpp v77, v77, v77 row_ror:4 row_mask:0xf bank_mask:0xf
    s_nop 0
    v_readfirstlane_b32 s97, v77
    s_sub_u32 s31, s31, 1
    s_cbranch_scc1 cs_kvw_x
    s_cmp_le_u32 s40, s97
    s_cbranch_scc1 cs_kvw_x
    s_sleep 2
    s_branch cs_kvw
cs_kvw_x:
    s_branch cs_kvok
cs_last:
    s_nop 7
    v_cvt_pk_bf16_f32 v38, v16, v17
    v_cvt_pk_bf16_f32 v39, v18, v19
    v_cvt_pk_bf16_f32 v40, v20, v21
    v_cvt_pk_bf16_f32 v41, v22, v23
    buffer_store_dwordx4 v[38:41], v65, s[4:7], s27 offen sc1
    s_add_u32 s40, s95, 64
    v_mov_b32 v78, s40
    s_waitcnt vmcnt(0)
    s_barrier
    s_mov_b64 exec, s[100:101]
    buffer_store_dword v78, off, s[4:7], s29 sc1
    s_mov_b64 exec, -1
cs_end:
    s_endpgm
L_xform:
    v_and_b32 v1, 63, v0
    v_and_b32 v2, 15, v1
    v_lshrrev_b32 v3, 4, v1
    v_mov_b32 v7, 0x05040100
    v_mov_b32 v8, 0x07060302
    v_lshrrev_b32 v9, 6, v0
    v_lshlrev_b32 v9, 14, v9
    v_lshlrev_b32 v10, 4, v1
    v_add_u32 v11, v9, v10
    s_mov_b32 s10, 4718592
    s_mov_b32 s11, 0x20000
    s_mov_b64 s[8:9], s[58:59]
xf_f:
    s_sub_u32 s17, s16, 1504
    s_and_b32 s18, s17, 127
    s_lshr_b32 s17, s17, 7
    s_lshl_b32 s19, s17, 4
    v_add_u32 v6, s19, v2
    v_mul_u32_u24 v4, 9216, v3
    v_lshl_add_u32 v4, v6, 4, v4
    v_lshrrev_b32 v5, 2, v2
    v_lshlrev_b32 v5, 11, v5
    v_lshl_add_u32 v5, v3, 8, v5
    v_and_b32 v1, 3, v6
    v_lshl_add_u32 v5, v1, 6, v5
    v_add_u32 v5, v5, v9
    v_cmp_gt_u32 vcc, 72, v6
    s_nop 0
    s_mov_b64 exec, vcc
    s_mul_i32 s20, s18, 36864
    s_add_u32 s21, s20, 0
    buffer_load_dwordx4 v[12:15], v4, s[8:11], s21 offen
    s_add_u32 s21, s20, 1152
    buffer_load_dwordx4 v[16:19], v4, s[8:11], s21 offen
    s_add_u32 s21, s20, 2304
    buffer_load_dwordx4 v[20:23], v4, s[8:11], s21 offen
    s_add_u32 s21, s20, 3456
    buffer_load_dwordx4 v[24:27], v4, s[8:11], s21 offen
    s_add_u32 s21, s20, 4608
    buffer_load_dwordx4 v[28:31], v4, s[8:11], s21 offen
    s_add_u32 s21, s20, 5760
    buffer_load_dwordx4 v[32:35], v4, s[8:11], s21 offen
    s_add_u32 s21, s20, 6912
    buffer_load_dwordx4 v[36:39], v4, s[8:11], s21 offen
    s_add_u32 s21, s20, 8064
    buffer_load_dwordx4 v[40:43], v4, s[8:11], s21 offen
    s_lshl_b32 s20, s18, 11
    s_add_u32 s20, s20, 130023424
    s_waitcnt vmcnt(0)
    v_perm_b32 v76, v16, v12, v7
    v_perm_b32 v77, v24, v20, v7
    v_perm_b32 v78, v32, v28, v7
    v_perm_b32 v79, v40, v36, v7
    ds_write_b128 v5, v[76:79] offset:0
    v_perm_b32 v80, v17, v13, v7
    v_perm_b32 v81, v25, v21, v7
    v_perm_b32 v82, v33, v29, v7
    v_perm_b32 v83, v41, v37, v7
    ds_write_b128 v5, v[80:83] offset:16
    v_perm_b32 v84, v18, v14, v7
    v_perm_b32 v85, v26, v22, v7
    v_perm_b32 v86, v34, v30, v7
    v_perm_b32 v87, v42, v38, v7
    ds_write_b128 v5, v[84:87] offset:32
    v_perm_b32 v88, v19, v15, v7
    v_perm_b32 v89, v27, v23, v7
    v_perm_b32 v90, v35, v31, v7
    v_perm_b32 v91, v43, v39, v7
    ds_write_b128 v5, v[88:91] offset:48
    v_perm_b32 v92, v16, v12, v8
    v_perm_b32 v93, v24, v20, v8
    v_perm_b32 v94, v32, v28, v8
    v_perm_b32 v95, v40, v36, v8
    ds_write_b128 v5, v[92:95] offset:1024
    v_perm_b32 v96, v17, v13, v8
    v_perm_b32 v97, v25, v21, v8
    v_perm_b32 v98, v33, v29, v8
    v_perm_b32 v99, v41, v37, v8
    ds_write_b128 v5, v[96:99] offset:1040
    v_perm_b32 v100, v18, v14, v8
    v_perm_b32 v101, v26, v22, v8
    v_perm_b32 v102, v34, v30, v8
    v_perm_b32 v103, v42, v38, v8
    ds_write_b128 v5, v[100:103] offset:1056
    v_perm_b32 v104, v19, v15, v8
    v_perm_b32 v105, v27, v23, v8
    v_perm_b32 v106, v35, v31, v8
    v_perm_b32 v107, v43, v39, v8
    ds_write_b128 v5, v[104:107] offset:1072
    s_mov_b64 exec, -1
    s_lshl_b32 s21, s17, 20
    s_add_u32 s20, s20, s21
    s_waitcnt lgkmcnt(0)
    ds_read_b128 v[76:79], v11 offset:0
    ds_read_b128 v[80:83], v11 offset:1024
    ds_read_b128 v[84:87], v11 offset:2048
    ds_read_b128 v[88:91], v11 offset:3072
    ds_read_b128 v[92:95], v11 offset:4096
    ds_read_b128 v[96:99], v11 offset:5120
    ds_read_b128 v[100:103], v11 offset:6144
    ds_read_b128 v[104:107], v11 offset:7168
    s_add_u32 s19, s20, 0
    s_waitcnt lgkmcnt(7)
    buffer_store_dwordx4 v[76:79], v10, s[4:7], s19 offen sc1
    s_add_u32 s19, s20, 1024
    s_waitcnt lgkmcnt(6)
    buffer_store_dwordx4 v[80:83], v10, s[4:7], s19 offen sc1
    s_add_u32 s19, s20, 262144
    s_waitcnt lgkmcnt(5)
    buffer_store_dwordx4 v[84:87], v10, s[4:7], s19 offen sc1
    s_add_u32 s19, s20, 263168
    s_waitcnt lgkmcnt(4)
    buffer_store_dwordx4 v[88:91], v10, s[4:7], s19 offen sc1
    s_add_u32 s19, s20, 524288
    s_waitcnt lgkmcnt(3)
    buffer_store_dwordx4 v[92:95], v10, s[4:7], s19 offen sc1
    s_add_u32 s19, s20, 525312
    s_waitcnt lgkmcnt(2)
    buffer_store_dwordx4 v[96:99], v10, s[4:7], s19 offen sc1
    s_add_u32 s19, s20, 786432
    s_waitcnt lgkmcnt(1)
    buffer_store_dwordx4 v[100:103], v10, s[4:7], s19 offen sc1
    s_add_u32 s19, s20, 787456
    s_waitcnt lgkmcnt(0)
    buffer_store_dwordx4 v[104:107], v10, s[4:7], s19 offen sc1
xf_done:
    s_nop 1
    s_setpc_b64 s[46:47]
L_helper:
    s_load_dwordx16 s[64:79], s[0:1], 64
    s_waitcnt lgkmcnt(0)
L_qkv_next:
    s_mov_b32 s37, 4
    v_mov_b32 v250, 1
    v_mov_b32 v251, 163832
    v_cmp_eq_u32 vcc, 0, v0
    s_nop 0
    s_and_saveexec_b64 s[38:39], vcc
    s_cbranch_execz tk3
    buffer_atomic_add v250, off, s[84:87], s37 sc0
    s_waitcnt vmcnt(0)
    ds_write_b32 v251, v250
    s_waitcnt lgkmcnt(0)
tk3:
    s_mov_b64 exec, -1
    s_barrier
    ds_read_b32 v252, v251
    s_waitcnt lgkmcnt(0)
    v_readfirstlane_b32 s36, v252
    s_barrier
    s_nop 3
    s_or_b32 s37, s36, s32
    s_cbranch_scc1 L_non
    s_memrealtime s[90:91]
    s_waitcnt lgkmcnt(0)
    s_lshl_b32 s90, s90, 8
    s_or_b32 s90, s90, 1
    v_mov_b32 v250, s90
    s_mov_b64 exec, 1
    buffer_store_dword v250, off, s[84:87], 0 offset:216 sc1
    s_mov_b64 exec, -1
L_non:
    s_cmp_lt_u32 s36, 192
    s_cbranch_scc1 L_qkv
    s_mov_b32 s88, 4194304
gn4:
    buffer_load_dword v250, off, s[84:87], 0 offset:216 sc1
    s_waitcnt vmcnt(0)
    v_readfirstlane_b32 s95, v250
    s_sub_u32 s88, s88, 1
    s_cbranch_scc1 gn4x
    s_cmp_eq_u32 s95, 0
    s_cbranch_scc1 gn4
gn4x:
    s_cmp_lg_u32 s36, 192
    s_cbranch_scc1 L_ssm_next
    s_cmp_lg_u32 s32, 0
    s_cbranch_scc1 L_exit
    v_and_b32 v3, 31, v0
    v_lshlrev_b32 v3, 7, v3
    s_mov_b32 s17, 0
    s_mov_b32 s23, 125845504
    s_mov_b32 s24, 125853696
    s_mov_b32 s21, 16777216
rl_rwait:
    buffer_load_dword v4, v3, s[4:7], s23 offen sc1
    s_waitcnt vmcnt(0)
    v_subrev_u32 v4, s95, v4
    v_cmp_lt_u32 vcc, 64, v4
    s_nop 1
    v_cndmask_b32 v4, v4, 0, vcc
    s_nop 1
    v_min_u32_dpp v4, v4, v4 row_ror:1 row_mask:0xf bank_mask:0xf
    s_nop 1
    v_min_u32_dpp v4, v4, v4 row_ror:2 row_mask:0xf bank_mask:0xf
    s_nop 1
    v_min_u32_dpp v4, v4, v4 row_ror:4 row_mask:0xf bank_mask:0xf
    s_nop 1
    v_min_u32_dpp v4, v4, v4 row_ror:8 row_mask:0xf bank_mask:0xf
    s_nop 0
    v_readlane_b32 s16, v4, 0
    v_readlane_b32 s22, v4, 16
    s_nop 0
    s_min_u32 s16, s16, s22
    s_sub_u32 s21, s21, 1
    s_cbranch_scc1 rl_x
    s_cmp_gt_u32 s16, s17
    s_cbranch_scc1 rl_rpub
    s_sleep 2
    s_branch rl_rwait
rl_rpub:
    s_mov_b32 s17, s16
    s_add_u32 s22, s16, s95
    v_mov_b32 v4, s22
    s_mov_b64 exec, 1
    buffer_store_dword v4, off, s[4:7], s24 sc1
    s_mov_b64 exec, -1
    s_cmp_lt_u32 s16, 64
    s_cbranch_scc1 rl_rwait
rl_x:
    s_endpgm
L_qkv:
    s_and_b32 s17, s36, 15
    s_lshl_b32 s17, s17, 1
    s_lshr_b32 s36, s36, 4
    s_and_b32 s16, s36, 1
    s_add_u32 s16, s16, 1
    s_lshr_b32 s19, s36, 1
    s_and_b32 s37, s36, 3
    s_cmp_ge_u32 s36, 8
    s_cselect_b32 s16, 0, s16
    s_cselect_b32 s19, s37, s19
    v_lshrrev_b32 v4, 6, v0
    s_nop 0
    v_readfirstlane_b32 s18, v4
    v_lshlrev_b32 v7, 4, v0
    s_cmp_eq_u32 s16, 1
    s_cselect_b64 s[12:13], s[54:55], s[52:53]
    s_cmp_eq_u32 s16, 2
    s_cselect_b64 s[12:13], s[56:57], s[12:13]
    s_mov_b32 s14, 4718592
    s_mov_b32 s15, 0x20000
    v_bfe_u32 v4, v0, 5, 1
    v_lshlrev_b32 v5, 2, v4
    v_and_b32 v8, 31, v0
    v_xor_b32 v8, v8, v5
    v_lshlrev_b32 v8, 4, v8
    v_lshl_add_u32 v8, v4, 13, v8
    v_xor_b32 v9, 128, v8
    s_lshl_b32 s21, s17, 8
    s_lshl_b32 s42, s18, 16
    s_add_u32 s42, s42, s21
    s_lshl_b32 s44, s18, 12
    s_barrier
    s_add_u32 m0, s44, 73728
    s_add_u32 s22, s42, 0
    buffer_load_dwordx4 v8, s[12:15], s22 offen offset:0 lds
    s_add_u32 s22, s42, 15360
    buffer_load_dwordx4 v9, s[12:15], s22 offen offset:1024 lds
    s_add_u32 s22, s42, 30720
    buffer_load_dwordx4 v8, s[12:15], s22 offen offset:2048 lds
    s_add_u32 s22, s42, 46080
    buffer_load_dwordx4 v9, s[12:15], s22 offen offset:3072 lds
    s_add_u32 m0, s44, 90112
    s_add_u32 s22, s42, 262144
    buffer_load_dwordx4 v8, s[12:15], s22 offen offset:0 lds
    s_add_u32 s22, s42, 277504
    buffer_load_dwordx4 v9, s[12:15], s22 offen offset:1024 lds
    s_add_u32 s22, s42, 292864
    buffer_load_dwordx4 v8, s[12:15], s22 offen offset:2048 lds
    s_add_u32 s22, s42, 308224
    buffer_load_dwordx4 v9, s[12:15], s22 offen offset:3072 lds
    s_add_u32 m0, s44, 106496
    s_add_u32 s22, s42, 524288
    buffer_load_dwordx4 v8, s[12:15], s22 offen offset:0 lds
    s_add_u32 s22, s42, 539648
    buffer_load_dwordx4 v9, s[12:15], s22 offen offset:1024 lds
    s_add_u32 s22, s42, 555008
    buffer_load_dwordx4 v8, s[12:15], s22 offen offset:2048 lds
    s_add_u32 s22, s42, 570368
    buffer_load_dwordx4 v9, s[12:15], s22 offen offset:3072 lds
    s_add_u32 m0, s44, 122880
    s_add_u32 s22, s42, 786432
    buffer_load_dwordx4 v8, s[12:15], s22 offen offset:0 lds
    s_add_u32 s22, s42, 801792
    buffer_load_dwordx4 v9, s[12:15], s22 offen offset:1024 lds
    s_add_u32 s22, s42, 817152
    buffer_load_dwordx4 v8, s[12:15], s22 offen offset:2048 lds
    s_add_u32 s22, s42, 832512
    buffer_load_dwordx4 v9, s[12:15], s22 offen offset:3072 lds
    v_bfe_u32 v4, v0, 2, 2
    v_xor_b32 v5, s18, v4
    v_lshlrev_b32 v10, 6, v5
    v_lshl_add_u32 v10, v4, 9, v10
    v_and_b32 v4, 3, v0
    v_lshl_add_u32 v10, v4, 4, v10
    v_bfe_u32 v4, v0, 4, 2
    v_lshl_add_u32 v10, v4, 12, v10
    v_add_u32 v10, 73728, v10
    v_add_u32 v11, 49152, v10
    v_and_b32 v4, 63, v0
    v_and_b32 v5, 15, v4
    v_lshrrev_b32 v3, 4, v4
    v_lshrrev_b32 v2, 2, v5
    v_xor_b32 v3, v3, v2
    v_lshl_add_u32 v3, v5, 2, v3
    v_lshlrev_b32 v1, 4, v3
    v_lshrrev_b32 v5, 2, v4
    v_lshrrev_b32 v3, 4, v4
    v_and_b32 v4, 3, v4
    v_xor_b32 v4, v4, v3
    v_lshlrev_b32 v3, 3, v3
    v_and_b32 v5, 3, v5
    v_add_u32 v3, v3, v5
    v_mul_u32_u24 v2, 1152, v3
    v_lshl_add_u32 v2, v4, 4, v2
    s_mov_b32 s8, s48
    s_mov_b32 s9, s49
    s_mov_b32 s10, 2359296
    s_mov_b32 s11, 0x20000
    s_lshr_b32 s22, s18, 1
    s_mul_i32 s24, s22, 4608
    s_mul_i32 s25, s22, 18432
    s_and_b32 s22, s18, 1
    s_mul_i32 s23, s22, 576
    s_add_u32 s24, s24, s23
    s_mul_i32 s25, s18, 9216
    s_mul_i32 s22, s19, 36864
    s_add_u32 s24, s24, s22
    s_mov_b32 s20, 64
    s_lshl_b32 s22, s19, 5
    s_add_u32 s22, s22, s17
    s_lshl_b32 s26, s22, 14
    s_mul_i32 s23, s18, 3072
    s_add_u32 s26, s26, s23
    s_lshl_b32 s23, s16, 11
    s_add_u32 s26, s26, s23
    s_add_u32 s26, s26, -2048
    s_lshl_b32 s22, s22, 13
    s_add_u32 s22, s22, 33554432
    s_cmp_eq_u32 s16, 0
    s_cselect_b32 s26, s22, s26
    s_cselect_b32 s40, 4096, 64
    s_cselect_b32 s41, 1, 2
    s_max_u32 s40, s40, 1024
    s_lshl_b32 s41, s41, 18
    s_lshl_b32 s29, s17, 7
    s_lshl_b32 s22, s16, 4
    s_add_u32 s29, s29, s22
    s_lshl_b32 s22, s19, 2
    s_add_u32 s29, s29, s22
    s_add_u32 s29, s29, 125829120
    s_mov_b32 s27, 0
    s_add_u32 s23, s27, s25
    s_add_u32 m0, s23, 0
    s_nop 0
    buffer_load_dwordx4 v2, s[8:11], s24 offen offset:0 lds
    s_add_u32 m0, s23, 960
    s_nop 0
    buffer_load_dwordx4 v2, s[8:11], s24 offen offset:64 lds
    s_add_u32 m0, s23, 1920
    s_nop 0
    buffer_load_dwordx4 v2, s[8:11], s24 offen offset:128 lds
    s_add_u32 m0, s23, 2880
    s_nop 0
    buffer_load_dwordx4 v2, s[8:11], s24 offen offset:192 lds
    s_add_u32 m0, s23, 3840
    s_nop 0
    buffer_load_dwordx4 v2, s[8:11], s24 offen offset:256 lds
    s_add_u32 m0, s23, 4800
    s_nop 0
    buffer_load_dwordx4 v2, s[8:11], s24 offen offset:320 lds
    s_add_u32 m0, s23, 5760
    s_nop 0
    buffer_load_dwordx4 v2, s[8:11], s24 offen offset:384 lds
    s_add_u32 m0, s23, 6720
    s_nop 0
    buffer_load_dwordx4 v2, s[8:11], s24 offen offset:448 lds
    s_add_u32 m0, s23, 7680
    s_nop 0
    buffer_load_dwordx4 v2, s[8:11], s24 offen offset:512 lds
    s_add_u32 s24, s24, 147456
    s_waitcnt vmcnt(21) lgkmcnt(0)
    s_barrier
    s_add_u32 m0, s44, 139264
    s_add_u32 s22, s42, 1048576
    buffer_load_dwordx4 v8, s[12:15], s22 offen offset:0 lds
    s_add_u32 s22, s42, 1063936
    buffer_load_dwordx4 v9, s[12:15], s22 offen offset:1024 lds
    s_add_u32 s22, s42, 1079296
    buffer_load_dwordx4 v8, s[12:15], s22 offen offset:2048 lds
    s_add_u32 s22, s42, 1094656
    buffer_load_dwordx4 v9, s[12:15], s22 offen offset:3072 lds
    ds_read_b64_tr_b16 v[64:65], v10 offset:0
    ds_read_b64_tr_b16 v[66:67], v10 offset:2048
    ds_read_b64_tr_b16 v[136:137], v10 offset:8
    ds_read_b64_tr_b16 v[138:139], v10 offset:2056
    ds_read_b64_tr_b16 a[0:1], v10 offset:256
    ds_read_b64_tr_b16 a[2:3], v10 offset:2304
    ds_read_b64_tr_b16 a[72:73], v10 offset:264
    ds_read_b64_tr_b16 a[74:75], v10 offset:2312
    s_waitcnt vmcnt(21) lgkmcnt(0)
    s_barrier
    s_add_u32 m0, s44, 73728
    s_add_u32 s22, s42, 1310720
    buffer_load_dwordx4 v8, s[12:15], s22 offen offset:0 lds
    s_add_u32 s22, s42, 1326080
    buffer_load_dwordx4 v9, s[12:15], s22 offen offset:1024 lds
    s_add_u32 s22, s42, 1341440
    buffer_load_dwordx4 v8, s[12:15], s22 offen offset:2048 lds
    s_add_u32 s22, s42, 1356800
    buffer_load_dwordx4 v9, s[12:15], s22 offen offset:3072 lds
    ds_read_b64_tr_b16 v[68:69], v10 offset:16384
    ds_read_b64_tr_b16 v[70:71], v10 offset:18432
    ds_read_b64_tr_b16 v[140:141], v10 offset:16392
    ds_read_b64_tr_b16 v[142:143], v10 offset:18440
    ds_read_b64_tr_b16 a[4:5], v10 offset:16640
    ds_read_b64_tr_b16 a[6:7], v10 offset:18688
    ds_read_b64_tr_b16 a[76:77], v10 offset:16648
    ds_read_b64_tr_b16 a[78:79], v10 offset:18696
    s_waitcnt vmcnt(21) lgkmcnt(0)
    s_barrier
    s_add_u32 m0, s44, 90112
    s_add_u32 s22, s42, 1572864
    buffer_load_dwordx4 v8, s[12:15], s22 offen offset:0 lds
    s_add_u32 s22, s42, 1588224
    buffer_load_dwordx4 v9, s[12:15], s22 offen offset:1024 lds
    s_add_u32 s22, s42, 1603584
    buffer_load_dwordx4 v8, s[12:15], s22 offen offset:2048 lds
    s_add_u32 s22, s42, 1618944
    buffer_load_dwordx4 v9, s[12:15], s22 offen offset:3072 lds
    ds_read_b64_tr_b16 v[72:73], v10 offset:32768
    ds_read_b64_tr_b16 v[74:75], v10 offset:34816
    ds_read_b64_tr_b16 v[144:145], v10 offset:32776
    ds_read_b64_tr_b16 v[146:147], v10 offset:34824
    ds_read_b64_tr_b16 a[8:9], v10 offset:33024
    ds_read_b64_tr_b16 a[10:11], v10 offset:35072
    ds_read_b64_tr_b16 a[80:81], v10 offset:33032
    ds_read_b64_tr_b16 a[82:83], v10 offset:35080
    s_waitcnt vmcnt(21) lgkmcnt(0)
    s_barrier
    s_add_u32 m0, s44, 106496
    s_add_u32 s22, s42, 1835008
    buffer_load_dwordx4 v8, s[12:15], s22 offen offset:0 lds
    s_add_u32 s22, s42, 1850368
    buffer_load_dwordx4 v9, s[12:15], s22 offen offset:1024 lds
    s_add_u32 s22, s42, 1865728
    buffer_load_dwordx4 v8, s[12:15], s22 offen offset:2048 lds
    s_add_u32 s22, s42, 1881088
    buffer_load_dwordx4 v9, s[12:15], s22 offen offset:3072 lds
    ds_read_b64_tr_b16 v[76:77], v11 offset:0
    ds_read_b64_tr_b16 v[78:79], v11 offset:2048
    ds_read_b64_tr_b16 v[148:149], v11 offset:8
    ds_read_b64_tr_b16 v[150:151], v11 offset:2056
    ds_read_b64_tr_b16 a[12:13], v11 offset:256
    ds_read_b64_tr_b16 a[14:15], v11 offset:2304
    ds_read_b64_tr_b16 a[84:85], v11 offset:264
    ds_read_b64_tr_b16 a[86:87], v11 offset:2312
    s_waitcnt vmcnt(12) lgkmcnt(0)
    s_barrier
    s_add_u32 m0, s44, 122880
    s_add_u32 s22, s42, 2097152
    buffer_load_dwordx4 v8, s[12:15], s22 offen offset:0 lds
    s_add_u32 s22, s42, 2112512
    buffer_load_dwordx4 v9, s[12:15], s22 offen offset:1024 lds
    s_add_u32 s22, s42, 2127872
    buffer_load_dwordx4 v8, s[12:15], s22 offen offset:2048 lds
    s_add_u32 s22, s42, 2143232
    buffer_load_dwordx4 v9, s[12:15], s22 offen offset:3072 lds
    ds_read_b64_tr_b16 v[80:81], v11 offset:16384
    ds_read_b64_tr_b16 v[82:83], v11 offset:18432
    ds_read_b64_tr_b16 v[152:153], v11 offset:16392
    ds_read_b64_tr_b16 v[154:155], v11 offset:18440
    ds_read_b64_tr_b16 a[16:17], v11 offset:16640
    ds_read_b64_tr_b16 a[18:19], v11 offset:18688
    ds_read_b64_tr_b16 a[88:89], v11 offset:16648
    ds_read_b64_tr_b16 a[90:91], v11 offset:18696
    s_waitcnt vmcnt(12) lgkmcnt(0)
    s_barrier
    s_add_u32 m0, s44, 139264
    s_add_u32 s22, s42, 2359296
    buffer_load_dwordx4 v8, s[12:15], s22 offen offset:0 lds
    s_add_u32 s22, s42, 2374656
    buffer_load_dwordx4 v9, s[12:15], s22 offen offset:1024 lds
    s_add_u32 s22, s42, 2390016
    buffer_load_dwordx4 v8, s[12:15], s22 offen offset:2048 lds
    s_add_u32 s22, s42, 2405376
    buffer_load_dwordx4 v9, s[12:15], s22 offen offset:3072 lds
    ds_read_b64_tr_b16 v[84:85], v10 offset:0
    ds_read_b64_tr_b16 v[86:87], v10 offset:2048
    ds_read_b64_tr_b16 v[156:157], v10 offset:8
    ds_read_b64_tr_b16 v[158:159], v10 offset:2056
    ds_read_b64_tr_b16 a[20:21], v10 offset:256
    ds_read_b64_tr_b16 a[22:23], v10 offset:2304
    ds_read_b64_tr_b16 a[92:93], v10 offset:264
    ds_read_b64_tr_b16 a[94:95], v10 offset:2312
    s_waitcnt vmcnt(12) lgkmcnt(0)
    s_barrier
    s_add_u32 m0, s44, 73728
    s_add_u32 s22, s42, 2621440
    buffer_load_dwordx4 v8, s[12:15], s22 offen offset:0 lds
    s_add_u32 s22, s42, 2636800
    buffer_load_dwordx4 v9, s[12:15], s22 offen offset:1024 lds
    s_add_u32 s22, s42, 2652160
    buffer_load_dwordx4 v8, s[12:15], s22 offen offset:2048 lds
    s_add_u32 s22, s42, 2667520
    buffer_load_dwordx4 v9, s[12:15], s22 offen offset:3072 lds
    ds_read_b64_tr_b16 v[88:89], v10 offset:16384
    ds_read_b64_tr_b16 v[90:91], v10 offset:18432
    ds_read_b64_tr_b16 v[160:161], v10 offset:16392
    ds_read_b64_tr_b16 v[162:163], v10 offset:18440
    ds_read_b64_tr_b16 a[24:25], v10 offset:16640
    ds_read_b64_tr_b16 a[26:27], v10 offset:18688
    ds_read_b64_tr_b16 a[96:97], v10 offset:16648
    ds_read_b64_tr_b16 a[98:99], v10 offset:18696
    s_waitcnt vmcnt(12) lgkmcnt(0)
    s_barrier
    s_add_u32 m0, s44, 90112
    s_add_u32 s22, s42, 2883584
    buffer_load_dwordx4 v8, s[12:15], s22 offen offset:0 lds
    s_add_u32 s22, s42, 2898944
    buffer_load_dwordx4 v9, s[12:15], s22 offen offset:1024 lds
    s_add_u32 s22, s42, 2914304
    buffer_load_dwordx4 v8, s[12:15], s22 offen offset:2048 lds
    s_add_u32 s22, s42, 2929664
    buffer_load_dwordx4 v9, s[12:15], s22 offen offset:3072 lds
    ds_read_b64_tr_b16 v[92:93], v10 offset:32768
    ds_read_b64_tr_b16 v[94:95], v10 offset:34816
    ds_read_b64_tr_b16 v[164:165], v10 offset:32776
    ds_read_b64_tr_b16 v[166:167], v10 offset:34824
    ds_read_b64_tr_b16 a[28:29], v10 offset:33024
    ds_read_b64_tr_b16 a[30:31], v10 offset:35072
    ds_read_b64_tr_b16 a[100:101], v10 offset:33032
    ds_read_b64_tr_b16 a[102:103], v10 offset:35080
    s_waitcnt vmcnt(12) lgkmcnt(0)
    s_barrier
    s_add_u32 m0, s44, 106496
    s_add_u32 s22, s42, 3145728
    buffer_load_dwordx4 v8, s[12:15], s22 offen offset:0 lds
    s_add_u32 s22, s42, 3161088
    buffer_load_dwordx4 v9, s[12:15], s22 offen offset:1024 lds
    s_add_u32 s22, s42, 3176448
    buffer_load_dwordx4 v8, s[12:15], s22 offen offset:2048 lds
    s_add_u32 s22, s42, 3191808
    buffer_load_dwordx4 v9, s[12:15], s22 offen offset:3072 lds
    ds_read_b64_tr_b16 v[96:97], v11 offset:0
    ds_read_b64_tr_b16 v[98:99], v11 offset:2048
    ds_read_b64_tr_b16 v[168:169], v11 offset:8
    ds_read_b64_tr_b16 v[170:171], v11 offset:2056
    ds_read_b64_tr_b16 a[32:33], v11 offset:256
    ds_read_b64_tr_b16 a[34:35], v11 offset:2304
    ds_read_b64_tr_b16 a[104:105], v11 offset:264
    ds_read_b64_tr_b16 a[106:107], v11 offset:2312
    s_waitcnt vmcnt(12) lgkmcnt(0)
    s_barrier
    s_add_u32 m0, s44, 122880
    s_add_u32 s22, s42, 3407872
    buffer_load_dwordx4 v8, s[12:15], s22 offen offset:0 lds
    s_add_u32 s22, s42, 3423232
    buffer_load_dwordx4 v9, s[12:15], s22 offen offset:1024 lds
    s_add_u32 s22, s42, 3438592
    buffer_load_dwordx4 v8, s[12:15], s22 offen offset:2048 lds
    s_add_u32 s22, s42, 3453952
    buffer_load_dwordx4 v9, s[12:15], s22 offen offset:3072 lds
    ds_read_b64_tr_b16 v[100:101], v11 offset:16384
    ds_read_b64_tr_b16 v[102:103], v11 offset:18432
    ds_read_b64_tr_b16 v[172:173], v11 offset:16392
    ds_read_b64_tr_b16 v[174:175], v11 offset:18440
    ds_read_b64_tr_b16 a[36:37], v11 offset:16640
    ds_read_b64_tr_b16 a[38:39], v11 offset:18688
    ds_read_b64_tr_b16 a[108:109], v11 offset:16648
    ds_read_b64_tr_b16 a[110:111], v11 offset:18696
    s_waitcnt vmcnt(12) lgkmcnt(0)
    s_barrier
    s_add_u32 m0, s44, 139264
    s_add_u32 s22, s42, 3670016
    buffer_load_dwordx4 v8, s[12:15], s22 offen offset:0 lds
    s_add_u32 s22, s42, 3685376
    buffer_load_dwordx4 v9, s[12:15], s22 offen offset:1024 lds
    s_add_u32 s22, s42, 3700736
    buffer_load_dwordx4 v8, s[12:15], s22 offen offset:2048 lds
    s_add_u32 s22, s42, 3716096
    buffer_load_dwordx4 v9, s[12:15], s22 offen offset:3072 lds
    ds_read_b64_tr_b16 v[104:105], v10 offset:0
    ds_read_b64_tr_b16 v[106:107], v10 offset:2048
    ds_read_b64_tr_b16 v[176:177], v10 offset:8
    ds_read_b64_tr_b16 v[178:179], v10 offset:2056
    ds_read_b64_tr_b16 a[40:41], v10 offset:256
    ds_read_b64_tr_b16 a[42:43], v10 offset:2304
    ds_read_b64_tr_b16 a[112:113], v10 offset:264
    ds_read_b64_tr_b16 a[114:115], v10 offset:2312
    s_waitcnt vmcnt(12) lgkmcnt(0)
    s_barrier
    s_add_u32 m0, s44, 73728
    s_add_u32 s22, s42, 3932160
    buffer_load_dwordx4 v8, s[12:15], s22 offen offset:0 lds
    s_add_u32 s22, s42, 3947520
    buffer_load_dwordx4 v9, s[12:15], s22 offen offset:1024 lds
    s_add_u32 s22, s42, 3962880
    buffer_load_dwordx4 v8, s[12:15], s22 offen offset:2048 lds
    s_add_u32 s22, s42, 3978240
    buffer_load_dwordx4 v9, s[12:15], s22 offen offset:3072 lds
    ds_read_b64_tr_b16 v[108:109], v10 offset:16384
    ds_read_b64_tr_b16 v[110:111], v10 offset:18432
    ds_read_b64_tr_b16 v[180:181], v10 offset:16392
    ds_read_b64_tr_b16 v[182:183], v10 offset:18440
    ds_read_b64_tr_b16 a[44:45], v10 offset:16640
    ds_read_b64_tr_b16 a[46:47], v10 offset:18688
    ds_read_b64_tr_b16 a[116:117], v10 offset:16648
    ds_read_b64_tr_b16 a[118:119], v10 offset:18696
    s_waitcnt vmcnt(12) lgkmcnt(0)
    s_barrier
    s_add_u32 m0, s44, 90112
    s_add_u32 s22, s42, 4194304
    buffer_load_dwordx4 v8, s[12:15], s22 offen offset:0 lds
    s_add_u32 s22, s42, 4209664
    buffer_load_dwordx4 v9, s[12:15], s22 offen offset:1024 lds
    s_add_u32 s22, s42, 4225024
    buffer_load_dwordx4 v8, s[12:15], s22 offen offset:2048 lds
    s_add_u32 s22, s42, 4240384
    buffer_load_dwordx4 v9, s[12:15], s22 offen offset:3072 lds
    ds_read_b64_tr_b16 v[112:113], v10 offset:32768
    ds_read_b64_tr_b16 v[114:115], v10 offset:34816
    ds_read_b64_tr_b16 v[184:185], v10 offset:32776
    ds_read_b64_tr_b16 v[186:187], v10 offset:34824
    ds_read_b64_tr_b16 a[48:49], v10 offset:33024
    ds_read_b64_tr_b16 a[50:51], v10 offset:35072
    ds_read_b64_tr_b16 a[120:121], v10 offset:33032
    ds_read_b64_tr_b16 a[122:123], v10 offset:35080
    s_waitcnt vmcnt(12) lgkmcnt(0)
    s_barrier
    s_add_u32 m0, s44, 106496
    s_add_u32 s22, s42, 4456448
    buffer_load_dwordx4 v8, s[12:15], s22 offen offset:0 lds
    s_add_u32 s22, s42, 4471808
    buffer_load_dwordx4 v9, s[12:15], s22 offen offset:1024 lds
    s_add_u32 s22, s42, 4487168
    buffer_load_dwordx4 v8, s[12:15], s22 offen offset:2048 lds
    s_add_u32 s22, s42, 4502528
    buffer_load_dwordx4 v9, s[12:15], s22 offen offset:3072 lds
    ds_read_b64_tr_b16 v[116:117], v11 offset:0
    ds_read_b64_tr_b16 v[118:119], v11 offset:2048
    ds_read_b64_tr_b16 v[188:189], v11 offset:8
    ds_read_b64_tr_b16 v[190:191], v11 offset:2056
    ds_read_b64_tr_b16 a[52:53], v11 offset:256
    ds_read_b64_tr_b16 a[54:55], v11 offset:2304
    ds_read_b64_tr_b16 a[124:125], v11 offset:264
    ds_read_b64_tr_b16 a[126:127], v11 offset:2312
    s_waitcnt vmcnt(12) lgkmcnt(0)
    s_barrier
    s_mov_b32 s27, 36864
    s_add_u32 s23, s27, s25
    s_add_u32 m0, s23, 0
    s_nop 0
    buffer_load_dwordx4 v2, s[8:11], s24 offen offset:0 lds
    s_add_u32 m0, s23, 960
    s_nop 0
    buffer_load_dwordx4 v2, s[8:11], s24 offen offset:64 lds
    s_add_u32 m0, s23, 1920
    s_nop 0
    buffer_load_dwordx4 v2, s[8:11], s24 offen offset:128 lds
    s_add_u32 m0, s23, 2880
    s_nop 0
    buffer_load_dwordx4 v2, s[8:11], s24 offen offset:192 lds
    s_add_u32 m0, s23, 3840
    s_nop 0
    buffer_load_dwordx4 v2, s[8:11], s24 offen offset:256 lds
    s_add_u32 m0, s23, 4800
    s_nop 0
    buffer_load_dwordx4 v2, s[8:11], s24 offen offset:320 lds
    s_add_u32 m0, s23, 5760
    s_nop 0
    buffer_load_dwordx4 v2, s[8:11], s24 offen offset:384 lds
    s_add_u32 m0, s23, 6720
    s_nop 0
    buffer_load_dwordx4 v2, s[8:11], s24 offen offset:448 lds
    s_add_u32 m0, s23, 7680
    s_nop 0
    buffer_load_dwordx4 v2, s[8:11], s24 offen offset:512 lds
    s_add_u32 s24, s24, 147456
    ds_read_b64_tr_b16 v[120:121], v11 offset:16384
    ds_read_b64_tr_b16 v[122:123], v11 offset:18432
    ds_read_b64_tr_b16 v[192:193], v11 offset:16392
    ds_read_b64_tr_b16 v[194:195], v11 offset:18440
    ds_read_b64_tr_b16 a[56:57], v11 offset:16640
    ds_read_b64_tr_b16 a[58:59], v11 offset:18688
    ds_read_b64_tr_b16 a[128:129], v11 offset:16648
    ds_read_b64_tr_b16 a[130:131], v11 offset:18696
    s_waitcnt vmcnt(17) lgkmcnt(0)
    s_barrier
    ds_read_b64_tr_b16 v[124:125], v10 offset:0
    ds_read_b64_tr_b16 v[126:127], v10 offset:2048
    ds_read_b64_tr_b16 v[196:197], v10 offset:8
    ds_read_b64_tr_b16 v[198:199], v10 offset:2056
    ds_read_b64_tr_b16 a[60:61], v10 offset:256
    ds_read_b64_tr_b16 a[62:63], v10 offset:2304
    ds_read_b64_tr_b16 a[132:133], v10 offset:264
    ds_read_b64_tr_b16 a[134:135], v10 offset:2312
    s_waitcnt vmcnt(13) lgkmcnt(0)
    s_barrier
    ds_read_b64_tr_b16 v[128:129], v10 offset:16384
    ds_read_b64_tr_b16 v[130:131], v10 offset:18432
    ds_read_b64_tr_b16 v[200:201], v10 offset:16392
    ds_read_b64_tr_b16 v[202:203], v10 offset:18440
    ds_read_b64_tr_b16 a[64:65], v10 offset:16640
    ds_read_b64_tr_b16 a[66:67], v10 offset:18688
    ds_read_b64_tr_b16 a[136:137], v10 offset:16648
    ds_read_b64_tr_b16 a[138:139], v10 offset:18696
    s_waitcnt vmcnt(9) lgkmcnt(0)
    s_barrier
    ds_read_b64_tr_b16 v[132:133], v10 offset:32768
    ds_read_b64_tr_b16 v[134:135], v10 offset:34816
    ds_read_b64_tr_b16 v[204:205], v10 offset:32776
    ds_read_b64_tr_b16 v[206:207], v10 offset:34824
    ds_read_b64_tr_b16 a[68:69], v10 offset:33024
    ds_read_b64_tr_b16 a[70:71], v10 offset:35072
    ds_read_b64_tr_b16 a[140:141], v10 offset:33032
    ds_read_b64_tr_b16 a[142:143], v10 offset:35080
    s_mov_b32 s88, 4194304
gn5:
    buffer_load_dword v250, off, s[84:87], 0 offset:216 sc1
    s_waitcnt vmcnt(0)
    v_readfirstlane_b32 s95, v250
    s_sub_u32 s88, s88, 1
    s_cbranch_scc1 gn5x
    s_cmp_eq_u32 s95, 0
    s_cbranch_scc1 gn5
gn5x:
    s_waitcnt lgkmcnt(0)
    s_mov_b32 s45, 0
    s_mov_b32 s27, 0
    s_cmp_eq_u32 s18, 0
    s_cselect_b32 s34, 1, 0
    s_mov_b32 s35, 0
    s_cmp_eq_u32 s16, 2
    s_cbranch_scc1 qk_vloop
qk_loop:
    s_barrier
    v_add_u32 v3, s27, v1
    ds_read_b128 v[32:35], v3 offset:0
    ds_read_b128 v[36:39], v3 offset:18432
    ds_read_b128 v[40:43], v3 offset:1024
    ds_read_b128 v[44:47], v3 offset:19456
    ds_read_b128 v[48:51], v3 offset:2048
    ds_read_b128 v[52:55], v3 offset:20480
    s_add_u32 s23, s45, s95
    v_mov_b32 v4, s23
    s_mov_b64 exec, s[34:35]
    buffer_store_dword v4, off, s[4:7], s29 sc1
    buffer_store_dword v4, off, s[4:7], s29 offset:128 sc1
    s_mov_b64 exec, -1
    s_add_u32 s22, s27, 73728
    s_sub_u32 s21, s22, 110592
    s_cselect_b32 s22, s22, s21
    ds_read_b128 v[56:59], v3 offset:3072
    ds_read_b128 v[60:63], v3 offset:21504
    s_add_u32 s23, s22, s25
    s_add_u32 m0, s23, 0
    s_nop 0
    buffer_load_dwordx4 v2, s[8:11], s24 offen offset:0 lds
    s_waitcnt lgkmcnt(6)
    v_mfma_f32_16x16x32_bf16 v[208:211], v[64:67], v[32:35], 0
    v_mfma_f32_16x16x32_bf16 v[212:215], v[136:139], v[32:35], 0
    v_mfma_f32_16x16x32_bf16 v[216:219], v[64:67], v[36:39], 0
    v_mfma_f32_16x16x32_bf16 v[220:223], v[136:139], v[36:39], 0
    v_mfma_f32_16x16x32_bf16 v[224:227], a[0:3], v[32:35], 0
    v_mfma_f32_16x16x32_bf16 v[228:231], a[72:75], v[32:35], 0
    v_mfma_f32_16x16x32_bf16 v[232:235], a[0:3], v[36:39], 0
    v_mfma_f32_16x16x32_bf16 v[236:239], a[72:75], v[36:39], 0
    ds_read_b128 v[32:35], v3 offset:4096
    ds_read_b128 v[36:39], v3 offset:22528
    s_add_u32 m0, s23, 960
    s_nop 0
    buffer_load_dwordx4 v2, s[8:11], s24 offen offset:64 lds
    s_waitcnt lgkmcnt(6)
    v_mfma_f32_16x16x32_bf16 v[208:211], v[68:71], v[40:43], v[208:211]
    v_mfma_f32_16x16x32_bf16 v[212:215], v[140:143], v[40:43], v[212:215]
    v_mfma_f32_16x16x32_bf16 v[216:219], v[68:71], v[44:47], v[216:219]
    v_mfma_f32_16x16x32_bf16 v[220:223], v[140:143], v[44:47], v[220:223]
    v_mfma_f32_16x16x32_bf16 v[224:227], a[4:7], v[40:43], v[224:227]
    v_mfma_f32_16x16x32_bf16 v[228:231], a[76:79], v[40:43], v[228:231]
    v_mfma_f32_16x16x32_bf16 v[232:235], a[4:7], v[44:47], v[232:235]
    v_mfma_f32_16x16x32_bf16 v[236:239], a[76:79], v[44:47], v[236:239]
    ds_read_b128 v[40:43], v3 offset:5120
    ds_read_b128 v[44:47], v3 offset:23552
    s_add_u32 m0, s23, 1920
    s_nop 0
    buffer_load_dwordx4 v2, s[8:11], s24 offen offset:128 lds
    s_waitcnt lgkmcnt(6)
    v_mfma_f32_16x16x32_bf16 v[208:211], v[72:75], v[48:51], v[208:211]
    v_mfma_f32_16x16x32_bf16 v[212:215], v[144:147], v[48:51], v[212:215]
    v_mfma_f32_16x16x32_bf16 v[216:219], v[72:75], v[52:55], v[216:219]
    v_mfma_f32_16x16x32_bf16 v[220:223], v[144:147], v[52:55], v[220:223]
    v_mfma_f32_16x16x32_bf16 v[224:227], a[8:11], v[48:51], v[224:227]
    v_mfma_f32_16x16x32_bf16 v[228:231], a[80:83], v[48:51], v[228:231]
    v_mfma_f32_16x16x32_bf16 v[232:235], a[8:11], v[52:55], v[232:235]
    v_mfma_f32_16x16x32_bf16 v[236:239], a[80:83], v[52:55], v[236:239]
    ds_read_b128 v[48:51], v3 offset:6144
    ds_read_b128 v[52:55], v3 offset:24576
    s_add_u32 m0, s23, 2880
    s_nop 0
    buffer_load_dwordx4 v2, s[8:11], s24 offen offset:192 lds
    s_waitcnt lgkmcnt(6)
    v_mfma_f32_16x16x32_bf16 v[208:211], v[76:79], v[56:59], v[208:211]
    v_mfma_f32_16x16x32_bf16 v[212:215], v[148:151], v[56:59], v[212:215]
    v_mfma_f32_16x16x32_bf16 v[216:219], v[76:79], v[60:63], v[216:219]
    v_mfma_f32_16x16x32_bf16 v[220:223], v[148:151], v[60:63], v[220:223]
    v_mfma_f32_16x16x32_bf16 v[224:227], a[12:15], v[56:59], v[224:227]
    v_mfma_f32_16x16x32_bf16 v[228:231], a[84:87], v[56:59], v[228:231]
    v_mfma_f32_16x16x32_bf16 v[232:235], a[12:15], v[60:63], v[232:235]
    v_mfma_f32_16x16x32_bf16 v[236:239], a[84:87], v[60:63], v[236:239]
    ds_read_b128 v[56:59], v3 offset:7168
    ds_read_b128 v[60:63], v3 offset:25600
    s_add_u32 m0, s23, 3840
    s_nop 0
    buffer_load_dwordx4 v2, s[8:11], s24 offen offset:256 lds
    s_waitcnt lgkmcnt(6)
    v_mfma_f32_16x16x32_bf16 v[208:211], v[80:83], v[32:35], v[208:211]
    v_mfma_f32_16x16x32_bf16 v[212:215], v[152:155], v[32:35], v[212:215]
    v_mfma_f32_16x16x32_bf16 v[216:219], v[80:83], v[36:39], v[216:219]
    v_mfma_f32_16x16x32_bf16 v[220:223], v[152:155], v[36:39], v[220:223]
    v_mfma_f32_16x16x32_bf16 v[224:227], a[16:19], v[32:35], v[224:227]
    v_mfma_f32_16x16x32_bf16 v[228:231], a[88:91], v[32:35], v[228:231]
    v_mfma_f32_16x16x32_bf16 v[232:235], a[16:19], v[36:39], v[232:235]
    v_mfma_f32_16x16x32_bf16 v[236:239], a[88:91], v[36:39], v[236:239]
    ds_read_b128 v[32:35], v3 offset:8192
    ds_read_b128 v[36:39], v3 offset:26624
    s_add_u32 m0, s23, 4800
    s_nop 0
    buffer_load_dwordx4 v2, s[8:11], s24 offen offset:320 lds
    s_waitcnt lgkmcnt(6)
    v_mfma_f32_16x16x32_bf16 v[208:211], v[84:87], v[40:43], v[208:211]
    v_mfma_f32_16x16x32_bf16 v[212:215], v[156:159], v[40:43], v[212:215]
    v_mfma_f32_16x16x32_bf16 v[216:219], v[84:87], v[44:47], v[216:219]
    v_mfma_f32_16x16x32_bf16 v[220:223], v[156:159], v[44:47], v[220:223]
    v_mfma_f32_16x16x32_bf16 v[224:227], a[20:23], v[40:43], v[224:227]
    v_mfma_f32_16x16x32_bf16 v[228:231], a[92:95], v[40:43], v[228:231]
    v_mfma_f32_16x16x32_bf16 v[232:235], a[20:23], v[44:47], v[232:235]
    v_mfma_f32_16x16x32_bf16 v[236:239], a[92:95], v[44:47], v[236:239]
    ds_read_b128 v[40:43], v3 offset:9216
    ds_read_b128 v[44:47], v3 offset:27648
    s_add_u32 m0, s23, 5760
    s_nop 0
    buffer_load_dwordx4 v2, s[8:11], s24 offen offset:384 lds
    s_waitcnt lgkmcnt(6)
    v_mfma_f32_16x16x32_bf16 v[208:211], v[88:91], v[48:51], v[208:211]
    v_mfma_f32_16x16x32_bf16 v[212:215], v[160:163], v[48:51], v[212:215]
    v_mfma_f32_16x16x32_bf16 v[216:219], v[88:91], v[52:55], v[216:219]
    v_mfma_f32_16x16x32_bf16 v[220:223], v[160:163], v[52:55], v[220:223]
    v_mfma_f32_16x16x32_bf16 v[224:227], a[24:27], v[48:51], v[224:227]
    v_mfma_f32_16x16x32_bf16 v[228:231], a[96:99], v[48:51], v[228:231]
    v_mfma_f32_16x16x32_bf16 v[232:235], a[24:27], v[52:55], v[232:235]
    v_mfma_f32_16x16x32_bf16 v[236:239], a[96:99], v[52:55], v[236:239]
    ds_read_b128 v[48:51], v3 offset:10240
    ds_read_b128 v[52:55], v3 offset:28672
    s_add_u32 m0, s23, 6720
    s_nop 0
    buffer_load_dwordx4 v2, s[8:11], s24 offen offset:448 lds
    s_waitcnt lgkmcnt(6)
    v_mfma_f32_16x16x32_bf16 v[208:211], v[92:95], v[56:59], v[208:211]
    v_mfma_f32_16x16x32_bf16 v[212:215], v[164:167], v[56:59], v[212:215]
    v_mfma_f32_16x16x32_bf16 v[216:219], v[92:95], v[60:63], v[216:219]
    v_mfma_f32_16x16x32_bf16 v[220:223], v[164:167], v[60:63], v[220:223]
    v_mfma_f32_16x16x32_bf16 v[224:227], a[28:31], v[56:59], v[224:227]
    v_mfma_f32_16x16x32_bf16 v[228:231], a[100:103], v[56:59], v[228:231]
    v_mfma_f32_16x16x32_bf16 v[232:235], a[28:31], v[60:63], v[232:235]
    v_mfma_f32_16x16x32_bf16 v[236:239], a[100:103], v[60:63], v[236:239]
    ds_read_b128 v[56:59], v3 offset:11264
    ds_read_b128 v[60:63], v3 offset:29696
    s_add_u32 m0, s23, 7680
    s_nop 0
    buffer_load_dwordx4 v2, s[8:11], s24 offen offset:512 lds
    s_add_u32 s24, s24, 147456
    s_waitcnt lgkmcnt(6)
    v_mfma_f32_16x16x32_bf16 v[208:211], v[96:99], v[32:35], v[208:211]
    v_mfma_f32_16x16x32_bf16 v[212:215], v[168:171], v[32:35], v[212:215]
    v_mfma_f32_16x16x32_bf16 v[216:219], v[96:99], v[36:39], v[216:219]
    v_mfma_f32_16x16x32_bf16 v[220:223], v[168:171], v[36:39], v[220:223]
    v_mfma_f32_16x16x32_bf16 v[224:227], a[32:35], v[32:35], v[224:227]
    v_mfma_f32_16x16x32_bf16 v[228:231], a[104:107], v[32:35], v[228:231]
    v_mfma_f32_16x16x32_bf16 v[232:235], a[32:35], v[36:39], v[232:235]
    v_mfma_f32_16x16x32_bf16 v[236:239], a[104:107], v[36:39], v[236:239]
    ds_read_b128 v[32:35], v3 offset:12288
    ds_read_b128 v[36:39], v3 offset:30720
    s_waitcnt lgkmcnt(6)
    v_mfma_f32_16x16x32_bf16 v[208:211], v[100:103], v[40:43], v[208:211]
    v_mfma_f32_16x16x32_bf16 v[212:215], v[172:175], v[40:43], v[212:215]
    v_mfma_f32_16x16x32_bf16 v[216:219], v[100:103], v[44:47], v[216:219]
    v_mfma_f32_16x16x32_bf16 v[220:223], v[172:175], v[44:47], v[220:223]
    v_mfma_f32_16x16x32_bf16 v[224:227], a[36:39], v[40:43], v[224:227]
    v_mfma_f32_16x16x32_bf16 v[228:231], a[108:111], v[40:43], v[228:231]
    v_mfma_f32_16x16x32_bf16 v[232:235], a[36:39], v[44:47], v[232:235]
    v_mfma_f32_16x16x32_bf16 v[236:239], a[108:111], v[44:47], v[236:239]
    ds_read_b128 v[40:43], v3 offset:13312
    ds_read_b128 v[44:47], v3 offset:31744
    s_waitcnt lgkmcnt(6)
    v_mfma_f32_16x16x32_bf16 v[208:211], v[104:107], v[48:51], v[208:211]
    v_mfma_f32_16x16x32_bf16 v[212:215], v[176:179], v[48:51], v[212:215]
    v_mfma_f32_16x16x32_bf16 v[216:219], v[104:107], v[52:55], v[216:219]
    v_mfma_f32_16x16x32_bf16 v[220:223], v[176:179], v[52:55], v[220:223]
    v_mfma_f32_16x16x32_bf16 v[224:227], a[40:43], v[48:51], v[224:227]
    v_mfma_f32_16x16x32_bf16 v[228:231], a[112:115], v[48:51], v[228:231]
    v_mfma_f32_16x16x32_bf16 v[232:235], a[40:43], v[52:55], v[232:235]
    v_mfma_f32_16x16x32_bf16 v[236:239], a[112:115], v[52:55], v[236:239]
    ds_read_b128 v[48:51], v3 offset:14336
    ds_read_b128 v[52:55], v3 offset:32768
    s_waitcnt lgkmcnt(6)
    v_mfma_f32_16x16x32_bf16 v[208:211], v[108:111], v[56:59], v[208:211]
    v_mfma_f32_16x16x32_bf16 v[212:215], v[180:183], v[56:59], v[212:215]
    v_mfma_f32_16x16x32_bf16 v[216:219], v[108:111], v[60:63], v[216:219]
    v_mfma_f32_16x16x32_bf16 v[220:223], v[180:183], v[60:63], v[220:223]
    v_mfma_f32_16x16x32_bf16 v[224:227], a[44:47], v[56:59], v[224:227]
    v_mfma_f32_16x16x32_bf16 v[228:231], a[116:119], v[56:59], v[228:231]
    v_mfma_f32_16x16x32_bf16 v[232:235], a[44:47], v[60:63], v[232:235]
    v_mfma_f32_16x16x32_bf16 v[236:239], a[116:119], v[60:63], v[236:239]
    ds_read_b128 v[56:59], v3 offset:15360
    ds_read_b128 v[60:63], v3 offset:33792
    s_waitcnt lgkmcnt(6)
    v_mfma_f32_16x16x32_bf16 v[208:211], v[112:115], v[32:35], v[208:211]
    v_mfma_f32_16x16x32_bf16 v[212:215], v[184:187], v[32:35], v[212:215]
    v_mfma_f32_16x16x32_bf16 v[216:219], v[112:115], v[36:39], v[216:219]
    v_mfma_f32_16x16x32_bf16 v[220:223], v[184:187], v[36:39], v[220:223]
    v_mfma_f32_16x16x32_bf16 v[224:227], a[48:51], v[32:35], v[224:227]
    v_mfma_f32_16x16x32_bf16 v[228:231], a[120:123], v[32:35], v[228:231]
    v_mfma_f32_16x16x32_bf16 v[232:235], a[48:51], v[36:39], v[232:235]
    v_mfma_f32_16x16x32_bf16 v[236:239], a[120:123], v[36:39], v[236:239]
    ds_read_b128 v[32:35], v3 offset:16384
    ds_read_b128 v[36:39], v3 offset:34816
    s_waitcnt lgkmcnt(6)
    v_mfma_f32_16x16x32_bf16 v[208:211], v[116:119], v[40:43], v[208:211]
    v_mfma_f32_16x16x32_bf16 v[212:215], v[188:191], v[40:43], v[212:215]
    v_mfma_f32_16x16x32_bf16 v[216:219], v[116:119], v[44:47], v[216:219]
    v_mfma_f32_16x16x32_bf16 v[220:223], v[188:191], v[44:47], v[220:223]
    v_mfma_f32_16x16x32_bf16 v[224:227], a[52:55], v[40:43], v[224:227]
    v_mfma_f32_16x16x32_bf16 v[228:231], a[124:127], v[40:43], v[228:231]
    v_mfma_f32_16x16x32_bf16 v[232:235], a[52:55], v[44:47], v[232:235]
    v_mfma_f32_16x16x32_bf16 v[236:239], a[124:127], v[44:47], v[236:239]
    ds_read_b128 v[40:43], v3 offset:17408
    ds_read_b128 v[44:47], v3 offset:35840
    s_waitcnt lgkmcnt(6)
    v_mfma_f32_16x16x32_bf16 v[208:211], v[120:123], v[48:51], v[208:211]
    v_mfma_f32_16x16x32_bf16 v[212:215], v[192:195], v[48:51], v[212:215]
    v_mfma_f32_16x16x32_bf16 v[216:219], v[120:123], v[52:55], v[216:219]
    v_mfma_f32_16x16x32_bf16 v[220:223], v[192:195], v[52:55], v[220:223]
    v_mfma_f32_16x16x32_bf16 v[224:227], a[56:59], v[48:51], v[224:227]
    v_mfma_f32_16x16x32_bf16 v[228:231], a[128:131], v[48:51], v[228:231]
    v_mfma_f32_16x16x32_bf16 v[232:235], a[56:59], v[52:55], v[232:235]
    v_mfma_f32_16x16x32_bf16 v[236:239], a[128:131], v[52:55], v[236:239]
    s_waitcnt lgkmcnt(4)
    v_mfma_f32_16x16x32_bf16 v[208:211], v[124:127], v[56:59], v[208:211]
    v_mfma_f32_16x16x32_bf16 v[212:215], v[196:199], v[56:59], v[212:215]
    v_mfma_f32_16x16x32_bf16 v[216:219], v[124:127], v[60:63], v[216:219]
    v_mfma_f32_16x16x32_bf16 v[220:223], v[196:199], v[60:63], v[220:223]
    v_mfma_f32_16x16x32_bf16 v[224:227], a[60:63], v[56:59], v[224:227]
    v_mfma_f32_16x16x32_bf16 v[228:231], a[132:135], v[56:59], v[228:231]
    v_mfma_f32_16x16x32_bf16 v[232:235], a[60:63], v[60:63], v[232:235]
    v_mfma_f32_16x16x32_bf16 v[236:239], a[132:135], v[60:63], v[236:239]
    s_waitcnt lgkmcnt(2)
    v_mfma_f32_16x16x32_bf16 v[208:211], v[128:131], v[32:35], v[208:211]
    v_mfma_f32_16x16x32_bf16 v[212:215], v[200:203], v[32:35], v[212:215]
    v_mfma_f32_16x16x32_bf16 v[216:219], v[128:131], v[36:39], v[216:219]
    v_mfma_f32_16x16x32_bf16 v[220:223], v[200:203], v[36:39], v[220:223]
    v_mfma_f32_16x16x32_bf16 v[224:227], a[64:67], v[32:35], v[224:227]
    v_mfma_f32_16x16x32_bf16 v[228:231], a[136:139], v[32:35], v[228:231]
    v_mfma_f32_16x16x32_bf16 v[232:235], a[64:67], v[36:39], v[232:235]
    v_mfma_f32_16x16x32_bf16 v[236:239], a[136:139], v[36:39], v[236:239]
    s_waitcnt lgkmcnt(0)
    v_mfma_f32_16x16x32_bf16 v[208:211], v[132:135], v[40:43], v[208:211]
    v_mfma_f32_16x16x32_bf16 v[212:215], v[204:207], v[40:43], v[212:215]
    v_mfma_f32_16x16x32_bf16 v[216:219], v[132:135], v[44:47], v[216:219]
    v_mfma_f32_16x16x32_bf16 v[220:223], v[204:207], v[44:47], v[220:223]
    v_mfma_f32_16x16x32_bf16 v[224:227], a[68:71], v[40:43], v[224:227]
    v_mfma_f32_16x16x32_bf16 v[228:231], a[140:143], v[40:43], v[228:231]
    v_mfma_f32_16x16x32_bf16 v[232:235], a[68:71], v[44:47], v[232:235]
    v_mfma_f32_16x16x32_bf16 v[236:239], a[140:143], v[44:47], v[236:239]
    s_waitcnt vmcnt(0)
    v_cvt_pk_bf16_f32 v8, v208, v209
    v_cvt_pk_bf16_f32 v9, v210, v211
    v_cvt_pk_bf16_f32 v10, v212, v213
    v_cvt_pk_bf16_f32 v11, v214, v215
    s_lshr_b32 s22, s41, 5
    s_mul_i32 s22, s22, 0
    s_add_u32 s28, s26, s22
    buffer_store_dwordx4 v[8:11], v7, s[4:7], s28 offen sc1
    v_cvt_pk_bf16_f32 v12, v216, v217
    v_cvt_pk_bf16_f32 v13, v218, v219
    v_cvt_pk_bf16_f32 v14, v220, v221
    v_cvt_pk_bf16_f32 v15, v222, v223
    s_lshr_b32 s22, s41, 5
    s_mul_i32 s22, s22, 0
    s_add_u32 s28, s26, s22
    s_add_u32 s28, s28, s40
    buffer_store_dwordx4 v[12:15], v7, s[4:7], s28 offen sc1
    v_cvt_pk_bf16_f32 v16, v224, v225
    v_cvt_pk_bf16_f32 v17, v226, v227
    v_cvt_pk_bf16_f32 v18, v228, v229
    v_cvt_pk_bf16_f32 v19, v230, v231
    s_lshr_b32 s22, s41, 5
    s_mul_i32 s22, s22, 1
    s_add_u32 s28, s26, s22
    buffer_store_dwordx4 v[16:19], v7, s[4:7], s28 offen sc1
    v_cvt_pk_bf16_f32 v20, v232, v233
    v_cvt_pk_bf16_f32 v21, v234, v235
    v_cvt_pk_bf16_f32 v22, v236, v237
    v_cvt_pk_bf16_f32 v23, v238, v239
    s_lshr_b32 s22, s41, 5
    s_mul_i32 s22, s22, 1
    s_add_u32 s28, s26, s22
    s_add_u32 s28, s28, s40
    buffer_store_dwordx4 v[20:23], v7, s[4:7], s28 offen sc1
    s_lshl_b32 s22, s41, 2
    s_add_u32 s26, s26, s22
    s_lshr_b32 s45, s19, 2
    s_cbranch_scc1 qk_loop_nf
    s_waitcnt vmcnt(0)
    s_mov_b32 s45, 1
qk_loop_nf:
    s_add_u32 s27, s27, 36864
    s_cmp_eq_u32 s27, 110592
    s_cselect_b32 s27, 0, s27
    s_add_u32 s19, s19, 4
    s_cmp_lt_u32 s19, s20
    s_cbranch_scc1 qk_loop
    s_branch qk_done
qk_vloop:
    s_barrier
    v_add_u32 v3, s27, v1
    ds_read_b128 v[32:35], v3 offset:0
    ds_read_b128 v[36:39], v3 offset:18432
    ds_read_b128 v[40:43], v3 offset:1024
    ds_read_b128 v[44:47], v3 offset:19456
    ds_read_b128 v[48:51], v3 offset:2048
    ds_read_b128 v[52:55], v3 offset:20480
    s_add_u32 s23, s45, s95
    v_mov_b32 v4, s23
    s_mov_b64 exec, s[34:35]
    buffer_store_dword v4, off, s[4:7], s29 sc1
    buffer_store_dword v4, off, s[4:7], s29 offset:128 sc1
    s_mov_b64 exec, -1
    s_add_u32 s22, s27, 73728
    s_sub_u32 s21, s22, 110592
    s_cselect_b32 s22, s22, s21
    ds_read_b128 v[56:59], v3 offset:3072
    ds_read_b128 v[60:63], v3 offset:21504
    s_add_u32 s23, s22, s25
    s_add_u32 m0, s23, 0
    s_nop 0
    buffer_load_dwordx4 v2, s[8:11], s24 offen offset:0 lds
    s_waitcnt lgkmcnt(6)
    v_mfma_f32_16x16x32_bf16 v[208:211], v[32:35], v[64:67], 0
    v_mfma_f32_16x16x32_bf16 v[212:215], v[32:35], v[136:139], 0
    v_mfma_f32_16x16x32_bf16 v[216:219], v[36:39], v[64:67], 0
    v_mfma_f32_16x16x32_bf16 v[220:223], v[36:39], v[136:139], 0
    v_mfma_f32_16x16x32_bf16 v[224:227], v[32:35], a[0:3], 0
    v_mfma_f32_16x16x32_bf16 v[228:231], v[32:35], a[72:75], 0
    v_mfma_f32_16x16x32_bf16 v[232:235], v[36:39], a[0:3], 0
    v_mfma_f32_16x16x32_bf16 v[236:239], v[36:39], a[72:75], 0
    ds_read_b128 v[32:35], v3 offset:4096
    ds_read_b128 v[36:39], v3 offset:22528
    s_add_u32 m0, s23, 960
    s_nop 0
    buffer_load_dwordx4 v2, s[8:11], s24 offen offset:64 lds
    s_waitcnt lgkmcnt(6)
    v_mfma_f32_16x16x32_bf16 v[208:211], v[40:43], v[68:71], v[208:211]
    v_mfma_f32_16x16x32_bf16 v[212:215], v[40:43], v[140:143], v[212:215]
    v_mfma_f32_16x16x32_bf16 v[216:219], v[44:47], v[68:71], v[216:219]
    v_mfma_f32_16x16x32_bf16 v[220:223], v[44:47], v[140:143], v[220:223]
    v_mfma_f32_16x16x32_bf16 v[224:227], v[40:43], a[4:7], v[224:227]
    v_mfma_f32_16x16x32_bf16 v[228:231], v[40:43], a[76:79], v[228:231]
    v_mfma_f32_16x16x32_bf16 v[232:235], v[44:47], a[4:7], v[232:235]
    v_mfma_f32_16x16x32_bf16 v[236:239], v[44:47], a[76:79], v[236:239]
    ds_read_b128 v[40:43], v3 offset:5120
    ds_read_b128 v[44:47], v3 offset:23552
    s_add_u32 m0, s23, 1920
    s_nop 0
    buffer_load_dwordx4 v2, s[8:11], s24 offen offset:128 lds
    s_waitcnt lgkmcnt(6)
    v_mfma_f32_16x16x32_bf16 v[208:211], v[48:51], v[72:75], v[208:211]
    v_mfma_f32_16x16x32_bf16 v[212:215], v[48:51], v[144:147], v[212:215]
    v_mfma_f32_16x16x32_bf16 v[216:219], v[52:55], v[72:75], v[216:219]
    v_mfma_f32_16x16x32_bf16 v[220:223], v[52:55], v[144:147], v[220:223]
    v_mfma_f32_16x16x32_bf16 v[224:227], v[48:51], a[8:11], v[224:227]
    v_mfma_f32_16x16x32_bf16 v[228:231], v[48:51], a[80:83], v[228:231]
    v_mfma_f32_16x16x32_bf16 v[232:235], v[52:55], a[8:11], v[232:235]
    v_mfma_f32_16x16x32_bf16 v[236:239], v[52:55], a[80:83], v[236:239]
    ds_read_b128 v[48:51], v3 offset:6144
    ds_read_b128 v[52:55], v3 offset:24576
    s_add_u32 m0, s23, 2880
    s_nop 0
    buffer_load_dwordx4 v2, s[8:11], s24 offen offset:192 lds
    s_waitcnt lgkmcnt(6)
    v_mfma_f32_16x16x32_bf16 v[208:211], v[56:59], v[76:79], v[208:211]
    v_mfma_f32_16x16x32_bf16 v[212:215], v[56:59], v[148:151], v[212:215]
    v_mfma_f32_16x16x32_bf16 v[216:219], v[60:63], v[76:79], v[216:219]
    v_mfma_f32_16x16x32_bf16 v[220:223], v[60:63], v[148:151], v[220:223]
    v_mfma_f32_16x16x32_bf16 v[224:227], v[56:59], a[12:15], v[224:227]
    v_mfma_f32_16x16x32_bf16 v[228:231], v[56:59], a[84:87], v[228:231]
    v_mfma_f32_16x16x32_bf16 v[232:235], v[60:63], a[12:15], v[232:235]
    v_mfma_f32_16x16x32_bf16 v[236:239], v[60:63], a[84:87], v[236:239]
    ds_read_b128 v[56:59], v3 offset:7168
    ds_read_b128 v[60:63], v3 offset:25600
    s_add_u32 m0, s23, 3840
    s_nop 0
    buffer_load_dwordx4 v2, s[8:11], s24 offen offset:256 lds
    s_waitcnt lgkmcnt(6)
    v_mfma_f32_16x16x32_bf16 v[208:211], v[32:35], v[80:83], v[208:211]
    v_mfma_f32_16x16x32_bf16 v[212:215], v[32:35], v[152:155], v[212:215]
    v_mfma_f32_16x16x32_bf16 v[216:219], v[36:39], v[80:83], v[216:219]
    v_mfma_f32_16x16x32_bf16 v[220:223], v[36:39], v[152:155], v[220:223]
    v_mfma_f32_16x16x32_bf16 v[224:227], v[32:35], a[16:19], v[224:227]
    v_mfma_f32_16x16x32_bf16 v[228:231], v[32:35], a[88:91], v[228:231]
    v_mfma_f32_16x16x32_bf16 v[232:235], v[36:39], a[16:19], v[232:235]
    v_mfma_f32_16x16x32_bf16 v[236:239], v[36:39], a[88:91], v[236:239]
    ds_read_b128 v[32:35], v3 offset:8192
    ds_read_b128 v[36:39], v3 offset:26624
    s_add_u32 m0, s23, 4800
    s_nop 0
    buffer_load_dwordx4 v2, s[8:11], s24 offen offset:320 lds
    s_waitcnt lgkmcnt(6)
    v_mfma_f32_16x16x32_bf16 v[208:211], v[40:43], v[84:87], v[208:211]
    v_mfma_f32_16x16x32_bf16 v[212:215], v[40:43], v[156:159], v[212:215]
    v_mfma_f32_16x16x32_bf16 v[216:219], v[44:47], v[84:87], v[216:219]
    v_mfma_f32_16x16x32_bf16 v[220:223], v[44:47], v[156:159], v[220:223]
    v_mfma_f32_16x16x32_bf16 v[224:227], v[40:43], a[20:23], v[224:227]
    v_mfma_f32_16x16x32_bf16 v[228:231], v[40:43], a[92:95], v[228:231]
    v_mfma_f32_16x16x32_bf16 v[232:235], v[44:47], a[20:23], v[232:235]
    v_mfma_f32_16x16x32_bf16 v[236:239], v[44:47], a[92:95], v[236:239]
    ds_read_b128 v[40:43], v3 offset:9216
    ds_read_b128 v[44:47], v3 offset:27648
    s_add_u32 m0, s23, 5760
    s_nop 0
    buffer_load_dwordx4 v2, s[8:11], s24 offen offset:384 lds
    s_waitcnt lgkmcnt(6)
    v_mfma_f32_16x16x32_bf16 v[208:211], v[48:51], v[88:91], v[208:211]
    v_mfma_f32_16x16x32_bf16 v[212:215], v[48:51], v[160:163], v[212:215]
    v_mfma_f32_16x16x32_bf16 v[216:219], v[52:55], v[88:91], v[216:219]
    v_mfma_f32_16x16x32_bf16 v[220:223], v[52:55], v[160:163], v[220:223]
    v_mfma_f32_16x16x32_bf16 v[224:227], v[48:51], a[24:27], v[224:227]
    v_mfma_f32_16x16x32_bf16 v[228:231], v[48:51], a[96:99], v[228:231]
    v_mfma_f32_16x16x32_bf16 v[232:235], v[52:55], a[24:27], v[232:235]
    v_mfma_f32_16x16x32_bf16 v[236:239], v[52:55], a[96:99], v[236:239]
    ds_read_b128 v[48:51], v3 offset:10240
    ds_read_b128 v[52:55], v3 offset:28672
    s_add_u32 m0, s23, 6720
    s_nop 0
    buffer_load_dwordx4 v2, s[8:11], s24 offen offset:448 lds
    s_waitcnt lgkmcnt(6)
    v_mfma_f32_16x16x32_bf16 v[208:211], v[56:59], v[92:95], v[208:211]
    v_mfma_f32_16x16x32_bf16 v[212:215], v[56:59], v[164:167], v[212:215]
    v_mfma_f32_16x16x32_bf16 v[216:219], v[60:63], v[92:95], v[216:219]
    v_mfma_f32_16x16x32_bf16 v[220:223], v[60:63], v[164:167], v[220:223]
    v_mfma_f32_16x16x32_bf16 v[224:227], v[56:59], a[28:31], v[224:227]
    v_mfma_f32_16x16x32_bf16 v[228:231], v[56:59], a[100:103], v[228:231]
    v_mfma_f32_16x16x32_bf16 v[232:235], v[60:63], a[28:31], v[232:235]
    v_mfma_f32_16x16x32_bf16 v[236:239], v[60:63], a[100:103], v[236:239]
    ds_read_b128 v[56:59], v3 offset:11264
    ds_read_b128 v[60:63], v3 offset:29696
    s_add_u32 m0, s23, 7680
    s_nop 0
    buffer_load_dwordx4 v2, s[8:11], s24 offen offset:512 lds
    s_add_u32 s24, s24, 147456
    s_waitcnt lgkmcnt(6)
    v_mfma_f32_16x16x32_bf16 v[208:211], v[32:35], v[96:99], v[208:211]
    v_mfma_f32_16x16x32_bf16 v[212:215], v[32:35], v[168:171], v[212:215]
    v_mfma_f32_16x16x32_bf16 v[216:219], v[36:39], v[96:99], v[216:219]
    v_mfma_f32_16x16x32_bf16 v[220:223], v[36:39], v[168:171], v[220:223]
    v_mfma_f32_16x16x32_bf16 v[224:227], v[32:35], a[32:35], v[224:227]
    v_mfma_f32_16x16x32_bf16 v[228:231], v[32:35], a[104:107], v[228:231]
    v_mfma_f32_16x16x32_bf16 v[232:235], v[36:39], a[32:35], v[232:235]
    v_mfma_f32_16x16x32_bf16 v[236:239], v[36:39], a[104:107], v[236:239]
    ds_read_b128 v[32:35], v3 offset:12288
    ds_read_b128 v[36:39], v3 offset:30720
    s_waitcnt lgkmcnt(6)
    v_mfma_f32_16x16x32_bf16 v[208:211], v[40:43], v[100:103], v[208:211]
    v_mfma_f32_16x16x32_bf16 v[212:215], v[40:43], v[172:175], v[212:215]
    v_mfma_f32_16x16x32_bf16 v[216:219], v[44:47], v[100:103], v[216:219]
    v_mfma_f32_16x16x32_bf16 v[220:223], v[44:47], v[172:175], v[220:223]
    v_mfma_f32_16x16x32_bf16 v[224:227], v[40:43], a[36:39], v[224:227]
    v_mfma_f32_16x16x32_bf16 v[228:231], v[40:43], a[108:111], v[228:231]
    v_mfma_f32_16x16x32_bf16 v[232:235], v[44:47], a[36:39], v[232:235]
    v_mfma_f32_16x16x32_bf16 v[236:239], v[44:47], a[108:111], v[236:239]
    ds_read_b128 v[40:43], v3 offset:13312
    ds_read_b128 v[44:47], v3 offset:31744
    s_waitcnt lgkmcnt(6)
    v_mfma_f32_16x16x32_bf16 v[208:211], v[48:51], v[104:107], v[208:211]
    v_mfma_f32_16x16x32_bf16 v[212:215], v[48:51], v[176:179], v[212:215]
    v_mfma_f32_16x16x32_bf16 v[216:219], v[52:55], v[104:107], v[216:219]
    v_mfma_f32_16x16x32_bf16 v[220:223], v[52:55], v[176:179], v[220:223]
    v_mfma_f32_16x16x32_bf16 v[224:227], v[48:51], a[40:43], v[224:227]
    v_mfma_f32_16x16x32_bf16 v[228:231], v[48:51], a[112:115], v[228:231]
    v_mfma_f32_16x16x32_bf16 v[232:235], v[52:55], a[40:43], v[232:235]
    v_mfma_f32_16x16x32_bf16 v[236:239], v[52:55], a[112:115], v[236:239]
    ds_read_b128 v[48:51], v3 offset:14336
    ds_read_b128 v[52:55], v3 offset:32768
    s_waitcnt lgkmcnt(6)
    v_mfma_f32_16x16x32_bf16 v[208:211], v[56:59], v[108:111], v[208:211]
    v_mfma_f32_16x16x32_bf16 v[212:215], v[56:59], v[180:183], v[212:215]
    v_mfma_f32_16x16x32_bf16 v[216:219], v[60:63], v[108:111], v[216:219]
    v_mfma_f32_16x16x32_bf16 v[220:223], v[60:63], v[180:183], v[220:223]
    v_mfma_f32_16x16x32_bf16 v[224:227], v[56:59], a[44:47], v[224:227]
    v_mfma_f32_16x16x32_bf16 v[228:231], v[56:59], a[116:119], v[228:231]
    v_mfma_f32_16x16x32_bf16 v[232:235], v[60:63], a[44:47], v[232:235]
    v_mfma_f32_16x16x32_bf16 v[236:239], v[60:63], a[116:119], v[236:239]
    ds_read_b128 v[56:59], v3 offset:15360
    ds_read_b128 v[60:63], v3 offset:33792
    s_waitcnt lgkmcnt(6)
    v_mfma_f32_16x16x32_bf16 v[208:211], v[32:35], v[112:115], v[208:211]
    v_mfma_f32_16x16x32_bf16 v[212:215], v[32:35], v[184:187], v[212:215]
    v_mfma_f32_16x16x32_bf16 v[216:219], v[36:39], v[112:115], v[216:219]
    v_mfma_f32_16x16x32_bf16 v[220:223], v[36:39], v[184:187], v[220:223]
    v_mfma_f32_16x16x32_bf16 v[224:227], v[32:35], a[48:51], v[224:227]
    v_mfma_f32_16x16x32_bf16 v[228:231], v[32:35], a[120:123], v[228:231]
    v_mfma_f32_16x16x32_bf16 v[232:235], v[36:39], a[48:51], v[232:235]
    v_mfma_f32_16x16x32_bf16 v[236:239], v[36:39], a[120:123], v[236:239]
    ds_read_b128 v[32:35], v3 offset:16384
    ds_read_b128 v[36:39], v3 offset:34816
    s_waitcnt lgkmcnt(6)
    v_mfma_f32_16x16x32_bf16 v[208:211], v[40:43], v[116:119], v[208:211]
    v_mfma_f32_16x16x32_bf16 v[212:215], v[40:43], v[188:191], v[212:215]
    v_mfma_f32_16x16x32_bf16 v[216:219], v[44:47], v[116:119], v[216:219]
    v_mfma_f32_16x16x32_bf16 v[220:223], v[44:47], v[188:191], v[220:223]
    v_mfma_f32_16x16x32_bf16 v[224:227], v[40:43], a[52:55], v[224:227]
    v_mfma_f32_16x16x32_bf16 v[228:231], v[40:43], a[124:127], v[228:231]
    v_mfma_f32_16x16x32_bf16 v[232:235], v[44:47], a[52:55], v[232:235]
    v_mfma_f32_16x16x32_bf16 v[236:239], v[44:47], a[124:127], v[236:239]
    ds_read_b128 v[40:43], v3 offset:17408
    ds_read_b128 v[44:47], v3 offset:35840
    s_waitcnt lgkmcnt(6)
    v_mfma_f32_16x16x32_bf16 v[208:211], v[48:51], v[120:123], v[208:211]
    v_mfma_f32_16x16x32_bf16 v[212:215], v[48:51], v[192:195], v[212:215]
    v_mfma_f32_16x16x32_bf16 v[216:219], v[52:55], v[120:123], v[216:219]
    v_mfma_f32_16x16x32_bf16 v[220:223], v[52:55], v[192:195], v[220:223]
    v_mfma_f32_16x16x32_bf16 v[224:227], v[48:51], a[56:59], v[224:227]
    v_mfma_f32_16x16x32_bf16 v[228:231], v[48:51], a[128:131], v[228:231]
    v_mfma_f32_16x16x32_bf16 v[232:235], v[52:55], a[56:59], v[232:235]
    v_mfma_f32_16x16x32_bf16 v[236:239], v[52:55], a[128:131], v[236:239]
    s_waitcnt lgkmcnt(4)
    v_mfma_f32_16x16x32_bf16 v[208:211], v[56:59], v[124:127], v[208:211]
    v_mfma_f32_16x16x32_bf16 v[212:215], v[56:59], v[196:199], v[212:215]
    v_mfma_f32_16x16x32_bf16 v[216:219], v[60:63], v[124:127], v[216:219]
    v_mfma_f32_16x16x32_bf16 v[220:223], v[60:63], v[196:199], v[220:223]
    v_mfma_f32_16x16x32_bf16 v[224:227], v[56:59], a[60:63], v[224:227]
    v_mfma_f32_16x16x32_bf16 v[228:231], v[56:59], a[132:135], v[228:231]
    v_mfma_f32_16x16x32_bf16 v[232:235], v[60:63], a[60:63], v[232:235]
    v_mfma_f32_16x16x32_bf16 v[236:239], v[60:63], a[132:135], v[236:239]
    s_waitcnt lgkmcnt(2)
    v_mfma_f32_16x16x32_bf16 v[208:211], v[32:35], v[128:131], v[208:211]
    v_mfma_f32_16x16x32_bf16 v[212:215], v[32:35], v[200:203], v[212:215]
    v_mfma_f32_16x16x32_bf16 v[216:219], v[36:39], v[128:131], v[216:219]
    v_mfma_f32_16x16x32_bf16 v[220:223], v[36:39], v[200:203], v[220:223]
    v_mfma_f32_16x16x32_bf16 v[224:227], v[32:35], a[64:67], v[224:227]
    v_mfma_f32_16x16x32_bf16 v[228:231], v[32:35], a[136:139], v[228:231]
    v_mfma_f32_16x16x32_bf16 v[232:235], v[36:39], a[64:67], v[232:235]
    v_mfma_f32_16x16x32_bf16 v[236:239], v[36:39], a[136:139], v[236:239]
    s_waitcnt lgkmcnt(0)
    v_mfma_f32_16x16x32_bf16 v[208:211], v[40:43], v[132:135], v[208:211]
    v_mfma_f32_16x16x32_bf16 v[212:215], v[40:43], v[204:207], v[212:215]
    v_mfma_f32_16x16x32_bf16 v[216:219], v[44:47], v[132:135], v[216:219]
    v_mfma_f32_16x16x32_bf16 v[220:223], v[44:47], v[204:207], v[220:223]
    v_mfma_f32_16x16x32_bf16 v[224:227], v[40:43], a[68:71], v[224:227]
    v_mfma_f32_16x16x32_bf16 v[228:231], v[40:43], a[140:143], v[228:231]
    v_mfma_f32_16x16x32_bf16 v[232:235], v[44:47], a[68:71], v[232:235]
    v_mfma_f32_16x16x32_bf16 v[236:239], v[44:47], a[140:143], v[236:239]
    s_waitcnt vmcnt(0)
    v_cvt_pk_bf16_f32 v8, v208, v209
    v_cvt_pk_bf16_f32 v9, v210, v211
    v_cvt_pk_bf16_f32 v10, v216, v217
    v_cvt_pk_bf16_f32 v11, v218, v219
    s_lshr_b32 s22, s41, 5
    s_mul_i32 s22, s22, 0
    s_add_u32 s28, s26, s22
    buffer_store_dwordx4 v[8:11], v7, s[4:7], s28 offen sc1
    v_cvt_pk_bf16_f32 v12, v212, v213
    v_cvt_pk_bf16_f32 v13, v214, v215
    v_cvt_pk_bf16_f32 v14, v220, v221
    v_cvt_pk_bf16_f32 v15, v222, v223
    s_lshr_b32 s22, s41, 5
    s_mul_i32 s22, s22, 0
    s_add_u32 s28, s26, s22
    s_add_u32 s28, s28, s40
    buffer_store_dwordx4 v[12:15], v7, s[4:7], s28 offen sc1
    v_cvt_pk_bf16_f32 v16, v224, v225
    v_cvt_pk_bf16_f32 v17, v226, v227
    v_cvt_pk_bf16_f32 v18, v232, v233
    v_cvt_pk_bf16_f32 v19, v234, v235
    s_lshr_b32 s22, s41, 5
    s_mul_i32 s22, s22, 1
    s_add_u32 s28, s26, s22
    buffer_store_dwordx4 v[16:19], v7, s[4:7], s28 offen sc1
    v_cvt_pk_bf16_f32 v20, v228, v229
    v_cvt_pk_bf16_f32 v21, v230, v231
    v_cvt_pk_bf16_f32 v22, v236, v237
    v_cvt_pk_bf16_f32 v23, v238, v239
    s_lshr_b32 s22, s41, 5
    s_mul_i32 s22, s22, 1
    s_add_u32 s28, s26, s22
    s_add_u32 s28, s28, s40
    buffer_store_dwordx4 v[20:23], v7, s[4:7], s28 offen sc1
    s_lshl_b32 s22, s41, 2
    s_add_u32 s26, s26, s22
    s_lshr_b32 s45, s19, 2
    s_cbranch_scc1 qk_vloop_nf
    s_waitcnt vmcnt(0)
    s_mov_b32 s45, 1
qk_vloop_nf:
    s_add_u32 s27, s27, 36864
    s_cmp_eq_u32 s27, 110592
    s_cselect_b32 s27, 0, s27
    s_add_u32 s19, s19, 4
    s_cmp_lt_u32 s19, s20
    s_cbranch_scc1 qk_vloop
qk_done:
    s_waitcnt vmcnt(0)
    s_barrier
    s_mov_b32 s45, 16
    s_add_u32 s23, s45, s95
    v_mov_b32 v4, s23
    s_mov_b64 exec, s[34:35]
    buffer_store_dword v4, off, s[4:7], s29 sc1
    buffer_store_dword v4, off, s[4:7], s29 offset:128 sc1
    s_mov_b64 exec, -1
    s_cmp_eq_u32 s16, 0
    s_cbranch_scc1 L_qkv_next
    s_cmp_lg_u32 s19, 64
    s_cbranch_scc1 L_qkv_next
    v_and_b32 v4, 63, v0
    v_and_b32 v2, 7, v4
    v_lshrrev_b32 v5, 4, v4
    v_lshl_add_u32 v2, v5, 3, v2
    v_lshlrev_b32 v2, 4, v2
    v_bfe_u32 v3, v4, 3, 1
    v_mul_u32_u24 v5, 9216, v3
    v_add_u32 v2, v2, v5
    v_mov_b32 v240, 0x05040100
    v_mov_b32 v241, 0x07060302
    v_lshrrev_b32 v5, 5, v4
    v_and_b32 v1, 0xdff, v7
    s_cmp_eq_u32 s16, 2
    s_cbranch_scc1 mk_isv
    v_mov_b32 v5, v3
    v_or_b32 v1, 128, v7
mk_isv:
    v_lshl_add_u32 v1, v5, 17, v1
    s_mov_b32 s28, 0
    s_mov_b32 s19, 2
    s_mov_b32 s24, 138412032
    s_lshl_b32 s26, s17, 12
    s_mov_b32 s21, 69206016
    s_cmp_eq_u32 s16, 2
    s_cselect_b32 s21, 77594624, s21
    s_add_u32 s26, s26, s21
    s_lshl_b32 s29, s17, 7
    s_lshl_b32 s21, s16, 2
    s_add_u32 s29, s29, s21
    s_add_u32 s29, s29, 125829164
mk_loop:
    s_cmp_lg_u32 s18, 0
    s_cbranch_scc1 mk_go
    s_cmp_le_u32 s19, s28
    s_cbranch_scc1 mk_go
    s_mov_b32 s23, 125853696
    s_mov_b32 s21, 4194304
mk_wait:
    buffer_load_dword v4, off, s[4:7], s23 sc1
    s_sub_u32 s21, s21, 1
    s_cbranch_scc1 mk_go
    s_waitcnt vmcnt(0)
    v_readfirstlane_b32 s28, v4
    s_nop 0
    s_sub_u32 s28, s28, s95
    s_cmp_gt_u32 s28, 64
    s_cselect_b32 s28, 0, s28
    s_cmp_le_u32 s19, s28
    s_cbranch_scc1 mk_go
    s_sleep 4
    s_branch mk_wait
mk_go:
    s_barrier
    s_add_u32 s21, s24, 4096
    s_add_u32 s23, s24, 8192
    buffer_load_dwordx4 v[24:27], v2, s[4:7], s24 offen offset:0 sc1
    buffer_load_dwordx4 v[28:31], v2, s[4:7], s24 offen offset:512 sc1
    buffer_load_dwordx4 v[32:35], v2, s[4:7], s21 offen offset:0 sc1
    buffer_load_dwordx4 v[36:39], v2, s[4:7], s21 offen offset:512 sc1
    buffer_load_dwordx4 v[40:43], v2, s[4:7], s24 offen offset:1024 sc1
    buffer_load_dwordx4 v[44:47], v2, s[4:7], s24 offen offset:1536 sc1
    buffer_load_dwordx4 v[48:51], v2, s[4:7], s21 offen offset:1024 sc1
    buffer_load_dwordx4 v[52:55], v2, s[4:7], s21 offen offset:1536 sc1
    buffer_load_dwordx4 v[56:59], v2, s[4:7], s24 offen offset:2048 sc1
    buffer_load_dwordx4 v[60:63], v2, s[4:7], s24 offen offset:2560 sc1
    buffer_load_dwordx4 v[208:211], v2, s[4:7], s21 offen offset:2048 sc1
    buffer_load_dwordx4 v[212:215], v2, s[4:7], s21 offen offset:2560 sc1
    buffer_load_dwordx4 v[216:219], v2, s[4:7], s24 offen offset:3072 sc1
    buffer_load_dwordx4 v[220:223], v2, s[4:7], s24 offen offset:3584 sc1
    buffer_load_dwordx4 v[224:227], v2, s[4:7], s21 offen offset:3072 sc1
    buffer_load_dwordx4 v[228:231], v2, s[4:7], s21 offen offset:3584 sc1
    buffer_load_dwordx4 v[232:235], v2, s[4:7], s23 offen offset:0 sc1
    buffer_load_dwordx4 v[236:239], v2, s[4:7], s23 offen offset:512 sc1
    s_add_u32 s24, s24, 18432
    s_cmp_eq_u32 s16, 2
    s_cbranch_scc1 mk_v
    s_waitcnt vmcnt(17)
    v_perm_b32 v244, v25, v24, v240
    v_perm_b32 v245, v27, v26, v240
    v_perm_b32 v246, v25, v24, v241
    v_perm_b32 v247, v27, v26, v241
    s_waitcnt vmcnt(16)
    v_perm_b32 v248, v29, v28, v240
    v_perm_b32 v249, v31, v30, v240
    v_perm_b32 v250, v29, v28, v241
    v_perm_b32 v251, v31, v30, v241
    v_mfma_f32_16x16x32_bf16 v[8:11], v[64:67], v[244:247], 0
    v_mfma_f32_16x16x32_bf16 v[12:15], v[136:139], v[244:247], 0
    v_mfma_f32_16x16x32_bf16 v[16:19], a[0:3], v[244:247], 0
    v_mfma_f32_16x16x32_bf16 v[20:23], a[72:75], v[244:247], 0
    s_waitcnt vmcnt(15)
    v_perm_b32 v244, v33, v32, v240
    v_perm_b32 v245, v35, v34, v240
    v_perm_b32 v246, v33, v32, v241
    v_perm_b32 v247, v35, v34, v241
    v_mfma_f32_16x16x32_bf16 v[8:11], v[68:71], v[248:251], v[8:11]
    v_mfma_f32_16x16x32_bf16 v[12:15], v[140:143], v[248:251], v[12:15]
    v_mfma_f32_16x16x32_bf16 v[16:19], a[4:7], v[248:251], v[16:19]
    v_mfma_f32_16x16x32_bf16 v[20:23], a[76:79], v[248:251], v[20:23]
    s_waitcnt vmcnt(14)
    v_perm_b32 v248, v37, v36, v240
    v_perm_b32 v249, v39, v38, v240
    v_perm_b32 v250, v37, v36, v241
    v_perm_b32 v251, v39, v38, v241
    v_mfma_f32_16x16x32_bf16 v[8:11], v[72:75], v[244:247], v[8:11]
    v_mfma_f32_16x16x32_bf16 v[12:15], v[144:147], v[244:247], v[12:15]
    v_mfma_f32_16x16x32_bf16 v[16:19], a[8:11], v[244:247], v[16:19]
    v_mfma_f32_16x16x32_bf16 v[20:23], a[80:83], v[244:247], v[20:23]
    s_waitcnt vmcnt(13)
    v_perm_b32 v244, v41, v40, v240
    v_perm_b32 v245, v43, v42, v240
    v_perm_b32 v246, v41, v40, v241
    v_perm_b32 v247, v43, v42, v241
    v_mfma_f32_16x16x32_bf16 v[8:11], v[76:79], v[248:251], v[8:11]
    v_mfma_f32_16x16x32_bf16 v[12:15], v[148:151], v[248:251], v[12:15]
    v_mfma_f32_16x16x32_bf16 v[16:19], a[12:15], v[248:251], v[16:19]
    v_mfma_f32_16x16x32_bf16 v[20:23], a[84:87], v[248:251], v[20:23]
    s_waitcnt vmcnt(12)
    v_perm_b32 v248, v45, v44, v240
    v_perm_b32 v249, v47, v46, v240
    v_perm_b32 v250, v45, v44, v241
    v_perm_b32 v251, v47, v46, v241
    v_mfma_f32_16x16x32_bf16 v[8:11], v[80:83], v[244:247], v[8:11]
    v_mfma_f32_16x16x32_bf16 v[12:15], v[152:155], v[244:247], v[12:15]
    v_mfma_f32_16x16x32_bf16 v[16:19], a[16:19], v[244:247], v[16:19]
    v_mfma_f32_16x16x32_bf16 v[20:23], a[88:91], v[244:247], v[20:23]
    s_waitcnt vmcnt(11)
    v_perm_b32 v244, v49, v48, v240
    v_perm_b32 v245, v51, v50, v240
    v_perm_b32 v246, v49, v48, v241
    v_perm_b32 v247, v51, v50, v241
    v_mfma_f32_16x16x32_bf16 v[8:11], v[84:87], v[248:251], v[8:11]
    v_mfma_f32_16x16x32_bf16 v[12:15], v[156:159], v[248:251], v[12:15]
    v_mfma_f32_16x16x32_bf16 v[16:19], a[20:23], v[248:251], v[16:19]
    v_mfma_f32_16x16x32_bf16 v[20:23], a[92:95], v[248:251], v[20:23]
    s_waitcnt vmcnt(10)
    v_perm_b32 v248, v53, v52, v240
    v_perm_b32 v249, v55, v54, v240
    v_perm_b32 v250, v53, v52, v241
    v_perm_b32 v251, v55, v54, v241
    v_mfma_f32_16x16x32_bf16 v[8:11], v[88:91], v[244:247], v[8:11]
    v_mfma_f32_16x16x32_bf16 v[12:15], v[160:163], v[244:247], v[12:15]
    v_mfma_f32_16x16x32_bf16 v[16:19], a[24:27], v[244:247], v[16:19]
    v_mfma_f32_16x16x32_bf16 v[20:23], a[96:99], v[244:247], v[20:23]
    s_waitcnt vmcnt(9)
    v_perm_b32 v244, v57, v56, v240
    v_perm_b32 v245, v59, v58, v240
    v_perm_b32 v246, v57, v56, v241
    v_perm_b32 v247, v59, v58, v241
    v_mfma_f32_16x16x32_bf16 v[8:11], v[92:95], v[248:251], v[8:11]
    v_mfma_f32_16x16x32_bf16 v[12:15], v[164:167], v[248:251], v[12:15]
    v_mfma_f32_16x16x32_bf16 v[16:19], a[28:31], v[248:251], v[16:19]
    v_mfma_f32_16x16x32_bf16 v[20:23], a[100:103], v[248:251], v[20:23]
    s_waitcnt vmcnt(8)
    v_perm_b32 v248, v61, v60, v240
    v_perm_b32 v249, v63, v62, v240
    v_perm_b32 v250, v61, v60, v241
    v_perm_b32 v251, v63, v62, v241
    v_mfma_f32_16x16x32_bf16 v[8:11], v[96:99], v[244:247], v[8:11]
    v_mfma_f32_16x16x32_bf16 v[12:15], v[168:171], v[244:247], v[12:15]
    v_mfma_f32_16x16x32_bf16 v[16:19], a[32:35], v[244:247], v[16:19]
    v_mfma_f32_16x16x32_bf16 v[20:23], a[104:107], v[244:247], v[20:23]
    s_waitcnt vmcnt(7)
    v_perm_b32 v244, v209, v208, v240
    v_perm_b32 v245, v211, v210, v240
    v_perm_b32 v246, v209, v208, v241
    v_perm_b32 v247, v211, v210, v241
    v_mfma_f32_16x16x32_bf16 v[8:11], v[100:103], v[248:251], v[8:11]
    v_mfma_f32_16x16x32_bf16 v[12:15], v[172:175], v[248:251], v[12:15]
    v_mfma_f32_16x16x32_bf16 v[16:19], a[36:39], v[248:251], v[16:19]
    v_mfma_f32_16x16x32_bf16 v[20:23], a[108:111], v[248:251], v[20:23]
    s_waitcnt vmcnt(6)
    v_perm_b32 v248, v213, v212, v240
    v_perm_b32 v249, v215, v214, v240
    v_perm_b32 v250, v213, v212, v241
    v_perm_b32 v251, v215, v214, v241
    v_mfma_f32_16x16x32_bf16 v[8:11], v[104:107], v[244:247], v[8:11]
    v_mfma_f32_16x16x32_bf16 v[12:15], v[176:179], v[244:247], v[12:15]
    v_mfma_f32_16x16x32_bf16 v[16:19], a[40:43], v[244:247], v[16:19]
    v_mfma_f32_16x16x32_bf16 v[20:23], a[112:115], v[244:247], v[20:23]
    s_waitcnt vmcnt(5)
    v_perm_b32 v244, v217, v216, v240
    v_perm_b32 v245, v219, v218, v240
    v_perm_b32 v246, v217, v216, v241
    v_perm_b32 v247, v219, v218, v241
    v_mfma_f32_16x16x32_bf16 v[8:11], v[108:111], v[248:251], v[8:11]
    v_mfma_f32_16x16x32_bf16 v[12:15], v[180:183], v[248:251], v[12:15]
    v_mfma_f32_16x16x32_bf16 v[16:19], a[44:47], v[248:251], v[16:19]
    v_mfma_f32_16x16x32_bf16 v[20:23], a[116:119], v[248:251], v[20:23]
    s_waitcnt vmcnt(4)
    v_perm_b32 v248, v221, v220, v240
    v_perm_b32 v249, v223, v222, v240
    v_perm_b32 v250, v221, v220, v241
    v_perm_b32 v251, v223, v222, v241
    v_mfma_f32_16x16x32_bf16 v[8:11], v[112:115], v[244:247], v[8:11]
    v_mfma_f32_16x16x32_bf16 v[12:15], v[184:187], v[244:247], v[12:15]
    v_mfma_f32_16x16x32_bf16 v[16:19], a[48:51], v[244:247], v[16:19]
    v_mfma_f32_16x16x32_bf16 v[20:23], a[120:123], v[244:247], v[20:23]
    s_waitcnt vmcnt(3)
    v_perm_b32 v244, v225, v224, v240
    v_perm_b32 v245, v227, v226, v240
    v_perm_b32 v246, v225, v224, v241
    v_perm_b32 v247, v227, v226, v241
    v_mfma_f32_16x16x32_bf16 v[8:11], v[116:119], v[248:251], v[8:11]
    v_mfma_f32_16x16x32_bf16 v[12:15], v[188:191], v[248:251], v[12:15]
    v_mfma_f32_16x16x32_bf16 v[16:19], a[52:55], v[248:251], v[16:19]
    v_mfma_f32_16x16x32_bf16 v[20:23], a[124:127], v[248:251], v[20:23]
    s_waitcnt vmcnt(2)
    v_perm_b32 v248, v229, v228, v240
    v_perm_b32 v249, v231, v230, v240
    v_perm_b32 v250, v229, v228, v241
    v_perm_b32 v251, v231, v230, v241
    v_mfma_f32_16x16x32_bf16 v[8:11], v[120:123], v[244:247], v[8:11]
    v_mfma_f32_16x16x32_bf16 v[12:15], v[192:195], v[244:247], v[12:15]
    v_mfma_f32_16x16x32_bf16 v[16:19], a[56:59], v[244:247], v[16:19]
    v_mfma_f32_16x16x32_bf16 v[20:23], a[128:131], v[244:247], v[20:23]
    s_waitcnt vmcnt(1)
    v_mfma_f32_16x16x32_bf16 v[8:11], v[124:127], v[248:251], v[8:11]
    v_mfma_f32_16x16x32_bf16 v[12:15], v[196:199], v[248:251], v[12:15]
    v_mfma_f32_16x16x32_bf16 v[16:19], a[60:63], v[248:251], v[16:19]
    v_mfma_f32_16x16x32_bf16 v[20:23], a[132:135], v[248:251], v[20:23]
    s_waitcnt vmcnt(0)
    v_mfma_f32_16x16x32_bf16 v[8:11], v[128:131], v[232:235], v[8:11]
    v_mfma_f32_16x16x32_bf16 v[12:15], v[200:203], v[232:235], v[12:15]
    v_mfma_f32_16x16x32_bf16 v[16:19], a[64:67], v[232:235], v[16:19]
    v_mfma_f32_16x16x32_bf16 v[20:23], a[136:139], v[232:235], v[20:23]
    v_mfma_f32_16x16x32_bf16 v[8:11], v[132:135], v[236:239], v[8:11]
    v_mfma_f32_16x16x32_bf16 v[12:15], v[204:207], v[236:239], v[12:15]
    v_mfma_f32_16x16x32_bf16 v[16:19], a[68:71], v[236:239], v[16:19]
    v_mfma_f32_16x16x32_bf16 v[20:23], a[140:143], v[236:239], v[20:23]
    s_nop 7
    s_branch mk_st
mk_v:
    s_waitcnt vmcnt(17)
    v_perm_b32 v244, v25, v24, v240
    v_perm_b32 v245, v27, v26, v240
    v_perm_b32 v246, v25, v24, v241
    v_perm_b32 v247, v27, v26, v241
    s_waitcnt vmcnt(16)
    v_perm_b32 v248, v29, v28, v240
    v_perm_b32 v249, v31, v30, v240
    v_perm_b32 v250, v29, v28, v241
    v_perm_b32 v251, v31, v30, v241
    v_mfma_f32_16x16x32_bf16 v[8:11], v[244:247], v[64:67], 0
    v_mfma_f32_16x16x32_bf16 v[12:15], v[244:247], v[136:139], 0
    v_mfma_f32_16x16x32_bf16 v[16:19], v[244:247], a[0:3], 0
    v_mfma_f32_16x16x32_bf16 v[20:23], v[244:247], a[72:75], 0
    s_waitcnt vmcnt(15)
    v_perm_b32 v244, v33, v32, v240
    v_perm_b32 v245, v35, v34, v240
    v_perm_b32 v246, v33, v32, v241
    v_perm_b32 v247, v35, v34, v241
    v_mfma_f32_16x16x32_bf16 v[8:11], v[248:251], v[68:71], v[8:11]
    v_mfma_f32_16x16x32_bf16 v[12:15], v[248:251], v[140:143], v[12:15]
    v_mfma_f32_16x16x32_bf16 v[16:19], v[248:251], a[4:7], v[16:19]
    v_mfma_f32_16x16x32_bf16 v[20:23], v[248:251], a[76:79], v[20:23]
    s_waitcnt vmcnt(14)
    v_perm_b32 v248, v37, v36, v240
    v_perm_b32 v249, v39, v38, v240
    v_perm_b32 v250, v37, v36, v241
    v_perm_b32 v251, v39, v38, v241
    v_mfma_f32_16x16x32_bf16 v[8:11], v[244:247], v[72:75], v[8:11]
    v_mfma_f32_16x16x32_bf16 v[12:15], v[244:247], v[144:147], v[12:15]
    v_mfma_f32_16x16x32_bf16 v[16:19], v[244:247], a[8:11], v[16:19]
    v_mfma_f32_16x16x32_bf16 v[20:23], v[244:247], a[80:83], v[20:23]
    s_waitcnt vmcnt(13)
    v_perm_b32 v244, v41, v40, v240
    v_perm_b32 v245, v43, v42, v240
    v_perm_b32 v246, v41, v40, v241
    v_perm_b32 v247, v43, v42, v241
    v_mfma_f32_16x16x32_bf16 v[8:11], v[248:251], v[76:79], v[8:11]
    v_mfma_f32_16x16x32_bf16 v[12:15], v[248:251], v[148:151], v[12:15]
    v_mfma_f32_16x16x32_bf16 v[16:19], v[248:251], a[12:15], v[16:19]
    v_mfma_f32_16x16x32_bf16 v[20:23], v[248:251], a[84:87], v[20:23]
    s_waitcnt vmcnt(12)
    v_perm_b32 v248, v45, v44, v240
    v_perm_b32 v249, v47, v46, v240
    v_perm_b32 v250, v45, v44, v241
    v_perm_b32 v251, v47, v46, v241
    v_mfma_f32_16x16x32_bf16 v[8:11], v[244:247], v[80:83], v[8:11]
    v_mfma_f32_16x16x32_bf16 v[12:15], v[244:247], v[152:155], v[12:15]
    v_mfma_f32_16x16x32_bf16 v[16:19], v[244:247], a[16:19], v[16:19]
    v_mfma_f32_16x16x32_bf16 v[20:23], v[244:247], a[88:91], v[20:23]
    s_waitcnt vmcnt(11)
    v_perm_b32 v244, v49, v48, v240
    v_perm_b32 v245, v51, v50, v240
    v_perm_b32 v246, v49, v48, v241
    v_perm_b32 v247, v51, v50, v241
    v_mfma_f32_16x16x32_bf16 v[8:11], v[248:251], v[84:87], v[8:11]
    v_mfma_f32_16x16x32_bf16 v[12:15], v[248:251], v[156:159], v[12:15]
    v_mfma_f32_16x16x32_bf16 v[16:19], v[248:251], a[20:23], v[16:19]
    v_mfma_f32_16x16x32_bf16 v[20:23], v[248:251], a[92:95], v[20:23]
    s_waitcnt vmcnt(10)
    v_perm_b32 v248, v53, v52, v240
    v_perm_b32 v249, v55, v54, v240
    v_perm_b32 v250, v53, v52, v241
    v_perm_b32 v251, v55, v54, v241
    v_mfma_f32_16x16x32_bf16 v[8:11], v[244:247], v[88:91], v[8:11]
    v_mfma_f32_16x16x32_bf16 v[12:15], v[244:247], v[160:163], v[12:15]
    v_mfma_f32_16x16x32_bf16 v[16:19], v[244:247], a[24:27], v[16:19]
    v_mfma_f32_16x16x32_bf16 v[20:23], v[244:247], a[96:99], v[20:23]
    s_waitcnt vmcnt(9)
    v_perm_b32 v244, v57, v56, v240
    v_perm_b32 v245, v59, v58, v240
    v_perm_b32 v246, v57, v56, v241
    v_perm_b32 v247, v59, v58, v241
    v_mfma_f32_16x16x32_bf16 v[8:11], v[248:251], v[92:95], v[8:11]
    v_mfma_f32_16x16x32_bf16 v[12:15], v[248:251], v[164:167], v[12:15]
    v_mfma_f32_16x16x32_bf16 v[16:19], v[248:251], a[28:31], v[16:19]
    v_mfma_f32_16x16x32_bf16 v[20:23], v[248:251], a[100:103], v[20:23]
    s_waitcnt vmcnt(8)
    v_perm_b32 v248, v61, v60, v240
    v_perm_b32 v249, v63, v62, v240
    v_perm_b32 v250, v61, v60, v241
    v_perm_b32 v251, v63, v62, v241
    v_mfma_f32_16x16x32_bf16 v[8:11], v[244:247], v[96:99], v[8:11]
    v_mfma_f32_16x16x32_bf16 v[12:15], v[244:247], v[168:171], v[12:15]
    v_mfma_f32_16x16x32_bf16 v[16:19], v[244:247], a[32:35], v[16:19]
    v_mfma_f32_16x16x32_bf16 v[20:23], v[244:247], a[104:107], v[20:23]
    s_waitcnt vmcnt(7)
    v_perm_b32 v244, v209, v208, v240
    v_perm_b32 v245, v211, v210, v240
    v_perm_b32 v246, v209, v208, v241
    v_perm_b32 v247, v211, v210, v241
    v_mfma_f32_16x16x32_bf16 v[8:11], v[248:251], v[100:103], v[8:11]
    v_mfma_f32_16x16x32_bf16 v[12:15], v[248:251], v[172:175], v[12:15]
    v_mfma_f32_16x16x32_bf16 v[16:19], v[248:251], a[36:39], v[16:19]
    v_mfma_f32_16x16x32_bf16 v[20:23], v[248:251], a[108:111], v[20:23]
    s_waitcnt vmcnt(6)
    v_perm_b32 v248, v213, v212, v240
    v_perm_b32 v249, v215, v214, v240
    v_perm_b32 v250, v213, v212, v241
    v_perm_b32 v251, v215, v214, v241
    v_mfma_f32_16x16x32_bf16 v[8:11], v[244:247], v[104:107], v[8:11]
    v_mfma_f32_16x16x32_bf16 v[12:15], v[244:247], v[176:179], v[12:15]
    v_mfma_f32_16x16x32_bf16 v[16:19], v[244:247], a[40:43], v[16:19]
    v_mfma_f32_16x16x32_bf16 v[20:23], v[244:247], a[112:115], v[20:23]
    s_waitcnt vmcnt(5)
    v_perm_b32 v244, v217, v216, v240
    v_perm_b32 v245, v219, v218, v240
    v_perm_b32 v246, v217, v216, v241
    v_perm_b32 v247, v219, v218, v241
    v_mfma_f32_16x16x32_bf16 v[8:11], v[248:251], v[108:111], v[8:11]
    v_mfma_f32_16x16x32_bf16 v[12:15], v[248:251], v[180:183], v[12:15]
    v_mfma_f32_16x16x32_bf16 v[16:19], v[248:251], a[44:47], v[16:19]
    v_mfma_f32_16x16x32_bf16 v[20:23], v[248:251], a[116:119], v[20:23]
    s_waitcnt vmcnt(4)
    v_perm_b32 v248, v221, v220, v240
    v_perm_b32 v249, v223, v222, v240
    v_perm_b32 v250, v221, v220, v241
    v_perm_b32 v251, v223, v222, v241
    v_mfma_f32_16x16x32_bf16 v[8:11], v[244:247], v[112:115], v[8:11]
    v_mfma_f32_16x16x32_bf16 v[12:15], v[244:247], v[184:187], v[12:15]
    v_mfma_f32_16x16x32_bf16 v[16:19], v[244:247], a[48:51], v[16:19]
    v_mfma_f32_16x16x32_bf16 v[20:23], v[244:247], a[120:123], v[20:23]
    s_waitcnt vmcnt(3)
    v_perm_b32 v244, v225, v224, v240
    v_perm_b32 v245, v227, v226, v240
    v_perm_b32 v246, v225, v224, v241
    v_perm_b32 v247, v227, v226, v241
    v_mfma_f32_16x16x32_bf16 v[8:11], v[248:251], v[116:119], v[8:11]
    v_mfma_f32_16x16x32_bf16 v[12:15], v[248:251], v[188:191], v[12:15]
    v_mfma_f32_16x16x32_bf16 v[16:19], v[248:251], a[52:55], v[16:19]
    v_mfma_f32_16x16x32_bf16 v[20:23], v[248:251], a[124:127], v[20:23]
    s_waitcnt vmcnt(2)
    v_perm_b32 v248, v229, v228, v240
    v_perm_b32 v249, v231, v230, v240
    v_perm_b32 v250, v229, v228, v241
    v_perm_b32 v251, v231, v230, v241
    v_mfma_f32_16x16x32_bf16 v[8:11], v[244:247], v[120:123], v[8:11]
    v_mfma_f32_16x16x32_bf16 v[12:15], v[244:247], v[192:195], v[12:15]
    v_mfma_f32_16x16x32_bf16 v[16:19], v[244:247], a[56:59], v[16:19]
    v_mfma_f32_16x16x32_bf16 v[20:23], v[244:247], a[128:131], v[20:23]
    s_waitcnt vmcnt(1)
    v_mfma_f32_16x16x32_bf16 v[8:11], v[248:251], v[124:127], v[8:11]
    v_mfma_f32_16x16x32_bf16 v[12:15], v[248:251], v[196:199], v[12:15]
    v_mfma_f32_16x16x32_bf16 v[16:19], v[248:251], a[60:63], v[16:19]
    v_mfma_f32_16x16x32_bf16 v[20:23], v[248:251], a[132:135], v[20:23]
    s_waitcnt vmcnt(0)
    v_mfma_f32_16x16x32_bf16 v[8:11], v[232:235], v[128:131], v[8:11]
    v_mfma_f32_16x16x32_bf16 v[12:15], v[232:235], v[200:203], v[12:15]
    v_mfma_f32_16x16x32_bf16 v[16:19], v[232:235], a[64:67], v[16:19]
    v_mfma_f32_16x16x32_bf16 v[20:23], v[232:235], a[136:139], v[20:23]
    v_mfma_f32_16x16x32_bf16 v[8:11], v[236:239], v[132:135], v[8:11]
    v_mfma_f32_16x16x32_bf16 v[12:15], v[236:239], v[204:207], v[12:15]
    v_mfma_f32_16x16x32_bf16 v[16:19], v[236:239], a[68:71], v[16:19]
    v_mfma_f32_16x16x32_bf16 v[20:23], v[236:239], a[140:143], v[20:23]
    s_nop 4
    v_pk_mul_f32 v[8:9], v[8:9], 0.5 op_sel_hi:[1,0]
    v_pk_mul_f32 v[10:11], v[10:11], 0.5 op_sel_hi:[1,0]
    v_pk_mul_f32 v[12:13], v[12:13], 0.5 op_sel_hi:[1,0]
    v_pk_mul_f32 v[14:15], v[14:15], 0.5 op_sel_hi:[1,0]
    v_pk_mul_f32 v[16:17], v[16:17], 0.5 op_sel_hi:[1,0]
    v_pk_mul_f32 v[18:19], v[18:19], 0.5 op_sel_hi:[1,0]
    v_pk_mul_f32 v[20:21], v[20:21], 0.5 op_sel_hi:[1,0]
    v_pk_mul_f32 v[22:23], v[22:23], 0.5 op_sel_hi:[1,0]
mk_st:
    s_nop 1
    v_cvt_pk_bf16_f32 v24, v8, v9
    v_cvt_pk_bf16_f32 v25, v10, v11
    v_cvt_pk_bf16_f32 v26, v12, v13
    v_cvt_pk_bf16_f32 v27, v14, v15
    v_cvt_pk_bf16_f32 v28, v16, v17
    v_cvt_pk_bf16_f32 v29, v18, v19
    v_cvt_pk_bf16_f32 v30, v20, v21
    v_cvt_pk_bf16_f32 v31, v22, v23
    s_add_u32 s21, s26, 4096
    buffer_store_dwordx4 v[24:27], v1, s[4:7], s26 offen sc1
    buffer_store_dwordx4 v[28:31], v1, s[4:7], s21 offen sc1
    s_add_u32 s22, s19, s95
    s_waitcnt vmcnt(0)
    s_barrier
    v_mov_b32 v4, s22
    s_mov_b64 exec, s[34:35]
    buffer_store_dword v4, off, s[4:7], s29 sc1
    buffer_store_dword v4, off, s[4:7], s29 offset:128 sc1
    s_mov_b64 exec, -1
    s_add_u32 s19, s19, 2
    s_add_u32 s26, s26, 262144
    s_cmp_le_u32 s19, 58
    s_cbranch_scc1 mk_loop
    s_endpgm
L_ssm_next:
    s_mov_b32 s37, 8
    v_mov_b32 v250, 1
    v_mov_b32 v251, 163832
    v_cmp_eq_u32 vcc, 0, v0
    s_nop 0
    s_and_saveexec_b64 s[38:39], vcc
    s_cbranch_execz tk6
    buffer_atomic_add v250, off, s[84:87], s37 sc0
    s_waitcnt vmcnt(0)
    ds_write_b32 v251, v250
    s_waitcnt lgkmcnt(0)
tk6:
    s_mov_b64 exec, -1
    s_barrier
    ds_read_b32 v252, v251
    s_waitcnt lgkmcnt(0)
    v_readfirstlane_b32 s20, v252
    s_barrier
    s_nop 3
    s_cmp_ge_u32 s20, 144
    s_cbranch_scc1 L_wf_next
    s_lshl_b32 s20, s20, 2
    v_lshrrev_b32 v5, 6, v0
    s_nop 0
    v_readfirstlane_b32 s21, v5
    v_and_b32 v1, 63, v0
    v_and_b32 v2, 15, v1
    v_lshrrev_b32 v3, 4, v1
    v_lshlrev_b32 v4, 14, v5
    s_mov_b32 s8, s62
    s_mov_b32 s9, s63
    s_mov_b32 s10, 2359296
    s_mov_b32 s11, 0x20000
    s_mov_b32 s16, s76
    s_mov_b32 s17, s77
    s_mov_b32 s18, 4718592
    s_mov_b32 s19, 0x20000
    v_mul_u32_u24 v5, 9216, v0
    s_lshl_b32 s22, s20, 1
    s_add_u32 s23, s22, 0
    buffer_load_dwordx2 v[8:9], v5, s[8:11], s23 offen
    s_add_u32 s23, s22, 1152
    buffer_load_dwordx2 v[10:11], v5, s[8:11], s23 offen
    s_add_u32 s23, s22, 2304
    buffer_load_dwordx2 v[12:13], v5, s[8:11], s23 offen
    s_add_u32 s23, s22, 3456
    buffer_load_dwordx2 v[14:15], v5, s[8:11], s23 offen
    s_add_u32 s23, s22, 4608
    buffer_load_dwordx2 v[16:17], v5, s[8:11], s23 offen
    s_add_u32 s23, s22, 5760
    buffer_load_dwordx2 v[18:19], v5, s[8:11], s23 offen
    s_add_u32 s23, s22, 6912
    buffer_load_dwordx2 v[20:21], v5, s[8:11], s23 offen
    s_add_u32 s23, s22, 8064
    buffer_load_dwordx2 v[22:23], v5, s[8:11], s23 offen
    s_add_u32 s22, s20, s21
    s_lshl_b32 s23, s22, 8
    v_lshlrev_b32 v6, 3, v2
    v_lshl_add_u32 v6, v3, 1, v6
    s_mov_b32 s12, s64
    s_mov_b32 s13, s65
    s_mov_b32 s14, 147456
    s_mov_b32 s15, 0x20000
    buffer_load_ushort v24, v6, s[12:15], s23 offen offset:0
    buffer_load_ushort v28, v6, s[12:15], s23 offen offset:128
    s_mov_b32 s12, s66
    s_mov_b32 s13, s67
    s_mov_b32 s14, 147456
    s_mov_b32 s15, 0x20000
    buffer_load_ushort v25, v6, s[12:15], s23 offen offset:0
    buffer_load_ushort v29, v6, s[12:15], s23 offen offset:128
    s_mov_b32 s12, s68
    s_mov_b32 s13, s69
    s_mov_b32 s14, 147456
    s_mov_b32 s15, 0x20000
    buffer_load_ushort v26, v6, s[12:15], s23 offen offset:0
    buffer_load_ushort v30, v6, s[12:15], s23 offen offset:128
    s_mov_b32 s12, s70
    s_mov_b32 s13, s71
    s_mov_b32 s14, 147456
    s_mov_b32 s15, 0x20000
    buffer_load_ushort v27, v6, s[12:15], s23 offen offset:0
    buffer_load_ushort v31, v6, s[12:15], s23 offen offset:128
    s_mov_b32 s12, s72
    s_mov_b32 s13, s73
    s_mov_b32 s14, 1152
    s_mov_b32 s15, 0x20000
    s_lshl_b32 s23, s22, 1
    buffer_load_ushort v32, off, s[12:15], s23
    s_mov_b32 s26, 0x3fb8aa3b
    s_mov_b32 s27, 0x3e22f983
    v_mov_b32 v34, 0
    v_mov_b32 v35, 0
    v_lshl_add_u32 v6, v1, 3, v4
    ds_write_b64 v6, v[34:35] offset:0
    s_waitcnt vmcnt(0)
    v_mov_b32 v36, 0x05040100
    v_mov_b32 v37, 0x07060302
    v_lshlrev_b32 v6, 4, v0
    v_perm_b32 v40, v10, v8, v36
    v_perm_b32 v41, v14, v12, v36
    v_perm_b32 v42, v18, v16, v36
    v_perm_b32 v43, v22, v20, v36
    ds_write_b128 v6, v[40:43] offset:512
    s_nop 1
    v_perm_b32 v40, v10, v8, v37
    v_perm_b32 v41, v14, v12, v37
    v_perm_b32 v42, v18, v16, v37
    v_perm_b32 v43, v22, v20, v37
    ds_write_b128 v6, v[40:43] offset:16896
    s_nop 1
    v_perm_b32 v40, v11, v9, v36
    v_perm_b32 v41, v15, v13, v36
    v_perm_b32 v42, v19, v17, v36
    v_perm_b32 v43, v23, v21, v36
    ds_write_b128 v6, v[40:43] offset:33280
    s_nop 1
    v_perm_b32 v40, v11, v9, v37
    v_perm_b32 v41, v15, v13, v37
    v_perm_b32 v42, v19, v17, v37
    v_perm_b32 v43, v23, v21, v37
    ds_write_b128 v6, v[40:43] offset:49664
    s_nop 1
    v_lshlrev_b32 v32, 16, v32
    v_mul_f32 v32, s26, v32
    v_exp_f32 v32, v32
    s_nop 0
    v_cvt_pk_bf16_f32 v32, v32, v32
    v_and_b32 v32, 0xffff0000, v32
    v_add_f32 v33, v32, v32
    v_lshlrev_b32 v24, 16, v24
    v_mul_f32 v24, s26, v24
    v_exp_f32 v24, v24
    s_nop 0
    v_cvt_pk_bf16_f32 v24, v24, v24
    v_and_b32 v24, 0xffff0000, v24
    v_mul_f32 v24, v24, v32
    v_mul_f32 v24, s26, v24
    v_sub_f32 v24, 0, v24
    v_lshlrev_b32 v25, 16, v25
    v_mul_f32 v25, v25, v32
    v_mul_f32 v25, s27, v25
    v_lshlrev_b32 v26, 16, v26
    v_mul_f32 v26, v26, v33
    v_lshlrev_b32 v27, 16, v27
    v_mul_f32 v27, v27, v33
    v_lshlrev_b32 v28, 16, v28
    v_mul_f32 v28, s26, v28
    v_exp_f32 v28, v28
    s_nop 0
    v_cvt_pk_bf16_f32 v28, v28, v28
    v_and_b32 v28, 0xffff0000, v28
    v_mul_f32 v28, v28, v32
    v_mul_f32 v28, s26, v28
    v_sub_f32 v28, 0, v28
    v_lshlrev_b32 v29, 16, v29
    v_mul_f32 v29, v29, v32
    v_mul_f32 v29, s27, v29
    v_lshlrev_b32 v30, 16, v30
    v_mul_f32 v30, v30, v33
    v_lshlrev_b32 v31, 16, v31
    v_mul_f32 v31, v31, v33
    v_cvt_f32_u32 v47, v2
    v_mul_f32 v44, 0x41800000, v47
    v_and_b32 v5, 7, v2
    v_add_u32 v5, 8, v5
    v_cvt_f32_u32 v5, v5
    v_mul_f32 v45, 0x42000000, v5
    v_mul_f32 v6, 0x42800000, v5
    v_cmp_lt_u32 vcc, 7, v2
    s_nop 1
    v_cndmask_b32 v45, v45, v6, vcc
    v_add_f32 v5, 0x41000000, v47
    v_mul_f32 v46, 0x43000000, v5
    v_mov_b32 v48, 0
    v_mov_b32 v49, 0
    v_mov_b32 v50, 0
    v_mov_b32 v51, 0
    v_mov_b32 v52, 0
    v_mov_b32 v53, 0
    v_mov_b32 v54, 0
    v_mov_b32 v55, 0
    v_mov_b32 v56, 0
    v_mov_b32 v57, 0
    v_mov_b32 v58, 0
    v_mov_b32 v59, 0
    v_mov_b32 v60, 0
    v_mov_b32 v61, 0
    v_mov_b32 v62, 0
    v_mov_b32 v63, 0
    v_mov_b32_dpp v64, v24 row_newbcast:0 row_mask:0xf bank_mask:0xf
    v_mov_b32_dpp v65, v25 row_newbcast:0 row_mask:0xf bank_mask:0xf
    v_mov_b32_dpp v66, v26 row_newbcast:0 row_mask:0xf bank_mask:0xf
    v_mov_b32_dpp v67, v27 row_newbcast:0 row_mask:0xf bank_mask:0xf
    v_mul_f32 v82, v64, v47
    v_mul_f32 v83, v65, v47
    v_exp_f32 v82, v82
    v_fract_f32 v83, v83
    v_cos_f32 v74, v83
    v_sin_f32 v75, v83
    v_mul_f32 v74, v74, v82
    v_mul_f32 v75, v75, v82
    v_mul_f32 v84, v75, v75
    v_add_f32 v85, v74, v74
    v_fma_f32 v76, v74, v74, -v84
    v_mul_f32 v77, v85, v75
    v_mul_f32 v84, v77, v77
    v_add_f32 v85, v76, v76
    v_fma_f32 v78, v76, v76, -v84
    v_mul_f32 v79, v85, v77
    v_mul_f32 v84, v79, v79
    v_add_f32 v85, v78, v78
    v_fma_f32 v80, v78, v78, -v84
    v_mul_f32 v81, v85, v79
    v_mul_f32 v82, v64, v44
    v_mul_f32 v83, v65, v44
    v_exp_f32 v82, v82
    v_fract_f32 v83, v83
    v_cos_f32 v68, v83
    v_sin_f32 v69, v83
    v_mul_f32 v68, v68, v82
    v_mul_f32 v69, v69, v82
    v_mul_f32 v84, v67, v69
    v_mul_f32 v85, v67, v68
    v_fma_f32 v68, v66, v68, -v84
    v_fma_f32 v69, -v66, v69, -v85
    v_mul_f32 v82, v64, v45
    v_mul_f32 v83, v65, v45
    v_exp_f32 v82, v82
    v_fract_f32 v83, v83
    v_cos_f32 v70, v83
    v_sin_f32 v71, v83
    v_mul_f32 v70, v70, v82
    v_mul_f32 v71, v71, v82
    v_mul_f32 v84, v67, v71
    v_mul_f32 v85, v67, v70
    v_fma_f32 v70, v66, v70, -v84
    v_fma_f32 v71, -v66, v71, -v85
    v_mul_f32 v82, v64, v46
    v_mul_f32 v83, v65, v46
    v_exp_f32 v82, v82
    v_fract_f32 v83, v83
    v_cos_f32 v72, v83
    v_sin_f32 v73, v83
    v_mul_f32 v72, v72, v82
    v_mul_f32 v73, v73, v82
    v_mul_f32 v84, v67, v73
    v_mul_f32 v85, v67, v72
    v_fma_f32 v72, v66, v72, -v84
    v_fma_f32 v73, -v66, v73, -v85
    v_mfma_f32_16x16x4_f32 v[48:51], v68, v74, v[48:51]
    v_mfma_f32_16x16x4_f32 v[52:55], v70, v76, v[52:55]
    v_mfma_f32_16x16x4_f32 v[56:59], v70, v78, v[56:59]
    v_mfma_f32_16x16x4_f32 v[60:63], v72, v80, v[60:63]
    v_mfma_f32_16x16x4_f32 v[48:51], v69, v75, v[48:51]
    v_mfma_f32_16x16x4_f32 v[52:55], v71, v77, v[52:55]
    v_mfma_f32_16x16x4_f32 v[56:59], v71, v79, v[56:59]
    v_mfma_f32_16x16x4_f32 v[60:63], v73, v81, v[60:63]
    v_mov_b32_dpp v64, v24 row_newbcast:1 row_mask:0xf bank_mask:0xf
    v_mov_b32_dpp v65, v25 row_newbcast:1 row_mask:0xf bank_mask:0xf
    v_mov_b32_dpp v66, v26 row_newbcast:1 row_mask:0xf bank_mask:0xf
    v_mov_b32_dpp v67, v27 row_newbcast:1 row_mask:0xf bank_mask:0xf
    v_mul_f32 v82, v64, v47
    v_mul_f32 v83, v65, v47
    v_exp_f32 v82, v82
    v_fract_f32 v83, v83
    v_cos_f32 v74, v83
    v_sin_f32 v75, v83
    v_mul_f32 v74, v74, v82
    v_mul_f32 v75, v75, v82
    v_mul_f32 v84, v75, v75
    v_add_f32 v85, v74, v74
    v_fma_f32 v76, v74, v74, -v84
    v_mul_f32 v77, v85, v75
    v_mul_f32 v84, v77, v77
    v_add_f32 v85, v76, v76
    v_fma_f32 v78, v76, v76, -v84
    v_mul_f32 v79, v85, v77
    v_mul_f32 v84, v79, v79
    v_add_f32 v85, v78, v78
    v_fma_f32 v80, v78, v78, -v84
    v_mul_f32 v81, v85, v79
    v_mul_f32 v82, v64, v44
    v_mul_f32 v83, v65, v44
    v_exp_f32 v82, v82
    v_fract_f32 v83, v83
    v_cos_f32 v68, v83
    v_sin_f32 v69, v83
    v_mul_f32 v68, v68, v82
    v_mul_f32 v69, v69, v82
    v_mul_f32 v84, v67, v69
    v_mul_f32 v85, v67, v68
    v_fma_f32 v68, v66, v68, -v84
    v_fma_f32 v69, -v66, v69, -v85
    v_mul_f32 v82, v64, v45
    v_mul_f32 v83, v65, v45
    v_exp_f32 v82, v82
    v_fract_f32 v83, v83
    v_cos_f32 v70, v83
    v_sin_f32 v71, v83
    v_mul_f32 v70, v70, v82
    v_mul_f32 v71, v71, v82
    v_mul_f32 v84, v67, v71
    v_mul_f32 v85, v67, v70
    v_fma_f32 v70, v66, v70, -v84
    v_fma_f32 v71, -v66, v71, -v85
    v_mul_f32 v82, v64, v46
    v_mul_f32 v83, v65, v46
    v_exp_f32 v82, v82
    v_fract_f32 v83, v83
    v_cos_f32 v72, v83
    v_sin_f32 v73, v83
    v_mul_f32 v72, v72, v82
    v_mul_f32 v73, v73, v82
    v_mul_f32 v84, v67, v73
    v_mul_f32 v85, v67, v72
    v_fma_f32 v72, v66, v72, -v84
    v_fma_f32 v73, -v66, v73, -v85
    v_mfma_f32_16x16x4_f32 v[48:51], v68, v74, v[48:51]
    v_mfma_f32_16x16x4_f32 v[52:55], v70, v76, v[52:55]
    v_mfma_f32_16x16x4_f32 v[56:59], v70, v78, v[56:59]
    v_mfma_f32_16x16x4_f32 v[60:63], v72, v80, v[60:63]
    v_mfma_f32_16x16x4_f32 v[48:51], v69, v75, v[48:51]
    v_mfma_f32_16x16x4_f32 v[52:55], v71, v77, v[52:55]
    v_mfma_f32_16x16x4_f32 v[56:59], v71, v79, v[56:59]
    v_mfma_f32_16x16x4_f32 v[60:63], v73, v81, v[60:63]
    v_mov_b32_dpp v64, v24 row_newbcast:2 row_mask:0xf bank_mask:0xf
    v_mov_b32_dpp v65, v25 row_newbcast:2 row_mask:0xf bank_mask:0xf
    v_mov_b32_dpp v66, v26 row_newbcast:2 row_mask:0xf bank_mask:0xf
    v_mov_b32_dpp v67, v27 row_newbcast:2 row_mask:0xf bank_mask:0xf
    v_mul_f32 v82, v64, v47
    v_mul_f32 v83, v65, v47
    v_exp_f32 v82, v82
    v_fract_f32 v83, v83
    v_cos_f32 v74, v83
    v_sin_f32 v75, v83
    v_mul_f32 v74, v74, v82
    v_mul_f32 v75, v75, v82
    v_mul_f32 v84, v75, v75
    v_add_f32 v85, v74, v74
    v_fma_f32 v76, v74, v74, -v84
    v_mul_f32 v77, v85, v75
    v_mul_f32 v84, v77, v77
    v_add_f32 v85, v76, v76
    v_fma_f32 v78, v76, v76, -v84
    v_mul_f32 v79, v85, v77
    v_mul_f32 v84, v79, v79
    v_add_f32 v85, v78, v78
    v_fma_f32 v80, v78, v78, -v84
    v_mul_f32 v81, v85, v79
    v_mul_f32 v82, v64, v44
    v_mul_f32 v83, v65, v44
    v_exp_f32 v82, v82
    v_fract_f32 v83, v83
    v_cos_f32 v68, v83
    v_sin_f32 v69, v83
    v_mul_f32 v68, v68, v82
    v_mul_f32 v69, v69, v82
    v_mul_f32 v84, v67, v69
    v_mul_f32 v85, v67, v68
    v_fma_f32 v68, v66, v68, -v84
    v_fma_f32 v69, -v66, v69, -v85
    v_mul_f32 v82, v64, v45
    v_mul_f32 v83, v65, v45
    v_exp_f32 v82, v82
    v_fract_f32 v83, v83
    v_cos_f32 v70, v83
    v_sin_f32 v71, v83
    v_mul_f32 v70, v70, v82
    v_mul_f32 v71, v71, v82
    v_mul_f32 v84, v67, v71
    v_mul_f32 v85, v67, v70
    v_fma_f32 v70, v66, v70, -v84
    v_fma_f32 v71, -v66, v71, -v85
    v_mul_f32 v82, v64, v46
    v_mul_f32 v83, v65, v46
    v_exp_f32 v82, v82
    v_fract_f32 v83, v83
    v_cos_f32 v72, v83
    v_sin_f32 v73, v83
    v_mul_f32 v72, v72, v82
    v_mul_f32 v73, v73, v82
    v_mul_f32 v84, v67, v73
    v_mul_f32 v85, v67, v72
    v_fma_f32 v72, v66, v72, -v84
    v_fma_f32 v73, -v66, v73, -v85
    v_mfma_f32_16x16x4_f32 v[48:51], v68, v74, v[48:51]
    v_mfma_f32_16x16x4_f32 v[52:55], v70, v76, v[52:55]
    v_mfma_f32_16x16x4_f32 v[56:59], v70, v78, v[56:59]
    v_mfma_f32_16x16x4_f32 v[60:63], v72, v80, v[60:63]
    v_mfma_f32_16x16x4_f32 v[48:51], v69, v75, v[48:51]
    v_mfma_f32_16x16x4_f32 v[52:55], v71, v77, v[52:55]
    v_mfma_f32_16x16x4_f32 v[56:59], v71, v79, v[56:59]
    v_mfma_f32_16x16x4_f32 v[60:63], v73, v81, v[60:63]
    v_mov_b32_dpp v64, v24 row_newbcast:3 row_mask:0xf bank_mask:0xf
    v_mov_b32_dpp v65, v25 row_newbcast:3 row_mask:0xf bank_mask:0xf
    v_mov_b32_dpp v66, v26 row_newbcast:3 row_mask:0xf bank_mask:0xf
    v_mov_b32_dpp v67, v27 row_newbcast:3 row_mask:0xf bank_mask:0xf
    v_mul_f32 v82, v64, v47
    v_mul_f32 v83, v65, v47
    v_exp_f32 v82, v82
    v_fract_f32 v83, v83
    v_cos_f32 v74, v83
    v_sin_f32 v75, v83
    v_mul_f32 v74, v74, v82
    v_mul_f32 v75, v75, v82
    v_mul_f32 v84, v75, v75
    v_add_f32 v85, v74, v74
    v_fma_f32 v76, v74, v74, -v84
    v_mul_f32 v77, v85, v75
    v_mul_f32 v84, v77, v77
    v_add_f32 v85, v76, v76
    v_fma_f32 v78, v76, v76, -v84
    v_mul_f32 v79, v85, v77
    v_mul_f32 v84, v79, v79
    v_add_f32 v85, v78, v78
    v_fma_f32 v80, v78, v78, -v84
    v_mul_f32 v81, v85, v79
    v_mul_f32 v82, v64, v44
    v_mul_f32 v83, v65, v44
    v_exp_f32 v82, v82
    v_fract_f32 v83, v83
    v_cos_f32 v68, v83
    v_sin_f32 v69, v83
    v_mul_f32 v68, v68, v82
    v_mul_f32 v69, v69, v82
    v_mul_f32 v84, v67, v69
    v_mul_f32 v85, v67, v68
    v_fma_f32 v68, v66, v68, -v84
    v_fma_f32 v69, -v66, v69, -v85
    v_mul_f32 v82, v64, v45
    v_mul_f32 v83, v65, v45
    v_exp_f32 v82, v82
    v_fract_f32 v83, v83
    v_cos_f32 v70, v83
    v_sin_f32 v71, v83
    v_mul_f32 v70, v70, v82
    v_mul_f32 v71, v71, v82
    v_mul_f32 v84, v67, v71
    v_mul_f32 v85, v67, v70
    v_fma_f32 v70, v66, v70, -v84
    v_fma_f32 v71, -v66, v71, -v85
    v_mul_f32 v82, v64, v46
    v_mul_f32 v83, v65, v46
    v_exp_f32 v82, v82
    v_fract_f32 v83, v83
    v_cos_f32 v72, v83
    v_sin_f32 v73, v83
    v_mul_f32 v72, v72, v82
    v_mul_f32 v73, v73, v82
    v_mul_f32 v84, v67, v73
    v_mul_f32 v85, v67, v72
    v_fma_f32 v72, v66, v72, -v84
    v_fma_f32 v73, -v66, v73, -v85
    v_mfma_f32_16x16x4_f32 v[48:51], v68, v74, v[48:51]
    v_mfma_f32_16x16x4_f32 v[52:55], v70, v76, v[52:55]
    v_mfma_f32_16x16x4_f32 v[56:59], v70, v78, v[56:59]
    v_mfma_f32_16x16x4_f32 v[60:63], v72, v80, v[60:63]
    v_mfma_f32_16x16x4_f32 v[48:51], v69, v75, v[48:51]
    v_mfma_f32_16x16x4_f32 v[52:55], v71, v77, v[52:55]
    v_mfma_f32_16x16x4_f32 v[56:59], v71, v79, v[56:59]
    v_mfma_f32_16x16x4_f32 v[60:63], v73, v81, v[60:63]
    v_mov_b32_dpp v64, v24 row_newbcast:4 row_mask:0xf bank_mask:0xf
    v_mov_b32_dpp v65, v25 row_newbcast:4 row_mask:0xf bank_mask:0xf
    v_mov_b32_dpp v66, v26 row_newbcast:4 row_mask:0xf bank_mask:0xf
    v_mov_b32_dpp v67, v27 row_newbcast:4 row_mask:0xf bank_mask:0xf
    v_mul_f32 v82, v64, v47
    v_mul_f32 v83, v65, v47
    v_exp_f32 v82, v82
    v_fract_f32 v83, v83
    v_cos_f32 v74, v83
    v_sin_f32 v75, v83
    v_mul_f32 v74, v74, v82
    v_mul_f32 v75, v75, v82
    v_mul_f32 v84, v75, v75
    v_add_f32 v85, v74, v74
    v_fma_f32 v76, v74, v74, -v84
    v_mul_f32 v77, v85, v75
    v_mul_f32 v84, v77, v77
    v_add_f32 v85, v76, v76
    v_fma_f32 v78, v76, v76, -v84
    v_mul_f32 v79, v85, v77
    v_mul_f32 v84, v79, v79
    v_add_f32 v85, v78, v78
    v_fma_f32 v80, v78, v78, -v84
    v_mul_f32 v81, v85, v79
    v_mul_f32 v82, v64, v44
    v_mul_f32 v83, v65, v44
    v_exp_f32 v82, v82
    v_fract_f32 v83, v83
    v_cos_f32 v68, v83
    v_sin_f32 v69, v83
    v_mul_f32 v68, v68, v82
    v_mul_f32 v69, v69, v82
    v_mul_f32 v84, v67, v69
    v_mul_f32 v85, v67, v68
    v_fma_f32 v68, v66, v68, -v84
    v_fma_f32 v69, -v66, v69, -v85
    v_mul_f32 v82, v64, v45
    v_mul_f32 v83, v65, v45
    v_exp_f32 v82, v82
    v_fract_f32 v83, v83
    v_cos_f32 v70, v83
    v_sin_f32 v71, v83
    v_mul_f32 v70, v70, v82
    v_mul_f32 v71, v71, v82
    v_mul_f32 v84, v67, v71
    v_mul_f32 v85, v67, v70
    v_fma_f32 v70, v66, v70, -v84
    v_fma_f32 v71, -v66, v71, -v85
    v_mul_f32 v82, v64, v46
    v_mul_f32 v83, v65, v46
    v_exp_f32 v82, v82
    v_fract_f32 v83, v83
    v_cos_f32 v72, v83
    v_sin_f32 v73, v83
    v_mul_f32 v72, v72, v82
    v_mul_f32 v73, v73, v82
    v_mul_f32 v84, v67, v73
    v_mul_f32 v85, v67, v72
    v_fma_f32 v72, v66, v72, -v84
    v_fma_f32 v73, -v66, v73, -v85
    v_mfma_f32_16x16x4_f32 v[48:51], v68, v74, v[48:51]
    v_mfma_f32_16x16x4_f32 v[52:55], v70, v76, v[52:55]
    v_mfma_f32_16x16x4_f32 v[56:59], v70, v78, v[56:59]
    v_mfma_f32_16x16x4_f32 v[60:63], v72, v80, v[60:63]
    v_mfma_f32_16x16x4_f32 v[48:51], v69, v75, v[48:51]
    v_mfma_f32_16x16x4_f32 v[52:55], v71, v77, v[52:55]
    v_mfma_f32_16x16x4_f32 v[56:59], v71, v79, v[56:59]
    v_mfma_f32_16x16x4_f32 v[60:63], v73, v81, v[60:63]
    v_mov_b32_dpp v64, v24 row_newbcast:5 row_mask:0xf bank_mask:0xf
    v_mov_b32_dpp v65, v25 row_newbcast:5 row_mask:0xf bank_mask:0xf
    v_mov_b32_dpp v66, v26 row_newbcast:5 row_mask:0xf bank_mask:0xf
    v_mov_b32_dpp v67, v27 row_newbcast:5 row_mask:0xf bank_mask:0xf
    v_mul_f32 v82, v64, v47
    v_mul_f32 v83, v65, v47
    v_exp_f32 v82, v82
    v_fract_f32 v83, v83
    v_cos_f32 v74, v83
    v_sin_f32 v75, v83
    v_mul_f32 v74, v74, v82
    v_mul_f32 v75, v75, v82
    v_mul_f32 v84, v75, v75
    v_add_f32 v85, v74, v74
    v_fma_f32 v76, v74, v74, -v84
    v_mul_f32 v77, v85, v75
    v_mul_f32 v84, v77, v77
    v_add_f32 v85, v76, v76
    v_fma_f32 v78, v76, v76, -v84
    v_mul_f32 v79, v85, v77
    v_mul_f32 v84, v79, v79
    v_add_f32 v85, v78, v78
    v_fma_f32 v80, v78, v78, -v84
    v_mul_f32 v81, v85, v79
    v_mul_f32 v82, v64, v44
    v_mul_f32 v83, v65, v44
    v_exp_f32 v82, v82
    v_fract_f32 v83, v83
    v_cos_f32 v68, v83
    v_sin_f32 v69, v83
    v_mul_f32 v68, v68, v82
    v_mul_f32 v69, v69, v82
    v_mul_f32 v84, v67, v69
    v_mul_f32 v85, v67, v68
    v_fma_f32 v68, v66, v68, -v84
    v_fma_f32 v69, -v66, v69, -v85
    v_mul_f32 v82, v64, v45
    v_mul_f32 v83, v65, v45
    v_exp_f32 v82, v82
    v_fract_f32 v83, v83
    v_cos_f32 v70, v83
    v_sin_f32 v71, v83
    v_mul_f32 v70, v70, v82
    v_mul_f32 v71, v71, v82
    v_mul_f32 v84, v67, v71
    v_mul_f32 v85, v67, v70
    v_fma_f32 v70, v66, v70, -v84
    v_fma_f32 v71, -v66, v71, -v85
    v_mul_f32 v82, v64, v46
    v_mul_f32 v83, v65, v46
    v_exp_f32 v82, v82
    v_fract_f32 v83, v83
    v_cos_f32 v72, v83
    v_sin_f32 v73, v83
    v_mul_f32 v72, v72, v82
    v_mul_f32 v73, v73, v82
    v_mul_f32 v84, v67, v73
    v_mul_f32 v85, v67, v72
    v_fma_f32 v72, v66, v72, -v84
    v_fma_f32 v73, -v66, v73, -v85
    v_mfma_f32_16x16x4_f32 v[48:51], v68, v74, v[48:51]
    v_mfma_f32_16x16x4_f32 v[52:55], v70, v76, v[52:55]
    v_mfma_f32_16x16x4_f32 v[56:59], v70, v78, v[56:59]
    v_mfma_f32_16x16x4_f32 v[60:63], v72, v80, v[60:63]
    v_mfma_f32_16x16x4_f32 v[48:51], v69, v75, v[48:51]
    v_mfma_f32_16x16x4_f32 v[52:55], v71, v77, v[52:55]
    v_mfma_f32_16x16x4_f32 v[56:59], v71, v79, v[56:59]
    v_mfma_f32_16x16x4_f32 v[60:63], v73, v81, v[60:63]
    v_mov_b32_dpp v64, v24 row_newbcast:6 row_mask:0xf bank_mask:0xf
    v_mov_b32_dpp v65, v25 row_newbcast:6 row_mask:0xf bank_mask:0xf
    v_mov_b32_dpp v66, v26 row_newbcast:6 row_mask:0xf bank_mask:0xf
    v_mov_b32_dpp v67, v27 row_newbcast:6 row_mask:0xf bank_mask:0xf
    v_mul_f32 v82, v64, v47
    v_mul_f32 v83, v65, v47
    v_exp_f32 v82, v82
    v_fract_f32 v83, v83
    v_cos_f32 v74, v83
    v_sin_f32 v75, v83
    v_mul_f32 v74, v74, v82
    v_mul_f32 v75, v75, v82
    v_mul_f32 v84, v75, v75
    v_add_f32 v85, v74, v74
    v_fma_f32 v76, v74, v74, -v84
    v_mul_f32 v77, v85, v75
    v_mul_f32 v84, v77, v77
    v_add_f32 v85, v76, v76
    v_fma_f32 v78, v76, v76, -v84
    v_mul_f32 v79, v85, v77
    v_mul_f32 v84, v79, v79
    v_add_f32 v85, v78, v78
    v_fma_f32 v80, v78, v78, -v84
    v_mul_f32 v81, v85, v79
    v_mul_f32 v82, v64, v44
    v_mul_f32 v83, v65, v44
    v_exp_f32 v82, v82
    v_fract_f32 v83, v83
    v_cos_f32 v68, v83
    v_sin_f32 v69, v83
    v_mul_f32 v68, v68, v82
    v_mul_f32 v69, v69, v82
    v_mul_f32 v84, v67, v69
    v_mul_f32 v85, v67, v68
    v_fma_f32 v68, v66, v68, -v84
    v_fma_f32 v69, -v66, v69, -v85
    v_mul_f32 v82, v64, v45
    v_mul_f32 v83, v65, v45
    v_exp_f32 v82, v82
    v_fract_f32 v83, v83
    v_cos_f32 v70, v83
    v_sin_f32 v71, v83
    v_mul_f32 v70, v70, v82
    v_mul_f32 v71, v71, v82
    v_mul_f32 v84, v67, v71
    v_mul_f32 v85, v67, v70
    v_fma_f32 v70, v66, v70, -v84
    v_fma_f32 v71, -v66, v71, -v85
    v_mul_f32 v82, v64, v46
    v_mul_f32 v83, v65, v46
    v_exp_f32 v82, v82
    v_fract_f32 v83, v83
    v_cos_f32 v72, v83
    v_sin_f32 v73, v83
    v_mul_f32 v72, v72, v82
    v_mul_f32 v73, v73, v82
    v_mul_f32 v84, v67, v73
    v_mul_f32 v85, v67, v72
    v_fma_f32 v72, v66, v72, -v84
    v_fma_f32 v73, -v66, v73, -v85
    v_mfma_f32_16x16x4_f32 v[48:51], v68, v74, v[48:51]
    v_mfma_f32_16x16x4_f32 v[52:55], v70, v76, v[52:55]
    v_mfma_f32_16x16x4_f32 v[56:59], v70, v78, v[56:59]
    v_mfma_f32_16x16x4_f32 v[60:63], v72, v80, v[60:63]
    v_mfma_f32_16x16x4_f32 v[48:51], v69, v75, v[48:51]
    v_mfma_f32_16x16x4_f32 v[52:55], v71, v77, v[52:55]
    v_mfma_f32_16x16x4_f32 v[56:59], v71, v79, v[56:59]
    v_mfma_f32_16x16x4_f32 v[60:63], v73, v81, v[60:63]
    v_mov_b32_dpp v64, v24 row_newbcast:7 row_mask:0xf bank_mask:0xf
    v_mov_b32_dpp v65, v25 row_newbcast:7 row_mask:0xf bank_mask:0xf
    v_mov_b32_dpp v66, v26 row_newbcast:7 row_mask:0xf bank_mask:0xf
    v_mov_b32_dpp v67, v27 row_newbcast:7 row_mask:0xf bank_mask:0xf
    v_mul_f32 v82, v64, v47
    v_mul_f32 v83, v65, v47
    v_exp_f32 v82, v82
    v_fract_f32 v83, v83
    v_cos_f32 v74, v83
    v_sin_f32 v75, v83
    v_mul_f32 v74, v74, v82
    v_mul_f32 v75, v75, v82
    v_mul_f32 v84, v75, v75
    v_add_f32 v85, v74, v74
    v_fma_f32 v76, v74, v74, -v84
    v_mul_f32 v77, v85, v75
    v_mul_f32 v84, v77, v77
    v_add_f32 v85, v76, v76
    v_fma_f32 v78, v76, v76, -v84
    v_mul_f32 v79, v85, v77
    v_mul_f32 v84, v79, v79
    v_add_f32 v85, v78, v78
    v_fma_f32 v80, v78, v78, -v84
    v_mul_f32 v81, v85, v79
    v_mul_f32 v82, v64, v44
    v_mul_f32 v83, v65, v44
    v_exp_f32 v82, v82
    v_fract_f32 v83, v83
    v_cos_f32 v68, v83
    v_sin_f32 v69, v83
    v_mul_f32 v68, v68, v82
    v_mul_f32 v69, v69, v82
    v_mul_f32 v84, v67, v69
    v_mul_f32 v85, v67, v68
    v_fma_f32 v68, v66, v68, -v84
    v_fma_f32 v69, -v66, v69, -v85
    v_mul_f32 v82, v64, v45
    v_mul_f32 v83, v65, v45
    v_exp_f32 v82, v82
    v_fract_f32 v83, v83
    v_cos_f32 v70, v83
    v_sin_f32 v71, v83
    v_mul_f32 v70, v70, v82
    v_mul_f32 v71, v71, v82
    v_mul_f32 v84, v67, v71
    v_mul_f32 v85, v67, v70
    v_fma_f32 v70, v66, v70, -v84
    v_fma_f32 v71, -v66, v71, -v85
    v_mul_f32 v82, v64, v46
    v_mul_f32 v83, v65, v46
    v_exp_f32 v82, v82
    v_fract_f32 v83, v83
    v_cos_f32 v72, v83
    v_sin_f32 v73, v83
    v_mul_f32 v72, v72, v82
    v_mul_f32 v73, v73, v82
    v_mul_f32 v84, v67, v73
    v_mul_f32 v85, v67, v72
    v_fma_f32 v72, v66, v72, -v84
    v_fma_f32 v73, -v66, v73, -v85
    v_mfma_f32_16x16x4_f32 v[48:51], v68, v74, v[48:51]
    v_mfma_f32_16x16x4_f32 v[52:55], v70, v76, v[52:55]
    v_mfma_f32_16x16x4_f32 v[56:59], v70, v78, v[56:59]
    v_mfma_f32_16x16x4_f32 v[60:63], v72, v80, v[60:63]
    v_mfma_f32_16x16x4_f32 v[48:51], v69, v75, v[48:51]
    v_mfma_f32_16x16x4_f32 v[52:55], v71, v77, v[52:55]
    v_mfma_f32_16x16x4_f32 v[56:59], v71, v79, v[56:59]
    v_mfma_f32_16x16x4_f32 v[60:63], v73, v81, v[60:63]
    v_mov_b32_dpp v64, v24 row_newbcast:8 row_mask:0xf bank_mask:0xf
    v_mov_b32_dpp v65, v25 row_newbcast:8 row_mask:0xf bank_mask:0xf
    v_mov_b32_dpp v66, v26 row_newbcast:8 row_mask:0xf bank_mask:0xf
    v_mov_b32_dpp v67, v27 row_newbcast:8 row_mask:0xf bank_mask:0xf
    v_mul_f32 v82, v64, v47
    v_mul_f32 v83, v65, v47
    v_exp_f32 v82, v82
    v_fract_f32 v83, v83
    v_cos_f32 v74, v83
    v_sin_f32 v75, v83
    v_mul_f32 v74, v74, v82
    v_mul_f32 v75, v75, v82
    v_mul_f32 v84, v75, v75
    v_add_f32 v85, v74, v74
    v_fma_f32 v76, v74, v74, -v84
    v_mul_f32 v77, v85, v75
    v_mul_f32 v84, v77, v77
    v_add_f32 v85, v76, v76
    v_fma_f32 v78, v76, v76, -v84
    v_mul_f32 v79, v85, v77
    v_mul_f32 v84, v79, v79
    v_add_f32 v85, v78, v78
    v_fma_f32 v80, v78, v78, -v84
    v_mul_f32 v81, v85, v79
    v_mul_f32 v82, v64, v44
    v_mul_f32 v83, v65, v44
    v_exp_f32 v82, v82
    v_fract_f32 v83, v83
    v_cos_f32 v68, v83
    v_sin_f32 v69, v83
    v_mul_f32 v68, v68, v82
    v_mul_f32 v69, v69, v82
    v_mul_f32 v84, v67, v69
    v_mul_f32 v85, v67, v68
    v_fma_f32 v68, v66, v68, -v84
    v_fma_f32 v69, -v66, v69, -v85
    v_mul_f32 v82, v64, v45
    v_mul_f32 v83, v65, v45
    v_exp_f32 v82, v82
    v_fract_f32 v83, v83
    v_cos_f32 v70, v83
    v_sin_f32 v71, v83
    v_mul_f32 v70, v70, v82
    v_mul_f32 v71, v71, v82
    v_mul_f32 v84, v67, v71
    v_mul_f32 v85, v67, v70
    v_fma_f32 v70, v66, v70, -v84
    v_fma_f32 v71, -v66, v71, -v85
    v_mul_f32 v82, v64, v46
    v_mul_f32 v83, v65, v46
    v_exp_f32 v82, v82
    v_fract_f32 v83, v83
    v_cos_f32 v72, v83
    v_sin_f32 v73, v83
    v_mul_f32 v72, v72, v82
    v_mul_f32 v73, v73, v82
    v_mul_f32 v84, v67, v73
    v_mul_f32 v85, v67, v72
    v_fma_f32 v72, v66, v72, -v84
    v_fma_f32 v73, -v66, v73, -v85
    v_mfma_f32_16x16x4_f32 v[48:51], v68, v74, v[48:51]
    v_mfma_f32_16x16x4_f32 v[52:55], v70, v76, v[52:55]
    v_mfma_f32_16x16x4_f32 v[56:59], v70, v78, v[56:59]
    v_mfma_f32_16x16x4_f32 v[60:63], v72, v80, v[60:63]
    v_mfma_f32_16x16x4_f32 v[48:51], v69, v75, v[48:51]
    v_mfma_f32_16x16x4_f32 v[52:55], v71, v77, v[52:55]
    v_mfma_f32_16x16x4_f32 v[56:59], v71, v79, v[56:59]
    v_mfma_f32_16x16x4_f32 v[60:63], v73, v81, v[60:63]
    v_mov_b32_dpp v64, v24 row_newbcast:9 row_mask:0xf bank_mask:0xf
    v_mov_b32_dpp v65, v25 row_newbcast:9 row_mask:0xf bank_mask:0xf
    v_mov_b32_dpp v66, v26 row_newbcast:9 row_mask:0xf bank_mask:0xf
    v_mov_b32_dpp v67, v27 row_newbcast:9 row_mask:0xf bank_mask:0xf
    v_mul_f32 v82, v64, v47
    v_mul_f32 v83, v65, v47
    v_exp_f32 v82, v82
    v_fract_f32 v83, v83
    v_cos_f32 v74, v83
    v_sin_f32 v75, v83
    v_mul_f32 v74, v74, v82
    v_mul_f32 v75, v75, v82
    v_mul_f32 v84, v75, v75
    v_add_f32 v85, v74, v74
    v_fma_f32 v76, v74, v74, -v84
    v_mul_f32 v77, v85, v75
    v_mul_f32 v84, v77, v77
    v_add_f32 v85, v76, v76
    v_fma_f32 v78, v76, v76, -v84
    v_mul_f32 v79, v85, v77
    v_mul_f32 v84, v79, v79
    v_add_f32 v85, v78, v78
    v_fma_f32 v80, v78, v78, -v84
    v_mul_f32 v81, v85, v79
    v_mul_f32 v82, v64, v44
    v_mul_f32 v83, v65, v44
    v_exp_f32 v82, v82
    v_fract_f32 v83, v83
    v_cos_f32 v68, v83
    v_sin_f32 v69, v83
    v_mul_f32 v68, v68, v82
    v_mul_f32 v69, v69, v82
    v_mul_f32 v84, v67, v69
    v_mul_f32 v85, v67, v68
    v_fma_f32 v68, v66, v68, -v84
    v_fma_f32 v69, -v66, v69, -v85
    v_mul_f32 v82, v64, v45
    v_mul_f32 v83, v65, v45
    v_exp_f32 v82, v82
    v_fract_f32 v83, v83
    v_cos_f32 v70, v83
    v_sin_f32 v71, v83
    v_mul_f32 v70, v70, v82
    v_mul_f32 v71, v71, v82
    v_mul_f32 v84, v67, v71
    v_mul_f32 v85, v67, v70
    v_fma_f32 v70, v66, v70, -v84
    v_fma_f32 v71, -v66, v71, -v85
    v_mul_f32 v82, v64, v46
    v_mul_f32 v83, v65, v46
    v_exp_f32 v82, v82
    v_fract_f32 v83, v83
    v_cos_f32 v72, v83
    v_sin_f32 v73, v83
    v_mul_f32 v72, v72, v82
    v_mul_f32 v73, v73, v82
    v_mul_f32 v84, v67, v73
    v_mul_f32 v85, v67, v72
    v_fma_f32 v72, v66, v72, -v84
    v_fma_f32 v73, -v66, v73, -v85
    v_mfma_f32_16x16x4_f32 v[48:51], v68, v74, v[48:51]
    v_mfma_f32_16x16x4_f32 v[52:55], v70, v76, v[52:55]
    v_mfma_f32_16x16x4_f32 v[56:59], v70, v78, v[56:59]
    v_mfma_f32_16x16x4_f32 v[60:63], v72, v80, v[60:63]
    v_mfma_f32_16x16x4_f32 v[48:51], v69, v75, v[48:51]
    v_mfma_f32_16x16x4_f32 v[52:55], v71, v77, v[52:55]
    v_mfma_f32_16x16x4_f32 v[56:59], v71, v79, v[56:59]
    v_mfma_f32_16x16x4_f32 v[60:63], v73, v81, v[60:63]
    v_mov_b32_dpp v64, v24 row_newbcast:10 row_mask:0xf bank_mask:0xf
    v_mov_b32_dpp v65, v25 row_newbcast:10 row_mask:0xf bank_mask:0xf
    v_mov_b32_dpp v66, v26 row_newbcast:10 row_mask:0xf bank_mask:0xf
    v_mov_b32_dpp v67, v27 row_newbcast:10 row_mask:0xf bank_mask:0xf
    v_mul_f32 v82, v64, v47
    v_mul_f32 v83, v65, v47
    v_exp_f32 v82, v82
    v_fract_f32 v83, v83
    v_cos_f32 v74, v83
    v_sin_f32 v75, v83
    v_mul_f32 v74, v74, v82
    v_mul_f32 v75, v75, v82
    v_mul_f32 v84, v75, v75
    v_add_f32 v85, v74, v74
    v_fma_f32 v76, v74, v74, -v84
    v_mul_f32 v77, v85, v75
    v_mul_f32 v84, v77, v77
    v_add_f32 v85, v76, v76
    v_fma_f32 v78, v76, v76, -v84
    v_mul_f32 v79, v85, v77
    v_mul_f32 v84, v79, v79
    v_add_f32 v85, v78, v78
    v_fma_f32 v80, v78, v78, -v84
    v_mul_f32 v81, v85, v79
    v_mul_f32 v82, v64, v44
    v_mul_f32 v83, v65, v44
    v_exp_f32 v82, v82
    v_fract_f32 v83, v83
    v_cos_f32 v68, v83
    v_sin_f32 v69, v83
    v_mul_f32 v68, v68, v82
    v_mul_f32 v69, v69, v82
    v_mul_f32 v84, v67, v69
    v_mul_f32 v85, v67, v68
    v_fma_f32 v68, v66, v68, -v84
    v_fma_f32 v69, -v66, v69, -v85
    v_mul_f32 v82, v64, v45
    v_mul_f32 v83, v65, v45
    v_exp_f32 v82, v82
    v_fract_f32 v83, v83
    v_cos_f32 v70, v83
    v_sin_f32 v71, v83
    v_mul_f32 v70, v70, v82
    v_mul_f32 v71, v71, v82
    v_mul_f32 v84, v67, v71
    v_mul_f32 v85, v67, v70
    v_fma_f32 v70, v66, v70, -v84
    v_fma_f32 v71, -v66, v71, -v85
    v_mul_f32 v82, v64, v46
    v_mul_f32 v83, v65, v46
    v_exp_f32 v82, v82
    v_fract_f32 v83, v83
    v_cos_f32 v72, v83
    v_sin_f32 v73, v83
    v_mul_f32 v72, v72, v82
    v_mul_f32 v73, v73, v82
    v_mul_f32 v84, v67, v73
    v_mul_f32 v85, v67, v72
    v_fma_f32 v72, v66, v72, -v84
    v_fma_f32 v73, -v66, v73, -v85
    v_mfma_f32_16x16x4_f32 v[48:51], v68, v74, v[48:51]
    v_mfma_f32_16x16x4_f32 v[52:55], v70, v76, v[52:55]
    v_mfma_f32_16x16x4_f32 v[56:59], v70, v78, v[56:59]
    v_mfma_f32_16x16x4_f32 v[60:63], v72, v80, v[60:63]
    v_mfma_f32_16x16x4_f32 v[48:51], v69, v75, v[48:51]
    v_mfma_f32_16x16x4_f32 v[52:55], v71, v77, v[52:55]
    v_mfma_f32_16x16x4_f32 v[56:59], v71, v79, v[56:59]
    v_mfma_f32_16x16x4_f32 v[60:63], v73, v81, v[60:63]
    v_mov_b32_dpp v64, v24 row_newbcast:11 row_mask:0xf bank_mask:0xf
    v_mov_b32_dpp v65, v25 row_newbcast:11 row_mask:0xf bank_mask:0xf
    v_mov_b32_dpp v66, v26 row_newbcast:11 row_mask:0xf bank_mask:0xf
    v_mov_b32_dpp v67, v27 row_newbcast:11 row_mask:0xf bank_mask:0xf
    v_mul_f32 v82, v64, v47
    v_mul_f32 v83, v65, v47
    v_exp_f32 v82, v82
    v_fract_f32 v83, v83
    v_cos_f32 v74, v83
    v_sin_f32 v75, v83
    v_mul_f32 v74, v74, v82
    v_mul_f32 v75, v75, v82
    v_mul_f32 v84, v75, v75
    v_add_f32 v85, v74, v74
    v_fma_f32 v76, v74, v74, -v84
    v_mul_f32 v77, v85, v75
    v_mul_f32 v84, v77, v77
    v_add_f32 v85, v76, v76
    v_fma_f32 v78, v76, v76, -v84
    v_mul_f32 v79, v85, v77
    v_mul_f32 v84, v79, v79
    v_add_f32 v85, v78, v78
    v_fma_f32 v80, v78, v78, -v84
    v_mul_f32 v81, v85, v79
    v_mul_f32 v82, v64, v44
    v_mul_f32 v83, v65, v44
    v_exp_f32 v82, v82
    v_fract_f32 v83, v83
    v_cos_f32 v68, v83
    v_sin_f32 v69, v83
    v_mul_f32 v68, v68, v82
    v_mul_f32 v69, v69, v82
    v_mul_f32 v84, v67, v69
    v_mul_f32 v85, v67, v68
    v_fma_f32 v68, v66, v68, -v84
    v_fma_f32 v69, -v66, v69, -v85
    v_mul_f32 v82, v64, v45
    v_mul_f32 v83, v65, v45
    v_exp_f32 v82, v82
    v_fract_f32 v83, v83
    v_cos_f32 v70, v83
    v_sin_f32 v71, v83
    v_mul_f32 v70, v70, v82
    v_mul_f32 v71, v71, v82
    v_mul_f32 v84, v67, v71
    v_mul_f32 v85, v67, v70
    v_fma_f32 v70, v66, v70, -v84
    v_fma_f32 v71, -v66, v71, -v85
    v_mul_f32 v82, v64, v46
    v_mul_f32 v83, v65, v46
    v_exp_f32 v82, v82
    v_fract_f32 v83, v83
    v_cos_f32 v72, v83
    v_sin_f32 v73, v83
    v_mul_f32 v72, v72, v82
    v_mul_f32 v73, v73, v82
    v_mul_f32 v84, v67, v73
    v_mul_f32 v85, v67, v72
    v_fma_f32 v72, v66, v72, -v84
    v_fma_f32 v73, -v66, v73, -v85
    v_mfma_f32_16x16x4_f32 v[48:51], v68, v74, v[48:51]
    v_mfma_f32_16x16x4_f32 v[52:55], v70, v76, v[52:55]
    v_mfma_f32_16x16x4_f32 v[56:59], v70, v78, v[56:59]
    v_mfma_f32_16x16x4_f32 v[60:63], v72, v80, v[60:63]
    v_mfma_f32_16x16x4_f32 v[48:51], v69, v75, v[48:51]
    v_mfma_f32_16x16x4_f32 v[52:55], v71, v77, v[52:55]
    v_mfma_f32_16x16x4_f32 v[56:59], v71, v79, v[56:59]
    v_mfma_f32_16x16x4_f32 v[60:63], v73, v81, v[60:63]
    v_mov_b32_dpp v64, v24 row_newbcast:12 row_mask:0xf bank_mask:0xf
    v_mov_b32_dpp v65, v25 row_newbcast:12 row_mask:0xf bank_mask:0xf
    v_mov_b32_dpp v66, v26 row_newbcast:12 row_mask:0xf bank_mask:0xf
    v_mov_b32_dpp v67, v27 row_newbcast:12 row_mask:0xf bank_mask:0xf
    v_mul_f32 v82, v64, v47
    v_mul_f32 v83, v65, v47
    v_exp_f32 v82, v82
    v_fract_f32 v83, v83
    v_cos_f32 v74, v83
    v_sin_f32 v75, v83
    v_mul_f32 v74, v74, v82
    v_mul_f32 v75, v75, v82
    v_mul_f32 v84, v75, v75
    v_add_f32 v85, v74, v74
    v_fma_f32 v76, v74, v74, -v84
    v_mul_f32 v77, v85, v75
    v_mul_f32 v84, v77, v77
    v_add_f32 v85, v76, v76
    v_fma_f32 v78, v76, v76, -v84
    v_mul_f32 v79, v85, v77
    v_mul_f32 v84, v79, v79
    v_add_f32 v85, v78, v78
    v_fma_f32 v80, v78, v78, -v84
    v_mul_f32 v81, v85, v79
    v_mul_f32 v82, v64, v44
    v_mul_f32 v83, v65, v44
    v_exp_f32 v82, v82
    v_fract_f32 v83, v83
    v_cos_f32 v68, v83
    v_sin_f32 v69, v83
    v_mul_f32 v68, v68, v82
    v_mul_f32 v69, v69, v82
    v_mul_f32 v84, v67, v69
    v_mul_f32 v85, v67, v68
    v_fma_f32 v68, v66, v68, -v84
    v_fma_f32 v69, -v66, v69, -v85
    v_mul_f32 v82, v64, v45
    v_mul_f32 v83, v65, v45
    v_exp_f32 v82, v82
    v_fract_f32 v83, v83
    v_cos_f32 v70, v83
    v_sin_f32 v71, v83
    v_mul_f32 v70, v70, v82
    v_mul_f32 v71, v71, v82
    v_mul_f32 v84, v67, v71
    v_mul_f32 v85, v67, v70
    v_fma_f32 v70, v66, v70, -v84
    v_fma_f32 v71, -v66, v71, -v85
    v_mul_f32 v82, v64, v46
    v_mul_f32 v83, v65, v46
    v_exp_f32 v82, v82
    v_fract_f32 v83, v83
    v_cos_f32 v72, v83
    v_sin_f32 v73, v83
    v_mul_f32 v72, v72, v82
    v_mul_f32 v73, v73, v82
    v_mul_f32 v84, v67, v73
    v_mul_f32 v85, v67, v72
    v_fma_f32 v72, v66, v72, -v84
    v_fma_f32 v73, -v66, v73, -v85
    v_mfma_f32_16x16x4_f32 v[48:51], v68, v74, v[48:51]
    v_mfma_f32_16x16x4_f32 v[52:55], v70, v76, v[52:55]
    v_mfma_f32_16x16x4_f32 v[56:59], v70, v78, v[56:59]
    v_mfma_f32_16x16x4_f32 v[60:63], v72, v80, v[60:63]
    v_mfma_f32_16x16x4_f32 v[48:51], v69, v75, v[48:51]
    v_mfma_f32_16x16x4_f32 v[52:55], v71, v77, v[52:55]
    v_mfma_f32_16x16x4_f32 v[56:59], v71, v79, v[56:59]
    v_mfma_f32_16x16x4_f32 v[60:63], v73, v81, v[60:63]
    v_mov_b32_dpp v64, v24 row_newbcast:13 row_mask:0xf bank_mask:0xf
    v_mov_b32_dpp v65, v25 row_newbcast:13 row_mask:0xf bank_mask:0xf
    v_mov_b32_dpp v66, v26 row_newbcast:13 row_mask:0xf bank_mask:0xf
    v_mov_b32_dpp v67, v27 row_newbcast:13 row_mask:0xf bank_mask:0xf
    v_mul_f32 v82, v64, v47
    v_mul_f32 v83, v65, v47
    v_exp_f32 v82, v82
    v_fract_f32 v83, v83
    v_cos_f32 v74, v83
    v_sin_f32 v75, v83
    v_mul_f32 v74, v74, v82
    v_mul_f32 v75, v75, v82
    v_mul_f32 v84, v75, v75
    v_add_f32 v85, v74, v74
    v_fma_f32 v76, v74, v74, -v84
    v_mul_f32 v77, v85, v75
    v_mul_f32 v84, v77, v77
    v_add_f32 v85, v76, v76
    v_fma_f32 v78, v76, v76, -v84
    v_mul_f32 v79, v85, v77
    v_mul_f32 v84, v79, v79
    v_add_f32 v85, v78, v78
    v_fma_f32 v80, v78, v78, -v84
    v_mul_f32 v81, v85, v79
    v_mul_f32 v82, v64, v44
    v_mul_f32 v83, v65, v44
    v_exp_f32 v82, v82
    v_fract_f32 v83, v83
    v_cos_f32 v68, v83
    v_sin_f32 v69, v83
    v_mul_f32 v68, v68, v82
    v_mul_f32 v69, v69, v82
    v_mul_f32 v84, v67, v69
    v_mul_f32 v85, v67, v68
    v_fma_f32 v68, v66, v68, -v84
    v_fma_f32 v69, -v66, v69, -v85
    v_mul_f32 v82, v64, v45
    v_mul_f32 v83, v65, v45
    v_exp_f32 v82, v82
    v_fract_f32 v83, v83
    v_cos_f32 v70, v83
    v_sin_f32 v71, v83
    v_mul_f32 v70, v70, v82
    v_mul_f32 v71, v71, v82
    v_mul_f32 v84, v67, v71
    v_mul_f32 v85, v67, v70
    v_fma_f32 v70, v66, v70, -v84
    v_fma_f32 v71, -v66, v71, -v85
    v_mul_f32 v82, v64, v46
    v_mul_f32 v83, v65, v46
    v_exp_f32 v82, v82
    v_fract_f32 v83, v83
    v_cos_f32 v72, v83
    v_sin_f32 v73, v83
    v_mul_f32 v72, v72, v82
    v_mul_f32 v73, v73, v82
    v_mul_f32 v84, v67, v73
    v_mul_f32 v85, v67, v72
    v_fma_f32 v72, v66, v72, -v84
    v_fma_f32 v73, -v66, v73, -v85
    v_mfma_f32_16x16x4_f32 v[48:51], v68, v74, v[48:51]
    v_mfma_f32_16x16x4_f32 v[52:55], v70, v76, v[52:55]
    v_mfma_f32_16x16x4_f32 v[56:59], v70, v78, v[56:59]
    v_mfma_f32_16x16x4_f32 v[60:63], v72, v80, v[60:63]
    v_mfma_f32_16x16x4_f32 v[48:51], v69, v75, v[48:51]
    v_mfma_f32_16x16x4_f32 v[52:55], v71, v77, v[52:55]
    v_mfma_f32_16x16x4_f32 v[56:59], v71, v79, v[56:59]
    v_mfma_f32_16x16x4_f32 v[60:63], v73, v81, v[60:63]
    v_mov_b32_dpp v64, v24 row_newbcast:14 row_mask:0xf bank_mask:0xf
    v_mov_b32_dpp v65, v25 row_newbcast:14 row_mask:0xf bank_mask:0xf
    v_mov_b32_dpp v66, v26 row_newbcast:14 row_mask:0xf bank_mask:0xf
    v_mov_b32_dpp v67, v27 row_newbcast:14 row_mask:0xf bank_mask:0xf
    v_mul_f32 v82, v64, v47
    v_mul_f32 v83, v65, v47
    v_exp_f32 v82, v82
    v_fract_f32 v83, v83
    v_cos_f32 v74, v83
    v_sin_f32 v75, v83
    v_mul_f32 v74, v74, v82
    v_mul_f32 v75, v75, v82
    v_mul_f32 v84, v75, v75
    v_add_f32 v85, v74, v74
    v_fma_f32 v76, v74, v74, -v84
    v_mul_f32 v77, v85, v75
    v_mul_f32 v84, v77, v77
    v_add_f32 v85, v76, v76
    v_fma_f32 v78, v76, v76, -v84
    v_mul_f32 v79, v85, v77
    v_mul_f32 v84, v79, v79
    v_add_f32 v85, v78, v78
    v_fma_f32 v80, v78, v78, -v84
    v_mul_f32 v81, v85, v79
    v_mul_f32 v82, v64, v44
    v_mul_f32 v83, v65, v44
    v_exp_f32 v82, v82
    v_fract_f32 v83, v83
    v_cos_f32 v68, v83
    v_sin_f32 v69, v83
    v_mul_f32 v68, v68, v82
    v_mul_f32 v69, v69, v82
    v_mul_f32 v84, v67, v69
    v_mul_f32 v85, v67, v68
    v_fma_f32 v68, v66, v68, -v84
    v_fma_f32 v69, -v66, v69, -v85
    v_mul_f32 v82, v64, v45
    v_mul_f32 v83, v65, v45
    v_exp_f32 v82, v82
    v_fract_f32 v83, v83
    v_cos_f32 v70, v83
    v_sin_f32 v71, v83
    v_mul_f32 v70, v70, v82
    v_mul_f32 v71, v71, v82
    v_mul_f32 v84, v67, v71
    v_mul_f32 v85, v67, v70
    v_fma_f32 v70, v66, v70, -v84
    v_fma_f32 v71, -v66, v71, -v85
    v_mul_f32 v82, v64, v46
    v_mul_f32 v83, v65, v46
    v_exp_f32 v82, v82
    v_fract_f32 v83, v83
    v_cos_f32 v72, v83
    v_sin_f32 v73, v83
    v_mul_f32 v72, v72, v82
    v_mul_f32 v73, v73, v82
    v_mul_f32 v84, v67, v73
    v_mul_f32 v85, v67, v72
    v_fma_f32 v72, v66, v72, -v84
    v_fma_f32 v73, -v66, v73, -v85
    v_mfma_f32_16x16x4_f32 v[48:51], v68, v74, v[48:51]
    v_mfma_f32_16x16x4_f32 v[52:55], v70, v76, v[52:55]
    v_mfma_f32_16x16x4_f32 v[56:59], v70, v78, v[56:59]
    v_mfma_f32_16x16x4_f32 v[60:63], v72, v80, v[60:63]
    v_mfma_f32_16x16x4_f32 v[48:51], v69, v75, v[48:51]
    v_mfma_f32_16x16x4_f32 v[52:55], v71, v77, v[52:55]
    v_mfma_f32_16x16x4_f32 v[56:59], v71, v79, v[56:59]
    v_mfma_f32_16x16x4_f32 v[60:63], v73, v81, v[60:63]
    v_mov_b32_dpp v64, v24 row_newbcast:15 row_mask:0xf bank_mask:0xf
    v_mov_b32_dpp v65, v25 row_newbcast:15 row_mask:0xf bank_mask:0xf
    v_mov_b32_dpp v66, v26 row_newbcast:15 row_mask:0xf bank_mask:0xf
    v_mov_b32_dpp v67, v27 row_newbcast:15 row_mask:0xf bank_mask:0xf
    v_mul_f32 v82, v64, v47
    v_mul_f32 v83, v65, v47
    v_exp_f32 v82, v82
    v_fract_f32 v83, v83
    v_cos_f32 v74, v83
    v_sin_f32 v75, v83
    v_mul_f32 v74, v74, v82
    v_mul_f32 v75, v75, v82
    v_mul_f32 v84, v75, v75
    v_add_f32 v85, v74, v74
    v_fma_f32 v76, v74, v74, -v84
    v_mul_f32 v77, v85, v75
    v_mul_f32 v84, v77, v77
    v_add_f32 v85, v76, v76
    v_fma_f32 v78, v76, v76, -v84
    v_mul_f32 v79, v85, v77
    v_mul_f32 v84, v79, v79
    v_add_f32 v85, v78, v78
    v_fma_f32 v80, v78, v78, -v84
    v_mul_f32 v81, v85, v79
    v_mul_f32 v82, v64, v44
    v_mul_f32 v83, v65, v44
    v_exp_f32 v82, v82
    v_fract_f32 v83, v83
    v_cos_f32 v68, v83
    v_sin_f32 v69, v83
    v_mul_f32 v68, v68, v82
    v_mul_f32 v69, v69, v82
    v_mul_f32 v84, v67, v69
    v_mul_f32 v85, v67, v68
    v_fma_f32 v68, v66, v68, -v84
    v_fma_f32 v69, -v66, v69, -v85
    v_mul_f32 v82, v64, v45
    v_mul_f32 v83, v65, v45
    v_exp_f32 v82, v82
    v_fract_f32 v83, v83
    v_cos_f32 v70, v83
    v_sin_f32 v71, v83
    v_mul_f32 v70, v70, v82
    v_mul_f32 v71, v71, v82
    v_mul_f32 v84, v67, v71
    v_mul_f32 v85, v67, v70
    v_fma_f32 v70, v66, v70, -v84
    v_fma_f32 v71, -v66, v71, -v85
    v_mul_f32 v82, v64, v46
    v_mul_f32 v83, v65, v46
    v_exp_f32 v82, v82
    v_fract_f32 v83, v83
    v_cos_f32 v72, v83
    v_sin_f32 v73, v83
    v_mul_f32 v72, v72, v82
    v_mul_f32 v73, v73, v82
    v_mul_f32 v84, v67, v73
    v_mul_f32 v85, v67, v72
    v_fma_f32 v72, v66, v72, -v84
    v_fma_f32 v73, -v66, v73, -v85
    v_mfma_f32_16x16x4_f32 v[48:51], v68, v74, v[48:51]
    v_mfma_f32_16x16x4_f32 v[52:55], v70, v76, v[52:55]
    v_mfma_f32_16x16x4_f32 v[56:59], v70, v78, v[56:59]
    v_mfma_f32_16x16x4_f32 v[60:63], v72, v80, v[60:63]
    v_mfma_f32_16x16x4_f32 v[48:51], v69, v75, v[48:51]
    v_mfma_f32_16x16x4_f32 v[52:55], v71, v77, v[52:55]
    v_mfma_f32_16x16x4_f32 v[56:59], v71, v79, v[56:59]
    v_mfma_f32_16x16x4_f32 v[60:63], v73, v81, v[60:63]
    v_mov_b32_dpp v64, v28 row_newbcast:0 row_mask:0xf bank_mask:0xf
    v_mov_b32_dpp v65, v29 row_newbcast:0 row_mask:0xf bank_mask:0xf
    v_mov_b32_dpp v66, v30 row_newbcast:0 row_mask:0xf bank_mask:0xf
    v_mov_b32_dpp v67, v31 row_newbcast:0 row_mask:0xf bank_mask:0xf
    v_mul_f32 v82, v64, v47
    v_mul_f32 v83, v65, v47
    v_exp_f32 v82, v82
    v_fract_f32 v83, v83
    v_cos_f32 v74, v83
    v_sin_f32 v75, v83
    v_mul_f32 v74, v74, v82
    v_mul_f32 v75, v75, v82
    v_mul_f32 v84, v75, v75
    v_add_f32 v85, v74, v74
    v_fma_f32 v76, v74, v74, -v84
    v_mul_f32 v77, v85, v75
    v_mul_f32 v84, v77, v77
    v_add_f32 v85, v76, v76
    v_fma_f32 v78, v76, v76, -v84
    v_mul_f32 v79, v85, v77
    v_mul_f32 v84, v79, v79
    v_add_f32 v85, v78, v78
    v_fma_f32 v80, v78, v78, -v84
    v_mul_f32 v81, v85, v79
    v_mul_f32 v82, v64, v44
    v_mul_f32 v83, v65, v44
    v_exp_f32 v82, v82
    v_fract_f32 v83, v83
    v_cos_f32 v68, v83
    v_sin_f32 v69, v83
    v_mul_f32 v68, v68, v82
    v_mul_f32 v69, v69, v82
    v_mul_f32 v84, v67, v69
    v_mul_f32 v85, v67, v68
    v_fma_f32 v68, v66, v68, -v84
    v_fma_f32 v69, -v66, v69, -v85
    v_mul_f32 v82, v64, v45
    v_mul_f32 v83, v65, v45
    v_exp_f32 v82, v82
    v_fract_f32 v83, v83
    v_cos_f32 v70, v83
    v_sin_f32 v71, v83
    v_mul_f32 v70, v70, v82
    v_mul_f32 v71, v71, v82
    v_mul_f32 v84, v67, v71
    v_mul_f32 v85, v67, v70
    v_fma_f32 v70, v66, v70, -v84
    v_fma_f32 v71, -v66, v71, -v85
    v_mul_f32 v82, v64, v46
    v_mul_f32 v83, v65, v46
    v_exp_f32 v82, v82
    v_fract_f32 v83, v83
    v_cos_f32 v72, v83
    v_sin_f32 v73, v83
    v_mul_f32 v72, v72, v82
    v_mul_f32 v73, v73, v82
    v_mul_f32 v84, v67, v73
    v_mul_f32 v85, v67, v72
    v_fma_f32 v72, v66, v72, -v84
    v_fma_f32 v73, -v66, v73, -v85
    v_mfma_f32_16x16x4_f32 v[48:51], v68, v74, v[48:51]
    v_mfma_f32_16x16x4_f32 v[52:55], v70, v76, v[52:55]
    v_mfma_f32_16x16x4_f32 v[56:59], v70, v78, v[56:59]
    v_mfma_f32_16x16x4_f32 v[60:63], v72, v80, v[60:63]
    v_mfma_f32_16x16x4_f32 v[48:51], v69, v75, v[48:51]
    v_mfma_f32_16x16x4_f32 v[52:55], v71, v77, v[52:55]
    v_mfma_f32_16x16x4_f32 v[56:59], v71, v79, v[56:59]
    v_mfma_f32_16x16x4_f32 v[60:63], v73, v81, v[60:63]
    v_mov_b32_dpp v64, v28 row_newbcast:1 row_mask:0xf bank_mask:0xf
    v_mov_b32_dpp v65, v29 row_newbcast:1 row_mask:0xf bank_mask:0xf
    v_mov_b32_dpp v66, v30 row_newbcast:1 row_mask:0xf bank_mask:0xf
    v_mov_b32_dpp v67, v31 row_newbcast:1 row_mask:0xf bank_mask:0xf
    v_mul_f32 v82, v64, v47
    v_mul_f32 v83, v65, v47
    v_exp_f32 v82, v82
    v_fract_f32 v83, v83
    v_cos_f32 v74, v83
    v_sin_f32 v75, v83
    v_mul_f32 v74, v74, v82
    v_mul_f32 v75, v75, v82
    v_mul_f32 v84, v75, v75
    v_add_f32 v85, v74, v74
    v_fma_f32 v76, v74, v74, -v84
    v_mul_f32 v77, v85, v75
    v_mul_f32 v84, v77, v77
    v_add_f32 v85, v76, v76
    v_fma_f32 v78, v76, v76, -v84
    v_mul_f32 v79, v85, v77
    v_mul_f32 v84, v79, v79
    v_add_f32 v85, v78, v78
    v_fma_f32 v80, v78, v78, -v84
    v_mul_f32 v81, v85, v79
    v_mul_f32 v82, v64, v44
    v_mul_f32 v83, v65, v44
    v_exp_f32 v82, v82
    v_fract_f32 v83, v83
    v_cos_f32 v68, v83
    v_sin_f32 v69, v83
    v_mul_f32 v68, v68, v82
    v_mul_f32 v69, v69, v82
    v_mul_f32 v84, v67, v69
    v_mul_f32 v85, v67, v68
    v_fma_f32 v68, v66, v68, -v84
    v_fma_f32 v69, -v66, v69, -v85
    v_mul_f32 v82, v64, v45
    v_mul_f32 v83, v65, v45
    v_exp_f32 v82, v82
    v_fract_f32 v83, v83
    v_cos_f32 v70, v83
    v_sin_f32 v71, v83
    v_mul_f32 v70, v70, v82
    v_mul_f32 v71, v71, v82
    v_mul_f32 v84, v67, v71
    v_mul_f32 v85, v67, v70
    v_fma_f32 v70, v66, v70, -v84
    v_fma_f32 v71, -v66, v71, -v85
    v_mul_f32 v82, v64, v46
    v_mul_f32 v83, v65, v46
    v_exp_f32 v82, v82
    v_fract_f32 v83, v83
    v_cos_f32 v72, v83
    v_sin_f32 v73, v83
    v_mul_f32 v72, v72, v82
    v_mul_f32 v73, v73, v82
    v_mul_f32 v84, v67, v73
    v_mul_f32 v85, v67, v72
    v_fma_f32 v72, v66, v72, -v84
    v_fma_f32 v73, -v66, v73, -v85
    v_mfma_f32_16x16x4_f32 v[48:51], v68, v74, v[48:51]
    v_mfma_f32_16x16x4_f32 v[52:55], v70, v76, v[52:55]
    v_mfma_f32_16x16x4_f32 v[56:59], v70, v78, v[56:59]
    v_mfma_f32_16x16x4_f32 v[60:63], v72, v80, v[60:63]
    v_mfma_f32_16x16x4_f32 v[48:51], v69, v75, v[48:51]
    v_mfma_f32_16x16x4_f32 v[52:55], v71, v77, v[52:55]
    v_mfma_f32_16x16x4_f32 v[56:59], v71, v79, v[56:59]
    v_mfma_f32_16x16x4_f32 v[60:63], v73, v81, v[60:63]
    v_mov_b32_dpp v64, v28 row_newbcast:2 row_mask:0xf bank_mask:0xf
    v_mov_b32_dpp v65, v29 row_newbcast:2 row_mask:0xf bank_mask:0xf
    v_mov_b32_dpp v66, v30 row_newbcast:2 row_mask:0xf bank_mask:0xf
    v_mov_b32_dpp v67, v31 row_newbcast:2 row_mask:0xf bank_mask:0xf
    v_mul_f32 v82, v64, v47
    v_mul_f32 v83, v65, v47
    v_exp_f32 v82, v82
    v_fract_f32 v83, v83
    v_cos_f32 v74, v83
    v_sin_f32 v75, v83
    v_mul_f32 v74, v74, v82
    v_mul_f32 v75, v75, v82
    v_mul_f32 v84, v75, v75
    v_add_f32 v85, v74, v74
    v_fma_f32 v76, v74, v74, -v84
    v_mul_f32 v77, v85, v75
    v_mul_f32 v84, v77, v77
    v_add_f32 v85, v76, v76
    v_fma_f32 v78, v76, v76, -v84
    v_mul_f32 v79, v85, v77
    v_mul_f32 v84, v79, v79
    v_add_f32 v85, v78, v78
    v_fma_f32 v80, v78, v78, -v84
    v_mul_f32 v81, v85, v79
    v_mul_f32 v82, v64, v44
    v_mul_f32 v83, v65, v44
    v_exp_f32 v82, v82
    v_fract_f32 v83, v83
    v_cos_f32 v68, v83
    v_sin_f32 v69, v83
    v_mul_f32 v68, v68, v82
    v_mul_f32 v69, v69, v82
    v_mul_f32 v84, v67, v69
    v_mul_f32 v85, v67, v68
    v_fma_f32 v68, v66, v68, -v84
    v_fma_f32 v69, -v66, v69, -v85
    v_mul_f32 v82, v64, v45
    v_mul_f32 v83, v65, v45
    v_exp_f32 v82, v82
    v_fract_f32 v83, v83
    v_cos_f32 v70, v83
    v_sin_f32 v71, v83
    v_mul_f32 v70, v70, v82
    v_mul_f32 v71, v71, v82
    v_mul_f32 v84, v67, v71
    v_mul_f32 v85, v67, v70
    v_fma_f32 v70, v66, v70, -v84
    v_fma_f32 v71, -v66, v71, -v85
    v_mul_f32 v82, v64, v46
    v_mul_f32 v83, v65, v46
    v_exp_f32 v82, v82
    v_fract_f32 v83, v83
    v_cos_f32 v72, v83
    v_sin_f32 v73, v83
    v_mul_f32 v72, v72, v82
    v_mul_f32 v73, v73, v82
    v_mul_f32 v84, v67, v73
    v_mul_f32 v85, v67, v72
    v_fma_f32 v72, v66, v72, -v84
    v_fma_f32 v73, -v66, v73, -v85
    v_mfma_f32_16x16x4_f32 v[48:51], v68, v74, v[48:51]
    v_mfma_f32_16x16x4_f32 v[52:55], v70, v76, v[52:55]
    v_mfma_f32_16x16x4_f32 v[56:59], v70, v78, v[56:59]
    v_mfma_f32_16x16x4_f32 v[60:63], v72, v80, v[60:63]
    v_mfma_f32_16x16x4_f32 v[48:51], v69, v75, v[48:51]
    v_mfma_f32_16x16x4_f32 v[52:55], v71, v77, v[52:55]
    v_mfma_f32_16x16x4_f32 v[56:59], v71, v79, v[56:59]
    v_mfma_f32_16x16x4_f32 v[60:63], v73, v81, v[60:63]
    v_mov_b32_dpp v64, v28 row_newbcast:3 row_mask:0xf bank_mask:0xf
    v_mov_b32_dpp v65, v29 row_newbcast:3 row_mask:0xf bank_mask:0xf
    v_mov_b32_dpp v66, v30 row_newbcast:3 row_mask:0xf bank_mask:0xf
    v_mov_b32_dpp v67, v31 row_newbcast:3 row_mask:0xf bank_mask:0xf
    v_mul_f32 v82, v64, v47
    v_mul_f32 v83, v65, v47
    v_exp_f32 v82, v82
    v_fract_f32 v83, v83
    v_cos_f32 v74, v83
    v_sin_f32 v75, v83
    v_mul_f32 v74, v74, v82
    v_mul_f32 v75, v75, v82
    v_mul_f32 v84, v75, v75
    v_add_f32 v85, v74, v74
    v_fma_f32 v76, v74, v74, -v84
    v_mul_f32 v77, v85, v75
    v_mul_f32 v84, v77, v77
    v_add_f32 v85, v76, v76
    v_fma_f32 v78, v76, v76, -v84
    v_mul_f32 v79, v85, v77
    v_mul_f32 v84, v79, v79
    v_add_f32 v85, v78, v78
    v_fma_f32 v80, v78, v78, -v84
    v_mul_f32 v81, v85, v79
    v_mul_f32 v82, v64, v44
    v_mul_f32 v83, v65, v44
    v_exp_f32 v82, v82
    v_fract_f32 v83, v83
    v_cos_f32 v68, v83
    v_sin_f32 v69, v83
    v_mul_f32 v68, v68, v82
    v_mul_f32 v69, v69, v82
    v_mul_f32 v84, v67, v69
    v_mul_f32 v85, v67, v68
    v_fma_f32 v68, v66, v68, -v84
    v_fma_f32 v69, -v66, v69, -v85
    v_mul_f32 v82, v64, v45
    v_mul_f32 v83, v65, v45
    v_exp_f32 v82, v82
    v_fract_f32 v83, v83
    v_cos_f32 v70, v83
    v_sin_f32 v71, v83
    v_mul_f32 v70, v70, v82
    v_mul_f32 v71, v71, v82
    v_mul_f32 v84, v67, v71
    v_mul_f32 v85, v67, v70
    v_fma_f32 v70, v66, v70, -v84
    v_fma_f32 v71, -v66, v71, -v85
    v_mul_f32 v82, v64, v46
    v_mul_f32 v83, v65, v46
    v_exp_f32 v82, v82
    v_fract_f32 v83, v83
    v_cos_f32 v72, v83
    v_sin_f32 v73, v83
    v_mul_f32 v72, v72, v82
    v_mul_f32 v73, v73, v82
    v_mul_f32 v84, v67, v73
    v_mul_f32 v85, v67, v72
    v_fma_f32 v72, v66, v72, -v84
    v_fma_f32 v73, -v66, v73, -v85
    v_mfma_f32_16x16x4_f32 v[48:51], v68, v74, v[48:51]
    v_mfma_f32_16x16x4_f32 v[52:55], v70, v76, v[52:55]
    v_mfma_f32_16x16x4_f32 v[56:59], v70, v78, v[56:59]
    v_mfma_f32_16x16x4_f32 v[60:63], v72, v80, v[60:63]
    v_mfma_f32_16x16x4_f32 v[48:51], v69, v75, v[48:51]
    v_mfma_f32_16x16x4_f32 v[52:55], v71, v77, v[52:55]
    v_mfma_f32_16x16x4_f32 v[56:59], v71, v79, v[56:59]
    v_mfma_f32_16x16x4_f32 v[60:63], v73, v81, v[60:63]
    v_mov_b32_dpp v64, v28 row_newbcast:4 row_mask:0xf bank_mask:0xf
    v_mov_b32_dpp v65, v29 row_newbcast:4 row_mask:0xf bank_mask:0xf
    v_mov_b32_dpp v66, v30 row_newbcast:4 row_mask:0xf bank_mask:0xf
    v_mov_b32_dpp v67, v31 row_newbcast:4 row_mask:0xf bank_mask:0xf
    v_mul_f32 v82, v64, v47
    v_mul_f32 v83, v65, v47
    v_exp_f32 v82, v82
    v_fract_f32 v83, v83
    v_cos_f32 v74, v83
    v_sin_f32 v75, v83
    v_mul_f32 v74, v74, v82
    v_mul_f32 v75, v75, v82
    v_mul_f32 v84, v75, v75
    v_add_f32 v85, v74, v74
    v_fma_f32 v76, v74, v74, -v84
    v_mul_f32 v77, v85, v75
    v_mul_f32 v84, v77, v77
    v_add_f32 v85, v76, v76
    v_fma_f32 v78, v76, v76, -v84
    v_mul_f32 v79, v85, v77
    v_mul_f32 v84, v79, v79
    v_add_f32 v85, v78, v78
    v_fma_f32 v80, v78, v78, -v84
    v_mul_f32 v81, v85, v79
    v_mul_f32 v82, v64, v44
    v_mul_f32 v83, v65, v44
    v_exp_f32 v82, v82
    v_fract_f32 v83, v83
    v_cos_f32 v68, v83
    v_sin_f32 v69, v83
    v_mul_f32 v68, v68, v82
    v_mul_f32 v69, v69, v82
    v_mul_f32 v84, v67, v69
    v_mul_f32 v85, v67, v68
    v_fma_f32 v68, v66, v68, -v84
    v_fma_f32 v69, -v66, v69, -v85
    v_mul_f32 v82, v64, v45
    v_mul_f32 v83, v65, v45
    v_exp_f32 v82, v82
    v_fract_f32 v83, v83
    v_cos_f32 v70, v83
    v_sin_f32 v71, v83
    v_mul_f32 v70, v70, v82
    v_mul_f32 v71, v71, v82
    v_mul_f32 v84, v67, v71
    v_mul_f32 v85, v67, v70
    v_fma_f32 v70, v66, v70, -v84
    v_fma_f32 v71, -v66, v71, -v85
    v_mul_f32 v82, v64, v46
    v_mul_f32 v83, v65, v46
    v_exp_f32 v82, v82
    v_fract_f32 v83, v83
    v_cos_f32 v72, v83
    v_sin_f32 v73, v83
    v_mul_f32 v72, v72, v82
    v_mul_f32 v73, v73, v82
    v_mul_f32 v84, v67, v73
    v_mul_f32 v85, v67, v72
    v_fma_f32 v72, v66, v72, -v84
    v_fma_f32 v73, -v66, v73, -v85
    v_mfma_f32_16x16x4_f32 v[48:51], v68, v74, v[48:51]
    v_mfma_f32_16x16x4_f32 v[52:55], v70, v76, v[52:55]
    v_mfma_f32_16x16x4_f32 v[56:59], v70, v78, v[56:59]
    v_mfma_f32_16x16x4_f32 v[60:63], v72, v80, v[60:63]
    v_mfma_f32_16x16x4_f32 v[48:51], v69, v75, v[48:51]
    v_mfma_f32_16x16x4_f32 v[52:55], v71, v77, v[52:55]
    v_mfma_f32_16x16x4_f32 v[56:59], v71, v79, v[56:59]
    v_mfma_f32_16x16x4_f32 v[60:63], v73, v81, v[60:63]
    v_mov_b32_dpp v64, v28 row_newbcast:5 row_mask:0xf bank_mask:0xf
    v_mov_b32_dpp v65, v29 row_newbcast:5 row_mask:0xf bank_mask:0xf
    v_mov_b32_dpp v66, v30 row_newbcast:5 row_mask:0xf bank_mask:0xf
    v_mov_b32_dpp v67, v31 row_newbcast:5 row_mask:0xf bank_mask:0xf
    v_mul_f32 v82, v64, v47
    v_mul_f32 v83, v65, v47
    v_exp_f32 v82, v82
    v_fract_f32 v83, v83
    v_cos_f32 v74, v83
    v_sin_f32 v75, v83
    v_mul_f32 v74, v74, v82
    v_mul_f32 v75, v75, v82
    v_mul_f32 v84, v75, v75
    v_add_f32 v85, v74, v74
    v_fma_f32 v76, v74, v74, -v84
    v_mul_f32 v77, v85, v75
    v_mul_f32 v84, v77, v77
    v_add_f32 v85, v76, v76
    v_fma_f32 v78, v76, v76, -v84
    v_mul_f32 v79, v85, v77
    v_mul_f32 v84, v79, v79
    v_add_f32 v85, v78, v78
    v_fma_f32 v80, v78, v78, -v84
    v_mul_f32 v81, v85, v79
    v_mul_f32 v82, v64, v44
    v_mul_f32 v83, v65, v44
    v_exp_f32 v82, v82
    v_fract_f32 v83, v83
    v_cos_f32 v68, v83
    v_sin_f32 v69, v83
    v_mul_f32 v68, v68, v82
    v_mul_f32 v69, v69, v82
    v_mul_f32 v84, v67, v69
    v_mul_f32 v85, v67, v68
    v_fma_f32 v68, v66, v68, -v84
    v_fma_f32 v69, -v66, v69, -v85
    v_mul_f32 v82, v64, v45
    v_mul_f32 v83, v65, v45
    v_exp_f32 v82, v82
    v_fract_f32 v83, v83
    v_cos_f32 v70, v83
    v_sin_f32 v71, v83
    v_mul_f32 v70, v70, v82
    v_mul_f32 v71, v71, v82
    v_mul_f32 v84, v67, v71
    v_mul_f32 v85, v67, v70
    v_fma_f32 v70, v66, v70, -v84
    v_fma_f32 v71, -v66, v71, -v85
    v_mul_f32 v82, v64, v46
    v_mul_f32 v83, v65, v46
    v_exp_f32 v82, v82
    v_fract_f32 v83, v83
    v_cos_f32 v72, v83
    v_sin_f32 v73, v83
    v_mul_f32 v72, v72, v82
    v_mul_f32 v73, v73, v82
    v_mul_f32 v84, v67, v73
    v_mul_f32 v85, v67, v72
    v_fma_f32 v72, v66, v72, -v84
    v_fma_f32 v73, -v66, v73, -v85
    v_mfma_f32_16x16x4_f32 v[48:51], v68, v74, v[48:51]
    v_mfma_f32_16x16x4_f32 v[52:55], v70, v76, v[52:55]
    v_mfma_f32_16x16x4_f32 v[56:59], v70, v78, v[56:59]
    v_mfma_f32_16x16x4_f32 v[60:63], v72, v80, v[60:63]
    v_mfma_f32_16x16x4_f32 v[48:51], v69, v75, v[48:51]
    v_mfma_f32_16x16x4_f32 v[52:55], v71, v77, v[52:55]
    v_mfma_f32_16x16x4_f32 v[56:59], v71, v79, v[56:59]
    v_mfma_f32_16x16x4_f32 v[60:63], v73, v81, v[60:63]
    v_mov_b32_dpp v64, v28 row_newbcast:6 row_mask:0xf bank_mask:0xf
    v_mov_b32_dpp v65, v29 row_newbcast:6 row_mask:0xf bank_mask:0xf
    v_mov_b32_dpp v66, v30 row_newbcast:6 row_mask:0xf bank_mask:0xf
    v_mov_b32_dpp v67, v31 row_newbcast:6 row_mask:0xf bank_mask:0xf
    v_mul_f32 v82, v64, v47
    v_mul_f32 v83, v65, v47
    v_exp_f32 v82, v82
    v_fract_f32 v83, v83
    v_cos_f32 v74, v83
    v_sin_f32 v75, v83
    v_mul_f32 v74, v74, v82
    v_mul_f32 v75, v75, v82
    v_mul_f32 v84, v75, v75
    v_add_f32 v85, v74, v74
    v_fma_f32 v76, v74, v74, -v84
    v_mul_f32 v77, v85, v75
    v_mul_f32 v84, v77, v77
    v_add_f32 v85, v76, v76
    v_fma_f32 v78, v76, v76, -v84
    v_mul_f32 v79, v85, v77
    v_mul_f32 v84, v79, v79
    v_add_f32 v85, v78, v78
    v_fma_f32 v80, v78, v78, -v84
    v_mul_f32 v81, v85, v79
    v_mul_f32 v82, v64, v44
    v_mul_f32 v83, v65, v44
    v_exp_f32 v82, v82
    v_fract_f32 v83, v83
    v_cos_f32 v68, v83
    v_sin_f32 v69, v83
    v_mul_f32 v68, v68, v82
    v_mul_f32 v69, v69, v82
    v_mul_f32 v84, v67, v69
    v_mul_f32 v85, v67, v68
    v_fma_f32 v68, v66, v68, -v84
    v_fma_f32 v69, -v66, v69, -v85
    v_mul_f32 v82, v64, v45
    v_mul_f32 v83, v65, v45
    v_exp_f32 v82, v82
    v_fract_f32 v83, v83
    v_cos_f32 v70, v83
    v_sin_f32 v71, v83
    v_mul_f32 v70, v70, v82
    v_mul_f32 v71, v71, v82
    v_mul_f32 v84, v67, v71
    v_mul_f32 v85, v67, v70
    v_fma_f32 v70, v66, v70, -v84
    v_fma_f32 v71, -v66, v71, -v85
    v_mul_f32 v82, v64, v46
    v_mul_f32 v83, v65, v46
    v_exp_f32 v82, v82
    v_fract_f32 v83, v83
    v_cos_f32 v72, v83
    v_sin_f32 v73, v83
    v_mul_f32 v72, v72, v82
    v_mul_f32 v73, v73, v82
    v_mul_f32 v84, v67, v73
    v_mul_f32 v85, v67, v72
    v_fma_f32 v72, v66, v72, -v84
    v_fma_f32 v73, -v66, v73, -v85
    v_mfma_f32_16x16x4_f32 v[48:51], v68, v74, v[48:51]
    v_mfma_f32_16x16x4_f32 v[52:55], v70, v76, v[52:55]
    v_mfma_f32_16x16x4_f32 v[56:59], v70, v78, v[56:59]
    v_mfma_f32_16x16x4_f32 v[60:63], v72, v80, v[60:63]
    v_mfma_f32_16x16x4_f32 v[48:51], v69, v75, v[48:51]
    v_mfma_f32_16x16x4_f32 v[52:55], v71, v77, v[52:55]
    v_mfma_f32_16x16x4_f32 v[56:59], v71, v79, v[56:59]
    v_mfma_f32_16x16x4_f32 v[60:63], v73, v81, v[60:63]
    v_mov_b32_dpp v64, v28 row_newbcast:7 row_mask:0xf bank_mask:0xf
    v_mov_b32_dpp v65, v29 row_newbcast:7 row_mask:0xf bank_mask:0xf
    v_mov_b32_dpp v66, v30 row_newbcast:7 row_mask:0xf bank_mask:0xf
    v_mov_b32_dpp v67, v31 row_newbcast:7 row_mask:0xf bank_mask:0xf
    v_mul_f32 v82, v64, v47
    v_mul_f32 v83, v65, v47
    v_exp_f32 v82, v82
    v_fract_f32 v83, v83
    v_cos_f32 v74, v83
    v_sin_f32 v75, v83
    v_mul_f32 v74, v74, v82
    v_mul_f32 v75, v75, v82
    v_mul_f32 v84, v75, v75
    v_add_f32 v85, v74, v74
    v_fma_f32 v76, v74, v74, -v84
    v_mul_f32 v77, v85, v75
    v_mul_f32 v84, v77, v77
    v_add_f32 v85, v76, v76
    v_fma_f32 v78, v76, v76, -v84
    v_mul_f32 v79, v85, v77
    v_mul_f32 v84, v79, v79
    v_add_f32 v85, v78, v78
    v_fma_f32 v80, v78, v78, -v84
    v_mul_f32 v81, v85, v79
    v_mul_f32 v82, v64, v44
    v_mul_f32 v83, v65, v44
    v_exp_f32 v82, v82
    v_fract_f32 v83, v83
    v_cos_f32 v68, v83
    v_sin_f32 v69, v83
    v_mul_f32 v68, v68, v82
    v_mul_f32 v69, v69, v82
    v_mul_f32 v84, v67, v69
    v_mul_f32 v85, v67, v68
    v_fma_f32 v68, v66, v68, -v84
    v_fma_f32 v69, -v66, v69, -v85
    v_mul_f32 v82, v64, v45
    v_mul_f32 v83, v65, v45
    v_exp_f32 v82, v82
    v_fract_f32 v83, v83
    v_cos_f32 v70, v83
    v_sin_f32 v71, v83
    v_mul_f32 v70, v70, v82
    v_mul_f32 v71, v71, v82
    v_mul_f32 v84, v67, v71
    v_mul_f32 v85, v67, v70
    v_fma_f32 v70, v66, v70, -v84
    v_fma_f32 v71, -v66, v71, -v85
    v_mul_f32 v82, v64, v46
    v_mul_f32 v83, v65, v46
    v_exp_f32 v82, v82
    v_fract_f32 v83, v83
    v_cos_f32 v72, v83
    v_sin_f32 v73, v83
    v_mul_f32 v72, v72, v82
    v_mul_f32 v73, v73, v82
    v_mul_f32 v84, v67, v73
    v_mul_f32 v85, v67, v72
    v_fma_f32 v72, v66, v72, -v84
    v_fma_f32 v73, -v66, v73, -v85
    v_mfma_f32_16x16x4_f32 v[48:51], v68, v74, v[48:51]
    v_mfma_f32_16x16x4_f32 v[52:55], v70, v76, v[52:55]
    v_mfma_f32_16x16x4_f32 v[56:59], v70, v78, v[56:59]
    v_mfma_f32_16x16x4_f32 v[60:63], v72, v80, v[60:63]
    v_mfma_f32_16x16x4_f32 v[48:51], v69, v75, v[48:51]
    v_mfma_f32_16x16x4_f32 v[52:55], v71, v77, v[52:55]
    v_mfma_f32_16x16x4_f32 v[56:59], v71, v79, v[56:59]
    v_mfma_f32_16x16x4_f32 v[60:63], v73, v81, v[60:63]
    v_mov_b32_dpp v64, v28 row_newbcast:8 row_mask:0xf bank_mask:0xf
    v_mov_b32_dpp v65, v29 row_newbcast:8 row_mask:0xf bank_mask:0xf
    v_mov_b32_dpp v66, v30 row_newbcast:8 row_mask:0xf bank_mask:0xf
    v_mov_b32_dpp v67, v31 row_newbcast:8 row_mask:0xf bank_mask:0xf
    v_mul_f32 v82, v64, v47
    v_mul_f32 v83, v65, v47
    v_exp_f32 v82, v82
    v_fract_f32 v83, v83
    v_cos_f32 v74, v83
    v_sin_f32 v75, v83
    v_mul_f32 v74, v74, v82
    v_mul_f32 v75, v75, v82
    v_mul_f32 v84, v75, v75
    v_add_f32 v85, v74, v74
    v_fma_f32 v76, v74, v74, -v84
    v_mul_f32 v77, v85, v75
    v_mul_f32 v84, v77, v77
    v_add_f32 v85, v76, v76
    v_fma_f32 v78, v76, v76, -v84
    v_mul_f32 v79, v85, v77
    v_mul_f32 v84, v79, v79
    v_add_f32 v85, v78, v78
    v_fma_f32 v80, v78, v78, -v84
    v_mul_f32 v81, v85, v79
    v_mul_f32 v82, v64, v44
    v_mul_f32 v83, v65, v44
    v_exp_f32 v82, v82
    v_fract_f32 v83, v83
    v_cos_f32 v68, v83
    v_sin_f32 v69, v83
    v_mul_f32 v68, v68, v82
    v_mul_f32 v69, v69, v82
    v_mul_f32 v84, v67, v69
    v_mul_f32 v85, v67, v68
    v_fma_f32 v68, v66, v68, -v84
    v_fma_f32 v69, -v66, v69, -v85
    v_mul_f32 v82, v64, v45
    v_mul_f32 v83, v65, v45
    v_exp_f32 v82, v82
    v_fract_f32 v83, v83
    v_cos_f32 v70, v83
    v_sin_f32 v71, v83
    v_mul_f32 v70, v70, v82
    v_mul_f32 v71, v71, v82
    v_mul_f32 v84, v67, v71
    v_mul_f32 v85, v67, v70
    v_fma_f32 v70, v66, v70, -v84
    v_fma_f32 v71, -v66, v71, -v85
    v_mul_f32 v82, v64, v46
    v_mul_f32 v83, v65, v46
    v_exp_f32 v82, v82
    v_fract_f32 v83, v83
    v_cos_f32 v72, v83
    v_sin_f32 v73, v83
    v_mul_f32 v72, v72, v82
    v_mul_f32 v73, v73, v82
    v_mul_f32 v84, v67, v73
    v_mul_f32 v85, v67, v72
    v_fma_f32 v72, v66, v72, -v84
    v_fma_f32 v73, -v66, v73, -v85
    v_mfma_f32_16x16x4_f32 v[48:51], v68, v74, v[48:51]
    v_mfma_f32_16x16x4_f32 v[52:55], v70, v76, v[52:55]
    v_mfma_f32_16x16x4_f32 v[56:59], v70, v78, v[56:59]
    v_mfma_f32_16x16x4_f32 v[60:63], v72, v80, v[60:63]
    v_mfma_f32_16x16x4_f32 v[48:51], v69, v75, v[48:51]
    v_mfma_f32_16x16x4_f32 v[52:55], v71, v77, v[52:55]
    v_mfma_f32_16x16x4_f32 v[56:59], v71, v79, v[56:59]
    v_mfma_f32_16x16x4_f32 v[60:63], v73, v81, v[60:63]
    v_mov_b32_dpp v64, v28 row_newbcast:9 row_mask:0xf bank_mask:0xf
    v_mov_b32_dpp v65, v29 row_newbcast:9 row_mask:0xf bank_mask:0xf
    v_mov_b32_dpp v66, v30 row_newbcast:9 row_mask:0xf bank_mask:0xf
    v_mov_b32_dpp v67, v31 row_newbcast:9 row_mask:0xf bank_mask:0xf
    v_mul_f32 v82, v64, v47
    v_mul_f32 v83, v65, v47
    v_exp_f32 v82, v82
    v_fract_f32 v83, v83
    v_cos_f32 v74, v83
    v_sin_f32 v75, v83
    v_mul_f32 v74, v74, v82
    v_mul_f32 v75, v75, v82
    v_mul_f32 v84, v75, v75
    v_add_f32 v85, v74, v74
    v_fma_f32 v76, v74, v74, -v84
    v_mul_f32 v77, v85, v75
    v_mul_f32 v84, v77, v77
    v_add_f32 v85, v76, v76
    v_fma_f32 v78, v76, v76, -v84
    v_mul_f32 v79, v85, v77
    v_mul_f32 v84, v79, v79
    v_add_f32 v85, v78, v78
    v_fma_f32 v80, v78, v78, -v84
    v_mul_f32 v81, v85, v79
    v_mul_f32 v82, v64, v44
    v_mul_f32 v83, v65, v44
    v_exp_f32 v82, v82
    v_fract_f32 v83, v83
    v_cos_f32 v68, v83
    v_sin_f32 v69, v83
    v_mul_f32 v68, v68, v82
    v_mul_f32 v69, v69, v82
    v_mul_f32 v84, v67, v69
    v_mul_f32 v85, v67, v68
    v_fma_f32 v68, v66, v68, -v84
    v_fma_f32 v69, -v66, v69, -v85
    v_mul_f32 v82, v64, v45
    v_mul_f32 v83, v65, v45
    v_exp_f32 v82, v82
    v_fract_f32 v83, v83
    v_cos_f32 v70, v83
    v_sin_f32 v71, v83
    v_mul_f32 v70, v70, v82
    v_mul_f32 v71, v71, v82
    v_mul_f32 v84, v67, v71
    v_mul_f32 v85, v67, v70
    v_fma_f32 v70, v66, v70, -v84
    v_fma_f32 v71, -v66, v71, -v85
    v_mul_f32 v82, v64, v46
    v_mul_f32 v83, v65, v46
    v_exp_f32 v82, v82
    v_fract_f32 v83, v83
    v_cos_f32 v72, v83
    v_sin_f32 v73, v83
    v_mul_f32 v72, v72, v82
    v_mul_f32 v73, v73, v82
    v_mul_f32 v84, v67, v73
    v_mul_f32 v85, v67, v72
    v_fma_f32 v72, v66, v72, -v84
    v_fma_f32 v73, -v66, v73, -v85
    v_mfma_f32_16x16x4_f32 v[48:51], v68, v74, v[48:51]
    v_mfma_f32_16x16x4_f32 v[52:55], v70, v76, v[52:55]
    v_mfma_f32_16x16x4_f32 v[56:59], v70, v78, v[56:59]
    v_mfma_f32_16x16x4_f32 v[60:63], v72, v80, v[60:63]
    v_mfma_f32_16x16x4_f32 v[48:51], v69, v75, v[48:51]
    v_mfma_f32_16x16x4_f32 v[52:55], v71, v77, v[52:55]
    v_mfma_f32_16x16x4_f32 v[56:59], v71, v79, v[56:59]
    v_mfma_f32_16x16x4_f32 v[60:63], v73, v81, v[60:63]
    v_mov_b32_dpp v64, v28 row_newbcast:10 row_mask:0xf bank_mask:0xf
    v_mov_b32_dpp v65, v29 row_newbcast:10 row_mask:0xf bank_mask:0xf
    v_mov_b32_dpp v66, v30 row_newbcast:10 row_mask:0xf bank_mask:0xf
    v_mov_b32_dpp v67, v31 row_newbcast:10 row_mask:0xf bank_mask:0xf
    v_mul_f32 v82, v64, v47
    v_mul_f32 v83, v65, v47
    v_exp_f32 v82, v82
    v_fract_f32 v83, v83
    v_cos_f32 v74, v83
    v_sin_f32 v75, v83
    v_mul_f32 v74, v74, v82
    v_mul_f32 v75, v75, v82
    v_mul_f32 v84, v75, v75
    v_add_f32 v85, v74, v74
    v_fma_f32 v76, v74, v74, -v84
    v_mul_f32 v77, v85, v75
    v_mul_f32 v84, v77, v77
    v_add_f32 v85, v76, v76
    v_fma_f32 v78, v76, v76, -v84
    v_mul_f32 v79, v85, v77
    v_mul_f32 v84, v79, v79
    v_add_f32 v85, v78, v78
    v_fma_f32 v80, v78, v78, -v84
    v_mul_f32 v81, v85, v79
    v_mul_f32 v82, v64, v44
    v_mul_f32 v83, v65, v44
    v_exp_f32 v82, v82
    v_fract_f32 v83, v83
    v_cos_f32 v68, v83
    v_sin_f32 v69, v83
    v_mul_f32 v68, v68, v82
    v_mul_f32 v69, v69, v82
    v_mul_f32 v84, v67, v69
    v_mul_f32 v85, v67, v68
    v_fma_f32 v68, v66, v68, -v84
    v_fma_f32 v69, -v66, v69, -v85
    v_mul_f32 v82, v64, v45
    v_mul_f32 v83, v65, v45
    v_exp_f32 v82, v82
    v_fract_f32 v83, v83
    v_cos_f32 v70, v83
    v_sin_f32 v71, v83
    v_mul_f32 v70, v70, v82
    v_mul_f32 v71, v71, v82
    v_mul_f32 v84, v67, v71
    v_mul_f32 v85, v67, v70
    v_fma_f32 v70, v66, v70, -v84
    v_fma_f32 v71, -v66, v71, -v85
    v_mul_f32 v82, v64, v46
    v_mul_f32 v83, v65, v46
    v_exp_f32 v82, v82
    v_fract_f32 v83, v83
    v_cos_f32 v72, v83
    v_sin_f32 v73, v83
    v_mul_f32 v72, v72, v82
    v_mul_f32 v73, v73, v82
    v_mul_f32 v84, v67, v73
    v_mul_f32 v85, v67, v72
    v_fma_f32 v72, v66, v72, -v84
    v_fma_f32 v73, -v66, v73, -v85
    v_mfma_f32_16x16x4_f32 v[48:51], v68, v74, v[48:51]
    v_mfma_f32_16x16x4_f32 v[52:55], v70, v76, v[52:55]
    v_mfma_f32_16x16x4_f32 v[56:59], v70, v78, v[56:59]
    v_mfma_f32_16x16x4_f32 v[60:63], v72, v80, v[60:63]
    v_mfma_f32_16x16x4_f32 v[48:51], v69, v75, v[48:51]
    v_mfma_f32_16x16x4_f32 v[52:55], v71, v77, v[52:55]
    v_mfma_f32_16x16x4_f32 v[56:59], v71, v79, v[56:59]
    v_mfma_f32_16x16x4_f32 v[60:63], v73, v81, v[60:63]
    v_mov_b32_dpp v64, v28 row_newbcast:11 row_mask:0xf bank_mask:0xf
    v_mov_b32_dpp v65, v29 row_newbcast:11 row_mask:0xf bank_mask:0xf
    v_mov_b32_dpp v66, v30 row_newbcast:11 row_mask:0xf bank_mask:0xf
    v_mov_b32_dpp v67, v31 row_newbcast:11 row_mask:0xf bank_mask:0xf
    v_mul_f32 v82, v64, v47
    v_mul_f32 v83, v65, v47
    v_exp_f32 v82, v82
    v_fract_f32 v83, v83
    v_cos_f32 v74, v83
    v_sin_f32 v75, v83
    v_mul_f32 v74, v74, v82
    v_mul_f32 v75, v75, v82
    v_mul_f32 v84, v75, v75
    v_add_f32 v85, v74, v74
    v_fma_f32 v76, v74, v74, -v84
    v_mul_f32 v77, v85, v75
    v_mul_f32 v84, v77, v77
    v_add_f32 v85, v76, v76
    v_fma_f32 v78, v76, v76, -v84
    v_mul_f32 v79, v85, v77
    v_mul_f32 v84, v79, v79
    v_add_f32 v85, v78, v78
    v_fma_f32 v80, v78, v78, -v84
    v_mul_f32 v81, v85, v79
    v_mul_f32 v82, v64, v44
    v_mul_f32 v83, v65, v44
    v_exp_f32 v82, v82
    v_fract_f32 v83, v83
    v_cos_f32 v68, v83
    v_sin_f32 v69, v83
    v_mul_f32 v68, v68, v82
    v_mul_f32 v69, v69, v82
    v_mul_f32 v84, v67, v69
    v_mul_f32 v85, v67, v68
    v_fma_f32 v68, v66, v68, -v84
    v_fma_f32 v69, -v66, v69, -v85
    v_mul_f32 v82, v64, v45
    v_mul_f32 v83, v65, v45
    v_exp_f32 v82, v82
    v_fract_f32 v83, v83
    v_cos_f32 v70, v83
    v_sin_f32 v71, v83
    v_mul_f32 v70, v70, v82
    v_mul_f32 v71, v71, v82
    v_mul_f32 v84, v67, v71
    v_mul_f32 v85, v67, v70
    v_fma_f32 v70, v66, v70, -v84
    v_fma_f32 v71, -v66, v71, -v85
    v_mul_f32 v82, v64, v46
    v_mul_f32 v83, v65, v46
    v_exp_f32 v82, v82
    v_fract_f32 v83, v83
    v_cos_f32 v72, v83
    v_sin_f32 v73, v83
    v_mul_f32 v72, v72, v82
    v_mul_f32 v73, v73, v82
    v_mul_f32 v84, v67, v73
    v_mul_f32 v85, v67, v72
    v_fma_f32 v72, v66, v72, -v84
    v_fma_f32 v73, -v66, v73, -v85
    v_mfma_f32_16x16x4_f32 v[48:51], v68, v74, v[48:51]
    v_mfma_f32_16x16x4_f32 v[52:55], v70, v76, v[52:55]
    v_mfma_f32_16x16x4_f32 v[56:59], v70, v78, v[56:59]
    v_mfma_f32_16x16x4_f32 v[60:63], v72, v80, v[60:63]
    v_mfma_f32_16x16x4_f32 v[48:51], v69, v75, v[48:51]
    v_mfma_f32_16x16x4_f32 v[52:55], v71, v77, v[52:55]
    v_mfma_f32_16x16x4_f32 v[56:59], v71, v79, v[56:59]
    v_mfma_f32_16x16x4_f32 v[60:63], v73, v81, v[60:63]
    v_mov_b32_dpp v64, v28 row_newbcast:12 row_mask:0xf bank_mask:0xf
    v_mov_b32_dpp v65, v29 row_newbcast:12 row_mask:0xf bank_mask:0xf
    v_mov_b32_dpp v66, v30 row_newbcast:12 row_mask:0xf bank_mask:0xf
    v_mov_b32_dpp v67, v31 row_newbcast:12 row_mask:0xf bank_mask:0xf
    v_mul_f32 v82, v64, v47
    v_mul_f32 v83, v65, v47
    v_exp_f32 v82, v82
    v_fract_f32 v83, v83
    v_cos_f32 v74, v83
    v_sin_f32 v75, v83
    v_mul_f32 v74, v74, v82
    v_mul_f32 v75, v75, v82
    v_mul_f32 v84, v75, v75
    v_add_f32 v85, v74, v74
    v_fma_f32 v76, v74, v74, -v84
    v_mul_f32 v77, v85, v75
    v_mul_f32 v84, v77, v77
    v_add_f32 v85, v76, v76
    v_fma_f32 v78, v76, v76, -v84
    v_mul_f32 v79, v85, v77
    v_mul_f32 v84, v79, v79
    v_add_f32 v85, v78, v78
    v_fma_f32 v80, v78, v78, -v84
    v_mul_f32 v81, v85, v79
    v_mul_f32 v82, v64, v44
    v_mul_f32 v83, v65, v44
    v_exp_f32 v82, v82
    v_fract_f32 v83, v83
    v_cos_f32 v68, v83
    v_sin_f32 v69, v83
    v_mul_f32 v68, v68, v82
    v_mul_f32 v69, v69, v82
    v_mul_f32 v84, v67, v69
    v_mul_f32 v85, v67, v68
    v_fma_f32 v68, v66, v68, -v84
    v_fma_f32 v69, -v66, v69, -v85
    v_mul_f32 v82, v64, v45
    v_mul_f32 v83, v65, v45
    v_exp_f32 v82, v82
    v_fract_f32 v83, v83
    v_cos_f32 v70, v83
    v_sin_f32 v71, v83
    v_mul_f32 v70, v70, v82
    v_mul_f32 v71, v71, v82
    v_mul_f32 v84, v67, v71
    v_mul_f32 v85, v67, v70
    v_fma_f32 v70, v66, v70, -v84
    v_fma_f32 v71, -v66, v71, -v85
    v_mul_f32 v82, v64, v46
    v_mul_f32 v83, v65, v46
    v_exp_f32 v82, v82
    v_fract_f32 v83, v83
    v_cos_f32 v72, v83
    v_sin_f32 v73, v83
    v_mul_f32 v72, v72, v82
    v_mul_f32 v73, v73, v82
    v_mul_f32 v84, v67, v73
    v_mul_f32 v85, v67, v72
    v_fma_f32 v72, v66, v72, -v84
    v_fma_f32 v73, -v66, v73, -v85
    v_mfma_f32_16x16x4_f32 v[48:51], v68, v74, v[48:51]
    v_mfma_f32_16x16x4_f32 v[52:55], v70, v76, v[52:55]
    v_mfma_f32_16x16x4_f32 v[56:59], v70, v78, v[56:59]
    v_mfma_f32_16x16x4_f32 v[60:63], v72, v80, v[60:63]
    v_mfma_f32_16x16x4_f32 v[48:51], v69, v75, v[48:51]
    v_mfma_f32_16x16x4_f32 v[52:55], v71, v77, v[52:55]
    v_mfma_f32_16x16x4_f32 v[56:59], v71, v79, v[56:59]
    v_mfma_f32_16x16x4_f32 v[60:63], v73, v81, v[60:63]
    v_mov_b32_dpp v64, v28 row_newbcast:13 row_mask:0xf bank_mask:0xf
    v_mov_b32_dpp v65, v29 row_newbcast:13 row_mask:0xf bank_mask:0xf
    v_mov_b32_dpp v66, v30 row_newbcast:13 row_mask:0xf bank_mask:0xf
    v_mov_b32_dpp v67, v31 row_newbcast:13 row_mask:0xf bank_mask:0xf
    v_mul_f32 v82, v64, v47
    v_mul_f32 v83, v65, v47
    v_exp_f32 v82, v82
    v_fract_f32 v83, v83
    v_cos_f32 v74, v83
    v_sin_f32 v75, v83
    v_mul_f32 v74, v74, v82
    v_mul_f32 v75, v75, v82
    v_mul_f32 v84, v75, v75
    v_add_f32 v85, v74, v74
    v_fma_f32 v76, v74, v74, -v84
    v_mul_f32 v77, v85, v75
    v_mul_f32 v84, v77, v77
    v_add_f32 v85, v76, v76
    v_fma_f32 v78, v76, v76, -v84
    v_mul_f32 v79, v85, v77
    v_mul_f32 v84, v79, v79
    v_add_f32 v85, v78, v78
    v_fma_f32 v80, v78, v78, -v84
    v_mul_f32 v81, v85, v79
    v_mul_f32 v82, v64, v44
    v_mul_f32 v83, v65, v44
    v_exp_f32 v82, v82
    v_fract_f32 v83, v83
    v_cos_f32 v68, v83
    v_sin_f32 v69, v83
    v_mul_f32 v68, v68, v82
    v_mul_f32 v69, v69, v82
    v_mul_f32 v84, v67, v69
    v_mul_f32 v85, v67, v68
    v_fma_f32 v68, v66, v68, -v84
    v_fma_f32 v69, -v66, v69, -v85
    v_mul_f32 v82, v64, v45
    v_mul_f32 v83, v65, v45
    v_exp_f32 v82, v82
    v_fract_f32 v83, v83
    v_cos_f32 v70, v83
    v_sin_f32 v71, v83
    v_mul_f32 v70, v70, v82
    v_mul_f32 v71, v71, v82
    v_mul_f32 v84, v67, v71
    v_mul_f32 v85, v67, v70
    v_fma_f32 v70, v66, v70, -v84
    v_fma_f32 v71, -v66, v71, -v85
    v_mul_f32 v82, v64, v46
    v_mul_f32 v83, v65, v46
    v_exp_f32 v82, v82
    v_fract_f32 v83, v83
    v_cos_f32 v72, v83
    v_sin_f32 v73, v83
    v_mul_f32 v72, v72, v82
    v_mul_f32 v73, v73, v82
    v_mul_f32 v84, v67, v73
    v_mul_f32 v85, v67, v72
    v_fma_f32 v72, v66, v72, -v84
    v_fma_f32 v73, -v66, v73, -v85
    v_mfma_f32_16x16x4_f32 v[48:51], v68, v74, v[48:51]
    v_mfma_f32_16x16x4_f32 v[52:55], v70, v76, v[52:55]
    v_mfma_f32_16x16x4_f32 v[56:59], v70, v78, v[56:59]
    v_mfma_f32_16x16x4_f32 v[60:63], v72, v80, v[60:63]
    v_mfma_f32_16x16x4_f32 v[48:51], v69, v75, v[48:51]
    v_mfma_f32_16x16x4_f32 v[52:55], v71, v77, v[52:55]
    v_mfma_f32_16x16x4_f32 v[56:59], v71, v79, v[56:59]
    v_mfma_f32_16x16x4_f32 v[60:63], v73, v81, v[60:63]
    v_mov_b32_dpp v64, v28 row_newbcast:14 row_mask:0xf bank_mask:0xf
    v_mov_b32_dpp v65, v29 row_newbcast:14 row_mask:0xf bank_mask:0xf
    v_mov_b32_dpp v66, v30 row_newbcast:14 row_mask:0xf bank_mask:0xf
    v_mov_b32_dpp v67, v31 row_newbcast:14 row_mask:0xf bank_mask:0xf
    v_mul_f32 v82, v64, v47
    v_mul_f32 v83, v65, v47
    v_exp_f32 v82, v82
    v_fract_f32 v83, v83
    v_cos_f32 v74, v83
    v_sin_f32 v75, v83
    v_mul_f32 v74, v74, v82
    v_mul_f32 v75, v75, v82
    v_mul_f32 v84, v75, v75
    v_add_f32 v85, v74, v74
    v_fma_f32 v76, v74, v74, -v84
    v_mul_f32 v77, v85, v75
    v_mul_f32 v84, v77, v77
    v_add_f32 v85, v76, v76
    v_fma_f32 v78, v76, v76, -v84
    v_mul_f32 v79, v85, v77
    v_mul_f32 v84, v79, v79
    v_add_f32 v85, v78, v78
    v_fma_f32 v80, v78, v78, -v84
    v_mul_f32 v81, v85, v79
    v_mul_f32 v82, v64, v44
    v_mul_f32 v83, v65, v44
    v_exp_f32 v82, v82
    v_fract_f32 v83, v83
    v_cos_f32 v68, v83
    v_sin_f32 v69, v83
    v_mul_f32 v68, v68, v82
    v_mul_f32 v69, v69, v82
    v_mul_f32 v84, v67, v69
    v_mul_f32 v85, v67, v68
    v_fma_f32 v68, v66, v68, -v84
    v_fma_f32 v69, -v66, v69, -v85
    v_mul_f32 v82, v64, v45
    v_mul_f32 v83, v65, v45
    v_exp_f32 v82, v82
    v_fract_f32 v83, v83
    v_cos_f32 v70, v83
    v_sin_f32 v71, v83
    v_mul_f32 v70, v70, v82
    v_mul_f32 v71, v71, v82
    v_mul_f32 v84, v67, v71
    v_mul_f32 v85, v67, v70
    v_fma_f32 v70, v66, v70, -v84
    v_fma_f32 v71, -v66, v71, -v85
    v_mul_f32 v82, v64, v46
    v_mul_f32 v83, v65, v46
    v_exp_f32 v82, v82
    v_fract_f32 v83, v83
    v_cos_f32 v72, v83
    v_sin_f32 v73, v83
    v_mul_f32 v72, v72, v82
    v_mul_f32 v73, v73, v82
    v_mul_f32 v84, v67, v73
    v_mul_f32 v85, v67, v72
    v_fma_f32 v72, v66, v72, -v84
    v_fma_f32 v73, -v66, v73, -v85
    v_mfma_f32_16x16x4_f32 v[48:51], v68, v74, v[48:51]
    v_mfma_f32_16x16x4_f32 v[52:55], v70, v76, v[52:55]
    v_mfma_f32_16x16x4_f32 v[56:59], v70, v78, v[56:59]
    v_mfma_f32_16x16x4_f32 v[60:63], v72, v80, v[60:63]
    v_mfma_f32_16x16x4_f32 v[48:51], v69, v75, v[48:51]
    v_mfma_f32_16x16x4_f32 v[52:55], v71, v77, v[52:55]
    v_mfma_f32_16x16x4_f32 v[56:59], v71, v79, v[56:59]
    v_mfma_f32_16x16x4_f32 v[60:63], v73, v81, v[60:63]
    v_mov_b32_dpp v64, v28 row_newbcast:15 row_mask:0xf bank_mask:0xf
    v_mov_b32_dpp v65, v29 row_newbcast:15 row_mask:0xf bank_mask:0xf
    v_mov_b32_dpp v66, v30 row_newbcast:15 row_mask:0xf bank_mask:0xf
    v_mov_b32_dpp v67, v31 row_newbcast:15 row_mask:0xf bank_mask:0xf
    v_mul_f32 v82, v64, v47
    v_mul_f32 v83, v65, v47
    v_exp_f32 v82, v82
    v_fract_f32 v83, v83
    v_cos_f32 v74, v83
    v_sin_f32 v75, v83
    v_mul_f32 v74, v74, v82
    v_mul_f32 v75, v75, v82
    v_mul_f32 v84, v75, v75
    v_add_f32 v85, v74, v74
    v_fma_f32 v76, v74, v74, -v84
    v_mul_f32 v77, v85, v75
    v_mul_f32 v84, v77, v77
    v_add_f32 v85, v76, v76
    v_fma_f32 v78, v76, v76, -v84
    v_mul_f32 v79, v85, v77
    v_mul_f32 v84, v79, v79
    v_add_f32 v85, v78, v78
    v_fma_f32 v80, v78, v78, -v84
    v_mul_f32 v81, v85, v79
    v_mul_f32 v82, v64, v44
    v_mul_f32 v83, v65, v44
    v_exp_f32 v82, v82
    v_fract_f32 v83, v83
    v_cos_f32 v68, v83
    v_sin_f32 v69, v83
    v_mul_f32 v68, v68, v82
    v_mul_f32 v69, v69, v82
    v_mul_f32 v84, v67, v69
    v_mul_f32 v85, v67, v68
    v_fma_f32 v68, v66, v68, -v84
    v_fma_f32 v69, -v66, v69, -v85
    v_mul_f32 v82, v64, v45
    v_mul_f32 v83, v65, v45
    v_exp_f32 v82, v82
    v_fract_f32 v83, v83
    v_cos_f32 v70, v83
    v_sin_f32 v71, v83
    v_mul_f32 v70, v70, v82
    v_mul_f32 v71, v71, v82
    v_mul_f32 v84, v67, v71
    v_mul_f32 v85, v67, v70
    v_fma_f32 v70, v66, v70, -v84
    v_fma_f32 v71, -v66, v71, -v85
    v_mul_f32 v82, v64, v46
    v_mul_f32 v83, v65, v46
    v_exp_f32 v82, v82
    v_fract_f32 v83, v83
    v_cos_f32 v72, v83
    v_sin_f32 v73, v83
    v_mul_f32 v72, v72, v82
    v_mul_f32 v73, v73, v82
    v_mul_f32 v84, v67, v73
    v_mul_f32 v85, v67, v72
    v_fma_f32 v72, v66, v72, -v84
    v_fma_f32 v73, -v66, v73, -v85
    v_mfma_f32_16x16x4_f32 v[48:51], v68, v74, v[48:51]
    v_mfma_f32_16x16x4_f32 v[52:55], v70, v76, v[52:55]
    v_mfma_f32_16x16x4_f32 v[56:59], v70, v78, v[56:59]
    v_mfma_f32_16x16x4_f32 v[60:63], v72, v80, v[60:63]
    v_mfma_f32_16x16x4_f32 v[48:51], v69, v75, v[48:51]
    v_mfma_f32_16x16x4_f32 v[52:55], v71, v77, v[52:55]
    v_mfma_f32_16x16x4_f32 v[56:59], v71, v79, v[56:59]
    v_mfma_f32_16x16x4_f32 v[60:63], v73, v81, v[60:63]
    v_lshlrev_b32 v5, 8, v3
    v_lshl_add_u32 v5, v2, 2, v5
    v_add_u32 v5, v5, v4
    s_nop 5
    ds_write_b32 v5, v48 offset:4608
    ds_write_b32 v5, v49 offset:4672
    ds_write_b32 v5, v50 offset:4736
    ds_write_b32 v5, v51 offset:4800
    v_cmp_gt_u32 vcc, 2, v3
    s_nop 0
    s_mov_b64 exec, vcc
    ds_write_b32 v5, v52 offset:5632
    ds_write_b32 v5, v53 offset:5696
    ds_write_b32 v5, v54 offset:5760
    ds_write_b32 v5, v55 offset:5824
    ds_write_b32 v5, v60 offset:6656
    ds_write_b32 v5, v61 offset:6720
    ds_write_b32 v5, v62 offset:6784
    ds_write_b32 v5, v63 offset:6848
    s_not_b64 exec, exec
    ds_write_b32 v5, v56 offset:5632
    ds_write_b32 v5, v57 offset:5696
    ds_write_b32 v5, v58 offset:5760
    ds_write_b32 v5, v59 offset:5824
    s_mov_b32 exec_lo, 0
    s_mov_b32 exec_hi, 3
    v_cmp_eq_u32 vcc, 0, v2
    s_nop 1
    v_cndmask_b32 v6, 0, v60, vcc
    ds_write_b32 v5, v6 offset:6656
    s_mov_b64 exec, -1
    s_waitcnt lgkmcnt(0)
    v_lshlrev_b32 v7, 1, v1
    v_sub_u32 v7, 2065, v7
    v_lshl_add_u32 v64, v1, 2, v4
    v_mov_b32 v65, 641
    s_mov_b32 s25, 17
ss_exp:
    v_subrev_u32 v66, 0, v7
    v_cvt_f32_u32 v70, v66
    v_cvt_pk_bf16_f32 v70, v70, v70
    v_and_b32 v70, 0xffff, v70
    v_subrev_u32 v70, 0x4280, v70
    v_cmp_gt_u32 vcc, 256, v66
    s_nop 1
    v_cndmask_b32 v70, v70, v66, vcc
    v_cmp_gt_u32 vcc, 2048, v66
    s_nop 1
    v_cndmask_b32 v70, v65, v70, vcc
    v_lshl_add_u32 v70, v70, 2, v4
    ds_read_b32 v74, v70 offset:4608
    v_subrev_u32 v67, 1, v7
    v_cvt_f32_u32 v71, v67
    v_cvt_pk_bf16_f32 v71, v71, v71
    v_and_b32 v71, 0xffff, v71
    v_subrev_u32 v71, 0x4280, v71
    v_cmp_gt_u32 vcc, 256, v67
    s_nop 1
    v_cndmask_b32 v71, v71, v67, vcc
    v_cmp_gt_u32 vcc, 2048, v67
    s_nop 1
    v_cndmask_b32 v71, v65, v71, vcc
    v_lshl_add_u32 v71, v71, 2, v4
    ds_read_b32 v75, v71 offset:4608
    v_subrev_u32 v68, 2, v7
    v_cvt_f32_u32 v72, v68
    v_cvt_pk_bf16_f32 v72, v72, v72
    v_and_b32 v72, 0xffff, v72
    v_subrev_u32 v72, 0x4280, v72
    v_cmp_gt_u32 vcc, 256, v68
    s_nop 1
    v_cndmask_b32 v72, v72, v68, vcc
    v_cmp_gt_u32 vcc, 2048, v68
    s_nop 1
    v_cndmask_b32 v72, v65, v72, vcc
    v_lshl_add_u32 v72, v72, 2, v4
    ds_read_b32 v76, v72 offset:4608
    s_waitcnt lgkmcnt(0)
    v_cvt_pk_bf16_f32 v78, v75, v76
    v_cvt_pk_bf16_f32 v79, v74, v75
    ds_write_b32 v64, v78 offset:7424
    ds_write_b32 v64, v79 offset:11776
    v_subrev_u32 v7, 128, v7
    v_add_u32 v64, 256, v64
    s_sub_u32 s25, s25, 1
    s_cmp_lg_u32 s25, 0
    s_cbranch_scc1 ss_exp
    s_waitcnt lgkmcnt(0)
    s_barrier
    v_and_b32 v5, 1, v2
    v_mul_u32_u24 v64, 4352, v5
    v_sub_u32 v5, v5, v2
    v_lshl_add_u32 v5, v3, 3, v5
    v_lshl_add_u32 v64, v5, 1, v64
    v_add_u32 v64, 11520, v64
    v_add_u32 v64, v64, v4
    v_lshlrev_b32 v65, 5, v2
    v_lshl_add_u32 v65, v3, 4, v65
    v_add_u32 v65, 480, v65
    v_add_u32 v65, v65, v4
    v_mov_b32 v96, 0
    v_mov_b32 v97, 0
    v_mov_b32 v98, 0
    v_mov_b32 v99, 0
    v_mov_b32 v100, 0
    v_mov_b32 v101, 0
    v_mov_b32 v102, 0
    v_mov_b32 v103, 0
    v_mov_b32 v104, 0
    v_mov_b32 v105, 0
    v_mov_b32 v106, 0
    v_mov_b32 v107, 0
    v_mov_b32 v108, 0
    v_mov_b32 v109, 0
    v_mov_b32 v110, 0
    v_mov_b32 v111, 0
    v_mov_b32 v112, 0
    v_mov_b32 v113, 0
    v_mov_b32 v114, 0
    v_mov_b32 v115, 0
    v_mov_b32 v116, 0
    v_mov_b32 v117, 0
    v_mov_b32 v118, 0
    v_mov_b32 v119, 0
    v_mov_b32 v120, 0
    v_mov_b32 v121, 0
    v_mov_b32 v122, 0
    v_mov_b32 v123, 0
    v_mov_b32 v124, 0
    v_mov_b32 v125, 0
    v_mov_b32 v126, 0
    v_mov_b32 v127, 0
    s_mov_b32 s25, 8
ss_cv0:
    ds_read2_b32 v[68:69], v64 offset0:0 offset1:1
    ds_read2_b32 v[70:71], v64 offset0:2 offset1:3
    ds_read_b128 v[128:131], v65 offset:0
    ds_read_b128 v[132:135], v65 offset:512
    ds_read_b128 v[136:139], v65 offset:1024
    ds_read_b128 v[140:143], v65 offset:1536
    ds_read_b128 v[144:147], v65 offset:2048
    ds_read_b128 v[148:151], v65 offset:2560
    ds_read_b128 v[152:155], v65 offset:3072
    ds_read_b128 v[156:159], v65 offset:3584
    v_subrev_u32 v64, 64, v64
    v_subrev_u32 v65, 64, v65
    s_waitcnt lgkmcnt(7)
    v_mfma_f32_16x16x32_bf16 v[96:99], v[68:71], v[128:131], v[96:99]
    s_waitcnt lgkmcnt(6)
    v_mfma_f32_16x16x32_bf16 v[100:103], v[68:71], v[132:135], v[100:103]
    s_waitcnt lgkmcnt(5)
    v_mfma_f32_16x16x32_bf16 v[104:107], v[68:71], v[136:139], v[104:107]
    s_waitcnt lgkmcnt(4)
    v_mfma_f32_16x16x32_bf16 v[108:111], v[68:71], v[140:143], v[108:111]
    s_waitcnt lgkmcnt(3)
    v_mfma_f32_16x16x32_bf16 v[112:115], v[68:71], v[144:147], v[112:115]
    s_waitcnt lgkmcnt(2)
    v_mfma_f32_16x16x32_bf16 v[116:119], v[68:71], v[148:151], v[116:119]
    s_waitcnt lgkmcnt(1)
    v_mfma_f32_16x16x32_bf16 v[120:123], v[68:71], v[152:155], v[120:123]
    s_waitcnt lgkmcnt(0)
    v_mfma_f32_16x16x32_bf16 v[124:127], v[68:71], v[156:159], v[124:127]
    s_sub_u32 s25, s25, 1
    s_cmp_lg_u32 s25, 0
    s_cbranch_scc1 ss_cv0
    v_add_u32 v65, 512, v65
    s_mov_b32 s25, 8
ss_cv1:
    ds_read2_b32 v[68:69], v64 offset0:0 offset1:1
    ds_read2_b32 v[70:71], v64 offset0:2 offset1:3
    ds_read_b128 v[132:135], v65 offset:0
    ds_read_b128 v[136:139], v65 offset:512
    ds_read_b128 v[140:143], v65 offset:1024
    ds_read_b128 v[144:147], v65 offset:1536
    ds_read_b128 v[148:151], v65 offset:2048
    ds_read_b128 v[152:155], v65 offset:2560
    ds_read_b128 v[156:159], v65 offset:3072
    v_subrev_u32 v64, 64, v64
    v_subrev_u32 v65, 64, v65
    s_waitcnt lgkmcnt(6)
    v_mfma_f32_16x16x32_bf16 v[100:103], v[68:71], v[132:135], v[100:103]
    s_waitcnt lgkmcnt(5)
    v_mfma_f32_16x16x32_bf16 v[104:107], v[68:71], v[136:139], v[104:107]
    s_waitcnt lgkmcnt(4)
    v_mfma_f32_16x16x32_bf16 v[108:111], v[68:71], v[140:143], v[108:111]
    s_waitcnt lgkmcnt(3)
    v_mfma_f32_16x16x32_bf16 v[112:115], v[68:71], v[144:147], v[112:115]
    s_waitcnt lgkmcnt(2)
    v_mfma_f32_16x16x32_bf16 v[116:119], v[68:71], v[148:151], v[116:119]
    s_waitcnt lgkmcnt(1)
    v_mfma_f32_16x16x32_bf16 v[120:123], v[68:71], v[152:155], v[120:123]
    s_waitcnt lgkmcnt(0)
    v_mfma_f32_16x16x32_bf16 v[124:127], v[68:71], v[156:159], v[124:127]
    s_sub_u32 s25, s25, 1
    s_cmp_lg_u32 s25, 0
    s_cbranch_scc1 ss_cv1
    v_add_u32 v65, 512, v65
    s_mov_b32 s25, 8
ss_cv2:
    ds_read2_b32 v[68:69], v64 offset0:0 offset1:1
    ds_read2_b32 v[70:71], v64 offset0:2 offset1:3
    ds_read_b128 v[136:139], v65 offset:0
    ds_read_b128 v[140:143], v65 offset:512
    ds_read_b128 v[144:147], v65 offset:1024
    ds_read_b128 v[148:151], v65 offset:1536
    ds_read_b128 v[152:155], v65 offset:2048
    ds_read_b128 v[156:159], v65 offset:2560
    v_subrev_u32 v64, 64, v64
    v_subrev_u32 v65, 64, v65
    s_waitcnt lgkmcnt(5)
    v_mfma_f32_16x16x32_bf16 v[104:107], v[68:71], v[136:139], v[104:107]
    s_waitcnt lgkmcnt(4)
    v_mfma_f32_16x16x32_bf16 v[108:111], v[68:71], v[140:143], v[108:111]
    s_waitcnt lgkmcnt(3)
    v_mfma_f32_16x16x32_bf16 v[112:115], v[68:71], v[144:147], v[112:115]
    s_waitcnt lgkmcnt(2)
    v_mfma_f32_16x16x32_bf16 v[116:119], v[68:71], v[148:151], v[116:119]
    s_waitcnt lgkmcnt(1)
    v_mfma_f32_16x16x32_bf16 v[120:123], v[68:71], v[152:155], v[120:123]
    s_waitcnt lgkmcnt(0)
    v_mfma_f32_16x16x32_bf16 v[124:127], v[68:71], v[156:159], v[124:127]
    s_sub_u32 s25, s25, 1
    s_cmp_lg_u32 s25, 0
    s_cbranch_scc1 ss_cv2
    v_add_u32 v65, 512, v65
    s_mov_b32 s25, 8
ss_cv3:
    ds_read2_b32 v[68:69], v64 offset0:0 offset1:1
    ds_read2_b32 v[70:71], v64 offset0:2 offset1:3
    ds_read_b128 v[140:143], v65 offset:0
    ds_read_b128 v[144:147], v65 offset:512
    ds_read_b128 v[148:151], v65 offset:1024
    ds_read_b128 v[152:155], v65 offset:1536
    ds_read_b128 v[156:159], v65 offset:2048
    v_subrev_u32 v64, 64, v64
    v_subrev_u32 v65, 64, v65
    s_waitcnt lgkmcnt(4)
    v_mfma_f32_16x16x32_bf16 v[108:111], v[68:71], v[140:143], v[108:111]
    s_waitcnt lgkmcnt(3)
    v_mfma_f32_16x16x32_bf16 v[112:115], v[68:71], v[144:147], v[112:115]
    s_waitcnt lgkmcnt(2)
    v_mfma_f32_16x16x32_bf16 v[116:119], v[68:71], v[148:151], v[116:119]
    s_waitcnt lgkmcnt(1)
    v_mfma_f32_16x16x32_bf16 v[120:123], v[68:71], v[152:155], v[120:123]
    s_waitcnt lgkmcnt(0)
    v_mfma_f32_16x16x32_bf16 v[124:127], v[68:71], v[156:159], v[124:127]
    s_sub_u32 s25, s25, 1
    s_cmp_lg_u32 s25, 0
    s_cbranch_scc1 ss_cv3
    v_add_u32 v65, 512, v65
    s_mov_b32 s25, 8
ss_cv4:
    ds_read2_b32 v[68:69], v64 offset0:0 offset1:1
    ds_read2_b32 v[70:71], v64 offset0:2 offset1:3
    ds_read_b128 v[144:147], v65 offset:0
    ds_read_b128 v[148:151], v65 offset:512
    ds_read_b128 v[152:155], v65 offset:1024
    ds_read_b128 v[156:159], v65 offset:1536
    v_subrev_u32 v64, 64, v64
    v_subrev_u32 v65, 64, v65
    s_waitcnt lgkmcnt(3)
    v_mfma_f32_16x16x32_bf16 v[112:115], v[68:71], v[144:147], v[112:115]
    s_waitcnt lgkmcnt(2)
    v_mfma_f32_16x16x32_bf16 v[116:119], v[68:71], v[148:151], v[116:119]
    s_waitcnt lgkmcnt(1)
    v_mfma_f32_16x16x32_bf16 v[120:123], v[68:71], v[152:155], v[120:123]
    s_waitcnt lgkmcnt(0)
    v_mfma_f32_16x16x32_bf16 v[124:127], v[68:71], v[156:159], v[124:127]
    s_sub_u32 s25, s25, 1
    s_cmp_lg_u32 s25, 0
    s_cbranch_scc1 ss_cv4
    v_add_u32 v65, 512, v65
    s_mov_b32 s25, 8
ss_cv5:
    ds_read2_b32 v[68:69], v64 offset0:0 offset1:1
    ds_read2_b32 v[70:71], v64 offset0:2 offset1:3
    ds_read_b128 v[148:151], v65 offset:0
    ds_read_b128 v[152:155], v65 offset:512
    ds_read_b128 v[156:159], v65 offset:1024
    v_subrev_u32 v64, 64, v64
    v_subrev_u32 v65, 64, v65
    s_waitcnt lgkmcnt(2)
    v_mfma_f32_16x16x32_bf16 v[116:119], v[68:71], v[148:151], v[116:119]
    s_waitcnt lgkmcnt(1)
    v_mfma_f32_16x16x32_bf16 v[120:123], v[68:71], v[152:155], v[120:123]
    s_waitcnt lgkmcnt(0)
    v_mfma_f32_16x16x32_bf16 v[124:127], v[68:71], v[156:159], v[124:127]
    s_sub_u32 s25, s25, 1
    s_cmp_lg_u32 s25, 0
    s_cbranch_scc1 ss_cv5
    v_add_u32 v65, 512, v65
    s_mov_b32 s25, 8
ss_cv6:
    ds_read2_b32 v[68:69], v64 offset0:0 offset1:1
    ds_read2_b32 v[70:71], v64 offset0:2 offset1:3
    ds_read_b128 v[152:155], v65 offset:0
    ds_read_b128 v[156:159], v65 offset:512
    v_subrev_u32 v64, 64, v64
    v_subrev_u32 v65, 64, v65
    s_waitcnt lgkmcnt(1)
    v_mfma_f32_16x16x32_bf16 v[120:123], v[68:71], v[152:155], v[120:123]
    s_waitcnt lgkmcnt(0)
    v_mfma_f32_16x16x32_bf16 v[124:127], v[68:71], v[156:159], v[124:127]
    s_sub_u32 s25, s25, 1
    s_cmp_lg_u32 s25, 0
    s_cbranch_scc1 ss_cv6
    v_add_u32 v65, 512, v65
    s_mov_b32 s25, 8
ss_cv7:
    ds_read2_b32 v[68:69], v64 offset0:0 offset1:1
    ds_read2_b32 v[70:71], v64 offset0:2 offset1:3
    ds_read_b128 v[156:159], v65 offset:0
    v_subrev_u32 v64, 64, v64
    v_subrev_u32 v65, 64, v65
    s_waitcnt lgkmcnt(0)
    v_mfma_f32_16x16x32_bf16 v[124:127], v[68:71], v[156:159], v[124:127]
    s_sub_u32 s25, s25, 1
    s_cmp_lg_u32 s25, 0
    s_cbranch_scc1 ss_cv7
    v_add_u32 v65, 512, v65
    s_nop 3
    v_lshlrev_b32 v5, 6, v2
    v_lshl_add_u32 v5, v3, 4, v5
    v_add_u32 v5, v5, v4
    ds_write_b128 v5, v[96:99] offset:7424
    ds_write_b128 v5, v[100:103] offset:8448
    ds_write_b128 v5, v[104:107] offset:9472
    ds_write_b128 v5, v[108:111] offset:10496
    ds_write_b128 v5, v[112:115] offset:11520
    ds_write_b128 v5, v[116:119] offset:12544
    ds_write_b128 v5, v[120:123] offset:13568
    ds_write_b128 v5, v[124:127] offset:14592
    s_mov_b32 s12, s74
    s_mov_b32 s13, s75
    s_mov_b32 s14, 1152
    s_mov_b32 s15, 0x20000
    s_lshl_b32 s23, s20, 1
    buffer_load_dwordx2 v[24:25], off, s[12:15], s23
    s_waitcnt vmcnt(0) lgkmcnt(0)
    s_barrier
    v_lshlrev_b32 v26, 16, v24
    v_and_b32 v27, 0xffff0000, v24
    v_lshlrev_b32 v28, 16, v25
    v_and_b32 v29, 0xffff0000, v25
    v_lshlrev_b32 v5, 5, v0
    ds_read_b128 v[64:67], v5 offset:7424
    ds_read_b128 v[68:71], v5 offset:7440
    ds_read_b128 v[72:75], v5 offset:23808
    ds_read_b128 v[76:79], v5 offset:23824
    ds_read_b128 v[80:83], v5 offset:40192
    ds_read_b128 v[84:87], v5 offset:40208
    ds_read_b128 v[88:91], v5 offset:56576
    ds_read_b128 v[92:95], v5 offset:56592
    s_waitcnt lgkmcnt(0)
    v_mul_u32_u24 v5, 18432, v0
    s_lshl_b32 s22, s20, 1
    s_add_u32 s22, s22, 1152
    v_lshlrev_b32 v6, 16, v8
    v_fmac_f32 v64, v6, v26
    v_and_b32 v6, 0xffff0000, v8
    v_fmac_f32 v72, v6, v27
    v_lshlrev_b32 v6, 16, v9
    v_fmac_f32 v80, v6, v28
    v_and_b32 v6, 0xffff0000, v9
    v_fmac_f32 v88, v6, v29
    v_cvt_pk_bf16_f32 v8, v64, v72
    v_cvt_pk_bf16_f32 v9, v80, v88
    s_add_u32 s23, s22, 0
    buffer_store_dwordx2 v[8:9], v5, s[16:19], s23 offen
    v_lshlrev_b32 v6, 16, v10
    v_fmac_f32 v65, v6, v26
    v_and_b32 v6, 0xffff0000, v10
    v_fmac_f32 v73, v6, v27
    v_lshlrev_b32 v6, 16, v11
    v_fmac_f32 v81, v6, v28
    v_and_b32 v6, 0xffff0000, v11
    v_fmac_f32 v89, v6, v29
    v_cvt_pk_bf16_f32 v10, v65, v73
    v_cvt_pk_bf16_f32 v11, v81, v89
    s_add_u32 s23, s22, 2304
    buffer_store_dwordx2 v[10:11], v5, s[16:19], s23 offen
    v_lshlrev_b32 v6, 16, v12
    v_fmac_f32 v66, v6, v26
    v_and_b32 v6, 0xffff0000, v12
    v_fmac_f32 v74, v6, v27
    v_lshlrev_b32 v6, 16, v13
    v_fmac_f32 v82, v6, v28
    v_and_b32 v6, 0xffff0000, v13
    v_fmac_f32 v90, v6, v29
    v_cvt_pk_bf16_f32 v12, v66, v74
    v_cvt_pk_bf16_f32 v13, v82, v90
    s_add_u32 s23, s22, 4608
    buffer_store_dwordx2 v[12:13], v5, s[16:19], s23 offen
    v_lshlrev_b32 v6, 16, v14
    v_fmac_f32 v67, v6, v26
    v_and_b32 v6, 0xffff0000, v14
    v_fmac_f32 v75, v6, v27
    v_lshlrev_b32 v6, 16, v15
    v_fmac_f32 v83, v6, v28
    v_and_b32 v6, 0xffff0000, v15
    v_fmac_f32 v91, v6, v29
    v_cvt_pk_bf16_f32 v14, v67, v75
    v_cvt_pk_bf16_f32 v15, v83, v91
    s_add_u32 s23, s22, 6912
    buffer_store_dwordx2 v[14:15], v5, s[16:19], s23 offen
    v_lshlrev_b32 v6, 16, v16
    v_fmac_f32 v68, v6, v26
    v_and_b32 v6, 0xffff0000, v16
    v_fmac_f32 v76, v6, v27
    v_lshlrev_b32 v6, 16, v17
    v_fmac_f32 v84, v6, v28
    v_and_b32 v6, 0xffff0000, v17
    v_fmac_f32 v92, v6, v29
    v_cvt_pk_bf16_f32 v16, v68, v76
    v_cvt_pk_bf16_f32 v17, v84, v92
    s_add_u32 s23, s22, 9216
    buffer_store_dwordx2 v[16:17], v5, s[16:19], s23 offen
    v_lshlrev_b32 v6, 16, v18
    v_fmac_f32 v69, v6, v26
    v_and_b32 v6, 0xffff0000, v18
    v_fmac_f32 v77, v6, v27
    v_lshlrev_b32 v6, 16, v19
    v_fmac_f32 v85, v6, v28
    v_and_b32 v6, 0xffff0000, v19
    v_fmac_f32 v93, v6, v29
    v_cvt_pk_bf16_f32 v18, v69, v77
    v_cvt_pk_bf16_f32 v19, v85, v93
    s_add_u32 s23, s22, 11520
    buffer_store_dwordx2 v[18:19], v5, s[16:19], s23 offen
    v_lshlrev_b32 v6, 16, v20
    v_fmac_f32 v70, v6, v26
    v_and_b32 v6, 0xffff0000, v20
    v_fmac_f32 v78, v6, v27
    v_lshlrev_b32 v6, 16, v21
    v_fmac_f32 v86, v6, v28
    v_and_b32 v6, 0xffff0000, v21
    v_fmac_f32 v94, v6, v29
    v_cvt_pk_bf16_f32 v20, v70, v78
    v_cvt_pk_bf16_f32 v21, v86, v94
    s_add_u32 s23, s22, 13824
    buffer_store_dwordx2 v[20:21], v5, s[16:19], s23 offen
    v_lshlrev_b32 v6, 16, v22
    v_fmac_f32 v71, v6, v26
    v_and_b32 v6, 0xffff0000, v22
    v_fmac_f32 v79, v6, v27
    v_lshlrev_b32 v6, 16, v23
    v_fmac_f32 v87, v6, v28
    v_and_b32 v6, 0xffff0000, v23
    v_fmac_f32 v95, v6, v29
    v_cvt_pk_bf16_f32 v22, v71, v79
    v_cvt_pk_bf16_f32 v23, v87, v95
    s_add_u32 s23, s22, 16128
    buffer_store_dwordx2 v[22:23], v5, s[16:19], s23 offen
    s_branch L_ssm_next
L_wf_next:
    s_mov_b32 s37, 20
    v_mov_b32 v250, 1
    v_mov_b32 v251, 163832
    v_cmp_eq_u32 vcc, 0, v0
    s_nop 0
    s_and_saveexec_b64 s[38:39], vcc
    s_cbranch_execz tk7
    buffer_atomic_add v250, off, s[84:87], s37 sc0
    s_waitcnt vmcnt(0)
    ds_write_b32 v251, v250
    s_waitcnt lgkmcnt(0)
tk7:
    s_mov_b64 exec, -1
    s_barrier
    ds_read_b32 v252, v251
    s_waitcnt lgkmcnt(0)
    v_readfirstlane_b32 s33, v252
    s_barrier
    s_nop 3
    s_cmp_ge_u32 s33, 160
    s_cbranch_scc1 L_phase2
    s_lshl_b32 s16, s33, 2
    s_add_u32 s16, s16, s32
    s_add_u32 s16, s16, 1504
    s_call_b64 s[46:47], L_xform
    s_lshl_b32 s40, s33, 2
    s_add_u32 s40, s40, 125841408
    s_waitcnt vmcnt(0)
    s_barrier
    v_mov_b32 v250, s95
    v_cmp_eq_u32 vcc, 0, v0
    s_nop 0
    s_and_saveexec_b64 s[38:39], vcc
    s_cbranch_execz fs8
    buffer_store_dword v250, off, s[4:7], s40 sc1
fs8:
    s_mov_b64 exec, -1
    s_branch L_wf_next
L_phase2:
    s_mov_b32 s40, 524288
mc2_w:
    buffer_load_dword v250, off, s[84:87], 0 offset:28 sc1
    s_waitcnt vmcnt(0)
    v_readfirstlane_b32 s41, v250
    s_nop 0
    s_cmp_lg_u32 s41, 0
    s_cbranch_scc1 mc2_known
    s_sub_u32 s40, s40, 1
    s_cbranch_scc1 mc2_force
    s_sleep 2
    s_branch mc2_w
mc2_force:
    v_mov_b32 v250, 2
    v_mov_b32 v251, 0
    s_mov_b64 exec, 1
    buffer_atomic_cmpswap v[250:251], off, s[84:87], 0 offset:28
    s_mov_b64 exec, -1
    s_waitcnt vmcnt(0)
    s_mov_b32 s40, 524288
    s_branch mc2_w
mc2_known:
    s_cmp_eq_u32 s41, 1
    s_cbranch_scc1 L_phase2b
    s_mov_b32 s37, 208
    v_mov_b32 v250, 1
    v_mov_b32 v251, 163832
    v_cmp_eq_u32 vcc, 0, v0
    s_nop 0
    s_and_saveexec_b64 s[38:39], vcc
    s_cbranch_execz tk9
    buffer_atomic_add v250, off, s[84:87], s37 sc0
    s_waitcnt vmcnt(0)
    ds_write_b32 v251, v250
    s_waitcnt lgkmcnt(0)
tk9:
    s_mov_b64 exec, -1
    s_barrier
    ds_read_b32 v252, v251
    s_waitcnt lgkmcnt(0)
    v_readfirstlane_b32 s12, v252
    s_barrier
    s_nop 3
    s_cmp_lt_u32 s12, 32
    s_cbranch_scc1 L_chain_safe
L_phase2b:
    s_mov_b32 s8, s76
    s_mov_b32 s9, s77
    s_mov_b32 s10, 4718592
    s_mov_b32 s11, 0x20000
    s_mov_b32 s37, 12
    v_mov_b32 v250, 1
    v_mov_b32 v251, 163832
    v_cmp_eq_u32 vcc, 0, v0
    s_nop 0
    s_and_saveexec_b64 s[38:39], vcc
    s_cbranch_execz tk10
    buffer_atomic_add v250, off, s[84:87], s37 sc0
    s_waitcnt vmcnt(0)
    ds_write_b32 v251, v250
    s_waitcnt lgkmcnt(0)
tk10:
    s_mov_b64 exec, -1
    s_barrier
    ds_read_b32 v252, v251
    s_waitcnt lgkmcnt(0)
    v_readfirstlane_b32 s36, v252
    s_barrier
    s_nop 3
    s_mul_hi_u32 s37, s36, 0x55555556
    s_mul_i32 s40, s37, 3
    s_sub_u32 s33, s36, s37
    s_mul_hi_u32 s41, s33, 0x0e38e38f
    s_mul_i32 s41, s41, 18
    s_sub_u32 s33, s33, s41
    s_cmp_lg_u32 s40, s36
    s_cbranch_scc1 L_op_start
L_att_next:
    s_mov_b32 s37, 16
    v_mov_b32 v250, 1
    v_mov_b32 v251, 163832
    v_cmp_eq_u32 vcc, 0, v0
    s_nop 0
    s_and_saveexec_b64 s[38:39], vcc
    s_cbranch_execz tk11
    buffer_atomic_add v250, off, s[84:87], s37 sc0
    s_waitcnt vmcnt(0)
    ds_write_b32 v251, v250
    s_waitcnt lgkmcnt(0)
tk11:
    s_mov_b64 exec, -1
    s_barrier
    ds_read_b32 v252, v251
    s_waitcnt lgkmcnt(0)
    v_readfirstlane_b32 s34, v252
    s_barrier
    s_nop 3
    s_cmp_ge_u32 s34, 512
    s_cbranch_scc1 L_op_nextcb
    s_lshr_b32 s16, s34, 3
    s_and_b32 s17, s34, 7
    s_lshl_b32 s17, s17, 2
    s_add_u32 s17, s17, s32
    s_lshl_b32 s36, s17, 7
    s_add_u32 s36, s36, 125829120
    s_lshr_b32 s41, s16, 2
    s_add_u32 s41, s41, s95
    s_add_u32 s41, s41, 1
    v_and_b32 v1, 3, v0
    v_min_u32 v1, 2, v1
    v_lshlrev_b32 v2, 4, v1
    s_and_b32 s37, s16, 3
    s_lshl_b32 s37, s37, 2
    v_add_u32 v2, s37, v2
    s_mov_b32 s40, 4194304
L_aw1:
    buffer_load_dword v3, v2, s[4:7], s36 offen sc1
    s_sub_u32 s40, s40, 1
    s_cbranch_scc1 L_aw1_go
    s_waitcnt vmcnt(0)
    v_subrev_u32 v3, s41, v3
    v_cmp_lt_u32 vcc, 64, v3
    s_cbranch_vccz L_aw1_go
    s_sleep 4
    s_branch L_aw1
L_aw1_go:
    v_and_b32 v5, 63, v0
    v_lshlrev_b32 v1, 4, v5
    s_cmp_ge_u32 s16, 58
    s_cselect_b32 s18, -1, 511
    v_and_b32 v2, s18, v1
    v_or_b32 v3, 128, v1
    v_lshrrev_b32 v4, 4, v5
    v_bfe_u32 v6, v5, 2, 2
    v_sub_u32 v4, v6, v4
    v_lshlrev_b32 v4, 3, v4
    v_and_b32 v6, 3, v5
    v_add_u32 v4, v4, v6
    v_mov_b32 v6, 0xf149f2ca
    s_mov_b32 s22, 0x3e0293ee
    s_lshl_b32 s18, s16, 5
    s_add_u32 s18, s18, s17
    s_lshl_b32 s19, s18, 13
    s_add_u32 s20, s19, 33554432
    buffer_load_dwordx4 v[8:11], v1, s[4:7], s20 offen offset:0 sc1
    s_add_u32 s20, s19, 33554432
    buffer_load_dwordx4 v[12:15], v1, s[4:7], s20 offen offset:1024 sc1
    s_add_u32 s20, s19, 33554432
    buffer_load_dwordx4 v[16:19], v1, s[4:7], s20 offen offset:2048 sc1
    s_add_u32 s20, s19, 33554432
    buffer_load_dwordx4 v[20:23], v1, s[4:7], s20 offen offset:3072 sc1
    s_add_u32 s20, s19, 33558528
    buffer_load_dwordx4 v[24:27], v1, s[4:7], s20 offen offset:0 sc1
    s_add_u32 s20, s19, 33558528
    buffer_load_dwordx4 v[28:31], v1, s[4:7], s20 offen offset:1024 sc1
    s_add_u32 s20, s19, 33558528
    buffer_load_dwordx4 v[32:35], v1, s[4:7], s20 offen offset:2048 sc1
    s_add_u32 s20, s19, 33558528
    buffer_load_dwordx4 v[36:39], v1, s[4:7], s20 offen offset:3072 sc1
    s_lshl_b32 s21, s18, 14
    s_add_u32 s20, s21, 0
    buffer_load_dwordx4 v[40:43], v1, s[4:7], s20 offen offset:0 sc1
    s_add_u32 s20, s21, 4096
    buffer_load_dwordx4 v[44:47], v1, s[4:7], s20 offen offset:0 sc1
    s_add_u32 s20, s21, 8192
    buffer_load_dwordx4 v[48:51], v1, s[4:7], s20 offen offset:0 sc1
    s_add_u32 s20, s21, 12288
    buffer_load_dwordx4 v[52:55], v1, s[4:7], s20 offen offset:0 sc1
    s_add_u32 s20, s21, 0
    buffer_load_dwordx4 v[56:59], v1, s[4:7], s20 offen offset:1024 sc1
    s_add_u32 s20, s21, 4096
    buffer_load_dwordx4 v[60:63], v1, s[4:7], s20 offen offset:1024 sc1
    s_add_u32 s20, s21, 8192
    buffer_load_dwordx4 v[64:67], v1, s[4:7], s20 offen offset:1024 sc1
    s_add_u32 s20, s21, 12288
    buffer_load_dwordx4 v[68:71], v1, s[4:7], s20 offen offset:1024 sc1
    s_add_u32 s20, s21, 0
    buffer_load_dwordx4 v[88:91], v1, s[4:7], s20 offen offset:2048 sc1
    s_add_u32 s20, s21, 4096
    buffer_load_dwordx4 v[92:95], v1, s[4:7], s20 offen offset:2048 sc1
    s_add_u32 s20, s21, 8192
    buffer_load_dwordx4 v[96:99], v1, s[4:7], s20 offen offset:2048 sc1
    s_add_u32 s20, s21, 12288
    buffer_load_dwordx4 v[100:103], v1, s[4:7], s20 offen offset:2048 sc1
    s_add_u32 s20, s21, 0
    buffer_load_dwordx4 v[104:107], v1, s[4:7], s20 offen offset:3072 sc1
    s_add_u32 s20, s21, 4096
    buffer_load_dwordx4 v[108:111], v1, s[4:7], s20 offen offset:3072 sc1
    s_add_u32 s20, s21, 8192
    buffer_load_dwordx4 v[112:115], v1, s[4:7], s20 offen offset:3072 sc1
    s_add_u32 s20, s21, 12288
    buffer_load_dwordx4 v[116:119], v1, s[4:7], s20 offen offset:3072 sc1
    v_mov_b32 v172, 0x3f803f80
    v_mov_b32 v173, 0x3f803f80
    v_mov_b32 v174, 0x3f803f80
    v_mov_b32 v175, 0x3f803f80
    v_mov_b32 v176, 0x3f003f00
    v_mov_b32 v177, 0x3f003f00
    s_waitcnt vmcnt(8)
    v_mfma_f32_16x16x32_bf16 v[136:139], v[40:43], v[8:11], 0
    v_mfma_f32_16x16x32_bf16 v[140:143], v[56:59], v[8:11], 0
    v_mfma_f32_16x16x32_bf16 v[148:151], v[40:43], v[24:27], 0
    v_mfma_f32_16x16x32_bf16 v[152:155], v[56:59], v[24:27], 0
    v_mfma_f32_16x16x32_bf16 v[136:139], v[44:47], v[12:15], v[136:139]
    v_mfma_f32_16x16x32_bf16 v[140:143], v[60:63], v[12:15], v[140:143]
    v_mfma_f32_16x16x32_bf16 v[148:151], v[44:47], v[28:31], v[148:151]
    v_mfma_f32_16x16x32_bf16 v[152:155], v[60:63], v[28:31], v[152:155]
    v_mfma_f32_16x16x32_bf16 v[136:139], v[48:51], v[16:19], v[136:139]
    v_mfma_f32_16x16x32_bf16 v[140:143], v[64:67], v[16:19], v[140:143]
    v_mfma_f32_16x16x32_bf16 v[148:151], v[48:51], v[32:35], v[148:151]
    v_mfma_f32_16x16x32_bf16 v[152:155], v[64:67], v[32:35], v[152:155]
    v_mfma_f32_16x16x32_bf16 v[136:139], v[52:55], v[20:23], v[136:139]
    v_mfma_f32_16x16x32_bf16 v[140:143], v[68:71], v[20:23], v[140:143]
    v_mfma_f32_16x16x32_bf16 v[148:151], v[52:55], v[36:39], v[148:151]
    v_mfma_f32_16x16x32_bf16 v[152:155], v[68:71], v[36:39], v[152:155]
    v_cmp_le_i32 vcc, 0, v4
    s_nop 3
    v_cndmask_b32 v136, v6, v136, vcc
    v_cmp_le_i32 vcc, 1, v4
    s_nop 1
    v_cndmask_b32 v137, v6, v137, vcc
    v_cmp_le_i32 vcc, 2, v4
    s_nop 1
    v_cndmask_b32 v138, v6, v138, vcc
    v_cmp_le_i32 vcc, 3, v4
    s_nop 1
    v_cndmask_b32 v139, v6, v139, vcc
    v_cmp_le_i32 vcc, 4, v4
    s_nop 1
    v_cndmask_b32 v140, v6, v140, vcc
    v_cmp_le_i32 vcc, 5, v4
    s_nop 1
    v_cndmask_b32 v141, v6, v141, vcc
    v_cmp_le_i32 vcc, 6, v4
    s_nop 1
    v_cndmask_b32 v142, v6, v142, vcc
    v_cmp_le_i32 vcc, 7, v4
    s_nop 1
    v_cndmask_b32 v143, v6, v143, vcc
    v_cmp_le_i32 vcc, -4, v4
    s_nop 1
    v_cndmask_b32 v148, v6, v148, vcc
    v_cmp_le_i32 vcc, -3, v4
    s_nop 1
    v_cndmask_b32 v149, v6, v149, vcc
    v_cmp_le_i32 vcc, -2, v4
    s_nop 1
    v_cndmask_b32 v150, v6, v150, vcc
    v_cmp_le_i32 vcc, -1, v4
    s_nop 1
    v_cndmask_b32 v151, v6, v151, vcc
    v_cmp_le_i32 vcc, 0, v4
    s_nop 1
    v_cndmask_b32 v152, v6, v152, vcc
    v_cmp_le_i32 vcc, 1, v4
    s_nop 1
    v_cndmask_b32 v153, v6, v153, vcc
    v_cmp_le_i32 vcc, 2, v4
    s_nop 1
    v_cndmask_b32 v154, v6, v154, vcc
    v_cmp_le_i32 vcc, 3, v4
    s_nop 1
    v_cndmask_b32 v155, v6, v155, vcc
    s_nop 1
    v_and_b32 v198, 1, v0
    v_lshlrev_b32 v198, 2, v198
    v_add_u32 v198, 48, v198
    s_add_u32 s41, s16, s95
    s_add_u32 s41, s41, 1
    s_cmp_lt_u32 s16, 58
    s_cbranch_scc1 L_amk
    v_mov_b32 v198, 16384
L_amk:
    s_nop 1
    s_mov_b32 s88, 65536
    s_mov_b32 s89, 125853696
cw12:
    buffer_load_dword v199, off, s[4:7], s89 sc1
    s_waitcnt vmcnt(0)
    v_readfirstlane_b32 s42, v199
    s_nop 0
    s_sub_u32 s42, s42, s95
    s_cmp_gt_u32 s42, 64
    s_cselect_b32 s42, 0, s42
    s_add_u32 s42, s42, 1
    s_cmp_ge_u32 s42, s16
    s_cbranch_scc1 cw12x
    s_sub_u32 s88, s88, 1
    s_cbranch_scc1 cw12x
    s_sub_u32 s42, s16, s42
    s_min_u32 s42, s42, 6
cw12s:
    s_sleep 24
    s_sub_u32 s42, s42, 1
    s_cmp_lg_u32 s42, 0
    s_cbranch_scc1 cw12s
    s_branch cw12
cw12x:
    s_mov_b32 s40, 4194304
L_aw2:
    buffer_load_dword v199, v198, s[4:7], s36 offen sc1
    s_sub_u32 s40, s40, 1
    s_cbranch_scc1 L_aw2_go
    s_waitcnt vmcnt(0)
    v_subrev_u32 v199, s41, v199
    v_cmp_lt_u32 vcc, 64, v199
    s_cbranch_vccz L_aw2_go
    s_sleep 4
    s_branch L_aw2
L_aw2_go:
    s_lshl_b32 s20, s18, 12
    s_add_u32 s20, s20, 69206016
    buffer_load_dwordx4 v[72:75], v3, s[4:7], s20 offen offset:0 sc1
    buffer_load_dwordx4 v[76:79], v3, s[4:7], s20 offen offset:1024 sc1
    buffer_load_dwordx4 v[80:83], v3, s[4:7], s20 offen offset:2048 sc1
    buffer_load_dwordx4 v[84:87], v3, s[4:7], s20 offen offset:3072 sc1
    s_lshl_b32 s20, s18, 12
    s_add_u32 s20, s20, 77594624
    buffer_load_dwordx4 v[120:123], v2, s[4:7], s20 offen offset:0 sc1
    buffer_load_dwordx4 v[124:127], v2, s[4:7], s20 offen offset:1024 sc1
    buffer_load_dwordx4 v[128:131], v2, s[4:7], s20 offen offset:2048 sc1
    buffer_load_dwordx4 v[132:135], v2, s[4:7], s20 offen offset:3072 sc1
    s_waitcnt vmcnt(4)
    v_mfma_f32_16x16x32_bf16 v[144:147], v[72:75], v[8:11], 0
    v_mfma_f32_16x16x32_bf16 v[156:159], v[72:75], v[24:27], 0
    v_mfma_f32_16x16x32_bf16 v[144:147], v[76:79], v[12:15], v[144:147]
    v_mfma_f32_16x16x32_bf16 v[156:159], v[76:79], v[28:31], v[156:159]
    v_mfma_f32_16x16x32_bf16 v[144:147], v[80:83], v[16:19], v[144:147]
    v_mfma_f32_16x16x32_bf16 v[156:159], v[80:83], v[32:35], v[156:159]
    v_mfma_f32_16x16x32_bf16 v[144:147], v[84:87], v[20:23], v[144:147]
    v_mfma_f32_16x16x32_bf16 v[156:159], v[84:87], v[36:39], v[156:159]
    v_max3_f32 v196, v136, v137, v138
    v_max3_f32 v197, v139, v140, v141
    v_max3_f32 v196, v196, v142, v143
    s_nop 3
    v_max3_f32 v197, v197, v144, v145
    v_max3_f32 v196, v196, v146, v147
    v_max_f32 v196, v196, v197
    v_mov_b32 v197, v196
    s_nop 1
    v_permlane32_swap_b32 v196, v197
    v_max_f32 v196, v196, v197
    v_mov_b32 v197, v196
    s_nop 1
    v_permlane16_swap_b32 v196, v197
    v_max_f32 v196, v196, v197
    v_mul_f32 v196, s22, v196
    v_sub_f32 v196, 0, v196
    v_fma_f32 v136, v136, s22, v196
    v_fma_f32 v137, v137, s22, v196
    v_fma_f32 v138, v138, s22, v196
    v_fma_f32 v139, v139, s22, v196
    v_fma_f32 v140, v140, s22, v196
    v_fma_f32 v141, v141, s22, v196
    v_fma_f32 v142, v142, s22, v196
    v_fma_f32 v143, v143, s22, v196
    v_fma_f32 v144, v144, s22, v196
    v_fma_f32 v145, v145, s22, v196
    v_fma_f32 v146, v146, s22, v196
    v_fma_f32 v147, v147, s22, v196
    v_exp_f32 v136, v136
    v_exp_f32 v137, v137
    v_exp_f32 v138, v138
    v_exp_f32 v139, v139
    v_exp_f32 v140, v140
    v_exp_f32 v141, v141
    v_exp_f32 v142, v142
    v_exp_f32 v143, v143
    v_exp_f32 v144, v144
    v_exp_f32 v145, v145
    v_exp_f32 v146, v146
    v_exp_f32 v147, v147
    v_cvt_pk_bf16_f32 v160, v136, v137
    v_cvt_pk_bf16_f32 v161, v138, v139
    v_cvt_pk_bf16_f32 v162, v140, v141
    v_cvt_pk_bf16_f32 v163, v142, v143
    v_cvt_pk_bf16_f32 v164, v144, v145
    v_cvt_pk_bf16_f32 v165, v146, v147
    v_max3_f32 v196, v148, v149, v150
    v_max3_f32 v197, v151, v152, v153
    v_max3_f32 v196, v196, v154, v155
    v_max3_f32 v197, v197, v156, v157
    v_max3_f32 v196, v196, v158, v159
    v_max_f32 v196, v196, v197
    v_mov_b32 v197, v196
    s_nop 1
    v_permlane32_swap_b32 v196, v197
    v_max_f32 v196, v196, v197
    v_mov_b32 v197, v196
    s_nop 1
    v_permlane16_swap_b32 v196, v197
    v_max_f32 v196, v196, v197
    v_mul_f32 v196, s22, v196
    v_sub_f32 v196, 0, v196
    v_fma_f32 v148, v148, s22, v196
    v_fma_f32 v149, v149, s22, v196
    v_fma_f32 v150, v150, s22, v196
    v_fma_f32 v151, v151, s22, v196
    v_fma_f32 v152, v152, s22, v196
    v_fma_f32 v153, v153, s22, v196
    v_fma_f32 v154, v154, s22, v196
    v_fma_f32 v155, v155, s22, v196
    v_fma_f32 v156, v156, s22, v196
    v_fma_f32 v157, v157, s22, v196
    v_fma_f32 v158, v158, s22, v196
    v_fma_f32 v159, v159, s22, v196
    v_exp_f32 v148, v148
    v_exp_f32 v149, v149
    v_exp_f32 v150, v150
    v_exp_f32 v151, v151
    v_exp_f32 v152, v152
    v_exp_f32 v153, v153
    v_exp_f32 v154, v154
    v_exp_f32 v155, v155
    v_exp_f32 v156, v156
    v_exp_f32 v157, v157
    v_exp_f32 v158, v158
    v_exp_f32 v159, v159
    v_cvt_pk_bf16_f32 v166, v148, v149
    v_cvt_pk_bf16_f32 v167, v150, v151
    v_cvt_pk_bf16_f32 v168, v152, v153
    v_cvt_pk_bf16_f32 v169, v154, v155
    v_cvt_pk_bf16_f32 v170, v156, v157
    v_cvt_pk_bf16_f32 v171, v158, v159
    v_mfma_f32_16x16x32_bf16 v[180:183], v[172:175], v[160:163], 0
    v_mfma_f32_16x16x32_bf16 v[184:187], v[172:175], v[166:169], 0
    s_nop 4
    v_mfma_f32_16x16x16_bf16 v[180:183], v[176:177], v[164:165], v[180:183]
    v_mfma_f32_16x16x16_bf16 v[184:187], v[176:177], v[170:171], v[184:187]
    s_nop 6
    v_rcp_f32 v180, v180
    v_rcp_f32 v184, v184
    s_waitcnt vmcnt(0)
    s_lshl_b32 s18, s16, 18
    s_lshl_b32 s19, s17, 12
    s_add_u32 s18, s18, s19
    s_add_u32 s18, s18, 50331648
    s_add_u32 s19, s18, 131072
    v_mfma_f32_16x16x32_bf16 v[8:11], v[88:91], v[160:163], 0
    v_mfma_f32_16x16x32_bf16 v[12:15], v[104:107], v[160:163], 0
    v_mfma_f32_16x16x32_bf16 v[16:19], v[88:91], v[166:169], 0
    v_mfma_f32_16x16x32_bf16 v[20:23], v[104:107], v[166:169], 0
    v_mfma_f32_16x16x32_bf16 v[24:27], v[92:95], v[160:163], 0
    v_mfma_f32_16x16x32_bf16 v[28:31], v[108:111], v[160:163], 0
    v_mfma_f32_16x16x32_bf16 v[32:35], v[92:95], v[166:169], 0
    v_mfma_f32_16x16x32_bf16 v[36:39], v[108:111], v[166:169], 0
    v_mfma_f32_16x16x32_bf16 v[40:43], v[96:99], v[160:163], 0
    v_mfma_f32_16x16x32_bf16 v[44:47], v[112:115], v[160:163], 0
    v_mfma_f32_16x16x32_bf16 v[48:51], v[96:99], v[166:169], 0
    v_mfma_f32_16x16x32_bf16 v[52:55], v[112:115], v[166:169], 0
    v_mfma_f32_16x16x32_bf16 v[56:59], v[100:103], v[160:163], 0
    v_mfma_f32_16x16x32_bf16 v[60:63], v[116:119], v[160:163], 0
    v_mfma_f32_16x16x32_bf16 v[64:67], v[100:103], v[166:169], 0
    v_mfma_f32_16x16x32_bf16 v[68:71], v[116:119], v[166:169], 0
    v_mfma_f32_16x16x16_bf16 v[8:11], v[120:121], v[164:165], v[8:11]
    v_mfma_f32_16x16x16_bf16 v[12:15], v[122:123], v[164:165], v[12:15]
    v_mfma_f32_16x16x16_bf16 v[16:19], v[120:121], v[170:171], v[16:19]
    v_mfma_f32_16x16x16_bf16 v[20:23], v[122:123], v[170:171], v[20:23]
    v_mfma_f32_16x16x16_bf16 v[24:27], v[124:125], v[164:165], v[24:27]
    v_mfma_f32_16x16x16_bf16 v[28:31], v[126:127], v[164:165], v[28:31]
    v_mfma_f32_16x16x16_bf16 v[32:35], v[124:125], v[170:171], v[32:35]
    v_mfma_f32_16x16x16_bf16 v[36:39], v[126:127], v[170:171], v[36:39]
    v_mfma_f32_16x16x16_bf16 v[40:43], v[128:129], v[164:165], v[40:43]
    v_mfma_f32_16x16x16_bf16 v[44:47], v[130:131], v[164:165], v[44:47]
    v_mfma_f32_16x16x16_bf16 v[48:51], v[128:129], v[170:171], v[48:51]
    v_mfma_f32_16x16x16_bf16 v[52:55], v[130:131], v[170:171], v[52:55]
    v_mfma_f32_16x16x16_bf16 v[56:59], v[132:133], v[164:165], v[56:59]
    v_mfma_f32_16x16x16_bf16 v[60:63], v[134:135], v[164:165], v[60:63]
    v_mfma_f32_16x16x16_bf16 v[64:67], v[132:133], v[170:171], v[64:67]
    v_mfma_f32_16x16x16_bf16 v[68:71], v[134:135], v[170:171], v[68:71]
    v_mul_f32 v8, v8, v180
    v_mul_f32 v12, v12, v180
    v_mul_f32 v9, v9, v180
    v_mul_f32 v13, v13, v180
    v_mul_f32 v10, v10, v180
    v_mul_f32 v14, v14, v180
    v_mul_f32 v11, v11, v180
    v_mul_f32 v15, v15, v180
    v_cvt_pk_bf16_f32 v8, v8, v9
    v_cvt_pk_bf16_f32 v9, v10, v11
    v_cvt_pk_bf16_f32 v10, v12, v13
    v_cvt_pk_bf16_f32 v11, v14, v15
    buffer_store_dwordx4 v[8:11], v1, s[4:7], s18 offen offset:0 sc1
    v_mul_f32 v16, v16, v184
    v_mul_f32 v20, v20, v184
    v_mul_f32 v17, v17, v184
    v_mul_f32 v21, v21, v184
    v_mul_f32 v18, v18, v184
    v_mul_f32 v22, v22, v184
    v_mul_f32 v19, v19, v184
    v_mul_f32 v23, v23, v184
    v_cvt_pk_bf16_f32 v16, v16, v17
    v_cvt_pk_bf16_f32 v17, v18, v19
    v_cvt_pk_bf16_f32 v18, v20, v21
    v_cvt_pk_bf16_f32 v19, v22, v23
    buffer_store_dwordx4 v[16:19], v1, s[4:7], s19 offen offset:0 sc1
    v_mul_f32 v24, v24, v180
    v_mul_f32 v28, v28, v180
    v_mul_f32 v25, v25, v180
    v_mul_f32 v29, v29, v180
    v_mul_f32 v26, v26, v180
    v_mul_f32 v30, v30, v180
    v_mul_f32 v27, v27, v180
    v_mul_f32 v31, v31, v180
    v_cvt_pk_bf16_f32 v24, v24, v25
    v_cvt_pk_bf16_f32 v25, v26, v27
    v_cvt_pk_bf16_f32 v26, v28, v29
    v_cvt_pk_bf16_f32 v27, v30, v31
    buffer_store_dwordx4 v[24:27], v1, s[4:7], s18 offen offset:1024 sc1
    v_mul_f32 v32, v32, v184
    v_mul_f32 v36, v36, v184
    v_mul_f32 v33, v33, v184
    v_mul_f32 v37, v37, v184
    v_mul_f32 v34, v34, v184
    v_mul_f32 v38, v38, v184
    v_mul_f32 v35, v35, v184
    v_mul_f32 v39, v39, v184
    v_cvt_pk_bf16_f32 v32, v32, v33
    v_cvt_pk_bf16_f32 v33, v34, v35
    v_cvt_pk_bf16_f32 v34, v36, v37
    v_cvt_pk_bf16_f32 v35, v38, v39
    buffer_store_dwordx4 v[32:35], v1, s[4:7], s19 offen offset:1024 sc1
    v_mul_f32 v40, v40, v180
    v_mul_f32 v44, v44, v180
    v_mul_f32 v41, v41, v180
    v_mul_f32 v45, v45, v180
    v_mul_f32 v42, v42, v180
    v_mul_f32 v46, v46, v180
    v_mul_f32 v43, v43, v180
    v_mul_f32 v47, v47, v180
    v_cvt_pk_bf16_f32 v40, v40, v41
    v_cvt_pk_bf16_f32 v41, v42, v43
    v_cvt_pk_bf16_f32 v42, v44, v45
    v_cvt_pk_bf16_f32 v43, v46, v47
    buffer_store_dwordx4 v[40:43], v1, s[4:7], s18 offen offset:2048 sc1
    v_mul_f32 v48, v48, v184
    v_mul_f32 v52, v52, v184
    v_mul_f32 v49, v49, v184
    v_mul_f32 v53, v53, v184
    v_mul_f32 v50, v50, v184
    v_mul_f32 v54, v54, v184
    v_mul_f32 v51, v51, v184
    v_mul_f32 v55, v55, v184
    v_cvt_pk_bf16_f32 v48, v48, v49
    v_cvt_pk_bf16_f32 v49, v50, v51
    v_cvt_pk_bf16_f32 v50, v52, v53
    v_cvt_pk_bf16_f32 v51, v54, v55
    buffer_store_dwordx4 v[48:51], v1, s[4:7], s19 offen offset:2048 sc1
    v_mul_f32 v56, v56, v180
    v_mul_f32 v60, v60, v180
    v_mul_f32 v57, v57, v180
    v_mul_f32 v61, v61, v180
    v_mul_f32 v58, v58, v180
    v_mul_f32 v62, v62, v180
    v_mul_f32 v59, v59, v180
    v_mul_f32 v63, v63, v180
    v_cvt_pk_bf16_f32 v56, v56, v57
    v_cvt_pk_bf16_f32 v57, v58, v59
    v_cvt_pk_bf16_f32 v58, v60, v61
    v_cvt_pk_bf16_f32 v59, v62, v63
    buffer_store_dwordx4 v[56:59], v1, s[4:7], s18 offen offset:3072 sc1
    v_mul_f32 v64, v64, v184
    v_mul_f32 v68, v68, v184
    v_mul_f32 v65, v65, v184
    v_mul_f32 v69, v69, v184
    v_mul_f32 v66, v66, v184
    v_mul_f32 v70, v70, v184
    v_mul_f32 v67, v67, v184
    v_mul_f32 v71, v71, v184
    v_cvt_pk_bf16_f32 v64, v64, v65
    v_cvt_pk_bf16_f32 v65, v66, v67
    v_cvt_pk_bf16_f32 v66, v68, v69
    v_cvt_pk_bf16_f32 v67, v70, v71
    buffer_store_dwordx4 v[64:67], v1, s[4:7], s19 offen offset:3072 sc1
    s_lshr_b32 s40, s34, 1
    s_lshl_b32 s40, s40, 7
    s_and_b32 s41, s34, 1
    s_lshl_b32 s41, s41, 2
    s_add_u32 s40, s40, s41
    s_add_u32 s40, s40, 125894656
    s_waitcnt vmcnt(0)
    s_barrier
    v_mov_b32 v250, s95
    v_cmp_eq_u32 vcc, 0, v0
    s_nop 0
    s_and_saveexec_b64 s[38:39], vcc
    s_cbranch_execz fs13
    buffer_store_dword v250, off, s[4:7], s40 sc1
fs13:
    s_mov_b64 exec, -1
    s_branch L_att_next
L_op_start:
    s_lshl_b32 s35, s33, 2
    s_add_u32 s35, s35, 136
    s_lshr_b32 s89, s33, 2
    s_lshl_b32 s89, s89, 7
    s_add_u32 s89, s89, 125841408
    v_mbcnt_lo_u32_b32 v2, -1, 0
    v_mbcnt_hi_u32_b32 v2, -1, v2
    v_min_u32 v2, 31, v2
    v_lshlrev_b32 v2, 2, v2
    s_mov_b32 s88, 4194304
fw14:
    buffer_load_dword v3, v2, s[4:7], s89 offen offset:0 sc1
    s_sub_u32 s88, s88, 1
    s_cbranch_scc1 fw14x
    s_waitcnt vmcnt(0)
    v_cmp_ne_u32 vcc, s95, v3
    s_cbranch_vccz fw14x
    s_sleep 4
    s_branch fw14
fw14x:
    v_and_b32 v1, 63, v0
    v_lshlrev_b32 v1, 4, v1
    s_lshl_b32 s18, s33, 18
    s_lshl_b32 s19, s32, 16
    s_add_u32 s18, s18, s19
    s_add_u32 s18, s18, 130023424
    buffer_load_dwordx4 a[0:3], v1, s[4:7], s18 offen offset:0 sc1
    buffer_load_dwordx4 a[4:7], v1, s[4:7], s18 offen offset:1024 sc1
    buffer_load_dwordx4 a[8:11], v1, s[4:7], s18 offen offset:2048 sc1
    buffer_load_dwordx4 a[12:15], v1, s[4:7], s18 offen offset:3072 sc1
    s_add_u32 s18, s18, 4096
    buffer_load_dwordx4 a[16:19], v1, s[4:7], s18 offen offset:0 sc1
    buffer_load_dwordx4 a[20:23], v1, s[4:7], s18 offen offset:1024 sc1
    buffer_load_dwordx4 a[24:27], v1, s[4:7], s18 offen offset:2048 sc1
    buffer_load_dwordx4 a[28:31], v1, s[4:7], s18 offen offset:3072 sc1
    s_add_u32 s18, s18, 4096
    buffer_load_dwordx4 a[32:35], v1, s[4:7], s18 offen offset:0 sc1
    buffer_load_dwordx4 a[36:39], v1, s[4:7], s18 offen offset:1024 sc1
    buffer_load_dwordx4 a[40:43], v1, s[4:7], s18 offen offset:2048 sc1
    buffer_load_dwordx4 a[44:47], v1, s[4:7], s18 offen offset:3072 sc1
    s_add_u32 s18, s18, 4096
    buffer_load_dwordx4 a[48:51], v1, s[4:7], s18 offen offset:0 sc1
    buffer_load_dwordx4 a[52:55], v1, s[4:7], s18 offen offset:1024 sc1
    buffer_load_dwordx4 a[56:59], v1, s[4:7], s18 offen offset:2048 sc1
    buffer_load_dwordx4 a[60:63], v1, s[4:7], s18 offen offset:3072 sc1
    s_add_u32 s18, s18, 4096
    buffer_load_dwordx4 a[64:67], v1, s[4:7], s18 offen offset:0 sc1
    buffer_load_dwordx4 a[68:71], v1, s[4:7], s18 offen offset:1024 sc1
    buffer_load_dwordx4 a[72:75], v1, s[4:7], s18 offen offset:2048 sc1
    buffer_load_dwordx4 a[76:79], v1, s[4:7], s18 offen offset:3072 sc1
    s_add_u32 s18, s18, 4096
    buffer_load_dwordx4 a[80:83], v1, s[4:7], s18 offen offset:0 sc1
    buffer_load_dwordx4 a[84:87], v1, s[4:7], s18 offen offset:1024 sc1
    buffer_load_dwordx4 a[88:91], v1, s[4:7], s18 offen offset:2048 sc1
    buffer_load_dwordx4 a[92:95], v1, s[4:7], s18 offen offset:3072 sc1
    s_add_u32 s18, s18, 4096
    buffer_load_dwordx4 a[96:99], v1, s[4:7], s18 offen offset:0 sc1
    buffer_load_dwordx4 a[100:103], v1, s[4:7], s18 offen offset:1024 sc1
    buffer_load_dwordx4 a[104:107], v1, s[4:7], s18 offen offset:2048 sc1
    buffer_load_dwordx4 a[108:111], v1, s[4:7], s18 offen offset:3072 sc1
    s_add_u32 s18, s18, 4096
    buffer_load_dwordx4 a[112:115], v1, s[4:7], s18 offen offset:0 sc1
    buffer_load_dwordx4 a[116:119], v1, s[4:7], s18 offen offset:1024 sc1
    buffer_load_dwordx4 a[120:123], v1, s[4:7], s18 offen offset:2048 sc1
    buffer_load_dwordx4 a[124:127], v1, s[4:7], s18 offen offset:3072 sc1
    s_add_u32 s18, s18, 4096
    buffer_load_dwordx4 a[128:131], v1, s[4:7], s18 offen offset:0 sc1
    buffer_load_dwordx4 a[132:135], v1, s[4:7], s18 offen offset:1024 sc1
    buffer_load_dwordx4 a[136:139], v1, s[4:7], s18 offen offset:2048 sc1
    buffer_load_dwordx4 a[140:143], v1, s[4:7], s18 offen offset:3072 sc1
    s_add_u32 s18, s18, 4096
    buffer_load_dwordx4 a[144:147], v1, s[4:7], s18 offen offset:0 sc1
    buffer_load_dwordx4 a[148:151], v1, s[4:7], s18 offen offset:1024 sc1
    buffer_load_dwordx4 a[152:155], v1, s[4:7], s18 offen offset:2048 sc1
    buffer_load_dwordx4 a[156:159], v1, s[4:7], s18 offen offset:3072 sc1
    s_add_u32 s18, s18, 4096
    buffer_load_dwordx4 a[160:163], v1, s[4:7], s18 offen offset:0 sc1
    s_waitcnt vmcnt(20)
    buffer_load_dwordx4 a[164:167], v1, s[4:7], s18 offen offset:1024 sc1
    buffer_load_dwordx4 a[168:171], v1, s[4:7], s18 offen offset:2048 sc1
    buffer_load_dwordx4 a[172:175], v1, s[4:7], s18 offen offset:3072 sc1
    s_add_u32 s18, s18, 4096
    buffer_load_dwordx4 a[176:179], v1, s[4:7], s18 offen offset:0 sc1
    buffer_load_dwordx4 a[180:183], v1, s[4:7], s18 offen offset:1024 sc1
    buffer_load_dwordx4 a[184:187], v1, s[4:7], s18 offen offset:2048 sc1
    buffer_load_dwordx4 a[188:191], v1, s[4:7], s18 offen offset:3072 sc1
    s_add_u32 s18, s18, 4096
    buffer_load_dwordx4 a[192:195], v1, s[4:7], s18 offen offset:0 sc1
    buffer_load_dwordx4 a[196:199], v1, s[4:7], s18 offen offset:1024 sc1
    buffer_load_dwordx4 a[200:203], v1, s[4:7], s18 offen offset:2048 sc1
    buffer_load_dwordx4 a[204:207], v1, s[4:7], s18 offen offset:3072 sc1
    s_add_u32 s18, s18, 4096
    buffer_load_dwordx4 a[208:211], v1, s[4:7], s18 offen offset:0 sc1
    buffer_load_dwordx4 a[212:215], v1, s[4:7], s18 offen offset:1024 sc1
    buffer_load_dwordx4 a[216:219], v1, s[4:7], s18 offen offset:2048 sc1
    buffer_load_dwordx4 a[220:223], v1, s[4:7], s18 offen offset:3072 sc1
    s_add_u32 s18, s18, 4096
    buffer_load_dwordx4 a[224:227], v1, s[4:7], s18 offen offset:0 sc1
    buffer_load_dwordx4 a[228:231], v1, s[4:7], s18 offen offset:1024 sc1
    buffer_load_dwordx4 a[232:235], v1, s[4:7], s18 offen offset:2048 sc1
    buffer_load_dwordx4 a[236:239], v1, s[4:7], s18 offen offset:3072 sc1
    s_add_u32 s18, s18, 4096
    buffer_load_dwordx4 a[240:243], v1, s[4:7], s18 offen offset:0 sc1
    buffer_load_dwordx4 a[244:247], v1, s[4:7], s18 offen offset:1024 sc1
    buffer_load_dwordx4 a[248:251], v1, s[4:7], s18 offen offset:2048 sc1
    buffer_load_dwordx4 a[252:255], v1, s[4:7], s18 offen offset:3072 sc1
    s_waitcnt vmcnt(0)
    s_mov_b32 s37, s35
    v_mov_b32 v250, 1
    v_mov_b32 v251, 163832
    v_cmp_eq_u32 vcc, 0, v0
    s_nop 0
    s_and_saveexec_b64 s[38:39], vcc
    s_cbranch_execz tk15
    buffer_atomic_add v250, off, s[84:87], s37 sc0
    s_waitcnt vmcnt(0)
    ds_write_b32 v251, v250
    s_waitcnt lgkmcnt(0)
tk15:
    s_mov_b64 exec, -1
    s_barrier
    ds_read_b32 v252, v251
    s_waitcnt lgkmcnt(0)
    v_readfirstlane_b32 s16, v252
    s_barrier
    s_nop 3
    s_cmp_ge_u32 s16, 128
    s_cbranch_scc1 L_op_nextcb
L_op_seg:
    s_lshr_b32 s43, s16, 1
    s_add_u32 s43, s43, 2
    s_min_u32 s43, s43, 65
    s_lshl_b32 s94, s33, 7
    s_add_u32 s94, s94, s16
    s_mov_b32 s88, 65536
    s_mov_b32 s89, 125853696
cw16:
    buffer_load_dword v3, off, s[4:7], s89 sc1
    s_waitcnt vmcnt(0)
    v_readfirstlane_b32 s42, v3
    s_nop 0
    s_sub_u32 s42, s42, s95
    s_cmp_gt_u32 s42, 64
    s_cselect_b32 s42, 0, s42
    s_add_u32 s42, s42, 1
    s_cmp_ge_u32 s42, s43
    s_cbranch_scc1 cw16x
    s_sub_u32 s88, s88, 1
    s_cbranch_scc1 cw16x
    s_sub_u32 s42, s43, s42
    s_min_u32 s42, s42, 6
cw16s:
    s_sleep 24
    s_sub_u32 s42, s42, 1
    s_cmp_lg_u32 s42, 0
    s_cbranch_scc1 cw16s
    s_branch cw16
cw16x:
    s_lshr_b32 s89, s16, 1
    s_lshl_b32 s89, s89, 2
    s_add_u32 s89, s89, s32
    s_lshl_b32 s89, s89, 7
    s_add_u32 s89, s89, 125894656
    v_mbcnt_lo_u32_b32 v2, -1, 0
    v_mbcnt_hi_u32_b32 v2, -1, v2
    v_min_u32 v2, 1, v2
    v_lshlrev_b32 v2, 2, v2
    s_mov_b32 s88, 4194304
fw17:
    buffer_load_dword v3, v2, s[4:7], s89 offen offset:0 sc1
    s_sub_u32 s88, s88, 1
    s_cbranch_scc1 fw17x
    s_waitcnt vmcnt(0)
    v_cmp_ne_u32 vcc, s95, v3
    s_cbranch_vccz fw17x
    s_sleep 6
    s_branch fw17
fw17x:
    s_lshl_b32 s18, s16, 17
    s_lshl_b32 s19, s32, 15
    s_add_u32 s18, s18, s19
    s_add_u32 s18, s18, 50331648
    buffer_load_dwordx4 v[32:35], v1, s[4:7], s18 offen offset:0 sc1
    buffer_load_dwordx4 v[36:39], v1, s[4:7], s18 offen offset:1024 sc1
    buffer_load_dwordx4 v[40:43], v1, s[4:7], s18 offen offset:2048 sc1
    buffer_load_dwordx4 v[44:47], v1, s[4:7], s18 offen offset:3072 sc1
    s_add_u32 s18, s18, 4096
    buffer_load_dwordx4 v[48:51], v1, s[4:7], s18 offen offset:0 sc1
    buffer_load_dwordx4 v[52:55], v1, s[4:7], s18 offen offset:1024 sc1
    buffer_load_dwordx4 v[56:59], v1, s[4:7], s18 offen offset:2048 sc1
    buffer_load_dwordx4 v[60:63], v1, s[4:7], s18 offen offset:3072 sc1
    s_add_u32 s18, s18, 4096
    buffer_load_dwordx4 v[64:67], v1, s[4:7], s18 offen offset:0 sc1
    buffer_load_dwordx4 v[68:71], v1, s[4:7], s18 offen offset:1024 sc1
    buffer_load_dwordx4 v[72:75], v1, s[4:7], s18 offen offset:2048 sc1
    buffer_load_dwordx4 v[76:79], v1, s[4:7], s18 offen offset:3072 sc1
    s_add_u32 s18, s18, 4096
    buffer_load_dwordx4 v[80:83], v1, s[4:7], s18 offen offset:0 sc1
    buffer_load_dwordx4 v[84:87], v1, s[4:7], s18 offen offset:1024 sc1
    buffer_load_dwordx4 v[88:91], v1, s[4:7], s18 offen offset:2048 sc1
    buffer_load_dwordx4 v[92:95], v1, s[4:7], s18 offen offset:3072 sc1
    s_add_u32 s18, s18, 4096
    buffer_load_dwordx4 v[96:99], v1, s[4:7], s18 offen offset:0 sc1
    buffer_load_dwordx4 v[100:103], v1, s[4:7], s18 offen offset:1024 sc1
    buffer_load_dwordx4 v[104:107], v1, s[4:7], s18 offen offset:2048 sc1
    buffer_load_dwordx4 v[108:111], v1, s[4:7], s18 offen offset:3072 sc1
    s_add_u32 s18, s18, 4096
    buffer_load_dwordx4 v[112:115], v1, s[4:7], s18 offen offset:0 sc1
    buffer_load_dwordx4 v[116:119], v1, s[4:7], s18 offen offset:1024 sc1
    buffer_load_dwordx4 v[120:123], v1, s[4:7], s18 offen offset:2048 sc1
    buffer_load_dwordx4 v[124:127], v1, s[4:7], s18 offen offset:3072 sc1
    s_add_u32 s18, s18, 4096
    buffer_load_dwordx4 v[128:131], v1, s[4:7], s18 offen offset:0 sc1
    buffer_load_dwordx4 v[132:135], v1, s[4:7], s18 offen offset:1024 sc1
    buffer_load_dwordx4 v[136:139], v1, s[4:7], s18 offen offset:2048 sc1
    buffer_load_dwordx4 v[140:143], v1, s[4:7], s18 offen offset:3072 sc1
    s_add_u32 s18, s18, 4096
    buffer_load_dwordx4 v[144:147], v1, s[4:7], s18 offen offset:0 sc1
    buffer_load_dwordx4 v[148:151], v1, s[4:7], s18 offen offset:1024 sc1
    buffer_load_dwordx4 v[152:155], v1, s[4:7], s18 offen offset:2048 sc1
    buffer_load_dwordx4 v[156:159], v1, s[4:7], s18 offen offset:3072 sc1
    v_lshlrev_b32 v2, 4, v0
    v_and_b32 v3, 3072, v2
    v_lshl_add_u32 v2, v3, 1, v1
    s_waitcnt vmcnt(31)
    v_mfma_f32_16x16x32_bf16 v[8:11], a[0:3], v[32:35], 0
    v_mfma_f32_16x16x32_bf16 v[12:15], a[4:7], v[32:35], 0
    s_waitcnt vmcnt(30)
    v_mfma_f32_16x16x32_bf16 v[8:11], a[8:11], v[36:39], v[8:11]
    v_mfma_f32_16x16x32_bf16 v[12:15], a[12:15], v[36:39], v[12:15]
    s_waitcnt vmcnt(29)
    v_mfma_f32_16x16x32_bf16 v[8:11], a[16:19], v[40:43], v[8:11]
    v_mfma_f32_16x16x32_bf16 v[12:15], a[20:23], v[40:43], v[12:15]
    s_waitcnt vmcnt(28)
    v_mfma_f32_16x16x32_bf16 v[8:11], a[24:27], v[44:47], v[8:11]
    v_mfma_f32_16x16x32_bf16 v[12:15], a[28:31], v[44:47], v[12:15]
    s_waitcnt vmcnt(27)
    v_mfma_f32_16x16x32_bf16 v[8:11], a[32:35], v[48:51], v[8:11]
    v_mfma_f32_16x16x32_bf16 v[12:15], a[36:39], v[48:51], v[12:15]
    s_waitcnt vmcnt(26)
    v_mfma_f32_16x16x32_bf16 v[8:11], a[40:43], v[52:55], v[8:11]
    v_mfma_f32_16x16x32_bf16 v[12:15], a[44:47], v[52:55], v[12:15]
    s_waitcnt vmcnt(25)
    v_mfma_f32_16x16x32_bf16 v[8:11], a[48:51], v[56:59], v[8:11]
    v_mfma_f32_16x16x32_bf16 v[12:15], a[52:55], v[56:59], v[12:15]
    s_waitcnt vmcnt(24)
    v_mfma_f32_16x16x32_bf16 v[8:11], a[56:59], v[60:63], v[8:11]
    v_mfma_f32_16x16x32_bf16 v[12:15], a[60:63], v[60:63], v[12:15]
    s_waitcnt vmcnt(23)
    v_mfma_f32_16x16x32_bf16 v[8:11], a[64:67], v[64:67], v[8:11]
    v_mfma_f32_16x16x32_bf16 v[12:15], a[68:71], v[64:67], v[12:15]
    s_waitcnt vmcnt(22)
    v_mfma_f32_16x16x32_bf16 v[8:11], a[72:75], v[68:71], v[8:11]
    v_mfma_f32_16x16x32_bf16 v[12:15], a[76:79], v[68:71], v[12:15]
    s_waitcnt vmcnt(21)
    v_mfma_f32_16x16x32_bf16 v[8:11], a[80:83], v[72:75], v[8:11]
    v_mfma_f32_16x16x32_bf16 v[12:15], a[84:87], v[72:75], v[12:15]
    s_waitcnt vmcnt(20)
    v_mfma_f32_16x16x32_bf16 v[8:11], a[88:91], v[76:79], v[8:11]
    v_mfma_f32_16x16x32_bf16 v[12:15], a[92:95], v[76:79], v[12:15]
    s_waitcnt vmcnt(19)
    v_mfma_f32_16x16x32_bf16 v[8:11], a[96:99], v[80:83], v[8:11]
    v_mfma_f32_16x16x32_bf16 v[12:15], a[100:103], v[80:83], v[12:15]
    s_waitcnt vmcnt(18)
    v_mfma_f32_16x16x32_bf16 v[8:11], a[104:107], v[84:87], v[8:11]
    v_mfma_f32_16x16x32_bf16 v[12:15], a[108:111], v[84:87], v[12:15]
    s_waitcnt vmcnt(17)
    v_mfma_f32_16x16x32_bf16 v[8:11], a[112:115], v[88:91], v[8:11]
    v_mfma_f32_16x16x32_bf16 v[12:15], a[116:119], v[88:91], v[12:15]
    s_waitcnt vmcnt(16)
    v_mfma_f32_16x16x32_bf16 v[8:11], a[120:123], v[92:95], v[8:11]
    v_mfma_f32_16x16x32_bf16 v[12:15], a[124:127], v[92:95], v[12:15]
    s_waitcnt vmcnt(15)
    v_mfma_f32_16x16x32_bf16 v[8:11], a[128:131], v[96:99], v[8:11]
    v_mfma_f32_16x16x32_bf16 v[12:15], a[132:135], v[96:99], v[12:15]
    s_waitcnt vmcnt(14)
    v_mfma_f32_16x16x32_bf16 v[8:11], a[136:139], v[100:103], v[8:11]
    v_mfma_f32_16x16x32_bf16 v[12:15], a[140:143], v[100:103], v[12:15]
    s_waitcnt vmcnt(13)
    v_mfma_f32_16x16x32_bf16 v[8:11], a[144:147], v[104:107], v[8:11]
    v_mfma_f32_16x16x32_bf16 v[12:15], a[148:151], v[104:107], v[12:15]
    s_waitcnt vmcnt(12)
    v_mfma_f32_16x16x32_bf16 v[8:11], a[152:155], v[108:111], v[8:11]
    v_mfma_f32_16x16x32_bf16 v[12:15], a[156:159], v[108:111], v[12:15]
    s_waitcnt vmcnt(11)
    v_mfma_f32_16x16x32_bf16 v[8:11], a[160:163], v[112:115], v[8:11]
    v_mfma_f32_16x16x32_bf16 v[12:15], a[164:167], v[112:115], v[12:15]
    s_waitcnt vmcnt(10)
    v_mfma_f32_16x16x32_bf16 v[8:11], a[168:171], v[116:119], v[8:11]
    v_mfma_f32_16x16x32_bf16 v[12:15], a[172:175], v[116:119], v[12:15]
    s_waitcnt vmcnt(9)
    v_mfma_f32_16x16x32_bf16 v[8:11], a[176:179], v[120:123], v[8:11]
    v_mfma_f32_16x16x32_bf16 v[12:15], a[180:183], v[120:123], v[12:15]
    s_waitcnt vmcnt(8)
    v_mfma_f32_16x16x32_bf16 v[8:11], a[184:187], v[124:127], v[8:11]
    v_mfma_f32_16x16x32_bf16 v[12:15], a[188:191], v[124:127], v[12:15]
    s_waitcnt vmcnt(7)
    v_mfma_f32_16x16x32_bf16 v[8:11], a[192:195], v[128:131], v[8:11]
    v_mfma_f32_16x16x32_bf16 v[12:15], a[196:199], v[128:131], v[12:15]
    s_waitcnt vmcnt(6)
    v_mfma_f32_16x16x32_bf16 v[8:11], a[200:203], v[132:135], v[8:11]
    v_mfma_f32_16x16x32_bf16 v[12:15], a[204:207], v[132:135], v[12:15]
    s_waitcnt vmcnt(5)
    v_mfma_f32_16x16x32_bf16 v[8:11], a[208:211], v[136:139], v[8:11]
    v_mfma_f32_16x16x32_bf16 v[12:15], a[212:215], v[136:139], v[12:15]
    s_waitcnt vmcnt(4)
    v_mfma_f32_16x16x32_bf16 v[8:11], a[216:219], v[140:143], v[8:11]
    v_mfma_f32_16x16x32_bf16 v[12:15], a[220:223], v[140:143], v[12:15]
    s_waitcnt vmcnt(3)
    v_mfma_f32_16x16x32_bf16 v[8:11], a[224:227], v[144:147], v[8:11]
    v_mfma_f32_16x16x32_bf16 v[12:15], a[228:231], v[144:147], v[12:15]
    s_waitcnt vmcnt(2)
    v_mfma_f32_16x16x32_bf16 v[8:11], a[232:235], v[148:151], v[8:11]
    v_mfma_f32_16x16x32_bf16 v[12:15], a[236:239], v[148:151], v[12:15]
    s_waitcnt vmcnt(1)
    v_mfma_f32_16x16x32_bf16 v[8:11], a[240:243], v[152:155], v[8:11]
    v_mfma_f32_16x16x32_bf16 v[12:15], a[244:247], v[152:155], v[12:15]
    s_waitcnt vmcnt(0)
    v_mfma_f32_16x16x32_bf16 v[8:11], a[248:251], v[156:159], v[8:11]
    v_mfma_f32_16x16x32_bf16 v[12:15], a[252:255], v[156:159], v[12:15]
    s_nop 6
    ds_write_b128 v2, v[8:11] offset:0
    ds_write_b128 v2, v[12:15] offset:1024
    s_waitcnt lgkmcnt(0)
    s_barrier
    s_cmp_lg_u32 s32, 0
    s_cbranch_scc1 os_skip
    ds_read_b128 v[40:43], v1 offset:2048
    ds_read_b128 v[44:47], v1 offset:3072
    ds_read_b128 v[48:51], v1 offset:4096
    ds_read_b128 v[52:55], v1 offset:5120
    ds_read_b128 v[56:59], v1 offset:6144
    ds_read_b128 v[60:63], v1 offset:7168
    v_lshrrev_b32 v3, 4, v1
    v_bfe_u32 v4, v3, 2, 2
    v_lshlrev_b32 v4, 3, v4
    v_and_b32 v2, 3, v3
    v_add_u32 v4, v4, v2
    v_mul_u32_u24 v4, 2304, v4
    v_lshrrev_b32 v3, 4, v3
    v_lshl_add_u32 v4, v3, 4, v4
    s_lshr_b32 s18, s16, 1
    s_lshl_b32 s18, s18, 3
    s_and_b32 s19, s16, 1
    s_add_u32 s18, s18, s19
    s_mul_i32 s18, s18, 9216
    s_lshl_b32 s19, s33, 6
    s_add_u32 s18, s18, s19
    s_waitcnt lgkmcnt(0)
    v_pk_add_f32 v[8:9], v[8:9], v[40:41]
    v_pk_add_f32 v[48:49], v[48:49], v[56:57]
    v_pk_add_f32 v[8:9], v[8:9], v[48:49]
    v_pk_add_f32 v[10:11], v[10:11], v[42:43]
    v_pk_add_f32 v[50:51], v[50:51], v[58:59]
    v_pk_add_f32 v[10:11], v[10:11], v[50:51]
    v_pk_add_f32 v[12:13], v[12:13], v[44:45]
    v_pk_add_f32 v[52:53], v[52:53], v[60:61]
    v_pk_add_f32 v[12:13], v[12:13], v[52:53]
    v_pk_add_f32 v[14:15], v[14:15], v[46:47]
    v_pk_add_f32 v[54:55], v[54:55], v[62:63]
    v_pk_add_f32 v[14:15], v[14:15], v[54:55]
    v_cvt_pk_bf16_f32 v32, v8, v12
    v_cvt_pk_bf16_f32 v33, v9, v13
    v_cvt_pk_bf16_f32 v34, v10, v14
    v_cvt_pk_bf16_f32 v35, v11, v15
    buffer_store_dwordx4 v[32:35], v4, s[8:11], s18 offen
os_skip:
    s_nop 1
    s_mov_b32 s37, s35
    v_mov_b32 v250, 1
    v_mov_b32 v251, 163832
    v_cmp_eq_u32 vcc, 0, v0
    s_nop 0
    s_and_saveexec_b64 s[38:39], vcc
    s_cbranch_execz tk18
    buffer_atomic_add v250, off, s[84:87], s37 sc0
    s_waitcnt vmcnt(0)
    ds_write_b32 v251, v250
    s_waitcnt lgkmcnt(0)
tk18:
    s_mov_b64 exec, -1
    s_barrier
    ds_read_b32 v252, v251
    s_waitcnt lgkmcnt(0)
    v_readfirstlane_b32 s16, v252
    s_barrier
    s_nop 3
    s_cmp_lt_u32 s16, 128
    s_cbranch_scc1 L_op_seg
L_op_nextcb:
    s_mov_b32 s40, -1
    s_cmp_lg_u32 s32, 0
    s_cbranch_scc1 L_op_dec
    v_and_b32 v1, 63, v0
    v_min_u32 v1, 17, v1
    v_lshlrev_b32 v2, 2, v1
    buffer_load_dword v3, v2, s[84:87], 0 offen offset:136 sc1
    s_waitcnt vmcnt(0)
    v_cmp_gt_u32 vcc, 100, v3
    s_nop 0
    s_ff1_i32_b64 s40, vcc
L_op_dec:
    v_mov_b32 v250, s40
    v_mov_b32 v251, 163832
    s_cmp_lg_u32 s32, 0
    s_cbranch_scc1 L_op_nw
    ds_write_b32 v251, v250
    s_waitcnt lgkmcnt(0)
L_op_nw:
    s_barrier
    ds_read_b32 v252, v251
    s_waitcnt lgkmcnt(0)
    v_readfirstlane_b32 s33, v252
    s_barrier
    s_nop 1
    s_cmp_lt_u32 s33, 18
    s_cbranch_scc1 L_op_start
L_exit:
    s_endpgm
.section .rodata,"a"
.p2align 6
.amdhsa_kernel concat_heads__memory_aug_recurrent_mem_tr__ssm_conv_s4d__prompt_kernel
  .amdhsa_next_free_vgpr 512
  .amdhsa_next_free_sgpr 102
  .amdhsa_accum_offset 256
  .amdhsa_group_segment_fixed_size 0
  .amdhsa_kernarg_size 136
  .amdhsa_user_sgpr_count 2
  .amdhsa_user_sgpr_kernarg_segment_ptr 1
  .amdhsa_system_sgpr_workgroup_id_x 1
.end_amdhsa_kernel
.text
```

```asm
; @launch grid=(256,1,1) block=(256,1,1) lds=163840
.amdgcn_target "amdgcn-amd-amdhsa--gfx950"
.text
.globl concat_heads__memory_aug_recurrent_mem_tr__ssm_conv_s4d__prompt_kernel
.p2align 8
.type concat_heads__memory_aug_recurrent_mem_tr__ssm_conv_s4d__prompt_kernel,@function
concat_heads__memory_aug_recurrent_mem_tr__ssm_conv_s4d__prompt_kernel:
    s_cmp_ge_u32 s2, 256
    s_cbranch_scc1 L_exit
    s_load_dwordx4 s[80:83], s[0:1], 120
    s_load_dwordx16 s[48:63], s[0:1], 0
    s_memrealtime s[90:91]
    v_lshrrev_b32 v1, 6, v0
    s_nop 0
    v_readfirstlane_b32 s32, v1
    s_waitcnt lgkmcnt(0)
    s_mov_b32 s4, s82
    s_mov_b32 s5, s83
    s_mov_b32 s6, 268435456
    s_mov_b32 s7, 0x20000
    s_mov_b32 s84, s80
    s_mov_b32 s85, s81
    s_mov_b32 s86, 256
    s_mov_b32 s87, 0x20000
    s_cmp_lg_u32 s32, 0
    s_cbranch_scc1 L_nod0
L_nod0:
    s_cmp_lg_u32 s32, 3
    s_cbranch_scc1 L_nowarm
    s_getpc_b64 s[44:45]
L_pcw:
    v_and_b32 v1, 63, v0
    v_lshlrev_b32 v1, 7, v1
    v_min_u32 v2, L_exit-L_pcw, v1
    global_load_dword v210, v2, s[44:45]
    v_add_u32 v1, 8192, v1
    v_min_u32 v2, L_exit-L_pcw, v1
    global_load_dword v211, v2, s[44:45]
    v_add_u32 v1, 8192, v1
    v_min_u32 v2, L_exit-L_pcw, v1
    global_load_dword v212, v2, s[44:45]
    v_add_u32 v1, 8192, v1
    v_min_u32 v2, L_exit-L_pcw, v1
    global_load_dword v213, v2, s[44:45]
    v_add_u32 v1, 8192, v1
    v_min_u32 v2, L_exit-L_pcw, v1
    global_load_dword v214, v2, s[44:45]
    v_add_u32 v1, 8192, v1
    v_min_u32 v2, L_exit-L_pcw, v1
    global_load_dword v215, v2, s[44:45]
    v_add_u32 v1, 8192, v1
    v_min_u32 v2, L_exit-L_pcw, v1
    global_load_dword v216, v2, s[44:45]
    v_add_u32 v1, 8192, v1
    v_min_u32 v2, L_exit-L_pcw, v1
    global_load_dword v217, v2, s[44:45]
    v_add_u32 v1, 8192, v1
L_nowarm:
    s_getreg_b32 s3, hwreg(HW_REG_XCC_ID)
    s_and_b32 s3, s3, 15
    s_cmp_lg_u32 s3, 0
    s_cbranch_scc1 L_helper
    s_mov_b32 s37, 128
    v_mov_b32 v250, 1
    v_mov_b32 v251, 163832
    v_cmp_eq_u32 vcc, 0, v0
    s_nop 0
    s_and_saveexec_b64 s[38:39], vcc
    s_cbranch_execz tk35
    buffer_atomic_add v250, off, s[84:87], s37 sc0
    s_waitcnt vmcnt(0)
    ds_write_b32 v251, v250
    s_waitcnt lgkmcnt(0)
tk35:
    s_mov_b64 exec, -1
    s_barrier
    ds_read_b32 v252, v251
    s_waitcnt lgkmcnt(0)
    v_readfirstlane_b32 s12, v252
    s_barrier
    s_nop 3
    s_cmp_ge_u32 s12, 32
    s_cbranch_scc1 L_helper
L_chain:
    s_load_dwordx8 s[48:55], s[0:1], 8
    s_load_dwordx2 s[56:57], s[0:1], 40
    s_waitcnt lgkmcnt(0)
    v_lshrrev_b32 v77, 6, v0
    s_nop 0
    v_readfirstlane_b32 s13, v77
    v_lshlrev_b32 v65, 4, v0
    v_and_b32 v48, 63, v0
    s_mov_b32 s10, 4718592
    s_mov_b32 s11, 0x20000
    v_lshrrev_b32 v49, 3, v48
    v_mul_u32_u24 v18, 1152, v49
    v_and_b32 v49, 7, v48
    v_lshl_add_u32 v18, v49, 4, v18
    s_mul_i32 s40, s12, 147456
    s_lshl_b32 s41, s13, 8
    s_add_u32 s40, s40, s41
    s_mov_b32 s42, s40
    s_xor_b32 s41, s13, 0
    s_mul_i32 s41, s41, 36864
    s_add_u32 s60, s41, s40
    s_xor_b32 s41, s13, 1
    s_mul_i32 s41, s41, 36864
    s_add_u32 s61, s41, s40
    s_xor_b32 s41, s13, 2
    s_mul_i32 s41, s41, 36864
    s_add_u32 s62, s41, s40
    s_xor_b32 s41, s13, 3
    s_mul_i32 s41, s41, 36864
    s_add_u32 s63, s41, s40
    s_lshl_b32 s43, s13, 12
    s_mov_b64 s[8:9], s[56:57]
    s_add_u32 m0, s43, 0
    s_add_u32 s41, s60, 0
    buffer_load_dwordx4 v18, s[8:11], s41 offen offset:0 nt lds
    s_add_u32 s41, s60, 8192
    buffer_load_dwordx4 v18, s[8:11], s41 offen offset:1024 nt lds
    s_add_u32 s41, s60, 16384
    buffer_load_dwordx4 v18, s[8:11], s41 offen offset:2048 nt lds
    s_add_u32 s41, s60, 24576
    buffer_load_dwordx4 v18, s[8:11], s41 offen offset:3072 nt lds
    s_add_u32 m0, s43, 36864
    s_add_u32 s41, s61, 0
    buffer_load_dwordx4 v18, s[8:11], s41 offen offset:0 nt lds
    s_add_u32 s41, s61, 8192
    buffer_load_dwordx4 v18, s[8:11], s41 offen offset:1024 nt lds
    s_add_u32 s41, s61, 16384
    buffer_load_dwordx4 v18, s[8:11], s41 offen offset:2048 nt lds
    s_add_u32 s41, s61, 24576
    buffer_load_dwordx4 v18, s[8:11], s41 offen offset:3072 nt lds
    s_add_u32 m0, s43, 73728
    s_add_u32 s41, s62, 0
    buffer_load_dwordx4 v18, s[8:11], s41 offen offset:0 nt lds
    s_add_u32 s41, s62, 8192
    buffer_load_dwordx4 v18, s[8:11], s41 offen offset:1024 nt lds
    s_add_u32 s41, s62, 16384
    buffer_load_dwordx4 v18, s[8:11], s41 offen offset:2048 nt lds
    s_add_u32 s41, s62, 24576
    buffer_load_dwordx4 v18, s[8:11], s41 offen offset:3072 nt lds
    s_add_u32 m0, s43, 110592
    s_add_u32 s41, s63, 0
    buffer_load_dwordx4 v18, s[8:11], s41 offen offset:0 nt lds
    s_add_u32 s41, s63, 8192
    buffer_load_dwordx4 v18, s[8:11], s41 offen offset:1024 nt lds
    s_add_u32 s41, s63, 16384
    buffer_load_dwordx4 v18, s[8:11], s41 offen offset:2048 nt lds
    s_add_u32 s41, s63, 24576
    buffer_load_dwordx4 v18, s[8:11], s41 offen offset:3072 nt lds
    v_lshrrev_b32 v49, 1, v48
    v_mul_u32_u24 v19, 1152, v49
    v_and_b32 v49, 1, v48
    v_lshl_add_u32 v19, v49, 4, v19
    s_mul_i32 s41, s13, 224
    s_sub_u32 s41, 1024, s41
    v_add_u32 v19, s41, v19
    v_lshrrev_b32 v49, 4, v48
    v_lshlrev_b32 v50, 2, v49
    v_and_b32 v51, 15, v48
    v_xor_b32 v51, v51, v50
    v_lshlrev_b32 v51, 4, v51
    v_lshl_add_u32 v16, v49, 15, v51
    v_lshrrev_b32 v50, 1, v49
    v_lshl_add_u32 v17, v50, 16, v51
    v_and_b32 v50, 1, v49
    v_lshl_add_u32 v17, v50, 13, v17
    s_lshl_b32 s40, s12, 8
    s_mul_i32 s58, s13, 1048576
    s_add_u32 s58, s58, s40
    s_lshr_b32 s41, s13, 1
    s_mul_i32 s59, s41, 262144
    s_and_b32 s41, s13, 1
    s_lshl_b32 s41, s41, 14
    s_add_u32 s59, s59, s41
    s_add_u32 s59, s59, s40
    s_add_u32 s59, s59, 4194304
    v_bfe_u32 v50, v48, 2, 2
    v_xor_b32 v51, s13, v50
    v_lshlrev_b32 v20, 6, v51
    v_and_b32 v51, 3, v48
    v_lshl_add_u32 v20, v51, 4, v20
    v_lshrrev_b32 v23, 2, v48
    v_lshl_add_u32 v20, v23, 8, v20
    s_xor_b32 s41, s43, 0
    v_add_u32 v24, s41, v20
    s_xor_b32 s41, s43, 4096
    v_add_u32 v25, s41, v20
    s_xor_b32 s41, s43, 8192
    v_add_u32 v26, s41, v20
    s_xor_b32 s41, s43, 12288
    v_add_u32 v27, s41, v20
    v_and_b32 v23, 1, v50
    v_lshl_add_u32 v23, v49, 2, v23
    v_lshrrev_b32 v50, 1, v50
    v_lshlrev_b32 v21, 7, v23
    v_lshl_add_u32 v21, v50, 6, v21
    v_lshl_add_u32 v21, v51, 4, v21
    v_add_u32 v21, s43, v21
    v_lshlrev_b32 v22, 9, v50
    v_xor_b32 v22, v22, v21
    v_lshlrev_b32 v23, 5, v23
    v_lshl_add_u32 v23, v50, 10, v23
    v_lshl_add_u32 v23, v51, 3, v23
    v_add_u32 v23, s43, v23
    v_bfe_u32 v60, v65, 4, 6
    v_and_b32 v61, 15, v60
    v_lshrrev_b32 v62, 4, v60
    v_mov_b32 v64, 0x4444
    v_mov_b32 v77, 0xeeee
    v_cmp_lt_u32 vcc, 7, v61
    s_nop 1
    v_cndmask_b32 v64, v64, v77, vcc
    v_xor_b32 v66, 1024, v65
    v_xor_b32 v67, 2048, v65
    v_xor_b32 v68, 3072, v65
    v_and_b32 v69, 511, v65
    s_mul_i32 s96, s13, 36864
    s_add_u32 s96, s96, 16384
    v_lshlrev_b32 v70, 4, v60
    v_add_u32 v70, s96, v70
    v_lshrrev_b32 v79, 1, v69
    s_lshl_b32 s96, s13, 8
    s_add_u32 s96, s96, 14336
    s_lshl_b32 s33, s13, 10
    s_add_u32 s97, s33, 8192
    v_mov_b32 v77, s97
    v_mov_b32 v78, s96
    v_cmp_lt_u32 vcc, 31, v60
    s_nop 1
    v_cndmask_b32 v71, v77, v78, vcc
    v_add_u32 v71, v71, v79
    v_and_b32 v77, 7, v61
    v_lshrrev_b32 v78, 3, v61
    v_lshlrev_b32 v74, 4, v77
    v_lshl_add_u32 v73, v62, 7, v74
    v_lshl_add_u32 v73, v78, 3, v73
    s_lshl_b32 s96, s13, 9
    v_add_u32 v73, s96, v73
    v_lshl_add_u32 v74, v78, 14, v74
    v_lshl_add_u32 v74, v62, 15, v74
    s_lshl_b32 s96, s13, 17
    v_add_u32 v74, s96, v74
    v_bfe_u32 v77, v61, 2, 1
    v_and_b32 v78, 3, v61
    v_bfe_u32 v79, v61, 1, 2
    s_cmp_lt_u32 s13, 2
    s_cselect_b64 vcc, -1, 0
    v_cndmask_b32 v77, 0, v77, vcc
    v_cndmask_b32 v78, v79, v78, vcc
    v_lshlrev_b32 v75, 7, v77
    v_lshl_add_u32 v75, v62, 4, v75
    v_lshl_add_u32 v75, v78, 2, v75
    v_lshl_add_u32 v58, v77, 3, v78
    v_lshlrev_b32 v79, 1, v78
    v_cndmask_b32 v58, v79, v58, vcc
    s_bfe_u32 s97, s12, 0x10001
    s_lshl_b32 s68, s97, 6
    s_lshl_b32 s97, s97, 2
    v_add_u32 v59, s97, v62
    s_bfe_u32 s96, s12, 0x10002
    s_and_b32 s40, s12, 1
    s_lshl_b32 s96, s96, 1
    s_add_u32 s96, s96, s40
    s_lshr_b32 s97, s12, 3
    s_lshl_b32 s98, s13, 2
    s_add_u32 s98, s98, s97
    s_lshl_b32 s98, s98, 2
    s_add_u32 s98, s98, s96
    s_lshl_b32 s98, s98, 8
    s_lshl_b32 s99, s13, 2
    s_add_u32 s99, s99, s96
    s_lshl_b32 s99, s99, 4
    s_lshl_b32 s41, s97, 1
    s_add_u32 s41, s41, s40
    s_lshl_b32 s41, s41, 7
    s_add_u32 s41, s41, 8192
    s_lshl_b32 s40, s40, 3
    s_add_u32 s40, s40, 512
    s_cmp_lt_u32 s13, 2
    s_cselect_b32 s96, 7, 4
    s_cselect_b32 s98, s98, s41
    s_cselect_b32 s99, s99, s40
    s_cselect_b32 s32, 1, 0
    s_add_u32 s68, s68, s98
    s_lshl_b32 s97, s97, s96
    s_add_u32 s99, s99, s97
    v_add_u32 v58, s99, v58
    s_and_b32 s97, s12, 4
    s_or_b32 s97, s97, s13
    s_cmp_eq_u32 s97, 2
    s_cselect_b32 s32, 2, s32
    s_mov_b32 s8, s48
    s_mov_b32 s9, s49
    s_mov_b32 s10, 9216
    s_cmp_lt_u32 s13, 2
    s_cselect_b32 s96, 8, 2
    v_mul_u32_u24 v77, 1152, v59
    v_lshl_add_u32 v77, v58, 1, v77
    buffer_load_ushort v72, v77, s[8:11], 0 offen
    buffer_load_ushort v76, v77, s[8:11], s96 offen
    s_mov_b32 s10, 4718592
    s_waitcnt vmcnt(12) lgkmcnt(0)
    s_barrier
    s_mov_b64 s[8:9], s[56:57]
    s_add_u32 m0, s43, 147456
    s_add_u32 s41, s42, 0
    buffer_load_dwordx4 v19, s[8:11], s41 offen offset:0 nt lds
    s_add_u32 s41, s42, 35840
    buffer_load_dwordx4 v19, s[8:11], s41 offen offset:1024 nt lds
    s_add_u32 s41, s42, 71680
    buffer_load_dwordx4 v19, s[8:11], s41 offen offset:2048 nt lds
    s_add_u32 s41, s42, 107520
    buffer_load_dwordx4 v19, s[8:11], s41 offen offset:3072 nt lds
    v_mov_b32 v78, v21
    v_mov_b32 v79, v22
    v_add_u32 v77, 0, v79
    ds_read_b64_tr_b16 v[80:81], v77 offset:0
    ds_read_b64_tr_b16 v[82:83], v77 offset:256
    ds_read_b64_tr_b16 v[84:85], v77 offset:2048
    ds_read_b64_tr_b16 v[86:87], v77 offset:2304
    ds_read_b64_tr_b16 v[112:113], v77 offset:8
    ds_read_b64_tr_b16 v[114:115], v77 offset:264
    ds_read_b64_tr_b16 v[116:117], v77 offset:2056
    ds_read_b64_tr_b16 v[118:119], v77 offset:2312
    s_waitcnt vmcnt(12) lgkmcnt(0)
    s_barrier
    s_mov_b64 s[8:9], s[52:53]
    s_add_u32 m0, s43, 0
    s_add_u32 s41, s58, 0
    buffer_load_dwordx4 v16, s[8:11], s41 offen offset:0 nt lds
    s_add_u32 s41, s58, 15360
    buffer_load_dwordx4 v16, s[8:11], s41 offen offset:1024 nt lds
    s_add_u32 s41, s58, 129024
    buffer_load_dwordx4 v16, s[8:11], s41 offen offset:2048 nt lds
    s_add_u32 s41, s58, 144384
    buffer_load_dwordx4 v16, s[8:11], s41 offen offset:3072 nt lds
    v_add_u32 v77, 36864, v78
    ds_read_b64_tr_b16 v[88:89], v77 offset:0
    ds_read_b64_tr_b16 v[90:91], v77 offset:256
    ds_read_b64_tr_b16 v[92:93], v77 offset:2048
    ds_read_b64_tr_b16 v[94:95], v77 offset:2304
    ds_read_b64_tr_b16 v[120:121], v77 offset:8
    ds_read_b64_tr_b16 v[122:123], v77 offset:264
    ds_read_b64_tr_b16 v[124:125], v77 offset:2056
    ds_read_b64_tr_b16 v[126:127], v77 offset:2312
    s_waitcnt vmcnt(12) lgkmcnt(0)
    s_barrier
    s_add_u32 m0, s43, 36864
    s_add_u32 s41, s58, 8192
    buffer_load_dwordx4 v16, s[8:11], s41 offen offset:0 nt lds
    s_add_u32 s41, s58, 23552
    buffer_load_dwordx4 v16, s[8:11], s41 offen offset:1024 nt lds
    s_add_u32 s41, s58, 137216
    buffer_load_dwordx4 v16, s[8:11], s41 offen offset:2048 nt lds
    s_add_u32 s41, s58, 152576
    buffer_load_dwordx4 v16, s[8:11], s41 offen offset:3072 nt lds
    v_add_u32 v77, 73728, v78
    ds_read_b64_tr_b16 v[96:97], v77 offset:0
    ds_read_b64_tr_b16 v[98:99], v77 offset:256
    ds_read_b64_tr_b16 v[100:101], v77 offset:2048
    ds_read_b64_tr_b16 v[102:103], v77 offset:2304
    ds_read_b64_tr_b16 v[128:129], v77 offset:8
    ds_read_b64_tr_b16 v[130:131], v77 offset:264
    ds_read_b64_tr_b16 v[132:133], v77 offset:2056
    ds_read_b64_tr_b16 v[134:135], v77 offset:2312
    s_waitcnt vmcnt(12) lgkmcnt(0)
    s_barrier
    s_add_u32 m0, s43, 73728
    s_add_u32 s41, s58, 262144
    buffer_load_dwordx4 v16, s[8:11], s41 offen offset:0 nt lds
    s_add_u32 s41, s58, 277504
    buffer_load_dwordx4 v16, s[8:11], s41 offen offset:1024 nt lds
    s_add_u32 s41, s58, 391168
    buffer_load_dwordx4 v16, s[8:11], s41 offen offset:2048 nt lds
    s_add_u32 s41, s58, 406528
    buffer_load_dwordx4 v16, s[8:11], s41 offen offset:3072 nt lds
    v_add_u32 v77, 110592, v78
    ds_read_b64_tr_b16 v[104:105], v77 offset:0
    ds_read_b64_tr_b16 v[106:107], v77 offset:256
    ds_read_b64_tr_b16 v[108:109], v77 offset:2048
    ds_read_b64_tr_b16 v[110:111], v77 offset:2304
    ds_read_b64_tr_b16 v[136:137], v77 offset:8
    ds_read_b64_tr_b16 v[138:139], v77 offset:264
    ds_read_b64_tr_b16 v[140:141], v77 offset:2056
    ds_read_b64_tr_b16 v[142:143], v77 offset:2312
    s_waitcnt vmcnt(12) lgkmcnt(0)
    s_barrier
    s_add_u32 m0, s43, 110592
    s_add_u32 s41, s58, 270336
    buffer_load_dwordx4 v16, s[8:11], s41 offen offset:0 nt lds
    s_add_u32 s41, s58, 285696
    buffer_load_dwordx4 v16, s[8:11], s41 offen offset:1024 nt lds
    s_add_u32 s41, s58, 399360
    buffer_load_dwordx4 v16, s[8:11], s41 offen offset:2048 nt lds
    s_add_u32 s41, s58, 414720
    buffer_load_dwordx4 v16, s[8:11], s41 offen offset:3072 nt lds
    v_add_u32 v77, 147456, v23
    ds_read_b64_tr_b16 v[144:145], v77 offset:0
    ds_read_b64_tr_b16 v[146:147], v77 offset:64
    ds_read_b64_tr_b16 v[148:149], v77 offset:512
    ds_read_b64_tr_b16 v[150:151], v77 offset:576
    ds_read_b64_tr_b16 v[152:153], v77 offset:2048
    ds_read_b64_tr_b16 v[154:155], v77 offset:2112
    ds_read_b64_tr_b16 v[156:157], v77 offset:2560
    ds_read_b64_tr_b16 v[158:159], v77 offset:2624
    s_waitcnt vmcnt(12) lgkmcnt(0)
    s_barrier
    s_add_u32 m0, s43, 147456
    s_add_u32 s41, s58, 524288
    buffer_load_dwordx4 v16, s[8:11], s41 offen offset:0 nt lds
    s_add_u32 s41, s58, 539648
    buffer_load_dwordx4 v16, s[8:11], s41 offen offset:1024 nt lds
    s_add_u32 s41, s58, 653312
    buffer_load_dwordx4 v16, s[8:11], s41 offen offset:2048 nt lds
    s_add_u32 s41, s58, 668672
    buffer_load_dwordx4 v16, s[8:11], s41 offen offset:3072 nt lds
    s_cmp_eq_u32 s32, 0
    s_cbranch_scc1 cf_init_done
    v_mov_b32 v52, 1
    v_mov_b32 v53, 1
    v_mov_b32 v54, 1
    v_mov_b32 v55, 1
    v_mov_b32 v56, 0
    v_lshl_or_b32 v72, v76, 16, v72
    s_lshl_b32 s96, s12, 14
    s_add_u32 s96, s96, 68157440
    s_add_u32 s97, s96, 0
    buffer_store_dwordx4 v[52:55], v65, s[4:7], s97 offen
    buffer_load_dwordx4 v[60:63], v65, s[4:7], s97 offen sc1
    s_add_u32 s97, s96, 4096
    buffer_store_dwordx4 v[52:55], v65, s[4:7], s97 offen
    buffer_load_dwordx4 v[60:63], v65, s[4:7], s97 offen sc1
    s_add_u32 s97, s96, 8192
    buffer_store_dwordx4 v[52:55], v65, s[4:7], s97 offen
    buffer_load_dwordx4 v[60:63], v65, s[4:7], s97 offen sc1
    s_add_u32 s97, s96, 12288
    buffer_store_dwordx4 v[52:55], v65, s[4:7], s97 offen
    buffer_load_dwordx4 v[60:63], v65, s[4:7], s97 offen sc1
    s_add_u32 s96, s68, 67108864
    s_add_u32 s97, s96, 16384
    buffer_store_dword v56, v75, s[4:7], s96 offen offset:0
    buffer_store_dword v72, v75, s[4:7], s97 offen offset:0
    buffer_load_dword v60, v75, s[4:7], s96 offen offset:0 sc1
    buffer_load_dword v60, v75, s[4:7], s97 offen offset:0 sc1
    s_cmp_lg_u32 s32, 2
    s_cbranch_scc1 cf_init_done
    buffer_store_dword v56, v75, s[4:7], s96 offen offset:1024
    buffer_store_dword v72, v75, s[4:7], s97 offen offset:1024
    buffer_load_dword v60, v75, s[4:7], s96 offen offset:1024 sc1
    buffer_load_dword v60, v75, s[4:7], s97 offen offset:1024 sc1
    buffer_store_dword v56, v75, s[4:7], s96 offen offset:2048
    buffer_store_dword v72, v75, s[4:7], s97 offen offset:2048
    buffer_load_dword v60, v75, s[4:7], s96 offen offset:2048 sc1
    buffer_load_dword v60, v75, s[4:7], s97 offen offset:2048 sc1
    buffer_store_dword v56, v75, s[4:7], s96 offen offset:3072
    buffer_store_dword v72, v75, s[4:7], s97 offen offset:3072
    buffer_load_dword v60, v75, s[4:7], s96 offen offset:3072 sc1
    buffer_load_dword v60, v75, s[4:7], s97 offen offset:3072 sc1
cf_init_done:
    v_add_u32 v28, 0, v24
    v_add_u32 v29, 0, v25
    v_add_u32 v30, 0, v26
    v_add_u32 v31, 0, v27
    ds_read_b64_tr_b16 a[96:97], v28 offset:0
    ds_read_b64_tr_b16 a[104:105], v28 offset:8
    ds_read_b64_tr_b16 a[112:113], v29 offset:0
    ds_read_b64_tr_b16 a[120:121], v29 offset:8
    ds_read_b64_tr_b16 a[128:129], v30 offset:0
    ds_read_b64_tr_b16 a[136:137], v30 offset:8
    ds_read_b64_tr_b16 a[144:145], v31 offset:0
    ds_read_b64_tr_b16 v[32:33], v31 offset:8
    s_waitcnt vmcnt(12) lgkmcnt(0)
    s_barrier
    s_add_u32 m0, s43, 0
    s_add_u32 s41, s58, 532480
    buffer_load_dwordx4 v16, s[8:11], s41 offen offset:0 nt lds
    s_add_u32 s41, s58, 547840
    buffer_load_dwordx4 v16, s[8:11], s41 offen offset:1024 nt lds
    s_add_u32 s41, s58, 661504
    buffer_load_dwordx4 v16, s[8:11], s41 offen offset:2048 nt lds
    s_add_u32 s41, s58, 676864
    buffer_load_dwordx4 v16, s[8:11], s41 offen offset:3072 nt lds
    ds_write_b64 v70, v[32:33] offset:12288
    v_add_u32 v28, 36864, v24
    v_add_u32 v29, 36864, v25
    v_add_u32 v30, 36864, v26
    v_add_u32 v31, 36864, v27
    ds_read_b64_tr_b16 a[98:99], v28 offset:0
    ds_read_b64_tr_b16 a[106:107], v28 offset:8
    ds_read_b64_tr_b16 a[114:115], v29 offset:0
    ds_read_b64_tr_b16 a[122:123], v29 offset:8
    ds_read_b64_tr_b16 a[130:131], v30 offset:0
    ds_read_b64_tr_b16 a[138:139], v30 offset:8
    ds_read_b64_tr_b16 a[146:147], v31 offset:0
    ds_read_b64_tr_b16 v[0:1], v31 offset:8
    s_waitcnt vmcnt(12) lgkmcnt(0)
    s_barrier
    s_add_u32 m0, s43, 36864
    s_add_u32 s41, s58, 786432
    buffer_load_dwordx4 v16, s[8:11], s41 offen offset:0 nt lds
    s_add_u32 s41, s58, 801792
    buffer_load_dwordx4 v16, s[8:11], s41 offen offset:1024 nt lds
    s_add_u32 s41, s58, 915456
    buffer_load_dwordx4 v16, s[8:11], s41 offen offset:2048 nt lds
    s_add_u32 s41, s58, 930816
    buffer_load_dwordx4 v16, s[8:11], s41 offen offset:3072 nt lds
    ds_write_b64 v70, v[0:1] offset:12296
    v_add_u32 v28, 73728, v24
    v_add_u32 v29, 73728, v25
    v_add_u32 v30, 73728, v26
    v_add_u32 v31, 73728, v27
    ds_read_b64_tr_b16 a[100:101], v28 offset:0
    ds_read_b64_tr_b16 a[108:109], v28 offset:8
    ds_read_b64_tr_b16 a[116:117], v29 offset:0
    ds_read_b64_tr_b16 a[124:125], v29 offset:8
    ds_read_b64_tr_b16 a[132:133], v30 offset:0
    ds_read_b64_tr_b16 a[140:141], v30 offset:8
    ds_read_b64_tr_b16 a[148:149], v31 offset:0
    ds_read_b64_tr_b16 v[32:33], v31 offset:8
    s_waitcnt vmcnt(12) lgkmcnt(0)
    s_barrier
    s_add_u32 m0, s43, 73728
    s_add_u32 s41, s58, 794624
    buffer_load_dwordx4 v16, s[8:11], s41 offen offset:0 nt lds
    s_add_u32 s41, s58, 809984
    buffer_load_dwordx4 v16, s[8:11], s41 offen offset:1024 nt lds
    s_add_u32 s41, s58, 923648
    buffer_load_dwordx4 v16, s[8:11], s41 offen offset:2048 nt lds
    s_add_u32 s41, s58, 939008
    buffer_load_dwordx4 v16, s[8:11], s41 offen offset:3072 nt lds
    ds_write_b64 v70, v[32:33] offset:13312
    v_add_u32 v28, 110592, v24
    v_add_u32 v29, 110592, v25
    v_add_u32 v30, 110592, v26
    v_add_u32 v31, 110592, v27
    ds_read_b64_tr_b16 a[102:103], v28 offset:0
    ds_read_b64_tr_b16 a[110:111], v28 offset:8
    ds_read_b64_tr_b16 a[118:119], v29 offset:0
    ds_read_b64_tr_b16 a[126:127], v29 offset:8
    ds_read_b64_tr_b16 a[134:135], v30 offset:0
    ds_read_b64_tr_b16 a[142:143], v30 offset:8
    ds_read_b64_tr_b16 a[150:151], v31 offset:0
    ds_read_b64_tr_b16 v[0:1], v31 offset:8
    s_waitcnt vmcnt(12) lgkmcnt(0)
    s_barrier
    s_add_u32 m0, s43, 110592
    s_add_u32 s41, s59, 0
    buffer_load_dwordx4 v17, s[8:11], s41 offen offset:0 nt lds
    s_add_u32 s41, s59, 31744
    buffer_load_dwordx4 v17, s[8:11], s41 offen offset:1024 nt lds
    s_add_u32 s41, s59, 129024
    buffer_load_dwordx4 v17, s[8:11], s41 offen offset:2048 nt lds
    s_add_u32 s41, s59, 160768
    buffer_load_dwordx4 v17, s[8:11], s41 offen offset:3072 nt lds
    ds_write_b64 v70, v[0:1] offset:13320
    v_add_u32 v28, 147456, v24
    v_add_u32 v29, 147456, v25
    v_add_u32 v30, 147456, v26
    v_add_u32 v31, 147456, v27
    ds_read_b64_tr_b16 a[152:153], v28 offset:0
    ds_read_b64_tr_b16 a[160:161], v28 offset:8
    ds_read_b64_tr_b16 v[32:33], v29 offset:0
    ds_read_b64_tr_b16 a[168:169], v29 offset:8
    ds_read_b64_tr_b16 a[176:177], v30 offset:0
    ds_read_b64_tr_b16 a[184:185], v30 offset:8
    ds_read_b64_tr_b16 v[34:35], v31 offset:0
    ds_read_b64_tr_b16 a[192:193], v31 offset:8
    s_waitcnt vmcnt(12) lgkmcnt(0)
    s_barrier
    s_mov_b64 s[8:9], s[50:51]
    s_add_u32 m0, s43, 147456
    s_add_u32 s41, s58, 0
    buffer_load_dwordx4 v16, s[8:11], s41 offen offset:0 nt lds
    s_add_u32 s41, s58, 15360
    buffer_load_dwordx4 v16, s[8:11], s41 offen offset:1024 nt lds
    s_add_u32 s41, s58, 129024
    buffer_load_dwordx4 v16, s[8:11], s41 offen offset:2048 nt lds
    s_add_u32 s41, s58, 144384
    buffer_load_dwordx4 v16, s[8:11], s41 offen offset:3072 nt lds
    s_cmp_lg_u32 s13, 0
    s_cbranch_scc1 cf_ma
    v_mov_b32 v54, 1
    s_mov_b64 exec, 1
    buffer_atomic_add v54, off, s[84:87], 0 offset:132
    s_mov_b64 exec, -1
cf_ma:
    ds_write_b64 v70, v[32:33] offset:16384
    ds_write_b64 v70, v[34:35] offset:18432
    v_add_u32 v28, 0, v24
    v_add_u32 v29, 0, v25
    v_add_u32 v30, 0, v26
    v_add_u32 v31, 0, v27
    ds_read_b64_tr_b16 a[154:155], v28 offset:0
    ds_read_b64_tr_b16 a[162:163], v28 offset:8
    ds_read_b64_tr_b16 v[0:1], v29 offset:0
    ds_read_b64_tr_b16 a[170:171], v29 offset:8
    ds_read_b64_tr_b16 a[178:179], v30 offset:0
    ds_read_b64_tr_b16 a[186:187], v30 offset:8
    ds_read_b64_tr_b16 v[2:3], v31 offset:0
    ds_read_b64_tr_b16 a[194:195], v31 offset:8
    s_waitcnt vmcnt(12) lgkmcnt(0)
    s_barrier
    s_add_u32 m0, s43, 0
    s_add_u32 s41, s58, 8192
    buffer_load_dwordx4 v16, s[8:11], s41 offen offset:0 nt lds
    s_add_u32 s41, s58, 23552
    buffer_load_dwordx4 v16, s[8:11], s41 offen offset:1024 nt lds
    s_add_u32 s41, s58, 137216
    buffer_load_dwordx4 v16, s[8:11], s41 offen offset:2048 nt lds
    s_add_u32 s41, s58, 152576
    buffer_load_dwordx4 v16, s[8:11], s41 offen offset:3072 nt lds
    ds_write_b64 v70, v[0:1] offset:16392
    ds_write_b64 v70, v[2:3] offset:18440
    v_add_u32 v28, 36864, v24
    v_add_u32 v29, 36864, v25
    v_add_u32 v30, 36864, v26
    v_add_u32 v31, 36864, v27
    ds_read_b64_tr_b16 a[156:157], v28 offset:0
    ds_read_b64_tr_b16 a[164:165], v28 offset:8
    ds_read_b64_tr_b16 v[32:33], v29 offset:0
    ds_read_b64_tr_b16 a[172:173], v29 offset:8
    ds_read_b64_tr_b16 a[180:181], v30 offset:0
    ds_read_b64_tr_b16 a[188:189], v30 offset:8
    ds_read_b64_tr_b16 v[34:35], v31 offset:0
    ds_read_b64_tr_b16 a[196:197], v31 offset:8
    s_waitcnt vmcnt(12) lgkmcnt(0)
    s_barrier
    s_add_u32 m0, s43, 36864
    s_add_u32 s41, s58, 262144
    buffer_load_dwordx4 v16, s[8:11], s41 offen offset:0 nt lds
    s_add_u32 s41, s58, 277504
    buffer_load_dwordx4 v16, s[8:11], s41 offen offset:1024 nt lds
    s_add_u32 s41, s58, 391168
    buffer_load_dwordx4 v16, s[8:11], s41 offen offset:2048 nt lds
    s_add_u32 s41, s58, 406528
    buffer_load_dwordx4 v16, s[8:11], s41 offen offset:3072 nt lds
    ds_write_b64 v70, v[32:33] offset:17408
    ds_write_b64 v70, v[34:35] offset:19456
    v_add_u32 v28, 73728, v24
    v_add_u32 v29, 73728, v25
    v_add_u32 v30, 73728, v26
    v_add_u32 v31, 73728, v27
    ds_read_b64_tr_b16 a[158:159], v28 offset:0
    ds_read_b64_tr_b16 a[166:167], v28 offset:8
    ds_read_b64_tr_b16 v[0:1], v29 offset:0
    ds_read_b64_tr_b16 a[174:175], v29 offset:8
    ds_read_b64_tr_b16 a[182:183], v30 offset:0
    ds_read_b64_tr_b16 a[190:191], v30 offset:8
    ds_read_b64_tr_b16 v[2:3], v31 offset:0
    ds_read_b64_tr_b16 a[198:199], v31 offset:8
    s_waitcnt vmcnt(12) lgkmcnt(0)
    s_barrier
    s_add_u32 m0, s43, 73728
    s_add_u32 s41, s58, 270336
    buffer_load_dwordx4 v16, s[8:11], s41 offen offset:0 nt lds
    s_add_u32 s41, s58, 285696
    buffer_load_dwordx4 v16, s[8:11], s41 offen offset:1024 nt lds
    s_add_u32 s41, s58, 399360
    buffer_load_dwordx4 v16, s[8:11], s41 offen offset:2048 nt lds
    s_add_u32 s41, s58, 414720
    buffer_load_dwordx4 v16, s[8:11], s41 offen offset:3072 nt lds
    ds_write_b64 v70, v[0:1] offset:17416
    ds_write_b64 v70, v[2:3] offset:19464
    v_add_u32 v77, 110592, v20
    ds_read_b64_tr_b16 a[200:201], v77 offset:0
    ds_read_b64_tr_b16 a[202:203], v77 offset:4096
    ds_read_b64_tr_b16 a[204:205], v77 offset:8192
    ds_read_b64_tr_b16 a[206:207], v77 offset:12288
    ds_read_b64_tr_b16 a[208:209], v77 offset:8
    ds_read_b64_tr_b16 a[210:211], v77 offset:4104
    ds_read_b64_tr_b16 a[212:213], v77 offset:8200
    ds_read_b64_tr_b16 a[214:215], v77 offset:12296
    s_waitcnt vmcnt(12) lgkmcnt(0)
    s_barrier
    s_add_u32 m0, s43, 110592
    s_add_u32 s41, s58, 524288
    buffer_load_dwordx4 v16, s[8:11], s41 offen offset:0 nt lds
    s_add_u32 s41, s58, 539648
    buffer_load_dwordx4 v16, s[8:11], s41 offen offset:1024 nt lds
    s_add_u32 s41, s58, 653312
    buffer_load_dwordx4 v16, s[8:11], s41 offen offset:2048 nt lds
    s_add_u32 s41, s58, 668672
    buffer_load_dwordx4 v16, s[8:11], s41 offen offset:3072 nt lds
    v_add_u32 v28, 147456, v24
    v_add_u32 v29, 147456, v25
    v_add_u32 v30, 147456, v26
    v_add_u32 v31, 147456, v27
    ds_read_b64_tr_b16 v[0:1], v28 offset:0
    ds_read_b64_tr_b16 v[2:3], v28 offset:8
    ds_read_b64_tr_b16 v[4:5], v29 offset:0
    ds_read_b64_tr_b16 v[6:7], v29 offset:8
    ds_read_b64_tr_b16 a[0:1], v30 offset:0
    ds_read_b64_tr_b16 v[8:9], v30 offset:8
    ds_read_b64_tr_b16 a[8:9], v31 offset:0
    ds_read_b64_tr_b16 v[10:11], v31 offset:8
    s_waitcnt vmcnt(12) lgkmcnt(0)
    s_barrier
    s_add_u32 m0, s43, 147456
    s_add_u32 s41, s58, 532480
    buffer_load_dwordx4 v16, s[8:11], s41 offen offset:0 nt lds
    s_add_u32 s41, s58, 547840
    buffer_load_dwordx4 v16, s[8:11], s41 offen offset:1024 nt lds
    s_add_u32 s41, s58, 661504
    buffer_load_dwordx4 v16, s[8:11], s41 offen offset:2048 nt lds
    s_add_u32 s41, s58, 676864
    buffer_load_dwordx4 v16, s[8:11], s41 offen offset:3072 nt lds
    ds_write_b64 v70, v[0:1] offset:0
    ds_write_b64 v70, v[2:3] offset:2048
    ds_write_b64 v70, v[4:5] offset:4096
    ds_write_b64 v70, v[6:7] offset:6144
    ds_write_b64 v70, v[8:9] offset:10240
    ds_write_b64 v70, v[10:11] offset:14336
    v_add_u32 v28, 0, v24
    v_add_u32 v29, 0, v25
    v_add_u32 v30, 0, v26
    v_add_u32 v31, 0, v27
    ds_read_b64_tr_b16 v[32:33], v28 offset:0
    ds_read_b64_tr_b16 v[34:35], v28 offset:8
    ds_read_b64_tr_b16 v[36:37], v29 offset:0
    ds_read_b64_tr_b16 v[38:39], v29 offset:8
    ds_read_b64_tr_b16 a[2:3], v30 offset:0
    ds_read_b64_tr_b16 v[40:41], v30 offset:8
    ds_read_b64_tr_b16 a[10:11], v31 offset:0
    ds_read_b64_tr_b16 v[42:43], v31 offset:8
    s_waitcnt vmcnt(12) lgkmcnt(0)
    s_barrier
    s_add_u32 m0, s43, 0
    s_add_u32 s41, s58, 786432
    buffer_load_dwordx4 v16, s[8:11], s41 offen offset:0 nt lds
    s_add_u32 s41, s58, 801792
    buffer_load_dwordx4 v16, s[8:11], s41 offen offset:1024 nt lds
    s_add_u32 s41, s58, 915456
    buffer_load_dwordx4 v16, s[8:11], s41 offen offset:2048 nt lds
    s_add_u32 s41, s58, 930816
    buffer_load_dwordx4 v16, s[8:11], s41 offen offset:3072 nt lds
    ds_write_b64 v70, v[32:33] offset:8
    ds_write_b64 v70, v[34:35] offset:2056
    ds_write_b64 v70, v[36:37] offset:4104
    ds_write_b64 v70, v[38:39] offset:6152
    ds_write_b64 v70, v[40:41] offset:10248
    ds_write_b64 v70, v[42:43] offset:14344
    v_add_u32 v28, 36864, v24
    v_add_u32 v29, 36864, v25
    v_add_u32 v30, 36864, v26
    v_add_u32 v31, 36864, v27
    ds_read_b64_tr_b16 v[0:1], v28 offset:0
    ds_read_b64_tr_b16 v[2:3], v28 offset:8
    ds_read_b64_tr_b16 v[4:5], v29 offset:0
    ds_read_b64_tr_b16 v[6:7], v29 offset:8
    ds_read_b64_tr_b16 a[4:5], v30 offset:0
    ds_read_b64_tr_b16 v[8:9], v30 offset:8
    ds_read_b64_tr_b16 a[12:13], v31 offset:0
    ds_read_b64_tr_b16 v[10:11], v31 offset:8
    s_waitcnt vmcnt(12) lgkmcnt(0)
    s_barrier
    s_add_u32 m0, s43, 36864
    s_add_u32 s41, s58, 794624
    buffer_load_dwordx4 v16, s[8:11], s41 offen offset:0 nt lds
    s_add_u32 s41, s58, 809984
    buffer_load_dwordx4 v16, s[8:11], s41 offen offset:1024 nt lds
    s_add_u32 s41, s58, 923648
    buffer_load_dwordx4 v16, s[8:11], s41 offen offset:2048 nt lds
    s_add_u32 s41, s58, 939008
    buffer_load_dwordx4 v16, s[8:11], s41 offen offset:3072 nt lds
    ds_write_b64 v70, v[0:1] offset:1024
    ds_write_b64 v70, v[2:3] offset:3072
    ds_write_b64 v70, v[4:5] offset:5120
    ds_write_b64 v70, v[6:7] offset:7168
    ds_write_b64 v70, v[8:9] offset:11264
    ds_write_b64 v70, v[10:11] offset:15360
    v_add_u32 v28, 73728, v24
    v_add_u32 v29, 73728, v25
    v_add_u32 v30, 73728, v26
    v_add_u32 v31, 73728, v27
    ds_read_b64_tr_b16 v[32:33], v28 offset:0
    ds_read_b64_tr_b16 v[34:35], v28 offset:8
    ds_read_b64_tr_b16 v[36:37], v29 offset:0
    ds_read_b64_tr_b16 v[38:39], v29 offset:8
    ds_read_b64_tr_b16 a[6:7], v30 offset:0
    ds_read_b64_tr_b16 v[40:41], v30 offset:8
    ds_read_b64_tr_b16 a[14:15], v31 offset:0
    ds_read_b64_tr_b16 v[42:43], v31 offset:8
    s_waitcnt vmcnt(12) lgkmcnt(0)
    s_barrier
    s_add_u32 m0, s43, 73728
    s_add_u32 s41, s59, 0
    buffer_load_dwordx4 v17, s[8:11], s41 offen offset:0 nt lds
    s_add_u32 s41, s59, 31744
    buffer_load_dwordx4 v17, s[8:11], s41 offen offset:1024 nt lds
    s_add_u32 s41, s59, 129024
    buffer_load_dwordx4 v17, s[8:11], s41 offen offset:2048 nt lds
    s_add_u32 s41, s59, 160768
    buffer_load_dwordx4 v17, s[8:11], s41 offen offset:3072 nt lds
    ds_write_b64 v70, v[32:33] offset:1032
    ds_write_b64 v70, v[34:35] offset:3080
    ds_write_b64 v70, v[36:37] offset:5128
    ds_write_b64 v70, v[38:39] offset:7176
    ds_write_b64 v70, v[40:41] offset:11272
    ds_write_b64 v70, v[42:43] offset:15368
    v_add_u32 v28, 110592, v24
    v_add_u32 v29, 110592, v25
    v_add_u32 v30, 110592, v26
    v_add_u32 v31, 110592, v27
    ds_read_b64_tr_b16 a[16:17], v28 offset:0
    ds_read_b64_tr_b16 a[24:25], v28 offset:8
    ds_read_b64_tr_b16 a[32:33], v29 offset:0
    ds_read_b64_tr_b16 a[40:41], v29 offset:8
    ds_read_b64_tr_b16 a[48:49], v30 offset:0
    ds_read_b64_tr_b16 a[56:57], v30 offset:8
    ds_read_b64_tr_b16 a[64:65], v31 offset:0
    ds_read_b64_tr_b16 a[72:73], v31 offset:8
    s_waitcnt vmcnt(12) lgkmcnt(0)
    s_barrier
    s_mov_b64 s[8:9], s[54:55]
    s_add_u32 m0, s43, 110592
    s_add_u32 s41, s58, 0
    buffer_load_dwordx4 v16, s[8:11], s41 offen offset:0 nt lds
    s_add_u32 s41, s58, 15360
    buffer_load_dwordx4 v16, s[8:11], s41 offen offset:1024 nt lds
    s_add_u32 s41, s58, 129024
    buffer_load_dwordx4 v16, s[8:11], s41 offen offset:2048 nt lds
    s_add_u32 s41, s58, 144384
    buffer_load_dwordx4 v16, s[8:11], s41 offen offset:3072 nt lds
    v_add_u32 v28, 147456, v24
    v_add_u32 v29, 147456, v25
    v_add_u32 v30, 147456, v26
    v_add_u32 v31, 147456, v27
    ds_read_b64_tr_b16 a[18:19], v28 offset:0
    ds_read_b64_tr_b16 a[26:27], v28 offset:8
    ds_read_b64_tr_b16 a[34:35], v29 offset:0
    ds_read_b64_tr_b16 a[42:43], v29 offset:8
    ds_read_b64_tr_b16 a[50:51], v30 offset:0
    ds_read_b64_tr_b16 a[58:59], v30 offset:8
    ds_read_b64_tr_b16 a[66:67], v31 offset:0
    ds_read_b64_tr_b16 a[74:75], v31 offset:8
    s_waitcnt vmcnt(12) lgkmcnt(0)
    s_barrier
    s_add_u32 m0, s43, 147456
    s_add_u32 s41, s58, 8192
    buffer_load_dwordx4 v16, s[8:11], s41 offen offset:0 nt lds
    s_add_u32 s41, s58, 23552
    buffer_load_dwordx4 v16, s[8:11], s41 offen offset:1024 nt lds
    s_add_u32 s41, s58, 137216
    buffer_load_dwordx4 v16, s[8:11], s41 offen offset:2048 nt lds
    s_add_u32 s41, s58, 152576
    buffer_load_dwordx4 v16, s[8:11], s41 offen offset:3072 nt lds
    v_add_u32 v28, 0, v24
    v_add_u32 v29, 0, v25
    v_add_u32 v30, 0, v26
    v_add_u32 v31, 0, v27
    ds_read_b64_tr_b16 a[20:21], v28 offset:0
    ds_read_b64_tr_b16 a[28:29], v28 offset:8
    ds_read_b64_tr_b16 a[36:37], v29 offset:0
    ds_read_b64_tr_b16 a[44:45], v29 offset:8
    ds_read_b64_tr_b16 a[52:53], v30 offset:0
    ds_read_b64_tr_b16 a[60:61], v30 offset:8
    ds_read_b64_tr_b16 a[68:69], v31 offset:0
    ds_read_b64_tr_b16 a[76:77], v31 offset:8
    s_waitcnt vmcnt(12) lgkmcnt(0)
    s_barrier
    s_add_u32 m0, s43, 0
    s_add_u32 s41, s58, 262144
    buffer_load_dwordx4 v16, s[8:11], s41 offen offset:0 nt lds
    s_add_u32 s41, s58, 277504
    buffer_load_dwordx4 v16, s[8:11], s41 offen offset:1024 nt lds
    s_add_u32 s41, s58, 391168
    buffer_load_dwordx4 v16, s[8:11], s41 offen offset:2048 nt lds
    s_add_u32 s41, s58, 406528
    buffer_load_dwordx4 v16, s[8:11], s41 offen offset:3072 nt lds
    v_add_u32 v28, 36864, v24
    v_add_u32 v29, 36864, v25
    v_add_u32 v30, 36864, v26
    v_add_u32 v31, 36864, v27
    ds_read_b64_tr_b16 a[22:23], v28 offset:0
    ds_read_b64_tr_b16 a[30:31], v28 offset:8
    ds_read_b64_tr_b16 a[38:39], v29 offset:0
    ds_read_b64_tr_b16 a[46:47], v29 offset:8
    ds_read_b64_tr_b16 a[54:55], v30 offset:0
    ds_read_b64_tr_b16 a[62:63], v30 offset:8
    ds_read_b64_tr_b16 a[70:71], v31 offset:0
    ds_read_b64_tr_b16 a[78:79], v31 offset:8
    s_waitcnt vmcnt(12) lgkmcnt(0)
    s_barrier
    s_add_u32 m0, s43, 36864
    s_add_u32 s41, s58, 270336
    buffer_load_dwordx4 v16, s[8:11], s41 offen offset:0 nt lds
    s_add_u32 s41, s58, 285696
    buffer_load_dwordx4 v16, s[8:11], s41 offen offset:1024 nt lds
    s_add_u32 s41, s58, 399360
    buffer_load_dwordx4 v16, s[8:11], s41 offen offset:2048 nt lds
    s_add_u32 s41, s58, 414720
    buffer_load_dwordx4 v16, s[8:11], s41 offen offset:3072 nt lds
    s_lshl_b32 s26, s12, 14
    s_add_u32 s26, s26, 0
    s_mul_i32 s40, s13, 3072
    s_add_u32 s24, s26, s40
    s_lshl_b32 s96, s12, 7
    s_add_u32 s29, s96, 125845504
    s_add_u32 s96, s96, 125829120
    v_bfe_u32 v78, v65, 2, 5
    buffer_load_dword v54, off, s[84:87], 0 offset:132 sc1
    buffer_load_dword v55, off, s[84:87], 0 offset:216 sc1
    buffer_load_dword v56, v78, s[4:7], s96 offen offset:16 sc1
    v_add_u32 v77, 73728, v20
    ds_read_b64_tr_b16 a[80:81], v77 offset:0
    ds_read_b64_tr_b16 a[82:83], v77 offset:4096
    ds_read_b64_tr_b16 a[84:85], v77 offset:8192
    ds_read_b64_tr_b16 a[86:87], v77 offset:12288
    ds_read_b64_tr_b16 a[88:89], v77 offset:8
    ds_read_b64_tr_b16 a[90:91], v77 offset:4104
    ds_read_b64_tr_b16 a[92:93], v77 offset:8200
    ds_read_b64_tr_b16 a[94:95], v77 offset:12296
    s_waitcnt vmcnt(12) lgkmcnt(0)
    s_barrier
    s_add_u32 m0, s43, 73728
    s_add_u32 s41, s58, 524288
    buffer_load_dwordx4 v16, s[8:11], s41 offen offset:0 nt lds
    s_add_u32 s41, s58, 539648
    buffer_load_dwordx4 v16, s[8:11], s41 offen offset:1024 nt lds
    s_add_u32 s41, s58, 653312
    buffer_load_dwordx4 v16, s[8:11], s41 offen offset:2048 nt lds
    s_add_u32 s41, s58, 668672
    buffer_load_dwordx4 v16, s[8:11], s41 offen offset:3072 nt lds
    v_add_u32 v28, 110592, v24
    v_add_u32 v29, 110592, v25
    v_add_u32 v30, 110592, v26
    v_add_u32 v31, 110592, v27
    ds_read_b64_tr_b16 a[216:217], v28 offset:0
    ds_read_b64_tr_b16 v[32:33], v28 offset:8
    ds_read_b64_tr_b16 a[224:225], v29 offset:0
    ds_read_b64_tr_b16 a[232:233], v29 offset:8
    ds_read_b64_tr_b16 a[240:241], v30 offset:0
    ds_read_b64_tr_b16 a[248:249], v30 offset:8
    ds_read_b64_tr_b16 v[160:161], v31 offset:0
    ds_read_b64_tr_b16 v[168:169], v31 offset:8
    s_waitcnt vmcnt(12) lgkmcnt(0)
    s_barrier
    s_add_u32 m0, s43, 110592
    s_add_u32 s41, s58, 532480
    buffer_load_dwordx4 v16, s[8:11], s41 offen offset:0 nt lds
    s_add_u32 s41, s58, 547840
    buffer_load_dwordx4 v16, s[8:11], s41 offen offset:1024 nt lds
    s_add_u32 s41, s58, 661504
    buffer_load_dwordx4 v16, s[8:11], s41 offen offset:2048 nt lds
    s_add_u32 s41, s58, 676864
    buffer_load_dwordx4 v16, s[8:11], s41 offen offset:3072 nt lds
    ds_write_b64 v70, v[32:33] offset:8192
    v_add_u32 v28, 147456, v24
    v_add_u32 v29, 147456, v25
    v_add_u32 v30, 147456, v26
    v_add_u32 v31, 147456, v27
    ds_read_b64_tr_b16 a[218:219], v28 offset:0
    ds_read_b64_tr_b16 v[0:1], v28 offset:8
    ds_read_b64_tr_b16 a[226:227], v29 offset:0
    ds_read_b64_tr_b16 a[234:235], v29 offset:8
    ds_read_b64_tr_b16 a[242:243], v30 offset:0
    ds_read_b64_tr_b16 a[250:251], v30 offset:8
    ds_read_b64_tr_b16 v[162:163], v31 offset:0
    ds_read_b64_tr_b16 v[170:171], v31 offset:8
    s_waitcnt vmcnt(12) lgkmcnt(0)
    s_barrier
    s_add_u32 m0, s43, 147456
    s_add_u32 s41, s58, 786432
    buffer_load_dwordx4 v16, s[8:11], s41 offen offset:0 nt lds
    s_add_u32 s41, s58, 801792
    buffer_load_dwordx4 v16, s[8:11], s41 offen offset:1024 nt lds
    s_add_u32 s41, s58, 915456
    buffer_load_dwordx4 v16, s[8:11], s41 offen offset:2048 nt lds
    s_add_u32 s41, s58, 930816
    buffer_load_dwordx4 v16, s[8:11], s41 offen offset:3072 nt lds
    ds_write_b64 v70, v[0:1] offset:8200
    v_add_u32 v28, 0, v24
    v_add_u32 v29, 0, v25
    v_add_u32 v30, 0, v26
    v_add_u32 v31, 0, v27
    ds_read_b64_tr_b16 a[220:221], v28 offset:0
    ds_read_b64_tr_b16 v[32:33], v28 offset:8
    ds_read_b64_tr_b16 a[228:229], v29 offset:0
    ds_read_b64_tr_b16 a[236:237], v29 offset:8
    ds_read_b64_tr_b16 a[244:245], v30 offset:0
    ds_read_b64_tr_b16 a[252:253], v30 offset:8
    ds_read_b64_tr_b16 v[164:165], v31 offset:0
    ds_read_b64_tr_b16 v[172:173], v31 offset:8
    s_waitcnt vmcnt(12) lgkmcnt(0)
    s_barrier
    s_add_u32 m0, s43, 0
    s_add_u32 s41, s58, 794624
    buffer_load_dwordx4 v16, s[8:11], s41 offen offset:0 nt lds
    s_add_u32 s41, s58, 809984
    buffer_load_dwordx4 v16, s[8:11], s41 offen offset:1024 nt lds
    s_add_u32 s41, s58, 923648
    buffer_load_dwordx4 v16, s[8:11], s41 offen offset:2048 nt lds
    s_add_u32 s41, s58, 939008
    buffer_load_dwordx4 v16, s[8:11], s41 offen offset:3072 nt lds
    ds_write_b64 v70, v[32:33] offset:9216
    v_add_u32 v28, 36864, v24
    v_add_u32 v29, 36864, v25
    v_add_u32 v30, 36864, v26
    v_add_u32 v31, 36864, v27
    ds_read_b64_tr_b16 a[222:223], v28 offset:0
    ds_read_b64_tr_b16 v[0:1], v28 offset:8
    ds_read_b64_tr_b16 a[230:231], v29 offset:0
    ds_read_b64_tr_b16 a[238:239], v29 offset:8
    ds_read_b64_tr_b16 a[246:247], v30 offset:0
    ds_read_b64_tr_b16 a[254:255], v30 offset:8
    ds_read_b64_tr_b16 v[166:167], v31 offset:0
    ds_read_b64_tr_b16 v[174:175], v31 offset:8
    s_waitcnt vmcnt(12) lgkmcnt(0)
    s_barrier
    s_add_u32 m0, s43, 36864
    s_add_u32 s41, s59, 0
    buffer_load_dwordx4 v17, s[8:11], s41 offen offset:0 nt lds
    s_add_u32 s41, s59, 31744
    buffer_load_dwordx4 v17, s[8:11], s41 offen offset:1024 nt lds
    s_add_u32 s41, s59, 129024
    buffer_load_dwordx4 v17, s[8:11], s41 offen offset:2048 nt lds
    s_add_u32 s41, s59, 160768
    buffer_load_dwordx4 v17, s[8:11], s41 offen offset:3072 nt lds
    v_readfirstlane_b32 s94, v54
    v_readfirstlane_b32 s95, v55
    v_mov_b32 v77, v56
    s_nop 0
    v_subrev_u32 v77, s95, v77
    v_cmp_lt_u32 vcc, 16, v77
    s_nop 1
    v_cndmask_b32 v77, v77, 0, vcc
    v_bfe_u32 v79, v78, 2, 2
    v_lshl_add_u32 v77, v77, 2, v79
    s_nop 1
    v_min_u32_dpp v77, v77, v77 row_ror:1 row_mask:0xf bank_mask:0xf
    s_nop 1
    v_min_u32_dpp v77, v77, v77 row_ror:2 row_mask:0xf bank_mask:0xf
    s_nop 1
    v_min_u32_dpp v77, v77, v77 row_ror:4 row_mask:0xf bank_mask:0xf
    s_nop 0
    v_readfirstlane_b32 s97, v77
    s_cmp_eq_u32 s95, 0
    s_cselect_b32 s97, 0, s97
    s_cmp_lt_u32 s97, 3
    s_cbranch_scc1 cf_mb
    s_add_u32 s40, s26, 0
    v_lshlrev_b32 v78, 2, v65
    buffer_load_dword v58, v78, s[4:7], s40 offen sc1
    s_add_u32 s40, s26, 524288
    v_lshlrev_b32 v78, 2, v65
    buffer_load_dword v58, v78, s[4:7], s40 offen sc1
cf_mb:
    s_cmp_lt_u32 s94, 32
    s_cbranch_scc1 cf_mc
    s_cmp_lg_u32 s13, 0
    s_cbranch_scc1 cf_mc
    v_mov_b32 v76, 1
    v_mov_b32 v77, 0
    s_mov_b64 exec, 1
    buffer_atomic_cmpswap v[76:77], off, s[84:87], 0 offset:28 sc0
    s_mov_b64 exec, -1
cf_mc:
    s_nop 1
    ds_write_b64 v70, v[0:1] offset:9224
    v_add_u32 v28, 73728, v24
    v_add_u32 v29, 73728, v25
    v_add_u32 v30, 73728, v26
    v_add_u32 v31, 73728, v27
    ds_read_b64_tr_b16 v[176:177], v28 offset:0
    ds_read_b64_tr_b16 v[184:185], v28 offset:8
    ds_read_b64_tr_b16 v[192:193], v29 offset:0
    ds_read_b64_tr_b16 v[200:201], v29 offset:8
    ds_read_b64_tr_b16 v[208:209], v30 offset:0
    ds_read_b64_tr_b16 v[216:217], v30 offset:8
    ds_read_b64_tr_b16 v[224:225], v31 offset:0
    ds_read_b64_tr_b16 v[232:233], v31 offset:8
    s_waitcnt vmcnt(12) lgkmcnt(0)
    s_barrier
    s_mov_b64 s[8:9], s[56:57]
    s_add_u32 m0, s43, 73728
    s_add_u32 s41, s60, 128
    buffer_load_dwordx4 v18, s[8:11], s41 offen offset:0 nt lds
    s_add_u32 s41, s60, 8320
    buffer_load_dwordx4 v18, s[8:11], s41 offen offset:1024 nt lds
    s_add_u32 s41, s60, 16512
    buffer_load_dwordx4 v18, s[8:11], s41 offen offset:2048 nt lds
    s_add_u32 s41, s60, 24704
    buffer_load_dwordx4 v18, s[8:11], s41 offen offset:3072 nt lds
    v_add_u32 v28, 110592, v24
    v_add_u32 v29, 110592, v25
    v_add_u32 v30, 110592, v26
    v_add_u32 v31, 110592, v27
    ds_read_b64_tr_b16 v[178:179], v28 offset:0
    ds_read_b64_tr_b16 v[186:187], v28 offset:8
    ds_read_b64_tr_b16 v[194:195], v29 offset:0
    ds_read_b64_tr_b16 v[202:203], v29 offset:8
    ds_read_b64_tr_b16 v[210:211], v30 offset:0
    ds_read_b64_tr_b16 v[218:219], v30 offset:8
    ds_read_b64_tr_b16 v[226:227], v31 offset:0
    ds_read_b64_tr_b16 v[234:235], v31 offset:8
    s_waitcnt vmcnt(12) lgkmcnt(0)
    s_barrier
    s_add_u32 m0, s43, 110592
    s_add_u32 s41, s61, 128
    buffer_load_dwordx4 v18, s[8:11], s41 offen offset:0 nt lds
    s_add_u32 s41, s61, 8320
    buffer_load_dwordx4 v18, s[8:11], s41 offen offset:1024 nt lds
    s_add_u32 s41, s61, 16512
    buffer_load_dwordx4 v18, s[8:11], s41 offen offset:2048 nt lds
    s_add_u32 s41, s61, 24704
    buffer_load_dwordx4 v18, s[8:11], s41 offen offset:3072 nt lds
    v_add_u32 v28, 147456, v24
    v_add_u32 v29, 147456, v25
    v_add_u32 v30, 147456, v26
    v_add_u32 v31, 147456, v27
    ds_read_b64_tr_b16 v[180:181], v28 offset:0
    ds_read_b64_tr_b16 v[188:189], v28 offset:8
    ds_read_b64_tr_b16 v[196:197], v29 offset:0
    ds_read_b64_tr_b16 v[204:205], v29 offset:8
    ds_read_b64_tr_b16 v[212:213], v30 offset:0
    ds_read_b64_tr_b16 v[220:221], v30 offset:8
    ds_read_b64_tr_b16 v[228:229], v31 offset:0
    ds_read_b64_tr_b16 v[236:237], v31 offset:8
    s_waitcnt vmcnt(12) lgkmcnt(0)
    s_barrier
    s_add_u32 m0, s43, 147456
    s_add_u32 s41, s62, 128
    buffer_load_dwordx4 v18, s[8:11], s41 offen offset:0 nt lds
    s_add_u32 s41, s62, 8320
    buffer_load_dwordx4 v18, s[8:11], s41 offen offset:1024 nt lds
    s_add_u32 s41, s62, 16512
    buffer_load_dwordx4 v18, s[8:11], s41 offen offset:2048 nt lds
    s_add_u32 s41, s62, 24704
    buffer_load_dwordx4 v18, s[8:11], s41 offen offset:3072 nt lds
    v_add_u32 v28, 0, v24
    v_add_u32 v29, 0, v25
    v_add_u32 v30, 0, v26
    v_add_u32 v31, 0, v27
    ds_read_b64_tr_b16 v[182:183], v28 offset:0
    ds_read_b64_tr_b16 v[190:191], v28 offset:8
    ds_read_b64_tr_b16 v[198:199], v29 offset:0
    ds_read_b64_tr_b16 v[206:207], v29 offset:8
    ds_read_b64_tr_b16 v[214:215], v30 offset:0
    ds_read_b64_tr_b16 v[222:223], v30 offset:8
    ds_read_b64_tr_b16 v[230:231], v31 offset:0
    ds_read_b64_tr_b16 v[238:239], v31 offset:8
    s_waitcnt vmcnt(12) lgkmcnt(0)
    s_barrier
    s_add_u32 m0, s43, 0
    s_add_u32 s41, s63, 128
    buffer_load_dwordx4 v18, s[8:11], s41 offen offset:0 nt lds
    s_add_u32 s41, s63, 8320
    buffer_load_dwordx4 v18, s[8:11], s41 offen offset:1024 nt lds
    s_add_u32 s41, s63, 16512
    buffer_load_dwordx4 v18, s[8:11], s41 offen offset:2048 nt lds
    s_add_u32 s41, s63, 24704
    buffer_load_dwordx4 v18, s[8:11], s41 offen offset:3072 nt lds
    v_mov_b32 v78, v21
    v_mov_b32 v79, v22
    v_add_u32 v77, 36864, v20
    ds_read_b64_tr_b16 v[240:241], v77 offset:0
    ds_read_b64_tr_b16 v[242:243], v77 offset:4096
    ds_read_b64_tr_b16 v[244:245], v77 offset:8192
    ds_read_b64_tr_b16 v[246:247], v77 offset:12288
    ds_read_b64_tr_b16 v[248:249], v77 offset:8
    ds_read_b64_tr_b16 v[250:251], v77 offset:4104
    ds_read_b64_tr_b16 v[252:253], v77 offset:8200
    ds_read_b64_tr_b16 v[254:255], v77 offset:12296
    s_waitcnt vmcnt(12) lgkmcnt(0)
    s_barrier
    v_add_u32 v77, 73728, v79
    s_waitcnt lgkmcnt(0)
    ds_read_b64_tr_b16 v[0:1], v77 offset:0
    ds_read_b64_tr_b16 v[2:3], v77 offset:256
    ds_read_b64_tr_b16 v[4:5], v77 offset:2048
    ds_read_b64_tr_b16 v[6:7], v77 offset:2304
    ds_read_b64_tr_b16 v[8:9], v77 offset:8
    ds_read_b64_tr_b16 v[10:11], v77 offset:264
    ds_read_b64_tr_b16 v[12:13], v77 offset:2056
    ds_read_b64_tr_b16 v[14:15], v77 offset:2312
    s_waitcnt vmcnt(8) lgkmcnt(0)
    s_barrier
    v_add_u32 v77, 110592, v78
    ds_read_b64_tr_b16 v[16:17], v77 offset:0
    ds_read_b64_tr_b16 v[18:19], v77 offset:256
    ds_read_b64_tr_b16 v[20:21], v77 offset:2048
    ds_read_b64_tr_b16 v[22:23], v77 offset:2304
    ds_read_b64_tr_b16 v[24:25], v77 offset:8
    ds_read_b64_tr_b16 v[26:27], v77 offset:264
    ds_read_b64_tr_b16 v[28:29], v77 offset:2056
    ds_read_b64_tr_b16 v[30:31], v77 offset:2312
    s_waitcnt vmcnt(4) lgkmcnt(0)
    s_barrier
    v_add_u32 v77, 147456, v78
    ds_read_b64_tr_b16 v[32:33], v77 offset:0
    ds_read_b64_tr_b16 v[34:35], v77 offset:256
    ds_read_b64_tr_b16 v[36:37], v77 offset:2048
    ds_read_b64_tr_b16 v[38:39], v77 offset:2304
    ds_read_b64_tr_b16 v[40:41], v77 offset:8
    ds_read_b64_tr_b16 v[42:43], v77 offset:264
    ds_read_b64_tr_b16 v[44:45], v77 offset:2056
    ds_read_b64_tr_b16 v[46:47], v77 offset:2312
    s_waitcnt vmcnt(0) lgkmcnt(0)
    s_barrier
    v_add_u32 v77, 0, v78
    ds_read_b64_tr_b16 v[48:49], v77 offset:0
    ds_read_b64_tr_b16 v[50:51], v77 offset:256
    ds_read_b64_tr_b16 v[52:53], v77 offset:2048
    ds_read_b64_tr_b16 v[54:55], v77 offset:2304
    ds_read_b64_tr_b16 v[56:57], v77 offset:8
    ds_read_b64_tr_b16 v[58:59], v77 offset:264
    ds_read_b64_tr_b16 v[60:61], v77 offset:2056
    ds_read_b64_tr_b16 v[62:63], v77 offset:2312
    s_waitcnt lgkmcnt(0)
    s_barrier
    ds_write_b128 v70, v[0:3] offset:20480
    ds_write_b128 v70, v[4:7] offset:21504
    ds_write_b128 v70, v[8:11] offset:22528
    ds_write_b128 v70, v[12:15] offset:23552
    ds_write_b128 v70, v[16:19] offset:24576
    ds_write_b128 v70, v[20:23] offset:25600
    ds_write_b128 v70, v[24:27] offset:26624
    ds_write_b128 v70, v[28:31] offset:27648
    ds_write_b128 v70, v[32:35] offset:28672
    ds_write_b128 v70, v[36:39] offset:29696
    ds_write_b128 v70, v[40:43] offset:30720
    ds_write_b128 v70, v[44:47] offset:31744
    ds_write_b128 v70, v[48:51] offset:32768
    ds_write_b128 v70, v[52:55] offset:33792
    ds_write_b128 v70, v[56:59] offset:34816
    ds_write_b128 v70, v[60:63] offset:35840
    s_waitcnt lgkmcnt(0)
    v_bfe_u32 v60, v65, 4, 6
    v_and_b32 v61, 15, v60
    v_lshrrev_b32 v62, 4, v60
    v_mov_b32 v50, 0x3f80
    v_mov_b32 v51, 0x3f800000
    v_and_b32 v77, 1, v62
    v_lshlrev_b32 v77, 2, v77
    v_sub_u32 v77, v61, v77
    v_and_b32 v78, 3, v61
    v_lshlrev_b32 v78, 2, v78
    v_lshrrev_b32 v79, 2, v61
    v_add_u32 v78, v78, v79
    v_cmp_eq_u32 vcc, 0, v77
    s_nop 1
    v_cndmask_b32 v8, 0, v50, vcc
    v_cmp_eq_u32 vcc, 1, v77
    s_nop 1
    v_cndmask_b32 v8, v8, v51, vcc
    v_cmp_eq_u32 vcc, 0, v78
    s_nop 1
    v_cndmask_b32 v12, 0, v50, vcc
    v_cmp_eq_u32 vcc, 1, v78
    s_nop 1
    v_cndmask_b32 v12, v12, v51, vcc
    v_cmp_eq_u32 vcc, 2, v77
    s_nop 1
    v_cndmask_b32 v9, 0, v50, vcc
    v_cmp_eq_u32 vcc, 3, v77
    s_nop 1
    v_cndmask_b32 v9, v9, v51, vcc
    v_cmp_eq_u32 vcc, 2, v78
    s_nop 1
    v_cndmask_b32 v13, 0, v50, vcc
    v_cmp_eq_u32 vcc, 3, v78
    s_nop 1
    v_cndmask_b32 v13, v13, v51, vcc
    v_cmp_eq_u32 vcc, 8, v77
    s_nop 1
    v_cndmask_b32 v10, 0, v50, vcc
    v_cmp_eq_u32 vcc, 9, v77
    s_nop 1
    v_cndmask_b32 v10, v10, v51, vcc
    v_cmp_eq_u32 vcc, 4, v78
    s_nop 1
    v_cndmask_b32 v14, 0, v50, vcc
    v_cmp_eq_u32 vcc, 5, v78
    s_nop 1
    v_cndmask_b32 v14, v14, v51, vcc
    v_cmp_eq_u32 vcc, 10, v77
    s_nop 1
    v_cndmask_b32 v11, 0, v50, vcc
    v_cmp_eq_u32 vcc, 11, v77
    s_nop 1
    v_cndmask_b32 v11, v11, v51, vcc
    v_cmp_eq_u32 vcc, 6, v78
    s_nop 1
    v_cndmask_b32 v15, 0, v50, vcc
    v_cmp_eq_u32 vcc, 7, v78
    s_nop 1
    v_cndmask_b32 v15, v15, v51, vcc
    v_lshlrev_b32 v77, 4, v61
    ds_write_b128 v69, v[8:11] offset:15360
    ds_write_b128 v77, v[12:15] offset:15872
    s_waitcnt vmcnt(0) lgkmcnt(0)
    s_cmp_lg_u32 s95, 0
    s_cbranch_scc1 cf_hn
    s_mov_b32 s88, 4194304
gn36:
    buffer_load_dword v2, off, s[84:87], 0 offset:216 sc1
    s_waitcnt vmcnt(0)
    v_readfirstlane_b32 s95, v2
    s_sub_u32 s88, s88, 1
    s_cbranch_scc1 gn36x
    s_cmp_eq_u32 s95, 0
    s_cbranch_scc1 gn36
gn36x:
cf_hn:
    v_mov_b32 v2, 1
    s_cmp_lg_u32 s13, 0
    s_cbranch_scc1 cf_noarr
    s_mov_b64 exec, 1
    s_mov_b32 s42, 1
    v_mov_b32 v4, v76
    s_cmp_ge_u32 s94, 32
    s_cbranch_scc1 cf_have
    s_mov_b32 s40, 131072
    s_mov_b32 s42, 2
cf_startpoll:
    buffer_load_dword v3, off, s[84:87], 0 offset:132 sc1
    s_sub_u32 s40, s40, 1
    s_cbranch_scc1 cf_decide
    s_waitcnt vmcnt(0)
    v_readfirstlane_b32 s41, v3
    s_nop 1
    s_cmp_lt_u32 s41, 32
    s_cbranch_scc1 cf_startpoll
    s_mov_b32 s42, 1
cf_decide:
    v_mov_b32 v4, s42
    v_mov_b32 v5, 0
    buffer_atomic_cmpswap v[4:5], off, s[84:87], 0 offset:28 sc0
    s_waitcnt vmcnt(0)
cf_have:
    v_mov_b32 v5, s42
    v_cmp_eq_u32 vcc, 0, v4
    s_nop 1
    v_cndmask_b32 v4, v4, v5, vcc
    v_mov_b32 v5, 16192
    ds_write_b32 v5, v4
    s_waitcnt lgkmcnt(0)
    s_mov_b64 exec, -1
cf_noarr:
    s_barrier
    v_mov_b32 v5, 16192
    ds_read_b32 v4, v5
    s_waitcnt lgkmcnt(0)
    v_readfirstlane_b32 s41, v4
    s_nop 1
    s_cmp_eq_u32 s41, 1
    s_cbranch_scc1 cf_run
    v_lshrrev_b32 v0, 4, v65
    s_mov_b32 s32, s13
    s_load_dwordx16 s[48:63], s[0:1], 0
    s_waitcnt lgkmcnt(0)
    s_branch L_helper
cf_run:
    s_mov_b32 m0, 16128
    s_mov_b32 s44, 0x3e0293ee
    s_mov_b32 s45, s44
    s_or_b32 s66, s44, 0x80000000
    s_mov_b32 s48, 0x3f003f00
    s_mov_b32 s49, 0
    s_mov_b32 s50, 0x3f803f80
    s_mov_b32 s51, 0x3f803f80
    s_mov_b32 s52, 512
    s_mov_b32 s53, 1024
    s_mov_b32 s54, 1536
    s_mov_b32 s30, 0
    s_lshl_b32 s47, s13, 9
    s_cmp_lg_u32 s32, 0
    s_cselect_b32 s71, s13, 3
    s_add_u32 s46, s71, 1
    s_lshr_b32 s46, s46, 1
    s_mov_b32 s14, 67125248
    s_mov_b32 s15, 67129344
    s_mov_b32 s16, 67133440
    s_mov_b32 s36, 0
    s_add_u32 s17, s68, 67108864
    s_mov_b32 s69, 0
    s_mov_b32 s70, 0
    s_lshl_b32 s26, s12, 14
    s_add_u32 s26, s26, 0
    s_mul_i32 s40, s13, 3072
    s_add_u32 s24, s26, s40
    s_lshl_b32 s96, s12, 7
    s_add_u32 s29, s96, 125845504
    s_add_u32 s96, s96, 125829120
    s_lshl_b32 s40, s12, 14
    s_add_u32 s40, s40, 68157440
    s_add_u32 s18, s40, 0
    s_add_u32 s19, s40, 4096
    s_add_u32 s20, s40, 8192
    s_add_u32 s21, s40, 12288
    s_lshr_b32 s40, s12, 3
    s_lshl_b32 s40, s40, 12
    s_and_b32 s41, s12, 7
    s_lshl_b32 s41, s41, 7
    s_add_u32 s40, s40, s41
    s_add_u32 s22, s40, 68157440
    s_add_u32 s23, s22, 1024
    s_add_u32 s25, s22, 2048
    s_mov_b32 s56, -65528
    s_cmp_lg_u32 s32, 0
    s_cselect_b64 s[38:39], -1, 0
    s_add_u32 s55, s68, 138412032
    s_cmp_eq_u32 s13, 3
    s_cselect_b64 s[100:101], 1, 0
    s_cselect_b64 s[38:39], 1, s[38:39]
    s_cselect_b32 s93, 64, 0
    s_cselect_b32 s55, s29, s55
    s_cselect_b32 s57, 0, 9216
    s_mov_b64 exec, s[100:101]
    v_mov_b32 v72, s95
    s_mov_b64 exec, -1
    s_mov_b32 s34, 0xff00ff00
    s_mov_b32 s35, 0xff00ff00
    s_lshl_b32 s28, s12, 12
    s_add_u32 s28, s28, 7602176
    s_add_u32 s27, s28, 77594624
    s_add_u32 s28, s28, 69206016
    s_mov_b32 s37, s93
    s_cmp_ge_u32 s97, 3
    s_cbranch_scc1 cf_kvdone
    s_mov_b32 s40, 3
    v_bfe_u32 v78, v65, 2, 5
    s_mov_b32 s31, 4194304
cf_kv0:
    buffer_load_dword v77, v78, s[4:7], s96 offen offset:16 sc1
    s_waitcnt vmcnt(0)
    v_subrev_u32 v77, s95, v77
    v_cmp_lt_u32 vcc, 16, v77
    s_nop 1
    v_cndmask_b32 v77, v77, 0, vcc
    v_bfe_u32 v79, v78, 2, 2
    v_lshl_add_u32 v77, v77, 2, v79
    s_nop 1
    v_min_u32_dpp v77, v77, v77 row_ror:1 row_mask:0xf bank_mask:0xf
    s_nop 1
    v_min_u32_dpp v77, v77, v77 row_ror:2 row_mask:0xf bank_mask:0xf
    s_nop 1
    v_min_u32_dpp v77, v77, v77 row_ror:4 row_mask:0xf bank_mask:0xf
    s_nop 0
    v_readfirstlane_b32 s97, v77
    s_sub_u32 s31, s31, 1
    s_cbranch_scc1 cf_kv0_x
    s_cmp_le_u32 s40, s97
    s_cbranch_scc1 cf_kv0_x
    s_sleep 2
    s_branch cf_kv0
cf_kv0_x:
    s_add_u32 s40, s26, 0
    v_lshlrev_b32 v78, 2, v65
    buffer_load_dword v76, v78, s[4:7], s40 offen sc1
    s_add_u32 s40, s26, 524288
    v_lshlrev_b32 v78, 2, v65
    buffer_load_dword v76, v78, s[4:7], s40 offen sc1
cf_kvdone:
    v_mov_b64 v[0:1], 0
    v_mov_b64 v[2:3], 0
    v_mov_b64 v[4:5], 0
    v_mov_b64 v[6:7], 0
    v_mov_b64 v[8:9], 0
    v_mov_b64 v[10:11], 0
    v_mov_b64 v[12:13], 0
    v_mov_b64 v[14:15], 0
    v_mov_b64 v[16:17], 0
    v_mov_b64 v[18:19], 0
    v_mov_b64 v[20:21], 0
    v_mov_b64 v[22:23], 0
    ds_read_b128 v[40:43], v70 offset:0
    ds_read_b128 v[44:47], v70 offset:1024
    ds_read_b128 v[48:51], v70 offset:2048
    ds_read_b128 v[52:55], v70 offset:3072
    ds_read_b128 v[24:27], v70 offset:4096
    ds_read_b128 v[28:31], v70 offset:5120
    ds_read_b128 v[32:35], v70 offset:6144
    ds_read_b128 v[36:39], v70 offset:7168
    buffer_load_dwordx4 v[60:63], v65, s[4:7], s14 offen offset:0 nt
    buffer_load_dwordx4 v[56:59], v66, s[4:7], s14 offen offset:0 nt
    s_mov_b32 s31, 1048576
    s_waitcnt vmcnt(0) lgkmcnt(0)
    s_branch cf_goA
cf_loop:
    s_add_u32 s40, s30, 3
    s_min_u32 s40, s40, 64
    s_cmp_le_u32 s40, s97
    s_cbranch_scc0 cf_kvwait
cf_kvok:
    s_mov_b32 s31, 1048576
    s_mov_b32 s69, s70
    s_waitcnt lgkmcnt(0)
cf_cA:
    buffer_load_dwordx4 v[60:63], v65, s[4:7], s14 offen offset:0 nt
    buffer_load_dwordx4 v[56:59], v66, s[4:7], s14 offen offset:0 nt
cf_cA1:
    v_bitop3_b32 v77, v60, v56, s70 bitop3:0x7e
    v_and_b32 v77, 1, v77
    v_cmp_ne_u32 vcc, 0, v77
    s_cbranch_vccz cf_goA
    v_bitop3_b32 v77, v60, v56, s70 bitop3:0x7e
    v_and_b32 v77, 1, v77
    v_cmp_ne_u32 vcc, 0, v77
    s_cbranch_vccz cf_goA
    v_bitop3_b32 v77, v60, v56, s70 bitop3:0x7e
    v_and_b32 v77, 1, v77
    v_cmp_ne_u32 vcc, 0, v77
    s_cbranch_vccz cf_goA
    v_bitop3_b32 v77, v60, v56, s70 bitop3:0x7e
    v_and_b32 v77, 1, v77
    v_cmp_ne_u32 vcc, 0, v77
    s_cbranch_vccz cf_goA
    v_bitop3_b32 v77, v60, v56, s70 bitop3:0x7e
    v_and_b32 v77, 1, v77
    v_cmp_ne_u32 vcc, 0, v77
    s_cbranch_vccz cf_goA
    buffer_load_dwordx4 v[60:63], v65, s[4:7], s14 offen offset:0 nt
    buffer_load_dwordx4 v[56:59], v66, s[4:7], s14 offen offset:0 nt
    v_bitop3_b32 v77, v60, v56, s70 bitop3:0x7e
    v_and_b32 v77, 1, v77
    v_cmp_ne_u32 vcc, 0, v77
    s_cbranch_vccz cf_goA
    v_bitop3_b32 v77, v60, v56, s70 bitop3:0x7e
    v_and_b32 v77, 1, v77
    v_cmp_ne_u32 vcc, 0, v77
    s_cbranch_vccz cf_goA
    v_bitop3_b32 v77, v60, v56, s70 bitop3:0x7e
    v_and_b32 v77, 1, v77
    v_cmp_ne_u32 vcc, 0, v77
    s_cbranch_vccz cf_goA
    v_bitop3_b32 v77, v60, v56, s70 bitop3:0x7e
    v_and_b32 v77, 1, v77
    v_cmp_ne_u32 vcc, 0, v77
    s_cbranch_vccz cf_goA
    v_bitop3_b32 v77, v60, v56, s70 bitop3:0x7e
    v_and_b32 v77, 1, v77
    v_cmp_ne_u32 vcc, 0, v77
    s_cbranch_vccz cf_goA
    buffer_load_dwordx4 v[60:63], v65, s[4:7], s14 offen offset:0 nt
    buffer_load_dwordx4 v[56:59], v66, s[4:7], s14 offen offset:0 nt
    v_bitop3_b32 v77, v60, v56, s70 bitop3:0x7e
    v_and_b32 v77, 1, v77
    v_cmp_ne_u32 vcc, 0, v77
    s_cbranch_vccz cf_goA
    v_bitop3_b32 v77, v60, v56, s70 bitop3:0x7e
    v_and_b32 v77, 1, v77
    v_cmp_ne_u32 vcc, 0, v77
    s_cbranch_vccz cf_goA
    v_bitop3_b32 v77, v60, v56, s70 bitop3:0x7e
    v_and_b32 v77, 1, v77
    v_cmp_ne_u32 vcc, 0, v77
    s_cbranch_vccz cf_goA
    v_bitop3_b32 v77, v60, v56, s70 bitop3:0x7e
    v_and_b32 v77, 1, v77
    v_cmp_ne_u32 vcc, 0, v77
    s_cbranch_vccz cf_goA
    v_bitop3_b32 v77, v60, v56, s70 bitop3:0x7e
    v_and_b32 v77, 1, v77
    v_cmp_ne_u32 vcc, 0, v77
    s_cbranch_vccz cf_goA
    buffer_load_dwordx4 v[60:63], v65, s[4:7], s14 offen offset:0 nt
    buffer_load_dwordx4 v[56:59], v66, s[4:7], s14 offen offset:0 nt
    v_bitop3_b32 v77, v60, v56, s70 bitop3:0x7e
    v_and_b32 v77, 1, v77
    v_cmp_ne_u32 vcc, 0, v77
    s_cbranch_vccz cf_goA
    v_bitop3_b32 v77, v60, v56, s70 bitop3:0x7e
    v_and_b32 v77, 1, v77
    v_cmp_ne_u32 vcc, 0, v77
    s_cbranch_vccz cf_goA
    v_bitop3_b32 v77, v60, v56, s70 bitop3:0x7e
    v_and_b32 v77, 1, v77
    v_cmp_ne_u32 vcc, 0, v77
    s_cbranch_vccz cf_goA
    v_bitop3_b32 v77, v60, v56, s70 bitop3:0x7e
    v_and_b32 v77, 1, v77
    v_cmp_ne_u32 vcc, 0, v77
    s_cbranch_vccz cf_goA
    v_bitop3_b32 v77, v60, v56, s70 bitop3:0x7e
    v_and_b32 v77, 1, v77
    v_cmp_ne_u32 vcc, 0, v77
    s_cbranch_vccz cf_goA
    s_sub_u32 s31, s31, 64
    s_cbranch_scc0 cf_cA
cf_goA:
    ds_write_b128 v65, v[60:63] offset:0
    v_smfmac_f32_16x16x64_bf16 v[0:3], v[60:63], v[40:47], v64
    v_smfmac_f32_16x16x64_bf16 v[4:7], v[60:63], v[48:55], v64
    buffer_load_dwordx4 v[40:43], v65, s[4:7], s15 offen offset:0 nt
    v_smfmac_f32_16x16x64_bf16 v[0:3], v[56:59], v[24:31], v64
    v_smfmac_f32_16x16x64_bf16 v[4:7], v[56:59], v[32:39], v64
    ds_read_b128 v[24:27], v70 offset:8192
    v_smfmac_f32_16x16x64_bf16 v[8:11], v[60:63], a[96:103], v64
    ds_read_b128 v[28:31], v70 offset:9216
    v_smfmac_f32_16x16x64_bf16 v[12:15], v[60:63], a[104:111], v64
    ds_read_b128 v[32:35], v70 offset:10240
    s_waitcnt lgkmcnt(3)
    s_barrier
    ds_read_b128 v[48:51], v67 offset:0
    v_smfmac_f32_16x16x64_bf16 v[8:11], v[56:59], a[112:119], v64
    ds_read_b128 v[36:39], v70 offset:11264
    v_bitop3_b32 v79, v73, -9, s54 bitop3:0x6a
    v_smfmac_f32_16x16x64_bf16 v[12:15], v[56:59], a[120:127], v64
    ds_read_b128 v[52:55], v68 offset:0
    v_lshlrev_b32 v78, 2, v65
    v_smfmac_f32_16x16x64_bf16 v[16:19], v[60:63], a[216:223], v64
    buffer_load_dwordx4 v[40:43], v65, s[4:7], s15 offen offset:0 nt
    s_waitcnt lgkmcnt(4)
    v_smfmac_f32_16x16x64_bf16 v[20:23], v[60:63], v[24:31], v64
    ds_read_b128 v[24:27], v70 offset:12288
    s_waitcnt lgkmcnt(3)
    v_smfmac_f32_16x16x64_bf16 v[0:3], v[48:51], a[0:7], v64
    ds_read_b128 v[28:31], v70 offset:13312
    s_waitcnt lgkmcnt(3)
    v_smfmac_f32_16x16x64_bf16 v[4:7], v[48:51], v[32:39], v64
    ds_read_b128 v[32:35], v70 offset:14336
    s_add_u32 s40, s26, 1048576
    v_smfmac_f32_16x16x64_bf16 v[8:11], v[48:51], a[128:135], v64
    ds_read_b128 v[36:39], v70 offset:15360
    v_smfmac_f32_16x16x64_bf16 v[12:15], v[48:51], a[136:143], v64
    buffer_load_dwordx4 v[60:63], v65, s[4:7], s16 offen offset:0 nt
    v_smfmac_f32_16x16x64_bf16 v[16:19], v[56:59], a[224:231], v64
    v_smfmac_f32_16x16x64_bf16 v[20:23], v[56:59], a[232:239], v64
    s_waitcnt lgkmcnt(2)
    s_waitcnt vmcnt(2)
    v_and_b32 v77, s36, v40
    v_smfmac_f32_16x16x64_bf16 v[12:15], v[52:55], v[24:31], v64
    ds_write_b128 v65, v[40:43] offset:4096
    v_smfmac_f32_16x16x64_bf16 v[0:3], v[52:55], a[8:15], v64
    s_waitcnt lgkmcnt(1)
    v_cmp_ne_u32 vcc, s70, v77
    v_smfmac_f32_16x16x64_bf16 v[4:7], v[52:55], v[32:39], v64
    buffer_load_dwordx4 v[24:27], v65, s[4:7], s24 offen offset:0 sc1
    v_smfmac_f32_16x16x64_bf16 v[8:11], v[52:55], a[144:151], v64
    s_cbranch_vccnz cf_spinB
cf_backB:
    v_smfmac_f32_16x16x64_bf16 v[16:19], v[40:43], v[176:183], v64
    s_waitcnt lgkmcnt(0)
    s_barrier
    ds_read_b128 v[44:47], v66 offset:4096
    v_smfmac_f32_16x16x64_bf16 v[12:15], v[40:43], a[160:167], v64
    ds_read_b128 v[32:35], v70 offset:16384
    v_smfmac_f32_16x16x64_bf16 v[0:3], v[40:43], a[16:23], v64
    ds_read_b128 v[36:39], v70 offset:17408
    v_smfmac_f32_16x16x64_bf16 v[8:11], v[40:43], a[152:159], v64
    ds_read_b128 v[48:51], v67 offset:4096
    v_smfmac_f32_16x16x64_bf16 v[4:7], v[40:43], a[24:31], v64
    ds_read_b128 v[52:55], v68 offset:4096
    v_smfmac_f32_16x16x64_bf16 v[20:23], v[40:43], v[184:191], v64
    buffer_load_dwordx4 v[28:31], v65, s[4:7], s24 offen offset:1024 sc1
    s_waitcnt lgkmcnt(4)
    v_smfmac_f32_16x16x64_bf16 v[0:3], v[44:47], a[32:39], v64
    ds_read_b128 v[56:59], v69 offset:15360
    s_waitcnt lgkmcnt(3)
    v_smfmac_f32_16x16x64_bf16 v[8:11], v[44:47], v[32:39], v64
    ds_read_b128 v[32:35], v70 offset:18432
    v_smfmac_f32_16x16x64_bf16 v[4:7], v[44:47], a[40:47], v64
    ds_read_b128 v[36:39], v70 offset:19456
    v_smfmac_f32_16x16x64_bf16 v[12:15], v[44:47], a[168:175], v64
    buffer_load_dwordx4 v[42:45], v65, s[4:7], s24 offen offset:3072 sc1
    s_waitcnt lgkmcnt(3)
    v_smfmac_f32_16x16x64_bf16 v[0:3], v[48:51], a[48:55], v64
    s_waitcnt vmcnt(3)
    v_and_b32 v77, s36, v60
    v_smfmac_f32_16x16x64_bf16 v[8:11], v[48:51], a[176:183], v64
    v_cmp_ne_u32 vcc, s70, v77
    v_smfmac_f32_16x16x64_bf16 v[0:3], v[52:55], a[64:71], v64
    s_waitcnt lgkmcnt(0)
    v_smfmac_f32_16x16x64_bf16 v[8:11], v[52:55], v[32:39], v64
    s_cbranch_vccnz cf_spin8
cf_back8:
    v_smfmac_f32_16x16x64_bf16 v[0:3], v[60:63], a[80:87], v64
    buffer_load_dwordx4 v[34:37], v65, s[4:7], s24 offen offset:2048 sc1
    s_nop 1
    v_smfmac_f32_16x16x64_bf16 v[8:11], v[60:63], a[200:207], v64
    s_nop 1
    v_lshrrev_b32 v77, 1, v69
    v_smfmac_f32_16x16x64_bf16 v[4:7], v[48:51], a[56:63], v64
    s_nop 1
    v_cvt_pk_bf16_f32 v0, v0, v1
    v_smfmac_f32_16x16x64_bf16 v[12:15], v[48:51], a[184:191], v64
    s_nop 1
    v_cvt_pk_bf16_f32 v1, v2, v3
    v_smfmac_f32_16x16x64_bf16 v[4:7], v[52:55], a[72:79], v64
    s_nop 1
    v_cvt_pk_bf16_f32 v2, v8, v9
    v_smfmac_f32_16x16x64_bf16 v[12:15], v[52:55], a[192:199], v64
    s_nop 1
    v_cvt_pk_bf16_f32 v3, v10, v11
    v_smfmac_f32_16x16x64_bf16 v[4:7], v[60:63], a[88:95], v64
    s_nop 2
    v_smfmac_f32_16x16x64_bf16 v[12:15], v[60:63], a[208:215], v64
    buffer_load_dword v76, v78, s[4:7], s40 offen sc1
    s_nop 1
    v_mfma_f32_16x16x32_bf16 v[8:11], v[0:3], v[56:59], 0
    s_nop 0
    v_cvt_pk_bf16_f32 v4, v4, v5
    v_cvt_pk_bf16_f32 v5, v6, v7
    s_nop 0
    v_cvt_pk_bf16_f32 v6, v12, v13
    v_cvt_pk_bf16_f32 v7, v14, v15
    s_nop 1
    v_mfma_f32_16x16x32_bf16 v[12:15], v[4:7], v[56:59], 0
    ds_read_b128 v[56:59], v66 offset:4096
    v_cvt_pk_bf16_f32 v0, v8, v9
    v_cvt_pk_bf16_f32 v1, v10, v11
    v_smfmac_f32_16x16x64_bf16 v[16:19], v[48:51], v[208:215], v64
    s_waitcnt vmcnt(3)
    s_nop 2
    v_cvt_pk_bf16_f32 v2, v12, v13
    v_cvt_pk_bf16_f32 v3, v14, v15
    s_nop 1
    v_mfma_f32_16x16x32_bf16 v[12:15], v[0:3], v[0:3], 0
    s_nop 1
    v_bitop3_b32 v78, v73, -9, s53 bitop3:0x6a
    v_mfma_f32_16x16x32_bf16 v[4:7], v[24:27], v[0:3], 0
    ds_read_b128 v[24:27], v67 offset:0
    s_nop 1
    v_mfma_f32_16x16x32_bf16 v[8:11], v[28:31], v[0:3], 0
    s_nop 0
    v_mov_b32_dpp v12, v14 row_ror:8 row_mask:0xf bank_mask:0xc
    v_mov_b32_dpp v13, v15 row_ror:8 row_mask:0xf bank_mask:0xc
    v_smfmac_f32_16x16x64_bf16 v[20:23], v[48:51], v[216:223], v64
    ds_write_b64 v71, v[12:13]
    ds_read_b128 v[48:51], v68 offset:0
    s_nop 1
    v_mov_b32_dpp v4, v8 row_ror:8 row_mask:0xf bank_mask:0xc
    v_mov_b32_dpp v5, v9 row_ror:8 row_mask:0xf bank_mask:0xc
    v_mov_b32_dpp v6, v10 row_ror:8 row_mask:0xf bank_mask:0xc
    v_mov_b32_dpp v7, v11 row_ror:8 row_mask:0xf bank_mask:0xc
    v_smfmac_f32_16x16x64_bf16 v[16:19], v[52:55], v[224:231], v64
    ds_write_b128 v65, v[4:7] offset:8192
    v_smfmac_f32_16x16x64_bf16 v[20:23], v[52:55], v[232:239], v64
    s_waitcnt lgkmcnt(3)
    v_smfmac_f32_16x16x64_bf16 v[16:19], v[24:27], a[240:247], v64
    s_waitcnt vmcnt(1)
    v_smfmac_f32_16x16x64_bf16 v[20:23], v[24:27], a[248:255], v64
    s_mov_b64 exec, s[38:39]
    buffer_store_dword v72, v75, s[4:7], s55 offen sc1
    s_mov_b64 exec, -1
    v_smfmac_f32_16x16x64_bf16 v[16:19], v[60:63], v[240:247], v64
    s_cmp_lg_u32 s37, 0
    s_waitcnt lgkmcnt(0)
    s_barrier
    ds_read_b128 v[8:11], v66 offset:8192
    v_smfmac_f32_16x16x64_bf16 v[20:23], v[60:63], v[248:255], v64
    ds_read_b128 v[12:15], v67 offset:8192
    v_and_b32 v72, 8, v73
    v_smfmac_f32_16x16x64_bf16 v[16:19], v[56:59], v[192:199], v64
    ds_read_b128 v[52:55], v68 offset:8192
    v_mad_u32_u24 v72, v72, 63, v73
    v_smfmac_f32_16x16x64_bf16 v[20:23], v[56:59], v[200:207], v64
    ds_read_b64 v[24:25], v77 offset:14336
    ds_read_b64 v[26:27], v77 offset:14592
    v_subrev_u32 v72, s47, v72
    v_smfmac_f32_16x16x64_bf16 v[16:19], v[48:51], v[160:167], v64
    ds_read_b64 v[28:29], v77 offset:14848
    ds_read_b64 v[30:31], v77 offset:15104
    v_bitop3_b32 v77, v73, -9, s52 bitop3:0x6a
    v_smfmac_f32_16x16x64_bf16 v[20:23], v[48:51], v[168:175], v64
    s_cbranch_scc1 cf_rare
cf_rare_x:
    ds_read_b128 v[56:59], v70 offset:22528
    ds_read_b128 v[60:63], v70 offset:23552
    s_waitcnt lgkmcnt(6)
    v_pk_add_f32 v[4:5], v[4:5], v[8:9]
    v_pk_add_f32 v[6:7], v[6:7], v[10:11]
    v_pk_add_f32 v[12:13], v[12:13], v[52:53]
    v_pk_add_f32 v[14:15], v[14:15], v[54:55]
    v_pk_add_f32 v[4:5], v[4:5], v[12:13]
    v_pk_add_f32 v[6:7], v[6:7], v[14:15]
    s_waitcnt lgkmcnt(2)
    v_pk_add_f32 v[24:25], v[24:25], v[26:27]
    v_pk_add_f32 v[28:29], v[28:29], v[30:31]
    v_max3_f32 v8, v4, v5, v6
    v_pk_add_f32 v[24:25], v[24:25], v[28:29]
    v_max_f32 v8, v8, v7
    v_max3_f32 v8, v8, v24, v25
    v_cvt_pk_bf16_f32 v32, v16, v17
    v_cvt_pk_bf16_f32 v38, v18, v19
    v_max_f32_dpp v8, v8, v8 row_ror:8 row_mask:0xf bank_mask:0xf
    v_mov_b32 v9, v8
    v_cvt_pk_bf16_f32 v40, v20, v21
    v_cvt_pk_bf16_f32 v46, v22, v23
    v_permlane32_swap_b32 v8, v9
    v_max_f32 v8, v8, v9
    v_mov_b32 v9, v8
    v_mov_b32 v11, 0
    v_mov_b32 v15, 0
    v_permlane16_swap_b32 v8, v9
    v_max_f32 v8, v8, v9
    v_mul_f32 v8, s66, v8
    v_pk_fma_f32 v[4:5], v[4:5], s[44:45], v[8:9] op_sel_hi:[1,1,0]
    v_pk_fma_f32 v[6:7], v[6:7], s[44:45], v[8:9] op_sel_hi:[1,1,0]
    v_pk_fma_f32 v[24:25], v[24:25], s[44:45], v[8:9] op_sel_hi:[1,1,0]
    v_exp_f32 v4, v4
    v_exp_f32 v5, v5
    v_exp_f32 v6, v6
    v_exp_f32 v7, v7
    v_exp_f32 v24, v24
    v_exp_f32 v25, v25
    v_cvt_pk_bf16_f32 v12, v4, v5
    v_cvt_pk_bf16_f32 v13, v6, v7
    v_cvt_pk_bf16_f32 v10, v24, v25
    v_cvt_pk_bf16_f32 v14, v24, v25
    v_mov_b64 v[0:1], s[48:49]
    v_mfma_f32_16x16x32_bf16 v[4:7], v[32:35], v[10:13], 0
    ds_read_b128 v[48:51], v70 offset:20480
    v_mov_b64 v[2:3], s[50:51]
    v_mfma_f32_16x16x32_bf16 v[24:27], v[36:39], v[12:15], 0
    ds_read_b128 v[52:55], v70 offset:21504
    v_mov_b64 v[8:9], 0
    v_mfma_f32_16x16x32_bf16 v[28:31], v[0:3], v[10:13], 0
    ds_read_b128 v[32:35], v70 offset:24576
    v_mov_b64 v[0:1], 0
    v_mfma_f32_16x16x32_bf16 v[16:19], v[40:43], v[10:13], 0
    ds_read_b128 v[36:39], v70 offset:25600
    v_mov_b64 v[2:3], 0
    v_mfma_f32_16x16x32_bf16 v[20:23], v[44:47], v[12:15], 0
    ds_read_b128 v[40:43], v70 offset:26624
    v_add_f32_dpp v4, v24, v4 row_ror:8 row_mask:0xf bank_mask:0xf
    v_add_f32_dpp v5, v25, v5 row_ror:8 row_mask:0xf bank_mask:0xf
    v_add_f32_dpp v6, v26, v6 row_ror:8 row_mask:0xf bank_mask:0xf
    v_add_f32_dpp v7, v27, v7 row_ror:8 row_mask:0xf bank_mask:0xf
    v_add_f32_dpp v29, v28, v28 row_ror:8 row_mask:0xf bank_mask:0xf
    v_rcp_f32 v28, v29
    v_mov_b64 v[10:11], 0
    v_add_f32_dpp v4, v16, v20 row_ror:8 row_mask:0xf bank_mask:0xc
    v_add_f32_dpp v5, v17, v21 row_ror:8 row_mask:0xf bank_mask:0xc
    v_add_f32_dpp v6, v18, v22 row_ror:8 row_mask:0xf bank_mask:0xc
    v_add_f32_dpp v7, v19, v23 row_ror:8 row_mask:0xf bank_mask:0xc
    v_pk_mul_f32 v[4:5], v[4:5], v[28:29] op_sel_hi:[1,0]
    v_pk_mul_f32 v[6:7], v[6:7], v[28:29] op_sel_hi:[1,0]
    v_cvt_pk_bf16_f32 v4, v4, v5
    v_cvt_pk_bf16_f32 v5, v6, v7
    ds_write_b64 v73, v[4:5] offset:12288
    v_mov_b32_dpp v6, v4 row_ror:8 row_mask:0xf bank_mask:0xf
    v_mov_b32_dpp v7, v5 row_ror:8 row_mask:0xf bank_mask:0xf
    v_mov_b64 v[12:13], 0
    v_mov_b64 v[14:15], 0
    v_smfmac_f32_16x16x64_bf16 v[8:11], v[4:7], v[80:87], v64
    s_waitcnt lgkmcnt(4)
    v_mov_b64 v[24:25], 0
    v_smfmac_f32_16x16x64_bf16 v[0:3], v[4:7], v[48:55], v64
    ds_read_b128 v[44:47], v70 offset:27648
    v_mov_b64 v[26:27], 0
    v_smfmac_f32_16x16x64_bf16 v[12:15], v[4:7], v[112:119], v64
    s_waitcnt lgkmcnt(1)
    s_barrier
    ds_read_b128 v[16:19], v77 offset:12288
    v_smfmac_f32_16x16x64_bf16 v[24:27], v[4:7], v[56:63], v64
    ds_read_b128 v[20:23], v78 offset:12288
    ds_read_b128 v[28:31], v79 offset:12288
    v_mov_b64 v[4:5], 0
    v_mov_b64 v[6:7], 0
    v_bfe_u32 v77, v74, 16, 1
    v_mad_i32_i24 v77, v77, s56, v74
    s_waitcnt lgkmcnt(2)
    v_smfmac_f32_16x16x64_bf16 v[8:11], v[16:19], v[88:95], v64
    ds_read_b128 v[56:59], v70 offset:28672
    v_smfmac_f32_16x16x64_bf16 v[12:15], v[16:19], v[120:127], v64
    ds_read_b128 v[60:63], v70 offset:29696
    s_waitcnt lgkmcnt(3)
    v_smfmac_f32_16x16x64_bf16 v[8:11], v[20:23], v[96:103], v64
    ds_read_b128 v[48:51], v70 offset:30720
    v_smfmac_f32_16x16x64_bf16 v[12:15], v[20:23], v[128:135], v64
    ds_read_b128 v[52:55], v70 offset:31744
    s_waitcnt lgkmcnt(4)
    v_smfmac_f32_16x16x64_bf16 v[8:11], v[28:31], v[104:111], v64
    s_add_u32 s30, s30, 1
    s_xor_b32 s70, s70, 1
    s_cmp_lg_u32 s71, 0
    v_smfmac_f32_16x16x64_bf16 v[12:15], v[28:31], v[136:143], v64
    s_nop 2
    v_smfmac_f32_16x16x64_bf16 v[0:3], v[16:19], v[32:39], v64
    ds_read_b128 v[32:35], v70 offset:32768
    ds_read_b128 v[36:39], v70 offset:33792
    v_cvt_pk_bf16_f32 v8, v8, v9
    v_cvt_pk_bf16_f32 v9, v10, v11
    v_and_or_b32 v8, v8, -2, s69
    v_cvt_pk_bf16_f32 v10, v12, v13
    v_cvt_pk_bf16_f32 v11, v14, v15
    v_smfmac_f32_16x16x64_bf16 v[24:27], v[16:19], v[40:47], v64
    buffer_store_dwordx4 v[8:11], v74, s[4:7], s22 offen
    ds_read_b128 v[40:43], v70 offset:34816
    s_waitcnt lgkmcnt(3)
    v_smfmac_f32_16x16x64_bf16 v[0:3], v[20:23], v[56:63], v64
    ds_read_b128 v[44:47], v70 offset:35840
    ds_read_b128 v[56:59], v72 offset:12288
    v_smfmac_f32_16x16x64_bf16 v[24:27], v[20:23], v[48:55], v64
    ds_read_b128 v[60:63], v72 offset:13312
    s_waitcnt lgkmcnt(4)
    v_smfmac_f32_16x16x64_bf16 v[0:3], v[28:31], v[32:39], v64
    s_waitcnt lgkmcnt(2)
    s_nop 1
    v_smfmac_f32_16x16x64_bf16 v[24:27], v[28:31], v[40:47], v64
    s_waitcnt lgkmcnt(0)
    s_nop 1
    v_smfmac_f32_16x16x64_bf16 v[4:7], v[56:59], v[144:151], v64
    v_cvt_pk_bf16_f32 v0, v0, v1
    v_cvt_pk_bf16_f32 v1, v2, v3
    v_and_or_b32 v0, v0, -2, s69
    s_nop 0
    v_cvt_pk_bf16_f32 v2, v24, v25
    v_cvt_pk_bf16_f32 v3, v26, v27
    v_smfmac_f32_16x16x64_bf16 v[4:7], v[60:63], v[152:159], v64
    buffer_store_dwordx4 v[0:3], v74, s[4:7], s23 offen
    s_nop 6
    v_cvt_pk_bf16_f32 v4, v4, v5
    v_cvt_pk_bf16_f32 v5, v6, v7
    v_and_or_b32 v4, v4, -2, s69
    buffer_store_dwordx2 v[4:5], v77, s[4:7], s25 offen
    s_cbranch_scc1 cf_e1
    s_nop 2
    v_mov_b32 v79, v79
    s_nop 2
    v_mov_b32 v79, v79
    s_nop 2
    v_mov_b32 v79, v79
    s_nop 2
    v_mov_b32 v79, v79
    s_nop 2
    v_mov_b32 v79, v79
    s_nop 2
    v_mov_b32 v79, v79
    s_nop 2
    v_mov_b32 v79, v79
    s_nop 2
    v_mov_b32 v79, v79
    s_nop 2
    v_mov_b32 v79, v79
    s_nop 2
    v_mov_b32 v79, v79
    s_nop 2
    v_mov_b32 v79, v79
    s_nop 2
    v_mov_b32 v79, v79
    s_nop 2
    v_mov_b32 v79, v79
    s_nop 2
    v_mov_b32 v79, v79
    buffer_load_dwordx4 v[8:11], v65, s[4:7], s18 offen nt
    buffer_load_dwordx4 v[12:15], v65, s[4:7], s19 offen nt
    buffer_load_dwordx4 v[16:19], v65, s[4:7], s20 offen nt
    buffer_load_dwordx4 v[20:23], v65, s[4:7], s21 offen nt
    v_and_b32 v77, 255, v69
    ds_read_b128 v[4:7], v77 offset:15872
    ds_read_b128 v[40:43], v70 offset:0
    ds_read_b128 v[44:47], v70 offset:1024
    ds_read_b128 v[48:51], v70 offset:2048
    ds_read_b128 v[52:55], v70 offset:3072
    ds_read_b128 v[24:27], v70 offset:4096
    ds_read_b128 v[28:31], v70 offset:5120
    ds_read_b128 v[32:35], v70 offset:6144
    ds_read_b128 v[36:39], v70 offset:7168
    s_mov_b32 s31, 65536
    s_add_u32 s24, s24, 524288
    s_add_u32 s26, s26, 524288
    s_add_u32 s55, s55, s57
    s_cmp_lt_u32 s97, s93
    s_cselect_b32 s37, 1, 0
    s_cmp_ge_u32 s30, 58
    s_cselect_b32 s37, 1, s37
    s_mov_b32 s14, 67108864
    s_mov_b32 s15, 67112960
    s_mov_b32 s16, 67117056
    s_mov_b32 s36, 1
    v_mov_b32 v60, s69
    v_mov_b32 v56, s69
    v_and_b32 v79, 12, v75
    v_cmp_eq_u32 vcc, 0, v79
    s_nop 1
    v_cndmask_b32 v79, 0, 1, vcc
    s_waitcnt lgkmcnt(0)
    s_waitcnt vmcnt(3)
    v_xor_b32 v77, s69, v8
    v_mfma_f32_16x16x32_bf16 v[0:3], v[4:7], v[8:11], 0
    v_mov_b64 v[8:9], 0
    v_mov_b64 v[10:11], 0
    s_waitcnt vmcnt(2)
    v_bitop3_b32 v77, v77, v12, s69 bitop3:0xf6
    v_mfma_f32_16x16x32_bf16 v[0:3], v[4:7], v[12:15], v[0:3]
    v_mov_b64 v[12:13], 0
    v_mov_b64 v[14:15], 0
    s_waitcnt vmcnt(1)
    v_bitop3_b32 v77, v77, v16, s69 bitop3:0xf6
    v_mfma_f32_16x16x32_bf16 v[0:3], v[4:7], v[16:19], v[0:3]
    v_mov_b64 v[16:17], 0
    v_mov_b64 v[18:19], 0
    s_waitcnt vmcnt(0)
    v_bitop3_b32 v77, v77, v20, s69 bitop3:0xf6
    v_mfma_f32_16x16x32_bf16 v[0:3], v[4:7], v[20:23], v[0:3]
    v_and_b32 v77, 1, v77
    v_cmp_ne_u32 vcc, 0, v77
    v_mov_b64 v[20:21], 0
    v_mov_b64 v[22:23], 0
    s_cmp_eq_u64 vcc, 0
    s_cselect_b64 s[42:43], -1, 0
    s_nop 1
    v_add_f32_dpp v0, v0, v0 row_ror:8 row_mask:0xf bank_mask:0xf
    v_add_f32_dpp v1, v1, v1 row_ror:8 row_mask:0xf bank_mask:0xf
    s_mov_b64 exec, s[42:43]
    v_cvt_pk_bf16_f32 v72, v0, v1
    v_bfi_b32 v72, v79, s70, v72
    buffer_store_dword v72, v75, s[4:7], s17 offen offset:0
    s_mov_b64 exec, -1
    s_cbranch_scc0 cf_f0_retry
cf_f0_go:
    v_mov_b64 v[0:1], 0
    v_mov_b64 v[2:3], 0
    v_mov_b64 v[4:5], 0
    v_mov_b64 v[6:7], 0
    s_nop 2
    v_mov_b32 v79, v79
    s_nop 2
    v_mov_b32 v79, v79
    s_nop 2
    v_mov_b32 v79, v79
    s_nop 2
    v_mov_b32 v79, v79
    s_branch cf_loop
cf_e1:
    s_cmp_lg_u32 s71, 2
    s_cbranch_scc1 cf_f1
    v_and_b32 v77, 255, v69
    ds_read_b128 v[4:7], v77 offset:15872
    ds_read_b128 v[40:43], v70 offset:0
    ds_read_b128 v[44:47], v70 offset:1024
    ds_read_b128 v[48:51], v70 offset:2048
    ds_read_b128 v[52:55], v70 offset:3072
    ds_read_b128 v[24:27], v70 offset:4096
    ds_read_b128 v[28:31], v70 offset:5120
    ds_read_b128 v[32:35], v70 offset:6144
    ds_read_b128 v[36:39], v70 offset:7168
    s_mov_b32 s31, 65536
    s_add_u32 s24, s24, 524288
    s_add_u32 s26, s26, 524288
    s_add_u32 s55, s55, s57
    s_cmp_lt_u32 s97, s93
    s_cselect_b32 s37, 1, 0
    s_cmp_ge_u32 s30, 58
    s_cselect_b32 s37, 1, s37
    s_mov_b32 s14, 67108864
    s_mov_b32 s15, 67112960
    s_mov_b32 s16, 67117056
    s_mov_b32 s36, 1
    v_mov_b32 v60, s69
    v_mov_b32 v56, s69
    v_and_b32 v79, 12, v75
    v_cmp_eq_u32 vcc, 0, v79
    s_nop 1
    v_cndmask_b32 v79, 0, 1, vcc
    s_nop 2
    v_mov_b32 v79, v79
    s_nop 2
    v_mov_b32 v79, v79
    s_nop 2
    v_mov_b32 v79, v79
    s_nop 2
    v_mov_b32 v79, v79
    s_nop 2
    v_mov_b32 v79, v79
    s_nop 2
    v_mov_b32 v79, v79
    s_nop 2
    v_mov_b32 v79, v79
    s_nop 2
    v_mov_b32 v79, v79
    s_nop 2
    v_mov_b32 v79, v79
    s_nop 2
    v_mov_b32 v79, v79
    s_nop 2
    v_mov_b32 v79, v79
    s_nop 2
    v_mov_b32 v79, v79
    s_nop 2
    v_mov_b32 v79, v79
    s_nop 2
    v_mov_b32 v79, v79
    s_waitcnt vmcnt(0)
    buffer_load_dwordx4 v[8:11], v65, s[4:7], s18 offen nt
    buffer_load_dwordx4 v[12:15], v65, s[4:7], s19 offen nt
    buffer_load_dwordx4 v[16:19], v65, s[4:7], s20 offen nt
    buffer_load_dwordx4 v[20:23], v65, s[4:7], s21 offen nt
    s_nop 2
    v_mov_b32 v79, v79
    s_nop 2
    v_mov_b32 v79, v79
    s_nop 2
    v_mov_b32 v79, v79
    s_nop 2
    v_mov_b32 v79, v79
    s_nop 2
    v_mov_b32 v79, v79
    s_nop 2
    v_mov_b32 v79, v79
    s_nop 2
    v_mov_b32 v79, v79
    s_nop 2
    v_mov_b32 v79, v79
    s_nop 2
    v_mov_b32 v79, v79
    s_nop 2
    v_mov_b32 v79, v79
    buffer_load_dwordx4 v[60:63], v65, s[4:7], s14 offen offset:0 nt
    buffer_load_dwordx4 v[56:59], v66, s[4:7], s14 offen offset:0 nt
    s_waitcnt lgkmcnt(0)
    s_waitcnt vmcnt(5)
    v_xor_b32 v77, s69, v8
    v_bitop3_b32 v77, v77, v10, s69 bitop3:0xf6
    v_mfma_f32_16x16x32_bf16 v[0:3], v[4:7], v[8:11], 0
    v_mov_b64 v[8:9], 0
    v_mov_b64 v[10:11], 0
    s_waitcnt vmcnt(4)
    v_bitop3_b32 v77, v77, v12, s69 bitop3:0xf6
    v_bitop3_b32 v77, v77, v14, s69 bitop3:0xf6
    v_mfma_f32_16x16x32_bf16 v[0:3], v[4:7], v[12:15], v[0:3]
    v_mov_b64 v[12:13], 0
    v_mov_b64 v[14:15], 0
    s_waitcnt vmcnt(3)
    v_bitop3_b32 v77, v77, v16, s69 bitop3:0xf6
    v_bitop3_b32 v77, v77, v18, s69 bitop3:0xf6
    v_mfma_f32_16x16x32_bf16 v[0:3], v[4:7], v[16:19], v[0:3]
    v_mov_b64 v[16:17], 0
    v_mov_b64 v[18:19], 0
    s_waitcnt vmcnt(2)
    v_bitop3_b32 v77, v77, v20, s69 bitop3:0xf6
    v_bitop3_b32 v77, v77, v22, s69 bitop3:0xf6
    v_mfma_f32_16x16x32_bf16 v[0:3], v[4:7], v[20:23], v[0:3]
    v_and_b32 v77, 1, v77
    v_cmp_ne_u32 vcc, 0, v77
    v_mov_b64 v[20:21], 0
    v_mov_b64 v[22:23], 0
    buffer_load_dwordx4 v[60:63], v65, s[4:7], s14 offen offset:0 nt
    buffer_load_dwordx4 v[56:59], v66, s[4:7], s14 offen offset:0 nt
    s_cmp_eq_u64 vcc, 0
    s_cselect_b64 s[42:43], -1, 0
    v_add_f32 v2, v0, v1
    s_nop 1
    v_add_f32_dpp v2, v2, v2 row_ror:8 row_mask:0xf bank_mask:0xf
    s_nop 1
    v_mov_b32_dpp v0, v2 quad_perm:[0,0,2,2] row_mask:0xf bank_mask:0xf
    v_mov_b32_dpp v1, v2 quad_perm:[1,1,3,3] row_mask:0xf bank_mask:0xf
    s_mov_b64 exec, s[42:43]
    v_cvt_pk_bf16_f32 v72, v0, v1
    v_bfi_b32 v72, v79, s70, v72
    buffer_store_dword v72, v75, s[4:7], s17 offen offset:0
    buffer_store_dword v72, v75, s[4:7], s17 offen offset:1024
    buffer_store_dword v72, v75, s[4:7], s17 offen offset:2048
    buffer_store_dword v72, v75, s[4:7], s17 offen offset:3072
    s_mov_b64 exec, -1
    s_cbranch_scc0 cf_f2_retry
cf_f2_go:
    v_mov_b64 v[0:1], 0
    v_mov_b64 v[2:3], 0
    v_mov_b64 v[4:5], 0
    v_mov_b64 v[6:7], 0
    s_branch cf_loop
cf_f1:
    s_cmp_lg_u32 s32, 1
    s_cbranch_scc1 cf_f3
    v_and_b32 v77, 255, v69
    ds_read_b128 v[4:7], v77 offset:15872
    ds_read_b128 v[40:43], v70 offset:0
    ds_read_b128 v[44:47], v70 offset:1024
    ds_read_b128 v[48:51], v70 offset:2048
    ds_read_b128 v[52:55], v70 offset:3072
    ds_read_b128 v[24:27], v70 offset:4096
    ds_read_b128 v[28:31], v70 offset:5120
    ds_read_b128 v[32:35], v70 offset:6144
    ds_read_b128 v[36:39], v70 offset:7168
    s_mov_b32 s31, 65536
    s_add_u32 s24, s24, 524288
    s_add_u32 s26, s26, 524288
    s_add_u32 s55, s55, s57
    s_cmp_lt_u32 s97, s93
    s_cselect_b32 s37, 1, 0
    s_cmp_ge_u32 s30, 58
    s_cselect_b32 s37, 1, s37
    s_mov_b32 s14, 67108864
    s_mov_b32 s15, 67112960
    s_mov_b32 s16, 67117056
    s_mov_b32 s36, 1
    v_mov_b32 v60, s69
    v_mov_b32 v56, s69
    v_and_b32 v79, 12, v75
    v_cmp_eq_u32 vcc, 0, v79
    s_nop 1
    v_cndmask_b32 v79, 0, 1, vcc
    s_nop 2
    v_mov_b32 v79, v79
    s_nop 2
    v_mov_b32 v79, v79
    s_nop 2
    v_mov_b32 v79, v79
    s_nop 2
    v_mov_b32 v79, v79
    s_nop 2
    v_mov_b32 v79, v79
    s_nop 2
    v_mov_b32 v79, v79
    s_nop 2
    v_mov_b32 v79, v79
    s_nop 2
    v_mov_b32 v79, v79
    s_nop 2
    v_mov_b32 v79, v79
    s_nop 2
    v_mov_b32 v79, v79
    s_nop 2
    v_mov_b32 v79, v79
    s_nop 2
    v_mov_b32 v79, v79
    s_waitcnt vmcnt(0)
    buffer_load_dwordx4 v[8:11], v65, s[4:7], s18 offen nt
    buffer_load_dwordx4 v[12:15], v65, s[4:7], s19 offen nt
    buffer_load_dwordx4 v[16:19], v65, s[4:7], s20 offen nt
    buffer_load_dwordx4 v[20:23], v65, s[4:7], s21 offen nt
    s_nop 2
    v_mov_b32 v79, v79
    s_nop 2
    v_mov_b32 v79, v79
    s_nop 2
    v_mov_b32 v79, v79
    s_nop 2
    v_mov_b32 v79, v79
    s_nop 2
    v_mov_b32 v79, v79
    s_nop 2
    v_mov_b32 v79, v79
    s_nop 2
    v_mov_b32 v79, v79
    s_nop 2
    v_mov_b32 v79, v79
    s_nop 2
    v_mov_b32 v79, v79
    s_nop 2
    v_mov_b32 v79, v79
    buffer_load_dwordx4 v[60:63], v65, s[4:7], s14 offen offset:0 nt
    buffer_load_dwordx4 v[56:59], v66, s[4:7], s14 offen offset:0 nt
    s_waitcnt lgkmcnt(0)
    s_waitcnt vmcnt(5)
    v_xor_b32 v77, s69, v8
    v_mfma_f32_16x16x32_bf16 v[0:3], v[4:7], v[8:11], 0
    v_mov_b64 v[8:9], 0
    v_mov_b64 v[10:11], 0
    s_waitcnt vmcnt(4)
    v_bitop3_b32 v77, v77, v12, s69 bitop3:0xf6
    v_mfma_f32_16x16x32_bf16 v[0:3], v[4:7], v[12:15], v[0:3]
    v_mov_b64 v[12:13], 0
    v_mov_b64 v[14:15], 0
    s_waitcnt vmcnt(3)
    v_bitop3_b32 v77, v77, v16, s69 bitop3:0xf6
    v_mfma_f32_16x16x32_bf16 v[0:3], v[4:7], v[16:19], v[0:3]
    v_mov_b64 v[16:17], 0
    v_mov_b64 v[18:19], 0
    s_waitcnt vmcnt(2)
    v_bitop3_b32 v77, v77, v20, s69 bitop3:0xf6
    v_mfma_f32_16x16x32_bf16 v[0:3], v[4:7], v[20:23], v[0:3]
    v_and_b32 v77, 1, v77
    v_cmp_ne_u32 vcc, 0, v77
    v_mov_b64 v[20:21], 0
    v_mov_b64 v[22:23], 0
    buffer_load_dwordx4 v[60:63], v65, s[4:7], s14 offen offset:0 nt
    buffer_load_dwordx4 v[56:59], v66, s[4:7], s14 offen offset:0 nt
    s_cmp_eq_u64 vcc, 0
    s_cselect_b64 s[42:43], -1, 0
    v_add_f32_dpp v0, v0, v0 row_ror:8 row_mask:0xf bank_mask:0xf
    v_add_f32_dpp v1, v1, v1 row_ror:8 row_mask:0xf bank_mask:0xf
    s_mov_b64 exec, s[42:43]
    v_cvt_pk_bf16_f32 v72, v0, v1
    v_bfi_b32 v72, v79, s70, v72
    buffer_store_dword v72, v75, s[4:7], s17 offen offset:0
    s_mov_b64 exec, -1
    s_cbranch_scc0 cf_f1_retry
cf_f1_go:
    v_mov_b64 v[0:1], 0
    v_mov_b64 v[2:3], 0
    v_mov_b64 v[4:5], 0
    v_mov_b64 v[6:7], 0
    s_branch cf_loop
cf_f3:
    v_and_b32 v77, 255, v69
    ds_read_b128 v[4:7], v77 offset:15872
    ds_read_b128 v[40:43], v70 offset:0
    ds_read_b128 v[44:47], v70 offset:1024
    ds_read_b128 v[48:51], v70 offset:2048
    ds_read_b128 v[52:55], v70 offset:3072
    ds_read_b128 v[24:27], v70 offset:4096
    ds_read_b128 v[28:31], v70 offset:5120
    ds_read_b128 v[32:35], v70 offset:6144
    ds_read_b128 v[36:39], v70 offset:7168
    s_mov_b32 s31, 65536
    s_add_u32 s24, s24, 524288
    s_add_u32 s26, s26, 524288
    s_add_u32 s55, s55, s57
    s_cmp_lt_u32 s97, s93
    s_cselect_b32 s37, 1, 0
    s_cmp_ge_u32 s30, 58
    s_cselect_b32 s37, 1, s37
    s_mov_b32 s14, 67108864
    s_mov_b32 s15, 67112960
    s_mov_b32 s16, 67117056
    s_mov_b32 s36, 1
    v_mov_b32 v60, s69
    v_mov_b32 v56, s69
    v_and_b32 v79, 12, v75
    v_cmp_eq_u32 vcc, 0, v79
    s_nop 1
    v_cndmask_b32 v79, 0, 1, vcc
    s_add_u32 s40, s30, s95
    v_mov_b32 v72, s40
    s_waitcnt lgkmcnt(0)
    v_mov_b64 v[0:1], 0
    v_mov_b64 v[2:3], 0
    v_mov_b64 v[4:5], 0
    v_mov_b64 v[6:7], 0
    v_mov_b64 v[8:9], 0
    v_mov_b64 v[10:11], 0
    v_mov_b64 v[12:13], 0
    v_mov_b64 v[14:15], 0
    v_mov_b64 v[16:17], 0
    v_mov_b64 v[18:19], 0
    v_mov_b64 v[20:21], 0
    v_mov_b64 v[22:23], 0
    s_nop 2
    v_mov_b32 v79, v79
    s_nop 2
    v_mov_b32 v79, v79
    s_nop 2
    v_mov_b32 v79, v79
    s_nop 2
    v_mov_b32 v79, v79
    s_nop 2
    v_mov_b32 v79, v79
    s_nop 2
    v_mov_b32 v79, v79
    s_nop 2
    v_mov_b32 v79, v79
    s_nop 2
    v_mov_b32 v79, v79
    s_nop 2
    v_mov_b32 v79, v79
    s_nop 2
    v_mov_b32 v79, v79
    s_nop 2
    v_mov_b32 v79, v79
    s_nop 2
    v_mov_b32 v79, v79
    s_nop 2
    v_mov_b32 v79, v79
    s_nop 2
    v_mov_b32 v79, v79
    s_nop 2
    v_mov_b32 v79, v79
    s_nop 2
    v_mov_b32 v79, v79
    s_nop 2
    v_mov_b32 v79, v79
    s_nop 2
    v_mov_b32 v79, v79
    s_nop 2
    v_mov_b32 v79, v79
    s_nop 2
    v_mov_b32 v79, v79
    s_nop 2
    v_mov_b32 v79, v79
    s_nop 2
    v_mov_b32 v79, v79
    s_nop 2
    v_mov_b32 v79, v79
    s_nop 2
    v_mov_b32 v79, v79
    s_nop 2
    v_mov_b32 v79, v79
    s_nop 2
    v_mov_b32 v79, v79
    s_nop 2
    v_mov_b32 v79, v79
    s_nop 2
    v_mov_b32 v79, v79
    s_waitcnt vmcnt(0)
    s_branch cf_loop
cf_f0_retry:
cf_f0_spin:
    buffer_load_dwordx4 v[8:11], v65, s[4:7], s18 offen nt
    buffer_load_dwordx4 v[12:15], v65, s[4:7], s19 offen nt
    buffer_load_dwordx4 v[16:19], v65, s[4:7], s20 offen nt
    buffer_load_dwordx4 v[20:23], v65, s[4:7], s21 offen nt
    s_nop 2
    v_mov_b32 v79, v79
    s_nop 2
    v_mov_b32 v79, v79
    s_nop 2
    v_mov_b32 v79, v79
    s_nop 2
    v_mov_b32 v79, v79
    s_nop 2
    v_mov_b32 v79, v79
    s_nop 2
    v_mov_b32 v79, v79
    buffer_load_dwordx4 v[60:63], v65, s[4:7], s14 offen offset:0 nt
    buffer_load_dwordx4 v[56:59], v66, s[4:7], s14 offen offset:0 nt
    s_waitcnt vmcnt(5)
    v_xor_b32 v77, s69, v8
    v_mfma_f32_16x16x32_bf16 v[0:3], v[4:7], v[8:11], 0
    v_mov_b64 v[8:9], 0
    v_mov_b64 v[10:11], 0
    s_waitcnt vmcnt(4)
    v_bitop3_b32 v77, v77, v12, s69 bitop3:0xf6
    v_mfma_f32_16x16x32_bf16 v[0:3], v[4:7], v[12:15], v[0:3]
    v_mov_b64 v[12:13], 0
    v_mov_b64 v[14:15], 0
    s_waitcnt vmcnt(3)
    v_bitop3_b32 v77, v77, v16, s69 bitop3:0xf6
    v_mfma_f32_16x16x32_bf16 v[0:3], v[4:7], v[16:19], v[0:3]
    v_mov_b64 v[16:17], 0
    v_mov_b64 v[18:19], 0
    s_waitcnt vmcnt(2)
    v_bitop3_b32 v77, v77, v20, s69 bitop3:0xf6
    v_mfma_f32_16x16x32_bf16 v[0:3], v[4:7], v[20:23], v[0:3]
    v_and_b32 v77, 1, v77
    v_cmp_ne_u32 vcc, 0, v77
    v_mov_b64 v[20:21], 0
    v_mov_b64 v[22:23], 0
    buffer_load_dwordx4 v[60:63], v65, s[4:7], s14 offen offset:0 nt
    buffer_load_dwordx4 v[56:59], v66, s[4:7], s14 offen offset:0 nt
    s_cmp_eq_u64 vcc, 0
    s_cselect_b64 s[42:43], -1, 0
    v_add_f32_dpp v0, v0, v0 row_ror:8 row_mask:0xf bank_mask:0xf
    v_add_f32_dpp v1, v1, v1 row_ror:8 row_mask:0xf bank_mask:0xf
    s_mov_b64 exec, s[42:43]
    v_cvt_pk_bf16_f32 v72, v0, v1
    v_bfi_b32 v72, v79, s70, v72
    buffer_store_dword v72, v75, s[4:7], s17 offen offset:0
    s_mov_b64 exec, -1
    s_cbranch_scc1 cf_f0_rx
    s_sub_u32 s31, s31, 1
    s_cbranch_scc0 cf_f0_spin
cf_f0_rx:
    v_mov_b64 v[0:1], 0
    v_mov_b64 v[2:3], 0
    v_mov_b64 v[4:5], 0
    v_mov_b64 v[6:7], 0
    s_branch cf_loop
cf_f1_retry:
cf_f1_spin:
    s_nop 0
    buffer_load_dwordx4 v[8:11], v65, s[4:7], s18 offen nt
    buffer_load_dwordx4 v[12:15], v65, s[4:7], s19 offen nt
    buffer_load_dwordx4 v[16:19], v65, s[4:7], s20 offen nt
    buffer_load_dwordx4 v[20:23], v65, s[4:7], s21 offen nt
    s_nop 2
    v_mov_b32 v79, v79
    s_nop 2
    v_mov_b32 v79, v79
    s_nop 2
    v_mov_b32 v79, v79
    s_nop 2
    v_mov_b32 v79, v79
    s_nop 2
    v_mov_b32 v79, v79
    s_nop 2
    v_mov_b32 v79, v79
    buffer_load_dwordx4 v[60:63], v65, s[4:7], s14 offen offset:0 nt
    buffer_load_dwordx4 v[56:59], v66, s[4:7], s14 offen offset:0 nt
    s_waitcnt vmcnt(5)
    v_xor_b32 v77, s69, v8
    v_mfma_f32_16x16x32_bf16 v[0:3], v[4:7], v[8:11], 0
    v_mov_b64 v[8:9], 0
    v_mov_b64 v[10:11], 0
    s_waitcnt vmcnt(4)
    v_bitop3_b32 v77, v77, v12, s69 bitop3:0xf6
    v_mfma_f32_16x16x32_bf16 v[0:3], v[4:7], v[12:15], v[0:3]
    v_mov_b64 v[12:13], 0
    v_mov_b64 v[14:15], 0
    s_waitcnt vmcnt(3)
    v_bitop3_b32 v77, v77, v16, s69 bitop3:0xf6
    v_mfma_f32_16x16x32_bf16 v[0:3], v[4:7], v[16:19], v[0:3]
    v_mov_b64 v[16:17], 0
    v_mov_b64 v[18:19], 0
    s_waitcnt vmcnt(2)
    v_bitop3_b32 v77, v77, v20, s69 bitop3:0xf6
    v_mfma_f32_16x16x32_bf16 v[0:3], v[4:7], v[20:23], v[0:3]
    v_and_b32 v77, 1, v77
    v_cmp_ne_u32 vcc, 0, v77
    v_mov_b64 v[20:21], 0
    v_mov_b64 v[22:23], 0
    buffer_load_dwordx4 v[60:63], v65, s[4:7], s14 offen offset:0 nt
    buffer_load_dwordx4 v[56:59], v66, s[4:7], s14 offen offset:0 nt
    s_cmp_eq_u64 vcc, 0
    s_cselect_b64 s[42:43], -1, 0
    v_add_f32_dpp v0, v0, v0 row_ror:8 row_mask:0xf bank_mask:0xf
    v_add_f32_dpp v1, v1, v1 row_ror:8 row_mask:0xf bank_mask:0xf
    s_mov_b64 exec, s[42:43]
    v_cvt_pk_bf16_f32 v72, v0, v1
    v_bfi_b32 v72, v79, s70, v72
    buffer_store_dword v72, v75, s[4:7], s17 offen offset:0
    s_mov_b64 exec, -1
    s_cbranch_scc1 cf_f1_rx
    s_sub_u32 s31, s31, 1
    s_cbranch_scc0 cf_f1_spin
cf_f1_rx:
    v_mov_b64 v[0:1], 0
    v_mov_b64 v[2:3], 0
    v_mov_b64 v[4:5], 0
    v_mov_b64 v[6:7], 0
    s_branch cf_loop
cf_f2_retry:
cf_f2_spin:
    s_nop 0
    buffer_load_dwordx4 v[8:11], v65, s[4:7], s18 offen nt
    buffer_load_dwordx4 v[12:15], v65, s[4:7], s19 offen nt
    buffer_load_dwordx4 v[16:19], v65, s[4:7], s20 offen nt
    buffer_load_dwordx4 v[20:23], v65, s[4:7], s21 offen nt
    s_nop 2
    v_mov_b32 v79, v79
    s_nop 2
    v_mov_b32 v79, v79
    s_nop 2
    v_mov_b32 v79, v79
    s_nop 2
    v_mov_b32 v79, v79
    s_nop 2
    v_mov_b32 v79, v79
    s_nop 2
    v_mov_b32 v79, v79
    buffer_load_dwordx4 v[60:63], v65, s[4:7], s14 offen offset:0 nt
    buffer_load_dwordx4 v[56:59], v66, s[4:7], s14 offen offset:0 nt
    s_waitcnt vmcnt(5)
    v_xor_b32 v77, s69, v8
    v_bitop3_b32 v77, v77, v10, s69 bitop3:0xf6
    v_mfma_f32_16x16x32_bf16 v[0:3], v[4:7], v[8:11], 0
    v_mov_b64 v[8:9], 0
    v_mov_b64 v[10:11], 0
    s_waitcnt vmcnt(4)
    v_bitop3_b32 v77, v77, v12, s69 bitop3:0xf6
    v_bitop3_b32 v77, v77, v14, s69 bitop3:0xf6
    v_mfma_f32_16x16x32_bf16 v[0:3], v[4:7], v[12:15], v[0:3]
    v_mov_b64 v[12:13], 0
    v_mov_b64 v[14:15], 0
    s_waitcnt vmcnt(3)
    v_bitop3_b32 v77, v77, v16, s69 bitop3:0xf6
    v_bitop3_b32 v77, v77, v18, s69 bitop3:0xf6
    v_mfma_f32_16x16x32_bf16 v[0:3], v[4:7], v[16:19], v[0:3]
    v_mov_b64 v[16:17], 0
    v_mov_b64 v[18:19], 0
    s_waitcnt vmcnt(2)
    v_bitop3_b32 v77, v77, v20, s69 bitop3:0xf6
    v_bitop3_b32 v77, v77, v22, s69 bitop3:0xf6
    v_mfma_f32_16x16x32_bf16 v[0:3], v[4:7], v[20:23], v[0:3]
    v_and_b32 v77, 1, v77
    v_cmp_ne_u32 vcc, 0, v77
    v_mov_b64 v[20:21], 0
    v_mov_b64 v[22:23], 0
    buffer_load_dwordx4 v[60:63], v65, s[4:7], s14 offen offset:0 nt
    buffer_load_dwordx4 v[56:59], v66, s[4:7], s14 offen offset:0 nt
    s_cmp_eq_u64 vcc, 0
    s_cselect_b64 s[42:43], -1, 0
    v_add_f32 v2, v0, v1
    s_nop 1
    v_add_f32_dpp v2, v2, v2 row_ror:8 row_mask:0xf bank_mask:0xf
    s_nop 1
    v_mov_b32_dpp v0, v2 quad_perm:[0,0,2,2] row_mask:0xf bank_mask:0xf
    v_mov_b32_dpp v1, v2 quad_perm:[1,1,3,3] row_mask:0xf bank_mask:0xf
    s_mov_b64 exec, s[42:43]
    v_cvt_pk_bf16_f32 v72, v0, v1
    v_bfi_b32 v72, v79, s70, v72
    buffer_store_dword v72, v75, s[4:7], s17 offen offset:0
    buffer_store_dword v72, v75, s[4:7], s17 offen offset:1024
    buffer_store_dword v72, v75, s[4:7], s17 offen offset:2048
    buffer_store_dword v72, v75, s[4:7], s17 offen offset:3072
    s_mov_b64 exec, -1
    s_cbranch_scc1 cf_f2_rx
    s_sub_u32 s31, s31, 1
    s_cbranch_scc0 cf_f2_spin
cf_f2_rx:
    v_mov_b64 v[0:1], 0
    v_mov_b64 v[2:3], 0
    v_mov_b64 v[4:5], 0
    v_mov_b64 v[6:7], 0
    s_branch cf_loop
cf_spinB:
    buffer_load_dwordx4 v[40:43], v65, s[4:7], s15 offen nt
cf_spinB_l:
    v_and_b32 v77, s36, v40
    v_cmp_ne_u32 vcc, s70, v77
    s_cbranch_vccz cf_spinB_x
    s_nop 1
    v_and_b32 v77, s36, v40
    v_cmp_ne_u32 vcc, s70, v77
    s_cbranch_vccz cf_spinB_x
    s_nop 1
    v_and_b32 v77, s36, v40
    v_cmp_ne_u32 vcc, s70, v77
    s_cbranch_vccz cf_spinB_x
    s_nop 1
    buffer_load_dwordx4 v[40:43], v65, s[4:7], s15 offen nt
    s_sub_u32 s31, s31, 16
    s_cbranch_scc0 cf_spinB_l
cf_spinB_x:
    ds_write_b128 v65, v[40:43] offset:4096
    s_waitcnt lgkmcnt(0)
    s_branch cf_backB
cf_spin8:
    buffer_load_dwordx4 v[60:63], v65, s[4:7], s16 offen nt
cf_spin8_l:
    v_and_b32 v77, s36, v60
    v_cmp_ne_u32 vcc, s70, v77
    s_cbranch_vccz cf_spin8_x
    s_nop 1
    v_and_b32 v77, s36, v60
    v_cmp_ne_u32 vcc, s70, v77
    s_cbranch_vccz cf_spin8_x
    s_nop 1
    v_and_b32 v77, s36, v60
    v_cmp_ne_u32 vcc, s70, v77
    s_cbranch_vccz cf_spin8_x
    s_nop 1
    buffer_load_dwordx4 v[60:63], v65, s[4:7], s16 offen nt
    s_sub_u32 s31, s31, 16
    s_cbranch_scc0 cf_spin8_l
cf_spin8_x:
    s_branch cf_back8
cf_rare:
    s_cmp_lt_u32 s30, 58
    s_cbranch_scc1 cf_nopub
    s_mov_b64 exec, s[34:35]
    buffer_store_dwordx4 v[0:3], v65, s[4:7], s28 offen sc1
    s_mov_b64 exec, -1
    s_nop 3
    v_cvt_pk_bf16_f32 v48, v16, v17
    v_cvt_pk_bf16_f32 v49, v18, v19
    v_cvt_pk_bf16_f32 v50, v20, v21
    v_cvt_pk_bf16_f32 v51, v22, v23
    buffer_store_dwordx4 v[48:51], v65, s[4:7], s27 offen sc1
    s_add_u32 s28, s28, 131072
    s_add_u32 s27, s27, 131072
    s_cmp_eq_u32 s30, 63
    s_cbranch_scc1 cf_last
cf_nopub:
    s_cmp_ge_u32 s97, s93
    s_cbranch_scc1 cf_rare_x
    s_nop 1
    v_bfe_u32 v48, v65, 2, 8
    s_mov_b64 exec, 0xffff
    buffer_load_dword v48, s[4:7], s96 offen sc1 lds
    s_mov_b64 exec, -1
    s_branch cf_rare_x
cf_kvwait:
    v_bfe_u32 v78, v65, 2, 5
    ds_read_b32 v77, v78 offset:16144
    s_waitcnt lgkmcnt(0)
    v_subrev_u32 v77, s95, v77
    v_cmp_lt_u32 vcc, 16, v77
    s_nop 1
    v_cndmask_b32 v77, v77, 0, vcc
    v_bfe_u32 v79, v78, 2, 2
    v_lshl_add_u32 v77, v77, 2, v79
    s_nop 1
    v_min_u32_dpp v77, v77, v77 row_ror:1 row_mask:0xf bank_mask:0xf
    s_nop 1
    v_min_u32_dpp v77, v77, v77 row_ror:2 row_mask:0xf bank_mask:0xf
    s_nop 1
    v_min_u32_dpp v77, v77, v77 row_ror:4 row_mask:0xf bank_mask:0xf
    s_nop 0
    v_readfirstlane_b32 s97, v77
    s_nop 0
    s_cmp_le_u32 s40, s97
    s_cbranch_scc1 cf_kvw_x
    v_bfe_u32 v78, v65, 2, 5
    s_mov_b32 s31, 4194304
cf_kvw:
    buffer_load_dword v77, v78, s[4:7], s96 offen offset:16 sc1
    s_waitcnt vmcnt(0)
    v_subrev_u32 v77, s95, v77
    v_cmp_lt_u32 vcc, 16, v77
    s_nop 1
    v_cndmask_b32 v77, v77, 0, vcc
    v_bfe_u32 v79, v78, 2, 2
    v_lshl_add_u32 v77, v77, 2, v79
    s_nop 1
    v_min_u32_dpp v77, v77, v77 row_ror:1 row_mask:0xf bank_mask:0xf
    s_nop 1
    v_min_u32_dpp v77, v77, v77 row_ror:2 row_mask:0xf bank_mask:0xf
    s_nop 1
    v_min_u32_dpp v77, v77, v77 row_ror:4 row_mask:0xf bank_mask:0xf
    s_nop 0
    v_readfirstlane_b32 s97, v77
    s_sub_u32 s31, s31, 1
    s_cbranch_scc1 cf_kvw_x
    s_cmp_le_u32 s40, s97
    s_cbranch_scc1 cf_kvw_x
    s_sleep 2
    s_branch cf_kvw
cf_kvw_x:
    s_branch cf_kvok
cf_last:
    s_add_u32 s40, s95, 64
    v_mov_b32 v78, s40
    s_waitcnt vmcnt(0)
    s_barrier
    s_mov_b64 exec, s[100:101]
    buffer_store_dword v78, off, s[4:7], s29 sc1
    s_mov_b64 exec, -1
cf_end:
    s_endpgm
L_chain_safe:
    s_load_dwordx8 s[48:55], s[0:1], 8
    s_load_dwordx2 s[56:57], s[0:1], 40
    s_waitcnt lgkmcnt(0)
    v_lshrrev_b32 v77, 6, v0
    s_nop 0
    v_readfirstlane_b32 s13, v77
    v_lshlrev_b32 v65, 4, v0
    v_and_b32 v48, 63, v0
    s_mov_b32 s10, 4718592
    s_mov_b32 s11, 0x20000
    v_lshrrev_b32 v49, 3, v48
    v_mul_u32_u24 v18, 1152, v49
    v_and_b32 v49, 7, v48
    v_lshl_add_u32 v18, v49, 4, v18
    s_mul_i32 s40, s12, 147456
    s_lshl_b32 s41, s13, 8
    s_add_u32 s40, s40, s41
    s_mov_b32 s42, s40
    s_xor_b32 s41, s13, 0
    s_mul_i32 s41, s41, 36864
    s_add_u32 s60, s41, s40
    s_xor_b32 s41, s13, 1
    s_mul_i32 s41, s41, 36864
    s_add_u32 s61, s41, s40
    s_xor_b32 s41, s13, 2
    s_mul_i32 s41, s41, 36864
    s_add_u32 s62, s41, s40
    s_xor_b32 s41, s13, 3
    s_mul_i32 s41, s41, 36864
    s_add_u32 s63, s41, s40
    s_lshl_b32 s43, s13, 12
    s_mov_b64 s[8:9], s[56:57]
    s_add_u32 m0, s43, 0
    s_add_u32 s41, s60, 0
    buffer_load_dwordx4 v18, s[8:11], s41 offen offset:0 nt lds
    s_add_u32 s41, s60, 8192
    buffer_load_dwordx4 v18, s[8:11], s41 offen offset:1024 nt lds
    s_add_u32 s41, s60, 16384
    buffer_load_dwordx4 v18, s[8:11], s41 offen offset:2048 nt lds
    s_add_u32 s41, s60, 24576
    buffer_load_dwordx4 v18, s[8:11], s41 offen offset:3072 nt lds
    s_add_u32 m0, s43, 36864
    s_add_u32 s41, s61, 0
    buffer_load_dwordx4 v18, s[8:11], s41 offen offset:0 nt lds
    s_add_u32 s41, s61, 8192
    buffer_load_dwordx4 v18, s[8:11], s41 offen offset:1024 nt lds
    s_add_u32 s41, s61, 16384
    buffer_load_dwordx4 v18, s[8:11], s41 offen offset:2048 nt lds
    s_add_u32 s41, s61, 24576
    buffer_load_dwordx4 v18, s[8:11], s41 offen offset:3072 nt lds
    s_add_u32 m0, s43, 73728
    s_add_u32 s41, s62, 0
    buffer_load_dwordx4 v18, s[8:11], s41 offen offset:0 nt lds
    s_add_u32 s41, s62, 8192
    buffer_load_dwordx4 v18, s[8:11], s41 offen offset:1024 nt lds
    s_add_u32 s41, s62, 16384
    buffer_load_dwordx4 v18, s[8:11], s41 offen offset:2048 nt lds
    s_add_u32 s41, s62, 24576
    buffer_load_dwordx4 v18, s[8:11], s41 offen offset:3072 nt lds
    s_add_u32 m0, s43, 110592
    s_add_u32 s41, s63, 0
    buffer_load_dwordx4 v18, s[8:11], s41 offen offset:0 nt lds
    s_add_u32 s41, s63, 8192
    buffer_load_dwordx4 v18, s[8:11], s41 offen offset:1024 nt lds
    s_add_u32 s41, s63, 16384
    buffer_load_dwordx4 v18, s[8:11], s41 offen offset:2048 nt lds
    s_add_u32 s41, s63, 24576
    buffer_load_dwordx4 v18, s[8:11], s41 offen offset:3072 nt lds
    v_lshrrev_b32 v49, 1, v48
    v_mul_u32_u24 v19, 1152, v49
    v_and_b32 v49, 1, v48
    v_lshl_add_u32 v19, v49, 4, v19
    s_mul_i32 s41, s13, 224
    s_sub_u32 s41, 1024, s41
    v_add_u32 v19, s41, v19
    v_lshrrev_b32 v49, 4, v48
    v_lshlrev_b32 v50, 2, v49
    v_and_b32 v51, 15, v48
    v_xor_b32 v51, v51, v50
    v_lshlrev_b32 v51, 4, v51
    v_lshl_add_u32 v16, v49, 15, v51
    v_lshrrev_b32 v50, 1, v49
    v_lshl_add_u32 v17, v50, 16, v51
    v_and_b32 v50, 1, v49
    v_lshl_add_u32 v17, v50, 13, v17
    s_lshl_b32 s40, s12, 8
    s_mul_i32 s58, s13, 1048576
    s_add_u32 s58, s58, s40
    s_lshr_b32 s41, s13, 1
    s_mul_i32 s59, s41, 262144
    s_and_b32 s41, s13, 1
    s_lshl_b32 s41, s41, 14
    s_add_u32 s59, s59, s41
    s_add_u32 s59, s59, s40
    s_add_u32 s59, s59, 4194304
    v_bfe_u32 v50, v48, 2, 2
    v_xor_b32 v51, s13, v50
    v_lshlrev_b32 v20, 6, v51
    v_and_b32 v51, 3, v48
    v_lshl_add_u32 v20, v51, 4, v20
    v_lshrrev_b32 v23, 2, v48
    v_lshl_add_u32 v20, v23, 8, v20
    s_xor_b32 s41, s43, 0
    v_add_u32 v24, s41, v20
    s_xor_b32 s41, s43, 4096
    v_add_u32 v25, s41, v20
    s_xor_b32 s41, s43, 8192
    v_add_u32 v26, s41, v20
    s_xor_b32 s41, s43, 12288
    v_add_u32 v27, s41, v20
    v_and_b32 v23, 1, v50
    v_lshl_add_u32 v23, v49, 2, v23
    v_lshrrev_b32 v50, 1, v50
    v_lshlrev_b32 v21, 7, v23
    v_lshl_add_u32 v21, v50, 6, v21
    v_lshl_add_u32 v21, v51, 4, v21
    v_add_u32 v21, s43, v21
    v_lshlrev_b32 v22, 9, v50
    v_xor_b32 v22, v22, v21
    v_lshlrev_b32 v23, 5, v23
    v_lshl_add_u32 v23, v50, 10, v23
    v_lshl_add_u32 v23, v51, 3, v23
    v_add_u32 v23, s43, v23
    v_bfe_u32 v60, v65, 4, 6
    v_and_b32 v61, 15, v60
    v_lshrrev_b32 v62, 4, v60
    v_mov_b32 v64, 0x4444
    v_mov_b32 v77, 0xeeee
    v_cmp_lt_u32 vcc, 7, v61
    s_nop 1
    v_cndmask_b32 v64, v64, v77, vcc
    v_xor_b32 v66, 1024, v65
    v_xor_b32 v67, 2048, v65
    v_xor_b32 v68, 3072, v65
    v_and_b32 v69, 511, v65
    s_mul_i32 s96, s13, 36864
    s_add_u32 s96, s96, 16384
    v_lshlrev_b32 v70, 4, v60
    v_add_u32 v70, s96, v70
    v_lshrrev_b32 v79, 1, v69
    s_lshl_b32 s96, s13, 8
    s_add_u32 s96, s96, 14336
    s_lshl_b32 s33, s13, 10
    s_add_u32 s97, s33, 8192
    v_mov_b32 v77, s97
    v_mov_b32 v78, s96
    v_cmp_lt_u32 vcc, 31, v60
    s_nop 1
    v_cndmask_b32 v71, v77, v78, vcc
    v_add_u32 v71, v71, v79
    v_and_b32 v77, 7, v61
    v_lshrrev_b32 v78, 3, v61
    v_lshlrev_b32 v74, 4, v77
    v_lshl_add_u32 v73, v62, 7, v74
    v_lshl_add_u32 v73, v78, 3, v73
    s_lshl_b32 s96, s13, 9
    v_add_u32 v73, s96, v73
    v_lshl_add_u32 v74, v78, 14, v74
    v_lshl_add_u32 v74, v62, 15, v74
    s_lshl_b32 s96, s13, 17
    v_add_u32 v74, s96, v74
    v_bfe_u32 v77, v61, 2, 1
    v_and_b32 v78, 3, v61
    v_bfe_u32 v79, v61, 1, 2
    s_cmp_lt_u32 s13, 2
    s_cselect_b64 vcc, -1, 0
    v_cndmask_b32 v77, 0, v77, vcc
    v_cndmask_b32 v78, v79, v78, vcc
    v_lshlrev_b32 v75, 7, v77
    v_lshl_add_u32 v75, v62, 4, v75
    v_lshl_add_u32 v75, v78, 2, v75
    v_lshl_add_u32 v58, v77, 3, v78
    v_lshlrev_b32 v79, 1, v78
    v_cndmask_b32 v58, v79, v58, vcc
    s_bfe_u32 s97, s12, 0x10001
    s_lshl_b32 s68, s97, 6
    s_lshl_b32 s97, s97, 2
    v_add_u32 v59, s97, v62
    s_bfe_u32 s96, s12, 0x10002
    s_and_b32 s40, s12, 1
    s_lshl_b32 s96, s96, 1
    s_add_u32 s96, s96, s40
    s_lshr_b32 s97, s12, 3
    s_lshl_b32 s98, s13, 2
    s_add_u32 s98, s98, s97
    s_lshl_b32 s98, s98, 2
    s_add_u32 s98, s98, s96
    s_lshl_b32 s98, s98, 8
    s_lshl_b32 s99, s13, 2
    s_add_u32 s99, s99, s96
    s_lshl_b32 s99, s99, 4
    s_lshl_b32 s41, s97, 1
    s_add_u32 s41, s41, s40
    s_lshl_b32 s41, s41, 7
    s_add_u32 s41, s41, 8192
    s_lshl_b32 s40, s40, 3
    s_add_u32 s40, s40, 512
    s_cmp_lt_u32 s13, 2
    s_cselect_b32 s96, 7, 4
    s_cselect_b32 s98, s98, s41
    s_cselect_b32 s99, s99, s40
    s_cselect_b32 s32, 1, 0
    s_add_u32 s68, s68, s98
    s_lshl_b32 s97, s97, s96
    s_add_u32 s99, s99, s97
    v_add_u32 v58, s99, v58
    s_and_b32 s97, s12, 4
    s_or_b32 s97, s97, s13
    s_cmp_eq_u32 s97, 2
    s_cselect_b32 s32, 2, s32
    s_mov_b32 s8, s48
    s_mov_b32 s9, s49
    s_mov_b32 s10, 9216
    s_cmp_lt_u32 s13, 2
    s_cselect_b32 s96, 8, 2
    v_mul_u32_u24 v77, 1152, v59
    v_lshl_add_u32 v77, v58, 1, v77
    buffer_load_ushort v72, v77, s[8:11], 0 offen
    buffer_load_ushort v76, v77, s[8:11], s96 offen
    s_mov_b32 s10, 4718592
    s_waitcnt vmcnt(12) lgkmcnt(0)
    s_barrier
    s_mov_b64 s[8:9], s[56:57]
    s_add_u32 m0, s43, 147456
    s_add_u32 s41, s42, 0
    buffer_load_dwordx4 v19, s[8:11], s41 offen offset:0 nt lds
    s_add_u32 s41, s42, 35840
    buffer_load_dwordx4 v19, s[8:11], s41 offen offset:1024 nt lds
    s_add_u32 s41, s42, 71680
    buffer_load_dwordx4 v19, s[8:11], s41 offen offset:2048 nt lds
    s_add_u32 s41, s42, 107520
    buffer_load_dwordx4 v19, s[8:11], s41 offen offset:3072 nt lds
    v_mov_b32 v78, v21
    v_mov_b32 v79, v22
    v_add_u32 v77, 0, v79
    ds_read_b64_tr_b16 v[80:81], v77 offset:0
    ds_read_b64_tr_b16 v[82:83], v77 offset:256
    ds_read_b64_tr_b16 v[84:85], v77 offset:2048
    ds_read_b64_tr_b16 v[86:87], v77 offset:2304
    ds_read_b64_tr_b16 v[112:113], v77 offset:8
    ds_read_b64_tr_b16 v[114:115], v77 offset:264
    ds_read_b64_tr_b16 v[116:117], v77 offset:2056
    ds_read_b64_tr_b16 v[118:119], v77 offset:2312
    s_waitcnt vmcnt(12) lgkmcnt(0)
    s_barrier
    s_mov_b64 s[8:9], s[52:53]
    s_add_u32 m0, s43, 0
    s_add_u32 s41, s58, 0
    buffer_load_dwordx4 v16, s[8:11], s41 offen offset:0 nt lds
    s_add_u32 s41, s58, 15360
    buffer_load_dwordx4 v16, s[8:11], s41 offen offset:1024 nt lds
    s_add_u32 s41, s58, 129024
    buffer_load_dwordx4 v16, s[8:11], s41 offen offset:2048 nt lds
    s_add_u32 s41, s58, 144384
    buffer_load_dwordx4 v16, s[8:11], s41 offen offset:3072 nt lds
    v_add_u32 v77, 36864, v78
    ds_read_b64_tr_b16 v[88:89], v77 offset:0
    ds_read_b64_tr_b16 v[90:91], v77 offset:256
    ds_read_b64_tr_b16 v[92:93], v77 offset:2048
    ds_read_b64_tr_b16 v[94:95], v77 offset:2304
    ds_read_b64_tr_b16 v[120:121], v77 offset:8
    ds_read_b64_tr_b16 v[122:123], v77 offset:264
    ds_read_b64_tr_b16 v[124:125], v77 offset:2056
    ds_read_b64_tr_b16 v[126:127], v77 offset:2312
    s_waitcnt vmcnt(12) lgkmcnt(0)
    s_barrier
    s_add_u32 m0, s43, 36864
    s_add_u32 s41, s58, 8192
    buffer_load_dwordx4 v16, s[8:11], s41 offen offset:0 nt lds
    s_add_u32 s41, s58, 23552
    buffer_load_dwordx4 v16, s[8:11], s41 offen offset:1024 nt lds
    s_add_u32 s41, s58, 137216
    buffer_load_dwordx4 v16, s[8:11], s41 offen offset:2048 nt lds
    s_add_u32 s41, s58, 152576
    buffer_load_dwordx4 v16, s[8:11], s41 offen offset:3072 nt lds
    v_add_u32 v77, 73728, v78
    ds_read_b64_tr_b16 v[96:97], v77 offset:0
    ds_read_b64_tr_b16 v[98:99], v77 offset:256
    ds_read_b64_tr_b16 v[100:101], v77 offset:2048
    ds_read_b64_tr_b16 v[102:103], v77 offset:2304
    ds_read_b64_tr_b16 v[128:129], v77 offset:8
    ds_read_b64_tr_b16 v[130:131], v77 offset:264
    ds_read_b64_tr_b16 v[132:133], v77 offset:2056
    ds_read_b64_tr_b16 v[134:135], v77 offset:2312
    s_waitcnt vmcnt(12) lgkmcnt(0)
    s_barrier
    s_add_u32 m0, s43, 73728
    s_add_u32 s41, s58, 262144
    buffer_load_dwordx4 v16, s[8:11], s41 offen offset:0 nt lds
    s_add_u32 s41, s58, 277504
    buffer_load_dwordx4 v16, s[8:11], s41 offen offset:1024 nt lds
    s_add_u32 s41, s58, 391168
    buffer_load_dwordx4 v16, s[8:11], s41 offen offset:2048 nt lds
    s_add_u32 s41, s58, 406528
    buffer_load_dwordx4 v16, s[8:11], s41 offen offset:3072 nt lds
    v_add_u32 v77, 110592, v78
    ds_read_b64_tr_b16 v[104:105], v77 offset:0
    ds_read_b64_tr_b16 v[106:107], v77 offset:256
    ds_read_b64_tr_b16 v[108:109], v77 offset:2048
    ds_read_b64_tr_b16 v[110:111], v77 offset:2304
    ds_read_b64_tr_b16 v[136:137], v77 offset:8
    ds_read_b64_tr_b16 v[138:139], v77 offset:264
    ds_read_b64_tr_b16 v[140:141], v77 offset:2056
    ds_read_b64_tr_b16 v[142:143], v77 offset:2312
    s_waitcnt vmcnt(12) lgkmcnt(0)
    s_barrier
    s_add_u32 m0, s43, 110592
    s_add_u32 s41, s58, 270336
    buffer_load_dwordx4 v16, s[8:11], s41 offen offset:0 nt lds
    s_add_u32 s41, s58, 285696
    buffer_load_dwordx4 v16, s[8:11], s41 offen offset:1024 nt lds
    s_add_u32 s41, s58, 399360
    buffer_load_dwordx4 v16, s[8:11], s41 offen offset:2048 nt lds
    s_add_u32 s41, s58, 414720
    buffer_load_dwordx4 v16, s[8:11], s41 offen offset:3072 nt lds
    v_add_u32 v77, 147456, v23
    ds_read_b64_tr_b16 v[144:145], v77 offset:0
    ds_read_b64_tr_b16 v[146:147], v77 offset:64
    ds_read_b64_tr_b16 v[148:149], v77 offset:512
    ds_read_b64_tr_b16 v[150:151], v77 offset:576
    ds_read_b64_tr_b16 v[152:153], v77 offset:2048
    ds_read_b64_tr_b16 v[154:155], v77 offset:2112
    ds_read_b64_tr_b16 v[156:157], v77 offset:2560
    ds_read_b64_tr_b16 v[158:159], v77 offset:2624
    s_waitcnt vmcnt(12) lgkmcnt(0)
    s_barrier
    s_add_u32 m0, s43, 147456
    s_add_u32 s41, s58, 524288
    buffer_load_dwordx4 v16, s[8:11], s41 offen offset:0 nt lds
    s_add_u32 s41, s58, 539648
    buffer_load_dwordx4 v16, s[8:11], s41 offen offset:1024 nt lds
    s_add_u32 s41, s58, 653312
    buffer_load_dwordx4 v16, s[8:11], s41 offen offset:2048 nt lds
    s_add_u32 s41, s58, 668672
    buffer_load_dwordx4 v16, s[8:11], s41 offen offset:3072 nt lds
    s_cmp_eq_u32 s32, 0
    s_cbranch_scc1 cs_init_done
    v_mov_b32 v52, 1
    v_mov_b32 v53, 1
    v_mov_b32 v54, 1
    v_mov_b32 v55, 1
    v_mov_b32 v56, 0
    v_lshl_or_b32 v72, v76, 16, v72
    s_lshl_b32 s96, s12, 14
    s_add_u32 s96, s96, 68681728
    s_add_u32 s97, s96, 0
    buffer_store_dwordx4 v[52:55], v65, s[4:7], s97 offen sc1
    s_add_u32 s97, s96, 4096
    buffer_store_dwordx4 v[52:55], v65, s[4:7], s97 offen sc1
    s_add_u32 s97, s96, 8192
    buffer_store_dwordx4 v[52:55], v65, s[4:7], s97 offen sc1
    s_add_u32 s97, s96, 12288
    buffer_store_dwordx4 v[52:55], v65, s[4:7], s97 offen sc1
    s_add_u32 s96, s68, 67633152
    s_add_u32 s97, s96, 16384
    buffer_store_dword v56, v75, s[4:7], s96 offen offset:0 sc1
    buffer_store_dword v72, v75, s[4:7], s97 offen offset:0 sc1
    s_cmp_lg_u32 s32, 2
    s_cbranch_scc1 cs_init_done
    buffer_store_dword v56, v75, s[4:7], s96 offen offset:1024 sc1
    buffer_store_dword v72, v75, s[4:7], s97 offen offset:1024 sc1
    buffer_store_dword v56, v75, s[4:7], s96 offen offset:2048 sc1
    buffer_store_dword v72, v75, s[4:7], s97 offen offset:2048 sc1
    buffer_store_dword v56, v75, s[4:7], s96 offen offset:3072 sc1
    buffer_store_dword v72, v75, s[4:7], s97 offen offset:3072 sc1
cs_init_done:
    v_add_u32 v28, 0, v24
    v_add_u32 v29, 0, v25
    v_add_u32 v30, 0, v26
    v_add_u32 v31, 0, v27
    ds_read_b64_tr_b16 a[96:97], v28 offset:0
    ds_read_b64_tr_b16 a[104:105], v28 offset:8
    ds_read_b64_tr_b16 a[112:113], v29 offset:0
    ds_read_b64_tr_b16 a[120:121], v29 offset:8
    ds_read_b64_tr_b16 a[128:129], v30 offset:0
    ds_read_b64_tr_b16 a[136:137], v30 offset:8
    ds_read_b64_tr_b16 a[144:145], v31 offset:0
    ds_read_b64_tr_b16 v[32:33], v31 offset:8
    s_waitcnt vmcnt(12) lgkmcnt(0)
    s_barrier
    s_add_u32 m0, s43, 0
    s_add_u32 s41, s58, 532480
    buffer_load_dwordx4 v16, s[8:11], s41 offen offset:0 nt lds
    s_add_u32 s41, s58, 547840
    buffer_load_dwordx4 v16, s[8:11], s41 offen offset:1024 nt lds
    s_add_u32 s41, s58, 661504
    buffer_load_dwordx4 v16, s[8:11], s41 offen offset:2048 nt lds
    s_add_u32 s41, s58, 676864
    buffer_load_dwordx4 v16, s[8:11], s41 offen offset:3072 nt lds
    ds_write_b64 v70, v[32:33] offset:12288
    v_add_u32 v28, 36864, v24
    v_add_u32 v29, 36864, v25
    v_add_u32 v30, 36864, v26
    v_add_u32 v31, 36864, v27
    ds_read_b64_tr_b16 a[98:99], v28 offset:0
    ds_read_b64_tr_b16 a[106:107], v28 offset:8
    ds_read_b64_tr_b16 a[114:115], v29 offset:0
    ds_read_b64_tr_b16 a[122:123], v29 offset:8
    ds_read_b64_tr_b16 a[130:131], v30 offset:0
    ds_read_b64_tr_b16 a[138:139], v30 offset:8
    ds_read_b64_tr_b16 a[146:147], v31 offset:0
    ds_read_b64_tr_b16 v[0:1], v31 offset:8
    s_waitcnt vmcnt(12) lgkmcnt(0)
    s_barrier
    s_add_u32 m0, s43, 36864
    s_add_u32 s41, s58, 786432
    buffer_load_dwordx4 v16, s[8:11], s41 offen offset:0 nt lds
    s_add_u32 s41, s58, 801792
    buffer_load_dwordx4 v16, s[8:11], s41 offen offset:1024 nt lds
    s_add_u32 s41, s58, 915456
    buffer_load_dwordx4 v16, s[8:11], s41 offen offset:2048 nt lds
    s_add_u32 s41, s58, 930816
    buffer_load_dwordx4 v16, s[8:11], s41 offen offset:3072 nt lds
    ds_write_b64 v70, v[0:1] offset:12296
    v_add_u32 v28, 73728, v24
    v_add_u32 v29, 73728, v25
    v_add_u32 v30, 73728, v26
    v_add_u32 v31, 73728, v27
    ds_read_b64_tr_b16 a[100:101], v28 offset:0
    ds_read_b64_tr_b16 a[108:109], v28 offset:8
    ds_read_b64_tr_b16 a[116:117], v29 offset:0
    ds_read_b64_tr_b16 a[124:125], v29 offset:8
    ds_read_b64_tr_b16 a[132:133], v30 offset:0
    ds_read_b64_tr_b16 a[140:141], v30 offset:8
    ds_read_b64_tr_b16 a[148:149], v31 offset:0
    ds_read_b64_tr_b16 v[32:33], v31 offset:8
    s_waitcnt vmcnt(12) lgkmcnt(0)
    s_barrier
    s_add_u32 m0, s43, 73728
    s_add_u32 s41, s58, 794624
    buffer_load_dwordx4 v16, s[8:11], s41 offen offset:0 nt lds
    s_add_u32 s41, s58, 809984
    buffer_load_dwordx4 v16, s[8:11], s41 offen offset:1024 nt lds
    s_add_u32 s41, s58, 923648
    buffer_load_dwordx4 v16, s[8:11], s41 offen offset:2048 nt lds
    s_add_u32 s41, s58, 939008
    buffer_load_dwordx4 v16, s[8:11], s41 offen offset:3072 nt lds
    ds_write_b64 v70, v[32:33] offset:13312
    v_add_u32 v28, 110592, v24
    v_add_u32 v29, 110592, v25
    v_add_u32 v30, 110592, v26
    v_add_u32 v31, 110592, v27
    ds_read_b64_tr_b16 a[102:103], v28 offset:0
    ds_read_b64_tr_b16 a[110:111], v28 offset:8
    ds_read_b64_tr_b16 a[118:119], v29 offset:0
    ds_read_b64_tr_b16 a[126:127], v29 offset:8
    ds_read_b64_tr_b16 a[134:135], v30 offset:0
    ds_read_b64_tr_b16 a[142:143], v30 offset:8
    ds_read_b64_tr_b16 a[150:151], v31 offset:0
    ds_read_b64_tr_b16 v[0:1], v31 offset:8
    s_waitcnt vmcnt(12) lgkmcnt(0)
    s_barrier
    s_add_u32 m0, s43, 110592
    s_add_u32 s41, s59, 0
    buffer_load_dwordx4 v17, s[8:11], s41 offen offset:0 nt lds
    s_add_u32 s41, s59, 31744
    buffer_load_dwordx4 v17, s[8:11], s41 offen offset:1024 nt lds
    s_add_u32 s41, s59, 129024
    buffer_load_dwordx4 v17, s[8:11], s41 offen offset:2048 nt lds
    s_add_u32 s41, s59, 160768
    buffer_load_dwordx4 v17, s[8:11], s41 offen offset:3072 nt lds
    ds_write_b64 v70, v[0:1] offset:13320
    v_add_u32 v28, 147456, v24
    v_add_u32 v29, 147456, v25
    v_add_u32 v30, 147456, v26
    v_add_u32 v31, 147456, v27
    ds_read_b64_tr_b16 a[152:153], v28 offset:0
    ds_read_b64_tr_b16 a[160:161], v28 offset:8
    ds_read_b64_tr_b16 v[32:33], v29 offset:0
    ds_read_b64_tr_b16 a[168:169], v29 offset:8
    ds_read_b64_tr_b16 a[176:177], v30 offset:0
    ds_read_b64_tr_b16 a[184:185], v30 offset:8
    ds_read_b64_tr_b16 v[34:35], v31 offset:0
    ds_read_b64_tr_b16 a[192:193], v31 offset:8
    s_waitcnt vmcnt(12) lgkmcnt(0)
    s_barrier
    s_mov_b64 s[8:9], s[50:51]
    s_add_u32 m0, s43, 147456
    s_add_u32 s41, s58, 0
    buffer_load_dwordx4 v16, s[8:11], s41 offen offset:0 nt lds
    s_add_u32 s41, s58, 15360
    buffer_load_dwordx4 v16, s[8:11], s41 offen offset:1024 nt lds
    s_add_u32 s41, s58, 129024
    buffer_load_dwordx4 v16, s[8:11], s41 offen offset:2048 nt lds
    s_add_u32 s41, s58, 144384
    buffer_load_dwordx4 v16, s[8:11], s41 offen offset:3072 nt lds
    ds_write_b64 v70, v[32:33] offset:16384
    ds_write_b64 v70, v[34:35] offset:18432
    v_add_u32 v28, 0, v24
    v_add_u32 v29, 0, v25
    v_add_u32 v30, 0, v26
    v_add_u32 v31, 0, v27
    ds_read_b64_tr_b16 a[154:155], v28 offset:0
    ds_read_b64_tr_b16 a[162:163], v28 offset:8
    ds_read_b64_tr_b16 v[0:1], v29 offset:0
    ds_read_b64_tr_b16 a[170:171], v29 offset:8
    ds_read_b64_tr_b16 a[178:179], v30 offset:0
    ds_read_b64_tr_b16 a[186:187], v30 offset:8
    ds_read_b64_tr_b16 v[2:3], v31 offset:0
    ds_read_b64_tr_b16 a[194:195], v31 offset:8
    s_waitcnt vmcnt(12) lgkmcnt(0)
    s_barrier
    s_add_u32 m0, s43, 0
    s_add_u32 s41, s58, 8192
    buffer_load_dwordx4 v16, s[8:11], s41 offen offset:0 nt lds
    s_add_u32 s41, s58, 23552
    buffer_load_dwordx4 v16, s[8:11], s41 offen offset:1024 nt lds
    s_add_u32 s41, s58, 137216
    buffer_load_dwordx4 v16, s[8:11], s41 offen offset:2048 nt lds
    s_add_u32 s41, s58, 152576
    buffer_load_dwordx4 v16, s[8:11], s41 offen offset:3072 nt lds
    ds_write_b64 v70, v[0:1] offset:16392
    ds_write_b64 v70, v[2:3] offset:18440
    v_add_u32 v28, 36864, v24
    v_add_u32 v29, 36864, v25
    v_add_u32 v30, 36864, v26
    v_add_u32 v31, 36864, v27
    ds_read_b64_tr_b16 a[156:157], v28 offset:0
    ds_read_b64_tr_b16 a[164:165], v28 offset:8
    ds_read_b64_tr_b16 v[32:33], v29 offset:0
    ds_read_b64_tr_b16 a[172:173], v29 offset:8
    ds_read_b64_tr_b16 a[180:181], v30 offset:0
    ds_read_b64_tr_b16 a[188:189], v30 offset:8
    ds_read_b64_tr_b16 v[34:35], v31 offset:0
    ds_read_b64_tr_b16 a[196:197], v31 offset:8
    s_waitcnt vmcnt(12) lgkmcnt(0)
    s_barrier
    s_add_u32 m0, s43, 36864
    s_add_u32 s41, s58, 262144
    buffer_load_dwordx4 v16, s[8:11], s41 offen offset:0 nt lds
    s_add_u32 s41, s58, 277504
    buffer_load_dwordx4 v16, s[8:11], s41 offen offset:1024 nt lds
    s_add_u32 s41, s58, 391168
    buffer_load_dwordx4 v16, s[8:11], s41 offen offset:2048 nt lds
    s_add_u32 s41, s58, 406528
    buffer_load_dwordx4 v16, s[8:11], s41 offen offset:3072 nt lds
    ds_write_b64 v70, v[32:33] offset:17408
    ds_write_b64 v70, v[34:35] offset:19456
    v_add_u32 v28, 73728, v24
    v_add_u32 v29, 73728, v25
    v_add_u32 v30, 73728, v26
    v_add_u32 v31, 73728, v27
    ds_read_b64_tr_b16 a[158:159], v28 offset:0
    ds_read_b64_tr_b16 a[166:167], v28 offset:8
    ds_read_b64_tr_b16 v[0:1], v29 offset:0
    ds_read_b64_tr_b16 a[174:175], v29 offset:8
    ds_read_b64_tr_b16 a[182:183], v30 offset:0
    ds_read_b64_tr_b16 a[190:191], v30 offset:8
    ds_read_b64_tr_b16 v[2:3], v31 offset:0
    ds_read_b64_tr_b16 a[198:199], v31 offset:8
    s_waitcnt vmcnt(12) lgkmcnt(0)
    s_barrier
    s_add_u32 m0, s43, 73728
    s_add_u32 s41, s58, 270336
    buffer_load_dwordx4 v16, s[8:11], s41 offen offset:0 nt lds
    s_add_u32 s41, s58, 285696
    buffer_load_dwordx4 v16, s[8:11], s41 offen offset:1024 nt lds
    s_add_u32 s41, s58, 399360
    buffer_load_dwordx4 v16, s[8:11], s41 offen offset:2048 nt lds
    s_add_u32 s41, s58, 414720
    buffer_load_dwordx4 v16, s[8:11], s41 offen offset:3072 nt lds
    ds_write_b64 v70, v[0:1] offset:17416
    ds_write_b64 v70, v[2:3] offset:19464
    v_add_u32 v77, 110592, v20
    ds_read_b64_tr_b16 a[200:201], v77 offset:0
    ds_read_b64_tr_b16 a[202:203], v77 offset:4096
    ds_read_b64_tr_b16 a[204:205], v77 offset:8192
    ds_read_b64_tr_b16 a[206:207], v77 offset:12288
    ds_read_b64_tr_b16 a[208:209], v77 offset:8
    ds_read_b64_tr_b16 a[210:211], v77 offset:4104
    ds_read_b64_tr_b16 a[212:213], v77 offset:8200
    ds_read_b64_tr_b16 a[214:215], v77 offset:12296
    s_waitcnt vmcnt(12) lgkmcnt(0)
    s_barrier
    s_add_u32 m0, s43, 110592
    s_add_u32 s41, s58, 524288
    buffer_load_dwordx4 v16, s[8:11], s41 offen offset:0 nt lds
    s_add_u32 s41, s58, 539648
    buffer_load_dwordx4 v16, s[8:11], s41 offen offset:1024 nt lds
    s_add_u32 s41, s58, 653312
    buffer_load_dwordx4 v16, s[8:11], s41 offen offset:2048 nt lds
    s_add_u32 s41, s58, 668672
    buffer_load_dwordx4 v16, s[8:11], s41 offen offset:3072 nt lds
    v_add_u32 v28, 147456, v24
    v_add_u32 v29, 147456, v25
    v_add_u32 v30, 147456, v26
    v_add_u32 v31, 147456, v27
    ds_read_b64_tr_b16 v[0:1], v28 offset:0
    ds_read_b64_tr_b16 v[2:3], v28 offset:8
    ds_read_b64_tr_b16 v[4:5], v29 offset:0
    ds_read_b64_tr_b16 v[6:7], v29 offset:8
    ds_read_b64_tr_b16 a[0:1], v30 offset:0
    ds_read_b64_tr_b16 v[8:9], v30 offset:8
    ds_read_b64_tr_b16 a[8:9], v31 offset:0
    ds_read_b64_tr_b16 v[10:11], v31 offset:8
    s_waitcnt vmcnt(12) lgkmcnt(0)
    s_barrier
    s_add_u32 m0, s43, 147456
    s_add_u32 s41, s58, 532480
    buffer_load_dwordx4 v16, s[8:11], s41 offen offset:0 nt lds
    s_add_u32 s41, s58, 547840
    buffer_load_dwordx4 v16, s[8:11], s41 offen offset:1024 nt lds
    s_add_u32 s41, s58, 661504
    buffer_load_dwordx4 v16, s[8:11], s41 offen offset:2048 nt lds
    s_add_u32 s41, s58, 676864
    buffer_load_dwordx4 v16, s[8:11], s41 offen offset:3072 nt lds
    ds_write_b64 v70, v[0:1] offset:0
    ds_write_b64 v70, v[2:3] offset:2048
    ds_write_b64 v70, v[4:5] offset:4096
    ds_write_b64 v70, v[6:7] offset:6144
    ds_write_b64 v70, v[8:9] offset:10240
    ds_write_b64 v70, v[10:11] offset:14336
    v_add_u32 v28, 0, v24
    v_add_u32 v29, 0, v25
    v_add_u32 v30, 0, v26
    v_add_u32 v31, 0, v27
    ds_read_b64_tr_b16 v[32:33], v28 offset:0
    ds_read_b64_tr_b16 v[34:35], v28 offset:8
    ds_read_b64_tr_b16 v[36:37], v29 offset:0
    ds_read_b64_tr_b16 v[38:39], v29 offset:8
    ds_read_b64_tr_b16 a[2:3], v30 offset:0
    ds_read_b64_tr_b16 v[40:41], v30 offset:8
    ds_read_b64_tr_b16 a[10:11], v31 offset:0
    ds_read_b64_tr_b16 v[42:43], v31 offset:8
    s_waitcnt vmcnt(12) lgkmcnt(0)
    s_barrier
    s_add_u32 m0, s43, 0
    s_add_u32 s41, s58, 786432
    buffer_load_dwordx4 v16, s[8:11], s41 offen offset:0 nt lds
    s_add_u32 s41, s58, 801792
    buffer_load_dwordx4 v16, s[8:11], s41 offen offset:1024 nt lds
    s_add_u32 s41, s58, 915456
    buffer_load_dwordx4 v16, s[8:11], s41 offen offset:2048 nt lds
    s_add_u32 s41, s58, 930816
    buffer_load_dwordx4 v16, s[8:11], s41 offen offset:3072 nt lds
    ds_write_b64 v70, v[32:33] offset:8
    ds_write_b64 v70, v[34:35] offset:2056
    ds_write_b64 v70, v[36:37] offset:4104
    ds_write_b64 v70, v[38:39] offset:6152
    ds_write_b64 v70, v[40:41] offset:10248
    ds_write_b64 v70, v[42:43] offset:14344
    v_add_u32 v28, 36864, v24
    v_add_u32 v29, 36864, v25
    v_add_u32 v30, 36864, v26
    v_add_u32 v31, 36864, v27
    ds_read_b64_tr_b16 v[0:1], v28 offset:0
    ds_read_b64_tr_b16 v[2:3], v28 offset:8
    ds_read_b64_tr_b16 v[4:5], v29 offset:0
    ds_read_b64_tr_b16 v[6:7], v29 offset:8
    ds_read_b64_tr_b16 a[4:5], v30 offset:0
    ds_read_b64_tr_b16 v[8:9], v30 offset:8
    ds_read_b64_tr_b16 a[12:13], v31 offset:0
    ds_read_b64_tr_b16 v[10:11], v31 offset:8
    s_waitcnt vmcnt(12) lgkmcnt(0)
    s_barrier
    s_add_u32 m0, s43, 36864
    s_add_u32 s41, s58, 794624
    buffer_load_dwordx4 v16, s[8:11], s41 offen offset:0 nt lds
    s_add_u32 s41, s58, 809984
    buffer_load_dwordx4 v16, s[8:11], s41 offen offset:1024 nt lds
    s_add_u32 s41, s58, 923648
    buffer_load_dwordx4 v16, s[8:11], s41 offen offset:2048 nt lds
    s_add_u32 s41, s58, 939008
    buffer_load_dwordx4 v16, s[8:11], s41 offen offset:3072 nt lds
    ds_write_b64 v70, v[0:1] offset:1024
    ds_write_b64 v70, v[2:3] offset:3072
    ds_write_b64 v70, v[4:5] offset:5120
    ds_write_b64 v70, v[6:7] offset:7168
    ds_write_b64 v70, v[8:9] offset:11264
    ds_write_b64 v70, v[10:11] offset:15360
    v_add_u32 v28, 73728, v24
    v_add_u32 v29, 73728, v25
    v_add_u32 v30, 73728, v26
    v_add_u32 v31, 73728, v27
    ds_read_b64_tr_b16 v[32:33], v28 offset:0
    ds_read_b64_tr_b16 v[34:35], v28 offset:8
    ds_read_b64_tr_b16 v[36:37], v29 offset:0
    ds_read_b64_tr_b16 v[38:39], v29 offset:8
    ds_read_b64_tr_b16 a[6:7], v30 offset:0
    ds_read_b64_tr_b16 v[40:41], v30 offset:8
    ds_read_b64_tr_b16 a[14:15], v31 offset:0
    ds_read_b64_tr_b16 v[42:43], v31 offset:8
    s_waitcnt vmcnt(12) lgkmcnt(0)
    s_barrier
    s_add_u32 m0, s43, 73728
    s_add_u32 s41, s59, 0
    buffer_load_dwordx4 v17, s[8:11], s41 offen offset:0 nt lds
    s_add_u32 s41, s59, 31744
    buffer_load_dwordx4 v17, s[8:11], s41 offen offset:1024 nt lds
    s_add_u32 s41, s59, 129024
    buffer_load_dwordx4 v17, s[8:11], s41 offen offset:2048 nt lds
    s_add_u32 s41, s59, 160768
    buffer_load_dwordx4 v17, s[8:11], s41 offen offset:3072 nt lds
    ds_write_b64 v70, v[32:33] offset:1032
    ds_write_b64 v70, v[34:35] offset:3080
    ds_write_b64 v70, v[36:37] offset:5128
    ds_write_b64 v70, v[38:39] offset:7176
    ds_write_b64 v70, v[40:41] offset:11272
    ds_write_b64 v70, v[42:43] offset:15368
    v_add_u32 v28, 110592, v24
    v_add_u32 v29, 110592, v25
    v_add_u32 v30, 110592, v26
    v_add_u32 v31, 110592, v27
    ds_read_b64_tr_b16 a[16:17], v28 offset:0
    ds_read_b64_tr_b16 a[24:25], v28 offset:8
    ds_read_b64_tr_b16 a[32:33], v29 offset:0
    ds_read_b64_tr_b16 a[40:41], v29 offset:8
    ds_read_b64_tr_b16 a[48:49], v30 offset:0
    ds_read_b64_tr_b16 a[56:57], v30 offset:8
    ds_read_b64_tr_b16 a[64:65], v31 offset:0
    ds_read_b64_tr_b16 a[72:73], v31 offset:8
    s_waitcnt vmcnt(12) lgkmcnt(0)
    s_barrier
    s_mov_b64 s[8:9], s[54:55]
    s_add_u32 m0, s43, 110592
    s_add_u32 s41, s58, 0
    buffer_load_dwordx4 v16, s[8:11], s41 offen offset:0 nt lds
    s_add_u32 s41, s58, 15360
    buffer_load_dwordx4 v16, s[8:11], s41 offen offset:1024 nt lds
    s_add_u32 s41, s58, 129024
    buffer_load_dwordx4 v16, s[8:11], s41 offen offset:2048 nt lds
    s_add_u32 s41, s58, 144384
    buffer_load_dwordx4 v16, s[8:11], s41 offen offset:3072 nt lds
    v_add_u32 v28, 147456, v24
    v_add_u32 v29, 147456, v25
    v_add_u32 v30, 147456, v26
    v_add_u32 v31, 147456, v27
    ds_read_b64_tr_b16 a[18:19], v28 offset:0
    ds_read_b64_tr_b16 a[26:27], v28 offset:8
    ds_read_b64_tr_b16 a[34:35], v29 offset:0
    ds_read_b64_tr_b16 a[42:43], v29 offset:8
    ds_read_b64_tr_b16 a[50:51], v30 offset:0
    ds_read_b64_tr_b16 a[58:59], v30 offset:8
    ds_read_b64_tr_b16 a[66:67], v31 offset:0
    ds_read_b64_tr_b16 a[74:75], v31 offset:8
    s_waitcnt vmcnt(12) lgkmcnt(0)
    s_barrier
    s_add_u32 m0, s43, 147456
    s_add_u32 s41, s58, 8192
    buffer_load_dwordx4 v16, s[8:11], s41 offen offset:0 nt lds
    s_add_u32 s41, s58, 23552
    buffer_load_dwordx4 v16, s[8:11], s41 offen offset:1024 nt lds
    s_add_u32 s41, s58, 137216
    buffer_load_dwordx4 v16, s[8:11], s41 offen offset:2048 nt lds
    s_add_u32 s41, s58, 152576
    buffer_load_dwordx4 v16, s[8:11], s41 offen offset:3072 nt lds
    v_add_u32 v28, 0, v24
    v_add_u32 v29, 0, v25
    v_add_u32 v30, 0, v26
    v_add_u32 v31, 0, v27
    ds_read_b64_tr_b16 a[20:21], v28 offset:0
    ds_read_b64_tr_b16 a[28:29], v28 offset:8
    ds_read_b64_tr_b16 a[36:37], v29 offset:0
    ds_read_b64_tr_b16 a[44:45], v29 offset:8
    ds_read_b64_tr_b16 a[52:53], v30 offset:0
    ds_read_b64_tr_b16 a[60:61], v30 offset:8
    ds_read_b64_tr_b16 a[68:69], v31 offset:0
    ds_read_b64_tr_b16 a[76:77], v31 offset:8
    s_waitcnt vmcnt(12) lgkmcnt(0)
    s_barrier
    s_add_u32 m0, s43, 0
    s_add_u32 s41, s58, 262144
    buffer_load_dwordx4 v16, s[8:11], s41 offen offset:0 nt lds
    s_add_u32 s41, s58, 277504
    buffer_load_dwordx4 v16, s[8:11], s41 offen offset:1024 nt lds
    s_add_u32 s41, s58, 391168
    buffer_load_dwordx4 v16, s[8:11], s41 offen offset:2048 nt lds
    s_add_u32 s41, s58, 406528
    buffer_load_dwordx4 v16, s[8:11], s41 offen offset:3072 nt lds
    v_add_u32 v28, 36864, v24
    v_add_u32 v29, 36864, v25
    v_add_u32 v30, 36864, v26
    v_add_u32 v31, 36864, v27
    ds_read_b64_tr_b16 a[22:23], v28 offset:0
    ds_read_b64_tr_b16 a[30:31], v28 offset:8
    ds_read_b64_tr_b16 a[38:39], v29 offset:0
    ds_read_b64_tr_b16 a[46:47], v29 offset:8
    ds_read_b64_tr_b16 a[54:55], v30 offset:0
    ds_read_b64_tr_b16 a[62:63], v30 offset:8
    ds_read_b64_tr_b16 a[70:71], v31 offset:0
    ds_read_b64_tr_b16 a[78:79], v31 offset:8
    s_waitcnt vmcnt(12) lgkmcnt(0)
    s_barrier
    s_add_u32 m0, s43, 36864
    s_add_u32 s41, s58, 270336
    buffer_load_dwordx4 v16, s[8:11], s41 offen offset:0 nt lds
    s_add_u32 s41, s58, 285696
    buffer_load_dwordx4 v16, s[8:11], s41 offen offset:1024 nt lds
    s_add_u32 s41, s58, 399360
    buffer_load_dwordx4 v16, s[8:11], s41 offen offset:2048 nt lds
    s_add_u32 s41, s58, 414720
    buffer_load_dwordx4 v16, s[8:11], s41 offen offset:3072 nt lds
    v_add_u32 v77, 73728, v20
    ds_read_b64_tr_b16 a[80:81], v77 offset:0
    ds_read_b64_tr_b16 a[82:83], v77 offset:4096
    ds_read_b64_tr_b16 a[84:85], v77 offset:8192
    ds_read_b64_tr_b16 a[86:87], v77 offset:12288
    ds_read_b64_tr_b16 a[88:89], v77 offset:8
    ds_read_b64_tr_b16 a[90:91], v77 offset:4104
    ds_read_b64_tr_b16 a[92:93], v77 offset:8200
    ds_read_b64_tr_b16 a[94:95], v77 offset:12296
    s_waitcnt vmcnt(12) lgkmcnt(0)
    s_barrier
    s_add_u32 m0, s43, 73728
    s_add_u32 s41, s58, 524288
    buffer_load_dwordx4 v16, s[8:11], s41 offen offset:0 nt lds
    s_add_u32 s41, s58, 539648
    buffer_load_dwordx4 v16, s[8:11], s41 offen offset:1024 nt lds
    s_add_u32 s41, s58, 653312
    buffer_load_dwordx4 v16, s[8:11], s41 offen offset:2048 nt lds
    s_add_u32 s41, s58, 668672
    buffer_load_dwordx4 v16, s[8:11], s41 offen offset:3072 nt lds
    v_add_u32 v28, 110592, v24
    v_add_u32 v29, 110592, v25
    v_add_u32 v30, 110592, v26
    v_add_u32 v31, 110592, v27
    ds_read_b64_tr_b16 a[216:217], v28 offset:0
    ds_read_b64_tr_b16 v[32:33], v28 offset:8
    ds_read_b64_tr_b16 a[224:225], v29 offset:0
    ds_read_b64_tr_b16 a[232:233], v29 offset:8
    ds_read_b64_tr_b16 a[240:241], v30 offset:0
    ds_read_b64_tr_b16 a[248:249], v30 offset:8
    ds_read_b64_tr_b16 v[160:161], v31 offset:0
    ds_read_b64_tr_b16 v[168:169], v31 offset:8
    s_waitcnt vmcnt(12) lgkmcnt(0)
    s_barrier
    s_add_u32 m0, s43, 110592
    s_add_u32 s41, s58, 532480
    buffer_load_dwordx4 v16, s[8:11], s41 offen offset:0 nt lds
    s_add_u32 s41, s58, 547840
    buffer_load_dwordx4 v16, s[8:11], s41 offen offset:1024 nt lds
    s_add_u32 s41, s58, 661504
    buffer_load_dwordx4 v16, s[8:11], s41 offen offset:2048 nt lds
    s_add_u32 s41, s58, 676864
    buffer_load_dwordx4 v16, s[8:11], s41 offen offset:3072 nt lds
    ds_write_b64 v70, v[32:33] offset:8192
    v_add_u32 v28, 147456, v24
    v_add_u32 v29, 147456, v25
    v_add_u32 v30, 147456, v26
    v_add_u32 v31, 147456, v27
    ds_read_b64_tr_b16 a[218:219], v28 offset:0
    ds_read_b64_tr_b16 v[0:1], v28 offset:8
    ds_read_b64_tr_b16 a[226:227], v29 offset:0
    ds_read_b64_tr_b16 a[234:235], v29 offset:8
    ds_read_b64_tr_b16 a[242:243], v30 offset:0
    ds_read_b64_tr_b16 a[250:251], v30 offset:8
    ds_read_b64_tr_b16 v[162:163], v31 offset:0
    ds_read_b64_tr_b16 v[170:171], v31 offset:8
    s_waitcnt vmcnt(12) lgkmcnt(0)
    s_barrier
    s_add_u32 m0, s43, 147456
    s_add_u32 s41, s58, 786432
    buffer_load_dwordx4 v16, s[8:11], s41 offen offset:0 nt lds
    s_add_u32 s41, s58, 801792
    buffer_load_dwordx4 v16, s[8:11], s41 offen offset:1024 nt lds
    s_add_u32 s41, s58, 915456
    buffer_load_dwordx4 v16, s[8:11], s41 offen offset:2048 nt lds
    s_add_u32 s41, s58, 930816
    buffer_load_dwordx4 v16, s[8:11], s41 offen offset:3072 nt lds
    ds_write_b64 v70, v[0:1] offset:8200
    v_add_u32 v28, 0, v24
    v_add_u32 v29, 0, v25
    v_add_u32 v30, 0, v26
    v_add_u32 v31, 0, v27
    ds_read_b64_tr_b16 a[220:221], v28 offset:0
    ds_read_b64_tr_b16 v[32:33], v28 offset:8
    ds_read_b64_tr_b16 a[228:229], v29 offset:0
    ds_read_b64_tr_b16 a[236:237], v29 offset:8
    ds_read_b64_tr_b16 a[244:245], v30 offset:0
    ds_read_b64_tr_b16 a[252:253], v30 offset:8
    ds_read_b64_tr_b16 v[164:165], v31 offset:0
    ds_read_b64_tr_b16 v[172:173], v31 offset:8
    s_waitcnt vmcnt(12) lgkmcnt(0)
    s_barrier
    s_add_u32 m0, s43, 0
    s_add_u32 s41, s58, 794624
    buffer_load_dwordx4 v16, s[8:11], s41 offen offset:0 nt lds
    s_add_u32 s41, s58, 809984
    buffer_load_dwordx4 v16, s[8:11], s41 offen offset:1024 nt lds
    s_add_u32 s41, s58, 923648
    buffer_load_dwordx4 v16, s[8:11], s41 offen offset:2048 nt lds
    s_add_u32 s41, s58, 939008
    buffer_load_dwordx4 v16, s[8:11], s41 offen offset:3072 nt lds
    ds_write_b64 v70, v[32:33] offset:9216
    v_add_u32 v28, 36864, v24
    v_add_u32 v29, 36864, v25
    v_add_u32 v30, 36864, v26
    v_add_u32 v31, 36864, v27
    ds_read_b64_tr_b16 a[222:223], v28 offset:0
    ds_read_b64_tr_b16 v[0:1], v28 offset:8
    ds_read_b64_tr_b16 a[230:231], v29 offset:0
    ds_read_b64_tr_b16 a[238:239], v29 offset:8
    ds_read_b64_tr_b16 a[246:247], v30 offset:0
    ds_read_b64_tr_b16 a[254:255], v30 offset:8
    ds_read_b64_tr_b16 v[166:167], v31 offset:0
    ds_read_b64_tr_b16 v[174:175], v31 offset:8
    s_waitcnt vmcnt(12) lgkmcnt(0)
    s_barrier
    s_add_u32 m0, s43, 36864
    s_add_u32 s41, s59, 0
    buffer_load_dwordx4 v17, s[8:11], s41 offen offset:0 nt lds
    s_add_u32 s41, s59, 31744
    buffer_load_dwordx4 v17, s[8:11], s41 offen offset:1024 nt lds
    s_add_u32 s41, s59, 129024
    buffer_load_dwordx4 v17, s[8:11], s41 offen offset:2048 nt lds
    s_add_u32 s41, s59, 160768
    buffer_load_dwordx4 v17, s[8:11], s41 offen offset:3072 nt lds
    ds_write_b64 v70, v[0:1] offset:9224
    v_add_u32 v28, 73728, v24
    v_add_u32 v29, 73728, v25
    v_add_u32 v30, 73728, v26
    v_add_u32 v31, 73728, v27
    ds_read_b64_tr_b16 v[176:177], v28 offset:0
    ds_read_b64_tr_b16 v[184:185], v28 offset:8
    ds_read_b64_tr_b16 v[192:193], v29 offset:0
    ds_read_b64_tr_b16 v[200:201], v29 offset:8
    ds_read_b64_tr_b16 v[208:209], v30 offset:0
    ds_read_b64_tr_b16 v[216:217], v30 offset:8
    ds_read_b64_tr_b16 v[224:225], v31 offset:0
    ds_read_b64_tr_b16 v[232:233], v31 offset:8
    s_waitcnt vmcnt(12) lgkmcnt(0)
    s_barrier
    s_mov_b64 s[8:9], s[56:57]
    s_add_u32 m0, s43, 73728
    s_add_u32 s41, s60, 128
    buffer_load_dwordx4 v18, s[8:11], s41 offen offset:0 nt lds
    s_add_u32 s41, s60, 8320
    buffer_load_dwordx4 v18, s[8:11], s41 offen offset:1024 nt lds
    s_add_u32 s41, s60, 16512
    buffer_load_dwordx4 v18, s[8:11], s41 offen offset:2048 nt lds
    s_add_u32 s41, s60, 24704
    buffer_load_dwordx4 v18, s[8:11], s41 offen offset:3072 nt lds
    v_add_u32 v28, 110592, v24
    v_add_u32 v29, 110592, v25
    v_add_u32 v30, 110592, v26
    v_add_u32 v31, 110592, v27
    ds_read_b64_tr_b16 v[178:179], v28 offset:0
    ds_read_b64_tr_b16 v[186:187], v28 offset:8
    ds_read_b64_tr_b16 v[194:195], v29 offset:0
    ds_read_b64_tr_b16 v[202:203], v29 offset:8
    ds_read_b64_tr_b16 v[210:211], v30 offset:0
    ds_read_b64_tr_b16 v[218:219], v30 offset:8
    ds_read_b64_tr_b16 v[226:227], v31 offset:0
    ds_read_b64_tr_b16 v[234:235], v31 offset:8
    s_waitcnt vmcnt(12) lgkmcnt(0)
    s_barrier
    s_add_u32 m0, s43, 110592
    s_add_u32 s41, s61, 128
    buffer_load_dwordx4 v18, s[8:11], s41 offen offset:0 nt lds
    s_add_u32 s41, s61, 8320
    buffer_load_dwordx4 v18, s[8:11], s41 offen offset:1024 nt lds
    s_add_u32 s41, s61, 16512
    buffer_load_dwordx4 v18, s[8:11], s41 offen offset:2048 nt lds
    s_add_u32 s41, s61, 24704
    buffer_load_dwordx4 v18, s[8:11], s41 offen offset:3072 nt lds
    v_add_u32 v28, 147456, v24
    v_add_u32 v29, 147456, v25
    v_add_u32 v30, 147456, v26
    v_add_u32 v31, 147456, v27
    ds_read_b64_tr_b16 v[180:181], v28 offset:0
    ds_read_b64_tr_b16 v[188:189], v28 offset:8
    ds_read_b64_tr_b16 v[196:197], v29 offset:0
    ds_read_b64_tr_b16 v[204:205], v29 offset:8
    ds_read_b64_tr_b16 v[212:213], v30 offset:0
    ds_read_b64_tr_b16 v[220:221], v30 offset:8
    ds_read_b64_tr_b16 v[228:229], v31 offset:0
    ds_read_b64_tr_b16 v[236:237], v31 offset:8
    s_waitcnt vmcnt(12) lgkmcnt(0)
    s_barrier
    s_add_u32 m0, s43, 147456
    s_add_u32 s41, s62, 128
    buffer_load_dwordx4 v18, s[8:11], s41 offen offset:0 nt lds
    s_add_u32 s41, s62, 8320
    buffer_load_dwordx4 v18, s[8:11], s41 offen offset:1024 nt lds
    s_add_u32 s41, s62, 16512
    buffer_load_dwordx4 v18, s[8:11], s41 offen offset:2048 nt lds
    s_add_u32 s41, s62, 24704
    buffer_load_dwordx4 v18, s[8:11], s41 offen offset:3072 nt lds
    v_add_u32 v28, 0, v24
    v_add_u32 v29, 0, v25
    v_add_u32 v30, 0, v26
    v_add_u32 v31, 0, v27
    ds_read_b64_tr_b16 v[182:183], v28 offset:0
    ds_read_b64_tr_b16 v[190:191], v28 offset:8
    ds_read_b64_tr_b16 v[198:199], v29 offset:0
    ds_read_b64_tr_b16 v[206:207], v29 offset:8
    ds_read_b64_tr_b16 v[214:215], v30 offset:0
    ds_read_b64_tr_b16 v[222:223], v30 offset:8
    ds_read_b64_tr_b16 v[230:231], v31 offset:0
    ds_read_b64_tr_b16 v[238:239], v31 offset:8
    s_waitcnt vmcnt(12) lgkmcnt(0)
    s_barrier
    s_add_u32 m0, s43, 0
    s_add_u32 s41, s63, 128
    buffer_load_dwordx4 v18, s[8:11], s41 offen offset:0 nt lds
    s_add_u32 s41, s63, 8320
    buffer_load_dwordx4 v18, s[8:11], s41 offen offset:1024 nt lds
    s_add_u32 s41, s63, 16512
    buffer_load_dwordx4 v18, s[8:11], s41 offen offset:2048 nt lds
    s_add_u32 s41, s63, 24704
    buffer_load_dwordx4 v18, s[8:11], s41 offen offset:3072 nt lds
    v_mov_b32 v78, v21
    v_mov_b32 v79, v22
    v_add_u32 v77, 36864, v20
    ds_read_b64_tr_b16 v[240:241], v77 offset:0
    ds_read_b64_tr_b16 v[242:243], v77 offset:4096
    ds_read_b64_tr_b16 v[244:245], v77 offset:8192
    ds_read_b64_tr_b16 v[246:247], v77 offset:12288
    ds_read_b64_tr_b16 v[248:249], v77 offset:8
    ds_read_b64_tr_b16 v[250:251], v77 offset:4104
    ds_read_b64_tr_b16 v[252:253], v77 offset:8200
    ds_read_b64_tr_b16 v[254:255], v77 offset:12296
    s_waitcnt vmcnt(12) lgkmcnt(0)
    s_barrier
    v_add_u32 v77, 73728, v79
    s_waitcnt lgkmcnt(0)
    ds_read_b64_tr_b16 v[0:1], v77 offset:0
    ds_read_b64_tr_b16 v[2:3], v77 offset:256
    ds_read_b64_tr_b16 v[4:5], v77 offset:2048
    ds_read_b64_tr_b16 v[6:7], v77 offset:2304
    ds_read_b64_tr_b16 v[8:9], v77 offset:8
    ds_read_b64_tr_b16 v[10:11], v77 offset:264
    ds_read_b64_tr_b16 v[12:13], v77 offset:2056
    ds_read_b64_tr_b16 v[14:15], v77 offset:2312
    s_waitcnt vmcnt(8) lgkmcnt(0)
    s_barrier
    v_add_u32 v77, 110592, v78
    ds_read_b64_tr_b16 v[16:17], v77 offset:0
    ds_read_b64_tr_b16 v[18:19], v77 offset:256
    ds_read_b64_tr_b16 v[20:21], v77 offset:2048
    ds_read_b64_tr_b16 v[22:23], v77 offset:2304
    ds_read_b64_tr_b16 v[24:25], v77 offset:8
    ds_read_b64_tr_b16 v[26:27], v77 offset:264
    ds_read_b64_tr_b16 v[28:29], v77 offset:2056
    ds_read_b64_tr_b16 v[30:31], v77 offset:2312
    s_waitcnt vmcnt(4) lgkmcnt(0)
    s_barrier
    v_add_u32 v77, 147456, v78
    ds_read_b64_tr_b16 v[32:33], v77 offset:0
    ds_read_b64_tr_b16 v[34:35], v77 offset:256
    ds_read_b64_tr_b16 v[36:37], v77 offset:2048
    ds_read_b64_tr_b16 v[38:39], v77 offset:2304
    ds_read_b64_tr_b16 v[40:41], v77 offset:8
    ds_read_b64_tr_b16 v[42:43], v77 offset:264
    ds_read_b64_tr_b16 v[44:45], v77 offset:2056
    ds_read_b64_tr_b16 v[46:47], v77 offset:2312
    s_waitcnt vmcnt(0) lgkmcnt(0)
    s_barrier
    v_add_u32 v77, 0, v78
    ds_read_b64_tr_b16 v[48:49], v77 offset:0
    ds_read_b64_tr_b16 v[50:51], v77 offset:256
    ds_read_b64_tr_b16 v[52:53], v77 offset:2048
    ds_read_b64_tr_b16 v[54:55], v77 offset:2304
    ds_read_b64_tr_b16 v[56:57], v77 offset:8
    ds_read_b64_tr_b16 v[58:59], v77 offset:264
    ds_read_b64_tr_b16 v[60:61], v77 offset:2056
    ds_read_b64_tr_b16 v[62:63], v77 offset:2312
    s_waitcnt lgkmcnt(0)
    s_barrier
    ds_write_b128 v70, v[0:3] offset:20480
    ds_write_b128 v70, v[4:7] offset:21504
    ds_write_b128 v70, v[8:11] offset:22528
    ds_write_b128 v70, v[12:15] offset:23552
    ds_write_b128 v70, v[16:19] offset:24576
    ds_write_b128 v70, v[20:23] offset:25600
    ds_write_b128 v70, v[24:27] offset:26624
    ds_write_b128 v70, v[28:31] offset:27648
    ds_write_b128 v70, v[32:35] offset:28672
    ds_write_b128 v70, v[36:39] offset:29696
    ds_write_b128 v70, v[40:43] offset:30720
    ds_write_b128 v70, v[44:47] offset:31744
    ds_write_b128 v70, v[48:51] offset:32768
    ds_write_b128 v70, v[52:55] offset:33792
    ds_write_b128 v70, v[56:59] offset:34816
    ds_write_b128 v70, v[60:63] offset:35840
    s_waitcnt lgkmcnt(0)
    v_bfe_u32 v60, v65, 4, 6
    v_and_b32 v61, 15, v60
    v_lshrrev_b32 v62, 4, v60
    v_mov_b32 v50, 0x3f80
    v_mov_b32 v51, 0x3f800000
    v_and_b32 v77, 1, v62
    v_lshlrev_b32 v77, 2, v77
    v_sub_u32 v77, v61, v77
    v_and_b32 v78, 3, v61
    v_lshlrev_b32 v78, 2, v78
    v_lshrrev_b32 v79, 2, v61
    v_add_u32 v78, v78, v79
    v_cmp_eq_u32 vcc, 0, v77
    s_nop 1
    v_cndmask_b32 v8, 0, v50, vcc
    v_cmp_eq_u32 vcc, 1, v77
    s_nop 1
    v_cndmask_b32 v8, v8, v51, vcc
    v_cmp_eq_u32 vcc, 0, v78
    s_nop 1
    v_cndmask_b32 v12, 0, v50, vcc
    v_cmp_eq_u32 vcc, 1, v78
    s_nop 1
    v_cndmask_b32 v12, v12, v51, vcc
    v_cmp_eq_u32 vcc, 2, v77
    s_nop 1
    v_cndmask_b32 v9, 0, v50, vcc
    v_cmp_eq_u32 vcc, 3, v77
    s_nop 1
    v_cndmask_b32 v9, v9, v51, vcc
    v_cmp_eq_u32 vcc, 2, v78
    s_nop 1
    v_cndmask_b32 v13, 0, v50, vcc
    v_cmp_eq_u32 vcc, 3, v78
    s_nop 1
    v_cndmask_b32 v13, v13, v51, vcc
    v_cmp_eq_u32 vcc, 8, v77
    s_nop 1
    v_cndmask_b32 v10, 0, v50, vcc
    v_cmp_eq_u32 vcc, 9, v77
    s_nop 1
    v_cndmask_b32 v10, v10, v51, vcc
    v_cmp_eq_u32 vcc, 4, v78
    s_nop 1
    v_cndmask_b32 v14, 0, v50, vcc
    v_cmp_eq_u32 vcc, 5, v78
    s_nop 1
    v_cndmask_b32 v14, v14, v51, vcc
    v_cmp_eq_u32 vcc, 10, v77
    s_nop 1
    v_cndmask_b32 v11, 0, v50, vcc
    v_cmp_eq_u32 vcc, 11, v77
    s_nop 1
    v_cndmask_b32 v11, v11, v51, vcc
    v_cmp_eq_u32 vcc, 6, v78
    s_nop 1
    v_cndmask_b32 v15, 0, v50, vcc
    v_cmp_eq_u32 vcc, 7, v78
    s_nop 1
    v_cndmask_b32 v15, v15, v51, vcc
    v_lshlrev_b32 v77, 4, v61
    ds_write_b128 v69, v[8:11] offset:15360
    ds_write_b128 v77, v[12:15] offset:15872
    s_waitcnt vmcnt(0) lgkmcnt(0)
    s_barrier
    v_mov_b32 v2, 1
    s_cmp_lg_u32 s13, 0
    s_cbranch_scc1 cs_noarr
    s_mov_b64 exec, 1
    buffer_atomic_add v2, off, s[84:87], 0 offset:212
    s_mov_b32 s40, 16777216
    s_mov_b32 s42, 2
cs_startpoll:
    buffer_load_dword v3, off, s[84:87], 0 offset:212 sc1
    s_sub_u32 s40, s40, 1
    s_cbranch_scc1 cs_decide
    s_waitcnt vmcnt(0)
    v_readfirstlane_b32 s41, v3
    s_nop 1
    s_cmp_lt_u32 s41, 32
    s_cbranch_scc1 cs_startpoll
    s_mov_b32 s42, 1
cs_decide:
    s_mov_b64 exec, -1
cs_noarr:
    s_barrier
    s_mov_b32 m0, 16128
    s_mov_b32 s44, 0x3e0293ee
    s_mov_b32 s45, s44
    s_or_b32 s66, s44, 0x80000000
    s_mov_b32 s48, 0x3f003f00
    s_mov_b32 s49, 0
    s_mov_b32 s50, 0x3f803f80
    s_mov_b32 s51, 0x3f803f80
    s_mov_b32 s52, 512
    s_mov_b32 s53, 1024
    s_mov_b32 s54, 1536
    s_mov_b32 s30, 0
    s_lshl_b32 s47, s13, 9
    s_cmp_lg_u32 s32, 0
    s_cselect_b32 s71, s13, 3
    s_add_u32 s46, s71, 1
    s_lshr_b32 s46, s46, 1
    s_mov_b32 s14, 67649536
    s_mov_b32 s15, 67653632
    s_mov_b32 s16, 67657728
    s_mov_b32 s36, 0
    s_add_u32 s17, s68, 67633152
    s_mov_b32 s69, 0
    s_mov_b32 s70, 0
    s_lshl_b32 s26, s12, 14
    s_add_u32 s26, s26, 0
    s_mul_i32 s40, s13, 3072
    s_add_u32 s24, s26, s40
    s_lshl_b32 s96, s12, 7
    s_add_u32 s29, s96, 125845504
    s_add_u32 s96, s96, 125829120
    s_lshl_b32 s40, s12, 14
    s_add_u32 s40, s40, 68681728
    s_add_u32 s18, s40, 0
    s_add_u32 s19, s40, 4096
    s_add_u32 s20, s40, 8192
    s_add_u32 s21, s40, 12288
    s_lshr_b32 s40, s12, 3
    s_lshl_b32 s40, s40, 12
    s_and_b32 s41, s12, 7
    s_lshl_b32 s41, s41, 7
    s_add_u32 s40, s40, s41
    s_add_u32 s22, s40, 68681728
    s_add_u32 s23, s22, 1024
    s_add_u32 s25, s22, 2048
    s_mov_b32 s56, -65528
    s_cmp_lg_u32 s32, 0
    s_cselect_b64 s[38:39], -1, 0
    s_add_u32 s55, s68, 138412032
    s_cmp_eq_u32 s13, 3
    s_cselect_b64 s[100:101], 1, 0
    s_cselect_b64 s[38:39], 1, s[38:39]
    s_cselect_b32 s93, 64, 0
    s_cselect_b32 s55, s29, s55
    s_cselect_b32 s57, 0, 9216
    s_mov_b64 exec, s[100:101]
    v_mov_b32 v72, s95
    s_mov_b64 exec, -1
    s_mov_b32 s34, 0xff00ff00
    s_mov_b32 s35, 0xff00ff00
    s_lshl_b32 s28, s12, 12
    s_add_u32 s28, s28, 7602176
    s_add_u32 s27, s28, 77594624
    s_add_u32 s28, s28, 69206016
    s_mov_b32 s37, s93
    s_mov_b32 s40, 3
    v_bfe_u32 v78, v65, 2, 5
    s_mov_b32 s31, 4194304
cs_kv0:
    buffer_load_dword v77, v78, s[4:7], s96 offen offset:16 sc1
    s_waitcnt vmcnt(0)
    v_subrev_u32 v77, s95, v77
    v_cmp_lt_u32 vcc, 16, v77
    s_nop 1
    v_cndmask_b32 v77, v77, 0, vcc
    v_bfe_u32 v79, v78, 2, 2
    v_lshl_add_u32 v77, v77, 2, v79
    s_nop 1
    v_min_u32_dpp v77, v77, v77 row_ror:1 row_mask:0xf bank_mask:0xf
    s_nop 1
    v_min_u32_dpp v77, v77, v77 row_ror:2 row_mask:0xf bank_mask:0xf
    s_nop 1
    v_min_u32_dpp v77, v77, v77 row_ror:4 row_mask:0xf bank_mask:0xf
    s_nop 0
    v_readfirstlane_b32 s97, v77
    s_sub_u32 s31, s31, 1
    s_cbranch_scc1 cs_kv0_x
    s_cmp_le_u32 s40, s97
    s_cbranch_scc1 cs_kv0_x
    s_sleep 2
    s_branch cs_kv0
cs_kv0_x:
    s_add_u32 s40, s26, 0
    v_lshlrev_b32 v78, 2, v65
    buffer_load_dword v76, v78, s[4:7], s40 offen sc1
    s_add_u32 s40, s26, 524288
    v_lshlrev_b32 v78, 2, v65
    buffer_load_dword v76, v78, s[4:7], s40 offen sc1
cs_kvdone:
    v_mov_b64 v[0:1], 0
    v_mov_b64 v[2:3], 0
    v_mov_b64 v[4:5], 0
    v_mov_b64 v[6:7], 0
    v_mov_b64 v[8:9], 0
    v_mov_b64 v[10:11], 0
    v_mov_b64 v[12:13], 0
    v_mov_b64 v[14:15], 0
    v_mov_b64 v[16:17], 0
    v_mov_b64 v[18:19], 0
    v_mov_b64 v[20:21], 0
    v_mov_b64 v[22:23], 0
    ds_read_b128 v[40:43], v70 offset:0
    ds_read_b128 v[44:47], v70 offset:1024
    ds_read_b128 v[48:51], v70 offset:2048
    ds_read_b128 v[52:55], v70 offset:3072
    ds_read_b128 v[24:27], v70 offset:4096
    ds_read_b128 v[28:31], v70 offset:5120
    ds_read_b128 v[32:35], v70 offset:6144
    ds_read_b128 v[36:39], v70 offset:7168
    buffer_load_dwordx4 v[60:63], v65, s[4:7], s14 offen offset:0 sc1
    buffer_load_dwordx4 v[56:59], v66, s[4:7], s14 offen offset:0 sc1
    s_mov_b32 s31, 1048576
    s_waitcnt vmcnt(0) lgkmcnt(0)
    s_branch cs_goA
cs_loop:
    s_add_u32 s40, s30, 3
    s_min_u32 s40, s40, 64
    s_cmp_le_u32 s40, s97
    s_cbranch_scc0 cs_kvwait
cs_kvok:
    s_mov_b32 s31, 1048576
    s_mov_b32 s69, s70
    s_waitcnt lgkmcnt(0)
cs_cA:
    buffer_load_dwordx4 v[60:63], v65, s[4:7], s14 offen offset:0 sc1
    buffer_load_dwordx4 v[56:59], v66, s[4:7], s14 offen offset:0 sc1
cs_cA1:
    v_bitop3_b32 v77, v60, v56, s70 bitop3:0x7e
    v_and_b32 v77, 1, v77
    v_cmp_ne_u32 vcc, 0, v77
    s_cbranch_vccz cs_goA
    s_nop 15
    s_nop 15
    s_nop 7
    v_bitop3_b32 v77, v60, v56, s70 bitop3:0x7e
    v_and_b32 v77, 1, v77
    v_cmp_ne_u32 vcc, 0, v77
    s_cbranch_vccz cs_goA
    s_nop 15
    s_nop 15
    s_nop 7
    v_bitop3_b32 v77, v60, v56, s70 bitop3:0x7e
    v_and_b32 v77, 1, v77
    v_cmp_ne_u32 vcc, 0, v77
    s_cbranch_vccz cs_goA
    s_nop 15
    s_nop 15
    s_nop 7
    v_bitop3_b32 v77, v60, v56, s70 bitop3:0x7e
    v_and_b32 v77, 1, v77
    v_cmp_ne_u32 vcc, 0, v77
    s_cbranch_vccz cs_goA
    s_nop 15
    s_nop 15
    s_nop 7
    v_bitop3_b32 v77, v60, v56, s70 bitop3:0x7e
    v_and_b32 v77, 1, v77
    v_cmp_ne_u32 vcc, 0, v77
    s_cbranch_vccz cs_goA
    s_nop 15
    s_nop 15
    s_nop 7
    buffer_load_dwordx4 v[60:63], v65, s[4:7], s14 offen offset:0 sc1
    buffer_load_dwordx4 v[56:59], v66, s[4:7], s14 offen offset:0 sc1
    v_bitop3_b32 v77, v60, v56, s70 bitop3:0x7e
    v_and_b32 v77, 1, v77
    v_cmp_ne_u32 vcc, 0, v77
    s_cbranch_vccz cs_goA
    s_nop 15
    s_nop 15
    s_nop 7
    v_bitop3_b32 v77, v60, v56, s70 bitop3:0x7e
    v_and_b32 v77, 1, v77
    v_cmp_ne_u32 vcc, 0, v77
    s_cbranch_vccz cs_goA
    s_nop 15
    s_nop 15
    s_nop 7
    v_bitop3_b32 v77, v60, v56, s70 bitop3:0x7e
    v_and_b32 v77, 1, v77
    v_cmp_ne_u32 vcc, 0, v77
    s_cbranch_vccz cs_goA
    s_nop 15
    s_nop 15
    s_nop 7
    v_bitop3_b32 v77, v60, v56, s70 bitop3:0x7e
    v_and_b32 v77, 1, v77
    v_cmp_ne_u32 vcc, 0, v77
    s_cbranch_vccz cs_goA
    s_nop 15
    s_nop 15
    s_nop 7
    v_bitop3_b32 v77, v60, v56, s70 bitop3:0x7e
    v_and_b32 v77, 1, v77
    v_cmp_ne_u32 vcc, 0, v77
    s_cbranch_vccz cs_goA
    s_nop 15
    s_nop 15
    s_nop 7
    buffer_load_dwordx4 v[60:63], v65, s[4:7], s14 offen offset:0 sc1
    buffer_load_dwordx4 v[56:59], v66, s[4:7], s14 offen offset:0 sc1
    v_bitop3_b32 v77, v60, v56, s70 bitop3:0x7e
    v_and_b32 v77, 1, v77
    v_cmp_ne_u32 vcc, 0, v77
    s_cbranch_vccz cs_goA
    s_nop 15
    s_nop 15
    s_nop 7
    v_bitop3_b32 v77, v60, v56, s70 bitop3:0x7e
    v_and_b32 v77, 1, v77
    v_cmp_ne_u32 vcc, 0, v77
    s_cbranch_vccz cs_goA
    s_nop 15
    s_nop 15
    s_nop 7
    v_bitop3_b32 v77, v60, v56, s70 bitop3:0x7e
    v_and_b32 v77, 1, v77
    v_cmp_ne_u32 vcc, 0, v77
    s_cbranch_vccz cs_goA
    s_nop 15
    s_nop 15
    s_nop 7
    v_bitop3_b32 v77, v60, v56, s70 bitop3:0x7e
    v_and_b32 v77, 1, v77
    v_cmp_ne_u32 vcc, 0, v77
    s_cbranch_vccz cs_goA
    s_nop 15
    s_nop 15
    s_nop 7
    v_bitop3_b32 v77, v60, v56, s70 bitop3:0x7e
    v_and_b32 v77, 1, v77
    v_cmp_ne_u32 vcc, 0, v77
    s_cbranch_vccz cs_goA
    s_nop 15
    s_nop 15
    s_nop 7
    buffer_load_dwordx4 v[60:63], v65, s[4:7], s14 offen offset:0 sc1
    buffer_load_dwordx4 v[56:59], v66, s[4:7], s14 offen offset:0 sc1
    v_bitop3_b32 v77, v60, v56, s70 bitop3:0x7e
    v_and_b32 v77, 1, v77
    v_cmp_ne_u32 vcc, 0, v77
    s_cbranch_vccz cs_goA
    s_nop 15
    s_nop 15
    s_nop 7
    v_bitop3_b32 v77, v60, v56, s70 bitop3:0x7e
    v_and_b32 v77, 1, v77
    v_cmp_ne_u32 vcc, 0, v77
    s_cbranch_vccz cs_goA
    s_nop 15
    s_nop 15
    s_nop 7
    v_bitop3_b32 v77, v60, v56, s70 bitop3:0x7e
    v_and_b32 v77, 1, v77
    v_cmp_ne_u32 vcc, 0, v77
    s_cbranch_vccz cs_goA
    s_nop 15
    s_nop 15
    s_nop 7
    v_bitop3_b32 v77, v60, v56, s70 bitop3:0x7e
    v_and_b32 v77, 1, v77
    v_cmp_ne_u32 vcc, 0, v77
    s_cbranch_vccz cs_goA
    s_nop 15
    s_nop 15
    s_nop 7
    v_bitop3_b32 v77, v60, v56, s70 bitop3:0x7e
    v_and_b32 v77, 1, v77
    v_cmp_ne_u32 vcc, 0, v77
    s_cbranch_vccz cs_goA
    s_nop 15
    s_nop 15
    s_nop 7
    s_sub_u32 s31, s31, 64
    s_cbranch_scc0 cs_cA
cs_goA:
    ds_write_b128 v65, v[60:63] offset:0
    v_smfmac_f32_16x16x64_bf16 v[0:3], v[60:63], v[40:47], v64
    v_smfmac_f32_16x16x64_bf16 v[4:7], v[60:63], v[48:55], v64
    buffer_load_dwordx4 v[40:43], v65, s[4:7], s15 offen offset:0 sc1
    v_smfmac_f32_16x16x64_bf16 v[0:3], v[56:59], v[24:31], v64
    v_smfmac_f32_16x16x64_bf16 v[4:7], v[56:59], v[32:39], v64
    ds_read_b128 v[24:27], v70 offset:8192
    v_smfmac_f32_16x16x64_bf16 v[8:11], v[60:63], a[96:103], v64
    ds_read_b128 v[28:31], v70 offset:9216
    v_smfmac_f32_16x16x64_bf16 v[12:15], v[60:63], a[104:111], v64
    ds_read_b128 v[32:35], v70 offset:10240
    s_waitcnt lgkmcnt(3)
    s_barrier
    ds_read_b128 v[48:51], v67 offset:0
    v_smfmac_f32_16x16x64_bf16 v[8:11], v[56:59], a[112:119], v64
    ds_read_b128 v[36:39], v70 offset:11264
    v_bitop3_b32 v79, v73, -9, s54 bitop3:0x6a
    v_smfmac_f32_16x16x64_bf16 v[12:15], v[56:59], a[120:127], v64
    ds_read_b128 v[52:55], v68 offset:0
    v_lshlrev_b32 v78, 2, v65
    v_smfmac_f32_16x16x64_bf16 v[16:19], v[60:63], a[216:223], v64
    buffer_load_dwordx4 v[40:43], v65, s[4:7], s15 offen offset:0 sc1
    s_waitcnt lgkmcnt(4)
    v_smfmac_f32_16x16x64_bf16 v[20:23], v[60:63], v[24:31], v64
    ds_read_b128 v[24:27], v70 offset:12288
    s_waitcnt lgkmcnt(3)
    v_smfmac_f32_16x16x64_bf16 v[0:3], v[48:51], a[0:7], v64
    ds_read_b128 v[28:31], v70 offset:13312
    s_waitcnt lgkmcnt(3)
    v_smfmac_f32_16x16x64_bf16 v[4:7], v[48:51], v[32:39], v64
    ds_read_b128 v[32:35], v70 offset:14336
    s_add_u32 s40, s26, 1048576
    v_smfmac_f32_16x16x64_bf16 v[8:11], v[48:51], a[128:135], v64
    ds_read_b128 v[36:39], v70 offset:15360
    v_smfmac_f32_16x16x64_bf16 v[12:15], v[48:51], a[136:143], v64
    buffer_load_dwordx4 v[60:63], v65, s[4:7], s16 offen offset:0 sc1
    v_smfmac_f32_16x16x64_bf16 v[16:19], v[56:59], a[224:231], v64
    v_smfmac_f32_16x16x64_bf16 v[20:23], v[56:59], a[232:239], v64
    s_waitcnt lgkmcnt(2)
    s_waitcnt vmcnt(2)
    v_and_b32 v77, s36, v40
    v_smfmac_f32_16x16x64_bf16 v[12:15], v[52:55], v[24:31], v64
    ds_write_b128 v65, v[40:43] offset:4096
    v_smfmac_f32_16x16x64_bf16 v[0:3], v[52:55], a[8:15], v64
    s_waitcnt lgkmcnt(1)
    v_cmp_ne_u32 vcc, s70, v77
    v_smfmac_f32_16x16x64_bf16 v[4:7], v[52:55], v[32:39], v64
    buffer_load_dwordx4 v[24:27], v65, s[4:7], s24 offen offset:0 sc1
    v_smfmac_f32_16x16x64_bf16 v[8:11], v[52:55], a[144:151], v64
    s_cbranch_vccnz cs_spinB
cs_backB:
    v_smfmac_f32_16x16x64_bf16 v[16:19], v[40:43], v[176:183], v64
    s_waitcnt lgkmcnt(0)
    s_barrier
    ds_read_b128 v[44:47], v66 offset:4096
    v_smfmac_f32_16x16x64_bf16 v[12:15], v[40:43], a[160:167], v64
    ds_read_b128 v[32:35], v70 offset:16384
    v_smfmac_f32_16x16x64_bf16 v[0:3], v[40:43], a[16:23], v64
    ds_read_b128 v[36:39], v70 offset:17408
    v_smfmac_f32_16x16x64_bf16 v[8:11], v[40:43], a[152:159], v64
    ds_read_b128 v[48:51], v67 offset:4096
    v_smfmac_f32_16x16x64_bf16 v[4:7], v[40:43], a[24:31], v64
    ds_read_b128 v[52:55], v68 offset:4096
    v_smfmac_f32_16x16x64_bf16 v[20:23], v[40:43], v[184:191], v64
    buffer_load_dwordx4 v[28:31], v65, s[4:7], s24 offen offset:1024 sc1
    s_waitcnt lgkmcnt(4)
    v_smfmac_f32_16x16x64_bf16 v[0:3], v[44:47], a[32:39], v64
    ds_read_b128 v[56:59], v69 offset:15360
    s_waitcnt lgkmcnt(3)
    v_smfmac_f32_16x16x64_bf16 v[8:11], v[44:47], v[32:39], v64
    ds_read_b128 v[32:35], v70 offset:18432
    v_smfmac_f32_16x16x64_bf16 v[4:7], v[44:47], a[40:47], v64
    ds_read_b128 v[36:39], v70 offset:19456
    v_smfmac_f32_16x16x64_bf16 v[12:15], v[44:47], a[168:175], v64
    buffer_load_dwordx4 v[42:45], v65, s[4:7], s24 offen offset:3072 sc1
    s_waitcnt lgkmcnt(3)
    v_smfmac_f32_16x16x64_bf16 v[0:3], v[48:51], a[48:55], v64
    s_waitcnt vmcnt(3)
    v_and_b32 v77, s36, v60
    v_smfmac_f32_16x16x64_bf16 v[8:11], v[48:51], a[176:183], v64
    v_cmp_ne_u32 vcc, s70, v77
    v_smfmac_f32_16x16x64_bf16 v[0:3], v[52:55], a[64:71], v64
    s_waitcnt lgkmcnt(0)
    v_smfmac_f32_16x16x64_bf16 v[8:11], v[52:55], v[32:39], v64
    s_cbranch_vccnz cs_spin8
cs_back8:
    v_smfmac_f32_16x16x64_bf16 v[0:3], v[60:63], a[80:87], v64
    buffer_load_dwordx4 v[34:37], v65, s[4:7], s24 offen offset:2048 sc1
    s_nop 1
    v_smfmac_f32_16x16x64_bf16 v[8:11], v[60:63], a[200:207], v64
    s_nop 1
    v_lshrrev_b32 v77, 1, v69
    v_smfmac_f32_16x16x64_bf16 v[4:7], v[48:51], a[56:63], v64
    s_nop 1
    v_cvt_pk_bf16_f32 v0, v0, v1
    v_smfmac_f32_16x16x64_bf16 v[12:15], v[48:51], a[184:191], v64
    s_nop 1
    v_cvt_pk_bf16_f32 v1, v2, v3
    v_smfmac_f32_16x16x64_bf16 v[4:7], v[52:55], a[72:79], v64
    s_nop 1
    v_cvt_pk_bf16_f32 v2, v8, v9
    v_smfmac_f32_16x16x64_bf16 v[12:15], v[52:55], a[192:199], v64
    s_nop 1
    v_cvt_pk_bf16_f32 v3, v10, v11
    v_smfmac_f32_16x16x64_bf16 v[4:7], v[60:63], a[88:95], v64
    s_nop 2
    v_smfmac_f32_16x16x64_bf16 v[12:15], v[60:63], a[208:215], v64
    buffer_load_dword v76, v78, s[4:7], s40 offen sc1
    s_nop 1
    v_mfma_f32_16x16x32_bf16 v[8:11], v[0:3], v[56:59], 0
    s_nop 0
    v_cvt_pk_bf16_f32 v4, v4, v5
    v_cvt_pk_bf16_f32 v5, v6, v7
    s_nop 0
    v_cvt_pk_bf16_f32 v6, v12, v13
    v_cvt_pk_bf16_f32 v7, v14, v15
    s_nop 1
    v_mfma_f32_16x16x32_bf16 v[12:15], v[4:7], v[56:59], 0
    ds_read_b128 v[56:59], v66 offset:4096
    v_cvt_pk_bf16_f32 v0, v8, v9
    v_cvt_pk_bf16_f32 v1, v10, v11
    v_smfmac_f32_16x16x64_bf16 v[16:19], v[48:51], v[208:215], v64
    s_waitcnt vmcnt(3)
    s_nop 2
    v_cvt_pk_bf16_f32 v2, v12, v13
    v_cvt_pk_bf16_f32 v3, v14, v15
    s_nop 1
    v_mfma_f32_16x16x32_bf16 v[12:15], v[0:3], v[0:3], 0
    s_nop 1
    v_bitop3_b32 v78, v73, -9, s53 bitop3:0x6a
    v_mfma_f32_16x16x32_bf16 v[4:7], v[24:27], v[0:3], 0
    ds_read_b128 v[24:27], v67 offset:0
    s_nop 1
    v_mfma_f32_16x16x32_bf16 v[8:11], v[28:31], v[0:3], 0
    s_nop 0
    v_mov_b32_dpp v12, v14 row_ror:8 row_mask:0xf bank_mask:0xc
    v_mov_b32_dpp v13, v15 row_ror:8 row_mask:0xf bank_mask:0xc
    v_smfmac_f32_16x16x64_bf16 v[20:23], v[48:51], v[216:223], v64
    ds_write_b64 v71, v[12:13]
    ds_read_b128 v[48:51], v68 offset:0
    s_nop 1
    v_mov_b32_dpp v4, v8 row_ror:8 row_mask:0xf bank_mask:0xc
    v_mov_b32_dpp v5, v9 row_ror:8 row_mask:0xf bank_mask:0xc
    v_mov_b32_dpp v6, v10 row_ror:8 row_mask:0xf bank_mask:0xc
    v_mov_b32_dpp v7, v11 row_ror:8 row_mask:0xf bank_mask:0xc
    v_smfmac_f32_16x16x64_bf16 v[16:19], v[52:55], v[224:231], v64
    ds_write_b128 v65, v[4:7] offset:8192
    v_smfmac_f32_16x16x64_bf16 v[20:23], v[52:55], v[232:239], v64
    s_waitcnt lgkmcnt(3)
    v_smfmac_f32_16x16x64_bf16 v[16:19], v[24:27], a[240:247], v64
    s_waitcnt vmcnt(1)
    v_smfmac_f32_16x16x64_bf16 v[20:23], v[24:27], a[248:255], v64
    s_mov_b64 exec, s[38:39]
    buffer_store_dword v72, v75, s[4:7], s55 offen sc1
    s_mov_b64 exec, -1
    v_smfmac_f32_16x16x64_bf16 v[16:19], v[60:63], v[240:247], v64
    s_cmp_lg_u32 s37, 0
    s_waitcnt lgkmcnt(0)
    s_barrier
    ds_read_b128 v[8:11], v66 offset:8192
    v_smfmac_f32_16x16x64_bf16 v[20:23], v[60:63], v[248:255], v64
    ds_read_b128 v[12:15], v67 offset:8192
    v_and_b32 v72, 8, v73
    v_smfmac_f32_16x16x64_bf16 v[16:19], v[56:59], v[192:199], v64
    ds_read_b128 v[52:55], v68 offset:8192
    v_mad_u32_u24 v72, v72, 63, v73
    v_smfmac_f32_16x16x64_bf16 v[20:23], v[56:59], v[200:207], v64
    ds_read_b64 v[24:25], v77 offset:14336
    ds_read_b64 v[26:27], v77 offset:14592
    v_subrev_u32 v72, s47, v72
    v_smfmac_f32_16x16x64_bf16 v[16:19], v[48:51], v[160:167], v64
    ds_read_b64 v[28:29], v77 offset:14848
    ds_read_b64 v[30:31], v77 offset:15104
    v_bitop3_b32 v77, v73, -9, s52 bitop3:0x6a
    v_smfmac_f32_16x16x64_bf16 v[20:23], v[48:51], v[168:175], v64
    s_cbranch_scc1 cs_rare
cs_rare_x:
    ds_read_b128 v[56:59], v70 offset:22528
    ds_read_b128 v[60:63], v70 offset:23552
    s_waitcnt lgkmcnt(6)
    v_pk_add_f32 v[4:5], v[4:5], v[8:9]
    v_pk_add_f32 v[6:7], v[6:7], v[10:11]
    v_pk_add_f32 v[12:13], v[12:13], v[52:53]
    v_pk_add_f32 v[14:15], v[14:15], v[54:55]
    v_pk_add_f32 v[4:5], v[4:5], v[12:13]
    v_pk_add_f32 v[6:7], v[6:7], v[14:15]
    s_waitcnt lgkmcnt(2)
    v_pk_add_f32 v[24:25], v[24:25], v[26:27]
    v_pk_add_f32 v[28:29], v[28:29], v[30:31]
    v_max3_f32 v8, v4, v5, v6
    v_pk_add_f32 v[24:25], v[24:25], v[28:29]
    v_max_f32 v8, v8, v7
    v_max3_f32 v8, v8, v24, v25
    v_cvt_pk_bf16_f32 v32, v16, v17
    v_cvt_pk_bf16_f32 v38, v18, v19
    v_max_f32_dpp v8, v8, v8 row_ror:8 row_mask:0xf bank_mask:0xf
    v_mov_b32 v9, v8
    v_cvt_pk_bf16_f32 v40, v20, v21
    v_cvt_pk_bf16_f32 v46, v22, v23
    v_permlane32_swap_b32 v8, v9
    v_max_f32 v8, v8, v9
    v_mov_b32 v9, v8
    v_mov_b32 v11, 0
    v_mov_b32 v15, 0
    v_permlane16_swap_b32 v8, v9
    v_max_f32 v8, v8, v9
    v_mul_f32 v8, s66, v8
    v_pk_fma_f32 v[4:5], v[4:5], s[44:45], v[8:9] op_sel_hi:[1,1,0]
    v_pk_fma_f32 v[6:7], v[6:7], s[44:45], v[8:9] op_sel_hi:[1,1,0]
    v_pk_fma_f32 v[24:25], v[24:25], s[44:45], v[8:9] op_sel_hi:[1,1,0]
    v_exp_f32 v4, v4
    v_exp_f32 v5, v5
    v_exp_f32 v6, v6
    v_exp_f32 v7, v7
    v_exp_f32 v24, v24
    v_exp_f32 v25, v25
    v_cvt_pk_bf16_f32 v12, v4, v5
    v_cvt_pk_bf16_f32 v13, v6, v7
    v_cvt_pk_bf16_f32 v10, v24, v25
    v_cvt_pk_bf16_f32 v14, v24, v25
    v_mov_b64 v[0:1], s[48:49]
    v_mfma_f32_16x16x32_bf16 v[4:7], v[32:35], v[10:13], 0
    ds_read_b128 v[48:51], v70 offset:20480
    v_mov_b64 v[2:3], s[50:51]
    v_mfma_f32_16x16x32_bf16 v[24:27], v[36:39], v[12:15], 0
    ds_read_b128 v[52:55], v70 offset:21504
    v_mov_b64 v[8:9], 0
    v_mfma_f32_16x16x32_bf16 v[28:31], v[0:3], v[10:13], 0
    ds_read_b128 v[32:35], v70 offset:24576
    v_mov_b64 v[0:1], 0
    v_mfma_f32_16x16x32_bf16 v[16:19], v[40:43], v[10:13], 0
    ds_read_b128 v[36:39], v70 offset:25600
    v_mov_b64 v[2:3], 0
    v_mfma_f32_16x16x32_bf16 v[20:23], v[44:47], v[12:15], 0
    ds_read_b128 v[40:43], v70 offset:26624
    v_add_f32_dpp v4, v24, v4 row_ror:8 row_mask:0xf bank_mask:0xf
    v_add_f32_dpp v5, v25, v5 row_ror:8 row_mask:0xf bank_mask:0xf
    v_add_f32_dpp v6, v26, v6 row_ror:8 row_mask:0xf bank_mask:0xf
    v_add_f32_dpp v7, v27, v7 row_ror:8 row_mask:0xf bank_mask:0xf
    v_add_f32_dpp v29, v28, v28 row_ror:8 row_mask:0xf bank_mask:0xf
    v_rcp_f32 v28, v29
    v_mov_b64 v[10:11], 0
    v_add_f32_dpp v4, v16, v20 row_ror:8 row_mask:0xf bank_mask:0xc
    v_add_f32_dpp v5, v17, v21 row_ror:8 row_mask:0xf bank_mask:0xc
    v_add_f32_dpp v6, v18, v22 row_ror:8 row_mask:0xf bank_mask:0xc
    v_add_f32_dpp v7, v19, v23 row_ror:8 row_mask:0xf bank_mask:0xc
    v_pk_mul_f32 v[4:5], v[4:5], v[28:29] op_sel_hi:[1,0]
    v_pk_mul_f32 v[6:7], v[6:7], v[28:29] op_sel_hi:[1,0]
    v_cvt_pk_bf16_f32 v4, v4, v5
    v_cvt_pk_bf16_f32 v5, v6, v7
    ds_write_b64 v73, v[4:5] offset:12288
    v_mov_b32_dpp v6, v4 row_ror:8 row_mask:0xf bank_mask:0xf
    v_mov_b32_dpp v7, v5 row_ror:8 row_mask:0xf bank_mask:0xf
    v_mov_b64 v[12:13], 0
    v_mov_b64 v[14:15], 0
    v_smfmac_f32_16x16x64_bf16 v[8:11], v[4:7], v[80:87], v64
    s_waitcnt lgkmcnt(4)
    v_mov_b64 v[24:25], 0
    v_smfmac_f32_16x16x64_bf16 v[0:3], v[4:7], v[48:55], v64
    ds_read_b128 v[44:47], v70 offset:27648
    v_mov_b64 v[26:27], 0
    v_smfmac_f32_16x16x64_bf16 v[12:15], v[4:7], v[112:119], v64
    s_waitcnt lgkmcnt(1)
    s_barrier
    ds_read_b128 v[16:19], v77 offset:12288
    v_smfmac_f32_16x16x64_bf16 v[24:27], v[4:7], v[56:63], v64
    ds_read_b128 v[20:23], v78 offset:12288
    ds_read_b128 v[28:31], v79 offset:12288
    v_mov_b64 v[4:5], 0
    v_mov_b64 v[6:7], 0
    v_bfe_u32 v77, v74, 16, 1
    v_mad_i32_i24 v77, v77, s56, v74
    s_waitcnt lgkmcnt(2)
    v_smfmac_f32_16x16x64_bf16 v[8:11], v[16:19], v[88:95], v64
    ds_read_b128 v[56:59], v70 offset:28672
    v_smfmac_f32_16x16x64_bf16 v[12:15], v[16:19], v[120:127], v64
    ds_read_b128 v[60:63], v70 offset:29696
    s_waitcnt lgkmcnt(3)
    v_smfmac_f32_16x16x64_bf16 v[8:11], v[20:23], v[96:103], v64
    ds_read_b128 v[48:51], v70 offset:30720
    v_smfmac_f32_16x16x64_bf16 v[12:15], v[20:23], v[128:135], v64
    ds_read_b128 v[52:55], v70 offset:31744
    s_waitcnt lgkmcnt(4)
    v_smfmac_f32_16x16x64_bf16 v[8:11], v[28:31], v[104:111], v64
    s_add_u32 s30, s30, 1
    s_xor_b32 s70, s70, 1
    s_cmp_lg_u32 s71, 0
    v_smfmac_f32_16x16x64_bf16 v[12:15], v[28:31], v[136:143], v64
    s_nop 2
    v_smfmac_f32_16x16x64_bf16 v[0:3], v[16:19], v[32:39], v64
    ds_read_b128 v[32:35], v70 offset:32768
    ds_read_b128 v[36:39], v70 offset:33792
    v_cvt_pk_bf16_f32 v8, v8, v9
    v_cvt_pk_bf16_f32 v9, v10, v11
    v_and_or_b32 v8, v8, -2, s69
    v_cvt_pk_bf16_f32 v10, v12, v13
    v_cvt_pk_bf16_f32 v11, v14, v15
    v_smfmac_f32_16x16x64_bf16 v[24:27], v[16:19], v[40:47], v64
    buffer_store_dwordx4 v[8:11], v74, s[4:7], s22 offen sc1
    ds_read_b128 v[40:43], v70 offset:34816
    s_waitcnt lgkmcnt(3)
    v_smfmac_f32_16x16x64_bf16 v[0:3], v[20:23], v[56:63], v64
    ds_read_b128 v[44:47], v70 offset:35840
    ds_read_b128 v[56:59], v72 offset:12288
    v_smfmac_f32_16x16x64_bf16 v[24:27], v[20:23], v[48:55], v64
    ds_read_b128 v[60:63], v72 offset:13312
    s_waitcnt lgkmcnt(4)
    v_smfmac_f32_16x16x64_bf16 v[0:3], v[28:31], v[32:39], v64
    s_waitcnt lgkmcnt(2)
    s_nop 1
    v_smfmac_f32_16x16x64_bf16 v[24:27], v[28:31], v[40:47], v64
    s_waitcnt lgkmcnt(0)
    s_nop 1
    v_smfmac_f32_16x16x64_bf16 v[4:7], v[56:59], v[144:151], v64
    v_cvt_pk_bf16_f32 v0, v0, v1
    v_cvt_pk_bf16_f32 v1, v2, v3
    v_and_or_b32 v0, v0, -2, s69
    s_nop 0
    v_cvt_pk_bf16_f32 v2, v24, v25
    v_cvt_pk_bf16_f32 v3, v26, v27
    v_smfmac_f32_16x16x64_bf16 v[4:7], v[60:63], v[152:159], v64
    buffer_store_dwordx4 v[0:3], v74, s[4:7], s23 offen sc1
    s_nop 6
    v_cvt_pk_bf16_f32 v4, v4, v5
    v_cvt_pk_bf16_f32 v5, v6, v7
    v_and_or_b32 v4, v4, -2, s69
    buffer_store_dwordx2 v[4:5], v77, s[4:7], s25 offen sc1
    s_cbranch_scc1 cs_e1
    s_nop 2
    v_mov_b32 v79, v79
    s_nop 2
    v_mov_b32 v79, v79
    s_nop 2
    v_mov_b32 v79, v79
    s_nop 2
    v_mov_b32 v79, v79
    s_nop 2
    v_mov_b32 v79, v79
    s_nop 2
    v_mov_b32 v79, v79
    s_nop 2
    v_mov_b32 v79, v79
    s_nop 2
    v_mov_b32 v79, v79
    s_nop 2
    v_mov_b32 v79, v79
    s_nop 2
    v_mov_b32 v79, v79
    s_nop 2
    v_mov_b32 v79, v79
    s_nop 2
    v_mov_b32 v79, v79
    s_nop 2
    v_mov_b32 v79, v79
    s_nop 2
    v_mov_b32 v79, v79
    s_nop 2
    v_mov_b32 v79, v79
    s_nop 2
    v_mov_b32 v79, v79
    s_nop 2
    v_mov_b32 v79, v79
    s_nop 2
    v_mov_b32 v79, v79
    s_nop 2
    v_mov_b32 v79, v79
    s_nop 2
    v_mov_b32 v79, v79
    s_nop 2
    v_mov_b32 v79, v79
    s_nop 2
    v_mov_b32 v79, v79
    s_nop 2
    v_mov_b32 v79, v79
    s_nop 2
    v_mov_b32 v79, v79
    s_nop 2
    v_mov_b32 v79, v79
    s_nop 2
    v_mov_b32 v79, v79
    s_nop 2
    v_mov_b32 v79, v79
    s_nop 2
    v_mov_b32 v79, v79
    s_nop 2
    v_mov_b32 v79, v79
    s_nop 2
    v_mov_b32 v79, v79
    s_nop 2
    v_mov_b32 v79, v79
    s_nop 2
    v_mov_b32 v79, v79
    s_nop 2
    v_mov_b32 v79, v79
    s_nop 2
    v_mov_b32 v79, v79
    s_nop 2
    v_mov_b32 v79, v79
    s_nop 2
    v_mov_b32 v79, v79
    s_nop 2
    v_mov_b32 v79, v79
    s_nop 0
    v_mov_b32 v79, v79
    buffer_load_dwordx4 v[8:11], v65, s[4:7], s18 offen sc1
    buffer_load_dwordx4 v[12:15], v65, s[4:7], s19 offen sc1
    buffer_load_dwordx4 v[16:19], v65, s[4:7], s20 offen sc1
    buffer_load_dwordx4 v[20:23], v65, s[4:7], s21 offen sc1
    v_and_b32 v77, 255, v69
    ds_read_b128 v[4:7], v77 offset:15872
    ds_read_b128 v[40:43], v70 offset:0
    ds_read_b128 v[44:47], v70 offset:1024
    ds_read_b128 v[48:51], v70 offset:2048
    ds_read_b128 v[52:55], v70 offset:3072
    ds_read_b128 v[24:27], v70 offset:4096
    ds_read_b128 v[28:31], v70 offset:5120
    ds_read_b128 v[32:35], v70 offset:6144
    ds_read_b128 v[36:39], v70 offset:7168
    s_mov_b32 s31, 65536
    s_add_u32 s24, s24, 524288
    s_add_u32 s26, s26, 524288
    s_add_u32 s55, s55, s57
    s_cmp_lt_u32 s97, s93
    s_cselect_b32 s37, 1, 0
    s_cmp_ge_u32 s30, 58
    s_cselect_b32 s37, 1, s37
    s_mov_b32 s14, 67633152
    s_mov_b32 s15, 67637248
    s_mov_b32 s16, 67641344
    s_mov_b32 s36, 1
    v_mov_b32 v60, s69
    v_mov_b32 v56, s69
    v_and_b32 v79, 12, v75
    v_cmp_eq_u32 vcc, 0, v79
    s_nop 1
    v_cndmask_b32 v79, 0, 1, vcc
    s_waitcnt lgkmcnt(0)
    s_waitcnt vmcnt(3)
    v_xor_b32 v77, s69, v8
    v_mfma_f32_16x16x32_bf16 v[0:3], v[4:7], v[8:11], 0
    v_mov_b64 v[8:9], 0
    v_mov_b64 v[10:11], 0
    s_waitcnt vmcnt(2)
    v_bitop3_b32 v77, v77, v12, s69 bitop3:0xf6
    v_mfma_f32_16x16x32_bf16 v[0:3], v[4:7], v[12:15], v[0:3]
    v_mov_b64 v[12:13], 0
    v_mov_b64 v[14:15], 0
    s_waitcnt vmcnt(1)
    v_bitop3_b32 v77, v77, v16, s69 bitop3:0xf6
    v_mfma_f32_16x16x32_bf16 v[0:3], v[4:7], v[16:19], v[0:3]
    v_mov_b64 v[16:17], 0
    v_mov_b64 v[18:19], 0
    s_waitcnt vmcnt(0)
    v_bitop3_b32 v77, v77, v20, s69 bitop3:0xf6
    v_mfma_f32_16x16x32_bf16 v[0:3], v[4:7], v[20:23], v[0:3]
    v_and_b32 v77, 1, v77
    v_cmp_ne_u32 vcc, 0, v77
    v_mov_b64 v[20:21], 0
    v_mov_b64 v[22:23], 0
    s_cmp_eq_u64 vcc, 0
    s_cselect_b64 s[42:43], -1, 0
    s_nop 1
    v_add_f32_dpp v0, v0, v0 row_ror:8 row_mask:0xf bank_mask:0xf
    v_add_f32_dpp v1, v1, v1 row_ror:8 row_mask:0xf bank_mask:0xf
    s_mov_b64 exec, s[42:43]
    v_cvt_pk_bf16_f32 v72, v0, v1
    v_bfi_b32 v72, v79, s70, v72
    buffer_store_dword v72, v75, s[4:7], s17 offen offset:0 sc1
    s_mov_b64 exec, -1
    s_cbranch_scc0 cs_f0_retry
cs_f0_go:
    v_mov_b64 v[0:1], 0
    v_mov_b64 v[2:3], 0
    v_mov_b64 v[4:5], 0
    v_mov_b64 v[6:7], 0
    s_nop 2
    v_mov_b32 v79, v79
    s_nop 2
    v_mov_b32 v79, v79
    s_nop 2
    v_mov_b32 v79, v79
    s_nop 2
    v_mov_b32 v79, v79
    s_nop 2
    v_mov_b32 v79, v79
    s_nop 2
    v_mov_b32 v79, v79
    s_nop 2
    v_mov_b32 v79, v79
    s_nop 2
    v_mov_b32 v79, v79
    s_nop 2
    v_mov_b32 v79, v79
    s_nop 2
    v_mov_b32 v79, v79
    s_nop 2
    v_mov_b32 v79, v79
    s_nop 2
    v_mov_b32 v79, v79
    s_nop 2
    v_mov_b32 v79, v79
    s_nop 2
    v_mov_b32 v79, v79
    s_nop 2
    v_mov_b32 v79, v79
    s_nop 2
    v_mov_b32 v79, v79
    s_nop 2
    v_mov_b32 v79, v79
    s_nop 2
    v_mov_b32 v79, v79
    s_nop 2
    v_mov_b32 v79, v79
    s_nop 2
    v_mov_b32 v79, v79
    s_nop 2
    v_mov_b32 v79, v79
    s_nop 2
    v_mov_b32 v79, v79
    s_nop 2
    v_mov_b32 v79, v79
    s_nop 2
    v_mov_b32 v79, v79
    s_nop 2
    v_mov_b32 v79, v79
    s_branch cs_loop
cs_e1:
    s_cmp_lg_u32 s71, 2
    s_cbranch_scc1 cs_f1
    v_and_b32 v77, 255, v69
    ds_read_b128 v[4:7], v77 offset:15872
    ds_read_b128 v[40:43], v70 offset:0
    ds_read_b128 v[44:47], v70 offset:1024
    ds_read_b128 v[48:51], v70 offset:2048
    ds_read_b128 v[52:55], v70 offset:3072
    ds_read_b128 v[24:27], v70 offset:4096
    ds_read_b128 v[28:31], v70 offset:5120
    ds_read_b128 v[32:35], v70 offset:6144
    ds_read_b128 v[36:39], v70 offset:7168
    s_mov_b32 s31, 65536
    s_add_u32 s24, s24, 524288
    s_add_u32 s26, s26, 524288
    s_add_u32 s55, s55, s57
    s_cmp_lt_u32 s97, s93
    s_cselect_b32 s37, 1, 0
    s_cmp_ge_u32 s30, 58
    s_cselect_b32 s37, 1, s37
    s_mov_b32 s14, 67633152
    s_mov_b32 s15, 67637248
    s_mov_b32 s16, 67641344
    s_mov_b32 s36, 1
    v_mov_b32 v60, s69
    v_mov_b32 v56, s69
    v_and_b32 v79, 12, v75
    v_cmp_eq_u32 vcc, 0, v79
    s_nop 1
    v_cndmask_b32 v79, 0, 1, vcc
    s_nop 2
    v_mov_b32 v79, v79
    s_nop 2
    v_mov_b32 v79, v79
    s_nop 2
    v_mov_b32 v79, v79
    s_nop 2
    v_mov_b32 v79, v79
    s_nop 2
    v_mov_b32 v79, v79
    s_nop 2
    v_mov_b32 v79, v79
    s_nop 2
    v_mov_b32 v79, v79
    s_nop 2
    v_mov_b32 v79, v79
    s_nop 2
    v_mov_b32 v79, v79
    s_nop 2
    v_mov_b32 v79, v79
    s_nop 2
    v_mov_b32 v79, v79
    s_nop 2
    v_mov_b32 v79, v79
    s_nop 2
    v_mov_b32 v79, v79
    s_nop 2
    v_mov_b32 v79, v79
    s_nop 2
    v_mov_b32 v79, v79
    s_nop 2
    v_mov_b32 v79, v79
    s_nop 2
    v_mov_b32 v79, v79
    s_nop 2
    v_mov_b32 v79, v79
    s_nop 2
    v_mov_b32 v79, v79
    s_nop 2
    v_mov_b32 v79, v79
    s_nop 2
    v_mov_b32 v79, v79
    s_nop 2
    v_mov_b32 v79, v79
    s_nop 2
    v_mov_b32 v79, v79
    s_nop 2
    v_mov_b32 v79, v79
    s_nop 2
    v_mov_b32 v79, v79
    s_nop 2
    v_mov_b32 v79, v79
    s_nop 2
    v_mov_b32 v79, v79
    s_nop 2
    v_mov_b32 v79, v79
    s_nop 2
    v_mov_b32 v79, v79
    s_nop 2
    v_mov_b32 v79, v79
    s_nop 2
    v_mov_b32 v79, v79
    s_nop 2
    v_mov_b32 v79, v79
    s_nop 2
    v_mov_b32 v79, v79
    s_nop 2
    v_mov_b32 v79, v79
    s_nop 2
    v_mov_b32 v79, v79
    s_nop 2
    v_mov_b32 v79, v79
    s_nop 2
    v_mov_b32 v79, v79
    s_nop 0
    v_mov_b32 v79, v79
    s_waitcnt vmcnt(0)
    buffer_load_dwordx4 v[8:11], v65, s[4:7], s18 offen sc1
    buffer_load_dwordx4 v[12:15], v65, s[4:7], s19 offen sc1
    buffer_load_dwordx4 v[16:19], v65, s[4:7], s20 offen sc1
    buffer_load_dwordx4 v[20:23], v65, s[4:7], s21 offen sc1
    s_nop 2
    v_mov_b32 v79, v79
    s_nop 2
    v_mov_b32 v79, v79
    s_nop 2
    v_mov_b32 v79, v79
    s_nop 2
    v_mov_b32 v79, v79
    s_nop 2
    v_mov_b32 v79, v79
    s_nop 2
    v_mov_b32 v79, v79
    s_nop 2
    v_mov_b32 v79, v79
    s_nop 2
    v_mov_b32 v79, v79
    s_nop 2
    v_mov_b32 v79, v79
    s_nop 2
    v_mov_b32 v79, v79
    buffer_load_dwordx4 v[60:63], v65, s[4:7], s14 offen offset:0 sc1
    buffer_load_dwordx4 v[56:59], v66, s[4:7], s14 offen offset:0 sc1
    s_waitcnt lgkmcnt(0)
    s_waitcnt vmcnt(5)
    v_xor_b32 v77, s69, v8
    v_bitop3_b32 v77, v77, v10, s69 bitop3:0xf6
    v_mfma_f32_16x16x32_bf16 v[0:3], v[4:7], v[8:11], 0
    v_mov_b64 v[8:9], 0
    v_mov_b64 v[10:11], 0
    s_waitcnt vmcnt(4)
    v_bitop3_b32 v77, v77, v12, s69 bitop3:0xf6
    v_bitop3_b32 v77, v77, v14, s69 bitop3:0xf6
    v_mfma_f32_16x16x32_bf16 v[0:3], v[4:7], v[12:15], v[0:3]
    v_mov_b64 v[12:13], 0
    v_mov_b64 v[14:15], 0
    s_waitcnt vmcnt(3)
    v_bitop3_b32 v77, v77, v16, s69 bitop3:0xf6
    v_bitop3_b32 v77, v77, v18, s69 bitop3:0xf6
    v_mfma_f32_16x16x32_bf16 v[0:3], v[4:7], v[16:19], v[0:3]
    v_mov_b64 v[16:17], 0
    v_mov_b64 v[18:19], 0
    s_waitcnt vmcnt(2)
    v_bitop3_b32 v77, v77, v20, s69 bitop3:0xf6
    v_bitop3_b32 v77, v77, v22, s69 bitop3:0xf6
    v_mfma_f32_16x16x32_bf16 v[0:3], v[4:7], v[20:23], v[0:3]
    v_and_b32 v77, 1, v77
    v_cmp_ne_u32 vcc, 0, v77
    v_mov_b64 v[20:21], 0
    v_mov_b64 v[22:23], 0
    buffer_load_dwordx4 v[60:63], v65, s[4:7], s14 offen offset:0 sc1
    buffer_load_dwordx4 v[56:59], v66, s[4:7], s14 offen offset:0 sc1
    s_cmp_eq_u64 vcc, 0
    s_cselect_b64 s[42:43], -1, 0
    v_add_f32 v2, v0, v1
    s_nop 1
    v_add_f32_dpp v2, v2, v2 row_ror:8 row_mask:0xf bank_mask:0xf
    s_nop 1
    v_mov_b32_dpp v0, v2 quad_perm:[0,0,2,2] row_mask:0xf bank_mask:0xf
    v_mov_b32_dpp v1, v2 quad_perm:[1,1,3,3] row_mask:0xf bank_mask:0xf
    s_mov_b64 exec, s[42:43]
    v_cvt_pk_bf16_f32 v72, v0, v1
    v_bfi_b32 v72, v79, s70, v72
    buffer_store_dword v72, v75, s[4:7], s17 offen offset:0 sc1
    buffer_store_dword v72, v75, s[4:7], s17 offen offset:1024 sc1
    buffer_store_dword v72, v75, s[4:7], s17 offen offset:2048 sc1
    buffer_store_dword v72, v75, s[4:7], s17 offen offset:3072 sc1
    s_mov_b64 exec, -1
    s_cbranch_scc0 cs_f2_retry
cs_f2_go:
    v_mov_b64 v[0:1], 0
    v_mov_b64 v[2:3], 0
    v_mov_b64 v[4:5], 0
    v_mov_b64 v[6:7], 0
    s_nop 2
    v_mov_b32 v79, v79
    s_nop 2
    v_mov_b32 v79, v79
    s_nop 2
    v_mov_b32 v79, v79
    s_nop 2
    v_mov_b32 v79, v79
    s_nop 2
    v_mov_b32 v79, v79
    s_nop 2
    v_mov_b32 v79, v79
    s_nop 2
    v_mov_b32 v79, v79
    s_nop 2
    v_mov_b32 v79, v79
    s_nop 2
    v_mov_b32 v79, v79
    s_nop 2
    v_mov_b32 v79, v79
    s_nop 2
    v_mov_b32 v79, v79
    s_nop 2
    v_mov_b32 v79, v79
    s_nop 2
    v_mov_b32 v79, v79
    s_nop 2
    v_mov_b32 v79, v79
    s_nop 2
    v_mov_b32 v79, v79
    s_nop 2
    v_mov_b32 v79, v79
    s_nop 2
    v_mov_b32 v79, v79
    s_nop 2
    v_mov_b32 v79, v79
    s_nop 2
    v_mov_b32 v79, v79
    s_nop 2
    v_mov_b32 v79, v79
    s_nop 2
    v_mov_b32 v79, v79
    s_nop 2
    v_mov_b32 v79, v79
    s_nop 2
    v_mov_b32 v79, v79
    s_nop 2
    v_mov_b32 v79, v79
    s_nop 2
    v_mov_b32 v79, v79
    s_branch cs_loop
cs_f1:
    s_cmp_lg_u32 s32, 1
    s_cbranch_scc1 cs_f3
    v_and_b32 v77, 255, v69
    ds_read_b128 v[4:7], v77 offset:15872
    ds_read_b128 v[40:43], v70 offset:0
    ds_read_b128 v[44:47], v70 offset:1024
    ds_read_b128 v[48:51], v70 offset:2048
    ds_read_b128 v[52:55], v70 offset:3072
    ds_read_b128 v[24:27], v70 offset:4096
    ds_read_b128 v[28:31], v70 offset:5120
    ds_read_b128 v[32:35], v70 offset:6144
    ds_read_b128 v[36:39], v70 offset:7168
    s_mov_b32 s31, 65536
    s_add_u32 s24, s24, 524288
    s_add_u32 s26, s26, 524288
    s_add_u32 s55, s55, s57
    s_cmp_lt_u32 s97, s93
    s_cselect_b32 s37, 1, 0
    s_cmp_ge_u32 s30, 58
    s_cselect_b32 s37, 1, s37
    s_mov_b32 s14, 67633152
    s_mov_b32 s15, 67637248
    s_mov_b32 s16, 67641344
    s_mov_b32 s36, 1
    v_mov_b32 v60, s69
    v_mov_b32 v56, s69
    v_and_b32 v79, 12, v75
    v_cmp_eq_u32 vcc, 0, v79
    s_nop 1
    v_cndmask_b32 v79, 0, 1, vcc
    s_nop 2
    v_mov_b32 v79, v79
    s_nop 2
    v_mov_b32 v79, v79
    s_nop 2
    v_mov_b32 v79, v79
    s_nop 2
    v_mov_b32 v79, v79
    s_nop 2
    v_mov_b32 v79, v79
    s_nop 2
    v_mov_b32 v79, v79
    s_nop 2
    v_mov_b32 v79, v79
    s_nop 2
    v_mov_b32 v79, v79
    s_nop 2
    v_mov_b32 v79, v79
    s_nop 2
    v_mov_b32 v79, v79
    s_nop 2
    v_mov_b32 v79, v79
    s_nop 2
    v_mov_b32 v79, v79
    s_nop 2
    v_mov_b32 v79, v79
    s_nop 2
    v_mov_b32 v79, v79
    s_nop 2
    v_mov_b32 v79, v79
    s_nop 2
    v_mov_b32 v79, v79
    s_nop 2
    v_mov_b32 v79, v79
    s_nop 2
    v_mov_b32 v79, v79
    s_nop 2
    v_mov_b32 v79, v79
    s_nop 2
    v_mov_b32 v79, v79
    s_nop 2
    v_mov_b32 v79, v79
    s_nop 2
    v_mov_b32 v79, v79
    s_nop 2
    v_mov_b32 v79, v79
    s_nop 2
    v_mov_b32 v79, v79
    s_nop 2
    v_mov_b32 v79, v79
    s_nop 2
    v_mov_b32 v79, v79
    s_nop 2
    v_mov_b32 v79, v79
    s_nop 2
    v_mov_b32 v79, v79
    s_nop 2
    v_mov_b32 v79, v79
    s_nop 2
    v_mov_b32 v79, v79
    s_nop 2
    v_mov_b32 v79, v79
    s_nop 2
    v_mov_b32 v79, v79
    s_nop 2
    v_mov_b32 v79, v79
    s_nop 2
    v_mov_b32 v79, v79
    s_nop 2
    v_mov_b32 v79, v79
    s_nop 2
    v_mov_b32 v79, v79
    s_nop 2
    v_mov_b32 v79, v79
    s_nop 0
    v_mov_b32 v79, v79
    s_waitcnt vmcnt(0)
    buffer_load_dwordx4 v[8:11], v65, s[4:7], s18 offen sc1
    buffer_load_dwordx4 v[12:15], v65, s[4:7], s19 offen sc1
    buffer_load_dwordx4 v[16:19], v65, s[4:7], s20 offen sc1
    buffer_load_dwordx4 v[20:23], v65, s[4:7], s21 offen sc1
    s_nop 2
    v_mov_b32 v79, v79
    s_nop 2
    v_mov_b32 v79, v79
    s_nop 2
    v_mov_b32 v79, v79
    s_nop 2
    v_mov_b32 v79, v79
    s_nop 2
    v_mov_b32 v79, v79
    s_nop 2
    v_mov_b32 v79, v79
    s_nop 2
    v_mov_b32 v79, v79
    s_nop 2
    v_mov_b32 v79, v79
    s_nop 2
    v_mov_b32 v79, v79
    s_nop 2
    v_mov_b32 v79, v79
    buffer_load_dwordx4 v[60:63], v65, s[4:7], s14 offen offset:0 sc1
    buffer_load_dwordx4 v[56:59], v66, s[4:7], s14 offen offset:0 sc1
    s_waitcnt lgkmcnt(0)
    s_waitcnt vmcnt(5)
    v_xor_b32 v77, s69, v8
    v_mfma_f32_16x16x32_bf16 v[0:3], v[4:7], v[8:11], 0
    v_mov_b64 v[8:9], 0
    v_mov_b64 v[10:11], 0
    s_waitcnt vmcnt(4)
    v_bitop3_b32 v77, v77, v12, s69 bitop3:0xf6
    v_mfma_f32_16x16x32_bf16 v[0:3], v[4:7], v[12:15], v[0:3]
    v_mov_b64 v[12:13], 0
    v_mov_b64 v[14:15], 0
    s_waitcnt vmcnt(3)
    v_bitop3_b32 v77, v77, v16, s69 bitop3:0xf6
    v_mfma_f32_16x16x32_bf16 v[0:3], v[4:7], v[16:19], v[0:3]
    v_mov_b64 v[16:17], 0
    v_mov_b64 v[18:19], 0
    s_waitcnt vmcnt(2)
    v_bitop3_b32 v77, v77, v20, s69 bitop3:0xf6
    v_mfma_f32_16x16x32_bf16 v[0:3], v[4:7], v[20:23], v[0:3]
    v_and_b32 v77, 1, v77
    v_cmp_ne_u32 vcc, 0, v77
    v_mov_b64 v[20:21], 0
    v_mov_b64 v[22:23], 0
    buffer_load_dwordx4 v[60:63], v65, s[4:7], s14 offen offset:0 sc1
    buffer_load_dwordx4 v[56:59], v66, s[4:7], s14 offen offset:0 sc1
    s_cmp_eq_u64 vcc, 0
    s_cselect_b64 s[42:43], -1, 0
    v_add_f32_dpp v0, v0, v0 row_ror:8 row_mask:0xf bank_mask:0xf
    v_add_f32_dpp v1, v1, v1 row_ror:8 row_mask:0xf bank_mask:0xf
    s_mov_b64 exec, s[42:43]
    v_cvt_pk_bf16_f32 v72, v0, v1
    v_bfi_b32 v72, v79, s70, v72
    buffer_store_dword v72, v75, s[4:7], s17 offen offset:0 sc1
    s_mov_b64 exec, -1
    s_cbranch_scc0 cs_f1_retry
cs_f1_go:
    v_mov_b64 v[0:1], 0
    v_mov_b64 v[2:3], 0
    v_mov_b64 v[4:5], 0
    v_mov_b64 v[6:7], 0
    s_nop 2
    v_mov_b32 v79, v79
    s_nop 2
    v_mov_b32 v79, v79
    s_nop 2
    v_mov_b32 v79, v79
    s_nop 2
    v_mov_b32 v79, v79
    s_nop 2
    v_mov_b32 v79, v79
    s_nop 2
    v_mov_b32 v79, v79
    s_nop 2
    v_mov_b32 v79, v79
    s_nop 2
    v_mov_b32 v79, v79
    s_nop 2
    v_mov_b32 v79, v79
    s_nop 2
    v_mov_b32 v79, v79
    s_nop 2
    v_mov_b32 v79, v79
    s_nop 2
    v_mov_b32 v79, v79
    s_nop 2
    v_mov_b32 v79, v79
    s_nop 2
    v_mov_b32 v79, v79
    s_nop 2
    v_mov_b32 v79, v79
    s_nop 2
    v_mov_b32 v79, v79
    s_nop 2
    v_mov_b32 v79, v79
    s_nop 2
    v_mov_b32 v79, v79
    s_nop 2
    v_mov_b32 v79, v79
    s_nop 2
    v_mov_b32 v79, v79
    s_nop 2
    v_mov_b32 v79, v79
    s_nop 2
    v_mov_b32 v79, v79
    s_nop 2
    v_mov_b32 v79, v79
    s_nop 2
    v_mov_b32 v79, v79
    s_nop 2
    v_mov_b32 v79, v79
    s_branch cs_loop
cs_f3:
    v_and_b32 v77, 255, v69
    ds_read_b128 v[4:7], v77 offset:15872
    ds_read_b128 v[40:43], v70 offset:0
    ds_read_b128 v[44:47], v70 offset:1024
    ds_read_b128 v[48:51], v70 offset:2048
    ds_read_b128 v[52:55], v70 offset:3072
    ds_read_b128 v[24:27], v70 offset:4096
    ds_read_b128 v[28:31], v70 offset:5120
    ds_read_b128 v[32:35], v70 offset:6144
    ds_read_b128 v[36:39], v70 offset:7168
    s_mov_b32 s31, 65536
    s_add_u32 s24, s24, 524288
    s_add_u32 s26, s26, 524288
    s_add_u32 s55, s55, s57
    s_cmp_lt_u32 s97, s93
    s_cselect_b32 s37, 1, 0
    s_cmp_ge_u32 s30, 58
    s_cselect_b32 s37, 1, s37
    s_mov_b32 s14, 67633152
    s_mov_b32 s15, 67637248
    s_mov_b32 s16, 67641344
    s_mov_b32 s36, 1
    v_mov_b32 v60, s69
    v_mov_b32 v56, s69
    v_and_b32 v79, 12, v75
    v_cmp_eq_u32 vcc, 0, v79
    s_nop 1
    v_cndmask_b32 v79, 0, 1, vcc
    s_add_u32 s40, s30, s95
    v_mov_b32 v72, s40
    s_waitcnt lgkmcnt(0)
    v_mov_b64 v[0:1], 0
    v_mov_b64 v[2:3], 0
    v_mov_b64 v[4:5], 0
    v_mov_b64 v[6:7], 0
    v_mov_b64 v[8:9], 0
    v_mov_b64 v[10:11], 0
    v_mov_b64 v[12:13], 0
    v_mov_b64 v[14:15], 0
    v_mov_b64 v[16:17], 0
    v_mov_b64 v[18:19], 0
    v_mov_b64 v[20:21], 0
    v_mov_b64 v[22:23], 0
    s_nop 2
    v_mov_b32 v79, v79
    s_nop 2
    v_mov_b32 v79, v79
    s_nop 2
    v_mov_b32 v79, v79
    s_nop 2
    v_mov_b32 v79, v79
    s_nop 2
    v_mov_b32 v79, v79
    s_nop 2
    v_mov_b32 v79, v79
    s_nop 2
    v_mov_b32 v79, v79
    s_nop 2
    v_mov_b32 v79, v79
    s_nop 2
    v_mov_b32 v79, v79
    s_nop 2
    v_mov_b32 v79, v79
    s_nop 2
    v_mov_b32 v79, v79
    s_nop 2
    v_mov_b32 v79, v79
    s_nop 2
    v_mov_b32 v79, v79
    s_nop 2
    v_mov_b32 v79, v79
    s_nop 2
    v_mov_b32 v79, v79
    s_nop 2
    v_mov_b32 v79, v79
    s_nop 2
    v_mov_b32 v79, v79
    s_nop 2
    v_mov_b32 v79, v79
    s_nop 2
    v_mov_b32 v79, v79
    s_nop 2
    v_mov_b32 v79, v79
    s_nop 2
    v_mov_b32 v79, v79
    s_nop 2
    v_mov_b32 v79, v79
    s_nop 2
    v_mov_b32 v79, v79
    s_nop 2
    v_mov_b32 v79, v79
    s_nop 2
    v_mov_b32 v79, v79
    s_nop 2
    v_mov_b32 v79, v79
    s_nop 2
    v_mov_b32 v79, v79
    s_nop 2
    v_mov_b32 v79, v79
    s_nop 2
    v_mov_b32 v79, v79
    s_nop 2
    v_mov_b32 v79, v79
    s_nop 2
    v_mov_b32 v79, v79
    s_nop 2
    v_mov_b32 v79, v79
    s_nop 2
    v_mov_b32 v79, v79
    s_nop 2
    v_mov_b32 v79, v79
    s_nop 2
    v_mov_b32 v79, v79
    s_nop 2
    v_mov_b32 v79, v79
    s_nop 2
    v_mov_b32 v79, v79
    s_nop 2
    v_mov_b32 v79, v79
    s_nop 2
    v_mov_b32 v79, v79
    s_nop 2
    v_mov_b32 v79, v79
    s_nop 2
    v_mov_b32 v79, v79
    s_nop 2
    v_mov_b32 v79, v79
    s_nop 2
    v_mov_b32 v79, v79
    s_nop 2
    v_mov_b32 v79, v79
    s_nop 2
    v_mov_b32 v79, v79
    s_nop 2
    v_mov_b32 v79, v79
    s_nop 2
    v_mov_b32 v79, v79
    s_nop 2
    v_mov_b32 v79, v79
    s_nop 2
    v_mov_b32 v79, v79
    s_nop 2
    v_mov_b32 v79, v79
    s_nop 2
    v_mov_b32 v79, v79
    s_nop 2
    v_mov_b32 v79, v79
    s_nop 2
    v_mov_b32 v79, v79
    s_nop 2
    v_mov_b32 v79, v79
    s_nop 2
    v_mov_b32 v79, v79
    s_nop 2
    v_mov_b32 v79, v79
    s_nop 2
    v_mov_b32 v79, v79
    s_nop 2
    v_mov_b32 v79, v79
    s_nop 2
    v_mov_b32 v79, v79
    s_nop 2
    v_mov_b32 v79, v79
    s_nop 2
    v_mov_b32 v79, v79
    s_nop 2
    v_mov_b32 v79, v79
    s_nop 2
    v_mov_b32 v79, v79
    s_nop 2
    v_mov_b32 v79, v79
    s_nop 2
    v_mov_b32 v79, v79
    s_nop 2
    v_mov_b32 v79, v79
    s_nop 2
    v_mov_b32 v79, v79
    s_nop 2
    v_mov_b32 v79, v79
    s_nop 2
    v_mov_b32 v79, v79
    s_nop 2
    v_mov_b32 v79, v79
    s_nop 2
    v_mov_b32 v79, v79
    s_nop 2
    v_mov_b32 v79, v79
    s_nop 2
    v_mov_b32 v79, v79
    s_nop 2
    v_mov_b32 v79, v79
    s_nop 2
    v_mov_b32 v79, v79
    s_waitcnt vmcnt(0)
    s_branch cs_loop
cs_f0_retry:
cs_f0_spin:
    buffer_load_dwordx4 v[8:11], v65, s[4:7], s18 offen sc1
    buffer_load_dwordx4 v[12:15], v65, s[4:7], s19 offen sc1
    buffer_load_dwordx4 v[16:19], v65, s[4:7], s20 offen sc1
    buffer_load_dwordx4 v[20:23], v65, s[4:7], s21 offen sc1
    s_nop 2
    v_mov_b32 v79, v79
    s_nop 2
    v_mov_b32 v79, v79
    s_nop 2
    v_mov_b32 v79, v79
    s_nop 2
    v_mov_b32 v79, v79
    s_nop 2
    v_mov_b32 v79, v79
    s_nop 2
    v_mov_b32 v79, v79
    buffer_load_dwordx4 v[60:63], v65, s[4:7], s14 offen offset:0 sc1
    buffer_load_dwordx4 v[56:59], v66, s[4:7], s14 offen offset:0 sc1
    s_waitcnt vmcnt(5)
    v_xor_b32 v77, s69, v8
    v_mfma_f32_16x16x32_bf16 v[0:3], v[4:7], v[8:11], 0
    v_mov_b64 v[8:9], 0
    v_mov_b64 v[10:11], 0
    s_waitcnt vmcnt(4)
    v_bitop3_b32 v77, v77, v12, s69 bitop3:0xf6
    v_mfma_f32_16x16x32_bf16 v[0:3], v[4:7], v[12:15], v[0:3]
    v_mov_b64 v[12:13], 0
    v_mov_b64 v[14:15], 0
    s_waitcnt vmcnt(3)
    v_bitop3_b32 v77, v77, v16, s69 bitop3:0xf6
    v_mfma_f32_16x16x32_bf16 v[0:3], v[4:7], v[16:19], v[0:3]
    v_mov_b64 v[16:17], 0
    v_mov_b64 v[18:19], 0
    s_waitcnt vmcnt(2)
    v_bitop3_b32 v77, v77, v20, s69 bitop3:0xf6
    v_mfma_f32_16x16x32_bf16 v[0:3], v[4:7], v[20:23], v[0:3]
    v_and_b32 v77, 1, v77
    v_cmp_ne_u32 vcc, 0, v77
    v_mov_b64 v[20:21], 0
    v_mov_b64 v[22:23], 0
    buffer_load_dwordx4 v[60:63], v65, s[4:7], s14 offen offset:0 sc1
    buffer_load_dwordx4 v[56:59], v66, s[4:7], s14 offen offset:0 sc1
    s_cmp_eq_u64 vcc, 0
    s_cselect_b64 s[42:43], -1, 0
    v_add_f32_dpp v0, v0, v0 row_ror:8 row_mask:0xf bank_mask:0xf
    v_add_f32_dpp v1, v1, v1 row_ror:8 row_mask:0xf bank_mask:0xf
    s_mov_b64 exec, s[42:43]
    v_cvt_pk_bf16_f32 v72, v0, v1
    v_bfi_b32 v72, v79, s70, v72
    buffer_store_dword v72, v75, s[4:7], s17 offen offset:0 sc1
    s_mov_b64 exec, -1
    s_cbranch_scc1 cs_f0_rx
    s_sub_u32 s31, s31, 1
    s_cbranch_scc0 cs_f0_spin
cs_f0_rx:
    v_mov_b64 v[0:1], 0
    v_mov_b64 v[2:3], 0
    v_mov_b64 v[4:5], 0
    v_mov_b64 v[6:7], 0
    s_branch cs_loop
cs_f1_retry:
cs_f1_spin:
    s_nop 0
    buffer_load_dwordx4 v[8:11], v65, s[4:7], s18 offen sc1
    buffer_load_dwordx4 v[12:15], v65, s[4:7], s19 offen sc1
    buffer_load_dwordx4 v[16:19], v65, s[4:7], s20 offen sc1
    buffer_load_dwordx4 v[20:23], v65, s[4:7], s21 offen sc1
    s_nop 2
    v_mov_b32 v79, v79
    s_nop 2
    v_mov_b32 v79, v79
    s_nop 2
    v_mov_b32 v79, v79
    s_nop 2
    v_mov_b32 v79, v79
    s_nop 2
    v_mov_b32 v79, v79
    s_nop 2
    v_mov_b32 v79, v79
    buffer_load_dwordx4 v[60:63], v65, s[4:7], s14 offen offset:0 sc1
    buffer_load_dwordx4 v[56:59], v66, s[4:7], s14 offen offset:0 sc1
    s_waitcnt vmcnt(5)
    v_xor_b32 v77, s69, v8
    v_mfma_f32_16x16x32_bf16 v[0:3], v[4:7], v[8:11], 0
    v_mov_b64 v[8:9], 0
    v_mov_b64 v[10:11], 0
    s_waitcnt vmcnt(4)
    v_bitop3_b32 v77, v77, v12, s69 bitop3:0xf6
    v_mfma_f32_16x16x32_bf16 v[0:3], v[4:7], v[12:15], v[0:3]
    v_mov_b64 v[12:13], 0
    v_mov_b64 v[14:15], 0
    s_waitcnt vmcnt(3)
    v_bitop3_b32 v77, v77, v16, s69 bitop3:0xf6
    v_mfma_f32_16x16x32_bf16 v[0:3], v[4:7], v[16:19], v[0:3]
    v_mov_b64 v[16:17], 0
    v_mov_b64 v[18:19], 0
    s_waitcnt vmcnt(2)
    v_bitop3_b32 v77, v77, v20, s69 bitop3:0xf6
    v_mfma_f32_16x16x32_bf16 v[0:3], v[4:7], v[20:23], v[0:3]
    v_and_b32 v77, 1, v77
    v_cmp_ne_u32 vcc, 0, v77
    v_mov_b64 v[20:21], 0
    v_mov_b64 v[22:23], 0
    buffer_load_dwordx4 v[60:63], v65, s[4:7], s14 offen offset:0 sc1
    buffer_load_dwordx4 v[56:59], v66, s[4:7], s14 offen offset:0 sc1
    s_cmp_eq_u64 vcc, 0
    s_cselect_b64 s[42:43], -1, 0
    v_add_f32_dpp v0, v0, v0 row_ror:8 row_mask:0xf bank_mask:0xf
    v_add_f32_dpp v1, v1, v1 row_ror:8 row_mask:0xf bank_mask:0xf
    s_mov_b64 exec, s[42:43]
    v_cvt_pk_bf16_f32 v72, v0, v1
    v_bfi_b32 v72, v79, s70, v72
    buffer_store_dword v72, v75, s[4:7], s17 offen offset:0 sc1
    s_mov_b64 exec, -1
    s_cbranch_scc1 cs_f1_rx
    s_sub_u32 s31, s31, 1
    s_cbranch_scc0 cs_f1_spin
cs_f1_rx:
    v_mov_b64 v[0:1], 0
    v_mov_b64 v[2:3], 0
    v_mov_b64 v[4:5], 0
    v_mov_b64 v[6:7], 0
    s_branch cs_loop
cs_f2_retry:
cs_f2_spin:
    s_nop 0
    buffer_load_dwordx4 v[8:11], v65, s[4:7], s18 offen sc1
    buffer_load_dwordx4 v[12:15], v65, s[4:7], s19 offen sc1
    buffer_load_dwordx4 v[16:19], v65, s[4:7], s20 offen sc1
    buffer_load_dwordx4 v[20:23], v65, s[4:7], s21 offen sc1
    s_nop 2
    v_mov_b32 v79, v79
    s_nop 2
    v_mov_b32 v79, v79
    s_nop 2
    v_mov_b32 v79, v79
    s_nop 2
    v_mov_b32 v79, v79
    s_nop 2
    v_mov_b32 v79, v79
    s_nop 2
    v_mov_b32 v79, v79
    buffer_load_dwordx4 v[60:63], v65, s[4:7], s14 offen offset:0 sc1
    buffer_load_dwordx4 v[56:59], v66, s[4:7], s14 offen offset:0 sc1
    s_waitcnt vmcnt(5)
    v_xor_b32 v77, s69, v8
    v_bitop3_b32 v77, v77, v10, s69 bitop3:0xf6
    v_mfma_f32_16x16x32_bf16 v[0:3], v[4:7], v[8:11], 0
    v_mov_b64 v[8:9], 0
    v_mov_b64 v[10:11], 0
    s_waitcnt vmcnt(4)
    v_bitop3_b32 v77, v77, v12, s69 bitop3:0xf6
    v_bitop3_b32 v77, v77, v14, s69 bitop3:0xf6
    v_mfma_f32_16x16x32_bf16 v[0:3], v[4:7], v[12:15], v[0:3]
    v_mov_b64 v[12:13], 0
    v_mov_b64 v[14:15], 0
    s_waitcnt vmcnt(3)
    v_bitop3_b32 v77, v77, v16, s69 bitop3:0xf6
    v_bitop3_b32 v77, v77, v18, s69 bitop3:0xf6
    v_mfma_f32_16x16x32_bf16 v[0:3], v[4:7], v[16:19], v[0:3]
    v_mov_b64 v[16:17], 0
    v_mov_b64 v[18:19], 0
    s_waitcnt vmcnt(2)
    v_bitop3_b32 v77, v77, v20, s69 bitop3:0xf6
    v_bitop3_b32 v77, v77, v22, s69 bitop3:0xf6
    v_mfma_f32_16x16x32_bf16 v[0:3], v[4:7], v[20:23], v[0:3]
    v_and_b32 v77, 1, v77
    v_cmp_ne_u32 vcc, 0, v77
    v_mov_b64 v[20:21], 0
    v_mov_b64 v[22:23], 0
    buffer_load_dwordx4 v[60:63], v65, s[4:7], s14 offen offset:0 sc1
    buffer_load_dwordx4 v[56:59], v66, s[4:7], s14 offen offset:0 sc1
    s_cmp_eq_u64 vcc, 0
    s_cselect_b64 s[42:43], -1, 0
    v_add_f32 v2, v0, v1
    s_nop 1
    v_add_f32_dpp v2, v2, v2 row_ror:8 row_mask:0xf bank_mask:0xf
    s_nop 1
    v_mov_b32_dpp v0, v2 quad_perm:[0,0,2,2] row_mask:0xf bank_mask:0xf
    v_mov_b32_dpp v1, v2 quad_perm:[1,1,3,3] row_mask:0xf bank_mask:0xf
    s_mov_b64 exec, s[42:43]
    v_cvt_pk_bf16_f32 v72, v0, v1
    v_bfi_b32 v72, v79, s70, v72
    buffer_store_dword v72, v75, s[4:7], s17 offen offset:0 sc1
    buffer_store_dword v72, v75, s[4:7], s17 offen offset:1024 sc1
    buffer_store_dword v72, v75, s[4:7], s17 offen offset:2048 sc1
    buffer_store_dword v72, v75, s[4:7], s17 offen offset:3072 sc1
    s_mov_b64 exec, -1
    s_cbranch_scc1 cs_f2_rx
    s_sub_u32 s31, s31, 1
    s_cbranch_scc0 cs_f2_spin
cs_f2_rx:
    v_mov_b64 v[0:1], 0
    v_mov_b64 v[2:3], 0
    v_mov_b64 v[4:5], 0
    v_mov_b64 v[6:7], 0
    s_branch cs_loop
cs_spinB:
    buffer_load_dwordx4 v[40:43], v65, s[4:7], s15 offen sc1
cs_spinB_l:
    v_and_b32 v77, s36, v40
    v_cmp_ne_u32 vcc, s70, v77
    s_cbranch_vccz cs_spinB_x
    s_nop 15
    s_nop 15
    s_nop 15
    s_nop 11
    v_and_b32 v77, s36, v40
    v_cmp_ne_u32 vcc, s70, v77
    s_cbranch_vccz cs_spinB_x
    s_nop 15
    s_nop 15
    s_nop 15
    s_nop 11
    v_and_b32 v77, s36, v40
    v_cmp_ne_u32 vcc, s70, v77
    s_cbranch_vccz cs_spinB_x
    s_nop 15
    s_nop 15
    s_nop 15
    s_nop 11
    buffer_load_dwordx4 v[40:43], v65, s[4:7], s15 offen sc1
    s_sub_u32 s31, s31, 16
    s_cbranch_scc0 cs_spinB_l
cs_spinB_x:
    ds_write_b128 v65, v[40:43] offset:4096
    s_waitcnt lgkmcnt(0)
    s_branch cs_backB
cs_spin8:
    buffer_load_dwordx4 v[60:63], v65, s[4:7], s16 offen sc1
cs_spin8_l:
    v_and_b32 v77, s36, v60
    v_cmp_ne_u32 vcc, s70, v77
    s_cbranch_vccz cs_spin8_x
    s_nop 15
    s_nop 15
    s_nop 15
    s_nop 11
    v_and_b32 v77, s36, v60
    v_cmp_ne_u32 vcc, s70, v77
    s_cbranch_vccz cs_spin8_x
    s_nop 15
    s_nop 15
    s_nop 15
    s_nop 11
    v_and_b32 v77, s36, v60
    v_cmp_ne_u32 vcc, s70, v77
    s_cbranch_vccz cs_spin8_x
    s_nop 15
    s_nop 15
    s_nop 15
    s_nop 11
    buffer_load_dwordx4 v[60:63], v65, s[4:7], s16 offen sc1
    s_sub_u32 s31, s31, 16
    s_cbranch_scc0 cs_spin8_l
cs_spin8_x:
    s_branch cs_back8
cs_rare:
    s_cmp_lt_u32 s30, 58
    s_cbranch_scc1 cs_nopub
    s_mov_b64 exec, s[34:35]
    buffer_store_dwordx4 v[0:3], v65, s[4:7], s28 offen sc1
    s_mov_b64 exec, -1
    s_nop 3
    v_cvt_pk_bf16_f32 v48, v16, v17
    v_cvt_pk_bf16_f32 v49, v18, v19
    v_cvt_pk_bf16_f32 v50, v20, v21
    v_cvt_pk_bf16_f32 v51, v22, v23
    buffer_store_dwordx4 v[48:51], v65, s[4:7], s27 offen sc1
    s_add_u32 s28, s28, 131072
    s_add_u32 s27, s27, 131072
    s_cmp_eq_u32 s30, 63
    s_cbranch_scc1 cs_last
cs_nopub:
    s_cmp_ge_u32 s97, s93
    s_cbranch_scc1 cs_rare_x
    s_nop 1
    v_bfe_u32 v48, v65, 2, 8
    s_mov_b64 exec, 0xffff
    buffer_load_dword v48, s[4:7], s96 offen sc1 lds
    s_mov_b64 exec, -1
    s_branch cs_rare_x
cs_kvwait:
    v_bfe_u32 v78, v65, 2, 5
    ds_read_b32 v77, v78 offset:16144
    s_waitcnt lgkmcnt(0)
    v_subrev_u32 v77, s95, v77
    v_cmp_lt_u32 vcc, 16, v77
    s_nop 1
    v_cndmask_b32 v77, v77, 0, vcc
    v_bfe_u32 v79, v78, 2, 2
    v_lshl_add_u32 v77, v77, 2, v79
    s_nop 1
    v_min_u32_dpp v77, v77, v77 row_ror:1 row_mask:0xf bank_mask:0xf
    s_nop 1
    v_min_u32_dpp v77, v77, v77 row_ror:2 row_mask:0xf bank_mask:0xf
    s_nop 1
    v_min_u32_dpp v77, v77, v77 row_ror:4 row_mask:0xf bank_mask:0xf
    s_nop 0
    v_readfirstlane_b32 s97, v77
    s_nop 0
    s_cmp_le_u32 s40, s97
    s_cbranch_scc1 cs_kvw_x
    v_bfe_u32 v78, v65, 2, 5
    s_mov_b32 s31, 4194304
cs_kvw:
    buffer_load_dword v77, v78, s[4:7], s96 offen offset:16 sc1
    s_waitcnt vmcnt(0)
    v_subrev_u32 v77, s95, v77
    v_cmp_lt_u32 vcc, 16, v77
    s_nop 1
    v_cndmask_b32 v77, v77, 0, vcc
    v_bfe_u32 v79, v78, 2, 2
    v_lshl_add_u32 v77, v77, 2, v79
    s_nop 1
    v_min_u32_dpp v77, v77, v77 row_ror:1 row_mask:0xf bank_mask:0xf
    s_nop 1
    v_min_u32_dpp v77, v77, v77 row_ror:2 row_mask:0xf bank_mask:0xf
    s_nop 1
    v_min_u32_dpp v77, v77, v77 row_ror:4 row_mask:0xf bank_mask:0xf
    s_nop 0
    v_readfirstlane_b32 s97, v77
    s_sub_u32 s31, s31, 1
    s_cbranch_scc1 cs_kvw_x
    s_cmp_le_u32 s40, s97
    s_cbranch_scc1 cs_kvw_x
    s_sleep 2
    s_branch cs_kvw
cs_kvw_x:
    s_branch cs_kvok
cs_last:
    s_add_u32 s40, s95, 64
    v_mov_b32 v78, s40
    s_waitcnt vmcnt(0)
    s_barrier
    s_mov_b64 exec, s[100:101]
    buffer_store_dword v78, off, s[4:7], s29 sc1
    s_mov_b64 exec, -1
cs_end:
    s_endpgm
L_xform:
    v_and_b32 v1, 63, v0
    v_and_b32 v2, 15, v1
    v_lshrrev_b32 v3, 4, v1
    v_mov_b32 v7, 0x05040100
    v_mov_b32 v8, 0x07060302
    v_lshrrev_b32 v9, 6, v0
    v_lshlrev_b32 v9, 14, v9
    v_lshlrev_b32 v10, 4, v1
    v_add_u32 v11, v9, v10
    s_mov_b32 s10, 4718592
    s_mov_b32 s11, 0x20000
    s_mov_b64 s[8:9], s[58:59]
xf_f:
    s_sub_u32 s17, s16, 1504
    s_and_b32 s18, s17, 127
    s_lshr_b32 s17, s17, 7
    s_lshl_b32 s19, s17, 4
    v_add_u32 v6, s19, v2
    v_mul_u32_u24 v4, 9216, v3
    v_lshl_add_u32 v4, v6, 4, v4
    v_lshrrev_b32 v5, 2, v2
    v_lshlrev_b32 v5, 11, v5
    v_lshl_add_u32 v5, v3, 8, v5
    v_and_b32 v1, 3, v6
    v_lshl_add_u32 v5, v1, 6, v5
    v_add_u32 v5, v5, v9
    v_cmp_gt_u32 vcc, 72, v6
    s_nop 0
    s_mov_b64 exec, vcc
    s_mul_i32 s20, s18, 36864
    s_add_u32 s21, s20, 0
    buffer_load_dwordx4 v[12:15], v4, s[8:11], s21 offen
    s_add_u32 s21, s20, 1152
    buffer_load_dwordx4 v[16:19], v4, s[8:11], s21 offen
    s_add_u32 s21, s20, 2304
    buffer_load_dwordx4 v[20:23], v4, s[8:11], s21 offen
    s_add_u32 s21, s20, 3456
    buffer_load_dwordx4 v[24:27], v4, s[8:11], s21 offen
    s_add_u32 s21, s20, 4608
    buffer_load_dwordx4 v[28:31], v4, s[8:11], s21 offen
    s_add_u32 s21, s20, 5760
    buffer_load_dwordx4 v[32:35], v4, s[8:11], s21 offen
    s_add_u32 s21, s20, 6912
    buffer_load_dwordx4 v[36:39], v4, s[8:11], s21 offen
    s_add_u32 s21, s20, 8064
    buffer_load_dwordx4 v[40:43], v4, s[8:11], s21 offen
    s_lshl_b32 s20, s18, 11
    s_add_u32 s20, s20, 130023424
    s_waitcnt vmcnt(0)
    v_perm_b32 v76, v16, v12, v7
    v_perm_b32 v77, v24, v20, v7
    v_perm_b32 v78, v32, v28, v7
    v_perm_b32 v79, v40, v36, v7
    ds_write_b128 v5, v[76:79] offset:0
    v_perm_b32 v80, v17, v13, v7
    v_perm_b32 v81, v25, v21, v7
    v_perm_b32 v82, v33, v29, v7
    v_perm_b32 v83, v41, v37, v7
    ds_write_b128 v5, v[80:83] offset:16
    v_perm_b32 v84, v18, v14, v7
    v_perm_b32 v85, v26, v22, v7
    v_perm_b32 v86, v34, v30, v7
    v_perm_b32 v87, v42, v38, v7
    ds_write_b128 v5, v[84:87] offset:32
    v_perm_b32 v88, v19, v15, v7
    v_perm_b32 v89, v27, v23, v7
    v_perm_b32 v90, v35, v31, v7
    v_perm_b32 v91, v43, v39, v7
    ds_write_b128 v5, v[88:91] offset:48
    v_perm_b32 v92, v16, v12, v8
    v_perm_b32 v93, v24, v20, v8
    v_perm_b32 v94, v32, v28, v8
    v_perm_b32 v95, v40, v36, v8
    ds_write_b128 v5, v[92:95] offset:1024
    v_perm_b32 v96, v17, v13, v8
    v_perm_b32 v97, v25, v21, v8
    v_perm_b32 v98, v33, v29, v8
    v_perm_b32 v99, v41, v37, v8
    ds_write_b128 v5, v[96:99] offset:1040
    v_perm_b32 v100, v18, v14, v8
    v_perm_b32 v101, v26, v22, v8
    v_perm_b32 v102, v34, v30, v8
    v_perm_b32 v103, v42, v38, v8
    ds_write_b128 v5, v[100:103] offset:1056
    v_perm_b32 v104, v19, v15, v8
    v_perm_b32 v105, v27, v23, v8
    v_perm_b32 v106, v35, v31, v8
    v_perm_b32 v107, v43, v39, v8
    ds_write_b128 v5, v[104:107] offset:1072
    s_mov_b64 exec, -1
    s_lshl_b32 s21, s17, 20
    s_add_u32 s20, s20, s21
    s_waitcnt lgkmcnt(0)
    ds_read_b128 v[76:79], v11 offset:0
    ds_read_b128 v[80:83], v11 offset:1024
    ds_read_b128 v[84:87], v11 offset:2048
    ds_read_b128 v[88:91], v11 offset:3072
    ds_read_b128 v[92:95], v11 offset:4096
    ds_read_b128 v[96:99], v11 offset:5120
    ds_read_b128 v[100:103], v11 offset:6144
    ds_read_b128 v[104:107], v11 offset:7168
    s_add_u32 s19, s20, 0
    s_waitcnt lgkmcnt(7)
    buffer_store_dwordx4 v[76:79], v10, s[4:7], s19 offen sc1
    s_add_u32 s19, s20, 1024
    s_waitcnt lgkmcnt(6)
    buffer_store_dwordx4 v[80:83], v10, s[4:7], s19 offen sc1
    s_add_u32 s19, s20, 262144
    s_waitcnt lgkmcnt(5)
    buffer_store_dwordx4 v[84:87], v10, s[4:7], s19 offen sc1
    s_add_u32 s19, s20, 263168
    s_waitcnt lgkmcnt(4)
    buffer_store_dwordx4 v[88:91], v10, s[4:7], s19 offen sc1
    s_add_u32 s19, s20, 524288
    s_waitcnt lgkmcnt(3)
    buffer_store_dwordx4 v[92:95], v10, s[4:7], s19 offen sc1
    s_add_u32 s19, s20, 525312
    s_waitcnt lgkmcnt(2)
    buffer_store_dwordx4 v[96:99], v10, s[4:7], s19 offen sc1
    s_add_u32 s19, s20, 786432
    s_waitcnt lgkmcnt(1)
    buffer_store_dwordx4 v[100:103], v10, s[4:7], s19 offen sc1
    s_add_u32 s19, s20, 787456
    s_waitcnt lgkmcnt(0)
    buffer_store_dwordx4 v[104:107], v10, s[4:7], s19 offen sc1
xf_done:
    s_nop 1
    s_setpc_b64 s[46:47]
L_helper:
    s_load_dwordx16 s[64:79], s[0:1], 64
    s_waitcnt lgkmcnt(0)
L_qkv_next:
    s_mov_b32 s37, 4
    v_mov_b32 v250, 1
    v_mov_b32 v251, 163832
    v_cmp_eq_u32 vcc, 0, v0
    s_nop 0
    s_and_saveexec_b64 s[38:39], vcc
    s_cbranch_execz tk37
    buffer_atomic_add v250, off, s[84:87], s37 sc0
    s_waitcnt vmcnt(0)
    ds_write_b32 v251, v250
    s_waitcnt lgkmcnt(0)
tk37:
    s_mov_b64 exec, -1
    s_barrier
    ds_read_b32 v252, v251
    s_waitcnt lgkmcnt(0)
    v_readfirstlane_b32 s36, v252
    s_barrier
    s_nop 3
    s_or_b32 s37, s36, s32
    s_cbranch_scc1 L_non
    s_memrealtime s[90:91]
    s_waitcnt lgkmcnt(0)
    s_lshl_b32 s90, s90, 8
    s_or_b32 s90, s90, 1
    v_mov_b32 v250, s90
    s_mov_b64 exec, 1
    buffer_store_dword v250, off, s[84:87], 0 offset:216 sc1
    s_mov_b64 exec, -1
L_non:
    s_cmp_lt_u32 s36, 192
    s_cbranch_scc1 L_qkv
    s_mov_b32 s88, 4194304
gn38:
    buffer_load_dword v250, off, s[84:87], 0 offset:216 sc1
    s_waitcnt vmcnt(0)
    v_readfirstlane_b32 s95, v250
    s_sub_u32 s88, s88, 1
    s_cbranch_scc1 gn38x
    s_cmp_eq_u32 s95, 0
    s_cbranch_scc1 gn38
gn38x:
    s_cmp_lg_u32 s36, 192
    s_cbranch_scc1 L_ssm_next
    s_cmp_lg_u32 s32, 0
    s_cbranch_scc1 L_exit
    v_and_b32 v3, 31, v0
    v_lshlrev_b32 v3, 7, v3
    s_mov_b32 s17, 0
    s_mov_b32 s23, 125845504
    s_mov_b32 s24, 125853696
    s_mov_b32 s21, 16777216
rl_rwait:
    buffer_load_dword v4, v3, s[4:7], s23 offen sc1
    s_waitcnt vmcnt(0)
    v_subrev_u32 v4, s95, v4
    v_cmp_lt_u32 vcc, 64, v4
    s_nop 1
    v_cndmask_b32 v4, v4, 0, vcc
    s_nop 1
    v_min_u32_dpp v4, v4, v4 row_ror:1 row_mask:0xf bank_mask:0xf
    s_nop 1
    v_min_u32_dpp v4, v4, v4 row_ror:2 row_mask:0xf bank_mask:0xf
    s_nop 1
    v_min_u32_dpp v4, v4, v4 row_ror:4 row_mask:0xf bank_mask:0xf
    s_nop 1
    v_min_u32_dpp v4, v4, v4 row_ror:8 row_mask:0xf bank_mask:0xf
    s_nop 0
    v_readlane_b32 s16, v4, 0
    v_readlane_b32 s22, v4, 16
    s_nop 0
    s_min_u32 s16, s16, s22
    s_sub_u32 s21, s21, 1
    s_cbranch_scc1 rl_x
    s_cmp_gt_u32 s16, s17
    s_cbranch_scc1 rl_rpub
    s_sleep 2
    s_branch rl_rwait
rl_rpub:
    s_mov_b32 s17, s16
    s_add_u32 s22, s16, s95
    v_mov_b32 v4, s22
    s_mov_b64 exec, 1
    buffer_store_dword v4, off, s[4:7], s24 sc1
    s_mov_b64 exec, -1
    s_cmp_lt_u32 s16, 64
    s_cbranch_scc1 rl_rwait
rl_x:
    s_endpgm
L_qkv:
    s_and_b32 s17, s36, 15
    s_lshl_b32 s17, s17, 1
    s_lshr_b32 s36, s36, 4
    s_and_b32 s16, s36, 1
    s_add_u32 s16, s16, 1
    s_lshr_b32 s19, s36, 1
    s_and_b32 s37, s36, 3
    s_cmp_ge_u32 s36, 8
    s_cselect_b32 s16, 0, s16
    s_cselect_b32 s19, s37, s19
    v_lshrrev_b32 v4, 6, v0
    s_nop 0
    v_readfirstlane_b32 s18, v4
    v_lshlrev_b32 v7, 4, v0
    s_cmp_eq_u32 s16, 1
    s_cselect_b64 s[12:13], s[54:55], s[52:53]
    s_cmp_eq_u32 s16, 2
    s_cselect_b64 s[12:13], s[56:57], s[12:13]
    s_mov_b32 s14, 4718592
    s_mov_b32 s15, 0x20000
    v_bfe_u32 v4, v0, 5, 1
    v_lshlrev_b32 v5, 2, v4
    v_and_b32 v8, 31, v0
    v_xor_b32 v8, v8, v5
    v_lshlrev_b32 v8, 4, v8
    v_lshl_add_u32 v8, v4, 13, v8
    v_xor_b32 v9, 128, v8
    s_lshl_b32 s21, s17, 8
    s_lshl_b32 s42, s18, 16
    s_add_u32 s42, s42, s21
    s_lshl_b32 s44, s18, 12
    s_barrier
    s_add_u32 m0, s44, 73728
    s_add_u32 s22, s42, 0
    buffer_load_dwordx4 v8, s[12:15], s22 offen offset:0 lds
    s_add_u32 s22, s42, 15360
    buffer_load_dwordx4 v9, s[12:15], s22 offen offset:1024 lds
    s_add_u32 s22, s42, 30720
    buffer_load_dwordx4 v8, s[12:15], s22 offen offset:2048 lds
    s_add_u32 s22, s42, 46080
    buffer_load_dwordx4 v9, s[12:15], s22 offen offset:3072 lds
    s_add_u32 m0, s44, 90112
    s_add_u32 s22, s42, 262144
    buffer_load_dwordx4 v8, s[12:15], s22 offen offset:0 lds
    s_add_u32 s22, s42, 277504
    buffer_load_dwordx4 v9, s[12:15], s22 offen offset:1024 lds
    s_add_u32 s22, s42, 292864
    buffer_load_dwordx4 v8, s[12:15], s22 offen offset:2048 lds
    s_add_u32 s22, s42, 308224
    buffer_load_dwordx4 v9, s[12:15], s22 offen offset:3072 lds
    s_add_u32 m0, s44, 106496
    s_add_u32 s22, s42, 524288
    buffer_load_dwordx4 v8, s[12:15], s22 offen offset:0 lds
    s_add_u32 s22, s42, 539648
    buffer_load_dwordx4 v9, s[12:15], s22 offen offset:1024 lds
    s_add_u32 s22, s42, 555008
    buffer_load_dwordx4 v8, s[12:15], s22 offen offset:2048 lds
    s_add_u32 s22, s42, 570368
    buffer_load_dwordx4 v9, s[12:15], s22 offen offset:3072 lds
    s_add_u32 m0, s44, 122880
    s_add_u32 s22, s42, 786432
    buffer_load_dwordx4 v8, s[12:15], s22 offen offset:0 lds
    s_add_u32 s22, s42, 801792
    buffer_load_dwordx4 v9, s[12:15], s22 offen offset:1024 lds
    s_add_u32 s22, s42, 817152
    buffer_load_dwordx4 v8, s[12:15], s22 offen offset:2048 lds
    s_add_u32 s22, s42, 832512
    buffer_load_dwordx4 v9, s[12:15], s22 offen offset:3072 lds
    v_bfe_u32 v4, v0, 2, 2
    v_xor_b32 v5, s18, v4
    v_lshlrev_b32 v10, 6, v5
    v_lshl_add_u32 v10, v4, 9, v10
    v_and_b32 v4, 3, v0
    v_lshl_add_u32 v10, v4, 4, v10
    v_bfe_u32 v4, v0, 4, 2
    v_lshl_add_u32 v10, v4, 12, v10
    v_add_u32 v10, 73728, v10
    v_add_u32 v11, 49152, v10
    v_and_b32 v4, 63, v0
    v_and_b32 v5, 15, v4
    v_lshrrev_b32 v3, 4, v4
    v_lshrrev_b32 v2, 2, v5
    v_xor_b32 v3, v3, v2
    v_lshl_add_u32 v3, v5, 2, v3
    v_lshlrev_b32 v1, 4, v3
    v_lshrrev_b32 v5, 2, v4
    v_lshrrev_b32 v3, 4, v4
    v_and_b32 v4, 3, v4
    v_xor_b32 v4, v4, v3
    v_lshlrev_b32 v3, 3, v3
    v_and_b32 v5, 3, v5
    v_add_u32 v3, v3, v5
    v_mul_u32_u24 v2, 1152, v3
    v_lshl_add_u32 v2, v4, 4, v2
    s_mov_b32 s8, s48
    s_mov_b32 s9, s49
    s_mov_b32 s10, 2359296
    s_mov_b32 s11, 0x20000
    s_lshr_b32 s22, s18, 1
    s_mul_i32 s24, s22, 4608
    s_mul_i32 s25, s22, 18432
    s_and_b32 s22, s18, 1
    s_mul_i32 s23, s22, 576
    s_add_u32 s24, s24, s23
    s_mul_i32 s25, s18, 9216
    s_mul_i32 s22, s19, 36864
    s_add_u32 s24, s24, s22
    s_mov_b32 s20, 64
    s_lshl_b32 s22, s19, 5
    s_add_u32 s22, s22, s17
    s_lshl_b32 s26, s22, 14
    s_mul_i32 s23, s18, 3072
    s_add_u32 s26, s26, s23
    s_lshl_b32 s23, s16, 11
    s_add_u32 s26, s26, s23
    s_add_u32 s26, s26, -2048
    s_lshl_b32 s22, s22, 13
    s_add_u32 s22, s22, 33554432
    s_cmp_eq_u32 s16, 0
    s_cselect_b32 s26, s22, s26
    s_cselect_b32 s40, 4096, 64
    s_cselect_b32 s41, 1, 2
    s_max_u32 s40, s40, 1024
    s_lshl_b32 s41, s41, 18
    s_lshl_b32 s29, s17, 7
    s_lshl_b32 s22, s16, 4
    s_add_u32 s29, s29, s22
    s_lshl_b32 s22, s19, 2
    s_add_u32 s29, s29, s22
    s_add_u32 s29, s29, 125829120
    s_mov_b32 s27, 0
    s_add_u32 s23, s27, s25
    s_add_u32 m0, s23, 0
    s_nop 0
    buffer_load_dwordx4 v2, s[8:11], s24 offen offset:0 lds
    s_add_u32 m0, s23, 960
    s_nop 0
    buffer_load_dwordx4 v2, s[8:11], s24 offen offset:64 lds
    s_add_u32 m0, s23, 1920
    s_nop 0
    buffer_load_dwordx4 v2, s[8:11], s24 offen offset:128 lds
    s_add_u32 m0, s23, 2880
    s_nop 0
    buffer_load_dwordx4 v2, s[8:11], s24 offen offset:192 lds
    s_add_u32 m0, s23, 3840
    s_nop 0
    buffer_load_dwordx4 v2, s[8:11], s24 offen offset:256 lds
    s_add_u32 m0, s23, 4800
    s_nop 0
    buffer_load_dwordx4 v2, s[8:11], s24 offen offset:320 lds
    s_add_u32 m0, s23, 5760
    s_nop 0
    buffer_load_dwordx4 v2, s[8:11], s24 offen offset:384 lds
    s_add_u32 m0, s23, 6720
    s_nop 0
    buffer_load_dwordx4 v2, s[8:11], s24 offen offset:448 lds
    s_add_u32 m0, s23, 7680
    s_nop 0
    buffer_load_dwordx4 v2, s[8:11], s24 offen offset:512 lds
    s_add_u32 s24, s24, 147456
    s_waitcnt vmcnt(21) lgkmcnt(0)
    s_barrier
    s_add_u32 m0, s44, 139264
    s_add_u32 s22, s42, 1048576
    buffer_load_dwordx4 v8, s[12:15], s22 offen offset:0 lds
    s_add_u32 s22, s42, 1063936
    buffer_load_dwordx4 v9, s[12:15], s22 offen offset:1024 lds
    s_add_u32 s22, s42, 1079296
    buffer_load_dwordx4 v8, s[12:15], s22 offen offset:2048 lds
    s_add_u32 s22, s42, 1094656
    buffer_load_dwordx4 v9, s[12:15], s22 offen offset:3072 lds
    ds_read_b64_tr_b16 v[64:65], v10 offset:0
    ds_read_b64_tr_b16 v[66:67], v10 offset:2048
    ds_read_b64_tr_b16 v[136:137], v10 offset:8
    ds_read_b64_tr_b16 v[138:139], v10 offset:2056
    ds_read_b64_tr_b16 a[0:1], v10 offset:256
    ds_read_b64_tr_b16 a[2:3], v10 offset:2304
    ds_read_b64_tr_b16 a[72:73], v10 offset:264
    ds_read_b64_tr_b16 a[74:75], v10 offset:2312
    s_waitcnt vmcnt(21) lgkmcnt(0)
    s_barrier
    s_add_u32 m0, s44, 73728
    s_add_u32 s22, s42, 1310720
    buffer_load_dwordx4 v8, s[12:15], s22 offen offset:0 lds
    s_add_u32 s22, s42, 1326080
    buffer_load_dwordx4 v9, s[12:15], s22 offen offset:1024 lds
    s_add_u32 s22, s42, 1341440
    buffer_load_dwordx4 v8, s[12:15], s22 offen offset:2048 lds
    s_add_u32 s22, s42, 1356800
    buffer_load_dwordx4 v9, s[12:15], s22 offen offset:3072 lds
    ds_read_b64_tr_b16 v[68:69], v10 offset:16384
    ds_read_b64_tr_b16 v[70:71], v10 offset:18432
    ds_read_b64_tr_b16 v[140:141], v10 offset:16392
    ds_read_b64_tr_b16 v[142:143], v10 offset:18440
    ds_read_b64_tr_b16 a[4:5], v10 offset:16640
    ds_read_b64_tr_b16 a[6:7], v10 offset:18688
    ds_read_b64_tr_b16 a[76:77], v10 offset:16648
    ds_read_b64_tr_b16 a[78:79], v10 offset:18696
    s_waitcnt vmcnt(21) lgkmcnt(0)
    s_barrier
    s_add_u32 m0, s44, 90112
    s_add_u32 s22, s42, 1572864
    buffer_load_dwordx4 v8, s[12:15], s22 offen offset:0 lds
    s_add_u32 s22, s42, 1588224
    buffer_load_dwordx4 v9, s[12:15], s22 offen offset:1024 lds
    s_add_u32 s22, s42, 1603584
    buffer_load_dwordx4 v8, s[12:15], s22 offen offset:2048 lds
    s_add_u32 s22, s42, 1618944
    buffer_load_dwordx4 v9, s[12:15], s22 offen offset:3072 lds
    ds_read_b64_tr_b16 v[72:73], v10 offset:32768
    ds_read_b64_tr_b16 v[74:75], v10 offset:34816
    ds_read_b64_tr_b16 v[144:145], v10 offset:32776
    ds_read_b64_tr_b16 v[146:147], v10 offset:34824
    ds_read_b64_tr_b16 a[8:9], v10 offset:33024
    ds_read_b64_tr_b16 a[10:11], v10 offset:35072
    ds_read_b64_tr_b16 a[80:81], v10 offset:33032
    ds_read_b64_tr_b16 a[82:83], v10 offset:35080
    s_waitcnt vmcnt(21) lgkmcnt(0)
    s_barrier
    s_add_u32 m0, s44, 106496
    s_add_u32 s22, s42, 1835008
    buffer_load_dwordx4 v8, s[12:15], s22 offen offset:0 lds
    s_add_u32 s22, s42, 1850368
    buffer_load_dwordx4 v9, s[12:15], s22 offen offset:1024 lds
    s_add_u32 s22, s42, 1865728
    buffer_load_dwordx4 v8, s[12:15], s22 offen offset:2048 lds
    s_add_u32 s22, s42, 1881088
    buffer_load_dwordx4 v9, s[12:15], s22 offen offset:3072 lds
    ds_read_b64_tr_b16 v[76:77], v11 offset:0
    ds_read_b64_tr_b16 v[78:79], v11 offset:2048
    ds_read_b64_tr_b16 v[148:149], v11 offset:8
    ds_read_b64_tr_b16 v[150:151], v11 offset:2056
    ds_read_b64_tr_b16 a[12:13], v11 offset:256
    ds_read_b64_tr_b16 a[14:15], v11 offset:2304
    ds_read_b64_tr_b16 a[84:85], v11 offset:264
    ds_read_b64_tr_b16 a[86:87], v11 offset:2312
    s_waitcnt vmcnt(12) lgkmcnt(0)
    s_barrier
    s_add_u32 m0, s44, 122880
    s_add_u32 s22, s42, 2097152
    buffer_load_dwordx4 v8, s[12:15], s22 offen offset:0 lds
    s_add_u32 s22, s42, 2112512
    buffer_load_dwordx4 v9, s[12:15], s22 offen offset:1024 lds
    s_add_u32 s22, s42, 2127872
    buffer_load_dwordx4 v8, s[12:15], s22 offen offset:2048 lds
    s_add_u32 s22, s42, 2143232
    buffer_load_dwordx4 v9, s[12:15], s22 offen offset:3072 lds
    ds_read_b64_tr_b16 v[80:81], v11 offset:16384
    ds_read_b64_tr_b16 v[82:83], v11 offset:18432
    ds_read_b64_tr_b16 v[152:153], v11 offset:16392
    ds_read_b64_tr_b16 v[154:155], v11 offset:18440
    ds_read_b64_tr_b16 a[16:17], v11 offset:16640
    ds_read_b64_tr_b16 a[18:19], v11 offset:18688
    ds_read_b64_tr_b16 a[88:89], v11 offset:16648
    ds_read_b64_tr_b16 a[90:91], v11 offset:18696
    s_waitcnt vmcnt(12) lgkmcnt(0)
    s_barrier
    s_add_u32 m0, s44, 139264
    s_add_u32 s22, s42, 2359296
    buffer_load_dwordx4 v8, s[12:15], s22 offen offset:0 lds
    s_add_u32 s22, s42, 2374656
    buffer_load_dwordx4 v9, s[12:15], s22 offen offset:1024 lds
    s_add_u32 s22, s42, 2390016
    buffer_load_dwordx4 v8, s[12:15], s22 offen offset:2048 lds
    s_add_u32 s22, s42, 2405376
    buffer_load_dwordx4 v9, s[12:15], s22 offen offset:3072 lds
    ds_read_b64_tr_b16 v[84:85], v10 offset:0
    ds_read_b64_tr_b16 v[86:87], v10 offset:2048
    ds_read_b64_tr_b16 v[156:157], v10 offset:8
    ds_read_b64_tr_b16 v[158:159], v10 offset:2056
    ds_read_b64_tr_b16 a[20:21], v10 offset:256
    ds_read_b64_tr_b16 a[22:23], v10 offset:2304
    ds_read_b64_tr_b16 a[92:93], v10 offset:264
    ds_read_b64_tr_b16 a[94:95], v10 offset:2312
    s_waitcnt vmcnt(12) lgkmcnt(0)
    s_barrier
    s_add_u32 m0, s44, 73728
    s_add_u32 s22, s42, 2621440
    buffer_load_dwordx4 v8, s[12:15], s22 offen offset:0 lds
    s_add_u32 s22, s42, 2636800
    buffer_load_dwordx4 v9, s[12:15], s22 offen offset:1024 lds
    s_add_u32 s22, s42, 2652160
    buffer_load_dwordx4 v8, s[12:15], s22 offen offset:2048 lds
    s_add_u32 s22, s42, 2667520
    buffer_load_dwordx4 v9, s[12:15], s22 offen offset:3072 lds
    ds_read_b64_tr_b16 v[88:89], v10 offset:16384
    ds_read_b64_tr_b16 v[90:91], v10 offset:18432
    ds_read_b64_tr_b16 v[160:161], v10 offset:16392
    ds_read_b64_tr_b16 v[162:163], v10 offset:18440
    ds_read_b64_tr_b16 a[24:25], v10 offset:16640
    ds_read_b64_tr_b16 a[26:27], v10 offset:18688
    ds_read_b64_tr_b16 a[96:97], v10 offset:16648
    ds_read_b64_tr_b16 a[98:99], v10 offset:18696
    s_waitcnt vmcnt(12) lgkmcnt(0)
    s_barrier
    s_add_u32 m0, s44, 90112
    s_add_u32 s22, s42, 2883584
    buffer_load_dwordx4 v8, s[12:15], s22 offen offset:0 lds
    s_add_u32 s22, s42, 2898944
    buffer_load_dwordx4 v9, s[12:15], s22 offen offset:1024 lds
    s_add_u32 s22, s42, 2914304
    buffer_load_dwordx4 v8, s[12:15], s22 offen offset:2048 lds
    s_add_u32 s22, s42, 2929664
    buffer_load_dwordx4 v9, s[12:15], s22 offen offset:3072 lds
    ds_read_b64_tr_b16 v[92:93], v10 offset:32768
    ds_read_b64_tr_b16 v[94:95], v10 offset:34816
    ds_read_b64_tr_b16 v[164:165], v10 offset:32776
    ds_read_b64_tr_b16 v[166:167], v10 offset:34824
    ds_read_b64_tr_b16 a[28:29], v10 offset:33024
    ds_read_b64_tr_b16 a[30:31], v10 offset:35072
    ds_read_b64_tr_b16 a[100:101], v10 offset:33032
    ds_read_b64_tr_b16 a[102:103], v10 offset:35080
    s_waitcnt vmcnt(12) lgkmcnt(0)
    s_barrier
    s_add_u32 m0, s44, 106496
    s_add_u32 s22, s42, 3145728
    buffer_load_dwordx4 v8, s[12:15], s22 offen offset:0 lds
    s_add_u32 s22, s42, 3161088
    buffer_load_dwordx4 v9, s[12:15], s22 offen offset:1024 lds
    s_add_u32 s22, s42, 3176448
    buffer_load_dwordx4 v8, s[12:15], s22 offen offset:2048 lds
    s_add_u32 s22, s42, 3191808
    buffer_load_dwordx4 v9, s[12:15], s22 offen offset:3072 lds
    ds_read_b64_tr_b16 v[96:97], v11 offset:0
    ds_read_b64_tr_b16 v[98:99], v11 offset:2048
    ds_read_b64_tr_b16 v[168:169], v11 offset:8
    ds_read_b64_tr_b16 v[170:171], v11 offset:2056
    ds_read_b64_tr_b16 a[32:33], v11 offset:256
    ds_read_b64_tr_b16 a[34:35], v11 offset:2304
    ds_read_b64_tr_b16 a[104:105], v11 offset:264
    ds_read_b64_tr_b16 a[106:107], v11 offset:2312
    s_waitcnt vmcnt(12) lgkmcnt(0)
    s_barrier
    s_add_u32 m0, s44, 122880
    s_add_u32 s22, s42, 3407872
    buffer_load_dwordx4 v8, s[12:15], s22 offen offset:0 lds
    s_add_u32 s22, s42, 3423232
    buffer_load_dwordx4 v9, s[12:15], s22 offen offset:1024 lds
    s_add_u32 s22, s42, 3438592
    buffer_load_dwordx4 v8, s[12:15], s22 offen offset:2048 lds
    s_add_u32 s22, s42, 3453952
    buffer_load_dwordx4 v9, s[12:15], s22 offen offset:3072 lds
    ds_read_b64_tr_b16 v[100:101], v11 offset:16384
    ds_read_b64_tr_b16 v[102:103], v11 offset:18432
    ds_read_b64_tr_b16 v[172:173], v11 offset:16392
    ds_read_b64_tr_b16 v[174:175], v11 offset:18440
    ds_read_b64_tr_b16 a[36:37], v11 offset:16640
    ds_read_b64_tr_b16 a[38:39], v11 offset:18688
    ds_read_b64_tr_b16 a[108:109], v11 offset:16648
    ds_read_b64_tr_b16 a[110:111], v11 offset:18696
    s_waitcnt vmcnt(12) lgkmcnt(0)
    s_barrier
    s_add_u32 m0, s44, 139264
    s_add_u32 s22, s42, 3670016
    buffer_load_dwordx4 v8, s[12:15], s22 offen offset:0 lds
    s_add_u32 s22, s42, 3685376
    buffer_load_dwordx4 v9, s[12:15], s22 offen offset:1024 lds
    s_add_u32 s22, s42, 3700736
    buffer_load_dwordx4 v8, s[12:15], s22 offen offset:2048 lds
    s_add_u32 s22, s42, 3716096
    buffer_load_dwordx4 v9, s[12:15], s22 offen offset:3072 lds
    ds_read_b64_tr_b16 v[104:105], v10 offset:0
    ds_read_b64_tr_b16 v[106:107], v10 offset:2048
    ds_read_b64_tr_b16 v[176:177], v10 offset:8
    ds_read_b64_tr_b16 v[178:179], v10 offset:2056
    ds_read_b64_tr_b16 a[40:41], v10 offset:256
    ds_read_b64_tr_b16 a[42:43], v10 offset:2304
    ds_read_b64_tr_b16 a[112:113], v10 offset:264
    ds_read_b64_tr_b16 a[114:115], v10 offset:2312
    s_waitcnt vmcnt(12) lgkmcnt(0)
    s_barrier
    s_add_u32 m0, s44, 73728
    s_add_u32 s22, s42, 3932160
    buffer_load_dwordx4 v8, s[12:15], s22 offen offset:0 lds
    s_add_u32 s22, s42, 3947520
    buffer_load_dwordx4 v9, s[12:15], s22 offen offset:1024 lds
    s_add_u32 s22, s42, 3962880
    buffer_load_dwordx4 v8, s[12:15], s22 offen offset:2048 lds
    s_add_u32 s22, s42, 3978240
    buffer_load_dwordx4 v9, s[12:15], s22 offen offset:3072 lds
    ds_read_b64_tr_b16 v[108:109], v10 offset:16384
    ds_read_b64_tr_b16 v[110:111], v10 offset:18432
    ds_read_b64_tr_b16 v[180:181], v10 offset:16392
    ds_read_b64_tr_b16 v[182:183], v10 offset:18440
    ds_read_b64_tr_b16 a[44:45], v10 offset:16640
    ds_read_b64_tr_b16 a[46:47], v10 offset:18688
    ds_read_b64_tr_b16 a[116:117], v10 offset:16648
    ds_read_b64_tr_b16 a[118:119], v10 offset:18696
    s_waitcnt vmcnt(12) lgkmcnt(0)
    s_barrier
    s_add_u32 m0, s44, 90112
    s_add_u32 s22, s42, 4194304
    buffer_load_dwordx4 v8, s[12:15], s22 offen offset:0 lds
    s_add_u32 s22, s42, 4209664
    buffer_load_dwordx4 v9, s[12:15], s22 offen offset:1024 lds
    s_add_u32 s22, s42, 4225024
    buffer_load_dwordx4 v8, s[12:15], s22 offen offset:2048 lds
    s_add_u32 s22, s42, 4240384
    buffer_load_dwordx4 v9, s[12:15], s22 offen offset:3072 lds
    ds_read_b64_tr_b16 v[112:113], v10 offset:32768
    ds_read_b64_tr_b16 v[114:115], v10 offset:34816
    ds_read_b64_tr_b16 v[184:185], v10 offset:32776
    ds_read_b64_tr_b16 v[186:187], v10 offset:34824
    ds_read_b64_tr_b16 a[48:49], v10 offset:33024
    ds_read_b64_tr_b16 a[50:51], v10 offset:35072
    ds_read_b64_tr_b16 a[120:121], v10 offset:33032
    ds_read_b64_tr_b16 a[122:123], v10 offset:35080
    s_waitcnt vmcnt(12) lgkmcnt(0)
    s_barrier
    s_add_u32 m0, s44, 106496
    s_add_u32 s22, s42, 4456448
    buffer_load_dwordx4 v8, s[12:15], s22 offen offset:0 lds
    s_add_u32 s22, s42, 4471808
    buffer_load_dwordx4 v9, s[12:15], s22 offen offset:1024 lds
    s_add_u32 s22, s42, 4487168
    buffer_load_dwordx4 v8, s[12:15], s22 offen offset:2048 lds
    s_add_u32 s22, s42, 4502528
    buffer_load_dwordx4 v9, s[12:15], s22 offen offset:3072 lds
    ds_read_b64_tr_b16 v[116:117], v11 offset:0
    ds_read_b64_tr_b16 v[118:119], v11 offset:2048
    ds_read_b64_tr_b16 v[188:189], v11 offset:8
    ds_read_b64_tr_b16 v[190:191], v11 offset:2056
    ds_read_b64_tr_b16 a[52:53], v11 offset:256
    ds_read_b64_tr_b16 a[54:55], v11 offset:2304
    ds_read_b64_tr_b16 a[124:125], v11 offset:264
    ds_read_b64_tr_b16 a[126:127], v11 offset:2312
    s_waitcnt vmcnt(12) lgkmcnt(0)
    s_barrier
    s_mov_b32 s27, 36864
    s_add_u32 s23, s27, s25
    s_add_u32 m0, s23, 0
    s_nop 0
    buffer_load_dwordx4 v2, s[8:11], s24 offen offset:0 lds
    s_add_u32 m0, s23, 960
    s_nop 0
    buffer_load_dwordx4 v2, s[8:11], s24 offen offset:64 lds
    s_add_u32 m0, s23, 1920
    s_nop 0
    buffer_load_dwordx4 v2, s[8:11], s24 offen offset:128 lds
    s_add_u32 m0, s23, 2880
    s_nop 0
    buffer_load_dwordx4 v2, s[8:11], s24 offen offset:192 lds
    s_add_u32 m0, s23, 3840
    s_nop 0
    buffer_load_dwordx4 v2, s[8:11], s24 offen offset:256 lds
    s_add_u32 m0, s23, 4800
    s_nop 0
    buffer_load_dwordx4 v2, s[8:11], s24 offen offset:320 lds
    s_add_u32 m0, s23, 5760
    s_nop 0
    buffer_load_dwordx4 v2, s[8:11], s24 offen offset:384 lds
    s_add_u32 m0, s23, 6720
    s_nop 0
    buffer_load_dwordx4 v2, s[8:11], s24 offen offset:448 lds
    s_add_u32 m0, s23, 7680
    s_nop 0
    buffer_load_dwordx4 v2, s[8:11], s24 offen offset:512 lds
    s_add_u32 s24, s24, 147456
    ds_read_b64_tr_b16 v[120:121], v11 offset:16384
    ds_read_b64_tr_b16 v[122:123], v11 offset:18432
    ds_read_b64_tr_b16 v[192:193], v11 offset:16392
    ds_read_b64_tr_b16 v[194:195], v11 offset:18440
    ds_read_b64_tr_b16 a[56:57], v11 offset:16640
    ds_read_b64_tr_b16 a[58:59], v11 offset:18688
    ds_read_b64_tr_b16 a[128:129], v11 offset:16648
    ds_read_b64_tr_b16 a[130:131], v11 offset:18696
    s_waitcnt vmcnt(17) lgkmcnt(0)
    s_barrier
    ds_read_b64_tr_b16 v[124:125], v10 offset:0
    ds_read_b64_tr_b16 v[126:127], v10 offset:2048
    ds_read_b64_tr_b16 v[196:197], v10 offset:8
    ds_read_b64_tr_b16 v[198:199], v10 offset:2056
    ds_read_b64_tr_b16 a[60:61], v10 offset:256
    ds_read_b64_tr_b16 a[62:63], v10 offset:2304
    ds_read_b64_tr_b16 a[132:133], v10 offset:264
    ds_read_b64_tr_b16 a[134:135], v10 offset:2312
    s_waitcnt vmcnt(13) lgkmcnt(0)
    s_barrier
    ds_read_b64_tr_b16 v[128:129], v10 offset:16384
    ds_read_b64_tr_b16 v[130:131], v10 offset:18432
    ds_read_b64_tr_b16 v[200:201], v10 offset:16392
    ds_read_b64_tr_b16 v[202:203], v10 offset:18440
    ds_read_b64_tr_b16 a[64:65], v10 offset:16640
    ds_read_b64_tr_b16 a[66:67], v10 offset:18688
    ds_read_b64_tr_b16 a[136:137], v10 offset:16648
    ds_read_b64_tr_b16 a[138:139], v10 offset:18696
    s_waitcnt vmcnt(9) lgkmcnt(0)
    s_barrier
    ds_read_b64_tr_b16 v[132:133], v10 offset:32768
    ds_read_b64_tr_b16 v[134:135], v10 offset:34816
    ds_read_b64_tr_b16 v[204:205], v10 offset:32776
    ds_read_b64_tr_b16 v[206:207], v10 offset:34824
    ds_read_b64_tr_b16 a[68:69], v10 offset:33024
    ds_read_b64_tr_b16 a[70:71], v10 offset:35072
    ds_read_b64_tr_b16 a[140:141], v10 offset:33032
    ds_read_b64_tr_b16 a[142:143], v10 offset:35080
    s_mov_b32 s88, 4194304
gn39:
    buffer_load_dword v250, off, s[84:87], 0 offset:216 sc1
    s_waitcnt vmcnt(0)
    v_readfirstlane_b32 s95, v250
    s_sub_u32 s88, s88, 1
    s_cbranch_scc1 gn39x
    s_cmp_eq_u32 s95, 0
    s_cbranch_scc1 gn39
gn39x:
    s_waitcnt lgkmcnt(0)
    s_mov_b32 s45, 0
    s_mov_b32 s27, 0
    s_cmp_eq_u32 s18, 0
    s_cselect_b32 s34, 1, 0
    s_mov_b32 s35, 0
    s_cmp_eq_u32 s16, 2
    s_cbranch_scc1 qk_vloop
qk_loop:
    s_barrier
    v_add_u32 v3, s27, v1
    ds_read_b128 v[32:35], v3 offset:0
    ds_read_b128 v[36:39], v3 offset:18432
    ds_read_b128 v[40:43], v3 offset:1024
    ds_read_b128 v[44:47], v3 offset:19456
    ds_read_b128 v[48:51], v3 offset:2048
    ds_read_b128 v[52:55], v3 offset:20480
    s_add_u32 s23, s45, s95
    v_mov_b32 v4, s23
    s_mov_b64 exec, s[34:35]
    buffer_store_dword v4, off, s[4:7], s29 sc1
    buffer_store_dword v4, off, s[4:7], s29 offset:128 sc1
    s_mov_b64 exec, -1
    s_add_u32 s22, s27, 73728
    s_sub_u32 s21, s22, 110592
    s_cselect_b32 s22, s22, s21
    ds_read_b128 v[56:59], v3 offset:3072
    ds_read_b128 v[60:63], v3 offset:21504
    s_add_u32 s23, s22, s25
    s_add_u32 m0, s23, 0
    s_nop 0
    buffer_load_dwordx4 v2, s[8:11], s24 offen offset:0 lds
    s_waitcnt lgkmcnt(6)
    v_mfma_f32_16x16x32_bf16 v[208:211], v[64:67], v[32:35], 0
    v_mfma_f32_16x16x32_bf16 v[212:215], v[136:139], v[32:35], 0
    v_mfma_f32_16x16x32_bf16 v[216:219], v[64:67], v[36:39], 0
    v_mfma_f32_16x16x32_bf16 v[220:223], v[136:139], v[36:39], 0
    v_mfma_f32_16x16x32_bf16 v[224:227], a[0:3], v[32:35], 0
    v_mfma_f32_16x16x32_bf16 v[228:231], a[72:75], v[32:35], 0
    v_mfma_f32_16x16x32_bf16 v[232:235], a[0:3], v[36:39], 0
    v_mfma_f32_16x16x32_bf16 v[236:239], a[72:75], v[36:39], 0
    ds_read_b128 v[32:35], v3 offset:4096
    ds_read_b128 v[36:39], v3 offset:22528
    s_add_u32 m0, s23, 960
    s_nop 0
    buffer_load_dwordx4 v2, s[8:11], s24 offen offset:64 lds
    s_waitcnt lgkmcnt(6)
    v_mfma_f32_16x16x32_bf16 v[208:211], v[68:71], v[40:43], v[208:211]
    v_mfma_f32_16x16x32_bf16 v[212:215], v[140:143], v[40:43], v[212:215]
    v_mfma_f32_16x16x32_bf16 v[216:219], v[68:71], v[44:47], v[216:219]
    v_mfma_f32_16x16x32_bf16 v[220:223], v[140:143], v[44:47], v[220:223]
    v_mfma_f32_16x16x32_bf16 v[224:227], a[4:7], v[40:43], v[224:227]
    v_mfma_f32_16x16x32_bf16 v[228:231], a[76:79], v[40:43], v[228:231]
    v_mfma_f32_16x16x32_bf16 v[232:235], a[4:7], v[44:47], v[232:235]
    v_mfma_f32_16x16x32_bf16 v[236:239], a[76:79], v[44:47], v[236:239]
    ds_read_b128 v[40:43], v3 offset:5120
    ds_read_b128 v[44:47], v3 offset:23552
    s_add_u32 m0, s23, 1920
    s_nop 0
    buffer_load_dwordx4 v2, s[8:11], s24 offen offset:128 lds
    s_waitcnt lgkmcnt(6)
    v_mfma_f32_16x16x32_bf16 v[208:211], v[72:75], v[48:51], v[208:211]
    v_mfma_f32_16x16x32_bf16 v[212:215], v[144:147], v[48:51], v[212:215]
    v_mfma_f32_16x16x32_bf16 v[216:219], v[72:75], v[52:55], v[216:219]
    v_mfma_f32_16x16x32_bf16 v[220:223], v[144:147], v[52:55], v[220:223]
    v_mfma_f32_16x16x32_bf16 v[224:227], a[8:11], v[48:51], v[224:227]
    v_mfma_f32_16x16x32_bf16 v[228:231], a[80:83], v[48:51], v[228:231]
    v_mfma_f32_16x16x32_bf16 v[232:235], a[8:11], v[52:55], v[232:235]
    v_mfma_f32_16x16x32_bf16 v[236:239], a[80:83], v[52:55], v[236:239]
    ds_read_b128 v[48:51], v3 offset:6144
    ds_read_b128 v[52:55], v3 offset:24576
    s_add_u32 m0, s23, 2880
    s_nop 0
    buffer_load_dwordx4 v2, s[8:11], s24 offen offset:192 lds
    s_waitcnt lgkmcnt(6)
    v_mfma_f32_16x16x32_bf16 v[208:211], v[76:79], v[56:59], v[208:211]
    v_mfma_f32_16x16x32_bf16 v[212:215], v[148:151], v[56:59], v[212:215]
    v_mfma_f32_16x16x32_bf16 v[216:219], v[76:79], v[60:63], v[216:219]
    v_mfma_f32_16x16x32_bf16 v[220:223], v[148:151], v[60:63], v[220:223]
    v_mfma_f32_16x16x32_bf16 v[224:227], a[12:15], v[56:59], v[224:227]
    v_mfma_f32_16x16x32_bf16 v[228:231], a[84:87], v[56:59], v[228:231]
    v_mfma_f32_16x16x32_bf16 v[232:235], a[12:15], v[60:63], v[232:235]
    v_mfma_f32_16x16x32_bf16 v[236:239], a[84:87], v[60:63], v[236:239]
    ds_read_b128 v[56:59], v3 offset:7168
    ds_read_b128 v[60:63], v3 offset:25600
    s_add_u32 m0, s23, 3840
    s_nop 0
    buffer_load_dwordx4 v2, s[8:11], s24 offen offset:256 lds
    s_waitcnt lgkmcnt(6)
    v_mfma_f32_16x16x32_bf16 v[208:211], v[80:83], v[32:35], v[208:211]
    v_mfma_f32_16x16x32_bf16 v[212:215], v[152:155], v[32:35], v[212:215]
    v_mfma_f32_16x16x32_bf16 v[216:219], v[80:83], v[36:39], v[216:219]
    v_mfma_f32_16x16x32_bf16 v[220:223], v[152:155], v[36:39], v[220:223]
    v_mfma_f32_16x16x32_bf16 v[224:227], a[16:19], v[32:35], v[224:227]
    v_mfma_f32_16x16x32_bf16 v[228:231], a[88:91], v[32:35], v[228:231]
    v_mfma_f32_16x16x32_bf16 v[232:235], a[16:19], v[36:39], v[232:235]
    v_mfma_f32_16x16x32_bf16 v[236:239], a[88:91], v[36:39], v[236:239]
    ds_read_b128 v[32:35], v3 offset:8192
    ds_read_b128 v[36:39], v3 offset:26624
    s_add_u32 m0, s23, 4800
    s_nop 0
    buffer_load_dwordx4 v2, s[8:11], s24 offen offset:320 lds
    s_waitcnt lgkmcnt(6)
    v_mfma_f32_16x16x32_bf16 v[208:211], v[84:87], v[40:43], v[208:211]
    v_mfma_f32_16x16x32_bf16 v[212:215], v[156:159], v[40:43], v[212:215]
    v_mfma_f32_16x16x32_bf16 v[216:219], v[84:87], v[44:47], v[216:219]
    v_mfma_f32_16x16x32_bf16 v[220:223], v[156:159], v[44:47], v[220:223]
    v_mfma_f32_16x16x32_bf16 v[224:227], a[20:23], v[40:43], v[224:227]
    v_mfma_f32_16x16x32_bf16 v[228:231], a[92:95], v[40:43], v[228:231]
    v_mfma_f32_16x16x32_bf16 v[232:235], a[20:23], v[44:47], v[232:235]
    v_mfma_f32_16x16x32_bf16 v[236:239], a[92:95], v[44:47], v[236:239]
    ds_read_b128 v[40:43], v3 offset:9216
    ds_read_b128 v[44:47], v3 offset:27648
    s_add_u32 m0, s23, 5760
    s_nop 0
    buffer_load_dwordx4 v2, s[8:11], s24 offen offset:384 lds
    s_waitcnt lgkmcnt(6)
    v_mfma_f32_16x16x32_bf16 v[208:211], v[88:91], v[48:51], v[208:211]
    v_mfma_f32_16x16x32_bf16 v[212:215], v[160:163], v[48:51], v[212:215]
    v_mfma_f32_16x16x32_bf16 v[216:219], v[88:91], v[52:55], v[216:219]
    v_mfma_f32_16x16x32_bf16 v[220:223], v[160:163], v[52:55], v[220:223]
    v_mfma_f32_16x16x32_bf16 v[224:227], a[24:27], v[48:51], v[224:227]
    v_mfma_f32_16x16x32_bf16 v[228:231], a[96:99], v[48:51], v[228:231]
    v_mfma_f32_16x16x32_bf16 v[232:235], a[24:27], v[52:55], v[232:235]
    v_mfma_f32_16x16x32_bf16 v[236:239], a[96:99], v[52:55], v[236:239]
    ds_read_b128 v[48:51], v3 offset:10240
    ds_read_b128 v[52:55], v3 offset:28672
    s_add_u32 m0, s23, 6720
    s_nop 0
    buffer_load_dwordx4 v2, s[8:11], s24 offen offset:448 lds
    s_waitcnt lgkmcnt(6)
    v_mfma_f32_16x16x32_bf16 v[208:211], v[92:95], v[56:59], v[208:211]
    v_mfma_f32_16x16x32_bf16 v[212:215], v[164:167], v[56:59], v[212:215]
    v_mfma_f32_16x16x32_bf16 v[216:219], v[92:95], v[60:63], v[216:219]
    v_mfma_f32_16x16x32_bf16 v[220:223], v[164:167], v[60:63], v[220:223]
    v_mfma_f32_16x16x32_bf16 v[224:227], a[28:31], v[56:59], v[224:227]
    v_mfma_f32_16x16x32_bf16 v[228:231], a[100:103], v[56:59], v[228:231]
    v_mfma_f32_16x16x32_bf16 v[232:235], a[28:31], v[60:63], v[232:235]
    v_mfma_f32_16x16x32_bf16 v[236:239], a[100:103], v[60:63], v[236:239]
    ds_read_b128 v[56:59], v3 offset:11264
    ds_read_b128 v[60:63], v3 offset:29696
    s_add_u32 m0, s23, 7680
    s_nop 0
    buffer_load_dwordx4 v2, s[8:11], s24 offen offset:512 lds
    s_add_u32 s24, s24, 147456
    s_waitcnt lgkmcnt(6)
    v_mfma_f32_16x16x32_bf16 v[208:211], v[96:99], v[32:35], v[208:211]
    v_mfma_f32_16x16x32_bf16 v[212:215], v[168:171], v[32:35], v[212:215]
    v_mfma_f32_16x16x32_bf16 v[216:219], v[96:99], v[36:39], v[216:219]
    v_mfma_f32_16x16x32_bf16 v[220:223], v[168:171], v[36:39], v[220:223]
    v_mfma_f32_16x16x32_bf16 v[224:227], a[32:35], v[32:35], v[224:227]
    v_mfma_f32_16x16x32_bf16 v[228:231], a[104:107], v[32:35], v[228:231]
    v_mfma_f32_16x16x32_bf16 v[232:235], a[32:35], v[36:39], v[232:235]
    v_mfma_f32_16x16x32_bf16 v[236:239], a[104:107], v[36:39], v[236:239]
    ds_read_b128 v[32:35], v3 offset:12288
    ds_read_b128 v[36:39], v3 offset:30720
    s_waitcnt lgkmcnt(6)
    v_mfma_f32_16x16x32_bf16 v[208:211], v[100:103], v[40:43], v[208:211]
    v_mfma_f32_16x16x32_bf16 v[212:215], v[172:175], v[40:43], v[212:215]
    v_mfma_f32_16x16x32_bf16 v[216:219], v[100:103], v[44:47], v[216:219]
    v_mfma_f32_16x16x32_bf16 v[220:223], v[172:175], v[44:47], v[220:223]
    v_mfma_f32_16x16x32_bf16 v[224:227], a[36:39], v[40:43], v[224:227]
    v_mfma_f32_16x16x32_bf16 v[228:231], a[108:111], v[40:43], v[228:231]
    v_mfma_f32_16x16x32_bf16 v[232:235], a[36:39], v[44:47], v[232:235]
    v_mfma_f32_16x16x32_bf16 v[236:239], a[108:111], v[44:47], v[236:239]
    ds_read_b128 v[40:43], v3 offset:13312
    ds_read_b128 v[44:47], v3 offset:31744
    s_waitcnt lgkmcnt(6)
    v_mfma_f32_16x16x32_bf16 v[208:211], v[104:107], v[48:51], v[208:211]
    v_mfma_f32_16x16x32_bf16 v[212:215], v[176:179], v[48:51], v[212:215]
    v_mfma_f32_16x16x32_bf16 v[216:219], v[104:107], v[52:55], v[216:219]
    v_mfma_f32_16x16x32_bf16 v[220:223], v[176:179], v[52:55], v[220:223]
    v_mfma_f32_16x16x32_bf16 v[224:227], a[40:43], v[48:51], v[224:227]
    v_mfma_f32_16x16x32_bf16 v[228:231], a[112:115], v[48:51], v[228:231]
    v_mfma_f32_16x16x32_bf16 v[232:235], a[40:43], v[52:55], v[232:235]
    v_mfma_f32_16x16x32_bf16 v[236:239], a[112:115], v[52:55], v[236:239]
    ds_read_b128 v[48:51], v3 offset:14336
    ds_read_b128 v[52:55], v3 offset:32768
    s_waitcnt lgkmcnt(6)
    v_mfma_f32_16x16x32_bf16 v[208:211], v[108:111], v[56:59], v[208:211]
    v_mfma_f32_16x16x32_bf16 v[212:215], v[180:183], v[56:59], v[212:215]
    v_mfma_f32_16x16x32_bf16 v[216:219], v[108:111], v[60:63], v[216:219]
    v_mfma_f32_16x16x32_bf16 v[220:223], v[180:183], v[60:63], v[220:223]
    v_mfma_f32_16x16x32_bf16 v[224:227], a[44:47], v[56:59], v[224:227]
    v_mfma_f32_16x16x32_bf16 v[228:231], a[116:119], v[56:59], v[228:231]
    v_mfma_f32_16x16x32_bf16 v[232:235], a[44:47], v[60:63], v[232:235]
    v_mfma_f32_16x16x32_bf16 v[236:239], a[116:119], v[60:63], v[236:239]
    ds_read_b128 v[56:59], v3 offset:15360
    ds_read_b128 v[60:63], v3 offset:33792
    s_waitcnt lgkmcnt(6)
    v_mfma_f32_16x16x32_bf16 v[208:211], v[112:115], v[32:35], v[208:211]
    v_mfma_f32_16x16x32_bf16 v[212:215], v[184:187], v[32:35], v[212:215]
    v_mfma_f32_16x16x32_bf16 v[216:219], v[112:115], v[36:39], v[216:219]
    v_mfma_f32_16x16x32_bf16 v[220:223], v[184:187], v[36:39], v[220:223]
    v_mfma_f32_16x16x32_bf16 v[224:227], a[48:51], v[32:35], v[224:227]
    v_mfma_f32_16x16x32_bf16 v[228:231], a[120:123], v[32:35], v[228:231]
    v_mfma_f32_16x16x32_bf16 v[232:235], a[48:51], v[36:39], v[232:235]
    v_mfma_f32_16x16x32_bf16 v[236:239], a[120:123], v[36:39], v[236:239]
    ds_read_b128 v[32:35], v3 offset:16384
    ds_read_b128 v[36:39], v3 offset:34816
    s_waitcnt lgkmcnt(6)
    v_mfma_f32_16x16x32_bf16 v[208:211], v[116:119], v[40:43], v[208:211]
    v_mfma_f32_16x16x32_bf16 v[212:215], v[188:191], v[40:43], v[212:215]
    v_mfma_f32_16x16x32_bf16 v[216:219], v[116:119], v[44:47], v[216:219]
    v_mfma_f32_16x16x32_bf16 v[220:223], v[188:191], v[44:47], v[220:223]
    v_mfma_f32_16x16x32_bf16 v[224:227], a[52:55], v[40:43], v[224:227]
    v_mfma_f32_16x16x32_bf16 v[228:231], a[124:127], v[40:43], v[228:231]
    v_mfma_f32_16x16x32_bf16 v[232:235], a[52:55], v[44:47], v[232:235]
    v_mfma_f32_16x16x32_bf16 v[236:239], a[124:127], v[44:47], v[236:239]
    ds_read_b128 v[40:43], v3 offset:17408
    ds_read_b128 v[44:47], v3 offset:35840
    s_waitcnt lgkmcnt(6)
    v_mfma_f32_16x16x32_bf16 v[208:211], v[120:123], v[48:51], v[208:211]
    v_mfma_f32_16x16x32_bf16 v[212:215], v[192:195], v[48:51], v[212:215]
    v_mfma_f32_16x16x32_bf16 v[216:219], v[120:123], v[52:55], v[216:219]
    v_mfma_f32_16x16x32_bf16 v[220:223], v[192:195], v[52:55], v[220:223]
    v_mfma_f32_16x16x32_bf16 v[224:227], a[56:59], v[48:51], v[224:227]
    v_mfma_f32_16x16x32_bf16 v[228:231], a[128:131], v[48:51], v[228:231]
    v_mfma_f32_16x16x32_bf16 v[232:235], a[56:59], v[52:55], v[232:235]
    v_mfma_f32_16x16x32_bf16 v[236:239], a[128:131], v[52:55], v[236:239]
    s_waitcnt lgkmcnt(4)
    v_mfma_f32_16x16x32_bf16 v[208:211], v[124:127], v[56:59], v[208:211]
    v_mfma_f32_16x16x32_bf16 v[212:215], v[196:199], v[56:59], v[212:215]
    v_mfma_f32_16x16x32_bf16 v[216:219], v[124:127], v[60:63], v[216:219]
    v_mfma_f32_16x16x32_bf16 v[220:223], v[196:199], v[60:63], v[220:223]
    v_mfma_f32_16x16x32_bf16 v[224:227], a[60:63], v[56:59], v[224:227]
    v_mfma_f32_16x16x32_bf16 v[228:231], a[132:135], v[56:59], v[228:231]
    v_mfma_f32_16x16x32_bf16 v[232:235], a[60:63], v[60:63], v[232:235]
    v_mfma_f32_16x16x32_bf16 v[236:239], a[132:135], v[60:63], v[236:239]
    s_waitcnt lgkmcnt(2)
    v_mfma_f32_16x16x32_bf16 v[208:211], v[128:131], v[32:35], v[208:211]
    v_mfma_f32_16x16x32_bf16 v[212:215], v[200:203], v[32:35], v[212:215]
    v_mfma_f32_16x16x32_bf16 v[216:219], v[128:131], v[36:39], v[216:219]
    v_mfma_f32_16x16x32_bf16 v[220:223], v[200:203], v[36:39], v[220:223]
    v_mfma_f32_16x16x32_bf16 v[224:227], a[64:67], v[32:35], v[224:227]
    v_mfma_f32_16x16x32_bf16 v[228:231], a[136:139], v[32:35], v[228:231]
    v_mfma_f32_16x16x32_bf16 v[232:235], a[64:67], v[36:39], v[232:235]
    v_mfma_f32_16x16x32_bf16 v[236:239], a[136:139], v[36:39], v[236:239]
    s_waitcnt lgkmcnt(0)
    v_mfma_f32_16x16x32_bf16 v[208:211], v[132:135], v[40:43], v[208:211]
    v_mfma_f32_16x16x32_bf16 v[212:215], v[204:207], v[40:43], v[212:215]
    v_mfma_f32_16x16x32_bf16 v[216:219], v[132:135], v[44:47], v[216:219]
    v_mfma_f32_16x16x32_bf16 v[220:223], v[204:207], v[44:47], v[220:223]
    v_mfma_f32_16x16x32_bf16 v[224:227], a[68:71], v[40:43], v[224:227]
    v_mfma_f32_16x16x32_bf16 v[228:231], a[140:143], v[40:43], v[228:231]
    v_mfma_f32_16x16x32_bf16 v[232:235], a[68:71], v[44:47], v[232:235]
    v_mfma_f32_16x16x32_bf16 v[236:239], a[140:143], v[44:47], v[236:239]
    s_waitcnt vmcnt(0)
    v_cvt_pk_bf16_f32 v8, v208, v209
    v_cvt_pk_bf16_f32 v9, v210, v211
    v_cvt_pk_bf16_f32 v10, v212, v213
    v_cvt_pk_bf16_f32 v11, v214, v215
    s_lshr_b32 s22, s41, 5
    s_mul_i32 s22, s22, 0
    s_add_u32 s28, s26, s22
    buffer_store_dwordx4 v[8:11], v7, s[4:7], s28 offen sc1
    v_cvt_pk_bf16_f32 v12, v216, v217
    v_cvt_pk_bf16_f32 v13, v218, v219
    v_cvt_pk_bf16_f32 v14, v220, v221
    v_cvt_pk_bf16_f32 v15, v222, v223
    s_lshr_b32 s22, s41, 5
    s_mul_i32 s22, s22, 0
    s_add_u32 s28, s26, s22
    s_add_u32 s28, s28, s40
    buffer_store_dwordx4 v[12:15], v7, s[4:7], s28 offen sc1
    v_cvt_pk_bf16_f32 v16, v224, v225
    v_cvt_pk_bf16_f32 v17, v226, v227
    v_cvt_pk_bf16_f32 v18, v228, v229
    v_cvt_pk_bf16_f32 v19, v230, v231
    s_lshr_b32 s22, s41, 5
    s_mul_i32 s22, s22, 1
    s_add_u32 s28, s26, s22
    buffer_store_dwordx4 v[16:19], v7, s[4:7], s28 offen sc1
    v_cvt_pk_bf16_f32 v20, v232, v233
    v_cvt_pk_bf16_f32 v21, v234, v235
    v_cvt_pk_bf16_f32 v22, v236, v237
    v_cvt_pk_bf16_f32 v23, v238, v239
    s_lshr_b32 s22, s41, 5
    s_mul_i32 s22, s22, 1
    s_add_u32 s28, s26, s22
    s_add_u32 s28, s28, s40
    buffer_store_dwordx4 v[20:23], v7, s[4:7], s28 offen sc1
    s_lshl_b32 s22, s41, 2
    s_add_u32 s26, s26, s22
    s_lshr_b32 s45, s19, 2
    s_cbranch_scc1 qk_loop_nf
    s_waitcnt vmcnt(0)
    s_mov_b32 s45, 1
qk_loop_nf:
    s_add_u32 s27, s27, 36864
    s_cmp_eq_u32 s27, 110592
    s_cselect_b32 s27, 0, s27
    s_add_u32 s19, s19, 4
    s_cmp_lt_u32 s19, s20
    s_cbranch_scc1 qk_loop
    s_branch qk_done
qk_vloop:
    s_barrier
    v_add_u32 v3, s27, v1
    ds_read_b128 v[32:35], v3 offset:0
    ds_read_b128 v[36:39], v3 offset:18432
    ds_read_b128 v[40:43], v3 offset:1024
    ds_read_b128 v[44:47], v3 offset:19456
    ds_read_b128 v[48:51], v3 offset:2048
    ds_read_b128 v[52:55], v3 offset:20480
    s_add_u32 s23, s45, s95
    v_mov_b32 v4, s23
    s_mov_b64 exec, s[34:35]
    buffer_store_dword v4, off, s[4:7], s29 sc1
    buffer_store_dword v4, off, s[4:7], s29 offset:128 sc1
    s_mov_b64 exec, -1
    s_add_u32 s22, s27, 73728
    s_sub_u32 s21, s22, 110592
    s_cselect_b32 s22, s22, s21
    ds_read_b128 v[56:59], v3 offset:3072
    ds_read_b128 v[60:63], v3 offset:21504
    s_add_u32 s23, s22, s25
    s_add_u32 m0, s23, 0
    s_nop 0
    buffer_load_dwordx4 v2, s[8:11], s24 offen offset:0 lds
    s_waitcnt lgkmcnt(6)
    v_mfma_f32_16x16x32_bf16 v[208:211], v[32:35], v[64:67], 0
    v_mfma_f32_16x16x32_bf16 v[212:215], v[32:35], v[136:139], 0
    v_mfma_f32_16x16x32_bf16 v[216:219], v[36:39], v[64:67], 0
    v_mfma_f32_16x16x32_bf16 v[220:223], v[36:39], v[136:139], 0
    v_mfma_f32_16x16x32_bf16 v[224:227], v[32:35], a[0:3], 0
    v_mfma_f32_16x16x32_bf16 v[228:231], v[32:35], a[72:75], 0
    v_mfma_f32_16x16x32_bf16 v[232:235], v[36:39], a[0:3], 0
    v_mfma_f32_16x16x32_bf16 v[236:239], v[36:39], a[72:75], 0
    ds_read_b128 v[32:35], v3 offset:4096
    ds_read_b128 v[36:39], v3 offset:22528
    s_add_u32 m0, s23, 960
    s_nop 0
    buffer_load_dwordx4 v2, s[8:11], s24 offen offset:64 lds
    s_waitcnt lgkmcnt(6)
    v_mfma_f32_16x16x32_bf16 v[208:211], v[40:43], v[68:71], v[208:211]
    v_mfma_f32_16x16x32_bf16 v[212:215], v[40:43], v[140:143], v[212:215]
    v_mfma_f32_16x16x32_bf16 v[216:219], v[44:47], v[68:71], v[216:219]
    v_mfma_f32_16x16x32_bf16 v[220:223], v[44:47], v[140:143], v[220:223]
    v_mfma_f32_16x16x32_bf16 v[224:227], v[40:43], a[4:7], v[224:227]
    v_mfma_f32_16x16x32_bf16 v[228:231], v[40:43], a[76:79], v[228:231]
    v_mfma_f32_16x16x32_bf16 v[232:235], v[44:47], a[4:7], v[232:235]
    v_mfma_f32_16x16x32_bf16 v[236:239], v[44:47], a[76:79], v[236:239]
    ds_read_b128 v[40:43], v3 offset:5120
    ds_read_b128 v[44:47], v3 offset:23552
    s_add_u32 m0, s23, 1920
    s_nop 0
    buffer_load_dwordx4 v2, s[8:11], s24 offen offset:128 lds
    s_waitcnt lgkmcnt(6)
    v_mfma_f32_16x16x32_bf16 v[208:211], v[48:51], v[72:75], v[208:211]
    v_mfma_f32_16x16x32_bf16 v[212:215], v[48:51], v[144:147], v[212:215]
    v_mfma_f32_16x16x32_bf16 v[216:219], v[52:55], v[72:75], v[216:219]
    v_mfma_f32_16x16x32_bf16 v[220:223], v[52:55], v[144:147], v[220:223]
    v_mfma_f32_16x16x32_bf16 v[224:227], v[48:51], a[8:11], v[224:227]
    v_mfma_f32_16x16x32_bf16 v[228:231], v[48:51], a[80:83], v[228:231]
    v_mfma_f32_16x16x32_bf16 v[232:235], v[52:55], a[8:11], v[232:235]
    v_mfma_f32_16x16x32_bf16 v[236:239], v[52:55], a[80:83], v[236:239]
    ds_read_b128 v[48:51], v3 offset:6144
    ds_read_b128 v[52:55], v3 offset:24576
    s_add_u32 m0, s23, 2880
    s_nop 0
    buffer_load_dwordx4 v2, s[8:11], s24 offen offset:192 lds
    s_waitcnt lgkmcnt(6)
    v_mfma_f32_16x16x32_bf16 v[208:211], v[56:59], v[76:79], v[208:211]
    v_mfma_f32_16x16x32_bf16 v[212:215], v[56:59], v[148:151], v[212:215]
    v_mfma_f32_16x16x32_bf16 v[216:219], v[60:63], v[76:79], v[216:219]
    v_mfma_f32_16x16x32_bf16 v[220:223], v[60:63], v[148:151], v[220:223]
    v_mfma_f32_16x16x32_bf16 v[224:227], v[56:59], a[12:15], v[224:227]
    v_mfma_f32_16x16x32_bf16 v[228:231], v[56:59], a[84:87], v[228:231]
    v_mfma_f32_16x16x32_bf16 v[232:235], v[60:63], a[12:15], v[232:235]
    v_mfma_f32_16x16x32_bf16 v[236:239], v[60:63], a[84:87], v[236:239]
    ds_read_b128 v[56:59], v3 offset:7168
    ds_read_b128 v[60:63], v3 offset:25600
    s_add_u32 m0, s23, 3840
    s_nop 0
    buffer_load_dwordx4 v2, s[8:11], s24 offen offset:256 lds
    s_waitcnt lgkmcnt(6)
    v_mfma_f32_16x16x32_bf16 v[208:211], v[32:35], v[80:83], v[208:211]
    v_mfma_f32_16x16x32_bf16 v[212:215], v[32:35], v[152:155], v[212:215]
    v_mfma_f32_16x16x32_bf16 v[216:219], v[36:39], v[80:83], v[216:219]
    v_mfma_f32_16x16x32_bf16 v[220:223], v[36:39], v[152:155], v[220:223]
    v_mfma_f32_16x16x32_bf16 v[224:227], v[32:35], a[16:19], v[224:227]
    v_mfma_f32_16x16x32_bf16 v[228:231], v[32:35], a[88:91], v[228:231]
    v_mfma_f32_16x16x32_bf16 v[232:235], v[36:39], a[16:19], v[232:235]
    v_mfma_f32_16x16x32_bf16 v[236:239], v[36:39], a[88:91], v[236:239]
    ds_read_b128 v[32:35], v3 offset:8192
    ds_read_b128 v[36:39], v3 offset:26624
    s_add_u32 m0, s23, 4800
    s_nop 0
    buffer_load_dwordx4 v2, s[8:11], s24 offen offset:320 lds
    s_waitcnt lgkmcnt(6)
    v_mfma_f32_16x16x32_bf16 v[208:211], v[40:43], v[84:87], v[208:211]
    v_mfma_f32_16x16x32_bf16 v[212:215], v[40:43], v[156:159], v[212:215]
    v_mfma_f32_16x16x32_bf16 v[216:219], v[44:47], v[84:87], v[216:219]
    v_mfma_f32_16x16x32_bf16 v[220:223], v[44:47], v[156:159], v[220:223]
    v_mfma_f32_16x16x32_bf16 v[224:227], v[40:43], a[20:23], v[224:227]
    v_mfma_f32_16x16x32_bf16 v[228:231], v[40:43], a[92:95], v[228:231]
    v_mfma_f32_16x16x32_bf16 v[232:235], v[44:47], a[20:23], v[232:235]
    v_mfma_f32_16x16x32_bf16 v[236:239], v[44:47], a[92:95], v[236:239]
    ds_read_b128 v[40:43], v3 offset:9216
    ds_read_b128 v[44:47], v3 offset:27648
    s_add_u32 m0, s23, 5760
    s_nop 0
    buffer_load_dwordx4 v2, s[8:11], s24 offen offset:384 lds
    s_waitcnt lgkmcnt(6)
    v_mfma_f32_16x16x32_bf16 v[208:211], v[48:51], v[88:91], v[208:211]
    v_mfma_f32_16x16x32_bf16 v[212:215], v[48:51], v[160:163], v[212:215]
    v_mfma_f32_16x16x32_bf16 v[216:219], v[52:55], v[88:91], v[216:219]
    v_mfma_f32_16x16x32_bf16 v[220:223], v[52:55], v[160:163], v[220:223]
    v_mfma_f32_16x16x32_bf16 v[224:227], v[48:51], a[24:27], v[224:227]
    v_mfma_f32_16x16x32_bf16 v[228:231], v[48:51], a[96:99], v[228:231]
    v_mfma_f32_16x16x32_bf16 v[232:235], v[52:55], a[24:27], v[232:235]
    v_mfma_f32_16x16x32_bf16 v[236:239], v[52:55], a[96:99], v[236:239]
    ds_read_b128 v[48:51], v3 offset:10240
    ds_read_b128 v[52:55], v3 offset:28672
    s_add_u32 m0, s23, 6720
    s_nop 0
    buffer_load_dwordx4 v2, s[8:11], s24 offen offset:448 lds
    s_waitcnt lgkmcnt(6)
    v_mfma_f32_16x16x32_bf16 v[208:211], v[56:59], v[92:95], v[208:211]
    v_mfma_f32_16x16x32_bf16 v[212:215], v[56:59], v[164:167], v[212:215]
    v_mfma_f32_16x16x32_bf16 v[216:219], v[60:63], v[92:95], v[216:219]
    v_mfma_f32_16x16x32_bf16 v[220:223], v[60:63], v[164:167], v[220:223]
    v_mfma_f32_16x16x32_bf16 v[224:227], v[56:59], a[28:31], v[224:227]
    v_mfma_f32_16x16x32_bf16 v[228:231], v[56:59], a[100:103], v[228:231]
    v_mfma_f32_16x16x32_bf16 v[232:235], v[60:63], a[28:31], v[232:235]
    v_mfma_f32_16x16x32_bf16 v[236:239], v[60:63], a[100:103], v[236:239]
    ds_read_b128 v[56:59], v3 offset:11264
    ds_read_b128 v[60:63], v3 offset:29696
    s_add_u32 m0, s23, 7680
    s_nop 0
    buffer_load_dwordx4 v2, s[8:11], s24 offen offset:512 lds
    s_add_u32 s24, s24, 147456
    s_waitcnt lgkmcnt(6)
    v_mfma_f32_16x16x32_bf16 v[208:211], v[32:35], v[96:99], v[208:211]
    v_mfma_f32_16x16x32_bf16 v[212:215], v[32:35], v[168:171], v[212:215]
    v_mfma_f32_16x16x32_bf16 v[216:219], v[36:39], v[96:99], v[216:219]
    v_mfma_f32_16x16x32_bf16 v[220:223], v[36:39], v[168:171], v[220:223]
    v_mfma_f32_16x16x32_bf16 v[224:227], v[32:35], a[32:35], v[224:227]
    v_mfma_f32_16x16x32_bf16 v[228:231], v[32:35], a[104:107], v[228:231]
    v_mfma_f32_16x16x32_bf16 v[232:235], v[36:39], a[32:35], v[232:235]
    v_mfma_f32_16x16x32_bf16 v[236:239], v[36:39], a[104:107], v[236:239]
    ds_read_b128 v[32:35], v3 offset:12288
    ds_read_b128 v[36:39], v3 offset:30720
    s_waitcnt lgkmcnt(6)
    v_mfma_f32_16x16x32_bf16 v[208:211], v[40:43], v[100:103], v[208:211]
    v_mfma_f32_16x16x32_bf16 v[212:215], v[40:43], v[172:175], v[212:215]
    v_mfma_f32_16x16x32_bf16 v[216:219], v[44:47], v[100:103], v[216:219]
    v_mfma_f32_16x16x32_bf16 v[220:223], v[44:47], v[172:175], v[220:223]
    v_mfma_f32_16x16x32_bf16 v[224:227], v[40:43], a[36:39], v[224:227]
    v_mfma_f32_16x16x32_bf16 v[228:231], v[40:43], a[108:111], v[228:231]
    v_mfma_f32_16x16x32_bf16 v[232:235], v[44:47], a[36:39], v[232:235]
    v_mfma_f32_16x16x32_bf16 v[236:239], v[44:47], a[108:111], v[236:239]
    ds_read_b128 v[40:43], v3 offset:13312
    ds_read_b128 v[44:47], v3 offset:31744
    s_waitcnt lgkmcnt(6)
    v_mfma_f32_16x16x32_bf16 v[208:211], v[48:51], v[104:107], v[208:211]
    v_mfma_f32_16x16x32_bf16 v[212:215], v[48:51], v[176:179], v[212:215]
    v_mfma_f32_16x16x32_bf16 v[216:219], v[52:55], v[104:107], v[216:219]
    v_mfma_f32_16x16x32_bf16 v[220:223], v[52:55], v[176:179], v[220:223]
    v_mfma_f32_16x16x32_bf16 v[224:227], v[48:51], a[40:43], v[224:227]
    v_mfma_f32_16x16x32_bf16 v[228:231], v[48:51], a[112:115], v[228:231]
    v_mfma_f32_16x16x32_bf16 v[232:235], v[52:55], a[40:43], v[232:235]
    v_mfma_f32_16x16x32_bf16 v[236:239], v[52:55], a[112:115], v[236:239]
    ds_read_b128 v[48:51], v3 offset:14336
    ds_read_b128 v[52:55], v3 offset:32768
    s_waitcnt lgkmcnt(6)
    v_mfma_f32_16x16x32_bf16 v[208:211], v[56:59], v[108:111], v[208:211]
    v_mfma_f32_16x16x32_bf16 v[212:215], v[56:59], v[180:183], v[212:215]
    v_mfma_f32_16x16x32_bf16 v[216:219], v[60:63], v[108:111], v[216:219]
    v_mfma_f32_16x16x32_bf16 v[220:223], v[60:63], v[180:183], v[220:223]
    v_mfma_f32_16x16x32_bf16 v[224:227], v[56:59], a[44:47], v[224:227]
    v_mfma_f32_16x16x32_bf16 v[228:231], v[56:59], a[116:119], v[228:231]
    v_mfma_f32_16x16x32_bf16 v[232:235], v[60:63], a[44:47], v[232:235]
    v_mfma_f32_16x16x32_bf16 v[236:239], v[60:63], a[116:119], v[236:239]
    ds_read_b128 v[56:59], v3 offset:15360
    ds_read_b128 v[60:63], v3 offset:33792
    s_waitcnt lgkmcnt(6)
    v_mfma_f32_16x16x32_bf16 v[208:211], v[32:35], v[112:115], v[208:211]
    v_mfma_f32_16x16x32_bf16 v[212:215], v[32:35], v[184:187], v[212:215]
    v_mfma_f32_16x16x32_bf16 v[216:219], v[36:39], v[112:115], v[216:219]
    v_mfma_f32_16x16x32_bf16 v[220:223], v[36:39], v[184:187], v[220:223]
    v_mfma_f32_16x16x32_bf16 v[224:227], v[32:35], a[48:51], v[224:227]
    v_mfma_f32_16x16x32_bf16 v[228:231], v[32:35], a[120:123], v[228:231]
    v_mfma_f32_16x16x32_bf16 v[232:235], v[36:39], a[48:51], v[232:235]
    v_mfma_f32_16x16x32_bf16 v[236:239], v[36:39], a[120:123], v[236:239]
    ds_read_b128 v[32:35], v3 offset:16384
    ds_read_b128 v[36:39], v3 offset:34816
    s_waitcnt lgkmcnt(6)
    v_mfma_f32_16x16x32_bf16 v[208:211], v[40:43], v[116:119], v[208:211]
    v_mfma_f32_16x16x32_bf16 v[212:215], v[40:43], v[188:191], v[212:215]
    v_mfma_f32_16x16x32_bf16 v[216:219], v[44:47], v[116:119], v[216:219]
    v_mfma_f32_16x16x32_bf16 v[220:223], v[44:47], v[188:191], v[220:223]
    v_mfma_f32_16x16x32_bf16 v[224:227], v[40:43], a[52:55], v[224:227]
    v_mfma_f32_16x16x32_bf16 v[228:231], v[40:43], a[124:127], v[228:231]
    v_mfma_f32_16x16x32_bf16 v[232:235], v[44:47], a[52:55], v[232:235]
    v_mfma_f32_16x16x32_bf16 v[236:239], v[44:47], a[124:127], v[236:239]
    ds_read_b128 v[40:43], v3 offset:17408
    ds_read_b128 v[44:47], v3 offset:35840
    s_waitcnt lgkmcnt(6)
    v_mfma_f32_16x16x32_bf16 v[208:211], v[48:51], v[120:123], v[208:211]
    v_mfma_f32_16x16x32_bf16 v[212:215], v[48:51], v[192:195], v[212:215]
    v_mfma_f32_16x16x32_bf16 v[216:219], v[52:55], v[120:123], v[216:219]
    v_mfma_f32_16x16x32_bf16 v[220:223], v[52:55], v[192:195], v[220:223]
    v_mfma_f32_16x16x32_bf16 v[224:227], v[48:51], a[56:59], v[224:227]
    v_mfma_f32_16x16x32_bf16 v[228:231], v[48:51], a[128:131], v[228:231]
    v_mfma_f32_16x16x32_bf16 v[232:235], v[52:55], a[56:59], v[232:235]
    v_mfma_f32_16x16x32_bf16 v[236:239], v[52:55], a[128:131], v[236:239]
    s_waitcnt lgkmcnt(4)
    v_mfma_f32_16x16x32_bf16 v[208:211], v[56:59], v[124:127], v[208:211]
    v_mfma_f32_16x16x32_bf16 v[212:215], v[56:59], v[196:199], v[212:215]
    v_mfma_f32_16x16x32_bf16 v[216:219], v[60:63], v[124:127], v[216:219]
    v_mfma_f32_16x16x32_bf16 v[220:223], v[60:63], v[196:199], v[220:223]
    v_mfma_f32_16x16x32_bf16 v[224:227], v[56:59], a[60:63], v[224:227]
    v_mfma_f32_16x16x32_bf16 v[228:231], v[56:59], a[132:135], v[228:231]
    v_mfma_f32_16x16x32_bf16 v[232:235], v[60:63], a[60:63], v[232:235]
    v_mfma_f32_16x16x32_bf16 v[236:239], v[60:63], a[132:135], v[236:239]
    s_waitcnt lgkmcnt(2)
    v_mfma_f32_16x16x32_bf16 v[208:211], v[32:35], v[128:131], v[208:211]
    v_mfma_f32_16x16x32_bf16 v[212:215], v[32:35], v[200:203], v[212:215]
    v_mfma_f32_16x16x32_bf16 v[216:219], v[36:39], v[128:131], v[216:219]
    v_mfma_f32_16x16x32_bf16 v[220:223], v[36:39], v[200:203], v[220:223]
    v_mfma_f32_16x16x32_bf16 v[224:227], v[32:35], a[64:67], v[224:227]
    v_mfma_f32_16x16x32_bf16 v[228:231], v[32:35], a[136:139], v[228:231]
    v_mfma_f32_16x16x32_bf16 v[232:235], v[36:39], a[64:67], v[232:235]
    v_mfma_f32_16x16x32_bf16 v[236:239], v[36:39], a[136:139], v[236:239]
    s_waitcnt lgkmcnt(0)
    v_mfma_f32_16x16x32_bf16 v[208:211], v[40:43], v[132:135], v[208:211]
    v_mfma_f32_16x16x32_bf16 v[212:215], v[40:43], v[204:207], v[212:215]
    v_mfma_f32_16x16x32_bf16 v[216:219], v[44:47], v[132:135], v[216:219]
    v_mfma_f32_16x16x32_bf16 v[220:223], v[44:47], v[204:207], v[220:223]
    v_mfma_f32_16x16x32_bf16 v[224:227], v[40:43], a[68:71], v[224:227]
    v_mfma_f32_16x16x32_bf16 v[228:231], v[40:43], a[140:143], v[228:231]
    v_mfma_f32_16x16x32_bf16 v[232:235], v[44:47], a[68:71], v[232:235]
    v_mfma_f32_16x16x32_bf16 v[236:239], v[44:47], a[140:143], v[236:239]
    s_waitcnt vmcnt(0)
    v_cvt_pk_bf16_f32 v8, v208, v209
    v_cvt_pk_bf16_f32 v9, v210, v211
    v_cvt_pk_bf16_f32 v10, v216, v217
    v_cvt_pk_bf16_f32 v11, v218, v219
    s_lshr_b32 s22, s41, 5
    s_mul_i32 s22, s22, 0
    s_add_u32 s28, s26, s22
    buffer_store_dwordx4 v[8:11], v7, s[4:7], s28 offen sc1
    v_cvt_pk_bf16_f32 v12, v212, v213
    v_cvt_pk_bf16_f32 v13, v214, v215
    v_cvt_pk_bf16_f32 v14, v220, v221
    v_cvt_pk_bf16_f32 v15, v222, v223
    s_lshr_b32 s22, s41, 5
    s_mul_i32 s22, s22, 0
    s_add_u32 s28, s26, s22
    s_add_u32 s28, s28, s40
    buffer_store_dwordx4 v[12:15], v7, s[4:7], s28 offen sc1
    v_cvt_pk_bf16_f32 v16, v224, v225
    v_cvt_pk_bf16_f32 v17, v226, v227
    v_cvt_pk_bf16_f32 v18, v232, v233
    v_cvt_pk_bf16_f32 v19, v234, v235
    s_lshr_b32 s22, s41, 5
    s_mul_i32 s22, s22, 1
    s_add_u32 s28, s26, s22
    buffer_store_dwordx4 v[16:19], v7, s[4:7], s28 offen sc1
    v_cvt_pk_bf16_f32 v20, v228, v229
    v_cvt_pk_bf16_f32 v21, v230, v231
    v_cvt_pk_bf16_f32 v22, v236, v237
    v_cvt_pk_bf16_f32 v23, v238, v239
    s_lshr_b32 s22, s41, 5
    s_mul_i32 s22, s22, 1
    s_add_u32 s28, s26, s22
    s_add_u32 s28, s28, s40
    buffer_store_dwordx4 v[20:23], v7, s[4:7], s28 offen sc1
    s_lshl_b32 s22, s41, 2
    s_add_u32 s26, s26, s22
    s_lshr_b32 s45, s19, 2
    s_cbranch_scc1 qk_vloop_nf
    s_waitcnt vmcnt(0)
    s_mov_b32 s45, 1
qk_vloop_nf:
    s_add_u32 s27, s27, 36864
    s_cmp_eq_u32 s27, 110592
    s_cselect_b32 s27, 0, s27
    s_add_u32 s19, s19, 4
    s_cmp_lt_u32 s19, s20
    s_cbranch_scc1 qk_vloop
qk_done:
    s_waitcnt vmcnt(0)
    s_barrier
    s_mov_b32 s45, 16
    s_add_u32 s23, s45, s95
    v_mov_b32 v4, s23
    s_mov_b64 exec, s[34:35]
    buffer_store_dword v4, off, s[4:7], s29 sc1
    buffer_store_dword v4, off, s[4:7], s29 offset:128 sc1
    s_mov_b64 exec, -1
    s_cmp_eq_u32 s16, 0
    s_cbranch_scc1 L_qkv_next
    s_cmp_lg_u32 s19, 64
    s_cbranch_scc1 L_qkv_next
    v_and_b32 v4, 63, v0
    v_and_b32 v2, 7, v4
    v_lshrrev_b32 v5, 4, v4
    v_lshl_add_u32 v2, v5, 3, v2
    v_lshlrev_b32 v2, 4, v2
    v_bfe_u32 v3, v4, 3, 1
    v_mul_u32_u24 v5, 9216, v3
    v_add_u32 v2, v2, v5
    v_mov_b32 v240, 0x05040100
    v_mov_b32 v241, 0x07060302
    v_lshrrev_b32 v5, 5, v4
    v_and_b32 v1, 0xdff, v7
    s_cmp_eq_u32 s16, 2
    s_cbranch_scc1 mk_isv
    v_mov_b32 v5, v3
    v_or_b32 v1, 128, v7
mk_isv:
    v_lshl_add_u32 v1, v5, 17, v1
    s_mov_b32 s28, 0
    s_mov_b32 s19, 2
    s_mov_b32 s24, 138412032
    s_lshl_b32 s26, s17, 12
    s_mov_b32 s21, 69206016
    s_cmp_eq_u32 s16, 2
    s_cselect_b32 s21, 77594624, s21
    s_add_u32 s26, s26, s21
    s_lshl_b32 s29, s17, 7
    s_lshl_b32 s21, s16, 2
    s_add_u32 s29, s29, s21
    s_add_u32 s29, s29, 125829164
mk_loop:
    s_cmp_lg_u32 s18, 0
    s_cbranch_scc1 mk_go
    s_cmp_le_u32 s19, s28
    s_cbranch_scc1 mk_go
    s_mov_b32 s23, 125853696
    s_mov_b32 s21, 4194304
mk_wait:
    buffer_load_dword v4, off, s[4:7], s23 sc1
    s_sub_u32 s21, s21, 1
    s_cbranch_scc1 mk_go
    s_waitcnt vmcnt(0)
    v_readfirstlane_b32 s28, v4
    s_nop 0
    s_sub_u32 s28, s28, s95
    s_cmp_gt_u32 s28, 64
    s_cselect_b32 s28, 0, s28
    s_cmp_le_u32 s19, s28
    s_cbranch_scc1 mk_go
    s_sleep 4
    s_branch mk_wait
mk_go:
    s_barrier
    s_add_u32 s21, s24, 4096
    s_add_u32 s23, s24, 8192
    buffer_load_dwordx4 v[24:27], v2, s[4:7], s24 offen offset:0 sc1
    buffer_load_dwordx4 v[28:31], v2, s[4:7], s24 offen offset:512 sc1
    buffer_load_dwordx4 v[32:35], v2, s[4:7], s21 offen offset:0 sc1
    buffer_load_dwordx4 v[36:39], v2, s[4:7], s21 offen offset:512 sc1
    buffer_load_dwordx4 v[40:43], v2, s[4:7], s24 offen offset:1024 sc1
    buffer_load_dwordx4 v[44:47], v2, s[4:7], s24 offen offset:1536 sc1
    buffer_load_dwordx4 v[48:51], v2, s[4:7], s21 offen offset:1024 sc1
    buffer_load_dwordx4 v[52:55], v2, s[4:7], s21 offen offset:1536 sc1
    buffer_load_dwordx4 v[56:59], v2, s[4:7], s24 offen offset:2048 sc1
    buffer_load_dwordx4 v[60:63], v2, s[4:7], s24 offen offset:2560 sc1
    buffer_load_dwordx4 v[208:211], v2, s[4:7], s21 offen offset:2048 sc1
    buffer_load_dwordx4 v[212:215], v2, s[4:7], s21 offen offset:2560 sc1
    buffer_load_dwordx4 v[216:219], v2, s[4:7], s24 offen offset:3072 sc1
    buffer_load_dwordx4 v[220:223], v2, s[4:7], s24 offen offset:3584 sc1
    buffer_load_dwordx4 v[224:227], v2, s[4:7], s21 offen offset:3072 sc1
    buffer_load_dwordx4 v[228:231], v2, s[4:7], s21 offen offset:3584 sc1
    buffer_load_dwordx4 v[232:235], v2, s[4:7], s23 offen offset:0 sc1
    buffer_load_dwordx4 v[236:239], v2, s[4:7], s23 offen offset:512 sc1
    s_add_u32 s24, s24, 18432
    s_cmp_eq_u32 s16, 2
    s_cbranch_scc1 mk_v
    s_waitcnt vmcnt(17)
    v_perm_b32 v244, v25, v24, v240
    v_perm_b32 v245, v27, v26, v240
    v_perm_b32 v246, v25, v24, v241
    v_perm_b32 v247, v27, v26, v241
    s_waitcnt vmcnt(16)
    v_perm_b32 v248, v29, v28, v240
    v_perm_b32 v249, v31, v30, v240
    v_perm_b32 v250, v29, v28, v241
    v_perm_b32 v251, v31, v30, v241
    v_mfma_f32_16x16x32_bf16 v[8:11], v[64:67], v[244:247], 0
    v_mfma_f32_16x16x32_bf16 v[12:15], v[136:139], v[244:247], 0
    v_mfma_f32_16x16x32_bf16 v[16:19], a[0:3], v[244:247], 0
    v_mfma_f32_16x16x32_bf16 v[20:23], a[72:75], v[244:247], 0
    s_waitcnt vmcnt(15)
    v_perm_b32 v244, v33, v32, v240
    v_perm_b32 v245, v35, v34, v240
    v_perm_b32 v246, v33, v32, v241
    v_perm_b32 v247, v35, v34, v241
    v_mfma_f32_16x16x32_bf16 v[8:11], v[68:71], v[248:251], v[8:11]
    v_mfma_f32_16x16x32_bf16 v[12:15], v[140:143], v[248:251], v[12:15]
    v_mfma_f32_16x16x32_bf16 v[16:19], a[4:7], v[248:251], v[16:19]
    v_mfma_f32_16x16x32_bf16 v[20:23], a[76:79], v[248:251], v[20:23]
    s_waitcnt vmcnt(14)
    v_perm_b32 v248, v37, v36, v240
    v_perm_b32 v249, v39, v38, v240
    v_perm_b32 v250, v37, v36, v241
    v_perm_b32 v251, v39, v38, v241
    v_mfma_f32_16x16x32_bf16 v[8:11], v[72:75], v[244:247], v[8:11]
    v_mfma_f32_16x16x32_bf16 v[12:15], v[144:147], v[244:247], v[12:15]
    v_mfma_f32_16x16x32_bf16 v[16:19], a[8:11], v[244:247], v[16:19]
    v_mfma_f32_16x16x32_bf16 v[20:23], a[80:83], v[244:247], v[20:23]
    s_waitcnt vmcnt(13)
    v_perm_b32 v244, v41, v40, v240
    v_perm_b32 v245, v43, v42, v240
    v_perm_b32 v246, v41, v40, v241
    v_perm_b32 v247, v43, v42, v241
    v_mfma_f32_16x16x32_bf16 v[8:11], v[76:79], v[248:251], v[8:11]
    v_mfma_f32_16x16x32_bf16 v[12:15], v[148:151], v[248:251], v[12:15]
    v_mfma_f32_16x16x32_bf16 v[16:19], a[12:15], v[248:251], v[16:19]
    v_mfma_f32_16x16x32_bf16 v[20:23], a[84:87], v[248:251], v[20:23]
    s_waitcnt vmcnt(12)
    v_perm_b32 v248, v45, v44, v240
    v_perm_b32 v249, v47, v46, v240
    v_perm_b32 v250, v45, v44, v241
    v_perm_b32 v251, v47, v46, v241
    v_mfma_f32_16x16x32_bf16 v[8:11], v[80:83], v[244:247], v[8:11]
    v_mfma_f32_16x16x32_bf16 v[12:15], v[152:155], v[244:247], v[12:15]
    v_mfma_f32_16x16x32_bf16 v[16:19], a[16:19], v[244:247], v[16:19]
    v_mfma_f32_16x16x32_bf16 v[20:23], a[88:91], v[244:247], v[20:23]
    s_waitcnt vmcnt(11)
    v_perm_b32 v244, v49, v48, v240
    v_perm_b32 v245, v51, v50, v240
    v_perm_b32 v246, v49, v48, v241
    v_perm_b32 v247, v51, v50, v241
    v_mfma_f32_16x16x32_bf16 v[8:11], v[84:87], v[248:251], v[8:11]
    v_mfma_f32_16x16x32_bf16 v[12:15], v[156:159], v[248:251], v[12:15]
    v_mfma_f32_16x16x32_bf16 v[16:19], a[20:23], v[248:251], v[16:19]
    v_mfma_f32_16x16x32_bf16 v[20:23], a[92:95], v[248:251], v[20:23]
    s_waitcnt vmcnt(10)
    v_perm_b32 v248, v53, v52, v240
    v_perm_b32 v249, v55, v54, v240
    v_perm_b32 v250, v53, v52, v241
    v_perm_b32 v251, v55, v54, v241
    v_mfma_f32_16x16x32_bf16 v[8:11], v[88:91], v[244:247], v[8:11]
    v_mfma_f32_16x16x32_bf16 v[12:15], v[160:163], v[244:247], v[12:15]
    v_mfma_f32_16x16x32_bf16 v[16:19], a[24:27], v[244:247], v[16:19]
    v_mfma_f32_16x16x32_bf16 v[20:23], a[96:99], v[244:247], v[20:23]
    s_waitcnt vmcnt(9)
    v_perm_b32 v244, v57, v56, v240
    v_perm_b32 v245, v59, v58, v240
    v_perm_b32 v246, v57, v56, v241
    v_perm_b32 v247, v59, v58, v241
    v_mfma_f32_16x16x32_bf16 v[8:11], v[92:95], v[248:251], v[8:11]
    v_mfma_f32_16x16x32_bf16 v[12:15], v[164:167], v[248:251], v[12:15]
    v_mfma_f32_16x16x32_bf16 v[16:19], a[28:31], v[248:251], v[16:19]
    v_mfma_f32_16x16x32_bf16 v[20:23], a[100:103], v[248:251], v[20:23]
    s_waitcnt vmcnt(8)
    v_perm_b32 v248, v61, v60, v240
    v_perm_b32 v249, v63, v62, v240
    v_perm_b32 v250, v61, v60, v241
    v_perm_b32 v251, v63, v62, v241
    v_mfma_f32_16x16x32_bf16 v[8:11], v[96:99], v[244:247], v[8:11]
    v_mfma_f32_16x16x32_bf16 v[12:15], v[168:171], v[244:247], v[12:15]
    v_mfma_f32_16x16x32_bf16 v[16:19], a[32:35], v[244:247], v[16:19]
    v_mfma_f32_16x16x32_bf16 v[20:23], a[104:107], v[244:247], v[20:23]
    s_waitcnt vmcnt(7)
    v_perm_b32 v244, v209, v208, v240
    v_perm_b32 v245, v211, v210, v240
    v_perm_b32 v246, v209, v208, v241
    v_perm_b32 v247, v211, v210, v241
    v_mfma_f32_16x16x32_bf16 v[8:11], v[100:103], v[248:251], v[8:11]
    v_mfma_f32_16x16x32_bf16 v[12:15], v[172:175], v[248:251], v[12:15]
    v_mfma_f32_16x16x32_bf16 v[16:19], a[36:39], v[248:251], v[16:19]
    v_mfma_f32_16x16x32_bf16 v[20:23], a[108:111], v[248:251], v[20:23]
    s_waitcnt vmcnt(6)
    v_perm_b32 v248, v213, v212, v240
    v_perm_b32 v249, v215, v214, v240
    v_perm_b32 v250, v213, v212, v241
    v_perm_b32 v251, v215, v214, v241
    v_mfma_f32_16x16x32_bf16 v[8:11], v[104:107], v[244:247], v[8:11]
    v_mfma_f32_16x16x32_bf16 v[12:15], v[176:179], v[244:247], v[12:15]
    v_mfma_f32_16x16x32_bf16 v[16:19], a[40:43], v[244:247], v[16:19]
    v_mfma_f32_16x16x32_bf16 v[20:23], a[112:115], v[244:247], v[20:23]
    s_waitcnt vmcnt(5)
    v_perm_b32 v244, v217, v216, v240
    v_perm_b32 v245, v219, v218, v240
    v_perm_b32 v246, v217, v216, v241
    v_perm_b32 v247, v219, v218, v241
    v_mfma_f32_16x16x32_bf16 v[8:11], v[108:111], v[248:251], v[8:11]
    v_mfma_f32_16x16x32_bf16 v[12:15], v[180:183], v[248:251], v[12:15]
    v_mfma_f32_16x16x32_bf16 v[16:19], a[44:47], v[248:251], v[16:19]
    v_mfma_f32_16x16x32_bf16 v[20:23], a[116:119], v[248:251], v[20:23]
    s_waitcnt vmcnt(4)
    v_perm_b32 v248, v221, v220, v240
    v_perm_b32 v249, v223, v222, v240
    v_perm_b32 v250, v221, v220, v241
    v_perm_b32 v251, v223, v222, v241
    v_mfma_f32_16x16x32_bf16 v[8:11], v[112:115], v[244:247], v[8:11]
    v_mfma_f32_16x16x32_bf16 v[12:15], v[184:187], v[244:247], v[12:15]
    v_mfma_f32_16x16x32_bf16 v[16:19], a[48:51], v[244:247], v[16:19]
    v_mfma_f32_16x16x32_bf16 v[20:23], a[120:123], v[244:247], v[20:23]
    s_waitcnt vmcnt(3)
    v_perm_b32 v244, v225, v224, v240
    v_perm_b32 v245, v227, v226, v240
    v_perm_b32 v246, v225, v224, v241
    v_perm_b32 v247, v227, v226, v241
    v_mfma_f32_16x16x32_bf16 v[8:11], v[116:119], v[248:251], v[8:11]
    v_mfma_f32_16x16x32_bf16 v[12:15], v[188:191], v[248:251], v[12:15]
    v_mfma_f32_16x16x32_bf16 v[16:19], a[52:55], v[248:251], v[16:19]
    v_mfma_f32_16x16x32_bf16 v[20:23], a[124:127], v[248:251], v[20:23]
    s_waitcnt vmcnt(2)
    v_perm_b32 v248, v229, v228, v240
    v_perm_b32 v249, v231, v230, v240
    v_perm_b32 v250, v229, v228, v241
    v_perm_b32 v251, v231, v230, v241
    v_mfma_f32_16x16x32_bf16 v[8:11], v[120:123], v[244:247], v[8:11]
    v_mfma_f32_16x16x32_bf16 v[12:15], v[192:195], v[244:247], v[12:15]
    v_mfma_f32_16x16x32_bf16 v[16:19], a[56:59], v[244:247], v[16:19]
    v_mfma_f32_16x16x32_bf16 v[20:23], a[128:131], v[244:247], v[20:23]
    s_waitcnt vmcnt(1)
    v_mfma_f32_16x16x32_bf16 v[8:11], v[124:127], v[248:251], v[8:11]
    v_mfma_f32_16x16x32_bf16 v[12:15], v[196:199], v[248:251], v[12:15]
    v_mfma_f32_16x16x32_bf16 v[16:19], a[60:63], v[248:251], v[16:19]
    v_mfma_f32_16x16x32_bf16 v[20:23], a[132:135], v[248:251], v[20:23]
    s_waitcnt vmcnt(0)
    v_mfma_f32_16x16x32_bf16 v[8:11], v[128:131], v[232:235], v[8:11]
    v_mfma_f32_16x16x32_bf16 v[12:15], v[200:203], v[232:235], v[12:15]
    v_mfma_f32_16x16x32_bf16 v[16:19], a[64:67], v[232:235], v[16:19]
    v_mfma_f32_16x16x32_bf16 v[20:23], a[136:139], v[232:235], v[20:23]
    v_mfma_f32_16x16x32_bf16 v[8:11], v[132:135], v[236:239], v[8:11]
    v_mfma_f32_16x16x32_bf16 v[12:15], v[204:207], v[236:239], v[12:15]
    v_mfma_f32_16x16x32_bf16 v[16:19], a[68:71], v[236:239], v[16:19]
    v_mfma_f32_16x16x32_bf16 v[20:23], a[140:143], v[236:239], v[20:23]
    s_nop 7
    s_branch mk_st
mk_v:
    s_waitcnt vmcnt(17)
    v_perm_b32 v244, v25, v24, v240
    v_perm_b32 v245, v27, v26, v240
    v_perm_b32 v246, v25, v24, v241
    v_perm_b32 v247, v27, v26, v241
    s_waitcnt vmcnt(16)
    v_perm_b32 v248, v29, v28, v240
    v_perm_b32 v249, v31, v30, v240
    v_perm_b32 v250, v29, v28, v241
    v_perm_b32 v251, v31, v30, v241
    v_mfma_f32_16x16x32_bf16 v[8:11], v[244:247], v[64:67], 0
    v_mfma_f32_16x16x32_bf16 v[12:15], v[244:247], v[136:139], 0
    v_mfma_f32_16x16x32_bf16 v[16:19], v[244:247], a[0:3], 0
    v_mfma_f32_16x16x32_bf16 v[20:23], v[244:247], a[72:75], 0
    s_waitcnt vmcnt(15)
    v_perm_b32 v244, v33, v32, v240
    v_perm_b32 v245, v35, v34, v240
    v_perm_b32 v246, v33, v32, v241
    v_perm_b32 v247, v35, v34, v241
    v_mfma_f32_16x16x32_bf16 v[8:11], v[248:251], v[68:71], v[8:11]
    v_mfma_f32_16x16x32_bf16 v[12:15], v[248:251], v[140:143], v[12:15]
    v_mfma_f32_16x16x32_bf16 v[16:19], v[248:251], a[4:7], v[16:19]
    v_mfma_f32_16x16x32_bf16 v[20:23], v[248:251], a[76:79], v[20:23]
    s_waitcnt vmcnt(14)
    v_perm_b32 v248, v37, v36, v240
    v_perm_b32 v249, v39, v38, v240
    v_perm_b32 v250, v37, v36, v241
    v_perm_b32 v251, v39, v38, v241
    v_mfma_f32_16x16x32_bf16 v[8:11], v[244:247], v[72:75], v[8:11]
    v_mfma_f32_16x16x32_bf16 v[12:15], v[244:247], v[144:147], v[12:15]
    v_mfma_f32_16x16x32_bf16 v[16:19], v[244:247], a[8:11], v[16:19]
    v_mfma_f32_16x16x32_bf16 v[20:23], v[244:247], a[80:83], v[20:23]
    s_waitcnt vmcnt(13)
    v_perm_b32 v244, v41, v40, v240
    v_perm_b32 v245, v43, v42, v240
    v_perm_b32 v246, v41, v40, v241
    v_perm_b32 v247, v43, v42, v241
    v_mfma_f32_16x16x32_bf16 v[8:11], v[248:251], v[76:79], v[8:11]
    v_mfma_f32_16x16x32_bf16 v[12:15], v[248:251], v[148:151], v[12:15]
    v_mfma_f32_16x16x32_bf16 v[16:19], v[248:251], a[12:15], v[16:19]
    v_mfma_f32_16x16x32_bf16 v[20:23], v[248:251], a[84:87], v[20:23]
    s_waitcnt vmcnt(12)
    v_perm_b32 v248, v45, v44, v240
    v_perm_b32 v249, v47, v46, v240
    v_perm_b32 v250, v45, v44, v241
    v_perm_b32 v251, v47, v46, v241
    v_mfma_f32_16x16x32_bf16 v[8:11], v[244:247], v[80:83], v[8:11]
    v_mfma_f32_16x16x32_bf16 v[12:15], v[244:247], v[152:155], v[12:15]
    v_mfma_f32_16x16x32_bf16 v[16:19], v[244:247], a[16:19], v[16:19]
    v_mfma_f32_16x16x32_bf16 v[20:23], v[244:247], a[88:91], v[20:23]
    s_waitcnt vmcnt(11)
    v_perm_b32 v244, v49, v48, v240
    v_perm_b32 v245, v51, v50, v240
    v_perm_b32 v246, v49, v48, v241
    v_perm_b32 v247, v51, v50, v241
    v_mfma_f32_16x16x32_bf16 v[8:11], v[248:251], v[84:87], v[8:11]
    v_mfma_f32_16x16x32_bf16 v[12:15], v[248:251], v[156:159], v[12:15]
    v_mfma_f32_16x16x32_bf16 v[16:19], v[248:251], a[20:23], v[16:19]
    v_mfma_f32_16x16x32_bf16 v[20:23], v[248:251], a[92:95], v[20:23]
    s_waitcnt vmcnt(10)
    v_perm_b32 v248, v53, v52, v240
    v_perm_b32 v249, v55, v54, v240
    v_perm_b32 v250, v53, v52, v241
    v_perm_b32 v251, v55, v54, v241
    v_mfma_f32_16x16x32_bf16 v[8:11], v[244:247], v[88:91], v[8:11]
    v_mfma_f32_16x16x32_bf16 v[12:15], v[244:247], v[160:163], v[12:15]
    v_mfma_f32_16x16x32_bf16 v[16:19], v[244:247], a[24:27], v[16:19]
    v_mfma_f32_16x16x32_bf16 v[20:23], v[244:247], a[96:99], v[20:23]
    s_waitcnt vmcnt(9)
    v_perm_b32 v244, v57, v56, v240
    v_perm_b32 v245, v59, v58, v240
    v_perm_b32 v246, v57, v56, v241
    v_perm_b32 v247, v59, v58, v241
    v_mfma_f32_16x16x32_bf16 v[8:11], v[248:251], v[92:95], v[8:11]
    v_mfma_f32_16x16x32_bf16 v[12:15], v[248:251], v[164:167], v[12:15]
    v_mfma_f32_16x16x32_bf16 v[16:19], v[248:251], a[28:31], v[16:19]
    v_mfma_f32_16x16x32_bf16 v[20:23], v[248:251], a[100:103], v[20:23]
    s_waitcnt vmcnt(8)
    v_perm_b32 v248, v61, v60, v240
    v_perm_b32 v249, v63, v62, v240
    v_perm_b32 v250, v61, v60, v241
    v_perm_b32 v251, v63, v62, v241
    v_mfma_f32_16x16x32_bf16 v[8:11], v[244:247], v[96:99], v[8:11]
    v_mfma_f32_16x16x32_bf16 v[12:15], v[244:247], v[168:171], v[12:15]
    v_mfma_f32_16x16x32_bf16 v[16:19], v[244:247], a[32:35], v[16:19]
    v_mfma_f32_16x16x32_bf16 v[20:23], v[244:247], a[104:107], v[20:23]
    s_waitcnt vmcnt(7)
    v_perm_b32 v244, v209, v208, v240
    v_perm_b32 v245, v211, v210, v240
    v_perm_b32 v246, v209, v208, v241
    v_perm_b32 v247, v211, v210, v241
    v_mfma_f32_16x16x32_bf16 v[8:11], v[248:251], v[100:103], v[8:11]
    v_mfma_f32_16x16x32_bf16 v[12:15], v[248:251], v[172:175], v[12:15]
    v_mfma_f32_16x16x32_bf16 v[16:19], v[248:251], a[36:39], v[16:19]
    v_mfma_f32_16x16x32_bf16 v[20:23], v[248:251], a[108:111], v[20:23]
    s_waitcnt vmcnt(6)
    v_perm_b32 v248, v213, v212, v240
    v_perm_b32 v249, v215, v214, v240
    v_perm_b32 v250, v213, v212, v241
    v_perm_b32 v251, v215, v214, v241
    v_mfma_f32_16x16x32_bf16 v[8:11], v[244:247], v[104:107], v[8:11]
    v_mfma_f32_16x16x32_bf16 v[12:15], v[244:247], v[176:179], v[12:15]
    v_mfma_f32_16x16x32_bf16 v[16:19], v[244:247], a[40:43], v[16:19]
    v_mfma_f32_16x16x32_bf16 v[20:23], v[244:247], a[112:115], v[20:23]
    s_waitcnt vmcnt(5)
    v_perm_b32 v244, v217, v216, v240
    v_perm_b32 v245, v219, v218, v240
    v_perm_b32 v246, v217, v216, v241
    v_perm_b32 v247, v219, v218, v241
    v_mfma_f32_16x16x32_bf16 v[8:11], v[248:251], v[108:111], v[8:11]
    v_mfma_f32_16x16x32_bf16 v[12:15], v[248:251], v[180:183], v[12:15]
    v_mfma_f32_16x16x32_bf16 v[16:19], v[248:251], a[44:47], v[16:19]
    v_mfma_f32_16x16x32_bf16 v[20:23], v[248:251], a[116:119], v[20:23]
    s_waitcnt vmcnt(4)
    v_perm_b32 v248, v221, v220, v240
    v_perm_b32 v249, v223, v222, v240
    v_perm_b32 v250, v221, v220, v241
    v_perm_b32 v251, v223, v222, v241
    v_mfma_f32_16x16x32_bf16 v[8:11], v[244:247], v[112:115], v[8:11]
    v_mfma_f32_16x16x32_bf16 v[12:15], v[244:247], v[184:187], v[12:15]
    v_mfma_f32_16x16x32_bf16 v[16:19], v[244:247], a[48:51], v[16:19]
    v_mfma_f32_16x16x32_bf16 v[20:23], v[244:247], a[120:123], v[20:23]
    s_waitcnt vmcnt(3)
    v_perm_b32 v244, v225, v224, v240
    v_perm_b32 v245, v227, v226, v240
    v_perm_b32 v246, v225, v224, v241
    v_perm_b32 v247, v227, v226, v241
    v_mfma_f32_16x16x32_bf16 v[8:11], v[248:251], v[116:119], v[8:11]
    v_mfma_f32_16x16x32_bf16 v[12:15], v[248:251], v[188:191], v[12:15]
    v_mfma_f32_16x16x32_bf16 v[16:19], v[248:251], a[52:55], v[16:19]
    v_mfma_f32_16x16x32_bf16 v[20:23], v[248:251], a[124:127], v[20:23]
    s_waitcnt vmcnt(2)
    v_perm_b32 v248, v229, v228, v240
    v_perm_b32 v249, v231, v230, v240
    v_perm_b32 v250, v229, v228, v241
    v_perm_b32 v251, v231, v230, v241
    v_mfma_f32_16x16x32_bf16 v[8:11], v[244:247], v[120:123], v[8:11]
    v_mfma_f32_16x16x32_bf16 v[12:15], v[244:247], v[192:195], v[12:15]
    v_mfma_f32_16x16x32_bf16 v[16:19], v[244:247], a[56:59], v[16:19]
    v_mfma_f32_16x16x32_bf16 v[20:23], v[244:247], a[128:131], v[20:23]
    s_waitcnt vmcnt(1)
    v_mfma_f32_16x16x32_bf16 v[8:11], v[248:251], v[124:127], v[8:11]
    v_mfma_f32_16x16x32_bf16 v[12:15], v[248:251], v[196:199], v[12:15]
    v_mfma_f32_16x16x32_bf16 v[16:19], v[248:251], a[60:63], v[16:19]
    v_mfma_f32_16x16x32_bf16 v[20:23], v[248:251], a[132:135], v[20:23]
    s_waitcnt vmcnt(0)
    v_mfma_f32_16x16x32_bf16 v[8:11], v[232:235], v[128:131], v[8:11]
    v_mfma_f32_16x16x32_bf16 v[12:15], v[232:235], v[200:203], v[12:15]
    v_mfma_f32_16x16x32_bf16 v[16:19], v[232:235], a[64:67], v[16:19]
    v_mfma_f32_16x16x32_bf16 v[20:23], v[232:235], a[136:139], v[20:23]
    v_mfma_f32_16x16x32_bf16 v[8:11], v[236:239], v[132:135], v[8:11]
    v_mfma_f32_16x16x32_bf16 v[12:15], v[236:239], v[204:207], v[12:15]
    v_mfma_f32_16x16x32_bf16 v[16:19], v[236:239], a[68:71], v[16:19]
    v_mfma_f32_16x16x32_bf16 v[20:23], v[236:239], a[140:143], v[20:23]
    s_nop 4
    v_pk_mul_f32 v[8:9], v[8:9], 0.5 op_sel_hi:[1,0]
    v_pk_mul_f32 v[10:11], v[10:11], 0.5 op_sel_hi:[1,0]
    v_pk_mul_f32 v[12:13], v[12:13], 0.5 op_sel_hi:[1,0]
    v_pk_mul_f32 v[14:15], v[14:15], 0.5 op_sel_hi:[1,0]
    v_pk_mul_f32 v[16:17], v[16:17], 0.5 op_sel_hi:[1,0]
    v_pk_mul_f32 v[18:19], v[18:19], 0.5 op_sel_hi:[1,0]
    v_pk_mul_f32 v[20:21], v[20:21], 0.5 op_sel_hi:[1,0]
    v_pk_mul_f32 v[22:23], v[22:23], 0.5 op_sel_hi:[1,0]
mk_st:
    s_nop 1
    v_cvt_pk_bf16_f32 v24, v8, v9
    v_cvt_pk_bf16_f32 v25, v10, v11
    v_cvt_pk_bf16_f32 v26, v12, v13
    v_cvt_pk_bf16_f32 v27, v14, v15
    v_cvt_pk_bf16_f32 v28, v16, v17
    v_cvt_pk_bf16_f32 v29, v18, v19
    v_cvt_pk_bf16_f32 v30, v20, v21
    v_cvt_pk_bf16_f32 v31, v22, v23
    s_add_u32 s21, s26, 4096
    buffer_store_dwordx4 v[24:27], v1, s[4:7], s26 offen sc1
    buffer_store_dwordx4 v[28:31], v1, s[4:7], s21 offen sc1
    s_add_u32 s22, s19, s95
    s_waitcnt vmcnt(0)
    s_barrier
    v_mov_b32 v4, s22
    s_mov_b64 exec, s[34:35]
    buffer_store_dword v4, off, s[4:7], s29 sc1
    buffer_store_dword v4, off, s[4:7], s29 offset:128 sc1
    s_mov_b64 exec, -1
    s_add_u32 s19, s19, 2
    s_add_u32 s26, s26, 262144
    s_cmp_le_u32 s19, 58
    s_cbranch_scc1 mk_loop
    s_endpgm
L_ssm_next:
    s_mov_b32 s37, 8
    v_mov_b32 v250, 1
    v_mov_b32 v251, 163832
    v_cmp_eq_u32 vcc, 0, v0
    s_nop 0
    s_and_saveexec_b64 s[38:39], vcc
    s_cbranch_execz tk40
    buffer_atomic_add v250, off, s[84:87], s37 sc0
    s_waitcnt vmcnt(0)
    ds_write_b32 v251, v250
    s_waitcnt lgkmcnt(0)
tk40:
    s_mov_b64 exec, -1
    s_barrier
    ds_read_b32 v252, v251
    s_waitcnt lgkmcnt(0)
    v_readfirstlane_b32 s20, v252
    s_barrier
    s_nop 3
    s_cmp_ge_u32 s20, 144
    s_cbranch_scc1 L_wf_next
    s_lshl_b32 s20, s20, 2
    v_lshrrev_b32 v5, 6, v0
    s_nop 0
    v_readfirstlane_b32 s21, v5
    v_and_b32 v1, 63, v0
    v_and_b32 v2, 15, v1
    v_lshrrev_b32 v3, 4, v1
    v_lshlrev_b32 v4, 14, v5
    s_mov_b32 s8, s62
    s_mov_b32 s9, s63
    s_mov_b32 s10, 2359296
    s_mov_b32 s11, 0x20000
    s_mov_b32 s16, s76
    s_mov_b32 s17, s77
    s_mov_b32 s18, 4718592
    s_mov_b32 s19, 0x20000
    v_mul_u32_u24 v5, 9216, v0
    s_lshl_b32 s22, s20, 1
    s_add_u32 s23, s22, 0
    buffer_load_dwordx2 v[8:9], v5, s[8:11], s23 offen
    s_add_u32 s23, s22, 1152
    buffer_load_dwordx2 v[10:11], v5, s[8:11], s23 offen
    s_add_u32 s23, s22, 2304
    buffer_load_dwordx2 v[12:13], v5, s[8:11], s23 offen
    s_add_u32 s23, s22, 3456
    buffer_load_dwordx2 v[14:15], v5, s[8:11], s23 offen
    s_add_u32 s23, s22, 4608
    buffer_load_dwordx2 v[16:17], v5, s[8:11], s23 offen
    s_add_u32 s23, s22, 5760
    buffer_load_dwordx2 v[18:19], v5, s[8:11], s23 offen
    s_add_u32 s23, s22, 6912
    buffer_load_dwordx2 v[20:21], v5, s[8:11], s23 offen
    s_add_u32 s23, s22, 8064
    buffer_load_dwordx2 v[22:23], v5, s[8:11], s23 offen
    s_add_u32 s22, s20, s21
    s_lshl_b32 s23, s22, 8
    v_lshlrev_b32 v6, 3, v2
    v_lshl_add_u32 v6, v3, 1, v6
    s_mov_b32 s12, s64
    s_mov_b32 s13, s65
    s_mov_b32 s14, 147456
    s_mov_b32 s15, 0x20000
    buffer_load_ushort v24, v6, s[12:15], s23 offen offset:0
    buffer_load_ushort v28, v6, s[12:15], s23 offen offset:128
    s_mov_b32 s12, s66
    s_mov_b32 s13, s67
    s_mov_b32 s14, 147456
    s_mov_b32 s15, 0x20000
    buffer_load_ushort v25, v6, s[12:15], s23 offen offset:0
    buffer_load_ushort v29, v6, s[12:15], s23 offen offset:128
    s_mov_b32 s12, s68
    s_mov_b32 s13, s69
    s_mov_b32 s14, 147456
    s_mov_b32 s15, 0x20000
    buffer_load_ushort v26, v6, s[12:15], s23 offen offset:0
    buffer_load_ushort v30, v6, s[12:15], s23 offen offset:128
    s_mov_b32 s12, s70
    s_mov_b32 s13, s71
    s_mov_b32 s14, 147456
    s_mov_b32 s15, 0x20000
    buffer_load_ushort v27, v6, s[12:15], s23 offen offset:0
    buffer_load_ushort v31, v6, s[12:15], s23 offen offset:128
    s_mov_b32 s12, s72
    s_mov_b32 s13, s73
    s_mov_b32 s14, 1152
    s_mov_b32 s15, 0x20000
    s_lshl_b32 s23, s22, 1
    buffer_load_ushort v32, off, s[12:15], s23
    s_mov_b32 s26, 0x3fb8aa3b
    s_mov_b32 s27, 0x3e22f983
    v_mov_b32 v34, 0
    v_mov_b32 v35, 0
    v_lshl_add_u32 v6, v1, 3, v4
    ds_write_b64 v6, v[34:35] offset:0
    s_waitcnt vmcnt(0)
    v_mov_b32 v36, 0x05040100
    v_mov_b32 v37, 0x07060302
    v_lshlrev_b32 v6, 4, v0
    v_perm_b32 v40, v10, v8, v36
    v_perm_b32 v41, v14, v12, v36
    v_perm_b32 v42, v18, v16, v36
    v_perm_b32 v43, v22, v20, v36
    ds_write_b128 v6, v[40:43] offset:512
    s_nop 1
    v_perm_b32 v40, v10, v8, v37
    v_perm_b32 v41, v14, v12, v37
    v_perm_b32 v42, v18, v16, v37
    v_perm_b32 v43, v22, v20, v37
    ds_write_b128 v6, v[40:43] offset:16896
    s_nop 1
    v_perm_b32 v40, v11, v9, v36
    v_perm_b32 v41, v15, v13, v36
    v_perm_b32 v42, v19, v17, v36
    v_perm_b32 v43, v23, v21, v36
    ds_write_b128 v6, v[40:43] offset:33280
    s_nop 1
    v_perm_b32 v40, v11, v9, v37
    v_perm_b32 v41, v15, v13, v37
    v_perm_b32 v42, v19, v17, v37
    v_perm_b32 v43, v23, v21, v37
    ds_write_b128 v6, v[40:43] offset:49664
    s_nop 1
    v_lshlrev_b32 v32, 16, v32
    v_mul_f32 v32, s26, v32
    v_exp_f32 v32, v32
    s_nop 0
    v_cvt_pk_bf16_f32 v32, v32, v32
    v_and_b32 v32, 0xffff0000, v32
    v_add_f32 v33, v32, v32
    v_lshlrev_b32 v24, 16, v24
    v_mul_f32 v24, s26, v24
    v_exp_f32 v24, v24
    s_nop 0
    v_cvt_pk_bf16_f32 v24, v24, v24
    v_and_b32 v24, 0xffff0000, v24
    v_mul_f32 v24, v24, v32
    v_mul_f32 v24, s26, v24
    v_sub_f32 v24, 0, v24
    v_lshlrev_b32 v25, 16, v25
    v_mul_f32 v25, v25, v32
    v_mul_f32 v25, s27, v25
    v_lshlrev_b32 v26, 16, v26
    v_mul_f32 v26, v26, v33
    v_lshlrev_b32 v27, 16, v27
    v_mul_f32 v27, v27, v33
    v_lshlrev_b32 v28, 16, v28
    v_mul_f32 v28, s26, v28
    v_exp_f32 v28, v28
    s_nop 0
    v_cvt_pk_bf16_f32 v28, v28, v28
    v_and_b32 v28, 0xffff0000, v28
    v_mul_f32 v28, v28, v32
    v_mul_f32 v28, s26, v28
    v_sub_f32 v28, 0, v28
    v_lshlrev_b32 v29, 16, v29
    v_mul_f32 v29, v29, v32
    v_mul_f32 v29, s27, v29
    v_lshlrev_b32 v30, 16, v30
    v_mul_f32 v30, v30, v33
    v_lshlrev_b32 v31, 16, v31
    v_mul_f32 v31, v31, v33
    v_cvt_f32_u32 v47, v2
    v_mul_f32 v44, 0x41800000, v47
    v_and_b32 v5, 7, v2
    v_add_u32 v5, 8, v5
    v_cvt_f32_u32 v5, v5
    v_mul_f32 v45, 0x42000000, v5
    v_mul_f32 v6, 0x42800000, v5
    v_cmp_lt_u32 vcc, 7, v2
    s_nop 1
    v_cndmask_b32 v45, v45, v6, vcc
    v_add_f32 v5, 0x41000000, v47
    v_mul_f32 v46, 0x43000000, v5
    v_mov_b32 v48, 0
    v_mov_b32 v49, 0
    v_mov_b32 v50, 0
    v_mov_b32 v51, 0
    v_mov_b32 v52, 0
    v_mov_b32 v53, 0
    v_mov_b32 v54, 0
    v_mov_b32 v55, 0
    v_mov_b32 v56, 0
    v_mov_b32 v57, 0
    v_mov_b32 v58, 0
    v_mov_b32 v59, 0
    v_mov_b32 v60, 0
    v_mov_b32 v61, 0
    v_mov_b32 v62, 0
    v_mov_b32 v63, 0
    v_mov_b32_dpp v64, v24 row_newbcast:0 row_mask:0xf bank_mask:0xf
    v_mov_b32_dpp v65, v25 row_newbcast:0 row_mask:0xf bank_mask:0xf
    v_mov_b32_dpp v66, v26 row_newbcast:0 row_mask:0xf bank_mask:0xf
    v_mov_b32_dpp v67, v27 row_newbcast:0 row_mask:0xf bank_mask:0xf
    v_mul_f32 v82, v64, v47
    v_mul_f32 v83, v65, v47
    v_exp_f32 v82, v82
    v_fract_f32 v83, v83
    v_cos_f32 v74, v83
    v_sin_f32 v75, v83
    v_mul_f32 v74, v74, v82
    v_mul_f32 v75, v75, v82
    v_mul_f32 v84, v75, v75
    v_add_f32 v85, v74, v74
    v_fma_f32 v76, v74, v74, -v84
    v_mul_f32 v77, v85, v75
    v_mul_f32 v84, v77, v77
    v_add_f32 v85, v76, v76
    v_fma_f32 v78, v76, v76, -v84
    v_mul_f32 v79, v85, v77
    v_mul_f32 v84, v79, v79
    v_add_f32 v85, v78, v78
    v_fma_f32 v80, v78, v78, -v84
    v_mul_f32 v81, v85, v79
    v_mul_f32 v82, v64, v44
    v_mul_f32 v83, v65, v44
    v_exp_f32 v82, v82
    v_fract_f32 v83, v83
    v_cos_f32 v68, v83
    v_sin_f32 v69, v83
    v_mul_f32 v68, v68, v82
    v_mul_f32 v69, v69, v82
    v_mul_f32 v84, v67, v69
    v_mul_f32 v85, v67, v68
    v_fma_f32 v68, v66, v68, -v84
    v_fma_f32 v69, -v66, v69, -v85
    v_mul_f32 v82, v64, v45
    v_mul_f32 v83, v65, v45
    v_exp_f32 v82, v82
    v_fract_f32 v83, v83
    v_cos_f32 v70, v83
    v_sin_f32 v71, v83
    v_mul_f32 v70, v70, v82
    v_mul_f32 v71, v71, v82
    v_mul_f32 v84, v67, v71
    v_mul_f32 v85, v67, v70
    v_fma_f32 v70, v66, v70, -v84
    v_fma_f32 v71, -v66, v71, -v85
    v_mul_f32 v82, v64, v46
    v_mul_f32 v83, v65, v46
    v_exp_f32 v82, v82
    v_fract_f32 v83, v83
    v_cos_f32 v72, v83
    v_sin_f32 v73, v83
    v_mul_f32 v72, v72, v82
    v_mul_f32 v73, v73, v82
    v_mul_f32 v84, v67, v73
    v_mul_f32 v85, v67, v72
    v_fma_f32 v72, v66, v72, -v84
    v_fma_f32 v73, -v66, v73, -v85
    v_mfma_f32_16x16x4_f32 v[48:51], v68, v74, v[48:51]
    v_mfma_f32_16x16x4_f32 v[52:55], v70, v76, v[52:55]
    v_mfma_f32_16x16x4_f32 v[56:59], v70, v78, v[56:59]
    v_mfma_f32_16x16x4_f32 v[60:63], v72, v80, v[60:63]
    v_mfma_f32_16x16x4_f32 v[48:51], v69, v75, v[48:51]
    v_mfma_f32_16x16x4_f32 v[52:55], v71, v77, v[52:55]
    v_mfma_f32_16x16x4_f32 v[56:59], v71, v79, v[56:59]
    v_mfma_f32_16x16x4_f32 v[60:63], v73, v81, v[60:63]
    v_mov_b32_dpp v64, v24 row_newbcast:1 row_mask:0xf bank_mask:0xf
    v_mov_b32_dpp v65, v25 row_newbcast:1 row_mask:0xf bank_mask:0xf
    v_mov_b32_dpp v66, v26 row_newbcast:1 row_mask:0xf bank_mask:0xf
    v_mov_b32_dpp v67, v27 row_newbcast:1 row_mask:0xf bank_mask:0xf
    v_mul_f32 v82, v64, v47
    v_mul_f32 v83, v65, v47
    v_exp_f32 v82, v82
    v_fract_f32 v83, v83
    v_cos_f32 v74, v83
    v_sin_f32 v75, v83
    v_mul_f32 v74, v74, v82
    v_mul_f32 v75, v75, v82
    v_mul_f32 v84, v75, v75
    v_add_f32 v85, v74, v74
    v_fma_f32 v76, v74, v74, -v84
    v_mul_f32 v77, v85, v75
    v_mul_f32 v84, v77, v77
    v_add_f32 v85, v76, v76
    v_fma_f32 v78, v76, v76, -v84
    v_mul_f32 v79, v85, v77
    v_mul_f32 v84, v79, v79
    v_add_f32 v85, v78, v78
    v_fma_f32 v80, v78, v78, -v84
    v_mul_f32 v81, v85, v79
    v_mul_f32 v82, v64, v44
    v_mul_f32 v83, v65, v44
    v_exp_f32 v82, v82
    v_fract_f32 v83, v83
    v_cos_f32 v68, v83
    v_sin_f32 v69, v83
    v_mul_f32 v68, v68, v82
    v_mul_f32 v69, v69, v82
    v_mul_f32 v84, v67, v69
    v_mul_f32 v85, v67, v68
    v_fma_f32 v68, v66, v68, -v84
    v_fma_f32 v69, -v66, v69, -v85
    v_mul_f32 v82, v64, v45
    v_mul_f32 v83, v65, v45
    v_exp_f32 v82, v82
    v_fract_f32 v83, v83
    v_cos_f32 v70, v83
    v_sin_f32 v71, v83
    v_mul_f32 v70, v70, v82
    v_mul_f32 v71, v71, v82
    v_mul_f32 v84, v67, v71
    v_mul_f32 v85, v67, v70
    v_fma_f32 v70, v66, v70, -v84
    v_fma_f32 v71, -v66, v71, -v85
    v_mul_f32 v82, v64, v46
    v_mul_f32 v83, v65, v46
    v_exp_f32 v82, v82
    v_fract_f32 v83, v83
    v_cos_f32 v72, v83
    v_sin_f32 v73, v83
    v_mul_f32 v72, v72, v82
    v_mul_f32 v73, v73, v82
    v_mul_f32 v84, v67, v73
    v_mul_f32 v85, v67, v72
    v_fma_f32 v72, v66, v72, -v84
    v_fma_f32 v73, -v66, v73, -v85
    v_mfma_f32_16x16x4_f32 v[48:51], v68, v74, v[48:51]
    v_mfma_f32_16x16x4_f32 v[52:55], v70, v76, v[52:55]
    v_mfma_f32_16x16x4_f32 v[56:59], v70, v78, v[56:59]
    v_mfma_f32_16x16x4_f32 v[60:63], v72, v80, v[60:63]
    v_mfma_f32_16x16x4_f32 v[48:51], v69, v75, v[48:51]
    v_mfma_f32_16x16x4_f32 v[52:55], v71, v77, v[52:55]
    v_mfma_f32_16x16x4_f32 v[56:59], v71, v79, v[56:59]
    v_mfma_f32_16x16x4_f32 v[60:63], v73, v81, v[60:63]
    v_mov_b32_dpp v64, v24 row_newbcast:2 row_mask:0xf bank_mask:0xf
    v_mov_b32_dpp v65, v25 row_newbcast:2 row_mask:0xf bank_mask:0xf
    v_mov_b32_dpp v66, v26 row_newbcast:2 row_mask:0xf bank_mask:0xf
    v_mov_b32_dpp v67, v27 row_newbcast:2 row_mask:0xf bank_mask:0xf
    v_mul_f32 v82, v64, v47
    v_mul_f32 v83, v65, v47
    v_exp_f32 v82, v82
    v_fract_f32 v83, v83
    v_cos_f32 v74, v83
    v_sin_f32 v75, v83
    v_mul_f32 v74, v74, v82
    v_mul_f32 v75, v75, v82
    v_mul_f32 v84, v75, v75
    v_add_f32 v85, v74, v74
    v_fma_f32 v76, v74, v74, -v84
    v_mul_f32 v77, v85, v75
    v_mul_f32 v84, v77, v77
    v_add_f32 v85, v76, v76
    v_fma_f32 v78, v76, v76, -v84
    v_mul_f32 v79, v85, v77
    v_mul_f32 v84, v79, v79
    v_add_f32 v85, v78, v78
    v_fma_f32 v80, v78, v78, -v84
    v_mul_f32 v81, v85, v79
    v_mul_f32 v82, v64, v44
    v_mul_f32 v83, v65, v44
    v_exp_f32 v82, v82
    v_fract_f32 v83, v83
    v_cos_f32 v68, v83
    v_sin_f32 v69, v83
    v_mul_f32 v68, v68, v82
    v_mul_f32 v69, v69, v82
    v_mul_f32 v84, v67, v69
    v_mul_f32 v85, v67, v68
    v_fma_f32 v68, v66, v68, -v84
    v_fma_f32 v69, -v66, v69, -v85
    v_mul_f32 v82, v64, v45
    v_mul_f32 v83, v65, v45
    v_exp_f32 v82, v82
    v_fract_f32 v83, v83
    v_cos_f32 v70, v83
    v_sin_f32 v71, v83
    v_mul_f32 v70, v70, v82
    v_mul_f32 v71, v71, v82
    v_mul_f32 v84, v67, v71
    v_mul_f32 v85, v67, v70
    v_fma_f32 v70, v66, v70, -v84
    v_fma_f32 v71, -v66, v71, -v85
    v_mul_f32 v82, v64, v46
    v_mul_f32 v83, v65, v46
    v_exp_f32 v82, v82
    v_fract_f32 v83, v83
    v_cos_f32 v72, v83
    v_sin_f32 v73, v83
    v_mul_f32 v72, v72, v82
    v_mul_f32 v73, v73, v82
    v_mul_f32 v84, v67, v73
    v_mul_f32 v85, v67, v72
    v_fma_f32 v72, v66, v72, -v84
    v_fma_f32 v73, -v66, v73, -v85
    v_mfma_f32_16x16x4_f32 v[48:51], v68, v74, v[48:51]
    v_mfma_f32_16x16x4_f32 v[52:55], v70, v76, v[52:55]
    v_mfma_f32_16x16x4_f32 v[56:59], v70, v78, v[56:59]
    v_mfma_f32_16x16x4_f32 v[60:63], v72, v80, v[60:63]
    v_mfma_f32_16x16x4_f32 v[48:51], v69, v75, v[48:51]
    v_mfma_f32_16x16x4_f32 v[52:55], v71, v77, v[52:55]
    v_mfma_f32_16x16x4_f32 v[56:59], v71, v79, v[56:59]
    v_mfma_f32_16x16x4_f32 v[60:63], v73, v81, v[60:63]
    v_mov_b32_dpp v64, v24 row_newbcast:3 row_mask:0xf bank_mask:0xf
    v_mov_b32_dpp v65, v25 row_newbcast:3 row_mask:0xf bank_mask:0xf
    v_mov_b32_dpp v66, v26 row_newbcast:3 row_mask:0xf bank_mask:0xf
    v_mov_b32_dpp v67, v27 row_newbcast:3 row_mask:0xf bank_mask:0xf
    v_mul_f32 v82, v64, v47
    v_mul_f32 v83, v65, v47
    v_exp_f32 v82, v82
    v_fract_f32 v83, v83
    v_cos_f32 v74, v83
    v_sin_f32 v75, v83
    v_mul_f32 v74, v74, v82
    v_mul_f32 v75, v75, v82
    v_mul_f32 v84, v75, v75
    v_add_f32 v85, v74, v74
    v_fma_f32 v76, v74, v74, -v84
    v_mul_f32 v77, v85, v75
    v_mul_f32 v84, v77, v77
    v_add_f32 v85, v76, v76
    v_fma_f32 v78, v76, v76, -v84
    v_mul_f32 v79, v85, v77
    v_mul_f32 v84, v79, v79
    v_add_f32 v85, v78, v78
    v_fma_f32 v80, v78, v78, -v84
    v_mul_f32 v81, v85, v79
    v_mul_f32 v82, v64, v44
    v_mul_f32 v83, v65, v44
    v_exp_f32 v82, v82
    v_fract_f32 v83, v83
    v_cos_f32 v68, v83
    v_sin_f32 v69, v83
    v_mul_f32 v68, v68, v82
    v_mul_f32 v69, v69, v82
    v_mul_f32 v84, v67, v69
    v_mul_f32 v85, v67, v68
    v_fma_f32 v68, v66, v68, -v84
    v_fma_f32 v69, -v66, v69, -v85
    v_mul_f32 v82, v64, v45
    v_mul_f32 v83, v65, v45
    v_exp_f32 v82, v82
    v_fract_f32 v83, v83
    v_cos_f32 v70, v83
    v_sin_f32 v71, v83
    v_mul_f32 v70, v70, v82
    v_mul_f32 v71, v71, v82
    v_mul_f32 v84, v67, v71
    v_mul_f32 v85, v67, v70
    v_fma_f32 v70, v66, v70, -v84
    v_fma_f32 v71, -v66, v71, -v85
    v_mul_f32 v82, v64, v46
    v_mul_f32 v83, v65, v46
    v_exp_f32 v82, v82
    v_fract_f32 v83, v83
    v_cos_f32 v72, v83
    v_sin_f32 v73, v83
    v_mul_f32 v72, v72, v82
    v_mul_f32 v73, v73, v82
    v_mul_f32 v84, v67, v73
    v_mul_f32 v85, v67, v72
    v_fma_f32 v72, v66, v72, -v84
    v_fma_f32 v73, -v66, v73, -v85
    v_mfma_f32_16x16x4_f32 v[48:51], v68, v74, v[48:51]
    v_mfma_f32_16x16x4_f32 v[52:55], v70, v76, v[52:55]
    v_mfma_f32_16x16x4_f32 v[56:59], v70, v78, v[56:59]
    v_mfma_f32_16x16x4_f32 v[60:63], v72, v80, v[60:63]
    v_mfma_f32_16x16x4_f32 v[48:51], v69, v75, v[48:51]
    v_mfma_f32_16x16x4_f32 v[52:55], v71, v77, v[52:55]
    v_mfma_f32_16x16x4_f32 v[56:59], v71, v79, v[56:59]
    v_mfma_f32_16x16x4_f32 v[60:63], v73, v81, v[60:63]
    v_mov_b32_dpp v64, v24 row_newbcast:4 row_mask:0xf bank_mask:0xf
    v_mov_b32_dpp v65, v25 row_newbcast:4 row_mask:0xf bank_mask:0xf
    v_mov_b32_dpp v66, v26 row_newbcast:4 row_mask:0xf bank_mask:0xf
    v_mov_b32_dpp v67, v27 row_newbcast:4 row_mask:0xf bank_mask:0xf
    v_mul_f32 v82, v64, v47
    v_mul_f32 v83, v65, v47
    v_exp_f32 v82, v82
    v_fract_f32 v83, v83
    v_cos_f32 v74, v83
    v_sin_f32 v75, v83
    v_mul_f32 v74, v74, v82
    v_mul_f32 v75, v75, v82
    v_mul_f32 v84, v75, v75
    v_add_f32 v85, v74, v74
    v_fma_f32 v76, v74, v74, -v84
    v_mul_f32 v77, v85, v75
    v_mul_f32 v84, v77, v77
    v_add_f32 v85, v76, v76
    v_fma_f32 v78, v76, v76, -v84
    v_mul_f32 v79, v85, v77
    v_mul_f32 v84, v79, v79
    v_add_f32 v85, v78, v78
    v_fma_f32 v80, v78, v78, -v84
    v_mul_f32 v81, v85, v79
    v_mul_f32 v82, v64, v44
    v_mul_f32 v83, v65, v44
    v_exp_f32 v82, v82
    v_fract_f32 v83, v83
    v_cos_f32 v68, v83
    v_sin_f32 v69, v83
    v_mul_f32 v68, v68, v82
    v_mul_f32 v69, v69, v82
    v_mul_f32 v84, v67, v69
    v_mul_f32 v85, v67, v68
    v_fma_f32 v68, v66, v68, -v84
    v_fma_f32 v69, -v66, v69, -v85
    v_mul_f32 v82, v64, v45
    v_mul_f32 v83, v65, v45
    v_exp_f32 v82, v82
    v_fract_f32 v83, v83
    v_cos_f32 v70, v83
    v_sin_f32 v71, v83
    v_mul_f32 v70, v70, v82
    v_mul_f32 v71, v71, v82
    v_mul_f32 v84, v67, v71
    v_mul_f32 v85, v67, v70
    v_fma_f32 v70, v66, v70, -v84
    v_fma_f32 v71, -v66, v71, -v85
    v_mul_f32 v82, v64, v46
    v_mul_f32 v83, v65, v46
    v_exp_f32 v82, v82
    v_fract_f32 v83, v83
    v_cos_f32 v72, v83
    v_sin_f32 v73, v83
    v_mul_f32 v72, v72, v82
    v_mul_f32 v73, v73, v82
    v_mul_f32 v84, v67, v73
    v_mul_f32 v85, v67, v72
    v_fma_f32 v72, v66, v72, -v84
    v_fma_f32 v73, -v66, v73, -v85
    v_mfma_f32_16x16x4_f32 v[48:51], v68, v74, v[48:51]
    v_mfma_f32_16x16x4_f32 v[52:55], v70, v76, v[52:55]
    v_mfma_f32_16x16x4_f32 v[56:59], v70, v78, v[56:59]
    v_mfma_f32_16x16x4_f32 v[60:63], v72, v80, v[60:63]
    v_mfma_f32_16x16x4_f32 v[48:51], v69, v75, v[48:51]
    v_mfma_f32_16x16x4_f32 v[52:55], v71, v77, v[52:55]
    v_mfma_f32_16x16x4_f32 v[56:59], v71, v79, v[56:59]
    v_mfma_f32_16x16x4_f32 v[60:63], v73, v81, v[60:63]
    v_mov_b32_dpp v64, v24 row_newbcast:5 row_mask:0xf bank_mask:0xf
    v_mov_b32_dpp v65, v25 row_newbcast:5 row_mask:0xf bank_mask:0xf
    v_mov_b32_dpp v66, v26 row_newbcast:5 row_mask:0xf bank_mask:0xf
    v_mov_b32_dpp v67, v27 row_newbcast:5 row_mask:0xf bank_mask:0xf
    v_mul_f32 v82, v64, v47
    v_mul_f32 v83, v65, v47
    v_exp_f32 v82, v82
    v_fract_f32 v83, v83
    v_cos_f32 v74, v83
    v_sin_f32 v75, v83
    v_mul_f32 v74, v74, v82
    v_mul_f32 v75, v75, v82
    v_mul_f32 v84, v75, v75
    v_add_f32 v85, v74, v74
    v_fma_f32 v76, v74, v74, -v84
    v_mul_f32 v77, v85, v75
    v_mul_f32 v84, v77, v77
    v_add_f32 v85, v76, v76
    v_fma_f32 v78, v76, v76, -v84
    v_mul_f32 v79, v85, v77
    v_mul_f32 v84, v79, v79
    v_add_f32 v85, v78, v78
    v_fma_f32 v80, v78, v78, -v84
    v_mul_f32 v81, v85, v79
    v_mul_f32 v82, v64, v44
    v_mul_f32 v83, v65, v44
    v_exp_f32 v82, v82
    v_fract_f32 v83, v83
    v_cos_f32 v68, v83
    v_sin_f32 v69, v83
    v_mul_f32 v68, v68, v82
    v_mul_f32 v69, v69, v82
    v_mul_f32 v84, v67, v69
    v_mul_f32 v85, v67, v68
    v_fma_f32 v68, v66, v68, -v84
    v_fma_f32 v69, -v66, v69, -v85
    v_mul_f32 v82, v64, v45
    v_mul_f32 v83, v65, v45
    v_exp_f32 v82, v82
    v_fract_f32 v83, v83
    v_cos_f32 v70, v83
    v_sin_f32 v71, v83
    v_mul_f32 v70, v70, v82
    v_mul_f32 v71, v71, v82
    v_mul_f32 v84, v67, v71
    v_mul_f32 v85, v67, v70
    v_fma_f32 v70, v66, v70, -v84
    v_fma_f32 v71, -v66, v71, -v85
    v_mul_f32 v82, v64, v46
    v_mul_f32 v83, v65, v46
    v_exp_f32 v82, v82
    v_fract_f32 v83, v83
    v_cos_f32 v72, v83
    v_sin_f32 v73, v83
    v_mul_f32 v72, v72, v82
    v_mul_f32 v73, v73, v82
    v_mul_f32 v84, v67, v73
    v_mul_f32 v85, v67, v72
    v_fma_f32 v72, v66, v72, -v84
    v_fma_f32 v73, -v66, v73, -v85
    v_mfma_f32_16x16x4_f32 v[48:51], v68, v74, v[48:51]
    v_mfma_f32_16x16x4_f32 v[52:55], v70, v76, v[52:55]
    v_mfma_f32_16x16x4_f32 v[56:59], v70, v78, v[56:59]
    v_mfma_f32_16x16x4_f32 v[60:63], v72, v80, v[60:63]
    v_mfma_f32_16x16x4_f32 v[48:51], v69, v75, v[48:51]
    v_mfma_f32_16x16x4_f32 v[52:55], v71, v77, v[52:55]
    v_mfma_f32_16x16x4_f32 v[56:59], v71, v79, v[56:59]
    v_mfma_f32_16x16x4_f32 v[60:63], v73, v81, v[60:63]
    v_mov_b32_dpp v64, v24 row_newbcast:6 row_mask:0xf bank_mask:0xf
    v_mov_b32_dpp v65, v25 row_newbcast:6 row_mask:0xf bank_mask:0xf
    v_mov_b32_dpp v66, v26 row_newbcast:6 row_mask:0xf bank_mask:0xf
    v_mov_b32_dpp v67, v27 row_newbcast:6 row_mask:0xf bank_mask:0xf
    v_mul_f32 v82, v64, v47
    v_mul_f32 v83, v65, v47
    v_exp_f32 v82, v82
    v_fract_f32 v83, v83
    v_cos_f32 v74, v83
    v_sin_f32 v75, v83
    v_mul_f32 v74, v74, v82
    v_mul_f32 v75, v75, v82
    v_mul_f32 v84, v75, v75
    v_add_f32 v85, v74, v74
    v_fma_f32 v76, v74, v74, -v84
    v_mul_f32 v77, v85, v75
    v_mul_f32 v84, v77, v77
    v_add_f32 v85, v76, v76
    v_fma_f32 v78, v76, v76, -v84
    v_mul_f32 v79, v85, v77
    v_mul_f32 v84, v79, v79
    v_add_f32 v85, v78, v78
    v_fma_f32 v80, v78, v78, -v84
    v_mul_f32 v81, v85, v79
    v_mul_f32 v82, v64, v44
    v_mul_f32 v83, v65, v44
    v_exp_f32 v82, v82
    v_fract_f32 v83, v83
    v_cos_f32 v68, v83
    v_sin_f32 v69, v83
    v_mul_f32 v68, v68, v82
    v_mul_f32 v69, v69, v82
    v_mul_f32 v84, v67, v69
    v_mul_f32 v85, v67, v68
    v_fma_f32 v68, v66, v68, -v84
    v_fma_f32 v69, -v66, v69, -v85
    v_mul_f32 v82, v64, v45
    v_mul_f32 v83, v65, v45
    v_exp_f32 v82, v82
    v_fract_f32 v83, v83
    v_cos_f32 v70, v83
    v_sin_f32 v71, v83
    v_mul_f32 v70, v70, v82
    v_mul_f32 v71, v71, v82
    v_mul_f32 v84, v67, v71
    v_mul_f32 v85, v67, v70
    v_fma_f32 v70, v66, v70, -v84
    v_fma_f32 v71, -v66, v71, -v85
    v_mul_f32 v82, v64, v46
    v_mul_f32 v83, v65, v46
    v_exp_f32 v82, v82
    v_fract_f32 v83, v83
    v_cos_f32 v72, v83
    v_sin_f32 v73, v83
    v_mul_f32 v72, v72, v82
    v_mul_f32 v73, v73, v82
    v_mul_f32 v84, v67, v73
    v_mul_f32 v85, v67, v72
    v_fma_f32 v72, v66, v72, -v84
    v_fma_f32 v73, -v66, v73, -v85
    v_mfma_f32_16x16x4_f32 v[48:51], v68, v74, v[48:51]
    v_mfma_f32_16x16x4_f32 v[52:55], v70, v76, v[52:55]
    v_mfma_f32_16x16x4_f32 v[56:59], v70, v78, v[56:59]
    v_mfma_f32_16x16x4_f32 v[60:63], v72, v80, v[60:63]
    v_mfma_f32_16x16x4_f32 v[48:51], v69, v75, v[48:51]
    v_mfma_f32_16x16x4_f32 v[52:55], v71, v77, v[52:55]
    v_mfma_f32_16x16x4_f32 v[56:59], v71, v79, v[56:59]
    v_mfma_f32_16x16x4_f32 v[60:63], v73, v81, v[60:63]
    v_mov_b32_dpp v64, v24 row_newbcast:7 row_mask:0xf bank_mask:0xf
    v_mov_b32_dpp v65, v25 row_newbcast:7 row_mask:0xf bank_mask:0xf
    v_mov_b32_dpp v66, v26 row_newbcast:7 row_mask:0xf bank_mask:0xf
    v_mov_b32_dpp v67, v27 row_newbcast:7 row_mask:0xf bank_mask:0xf
    v_mul_f32 v82, v64, v47
    v_mul_f32 v83, v65, v47
    v_exp_f32 v82, v82
    v_fract_f32 v83, v83
    v_cos_f32 v74, v83
    v_sin_f32 v75, v83
    v_mul_f32 v74, v74, v82
    v_mul_f32 v75, v75, v82
    v_mul_f32 v84, v75, v75
    v_add_f32 v85, v74, v74
    v_fma_f32 v76, v74, v74, -v84
    v_mul_f32 v77, v85, v75
    v_mul_f32 v84, v77, v77
    v_add_f32 v85, v76, v76
    v_fma_f32 v78, v76, v76, -v84
    v_mul_f32 v79, v85, v77
    v_mul_f32 v84, v79, v79
    v_add_f32 v85, v78, v78
    v_fma_f32 v80, v78, v78, -v84
    v_mul_f32 v81, v85, v79
    v_mul_f32 v82, v64, v44
    v_mul_f32 v83, v65, v44
    v_exp_f32 v82, v82
    v_fract_f32 v83, v83
    v_cos_f32 v68, v83
    v_sin_f32 v69, v83
    v_mul_f32 v68, v68, v82
    v_mul_f32 v69, v69, v82
    v_mul_f32 v84, v67, v69
    v_mul_f32 v85, v67, v68
    v_fma_f32 v68, v66, v68, -v84
    v_fma_f32 v69, -v66, v69, -v85
    v_mul_f32 v82, v64, v45
    v_mul_f32 v83, v65, v45
    v_exp_f32 v82, v82
    v_fract_f32 v83, v83
    v_cos_f32 v70, v83
    v_sin_f32 v71, v83
    v_mul_f32 v70, v70, v82
    v_mul_f32 v71, v71, v82
    v_mul_f32 v84, v67, v71
    v_mul_f32 v85, v67, v70
    v_fma_f32 v70, v66, v70, -v84
    v_fma_f32 v71, -v66, v71, -v85
    v_mul_f32 v82, v64, v46
    v_mul_f32 v83, v65, v46
    v_exp_f32 v82, v82
    v_fract_f32 v83, v83
    v_cos_f32 v72, v83
    v_sin_f32 v73, v83
    v_mul_f32 v72, v72, v82
    v_mul_f32 v73, v73, v82
    v_mul_f32 v84, v67, v73
    v_mul_f32 v85, v67, v72
    v_fma_f32 v72, v66, v72, -v84
    v_fma_f32 v73, -v66, v73, -v85
    v_mfma_f32_16x16x4_f32 v[48:51], v68, v74, v[48:51]
    v_mfma_f32_16x16x4_f32 v[52:55], v70, v76, v[52:55]
    v_mfma_f32_16x16x4_f32 v[56:59], v70, v78, v[56:59]
    v_mfma_f32_16x16x4_f32 v[60:63], v72, v80, v[60:63]
    v_mfma_f32_16x16x4_f32 v[48:51], v69, v75, v[48:51]
    v_mfma_f32_16x16x4_f32 v[52:55], v71, v77, v[52:55]
    v_mfma_f32_16x16x4_f32 v[56:59], v71, v79, v[56:59]
    v_mfma_f32_16x16x4_f32 v[60:63], v73, v81, v[60:63]
    v_mov_b32_dpp v64, v24 row_newbcast:8 row_mask:0xf bank_mask:0xf
    v_mov_b32_dpp v65, v25 row_newbcast:8 row_mask:0xf bank_mask:0xf
    v_mov_b32_dpp v66, v26 row_newbcast:8 row_mask:0xf bank_mask:0xf
    v_mov_b32_dpp v67, v27 row_newbcast:8 row_mask:0xf bank_mask:0xf
    v_mul_f32 v82, v64, v47
    v_mul_f32 v83, v65, v47
    v_exp_f32 v82, v82
    v_fract_f32 v83, v83
    v_cos_f32 v74, v83
    v_sin_f32 v75, v83
    v_mul_f32 v74, v74, v82
    v_mul_f32 v75, v75, v82
    v_mul_f32 v84, v75, v75
    v_add_f32 v85, v74, v74
    v_fma_f32 v76, v74, v74, -v84
    v_mul_f32 v77, v85, v75
    v_mul_f32 v84, v77, v77
    v_add_f32 v85, v76, v76
    v_fma_f32 v78, v76, v76, -v84
    v_mul_f32 v79, v85, v77
    v_mul_f32 v84, v79, v79
    v_add_f32 v85, v78, v78
    v_fma_f32 v80, v78, v78, -v84
    v_mul_f32 v81, v85, v79
    v_mul_f32 v82, v64, v44
    v_mul_f32 v83, v65, v44
    v_exp_f32 v82, v82
    v_fract_f32 v83, v83
    v_cos_f32 v68, v83
    v_sin_f32 v69, v83
    v_mul_f32 v68, v68, v82
    v_mul_f32 v69, v69, v82
    v_mul_f32 v84, v67, v69
    v_mul_f32 v85, v67, v68
    v_fma_f32 v68, v66, v68, -v84
    v_fma_f32 v69, -v66, v69, -v85
    v_mul_f32 v82, v64, v45
    v_mul_f32 v83, v65, v45
    v_exp_f32 v82, v82
    v_fract_f32 v83, v83
    v_cos_f32 v70, v83
    v_sin_f32 v71, v83
    v_mul_f32 v70, v70, v82
    v_mul_f32 v71, v71, v82
    v_mul_f32 v84, v67, v71
    v_mul_f32 v85, v67, v70
    v_fma_f32 v70, v66, v70, -v84
    v_fma_f32 v71, -v66, v71, -v85
    v_mul_f32 v82, v64, v46
    v_mul_f32 v83, v65, v46
    v_exp_f32 v82, v82
    v_fract_f32 v83, v83
    v_cos_f32 v72, v83
    v_sin_f32 v73, v83
    v_mul_f32 v72, v72, v82
    v_mul_f32 v73, v73, v82
    v_mul_f32 v84, v67, v73
    v_mul_f32 v85, v67, v72
    v_fma_f32 v72, v66, v72, -v84
    v_fma_f32 v73, -v66, v73, -v85
    v_mfma_f32_16x16x4_f32 v[48:51], v68, v74, v[48:51]
    v_mfma_f32_16x16x4_f32 v[52:55], v70, v76, v[52:55]
    v_mfma_f32_16x16x4_f32 v[56:59], v70, v78, v[56:59]
    v_mfma_f32_16x16x4_f32 v[60:63], v72, v80, v[60:63]
    v_mfma_f32_16x16x4_f32 v[48:51], v69, v75, v[48:51]
    v_mfma_f32_16x16x4_f32 v[52:55], v71, v77, v[52:55]
    v_mfma_f32_16x16x4_f32 v[56:59], v71, v79, v[56:59]
    v_mfma_f32_16x16x4_f32 v[60:63], v73, v81, v[60:63]
    v_mov_b32_dpp v64, v24 row_newbcast:9 row_mask:0xf bank_mask:0xf
    v_mov_b32_dpp v65, v25 row_newbcast:9 row_mask:0xf bank_mask:0xf
    v_mov_b32_dpp v66, v26 row_newbcast:9 row_mask:0xf bank_mask:0xf
    v_mov_b32_dpp v67, v27 row_newbcast:9 row_mask:0xf bank_mask:0xf
    v_mul_f32 v82, v64, v47
    v_mul_f32 v83, v65, v47
    v_exp_f32 v82, v82
    v_fract_f32 v83, v83
    v_cos_f32 v74, v83
    v_sin_f32 v75, v83
    v_mul_f32 v74, v74, v82
    v_mul_f32 v75, v75, v82
    v_mul_f32 v84, v75, v75
    v_add_f32 v85, v74, v74
    v_fma_f32 v76, v74, v74, -v84
    v_mul_f32 v77, v85, v75
    v_mul_f32 v84, v77, v77
    v_add_f32 v85, v76, v76
    v_fma_f32 v78, v76, v76, -v84
    v_mul_f32 v79, v85, v77
    v_mul_f32 v84, v79, v79
    v_add_f32 v85, v78, v78
    v_fma_f32 v80, v78, v78, -v84
    v_mul_f32 v81, v85, v79
    v_mul_f32 v82, v64, v44
    v_mul_f32 v83, v65, v44
    v_exp_f32 v82, v82
    v_fract_f32 v83, v83
    v_cos_f32 v68, v83
    v_sin_f32 v69, v83
    v_mul_f32 v68, v68, v82
    v_mul_f32 v69, v69, v82
    v_mul_f32 v84, v67, v69
    v_mul_f32 v85, v67, v68
    v_fma_f32 v68, v66, v68, -v84
    v_fma_f32 v69, -v66, v69, -v85
    v_mul_f32 v82, v64, v45
    v_mul_f32 v83, v65, v45
    v_exp_f32 v82, v82
    v_fract_f32 v83, v83
    v_cos_f32 v70, v83
    v_sin_f32 v71, v83
    v_mul_f32 v70, v70, v82
    v_mul_f32 v71, v71, v82
    v_mul_f32 v84, v67, v71
    v_mul_f32 v85, v67, v70
    v_fma_f32 v70, v66, v70, -v84
    v_fma_f32 v71, -v66, v71, -v85
    v_mul_f32 v82, v64, v46
    v_mul_f32 v83, v65, v46
    v_exp_f32 v82, v82
    v_fract_f32 v83, v83
    v_cos_f32 v72, v83
    v_sin_f32 v73, v83
    v_mul_f32 v72, v72, v82
    v_mul_f32 v73, v73, v82
    v_mul_f32 v84, v67, v73
    v_mul_f32 v85, v67, v72
    v_fma_f32 v72, v66, v72, -v84
    v_fma_f32 v73, -v66, v73, -v85
    v_mfma_f32_16x16x4_f32 v[48:51], v68, v74, v[48:51]
    v_mfma_f32_16x16x4_f32 v[52:55], v70, v76, v[52:55]
    v_mfma_f32_16x16x4_f32 v[56:59], v70, v78, v[56:59]
    v_mfma_f32_16x16x4_f32 v[60:63], v72, v80, v[60:63]
    v_mfma_f32_16x16x4_f32 v[48:51], v69, v75, v[48:51]
    v_mfma_f32_16x16x4_f32 v[52:55], v71, v77, v[52:55]
    v_mfma_f32_16x16x4_f32 v[56:59], v71, v79, v[56:59]
    v_mfma_f32_16x16x4_f32 v[60:63], v73, v81, v[60:63]
    v_mov_b32_dpp v64, v24 row_newbcast:10 row_mask:0xf bank_mask:0xf
    v_mov_b32_dpp v65, v25 row_newbcast:10 row_mask:0xf bank_mask:0xf
    v_mov_b32_dpp v66, v26 row_newbcast:10 row_mask:0xf bank_mask:0xf
    v_mov_b32_dpp v67, v27 row_newbcast:10 row_mask:0xf bank_mask:0xf
    v_mul_f32 v82, v64, v47
    v_mul_f32 v83, v65, v47
    v_exp_f32 v82, v82
    v_fract_f32 v83, v83
    v_cos_f32 v74, v83
    v_sin_f32 v75, v83
    v_mul_f32 v74, v74, v82
    v_mul_f32 v75, v75, v82
    v_mul_f32 v84, v75, v75
    v_add_f32 v85, v74, v74
    v_fma_f32 v76, v74, v74, -v84
    v_mul_f32 v77, v85, v75
    v_mul_f32 v84, v77, v77
    v_add_f32 v85, v76, v76
    v_fma_f32 v78, v76, v76, -v84
    v_mul_f32 v79, v85, v77
    v_mul_f32 v84, v79, v79
    v_add_f32 v85, v78, v78
    v_fma_f32 v80, v78, v78, -v84
    v_mul_f32 v81, v85, v79
    v_mul_f32 v82, v64, v44
    v_mul_f32 v83, v65, v44
    v_exp_f32 v82, v82
    v_fract_f32 v83, v83
    v_cos_f32 v68, v83
    v_sin_f32 v69, v83
    v_mul_f32 v68, v68, v82
    v_mul_f32 v69, v69, v82
    v_mul_f32 v84, v67, v69
    v_mul_f32 v85, v67, v68
    v_fma_f32 v68, v66, v68, -v84
    v_fma_f32 v69, -v66, v69, -v85
    v_mul_f32 v82, v64, v45
    v_mul_f32 v83, v65, v45
    v_exp_f32 v82, v82
    v_fract_f32 v83, v83
    v_cos_f32 v70, v83
    v_sin_f32 v71, v83
    v_mul_f32 v70, v70, v82
    v_mul_f32 v71, v71, v82
    v_mul_f32 v84, v67, v71
    v_mul_f32 v85, v67, v70
    v_fma_f32 v70, v66, v70, -v84
    v_fma_f32 v71, -v66, v71, -v85
    v_mul_f32 v82, v64, v46
    v_mul_f32 v83, v65, v46
    v_exp_f32 v82, v82
    v_fract_f32 v83, v83
    v_cos_f32 v72, v83
    v_sin_f32 v73, v83
    v_mul_f32 v72, v72, v82
    v_mul_f32 v73, v73, v82
    v_mul_f32 v84, v67, v73
    v_mul_f32 v85, v67, v72
    v_fma_f32 v72, v66, v72, -v84
    v_fma_f32 v73, -v66, v73, -v85
    v_mfma_f32_16x16x4_f32 v[48:51], v68, v74, v[48:51]
    v_mfma_f32_16x16x4_f32 v[52:55], v70, v76, v[52:55]
    v_mfma_f32_16x16x4_f32 v[56:59], v70, v78, v[56:59]
    v_mfma_f32_16x16x4_f32 v[60:63], v72, v80, v[60:63]
    v_mfma_f32_16x16x4_f32 v[48:51], v69, v75, v[48:51]
    v_mfma_f32_16x16x4_f32 v[52:55], v71, v77, v[52:55]
    v_mfma_f32_16x16x4_f32 v[56:59], v71, v79, v[56:59]
    v_mfma_f32_16x16x4_f32 v[60:63], v73, v81, v[60:63]
    v_mov_b32_dpp v64, v24 row_newbcast:11 row_mask:0xf bank_mask:0xf
    v_mov_b32_dpp v65, v25 row_newbcast:11 row_mask:0xf bank_mask:0xf
    v_mov_b32_dpp v66, v26 row_newbcast:11 row_mask:0xf bank_mask:0xf
    v_mov_b32_dpp v67, v27 row_newbcast:11 row_mask:0xf bank_mask:0xf
    v_mul_f32 v82, v64, v47
    v_mul_f32 v83, v65, v47
    v_exp_f32 v82, v82
    v_fract_f32 v83, v83
    v_cos_f32 v74, v83
    v_sin_f32 v75, v83
    v_mul_f32 v74, v74, v82
    v_mul_f32 v75, v75, v82
    v_mul_f32 v84, v75, v75
    v_add_f32 v85, v74, v74
    v_fma_f32 v76, v74, v74, -v84
    v_mul_f32 v77, v85, v75
    v_mul_f32 v84, v77, v77
    v_add_f32 v85, v76, v76
    v_fma_f32 v78, v76, v76, -v84
    v_mul_f32 v79, v85, v77
    v_mul_f32 v84, v79, v79
    v_add_f32 v85, v78, v78
    v_fma_f32 v80, v78, v78, -v84
    v_mul_f32 v81, v85, v79
    v_mul_f32 v82, v64, v44
    v_mul_f32 v83, v65, v44
    v_exp_f32 v82, v82
    v_fract_f32 v83, v83
    v_cos_f32 v68, v83
    v_sin_f32 v69, v83
    v_mul_f32 v68, v68, v82
    v_mul_f32 v69, v69, v82
    v_mul_f32 v84, v67, v69
    v_mul_f32 v85, v67, v68
    v_fma_f32 v68, v66, v68, -v84
    v_fma_f32 v69, -v66, v69, -v85
    v_mul_f32 v82, v64, v45
    v_mul_f32 v83, v65, v45
    v_exp_f32 v82, v82
    v_fract_f32 v83, v83
    v_cos_f32 v70, v83
    v_sin_f32 v71, v83
    v_mul_f32 v70, v70, v82
    v_mul_f32 v71, v71, v82
    v_mul_f32 v84, v67, v71
    v_mul_f32 v85, v67, v70
    v_fma_f32 v70, v66, v70, -v84
    v_fma_f32 v71, -v66, v71, -v85
    v_mul_f32 v82, v64, v46
    v_mul_f32 v83, v65, v46
    v_exp_f32 v82, v82
    v_fract_f32 v83, v83
    v_cos_f32 v72, v83
    v_sin_f32 v73, v83
    v_mul_f32 v72, v72, v82
    v_mul_f32 v73, v73, v82
    v_mul_f32 v84, v67, v73
    v_mul_f32 v85, v67, v72
    v_fma_f32 v72, v66, v72, -v84
    v_fma_f32 v73, -v66, v73, -v85
    v_mfma_f32_16x16x4_f32 v[48:51], v68, v74, v[48:51]
    v_mfma_f32_16x16x4_f32 v[52:55], v70, v76, v[52:55]
    v_mfma_f32_16x16x4_f32 v[56:59], v70, v78, v[56:59]
    v_mfma_f32_16x16x4_f32 v[60:63], v72, v80, v[60:63]
    v_mfma_f32_16x16x4_f32 v[48:51], v69, v75, v[48:51]
    v_mfma_f32_16x16x4_f32 v[52:55], v71, v77, v[52:55]
    v_mfma_f32_16x16x4_f32 v[56:59], v71, v79, v[56:59]
    v_mfma_f32_16x16x4_f32 v[60:63], v73, v81, v[60:63]
    v_mov_b32_dpp v64, v24 row_newbcast:12 row_mask:0xf bank_mask:0xf
    v_mov_b32_dpp v65, v25 row_newbcast:12 row_mask:0xf bank_mask:0xf
    v_mov_b32_dpp v66, v26 row_newbcast:12 row_mask:0xf bank_mask:0xf
    v_mov_b32_dpp v67, v27 row_newbcast:12 row_mask:0xf bank_mask:0xf
    v_mul_f32 v82, v64, v47
    v_mul_f32 v83, v65, v47
    v_exp_f32 v82, v82
    v_fract_f32 v83, v83
    v_cos_f32 v74, v83
    v_sin_f32 v75, v83
    v_mul_f32 v74, v74, v82
    v_mul_f32 v75, v75, v82
    v_mul_f32 v84, v75, v75
    v_add_f32 v85, v74, v74
    v_fma_f32 v76, v74, v74, -v84
    v_mul_f32 v77, v85, v75
    v_mul_f32 v84, v77, v77
    v_add_f32 v85, v76, v76
    v_fma_f32 v78, v76, v76, -v84
    v_mul_f32 v79, v85, v77
    v_mul_f32 v84, v79, v79
    v_add_f32 v85, v78, v78
    v_fma_f32 v80, v78, v78, -v84
    v_mul_f32 v81, v85, v79
    v_mul_f32 v82, v64, v44
    v_mul_f32 v83, v65, v44
    v_exp_f32 v82, v82
    v_fract_f32 v83, v83
    v_cos_f32 v68, v83
    v_sin_f32 v69, v83
    v_mul_f32 v68, v68, v82
    v_mul_f32 v69, v69, v82
    v_mul_f32 v84, v67, v69
    v_mul_f32 v85, v67, v68
    v_fma_f32 v68, v66, v68, -v84
    v_fma_f32 v69, -v66, v69, -v85
    v_mul_f32 v82, v64, v45
    v_mul_f32 v83, v65, v45
    v_exp_f32 v82, v82
    v_fract_f32 v83, v83
    v_cos_f32 v70, v83
    v_sin_f32 v71, v83
    v_mul_f32 v70, v70, v82
    v_mul_f32 v71, v71, v82
    v_mul_f32 v84, v67, v71
    v_mul_f32 v85, v67, v70
    v_fma_f32 v70, v66, v70, -v84
    v_fma_f32 v71, -v66, v71, -v85
    v_mul_f32 v82, v64, v46
    v_mul_f32 v83, v65, v46
    v_exp_f32 v82, v82
    v_fract_f32 v83, v83
    v_cos_f32 v72, v83
    v_sin_f32 v73, v83
    v_mul_f32 v72, v72, v82
    v_mul_f32 v73, v73, v82
    v_mul_f32 v84, v67, v73
    v_mul_f32 v85, v67, v72
    v_fma_f32 v72, v66, v72, -v84
    v_fma_f32 v73, -v66, v73, -v85
    v_mfma_f32_16x16x4_f32 v[48:51], v68, v74, v[48:51]
    v_mfma_f32_16x16x4_f32 v[52:55], v70, v76, v[52:55]
    v_mfma_f32_16x16x4_f32 v[56:59], v70, v78, v[56:59]
    v_mfma_f32_16x16x4_f32 v[60:63], v72, v80, v[60:63]
    v_mfma_f32_16x16x4_f32 v[48:51], v69, v75, v[48:51]
    v_mfma_f32_16x16x4_f32 v[52:55], v71, v77, v[52:55]
    v_mfma_f32_16x16x4_f32 v[56:59], v71, v79, v[56:59]
    v_mfma_f32_16x16x4_f32 v[60:63], v73, v81, v[60:63]
    v_mov_b32_dpp v64, v24 row_newbcast:13 row_mask:0xf bank_mask:0xf
    v_mov_b32_dpp v65, v25 row_newbcast:13 row_mask:0xf bank_mask:0xf
    v_mov_b32_dpp v66, v26 row_newbcast:13 row_mask:0xf bank_mask:0xf
    v_mov_b32_dpp v67, v27 row_newbcast:13 row_mask:0xf bank_mask:0xf
    v_mul_f32 v82, v64, v47
    v_mul_f32 v83, v65, v47
    v_exp_f32 v82, v82
    v_fract_f32 v83, v83
    v_cos_f32 v74, v83
    v_sin_f32 v75, v83
    v_mul_f32 v74, v74, v82
    v_mul_f32 v75, v75, v82
    v_mul_f32 v84, v75, v75
    v_add_f32 v85, v74, v74
    v_fma_f32 v76, v74, v74, -v84
    v_mul_f32 v77, v85, v75
    v_mul_f32 v84, v77, v77
    v_add_f32 v85, v76, v76
    v_fma_f32 v78, v76, v76, -v84
    v_mul_f32 v79, v85, v77
    v_mul_f32 v84, v79, v79
    v_add_f32 v85, v78, v78
    v_fma_f32 v80, v78, v78, -v84
    v_mul_f32 v81, v85, v79
    v_mul_f32 v82, v64, v44
    v_mul_f32 v83, v65, v44
    v_exp_f32 v82, v82
    v_fract_f32 v83, v83
    v_cos_f32 v68, v83
    v_sin_f32 v69, v83
    v_mul_f32 v68, v68, v82
    v_mul_f32 v69, v69, v82
    v_mul_f32 v84, v67, v69
    v_mul_f32 v85, v67, v68
    v_fma_f32 v68, v66, v68, -v84
    v_fma_f32 v69, -v66, v69, -v85
    v_mul_f32 v82, v64, v45
    v_mul_f32 v83, v65, v45
    v_exp_f32 v82, v82
    v_fract_f32 v83, v83
    v_cos_f32 v70, v83
    v_sin_f32 v71, v83
    v_mul_f32 v70, v70, v82
    v_mul_f32 v71, v71, v82
    v_mul_f32 v84, v67, v71
    v_mul_f32 v85, v67, v70
    v_fma_f32 v70, v66, v70, -v84
    v_fma_f32 v71, -v66, v71, -v85
    v_mul_f32 v82, v64, v46
    v_mul_f32 v83, v65, v46
    v_exp_f32 v82, v82
    v_fract_f32 v83, v83
    v_cos_f32 v72, v83
    v_sin_f32 v73, v83
    v_mul_f32 v72, v72, v82
    v_mul_f32 v73, v73, v82
    v_mul_f32 v84, v67, v73
    v_mul_f32 v85, v67, v72
    v_fma_f32 v72, v66, v72, -v84
    v_fma_f32 v73, -v66, v73, -v85
    v_mfma_f32_16x16x4_f32 v[48:51], v68, v74, v[48:51]
    v_mfma_f32_16x16x4_f32 v[52:55], v70, v76, v[52:55]
    v_mfma_f32_16x16x4_f32 v[56:59], v70, v78, v[56:59]
    v_mfma_f32_16x16x4_f32 v[60:63], v72, v80, v[60:63]
    v_mfma_f32_16x16x4_f32 v[48:51], v69, v75, v[48:51]
    v_mfma_f32_16x16x4_f32 v[52:55], v71, v77, v[52:55]
    v_mfma_f32_16x16x4_f32 v[56:59], v71, v79, v[56:59]
    v_mfma_f32_16x16x4_f32 v[60:63], v73, v81, v[60:63]
    v_mov_b32_dpp v64, v24 row_newbcast:14 row_mask:0xf bank_mask:0xf
    v_mov_b32_dpp v65, v25 row_newbcast:14 row_mask:0xf bank_mask:0xf
    v_mov_b32_dpp v66, v26 row_newbcast:14 row_mask:0xf bank_mask:0xf
    v_mov_b32_dpp v67, v27 row_newbcast:14 row_mask:0xf bank_mask:0xf
    v_mul_f32 v82, v64, v47
    v_mul_f32 v83, v65, v47
    v_exp_f32 v82, v82
    v_fract_f32 v83, v83
    v_cos_f32 v74, v83
    v_sin_f32 v75, v83
    v_mul_f32 v74, v74, v82
    v_mul_f32 v75, v75, v82
    v_mul_f32 v84, v75, v75
    v_add_f32 v85, v74, v74
    v_fma_f32 v76, v74, v74, -v84
    v_mul_f32 v77, v85, v75
    v_mul_f32 v84, v77, v77
    v_add_f32 v85, v76, v76
    v_fma_f32 v78, v76, v76, -v84
    v_mul_f32 v79, v85, v77
    v_mul_f32 v84, v79, v79
    v_add_f32 v85, v78, v78
    v_fma_f32 v80, v78, v78, -v84
    v_mul_f32 v81, v85, v79
    v_mul_f32 v82, v64, v44
    v_mul_f32 v83, v65, v44
    v_exp_f32 v82, v82
    v_fract_f32 v83, v83
    v_cos_f32 v68, v83
    v_sin_f32 v69, v83
    v_mul_f32 v68, v68, v82
    v_mul_f32 v69, v69, v82
    v_mul_f32 v84, v67, v69
    v_mul_f32 v85, v67, v68
    v_fma_f32 v68, v66, v68, -v84
    v_fma_f32 v69, -v66, v69, -v85
    v_mul_f32 v82, v64, v45
    v_mul_f32 v83, v65, v45
    v_exp_f32 v82, v82
    v_fract_f32 v83, v83
    v_cos_f32 v70, v83
    v_sin_f32 v71, v83
    v_mul_f32 v70, v70, v82
    v_mul_f32 v71, v71, v82
    v_mul_f32 v84, v67, v71
    v_mul_f32 v85, v67, v70
    v_fma_f32 v70, v66, v70, -v84
    v_fma_f32 v71, -v66, v71, -v85
    v_mul_f32 v82, v64, v46
    v_mul_f32 v83, v65, v46
    v_exp_f32 v82, v82
    v_fract_f32 v83, v83
    v_cos_f32 v72, v83
    v_sin_f32 v73, v83
    v_mul_f32 v72, v72, v82
    v_mul_f32 v73, v73, v82
    v_mul_f32 v84, v67, v73
    v_mul_f32 v85, v67, v72
    v_fma_f32 v72, v66, v72, -v84
    v_fma_f32 v73, -v66, v73, -v85
    v_mfma_f32_16x16x4_f32 v[48:51], v68, v74, v[48:51]
    v_mfma_f32_16x16x4_f32 v[52:55], v70, v76, v[52:55]
    v_mfma_f32_16x16x4_f32 v[56:59], v70, v78, v[56:59]
    v_mfma_f32_16x16x4_f32 v[60:63], v72, v80, v[60:63]
    v_mfma_f32_16x16x4_f32 v[48:51], v69, v75, v[48:51]
    v_mfma_f32_16x16x4_f32 v[52:55], v71, v77, v[52:55]
    v_mfma_f32_16x16x4_f32 v[56:59], v71, v79, v[56:59]
    v_mfma_f32_16x16x4_f32 v[60:63], v73, v81, v[60:63]
    v_mov_b32_dpp v64, v24 row_newbcast:15 row_mask:0xf bank_mask:0xf
    v_mov_b32_dpp v65, v25 row_newbcast:15 row_mask:0xf bank_mask:0xf
    v_mov_b32_dpp v66, v26 row_newbcast:15 row_mask:0xf bank_mask:0xf
    v_mov_b32_dpp v67, v27 row_newbcast:15 row_mask:0xf bank_mask:0xf
    v_mul_f32 v82, v64, v47
    v_mul_f32 v83, v65, v47
    v_exp_f32 v82, v82
    v_fract_f32 v83, v83
    v_cos_f32 v74, v83
    v_sin_f32 v75, v83
    v_mul_f32 v74, v74, v82
    v_mul_f32 v75, v75, v82
    v_mul_f32 v84, v75, v75
    v_add_f32 v85, v74, v74
    v_fma_f32 v76, v74, v74, -v84
    v_mul_f32 v77, v85, v75
    v_mul_f32 v84, v77, v77
    v_add_f32 v85, v76, v76
    v_fma_f32 v78, v76, v76, -v84
    v_mul_f32 v79, v85, v77
    v_mul_f32 v84, v79, v79
    v_add_f32 v85, v78, v78
    v_fma_f32 v80, v78, v78, -v84
    v_mul_f32 v81, v85, v79
    v_mul_f32 v82, v64, v44
    v_mul_f32 v83, v65, v44
    v_exp_f32 v82, v82
    v_fract_f32 v83, v83
    v_cos_f32 v68, v83
    v_sin_f32 v69, v83
    v_mul_f32 v68, v68, v82
    v_mul_f32 v69, v69, v82
    v_mul_f32 v84, v67, v69
    v_mul_f32 v85, v67, v68
    v_fma_f32 v68, v66, v68, -v84
    v_fma_f32 v69, -v66, v69, -v85
    v_mul_f32 v82, v64, v45
    v_mul_f32 v83, v65, v45
    v_exp_f32 v82, v82
    v_fract_f32 v83, v83
    v_cos_f32 v70, v83
    v_sin_f32 v71, v83
    v_mul_f32 v70, v70, v82
    v_mul_f32 v71, v71, v82
    v_mul_f32 v84, v67, v71
    v_mul_f32 v85, v67, v70
    v_fma_f32 v70, v66, v70, -v84
    v_fma_f32 v71, -v66, v71, -v85
    v_mul_f32 v82, v64, v46
    v_mul_f32 v83, v65, v46
    v_exp_f32 v82, v82
    v_fract_f32 v83, v83
    v_cos_f32 v72, v83
    v_sin_f32 v73, v83
    v_mul_f32 v72, v72, v82
    v_mul_f32 v73, v73, v82
    v_mul_f32 v84, v67, v73
    v_mul_f32 v85, v67, v72
    v_fma_f32 v72, v66, v72, -v84
    v_fma_f32 v73, -v66, v73, -v85
    v_mfma_f32_16x16x4_f32 v[48:51], v68, v74, v[48:51]
    v_mfma_f32_16x16x4_f32 v[52:55], v70, v76, v[52:55]
    v_mfma_f32_16x16x4_f32 v[56:59], v70, v78, v[56:59]
    v_mfma_f32_16x16x4_f32 v[60:63], v72, v80, v[60:63]
    v_mfma_f32_16x16x4_f32 v[48:51], v69, v75, v[48:51]
    v_mfma_f32_16x16x4_f32 v[52:55], v71, v77, v[52:55]
    v_mfma_f32_16x16x4_f32 v[56:59], v71, v79, v[56:59]
    v_mfma_f32_16x16x4_f32 v[60:63], v73, v81, v[60:63]
    v_mov_b32_dpp v64, v28 row_newbcast:0 row_mask:0xf bank_mask:0xf
    v_mov_b32_dpp v65, v29 row_newbcast:0 row_mask:0xf bank_mask:0xf
    v_mov_b32_dpp v66, v30 row_newbcast:0 row_mask:0xf bank_mask:0xf
    v_mov_b32_dpp v67, v31 row_newbcast:0 row_mask:0xf bank_mask:0xf
    v_mul_f32 v82, v64, v47
    v_mul_f32 v83, v65, v47
    v_exp_f32 v82, v82
    v_fract_f32 v83, v83
    v_cos_f32 v74, v83
    v_sin_f32 v75, v83
    v_mul_f32 v74, v74, v82
    v_mul_f32 v75, v75, v82
    v_mul_f32 v84, v75, v75
    v_add_f32 v85, v74, v74
    v_fma_f32 v76, v74, v74, -v84
    v_mul_f32 v77, v85, v75
    v_mul_f32 v84, v77, v77
    v_add_f32 v85, v76, v76
    v_fma_f32 v78, v76, v76, -v84
    v_mul_f32 v79, v85, v77
    v_mul_f32 v84, v79, v79
    v_add_f32 v85, v78, v78
    v_fma_f32 v80, v78, v78, -v84
    v_mul_f32 v81, v85, v79
    v_mul_f32 v82, v64, v44
    v_mul_f32 v83, v65, v44
    v_exp_f32 v82, v82
    v_fract_f32 v83, v83
    v_cos_f32 v68, v83
    v_sin_f32 v69, v83
    v_mul_f32 v68, v68, v82
    v_mul_f32 v69, v69, v82
    v_mul_f32 v84, v67, v69
    v_mul_f32 v85, v67, v68
    v_fma_f32 v68, v66, v68, -v84
    v_fma_f32 v69, -v66, v69, -v85
    v_mul_f32 v82, v64, v45
    v_mul_f32 v83, v65, v45
    v_exp_f32 v82, v82
    v_fract_f32 v83, v83
    v_cos_f32 v70, v83
    v_sin_f32 v71, v83
    v_mul_f32 v70, v70, v82
    v_mul_f32 v71, v71, v82
    v_mul_f32 v84, v67, v71
    v_mul_f32 v85, v67, v70
    v_fma_f32 v70, v66, v70, -v84
    v_fma_f32 v71, -v66, v71, -v85
    v_mul_f32 v82, v64, v46
    v_mul_f32 v83, v65, v46
    v_exp_f32 v82, v82
    v_fract_f32 v83, v83
    v_cos_f32 v72, v83
    v_sin_f32 v73, v83
    v_mul_f32 v72, v72, v82
    v_mul_f32 v73, v73, v82
    v_mul_f32 v84, v67, v73
    v_mul_f32 v85, v67, v72
    v_fma_f32 v72, v66, v72, -v84
    v_fma_f32 v73, -v66, v73, -v85
    v_mfma_f32_16x16x4_f32 v[48:51], v68, v74, v[48:51]
    v_mfma_f32_16x16x4_f32 v[52:55], v70, v76, v[52:55]
    v_mfma_f32_16x16x4_f32 v[56:59], v70, v78, v[56:59]
    v_mfma_f32_16x16x4_f32 v[60:63], v72, v80, v[60:63]
    v_mfma_f32_16x16x4_f32 v[48:51], v69, v75, v[48:51]
    v_mfma_f32_16x16x4_f32 v[52:55], v71, v77, v[52:55]
    v_mfma_f32_16x16x4_f32 v[56:59], v71, v79, v[56:59]
    v_mfma_f32_16x16x4_f32 v[60:63], v73, v81, v[60:63]
    v_mov_b32_dpp v64, v28 row_newbcast:1 row_mask:0xf bank_mask:0xf
    v_mov_b32_dpp v65, v29 row_newbcast:1 row_mask:0xf bank_mask:0xf
    v_mov_b32_dpp v66, v30 row_newbcast:1 row_mask:0xf bank_mask:0xf
    v_mov_b32_dpp v67, v31 row_newbcast:1 row_mask:0xf bank_mask:0xf
    v_mul_f32 v82, v64, v47
    v_mul_f32 v83, v65, v47
    v_exp_f32 v82, v82
    v_fract_f32 v83, v83
    v_cos_f32 v74, v83
    v_sin_f32 v75, v83
    v_mul_f32 v74, v74, v82
    v_mul_f32 v75, v75, v82
    v_mul_f32 v84, v75, v75
    v_add_f32 v85, v74, v74
    v_fma_f32 v76, v74, v74, -v84
    v_mul_f32 v77, v85, v75
    v_mul_f32 v84, v77, v77
    v_add_f32 v85, v76, v76
    v_fma_f32 v78, v76, v76, -v84
    v_mul_f32 v79, v85, v77
    v_mul_f32 v84, v79, v79
    v_add_f32 v85, v78, v78
    v_fma_f32 v80, v78, v78, -v84
    v_mul_f32 v81, v85, v79
    v_mul_f32 v82, v64, v44
    v_mul_f32 v83, v65, v44
    v_exp_f32 v82, v82
    v_fract_f32 v83, v83
    v_cos_f32 v68, v83
    v_sin_f32 v69, v83
    v_mul_f32 v68, v68, v82
    v_mul_f32 v69, v69, v82
    v_mul_f32 v84, v67, v69
    v_mul_f32 v85, v67, v68
    v_fma_f32 v68, v66, v68, -v84
    v_fma_f32 v69, -v66, v69, -v85
    v_mul_f32 v82, v64, v45
    v_mul_f32 v83, v65, v45
    v_exp_f32 v82, v82
    v_fract_f32 v83, v83
    v_cos_f32 v70, v83
    v_sin_f32 v71, v83
    v_mul_f32 v70, v70, v82
    v_mul_f32 v71, v71, v82
    v_mul_f32 v84, v67, v71
    v_mul_f32 v85, v67, v70
    v_fma_f32 v70, v66, v70, -v84
    v_fma_f32 v71, -v66, v71, -v85
    v_mul_f32 v82, v64, v46
    v_mul_f32 v83, v65, v46
    v_exp_f32 v82, v82
    v_fract_f32 v83, v83
    v_cos_f32 v72, v83
    v_sin_f32 v73, v83
    v_mul_f32 v72, v72, v82
    v_mul_f32 v73, v73, v82
    v_mul_f32 v84, v67, v73
    v_mul_f32 v85, v67, v72
    v_fma_f32 v72, v66, v72, -v84
    v_fma_f32 v73, -v66, v73, -v85
    v_mfma_f32_16x16x4_f32 v[48:51], v68, v74, v[48:51]
    v_mfma_f32_16x16x4_f32 v[52:55], v70, v76, v[52:55]
    v_mfma_f32_16x16x4_f32 v[56:59], v70, v78, v[56:59]
    v_mfma_f32_16x16x4_f32 v[60:63], v72, v80, v[60:63]
    v_mfma_f32_16x16x4_f32 v[48:51], v69, v75, v[48:51]
    v_mfma_f32_16x16x4_f32 v[52:55], v71, v77, v[52:55]
    v_mfma_f32_16x16x4_f32 v[56:59], v71, v79, v[56:59]
    v_mfma_f32_16x16x4_f32 v[60:63], v73, v81, v[60:63]
    v_mov_b32_dpp v64, v28 row_newbcast:2 row_mask:0xf bank_mask:0xf
    v_mov_b32_dpp v65, v29 row_newbcast:2 row_mask:0xf bank_mask:0xf
    v_mov_b32_dpp v66, v30 row_newbcast:2 row_mask:0xf bank_mask:0xf
    v_mov_b32_dpp v67, v31 row_newbcast:2 row_mask:0xf bank_mask:0xf
    v_mul_f32 v82, v64, v47
    v_mul_f32 v83, v65, v47
    v_exp_f32 v82, v82
    v_fract_f32 v83, v83
    v_cos_f32 v74, v83
    v_sin_f32 v75, v83
    v_mul_f32 v74, v74, v82
    v_mul_f32 v75, v75, v82
    v_mul_f32 v84, v75, v75
    v_add_f32 v85, v74, v74
    v_fma_f32 v76, v74, v74, -v84
    v_mul_f32 v77, v85, v75
    v_mul_f32 v84, v77, v77
    v_add_f32 v85, v76, v76
    v_fma_f32 v78, v76, v76, -v84
    v_mul_f32 v79, v85, v77
    v_mul_f32 v84, v79, v79
    v_add_f32 v85, v78, v78
    v_fma_f32 v80, v78, v78, -v84
    v_mul_f32 v81, v85, v79
    v_mul_f32 v82, v64, v44
    v_mul_f32 v83, v65, v44
    v_exp_f32 v82, v82
    v_fract_f32 v83, v83
    v_cos_f32 v68, v83
    v_sin_f32 v69, v83
    v_mul_f32 v68, v68, v82
    v_mul_f32 v69, v69, v82
    v_mul_f32 v84, v67, v69
    v_mul_f32 v85, v67, v68
    v_fma_f32 v68, v66, v68, -v84
    v_fma_f32 v69, -v66, v69, -v85
    v_mul_f32 v82, v64, v45
    v_mul_f32 v83, v65, v45
    v_exp_f32 v82, v82
    v_fract_f32 v83, v83
    v_cos_f32 v70, v83
    v_sin_f32 v71, v83
    v_mul_f32 v70, v70, v82
    v_mul_f32 v71, v71, v82
    v_mul_f32 v84, v67, v71
    v_mul_f32 v85, v67, v70
    v_fma_f32 v70, v66, v70, -v84
    v_fma_f32 v71, -v66, v71, -v85
    v_mul_f32 v82, v64, v46
    v_mul_f32 v83, v65, v46
    v_exp_f32 v82, v82
    v_fract_f32 v83, v83
    v_cos_f32 v72, v83
    v_sin_f32 v73, v83
    v_mul_f32 v72, v72, v82
    v_mul_f32 v73, v73, v82
    v_mul_f32 v84, v67, v73
    v_mul_f32 v85, v67, v72
    v_fma_f32 v72, v66, v72, -v84
    v_fma_f32 v73, -v66, v73, -v85
    v_mfma_f32_16x16x4_f32 v[48:51], v68, v74, v[48:51]
    v_mfma_f32_16x16x4_f32 v[52:55], v70, v76, v[52:55]
    v_mfma_f32_16x16x4_f32 v[56:59], v70, v78, v[56:59]
    v_mfma_f32_16x16x4_f32 v[60:63], v72, v80, v[60:63]
    v_mfma_f32_16x16x4_f32 v[48:51], v69, v75, v[48:51]
    v_mfma_f32_16x16x4_f32 v[52:55], v71, v77, v[52:55]
    v_mfma_f32_16x16x4_f32 v[56:59], v71, v79, v[56:59]
    v_mfma_f32_16x16x4_f32 v[60:63], v73, v81, v[60:63]
    v_mov_b32_dpp v64, v28 row_newbcast:3 row_mask:0xf bank_mask:0xf
    v_mov_b32_dpp v65, v29 row_newbcast:3 row_mask:0xf bank_mask:0xf
    v_mov_b32_dpp v66, v30 row_newbcast:3 row_mask:0xf bank_mask:0xf
    v_mov_b32_dpp v67, v31 row_newbcast:3 row_mask:0xf bank_mask:0xf
    v_mul_f32 v82, v64, v47
    v_mul_f32 v83, v65, v47
    v_exp_f32 v82, v82
    v_fract_f32 v83, v83
    v_cos_f32 v74, v83
    v_sin_f32 v75, v83
    v_mul_f32 v74, v74, v82
    v_mul_f32 v75, v75, v82
    v_mul_f32 v84, v75, v75
    v_add_f32 v85, v74, v74
    v_fma_f32 v76, v74, v74, -v84
    v_mul_f32 v77, v85, v75
    v_mul_f32 v84, v77, v77
    v_add_f32 v85, v76, v76
    v_fma_f32 v78, v76, v76, -v84
    v_mul_f32 v79, v85, v77
    v_mul_f32 v84, v79, v79
    v_add_f32 v85, v78, v78
    v_fma_f32 v80, v78, v78, -v84
    v_mul_f32 v81, v85, v79
    v_mul_f32 v82, v64, v44
    v_mul_f32 v83, v65, v44
    v_exp_f32 v82, v82
    v_fract_f32 v83, v83
    v_cos_f32 v68, v83
    v_sin_f32 v69, v83
    v_mul_f32 v68, v68, v82
    v_mul_f32 v69, v69, v82
    v_mul_f32 v84, v67, v69
    v_mul_f32 v85, v67, v68
    v_fma_f32 v68, v66, v68, -v84
    v_fma_f32 v69, -v66, v69, -v85
    v_mul_f32 v82, v64, v45
    v_mul_f32 v83, v65, v45
    v_exp_f32 v82, v82
    v_fract_f32 v83, v83
    v_cos_f32 v70, v83
    v_sin_f32 v71, v83
    v_mul_f32 v70, v70, v82
    v_mul_f32 v71, v71, v82
    v_mul_f32 v84, v67, v71
    v_mul_f32 v85, v67, v70
    v_fma_f32 v70, v66, v70, -v84
    v_fma_f32 v71, -v66, v71, -v85
    v_mul_f32 v82, v64, v46
    v_mul_f32 v83, v65, v46
    v_exp_f32 v82, v82
    v_fract_f32 v83, v83
    v_cos_f32 v72, v83
    v_sin_f32 v73, v83
    v_mul_f32 v72, v72, v82
    v_mul_f32 v73, v73, v82
    v_mul_f32 v84, v67, v73
    v_mul_f32 v85, v67, v72
    v_fma_f32 v72, v66, v72, -v84
    v_fma_f32 v73, -v66, v73, -v85
    v_mfma_f32_16x16x4_f32 v[48:51], v68, v74, v[48:51]
    v_mfma_f32_16x16x4_f32 v[52:55], v70, v76, v[52:55]
    v_mfma_f32_16x16x4_f32 v[56:59], v70, v78, v[56:59]
    v_mfma_f32_16x16x4_f32 v[60:63], v72, v80, v[60:63]
    v_mfma_f32_16x16x4_f32 v[48:51], v69, v75, v[48:51]
    v_mfma_f32_16x16x4_f32 v[52:55], v71, v77, v[52:55]
    v_mfma_f32_16x16x4_f32 v[56:59], v71, v79, v[56:59]
    v_mfma_f32_16x16x4_f32 v[60:63], v73, v81, v[60:63]
    v_mov_b32_dpp v64, v28 row_newbcast:4 row_mask:0xf bank_mask:0xf
    v_mov_b32_dpp v65, v29 row_newbcast:4 row_mask:0xf bank_mask:0xf
    v_mov_b32_dpp v66, v30 row_newbcast:4 row_mask:0xf bank_mask:0xf
    v_mov_b32_dpp v67, v31 row_newbcast:4 row_mask:0xf bank_mask:0xf
    v_mul_f32 v82, v64, v47
    v_mul_f32 v83, v65, v47
    v_exp_f32 v82, v82
    v_fract_f32 v83, v83
    v_cos_f32 v74, v83
    v_sin_f32 v75, v83
    v_mul_f32 v74, v74, v82
    v_mul_f32 v75, v75, v82
    v_mul_f32 v84, v75, v75
    v_add_f32 v85, v74, v74
    v_fma_f32 v76, v74, v74, -v84
    v_mul_f32 v77, v85, v75
    v_mul_f32 v84, v77, v77
    v_add_f32 v85, v76, v76
    v_fma_f32 v78, v76, v76, -v84
    v_mul_f32 v79, v85, v77
    v_mul_f32 v84, v79, v79
    v_add_f32 v85, v78, v78
    v_fma_f32 v80, v78, v78, -v84
    v_mul_f32 v81, v85, v79
    v_mul_f32 v82, v64, v44
    v_mul_f32 v83, v65, v44
    v_exp_f32 v82, v82
    v_fract_f32 v83, v83
    v_cos_f32 v68, v83
    v_sin_f32 v69, v83
    v_mul_f32 v68, v68, v82
    v_mul_f32 v69, v69, v82
    v_mul_f32 v84, v67, v69
    v_mul_f32 v85, v67, v68
    v_fma_f32 v68, v66, v68, -v84
    v_fma_f32 v69, -v66, v69, -v85
    v_mul_f32 v82, v64, v45
    v_mul_f32 v83, v65, v45
    v_exp_f32 v82, v82
    v_fract_f32 v83, v83
    v_cos_f32 v70, v83
    v_sin_f32 v71, v83
    v_mul_f32 v70, v70, v82
    v_mul_f32 v71, v71, v82
    v_mul_f32 v84, v67, v71
    v_mul_f32 v85, v67, v70
    v_fma_f32 v70, v66, v70, -v84
    v_fma_f32 v71, -v66, v71, -v85
    v_mul_f32 v82, v64, v46
    v_mul_f32 v83, v65, v46
    v_exp_f32 v82, v82
    v_fract_f32 v83, v83
    v_cos_f32 v72, v83
    v_sin_f32 v73, v83
    v_mul_f32 v72, v72, v82
    v_mul_f32 v73, v73, v82
    v_mul_f32 v84, v67, v73
    v_mul_f32 v85, v67, v72
    v_fma_f32 v72, v66, v72, -v84
    v_fma_f32 v73, -v66, v73, -v85
    v_mfma_f32_16x16x4_f32 v[48:51], v68, v74, v[48:51]
    v_mfma_f32_16x16x4_f32 v[52:55], v70, v76, v[52:55]
    v_mfma_f32_16x16x4_f32 v[56:59], v70, v78, v[56:59]
    v_mfma_f32_16x16x4_f32 v[60:63], v72, v80, v[60:63]
    v_mfma_f32_16x16x4_f32 v[48:51], v69, v75, v[48:51]
    v_mfma_f32_16x16x4_f32 v[52:55], v71, v77, v[52:55]
    v_mfma_f32_16x16x4_f32 v[56:59], v71, v79, v[56:59]
    v_mfma_f32_16x16x4_f32 v[60:63], v73, v81, v[60:63]
    v_mov_b32_dpp v64, v28 row_newbcast:5 row_mask:0xf bank_mask:0xf
    v_mov_b32_dpp v65, v29 row_newbcast:5 row_mask:0xf bank_mask:0xf
    v_mov_b32_dpp v66, v30 row_newbcast:5 row_mask:0xf bank_mask:0xf
    v_mov_b32_dpp v67, v31 row_newbcast:5 row_mask:0xf bank_mask:0xf
    v_mul_f32 v82, v64, v47
    v_mul_f32 v83, v65, v47
    v_exp_f32 v82, v82
    v_fract_f32 v83, v83
    v_cos_f32 v74, v83
    v_sin_f32 v75, v83
    v_mul_f32 v74, v74, v82
    v_mul_f32 v75, v75, v82
    v_mul_f32 v84, v75, v75
    v_add_f32 v85, v74, v74
    v_fma_f32 v76, v74, v74, -v84
    v_mul_f32 v77, v85, v75
    v_mul_f32 v84, v77, v77
    v_add_f32 v85, v76, v76
    v_fma_f32 v78, v76, v76, -v84
    v_mul_f32 v79, v85, v77
    v_mul_f32 v84, v79, v79
    v_add_f32 v85, v78, v78
    v_fma_f32 v80, v78, v78, -v84
    v_mul_f32 v81, v85, v79
    v_mul_f32 v82, v64, v44
    v_mul_f32 v83, v65, v44
    v_exp_f32 v82, v82
    v_fract_f32 v83, v83
    v_cos_f32 v68, v83
    v_sin_f32 v69, v83
    v_mul_f32 v68, v68, v82
    v_mul_f32 v69, v69, v82
    v_mul_f32 v84, v67, v69
    v_mul_f32 v85, v67, v68
    v_fma_f32 v68, v66, v68, -v84
    v_fma_f32 v69, -v66, v69, -v85
    v_mul_f32 v82, v64, v45
    v_mul_f32 v83, v65, v45
    v_exp_f32 v82, v82
    v_fract_f32 v83, v83
    v_cos_f32 v70, v83
    v_sin_f32 v71, v83
    v_mul_f32 v70, v70, v82
    v_mul_f32 v71, v71, v82
    v_mul_f32 v84, v67, v71
    v_mul_f32 v85, v67, v70
    v_fma_f32 v70, v66, v70, -v84
    v_fma_f32 v71, -v66, v71, -v85
    v_mul_f32 v82, v64, v46
    v_mul_f32 v83, v65, v46
    v_exp_f32 v82, v82
    v_fract_f32 v83, v83
    v_cos_f32 v72, v83
    v_sin_f32 v73, v83
    v_mul_f32 v72, v72, v82
    v_mul_f32 v73, v73, v82
    v_mul_f32 v84, v67, v73
    v_mul_f32 v85, v67, v72
    v_fma_f32 v72, v66, v72, -v84
    v_fma_f32 v73, -v66, v73, -v85
    v_mfma_f32_16x16x4_f32 v[48:51], v68, v74, v[48:51]
    v_mfma_f32_16x16x4_f32 v[52:55], v70, v76, v[52:55]
    v_mfma_f32_16x16x4_f32 v[56:59], v70, v78, v[56:59]
    v_mfma_f32_16x16x4_f32 v[60:63], v72, v80, v[60:63]
    v_mfma_f32_16x16x4_f32 v[48:51], v69, v75, v[48:51]
    v_mfma_f32_16x16x4_f32 v[52:55], v71, v77, v[52:55]
    v_mfma_f32_16x16x4_f32 v[56:59], v71, v79, v[56:59]
    v_mfma_f32_16x16x4_f32 v[60:63], v73, v81, v[60:63]
    v_mov_b32_dpp v64, v28 row_newbcast:6 row_mask:0xf bank_mask:0xf
    v_mov_b32_dpp v65, v29 row_newbcast:6 row_mask:0xf bank_mask:0xf
    v_mov_b32_dpp v66, v30 row_newbcast:6 row_mask:0xf bank_mask:0xf
    v_mov_b32_dpp v67, v31 row_newbcast:6 row_mask:0xf bank_mask:0xf
    v_mul_f32 v82, v64, v47
    v_mul_f32 v83, v65, v47
    v_exp_f32 v82, v82
    v_fract_f32 v83, v83
    v_cos_f32 v74, v83
    v_sin_f32 v75, v83
    v_mul_f32 v74, v74, v82
    v_mul_f32 v75, v75, v82
    v_mul_f32 v84, v75, v75
    v_add_f32 v85, v74, v74
    v_fma_f32 v76, v74, v74, -v84
    v_mul_f32 v77, v85, v75
    v_mul_f32 v84, v77, v77
    v_add_f32 v85, v76, v76
    v_fma_f32 v78, v76, v76, -v84
    v_mul_f32 v79, v85, v77
    v_mul_f32 v84, v79, v79
    v_add_f32 v85, v78, v78
    v_fma_f32 v80, v78, v78, -v84
    v_mul_f32 v81, v85, v79
    v_mul_f32 v82, v64, v44
    v_mul_f32 v83, v65, v44
    v_exp_f32 v82, v82
    v_fract_f32 v83, v83
    v_cos_f32 v68, v83
    v_sin_f32 v69, v83
    v_mul_f32 v68, v68, v82
    v_mul_f32 v69, v69, v82
    v_mul_f32 v84, v67, v69
    v_mul_f32 v85, v67, v68
    v_fma_f32 v68, v66, v68, -v84
    v_fma_f32 v69, -v66, v69, -v85
    v_mul_f32 v82, v64, v45
    v_mul_f32 v83, v65, v45
    v_exp_f32 v82, v82
    v_fract_f32 v83, v83
    v_cos_f32 v70, v83
    v_sin_f32 v71, v83
    v_mul_f32 v70, v70, v82
    v_mul_f32 v71, v71, v82
    v_mul_f32 v84, v67, v71
    v_mul_f32 v85, v67, v70
    v_fma_f32 v70, v66, v70, -v84
    v_fma_f32 v71, -v66, v71, -v85
    v_mul_f32 v82, v64, v46
    v_mul_f32 v83, v65, v46
    v_exp_f32 v82, v82
    v_fract_f32 v83, v83
    v_cos_f32 v72, v83
    v_sin_f32 v73, v83
    v_mul_f32 v72, v72, v82
    v_mul_f32 v73, v73, v82
    v_mul_f32 v84, v67, v73
    v_mul_f32 v85, v67, v72
    v_fma_f32 v72, v66, v72, -v84
    v_fma_f32 v73, -v66, v73, -v85
    v_mfma_f32_16x16x4_f32 v[48:51], v68, v74, v[48:51]
    v_mfma_f32_16x16x4_f32 v[52:55], v70, v76, v[52:55]
    v_mfma_f32_16x16x4_f32 v[56:59], v70, v78, v[56:59]
    v_mfma_f32_16x16x4_f32 v[60:63], v72, v80, v[60:63]
    v_mfma_f32_16x16x4_f32 v[48:51], v69, v75, v[48:51]
    v_mfma_f32_16x16x4_f32 v[52:55], v71, v77, v[52:55]
    v_mfma_f32_16x16x4_f32 v[56:59], v71, v79, v[56:59]
    v_mfma_f32_16x16x4_f32 v[60:63], v73, v81, v[60:63]
    v_mov_b32_dpp v64, v28 row_newbcast:7 row_mask:0xf bank_mask:0xf
    v_mov_b32_dpp v65, v29 row_newbcast:7 row_mask:0xf bank_mask:0xf
    v_mov_b32_dpp v66, v30 row_newbcast:7 row_mask:0xf bank_mask:0xf
    v_mov_b32_dpp v67, v31 row_newbcast:7 row_mask:0xf bank_mask:0xf
    v_mul_f32 v82, v64, v47
    v_mul_f32 v83, v65, v47
    v_exp_f32 v82, v82
    v_fract_f32 v83, v83
    v_cos_f32 v74, v83
    v_sin_f32 v75, v83
    v_mul_f32 v74, v74, v82
    v_mul_f32 v75, v75, v82
    v_mul_f32 v84, v75, v75
    v_add_f32 v85, v74, v74
    v_fma_f32 v76, v74, v74, -v84
    v_mul_f32 v77, v85, v75
    v_mul_f32 v84, v77, v77
    v_add_f32 v85, v76, v76
    v_fma_f32 v78, v76, v76, -v84
    v_mul_f32 v79, v85, v77
    v_mul_f32 v84, v79, v79
    v_add_f32 v85, v78, v78
    v_fma_f32 v80, v78, v78, -v84
    v_mul_f32 v81, v85, v79
    v_mul_f32 v82, v64, v44
    v_mul_f32 v83, v65, v44
    v_exp_f32 v82, v82
    v_fract_f32 v83, v83
    v_cos_f32 v68, v83
    v_sin_f32 v69, v83
    v_mul_f32 v68, v68, v82
    v_mul_f32 v69, v69, v82
    v_mul_f32 v84, v67, v69
    v_mul_f32 v85, v67, v68
    v_fma_f32 v68, v66, v68, -v84
    v_fma_f32 v69, -v66, v69, -v85
    v_mul_f32 v82, v64, v45
    v_mul_f32 v83, v65, v45
    v_exp_f32 v82, v82
    v_fract_f32 v83, v83
    v_cos_f32 v70, v83
    v_sin_f32 v71, v83
    v_mul_f32 v70, v70, v82
    v_mul_f32 v71, v71, v82
    v_mul_f32 v84, v67, v71
    v_mul_f32 v85, v67, v70
    v_fma_f32 v70, v66, v70, -v84
    v_fma_f32 v71, -v66, v71, -v85
    v_mul_f32 v82, v64, v46
    v_mul_f32 v83, v65, v46
    v_exp_f32 v82, v82
    v_fract_f32 v83, v83
    v_cos_f32 v72, v83
    v_sin_f32 v73, v83
    v_mul_f32 v72, v72, v82
    v_mul_f32 v73, v73, v82
    v_mul_f32 v84, v67, v73
    v_mul_f32 v85, v67, v72
    v_fma_f32 v72, v66, v72, -v84
    v_fma_f32 v73, -v66, v73, -v85
    v_mfma_f32_16x16x4_f32 v[48:51], v68, v74, v[48:51]
    v_mfma_f32_16x16x4_f32 v[52:55], v70, v76, v[52:55]
    v_mfma_f32_16x16x4_f32 v[56:59], v70, v78, v[56:59]
    v_mfma_f32_16x16x4_f32 v[60:63], v72, v80, v[60:63]
    v_mfma_f32_16x16x4_f32 v[48:51], v69, v75, v[48:51]
    v_mfma_f32_16x16x4_f32 v[52:55], v71, v77, v[52:55]
    v_mfma_f32_16x16x4_f32 v[56:59], v71, v79, v[56:59]
    v_mfma_f32_16x16x4_f32 v[60:63], v73, v81, v[60:63]
    v_mov_b32_dpp v64, v28 row_newbcast:8 row_mask:0xf bank_mask:0xf
    v_mov_b32_dpp v65, v29 row_newbcast:8 row_mask:0xf bank_mask:0xf
    v_mov_b32_dpp v66, v30 row_newbcast:8 row_mask:0xf bank_mask:0xf
    v_mov_b32_dpp v67, v31 row_newbcast:8 row_mask:0xf bank_mask:0xf
    v_mul_f32 v82, v64, v47
    v_mul_f32 v83, v65, v47
    v_exp_f32 v82, v82
    v_fract_f32 v83, v83
    v_cos_f32 v74, v83
    v_sin_f32 v75, v83
    v_mul_f32 v74, v74, v82
    v_mul_f32 v75, v75, v82
    v_mul_f32 v84, v75, v75
    v_add_f32 v85, v74, v74
    v_fma_f32 v76, v74, v74, -v84
    v_mul_f32 v77, v85, v75
    v_mul_f32 v84, v77, v77
    v_add_f32 v85, v76, v76
    v_fma_f32 v78, v76, v76, -v84
    v_mul_f32 v79, v85, v77
    v_mul_f32 v84, v79, v79
    v_add_f32 v85, v78, v78
    v_fma_f32 v80, v78, v78, -v84
    v_mul_f32 v81, v85, v79
    v_mul_f32 v82, v64, v44
    v_mul_f32 v83, v65, v44
    v_exp_f32 v82, v82
    v_fract_f32 v83, v83
    v_cos_f32 v68, v83
    v_sin_f32 v69, v83
    v_mul_f32 v68, v68, v82
    v_mul_f32 v69, v69, v82
    v_mul_f32 v84, v67, v69
    v_mul_f32 v85, v67, v68
    v_fma_f32 v68, v66, v68, -v84
    v_fma_f32 v69, -v66, v69, -v85
    v_mul_f32 v82, v64, v45
    v_mul_f32 v83, v65, v45
    v_exp_f32 v82, v82
    v_fract_f32 v83, v83
    v_cos_f32 v70, v83
    v_sin_f32 v71, v83
    v_mul_f32 v70, v70, v82
    v_mul_f32 v71, v71, v82
    v_mul_f32 v84, v67, v71
    v_mul_f32 v85, v67, v70
    v_fma_f32 v70, v66, v70, -v84
    v_fma_f32 v71, -v66, v71, -v85
    v_mul_f32 v82, v64, v46
    v_mul_f32 v83, v65, v46
    v_exp_f32 v82, v82
    v_fract_f32 v83, v83
    v_cos_f32 v72, v83
    v_sin_f32 v73, v83
    v_mul_f32 v72, v72, v82
    v_mul_f32 v73, v73, v82
    v_mul_f32 v84, v67, v73
    v_mul_f32 v85, v67, v72
    v_fma_f32 v72, v66, v72, -v84
    v_fma_f32 v73, -v66, v73, -v85
    v_mfma_f32_16x16x4_f32 v[48:51], v68, v74, v[48:51]
    v_mfma_f32_16x16x4_f32 v[52:55], v70, v76, v[52:55]
    v_mfma_f32_16x16x4_f32 v[56:59], v70, v78, v[56:59]
    v_mfma_f32_16x16x4_f32 v[60:63], v72, v80, v[60:63]
    v_mfma_f32_16x16x4_f32 v[48:51], v69, v75, v[48:51]
    v_mfma_f32_16x16x4_f32 v[52:55], v71, v77, v[52:55]
    v_mfma_f32_16x16x4_f32 v[56:59], v71, v79, v[56:59]
    v_mfma_f32_16x16x4_f32 v[60:63], v73, v81, v[60:63]
    v_mov_b32_dpp v64, v28 row_newbcast:9 row_mask:0xf bank_mask:0xf
    v_mov_b32_dpp v65, v29 row_newbcast:9 row_mask:0xf bank_mask:0xf
    v_mov_b32_dpp v66, v30 row_newbcast:9 row_mask:0xf bank_mask:0xf
    v_mov_b32_dpp v67, v31 row_newbcast:9 row_mask:0xf bank_mask:0xf
    v_mul_f32 v82, v64, v47
    v_mul_f32 v83, v65, v47
    v_exp_f32 v82, v82
    v_fract_f32 v83, v83
    v_cos_f32 v74, v83
    v_sin_f32 v75, v83
    v_mul_f32 v74, v74, v82
    v_mul_f32 v75, v75, v82
    v_mul_f32 v84, v75, v75
    v_add_f32 v85, v74, v74
    v_fma_f32 v76, v74, v74, -v84
    v_mul_f32 v77, v85, v75
    v_mul_f32 v84, v77, v77
    v_add_f32 v85, v76, v76
    v_fma_f32 v78, v76, v76, -v84
    v_mul_f32 v79, v85, v77
    v_mul_f32 v84, v79, v79
    v_add_f32 v85, v78, v78
    v_fma_f32 v80, v78, v78, -v84
    v_mul_f32 v81, v85, v79
    v_mul_f32 v82, v64, v44
    v_mul_f32 v83, v65, v44
    v_exp_f32 v82, v82
    v_fract_f32 v83, v83
    v_cos_f32 v68, v83
    v_sin_f32 v69, v83
    v_mul_f32 v68, v68, v82
    v_mul_f32 v69, v69, v82
    v_mul_f32 v84, v67, v69
    v_mul_f32 v85, v67, v68
    v_fma_f32 v68, v66, v68, -v84
    v_fma_f32 v69, -v66, v69, -v85
    v_mul_f32 v82, v64, v45
    v_mul_f32 v83, v65, v45
    v_exp_f32 v82, v82
    v_fract_f32 v83, v83
    v_cos_f32 v70, v83
    v_sin_f32 v71, v83
    v_mul_f32 v70, v70, v82
    v_mul_f32 v71, v71, v82
    v_mul_f32 v84, v67, v71
    v_mul_f32 v85, v67, v70
    v_fma_f32 v70, v66, v70, -v84
    v_fma_f32 v71, -v66, v71, -v85
    v_mul_f32 v82, v64, v46
    v_mul_f32 v83, v65, v46
    v_exp_f32 v82, v82
    v_fract_f32 v83, v83
    v_cos_f32 v72, v83
    v_sin_f32 v73, v83
    v_mul_f32 v72, v72, v82
    v_mul_f32 v73, v73, v82
    v_mul_f32 v84, v67, v73
    v_mul_f32 v85, v67, v72
    v_fma_f32 v72, v66, v72, -v84
    v_fma_f32 v73, -v66, v73, -v85
    v_mfma_f32_16x16x4_f32 v[48:51], v68, v74, v[48:51]
    v_mfma_f32_16x16x4_f32 v[52:55], v70, v76, v[52:55]
    v_mfma_f32_16x16x4_f32 v[56:59], v70, v78, v[56:59]
    v_mfma_f32_16x16x4_f32 v[60:63], v72, v80, v[60:63]
    v_mfma_f32_16x16x4_f32 v[48:51], v69, v75, v[48:51]
    v_mfma_f32_16x16x4_f32 v[52:55], v71, v77, v[52:55]
    v_mfma_f32_16x16x4_f32 v[56:59], v71, v79, v[56:59]
    v_mfma_f32_16x16x4_f32 v[60:63], v73, v81, v[60:63]
    v_mov_b32_dpp v64, v28 row_newbcast:10 row_mask:0xf bank_mask:0xf
    v_mov_b32_dpp v65, v29 row_newbcast:10 row_mask:0xf bank_mask:0xf
    v_mov_b32_dpp v66, v30 row_newbcast:10 row_mask:0xf bank_mask:0xf
    v_mov_b32_dpp v67, v31 row_newbcast:10 row_mask:0xf bank_mask:0xf
    v_mul_f32 v82, v64, v47
    v_mul_f32 v83, v65, v47
    v_exp_f32 v82, v82
    v_fract_f32 v83, v83
    v_cos_f32 v74, v83
    v_sin_f32 v75, v83
    v_mul_f32 v74, v74, v82
    v_mul_f32 v75, v75, v82
    v_mul_f32 v84, v75, v75
    v_add_f32 v85, v74, v74
    v_fma_f32 v76, v74, v74, -v84
    v_mul_f32 v77, v85, v75
    v_mul_f32 v84, v77, v77
    v_add_f32 v85, v76, v76
    v_fma_f32 v78, v76, v76, -v84
    v_mul_f32 v79, v85, v77
    v_mul_f32 v84, v79, v79
    v_add_f32 v85, v78, v78
    v_fma_f32 v80, v78, v78, -v84
    v_mul_f32 v81, v85, v79
    v_mul_f32 v82, v64, v44
    v_mul_f32 v83, v65, v44
    v_exp_f32 v82, v82
    v_fract_f32 v83, v83
    v_cos_f32 v68, v83
    v_sin_f32 v69, v83
    v_mul_f32 v68, v68, v82
    v_mul_f32 v69, v69, v82
    v_mul_f32 v84, v67, v69
    v_mul_f32 v85, v67, v68
    v_fma_f32 v68, v66, v68, -v84
    v_fma_f32 v69, -v66, v69, -v85
    v_mul_f32 v82, v64, v45
    v_mul_f32 v83, v65, v45
    v_exp_f32 v82, v82
    v_fract_f32 v83, v83
    v_cos_f32 v70, v83
    v_sin_f32 v71, v83
    v_mul_f32 v70, v70, v82
    v_mul_f32 v71, v71, v82
    v_mul_f32 v84, v67, v71
    v_mul_f32 v85, v67, v70
    v_fma_f32 v70, v66, v70, -v84
    v_fma_f32 v71, -v66, v71, -v85
    v_mul_f32 v82, v64, v46
    v_mul_f32 v83, v65, v46
    v_exp_f32 v82, v82
    v_fract_f32 v83, v83
    v_cos_f32 v72, v83
    v_sin_f32 v73, v83
    v_mul_f32 v72, v72, v82
    v_mul_f32 v73, v73, v82
    v_mul_f32 v84, v67, v73
    v_mul_f32 v85, v67, v72
    v_fma_f32 v72, v66, v72, -v84
    v_fma_f32 v73, -v66, v73, -v85
    v_mfma_f32_16x16x4_f32 v[48:51], v68, v74, v[48:51]
    v_mfma_f32_16x16x4_f32 v[52:55], v70, v76, v[52:55]
    v_mfma_f32_16x16x4_f32 v[56:59], v70, v78, v[56:59]
    v_mfma_f32_16x16x4_f32 v[60:63], v72, v80, v[60:63]
    v_mfma_f32_16x16x4_f32 v[48:51], v69, v75, v[48:51]
    v_mfma_f32_16x16x4_f32 v[52:55], v71, v77, v[52:55]
    v_mfma_f32_16x16x4_f32 v[56:59], v71, v79, v[56:59]
    v_mfma_f32_16x16x4_f32 v[60:63], v73, v81, v[60:63]
    v_mov_b32_dpp v64, v28 row_newbcast:11 row_mask:0xf bank_mask:0xf
    v_mov_b32_dpp v65, v29 row_newbcast:11 row_mask:0xf bank_mask:0xf
    v_mov_b32_dpp v66, v30 row_newbcast:11 row_mask:0xf bank_mask:0xf
    v_mov_b32_dpp v67, v31 row_newbcast:11 row_mask:0xf bank_mask:0xf
    v_mul_f32 v82, v64, v47
    v_mul_f32 v83, v65, v47
    v_exp_f32 v82, v82
    v_fract_f32 v83, v83
    v_cos_f32 v74, v83
    v_sin_f32 v75, v83
    v_mul_f32 v74, v74, v82
    v_mul_f32 v75, v75, v82
    v_mul_f32 v84, v75, v75
    v_add_f32 v85, v74, v74
    v_fma_f32 v76, v74, v74, -v84
    v_mul_f32 v77, v85, v75
    v_mul_f32 v84, v77, v77
    v_add_f32 v85, v76, v76
    v_fma_f32 v78, v76, v76, -v84
    v_mul_f32 v79, v85, v77
    v_mul_f32 v84, v79, v79
    v_add_f32 v85, v78, v78
    v_fma_f32 v80, v78, v78, -v84
    v_mul_f32 v81, v85, v79
    v_mul_f32 v82, v64, v44
    v_mul_f32 v83, v65, v44
    v_exp_f32 v82, v82
    v_fract_f32 v83, v83
    v_cos_f32 v68, v83
    v_sin_f32 v69, v83
    v_mul_f32 v68, v68, v82
    v_mul_f32 v69, v69, v82
    v_mul_f32 v84, v67, v69
    v_mul_f32 v85, v67, v68
    v_fma_f32 v68, v66, v68, -v84
    v_fma_f32 v69, -v66, v69, -v85
    v_mul_f32 v82, v64, v45
    v_mul_f32 v83, v65, v45
    v_exp_f32 v82, v82
    v_fract_f32 v83, v83
    v_cos_f32 v70, v83
    v_sin_f32 v71, v83
    v_mul_f32 v70, v70, v82
    v_mul_f32 v71, v71, v82
    v_mul_f32 v84, v67, v71
    v_mul_f32 v85, v67, v70
    v_fma_f32 v70, v66, v70, -v84
    v_fma_f32 v71, -v66, v71, -v85
    v_mul_f32 v82, v64, v46
    v_mul_f32 v83, v65, v46
    v_exp_f32 v82, v82
    v_fract_f32 v83, v83
    v_cos_f32 v72, v83
    v_sin_f32 v73, v83
    v_mul_f32 v72, v72, v82
    v_mul_f32 v73, v73, v82
    v_mul_f32 v84, v67, v73
    v_mul_f32 v85, v67, v72
    v_fma_f32 v72, v66, v72, -v84
    v_fma_f32 v73, -v66, v73, -v85
    v_mfma_f32_16x16x4_f32 v[48:51], v68, v74, v[48:51]
    v_mfma_f32_16x16x4_f32 v[52:55], v70, v76, v[52:55]
    v_mfma_f32_16x16x4_f32 v[56:59], v70, v78, v[56:59]
    v_mfma_f32_16x16x4_f32 v[60:63], v72, v80, v[60:63]
    v_mfma_f32_16x16x4_f32 v[48:51], v69, v75, v[48:51]
    v_mfma_f32_16x16x4_f32 v[52:55], v71, v77, v[52:55]
    v_mfma_f32_16x16x4_f32 v[56:59], v71, v79, v[56:59]
    v_mfma_f32_16x16x4_f32 v[60:63], v73, v81, v[60:63]
    v_mov_b32_dpp v64, v28 row_newbcast:12 row_mask:0xf bank_mask:0xf
    v_mov_b32_dpp v65, v29 row_newbcast:12 row_mask:0xf bank_mask:0xf
    v_mov_b32_dpp v66, v30 row_newbcast:12 row_mask:0xf bank_mask:0xf
    v_mov_b32_dpp v67, v31 row_newbcast:12 row_mask:0xf bank_mask:0xf
    v_mul_f32 v82, v64, v47
    v_mul_f32 v83, v65, v47
    v_exp_f32 v82, v82
    v_fract_f32 v83, v83
    v_cos_f32 v74, v83
    v_sin_f32 v75, v83
    v_mul_f32 v74, v74, v82
    v_mul_f32 v75, v75, v82
    v_mul_f32 v84, v75, v75
    v_add_f32 v85, v74, v74
    v_fma_f32 v76, v74, v74, -v84
    v_mul_f32 v77, v85, v75
    v_mul_f32 v84, v77, v77
    v_add_f32 v85, v76, v76
    v_fma_f32 v78, v76, v76, -v84
    v_mul_f32 v79, v85, v77
    v_mul_f32 v84, v79, v79
    v_add_f32 v85, v78, v78
    v_fma_f32 v80, v78, v78, -v84
    v_mul_f32 v81, v85, v79
    v_mul_f32 v82, v64, v44
    v_mul_f32 v83, v65, v44
    v_exp_f32 v82, v82
    v_fract_f32 v83, v83
    v_cos_f32 v68, v83
    v_sin_f32 v69, v83
    v_mul_f32 v68, v68, v82
    v_mul_f32 v69, v69, v82
    v_mul_f32 v84, v67, v69
    v_mul_f32 v85, v67, v68
    v_fma_f32 v68, v66, v68, -v84
    v_fma_f32 v69, -v66, v69, -v85
    v_mul_f32 v82, v64, v45
    v_mul_f32 v83, v65, v45
    v_exp_f32 v82, v82
    v_fract_f32 v83, v83
    v_cos_f32 v70, v83
    v_sin_f32 v71, v83
    v_mul_f32 v70, v70, v82
    v_mul_f32 v71, v71, v82
    v_mul_f32 v84, v67, v71
    v_mul_f32 v85, v67, v70
    v_fma_f32 v70, v66, v70, -v84
    v_fma_f32 v71, -v66, v71, -v85
    v_mul_f32 v82, v64, v46
    v_mul_f32 v83, v65, v46
    v_exp_f32 v82, v82
    v_fract_f32 v83, v83
    v_cos_f32 v72, v83
    v_sin_f32 v73, v83
    v_mul_f32 v72, v72, v82
    v_mul_f32 v73, v73, v82
    v_mul_f32 v84, v67, v73
    v_mul_f32 v85, v67, v72
    v_fma_f32 v72, v66, v72, -v84
    v_fma_f32 v73, -v66, v73, -v85
    v_mfma_f32_16x16x4_f32 v[48:51], v68, v74, v[48:51]
    v_mfma_f32_16x16x4_f32 v[52:55], v70, v76, v[52:55]
    v_mfma_f32_16x16x4_f32 v[56:59], v70, v78, v[56:59]
    v_mfma_f32_16x16x4_f32 v[60:63], v72, v80, v[60:63]
    v_mfma_f32_16x16x4_f32 v[48:51], v69, v75, v[48:51]
    v_mfma_f32_16x16x4_f32 v[52:55], v71, v77, v[52:55]
    v_mfma_f32_16x16x4_f32 v[56:59], v71, v79, v[56:59]
    v_mfma_f32_16x16x4_f32 v[60:63], v73, v81, v[60:63]
    v_mov_b32_dpp v64, v28 row_newbcast:13 row_mask:0xf bank_mask:0xf
    v_mov_b32_dpp v65, v29 row_newbcast:13 row_mask:0xf bank_mask:0xf
    v_mov_b32_dpp v66, v30 row_newbcast:13 row_mask:0xf bank_mask:0xf
    v_mov_b32_dpp v67, v31 row_newbcast:13 row_mask:0xf bank_mask:0xf
    v_mul_f32 v82, v64, v47
    v_mul_f32 v83, v65, v47
    v_exp_f32 v82, v82
    v_fract_f32 v83, v83
    v_cos_f32 v74, v83
    v_sin_f32 v75, v83
    v_mul_f32 v74, v74, v82
    v_mul_f32 v75, v75, v82
    v_mul_f32 v84, v75, v75
    v_add_f32 v85, v74, v74
    v_fma_f32 v76, v74, v74, -v84
    v_mul_f32 v77, v85, v75
    v_mul_f32 v84, v77, v77
    v_add_f32 v85, v76, v76
    v_fma_f32 v78, v76, v76, -v84
    v_mul_f32 v79, v85, v77
    v_mul_f32 v84, v79, v79
    v_add_f32 v85, v78, v78
    v_fma_f32 v80, v78, v78, -v84
    v_mul_f32 v81, v85, v79
    v_mul_f32 v82, v64, v44
    v_mul_f32 v83, v65, v44
    v_exp_f32 v82, v82
    v_fract_f32 v83, v83
    v_cos_f32 v68, v83
    v_sin_f32 v69, v83
    v_mul_f32 v68, v68, v82
    v_mul_f32 v69, v69, v82
    v_mul_f32 v84, v67, v69
    v_mul_f32 v85, v67, v68
    v_fma_f32 v68, v66, v68, -v84
    v_fma_f32 v69, -v66, v69, -v85
    v_mul_f32 v82, v64, v45
    v_mul_f32 v83, v65, v45
    v_exp_f32 v82, v82
    v_fract_f32 v83, v83
    v_cos_f32 v70, v83
    v_sin_f32 v71, v83
    v_mul_f32 v70, v70, v82
    v_mul_f32 v71, v71, v82
    v_mul_f32 v84, v67, v71
    v_mul_f32 v85, v67, v70
    v_fma_f32 v70, v66, v70, -v84
    v_fma_f32 v71, -v66, v71, -v85
    v_mul_f32 v82, v64, v46
    v_mul_f32 v83, v65, v46
    v_exp_f32 v82, v82
    v_fract_f32 v83, v83
    v_cos_f32 v72, v83
    v_sin_f32 v73, v83
    v_mul_f32 v72, v72, v82
    v_mul_f32 v73, v73, v82
    v_mul_f32 v84, v67, v73
    v_mul_f32 v85, v67, v72
    v_fma_f32 v72, v66, v72, -v84
    v_fma_f32 v73, -v66, v73, -v85
    v_mfma_f32_16x16x4_f32 v[48:51], v68, v74, v[48:51]
    v_mfma_f32_16x16x4_f32 v[52:55], v70, v76, v[52:55]
    v_mfma_f32_16x16x4_f32 v[56:59], v70, v78, v[56:59]
    v_mfma_f32_16x16x4_f32 v[60:63], v72, v80, v[60:63]
    v_mfma_f32_16x16x4_f32 v[48:51], v69, v75, v[48:51]
    v_mfma_f32_16x16x4_f32 v[52:55], v71, v77, v[52:55]
    v_mfma_f32_16x16x4_f32 v[56:59], v71, v79, v[56:59]
    v_mfma_f32_16x16x4_f32 v[60:63], v73, v81, v[60:63]
    v_mov_b32_dpp v64, v28 row_newbcast:14 row_mask:0xf bank_mask:0xf
    v_mov_b32_dpp v65, v29 row_newbcast:14 row_mask:0xf bank_mask:0xf
    v_mov_b32_dpp v66, v30 row_newbcast:14 row_mask:0xf bank_mask:0xf
    v_mov_b32_dpp v67, v31 row_newbcast:14 row_mask:0xf bank_mask:0xf
    v_mul_f32 v82, v64, v47
    v_mul_f32 v83, v65, v47
    v_exp_f32 v82, v82
    v_fract_f32 v83, v83
    v_cos_f32 v74, v83
    v_sin_f32 v75, v83
    v_mul_f32 v74, v74, v82
    v_mul_f32 v75, v75, v82
    v_mul_f32 v84, v75, v75
    v_add_f32 v85, v74, v74
    v_fma_f32 v76, v74, v74, -v84
    v_mul_f32 v77, v85, v75
    v_mul_f32 v84, v77, v77
    v_add_f32 v85, v76, v76
    v_fma_f32 v78, v76, v76, -v84
    v_mul_f32 v79, v85, v77
    v_mul_f32 v84, v79, v79
    v_add_f32 v85, v78, v78
    v_fma_f32 v80, v78, v78, -v84
    v_mul_f32 v81, v85, v79
    v_mul_f32 v82, v64, v44
    v_mul_f32 v83, v65, v44
    v_exp_f32 v82, v82
    v_fract_f32 v83, v83
    v_cos_f32 v68, v83
    v_sin_f32 v69, v83
    v_mul_f32 v68, v68, v82
    v_mul_f32 v69, v69, v82
    v_mul_f32 v84, v67, v69
    v_mul_f32 v85, v67, v68
    v_fma_f32 v68, v66, v68, -v84
    v_fma_f32 v69, -v66, v69, -v85
    v_mul_f32 v82, v64, v45
    v_mul_f32 v83, v65, v45
    v_exp_f32 v82, v82
    v_fract_f32 v83, v83
    v_cos_f32 v70, v83
    v_sin_f32 v71, v83
    v_mul_f32 v70, v70, v82
    v_mul_f32 v71, v71, v82
    v_mul_f32 v84, v67, v71
    v_mul_f32 v85, v67, v70
    v_fma_f32 v70, v66, v70, -v84
    v_fma_f32 v71, -v66, v71, -v85
    v_mul_f32 v82, v64, v46
    v_mul_f32 v83, v65, v46
    v_exp_f32 v82, v82
    v_fract_f32 v83, v83
    v_cos_f32 v72, v83
    v_sin_f32 v73, v83
    v_mul_f32 v72, v72, v82
    v_mul_f32 v73, v73, v82
    v_mul_f32 v84, v67, v73
    v_mul_f32 v85, v67, v72
    v_fma_f32 v72, v66, v72, -v84
    v_fma_f32 v73, -v66, v73, -v85
    v_mfma_f32_16x16x4_f32 v[48:51], v68, v74, v[48:51]
    v_mfma_f32_16x16x4_f32 v[52:55], v70, v76, v[52:55]
    v_mfma_f32_16x16x4_f32 v[56:59], v70, v78, v[56:59]
    v_mfma_f32_16x16x4_f32 v[60:63], v72, v80, v[60:63]
    v_mfma_f32_16x16x4_f32 v[48:51], v69, v75, v[48:51]
    v_mfma_f32_16x16x4_f32 v[52:55], v71, v77, v[52:55]
    v_mfma_f32_16x16x4_f32 v[56:59], v71, v79, v[56:59]
    v_mfma_f32_16x16x4_f32 v[60:63], v73, v81, v[60:63]
    v_mov_b32_dpp v64, v28 row_newbcast:15 row_mask:0xf bank_mask:0xf
    v_mov_b32_dpp v65, v29 row_newbcast:15 row_mask:0xf bank_mask:0xf
    v_mov_b32_dpp v66, v30 row_newbcast:15 row_mask:0xf bank_mask:0xf
    v_mov_b32_dpp v67, v31 row_newbcast:15 row_mask:0xf bank_mask:0xf
    v_mul_f32 v82, v64, v47
    v_mul_f32 v83, v65, v47
    v_exp_f32 v82, v82
    v_fract_f32 v83, v83
    v_cos_f32 v74, v83
    v_sin_f32 v75, v83
    v_mul_f32 v74, v74, v82
    v_mul_f32 v75, v75, v82
    v_mul_f32 v84, v75, v75
    v_add_f32 v85, v74, v74
    v_fma_f32 v76, v74, v74, -v84
    v_mul_f32 v77, v85, v75
    v_mul_f32 v84, v77, v77
    v_add_f32 v85, v76, v76
    v_fma_f32 v78, v76, v76, -v84
    v_mul_f32 v79, v85, v77
    v_mul_f32 v84, v79, v79
    v_add_f32 v85, v78, v78
    v_fma_f32 v80, v78, v78, -v84
    v_mul_f32 v81, v85, v79
    v_mul_f32 v82, v64, v44
    v_mul_f32 v83, v65, v44
    v_exp_f32 v82, v82
    v_fract_f32 v83, v83
    v_cos_f32 v68, v83
    v_sin_f32 v69, v83
    v_mul_f32 v68, v68, v82
    v_mul_f32 v69, v69, v82
    v_mul_f32 v84, v67, v69
    v_mul_f32 v85, v67, v68
    v_fma_f32 v68, v66, v68, -v84
    v_fma_f32 v69, -v66, v69, -v85
    v_mul_f32 v82, v64, v45
    v_mul_f32 v83, v65, v45
    v_exp_f32 v82, v82
    v_fract_f32 v83, v83
    v_cos_f32 v70, v83
    v_sin_f32 v71, v83
    v_mul_f32 v70, v70, v82
    v_mul_f32 v71, v71, v82
    v_mul_f32 v84, v67, v71
    v_mul_f32 v85, v67, v70
    v_fma_f32 v70, v66, v70, -v84
    v_fma_f32 v71, -v66, v71, -v85
    v_mul_f32 v82, v64, v46
    v_mul_f32 v83, v65, v46
    v_exp_f32 v82, v82
    v_fract_f32 v83, v83
    v_cos_f32 v72, v83
    v_sin_f32 v73, v83
    v_mul_f32 v72, v72, v82
    v_mul_f32 v73, v73, v82
    v_mul_f32 v84, v67, v73
    v_mul_f32 v85, v67, v72
    v_fma_f32 v72, v66, v72, -v84
    v_fma_f32 v73, -v66, v73, -v85
    v_mfma_f32_16x16x4_f32 v[48:51], v68, v74, v[48:51]
    v_mfma_f32_16x16x4_f32 v[52:55], v70, v76, v[52:55]
    v_mfma_f32_16x16x4_f32 v[56:59], v70, v78, v[56:59]
    v_mfma_f32_16x16x4_f32 v[60:63], v72, v80, v[60:63]
    v_mfma_f32_16x16x4_f32 v[48:51], v69, v75, v[48:51]
    v_mfma_f32_16x16x4_f32 v[52:55], v71, v77, v[52:55]
    v_mfma_f32_16x16x4_f32 v[56:59], v71, v79, v[56:59]
    v_mfma_f32_16x16x4_f32 v[60:63], v73, v81, v[60:63]
    v_lshlrev_b32 v5, 8, v3
    v_lshl_add_u32 v5, v2, 2, v5
    v_add_u32 v5, v5, v4
    s_nop 5
    ds_write_b32 v5, v48 offset:4608
    ds_write_b32 v5, v49 offset:4672
    ds_write_b32 v5, v50 offset:4736
    ds_write_b32 v5, v51 offset:4800
    v_cmp_gt_u32 vcc, 2, v3
    s_nop 0
    s_mov_b64 exec, vcc
    ds_write_b32 v5, v52 offset:5632
    ds_write_b32 v5, v53 offset:5696
    ds_write_b32 v5, v54 offset:5760
    ds_write_b32 v5, v55 offset:5824
    ds_write_b32 v5, v60 offset:6656
    ds_write_b32 v5, v61 offset:6720
    ds_write_b32 v5, v62 offset:6784
    ds_write_b32 v5, v63 offset:6848
    s_not_b64 exec, exec
    ds_write_b32 v5, v56 offset:5632
    ds_write_b32 v5, v57 offset:5696
    ds_write_b32 v5, v58 offset:5760
    ds_write_b32 v5, v59 offset:5824
    s_mov_b32 exec_lo, 0
    s_mov_b32 exec_hi, 3
    v_cmp_eq_u32 vcc, 0, v2
    s_nop 1
    v_cndmask_b32 v6, 0, v60, vcc
    ds_write_b32 v5, v6 offset:6656
    s_mov_b64 exec, -1
    s_waitcnt lgkmcnt(0)
    v_lshlrev_b32 v7, 1, v1
    v_sub_u32 v7, 2065, v7
    v_lshl_add_u32 v64, v1, 2, v4
    v_mov_b32 v65, 641
    s_mov_b32 s25, 17
ss_exp:
    v_subrev_u32 v66, 0, v7
    v_cvt_f32_u32 v70, v66
    v_cvt_pk_bf16_f32 v70, v70, v70
    v_and_b32 v70, 0xffff, v70
    v_subrev_u32 v70, 0x4280, v70
    v_cmp_gt_u32 vcc, 256, v66
    s_nop 1
    v_cndmask_b32 v70, v70, v66, vcc
    v_cmp_gt_u32 vcc, 2048, v66
    s_nop 1
    v_cndmask_b32 v70, v65, v70, vcc
    v_lshl_add_u32 v70, v70, 2, v4
    ds_read_b32 v74, v70 offset:4608
    v_subrev_u32 v67, 1, v7
    v_cvt_f32_u32 v71, v67
    v_cvt_pk_bf16_f32 v71, v71, v71
    v_and_b32 v71, 0xffff, v71
    v_subrev_u32 v71, 0x4280, v71
    v_cmp_gt_u32 vcc, 256, v67
    s_nop 1
    v_cndmask_b32 v71, v71, v67, vcc
    v_cmp_gt_u32 vcc, 2048, v67
    s_nop 1
    v_cndmask_b32 v71, v65, v71, vcc
    v_lshl_add_u32 v71, v71, 2, v4
    ds_read_b32 v75, v71 offset:4608
    v_subrev_u32 v68, 2, v7
    v_cvt_f32_u32 v72, v68
    v_cvt_pk_bf16_f32 v72, v72, v72
    v_and_b32 v72, 0xffff, v72
    v_subrev_u32 v72, 0x4280, v72
    v_cmp_gt_u32 vcc, 256, v68
    s_nop 1
    v_cndmask_b32 v72, v72, v68, vcc
    v_cmp_gt_u32 vcc, 2048, v68
    s_nop 1
    v_cndmask_b32 v72, v65, v72, vcc
    v_lshl_add_u32 v72, v72, 2, v4
    ds_read_b32 v76, v72 offset:4608
    s_waitcnt lgkmcnt(0)
    v_cvt_pk_bf16_f32 v78, v75, v76
    v_cvt_pk_bf16_f32 v79, v74, v75
    ds_write_b32 v64, v78 offset:7424
    ds_write_b32 v64, v79 offset:11776
    v_subrev_u32 v7, 128, v7
    v_add_u32 v64, 256, v64
    s_sub_u32 s25, s25, 1
    s_cmp_lg_u32 s25, 0
    s_cbranch_scc1 ss_exp
    s_waitcnt lgkmcnt(0)
    s_barrier
    v_and_b32 v5, 1, v2
    v_mul_u32_u24 v64, 4352, v5
    v_sub_u32 v5, v5, v2
    v_lshl_add_u32 v5, v3, 3, v5
    v_lshl_add_u32 v64, v5, 1, v64
    v_add_u32 v64, 11520, v64
    v_add_u32 v64, v64, v4
    v_lshlrev_b32 v65, 5, v2
    v_lshl_add_u32 v65, v3, 4, v65
    v_add_u32 v65, 480, v65
    v_add_u32 v65, v65, v4
    v_mov_b32 v96, 0
    v_mov_b32 v97, 0
    v_mov_b32 v98, 0
    v_mov_b32 v99, 0
    v_mov_b32 v100, 0
    v_mov_b32 v101, 0
    v_mov_b32 v102, 0
    v_mov_b32 v103, 0
    v_mov_b32 v104, 0
    v_mov_b32 v105, 0
    v_mov_b32 v106, 0
    v_mov_b32 v107, 0
    v_mov_b32 v108, 0
    v_mov_b32 v109, 0
    v_mov_b32 v110, 0
    v_mov_b32 v111, 0
    v_mov_b32 v112, 0
    v_mov_b32 v113, 0
    v_mov_b32 v114, 0
    v_mov_b32 v115, 0
    v_mov_b32 v116, 0
    v_mov_b32 v117, 0
    v_mov_b32 v118, 0
    v_mov_b32 v119, 0
    v_mov_b32 v120, 0
    v_mov_b32 v121, 0
    v_mov_b32 v122, 0
    v_mov_b32 v123, 0
    v_mov_b32 v124, 0
    v_mov_b32 v125, 0
    v_mov_b32 v126, 0
    v_mov_b32 v127, 0
    s_mov_b32 s25, 8
ss_cv0:
    ds_read2_b32 v[68:69], v64 offset0:0 offset1:1
    ds_read2_b32 v[70:71], v64 offset0:2 offset1:3
    ds_read_b128 v[128:131], v65 offset:0
    ds_read_b128 v[132:135], v65 offset:512
    ds_read_b128 v[136:139], v65 offset:1024
    ds_read_b128 v[140:143], v65 offset:1536
    ds_read_b128 v[144:147], v65 offset:2048
    ds_read_b128 v[148:151], v65 offset:2560
    ds_read_b128 v[152:155], v65 offset:3072
    ds_read_b128 v[156:159], v65 offset:3584
    v_subrev_u32 v64, 64, v64
    v_subrev_u32 v65, 64, v65
    s_waitcnt lgkmcnt(7)
    v_mfma_f32_16x16x32_bf16 v[96:99], v[68:71], v[128:131], v[96:99]
    s_waitcnt lgkmcnt(6)
    v_mfma_f32_16x16x32_bf16 v[100:103], v[68:71], v[132:135], v[100:103]
    s_waitcnt lgkmcnt(5)
    v_mfma_f32_16x16x32_bf16 v[104:107], v[68:71], v[136:139], v[104:107]
    s_waitcnt lgkmcnt(4)
    v_mfma_f32_16x16x32_bf16 v[108:111], v[68:71], v[140:143], v[108:111]
    s_waitcnt lgkmcnt(3)
    v_mfma_f32_16x16x32_bf16 v[112:115], v[68:71], v[144:147], v[112:115]
    s_waitcnt lgkmcnt(2)
    v_mfma_f32_16x16x32_bf16 v[116:119], v[68:71], v[148:151], v[116:119]
    s_waitcnt lgkmcnt(1)
    v_mfma_f32_16x16x32_bf16 v[120:123], v[68:71], v[152:155], v[120:123]
    s_waitcnt lgkmcnt(0)
    v_mfma_f32_16x16x32_bf16 v[124:127], v[68:71], v[156:159], v[124:127]
    s_sub_u32 s25, s25, 1
    s_cmp_lg_u32 s25, 0
    s_cbranch_scc1 ss_cv0
    v_add_u32 v65, 512, v65
    s_mov_b32 s25, 8
ss_cv1:
    ds_read2_b32 v[68:69], v64 offset0:0 offset1:1
    ds_read2_b32 v[70:71], v64 offset0:2 offset1:3
    ds_read_b128 v[132:135], v65 offset:0
    ds_read_b128 v[136:139], v65 offset:512
    ds_read_b128 v[140:143], v65 offset:1024
    ds_read_b128 v[144:147], v65 offset:1536
    ds_read_b128 v[148:151], v65 offset:2048
    ds_read_b128 v[152:155], v65 offset:2560
    ds_read_b128 v[156:159], v65 offset:3072
    v_subrev_u32 v64, 64, v64
    v_subrev_u32 v65, 64, v65
    s_waitcnt lgkmcnt(6)
    v_mfma_f32_16x16x32_bf16 v[100:103], v[68:71], v[132:135], v[100:103]
    s_waitcnt lgkmcnt(5)
    v_mfma_f32_16x16x32_bf16 v[104:107], v[68:71], v[136:139], v[104:107]
    s_waitcnt lgkmcnt(4)
    v_mfma_f32_16x16x32_bf16 v[108:111], v[68:71], v[140:143], v[108:111]
    s_waitcnt lgkmcnt(3)
    v_mfma_f32_16x16x32_bf16 v[112:115], v[68:71], v[144:147], v[112:115]
    s_waitcnt lgkmcnt(2)
    v_mfma_f32_16x16x32_bf16 v[116:119], v[68:71], v[148:151], v[116:119]
    s_waitcnt lgkmcnt(1)
    v_mfma_f32_16x16x32_bf16 v[120:123], v[68:71], v[152:155], v[120:123]
    s_waitcnt lgkmcnt(0)
    v_mfma_f32_16x16x32_bf16 v[124:127], v[68:71], v[156:159], v[124:127]
    s_sub_u32 s25, s25, 1
    s_cmp_lg_u32 s25, 0
    s_cbranch_scc1 ss_cv1
    v_add_u32 v65, 512, v65
    s_mov_b32 s25, 8
ss_cv2:
    ds_read2_b32 v[68:69], v64 offset0:0 offset1:1
    ds_read2_b32 v[70:71], v64 offset0:2 offset1:3
    ds_read_b128 v[136:139], v65 offset:0
    ds_read_b128 v[140:143], v65 offset:512
    ds_read_b128 v[144:147], v65 offset:1024
    ds_read_b128 v[148:151], v65 offset:1536
    ds_read_b128 v[152:155], v65 offset:2048
    ds_read_b128 v[156:159], v65 offset:2560
    v_subrev_u32 v64, 64, v64
    v_subrev_u32 v65, 64, v65
    s_waitcnt lgkmcnt(5)
    v_mfma_f32_16x16x32_bf16 v[104:107], v[68:71], v[136:139], v[104:107]
    s_waitcnt lgkmcnt(4)
    v_mfma_f32_16x16x32_bf16 v[108:111], v[68:71], v[140:143], v[108:111]
    s_waitcnt lgkmcnt(3)
    v_mfma_f32_16x16x32_bf16 v[112:115], v[68:71], v[144:147], v[112:115]
    s_waitcnt lgkmcnt(2)
    v_mfma_f32_16x16x32_bf16 v[116:119], v[68:71], v[148:151], v[116:119]
    s_waitcnt lgkmcnt(1)
    v_mfma_f32_16x16x32_bf16 v[120:123], v[68:71], v[152:155], v[120:123]
    s_waitcnt lgkmcnt(0)
    v_mfma_f32_16x16x32_bf16 v[124:127], v[68:71], v[156:159], v[124:127]
    s_sub_u32 s25, s25, 1
    s_cmp_lg_u32 s25, 0
    s_cbranch_scc1 ss_cv2
    v_add_u32 v65, 512, v65
    s_mov_b32 s25, 8
ss_cv3:
    ds_read2_b32 v[68:69], v64 offset0:0 offset1:1
    ds_read2_b32 v[70:71], v64 offset0:2 offset1:3
    ds_read_b128 v[140:143], v65 offset:0
    ds_read_b128 v[144:147], v65 offset:512
    ds_read_b128 v[148:151], v65 offset:1024
    ds_read_b128 v[152:155], v65 offset:1536
    ds_read_b128 v[156:159], v65 offset:2048
    v_subrev_u32 v64, 64, v64
    v_subrev_u32 v65, 64, v65
    s_waitcnt lgkmcnt(4)
    v_mfma_f32_16x16x32_bf16 v[108:111], v[68:71], v[140:143], v[108:111]
    s_waitcnt lgkmcnt(3)
    v_mfma_f32_16x16x32_bf16 v[112:115], v[68:71], v[144:147], v[112:115]
    s_waitcnt lgkmcnt(2)
    v_mfma_f32_16x16x32_bf16 v[116:119], v[68:71], v[148:151], v[116:119]
    s_waitcnt lgkmcnt(1)
    v_mfma_f32_16x16x32_bf16 v[120:123], v[68:71], v[152:155], v[120:123]
    s_waitcnt lgkmcnt(0)
    v_mfma_f32_16x16x32_bf16 v[124:127], v[68:71], v[156:159], v[124:127]
    s_sub_u32 s25, s25, 1
    s_cmp_lg_u32 s25, 0
    s_cbranch_scc1 ss_cv3
    v_add_u32 v65, 512, v65
    s_mov_b32 s25, 8
ss_cv4:
    ds_read2_b32 v[68:69], v64 offset0:0 offset1:1
    ds_read2_b32 v[70:71], v64 offset0:2 offset1:3
    ds_read_b128 v[144:147], v65 offset:0
    ds_read_b128 v[148:151], v65 offset:512
    ds_read_b128 v[152:155], v65 offset:1024
    ds_read_b128 v[156:159], v65 offset:1536
    v_subrev_u32 v64, 64, v64
    v_subrev_u32 v65, 64, v65
    s_waitcnt lgkmcnt(3)
    v_mfma_f32_16x16x32_bf16 v[112:115], v[68:71], v[144:147], v[112:115]
    s_waitcnt lgkmcnt(2)
    v_mfma_f32_16x16x32_bf16 v[116:119], v[68:71], v[148:151], v[116:119]
    s_waitcnt lgkmcnt(1)
    v_mfma_f32_16x16x32_bf16 v[120:123], v[68:71], v[152:155], v[120:123]
    s_waitcnt lgkmcnt(0)
    v_mfma_f32_16x16x32_bf16 v[124:127], v[68:71], v[156:159], v[124:127]
    s_sub_u32 s25, s25, 1
    s_cmp_lg_u32 s25, 0
    s_cbranch_scc1 ss_cv4
    v_add_u32 v65, 512, v65
    s_mov_b32 s25, 8
ss_cv5:
    ds_read2_b32 v[68:69], v64 offset0:0 offset1:1
    ds_read2_b32 v[70:71], v64 offset0:2 offset1:3
    ds_read_b128 v[148:151], v65 offset:0
    ds_read_b128 v[152:155], v65 offset:512
    ds_read_b128 v[156:159], v65 offset:1024
    v_subrev_u32 v64, 64, v64
    v_subrev_u32 v65, 64, v65
    s_waitcnt lgkmcnt(2)
    v_mfma_f32_16x16x32_bf16 v[116:119], v[68:71], v[148:151], v[116:119]
    s_waitcnt lgkmcnt(1)
    v_mfma_f32_16x16x32_bf16 v[120:123], v[68:71], v[152:155], v[120:123]
    s_waitcnt lgkmcnt(0)
    v_mfma_f32_16x16x32_bf16 v[124:127], v[68:71], v[156:159], v[124:127]
    s_sub_u32 s25, s25, 1
    s_cmp_lg_u32 s25, 0
    s_cbranch_scc1 ss_cv5
    v_add_u32 v65, 512, v65
    s_mov_b32 s25, 8
ss_cv6:
    ds_read2_b32 v[68:69], v64 offset0:0 offset1:1
    ds_read2_b32 v[70:71], v64 offset0:2 offset1:3
    ds_read_b128 v[152:155], v65 offset:0
    ds_read_b128 v[156:159], v65 offset:512
    v_subrev_u32 v64, 64, v64
    v_subrev_u32 v65, 64, v65
    s_waitcnt lgkmcnt(1)
    v_mfma_f32_16x16x32_bf16 v[120:123], v[68:71], v[152:155], v[120:123]
    s_waitcnt lgkmcnt(0)
    v_mfma_f32_16x16x32_bf16 v[124:127], v[68:71], v[156:159], v[124:127]
    s_sub_u32 s25, s25, 1
    s_cmp_lg_u32 s25, 0
    s_cbranch_scc1 ss_cv6
    v_add_u32 v65, 512, v65
    s_mov_b32 s25, 8
ss_cv7:
    ds_read2_b32 v[68:69], v64 offset0:0 offset1:1
    ds_read2_b32 v[70:71], v64 offset0:2 offset1:3
    ds_read_b128 v[156:159], v65 offset:0
    v_subrev_u32 v64, 64, v64
    v_subrev_u32 v65, 64, v65
    s_waitcnt lgkmcnt(0)
    v_mfma_f32_16x16x32_bf16 v[124:127], v[68:71], v[156:159], v[124:127]
    s_sub_u32 s25, s25, 1
    s_cmp_lg_u32 s25, 0
    s_cbranch_scc1 ss_cv7
    v_add_u32 v65, 512, v65
    s_nop 3
    v_lshlrev_b32 v5, 6, v2
    v_lshl_add_u32 v5, v3, 4, v5
    v_add_u32 v5, v5, v4
    ds_write_b128 v5, v[96:99] offset:7424
    ds_write_b128 v5, v[100:103] offset:8448
    ds_write_b128 v5, v[104:107] offset:9472
    ds_write_b128 v5, v[108:111] offset:10496
    ds_write_b128 v5, v[112:115] offset:11520
    ds_write_b128 v5, v[116:119] offset:12544
    ds_write_b128 v5, v[120:123] offset:13568
    ds_write_b128 v5, v[124:127] offset:14592
    s_mov_b32 s12, s74
    s_mov_b32 s13, s75
    s_mov_b32 s14, 1152
    s_mov_b32 s15, 0x20000
    s_lshl_b32 s23, s20, 1
    buffer_load_dwordx2 v[24:25], off, s[12:15], s23
    s_waitcnt vmcnt(0) lgkmcnt(0)
    s_barrier
    v_lshlrev_b32 v26, 16, v24
    v_and_b32 v27, 0xffff0000, v24
    v_lshlrev_b32 v28, 16, v25
    v_and_b32 v29, 0xffff0000, v25
    v_lshlrev_b32 v5, 5, v0
    ds_read_b128 v[64:67], v5 offset:7424
    ds_read_b128 v[68:71], v5 offset:7440
    ds_read_b128 v[72:75], v5 offset:23808
    ds_read_b128 v[76:79], v5 offset:23824
    ds_read_b128 v[80:83], v5 offset:40192
    ds_read_b128 v[84:87], v5 offset:40208
    ds_read_b128 v[88:91], v5 offset:56576
    ds_read_b128 v[92:95], v5 offset:56592
    s_waitcnt lgkmcnt(0)
    v_mul_u32_u24 v5, 18432, v0
    s_lshl_b32 s22, s20, 1
    s_add_u32 s22, s22, 1152
    v_lshlrev_b32 v6, 16, v8
    v_fmac_f32 v64, v6, v26
    v_and_b32 v6, 0xffff0000, v8
    v_fmac_f32 v72, v6, v27
    v_lshlrev_b32 v6, 16, v9
    v_fmac_f32 v80, v6, v28
    v_and_b32 v6, 0xffff0000, v9
    v_fmac_f32 v88, v6, v29
    v_cvt_pk_bf16_f32 v8, v64, v72
    v_cvt_pk_bf16_f32 v9, v80, v88
    s_add_u32 s23, s22, 0
    buffer_store_dwordx2 v[8:9], v5, s[16:19], s23 offen
    v_lshlrev_b32 v6, 16, v10
    v_fmac_f32 v65, v6, v26
    v_and_b32 v6, 0xffff0000, v10
    v_fmac_f32 v73, v6, v27
    v_lshlrev_b32 v6, 16, v11
    v_fmac_f32 v81, v6, v28
    v_and_b32 v6, 0xffff0000, v11
    v_fmac_f32 v89, v6, v29
    v_cvt_pk_bf16_f32 v10, v65, v73
    v_cvt_pk_bf16_f32 v11, v81, v89
    s_add_u32 s23, s22, 2304
    buffer_store_dwordx2 v[10:11], v5, s[16:19], s23 offen
    v_lshlrev_b32 v6, 16, v12
    v_fmac_f32 v66, v6, v26
    v_and_b32 v6, 0xffff0000, v12
    v_fmac_f32 v74, v6, v27
    v_lshlrev_b32 v6, 16, v13
    v_fmac_f32 v82, v6, v28
    v_and_b32 v6, 0xffff0000, v13
    v_fmac_f32 v90, v6, v29
    v_cvt_pk_bf16_f32 v12, v66, v74
    v_cvt_pk_bf16_f32 v13, v82, v90
    s_add_u32 s23, s22, 4608
    buffer_store_dwordx2 v[12:13], v5, s[16:19], s23 offen
    v_lshlrev_b32 v6, 16, v14
    v_fmac_f32 v67, v6, v26
    v_and_b32 v6, 0xffff0000, v14
    v_fmac_f32 v75, v6, v27
    v_lshlrev_b32 v6, 16, v15
    v_fmac_f32 v83, v6, v28
    v_and_b32 v6, 0xffff0000, v15
    v_fmac_f32 v91, v6, v29
    v_cvt_pk_bf16_f32 v14, v67, v75
    v_cvt_pk_bf16_f32 v15, v83, v91
    s_add_u32 s23, s22, 6912
    buffer_store_dwordx2 v[14:15], v5, s[16:19], s23 offen
    v_lshlrev_b32 v6, 16, v16
    v_fmac_f32 v68, v6, v26
    v_and_b32 v6, 0xffff0000, v16
    v_fmac_f32 v76, v6, v27
    v_lshlrev_b32 v6, 16, v17
    v_fmac_f32 v84, v6, v28
    v_and_b32 v6, 0xffff0000, v17
    v_fmac_f32 v92, v6, v29
    v_cvt_pk_bf16_f32 v16, v68, v76
    v_cvt_pk_bf16_f32 v17, v84, v92
    s_add_u32 s23, s22, 9216
    buffer_store_dwordx2 v[16:17], v5, s[16:19], s23 offen
    v_lshlrev_b32 v6, 16, v18
    v_fmac_f32 v69, v6, v26
    v_and_b32 v6, 0xffff0000, v18
    v_fmac_f32 v77, v6, v27
    v_lshlrev_b32 v6, 16, v19
    v_fmac_f32 v85, v6, v28
    v_and_b32 v6, 0xffff0000, v19
    v_fmac_f32 v93, v6, v29
    v_cvt_pk_bf16_f32 v18, v69, v77
    v_cvt_pk_bf16_f32 v19, v85, v93
    s_add_u32 s23, s22, 11520
    buffer_store_dwordx2 v[18:19], v5, s[16:19], s23 offen
    v_lshlrev_b32 v6, 16, v20
    v_fmac_f32 v70, v6, v26
    v_and_b32 v6, 0xffff0000, v20
    v_fmac_f32 v78, v6, v27
    v_lshlrev_b32 v6, 16, v21
    v_fmac_f32 v86, v6, v28
    v_and_b32 v6, 0xffff0000, v21
    v_fmac_f32 v94, v6, v29
    v_cvt_pk_bf16_f32 v20, v70, v78
    v_cvt_pk_bf16_f32 v21, v86, v94
    s_add_u32 s23, s22, 13824
    buffer_store_dwordx2 v[20:21], v5, s[16:19], s23 offen
    v_lshlrev_b32 v6, 16, v22
    v_fmac_f32 v71, v6, v26
    v_and_b32 v6, 0xffff0000, v22
    v_fmac_f32 v79, v6, v27
    v_lshlrev_b32 v6, 16, v23
    v_fmac_f32 v87, v6, v28
    v_and_b32 v6, 0xffff0000, v23
    v_fmac_f32 v95, v6, v29
    v_cvt_pk_bf16_f32 v22, v71, v79
    v_cvt_pk_bf16_f32 v23, v87, v95
    s_add_u32 s23, s22, 16128
    buffer_store_dwordx2 v[22:23], v5, s[16:19], s23 offen
    s_branch L_ssm_next
L_wf_next:
    s_mov_b32 s37, 20
    v_mov_b32 v250, 1
    v_mov_b32 v251, 163832
    v_cmp_eq_u32 vcc, 0, v0
    s_nop 0
    s_and_saveexec_b64 s[38:39], vcc
    s_cbranch_execz tk41
    buffer_atomic_add v250, off, s[84:87], s37 sc0
    s_waitcnt vmcnt(0)
    ds_write_b32 v251, v250
    s_waitcnt lgkmcnt(0)
tk41:
    s_mov_b64 exec, -1
    s_barrier
    ds_read_b32 v252, v251
    s_waitcnt lgkmcnt(0)
    v_readfirstlane_b32 s33, v252
    s_barrier
    s_nop 3
    s_cmp_ge_u32 s33, 160
    s_cbranch_scc1 L_phase2
    s_lshl_b32 s16, s33, 2
    s_add_u32 s16, s16, s32
    s_add_u32 s16, s16, 1504
    s_call_b64 s[46:47], L_xform
    s_lshl_b32 s40, s33, 2
    s_add_u32 s40, s40, 125841408
    s_waitcnt vmcnt(0)
    s_barrier
    v_mov_b32 v250, s95
    v_cmp_eq_u32 vcc, 0, v0
    s_nop 0
    s_and_saveexec_b64 s[38:39], vcc
    s_cbranch_execz fs42
    buffer_store_dword v250, off, s[4:7], s40 sc1
fs42:
    s_mov_b64 exec, -1
    s_branch L_wf_next
L_phase2:
    s_mov_b32 s40, 524288
mc2_w:
    buffer_load_dword v250, off, s[84:87], 0 offset:28 sc1
    s_waitcnt vmcnt(0)
    v_readfirstlane_b32 s41, v250
    s_nop 0
    s_cmp_lg_u32 s41, 0
    s_cbranch_scc1 mc2_known
    s_sub_u32 s40, s40, 1
    s_cbranch_scc1 mc2_force
    s_sleep 2
    s_branch mc2_w
mc2_force:
    v_mov_b32 v250, 2
    v_mov_b32 v251, 0
    s_mov_b64 exec, 1
    buffer_atomic_cmpswap v[250:251], off, s[84:87], 0 offset:28
    s_mov_b64 exec, -1
    s_waitcnt vmcnt(0)
    s_mov_b32 s40, 524288
    s_branch mc2_w
mc2_known:
    s_cmp_eq_u32 s41, 1
    s_cbranch_scc1 L_phase2b
    s_mov_b32 s37, 208
    v_mov_b32 v250, 1
    v_mov_b32 v251, 163832
    v_cmp_eq_u32 vcc, 0, v0
    s_nop 0
    s_and_saveexec_b64 s[38:39], vcc
    s_cbranch_execz tk43
    buffer_atomic_add v250, off, s[84:87], s37 sc0
    s_waitcnt vmcnt(0)
    ds_write_b32 v251, v250
    s_waitcnt lgkmcnt(0)
tk43:
    s_mov_b64 exec, -1
    s_barrier
    ds_read_b32 v252, v251
    s_waitcnt lgkmcnt(0)
    v_readfirstlane_b32 s12, v252
    s_barrier
    s_nop 3
    s_cmp_lt_u32 s12, 32
    s_cbranch_scc1 L_chain_safe
L_phase2b:
    s_mov_b32 s8, s76
    s_mov_b32 s9, s77
    s_mov_b32 s10, 4718592
    s_mov_b32 s11, 0x20000
    s_mov_b32 s37, 12
    v_mov_b32 v250, 1
    v_mov_b32 v251, 163832
    v_cmp_eq_u32 vcc, 0, v0
    s_nop 0
    s_and_saveexec_b64 s[38:39], vcc
    s_cbranch_execz tk44
    buffer_atomic_add v250, off, s[84:87], s37 sc0
    s_waitcnt vmcnt(0)
    ds_write_b32 v251, v250
    s_waitcnt lgkmcnt(0)
tk44:
    s_mov_b64 exec, -1
    s_barrier
    ds_read_b32 v252, v251
    s_waitcnt lgkmcnt(0)
    v_readfirstlane_b32 s36, v252
    s_barrier
    s_nop 3
    s_mul_hi_u32 s37, s36, 0x55555556
    s_mul_i32 s40, s37, 3
    s_sub_u32 s33, s36, s37
    s_mul_hi_u32 s41, s33, 0x0e38e38f
    s_mul_i32 s41, s41, 18
    s_sub_u32 s33, s33, s41
    s_cmp_lg_u32 s40, s36
    s_cbranch_scc1 L_op_start
L_att_next:
    s_mov_b32 s37, 16
    v_mov_b32 v250, 1
    v_mov_b32 v251, 163832
    v_cmp_eq_u32 vcc, 0, v0
    s_nop 0
    s_and_saveexec_b64 s[38:39], vcc
    s_cbranch_execz tk45
    buffer_atomic_add v250, off, s[84:87], s37 sc0
    s_waitcnt vmcnt(0)
    ds_write_b32 v251, v250
    s_waitcnt lgkmcnt(0)
tk45:
    s_mov_b64 exec, -1
    s_barrier
    ds_read_b32 v252, v251
    s_waitcnt lgkmcnt(0)
    v_readfirstlane_b32 s34, v252
    s_barrier
    s_nop 3
    s_cmp_ge_u32 s34, 512
    s_cbranch_scc1 L_op_nextcb
    s_lshr_b32 s16, s34, 3
    s_and_b32 s17, s34, 7
    s_lshl_b32 s17, s17, 2
    s_add_u32 s17, s17, s32
    s_lshl_b32 s36, s17, 7
    s_add_u32 s36, s36, 125829120
    s_lshr_b32 s41, s16, 2
    s_add_u32 s41, s41, s95
    s_add_u32 s41, s41, 1
    v_and_b32 v1, 3, v0
    v_min_u32 v1, 2, v1
    v_lshlrev_b32 v2, 4, v1
    s_and_b32 s37, s16, 3
    s_lshl_b32 s37, s37, 2
    v_add_u32 v2, s37, v2
    s_mov_b32 s40, 4194304
L_aw1:
    buffer_load_dword v3, v2, s[4:7], s36 offen sc1
    s_sub_u32 s40, s40, 1
    s_cbranch_scc1 L_aw1_go
    s_waitcnt vmcnt(0)
    v_subrev_u32 v3, s41, v3
    v_cmp_lt_u32 vcc, 64, v3
    s_cbranch_vccz L_aw1_go
    s_sleep 4
    s_branch L_aw1
L_aw1_go:
    v_and_b32 v5, 63, v0
    v_lshlrev_b32 v1, 4, v5
    s_cmp_ge_u32 s16, 58
    s_cselect_b32 s18, -1, 511
    v_and_b32 v2, s18, v1
    v_or_b32 v3, 128, v1
    v_lshrrev_b32 v4, 4, v5
    v_bfe_u32 v6, v5, 2, 2
    v_sub_u32 v4, v6, v4
    v_lshlrev_b32 v4, 3, v4
    v_and_b32 v6, 3, v5
    v_add_u32 v4, v4, v6
    v_mov_b32 v6, 0xf149f2ca
    s_mov_b32 s22, 0x3e0293ee
    s_lshl_b32 s18, s16, 5
    s_add_u32 s18, s18, s17
    s_lshl_b32 s19, s18, 13
    s_add_u32 s20, s19, 33554432
    buffer_load_dwordx4 v[8:11], v1, s[4:7], s20 offen offset:0 sc1
    s_add_u32 s20, s19, 33554432
    buffer_load_dwordx4 v[12:15], v1, s[4:7], s20 offen offset:1024 sc1
    s_add_u32 s20, s19, 33554432
    buffer_load_dwordx4 v[16:19], v1, s[4:7], s20 offen offset:2048 sc1
    s_add_u32 s20, s19, 33554432
    buffer_load_dwordx4 v[20:23], v1, s[4:7], s20 offen offset:3072 sc1
    s_add_u32 s20, s19, 33558528
    buffer_load_dwordx4 v[24:27], v1, s[4:7], s20 offen offset:0 sc1
    s_add_u32 s20, s19, 33558528
    buffer_load_dwordx4 v[28:31], v1, s[4:7], s20 offen offset:1024 sc1
    s_add_u32 s20, s19, 33558528
    buffer_load_dwordx4 v[32:35], v1, s[4:7], s20 offen offset:2048 sc1
    s_add_u32 s20, s19, 33558528
    buffer_load_dwordx4 v[36:39], v1, s[4:7], s20 offen offset:3072 sc1
    s_lshl_b32 s21, s18, 14
    s_add_u32 s20, s21, 0
    buffer_load_dwordx4 v[40:43], v1, s[4:7], s20 offen offset:0 sc1
    s_add_u32 s20, s21, 4096
    buffer_load_dwordx4 v[44:47], v1, s[4:7], s20 offen offset:0 sc1
    s_add_u32 s20, s21, 8192
    buffer_load_dwordx4 v[48:51], v1, s[4:7], s20 offen offset:0 sc1
    s_add_u32 s20, s21, 12288
    buffer_load_dwordx4 v[52:55], v1, s[4:7], s20 offen offset:0 sc1
    s_add_u32 s20, s21, 0
    buffer_load_dwordx4 v[56:59], v1, s[4:7], s20 offen offset:1024 sc1
    s_add_u32 s20, s21, 4096
    buffer_load_dwordx4 v[60:63], v1, s[4:7], s20 offen offset:1024 sc1
    s_add_u32 s20, s21, 8192
    buffer_load_dwordx4 v[64:67], v1, s[4:7], s20 offen offset:1024 sc1
    s_add_u32 s20, s21, 12288
    buffer_load_dwordx4 v[68:71], v1, s[4:7], s20 offen offset:1024 sc1
    s_add_u32 s20, s21, 0
    buffer_load_dwordx4 v[88:91], v1, s[4:7], s20 offen offset:2048 sc1
    s_add_u32 s20, s21, 4096
    buffer_load_dwordx4 v[92:95], v1, s[4:7], s20 offen offset:2048 sc1
    s_add_u32 s20, s21, 8192
    buffer_load_dwordx4 v[96:99], v1, s[4:7], s20 offen offset:2048 sc1
    s_add_u32 s20, s21, 12288
    buffer_load_dwordx4 v[100:103], v1, s[4:7], s20 offen offset:2048 sc1
    s_add_u32 s20, s21, 0
    buffer_load_dwordx4 v[104:107], v1, s[4:7], s20 offen offset:3072 sc1
    s_add_u32 s20, s21, 4096
    buffer_load_dwordx4 v[108:111], v1, s[4:7], s20 offen offset:3072 sc1
    s_add_u32 s20, s21, 8192
    buffer_load_dwordx4 v[112:115], v1, s[4:7], s20 offen offset:3072 sc1
    s_add_u32 s20, s21, 12288
    buffer_load_dwordx4 v[116:119], v1, s[4:7], s20 offen offset:3072 sc1
    v_mov_b32 v172, 0x3f803f80
    v_mov_b32 v173, 0x3f803f80
    v_mov_b32 v174, 0x3f803f80
    v_mov_b32 v175, 0x3f803f80
    v_mov_b32 v176, 0x3f003f00
    v_mov_b32 v177, 0x3f003f00
    s_waitcnt vmcnt(8)
    v_mfma_f32_16x16x32_bf16 v[136:139], v[40:43], v[8:11], 0
    v_mfma_f32_16x16x32_bf16 v[140:143], v[56:59], v[8:11], 0
    v_mfma_f32_16x16x32_bf16 v[148:151], v[40:43], v[24:27], 0
    v_mfma_f32_16x16x32_bf16 v[152:155], v[56:59], v[24:27], 0
    v_mfma_f32_16x16x32_bf16 v[136:139], v[44:47], v[12:15], v[136:139]
    v_mfma_f32_16x16x32_bf16 v[140:143], v[60:63], v[12:15], v[140:143]
    v_mfma_f32_16x16x32_bf16 v[148:151], v[44:47], v[28:31], v[148:151]
    v_mfma_f32_16x16x32_bf16 v[152:155], v[60:63], v[28:31], v[152:155]
    v_mfma_f32_16x16x32_bf16 v[136:139], v[48:51], v[16:19], v[136:139]
    v_mfma_f32_16x16x32_bf16 v[140:143], v[64:67], v[16:19], v[140:143]
    v_mfma_f32_16x16x32_bf16 v[148:151], v[48:51], v[32:35], v[148:151]
    v_mfma_f32_16x16x32_bf16 v[152:155], v[64:67], v[32:35], v[152:155]
    v_mfma_f32_16x16x32_bf16 v[136:139], v[52:55], v[20:23], v[136:139]
    v_mfma_f32_16x16x32_bf16 v[140:143], v[68:71], v[20:23], v[140:143]
    v_mfma_f32_16x16x32_bf16 v[148:151], v[52:55], v[36:39], v[148:151]
    v_mfma_f32_16x16x32_bf16 v[152:155], v[68:71], v[36:39], v[152:155]
    v_cmp_le_i32 vcc, 0, v4
    s_nop 3
    v_cndmask_b32 v136, v6, v136, vcc
    v_cmp_le_i32 vcc, 1, v4
    s_nop 1
    v_cndmask_b32 v137, v6, v137, vcc
    v_cmp_le_i32 vcc, 2, v4
    s_nop 1
    v_cndmask_b32 v138, v6, v138, vcc
    v_cmp_le_i32 vcc, 3, v4
    s_nop 1
    v_cndmask_b32 v139, v6, v139, vcc
    v_cmp_le_i32 vcc, 4, v4
    s_nop 1
    v_cndmask_b32 v140, v6, v140, vcc
    v_cmp_le_i32 vcc, 5, v4
    s_nop 1
    v_cndmask_b32 v141, v6, v141, vcc
    v_cmp_le_i32 vcc, 6, v4
    s_nop 1
    v_cndmask_b32 v142, v6, v142, vcc
    v_cmp_le_i32 vcc, 7, v4
    s_nop 1
    v_cndmask_b32 v143, v6, v143, vcc
    v_cmp_le_i32 vcc, -4, v4
    s_nop 1
    v_cndmask_b32 v148, v6, v148, vcc
    v_cmp_le_i32 vcc, -3, v4
    s_nop 1
    v_cndmask_b32 v149, v6, v149, vcc
    v_cmp_le_i32 vcc, -2, v4
    s_nop 1
    v_cndmask_b32 v150, v6, v150, vcc
    v_cmp_le_i32 vcc, -1, v4
    s_nop 1
    v_cndmask_b32 v151, v6, v151, vcc
    v_cmp_le_i32 vcc, 0, v4
    s_nop 1
    v_cndmask_b32 v152, v6, v152, vcc
    v_cmp_le_i32 vcc, 1, v4
    s_nop 1
    v_cndmask_b32 v153, v6, v153, vcc
    v_cmp_le_i32 vcc, 2, v4
    s_nop 1
    v_cndmask_b32 v154, v6, v154, vcc
    v_cmp_le_i32 vcc, 3, v4
    s_nop 1
    v_cndmask_b32 v155, v6, v155, vcc
    s_nop 1
    v_and_b32 v198, 1, v0
    v_lshlrev_b32 v198, 2, v198
    v_add_u32 v198, 48, v198
    s_add_u32 s41, s16, s95
    s_add_u32 s41, s41, 1
    s_cmp_lt_u32 s16, 58
    s_cbranch_scc1 L_amk
    v_mov_b32 v198, 16384
L_amk:
    s_nop 1
    s_mov_b32 s88, 65536
    s_mov_b32 s89, 125853696
cw46:
    buffer_load_dword v199, off, s[4:7], s89 sc1
    s_waitcnt vmcnt(0)
    v_readfirstlane_b32 s42, v199
    s_nop 0
    s_sub_u32 s42, s42, s95
    s_cmp_gt_u32 s42, 64
    s_cselect_b32 s42, 0, s42
    s_add_u32 s42, s42, 1
    s_cmp_ge_u32 s42, s16
    s_cbranch_scc1 cw46x
    s_sub_u32 s88, s88, 1
    s_cbranch_scc1 cw46x
    s_sub_u32 s42, s16, s42
    s_min_u32 s42, s42, 6
cw46s:
    s_sleep 24
    s_sub_u32 s42, s42, 1
    s_cmp_lg_u32 s42, 0
    s_cbranch_scc1 cw46s
    s_branch cw46
cw46x:
    s_mov_b32 s40, 4194304
L_aw2:
    buffer_load_dword v199, v198, s[4:7], s36 offen sc1
    s_sub_u32 s40, s40, 1
    s_cbranch_scc1 L_aw2_go
    s_waitcnt vmcnt(0)
    v_subrev_u32 v199, s41, v199
    v_cmp_lt_u32 vcc, 64, v199
    s_cbranch_vccz L_aw2_go
    s_sleep 1
    s_branch L_aw2
L_aw2_go:
    s_lshl_b32 s20, s18, 12
    s_add_u32 s20, s20, 69206016
    buffer_load_dwordx4 v[72:75], v3, s[4:7], s20 offen offset:0 sc1
    buffer_load_dwordx4 v[76:79], v3, s[4:7], s20 offen offset:1024 sc1
    buffer_load_dwordx4 v[80:83], v3, s[4:7], s20 offen offset:2048 sc1
    buffer_load_dwordx4 v[84:87], v3, s[4:7], s20 offen offset:3072 sc1
    s_lshl_b32 s20, s18, 12
    s_add_u32 s20, s20, 77594624
    buffer_load_dwordx4 v[120:123], v2, s[4:7], s20 offen offset:0 sc1
    buffer_load_dwordx4 v[124:127], v2, s[4:7], s20 offen offset:1024 sc1
    buffer_load_dwordx4 v[128:131], v2, s[4:7], s20 offen offset:2048 sc1
    buffer_load_dwordx4 v[132:135], v2, s[4:7], s20 offen offset:3072 sc1
    s_waitcnt vmcnt(4)
    v_mfma_f32_16x16x32_bf16 v[144:147], v[72:75], v[8:11], 0
    v_mfma_f32_16x16x32_bf16 v[156:159], v[72:75], v[24:27], 0
    v_mfma_f32_16x16x32_bf16 v[144:147], v[76:79], v[12:15], v[144:147]
    v_mfma_f32_16x16x32_bf16 v[156:159], v[76:79], v[28:31], v[156:159]
    v_mfma_f32_16x16x32_bf16 v[144:147], v[80:83], v[16:19], v[144:147]
    v_mfma_f32_16x16x32_bf16 v[156:159], v[80:83], v[32:35], v[156:159]
    v_mfma_f32_16x16x32_bf16 v[144:147], v[84:87], v[20:23], v[144:147]
    v_mfma_f32_16x16x32_bf16 v[156:159], v[84:87], v[36:39], v[156:159]
    v_max3_f32 v196, v136, v137, v138
    v_max3_f32 v197, v139, v140, v141
    v_max3_f32 v196, v196, v142, v143
    s_nop 3
    v_max3_f32 v197, v197, v144, v145
    v_max3_f32 v196, v196, v146, v147
    v_max_f32 v196, v196, v197
    v_mov_b32 v197, v196
    s_nop 1
    v_permlane32_swap_b32 v196, v197
    v_max_f32 v196, v196, v197
    v_mov_b32 v197, v196
    s_nop 1
    v_permlane16_swap_b32 v196, v197
    v_max_f32 v196, v196, v197
    v_mul_f32 v196, s22, v196
    v_sub_f32 v196, 0, v196
    v_fma_f32 v136, v136, s22, v196
    v_fma_f32 v137, v137, s22, v196
    v_fma_f32 v138, v138, s22, v196
    v_fma_f32 v139, v139, s22, v196
    v_fma_f32 v140, v140, s22, v196
    v_fma_f32 v141, v141, s22, v196
    v_fma_f32 v142, v142, s22, v196
    v_fma_f32 v143, v143, s22, v196
    v_fma_f32 v144, v144, s22, v196
    v_fma_f32 v145, v145, s22, v196
    v_fma_f32 v146, v146, s22, v196
    v_fma_f32 v147, v147, s22, v196
    v_exp_f32 v136, v136
    v_exp_f32 v137, v137
    v_exp_f32 v138, v138
    v_exp_f32 v139, v139
    v_exp_f32 v140, v140
    v_exp_f32 v141, v141
    v_exp_f32 v142, v142
    v_exp_f32 v143, v143
    v_exp_f32 v144, v144
    v_exp_f32 v145, v145
    v_exp_f32 v146, v146
    v_exp_f32 v147, v147
    v_cvt_pk_bf16_f32 v160, v136, v137
    v_cvt_pk_bf16_f32 v161, v138, v139
    v_cvt_pk_bf16_f32 v162, v140, v141
    v_cvt_pk_bf16_f32 v163, v142, v143
    v_cvt_pk_bf16_f32 v164, v144, v145
    v_cvt_pk_bf16_f32 v165, v146, v147
    v_max3_f32 v196, v148, v149, v150
    v_max3_f32 v197, v151, v152, v153
    v_max3_f32 v196, v196, v154, v155
    v_max3_f32 v197, v197, v156, v157
    v_max3_f32 v196, v196, v158, v159
    v_max_f32 v196, v196, v197
    v_mov_b32 v197, v196
    s_nop 1
    v_permlane32_swap_b32 v196, v197
    v_max_f32 v196, v196, v197
    v_mov_b32 v197, v196
    s_nop 1
    v_permlane16_swap_b32 v196, v197
    v_max_f32 v196, v196, v197
    v_mul_f32 v196, s22, v196
    v_sub_f32 v196, 0, v196
    v_fma_f32 v148, v148, s22, v196
    v_fma_f32 v149, v149, s22, v196
    v_fma_f32 v150, v150, s22, v196
    v_fma_f32 v151, v151, s22, v196
    v_fma_f32 v152, v152, s22, v196
    v_fma_f32 v153, v153, s22, v196
    v_fma_f32 v154, v154, s22, v196
    v_fma_f32 v155, v155, s22, v196
    v_fma_f32 v156, v156, s22, v196
    v_fma_f32 v157, v157, s22, v196
    v_fma_f32 v158, v158, s22, v196
    v_fma_f32 v159, v159, s22, v196
    v_exp_f32 v148, v148
    v_exp_f32 v149, v149
    v_exp_f32 v150, v150
    v_exp_f32 v151, v151
    v_exp_f32 v152, v152
    v_exp_f32 v153, v153
    v_exp_f32 v154, v154
    v_exp_f32 v155, v155
    v_exp_f32 v156, v156
    v_exp_f32 v157, v157
    v_exp_f32 v158, v158
    v_exp_f32 v159, v159
    v_cvt_pk_bf16_f32 v166, v148, v149
    v_cvt_pk_bf16_f32 v167, v150, v151
    v_cvt_pk_bf16_f32 v168, v152, v153
    v_cvt_pk_bf16_f32 v169, v154, v155
    v_cvt_pk_bf16_f32 v170, v156, v157
    v_cvt_pk_bf16_f32 v171, v158, v159
    v_mfma_f32_16x16x32_bf16 v[180:183], v[172:175], v[160:163], 0
    v_mfma_f32_16x16x32_bf16 v[184:187], v[172:175], v[166:169], 0
    s_nop 4
    v_mfma_f32_16x16x16_bf16 v[180:183], v[176:177], v[164:165], v[180:183]
    v_mfma_f32_16x16x16_bf16 v[184:187], v[176:177], v[170:171], v[184:187]
    s_nop 6
    v_rcp_f32 v180, v180
    v_rcp_f32 v184, v184
    s_waitcnt vmcnt(0)
    s_lshl_b32 s18, s16, 18
    s_lshl_b32 s19, s17, 12
    s_add_u32 s18, s18, s19
    s_add_u32 s18, s18, 50331648
    s_add_u32 s19, s18, 131072
    v_mfma_f32_16x16x32_bf16 v[8:11], v[88:91], v[160:163], 0
    v_mfma_f32_16x16x32_bf16 v[12:15], v[104:107], v[160:163], 0
    v_mfma_f32_16x16x32_bf16 v[16:19], v[88:91], v[166:169], 0
    v_mfma_f32_16x16x32_bf16 v[20:23], v[104:107], v[166:169], 0
    v_mfma_f32_16x16x32_bf16 v[24:27], v[92:95], v[160:163], 0
    v_mfma_f32_16x16x32_bf16 v[28:31], v[108:111], v[160:163], 0
    v_mfma_f32_16x16x32_bf16 v[32:35], v[92:95], v[166:169], 0
    v_mfma_f32_16x16x32_bf16 v[36:39], v[108:111], v[166:169], 0
    v_mfma_f32_16x16x32_bf16 v[40:43], v[96:99], v[160:163], 0
    v_mfma_f32_16x16x32_bf16 v[44:47], v[112:115], v[160:163], 0
    v_mfma_f32_16x16x32_bf16 v[48:51], v[96:99], v[166:169], 0
    v_mfma_f32_16x16x32_bf16 v[52:55], v[112:115], v[166:169], 0
    v_mfma_f32_16x16x32_bf16 v[56:59], v[100:103], v[160:163], 0
    v_mfma_f32_16x16x32_bf16 v[60:63], v[116:119], v[160:163], 0
    v_mfma_f32_16x16x32_bf16 v[64:67], v[100:103], v[166:169], 0
    v_mfma_f32_16x16x32_bf16 v[68:71], v[116:119], v[166:169], 0
    v_mfma_f32_16x16x16_bf16 v[8:11], v[120:121], v[164:165], v[8:11]
    v_mfma_f32_16x16x16_bf16 v[12:15], v[122:123], v[164:165], v[12:15]
    v_mfma_f32_16x16x16_bf16 v[16:19], v[120:121], v[170:171], v[16:19]
    v_mfma_f32_16x16x16_bf16 v[20:23], v[122:123], v[170:171], v[20:23]
    v_mfma_f32_16x16x16_bf16 v[24:27], v[124:125], v[164:165], v[24:27]
    v_mfma_f32_16x16x16_bf16 v[28:31], v[126:127], v[164:165], v[28:31]
    v_mfma_f32_16x16x16_bf16 v[32:35], v[124:125], v[170:171], v[32:35]
    v_mfma_f32_16x16x16_bf16 v[36:39], v[126:127], v[170:171], v[36:39]
    v_mfma_f32_16x16x16_bf16 v[40:43], v[128:129], v[164:165], v[40:43]
    v_mfma_f32_16x16x16_bf16 v[44:47], v[130:131], v[164:165], v[44:47]
    v_mfma_f32_16x16x16_bf16 v[48:51], v[128:129], v[170:171], v[48:51]
    v_mfma_f32_16x16x16_bf16 v[52:55], v[130:131], v[170:171], v[52:55]
    v_mfma_f32_16x16x16_bf16 v[56:59], v[132:133], v[164:165], v[56:59]
    v_mfma_f32_16x16x16_bf16 v[60:63], v[134:135], v[164:165], v[60:63]
    v_mfma_f32_16x16x16_bf16 v[64:67], v[132:133], v[170:171], v[64:67]
    v_mfma_f32_16x16x16_bf16 v[68:71], v[134:135], v[170:171], v[68:71]
    v_mul_f32 v8, v8, v180
    v_mul_f32 v12, v12, v180
    v_mul_f32 v9, v9, v180
    v_mul_f32 v13, v13, v180
    v_mul_f32 v10, v10, v180
    v_mul_f32 v14, v14, v180
    v_mul_f32 v11, v11, v180
    v_mul_f32 v15, v15, v180
    v_cvt_pk_bf16_f32 v8, v8, v9
    v_cvt_pk_bf16_f32 v9, v10, v11
    v_cvt_pk_bf16_f32 v10, v12, v13
    v_cvt_pk_bf16_f32 v11, v14, v15
    buffer_store_dwordx4 v[8:11], v1, s[4:7], s18 offen offset:0 sc1
    v_mul_f32 v16, v16, v184
    v_mul_f32 v20, v20, v184
    v_mul_f32 v17, v17, v184
    v_mul_f32 v21, v21, v184
    v_mul_f32 v18, v18, v184
    v_mul_f32 v22, v22, v184
    v_mul_f32 v19, v19, v184
    v_mul_f32 v23, v23, v184
    v_cvt_pk_bf16_f32 v16, v16, v17
    v_cvt_pk_bf16_f32 v17, v18, v19
    v_cvt_pk_bf16_f32 v18, v20, v21
    v_cvt_pk_bf16_f32 v19, v22, v23
    buffer_store_dwordx4 v[16:19], v1, s[4:7], s19 offen offset:0 sc1
    v_mul_f32 v24, v24, v180
    v_mul_f32 v28, v28, v180
    v_mul_f32 v25, v25, v180
    v_mul_f32 v29, v29, v180
    v_mul_f32 v26, v26, v180
    v_mul_f32 v30, v30, v180
    v_mul_f32 v27, v27, v180
    v_mul_f32 v31, v31, v180
    v_cvt_pk_bf16_f32 v24, v24, v25
    v_cvt_pk_bf16_f32 v25, v26, v27
    v_cvt_pk_bf16_f32 v26, v28, v29
    v_cvt_pk_bf16_f32 v27, v30, v31
    buffer_store_dwordx4 v[24:27], v1, s[4:7], s18 offen offset:1024 sc1
    v_mul_f32 v32, v32, v184
    v_mul_f32 v36, v36, v184
    v_mul_f32 v33, v33, v184
    v_mul_f32 v37, v37, v184
    v_mul_f32 v34, v34, v184
    v_mul_f32 v38, v38, v184
    v_mul_f32 v35, v35, v184
    v_mul_f32 v39, v39, v184
    v_cvt_pk_bf16_f32 v32, v32, v33
    v_cvt_pk_bf16_f32 v33, v34, v35
    v_cvt_pk_bf16_f32 v34, v36, v37
    v_cvt_pk_bf16_f32 v35, v38, v39
    buffer_store_dwordx4 v[32:35], v1, s[4:7], s19 offen offset:1024 sc1
    v_mul_f32 v40, v40, v180
    v_mul_f32 v44, v44, v180
    v_mul_f32 v41, v41, v180
    v_mul_f32 v45, v45, v180
    v_mul_f32 v42, v42, v180
    v_mul_f32 v46, v46, v180
    v_mul_f32 v43, v43, v180
    v_mul_f32 v47, v47, v180
    v_cvt_pk_bf16_f32 v40, v40, v41
    v_cvt_pk_bf16_f32 v41, v42, v43
    v_cvt_pk_bf16_f32 v42, v44, v45
    v_cvt_pk_bf16_f32 v43, v46, v47
    buffer_store_dwordx4 v[40:43], v1, s[4:7], s18 offen offset:2048 sc1
    v_mul_f32 v48, v48, v184
    v_mul_f32 v52, v52, v184
    v_mul_f32 v49, v49, v184
    v_mul_f32 v53, v53, v184
    v_mul_f32 v50, v50, v184
    v_mul_f32 v54, v54, v184
    v_mul_f32 v51, v51, v184
    v_mul_f32 v55, v55, v184
    v_cvt_pk_bf16_f32 v48, v48, v49
    v_cvt_pk_bf16_f32 v49, v50, v51
    v_cvt_pk_bf16_f32 v50, v52, v53
    v_cvt_pk_bf16_f32 v51, v54, v55
    buffer_store_dwordx4 v[48:51], v1, s[4:7], s19 offen offset:2048 sc1
    v_mul_f32 v56, v56, v180
    v_mul_f32 v60, v60, v180
    v_mul_f32 v57, v57, v180
    v_mul_f32 v61, v61, v180
    v_mul_f32 v58, v58, v180
    v_mul_f32 v62, v62, v180
    v_mul_f32 v59, v59, v180
    v_mul_f32 v63, v63, v180
    v_cvt_pk_bf16_f32 v56, v56, v57
    v_cvt_pk_bf16_f32 v57, v58, v59
    v_cvt_pk_bf16_f32 v58, v60, v61
    v_cvt_pk_bf16_f32 v59, v62, v63
    buffer_store_dwordx4 v[56:59], v1, s[4:7], s18 offen offset:3072 sc1
    v_mul_f32 v64, v64, v184
    v_mul_f32 v68, v68, v184
    v_mul_f32 v65, v65, v184
    v_mul_f32 v69, v69, v184
    v_mul_f32 v66, v66, v184
    v_mul_f32 v70, v70, v184
    v_mul_f32 v67, v67, v184
    v_mul_f32 v71, v71, v184
    v_cvt_pk_bf16_f32 v64, v64, v65
    v_cvt_pk_bf16_f32 v65, v66, v67
    v_cvt_pk_bf16_f32 v66, v68, v69
    v_cvt_pk_bf16_f32 v67, v70, v71
    buffer_store_dwordx4 v[64:67], v1, s[4:7], s19 offen offset:3072 sc1
    s_lshr_b32 s40, s34, 1
    s_lshl_b32 s40, s40, 7
    s_and_b32 s41, s34, 1
    s_lshl_b32 s41, s41, 2
    s_add_u32 s40, s40, s41
    s_add_u32 s40, s40, 125894656
    s_waitcnt vmcnt(0)
    s_barrier
    v_mov_b32 v250, s95
    v_cmp_eq_u32 vcc, 0, v0
    s_nop 0
    s_and_saveexec_b64 s[38:39], vcc
    s_cbranch_execz fs47
    buffer_store_dword v250, off, s[4:7], s40 sc1
fs47:
    s_mov_b64 exec, -1
    s_branch L_att_next
L_op_start:
    s_lshl_b32 s35, s33, 2
    s_add_u32 s35, s35, 136
    s_lshr_b32 s89, s33, 2
    s_lshl_b32 s89, s89, 7
    s_add_u32 s89, s89, 125841408
    v_mbcnt_lo_u32_b32 v2, -1, 0
    v_mbcnt_hi_u32_b32 v2, -1, v2
    v_min_u32 v2, 31, v2
    v_lshlrev_b32 v2, 2, v2
    s_mov_b32 s88, 4194304
fw48:
    buffer_load_dword v3, v2, s[4:7], s89 offen offset:0 sc1
    s_sub_u32 s88, s88, 1
    s_cbranch_scc1 fw48x
    s_waitcnt vmcnt(0)
    v_cmp_ne_u32 vcc, s95, v3
    s_cbranch_vccz fw48x
    s_sleep 4
    s_branch fw48
fw48x:
    v_and_b32 v1, 63, v0
    v_lshlrev_b32 v1, 4, v1
    s_lshl_b32 s18, s33, 18
    s_lshl_b32 s19, s32, 16
    s_add_u32 s18, s18, s19
    s_add_u32 s18, s18, 130023424
    buffer_load_dwordx4 a[0:3], v1, s[4:7], s18 offen offset:0 sc1
    buffer_load_dwordx4 a[4:7], v1, s[4:7], s18 offen offset:1024 sc1
    buffer_load_dwordx4 a[8:11], v1, s[4:7], s18 offen offset:2048 sc1
    buffer_load_dwordx4 a[12:15], v1, s[4:7], s18 offen offset:3072 sc1
    s_add_u32 s18, s18, 4096
    buffer_load_dwordx4 a[16:19], v1, s[4:7], s18 offen offset:0 sc1
    buffer_load_dwordx4 a[20:23], v1, s[4:7], s18 offen offset:1024 sc1
    buffer_load_dwordx4 a[24:27], v1, s[4:7], s18 offen offset:2048 sc1
    buffer_load_dwordx4 a[28:31], v1, s[4:7], s18 offen offset:3072 sc1
    s_add_u32 s18, s18, 4096
    buffer_load_dwordx4 a[32:35], v1, s[4:7], s18 offen offset:0 sc1
    buffer_load_dwordx4 a[36:39], v1, s[4:7], s18 offen offset:1024 sc1
    buffer_load_dwordx4 a[40:43], v1, s[4:7], s18 offen offset:2048 sc1
    buffer_load_dwordx4 a[44:47], v1, s[4:7], s18 offen offset:3072 sc1
    s_add_u32 s18, s18, 4096
    buffer_load_dwordx4 a[48:51], v1, s[4:7], s18 offen offset:0 sc1
    buffer_load_dwordx4 a[52:55], v1, s[4:7], s18 offen offset:1024 sc1
    buffer_load_dwordx4 a[56:59], v1, s[4:7], s18 offen offset:2048 sc1
    buffer_load_dwordx4 a[60:63], v1, s[4:7], s18 offen offset:3072 sc1
    s_add_u32 s18, s18, 4096
    buffer_load_dwordx4 a[64:67], v1, s[4:7], s18 offen offset:0 sc1
    buffer_load_dwordx4 a[68:71], v1, s[4:7], s18 offen offset:1024 sc1
    buffer_load_dwordx4 a[72:75], v1, s[4:7], s18 offen offset:2048 sc1
    buffer_load_dwordx4 a[76:79], v1, s[4:7], s18 offen offset:3072 sc1
    s_add_u32 s18, s18, 4096
    buffer_load_dwordx4 a[80:83], v1, s[4:7], s18 offen offset:0 sc1
    buffer_load_dwordx4 a[84:87], v1, s[4:7], s18 offen offset:1024 sc1
    buffer_load_dwordx4 a[88:91], v1, s[4:7], s18 offen offset:2048 sc1
    buffer_load_dwordx4 a[92:95], v1, s[4:7], s18 offen offset:3072 sc1
    s_add_u32 s18, s18, 4096
    buffer_load_dwordx4 a[96:99], v1, s[4:7], s18 offen offset:0 sc1
    buffer_load_dwordx4 a[100:103], v1, s[4:7], s18 offen offset:1024 sc1
    buffer_load_dwordx4 a[104:107], v1, s[4:7], s18 offen offset:2048 sc1
    buffer_load_dwordx4 a[108:111], v1, s[4:7], s18 offen offset:3072 sc1
    s_add_u32 s18, s18, 4096
    buffer_load_dwordx4 a[112:115], v1, s[4:7], s18 offen offset:0 sc1
    buffer_load_dwordx4 a[116:119], v1, s[4:7], s18 offen offset:1024 sc1
    buffer_load_dwordx4 a[120:123], v1, s[4:7], s18 offen offset:2048 sc1
    buffer_load_dwordx4 a[124:127], v1, s[4:7], s18 offen offset:3072 sc1
    s_add_u32 s18, s18, 4096
    buffer_load_dwordx4 a[128:131], v1, s[4:7], s18 offen offset:0 sc1
    buffer_load_dwordx4 a[132:135], v1, s[4:7], s18 offen offset:1024 sc1
    buffer_load_dwordx4 a[136:139], v1, s[4:7], s18 offen offset:2048 sc1
    buffer_load_dwordx4 a[140:143], v1, s[4:7], s18 offen offset:3072 sc1
    s_add_u32 s18, s18, 4096
    buffer_load_dwordx4 a[144:147], v1, s[4:7], s18 offen offset:0 sc1
    buffer_load_dwordx4 a[148:151], v1, s[4:7], s18 offen offset:1024 sc1
    buffer_load_dwordx4 a[152:155], v1, s[4:7], s18 offen offset:2048 sc1
    buffer_load_dwordx4 a[156:159], v1, s[4:7], s18 offen offset:3072 sc1
    s_add_u32 s18, s18, 4096
    buffer_load_dwordx4 a[160:163], v1, s[4:7], s18 offen offset:0 sc1
    s_waitcnt vmcnt(20)
    buffer_load_dwordx4 a[164:167], v1, s[4:7], s18 offen offset:1024 sc1
    buffer_load_dwordx4 a[168:171], v1, s[4:7], s18 offen offset:2048 sc1
    buffer_load_dwordx4 a[172:175], v1, s[4:7], s18 offen offset:3072 sc1
    s_add_u32 s18, s18, 4096
    buffer_load_dwordx4 a[176:179], v1, s[4:7], s18 offen offset:0 sc1
    buffer_load_dwordx4 a[180:183], v1, s[4:7], s18 offen offset:1024 sc1
    buffer_load_dwordx4 a[184:187], v1, s[4:7], s18 offen offset:2048 sc1
    buffer_load_dwordx4 a[188:191], v1, s[4:7], s18 offen offset:3072 sc1
    s_add_u32 s18, s18, 4096
    buffer_load_dwordx4 a[192:195], v1, s[4:7], s18 offen offset:0 sc1
    buffer_load_dwordx4 a[196:199], v1, s[4:7], s18 offen offset:1024 sc1
    buffer_load_dwordx4 a[200:203], v1, s[4:7], s18 offen offset:2048 sc1
    buffer_load_dwordx4 a[204:207], v1, s[4:7], s18 offen offset:3072 sc1
    s_add_u32 s18, s18, 4096
    buffer_load_dwordx4 a[208:211], v1, s[4:7], s18 offen offset:0 sc1
    buffer_load_dwordx4 a[212:215], v1, s[4:7], s18 offen offset:1024 sc1
    buffer_load_dwordx4 a[216:219], v1, s[4:7], s18 offen offset:2048 sc1
    buffer_load_dwordx4 a[220:223], v1, s[4:7], s18 offen offset:3072 sc1
    s_add_u32 s18, s18, 4096
    buffer_load_dwordx4 a[224:227], v1, s[4:7], s18 offen offset:0 sc1
    buffer_load_dwordx4 a[228:231], v1, s[4:7], s18 offen offset:1024 sc1
    buffer_load_dwordx4 a[232:235], v1, s[4:7], s18 offen offset:2048 sc1
    buffer_load_dwordx4 a[236:239], v1, s[4:7], s18 offen offset:3072 sc1
    s_add_u32 s18, s18, 4096
    buffer_load_dwordx4 a[240:243], v1, s[4:7], s18 offen offset:0 sc1
    buffer_load_dwordx4 a[244:247], v1, s[4:7], s18 offen offset:1024 sc1
    buffer_load_dwordx4 a[248:251], v1, s[4:7], s18 offen offset:2048 sc1
    buffer_load_dwordx4 a[252:255], v1, s[4:7], s18 offen offset:3072 sc1
    s_waitcnt vmcnt(0)
    s_mov_b32 s44, 0
    s_mov_b32 s37, s35
    v_mov_b32 v250, 1
    v_mov_b32 v251, 163832
    v_cmp_eq_u32 vcc, 0, v0
    s_nop 0
    s_and_saveexec_b64 s[38:39], vcc
    s_cbranch_execz tk49
    buffer_atomic_add v250, off, s[84:87], s37 sc0
    s_waitcnt vmcnt(0)
    ds_write_b32 v251, v250
    s_waitcnt lgkmcnt(0)
tk49:
    s_mov_b64 exec, -1
    s_barrier
    ds_read_b32 v252, v251
    s_waitcnt lgkmcnt(0)
    v_readfirstlane_b32 s16, v252
    s_barrier
    s_nop 3
    s_cmp_ge_u32 s16, 128
    s_cbranch_scc1 L_op_nextcb
L_op_seg:
    s_lshr_b32 s43, s16, 1
    s_add_u32 s43, s43, 2
    s_min_u32 s43, s43, 63
    s_lshl_b32 s94, s33, 7
    s_add_u32 s94, s94, s16
    s_mov_b32 s88, 65536
    s_mov_b32 s89, 125853696
cw50:
    buffer_load_dword v3, off, s[4:7], s89 sc1
    s_waitcnt vmcnt(0)
    v_readfirstlane_b32 s42, v3
    s_nop 0
    s_sub_u32 s42, s42, s95
    s_cmp_gt_u32 s42, 64
    s_cselect_b32 s42, 0, s42
    s_add_u32 s42, s42, 1
    s_cmp_ge_u32 s42, s43
    s_cbranch_scc1 cw50x
    s_sub_u32 s88, s88, 1
    s_cbranch_scc1 cw50x
    s_sub_u32 s42, s43, s42
    s_min_u32 s42, s42, 6
cw50s:
    s_sleep 24
    s_sub_u32 s42, s42, 1
    s_cmp_lg_u32 s42, 0
    s_cbranch_scc1 cw50s
    s_branch cw50
cw50x:
    s_lshr_b32 s89, s16, 1
    s_lshl_b32 s89, s89, 2
    s_add_u32 s89, s89, s32
    s_lshl_b32 s89, s89, 7
    s_add_u32 s89, s89, 125894656
    v_mbcnt_lo_u32_b32 v2, -1, 0
    v_mbcnt_hi_u32_b32 v2, -1, v2
    v_min_u32 v2, 1, v2
    v_lshlrev_b32 v2, 2, v2
    s_mov_b32 s88, 4194304
fw51:
    buffer_load_dword v3, v2, s[4:7], s89 offen offset:0 sc1
    s_sub_u32 s88, s88, 1
    s_cbranch_scc1 fw51x
    s_waitcnt vmcnt(0)
    v_cmp_ne_u32 vcc, s95, v3
    s_cbranch_vccz fw51x
    s_sleep 2
    s_branch fw51
fw51x:
    v_mov_b32 v250, 1
    v_lshrrev_b32 v252, 2, v1
    v_min_u32 v252, 68, v252
    s_cmp_lg_u32 s32, 0
    s_cbranch_scc1 L_op_na
    s_mov_b64 exec, 1
    buffer_atomic_add v250, off, s[84:87], s35 sc0
    s_mov_b64 exec, -1
    s_cmp_lg_u32 s44, 0
    s_cbranch_scc1 L_op_na
    buffer_load_dword v253, v252, s[84:87], 0 offen offset:136 sc1
L_op_na:
    s_lshl_b32 s18, s16, 17
    s_lshl_b32 s19, s32, 15
    s_add_u32 s18, s18, s19
    s_add_u32 s18, s18, 50331648
    buffer_load_dwordx4 v[32:35], v1, s[4:7], s18 offen offset:0 sc1
    buffer_load_dwordx4 v[36:39], v1, s[4:7], s18 offen offset:1024 sc1
    buffer_load_dwordx4 v[40:43], v1, s[4:7], s18 offen offset:2048 sc1
    buffer_load_dwordx4 v[44:47], v1, s[4:7], s18 offen offset:3072 sc1
    s_add_u32 s18, s18, 4096
    buffer_load_dwordx4 v[48:51], v1, s[4:7], s18 offen offset:0 sc1
    buffer_load_dwordx4 v[52:55], v1, s[4:7], s18 offen offset:1024 sc1
    buffer_load_dwordx4 v[56:59], v1, s[4:7], s18 offen offset:2048 sc1
    buffer_load_dwordx4 v[60:63], v1, s[4:7], s18 offen offset:3072 sc1
    s_add_u32 s18, s18, 4096
    buffer_load_dwordx4 v[64:67], v1, s[4:7], s18 offen offset:0 sc1
    buffer_load_dwordx4 v[68:71], v1, s[4:7], s18 offen offset:1024 sc1
    buffer_load_dwordx4 v[72:75], v1, s[4:7], s18 offen offset:2048 sc1
    buffer_load_dwordx4 v[76:79], v1, s[4:7], s18 offen offset:3072 sc1
    s_add_u32 s18, s18, 4096
    buffer_load_dwordx4 v[80:83], v1, s[4:7], s18 offen offset:0 sc1
    buffer_load_dwordx4 v[84:87], v1, s[4:7], s18 offen offset:1024 sc1
    buffer_load_dwordx4 v[88:91], v1, s[4:7], s18 offen offset:2048 sc1
    buffer_load_dwordx4 v[92:95], v1, s[4:7], s18 offen offset:3072 sc1
    s_add_u32 s18, s18, 4096
    buffer_load_dwordx4 v[96:99], v1, s[4:7], s18 offen offset:0 sc1
    buffer_load_dwordx4 v[100:103], v1, s[4:7], s18 offen offset:1024 sc1
    buffer_load_dwordx4 v[104:107], v1, s[4:7], s18 offen offset:2048 sc1
    buffer_load_dwordx4 v[108:111], v1, s[4:7], s18 offen offset:3072 sc1
    s_add_u32 s18, s18, 4096
    buffer_load_dwordx4 v[112:115], v1, s[4:7], s18 offen offset:0 sc1
    buffer_load_dwordx4 v[116:119], v1, s[4:7], s18 offen offset:1024 sc1
    buffer_load_dwordx4 v[120:123], v1, s[4:7], s18 offen offset:2048 sc1
    buffer_load_dwordx4 v[124:127], v1, s[4:7], s18 offen offset:3072 sc1
    s_add_u32 s18, s18, 4096
    buffer_load_dwordx4 v[128:131], v1, s[4:7], s18 offen offset:0 sc1
    buffer_load_dwordx4 v[132:135], v1, s[4:7], s18 offen offset:1024 sc1
    buffer_load_dwordx4 v[136:139], v1, s[4:7], s18 offen offset:2048 sc1
    buffer_load_dwordx4 v[140:143], v1, s[4:7], s18 offen offset:3072 sc1
    s_add_u32 s18, s18, 4096
    buffer_load_dwordx4 v[144:147], v1, s[4:7], s18 offen offset:0 sc1
    buffer_load_dwordx4 v[148:151], v1, s[4:7], s18 offen offset:1024 sc1
    buffer_load_dwordx4 v[152:155], v1, s[4:7], s18 offen offset:2048 sc1
    buffer_load_dwordx4 v[156:159], v1, s[4:7], s18 offen offset:3072 sc1
    v_lshlrev_b32 v2, 4, v0
    v_and_b32 v3, 3072, v2
    v_lshl_add_u32 v2, v3, 1, v1
    s_waitcnt vmcnt(31)
    v_mfma_f32_16x16x32_bf16 v[8:11], a[0:3], v[32:35], 0
    v_mfma_f32_16x16x32_bf16 v[12:15], a[4:7], v[32:35], 0
    s_waitcnt vmcnt(30)
    v_mfma_f32_16x16x32_bf16 v[8:11], a[8:11], v[36:39], v[8:11]
    v_mfma_f32_16x16x32_bf16 v[12:15], a[12:15], v[36:39], v[12:15]
    s_waitcnt vmcnt(29)
    v_mfma_f32_16x16x32_bf16 v[8:11], a[16:19], v[40:43], v[8:11]
    v_mfma_f32_16x16x32_bf16 v[12:15], a[20:23], v[40:43], v[12:15]
    s_waitcnt vmcnt(28)
    v_mfma_f32_16x16x32_bf16 v[8:11], a[24:27], v[44:47], v[8:11]
    v_mfma_f32_16x16x32_bf16 v[12:15], a[28:31], v[44:47], v[12:15]
    s_waitcnt vmcnt(27)
    v_mfma_f32_16x16x32_bf16 v[8:11], a[32:35], v[48:51], v[8:11]
    v_mfma_f32_16x16x32_bf16 v[12:15], a[36:39], v[48:51], v[12:15]
    s_waitcnt vmcnt(26)
    v_mfma_f32_16x16x32_bf16 v[8:11], a[40:43], v[52:55], v[8:11]
    v_mfma_f32_16x16x32_bf16 v[12:15], a[44:47], v[52:55], v[12:15]
    s_waitcnt vmcnt(25)
    v_mfma_f32_16x16x32_bf16 v[8:11], a[48:51], v[56:59], v[8:11]
    v_mfma_f32_16x16x32_bf16 v[12:15], a[52:55], v[56:59], v[12:15]
    s_waitcnt vmcnt(24)
    v_mfma_f32_16x16x32_bf16 v[8:11], a[56:59], v[60:63], v[8:11]
    v_mfma_f32_16x16x32_bf16 v[12:15], a[60:63], v[60:63], v[12:15]
    s_waitcnt vmcnt(23)
    v_mfma_f32_16x16x32_bf16 v[8:11], a[64:67], v[64:67], v[8:11]
    v_mfma_f32_16x16x32_bf16 v[12:15], a[68:71], v[64:67], v[12:15]
    s_waitcnt vmcnt(22)
    v_mfma_f32_16x16x32_bf16 v[8:11], a[72:75], v[68:71], v[8:11]
    v_mfma_f32_16x16x32_bf16 v[12:15], a[76:79], v[68:71], v[12:15]
    s_waitcnt vmcnt(21)
    v_mfma_f32_16x16x32_bf16 v[8:11], a[80:83], v[72:75], v[8:11]
    v_mfma_f32_16x16x32_bf16 v[12:15], a[84:87], v[72:75], v[12:15]
    s_waitcnt vmcnt(20)
    v_mfma_f32_16x16x32_bf16 v[8:11], a[88:91], v[76:79], v[8:11]
    v_mfma_f32_16x16x32_bf16 v[12:15], a[92:95], v[76:79], v[12:15]
    s_waitcnt vmcnt(19)
    v_mfma_f32_16x16x32_bf16 v[8:11], a[96:99], v[80:83], v[8:11]
    v_mfma_f32_16x16x32_bf16 v[12:15], a[100:103], v[80:83], v[12:15]
    s_waitcnt vmcnt(18)
    v_mfma_f32_16x16x32_bf16 v[8:11], a[104:107], v[84:87], v[8:11]
    v_mfma_f32_16x16x32_bf16 v[12:15], a[108:111], v[84:87], v[12:15]
    s_waitcnt vmcnt(17)
    v_mfma_f32_16x16x32_bf16 v[8:11], a[112:115], v[88:91], v[8:11]
    v_mfma_f32_16x16x32_bf16 v[12:15], a[116:119], v[88:91], v[12:15]
    s_waitcnt vmcnt(16)
    v_mfma_f32_16x16x32_bf16 v[8:11], a[120:123], v[92:95], v[8:11]
    v_mfma_f32_16x16x32_bf16 v[12:15], a[124:127], v[92:95], v[12:15]
    s_waitcnt vmcnt(15)
    v_mfma_f32_16x16x32_bf16 v[8:11], a[128:131], v[96:99], v[8:11]
    v_mfma_f32_16x16x32_bf16 v[12:15], a[132:135], v[96:99], v[12:15]
    s_waitcnt vmcnt(14)
    v_mfma_f32_16x16x32_bf16 v[8:11], a[136:139], v[100:103], v[8:11]
    v_mfma_f32_16x16x32_bf16 v[12:15], a[140:143], v[100:103], v[12:15]
    s_waitcnt vmcnt(13)
    v_mfma_f32_16x16x32_bf16 v[8:11], a[144:147], v[104:107], v[8:11]
    v_mfma_f32_16x16x32_bf16 v[12:15], a[148:151], v[104:107], v[12:15]
    s_waitcnt vmcnt(12)
    v_mfma_f32_16x16x32_bf16 v[8:11], a[152:155], v[108:111], v[8:11]
    v_mfma_f32_16x16x32_bf16 v[12:15], a[156:159], v[108:111], v[12:15]
    s_waitcnt vmcnt(11)
    v_mfma_f32_16x16x32_bf16 v[8:11], a[160:163], v[112:115], v[8:11]
    v_mfma_f32_16x16x32_bf16 v[12:15], a[164:167], v[112:115], v[12:15]
    s_waitcnt vmcnt(10)
    v_mfma_f32_16x16x32_bf16 v[8:11], a[168:171], v[116:119], v[8:11]
    v_mfma_f32_16x16x32_bf16 v[12:15], a[172:175], v[116:119], v[12:15]
    s_waitcnt vmcnt(9)
    v_mfma_f32_16x16x32_bf16 v[8:11], a[176:179], v[120:123], v[8:11]
    v_mfma_f32_16x16x32_bf16 v[12:15], a[180:183], v[120:123], v[12:15]
    s_waitcnt vmcnt(8)
    v_mfma_f32_16x16x32_bf16 v[8:11], a[184:187], v[124:127], v[8:11]
    v_mfma_f32_16x16x32_bf16 v[12:15], a[188:191], v[124:127], v[12:15]
    s_waitcnt vmcnt(7)
    v_mfma_f32_16x16x32_bf16 v[8:11], a[192:195], v[128:131], v[8:11]
    v_mfma_f32_16x16x32_bf16 v[12:15], a[196:199], v[128:131], v[12:15]
    s_waitcnt vmcnt(6)
    v_mfma_f32_16x16x32_bf16 v[8:11], a[200:203], v[132:135], v[8:11]
    v_mfma_f32_16x16x32_bf16 v[12:15], a[204:207], v[132:135], v[12:15]
    s_waitcnt vmcnt(5)
    v_mfma_f32_16x16x32_bf16 v[8:11], a[208:211], v[136:139], v[8:11]
    v_mfma_f32_16x16x32_bf16 v[12:15], a[212:215], v[136:139], v[12:15]
    s_waitcnt vmcnt(4)
    v_mfma_f32_16x16x32_bf16 v[8:11], a[216:219], v[140:143], v[8:11]
    v_mfma_f32_16x16x32_bf16 v[12:15], a[220:223], v[140:143], v[12:15]
    s_waitcnt vmcnt(3)
    v_mfma_f32_16x16x32_bf16 v[8:11], a[224:227], v[144:147], v[8:11]
    v_mfma_f32_16x16x32_bf16 v[12:15], a[228:231], v[144:147], v[12:15]
    s_waitcnt vmcnt(2)
    v_mfma_f32_16x16x32_bf16 v[8:11], a[232:235], v[148:151], v[8:11]
    v_mfma_f32_16x16x32_bf16 v[12:15], a[236:239], v[148:151], v[12:15]
    s_waitcnt vmcnt(1)
    v_mfma_f32_16x16x32_bf16 v[8:11], a[240:243], v[152:155], v[8:11]
    v_mfma_f32_16x16x32_bf16 v[12:15], a[244:247], v[152:155], v[12:15]
    s_waitcnt vmcnt(0)
    v_mfma_f32_16x16x32_bf16 v[8:11], a[248:251], v[156:159], v[8:11]
    v_mfma_f32_16x16x32_bf16 v[12:15], a[252:255], v[156:159], v[12:15]
    s_nop 6
    ds_write_b128 v2, v[8:11] offset:0
    ds_write_b128 v2, v[12:15] offset:1024
    s_cmp_lg_u32 s32, 0
    s_cbranch_scc1 L_op_nb
    v_cmp_eq_u32 vcc, 0, v253
    s_nop 0
    s_cmp_eq_u64 vcc, 0
    s_cselect_b32 s44, 65536, 0
    v_or_b32 v250, s44, v250
    v_mov_b32 v251, 163832
    s_mov_b64 exec, 1
    ds_write_b32 v251, v250
    s_mov_b64 exec, -1
L_op_nb:
    s_waitcnt lgkmcnt(0)
    s_barrier
    s_cmp_lg_u32 s32, 0
    s_cbranch_scc1 os_skip
    ds_read_b128 v[40:43], v1 offset:2048
    ds_read_b128 v[44:47], v1 offset:3072
    ds_read_b128 v[48:51], v1 offset:4096
    ds_read_b128 v[52:55], v1 offset:5120
    ds_read_b128 v[56:59], v1 offset:6144
    ds_read_b128 v[60:63], v1 offset:7168
    v_lshrrev_b32 v3, 4, v1
    v_bfe_u32 v4, v3, 2, 2
    v_lshlrev_b32 v4, 3, v4
    v_and_b32 v2, 3, v3
    v_add_u32 v4, v4, v2
    v_mul_u32_u24 v4, 2304, v4
    v_lshrrev_b32 v3, 4, v3
    v_lshl_add_u32 v4, v3, 4, v4
    s_lshr_b32 s18, s16, 1
    s_lshl_b32 s18, s18, 3
    s_and_b32 s19, s16, 1
    s_add_u32 s18, s18, s19
    s_mul_i32 s18, s18, 9216
    s_lshl_b32 s19, s33, 6
    s_add_u32 s18, s18, s19
    s_waitcnt lgkmcnt(0)
    v_pk_add_f32 v[8:9], v[8:9], v[40:41]
    v_pk_add_f32 v[48:49], v[48:49], v[56:57]
    v_pk_add_f32 v[8:9], v[8:9], v[48:49]
    v_pk_add_f32 v[10:11], v[10:11], v[42:43]
    v_pk_add_f32 v[50:51], v[50:51], v[58:59]
    v_pk_add_f32 v[10:11], v[10:11], v[50:51]
    v_pk_add_f32 v[12:13], v[12:13], v[44:45]
    v_pk_add_f32 v[52:53], v[52:53], v[60:61]
    v_pk_add_f32 v[12:13], v[12:13], v[52:53]
    v_pk_add_f32 v[14:15], v[14:15], v[46:47]
    v_pk_add_f32 v[54:55], v[54:55], v[62:63]
    v_pk_add_f32 v[14:15], v[14:15], v[54:55]
    v_cvt_pk_bf16_f32 v32, v8, v12
    v_cvt_pk_bf16_f32 v33, v9, v13
    v_cvt_pk_bf16_f32 v34, v10, v14
    v_cvt_pk_bf16_f32 v35, v11, v15
    buffer_store_dwordx4 v[32:35], v4, s[8:11], s18 offen
os_skip:
    s_nop 1
    v_mov_b32 v251, 163832
    ds_read_b32 v252, v251
    s_waitcnt lgkmcnt(0)
    v_readfirstlane_b32 s40, v252
    s_nop 1
    s_cmp_ge_u32 s40, 65664
    s_cbranch_scc1 L_done
    s_barrier
    s_and_b32 s16, s40, 0xffff
    s_cmp_lt_u32 s16, 128
    s_cbranch_scc1 L_op_seg
L_op_nextcb:
    s_mov_b32 s40, -1
    s_cmp_lg_u32 s32, 0
    s_cbranch_scc1 L_op_dec
    v_and_b32 v1, 63, v0
    v_min_u32 v1, 17, v1
    v_lshlrev_b32 v2, 2, v1
    buffer_load_dword v3, v2, s[84:87], 0 offen offset:136 sc1
    s_waitcnt vmcnt(0)
    v_cmp_gt_u32 vcc, 100, v3
    s_nop 0
    s_ff1_i32_b64 s40, vcc
L_op_dec:
    v_mov_b32 v250, s40
    v_mov_b32 v251, 163832
    s_cmp_lg_u32 s32, 0
    s_cbranch_scc1 L_op_nw
    ds_write_b32 v251, v250
    s_waitcnt lgkmcnt(0)
L_op_nw:
    s_barrier
    ds_read_b32 v252, v251
    s_waitcnt lgkmcnt(0)
    v_readfirstlane_b32 s33, v252
    s_barrier
    s_nop 1
    s_cmp_lt_u32 s33, 18
    s_cbranch_scc1 L_op_start
L_done:
L_exit:
    s_endpgm
.section .rodata,"a"
.p2align 6
.amdhsa_kernel concat_heads__memory_aug_recurrent_mem_tr__ssm_conv_s4d__prompt_kernel
  .amdhsa_next_free_vgpr 512
  .amdhsa_next_free_sgpr 102
  .amdhsa_accum_offset 256
  .amdhsa_group_segment_fixed_size 0
  .amdhsa_kernarg_size 136
  .amdhsa_user_sgpr_count 2
  .amdhsa_user_sgpr_kernarg_segment_ptr 1
  .amdhsa_system_sgpr_workgroup_id_x 1
.end_amdhsa_kernel
.text
```

```asm
; @launch grid=(256,1,1) block=(256,1,1) lds=163840
.amdgcn_target "amdgcn-amd-amdhsa--gfx950"
.text
.globl concat_heads__memory_aug_recurrent_mem_tr__ssm_conv_s4d__prompt_kernel
.p2align 8
.type concat_heads__memory_aug_recurrent_mem_tr__ssm_conv_s4d__prompt_kernel,@function
concat_heads__memory_aug_recurrent_mem_tr__ssm_conv_s4d__prompt_kernel:
    s_cmp_ge_u32 s2, 256
    s_cbranch_scc1 L_exit
    s_load_dwordx4 s[80:83], s[0:1], 120
    s_load_dwordx16 s[48:63], s[0:1], 0
    s_memrealtime s[90:91]
    v_lshrrev_b32 v1, 6, v0
    s_nop 0
    v_readfirstlane_b32 s32, v1
    s_waitcnt lgkmcnt(0)
    s_mov_b32 s4, s82
    s_mov_b32 s5, s83
    s_mov_b32 s6, 268435456
    s_mov_b32 s7, 0x20000
    s_mov_b32 s84, s80
    s_mov_b32 s85, s81
    s_mov_b32 s86, 256
    s_mov_b32 s87, 0x20000
    s_cmp_lg_u32 s32, 0
    s_cbranch_scc1 L_nod0
L_nod0:
    s_cmp_lg_u32 s32, 3
    s_cbranch_scc1 L_nowarm
    s_getpc_b64 s[44:45]
L_pcw:
    v_and_b32 v1, 63, v0
    v_lshlrev_b32 v1, 7, v1
    v_min_u32 v2, L_exit-L_pcw, v1
    global_load_dword v210, v2, s[44:45]
    v_add_u32 v1, 8192, v1
    v_min_u32 v2, L_exit-L_pcw, v1
    global_load_dword v211, v2, s[44:45]
    v_add_u32 v1, 8192, v1
    v_min_u32 v2, L_exit-L_pcw, v1
    global_load_dword v212, v2, s[44:45]
    v_add_u32 v1, 8192, v1
    v_min_u32 v2, L_exit-L_pcw, v1
    global_load_dword v213, v2, s[44:45]
    v_add_u32 v1, 8192, v1
    v_min_u32 v2, L_exit-L_pcw, v1
    global_load_dword v214, v2, s[44:45]
    v_add_u32 v1, 8192, v1
    v_min_u32 v2, L_exit-L_pcw, v1
    global_load_dword v215, v2, s[44:45]
    v_add_u32 v1, 8192, v1
    v_min_u32 v2, L_exit-L_pcw, v1
    global_load_dword v216, v2, s[44:45]
    v_add_u32 v1, 8192, v1
    v_min_u32 v2, L_exit-L_pcw, v1
    global_load_dword v217, v2, s[44:45]
    v_add_u32 v1, 8192, v1
L_nowarm:
    s_getreg_b32 s3, hwreg(HW_REG_XCC_ID)
    s_and_b32 s3, s3, 15
    s_cmp_lg_u32 s3, 0
    s_cbranch_scc1 L_helper
    s_mov_b32 s37, 128
    v_mov_b32 v250, 1
    v_mov_b32 v251, 163832
    v_cmp_eq_u32 vcc, 0, v0
    s_nop 0
    s_and_saveexec_b64 s[38:39], vcc
    s_cbranch_execz tk1
    buffer_atomic_add v250, off, s[84:87], s37 sc0
    s_waitcnt vmcnt(0)
    ds_write_b32 v251, v250
    s_waitcnt lgkmcnt(0)
tk1:
    s_mov_b64 exec, -1
    s_barrier
    ds_read_b32 v252, v251
    s_waitcnt lgkmcnt(0)
    v_readfirstlane_b32 s12, v252
    s_barrier
    s_nop 3
    s_cmp_ge_u32 s12, 32
    s_cbranch_scc1 L_helper
L_chain:
    s_load_dwordx8 s[48:55], s[0:1], 8
    s_load_dwordx2 s[56:57], s[0:1], 40
    s_waitcnt lgkmcnt(0)
    v_lshrrev_b32 v77, 6, v0
    s_nop 0
    v_readfirstlane_b32 s13, v77
    v_lshlrev_b32 v65, 4, v0
    v_and_b32 v48, 63, v0
    s_mov_b32 s10, 4718592
    s_mov_b32 s11, 0x20000
    v_lshrrev_b32 v49, 3, v48
    v_mul_u32_u24 v18, 1152, v49
    v_and_b32 v49, 7, v48
    v_lshl_add_u32 v18, v49, 4, v18
    s_mul_i32 s40, s12, 147456
    s_lshl_b32 s41, s13, 8
    s_add_u32 s40, s40, s41
    s_mov_b32 s42, s40
    s_xor_b32 s41, s13, 0
    s_mul_i32 s41, s41, 36864
    s_add_u32 s60, s41, s40
    s_xor_b32 s41, s13, 1
    s_mul_i32 s41, s41, 36864
    s_add_u32 s61, s41, s40
    s_xor_b32 s41, s13, 2
    s_mul_i32 s41, s41, 36864
    s_add_u32 s62, s41, s40
    s_xor_b32 s41, s13, 3
    s_mul_i32 s41, s41, 36864
    s_add_u32 s63, s41, s40
    s_lshl_b32 s43, s13, 12
    s_mov_b64 s[8:9], s[56:57]
    s_add_u32 m0, s43, 0
    s_add_u32 s41, s60, 0
    buffer_load_dwordx4 v18, s[8:11], s41 offen offset:0 nt lds
    s_add_u32 s41, s60, 8192
    buffer_load_dwordx4 v18, s[8:11], s41 offen offset:1024 nt lds
    s_add_u32 s41, s60, 16384
    buffer_load_dwordx4 v18, s[8:11], s41 offen offset:2048 nt lds
    s_add_u32 s41, s60, 24576
    buffer_load_dwordx4 v18, s[8:11], s41 offen offset:3072 nt lds
    s_add_u32 m0, s43, 36864
    s_add_u32 s41, s61, 0
    buffer_load_dwordx4 v18, s[8:11], s41 offen offset:0 nt lds
    s_add_u32 s41, s61, 8192
    buffer_load_dwordx4 v18, s[8:11], s41 offen offset:1024 nt lds
    s_add_u32 s41, s61, 16384
    buffer_load_dwordx4 v18, s[8:11], s41 offen offset:2048 nt lds
    s_add_u32 s41, s61, 24576
    buffer_load_dwordx4 v18, s[8:11], s41 offen offset:3072 nt lds
    s_add_u32 m0, s43, 73728
    s_add_u32 s41, s62, 0
    buffer_load_dwordx4 v18, s[8:11], s41 offen offset:0 nt lds
    s_add_u32 s41, s62, 8192
    buffer_load_dwordx4 v18, s[8:11], s41 offen offset:1024 nt lds
    s_add_u32 s41, s62, 16384
    buffer_load_dwordx4 v18, s[8:11], s41 offen offset:2048 nt lds
    s_add_u32 s41, s62, 24576
    buffer_load_dwordx4 v18, s[8:11], s41 offen offset:3072 nt lds
    s_add_u32 m0, s43, 110592
    s_add_u32 s41, s63, 0
    buffer_load_dwordx4 v18, s[8:11], s41 offen offset:0 nt lds
    s_add_u32 s41, s63, 8192
    buffer_load_dwordx4 v18, s[8:11], s41 offen offset:1024 nt lds
    s_add_u32 s41, s63, 16384
    buffer_load_dwordx4 v18, s[8:11], s41 offen offset:2048 nt lds
    s_add_u32 s41, s63, 24576
    buffer_load_dwordx4 v18, s[8:11], s41 offen offset:3072 nt lds
    v_lshrrev_b32 v49, 1, v48
    v_mul_u32_u24 v19, 1152, v49
    v_and_b32 v49, 1, v48
    v_lshl_add_u32 v19, v49, 4, v19
    s_mul_i32 s41, s13, 224
    s_sub_u32 s41, 1024, s41
    v_add_u32 v19, s41, v19
    v_lshrrev_b32 v49, 4, v48
    v_lshlrev_b32 v50, 2, v49
    v_and_b32 v51, 15, v48
    v_xor_b32 v51, v51, v50
    v_lshlrev_b32 v51, 4, v51
    v_lshl_add_u32 v16, v49, 15, v51
    v_lshrrev_b32 v50, 1, v49
    v_lshl_add_u32 v17, v50, 16, v51
    v_and_b32 v50, 1, v49
    v_lshl_add_u32 v17, v50, 13, v17
    s_lshl_b32 s40, s12, 8
    s_mul_i32 s58, s13, 1048576
    s_add_u32 s58, s58, s40
    s_lshr_b32 s41, s13, 1
    s_mul_i32 s59, s41, 262144
    s_and_b32 s41, s13, 1
    s_lshl_b32 s41, s41, 14
    s_add_u32 s59, s59, s41
    s_add_u32 s59, s59, s40
    s_add_u32 s59, s59, 4194304
    v_bfe_u32 v50, v48, 2, 2
    v_xor_b32 v51, s13, v50
    v_lshlrev_b32 v20, 6, v51
    v_and_b32 v51, 3, v48
    v_lshl_add_u32 v20, v51, 4, v20
    v_lshrrev_b32 v23, 2, v48
    v_lshl_add_u32 v20, v23, 8, v20
    s_xor_b32 s41, s43, 0
    v_add_u32 v24, s41, v20
    s_xor_b32 s41, s43, 4096
    v_add_u32 v25, s41, v20
    s_xor_b32 s41, s43, 8192
    v_add_u32 v26, s41, v20
    s_xor_b32 s41, s43, 12288
    v_add_u32 v27, s41, v20
    v_and_b32 v23, 1, v50
    v_lshl_add_u32 v23, v49, 2, v23
    v_lshrrev_b32 v50, 1, v50
    v_lshlrev_b32 v21, 7, v23
    v_lshl_add_u32 v21, v50, 6, v21
    v_lshl_add_u32 v21, v51, 4, v21
    v_add_u32 v21, s43, v21
    v_lshlrev_b32 v22, 9, v50
    v_xor_b32 v22, v22, v21
    v_lshlrev_b32 v23, 5, v23
    v_lshl_add_u32 v23, v50, 10, v23
    v_lshl_add_u32 v23, v51, 3, v23
    v_add_u32 v23, s43, v23
    v_bfe_u32 v60, v65, 4, 6
    v_and_b32 v61, 15, v60
    v_lshrrev_b32 v62, 4, v60
    v_mov_b32 v64, 0x4444
    v_mov_b32 v77, 0xeeee
    v_cmp_lt_u32 vcc, 7, v61
    s_nop 1
    v_cndmask_b32 v64, v64, v77, vcc
    v_xor_b32 v66, 1024, v65
    v_xor_b32 v67, 2048, v65
    v_xor_b32 v68, 3072, v65
    v_and_b32 v69, 511, v65
    s_mul_i32 s96, s13, 36864
    s_add_u32 s96, s96, 16384
    v_lshlrev_b32 v70, 4, v60
    v_add_u32 v70, s96, v70
    v_lshrrev_b32 v79, 1, v69
    s_lshl_b32 s96, s13, 8
    s_add_u32 s96, s96, 14336
    s_lshl_b32 s33, s13, 10
    s_add_u32 s97, s33, 8192
    v_mov_b32 v77, s97
    v_mov_b32 v78, s96
    v_cmp_lt_u32 vcc, 31, v60
    s_nop 1
    v_cndmask_b32 v71, v77, v78, vcc
    v_add_u32 v71, v71, v79
    v_and_b32 v77, 7, v61
    v_lshrrev_b32 v78, 3, v61
    v_lshlrev_b32 v74, 4, v77
    v_lshl_add_u32 v73, v62, 7, v74
    v_lshl_add_u32 v73, v78, 3, v73
    s_lshl_b32 s96, s13, 9
    v_add_u32 v73, s96, v73
    v_lshl_add_u32 v74, v78, 14, v74
    v_lshl_add_u32 v74, v62, 15, v74
    s_lshl_b32 s96, s13, 17
    v_add_u32 v74, s96, v74
    v_bfe_u32 v77, v61, 2, 1
    v_and_b32 v78, 3, v61
    v_bfe_u32 v79, v61, 1, 2
    s_cmp_lt_u32 s13, 2
    s_cselect_b64 vcc, -1, 0
    v_cndmask_b32 v77, 0, v77, vcc
    v_cndmask_b32 v78, v79, v78, vcc
    v_lshlrev_b32 v75, 7, v77
    v_lshl_add_u32 v75, v62, 4, v75
    v_lshl_add_u32 v75, v78, 2, v75
    v_lshl_add_u32 v58, v77, 3, v78
    v_lshlrev_b32 v79, 1, v78
    v_cndmask_b32 v58, v79, v58, vcc
    s_bfe_u32 s97, s12, 0x10001
    s_lshl_b32 s68, s97, 6
    s_lshl_b32 s97, s97, 2
    v_add_u32 v59, s97, v62
    s_bfe_u32 s96, s12, 0x10002
    s_and_b32 s40, s12, 1
    s_lshl_b32 s96, s96, 1
    s_add_u32 s96, s96, s40
    s_lshr_b32 s97, s12, 3
    s_lshl_b32 s98, s13, 2
    s_add_u32 s98, s98, s97
    s_lshl_b32 s98, s98, 2
    s_add_u32 s98, s98, s96
    s_lshl_b32 s98, s98, 8
    s_lshl_b32 s99, s13, 2
    s_add_u32 s99, s99, s96
    s_lshl_b32 s99, s99, 4
    s_lshl_b32 s41, s97, 1
    s_add_u32 s41, s41, s40
    s_lshl_b32 s41, s41, 7
    s_add_u32 s41, s41, 8192
    s_lshl_b32 s40, s40, 3
    s_add_u32 s40, s40, 512
    s_cmp_lt_u32 s13, 2
    s_cselect_b32 s96, 7, 4
    s_cselect_b32 s98, s98, s41
    s_cselect_b32 s99, s99, s40
    s_cselect_b32 s32, 1, 0
    s_add_u32 s68, s68, s98
    s_lshl_b32 s97, s97, s96
    s_add_u32 s99, s99, s97
    v_add_u32 v58, s99, v58
    s_and_b32 s97, s12, 4
    s_or_b32 s97, s97, s13
    s_cmp_eq_u32 s97, 2
    s_cselect_b32 s32, 2, s32
    s_mov_b32 s8, s48
    s_mov_b32 s9, s49
    s_mov_b32 s10, 9216
    s_cmp_lt_u32 s13, 2
    s_cselect_b32 s96, 8, 2
    v_mul_u32_u24 v77, 1152, v59
    v_lshl_add_u32 v77, v58, 1, v77
    buffer_load_ushort v72, v77, s[8:11], 0 offen
    buffer_load_ushort v76, v77, s[8:11], s96 offen
    s_mov_b32 s10, 4718592
    s_waitcnt vmcnt(12) lgkmcnt(0)
    s_barrier
    s_mov_b64 s[8:9], s[56:57]
    s_add_u32 m0, s43, 147456
    s_add_u32 s41, s42, 0
    buffer_load_dwordx4 v19, s[8:11], s41 offen offset:0 nt lds
    s_add_u32 s41, s42, 35840
    buffer_load_dwordx4 v19, s[8:11], s41 offen offset:1024 nt lds
    s_add_u32 s41, s42, 71680
    buffer_load_dwordx4 v19, s[8:11], s41 offen offset:2048 nt lds
    s_add_u32 s41, s42, 107520
    buffer_load_dwordx4 v19, s[8:11], s41 offen offset:3072 nt lds
    v_mov_b32 v78, v21
    v_mov_b32 v79, v22
    v_add_u32 v77, 0, v79
    ds_read_b64_tr_b16 v[80:81], v77 offset:0
    ds_read_b64_tr_b16 v[82:83], v77 offset:256
    ds_read_b64_tr_b16 v[84:85], v77 offset:2048
    ds_read_b64_tr_b16 v[86:87], v77 offset:2304
    ds_read_b64_tr_b16 v[112:113], v77 offset:8
    ds_read_b64_tr_b16 v[114:115], v77 offset:264
    ds_read_b64_tr_b16 v[116:117], v77 offset:2056
    ds_read_b64_tr_b16 v[118:119], v77 offset:2312
    s_waitcnt vmcnt(12) lgkmcnt(0)
    s_barrier
    s_mov_b64 s[8:9], s[52:53]
    s_add_u32 m0, s43, 0
    s_add_u32 s41, s58, 0
    buffer_load_dwordx4 v16, s[8:11], s41 offen offset:0 nt lds
    s_add_u32 s41, s58, 15360
    buffer_load_dwordx4 v16, s[8:11], s41 offen offset:1024 nt lds
    s_add_u32 s41, s58, 129024
    buffer_load_dwordx4 v16, s[8:11], s41 offen offset:2048 nt lds
    s_add_u32 s41, s58, 144384
    buffer_load_dwordx4 v16, s[8:11], s41 offen offset:3072 nt lds
    v_add_u32 v77, 36864, v78
    ds_read_b64_tr_b16 v[88:89], v77 offset:0
    ds_read_b64_tr_b16 v[90:91], v77 offset:256
    ds_read_b64_tr_b16 v[92:93], v77 offset:2048
    ds_read_b64_tr_b16 v[94:95], v77 offset:2304
    ds_read_b64_tr_b16 v[120:121], v77 offset:8
    ds_read_b64_tr_b16 v[122:123], v77 offset:264
    ds_read_b64_tr_b16 v[124:125], v77 offset:2056
    ds_read_b64_tr_b16 v[126:127], v77 offset:2312
    s_waitcnt vmcnt(12) lgkmcnt(0)
    s_barrier
    s_add_u32 m0, s43, 36864
    s_add_u32 s41, s58, 8192
    buffer_load_dwordx4 v16, s[8:11], s41 offen offset:0 nt lds
    s_add_u32 s41, s58, 23552
    buffer_load_dwordx4 v16, s[8:11], s41 offen offset:1024 nt lds
    s_add_u32 s41, s58, 137216
    buffer_load_dwordx4 v16, s[8:11], s41 offen offset:2048 nt lds
    s_add_u32 s41, s58, 152576
    buffer_load_dwordx4 v16, s[8:11], s41 offen offset:3072 nt lds
    v_add_u32 v77, 73728, v78
    ds_read_b64_tr_b16 v[96:97], v77 offset:0
    ds_read_b64_tr_b16 v[98:99], v77 offset:256
    ds_read_b64_tr_b16 v[100:101], v77 offset:2048
    ds_read_b64_tr_b16 v[102:103], v77 offset:2304
    ds_read_b64_tr_b16 v[128:129], v77 offset:8
    ds_read_b64_tr_b16 v[130:131], v77 offset:264
    ds_read_b64_tr_b16 v[132:133], v77 offset:2056
    ds_read_b64_tr_b16 v[134:135], v77 offset:2312
    s_waitcnt vmcnt(12) lgkmcnt(0)
    s_barrier
    s_add_u32 m0, s43, 73728
    s_add_u32 s41, s58, 262144
    buffer_load_dwordx4 v16, s[8:11], s41 offen offset:0 nt lds
    s_add_u32 s41, s58, 277504
    buffer_load_dwordx4 v16, s[8:11], s41 offen offset:1024 nt lds
    s_add_u32 s41, s58, 391168
    buffer_load_dwordx4 v16, s[8:11], s41 offen offset:2048 nt lds
    s_add_u32 s41, s58, 406528
    buffer_load_dwordx4 v16, s[8:11], s41 offen offset:3072 nt lds
    v_add_u32 v77, 110592, v78
    ds_read_b64_tr_b16 v[104:105], v77 offset:0
    ds_read_b64_tr_b16 v[106:107], v77 offset:256
    ds_read_b64_tr_b16 v[108:109], v77 offset:2048
    ds_read_b64_tr_b16 v[110:111], v77 offset:2304
    ds_read_b64_tr_b16 v[136:137], v77 offset:8
    ds_read_b64_tr_b16 v[138:139], v77 offset:264
    ds_read_b64_tr_b16 v[140:141], v77 offset:2056
    ds_read_b64_tr_b16 v[142:143], v77 offset:2312
    s_waitcnt vmcnt(12) lgkmcnt(0)
    s_barrier
    s_add_u32 m0, s43, 110592
    s_add_u32 s41, s58, 270336
    buffer_load_dwordx4 v16, s[8:11], s41 offen offset:0 nt lds
    s_add_u32 s41, s58, 285696
    buffer_load_dwordx4 v16, s[8:11], s41 offen offset:1024 nt lds
    s_add_u32 s41, s58, 399360
    buffer_load_dwordx4 v16, s[8:11], s41 offen offset:2048 nt lds
    s_add_u32 s41, s58, 414720
    buffer_load_dwordx4 v16, s[8:11], s41 offen offset:3072 nt lds
    v_add_u32 v77, 147456, v23
    ds_read_b64_tr_b16 v[144:145], v77 offset:0
    ds_read_b64_tr_b16 v[146:147], v77 offset:64
    ds_read_b64_tr_b16 v[148:149], v77 offset:512
    ds_read_b64_tr_b16 v[150:151], v77 offset:576
    ds_read_b64_tr_b16 v[152:153], v77 offset:2048
    ds_read_b64_tr_b16 v[154:155], v77 offset:2112
    ds_read_b64_tr_b16 v[156:157], v77 offset:2560
    ds_read_b64_tr_b16 v[158:159], v77 offset:2624
    s_waitcnt vmcnt(12) lgkmcnt(0)
    s_barrier
    s_add_u32 m0, s43, 147456
    s_add_u32 s41, s58, 524288
    buffer_load_dwordx4 v16, s[8:11], s41 offen offset:0 nt lds
    s_add_u32 s41, s58, 539648
    buffer_load_dwordx4 v16, s[8:11], s41 offen offset:1024 nt lds
    s_add_u32 s41, s58, 653312
    buffer_load_dwordx4 v16, s[8:11], s41 offen offset:2048 nt lds
    s_add_u32 s41, s58, 668672
    buffer_load_dwordx4 v16, s[8:11], s41 offen offset:3072 nt lds
    s_cmp_eq_u32 s32, 0
    s_cbranch_scc1 cf_init_done
    v_mov_b32 v52, 1
    v_mov_b32 v53, 1
    v_mov_b32 v54, 1
    v_mov_b32 v55, 1
    v_mov_b32 v56, 0
    v_lshl_or_b32 v72, v76, 16, v72
    s_lshl_b32 s96, s12, 14
    s_add_u32 s96, s96, 68157440
    s_add_u32 s97, s96, 0
    buffer_store_dwordx4 v[52:55], v65, s[4:7], s97 offen
    buffer_load_dwordx4 v[60:63], v65, s[4:7], s97 offen sc1
    s_add_u32 s97, s96, 4096
    buffer_store_dwordx4 v[52:55], v65, s[4:7], s97 offen
    buffer_load_dwordx4 v[60:63], v65, s[4:7], s97 offen sc1
    s_add_u32 s97, s96, 8192
    buffer_store_dwordx4 v[52:55], v65, s[4:7], s97 offen
    buffer_load_dwordx4 v[60:63], v65, s[4:7], s97 offen sc1
    s_add_u32 s97, s96, 12288
    buffer_store_dwordx4 v[52:55], v65, s[4:7], s97 offen
    buffer_load_dwordx4 v[60:63], v65, s[4:7], s97 offen sc1
    s_add_u32 s96, s68, 67108864
    s_add_u32 s97, s96, 16384
    buffer_store_dword v56, v75, s[4:7], s96 offen offset:0
    buffer_store_dword v72, v75, s[4:7], s97 offen offset:0
    buffer_load_dword v60, v75, s[4:7], s96 offen offset:0 sc1
    buffer_load_dword v60, v75, s[4:7], s97 offen offset:0 sc1
    s_cmp_lg_u32 s32, 2
    s_cbranch_scc1 cf_init_done
    buffer_store_dword v56, v75, s[4:7], s96 offen offset:1024
    buffer_store_dword v72, v75, s[4:7], s97 offen offset:1024
    buffer_load_dword v60, v75, s[4:7], s96 offen offset:1024 sc1
    buffer_load_dword v60, v75, s[4:7], s97 offen offset:1024 sc1
    buffer_store_dword v56, v75, s[4:7], s96 offen offset:2048
    buffer_store_dword v72, v75, s[4:7], s97 offen offset:2048
    buffer_load_dword v60, v75, s[4:7], s96 offen offset:2048 sc1
    buffer_load_dword v60, v75, s[4:7], s97 offen offset:2048 sc1
    buffer_store_dword v56, v75, s[4:7], s96 offen offset:3072
    buffer_store_dword v72, v75, s[4:7], s97 offen offset:3072
    buffer_load_dword v60, v75, s[4:7], s96 offen offset:3072 sc1
    buffer_load_dword v60, v75, s[4:7], s97 offen offset:3072 sc1
cf_init_done:
    v_add_u32 v28, 0, v24
    v_add_u32 v29, 0, v25
    v_add_u32 v30, 0, v26
    v_add_u32 v31, 0, v27
    ds_read_b64_tr_b16 a[96:97], v28 offset:0
    ds_read_b64_tr_b16 a[104:105], v28 offset:8
    ds_read_b64_tr_b16 a[112:113], v29 offset:0
    ds_read_b64_tr_b16 a[120:121], v29 offset:8
    ds_read_b64_tr_b16 a[128:129], v30 offset:0
    ds_read_b64_tr_b16 a[136:137], v30 offset:8
    ds_read_b64_tr_b16 a[144:145], v31 offset:0
    ds_read_b64_tr_b16 v[32:33], v31 offset:8
    s_waitcnt vmcnt(12) lgkmcnt(0)
    s_barrier
    s_add_u32 m0, s43, 0
    s_add_u32 s41, s58, 532480
    buffer_load_dwordx4 v16, s[8:11], s41 offen offset:0 nt lds
    s_add_u32 s41, s58, 547840
    buffer_load_dwordx4 v16, s[8:11], s41 offen offset:1024 nt lds
    s_add_u32 s41, s58, 661504
    buffer_load_dwordx4 v16, s[8:11], s41 offen offset:2048 nt lds
    s_add_u32 s41, s58, 676864
    buffer_load_dwordx4 v16, s[8:11], s41 offen offset:3072 nt lds
    ds_write_b64 v70, v[32:33] offset:12288
    v_add_u32 v28, 36864, v24
    v_add_u32 v29, 36864, v25
    v_add_u32 v30, 36864, v26
    v_add_u32 v31, 36864, v27
    ds_read_b64_tr_b16 a[98:99], v28 offset:0
    ds_read_b64_tr_b16 a[106:107], v28 offset:8
    ds_read_b64_tr_b16 a[114:115], v29 offset:0
    ds_read_b64_tr_b16 a[122:123], v29 offset:8
    ds_read_b64_tr_b16 a[130:131], v30 offset:0
    ds_read_b64_tr_b16 a[138:139], v30 offset:8
    ds_read_b64_tr_b16 a[146:147], v31 offset:0
    ds_read_b64_tr_b16 v[0:1], v31 offset:8
    s_waitcnt vmcnt(12) lgkmcnt(0)
    s_barrier
    s_add_u32 m0, s43, 36864
    s_add_u32 s41, s58, 786432
    buffer_load_dwordx4 v16, s[8:11], s41 offen offset:0 nt lds
    s_add_u32 s41, s58, 801792
    buffer_load_dwordx4 v16, s[8:11], s41 offen offset:1024 nt lds
    s_add_u32 s41, s58, 915456
    buffer_load_dwordx4 v16, s[8:11], s41 offen offset:2048 nt lds
    s_add_u32 s41, s58, 930816
    buffer_load_dwordx4 v16, s[8:11], s41 offen offset:3072 nt lds
    ds_write_b64 v70, v[0:1] offset:12296
    v_add_u32 v28, 73728, v24
    v_add_u32 v29, 73728, v25
    v_add_u32 v30, 73728, v26
    v_add_u32 v31, 73728, v27
    ds_read_b64_tr_b16 a[100:101], v28 offset:0
    ds_read_b64_tr_b16 a[108:109], v28 offset:8
    ds_read_b64_tr_b16 a[116:117], v29 offset:0
    ds_read_b64_tr_b16 a[124:125], v29 offset:8
    ds_read_b64_tr_b16 a[132:133], v30 offset:0
    ds_read_b64_tr_b16 a[140:141], v30 offset:8
    ds_read_b64_tr_b16 a[148:149], v31 offset:0
    ds_read_b64_tr_b16 v[32:33], v31 offset:8
    s_waitcnt vmcnt(12) lgkmcnt(0)
    s_barrier
    s_add_u32 m0, s43, 73728
    s_add_u32 s41, s58, 794624
    buffer_load_dwordx4 v16, s[8:11], s41 offen offset:0 nt lds
    s_add_u32 s41, s58, 809984
    buffer_load_dwordx4 v16, s[8:11], s41 offen offset:1024 nt lds
    s_add_u32 s41, s58, 923648
    buffer_load_dwordx4 v16, s[8:11], s41 offen offset:2048 nt lds
    s_add_u32 s41, s58, 939008
    buffer_load_dwordx4 v16, s[8:11], s41 offen offset:3072 nt lds
    ds_write_b64 v70, v[32:33] offset:13312
    v_add_u32 v28, 110592, v24
    v_add_u32 v29, 110592, v25
    v_add_u32 v30, 110592, v26
    v_add_u32 v31, 110592, v27
    ds_read_b64_tr_b16 a[102:103], v28 offset:0
    ds_read_b64_tr_b16 a[110:111], v28 offset:8
    ds_read_b64_tr_b16 a[118:119], v29 offset:0
    ds_read_b64_tr_b16 a[126:127], v29 offset:8
    ds_read_b64_tr_b16 a[134:135], v30 offset:0
    ds_read_b64_tr_b16 a[142:143], v30 offset:8
    ds_read_b64_tr_b16 a[150:151], v31 offset:0
    ds_read_b64_tr_b16 v[0:1], v31 offset:8
    s_waitcnt vmcnt(12) lgkmcnt(0)
    s_barrier
    s_add_u32 m0, s43, 110592
    s_add_u32 s41, s59, 0
    buffer_load_dwordx4 v17, s[8:11], s41 offen offset:0 nt lds
    s_add_u32 s41, s59, 31744
    buffer_load_dwordx4 v17, s[8:11], s41 offen offset:1024 nt lds
    s_add_u32 s41, s59, 129024
    buffer_load_dwordx4 v17, s[8:11], s41 offen offset:2048 nt lds
    s_add_u32 s41, s59, 160768
    buffer_load_dwordx4 v17, s[8:11], s41 offen offset:3072 nt lds
    ds_write_b64 v70, v[0:1] offset:13320
    v_add_u32 v28, 147456, v24
    v_add_u32 v29, 147456, v25
    v_add_u32 v30, 147456, v26
    v_add_u32 v31, 147456, v27
    ds_read_b64_tr_b16 a[152:153], v28 offset:0
    ds_read_b64_tr_b16 a[160:161], v28 offset:8
    ds_read_b64_tr_b16 v[32:33], v29 offset:0
    ds_read_b64_tr_b16 a[168:169], v29 offset:8
    ds_read_b64_tr_b16 a[176:177], v30 offset:0
    ds_read_b64_tr_b16 a[184:185], v30 offset:8
    ds_read_b64_tr_b16 v[34:35], v31 offset:0
    ds_read_b64_tr_b16 a[192:193], v31 offset:8
    s_waitcnt vmcnt(12) lgkmcnt(0)
    s_barrier
    s_mov_b64 s[8:9], s[50:51]
    s_add_u32 m0, s43, 147456
    s_add_u32 s41, s58, 0
    buffer_load_dwordx4 v16, s[8:11], s41 offen offset:0 nt lds
    s_add_u32 s41, s58, 15360
    buffer_load_dwordx4 v16, s[8:11], s41 offen offset:1024 nt lds
    s_add_u32 s41, s58, 129024
    buffer_load_dwordx4 v16, s[8:11], s41 offen offset:2048 nt lds
    s_add_u32 s41, s58, 144384
    buffer_load_dwordx4 v16, s[8:11], s41 offen offset:3072 nt lds
    s_cmp_lg_u32 s13, 0
    s_cbranch_scc1 cf_ma
    v_mov_b32 v54, 1
    s_mov_b64 exec, 1
    buffer_atomic_add v54, off, s[84:87], 0 offset:132
    s_mov_b64 exec, -1
cf_ma:
    ds_write_b64 v70, v[32:33] offset:16384
    ds_write_b64 v70, v[34:35] offset:18432
    v_add_u32 v28, 0, v24
    v_add_u32 v29, 0, v25
    v_add_u32 v30, 0, v26
    v_add_u32 v31, 0, v27
    ds_read_b64_tr_b16 a[154:155], v28 offset:0
    ds_read_b64_tr_b16 a[162:163], v28 offset:8
    ds_read_b64_tr_b16 v[0:1], v29 offset:0
    ds_read_b64_tr_b16 a[170:171], v29 offset:8
    ds_read_b64_tr_b16 a[178:179], v30 offset:0
    ds_read_b64_tr_b16 a[186:187], v30 offset:8
    ds_read_b64_tr_b16 v[2:3], v31 offset:0
    ds_read_b64_tr_b16 a[194:195], v31 offset:8
    s_waitcnt vmcnt(12) lgkmcnt(0)
    s_barrier
    s_add_u32 m0, s43, 0
    s_add_u32 s41, s58, 8192
    buffer_load_dwordx4 v16, s[8:11], s41 offen offset:0 nt lds
    s_add_u32 s41, s58, 23552
    buffer_load_dwordx4 v16, s[8:11], s41 offen offset:1024 nt lds
    s_add_u32 s41, s58, 137216
    buffer_load_dwordx4 v16, s[8:11], s41 offen offset:2048 nt lds
    s_add_u32 s41, s58, 152576
    buffer_load_dwordx4 v16, s[8:11], s41 offen offset:3072 nt lds
    ds_write_b64 v70, v[0:1] offset:16392
    ds_write_b64 v70, v[2:3] offset:18440
    v_add_u32 v28, 36864, v24
    v_add_u32 v29, 36864, v25
    v_add_u32 v30, 36864, v26
    v_add_u32 v31, 36864, v27
    ds_read_b64_tr_b16 a[156:157], v28 offset:0
    ds_read_b64_tr_b16 a[164:165], v28 offset:8
    ds_read_b64_tr_b16 v[32:33], v29 offset:0
    ds_read_b64_tr_b16 a[172:173], v29 offset:8
    ds_read_b64_tr_b16 a[180:181], v30 offset:0
    ds_read_b64_tr_b16 a[188:189], v30 offset:8
    ds_read_b64_tr_b16 v[34:35], v31 offset:0
    ds_read_b64_tr_b16 a[196:197], v31 offset:8
    s_waitcnt vmcnt(12) lgkmcnt(0)
    s_barrier
    s_add_u32 m0, s43, 36864
    s_add_u32 s41, s58, 262144
    buffer_load_dwordx4 v16, s[8:11], s41 offen offset:0 nt lds
    s_add_u32 s41, s58, 277504
    buffer_load_dwordx4 v16, s[8:11], s41 offen offset:1024 nt lds
    s_add_u32 s41, s58, 391168
    buffer_load_dwordx4 v16, s[8:11], s41 offen offset:2048 nt lds
    s_add_u32 s41, s58, 406528
    buffer_load_dwordx4 v16, s[8:11], s41 offen offset:3072 nt lds
    ds_write_b64 v70, v[32:33] offset:17408
    ds_write_b64 v70, v[34:35] offset:19456
    v_add_u32 v28, 73728, v24
    v_add_u32 v29, 73728, v25
    v_add_u32 v30, 73728, v26
    v_add_u32 v31, 73728, v27
    ds_read_b64_tr_b16 a[158:159], v28 offset:0
    ds_read_b64_tr_b16 a[166:167], v28 offset:8
    ds_read_b64_tr_b16 v[0:1], v29 offset:0
    ds_read_b64_tr_b16 a[174:175], v29 offset:8
    ds_read_b64_tr_b16 a[182:183], v30 offset:0
    ds_read_b64_tr_b16 a[190:191], v30 offset:8
    ds_read_b64_tr_b16 v[2:3], v31 offset:0
    ds_read_b64_tr_b16 a[198:199], v31 offset:8
    s_waitcnt vmcnt(12) lgkmcnt(0)
    s_barrier
    s_add_u32 m0, s43, 73728
    s_add_u32 s41, s58, 270336
    buffer_load_dwordx4 v16, s[8:11], s41 offen offset:0 nt lds
    s_add_u32 s41, s58, 285696
    buffer_load_dwordx4 v16, s[8:11], s41 offen offset:1024 nt lds
    s_add_u32 s41, s58, 399360
    buffer_load_dwordx4 v16, s[8:11], s41 offen offset:2048 nt lds
    s_add_u32 s41, s58, 414720
    buffer_load_dwordx4 v16, s[8:11], s41 offen offset:3072 nt lds
    ds_write_b64 v70, v[0:1] offset:17416
    ds_write_b64 v70, v[2:3] offset:19464
    v_add_u32 v77, 110592, v20
    ds_read_b64_tr_b16 a[200:201], v77 offset:0
    ds_read_b64_tr_b16 a[202:203], v77 offset:4096
    ds_read_b64_tr_b16 a[204:205], v77 offset:8192
    ds_read_b64_tr_b16 a[206:207], v77 offset:12288
    ds_read_b64_tr_b16 a[208:209], v77 offset:8
    ds_read_b64_tr_b16 a[210:211], v77 offset:4104
    ds_read_b64_tr_b16 a[212:213], v77 offset:8200
    ds_read_b64_tr_b16 a[214:215], v77 offset:12296
    s_waitcnt vmcnt(12) lgkmcnt(0)
    s_barrier
    s_add_u32 m0, s43, 110592
    s_add_u32 s41, s58, 524288
    buffer_load_dwordx4 v16, s[8:11], s41 offen offset:0 nt lds
    s_add_u32 s41, s58, 539648
    buffer_load_dwordx4 v16, s[8:11], s41 offen offset:1024 nt lds
    s_add_u32 s41, s58, 653312
    buffer_load_dwordx4 v16, s[8:11], s41 offen offset:2048 nt lds
    s_add_u32 s41, s58, 668672
    buffer_load_dwordx4 v16, s[8:11], s41 offen offset:3072 nt lds
    v_add_u32 v28, 147456, v24
    v_add_u32 v29, 147456, v25
    v_add_u32 v30, 147456, v26
    v_add_u32 v31, 147456, v27
    ds_read_b64_tr_b16 v[0:1], v28 offset:0
    ds_read_b64_tr_b16 v[2:3], v28 offset:8
    ds_read_b64_tr_b16 v[4:5], v29 offset:0
    ds_read_b64_tr_b16 v[6:7], v29 offset:8
    ds_read_b64_tr_b16 a[0:1], v30 offset:0
    ds_read_b64_tr_b16 v[8:9], v30 offset:8
    ds_read_b64_tr_b16 a[8:9], v31 offset:0
    ds_read_b64_tr_b16 v[10:11], v31 offset:8
    s_waitcnt vmcnt(12) lgkmcnt(0)
    s_barrier
    s_add_u32 m0, s43, 147456
    s_add_u32 s41, s58, 532480
    buffer_load_dwordx4 v16, s[8:11], s41 offen offset:0 nt lds
    s_add_u32 s41, s58, 547840
    buffer_load_dwordx4 v16, s[8:11], s41 offen offset:1024 nt lds
    s_add_u32 s41, s58, 661504
    buffer_load_dwordx4 v16, s[8:11], s41 offen offset:2048 nt lds
    s_add_u32 s41, s58, 676864
    buffer_load_dwordx4 v16, s[8:11], s41 offen offset:3072 nt lds
    ds_write_b64 v70, v[0:1] offset:0
    ds_write_b64 v70, v[2:3] offset:2048
    ds_write_b64 v70, v[4:5] offset:4096
    ds_write_b64 v70, v[6:7] offset:6144
    ds_write_b64 v70, v[8:9] offset:10240
    ds_write_b64 v70, v[10:11] offset:14336
    v_add_u32 v28, 0, v24
    v_add_u32 v29, 0, v25
    v_add_u32 v30, 0, v26
    v_add_u32 v31, 0, v27
    ds_read_b64_tr_b16 v[32:33], v28 offset:0
    ds_read_b64_tr_b16 v[34:35], v28 offset:8
    ds_read_b64_tr_b16 v[36:37], v29 offset:0
    ds_read_b64_tr_b16 v[38:39], v29 offset:8
    ds_read_b64_tr_b16 a[2:3], v30 offset:0
    ds_read_b64_tr_b16 v[40:41], v30 offset:8
    ds_read_b64_tr_b16 a[10:11], v31 offset:0
    ds_read_b64_tr_b16 v[42:43], v31 offset:8
    s_waitcnt vmcnt(12) lgkmcnt(0)
    s_barrier
    s_add_u32 m0, s43, 0
    s_add_u32 s41, s58, 786432
    buffer_load_dwordx4 v16, s[8:11], s41 offen offset:0 nt lds
    s_add_u32 s41, s58, 801792
    buffer_load_dwordx4 v16, s[8:11], s41 offen offset:1024 nt lds
    s_add_u32 s41, s58, 915456
    buffer_load_dwordx4 v16, s[8:11], s41 offen offset:2048 nt lds
    s_add_u32 s41, s58, 930816
    buffer_load_dwordx4 v16, s[8:11], s41 offen offset:3072 nt lds
    ds_write_b64 v70, v[32:33] offset:8
    ds_write_b64 v70, v[34:35] offset:2056
    ds_write_b64 v70, v[36:37] offset:4104
    ds_write_b64 v70, v[38:39] offset:6152
    ds_write_b64 v70, v[40:41] offset:10248
    ds_write_b64 v70, v[42:43] offset:14344
    v_add_u32 v28, 36864, v24
    v_add_u32 v29, 36864, v25
    v_add_u32 v30, 36864, v26
    v_add_u32 v31, 36864, v27
    ds_read_b64_tr_b16 v[0:1], v28 offset:0
    ds_read_b64_tr_b16 v[2:3], v28 offset:8
    ds_read_b64_tr_b16 v[4:5], v29 offset:0
    ds_read_b64_tr_b16 v[6:7], v29 offset:8
    ds_read_b64_tr_b16 a[4:5], v30 offset:0
    ds_read_b64_tr_b16 v[8:9], v30 offset:8
    ds_read_b64_tr_b16 a[12:13], v31 offset:0
    ds_read_b64_tr_b16 v[10:11], v31 offset:8
    s_waitcnt vmcnt(12) lgkmcnt(0)
    s_barrier
    s_add_u32 m0, s43, 36864
    s_add_u32 s41, s58, 794624
    buffer_load_dwordx4 v16, s[8:11], s41 offen offset:0 nt lds
    s_add_u32 s41, s58, 809984
    buffer_load_dwordx4 v16, s[8:11], s41 offen offset:1024 nt lds
    s_add_u32 s41, s58, 923648
    buffer_load_dwordx4 v16, s[8:11], s41 offen offset:2048 nt lds
    s_add_u32 s41, s58, 939008
    buffer_load_dwordx4 v16, s[8:11], s41 offen offset:3072 nt lds
    ds_write_b64 v70, v[0:1] offset:1024
    ds_write_b64 v70, v[2:3] offset:3072
    ds_write_b64 v70, v[4:5] offset:5120
    ds_write_b64 v70, v[6:7] offset:7168
    ds_write_b64 v70, v[8:9] offset:11264
    ds_write_b64 v70, v[10:11] offset:15360
    v_add_u32 v28, 73728, v24
    v_add_u32 v29, 73728, v25
    v_add_u32 v30, 73728, v26
    v_add_u32 v31, 73728, v27
    ds_read_b64_tr_b16 v[32:33], v28 offset:0
    ds_read_b64_tr_b16 v[34:35], v28 offset:8
    ds_read_b64_tr_b16 v[36:37], v29 offset:0
    ds_read_b64_tr_b16 v[38:39], v29 offset:8
    ds_read_b64_tr_b16 a[6:7], v30 offset:0
    ds_read_b64_tr_b16 v[40:41], v30 offset:8
    ds_read_b64_tr_b16 a[14:15], v31 offset:0
    ds_read_b64_tr_b16 v[42:43], v31 offset:8
    s_waitcnt vmcnt(12) lgkmcnt(0)
    s_barrier
    s_add_u32 m0, s43, 73728
    s_add_u32 s41, s59, 0
    buffer_load_dwordx4 v17, s[8:11], s41 offen offset:0 nt lds
    s_add_u32 s41, s59, 31744
    buffer_load_dwordx4 v17, s[8:11], s41 offen offset:1024 nt lds
    s_add_u32 s41, s59, 129024
    buffer_load_dwordx4 v17, s[8:11], s41 offen offset:2048 nt lds
    s_add_u32 s41, s59, 160768
    buffer_load_dwordx4 v17, s[8:11], s41 offen offset:3072 nt lds
    ds_write_b64 v70, v[32:33] offset:1032
    ds_write_b64 v70, v[34:35] offset:3080
    ds_write_b64 v70, v[36:37] offset:5128
    ds_write_b64 v70, v[38:39] offset:7176
    ds_write_b64 v70, v[40:41] offset:11272
    ds_write_b64 v70, v[42:43] offset:15368
    v_add_u32 v28, 110592, v24
    v_add_u32 v29, 110592, v25
    v_add_u32 v30, 110592, v26
    v_add_u32 v31, 110592, v27
    ds_read_b64_tr_b16 a[16:17], v28 offset:0
    ds_read_b64_tr_b16 a[24:25], v28 offset:8
    ds_read_b64_tr_b16 a[32:33], v29 offset:0
    ds_read_b64_tr_b16 a[40:41], v29 offset:8
    ds_read_b64_tr_b16 a[48:49], v30 offset:0
    ds_read_b64_tr_b16 a[56:57], v30 offset:8
    ds_read_b64_tr_b16 a[64:65], v31 offset:0
    ds_read_b64_tr_b16 a[72:73], v31 offset:8
    s_waitcnt vmcnt(12) lgkmcnt(0)
    s_barrier
    s_mov_b64 s[8:9], s[54:55]
    s_add_u32 m0, s43, 110592
    s_add_u32 s41, s58, 0
    buffer_load_dwordx4 v16, s[8:11], s41 offen offset:0 nt lds
    s_add_u32 s41, s58, 15360
    buffer_load_dwordx4 v16, s[8:11], s41 offen offset:1024 nt lds
    s_add_u32 s41, s58, 129024
    buffer_load_dwordx4 v16, s[8:11], s41 offen offset:2048 nt lds
    s_add_u32 s41, s58, 144384
    buffer_load_dwordx4 v16, s[8:11], s41 offen offset:3072 nt lds
    v_add_u32 v28, 147456, v24
    v_add_u32 v29, 147456, v25
    v_add_u32 v30, 147456, v26
    v_add_u32 v31, 147456, v27
    ds_read_b64_tr_b16 a[18:19], v28 offset:0
    ds_read_b64_tr_b16 a[26:27], v28 offset:8
    ds_read_b64_tr_b16 a[34:35], v29 offset:0
    ds_read_b64_tr_b16 a[42:43], v29 offset:8
    ds_read_b64_tr_b16 a[50:51], v30 offset:0
    ds_read_b64_tr_b16 a[58:59], v30 offset:8
    ds_read_b64_tr_b16 a[66:67], v31 offset:0
    ds_read_b64_tr_b16 a[74:75], v31 offset:8
    s_waitcnt vmcnt(12) lgkmcnt(0)
    s_barrier
    s_add_u32 m0, s43, 147456
    s_add_u32 s41, s58, 8192
    buffer_load_dwordx4 v16, s[8:11], s41 offen offset:0 nt lds
    s_add_u32 s41, s58, 23552
    buffer_load_dwordx4 v16, s[8:11], s41 offen offset:1024 nt lds
    s_add_u32 s41, s58, 137216
    buffer_load_dwordx4 v16, s[8:11], s41 offen offset:2048 nt lds
    s_add_u32 s41, s58, 152576
    buffer_load_dwordx4 v16, s[8:11], s41 offen offset:3072 nt lds
    v_add_u32 v28, 0, v24
    v_add_u32 v29, 0, v25
    v_add_u32 v30, 0, v26
    v_add_u32 v31, 0, v27
    ds_read_b64_tr_b16 a[20:21], v28 offset:0
    ds_read_b64_tr_b16 a[28:29], v28 offset:8
    ds_read_b64_tr_b16 a[36:37], v29 offset:0
    ds_read_b64_tr_b16 a[44:45], v29 offset:8
    ds_read_b64_tr_b16 a[52:53], v30 offset:0
    ds_read_b64_tr_b16 a[60:61], v30 offset:8
    ds_read_b64_tr_b16 a[68:69], v31 offset:0
    ds_read_b64_tr_b16 a[76:77], v31 offset:8
    s_waitcnt vmcnt(12) lgkmcnt(0)
    s_barrier
    s_add_u32 m0, s43, 0
    s_add_u32 s41, s58, 262144
    buffer_load_dwordx4 v16, s[8:11], s41 offen offset:0 nt lds
    s_add_u32 s41, s58, 277504
    buffer_load_dwordx4 v16, s[8:11], s41 offen offset:1024 nt lds
    s_add_u32 s41, s58, 391168
    buffer_load_dwordx4 v16, s[8:11], s41 offen offset:2048 nt lds
    s_add_u32 s41, s58, 406528
    buffer_load_dwordx4 v16, s[8:11], s41 offen offset:3072 nt lds
    v_add_u32 v28, 36864, v24
    v_add_u32 v29, 36864, v25
    v_add_u32 v30, 36864, v26
    v_add_u32 v31, 36864, v27
    ds_read_b64_tr_b16 a[22:23], v28 offset:0
    ds_read_b64_tr_b16 a[30:31], v28 offset:8
    ds_read_b64_tr_b16 a[38:39], v29 offset:0
    ds_read_b64_tr_b16 a[46:47], v29 offset:8
    ds_read_b64_tr_b16 a[54:55], v30 offset:0
    ds_read_b64_tr_b16 a[62:63], v30 offset:8
    ds_read_b64_tr_b16 a[70:71], v31 offset:0
    ds_read_b64_tr_b16 a[78:79], v31 offset:8
    s_waitcnt vmcnt(12) lgkmcnt(0)
    s_barrier
    s_add_u32 m0, s43, 36864
    s_add_u32 s41, s58, 270336
    buffer_load_dwordx4 v16, s[8:11], s41 offen offset:0 nt lds
    s_add_u32 s41, s58, 285696
    buffer_load_dwordx4 v16, s[8:11], s41 offen offset:1024 nt lds
    s_add_u32 s41, s58, 399360
    buffer_load_dwordx4 v16, s[8:11], s41 offen offset:2048 nt lds
    s_add_u32 s41, s58, 414720
    buffer_load_dwordx4 v16, s[8:11], s41 offen offset:3072 nt lds
    s_lshl_b32 s26, s12, 14
    s_add_u32 s26, s26, 0
    s_mul_i32 s40, s13, 3072
    s_add_u32 s24, s26, s40
    s_lshl_b32 s96, s12, 7
    s_add_u32 s29, s96, 125845504
    s_add_u32 s96, s96, 125829120
    v_bfe_u32 v78, v65, 2, 5
    buffer_load_dword v54, off, s[84:87], 0 offset:132 sc1
    buffer_load_dword v55, off, s[84:87], 0 offset:216 sc1
    buffer_load_dword v56, v78, s[4:7], s96 offen offset:16 sc1
    v_add_u32 v77, 73728, v20
    ds_read_b64_tr_b16 a[80:81], v77 offset:0
    ds_read_b64_tr_b16 a[82:83], v77 offset:4096
    ds_read_b64_tr_b16 a[84:85], v77 offset:8192
    ds_read_b64_tr_b16 a[86:87], v77 offset:12288
    ds_read_b64_tr_b16 a[88:89], v77 offset:8
    ds_read_b64_tr_b16 a[90:91], v77 offset:4104
    ds_read_b64_tr_b16 a[92:93], v77 offset:8200
    ds_read_b64_tr_b16 a[94:95], v77 offset:12296
    s_waitcnt vmcnt(12) lgkmcnt(0)
    s_barrier
    s_add_u32 m0, s43, 73728
    s_add_u32 s41, s58, 524288
    buffer_load_dwordx4 v16, s[8:11], s41 offen offset:0 nt lds
    s_add_u32 s41, s58, 539648
    buffer_load_dwordx4 v16, s[8:11], s41 offen offset:1024 nt lds
    s_add_u32 s41, s58, 653312
    buffer_load_dwordx4 v16, s[8:11], s41 offen offset:2048 nt lds
    s_add_u32 s41, s58, 668672
    buffer_load_dwordx4 v16, s[8:11], s41 offen offset:3072 nt lds
    v_add_u32 v28, 110592, v24
    v_add_u32 v29, 110592, v25
    v_add_u32 v30, 110592, v26
    v_add_u32 v31, 110592, v27
    ds_read_b64_tr_b16 a[216:217], v28 offset:0
    ds_read_b64_tr_b16 v[32:33], v28 offset:8
    ds_read_b64_tr_b16 a[224:225], v29 offset:0
    ds_read_b64_tr_b16 a[232:233], v29 offset:8
    ds_read_b64_tr_b16 a[240:241], v30 offset:0
    ds_read_b64_tr_b16 a[248:249], v30 offset:8
    ds_read_b64_tr_b16 v[160:161], v31 offset:0
    ds_read_b64_tr_b16 v[168:169], v31 offset:8
    s_waitcnt vmcnt(12) lgkmcnt(0)
    s_barrier
    s_add_u32 m0, s43, 110592
    s_add_u32 s41, s58, 532480
    buffer_load_dwordx4 v16, s[8:11], s41 offen offset:0 nt lds
    s_add_u32 s41, s58, 547840
    buffer_load_dwordx4 v16, s[8:11], s41 offen offset:1024 nt lds
    s_add_u32 s41, s58, 661504
    buffer_load_dwordx4 v16, s[8:11], s41 offen offset:2048 nt lds
    s_add_u32 s41, s58, 676864
    buffer_load_dwordx4 v16, s[8:11], s41 offen offset:3072 nt lds
    ds_write_b64 v70, v[32:33] offset:8192
    v_add_u32 v28, 147456, v24
    v_add_u32 v29, 147456, v25
    v_add_u32 v30, 147456, v26
    v_add_u32 v31, 147456, v27
    ds_read_b64_tr_b16 a[218:219], v28 offset:0
    ds_read_b64_tr_b16 v[0:1], v28 offset:8
    ds_read_b64_tr_b16 a[226:227], v29 offset:0
    ds_read_b64_tr_b16 a[234:235], v29 offset:8
    ds_read_b64_tr_b16 a[242:243], v30 offset:0
    ds_read_b64_tr_b16 a[250:251], v30 offset:8
    ds_read_b64_tr_b16 v[162:163], v31 offset:0
    ds_read_b64_tr_b16 v[170:171], v31 offset:8
    s_waitcnt vmcnt(12) lgkmcnt(0)
    s_barrier
    s_add_u32 m0, s43, 147456
    s_add_u32 s41, s58, 786432
    buffer_load_dwordx4 v16, s[8:11], s41 offen offset:0 nt lds
    s_add_u32 s41, s58, 801792
    buffer_load_dwordx4 v16, s[8:11], s41 offen offset:1024 nt lds
    s_add_u32 s41, s58, 915456
    buffer_load_dwordx4 v16, s[8:11], s41 offen offset:2048 nt lds
    s_add_u32 s41, s58, 930816
    buffer_load_dwordx4 v16, s[8:11], s41 offen offset:3072 nt lds
    ds_write_b64 v70, v[0:1] offset:8200
    v_add_u32 v28, 0, v24
    v_add_u32 v29, 0, v25
    v_add_u32 v30, 0, v26
    v_add_u32 v31, 0, v27
    ds_read_b64_tr_b16 a[220:221], v28 offset:0
    ds_read_b64_tr_b16 v[32:33], v28 offset:8
    ds_read_b64_tr_b16 a[228:229], v29 offset:0
    ds_read_b64_tr_b16 a[236:237], v29 offset:8
    ds_read_b64_tr_b16 a[244:245], v30 offset:0
    ds_read_b64_tr_b16 a[252:253], v30 offset:8
    ds_read_b64_tr_b16 v[164:165], v31 offset:0
    ds_read_b64_tr_b16 v[172:173], v31 offset:8
    s_waitcnt vmcnt(12) lgkmcnt(0)
    s_barrier
    s_add_u32 m0, s43, 0
    s_add_u32 s41, s58, 794624
    buffer_load_dwordx4 v16, s[8:11], s41 offen offset:0 nt lds
    s_add_u32 s41, s58, 809984
    buffer_load_dwordx4 v16, s[8:11], s41 offen offset:1024 nt lds
    s_add_u32 s41, s58, 923648
    buffer_load_dwordx4 v16, s[8:11], s41 offen offset:2048 nt lds
    s_add_u32 s41, s58, 939008
    buffer_load_dwordx4 v16, s[8:11], s41 offen offset:3072 nt lds
    ds_write_b64 v70, v[32:33] offset:9216
    v_add_u32 v28, 36864, v24
    v_add_u32 v29, 36864, v25
    v_add_u32 v30, 36864, v26
    v_add_u32 v31, 36864, v27
    ds_read_b64_tr_b16 a[222:223], v28 offset:0
    ds_read_b64_tr_b16 v[0:1], v28 offset:8
    ds_read_b64_tr_b16 a[230:231], v29 offset:0
    ds_read_b64_tr_b16 a[238:239], v29 offset:8
    ds_read_b64_tr_b16 a[246:247], v30 offset:0
    ds_read_b64_tr_b16 a[254:255], v30 offset:8
    ds_read_b64_tr_b16 v[166:167], v31 offset:0
    ds_read_b64_tr_b16 v[174:175], v31 offset:8
    s_waitcnt vmcnt(12) lgkmcnt(0)
    s_barrier
    s_add_u32 m0, s43, 36864
    s_add_u32 s41, s59, 0
    buffer_load_dwordx4 v17, s[8:11], s41 offen offset:0 nt lds
    s_add_u32 s41, s59, 31744
    buffer_load_dwordx4 v17, s[8:11], s41 offen offset:1024 nt lds
    s_add_u32 s41, s59, 129024
    buffer_load_dwordx4 v17, s[8:11], s41 offen offset:2048 nt lds
    s_add_u32 s41, s59, 160768
    buffer_load_dwordx4 v17, s[8:11], s41 offen offset:3072 nt lds
    v_readfirstlane_b32 s94, v54
    v_readfirstlane_b32 s95, v55
    v_mov_b32 v77, v56
    s_nop 0
    v_subrev_u32 v77, s95, v77
    v_cmp_lt_u32 vcc, 16, v77
    s_nop 1
    v_cndmask_b32 v77, v77, 0, vcc
    v_bfe_u32 v79, v78, 2, 2
    v_lshl_add_u32 v77, v77, 2, v79
    s_nop 1
    v_min_u32_dpp v77, v77, v77 row_ror:1 row_mask:0xf bank_mask:0xf
    s_nop 1
    v_min_u32_dpp v77, v77, v77 row_ror:2 row_mask:0xf bank_mask:0xf
    s_nop 1
    v_min_u32_dpp v77, v77, v77 row_ror:4 row_mask:0xf bank_mask:0xf
    s_nop 0
    v_readfirstlane_b32 s97, v77
    s_cmp_eq_u32 s95, 0
    s_cselect_b32 s97, 0, s97
    s_cmp_lt_u32 s97, 3
    s_cbranch_scc1 cf_mb
    s_add_u32 s40, s24, 0
    s_add_u32 s40, s40, s33
    s_sub_u32 s41, s96, s40
    v_bfe_u32 v77, v65, 2, 5
    v_add3_u32 v77, v77, s41, 16
    v_lshlrev_b32 v78, 3, v69
    s_nop 0
    v_mov_b32_dpp v78, v77 quad_perm:[0,1,2,3] row_mask:0xc bank_mask:0xf
    buffer_load_dword v58, v78, s[4:7], s40 offen sc1
    s_add_u32 s40, s24, 524288
    s_add_u32 s40, s40, s33
    s_sub_u32 s41, s96, s40
    v_bfe_u32 v77, v65, 2, 5
    v_add3_u32 v77, v77, s41, 16
    v_lshlrev_b32 v78, 3, v69
    s_nop 0
    v_mov_b32_dpp v78, v77 quad_perm:[0,1,2,3] row_mask:0xc bank_mask:0xf
    buffer_load_dword v58, v78, s[4:7], s40 offen sc1
cf_mb:
    s_cmp_lt_u32 s94, 32
    s_cbranch_scc1 cf_mc
    s_cmp_lg_u32 s13, 0
    s_cbranch_scc1 cf_mc
    v_mov_b32 v76, 1
    v_mov_b32 v77, 0
    s_mov_b64 exec, 1
    buffer_atomic_cmpswap v[76:77], off, s[84:87], 0 offset:28 sc0
    s_mov_b64 exec, -1
cf_mc:
    s_nop 1
    ds_write_b64 v70, v[0:1] offset:9224
    v_add_u32 v28, 73728, v24
    v_add_u32 v29, 73728, v25
    v_add_u32 v30, 73728, v26
    v_add_u32 v31, 73728, v27
    ds_read_b64_tr_b16 v[176:177], v28 offset:0
    ds_read_b64_tr_b16 v[184:185], v28 offset:8
    ds_read_b64_tr_b16 v[192:193], v29 offset:0
    ds_read_b64_tr_b16 v[200:201], v29 offset:8
    ds_read_b64_tr_b16 v[208:209], v30 offset:0
    ds_read_b64_tr_b16 v[216:217], v30 offset:8
    ds_read_b64_tr_b16 v[224:225], v31 offset:0
    ds_read_b64_tr_b16 v[232:233], v31 offset:8
    s_waitcnt vmcnt(12) lgkmcnt(0)
    s_barrier
    s_mov_b64 s[8:9], s[56:57]
    s_add_u32 m0, s43, 73728
    s_add_u32 s41, s60, 128
    buffer_load_dwordx4 v18, s[8:11], s41 offen offset:0 nt lds
    s_add_u32 s41, s60, 8320
    buffer_load_dwordx4 v18, s[8:11], s41 offen offset:1024 nt lds
    s_add_u32 s41, s60, 16512
    buffer_load_dwordx4 v18, s[8:11], s41 offen offset:2048 nt lds
    s_add_u32 s41, s60, 24704
    buffer_load_dwordx4 v18, s[8:11], s41 offen offset:3072 nt lds
    v_add_u32 v28, 110592, v24
    v_add_u32 v29, 110592, v25
    v_add_u32 v30, 110592, v26
    v_add_u32 v31, 110592, v27
    ds_read_b64_tr_b16 v[178:179], v28 offset:0
    ds_read_b64_tr_b16 v[186:187], v28 offset:8
    ds_read_b64_tr_b16 v[194:195], v29 offset:0
    ds_read_b64_tr_b16 v[202:203], v29 offset:8
    ds_read_b64_tr_b16 v[210:211], v30 offset:0
    ds_read_b64_tr_b16 v[218:219], v30 offset:8
    ds_read_b64_tr_b16 v[226:227], v31 offset:0
    ds_read_b64_tr_b16 v[234:235], v31 offset:8
    s_waitcnt vmcnt(12) lgkmcnt(0)
    s_barrier
    s_add_u32 m0, s43, 110592
    s_add_u32 s41, s61, 128
    buffer_load_dwordx4 v18, s[8:11], s41 offen offset:0 nt lds
    s_add_u32 s41, s61, 8320
    buffer_load_dwordx4 v18, s[8:11], s41 offen offset:1024 nt lds
    s_add_u32 s41, s61, 16512
    buffer_load_dwordx4 v18, s[8:11], s41 offen offset:2048 nt lds
    s_add_u32 s41, s61, 24704
    buffer_load_dwordx4 v18, s[8:11], s41 offen offset:3072 nt lds
    v_add_u32 v28, 147456, v24
    v_add_u32 v29, 147456, v25
    v_add_u32 v30, 147456, v26
    v_add_u32 v31, 147456, v27
    ds_read_b64_tr_b16 v[180:181], v28 offset:0
    ds_read_b64_tr_b16 v[188:189], v28 offset:8
    ds_read_b64_tr_b16 v[196:197], v29 offset:0
    ds_read_b64_tr_b16 v[204:205], v29 offset:8
    ds_read_b64_tr_b16 v[212:213], v30 offset:0
    ds_read_b64_tr_b16 v[220:221], v30 offset:8
    ds_read_b64_tr_b16 v[228:229], v31 offset:0
    ds_read_b64_tr_b16 v[236:237], v31 offset:8
    s_waitcnt vmcnt(12) lgkmcnt(0)
    s_barrier
    s_add_u32 m0, s43, 147456
    s_add_u32 s41, s62, 128
    buffer_load_dwordx4 v18, s[8:11], s41 offen offset:0 nt lds
    s_add_u32 s41, s62, 8320
    buffer_load_dwordx4 v18, s[8:11], s41 offen offset:1024 nt lds
    s_add_u32 s41, s62, 16512
    buffer_load_dwordx4 v18, s[8:11], s41 offen offset:2048 nt lds
    s_add_u32 s41, s62, 24704
    buffer_load_dwordx4 v18, s[8:11], s41 offen offset:3072 nt lds
    v_add_u32 v28, 0, v24
    v_add_u32 v29, 0, v25
    v_add_u32 v30, 0, v26
    v_add_u32 v31, 0, v27
    ds_read_b64_tr_b16 v[182:183], v28 offset:0
    ds_read_b64_tr_b16 v[190:191], v28 offset:8
    ds_read_b64_tr_b16 v[198:199], v29 offset:0
    ds_read_b64_tr_b16 v[206:207], v29 offset:8
    ds_read_b64_tr_b16 v[214:215], v30 offset:0
    ds_read_b64_tr_b16 v[222:223], v30 offset:8
    ds_read_b64_tr_b16 v[230:231], v31 offset:0
    ds_read_b64_tr_b16 v[238:239], v31 offset:8
    s_waitcnt vmcnt(12) lgkmcnt(0)
    s_barrier
    s_add_u32 m0, s43, 0
    s_add_u32 s41, s63, 128
    buffer_load_dwordx4 v18, s[8:11], s41 offen offset:0 nt lds
    s_add_u32 s41, s63, 8320
    buffer_load_dwordx4 v18, s[8:11], s41 offen offset:1024 nt lds
    s_add_u32 s41, s63, 16512
    buffer_load_dwordx4 v18, s[8:11], s41 offen offset:2048 nt lds
    s_add_u32 s41, s63, 24704
    buffer_load_dwordx4 v18, s[8:11], s41 offen offset:3072 nt lds
    v_mov_b32 v78, v21
    v_mov_b32 v79, v22
    v_add_u32 v77, 36864, v20
    ds_read_b64_tr_b16 v[240:241], v77 offset:0
    ds_read_b64_tr_b16 v[242:243], v77 offset:4096
    ds_read_b64_tr_b16 v[244:245], v77 offset:8192
    ds_read_b64_tr_b16 v[246:247], v77 offset:12288
    ds_read_b64_tr_b16 v[248:249], v77 offset:8
    ds_read_b64_tr_b16 v[250:251], v77 offset:4104
    ds_read_b64_tr_b16 v[252:253], v77 offset:8200
    ds_read_b64_tr_b16 v[254:255], v77 offset:12296
    s_waitcnt vmcnt(12) lgkmcnt(0)
    s_barrier
    v_add_u32 v77, 73728, v79
    s_waitcnt lgkmcnt(0)
    ds_read_b64_tr_b16 v[0:1], v77 offset:0
    ds_read_b64_tr_b16 v[2:3], v77 offset:256
    ds_read_b64_tr_b16 v[4:5], v77 offset:2048
    ds_read_b64_tr_b16 v[6:7], v77 offset:2304
    ds_read_b64_tr_b16 v[8:9], v77 offset:8
    ds_read_b64_tr_b16 v[10:11], v77 offset:264
    ds_read_b64_tr_b16 v[12:13], v77 offset:2056
    ds_read_b64_tr_b16 v[14:15], v77 offset:2312
    s_waitcnt vmcnt(8) lgkmcnt(0)
    s_barrier
    v_add_u32 v77, 110592, v78
    ds_read_b64_tr_b16 v[16:17], v77 offset:0
    ds_read_b64_tr_b16 v[18:19], v77 offset:256
    ds_read_b64_tr_b16 v[20:21], v77 offset:2048
    ds_read_b64_tr_b16 v[22:23], v77 offset:2304
    ds_read_b64_tr_b16 v[24:25], v77 offset:8
    ds_read_b64_tr_b16 v[26:27], v77 offset:264
    ds_read_b64_tr_b16 v[28:29], v77 offset:2056
    ds_read_b64_tr_b16 v[30:31], v77 offset:2312
    s_waitcnt vmcnt(4) lgkmcnt(0)
    s_barrier
    v_add_u32 v77, 147456, v78
    ds_read_b64_tr_b16 v[32:33], v77 offset:0
    ds_read_b64_tr_b16 v[34:35], v77 offset:256
    ds_read_b64_tr_b16 v[36:37], v77 offset:2048
    ds_read_b64_tr_b16 v[38:39], v77 offset:2304
    ds_read_b64_tr_b16 v[40:41], v77 offset:8
    ds_read_b64_tr_b16 v[42:43], v77 offset:264
    ds_read_b64_tr_b16 v[44:45], v77 offset:2056
    ds_read_b64_tr_b16 v[46:47], v77 offset:2312
    s_waitcnt vmcnt(0) lgkmcnt(0)
    s_barrier
    v_add_u32 v77, 0, v78
    ds_read_b64_tr_b16 v[48:49], v77 offset:0
    ds_read_b64_tr_b16 v[50:51], v77 offset:256
    ds_read_b64_tr_b16 v[52:53], v77 offset:2048
    ds_read_b64_tr_b16 v[54:55], v77 offset:2304
    ds_read_b64_tr_b16 v[56:57], v77 offset:8
    ds_read_b64_tr_b16 v[58:59], v77 offset:264
    ds_read_b64_tr_b16 v[60:61], v77 offset:2056
    ds_read_b64_tr_b16 v[62:63], v77 offset:2312
    s_waitcnt lgkmcnt(0)
    s_barrier
    ds_write_b128 v70, v[0:3] offset:20480
    ds_write_b128 v70, v[4:7] offset:21504
    ds_write_b128 v70, v[8:11] offset:22528
    ds_write_b128 v70, v[12:15] offset:23552
    ds_write_b128 v70, v[16:19] offset:24576
    ds_write_b128 v70, v[20:23] offset:25600
    ds_write_b128 v70, v[24:27] offset:26624
    ds_write_b128 v70, v[28:31] offset:27648
    ds_write_b128 v70, v[32:35] offset:28672
    ds_write_b128 v70, v[36:39] offset:29696
    ds_write_b128 v70, v[40:43] offset:30720
    ds_write_b128 v70, v[44:47] offset:31744
    ds_write_b128 v70, v[48:51] offset:32768
    ds_write_b128 v70, v[52:55] offset:33792
    ds_write_b128 v70, v[56:59] offset:34816
    ds_write_b128 v70, v[60:63] offset:35840
    s_waitcnt lgkmcnt(0)
    v_bfe_u32 v60, v65, 4, 6
    v_and_b32 v61, 15, v60
    v_lshrrev_b32 v62, 4, v60
    v_mov_b32 v50, 0x3f80
    v_mov_b32 v51, 0x3f800000
    v_and_b32 v77, 1, v62
    v_lshlrev_b32 v77, 2, v77
    v_sub_u32 v77, v61, v77
    v_and_b32 v78, 3, v61
    v_lshlrev_b32 v78, 2, v78
    v_lshrrev_b32 v79, 2, v61
    v_add_u32 v78, v78, v79
    v_cmp_eq_u32 vcc, 0, v77
    s_nop 1
    v_cndmask_b32 v8, 0, v50, vcc
    v_cmp_eq_u32 vcc, 1, v77
    s_nop 1
    v_cndmask_b32 v8, v8, v51, vcc
    v_cmp_eq_u32 vcc, 0, v78
    s_nop 1
    v_cndmask_b32 v12, 0, v50, vcc
    v_cmp_eq_u32 vcc, 1, v78
    s_nop 1
    v_cndmask_b32 v12, v12, v51, vcc
    v_cmp_eq_u32 vcc, 2, v77
    s_nop 1
    v_cndmask_b32 v9, 0, v50, vcc
    v_cmp_eq_u32 vcc, 3, v77
    s_nop 1
    v_cndmask_b32 v9, v9, v51, vcc
    v_cmp_eq_u32 vcc, 2, v78
    s_nop 1
    v_cndmask_b32 v13, 0, v50, vcc
    v_cmp_eq_u32 vcc, 3, v78
    s_nop 1
    v_cndmask_b32 v13, v13, v51, vcc
    v_cmp_eq_u32 vcc, 8, v77
    s_nop 1
    v_cndmask_b32 v10, 0, v50, vcc
    v_cmp_eq_u32 vcc, 9, v77
    s_nop 1
    v_cndmask_b32 v10, v10, v51, vcc
    v_cmp_eq_u32 vcc, 4, v78
    s_nop 1
    v_cndmask_b32 v14, 0, v50, vcc
    v_cmp_eq_u32 vcc, 5, v78
    s_nop 1
    v_cndmask_b32 v14, v14, v51, vcc
    v_cmp_eq_u32 vcc, 10, v77
    s_nop 1
    v_cndmask_b32 v11, 0, v50, vcc
    v_cmp_eq_u32 vcc, 11, v77
    s_nop 1
    v_cndmask_b32 v11, v11, v51, vcc
    v_cmp_eq_u32 vcc, 6, v78
    s_nop 1
    v_cndmask_b32 v15, 0, v50, vcc
    v_cmp_eq_u32 vcc, 7, v78
    s_nop 1
    v_cndmask_b32 v15, v15, v51, vcc
    v_lshlrev_b32 v77, 4, v61
    ds_write_b128 v69, v[8:11] offset:15360
    ds_write_b128 v77, v[12:15] offset:15872
    s_waitcnt vmcnt(0) lgkmcnt(0)
    s_cmp_lg_u32 s95, 0
    s_cbranch_scc1 cf_hn
    s_mov_b32 s88, 4194304
gn2:
    buffer_load_dword v2, off, s[84:87], 0 offset:216 sc1
    s_waitcnt vmcnt(0)
    v_readfirstlane_b32 s95, v2
    s_sub_u32 s88, s88, 1
    s_cbranch_scc1 gn2x
    s_cmp_eq_u32 s95, 0
    s_cbranch_scc1 gn2
gn2x:
cf_hn:
    v_mov_b32 v2, 1
    s_cmp_lg_u32 s13, 0
    s_cbranch_scc1 cf_noarr
    s_mov_b64 exec, 1
    s_mov_b32 s42, 1
    v_mov_b32 v4, v76
    s_cmp_ge_u32 s94, 32
    s_cbranch_scc1 cf_have
    s_mov_b32 s40, 131072
    s_mov_b32 s42, 2
cf_startpoll:
    buffer_load_dword v3, off, s[84:87], 0 offset:132 sc1
    s_sub_u32 s40, s40, 1
    s_cbranch_scc1 cf_decide
    s_waitcnt vmcnt(0)
    v_readfirstlane_b32 s41, v3
    s_nop 1
    s_cmp_lt_u32 s41, 32
    s_cbranch_scc1 cf_startpoll
    s_mov_b32 s42, 1
cf_decide:
    v_mov_b32 v4, s42
    v_mov_b32 v5, 0
    buffer_atomic_cmpswap v[4:5], off, s[84:87], 0 offset:28 sc0
    s_waitcnt vmcnt(0)
cf_have:
    v_mov_b32 v5, s42
    v_cmp_eq_u32 vcc, 0, v4
    s_nop 1
    v_cndmask_b32 v4, v4, v5, vcc
    v_mov_b32 v5, 16192
    ds_write_b32 v5, v4
    s_waitcnt lgkmcnt(0)
    s_mov_b64 exec, -1
cf_noarr:
    s_barrier
    v_mov_b32 v5, 16192
    ds_read_b32 v4, v5
    s_waitcnt lgkmcnt(0)
    v_readfirstlane_b32 s41, v4
    s_nop 1
    s_cmp_eq_u32 s41, 1
    s_cbranch_scc1 cf_run
    v_lshrrev_b32 v0, 4, v65
    s_mov_b32 s32, s13
    s_load_dwordx16 s[48:63], s[0:1], 0
    s_waitcnt lgkmcnt(0)
    s_branch L_helper
cf_run:
    s_mov_b32 s44, 0x3e0293ee
    s_mov_b32 s45, s44
    s_or_b32 s66, s44, 0x80000000
    s_mov_b32 s48, 0x3f003f00
    s_mov_b32 s49, 0
    s_mov_b32 s50, 0x3f803f80
    s_mov_b32 s51, 0x3f803f80
    s_mov_b32 s52, 512
    s_mov_b32 s53, 1024
    s_mov_b32 s54, 1536
    s_mov_b32 s30, 0
    s_lshl_b32 s47, s13, 9
    s_cmp_lg_u32 s32, 0
    s_cselect_b32 s71, s13, 3
    s_add_u32 s46, s71, 1
    s_lshr_b32 s46, s46, 1
    s_mov_b32 s14, 67125248
    s_mov_b32 s15, 67129344
    s_mov_b32 s16, 67133440
    s_mov_b32 s36, 0
    s_add_u32 s17, s68, 67108864
    s_mov_b32 s69, 0
    s_mov_b32 s70, 0
    s_lshl_b32 s26, s12, 14
    s_add_u32 s26, s26, 0
    s_mul_i32 s40, s13, 3072
    s_add_u32 s24, s26, s40
    s_lshl_b32 s96, s12, 7
    s_add_u32 s29, s96, 125845504
    s_add_u32 s96, s96, 125829120
    s_lshl_b32 s40, s12, 14
    s_add_u32 s40, s40, 68157440
    s_add_u32 s18, s40, 0
    s_add_u32 s19, s40, 4096
    s_add_u32 s20, s40, 8192
    s_add_u32 s21, s40, 12288
    s_lshr_b32 s40, s12, 3
    s_lshl_b32 s40, s40, 12
    s_and_b32 s41, s12, 7
    s_lshl_b32 s41, s41, 7
    s_add_u32 s40, s40, s41
    s_add_u32 s22, s40, 68157440
    s_add_u32 s23, s22, 1024
    s_add_u32 s25, s22, 2048
    s_mov_b32 s56, -65528
    s_cmp_lg_u32 s32, 0
    s_cselect_b64 s[38:39], -1, 0
    s_add_u32 s55, s68, 138412032
    s_cmp_eq_u32 s13, 3
    s_cselect_b64 s[100:101], 1, 0
    s_cselect_b64 s[38:39], 1, s[38:39]
    s_cselect_b32 s93, 64, 0
    s_cselect_b32 s55, s29, s55
    s_cselect_b32 s57, 0, 9216
    s_mov_b64 exec, s[100:101]
    v_mov_b32 v72, s95
    s_mov_b64 exec, -1
    s_mov_b32 s34, 0xff00ff00
    s_mov_b32 s35, 0xff00ff00
    s_lshl_b32 s28, s12, 12
    s_add_u32 s28, s28, 7602176
    s_add_u32 s27, s28, 77594624
    s_add_u32 s28, s28, 69206016
    s_cmp_ge_u32 s97, 3
    s_cbranch_scc1 cf_kvdone
    s_mov_b32 s40, 3
    v_bfe_u32 v78, v65, 2, 5
    s_mov_b32 s31, 4194304
cf_kv0:
    buffer_load_dword v77, v78, s[4:7], s96 offen offset:16 sc1
    s_waitcnt vmcnt(0)
    v_subrev_u32 v77, s95, v77
    v_cmp_lt_u32 vcc, 16, v77
    s_nop 1
    v_cndmask_b32 v77, v77, 0, vcc
    v_bfe_u32 v79, v78, 2, 2
    v_lshl_add_u32 v77, v77, 2, v79
    s_nop 1
    v_min_u32_dpp v77, v77, v77 row_ror:1 row_mask:0xf bank_mask:0xf
    s_nop 1
    v_min_u32_dpp v77, v77, v77 row_ror:2 row_mask:0xf bank_mask:0xf
    s_nop 1
    v_min_u32_dpp v77, v77, v77 row_ror:4 row_mask:0xf bank_mask:0xf
    s_nop 0
    v_readfirstlane_b32 s97, v77
    s_sub_u32 s31, s31, 1
    s_cbranch_scc1 cf_kv0_x
    s_cmp_le_u32 s40, s97
    s_cbranch_scc1 cf_kv0_x
    s_sleep 2
    s_branch cf_kv0
cf_kv0_x:
    s_add_u32 s40, s24, 0
    s_add_u32 s40, s40, s33
    s_sub_u32 s41, s96, s40
    v_bfe_u32 v77, v65, 2, 5
    v_add3_u32 v77, v77, s41, 16
    v_lshlrev_b32 v78, 3, v69
    s_nop 0
    v_mov_b32_dpp v78, v77 quad_perm:[0,1,2,3] row_mask:0xc bank_mask:0xf
    buffer_load_dword v76, v78, s[4:7], s40 offen sc1
    s_add_u32 s40, s24, 524288
    s_add_u32 s40, s40, s33
    s_sub_u32 s41, s96, s40
    v_bfe_u32 v77, v65, 2, 5
    v_add3_u32 v77, v77, s41, 16
    v_lshlrev_b32 v78, 3, v69
    s_nop 0
    v_mov_b32_dpp v78, v77 quad_perm:[0,1,2,3] row_mask:0xc bank_mask:0xf
    buffer_load_dword v76, v78, s[4:7], s40 offen sc1
cf_kvdone:
    v_mov_b64 v[0:1], 0
    v_mov_b64 v[2:3], 0
    v_mov_b64 v[4:5], 0
    v_mov_b64 v[6:7], 0
    v_mov_b64 v[8:9], 0
    v_mov_b64 v[10:11], 0
    v_mov_b64 v[12:13], 0
    v_mov_b64 v[14:15], 0
    v_mov_b64 v[16:17], 0
    v_mov_b64 v[18:19], 0
    v_mov_b64 v[20:21], 0
    v_mov_b64 v[22:23], 0
    ds_read_b128 v[40:43], v70 offset:0
    ds_read_b128 v[44:47], v70 offset:1024
    ds_read_b128 v[48:51], v70 offset:2048
    ds_read_b128 v[52:55], v70 offset:3072
    ds_read_b128 v[24:27], v70 offset:4096
    ds_read_b128 v[28:31], v70 offset:5120
    ds_read_b128 v[32:35], v70 offset:6144
    ds_read_b128 v[36:39], v70 offset:7168
    buffer_load_dwordx4 v[60:63], v65, s[4:7], s14 offen offset:0 nt
    buffer_load_dwordx4 v[56:59], v66, s[4:7], s14 offen offset:0 nt
    s_mov_b32 s31, 1048576
    s_waitcnt vmcnt(0) lgkmcnt(0)
    s_branch cf_goA
cf_loop:
    s_mov_b32 s31, 1048576
    s_mov_b32 s69, s70
    s_waitcnt lgkmcnt(0)
cf_cA:
    buffer_load_dwordx4 v[60:63], v65, s[4:7], s14 offen offset:0 nt
    buffer_load_dwordx4 v[56:59], v66, s[4:7], s14 offen offset:0 nt
cf_cA1:
    v_bitop3_b32 v77, v60, v56, s70 bitop3:0x7e
    v_and_b32 v77, 1, v77
    v_cmp_ne_u32 vcc, 0, v77
    s_cbranch_vccz cf_goA
    v_bitop3_b32 v77, v60, v56, s70 bitop3:0x7e
    v_and_b32 v77, 1, v77
    v_cmp_ne_u32 vcc, 0, v77
    s_cbranch_vccz cf_goA
    v_bitop3_b32 v77, v60, v56, s70 bitop3:0x7e
    v_and_b32 v77, 1, v77
    v_cmp_ne_u32 vcc, 0, v77
    s_cbranch_vccz cf_goA
    v_bitop3_b32 v77, v60, v56, s70 bitop3:0x7e
    v_and_b32 v77, 1, v77
    v_cmp_ne_u32 vcc, 0, v77
    s_cbranch_vccz cf_goA
    v_bitop3_b32 v77, v60, v56, s70 bitop3:0x7e
    v_and_b32 v77, 1, v77
    v_cmp_ne_u32 vcc, 0, v77
    s_cbranch_vccz cf_goA
    buffer_load_dwordx4 v[60:63], v65, s[4:7], s14 offen offset:0 nt
    buffer_load_dwordx4 v[56:59], v66, s[4:7], s14 offen offset:0 nt
    v_bitop3_b32 v77, v60, v56, s70 bitop3:0x7e
    v_and_b32 v77, 1, v77
    v_cmp_ne_u32 vcc, 0, v77
    s_cbranch_vccz cf_goA
    v_bitop3_b32 v77, v60, v56, s70 bitop3:0x7e
    v_and_b32 v77, 1, v77
    v_cmp_ne_u32 vcc, 0, v77
    s_cbranch_vccz cf_goA
    v_bitop3_b32 v77, v60, v56, s70 bitop3:0x7e
    v_and_b32 v77, 1, v77
    v_cmp_ne_u32 vcc, 0, v77
    s_cbranch_vccz cf_goA
    v_bitop3_b32 v77, v60, v56, s70 bitop3:0x7e
    v_and_b32 v77, 1, v77
    v_cmp_ne_u32 vcc, 0, v77
    s_cbranch_vccz cf_goA
    v_bitop3_b32 v77, v60, v56, s70 bitop3:0x7e
    v_and_b32 v77, 1, v77
    v_cmp_ne_u32 vcc, 0, v77
    s_cbranch_vccz cf_goA
    buffer_load_dwordx4 v[60:63], v65, s[4:7], s14 offen offset:0 nt
    buffer_load_dwordx4 v[56:59], v66, s[4:7], s14 offen offset:0 nt
    v_bitop3_b32 v77, v60, v56, s70 bitop3:0x7e
    v_and_b32 v77, 1, v77
    v_cmp_ne_u32 vcc, 0, v77
    s_cbranch_vccz cf_goA
    v_bitop3_b32 v77, v60, v56, s70 bitop3:0x7e
    v_and_b32 v77, 1, v77
    v_cmp_ne_u32 vcc, 0, v77
    s_cbranch_vccz cf_goA
    v_bitop3_b32 v77, v60, v56, s70 bitop3:0x7e
    v_and_b32 v77, 1, v77
    v_cmp_ne_u32 vcc, 0, v77
    s_cbranch_vccz cf_goA
    v_bitop3_b32 v77, v60, v56, s70 bitop3:0x7e
    v_and_b32 v77, 1, v77
    v_cmp_ne_u32 vcc, 0, v77
    s_cbranch_vccz cf_goA
    v_bitop3_b32 v77, v60, v56, s70 bitop3:0x7e
    v_and_b32 v77, 1, v77
    v_cmp_ne_u32 vcc, 0, v77
    s_cbranch_vccz cf_goA
    buffer_load_dwordx4 v[60:63], v65, s[4:7], s14 offen offset:0 nt
    buffer_load_dwordx4 v[56:59], v66, s[4:7], s14 offen offset:0 nt
    v_bitop3_b32 v77, v60, v56, s70 bitop3:0x7e
    v_and_b32 v77, 1, v77
    v_cmp_ne_u32 vcc, 0, v77
    s_cbranch_vccz cf_goA
    v_bitop3_b32 v77, v60, v56, s70 bitop3:0x7e
    v_and_b32 v77, 1, v77
    v_cmp_ne_u32 vcc, 0, v77
    s_cbranch_vccz cf_goA
    v_bitop3_b32 v77, v60, v56, s70 bitop3:0x7e
    v_and_b32 v77, 1, v77
    v_cmp_ne_u32 vcc, 0, v77
    s_cbranch_vccz cf_goA
    v_bitop3_b32 v77, v60, v56, s70 bitop3:0x7e
    v_and_b32 v77, 1, v77
    v_cmp_ne_u32 vcc, 0, v77
    s_cbranch_vccz cf_goA
    v_bitop3_b32 v77, v60, v56, s70 bitop3:0x7e
    v_and_b32 v77, 1, v77
    v_cmp_ne_u32 vcc, 0, v77
    s_cbranch_vccz cf_goA
    s_sub_u32 s31, s31, 64
    s_cbranch_scc0 cf_cA
cf_goA:
    ds_write_b128 v65, v[60:63] offset:0
    v_smfmac_f32_16x16x64_bf16 v[0:3], v[60:63], v[40:47], v64
    v_smfmac_f32_16x16x64_bf16 v[4:7], v[60:63], v[48:55], v64
    buffer_load_dwordx4 v[40:43], v65, s[4:7], s15 offen offset:0 nt
    v_smfmac_f32_16x16x64_bf16 v[0:3], v[56:59], v[24:31], v64
    s_add_u32 s40, s24, 1048576
    s_add_u32 s40, s40, s33
    s_sub_u32 s41, s96, s40
    v_smfmac_f32_16x16x64_bf16 v[4:7], v[56:59], v[32:39], v64
    ds_read_b128 v[24:27], v70 offset:8192
    s_cmp_lt_u32 s97, s93
    s_cselect_b32 s41, s41, 0
    v_smfmac_f32_16x16x64_bf16 v[8:11], v[60:63], a[96:103], v64
    ds_read_b128 v[28:31], v70 offset:9216
    v_smfmac_f32_16x16x64_bf16 v[12:15], v[60:63], a[104:111], v64
    ds_read_b128 v[32:35], v70 offset:10240
    s_waitcnt lgkmcnt(3)
    s_barrier
    ds_read_b128 v[48:51], v67 offset:0
    v_smfmac_f32_16x16x64_bf16 v[8:11], v[56:59], a[112:119], v64
    ds_read_b128 v[36:39], v70 offset:11264
    v_bitop3_b32 v79, v73, -9, s54 bitop3:0x6a
    v_smfmac_f32_16x16x64_bf16 v[12:15], v[56:59], a[120:127], v64
    ds_read_b128 v[52:55], v68 offset:0
    v_bfe_u32 v77, v65, 2, 5
    v_smfmac_f32_16x16x64_bf16 v[16:19], v[60:63], a[216:223], v64
    buffer_load_dwordx4 v[40:43], v65, s[4:7], s15 offen offset:0 nt
    s_waitcnt lgkmcnt(4)
    v_smfmac_f32_16x16x64_bf16 v[20:23], v[60:63], v[24:31], v64
    ds_read_b128 v[24:27], v70 offset:12288
    s_waitcnt lgkmcnt(3)
    v_smfmac_f32_16x16x64_bf16 v[0:3], v[48:51], a[0:7], v64
    ds_read_b128 v[28:31], v70 offset:13312
    s_waitcnt lgkmcnt(3)
    v_smfmac_f32_16x16x64_bf16 v[4:7], v[48:51], v[32:39], v64
    ds_read_b128 v[32:35], v70 offset:14336
    v_add3_u32 v77, v77, s41, 16
    v_smfmac_f32_16x16x64_bf16 v[8:11], v[48:51], a[128:135], v64
    ds_read_b128 v[36:39], v70 offset:15360
    v_lshlrev_b32 v78, 3, v69
    v_smfmac_f32_16x16x64_bf16 v[12:15], v[48:51], a[136:143], v64
    buffer_load_dwordx4 v[60:63], v65, s[4:7], s16 offen offset:0 nt
    v_smfmac_f32_16x16x64_bf16 v[16:19], v[56:59], a[224:231], v64
    v_mov_b32_dpp v78, v77 quad_perm:[0,1,2,3] row_mask:0xc bank_mask:0xf
    v_smfmac_f32_16x16x64_bf16 v[20:23], v[56:59], a[232:239], v64
    s_waitcnt lgkmcnt(2)
    s_waitcnt vmcnt(2)
    v_and_b32 v77, s36, v40
    v_smfmac_f32_16x16x64_bf16 v[12:15], v[52:55], v[24:31], v64
    ds_write_b128 v65, v[40:43] offset:4096
    v_smfmac_f32_16x16x64_bf16 v[0:3], v[52:55], a[8:15], v64
    s_waitcnt lgkmcnt(1)
    v_cmp_ne_u32 vcc, s70, v77
    v_smfmac_f32_16x16x64_bf16 v[4:7], v[52:55], v[32:39], v64
    buffer_load_dwordx4 v[24:27], v65, s[4:7], s24 offen offset:0 sc1
    v_smfmac_f32_16x16x64_bf16 v[8:11], v[52:55], a[144:151], v64
    s_cbranch_vccnz cf_spinB
cf_backB:
    v_smfmac_f32_16x16x64_bf16 v[16:19], v[40:43], v[176:183], v64
    s_waitcnt lgkmcnt(0)
    s_barrier
    ds_read_b128 v[44:47], v66 offset:4096
    v_smfmac_f32_16x16x64_bf16 v[12:15], v[40:43], a[160:167], v64
    ds_read_b128 v[32:35], v70 offset:16384
    v_smfmac_f32_16x16x64_bf16 v[0:3], v[40:43], a[16:23], v64
    ds_read_b128 v[36:39], v70 offset:17408
    v_smfmac_f32_16x16x64_bf16 v[8:11], v[40:43], a[152:159], v64
    ds_read_b128 v[48:51], v67 offset:4096
    v_smfmac_f32_16x16x64_bf16 v[4:7], v[40:43], a[24:31], v64
    ds_read_b128 v[52:55], v68 offset:4096
    v_smfmac_f32_16x16x64_bf16 v[20:23], v[40:43], v[184:191], v64
    buffer_load_dwordx4 v[28:31], v65, s[4:7], s24 offen offset:1024 sc1
    s_waitcnt lgkmcnt(4)
    v_smfmac_f32_16x16x64_bf16 v[0:3], v[44:47], a[32:39], v64
    ds_read_b128 v[56:59], v69 offset:15360
    s_waitcnt lgkmcnt(3)
    v_smfmac_f32_16x16x64_bf16 v[8:11], v[44:47], v[32:39], v64
    ds_read_b128 v[32:35], v70 offset:18432
    v_smfmac_f32_16x16x64_bf16 v[4:7], v[44:47], a[40:47], v64
    ds_read_b128 v[36:39], v70 offset:19456
    v_smfmac_f32_16x16x64_bf16 v[12:15], v[44:47], a[168:175], v64
    buffer_load_dwordx4 v[42:45], v65, s[4:7], s24 offen offset:3072 sc1
    s_waitcnt lgkmcnt(3)
    v_smfmac_f32_16x16x64_bf16 v[0:3], v[48:51], a[48:55], v64
    s_waitcnt vmcnt(3)
    v_and_b32 v77, s36, v60
    v_smfmac_f32_16x16x64_bf16 v[8:11], v[48:51], a[176:183], v64
    v_cmp_ne_u32 vcc, s70, v77
    v_smfmac_f32_16x16x64_bf16 v[0:3], v[52:55], a[64:71], v64
    s_waitcnt lgkmcnt(0)
    v_smfmac_f32_16x16x64_bf16 v[8:11], v[52:55], v[32:39], v64
    s_cbranch_vccnz cf_spin8
cf_back8:
    v_smfmac_f32_16x16x64_bf16 v[0:3], v[60:63], a[80:87], v64
    buffer_load_dwordx4 v[34:37], v65, s[4:7], s24 offen offset:2048 sc1
    s_nop 1
    v_smfmac_f32_16x16x64_bf16 v[8:11], v[60:63], a[200:207], v64
    s_nop 1
    v_lshrrev_b32 v77, 1, v69
    v_smfmac_f32_16x16x64_bf16 v[4:7], v[48:51], a[56:63], v64
    s_nop 1
    v_cvt_pk_bf16_f32 v0, v0, v1
    v_smfmac_f32_16x16x64_bf16 v[12:15], v[48:51], a[184:191], v64
    s_nop 1
    v_cvt_pk_bf16_f32 v1, v2, v3
    v_smfmac_f32_16x16x64_bf16 v[4:7], v[52:55], a[72:79], v64
    s_nop 1
    v_cvt_pk_bf16_f32 v2, v8, v9
    v_smfmac_f32_16x16x64_bf16 v[12:15], v[52:55], a[192:199], v64
    s_nop 1
    v_cvt_pk_bf16_f32 v3, v10, v11
    v_smfmac_f32_16x16x64_bf16 v[4:7], v[60:63], a[88:95], v64
    s_nop 2
    v_smfmac_f32_16x16x64_bf16 v[12:15], v[60:63], a[208:215], v64
    buffer_load_dword v76, v78, s[4:7], s40 offen sc1
    s_nop 1
    v_mfma_f32_16x16x32_bf16 v[8:11], v[0:3], v[56:59], 0
    s_nop 0
    v_cvt_pk_bf16_f32 v4, v4, v5
    v_cvt_pk_bf16_f32 v5, v6, v7
    s_nop 0
    v_cvt_pk_bf16_f32 v6, v12, v13
    v_cvt_pk_bf16_f32 v7, v14, v15
    s_nop 1
    v_mfma_f32_16x16x32_bf16 v[12:15], v[4:7], v[56:59], 0
    ds_read_b128 v[56:59], v66 offset:4096
    v_cvt_pk_bf16_f32 v0, v8, v9
    v_cvt_pk_bf16_f32 v1, v10, v11
    v_smfmac_f32_16x16x64_bf16 v[16:19], v[48:51], v[208:215], v64
    s_waitcnt vmcnt(3)
    s_nop 2
    v_cvt_pk_bf16_f32 v2, v12, v13
    v_cvt_pk_bf16_f32 v3, v14, v15
    s_nop 1
    v_mfma_f32_16x16x32_bf16 v[12:15], v[0:3], v[0:3], 0
    s_nop 1
    v_bitop3_b32 v78, v73, -9, s53 bitop3:0x6a
    v_mfma_f32_16x16x32_bf16 v[4:7], v[24:27], v[0:3], 0
    ds_read_b128 v[24:27], v67 offset:0
    s_nop 1
    v_mfma_f32_16x16x32_bf16 v[8:11], v[28:31], v[0:3], 0
    s_nop 0
    v_mov_b32_dpp v12, v14 row_ror:8 row_mask:0xf bank_mask:0xc
    v_mov_b32_dpp v13, v15 row_ror:8 row_mask:0xf bank_mask:0xc
    v_smfmac_f32_16x16x64_bf16 v[20:23], v[48:51], v[216:223], v64
    ds_write_b64 v71, v[12:13]
    ds_read_b128 v[48:51], v68 offset:0
    s_nop 1
    v_mov_b32_dpp v4, v8 row_ror:8 row_mask:0xf bank_mask:0xc
    v_mov_b32_dpp v5, v9 row_ror:8 row_mask:0xf bank_mask:0xc
    v_mov_b32_dpp v6, v10 row_ror:8 row_mask:0xf bank_mask:0xc
    v_mov_b32_dpp v7, v11 row_ror:8 row_mask:0xf bank_mask:0xc
    v_smfmac_f32_16x16x64_bf16 v[16:19], v[52:55], v[224:231], v64
    ds_write_b128 v65, v[4:7] offset:8192
    v_smfmac_f32_16x16x64_bf16 v[20:23], v[52:55], v[232:239], v64
    s_waitcnt lgkmcnt(3)
    v_smfmac_f32_16x16x64_bf16 v[16:19], v[24:27], a[240:247], v64
    s_waitcnt vmcnt(1)
    v_smfmac_f32_16x16x64_bf16 v[20:23], v[24:27], a[248:255], v64
    s_mov_b64 exec, s[38:39]
    buffer_store_dword v72, v75, s[4:7], s55 offen sc1
    s_mov_b64 exec, -1
    v_smfmac_f32_16x16x64_bf16 v[16:19], v[60:63], v[240:247], v64
    s_cmp_ge_u32 s30, 58
    s_waitcnt lgkmcnt(0)
    s_barrier
    ds_read_b128 v[8:11], v66 offset:8192
    v_smfmac_f32_16x16x64_bf16 v[20:23], v[60:63], v[248:255], v64
    ds_read_b128 v[12:15], v67 offset:8192
    v_smfmac_f32_16x16x64_bf16 v[16:19], v[56:59], v[192:199], v64
    ds_read_b128 v[52:55], v68 offset:8192
    v_smfmac_f32_16x16x64_bf16 v[20:23], v[56:59], v[200:207], v64
    ds_read_b64 v[24:25], v77 offset:14336
    ds_read_b64 v[26:27], v77 offset:14592
    v_smfmac_f32_16x16x64_bf16 v[16:19], v[48:51], v[160:167], v64
    ds_read_b64 v[28:29], v77 offset:14848
    ds_read_b64 v[30:31], v77 offset:15104
    v_bitop3_b32 v77, v73, -9, s52 bitop3:0x6a
    v_smfmac_f32_16x16x64_bf16 v[20:23], v[48:51], v[168:175], v64
    s_cbranch_scc1 cf_rare
cf_rare_x:
    ds_read_b128 v[56:59], v70 offset:22528
    ds_read_b128 v[60:63], v70 offset:23552
    s_waitcnt lgkmcnt(6)
    v_pk_add_f32 v[4:5], v[4:5], v[8:9]
    v_pk_add_f32 v[6:7], v[6:7], v[10:11]
    v_pk_add_f32 v[12:13], v[12:13], v[52:53]
    v_pk_add_f32 v[14:15], v[14:15], v[54:55]
    v_pk_add_f32 v[4:5], v[4:5], v[12:13]
    v_pk_add_f32 v[6:7], v[6:7], v[14:15]
    s_waitcnt lgkmcnt(2)
    v_pk_add_f32 v[24:25], v[24:25], v[26:27]
    v_pk_add_f32 v[28:29], v[28:29], v[30:31]
    v_max3_f32 v8, v4, v5, v6
    v_pk_add_f32 v[24:25], v[24:25], v[28:29]
    v_max_f32 v8, v8, v7
    v_max3_f32 v8, v8, v24, v25
    v_cvt_pk_bf16_f32 v32, v16, v17
    v_cvt_pk_bf16_f32 v38, v18, v19
    v_max_f32_dpp v8, v8, v8 row_ror:8 row_mask:0xf bank_mask:0xf
    v_mov_b32 v9, v8
    v_cvt_pk_bf16_f32 v40, v20, v21
    v_cvt_pk_bf16_f32 v46, v22, v23
    v_permlane32_swap_b32 v8, v9
    v_max_f32 v8, v8, v9
    v_mov_b32 v9, v8
    v_mov_b32 v11, 0
    v_mov_b32 v15, 0
    v_permlane16_swap_b32 v8, v9
    v_max_f32 v8, v8, v9
    v_mul_f32 v8, s66, v8
    v_pk_fma_f32 v[4:5], v[4:5], s[44:45], v[8:9] op_sel_hi:[1,1,0]
    v_pk_fma_f32 v[6:7], v[6:7], s[44:45], v[8:9] op_sel_hi:[1,1,0]
    v_pk_fma_f32 v[24:25], v[24:25], s[44:45], v[8:9] op_sel_hi:[1,1,0]
    v_exp_f32 v4, v4
    v_exp_f32 v5, v5
    v_exp_f32 v6, v6
    v_exp_f32 v7, v7
    v_exp_f32 v24, v24
    v_exp_f32 v25, v25
    v_cvt_pk_bf16_f32 v12, v4, v5
    v_cvt_pk_bf16_f32 v13, v6, v7
    v_cvt_pk_bf16_f32 v10, v24, v25
    v_cvt_pk_bf16_f32 v14, v24, v25
    v_mov_b64 v[0:1], s[48:49]
    v_mfma_f32_16x16x32_bf16 v[4:7], v[32:35], v[10:13], 0
    ds_read_b128 v[48:51], v70 offset:20480
    v_mov_b64 v[2:3], s[50:51]
    v_mfma_f32_16x16x32_bf16 v[24:27], v[36:39], v[12:15], 0
    ds_read_b128 v[52:55], v70 offset:21504
    v_mov_b64 v[8:9], 0
    v_mfma_f32_16x16x32_bf16 v[28:31], v[0:3], v[10:13], 0
    ds_read_b128 v[32:35], v70 offset:24576
    v_mov_b64 v[0:1], 0
    v_mfma_f32_16x16x32_bf16 v[16:19], v[40:43], v[10:13], 0
    ds_read_b128 v[36:39], v70 offset:25600
    v_mov_b64 v[2:3], 0
    v_mfma_f32_16x16x32_bf16 v[20:23], v[44:47], v[12:15], 0
    ds_read_b128 v[40:43], v70 offset:26624
    v_add_f32_dpp v4, v24, v4 row_ror:8 row_mask:0xf bank_mask:0xf
    v_add_f32_dpp v5, v25, v5 row_ror:8 row_mask:0xf bank_mask:0xf
    v_add_f32_dpp v6, v26, v6 row_ror:8 row_mask:0xf bank_mask:0xf
    v_add_f32_dpp v7, v27, v7 row_ror:8 row_mask:0xf bank_mask:0xf
    v_add_f32_dpp v29, v28, v28 row_ror:8 row_mask:0xf bank_mask:0xf
    v_rcp_f32 v28, v29
    v_mov_b64 v[10:11], 0
    v_add_f32_dpp v4, v16, v20 row_ror:8 row_mask:0xf bank_mask:0xc
    v_add_f32_dpp v5, v17, v21 row_ror:8 row_mask:0xf bank_mask:0xc
    v_add_f32_dpp v6, v18, v22 row_ror:8 row_mask:0xf bank_mask:0xc
    v_add_f32_dpp v7, v19, v23 row_ror:8 row_mask:0xf bank_mask:0xc
    v_pk_mul_f32 v[4:5], v[4:5], v[28:29] op_sel_hi:[1,0]
    v_pk_mul_f32 v[6:7], v[6:7], v[28:29] op_sel_hi:[1,0]
    v_cvt_pk_bf16_f32 v4, v4, v5
    v_cvt_pk_bf16_f32 v5, v6, v7
    ds_write_b64 v73, v[4:5] offset:12288
    v_mov_b32_dpp v6, v4 row_ror:8 row_mask:0xf bank_mask:0xf
    v_mov_b32_dpp v7, v5 row_ror:8 row_mask:0xf bank_mask:0xf
    v_mov_b64 v[12:13], 0
    v_mov_b64 v[14:15], 0
    v_smfmac_f32_16x16x64_bf16 v[8:11], v[4:7], v[80:87], v64
    s_waitcnt lgkmcnt(4)
    v_mov_b64 v[24:25], 0
    v_smfmac_f32_16x16x64_bf16 v[0:3], v[4:7], v[48:55], v64
    ds_read_b128 v[44:47], v70 offset:27648
    v_mov_b64 v[26:27], 0
    v_smfmac_f32_16x16x64_bf16 v[12:15], v[4:7], v[112:119], v64
    s_waitcnt lgkmcnt(1)
    s_barrier
    ds_read_b128 v[16:19], v77 offset:12288
    v_smfmac_f32_16x16x64_bf16 v[24:27], v[4:7], v[56:63], v64
    ds_read_b128 v[20:23], v78 offset:12288
    ds_read_b128 v[28:31], v79 offset:12288
    v_mov_b64 v[4:5], 0
    v_mov_b64 v[6:7], 0
    v_bfe_u32 v77, v74, 16, 1
    v_mad_i32_i24 v77, v77, s56, v74
    s_waitcnt lgkmcnt(2)
    v_smfmac_f32_16x16x64_bf16 v[8:11], v[16:19], v[88:95], v64
    ds_read_b128 v[56:59], v70 offset:28672
    v_and_b32 v72, 8, v73
    v_smfmac_f32_16x16x64_bf16 v[12:15], v[16:19], v[120:127], v64
    ds_read_b128 v[60:63], v70 offset:29696
    s_waitcnt lgkmcnt(3)
    v_mad_u32_u24 v72, v72, 63, v73
    v_smfmac_f32_16x16x64_bf16 v[8:11], v[20:23], v[96:103], v64
    ds_read_b128 v[48:51], v70 offset:30720
    v_subrev_u32 v72, s47, v72
    v_smfmac_f32_16x16x64_bf16 v[12:15], v[20:23], v[128:135], v64
    ds_read_b128 v[52:55], v70 offset:31744
    s_waitcnt lgkmcnt(4)
    v_smfmac_f32_16x16x64_bf16 v[8:11], v[28:31], v[104:111], v64
    s_add_u32 s30, s30, 1
    s_xor_b32 s70, s70, 1
    s_cmp_lg_u32 s71, 0
    v_smfmac_f32_16x16x64_bf16 v[12:15], v[28:31], v[136:143], v64
    s_nop 2
    v_smfmac_f32_16x16x64_bf16 v[0:3], v[16:19], v[32:39], v64
    ds_read_b128 v[32:35], v70 offset:32768
    ds_read_b128 v[36:39], v70 offset:33792
    v_cvt_pk_bf16_f32 v8, v8, v9
    v_cvt_pk_bf16_f32 v9, v10, v11
    v_and_or_b32 v8, v8, -2, s69
    v_cvt_pk_bf16_f32 v10, v12, v13
    v_cvt_pk_bf16_f32 v11, v14, v15
    v_smfmac_f32_16x16x64_bf16 v[24:27], v[16:19], v[40:47], v64
    buffer_store_dwordx4 v[8:11], v74, s[4:7], s22 offen
    ds_read_b128 v[40:43], v70 offset:34816
    s_waitcnt lgkmcnt(3)
    v_smfmac_f32_16x16x64_bf16 v[0:3], v[20:23], v[56:63], v64
    ds_read_b128 v[44:47], v70 offset:35840
    ds_read_b128 v[56:59], v72 offset:12288
    v_smfmac_f32_16x16x64_bf16 v[24:27], v[20:23], v[48:55], v64
    ds_read_b128 v[60:63], v72 offset:13312
    s_waitcnt lgkmcnt(4)
    v_smfmac_f32_16x16x64_bf16 v[0:3], v[28:31], v[32:39], v64
    s_waitcnt lgkmcnt(2)
    s_nop 1
    v_smfmac_f32_16x16x64_bf16 v[24:27], v[28:31], v[40:47], v64
    s_waitcnt lgkmcnt(0)
    s_nop 1
    v_smfmac_f32_16x16x64_bf16 v[4:7], v[56:59], v[144:151], v64
    v_cvt_pk_bf16_f32 v0, v0, v1
    v_cvt_pk_bf16_f32 v1, v2, v3
    v_and_or_b32 v0, v0, -2, s69
    s_nop 0
    v_cvt_pk_bf16_f32 v2, v24, v25
    v_cvt_pk_bf16_f32 v3, v26, v27
    v_smfmac_f32_16x16x64_bf16 v[4:7], v[60:63], v[152:159], v64
    buffer_store_dwordx4 v[0:3], v74, s[4:7], s23 offen
    s_nop 6
    v_cvt_pk_bf16_f32 v4, v4, v5
    v_cvt_pk_bf16_f32 v5, v6, v7
    v_and_or_b32 v4, v4, -2, s69
    buffer_store_dwordx2 v[4:5], v77, s[4:7], s25 offen
    s_cbranch_scc1 cf_e1
    s_nop 2
    v_mov_b32 v79, v79
    s_nop 2
    v_mov_b32 v79, v79
    s_nop 2
    v_mov_b32 v79, v79
    s_nop 2
    v_mov_b32 v79, v79
    s_nop 2
    v_mov_b32 v79, v79
    s_nop 2
    v_mov_b32 v79, v79
    s_nop 2
    v_mov_b32 v79, v79
    s_nop 2
    v_mov_b32 v79, v79
    s_nop 2
    v_mov_b32 v79, v79
    s_nop 2
    v_mov_b32 v79, v79
    s_nop 2
    v_mov_b32 v79, v79
    s_nop 2
    v_mov_b32 v79, v79
    s_nop 2
    v_mov_b32 v79, v79
    s_nop 2
    v_mov_b32 v79, v79
    buffer_load_dwordx4 v[8:11], v65, s[4:7], s18 offen nt
    buffer_load_dwordx4 v[12:15], v65, s[4:7], s19 offen nt
    buffer_load_dwordx4 v[16:19], v65, s[4:7], s20 offen nt
    buffer_load_dwordx4 v[20:23], v65, s[4:7], s21 offen nt
    v_and_b32 v77, 255, v69
    ds_read_b128 v[4:7], v77 offset:15872
    ds_read_b128 v[40:43], v70 offset:0
    ds_read_b128 v[44:47], v70 offset:1024
    ds_read_b128 v[48:51], v70 offset:2048
    ds_read_b128 v[52:55], v70 offset:3072
    ds_read_b128 v[24:27], v70 offset:4096
    ds_read_b128 v[28:31], v70 offset:5120
    ds_read_b128 v[32:35], v70 offset:6144
    ds_read_b128 v[36:39], v70 offset:7168
    s_mov_b32 s31, 65536
    s_add_u32 s24, s24, 524288
    s_add_u32 s26, s26, 524288
    s_add_u32 s55, s55, s57
    s_mov_b32 s14, 67108864
    s_mov_b32 s15, 67112960
    s_mov_b32 s16, 67117056
    s_mov_b32 s36, 1
    v_mov_b32 v60, s69
    v_mov_b32 v56, s69
    v_and_b32 v79, 12, v75
    v_cmp_eq_u32 vcc, 0, v79
    s_nop 1
    v_cndmask_b32 v79, 0, 1, vcc
    s_waitcnt lgkmcnt(0)
    s_waitcnt vmcnt(3)
    v_xor_b32 v77, s69, v8
    v_mfma_f32_16x16x32_bf16 v[0:3], v[4:7], v[8:11], 0
    v_mov_b64 v[8:9], 0
    v_mov_b64 v[10:11], 0
    s_waitcnt vmcnt(2)
    v_bitop3_b32 v77, v77, v12, s69 bitop3:0xf6
    v_mfma_f32_16x16x32_bf16 v[0:3], v[4:7], v[12:15], v[0:3]
    v_mov_b64 v[12:13], 0
    v_mov_b64 v[14:15], 0
    s_waitcnt vmcnt(1)
    v_bitop3_b32 v77, v77, v16, s69 bitop3:0xf6
    v_mfma_f32_16x16x32_bf16 v[0:3], v[4:7], v[16:19], v[0:3]
    v_mov_b64 v[16:17], 0
    v_mov_b64 v[18:19], 0
    s_waitcnt vmcnt(0)
    v_bitop3_b32 v77, v77, v20, s69 bitop3:0xf6
    v_mfma_f32_16x16x32_bf16 v[0:3], v[4:7], v[20:23], v[0:3]
    v_and_b32 v77, 1, v77
    v_cmp_ne_u32 vcc, 0, v77
    v_mov_b64 v[20:21], 0
    v_mov_b64 v[22:23], 0
    s_cmp_eq_u64 vcc, 0
    s_cselect_b64 s[42:43], -1, 0
    s_nop 1
    v_add_f32_dpp v0, v0, v0 row_ror:8 row_mask:0xf bank_mask:0xf
    v_add_f32_dpp v1, v1, v1 row_ror:8 row_mask:0xf bank_mask:0xf
    s_mov_b64 exec, s[42:43]
    v_cvt_pk_bf16_f32 v72, v0, v1
    v_bfi_b32 v72, v79, s70, v72
    buffer_store_dword v72, v75, s[4:7], s17 offen offset:0
    s_mov_b64 exec, -1
    s_cbranch_scc0 cf_f0_retry
cf_f0_go:
    v_mov_b64 v[0:1], 0
    v_mov_b64 v[2:3], 0
    v_mov_b64 v[4:5], 0
    v_mov_b64 v[6:7], 0
    s_nop 2
    v_mov_b32 v79, v79
    s_nop 2
    v_mov_b32 v79, v79
    s_nop 2
    v_mov_b32 v79, v79
    s_nop 2
    v_mov_b32 v79, v79
    s_branch cf_loop
cf_e1:
    s_cmp_lg_u32 s71, 2
    s_cbranch_scc1 cf_f1
    v_and_b32 v77, 255, v69
    ds_read_b128 v[4:7], v77 offset:15872
    ds_read_b128 v[40:43], v70 offset:0
    ds_read_b128 v[44:47], v70 offset:1024
    ds_read_b128 v[48:51], v70 offset:2048
    ds_read_b128 v[52:55], v70 offset:3072
    ds_read_b128 v[24:27], v70 offset:4096
    ds_read_b128 v[28:31], v70 offset:5120
    ds_read_b128 v[32:35], v70 offset:6144
    ds_read_b128 v[36:39], v70 offset:7168
    s_mov_b32 s31, 65536
    s_add_u32 s24, s24, 524288
    s_add_u32 s26, s26, 524288
    s_add_u32 s55, s55, s57
    s_mov_b32 s14, 67108864
    s_mov_b32 s15, 67112960
    s_mov_b32 s16, 67117056
    s_mov_b32 s36, 1
    v_mov_b32 v60, s69
    v_mov_b32 v56, s69
    v_and_b32 v79, 12, v75
    v_cmp_eq_u32 vcc, 0, v79
    s_nop 1
    v_cndmask_b32 v79, 0, 1, vcc
    s_nop 2
    v_mov_b32 v79, v79
    s_nop 2
    v_mov_b32 v79, v79
    s_nop 2
    v_mov_b32 v79, v79
    s_nop 2
    v_mov_b32 v79, v79
    s_nop 2
    v_mov_b32 v79, v79
    s_nop 2
    v_mov_b32 v79, v79
    s_nop 2
    v_mov_b32 v79, v79
    s_nop 2
    v_mov_b32 v79, v79
    s_nop 2
    v_mov_b32 v79, v79
    s_nop 2
    v_mov_b32 v79, v79
    s_nop 2
    v_mov_b32 v79, v79
    s_nop 2
    v_mov_b32 v79, v79
    s_nop 2
    v_mov_b32 v79, v79
    s_nop 2
    v_mov_b32 v79, v79
    s_waitcnt vmcnt(0)
    buffer_load_dwordx4 v[8:11], v65, s[4:7], s18 offen nt
    buffer_load_dwordx4 v[12:15], v65, s[4:7], s19 offen nt
    buffer_load_dwordx4 v[16:19], v65, s[4:7], s20 offen nt
    buffer_load_dwordx4 v[20:23], v65, s[4:7], s21 offen nt
    s_nop 2
    v_mov_b32 v79, v79
    s_nop 2
    v_mov_b32 v79, v79
    s_nop 2
    v_mov_b32 v79, v79
    s_nop 2
    v_mov_b32 v79, v79
    s_nop 2
    v_mov_b32 v79, v79
    s_nop 2
    v_mov_b32 v79, v79
    s_nop 2
    v_mov_b32 v79, v79
    s_nop 2
    v_mov_b32 v79, v79
    s_nop 2
    v_mov_b32 v79, v79
    s_nop 2
    v_mov_b32 v79, v79
    buffer_load_dwordx4 v[60:63], v65, s[4:7], s14 offen offset:0 nt
    buffer_load_dwordx4 v[56:59], v66, s[4:7], s14 offen offset:0 nt
    s_waitcnt lgkmcnt(0)
    s_waitcnt vmcnt(5)
    v_xor_b32 v77, s69, v8
    v_bitop3_b32 v77, v77, v10, s69 bitop3:0xf6
    v_mfma_f32_16x16x32_bf16 v[0:3], v[4:7], v[8:11], 0
    v_mov_b64 v[8:9], 0
    v_mov_b64 v[10:11], 0
    s_waitcnt vmcnt(4)
    v_bitop3_b32 v77, v77, v12, s69 bitop3:0xf6
    v_bitop3_b32 v77, v77, v14, s69 bitop3:0xf6
    v_mfma_f32_16x16x32_bf16 v[0:3], v[4:7], v[12:15], v[0:3]
    v_mov_b64 v[12:13], 0
    v_mov_b64 v[14:15], 0
    s_waitcnt vmcnt(3)
    v_bitop3_b32 v77, v77, v16, s69 bitop3:0xf6
    v_bitop3_b32 v77, v77, v18, s69 bitop3:0xf6
    v_mfma_f32_16x16x32_bf16 v[0:3], v[4:7], v[16:19], v[0:3]
    v_mov_b64 v[16:17], 0
    v_mov_b64 v[18:19], 0
    s_waitcnt vmcnt(2)
    v_bitop3_b32 v77, v77, v20, s69 bitop3:0xf6
    v_bitop3_b32 v77, v77, v22, s69 bitop3:0xf6
    v_mfma_f32_16x16x32_bf16 v[0:3], v[4:7], v[20:23], v[0:3]
    v_and_b32 v77, 1, v77
    v_cmp_ne_u32 vcc, 0, v77
    v_mov_b64 v[20:21], 0
    v_mov_b64 v[22:23], 0
    buffer_load_dwordx4 v[60:63], v65, s[4:7], s14 offen offset:0 nt
    buffer_load_dwordx4 v[56:59], v66, s[4:7], s14 offen offset:0 nt
    s_cmp_eq_u64 vcc, 0
    s_cselect_b64 s[42:43], -1, 0
    v_add_f32 v2, v0, v1
    s_nop 1
    v_add_f32_dpp v2, v2, v2 row_ror:8 row_mask:0xf bank_mask:0xf
    s_nop 1
    v_mov_b32_dpp v0, v2 quad_perm:[0,0,2,2] row_mask:0xf bank_mask:0xf
    v_mov_b32_dpp v1, v2 quad_perm:[1,1,3,3] row_mask:0xf bank_mask:0xf
    s_mov_b64 exec, s[42:43]
    v_cvt_pk_bf16_f32 v72, v0, v1
    v_bfi_b32 v72, v79, s70, v72
    buffer_store_dword v72, v75, s[4:7], s17 offen offset:0
    buffer_store_dword v72, v75, s[4:7], s17 offen offset:1024
    buffer_store_dword v72, v75, s[4:7], s17 offen offset:2048
    buffer_store_dword v72, v75, s[4:7], s17 offen offset:3072
    s_mov_b64 exec, -1
    s_cbranch_scc0 cf_f2_retry
cf_f2_go:
    v_mov_b64 v[0:1], 0
    v_mov_b64 v[2:3], 0
    v_mov_b64 v[4:5], 0
    v_mov_b64 v[6:7], 0
    s_branch cf_loop
cf_f1:
    s_cmp_lg_u32 s32, 1
    s_cbranch_scc1 cf_f3
    v_and_b32 v77, 255, v69
    ds_read_b128 v[4:7], v77 offset:15872
    ds_read_b128 v[40:43], v70 offset:0
    ds_read_b128 v[44:47], v70 offset:1024
    ds_read_b128 v[48:51], v70 offset:2048
    ds_read_b128 v[52:55], v70 offset:3072
    ds_read_b128 v[24:27], v70 offset:4096
    ds_read_b128 v[28:31], v70 offset:5120
    ds_read_b128 v[32:35], v70 offset:6144
    ds_read_b128 v[36:39], v70 offset:7168
    s_mov_b32 s31, 65536
    s_add_u32 s24, s24, 524288
    s_add_u32 s26, s26, 524288
    s_add_u32 s55, s55, s57
    s_mov_b32 s14, 67108864
    s_mov_b32 s15, 67112960
    s_mov_b32 s16, 67117056
    s_mov_b32 s36, 1
    v_mov_b32 v60, s69
    v_mov_b32 v56, s69
    v_and_b32 v79, 12, v75
    v_cmp_eq_u32 vcc, 0, v79
    s_nop 1
    v_cndmask_b32 v79, 0, 1, vcc
    s_nop 2
    v_mov_b32 v79, v79
    s_nop 2
    v_mov_b32 v79, v79
    s_nop 2
    v_mov_b32 v79, v79
    s_nop 2
    v_mov_b32 v79, v79
    s_nop 2
    v_mov_b32 v79, v79
    s_nop 2
    v_mov_b32 v79, v79
    s_nop 2
    v_mov_b32 v79, v79
    s_nop 2
    v_mov_b32 v79, v79
    s_nop 2
    v_mov_b32 v79, v79
    s_nop 2
    v_mov_b32 v79, v79
    s_nop 2
    v_mov_b32 v79, v79
    s_nop 2
    v_mov_b32 v79, v79
    s_waitcnt vmcnt(0)
    buffer_load_dwordx4 v[8:11], v65, s[4:7], s18 offen nt
    buffer_load_dwordx4 v[12:15], v65, s[4:7], s19 offen nt
    buffer_load_dwordx4 v[16:19], v65, s[4:7], s20 offen nt
    buffer_load_dwordx4 v[20:23], v65, s[4:7], s21 offen nt
    s_nop 2
    v_mov_b32 v79, v79
    s_nop 2
    v_mov_b32 v79, v79
    s_nop 2
    v_mov_b32 v79, v79
    s_nop 2
    v_mov_b32 v79, v79
    s_nop 2
    v_mov_b32 v79, v79
    s_nop 2
    v_mov_b32 v79, v79
    s_nop 2
    v_mov_b32 v79, v79
    s_nop 2
    v_mov_b32 v79, v79
    s_nop 2
    v_mov_b32 v79, v79
    s_nop 2
    v_mov_b32 v79, v79
    buffer_load_dwordx4 v[60:63], v65, s[4:7], s14 offen offset:0 nt
    buffer_load_dwordx4 v[56:59], v66, s[4:7], s14 offen offset:0 nt
    s_waitcnt lgkmcnt(0)
    s_waitcnt vmcnt(5)
    v_xor_b32 v77, s69, v8
    v_mfma_f32_16x16x32_bf16 v[0:3], v[4:7], v[8:11], 0
    v_mov_b64 v[8:9], 0
    v_mov_b64 v[10:11], 0
    s_waitcnt vmcnt(4)
    v_bitop3_b32 v77, v77, v12, s69 bitop3:0xf6
    v_mfma_f32_16x16x32_bf16 v[0:3], v[4:7], v[12:15], v[0:3]
    v_mov_b64 v[12:13], 0
    v_mov_b64 v[14:15], 0
    s_waitcnt vmcnt(3)
    v_bitop3_b32 v77, v77, v16, s69 bitop3:0xf6
    v_mfma_f32_16x16x32_bf16 v[0:3], v[4:7], v[16:19], v[0:3]
    v_mov_b64 v[16:17], 0
    v_mov_b64 v[18:19], 0
    s_waitcnt vmcnt(2)
    v_bitop3_b32 v77, v77, v20, s69 bitop3:0xf6
    v_mfma_f32_16x16x32_bf16 v[0:3], v[4:7], v[20:23], v[0:3]
    v_and_b32 v77, 1, v77
    v_cmp_ne_u32 vcc, 0, v77
    v_mov_b64 v[20:21], 0
    v_mov_b64 v[22:23], 0
    buffer_load_dwordx4 v[60:63], v65, s[4:7], s14 offen offset:0 nt
    buffer_load_dwordx4 v[56:59], v66, s[4:7], s14 offen offset:0 nt
    s_cmp_eq_u64 vcc, 0
    s_cselect_b64 s[42:43], -1, 0
    v_add_f32_dpp v0, v0, v0 row_ror:8 row_mask:0xf bank_mask:0xf
    v_add_f32_dpp v1, v1, v1 row_ror:8 row_mask:0xf bank_mask:0xf
    s_mov_b64 exec, s[42:43]
    v_cvt_pk_bf16_f32 v72, v0, v1
    v_bfi_b32 v72, v79, s70, v72
    buffer_store_dword v72, v75, s[4:7], s17 offen offset:0
    s_mov_b64 exec, -1
    s_cbranch_scc0 cf_f1_retry
cf_f1_go:
    v_mov_b64 v[0:1], 0
    v_mov_b64 v[2:3], 0
    v_mov_b64 v[4:5], 0
    v_mov_b64 v[6:7], 0
    s_branch cf_loop
cf_f3:
    v_and_b32 v77, 255, v69
    ds_read_b128 v[4:7], v77 offset:15872
    ds_read_b128 v[40:43], v70 offset:0
    ds_read_b128 v[44:47], v70 offset:1024
    ds_read_b128 v[48:51], v70 offset:2048
    ds_read_b128 v[52:55], v70 offset:3072
    ds_read_b128 v[24:27], v70 offset:4096
    ds_read_b128 v[28:31], v70 offset:5120
    ds_read_b128 v[32:35], v70 offset:6144
    ds_read_b128 v[36:39], v70 offset:7168
    s_mov_b32 s31, 65536
    s_add_u32 s24, s24, 524288
    s_add_u32 s26, s26, 524288
    s_add_u32 s55, s55, s57
    s_mov_b32 s14, 67108864
    s_mov_b32 s15, 67112960
    s_mov_b32 s16, 67117056
    s_mov_b32 s36, 1
    v_mov_b32 v60, s69
    v_mov_b32 v56, s69
    v_and_b32 v79, 12, v75
    v_cmp_eq_u32 vcc, 0, v79
    s_nop 1
    v_cndmask_b32 v79, 0, 1, vcc
    s_add_u32 s40, s30, s95
    v_mov_b32 v72, s40
    s_waitcnt lgkmcnt(0)
    v_mov_b64 v[0:1], 0
    v_mov_b64 v[2:3], 0
    v_mov_b64 v[4:5], 0
    v_mov_b64 v[6:7], 0
    v_mov_b64 v[8:9], 0
    v_mov_b64 v[10:11], 0
    v_mov_b64 v[12:13], 0
    v_mov_b64 v[14:15], 0
    v_mov_b64 v[16:17], 0
    v_mov_b64 v[18:19], 0
    v_mov_b64 v[20:21], 0
    v_mov_b64 v[22:23], 0
    s_nop 2
    v_mov_b32 v79, v79
    s_nop 2
    v_mov_b32 v79, v79
    s_nop 2
    v_mov_b32 v79, v79
    s_nop 2
    v_mov_b32 v79, v79
    s_nop 2
    v_mov_b32 v79, v79
    s_nop 2
    v_mov_b32 v79, v79
    s_nop 2
    v_mov_b32 v79, v79
    s_nop 2
    v_mov_b32 v79, v79
    s_nop 2
    v_mov_b32 v79, v79
    s_nop 2
    v_mov_b32 v79, v79
    s_nop 2
    v_mov_b32 v79, v79
    s_nop 2
    v_mov_b32 v79, v79
    s_nop 2
    v_mov_b32 v79, v79
    s_nop 2
    v_mov_b32 v79, v79
    s_nop 2
    v_mov_b32 v79, v79
    s_nop 2
    v_mov_b32 v79, v79
    s_nop 2
    v_mov_b32 v79, v79
    s_nop 2
    v_mov_b32 v79, v79
    s_waitcnt vmcnt(0)
    s_cmp_lt_u32 s97, s93
    s_cbranch_scc1 cf_kvwait
    s_nop 2
    v_mov_b32 v79, v79
    s_nop 2
    v_mov_b32 v79, v79
    s_nop 2
    v_mov_b32 v79, v79
    s_nop 2
    v_mov_b32 v79, v79
    s_nop 2
    v_mov_b32 v79, v79
    s_nop 2
    v_mov_b32 v79, v79
    s_nop 2
    v_mov_b32 v79, v79
    s_nop 2
    v_mov_b32 v79, v79
cf_kvok:
    s_branch cf_loop
cf_f0_retry:
cf_f0_spin:
    s_nop 0
    buffer_load_dwordx4 v[8:11], v65, s[4:7], s18 offen nt
    buffer_load_dwordx4 v[12:15], v65, s[4:7], s19 offen nt
    buffer_load_dwordx4 v[16:19], v65, s[4:7], s20 offen nt
    buffer_load_dwordx4 v[20:23], v65, s[4:7], s21 offen nt
    s_nop 2
    v_mov_b32 v79, v79
    s_nop 2
    v_mov_b32 v79, v79
    s_nop 2
    v_mov_b32 v79, v79
    s_nop 2
    v_mov_b32 v79, v79
    s_nop 2
    v_mov_b32 v79, v79
    s_nop 2
    v_mov_b32 v79, v79
    buffer_load_dwordx4 v[60:63], v65, s[4:7], s14 offen offset:0 nt
    buffer_load_dwordx4 v[56:59], v66, s[4:7], s14 offen offset:0 nt
    s_waitcnt vmcnt(5)
    v_xor_b32 v77, s69, v8
    v_mfma_f32_16x16x32_bf16 v[0:3], v[4:7], v[8:11], 0
    v_mov_b64 v[8:9], 0
    v_mov_b64 v[10:11], 0
    s_waitcnt vmcnt(4)
    v_bitop3_b32 v77, v77, v12, s69 bitop3:0xf6
    v_mfma_f32_16x16x32_bf16 v[0:3], v[4:7], v[12:15], v[0:3]
    v_mov_b64 v[12:13], 0
    v_mov_b64 v[14:15], 0
    s_waitcnt vmcnt(3)
    v_bitop3_b32 v77, v77, v16, s69 bitop3:0xf6
    v_mfma_f32_16x16x32_bf16 v[0:3], v[4:7], v[16:19], v[0:3]
    v_mov_b64 v[16:17], 0
    v_mov_b64 v[18:19], 0
    s_waitcnt vmcnt(2)
    v_bitop3_b32 v77, v77, v20, s69 bitop3:0xf6
    v_mfma_f32_16x16x32_bf16 v[0:3], v[4:7], v[20:23], v[0:3]
    v_and_b32 v77, 1, v77
    v_cmp_ne_u32 vcc, 0, v77
    v_mov_b64 v[20:21], 0
    v_mov_b64 v[22:23], 0
    buffer_load_dwordx4 v[60:63], v65, s[4:7], s14 offen offset:0 nt
    buffer_load_dwordx4 v[56:59], v66, s[4:7], s14 offen offset:0 nt
    s_cmp_eq_u64 vcc, 0
    s_cselect_b64 s[42:43], -1, 0
    v_add_f32_dpp v0, v0, v0 row_ror:8 row_mask:0xf bank_mask:0xf
    v_add_f32_dpp v1, v1, v1 row_ror:8 row_mask:0xf bank_mask:0xf
    s_mov_b64 exec, s[42:43]
    v_cvt_pk_bf16_f32 v72, v0, v1
    v_bfi_b32 v72, v79, s70, v72
    buffer_store_dword v72, v75, s[4:7], s17 offen offset:0
    s_mov_b64 exec, -1
    s_cbranch_scc1 cf_f0_rx
    s_sub_u32 s31, s31, 1
    s_cbranch_scc0 cf_f0_spin
cf_f0_rx:
    v_mov_b64 v[0:1], 0
    v_mov_b64 v[2:3], 0
    v_mov_b64 v[4:5], 0
    v_mov_b64 v[6:7], 0
    s_branch cf_loop
cf_f1_retry:
cf_f1_spin:
    s_nop 0
    buffer_load_dwordx4 v[8:11], v65, s[4:7], s18 offen nt
    buffer_load_dwordx4 v[12:15], v65, s[4:7], s19 offen nt
    buffer_load_dwordx4 v[16:19], v65, s[4:7], s20 offen nt
    buffer_load_dwordx4 v[20:23], v65, s[4:7], s21 offen nt
    s_nop 2
    v_mov_b32 v79, v79
    s_nop 2
    v_mov_b32 v79, v79
    s_nop 2
    v_mov_b32 v79, v79
    s_nop 2
    v_mov_b32 v79, v79
    s_nop 2
    v_mov_b32 v79, v79
    s_nop 2
    v_mov_b32 v79, v79
    buffer_load_dwordx4 v[60:63], v65, s[4:7], s14 offen offset:0 nt
    buffer_load_dwordx4 v[56:59], v66, s[4:7], s14 offen offset:0 nt
    s_waitcnt vmcnt(5)
    v_xor_b32 v77, s69, v8
    v_mfma_f32_16x16x32_bf16 v[0:3], v[4:7], v[8:11], 0
    v_mov_b64 v[8:9], 0
    v_mov_b64 v[10:11], 0
    s_waitcnt vmcnt(4)
    v_bitop3_b32 v77, v77, v12, s69 bitop3:0xf6
    v_mfma_f32_16x16x32_bf16 v[0:3], v[4:7], v[12:15], v[0:3]
    v_mov_b64 v[12:13], 0
    v_mov_b64 v[14:15], 0
    s_waitcnt vmcnt(3)
    v_bitop3_b32 v77, v77, v16, s69 bitop3:0xf6
    v_mfma_f32_16x16x32_bf16 v[0:3], v[4:7], v[16:19], v[0:3]
    v_mov_b64 v[16:17], 0
    v_mov_b64 v[18:19], 0
    s_waitcnt vmcnt(2)
    v_bitop3_b32 v77, v77, v20, s69 bitop3:0xf6
    v_mfma_f32_16x16x32_bf16 v[0:3], v[4:7], v[20:23], v[0:3]
    v_and_b32 v77, 1, v77
    v_cmp_ne_u32 vcc, 0, v77
    v_mov_b64 v[20:21], 0
    v_mov_b64 v[22:23], 0
    buffer_load_dwordx4 v[60:63], v65, s[4:7], s14 offen offset:0 nt
    buffer_load_dwordx4 v[56:59], v66, s[4:7], s14 offen offset:0 nt
    s_cmp_eq_u64 vcc, 0
    s_cselect_b64 s[42:43], -1, 0
    v_add_f32_dpp v0, v0, v0 row_ror:8 row_mask:0xf bank_mask:0xf
    v_add_f32_dpp v1, v1, v1 row_ror:8 row_mask:0xf bank_mask:0xf
    s_mov_b64 exec, s[42:43]
    v_cvt_pk_bf16_f32 v72, v0, v1
    v_bfi_b32 v72, v79, s70, v72
    buffer_store_dword v72, v75, s[4:7], s17 offen offset:0
    s_mov_b64 exec, -1
    s_cbranch_scc1 cf_f1_rx
    s_sub_u32 s31, s31, 1
    s_cbranch_scc0 cf_f1_spin
cf_f1_rx:
    v_mov_b64 v[0:1], 0
    v_mov_b64 v[2:3], 0
    v_mov_b64 v[4:5], 0
    v_mov_b64 v[6:7], 0
    s_branch cf_loop
cf_f2_retry:
cf_f2_spin:
    s_nop 0
    buffer_load_dwordx4 v[8:11], v65, s[4:7], s18 offen nt
    buffer_load_dwordx4 v[12:15], v65, s[4:7], s19 offen nt
    buffer_load_dwordx4 v[16:19], v65, s[4:7], s20 offen nt
    buffer_load_dwordx4 v[20:23], v65, s[4:7], s21 offen nt
    s_nop 2
    v_mov_b32 v79, v79
    s_nop 2
    v_mov_b32 v79, v79
    s_nop 2
    v_mov_b32 v79, v79
    s_nop 2
    v_mov_b32 v79, v79
    s_nop 2
    v_mov_b32 v79, v79
    s_nop 2
    v_mov_b32 v79, v79
    buffer_load_dwordx4 v[60:63], v65, s[4:7], s14 offen offset:0 nt
    buffer_load_dwordx4 v[56:59], v66, s[4:7], s14 offen offset:0 nt
    s_waitcnt vmcnt(5)
    v_xor_b32 v77, s69, v8
    v_bitop3_b32 v77, v77, v10, s69 bitop3:0xf6
    v_mfma_f32_16x16x32_bf16 v[0:3], v[4:7], v[8:11], 0
    v_mov_b64 v[8:9], 0
    v_mov_b64 v[10:11], 0
    s_waitcnt vmcnt(4)
    v_bitop3_b32 v77, v77, v12, s69 bitop3:0xf6
    v_bitop3_b32 v77, v77, v14, s69 bitop3:0xf6
    v_mfma_f32_16x16x32_bf16 v[0:3], v[4:7], v[12:15], v[0:3]
    v_mov_b64 v[12:13], 0
    v_mov_b64 v[14:15], 0
    s_waitcnt vmcnt(3)
    v_bitop3_b32 v77, v77, v16, s69 bitop3:0xf6
    v_bitop3_b32 v77, v77, v18, s69 bitop3:0xf6
    v_mfma_f32_16x16x32_bf16 v[0:3], v[4:7], v[16:19], v[0:3]
    v_mov_b64 v[16:17], 0
    v_mov_b64 v[18:19], 0
    s_waitcnt vmcnt(2)
    v_bitop3_b32 v77, v77, v20, s69 bitop3:0xf6
    v_bitop3_b32 v77, v77, v22, s69 bitop3:0xf6
    v_mfma_f32_16x16x32_bf16 v[0:3], v[4:7], v[20:23], v[0:3]
    v_and_b32 v77, 1, v77
    v_cmp_ne_u32 vcc, 0, v77
    v_mov_b64 v[20:21], 0
    v_mov_b64 v[22:23], 0
    buffer_load_dwordx4 v[60:63], v65, s[4:7], s14 offen offset:0 nt
    buffer_load_dwordx4 v[56:59], v66, s[4:7], s14 offen offset:0 nt
    s_cmp_eq_u64 vcc, 0
    s_cselect_b64 s[42:43], -1, 0
    v_add_f32 v2, v0, v1
    s_nop 1
    v_add_f32_dpp v2, v2, v2 row_ror:8 row_mask:0xf bank_mask:0xf
    s_nop 1
    v_mov_b32_dpp v0, v2 quad_perm:[0,0,2,2] row_mask:0xf bank_mask:0xf
    v_mov_b32_dpp v1, v2 quad_perm:[1,1,3,3] row_mask:0xf bank_mask:0xf
    s_mov_b64 exec, s[42:43]
    v_cvt_pk_bf16_f32 v72, v0, v1
    v_bfi_b32 v72, v79, s70, v72
    buffer_store_dword v72, v75, s[4:7], s17 offen offset:0
    buffer_store_dword v72, v75, s[4:7], s17 offen offset:1024
    buffer_store_dword v72, v75, s[4:7], s17 offen offset:2048
    buffer_store_dword v72, v75, s[4:7], s17 offen offset:3072
    s_mov_b64 exec, -1
    s_cbranch_scc1 cf_f2_rx
    s_sub_u32 s31, s31, 1
    s_cbranch_scc0 cf_f2_spin
cf_f2_rx:
    v_mov_b64 v[0:1], 0
    v_mov_b64 v[2:3], 0
    v_mov_b64 v[4:5], 0
    v_mov_b64 v[6:7], 0
    s_branch cf_loop
cf_spinB:
    buffer_load_dwordx4 v[40:43], v65, s[4:7], s15 offen nt
cf_spinB_l:
    v_and_b32 v77, s36, v40
    v_cmp_ne_u32 vcc, s70, v77
    s_cbranch_vccz cf_spinB_x
    s_nop 1
    v_and_b32 v77, s36, v40
    v_cmp_ne_u32 vcc, s70, v77
    s_cbranch_vccz cf_spinB_x
    s_nop 1
    v_and_b32 v77, s36, v40
    v_cmp_ne_u32 vcc, s70, v77
    s_cbranch_vccz cf_spinB_x
    s_nop 1
    buffer_load_dwordx4 v[40:43], v65, s[4:7], s15 offen nt
    s_sub_u32 s31, s31, 16
    s_cbranch_scc0 cf_spinB_l
cf_spinB_x:
    ds_write_b128 v65, v[40:43] offset:4096
    s_waitcnt lgkmcnt(0)
    s_branch cf_backB
cf_spin8:
    buffer_load_dwordx4 v[60:63], v65, s[4:7], s16 offen nt
cf_spin8_l:
    v_and_b32 v77, s36, v60
    v_cmp_ne_u32 vcc, s70, v77
    s_cbranch_vccz cf_spin8_x
    s_nop 1
    v_and_b32 v77, s36, v60
    v_cmp_ne_u32 vcc, s70, v77
    s_cbranch_vccz cf_spin8_x
    s_nop 1
    v_and_b32 v77, s36, v60
    v_cmp_ne_u32 vcc, s70, v77
    s_cbranch_vccz cf_spin8_x
    s_nop 1
    buffer_load_dwordx4 v[60:63], v65, s[4:7], s16 offen nt
    s_sub_u32 s31, s31, 16
    s_cbranch_scc0 cf_spin8_l
cf_spin8_x:
    s_branch cf_back8
cf_rare:
    s_mov_b64 exec, s[34:35]
    buffer_store_dwordx4 v[0:3], v65, s[4:7], s28 offen sc1
    s_mov_b64 exec, -1
    s_nop 3
    v_cvt_pk_bf16_f32 v48, v16, v17
    v_cvt_pk_bf16_f32 v49, v18, v19
    v_cvt_pk_bf16_f32 v50, v20, v21
    v_cvt_pk_bf16_f32 v51, v22, v23
    buffer_store_dwordx4 v[48:51], v65, s[4:7], s27 offen sc1
    s_add_u32 s28, s28, 131072
    s_add_u32 s27, s27, 131072
    s_cmp_eq_u32 s30, 63
    s_cbranch_scc1 cf_last
    s_branch cf_rare_x
cf_kvwait:
    s_mov_b32 s41, s97
    v_bfe_u32 v78, v65, 2, 5
    v_mov_b32 v77, v76
    s_nop 1
    v_permlane32_swap_b32 v76, v77
    v_subrev_u32 v77, s95, v77
    v_cmp_lt_u32 vcc, 16, v77
    s_nop 1
    v_cndmask_b32 v77, v77, 0, vcc
    v_bfe_u32 v79, v78, 2, 2
    v_lshl_add_u32 v77, v77, 2, v79
    s_nop 1
    v_min_u32_dpp v77, v77, v77 row_ror:1 row_mask:0xf bank_mask:0xf
    s_nop 1
    v_min_u32_dpp v77, v77, v77 row_ror:2 row_mask:0xf bank_mask:0xf
    s_nop 1
    v_min_u32_dpp v77, v77, v77 row_ror:4 row_mask:0xf bank_mask:0xf
    s_nop 0
    v_readfirstlane_b32 s97, v77
    s_nop 0
    s_max_u32 s97, s97, s41
    s_add_u32 s40, s30, 3
    s_min_u32 s40, s40, 64
    s_cmp_le_u32 s40, s97
    s_cbranch_scc1 cf_kvw_x
    v_bfe_u32 v78, v65, 2, 5
    s_mov_b32 s31, 4194304
cf_kvw:
    buffer_load_dword v77, v78, s[4:7], s96 offen offset:16 sc1
    s_waitcnt vmcnt(0)
    v_subrev_u32 v77, s95, v77
    v_cmp_lt_u32 vcc, 16, v77
    s_nop 1
    v_cndmask_b32 v77, v77, 0, vcc
    v_bfe_u32 v79, v78, 2, 2
    v_lshl_add_u32 v77, v77, 2, v79
    s_nop 1
    v_min_u32_dpp v77, v77, v77 row_ror:1 row_mask:0xf bank_mask:0xf
    s_nop 1
    v_min_u32_dpp v77, v77, v77 row_ror:2 row_mask:0xf bank_mask:0xf
    s_nop 1
    v_min_u32_dpp v77, v77, v77 row_ror:4 row_mask:0xf bank_mask:0xf
    s_nop 0
    v_readfirstlane_b32 s97, v77
    s_sub_u32 s31, s31, 1
    s_cbranch_scc1 cf_kvw_x
    s_cmp_le_u32 s40, s97
    s_cbranch_scc1 cf_kvw_x
    s_sleep 2
    s_branch cf_kvw
cf_kvw_x:
    s_branch cf_kvok
cf_last:
    s_add_u32 s40, s95, 64
    v_mov_b32 v78, s40
    s_waitcnt vmcnt(0)
    s_barrier
    s_mov_b64 exec, s[100:101]
    buffer_store_dword v78, off, s[4:7], s29 sc1
    s_mov_b64 exec, -1
cf_end:
    s_endpgm
L_chain_safe:
    s_load_dwordx8 s[48:55], s[0:1], 8
    s_load_dwordx2 s[56:57], s[0:1], 40
    s_waitcnt lgkmcnt(0)
    v_lshrrev_b32 v77, 6, v0
    s_nop 0
    v_readfirstlane_b32 s13, v77
    v_lshlrev_b32 v65, 4, v0
    v_and_b32 v48, 63, v0
    s_mov_b32 s10, 4718592
    s_mov_b32 s11, 0x20000
    v_lshrrev_b32 v49, 3, v48
    v_mul_u32_u24 v18, 1152, v49
    v_and_b32 v49, 7, v48
    v_lshl_add_u32 v18, v49, 4, v18
    s_mul_i32 s40, s12, 147456
    s_lshl_b32 s41, s13, 8
    s_add_u32 s40, s40, s41
    s_mov_b32 s42, s40
    s_xor_b32 s41, s13, 0
    s_mul_i32 s41, s41, 36864
    s_add_u32 s60, s41, s40
    s_xor_b32 s41, s13, 1
    s_mul_i32 s41, s41, 36864
    s_add_u32 s61, s41, s40
    s_xor_b32 s41, s13, 2
    s_mul_i32 s41, s41, 36864
    s_add_u32 s62, s41, s40
    s_xor_b32 s41, s13, 3
    s_mul_i32 s41, s41, 36864
    s_add_u32 s63, s41, s40
    s_lshl_b32 s43, s13, 12
    s_mov_b64 s[8:9], s[56:57]
    s_add_u32 m0, s43, 0
    s_add_u32 s41, s60, 0
    buffer_load_dwordx4 v18, s[8:11], s41 offen offset:0 nt lds
    s_add_u32 s41, s60, 8192
    buffer_load_dwordx4 v18, s[8:11], s41 offen offset:1024 nt lds
    s_add_u32 s41, s60, 16384
    buffer_load_dwordx4 v18, s[8:11], s41 offen offset:2048 nt lds
    s_add_u32 s41, s60, 24576
    buffer_load_dwordx4 v18, s[8:11], s41 offen offset:3072 nt lds
    s_add_u32 m0, s43, 36864
    s_add_u32 s41, s61, 0
    buffer_load_dwordx4 v18, s[8:11], s41 offen offset:0 nt lds
    s_add_u32 s41, s61, 8192
    buffer_load_dwordx4 v18, s[8:11], s41 offen offset:1024 nt lds
    s_add_u32 s41, s61, 16384
    buffer_load_dwordx4 v18, s[8:11], s41 offen offset:2048 nt lds
    s_add_u32 s41, s61, 24576
    buffer_load_dwordx4 v18, s[8:11], s41 offen offset:3072 nt lds
    s_add_u32 m0, s43, 73728
    s_add_u32 s41, s62, 0
    buffer_load_dwordx4 v18, s[8:11], s41 offen offset:0 nt lds
    s_add_u32 s41, s62, 8192
    buffer_load_dwordx4 v18, s[8:11], s41 offen offset:1024 nt lds
    s_add_u32 s41, s62, 16384
    buffer_load_dwordx4 v18, s[8:11], s41 offen offset:2048 nt lds
    s_add_u32 s41, s62, 24576
    buffer_load_dwordx4 v18, s[8:11], s41 offen offset:3072 nt lds
    s_add_u32 m0, s43, 110592
    s_add_u32 s41, s63, 0
    buffer_load_dwordx4 v18, s[8:11], s41 offen offset:0 nt lds
    s_add_u32 s41, s63, 8192
    buffer_load_dwordx4 v18, s[8:11], s41 offen offset:1024 nt lds
    s_add_u32 s41, s63, 16384
    buffer_load_dwordx4 v18, s[8:11], s41 offen offset:2048 nt lds
    s_add_u32 s41, s63, 24576
    buffer_load_dwordx4 v18, s[8:11], s41 offen offset:3072 nt lds
    v_lshrrev_b32 v49, 1, v48
    v_mul_u32_u24 v19, 1152, v49
    v_and_b32 v49, 1, v48
    v_lshl_add_u32 v19, v49, 4, v19
    s_mul_i32 s41, s13, 224
    s_sub_u32 s41, 1024, s41
    v_add_u32 v19, s41, v19
    v_lshrrev_b32 v49, 4, v48
    v_lshlrev_b32 v50, 2, v49
    v_and_b32 v51, 15, v48
    v_xor_b32 v51, v51, v50
    v_lshlrev_b32 v51, 4, v51
    v_lshl_add_u32 v16, v49, 15, v51
    v_lshrrev_b32 v50, 1, v49
    v_lshl_add_u32 v17, v50, 16, v51
    v_and_b32 v50, 1, v49
    v_lshl_add_u32 v17, v50, 13, v17
    s_lshl_b32 s40, s12, 8
    s_mul_i32 s58, s13, 1048576
    s_add_u32 s58, s58, s40
    s_lshr_b32 s41, s13, 1
    s_mul_i32 s59, s41, 262144
    s_and_b32 s41, s13, 1
    s_lshl_b32 s41, s41, 14
    s_add_u32 s59, s59, s41
    s_add_u32 s59, s59, s40
    s_add_u32 s59, s59, 4194304
    v_bfe_u32 v50, v48, 2, 2
    v_xor_b32 v51, s13, v50
    v_lshlrev_b32 v20, 6, v51
    v_and_b32 v51, 3, v48
    v_lshl_add_u32 v20, v51, 4, v20
    v_lshrrev_b32 v23, 2, v48
    v_lshl_add_u32 v20, v23, 8, v20
    s_xor_b32 s41, s43, 0
    v_add_u32 v24, s41, v20
    s_xor_b32 s41, s43, 4096
    v_add_u32 v25, s41, v20
    s_xor_b32 s41, s43, 8192
    v_add_u32 v26, s41, v20
    s_xor_b32 s41, s43, 12288
    v_add_u32 v27, s41, v20
    v_and_b32 v23, 1, v50
    v_lshl_add_u32 v23, v49, 2, v23
    v_lshrrev_b32 v50, 1, v50
    v_lshlrev_b32 v21, 7, v23
    v_lshl_add_u32 v21, v50, 6, v21
    v_lshl_add_u32 v21, v51, 4, v21
    v_add_u32 v21, s43, v21
    v_lshlrev_b32 v22, 9, v50
    v_xor_b32 v22, v22, v21
    v_lshlrev_b32 v23, 5, v23
    v_lshl_add_u32 v23, v50, 10, v23
    v_lshl_add_u32 v23, v51, 3, v23
    v_add_u32 v23, s43, v23
    v_bfe_u32 v60, v65, 4, 6
    v_and_b32 v61, 15, v60
    v_lshrrev_b32 v62, 4, v60
    v_mov_b32 v64, 0x4444
    v_mov_b32 v77, 0xeeee
    v_cmp_lt_u32 vcc, 7, v61
    s_nop 1
    v_cndmask_b32 v64, v64, v77, vcc
    v_xor_b32 v66, 1024, v65
    v_xor_b32 v67, 2048, v65
    v_xor_b32 v68, 3072, v65
    v_and_b32 v69, 511, v65
    s_mul_i32 s96, s13, 36864
    s_add_u32 s96, s96, 16384
    v_lshlrev_b32 v70, 4, v60
    v_add_u32 v70, s96, v70
    v_lshrrev_b32 v79, 1, v69
    s_lshl_b32 s96, s13, 8
    s_add_u32 s96, s96, 14336
    s_lshl_b32 s33, s13, 10
    s_add_u32 s97, s33, 8192
    v_mov_b32 v77, s97
    v_mov_b32 v78, s96
    v_cmp_lt_u32 vcc, 31, v60
    s_nop 1
    v_cndmask_b32 v71, v77, v78, vcc
    v_add_u32 v71, v71, v79
    v_and_b32 v77, 7, v61
    v_lshrrev_b32 v78, 3, v61
    v_lshlrev_b32 v74, 4, v77
    v_lshl_add_u32 v73, v62, 7, v74
    v_lshl_add_u32 v73, v78, 3, v73
    s_lshl_b32 s96, s13, 9
    v_add_u32 v73, s96, v73
    v_lshl_add_u32 v74, v78, 14, v74
    v_lshl_add_u32 v74, v62, 15, v74
    s_lshl_b32 s96, s13, 17
    v_add_u32 v74, s96, v74
    v_bfe_u32 v77, v61, 2, 1
    v_and_b32 v78, 3, v61
    v_bfe_u32 v79, v61, 1, 2
    s_cmp_lt_u32 s13, 2
    s_cselect_b64 vcc, -1, 0
    v_cndmask_b32 v77, 0, v77, vcc
    v_cndmask_b32 v78, v79, v78, vcc
    v_lshlrev_b32 v75, 7, v77
    v_lshl_add_u32 v75, v62, 4, v75
    v_lshl_add_u32 v75, v78, 2, v75
    v_lshl_add_u32 v58, v77, 3, v78
    v_lshlrev_b32 v79, 1, v78
    v_cndmask_b32 v58, v79, v58, vcc
    s_bfe_u32 s97, s12, 0x10001
    s_lshl_b32 s68, s97, 6
    s_lshl_b32 s97, s97, 2
    v_add_u32 v59, s97, v62
    s_bfe_u32 s96, s12, 0x10002
    s_and_b32 s40, s12, 1
    s_lshl_b32 s96, s96, 1
    s_add_u32 s96, s96, s40
    s_lshr_b32 s97, s12, 3
    s_lshl_b32 s98, s13, 2
    s_add_u32 s98, s98, s97
    s_lshl_b32 s98, s98, 2
    s_add_u32 s98, s98, s96
    s_lshl_b32 s98, s98, 8
    s_lshl_b32 s99, s13, 2
    s_add_u32 s99, s99, s96
    s_lshl_b32 s99, s99, 4
    s_lshl_b32 s41, s97, 1
    s_add_u32 s41, s41, s40
    s_lshl_b32 s41, s41, 7
    s_add_u32 s41, s41, 8192
    s_lshl_b32 s40, s40, 3
    s_add_u32 s40, s40, 512
    s_cmp_lt_u32 s13, 2
    s_cselect_b32 s96, 7, 4
    s_cselect_b32 s98, s98, s41
    s_cselect_b32 s99, s99, s40
    s_cselect_b32 s32, 1, 0
    s_add_u32 s68, s68, s98
    s_lshl_b32 s97, s97, s96
    s_add_u32 s99, s99, s97
    v_add_u32 v58, s99, v58
    s_and_b32 s97, s12, 4
    s_or_b32 s97, s97, s13
    s_cmp_eq_u32 s97, 2
    s_cselect_b32 s32, 2, s32
    s_mov_b32 s8, s48
    s_mov_b32 s9, s49
    s_mov_b32 s10, 9216
    s_cmp_lt_u32 s13, 2
    s_cselect_b32 s96, 8, 2
    v_mul_u32_u24 v77, 1152, v59
    v_lshl_add_u32 v77, v58, 1, v77
    buffer_load_ushort v72, v77, s[8:11], 0 offen
    buffer_load_ushort v76, v77, s[8:11], s96 offen
    s_mov_b32 s10, 4718592
    s_waitcnt vmcnt(12) lgkmcnt(0)
    s_barrier
    s_mov_b64 s[8:9], s[56:57]
    s_add_u32 m0, s43, 147456
    s_add_u32 s41, s42, 0
    buffer_load_dwordx4 v19, s[8:11], s41 offen offset:0 nt lds
    s_add_u32 s41, s42, 35840
    buffer_load_dwordx4 v19, s[8:11], s41 offen offset:1024 nt lds
    s_add_u32 s41, s42, 71680
    buffer_load_dwordx4 v19, s[8:11], s41 offen offset:2048 nt lds
    s_add_u32 s41, s42, 107520
    buffer_load_dwordx4 v19, s[8:11], s41 offen offset:3072 nt lds
    v_mov_b32 v78, v21
    v_mov_b32 v79, v22
    v_add_u32 v77, 0, v79
    ds_read_b64_tr_b16 v[80:81], v77 offset:0
    ds_read_b64_tr_b16 v[82:83], v77 offset:256
    ds_read_b64_tr_b16 v[84:85], v77 offset:2048
    ds_read_b64_tr_b16 v[86:87], v77 offset:2304
    ds_read_b64_tr_b16 v[112:113], v77 offset:8
    ds_read_b64_tr_b16 v[114:115], v77 offset:264
    ds_read_b64_tr_b16 v[116:117], v77 offset:2056
    ds_read_b64_tr_b16 v[118:119], v77 offset:2312
    s_waitcnt vmcnt(12) lgkmcnt(0)
    s_barrier
    s_mov_b64 s[8:9], s[52:53]
    s_add_u32 m0, s43, 0
    s_add_u32 s41, s58, 0
    buffer_load_dwordx4 v16, s[8:11], s41 offen offset:0 nt lds
    s_add_u32 s41, s58, 15360
    buffer_load_dwordx4 v16, s[8:11], s41 offen offset:1024 nt lds
    s_add_u32 s41, s58, 129024
    buffer_load_dwordx4 v16, s[8:11], s41 offen offset:2048 nt lds
    s_add_u32 s41, s58, 144384
    buffer_load_dwordx4 v16, s[8:11], s41 offen offset:3072 nt lds
    v_add_u32 v77, 36864, v78
    ds_read_b64_tr_b16 v[88:89], v77 offset:0
    ds_read_b64_tr_b16 v[90:91], v77 offset:256
    ds_read_b64_tr_b16 v[92:93], v77 offset:2048
    ds_read_b64_tr_b16 v[94:95], v77 offset:2304
    ds_read_b64_tr_b16 v[120:121], v77 offset:8
    ds_read_b64_tr_b16 v[122:123], v77 offset:264
    ds_read_b64_tr_b16 v[124:125], v77 offset:2056
    ds_read_b64_tr_b16 v[126:127], v77 offset:2312
    s_waitcnt vmcnt(12) lgkmcnt(0)
    s_barrier
    s_add_u32 m0, s43, 36864
    s_add_u32 s41, s58, 8192
    buffer_load_dwordx4 v16, s[8:11], s41 offen offset:0 nt lds
    s_add_u32 s41, s58, 23552
    buffer_load_dwordx4 v16, s[8:11], s41 offen offset:1024 nt lds
    s_add_u32 s41, s58, 137216
    buffer_load_dwordx4 v16, s[8:11], s41 offen offset:2048 nt lds
    s_add_u32 s41, s58, 152576
    buffer_load_dwordx4 v16, s[8:11], s41 offen offset:3072 nt lds
    v_add_u32 v77, 73728, v78
    ds_read_b64_tr_b16 v[96:97], v77 offset:0
    ds_read_b64_tr_b16 v[98:99], v77 offset:256
    ds_read_b64_tr_b16 v[100:101], v77 offset:2048
    ds_read_b64_tr_b16 v[102:103], v77 offset:2304
    ds_read_b64_tr_b16 v[128:129], v77 offset:8
    ds_read_b64_tr_b16 v[130:131], v77 offset:264
    ds_read_b64_tr_b16 v[132:133], v77 offset:2056
    ds_read_b64_tr_b16 v[134:135], v77 offset:2312
    s_waitcnt vmcnt(12) lgkmcnt(0)
    s_barrier
    s_add_u32 m0, s43, 73728
    s_add_u32 s41, s58, 262144
    buffer_load_dwordx4 v16, s[8:11], s41 offen offset:0 nt lds
    s_add_u32 s41, s58, 277504
    buffer_load_dwordx4 v16, s[8:11], s41 offen offset:1024 nt lds
    s_add_u32 s41, s58, 391168
    buffer_load_dwordx4 v16, s[8:11], s41 offen offset:2048 nt lds
    s_add_u32 s41, s58, 406528
    buffer_load_dwordx4 v16, s[8:11], s41 offen offset:3072 nt lds
    v_add_u32 v77, 110592, v78
    ds_read_b64_tr_b16 v[104:105], v77 offset:0
    ds_read_b64_tr_b16 v[106:107], v77 offset:256
    ds_read_b64_tr_b16 v[108:109], v77 offset:2048
    ds_read_b64_tr_b16 v[110:111], v77 offset:2304
    ds_read_b64_tr_b16 v[136:137], v77 offset:8
    ds_read_b64_tr_b16 v[138:139], v77 offset:264
    ds_read_b64_tr_b16 v[140:141], v77 offset:2056
    ds_read_b64_tr_b16 v[142:143], v77 offset:2312
    s_waitcnt vmcnt(12) lgkmcnt(0)
    s_barrier
    s_add_u32 m0, s43, 110592
    s_add_u32 s41, s58, 270336
    buffer_load_dwordx4 v16, s[8:11], s41 offen offset:0 nt lds
    s_add_u32 s41, s58, 285696
    buffer_load_dwordx4 v16, s[8:11], s41 offen offset:1024 nt lds
    s_add_u32 s41, s58, 399360
    buffer_load_dwordx4 v16, s[8:11], s41 offen offset:2048 nt lds
    s_add_u32 s41, s58, 414720
    buffer_load_dwordx4 v16, s[8:11], s41 offen offset:3072 nt lds
    v_add_u32 v77, 147456, v23
    ds_read_b64_tr_b16 v[144:145], v77 offset:0
    ds_read_b64_tr_b16 v[146:147], v77 offset:64
    ds_read_b64_tr_b16 v[148:149], v77 offset:512
    ds_read_b64_tr_b16 v[150:151], v77 offset:576
    ds_read_b64_tr_b16 v[152:153], v77 offset:2048
    ds_read_b64_tr_b16 v[154:155], v77 offset:2112
    ds_read_b64_tr_b16 v[156:157], v77 offset:2560
    ds_read_b64_tr_b16 v[158:159], v77 offset:2624
    s_waitcnt vmcnt(12) lgkmcnt(0)
    s_barrier
    s_add_u32 m0, s43, 147456
    s_add_u32 s41, s58, 524288
    buffer_load_dwordx4 v16, s[8:11], s41 offen offset:0 nt lds
    s_add_u32 s41, s58, 539648
    buffer_load_dwordx4 v16, s[8:11], s41 offen offset:1024 nt lds
    s_add_u32 s41, s58, 653312
    buffer_load_dwordx4 v16, s[8:11], s41 offen offset:2048 nt lds
    s_add_u32 s41, s58, 668672
    buffer_load_dwordx4 v16, s[8:11], s41 offen offset:3072 nt lds
    s_cmp_eq_u32 s32, 0
    s_cbranch_scc1 cs_init_done
    v_mov_b32 v52, 1
    v_mov_b32 v53, 1
    v_mov_b32 v54, 1
    v_mov_b32 v55, 1
    v_mov_b32 v56, 0
    v_lshl_or_b32 v72, v76, 16, v72
    s_lshl_b32 s96, s12, 14
    s_add_u32 s96, s96, 68681728
    s_add_u32 s97, s96, 0
    buffer_store_dwordx4 v[52:55], v65, s[4:7], s97 offen sc1
    s_add_u32 s97, s96, 4096
    buffer_store_dwordx4 v[52:55], v65, s[4:7], s97 offen sc1
    s_add_u32 s97, s96, 8192
    buffer_store_dwordx4 v[52:55], v65, s[4:7], s97 offen sc1
    s_add_u32 s97, s96, 12288
    buffer_store_dwordx4 v[52:55], v65, s[4:7], s97 offen sc1
    s_add_u32 s96, s68, 67633152
    s_add_u32 s97, s96, 16384
    buffer_store_dword v56, v75, s[4:7], s96 offen offset:0 sc1
    buffer_store_dword v72, v75, s[4:7], s97 offen offset:0 sc1
    s_cmp_lg_u32 s32, 2
    s_cbranch_scc1 cs_init_done
    buffer_store_dword v56, v75, s[4:7], s96 offen offset:1024 sc1
    buffer_store_dword v72, v75, s[4:7], s97 offen offset:1024 sc1
    buffer_store_dword v56, v75, s[4:7], s96 offen offset:2048 sc1
    buffer_store_dword v72, v75, s[4:7], s97 offen offset:2048 sc1
    buffer_store_dword v56, v75, s[4:7], s96 offen offset:3072 sc1
    buffer_store_dword v72, v75, s[4:7], s97 offen offset:3072 sc1
cs_init_done:
    v_add_u32 v28, 0, v24
    v_add_u32 v29, 0, v25
    v_add_u32 v30, 0, v26
    v_add_u32 v31, 0, v27
    ds_read_b64_tr_b16 a[96:97], v28 offset:0
    ds_read_b64_tr_b16 a[104:105], v28 offset:8
    ds_read_b64_tr_b16 a[112:113], v29 offset:0
    ds_read_b64_tr_b16 a[120:121], v29 offset:8
    ds_read_b64_tr_b16 a[128:129], v30 offset:0
    ds_read_b64_tr_b16 a[136:137], v30 offset:8
    ds_read_b64_tr_b16 a[144:145], v31 offset:0
    ds_read_b64_tr_b16 v[32:33], v31 offset:8
    s_waitcnt vmcnt(12) lgkmcnt(0)
    s_barrier
    s_add_u32 m0, s43, 0
    s_add_u32 s41, s58, 532480
    buffer_load_dwordx4 v16, s[8:11], s41 offen offset:0 nt lds
    s_add_u32 s41, s58, 547840
    buffer_load_dwordx4 v16, s[8:11], s41 offen offset:1024 nt lds
    s_add_u32 s41, s58, 661504
    buffer_load_dwordx4 v16, s[8:11], s41 offen offset:2048 nt lds
    s_add_u32 s41, s58, 676864
    buffer_load_dwordx4 v16, s[8:11], s41 offen offset:3072 nt lds
    ds_write_b64 v70, v[32:33] offset:12288
    v_add_u32 v28, 36864, v24
    v_add_u32 v29, 36864, v25
    v_add_u32 v30, 36864, v26
    v_add_u32 v31, 36864, v27
    ds_read_b64_tr_b16 a[98:99], v28 offset:0
    ds_read_b64_tr_b16 a[106:107], v28 offset:8
    ds_read_b64_tr_b16 a[114:115], v29 offset:0
    ds_read_b64_tr_b16 a[122:123], v29 offset:8
    ds_read_b64_tr_b16 a[130:131], v30 offset:0
    ds_read_b64_tr_b16 a[138:139], v30 offset:8
    ds_read_b64_tr_b16 a[146:147], v31 offset:0
    ds_read_b64_tr_b16 v[0:1], v31 offset:8
    s_waitcnt vmcnt(12) lgkmcnt(0)
    s_barrier
    s_add_u32 m0, s43, 36864
    s_add_u32 s41, s58, 786432
    buffer_load_dwordx4 v16, s[8:11], s41 offen offset:0 nt lds
    s_add_u32 s41, s58, 801792
    buffer_load_dwordx4 v16, s[8:11], s41 offen offset:1024 nt lds
    s_add_u32 s41, s58, 915456
    buffer_load_dwordx4 v16, s[8:11], s41 offen offset:2048 nt lds
    s_add_u32 s41, s58, 930816
    buffer_load_dwordx4 v16, s[8:11], s41 offen offset:3072 nt lds
    ds_write_b64 v70, v[0:1] offset:12296
    v_add_u32 v28, 73728, v24
    v_add_u32 v29, 73728, v25
    v_add_u32 v30, 73728, v26
    v_add_u32 v31, 73728, v27
    ds_read_b64_tr_b16 a[100:101], v28 offset:0
    ds_read_b64_tr_b16 a[108:109], v28 offset:8
    ds_read_b64_tr_b16 a[116:117], v29 offset:0
    ds_read_b64_tr_b16 a[124:125], v29 offset:8
    ds_read_b64_tr_b16 a[132:133], v30 offset:0
    ds_read_b64_tr_b16 a[140:141], v30 offset:8
    ds_read_b64_tr_b16 a[148:149], v31 offset:0
    ds_read_b64_tr_b16 v[32:33], v31 offset:8
    s_waitcnt vmcnt(12) lgkmcnt(0)
    s_barrier
    s_add_u32 m0, s43, 73728
    s_add_u32 s41, s58, 794624
    buffer_load_dwordx4 v16, s[8:11], s41 offen offset:0 nt lds
    s_add_u32 s41, s58, 809984
    buffer_load_dwordx4 v16, s[8:11], s41 offen offset:1024 nt lds
    s_add_u32 s41, s58, 923648
    buffer_load_dwordx4 v16, s[8:11], s41 offen offset:2048 nt lds
    s_add_u32 s41, s58, 939008
    buffer_load_dwordx4 v16, s[8:11], s41 offen offset:3072 nt lds
    ds_write_b64 v70, v[32:33] offset:13312
    v_add_u32 v28, 110592, v24
    v_add_u32 v29, 110592, v25
    v_add_u32 v30, 110592, v26
    v_add_u32 v31, 110592, v27
    ds_read_b64_tr_b16 a[102:103], v28 offset:0
    ds_read_b64_tr_b16 a[110:111], v28 offset:8
    ds_read_b64_tr_b16 a[118:119], v29 offset:0
    ds_read_b64_tr_b16 a[126:127], v29 offset:8
    ds_read_b64_tr_b16 a[134:135], v30 offset:0
    ds_read_b64_tr_b16 a[142:143], v30 offset:8
    ds_read_b64_tr_b16 a[150:151], v31 offset:0
    ds_read_b64_tr_b16 v[0:1], v31 offset:8
    s_waitcnt vmcnt(12) lgkmcnt(0)
    s_barrier
    s_add_u32 m0, s43, 110592
    s_add_u32 s41, s59, 0
    buffer_load_dwordx4 v17, s[8:11], s41 offen offset:0 nt lds
    s_add_u32 s41, s59, 31744
    buffer_load_dwordx4 v17, s[8:11], s41 offen offset:1024 nt lds
    s_add_u32 s41, s59, 129024
    buffer_load_dwordx4 v17, s[8:11], s41 offen offset:2048 nt lds
    s_add_u32 s41, s59, 160768
    buffer_load_dwordx4 v17, s[8:11], s41 offen offset:3072 nt lds
    ds_write_b64 v70, v[0:1] offset:13320
    v_add_u32 v28, 147456, v24
    v_add_u32 v29, 147456, v25
    v_add_u32 v30, 147456, v26
    v_add_u32 v31, 147456, v27
    ds_read_b64_tr_b16 a[152:153], v28 offset:0
    ds_read_b64_tr_b16 a[160:161], v28 offset:8
    ds_read_b64_tr_b16 v[32:33], v29 offset:0
    ds_read_b64_tr_b16 a[168:169], v29 offset:8
    ds_read_b64_tr_b16 a[176:177], v30 offset:0
    ds_read_b64_tr_b16 a[184:185], v30 offset:8
    ds_read_b64_tr_b16 v[34:35], v31 offset:0
    ds_read_b64_tr_b16 a[192:193], v31 offset:8
    s_waitcnt vmcnt(12) lgkmcnt(0)
    s_barrier
    s_mov_b64 s[8:9], s[50:51]
    s_add_u32 m0, s43, 147456
    s_add_u32 s41, s58, 0
    buffer_load_dwordx4 v16, s[8:11], s41 offen offset:0 nt lds
    s_add_u32 s41, s58, 15360
    buffer_load_dwordx4 v16, s[8:11], s41 offen offset:1024 nt lds
    s_add_u32 s41, s58, 129024
    buffer_load_dwordx4 v16, s[8:11], s41 offen offset:2048 nt lds
    s_add_u32 s41, s58, 144384
    buffer_load_dwordx4 v16, s[8:11], s41 offen offset:3072 nt lds
    ds_write_b64 v70, v[32:33] offset:16384
    ds_write_b64 v70, v[34:35] offset:18432
    v_add_u32 v28, 0, v24
    v_add_u32 v29, 0, v25
    v_add_u32 v30, 0, v26
    v_add_u32 v31, 0, v27
    ds_read_b64_tr_b16 a[154:155], v28 offset:0
    ds_read_b64_tr_b16 a[162:163], v28 offset:8
    ds_read_b64_tr_b16 v[0:1], v29 offset:0
    ds_read_b64_tr_b16 a[170:171], v29 offset:8
    ds_read_b64_tr_b16 a[178:179], v30 offset:0
    ds_read_b64_tr_b16 a[186:187], v30 offset:8
    ds_read_b64_tr_b16 v[2:3], v31 offset:0
    ds_read_b64_tr_b16 a[194:195], v31 offset:8
    s_waitcnt vmcnt(12) lgkmcnt(0)
    s_barrier
    s_add_u32 m0, s43, 0
    s_add_u32 s41, s58, 8192
    buffer_load_dwordx4 v16, s[8:11], s41 offen offset:0 nt lds
    s_add_u32 s41, s58, 23552
    buffer_load_dwordx4 v16, s[8:11], s41 offen offset:1024 nt lds
    s_add_u32 s41, s58, 137216
    buffer_load_dwordx4 v16, s[8:11], s41 offen offset:2048 nt lds
    s_add_u32 s41, s58, 152576
    buffer_load_dwordx4 v16, s[8:11], s41 offen offset:3072 nt lds
    ds_write_b64 v70, v[0:1] offset:16392
    ds_write_b64 v70, v[2:3] offset:18440
    v_add_u32 v28, 36864, v24
    v_add_u32 v29, 36864, v25
    v_add_u32 v30, 36864, v26
    v_add_u32 v31, 36864, v27
    ds_read_b64_tr_b16 a[156:157], v28 offset:0
    ds_read_b64_tr_b16 a[164:165], v28 offset:8
    ds_read_b64_tr_b16 v[32:33], v29 offset:0
    ds_read_b64_tr_b16 a[172:173], v29 offset:8
    ds_read_b64_tr_b16 a[180:181], v30 offset:0
    ds_read_b64_tr_b16 a[188:189], v30 offset:8
    ds_read_b64_tr_b16 v[34:35], v31 offset:0
    ds_read_b64_tr_b16 a[196:197], v31 offset:8
    s_waitcnt vmcnt(12) lgkmcnt(0)
    s_barrier
    s_add_u32 m0, s43, 36864
    s_add_u32 s41, s58, 262144
    buffer_load_dwordx4 v16, s[8:11], s41 offen offset:0 nt lds
    s_add_u32 s41, s58, 277504
    buffer_load_dwordx4 v16, s[8:11], s41 offen offset:1024 nt lds
    s_add_u32 s41, s58, 391168
    buffer_load_dwordx4 v16, s[8:11], s41 offen offset:2048 nt lds
    s_add_u32 s41, s58, 406528
    buffer_load_dwordx4 v16, s[8:11], s41 offen offset:3072 nt lds
    ds_write_b64 v70, v[32:33] offset:17408
    ds_write_b64 v70, v[34:35] offset:19456
    v_add_u32 v28, 73728, v24
    v_add_u32 v29, 73728, v25
    v_add_u32 v30, 73728, v26
    v_add_u32 v31, 73728, v27
    ds_read_b64_tr_b16 a[158:159], v28 offset:0
    ds_read_b64_tr_b16 a[166:167], v28 offset:8
    ds_read_b64_tr_b16 v[0:1], v29 offset:0
    ds_read_b64_tr_b16 a[174:175], v29 offset:8
    ds_read_b64_tr_b16 a[182:183], v30 offset:0
    ds_read_b64_tr_b16 a[190:191], v30 offset:8
    ds_read_b64_tr_b16 v[2:3], v31 offset:0
    ds_read_b64_tr_b16 a[198:199], v31 offset:8
    s_waitcnt vmcnt(12) lgkmcnt(0)
    s_barrier
    s_add_u32 m0, s43, 73728
    s_add_u32 s41, s58, 270336
    buffer_load_dwordx4 v16, s[8:11], s41 offen offset:0 nt lds
    s_add_u32 s41, s58, 285696
    buffer_load_dwordx4 v16, s[8:11], s41 offen offset:1024 nt lds
    s_add_u32 s41, s58, 399360
    buffer_load_dwordx4 v16, s[8:11], s41 offen offset:2048 nt lds
    s_add_u32 s41, s58, 414720
    buffer_load_dwordx4 v16, s[8:11], s41 offen offset:3072 nt lds
    ds_write_b64 v70, v[0:1] offset:17416
    ds_write_b64 v70, v[2:3] offset:19464
    v_add_u32 v77, 110592, v20
    ds_read_b64_tr_b16 a[200:201], v77 offset:0
    ds_read_b64_tr_b16 a[202:203], v77 offset:4096
    ds_read_b64_tr_b16 a[204:205], v77 offset:8192
    ds_read_b64_tr_b16 a[206:207], v77 offset:12288
    ds_read_b64_tr_b16 a[208:209], v77 offset:8
    ds_read_b64_tr_b16 a[210:211], v77 offset:4104
    ds_read_b64_tr_b16 a[212:213], v77 offset:8200
    ds_read_b64_tr_b16 a[214:215], v77 offset:12296
    s_waitcnt vmcnt(12) lgkmcnt(0)
    s_barrier
    s_add_u32 m0, s43, 110592
    s_add_u32 s41, s58, 524288
    buffer_load_dwordx4 v16, s[8:11], s41 offen offset:0 nt lds
    s_add_u32 s41, s58, 539648
    buffer_load_dwordx4 v16, s[8:11], s41 offen offset:1024 nt lds
    s_add_u32 s41, s58, 653312
    buffer_load_dwordx4 v16, s[8:11], s41 offen offset:2048 nt lds
    s_add_u32 s41, s58, 668672
    buffer_load_dwordx4 v16, s[8:11], s41 offen offset:3072 nt lds
    v_add_u32 v28, 147456, v24
    v_add_u32 v29, 147456, v25
    v_add_u32 v30, 147456, v26
    v_add_u32 v31, 147456, v27
    ds_read_b64_tr_b16 v[0:1], v28 offset:0
    ds_read_b64_tr_b16 v[2:3], v28 offset:8
    ds_read_b64_tr_b16 v[4:5], v29 offset:0
    ds_read_b64_tr_b16 v[6:7], v29 offset:8
    ds_read_b64_tr_b16 a[0:1], v30 offset:0
    ds_read_b64_tr_b16 v[8:9], v30 offset:8
    ds_read_b64_tr_b16 a[8:9], v31 offset:0
    ds_read_b64_tr_b16 v[10:11], v31 offset:8
    s_waitcnt vmcnt(12) lgkmcnt(0)
    s_barrier
    s_add_u32 m0, s43, 147456
    s_add_u32 s41, s58, 532480
    buffer_load_dwordx4 v16, s[8:11], s41 offen offset:0 nt lds
    s_add_u32 s41, s58, 547840
    buffer_load_dwordx4 v16, s[8:11], s41 offen offset:1024 nt lds
    s_add_u32 s41, s58, 661504
    buffer_load_dwordx4 v16, s[8:11], s41 offen offset:2048 nt lds
    s_add_u32 s41, s58, 676864
    buffer_load_dwordx4 v16, s[8:11], s41 offen offset:3072 nt lds
    ds_write_b64 v70, v[0:1] offset:0
    ds_write_b64 v70, v[2:3] offset:2048
    ds_write_b64 v70, v[4:5] offset:4096
    ds_write_b64 v70, v[6:7] offset:6144
    ds_write_b64 v70, v[8:9] offset:10240
    ds_write_b64 v70, v[10:11] offset:14336
    v_add_u32 v28, 0, v24
    v_add_u32 v29, 0, v25
    v_add_u32 v30, 0, v26
    v_add_u32 v31, 0, v27
    ds_read_b64_tr_b16 v[32:33], v28 offset:0
    ds_read_b64_tr_b16 v[34:35], v28 offset:8
    ds_read_b64_tr_b16 v[36:37], v29 offset:0
    ds_read_b64_tr_b16 v[38:39], v29 offset:8
    ds_read_b64_tr_b16 a[2:3], v30 offset:0
    ds_read_b64_tr_b16 v[40:41], v30 offset:8
    ds_read_b64_tr_b16 a[10:11], v31 offset:0
    ds_read_b64_tr_b16 v[42:43], v31 offset:8
    s_waitcnt vmcnt(12) lgkmcnt(0)
    s_barrier
    s_add_u32 m0, s43, 0
    s_add_u32 s41, s58, 786432
    buffer_load_dwordx4 v16, s[8:11], s41 offen offset:0 nt lds
    s_add_u32 s41, s58, 801792
    buffer_load_dwordx4 v16, s[8:11], s41 offen offset:1024 nt lds
    s_add_u32 s41, s58, 915456
    buffer_load_dwordx4 v16, s[8:11], s41 offen offset:2048 nt lds
    s_add_u32 s41, s58, 930816
    buffer_load_dwordx4 v16, s[8:11], s41 offen offset:3072 nt lds
    ds_write_b64 v70, v[32:33] offset:8
    ds_write_b64 v70, v[34:35] offset:2056
    ds_write_b64 v70, v[36:37] offset:4104
    ds_write_b64 v70, v[38:39] offset:6152
    ds_write_b64 v70, v[40:41] offset:10248
    ds_write_b64 v70, v[42:43] offset:14344
    v_add_u32 v28, 36864, v24
    v_add_u32 v29, 36864, v25
    v_add_u32 v30, 36864, v26
    v_add_u32 v31, 36864, v27
    ds_read_b64_tr_b16 v[0:1], v28 offset:0
    ds_read_b64_tr_b16 v[2:3], v28 offset:8
    ds_read_b64_tr_b16 v[4:5], v29 offset:0
    ds_read_b64_tr_b16 v[6:7], v29 offset:8
    ds_read_b64_tr_b16 a[4:5], v30 offset:0
    ds_read_b64_tr_b16 v[8:9], v30 offset:8
    ds_read_b64_tr_b16 a[12:13], v31 offset:0
    ds_read_b64_tr_b16 v[10:11], v31 offset:8
    s_waitcnt vmcnt(12) lgkmcnt(0)
    s_barrier
    s_add_u32 m0, s43, 36864
    s_add_u32 s41, s58, 794624
    buffer_load_dwordx4 v16, s[8:11], s41 offen offset:0 nt lds
    s_add_u32 s41, s58, 809984
    buffer_load_dwordx4 v16, s[8:11], s41 offen offset:1024 nt lds
    s_add_u32 s41, s58, 923648
    buffer_load_dwordx4 v16, s[8:11], s41 offen offset:2048 nt lds
    s_add_u32 s41, s58, 939008
    buffer_load_dwordx4 v16, s[8:11], s41 offen offset:3072 nt lds
    ds_write_b64 v70, v[0:1] offset:1024
    ds_write_b64 v70, v[2:3] offset:3072
    ds_write_b64 v70, v[4:5] offset:5120
    ds_write_b64 v70, v[6:7] offset:7168
    ds_write_b64 v70, v[8:9] offset:11264
    ds_write_b64 v70, v[10:11] offset:15360
    v_add_u32 v28, 73728, v24
    v_add_u32 v29, 73728, v25
    v_add_u32 v30, 73728, v26
    v_add_u32 v31, 73728, v27
    ds_read_b64_tr_b16 v[32:33], v28 offset:0
    ds_read_b64_tr_b16 v[34:35], v28 offset:8
    ds_read_b64_tr_b16 v[36:37], v29 offset:0
    ds_read_b64_tr_b16 v[38:39], v29 offset:8
    ds_read_b64_tr_b16 a[6:7], v30 offset:0
    ds_read_b64_tr_b16 v[40:41], v30 offset:8
    ds_read_b64_tr_b16 a[14:15], v31 offset:0
    ds_read_b64_tr_b16 v[42:43], v31 offset:8
    s_waitcnt vmcnt(12) lgkmcnt(0)
    s_barrier
    s_add_u32 m0, s43, 73728
    s_add_u32 s41, s59, 0
    buffer_load_dwordx4 v17, s[8:11], s41 offen offset:0 nt lds
    s_add_u32 s41, s59, 31744
    buffer_load_dwordx4 v17, s[8:11], s41 offen offset:1024 nt lds
    s_add_u32 s41, s59, 129024
    buffer_load_dwordx4 v17, s[8:11], s41 offen offset:2048 nt lds
    s_add_u32 s41, s59, 160768
    buffer_load_dwordx4 v17, s[8:11], s41 offen offset:3072 nt lds
    ds_write_b64 v70, v[32:33] offset:1032
    ds_write_b64 v70, v[34:35] offset:3080
    ds_write_b64 v70, v[36:37] offset:5128
    ds_write_b64 v70, v[38:39] offset:7176
    ds_write_b64 v70, v[40:41] offset:11272
    ds_write_b64 v70, v[42:43] offset:15368
    v_add_u32 v28, 110592, v24
    v_add_u32 v29, 110592, v25
    v_add_u32 v30, 110592, v26
    v_add_u32 v31, 110592, v27
    ds_read_b64_tr_b16 a[16:17], v28 offset:0
    ds_read_b64_tr_b16 a[24:25], v28 offset:8
    ds_read_b64_tr_b16 a[32:33], v29 offset:0
    ds_read_b64_tr_b16 a[40:41], v29 offset:8
    ds_read_b64_tr_b16 a[48:49], v30 offset:0
    ds_read_b64_tr_b16 a[56:57], v30 offset:8
    ds_read_b64_tr_b16 a[64:65], v31 offset:0
    ds_read_b64_tr_b16 a[72:73], v31 offset:8
    s_waitcnt vmcnt(12) lgkmcnt(0)
    s_barrier
    s_mov_b64 s[8:9], s[54:55]
    s_add_u32 m0, s43, 110592
    s_add_u32 s41, s58, 0
    buffer_load_dwordx4 v16, s[8:11], s41 offen offset:0 nt lds
    s_add_u32 s41, s58, 15360
    buffer_load_dwordx4 v16, s[8:11], s41 offen offset:1024 nt lds
    s_add_u32 s41, s58, 129024
    buffer_load_dwordx4 v16, s[8:11], s41 offen offset:2048 nt lds
    s_add_u32 s41, s58, 144384
    buffer_load_dwordx4 v16, s[8:11], s41 offen offset:3072 nt lds
    v_add_u32 v28, 147456, v24
    v_add_u32 v29, 147456, v25
    v_add_u32 v30, 147456, v26
    v_add_u32 v31, 147456, v27
    ds_read_b64_tr_b16 a[18:19], v28 offset:0
    ds_read_b64_tr_b16 a[26:27], v28 offset:8
    ds_read_b64_tr_b16 a[34:35], v29 offset:0
    ds_read_b64_tr_b16 a[42:43], v29 offset:8
    ds_read_b64_tr_b16 a[50:51], v30 offset:0
    ds_read_b64_tr_b16 a[58:59], v30 offset:8
    ds_read_b64_tr_b16 a[66:67], v31 offset:0
    ds_read_b64_tr_b16 a[74:75], v31 offset:8
    s_waitcnt vmcnt(12) lgkmcnt(0)
    s_barrier
    s_add_u32 m0, s43, 147456
    s_add_u32 s41, s58, 8192
    buffer_load_dwordx4 v16, s[8:11], s41 offen offset:0 nt lds
    s_add_u32 s41, s58, 23552
    buffer_load_dwordx4 v16, s[8:11], s41 offen offset:1024 nt lds
    s_add_u32 s41, s58, 137216
    buffer_load_dwordx4 v16, s[8:11], s41 offen offset:2048 nt lds
    s_add_u32 s41, s58, 152576
    buffer_load_dwordx4 v16, s[8:11], s41 offen offset:3072 nt lds
    v_add_u32 v28, 0, v24
    v_add_u32 v29, 0, v25
    v_add_u32 v30, 0, v26
    v_add_u32 v31, 0, v27
    ds_read_b64_tr_b16 a[20:21], v28 offset:0
    ds_read_b64_tr_b16 a[28:29], v28 offset:8
    ds_read_b64_tr_b16 a[36:37], v29 offset:0
    ds_read_b64_tr_b16 a[44:45], v29 offset:8
    ds_read_b64_tr_b16 a[52:53], v30 offset:0
    ds_read_b64_tr_b16 a[60:61], v30 offset:8
    ds_read_b64_tr_b16 a[68:69], v31 offset:0
    ds_read_b64_tr_b16 a[76:77], v31 offset:8
    s_waitcnt vmcnt(12) lgkmcnt(0)
    s_barrier
    s_add_u32 m0, s43, 0
    s_add_u32 s41, s58, 262144
    buffer_load_dwordx4 v16, s[8:11], s41 offen offset:0 nt lds
    s_add_u32 s41, s58, 277504
    buffer_load_dwordx4 v16, s[8:11], s41 offen offset:1024 nt lds
    s_add_u32 s41, s58, 391168
    buffer_load_dwordx4 v16, s[8:11], s41 offen offset:2048 nt lds
    s_add_u32 s41, s58, 406528
    buffer_load_dwordx4 v16, s[8:11], s41 offen offset:3072 nt lds
    v_add_u32 v28, 36864, v24
    v_add_u32 v29, 36864, v25
    v_add_u32 v30, 36864, v26
    v_add_u32 v31, 36864, v27
    ds_read_b64_tr_b16 a[22:23], v28 offset:0
    ds_read_b64_tr_b16 a[30:31], v28 offset:8
    ds_read_b64_tr_b16 a[38:39], v29 offset:0
    ds_read_b64_tr_b16 a[46:47], v29 offset:8
    ds_read_b64_tr_b16 a[54:55], v30 offset:0
    ds_read_b64_tr_b16 a[62:63], v30 offset:8
    ds_read_b64_tr_b16 a[70:71], v31 offset:0
    ds_read_b64_tr_b16 a[78:79], v31 offset:8
    s_waitcnt vmcnt(12) lgkmcnt(0)
    s_barrier
    s_add_u32 m0, s43, 36864
    s_add_u32 s41, s58, 270336
    buffer_load_dwordx4 v16, s[8:11], s41 offen offset:0 nt lds
    s_add_u32 s41, s58, 285696
    buffer_load_dwordx4 v16, s[8:11], s41 offen offset:1024 nt lds
    s_add_u32 s41, s58, 399360
    buffer_load_dwordx4 v16, s[8:11], s41 offen offset:2048 nt lds
    s_add_u32 s41, s58, 414720
    buffer_load_dwordx4 v16, s[8:11], s41 offen offset:3072 nt lds
    v_add_u32 v77, 73728, v20
    ds_read_b64_tr_b16 a[80:81], v77 offset:0
    ds_read_b64_tr_b16 a[82:83], v77 offset:4096
    ds_read_b64_tr_b16 a[84:85], v77 offset:8192
    ds_read_b64_tr_b16 a[86:87], v77 offset:12288
    ds_read_b64_tr_b16 a[88:89], v77 offset:8
    ds_read_b64_tr_b16 a[90:91], v77 offset:4104
    ds_read_b64_tr_b16 a[92:93], v77 offset:8200
    ds_read_b64_tr_b16 a[94:95], v77 offset:12296
    s_waitcnt vmcnt(12) lgkmcnt(0)
    s_barrier
    s_add_u32 m0, s43, 73728
    s_add_u32 s41, s58, 524288
    buffer_load_dwordx4 v16, s[8:11], s41 offen offset:0 nt lds
    s_add_u32 s41, s58, 539648
    buffer_load_dwordx4 v16, s[8:11], s41 offen offset:1024 nt lds
    s_add_u32 s41, s58, 653312
    buffer_load_dwordx4 v16, s[8:11], s41 offen offset:2048 nt lds
    s_add_u32 s41, s58, 668672
    buffer_load_dwordx4 v16, s[8:11], s41 offen offset:3072 nt lds
    v_add_u32 v28, 110592, v24
    v_add_u32 v29, 110592, v25
    v_add_u32 v30, 110592, v26
    v_add_u32 v31, 110592, v27
    ds_read_b64_tr_b16 a[216:217], v28 offset:0
    ds_read_b64_tr_b16 v[32:33], v28 offset:8
    ds_read_b64_tr_b16 a[224:225], v29 offset:0
    ds_read_b64_tr_b16 a[232:233], v29 offset:8
    ds_read_b64_tr_b16 a[240:241], v30 offset:0
    ds_read_b64_tr_b16 a[248:249], v30 offset:8
    ds_read_b64_tr_b16 v[160:161], v31 offset:0
    ds_read_b64_tr_b16 v[168:169], v31 offset:8
    s_waitcnt vmcnt(12) lgkmcnt(0)
    s_barrier
    s_add_u32 m0, s43, 110592
    s_add_u32 s41, s58, 532480
    buffer_load_dwordx4 v16, s[8:11], s41 offen offset:0 nt lds
    s_add_u32 s41, s58, 547840
    buffer_load_dwordx4 v16, s[8:11], s41 offen offset:1024 nt lds
    s_add_u32 s41, s58, 661504
    buffer_load_dwordx4 v16, s[8:11], s41 offen offset:2048 nt lds
    s_add_u32 s41, s58, 676864
    buffer_load_dwordx4 v16, s[8:11], s41 offen offset:3072 nt lds
    ds_write_b64 v70, v[32:33] offset:8192
    v_add_u32 v28, 147456, v24
    v_add_u32 v29, 147456, v25
    v_add_u32 v30, 147456, v26
    v_add_u32 v31, 147456, v27
    ds_read_b64_tr_b16 a[218:219], v28 offset:0
    ds_read_b64_tr_b16 v[0:1], v28 offset:8
    ds_read_b64_tr_b16 a[226:227], v29 offset:0
    ds_read_b64_tr_b16 a[234:235], v29 offset:8
    ds_read_b64_tr_b16 a[242:243], v30 offset:0
    ds_read_b64_tr_b16 a[250:251], v30 offset:8
    ds_read_b64_tr_b16 v[162:163], v31 offset:0
    ds_read_b64_tr_b16 v[170:171], v31 offset:8
    s_waitcnt vmcnt(12) lgkmcnt(0)
    s_barrier
    s_add_u32 m0, s43, 147456
    s_add_u32 s41, s58, 786432
    buffer_load_dwordx4 v16, s[8:11], s41 offen offset:0 nt lds
    s_add_u32 s41, s58, 801792
    buffer_load_dwordx4 v16, s[8:11], s41 offen offset:1024 nt lds
    s_add_u32 s41, s58, 915456
    buffer_load_dwordx4 v16, s[8:11], s41 offen offset:2048 nt lds
    s_add_u32 s41, s58, 930816
    buffer_load_dwordx4 v16, s[8:11], s41 offen offset:3072 nt lds
    ds_write_b64 v70, v[0:1] offset:8200
    v_add_u32 v28, 0, v24
    v_add_u32 v29, 0, v25
    v_add_u32 v30, 0, v26
    v_add_u32 v31, 0, v27
    ds_read_b64_tr_b16 a[220:221], v28 offset:0
    ds_read_b64_tr_b16 v[32:33], v28 offset:8
    ds_read_b64_tr_b16 a[228:229], v29 offset:0
    ds_read_b64_tr_b16 a[236:237], v29 offset:8
    ds_read_b64_tr_b16 a[244:245], v30 offset:0
    ds_read_b64_tr_b16 a[252:253], v30 offset:8
    ds_read_b64_tr_b16 v[164:165], v31 offset:0
    ds_read_b64_tr_b16 v[172:173], v31 offset:8
    s_waitcnt vmcnt(12) lgkmcnt(0)
    s_barrier
    s_add_u32 m0, s43, 0
    s_add_u32 s41, s58, 794624
    buffer_load_dwordx4 v16, s[8:11], s41 offen offset:0 nt lds
    s_add_u32 s41, s58, 809984
    buffer_load_dwordx4 v16, s[8:11], s41 offen offset:1024 nt lds
    s_add_u32 s41, s58, 923648
    buffer_load_dwordx4 v16, s[8:11], s41 offen offset:2048 nt lds
    s_add_u32 s41, s58, 939008
    buffer_load_dwordx4 v16, s[8:11], s41 offen offset:3072 nt lds
    ds_write_b64 v70, v[32:33] offset:9216
    v_add_u32 v28, 36864, v24
    v_add_u32 v29, 36864, v25
    v_add_u32 v30, 36864, v26
    v_add_u32 v31, 36864, v27
    ds_read_b64_tr_b16 a[222:223], v28 offset:0
    ds_read_b64_tr_b16 v[0:1], v28 offset:8
    ds_read_b64_tr_b16 a[230:231], v29 offset:0
    ds_read_b64_tr_b16 a[238:239], v29 offset:8
    ds_read_b64_tr_b16 a[246:247], v30 offset:0
    ds_read_b64_tr_b16 a[254:255], v30 offset:8
    ds_read_b64_tr_b16 v[166:167], v31 offset:0
    ds_read_b64_tr_b16 v[174:175], v31 offset:8
    s_waitcnt vmcnt(12) lgkmcnt(0)
    s_barrier
    s_add_u32 m0, s43, 36864
    s_add_u32 s41, s59, 0
    buffer_load_dwordx4 v17, s[8:11], s41 offen offset:0 nt lds
    s_add_u32 s41, s59, 31744
    buffer_load_dwordx4 v17, s[8:11], s41 offen offset:1024 nt lds
    s_add_u32 s41, s59, 129024
    buffer_load_dwordx4 v17, s[8:11], s41 offen offset:2048 nt lds
    s_add_u32 s41, s59, 160768
    buffer_load_dwordx4 v17, s[8:11], s41 offen offset:3072 nt lds
    ds_write_b64 v70, v[0:1] offset:9224
    v_add_u32 v28, 73728, v24
    v_add_u32 v29, 73728, v25
    v_add_u32 v30, 73728, v26
    v_add_u32 v31, 73728, v27
    ds_read_b64_tr_b16 v[176:177], v28 offset:0
    ds_read_b64_tr_b16 v[184:185], v28 offset:8
    ds_read_b64_tr_b16 v[192:193], v29 offset:0
    ds_read_b64_tr_b16 v[200:201], v29 offset:8
    ds_read_b64_tr_b16 v[208:209], v30 offset:0
    ds_read_b64_tr_b16 v[216:217], v30 offset:8
    ds_read_b64_tr_b16 v[224:225], v31 offset:0
    ds_read_b64_tr_b16 v[232:233], v31 offset:8
    s_waitcnt vmcnt(12) lgkmcnt(0)
    s_barrier
    s_mov_b64 s[8:9], s[56:57]
    s_add_u32 m0, s43, 73728
    s_add_u32 s41, s60, 128
    buffer_load_dwordx4 v18, s[8:11], s41 offen offset:0 nt lds
    s_add_u32 s41, s60, 8320
    buffer_load_dwordx4 v18, s[8:11], s41 offen offset:1024 nt lds
    s_add_u32 s41, s60, 16512
    buffer_load_dwordx4 v18, s[8:11], s41 offen offset:2048 nt lds
    s_add_u32 s41, s60, 24704
    buffer_load_dwordx4 v18, s[8:11], s41 offen offset:3072 nt lds
    v_add_u32 v28, 110592, v24
    v_add_u32 v29, 110592, v25
    v_add_u32 v30, 110592, v26
    v_add_u32 v31, 110592, v27
    ds_read_b64_tr_b16 v[178:179], v28 offset:0
    ds_read_b64_tr_b16 v[186:187], v28 offset:8
    ds_read_b64_tr_b16 v[194:195], v29 offset:0
    ds_read_b64_tr_b16 v[202:203], v29 offset:8
    ds_read_b64_tr_b16 v[210:211], v30 offset:0
    ds_read_b64_tr_b16 v[218:219], v30 offset:8
    ds_read_b64_tr_b16 v[226:227], v31 offset:0
    ds_read_b64_tr_b16 v[234:235], v31 offset:8
    s_waitcnt vmcnt(12) lgkmcnt(0)
    s_barrier
    s_add_u32 m0, s43, 110592
    s_add_u32 s41, s61, 128
    buffer_load_dwordx4 v18, s[8:11], s41 offen offset:0 nt lds
    s_add_u32 s41, s61, 8320
    buffer_load_dwordx4 v18, s[8:11], s41 offen offset:1024 nt lds
    s_add_u32 s41, s61, 16512
    buffer_load_dwordx4 v18, s[8:11], s41 offen offset:2048 nt lds
    s_add_u32 s41, s61, 24704
    buffer_load_dwordx4 v18, s[8:11], s41 offen offset:3072 nt lds
    v_add_u32 v28, 147456, v24
    v_add_u32 v29, 147456, v25
    v_add_u32 v30, 147456, v26
    v_add_u32 v31, 147456, v27
    ds_read_b64_tr_b16 v[180:181], v28 offset:0
    ds_read_b64_tr_b16 v[188:189], v28 offset:8
    ds_read_b64_tr_b16 v[196:197], v29 offset:0
    ds_read_b64_tr_b16 v[204:205], v29 offset:8
    ds_read_b64_tr_b16 v[212:213], v30 offset:0
    ds_read_b64_tr_b16 v[220:221], v30 offset:8
    ds_read_b64_tr_b16 v[228:229], v31 offset:0
    ds_read_b64_tr_b16 v[236:237], v31 offset:8
    s_waitcnt vmcnt(12) lgkmcnt(0)
    s_barrier
    s_add_u32 m0, s43, 147456
    s_add_u32 s41, s62, 128
    buffer_load_dwordx4 v18, s[8:11], s41 offen offset:0 nt lds
    s_add_u32 s41, s62, 8320
    buffer_load_dwordx4 v18, s[8:11], s41 offen offset:1024 nt lds
    s_add_u32 s41, s62, 16512
    buffer_load_dwordx4 v18, s[8:11], s41 offen offset:2048 nt lds
    s_add_u32 s41, s62, 24704
    buffer_load_dwordx4 v18, s[8:11], s41 offen offset:3072 nt lds
    v_add_u32 v28, 0, v24
    v_add_u32 v29, 0, v25
    v_add_u32 v30, 0, v26
    v_add_u32 v31, 0, v27
    ds_read_b64_tr_b16 v[182:183], v28 offset:0
    ds_read_b64_tr_b16 v[190:191], v28 offset:8
    ds_read_b64_tr_b16 v[198:199], v29 offset:0
    ds_read_b64_tr_b16 v[206:207], v29 offset:8
    ds_read_b64_tr_b16 v[214:215], v30 offset:0
    ds_read_b64_tr_b16 v[222:223], v30 offset:8
    ds_read_b64_tr_b16 v[230:231], v31 offset:0
    ds_read_b64_tr_b16 v[238:239], v31 offset:8
    s_waitcnt vmcnt(12) lgkmcnt(0)
    s_barrier
    s_add_u32 m0, s43, 0
    s_add_u32 s41, s63, 128
    buffer_load_dwordx4 v18, s[8:11], s41 offen offset:0 nt lds
    s_add_u32 s41, s63, 8320
    buffer_load_dwordx4 v18, s[8:11], s41 offen offset:1024 nt lds
    s_add_u32 s41, s63, 16512
    buffer_load_dwordx4 v18, s[8:11], s41 offen offset:2048 nt lds
    s_add_u32 s41, s63, 24704
    buffer_load_dwordx4 v18, s[8:11], s41 offen offset:3072 nt lds
    v_mov_b32 v78, v21
    v_mov_b32 v79, v22
    v_add_u32 v77, 36864, v20
    ds_read_b64_tr_b16 v[240:241], v77 offset:0
    ds_read_b64_tr_b16 v[242:243], v77 offset:4096
    ds_read_b64_tr_b16 v[244:245], v77 offset:8192
    ds_read_b64_tr_b16 v[246:247], v77 offset:12288
    ds_read_b64_tr_b16 v[248:249], v77 offset:8
    ds_read_b64_tr_b16 v[250:251], v77 offset:4104
    ds_read_b64_tr_b16 v[252:253], v77 offset:8200
    ds_read_b64_tr_b16 v[254:255], v77 offset:12296
    s_waitcnt vmcnt(12) lgkmcnt(0)
    s_barrier
    v_add_u32 v77, 73728, v79
    s_waitcnt lgkmcnt(0)
    ds_read_b64_tr_b16 v[0:1], v77 offset:0
    ds_read_b64_tr_b16 v[2:3], v77 offset:256
    ds_read_b64_tr_b16 v[4:5], v77 offset:2048
    ds_read_b64_tr_b16 v[6:7], v77 offset:2304
    ds_read_b64_tr_b16 v[8:9], v77 offset:8
    ds_read_b64_tr_b16 v[10:11], v77 offset:264
    ds_read_b64_tr_b16 v[12:13], v77 offset:2056
    ds_read_b64_tr_b16 v[14:15], v77 offset:2312
    s_waitcnt vmcnt(8) lgkmcnt(0)
    s_barrier
    v_add_u32 v77, 110592, v78
    ds_read_b64_tr_b16 v[16:17], v77 offset:0
    ds_read_b64_tr_b16 v[18:19], v77 offset:256
    ds_read_b64_tr_b16 v[20:21], v77 offset:2048
    ds_read_b64_tr_b16 v[22:23], v77 offset:2304
    ds_read_b64_tr_b16 v[24:25], v77 offset:8
    ds_read_b64_tr_b16 v[26:27], v77 offset:264
    ds_read_b64_tr_b16 v[28:29], v77 offset:2056
    ds_read_b64_tr_b16 v[30:31], v77 offset:2312
    s_waitcnt vmcnt(4) lgkmcnt(0)
    s_barrier
    v_add_u32 v77, 147456, v78
    ds_read_b64_tr_b16 v[32:33], v77 offset:0
    ds_read_b64_tr_b16 v[34:35], v77 offset:256
    ds_read_b64_tr_b16 v[36:37], v77 offset:2048
    ds_read_b64_tr_b16 v[38:39], v77 offset:2304
    ds_read_b64_tr_b16 v[40:41], v77 offset:8
    ds_read_b64_tr_b16 v[42:43], v77 offset:264
    ds_read_b64_tr_b16 v[44:45], v77 offset:2056
    ds_read_b64_tr_b16 v[46:47], v77 offset:2312
    s_waitcnt vmcnt(0) lgkmcnt(0)
    s_barrier
    v_add_u32 v77, 0, v78
    ds_read_b64_tr_b16 v[48:49], v77 offset:0
    ds_read_b64_tr_b16 v[50:51], v77 offset:256
    ds_read_b64_tr_b16 v[52:53], v77 offset:2048
    ds_read_b64_tr_b16 v[54:55], v77 offset:2304
    ds_read_b64_tr_b16 v[56:57], v77 offset:8
    ds_read_b64_tr_b16 v[58:59], v77 offset:264
    ds_read_b64_tr_b16 v[60:61], v77 offset:2056
    ds_read_b64_tr_b16 v[62:63], v77 offset:2312
    s_waitcnt lgkmcnt(0)
    s_barrier
    ds_write_b128 v70, v[0:3] offset:20480
    ds_write_b128 v70, v[4:7] offset:21504
    ds_write_b128 v70, v[8:11] offset:22528
    ds_write_b128 v70, v[12:15] offset:23552
    ds_write_b128 v70, v[16:19] offset:24576
    ds_write_b128 v70, v[20:23] offset:25600
    ds_write_b128 v70, v[24:27] offset:26624
    ds_write_b128 v70, v[28:31] offset:27648
    ds_write_b128 v70, v[32:35] offset:28672
    ds_write_b128 v70, v[36:39] offset:29696
    ds_write_b128 v70, v[40:43] offset:30720
    ds_write_b128 v70, v[44:47] offset:31744
    ds_write_b128 v70, v[48:51] offset:32768
    ds_write_b128 v70, v[52:55] offset:33792
    ds_write_b128 v70, v[56:59] offset:34816
    ds_write_b128 v70, v[60:63] offset:35840
    s_waitcnt lgkmcnt(0)
    v_bfe_u32 v60, v65, 4, 6
    v_and_b32 v61, 15, v60
    v_lshrrev_b32 v62, 4, v60
    v_mov_b32 v50, 0x3f80
    v_mov_b32 v51, 0x3f800000
    v_and_b32 v77, 1, v62
    v_lshlrev_b32 v77, 2, v77
    v_sub_u32 v77, v61, v77
    v_and_b32 v78, 3, v61
    v_lshlrev_b32 v78, 2, v78
    v_lshrrev_b32 v79, 2, v61
    v_add_u32 v78, v78, v79
    v_cmp_eq_u32 vcc, 0, v77
    s_nop 1
    v_cndmask_b32 v8, 0, v50, vcc
    v_cmp_eq_u32 vcc, 1, v77
    s_nop 1
    v_cndmask_b32 v8, v8, v51, vcc
    v_cmp_eq_u32 vcc, 0, v78
    s_nop 1
    v_cndmask_b32 v12, 0, v50, vcc
    v_cmp_eq_u32 vcc, 1, v78
    s_nop 1
    v_cndmask_b32 v12, v12, v51, vcc
    v_cmp_eq_u32 vcc, 2, v77
    s_nop 1
    v_cndmask_b32 v9, 0, v50, vcc
    v_cmp_eq_u32 vcc, 3, v77
    s_nop 1
    v_cndmask_b32 v9, v9, v51, vcc
    v_cmp_eq_u32 vcc, 2, v78
    s_nop 1
    v_cndmask_b32 v13, 0, v50, vcc
    v_cmp_eq_u32 vcc, 3, v78
    s_nop 1
    v_cndmask_b32 v13, v13, v51, vcc
    v_cmp_eq_u32 vcc, 8, v77
    s_nop 1
    v_cndmask_b32 v10, 0, v50, vcc
    v_cmp_eq_u32 vcc, 9, v77
    s_nop 1
    v_cndmask_b32 v10, v10, v51, vcc
    v_cmp_eq_u32 vcc, 4, v78
    s_nop 1
    v_cndmask_b32 v14, 0, v50, vcc
    v_cmp_eq_u32 vcc, 5, v78
    s_nop 1
    v_cndmask_b32 v14, v14, v51, vcc
    v_cmp_eq_u32 vcc, 10, v77
    s_nop 1
    v_cndmask_b32 v11, 0, v50, vcc
    v_cmp_eq_u32 vcc, 11, v77
    s_nop 1
    v_cndmask_b32 v11, v11, v51, vcc
    v_cmp_eq_u32 vcc, 6, v78
    s_nop 1
    v_cndmask_b32 v15, 0, v50, vcc
    v_cmp_eq_u32 vcc, 7, v78
    s_nop 1
    v_cndmask_b32 v15, v15, v51, vcc
    v_lshlrev_b32 v77, 4, v61
    ds_write_b128 v69, v[8:11] offset:15360
    ds_write_b128 v77, v[12:15] offset:15872
    s_waitcnt vmcnt(0) lgkmcnt(0)
    s_barrier
    v_mov_b32 v2, 1
    s_cmp_lg_u32 s13, 0
    s_cbranch_scc1 cs_noarr
    s_mov_b64 exec, 1
    buffer_atomic_add v2, off, s[84:87], 0 offset:212
    s_mov_b32 s40, 16777216
    s_mov_b32 s42, 2
cs_startpoll:
    buffer_load_dword v3, off, s[84:87], 0 offset:212 sc1
    s_sub_u32 s40, s40, 1
    s_cbranch_scc1 cs_decide
    s_waitcnt vmcnt(0)
    v_readfirstlane_b32 s41, v3
    s_nop 1
    s_cmp_lt_u32 s41, 32
    s_cbranch_scc1 cs_startpoll
    s_mov_b32 s42, 1
cs_decide:
    s_mov_b64 exec, -1
cs_noarr:
    s_barrier
    s_mov_b32 s44, 0x3e0293ee
    s_mov_b32 s45, s44
    s_or_b32 s66, s44, 0x80000000
    s_mov_b32 s48, 0x3f003f00
    s_mov_b32 s49, 0
    s_mov_b32 s50, 0x3f803f80
    s_mov_b32 s51, 0x3f803f80
    s_mov_b32 s52, 512
    s_mov_b32 s53, 1024
    s_mov_b32 s54, 1536
    s_mov_b32 s30, 0
    s_lshl_b32 s47, s13, 9
    s_cmp_lg_u32 s32, 0
    s_cselect_b32 s71, s13, 3
    s_add_u32 s46, s71, 1
    s_lshr_b32 s46, s46, 1
    s_mov_b32 s14, 67649536
    s_mov_b32 s15, 67653632
    s_mov_b32 s16, 67657728
    s_mov_b32 s36, 0
    s_add_u32 s17, s68, 67633152
    s_mov_b32 s69, 0
    s_mov_b32 s70, 0
    s_lshl_b32 s26, s12, 14
    s_add_u32 s26, s26, 0
    s_mul_i32 s40, s13, 3072
    s_add_u32 s24, s26, s40
    s_lshl_b32 s96, s12, 7
    s_add_u32 s29, s96, 125845504
    s_add_u32 s96, s96, 125829120
    s_lshl_b32 s40, s12, 14
    s_add_u32 s40, s40, 68681728
    s_add_u32 s18, s40, 0
    s_add_u32 s19, s40, 4096
    s_add_u32 s20, s40, 8192
    s_add_u32 s21, s40, 12288
    s_lshr_b32 s40, s12, 3
    s_lshl_b32 s40, s40, 12
    s_and_b32 s41, s12, 7
    s_lshl_b32 s41, s41, 7
    s_add_u32 s40, s40, s41
    s_add_u32 s22, s40, 68681728
    s_add_u32 s23, s22, 1024
    s_add_u32 s25, s22, 2048
    s_mov_b32 s56, -65528
    s_cmp_lg_u32 s32, 0
    s_cselect_b64 s[38:39], -1, 0
    s_add_u32 s55, s68, 138412032
    s_cmp_eq_u32 s13, 3
    s_cselect_b64 s[100:101], 1, 0
    s_cselect_b64 s[38:39], 1, s[38:39]
    s_cselect_b32 s93, 64, 0
    s_cselect_b32 s55, s29, s55
    s_cselect_b32 s57, 0, 9216
    s_mov_b64 exec, s[100:101]
    v_mov_b32 v72, s95
    s_mov_b64 exec, -1
    s_mov_b32 s34, 0xff00ff00
    s_mov_b32 s35, 0xff00ff00
    s_lshl_b32 s28, s12, 12
    s_add_u32 s28, s28, 7602176
    s_add_u32 s27, s28, 77594624
    s_add_u32 s28, s28, 69206016
    s_mov_b32 s40, 3
    v_bfe_u32 v78, v65, 2, 5
    s_mov_b32 s31, 4194304
cs_kv0:
    buffer_load_dword v77, v78, s[4:7], s96 offen offset:16 sc1
    s_waitcnt vmcnt(0)
    v_subrev_u32 v77, s95, v77
    v_cmp_lt_u32 vcc, 16, v77
    s_nop 1
    v_cndmask_b32 v77, v77, 0, vcc
    v_bfe_u32 v79, v78, 2, 2
    v_lshl_add_u32 v77, v77, 2, v79
    s_nop 1
    v_min_u32_dpp v77, v77, v77 row_ror:1 row_mask:0xf bank_mask:0xf
    s_nop 1
    v_min_u32_dpp v77, v77, v77 row_ror:2 row_mask:0xf bank_mask:0xf
    s_nop 1
    v_min_u32_dpp v77, v77, v77 row_ror:4 row_mask:0xf bank_mask:0xf
    s_nop 0
    v_readfirstlane_b32 s97, v77
    s_sub_u32 s31, s31, 1
    s_cbranch_scc1 cs_kv0_x
    s_cmp_le_u32 s40, s97
    s_cbranch_scc1 cs_kv0_x
    s_sleep 2
    s_branch cs_kv0
cs_kv0_x:
    s_add_u32 s40, s24, 0
    s_add_u32 s40, s40, s33
    s_sub_u32 s41, s96, s40
    v_bfe_u32 v77, v65, 2, 5
    v_add3_u32 v77, v77, s41, 16
    v_lshlrev_b32 v78, 3, v69
    s_nop 0
    v_mov_b32_dpp v78, v77 quad_perm:[0,1,2,3] row_mask:0xc bank_mask:0xf
    buffer_load_dword v76, v78, s[4:7], s40 offen sc1
    s_add_u32 s40, s24, 524288
    s_add_u32 s40, s40, s33
    s_sub_u32 s41, s96, s40
    v_bfe_u32 v77, v65, 2, 5
    v_add3_u32 v77, v77, s41, 16
    v_lshlrev_b32 v78, 3, v69
    s_nop 0
    v_mov_b32_dpp v78, v77 quad_perm:[0,1,2,3] row_mask:0xc bank_mask:0xf
    buffer_load_dword v76, v78, s[4:7], s40 offen sc1
cs_kvdone:
    v_mov_b64 v[0:1], 0
    v_mov_b64 v[2:3], 0
    v_mov_b64 v[4:5], 0
    v_mov_b64 v[6:7], 0
    v_mov_b64 v[8:9], 0
    v_mov_b64 v[10:11], 0
    v_mov_b64 v[12:13], 0
    v_mov_b64 v[14:15], 0
    v_mov_b64 v[16:17], 0
    v_mov_b64 v[18:19], 0
    v_mov_b64 v[20:21], 0
    v_mov_b64 v[22:23], 0
    ds_read_b128 v[40:43], v70 offset:0
    ds_read_b128 v[44:47], v70 offset:1024
    ds_read_b128 v[48:51], v70 offset:2048
    ds_read_b128 v[52:55], v70 offset:3072
    ds_read_b128 v[24:27], v70 offset:4096
    ds_read_b128 v[28:31], v70 offset:5120
    ds_read_b128 v[32:35], v70 offset:6144
    ds_read_b128 v[36:39], v70 offset:7168
    buffer_load_dwordx4 v[60:63], v65, s[4:7], s14 offen offset:0 sc1
    buffer_load_dwordx4 v[56:59], v66, s[4:7], s14 offen offset:0 sc1
    s_mov_b32 s31, 1048576
    s_waitcnt vmcnt(0) lgkmcnt(0)
    s_branch cs_goA
cs_loop:
    s_mov_b32 s31, 1048576
    s_mov_b32 s69, s70
    s_waitcnt lgkmcnt(0)
cs_cA:
    buffer_load_dwordx4 v[60:63], v65, s[4:7], s14 offen offset:0 sc1
    buffer_load_dwordx4 v[56:59], v66, s[4:7], s14 offen offset:0 sc1
cs_cA1:
    v_bitop3_b32 v77, v60, v56, s70 bitop3:0x7e
    v_and_b32 v77, 1, v77
    v_cmp_ne_u32 vcc, 0, v77
    s_cbranch_vccz cs_goA
    s_nop 15
    s_nop 15
    s_nop 7
    v_bitop3_b32 v77, v60, v56, s70 bitop3:0x7e
    v_and_b32 v77, 1, v77
    v_cmp_ne_u32 vcc, 0, v77
    s_cbranch_vccz cs_goA
    s_nop 15
    s_nop 15
    s_nop 7
    v_bitop3_b32 v77, v60, v56, s70 bitop3:0x7e
    v_and_b32 v77, 1, v77
    v_cmp_ne_u32 vcc, 0, v77
    s_cbranch_vccz cs_goA
    s_nop 15
    s_nop 15
    s_nop 7
    v_bitop3_b32 v77, v60, v56, s70 bitop3:0x7e
    v_and_b32 v77, 1, v77
    v_cmp_ne_u32 vcc, 0, v77
    s_cbranch_vccz cs_goA
    s_nop 15
    s_nop 15
    s_nop 7
    v_bitop3_b32 v77, v60, v56, s70 bitop3:0x7e
    v_and_b32 v77, 1, v77
    v_cmp_ne_u32 vcc, 0, v77
    s_cbranch_vccz cs_goA
    s_nop 15
    s_nop 15
    s_nop 7
    buffer_load_dwordx4 v[60:63], v65, s[4:7], s14 offen offset:0 sc1
    buffer_load_dwordx4 v[56:59], v66, s[4:7], s14 offen offset:0 sc1
    v_bitop3_b32 v77, v60, v56, s70 bitop3:0x7e
    v_and_b32 v77, 1, v77
    v_cmp_ne_u32 vcc, 0, v77
    s_cbranch_vccz cs_goA
    s_nop 15
    s_nop 15
    s_nop 7
    v_bitop3_b32 v77, v60, v56, s70 bitop3:0x7e
    v_and_b32 v77, 1, v77
    v_cmp_ne_u32 vcc, 0, v77
    s_cbranch_vccz cs_goA
    s_nop 15
    s_nop 15
    s_nop 7
    v_bitop3_b32 v77, v60, v56, s70 bitop3:0x7e
    v_and_b32 v77, 1, v77
    v_cmp_ne_u32 vcc, 0, v77
    s_cbranch_vccz cs_goA
    s_nop 15
    s_nop 15
    s_nop 7
    v_bitop3_b32 v77, v60, v56, s70 bitop3:0x7e
    v_and_b32 v77, 1, v77
    v_cmp_ne_u32 vcc, 0, v77
    s_cbranch_vccz cs_goA
    s_nop 15
    s_nop 15
    s_nop 7
    v_bitop3_b32 v77, v60, v56, s70 bitop3:0x7e
    v_and_b32 v77, 1, v77
    v_cmp_ne_u32 vcc, 0, v77
    s_cbranch_vccz cs_goA
    s_nop 15
    s_nop 15
    s_nop 7
    buffer_load_dwordx4 v[60:63], v65, s[4:7], s14 offen offset:0 sc1
    buffer_load_dwordx4 v[56:59], v66, s[4:7], s14 offen offset:0 sc1
    v_bitop3_b32 v77, v60, v56, s70 bitop3:0x7e
    v_and_b32 v77, 1, v77
    v_cmp_ne_u32 vcc, 0, v77
    s_cbranch_vccz cs_goA
    s_nop 15
    s_nop 15
    s_nop 7
    v_bitop3_b32 v77, v60, v56, s70 bitop3:0x7e
    v_and_b32 v77, 1, v77
    v_cmp_ne_u32 vcc, 0, v77
    s_cbranch_vccz cs_goA
    s_nop 15
    s_nop 15
    s_nop 7
    v_bitop3_b32 v77, v60, v56, s70 bitop3:0x7e
    v_and_b32 v77, 1, v77
    v_cmp_ne_u32 vcc, 0, v77
    s_cbranch_vccz cs_goA
    s_nop 15
    s_nop 15
    s_nop 7
    v_bitop3_b32 v77, v60, v56, s70 bitop3:0x7e
    v_and_b32 v77, 1, v77
    v_cmp_ne_u32 vcc, 0, v77
    s_cbranch_vccz cs_goA
    s_nop 15
    s_nop 15
    s_nop 7
    v_bitop3_b32 v77, v60, v56, s70 bitop3:0x7e
    v_and_b32 v77, 1, v77
    v_cmp_ne_u32 vcc, 0, v77
    s_cbranch_vccz cs_goA
    s_nop 15
    s_nop 15
    s_nop 7
    buffer_load_dwordx4 v[60:63], v65, s[4:7], s14 offen offset:0 sc1
    buffer_load_dwordx4 v[56:59], v66, s[4:7], s14 offen offset:0 sc1
    v_bitop3_b32 v77, v60, v56, s70 bitop3:0x7e
    v_and_b32 v77, 1, v77
    v_cmp_ne_u32 vcc, 0, v77
    s_cbranch_vccz cs_goA
    s_nop 15
    s_nop 15
    s_nop 7
    v_bitop3_b32 v77, v60, v56, s70 bitop3:0x7e
    v_and_b32 v77, 1, v77
    v_cmp_ne_u32 vcc, 0, v77
    s_cbranch_vccz cs_goA
    s_nop 15
    s_nop 15
    s_nop 7
    v_bitop3_b32 v77, v60, v56, s70 bitop3:0x7e
    v_and_b32 v77, 1, v77
    v_cmp_ne_u32 vcc, 0, v77
    s_cbranch_vccz cs_goA
    s_nop 15
    s_nop 15
    s_nop 7
    v_bitop3_b32 v77, v60, v56, s70 bitop3:0x7e
    v_and_b32 v77, 1, v77
    v_cmp_ne_u32 vcc, 0, v77
    s_cbranch_vccz cs_goA
    s_nop 15
    s_nop 15
    s_nop 7
    v_bitop3_b32 v77, v60, v56, s70 bitop3:0x7e
    v_and_b32 v77, 1, v77
    v_cmp_ne_u32 vcc, 0, v77
    s_cbranch_vccz cs_goA
    s_nop 15
    s_nop 15
    s_nop 7
    s_sub_u32 s31, s31, 64
    s_cbranch_scc0 cs_cA
cs_goA:
    ds_write_b128 v65, v[60:63] offset:0
    v_smfmac_f32_16x16x64_bf16 v[0:3], v[60:63], v[40:47], v64
    v_smfmac_f32_16x16x64_bf16 v[4:7], v[60:63], v[48:55], v64
    buffer_load_dwordx4 v[40:43], v65, s[4:7], s15 offen offset:0 sc1
    v_smfmac_f32_16x16x64_bf16 v[0:3], v[56:59], v[24:31], v64
    s_add_u32 s40, s24, 1048576
    s_add_u32 s40, s40, s33
    s_sub_u32 s41, s96, s40
    v_smfmac_f32_16x16x64_bf16 v[4:7], v[56:59], v[32:39], v64
    ds_read_b128 v[24:27], v70 offset:8192
    s_cmp_lt_u32 s97, s93
    s_cselect_b32 s41, s41, 0
    v_smfmac_f32_16x16x64_bf16 v[8:11], v[60:63], a[96:103], v64
    ds_read_b128 v[28:31], v70 offset:9216
    v_smfmac_f32_16x16x64_bf16 v[12:15], v[60:63], a[104:111], v64
    ds_read_b128 v[32:35], v70 offset:10240
    s_waitcnt lgkmcnt(3)
    s_barrier
    ds_read_b128 v[48:51], v67 offset:0
    v_smfmac_f32_16x16x64_bf16 v[8:11], v[56:59], a[112:119], v64
    ds_read_b128 v[36:39], v70 offset:11264
    v_bitop3_b32 v79, v73, -9, s54 bitop3:0x6a
    v_smfmac_f32_16x16x64_bf16 v[12:15], v[56:59], a[120:127], v64
    ds_read_b128 v[52:55], v68 offset:0
    v_bfe_u32 v77, v65, 2, 5
    v_smfmac_f32_16x16x64_bf16 v[16:19], v[60:63], a[216:223], v64
    buffer_load_dwordx4 v[40:43], v65, s[4:7], s15 offen offset:0 sc1
    s_waitcnt lgkmcnt(4)
    v_smfmac_f32_16x16x64_bf16 v[20:23], v[60:63], v[24:31], v64
    ds_read_b128 v[24:27], v70 offset:12288
    s_waitcnt lgkmcnt(3)
    v_smfmac_f32_16x16x64_bf16 v[0:3], v[48:51], a[0:7], v64
    ds_read_b128 v[28:31], v70 offset:13312
    s_waitcnt lgkmcnt(3)
    v_smfmac_f32_16x16x64_bf16 v[4:7], v[48:51], v[32:39], v64
    ds_read_b128 v[32:35], v70 offset:14336
    v_add3_u32 v77, v77, s41, 16
    v_smfmac_f32_16x16x64_bf16 v[8:11], v[48:51], a[128:135], v64
    ds_read_b128 v[36:39], v70 offset:15360
    v_lshlrev_b32 v78, 3, v69
    v_smfmac_f32_16x16x64_bf16 v[12:15], v[48:51], a[136:143], v64
    buffer_load_dwordx4 v[60:63], v65, s[4:7], s16 offen offset:0 sc1
    v_smfmac_f32_16x16x64_bf16 v[16:19], v[56:59], a[224:231], v64
    v_mov_b32_dpp v78, v77 quad_perm:[0,1,2,3] row_mask:0xc bank_mask:0xf
    v_smfmac_f32_16x16x64_bf16 v[20:23], v[56:59], a[232:239], v64
    s_waitcnt lgkmcnt(2)
    s_waitcnt vmcnt(2)
    v_and_b32 v77, s36, v40
    v_smfmac_f32_16x16x64_bf16 v[12:15], v[52:55], v[24:31], v64
    ds_write_b128 v65, v[40:43] offset:4096
    v_smfmac_f32_16x16x64_bf16 v[0:3], v[52:55], a[8:15], v64
    s_waitcnt lgkmcnt(1)
    v_cmp_ne_u32 vcc, s70, v77
    v_smfmac_f32_16x16x64_bf16 v[4:7], v[52:55], v[32:39], v64
    buffer_load_dwordx4 v[24:27], v65, s[4:7], s24 offen offset:0 sc1
    v_smfmac_f32_16x16x64_bf16 v[8:11], v[52:55], a[144:151], v64
    s_cbranch_vccnz cs_spinB
cs_backB:
    v_smfmac_f32_16x16x64_bf16 v[16:19], v[40:43], v[176:183], v64
    s_waitcnt lgkmcnt(0)
    s_barrier
    ds_read_b128 v[44:47], v66 offset:4096
    v_smfmac_f32_16x16x64_bf16 v[12:15], v[40:43], a[160:167], v64
    ds_read_b128 v[32:35], v70 offset:16384
    v_smfmac_f32_16x16x64_bf16 v[0:3], v[40:43], a[16:23], v64
    ds_read_b128 v[36:39], v70 offset:17408
    v_smfmac_f32_16x16x64_bf16 v[8:11], v[40:43], a[152:159], v64
    ds_read_b128 v[48:51], v67 offset:4096
    v_smfmac_f32_16x16x64_bf16 v[4:7], v[40:43], a[24:31], v64
    ds_read_b128 v[52:55], v68 offset:4096
    v_smfmac_f32_16x16x64_bf16 v[20:23], v[40:43], v[184:191], v64
    buffer_load_dwordx4 v[28:31], v65, s[4:7], s24 offen offset:1024 sc1
    s_waitcnt lgkmcnt(4)
    v_smfmac_f32_16x16x64_bf16 v[0:3], v[44:47], a[32:39], v64
    ds_read_b128 v[56:59], v69 offset:15360
    s_waitcnt lgkmcnt(3)
    v_smfmac_f32_16x16x64_bf16 v[8:11], v[44:47], v[32:39], v64
    ds_read_b128 v[32:35], v70 offset:18432
    v_smfmac_f32_16x16x64_bf16 v[4:7], v[44:47], a[40:47], v64
    ds_read_b128 v[36:39], v70 offset:19456
    v_smfmac_f32_16x16x64_bf16 v[12:15], v[44:47], a[168:175], v64
    buffer_load_dwordx4 v[42:45], v65, s[4:7], s24 offen offset:3072 sc1
    s_waitcnt lgkmcnt(3)
    v_smfmac_f32_16x16x64_bf16 v[0:3], v[48:51], a[48:55], v64
    s_waitcnt vmcnt(3)
    v_and_b32 v77, s36, v60
    v_smfmac_f32_16x16x64_bf16 v[8:11], v[48:51], a[176:183], v64
    v_cmp_ne_u32 vcc, s70, v77
    v_smfmac_f32_16x16x64_bf16 v[0:3], v[52:55], a[64:71], v64
    s_waitcnt lgkmcnt(0)
    v_smfmac_f32_16x16x64_bf16 v[8:11], v[52:55], v[32:39], v64
    s_cbranch_vccnz cs_spin8
cs_back8:
    v_smfmac_f32_16x16x64_bf16 v[0:3], v[60:63], a[80:87], v64
    buffer_load_dwordx4 v[34:37], v65, s[4:7], s24 offen offset:2048 sc1
    s_nop 1
    v_smfmac_f32_16x16x64_bf16 v[8:11], v[60:63], a[200:207], v64
    s_nop 1
    v_lshrrev_b32 v77, 1, v69
    v_smfmac_f32_16x16x64_bf16 v[4:7], v[48:51], a[56:63], v64
    s_nop 1
    v_cvt_pk_bf16_f32 v0, v0, v1
    v_smfmac_f32_16x16x64_bf16 v[12:15], v[48:51], a[184:191], v64
    s_nop 1
    v_cvt_pk_bf16_f32 v1, v2, v3
    v_smfmac_f32_16x16x64_bf16 v[4:7], v[52:55], a[72:79], v64
    s_nop 1
    v_cvt_pk_bf16_f32 v2, v8, v9
    v_smfmac_f32_16x16x64_bf16 v[12:15], v[52:55], a[192:199], v64
    s_nop 1
    v_cvt_pk_bf16_f32 v3, v10, v11
    v_smfmac_f32_16x16x64_bf16 v[4:7], v[60:63], a[88:95], v64
    s_nop 2
    v_smfmac_f32_16x16x64_bf16 v[12:15], v[60:63], a[208:215], v64
    buffer_load_dword v76, v78, s[4:7], s40 offen sc1
    s_nop 1
    v_mfma_f32_16x16x32_bf16 v[8:11], v[0:3], v[56:59], 0
    s_nop 0
    v_cvt_pk_bf16_f32 v4, v4, v5
    v_cvt_pk_bf16_f32 v5, v6, v7
    s_nop 0
    v_cvt_pk_bf16_f32 v6, v12, v13
    v_cvt_pk_bf16_f32 v7, v14, v15
    s_nop 1
    v_mfma_f32_16x16x32_bf16 v[12:15], v[4:7], v[56:59], 0
    ds_read_b128 v[56:59], v66 offset:4096
    v_cvt_pk_bf16_f32 v0, v8, v9
    v_cvt_pk_bf16_f32 v1, v10, v11
    v_smfmac_f32_16x16x64_bf16 v[16:19], v[48:51], v[208:215], v64
    s_waitcnt vmcnt(3)
    s_nop 2
    v_cvt_pk_bf16_f32 v2, v12, v13
    v_cvt_pk_bf16_f32 v3, v14, v15
    s_nop 1
    v_mfma_f32_16x16x32_bf16 v[12:15], v[0:3], v[0:3], 0
    s_nop 1
    v_bitop3_b32 v78, v73, -9, s53 bitop3:0x6a
    v_mfma_f32_16x16x32_bf16 v[4:7], v[24:27], v[0:3], 0
    ds_read_b128 v[24:27], v67 offset:0
    s_nop 1
    v_mfma_f32_16x16x32_bf16 v[8:11], v[28:31], v[0:3], 0
    s_nop 0
    v_mov_b32_dpp v12, v14 row_ror:8 row_mask:0xf bank_mask:0xc
    v_mov_b32_dpp v13, v15 row_ror:8 row_mask:0xf bank_mask:0xc
    v_smfmac_f32_16x16x64_bf16 v[20:23], v[48:51], v[216:223], v64
    ds_write_b64 v71, v[12:13]
    ds_read_b128 v[48:51], v68 offset:0
    s_nop 1
    v_mov_b32_dpp v4, v8 row_ror:8 row_mask:0xf bank_mask:0xc
    v_mov_b32_dpp v5, v9 row_ror:8 row_mask:0xf bank_mask:0xc
    v_mov_b32_dpp v6, v10 row_ror:8 row_mask:0xf bank_mask:0xc
    v_mov_b32_dpp v7, v11 row_ror:8 row_mask:0xf bank_mask:0xc
    v_smfmac_f32_16x16x64_bf16 v[16:19], v[52:55], v[224:231], v64
    ds_write_b128 v65, v[4:7] offset:8192
    v_smfmac_f32_16x16x64_bf16 v[20:23], v[52:55], v[232:239], v64
    s_waitcnt lgkmcnt(3)
    v_smfmac_f32_16x16x64_bf16 v[16:19], v[24:27], a[240:247], v64
    s_waitcnt vmcnt(1)
    v_smfmac_f32_16x16x64_bf16 v[20:23], v[24:27], a[248:255], v64
    s_mov_b64 exec, s[38:39]
    buffer_store_dword v72, v75, s[4:7], s55 offen sc1
    s_mov_b64 exec, -1
    v_smfmac_f32_16x16x64_bf16 v[16:19], v[60:63], v[240:247], v64
    s_cmp_ge_u32 s30, 58
    s_waitcnt lgkmcnt(0)
    s_barrier
    ds_read_b128 v[8:11], v66 offset:8192
    v_smfmac_f32_16x16x64_bf16 v[20:23], v[60:63], v[248:255], v64
    ds_read_b128 v[12:15], v67 offset:8192
    v_smfmac_f32_16x16x64_bf16 v[16:19], v[56:59], v[192:199], v64
    ds_read_b128 v[52:55], v68 offset:8192
    v_smfmac_f32_16x16x64_bf16 v[20:23], v[56:59], v[200:207], v64
    ds_read_b64 v[24:25], v77 offset:14336
    ds_read_b64 v[26:27], v77 offset:14592
    v_smfmac_f32_16x16x64_bf16 v[16:19], v[48:51], v[160:167], v64
    ds_read_b64 v[28:29], v77 offset:14848
    ds_read_b64 v[30:31], v77 offset:15104
    v_bitop3_b32 v77, v73, -9, s52 bitop3:0x6a
    v_smfmac_f32_16x16x64_bf16 v[20:23], v[48:51], v[168:175], v64
    s_cbranch_scc1 cs_rare
cs_rare_x:
    ds_read_b128 v[56:59], v70 offset:22528
    ds_read_b128 v[60:63], v70 offset:23552
    s_waitcnt lgkmcnt(6)
    v_pk_add_f32 v[4:5], v[4:5], v[8:9]
    v_pk_add_f32 v[6:7], v[6:7], v[10:11]
    v_pk_add_f32 v[12:13], v[12:13], v[52:53]
    v_pk_add_f32 v[14:15], v[14:15], v[54:55]
    v_pk_add_f32 v[4:5], v[4:5], v[12:13]
    v_pk_add_f32 v[6:7], v[6:7], v[14:15]
    s_waitcnt lgkmcnt(2)
    v_pk_add_f32 v[24:25], v[24:25], v[26:27]
    v_pk_add_f32 v[28:29], v[28:29], v[30:31]
    v_max3_f32 v8, v4, v5, v6
    v_pk_add_f32 v[24:25], v[24:25], v[28:29]
    v_max_f32 v8, v8, v7
    v_max3_f32 v8, v8, v24, v25
    v_cvt_pk_bf16_f32 v32, v16, v17
    v_cvt_pk_bf16_f32 v38, v18, v19
    v_max_f32_dpp v8, v8, v8 row_ror:8 row_mask:0xf bank_mask:0xf
    v_mov_b32 v9, v8
    v_cvt_pk_bf16_f32 v40, v20, v21
    v_cvt_pk_bf16_f32 v46, v22, v23
    v_permlane32_swap_b32 v8, v9
    v_max_f32 v8, v8, v9
    v_mov_b32 v9, v8
    v_mov_b32 v11, 0
    v_mov_b32 v15, 0
    v_permlane16_swap_b32 v8, v9
    v_max_f32 v8, v8, v9
    v_mul_f32 v8, s66, v8
    v_pk_fma_f32 v[4:5], v[4:5], s[44:45], v[8:9] op_sel_hi:[1,1,0]
    v_pk_fma_f32 v[6:7], v[6:7], s[44:45], v[8:9] op_sel_hi:[1,1,0]
    v_pk_fma_f32 v[24:25], v[24:25], s[44:45], v[8:9] op_sel_hi:[1,1,0]
    v_exp_f32 v4, v4
    v_exp_f32 v5, v5
    v_exp_f32 v6, v6
    v_exp_f32 v7, v7
    v_exp_f32 v24, v24
    v_exp_f32 v25, v25
    v_cvt_pk_bf16_f32 v12, v4, v5
    v_cvt_pk_bf16_f32 v13, v6, v7
    v_cvt_pk_bf16_f32 v10, v24, v25
    v_cvt_pk_bf16_f32 v14, v24, v25
    v_mov_b64 v[0:1], s[48:49]
    v_mfma_f32_16x16x32_bf16 v[4:7], v[32:35], v[10:13], 0
    ds_read_b128 v[48:51], v70 offset:20480
    v_mov_b64 v[2:3], s[50:51]
    v_mfma_f32_16x16x32_bf16 v[24:27], v[36:39], v[12:15], 0
    ds_read_b128 v[52:55], v70 offset:21504
    v_mov_b64 v[8:9], 0
    v_mfma_f32_16x16x32_bf16 v[28:31], v[0:3], v[10:13], 0
    ds_read_b128 v[32:35], v70 offset:24576
    v_mov_b64 v[0:1], 0
    v_mfma_f32_16x16x32_bf16 v[16:19], v[40:43], v[10:13], 0
    ds_read_b128 v[36:39], v70 offset:25600
    v_mov_b64 v[2:3], 0
    v_mfma_f32_16x16x32_bf16 v[20:23], v[44:47], v[12:15], 0
    ds_read_b128 v[40:43], v70 offset:26624
    v_add_f32_dpp v4, v24, v4 row_ror:8 row_mask:0xf bank_mask:0xf
    v_add_f32_dpp v5, v25, v5 row_ror:8 row_mask:0xf bank_mask:0xf
    v_add_f32_dpp v6, v26, v6 row_ror:8 row_mask:0xf bank_mask:0xf
    v_add_f32_dpp v7, v27, v7 row_ror:8 row_mask:0xf bank_mask:0xf
    v_add_f32_dpp v29, v28, v28 row_ror:8 row_mask:0xf bank_mask:0xf
    v_rcp_f32 v28, v29
    v_mov_b64 v[10:11], 0
    v_add_f32_dpp v4, v16, v20 row_ror:8 row_mask:0xf bank_mask:0xc
    v_add_f32_dpp v5, v17, v21 row_ror:8 row_mask:0xf bank_mask:0xc
    v_add_f32_dpp v6, v18, v22 row_ror:8 row_mask:0xf bank_mask:0xc
    v_add_f32_dpp v7, v19, v23 row_ror:8 row_mask:0xf bank_mask:0xc
    v_pk_mul_f32 v[4:5], v[4:5], v[28:29] op_sel_hi:[1,0]
    v_pk_mul_f32 v[6:7], v[6:7], v[28:29] op_sel_hi:[1,0]
    v_cvt_pk_bf16_f32 v4, v4, v5
    v_cvt_pk_bf16_f32 v5, v6, v7
    ds_write_b64 v73, v[4:5] offset:12288
    v_mov_b32_dpp v6, v4 row_ror:8 row_mask:0xf bank_mask:0xf
    v_mov_b32_dpp v7, v5 row_ror:8 row_mask:0xf bank_mask:0xf
    v_mov_b64 v[12:13], 0
    v_mov_b64 v[14:15], 0
    v_smfmac_f32_16x16x64_bf16 v[8:11], v[4:7], v[80:87], v64
    s_waitcnt lgkmcnt(4)
    v_mov_b64 v[24:25], 0
    v_smfmac_f32_16x16x64_bf16 v[0:3], v[4:7], v[48:55], v64
    ds_read_b128 v[44:47], v70 offset:27648
    v_mov_b64 v[26:27], 0
    v_smfmac_f32_16x16x64_bf16 v[12:15], v[4:7], v[112:119], v64
    s_waitcnt lgkmcnt(1)
    s_barrier
    ds_read_b128 v[16:19], v77 offset:12288
    v_smfmac_f32_16x16x64_bf16 v[24:27], v[4:7], v[56:63], v64
    ds_read_b128 v[20:23], v78 offset:12288
    ds_read_b128 v[28:31], v79 offset:12288
    v_mov_b64 v[4:5], 0
    v_mov_b64 v[6:7], 0
    v_bfe_u32 v77, v74, 16, 1
    v_mad_i32_i24 v77, v77, s56, v74
    s_waitcnt lgkmcnt(2)
    v_smfmac_f32_16x16x64_bf16 v[8:11], v[16:19], v[88:95], v64
    ds_read_b128 v[56:59], v70 offset:28672
    v_and_b32 v72, 8, v73
    v_smfmac_f32_16x16x64_bf16 v[12:15], v[16:19], v[120:127], v64
    ds_read_b128 v[60:63], v70 offset:29696
    s_waitcnt lgkmcnt(3)
    v_mad_u32_u24 v72, v72, 63, v73
    v_smfmac_f32_16x16x64_bf16 v[8:11], v[20:23], v[96:103], v64
    ds_read_b128 v[48:51], v70 offset:30720
    v_subrev_u32 v72, s47, v72
    v_smfmac_f32_16x16x64_bf16 v[12:15], v[20:23], v[128:135], v64
    ds_read_b128 v[52:55], v70 offset:31744
    s_waitcnt lgkmcnt(4)
    v_smfmac_f32_16x16x64_bf16 v[8:11], v[28:31], v[104:111], v64
    s_add_u32 s30, s30, 1
    s_xor_b32 s70, s70, 1
    s_cmp_lg_u32 s71, 0
    v_smfmac_f32_16x16x64_bf16 v[12:15], v[28:31], v[136:143], v64
    s_nop 2
    v_smfmac_f32_16x16x64_bf16 v[0:3], v[16:19], v[32:39], v64
    ds_read_b128 v[32:35], v70 offset:32768
    ds_read_b128 v[36:39], v70 offset:33792
    v_cvt_pk_bf16_f32 v8, v8, v9
    v_cvt_pk_bf16_f32 v9, v10, v11
    v_and_or_b32 v8, v8, -2, s69
    v_cvt_pk_bf16_f32 v10, v12, v13
    v_cvt_pk_bf16_f32 v11, v14, v15
    v_smfmac_f32_16x16x64_bf16 v[24:27], v[16:19], v[40:47], v64
    buffer_store_dwordx4 v[8:11], v74, s[4:7], s22 offen sc1
    ds_read_b128 v[40:43], v70 offset:34816
    s_waitcnt lgkmcnt(3)
    v_smfmac_f32_16x16x64_bf16 v[0:3], v[20:23], v[56:63], v64
    ds_read_b128 v[44:47], v70 offset:35840
    ds_read_b128 v[56:59], v72 offset:12288
    v_smfmac_f32_16x16x64_bf16 v[24:27], v[20:23], v[48:55], v64
    ds_read_b128 v[60:63], v72 offset:13312
    s_waitcnt lgkmcnt(4)
    v_smfmac_f32_16x16x64_bf16 v[0:3], v[28:31], v[32:39], v64
    s_waitcnt lgkmcnt(2)
    s_nop 1
    v_smfmac_f32_16x16x64_bf16 v[24:27], v[28:31], v[40:47], v64
    s_waitcnt lgkmcnt(0)
    s_nop 1
    v_smfmac_f32_16x16x64_bf16 v[4:7], v[56:59], v[144:151], v64
    v_cvt_pk_bf16_f32 v0, v0, v1
    v_cvt_pk_bf16_f32 v1, v2, v3
    v_and_or_b32 v0, v0, -2, s69
    s_nop 0
    v_cvt_pk_bf16_f32 v2, v24, v25
    v_cvt_pk_bf16_f32 v3, v26, v27
    v_smfmac_f32_16x16x64_bf16 v[4:7], v[60:63], v[152:159], v64
    buffer_store_dwordx4 v[0:3], v74, s[4:7], s23 offen sc1
    s_nop 6
    v_cvt_pk_bf16_f32 v4, v4, v5
    v_cvt_pk_bf16_f32 v5, v6, v7
    v_and_or_b32 v4, v4, -2, s69
    buffer_store_dwordx2 v[4:5], v77, s[4:7], s25 offen sc1
    s_cbranch_scc1 cs_e1
    s_nop 2
    v_mov_b32 v79, v79
    s_nop 2
    v_mov_b32 v79, v79
    s_nop 2
    v_mov_b32 v79, v79
    s_nop 2
    v_mov_b32 v79, v79
    s_nop 2
    v_mov_b32 v79, v79
    s_nop 2
    v_mov_b32 v79, v79
    s_nop 2
    v_mov_b32 v79, v79
    s_nop 2
    v_mov_b32 v79, v79
    s_nop 2
    v_mov_b32 v79, v79
    s_nop 2
    v_mov_b32 v79, v79
    s_nop 2
    v_mov_b32 v79, v79
    s_nop 2
    v_mov_b32 v79, v79
    s_nop 2
    v_mov_b32 v79, v79
    s_nop 2
    v_mov_b32 v79, v79
    s_nop 2
    v_mov_b32 v79, v79
    s_nop 2
    v_mov_b32 v79, v79
    s_nop 2
    v_mov_b32 v79, v79
    s_nop 2
    v_mov_b32 v79, v79
    s_nop 2
    v_mov_b32 v79, v79
    s_nop 2
    v_mov_b32 v79, v79
    s_nop 2
    v_mov_b32 v79, v79
    s_nop 2
    v_mov_b32 v79, v79
    s_nop 2
    v_mov_b32 v79, v79
    s_nop 2
    v_mov_b32 v79, v79
    s_nop 2
    v_mov_b32 v79, v79
    s_nop 2
    v_mov_b32 v79, v79
    s_nop 2
    v_mov_b32 v79, v79
    s_nop 2
    v_mov_b32 v79, v79
    s_nop 2
    v_mov_b32 v79, v79
    s_nop 2
    v_mov_b32 v79, v79
    s_nop 2
    v_mov_b32 v79, v79
    s_nop 2
    v_mov_b32 v79, v79
    s_nop 2
    v_mov_b32 v79, v79
    s_nop 2
    v_mov_b32 v79, v79
    s_nop 2
    v_mov_b32 v79, v79
    s_nop 2
    v_mov_b32 v79, v79
    s_nop 2
    v_mov_b32 v79, v79
    s_nop 0
    v_mov_b32 v79, v79
    buffer_load_dwordx4 v[8:11], v65, s[4:7], s18 offen sc1
    buffer_load_dwordx4 v[12:15], v65, s[4:7], s19 offen sc1
    buffer_load_dwordx4 v[16:19], v65, s[4:7], s20 offen sc1
    buffer_load_dwordx4 v[20:23], v65, s[4:7], s21 offen sc1
    v_and_b32 v77, 255, v69
    ds_read_b128 v[4:7], v77 offset:15872
    ds_read_b128 v[40:43], v70 offset:0
    ds_read_b128 v[44:47], v70 offset:1024
    ds_read_b128 v[48:51], v70 offset:2048
    ds_read_b128 v[52:55], v70 offset:3072
    ds_read_b128 v[24:27], v70 offset:4096
    ds_read_b128 v[28:31], v70 offset:5120
    ds_read_b128 v[32:35], v70 offset:6144
    ds_read_b128 v[36:39], v70 offset:7168
    s_mov_b32 s31, 65536
    s_add_u32 s24, s24, 524288
    s_add_u32 s26, s26, 524288
    s_add_u32 s55, s55, s57
    s_mov_b32 s14, 67633152
    s_mov_b32 s15, 67637248
    s_mov_b32 s16, 67641344
    s_mov_b32 s36, 1
    v_mov_b32 v60, s69
    v_mov_b32 v56, s69
    v_and_b32 v79, 12, v75
    v_cmp_eq_u32 vcc, 0, v79
    s_nop 1
    v_cndmask_b32 v79, 0, 1, vcc
    s_waitcnt lgkmcnt(0)
    s_waitcnt vmcnt(3)
    v_xor_b32 v77, s69, v8
    v_mfma_f32_16x16x32_bf16 v[0:3], v[4:7], v[8:11], 0
    v_mov_b64 v[8:9], 0
    v_mov_b64 v[10:11], 0
    s_waitcnt vmcnt(2)
    v_bitop3_b32 v77, v77, v12, s69 bitop3:0xf6
    v_mfma_f32_16x16x32_bf16 v[0:3], v[4:7], v[12:15], v[0:3]
    v_mov_b64 v[12:13], 0
    v_mov_b64 v[14:15], 0
    s_waitcnt vmcnt(1)
    v_bitop3_b32 v77, v77, v16, s69 bitop3:0xf6
    v_mfma_f32_16x16x32_bf16 v[0:3], v[4:7], v[16:19], v[0:3]
    v_mov_b64 v[16:17], 0
    v_mov_b64 v[18:19], 0
    s_waitcnt vmcnt(0)
    v_bitop3_b32 v77, v77, v20, s69 bitop3:0xf6
    v_mfma_f32_16x16x32_bf16 v[0:3], v[4:7], v[20:23], v[0:3]
    v_and_b32 v77, 1, v77
    v_cmp_ne_u32 vcc, 0, v77
    v_mov_b64 v[20:21], 0
    v_mov_b64 v[22:23], 0
    s_cmp_eq_u64 vcc, 0
    s_cselect_b64 s[42:43], -1, 0
    s_nop 1
    v_add_f32_dpp v0, v0, v0 row_ror:8 row_mask:0xf bank_mask:0xf
    v_add_f32_dpp v1, v1, v1 row_ror:8 row_mask:0xf bank_mask:0xf
    s_mov_b64 exec, s[42:43]
    v_cvt_pk_bf16_f32 v72, v0, v1
    v_bfi_b32 v72, v79, s70, v72
    buffer_store_dword v72, v75, s[4:7], s17 offen offset:0 sc1
    s_mov_b64 exec, -1
    s_cbranch_scc0 cs_f0_retry
cs_f0_go:
    v_mov_b64 v[0:1], 0
    v_mov_b64 v[2:3], 0
    v_mov_b64 v[4:5], 0
    v_mov_b64 v[6:7], 0
    s_nop 2
    v_mov_b32 v79, v79
    s_nop 2
    v_mov_b32 v79, v79
    s_nop 2
    v_mov_b32 v79, v79
    s_nop 2
    v_mov_b32 v79, v79
    s_nop 2
    v_mov_b32 v79, v79
    s_nop 2
    v_mov_b32 v79, v79
    s_nop 2
    v_mov_b32 v79, v79
    s_nop 2
    v_mov_b32 v79, v79
    s_nop 2
    v_mov_b32 v79, v79
    s_nop 2
    v_mov_b32 v79, v79
    s_nop 2
    v_mov_b32 v79, v79
    s_nop 2
    v_mov_b32 v79, v79
    s_nop 2
    v_mov_b32 v79, v79
    s_nop 2
    v_mov_b32 v79, v79
    s_nop 2
    v_mov_b32 v79, v79
    s_nop 2
    v_mov_b32 v79, v79
    s_nop 2
    v_mov_b32 v79, v79
    s_nop 2
    v_mov_b32 v79, v79
    s_nop 2
    v_mov_b32 v79, v79
    s_nop 2
    v_mov_b32 v79, v79
    s_nop 2
    v_mov_b32 v79, v79
    s_nop 2
    v_mov_b32 v79, v79
    s_nop 2
    v_mov_b32 v79, v79
    s_nop 2
    v_mov_b32 v79, v79
    s_nop 2
    v_mov_b32 v79, v79
    s_branch cs_loop
cs_e1:
    s_cmp_lg_u32 s71, 2
    s_cbranch_scc1 cs_f1
    v_and_b32 v77, 255, v69
    ds_read_b128 v[4:7], v77 offset:15872
    ds_read_b128 v[40:43], v70 offset:0
    ds_read_b128 v[44:47], v70 offset:1024
    ds_read_b128 v[48:51], v70 offset:2048
    ds_read_b128 v[52:55], v70 offset:3072
    ds_read_b128 v[24:27], v70 offset:4096
    ds_read_b128 v[28:31], v70 offset:5120
    ds_read_b128 v[32:35], v70 offset:6144
    ds_read_b128 v[36:39], v70 offset:7168
    s_mov_b32 s31, 65536
    s_add_u32 s24, s24, 524288
    s_add_u32 s26, s26, 524288
    s_add_u32 s55, s55, s57
    s_mov_b32 s14, 67633152
    s_mov_b32 s15, 67637248
    s_mov_b32 s16, 67641344
    s_mov_b32 s36, 1
    v_mov_b32 v60, s69
    v_mov_b32 v56, s69
    v_and_b32 v79, 12, v75
    v_cmp_eq_u32 vcc, 0, v79
    s_nop 1
    v_cndmask_b32 v79, 0, 1, vcc
    s_nop 2
    v_mov_b32 v79, v79
    s_nop 2
    v_mov_b32 v79, v79
    s_nop 2
    v_mov_b32 v79, v79
    s_nop 2
    v_mov_b32 v79, v79
    s_nop 2
    v_mov_b32 v79, v79
    s_nop 2
    v_mov_b32 v79, v79
    s_nop 2
    v_mov_b32 v79, v79
    s_nop 2
    v_mov_b32 v79, v79
    s_nop 2
    v_mov_b32 v79, v79
    s_nop 2
    v_mov_b32 v79, v79
    s_nop 2
    v_mov_b32 v79, v79
    s_nop 2
    v_mov_b32 v79, v79
    s_nop 2
    v_mov_b32 v79, v79
    s_nop 2
    v_mov_b32 v79, v79
    s_nop 2
    v_mov_b32 v79, v79
    s_nop 2
    v_mov_b32 v79, v79
    s_nop 2
    v_mov_b32 v79, v79
    s_nop 2
    v_mov_b32 v79, v79
    s_nop 2
    v_mov_b32 v79, v79
    s_nop 2
    v_mov_b32 v79, v79
    s_nop 2
    v_mov_b32 v79, v79
    s_nop 2
    v_mov_b32 v79, v79
    s_nop 2
    v_mov_b32 v79, v79
    s_nop 2
    v_mov_b32 v79, v79
    s_nop 2
    v_mov_b32 v79, v79
    s_nop 2
    v_mov_b32 v79, v79
    s_nop 2
    v_mov_b32 v79, v79
    s_nop 2
    v_mov_b32 v79, v79
    s_nop 2
    v_mov_b32 v79, v79
    s_nop 2
    v_mov_b32 v79, v79
    s_nop 2
    v_mov_b32 v79, v79
    s_nop 2
    v_mov_b32 v79, v79
    s_nop 2
    v_mov_b32 v79, v79
    s_nop 2
    v_mov_b32 v79, v79
    s_nop 2
    v_mov_b32 v79, v79
    s_nop 2
    v_mov_b32 v79, v79
    s_nop 2
    v_mov_b32 v79, v79
    s_nop 0
    v_mov_b32 v79, v79
    s_waitcnt vmcnt(0)
    buffer_load_dwordx4 v[8:11], v65, s[4:7], s18 offen sc1
    buffer_load_dwordx4 v[12:15], v65, s[4:7], s19 offen sc1
    buffer_load_dwordx4 v[16:19], v65, s[4:7], s20 offen sc1
    buffer_load_dwordx4 v[20:23], v65, s[4:7], s21 offen sc1
    s_nop 2
    v_mov_b32 v79, v79
    s_nop 2
    v_mov_b32 v79, v79
    s_nop 2
    v_mov_b32 v79, v79
    s_nop 2
    v_mov_b32 v79, v79
    s_nop 2
    v_mov_b32 v79, v79
    s_nop 2
    v_mov_b32 v79, v79
    s_nop 2
    v_mov_b32 v79, v79
    s_nop 2
    v_mov_b32 v79, v79
    s_nop 2
    v_mov_b32 v79, v79
    s_nop 2
    v_mov_b32 v79, v79
    buffer_load_dwordx4 v[60:63], v65, s[4:7], s14 offen offset:0 sc1
    buffer_load_dwordx4 v[56:59], v66, s[4:7], s14 offen offset:0 sc1
    s_waitcnt lgkmcnt(0)
    s_waitcnt vmcnt(5)
    v_xor_b32 v77, s69, v8
    v_bitop3_b32 v77, v77, v10, s69 bitop3:0xf6
    v_mfma_f32_16x16x32_bf16 v[0:3], v[4:7], v[8:11], 0
    v_mov_b64 v[8:9], 0
    v_mov_b64 v[10:11], 0
    s_waitcnt vmcnt(4)
    v_bitop3_b32 v77, v77, v12, s69 bitop3:0xf6
    v_bitop3_b32 v77, v77, v14, s69 bitop3:0xf6
    v_mfma_f32_16x16x32_bf16 v[0:3], v[4:7], v[12:15], v[0:3]
    v_mov_b64 v[12:13], 0
    v_mov_b64 v[14:15], 0
    s_waitcnt vmcnt(3)
    v_bitop3_b32 v77, v77, v16, s69 bitop3:0xf6
    v_bitop3_b32 v77, v77, v18, s69 bitop3:0xf6
    v_mfma_f32_16x16x32_bf16 v[0:3], v[4:7], v[16:19], v[0:3]
    v_mov_b64 v[16:17], 0
    v_mov_b64 v[18:19], 0
    s_waitcnt vmcnt(2)
    v_bitop3_b32 v77, v77, v20, s69 bitop3:0xf6
    v_bitop3_b32 v77, v77, v22, s69 bitop3:0xf6
    v_mfma_f32_16x16x32_bf16 v[0:3], v[4:7], v[20:23], v[0:3]
    v_and_b32 v77, 1, v77
    v_cmp_ne_u32 vcc, 0, v77
    v_mov_b64 v[20:21], 0
    v_mov_b64 v[22:23], 0
    buffer_load_dwordx4 v[60:63], v65, s[4:7], s14 offen offset:0 sc1
    buffer_load_dwordx4 v[56:59], v66, s[4:7], s14 offen offset:0 sc1
    s_cmp_eq_u64 vcc, 0
    s_cselect_b64 s[42:43], -1, 0
    v_add_f32 v2, v0, v1
    s_nop 1
    v_add_f32_dpp v2, v2, v2 row_ror:8 row_mask:0xf bank_mask:0xf
    s_nop 1
    v_mov_b32_dpp v0, v2 quad_perm:[0,0,2,2] row_mask:0xf bank_mask:0xf
    v_mov_b32_dpp v1, v2 quad_perm:[1,1,3,3] row_mask:0xf bank_mask:0xf
    s_mov_b64 exec, s[42:43]
    v_cvt_pk_bf16_f32 v72, v0, v1
    v_bfi_b32 v72, v79, s70, v72
    buffer_store_dword v72, v75, s[4:7], s17 offen offset:0 sc1
    buffer_store_dword v72, v75, s[4:7], s17 offen offset:1024 sc1
    buffer_store_dword v72, v75, s[4:7], s17 offen offset:2048 sc1
    buffer_store_dword v72, v75, s[4:7], s17 offen offset:3072 sc1
    s_mov_b64 exec, -1
    s_cbranch_scc0 cs_f2_retry
cs_f2_go:
    v_mov_b64 v[0:1], 0
    v_mov_b64 v[2:3], 0
    v_mov_b64 v[4:5], 0
    v_mov_b64 v[6:7], 0
    s_nop 2
    v_mov_b32 v79, v79
    s_nop 2
    v_mov_b32 v79, v79
    s_nop 2
    v_mov_b32 v79, v79
    s_nop 2
    v_mov_b32 v79, v79
    s_nop 2
    v_mov_b32 v79, v79
    s_nop 2
    v_mov_b32 v79, v79
    s_nop 2
    v_mov_b32 v79, v79
    s_nop 2
    v_mov_b32 v79, v79
    s_nop 2
    v_mov_b32 v79, v79
    s_nop 2
    v_mov_b32 v79, v79
    s_nop 2
    v_mov_b32 v79, v79
    s_nop 2
    v_mov_b32 v79, v79
    s_nop 2
    v_mov_b32 v79, v79
    s_nop 2
    v_mov_b32 v79, v79
    s_nop 2
    v_mov_b32 v79, v79
    s_nop 2
    v_mov_b32 v79, v79
    s_nop 2
    v_mov_b32 v79, v79
    s_nop 2
    v_mov_b32 v79, v79
    s_nop 2
    v_mov_b32 v79, v79
    s_nop 2
    v_mov_b32 v79, v79
    s_nop 2
    v_mov_b32 v79, v79
    s_nop 2
    v_mov_b32 v79, v79
    s_nop 2
    v_mov_b32 v79, v79
    s_nop 2
    v_mov_b32 v79, v79
    s_nop 2
    v_mov_b32 v79, v79
    s_branch cs_loop
cs_f1:
    s_cmp_lg_u32 s32, 1
    s_cbranch_scc1 cs_f3
    v_and_b32 v77, 255, v69
    ds_read_b128 v[4:7], v77 offset:15872
    ds_read_b128 v[40:43], v70 offset:0
    ds_read_b128 v[44:47], v70 offset:1024
    ds_read_b128 v[48:51], v70 offset:2048
    ds_read_b128 v[52:55], v70 offset:3072
    ds_read_b128 v[24:27], v70 offset:4096
    ds_read_b128 v[28:31], v70 offset:5120
    ds_read_b128 v[32:35], v70 offset:6144
    ds_read_b128 v[36:39], v70 offset:7168
    s_mov_b32 s31, 65536
    s_add_u32 s24, s24, 524288
    s_add_u32 s26, s26, 524288
    s_add_u32 s55, s55, s57
    s_mov_b32 s14, 67633152
    s_mov_b32 s15, 67637248
    s_mov_b32 s16, 67641344
    s_mov_b32 s36, 1
    v_mov_b32 v60, s69
    v_mov_b32 v56, s69
    v_and_b32 v79, 12, v75
    v_cmp_eq_u32 vcc, 0, v79
    s_nop 1
    v_cndmask_b32 v79, 0, 1, vcc
    s_nop 2
    v_mov_b32 v79, v79
    s_nop 2
    v_mov_b32 v79, v79
    s_nop 2
    v_mov_b32 v79, v79
    s_nop 2
    v_mov_b32 v79, v79
    s_nop 2
    v_mov_b32 v79, v79
    s_nop 2
    v_mov_b32 v79, v79
    s_nop 2
    v_mov_b32 v79, v79
    s_nop 2
    v_mov_b32 v79, v79
    s_nop 2
    v_mov_b32 v79, v79
    s_nop 2
    v_mov_b32 v79, v79
    s_nop 2
    v_mov_b32 v79, v79
    s_nop 2
    v_mov_b32 v79, v79
    s_nop 2
    v_mov_b32 v79, v79
    s_nop 2
    v_mov_b32 v79, v79
    s_nop 2
    v_mov_b32 v79, v79
    s_nop 2
    v_mov_b32 v79, v79
    s_nop 2
    v_mov_b32 v79, v79
    s_nop 2
    v_mov_b32 v79, v79
    s_nop 2
    v_mov_b32 v79, v79
    s_nop 2
    v_mov_b32 v79, v79
    s_nop 2
    v_mov_b32 v79, v79
    s_nop 2
    v_mov_b32 v79, v79
    s_nop 2
    v_mov_b32 v79, v79
    s_nop 2
    v_mov_b32 v79, v79
    s_nop 2
    v_mov_b32 v79, v79
    s_nop 2
    v_mov_b32 v79, v79
    s_nop 2
    v_mov_b32 v79, v79
    s_nop 2
    v_mov_b32 v79, v79
    s_nop 2
    v_mov_b32 v79, v79
    s_nop 2
    v_mov_b32 v79, v79
    s_nop 2
    v_mov_b32 v79, v79
    s_nop 2
    v_mov_b32 v79, v79
    s_nop 2
    v_mov_b32 v79, v79
    s_nop 2
    v_mov_b32 v79, v79
    s_nop 2
    v_mov_b32 v79, v79
    s_nop 2
    v_mov_b32 v79, v79
    s_nop 2
    v_mov_b32 v79, v79
    s_nop 0
    v_mov_b32 v79, v79
    s_waitcnt vmcnt(0)
    buffer_load_dwordx4 v[8:11], v65, s[4:7], s18 offen sc1
    buffer_load_dwordx4 v[12:15], v65, s[4:7], s19 offen sc1
    buffer_load_dwordx4 v[16:19], v65, s[4:7], s20 offen sc1
    buffer_load_dwordx4 v[20:23], v65, s[4:7], s21 offen sc1
    s_nop 2
    v_mov_b32 v79, v79
    s_nop 2
    v_mov_b32 v79, v79
    s_nop 2
    v_mov_b32 v79, v79
    s_nop 2
    v_mov_b32 v79, v79
    s_nop 2
    v_mov_b32 v79, v79
    s_nop 2
    v_mov_b32 v79, v79
    s_nop 2
    v_mov_b32 v79, v79
    s_nop 2
    v_mov_b32 v79, v79
    s_nop 2
    v_mov_b32 v79, v79
    s_nop 2
    v_mov_b32 v79, v79
    buffer_load_dwordx4 v[60:63], v65, s[4:7], s14 offen offset:0 sc1
    buffer_load_dwordx4 v[56:59], v66, s[4:7], s14 offen offset:0 sc1
    s_waitcnt lgkmcnt(0)
    s_waitcnt vmcnt(5)
    v_xor_b32 v77, s69, v8
    v_mfma_f32_16x16x32_bf16 v[0:3], v[4:7], v[8:11], 0
    v_mov_b64 v[8:9], 0
    v_mov_b64 v[10:11], 0
    s_waitcnt vmcnt(4)
    v_bitop3_b32 v77, v77, v12, s69 bitop3:0xf6
    v_mfma_f32_16x16x32_bf16 v[0:3], v[4:7], v[12:15], v[0:3]
    v_mov_b64 v[12:13], 0
    v_mov_b64 v[14:15], 0
    s_waitcnt vmcnt(3)
    v_bitop3_b32 v77, v77, v16, s69 bitop3:0xf6
    v_mfma_f32_16x16x32_bf16 v[0:3], v[4:7], v[16:19], v[0:3]
    v_mov_b64 v[16:17], 0
    v_mov_b64 v[18:19], 0
    s_waitcnt vmcnt(2)
    v_bitop3_b32 v77, v77, v20, s69 bitop3:0xf6
    v_mfma_f32_16x16x32_bf16 v[0:3], v[4:7], v[20:23], v[0:3]
    v_and_b32 v77, 1, v77
    v_cmp_ne_u32 vcc, 0, v77
    v_mov_b64 v[20:21], 0
    v_mov_b64 v[22:23], 0
    buffer_load_dwordx4 v[60:63], v65, s[4:7], s14 offen offset:0 sc1
    buffer_load_dwordx4 v[56:59], v66, s[4:7], s14 offen offset:0 sc1
    s_cmp_eq_u64 vcc, 0
    s_cselect_b64 s[42:43], -1, 0
    v_add_f32_dpp v0, v0, v0 row_ror:8 row_mask:0xf bank_mask:0xf
    v_add_f32_dpp v1, v1, v1 row_ror:8 row_mask:0xf bank_mask:0xf
    s_mov_b64 exec, s[42:43]
    v_cvt_pk_bf16_f32 v72, v0, v1
    v_bfi_b32 v72, v79, s70, v72
    buffer_store_dword v72, v75, s[4:7], s17 offen offset:0 sc1
    s_mov_b64 exec, -1
    s_cbranch_scc0 cs_f1_retry
cs_f1_go:
    v_mov_b64 v[0:1], 0
    v_mov_b64 v[2:3], 0
    v_mov_b64 v[4:5], 0
    v_mov_b64 v[6:7], 0
    s_nop 2
    v_mov_b32 v79, v79
    s_nop 2
    v_mov_b32 v79, v79
    s_nop 2
    v_mov_b32 v79, v79
    s_nop 2
    v_mov_b32 v79, v79
    s_nop 2
    v_mov_b32 v79, v79
    s_nop 2
    v_mov_b32 v79, v79
    s_nop 2
    v_mov_b32 v79, v79
    s_nop 2
    v_mov_b32 v79, v79
    s_nop 2
    v_mov_b32 v79, v79
    s_nop 2
    v_mov_b32 v79, v79
    s_nop 2
    v_mov_b32 v79, v79
    s_nop 2
    v_mov_b32 v79, v79
    s_nop 2
    v_mov_b32 v79, v79
    s_nop 2
    v_mov_b32 v79, v79
    s_nop 2
    v_mov_b32 v79, v79
    s_nop 2
    v_mov_b32 v79, v79
    s_nop 2
    v_mov_b32 v79, v79
    s_nop 2
    v_mov_b32 v79, v79
    s_nop 2
    v_mov_b32 v79, v79
    s_nop 2
    v_mov_b32 v79, v79
    s_nop 2
    v_mov_b32 v79, v79
    s_nop 2
    v_mov_b32 v79, v79
    s_nop 2
    v_mov_b32 v79, v79
    s_nop 2
    v_mov_b32 v79, v79
    s_nop 2
    v_mov_b32 v79, v79
    s_branch cs_loop
cs_f3:
    v_and_b32 v77, 255, v69
    ds_read_b128 v[4:7], v77 offset:15872
    ds_read_b128 v[40:43], v70 offset:0
    ds_read_b128 v[44:47], v70 offset:1024
    ds_read_b128 v[48:51], v70 offset:2048
    ds_read_b128 v[52:55], v70 offset:3072
    ds_read_b128 v[24:27], v70 offset:4096
    ds_read_b128 v[28:31], v70 offset:5120
    ds_read_b128 v[32:35], v70 offset:6144
    ds_read_b128 v[36:39], v70 offset:7168
    s_mov_b32 s31, 65536
    s_add_u32 s24, s24, 524288
    s_add_u32 s26, s26, 524288
    s_add_u32 s55, s55, s57
    s_mov_b32 s14, 67633152
    s_mov_b32 s15, 67637248
    s_mov_b32 s16, 67641344
    s_mov_b32 s36, 1
    v_mov_b32 v60, s69
    v_mov_b32 v56, s69
    v_and_b32 v79, 12, v75
    v_cmp_eq_u32 vcc, 0, v79
    s_nop 1
    v_cndmask_b32 v79, 0, 1, vcc
    s_add_u32 s40, s30, s95
    v_mov_b32 v72, s40
    s_waitcnt lgkmcnt(0)
    v_mov_b64 v[0:1], 0
    v_mov_b64 v[2:3], 0
    v_mov_b64 v[4:5], 0
    v_mov_b64 v[6:7], 0
    v_mov_b64 v[8:9], 0
    v_mov_b64 v[10:11], 0
    v_mov_b64 v[12:13], 0
    v_mov_b64 v[14:15], 0
    v_mov_b64 v[16:17], 0
    v_mov_b64 v[18:19], 0
    v_mov_b64 v[20:21], 0
    v_mov_b64 v[22:23], 0
    s_nop 2
    v_mov_b32 v79, v79
    s_nop 2
    v_mov_b32 v79, v79
    s_nop 2
    v_mov_b32 v79, v79
    s_nop 2
    v_mov_b32 v79, v79
    s_nop 2
    v_mov_b32 v79, v79
    s_nop 2
    v_mov_b32 v79, v79
    s_nop 2
    v_mov_b32 v79, v79
    s_nop 2
    v_mov_b32 v79, v79
    s_nop 2
    v_mov_b32 v79, v79
    s_nop 2
    v_mov_b32 v79, v79
    s_nop 2
    v_mov_b32 v79, v79
    s_nop 2
    v_mov_b32 v79, v79
    s_nop 2
    v_mov_b32 v79, v79
    s_nop 2
    v_mov_b32 v79, v79
    s_nop 2
    v_mov_b32 v79, v79
    s_nop 2
    v_mov_b32 v79, v79
    s_nop 2
    v_mov_b32 v79, v79
    s_nop 2
    v_mov_b32 v79, v79
    s_nop 2
    v_mov_b32 v79, v79
    s_nop 2
    v_mov_b32 v79, v79
    s_nop 2
    v_mov_b32 v79, v79
    s_nop 2
    v_mov_b32 v79, v79
    s_nop 2
    v_mov_b32 v79, v79
    s_nop 2
    v_mov_b32 v79, v79
    s_nop 2
    v_mov_b32 v79, v79
    s_nop 2
    v_mov_b32 v79, v79
    s_nop 2
    v_mov_b32 v79, v79
    s_nop 2
    v_mov_b32 v79, v79
    s_nop 2
    v_mov_b32 v79, v79
    s_nop 2
    v_mov_b32 v79, v79
    s_nop 2
    v_mov_b32 v79, v79
    s_nop 2
    v_mov_b32 v79, v79
    s_nop 2
    v_mov_b32 v79, v79
    s_nop 2
    v_mov_b32 v79, v79
    s_nop 2
    v_mov_b32 v79, v79
    s_nop 2
    v_mov_b32 v79, v79
    s_nop 2
    v_mov_b32 v79, v79
    s_nop 2
    v_mov_b32 v79, v79
    s_nop 2
    v_mov_b32 v79, v79
    s_nop 2
    v_mov_b32 v79, v79
    s_nop 2
    v_mov_b32 v79, v79
    s_nop 2
    v_mov_b32 v79, v79
    s_nop 2
    v_mov_b32 v79, v79
    s_nop 2
    v_mov_b32 v79, v79
    s_nop 2
    v_mov_b32 v79, v79
    s_nop 2
    v_mov_b32 v79, v79
    s_nop 2
    v_mov_b32 v79, v79
    s_nop 2
    v_mov_b32 v79, v79
    s_nop 2
    v_mov_b32 v79, v79
    s_nop 2
    v_mov_b32 v79, v79
    s_nop 2
    v_mov_b32 v79, v79
    s_nop 2
    v_mov_b32 v79, v79
    s_nop 2
    v_mov_b32 v79, v79
    s_nop 2
    v_mov_b32 v79, v79
    s_nop 2
    v_mov_b32 v79, v79
    s_nop 2
    v_mov_b32 v79, v79
    s_nop 2
    v_mov_b32 v79, v79
    s_nop 2
    v_mov_b32 v79, v79
    s_nop 2
    v_mov_b32 v79, v79
    s_nop 2
    v_mov_b32 v79, v79
    s_nop 2
    v_mov_b32 v79, v79
    s_nop 2
    v_mov_b32 v79, v79
    s_nop 2
    v_mov_b32 v79, v79
    s_nop 2
    v_mov_b32 v79, v79
    s_nop 2
    v_mov_b32 v79, v79
    s_waitcnt vmcnt(0)
    s_cmp_lt_u32 s97, s93
    s_cbranch_scc1 cs_kvwait
    s_nop 2
    v_mov_b32 v79, v79
    s_nop 2
    v_mov_b32 v79, v79
    s_nop 2
    v_mov_b32 v79, v79
    s_nop 2
    v_mov_b32 v79, v79
    s_nop 2
    v_mov_b32 v79, v79
    s_nop 2
    v_mov_b32 v79, v79
    s_nop 2
    v_mov_b32 v79, v79
    s_nop 2
    v_mov_b32 v79, v79
cs_kvok:
    s_branch cs_loop
cs_f0_retry:
cs_f0_spin:
    s_nop 0
    buffer_load_dwordx4 v[8:11], v65, s[4:7], s18 offen sc1
    buffer_load_dwordx4 v[12:15], v65, s[4:7], s19 offen sc1
    buffer_load_dwordx4 v[16:19], v65, s[4:7], s20 offen sc1
    buffer_load_dwordx4 v[20:23], v65, s[4:7], s21 offen sc1
    s_nop 2
    v_mov_b32 v79, v79
    s_nop 2
    v_mov_b32 v79, v79
    s_nop 2
    v_mov_b32 v79, v79
    s_nop 2
    v_mov_b32 v79, v79
    s_nop 2
    v_mov_b32 v79, v79
    s_nop 2
    v_mov_b32 v79, v79
    buffer_load_dwordx4 v[60:63], v65, s[4:7], s14 offen offset:0 sc1
    buffer_load_dwordx4 v[56:59], v66, s[4:7], s14 offen offset:0 sc1
    s_waitcnt vmcnt(5)
    v_xor_b32 v77, s69, v8
    v_mfma_f32_16x16x32_bf16 v[0:3], v[4:7], v[8:11], 0
    v_mov_b64 v[8:9], 0
    v_mov_b64 v[10:11], 0
    s_waitcnt vmcnt(4)
    v_bitop3_b32 v77, v77, v12, s69 bitop3:0xf6
    v_mfma_f32_16x16x32_bf16 v[0:3], v[4:7], v[12:15], v[0:3]
    v_mov_b64 v[12:13], 0
    v_mov_b64 v[14:15], 0
    s_waitcnt vmcnt(3)
    v_bitop3_b32 v77, v77, v16, s69 bitop3:0xf6
    v_mfma_f32_16x16x32_bf16 v[0:3], v[4:7], v[16:19], v[0:3]
    v_mov_b64 v[16:17], 0
    v_mov_b64 v[18:19], 0
    s_waitcnt vmcnt(2)
    v_bitop3_b32 v77, v77, v20, s69 bitop3:0xf6
    v_mfma_f32_16x16x32_bf16 v[0:3], v[4:7], v[20:23], v[0:3]
    v_and_b32 v77, 1, v77
    v_cmp_ne_u32 vcc, 0, v77
    v_mov_b64 v[20:21], 0
    v_mov_b64 v[22:23], 0
    buffer_load_dwordx4 v[60:63], v65, s[4:7], s14 offen offset:0 sc1
    buffer_load_dwordx4 v[56:59], v66, s[4:7], s14 offen offset:0 sc1
    s_cmp_eq_u64 vcc, 0
    s_cselect_b64 s[42:43], -1, 0
    v_add_f32_dpp v0, v0, v0 row_ror:8 row_mask:0xf bank_mask:0xf
    v_add_f32_dpp v1, v1, v1 row_ror:8 row_mask:0xf bank_mask:0xf
    s_mov_b64 exec, s[42:43]
    v_cvt_pk_bf16_f32 v72, v0, v1
    v_bfi_b32 v72, v79, s70, v72
    buffer_store_dword v72, v75, s[4:7], s17 offen offset:0 sc1
    s_mov_b64 exec, -1
    s_cbranch_scc1 cs_f0_rx
    s_sub_u32 s31, s31, 1
    s_cbranch_scc0 cs_f0_spin
cs_f0_rx:
    v_mov_b64 v[0:1], 0
    v_mov_b64 v[2:3], 0
    v_mov_b64 v[4:5], 0
    v_mov_b64 v[6:7], 0
    s_branch cs_loop
cs_f1_retry:
cs_f1_spin:
    s_nop 0
    buffer_load_dwordx4 v[8:11], v65, s[4:7], s18 offen sc1
    buffer_load_dwordx4 v[12:15], v65, s[4:7], s19 offen sc1
    buffer_load_dwordx4 v[16:19], v65, s[4:7], s20 offen sc1
    buffer_load_dwordx4 v[20:23], v65, s[4:7], s21 offen sc1
    s_nop 2
    v_mov_b32 v79, v79
    s_nop 2
    v_mov_b32 v79, v79
    s_nop 2
    v_mov_b32 v79, v79
    s_nop 2
    v_mov_b32 v79, v79
    s_nop 2
    v_mov_b32 v79, v79
    s_nop 2
    v_mov_b32 v79, v79
    buffer_load_dwordx4 v[60:63], v65, s[4:7], s14 offen offset:0 sc1
    buffer_load_dwordx4 v[56:59], v66, s[4:7], s14 offen offset:0 sc1
    s_waitcnt vmcnt(5)
    v_xor_b32 v77, s69, v8
    v_mfma_f32_16x16x32_bf16 v[0:3], v[4:7], v[8:11], 0
    v_mov_b64 v[8:9], 0
    v_mov_b64 v[10:11], 0
    s_waitcnt vmcnt(4)
    v_bitop3_b32 v77, v77, v12, s69 bitop3:0xf6
    v_mfma_f32_16x16x32_bf16 v[0:3], v[4:7], v[12:15], v[0:3]
    v_mov_b64 v[12:13], 0
    v_mov_b64 v[14:15], 0
    s_waitcnt vmcnt(3)
    v_bitop3_b32 v77, v77, v16, s69 bitop3:0xf6
    v_mfma_f32_16x16x32_bf16 v[0:3], v[4:7], v[16:19], v[0:3]
    v_mov_b64 v[16:17], 0
    v_mov_b64 v[18:19], 0
    s_waitcnt vmcnt(2)
    v_bitop3_b32 v77, v77, v20, s69 bitop3:0xf6
    v_mfma_f32_16x16x32_bf16 v[0:3], v[4:7], v[20:23], v[0:3]
    v_and_b32 v77, 1, v77
    v_cmp_ne_u32 vcc, 0, v77
    v_mov_b64 v[20:21], 0
    v_mov_b64 v[22:23], 0
    buffer_load_dwordx4 v[60:63], v65, s[4:7], s14 offen offset:0 sc1
    buffer_load_dwordx4 v[56:59], v66, s[4:7], s14 offen offset:0 sc1
    s_cmp_eq_u64 vcc, 0
    s_cselect_b64 s[42:43], -1, 0
    v_add_f32_dpp v0, v0, v0 row_ror:8 row_mask:0xf bank_mask:0xf
    v_add_f32_dpp v1, v1, v1 row_ror:8 row_mask:0xf bank_mask:0xf
    s_mov_b64 exec, s[42:43]
    v_cvt_pk_bf16_f32 v72, v0, v1
    v_bfi_b32 v72, v79, s70, v72
    buffer_store_dword v72, v75, s[4:7], s17 offen offset:0 sc1
    s_mov_b64 exec, -1
    s_cbranch_scc1 cs_f1_rx
    s_sub_u32 s31, s31, 1
    s_cbranch_scc0 cs_f1_spin
cs_f1_rx:
    v_mov_b64 v[0:1], 0
    v_mov_b64 v[2:3], 0
    v_mov_b64 v[4:5], 0
    v_mov_b64 v[6:7], 0
    s_branch cs_loop
cs_f2_retry:
cs_f2_spin:
    s_nop 0
    buffer_load_dwordx4 v[8:11], v65, s[4:7], s18 offen sc1
    buffer_load_dwordx4 v[12:15], v65, s[4:7], s19 offen sc1
    buffer_load_dwordx4 v[16:19], v65, s[4:7], s20 offen sc1
    buffer_load_dwordx4 v[20:23], v65, s[4:7], s21 offen sc1
    s_nop 2
    v_mov_b32 v79, v79
    s_nop 2
    v_mov_b32 v79, v79
    s_nop 2
    v_mov_b32 v79, v79
    s_nop 2
    v_mov_b32 v79, v79
    s_nop 2
    v_mov_b32 v79, v79
    s_nop 2
    v_mov_b32 v79, v79
    buffer_load_dwordx4 v[60:63], v65, s[4:7], s14 offen offset:0 sc1
    buffer_load_dwordx4 v[56:59], v66, s[4:7], s14 offen offset:0 sc1
    s_waitcnt vmcnt(5)
    v_xor_b32 v77, s69, v8
    v_bitop3_b32 v77, v77, v10, s69 bitop3:0xf6
    v_mfma_f32_16x16x32_bf16 v[0:3], v[4:7], v[8:11], 0
    v_mov_b64 v[8:9], 0
    v_mov_b64 v[10:11], 0
    s_waitcnt vmcnt(4)
    v_bitop3_b32 v77, v77, v12, s69 bitop3:0xf6
    v_bitop3_b32 v77, v77, v14, s69 bitop3:0xf6
    v_mfma_f32_16x16x32_bf16 v[0:3], v[4:7], v[12:15], v[0:3]
    v_mov_b64 v[12:13], 0
    v_mov_b64 v[14:15], 0
    s_waitcnt vmcnt(3)
    v_bitop3_b32 v77, v77, v16, s69 bitop3:0xf6
    v_bitop3_b32 v77, v77, v18, s69 bitop3:0xf6
    v_mfma_f32_16x16x32_bf16 v[0:3], v[4:7], v[16:19], v[0:3]
    v_mov_b64 v[16:17], 0
    v_mov_b64 v[18:19], 0
    s_waitcnt vmcnt(2)
    v_bitop3_b32 v77, v77, v20, s69 bitop3:0xf6
    v_bitop3_b32 v77, v77, v22, s69 bitop3:0xf6
    v_mfma_f32_16x16x32_bf16 v[0:3], v[4:7], v[20:23], v[0:3]
    v_and_b32 v77, 1, v77
    v_cmp_ne_u32 vcc, 0, v77
    v_mov_b64 v[20:21], 0
    v_mov_b64 v[22:23], 0
    buffer_load_dwordx4 v[60:63], v65, s[4:7], s14 offen offset:0 sc1
    buffer_load_dwordx4 v[56:59], v66, s[4:7], s14 offen offset:0 sc1
    s_cmp_eq_u64 vcc, 0
    s_cselect_b64 s[42:43], -1, 0
    v_add_f32 v2, v0, v1
    s_nop 1
    v_add_f32_dpp v2, v2, v2 row_ror:8 row_mask:0xf bank_mask:0xf
    s_nop 1
    v_mov_b32_dpp v0, v2 quad_perm:[0,0,2,2] row_mask:0xf bank_mask:0xf
    v_mov_b32_dpp v1, v2 quad_perm:[1,1,3,3] row_mask:0xf bank_mask:0xf
    s_mov_b64 exec, s[42:43]
    v_cvt_pk_bf16_f32 v72, v0, v1
    v_bfi_b32 v72, v79, s70, v72
    buffer_store_dword v72, v75, s[4:7], s17 offen offset:0 sc1
    buffer_store_dword v72, v75, s[4:7], s17 offen offset:1024 sc1
    buffer_store_dword v72, v75, s[4:7], s17 offen offset:2048 sc1
    buffer_store_dword v72, v75, s[4:7], s17 offen offset:3072 sc1
    s_mov_b64 exec, -1
    s_cbranch_scc1 cs_f2_rx
    s_sub_u32 s31, s31, 1
    s_cbranch_scc0 cs_f2_spin
cs_f2_rx:
    v_mov_b64 v[0:1], 0
    v_mov_b64 v[2:3], 0
    v_mov_b64 v[4:5], 0
    v_mov_b64 v[6:7], 0
    s_branch cs_loop
cs_spinB:
    buffer_load_dwordx4 v[40:43], v65, s[4:7], s15 offen sc1
cs_spinB_l:
    v_and_b32 v77, s36, v40
    v_cmp_ne_u32 vcc, s70, v77
    s_cbranch_vccz cs_spinB_x
    s_nop 15
    s_nop 15
    s_nop 15
    s_nop 11
    v_and_b32 v77, s36, v40
    v_cmp_ne_u32 vcc, s70, v77
    s_cbranch_vccz cs_spinB_x
    s_nop 15
    s_nop 15
    s_nop 15
    s_nop 11
    v_and_b32 v77, s36, v40
    v_cmp_ne_u32 vcc, s70, v77
    s_cbranch_vccz cs_spinB_x
    s_nop 15
    s_nop 15
    s_nop 15
    s_nop 11
    buffer_load_dwordx4 v[40:43], v65, s[4:7], s15 offen sc1
    s_sub_u32 s31, s31, 16
    s_cbranch_scc0 cs_spinB_l
cs_spinB_x:
    ds_write_b128 v65, v[40:43] offset:4096
    s_waitcnt lgkmcnt(0)
    s_branch cs_backB
cs_spin8:
    buffer_load_dwordx4 v[60:63], v65, s[4:7], s16 offen sc1
cs_spin8_l:
    v_and_b32 v77, s36, v60
    v_cmp_ne_u32 vcc, s70, v77
    s_cbranch_vccz cs_spin8_x
    s_nop 15
    s_nop 15
    s_nop 15
    s_nop 11
    v_and_b32 v77, s36, v60
    v_cmp_ne_u32 vcc, s70, v77
    s_cbranch_vccz cs_spin8_x
    s_nop 15
    s_nop 15
    s_nop 15
    s_nop 11
    v_and_b32 v77, s36, v60
    v_cmp_ne_u32 vcc, s70, v77
    s_cbranch_vccz cs_spin8_x
    s_nop 15
    s_nop 15
    s_nop 15
    s_nop 11
    buffer_load_dwordx4 v[60:63], v65, s[4:7], s16 offen sc1
    s_sub_u32 s31, s31, 16
    s_cbranch_scc0 cs_spin8_l
cs_spin8_x:
    s_branch cs_back8
cs_rare:
    s_mov_b64 exec, s[34:35]
    buffer_store_dwordx4 v[0:3], v65, s[4:7], s28 offen sc1
    s_mov_b64 exec, -1
    s_nop 3
    v_cvt_pk_bf16_f32 v48, v16, v17
    v_cvt_pk_bf16_f32 v49, v18, v19
    v_cvt_pk_bf16_f32 v50, v20, v21
    v_cvt_pk_bf16_f32 v51, v22, v23
    buffer_store_dwordx4 v[48:51], v65, s[4:7], s27 offen sc1
    s_add_u32 s28, s28, 131072
    s_add_u32 s27, s27, 131072
    s_cmp_eq_u32 s30, 63
    s_cbranch_scc1 cs_last
    s_branch cs_rare_x
cs_kvwait:
    s_mov_b32 s41, s97
    v_bfe_u32 v78, v65, 2, 5
    v_mov_b32 v77, v76
    s_nop 1
    v_permlane32_swap_b32 v76, v77
    v_subrev_u32 v77, s95, v77
    v_cmp_lt_u32 vcc, 16, v77
    s_nop 1
    v_cndmask_b32 v77, v77, 0, vcc
    v_bfe_u32 v79, v78, 2, 2
    v_lshl_add_u32 v77, v77, 2, v79
    s_nop 1
    v_min_u32_dpp v77, v77, v77 row_ror:1 row_mask:0xf bank_mask:0xf
    s_nop 1
    v_min_u32_dpp v77, v77, v77 row_ror:2 row_mask:0xf bank_mask:0xf
    s_nop 1
    v_min_u32_dpp v77, v77, v77 row_ror:4 row_mask:0xf bank_mask:0xf
    s_nop 0
    v_readfirstlane_b32 s97, v77
    s_nop 0
    s_max_u32 s97, s97, s41
    s_add_u32 s40, s30, 3
    s_min_u32 s40, s40, 64
    s_cmp_le_u32 s40, s97
    s_cbranch_scc1 cs_kvw_x
    v_bfe_u32 v78, v65, 2, 5
    s_mov_b32 s31, 4194304
cs_kvw:
    buffer_load_dword v77, v78, s[4:7], s96 offen offset:16 sc1
    s_waitcnt vmcnt(0)
    v_subrev_u32 v77, s95, v77
    v_cmp_lt_u32 vcc, 16, v77
    s_nop 1
    v_cndmask_b32 v77, v77, 0, vcc
    v_bfe_u32 v79, v78, 2, 2
    v_lshl_add_u32 v77, v77, 2, v79
    s_nop 1
    v_min_u32_dpp v77, v77, v77 row_ror:1 row_mask:0xf bank_mask:0xf
    s_nop 1
    v_min_u32_dpp v77, v77, v77 row_ror:2 row_mask:0xf bank_mask:0xf
    s_nop 1
    v_min_u32_dpp v77, v77, v77 row_ror:4 row_mask:0xf bank_mask:0xf
    s_nop 0
    v_readfirstlane_b32 s97, v77
    s_sub_u32 s31, s31, 1
    s_cbranch_scc1 cs_kvw_x
    s_cmp_le_u32 s40, s97
    s_cbranch_scc1 cs_kvw_x
    s_sleep 2
    s_branch cs_kvw
cs_kvw_x:
    s_branch cs_kvok
cs_last:
    s_add_u32 s40, s95, 64
    v_mov_b32 v78, s40
    s_waitcnt vmcnt(0)
    s_barrier
    s_mov_b64 exec, s[100:101]
    buffer_store_dword v78, off, s[4:7], s29 sc1
    s_mov_b64 exec, -1
cs_end:
    s_endpgm
L_xform:
    v_and_b32 v1, 63, v0
    v_and_b32 v2, 15, v1
    v_lshrrev_b32 v3, 4, v1
    v_mov_b32 v7, 0x05040100
    v_mov_b32 v8, 0x07060302
    v_lshrrev_b32 v9, 6, v0
    v_lshlrev_b32 v9, 14, v9
    v_lshlrev_b32 v10, 4, v1
    v_add_u32 v11, v9, v10
    s_mov_b32 s10, 4718592
    s_mov_b32 s11, 0x20000
    s_mov_b64 s[8:9], s[58:59]
xf_f:
    s_sub_u32 s17, s16, 1504
    s_and_b32 s18, s17, 127
    s_lshr_b32 s17, s17, 7
    s_lshl_b32 s19, s17, 4
    v_add_u32 v6, s19, v2
    v_mul_u32_u24 v4, 9216, v3
    v_lshl_add_u32 v4, v6, 4, v4
    v_lshrrev_b32 v5, 2, v2
    v_lshlrev_b32 v5, 11, v5
    v_lshl_add_u32 v5, v3, 8, v5
    v_and_b32 v1, 3, v6
    v_lshl_add_u32 v5, v1, 6, v5
    v_add_u32 v5, v5, v9
    v_cmp_gt_u32 vcc, 72, v6
    s_nop 0
    s_mov_b64 exec, vcc
    s_mul_i32 s20, s18, 36864
    s_add_u32 s21, s20, 0
    buffer_load_dwordx4 v[12:15], v4, s[8:11], s21 offen
    s_add_u32 s21, s20, 1152
    buffer_load_dwordx4 v[16:19], v4, s[8:11], s21 offen
    s_add_u32 s21, s20, 2304
    buffer_load_dwordx4 v[20:23], v4, s[8:11], s21 offen
    s_add_u32 s21, s20, 3456
    buffer_load_dwordx4 v[24:27], v4, s[8:11], s21 offen
    s_add_u32 s21, s20, 4608
    buffer_load_dwordx4 v[28:31], v4, s[8:11], s21 offen
    s_add_u32 s21, s20, 5760
    buffer_load_dwordx4 v[32:35], v4, s[8:11], s21 offen
    s_add_u32 s21, s20, 6912
    buffer_load_dwordx4 v[36:39], v4, s[8:11], s21 offen
    s_add_u32 s21, s20, 8064
    buffer_load_dwordx4 v[40:43], v4, s[8:11], s21 offen
    s_lshl_b32 s20, s18, 11
    s_add_u32 s20, s20, 130023424
    s_waitcnt vmcnt(0)
    v_perm_b32 v76, v16, v12, v7
    v_perm_b32 v77, v24, v20, v7
    v_perm_b32 v78, v32, v28, v7
    v_perm_b32 v79, v40, v36, v7
    ds_write_b128 v5, v[76:79] offset:0
    v_perm_b32 v80, v17, v13, v7
    v_perm_b32 v81, v25, v21, v7
    v_perm_b32 v82, v33, v29, v7
    v_perm_b32 v83, v41, v37, v7
    ds_write_b128 v5, v[80:83] offset:16
    v_perm_b32 v84, v18, v14, v7
    v_perm_b32 v85, v26, v22, v7
    v_perm_b32 v86, v34, v30, v7
    v_perm_b32 v87, v42, v38, v7
    ds_write_b128 v5, v[84:87] offset:32
    v_perm_b32 v88, v19, v15, v7
    v_perm_b32 v89, v27, v23, v7
    v_perm_b32 v90, v35, v31, v7
    v_perm_b32 v91, v43, v39, v7
    ds_write_b128 v5, v[88:91] offset:48
    v_perm_b32 v92, v16, v12, v8
    v_perm_b32 v93, v24, v20, v8
    v_perm_b32 v94, v32, v28, v8
    v_perm_b32 v95, v40, v36, v8
    ds_write_b128 v5, v[92:95] offset:1024
    v_perm_b32 v96, v17, v13, v8
    v_perm_b32 v97, v25, v21, v8
    v_perm_b32 v98, v33, v29, v8
    v_perm_b32 v99, v41, v37, v8
    ds_write_b128 v5, v[96:99] offset:1040
    v_perm_b32 v100, v18, v14, v8
    v_perm_b32 v101, v26, v22, v8
    v_perm_b32 v102, v34, v30, v8
    v_perm_b32 v103, v42, v38, v8
    ds_write_b128 v5, v[100:103] offset:1056
    v_perm_b32 v104, v19, v15, v8
    v_perm_b32 v105, v27, v23, v8
    v_perm_b32 v106, v35, v31, v8
    v_perm_b32 v107, v43, v39, v8
    ds_write_b128 v5, v[104:107] offset:1072
    s_mov_b64 exec, -1
    s_lshl_b32 s21, s17, 20
    s_add_u32 s20, s20, s21
    s_waitcnt lgkmcnt(0)
    ds_read_b128 v[76:79], v11 offset:0
    ds_read_b128 v[80:83], v11 offset:1024
    ds_read_b128 v[84:87], v11 offset:2048
    ds_read_b128 v[88:91], v11 offset:3072
    ds_read_b128 v[92:95], v11 offset:4096
    ds_read_b128 v[96:99], v11 offset:5120
    ds_read_b128 v[100:103], v11 offset:6144
    ds_read_b128 v[104:107], v11 offset:7168
    s_add_u32 s19, s20, 0
    s_waitcnt lgkmcnt(7)
    buffer_store_dwordx4 v[76:79], v10, s[4:7], s19 offen sc1
    s_add_u32 s19, s20, 1024
    s_waitcnt lgkmcnt(6)
    buffer_store_dwordx4 v[80:83], v10, s[4:7], s19 offen sc1
    s_add_u32 s19, s20, 262144
    s_waitcnt lgkmcnt(5)
    buffer_store_dwordx4 v[84:87], v10, s[4:7], s19 offen sc1
    s_add_u32 s19, s20, 263168
    s_waitcnt lgkmcnt(4)
    buffer_store_dwordx4 v[88:91], v10, s[4:7], s19 offen sc1
    s_add_u32 s19, s20, 524288
    s_waitcnt lgkmcnt(3)
    buffer_store_dwordx4 v[92:95], v10, s[4:7], s19 offen sc1
    s_add_u32 s19, s20, 525312
    s_waitcnt lgkmcnt(2)
    buffer_store_dwordx4 v[96:99], v10, s[4:7], s19 offen sc1
    s_add_u32 s19, s20, 786432
    s_waitcnt lgkmcnt(1)
    buffer_store_dwordx4 v[100:103], v10, s[4:7], s19 offen sc1
    s_add_u32 s19, s20, 787456
    s_waitcnt lgkmcnt(0)
    buffer_store_dwordx4 v[104:107], v10, s[4:7], s19 offen sc1
xf_done:
    s_nop 1
    s_setpc_b64 s[46:47]
L_helper:
    s_load_dwordx16 s[64:79], s[0:1], 64
    s_waitcnt lgkmcnt(0)
L_qkv_next:
    s_mov_b32 s37, 4
    v_mov_b32 v250, 1
    v_mov_b32 v251, 163832
    v_cmp_eq_u32 vcc, 0, v0
    s_nop 0
    s_and_saveexec_b64 s[38:39], vcc
    s_cbranch_execz tk3
    buffer_atomic_add v250, off, s[84:87], s37 sc0
    s_waitcnt vmcnt(0)
    ds_write_b32 v251, v250
    s_waitcnt lgkmcnt(0)
tk3:
    s_mov_b64 exec, -1
    s_barrier
    ds_read_b32 v252, v251
    s_waitcnt lgkmcnt(0)
    v_readfirstlane_b32 s36, v252
    s_barrier
    s_nop 3
    s_or_b32 s37, s36, s32
    s_cbranch_scc1 L_non
    s_memrealtime s[90:91]
    s_waitcnt lgkmcnt(0)
    s_lshl_b32 s90, s90, 8
    s_or_b32 s90, s90, 1
    v_mov_b32 v250, s90
    s_mov_b64 exec, 1
    buffer_store_dword v250, off, s[84:87], 0 offset:216 sc1
    s_mov_b64 exec, -1
L_non:
    s_cmp_lt_u32 s36, 192
    s_cbranch_scc1 L_qkv
    s_mov_b32 s88, 4194304
gn4:
    buffer_load_dword v250, off, s[84:87], 0 offset:216 sc1
    s_waitcnt vmcnt(0)
    v_readfirstlane_b32 s95, v250
    s_sub_u32 s88, s88, 1
    s_cbranch_scc1 gn4x
    s_cmp_eq_u32 s95, 0
    s_cbranch_scc1 gn4
gn4x:
    s_cmp_lg_u32 s36, 192
    s_cbranch_scc1 L_ssm_next
    s_cmp_lg_u32 s32, 0
    s_cbranch_scc1 L_exit
    v_and_b32 v3, 31, v0
    v_lshlrev_b32 v3, 7, v3
    s_mov_b32 s17, 0
    s_mov_b32 s23, 125845504
    s_mov_b32 s24, 125853696
    s_mov_b32 s21, 16777216
rl_rwait:
    buffer_load_dword v4, v3, s[4:7], s23 offen sc1
    s_waitcnt vmcnt(0)
    v_subrev_u32 v4, s95, v4
    v_cmp_lt_u32 vcc, 64, v4
    s_nop 1
    v_cndmask_b32 v4, v4, 0, vcc
    s_nop 1
    v_min_u32_dpp v4, v4, v4 row_ror:1 row_mask:0xf bank_mask:0xf
    s_nop 1
    v_min_u32_dpp v4, v4, v4 row_ror:2 row_mask:0xf bank_mask:0xf
    s_nop 1
    v_min_u32_dpp v4, v4, v4 row_ror:4 row_mask:0xf bank_mask:0xf
    s_nop 1
    v_min_u32_dpp v4, v4, v4 row_ror:8 row_mask:0xf bank_mask:0xf
    s_nop 0
    v_readlane_b32 s16, v4, 0
    v_readlane_b32 s22, v4, 16
    s_nop 0
    s_min_u32 s16, s16, s22
    s_sub_u32 s21, s21, 1
    s_cbranch_scc1 rl_x
    s_cmp_gt_u32 s16, s17
    s_cbranch_scc1 rl_rpub
    s_sleep 2
    s_branch rl_rwait
rl_rpub:
    s_mov_b32 s17, s16
    s_add_u32 s22, s16, s95
    v_mov_b32 v4, s22
    s_mov_b64 exec, 1
    buffer_store_dword v4, off, s[4:7], s24 sc1
    s_mov_b64 exec, -1
    s_cmp_lt_u32 s16, 64
    s_cbranch_scc1 rl_rwait
rl_x:
    s_endpgm
L_qkv:
    s_and_b32 s17, s36, 15
    s_lshl_b32 s17, s17, 1
    s_lshr_b32 s36, s36, 4
    s_and_b32 s16, s36, 1
    s_add_u32 s16, s16, 1
    s_lshr_b32 s19, s36, 1
    s_and_b32 s37, s36, 3
    s_cmp_ge_u32 s36, 8
    s_cselect_b32 s16, 0, s16
    s_cselect_b32 s19, s37, s19
    v_lshrrev_b32 v4, 6, v0
    s_nop 0
    v_readfirstlane_b32 s18, v4
    v_lshlrev_b32 v7, 4, v0
    s_cmp_eq_u32 s16, 1
    s_cselect_b64 s[12:13], s[54:55], s[52:53]
    s_cmp_eq_u32 s16, 2
    s_cselect_b64 s[12:13], s[56:57], s[12:13]
    s_mov_b32 s14, 4718592
    s_mov_b32 s15, 0x20000
    v_bfe_u32 v4, v0, 5, 1
    v_lshlrev_b32 v5, 2, v4
    v_and_b32 v8, 31, v0
    v_xor_b32 v8, v8, v5
    v_lshlrev_b32 v8, 4, v8
    v_lshl_add_u32 v8, v4, 13, v8
    v_xor_b32 v9, 128, v8
    s_lshl_b32 s21, s17, 8
    s_lshl_b32 s42, s18, 16
    s_add_u32 s42, s42, s21
    s_lshl_b32 s44, s18, 12
    s_barrier
    s_add_u32 m0, s44, 73728
    s_add_u32 s22, s42, 0
    buffer_load_dwordx4 v8, s[12:15], s22 offen offset:0 lds
    s_add_u32 s22, s42, 15360
    buffer_load_dwordx4 v9, s[12:15], s22 offen offset:1024 lds
    s_add_u32 s22, s42, 30720
    buffer_load_dwordx4 v8, s[12:15], s22 offen offset:2048 lds
    s_add_u32 s22, s42, 46080
    buffer_load_dwordx4 v9, s[12:15], s22 offen offset:3072 lds
    s_add_u32 m0, s44, 90112
    s_add_u32 s22, s42, 262144
    buffer_load_dwordx4 v8, s[12:15], s22 offen offset:0 lds
    s_add_u32 s22, s42, 277504
    buffer_load_dwordx4 v9, s[12:15], s22 offen offset:1024 lds
    s_add_u32 s22, s42, 292864
    buffer_load_dwordx4 v8, s[12:15], s22 offen offset:2048 lds
    s_add_u32 s22, s42, 308224
    buffer_load_dwordx4 v9, s[12:15], s22 offen offset:3072 lds
    s_add_u32 m0, s44, 106496
    s_add_u32 s22, s42, 524288
    buffer_load_dwordx4 v8, s[12:15], s22 offen offset:0 lds
    s_add_u32 s22, s42, 539648
    buffer_load_dwordx4 v9, s[12:15], s22 offen offset:1024 lds
    s_add_u32 s22, s42, 555008
    buffer_load_dwordx4 v8, s[12:15], s22 offen offset:2048 lds
    s_add_u32 s22, s42, 570368
    buffer_load_dwordx4 v9, s[12:15], s22 offen offset:3072 lds
    s_add_u32 m0, s44, 122880
    s_add_u32 s22, s42, 786432
    buffer_load_dwordx4 v8, s[12:15], s22 offen offset:0 lds
    s_add_u32 s22, s42, 801792
    buffer_load_dwordx4 v9, s[12:15], s22 offen offset:1024 lds
    s_add_u32 s22, s42, 817152
    buffer_load_dwordx4 v8, s[12:15], s22 offen offset:2048 lds
    s_add_u32 s22, s42, 832512
    buffer_load_dwordx4 v9, s[12:15], s22 offen offset:3072 lds
    v_bfe_u32 v4, v0, 2, 2
    v_xor_b32 v5, s18, v4
    v_lshlrev_b32 v10, 6, v5
    v_lshl_add_u32 v10, v4, 9, v10
    v_and_b32 v4, 3, v0
    v_lshl_add_u32 v10, v4, 4, v10
    v_bfe_u32 v4, v0, 4, 2
    v_lshl_add_u32 v10, v4, 12, v10
    v_add_u32 v10, 73728, v10
    v_add_u32 v11, 49152, v10
    v_and_b32 v4, 63, v0
    v_and_b32 v5, 15, v4
    v_lshrrev_b32 v3, 4, v4
    v_lshrrev_b32 v2, 2, v5
    v_xor_b32 v3, v3, v2
    v_lshl_add_u32 v3, v5, 2, v3
    v_lshlrev_b32 v1, 4, v3
    v_lshrrev_b32 v5, 2, v4
    v_lshrrev_b32 v3, 4, v4
    v_and_b32 v4, 3, v4
    v_xor_b32 v4, v4, v3
    v_lshlrev_b32 v3, 3, v3
    v_and_b32 v5, 3, v5
    v_add_u32 v3, v3, v5
    v_mul_u32_u24 v2, 1152, v3
    v_lshl_add_u32 v2, v4, 4, v2
    s_mov_b32 s8, s48
    s_mov_b32 s9, s49
    s_mov_b32 s10, 2359296
    s_mov_b32 s11, 0x20000
    s_lshr_b32 s22, s18, 1
    s_mul_i32 s24, s22, 4608
    s_mul_i32 s25, s22, 18432
    s_and_b32 s22, s18, 1
    s_mul_i32 s23, s22, 576
    s_add_u32 s24, s24, s23
    s_mul_i32 s25, s18, 9216
    s_mul_i32 s22, s19, 36864
    s_add_u32 s24, s24, s22
    s_mov_b32 s20, 64
    s_lshl_b32 s22, s19, 5
    s_add_u32 s22, s22, s17
    s_lshl_b32 s26, s22, 14
    s_mul_i32 s23, s18, 3072
    s_add_u32 s26, s26, s23
    s_lshl_b32 s23, s16, 11
    s_add_u32 s26, s26, s23
    s_add_u32 s26, s26, -2048
    s_lshl_b32 s22, s22, 13
    s_add_u32 s22, s22, 33554432
    s_cmp_eq_u32 s16, 0
    s_cselect_b32 s26, s22, s26
    s_cselect_b32 s40, 4096, 64
    s_cselect_b32 s41, 1, 2
    s_max_u32 s40, s40, 1024
    s_lshl_b32 s41, s41, 18
    s_lshl_b32 s29, s17, 7
    s_lshl_b32 s22, s16, 4
    s_add_u32 s29, s29, s22
    s_lshl_b32 s22, s19, 2
    s_add_u32 s29, s29, s22
    s_add_u32 s29, s29, 125829120
    s_mov_b32 s27, 0
    s_add_u32 s23, s27, s25
    s_add_u32 m0, s23, 0
    s_nop 0
    buffer_load_dwordx4 v2, s[8:11], s24 offen offset:0 lds
    s_add_u32 m0, s23, 960
    s_nop 0
    buffer_load_dwordx4 v2, s[8:11], s24 offen offset:64 lds
    s_add_u32 m0, s23, 1920
    s_nop 0
    buffer_load_dwordx4 v2, s[8:11], s24 offen offset:128 lds
    s_add_u32 m0, s23, 2880
    s_nop 0
    buffer_load_dwordx4 v2, s[8:11], s24 offen offset:192 lds
    s_add_u32 m0, s23, 3840
    s_nop 0
    buffer_load_dwordx4 v2, s[8:11], s24 offen offset:256 lds
    s_add_u32 m0, s23, 4800
    s_nop 0
    buffer_load_dwordx4 v2, s[8:11], s24 offen offset:320 lds
    s_add_u32 m0, s23, 5760
    s_nop 0
    buffer_load_dwordx4 v2, s[8:11], s24 offen offset:384 lds
    s_add_u32 m0, s23, 6720
    s_nop 0
    buffer_load_dwordx4 v2, s[8:11], s24 offen offset:448 lds
    s_add_u32 m0, s23, 7680
    s_nop 0
    buffer_load_dwordx4 v2, s[8:11], s24 offen offset:512 lds
    s_add_u32 s24, s24, 147456
    s_waitcnt vmcnt(21) lgkmcnt(0)
    s_barrier
    s_add_u32 m0, s44, 139264
    s_add_u32 s22, s42, 1048576
    buffer_load_dwordx4 v8, s[12:15], s22 offen offset:0 lds
    s_add_u32 s22, s42, 1063936
    buffer_load_dwordx4 v9, s[12:15], s22 offen offset:1024 lds
    s_add_u32 s22, s42, 1079296
    buffer_load_dwordx4 v8, s[12:15], s22 offen offset:2048 lds
    s_add_u32 s22, s42, 1094656
    buffer_load_dwordx4 v9, s[12:15], s22 offen offset:3072 lds
    ds_read_b64_tr_b16 v[64:65], v10 offset:0
    ds_read_b64_tr_b16 v[66:67], v10 offset:2048
    ds_read_b64_tr_b16 v[136:137], v10 offset:8
    ds_read_b64_tr_b16 v[138:139], v10 offset:2056
    ds_read_b64_tr_b16 a[0:1], v10 offset:256
    ds_read_b64_tr_b16 a[2:3], v10 offset:2304
    ds_read_b64_tr_b16 a[72:73], v10 offset:264
    ds_read_b64_tr_b16 a[74:75], v10 offset:2312
    s_waitcnt vmcnt(21) lgkmcnt(0)
    s_barrier
    s_add_u32 m0, s44, 73728
    s_add_u32 s22, s42, 1310720
    buffer_load_dwordx4 v8, s[12:15], s22 offen offset:0 lds
    s_add_u32 s22, s42, 1326080
    buffer_load_dwordx4 v9, s[12:15], s22 offen offset:1024 lds
    s_add_u32 s22, s42, 1341440
    buffer_load_dwordx4 v8, s[12:15], s22 offen offset:2048 lds
    s_add_u32 s22, s42, 1356800
    buffer_load_dwordx4 v9, s[12:15], s22 offen offset:3072 lds
    ds_read_b64_tr_b16 v[68:69], v10 offset:16384
    ds_read_b64_tr_b16 v[70:71], v10 offset:18432
    ds_read_b64_tr_b16 v[140:141], v10 offset:16392
    ds_read_b64_tr_b16 v[142:143], v10 offset:18440
    ds_read_b64_tr_b16 a[4:5], v10 offset:16640
    ds_read_b64_tr_b16 a[6:7], v10 offset:18688
    ds_read_b64_tr_b16 a[76:77], v10 offset:16648
    ds_read_b64_tr_b16 a[78:79], v10 offset:18696
    s_waitcnt vmcnt(21) lgkmcnt(0)
    s_barrier
    s_add_u32 m0, s44, 90112
    s_add_u32 s22, s42, 1572864
    buffer_load_dwordx4 v8, s[12:15], s22 offen offset:0 lds
    s_add_u32 s22, s42, 1588224
    buffer_load_dwordx4 v9, s[12:15], s22 offen offset:1024 lds
    s_add_u32 s22, s42, 1603584
    buffer_load_dwordx4 v8, s[12:15], s22 offen offset:2048 lds
    s_add_u32 s22, s42, 1618944
    buffer_load_dwordx4 v9, s[12:15], s22 offen offset:3072 lds
    ds_read_b64_tr_b16 v[72:73], v10 offset:32768
    ds_read_b64_tr_b16 v[74:75], v10 offset:34816
    ds_read_b64_tr_b16 v[144:145], v10 offset:32776
    ds_read_b64_tr_b16 v[146:147], v10 offset:34824
    ds_read_b64_tr_b16 a[8:9], v10 offset:33024
    ds_read_b64_tr_b16 a[10:11], v10 offset:35072
    ds_read_b64_tr_b16 a[80:81], v10 offset:33032
    ds_read_b64_tr_b16 a[82:83], v10 offset:35080
    s_waitcnt vmcnt(21) lgkmcnt(0)
    s_barrier
    s_add_u32 m0, s44, 106496
    s_add_u32 s22, s42, 1835008
    buffer_load_dwordx4 v8, s[12:15], s22 offen offset:0 lds
    s_add_u32 s22, s42, 1850368
    buffer_load_dwordx4 v9, s[12:15], s22 offen offset:1024 lds
    s_add_u32 s22, s42, 1865728
    buffer_load_dwordx4 v8, s[12:15], s22 offen offset:2048 lds
    s_add_u32 s22, s42, 1881088
    buffer_load_dwordx4 v9, s[12:15], s22 offen offset:3072 lds
    ds_read_b64_tr_b16 v[76:77], v11 offset:0
    ds_read_b64_tr_b16 v[78:79], v11 offset:2048
    ds_read_b64_tr_b16 v[148:149], v11 offset:8
    ds_read_b64_tr_b16 v[150:151], v11 offset:2056
    ds_read_b64_tr_b16 a[12:13], v11 offset:256
    ds_read_b64_tr_b16 a[14:15], v11 offset:2304
    ds_read_b64_tr_b16 a[84:85], v11 offset:264
    ds_read_b64_tr_b16 a[86:87], v11 offset:2312
    s_waitcnt vmcnt(12) lgkmcnt(0)
    s_barrier
    s_add_u32 m0, s44, 122880
    s_add_u32 s22, s42, 2097152
    buffer_load_dwordx4 v8, s[12:15], s22 offen offset:0 lds
    s_add_u32 s22, s42, 2112512
    buffer_load_dwordx4 v9, s[12:15], s22 offen offset:1024 lds
    s_add_u32 s22, s42, 2127872
    buffer_load_dwordx4 v8, s[12:15], s22 offen offset:2048 lds
    s_add_u32 s22, s42, 2143232
    buffer_load_dwordx4 v9, s[12:15], s22 offen offset:3072 lds
    ds_read_b64_tr_b16 v[80:81], v11 offset:16384
    ds_read_b64_tr_b16 v[82:83], v11 offset:18432
    ds_read_b64_tr_b16 v[152:153], v11 offset:16392
    ds_read_b64_tr_b16 v[154:155], v11 offset:18440
    ds_read_b64_tr_b16 a[16:17], v11 offset:16640
    ds_read_b64_tr_b16 a[18:19], v11 offset:18688
    ds_read_b64_tr_b16 a[88:89], v11 offset:16648
    ds_read_b64_tr_b16 a[90:91], v11 offset:18696
    s_waitcnt vmcnt(12) lgkmcnt(0)
    s_barrier
    s_add_u32 m0, s44, 139264
    s_add_u32 s22, s42, 2359296
    buffer_load_dwordx4 v8, s[12:15], s22 offen offset:0 lds
    s_add_u32 s22, s42, 2374656
    buffer_load_dwordx4 v9, s[12:15], s22 offen offset:1024 lds
    s_add_u32 s22, s42, 2390016
    buffer_load_dwordx4 v8, s[12:15], s22 offen offset:2048 lds
    s_add_u32 s22, s42, 2405376
    buffer_load_dwordx4 v9, s[12:15], s22 offen offset:3072 lds
    ds_read_b64_tr_b16 v[84:85], v10 offset:0
    ds_read_b64_tr_b16 v[86:87], v10 offset:2048
    ds_read_b64_tr_b16 v[156:157], v10 offset:8
    ds_read_b64_tr_b16 v[158:159], v10 offset:2056
    ds_read_b64_tr_b16 a[20:21], v10 offset:256
    ds_read_b64_tr_b16 a[22:23], v10 offset:2304
    ds_read_b64_tr_b16 a[92:93], v10 offset:264
    ds_read_b64_tr_b16 a[94:95], v10 offset:2312
    s_waitcnt vmcnt(12) lgkmcnt(0)
    s_barrier
    s_add_u32 m0, s44, 73728
    s_add_u32 s22, s42, 2621440
    buffer_load_dwordx4 v8, s[12:15], s22 offen offset:0 lds
    s_add_u32 s22, s42, 2636800
    buffer_load_dwordx4 v9, s[12:15], s22 offen offset:1024 lds
    s_add_u32 s22, s42, 2652160
    buffer_load_dwordx4 v8, s[12:15], s22 offen offset:2048 lds
    s_add_u32 s22, s42, 2667520
    buffer_load_dwordx4 v9, s[12:15], s22 offen offset:3072 lds
    ds_read_b64_tr_b16 v[88:89], v10 offset:16384
    ds_read_b64_tr_b16 v[90:91], v10 offset:18432
    ds_read_b64_tr_b16 v[160:161], v10 offset:16392
    ds_read_b64_tr_b16 v[162:163], v10 offset:18440
    ds_read_b64_tr_b16 a[24:25], v10 offset:16640
    ds_read_b64_tr_b16 a[26:27], v10 offset:18688
    ds_read_b64_tr_b16 a[96:97], v10 offset:16648
    ds_read_b64_tr_b16 a[98:99], v10 offset:18696
    s_waitcnt vmcnt(12) lgkmcnt(0)
    s_barrier
    s_add_u32 m0, s44, 90112
    s_add_u32 s22, s42, 2883584
    buffer_load_dwordx4 v8, s[12:15], s22 offen offset:0 lds
    s_add_u32 s22, s42, 2898944
    buffer_load_dwordx4 v9, s[12:15], s22 offen offset:1024 lds
    s_add_u32 s22, s42, 2914304
    buffer_load_dwordx4 v8, s[12:15], s22 offen offset:2048 lds
    s_add_u32 s22, s42, 2929664
    buffer_load_dwordx4 v9, s[12:15], s22 offen offset:3072 lds
    ds_read_b64_tr_b16 v[92:93], v10 offset:32768
    ds_read_b64_tr_b16 v[94:95], v10 offset:34816
    ds_read_b64_tr_b16 v[164:165], v10 offset:32776
    ds_read_b64_tr_b16 v[166:167], v10 offset:34824
    ds_read_b64_tr_b16 a[28:29], v10 offset:33024
    ds_read_b64_tr_b16 a[30:31], v10 offset:35072
    ds_read_b64_tr_b16 a[100:101], v10 offset:33032
    ds_read_b64_tr_b16 a[102:103], v10 offset:35080
    s_waitcnt vmcnt(12) lgkmcnt(0)
    s_barrier
    s_add_u32 m0, s44, 106496
    s_add_u32 s22, s42, 3145728
    buffer_load_dwordx4 v8, s[12:15], s22 offen offset:0 lds
    s_add_u32 s22, s42, 3161088
    buffer_load_dwordx4 v9, s[12:15], s22 offen offset:1024 lds
    s_add_u32 s22, s42, 3176448
    buffer_load_dwordx4 v8, s[12:15], s22 offen offset:2048 lds
    s_add_u32 s22, s42, 3191808
    buffer_load_dwordx4 v9, s[12:15], s22 offen offset:3072 lds
    ds_read_b64_tr_b16 v[96:97], v11 offset:0
    ds_read_b64_tr_b16 v[98:99], v11 offset:2048
    ds_read_b64_tr_b16 v[168:169], v11 offset:8
    ds_read_b64_tr_b16 v[170:171], v11 offset:2056
    ds_read_b64_tr_b16 a[32:33], v11 offset:256
    ds_read_b64_tr_b16 a[34:35], v11 offset:2304
    ds_read_b64_tr_b16 a[104:105], v11 offset:264
    ds_read_b64_tr_b16 a[106:107], v11 offset:2312
    s_waitcnt vmcnt(12) lgkmcnt(0)
    s_barrier
    s_add_u32 m0, s44, 122880
    s_add_u32 s22, s42, 3407872
    buffer_load_dwordx4 v8, s[12:15], s22 offen offset:0 lds
    s_add_u32 s22, s42, 3423232
    buffer_load_dwordx4 v9, s[12:15], s22 offen offset:1024 lds
    s_add_u32 s22, s42, 3438592
    buffer_load_dwordx4 v8, s[12:15], s22 offen offset:2048 lds
    s_add_u32 s22, s42, 3453952
    buffer_load_dwordx4 v9, s[12:15], s22 offen offset:3072 lds
    ds_read_b64_tr_b16 v[100:101], v11 offset:16384
    ds_read_b64_tr_b16 v[102:103], v11 offset:18432
    ds_read_b64_tr_b16 v[172:173], v11 offset:16392
    ds_read_b64_tr_b16 v[174:175], v11 offset:18440
    ds_read_b64_tr_b16 a[36:37], v11 offset:16640
    ds_read_b64_tr_b16 a[38:39], v11 offset:18688
    ds_read_b64_tr_b16 a[108:109], v11 offset:16648
    ds_read_b64_tr_b16 a[110:111], v11 offset:18696
    s_waitcnt vmcnt(12) lgkmcnt(0)
    s_barrier
    s_add_u32 m0, s44, 139264
    s_add_u32 s22, s42, 3670016
    buffer_load_dwordx4 v8, s[12:15], s22 offen offset:0 lds
    s_add_u32 s22, s42, 3685376
    buffer_load_dwordx4 v9, s[12:15], s22 offen offset:1024 lds
    s_add_u32 s22, s42, 3700736
    buffer_load_dwordx4 v8, s[12:15], s22 offen offset:2048 lds
    s_add_u32 s22, s42, 3716096
    buffer_load_dwordx4 v9, s[12:15], s22 offen offset:3072 lds
    ds_read_b64_tr_b16 v[104:105], v10 offset:0
    ds_read_b64_tr_b16 v[106:107], v10 offset:2048
    ds_read_b64_tr_b16 v[176:177], v10 offset:8
    ds_read_b64_tr_b16 v[178:179], v10 offset:2056
    ds_read_b64_tr_b16 a[40:41], v10 offset:256
    ds_read_b64_tr_b16 a[42:43], v10 offset:2304
    ds_read_b64_tr_b16 a[112:113], v10 offset:264
    ds_read_b64_tr_b16 a[114:115], v10 offset:2312
    s_waitcnt vmcnt(12) lgkmcnt(0)
    s_barrier
    s_add_u32 m0, s44, 73728
    s_add_u32 s22, s42, 3932160
    buffer_load_dwordx4 v8, s[12:15], s22 offen offset:0 lds
    s_add_u32 s22, s42, 3947520
    buffer_load_dwordx4 v9, s[12:15], s22 offen offset:1024 lds
    s_add_u32 s22, s42, 3962880
    buffer_load_dwordx4 v8, s[12:15], s22 offen offset:2048 lds
    s_add_u32 s22, s42, 3978240
    buffer_load_dwordx4 v9, s[12:15], s22 offen offset:3072 lds
    ds_read_b64_tr_b16 v[108:109], v10 offset:16384
    ds_read_b64_tr_b16 v[110:111], v10 offset:18432
    ds_read_b64_tr_b16 v[180:181], v10 offset:16392
    ds_read_b64_tr_b16 v[182:183], v10 offset:18440
    ds_read_b64_tr_b16 a[44:45], v10 offset:16640
    ds_read_b64_tr_b16 a[46:47], v10 offset:18688
    ds_read_b64_tr_b16 a[116:117], v10 offset:16648
    ds_read_b64_tr_b16 a[118:119], v10 offset:18696
    s_waitcnt vmcnt(12) lgkmcnt(0)
    s_barrier
    s_add_u32 m0, s44, 90112
    s_add_u32 s22, s42, 4194304
    buffer_load_dwordx4 v8, s[12:15], s22 offen offset:0 lds
    s_add_u32 s22, s42, 4209664
    buffer_load_dwordx4 v9, s[12:15], s22 offen offset:1024 lds
    s_add_u32 s22, s42, 4225024
    buffer_load_dwordx4 v8, s[12:15], s22 offen offset:2048 lds
    s_add_u32 s22, s42, 4240384
    buffer_load_dwordx4 v9, s[12:15], s22 offen offset:3072 lds
    ds_read_b64_tr_b16 v[112:113], v10 offset:32768
    ds_read_b64_tr_b16 v[114:115], v10 offset:34816
    ds_read_b64_tr_b16 v[184:185], v10 offset:32776
    ds_read_b64_tr_b16 v[186:187], v10 offset:34824
    ds_read_b64_tr_b16 a[48:49], v10 offset:33024
    ds_read_b64_tr_b16 a[50:51], v10 offset:35072
    ds_read_b64_tr_b16 a[120:121], v10 offset:33032
    ds_read_b64_tr_b16 a[122:123], v10 offset:35080
    s_waitcnt vmcnt(12) lgkmcnt(0)
    s_barrier
    s_add_u32 m0, s44, 106496
    s_add_u32 s22, s42, 4456448
    buffer_load_dwordx4 v8, s[12:15], s22 offen offset:0 lds
    s_add_u32 s22, s42, 4471808
    buffer_load_dwordx4 v9, s[12:15], s22 offen offset:1024 lds
    s_add_u32 s22, s42, 4487168
    buffer_load_dwordx4 v8, s[12:15], s22 offen offset:2048 lds
    s_add_u32 s22, s42, 4502528
    buffer_load_dwordx4 v9, s[12:15], s22 offen offset:3072 lds
    ds_read_b64_tr_b16 v[116:117], v11 offset:0
    ds_read_b64_tr_b16 v[118:119], v11 offset:2048
    ds_read_b64_tr_b16 v[188:189], v11 offset:8
    ds_read_b64_tr_b16 v[190:191], v11 offset:2056
    ds_read_b64_tr_b16 a[52:53], v11 offset:256
    ds_read_b64_tr_b16 a[54:55], v11 offset:2304
    ds_read_b64_tr_b16 a[124:125], v11 offset:264
    ds_read_b64_tr_b16 a[126:127], v11 offset:2312
    s_waitcnt vmcnt(12) lgkmcnt(0)
    s_barrier
    s_mov_b32 s27, 36864
    s_add_u32 s23, s27, s25
    s_add_u32 m0, s23, 0
    s_nop 0
    buffer_load_dwordx4 v2, s[8:11], s24 offen offset:0 lds
    s_add_u32 m0, s23, 960
    s_nop 0
    buffer_load_dwordx4 v2, s[8:11], s24 offen offset:64 lds
    s_add_u32 m0, s23, 1920
    s_nop 0
    buffer_load_dwordx4 v2, s[8:11], s24 offen offset:128 lds
    s_add_u32 m0, s23, 2880
    s_nop 0
    buffer_load_dwordx4 v2, s[8:11], s24 offen offset:192 lds
    s_add_u32 m0, s23, 3840
    s_nop 0
    buffer_load_dwordx4 v2, s[8:11], s24 offen offset:256 lds
    s_add_u32 m0, s23, 4800
    s_nop 0
    buffer_load_dwordx4 v2, s[8:11], s24 offen offset:320 lds
    s_add_u32 m0, s23, 5760
    s_nop 0
    buffer_load_dwordx4 v2, s[8:11], s24 offen offset:384 lds
    s_add_u32 m0, s23, 6720
    s_nop 0
    buffer_load_dwordx4 v2, s[8:11], s24 offen offset:448 lds
    s_add_u32 m0, s23, 7680
    s_nop 0
    buffer_load_dwordx4 v2, s[8:11], s24 offen offset:512 lds
    s_add_u32 s24, s24, 147456
    ds_read_b64_tr_b16 v[120:121], v11 offset:16384
    ds_read_b64_tr_b16 v[122:123], v11 offset:18432
    ds_read_b64_tr_b16 v[192:193], v11 offset:16392
    ds_read_b64_tr_b16 v[194:195], v11 offset:18440
    ds_read_b64_tr_b16 a[56:57], v11 offset:16640
    ds_read_b64_tr_b16 a[58:59], v11 offset:18688
    ds_read_b64_tr_b16 a[128:129], v11 offset:16648
    ds_read_b64_tr_b16 a[130:131], v11 offset:18696
    s_waitcnt vmcnt(17) lgkmcnt(0)
    s_barrier
    ds_read_b64_tr_b16 v[124:125], v10 offset:0
    ds_read_b64_tr_b16 v[126:127], v10 offset:2048
    ds_read_b64_tr_b16 v[196:197], v10 offset:8
    ds_read_b64_tr_b16 v[198:199], v10 offset:2056
    ds_read_b64_tr_b16 a[60:61], v10 offset:256
    ds_read_b64_tr_b16 a[62:63], v10 offset:2304
    ds_read_b64_tr_b16 a[132:133], v10 offset:264
    ds_read_b64_tr_b16 a[134:135], v10 offset:2312
    s_waitcnt vmcnt(13) lgkmcnt(0)
    s_barrier
    ds_read_b64_tr_b16 v[128:129], v10 offset:16384
    ds_read_b64_tr_b16 v[130:131], v10 offset:18432
    ds_read_b64_tr_b16 v[200:201], v10 offset:16392
    ds_read_b64_tr_b16 v[202:203], v10 offset:18440
    ds_read_b64_tr_b16 a[64:65], v10 offset:16640
    ds_read_b64_tr_b16 a[66:67], v10 offset:18688
    ds_read_b64_tr_b16 a[136:137], v10 offset:16648
    ds_read_b64_tr_b16 a[138:139], v10 offset:18696
    s_waitcnt vmcnt(9) lgkmcnt(0)
    s_barrier
    ds_read_b64_tr_b16 v[132:133], v10 offset:32768
    ds_read_b64_tr_b16 v[134:135], v10 offset:34816
    ds_read_b64_tr_b16 v[204:205], v10 offset:32776
    ds_read_b64_tr_b16 v[206:207], v10 offset:34824
    ds_read_b64_tr_b16 a[68:69], v10 offset:33024
    ds_read_b64_tr_b16 a[70:71], v10 offset:35072
    ds_read_b64_tr_b16 a[140:141], v10 offset:33032
    ds_read_b64_tr_b16 a[142:143], v10 offset:35080
    s_mov_b32 s88, 4194304
gn5:
    buffer_load_dword v250, off, s[84:87], 0 offset:216 sc1
    s_waitcnt vmcnt(0)
    v_readfirstlane_b32 s95, v250
    s_sub_u32 s88, s88, 1
    s_cbranch_scc1 gn5x
    s_cmp_eq_u32 s95, 0
    s_cbranch_scc1 gn5
gn5x:
    s_waitcnt lgkmcnt(0)
    s_mov_b32 s45, 0
    s_mov_b32 s27, 0
    s_cmp_eq_u32 s18, 0
    s_cselect_b32 s34, 1, 0
    s_mov_b32 s35, 0
    s_cmp_eq_u32 s16, 2
    s_cbranch_scc1 qk_vloop
qk_loop:
    s_barrier
    v_add_u32 v3, s27, v1
    ds_read_b128 v[32:35], v3 offset:0
    ds_read_b128 v[36:39], v3 offset:18432
    ds_read_b128 v[40:43], v3 offset:1024
    ds_read_b128 v[44:47], v3 offset:19456
    ds_read_b128 v[48:51], v3 offset:2048
    ds_read_b128 v[52:55], v3 offset:20480
    s_add_u32 s23, s45, s95
    v_mov_b32 v4, s23
    s_mov_b64 exec, s[34:35]
    buffer_store_dword v4, off, s[4:7], s29 sc1
    buffer_store_dword v4, off, s[4:7], s29 offset:128 sc1
    s_mov_b64 exec, -1
    s_add_u32 s22, s27, 73728
    s_sub_u32 s21, s22, 110592
    s_cselect_b32 s22, s22, s21
    ds_read_b128 v[56:59], v3 offset:3072
    ds_read_b128 v[60:63], v3 offset:21504
    s_add_u32 s23, s22, s25
    s_add_u32 m0, s23, 0
    s_nop 0
    buffer_load_dwordx4 v2, s[8:11], s24 offen offset:0 lds
    s_waitcnt lgkmcnt(6)
    v_mfma_f32_16x16x32_bf16 v[208:211], v[64:67], v[32:35], 0
    v_mfma_f32_16x16x32_bf16 v[212:215], v[136:139], v[32:35], 0
    v_mfma_f32_16x16x32_bf16 v[216:219], v[64:67], v[36:39], 0
    v_mfma_f32_16x16x32_bf16 v[220:223], v[136:139], v[36:39], 0
    v_mfma_f32_16x16x32_bf16 v[224:227], a[0:3], v[32:35], 0
    v_mfma_f32_16x16x32_bf16 v[228:231], a[72:75], v[32:35], 0
    v_mfma_f32_16x16x32_bf16 v[232:235], a[0:3], v[36:39], 0
    v_mfma_f32_16x16x32_bf16 v[236:239], a[72:75], v[36:39], 0
    ds_read_b128 v[32:35], v3 offset:4096
    ds_read_b128 v[36:39], v3 offset:22528
    s_add_u32 m0, s23, 960
    s_nop 0
    buffer_load_dwordx4 v2, s[8:11], s24 offen offset:64 lds
    s_waitcnt lgkmcnt(6)
    v_mfma_f32_16x16x32_bf16 v[208:211], v[68:71], v[40:43], v[208:211]
    v_mfma_f32_16x16x32_bf16 v[212:215], v[140:143], v[40:43], v[212:215]
    v_mfma_f32_16x16x32_bf16 v[216:219], v[68:71], v[44:47], v[216:219]
    v_mfma_f32_16x16x32_bf16 v[220:223], v[140:143], v[44:47], v[220:223]
    v_mfma_f32_16x16x32_bf16 v[224:227], a[4:7], v[40:43], v[224:227]
    v_mfma_f32_16x16x32_bf16 v[228:231], a[76:79], v[40:43], v[228:231]
    v_mfma_f32_16x16x32_bf16 v[232:235], a[4:7], v[44:47], v[232:235]
    v_mfma_f32_16x16x32_bf16 v[236:239], a[76:79], v[44:47], v[236:239]
    ds_read_b128 v[40:43], v3 offset:5120
    ds_read_b128 v[44:47], v3 offset:23552
    s_add_u32 m0, s23, 1920
    s_nop 0
    buffer_load_dwordx4 v2, s[8:11], s24 offen offset:128 lds
    s_waitcnt lgkmcnt(6)
    v_mfma_f32_16x16x32_bf16 v[208:211], v[72:75], v[48:51], v[208:211]
    v_mfma_f32_16x16x32_bf16 v[212:215], v[144:147], v[48:51], v[212:215]
    v_mfma_f32_16x16x32_bf16 v[216:219], v[72:75], v[52:55], v[216:219]
    v_mfma_f32_16x16x32_bf16 v[220:223], v[144:147], v[52:55], v[220:223]
    v_mfma_f32_16x16x32_bf16 v[224:227], a[8:11], v[48:51], v[224:227]
    v_mfma_f32_16x16x32_bf16 v[228:231], a[80:83], v[48:51], v[228:231]
    v_mfma_f32_16x16x32_bf16 v[232:235], a[8:11], v[52:55], v[232:235]
    v_mfma_f32_16x16x32_bf16 v[236:239], a[80:83], v[52:55], v[236:239]
    ds_read_b128 v[48:51], v3 offset:6144
    ds_read_b128 v[52:55], v3 offset:24576
    s_add_u32 m0, s23, 2880
    s_nop 0
    buffer_load_dwordx4 v2, s[8:11], s24 offen offset:192 lds
    s_waitcnt lgkmcnt(6)
    v_mfma_f32_16x16x32_bf16 v[208:211], v[76:79], v[56:59], v[208:211]
    v_mfma_f32_16x16x32_bf16 v[212:215], v[148:151], v[56:59], v[212:215]
    v_mfma_f32_16x16x32_bf16 v[216:219], v[76:79], v[60:63], v[216:219]
    v_mfma_f32_16x16x32_bf16 v[220:223], v[148:151], v[60:63], v[220:223]
    v_mfma_f32_16x16x32_bf16 v[224:227], a[12:15], v[56:59], v[224:227]
    v_mfma_f32_16x16x32_bf16 v[228:231], a[84:87], v[56:59], v[228:231]
    v_mfma_f32_16x16x32_bf16 v[232:235], a[12:15], v[60:63], v[232:235]
    v_mfma_f32_16x16x32_bf16 v[236:239], a[84:87], v[60:63], v[236:239]
    ds_read_b128 v[56:59], v3 offset:7168
    ds_read_b128 v[60:63], v3 offset:25600
    s_add_u32 m0, s23, 3840
    s_nop 0
    buffer_load_dwordx4 v2, s[8:11], s24 offen offset:256 lds
    s_waitcnt lgkmcnt(6)
    v_mfma_f32_16x16x32_bf16 v[208:211], v[80:83], v[32:35], v[208:211]
    v_mfma_f32_16x16x32_bf16 v[212:215], v[152:155], v[32:35], v[212:215]
    v_mfma_f32_16x16x32_bf16 v[216:219], v[80:83], v[36:39], v[216:219]
    v_mfma_f32_16x16x32_bf16 v[220:223], v[152:155], v[36:39], v[220:223]
    v_mfma_f32_16x16x32_bf16 v[224:227], a[16:19], v[32:35], v[224:227]
    v_mfma_f32_16x16x32_bf16 v[228:231], a[88:91], v[32:35], v[228:231]
    v_mfma_f32_16x16x32_bf16 v[232:235], a[16:19], v[36:39], v[232:235]
    v_mfma_f32_16x16x32_bf16 v[236:239], a[88:91], v[36:39], v[236:239]
    ds_read_b128 v[32:35], v3 offset:8192
    ds_read_b128 v[36:39], v3 offset:26624
    s_add_u32 m0, s23, 4800
    s_nop 0
    buffer_load_dwordx4 v2, s[8:11], s24 offen offset:320 lds
    s_waitcnt lgkmcnt(6)
    v_mfma_f32_16x16x32_bf16 v[208:211], v[84:87], v[40:43], v[208:211]
    v_mfma_f32_16x16x32_bf16 v[212:215], v[156:159], v[40:43], v[212:215]
    v_mfma_f32_16x16x32_bf16 v[216:219], v[84:87], v[44:47], v[216:219]
    v_mfma_f32_16x16x32_bf16 v[220:223], v[156:159], v[44:47], v[220:223]
    v_mfma_f32_16x16x32_bf16 v[224:227], a[20:23], v[40:43], v[224:227]
    v_mfma_f32_16x16x32_bf16 v[228:231], a[92:95], v[40:43], v[228:231]
    v_mfma_f32_16x16x32_bf16 v[232:235], a[20:23], v[44:47], v[232:235]
    v_mfma_f32_16x16x32_bf16 v[236:239], a[92:95], v[44:47], v[236:239]
    ds_read_b128 v[40:43], v3 offset:9216
    ds_read_b128 v[44:47], v3 offset:27648
    s_add_u32 m0, s23, 5760
    s_nop 0
    buffer_load_dwordx4 v2, s[8:11], s24 offen offset:384 lds
    s_waitcnt lgkmcnt(6)
    v_mfma_f32_16x16x32_bf16 v[208:211], v[88:91], v[48:51], v[208:211]
    v_mfma_f32_16x16x32_bf16 v[212:215], v[160:163], v[48:51], v[212:215]
    v_mfma_f32_16x16x32_bf16 v[216:219], v[88:91], v[52:55], v[216:219]
    v_mfma_f32_16x16x32_bf16 v[220:223], v[160:163], v[52:55], v[220:223]
    v_mfma_f32_16x16x32_bf16 v[224:227], a[24:27], v[48:51], v[224:227]
    v_mfma_f32_16x16x32_bf16 v[228:231], a[96:99], v[48:51], v[228:231]
    v_mfma_f32_16x16x32_bf16 v[232:235], a[24:27], v[52:55], v[232:235]
    v_mfma_f32_16x16x32_bf16 v[236:239], a[96:99], v[52:55], v[236:239]
    ds_read_b128 v[48:51], v3 offset:10240
    ds_read_b128 v[52:55], v3 offset:28672
    s_add_u32 m0, s23, 6720
    s_nop 0
    buffer_load_dwordx4 v2, s[8:11], s24 offen offset:448 lds
    s_waitcnt lgkmcnt(6)
    v_mfma_f32_16x16x32_bf16 v[208:211], v[92:95], v[56:59], v[208:211]
    v_mfma_f32_16x16x32_bf16 v[212:215], v[164:167], v[56:59], v[212:215]
    v_mfma_f32_16x16x32_bf16 v[216:219], v[92:95], v[60:63], v[216:219]
    v_mfma_f32_16x16x32_bf16 v[220:223], v[164:167], v[60:63], v[220:223]
    v_mfma_f32_16x16x32_bf16 v[224:227], a[28:31], v[56:59], v[224:227]
    v_mfma_f32_16x16x32_bf16 v[228:231], a[100:103], v[56:59], v[228:231]
    v_mfma_f32_16x16x32_bf16 v[232:235], a[28:31], v[60:63], v[232:235]
    v_mfma_f32_16x16x32_bf16 v[236:239], a[100:103], v[60:63], v[236:239]
    ds_read_b128 v[56:59], v3 offset:11264
    ds_read_b128 v[60:63], v3 offset:29696
    s_add_u32 m0, s23, 7680
    s_nop 0
    buffer_load_dwordx4 v2, s[8:11], s24 offen offset:512 lds
    s_add_u32 s24, s24, 147456
    s_waitcnt lgkmcnt(6)
    v_mfma_f32_16x16x32_bf16 v[208:211], v[96:99], v[32:35], v[208:211]
    v_mfma_f32_16x16x32_bf16 v[212:215], v[168:171], v[32:35], v[212:215]
    v_mfma_f32_16x16x32_bf16 v[216:219], v[96:99], v[36:39], v[216:219]
    v_mfma_f32_16x16x32_bf16 v[220:223], v[168:171], v[36:39], v[220:223]
    v_mfma_f32_16x16x32_bf16 v[224:227], a[32:35], v[32:35], v[224:227]
    v_mfma_f32_16x16x32_bf16 v[228:231], a[104:107], v[32:35], v[228:231]
    v_mfma_f32_16x16x32_bf16 v[232:235], a[32:35], v[36:39], v[232:235]
    v_mfma_f32_16x16x32_bf16 v[236:239], a[104:107], v[36:39], v[236:239]
    ds_read_b128 v[32:35], v3 offset:12288
    ds_read_b128 v[36:39], v3 offset:30720
    s_waitcnt lgkmcnt(6)
    v_mfma_f32_16x16x32_bf16 v[208:211], v[100:103], v[40:43], v[208:211]
    v_mfma_f32_16x16x32_bf16 v[212:215], v[172:175], v[40:43], v[212:215]
    v_mfma_f32_16x16x32_bf16 v[216:219], v[100:103], v[44:47], v[216:219]
    v_mfma_f32_16x16x32_bf16 v[220:223], v[172:175], v[44:47], v[220:223]
    v_mfma_f32_16x16x32_bf16 v[224:227], a[36:39], v[40:43], v[224:227]
    v_mfma_f32_16x16x32_bf16 v[228:231], a[108:111], v[40:43], v[228:231]
    v_mfma_f32_16x16x32_bf16 v[232:235], a[36:39], v[44:47], v[232:235]
    v_mfma_f32_16x16x32_bf16 v[236:239], a[108:111], v[44:47], v[236:239]
    ds_read_b128 v[40:43], v3 offset:13312
    ds_read_b128 v[44:47], v3 offset:31744
    s_waitcnt lgkmcnt(6)
    v_mfma_f32_16x16x32_bf16 v[208:211], v[104:107], v[48:51], v[208:211]
    v_mfma_f32_16x16x32_bf16 v[212:215], v[176:179], v[48:51], v[212:215]
    v_mfma_f32_16x16x32_bf16 v[216:219], v[104:107], v[52:55], v[216:219]
    v_mfma_f32_16x16x32_bf16 v[220:223], v[176:179], v[52:55], v[220:223]
    v_mfma_f32_16x16x32_bf16 v[224:227], a[40:43], v[48:51], v[224:227]
    v_mfma_f32_16x16x32_bf16 v[228:231], a[112:115], v[48:51], v[228:231]
    v_mfma_f32_16x16x32_bf16 v[232:235], a[40:43], v[52:55], v[232:235]
    v_mfma_f32_16x16x32_bf16 v[236:239], a[112:115], v[52:55], v[236:239]
    ds_read_b128 v[48:51], v3 offset:14336
    ds_read_b128 v[52:55], v3 offset:32768
    s_waitcnt lgkmcnt(6)
    v_mfma_f32_16x16x32_bf16 v[208:211], v[108:111], v[56:59], v[208:211]
    v_mfma_f32_16x16x32_bf16 v[212:215], v[180:183], v[56:59], v[212:215]
    v_mfma_f32_16x16x32_bf16 v[216:219], v[108:111], v[60:63], v[216:219]
    v_mfma_f32_16x16x32_bf16 v[220:223], v[180:183], v[60:63], v[220:223]
    v_mfma_f32_16x16x32_bf16 v[224:227], a[44:47], v[56:59], v[224:227]
    v_mfma_f32_16x16x32_bf16 v[228:231], a[116:119], v[56:59], v[228:231]
    v_mfma_f32_16x16x32_bf16 v[232:235], a[44:47], v[60:63], v[232:235]
    v_mfma_f32_16x16x32_bf16 v[236:239], a[116:119], v[60:63], v[236:239]
    ds_read_b128 v[56:59], v3 offset:15360
    ds_read_b128 v[60:63], v3 offset:33792
    s_waitcnt lgkmcnt(6)
    v_mfma_f32_16x16x32_bf16 v[208:211], v[112:115], v[32:35], v[208:211]
    v_mfma_f32_16x16x32_bf16 v[212:215], v[184:187], v[32:35], v[212:215]
    v_mfma_f32_16x16x32_bf16 v[216:219], v[112:115], v[36:39], v[216:219]
    v_mfma_f32_16x16x32_bf16 v[220:223], v[184:187], v[36:39], v[220:223]
    v_mfma_f32_16x16x32_bf16 v[224:227], a[48:51], v[32:35], v[224:227]
    v_mfma_f32_16x16x32_bf16 v[228:231], a[120:123], v[32:35], v[228:231]
    v_mfma_f32_16x16x32_bf16 v[232:235], a[48:51], v[36:39], v[232:235]
    v_mfma_f32_16x16x32_bf16 v[236:239], a[120:123], v[36:39], v[236:239]
    ds_read_b128 v[32:35], v3 offset:16384
    ds_read_b128 v[36:39], v3 offset:34816
    s_waitcnt lgkmcnt(6)
    v_mfma_f32_16x16x32_bf16 v[208:211], v[116:119], v[40:43], v[208:211]
    v_mfma_f32_16x16x32_bf16 v[212:215], v[188:191], v[40:43], v[212:215]
    v_mfma_f32_16x16x32_bf16 v[216:219], v[116:119], v[44:47], v[216:219]
    v_mfma_f32_16x16x32_bf16 v[220:223], v[188:191], v[44:47], v[220:223]
    v_mfma_f32_16x16x32_bf16 v[224:227], a[52:55], v[40:43], v[224:227]
    v_mfma_f32_16x16x32_bf16 v[228:231], a[124:127], v[40:43], v[228:231]
    v_mfma_f32_16x16x32_bf16 v[232:235], a[52:55], v[44:47], v[232:235]
    v_mfma_f32_16x16x32_bf16 v[236:239], a[124:127], v[44:47], v[236:239]
    ds_read_b128 v[40:43], v3 offset:17408
    ds_read_b128 v[44:47], v3 offset:35840
    s_waitcnt lgkmcnt(6)
    v_mfma_f32_16x16x32_bf16 v[208:211], v[120:123], v[48:51], v[208:211]
    v_mfma_f32_16x16x32_bf16 v[212:215], v[192:195], v[48:51], v[212:215]
    v_mfma_f32_16x16x32_bf16 v[216:219], v[120:123], v[52:55], v[216:219]
    v_mfma_f32_16x16x32_bf16 v[220:223], v[192:195], v[52:55], v[220:223]
    v_mfma_f32_16x16x32_bf16 v[224:227], a[56:59], v[48:51], v[224:227]
    v_mfma_f32_16x16x32_bf16 v[228:231], a[128:131], v[48:51], v[228:231]
    v_mfma_f32_16x16x32_bf16 v[232:235], a[56:59], v[52:55], v[232:235]
    v_mfma_f32_16x16x32_bf16 v[236:239], a[128:131], v[52:55], v[236:239]
    s_waitcnt lgkmcnt(4)
    v_mfma_f32_16x16x32_bf16 v[208:211], v[124:127], v[56:59], v[208:211]
    v_mfma_f32_16x16x32_bf16 v[212:215], v[196:199], v[56:59], v[212:215]
    v_mfma_f32_16x16x32_bf16 v[216:219], v[124:127], v[60:63], v[216:219]
    v_mfma_f32_16x16x32_bf16 v[220:223], v[196:199], v[60:63], v[220:223]
    v_mfma_f32_16x16x32_bf16 v[224:227], a[60:63], v[56:59], v[224:227]
    v_mfma_f32_16x16x32_bf16 v[228:231], a[132:135], v[56:59], v[228:231]
    v_mfma_f32_16x16x32_bf16 v[232:235], a[60:63], v[60:63], v[232:235]
    v_mfma_f32_16x16x32_bf16 v[236:239], a[132:135], v[60:63], v[236:239]
    s_waitcnt lgkmcnt(2)
    v_mfma_f32_16x16x32_bf16 v[208:211], v[128:131], v[32:35], v[208:211]
    v_mfma_f32_16x16x32_bf16 v[212:215], v[200:203], v[32:35], v[212:215]
    v_mfma_f32_16x16x32_bf16 v[216:219], v[128:131], v[36:39], v[216:219]
    v_mfma_f32_16x16x32_bf16 v[220:223], v[200:203], v[36:39], v[220:223]
    v_mfma_f32_16x16x32_bf16 v[224:227], a[64:67], v[32:35], v[224:227]
    v_mfma_f32_16x16x32_bf16 v[228:231], a[136:139], v[32:35], v[228:231]
    v_mfma_f32_16x16x32_bf16 v[232:235], a[64:67], v[36:39], v[232:235]
    v_mfma_f32_16x16x32_bf16 v[236:239], a[136:139], v[36:39], v[236:239]
    s_waitcnt lgkmcnt(0)
    v_mfma_f32_16x16x32_bf16 v[208:211], v[132:135], v[40:43], v[208:211]
    v_mfma_f32_16x16x32_bf16 v[212:215], v[204:207], v[40:43], v[212:215]
    v_mfma_f32_16x16x32_bf16 v[216:219], v[132:135], v[44:47], v[216:219]
    v_mfma_f32_16x16x32_bf16 v[220:223], v[204:207], v[44:47], v[220:223]
    v_mfma_f32_16x16x32_bf16 v[224:227], a[68:71], v[40:43], v[224:227]
    v_mfma_f32_16x16x32_bf16 v[228:231], a[140:143], v[40:43], v[228:231]
    v_mfma_f32_16x16x32_bf16 v[232:235], a[68:71], v[44:47], v[232:235]
    v_mfma_f32_16x16x32_bf16 v[236:239], a[140:143], v[44:47], v[236:239]
    s_waitcnt vmcnt(0)
    v_cvt_pk_bf16_f32 v8, v208, v209
    v_cvt_pk_bf16_f32 v9, v210, v211
    v_cvt_pk_bf16_f32 v10, v212, v213
    v_cvt_pk_bf16_f32 v11, v214, v215
    s_lshr_b32 s22, s41, 5
    s_mul_i32 s22, s22, 0
    s_add_u32 s28, s26, s22
    buffer_store_dwordx4 v[8:11], v7, s[4:7], s28 offen sc1
    v_cvt_pk_bf16_f32 v12, v216, v217
    v_cvt_pk_bf16_f32 v13, v218, v219
    v_cvt_pk_bf16_f32 v14, v220, v221
    v_cvt_pk_bf16_f32 v15, v222, v223
    s_lshr_b32 s22, s41, 5
    s_mul_i32 s22, s22, 0
    s_add_u32 s28, s26, s22
    s_add_u32 s28, s28, s40
    buffer_store_dwordx4 v[12:15], v7, s[4:7], s28 offen sc1
    v_cvt_pk_bf16_f32 v16, v224, v225
    v_cvt_pk_bf16_f32 v17, v226, v227
    v_cvt_pk_bf16_f32 v18, v228, v229
    v_cvt_pk_bf16_f32 v19, v230, v231
    s_lshr_b32 s22, s41, 5
    s_mul_i32 s22, s22, 1
    s_add_u32 s28, s26, s22
    buffer_store_dwordx4 v[16:19], v7, s[4:7], s28 offen sc1
    v_cvt_pk_bf16_f32 v20, v232, v233
    v_cvt_pk_bf16_f32 v21, v234, v235
    v_cvt_pk_bf16_f32 v22, v236, v237
    v_cvt_pk_bf16_f32 v23, v238, v239
    s_lshr_b32 s22, s41, 5
    s_mul_i32 s22, s22, 1
    s_add_u32 s28, s26, s22
    s_add_u32 s28, s28, s40
    buffer_store_dwordx4 v[20:23], v7, s[4:7], s28 offen sc1
    s_lshl_b32 s22, s41, 2
    s_add_u32 s26, s26, s22
    s_lshr_b32 s45, s19, 2
    s_cbranch_scc1 qk_loop_nf
    s_waitcnt vmcnt(0)
    s_mov_b32 s45, 1
qk_loop_nf:
    s_add_u32 s27, s27, 36864
    s_cmp_eq_u32 s27, 110592
    s_cselect_b32 s27, 0, s27
    s_add_u32 s19, s19, 4
    s_cmp_lt_u32 s19, s20
    s_cbranch_scc1 qk_loop
    s_branch qk_done
qk_vloop:
    s_barrier
    v_add_u32 v3, s27, v1
    ds_read_b128 v[32:35], v3 offset:0
    ds_read_b128 v[36:39], v3 offset:18432
    ds_read_b128 v[40:43], v3 offset:1024
    ds_read_b128 v[44:47], v3 offset:19456
    ds_read_b128 v[48:51], v3 offset:2048
    ds_read_b128 v[52:55], v3 offset:20480
    s_add_u32 s23, s45, s95
    v_mov_b32 v4, s23
    s_mov_b64 exec, s[34:35]
    buffer_store_dword v4, off, s[4:7], s29 sc1
    buffer_store_dword v4, off, s[4:7], s29 offset:128 sc1
    s_mov_b64 exec, -1
    s_add_u32 s22, s27, 73728
    s_sub_u32 s21, s22, 110592
    s_cselect_b32 s22, s22, s21
    ds_read_b128 v[56:59], v3 offset:3072
    ds_read_b128 v[60:63], v3 offset:21504
    s_add_u32 s23, s22, s25
    s_add_u32 m0, s23, 0
    s_nop 0
    buffer_load_dwordx4 v2, s[8:11], s24 offen offset:0 lds
    s_waitcnt lgkmcnt(6)
    v_mfma_f32_16x16x32_bf16 v[208:211], v[32:35], v[64:67], 0
    v_mfma_f32_16x16x32_bf16 v[212:215], v[32:35], v[136:139], 0
    v_mfma_f32_16x16x32_bf16 v[216:219], v[36:39], v[64:67], 0
    v_mfma_f32_16x16x32_bf16 v[220:223], v[36:39], v[136:139], 0
    v_mfma_f32_16x16x32_bf16 v[224:227], v[32:35], a[0:3], 0
    v_mfma_f32_16x16x32_bf16 v[228:231], v[32:35], a[72:75], 0
    v_mfma_f32_16x16x32_bf16 v[232:235], v[36:39], a[0:3], 0
    v_mfma_f32_16x16x32_bf16 v[236:239], v[36:39], a[72:75], 0
    ds_read_b128 v[32:35], v3 offset:4096
    ds_read_b128 v[36:39], v3 offset:22528
    s_add_u32 m0, s23, 960
    s_nop 0
    buffer_load_dwordx4 v2, s[8:11], s24 offen offset:64 lds
    s_waitcnt lgkmcnt(6)
    v_mfma_f32_16x16x32_bf16 v[208:211], v[40:43], v[68:71], v[208:211]
    v_mfma_f32_16x16x32_bf16 v[212:215], v[40:43], v[140:143], v[212:215]
    v_mfma_f32_16x16x32_bf16 v[216:219], v[44:47], v[68:71], v[216:219]
    v_mfma_f32_16x16x32_bf16 v[220:223], v[44:47], v[140:143], v[220:223]
    v_mfma_f32_16x16x32_bf16 v[224:227], v[40:43], a[4:7], v[224:227]
    v_mfma_f32_16x16x32_bf16 v[228:231], v[40:43], a[76:79], v[228:231]
    v_mfma_f32_16x16x32_bf16 v[232:235], v[44:47], a[4:7], v[232:235]
    v_mfma_f32_16x16x32_bf16 v[236:239], v[44:47], a[76:79], v[236:239]
    ds_read_b128 v[40:43], v3 offset:5120
    ds_read_b128 v[44:47], v3 offset:23552
    s_add_u32 m0, s23, 1920
    s_nop 0
    buffer_load_dwordx4 v2, s[8:11], s24 offen offset:128 lds
    s_waitcnt lgkmcnt(6)
    v_mfma_f32_16x16x32_bf16 v[208:211], v[48:51], v[72:75], v[208:211]
    v_mfma_f32_16x16x32_bf16 v[212:215], v[48:51], v[144:147], v[212:215]
    v_mfma_f32_16x16x32_bf16 v[216:219], v[52:55], v[72:75], v[216:219]
    v_mfma_f32_16x16x32_bf16 v[220:223], v[52:55], v[144:147], v[220:223]
    v_mfma_f32_16x16x32_bf16 v[224:227], v[48:51], a[8:11], v[224:227]
    v_mfma_f32_16x16x32_bf16 v[228:231], v[48:51], a[80:83], v[228:231]
    v_mfma_f32_16x16x32_bf16 v[232:235], v[52:55], a[8:11], v[232:235]
    v_mfma_f32_16x16x32_bf16 v[236:239], v[52:55], a[80:83], v[236:239]
    ds_read_b128 v[48:51], v3 offset:6144
    ds_read_b128 v[52:55], v3 offset:24576
    s_add_u32 m0, s23, 2880
    s_nop 0
    buffer_load_dwordx4 v2, s[8:11], s24 offen offset:192 lds
    s_waitcnt lgkmcnt(6)
    v_mfma_f32_16x16x32_bf16 v[208:211], v[56:59], v[76:79], v[208:211]
    v_mfma_f32_16x16x32_bf16 v[212:215], v[56:59], v[148:151], v[212:215]
    v_mfma_f32_16x16x32_bf16 v[216:219], v[60:63], v[76:79], v[216:219]
    v_mfma_f32_16x16x32_bf16 v[220:223], v[60:63], v[148:151], v[220:223]
    v_mfma_f32_16x16x32_bf16 v[224:227], v[56:59], a[12:15], v[224:227]
    v_mfma_f32_16x16x32_bf16 v[228:231], v[56:59], a[84:87], v[228:231]
    v_mfma_f32_16x16x32_bf16 v[232:235], v[60:63], a[12:15], v[232:235]
    v_mfma_f32_16x16x32_bf16 v[236:239], v[60:63], a[84:87], v[236:239]
    ds_read_b128 v[56:59], v3 offset:7168
    ds_read_b128 v[60:63], v3 offset:25600
    s_add_u32 m0, s23, 3840
    s_nop 0
    buffer_load_dwordx4 v2, s[8:11], s24 offen offset:256 lds
    s_waitcnt lgkmcnt(6)
    v_mfma_f32_16x16x32_bf16 v[208:211], v[32:35], v[80:83], v[208:211]
    v_mfma_f32_16x16x32_bf16 v[212:215], v[32:35], v[152:155], v[212:215]
    v_mfma_f32_16x16x32_bf16 v[216:219], v[36:39], v[80:83], v[216:219]
    v_mfma_f32_16x16x32_bf16 v[220:223], v[36:39], v[152:155], v[220:223]
    v_mfma_f32_16x16x32_bf16 v[224:227], v[32:35], a[16:19], v[224:227]
    v_mfma_f32_16x16x32_bf16 v[228:231], v[32:35], a[88:91], v[228:231]
    v_mfma_f32_16x16x32_bf16 v[232:235], v[36:39], a[16:19], v[232:235]
    v_mfma_f32_16x16x32_bf16 v[236:239], v[36:39], a[88:91], v[236:239]
    ds_read_b128 v[32:35], v3 offset:8192
    ds_read_b128 v[36:39], v3 offset:26624
    s_add_u32 m0, s23, 4800
    s_nop 0
    buffer_load_dwordx4 v2, s[8:11], s24 offen offset:320 lds
    s_waitcnt lgkmcnt(6)
    v_mfma_f32_16x16x32_bf16 v[208:211], v[40:43], v[84:87], v[208:211]
    v_mfma_f32_16x16x32_bf16 v[212:215], v[40:43], v[156:159], v[212:215]
    v_mfma_f32_16x16x32_bf16 v[216:219], v[44:47], v[84:87], v[216:219]
    v_mfma_f32_16x16x32_bf16 v[220:223], v[44:47], v[156:159], v[220:223]
    v_mfma_f32_16x16x32_bf16 v[224:227], v[40:43], a[20:23], v[224:227]
    v_mfma_f32_16x16x32_bf16 v[228:231], v[40:43], a[92:95], v[228:231]
    v_mfma_f32_16x16x32_bf16 v[232:235], v[44:47], a[20:23], v[232:235]
    v_mfma_f32_16x16x32_bf16 v[236:239], v[44:47], a[92:95], v[236:239]
    ds_read_b128 v[40:43], v3 offset:9216
    ds_read_b128 v[44:47], v3 offset:27648
    s_add_u32 m0, s23, 5760
    s_nop 0
    buffer_load_dwordx4 v2, s[8:11], s24 offen offset:384 lds
    s_waitcnt lgkmcnt(6)
    v_mfma_f32_16x16x32_bf16 v[208:211], v[48:51], v[88:91], v[208:211]
    v_mfma_f32_16x16x32_bf16 v[212:215], v[48:51], v[160:163], v[212:215]
    v_mfma_f32_16x16x32_bf16 v[216:219], v[52:55], v[88:91], v[216:219]
    v_mfma_f32_16x16x32_bf16 v[220:223], v[52:55], v[160:163], v[220:223]
    v_mfma_f32_16x16x32_bf16 v[224:227], v[48:51], a[24:27], v[224:227]
    v_mfma_f32_16x16x32_bf16 v[228:231], v[48:51], a[96:99], v[228:231]
    v_mfma_f32_16x16x32_bf16 v[232:235], v[52:55], a[24:27], v[232:235]
    v_mfma_f32_16x16x32_bf16 v[236:239], v[52:55], a[96:99], v[236:239]
    ds_read_b128 v[48:51], v3 offset:10240
    ds_read_b128 v[52:55], v3 offset:28672
    s_add_u32 m0, s23, 6720
    s_nop 0
    buffer_load_dwordx4 v2, s[8:11], s24 offen offset:448 lds
    s_waitcnt lgkmcnt(6)
    v_mfma_f32_16x16x32_bf16 v[208:211], v[56:59], v[92:95], v[208:211]
    v_mfma_f32_16x16x32_bf16 v[212:215], v[56:59], v[164:167], v[212:215]
    v_mfma_f32_16x16x32_bf16 v[216:219], v[60:63], v[92:95], v[216:219]
    v_mfma_f32_16x16x32_bf16 v[220:223], v[60:63], v[164:167], v[220:223]
    v_mfma_f32_16x16x32_bf16 v[224:227], v[56:59], a[28:31], v[224:227]
    v_mfma_f32_16x16x32_bf16 v[228:231], v[56:59], a[100:103], v[228:231]
    v_mfma_f32_16x16x32_bf16 v[232:235], v[60:63], a[28:31], v[232:235]
    v_mfma_f32_16x16x32_bf16 v[236:239], v[60:63], a[100:103], v[236:239]
    ds_read_b128 v[56:59], v3 offset:11264
    ds_read_b128 v[60:63], v3 offset:29696
    s_add_u32 m0, s23, 7680
    s_nop 0
    buffer_load_dwordx4 v2, s[8:11], s24 offen offset:512 lds
    s_add_u32 s24, s24, 147456
    s_waitcnt lgkmcnt(6)
    v_mfma_f32_16x16x32_bf16 v[208:211], v[32:35], v[96:99], v[208:211]
    v_mfma_f32_16x16x32_bf16 v[212:215], v[32:35], v[168:171], v[212:215]
    v_mfma_f32_16x16x32_bf16 v[216:219], v[36:39], v[96:99], v[216:219]
    v_mfma_f32_16x16x32_bf16 v[220:223], v[36:39], v[168:171], v[220:223]
    v_mfma_f32_16x16x32_bf16 v[224:227], v[32:35], a[32:35], v[224:227]
    v_mfma_f32_16x16x32_bf16 v[228:231], v[32:35], a[104:107], v[228:231]
    v_mfma_f32_16x16x32_bf16 v[232:235], v[36:39], a[32:35], v[232:235]
    v_mfma_f32_16x16x32_bf16 v[236:239], v[36:39], a[104:107], v[236:239]
    ds_read_b128 v[32:35], v3 offset:12288
    ds_read_b128 v[36:39], v3 offset:30720
    s_waitcnt lgkmcnt(6)
    v_mfma_f32_16x16x32_bf16 v[208:211], v[40:43], v[100:103], v[208:211]
    v_mfma_f32_16x16x32_bf16 v[212:215], v[40:43], v[172:175], v[212:215]
    v_mfma_f32_16x16x32_bf16 v[216:219], v[44:47], v[100:103], v[216:219]
    v_mfma_f32_16x16x32_bf16 v[220:223], v[44:47], v[172:175], v[220:223]
    v_mfma_f32_16x16x32_bf16 v[224:227], v[40:43], a[36:39], v[224:227]
    v_mfma_f32_16x16x32_bf16 v[228:231], v[40:43], a[108:111], v[228:231]
    v_mfma_f32_16x16x32_bf16 v[232:235], v[44:47], a[36:39], v[232:235]
    v_mfma_f32_16x16x32_bf16 v[236:239], v[44:47], a[108:111], v[236:239]
    ds_read_b128 v[40:43], v3 offset:13312
    ds_read_b128 v[44:47], v3 offset:31744
    s_waitcnt lgkmcnt(6)
    v_mfma_f32_16x16x32_bf16 v[208:211], v[48:51], v[104:107], v[208:211]
    v_mfma_f32_16x16x32_bf16 v[212:215], v[48:51], v[176:179], v[212:215]
    v_mfma_f32_16x16x32_bf16 v[216:219], v[52:55], v[104:107], v[216:219]
    v_mfma_f32_16x16x32_bf16 v[220:223], v[52:55], v[176:179], v[220:223]
    v_mfma_f32_16x16x32_bf16 v[224:227], v[48:51], a[40:43], v[224:227]
    v_mfma_f32_16x16x32_bf16 v[228:231], v[48:51], a[112:115], v[228:231]
    v_mfma_f32_16x16x32_bf16 v[232:235], v[52:55], a[40:43], v[232:235]
    v_mfma_f32_16x16x32_bf16 v[236:239], v[52:55], a[112:115], v[236:239]
    ds_read_b128 v[48:51], v3 offset:14336
    ds_read_b128 v[52:55], v3 offset:32768
    s_waitcnt lgkmcnt(6)
    v_mfma_f32_16x16x32_bf16 v[208:211], v[56:59], v[108:111], v[208:211]
    v_mfma_f32_16x16x32_bf16 v[212:215], v[56:59], v[180:183], v[212:215]
    v_mfma_f32_16x16x32_bf16 v[216:219], v[60:63], v[108:111], v[216:219]
    v_mfma_f32_16x16x32_bf16 v[220:223], v[60:63], v[180:183], v[220:223]
    v_mfma_f32_16x16x32_bf16 v[224:227], v[56:59], a[44:47], v[224:227]
    v_mfma_f32_16x16x32_bf16 v[228:231], v[56:59], a[116:119], v[228:231]
    v_mfma_f32_16x16x32_bf16 v[232:235], v[60:63], a[44:47], v[232:235]
    v_mfma_f32_16x16x32_bf16 v[236:239], v[60:63], a[116:119], v[236:239]
    ds_read_b128 v[56:59], v3 offset:15360
    ds_read_b128 v[60:63], v3 offset:33792
    s_waitcnt lgkmcnt(6)
    v_mfma_f32_16x16x32_bf16 v[208:211], v[32:35], v[112:115], v[208:211]
    v_mfma_f32_16x16x32_bf16 v[212:215], v[32:35], v[184:187], v[212:215]
    v_mfma_f32_16x16x32_bf16 v[216:219], v[36:39], v[112:115], v[216:219]
    v_mfma_f32_16x16x32_bf16 v[220:223], v[36:39], v[184:187], v[220:223]
    v_mfma_f32_16x16x32_bf16 v[224:227], v[32:35], a[48:51], v[224:227]
    v_mfma_f32_16x16x32_bf16 v[228:231], v[32:35], a[120:123], v[228:231]
    v_mfma_f32_16x16x32_bf16 v[232:235], v[36:39], a[48:51], v[232:235]
    v_mfma_f32_16x16x32_bf16 v[236:239], v[36:39], a[120:123], v[236:239]
    ds_read_b128 v[32:35], v3 offset:16384
    ds_read_b128 v[36:39], v3 offset:34816
    s_waitcnt lgkmcnt(6)
    v_mfma_f32_16x16x32_bf16 v[208:211], v[40:43], v[116:119], v[208:211]
    v_mfma_f32_16x16x32_bf16 v[212:215], v[40:43], v[188:191], v[212:215]
    v_mfma_f32_16x16x32_bf16 v[216:219], v[44:47], v[116:119], v[216:219]
    v_mfma_f32_16x16x32_bf16 v[220:223], v[44:47], v[188:191], v[220:223]
    v_mfma_f32_16x16x32_bf16 v[224:227], v[40:43], a[52:55], v[224:227]
    v_mfma_f32_16x16x32_bf16 v[228:231], v[40:43], a[124:127], v[228:231]
    v_mfma_f32_16x16x32_bf16 v[232:235], v[44:47], a[52:55], v[232:235]
    v_mfma_f32_16x16x32_bf16 v[236:239], v[44:47], a[124:127], v[236:239]
    ds_read_b128 v[40:43], v3 offset:17408
    ds_read_b128 v[44:47], v3 offset:35840
    s_waitcnt lgkmcnt(6)
    v_mfma_f32_16x16x32_bf16 v[208:211], v[48:51], v[120:123], v[208:211]
    v_mfma_f32_16x16x32_bf16 v[212:215], v[48:51], v[192:195], v[212:215]
    v_mfma_f32_16x16x32_bf16 v[216:219], v[52:55], v[120:123], v[216:219]
    v_mfma_f32_16x16x32_bf16 v[220:223], v[52:55], v[192:195], v[220:223]
    v_mfma_f32_16x16x32_bf16 v[224:227], v[48:51], a[56:59], v[224:227]
    v_mfma_f32_16x16x32_bf16 v[228:231], v[48:51], a[128:131], v[228:231]
    v_mfma_f32_16x16x32_bf16 v[232:235], v[52:55], a[56:59], v[232:235]
    v_mfma_f32_16x16x32_bf16 v[236:239], v[52:55], a[128:131], v[236:239]
    s_waitcnt lgkmcnt(4)
    v_mfma_f32_16x16x32_bf16 v[208:211], v[56:59], v[124:127], v[208:211]
    v_mfma_f32_16x16x32_bf16 v[212:215], v[56:59], v[196:199], v[212:215]
    v_mfma_f32_16x16x32_bf16 v[216:219], v[60:63], v[124:127], v[216:219]
    v_mfma_f32_16x16x32_bf16 v[220:223], v[60:63], v[196:199], v[220:223]
    v_mfma_f32_16x16x32_bf16 v[224:227], v[56:59], a[60:63], v[224:227]
    v_mfma_f32_16x16x32_bf16 v[228:231], v[56:59], a[132:135], v[228:231]
    v_mfma_f32_16x16x32_bf16 v[232:235], v[60:63], a[60:63], v[232:235]
    v_mfma_f32_16x16x32_bf16 v[236:239], v[60:63], a[132:135], v[236:239]
    s_waitcnt lgkmcnt(2)
    v_mfma_f32_16x16x32_bf16 v[208:211], v[32:35], v[128:131], v[208:211]
    v_mfma_f32_16x16x32_bf16 v[212:215], v[32:35], v[200:203], v[212:215]
    v_mfma_f32_16x16x32_bf16 v[216:219], v[36:39], v[128:131], v[216:219]
    v_mfma_f32_16x16x32_bf16 v[220:223], v[36:39], v[200:203], v[220:223]
    v_mfma_f32_16x16x32_bf16 v[224:227], v[32:35], a[64:67], v[224:227]
    v_mfma_f32_16x16x32_bf16 v[228:231], v[32:35], a[136:139], v[228:231]
    v_mfma_f32_16x16x32_bf16 v[232:235], v[36:39], a[64:67], v[232:235]
    v_mfma_f32_16x16x32_bf16 v[236:239], v[36:39], a[136:139], v[236:239]
    s_waitcnt lgkmcnt(0)
    v_mfma_f32_16x16x32_bf16 v[208:211], v[40:43], v[132:135], v[208:211]
    v_mfma_f32_16x16x32_bf16 v[212:215], v[40:43], v[204:207], v[212:215]
    v_mfma_f32_16x16x32_bf16 v[216:219], v[44:47], v[132:135], v[216:219]
    v_mfma_f32_16x16x32_bf16 v[220:223], v[44:47], v[204:207], v[220:223]
    v_mfma_f32_16x16x32_bf16 v[224:227], v[40:43], a[68:71], v[224:227]
    v_mfma_f32_16x16x32_bf16 v[228:231], v[40:43], a[140:143], v[228:231]
    v_mfma_f32_16x16x32_bf16 v[232:235], v[44:47], a[68:71], v[232:235]
    v_mfma_f32_16x16x32_bf16 v[236:239], v[44:47], a[140:143], v[236:239]
    s_waitcnt vmcnt(0)
    v_cvt_pk_bf16_f32 v8, v208, v209
    v_cvt_pk_bf16_f32 v9, v210, v211
    v_cvt_pk_bf16_f32 v10, v216, v217
    v_cvt_pk_bf16_f32 v11, v218, v219
    s_lshr_b32 s22, s41, 5
    s_mul_i32 s22, s22, 0
    s_add_u32 s28, s26, s22
    buffer_store_dwordx4 v[8:11], v7, s[4:7], s28 offen sc1
    v_cvt_pk_bf16_f32 v12, v212, v213
    v_cvt_pk_bf16_f32 v13, v214, v215
    v_cvt_pk_bf16_f32 v14, v220, v221
    v_cvt_pk_bf16_f32 v15, v222, v223
    s_lshr_b32 s22, s41, 5
    s_mul_i32 s22, s22, 0
    s_add_u32 s28, s26, s22
    s_add_u32 s28, s28, s40
    buffer_store_dwordx4 v[12:15], v7, s[4:7], s28 offen sc1
    v_cvt_pk_bf16_f32 v16, v224, v225
    v_cvt_pk_bf16_f32 v17, v226, v227
    v_cvt_pk_bf16_f32 v18, v232, v233
    v_cvt_pk_bf16_f32 v19, v234, v235
    s_lshr_b32 s22, s41, 5
    s_mul_i32 s22, s22, 1
    s_add_u32 s28, s26, s22
    buffer_store_dwordx4 v[16:19], v7, s[4:7], s28 offen sc1
    v_cvt_pk_bf16_f32 v20, v228, v229
    v_cvt_pk_bf16_f32 v21, v230, v231
    v_cvt_pk_bf16_f32 v22, v236, v237
    v_cvt_pk_bf16_f32 v23, v238, v239
    s_lshr_b32 s22, s41, 5
    s_mul_i32 s22, s22, 1
    s_add_u32 s28, s26, s22
    s_add_u32 s28, s28, s40
    buffer_store_dwordx4 v[20:23], v7, s[4:7], s28 offen sc1
    s_lshl_b32 s22, s41, 2
    s_add_u32 s26, s26, s22
    s_lshr_b32 s45, s19, 2
    s_cbranch_scc1 qk_vloop_nf
    s_waitcnt vmcnt(0)
    s_mov_b32 s45, 1
qk_vloop_nf:
    s_add_u32 s27, s27, 36864
    s_cmp_eq_u32 s27, 110592
    s_cselect_b32 s27, 0, s27
    s_add_u32 s19, s19, 4
    s_cmp_lt_u32 s19, s20
    s_cbranch_scc1 qk_vloop
qk_done:
    s_waitcnt vmcnt(0)
    s_barrier
    s_mov_b32 s45, 16
    s_add_u32 s23, s45, s95
    v_mov_b32 v4, s23
    s_mov_b64 exec, s[34:35]
    buffer_store_dword v4, off, s[4:7], s29 sc1
    buffer_store_dword v4, off, s[4:7], s29 offset:128 sc1
    s_mov_b64 exec, -1
    s_cmp_eq_u32 s16, 0
    s_cbranch_scc1 L_qkv_next
    s_cmp_lg_u32 s19, 64
    s_cbranch_scc1 L_qkv_next
    v_and_b32 v4, 63, v0
    v_and_b32 v2, 7, v4
    v_lshrrev_b32 v5, 4, v4
    v_lshl_add_u32 v2, v5, 3, v2
    v_lshlrev_b32 v2, 4, v2
    v_bfe_u32 v3, v4, 3, 1
    v_mul_u32_u24 v5, 9216, v3
    v_add_u32 v2, v2, v5
    v_mov_b32 v240, 0x05040100
    v_mov_b32 v241, 0x07060302
    v_lshrrev_b32 v5, 5, v4
    v_and_b32 v1, 0xdff, v7
    s_cmp_eq_u32 s16, 2
    s_cbranch_scc1 mk_isv
    v_mov_b32 v5, v3
    v_or_b32 v1, 128, v7
mk_isv:
    v_lshl_add_u32 v1, v5, 17, v1
    s_mov_b32 s28, 0
    s_mov_b32 s19, 2
    s_mov_b32 s24, 138412032
    s_lshl_b32 s26, s17, 12
    s_mov_b32 s21, 69206016
    s_cmp_eq_u32 s16, 2
    s_cselect_b32 s21, 77594624, s21
    s_add_u32 s26, s26, s21
    s_lshl_b32 s29, s17, 7
    s_lshl_b32 s21, s16, 2
    s_add_u32 s29, s29, s21
    s_add_u32 s29, s29, 125829164
mk_loop:
    s_cmp_lg_u32 s18, 0
    s_cbranch_scc1 mk_go
    s_cmp_le_u32 s19, s28
    s_cbranch_scc1 mk_go
    s_mov_b32 s23, 125853696
    s_mov_b32 s21, 4194304
mk_wait:
    buffer_load_dword v4, off, s[4:7], s23 sc1
    s_sub_u32 s21, s21, 1
    s_cbranch_scc1 mk_go
    s_waitcnt vmcnt(0)
    v_readfirstlane_b32 s28, v4
    s_nop 0
    s_sub_u32 s28, s28, s95
    s_cmp_gt_u32 s28, 64
    s_cselect_b32 s28, 0, s28
    s_cmp_le_u32 s19, s28
    s_cbranch_scc1 mk_go
    s_sleep 4
    s_branch mk_wait
mk_go:
    s_barrier
    s_add_u32 s21, s24, 4096
    s_add_u32 s23, s24, 8192
    buffer_load_dwordx4 v[24:27], v2, s[4:7], s24 offen offset:0 sc1
    buffer_load_dwordx4 v[28:31], v2, s[4:7], s24 offen offset:512 sc1
    buffer_load_dwordx4 v[32:35], v2, s[4:7], s21 offen offset:0 sc1
    buffer_load_dwordx4 v[36:39], v2, s[4:7], s21 offen offset:512 sc1
    buffer_load_dwordx4 v[40:43], v2, s[4:7], s24 offen offset:1024 sc1
    buffer_load_dwordx4 v[44:47], v2, s[4:7], s24 offen offset:1536 sc1
    buffer_load_dwordx4 v[48:51], v2, s[4:7], s21 offen offset:1024 sc1
    buffer_load_dwordx4 v[52:55], v2, s[4:7], s21 offen offset:1536 sc1
    buffer_load_dwordx4 v[56:59], v2, s[4:7], s24 offen offset:2048 sc1
    buffer_load_dwordx4 v[60:63], v2, s[4:7], s24 offen offset:2560 sc1
    buffer_load_dwordx4 v[208:211], v2, s[4:7], s21 offen offset:2048 sc1
    buffer_load_dwordx4 v[212:215], v2, s[4:7], s21 offen offset:2560 sc1
    buffer_load_dwordx4 v[216:219], v2, s[4:7], s24 offen offset:3072 sc1
    buffer_load_dwordx4 v[220:223], v2, s[4:7], s24 offen offset:3584 sc1
    buffer_load_dwordx4 v[224:227], v2, s[4:7], s21 offen offset:3072 sc1
    buffer_load_dwordx4 v[228:231], v2, s[4:7], s21 offen offset:3584 sc1
    buffer_load_dwordx4 v[232:235], v2, s[4:7], s23 offen offset:0 sc1
    buffer_load_dwordx4 v[236:239], v2, s[4:7], s23 offen offset:512 sc1
    s_add_u32 s24, s24, 18432
    s_cmp_eq_u32 s16, 2
    s_cbranch_scc1 mk_v
    s_waitcnt vmcnt(17)
    v_perm_b32 v244, v25, v24, v240
    v_perm_b32 v245, v27, v26, v240
    v_perm_b32 v246, v25, v24, v241
    v_perm_b32 v247, v27, v26, v241
    s_waitcnt vmcnt(16)
    v_perm_b32 v248, v29, v28, v240
    v_perm_b32 v249, v31, v30, v240
    v_perm_b32 v250, v29, v28, v241
    v_perm_b32 v251, v31, v30, v241
    v_mfma_f32_16x16x32_bf16 v[8:11], v[64:67], v[244:247], 0
    v_mfma_f32_16x16x32_bf16 v[12:15], v[136:139], v[244:247], 0
    v_mfma_f32_16x16x32_bf16 v[16:19], a[0:3], v[244:247], 0
    v_mfma_f32_16x16x32_bf16 v[20:23], a[72:75], v[244:247], 0
    s_waitcnt vmcnt(15)
    v_perm_b32 v244, v33, v32, v240
    v_perm_b32 v245, v35, v34, v240
    v_perm_b32 v246, v33, v32, v241
    v_perm_b32 v247, v35, v34, v241
    v_mfma_f32_16x16x32_bf16 v[8:11], v[68:71], v[248:251], v[8:11]
    v_mfma_f32_16x16x32_bf16 v[12:15], v[140:143], v[248:251], v[12:15]
    v_mfma_f32_16x16x32_bf16 v[16:19], a[4:7], v[248:251], v[16:19]
    v_mfma_f32_16x16x32_bf16 v[20:23], a[76:79], v[248:251], v[20:23]
    s_waitcnt vmcnt(14)
    v_perm_b32 v248, v37, v36, v240
    v_perm_b32 v249, v39, v38, v240
    v_perm_b32 v250, v37, v36, v241
    v_perm_b32 v251, v39, v38, v241
    v_mfma_f32_16x16x32_bf16 v[8:11], v[72:75], v[244:247], v[8:11]
    v_mfma_f32_16x16x32_bf16 v[12:15], v[144:147], v[244:247], v[12:15]
    v_mfma_f32_16x16x32_bf16 v[16:19], a[8:11], v[244:247], v[16:19]
    v_mfma_f32_16x16x32_bf16 v[20:23], a[80:83], v[244:247], v[20:23]
    s_waitcnt vmcnt(13)
    v_perm_b32 v244, v41, v40, v240
    v_perm_b32 v245, v43, v42, v240
    v_perm_b32 v246, v41, v40, v241
    v_perm_b32 v247, v43, v42, v241
    v_mfma_f32_16x16x32_bf16 v[8:11], v[76:79], v[248:251], v[8:11]
    v_mfma_f32_16x16x32_bf16 v[12:15], v[148:151], v[248:251], v[12:15]
    v_mfma_f32_16x16x32_bf16 v[16:19], a[12:15], v[248:251], v[16:19]
    v_mfma_f32_16x16x32_bf16 v[20:23], a[84:87], v[248:251], v[20:23]
    s_waitcnt vmcnt(12)
    v_perm_b32 v248, v45, v44, v240
    v_perm_b32 v249, v47, v46, v240
    v_perm_b32 v250, v45, v44, v241
    v_perm_b32 v251, v47, v46, v241
    v_mfma_f32_16x16x32_bf16 v[8:11], v[80:83], v[244:247], v[8:11]
    v_mfma_f32_16x16x32_bf16 v[12:15], v[152:155], v[244:247], v[12:15]
    v_mfma_f32_16x16x32_bf16 v[16:19], a[16:19], v[244:247], v[16:19]
    v_mfma_f32_16x16x32_bf16 v[20:23], a[88:91], v[244:247], v[20:23]
    s_waitcnt vmcnt(11)
    v_perm_b32 v244, v49, v48, v240
    v_perm_b32 v245, v51, v50, v240
    v_perm_b32 v246, v49, v48, v241
    v_perm_b32 v247, v51, v50, v241
    v_mfma_f32_16x16x32_bf16 v[8:11], v[84:87], v[248:251], v[8:11]
    v_mfma_f32_16x16x32_bf16 v[12:15], v[156:159], v[248:251], v[12:15]
    v_mfma_f32_16x16x32_bf16 v[16:19], a[20:23], v[248:251], v[16:19]
    v_mfma_f32_16x16x32_bf16 v[20:23], a[92:95], v[248:251], v[20:23]
    s_waitcnt vmcnt(10)
    v_perm_b32 v248, v53, v52, v240
    v_perm_b32 v249, v55, v54, v240
    v_perm_b32 v250, v53, v52, v241
    v_perm_b32 v251, v55, v54, v241
    v_mfma_f32_16x16x32_bf16 v[8:11], v[88:91], v[244:247], v[8:11]
    v_mfma_f32_16x16x32_bf16 v[12:15], v[160:163], v[244:247], v[12:15]
    v_mfma_f32_16x16x32_bf16 v[16:19], a[24:27], v[244:247], v[16:19]
    v_mfma_f32_16x16x32_bf16 v[20:23], a[96:99], v[244:247], v[20:23]
    s_waitcnt vmcnt(9)
    v_perm_b32 v244, v57, v56, v240
    v_perm_b32 v245, v59, v58, v240
    v_perm_b32 v246, v57, v56, v241
    v_perm_b32 v247, v59, v58, v241
    v_mfma_f32_16x16x32_bf16 v[8:11], v[92:95], v[248:251], v[8:11]
    v_mfma_f32_16x16x32_bf16 v[12:15], v[164:167], v[248:251], v[12:15]
    v_mfma_f32_16x16x32_bf16 v[16:19], a[28:31], v[248:251], v[16:19]
    v_mfma_f32_16x16x32_bf16 v[20:23], a[100:103], v[248:251], v[20:23]
    s_waitcnt vmcnt(8)
    v_perm_b32 v248, v61, v60, v240
    v_perm_b32 v249, v63, v62, v240
    v_perm_b32 v250, v61, v60, v241
    v_perm_b32 v251, v63, v62, v241
    v_mfma_f32_16x16x32_bf16 v[8:11], v[96:99], v[244:247], v[8:11]
    v_mfma_f32_16x16x32_bf16 v[12:15], v[168:171], v[244:247], v[12:15]
    v_mfma_f32_16x16x32_bf16 v[16:19], a[32:35], v[244:247], v[16:19]
    v_mfma_f32_16x16x32_bf16 v[20:23], a[104:107], v[244:247], v[20:23]
    s_waitcnt vmcnt(7)
    v_perm_b32 v244, v209, v208, v240
    v_perm_b32 v245, v211, v210, v240
    v_perm_b32 v246, v209, v208, v241
    v_perm_b32 v247, v211, v210, v241
    v_mfma_f32_16x16x32_bf16 v[8:11], v[100:103], v[248:251], v[8:11]
    v_mfma_f32_16x16x32_bf16 v[12:15], v[172:175], v[248:251], v[12:15]
    v_mfma_f32_16x16x32_bf16 v[16:19], a[36:39], v[248:251], v[16:19]
    v_mfma_f32_16x16x32_bf16 v[20:23], a[108:111], v[248:251], v[20:23]
    s_waitcnt vmcnt(6)
    v_perm_b32 v248, v213, v212, v240
    v_perm_b32 v249, v215, v214, v240
    v_perm_b32 v250, v213, v212, v241
    v_perm_b32 v251, v215, v214, v241
    v_mfma_f32_16x16x32_bf16 v[8:11], v[104:107], v[244:247], v[8:11]
    v_mfma_f32_16x16x32_bf16 v[12:15], v[176:179], v[244:247], v[12:15]
    v_mfma_f32_16x16x32_bf16 v[16:19], a[40:43], v[244:247], v[16:19]
    v_mfma_f32_16x16x32_bf16 v[20:23], a[112:115], v[244:247], v[20:23]
    s_waitcnt vmcnt(5)
    v_perm_b32 v244, v217, v216, v240
    v_perm_b32 v245, v219, v218, v240
    v_perm_b32 v246, v217, v216, v241
    v_perm_b32 v247, v219, v218, v241
    v_mfma_f32_16x16x32_bf16 v[8:11], v[108:111], v[248:251], v[8:11]
    v_mfma_f32_16x16x32_bf16 v[12:15], v[180:183], v[248:251], v[12:15]
    v_mfma_f32_16x16x32_bf16 v[16:19], a[44:47], v[248:251], v[16:19]
    v_mfma_f32_16x16x32_bf16 v[20:23], a[116:119], v[248:251], v[20:23]
    s_waitcnt vmcnt(4)
    v_perm_b32 v248, v221, v220, v240
    v_perm_b32 v249, v223, v222, v240
    v_perm_b32 v250, v221, v220, v241
    v_perm_b32 v251, v223, v222, v241
    v_mfma_f32_16x16x32_bf16 v[8:11], v[112:115], v[244:247], v[8:11]
    v_mfma_f32_16x16x32_bf16 v[12:15], v[184:187], v[244:247], v[12:15]
    v_mfma_f32_16x16x32_bf16 v[16:19], a[48:51], v[244:247], v[16:19]
    v_mfma_f32_16x16x32_bf16 v[20:23], a[120:123], v[244:247], v[20:23]
    s_waitcnt vmcnt(3)
    v_perm_b32 v244, v225, v224, v240
    v_perm_b32 v245, v227, v226, v240
    v_perm_b32 v246, v225, v224, v241
    v_perm_b32 v247, v227, v226, v241
    v_mfma_f32_16x16x32_bf16 v[8:11], v[116:119], v[248:251], v[8:11]
    v_mfma_f32_16x16x32_bf16 v[12:15], v[188:191], v[248:251], v[12:15]
    v_mfma_f32_16x16x32_bf16 v[16:19], a[52:55], v[248:251], v[16:19]
    v_mfma_f32_16x16x32_bf16 v[20:23], a[124:127], v[248:251], v[20:23]
    s_waitcnt vmcnt(2)
    v_perm_b32 v248, v229, v228, v240
    v_perm_b32 v249, v231, v230, v240
    v_perm_b32 v250, v229, v228, v241
    v_perm_b32 v251, v231, v230, v241
    v_mfma_f32_16x16x32_bf16 v[8:11], v[120:123], v[244:247], v[8:11]
    v_mfma_f32_16x16x32_bf16 v[12:15], v[192:195], v[244:247], v[12:15]
    v_mfma_f32_16x16x32_bf16 v[16:19], a[56:59], v[244:247], v[16:19]
    v_mfma_f32_16x16x32_bf16 v[20:23], a[128:131], v[244:247], v[20:23]
    s_waitcnt vmcnt(1)
    v_mfma_f32_16x16x32_bf16 v[8:11], v[124:127], v[248:251], v[8:11]
    v_mfma_f32_16x16x32_bf16 v[12:15], v[196:199], v[248:251], v[12:15]
    v_mfma_f32_16x16x32_bf16 v[16:19], a[60:63], v[248:251], v[16:19]
    v_mfma_f32_16x16x32_bf16 v[20:23], a[132:135], v[248:251], v[20:23]
    s_waitcnt vmcnt(0)
    v_mfma_f32_16x16x32_bf16 v[8:11], v[128:131], v[232:235], v[8:11]
    v_mfma_f32_16x16x32_bf16 v[12:15], v[200:203], v[232:235], v[12:15]
    v_mfma_f32_16x16x32_bf16 v[16:19], a[64:67], v[232:235], v[16:19]
    v_mfma_f32_16x16x32_bf16 v[20:23], a[136:139], v[232:235], v[20:23]
    v_mfma_f32_16x16x32_bf16 v[8:11], v[132:135], v[236:239], v[8:11]
    v_mfma_f32_16x16x32_bf16 v[12:15], v[204:207], v[236:239], v[12:15]
    v_mfma_f32_16x16x32_bf16 v[16:19], a[68:71], v[236:239], v[16:19]
    v_mfma_f32_16x16x32_bf16 v[20:23], a[140:143], v[236:239], v[20:23]
    s_nop 7
    s_branch mk_st
mk_v:
    s_waitcnt vmcnt(17)
    v_perm_b32 v244, v25, v24, v240
    v_perm_b32 v245, v27, v26, v240
    v_perm_b32 v246, v25, v24, v241
    v_perm_b32 v247, v27, v26, v241
    s_waitcnt vmcnt(16)
    v_perm_b32 v248, v29, v28, v240
    v_perm_b32 v249, v31, v30, v240
    v_perm_b32 v250, v29, v28, v241
    v_perm_b32 v251, v31, v30, v241
    v_mfma_f32_16x16x32_bf16 v[8:11], v[244:247], v[64:67], 0
    v_mfma_f32_16x16x32_bf16 v[12:15], v[244:247], v[136:139], 0
    v_mfma_f32_16x16x32_bf16 v[16:19], v[244:247], a[0:3], 0
    v_mfma_f32_16x16x32_bf16 v[20:23], v[244:247], a[72:75], 0
    s_waitcnt vmcnt(15)
    v_perm_b32 v244, v33, v32, v240
    v_perm_b32 v245, v35, v34, v240
    v_perm_b32 v246, v33, v32, v241
    v_perm_b32 v247, v35, v34, v241
    v_mfma_f32_16x16x32_bf16 v[8:11], v[248:251], v[68:71], v[8:11]
    v_mfma_f32_16x16x32_bf16 v[12:15], v[248:251], v[140:143], v[12:15]
    v_mfma_f32_16x16x32_bf16 v[16:19], v[248:251], a[4:7], v[16:19]
    v_mfma_f32_16x16x32_bf16 v[20:23], v[248:251], a[76:79], v[20:23]
    s_waitcnt vmcnt(14)
    v_perm_b32 v248, v37, v36, v240
    v_perm_b32 v249, v39, v38, v240
    v_perm_b32 v250, v37, v36, v241
    v_perm_b32 v251, v39, v38, v241
    v_mfma_f32_16x16x32_bf16 v[8:11], v[244:247], v[72:75], v[8:11]
    v_mfma_f32_16x16x32_bf16 v[12:15], v[244:247], v[144:147], v[12:15]
    v_mfma_f32_16x16x32_bf16 v[16:19], v[244:247], a[8:11], v[16:19]
    v_mfma_f32_16x16x32_bf16 v[20:23], v[244:247], a[80:83], v[20:23]
    s_waitcnt vmcnt(13)
    v_perm_b32 v244, v41, v40, v240
    v_perm_b32 v245, v43, v42, v240
    v_perm_b32 v246, v41, v40, v241
    v_perm_b32 v247, v43, v42, v241
    v_mfma_f32_16x16x32_bf16 v[8:11], v[248:251], v[76:79], v[8:11]
    v_mfma_f32_16x16x32_bf16 v[12:15], v[248:251], v[148:151], v[12:15]
    v_mfma_f32_16x16x32_bf16 v[16:19], v[248:251], a[12:15], v[16:19]
    v_mfma_f32_16x16x32_bf16 v[20:23], v[248:251], a[84:87], v[20:23]
    s_waitcnt vmcnt(12)
    v_perm_b32 v248, v45, v44, v240
    v_perm_b32 v249, v47, v46, v240
    v_perm_b32 v250, v45, v44, v241
    v_perm_b32 v251, v47, v46, v241
    v_mfma_f32_16x16x32_bf16 v[8:11], v[244:247], v[80:83], v[8:11]
    v_mfma_f32_16x16x32_bf16 v[12:15], v[244:247], v[152:155], v[12:15]
    v_mfma_f32_16x16x32_bf16 v[16:19], v[244:247], a[16:19], v[16:19]
    v_mfma_f32_16x16x32_bf16 v[20:23], v[244:247], a[88:91], v[20:23]
    s_waitcnt vmcnt(11)
    v_perm_b32 v244, v49, v48, v240
    v_perm_b32 v245, v51, v50, v240
    v_perm_b32 v246, v49, v48, v241
    v_perm_b32 v247, v51, v50, v241
    v_mfma_f32_16x16x32_bf16 v[8:11], v[248:251], v[84:87], v[8:11]
    v_mfma_f32_16x16x32_bf16 v[12:15], v[248:251], v[156:159], v[12:15]
    v_mfma_f32_16x16x32_bf16 v[16:19], v[248:251], a[20:23], v[16:19]
    v_mfma_f32_16x16x32_bf16 v[20:23], v[248:251], a[92:95], v[20:23]
    s_waitcnt vmcnt(10)
    v_perm_b32 v248, v53, v52, v240
    v_perm_b32 v249, v55, v54, v240
    v_perm_b32 v250, v53, v52, v241
    v_perm_b32 v251, v55, v54, v241
    v_mfma_f32_16x16x32_bf16 v[8:11], v[244:247], v[88:91], v[8:11]
    v_mfma_f32_16x16x32_bf16 v[12:15], v[244:247], v[160:163], v[12:15]
    v_mfma_f32_16x16x32_bf16 v[16:19], v[244:247], a[24:27], v[16:19]
    v_mfma_f32_16x16x32_bf16 v[20:23], v[244:247], a[96:99], v[20:23]
    s_waitcnt vmcnt(9)
    v_perm_b32 v244, v57, v56, v240
    v_perm_b32 v245, v59, v58, v240
    v_perm_b32 v246, v57, v56, v241
    v_perm_b32 v247, v59, v58, v241
    v_mfma_f32_16x16x32_bf16 v[8:11], v[248:251], v[92:95], v[8:11]
    v_mfma_f32_16x16x32_bf16 v[12:15], v[248:251], v[164:167], v[12:15]
    v_mfma_f32_16x16x32_bf16 v[16:19], v[248:251], a[28:31], v[16:19]
    v_mfma_f32_16x16x32_bf16 v[20:23], v[248:251], a[100:103], v[20:23]
    s_waitcnt vmcnt(8)
    v_perm_b32 v248, v61, v60, v240
    v_perm_b32 v249, v63, v62, v240
    v_perm_b32 v250, v61, v60, v241
    v_perm_b32 v251, v63, v62, v241
    v_mfma_f32_16x16x32_bf16 v[8:11], v[244:247], v[96:99], v[8:11]
    v_mfma_f32_16x16x32_bf16 v[12:15], v[244:247], v[168:171], v[12:15]
    v_mfma_f32_16x16x32_bf16 v[16:19], v[244:247], a[32:35], v[16:19]
    v_mfma_f32_16x16x32_bf16 v[20:23], v[244:247], a[104:107], v[20:23]
    s_waitcnt vmcnt(7)
    v_perm_b32 v244, v209, v208, v240
    v_perm_b32 v245, v211, v210, v240
    v_perm_b32 v246, v209, v208, v241
    v_perm_b32 v247, v211, v210, v241
    v_mfma_f32_16x16x32_bf16 v[8:11], v[248:251], v[100:103], v[8:11]
    v_mfma_f32_16x16x32_bf16 v[12:15], v[248:251], v[172:175], v[12:15]
    v_mfma_f32_16x16x32_bf16 v[16:19], v[248:251], a[36:39], v[16:19]
    v_mfma_f32_16x16x32_bf16 v[20:23], v[248:251], a[108:111], v[20:23]
    s_waitcnt vmcnt(6)
    v_perm_b32 v248, v213, v212, v240
    v_perm_b32 v249, v215, v214, v240
    v_perm_b32 v250, v213, v212, v241
    v_perm_b32 v251, v215, v214, v241
    v_mfma_f32_16x16x32_bf16 v[8:11], v[244:247], v[104:107], v[8:11]
    v_mfma_f32_16x16x32_bf16 v[12:15], v[244:247], v[176:179], v[12:15]
    v_mfma_f32_16x16x32_bf16 v[16:19], v[244:247], a[40:43], v[16:19]
    v_mfma_f32_16x16x32_bf16 v[20:23], v[244:247], a[112:115], v[20:23]
    s_waitcnt vmcnt(5)
    v_perm_b32 v244, v217, v216, v240
    v_perm_b32 v245, v219, v218, v240
    v_perm_b32 v246, v217, v216, v241
    v_perm_b32 v247, v219, v218, v241
    v_mfma_f32_16x16x32_bf16 v[8:11], v[248:251], v[108:111], v[8:11]
    v_mfma_f32_16x16x32_bf16 v[12:15], v[248:251], v[180:183], v[12:15]
    v_mfma_f32_16x16x32_bf16 v[16:19], v[248:251], a[44:47], v[16:19]
    v_mfma_f32_16x16x32_bf16 v[20:23], v[248:251], a[116:119], v[20:23]
    s_waitcnt vmcnt(4)
    v_perm_b32 v248, v221, v220, v240
    v_perm_b32 v249, v223, v222, v240
    v_perm_b32 v250, v221, v220, v241
    v_perm_b32 v251, v223, v222, v241
    v_mfma_f32_16x16x32_bf16 v[8:11], v[244:247], v[112:115], v[8:11]
    v_mfma_f32_16x16x32_bf16 v[12:15], v[244:247], v[184:187], v[12:15]
    v_mfma_f32_16x16x32_bf16 v[16:19], v[244:247], a[48:51], v[16:19]
    v_mfma_f32_16x16x32_bf16 v[20:23], v[244:247], a[120:123], v[20:23]
    s_waitcnt vmcnt(3)
    v_perm_b32 v244, v225, v224, v240
    v_perm_b32 v245, v227, v226, v240
    v_perm_b32 v246, v225, v224, v241
    v_perm_b32 v247, v227, v226, v241
    v_mfma_f32_16x16x32_bf16 v[8:11], v[248:251], v[116:119], v[8:11]
    v_mfma_f32_16x16x32_bf16 v[12:15], v[248:251], v[188:191], v[12:15]
    v_mfma_f32_16x16x32_bf16 v[16:19], v[248:251], a[52:55], v[16:19]
    v_mfma_f32_16x16x32_bf16 v[20:23], v[248:251], a[124:127], v[20:23]
    s_waitcnt vmcnt(2)
    v_perm_b32 v248, v229, v228, v240
    v_perm_b32 v249, v231, v230, v240
    v_perm_b32 v250, v229, v228, v241
    v_perm_b32 v251, v231, v230, v241
    v_mfma_f32_16x16x32_bf16 v[8:11], v[244:247], v[120:123], v[8:11]
    v_mfma_f32_16x16x32_bf16 v[12:15], v[244:247], v[192:195], v[12:15]
    v_mfma_f32_16x16x32_bf16 v[16:19], v[244:247], a[56:59], v[16:19]
    v_mfma_f32_16x16x32_bf16 v[20:23], v[244:247], a[128:131], v[20:23]
    s_waitcnt vmcnt(1)
    v_mfma_f32_16x16x32_bf16 v[8:11], v[248:251], v[124:127], v[8:11]
    v_mfma_f32_16x16x32_bf16 v[12:15], v[248:251], v[196:199], v[12:15]
    v_mfma_f32_16x16x32_bf16 v[16:19], v[248:251], a[60:63], v[16:19]
    v_mfma_f32_16x16x32_bf16 v[20:23], v[248:251], a[132:135], v[20:23]
    s_waitcnt vmcnt(0)
    v_mfma_f32_16x16x32_bf16 v[8:11], v[232:235], v[128:131], v[8:11]
    v_mfma_f32_16x16x32_bf16 v[12:15], v[232:235], v[200:203], v[12:15]
    v_mfma_f32_16x16x32_bf16 v[16:19], v[232:235], a[64:67], v[16:19]
    v_mfma_f32_16x16x32_bf16 v[20:23], v[232:235], a[136:139], v[20:23]
    v_mfma_f32_16x16x32_bf16 v[8:11], v[236:239], v[132:135], v[8:11]
    v_mfma_f32_16x16x32_bf16 v[12:15], v[236:239], v[204:207], v[12:15]
    v_mfma_f32_16x16x32_bf16 v[16:19], v[236:239], a[68:71], v[16:19]
    v_mfma_f32_16x16x32_bf16 v[20:23], v[236:239], a[140:143], v[20:23]
    s_nop 4
    v_pk_mul_f32 v[8:9], v[8:9], 0.5 op_sel_hi:[1,0]
    v_pk_mul_f32 v[10:11], v[10:11], 0.5 op_sel_hi:[1,0]
    v_pk_mul_f32 v[12:13], v[12:13], 0.5 op_sel_hi:[1,0]
    v_pk_mul_f32 v[14:15], v[14:15], 0.5 op_sel_hi:[1,0]
    v_pk_mul_f32 v[16:17], v[16:17], 0.5 op_sel_hi:[1,0]
    v_pk_mul_f32 v[18:19], v[18:19], 0.5 op_sel_hi:[1,0]
    v_pk_mul_f32 v[20:21], v[20:21], 0.5 op_sel_hi:[1,0]
    v_pk_mul_f32 v[22:23], v[22:23], 0.5 op_sel_hi:[1,0]
mk_st:
    s_nop 1
    v_cvt_pk_bf16_f32 v24, v8, v9
    v_cvt_pk_bf16_f32 v25, v10, v11
    v_cvt_pk_bf16_f32 v26, v12, v13
    v_cvt_pk_bf16_f32 v27, v14, v15
    v_cvt_pk_bf16_f32 v28, v16, v17
    v_cvt_pk_bf16_f32 v29, v18, v19
    v_cvt_pk_bf16_f32 v30, v20, v21
    v_cvt_pk_bf16_f32 v31, v22, v23
    s_add_u32 s21, s26, 4096
    buffer_store_dwordx4 v[24:27], v1, s[4:7], s26 offen sc1
    buffer_store_dwordx4 v[28:31], v1, s[4:7], s21 offen sc1
    s_add_u32 s22, s19, s95
    s_waitcnt vmcnt(0)
    s_barrier
    v_mov_b32 v4, s22
    s_mov_b64 exec, s[34:35]
    buffer_store_dword v4, off, s[4:7], s29 sc1
    buffer_store_dword v4, off, s[4:7], s29 offset:128 sc1
    s_mov_b64 exec, -1
    s_add_u32 s19, s19, 2
    s_add_u32 s26, s26, 262144
    s_cmp_le_u32 s19, 58
    s_cbranch_scc1 mk_loop
    s_endpgm
L_ssm_next:
    s_mov_b32 s37, 8
    v_mov_b32 v250, 1
    v_mov_b32 v251, 163832
    v_cmp_eq_u32 vcc, 0, v0
    s_nop 0
    s_and_saveexec_b64 s[38:39], vcc
    s_cbranch_execz tk6
    buffer_atomic_add v250, off, s[84:87], s37 sc0
    s_waitcnt vmcnt(0)
    ds_write_b32 v251, v250
    s_waitcnt lgkmcnt(0)
tk6:
    s_mov_b64 exec, -1
    s_barrier
    ds_read_b32 v252, v251
    s_waitcnt lgkmcnt(0)
    v_readfirstlane_b32 s20, v252
    s_barrier
    s_nop 3
    s_cmp_ge_u32 s20, 144
    s_cbranch_scc1 L_wf_next
    s_lshl_b32 s20, s20, 2
    v_lshrrev_b32 v5, 6, v0
    s_nop 0
    v_readfirstlane_b32 s21, v5
    v_and_b32 v1, 63, v0
    v_and_b32 v2, 15, v1
    v_lshrrev_b32 v3, 4, v1
    v_lshlrev_b32 v4, 14, v5
    s_mov_b32 s8, s62
    s_mov_b32 s9, s63
    s_mov_b32 s10, 2359296
    s_mov_b32 s11, 0x20000
    s_mov_b32 s16, s76
    s_mov_b32 s17, s77
    s_mov_b32 s18, 4718592
    s_mov_b32 s19, 0x20000
    v_mul_u32_u24 v5, 9216, v0
    s_lshl_b32 s22, s20, 1
    s_add_u32 s23, s22, 0
    buffer_load_dwordx2 v[8:9], v5, s[8:11], s23 offen
    s_add_u32 s23, s22, 1152
    buffer_load_dwordx2 v[10:11], v5, s[8:11], s23 offen
    s_add_u32 s23, s22, 2304
    buffer_load_dwordx2 v[12:13], v5, s[8:11], s23 offen
    s_add_u32 s23, s22, 3456
    buffer_load_dwordx2 v[14:15], v5, s[8:11], s23 offen
    s_add_u32 s23, s22, 4608
    buffer_load_dwordx2 v[16:17], v5, s[8:11], s23 offen
    s_add_u32 s23, s22, 5760
    buffer_load_dwordx2 v[18:19], v5, s[8:11], s23 offen
    s_add_u32 s23, s22, 6912
    buffer_load_dwordx2 v[20:21], v5, s[8:11], s23 offen
    s_add_u32 s23, s22, 8064
    buffer_load_dwordx2 v[22:23], v5, s[8:11], s23 offen
    s_add_u32 s22, s20, s21
    s_lshl_b32 s23, s22, 8
    v_lshlrev_b32 v6, 3, v2
    v_lshl_add_u32 v6, v3, 1, v6
    s_mov_b32 s12, s64
    s_mov_b32 s13, s65
    s_mov_b32 s14, 147456
    s_mov_b32 s15, 0x20000
    buffer_load_ushort v24, v6, s[12:15], s23 offen offset:0
    buffer_load_ushort v28, v6, s[12:15], s23 offen offset:128
    s_mov_b32 s12, s66
    s_mov_b32 s13, s67
    s_mov_b32 s14, 147456
    s_mov_b32 s15, 0x20000
    buffer_load_ushort v25, v6, s[12:15], s23 offen offset:0
    buffer_load_ushort v29, v6, s[12:15], s23 offen offset:128
    s_mov_b32 s12, s68
    s_mov_b32 s13, s69
    s_mov_b32 s14, 147456
    s_mov_b32 s15, 0x20000
    buffer_load_ushort v26, v6, s[12:15], s23 offen offset:0
    buffer_load_ushort v30, v6, s[12:15], s23 offen offset:128
    s_mov_b32 s12, s70
    s_mov_b32 s13, s71
    s_mov_b32 s14, 147456
    s_mov_b32 s15, 0x20000
    buffer_load_ushort v27, v6, s[12:15], s23 offen offset:0
    buffer_load_ushort v31, v6, s[12:15], s23 offen offset:128
    s_mov_b32 s12, s72
    s_mov_b32 s13, s73
    s_mov_b32 s14, 1152
    s_mov_b32 s15, 0x20000
    s_lshl_b32 s23, s22, 1
    buffer_load_ushort v32, off, s[12:15], s23
    s_mov_b32 s26, 0x3fb8aa3b
    s_mov_b32 s27, 0x3e22f983
    v_mov_b32 v34, 0
    v_mov_b32 v35, 0
    v_lshl_add_u32 v6, v1, 3, v4
    ds_write_b64 v6, v[34:35] offset:0
    s_waitcnt vmcnt(0)
    v_mov_b32 v36, 0x05040100
    v_mov_b32 v37, 0x07060302
    v_lshlrev_b32 v6, 4, v0
    v_perm_b32 v40, v10, v8, v36
    v_perm_b32 v41, v14, v12, v36
    v_perm_b32 v42, v18, v16, v36
    v_perm_b32 v43, v22, v20, v36
    ds_write_b128 v6, v[40:43] offset:512
    s_nop 1
    v_perm_b32 v40, v10, v8, v37
    v_perm_b32 v41, v14, v12, v37
    v_perm_b32 v42, v18, v16, v37
    v_perm_b32 v43, v22, v20, v37
    ds_write_b128 v6, v[40:43] offset:16896
    s_nop 1
    v_perm_b32 v40, v11, v9, v36
    v_perm_b32 v41, v15, v13, v36
    v_perm_b32 v42, v19, v17, v36
    v_perm_b32 v43, v23, v21, v36
    ds_write_b128 v6, v[40:43] offset:33280
    s_nop 1
    v_perm_b32 v40, v11, v9, v37
    v_perm_b32 v41, v15, v13, v37
    v_perm_b32 v42, v19, v17, v37
    v_perm_b32 v43, v23, v21, v37
    ds_write_b128 v6, v[40:43] offset:49664
    s_nop 1
    v_lshlrev_b32 v32, 16, v32
    v_mul_f32 v32, s26, v32
    v_exp_f32 v32, v32
    s_nop 0
    v_cvt_pk_bf16_f32 v32, v32, v32
    v_and_b32 v32, 0xffff0000, v32
    v_add_f32 v33, v32, v32
    v_lshlrev_b32 v24, 16, v24
    v_mul_f32 v24, s26, v24
    v_exp_f32 v24, v24
    s_nop 0
    v_cvt_pk_bf16_f32 v24, v24, v24
    v_and_b32 v24, 0xffff0000, v24
    v_mul_f32 v24, v24, v32
    v_mul_f32 v24, s26, v24
    v_sub_f32 v24, 0, v24
    v_lshlrev_b32 v25, 16, v25
    v_mul_f32 v25, v25, v32
    v_mul_f32 v25, s27, v25
    v_lshlrev_b32 v26, 16, v26
    v_mul_f32 v26, v26, v33
    v_lshlrev_b32 v27, 16, v27
    v_mul_f32 v27, v27, v33
    v_lshlrev_b32 v28, 16, v28
    v_mul_f32 v28, s26, v28
    v_exp_f32 v28, v28
    s_nop 0
    v_cvt_pk_bf16_f32 v28, v28, v28
    v_and_b32 v28, 0xffff0000, v28
    v_mul_f32 v28, v28, v32
    v_mul_f32 v28, s26, v28
    v_sub_f32 v28, 0, v28
    v_lshlrev_b32 v29, 16, v29
    v_mul_f32 v29, v29, v32
    v_mul_f32 v29, s27, v29
    v_lshlrev_b32 v30, 16, v30
    v_mul_f32 v30, v30, v33
    v_lshlrev_b32 v31, 16, v31
    v_mul_f32 v31, v31, v33
    v_cvt_f32_u32 v47, v2
    v_mul_f32 v44, 0x41800000, v47
    v_and_b32 v5, 7, v2
    v_add_u32 v5, 8, v5
    v_cvt_f32_u32 v5, v5
    v_mul_f32 v45, 0x42000000, v5
    v_mul_f32 v6, 0x42800000, v5
    v_cmp_lt_u32 vcc, 7, v2
    s_nop 1
    v_cndmask_b32 v45, v45, v6, vcc
    v_add_f32 v5, 0x41000000, v47
    v_mul_f32 v46, 0x43000000, v5
    v_mov_b32 v48, 0
    v_mov_b32 v49, 0
    v_mov_b32 v50, 0
    v_mov_b32 v51, 0
    v_mov_b32 v52, 0
    v_mov_b32 v53, 0
    v_mov_b32 v54, 0
    v_mov_b32 v55, 0
    v_mov_b32 v56, 0
    v_mov_b32 v57, 0
    v_mov_b32 v58, 0
    v_mov_b32 v59, 0
    v_mov_b32 v60, 0
    v_mov_b32 v61, 0
    v_mov_b32 v62, 0
    v_mov_b32 v63, 0
    v_mov_b32_dpp v64, v24 row_newbcast:0 row_mask:0xf bank_mask:0xf
    v_mov_b32_dpp v65, v25 row_newbcast:0 row_mask:0xf bank_mask:0xf
    v_mov_b32_dpp v66, v26 row_newbcast:0 row_mask:0xf bank_mask:0xf
    v_mov_b32_dpp v67, v27 row_newbcast:0 row_mask:0xf bank_mask:0xf
    v_mul_f32 v82, v64, v47
    v_mul_f32 v83, v65, v47
    v_exp_f32 v82, v82
    v_fract_f32 v83, v83
    v_cos_f32 v74, v83
    v_sin_f32 v75, v83
    v_mul_f32 v74, v74, v82
    v_mul_f32 v75, v75, v82
    v_mul_f32 v84, v75, v75
    v_add_f32 v85, v74, v74
    v_fma_f32 v76, v74, v74, -v84
    v_mul_f32 v77, v85, v75
    v_mul_f32 v84, v77, v77
    v_add_f32 v85, v76, v76
    v_fma_f32 v78, v76, v76, -v84
    v_mul_f32 v79, v85, v77
    v_mul_f32 v84, v79, v79
    v_add_f32 v85, v78, v78
    v_fma_f32 v80, v78, v78, -v84
    v_mul_f32 v81, v85, v79
    v_mul_f32 v82, v64, v44
    v_mul_f32 v83, v65, v44
    v_exp_f32 v82, v82
    v_fract_f32 v83, v83
    v_cos_f32 v68, v83
    v_sin_f32 v69, v83
    v_mul_f32 v68, v68, v82
    v_mul_f32 v69, v69, v82
    v_mul_f32 v84, v67, v69
    v_mul_f32 v85, v67, v68
    v_fma_f32 v68, v66, v68, -v84
    v_fma_f32 v69, -v66, v69, -v85
    v_mul_f32 v82, v64, v45
    v_mul_f32 v83, v65, v45
    v_exp_f32 v82, v82
    v_fract_f32 v83, v83
    v_cos_f32 v70, v83
    v_sin_f32 v71, v83
    v_mul_f32 v70, v70, v82
    v_mul_f32 v71, v71, v82
    v_mul_f32 v84, v67, v71
    v_mul_f32 v85, v67, v70
    v_fma_f32 v70, v66, v70, -v84
    v_fma_f32 v71, -v66, v71, -v85
    v_mul_f32 v82, v64, v46
    v_mul_f32 v83, v65, v46
    v_exp_f32 v82, v82
    v_fract_f32 v83, v83
    v_cos_f32 v72, v83
    v_sin_f32 v73, v83
    v_mul_f32 v72, v72, v82
    v_mul_f32 v73, v73, v82
    v_mul_f32 v84, v67, v73
    v_mul_f32 v85, v67, v72
    v_fma_f32 v72, v66, v72, -v84
    v_fma_f32 v73, -v66, v73, -v85
    v_mfma_f32_16x16x4_f32 v[48:51], v68, v74, v[48:51]
    v_mfma_f32_16x16x4_f32 v[52:55], v70, v76, v[52:55]
    v_mfma_f32_16x16x4_f32 v[56:59], v70, v78, v[56:59]
    v_mfma_f32_16x16x4_f32 v[60:63], v72, v80, v[60:63]
    v_mfma_f32_16x16x4_f32 v[48:51], v69, v75, v[48:51]
    v_mfma_f32_16x16x4_f32 v[52:55], v71, v77, v[52:55]
    v_mfma_f32_16x16x4_f32 v[56:59], v71, v79, v[56:59]
    v_mfma_f32_16x16x4_f32 v[60:63], v73, v81, v[60:63]
    v_mov_b32_dpp v64, v24 row_newbcast:1 row_mask:0xf bank_mask:0xf
    v_mov_b32_dpp v65, v25 row_newbcast:1 row_mask:0xf bank_mask:0xf
    v_mov_b32_dpp v66, v26 row_newbcast:1 row_mask:0xf bank_mask:0xf
    v_mov_b32_dpp v67, v27 row_newbcast:1 row_mask:0xf bank_mask:0xf
    v_mul_f32 v82, v64, v47
    v_mul_f32 v83, v65, v47
    v_exp_f32 v82, v82
    v_fract_f32 v83, v83
    v_cos_f32 v74, v83
    v_sin_f32 v75, v83
    v_mul_f32 v74, v74, v82
    v_mul_f32 v75, v75, v82
    v_mul_f32 v84, v75, v75
    v_add_f32 v85, v74, v74
    v_fma_f32 v76, v74, v74, -v84
    v_mul_f32 v77, v85, v75
    v_mul_f32 v84, v77, v77
    v_add_f32 v85, v76, v76
    v_fma_f32 v78, v76, v76, -v84
    v_mul_f32 v79, v85, v77
    v_mul_f32 v84, v79, v79
    v_add_f32 v85, v78, v78
    v_fma_f32 v80, v78, v78, -v84
    v_mul_f32 v81, v85, v79
    v_mul_f32 v82, v64, v44
    v_mul_f32 v83, v65, v44
    v_exp_f32 v82, v82
    v_fract_f32 v83, v83
    v_cos_f32 v68, v83
    v_sin_f32 v69, v83
    v_mul_f32 v68, v68, v82
    v_mul_f32 v69, v69, v82
    v_mul_f32 v84, v67, v69
    v_mul_f32 v85, v67, v68
    v_fma_f32 v68, v66, v68, -v84
    v_fma_f32 v69, -v66, v69, -v85
    v_mul_f32 v82, v64, v45
    v_mul_f32 v83, v65, v45
    v_exp_f32 v82, v82
    v_fract_f32 v83, v83
    v_cos_f32 v70, v83
    v_sin_f32 v71, v83
    v_mul_f32 v70, v70, v82
    v_mul_f32 v71, v71, v82
    v_mul_f32 v84, v67, v71
    v_mul_f32 v85, v67, v70
    v_fma_f32 v70, v66, v70, -v84
    v_fma_f32 v71, -v66, v71, -v85
    v_mul_f32 v82, v64, v46
    v_mul_f32 v83, v65, v46
    v_exp_f32 v82, v82
    v_fract_f32 v83, v83
    v_cos_f32 v72, v83
    v_sin_f32 v73, v83
    v_mul_f32 v72, v72, v82
    v_mul_f32 v73, v73, v82
    v_mul_f32 v84, v67, v73
    v_mul_f32 v85, v67, v72
    v_fma_f32 v72, v66, v72, -v84
    v_fma_f32 v73, -v66, v73, -v85
    v_mfma_f32_16x16x4_f32 v[48:51], v68, v74, v[48:51]
    v_mfma_f32_16x16x4_f32 v[52:55], v70, v76, v[52:55]
    v_mfma_f32_16x16x4_f32 v[56:59], v70, v78, v[56:59]
    v_mfma_f32_16x16x4_f32 v[60:63], v72, v80, v[60:63]
    v_mfma_f32_16x16x4_f32 v[48:51], v69, v75, v[48:51]
    v_mfma_f32_16x16x4_f32 v[52:55], v71, v77, v[52:55]
    v_mfma_f32_16x16x4_f32 v[56:59], v71, v79, v[56:59]
    v_mfma_f32_16x16x4_f32 v[60:63], v73, v81, v[60:63]
    v_mov_b32_dpp v64, v24 row_newbcast:2 row_mask:0xf bank_mask:0xf
    v_mov_b32_dpp v65, v25 row_newbcast:2 row_mask:0xf bank_mask:0xf
    v_mov_b32_dpp v66, v26 row_newbcast:2 row_mask:0xf bank_mask:0xf
    v_mov_b32_dpp v67, v27 row_newbcast:2 row_mask:0xf bank_mask:0xf
    v_mul_f32 v82, v64, v47
    v_mul_f32 v83, v65, v47
    v_exp_f32 v82, v82
    v_fract_f32 v83, v83
    v_cos_f32 v74, v83
    v_sin_f32 v75, v83
    v_mul_f32 v74, v74, v82
    v_mul_f32 v75, v75, v82
    v_mul_f32 v84, v75, v75
    v_add_f32 v85, v74, v74
    v_fma_f32 v76, v74, v74, -v84
    v_mul_f32 v77, v85, v75
    v_mul_f32 v84, v77, v77
    v_add_f32 v85, v76, v76
    v_fma_f32 v78, v76, v76, -v84
    v_mul_f32 v79, v85, v77
    v_mul_f32 v84, v79, v79
    v_add_f32 v85, v78, v78
    v_fma_f32 v80, v78, v78, -v84
    v_mul_f32 v81, v85, v79
    v_mul_f32 v82, v64, v44
    v_mul_f32 v83, v65, v44
    v_exp_f32 v82, v82
    v_fract_f32 v83, v83
    v_cos_f32 v68, v83
    v_sin_f32 v69, v83
    v_mul_f32 v68, v68, v82
    v_mul_f32 v69, v69, v82
    v_mul_f32 v84, v67, v69
    v_mul_f32 v85, v67, v68
    v_fma_f32 v68, v66, v68, -v84
    v_fma_f32 v69, -v66, v69, -v85
    v_mul_f32 v82, v64, v45
    v_mul_f32 v83, v65, v45
    v_exp_f32 v82, v82
    v_fract_f32 v83, v83
    v_cos_f32 v70, v83
    v_sin_f32 v71, v83
    v_mul_f32 v70, v70, v82
    v_mul_f32 v71, v71, v82
    v_mul_f32 v84, v67, v71
    v_mul_f32 v85, v67, v70
    v_fma_f32 v70, v66, v70, -v84
    v_fma_f32 v71, -v66, v71, -v85
    v_mul_f32 v82, v64, v46
    v_mul_f32 v83, v65, v46
    v_exp_f32 v82, v82
    v_fract_f32 v83, v83
    v_cos_f32 v72, v83
    v_sin_f32 v73, v83
    v_mul_f32 v72, v72, v82
    v_mul_f32 v73, v73, v82
    v_mul_f32 v84, v67, v73
    v_mul_f32 v85, v67, v72
    v_fma_f32 v72, v66, v72, -v84
    v_fma_f32 v73, -v66, v73, -v85
    v_mfma_f32_16x16x4_f32 v[48:51], v68, v74, v[48:51]
    v_mfma_f32_16x16x4_f32 v[52:55], v70, v76, v[52:55]
    v_mfma_f32_16x16x4_f32 v[56:59], v70, v78, v[56:59]
    v_mfma_f32_16x16x4_f32 v[60:63], v72, v80, v[60:63]
    v_mfma_f32_16x16x4_f32 v[48:51], v69, v75, v[48:51]
    v_mfma_f32_16x16x4_f32 v[52:55], v71, v77, v[52:55]
    v_mfma_f32_16x16x4_f32 v[56:59], v71, v79, v[56:59]
    v_mfma_f32_16x16x4_f32 v[60:63], v73, v81, v[60:63]
    v_mov_b32_dpp v64, v24 row_newbcast:3 row_mask:0xf bank_mask:0xf
    v_mov_b32_dpp v65, v25 row_newbcast:3 row_mask:0xf bank_mask:0xf
    v_mov_b32_dpp v66, v26 row_newbcast:3 row_mask:0xf bank_mask:0xf
    v_mov_b32_dpp v67, v27 row_newbcast:3 row_mask:0xf bank_mask:0xf
    v_mul_f32 v82, v64, v47
    v_mul_f32 v83, v65, v47
    v_exp_f32 v82, v82
    v_fract_f32 v83, v83
    v_cos_f32 v74, v83
    v_sin_f32 v75, v83
    v_mul_f32 v74, v74, v82
    v_mul_f32 v75, v75, v82
    v_mul_f32 v84, v75, v75
    v_add_f32 v85, v74, v74
    v_fma_f32 v76, v74, v74, -v84
    v_mul_f32 v77, v85, v75
    v_mul_f32 v84, v77, v77
    v_add_f32 v85, v76, v76
    v_fma_f32 v78, v76, v76, -v84
    v_mul_f32 v79, v85, v77
    v_mul_f32 v84, v79, v79
    v_add_f32 v85, v78, v78
    v_fma_f32 v80, v78, v78, -v84
    v_mul_f32 v81, v85, v79
    v_mul_f32 v82, v64, v44
    v_mul_f32 v83, v65, v44
    v_exp_f32 v82, v82
    v_fract_f32 v83, v83
    v_cos_f32 v68, v83
    v_sin_f32 v69, v83
    v_mul_f32 v68, v68, v82
    v_mul_f32 v69, v69, v82
    v_mul_f32 v84, v67, v69
    v_mul_f32 v85, v67, v68
    v_fma_f32 v68, v66, v68, -v84
    v_fma_f32 v69, -v66, v69, -v85
    v_mul_f32 v82, v64, v45
    v_mul_f32 v83, v65, v45
    v_exp_f32 v82, v82
    v_fract_f32 v83, v83
    v_cos_f32 v70, v83
    v_sin_f32 v71, v83
    v_mul_f32 v70, v70, v82
    v_mul_f32 v71, v71, v82
    v_mul_f32 v84, v67, v71
    v_mul_f32 v85, v67, v70
    v_fma_f32 v70, v66, v70, -v84
    v_fma_f32 v71, -v66, v71, -v85
    v_mul_f32 v82, v64, v46
    v_mul_f32 v83, v65, v46
    v_exp_f32 v82, v82
    v_fract_f32 v83, v83
    v_cos_f32 v72, v83
    v_sin_f32 v73, v83
    v_mul_f32 v72, v72, v82
    v_mul_f32 v73, v73, v82
    v_mul_f32 v84, v67, v73
    v_mul_f32 v85, v67, v72
    v_fma_f32 v72, v66, v72, -v84
    v_fma_f32 v73, -v66, v73, -v85
    v_mfma_f32_16x16x4_f32 v[48:51], v68, v74, v[48:51]
    v_mfma_f32_16x16x4_f32 v[52:55], v70, v76, v[52:55]
    v_mfma_f32_16x16x4_f32 v[56:59], v70, v78, v[56:59]
    v_mfma_f32_16x16x4_f32 v[60:63], v72, v80, v[60:63]
    v_mfma_f32_16x16x4_f32 v[48:51], v69, v75, v[48:51]
    v_mfma_f32_16x16x4_f32 v[52:55], v71, v77, v[52:55]
    v_mfma_f32_16x16x4_f32 v[56:59], v71, v79, v[56:59]
    v_mfma_f32_16x16x4_f32 v[60:63], v73, v81, v[60:63]
    v_mov_b32_dpp v64, v24 row_newbcast:4 row_mask:0xf bank_mask:0xf
    v_mov_b32_dpp v65, v25 row_newbcast:4 row_mask:0xf bank_mask:0xf
    v_mov_b32_dpp v66, v26 row_newbcast:4 row_mask:0xf bank_mask:0xf
    v_mov_b32_dpp v67, v27 row_newbcast:4 row_mask:0xf bank_mask:0xf
    v_mul_f32 v82, v64, v47
    v_mul_f32 v83, v65, v47
    v_exp_f32 v82, v82
    v_fract_f32 v83, v83
    v_cos_f32 v74, v83
    v_sin_f32 v75, v83
    v_mul_f32 v74, v74, v82
    v_mul_f32 v75, v75, v82
    v_mul_f32 v84, v75, v75
    v_add_f32 v85, v74, v74
    v_fma_f32 v76, v74, v74, -v84
    v_mul_f32 v77, v85, v75
    v_mul_f32 v84, v77, v77
    v_add_f32 v85, v76, v76
    v_fma_f32 v78, v76, v76, -v84
    v_mul_f32 v79, v85, v77
    v_mul_f32 v84, v79, v79
    v_add_f32 v85, v78, v78
    v_fma_f32 v80, v78, v78, -v84
    v_mul_f32 v81, v85, v79
    v_mul_f32 v82, v64, v44
    v_mul_f32 v83, v65, v44
    v_exp_f32 v82, v82
    v_fract_f32 v83, v83
    v_cos_f32 v68, v83
    v_sin_f32 v69, v83
    v_mul_f32 v68, v68, v82
    v_mul_f32 v69, v69, v82
    v_mul_f32 v84, v67, v69
    v_mul_f32 v85, v67, v68
    v_fma_f32 v68, v66, v68, -v84
    v_fma_f32 v69, -v66, v69, -v85
    v_mul_f32 v82, v64, v45
    v_mul_f32 v83, v65, v45
    v_exp_f32 v82, v82
    v_fract_f32 v83, v83
    v_cos_f32 v70, v83
    v_sin_f32 v71, v83
    v_mul_f32 v70, v70, v82
    v_mul_f32 v71, v71, v82
    v_mul_f32 v84, v67, v71
    v_mul_f32 v85, v67, v70
    v_fma_f32 v70, v66, v70, -v84
    v_fma_f32 v71, -v66, v71, -v85
    v_mul_f32 v82, v64, v46
    v_mul_f32 v83, v65, v46
    v_exp_f32 v82, v82
    v_fract_f32 v83, v83
    v_cos_f32 v72, v83
    v_sin_f32 v73, v83
    v_mul_f32 v72, v72, v82
    v_mul_f32 v73, v73, v82
    v_mul_f32 v84, v67, v73
    v_mul_f32 v85, v67, v72
    v_fma_f32 v72, v66, v72, -v84
    v_fma_f32 v73, -v66, v73, -v85
    v_mfma_f32_16x16x4_f32 v[48:51], v68, v74, v[48:51]
    v_mfma_f32_16x16x4_f32 v[52:55], v70, v76, v[52:55]
    v_mfma_f32_16x16x4_f32 v[56:59], v70, v78, v[56:59]
    v_mfma_f32_16x16x4_f32 v[60:63], v72, v80, v[60:63]
    v_mfma_f32_16x16x4_f32 v[48:51], v69, v75, v[48:51]
    v_mfma_f32_16x16x4_f32 v[52:55], v71, v77, v[52:55]
    v_mfma_f32_16x16x4_f32 v[56:59], v71, v79, v[56:59]
    v_mfma_f32_16x16x4_f32 v[60:63], v73, v81, v[60:63]
    v_mov_b32_dpp v64, v24 row_newbcast:5 row_mask:0xf bank_mask:0xf
    v_mov_b32_dpp v65, v25 row_newbcast:5 row_mask:0xf bank_mask:0xf
    v_mov_b32_dpp v66, v26 row_newbcast:5 row_mask:0xf bank_mask:0xf
    v_mov_b32_dpp v67, v27 row_newbcast:5 row_mask:0xf bank_mask:0xf
    v_mul_f32 v82, v64, v47
    v_mul_f32 v83, v65, v47
    v_exp_f32 v82, v82
    v_fract_f32 v83, v83
    v_cos_f32 v74, v83
    v_sin_f32 v75, v83
    v_mul_f32 v74, v74, v82
    v_mul_f32 v75, v75, v82
    v_mul_f32 v84, v75, v75
    v_add_f32 v85, v74, v74
    v_fma_f32 v76, v74, v74, -v84
    v_mul_f32 v77, v85, v75
    v_mul_f32 v84, v77, v77
    v_add_f32 v85, v76, v76
    v_fma_f32 v78, v76, v76, -v84
    v_mul_f32 v79, v85, v77
    v_mul_f32 v84, v79, v79
    v_add_f32 v85, v78, v78
    v_fma_f32 v80, v78, v78, -v84
    v_mul_f32 v81, v85, v79
    v_mul_f32 v82, v64, v44
    v_mul_f32 v83, v65, v44
    v_exp_f32 v82, v82
    v_fract_f32 v83, v83
    v_cos_f32 v68, v83
    v_sin_f32 v69, v83
    v_mul_f32 v68, v68, v82
    v_mul_f32 v69, v69, v82
    v_mul_f32 v84, v67, v69
    v_mul_f32 v85, v67, v68
    v_fma_f32 v68, v66, v68, -v84
    v_fma_f32 v69, -v66, v69, -v85
    v_mul_f32 v82, v64, v45
    v_mul_f32 v83, v65, v45
    v_exp_f32 v82, v82
    v_fract_f32 v83, v83
    v_cos_f32 v70, v83
    v_sin_f32 v71, v83
    v_mul_f32 v70, v70, v82
    v_mul_f32 v71, v71, v82
    v_mul_f32 v84, v67, v71
    v_mul_f32 v85, v67, v70
    v_fma_f32 v70, v66, v70, -v84
    v_fma_f32 v71, -v66, v71, -v85
    v_mul_f32 v82, v64, v46
    v_mul_f32 v83, v65, v46
    v_exp_f32 v82, v82
    v_fract_f32 v83, v83
    v_cos_f32 v72, v83
    v_sin_f32 v73, v83
    v_mul_f32 v72, v72, v82
    v_mul_f32 v73, v73, v82
    v_mul_f32 v84, v67, v73
    v_mul_f32 v85, v67, v72
    v_fma_f32 v72, v66, v72, -v84
    v_fma_f32 v73, -v66, v73, -v85
    v_mfma_f32_16x16x4_f32 v[48:51], v68, v74, v[48:51]
    v_mfma_f32_16x16x4_f32 v[52:55], v70, v76, v[52:55]
    v_mfma_f32_16x16x4_f32 v[56:59], v70, v78, v[56:59]
    v_mfma_f32_16x16x4_f32 v[60:63], v72, v80, v[60:63]
    v_mfma_f32_16x16x4_f32 v[48:51], v69, v75, v[48:51]
    v_mfma_f32_16x16x4_f32 v[52:55], v71, v77, v[52:55]
    v_mfma_f32_16x16x4_f32 v[56:59], v71, v79, v[56:59]
    v_mfma_f32_16x16x4_f32 v[60:63], v73, v81, v[60:63]
    v_mov_b32_dpp v64, v24 row_newbcast:6 row_mask:0xf bank_mask:0xf
    v_mov_b32_dpp v65, v25 row_newbcast:6 row_mask:0xf bank_mask:0xf
    v_mov_b32_dpp v66, v26 row_newbcast:6 row_mask:0xf bank_mask:0xf
    v_mov_b32_dpp v67, v27 row_newbcast:6 row_mask:0xf bank_mask:0xf
    v_mul_f32 v82, v64, v47
    v_mul_f32 v83, v65, v47
    v_exp_f32 v82, v82
    v_fract_f32 v83, v83
    v_cos_f32 v74, v83
    v_sin_f32 v75, v83
    v_mul_f32 v74, v74, v82
    v_mul_f32 v75, v75, v82
    v_mul_f32 v84, v75, v75
    v_add_f32 v85, v74, v74
    v_fma_f32 v76, v74, v74, -v84
    v_mul_f32 v77, v85, v75
    v_mul_f32 v84, v77, v77
    v_add_f32 v85, v76, v76
    v_fma_f32 v78, v76, v76, -v84
    v_mul_f32 v79, v85, v77
    v_mul_f32 v84, v79, v79
    v_add_f32 v85, v78, v78
    v_fma_f32 v80, v78, v78, -v84
    v_mul_f32 v81, v85, v79
    v_mul_f32 v82, v64, v44
    v_mul_f32 v83, v65, v44
    v_exp_f32 v82, v82
    v_fract_f32 v83, v83
    v_cos_f32 v68, v83
    v_sin_f32 v69, v83
    v_mul_f32 v68, v68, v82
    v_mul_f32 v69, v69, v82
    v_mul_f32 v84, v67, v69
    v_mul_f32 v85, v67, v68
    v_fma_f32 v68, v66, v68, -v84
    v_fma_f32 v69, -v66, v69, -v85
    v_mul_f32 v82, v64, v45
    v_mul_f32 v83, v65, v45
    v_exp_f32 v82, v82
    v_fract_f32 v83, v83
    v_cos_f32 v70, v83
    v_sin_f32 v71, v83
    v_mul_f32 v70, v70, v82
    v_mul_f32 v71, v71, v82
    v_mul_f32 v84, v67, v71
    v_mul_f32 v85, v67, v70
    v_fma_f32 v70, v66, v70, -v84
    v_fma_f32 v71, -v66, v71, -v85
    v_mul_f32 v82, v64, v46
    v_mul_f32 v83, v65, v46
    v_exp_f32 v82, v82
    v_fract_f32 v83, v83
    v_cos_f32 v72, v83
    v_sin_f32 v73, v83
    v_mul_f32 v72, v72, v82
    v_mul_f32 v73, v73, v82
    v_mul_f32 v84, v67, v73
    v_mul_f32 v85, v67, v72
    v_fma_f32 v72, v66, v72, -v84
    v_fma_f32 v73, -v66, v73, -v85
    v_mfma_f32_16x16x4_f32 v[48:51], v68, v74, v[48:51]
    v_mfma_f32_16x16x4_f32 v[52:55], v70, v76, v[52:55]
    v_mfma_f32_16x16x4_f32 v[56:59], v70, v78, v[56:59]
    v_mfma_f32_16x16x4_f32 v[60:63], v72, v80, v[60:63]
    v_mfma_f32_16x16x4_f32 v[48:51], v69, v75, v[48:51]
    v_mfma_f32_16x16x4_f32 v[52:55], v71, v77, v[52:55]
    v_mfma_f32_16x16x4_f32 v[56:59], v71, v79, v[56:59]
    v_mfma_f32_16x16x4_f32 v[60:63], v73, v81, v[60:63]
    v_mov_b32_dpp v64, v24 row_newbcast:7 row_mask:0xf bank_mask:0xf
    v_mov_b32_dpp v65, v25 row_newbcast:7 row_mask:0xf bank_mask:0xf
    v_mov_b32_dpp v66, v26 row_newbcast:7 row_mask:0xf bank_mask:0xf
    v_mov_b32_dpp v67, v27 row_newbcast:7 row_mask:0xf bank_mask:0xf
    v_mul_f32 v82, v64, v47
    v_mul_f32 v83, v65, v47
    v_exp_f32 v82, v82
    v_fract_f32 v83, v83
    v_cos_f32 v74, v83
    v_sin_f32 v75, v83
    v_mul_f32 v74, v74, v82
    v_mul_f32 v75, v75, v82
    v_mul_f32 v84, v75, v75
    v_add_f32 v85, v74, v74
    v_fma_f32 v76, v74, v74, -v84
    v_mul_f32 v77, v85, v75
    v_mul_f32 v84, v77, v77
    v_add_f32 v85, v76, v76
    v_fma_f32 v78, v76, v76, -v84
    v_mul_f32 v79, v85, v77
    v_mul_f32 v84, v79, v79
    v_add_f32 v85, v78, v78
    v_fma_f32 v80, v78, v78, -v84
    v_mul_f32 v81, v85, v79
    v_mul_f32 v82, v64, v44
    v_mul_f32 v83, v65, v44
    v_exp_f32 v82, v82
    v_fract_f32 v83, v83
    v_cos_f32 v68, v83
    v_sin_f32 v69, v83
    v_mul_f32 v68, v68, v82
    v_mul_f32 v69, v69, v82
    v_mul_f32 v84, v67, v69
    v_mul_f32 v85, v67, v68
    v_fma_f32 v68, v66, v68, -v84
    v_fma_f32 v69, -v66, v69, -v85
    v_mul_f32 v82, v64, v45
    v_mul_f32 v83, v65, v45
    v_exp_f32 v82, v82
    v_fract_f32 v83, v83
    v_cos_f32 v70, v83
    v_sin_f32 v71, v83
    v_mul_f32 v70, v70, v82
    v_mul_f32 v71, v71, v82
    v_mul_f32 v84, v67, v71
    v_mul_f32 v85, v67, v70
    v_fma_f32 v70, v66, v70, -v84
    v_fma_f32 v71, -v66, v71, -v85
    v_mul_f32 v82, v64, v46
    v_mul_f32 v83, v65, v46
    v_exp_f32 v82, v82
    v_fract_f32 v83, v83
    v_cos_f32 v72, v83
    v_sin_f32 v73, v83
    v_mul_f32 v72, v72, v82
    v_mul_f32 v73, v73, v82
    v_mul_f32 v84, v67, v73
    v_mul_f32 v85, v67, v72
    v_fma_f32 v72, v66, v72, -v84
    v_fma_f32 v73, -v66, v73, -v85
    v_mfma_f32_16x16x4_f32 v[48:51], v68, v74, v[48:51]
    v_mfma_f32_16x16x4_f32 v[52:55], v70, v76, v[52:55]
    v_mfma_f32_16x16x4_f32 v[56:59], v70, v78, v[56:59]
    v_mfma_f32_16x16x4_f32 v[60:63], v72, v80, v[60:63]
    v_mfma_f32_16x16x4_f32 v[48:51], v69, v75, v[48:51]
    v_mfma_f32_16x16x4_f32 v[52:55], v71, v77, v[52:55]
    v_mfma_f32_16x16x4_f32 v[56:59], v71, v79, v[56:59]
    v_mfma_f32_16x16x4_f32 v[60:63], v73, v81, v[60:63]
    v_mov_b32_dpp v64, v24 row_newbcast:8 row_mask:0xf bank_mask:0xf
    v_mov_b32_dpp v65, v25 row_newbcast:8 row_mask:0xf bank_mask:0xf
    v_mov_b32_dpp v66, v26 row_newbcast:8 row_mask:0xf bank_mask:0xf
    v_mov_b32_dpp v67, v27 row_newbcast:8 row_mask:0xf bank_mask:0xf
    v_mul_f32 v82, v64, v47
    v_mul_f32 v83, v65, v47
    v_exp_f32 v82, v82
    v_fract_f32 v83, v83
    v_cos_f32 v74, v83
    v_sin_f32 v75, v83
    v_mul_f32 v74, v74, v82
    v_mul_f32 v75, v75, v82
    v_mul_f32 v84, v75, v75
    v_add_f32 v85, v74, v74
    v_fma_f32 v76, v74, v74, -v84
    v_mul_f32 v77, v85, v75
    v_mul_f32 v84, v77, v77
    v_add_f32 v85, v76, v76
    v_fma_f32 v78, v76, v76, -v84
    v_mul_f32 v79, v85, v77
    v_mul_f32 v84, v79, v79
    v_add_f32 v85, v78, v78
    v_fma_f32 v80, v78, v78, -v84
    v_mul_f32 v81, v85, v79
    v_mul_f32 v82, v64, v44
    v_mul_f32 v83, v65, v44
    v_exp_f32 v82, v82
    v_fract_f32 v83, v83
    v_cos_f32 v68, v83
    v_sin_f32 v69, v83
    v_mul_f32 v68, v68, v82
    v_mul_f32 v69, v69, v82
    v_mul_f32 v84, v67, v69
    v_mul_f32 v85, v67, v68
    v_fma_f32 v68, v66, v68, -v84
    v_fma_f32 v69, -v66, v69, -v85
    v_mul_f32 v82, v64, v45
    v_mul_f32 v83, v65, v45
    v_exp_f32 v82, v82
    v_fract_f32 v83, v83
    v_cos_f32 v70, v83
    v_sin_f32 v71, v83
    v_mul_f32 v70, v70, v82
    v_mul_f32 v71, v71, v82
    v_mul_f32 v84, v67, v71
    v_mul_f32 v85, v67, v70
    v_fma_f32 v70, v66, v70, -v84
    v_fma_f32 v71, -v66, v71, -v85
    v_mul_f32 v82, v64, v46
    v_mul_f32 v83, v65, v46
    v_exp_f32 v82, v82
    v_fract_f32 v83, v83
    v_cos_f32 v72, v83
    v_sin_f32 v73, v83
    v_mul_f32 v72, v72, v82
    v_mul_f32 v73, v73, v82
    v_mul_f32 v84, v67, v73
    v_mul_f32 v85, v67, v72
    v_fma_f32 v72, v66, v72, -v84
    v_fma_f32 v73, -v66, v73, -v85
    v_mfma_f32_16x16x4_f32 v[48:51], v68, v74, v[48:51]
    v_mfma_f32_16x16x4_f32 v[52:55], v70, v76, v[52:55]
    v_mfma_f32_16x16x4_f32 v[56:59], v70, v78, v[56:59]
    v_mfma_f32_16x16x4_f32 v[60:63], v72, v80, v[60:63]
    v_mfma_f32_16x16x4_f32 v[48:51], v69, v75, v[48:51]
    v_mfma_f32_16x16x4_f32 v[52:55], v71, v77, v[52:55]
    v_mfma_f32_16x16x4_f32 v[56:59], v71, v79, v[56:59]
    v_mfma_f32_16x16x4_f32 v[60:63], v73, v81, v[60:63]
    v_mov_b32_dpp v64, v24 row_newbcast:9 row_mask:0xf bank_mask:0xf
    v_mov_b32_dpp v65, v25 row_newbcast:9 row_mask:0xf bank_mask:0xf
    v_mov_b32_dpp v66, v26 row_newbcast:9 row_mask:0xf bank_mask:0xf
    v_mov_b32_dpp v67, v27 row_newbcast:9 row_mask:0xf bank_mask:0xf
    v_mul_f32 v82, v64, v47
    v_mul_f32 v83, v65, v47
    v_exp_f32 v82, v82
    v_fract_f32 v83, v83
    v_cos_f32 v74, v83
    v_sin_f32 v75, v83
    v_mul_f32 v74, v74, v82
    v_mul_f32 v75, v75, v82
    v_mul_f32 v84, v75, v75
    v_add_f32 v85, v74, v74
    v_fma_f32 v76, v74, v74, -v84
    v_mul_f32 v77, v85, v75
    v_mul_f32 v84, v77, v77
    v_add_f32 v85, v76, v76
    v_fma_f32 v78, v76, v76, -v84
    v_mul_f32 v79, v85, v77
    v_mul_f32 v84, v79, v79
    v_add_f32 v85, v78, v78
    v_fma_f32 v80, v78, v78, -v84
    v_mul_f32 v81, v85, v79
    v_mul_f32 v82, v64, v44
    v_mul_f32 v83, v65, v44
    v_exp_f32 v82, v82
    v_fract_f32 v83, v83
    v_cos_f32 v68, v83
    v_sin_f32 v69, v83
    v_mul_f32 v68, v68, v82
    v_mul_f32 v69, v69, v82
    v_mul_f32 v84, v67, v69
    v_mul_f32 v85, v67, v68
    v_fma_f32 v68, v66, v68, -v84
    v_fma_f32 v69, -v66, v69, -v85
    v_mul_f32 v82, v64, v45
    v_mul_f32 v83, v65, v45
    v_exp_f32 v82, v82
    v_fract_f32 v83, v83
    v_cos_f32 v70, v83
    v_sin_f32 v71, v83
    v_mul_f32 v70, v70, v82
    v_mul_f32 v71, v71, v82
    v_mul_f32 v84, v67, v71
    v_mul_f32 v85, v67, v70
    v_fma_f32 v70, v66, v70, -v84
    v_fma_f32 v71, -v66, v71, -v85
    v_mul_f32 v82, v64, v46
    v_mul_f32 v83, v65, v46
    v_exp_f32 v82, v82
    v_fract_f32 v83, v83
    v_cos_f32 v72, v83
    v_sin_f32 v73, v83
    v_mul_f32 v72, v72, v82
    v_mul_f32 v73, v73, v82
    v_mul_f32 v84, v67, v73
    v_mul_f32 v85, v67, v72
    v_fma_f32 v72, v66, v72, -v84
    v_fma_f32 v73, -v66, v73, -v85
    v_mfma_f32_16x16x4_f32 v[48:51], v68, v74, v[48:51]
    v_mfma_f32_16x16x4_f32 v[52:55], v70, v76, v[52:55]
    v_mfma_f32_16x16x4_f32 v[56:59], v70, v78, v[56:59]
    v_mfma_f32_16x16x4_f32 v[60:63], v72, v80, v[60:63]
    v_mfma_f32_16x16x4_f32 v[48:51], v69, v75, v[48:51]
    v_mfma_f32_16x16x4_f32 v[52:55], v71, v77, v[52:55]
    v_mfma_f32_16x16x4_f32 v[56:59], v71, v79, v[56:59]
    v_mfma_f32_16x16x4_f32 v[60:63], v73, v81, v[60:63]
    v_mov_b32_dpp v64, v24 row_newbcast:10 row_mask:0xf bank_mask:0xf
    v_mov_b32_dpp v65, v25 row_newbcast:10 row_mask:0xf bank_mask:0xf
    v_mov_b32_dpp v66, v26 row_newbcast:10 row_mask:0xf bank_mask:0xf
    v_mov_b32_dpp v67, v27 row_newbcast:10 row_mask:0xf bank_mask:0xf
    v_mul_f32 v82, v64, v47
    v_mul_f32 v83, v65, v47
    v_exp_f32 v82, v82
    v_fract_f32 v83, v83
    v_cos_f32 v74, v83
    v_sin_f32 v75, v83
    v_mul_f32 v74, v74, v82
    v_mul_f32 v75, v75, v82
    v_mul_f32 v84, v75, v75
    v_add_f32 v85, v74, v74
    v_fma_f32 v76, v74, v74, -v84
    v_mul_f32 v77, v85, v75
    v_mul_f32 v84, v77, v77
    v_add_f32 v85, v76, v76
    v_fma_f32 v78, v76, v76, -v84
    v_mul_f32 v79, v85, v77
    v_mul_f32 v84, v79, v79
    v_add_f32 v85, v78, v78
    v_fma_f32 v80, v78, v78, -v84
    v_mul_f32 v81, v85, v79
    v_mul_f32 v82, v64, v44
    v_mul_f32 v83, v65, v44
    v_exp_f32 v82, v82
    v_fract_f32 v83, v83
    v_cos_f32 v68, v83
    v_sin_f32 v69, v83
    v_mul_f32 v68, v68, v82
    v_mul_f32 v69, v69, v82
    v_mul_f32 v84, v67, v69
    v_mul_f32 v85, v67, v68
    v_fma_f32 v68, v66, v68, -v84
    v_fma_f32 v69, -v66, v69, -v85
    v_mul_f32 v82, v64, v45
    v_mul_f32 v83, v65, v45
    v_exp_f32 v82, v82
    v_fract_f32 v83, v83
    v_cos_f32 v70, v83
    v_sin_f32 v71, v83
    v_mul_f32 v70, v70, v82
    v_mul_f32 v71, v71, v82
    v_mul_f32 v84, v67, v71
    v_mul_f32 v85, v67, v70
    v_fma_f32 v70, v66, v70, -v84
    v_fma_f32 v71, -v66, v71, -v85
    v_mul_f32 v82, v64, v46
    v_mul_f32 v83, v65, v46
    v_exp_f32 v82, v82
    v_fract_f32 v83, v83
    v_cos_f32 v72, v83
    v_sin_f32 v73, v83
    v_mul_f32 v72, v72, v82
    v_mul_f32 v73, v73, v82
    v_mul_f32 v84, v67, v73
    v_mul_f32 v85, v67, v72
    v_fma_f32 v72, v66, v72, -v84
    v_fma_f32 v73, -v66, v73, -v85
    v_mfma_f32_16x16x4_f32 v[48:51], v68, v74, v[48:51]
    v_mfma_f32_16x16x4_f32 v[52:55], v70, v76, v[52:55]
    v_mfma_f32_16x16x4_f32 v[56:59], v70, v78, v[56:59]
    v_mfma_f32_16x16x4_f32 v[60:63], v72, v80, v[60:63]
    v_mfma_f32_16x16x4_f32 v[48:51], v69, v75, v[48:51]
    v_mfma_f32_16x16x4_f32 v[52:55], v71, v77, v[52:55]
    v_mfma_f32_16x16x4_f32 v[56:59], v71, v79, v[56:59]
    v_mfma_f32_16x16x4_f32 v[60:63], v73, v81, v[60:63]
    v_mov_b32_dpp v64, v24 row_newbcast:11 row_mask:0xf bank_mask:0xf
    v_mov_b32_dpp v65, v25 row_newbcast:11 row_mask:0xf bank_mask:0xf
    v_mov_b32_dpp v66, v26 row_newbcast:11 row_mask:0xf bank_mask:0xf
    v_mov_b32_dpp v67, v27 row_newbcast:11 row_mask:0xf bank_mask:0xf
    v_mul_f32 v82, v64, v47
    v_mul_f32 v83, v65, v47
    v_exp_f32 v82, v82
    v_fract_f32 v83, v83
    v_cos_f32 v74, v83
    v_sin_f32 v75, v83
    v_mul_f32 v74, v74, v82
    v_mul_f32 v75, v75, v82
    v_mul_f32 v84, v75, v75
    v_add_f32 v85, v74, v74
    v_fma_f32 v76, v74, v74, -v84
    v_mul_f32 v77, v85, v75
    v_mul_f32 v84, v77, v77
    v_add_f32 v85, v76, v76
    v_fma_f32 v78, v76, v76, -v84
    v_mul_f32 v79, v85, v77
    v_mul_f32 v84, v79, v79
    v_add_f32 v85, v78, v78
    v_fma_f32 v80, v78, v78, -v84
    v_mul_f32 v81, v85, v79
    v_mul_f32 v82, v64, v44
    v_mul_f32 v83, v65, v44
    v_exp_f32 v82, v82
    v_fract_f32 v83, v83
    v_cos_f32 v68, v83
    v_sin_f32 v69, v83
    v_mul_f32 v68, v68, v82
    v_mul_f32 v69, v69, v82
    v_mul_f32 v84, v67, v69
    v_mul_f32 v85, v67, v68
    v_fma_f32 v68, v66, v68, -v84
    v_fma_f32 v69, -v66, v69, -v85
    v_mul_f32 v82, v64, v45
    v_mul_f32 v83, v65, v45
    v_exp_f32 v82, v82
    v_fract_f32 v83, v83
    v_cos_f32 v70, v83
    v_sin_f32 v71, v83
    v_mul_f32 v70, v70, v82
    v_mul_f32 v71, v71, v82
    v_mul_f32 v84, v67, v71
    v_mul_f32 v85, v67, v70
    v_fma_f32 v70, v66, v70, -v84
    v_fma_f32 v71, -v66, v71, -v85
    v_mul_f32 v82, v64, v46
    v_mul_f32 v83, v65, v46
    v_exp_f32 v82, v82
    v_fract_f32 v83, v83
    v_cos_f32 v72, v83
    v_sin_f32 v73, v83
    v_mul_f32 v72, v72, v82
    v_mul_f32 v73, v73, v82
    v_mul_f32 v84, v67, v73
    v_mul_f32 v85, v67, v72
    v_fma_f32 v72, v66, v72, -v84
    v_fma_f32 v73, -v66, v73, -v85
    v_mfma_f32_16x16x4_f32 v[48:51], v68, v74, v[48:51]
    v_mfma_f32_16x16x4_f32 v[52:55], v70, v76, v[52:55]
    v_mfma_f32_16x16x4_f32 v[56:59], v70, v78, v[56:59]
    v_mfma_f32_16x16x4_f32 v[60:63], v72, v80, v[60:63]
    v_mfma_f32_16x16x4_f32 v[48:51], v69, v75, v[48:51]
    v_mfma_f32_16x16x4_f32 v[52:55], v71, v77, v[52:55]
    v_mfma_f32_16x16x4_f32 v[56:59], v71, v79, v[56:59]
    v_mfma_f32_16x16x4_f32 v[60:63], v73, v81, v[60:63]
    v_mov_b32_dpp v64, v24 row_newbcast:12 row_mask:0xf bank_mask:0xf
    v_mov_b32_dpp v65, v25 row_newbcast:12 row_mask:0xf bank_mask:0xf
    v_mov_b32_dpp v66, v26 row_newbcast:12 row_mask:0xf bank_mask:0xf
    v_mov_b32_dpp v67, v27 row_newbcast:12 row_mask:0xf bank_mask:0xf
    v_mul_f32 v82, v64, v47
    v_mul_f32 v83, v65, v47
    v_exp_f32 v82, v82
    v_fract_f32 v83, v83
    v_cos_f32 v74, v83
    v_sin_f32 v75, v83
    v_mul_f32 v74, v74, v82
    v_mul_f32 v75, v75, v82
    v_mul_f32 v84, v75, v75
    v_add_f32 v85, v74, v74
    v_fma_f32 v76, v74, v74, -v84
    v_mul_f32 v77, v85, v75
    v_mul_f32 v84, v77, v77
    v_add_f32 v85, v76, v76
    v_fma_f32 v78, v76, v76, -v84
    v_mul_f32 v79, v85, v77
    v_mul_f32 v84, v79, v79
    v_add_f32 v85, v78, v78
    v_fma_f32 v80, v78, v78, -v84
    v_mul_f32 v81, v85, v79
    v_mul_f32 v82, v64, v44
    v_mul_f32 v83, v65, v44
    v_exp_f32 v82, v82
    v_fract_f32 v83, v83
    v_cos_f32 v68, v83
    v_sin_f32 v69, v83
    v_mul_f32 v68, v68, v82
    v_mul_f32 v69, v69, v82
    v_mul_f32 v84, v67, v69
    v_mul_f32 v85, v67, v68
    v_fma_f32 v68, v66, v68, -v84
    v_fma_f32 v69, -v66, v69, -v85
    v_mul_f32 v82, v64, v45
    v_mul_f32 v83, v65, v45
    v_exp_f32 v82, v82
    v_fract_f32 v83, v83
    v_cos_f32 v70, v83
    v_sin_f32 v71, v83
    v_mul_f32 v70, v70, v82
    v_mul_f32 v71, v71, v82
    v_mul_f32 v84, v67, v71
    v_mul_f32 v85, v67, v70
    v_fma_f32 v70, v66, v70, -v84
    v_fma_f32 v71, -v66, v71, -v85
    v_mul_f32 v82, v64, v46
    v_mul_f32 v83, v65, v46
    v_exp_f32 v82, v82
    v_fract_f32 v83, v83
    v_cos_f32 v72, v83
    v_sin_f32 v73, v83
    v_mul_f32 v72, v72, v82
    v_mul_f32 v73, v73, v82
    v_mul_f32 v84, v67, v73
    v_mul_f32 v85, v67, v72
    v_fma_f32 v72, v66, v72, -v84
    v_fma_f32 v73, -v66, v73, -v85
    v_mfma_f32_16x16x4_f32 v[48:51], v68, v74, v[48:51]
    v_mfma_f32_16x16x4_f32 v[52:55], v70, v76, v[52:55]
    v_mfma_f32_16x16x4_f32 v[56:59], v70, v78, v[56:59]
    v_mfma_f32_16x16x4_f32 v[60:63], v72, v80, v[60:63]
    v_mfma_f32_16x16x4_f32 v[48:51], v69, v75, v[48:51]
    v_mfma_f32_16x16x4_f32 v[52:55], v71, v77, v[52:55]
    v_mfma_f32_16x16x4_f32 v[56:59], v71, v79, v[56:59]
    v_mfma_f32_16x16x4_f32 v[60:63], v73, v81, v[60:63]
    v_mov_b32_dpp v64, v24 row_newbcast:13 row_mask:0xf bank_mask:0xf
    v_mov_b32_dpp v65, v25 row_newbcast:13 row_mask:0xf bank_mask:0xf
    v_mov_b32_dpp v66, v26 row_newbcast:13 row_mask:0xf bank_mask:0xf
    v_mov_b32_dpp v67, v27 row_newbcast:13 row_mask:0xf bank_mask:0xf
    v_mul_f32 v82, v64, v47
    v_mul_f32 v83, v65, v47
    v_exp_f32 v82, v82
    v_fract_f32 v83, v83
    v_cos_f32 v74, v83
    v_sin_f32 v75, v83
    v_mul_f32 v74, v74, v82
    v_mul_f32 v75, v75, v82
    v_mul_f32 v84, v75, v75
    v_add_f32 v85, v74, v74
    v_fma_f32 v76, v74, v74, -v84
    v_mul_f32 v77, v85, v75
    v_mul_f32 v84, v77, v77
    v_add_f32 v85, v76, v76
    v_fma_f32 v78, v76, v76, -v84
    v_mul_f32 v79, v85, v77
    v_mul_f32 v84, v79, v79
    v_add_f32 v85, v78, v78
    v_fma_f32 v80, v78, v78, -v84
    v_mul_f32 v81, v85, v79
    v_mul_f32 v82, v64, v44
    v_mul_f32 v83, v65, v44
    v_exp_f32 v82, v82
    v_fract_f32 v83, v83
    v_cos_f32 v68, v83
    v_sin_f32 v69, v83
    v_mul_f32 v68, v68, v82
    v_mul_f32 v69, v69, v82
    v_mul_f32 v84, v67, v69
    v_mul_f32 v85, v67, v68
    v_fma_f32 v68, v66, v68, -v84
    v_fma_f32 v69, -v66, v69, -v85
    v_mul_f32 v82, v64, v45
    v_mul_f32 v83, v65, v45
    v_exp_f32 v82, v82
    v_fract_f32 v83, v83
    v_cos_f32 v70, v83
    v_sin_f32 v71, v83
    v_mul_f32 v70, v70, v82
    v_mul_f32 v71, v71, v82
    v_mul_f32 v84, v67, v71
    v_mul_f32 v85, v67, v70
    v_fma_f32 v70, v66, v70, -v84
    v_fma_f32 v71, -v66, v71, -v85
    v_mul_f32 v82, v64, v46
    v_mul_f32 v83, v65, v46
    v_exp_f32 v82, v82
    v_fract_f32 v83, v83
    v_cos_f32 v72, v83
    v_sin_f32 v73, v83
    v_mul_f32 v72, v72, v82
    v_mul_f32 v73, v73, v82
    v_mul_f32 v84, v67, v73
    v_mul_f32 v85, v67, v72
    v_fma_f32 v72, v66, v72, -v84
    v_fma_f32 v73, -v66, v73, -v85
    v_mfma_f32_16x16x4_f32 v[48:51], v68, v74, v[48:51]
    v_mfma_f32_16x16x4_f32 v[52:55], v70, v76, v[52:55]
    v_mfma_f32_16x16x4_f32 v[56:59], v70, v78, v[56:59]
    v_mfma_f32_16x16x4_f32 v[60:63], v72, v80, v[60:63]
    v_mfma_f32_16x16x4_f32 v[48:51], v69, v75, v[48:51]
    v_mfma_f32_16x16x4_f32 v[52:55], v71, v77, v[52:55]
    v_mfma_f32_16x16x4_f32 v[56:59], v71, v79, v[56:59]
    v_mfma_f32_16x16x4_f32 v[60:63], v73, v81, v[60:63]
    v_mov_b32_dpp v64, v24 row_newbcast:14 row_mask:0xf bank_mask:0xf
    v_mov_b32_dpp v65, v25 row_newbcast:14 row_mask:0xf bank_mask:0xf
    v_mov_b32_dpp v66, v26 row_newbcast:14 row_mask:0xf bank_mask:0xf
    v_mov_b32_dpp v67, v27 row_newbcast:14 row_mask:0xf bank_mask:0xf
    v_mul_f32 v82, v64, v47
    v_mul_f32 v83, v65, v47
    v_exp_f32 v82, v82
    v_fract_f32 v83, v83
    v_cos_f32 v74, v83
    v_sin_f32 v75, v83
    v_mul_f32 v74, v74, v82
    v_mul_f32 v75, v75, v82
    v_mul_f32 v84, v75, v75
    v_add_f32 v85, v74, v74
    v_fma_f32 v76, v74, v74, -v84
    v_mul_f32 v77, v85, v75
    v_mul_f32 v84, v77, v77
    v_add_f32 v85, v76, v76
    v_fma_f32 v78, v76, v76, -v84
    v_mul_f32 v79, v85, v77
    v_mul_f32 v84, v79, v79
    v_add_f32 v85, v78, v78
    v_fma_f32 v80, v78, v78, -v84
    v_mul_f32 v81, v85, v79
    v_mul_f32 v82, v64, v44
    v_mul_f32 v83, v65, v44
    v_exp_f32 v82, v82
    v_fract_f32 v83, v83
    v_cos_f32 v68, v83
    v_sin_f32 v69, v83
    v_mul_f32 v68, v68, v82
    v_mul_f32 v69, v69, v82
    v_mul_f32 v84, v67, v69
    v_mul_f32 v85, v67, v68
    v_fma_f32 v68, v66, v68, -v84
    v_fma_f32 v69, -v66, v69, -v85
    v_mul_f32 v82, v64, v45
    v_mul_f32 v83, v65, v45
    v_exp_f32 v82, v82
    v_fract_f32 v83, v83
    v_cos_f32 v70, v83
    v_sin_f32 v71, v83
    v_mul_f32 v70, v70, v82
    v_mul_f32 v71, v71, v82
    v_mul_f32 v84, v67, v71
    v_mul_f32 v85, v67, v70
    v_fma_f32 v70, v66, v70, -v84
    v_fma_f32 v71, -v66, v71, -v85
    v_mul_f32 v82, v64, v46
    v_mul_f32 v83, v65, v46
    v_exp_f32 v82, v82
    v_fract_f32 v83, v83
    v_cos_f32 v72, v83
    v_sin_f32 v73, v83
    v_mul_f32 v72, v72, v82
    v_mul_f32 v73, v73, v82
    v_mul_f32 v84, v67, v73
    v_mul_f32 v85, v67, v72
    v_fma_f32 v72, v66, v72, -v84
    v_fma_f32 v73, -v66, v73, -v85
    v_mfma_f32_16x16x4_f32 v[48:51], v68, v74, v[48:51]
    v_mfma_f32_16x16x4_f32 v[52:55], v70, v76, v[52:55]
    v_mfma_f32_16x16x4_f32 v[56:59], v70, v78, v[56:59]
    v_mfma_f32_16x16x4_f32 v[60:63], v72, v80, v[60:63]
    v_mfma_f32_16x16x4_f32 v[48:51], v69, v75, v[48:51]
    v_mfma_f32_16x16x4_f32 v[52:55], v71, v77, v[52:55]
    v_mfma_f32_16x16x4_f32 v[56:59], v71, v79, v[56:59]
    v_mfma_f32_16x16x4_f32 v[60:63], v73, v81, v[60:63]
    v_mov_b32_dpp v64, v24 row_newbcast:15 row_mask:0xf bank_mask:0xf
    v_mov_b32_dpp v65, v25 row_newbcast:15 row_mask:0xf bank_mask:0xf
    v_mov_b32_dpp v66, v26 row_newbcast:15 row_mask:0xf bank_mask:0xf
    v_mov_b32_dpp v67, v27 row_newbcast:15 row_mask:0xf bank_mask:0xf
    v_mul_f32 v82, v64, v47
    v_mul_f32 v83, v65, v47
    v_exp_f32 v82, v82
    v_fract_f32 v83, v83
    v_cos_f32 v74, v83
    v_sin_f32 v75, v83
    v_mul_f32 v74, v74, v82
    v_mul_f32 v75, v75, v82
    v_mul_f32 v84, v75, v75
    v_add_f32 v85, v74, v74
    v_fma_f32 v76, v74, v74, -v84
    v_mul_f32 v77, v85, v75
    v_mul_f32 v84, v77, v77
    v_add_f32 v85, v76, v76
    v_fma_f32 v78, v76, v76, -v84
    v_mul_f32 v79, v85, v77
    v_mul_f32 v84, v79, v79
    v_add_f32 v85, v78, v78
    v_fma_f32 v80, v78, v78, -v84
    v_mul_f32 v81, v85, v79
    v_mul_f32 v82, v64, v44
    v_mul_f32 v83, v65, v44
    v_exp_f32 v82, v82
    v_fract_f32 v83, v83
    v_cos_f32 v68, v83
    v_sin_f32 v69, v83
    v_mul_f32 v68, v68, v82
    v_mul_f32 v69, v69, v82
    v_mul_f32 v84, v67, v69
    v_mul_f32 v85, v67, v68
    v_fma_f32 v68, v66, v68, -v84
    v_fma_f32 v69, -v66, v69, -v85
    v_mul_f32 v82, v64, v45
    v_mul_f32 v83, v65, v45
    v_exp_f32 v82, v82
    v_fract_f32 v83, v83
    v_cos_f32 v70, v83
    v_sin_f32 v71, v83
    v_mul_f32 v70, v70, v82
    v_mul_f32 v71, v71, v82
    v_mul_f32 v84, v67, v71
    v_mul_f32 v85, v67, v70
    v_fma_f32 v70, v66, v70, -v84
    v_fma_f32 v71, -v66, v71, -v85
    v_mul_f32 v82, v64, v46
    v_mul_f32 v83, v65, v46
    v_exp_f32 v82, v82
    v_fract_f32 v83, v83
    v_cos_f32 v72, v83
    v_sin_f32 v73, v83
    v_mul_f32 v72, v72, v82
    v_mul_f32 v73, v73, v82
    v_mul_f32 v84, v67, v73
    v_mul_f32 v85, v67, v72
    v_fma_f32 v72, v66, v72, -v84
    v_fma_f32 v73, -v66, v73, -v85
    v_mfma_f32_16x16x4_f32 v[48:51], v68, v74, v[48:51]
    v_mfma_f32_16x16x4_f32 v[52:55], v70, v76, v[52:55]
    v_mfma_f32_16x16x4_f32 v[56:59], v70, v78, v[56:59]
    v_mfma_f32_16x16x4_f32 v[60:63], v72, v80, v[60:63]
    v_mfma_f32_16x16x4_f32 v[48:51], v69, v75, v[48:51]
    v_mfma_f32_16x16x4_f32 v[52:55], v71, v77, v[52:55]
    v_mfma_f32_16x16x4_f32 v[56:59], v71, v79, v[56:59]
    v_mfma_f32_16x16x4_f32 v[60:63], v73, v81, v[60:63]
    v_mov_b32_dpp v64, v28 row_newbcast:0 row_mask:0xf bank_mask:0xf
    v_mov_b32_dpp v65, v29 row_newbcast:0 row_mask:0xf bank_mask:0xf
    v_mov_b32_dpp v66, v30 row_newbcast:0 row_mask:0xf bank_mask:0xf
    v_mov_b32_dpp v67, v31 row_newbcast:0 row_mask:0xf bank_mask:0xf
    v_mul_f32 v82, v64, v47
    v_mul_f32 v83, v65, v47
    v_exp_f32 v82, v82
    v_fract_f32 v83, v83
    v_cos_f32 v74, v83
    v_sin_f32 v75, v83
    v_mul_f32 v74, v74, v82
    v_mul_f32 v75, v75, v82
    v_mul_f32 v84, v75, v75
    v_add_f32 v85, v74, v74
    v_fma_f32 v76, v74, v74, -v84
    v_mul_f32 v77, v85, v75
    v_mul_f32 v84, v77, v77
    v_add_f32 v85, v76, v76
    v_fma_f32 v78, v76, v76, -v84
    v_mul_f32 v79, v85, v77
    v_mul_f32 v84, v79, v79
    v_add_f32 v85, v78, v78
    v_fma_f32 v80, v78, v78, -v84
    v_mul_f32 v81, v85, v79
    v_mul_f32 v82, v64, v44
    v_mul_f32 v83, v65, v44
    v_exp_f32 v82, v82
    v_fract_f32 v83, v83
    v_cos_f32 v68, v83
    v_sin_f32 v69, v83
    v_mul_f32 v68, v68, v82
    v_mul_f32 v69, v69, v82
    v_mul_f32 v84, v67, v69
    v_mul_f32 v85, v67, v68
    v_fma_f32 v68, v66, v68, -v84
    v_fma_f32 v69, -v66, v69, -v85
    v_mul_f32 v82, v64, v45
    v_mul_f32 v83, v65, v45
    v_exp_f32 v82, v82
    v_fract_f32 v83, v83
    v_cos_f32 v70, v83
    v_sin_f32 v71, v83
    v_mul_f32 v70, v70, v82
    v_mul_f32 v71, v71, v82
    v_mul_f32 v84, v67, v71
    v_mul_f32 v85, v67, v70
    v_fma_f32 v70, v66, v70, -v84
    v_fma_f32 v71, -v66, v71, -v85
    v_mul_f32 v82, v64, v46
    v_mul_f32 v83, v65, v46
    v_exp_f32 v82, v82
    v_fract_f32 v83, v83
    v_cos_f32 v72, v83
    v_sin_f32 v73, v83
    v_mul_f32 v72, v72, v82
    v_mul_f32 v73, v73, v82
    v_mul_f32 v84, v67, v73
    v_mul_f32 v85, v67, v72
    v_fma_f32 v72, v66, v72, -v84
    v_fma_f32 v73, -v66, v73, -v85
    v_mfma_f32_16x16x4_f32 v[48:51], v68, v74, v[48:51]
    v_mfma_f32_16x16x4_f32 v[52:55], v70, v76, v[52:55]
    v_mfma_f32_16x16x4_f32 v[56:59], v70, v78, v[56:59]
    v_mfma_f32_16x16x4_f32 v[60:63], v72, v80, v[60:63]
    v_mfma_f32_16x16x4_f32 v[48:51], v69, v75, v[48:51]
    v_mfma_f32_16x16x4_f32 v[52:55], v71, v77, v[52:55]
    v_mfma_f32_16x16x4_f32 v[56:59], v71, v79, v[56:59]
    v_mfma_f32_16x16x4_f32 v[60:63], v73, v81, v[60:63]
    v_mov_b32_dpp v64, v28 row_newbcast:1 row_mask:0xf bank_mask:0xf
    v_mov_b32_dpp v65, v29 row_newbcast:1 row_mask:0xf bank_mask:0xf
    v_mov_b32_dpp v66, v30 row_newbcast:1 row_mask:0xf bank_mask:0xf
    v_mov_b32_dpp v67, v31 row_newbcast:1 row_mask:0xf bank_mask:0xf
    v_mul_f32 v82, v64, v47
    v_mul_f32 v83, v65, v47
    v_exp_f32 v82, v82
    v_fract_f32 v83, v83
    v_cos_f32 v74, v83
    v_sin_f32 v75, v83
    v_mul_f32 v74, v74, v82
    v_mul_f32 v75, v75, v82
    v_mul_f32 v84, v75, v75
    v_add_f32 v85, v74, v74
    v_fma_f32 v76, v74, v74, -v84
    v_mul_f32 v77, v85, v75
    v_mul_f32 v84, v77, v77
    v_add_f32 v85, v76, v76
    v_fma_f32 v78, v76, v76, -v84
    v_mul_f32 v79, v85, v77
    v_mul_f32 v84, v79, v79
    v_add_f32 v85, v78, v78
    v_fma_f32 v80, v78, v78, -v84
    v_mul_f32 v81, v85, v79
    v_mul_f32 v82, v64, v44
    v_mul_f32 v83, v65, v44
    v_exp_f32 v82, v82
    v_fract_f32 v83, v83
    v_cos_f32 v68, v83
    v_sin_f32 v69, v83
    v_mul_f32 v68, v68, v82
    v_mul_f32 v69, v69, v82
    v_mul_f32 v84, v67, v69
    v_mul_f32 v85, v67, v68
    v_fma_f32 v68, v66, v68, -v84
    v_fma_f32 v69, -v66, v69, -v85
    v_mul_f32 v82, v64, v45
    v_mul_f32 v83, v65, v45
    v_exp_f32 v82, v82
    v_fract_f32 v83, v83
    v_cos_f32 v70, v83
    v_sin_f32 v71, v83
    v_mul_f32 v70, v70, v82
    v_mul_f32 v71, v71, v82
    v_mul_f32 v84, v67, v71
    v_mul_f32 v85, v67, v70
    v_fma_f32 v70, v66, v70, -v84
    v_fma_f32 v71, -v66, v71, -v85
    v_mul_f32 v82, v64, v46
    v_mul_f32 v83, v65, v46
    v_exp_f32 v82, v82
    v_fract_f32 v83, v83
    v_cos_f32 v72, v83
    v_sin_f32 v73, v83
    v_mul_f32 v72, v72, v82
    v_mul_f32 v73, v73, v82
    v_mul_f32 v84, v67, v73
    v_mul_f32 v85, v67, v72
    v_fma_f32 v72, v66, v72, -v84
    v_fma_f32 v73, -v66, v73, -v85
    v_mfma_f32_16x16x4_f32 v[48:51], v68, v74, v[48:51]
    v_mfma_f32_16x16x4_f32 v[52:55], v70, v76, v[52:55]
    v_mfma_f32_16x16x4_f32 v[56:59], v70, v78, v[56:59]
    v_mfma_f32_16x16x4_f32 v[60:63], v72, v80, v[60:63]
    v_mfma_f32_16x16x4_f32 v[48:51], v69, v75, v[48:51]
    v_mfma_f32_16x16x4_f32 v[52:55], v71, v77, v[52:55]
    v_mfma_f32_16x16x4_f32 v[56:59], v71, v79, v[56:59]
    v_mfma_f32_16x16x4_f32 v[60:63], v73, v81, v[60:63]
    v_mov_b32_dpp v64, v28 row_newbcast:2 row_mask:0xf bank_mask:0xf
    v_mov_b32_dpp v65, v29 row_newbcast:2 row_mask:0xf bank_mask:0xf
    v_mov_b32_dpp v66, v30 row_newbcast:2 row_mask:0xf bank_mask:0xf
    v_mov_b32_dpp v67, v31 row_newbcast:2 row_mask:0xf bank_mask:0xf
    v_mul_f32 v82, v64, v47
    v_mul_f32 v83, v65, v47
    v_exp_f32 v82, v82
    v_fract_f32 v83, v83
    v_cos_f32 v74, v83
    v_sin_f32 v75, v83
    v_mul_f32 v74, v74, v82
    v_mul_f32 v75, v75, v82
    v_mul_f32 v84, v75, v75
    v_add_f32 v85, v74, v74
    v_fma_f32 v76, v74, v74, -v84
    v_mul_f32 v77, v85, v75
    v_mul_f32 v84, v77, v77
    v_add_f32 v85, v76, v76
    v_fma_f32 v78, v76, v76, -v84
    v_mul_f32 v79, v85, v77
    v_mul_f32 v84, v79, v79
    v_add_f32 v85, v78, v78
    v_fma_f32 v80, v78, v78, -v84
    v_mul_f32 v81, v85, v79
    v_mul_f32 v82, v64, v44
    v_mul_f32 v83, v65, v44
    v_exp_f32 v82, v82
    v_fract_f32 v83, v83
    v_cos_f32 v68, v83
    v_sin_f32 v69, v83
    v_mul_f32 v68, v68, v82
    v_mul_f32 v69, v69, v82
    v_mul_f32 v84, v67, v69
    v_mul_f32 v85, v67, v68
    v_fma_f32 v68, v66, v68, -v84
    v_fma_f32 v69, -v66, v69, -v85
    v_mul_f32 v82, v64, v45
    v_mul_f32 v83, v65, v45
    v_exp_f32 v82, v82
    v_fract_f32 v83, v83
    v_cos_f32 v70, v83
    v_sin_f32 v71, v83
    v_mul_f32 v70, v70, v82
    v_mul_f32 v71, v71, v82
    v_mul_f32 v84, v67, v71
    v_mul_f32 v85, v67, v70
    v_fma_f32 v70, v66, v70, -v84
    v_fma_f32 v71, -v66, v71, -v85
    v_mul_f32 v82, v64, v46
    v_mul_f32 v83, v65, v46
    v_exp_f32 v82, v82
    v_fract_f32 v83, v83
    v_cos_f32 v72, v83
    v_sin_f32 v73, v83
    v_mul_f32 v72, v72, v82
    v_mul_f32 v73, v73, v82
    v_mul_f32 v84, v67, v73
    v_mul_f32 v85, v67, v72
    v_fma_f32 v72, v66, v72, -v84
    v_fma_f32 v73, -v66, v73, -v85
    v_mfma_f32_16x16x4_f32 v[48:51], v68, v74, v[48:51]
    v_mfma_f32_16x16x4_f32 v[52:55], v70, v76, v[52:55]
    v_mfma_f32_16x16x4_f32 v[56:59], v70, v78, v[56:59]
    v_mfma_f32_16x16x4_f32 v[60:63], v72, v80, v[60:63]
    v_mfma_f32_16x16x4_f32 v[48:51], v69, v75, v[48:51]
    v_mfma_f32_16x16x4_f32 v[52:55], v71, v77, v[52:55]
    v_mfma_f32_16x16x4_f32 v[56:59], v71, v79, v[56:59]
    v_mfma_f32_16x16x4_f32 v[60:63], v73, v81, v[60:63]
    v_mov_b32_dpp v64, v28 row_newbcast:3 row_mask:0xf bank_mask:0xf
    v_mov_b32_dpp v65, v29 row_newbcast:3 row_mask:0xf bank_mask:0xf
    v_mov_b32_dpp v66, v30 row_newbcast:3 row_mask:0xf bank_mask:0xf
    v_mov_b32_dpp v67, v31 row_newbcast:3 row_mask:0xf bank_mask:0xf
    v_mul_f32 v82, v64, v47
    v_mul_f32 v83, v65, v47
    v_exp_f32 v82, v82
    v_fract_f32 v83, v83
    v_cos_f32 v74, v83
    v_sin_f32 v75, v83
    v_mul_f32 v74, v74, v82
    v_mul_f32 v75, v75, v82
    v_mul_f32 v84, v75, v75
    v_add_f32 v85, v74, v74
    v_fma_f32 v76, v74, v74, -v84
    v_mul_f32 v77, v85, v75
    v_mul_f32 v84, v77, v77
    v_add_f32 v85, v76, v76
    v_fma_f32 v78, v76, v76, -v84
    v_mul_f32 v79, v85, v77
    v_mul_f32 v84, v79, v79
    v_add_f32 v85, v78, v78
    v_fma_f32 v80, v78, v78, -v84
    v_mul_f32 v81, v85, v79
    v_mul_f32 v82, v64, v44
    v_mul_f32 v83, v65, v44
    v_exp_f32 v82, v82
    v_fract_f32 v83, v83
    v_cos_f32 v68, v83
    v_sin_f32 v69, v83
    v_mul_f32 v68, v68, v82
    v_mul_f32 v69, v69, v82
    v_mul_f32 v84, v67, v69
    v_mul_f32 v85, v67, v68
    v_fma_f32 v68, v66, v68, -v84
    v_fma_f32 v69, -v66, v69, -v85
    v_mul_f32 v82, v64, v45
    v_mul_f32 v83, v65, v45
    v_exp_f32 v82, v82
    v_fract_f32 v83, v83
    v_cos_f32 v70, v83
    v_sin_f32 v71, v83
    v_mul_f32 v70, v70, v82
    v_mul_f32 v71, v71, v82
    v_mul_f32 v84, v67, v71
    v_mul_f32 v85, v67, v70
    v_fma_f32 v70, v66, v70, -v84
    v_fma_f32 v71, -v66, v71, -v85
    v_mul_f32 v82, v64, v46
    v_mul_f32 v83, v65, v46
    v_exp_f32 v82, v82
    v_fract_f32 v83, v83
    v_cos_f32 v72, v83
    v_sin_f32 v73, v83
    v_mul_f32 v72, v72, v82
    v_mul_f32 v73, v73, v82
    v_mul_f32 v84, v67, v73
    v_mul_f32 v85, v67, v72
    v_fma_f32 v72, v66, v72, -v84
    v_fma_f32 v73, -v66, v73, -v85
    v_mfma_f32_16x16x4_f32 v[48:51], v68, v74, v[48:51]
    v_mfma_f32_16x16x4_f32 v[52:55], v70, v76, v[52:55]
    v_mfma_f32_16x16x4_f32 v[56:59], v70, v78, v[56:59]
    v_mfma_f32_16x16x4_f32 v[60:63], v72, v80, v[60:63]
    v_mfma_f32_16x16x4_f32 v[48:51], v69, v75, v[48:51]
    v_mfma_f32_16x16x4_f32 v[52:55], v71, v77, v[52:55]
    v_mfma_f32_16x16x4_f32 v[56:59], v71, v79, v[56:59]
    v_mfma_f32_16x16x4_f32 v[60:63], v73, v81, v[60:63]
    v_mov_b32_dpp v64, v28 row_newbcast:4 row_mask:0xf bank_mask:0xf
    v_mov_b32_dpp v65, v29 row_newbcast:4 row_mask:0xf bank_mask:0xf
    v_mov_b32_dpp v66, v30 row_newbcast:4 row_mask:0xf bank_mask:0xf
    v_mov_b32_dpp v67, v31 row_newbcast:4 row_mask:0xf bank_mask:0xf
    v_mul_f32 v82, v64, v47
    v_mul_f32 v83, v65, v47
    v_exp_f32 v82, v82
    v_fract_f32 v83, v83
    v_cos_f32 v74, v83
    v_sin_f32 v75, v83
    v_mul_f32 v74, v74, v82
    v_mul_f32 v75, v75, v82
    v_mul_f32 v84, v75, v75
    v_add_f32 v85, v74, v74
    v_fma_f32 v76, v74, v74, -v84
    v_mul_f32 v77, v85, v75
    v_mul_f32 v84, v77, v77
    v_add_f32 v85, v76, v76
    v_fma_f32 v78, v76, v76, -v84
    v_mul_f32 v79, v85, v77
    v_mul_f32 v84, v79, v79
    v_add_f32 v85, v78, v78
    v_fma_f32 v80, v78, v78, -v84
    v_mul_f32 v81, v85, v79
    v_mul_f32 v82, v64, v44
    v_mul_f32 v83, v65, v44
    v_exp_f32 v82, v82
    v_fract_f32 v83, v83
    v_cos_f32 v68, v83
    v_sin_f32 v69, v83
    v_mul_f32 v68, v68, v82
    v_mul_f32 v69, v69, v82
    v_mul_f32 v84, v67, v69
    v_mul_f32 v85, v67, v68
    v_fma_f32 v68, v66, v68, -v84
    v_fma_f32 v69, -v66, v69, -v85
    v_mul_f32 v82, v64, v45
    v_mul_f32 v83, v65, v45
    v_exp_f32 v82, v82
    v_fract_f32 v83, v83
    v_cos_f32 v70, v83
    v_sin_f32 v71, v83
    v_mul_f32 v70, v70, v82
    v_mul_f32 v71, v71, v82
    v_mul_f32 v84, v67, v71
    v_mul_f32 v85, v67, v70
    v_fma_f32 v70, v66, v70, -v84
    v_fma_f32 v71, -v66, v71, -v85
    v_mul_f32 v82, v64, v46
    v_mul_f32 v83, v65, v46
    v_exp_f32 v82, v82
    v_fract_f32 v83, v83
    v_cos_f32 v72, v83
    v_sin_f32 v73, v83
    v_mul_f32 v72, v72, v82
    v_mul_f32 v73, v73, v82
    v_mul_f32 v84, v67, v73
    v_mul_f32 v85, v67, v72
    v_fma_f32 v72, v66, v72, -v84
    v_fma_f32 v73, -v66, v73, -v85
    v_mfma_f32_16x16x4_f32 v[48:51], v68, v74, v[48:51]
    v_mfma_f32_16x16x4_f32 v[52:55], v70, v76, v[52:55]
    v_mfma_f32_16x16x4_f32 v[56:59], v70, v78, v[56:59]
    v_mfma_f32_16x16x4_f32 v[60:63], v72, v80, v[60:63]
    v_mfma_f32_16x16x4_f32 v[48:51], v69, v75, v[48:51]
    v_mfma_f32_16x16x4_f32 v[52:55], v71, v77, v[52:55]
    v_mfma_f32_16x16x4_f32 v[56:59], v71, v79, v[56:59]
    v_mfma_f32_16x16x4_f32 v[60:63], v73, v81, v[60:63]
    v_mov_b32_dpp v64, v28 row_newbcast:5 row_mask:0xf bank_mask:0xf
    v_mov_b32_dpp v65, v29 row_newbcast:5 row_mask:0xf bank_mask:0xf
    v_mov_b32_dpp v66, v30 row_newbcast:5 row_mask:0xf bank_mask:0xf
    v_mov_b32_dpp v67, v31 row_newbcast:5 row_mask:0xf bank_mask:0xf
    v_mul_f32 v82, v64, v47
    v_mul_f32 v83, v65, v47
    v_exp_f32 v82, v82
    v_fract_f32 v83, v83
    v_cos_f32 v74, v83
    v_sin_f32 v75, v83
    v_mul_f32 v74, v74, v82
    v_mul_f32 v75, v75, v82
    v_mul_f32 v84, v75, v75
    v_add_f32 v85, v74, v74
    v_fma_f32 v76, v74, v74, -v84
    v_mul_f32 v77, v85, v75
    v_mul_f32 v84, v77, v77
    v_add_f32 v85, v76, v76
    v_fma_f32 v78, v76, v76, -v84
    v_mul_f32 v79, v85, v77
    v_mul_f32 v84, v79, v79
    v_add_f32 v85, v78, v78
    v_fma_f32 v80, v78, v78, -v84
    v_mul_f32 v81, v85, v79
    v_mul_f32 v82, v64, v44
    v_mul_f32 v83, v65, v44
    v_exp_f32 v82, v82
    v_fract_f32 v83, v83
    v_cos_f32 v68, v83
    v_sin_f32 v69, v83
    v_mul_f32 v68, v68, v82
    v_mul_f32 v69, v69, v82
    v_mul_f32 v84, v67, v69
    v_mul_f32 v85, v67, v68
    v_fma_f32 v68, v66, v68, -v84
    v_fma_f32 v69, -v66, v69, -v85
    v_mul_f32 v82, v64, v45
    v_mul_f32 v83, v65, v45
    v_exp_f32 v82, v82
    v_fract_f32 v83, v83
    v_cos_f32 v70, v83
    v_sin_f32 v71, v83
    v_mul_f32 v70, v70, v82
    v_mul_f32 v71, v71, v82
    v_mul_f32 v84, v67, v71
    v_mul_f32 v85, v67, v70
    v_fma_f32 v70, v66, v70, -v84
    v_fma_f32 v71, -v66, v71, -v85
    v_mul_f32 v82, v64, v46
    v_mul_f32 v83, v65, v46
    v_exp_f32 v82, v82
    v_fract_f32 v83, v83
    v_cos_f32 v72, v83
    v_sin_f32 v73, v83
    v_mul_f32 v72, v72, v82
    v_mul_f32 v73, v73, v82
    v_mul_f32 v84, v67, v73
    v_mul_f32 v85, v67, v72
    v_fma_f32 v72, v66, v72, -v84
    v_fma_f32 v73, -v66, v73, -v85
    v_mfma_f32_16x16x4_f32 v[48:51], v68, v74, v[48:51]
    v_mfma_f32_16x16x4_f32 v[52:55], v70, v76, v[52:55]
    v_mfma_f32_16x16x4_f32 v[56:59], v70, v78, v[56:59]
    v_mfma_f32_16x16x4_f32 v[60:63], v72, v80, v[60:63]
    v_mfma_f32_16x16x4_f32 v[48:51], v69, v75, v[48:51]
    v_mfma_f32_16x16x4_f32 v[52:55], v71, v77, v[52:55]
    v_mfma_f32_16x16x4_f32 v[56:59], v71, v79, v[56:59]
    v_mfma_f32_16x16x4_f32 v[60:63], v73, v81, v[60:63]
    v_mov_b32_dpp v64, v28 row_newbcast:6 row_mask:0xf bank_mask:0xf
    v_mov_b32_dpp v65, v29 row_newbcast:6 row_mask:0xf bank_mask:0xf
    v_mov_b32_dpp v66, v30 row_newbcast:6 row_mask:0xf bank_mask:0xf
    v_mov_b32_dpp v67, v31 row_newbcast:6 row_mask:0xf bank_mask:0xf
    v_mul_f32 v82, v64, v47
    v_mul_f32 v83, v65, v47
    v_exp_f32 v82, v82
    v_fract_f32 v83, v83
    v_cos_f32 v74, v83
    v_sin_f32 v75, v83
    v_mul_f32 v74, v74, v82
    v_mul_f32 v75, v75, v82
    v_mul_f32 v84, v75, v75
    v_add_f32 v85, v74, v74
    v_fma_f32 v76, v74, v74, -v84
    v_mul_f32 v77, v85, v75
    v_mul_f32 v84, v77, v77
    v_add_f32 v85, v76, v76
    v_fma_f32 v78, v76, v76, -v84
    v_mul_f32 v79, v85, v77
    v_mul_f32 v84, v79, v79
    v_add_f32 v85, v78, v78
    v_fma_f32 v80, v78, v78, -v84
    v_mul_f32 v81, v85, v79
    v_mul_f32 v82, v64, v44
    v_mul_f32 v83, v65, v44
    v_exp_f32 v82, v82
    v_fract_f32 v83, v83
    v_cos_f32 v68, v83
    v_sin_f32 v69, v83
    v_mul_f32 v68, v68, v82
    v_mul_f32 v69, v69, v82
    v_mul_f32 v84, v67, v69
    v_mul_f32 v85, v67, v68
    v_fma_f32 v68, v66, v68, -v84
    v_fma_f32 v69, -v66, v69, -v85
    v_mul_f32 v82, v64, v45
    v_mul_f32 v83, v65, v45
    v_exp_f32 v82, v82
    v_fract_f32 v83, v83
    v_cos_f32 v70, v83
    v_sin_f32 v71, v83
    v_mul_f32 v70, v70, v82
    v_mul_f32 v71, v71, v82
    v_mul_f32 v84, v67, v71
    v_mul_f32 v85, v67, v70
    v_fma_f32 v70, v66, v70, -v84
    v_fma_f32 v71, -v66, v71, -v85
    v_mul_f32 v82, v64, v46
    v_mul_f32 v83, v65, v46
    v_exp_f32 v82, v82
    v_fract_f32 v83, v83
    v_cos_f32 v72, v83
    v_sin_f32 v73, v83
    v_mul_f32 v72, v72, v82
    v_mul_f32 v73, v73, v82
    v_mul_f32 v84, v67, v73
    v_mul_f32 v85, v67, v72
    v_fma_f32 v72, v66, v72, -v84
    v_fma_f32 v73, -v66, v73, -v85
    v_mfma_f32_16x16x4_f32 v[48:51], v68, v74, v[48:51]
    v_mfma_f32_16x16x4_f32 v[52:55], v70, v76, v[52:55]
    v_mfma_f32_16x16x4_f32 v[56:59], v70, v78, v[56:59]
    v_mfma_f32_16x16x4_f32 v[60:63], v72, v80, v[60:63]
    v_mfma_f32_16x16x4_f32 v[48:51], v69, v75, v[48:51]
    v_mfma_f32_16x16x4_f32 v[52:55], v71, v77, v[52:55]
    v_mfma_f32_16x16x4_f32 v[56:59], v71, v79, v[56:59]
    v_mfma_f32_16x16x4_f32 v[60:63], v73, v81, v[60:63]
    v_mov_b32_dpp v64, v28 row_newbcast:7 row_mask:0xf bank_mask:0xf
    v_mov_b32_dpp v65, v29 row_newbcast:7 row_mask:0xf bank_mask:0xf
    v_mov_b32_dpp v66, v30 row_newbcast:7 row_mask:0xf bank_mask:0xf
    v_mov_b32_dpp v67, v31 row_newbcast:7 row_mask:0xf bank_mask:0xf
    v_mul_f32 v82, v64, v47
    v_mul_f32 v83, v65, v47
    v_exp_f32 v82, v82
    v_fract_f32 v83, v83
    v_cos_f32 v74, v83
    v_sin_f32 v75, v83
    v_mul_f32 v74, v74, v82
    v_mul_f32 v75, v75, v82
    v_mul_f32 v84, v75, v75
    v_add_f32 v85, v74, v74
    v_fma_f32 v76, v74, v74, -v84
    v_mul_f32 v77, v85, v75
    v_mul_f32 v84, v77, v77
    v_add_f32 v85, v76, v76
    v_fma_f32 v78, v76, v76, -v84
    v_mul_f32 v79, v85, v77
    v_mul_f32 v84, v79, v79
    v_add_f32 v85, v78, v78
    v_fma_f32 v80, v78, v78, -v84
    v_mul_f32 v81, v85, v79
    v_mul_f32 v82, v64, v44
    v_mul_f32 v83, v65, v44
    v_exp_f32 v82, v82
    v_fract_f32 v83, v83
    v_cos_f32 v68, v83
    v_sin_f32 v69, v83
    v_mul_f32 v68, v68, v82
    v_mul_f32 v69, v69, v82
    v_mul_f32 v84, v67, v69
    v_mul_f32 v85, v67, v68
    v_fma_f32 v68, v66, v68, -v84
    v_fma_f32 v69, -v66, v69, -v85
    v_mul_f32 v82, v64, v45
    v_mul_f32 v83, v65, v45
    v_exp_f32 v82, v82
    v_fract_f32 v83, v83
    v_cos_f32 v70, v83
    v_sin_f32 v71, v83
    v_mul_f32 v70, v70, v82
    v_mul_f32 v71, v71, v82
    v_mul_f32 v84, v67, v71
    v_mul_f32 v85, v67, v70
    v_fma_f32 v70, v66, v70, -v84
    v_fma_f32 v71, -v66, v71, -v85
    v_mul_f32 v82, v64, v46
    v_mul_f32 v83, v65, v46
    v_exp_f32 v82, v82
    v_fract_f32 v83, v83
    v_cos_f32 v72, v83
    v_sin_f32 v73, v83
    v_mul_f32 v72, v72, v82
    v_mul_f32 v73, v73, v82
    v_mul_f32 v84, v67, v73
    v_mul_f32 v85, v67, v72
    v_fma_f32 v72, v66, v72, -v84
    v_fma_f32 v73, -v66, v73, -v85
    v_mfma_f32_16x16x4_f32 v[48:51], v68, v74, v[48:51]
    v_mfma_f32_16x16x4_f32 v[52:55], v70, v76, v[52:55]
    v_mfma_f32_16x16x4_f32 v[56:59], v70, v78, v[56:59]
    v_mfma_f32_16x16x4_f32 v[60:63], v72, v80, v[60:63]
    v_mfma_f32_16x16x4_f32 v[48:51], v69, v75, v[48:51]
    v_mfma_f32_16x16x4_f32 v[52:55], v71, v77, v[52:55]
    v_mfma_f32_16x16x4_f32 v[56:59], v71, v79, v[56:59]
    v_mfma_f32_16x16x4_f32 v[60:63], v73, v81, v[60:63]
    v_mov_b32_dpp v64, v28 row_newbcast:8 row_mask:0xf bank_mask:0xf
    v_mov_b32_dpp v65, v29 row_newbcast:8 row_mask:0xf bank_mask:0xf
    v_mov_b32_dpp v66, v30 row_newbcast:8 row_mask:0xf bank_mask:0xf
    v_mov_b32_dpp v67, v31 row_newbcast:8 row_mask:0xf bank_mask:0xf
    v_mul_f32 v82, v64, v47
    v_mul_f32 v83, v65, v47
    v_exp_f32 v82, v82
    v_fract_f32 v83, v83
    v_cos_f32 v74, v83
    v_sin_f32 v75, v83
    v_mul_f32 v74, v74, v82
    v_mul_f32 v75, v75, v82
    v_mul_f32 v84, v75, v75
    v_add_f32 v85, v74, v74
    v_fma_f32 v76, v74, v74, -v84
    v_mul_f32 v77, v85, v75
    v_mul_f32 v84, v77, v77
    v_add_f32 v85, v76, v76
    v_fma_f32 v78, v76, v76, -v84
    v_mul_f32 v79, v85, v77
    v_mul_f32 v84, v79, v79
    v_add_f32 v85, v78, v78
    v_fma_f32 v80, v78, v78, -v84
    v_mul_f32 v81, v85, v79
    v_mul_f32 v82, v64, v44
    v_mul_f32 v83, v65, v44
    v_exp_f32 v82, v82
    v_fract_f32 v83, v83
    v_cos_f32 v68, v83
    v_sin_f32 v69, v83
    v_mul_f32 v68, v68, v82
    v_mul_f32 v69, v69, v82
    v_mul_f32 v84, v67, v69
    v_mul_f32 v85, v67, v68
    v_fma_f32 v68, v66, v68, -v84
    v_fma_f32 v69, -v66, v69, -v85
    v_mul_f32 v82, v64, v45
    v_mul_f32 v83, v65, v45
    v_exp_f32 v82, v82
    v_fract_f32 v83, v83
    v_cos_f32 v70, v83
    v_sin_f32 v71, v83
    v_mul_f32 v70, v70, v82
    v_mul_f32 v71, v71, v82
    v_mul_f32 v84, v67, v71
    v_mul_f32 v85, v67, v70
    v_fma_f32 v70, v66, v70, -v84
    v_fma_f32 v71, -v66, v71, -v85
    v_mul_f32 v82, v64, v46
    v_mul_f32 v83, v65, v46
    v_exp_f32 v82, v82
    v_fract_f32 v83, v83
    v_cos_f32 v72, v83
    v_sin_f32 v73, v83
    v_mul_f32 v72, v72, v82
    v_mul_f32 v73, v73, v82
    v_mul_f32 v84, v67, v73
    v_mul_f32 v85, v67, v72
    v_fma_f32 v72, v66, v72, -v84
    v_fma_f32 v73, -v66, v73, -v85
    v_mfma_f32_16x16x4_f32 v[48:51], v68, v74, v[48:51]
    v_mfma_f32_16x16x4_f32 v[52:55], v70, v76, v[52:55]
    v_mfma_f32_16x16x4_f32 v[56:59], v70, v78, v[56:59]
    v_mfma_f32_16x16x4_f32 v[60:63], v72, v80, v[60:63]
    v_mfma_f32_16x16x4_f32 v[48:51], v69, v75, v[48:51]
    v_mfma_f32_16x16x4_f32 v[52:55], v71, v77, v[52:55]
    v_mfma_f32_16x16x4_f32 v[56:59], v71, v79, v[56:59]
    v_mfma_f32_16x16x4_f32 v[60:63], v73, v81, v[60:63]
    v_mov_b32_dpp v64, v28 row_newbcast:9 row_mask:0xf bank_mask:0xf
    v_mov_b32_dpp v65, v29 row_newbcast:9 row_mask:0xf bank_mask:0xf
    v_mov_b32_dpp v66, v30 row_newbcast:9 row_mask:0xf bank_mask:0xf
    v_mov_b32_dpp v67, v31 row_newbcast:9 row_mask:0xf bank_mask:0xf
    v_mul_f32 v82, v64, v47
    v_mul_f32 v83, v65, v47
    v_exp_f32 v82, v82
    v_fract_f32 v83, v83
    v_cos_f32 v74, v83
    v_sin_f32 v75, v83
    v_mul_f32 v74, v74, v82
    v_mul_f32 v75, v75, v82
    v_mul_f32 v84, v75, v75
    v_add_f32 v85, v74, v74
    v_fma_f32 v76, v74, v74, -v84
    v_mul_f32 v77, v85, v75
    v_mul_f32 v84, v77, v77
    v_add_f32 v85, v76, v76
    v_fma_f32 v78, v76, v76, -v84
    v_mul_f32 v79, v85, v77
    v_mul_f32 v84, v79, v79
    v_add_f32 v85, v78, v78
    v_fma_f32 v80, v78, v78, -v84
    v_mul_f32 v81, v85, v79
    v_mul_f32 v82, v64, v44
    v_mul_f32 v83, v65, v44
    v_exp_f32 v82, v82
    v_fract_f32 v83, v83
    v_cos_f32 v68, v83
    v_sin_f32 v69, v83
    v_mul_f32 v68, v68, v82
    v_mul_f32 v69, v69, v82
    v_mul_f32 v84, v67, v69
    v_mul_f32 v85, v67, v68
    v_fma_f32 v68, v66, v68, -v84
    v_fma_f32 v69, -v66, v69, -v85
    v_mul_f32 v82, v64, v45
    v_mul_f32 v83, v65, v45
    v_exp_f32 v82, v82
    v_fract_f32 v83, v83
    v_cos_f32 v70, v83
    v_sin_f32 v71, v83
    v_mul_f32 v70, v70, v82
    v_mul_f32 v71, v71, v82
    v_mul_f32 v84, v67, v71
    v_mul_f32 v85, v67, v70
    v_fma_f32 v70, v66, v70, -v84
    v_fma_f32 v71, -v66, v71, -v85
    v_mul_f32 v82, v64, v46
    v_mul_f32 v83, v65, v46
    v_exp_f32 v82, v82
    v_fract_f32 v83, v83
    v_cos_f32 v72, v83
    v_sin_f32 v73, v83
    v_mul_f32 v72, v72, v82
    v_mul_f32 v73, v73, v82
    v_mul_f32 v84, v67, v73
    v_mul_f32 v85, v67, v72
    v_fma_f32 v72, v66, v72, -v84
    v_fma_f32 v73, -v66, v73, -v85
    v_mfma_f32_16x16x4_f32 v[48:51], v68, v74, v[48:51]
    v_mfma_f32_16x16x4_f32 v[52:55], v70, v76, v[52:55]
    v_mfma_f32_16x16x4_f32 v[56:59], v70, v78, v[56:59]
    v_mfma_f32_16x16x4_f32 v[60:63], v72, v80, v[60:63]
    v_mfma_f32_16x16x4_f32 v[48:51], v69, v75, v[48:51]
    v_mfma_f32_16x16x4_f32 v[52:55], v71, v77, v[52:55]
    v_mfma_f32_16x16x4_f32 v[56:59], v71, v79, v[56:59]
    v_mfma_f32_16x16x4_f32 v[60:63], v73, v81, v[60:63]
    v_mov_b32_dpp v64, v28 row_newbcast:10 row_mask:0xf bank_mask:0xf
    v_mov_b32_dpp v65, v29 row_newbcast:10 row_mask:0xf bank_mask:0xf
    v_mov_b32_dpp v66, v30 row_newbcast:10 row_mask:0xf bank_mask:0xf
    v_mov_b32_dpp v67, v31 row_newbcast:10 row_mask:0xf bank_mask:0xf
    v_mul_f32 v82, v64, v47
    v_mul_f32 v83, v65, v47
    v_exp_f32 v82, v82
    v_fract_f32 v83, v83
    v_cos_f32 v74, v83
    v_sin_f32 v75, v83
    v_mul_f32 v74, v74, v82
    v_mul_f32 v75, v75, v82
    v_mul_f32 v84, v75, v75
    v_add_f32 v85, v74, v74
    v_fma_f32 v76, v74, v74, -v84
    v_mul_f32 v77, v85, v75
    v_mul_f32 v84, v77, v77
    v_add_f32 v85, v76, v76
    v_fma_f32 v78, v76, v76, -v84
    v_mul_f32 v79, v85, v77
    v_mul_f32 v84, v79, v79
    v_add_f32 v85, v78, v78
    v_fma_f32 v80, v78, v78, -v84
    v_mul_f32 v81, v85, v79
    v_mul_f32 v82, v64, v44
    v_mul_f32 v83, v65, v44
    v_exp_f32 v82, v82
    v_fract_f32 v83, v83
    v_cos_f32 v68, v83
    v_sin_f32 v69, v83
    v_mul_f32 v68, v68, v82
    v_mul_f32 v69, v69, v82
    v_mul_f32 v84, v67, v69
    v_mul_f32 v85, v67, v68
    v_fma_f32 v68, v66, v68, -v84
    v_fma_f32 v69, -v66, v69, -v85
    v_mul_f32 v82, v64, v45
    v_mul_f32 v83, v65, v45
    v_exp_f32 v82, v82
    v_fract_f32 v83, v83
    v_cos_f32 v70, v83
    v_sin_f32 v71, v83
    v_mul_f32 v70, v70, v82
    v_mul_f32 v71, v71, v82
    v_mul_f32 v84, v67, v71
    v_mul_f32 v85, v67, v70
    v_fma_f32 v70, v66, v70, -v84
    v_fma_f32 v71, -v66, v71, -v85
    v_mul_f32 v82, v64, v46
    v_mul_f32 v83, v65, v46
    v_exp_f32 v82, v82
    v_fract_f32 v83, v83
    v_cos_f32 v72, v83
    v_sin_f32 v73, v83
    v_mul_f32 v72, v72, v82
    v_mul_f32 v73, v73, v82
    v_mul_f32 v84, v67, v73
    v_mul_f32 v85, v67, v72
    v_fma_f32 v72, v66, v72, -v84
    v_fma_f32 v73, -v66, v73, -v85
    v_mfma_f32_16x16x4_f32 v[48:51], v68, v74, v[48:51]
    v_mfma_f32_16x16x4_f32 v[52:55], v70, v76, v[52:55]
    v_mfma_f32_16x16x4_f32 v[56:59], v70, v78, v[56:59]
    v_mfma_f32_16x16x4_f32 v[60:63], v72, v80, v[60:63]
    v_mfma_f32_16x16x4_f32 v[48:51], v69, v75, v[48:51]
    v_mfma_f32_16x16x4_f32 v[52:55], v71, v77, v[52:55]
    v_mfma_f32_16x16x4_f32 v[56:59], v71, v79, v[56:59]
    v_mfma_f32_16x16x4_f32 v[60:63], v73, v81, v[60:63]
    v_mov_b32_dpp v64, v28 row_newbcast:11 row_mask:0xf bank_mask:0xf
    v_mov_b32_dpp v65, v29 row_newbcast:11 row_mask:0xf bank_mask:0xf
    v_mov_b32_dpp v66, v30 row_newbcast:11 row_mask:0xf bank_mask:0xf
    v_mov_b32_dpp v67, v31 row_newbcast:11 row_mask:0xf bank_mask:0xf
    v_mul_f32 v82, v64, v47
    v_mul_f32 v83, v65, v47
    v_exp_f32 v82, v82
    v_fract_f32 v83, v83
    v_cos_f32 v74, v83
    v_sin_f32 v75, v83
    v_mul_f32 v74, v74, v82
    v_mul_f32 v75, v75, v82
    v_mul_f32 v84, v75, v75
    v_add_f32 v85, v74, v74
    v_fma_f32 v76, v74, v74, -v84
    v_mul_f32 v77, v85, v75
    v_mul_f32 v84, v77, v77
    v_add_f32 v85, v76, v76
    v_fma_f32 v78, v76, v76, -v84
    v_mul_f32 v79, v85, v77
    v_mul_f32 v84, v79, v79
    v_add_f32 v85, v78, v78
    v_fma_f32 v80, v78, v78, -v84
    v_mul_f32 v81, v85, v79
    v_mul_f32 v82, v64, v44
    v_mul_f32 v83, v65, v44
    v_exp_f32 v82, v82
    v_fract_f32 v83, v83
    v_cos_f32 v68, v83
    v_sin_f32 v69, v83
    v_mul_f32 v68, v68, v82
    v_mul_f32 v69, v69, v82
    v_mul_f32 v84, v67, v69
    v_mul_f32 v85, v67, v68
    v_fma_f32 v68, v66, v68, -v84
    v_fma_f32 v69, -v66, v69, -v85
    v_mul_f32 v82, v64, v45
    v_mul_f32 v83, v65, v45
    v_exp_f32 v82, v82
    v_fract_f32 v83, v83
    v_cos_f32 v70, v83
    v_sin_f32 v71, v83
    v_mul_f32 v70, v70, v82
    v_mul_f32 v71, v71, v82
    v_mul_f32 v84, v67, v71
    v_mul_f32 v85, v67, v70
    v_fma_f32 v70, v66, v70, -v84
    v_fma_f32 v71, -v66, v71, -v85
    v_mul_f32 v82, v64, v46
    v_mul_f32 v83, v65, v46
    v_exp_f32 v82, v82
    v_fract_f32 v83, v83
    v_cos_f32 v72, v83
    v_sin_f32 v73, v83
    v_mul_f32 v72, v72, v82
    v_mul_f32 v73, v73, v82
    v_mul_f32 v84, v67, v73
    v_mul_f32 v85, v67, v72
    v_fma_f32 v72, v66, v72, -v84
    v_fma_f32 v73, -v66, v73, -v85
    v_mfma_f32_16x16x4_f32 v[48:51], v68, v74, v[48:51]
    v_mfma_f32_16x16x4_f32 v[52:55], v70, v76, v[52:55]
    v_mfma_f32_16x16x4_f32 v[56:59], v70, v78, v[56:59]
    v_mfma_f32_16x16x4_f32 v[60:63], v72, v80, v[60:63]
    v_mfma_f32_16x16x4_f32 v[48:51], v69, v75, v[48:51]
    v_mfma_f32_16x16x4_f32 v[52:55], v71, v77, v[52:55]
    v_mfma_f32_16x16x4_f32 v[56:59], v71, v79, v[56:59]
    v_mfma_f32_16x16x4_f32 v[60:63], v73, v81, v[60:63]
    v_mov_b32_dpp v64, v28 row_newbcast:12 row_mask:0xf bank_mask:0xf
    v_mov_b32_dpp v65, v29 row_newbcast:12 row_mask:0xf bank_mask:0xf
    v_mov_b32_dpp v66, v30 row_newbcast:12 row_mask:0xf bank_mask:0xf
    v_mov_b32_dpp v67, v31 row_newbcast:12 row_mask:0xf bank_mask:0xf
    v_mul_f32 v82, v64, v47
    v_mul_f32 v83, v65, v47
    v_exp_f32 v82, v82
    v_fract_f32 v83, v83
    v_cos_f32 v74, v83
    v_sin_f32 v75, v83
    v_mul_f32 v74, v74, v82
    v_mul_f32 v75, v75, v82
    v_mul_f32 v84, v75, v75
    v_add_f32 v85, v74, v74
    v_fma_f32 v76, v74, v74, -v84
    v_mul_f32 v77, v85, v75
    v_mul_f32 v84, v77, v77
    v_add_f32 v85, v76, v76
    v_fma_f32 v78, v76, v76, -v84
    v_mul_f32 v79, v85, v77
    v_mul_f32 v84, v79, v79
    v_add_f32 v85, v78, v78
    v_fma_f32 v80, v78, v78, -v84
    v_mul_f32 v81, v85, v79
    v_mul_f32 v82, v64, v44
    v_mul_f32 v83, v65, v44
    v_exp_f32 v82, v82
    v_fract_f32 v83, v83
    v_cos_f32 v68, v83
    v_sin_f32 v69, v83
    v_mul_f32 v68, v68, v82
    v_mul_f32 v69, v69, v82
    v_mul_f32 v84, v67, v69
    v_mul_f32 v85, v67, v68
    v_fma_f32 v68, v66, v68, -v84
    v_fma_f32 v69, -v66, v69, -v85
    v_mul_f32 v82, v64, v45
    v_mul_f32 v83, v65, v45
    v_exp_f32 v82, v82
    v_fract_f32 v83, v83
    v_cos_f32 v70, v83
    v_sin_f32 v71, v83
    v_mul_f32 v70, v70, v82
    v_mul_f32 v71, v71, v82
    v_mul_f32 v84, v67, v71
    v_mul_f32 v85, v67, v70
    v_fma_f32 v70, v66, v70, -v84
    v_fma_f32 v71, -v66, v71, -v85
    v_mul_f32 v82, v64, v46
    v_mul_f32 v83, v65, v46
    v_exp_f32 v82, v82
    v_fract_f32 v83, v83
    v_cos_f32 v72, v83
    v_sin_f32 v73, v83
    v_mul_f32 v72, v72, v82
    v_mul_f32 v73, v73, v82
    v_mul_f32 v84, v67, v73
    v_mul_f32 v85, v67, v72
    v_fma_f32 v72, v66, v72, -v84
    v_fma_f32 v73, -v66, v73, -v85
    v_mfma_f32_16x16x4_f32 v[48:51], v68, v74, v[48:51]
    v_mfma_f32_16x16x4_f32 v[52:55], v70, v76, v[52:55]
    v_mfma_f32_16x16x4_f32 v[56:59], v70, v78, v[56:59]
    v_mfma_f32_16x16x4_f32 v[60:63], v72, v80, v[60:63]
    v_mfma_f32_16x16x4_f32 v[48:51], v69, v75, v[48:51]
    v_mfma_f32_16x16x4_f32 v[52:55], v71, v77, v[52:55]
    v_mfma_f32_16x16x4_f32 v[56:59], v71, v79, v[56:59]
    v_mfma_f32_16x16x4_f32 v[60:63], v73, v81, v[60:63]
    v_mov_b32_dpp v64, v28 row_newbcast:13 row_mask:0xf bank_mask:0xf
    v_mov_b32_dpp v65, v29 row_newbcast:13 row_mask:0xf bank_mask:0xf
    v_mov_b32_dpp v66, v30 row_newbcast:13 row_mask:0xf bank_mask:0xf
    v_mov_b32_dpp v67, v31 row_newbcast:13 row_mask:0xf bank_mask:0xf
    v_mul_f32 v82, v64, v47
    v_mul_f32 v83, v65, v47
    v_exp_f32 v82, v82
    v_fract_f32 v83, v83
    v_cos_f32 v74, v83
    v_sin_f32 v75, v83
    v_mul_f32 v74, v74, v82
    v_mul_f32 v75, v75, v82
    v_mul_f32 v84, v75, v75
    v_add_f32 v85, v74, v74
    v_fma_f32 v76, v74, v74, -v84
    v_mul_f32 v77, v85, v75
    v_mul_f32 v84, v77, v77
    v_add_f32 v85, v76, v76
    v_fma_f32 v78, v76, v76, -v84
    v_mul_f32 v79, v85, v77
    v_mul_f32 v84, v79, v79
    v_add_f32 v85, v78, v78
    v_fma_f32 v80, v78, v78, -v84
    v_mul_f32 v81, v85, v79
    v_mul_f32 v82, v64, v44
    v_mul_f32 v83, v65, v44
    v_exp_f32 v82, v82
    v_fract_f32 v83, v83
    v_cos_f32 v68, v83
    v_sin_f32 v69, v83
    v_mul_f32 v68, v68, v82
    v_mul_f32 v69, v69, v82
    v_mul_f32 v84, v67, v69
    v_mul_f32 v85, v67, v68
    v_fma_f32 v68, v66, v68, -v84
    v_fma_f32 v69, -v66, v69, -v85
    v_mul_f32 v82, v64, v45
    v_mul_f32 v83, v65, v45
    v_exp_f32 v82, v82
    v_fract_f32 v83, v83
    v_cos_f32 v70, v83
    v_sin_f32 v71, v83
    v_mul_f32 v70, v70, v82
    v_mul_f32 v71, v71, v82
    v_mul_f32 v84, v67, v71
    v_mul_f32 v85, v67, v70
    v_fma_f32 v70, v66, v70, -v84
    v_fma_f32 v71, -v66, v71, -v85
    v_mul_f32 v82, v64, v46
    v_mul_f32 v83, v65, v46
    v_exp_f32 v82, v82
    v_fract_f32 v83, v83
    v_cos_f32 v72, v83
    v_sin_f32 v73, v83
    v_mul_f32 v72, v72, v82
    v_mul_f32 v73, v73, v82
    v_mul_f32 v84, v67, v73
    v_mul_f32 v85, v67, v72
    v_fma_f32 v72, v66, v72, -v84
    v_fma_f32 v73, -v66, v73, -v85
    v_mfma_f32_16x16x4_f32 v[48:51], v68, v74, v[48:51]
    v_mfma_f32_16x16x4_f32 v[52:55], v70, v76, v[52:55]
    v_mfma_f32_16x16x4_f32 v[56:59], v70, v78, v[56:59]
    v_mfma_f32_16x16x4_f32 v[60:63], v72, v80, v[60:63]
    v_mfma_f32_16x16x4_f32 v[48:51], v69, v75, v[48:51]
    v_mfma_f32_16x16x4_f32 v[52:55], v71, v77, v[52:55]
    v_mfma_f32_16x16x4_f32 v[56:59], v71, v79, v[56:59]
    v_mfma_f32_16x16x4_f32 v[60:63], v73, v81, v[60:63]
    v_mov_b32_dpp v64, v28 row_newbcast:14 row_mask:0xf bank_mask:0xf
    v_mov_b32_dpp v65, v29 row_newbcast:14 row_mask:0xf bank_mask:0xf
    v_mov_b32_dpp v66, v30 row_newbcast:14 row_mask:0xf bank_mask:0xf
    v_mov_b32_dpp v67, v31 row_newbcast:14 row_mask:0xf bank_mask:0xf
    v_mul_f32 v82, v64, v47
    v_mul_f32 v83, v65, v47
    v_exp_f32 v82, v82
    v_fract_f32 v83, v83
    v_cos_f32 v74, v83
    v_sin_f32 v75, v83
    v_mul_f32 v74, v74, v82
    v_mul_f32 v75, v75, v82
    v_mul_f32 v84, v75, v75
    v_add_f32 v85, v74, v74
    v_fma_f32 v76, v74, v74, -v84
    v_mul_f32 v77, v85, v75
    v_mul_f32 v84, v77, v77
    v_add_f32 v85, v76, v76
    v_fma_f32 v78, v76, v76, -v84
    v_mul_f32 v79, v85, v77
    v_mul_f32 v84, v79, v79
    v_add_f32 v85, v78, v78
    v_fma_f32 v80, v78, v78, -v84
    v_mul_f32 v81, v85, v79
    v_mul_f32 v82, v64, v44
    v_mul_f32 v83, v65, v44
    v_exp_f32 v82, v82
    v_fract_f32 v83, v83
    v_cos_f32 v68, v83
    v_sin_f32 v69, v83
    v_mul_f32 v68, v68, v82
    v_mul_f32 v69, v69, v82
    v_mul_f32 v84, v67, v69
    v_mul_f32 v85, v67, v68
    v_fma_f32 v68, v66, v68, -v84
    v_fma_f32 v69, -v66, v69, -v85
    v_mul_f32 v82, v64, v45
    v_mul_f32 v83, v65, v45
    v_exp_f32 v82, v82
    v_fract_f32 v83, v83
    v_cos_f32 v70, v83
    v_sin_f32 v71, v83
    v_mul_f32 v70, v70, v82
    v_mul_f32 v71, v71, v82
    v_mul_f32 v84, v67, v71
    v_mul_f32 v85, v67, v70
    v_fma_f32 v70, v66, v70, -v84
    v_fma_f32 v71, -v66, v71, -v85
    v_mul_f32 v82, v64, v46
    v_mul_f32 v83, v65, v46
    v_exp_f32 v82, v82
    v_fract_f32 v83, v83
    v_cos_f32 v72, v83
    v_sin_f32 v73, v83
    v_mul_f32 v72, v72, v82
    v_mul_f32 v73, v73, v82
    v_mul_f32 v84, v67, v73
    v_mul_f32 v85, v67, v72
    v_fma_f32 v72, v66, v72, -v84
    v_fma_f32 v73, -v66, v73, -v85
    v_mfma_f32_16x16x4_f32 v[48:51], v68, v74, v[48:51]
    v_mfma_f32_16x16x4_f32 v[52:55], v70, v76, v[52:55]
    v_mfma_f32_16x16x4_f32 v[56:59], v70, v78, v[56:59]
    v_mfma_f32_16x16x4_f32 v[60:63], v72, v80, v[60:63]
    v_mfma_f32_16x16x4_f32 v[48:51], v69, v75, v[48:51]
    v_mfma_f32_16x16x4_f32 v[52:55], v71, v77, v[52:55]
    v_mfma_f32_16x16x4_f32 v[56:59], v71, v79, v[56:59]
    v_mfma_f32_16x16x4_f32 v[60:63], v73, v81, v[60:63]
    v_mov_b32_dpp v64, v28 row_newbcast:15 row_mask:0xf bank_mask:0xf
    v_mov_b32_dpp v65, v29 row_newbcast:15 row_mask:0xf bank_mask:0xf
    v_mov_b32_dpp v66, v30 row_newbcast:15 row_mask:0xf bank_mask:0xf
    v_mov_b32_dpp v67, v31 row_newbcast:15 row_mask:0xf bank_mask:0xf
    v_mul_f32 v82, v64, v47
    v_mul_f32 v83, v65, v47
    v_exp_f32 v82, v82
    v_fract_f32 v83, v83
    v_cos_f32 v74, v83
    v_sin_f32 v75, v83
    v_mul_f32 v74, v74, v82
    v_mul_f32 v75, v75, v82
    v_mul_f32 v84, v75, v75
    v_add_f32 v85, v74, v74
    v_fma_f32 v76, v74, v74, -v84
    v_mul_f32 v77, v85, v75
    v_mul_f32 v84, v77, v77
    v_add_f32 v85, v76, v76
    v_fma_f32 v78, v76, v76, -v84
    v_mul_f32 v79, v85, v77
    v_mul_f32 v84, v79, v79
    v_add_f32 v85, v78, v78
    v_fma_f32 v80, v78, v78, -v84
    v_mul_f32 v81, v85, v79
    v_mul_f32 v82, v64, v44
    v_mul_f32 v83, v65, v44
    v_exp_f32 v82, v82
    v_fract_f32 v83, v83
    v_cos_f32 v68, v83
    v_sin_f32 v69, v83
    v_mul_f32 v68, v68, v82
    v_mul_f32 v69, v69, v82
    v_mul_f32 v84, v67, v69
    v_mul_f32 v85, v67, v68
    v_fma_f32 v68, v66, v68, -v84
    v_fma_f32 v69, -v66, v69, -v85
    v_mul_f32 v82, v64, v45
    v_mul_f32 v83, v65, v45
    v_exp_f32 v82, v82
    v_fract_f32 v83, v83
    v_cos_f32 v70, v83
    v_sin_f32 v71, v83
    v_mul_f32 v70, v70, v82
    v_mul_f32 v71, v71, v82
    v_mul_f32 v84, v67, v71
    v_mul_f32 v85, v67, v70
    v_fma_f32 v70, v66, v70, -v84
    v_fma_f32 v71, -v66, v71, -v85
    v_mul_f32 v82, v64, v46
    v_mul_f32 v83, v65, v46
    v_exp_f32 v82, v82
    v_fract_f32 v83, v83
    v_cos_f32 v72, v83
    v_sin_f32 v73, v83
    v_mul_f32 v72, v72, v82
    v_mul_f32 v73, v73, v82
    v_mul_f32 v84, v67, v73
    v_mul_f32 v85, v67, v72
    v_fma_f32 v72, v66, v72, -v84
    v_fma_f32 v73, -v66, v73, -v85
    v_mfma_f32_16x16x4_f32 v[48:51], v68, v74, v[48:51]
    v_mfma_f32_16x16x4_f32 v[52:55], v70, v76, v[52:55]
    v_mfma_f32_16x16x4_f32 v[56:59], v70, v78, v[56:59]
    v_mfma_f32_16x16x4_f32 v[60:63], v72, v80, v[60:63]
    v_mfma_f32_16x16x4_f32 v[48:51], v69, v75, v[48:51]
    v_mfma_f32_16x16x4_f32 v[52:55], v71, v77, v[52:55]
    v_mfma_f32_16x16x4_f32 v[56:59], v71, v79, v[56:59]
    v_mfma_f32_16x16x4_f32 v[60:63], v73, v81, v[60:63]
    v_lshlrev_b32 v5, 8, v3
    v_lshl_add_u32 v5, v2, 2, v5
    v_add_u32 v5, v5, v4
    s_nop 5
    ds_write_b32 v5, v48 offset:4608
    ds_write_b32 v5, v49 offset:4672
    ds_write_b32 v5, v50 offset:4736
    ds_write_b32 v5, v51 offset:4800
    v_cmp_gt_u32 vcc, 2, v3
    s_nop 0
    s_mov_b64 exec, vcc
    ds_write_b32 v5, v52 offset:5632
    ds_write_b32 v5, v53 offset:5696
    ds_write_b32 v5, v54 offset:5760
    ds_write_b32 v5, v55 offset:5824
    ds_write_b32 v5, v60 offset:6656
    ds_write_b32 v5, v61 offset:6720
    ds_write_b32 v5, v62 offset:6784
    ds_write_b32 v5, v63 offset:6848
    s_not_b64 exec, exec
    ds_write_b32 v5, v56 offset:5632
    ds_write_b32 v5, v57 offset:5696
    ds_write_b32 v5, v58 offset:5760
    ds_write_b32 v5, v59 offset:5824
    s_mov_b32 exec_lo, 0
    s_mov_b32 exec_hi, 3
    v_cmp_eq_u32 vcc, 0, v2
    s_nop 1
    v_cndmask_b32 v6, 0, v60, vcc
    ds_write_b32 v5, v6 offset:6656
    s_mov_b64 exec, -1
    s_waitcnt lgkmcnt(0)
    v_lshlrev_b32 v7, 1, v1
    v_sub_u32 v7, 2065, v7
    v_lshl_add_u32 v64, v1, 2, v4
    v_mov_b32 v65, 641
    s_mov_b32 s25, 17
ss_exp:
    v_subrev_u32 v66, 0, v7
    v_cvt_f32_u32 v70, v66
    v_cvt_pk_bf16_f32 v70, v70, v70
    v_and_b32 v70, 0xffff, v70
    v_subrev_u32 v70, 0x4280, v70
    v_cmp_gt_u32 vcc, 256, v66
    s_nop 1
    v_cndmask_b32 v70, v70, v66, vcc
    v_cmp_gt_u32 vcc, 2048, v66
    s_nop 1
    v_cndmask_b32 v70, v65, v70, vcc
    v_lshl_add_u32 v70, v70, 2, v4
    ds_read_b32 v74, v70 offset:4608
    v_subrev_u32 v67, 1, v7
    v_cvt_f32_u32 v71, v67
    v_cvt_pk_bf16_f32 v71, v71, v71
    v_and_b32 v71, 0xffff, v71
    v_subrev_u32 v71, 0x4280, v71
    v_cmp_gt_u32 vcc, 256, v67
    s_nop 1
    v_cndmask_b32 v71, v71, v67, vcc
    v_cmp_gt_u32 vcc, 2048, v67
    s_nop 1
    v_cndmask_b32 v71, v65, v71, vcc
    v_lshl_add_u32 v71, v71, 2, v4
    ds_read_b32 v75, v71 offset:4608
    v_subrev_u32 v68, 2, v7
    v_cvt_f32_u32 v72, v68
    v_cvt_pk_bf16_f32 v72, v72, v72
    v_and_b32 v72, 0xffff, v72
    v_subrev_u32 v72, 0x4280, v72
    v_cmp_gt_u32 vcc, 256, v68
    s_nop 1
    v_cndmask_b32 v72, v72, v68, vcc
    v_cmp_gt_u32 vcc, 2048, v68
    s_nop 1
    v_cndmask_b32 v72, v65, v72, vcc
    v_lshl_add_u32 v72, v72, 2, v4
    ds_read_b32 v76, v72 offset:4608
    s_waitcnt lgkmcnt(0)
    v_cvt_pk_bf16_f32 v78, v75, v76
    v_cvt_pk_bf16_f32 v79, v74, v75
    ds_write_b32 v64, v78 offset:7424
    ds_write_b32 v64, v79 offset:11776
    v_subrev_u32 v7, 128, v7
    v_add_u32 v64, 256, v64
    s_sub_u32 s25, s25, 1
    s_cmp_lg_u32 s25, 0
    s_cbranch_scc1 ss_exp
    s_waitcnt lgkmcnt(0)
    s_barrier
    v_and_b32 v5, 1, v2
    v_mul_u32_u24 v64, 4352, v5
    v_sub_u32 v5, v5, v2
    v_lshl_add_u32 v5, v3, 3, v5
    v_lshl_add_u32 v64, v5, 1, v64
    v_add_u32 v64, 11520, v64
    v_add_u32 v64, v64, v4
    v_lshlrev_b32 v65, 5, v2
    v_lshl_add_u32 v65, v3, 4, v65
    v_add_u32 v65, 480, v65
    v_add_u32 v65, v65, v4
    v_mov_b32 v96, 0
    v_mov_b32 v97, 0
    v_mov_b32 v98, 0
    v_mov_b32 v99, 0
    v_mov_b32 v100, 0
    v_mov_b32 v101, 0
    v_mov_b32 v102, 0
    v_mov_b32 v103, 0
    v_mov_b32 v104, 0
    v_mov_b32 v105, 0
    v_mov_b32 v106, 0
    v_mov_b32 v107, 0
    v_mov_b32 v108, 0
    v_mov_b32 v109, 0
    v_mov_b32 v110, 0
    v_mov_b32 v111, 0
    v_mov_b32 v112, 0
    v_mov_b32 v113, 0
    v_mov_b32 v114, 0
    v_mov_b32 v115, 0
    v_mov_b32 v116, 0
    v_mov_b32 v117, 0
    v_mov_b32 v118, 0
    v_mov_b32 v119, 0
    v_mov_b32 v120, 0
    v_mov_b32 v121, 0
    v_mov_b32 v122, 0
    v_mov_b32 v123, 0
    v_mov_b32 v124, 0
    v_mov_b32 v125, 0
    v_mov_b32 v126, 0
    v_mov_b32 v127, 0
    s_mov_b32 s25, 8
ss_cv0:
    ds_read2_b32 v[68:69], v64 offset0:0 offset1:1
    ds_read2_b32 v[70:71], v64 offset0:2 offset1:3
    ds_read_b128 v[128:131], v65 offset:0
    ds_read_b128 v[132:135], v65 offset:512
    ds_read_b128 v[136:139], v65 offset:1024
    ds_read_b128 v[140:143], v65 offset:1536
    ds_read_b128 v[144:147], v65 offset:2048
    ds_read_b128 v[148:151], v65 offset:2560
    ds_read_b128 v[152:155], v65 offset:3072
    ds_read_b128 v[156:159], v65 offset:3584
    v_subrev_u32 v64, 64, v64
    v_subrev_u32 v65, 64, v65
    s_waitcnt lgkmcnt(7)
    v_mfma_f32_16x16x32_bf16 v[96:99], v[68:71], v[128:131], v[96:99]
    s_waitcnt lgkmcnt(6)
    v_mfma_f32_16x16x32_bf16 v[100:103], v[68:71], v[132:135], v[100:103]
    s_waitcnt lgkmcnt(5)
    v_mfma_f32_16x16x32_bf16 v[104:107], v[68:71], v[136:139], v[104:107]
    s_waitcnt lgkmcnt(4)
    v_mfma_f32_16x16x32_bf16 v[108:111], v[68:71], v[140:143], v[108:111]
    s_waitcnt lgkmcnt(3)
    v_mfma_f32_16x16x32_bf16 v[112:115], v[68:71], v[144:147], v[112:115]
    s_waitcnt lgkmcnt(2)
    v_mfma_f32_16x16x32_bf16 v[116:119], v[68:71], v[148:151], v[116:119]
    s_waitcnt lgkmcnt(1)
    v_mfma_f32_16x16x32_bf16 v[120:123], v[68:71], v[152:155], v[120:123]
    s_waitcnt lgkmcnt(0)
    v_mfma_f32_16x16x32_bf16 v[124:127], v[68:71], v[156:159], v[124:127]
    s_sub_u32 s25, s25, 1
    s_cmp_lg_u32 s25, 0
    s_cbranch_scc1 ss_cv0
    v_add_u32 v65, 512, v65
    s_mov_b32 s25, 8
ss_cv1:
    ds_read2_b32 v[68:69], v64 offset0:0 offset1:1
    ds_read2_b32 v[70:71], v64 offset0:2 offset1:3
    ds_read_b128 v[132:135], v65 offset:0
    ds_read_b128 v[136:139], v65 offset:512
    ds_read_b128 v[140:143], v65 offset:1024
    ds_read_b128 v[144:147], v65 offset:1536
    ds_read_b128 v[148:151], v65 offset:2048
    ds_read_b128 v[152:155], v65 offset:2560
    ds_read_b128 v[156:159], v65 offset:3072
    v_subrev_u32 v64, 64, v64
    v_subrev_u32 v65, 64, v65
    s_waitcnt lgkmcnt(6)
    v_mfma_f32_16x16x32_bf16 v[100:103], v[68:71], v[132:135], v[100:103]
    s_waitcnt lgkmcnt(5)
    v_mfma_f32_16x16x32_bf16 v[104:107], v[68:71], v[136:139], v[104:107]
    s_waitcnt lgkmcnt(4)
    v_mfma_f32_16x16x32_bf16 v[108:111], v[68:71], v[140:143], v[108:111]
    s_waitcnt lgkmcnt(3)
    v_mfma_f32_16x16x32_bf16 v[112:115], v[68:71], v[144:147], v[112:115]
    s_waitcnt lgkmcnt(2)
    v_mfma_f32_16x16x32_bf16 v[116:119], v[68:71], v[148:151], v[116:119]
    s_waitcnt lgkmcnt(1)
    v_mfma_f32_16x16x32_bf16 v[120:123], v[68:71], v[152:155], v[120:123]
    s_waitcnt lgkmcnt(0)
    v_mfma_f32_16x16x32_bf16 v[124:127], v[68:71], v[156:159], v[124:127]
    s_sub_u32 s25, s25, 1
    s_cmp_lg_u32 s25, 0
    s_cbranch_scc1 ss_cv1
    v_add_u32 v65, 512, v65
    s_mov_b32 s25, 8
ss_cv2:
    ds_read2_b32 v[68:69], v64 offset0:0 offset1:1
    ds_read2_b32 v[70:71], v64 offset0:2 offset1:3
    ds_read_b128 v[136:139], v65 offset:0
    ds_read_b128 v[140:143], v65 offset:512
    ds_read_b128 v[144:147], v65 offset:1024
    ds_read_b128 v[148:151], v65 offset:1536
    ds_read_b128 v[152:155], v65 offset:2048
    ds_read_b128 v[156:159], v65 offset:2560
    v_subrev_u32 v64, 64, v64
    v_subrev_u32 v65, 64, v65
    s_waitcnt lgkmcnt(5)
    v_mfma_f32_16x16x32_bf16 v[104:107], v[68:71], v[136:139], v[104:107]
    s_waitcnt lgkmcnt(4)
    v_mfma_f32_16x16x32_bf16 v[108:111], v[68:71], v[140:143], v[108:111]
    s_waitcnt lgkmcnt(3)
    v_mfma_f32_16x16x32_bf16 v[112:115], v[68:71], v[144:147], v[112:115]
    s_waitcnt lgkmcnt(2)
    v_mfma_f32_16x16x32_bf16 v[116:119], v[68:71], v[148:151], v[116:119]
    s_waitcnt lgkmcnt(1)
    v_mfma_f32_16x16x32_bf16 v[120:123], v[68:71], v[152:155], v[120:123]
    s_waitcnt lgkmcnt(0)
    v_mfma_f32_16x16x32_bf16 v[124:127], v[68:71], v[156:159], v[124:127]
    s_sub_u32 s25, s25, 1
    s_cmp_lg_u32 s25, 0
    s_cbranch_scc1 ss_cv2
    v_add_u32 v65, 512, v65
    s_mov_b32 s25, 8
ss_cv3:
    ds_read2_b32 v[68:69], v64 offset0:0 offset1:1
    ds_read2_b32 v[70:71], v64 offset0:2 offset1:3
    ds_read_b128 v[140:143], v65 offset:0
    ds_read_b128 v[144:147], v65 offset:512
    ds_read_b128 v[148:151], v65 offset:1024
    ds_read_b128 v[152:155], v65 offset:1536
    ds_read_b128 v[156:159], v65 offset:2048
    v_subrev_u32 v64, 64, v64
    v_subrev_u32 v65, 64, v65
    s_waitcnt lgkmcnt(4)
    v_mfma_f32_16x16x32_bf16 v[108:111], v[68:71], v[140:143], v[108:111]
    s_waitcnt lgkmcnt(3)
    v_mfma_f32_16x16x32_bf16 v[112:115], v[68:71], v[144:147], v[112:115]
    s_waitcnt lgkmcnt(2)
    v_mfma_f32_16x16x32_bf16 v[116:119], v[68:71], v[148:151], v[116:119]
    s_waitcnt lgkmcnt(1)
    v_mfma_f32_16x16x32_bf16 v[120:123], v[68:71], v[152:155], v[120:123]
    s_waitcnt lgkmcnt(0)
    v_mfma_f32_16x16x32_bf16 v[124:127], v[68:71], v[156:159], v[124:127]
    s_sub_u32 s25, s25, 1
    s_cmp_lg_u32 s25, 0
    s_cbranch_scc1 ss_cv3
    v_add_u32 v65, 512, v65
    s_mov_b32 s25, 8
ss_cv4:
    ds_read2_b32 v[68:69], v64 offset0:0 offset1:1
    ds_read2_b32 v[70:71], v64 offset0:2 offset1:3
    ds_read_b128 v[144:147], v65 offset:0
    ds_read_b128 v[148:151], v65 offset:512
    ds_read_b128 v[152:155], v65 offset:1024
    ds_read_b128 v[156:159], v65 offset:1536
    v_subrev_u32 v64, 64, v64
    v_subrev_u32 v65, 64, v65
    s_waitcnt lgkmcnt(3)
    v_mfma_f32_16x16x32_bf16 v[112:115], v[68:71], v[144:147], v[112:115]
    s_waitcnt lgkmcnt(2)
    v_mfma_f32_16x16x32_bf16 v[116:119], v[68:71], v[148:151], v[116:119]
    s_waitcnt lgkmcnt(1)
    v_mfma_f32_16x16x32_bf16 v[120:123], v[68:71], v[152:155], v[120:123]
    s_waitcnt lgkmcnt(0)
    v_mfma_f32_16x16x32_bf16 v[124:127], v[68:71], v[156:159], v[124:127]
    s_sub_u32 s25, s25, 1
    s_cmp_lg_u32 s25, 0
    s_cbranch_scc1 ss_cv4
    v_add_u32 v65, 512, v65
    s_mov_b32 s25, 8
ss_cv5:
    ds_read2_b32 v[68:69], v64 offset0:0 offset1:1
    ds_read2_b32 v[70:71], v64 offset0:2 offset1:3
    ds_read_b128 v[148:151], v65 offset:0
    ds_read_b128 v[152:155], v65 offset:512
    ds_read_b128 v[156:159], v65 offset:1024
    v_subrev_u32 v64, 64, v64
    v_subrev_u32 v65, 64, v65
    s_waitcnt lgkmcnt(2)
    v_mfma_f32_16x16x32_bf16 v[116:119], v[68:71], v[148:151], v[116:119]
    s_waitcnt lgkmcnt(1)
    v_mfma_f32_16x16x32_bf16 v[120:123], v[68:71], v[152:155], v[120:123]
    s_waitcnt lgkmcnt(0)
    v_mfma_f32_16x16x32_bf16 v[124:127], v[68:71], v[156:159], v[124:127]
    s_sub_u32 s25, s25, 1
    s_cmp_lg_u32 s25, 0
    s_cbranch_scc1 ss_cv5
    v_add_u32 v65, 512, v65
    s_mov_b32 s25, 8
ss_cv6:
    ds_read2_b32 v[68:69], v64 offset0:0 offset1:1
    ds_read2_b32 v[70:71], v64 offset0:2 offset1:3
    ds_read_b128 v[152:155], v65 offset:0
    ds_read_b128 v[156:159], v65 offset:512
    v_subrev_u32 v64, 64, v64
    v_subrev_u32 v65, 64, v65
    s_waitcnt lgkmcnt(1)
    v_mfma_f32_16x16x32_bf16 v[120:123], v[68:71], v[152:155], v[120:123]
    s_waitcnt lgkmcnt(0)
    v_mfma_f32_16x16x32_bf16 v[124:127], v[68:71], v[156:159], v[124:127]
    s_sub_u32 s25, s25, 1
    s_cmp_lg_u32 s25, 0
    s_cbranch_scc1 ss_cv6
    v_add_u32 v65, 512, v65
    s_mov_b32 s25, 8
ss_cv7:
    ds_read2_b32 v[68:69], v64 offset0:0 offset1:1
    ds_read2_b32 v[70:71], v64 offset0:2 offset1:3
    ds_read_b128 v[156:159], v65 offset:0
    v_subrev_u32 v64, 64, v64
    v_subrev_u32 v65, 64, v65
    s_waitcnt lgkmcnt(0)
    v_mfma_f32_16x16x32_bf16 v[124:127], v[68:71], v[156:159], v[124:127]
    s_sub_u32 s25, s25, 1
    s_cmp_lg_u32 s25, 0
    s_cbranch_scc1 ss_cv7
    v_add_u32 v65, 512, v65
    s_nop 3
    v_lshlrev_b32 v5, 6, v2
    v_lshl_add_u32 v5, v3, 4, v5
    v_add_u32 v5, v5, v4
    ds_write_b128 v5, v[96:99] offset:7424
    ds_write_b128 v5, v[100:103] offset:8448
    ds_write_b128 v5, v[104:107] offset:9472
    ds_write_b128 v5, v[108:111] offset:10496
    ds_write_b128 v5, v[112:115] offset:11520
    ds_write_b128 v5, v[116:119] offset:12544
    ds_write_b128 v5, v[120:123] offset:13568
    ds_write_b128 v5, v[124:127] offset:14592
    s_mov_b32 s12, s74
    s_mov_b32 s13, s75
    s_mov_b32 s14, 1152
    s_mov_b32 s15, 0x20000
    s_lshl_b32 s23, s20, 1
    buffer_load_dwordx2 v[24:25], off, s[12:15], s23
    s_waitcnt vmcnt(0) lgkmcnt(0)
    s_barrier
    v_lshlrev_b32 v26, 16, v24
    v_and_b32 v27, 0xffff0000, v24
    v_lshlrev_b32 v28, 16, v25
    v_and_b32 v29, 0xffff0000, v25
    v_lshlrev_b32 v5, 5, v0
    ds_read_b128 v[64:67], v5 offset:7424
    ds_read_b128 v[68:71], v5 offset:7440
    ds_read_b128 v[72:75], v5 offset:23808
    ds_read_b128 v[76:79], v5 offset:23824
    ds_read_b128 v[80:83], v5 offset:40192
    ds_read_b128 v[84:87], v5 offset:40208
    ds_read_b128 v[88:91], v5 offset:56576
    ds_read_b128 v[92:95], v5 offset:56592
    s_waitcnt lgkmcnt(0)
    v_mul_u32_u24 v5, 18432, v0
    s_lshl_b32 s22, s20, 1
    s_add_u32 s22, s22, 1152
    v_lshlrev_b32 v6, 16, v8
    v_fmac_f32 v64, v6, v26
    v_and_b32 v6, 0xffff0000, v8
    v_fmac_f32 v72, v6, v27
    v_lshlrev_b32 v6, 16, v9
    v_fmac_f32 v80, v6, v28
    v_and_b32 v6, 0xffff0000, v9
    v_fmac_f32 v88, v6, v29
    v_cvt_pk_bf16_f32 v8, v64, v72
    v_cvt_pk_bf16_f32 v9, v80, v88
    s_add_u32 s23, s22, 0
    buffer_store_dwordx2 v[8:9], v5, s[16:19], s23 offen
    v_lshlrev_b32 v6, 16, v10
    v_fmac_f32 v65, v6, v26
    v_and_b32 v6, 0xffff0000, v10
    v_fmac_f32 v73, v6, v27
    v_lshlrev_b32 v6, 16, v11
    v_fmac_f32 v81, v6, v28
    v_and_b32 v6, 0xffff0000, v11
    v_fmac_f32 v89, v6, v29
    v_cvt_pk_bf16_f32 v10, v65, v73
    v_cvt_pk_bf16_f32 v11, v81, v89
    s_add_u32 s23, s22, 2304
    buffer_store_dwordx2 v[10:11], v5, s[16:19], s23 offen
    v_lshlrev_b32 v6, 16, v12
    v_fmac_f32 v66, v6, v26
    v_and_b32 v6, 0xffff0000, v12
    v_fmac_f32 v74, v6, v27
    v_lshlrev_b32 v6, 16, v13
    v_fmac_f32 v82, v6, v28
    v_and_b32 v6, 0xffff0000, v13
    v_fmac_f32 v90, v6, v29
    v_cvt_pk_bf16_f32 v12, v66, v74
    v_cvt_pk_bf16_f32 v13, v82, v90
    s_add_u32 s23, s22, 4608
    buffer_store_dwordx2 v[12:13], v5, s[16:19], s23 offen
    v_lshlrev_b32 v6, 16, v14
    v_fmac_f32 v67, v6, v26
    v_and_b32 v6, 0xffff0000, v14
    v_fmac_f32 v75, v6, v27
    v_lshlrev_b32 v6, 16, v15
    v_fmac_f32 v83, v6, v28
    v_and_b32 v6, 0xffff0000, v15
    v_fmac_f32 v91, v6, v29
    v_cvt_pk_bf16_f32 v14, v67, v75
    v_cvt_pk_bf16_f32 v15, v83, v91
    s_add_u32 s23, s22, 6912
    buffer_store_dwordx2 v[14:15], v5, s[16:19], s23 offen
    v_lshlrev_b32 v6, 16, v16
    v_fmac_f32 v68, v6, v26
    v_and_b32 v6, 0xffff0000, v16
    v_fmac_f32 v76, v6, v27
    v_lshlrev_b32 v6, 16, v17
    v_fmac_f32 v84, v6, v28
    v_and_b32 v6, 0xffff0000, v17
    v_fmac_f32 v92, v6, v29
    v_cvt_pk_bf16_f32 v16, v68, v76
    v_cvt_pk_bf16_f32 v17, v84, v92
    s_add_u32 s23, s22, 9216
    buffer_store_dwordx2 v[16:17], v5, s[16:19], s23 offen
    v_lshlrev_b32 v6, 16, v18
    v_fmac_f32 v69, v6, v26
    v_and_b32 v6, 0xffff0000, v18
    v_fmac_f32 v77, v6, v27
    v_lshlrev_b32 v6, 16, v19
    v_fmac_f32 v85, v6, v28
    v_and_b32 v6, 0xffff0000, v19
    v_fmac_f32 v93, v6, v29
    v_cvt_pk_bf16_f32 v18, v69, v77
    v_cvt_pk_bf16_f32 v19, v85, v93
    s_add_u32 s23, s22, 11520
    buffer_store_dwordx2 v[18:19], v5, s[16:19], s23 offen
    v_lshlrev_b32 v6, 16, v20
    v_fmac_f32 v70, v6, v26
    v_and_b32 v6, 0xffff0000, v20
    v_fmac_f32 v78, v6, v27
    v_lshlrev_b32 v6, 16, v21
    v_fmac_f32 v86, v6, v28
    v_and_b32 v6, 0xffff0000, v21
    v_fmac_f32 v94, v6, v29
    v_cvt_pk_bf16_f32 v20, v70, v78
    v_cvt_pk_bf16_f32 v21, v86, v94
    s_add_u32 s23, s22, 13824
    buffer_store_dwordx2 v[20:21], v5, s[16:19], s23 offen
    v_lshlrev_b32 v6, 16, v22
    v_fmac_f32 v71, v6, v26
    v_and_b32 v6, 0xffff0000, v22
    v_fmac_f32 v79, v6, v27
    v_lshlrev_b32 v6, 16, v23
    v_fmac_f32 v87, v6, v28
    v_and_b32 v6, 0xffff0000, v23
    v_fmac_f32 v95, v6, v29
    v_cvt_pk_bf16_f32 v22, v71, v79
    v_cvt_pk_bf16_f32 v23, v87, v95
    s_add_u32 s23, s22, 16128
    buffer_store_dwordx2 v[22:23], v5, s[16:19], s23 offen
    s_branch L_ssm_next
L_wf_next:
    s_mov_b32 s37, 20
    v_mov_b32 v250, 1
    v_mov_b32 v251, 163832
    v_cmp_eq_u32 vcc, 0, v0
    s_nop 0
    s_and_saveexec_b64 s[38:39], vcc
    s_cbranch_execz tk7
    buffer_atomic_add v250, off, s[84:87], s37 sc0
    s_waitcnt vmcnt(0)
    ds_write_b32 v251, v250
    s_waitcnt lgkmcnt(0)
tk7:
    s_mov_b64 exec, -1
    s_barrier
    ds_read_b32 v252, v251
    s_waitcnt lgkmcnt(0)
    v_readfirstlane_b32 s33, v252
    s_barrier
    s_nop 3
    s_cmp_ge_u32 s33, 160
    s_cbranch_scc1 L_phase2
    s_lshl_b32 s16, s33, 2
    s_add_u32 s16, s16, s32
    s_add_u32 s16, s16, 1504
    s_call_b64 s[46:47], L_xform
    s_lshl_b32 s40, s33, 2
    s_add_u32 s40, s40, 125841408
    s_waitcnt vmcnt(0)
    s_barrier
    v_mov_b32 v250, s95
    v_cmp_eq_u32 vcc, 0, v0
    s_nop 0
    s_and_saveexec_b64 s[38:39], vcc
    s_cbranch_execz fs8
    buffer_store_dword v250, off, s[4:7], s40 sc1
fs8:
    s_mov_b64 exec, -1
    s_branch L_wf_next
L_phase2:
    s_mov_b32 s40, 524288
mc2_w:
    buffer_load_dword v250, off, s[84:87], 0 offset:28 sc1
    s_waitcnt vmcnt(0)
    v_readfirstlane_b32 s41, v250
    s_nop 0
    s_cmp_lg_u32 s41, 0
    s_cbranch_scc1 mc2_known
    s_sub_u32 s40, s40, 1
    s_cbranch_scc1 mc2_force
    s_sleep 2
    s_branch mc2_w
mc2_force:
    v_mov_b32 v250, 2
    v_mov_b32 v251, 0
    s_mov_b64 exec, 1
    buffer_atomic_cmpswap v[250:251], off, s[84:87], 0 offset:28
    s_mov_b64 exec, -1
    s_waitcnt vmcnt(0)
    s_mov_b32 s40, 524288
    s_branch mc2_w
mc2_known:
    s_cmp_eq_u32 s41, 1
    s_cbranch_scc1 L_phase2b
    s_mov_b32 s37, 208
    v_mov_b32 v250, 1
    v_mov_b32 v251, 163832
    v_cmp_eq_u32 vcc, 0, v0
    s_nop 0
    s_and_saveexec_b64 s[38:39], vcc
    s_cbranch_execz tk9
    buffer_atomic_add v250, off, s[84:87], s37 sc0
    s_waitcnt vmcnt(0)
    ds_write_b32 v251, v250
    s_waitcnt lgkmcnt(0)
tk9:
    s_mov_b64 exec, -1
    s_barrier
    ds_read_b32 v252, v251
    s_waitcnt lgkmcnt(0)
    v_readfirstlane_b32 s12, v252
    s_barrier
    s_nop 3
    s_cmp_lt_u32 s12, 32
    s_cbranch_scc1 L_chain_safe
L_phase2b:
    s_mov_b32 s8, s76
    s_mov_b32 s9, s77
    s_mov_b32 s10, 4718592
    s_mov_b32 s11, 0x20000
    s_mov_b32 s37, 12
    v_mov_b32 v250, 1
    v_mov_b32 v251, 163832
    v_cmp_eq_u32 vcc, 0, v0
    s_nop 0
    s_and_saveexec_b64 s[38:39], vcc
    s_cbranch_execz tk10
    buffer_atomic_add v250, off, s[84:87], s37 sc0
    s_waitcnt vmcnt(0)
    ds_write_b32 v251, v250
    s_waitcnt lgkmcnt(0)
tk10:
    s_mov_b64 exec, -1
    s_barrier
    ds_read_b32 v252, v251
    s_waitcnt lgkmcnt(0)
    v_readfirstlane_b32 s36, v252
    s_barrier
    s_nop 3
    s_mul_hi_u32 s37, s36, 0x55555556
    s_mul_i32 s40, s37, 3
    s_sub_u32 s33, s36, s37
    s_mul_hi_u32 s41, s33, 0x0e38e38f
    s_mul_i32 s41, s41, 18
    s_sub_u32 s33, s33, s41
    s_cmp_lg_u32 s40, s36
    s_cbranch_scc1 L_op_start
L_att_next:
    s_mov_b32 s37, 16
    v_mov_b32 v250, 1
    v_mov_b32 v251, 163832
    v_cmp_eq_u32 vcc, 0, v0
    s_nop 0
    s_and_saveexec_b64 s[38:39], vcc
    s_cbranch_execz tk11
    buffer_atomic_add v250, off, s[84:87], s37 sc0
    s_waitcnt vmcnt(0)
    ds_write_b32 v251, v250
    s_waitcnt lgkmcnt(0)
tk11:
    s_mov_b64 exec, -1
    s_barrier
    ds_read_b32 v252, v251
    s_waitcnt lgkmcnt(0)
    v_readfirstlane_b32 s34, v252
    s_barrier
    s_nop 3
    s_cmp_ge_u32 s34, 512
    s_cbranch_scc1 L_op_nextcb
    s_lshr_b32 s16, s34, 3
    s_and_b32 s17, s34, 7
    s_lshl_b32 s17, s17, 2
    s_add_u32 s17, s17, s32
    s_lshl_b32 s36, s17, 7
    s_add_u32 s36, s36, 125829120
    s_lshr_b32 s41, s16, 2
    s_add_u32 s41, s41, s95
    s_add_u32 s41, s41, 1
    v_and_b32 v1, 3, v0
    v_min_u32 v1, 2, v1
    v_lshlrev_b32 v2, 4, v1
    s_and_b32 s37, s16, 3
    s_lshl_b32 s37, s37, 2
    v_add_u32 v2, s37, v2
    s_mov_b32 s40, 4194304
L_aw1:
    buffer_load_dword v3, v2, s[4:7], s36 offen sc1
    s_sub_u32 s40, s40, 1
    s_cbranch_scc1 L_aw1_go
    s_waitcnt vmcnt(0)
    v_subrev_u32 v3, s41, v3
    v_cmp_lt_u32 vcc, 64, v3
    s_cbranch_vccz L_aw1_go
    s_sleep 4
    s_branch L_aw1
L_aw1_go:
    v_and_b32 v5, 63, v0
    v_lshlrev_b32 v1, 4, v5
    s_cmp_ge_u32 s16, 58
    s_cselect_b32 s18, -1, 511
    v_and_b32 v2, s18, v1
    v_or_b32 v3, 128, v1
    v_lshrrev_b32 v4, 4, v5
    v_bfe_u32 v6, v5, 2, 2
    v_sub_u32 v4, v6, v4
    v_lshlrev_b32 v4, 3, v4
    v_and_b32 v6, 3, v5
    v_add_u32 v4, v4, v6
    v_mov_b32 v6, 0xf149f2ca
    s_mov_b32 s22, 0x3e0293ee
    s_lshl_b32 s18, s16, 5
    s_add_u32 s18, s18, s17
    s_lshl_b32 s19, s18, 13
    s_add_u32 s20, s19, 33554432
    buffer_load_dwordx4 v[8:11], v1, s[4:7], s20 offen offset:0 sc1
    s_add_u32 s20, s19, 33554432
    buffer_load_dwordx4 v[12:15], v1, s[4:7], s20 offen offset:1024 sc1
    s_add_u32 s20, s19, 33554432
    buffer_load_dwordx4 v[16:19], v1, s[4:7], s20 offen offset:2048 sc1
    s_add_u32 s20, s19, 33554432
    buffer_load_dwordx4 v[20:23], v1, s[4:7], s20 offen offset:3072 sc1
    s_add_u32 s20, s19, 33558528
    buffer_load_dwordx4 v[24:27], v1, s[4:7], s20 offen offset:0 sc1
    s_add_u32 s20, s19, 33558528
    buffer_load_dwordx4 v[28:31], v1, s[4:7], s20 offen offset:1024 sc1
    s_add_u32 s20, s19, 33558528
    buffer_load_dwordx4 v[32:35], v1, s[4:7], s20 offen offset:2048 sc1
    s_add_u32 s20, s19, 33558528
    buffer_load_dwordx4 v[36:39], v1, s[4:7], s20 offen offset:3072 sc1
    s_lshl_b32 s21, s18, 14
    s_add_u32 s20, s21, 0
    buffer_load_dwordx4 v[40:43], v1, s[4:7], s20 offen offset:0 sc1
    s_add_u32 s20, s21, 4096
    buffer_load_dwordx4 v[44:47], v1, s[4:7], s20 offen offset:0 sc1
    s_add_u32 s20, s21, 8192
    buffer_load_dwordx4 v[48:51], v1, s[4:7], s20 offen offset:0 sc1
    s_add_u32 s20, s21, 12288
    buffer_load_dwordx4 v[52:55], v1, s[4:7], s20 offen offset:0 sc1
    s_add_u32 s20, s21, 0
    buffer_load_dwordx4 v[56:59], v1, s[4:7], s20 offen offset:1024 sc1
    s_add_u32 s20, s21, 4096
    buffer_load_dwordx4 v[60:63], v1, s[4:7], s20 offen offset:1024 sc1
    s_add_u32 s20, s21, 8192
    buffer_load_dwordx4 v[64:67], v1, s[4:7], s20 offen offset:1024 sc1
    s_add_u32 s20, s21, 12288
    buffer_load_dwordx4 v[68:71], v1, s[4:7], s20 offen offset:1024 sc1
    s_add_u32 s20, s21, 0
    buffer_load_dwordx4 v[88:91], v1, s[4:7], s20 offen offset:2048 sc1
    s_add_u32 s20, s21, 4096
    buffer_load_dwordx4 v[92:95], v1, s[4:7], s20 offen offset:2048 sc1
    s_add_u32 s20, s21, 8192
    buffer_load_dwordx4 v[96:99], v1, s[4:7], s20 offen offset:2048 sc1
    s_add_u32 s20, s21, 12288
    buffer_load_dwordx4 v[100:103], v1, s[4:7], s20 offen offset:2048 sc1
    s_add_u32 s20, s21, 0
    buffer_load_dwordx4 v[104:107], v1, s[4:7], s20 offen offset:3072 sc1
    s_add_u32 s20, s21, 4096
    buffer_load_dwordx4 v[108:111], v1, s[4:7], s20 offen offset:3072 sc1
    s_add_u32 s20, s21, 8192
    buffer_load_dwordx4 v[112:115], v1, s[4:7], s20 offen offset:3072 sc1
    s_add_u32 s20, s21, 12288
    buffer_load_dwordx4 v[116:119], v1, s[4:7], s20 offen offset:3072 sc1
    v_mov_b32 v172, 0x3f803f80
    v_mov_b32 v173, 0x3f803f80
    v_mov_b32 v174, 0x3f803f80
    v_mov_b32 v175, 0x3f803f80
    v_mov_b32 v176, 0x3f003f00
    v_mov_b32 v177, 0x3f003f00
    s_waitcnt vmcnt(8)
    v_mfma_f32_16x16x32_bf16 v[136:139], v[40:43], v[8:11], 0
    v_mfma_f32_16x16x32_bf16 v[140:143], v[56:59], v[8:11], 0
    v_mfma_f32_16x16x32_bf16 v[148:151], v[40:43], v[24:27], 0
    v_mfma_f32_16x16x32_bf16 v[152:155], v[56:59], v[24:27], 0
    v_mfma_f32_16x16x32_bf16 v[136:139], v[44:47], v[12:15], v[136:139]
    v_mfma_f32_16x16x32_bf16 v[140:143], v[60:63], v[12:15], v[140:143]
    v_mfma_f32_16x16x32_bf16 v[148:151], v[44:47], v[28:31], v[148:151]
    v_mfma_f32_16x16x32_bf16 v[152:155], v[60:63], v[28:31], v[152:155]
    v_mfma_f32_16x16x32_bf16 v[136:139], v[48:51], v[16:19], v[136:139]
    v_mfma_f32_16x16x32_bf16 v[140:143], v[64:67], v[16:19], v[140:143]
    v_mfma_f32_16x16x32_bf16 v[148:151], v[48:51], v[32:35], v[148:151]
    v_mfma_f32_16x16x32_bf16 v[152:155], v[64:67], v[32:35], v[152:155]
    v_mfma_f32_16x16x32_bf16 v[136:139], v[52:55], v[20:23], v[136:139]
    v_mfma_f32_16x16x32_bf16 v[140:143], v[68:71], v[20:23], v[140:143]
    v_mfma_f32_16x16x32_bf16 v[148:151], v[52:55], v[36:39], v[148:151]
    v_mfma_f32_16x16x32_bf16 v[152:155], v[68:71], v[36:39], v[152:155]
    v_cmp_le_i32 vcc, 0, v4
    s_nop 3
    v_cndmask_b32 v136, v6, v136, vcc
    v_cmp_le_i32 vcc, 1, v4
    s_nop 1
    v_cndmask_b32 v137, v6, v137, vcc
    v_cmp_le_i32 vcc, 2, v4
    s_nop 1
    v_cndmask_b32 v138, v6, v138, vcc
    v_cmp_le_i32 vcc, 3, v4
    s_nop 1
    v_cndmask_b32 v139, v6, v139, vcc
    v_cmp_le_i32 vcc, 4, v4
    s_nop 1
    v_cndmask_b32 v140, v6, v140, vcc
    v_cmp_le_i32 vcc, 5, v4
    s_nop 1
    v_cndmask_b32 v141, v6, v141, vcc
    v_cmp_le_i32 vcc, 6, v4
    s_nop 1
    v_cndmask_b32 v142, v6, v142, vcc
    v_cmp_le_i32 vcc, 7, v4
    s_nop 1
    v_cndmask_b32 v143, v6, v143, vcc
    v_cmp_le_i32 vcc, -4, v4
    s_nop 1
    v_cndmask_b32 v148, v6, v148, vcc
    v_cmp_le_i32 vcc, -3, v4
    s_nop 1
    v_cndmask_b32 v149, v6, v149, vcc
    v_cmp_le_i32 vcc, -2, v4
    s_nop 1
    v_cndmask_b32 v150, v6, v150, vcc
    v_cmp_le_i32 vcc, -1, v4
    s_nop 1
    v_cndmask_b32 v151, v6, v151, vcc
    v_cmp_le_i32 vcc, 0, v4
    s_nop 1
    v_cndmask_b32 v152, v6, v152, vcc
    v_cmp_le_i32 vcc, 1, v4
    s_nop 1
    v_cndmask_b32 v153, v6, v153, vcc
    v_cmp_le_i32 vcc, 2, v4
    s_nop 1
    v_cndmask_b32 v154, v6, v154, vcc
    v_cmp_le_i32 vcc, 3, v4
    s_nop 1
    v_cndmask_b32 v155, v6, v155, vcc
    s_nop 1
    v_and_b32 v198, 1, v0
    v_lshlrev_b32 v198, 2, v198
    v_add_u32 v198, 48, v198
    s_add_u32 s41, s16, s95
    s_add_u32 s41, s41, 1
    s_cmp_lt_u32 s16, 58
    s_cbranch_scc1 L_amk
    v_mov_b32 v198, 16384
L_amk:
    s_nop 1
    s_mov_b32 s88, 65536
    s_mov_b32 s89, 125853696
cw12:
    buffer_load_dword v199, off, s[4:7], s89 sc1
    s_waitcnt vmcnt(0)
    v_readfirstlane_b32 s42, v199
    s_nop 0
    s_sub_u32 s42, s42, s95
    s_cmp_gt_u32 s42, 64
    s_cselect_b32 s42, 0, s42
    s_add_u32 s42, s42, 1
    s_cmp_ge_u32 s42, s16
    s_cbranch_scc1 cw12x
    s_sub_u32 s88, s88, 1
    s_cbranch_scc1 cw12x
    s_sub_u32 s42, s16, s42
    s_min_u32 s42, s42, 6
cw12s:
    s_sleep 24
    s_sub_u32 s42, s42, 1
    s_cmp_lg_u32 s42, 0
    s_cbranch_scc1 cw12s
    s_branch cw12
cw12x:
    s_mov_b32 s40, 4194304
L_aw2:
    buffer_load_dword v199, v198, s[4:7], s36 offen sc1
    s_sub_u32 s40, s40, 1
    s_cbranch_scc1 L_aw2_go
    s_waitcnt vmcnt(0)
    v_subrev_u32 v199, s41, v199
    v_cmp_lt_u32 vcc, 64, v199
    s_cbranch_vccz L_aw2_go
    s_sleep 1
    s_branch L_aw2
L_aw2_go:
    s_lshl_b32 s20, s18, 12
    s_add_u32 s20, s20, 69206016
    buffer_load_dwordx4 v[72:75], v3, s[4:7], s20 offen offset:0 sc1
    buffer_load_dwordx4 v[76:79], v3, s[4:7], s20 offen offset:1024 sc1
    buffer_load_dwordx4 v[80:83], v3, s[4:7], s20 offen offset:2048 sc1
    buffer_load_dwordx4 v[84:87], v3, s[4:7], s20 offen offset:3072 sc1
    s_lshl_b32 s20, s18, 12
    s_add_u32 s20, s20, 77594624
    buffer_load_dwordx4 v[120:123], v2, s[4:7], s20 offen offset:0 sc1
    buffer_load_dwordx4 v[124:127], v2, s[4:7], s20 offen offset:1024 sc1
    buffer_load_dwordx4 v[128:131], v2, s[4:7], s20 offen offset:2048 sc1
    buffer_load_dwordx4 v[132:135], v2, s[4:7], s20 offen offset:3072 sc1
    s_waitcnt vmcnt(4)
    v_mfma_f32_16x16x32_bf16 v[144:147], v[72:75], v[8:11], 0
    v_mfma_f32_16x16x32_bf16 v[156:159], v[72:75], v[24:27], 0
    v_mfma_f32_16x16x32_bf16 v[144:147], v[76:79], v[12:15], v[144:147]
    v_mfma_f32_16x16x32_bf16 v[156:159], v[76:79], v[28:31], v[156:159]
    v_mfma_f32_16x16x32_bf16 v[144:147], v[80:83], v[16:19], v[144:147]
    v_mfma_f32_16x16x32_bf16 v[156:159], v[80:83], v[32:35], v[156:159]
    v_mfma_f32_16x16x32_bf16 v[144:147], v[84:87], v[20:23], v[144:147]
    v_mfma_f32_16x16x32_bf16 v[156:159], v[84:87], v[36:39], v[156:159]
    v_max3_f32 v196, v136, v137, v138
    v_max3_f32 v197, v139, v140, v141
    v_max3_f32 v196, v196, v142, v143
    s_nop 3
    v_max3_f32 v197, v197, v144, v145
    v_max3_f32 v196, v196, v146, v147
    v_max_f32 v196, v196, v197
    v_mov_b32 v197, v196
    s_nop 1
    v_permlane32_swap_b32 v196, v197
    v_max_f32 v196, v196, v197
    v_mov_b32 v197, v196
    s_nop 1
    v_permlane16_swap_b32 v196, v197
    v_max_f32 v196, v196, v197
    v_mul_f32 v196, s22, v196
    v_sub_f32 v196, 0, v196
    v_fma_f32 v136, v136, s22, v196
    v_fma_f32 v137, v137, s22, v196
    v_fma_f32 v138, v138, s22, v196
    v_fma_f32 v139, v139, s22, v196
    v_fma_f32 v140, v140, s22, v196
    v_fma_f32 v141, v141, s22, v196
    v_fma_f32 v142, v142, s22, v196
    v_fma_f32 v143, v143, s22, v196
    v_fma_f32 v144, v144, s22, v196
    v_fma_f32 v145, v145, s22, v196
    v_fma_f32 v146, v146, s22, v196
    v_fma_f32 v147, v147, s22, v196
    v_exp_f32 v136, v136
    v_exp_f32 v137, v137
    v_exp_f32 v138, v138
    v_exp_f32 v139, v139
    v_exp_f32 v140, v140
    v_exp_f32 v141, v141
    v_exp_f32 v142, v142
    v_exp_f32 v143, v143
    v_exp_f32 v144, v144
    v_exp_f32 v145, v145
    v_exp_f32 v146, v146
    v_exp_f32 v147, v147
    v_cvt_pk_bf16_f32 v160, v136, v137
    v_cvt_pk_bf16_f32 v161, v138, v139
    v_cvt_pk_bf16_f32 v162, v140, v141
    v_cvt_pk_bf16_f32 v163, v142, v143
    v_cvt_pk_bf16_f32 v164, v144, v145
    v_cvt_pk_bf16_f32 v165, v146, v147
    v_max3_f32 v196, v148, v149, v150
    v_max3_f32 v197, v151, v152, v153
    v_max3_f32 v196, v196, v154, v155
    v_max3_f32 v197, v197, v156, v157
    v_max3_f32 v196, v196, v158, v159
    v_max_f32 v196, v196, v197
    v_mov_b32 v197, v196
    s_nop 1
    v_permlane32_swap_b32 v196, v197
    v_max_f32 v196, v196, v197
    v_mov_b32 v197, v196
    s_nop 1
    v_permlane16_swap_b32 v196, v197
    v_max_f32 v196, v196, v197
    v_mul_f32 v196, s22, v196
    v_sub_f32 v196, 0, v196
    v_fma_f32 v148, v148, s22, v196
    v_fma_f32 v149, v149, s22, v196
    v_fma_f32 v150, v150, s22, v196
    v_fma_f32 v151, v151, s22, v196
    v_fma_f32 v152, v152, s22, v196
    v_fma_f32 v153, v153, s22, v196
    v_fma_f32 v154, v154, s22, v196
    v_fma_f32 v155, v155, s22, v196
    v_fma_f32 v156, v156, s22, v196
    v_fma_f32 v157, v157, s22, v196
    v_fma_f32 v158, v158, s22, v196
    v_fma_f32 v159, v159, s22, v196
    v_exp_f32 v148, v148
    v_exp_f32 v149, v149
    v_exp_f32 v150, v150
    v_exp_f32 v151, v151
    v_exp_f32 v152, v152
    v_exp_f32 v153, v153
    v_exp_f32 v154, v154
    v_exp_f32 v155, v155
    v_exp_f32 v156, v156
    v_exp_f32 v157, v157
    v_exp_f32 v158, v158
    v_exp_f32 v159, v159
    v_cvt_pk_bf16_f32 v166, v148, v149
    v_cvt_pk_bf16_f32 v167, v150, v151
    v_cvt_pk_bf16_f32 v168, v152, v153
    v_cvt_pk_bf16_f32 v169, v154, v155
    v_cvt_pk_bf16_f32 v170, v156, v157
    v_cvt_pk_bf16_f32 v171, v158, v159
    v_mfma_f32_16x16x32_bf16 v[180:183], v[172:175], v[160:163], 0
    v_mfma_f32_16x16x32_bf16 v[184:187], v[172:175], v[166:169], 0
    s_nop 4
    v_mfma_f32_16x16x16_bf16 v[180:183], v[176:177], v[164:165], v[180:183]
    v_mfma_f32_16x16x16_bf16 v[184:187], v[176:177], v[170:171], v[184:187]
    s_nop 6
    v_rcp_f32 v180, v180
    v_rcp_f32 v184, v184
    s_waitcnt vmcnt(0)
    s_lshl_b32 s18, s16, 18
    s_lshl_b32 s19, s17, 12
    s_add_u32 s18, s18, s19
    s_add_u32 s18, s18, 50331648
    s_add_u32 s19, s18, 131072
    v_mfma_f32_16x16x32_bf16 v[8:11], v[88:91], v[160:163], 0
    v_mfma_f32_16x16x32_bf16 v[12:15], v[104:107], v[160:163], 0
    v_mfma_f32_16x16x32_bf16 v[16:19], v[88:91], v[166:169], 0
    v_mfma_f32_16x16x32_bf16 v[20:23], v[104:107], v[166:169], 0
    v_mfma_f32_16x16x32_bf16 v[24:27], v[92:95], v[160:163], 0
    v_mfma_f32_16x16x32_bf16 v[28:31], v[108:111], v[160:163], 0
    v_mfma_f32_16x16x32_bf16 v[32:35], v[92:95], v[166:169], 0
    v_mfma_f32_16x16x32_bf16 v[36:39], v[108:111], v[166:169], 0
    v_mfma_f32_16x16x32_bf16 v[40:43], v[96:99], v[160:163], 0
    v_mfma_f32_16x16x32_bf16 v[44:47], v[112:115], v[160:163], 0
    v_mfma_f32_16x16x32_bf16 v[48:51], v[96:99], v[166:169], 0
    v_mfma_f32_16x16x32_bf16 v[52:55], v[112:115], v[166:169], 0
    v_mfma_f32_16x16x32_bf16 v[56:59], v[100:103], v[160:163], 0
    v_mfma_f32_16x16x32_bf16 v[60:63], v[116:119], v[160:163], 0
    v_mfma_f32_16x16x32_bf16 v[64:67], v[100:103], v[166:169], 0
    v_mfma_f32_16x16x32_bf16 v[68:71], v[116:119], v[166:169], 0
    v_mfma_f32_16x16x16_bf16 v[8:11], v[120:121], v[164:165], v[8:11]
    v_mfma_f32_16x16x16_bf16 v[12:15], v[122:123], v[164:165], v[12:15]
    v_mfma_f32_16x16x16_bf16 v[16:19], v[120:121], v[170:171], v[16:19]
    v_mfma_f32_16x16x16_bf16 v[20:23], v[122:123], v[170:171], v[20:23]
    v_mfma_f32_16x16x16_bf16 v[24:27], v[124:125], v[164:165], v[24:27]
    v_mfma_f32_16x16x16_bf16 v[28:31], v[126:127], v[164:165], v[28:31]
    v_mfma_f32_16x16x16_bf16 v[32:35], v[124:125], v[170:171], v[32:35]
    v_mfma_f32_16x16x16_bf16 v[36:39], v[126:127], v[170:171], v[36:39]
    v_mfma_f32_16x16x16_bf16 v[40:43], v[128:129], v[164:165], v[40:43]
    v_mfma_f32_16x16x16_bf16 v[44:47], v[130:131], v[164:165], v[44:47]
    v_mfma_f32_16x16x16_bf16 v[48:51], v[128:129], v[170:171], v[48:51]
    v_mfma_f32_16x16x16_bf16 v[52:55], v[130:131], v[170:171], v[52:55]
    v_mfma_f32_16x16x16_bf16 v[56:59], v[132:133], v[164:165], v[56:59]
    v_mfma_f32_16x16x16_bf16 v[60:63], v[134:135], v[164:165], v[60:63]
    v_mfma_f32_16x16x16_bf16 v[64:67], v[132:133], v[170:171], v[64:67]
    v_mfma_f32_16x16x16_bf16 v[68:71], v[134:135], v[170:171], v[68:71]
    v_mul_f32 v8, v8, v180
    v_mul_f32 v12, v12, v180
    v_mul_f32 v9, v9, v180
    v_mul_f32 v13, v13, v180
    v_mul_f32 v10, v10, v180
    v_mul_f32 v14, v14, v180
    v_mul_f32 v11, v11, v180
    v_mul_f32 v15, v15, v180
    v_cvt_pk_bf16_f32 v8, v8, v9
    v_cvt_pk_bf16_f32 v9, v10, v11
    v_cvt_pk_bf16_f32 v10, v12, v13
    v_cvt_pk_bf16_f32 v11, v14, v15
    buffer_store_dwordx4 v[8:11], v1, s[4:7], s18 offen offset:0 sc1
    v_mul_f32 v16, v16, v184
    v_mul_f32 v20, v20, v184
    v_mul_f32 v17, v17, v184
    v_mul_f32 v21, v21, v184
    v_mul_f32 v18, v18, v184
    v_mul_f32 v22, v22, v184
    v_mul_f32 v19, v19, v184
    v_mul_f32 v23, v23, v184
    v_cvt_pk_bf16_f32 v16, v16, v17
    v_cvt_pk_bf16_f32 v17, v18, v19
    v_cvt_pk_bf16_f32 v18, v20, v21
    v_cvt_pk_bf16_f32 v19, v22, v23
    buffer_store_dwordx4 v[16:19], v1, s[4:7], s19 offen offset:0 sc1
    v_mul_f32 v24, v24, v180
    v_mul_f32 v28, v28, v180
    v_mul_f32 v25, v25, v180
    v_mul_f32 v29, v29, v180
    v_mul_f32 v26, v26, v180
    v_mul_f32 v30, v30, v180
    v_mul_f32 v27, v27, v180
    v_mul_f32 v31, v31, v180
    v_cvt_pk_bf16_f32 v24, v24, v25
    v_cvt_pk_bf16_f32 v25, v26, v27
    v_cvt_pk_bf16_f32 v26, v28, v29
    v_cvt_pk_bf16_f32 v27, v30, v31
    buffer_store_dwordx4 v[24:27], v1, s[4:7], s18 offen offset:1024 sc1
    v_mul_f32 v32, v32, v184
    v_mul_f32 v36, v36, v184
    v_mul_f32 v33, v33, v184
    v_mul_f32 v37, v37, v184
    v_mul_f32 v34, v34, v184
    v_mul_f32 v38, v38, v184
    v_mul_f32 v35, v35, v184
    v_mul_f32 v39, v39, v184
    v_cvt_pk_bf16_f32 v32, v32, v33
    v_cvt_pk_bf16_f32 v33, v34, v35
    v_cvt_pk_bf16_f32 v34, v36, v37
    v_cvt_pk_bf16_f32 v35, v38, v39
    buffer_store_dwordx4 v[32:35], v1, s[4:7], s19 offen offset:1024 sc1
    v_mul_f32 v40, v40, v180
    v_mul_f32 v44, v44, v180
    v_mul_f32 v41, v41, v180
    v_mul_f32 v45, v45, v180
    v_mul_f32 v42, v42, v180
    v_mul_f32 v46, v46, v180
    v_mul_f32 v43, v43, v180
    v_mul_f32 v47, v47, v180
    v_cvt_pk_bf16_f32 v40, v40, v41
    v_cvt_pk_bf16_f32 v41, v42, v43
    v_cvt_pk_bf16_f32 v42, v44, v45
    v_cvt_pk_bf16_f32 v43, v46, v47
    buffer_store_dwordx4 v[40:43], v1, s[4:7], s18 offen offset:2048 sc1
    v_mul_f32 v48, v48, v184
    v_mul_f32 v52, v52, v184
    v_mul_f32 v49, v49, v184
    v_mul_f32 v53, v53, v184
    v_mul_f32 v50, v50, v184
    v_mul_f32 v54, v54, v184
    v_mul_f32 v51, v51, v184
    v_mul_f32 v55, v55, v184
    v_cvt_pk_bf16_f32 v48, v48, v49
    v_cvt_pk_bf16_f32 v49, v50, v51
    v_cvt_pk_bf16_f32 v50, v52, v53
    v_cvt_pk_bf16_f32 v51, v54, v55
    buffer_store_dwordx4 v[48:51], v1, s[4:7], s19 offen offset:2048 sc1
    v_mul_f32 v56, v56, v180
    v_mul_f32 v60, v60, v180
    v_mul_f32 v57, v57, v180
    v_mul_f32 v61, v61, v180
    v_mul_f32 v58, v58, v180
    v_mul_f32 v62, v62, v180
    v_mul_f32 v59, v59, v180
    v_mul_f32 v63, v63, v180
    v_cvt_pk_bf16_f32 v56, v56, v57
    v_cvt_pk_bf16_f32 v57, v58, v59
    v_cvt_pk_bf16_f32 v58, v60, v61
    v_cvt_pk_bf16_f32 v59, v62, v63
    buffer_store_dwordx4 v[56:59], v1, s[4:7], s18 offen offset:3072 sc1
    v_mul_f32 v64, v64, v184
    v_mul_f32 v68, v68, v184
    v_mul_f32 v65, v65, v184
    v_mul_f32 v69, v69, v184
    v_mul_f32 v66, v66, v184
    v_mul_f32 v70, v70, v184
    v_mul_f32 v67, v67, v184
    v_mul_f32 v71, v71, v184
    v_cvt_pk_bf16_f32 v64, v64, v65
    v_cvt_pk_bf16_f32 v65, v66, v67
    v_cvt_pk_bf16_f32 v66, v68, v69
    v_cvt_pk_bf16_f32 v67, v70, v71
    buffer_store_dwordx4 v[64:67], v1, s[4:7], s19 offen offset:3072 sc1
    s_lshr_b32 s40, s34, 1
    s_lshl_b32 s40, s40, 7
    s_and_b32 s41, s34, 1
    s_lshl_b32 s41, s41, 2
    s_add_u32 s40, s40, s41
    s_add_u32 s40, s40, 125894656
    s_waitcnt vmcnt(0)
    s_barrier
    v_mov_b32 v250, s95
    v_cmp_eq_u32 vcc, 0, v0
    s_nop 0
    s_and_saveexec_b64 s[38:39], vcc
    s_cbranch_execz fs13
    buffer_store_dword v250, off, s[4:7], s40 sc1
fs13:
    s_mov_b64 exec, -1
    s_branch L_att_next
L_op_start:
    s_lshl_b32 s35, s33, 2
    s_add_u32 s35, s35, 136
    s_lshr_b32 s89, s33, 2
    s_lshl_b32 s89, s89, 7
    s_add_u32 s89, s89, 125841408
    v_mbcnt_lo_u32_b32 v2, -1, 0
    v_mbcnt_hi_u32_b32 v2, -1, v2
    v_min_u32 v2, 31, v2
    v_lshlrev_b32 v2, 2, v2
    s_mov_b32 s88, 4194304
fw14:
    buffer_load_dword v3, v2, s[4:7], s89 offen offset:0 sc1
    s_sub_u32 s88, s88, 1
    s_cbranch_scc1 fw14x
    s_waitcnt vmcnt(0)
    v_cmp_ne_u32 vcc, s95, v3
    s_cbranch_vccz fw14x
    s_sleep 4
    s_branch fw14
fw14x:
    v_and_b32 v1, 63, v0
    v_lshlrev_b32 v1, 4, v1
    s_lshl_b32 s18, s33, 18
    s_lshl_b32 s19, s32, 16
    s_add_u32 s18, s18, s19
    s_add_u32 s18, s18, 130023424
    buffer_load_dwordx4 a[0:3], v1, s[4:7], s18 offen offset:0 sc1
    buffer_load_dwordx4 a[4:7], v1, s[4:7], s18 offen offset:1024 sc1
    buffer_load_dwordx4 a[8:11], v1, s[4:7], s18 offen offset:2048 sc1
    buffer_load_dwordx4 a[12:15], v1, s[4:7], s18 offen offset:3072 sc1
    s_add_u32 s18, s18, 4096
    buffer_load_dwordx4 a[16:19], v1, s[4:7], s18 offen offset:0 sc1
    buffer_load_dwordx4 a[20:23], v1, s[4:7], s18 offen offset:1024 sc1
    buffer_load_dwordx4 a[24:27], v1, s[4:7], s18 offen offset:2048 sc1
    buffer_load_dwordx4 a[28:31], v1, s[4:7], s18 offen offset:3072 sc1
    s_add_u32 s18, s18, 4096
    buffer_load_dwordx4 a[32:35], v1, s[4:7], s18 offen offset:0 sc1
    buffer_load_dwordx4 a[36:39], v1, s[4:7], s18 offen offset:1024 sc1
    buffer_load_dwordx4 a[40:43], v1, s[4:7], s18 offen offset:2048 sc1
    buffer_load_dwordx4 a[44:47], v1, s[4:7], s18 offen offset:3072 sc1
    s_add_u32 s18, s18, 4096
    buffer_load_dwordx4 a[48:51], v1, s[4:7], s18 offen offset:0 sc1
    buffer_load_dwordx4 a[52:55], v1, s[4:7], s18 offen offset:1024 sc1
    buffer_load_dwordx4 a[56:59], v1, s[4:7], s18 offen offset:2048 sc1
    buffer_load_dwordx4 a[60:63], v1, s[4:7], s18 offen offset:3072 sc1
    s_add_u32 s18, s18, 4096
    buffer_load_dwordx4 a[64:67], v1, s[4:7], s18 offen offset:0 sc1
    buffer_load_dwordx4 a[68:71], v1, s[4:7], s18 offen offset:1024 sc1
    buffer_load_dwordx4 a[72:75], v1, s[4:7], s18 offen offset:2048 sc1
    buffer_load_dwordx4 a[76:79], v1, s[4:7], s18 offen offset:3072 sc1
    s_add_u32 s18, s18, 4096
    buffer_load_dwordx4 a[80:83], v1, s[4:7], s18 offen offset:0 sc1
    buffer_load_dwordx4 a[84:87], v1, s[4:7], s18 offen offset:1024 sc1
    buffer_load_dwordx4 a[88:91], v1, s[4:7], s18 offen offset:2048 sc1
    buffer_load_dwordx4 a[92:95], v1, s[4:7], s18 offen offset:3072 sc1
    s_add_u32 s18, s18, 4096
    buffer_load_dwordx4 a[96:99], v1, s[4:7], s18 offen offset:0 sc1
    buffer_load_dwordx4 a[100:103], v1, s[4:7], s18 offen offset:1024 sc1
    buffer_load_dwordx4 a[104:107], v1, s[4:7], s18 offen offset:2048 sc1
    buffer_load_dwordx4 a[108:111], v1, s[4:7], s18 offen offset:3072 sc1
    s_add_u32 s18, s18, 4096
    buffer_load_dwordx4 a[112:115], v1, s[4:7], s18 offen offset:0 sc1
    buffer_load_dwordx4 a[116:119], v1, s[4:7], s18 offen offset:1024 sc1
    buffer_load_dwordx4 a[120:123], v1, s[4:7], s18 offen offset:2048 sc1
    buffer_load_dwordx4 a[124:127], v1, s[4:7], s18 offen offset:3072 sc1
    s_add_u32 s18, s18, 4096
    buffer_load_dwordx4 a[128:131], v1, s[4:7], s18 offen offset:0 sc1
    buffer_load_dwordx4 a[132:135], v1, s[4:7], s18 offen offset:1024 sc1
    buffer_load_dwordx4 a[136:139], v1, s[4:7], s18 offen offset:2048 sc1
    buffer_load_dwordx4 a[140:143], v1, s[4:7], s18 offen offset:3072 sc1
    s_add_u32 s18, s18, 4096
    buffer_load_dwordx4 a[144:147], v1, s[4:7], s18 offen offset:0 sc1
    buffer_load_dwordx4 a[148:151], v1, s[4:7], s18 offen offset:1024 sc1
    buffer_load_dwordx4 a[152:155], v1, s[4:7], s18 offen offset:2048 sc1
    buffer_load_dwordx4 a[156:159], v1, s[4:7], s18 offen offset:3072 sc1
    s_add_u32 s18, s18, 4096
    buffer_load_dwordx4 a[160:163], v1, s[4:7], s18 offen offset:0 sc1
    s_waitcnt vmcnt(20)
    buffer_load_dwordx4 a[164:167], v1, s[4:7], s18 offen offset:1024 sc1
    buffer_load_dwordx4 a[168:171], v1, s[4:7], s18 offen offset:2048 sc1
    buffer_load_dwordx4 a[172:175], v1, s[4:7], s18 offen offset:3072 sc1
    s_add_u32 s18, s18, 4096
    buffer_load_dwordx4 a[176:179], v1, s[4:7], s18 offen offset:0 sc1
    buffer_load_dwordx4 a[180:183], v1, s[4:7], s18 offen offset:1024 sc1
    buffer_load_dwordx4 a[184:187], v1, s[4:7], s18 offen offset:2048 sc1
    buffer_load_dwordx4 a[188:191], v1, s[4:7], s18 offen offset:3072 sc1
    s_add_u32 s18, s18, 4096
    buffer_load_dwordx4 a[192:195], v1, s[4:7], s18 offen offset:0 sc1
    buffer_load_dwordx4 a[196:199], v1, s[4:7], s18 offen offset:1024 sc1
    buffer_load_dwordx4 a[200:203], v1, s[4:7], s18 offen offset:2048 sc1
    buffer_load_dwordx4 a[204:207], v1, s[4:7], s18 offen offset:3072 sc1
    s_add_u32 s18, s18, 4096
    buffer_load_dwordx4 a[208:211], v1, s[4:7], s18 offen offset:0 sc1
    buffer_load_dwordx4 a[212:215], v1, s[4:7], s18 offen offset:1024 sc1
    buffer_load_dwordx4 a[216:219], v1, s[4:7], s18 offen offset:2048 sc1
    buffer_load_dwordx4 a[220:223], v1, s[4:7], s18 offen offset:3072 sc1
    s_add_u32 s18, s18, 4096
    buffer_load_dwordx4 a[224:227], v1, s[4:7], s18 offen offset:0 sc1
    buffer_load_dwordx4 a[228:231], v1, s[4:7], s18 offen offset:1024 sc1
    buffer_load_dwordx4 a[232:235], v1, s[4:7], s18 offen offset:2048 sc1
    buffer_load_dwordx4 a[236:239], v1, s[4:7], s18 offen offset:3072 sc1
    s_add_u32 s18, s18, 4096
    buffer_load_dwordx4 a[240:243], v1, s[4:7], s18 offen offset:0 sc1
    buffer_load_dwordx4 a[244:247], v1, s[4:7], s18 offen offset:1024 sc1
    buffer_load_dwordx4 a[248:251], v1, s[4:7], s18 offen offset:2048 sc1
    buffer_load_dwordx4 a[252:255], v1, s[4:7], s18 offen offset:3072 sc1
    s_waitcnt vmcnt(0)
    s_mov_b32 s44, 0
    s_mov_b32 s37, s35
    v_mov_b32 v250, 1
    v_mov_b32 v251, 163832
    v_cmp_eq_u32 vcc, 0, v0
    s_nop 0
    s_and_saveexec_b64 s[38:39], vcc
    s_cbranch_execz tk15
    buffer_atomic_add v250, off, s[84:87], s37 sc0
    s_waitcnt vmcnt(0)
    ds_write_b32 v251, v250
    s_waitcnt lgkmcnt(0)
tk15:
    s_mov_b64 exec, -1
    s_barrier
    ds_read_b32 v252, v251
    s_waitcnt lgkmcnt(0)
    v_readfirstlane_b32 s16, v252
    s_barrier
    s_nop 3
    s_cmp_ge_u32 s16, 128
    s_cbranch_scc1 L_op_nextcb
L_op_seg:
    s_lshr_b32 s43, s16, 1
    s_add_u32 s43, s43, 2
    s_min_u32 s43, s43, 63
    s_lshl_b32 s94, s33, 7
    s_add_u32 s94, s94, s16
    s_mov_b32 s88, 65536
    s_mov_b32 s89, 125853696
cw16:
    buffer_load_dword v3, off, s[4:7], s89 sc1
    s_waitcnt vmcnt(0)
    v_readfirstlane_b32 s42, v3
    s_nop 0
    s_sub_u32 s42, s42, s95
    s_cmp_gt_u32 s42, 64
    s_cselect_b32 s42, 0, s42
    s_add_u32 s42, s42, 1
    s_cmp_ge_u32 s42, s43
    s_cbranch_scc1 cw16x
    s_sub_u32 s88, s88, 1
    s_cbranch_scc1 cw16x
    s_sub_u32 s42, s43, s42
    s_min_u32 s42, s42, 6
cw16s:
    s_sleep 24
    s_sub_u32 s42, s42, 1
    s_cmp_lg_u32 s42, 0
    s_cbranch_scc1 cw16s
    s_branch cw16
cw16x:
    s_lshr_b32 s89, s16, 1
    s_lshl_b32 s89, s89, 2
    s_add_u32 s89, s89, s32
    s_lshl_b32 s89, s89, 7
    s_add_u32 s89, s89, 125894656
    v_mbcnt_lo_u32_b32 v2, -1, 0
    v_mbcnt_hi_u32_b32 v2, -1, v2
    v_min_u32 v2, 1, v2
    v_lshlrev_b32 v2, 2, v2
    s_mov_b32 s88, 4194304
fw17:
    buffer_load_dword v3, v2, s[4:7], s89 offen offset:0 sc1
    s_sub_u32 s88, s88, 1
    s_cbranch_scc1 fw17x
    s_waitcnt vmcnt(0)
    v_cmp_ne_u32 vcc, s95, v3
    s_cbranch_vccz fw17x
    s_sleep 2
    s_branch fw17
fw17x:
    v_mov_b32 v250, 1
    v_lshrrev_b32 v252, 2, v1
    v_min_u32 v252, 68, v252
    s_cmp_lg_u32 s32, 0
    s_cbranch_scc1 L_op_na
    s_mov_b64 exec, 1
    buffer_atomic_add v250, off, s[84:87], s35 sc0
    s_mov_b64 exec, -1
    s_cmp_lg_u32 s44, 0
    s_cbranch_scc1 L_op_na
    buffer_load_dword v253, v252, s[84:87], 0 offen offset:136 sc1
L_op_na:
    s_lshl_b32 s18, s16, 17
    s_lshl_b32 s19, s32, 15
    s_add_u32 s18, s18, s19
    s_add_u32 s18, s18, 50331648
    buffer_load_dwordx4 v[32:35], v1, s[4:7], s18 offen offset:0 sc1
    buffer_load_dwordx4 v[36:39], v1, s[4:7], s18 offen offset:1024 sc1
    buffer_load_dwordx4 v[40:43], v1, s[4:7], s18 offen offset:2048 sc1
    buffer_load_dwordx4 v[44:47], v1, s[4:7], s18 offen offset:3072 sc1
    s_add_u32 s18, s18, 4096
    buffer_load_dwordx4 v[48:51], v1, s[4:7], s18 offen offset:0 sc1
    buffer_load_dwordx4 v[52:55], v1, s[4:7], s18 offen offset:1024 sc1
    buffer_load_dwordx4 v[56:59], v1, s[4:7], s18 offen offset:2048 sc1
    buffer_load_dwordx4 v[60:63], v1, s[4:7], s18 offen offset:3072 sc1
    s_add_u32 s18, s18, 4096
    buffer_load_dwordx4 v[64:67], v1, s[4:7], s18 offen offset:0 sc1
    buffer_load_dwordx4 v[68:71], v1, s[4:7], s18 offen offset:1024 sc1
    buffer_load_dwordx4 v[72:75], v1, s[4:7], s18 offen offset:2048 sc1
    buffer_load_dwordx4 v[76:79], v1, s[4:7], s18 offen offset:3072 sc1
    s_add_u32 s18, s18, 4096
    buffer_load_dwordx4 v[80:83], v1, s[4:7], s18 offen offset:0 sc1
    buffer_load_dwordx4 v[84:87], v1, s[4:7], s18 offen offset:1024 sc1
    buffer_load_dwordx4 v[88:91], v1, s[4:7], s18 offen offset:2048 sc1
    buffer_load_dwordx4 v[92:95], v1, s[4:7], s18 offen offset:3072 sc1
    s_add_u32 s18, s18, 4096
    buffer_load_dwordx4 v[96:99], v1, s[4:7], s18 offen offset:0 sc1
    buffer_load_dwordx4 v[100:103], v1, s[4:7], s18 offen offset:1024 sc1
    buffer_load_dwordx4 v[104:107], v1, s[4:7], s18 offen offset:2048 sc1
    buffer_load_dwordx4 v[108:111], v1, s[4:7], s18 offen offset:3072 sc1
    s_add_u32 s18, s18, 4096
    buffer_load_dwordx4 v[112:115], v1, s[4:7], s18 offen offset:0 sc1
    buffer_load_dwordx4 v[116:119], v1, s[4:7], s18 offen offset:1024 sc1
    buffer_load_dwordx4 v[120:123], v1, s[4:7], s18 offen offset:2048 sc1
    buffer_load_dwordx4 v[124:127], v1, s[4:7], s18 offen offset:3072 sc1
    s_add_u32 s18, s18, 4096
    buffer_load_dwordx4 v[128:131], v1, s[4:7], s18 offen offset:0 sc1
    buffer_load_dwordx4 v[132:135], v1, s[4:7], s18 offen offset:1024 sc1
    buffer_load_dwordx4 v[136:139], v1, s[4:7], s18 offen offset:2048 sc1
    buffer_load_dwordx4 v[140:143], v1, s[4:7], s18 offen offset:3072 sc1
    s_add_u32 s18, s18, 4096
    buffer_load_dwordx4 v[144:147], v1, s[4:7], s18 offen offset:0 sc1
    buffer_load_dwordx4 v[148:151], v1, s[4:7], s18 offen offset:1024 sc1
    buffer_load_dwordx4 v[152:155], v1, s[4:7], s18 offen offset:2048 sc1
    buffer_load_dwordx4 v[156:159], v1, s[4:7], s18 offen offset:3072 sc1
    v_lshlrev_b32 v2, 4, v0
    v_and_b32 v3, 3072, v2
    v_lshl_add_u32 v2, v3, 1, v1
    s_waitcnt vmcnt(31)
    v_mfma_f32_16x16x32_bf16 v[8:11], a[0:3], v[32:35], 0
    v_mfma_f32_16x16x32_bf16 v[12:15], a[4:7], v[32:35], 0
    s_waitcnt vmcnt(30)
    v_mfma_f32_16x16x32_bf16 v[8:11], a[8:11], v[36:39], v[8:11]
    v_mfma_f32_16x16x32_bf16 v[12:15], a[12:15], v[36:39], v[12:15]
    s_waitcnt vmcnt(29)
    v_mfma_f32_16x16x32_bf16 v[8:11], a[16:19], v[40:43], v[8:11]
    v_mfma_f32_16x16x32_bf16 v[12:15], a[20:23], v[40:43], v[12:15]
    s_waitcnt vmcnt(28)
    v_mfma_f32_16x16x32_bf16 v[8:11], a[24:27], v[44:47], v[8:11]
    v_mfma_f32_16x16x32_bf16 v[12:15], a[28:31], v[44:47], v[12:15]
    s_waitcnt vmcnt(27)
    v_mfma_f32_16x16x32_bf16 v[8:11], a[32:35], v[48:51], v[8:11]
    v_mfma_f32_16x16x32_bf16 v[12:15], a[36:39], v[48:51], v[12:15]
    s_waitcnt vmcnt(26)
    v_mfma_f32_16x16x32_bf16 v[8:11], a[40:43], v[52:55], v[8:11]
    v_mfma_f32_16x16x32_bf16 v[12:15], a[44:47], v[52:55], v[12:15]
    s_waitcnt vmcnt(25)
    v_mfma_f32_16x16x32_bf16 v[8:11], a[48:51], v[56:59], v[8:11]
    v_mfma_f32_16x16x32_bf16 v[12:15], a[52:55], v[56:59], v[12:15]
    s_waitcnt vmcnt(24)
    v_mfma_f32_16x16x32_bf16 v[8:11], a[56:59], v[60:63], v[8:11]
    v_mfma_f32_16x16x32_bf16 v[12:15], a[60:63], v[60:63], v[12:15]
    s_waitcnt vmcnt(23)
    v_mfma_f32_16x16x32_bf16 v[8:11], a[64:67], v[64:67], v[8:11]
    v_mfma_f32_16x16x32_bf16 v[12:15], a[68:71], v[64:67], v[12:15]
    s_waitcnt vmcnt(22)
    v_mfma_f32_16x16x32_bf16 v[8:11], a[72:75], v[68:71], v[8:11]
    v_mfma_f32_16x16x32_bf16 v[12:15], a[76:79], v[68:71], v[12:15]
    s_waitcnt vmcnt(21)
    v_mfma_f32_16x16x32_bf16 v[8:11], a[80:83], v[72:75], v[8:11]
    v_mfma_f32_16x16x32_bf16 v[12:15], a[84:87], v[72:75], v[12:15]
    s_waitcnt vmcnt(20)
    v_mfma_f32_16x16x32_bf16 v[8:11], a[88:91], v[76:79], v[8:11]
    v_mfma_f32_16x16x32_bf16 v[12:15], a[92:95], v[76:79], v[12:15]
    s_waitcnt vmcnt(19)
    v_mfma_f32_16x16x32_bf16 v[8:11], a[96:99], v[80:83], v[8:11]
    v_mfma_f32_16x16x32_bf16 v[12:15], a[100:103], v[80:83], v[12:15]
    s_waitcnt vmcnt(18)
    v_mfma_f32_16x16x32_bf16 v[8:11], a[104:107], v[84:87], v[8:11]
    v_mfma_f32_16x16x32_bf16 v[12:15], a[108:111], v[84:87], v[12:15]
    s_waitcnt vmcnt(17)
    v_mfma_f32_16x16x32_bf16 v[8:11], a[112:115], v[88:91], v[8:11]
    v_mfma_f32_16x16x32_bf16 v[12:15], a[116:119], v[88:91], v[12:15]
    s_waitcnt vmcnt(16)
    v_mfma_f32_16x16x32_bf16 v[8:11], a[120:123], v[92:95], v[8:11]
    v_mfma_f32_16x16x32_bf16 v[12:15], a[124:127], v[92:95], v[12:15]
    s_waitcnt vmcnt(15)
    v_mfma_f32_16x16x32_bf16 v[8:11], a[128:131], v[96:99], v[8:11]
    v_mfma_f32_16x16x32_bf16 v[12:15], a[132:135], v[96:99], v[12:15]
    s_waitcnt vmcnt(14)
    v_mfma_f32_16x16x32_bf16 v[8:11], a[136:139], v[100:103], v[8:11]
    v_mfma_f32_16x16x32_bf16 v[12:15], a[140:143], v[100:103], v[12:15]
    s_waitcnt vmcnt(13)
    v_mfma_f32_16x16x32_bf16 v[8:11], a[144:147], v[104:107], v[8:11]
    v_mfma_f32_16x16x32_bf16 v[12:15], a[148:151], v[104:107], v[12:15]
    s_waitcnt vmcnt(12)
    v_mfma_f32_16x16x32_bf16 v[8:11], a[152:155], v[108:111], v[8:11]
    v_mfma_f32_16x16x32_bf16 v[12:15], a[156:159], v[108:111], v[12:15]
    s_waitcnt vmcnt(11)
    v_mfma_f32_16x16x32_bf16 v[8:11], a[160:163], v[112:115], v[8:11]
    v_mfma_f32_16x16x32_bf16 v[12:15], a[164:167], v[112:115], v[12:15]
    s_waitcnt vmcnt(10)
    v_mfma_f32_16x16x32_bf16 v[8:11], a[168:171], v[116:119], v[8:11]
    v_mfma_f32_16x16x32_bf16 v[12:15], a[172:175], v[116:119], v[12:15]
    s_waitcnt vmcnt(9)
    v_mfma_f32_16x16x32_bf16 v[8:11], a[176:179], v[120:123], v[8:11]
    v_mfma_f32_16x16x32_bf16 v[12:15], a[180:183], v[120:123], v[12:15]
    s_waitcnt vmcnt(8)
    v_mfma_f32_16x16x32_bf16 v[8:11], a[184:187], v[124:127], v[8:11]
    v_mfma_f32_16x16x32_bf16 v[12:15], a[188:191], v[124:127], v[12:15]
    s_waitcnt vmcnt(7)
    v_mfma_f32_16x16x32_bf16 v[8:11], a[192:195], v[128:131], v[8:11]
    v_mfma_f32_16x16x32_bf16 v[12:15], a[196:199], v[128:131], v[12:15]
    s_waitcnt vmcnt(6)
    v_mfma_f32_16x16x32_bf16 v[8:11], a[200:203], v[132:135], v[8:11]
    v_mfma_f32_16x16x32_bf16 v[12:15], a[204:207], v[132:135], v[12:15]
    s_waitcnt vmcnt(5)
    v_mfma_f32_16x16x32_bf16 v[8:11], a[208:211], v[136:139], v[8:11]
    v_mfma_f32_16x16x32_bf16 v[12:15], a[212:215], v[136:139], v[12:15]
    s_waitcnt vmcnt(4)
    v_mfma_f32_16x16x32_bf16 v[8:11], a[216:219], v[140:143], v[8:11]
    v_mfma_f32_16x16x32_bf16 v[12:15], a[220:223], v[140:143], v[12:15]
    s_waitcnt vmcnt(3)
    v_mfma_f32_16x16x32_bf16 v[8:11], a[224:227], v[144:147], v[8:11]
    v_mfma_f32_16x16x32_bf16 v[12:15], a[228:231], v[144:147], v[12:15]
    s_waitcnt vmcnt(2)
    v_mfma_f32_16x16x32_bf16 v[8:11], a[232:235], v[148:151], v[8:11]
    v_mfma_f32_16x16x32_bf16 v[12:15], a[236:239], v[148:151], v[12:15]
    s_waitcnt vmcnt(1)
    v_mfma_f32_16x16x32_bf16 v[8:11], a[240:243], v[152:155], v[8:11]
    v_mfma_f32_16x16x32_bf16 v[12:15], a[244:247], v[152:155], v[12:15]
    s_waitcnt vmcnt(0)
    v_mfma_f32_16x16x32_bf16 v[8:11], a[248:251], v[156:159], v[8:11]
    v_mfma_f32_16x16x32_bf16 v[12:15], a[252:255], v[156:159], v[12:15]
    s_nop 6
    ds_write_b128 v2, v[8:11] offset:0
    ds_write_b128 v2, v[12:15] offset:1024
    s_cmp_lg_u32 s32, 0
    s_cbranch_scc1 L_op_nb
    v_cmp_eq_u32 vcc, 0, v253
    s_nop 0
    s_cmp_eq_u64 vcc, 0
    s_cselect_b32 s44, 65536, 0
    v_or_b32 v250, s44, v250
    v_mov_b32 v251, 163832
    s_mov_b64 exec, 1
    ds_write_b32 v251, v250
    s_mov_b64 exec, -1
L_op_nb:
    s_waitcnt lgkmcnt(0)
    s_barrier
    s_cmp_lg_u32 s32, 0
    s_cbranch_scc1 os_skip
    ds_read_b128 v[40:43], v1 offset:2048
    ds_read_b128 v[44:47], v1 offset:3072
    ds_read_b128 v[48:51], v1 offset:4096
    ds_read_b128 v[52:55], v1 offset:5120
    ds_read_b128 v[56:59], v1 offset:6144
    ds_read_b128 v[60:63], v1 offset:7168
    v_lshrrev_b32 v3, 4, v1
    v_bfe_u32 v4, v3, 2, 2
    v_lshlrev_b32 v4, 3, v4
    v_and_b32 v2, 3, v3
    v_add_u32 v4, v4, v2
    v_mul_u32_u24 v4, 2304, v4
    v_lshrrev_b32 v3, 4, v3
    v_lshl_add_u32 v4, v3, 4, v4
    s_lshr_b32 s18, s16, 1
    s_lshl_b32 s18, s18, 3
    s_and_b32 s19, s16, 1
    s_add_u32 s18, s18, s19
    s_mul_i32 s18, s18, 9216
    s_lshl_b32 s19, s33, 6
    s_add_u32 s18, s18, s19
    s_waitcnt lgkmcnt(0)
    v_pk_add_f32 v[8:9], v[8:9], v[40:41]
    v_pk_add_f32 v[48:49], v[48:49], v[56:57]
    v_pk_add_f32 v[8:9], v[8:9], v[48:49]
    v_pk_add_f32 v[10:11], v[10:11], v[42:43]
    v_pk_add_f32 v[50:51], v[50:51], v[58:59]
    v_pk_add_f32 v[10:11], v[10:11], v[50:51]
    v_pk_add_f32 v[12:13], v[12:13], v[44:45]
    v_pk_add_f32 v[52:53], v[52:53], v[60:61]
    v_pk_add_f32 v[12:13], v[12:13], v[52:53]
    v_pk_add_f32 v[14:15], v[14:15], v[46:47]
    v_pk_add_f32 v[54:55], v[54:55], v[62:63]
    v_pk_add_f32 v[14:15], v[14:15], v[54:55]
    v_cvt_pk_bf16_f32 v32, v8, v12
    v_cvt_pk_bf16_f32 v33, v9, v13
    v_cvt_pk_bf16_f32 v34, v10, v14
    v_cvt_pk_bf16_f32 v35, v11, v15
    buffer_store_dwordx4 v[32:35], v4, s[8:11], s18 offen
os_skip:
    s_nop 1
    v_mov_b32 v251, 163832
    ds_read_b32 v252, v251
    s_waitcnt lgkmcnt(0)
    v_readfirstlane_b32 s40, v252
    s_nop 1
    s_cmp_ge_u32 s40, 65664
    s_cbranch_scc1 L_done
    s_barrier
    s_and_b32 s16, s40, 0xffff
    s_cmp_lt_u32 s16, 128
    s_cbranch_scc1 L_op_seg
L_op_nextcb:
    s_mov_b32 s40, -1
    s_cmp_lg_u32 s32, 0
    s_cbranch_scc1 L_op_dec
    v_and_b32 v1, 63, v0
    v_min_u32 v1, 17, v1
    v_lshlrev_b32 v2, 2, v1
    buffer_load_dword v3, v2, s[84:87], 0 offen offset:136 sc1
    s_waitcnt vmcnt(0)
    v_cmp_gt_u32 vcc, 100, v3
    s_nop 0
    s_ff1_i32_b64 s40, vcc
L_op_dec:
    v_mov_b32 v250, s40
    v_mov_b32 v251, 163832
    s_cmp_lg_u32 s32, 0
    s_cbranch_scc1 L_op_nw
    ds_write_b32 v251, v250
    s_waitcnt lgkmcnt(0)
L_op_nw:
    s_barrier
    ds_read_b32 v252, v251
    s_waitcnt lgkmcnt(0)
    v_readfirstlane_b32 s33, v252
    s_barrier
    s_nop 1
    s_cmp_lt_u32 s33, 18
    s_cbranch_scc1 L_op_start
L_done:
L_exit:
    s_endpgm
.section .rodata,"a"
.p2align 6
.amdhsa_kernel concat_heads__memory_aug_recurrent_mem_tr__ssm_conv_s4d__prompt_kernel
  .amdhsa_next_free_vgpr 512
  .amdhsa_next_free_sgpr 102
  .amdhsa_accum_offset 256
  .amdhsa_group_segment_fixed_size 0
  .amdhsa_kernarg_size 136
  .amdhsa_user_sgpr_count 2
  .amdhsa_user_sgpr_kernarg_segment_ptr 1
  .amdhsa_system_sgpr_workgroup_id_x 1
.end_amdhsa_kernel
.text
```

```asm
; @launch grid=(256,1,1) block=(256,1,1) lds=163840
.amdgcn_target "amdgcn-amd-amdhsa--gfx950"
.text
.globl concat_heads__memory_aug_recurrent_mem_tr__ssm_conv_s4d__prompt_kernel
.p2align 8
.type concat_heads__memory_aug_recurrent_mem_tr__ssm_conv_s4d__prompt_kernel,@function
concat_heads__memory_aug_recurrent_mem_tr__ssm_conv_s4d__prompt_kernel:
    s_cmp_ge_u32 s2, 256
    s_cbranch_scc1 L_exit
    s_load_dwordx4 s[80:83], s[0:1], 120
    s_load_dwordx16 s[48:63], s[0:1], 0
    s_memrealtime s[90:91]
    v_lshrrev_b32 v1, 6, v0
    s_nop 0
    v_readfirstlane_b32 s32, v1
    s_waitcnt lgkmcnt(0)
    s_mov_b32 s4, s82
    s_mov_b32 s5, s83
    s_mov_b32 s6, 268435456
    s_mov_b32 s7, 0x20000
    s_mov_b32 s84, s80
    s_mov_b32 s85, s81
    s_mov_b32 s86, 256
    s_mov_b32 s87, 0x20000
    s_cmp_lg_u32 s32, 0
    s_cbranch_scc1 L_nod0
L_nod0:
    s_cmp_lg_u32 s32, 3
    s_cbranch_scc1 L_nowarm
    s_getpc_b64 s[44:45]
L_pcw:
    v_and_b32 v1, 63, v0
    v_lshlrev_b32 v1, 7, v1
    v_min_u32 v2, L_exit-L_pcw, v1
    global_load_dword v210, v2, s[44:45]
    v_add_u32 v1, 8192, v1
    v_min_u32 v2, L_exit-L_pcw, v1
    global_load_dword v211, v2, s[44:45]
    v_add_u32 v1, 8192, v1
    v_min_u32 v2, L_exit-L_pcw, v1
    global_load_dword v212, v2, s[44:45]
    v_add_u32 v1, 8192, v1
    v_min_u32 v2, L_exit-L_pcw, v1
    global_load_dword v213, v2, s[44:45]
    v_add_u32 v1, 8192, v1
    v_min_u32 v2, L_exit-L_pcw, v1
    global_load_dword v214, v2, s[44:45]
    v_add_u32 v1, 8192, v1
    v_min_u32 v2, L_exit-L_pcw, v1
    global_load_dword v215, v2, s[44:45]
    v_add_u32 v1, 8192, v1
    v_min_u32 v2, L_exit-L_pcw, v1
    global_load_dword v216, v2, s[44:45]
    v_add_u32 v1, 8192, v1
    v_min_u32 v2, L_exit-L_pcw, v1
    global_load_dword v217, v2, s[44:45]
    v_add_u32 v1, 8192, v1
L_nowarm:
    s_getreg_b32 s3, hwreg(HW_REG_XCC_ID)
    s_and_b32 s3, s3, 15
    s_cmp_lg_u32 s3, 3
    s_cbranch_scc1 L_helper
    s_mov_b32 s37, 128
    v_mov_b32 v250, 1
    v_mov_b32 v251, 163832
    v_cmp_eq_u32 vcc, 0, v0
    s_nop 0
    s_and_saveexec_b64 s[38:39], vcc
    s_cbranch_execz tk1
    buffer_atomic_add v250, off, s[84:87], s37 sc0
    s_waitcnt vmcnt(0)
    ds_write_b32 v251, v250
    s_waitcnt lgkmcnt(0)
tk1:
    s_mov_b64 exec, -1
    s_barrier
    ds_read_b32 v252, v251
    s_waitcnt lgkmcnt(0)
    v_readfirstlane_b32 s12, v252
    s_barrier
    s_nop 3
    s_cmp_ge_u32 s12, 32
    s_cbranch_scc1 L_helper
L_chain:
    s_load_dwordx8 s[48:55], s[0:1], 8
    s_load_dwordx2 s[56:57], s[0:1], 40
    s_waitcnt lgkmcnt(0)
    v_lshrrev_b32 v77, 6, v0
    s_nop 0
    v_readfirstlane_b32 s13, v77
    v_lshlrev_b32 v65, 4, v0
    v_and_b32 v48, 63, v0
    s_mov_b32 s10, 4718592
    s_mov_b32 s11, 0x20000
    v_lshrrev_b32 v49, 3, v48
    v_mul_u32_u24 v18, 1152, v49
    v_and_b32 v49, 7, v48
    v_lshl_add_u32 v18, v49, 4, v18
    s_mul_i32 s40, s12, 147456
    s_lshl_b32 s41, s13, 8
    s_add_u32 s40, s40, s41
    s_mov_b32 s42, s40
    s_xor_b32 s41, s13, 0
    s_mul_i32 s41, s41, 36864
    s_add_u32 s60, s41, s40
    s_xor_b32 s41, s13, 1
    s_mul_i32 s41, s41, 36864
    s_add_u32 s61, s41, s40
    s_xor_b32 s41, s13, 2
    s_mul_i32 s41, s41, 36864
    s_add_u32 s62, s41, s40
    s_xor_b32 s41, s13, 3
    s_mul_i32 s41, s41, 36864
    s_add_u32 s63, s41, s40
    s_lshl_b32 s43, s13, 12
    s_mov_b64 s[8:9], s[56:57]
    s_add_u32 m0, s43, 0
    s_add_u32 s41, s60, 0
    buffer_load_dwordx4 v18, s[8:11], s41 offen offset:0 nt lds
    s_add_u32 s41, s60, 8192
    buffer_load_dwordx4 v18, s[8:11], s41 offen offset:1024 nt lds
    s_add_u32 s41, s60, 16384
    buffer_load_dwordx4 v18, s[8:11], s41 offen offset:2048 nt lds
    s_add_u32 s41, s60, 24576
    buffer_load_dwordx4 v18, s[8:11], s41 offen offset:3072 nt lds
    s_add_u32 m0, s43, 36864
    s_add_u32 s41, s61, 0
    buffer_load_dwordx4 v18, s[8:11], s41 offen offset:0 nt lds
    s_add_u32 s41, s61, 8192
    buffer_load_dwordx4 v18, s[8:11], s41 offen offset:1024 nt lds
    s_add_u32 s41, s61, 16384
    buffer_load_dwordx4 v18, s[8:11], s41 offen offset:2048 nt lds
    s_add_u32 s41, s61, 24576
    buffer_load_dwordx4 v18, s[8:11], s41 offen offset:3072 nt lds
    s_add_u32 m0, s43, 73728
    s_add_u32 s41, s62, 0
    buffer_load_dwordx4 v18, s[8:11], s41 offen offset:0 nt lds
    s_add_u32 s41, s62, 8192
    buffer_load_dwordx4 v18, s[8:11], s41 offen offset:1024 nt lds
    s_add_u32 s41, s62, 16384
    buffer_load_dwordx4 v18, s[8:11], s41 offen offset:2048 nt lds
    s_add_u32 s41, s62, 24576
    buffer_load_dwordx4 v18, s[8:11], s41 offen offset:3072 nt lds
    s_add_u32 m0, s43, 110592
    s_add_u32 s41, s63, 0
    buffer_load_dwordx4 v18, s[8:11], s41 offen offset:0 nt lds
    s_add_u32 s41, s63, 8192
    buffer_load_dwordx4 v18, s[8:11], s41 offen offset:1024 nt lds
    s_add_u32 s41, s63, 16384
    buffer_load_dwordx4 v18, s[8:11], s41 offen offset:2048 nt lds
    s_add_u32 s41, s63, 24576
    buffer_load_dwordx4 v18, s[8:11], s41 offen offset:3072 nt lds
    v_lshrrev_b32 v49, 1, v48
    v_mul_u32_u24 v19, 1152, v49
    v_and_b32 v49, 1, v48
    v_lshl_add_u32 v19, v49, 4, v19
    s_mul_i32 s41, s13, 224
    s_sub_u32 s41, 1024, s41
    v_add_u32 v19, s41, v19
    v_lshrrev_b32 v49, 4, v48
    v_lshlrev_b32 v50, 2, v49
    v_and_b32 v51, 15, v48
    v_xor_b32 v51, v51, v50
    v_lshlrev_b32 v51, 4, v51
    v_lshl_add_u32 v16, v49, 15, v51
    v_lshrrev_b32 v50, 1, v49
    v_lshl_add_u32 v17, v50, 16, v51
    v_and_b32 v50, 1, v49
    v_lshl_add_u32 v17, v50, 13, v17
    s_lshl_b32 s40, s12, 8
    s_mul_i32 s58, s13, 1048576
    s_add_u32 s58, s58, s40
    s_lshr_b32 s41, s13, 1
    s_mul_i32 s59, s41, 262144
    s_and_b32 s41, s13, 1
    s_lshl_b32 s41, s41, 14
    s_add_u32 s59, s59, s41
    s_add_u32 s59, s59, s40
    s_add_u32 s59, s59, 4194304
    v_bfe_u32 v50, v48, 2, 2
    v_xor_b32 v51, s13, v50
    v_lshlrev_b32 v20, 6, v51
    v_and_b32 v51, 3, v48
    v_lshl_add_u32 v20, v51, 4, v20
    v_lshrrev_b32 v23, 2, v48
    v_lshl_add_u32 v20, v23, 8, v20
    s_xor_b32 s41, s43, 0
    v_add_u32 v24, s41, v20
    s_xor_b32 s41, s43, 4096
    v_add_u32 v25, s41, v20
    s_xor_b32 s41, s43, 8192
    v_add_u32 v26, s41, v20
    s_xor_b32 s41, s43, 12288
    v_add_u32 v27, s41, v20
    v_and_b32 v23, 1, v50
    v_lshl_add_u32 v23, v49, 2, v23
    v_lshrrev_b32 v50, 1, v50
    v_lshlrev_b32 v21, 7, v23
    v_lshl_add_u32 v21, v50, 6, v21
    v_lshl_add_u32 v21, v51, 4, v21
    v_add_u32 v21, s43, v21
    v_lshlrev_b32 v22, 9, v50
    v_xor_b32 v22, v22, v21
    v_lshlrev_b32 v23, 5, v23
    v_lshl_add_u32 v23, v50, 10, v23
    v_lshl_add_u32 v23, v51, 3, v23
    v_add_u32 v23, s43, v23
    v_bfe_u32 v60, v65, 4, 6
    v_and_b32 v61, 15, v60
    v_lshrrev_b32 v62, 4, v60
    v_mov_b32 v64, 0x4444
    v_mov_b32 v77, 0xeeee
    v_cmp_lt_u32 vcc, 7, v61
    s_nop 1
    v_cndmask_b32 v64, v64, v77, vcc
    v_xor_b32 v66, 1024, v65
    v_xor_b32 v67, 2048, v65
    v_xor_b32 v68, 3072, v65
    v_and_b32 v69, 511, v65
    s_mul_i32 s96, s13, 36864
    s_add_u32 s96, s96, 16384
    v_lshlrev_b32 v70, 4, v60
    v_add_u32 v70, s96, v70
    v_lshrrev_b32 v79, 1, v69
    s_lshl_b32 s96, s13, 8
    s_add_u32 s96, s96, 14336
    s_lshl_b32 s33, s13, 10
    s_add_u32 s97, s33, 8192
    v_mov_b32 v77, s97
    v_mov_b32 v78, s96
    v_cmp_lt_u32 vcc, 31, v60
    s_nop 1
    v_cndmask_b32 v71, v77, v78, vcc
    v_add_u32 v71, v71, v79
    v_and_b32 v77, 7, v61
    v_lshrrev_b32 v78, 3, v61
    v_lshlrev_b32 v74, 4, v77
    v_lshl_add_u32 v73, v62, 7, v74
    v_lshl_add_u32 v73, v78, 3, v73
    s_lshl_b32 s96, s13, 9
    v_add_u32 v73, s96, v73
    v_lshl_add_u32 v74, v78, 14, v74
    v_lshl_add_u32 v74, v62, 15, v74
    s_lshl_b32 s96, s13, 17
    v_add_u32 v74, s96, v74
    v_bfe_u32 v77, v61, 2, 1
    v_and_b32 v78, 3, v61
    v_bfe_u32 v79, v61, 1, 2
    s_cmp_lt_u32 s13, 2
    s_cselect_b64 vcc, -1, 0
    v_cndmask_b32 v77, 0, v77, vcc
    v_cndmask_b32 v78, v79, v78, vcc
    v_lshlrev_b32 v75, 7, v77
    v_lshl_add_u32 v75, v62, 4, v75
    v_lshl_add_u32 v75, v78, 2, v75
    v_lshl_add_u32 v58, v77, 3, v78
    v_lshlrev_b32 v79, 1, v78
    v_cndmask_b32 v58, v79, v58, vcc
    s_bfe_u32 s97, s12, 0x10001
    s_lshl_b32 s68, s97, 6
    s_lshl_b32 s97, s97, 2
    v_add_u32 v59, s97, v62
    s_bfe_u32 s96, s12, 0x10002
    s_and_b32 s40, s12, 1
    s_lshl_b32 s96, s96, 1
    s_add_u32 s96, s96, s40
    s_lshr_b32 s97, s12, 3
    s_lshl_b32 s98, s13, 2
    s_add_u32 s98, s98, s97
    s_lshl_b32 s98, s98, 2
    s_add_u32 s98, s98, s96
    s_lshl_b32 s98, s98, 8
    s_lshl_b32 s99, s13, 2
    s_add_u32 s99, s99, s96
    s_lshl_b32 s99, s99, 4
    s_lshl_b32 s41, s97, 1
    s_add_u32 s41, s41, s40
    s_lshl_b32 s41, s41, 7
    s_add_u32 s41, s41, 8192
    s_lshl_b32 s40, s40, 3
    s_add_u32 s40, s40, 512
    s_cmp_lt_u32 s13, 2
    s_cselect_b32 s96, 7, 4
    s_cselect_b32 s98, s98, s41
    s_cselect_b32 s99, s99, s40
    s_cselect_b32 s32, 1, 0
    s_add_u32 s68, s68, s98
    s_lshl_b32 s97, s97, s96
    s_add_u32 s99, s99, s97
    v_add_u32 v58, s99, v58
    s_and_b32 s97, s12, 4
    s_or_b32 s97, s97, s13
    s_cmp_eq_u32 s97, 2
    s_cselect_b32 s32, 2, s32
    s_mov_b32 s8, s48
    s_mov_b32 s9, s49
    s_mov_b32 s10, 9216
    s_cmp_lt_u32 s13, 2
    s_cselect_b32 s96, 8, 2
    v_mul_u32_u24 v77, 1152, v59
    v_lshl_add_u32 v77, v58, 1, v77
    buffer_load_ushort v72, v77, s[8:11], 0 offen
    buffer_load_ushort v76, v77, s[8:11], s96 offen
    s_mov_b32 s10, 4718592
    s_waitcnt vmcnt(12) lgkmcnt(0)
    s_barrier
    s_mov_b64 s[8:9], s[56:57]
    s_add_u32 m0, s43, 147456
    s_add_u32 s41, s42, 0
    buffer_load_dwordx4 v19, s[8:11], s41 offen offset:0 nt lds
    s_add_u32 s41, s42, 35840
    buffer_load_dwordx4 v19, s[8:11], s41 offen offset:1024 nt lds
    s_add_u32 s41, s42, 71680
    buffer_load_dwordx4 v19, s[8:11], s41 offen offset:2048 nt lds
    s_add_u32 s41, s42, 107520
    buffer_load_dwordx4 v19, s[8:11], s41 offen offset:3072 nt lds
    v_mov_b32 v78, v21
    v_mov_b32 v79, v22
    v_add_u32 v77, 0, v79
    ds_read_b64_tr_b16 v[80:81], v77 offset:0
    ds_read_b64_tr_b16 v[82:83], v77 offset:256
    ds_read_b64_tr_b16 v[84:85], v77 offset:2048
    ds_read_b64_tr_b16 v[86:87], v77 offset:2304
    ds_read_b64_tr_b16 v[112:113], v77 offset:8
    ds_read_b64_tr_b16 v[114:115], v77 offset:264
    ds_read_b64_tr_b16 v[116:117], v77 offset:2056
    ds_read_b64_tr_b16 v[118:119], v77 offset:2312
    s_waitcnt vmcnt(12) lgkmcnt(0)
    s_barrier
    s_mov_b64 s[8:9], s[52:53]
    s_add_u32 m0, s43, 0
    s_add_u32 s41, s58, 0
    buffer_load_dwordx4 v16, s[8:11], s41 offen offset:0 nt lds
    s_add_u32 s41, s58, 15360
    buffer_load_dwordx4 v16, s[8:11], s41 offen offset:1024 nt lds
    s_add_u32 s41, s58, 129024
    buffer_load_dwordx4 v16, s[8:11], s41 offen offset:2048 nt lds
    s_add_u32 s41, s58, 144384
    buffer_load_dwordx4 v16, s[8:11], s41 offen offset:3072 nt lds
    v_add_u32 v77, 36864, v78
    ds_read_b64_tr_b16 v[88:89], v77 offset:0
    ds_read_b64_tr_b16 v[90:91], v77 offset:256
    ds_read_b64_tr_b16 v[92:93], v77 offset:2048
    ds_read_b64_tr_b16 v[94:95], v77 offset:2304
    ds_read_b64_tr_b16 v[120:121], v77 offset:8
    ds_read_b64_tr_b16 v[122:123], v77 offset:264
    ds_read_b64_tr_b16 v[124:125], v77 offset:2056
    ds_read_b64_tr_b16 v[126:127], v77 offset:2312
    s_waitcnt vmcnt(12) lgkmcnt(0)
    s_barrier
    s_add_u32 m0, s43, 36864
    s_add_u32 s41, s58, 8192
    buffer_load_dwordx4 v16, s[8:11], s41 offen offset:0 nt lds
    s_add_u32 s41, s58, 23552
    buffer_load_dwordx4 v16, s[8:11], s41 offen offset:1024 nt lds
    s_add_u32 s41, s58, 137216
    buffer_load_dwordx4 v16, s[8:11], s41 offen offset:2048 nt lds
    s_add_u32 s41, s58, 152576
    buffer_load_dwordx4 v16, s[8:11], s41 offen offset:3072 nt lds
    v_add_u32 v77, 73728, v78
    ds_read_b64_tr_b16 v[96:97], v77 offset:0
    ds_read_b64_tr_b16 v[98:99], v77 offset:256
    ds_read_b64_tr_b16 v[100:101], v77 offset:2048
    ds_read_b64_tr_b16 v[102:103], v77 offset:2304
    ds_read_b64_tr_b16 v[128:129], v77 offset:8
    ds_read_b64_tr_b16 v[130:131], v77 offset:264
    ds_read_b64_tr_b16 v[132:133], v77 offset:2056
    ds_read_b64_tr_b16 v[134:135], v77 offset:2312
    s_waitcnt vmcnt(12) lgkmcnt(0)
    s_barrier
    s_add_u32 m0, s43, 73728
    s_add_u32 s41, s58, 262144
    buffer_load_dwordx4 v16, s[8:11], s41 offen offset:0 nt lds
    s_add_u32 s41, s58, 277504
    buffer_load_dwordx4 v16, s[8:11], s41 offen offset:1024 nt lds
    s_add_u32 s41, s58, 391168
    buffer_load_dwordx4 v16, s[8:11], s41 offen offset:2048 nt lds
    s_add_u32 s41, s58, 406528
    buffer_load_dwordx4 v16, s[8:11], s41 offen offset:3072 nt lds
    v_add_u32 v77, 110592, v78
    ds_read_b64_tr_b16 v[104:105], v77 offset:0
    ds_read_b64_tr_b16 v[106:107], v77 offset:256
    ds_read_b64_tr_b16 v[108:109], v77 offset:2048
    ds_read_b64_tr_b16 v[110:111], v77 offset:2304
    ds_read_b64_tr_b16 v[136:137], v77 offset:8
    ds_read_b64_tr_b16 v[138:139], v77 offset:264
    ds_read_b64_tr_b16 v[140:141], v77 offset:2056
    ds_read_b64_tr_b16 v[142:143], v77 offset:2312
    s_waitcnt vmcnt(12) lgkmcnt(0)
    s_barrier
    s_add_u32 m0, s43, 110592
    s_add_u32 s41, s58, 270336
    buffer_load_dwordx4 v16, s[8:11], s41 offen offset:0 nt lds
    s_add_u32 s41, s58, 285696
    buffer_load_dwordx4 v16, s[8:11], s41 offen offset:1024 nt lds
    s_add_u32 s41, s58, 399360
    buffer_load_dwordx4 v16, s[8:11], s41 offen offset:2048 nt lds
    s_add_u32 s41, s58, 414720
    buffer_load_dwordx4 v16, s[8:11], s41 offen offset:3072 nt lds
    v_add_u32 v77, 147456, v23
    ds_read_b64_tr_b16 v[144:145], v77 offset:0
    ds_read_b64_tr_b16 v[146:147], v77 offset:64
    ds_read_b64_tr_b16 v[148:149], v77 offset:512
    ds_read_b64_tr_b16 v[150:151], v77 offset:576
    ds_read_b64_tr_b16 v[152:153], v77 offset:2048
    ds_read_b64_tr_b16 v[154:155], v77 offset:2112
    ds_read_b64_tr_b16 v[156:157], v77 offset:2560
    ds_read_b64_tr_b16 v[158:159], v77 offset:2624
    s_waitcnt vmcnt(12) lgkmcnt(0)
    s_barrier
    s_add_u32 m0, s43, 147456
    s_add_u32 s41, s58, 524288
    buffer_load_dwordx4 v16, s[8:11], s41 offen offset:0 nt lds
    s_add_u32 s41, s58, 539648
    buffer_load_dwordx4 v16, s[8:11], s41 offen offset:1024 nt lds
    s_add_u32 s41, s58, 653312
    buffer_load_dwordx4 v16, s[8:11], s41 offen offset:2048 nt lds
    s_add_u32 s41, s58, 668672
    buffer_load_dwordx4 v16, s[8:11], s41 offen offset:3072 nt lds
    s_cmp_eq_u32 s32, 0
    s_cbranch_scc1 cf_init_done
    v_mov_b32 v52, 1
    v_mov_b32 v53, 1
    v_mov_b32 v54, 1
    v_mov_b32 v55, 1
    v_mov_b32 v56, 0
    v_lshl_or_b32 v72, v76, 16, v72
    s_lshl_b32 s96, s12, 14
    s_add_u32 s96, s96, 68157440
    s_add_u32 s97, s96, 0
    buffer_store_dwordx4 v[52:55], v65, s[4:7], s97 offen
    buffer_load_dwordx4 v[60:63], v65, s[4:7], s97 offen sc1
    s_add_u32 s97, s96, 4096
    buffer_store_dwordx4 v[52:55], v65, s[4:7], s97 offen
    buffer_load_dwordx4 v[60:63], v65, s[4:7], s97 offen sc1
    s_add_u32 s97, s96, 8192
    buffer_store_dwordx4 v[52:55], v65, s[4:7], s97 offen
    buffer_load_dwordx4 v[60:63], v65, s[4:7], s97 offen sc1
    s_add_u32 s97, s96, 12288
    buffer_store_dwordx4 v[52:55], v65, s[4:7], s97 offen
    buffer_load_dwordx4 v[60:63], v65, s[4:7], s97 offen sc1
    s_add_u32 s96, s68, 67108864
    s_add_u32 s97, s96, 16384
    buffer_store_dword v56, v75, s[4:7], s96 offen offset:0
    buffer_store_dword v72, v75, s[4:7], s97 offen offset:0
    buffer_load_dword v60, v75, s[4:7], s96 offen offset:0 sc1
    buffer_load_dword v60, v75, s[4:7], s97 offen offset:0 sc1
    s_cmp_lg_u32 s32, 2
    s_cbranch_scc1 cf_init_done
    buffer_store_dword v56, v75, s[4:7], s96 offen offset:1024
    buffer_store_dword v72, v75, s[4:7], s97 offen offset:1024
    buffer_load_dword v60, v75, s[4:7], s96 offen offset:1024 sc1
    buffer_load_dword v60, v75, s[4:7], s97 offen offset:1024 sc1
    buffer_store_dword v56, v75, s[4:7], s96 offen offset:2048
    buffer_store_dword v72, v75, s[4:7], s97 offen offset:2048
    buffer_load_dword v60, v75, s[4:7], s96 offen offset:2048 sc1
    buffer_load_dword v60, v75, s[4:7], s97 offen offset:2048 sc1
    buffer_store_dword v56, v75, s[4:7], s96 offen offset:3072
    buffer_store_dword v72, v75, s[4:7], s97 offen offset:3072
    buffer_load_dword v60, v75, s[4:7], s96 offen offset:3072 sc1
    buffer_load_dword v60, v75, s[4:7], s97 offen offset:3072 sc1
cf_init_done:
    v_add_u32 v28, 0, v24
    v_add_u32 v29, 0, v25
    v_add_u32 v30, 0, v26
    v_add_u32 v31, 0, v27
    ds_read_b64_tr_b16 a[96:97], v28 offset:0
    ds_read_b64_tr_b16 a[104:105], v28 offset:8
    ds_read_b64_tr_b16 a[112:113], v29 offset:0
    ds_read_b64_tr_b16 a[120:121], v29 offset:8
    ds_read_b64_tr_b16 a[128:129], v30 offset:0
    ds_read_b64_tr_b16 a[136:137], v30 offset:8
    ds_read_b64_tr_b16 a[144:145], v31 offset:0
    ds_read_b64_tr_b16 v[32:33], v31 offset:8
    s_waitcnt vmcnt(12) lgkmcnt(0)
    s_barrier
    s_add_u32 m0, s43, 0
    s_add_u32 s41, s58, 532480
    buffer_load_dwordx4 v16, s[8:11], s41 offen offset:0 nt lds
    s_add_u32 s41, s58, 547840
    buffer_load_dwordx4 v16, s[8:11], s41 offen offset:1024 nt lds
    s_add_u32 s41, s58, 661504
    buffer_load_dwordx4 v16, s[8:11], s41 offen offset:2048 nt lds
    s_add_u32 s41, s58, 676864
    buffer_load_dwordx4 v16, s[8:11], s41 offen offset:3072 nt lds
    ds_write_b64 v70, v[32:33] offset:12288
    v_add_u32 v28, 36864, v24
    v_add_u32 v29, 36864, v25
    v_add_u32 v30, 36864, v26
    v_add_u32 v31, 36864, v27
    ds_read_b64_tr_b16 a[98:99], v28 offset:0
    ds_read_b64_tr_b16 a[106:107], v28 offset:8
    ds_read_b64_tr_b16 a[114:115], v29 offset:0
    ds_read_b64_tr_b16 a[122:123], v29 offset:8
    ds_read_b64_tr_b16 a[130:131], v30 offset:0
    ds_read_b64_tr_b16 a[138:139], v30 offset:8
    ds_read_b64_tr_b16 a[146:147], v31 offset:0
    ds_read_b64_tr_b16 v[0:1], v31 offset:8
    s_waitcnt vmcnt(12) lgkmcnt(0)
    s_barrier
    s_add_u32 m0, s43, 36864
    s_add_u32 s41, s58, 786432
    buffer_load_dwordx4 v16, s[8:11], s41 offen offset:0 nt lds
    s_add_u32 s41, s58, 801792
    buffer_load_dwordx4 v16, s[8:11], s41 offen offset:1024 nt lds
    s_add_u32 s41, s58, 915456
    buffer_load_dwordx4 v16, s[8:11], s41 offen offset:2048 nt lds
    s_add_u32 s41, s58, 930816
    buffer_load_dwordx4 v16, s[8:11], s41 offen offset:3072 nt lds
    ds_write_b64 v70, v[0:1] offset:12296
    v_add_u32 v28, 73728, v24
    v_add_u32 v29, 73728, v25
    v_add_u32 v30, 73728, v26
    v_add_u32 v31, 73728, v27
    ds_read_b64_tr_b16 a[100:101], v28 offset:0
    ds_read_b64_tr_b16 a[108:109], v28 offset:8
    ds_read_b64_tr_b16 a[116:117], v29 offset:0
    ds_read_b64_tr_b16 a[124:125], v29 offset:8
    ds_read_b64_tr_b16 a[132:133], v30 offset:0
    ds_read_b64_tr_b16 a[140:141], v30 offset:8
    ds_read_b64_tr_b16 a[148:149], v31 offset:0
    ds_read_b64_tr_b16 v[32:33], v31 offset:8
    s_waitcnt vmcnt(12) lgkmcnt(0)
    s_barrier
    s_add_u32 m0, s43, 73728
    s_add_u32 s41, s58, 794624
    buffer_load_dwordx4 v16, s[8:11], s41 offen offset:0 nt lds
    s_add_u32 s41, s58, 809984
    buffer_load_dwordx4 v16, s[8:11], s41 offen offset:1024 nt lds
    s_add_u32 s41, s58, 923648
    buffer_load_dwordx4 v16, s[8:11], s41 offen offset:2048 nt lds
    s_add_u32 s41, s58, 939008
    buffer_load_dwordx4 v16, s[8:11], s41 offen offset:3072 nt lds
    ds_write_b64 v70, v[32:33] offset:13312
    v_add_u32 v28, 110592, v24
    v_add_u32 v29, 110592, v25
    v_add_u32 v30, 110592, v26
    v_add_u32 v31, 110592, v27
    ds_read_b64_tr_b16 a[102:103], v28 offset:0
    ds_read_b64_tr_b16 a[110:111], v28 offset:8
    ds_read_b64_tr_b16 a[118:119], v29 offset:0
    ds_read_b64_tr_b16 a[126:127], v29 offset:8
    ds_read_b64_tr_b16 a[134:135], v30 offset:0
    ds_read_b64_tr_b16 a[142:143], v30 offset:8
    ds_read_b64_tr_b16 a[150:151], v31 offset:0
    ds_read_b64_tr_b16 v[0:1], v31 offset:8
    s_waitcnt vmcnt(12) lgkmcnt(0)
    s_barrier
    s_add_u32 m0, s43, 110592
    s_add_u32 s41, s59, 0
    buffer_load_dwordx4 v17, s[8:11], s41 offen offset:0 nt lds
    s_add_u32 s41, s59, 31744
    buffer_load_dwordx4 v17, s[8:11], s41 offen offset:1024 nt lds
    s_add_u32 s41, s59, 129024
    buffer_load_dwordx4 v17, s[8:11], s41 offen offset:2048 nt lds
    s_add_u32 s41, s59, 160768
    buffer_load_dwordx4 v17, s[8:11], s41 offen offset:3072 nt lds
    ds_write_b64 v70, v[0:1] offset:13320
    v_add_u32 v28, 147456, v24
    v_add_u32 v29, 147456, v25
    v_add_u32 v30, 147456, v26
    v_add_u32 v31, 147456, v27
    ds_read_b64_tr_b16 a[152:153], v28 offset:0
    ds_read_b64_tr_b16 a[160:161], v28 offset:8
    ds_read_b64_tr_b16 v[32:33], v29 offset:0
    ds_read_b64_tr_b16 a[168:169], v29 offset:8
    ds_read_b64_tr_b16 a[176:177], v30 offset:0
    ds_read_b64_tr_b16 a[184:185], v30 offset:8
    ds_read_b64_tr_b16 v[34:35], v31 offset:0
    ds_read_b64_tr_b16 a[192:193], v31 offset:8
    s_waitcnt vmcnt(12) lgkmcnt(0)
    s_barrier
    s_mov_b64 s[8:9], s[50:51]
    s_add_u32 m0, s43, 147456
    s_add_u32 s41, s58, 0
    buffer_load_dwordx4 v16, s[8:11], s41 offen offset:0 nt lds
    s_add_u32 s41, s58, 15360
    buffer_load_dwordx4 v16, s[8:11], s41 offen offset:1024 nt lds
    s_add_u32 s41, s58, 129024
    buffer_load_dwordx4 v16, s[8:11], s41 offen offset:2048 nt lds
    s_add_u32 s41, s58, 144384
    buffer_load_dwordx4 v16, s[8:11], s41 offen offset:3072 nt lds
    s_cmp_lg_u32 s13, 0
    s_cbranch_scc1 cf_ma
    v_mov_b32 v54, 1
    s_mov_b64 exec, 1
    buffer_atomic_add v54, off, s[84:87], 0 offset:132
    s_mov_b64 exec, -1
cf_ma:
    ds_write_b64 v70, v[32:33] offset:16384
    ds_write_b64 v70, v[34:35] offset:18432
    v_add_u32 v28, 0, v24
    v_add_u32 v29, 0, v25
    v_add_u32 v30, 0, v26
    v_add_u32 v31, 0, v27
    ds_read_b64_tr_b16 a[154:155], v28 offset:0
    ds_read_b64_tr_b16 a[162:163], v28 offset:8
    ds_read_b64_tr_b16 v[0:1], v29 offset:0
    ds_read_b64_tr_b16 a[170:171], v29 offset:8
    ds_read_b64_tr_b16 a[178:179], v30 offset:0
    ds_read_b64_tr_b16 a[186:187], v30 offset:8
    ds_read_b64_tr_b16 v[2:3], v31 offset:0
    ds_read_b64_tr_b16 a[194:195], v31 offset:8
    s_waitcnt vmcnt(12) lgkmcnt(0)
    s_barrier
    s_add_u32 m0, s43, 0
    s_add_u32 s41, s58, 8192
    buffer_load_dwordx4 v16, s[8:11], s41 offen offset:0 nt lds
    s_add_u32 s41, s58, 23552
    buffer_load_dwordx4 v16, s[8:11], s41 offen offset:1024 nt lds
    s_add_u32 s41, s58, 137216
    buffer_load_dwordx4 v16, s[8:11], s41 offen offset:2048 nt lds
    s_add_u32 s41, s58, 152576
    buffer_load_dwordx4 v16, s[8:11], s41 offen offset:3072 nt lds
    ds_write_b64 v70, v[0:1] offset:16392
    ds_write_b64 v70, v[2:3] offset:18440
    v_add_u32 v28, 36864, v24
    v_add_u32 v29, 36864, v25
    v_add_u32 v30, 36864, v26
    v_add_u32 v31, 36864, v27
    ds_read_b64_tr_b16 a[156:157], v28 offset:0
    ds_read_b64_tr_b16 a[164:165], v28 offset:8
    ds_read_b64_tr_b16 v[32:33], v29 offset:0
    ds_read_b64_tr_b16 a[172:173], v29 offset:8
    ds_read_b64_tr_b16 a[180:181], v30 offset:0
    ds_read_b64_tr_b16 a[188:189], v30 offset:8
    ds_read_b64_tr_b16 v[34:35], v31 offset:0
    ds_read_b64_tr_b16 a[196:197], v31 offset:8
    s_waitcnt vmcnt(12) lgkmcnt(0)
    s_barrier
    s_add_u32 m0, s43, 36864
    s_add_u32 s41, s58, 262144
    buffer_load_dwordx4 v16, s[8:11], s41 offen offset:0 nt lds
    s_add_u32 s41, s58, 277504
    buffer_load_dwordx4 v16, s[8:11], s41 offen offset:1024 nt lds
    s_add_u32 s41, s58, 391168
    buffer_load_dwordx4 v16, s[8:11], s41 offen offset:2048 nt lds
    s_add_u32 s41, s58, 406528
    buffer_load_dwordx4 v16, s[8:11], s41 offen offset:3072 nt lds
    ds_write_b64 v70, v[32:33] offset:17408
    ds_write_b64 v70, v[34:35] offset:19456
    v_add_u32 v28, 73728, v24
    v_add_u32 v29, 73728, v25
    v_add_u32 v30, 73728, v26
    v_add_u32 v31, 73728, v27
    ds_read_b64_tr_b16 a[158:159], v28 offset:0
    ds_read_b64_tr_b16 a[166:167], v28 offset:8
    ds_read_b64_tr_b16 v[0:1], v29 offset:0
    ds_read_b64_tr_b16 a[174:175], v29 offset:8
    ds_read_b64_tr_b16 a[182:183], v30 offset:0
    ds_read_b64_tr_b16 a[190:191], v30 offset:8
    ds_read_b64_tr_b16 v[2:3], v31 offset:0
    ds_read_b64_tr_b16 a[198:199], v31 offset:8
    s_waitcnt vmcnt(12) lgkmcnt(0)
    s_barrier
    s_add_u32 m0, s43, 73728
    s_add_u32 s41, s58, 270336
    buffer_load_dwordx4 v16, s[8:11], s41 offen offset:0 nt lds
    s_add_u32 s41, s58, 285696
    buffer_load_dwordx4 v16, s[8:11], s41 offen offset:1024 nt lds
    s_add_u32 s41, s58, 399360
    buffer_load_dwordx4 v16, s[8:11], s41 offen offset:2048 nt lds
    s_add_u32 s41, s58, 414720
    buffer_load_dwordx4 v16, s[8:11], s41 offen offset:3072 nt lds
    ds_write_b64 v70, v[0:1] offset:17416
    ds_write_b64 v70, v[2:3] offset:19464
    v_add_u32 v77, 110592, v20
    ds_read_b64_tr_b16 a[200:201], v77 offset:0
    ds_read_b64_tr_b16 a[202:203], v77 offset:4096
    ds_read_b64_tr_b16 a[204:205], v77 offset:8192
    ds_read_b64_tr_b16 a[206:207], v77 offset:12288
    ds_read_b64_tr_b16 a[208:209], v77 offset:8
    ds_read_b64_tr_b16 a[210:211], v77 offset:4104
    ds_read_b64_tr_b16 a[212:213], v77 offset:8200
    ds_read_b64_tr_b16 a[214:215], v77 offset:12296
    s_waitcnt vmcnt(12) lgkmcnt(0)
    s_barrier
    s_add_u32 m0, s43, 110592
    s_add_u32 s41, s58, 524288
    buffer_load_dwordx4 v16, s[8:11], s41 offen offset:0 nt lds
    s_add_u32 s41, s58, 539648
    buffer_load_dwordx4 v16, s[8:11], s41 offen offset:1024 nt lds
    s_add_u32 s41, s58, 653312
    buffer_load_dwordx4 v16, s[8:11], s41 offen offset:2048 nt lds
    s_add_u32 s41, s58, 668672
    buffer_load_dwordx4 v16, s[8:11], s41 offen offset:3072 nt lds
    v_add_u32 v28, 147456, v24
    v_add_u32 v29, 147456, v25
    v_add_u32 v30, 147456, v26
    v_add_u32 v31, 147456, v27
    ds_read_b64_tr_b16 v[0:1], v28 offset:0
    ds_read_b64_tr_b16 v[2:3], v28 offset:8
    ds_read_b64_tr_b16 v[4:5], v29 offset:0
    ds_read_b64_tr_b16 v[6:7], v29 offset:8
    ds_read_b64_tr_b16 a[0:1], v30 offset:0
    ds_read_b64_tr_b16 v[8:9], v30 offset:8
    ds_read_b64_tr_b16 a[8:9], v31 offset:0
    ds_read_b64_tr_b16 v[10:11], v31 offset:8
    s_waitcnt vmcnt(12) lgkmcnt(0)
    s_barrier
    s_add_u32 m0, s43, 147456
    s_add_u32 s41, s58, 532480
    buffer_load_dwordx4 v16, s[8:11], s41 offen offset:0 nt lds
    s_add_u32 s41, s58, 547840
    buffer_load_dwordx4 v16, s[8:11], s41 offen offset:1024 nt lds
    s_add_u32 s41, s58, 661504
    buffer_load_dwordx4 v16, s[8:11], s41 offen offset:2048 nt lds
    s_add_u32 s41, s58, 676864
    buffer_load_dwordx4 v16, s[8:11], s41 offen offset:3072 nt lds
    ds_write_b64 v70, v[0:1] offset:0
    ds_write_b64 v70, v[2:3] offset:2048
    ds_write_b64 v70, v[4:5] offset:4096
    ds_write_b64 v70, v[6:7] offset:6144
    ds_write_b64 v70, v[8:9] offset:10240
    ds_write_b64 v70, v[10:11] offset:14336
    v_add_u32 v28, 0, v24
    v_add_u32 v29, 0, v25
    v_add_u32 v30, 0, v26
    v_add_u32 v31, 0, v27
    ds_read_b64_tr_b16 v[32:33], v28 offset:0
    ds_read_b64_tr_b16 v[34:35], v28 offset:8
    ds_read_b64_tr_b16 v[36:37], v29 offset:0
    ds_read_b64_tr_b16 v[38:39], v29 offset:8
    ds_read_b64_tr_b16 a[2:3], v30 offset:0
    ds_read_b64_tr_b16 v[40:41], v30 offset:8
    ds_read_b64_tr_b16 a[10:11], v31 offset:0
    ds_read_b64_tr_b16 v[42:43], v31 offset:8
    s_waitcnt vmcnt(12) lgkmcnt(0)
    s_barrier
    s_add_u32 m0, s43, 0
    s_add_u32 s41, s58, 786432
    buffer_load_dwordx4 v16, s[8:11], s41 offen offset:0 nt lds
    s_add_u32 s41, s58, 801792
    buffer_load_dwordx4 v16, s[8:11], s41 offen offset:1024 nt lds
    s_add_u32 s41, s58, 915456
    buffer_load_dwordx4 v16, s[8:11], s41 offen offset:2048 nt lds
    s_add_u32 s41, s58, 930816
    buffer_load_dwordx4 v16, s[8:11], s41 offen offset:3072 nt lds
    ds_write_b64 v70, v[32:33] offset:8
    ds_write_b64 v70, v[34:35] offset:2056
    ds_write_b64 v70, v[36:37] offset:4104
    ds_write_b64 v70, v[38:39] offset:6152
    ds_write_b64 v70, v[40:41] offset:10248
    ds_write_b64 v70, v[42:43] offset:14344
    v_add_u32 v28, 36864, v24
    v_add_u32 v29, 36864, v25
    v_add_u32 v30, 36864, v26
    v_add_u32 v31, 36864, v27
    ds_read_b64_tr_b16 v[0:1], v28 offset:0
    ds_read_b64_tr_b16 v[2:3], v28 offset:8
    ds_read_b64_tr_b16 v[4:5], v29 offset:0
    ds_read_b64_tr_b16 v[6:7], v29 offset:8
    ds_read_b64_tr_b16 a[4:5], v30 offset:0
    ds_read_b64_tr_b16 v[8:9], v30 offset:8
    ds_read_b64_tr_b16 a[12:13], v31 offset:0
    ds_read_b64_tr_b16 v[10:11], v31 offset:8
    s_waitcnt vmcnt(12) lgkmcnt(0)
    s_barrier
    s_add_u32 m0, s43, 36864
    s_add_u32 s41, s58, 794624
    buffer_load_dwordx4 v16, s[8:11], s41 offen offset:0 nt lds
    s_add_u32 s41, s58, 809984
    buffer_load_dwordx4 v16, s[8:11], s41 offen offset:1024 nt lds
    s_add_u32 s41, s58, 923648
    buffer_load_dwordx4 v16, s[8:11], s41 offen offset:2048 nt lds
    s_add_u32 s41, s58, 939008
    buffer_load_dwordx4 v16, s[8:11], s41 offen offset:3072 nt lds
    ds_write_b64 v70, v[0:1] offset:1024
    ds_write_b64 v70, v[2:3] offset:3072
    ds_write_b64 v70, v[4:5] offset:5120
    ds_write_b64 v70, v[6:7] offset:7168
    ds_write_b64 v70, v[8:9] offset:11264
    ds_write_b64 v70, v[10:11] offset:15360
    v_add_u32 v28, 73728, v24
    v_add_u32 v29, 73728, v25
    v_add_u32 v30, 73728, v26
    v_add_u32 v31, 73728, v27
    ds_read_b64_tr_b16 v[32:33], v28 offset:0
    ds_read_b64_tr_b16 v[34:35], v28 offset:8
    ds_read_b64_tr_b16 v[36:37], v29 offset:0
    ds_read_b64_tr_b16 v[38:39], v29 offset:8
    ds_read_b64_tr_b16 a[6:7], v30 offset:0
    ds_read_b64_tr_b16 v[40:41], v30 offset:8
    ds_read_b64_tr_b16 a[14:15], v31 offset:0
    ds_read_b64_tr_b16 v[42:43], v31 offset:8
    s_waitcnt vmcnt(12) lgkmcnt(0)
    s_barrier
    s_add_u32 m0, s43, 73728
    s_add_u32 s41, s59, 0
    buffer_load_dwordx4 v17, s[8:11], s41 offen offset:0 nt lds
    s_add_u32 s41, s59, 31744
    buffer_load_dwordx4 v17, s[8:11], s41 offen offset:1024 nt lds
    s_add_u32 s41, s59, 129024
    buffer_load_dwordx4 v17, s[8:11], s41 offen offset:2048 nt lds
    s_add_u32 s41, s59, 160768
    buffer_load_dwordx4 v17, s[8:11], s41 offen offset:3072 nt lds
    ds_write_b64 v70, v[32:33] offset:1032
    ds_write_b64 v70, v[34:35] offset:3080
    ds_write_b64 v70, v[36:37] offset:5128
    ds_write_b64 v70, v[38:39] offset:7176
    ds_write_b64 v70, v[40:41] offset:11272
    ds_write_b64 v70, v[42:43] offset:15368
    v_add_u32 v28, 110592, v24
    v_add_u32 v29, 110592, v25
    v_add_u32 v30, 110592, v26
    v_add_u32 v31, 110592, v27
    ds_read_b64_tr_b16 a[16:17], v28 offset:0
    ds_read_b64_tr_b16 a[24:25], v28 offset:8
    ds_read_b64_tr_b16 a[32:33], v29 offset:0
    ds_read_b64_tr_b16 a[40:41], v29 offset:8
    ds_read_b64_tr_b16 a[48:49], v30 offset:0
    ds_read_b64_tr_b16 a[56:57], v30 offset:8
    ds_read_b64_tr_b16 a[64:65], v31 offset:0
    ds_read_b64_tr_b16 a[72:73], v31 offset:8
    s_waitcnt vmcnt(12) lgkmcnt(0)
    s_barrier
    s_mov_b64 s[8:9], s[54:55]
    s_add_u32 m0, s43, 110592
    s_add_u32 s41, s58, 0
    buffer_load_dwordx4 v16, s[8:11], s41 offen offset:0 nt lds
    s_add_u32 s41, s58, 15360
    buffer_load_dwordx4 v16, s[8:11], s41 offen offset:1024 nt lds
    s_add_u32 s41, s58, 129024
    buffer_load_dwordx4 v16, s[8:11], s41 offen offset:2048 nt lds
    s_add_u32 s41, s58, 144384
    buffer_load_dwordx4 v16, s[8:11], s41 offen offset:3072 nt lds
    v_add_u32 v28, 147456, v24
    v_add_u32 v29, 147456, v25
    v_add_u32 v30, 147456, v26
    v_add_u32 v31, 147456, v27
    ds_read_b64_tr_b16 a[18:19], v28 offset:0
    ds_read_b64_tr_b16 a[26:27], v28 offset:8
    ds_read_b64_tr_b16 a[34:35], v29 offset:0
    ds_read_b64_tr_b16 a[42:43], v29 offset:8
    ds_read_b64_tr_b16 a[50:51], v30 offset:0
    ds_read_b64_tr_b16 a[58:59], v30 offset:8
    ds_read_b64_tr_b16 a[66:67], v31 offset:0
    ds_read_b64_tr_b16 a[74:75], v31 offset:8
    s_waitcnt vmcnt(12) lgkmcnt(0)
    s_barrier
    s_add_u32 m0, s43, 147456
    s_add_u32 s41, s58, 8192
    buffer_load_dwordx4 v16, s[8:11], s41 offen offset:0 nt lds
    s_add_u32 s41, s58, 23552
    buffer_load_dwordx4 v16, s[8:11], s41 offen offset:1024 nt lds
    s_add_u32 s41, s58, 137216
    buffer_load_dwordx4 v16, s[8:11], s41 offen offset:2048 nt lds
    s_add_u32 s41, s58, 152576
    buffer_load_dwordx4 v16, s[8:11], s41 offen offset:3072 nt lds
    v_add_u32 v28, 0, v24
    v_add_u32 v29, 0, v25
    v_add_u32 v30, 0, v26
    v_add_u32 v31, 0, v27
    ds_read_b64_tr_b16 a[20:21], v28 offset:0
    ds_read_b64_tr_b16 a[28:29], v28 offset:8
    ds_read_b64_tr_b16 a[36:37], v29 offset:0
    ds_read_b64_tr_b16 a[44:45], v29 offset:8
    ds_read_b64_tr_b16 a[52:53], v30 offset:0
    ds_read_b64_tr_b16 a[60:61], v30 offset:8
    ds_read_b64_tr_b16 a[68:69], v31 offset:0
    ds_read_b64_tr_b16 a[76:77], v31 offset:8
    s_waitcnt vmcnt(12) lgkmcnt(0)
    s_barrier
    s_add_u32 m0, s43, 0
    s_add_u32 s41, s58, 262144
    buffer_load_dwordx4 v16, s[8:11], s41 offen offset:0 nt lds
    s_add_u32 s41, s58, 277504
    buffer_load_dwordx4 v16, s[8:11], s41 offen offset:1024 nt lds
    s_add_u32 s41, s58, 391168
    buffer_load_dwordx4 v16, s[8:11], s41 offen offset:2048 nt lds
    s_add_u32 s41, s58, 406528
    buffer_load_dwordx4 v16, s[8:11], s41 offen offset:3072 nt lds
    v_add_u32 v28, 36864, v24
    v_add_u32 v29, 36864, v25
    v_add_u32 v30, 36864, v26
    v_add_u32 v31, 36864, v27
    ds_read_b64_tr_b16 a[22:23], v28 offset:0
    ds_read_b64_tr_b16 a[30:31], v28 offset:8
    ds_read_b64_tr_b16 a[38:39], v29 offset:0
    ds_read_b64_tr_b16 a[46:47], v29 offset:8
    ds_read_b64_tr_b16 a[54:55], v30 offset:0
    ds_read_b64_tr_b16 a[62:63], v30 offset:8
    ds_read_b64_tr_b16 a[70:71], v31 offset:0
    ds_read_b64_tr_b16 a[78:79], v31 offset:8
    s_waitcnt vmcnt(12) lgkmcnt(0)
    s_barrier
    s_add_u32 m0, s43, 36864
    s_add_u32 s41, s58, 270336
    buffer_load_dwordx4 v16, s[8:11], s41 offen offset:0 nt lds
    s_add_u32 s41, s58, 285696
    buffer_load_dwordx4 v16, s[8:11], s41 offen offset:1024 nt lds
    s_add_u32 s41, s58, 399360
    buffer_load_dwordx4 v16, s[8:11], s41 offen offset:2048 nt lds
    s_add_u32 s41, s58, 414720
    buffer_load_dwordx4 v16, s[8:11], s41 offen offset:3072 nt lds
    s_lshl_b32 s26, s12, 14
    s_add_u32 s26, s26, 0
    s_mul_i32 s40, s13, 3072
    s_add_u32 s24, s26, s40
    s_lshl_b32 s96, s12, 7
    s_add_u32 s29, s96, 125845504
    s_add_u32 s96, s96, 125829120
    v_bfe_u32 v78, v65, 2, 5
    buffer_load_dword v54, off, s[84:87], 0 offset:132 sc1
    buffer_load_dword v55, off, s[84:87], 0 offset:216 sc1
    buffer_load_dword v56, v78, s[4:7], s96 offen offset:16 sc1
    v_add_u32 v77, 73728, v20
    ds_read_b64_tr_b16 a[80:81], v77 offset:0
    ds_read_b64_tr_b16 a[82:83], v77 offset:4096
    ds_read_b64_tr_b16 a[84:85], v77 offset:8192
    ds_read_b64_tr_b16 a[86:87], v77 offset:12288
    ds_read_b64_tr_b16 a[88:89], v77 offset:8
    ds_read_b64_tr_b16 a[90:91], v77 offset:4104
    ds_read_b64_tr_b16 a[92:93], v77 offset:8200
    ds_read_b64_tr_b16 a[94:95], v77 offset:12296
    s_waitcnt vmcnt(12) lgkmcnt(0)
    s_barrier
    s_add_u32 m0, s43, 73728
    s_add_u32 s41, s58, 524288
    buffer_load_dwordx4 v16, s[8:11], s41 offen offset:0 nt lds
    s_add_u32 s41, s58, 539648
    buffer_load_dwordx4 v16, s[8:11], s41 offen offset:1024 nt lds
    s_add_u32 s41, s58, 653312
    buffer_load_dwordx4 v16, s[8:11], s41 offen offset:2048 nt lds
    s_add_u32 s41, s58, 668672
    buffer_load_dwordx4 v16, s[8:11], s41 offen offset:3072 nt lds
    v_add_u32 v28, 110592, v24
    v_add_u32 v29, 110592, v25
    v_add_u32 v30, 110592, v26
    v_add_u32 v31, 110592, v27
    ds_read_b64_tr_b16 a[216:217], v28 offset:0
    ds_read_b64_tr_b16 v[32:33], v28 offset:8
    ds_read_b64_tr_b16 a[224:225], v29 offset:0
    ds_read_b64_tr_b16 a[232:233], v29 offset:8
    ds_read_b64_tr_b16 a[240:241], v30 offset:0
    ds_read_b64_tr_b16 a[248:249], v30 offset:8
    ds_read_b64_tr_b16 v[160:161], v31 offset:0
    ds_read_b64_tr_b16 v[168:169], v31 offset:8
    s_waitcnt vmcnt(12) lgkmcnt(0)
    s_barrier
    s_add_u32 m0, s43, 110592
    s_add_u32 s41, s58, 532480
    buffer_load_dwordx4 v16, s[8:11], s41 offen offset:0 nt lds
    s_add_u32 s41, s58, 547840
    buffer_load_dwordx4 v16, s[8:11], s41 offen offset:1024 nt lds
    s_add_u32 s41, s58, 661504
    buffer_load_dwordx4 v16, s[8:11], s41 offen offset:2048 nt lds
    s_add_u32 s41, s58, 676864
    buffer_load_dwordx4 v16, s[8:11], s41 offen offset:3072 nt lds
    ds_write_b64 v70, v[32:33] offset:8192
    v_add_u32 v28, 147456, v24
    v_add_u32 v29, 147456, v25
    v_add_u32 v30, 147456, v26
    v_add_u32 v31, 147456, v27
    ds_read_b64_tr_b16 a[218:219], v28 offset:0
    ds_read_b64_tr_b16 v[0:1], v28 offset:8
    ds_read_b64_tr_b16 a[226:227], v29 offset:0
    ds_read_b64_tr_b16 a[234:235], v29 offset:8
    ds_read_b64_tr_b16 a[242:243], v30 offset:0
    ds_read_b64_tr_b16 a[250:251], v30 offset:8
    ds_read_b64_tr_b16 v[162:163], v31 offset:0
    ds_read_b64_tr_b16 v[170:171], v31 offset:8
    s_waitcnt vmcnt(12) lgkmcnt(0)
    s_barrier
    s_add_u32 m0, s43, 147456
    s_add_u32 s41, s58, 786432
    buffer_load_dwordx4 v16, s[8:11], s41 offen offset:0 nt lds
    s_add_u32 s41, s58, 801792
    buffer_load_dwordx4 v16, s[8:11], s41 offen offset:1024 nt lds
    s_add_u32 s41, s58, 915456
    buffer_load_dwordx4 v16, s[8:11], s41 offen offset:2048 nt lds
    s_add_u32 s41, s58, 930816
    buffer_load_dwordx4 v16, s[8:11], s41 offen offset:3072 nt lds
    ds_write_b64 v70, v[0:1] offset:8200
    v_add_u32 v28, 0, v24
    v_add_u32 v29, 0, v25
    v_add_u32 v30, 0, v26
    v_add_u32 v31, 0, v27
    ds_read_b64_tr_b16 a[220:221], v28 offset:0
    ds_read_b64_tr_b16 v[32:33], v28 offset:8
    ds_read_b64_tr_b16 a[228:229], v29 offset:0
    ds_read_b64_tr_b16 a[236:237], v29 offset:8
    ds_read_b64_tr_b16 a[244:245], v30 offset:0
    ds_read_b64_tr_b16 a[252:253], v30 offset:8
    ds_read_b64_tr_b16 v[164:165], v31 offset:0
    ds_read_b64_tr_b16 v[172:173], v31 offset:8
    s_waitcnt vmcnt(12) lgkmcnt(0)
    s_barrier
    s_add_u32 m0, s43, 0
    s_add_u32 s41, s58, 794624
    buffer_load_dwordx4 v16, s[8:11], s41 offen offset:0 nt lds
    s_add_u32 s41, s58, 809984
    buffer_load_dwordx4 v16, s[8:11], s41 offen offset:1024 nt lds
    s_add_u32 s41, s58, 923648
    buffer_load_dwordx4 v16, s[8:11], s41 offen offset:2048 nt lds
    s_add_u32 s41, s58, 939008
    buffer_load_dwordx4 v16, s[8:11], s41 offen offset:3072 nt lds
    ds_write_b64 v70, v[32:33] offset:9216
    v_add_u32 v28, 36864, v24
    v_add_u32 v29, 36864, v25
    v_add_u32 v30, 36864, v26
    v_add_u32 v31, 36864, v27
    ds_read_b64_tr_b16 a[222:223], v28 offset:0
    ds_read_b64_tr_b16 v[0:1], v28 offset:8
    ds_read_b64_tr_b16 a[230:231], v29 offset:0
    ds_read_b64_tr_b16 a[238:239], v29 offset:8
    ds_read_b64_tr_b16 a[246:247], v30 offset:0
    ds_read_b64_tr_b16 a[254:255], v30 offset:8
    ds_read_b64_tr_b16 v[166:167], v31 offset:0
    ds_read_b64_tr_b16 v[174:175], v31 offset:8
    s_waitcnt vmcnt(12) lgkmcnt(0)
    s_barrier
    s_add_u32 m0, s43, 36864
    s_add_u32 s41, s59, 0
    buffer_load_dwordx4 v17, s[8:11], s41 offen offset:0 nt lds
    s_add_u32 s41, s59, 31744
    buffer_load_dwordx4 v17, s[8:11], s41 offen offset:1024 nt lds
    s_add_u32 s41, s59, 129024
    buffer_load_dwordx4 v17, s[8:11], s41 offen offset:2048 nt lds
    s_add_u32 s41, s59, 160768
    buffer_load_dwordx4 v17, s[8:11], s41 offen offset:3072 nt lds
    v_readfirstlane_b32 s94, v54
    v_readfirstlane_b32 s95, v55
    v_mov_b32 v77, v56
    s_nop 0
    v_subrev_u32 v77, s95, v77
    v_cmp_lt_u32 vcc, 16, v77
    s_nop 1
    v_cndmask_b32 v77, v77, 0, vcc
    v_bfe_u32 v79, v78, 2, 2
    v_lshl_add_u32 v77, v77, 2, v79
    s_nop 1
    v_min_u32_dpp v77, v77, v77 row_ror:1 row_mask:0xf bank_mask:0xf
    s_nop 1
    v_min_u32_dpp v77, v77, v77 row_ror:2 row_mask:0xf bank_mask:0xf
    s_nop 1
    v_min_u32_dpp v77, v77, v77 row_ror:4 row_mask:0xf bank_mask:0xf
    s_nop 0
    v_readfirstlane_b32 s97, v77
    s_cmp_eq_u32 s95, 0
    s_cselect_b32 s97, 0, s97
    s_cmp_lt_u32 s97, 3
    s_cbranch_scc1 cf_mb
    s_add_u32 s40, s24, 0
    s_add_u32 s40, s40, s33
    s_sub_u32 s41, s96, s40
    v_bfe_u32 v77, v65, 2, 5
    v_add3_u32 v77, v77, s41, 16
    v_lshlrev_b32 v78, 3, v69
    s_nop 0
    v_mov_b32_dpp v78, v77 quad_perm:[0,1,2,3] row_mask:0xc bank_mask:0xf
    buffer_load_dword v58, v78, s[4:7], s40 offen sc1
    s_add_u32 s40, s24, 524288
    s_add_u32 s40, s40, s33
    s_sub_u32 s41, s96, s40
    v_bfe_u32 v77, v65, 2, 5
    v_add3_u32 v77, v77, s41, 16
    v_lshlrev_b32 v78, 3, v69
    s_nop 0
    v_mov_b32_dpp v78, v77 quad_perm:[0,1,2,3] row_mask:0xc bank_mask:0xf
    buffer_load_dword v58, v78, s[4:7], s40 offen sc1
cf_mb:
    s_cmp_lt_u32 s94, 32
    s_cbranch_scc1 cf_mc
    s_cmp_lg_u32 s13, 0
    s_cbranch_scc1 cf_mc
    v_mov_b32 v76, 1
    v_mov_b32 v77, 0
    s_mov_b64 exec, 1
    buffer_atomic_cmpswap v[76:77], off, s[84:87], 0 offset:28 sc0
    s_mov_b64 exec, -1
cf_mc:
    s_nop 1
    ds_write_b64 v70, v[0:1] offset:9224
    v_add_u32 v28, 73728, v24
    v_add_u32 v29, 73728, v25
    v_add_u32 v30, 73728, v26
    v_add_u32 v31, 73728, v27
    ds_read_b64_tr_b16 v[176:177], v28 offset:0
    ds_read_b64_tr_b16 v[184:185], v28 offset:8
    ds_read_b64_tr_b16 v[192:193], v29 offset:0
    ds_read_b64_tr_b16 v[200:201], v29 offset:8
    ds_read_b64_tr_b16 v[208:209], v30 offset:0
    ds_read_b64_tr_b16 v[216:217], v30 offset:8
    ds_read_b64_tr_b16 v[224:225], v31 offset:0
    ds_read_b64_tr_b16 v[232:233], v31 offset:8
    s_waitcnt vmcnt(12) lgkmcnt(0)
    s_barrier
    s_mov_b64 s[8:9], s[56:57]
    s_add_u32 m0, s43, 73728
    s_add_u32 s41, s60, 128
    buffer_load_dwordx4 v18, s[8:11], s41 offen offset:0 nt lds
    s_add_u32 s41, s60, 8320
    buffer_load_dwordx4 v18, s[8:11], s41 offen offset:1024 nt lds
    s_add_u32 s41, s60, 16512
    buffer_load_dwordx4 v18, s[8:11], s41 offen offset:2048 nt lds
    s_add_u32 s41, s60, 24704
    buffer_load_dwordx4 v18, s[8:11], s41 offen offset:3072 nt lds
    v_add_u32 v28, 110592, v24
    v_add_u32 v29, 110592, v25
    v_add_u32 v30, 110592, v26
    v_add_u32 v31, 110592, v27
    ds_read_b64_tr_b16 v[178:179], v28 offset:0
    ds_read_b64_tr_b16 v[186:187], v28 offset:8
    ds_read_b64_tr_b16 v[194:195], v29 offset:0
    ds_read_b64_tr_b16 v[202:203], v29 offset:8
    ds_read_b64_tr_b16 v[210:211], v30 offset:0
    ds_read_b64_tr_b16 v[218:219], v30 offset:8
    ds_read_b64_tr_b16 v[226:227], v31 offset:0
    ds_read_b64_tr_b16 v[234:235], v31 offset:8
    s_waitcnt vmcnt(12) lgkmcnt(0)
    s_barrier
    s_add_u32 m0, s43, 110592
    s_add_u32 s41, s61, 128
    buffer_load_dwordx4 v18, s[8:11], s41 offen offset:0 nt lds
    s_add_u32 s41, s61, 8320
    buffer_load_dwordx4 v18, s[8:11], s41 offen offset:1024 nt lds
    s_add_u32 s41, s61, 16512
    buffer_load_dwordx4 v18, s[8:11], s41 offen offset:2048 nt lds
    s_add_u32 s41, s61, 24704
    buffer_load_dwordx4 v18, s[8:11], s41 offen offset:3072 nt lds
    v_add_u32 v28, 147456, v24
    v_add_u32 v29, 147456, v25
    v_add_u32 v30, 147456, v26
    v_add_u32 v31, 147456, v27
    ds_read_b64_tr_b16 v[180:181], v28 offset:0
    ds_read_b64_tr_b16 v[188:189], v28 offset:8
    ds_read_b64_tr_b16 v[196:197], v29 offset:0
    ds_read_b64_tr_b16 v[204:205], v29 offset:8
    ds_read_b64_tr_b16 v[212:213], v30 offset:0
    ds_read_b64_tr_b16 v[220:221], v30 offset:8
    ds_read_b64_tr_b16 v[228:229], v31 offset:0
    ds_read_b64_tr_b16 v[236:237], v31 offset:8
    s_waitcnt vmcnt(12) lgkmcnt(0)
    s_barrier
    s_add_u32 m0, s43, 147456
    s_add_u32 s41, s62, 128
    buffer_load_dwordx4 v18, s[8:11], s41 offen offset:0 nt lds
    s_add_u32 s41, s62, 8320
    buffer_load_dwordx4 v18, s[8:11], s41 offen offset:1024 nt lds
    s_add_u32 s41, s62, 16512
    buffer_load_dwordx4 v18, s[8:11], s41 offen offset:2048 nt lds
    s_add_u32 s41, s62, 24704
    buffer_load_dwordx4 v18, s[8:11], s41 offen offset:3072 nt lds
    v_add_u32 v28, 0, v24
    v_add_u32 v29, 0, v25
    v_add_u32 v30, 0, v26
    v_add_u32 v31, 0, v27
    ds_read_b64_tr_b16 v[182:183], v28 offset:0
    ds_read_b64_tr_b16 v[190:191], v28 offset:8
    ds_read_b64_tr_b16 v[198:199], v29 offset:0
    ds_read_b64_tr_b16 v[206:207], v29 offset:8
    ds_read_b64_tr_b16 v[214:215], v30 offset:0
    ds_read_b64_tr_b16 v[222:223], v30 offset:8
    ds_read_b64_tr_b16 v[230:231], v31 offset:0
    ds_read_b64_tr_b16 v[238:239], v31 offset:8
    s_waitcnt vmcnt(12) lgkmcnt(0)
    s_barrier
    s_add_u32 m0, s43, 0
    s_add_u32 s41, s63, 128
    buffer_load_dwordx4 v18, s[8:11], s41 offen offset:0 nt lds
    s_add_u32 s41, s63, 8320
    buffer_load_dwordx4 v18, s[8:11], s41 offen offset:1024 nt lds
    s_add_u32 s41, s63, 16512
    buffer_load_dwordx4 v18, s[8:11], s41 offen offset:2048 nt lds
    s_add_u32 s41, s63, 24704
    buffer_load_dwordx4 v18, s[8:11], s41 offen offset:3072 nt lds
    v_mov_b32 v78, v21
    v_mov_b32 v79, v22
    v_add_u32 v77, 36864, v20
    ds_read_b64_tr_b16 v[240:241], v77 offset:0
    ds_read_b64_tr_b16 v[242:243], v77 offset:4096
    ds_read_b64_tr_b16 v[244:245], v77 offset:8192
    ds_read_b64_tr_b16 v[246:247], v77 offset:12288
    ds_read_b64_tr_b16 v[248:249], v77 offset:8
    ds_read_b64_tr_b16 v[250:251], v77 offset:4104
    ds_read_b64_tr_b16 v[252:253], v77 offset:8200
    ds_read_b64_tr_b16 v[254:255], v77 offset:12296
    s_waitcnt vmcnt(12) lgkmcnt(0)
    s_barrier
    v_add_u32 v77, 73728, v79
    s_waitcnt lgkmcnt(0)
    ds_read_b64_tr_b16 v[0:1], v77 offset:0
    ds_read_b64_tr_b16 v[2:3], v77 offset:256
    ds_read_b64_tr_b16 v[4:5], v77 offset:2048
    ds_read_b64_tr_b16 v[6:7], v77 offset:2304
    ds_read_b64_tr_b16 v[8:9], v77 offset:8
    ds_read_b64_tr_b16 v[10:11], v77 offset:264
    ds_read_b64_tr_b16 v[12:13], v77 offset:2056
    ds_read_b64_tr_b16 v[14:15], v77 offset:2312
    s_waitcnt vmcnt(8) lgkmcnt(0)
    s_barrier
    v_add_u32 v77, 110592, v78
    ds_read_b64_tr_b16 v[16:17], v77 offset:0
    ds_read_b64_tr_b16 v[18:19], v77 offset:256
    ds_read_b64_tr_b16 v[20:21], v77 offset:2048
    ds_read_b64_tr_b16 v[22:23], v77 offset:2304
    ds_read_b64_tr_b16 v[24:25], v77 offset:8
    ds_read_b64_tr_b16 v[26:27], v77 offset:264
    ds_read_b64_tr_b16 v[28:29], v77 offset:2056
    ds_read_b64_tr_b16 v[30:31], v77 offset:2312
    s_waitcnt vmcnt(4) lgkmcnt(0)
    s_barrier
    v_add_u32 v77, 147456, v78
    ds_read_b64_tr_b16 v[32:33], v77 offset:0
    ds_read_b64_tr_b16 v[34:35], v77 offset:256
    ds_read_b64_tr_b16 v[36:37], v77 offset:2048
    ds_read_b64_tr_b16 v[38:39], v77 offset:2304
    ds_read_b64_tr_b16 v[40:41], v77 offset:8
    ds_read_b64_tr_b16 v[42:43], v77 offset:264
    ds_read_b64_tr_b16 v[44:45], v77 offset:2056
    ds_read_b64_tr_b16 v[46:47], v77 offset:2312
    s_waitcnt vmcnt(0) lgkmcnt(0)
    s_barrier
    v_add_u32 v77, 0, v78
    ds_read_b64_tr_b16 v[48:49], v77 offset:0
    ds_read_b64_tr_b16 v[50:51], v77 offset:256
    ds_read_b64_tr_b16 v[52:53], v77 offset:2048
    ds_read_b64_tr_b16 v[54:55], v77 offset:2304
    ds_read_b64_tr_b16 v[56:57], v77 offset:8
    ds_read_b64_tr_b16 v[58:59], v77 offset:264
    ds_read_b64_tr_b16 v[60:61], v77 offset:2056
    ds_read_b64_tr_b16 v[62:63], v77 offset:2312
    s_waitcnt lgkmcnt(0)
    s_barrier
    ds_write_b128 v70, v[0:3] offset:20480
    ds_write_b128 v70, v[4:7] offset:21504
    ds_write_b128 v70, v[8:11] offset:22528
    ds_write_b128 v70, v[12:15] offset:23552
    ds_write_b128 v70, v[16:19] offset:24576
    ds_write_b128 v70, v[20:23] offset:25600
    ds_write_b128 v70, v[24:27] offset:26624
    ds_write_b128 v70, v[28:31] offset:27648
    ds_write_b128 v70, v[32:35] offset:28672
    ds_write_b128 v70, v[36:39] offset:29696
    ds_write_b128 v70, v[40:43] offset:30720
    ds_write_b128 v70, v[44:47] offset:31744
    ds_write_b128 v70, v[48:51] offset:32768
    ds_write_b128 v70, v[52:55] offset:33792
    ds_write_b128 v70, v[56:59] offset:34816
    ds_write_b128 v70, v[60:63] offset:35840
    s_waitcnt lgkmcnt(0)
    v_bfe_u32 v60, v65, 4, 6
    v_and_b32 v61, 15, v60
    v_lshrrev_b32 v62, 4, v60
    v_mov_b32 v50, 0x3f80
    v_mov_b32 v51, 0x3f800000
    v_and_b32 v77, 1, v62
    v_lshlrev_b32 v77, 2, v77
    v_sub_u32 v77, v61, v77
    v_and_b32 v78, 3, v61
    v_lshlrev_b32 v78, 2, v78
    v_lshrrev_b32 v79, 2, v61
    v_add_u32 v78, v78, v79
    v_cmp_eq_u32 vcc, 0, v77
    s_nop 1
    v_cndmask_b32 v8, 0, v50, vcc
    v_cmp_eq_u32 vcc, 1, v77
    s_nop 1
    v_cndmask_b32 v8, v8, v51, vcc
    v_cmp_eq_u32 vcc, 0, v78
    s_nop 1
    v_cndmask_b32 v12, 0, v50, vcc
    v_cmp_eq_u32 vcc, 1, v78
    s_nop 1
    v_cndmask_b32 v12, v12, v51, vcc
    v_cmp_eq_u32 vcc, 2, v77
    s_nop 1
    v_cndmask_b32 v9, 0, v50, vcc
    v_cmp_eq_u32 vcc, 3, v77
    s_nop 1
    v_cndmask_b32 v9, v9, v51, vcc
    v_cmp_eq_u32 vcc, 2, v78
    s_nop 1
    v_cndmask_b32 v13, 0, v50, vcc
    v_cmp_eq_u32 vcc, 3, v78
    s_nop 1
    v_cndmask_b32 v13, v13, v51, vcc
    v_cmp_eq_u32 vcc, 8, v77
    s_nop 1
    v_cndmask_b32 v10, 0, v50, vcc
    v_cmp_eq_u32 vcc, 9, v77
    s_nop 1
    v_cndmask_b32 v10, v10, v51, vcc
    v_cmp_eq_u32 vcc, 4, v78
    s_nop 1
    v_cndmask_b32 v14, 0, v50, vcc
    v_cmp_eq_u32 vcc, 5, v78
    s_nop 1
    v_cndmask_b32 v14, v14, v51, vcc
    v_cmp_eq_u32 vcc, 10, v77
    s_nop 1
    v_cndmask_b32 v11, 0, v50, vcc
    v_cmp_eq_u32 vcc, 11, v77
    s_nop 1
    v_cndmask_b32 v11, v11, v51, vcc
    v_cmp_eq_u32 vcc, 6, v78
    s_nop 1
    v_cndmask_b32 v15, 0, v50, vcc
    v_cmp_eq_u32 vcc, 7, v78
    s_nop 1
    v_cndmask_b32 v15, v15, v51, vcc
    v_lshlrev_b32 v77, 4, v61
    ds_write_b128 v69, v[8:11] offset:15360
    ds_write_b128 v77, v[12:15] offset:15872
    s_waitcnt vmcnt(0) lgkmcnt(0)
    s_cmp_lg_u32 s95, 0
    s_cbranch_scc1 cf_hn
    s_mov_b32 s88, 4194304
gn2:
    buffer_load_dword v2, off, s[84:87], 0 offset:216 sc1
    s_waitcnt vmcnt(0)
    v_readfirstlane_b32 s95, v2
    s_sub_u32 s88, s88, 1
    s_cbranch_scc1 gn2x
    s_cmp_eq_u32 s95, 0
    s_cbranch_scc1 gn2
gn2x:
cf_hn:
    v_mov_b32 v2, 1
    s_cmp_lg_u32 s13, 0
    s_cbranch_scc1 cf_noarr
    s_mov_b64 exec, 1
    s_mov_b32 s42, 1
    v_mov_b32 v4, v76
    s_cmp_ge_u32 s94, 32
    s_cbranch_scc1 cf_have
    s_mov_b32 s40, 131072
    s_mov_b32 s42, 2
cf_startpoll:
    buffer_load_dword v3, off, s[84:87], 0 offset:132 sc1
    s_sub_u32 s40, s40, 1
    s_cbranch_scc1 cf_decide
    s_waitcnt vmcnt(0)
    v_readfirstlane_b32 s41, v3
    s_nop 1
    s_cmp_lt_u32 s41, 32
    s_cbranch_scc1 cf_startpoll
    s_mov_b32 s42, 1
cf_decide:
    v_mov_b32 v4, s42
    v_mov_b32 v5, 0
    buffer_atomic_cmpswap v[4:5], off, s[84:87], 0 offset:28 sc0
    s_waitcnt vmcnt(0)
cf_have:
    v_mov_b32 v5, s42
    v_cmp_eq_u32 vcc, 0, v4
    s_nop 1
    v_cndmask_b32 v4, v4, v5, vcc
    v_mov_b32 v5, 16192
    ds_write_b32 v5, v4
    s_waitcnt lgkmcnt(0)
    s_mov_b64 exec, -1
cf_noarr:
    s_barrier
    v_mov_b32 v5, 16192
    ds_read_b32 v4, v5
    s_waitcnt lgkmcnt(0)
    v_readfirstlane_b32 s41, v4
    s_nop 1
    s_cmp_eq_u32 s41, 1
    s_cbranch_scc1 cf_run
    v_lshrrev_b32 v0, 4, v65
    s_mov_b32 s32, s13
    s_load_dwordx16 s[48:63], s[0:1], 0
    s_waitcnt lgkmcnt(0)
    s_branch L_helper
cf_run:
    s_mov_b32 s44, 0x3e0293ee
    s_mov_b32 s45, s44
    s_or_b32 s66, s44, 0x80000000
    s_mov_b32 s48, 0x3f003f00
    s_mov_b32 s49, 0
    s_mov_b32 s50, 0x3f803f80
    s_mov_b32 s51, 0x3f803f80
    s_mov_b32 s52, 512
    s_mov_b32 s53, 1024
    s_mov_b32 s54, 1536
    s_mov_b32 s30, 0
    s_lshl_b32 s47, s13, 9
    s_cmp_lg_u32 s32, 0
    s_cselect_b32 s71, s13, 3
    s_add_u32 s46, s71, 1
    s_lshr_b32 s46, s46, 1
    s_mov_b32 s14, 67125248
    s_mov_b32 s15, 67129344
    s_mov_b32 s16, 67133440
    s_mov_b32 s36, 0
    s_add_u32 s17, s68, 67108864
    s_mov_b32 s69, 0
    s_mov_b32 s70, 0
    s_lshl_b32 s26, s12, 14
    s_add_u32 s26, s26, 0
    s_mul_i32 s40, s13, 3072
    s_add_u32 s24, s26, s40
    s_lshl_b32 s96, s12, 7
    s_add_u32 s29, s96, 125845504
    s_add_u32 s96, s96, 125829120
    s_lshl_b32 s40, s12, 14
    s_add_u32 s40, s40, 68157440
    s_add_u32 s18, s40, 0
    s_add_u32 s19, s40, 4096
    s_add_u32 s20, s40, 8192
    s_add_u32 s21, s40, 12288
    s_lshr_b32 s40, s12, 3
    s_lshl_b32 s40, s40, 12
    s_and_b32 s41, s12, 7
    s_lshl_b32 s41, s41, 7
    s_add_u32 s40, s40, s41
    s_add_u32 s22, s40, 68157440
    s_add_u32 s23, s22, 1024
    s_add_u32 s25, s22, 2048
    s_mov_b32 s56, -65528
    s_cmp_lg_u32 s32, 0
    s_cselect_b64 s[38:39], -1, 0
    s_add_u32 s55, s68, 138412032
    s_cmp_eq_u32 s13, 3
    s_cselect_b64 s[100:101], 1, 0
    s_cselect_b64 s[38:39], 1, s[38:39]
    s_cselect_b32 s93, 64, 0
    s_cselect_b32 s55, s29, s55
    s_cselect_b32 s57, 0, 9216
    s_mov_b64 exec, s[100:101]
    v_mov_b32 v72, s95
    s_mov_b64 exec, -1
    s_mov_b32 s34, 0xff00ff00
    s_mov_b32 s35, 0xff00ff00
    s_lshl_b32 s28, s12, 12
    s_add_u32 s28, s28, 7602176
    s_add_u32 s27, s28, 77594624
    s_add_u32 s28, s28, 69206016
    s_cmp_ge_u32 s97, 3
    s_cbranch_scc1 cf_kvdone
    s_mov_b32 s40, 3
    v_bfe_u32 v78, v65, 2, 5
    s_mov_b32 s31, 4194304
cf_kv0:
    buffer_load_dword v77, v78, s[4:7], s96 offen offset:16 sc1
    s_waitcnt vmcnt(0)
    v_subrev_u32 v77, s95, v77
    v_cmp_lt_u32 vcc, 16, v77
    s_nop 1
    v_cndmask_b32 v77, v77, 0, vcc
    v_bfe_u32 v79, v78, 2, 2
    v_lshl_add_u32 v77, v77, 2, v79
    s_nop 1
    v_min_u32_dpp v77, v77, v77 row_ror:1 row_mask:0xf bank_mask:0xf
    s_nop 1
    v_min_u32_dpp v77, v77, v77 row_ror:2 row_mask:0xf bank_mask:0xf
    s_nop 1
    v_min_u32_dpp v77, v77, v77 row_ror:4 row_mask:0xf bank_mask:0xf
    s_nop 0
    v_readfirstlane_b32 s97, v77
    s_sub_u32 s31, s31, 1
    s_cbranch_scc1 cf_kv0_x
    s_cmp_le_u32 s40, s97
    s_cbranch_scc1 cf_kv0_x
    s_sleep 2
    s_branch cf_kv0
cf_kv0_x:
    s_add_u32 s40, s24, 0
    s_add_u32 s40, s40, s33
    s_sub_u32 s41, s96, s40
    v_bfe_u32 v77, v65, 2, 5
    v_add3_u32 v77, v77, s41, 16
    v_lshlrev_b32 v78, 3, v69
    s_nop 0
    v_mov_b32_dpp v78, v77 quad_perm:[0,1,2,3] row_mask:0xc bank_mask:0xf
    buffer_load_dword v76, v78, s[4:7], s40 offen sc1
    s_add_u32 s40, s24, 524288
    s_add_u32 s40, s40, s33
    s_sub_u32 s41, s96, s40
    v_bfe_u32 v77, v65, 2, 5
    v_add3_u32 v77, v77, s41, 16
    v_lshlrev_b32 v78, 3, v69
    s_nop 0
    v_mov_b32_dpp v78, v77 quad_perm:[0,1,2,3] row_mask:0xc bank_mask:0xf
    buffer_load_dword v76, v78, s[4:7], s40 offen sc1
cf_kvdone:
    v_mov_b64 v[0:1], 0
    v_mov_b64 v[2:3], 0
    v_mov_b64 v[4:5], 0
    v_mov_b64 v[6:7], 0
    v_mov_b64 v[8:9], 0
    v_mov_b64 v[10:11], 0
    v_mov_b64 v[12:13], 0
    v_mov_b64 v[14:15], 0
    v_mov_b64 v[16:17], 0
    v_mov_b64 v[18:19], 0
    v_mov_b64 v[20:21], 0
    v_mov_b64 v[22:23], 0
    ds_read_b128 v[40:43], v70 offset:0
    ds_read_b128 v[44:47], v70 offset:1024
    ds_read_b128 v[48:51], v70 offset:2048
    ds_read_b128 v[52:55], v70 offset:3072
    ds_read_b128 v[24:27], v70 offset:4096
    ds_read_b128 v[28:31], v70 offset:5120
    ds_read_b128 v[32:35], v70 offset:6144
    ds_read_b128 v[36:39], v70 offset:7168
    buffer_load_dwordx4 v[60:63], v65, s[4:7], s14 offen offset:0 nt
    buffer_load_dwordx4 v[56:59], v66, s[4:7], s14 offen offset:0 nt
    s_mov_b32 s31, 1048576
    s_waitcnt vmcnt(0) lgkmcnt(0)
    s_branch cf_goA
cf_loop:
    s_mov_b32 s31, 1048576
    s_mov_b32 s69, s70
    s_waitcnt lgkmcnt(0)
cf_cA:
    buffer_load_dwordx4 v[60:63], v65, s[4:7], s14 offen offset:0 nt
    buffer_load_dwordx4 v[56:59], v66, s[4:7], s14 offen offset:0 nt
cf_cA1:
    v_bitop3_b32 v77, v60, v56, s70 bitop3:0x7e
    v_and_b32 v77, 1, v77
    v_cmp_ne_u32 vcc, 0, v77
    s_cbranch_vccz cf_goA
    v_bitop3_b32 v77, v60, v56, s70 bitop3:0x7e
    v_and_b32 v77, 1, v77
    v_cmp_ne_u32 vcc, 0, v77
    s_cbranch_vccz cf_goA
    v_bitop3_b32 v77, v60, v56, s70 bitop3:0x7e
    v_and_b32 v77, 1, v77
    v_cmp_ne_u32 vcc, 0, v77
    s_cbranch_vccz cf_goA
    v_bitop3_b32 v77, v60, v56, s70 bitop3:0x7e
    v_and_b32 v77, 1, v77
    v_cmp_ne_u32 vcc, 0, v77
    s_cbranch_vccz cf_goA
    v_bitop3_b32 v77, v60, v56, s70 bitop3:0x7e
    v_and_b32 v77, 1, v77
    v_cmp_ne_u32 vcc, 0, v77
    s_cbranch_vccz cf_goA
    buffer_load_dwordx4 v[60:63], v65, s[4:7], s14 offen offset:0 nt
    buffer_load_dwordx4 v[56:59], v66, s[4:7], s14 offen offset:0 nt
    v_bitop3_b32 v77, v60, v56, s70 bitop3:0x7e
    v_and_b32 v77, 1, v77
    v_cmp_ne_u32 vcc, 0, v77
    s_cbranch_vccz cf_goA
    v_bitop3_b32 v77, v60, v56, s70 bitop3:0x7e
    v_and_b32 v77, 1, v77
    v_cmp_ne_u32 vcc, 0, v77
    s_cbranch_vccz cf_goA
    v_bitop3_b32 v77, v60, v56, s70 bitop3:0x7e
    v_and_b32 v77, 1, v77
    v_cmp_ne_u32 vcc, 0, v77
    s_cbranch_vccz cf_goA
    v_bitop3_b32 v77, v60, v56, s70 bitop3:0x7e
    v_and_b32 v77, 1, v77
    v_cmp_ne_u32 vcc, 0, v77
    s_cbranch_vccz cf_goA
    v_bitop3_b32 v77, v60, v56, s70 bitop3:0x7e
    v_and_b32 v77, 1, v77
    v_cmp_ne_u32 vcc, 0, v77
    s_cbranch_vccz cf_goA
    buffer_load_dwordx4 v[60:63], v65, s[4:7], s14 offen offset:0 nt
    buffer_load_dwordx4 v[56:59], v66, s[4:7], s14 offen offset:0 nt
    v_bitop3_b32 v77, v60, v56, s70 bitop3:0x7e
    v_and_b32 v77, 1, v77
    v_cmp_ne_u32 vcc, 0, v77
    s_cbranch_vccz cf_goA
    v_bitop3_b32 v77, v60, v56, s70 bitop3:0x7e
    v_and_b32 v77, 1, v77
    v_cmp_ne_u32 vcc, 0, v77
    s_cbranch_vccz cf_goA
    v_bitop3_b32 v77, v60, v56, s70 bitop3:0x7e
    v_and_b32 v77, 1, v77
    v_cmp_ne_u32 vcc, 0, v77
    s_cbranch_vccz cf_goA
    v_bitop3_b32 v77, v60, v56, s70 bitop3:0x7e
    v_and_b32 v77, 1, v77
    v_cmp_ne_u32 vcc, 0, v77
    s_cbranch_vccz cf_goA
    v_bitop3_b32 v77, v60, v56, s70 bitop3:0x7e
    v_and_b32 v77, 1, v77
    v_cmp_ne_u32 vcc, 0, v77
    s_cbranch_vccz cf_goA
    buffer_load_dwordx4 v[60:63], v65, s[4:7], s14 offen offset:0 nt
    buffer_load_dwordx4 v[56:59], v66, s[4:7], s14 offen offset:0 nt
    v_bitop3_b32 v77, v60, v56, s70 bitop3:0x7e
    v_and_b32 v77, 1, v77
    v_cmp_ne_u32 vcc, 0, v77
    s_cbranch_vccz cf_goA
    v_bitop3_b32 v77, v60, v56, s70 bitop3:0x7e
    v_and_b32 v77, 1, v77
    v_cmp_ne_u32 vcc, 0, v77
    s_cbranch_vccz cf_goA
    v_bitop3_b32 v77, v60, v56, s70 bitop3:0x7e
    v_and_b32 v77, 1, v77
    v_cmp_ne_u32 vcc, 0, v77
    s_cbranch_vccz cf_goA
    v_bitop3_b32 v77, v60, v56, s70 bitop3:0x7e
    v_and_b32 v77, 1, v77
    v_cmp_ne_u32 vcc, 0, v77
    s_cbranch_vccz cf_goA
    v_bitop3_b32 v77, v60, v56, s70 bitop3:0x7e
    v_and_b32 v77, 1, v77
    v_cmp_ne_u32 vcc, 0, v77
    s_cbranch_vccz cf_goA
    s_sub_u32 s31, s31, 64
    s_cbranch_scc0 cf_cA
cf_goA:
    ds_write_b128 v65, v[60:63] offset:0
    v_smfmac_f32_16x16x64_bf16 v[0:3], v[60:63], v[40:47], v64
    v_smfmac_f32_16x16x64_bf16 v[4:7], v[60:63], v[48:55], v64
    buffer_load_dwordx4 v[40:43], v65, s[4:7], s15 offen offset:0 nt
    v_smfmac_f32_16x16x64_bf16 v[0:3], v[56:59], v[24:31], v64
    s_add_u32 s40, s24, 1048576
    s_add_u32 s40, s40, s33
    s_sub_u32 s41, s96, s40
    v_smfmac_f32_16x16x64_bf16 v[4:7], v[56:59], v[32:39], v64
    ds_read_b128 v[24:27], v70 offset:8192
    s_cmp_lt_u32 s97, s93
    s_cselect_b32 s41, s41, 0
    v_smfmac_f32_16x16x64_bf16 v[8:11], v[60:63], a[96:103], v64
    ds_read_b128 v[28:31], v70 offset:9216
    v_smfmac_f32_16x16x64_bf16 v[12:15], v[60:63], a[104:111], v64
    ds_read_b128 v[32:35], v70 offset:10240
    s_waitcnt lgkmcnt(3)
    s_barrier
    ds_read_b128 v[48:51], v67 offset:0
    v_smfmac_f32_16x16x64_bf16 v[8:11], v[56:59], a[112:119], v64
    ds_read_b128 v[36:39], v70 offset:11264
    v_bitop3_b32 v79, v73, -9, s54 bitop3:0x6a
    v_smfmac_f32_16x16x64_bf16 v[12:15], v[56:59], a[120:127], v64
    ds_read_b128 v[52:55], v68 offset:0
    v_bfe_u32 v77, v65, 2, 5
    v_smfmac_f32_16x16x64_bf16 v[16:19], v[60:63], a[216:223], v64
    buffer_load_dwordx4 v[40:43], v65, s[4:7], s15 offen offset:0 nt
    s_waitcnt lgkmcnt(4)
    v_smfmac_f32_16x16x64_bf16 v[20:23], v[60:63], v[24:31], v64
    ds_read_b128 v[24:27], v70 offset:12288
    s_waitcnt lgkmcnt(3)
    v_smfmac_f32_16x16x64_bf16 v[0:3], v[48:51], a[0:7], v64
    ds_read_b128 v[28:31], v70 offset:13312
    s_waitcnt lgkmcnt(3)
    v_smfmac_f32_16x16x64_bf16 v[4:7], v[48:51], v[32:39], v64
    ds_read_b128 v[32:35], v70 offset:14336
    v_add3_u32 v77, v77, s41, 16
    v_smfmac_f32_16x16x64_bf16 v[8:11], v[48:51], a[128:135], v64
    ds_read_b128 v[36:39], v70 offset:15360
    v_lshlrev_b32 v78, 3, v69
    v_smfmac_f32_16x16x64_bf16 v[12:15], v[48:51], a[136:143], v64
    buffer_load_dwordx4 v[60:63], v65, s[4:7], s16 offen offset:0 nt
    v_smfmac_f32_16x16x64_bf16 v[16:19], v[56:59], a[224:231], v64
    v_mov_b32_dpp v78, v77 quad_perm:[0,1,2,3] row_mask:0xc bank_mask:0xf
    v_smfmac_f32_16x16x64_bf16 v[20:23], v[56:59], a[232:239], v64
    s_waitcnt lgkmcnt(2)
    s_waitcnt vmcnt(2)
    v_and_b32 v77, s36, v40
    v_smfmac_f32_16x16x64_bf16 v[12:15], v[52:55], v[24:31], v64
    ds_write_b128 v65, v[40:43] offset:4096
    v_smfmac_f32_16x16x64_bf16 v[0:3], v[52:55], a[8:15], v64
    s_waitcnt lgkmcnt(1)
    v_cmp_ne_u32 vcc, s70, v77
    v_smfmac_f32_16x16x64_bf16 v[4:7], v[52:55], v[32:39], v64
    buffer_load_dwordx4 v[24:27], v65, s[4:7], s24 offen offset:0 sc1
    v_smfmac_f32_16x16x64_bf16 v[8:11], v[52:55], a[144:151], v64
    s_cbranch_vccnz cf_spinB
cf_backB:
    v_smfmac_f32_16x16x64_bf16 v[16:19], v[40:43], v[176:183], v64
    s_waitcnt lgkmcnt(0)
    s_barrier
    ds_read_b128 v[44:47], v66 offset:4096
    v_smfmac_f32_16x16x64_bf16 v[12:15], v[40:43], a[160:167], v64
    ds_read_b128 v[32:35], v70 offset:16384
    v_smfmac_f32_16x16x64_bf16 v[0:3], v[40:43], a[16:23], v64
    ds_read_b128 v[36:39], v70 offset:17408
    v_smfmac_f32_16x16x64_bf16 v[8:11], v[40:43], a[152:159], v64
    ds_read_b128 v[48:51], v67 offset:4096
    v_smfmac_f32_16x16x64_bf16 v[4:7], v[40:43], a[24:31], v64
    ds_read_b128 v[52:55], v68 offset:4096
    v_smfmac_f32_16x16x64_bf16 v[20:23], v[40:43], v[184:191], v64
    buffer_load_dwordx4 v[28:31], v65, s[4:7], s24 offen offset:1024 sc1
    s_waitcnt lgkmcnt(4)
    v_smfmac_f32_16x16x64_bf16 v[0:3], v[44:47], a[32:39], v64
    ds_read_b128 v[56:59], v69 offset:15360
    s_waitcnt lgkmcnt(3)
    v_smfmac_f32_16x16x64_bf16 v[8:11], v[44:47], v[32:39], v64
    ds_read_b128 v[32:35], v70 offset:18432
    v_smfmac_f32_16x16x64_bf16 v[4:7], v[44:47], a[40:47], v64
    ds_read_b128 v[36:39], v70 offset:19456
    v_smfmac_f32_16x16x64_bf16 v[12:15], v[44:47], a[168:175], v64
    buffer_load_dwordx4 v[42:45], v65, s[4:7], s24 offen offset:3072 sc1
    s_waitcnt lgkmcnt(3)
    v_smfmac_f32_16x16x64_bf16 v[0:3], v[48:51], a[48:55], v64
    s_waitcnt vmcnt(3)
    v_and_b32 v77, s36, v60
    v_smfmac_f32_16x16x64_bf16 v[8:11], v[48:51], a[176:183], v64
    v_cmp_ne_u32 vcc, s70, v77
    v_smfmac_f32_16x16x64_bf16 v[0:3], v[52:55], a[64:71], v64
    s_waitcnt lgkmcnt(0)
    v_smfmac_f32_16x16x64_bf16 v[8:11], v[52:55], v[32:39], v64
    s_cbranch_vccnz cf_spin8
cf_back8:
    v_smfmac_f32_16x16x64_bf16 v[0:3], v[60:63], a[80:87], v64
    buffer_load_dwordx4 v[34:37], v65, s[4:7], s24 offen offset:2048 sc1
    s_nop 1
    v_smfmac_f32_16x16x64_bf16 v[8:11], v[60:63], a[200:207], v64
    s_nop 1
    v_lshrrev_b32 v77, 1, v69
    v_smfmac_f32_16x16x64_bf16 v[4:7], v[48:51], a[56:63], v64
    s_nop 1
    v_cvt_pk_bf16_f32 v0, v0, v1
    v_smfmac_f32_16x16x64_bf16 v[12:15], v[48:51], a[184:191], v64
    s_nop 1
    v_cvt_pk_bf16_f32 v1, v2, v3
    v_smfmac_f32_16x16x64_bf16 v[4:7], v[52:55], a[72:79], v64
    s_nop 1
    v_cvt_pk_bf16_f32 v2, v8, v9
    v_smfmac_f32_16x16x64_bf16 v[12:15], v[52:55], a[192:199], v64
    s_nop 1
    v_cvt_pk_bf16_f32 v3, v10, v11
    v_smfmac_f32_16x16x64_bf16 v[4:7], v[60:63], a[88:95], v64
    s_nop 2
    v_smfmac_f32_16x16x64_bf16 v[12:15], v[60:63], a[208:215], v64
    buffer_load_dword v76, v78, s[4:7], s40 offen sc1
    s_nop 1
    v_mfma_f32_16x16x32_bf16 v[8:11], v[0:3], v[56:59], 0
    s_nop 0
    v_cvt_pk_bf16_f32 v4, v4, v5
    v_cvt_pk_bf16_f32 v5, v6, v7
    s_nop 0
    v_cvt_pk_bf16_f32 v6, v12, v13
    v_cvt_pk_bf16_f32 v7, v14, v15
    s_nop 1
    v_mfma_f32_16x16x32_bf16 v[12:15], v[4:7], v[56:59], 0
    ds_read_b128 v[56:59], v66 offset:4096
    v_cvt_pk_bf16_f32 v0, v8, v9
    v_cvt_pk_bf16_f32 v1, v10, v11
    v_smfmac_f32_16x16x64_bf16 v[16:19], v[48:51], v[208:215], v64
    s_waitcnt vmcnt(3)
    s_nop 2
    v_cvt_pk_bf16_f32 v2, v12, v13
    v_cvt_pk_bf16_f32 v3, v14, v15
    s_nop 1
    v_mfma_f32_16x16x32_bf16 v[12:15], v[0:3], v[0:3], 0
    s_nop 1
    v_bitop3_b32 v78, v73, -9, s53 bitop3:0x6a
    v_mfma_f32_16x16x32_bf16 v[4:7], v[24:27], v[0:3], 0
    ds_read_b128 v[24:27], v67 offset:0
    s_nop 1
    v_mfma_f32_16x16x32_bf16 v[8:11], v[28:31], v[0:3], 0
    s_nop 0
    v_mov_b32_dpp v12, v14 row_ror:8 row_mask:0xf bank_mask:0xc
    v_mov_b32_dpp v13, v15 row_ror:8 row_mask:0xf bank_mask:0xc
    v_smfmac_f32_16x16x64_bf16 v[20:23], v[48:51], v[216:223], v64
    ds_write_b64 v71, v[12:13]
    ds_read_b128 v[48:51], v68 offset:0
    s_nop 1
    v_mov_b32_dpp v4, v8 row_ror:8 row_mask:0xf bank_mask:0xc
    v_mov_b32_dpp v5, v9 row_ror:8 row_mask:0xf bank_mask:0xc
    v_mov_b32_dpp v6, v10 row_ror:8 row_mask:0xf bank_mask:0xc
    v_mov_b32_dpp v7, v11 row_ror:8 row_mask:0xf bank_mask:0xc
    v_smfmac_f32_16x16x64_bf16 v[16:19], v[52:55], v[224:231], v64
    ds_write_b128 v65, v[4:7] offset:8192
    v_smfmac_f32_16x16x64_bf16 v[20:23], v[52:55], v[232:239], v64
    s_waitcnt lgkmcnt(3)
    v_smfmac_f32_16x16x64_bf16 v[16:19], v[24:27], a[240:247], v64
    s_waitcnt vmcnt(1)
    v_smfmac_f32_16x16x64_bf16 v[20:23], v[24:27], a[248:255], v64
    s_mov_b64 exec, s[38:39]
    buffer_store_dword v72, v75, s[4:7], s55 offen sc1
    s_mov_b64 exec, -1
    v_smfmac_f32_16x16x64_bf16 v[16:19], v[60:63], v[240:247], v64
    s_cmp_ge_u32 s30, 58
    s_waitcnt lgkmcnt(0)
    s_barrier
    ds_read_b128 v[8:11], v66 offset:8192
    v_smfmac_f32_16x16x64_bf16 v[20:23], v[60:63], v[248:255], v64
    ds_read_b128 v[12:15], v67 offset:8192
    v_smfmac_f32_16x16x64_bf16 v[16:19], v[56:59], v[192:199], v64
    ds_read_b128 v[52:55], v68 offset:8192
    v_smfmac_f32_16x16x64_bf16 v[20:23], v[56:59], v[200:207], v64
    ds_read_b64 v[24:25], v77 offset:14336
    ds_read_b64 v[26:27], v77 offset:14592
    v_smfmac_f32_16x16x64_bf16 v[16:19], v[48:51], v[160:167], v64
    ds_read_b64 v[28:29], v77 offset:14848
    ds_read_b64 v[30:31], v77 offset:15104
    v_bitop3_b32 v77, v73, -9, s52 bitop3:0x6a
    v_smfmac_f32_16x16x64_bf16 v[20:23], v[48:51], v[168:175], v64
    s_cbranch_scc1 cf_rare
cf_rare_x:
    ds_read_b128 v[56:59], v70 offset:22528
    ds_read_b128 v[60:63], v70 offset:23552
    s_waitcnt lgkmcnt(6)
    v_pk_add_f32 v[4:5], v[4:5], v[8:9]
    v_pk_add_f32 v[6:7], v[6:7], v[10:11]
    v_pk_add_f32 v[12:13], v[12:13], v[52:53]
    v_pk_add_f32 v[14:15], v[14:15], v[54:55]
    v_pk_add_f32 v[4:5], v[4:5], v[12:13]
    v_pk_add_f32 v[6:7], v[6:7], v[14:15]
    s_waitcnt lgkmcnt(2)
    v_pk_add_f32 v[24:25], v[24:25], v[26:27]
    v_pk_add_f32 v[28:29], v[28:29], v[30:31]
    v_max3_f32 v8, v4, v5, v6
    v_pk_add_f32 v[24:25], v[24:25], v[28:29]
    v_max_f32 v8, v8, v7
    v_max3_f32 v8, v8, v24, v25
    v_cvt_pk_bf16_f32 v32, v16, v17
    v_cvt_pk_bf16_f32 v38, v18, v19
    v_max_f32_dpp v8, v8, v8 row_ror:8 row_mask:0xf bank_mask:0xf
    v_mov_b32 v9, v8
    v_cvt_pk_bf16_f32 v40, v20, v21
    v_cvt_pk_bf16_f32 v46, v22, v23
    v_permlane32_swap_b32 v8, v9
    v_max_f32 v8, v8, v9
    v_mov_b32 v9, v8
    v_mov_b32 v11, 0
    v_mov_b32 v15, 0
    v_permlane16_swap_b32 v8, v9
    v_max_f32 v8, v8, v9
    v_mul_f32 v8, s66, v8
    v_pk_fma_f32 v[4:5], v[4:5], s[44:45], v[8:9] op_sel_hi:[1,1,0]
    v_pk_fma_f32 v[6:7], v[6:7], s[44:45], v[8:9] op_sel_hi:[1,1,0]
    v_pk_fma_f32 v[24:25], v[24:25], s[44:45], v[8:9] op_sel_hi:[1,1,0]
    v_exp_f32 v4, v4
    v_exp_f32 v5, v5
    v_exp_f32 v6, v6
    v_exp_f32 v7, v7
    v_exp_f32 v24, v24
    v_exp_f32 v25, v25
    v_cvt_pk_bf16_f32 v12, v4, v5
    v_cvt_pk_bf16_f32 v13, v6, v7
    v_cvt_pk_bf16_f32 v10, v24, v25
    v_cvt_pk_bf16_f32 v14, v24, v25
    v_mov_b64 v[0:1], s[48:49]
    v_mfma_f32_16x16x32_bf16 v[4:7], v[32:35], v[10:13], 0
    ds_read_b128 v[48:51], v70 offset:20480
    v_mov_b64 v[2:3], s[50:51]
    v_mfma_f32_16x16x32_bf16 v[24:27], v[36:39], v[12:15], 0
    ds_read_b128 v[52:55], v70 offset:21504
    v_mov_b64 v[8:9], 0
    v_mfma_f32_16x16x32_bf16 v[28:31], v[0:3], v[10:13], 0
    ds_read_b128 v[32:35], v70 offset:24576
    v_mov_b64 v[0:1], 0
    v_mfma_f32_16x16x32_bf16 v[16:19], v[40:43], v[10:13], 0
    ds_read_b128 v[36:39], v70 offset:25600
    v_mov_b64 v[2:3], 0
    v_mfma_f32_16x16x32_bf16 v[20:23], v[44:47], v[12:15], 0
    ds_read_b128 v[40:43], v70 offset:26624
    v_add_f32_dpp v4, v24, v4 row_ror:8 row_mask:0xf bank_mask:0xf
    v_add_f32_dpp v5, v25, v5 row_ror:8 row_mask:0xf bank_mask:0xf
    v_add_f32_dpp v6, v26, v6 row_ror:8 row_mask:0xf bank_mask:0xf
    v_add_f32_dpp v7, v27, v7 row_ror:8 row_mask:0xf bank_mask:0xf
    v_add_f32_dpp v29, v28, v28 row_ror:8 row_mask:0xf bank_mask:0xf
    v_rcp_f32 v28, v29
    v_mov_b64 v[10:11], 0
    v_add_f32_dpp v4, v16, v20 row_ror:8 row_mask:0xf bank_mask:0xc
    v_add_f32_dpp v5, v17, v21 row_ror:8 row_mask:0xf bank_mask:0xc
    v_add_f32_dpp v6, v18, v22 row_ror:8 row_mask:0xf bank_mask:0xc
    v_add_f32_dpp v7, v19, v23 row_ror:8 row_mask:0xf bank_mask:0xc
    v_pk_mul_f32 v[4:5], v[4:5], v[28:29] op_sel_hi:[1,0]
    v_pk_mul_f32 v[6:7], v[6:7], v[28:29] op_sel_hi:[1,0]
    v_cvt_pk_bf16_f32 v4, v4, v5
    v_cvt_pk_bf16_f32 v5, v6, v7
    ds_write_b64 v73, v[4:5] offset:12288
    v_mov_b32_dpp v6, v4 row_ror:8 row_mask:0xf bank_mask:0xf
    v_mov_b32_dpp v7, v5 row_ror:8 row_mask:0xf bank_mask:0xf
    v_mov_b64 v[12:13], 0
    v_mov_b64 v[14:15], 0
    v_smfmac_f32_16x16x64_bf16 v[8:11], v[4:7], v[80:87], v64
    s_waitcnt lgkmcnt(4)
    v_mov_b64 v[24:25], 0
    v_smfmac_f32_16x16x64_bf16 v[0:3], v[4:7], v[48:55], v64
    ds_read_b128 v[44:47], v70 offset:27648
    v_mov_b64 v[26:27], 0
    v_smfmac_f32_16x16x64_bf16 v[12:15], v[4:7], v[112:119], v64
    s_waitcnt lgkmcnt(1)
    s_barrier
    ds_read_b128 v[16:19], v77 offset:12288
    v_smfmac_f32_16x16x64_bf16 v[24:27], v[4:7], v[56:63], v64
    ds_read_b128 v[20:23], v78 offset:12288
    ds_read_b128 v[28:31], v79 offset:12288
    v_mov_b64 v[4:5], 0
    v_mov_b64 v[6:7], 0
    v_bfe_u32 v77, v74, 16, 1
    v_mad_i32_i24 v77, v77, s56, v74
    s_waitcnt lgkmcnt(2)
    v_smfmac_f32_16x16x64_bf16 v[8:11], v[16:19], v[88:95], v64
    ds_read_b128 v[56:59], v70 offset:28672
    v_and_b32 v72, 8, v73
    v_smfmac_f32_16x16x64_bf16 v[12:15], v[16:19], v[120:127], v64
    ds_read_b128 v[60:63], v70 offset:29696
    s_waitcnt lgkmcnt(3)
    v_mad_u32_u24 v72, v72, 63, v73
    v_smfmac_f32_16x16x64_bf16 v[8:11], v[20:23], v[96:103], v64
    ds_read_b128 v[48:51], v70 offset:30720
    v_subrev_u32 v72, s47, v72
    v_smfmac_f32_16x16x64_bf16 v[12:15], v[20:23], v[128:135], v64
    ds_read_b128 v[52:55], v70 offset:31744
    s_waitcnt lgkmcnt(4)
    v_smfmac_f32_16x16x64_bf16 v[8:11], v[28:31], v[104:111], v64
    s_add_u32 s30, s30, 1
    s_xor_b32 s70, s70, 1
    s_cmp_lg_u32 s71, 0
    v_smfmac_f32_16x16x64_bf16 v[12:15], v[28:31], v[136:143], v64
    s_nop 2
    v_smfmac_f32_16x16x64_bf16 v[0:3], v[16:19], v[32:39], v64
    ds_read_b128 v[32:35], v70 offset:32768
    ds_read_b128 v[36:39], v70 offset:33792
    v_cvt_pk_bf16_f32 v8, v8, v9
    v_cvt_pk_bf16_f32 v9, v10, v11
    v_and_or_b32 v8, v8, -2, s69
    v_cvt_pk_bf16_f32 v10, v12, v13
    v_cvt_pk_bf16_f32 v11, v14, v15
    v_smfmac_f32_16x16x64_bf16 v[24:27], v[16:19], v[40:47], v64
    buffer_store_dwordx4 v[8:11], v74, s[4:7], s22 offen
    ds_read_b128 v[40:43], v70 offset:34816
    s_waitcnt lgkmcnt(3)
    v_smfmac_f32_16x16x64_bf16 v[0:3], v[20:23], v[56:63], v64
    ds_read_b128 v[44:47], v70 offset:35840
    ds_read_b128 v[56:59], v72 offset:12288
    v_smfmac_f32_16x16x64_bf16 v[24:27], v[20:23], v[48:55], v64
    ds_read_b128 v[60:63], v72 offset:13312
    s_waitcnt lgkmcnt(4)
    v_smfmac_f32_16x16x64_bf16 v[0:3], v[28:31], v[32:39], v64
    s_waitcnt lgkmcnt(2)
    s_nop 1
    v_smfmac_f32_16x16x64_bf16 v[24:27], v[28:31], v[40:47], v64
    s_waitcnt lgkmcnt(0)
    s_nop 1
    v_smfmac_f32_16x16x64_bf16 v[4:7], v[56:59], v[144:151], v64
    v_cvt_pk_bf16_f32 v0, v0, v1
    v_cvt_pk_bf16_f32 v1, v2, v3
    v_and_or_b32 v0, v0, -2, s69
    s_nop 0
    v_cvt_pk_bf16_f32 v2, v24, v25
    v_cvt_pk_bf16_f32 v3, v26, v27
    v_smfmac_f32_16x16x64_bf16 v[4:7], v[60:63], v[152:159], v64
    buffer_store_dwordx4 v[0:3], v74, s[4:7], s23 offen
    s_nop 6
    v_cvt_pk_bf16_f32 v4, v4, v5
    v_cvt_pk_bf16_f32 v5, v6, v7
    v_and_or_b32 v4, v4, -2, s69
    buffer_store_dwordx2 v[4:5], v77, s[4:7], s25 offen
    s_cbranch_scc1 cf_e1
    s_nop 2
    v_mov_b32 v79, v79
    s_nop 2
    v_mov_b32 v79, v79
    s_nop 2
    v_mov_b32 v79, v79
    s_nop 2
    v_mov_b32 v79, v79
    s_nop 2
    v_mov_b32 v79, v79
    s_nop 2
    v_mov_b32 v79, v79
    s_nop 2
    v_mov_b32 v79, v79
    s_nop 2
    v_mov_b32 v79, v79
    s_nop 2
    v_mov_b32 v79, v79
    s_nop 2
    v_mov_b32 v79, v79
    s_nop 2
    v_mov_b32 v79, v79
    s_nop 2
    v_mov_b32 v79, v79
    s_nop 2
    v_mov_b32 v79, v79
    s_nop 2
    v_mov_b32 v79, v79
    buffer_load_dwordx4 v[8:11], v65, s[4:7], s18 offen nt
    buffer_load_dwordx4 v[12:15], v65, s[4:7], s19 offen nt
    buffer_load_dwordx4 v[16:19], v65, s[4:7], s20 offen nt
    buffer_load_dwordx4 v[20:23], v65, s[4:7], s21 offen nt
    v_and_b32 v77, 255, v69
    ds_read_b128 v[4:7], v77 offset:15872
    ds_read_b128 v[40:43], v70 offset:0
    ds_read_b128 v[44:47], v70 offset:1024
    ds_read_b128 v[48:51], v70 offset:2048
    ds_read_b128 v[52:55], v70 offset:3072
    ds_read_b128 v[24:27], v70 offset:4096
    ds_read_b128 v[28:31], v70 offset:5120
    ds_read_b128 v[32:35], v70 offset:6144
    ds_read_b128 v[36:39], v70 offset:7168
    s_mov_b32 s31, 65536
    s_add_u32 s24, s24, 524288
    s_add_u32 s26, s26, 524288
    s_add_u32 s55, s55, s57
    s_mov_b32 s14, 67108864
    s_mov_b32 s15, 67112960
    s_mov_b32 s16, 67117056
    s_mov_b32 s36, 1
    v_mov_b32 v60, s69
    v_mov_b32 v56, s69
    v_and_b32 v79, 12, v75
    v_cmp_eq_u32 vcc, 0, v79
    s_nop 1
    v_cndmask_b32 v79, 0, 1, vcc
    s_waitcnt lgkmcnt(0)
    s_waitcnt vmcnt(3)
    v_xor_b32 v77, s69, v8
    v_mfma_f32_16x16x32_bf16 v[0:3], v[4:7], v[8:11], 0
    v_mov_b64 v[8:9], 0
    v_mov_b64 v[10:11], 0
    s_waitcnt vmcnt(2)
    v_bitop3_b32 v77, v77, v12, s69 bitop3:0xf6
    v_mfma_f32_16x16x32_bf16 v[0:3], v[4:7], v[12:15], v[0:3]
    v_mov_b64 v[12:13], 0
    v_mov_b64 v[14:15], 0
    s_waitcnt vmcnt(1)
    v_bitop3_b32 v77, v77, v16, s69 bitop3:0xf6
    v_mfma_f32_16x16x32_bf16 v[0:3], v[4:7], v[16:19], v[0:3]
    v_mov_b64 v[16:17], 0
    v_mov_b64 v[18:19], 0
    s_waitcnt vmcnt(0)
    v_bitop3_b32 v77, v77, v20, s69 bitop3:0xf6
    v_mfma_f32_16x16x32_bf16 v[0:3], v[4:7], v[20:23], v[0:3]
    v_and_b32 v77, 1, v77
    v_cmp_ne_u32 vcc, 0, v77
    v_mov_b64 v[20:21], 0
    v_mov_b64 v[22:23], 0
    s_cmp_eq_u64 vcc, 0
    s_cselect_b64 s[42:43], -1, 0
    s_nop 1
    v_add_f32_dpp v0, v0, v0 row_ror:8 row_mask:0xf bank_mask:0xf
    v_add_f32_dpp v1, v1, v1 row_ror:8 row_mask:0xf bank_mask:0xf
    s_mov_b64 exec, s[42:43]
    v_cvt_pk_bf16_f32 v72, v0, v1
    v_bfi_b32 v72, v79, s70, v72
    buffer_store_dword v72, v75, s[4:7], s17 offen offset:0
    s_mov_b64 exec, -1
    s_cbranch_scc0 cf_f0_retry
cf_f0_go:
    v_mov_b64 v[0:1], 0
    v_mov_b64 v[2:3], 0
    v_mov_b64 v[4:5], 0
    v_mov_b64 v[6:7], 0
    s_nop 2
    v_mov_b32 v79, v79
    s_nop 2
    v_mov_b32 v79, v79
    s_nop 2
    v_mov_b32 v79, v79
    s_nop 2
    v_mov_b32 v79, v79
    s_branch cf_loop
cf_e1:
    s_cmp_lg_u32 s71, 2
    s_cbranch_scc1 cf_f1
    v_and_b32 v77, 255, v69
    ds_read_b128 v[4:7], v77 offset:15872
    ds_read_b128 v[40:43], v70 offset:0
    ds_read_b128 v[44:47], v70 offset:1024
    ds_read_b128 v[48:51], v70 offset:2048
    ds_read_b128 v[52:55], v70 offset:3072
    ds_read_b128 v[24:27], v70 offset:4096
    ds_read_b128 v[28:31], v70 offset:5120
    ds_read_b128 v[32:35], v70 offset:6144
    ds_read_b128 v[36:39], v70 offset:7168
    s_mov_b32 s31, 65536
    s_add_u32 s24, s24, 524288
    s_add_u32 s26, s26, 524288
    s_add_u32 s55, s55, s57
    s_mov_b32 s14, 67108864
    s_mov_b32 s15, 67112960
    s_mov_b32 s16, 67117056
    s_mov_b32 s36, 1
    v_mov_b32 v60, s69
    v_mov_b32 v56, s69
    v_and_b32 v79, 12, v75
    v_cmp_eq_u32 vcc, 0, v79
    s_nop 1
    v_cndmask_b32 v79, 0, 1, vcc
    s_nop 2
    v_mov_b32 v79, v79
    s_nop 2
    v_mov_b32 v79, v79
    s_nop 2
    v_mov_b32 v79, v79
    s_nop 2
    v_mov_b32 v79, v79
    s_nop 2
    v_mov_b32 v79, v79
    s_nop 2
    v_mov_b32 v79, v79
    s_nop 2
    v_mov_b32 v79, v79
    s_nop 2
    v_mov_b32 v79, v79
    s_nop 2
    v_mov_b32 v79, v79
    s_nop 2
    v_mov_b32 v79, v79
    s_nop 2
    v_mov_b32 v79, v79
    s_nop 2
    v_mov_b32 v79, v79
    s_nop 2
    v_mov_b32 v79, v79
    s_nop 2
    v_mov_b32 v79, v79
    s_waitcnt vmcnt(0)
    buffer_load_dwordx4 v[8:11], v65, s[4:7], s18 offen nt
    buffer_load_dwordx4 v[12:15], v65, s[4:7], s19 offen nt
    buffer_load_dwordx4 v[16:19], v65, s[4:7], s20 offen nt
    buffer_load_dwordx4 v[20:23], v65, s[4:7], s21 offen nt
    s_nop 2
    v_mov_b32 v79, v79
    s_nop 2
    v_mov_b32 v79, v79
    s_nop 2
    v_mov_b32 v79, v79
    s_nop 2
    v_mov_b32 v79, v79
    s_nop 2
    v_mov_b32 v79, v79
    s_nop 2
    v_mov_b32 v79, v79
    s_nop 2
    v_mov_b32 v79, v79
    s_nop 2
    v_mov_b32 v79, v79
    s_nop 2
    v_mov_b32 v79, v79
    s_nop 2
    v_mov_b32 v79, v79
    buffer_load_dwordx4 v[60:63], v65, s[4:7], s14 offen offset:0 nt
    buffer_load_dwordx4 v[56:59], v66, s[4:7], s14 offen offset:0 nt
    s_waitcnt lgkmcnt(0)
    s_waitcnt vmcnt(5)
    v_xor_b32 v77, s69, v8
    v_bitop3_b32 v77, v77, v10, s69 bitop3:0xf6
    v_mfma_f32_16x16x32_bf16 v[0:3], v[4:7], v[8:11], 0
    v_mov_b64 v[8:9], 0
    v_mov_b64 v[10:11], 0
    s_waitcnt vmcnt(4)
    v_bitop3_b32 v77, v77, v12, s69 bitop3:0xf6
    v_bitop3_b32 v77, v77, v14, s69 bitop3:0xf6
    v_mfma_f32_16x16x32_bf16 v[0:3], v[4:7], v[12:15], v[0:3]
    v_mov_b64 v[12:13], 0
    v_mov_b64 v[14:15], 0
    s_waitcnt vmcnt(3)
    v_bitop3_b32 v77, v77, v16, s69 bitop3:0xf6
    v_bitop3_b32 v77, v77, v18, s69 bitop3:0xf6
    v_mfma_f32_16x16x32_bf16 v[0:3], v[4:7], v[16:19], v[0:3]
    v_mov_b64 v[16:17], 0
    v_mov_b64 v[18:19], 0
    s_waitcnt vmcnt(2)
    v_bitop3_b32 v77, v77, v20, s69 bitop3:0xf6
    v_bitop3_b32 v77, v77, v22, s69 bitop3:0xf6
    v_mfma_f32_16x16x32_bf16 v[0:3], v[4:7], v[20:23], v[0:3]
    v_and_b32 v77, 1, v77
    v_cmp_ne_u32 vcc, 0, v77
    v_mov_b64 v[20:21], 0
    v_mov_b64 v[22:23], 0
    buffer_load_dwordx4 v[60:63], v65, s[4:7], s14 offen offset:0 nt
    buffer_load_dwordx4 v[56:59], v66, s[4:7], s14 offen offset:0 nt
    s_cmp_eq_u64 vcc, 0
    s_cselect_b64 s[42:43], -1, 0
    v_add_f32 v2, v0, v1
    s_nop 1
    v_add_f32_dpp v2, v2, v2 row_ror:8 row_mask:0xf bank_mask:0xf
    s_nop 1
    v_mov_b32_dpp v0, v2 quad_perm:[0,0,2,2] row_mask:0xf bank_mask:0xf
    v_mov_b32_dpp v1, v2 quad_perm:[1,1,3,3] row_mask:0xf bank_mask:0xf
    s_mov_b64 exec, s[42:43]
    v_cvt_pk_bf16_f32 v72, v0, v1
    v_bfi_b32 v72, v79, s70, v72
    buffer_store_dword v72, v75, s[4:7], s17 offen offset:0
    buffer_store_dword v72, v75, s[4:7], s17 offen offset:1024
    buffer_store_dword v72, v75, s[4:7], s17 offen offset:2048
    buffer_store_dword v72, v75, s[4:7], s17 offen offset:3072
    s_mov_b64 exec, -1
    s_cbranch_scc0 cf_f2_retry
cf_f2_go:
    v_mov_b64 v[0:1], 0
    v_mov_b64 v[2:3], 0
    v_mov_b64 v[4:5], 0
    v_mov_b64 v[6:7], 0
    s_branch cf_loop
cf_f1:
    s_cmp_lg_u32 s32, 1
    s_cbranch_scc1 cf_f3
    v_and_b32 v77, 255, v69
    ds_read_b128 v[4:7], v77 offset:15872
    ds_read_b128 v[40:43], v70 offset:0
    ds_read_b128 v[44:47], v70 offset:1024
    ds_read_b128 v[48:51], v70 offset:2048
    ds_read_b128 v[52:55], v70 offset:3072
    ds_read_b128 v[24:27], v70 offset:4096
    ds_read_b128 v[28:31], v70 offset:5120
    ds_read_b128 v[32:35], v70 offset:6144
    ds_read_b128 v[36:39], v70 offset:7168
    s_mov_b32 s31, 65536
    s_add_u32 s24, s24, 524288
    s_add_u32 s26, s26, 524288
    s_add_u32 s55, s55, s57
    s_mov_b32 s14, 67108864
    s_mov_b32 s15, 67112960
    s_mov_b32 s16, 67117056
    s_mov_b32 s36, 1
    v_mov_b32 v60, s69
    v_mov_b32 v56, s69
    v_and_b32 v79, 12, v75
    v_cmp_eq_u32 vcc, 0, v79
    s_nop 1
    v_cndmask_b32 v79, 0, 1, vcc
    s_nop 2
    v_mov_b32 v79, v79
    s_nop 2
    v_mov_b32 v79, v79
    s_nop 2
    v_mov_b32 v79, v79
    s_nop 2
    v_mov_b32 v79, v79
    s_nop 2
    v_mov_b32 v79, v79
    s_nop 2
    v_mov_b32 v79, v79
    s_nop 2
    v_mov_b32 v79, v79
    s_nop 2
    v_mov_b32 v79, v79
    s_nop 2
    v_mov_b32 v79, v79
    s_nop 2
    v_mov_b32 v79, v79
    s_nop 2
    v_mov_b32 v79, v79
    s_nop 2
    v_mov_b32 v79, v79
    s_waitcnt vmcnt(0)
    buffer_load_dwordx4 v[8:11], v65, s[4:7], s18 offen nt
    buffer_load_dwordx4 v[12:15], v65, s[4:7], s19 offen nt
    buffer_load_dwordx4 v[16:19], v65, s[4:7], s20 offen nt
    buffer_load_dwordx4 v[20:23], v65, s[4:7], s21 offen nt
    s_nop 2
    v_mov_b32 v79, v79
    s_nop 2
    v_mov_b32 v79, v79
    s_nop 2
    v_mov_b32 v79, v79
    s_nop 2
    v_mov_b32 v79, v79
    s_nop 2
    v_mov_b32 v79, v79
    s_nop 2
    v_mov_b32 v79, v79
    s_nop 2
    v_mov_b32 v79, v79
    s_nop 2
    v_mov_b32 v79, v79
    s_nop 2
    v_mov_b32 v79, v79
    s_nop 2
    v_mov_b32 v79, v79
    buffer_load_dwordx4 v[60:63], v65, s[4:7], s14 offen offset:0 nt
    buffer_load_dwordx4 v[56:59], v66, s[4:7], s14 offen offset:0 nt
    s_waitcnt lgkmcnt(0)
    s_waitcnt vmcnt(5)
    v_xor_b32 v77, s69, v8
    v_mfma_f32_16x16x32_bf16 v[0:3], v[4:7], v[8:11], 0
    v_mov_b64 v[8:9], 0
    v_mov_b64 v[10:11], 0
    s_waitcnt vmcnt(4)
    v_bitop3_b32 v77, v77, v12, s69 bitop3:0xf6
    v_mfma_f32_16x16x32_bf16 v[0:3], v[4:7], v[12:15], v[0:3]
    v_mov_b64 v[12:13], 0
    v_mov_b64 v[14:15], 0
    s_waitcnt vmcnt(3)
    v_bitop3_b32 v77, v77, v16, s69 bitop3:0xf6
    v_mfma_f32_16x16x32_bf16 v[0:3], v[4:7], v[16:19], v[0:3]
    v_mov_b64 v[16:17], 0
    v_mov_b64 v[18:19], 0
    s_waitcnt vmcnt(2)
    v_bitop3_b32 v77, v77, v20, s69 bitop3:0xf6
    v_mfma_f32_16x16x32_bf16 v[0:3], v[4:7], v[20:23], v[0:3]
    v_and_b32 v77, 1, v77
    v_cmp_ne_u32 vcc, 0, v77
    v_mov_b64 v[20:21], 0
    v_mov_b64 v[22:23], 0
    buffer_load_dwordx4 v[60:63], v65, s[4:7], s14 offen offset:0 nt
    buffer_load_dwordx4 v[56:59], v66, s[4:7], s14 offen offset:0 nt
    s_cmp_eq_u64 vcc, 0
    s_cselect_b64 s[42:43], -1, 0
    v_add_f32_dpp v0, v0, v0 row_ror:8 row_mask:0xf bank_mask:0xf
    v_add_f32_dpp v1, v1, v1 row_ror:8 row_mask:0xf bank_mask:0xf
    s_mov_b64 exec, s[42:43]
    v_cvt_pk_bf16_f32 v72, v0, v1
    v_bfi_b32 v72, v79, s70, v72
    buffer_store_dword v72, v75, s[4:7], s17 offen offset:0
    s_mov_b64 exec, -1
    s_cbranch_scc0 cf_f1_retry
cf_f1_go:
    v_mov_b64 v[0:1], 0
    v_mov_b64 v[2:3], 0
    v_mov_b64 v[4:5], 0
    v_mov_b64 v[6:7], 0
    s_branch cf_loop
cf_f3:
    v_and_b32 v77, 255, v69
    ds_read_b128 v[4:7], v77 offset:15872
    ds_read_b128 v[40:43], v70 offset:0
    ds_read_b128 v[44:47], v70 offset:1024
    ds_read_b128 v[48:51], v70 offset:2048
    ds_read_b128 v[52:55], v70 offset:3072
    ds_read_b128 v[24:27], v70 offset:4096
    ds_read_b128 v[28:31], v70 offset:5120
    ds_read_b128 v[32:35], v70 offset:6144
    ds_read_b128 v[36:39], v70 offset:7168
    s_mov_b32 s31, 65536
    s_add_u32 s24, s24, 524288
    s_add_u32 s26, s26, 524288
    s_add_u32 s55, s55, s57
    s_mov_b32 s14, 67108864
    s_mov_b32 s15, 67112960
    s_mov_b32 s16, 67117056
    s_mov_b32 s36, 1
    v_mov_b32 v60, s69
    v_mov_b32 v56, s69
    v_and_b32 v79, 12, v75
    v_cmp_eq_u32 vcc, 0, v79
    s_nop 1
    v_cndmask_b32 v79, 0, 1, vcc
    s_add_u32 s40, s30, s95
    v_mov_b32 v72, s40
    s_waitcnt lgkmcnt(0)
    v_mov_b64 v[0:1], 0
    v_mov_b64 v[2:3], 0
    v_mov_b64 v[4:5], 0
    v_mov_b64 v[6:7], 0
    v_mov_b64 v[8:9], 0
    v_mov_b64 v[10:11], 0
    v_mov_b64 v[12:13], 0
    v_mov_b64 v[14:15], 0
    v_mov_b64 v[16:17], 0
    v_mov_b64 v[18:19], 0
    v_mov_b64 v[20:21], 0
    v_mov_b64 v[22:23], 0
    s_nop 2
    v_mov_b32 v79, v79
    s_nop 2
    v_mov_b32 v79, v79
    s_nop 2
    v_mov_b32 v79, v79
    s_nop 2
    v_mov_b32 v79, v79
    s_nop 2
    v_mov_b32 v79, v79
    s_nop 2
    v_mov_b32 v79, v79
    s_nop 2
    v_mov_b32 v79, v79
    s_nop 2
    v_mov_b32 v79, v79
    s_nop 2
    v_mov_b32 v79, v79
    s_nop 2
    v_mov_b32 v79, v79
    s_nop 2
    v_mov_b32 v79, v79
    s_nop 2
    v_mov_b32 v79, v79
    s_nop 2
    v_mov_b32 v79, v79
    s_nop 2
    v_mov_b32 v79, v79
    s_nop 2
    v_mov_b32 v79, v79
    s_nop 2
    v_mov_b32 v79, v79
    s_nop 2
    v_mov_b32 v79, v79
    s_nop 2
    v_mov_b32 v79, v79
    s_waitcnt vmcnt(0)
    s_cmp_lt_u32 s97, s93
    s_cbranch_scc1 cf_kvwait
    s_nop 2
    v_mov_b32 v79, v79
    s_nop 2
    v_mov_b32 v79, v79
    s_nop 2
    v_mov_b32 v79, v79
    s_nop 2
    v_mov_b32 v79, v79
    s_nop 2
    v_mov_b32 v79, v79
    s_nop 2
    v_mov_b32 v79, v79
    s_nop 2
    v_mov_b32 v79, v79
    s_nop 2
    v_mov_b32 v79, v79
cf_kvok:
    s_branch cf_loop
cf_f0_retry:
cf_f0_spin:
    s_nop 0
    buffer_load_dwordx4 v[8:11], v65, s[4:7], s18 offen nt
    buffer_load_dwordx4 v[12:15], v65, s[4:7], s19 offen nt
    buffer_load_dwordx4 v[16:19], v65, s[4:7], s20 offen nt
    buffer_load_dwordx4 v[20:23], v65, s[4:7], s21 offen nt
    s_nop 2
    v_mov_b32 v79, v79
    s_nop 2
    v_mov_b32 v79, v79
    s_nop 2
    v_mov_b32 v79, v79
    s_nop 2
    v_mov_b32 v79, v79
    s_nop 2
    v_mov_b32 v79, v79
    s_nop 2
    v_mov_b32 v79, v79
    buffer_load_dwordx4 v[60:63], v65, s[4:7], s14 offen offset:0 nt
    buffer_load_dwordx4 v[56:59], v66, s[4:7], s14 offen offset:0 nt
    s_waitcnt vmcnt(5)
    v_xor_b32 v77, s69, v8
    v_mfma_f32_16x16x32_bf16 v[0:3], v[4:7], v[8:11], 0
    v_mov_b64 v[8:9], 0
    v_mov_b64 v[10:11], 0
    s_waitcnt vmcnt(4)
    v_bitop3_b32 v77, v77, v12, s69 bitop3:0xf6
    v_mfma_f32_16x16x32_bf16 v[0:3], v[4:7], v[12:15], v[0:3]
    v_mov_b64 v[12:13], 0
    v_mov_b64 v[14:15], 0
    s_waitcnt vmcnt(3)
    v_bitop3_b32 v77, v77, v16, s69 bitop3:0xf6
    v_mfma_f32_16x16x32_bf16 v[0:3], v[4:7], v[16:19], v[0:3]
    v_mov_b64 v[16:17], 0
    v_mov_b64 v[18:19], 0
    s_waitcnt vmcnt(2)
    v_bitop3_b32 v77, v77, v20, s69 bitop3:0xf6
    v_mfma_f32_16x16x32_bf16 v[0:3], v[4:7], v[20:23], v[0:3]
    v_and_b32 v77, 1, v77
    v_cmp_ne_u32 vcc, 0, v77
    v_mov_b64 v[20:21], 0
    v_mov_b64 v[22:23], 0
    buffer_load_dwordx4 v[60:63], v65, s[4:7], s14 offen offset:0 nt
    buffer_load_dwordx4 v[56:59], v66, s[4:7], s14 offen offset:0 nt
    s_cmp_eq_u64 vcc, 0
    s_cselect_b64 s[42:43], -1, 0
    v_add_f32_dpp v0, v0, v0 row_ror:8 row_mask:0xf bank_mask:0xf
    v_add_f32_dpp v1, v1, v1 row_ror:8 row_mask:0xf bank_mask:0xf
    s_mov_b64 exec, s[42:43]
    v_cvt_pk_bf16_f32 v72, v0, v1
    v_bfi_b32 v72, v79, s70, v72
    buffer_store_dword v72, v75, s[4:7], s17 offen offset:0
    s_mov_b64 exec, -1
    s_cbranch_scc1 cf_f0_rx
    s_sub_u32 s31, s31, 1
    s_cbranch_scc0 cf_f0_spin
cf_f0_rx:
    v_mov_b64 v[0:1], 0
    v_mov_b64 v[2:3], 0
    v_mov_b64 v[4:5], 0
    v_mov_b64 v[6:7], 0
    s_branch cf_loop
cf_f1_retry:
cf_f1_spin:
    s_nop 0
    buffer_load_dwordx4 v[8:11], v65, s[4:7], s18 offen nt
    buffer_load_dwordx4 v[12:15], v65, s[4:7], s19 offen nt
    buffer_load_dwordx4 v[16:19], v65, s[4:7], s20 offen nt
    buffer_load_dwordx4 v[20:23], v65, s[4:7], s21 offen nt
    s_nop 2
    v_mov_b32 v79, v79
    s_nop 2
    v_mov_b32 v79, v79
    s_nop 2
    v_mov_b32 v79, v79
    s_nop 2
    v_mov_b32 v79, v79
    s_nop 2
    v_mov_b32 v79, v79
    s_nop 2
    v_mov_b32 v79, v79
    buffer_load_dwordx4 v[60:63], v65, s[4:7], s14 offen offset:0 nt
    buffer_load_dwordx4 v[56:59], v66, s[4:7], s14 offen offset:0 nt
    s_waitcnt vmcnt(5)
    v_xor_b32 v77, s69, v8
    v_mfma_f32_16x16x32_bf16 v[0:3], v[4:7], v[8:11], 0
    v_mov_b64 v[8:9], 0
    v_mov_b64 v[10:11], 0
    s_waitcnt vmcnt(4)
    v_bitop3_b32 v77, v77, v12, s69 bitop3:0xf6
    v_mfma_f32_16x16x32_bf16 v[0:3], v[4:7], v[12:15], v[0:3]
    v_mov_b64 v[12:13], 0
    v_mov_b64 v[14:15], 0
    s_waitcnt vmcnt(3)
    v_bitop3_b32 v77, v77, v16, s69 bitop3:0xf6
    v_mfma_f32_16x16x32_bf16 v[0:3], v[4:7], v[16:19], v[0:3]
    v_mov_b64 v[16:17], 0
    v_mov_b64 v[18:19], 0
    s_waitcnt vmcnt(2)
    v_bitop3_b32 v77, v77, v20, s69 bitop3:0xf6
    v_mfma_f32_16x16x32_bf16 v[0:3], v[4:7], v[20:23], v[0:3]
    v_and_b32 v77, 1, v77
    v_cmp_ne_u32 vcc, 0, v77
    v_mov_b64 v[20:21], 0
    v_mov_b64 v[22:23], 0
    buffer_load_dwordx4 v[60:63], v65, s[4:7], s14 offen offset:0 nt
    buffer_load_dwordx4 v[56:59], v66, s[4:7], s14 offen offset:0 nt
    s_cmp_eq_u64 vcc, 0
    s_cselect_b64 s[42:43], -1, 0
    v_add_f32_dpp v0, v0, v0 row_ror:8 row_mask:0xf bank_mask:0xf
    v_add_f32_dpp v1, v1, v1 row_ror:8 row_mask:0xf bank_mask:0xf
    s_mov_b64 exec, s[42:43]
    v_cvt_pk_bf16_f32 v72, v0, v1
    v_bfi_b32 v72, v79, s70, v72
    buffer_store_dword v72, v75, s[4:7], s17 offen offset:0
    s_mov_b64 exec, -1
    s_cbranch_scc1 cf_f1_rx
    s_sub_u32 s31, s31, 1
    s_cbranch_scc0 cf_f1_spin
cf_f1_rx:
    v_mov_b64 v[0:1], 0
    v_mov_b64 v[2:3], 0
    v_mov_b64 v[4:5], 0
    v_mov_b64 v[6:7], 0
    s_branch cf_loop
cf_f2_retry:
cf_f2_spin:
    s_nop 0
    buffer_load_dwordx4 v[8:11], v65, s[4:7], s18 offen nt
    buffer_load_dwordx4 v[12:15], v65, s[4:7], s19 offen nt
    buffer_load_dwordx4 v[16:19], v65, s[4:7], s20 offen nt
    buffer_load_dwordx4 v[20:23], v65, s[4:7], s21 offen nt
    s_nop 2
    v_mov_b32 v79, v79
    s_nop 2
    v_mov_b32 v79, v79
    s_nop 2
    v_mov_b32 v79, v79
    s_nop 2
    v_mov_b32 v79, v79
    s_nop 2
    v_mov_b32 v79, v79
    s_nop 2
    v_mov_b32 v79, v79
    buffer_load_dwordx4 v[60:63], v65, s[4:7], s14 offen offset:0 nt
    buffer_load_dwordx4 v[56:59], v66, s[4:7], s14 offen offset:0 nt
    s_waitcnt vmcnt(5)
    v_xor_b32 v77, s69, v8
    v_bitop3_b32 v77, v77, v10, s69 bitop3:0xf6
    v_mfma_f32_16x16x32_bf16 v[0:3], v[4:7], v[8:11], 0
    v_mov_b64 v[8:9], 0
    v_mov_b64 v[10:11], 0
    s_waitcnt vmcnt(4)
    v_bitop3_b32 v77, v77, v12, s69 bitop3:0xf6
    v_bitop3_b32 v77, v77, v14, s69 bitop3:0xf6
    v_mfma_f32_16x16x32_bf16 v[0:3], v[4:7], v[12:15], v[0:3]
    v_mov_b64 v[12:13], 0
    v_mov_b64 v[14:15], 0
    s_waitcnt vmcnt(3)
    v_bitop3_b32 v77, v77, v16, s69 bitop3:0xf6
    v_bitop3_b32 v77, v77, v18, s69 bitop3:0xf6
    v_mfma_f32_16x16x32_bf16 v[0:3], v[4:7], v[16:19], v[0:3]
    v_mov_b64 v[16:17], 0
    v_mov_b64 v[18:19], 0
    s_waitcnt vmcnt(2)
    v_bitop3_b32 v77, v77, v20, s69 bitop3:0xf6
    v_bitop3_b32 v77, v77, v22, s69 bitop3:0xf6
    v_mfma_f32_16x16x32_bf16 v[0:3], v[4:7], v[20:23], v[0:3]
    v_and_b32 v77, 1, v77
    v_cmp_ne_u32 vcc, 0, v77
    v_mov_b64 v[20:21], 0
    v_mov_b64 v[22:23], 0
    buffer_load_dwordx4 v[60:63], v65, s[4:7], s14 offen offset:0 nt
    buffer_load_dwordx4 v[56:59], v66, s[4:7], s14 offen offset:0 nt
    s_cmp_eq_u64 vcc, 0
    s_cselect_b64 s[42:43], -1, 0
    v_add_f32 v2, v0, v1
    s_nop 1
    v_add_f32_dpp v2, v2, v2 row_ror:8 row_mask:0xf bank_mask:0xf
    s_nop 1
    v_mov_b32_dpp v0, v2 quad_perm:[0,0,2,2] row_mask:0xf bank_mask:0xf
    v_mov_b32_dpp v1, v2 quad_perm:[1,1,3,3] row_mask:0xf bank_mask:0xf
    s_mov_b64 exec, s[42:43]
    v_cvt_pk_bf16_f32 v72, v0, v1
    v_bfi_b32 v72, v79, s70, v72
    buffer_store_dword v72, v75, s[4:7], s17 offen offset:0
    buffer_store_dword v72, v75, s[4:7], s17 offen offset:1024
    buffer_store_dword v72, v75, s[4:7], s17 offen offset:2048
    buffer_store_dword v72, v75, s[4:7], s17 offen offset:3072
    s_mov_b64 exec, -1
    s_cbranch_scc1 cf_f2_rx
    s_sub_u32 s31, s31, 1
    s_cbranch_scc0 cf_f2_spin
cf_f2_rx:
    v_mov_b64 v[0:1], 0
    v_mov_b64 v[2:3], 0
    v_mov_b64 v[4:5], 0
    v_mov_b64 v[6:7], 0
    s_branch cf_loop
cf_spinB:
    buffer_load_dwordx4 v[40:43], v65, s[4:7], s15 offen nt
cf_spinB_l:
    v_and_b32 v77, s36, v40
    v_cmp_ne_u32 vcc, s70, v77
    s_cbranch_vccz cf_spinB_x
    s_nop 1
    v_and_b32 v77, s36, v40
    v_cmp_ne_u32 vcc, s70, v77
    s_cbranch_vccz cf_spinB_x
    s_nop 1
    v_and_b32 v77, s36, v40
    v_cmp_ne_u32 vcc, s70, v77
    s_cbranch_vccz cf_spinB_x
    s_nop 1
    buffer_load_dwordx4 v[40:43], v65, s[4:7], s15 offen nt
    s_sub_u32 s31, s31, 16
    s_cbranch_scc0 cf_spinB_l
cf_spinB_x:
    ds_write_b128 v65, v[40:43] offset:4096
    s_waitcnt lgkmcnt(0)
    s_branch cf_backB
cf_spin8:
    buffer_load_dwordx4 v[60:63], v65, s[4:7], s16 offen nt
cf_spin8_l:
    v_and_b32 v77, s36, v60
    v_cmp_ne_u32 vcc, s70, v77
    s_cbranch_vccz cf_spin8_x
    s_nop 1
    v_and_b32 v77, s36, v60
    v_cmp_ne_u32 vcc, s70, v77
    s_cbranch_vccz cf_spin8_x
    s_nop 1
    v_and_b32 v77, s36, v60
    v_cmp_ne_u32 vcc, s70, v77
    s_cbranch_vccz cf_spin8_x
    s_nop 1
    buffer_load_dwordx4 v[60:63], v65, s[4:7], s16 offen nt
    s_sub_u32 s31, s31, 16
    s_cbranch_scc0 cf_spin8_l
cf_spin8_x:
    s_branch cf_back8
cf_rare:
    s_mov_b64 exec, s[34:35]
    buffer_store_dwordx4 v[0:3], v65, s[4:7], s28 offen sc1
    s_mov_b64 exec, -1
    s_nop 3
    v_cvt_pk_bf16_f32 v48, v16, v17
    v_cvt_pk_bf16_f32 v49, v18, v19
    v_cvt_pk_bf16_f32 v50, v20, v21
    v_cvt_pk_bf16_f32 v51, v22, v23
    buffer_store_dwordx4 v[48:51], v65, s[4:7], s27 offen sc1
    s_add_u32 s28, s28, 131072
    s_add_u32 s27, s27, 131072
    s_cmp_eq_u32 s30, 63
    s_cbranch_scc1 cf_last
    s_branch cf_rare_x
cf_kvwait:
    s_mov_b32 s41, s97
    v_bfe_u32 v78, v65, 2, 5
    v_mov_b32 v77, v76
    s_nop 1
    v_permlane32_swap_b32 v76, v77
    v_subrev_u32 v77, s95, v77
    v_cmp_lt_u32 vcc, 16, v77
    s_nop 1
    v_cndmask_b32 v77, v77, 0, vcc
    v_bfe_u32 v79, v78, 2, 2
    v_lshl_add_u32 v77, v77, 2, v79
    s_nop 1
    v_min_u32_dpp v77, v77, v77 row_ror:1 row_mask:0xf bank_mask:0xf
    s_nop 1
    v_min_u32_dpp v77, v77, v77 row_ror:2 row_mask:0xf bank_mask:0xf
    s_nop 1
    v_min_u32_dpp v77, v77, v77 row_ror:4 row_mask:0xf bank_mask:0xf
    s_nop 0
    v_readfirstlane_b32 s97, v77
    s_nop 0
    s_max_u32 s97, s97, s41
    s_add_u32 s40, s30, 3
    s_min_u32 s40, s40, 64
    s_cmp_le_u32 s40, s97
    s_cbranch_scc1 cf_kvw_x
    v_bfe_u32 v78, v65, 2, 5
    s_mov_b32 s31, 4194304
cf_kvw:
    buffer_load_dword v77, v78, s[4:7], s96 offen offset:16 sc1
    s_waitcnt vmcnt(0)
    v_subrev_u32 v77, s95, v77
    v_cmp_lt_u32 vcc, 16, v77
    s_nop 1
    v_cndmask_b32 v77, v77, 0, vcc
    v_bfe_u32 v79, v78, 2, 2
    v_lshl_add_u32 v77, v77, 2, v79
    s_nop 1
    v_min_u32_dpp v77, v77, v77 row_ror:1 row_mask:0xf bank_mask:0xf
    s_nop 1
    v_min_u32_dpp v77, v77, v77 row_ror:2 row_mask:0xf bank_mask:0xf
    s_nop 1
    v_min_u32_dpp v77, v77, v77 row_ror:4 row_mask:0xf bank_mask:0xf
    s_nop 0
    v_readfirstlane_b32 s97, v77
    s_sub_u32 s31, s31, 1
    s_cbranch_scc1 cf_kvw_x
    s_cmp_le_u32 s40, s97
    s_cbranch_scc1 cf_kvw_x
    s_sleep 2
    s_branch cf_kvw
cf_kvw_x:
    s_branch cf_kvok
cf_last:
    s_add_u32 s40, s95, 64
    v_mov_b32 v78, s40
    s_waitcnt vmcnt(0)
    s_barrier
    s_mov_b64 exec, s[100:101]
    buffer_store_dword v78, off, s[4:7], s29 sc1
    s_mov_b64 exec, -1
cf_end:
    s_endpgm
L_chain_safe:
    s_load_dwordx8 s[48:55], s[0:1], 8
    s_load_dwordx2 s[56:57], s[0:1], 40
    s_waitcnt lgkmcnt(0)
    v_lshrrev_b32 v77, 6, v0
    s_nop 0
    v_readfirstlane_b32 s13, v77
    v_lshlrev_b32 v65, 4, v0
    v_and_b32 v48, 63, v0
    s_mov_b32 s10, 4718592
    s_mov_b32 s11, 0x20000
    v_lshrrev_b32 v49, 3, v48
    v_mul_u32_u24 v18, 1152, v49
    v_and_b32 v49, 7, v48
    v_lshl_add_u32 v18, v49, 4, v18
    s_mul_i32 s40, s12, 147456
    s_lshl_b32 s41, s13, 8
    s_add_u32 s40, s40, s41
    s_mov_b32 s42, s40
    s_xor_b32 s41, s13, 0
    s_mul_i32 s41, s41, 36864
    s_add_u32 s60, s41, s40
    s_xor_b32 s41, s13, 1
    s_mul_i32 s41, s41, 36864
    s_add_u32 s61, s41, s40
    s_xor_b32 s41, s13, 2
    s_mul_i32 s41, s41, 36864
    s_add_u32 s62, s41, s40
    s_xor_b32 s41, s13, 3
    s_mul_i32 s41, s41, 36864
    s_add_u32 s63, s41, s40
    s_lshl_b32 s43, s13, 12
    s_mov_b64 s[8:9], s[56:57]
    s_add_u32 m0, s43, 0
    s_add_u32 s41, s60, 0
    buffer_load_dwordx4 v18, s[8:11], s41 offen offset:0 nt lds
    s_add_u32 s41, s60, 8192
    buffer_load_dwordx4 v18, s[8:11], s41 offen offset:1024 nt lds
    s_add_u32 s41, s60, 16384
    buffer_load_dwordx4 v18, s[8:11], s41 offen offset:2048 nt lds
    s_add_u32 s41, s60, 24576
    buffer_load_dwordx4 v18, s[8:11], s41 offen offset:3072 nt lds
    s_add_u32 m0, s43, 36864
    s_add_u32 s41, s61, 0
    buffer_load_dwordx4 v18, s[8:11], s41 offen offset:0 nt lds
    s_add_u32 s41, s61, 8192
    buffer_load_dwordx4 v18, s[8:11], s41 offen offset:1024 nt lds
    s_add_u32 s41, s61, 16384
    buffer_load_dwordx4 v18, s[8:11], s41 offen offset:2048 nt lds
    s_add_u32 s41, s61, 24576
    buffer_load_dwordx4 v18, s[8:11], s41 offen offset:3072 nt lds
    s_add_u32 m0, s43, 73728
    s_add_u32 s41, s62, 0
    buffer_load_dwordx4 v18, s[8:11], s41 offen offset:0 nt lds
    s_add_u32 s41, s62, 8192
    buffer_load_dwordx4 v18, s[8:11], s41 offen offset:1024 nt lds
    s_add_u32 s41, s62, 16384
    buffer_load_dwordx4 v18, s[8:11], s41 offen offset:2048 nt lds
    s_add_u32 s41, s62, 24576
    buffer_load_dwordx4 v18, s[8:11], s41 offen offset:3072 nt lds
    s_add_u32 m0, s43, 110592
    s_add_u32 s41, s63, 0
    buffer_load_dwordx4 v18, s[8:11], s41 offen offset:0 nt lds
    s_add_u32 s41, s63, 8192
    buffer_load_dwordx4 v18, s[8:11], s41 offen offset:1024 nt lds
    s_add_u32 s41, s63, 16384
    buffer_load_dwordx4 v18, s[8:11], s41 offen offset:2048 nt lds
    s_add_u32 s41, s63, 24576
    buffer_load_dwordx4 v18, s[8:11], s41 offen offset:3072 nt lds
    v_lshrrev_b32 v49, 1, v48
    v_mul_u32_u24 v19, 1152, v49
    v_and_b32 v49, 1, v48
    v_lshl_add_u32 v19, v49, 4, v19
    s_mul_i32 s41, s13, 224
    s_sub_u32 s41, 1024, s41
    v_add_u32 v19, s41, v19
    v_lshrrev_b32 v49, 4, v48
    v_lshlrev_b32 v50, 2, v49
    v_and_b32 v51, 15, v48
    v_xor_b32 v51, v51, v50
    v_lshlrev_b32 v51, 4, v51
    v_lshl_add_u32 v16, v49, 15, v51
    v_lshrrev_b32 v50, 1, v49
    v_lshl_add_u32 v17, v50, 16, v51
    v_and_b32 v50, 1, v49
    v_lshl_add_u32 v17, v50, 13, v17
    s_lshl_b32 s40, s12, 8
    s_mul_i32 s58, s13, 1048576
    s_add_u32 s58, s58, s40
    s_lshr_b32 s41, s13, 1
    s_mul_i32 s59, s41, 262144
    s_and_b32 s41, s13, 1
    s_lshl_b32 s41, s41, 14
    s_add_u32 s59, s59, s41
    s_add_u32 s59, s59, s40
    s_add_u32 s59, s59, 4194304
    v_bfe_u32 v50, v48, 2, 2
    v_xor_b32 v51, s13, v50
    v_lshlrev_b32 v20, 6, v51
    v_and_b32 v51, 3, v48
    v_lshl_add_u32 v20, v51, 4, v20
    v_lshrrev_b32 v23, 2, v48
    v_lshl_add_u32 v20, v23, 8, v20
    s_xor_b32 s41, s43, 0
    v_add_u32 v24, s41, v20
    s_xor_b32 s41, s43, 4096
    v_add_u32 v25, s41, v20
    s_xor_b32 s41, s43, 8192
    v_add_u32 v26, s41, v20
    s_xor_b32 s41, s43, 12288
    v_add_u32 v27, s41, v20
    v_and_b32 v23, 1, v50
    v_lshl_add_u32 v23, v49, 2, v23
    v_lshrrev_b32 v50, 1, v50
    v_lshlrev_b32 v21, 7, v23
    v_lshl_add_u32 v21, v50, 6, v21
    v_lshl_add_u32 v21, v51, 4, v21
    v_add_u32 v21, s43, v21
    v_lshlrev_b32 v22, 9, v50
    v_xor_b32 v22, v22, v21
    v_lshlrev_b32 v23, 5, v23
    v_lshl_add_u32 v23, v50, 10, v23
    v_lshl_add_u32 v23, v51, 3, v23
    v_add_u32 v23, s43, v23
    v_bfe_u32 v60, v65, 4, 6
    v_and_b32 v61, 15, v60
    v_lshrrev_b32 v62, 4, v60
    v_mov_b32 v64, 0x4444
    v_mov_b32 v77, 0xeeee
    v_cmp_lt_u32 vcc, 7, v61
    s_nop 1
    v_cndmask_b32 v64, v64, v77, vcc
    v_xor_b32 v66, 1024, v65
    v_xor_b32 v67, 2048, v65
    v_xor_b32 v68, 3072, v65
    v_and_b32 v69, 511, v65
    s_mul_i32 s96, s13, 36864
    s_add_u32 s96, s96, 16384
    v_lshlrev_b32 v70, 4, v60
    v_add_u32 v70, s96, v70
    v_lshrrev_b32 v79, 1, v69
    s_lshl_b32 s96, s13, 8
    s_add_u32 s96, s96, 14336
    s_lshl_b32 s33, s13, 10
    s_add_u32 s97, s33, 8192
    v_mov_b32 v77, s97
    v_mov_b32 v78, s96
    v_cmp_lt_u32 vcc, 31, v60
    s_nop 1
    v_cndmask_b32 v71, v77, v78, vcc
    v_add_u32 v71, v71, v79
    v_and_b32 v77, 7, v61
    v_lshrrev_b32 v78, 3, v61
    v_lshlrev_b32 v74, 4, v77
    v_lshl_add_u32 v73, v62, 7, v74
    v_lshl_add_u32 v73, v78, 3, v73
    s_lshl_b32 s96, s13, 9
    v_add_u32 v73, s96, v73
    v_lshl_add_u32 v74, v78, 14, v74
    v_lshl_add_u32 v74, v62, 15, v74
    s_lshl_b32 s96, s13, 17
    v_add_u32 v74, s96, v74
    v_bfe_u32 v77, v61, 2, 1
    v_and_b32 v78, 3, v61
    v_bfe_u32 v79, v61, 1, 2
    s_cmp_lt_u32 s13, 2
    s_cselect_b64 vcc, -1, 0
    v_cndmask_b32 v77, 0, v77, vcc
    v_cndmask_b32 v78, v79, v78, vcc
    v_lshlrev_b32 v75, 7, v77
    v_lshl_add_u32 v75, v62, 4, v75
    v_lshl_add_u32 v75, v78, 2, v75
    v_lshl_add_u32 v58, v77, 3, v78
    v_lshlrev_b32 v79, 1, v78
    v_cndmask_b32 v58, v79, v58, vcc
    s_bfe_u32 s97, s12, 0x10001
    s_lshl_b32 s68, s97, 6
    s_lshl_b32 s97, s97, 2
    v_add_u32 v59, s97, v62
    s_bfe_u32 s96, s12, 0x10002
    s_and_b32 s40, s12, 1
    s_lshl_b32 s96, s96, 1
    s_add_u32 s96, s96, s40
    s_lshr_b32 s97, s12, 3
    s_lshl_b32 s98, s13, 2
    s_add_u32 s98, s98, s97
    s_lshl_b32 s98, s98, 2
    s_add_u32 s98, s98, s96
    s_lshl_b32 s98, s98, 8
    s_lshl_b32 s99, s13, 2
    s_add_u32 s99, s99, s96
    s_lshl_b32 s99, s99, 4
    s_lshl_b32 s41, s97, 1
    s_add_u32 s41, s41, s40
    s_lshl_b32 s41, s41, 7
    s_add_u32 s41, s41, 8192
    s_lshl_b32 s40, s40, 3
    s_add_u32 s40, s40, 512
    s_cmp_lt_u32 s13, 2
    s_cselect_b32 s96, 7, 4
    s_cselect_b32 s98, s98, s41
    s_cselect_b32 s99, s99, s40
    s_cselect_b32 s32, 1, 0
    s_add_u32 s68, s68, s98
    s_lshl_b32 s97, s97, s96
    s_add_u32 s99, s99, s97
    v_add_u32 v58, s99, v58
    s_and_b32 s97, s12, 4
    s_or_b32 s97, s97, s13
    s_cmp_eq_u32 s97, 2
    s_cselect_b32 s32, 2, s32
    s_mov_b32 s8, s48
    s_mov_b32 s9, s49
    s_mov_b32 s10, 9216
    s_cmp_lt_u32 s13, 2
    s_cselect_b32 s96, 8, 2
    v_mul_u32_u24 v77, 1152, v59
    v_lshl_add_u32 v77, v58, 1, v77
    buffer_load_ushort v72, v77, s[8:11], 0 offen
    buffer_load_ushort v76, v77, s[8:11], s96 offen
    s_mov_b32 s10, 4718592
    s_waitcnt vmcnt(12) lgkmcnt(0)
    s_barrier
    s_mov_b64 s[8:9], s[56:57]
    s_add_u32 m0, s43, 147456
    s_add_u32 s41, s42, 0
    buffer_load_dwordx4 v19, s[8:11], s41 offen offset:0 nt lds
    s_add_u32 s41, s42, 35840
    buffer_load_dwordx4 v19, s[8:11], s41 offen offset:1024 nt lds
    s_add_u32 s41, s42, 71680
    buffer_load_dwordx4 v19, s[8:11], s41 offen offset:2048 nt lds
    s_add_u32 s41, s42, 107520
    buffer_load_dwordx4 v19, s[8:11], s41 offen offset:3072 nt lds
    v_mov_b32 v78, v21
    v_mov_b32 v79, v22
    v_add_u32 v77, 0, v79
    ds_read_b64_tr_b16 v[80:81], v77 offset:0
    ds_read_b64_tr_b16 v[82:83], v77 offset:256
    ds_read_b64_tr_b16 v[84:85], v77 offset:2048
    ds_read_b64_tr_b16 v[86:87], v77 offset:2304
    ds_read_b64_tr_b16 v[112:113], v77 offset:8
    ds_read_b64_tr_b16 v[114:115], v77 offset:264
    ds_read_b64_tr_b16 v[116:117], v77 offset:2056
    ds_read_b64_tr_b16 v[118:119], v77 offset:2312
    s_waitcnt vmcnt(12) lgkmcnt(0)
    s_barrier
    s_mov_b64 s[8:9], s[52:53]
    s_add_u32 m0, s43, 0
    s_add_u32 s41, s58, 0
    buffer_load_dwordx4 v16, s[8:11], s41 offen offset:0 nt lds
    s_add_u32 s41, s58, 15360
    buffer_load_dwordx4 v16, s[8:11], s41 offen offset:1024 nt lds
    s_add_u32 s41, s58, 129024
    buffer_load_dwordx4 v16, s[8:11], s41 offen offset:2048 nt lds
    s_add_u32 s41, s58, 144384
    buffer_load_dwordx4 v16, s[8:11], s41 offen offset:3072 nt lds
    v_add_u32 v77, 36864, v78
    ds_read_b64_tr_b16 v[88:89], v77 offset:0
    ds_read_b64_tr_b16 v[90:91], v77 offset:256
    ds_read_b64_tr_b16 v[92:93], v77 offset:2048
    ds_read_b64_tr_b16 v[94:95], v77 offset:2304
    ds_read_b64_tr_b16 v[120:121], v77 offset:8
    ds_read_b64_tr_b16 v[122:123], v77 offset:264
    ds_read_b64_tr_b16 v[124:125], v77 offset:2056
    ds_read_b64_tr_b16 v[126:127], v77 offset:2312
    s_waitcnt vmcnt(12) lgkmcnt(0)
    s_barrier
    s_add_u32 m0, s43, 36864
    s_add_u32 s41, s58, 8192
    buffer_load_dwordx4 v16, s[8:11], s41 offen offset:0 nt lds
    s_add_u32 s41, s58, 23552
    buffer_load_dwordx4 v16, s[8:11], s41 offen offset:1024 nt lds
    s_add_u32 s41, s58, 137216
    buffer_load_dwordx4 v16, s[8:11], s41 offen offset:2048 nt lds
    s_add_u32 s41, s58, 152576
    buffer_load_dwordx4 v16, s[8:11], s41 offen offset:3072 nt lds
    v_add_u32 v77, 73728, v78
    ds_read_b64_tr_b16 v[96:97], v77 offset:0
    ds_read_b64_tr_b16 v[98:99], v77 offset:256
    ds_read_b64_tr_b16 v[100:101], v77 offset:2048
    ds_read_b64_tr_b16 v[102:103], v77 offset:2304
    ds_read_b64_tr_b16 v[128:129], v77 offset:8
    ds_read_b64_tr_b16 v[130:131], v77 offset:264
    ds_read_b64_tr_b16 v[132:133], v77 offset:2056
    ds_read_b64_tr_b16 v[134:135], v77 offset:2312
    s_waitcnt vmcnt(12) lgkmcnt(0)
    s_barrier
    s_add_u32 m0, s43, 73728
    s_add_u32 s41, s58, 262144
    buffer_load_dwordx4 v16, s[8:11], s41 offen offset:0 nt lds
    s_add_u32 s41, s58, 277504
    buffer_load_dwordx4 v16, s[8:11], s41 offen offset:1024 nt lds
    s_add_u32 s41, s58, 391168
    buffer_load_dwordx4 v16, s[8:11], s41 offen offset:2048 nt lds
    s_add_u32 s41, s58, 406528
    buffer_load_dwordx4 v16, s[8:11], s41 offen offset:3072 nt lds
    v_add_u32 v77, 110592, v78
    ds_read_b64_tr_b16 v[104:105], v77 offset:0
    ds_read_b64_tr_b16 v[106:107], v77 offset:256
    ds_read_b64_tr_b16 v[108:109], v77 offset:2048
    ds_read_b64_tr_b16 v[110:111], v77 offset:2304
    ds_read_b64_tr_b16 v[136:137], v77 offset:8
    ds_read_b64_tr_b16 v[138:139], v77 offset:264
    ds_read_b64_tr_b16 v[140:141], v77 offset:2056
    ds_read_b64_tr_b16 v[142:143], v77 offset:2312
    s_waitcnt vmcnt(12) lgkmcnt(0)
    s_barrier
    s_add_u32 m0, s43, 110592
    s_add_u32 s41, s58, 270336
    buffer_load_dwordx4 v16, s[8:11], s41 offen offset:0 nt lds
    s_add_u32 s41, s58, 285696
    buffer_load_dwordx4 v16, s[8:11], s41 offen offset:1024 nt lds
    s_add_u32 s41, s58, 399360
    buffer_load_dwordx4 v16, s[8:11], s41 offen offset:2048 nt lds
    s_add_u32 s41, s58, 414720
    buffer_load_dwordx4 v16, s[8:11], s41 offen offset:3072 nt lds
    v_add_u32 v77, 147456, v23
    ds_read_b64_tr_b16 v[144:145], v77 offset:0
    ds_read_b64_tr_b16 v[146:147], v77 offset:64
    ds_read_b64_tr_b16 v[148:149], v77 offset:512
    ds_read_b64_tr_b16 v[150:151], v77 offset:576
    ds_read_b64_tr_b16 v[152:153], v77 offset:2048
    ds_read_b64_tr_b16 v[154:155], v77 offset:2112
    ds_read_b64_tr_b16 v[156:157], v77 offset:2560
    ds_read_b64_tr_b16 v[158:159], v77 offset:2624
    s_waitcnt vmcnt(12) lgkmcnt(0)
    s_barrier
    s_add_u32 m0, s43, 147456
    s_add_u32 s41, s58, 524288
    buffer_load_dwordx4 v16, s[8:11], s41 offen offset:0 nt lds
    s_add_u32 s41, s58, 539648
    buffer_load_dwordx4 v16, s[8:11], s41 offen offset:1024 nt lds
    s_add_u32 s41, s58, 653312
    buffer_load_dwordx4 v16, s[8:11], s41 offen offset:2048 nt lds
    s_add_u32 s41, s58, 668672
    buffer_load_dwordx4 v16, s[8:11], s41 offen offset:3072 nt lds
    s_cmp_eq_u32 s32, 0
    s_cbranch_scc1 cs_init_done
    v_mov_b32 v52, 1
    v_mov_b32 v53, 1
    v_mov_b32 v54, 1
    v_mov_b32 v55, 1
    v_mov_b32 v56, 0
    v_lshl_or_b32 v72, v76, 16, v72
    s_lshl_b32 s96, s12, 14
    s_add_u32 s96, s96, 68681728
    s_add_u32 s97, s96, 0
    buffer_store_dwordx4 v[52:55], v65, s[4:7], s97 offen sc1
    s_add_u32 s97, s96, 4096
    buffer_store_dwordx4 v[52:55], v65, s[4:7], s97 offen sc1
    s_add_u32 s97, s96, 8192
    buffer_store_dwordx4 v[52:55], v65, s[4:7], s97 offen sc1
    s_add_u32 s97, s96, 12288
    buffer_store_dwordx4 v[52:55], v65, s[4:7], s97 offen sc1
    s_add_u32 s96, s68, 67633152
    s_add_u32 s97, s96, 16384
    buffer_store_dword v56, v75, s[4:7], s96 offen offset:0 sc1
    buffer_store_dword v72, v75, s[4:7], s97 offen offset:0 sc1
    s_cmp_lg_u32 s32, 2
    s_cbranch_scc1 cs_init_done
    buffer_store_dword v56, v75, s[4:7], s96 offen offset:1024 sc1
    buffer_store_dword v72, v75, s[4:7], s97 offen offset:1024 sc1
    buffer_store_dword v56, v75, s[4:7], s96 offen offset:2048 sc1
    buffer_store_dword v72, v75, s[4:7], s97 offen offset:2048 sc1
    buffer_store_dword v56, v75, s[4:7], s96 offen offset:3072 sc1
    buffer_store_dword v72, v75, s[4:7], s97 offen offset:3072 sc1
cs_init_done:
    v_add_u32 v28, 0, v24
    v_add_u32 v29, 0, v25
    v_add_u32 v30, 0, v26
    v_add_u32 v31, 0, v27
    ds_read_b64_tr_b16 a[96:97], v28 offset:0
    ds_read_b64_tr_b16 a[104:105], v28 offset:8
    ds_read_b64_tr_b16 a[112:113], v29 offset:0
    ds_read_b64_tr_b16 a[120:121], v29 offset:8
    ds_read_b64_tr_b16 a[128:129], v30 offset:0
    ds_read_b64_tr_b16 a[136:137], v30 offset:8
    ds_read_b64_tr_b16 a[144:145], v31 offset:0
    ds_read_b64_tr_b16 v[32:33], v31 offset:8
    s_waitcnt vmcnt(12) lgkmcnt(0)
    s_barrier
    s_add_u32 m0, s43, 0
    s_add_u32 s41, s58, 532480
    buffer_load_dwordx4 v16, s[8:11], s41 offen offset:0 nt lds
    s_add_u32 s41, s58, 547840
    buffer_load_dwordx4 v16, s[8:11], s41 offen offset:1024 nt lds
    s_add_u32 s41, s58, 661504
    buffer_load_dwordx4 v16, s[8:11], s41 offen offset:2048 nt lds
    s_add_u32 s41, s58, 676864
    buffer_load_dwordx4 v16, s[8:11], s41 offen offset:3072 nt lds
    ds_write_b64 v70, v[32:33] offset:12288
    v_add_u32 v28, 36864, v24
    v_add_u32 v29, 36864, v25
    v_add_u32 v30, 36864, v26
    v_add_u32 v31, 36864, v27
    ds_read_b64_tr_b16 a[98:99], v28 offset:0
    ds_read_b64_tr_b16 a[106:107], v28 offset:8
    ds_read_b64_tr_b16 a[114:115], v29 offset:0
    ds_read_b64_tr_b16 a[122:123], v29 offset:8
    ds_read_b64_tr_b16 a[130:131], v30 offset:0
    ds_read_b64_tr_b16 a[138:139], v30 offset:8
    ds_read_b64_tr_b16 a[146:147], v31 offset:0
    ds_read_b64_tr_b16 v[0:1], v31 offset:8
    s_waitcnt vmcnt(12) lgkmcnt(0)
    s_barrier
    s_add_u32 m0, s43, 36864
    s_add_u32 s41, s58, 786432
    buffer_load_dwordx4 v16, s[8:11], s41 offen offset:0 nt lds
    s_add_u32 s41, s58, 801792
    buffer_load_dwordx4 v16, s[8:11], s41 offen offset:1024 nt lds
    s_add_u32 s41, s58, 915456
    buffer_load_dwordx4 v16, s[8:11], s41 offen offset:2048 nt lds
    s_add_u32 s41, s58, 930816
    buffer_load_dwordx4 v16, s[8:11], s41 offen offset:3072 nt lds
    ds_write_b64 v70, v[0:1] offset:12296
    v_add_u32 v28, 73728, v24
    v_add_u32 v29, 73728, v25
    v_add_u32 v30, 73728, v26
    v_add_u32 v31, 73728, v27
    ds_read_b64_tr_b16 a[100:101], v28 offset:0
    ds_read_b64_tr_b16 a[108:109], v28 offset:8
    ds_read_b64_tr_b16 a[116:117], v29 offset:0
    ds_read_b64_tr_b16 a[124:125], v29 offset:8
    ds_read_b64_tr_b16 a[132:133], v30 offset:0
    ds_read_b64_tr_b16 a[140:141], v30 offset:8
    ds_read_b64_tr_b16 a[148:149], v31 offset:0
    ds_read_b64_tr_b16 v[32:33], v31 offset:8
    s_waitcnt vmcnt(12) lgkmcnt(0)
    s_barrier
    s_add_u32 m0, s43, 73728
    s_add_u32 s41, s58, 794624
    buffer_load_dwordx4 v16, s[8:11], s41 offen offset:0 nt lds
    s_add_u32 s41, s58, 809984
    buffer_load_dwordx4 v16, s[8:11], s41 offen offset:1024 nt lds
    s_add_u32 s41, s58, 923648
    buffer_load_dwordx4 v16, s[8:11], s41 offen offset:2048 nt lds
    s_add_u32 s41, s58, 939008
    buffer_load_dwordx4 v16, s[8:11], s41 offen offset:3072 nt lds
    ds_write_b64 v70, v[32:33] offset:13312
    v_add_u32 v28, 110592, v24
    v_add_u32 v29, 110592, v25
    v_add_u32 v30, 110592, v26
    v_add_u32 v31, 110592, v27
    ds_read_b64_tr_b16 a[102:103], v28 offset:0
    ds_read_b64_tr_b16 a[110:111], v28 offset:8
    ds_read_b64_tr_b16 a[118:119], v29 offset:0
    ds_read_b64_tr_b16 a[126:127], v29 offset:8
    ds_read_b64_tr_b16 a[134:135], v30 offset:0
    ds_read_b64_tr_b16 a[142:143], v30 offset:8
    ds_read_b64_tr_b16 a[150:151], v31 offset:0
    ds_read_b64_tr_b16 v[0:1], v31 offset:8
    s_waitcnt vmcnt(12) lgkmcnt(0)
    s_barrier
    s_add_u32 m0, s43, 110592
    s_add_u32 s41, s59, 0
    buffer_load_dwordx4 v17, s[8:11], s41 offen offset:0 nt lds
    s_add_u32 s41, s59, 31744
    buffer_load_dwordx4 v17, s[8:11], s41 offen offset:1024 nt lds
    s_add_u32 s41, s59, 129024
    buffer_load_dwordx4 v17, s[8:11], s41 offen offset:2048 nt lds
    s_add_u32 s41, s59, 160768
    buffer_load_dwordx4 v17, s[8:11], s41 offen offset:3072 nt lds
    ds_write_b64 v70, v[0:1] offset:13320
    v_add_u32 v28, 147456, v24
    v_add_u32 v29, 147456, v25
    v_add_u32 v30, 147456, v26
    v_add_u32 v31, 147456, v27
    ds_read_b64_tr_b16 a[152:153], v28 offset:0
    ds_read_b64_tr_b16 a[160:161], v28 offset:8
    ds_read_b64_tr_b16 v[32:33], v29 offset:0
    ds_read_b64_tr_b16 a[168:169], v29 offset:8
    ds_read_b64_tr_b16 a[176:177], v30 offset:0
    ds_read_b64_tr_b16 a[184:185], v30 offset:8
    ds_read_b64_tr_b16 v[34:35], v31 offset:0
    ds_read_b64_tr_b16 a[192:193], v31 offset:8
    s_waitcnt vmcnt(12) lgkmcnt(0)
    s_barrier
    s_mov_b64 s[8:9], s[50:51]
    s_add_u32 m0, s43, 147456
    s_add_u32 s41, s58, 0
    buffer_load_dwordx4 v16, s[8:11], s41 offen offset:0 nt lds
    s_add_u32 s41, s58, 15360
    buffer_load_dwordx4 v16, s[8:11], s41 offen offset:1024 nt lds
    s_add_u32 s41, s58, 129024
    buffer_load_dwordx4 v16, s[8:11], s41 offen offset:2048 nt lds
    s_add_u32 s41, s58, 144384
    buffer_load_dwordx4 v16, s[8:11], s41 offen offset:3072 nt lds
    ds_write_b64 v70, v[32:33] offset:16384
    ds_write_b64 v70, v[34:35] offset:18432
    v_add_u32 v28, 0, v24
    v_add_u32 v29, 0, v25
    v_add_u32 v30, 0, v26
    v_add_u32 v31, 0, v27
    ds_read_b64_tr_b16 a[154:155], v28 offset:0
    ds_read_b64_tr_b16 a[162:163], v28 offset:8
    ds_read_b64_tr_b16 v[0:1], v29 offset:0
    ds_read_b64_tr_b16 a[170:171], v29 offset:8
    ds_read_b64_tr_b16 a[178:179], v30 offset:0
    ds_read_b64_tr_b16 a[186:187], v30 offset:8
    ds_read_b64_tr_b16 v[2:3], v31 offset:0
    ds_read_b64_tr_b16 a[194:195], v31 offset:8
    s_waitcnt vmcnt(12) lgkmcnt(0)
    s_barrier
    s_add_u32 m0, s43, 0
    s_add_u32 s41, s58, 8192
    buffer_load_dwordx4 v16, s[8:11], s41 offen offset:0 nt lds
    s_add_u32 s41, s58, 23552
    buffer_load_dwordx4 v16, s[8:11], s41 offen offset:1024 nt lds
    s_add_u32 s41, s58, 137216
    buffer_load_dwordx4 v16, s[8:11], s41 offen offset:2048 nt lds
    s_add_u32 s41, s58, 152576
    buffer_load_dwordx4 v16, s[8:11], s41 offen offset:3072 nt lds
    ds_write_b64 v70, v[0:1] offset:16392
    ds_write_b64 v70, v[2:3] offset:18440
    v_add_u32 v28, 36864, v24
    v_add_u32 v29, 36864, v25
    v_add_u32 v30, 36864, v26
    v_add_u32 v31, 36864, v27
    ds_read_b64_tr_b16 a[156:157], v28 offset:0
    ds_read_b64_tr_b16 a[164:165], v28 offset:8
    ds_read_b64_tr_b16 v[32:33], v29 offset:0
    ds_read_b64_tr_b16 a[172:173], v29 offset:8
    ds_read_b64_tr_b16 a[180:181], v30 offset:0
    ds_read_b64_tr_b16 a[188:189], v30 offset:8
    ds_read_b64_tr_b16 v[34:35], v31 offset:0
    ds_read_b64_tr_b16 a[196:197], v31 offset:8
    s_waitcnt vmcnt(12) lgkmcnt(0)
    s_barrier
    s_add_u32 m0, s43, 36864
    s_add_u32 s41, s58, 262144
    buffer_load_dwordx4 v16, s[8:11], s41 offen offset:0 nt lds
    s_add_u32 s41, s58, 277504
    buffer_load_dwordx4 v16, s[8:11], s41 offen offset:1024 nt lds
    s_add_u32 s41, s58, 391168
    buffer_load_dwordx4 v16, s[8:11], s41 offen offset:2048 nt lds
    s_add_u32 s41, s58, 406528
    buffer_load_dwordx4 v16, s[8:11], s41 offen offset:3072 nt lds
    ds_write_b64 v70, v[32:33] offset:17408
    ds_write_b64 v70, v[34:35] offset:19456
    v_add_u32 v28, 73728, v24
    v_add_u32 v29, 73728, v25
    v_add_u32 v30, 73728, v26
    v_add_u32 v31, 73728, v27
    ds_read_b64_tr_b16 a[158:159], v28 offset:0
    ds_read_b64_tr_b16 a[166:167], v28 offset:8
    ds_read_b64_tr_b16 v[0:1], v29 offset:0
    ds_read_b64_tr_b16 a[174:175], v29 offset:8
    ds_read_b64_tr_b16 a[182:183], v30 offset:0
    ds_read_b64_tr_b16 a[190:191], v30 offset:8
    ds_read_b64_tr_b16 v[2:3], v31 offset:0
    ds_read_b64_tr_b16 a[198:199], v31 offset:8
    s_waitcnt vmcnt(12) lgkmcnt(0)
    s_barrier
    s_add_u32 m0, s43, 73728
    s_add_u32 s41, s58, 270336
    buffer_load_dwordx4 v16, s[8:11], s41 offen offset:0 nt lds
    s_add_u32 s41, s58, 285696
    buffer_load_dwordx4 v16, s[8:11], s41 offen offset:1024 nt lds
    s_add_u32 s41, s58, 399360
    buffer_load_dwordx4 v16, s[8:11], s41 offen offset:2048 nt lds
    s_add_u32 s41, s58, 414720
    buffer_load_dwordx4 v16, s[8:11], s41 offen offset:3072 nt lds
    ds_write_b64 v70, v[0:1] offset:17416
    ds_write_b64 v70, v[2:3] offset:19464
    v_add_u32 v77, 110592, v20
    ds_read_b64_tr_b16 a[200:201], v77 offset:0
    ds_read_b64_tr_b16 a[202:203], v77 offset:4096
    ds_read_b64_tr_b16 a[204:205], v77 offset:8192
    ds_read_b64_tr_b16 a[206:207], v77 offset:12288
    ds_read_b64_tr_b16 a[208:209], v77 offset:8
    ds_read_b64_tr_b16 a[210:211], v77 offset:4104
    ds_read_b64_tr_b16 a[212:213], v77 offset:8200
    ds_read_b64_tr_b16 a[214:215], v77 offset:12296
    s_waitcnt vmcnt(12) lgkmcnt(0)
    s_barrier
    s_add_u32 m0, s43, 110592
    s_add_u32 s41, s58, 524288
    buffer_load_dwordx4 v16, s[8:11], s41 offen offset:0 nt lds
    s_add_u32 s41, s58, 539648
    buffer_load_dwordx4 v16, s[8:11], s41 offen offset:1024 nt lds
    s_add_u32 s41, s58, 653312
    buffer_load_dwordx4 v16, s[8:11], s41 offen offset:2048 nt lds
    s_add_u32 s41, s58, 668672
    buffer_load_dwordx4 v16, s[8:11], s41 offen offset:3072 nt lds
    v_add_u32 v28, 147456, v24
    v_add_u32 v29, 147456, v25
    v_add_u32 v30, 147456, v26
    v_add_u32 v31, 147456, v27
    ds_read_b64_tr_b16 v[0:1], v28 offset:0
    ds_read_b64_tr_b16 v[2:3], v28 offset:8
    ds_read_b64_tr_b16 v[4:5], v29 offset:0
    ds_read_b64_tr_b16 v[6:7], v29 offset:8
    ds_read_b64_tr_b16 a[0:1], v30 offset:0
    ds_read_b64_tr_b16 v[8:9], v30 offset:8
    ds_read_b64_tr_b16 a[8:9], v31 offset:0
    ds_read_b64_tr_b16 v[10:11], v31 offset:8
    s_waitcnt vmcnt(12) lgkmcnt(0)
    s_barrier
    s_add_u32 m0, s43, 147456
    s_add_u32 s41, s58, 532480
    buffer_load_dwordx4 v16, s[8:11], s41 offen offset:0 nt lds
    s_add_u32 s41, s58, 547840
    buffer_load_dwordx4 v16, s[8:11], s41 offen offset:1024 nt lds
    s_add_u32 s41, s58, 661504
    buffer_load_dwordx4 v16, s[8:11], s41 offen offset:2048 nt lds
    s_add_u32 s41, s58, 676864
    buffer_load_dwordx4 v16, s[8:11], s41 offen offset:3072 nt lds
    ds_write_b64 v70, v[0:1] offset:0
    ds_write_b64 v70, v[2:3] offset:2048
    ds_write_b64 v70, v[4:5] offset:4096
    ds_write_b64 v70, v[6:7] offset:6144
    ds_write_b64 v70, v[8:9] offset:10240
    ds_write_b64 v70, v[10:11] offset:14336
    v_add_u32 v28, 0, v24
    v_add_u32 v29, 0, v25
    v_add_u32 v30, 0, v26
    v_add_u32 v31, 0, v27
    ds_read_b64_tr_b16 v[32:33], v28 offset:0
    ds_read_b64_tr_b16 v[34:35], v28 offset:8
    ds_read_b64_tr_b16 v[36:37], v29 offset:0
    ds_read_b64_tr_b16 v[38:39], v29 offset:8
    ds_read_b64_tr_b16 a[2:3], v30 offset:0
    ds_read_b64_tr_b16 v[40:41], v30 offset:8
    ds_read_b64_tr_b16 a[10:11], v31 offset:0
    ds_read_b64_tr_b16 v[42:43], v31 offset:8
    s_waitcnt vmcnt(12) lgkmcnt(0)
    s_barrier
    s_add_u32 m0, s43, 0
    s_add_u32 s41, s58, 786432
    buffer_load_dwordx4 v16, s[8:11], s41 offen offset:0 nt lds
    s_add_u32 s41, s58, 801792
    buffer_load_dwordx4 v16, s[8:11], s41 offen offset:1024 nt lds
    s_add_u32 s41, s58, 915456
    buffer_load_dwordx4 v16, s[8:11], s41 offen offset:2048 nt lds
    s_add_u32 s41, s58, 930816
    buffer_load_dwordx4 v16, s[8:11], s41 offen offset:3072 nt lds
    ds_write_b64 v70, v[32:33] offset:8
    ds_write_b64 v70, v[34:35] offset:2056
    ds_write_b64 v70, v[36:37] offset:4104
    ds_write_b64 v70, v[38:39] offset:6152
    ds_write_b64 v70, v[40:41] offset:10248
    ds_write_b64 v70, v[42:43] offset:14344
    v_add_u32 v28, 36864, v24
    v_add_u32 v29, 36864, v25
    v_add_u32 v30, 36864, v26
    v_add_u32 v31, 36864, v27
    ds_read_b64_tr_b16 v[0:1], v28 offset:0
    ds_read_b64_tr_b16 v[2:3], v28 offset:8
    ds_read_b64_tr_b16 v[4:5], v29 offset:0
    ds_read_b64_tr_b16 v[6:7], v29 offset:8
    ds_read_b64_tr_b16 a[4:5], v30 offset:0
    ds_read_b64_tr_b16 v[8:9], v30 offset:8
    ds_read_b64_tr_b16 a[12:13], v31 offset:0
    ds_read_b64_tr_b16 v[10:11], v31 offset:8
    s_waitcnt vmcnt(12) lgkmcnt(0)
    s_barrier
    s_add_u32 m0, s43, 36864
    s_add_u32 s41, s58, 794624
    buffer_load_dwordx4 v16, s[8:11], s41 offen offset:0 nt lds
    s_add_u32 s41, s58, 809984
    buffer_load_dwordx4 v16, s[8:11], s41 offen offset:1024 nt lds
    s_add_u32 s41, s58, 923648
    buffer_load_dwordx4 v16, s[8:11], s41 offen offset:2048 nt lds
    s_add_u32 s41, s58, 939008
    buffer_load_dwordx4 v16, s[8:11], s41 offen offset:3072 nt lds
    ds_write_b64 v70, v[0:1] offset:1024
    ds_write_b64 v70, v[2:3] offset:3072
    ds_write_b64 v70, v[4:5] offset:5120
    ds_write_b64 v70, v[6:7] offset:7168
    ds_write_b64 v70, v[8:9] offset:11264
    ds_write_b64 v70, v[10:11] offset:15360
    v_add_u32 v28, 73728, v24
    v_add_u32 v29, 73728, v25
    v_add_u32 v30, 73728, v26
    v_add_u32 v31, 73728, v27
    ds_read_b64_tr_b16 v[32:33], v28 offset:0
    ds_read_b64_tr_b16 v[34:35], v28 offset:8
    ds_read_b64_tr_b16 v[36:37], v29 offset:0
    ds_read_b64_tr_b16 v[38:39], v29 offset:8
    ds_read_b64_tr_b16 a[6:7], v30 offset:0
    ds_read_b64_tr_b16 v[40:41], v30 offset:8
    ds_read_b64_tr_b16 a[14:15], v31 offset:0
    ds_read_b64_tr_b16 v[42:43], v31 offset:8
    s_waitcnt vmcnt(12) lgkmcnt(0)
    s_barrier
    s_add_u32 m0, s43, 73728
    s_add_u32 s41, s59, 0
    buffer_load_dwordx4 v17, s[8:11], s41 offen offset:0 nt lds
    s_add_u32 s41, s59, 31744
    buffer_load_dwordx4 v17, s[8:11], s41 offen offset:1024 nt lds
    s_add_u32 s41, s59, 129024
    buffer_load_dwordx4 v17, s[8:11], s41 offen offset:2048 nt lds
    s_add_u32 s41, s59, 160768
    buffer_load_dwordx4 v17, s[8:11], s41 offen offset:3072 nt lds
    ds_write_b64 v70, v[32:33] offset:1032
    ds_write_b64 v70, v[34:35] offset:3080
    ds_write_b64 v70, v[36:37] offset:5128
    ds_write_b64 v70, v[38:39] offset:7176
    ds_write_b64 v70, v[40:41] offset:11272
    ds_write_b64 v70, v[42:43] offset:15368
    v_add_u32 v28, 110592, v24
    v_add_u32 v29, 110592, v25
    v_add_u32 v30, 110592, v26
    v_add_u32 v31, 110592, v27
    ds_read_b64_tr_b16 a[16:17], v28 offset:0
    ds_read_b64_tr_b16 a[24:25], v28 offset:8
    ds_read_b64_tr_b16 a[32:33], v29 offset:0
    ds_read_b64_tr_b16 a[40:41], v29 offset:8
    ds_read_b64_tr_b16 a[48:49], v30 offset:0
    ds_read_b64_tr_b16 a[56:57], v30 offset:8
    ds_read_b64_tr_b16 a[64:65], v31 offset:0
    ds_read_b64_tr_b16 a[72:73], v31 offset:8
    s_waitcnt vmcnt(12) lgkmcnt(0)
    s_barrier
    s_mov_b64 s[8:9], s[54:55]
    s_add_u32 m0, s43, 110592
    s_add_u32 s41, s58, 0
    buffer_load_dwordx4 v16, s[8:11], s41 offen offset:0 nt lds
    s_add_u32 s41, s58, 15360
    buffer_load_dwordx4 v16, s[8:11], s41 offen offset:1024 nt lds
    s_add_u32 s41, s58, 129024
    buffer_load_dwordx4 v16, s[8:11], s41 offen offset:2048 nt lds
    s_add_u32 s41, s58, 144384
    buffer_load_dwordx4 v16, s[8:11], s41 offen offset:3072 nt lds
    v_add_u32 v28, 147456, v24
    v_add_u32 v29, 147456, v25
    v_add_u32 v30, 147456, v26
    v_add_u32 v31, 147456, v27
    ds_read_b64_tr_b16 a[18:19], v28 offset:0
    ds_read_b64_tr_b16 a[26:27], v28 offset:8
    ds_read_b64_tr_b16 a[34:35], v29 offset:0
    ds_read_b64_tr_b16 a[42:43], v29 offset:8
    ds_read_b64_tr_b16 a[50:51], v30 offset:0
    ds_read_b64_tr_b16 a[58:59], v30 offset:8
    ds_read_b64_tr_b16 a[66:67], v31 offset:0
    ds_read_b64_tr_b16 a[74:75], v31 offset:8
    s_waitcnt vmcnt(12) lgkmcnt(0)
    s_barrier
    s_add_u32 m0, s43, 147456
    s_add_u32 s41, s58, 8192
    buffer_load_dwordx4 v16, s[8:11], s41 offen offset:0 nt lds
    s_add_u32 s41, s58, 23552
    buffer_load_dwordx4 v16, s[8:11], s41 offen offset:1024 nt lds
    s_add_u32 s41, s58, 137216
    buffer_load_dwordx4 v16, s[8:11], s41 offen offset:2048 nt lds
    s_add_u32 s41, s58, 152576
    buffer_load_dwordx4 v16, s[8:11], s41 offen offset:3072 nt lds
    v_add_u32 v28, 0, v24
    v_add_u32 v29, 0, v25
    v_add_u32 v30, 0, v26
    v_add_u32 v31, 0, v27
    ds_read_b64_tr_b16 a[20:21], v28 offset:0
    ds_read_b64_tr_b16 a[28:29], v28 offset:8
    ds_read_b64_tr_b16 a[36:37], v29 offset:0
    ds_read_b64_tr_b16 a[44:45], v29 offset:8
    ds_read_b64_tr_b16 a[52:53], v30 offset:0
    ds_read_b64_tr_b16 a[60:61], v30 offset:8
    ds_read_b64_tr_b16 a[68:69], v31 offset:0
    ds_read_b64_tr_b16 a[76:77], v31 offset:8
    s_waitcnt vmcnt(12) lgkmcnt(0)
    s_barrier
    s_add_u32 m0, s43, 0
    s_add_u32 s41, s58, 262144
    buffer_load_dwordx4 v16, s[8:11], s41 offen offset:0 nt lds
    s_add_u32 s41, s58, 277504
    buffer_load_dwordx4 v16, s[8:11], s41 offen offset:1024 nt lds
    s_add_u32 s41, s58, 391168
    buffer_load_dwordx4 v16, s[8:11], s41 offen offset:2048 nt lds
    s_add_u32 s41, s58, 406528
    buffer_load_dwordx4 v16, s[8:11], s41 offen offset:3072 nt lds
    v_add_u32 v28, 36864, v24
    v_add_u32 v29, 36864, v25
    v_add_u32 v30, 36864, v26
    v_add_u32 v31, 36864, v27
    ds_read_b64_tr_b16 a[22:23], v28 offset:0
    ds_read_b64_tr_b16 a[30:31], v28 offset:8
    ds_read_b64_tr_b16 a[38:39], v29 offset:0
    ds_read_b64_tr_b16 a[46:47], v29 offset:8
    ds_read_b64_tr_b16 a[54:55], v30 offset:0
    ds_read_b64_tr_b16 a[62:63], v30 offset:8
    ds_read_b64_tr_b16 a[70:71], v31 offset:0
    ds_read_b64_tr_b16 a[78:79], v31 offset:8
    s_waitcnt vmcnt(12) lgkmcnt(0)
    s_barrier
    s_add_u32 m0, s43, 36864
    s_add_u32 s41, s58, 270336
    buffer_load_dwordx4 v16, s[8:11], s41 offen offset:0 nt lds
    s_add_u32 s41, s58, 285696
    buffer_load_dwordx4 v16, s[8:11], s41 offen offset:1024 nt lds
    s_add_u32 s41, s58, 399360
    buffer_load_dwordx4 v16, s[8:11], s41 offen offset:2048 nt lds
    s_add_u32 s41, s58, 414720
    buffer_load_dwordx4 v16, s[8:11], s41 offen offset:3072 nt lds
    v_add_u32 v77, 73728, v20
    ds_read_b64_tr_b16 a[80:81], v77 offset:0
    ds_read_b64_tr_b16 a[82:83], v77 offset:4096
    ds_read_b64_tr_b16 a[84:85], v77 offset:8192
    ds_read_b64_tr_b16 a[86:87], v77 offset:12288
    ds_read_b64_tr_b16 a[88:89], v77 offset:8
    ds_read_b64_tr_b16 a[90:91], v77 offset:4104
    ds_read_b64_tr_b16 a[92:93], v77 offset:8200
    ds_read_b64_tr_b16 a[94:95], v77 offset:12296
    s_waitcnt vmcnt(12) lgkmcnt(0)
    s_barrier
    s_add_u32 m0, s43, 73728
    s_add_u32 s41, s58, 524288
    buffer_load_dwordx4 v16, s[8:11], s41 offen offset:0 nt lds
    s_add_u32 s41, s58, 539648
    buffer_load_dwordx4 v16, s[8:11], s41 offen offset:1024 nt lds
    s_add_u32 s41, s58, 653312
    buffer_load_dwordx4 v16, s[8:11], s41 offen offset:2048 nt lds
    s_add_u32 s41, s58, 668672
    buffer_load_dwordx4 v16, s[8:11], s41 offen offset:3072 nt lds
    v_add_u32 v28, 110592, v24
    v_add_u32 v29, 110592, v25
    v_add_u32 v30, 110592, v26
    v_add_u32 v31, 110592, v27
    ds_read_b64_tr_b16 a[216:217], v28 offset:0
    ds_read_b64_tr_b16 v[32:33], v28 offset:8
    ds_read_b64_tr_b16 a[224:225], v29 offset:0
    ds_read_b64_tr_b16 a[232:233], v29 offset:8
    ds_read_b64_tr_b16 a[240:241], v30 offset:0
    ds_read_b64_tr_b16 a[248:249], v30 offset:8
    ds_read_b64_tr_b16 v[160:161], v31 offset:0
    ds_read_b64_tr_b16 v[168:169], v31 offset:8
    s_waitcnt vmcnt(12) lgkmcnt(0)
    s_barrier
    s_add_u32 m0, s43, 110592
    s_add_u32 s41, s58, 532480
    buffer_load_dwordx4 v16, s[8:11], s41 offen offset:0 nt lds
    s_add_u32 s41, s58, 547840
    buffer_load_dwordx4 v16, s[8:11], s41 offen offset:1024 nt lds
    s_add_u32 s41, s58, 661504
    buffer_load_dwordx4 v16, s[8:11], s41 offen offset:2048 nt lds
    s_add_u32 s41, s58, 676864
    buffer_load_dwordx4 v16, s[8:11], s41 offen offset:3072 nt lds
    ds_write_b64 v70, v[32:33] offset:8192
    v_add_u32 v28, 147456, v24
    v_add_u32 v29, 147456, v25
    v_add_u32 v30, 147456, v26
    v_add_u32 v31, 147456, v27
    ds_read_b64_tr_b16 a[218:219], v28 offset:0
    ds_read_b64_tr_b16 v[0:1], v28 offset:8
    ds_read_b64_tr_b16 a[226:227], v29 offset:0
    ds_read_b64_tr_b16 a[234:235], v29 offset:8
    ds_read_b64_tr_b16 a[242:243], v30 offset:0
    ds_read_b64_tr_b16 a[250:251], v30 offset:8
    ds_read_b64_tr_b16 v[162:163], v31 offset:0
    ds_read_b64_tr_b16 v[170:171], v31 offset:8
    s_waitcnt vmcnt(12) lgkmcnt(0)
    s_barrier
    s_add_u32 m0, s43, 147456
    s_add_u32 s41, s58, 786432
    buffer_load_dwordx4 v16, s[8:11], s41 offen offset:0 nt lds
    s_add_u32 s41, s58, 801792
    buffer_load_dwordx4 v16, s[8:11], s41 offen offset:1024 nt lds
    s_add_u32 s41, s58, 915456
    buffer_load_dwordx4 v16, s[8:11], s41 offen offset:2048 nt lds
    s_add_u32 s41, s58, 930816
    buffer_load_dwordx4 v16, s[8:11], s41 offen offset:3072 nt lds
    ds_write_b64 v70, v[0:1] offset:8200
    v_add_u32 v28, 0, v24
    v_add_u32 v29, 0, v25
    v_add_u32 v30, 0, v26
    v_add_u32 v31, 0, v27
    ds_read_b64_tr_b16 a[220:221], v28 offset:0
    ds_read_b64_tr_b16 v[32:33], v28 offset:8
    ds_read_b64_tr_b16 a[228:229], v29 offset:0
    ds_read_b64_tr_b16 a[236:237], v29 offset:8
    ds_read_b64_tr_b16 a[244:245], v30 offset:0
    ds_read_b64_tr_b16 a[252:253], v30 offset:8
    ds_read_b64_tr_b16 v[164:165], v31 offset:0
    ds_read_b64_tr_b16 v[172:173], v31 offset:8
    s_waitcnt vmcnt(12) lgkmcnt(0)
    s_barrier
    s_add_u32 m0, s43, 0
    s_add_u32 s41, s58, 794624
    buffer_load_dwordx4 v16, s[8:11], s41 offen offset:0 nt lds
    s_add_u32 s41, s58, 809984
    buffer_load_dwordx4 v16, s[8:11], s41 offen offset:1024 nt lds
    s_add_u32 s41, s58, 923648
    buffer_load_dwordx4 v16, s[8:11], s41 offen offset:2048 nt lds
    s_add_u32 s41, s58, 939008
    buffer_load_dwordx4 v16, s[8:11], s41 offen offset:3072 nt lds
    ds_write_b64 v70, v[32:33] offset:9216
    v_add_u32 v28, 36864, v24
    v_add_u32 v29, 36864, v25
    v_add_u32 v30, 36864, v26
    v_add_u32 v31, 36864, v27
    ds_read_b64_tr_b16 a[222:223], v28 offset:0
    ds_read_b64_tr_b16 v[0:1], v28 offset:8
    ds_read_b64_tr_b16 a[230:231], v29 offset:0
    ds_read_b64_tr_b16 a[238:239], v29 offset:8
    ds_read_b64_tr_b16 a[246:247], v30 offset:0
    ds_read_b64_tr_b16 a[254:255], v30 offset:8
    ds_read_b64_tr_b16 v[166:167], v31 offset:0
    ds_read_b64_tr_b16 v[174:175], v31 offset:8
    s_waitcnt vmcnt(12) lgkmcnt(0)
    s_barrier
    s_add_u32 m0, s43, 36864
    s_add_u32 s41, s59, 0
    buffer_load_dwordx4 v17, s[8:11], s41 offen offset:0 nt lds
    s_add_u32 s41, s59, 31744
    buffer_load_dwordx4 v17, s[8:11], s41 offen offset:1024 nt lds
    s_add_u32 s41, s59, 129024
    buffer_load_dwordx4 v17, s[8:11], s41 offen offset:2048 nt lds
    s_add_u32 s41, s59, 160768
    buffer_load_dwordx4 v17, s[8:11], s41 offen offset:3072 nt lds
    ds_write_b64 v70, v[0:1] offset:9224
    v_add_u32 v28, 73728, v24
    v_add_u32 v29, 73728, v25
    v_add_u32 v30, 73728, v26
    v_add_u32 v31, 73728, v27
    ds_read_b64_tr_b16 v[176:177], v28 offset:0
    ds_read_b64_tr_b16 v[184:185], v28 offset:8
    ds_read_b64_tr_b16 v[192:193], v29 offset:0
    ds_read_b64_tr_b16 v[200:201], v29 offset:8
    ds_read_b64_tr_b16 v[208:209], v30 offset:0
    ds_read_b64_tr_b16 v[216:217], v30 offset:8
    ds_read_b64_tr_b16 v[224:225], v31 offset:0
    ds_read_b64_tr_b16 v[232:233], v31 offset:8
    s_waitcnt vmcnt(12) lgkmcnt(0)
    s_barrier
    s_mov_b64 s[8:9], s[56:57]
    s_add_u32 m0, s43, 73728
    s_add_u32 s41, s60, 128
    buffer_load_dwordx4 v18, s[8:11], s41 offen offset:0 nt lds
    s_add_u32 s41, s60, 8320
    buffer_load_dwordx4 v18, s[8:11], s41 offen offset:1024 nt lds
    s_add_u32 s41, s60, 16512
    buffer_load_dwordx4 v18, s[8:11], s41 offen offset:2048 nt lds
    s_add_u32 s41, s60, 24704
    buffer_load_dwordx4 v18, s[8:11], s41 offen offset:3072 nt lds
    v_add_u32 v28, 110592, v24
    v_add_u32 v29, 110592, v25
    v_add_u32 v30, 110592, v26
    v_add_u32 v31, 110592, v27
    ds_read_b64_tr_b16 v[178:179], v28 offset:0
    ds_read_b64_tr_b16 v[186:187], v28 offset:8
    ds_read_b64_tr_b16 v[194:195], v29 offset:0
    ds_read_b64_tr_b16 v[202:203], v29 offset:8
    ds_read_b64_tr_b16 v[210:211], v30 offset:0
    ds_read_b64_tr_b16 v[218:219], v30 offset:8
    ds_read_b64_tr_b16 v[226:227], v31 offset:0
    ds_read_b64_tr_b16 v[234:235], v31 offset:8
    s_waitcnt vmcnt(12) lgkmcnt(0)
    s_barrier
    s_add_u32 m0, s43, 110592
    s_add_u32 s41, s61, 128
    buffer_load_dwordx4 v18, s[8:11], s41 offen offset:0 nt lds
    s_add_u32 s41, s61, 8320
    buffer_load_dwordx4 v18, s[8:11], s41 offen offset:1024 nt lds
    s_add_u32 s41, s61, 16512
    buffer_load_dwordx4 v18, s[8:11], s41 offen offset:2048 nt lds
    s_add_u32 s41, s61, 24704
    buffer_load_dwordx4 v18, s[8:11], s41 offen offset:3072 nt lds
    v_add_u32 v28, 147456, v24
    v_add_u32 v29, 147456, v25
    v_add_u32 v30, 147456, v26
    v_add_u32 v31, 147456, v27
    ds_read_b64_tr_b16 v[180:181], v28 offset:0
    ds_read_b64_tr_b16 v[188:189], v28 offset:8
    ds_read_b64_tr_b16 v[196:197], v29 offset:0
    ds_read_b64_tr_b16 v[204:205], v29 offset:8
    ds_read_b64_tr_b16 v[212:213], v30 offset:0
    ds_read_b64_tr_b16 v[220:221], v30 offset:8
    ds_read_b64_tr_b16 v[228:229], v31 offset:0
    ds_read_b64_tr_b16 v[236:237], v31 offset:8
    s_waitcnt vmcnt(12) lgkmcnt(0)
    s_barrier
    s_add_u32 m0, s43, 147456
    s_add_u32 s41, s62, 128
    buffer_load_dwordx4 v18, s[8:11], s41 offen offset:0 nt lds
    s_add_u32 s41, s62, 8320
    buffer_load_dwordx4 v18, s[8:11], s41 offen offset:1024 nt lds
    s_add_u32 s41, s62, 16512
    buffer_load_dwordx4 v18, s[8:11], s41 offen offset:2048 nt lds
    s_add_u32 s41, s62, 24704
    buffer_load_dwordx4 v18, s[8:11], s41 offen offset:3072 nt lds
    v_add_u32 v28, 0, v24
    v_add_u32 v29, 0, v25
    v_add_u32 v30, 0, v26
    v_add_u32 v31, 0, v27
    ds_read_b64_tr_b16 v[182:183], v28 offset:0
    ds_read_b64_tr_b16 v[190:191], v28 offset:8
    ds_read_b64_tr_b16 v[198:199], v29 offset:0
    ds_read_b64_tr_b16 v[206:207], v29 offset:8
    ds_read_b64_tr_b16 v[214:215], v30 offset:0
    ds_read_b64_tr_b16 v[222:223], v30 offset:8
    ds_read_b64_tr_b16 v[230:231], v31 offset:0
    ds_read_b64_tr_b16 v[238:239], v31 offset:8
    s_waitcnt vmcnt(12) lgkmcnt(0)
    s_barrier
    s_add_u32 m0, s43, 0
    s_add_u32 s41, s63, 128
    buffer_load_dwordx4 v18, s[8:11], s41 offen offset:0 nt lds
    s_add_u32 s41, s63, 8320
    buffer_load_dwordx4 v18, s[8:11], s41 offen offset:1024 nt lds
    s_add_u32 s41, s63, 16512
    buffer_load_dwordx4 v18, s[8:11], s41 offen offset:2048 nt lds
    s_add_u32 s41, s63, 24704
    buffer_load_dwordx4 v18, s[8:11], s41 offen offset:3072 nt lds
    v_mov_b32 v78, v21
    v_mov_b32 v79, v22
    v_add_u32 v77, 36864, v20
    ds_read_b64_tr_b16 v[240:241], v77 offset:0
    ds_read_b64_tr_b16 v[242:243], v77 offset:4096
    ds_read_b64_tr_b16 v[244:245], v77 offset:8192
    ds_read_b64_tr_b16 v[246:247], v77 offset:12288
    ds_read_b64_tr_b16 v[248:249], v77 offset:8
    ds_read_b64_tr_b16 v[250:251], v77 offset:4104
    ds_read_b64_tr_b16 v[252:253], v77 offset:8200
    ds_read_b64_tr_b16 v[254:255], v77 offset:12296
    s_waitcnt vmcnt(12) lgkmcnt(0)
    s_barrier
    v_add_u32 v77, 73728, v79
    s_waitcnt lgkmcnt(0)
    ds_read_b64_tr_b16 v[0:1], v77 offset:0
    ds_read_b64_tr_b16 v[2:3], v77 offset:256
    ds_read_b64_tr_b16 v[4:5], v77 offset:2048
    ds_read_b64_tr_b16 v[6:7], v77 offset:2304
    ds_read_b64_tr_b16 v[8:9], v77 offset:8
    ds_read_b64_tr_b16 v[10:11], v77 offset:264
    ds_read_b64_tr_b16 v[12:13], v77 offset:2056
    ds_read_b64_tr_b16 v[14:15], v77 offset:2312
    s_waitcnt vmcnt(8) lgkmcnt(0)
    s_barrier
    v_add_u32 v77, 110592, v78
    ds_read_b64_tr_b16 v[16:17], v77 offset:0
    ds_read_b64_tr_b16 v[18:19], v77 offset:256
    ds_read_b64_tr_b16 v[20:21], v77 offset:2048
    ds_read_b64_tr_b16 v[22:23], v77 offset:2304
    ds_read_b64_tr_b16 v[24:25], v77 offset:8
    ds_read_b64_tr_b16 v[26:27], v77 offset:264
    ds_read_b64_tr_b16 v[28:29], v77 offset:2056
    ds_read_b64_tr_b16 v[30:31], v77 offset:2312
    s_waitcnt vmcnt(4) lgkmcnt(0)
    s_barrier
    v_add_u32 v77, 147456, v78
    ds_read_b64_tr_b16 v[32:33], v77 offset:0
    ds_read_b64_tr_b16 v[34:35], v77 offset:256
    ds_read_b64_tr_b16 v[36:37], v77 offset:2048
    ds_read_b64_tr_b16 v[38:39], v77 offset:2304
    ds_read_b64_tr_b16 v[40:41], v77 offset:8
    ds_read_b64_tr_b16 v[42:43], v77 offset:264
    ds_read_b64_tr_b16 v[44:45], v77 offset:2056
    ds_read_b64_tr_b16 v[46:47], v77 offset:2312
    s_waitcnt vmcnt(0) lgkmcnt(0)
    s_barrier
    v_add_u32 v77, 0, v78
    ds_read_b64_tr_b16 v[48:49], v77 offset:0
    ds_read_b64_tr_b16 v[50:51], v77 offset:256
    ds_read_b64_tr_b16 v[52:53], v77 offset:2048
    ds_read_b64_tr_b16 v[54:55], v77 offset:2304
    ds_read_b64_tr_b16 v[56:57], v77 offset:8
    ds_read_b64_tr_b16 v[58:59], v77 offset:264
    ds_read_b64_tr_b16 v[60:61], v77 offset:2056
    ds_read_b64_tr_b16 v[62:63], v77 offset:2312
    s_waitcnt lgkmcnt(0)
    s_barrier
    ds_write_b128 v70, v[0:3] offset:20480
    ds_write_b128 v70, v[4:7] offset:21504
    ds_write_b128 v70, v[8:11] offset:22528
    ds_write_b128 v70, v[12:15] offset:23552
    ds_write_b128 v70, v[16:19] offset:24576
    ds_write_b128 v70, v[20:23] offset:25600
    ds_write_b128 v70, v[24:27] offset:26624
    ds_write_b128 v70, v[28:31] offset:27648
    ds_write_b128 v70, v[32:35] offset:28672
    ds_write_b128 v70, v[36:39] offset:29696
    ds_write_b128 v70, v[40:43] offset:30720
    ds_write_b128 v70, v[44:47] offset:31744
    ds_write_b128 v70, v[48:51] offset:32768
    ds_write_b128 v70, v[52:55] offset:33792
    ds_write_b128 v70, v[56:59] offset:34816
    ds_write_b128 v70, v[60:63] offset:35840
    s_waitcnt lgkmcnt(0)
    v_bfe_u32 v60, v65, 4, 6
    v_and_b32 v61, 15, v60
    v_lshrrev_b32 v62, 4, v60
    v_mov_b32 v50, 0x3f80
    v_mov_b32 v51, 0x3f800000
    v_and_b32 v77, 1, v62
    v_lshlrev_b32 v77, 2, v77
    v_sub_u32 v77, v61, v77
    v_and_b32 v78, 3, v61
    v_lshlrev_b32 v78, 2, v78
    v_lshrrev_b32 v79, 2, v61
    v_add_u32 v78, v78, v79
    v_cmp_eq_u32 vcc, 0, v77
    s_nop 1
    v_cndmask_b32 v8, 0, v50, vcc
    v_cmp_eq_u32 vcc, 1, v77
    s_nop 1
    v_cndmask_b32 v8, v8, v51, vcc
    v_cmp_eq_u32 vcc, 0, v78
    s_nop 1
    v_cndmask_b32 v12, 0, v50, vcc
    v_cmp_eq_u32 vcc, 1, v78
    s_nop 1
    v_cndmask_b32 v12, v12, v51, vcc
    v_cmp_eq_u32 vcc, 2, v77
    s_nop 1
    v_cndmask_b32 v9, 0, v50, vcc
    v_cmp_eq_u32 vcc, 3, v77
    s_nop 1
    v_cndmask_b32 v9, v9, v51, vcc
    v_cmp_eq_u32 vcc, 2, v78
    s_nop 1
    v_cndmask_b32 v13, 0, v50, vcc
    v_cmp_eq_u32 vcc, 3, v78
    s_nop 1
    v_cndmask_b32 v13, v13, v51, vcc
    v_cmp_eq_u32 vcc, 8, v77
    s_nop 1
    v_cndmask_b32 v10, 0, v50, vcc
    v_cmp_eq_u32 vcc, 9, v77
    s_nop 1
    v_cndmask_b32 v10, v10, v51, vcc
    v_cmp_eq_u32 vcc, 4, v78
    s_nop 1
    v_cndmask_b32 v14, 0, v50, vcc
    v_cmp_eq_u32 vcc, 5, v78
    s_nop 1
    v_cndmask_b32 v14, v14, v51, vcc
    v_cmp_eq_u32 vcc, 10, v77
    s_nop 1
    v_cndmask_b32 v11, 0, v50, vcc
    v_cmp_eq_u32 vcc, 11, v77
    s_nop 1
    v_cndmask_b32 v11, v11, v51, vcc
    v_cmp_eq_u32 vcc, 6, v78
    s_nop 1
    v_cndmask_b32 v15, 0, v50, vcc
    v_cmp_eq_u32 vcc, 7, v78
    s_nop 1
    v_cndmask_b32 v15, v15, v51, vcc
    v_lshlrev_b32 v77, 4, v61
    ds_write_b128 v69, v[8:11] offset:15360
    ds_write_b128 v77, v[12:15] offset:15872
    s_waitcnt vmcnt(0) lgkmcnt(0)
    s_barrier
    v_mov_b32 v2, 1
    s_cmp_lg_u32 s13, 0
    s_cbranch_scc1 cs_noarr
    s_mov_b64 exec, 1
    buffer_atomic_add v2, off, s[84:87], 0 offset:212
    s_mov_b32 s40, 16777216
    s_mov_b32 s42, 2
cs_startpoll:
    buffer_load_dword v3, off, s[84:87], 0 offset:212 sc1
    s_sub_u32 s40, s40, 1
    s_cbranch_scc1 cs_decide
    s_waitcnt vmcnt(0)
    v_readfirstlane_b32 s41, v3
    s_nop 1
    s_cmp_lt_u32 s41, 32
    s_cbranch_scc1 cs_startpoll
    s_mov_b32 s42, 1
cs_decide:
    s_mov_b64 exec, -1
cs_noarr:
    s_barrier
    s_mov_b32 s44, 0x3e0293ee
    s_mov_b32 s45, s44
    s_or_b32 s66, s44, 0x80000000
    s_mov_b32 s48, 0x3f003f00
    s_mov_b32 s49, 0
    s_mov_b32 s50, 0x3f803f80
    s_mov_b32 s51, 0x3f803f80
    s_mov_b32 s52, 512
    s_mov_b32 s53, 1024
    s_mov_b32 s54, 1536
    s_mov_b32 s30, 0
    s_lshl_b32 s47, s13, 9
    s_cmp_lg_u32 s32, 0
    s_cselect_b32 s71, s13, 3
    s_add_u32 s46, s71, 1
    s_lshr_b32 s46, s46, 1
    s_mov_b32 s14, 67649536
    s_mov_b32 s15, 67653632
    s_mov_b32 s16, 67657728
    s_mov_b32 s36, 0
    s_add_u32 s17, s68, 67633152
    s_mov_b32 s69, 0
    s_mov_b32 s70, 0
    s_lshl_b32 s26, s12, 14
    s_add_u32 s26, s26, 0
    s_mul_i32 s40, s13, 3072
    s_add_u32 s24, s26, s40
    s_lshl_b32 s96, s12, 7
    s_add_u32 s29, s96, 125845504
    s_add_u32 s96, s96, 125829120
    s_lshl_b32 s40, s12, 14
    s_add_u32 s40, s40, 68681728
    s_add_u32 s18, s40, 0
    s_add_u32 s19, s40, 4096
    s_add_u32 s20, s40, 8192
    s_add_u32 s21, s40, 12288
    s_lshr_b32 s40, s12, 3
    s_lshl_b32 s40, s40, 12
    s_and_b32 s41, s12, 7
    s_lshl_b32 s41, s41, 7
    s_add_u32 s40, s40, s41
    s_add_u32 s22, s40, 68681728
    s_add_u32 s23, s22, 1024
    s_add_u32 s25, s22, 2048
    s_mov_b32 s56, -65528
    s_cmp_lg_u32 s32, 0
    s_cselect_b64 s[38:39], -1, 0
    s_add_u32 s55, s68, 138412032
    s_cmp_eq_u32 s13, 3
    s_cselect_b64 s[100:101], 1, 0
    s_cselect_b64 s[38:39], 1, s[38:39]
    s_cselect_b32 s93, 64, 0
    s_cselect_b32 s55, s29, s55
    s_cselect_b32 s57, 0, 9216
    s_mov_b64 exec, s[100:101]
    v_mov_b32 v72, s95
    s_mov_b64 exec, -1
    s_mov_b32 s34, 0xff00ff00
    s_mov_b32 s35, 0xff00ff00
    s_lshl_b32 s28, s12, 12
    s_add_u32 s28, s28, 7602176
    s_add_u32 s27, s28, 77594624
    s_add_u32 s28, s28, 69206016
    s_mov_b32 s40, 3
    v_bfe_u32 v78, v65, 2, 5
    s_mov_b32 s31, 4194304
cs_kv0:
    buffer_load_dword v77, v78, s[4:7], s96 offen offset:16 sc1
    s_waitcnt vmcnt(0)
    v_subrev_u32 v77, s95, v77
    v_cmp_lt_u32 vcc, 16, v77
    s_nop 1
    v_cndmask_b32 v77, v77, 0, vcc
    v_bfe_u32 v79, v78, 2, 2
    v_lshl_add_u32 v77, v77, 2, v79
    s_nop 1
    v_min_u32_dpp v77, v77, v77 row_ror:1 row_mask:0xf bank_mask:0xf
    s_nop 1
    v_min_u32_dpp v77, v77, v77 row_ror:2 row_mask:0xf bank_mask:0xf
    s_nop 1
    v_min_u32_dpp v77, v77, v77 row_ror:4 row_mask:0xf bank_mask:0xf
    s_nop 0
    v_readfirstlane_b32 s97, v77
    s_sub_u32 s31, s31, 1
    s_cbranch_scc1 cs_kv0_x
    s_cmp_le_u32 s40, s97
    s_cbranch_scc1 cs_kv0_x
    s_sleep 2
    s_branch cs_kv0
cs_kv0_x:
    s_add_u32 s40, s24, 0
    s_add_u32 s40, s40, s33
    s_sub_u32 s41, s96, s40
    v_bfe_u32 v77, v65, 2, 5
    v_add3_u32 v77, v77, s41, 16
    v_lshlrev_b32 v78, 3, v69
    s_nop 0
    v_mov_b32_dpp v78, v77 quad_perm:[0,1,2,3] row_mask:0xc bank_mask:0xf
    buffer_load_dword v76, v78, s[4:7], s40 offen sc1
    s_add_u32 s40, s24, 524288
    s_add_u32 s40, s40, s33
    s_sub_u32 s41, s96, s40
    v_bfe_u32 v77, v65, 2, 5
    v_add3_u32 v77, v77, s41, 16
    v_lshlrev_b32 v78, 3, v69
    s_nop 0
    v_mov_b32_dpp v78, v77 quad_perm:[0,1,2,3] row_mask:0xc bank_mask:0xf
    buffer_load_dword v76, v78, s[4:7], s40 offen sc1
cs_kvdone:
    v_mov_b64 v[0:1], 0
    v_mov_b64 v[2:3], 0
    v_mov_b64 v[4:5], 0
    v_mov_b64 v[6:7], 0
    v_mov_b64 v[8:9], 0
    v_mov_b64 v[10:11], 0
    v_mov_b64 v[12:13], 0
    v_mov_b64 v[14:15], 0
    v_mov_b64 v[16:17], 0
    v_mov_b64 v[18:19], 0
    v_mov_b64 v[20:21], 0
    v_mov_b64 v[22:23], 0
    ds_read_b128 v[40:43], v70 offset:0
    ds_read_b128 v[44:47], v70 offset:1024
    ds_read_b128 v[48:51], v70 offset:2048
    ds_read_b128 v[52:55], v70 offset:3072
    ds_read_b128 v[24:27], v70 offset:4096
    ds_read_b128 v[28:31], v70 offset:5120
    ds_read_b128 v[32:35], v70 offset:6144
    ds_read_b128 v[36:39], v70 offset:7168
    buffer_load_dwordx4 v[60:63], v65, s[4:7], s14 offen offset:0 sc1
    buffer_load_dwordx4 v[56:59], v66, s[4:7], s14 offen offset:0 sc1
    s_mov_b32 s31, 1048576
    s_waitcnt vmcnt(0) lgkmcnt(0)
    s_branch cs_goA
cs_loop:
    s_mov_b32 s31, 1048576
    s_mov_b32 s69, s70
    s_waitcnt lgkmcnt(0)
cs_cA:
    buffer_load_dwordx4 v[60:63], v65, s[4:7], s14 offen offset:0 sc1
    buffer_load_dwordx4 v[56:59], v66, s[4:7], s14 offen offset:0 sc1
cs_cA1:
    v_bitop3_b32 v77, v60, v56, s70 bitop3:0x7e
    v_and_b32 v77, 1, v77
    v_cmp_ne_u32 vcc, 0, v77
    s_cbranch_vccz cs_goA
    s_nop 15
    s_nop 15
    s_nop 7
    v_bitop3_b32 v77, v60, v56, s70 bitop3:0x7e
    v_and_b32 v77, 1, v77
    v_cmp_ne_u32 vcc, 0, v77
    s_cbranch_vccz cs_goA
    s_nop 15
    s_nop 15
    s_nop 7
    v_bitop3_b32 v77, v60, v56, s70 bitop3:0x7e
    v_and_b32 v77, 1, v77
    v_cmp_ne_u32 vcc, 0, v77
    s_cbranch_vccz cs_goA
    s_nop 15
    s_nop 15
    s_nop 7
    v_bitop3_b32 v77, v60, v56, s70 bitop3:0x7e
    v_and_b32 v77, 1, v77
    v_cmp_ne_u32 vcc, 0, v77
    s_cbranch_vccz cs_goA
    s_nop 15
    s_nop 15
    s_nop 7
    v_bitop3_b32 v77, v60, v56, s70 bitop3:0x7e
    v_and_b32 v77, 1, v77
    v_cmp_ne_u32 vcc, 0, v77
    s_cbranch_vccz cs_goA
    s_nop 15
    s_nop 15
    s_nop 7
    buffer_load_dwordx4 v[60:63], v65, s[4:7], s14 offen offset:0 sc1
    buffer_load_dwordx4 v[56:59], v66, s[4:7], s14 offen offset:0 sc1
    v_bitop3_b32 v77, v60, v56, s70 bitop3:0x7e
    v_and_b32 v77, 1, v77
    v_cmp_ne_u32 vcc, 0, v77
    s_cbranch_vccz cs_goA
    s_nop 15
    s_nop 15
    s_nop 7
    v_bitop3_b32 v77, v60, v56, s70 bitop3:0x7e
    v_and_b32 v77, 1, v77
    v_cmp_ne_u32 vcc, 0, v77
    s_cbranch_vccz cs_goA
    s_nop 15
    s_nop 15
    s_nop 7
    v_bitop3_b32 v77, v60, v56, s70 bitop3:0x7e
    v_and_b32 v77, 1, v77
    v_cmp_ne_u32 vcc, 0, v77
    s_cbranch_vccz cs_goA
    s_nop 15
    s_nop 15
    s_nop 7
    v_bitop3_b32 v77, v60, v56, s70 bitop3:0x7e
    v_and_b32 v77, 1, v77
    v_cmp_ne_u32 vcc, 0, v77
    s_cbranch_vccz cs_goA
    s_nop 15
    s_nop 15
    s_nop 7
    v_bitop3_b32 v77, v60, v56, s70 bitop3:0x7e
    v_and_b32 v77, 1, v77
    v_cmp_ne_u32 vcc, 0, v77
    s_cbranch_vccz cs_goA
    s_nop 15
    s_nop 15
    s_nop 7
    buffer_load_dwordx4 v[60:63], v65, s[4:7], s14 offen offset:0 sc1
    buffer_load_dwordx4 v[56:59], v66, s[4:7], s14 offen offset:0 sc1
    v_bitop3_b32 v77, v60, v56, s70 bitop3:0x7e
    v_and_b32 v77, 1, v77
    v_cmp_ne_u32 vcc, 0, v77
    s_cbranch_vccz cs_goA
    s_nop 15
    s_nop 15
    s_nop 7
    v_bitop3_b32 v77, v60, v56, s70 bitop3:0x7e
    v_and_b32 v77, 1, v77
    v_cmp_ne_u32 vcc, 0, v77
    s_cbranch_vccz cs_goA
    s_nop 15
    s_nop 15
    s_nop 7
    v_bitop3_b32 v77, v60, v56, s70 bitop3:0x7e
    v_and_b32 v77, 1, v77
    v_cmp_ne_u32 vcc, 0, v77
    s_cbranch_vccz cs_goA
    s_nop 15
    s_nop 15
    s_nop 7
    v_bitop3_b32 v77, v60, v56, s70 bitop3:0x7e
    v_and_b32 v77, 1, v77
    v_cmp_ne_u32 vcc, 0, v77
    s_cbranch_vccz cs_goA
    s_nop 15
    s_nop 15
    s_nop 7
    v_bitop3_b32 v77, v60, v56, s70 bitop3:0x7e
    v_and_b32 v77, 1, v77
    v_cmp_ne_u32 vcc, 0, v77
    s_cbranch_vccz cs_goA
    s_nop 15
    s_nop 15
    s_nop 7
    buffer_load_dwordx4 v[60:63], v65, s[4:7], s14 offen offset:0 sc1
    buffer_load_dwordx4 v[56:59], v66, s[4:7], s14 offen offset:0 sc1
    v_bitop3_b32 v77, v60, v56, s70 bitop3:0x7e
    v_and_b32 v77, 1, v77
    v_cmp_ne_u32 vcc, 0, v77
    s_cbranch_vccz cs_goA
    s_nop 15
    s_nop 15
    s_nop 7
    v_bitop3_b32 v77, v60, v56, s70 bitop3:0x7e
    v_and_b32 v77, 1, v77
    v_cmp_ne_u32 vcc, 0, v77
    s_cbranch_vccz cs_goA
    s_nop 15
    s_nop 15
    s_nop 7
    v_bitop3_b32 v77, v60, v56, s70 bitop3:0x7e
    v_and_b32 v77, 1, v77
    v_cmp_ne_u32 vcc, 0, v77
    s_cbranch_vccz cs_goA
    s_nop 15
    s_nop 15
    s_nop 7
    v_bitop3_b32 v77, v60, v56, s70 bitop3:0x7e
    v_and_b32 v77, 1, v77
    v_cmp_ne_u32 vcc, 0, v77
    s_cbranch_vccz cs_goA
    s_nop 15
    s_nop 15
    s_nop 7
    v_bitop3_b32 v77, v60, v56, s70 bitop3:0x7e
    v_and_b32 v77, 1, v77
    v_cmp_ne_u32 vcc, 0, v77
    s_cbranch_vccz cs_goA
    s_nop 15
    s_nop 15
    s_nop 7
    s_sub_u32 s31, s31, 64
    s_cbranch_scc0 cs_cA
cs_goA:
    ds_write_b128 v65, v[60:63] offset:0
    v_smfmac_f32_16x16x64_bf16 v[0:3], v[60:63], v[40:47], v64
    v_smfmac_f32_16x16x64_bf16 v[4:7], v[60:63], v[48:55], v64
    buffer_load_dwordx4 v[40:43], v65, s[4:7], s15 offen offset:0 sc1
    v_smfmac_f32_16x16x64_bf16 v[0:3], v[56:59], v[24:31], v64
    s_add_u32 s40, s24, 1048576
    s_add_u32 s40, s40, s33
    s_sub_u32 s41, s96, s40
    v_smfmac_f32_16x16x64_bf16 v[4:7], v[56:59], v[32:39], v64
    ds_read_b128 v[24:27], v70 offset:8192
    s_cmp_lt_u32 s97, s93
    s_cselect_b32 s41, s41, 0
    v_smfmac_f32_16x16x64_bf16 v[8:11], v[60:63], a[96:103], v64
    ds_read_b128 v[28:31], v70 offset:9216
    v_smfmac_f32_16x16x64_bf16 v[12:15], v[60:63], a[104:111], v64
    ds_read_b128 v[32:35], v70 offset:10240
    s_waitcnt lgkmcnt(3)
    s_barrier
    ds_read_b128 v[48:51], v67 offset:0
    v_smfmac_f32_16x16x64_bf16 v[8:11], v[56:59], a[112:119], v64
    ds_read_b128 v[36:39], v70 offset:11264
    v_bitop3_b32 v79, v73, -9, s54 bitop3:0x6a
    v_smfmac_f32_16x16x64_bf16 v[12:15], v[56:59], a[120:127], v64
    ds_read_b128 v[52:55], v68 offset:0
    v_bfe_u32 v77, v65, 2, 5
    v_smfmac_f32_16x16x64_bf16 v[16:19], v[60:63], a[216:223], v64
    buffer_load_dwordx4 v[40:43], v65, s[4:7], s15 offen offset:0 sc1
    s_waitcnt lgkmcnt(4)
    v_smfmac_f32_16x16x64_bf16 v[20:23], v[60:63], v[24:31], v64
    ds_read_b128 v[24:27], v70 offset:12288
    s_waitcnt lgkmcnt(3)
    v_smfmac_f32_16x16x64_bf16 v[0:3], v[48:51], a[0:7], v64
    ds_read_b128 v[28:31], v70 offset:13312
    s_waitcnt lgkmcnt(3)
    v_smfmac_f32_16x16x64_bf16 v[4:7], v[48:51], v[32:39], v64
    ds_read_b128 v[32:35], v70 offset:14336
    v_add3_u32 v77, v77, s41, 16
    v_smfmac_f32_16x16x64_bf16 v[8:11], v[48:51], a[128:135], v64
    ds_read_b128 v[36:39], v70 offset:15360
    v_lshlrev_b32 v78, 3, v69
    v_smfmac_f32_16x16x64_bf16 v[12:15], v[48:51], a[136:143], v64
    buffer_load_dwordx4 v[60:63], v65, s[4:7], s16 offen offset:0 sc1
    v_smfmac_f32_16x16x64_bf16 v[16:19], v[56:59], a[224:231], v64
    v_mov_b32_dpp v78, v77 quad_perm:[0,1,2,3] row_mask:0xc bank_mask:0xf
    v_smfmac_f32_16x16x64_bf16 v[20:23], v[56:59], a[232:239], v64
    s_waitcnt lgkmcnt(2)
    s_waitcnt vmcnt(2)
    v_and_b32 v77, s36, v40
    v_smfmac_f32_16x16x64_bf16 v[12:15], v[52:55], v[24:31], v64
    ds_write_b128 v65, v[40:43] offset:4096
    v_smfmac_f32_16x16x64_bf16 v[0:3], v[52:55], a[8:15], v64
    s_waitcnt lgkmcnt(1)
    v_cmp_ne_u32 vcc, s70, v77
    v_smfmac_f32_16x16x64_bf16 v[4:7], v[52:55], v[32:39], v64
    buffer_load_dwordx4 v[24:27], v65, s[4:7], s24 offen offset:0 sc1
    v_smfmac_f32_16x16x64_bf16 v[8:11], v[52:55], a[144:151], v64
    s_cbranch_vccnz cs_spinB
cs_backB:
    v_smfmac_f32_16x16x64_bf16 v[16:19], v[40:43], v[176:183], v64
    s_waitcnt lgkmcnt(0)
    s_barrier
    ds_read_b128 v[44:47], v66 offset:4096
    v_smfmac_f32_16x16x64_bf16 v[12:15], v[40:43], a[160:167], v64
    ds_read_b128 v[32:35], v70 offset:16384
    v_smfmac_f32_16x16x64_bf16 v[0:3], v[40:43], a[16:23], v64
    ds_read_b128 v[36:39], v70 offset:17408
    v_smfmac_f32_16x16x64_bf16 v[8:11], v[40:43], a[152:159], v64
    ds_read_b128 v[48:51], v67 offset:4096
    v_smfmac_f32_16x16x64_bf16 v[4:7], v[40:43], a[24:31], v64
    ds_read_b128 v[52:55], v68 offset:4096
    v_smfmac_f32_16x16x64_bf16 v[20:23], v[40:43], v[184:191], v64
    buffer_load_dwordx4 v[28:31], v65, s[4:7], s24 offen offset:1024 sc1
    s_waitcnt lgkmcnt(4)
    v_smfmac_f32_16x16x64_bf16 v[0:3], v[44:47], a[32:39], v64
    ds_read_b128 v[56:59], v69 offset:15360
    s_waitcnt lgkmcnt(3)
    v_smfmac_f32_16x16x64_bf16 v[8:11], v[44:47], v[32:39], v64
    ds_read_b128 v[32:35], v70 offset:18432
    v_smfmac_f32_16x16x64_bf16 v[4:7], v[44:47], a[40:47], v64
    ds_read_b128 v[36:39], v70 offset:19456
    v_smfmac_f32_16x16x64_bf16 v[12:15], v[44:47], a[168:175], v64
    buffer_load_dwordx4 v[42:45], v65, s[4:7], s24 offen offset:3072 sc1
    s_waitcnt lgkmcnt(3)
    v_smfmac_f32_16x16x64_bf16 v[0:3], v[48:51], a[48:55], v64
    s_waitcnt vmcnt(3)
    v_and_b32 v77, s36, v60
    v_smfmac_f32_16x16x64_bf16 v[8:11], v[48:51], a[176:183], v64
    v_cmp_ne_u32 vcc, s70, v77
    v_smfmac_f32_16x16x64_bf16 v[0:3], v[52:55], a[64:71], v64
    s_waitcnt lgkmcnt(0)
    v_smfmac_f32_16x16x64_bf16 v[8:11], v[52:55], v[32:39], v64
    s_cbranch_vccnz cs_spin8
cs_back8:
    v_smfmac_f32_16x16x64_bf16 v[0:3], v[60:63], a[80:87], v64
    buffer_load_dwordx4 v[34:37], v65, s[4:7], s24 offen offset:2048 sc1
    s_nop 1
    v_smfmac_f32_16x16x64_bf16 v[8:11], v[60:63], a[200:207], v64
    s_nop 1
    v_lshrrev_b32 v77, 1, v69
    v_smfmac_f32_16x16x64_bf16 v[4:7], v[48:51], a[56:63], v64
    s_nop 1
    v_cvt_pk_bf16_f32 v0, v0, v1
    v_smfmac_f32_16x16x64_bf16 v[12:15], v[48:51], a[184:191], v64
    s_nop 1
    v_cvt_pk_bf16_f32 v1, v2, v3
    v_smfmac_f32_16x16x64_bf16 v[4:7], v[52:55], a[72:79], v64
    s_nop 1
    v_cvt_pk_bf16_f32 v2, v8, v9
    v_smfmac_f32_16x16x64_bf16 v[12:15], v[52:55], a[192:199], v64
    s_nop 1
    v_cvt_pk_bf16_f32 v3, v10, v11
    v_smfmac_f32_16x16x64_bf16 v[4:7], v[60:63], a[88:95], v64
    s_nop 2
    v_smfmac_f32_16x16x64_bf16 v[12:15], v[60:63], a[208:215], v64
    buffer_load_dword v76, v78, s[4:7], s40 offen sc1
    s_nop 1
    v_mfma_f32_16x16x32_bf16 v[8:11], v[0:3], v[56:59], 0
    s_nop 0
    v_cvt_pk_bf16_f32 v4, v4, v5
    v_cvt_pk_bf16_f32 v5, v6, v7
    s_nop 0
    v_cvt_pk_bf16_f32 v6, v12, v13
    v_cvt_pk_bf16_f32 v7, v14, v15
    s_nop 1
    v_mfma_f32_16x16x32_bf16 v[12:15], v[4:7], v[56:59], 0
    ds_read_b128 v[56:59], v66 offset:4096
    v_cvt_pk_bf16_f32 v0, v8, v9
    v_cvt_pk_bf16_f32 v1, v10, v11
    v_smfmac_f32_16x16x64_bf16 v[16:19], v[48:51], v[208:215], v64
    s_waitcnt vmcnt(3)
    s_nop 2
    v_cvt_pk_bf16_f32 v2, v12, v13
    v_cvt_pk_bf16_f32 v3, v14, v15
    s_nop 1
    v_mfma_f32_16x16x32_bf16 v[12:15], v[0:3], v[0:3], 0
    s_nop 1
    v_bitop3_b32 v78, v73, -9, s53 bitop3:0x6a
    v_mfma_f32_16x16x32_bf16 v[4:7], v[24:27], v[0:3], 0
    ds_read_b128 v[24:27], v67 offset:0
    s_nop 1
    v_mfma_f32_16x16x32_bf16 v[8:11], v[28:31], v[0:3], 0
    s_nop 0
    v_mov_b32_dpp v12, v14 row_ror:8 row_mask:0xf bank_mask:0xc
    v_mov_b32_dpp v13, v15 row_ror:8 row_mask:0xf bank_mask:0xc
    v_smfmac_f32_16x16x64_bf16 v[20:23], v[48:51], v[216:223], v64
    ds_write_b64 v71, v[12:13]
    ds_read_b128 v[48:51], v68 offset:0
    s_nop 1
    v_mov_b32_dpp v4, v8 row_ror:8 row_mask:0xf bank_mask:0xc
    v_mov_b32_dpp v5, v9 row_ror:8 row_mask:0xf bank_mask:0xc
    v_mov_b32_dpp v6, v10 row_ror:8 row_mask:0xf bank_mask:0xc
    v_mov_b32_dpp v7, v11 row_ror:8 row_mask:0xf bank_mask:0xc
    v_smfmac_f32_16x16x64_bf16 v[16:19], v[52:55], v[224:231], v64
    ds_write_b128 v65, v[4:7] offset:8192
    v_smfmac_f32_16x16x64_bf16 v[20:23], v[52:55], v[232:239], v64
    s_waitcnt lgkmcnt(3)
    v_smfmac_f32_16x16x64_bf16 v[16:19], v[24:27], a[240:247], v64
    s_waitcnt vmcnt(1)
    v_smfmac_f32_16x16x64_bf16 v[20:23], v[24:27], a[248:255], v64
    s_mov_b64 exec, s[38:39]
    buffer_store_dword v72, v75, s[4:7], s55 offen sc1
    s_mov_b64 exec, -1
    v_smfmac_f32_16x16x64_bf16 v[16:19], v[60:63], v[240:247], v64
    s_cmp_ge_u32 s30, 58
    s_waitcnt lgkmcnt(0)
    s_barrier
    ds_read_b128 v[8:11], v66 offset:8192
    v_smfmac_f32_16x16x64_bf16 v[20:23], v[60:63], v[248:255], v64
    ds_read_b128 v[12:15], v67 offset:8192
    v_smfmac_f32_16x16x64_bf16 v[16:19], v[56:59], v[192:199], v64
    ds_read_b128 v[52:55], v68 offset:8192
    v_smfmac_f32_16x16x64_bf16 v[20:23], v[56:59], v[200:207], v64
    ds_read_b64 v[24:25], v77 offset:14336
    ds_read_b64 v[26:27], v77 offset:14592
    v_smfmac_f32_16x16x64_bf16 v[16:19], v[48:51], v[160:167], v64
    ds_read_b64 v[28:29], v77 offset:14848
    ds_read_b64 v[30:31], v77 offset:15104
    v_bitop3_b32 v77, v73, -9, s52 bitop3:0x6a
    v_smfmac_f32_16x16x64_bf16 v[20:23], v[48:51], v[168:175], v64
    s_cbranch_scc1 cs_rare
cs_rare_x:
    ds_read_b128 v[56:59], v70 offset:22528
    ds_read_b128 v[60:63], v70 offset:23552
    s_waitcnt lgkmcnt(6)
    v_pk_add_f32 v[4:5], v[4:5], v[8:9]
    v_pk_add_f32 v[6:7], v[6:7], v[10:11]
    v_pk_add_f32 v[12:13], v[12:13], v[52:53]
    v_pk_add_f32 v[14:15], v[14:15], v[54:55]
    v_pk_add_f32 v[4:5], v[4:5], v[12:13]
    v_pk_add_f32 v[6:7], v[6:7], v[14:15]
    s_waitcnt lgkmcnt(2)
    v_pk_add_f32 v[24:25], v[24:25], v[26:27]
    v_pk_add_f32 v[28:29], v[28:29], v[30:31]
    v_max3_f32 v8, v4, v5, v6
    v_pk_add_f32 v[24:25], v[24:25], v[28:29]
    v_max_f32 v8, v8, v7
    v_max3_f32 v8, v8, v24, v25
    v_cvt_pk_bf16_f32 v32, v16, v17
    v_cvt_pk_bf16_f32 v38, v18, v19
    v_max_f32_dpp v8, v8, v8 row_ror:8 row_mask:0xf bank_mask:0xf
    v_mov_b32 v9, v8
    v_cvt_pk_bf16_f32 v40, v20, v21
    v_cvt_pk_bf16_f32 v46, v22, v23
    v_permlane32_swap_b32 v8, v9
    v_max_f32 v8, v8, v9
    v_mov_b32 v9, v8
    v_mov_b32 v11, 0
    v_mov_b32 v15, 0
    v_permlane16_swap_b32 v8, v9
    v_max_f32 v8, v8, v9
    v_mul_f32 v8, s66, v8
    v_pk_fma_f32 v[4:5], v[4:5], s[44:45], v[8:9] op_sel_hi:[1,1,0]
    v_pk_fma_f32 v[6:7], v[6:7], s[44:45], v[8:9] op_sel_hi:[1,1,0]
    v_pk_fma_f32 v[24:25], v[24:25], s[44:45], v[8:9] op_sel_hi:[1,1,0]
    v_exp_f32 v4, v4
    v_exp_f32 v5, v5
    v_exp_f32 v6, v6
    v_exp_f32 v7, v7
    v_exp_f32 v24, v24
    v_exp_f32 v25, v25
    v_cvt_pk_bf16_f32 v12, v4, v5
    v_cvt_pk_bf16_f32 v13, v6, v7
    v_cvt_pk_bf16_f32 v10, v24, v25
    v_cvt_pk_bf16_f32 v14, v24, v25
    v_mov_b64 v[0:1], s[48:49]
    v_mfma_f32_16x16x32_bf16 v[4:7], v[32:35], v[10:13], 0
    ds_read_b128 v[48:51], v70 offset:20480
    v_mov_b64 v[2:3], s[50:51]
    v_mfma_f32_16x16x32_bf16 v[24:27], v[36:39], v[12:15], 0
    ds_read_b128 v[52:55], v70 offset:21504
    v_mov_b64 v[8:9], 0
    v_mfma_f32_16x16x32_bf16 v[28:31], v[0:3], v[10:13], 0
    ds_read_b128 v[32:35], v70 offset:24576
    v_mov_b64 v[0:1], 0
    v_mfma_f32_16x16x32_bf16 v[16:19], v[40:43], v[10:13], 0
    ds_read_b128 v[36:39], v70 offset:25600
    v_mov_b64 v[2:3], 0
    v_mfma_f32_16x16x32_bf16 v[20:23], v[44:47], v[12:15], 0
    ds_read_b128 v[40:43], v70 offset:26624
    v_add_f32_dpp v4, v24, v4 row_ror:8 row_mask:0xf bank_mask:0xf
    v_add_f32_dpp v5, v25, v5 row_ror:8 row_mask:0xf bank_mask:0xf
    v_add_f32_dpp v6, v26, v6 row_ror:8 row_mask:0xf bank_mask:0xf
    v_add_f32_dpp v7, v27, v7 row_ror:8 row_mask:0xf bank_mask:0xf
    v_add_f32_dpp v29, v28, v28 row_ror:8 row_mask:0xf bank_mask:0xf
    v_rcp_f32 v28, v29
    v_mov_b64 v[10:11], 0
    v_add_f32_dpp v4, v16, v20 row_ror:8 row_mask:0xf bank_mask:0xc
    v_add_f32_dpp v5, v17, v21 row_ror:8 row_mask:0xf bank_mask:0xc
    v_add_f32_dpp v6, v18, v22 row_ror:8 row_mask:0xf bank_mask:0xc
    v_add_f32_dpp v7, v19, v23 row_ror:8 row_mask:0xf bank_mask:0xc
    v_pk_mul_f32 v[4:5], v[4:5], v[28:29] op_sel_hi:[1,0]
    v_pk_mul_f32 v[6:7], v[6:7], v[28:29] op_sel_hi:[1,0]
    v_cvt_pk_bf16_f32 v4, v4, v5
    v_cvt_pk_bf16_f32 v5, v6, v7
    ds_write_b64 v73, v[4:5] offset:12288
    v_mov_b32_dpp v6, v4 row_ror:8 row_mask:0xf bank_mask:0xf
    v_mov_b32_dpp v7, v5 row_ror:8 row_mask:0xf bank_mask:0xf
    v_mov_b64 v[12:13], 0
    v_mov_b64 v[14:15], 0
    v_smfmac_f32_16x16x64_bf16 v[8:11], v[4:7], v[80:87], v64
    s_waitcnt lgkmcnt(4)
    v_mov_b64 v[24:25], 0
    v_smfmac_f32_16x16x64_bf16 v[0:3], v[4:7], v[48:55], v64
    ds_read_b128 v[44:47], v70 offset:27648
    v_mov_b64 v[26:27], 0
    v_smfmac_f32_16x16x64_bf16 v[12:15], v[4:7], v[112:119], v64
    s_waitcnt lgkmcnt(1)
    s_barrier
    ds_read_b128 v[16:19], v77 offset:12288
    v_smfmac_f32_16x16x64_bf16 v[24:27], v[4:7], v[56:63], v64
    ds_read_b128 v[20:23], v78 offset:12288
    ds_read_b128 v[28:31], v79 offset:12288
    v_mov_b64 v[4:5], 0
    v_mov_b64 v[6:7], 0
    v_bfe_u32 v77, v74, 16, 1
    v_mad_i32_i24 v77, v77, s56, v74
    s_waitcnt lgkmcnt(2)
    v_smfmac_f32_16x16x64_bf16 v[8:11], v[16:19], v[88:95], v64
    ds_read_b128 v[56:59], v70 offset:28672
    v_and_b32 v72, 8, v73
    v_smfmac_f32_16x16x64_bf16 v[12:15], v[16:19], v[120:127], v64
    ds_read_b128 v[60:63], v70 offset:29696
    s_waitcnt lgkmcnt(3)
    v_mad_u32_u24 v72, v72, 63, v73
    v_smfmac_f32_16x16x64_bf16 v[8:11], v[20:23], v[96:103], v64
    ds_read_b128 v[48:51], v70 offset:30720
    v_subrev_u32 v72, s47, v72
    v_smfmac_f32_16x16x64_bf16 v[12:15], v[20:23], v[128:135], v64
    ds_read_b128 v[52:55], v70 offset:31744
    s_waitcnt lgkmcnt(4)
    v_smfmac_f32_16x16x64_bf16 v[8:11], v[28:31], v[104:111], v64
    s_add_u32 s30, s30, 1
    s_xor_b32 s70, s70, 1
    s_cmp_lg_u32 s71, 0
    v_smfmac_f32_16x16x64_bf16 v[12:15], v[28:31], v[136:143], v64
    s_nop 2
    v_smfmac_f32_16x16x64_bf16 v[0:3], v[16:19], v[32:39], v64
    ds_read_b128 v[32:35], v70 offset:32768
    ds_read_b128 v[36:39], v70 offset:33792
    v_cvt_pk_bf16_f32 v8, v8, v9
    v_cvt_pk_bf16_f32 v9, v10, v11
    v_and_or_b32 v8, v8, -2, s69
    v_cvt_pk_bf16_f32 v10, v12, v13
    v_cvt_pk_bf16_f32 v11, v14, v15
    v_smfmac_f32_16x16x64_bf16 v[24:27], v[16:19], v[40:47], v64
    buffer_store_dwordx4 v[8:11], v74, s[4:7], s22 offen sc1
    ds_read_b128 v[40:43], v70 offset:34816
    s_waitcnt lgkmcnt(3)
    v_smfmac_f32_16x16x64_bf16 v[0:3], v[20:23], v[56:63], v64
    ds_read_b128 v[44:47], v70 offset:35840
    ds_read_b128 v[56:59], v72 offset:12288
    v_smfmac_f32_16x16x64_bf16 v[24:27], v[20:23], v[48:55], v64
    ds_read_b128 v[60:63], v72 offset:13312
    s_waitcnt lgkmcnt(4)
    v_smfmac_f32_16x16x64_bf16 v[0:3], v[28:31], v[32:39], v64
    s_waitcnt lgkmcnt(2)
    s_nop 1
    v_smfmac_f32_16x16x64_bf16 v[24:27], v[28:31], v[40:47], v64
    s_waitcnt lgkmcnt(0)
    s_nop 1
    v_smfmac_f32_16x16x64_bf16 v[4:7], v[56:59], v[144:151], v64
    v_cvt_pk_bf16_f32 v0, v0, v1
    v_cvt_pk_bf16_f32 v1, v2, v3
    v_and_or_b32 v0, v0, -2, s69
    s_nop 0
    v_cvt_pk_bf16_f32 v2, v24, v25
    v_cvt_pk_bf16_f32 v3, v26, v27
    v_smfmac_f32_16x16x64_bf16 v[4:7], v[60:63], v[152:159], v64
    buffer_store_dwordx4 v[0:3], v74, s[4:7], s23 offen sc1
    s_nop 6
    v_cvt_pk_bf16_f32 v4, v4, v5
    v_cvt_pk_bf16_f32 v5, v6, v7
    v_and_or_b32 v4, v4, -2, s69
    buffer_store_dwordx2 v[4:5], v77, s[4:7], s25 offen sc1
    s_cbranch_scc1 cs_e1
    s_nop 2
    v_mov_b32 v79, v79
    s_nop 2
    v_mov_b32 v79, v79
    s_nop 2
    v_mov_b32 v79, v79
    s_nop 2
    v_mov_b32 v79, v79
    s_nop 2
    v_mov_b32 v79, v79
    s_nop 2
    v_mov_b32 v79, v79
    s_nop 2
    v_mov_b32 v79, v79
    s_nop 2
    v_mov_b32 v79, v79
    s_nop 2
    v_mov_b32 v79, v79
    s_nop 2
    v_mov_b32 v79, v79
    s_nop 2
    v_mov_b32 v79, v79
    s_nop 2
    v_mov_b32 v79, v79
    s_nop 2
    v_mov_b32 v79, v79
    s_nop 2
    v_mov_b32 v79, v79
    s_nop 2
    v_mov_b32 v79, v79
    s_nop 2
    v_mov_b32 v79, v79
    s_nop 2
    v_mov_b32 v79, v79
    s_nop 2
    v_mov_b32 v79, v79
    s_nop 2
    v_mov_b32 v79, v79
    s_nop 2
    v_mov_b32 v79, v79
    s_nop 2
    v_mov_b32 v79, v79
    s_nop 2
    v_mov_b32 v79, v79
    s_nop 2
    v_mov_b32 v79, v79
    s_nop 2
    v_mov_b32 v79, v79
    s_nop 2
    v_mov_b32 v79, v79
    s_nop 2
    v_mov_b32 v79, v79
    s_nop 2
    v_mov_b32 v79, v79
    s_nop 2
    v_mov_b32 v79, v79
    s_nop 2
    v_mov_b32 v79, v79
    s_nop 2
    v_mov_b32 v79, v79
    s_nop 2
    v_mov_b32 v79, v79
    s_nop 2
    v_mov_b32 v79, v79
    s_nop 2
    v_mov_b32 v79, v79
    s_nop 2
    v_mov_b32 v79, v79
    s_nop 2
    v_mov_b32 v79, v79
    s_nop 2
    v_mov_b32 v79, v79
    s_nop 2
    v_mov_b32 v79, v79
    s_nop 0
    v_mov_b32 v79, v79
    buffer_load_dwordx4 v[8:11], v65, s[4:7], s18 offen sc1
    buffer_load_dwordx4 v[12:15], v65, s[4:7], s19 offen sc1
    buffer_load_dwordx4 v[16:19], v65, s[4:7], s20 offen sc1
    buffer_load_dwordx4 v[20:23], v65, s[4:7], s21 offen sc1
    v_and_b32 v77, 255, v69
    ds_read_b128 v[4:7], v77 offset:15872
    ds_read_b128 v[40:43], v70 offset:0
    ds_read_b128 v[44:47], v70 offset:1024
    ds_read_b128 v[48:51], v70 offset:2048
    ds_read_b128 v[52:55], v70 offset:3072
    ds_read_b128 v[24:27], v70 offset:4096
    ds_read_b128 v[28:31], v70 offset:5120
    ds_read_b128 v[32:35], v70 offset:6144
    ds_read_b128 v[36:39], v70 offset:7168
    s_mov_b32 s31, 65536
    s_add_u32 s24, s24, 524288
    s_add_u32 s26, s26, 524288
    s_add_u32 s55, s55, s57
    s_mov_b32 s14, 67633152
    s_mov_b32 s15, 67637248
    s_mov_b32 s16, 67641344
    s_mov_b32 s36, 1
    v_mov_b32 v60, s69
    v_mov_b32 v56, s69
    v_and_b32 v79, 12, v75
    v_cmp_eq_u32 vcc, 0, v79
    s_nop 1
    v_cndmask_b32 v79, 0, 1, vcc
    s_waitcnt lgkmcnt(0)
    s_waitcnt vmcnt(3)
    v_xor_b32 v77, s69, v8
    v_mfma_f32_16x16x32_bf16 v[0:3], v[4:7], v[8:11], 0
    v_mov_b64 v[8:9], 0
    v_mov_b64 v[10:11], 0
    s_waitcnt vmcnt(2)
    v_bitop3_b32 v77, v77, v12, s69 bitop3:0xf6
    v_mfma_f32_16x16x32_bf16 v[0:3], v[4:7], v[12:15], v[0:3]
    v_mov_b64 v[12:13], 0
    v_mov_b64 v[14:15], 0
    s_waitcnt vmcnt(1)
    v_bitop3_b32 v77, v77, v16, s69 bitop3:0xf6
    v_mfma_f32_16x16x32_bf16 v[0:3], v[4:7], v[16:19], v[0:3]
    v_mov_b64 v[16:17], 0
    v_mov_b64 v[18:19], 0
    s_waitcnt vmcnt(0)
    v_bitop3_b32 v77, v77, v20, s69 bitop3:0xf6
    v_mfma_f32_16x16x32_bf16 v[0:3], v[4:7], v[20:23], v[0:3]
    v_and_b32 v77, 1, v77
    v_cmp_ne_u32 vcc, 0, v77
    v_mov_b64 v[20:21], 0
    v_mov_b64 v[22:23], 0
    s_cmp_eq_u64 vcc, 0
    s_cselect_b64 s[42:43], -1, 0
    s_nop 1
    v_add_f32_dpp v0, v0, v0 row_ror:8 row_mask:0xf bank_mask:0xf
    v_add_f32_dpp v1, v1, v1 row_ror:8 row_mask:0xf bank_mask:0xf
    s_mov_b64 exec, s[42:43]
    v_cvt_pk_bf16_f32 v72, v0, v1
    v_bfi_b32 v72, v79, s70, v72
    buffer_store_dword v72, v75, s[4:7], s17 offen offset:0 sc1
    s_mov_b64 exec, -1
    s_cbranch_scc0 cs_f0_retry
cs_f0_go:
    v_mov_b64 v[0:1], 0
    v_mov_b64 v[2:3], 0
    v_mov_b64 v[4:5], 0
    v_mov_b64 v[6:7], 0
    s_nop 2
    v_mov_b32 v79, v79
    s_nop 2
    v_mov_b32 v79, v79
    s_nop 2
    v_mov_b32 v79, v79
    s_nop 2
    v_mov_b32 v79, v79
    s_nop 2
    v_mov_b32 v79, v79
    s_nop 2
    v_mov_b32 v79, v79
    s_nop 2
    v_mov_b32 v79, v79
    s_nop 2
    v_mov_b32 v79, v79
    s_nop 2
    v_mov_b32 v79, v79
    s_nop 2
    v_mov_b32 v79, v79
    s_nop 2
    v_mov_b32 v79, v79
    s_nop 2
    v_mov_b32 v79, v79
    s_nop 2
    v_mov_b32 v79, v79
    s_nop 2
    v_mov_b32 v79, v79
    s_nop 2
    v_mov_b32 v79, v79
    s_nop 2
    v_mov_b32 v79, v79
    s_nop 2
    v_mov_b32 v79, v79
    s_nop 2
    v_mov_b32 v79, v79
    s_nop 2
    v_mov_b32 v79, v79
    s_nop 2
    v_mov_b32 v79, v79
    s_nop 2
    v_mov_b32 v79, v79
    s_nop 2
    v_mov_b32 v79, v79
    s_nop 2
    v_mov_b32 v79, v79
    s_nop 2
    v_mov_b32 v79, v79
    s_nop 2
    v_mov_b32 v79, v79
    s_branch cs_loop
cs_e1:
    s_cmp_lg_u32 s71, 2
    s_cbranch_scc1 cs_f1
    v_and_b32 v77, 255, v69
    ds_read_b128 v[4:7], v77 offset:15872
    ds_read_b128 v[40:43], v70 offset:0
    ds_read_b128 v[44:47], v70 offset:1024
    ds_read_b128 v[48:51], v70 offset:2048
    ds_read_b128 v[52:55], v70 offset:3072
    ds_read_b128 v[24:27], v70 offset:4096
    ds_read_b128 v[28:31], v70 offset:5120
    ds_read_b128 v[32:35], v70 offset:6144
    ds_read_b128 v[36:39], v70 offset:7168
    s_mov_b32 s31, 65536
    s_add_u32 s24, s24, 524288
    s_add_u32 s26, s26, 524288
    s_add_u32 s55, s55, s57
    s_mov_b32 s14, 67633152
    s_mov_b32 s15, 67637248
    s_mov_b32 s16, 67641344
    s_mov_b32 s36, 1
    v_mov_b32 v60, s69
    v_mov_b32 v56, s69
    v_and_b32 v79, 12, v75
    v_cmp_eq_u32 vcc, 0, v79
    s_nop 1
    v_cndmask_b32 v79, 0, 1, vcc
    s_nop 2
    v_mov_b32 v79, v79
    s_nop 2
    v_mov_b32 v79, v79
    s_nop 2
    v_mov_b32 v79, v79
    s_nop 2
    v_mov_b32 v79, v79
    s_nop 2
    v_mov_b32 v79, v79
    s_nop 2
    v_mov_b32 v79, v79
    s_nop 2
    v_mov_b32 v79, v79
    s_nop 2
    v_mov_b32 v79, v79
    s_nop 2
    v_mov_b32 v79, v79
    s_nop 2
    v_mov_b32 v79, v79
    s_nop 2
    v_mov_b32 v79, v79
    s_nop 2
    v_mov_b32 v79, v79
    s_nop 2
    v_mov_b32 v79, v79
    s_nop 2
    v_mov_b32 v79, v79
    s_nop 2
    v_mov_b32 v79, v79
    s_nop 2
    v_mov_b32 v79, v79
    s_nop 2
    v_mov_b32 v79, v79
    s_nop 2
    v_mov_b32 v79, v79
    s_nop 2
    v_mov_b32 v79, v79
    s_nop 2
    v_mov_b32 v79, v79
    s_nop 2
    v_mov_b32 v79, v79
    s_nop 2
    v_mov_b32 v79, v79
    s_nop 2
    v_mov_b32 v79, v79
    s_nop 2
    v_mov_b32 v79, v79
    s_nop 2
    v_mov_b32 v79, v79
    s_nop 2
    v_mov_b32 v79, v79
    s_nop 2
    v_mov_b32 v79, v79
    s_nop 2
    v_mov_b32 v79, v79
    s_nop 2
    v_mov_b32 v79, v79
    s_nop 2
    v_mov_b32 v79, v79
    s_nop 2
    v_mov_b32 v79, v79
    s_nop 2
    v_mov_b32 v79, v79
    s_nop 2
    v_mov_b32 v79, v79
    s_nop 2
    v_mov_b32 v79, v79
    s_nop 2
    v_mov_b32 v79, v79
    s_nop 2
    v_mov_b32 v79, v79
    s_nop 2
    v_mov_b32 v79, v79
    s_nop 0
    v_mov_b32 v79, v79
    s_waitcnt vmcnt(0)
    buffer_load_dwordx4 v[8:11], v65, s[4:7], s18 offen sc1
    buffer_load_dwordx4 v[12:15], v65, s[4:7], s19 offen sc1
    buffer_load_dwordx4 v[16:19], v65, s[4:7], s20 offen sc1
    buffer_load_dwordx4 v[20:23], v65, s[4:7], s21 offen sc1
    s_nop 2
    v_mov_b32 v79, v79
    s_nop 2
    v_mov_b32 v79, v79
    s_nop 2
    v_mov_b32 v79, v79
    s_nop 2
    v_mov_b32 v79, v79
    s_nop 2
    v_mov_b32 v79, v79
    s_nop 2
    v_mov_b32 v79, v79
    s_nop 2
    v_mov_b32 v79, v79
    s_nop 2
    v_mov_b32 v79, v79
    s_nop 2
    v_mov_b32 v79, v79
    s_nop 2
    v_mov_b32 v79, v79
    buffer_load_dwordx4 v[60:63], v65, s[4:7], s14 offen offset:0 sc1
    buffer_load_dwordx4 v[56:59], v66, s[4:7], s14 offen offset:0 sc1
    s_waitcnt lgkmcnt(0)
    s_waitcnt vmcnt(5)
    v_xor_b32 v77, s69, v8
    v_bitop3_b32 v77, v77, v10, s69 bitop3:0xf6
    v_mfma_f32_16x16x32_bf16 v[0:3], v[4:7], v[8:11], 0
    v_mov_b64 v[8:9], 0
    v_mov_b64 v[10:11], 0
    s_waitcnt vmcnt(4)
    v_bitop3_b32 v77, v77, v12, s69 bitop3:0xf6
    v_bitop3_b32 v77, v77, v14, s69 bitop3:0xf6
    v_mfma_f32_16x16x32_bf16 v[0:3], v[4:7], v[12:15], v[0:3]
    v_mov_b64 v[12:13], 0
    v_mov_b64 v[14:15], 0
    s_waitcnt vmcnt(3)
    v_bitop3_b32 v77, v77, v16, s69 bitop3:0xf6
    v_bitop3_b32 v77, v77, v18, s69 bitop3:0xf6
    v_mfma_f32_16x16x32_bf16 v[0:3], v[4:7], v[16:19], v[0:3]
    v_mov_b64 v[16:17], 0
    v_mov_b64 v[18:19], 0
    s_waitcnt vmcnt(2)
    v_bitop3_b32 v77, v77, v20, s69 bitop3:0xf6
    v_bitop3_b32 v77, v77, v22, s69 bitop3:0xf6
    v_mfma_f32_16x16x32_bf16 v[0:3], v[4:7], v[20:23], v[0:3]
    v_and_b32 v77, 1, v77
    v_cmp_ne_u32 vcc, 0, v77
    v_mov_b64 v[20:21], 0
    v_mov_b64 v[22:23], 0
    buffer_load_dwordx4 v[60:63], v65, s[4:7], s14 offen offset:0 sc1
    buffer_load_dwordx4 v[56:59], v66, s[4:7], s14 offen offset:0 sc1
    s_cmp_eq_u64 vcc, 0
    s_cselect_b64 s[42:43], -1, 0
    v_add_f32 v2, v0, v1
    s_nop 1
    v_add_f32_dpp v2, v2, v2 row_ror:8 row_mask:0xf bank_mask:0xf
    s_nop 1
    v_mov_b32_dpp v0, v2 quad_perm:[0,0,2,2] row_mask:0xf bank_mask:0xf
    v_mov_b32_dpp v1, v2 quad_perm:[1,1,3,3] row_mask:0xf bank_mask:0xf
    s_mov_b64 exec, s[42:43]
    v_cvt_pk_bf16_f32 v72, v0, v1
    v_bfi_b32 v72, v79, s70, v72
    buffer_store_dword v72, v75, s[4:7], s17 offen offset:0 sc1
    buffer_store_dword v72, v75, s[4:7], s17 offen offset:1024 sc1
    buffer_store_dword v72, v75, s[4:7], s17 offen offset:2048 sc1
    buffer_store_dword v72, v75, s[4:7], s17 offen offset:3072 sc1
    s_mov_b64 exec, -1
    s_cbranch_scc0 cs_f2_retry
cs_f2_go:
    v_mov_b64 v[0:1], 0
    v_mov_b64 v[2:3], 0
    v_mov_b64 v[4:5], 0
    v_mov_b64 v[6:7], 0
    s_nop 2
    v_mov_b32 v79, v79
    s_nop 2
    v_mov_b32 v79, v79
    s_nop 2
    v_mov_b32 v79, v79
    s_nop 2
    v_mov_b32 v79, v79
    s_nop 2
    v_mov_b32 v79, v79
    s_nop 2
    v_mov_b32 v79, v79
    s_nop 2
    v_mov_b32 v79, v79
    s_nop 2
    v_mov_b32 v79, v79
    s_nop 2
    v_mov_b32 v79, v79
    s_nop 2
    v_mov_b32 v79, v79
    s_nop 2
    v_mov_b32 v79, v79
    s_nop 2
    v_mov_b32 v79, v79
    s_nop 2
    v_mov_b32 v79, v79
    s_nop 2
    v_mov_b32 v79, v79
    s_nop 2
    v_mov_b32 v79, v79
    s_nop 2
    v_mov_b32 v79, v79
    s_nop 2
    v_mov_b32 v79, v79
    s_nop 2
    v_mov_b32 v79, v79
    s_nop 2
    v_mov_b32 v79, v79
    s_nop 2
    v_mov_b32 v79, v79
    s_nop 2
    v_mov_b32 v79, v79
    s_nop 2
    v_mov_b32 v79, v79
    s_nop 2
    v_mov_b32 v79, v79
    s_nop 2
    v_mov_b32 v79, v79
    s_nop 2
    v_mov_b32 v79, v79
    s_branch cs_loop
cs_f1:
    s_cmp_lg_u32 s32, 1
    s_cbranch_scc1 cs_f3
    v_and_b32 v77, 255, v69
    ds_read_b128 v[4:7], v77 offset:15872
    ds_read_b128 v[40:43], v70 offset:0
    ds_read_b128 v[44:47], v70 offset:1024
    ds_read_b128 v[48:51], v70 offset:2048
    ds_read_b128 v[52:55], v70 offset:3072
    ds_read_b128 v[24:27], v70 offset:4096
    ds_read_b128 v[28:31], v70 offset:5120
    ds_read_b128 v[32:35], v70 offset:6144
    ds_read_b128 v[36:39], v70 offset:7168
    s_mov_b32 s31, 65536
    s_add_u32 s24, s24, 524288
    s_add_u32 s26, s26, 524288
    s_add_u32 s55, s55, s57
    s_mov_b32 s14, 67633152
    s_mov_b32 s15, 67637248
    s_mov_b32 s16, 67641344
    s_mov_b32 s36, 1
    v_mov_b32 v60, s69
    v_mov_b32 v56, s69
    v_and_b32 v79, 12, v75
    v_cmp_eq_u32 vcc, 0, v79
    s_nop 1
    v_cndmask_b32 v79, 0, 1, vcc
    s_nop 2
    v_mov_b32 v79, v79
    s_nop 2
    v_mov_b32 v79, v79
    s_nop 2
    v_mov_b32 v79, v79
    s_nop 2
    v_mov_b32 v79, v79
    s_nop 2
    v_mov_b32 v79, v79
    s_nop 2
    v_mov_b32 v79, v79
    s_nop 2
    v_mov_b32 v79, v79
    s_nop 2
    v_mov_b32 v79, v79
    s_nop 2
    v_mov_b32 v79, v79
    s_nop 2
    v_mov_b32 v79, v79
    s_nop 2
    v_mov_b32 v79, v79
    s_nop 2
    v_mov_b32 v79, v79
    s_nop 2
    v_mov_b32 v79, v79
    s_nop 2
    v_mov_b32 v79, v79
    s_nop 2
    v_mov_b32 v79, v79
    s_nop 2
    v_mov_b32 v79, v79
    s_nop 2
    v_mov_b32 v79, v79
    s_nop 2
    v_mov_b32 v79, v79
    s_nop 2
    v_mov_b32 v79, v79
    s_nop 2
    v_mov_b32 v79, v79
    s_nop 2
    v_mov_b32 v79, v79
    s_nop 2
    v_mov_b32 v79, v79
    s_nop 2
    v_mov_b32 v79, v79
    s_nop 2
    v_mov_b32 v79, v79
    s_nop 2
    v_mov_b32 v79, v79
    s_nop 2
    v_mov_b32 v79, v79
    s_nop 2
    v_mov_b32 v79, v79
    s_nop 2
    v_mov_b32 v79, v79
    s_nop 2
    v_mov_b32 v79, v79
    s_nop 2
    v_mov_b32 v79, v79
    s_nop 2
    v_mov_b32 v79, v79
    s_nop 2
    v_mov_b32 v79, v79
    s_nop 2
    v_mov_b32 v79, v79
    s_nop 2
    v_mov_b32 v79, v79
    s_nop 2
    v_mov_b32 v79, v79
    s_nop 2
    v_mov_b32 v79, v79
    s_nop 2
    v_mov_b32 v79, v79
    s_nop 0
    v_mov_b32 v79, v79
    s_waitcnt vmcnt(0)
    buffer_load_dwordx4 v[8:11], v65, s[4:7], s18 offen sc1
    buffer_load_dwordx4 v[12:15], v65, s[4:7], s19 offen sc1
    buffer_load_dwordx4 v[16:19], v65, s[4:7], s20 offen sc1
    buffer_load_dwordx4 v[20:23], v65, s[4:7], s21 offen sc1
    s_nop 2
    v_mov_b32 v79, v79
    s_nop 2
    v_mov_b32 v79, v79
    s_nop 2
    v_mov_b32 v79, v79
    s_nop 2
    v_mov_b32 v79, v79
    s_nop 2
    v_mov_b32 v79, v79
    s_nop 2
    v_mov_b32 v79, v79
    s_nop 2
    v_mov_b32 v79, v79
    s_nop 2
    v_mov_b32 v79, v79
    s_nop 2
    v_mov_b32 v79, v79
    s_nop 2
    v_mov_b32 v79, v79
    buffer_load_dwordx4 v[60:63], v65, s[4:7], s14 offen offset:0 sc1
    buffer_load_dwordx4 v[56:59], v66, s[4:7], s14 offen offset:0 sc1
    s_waitcnt lgkmcnt(0)
    s_waitcnt vmcnt(5)
    v_xor_b32 v77, s69, v8
    v_mfma_f32_16x16x32_bf16 v[0:3], v[4:7], v[8:11], 0
    v_mov_b64 v[8:9], 0
    v_mov_b64 v[10:11], 0
    s_waitcnt vmcnt(4)
    v_bitop3_b32 v77, v77, v12, s69 bitop3:0xf6
    v_mfma_f32_16x16x32_bf16 v[0:3], v[4:7], v[12:15], v[0:3]
    v_mov_b64 v[12:13], 0
    v_mov_b64 v[14:15], 0
    s_waitcnt vmcnt(3)
    v_bitop3_b32 v77, v77, v16, s69 bitop3:0xf6
    v_mfma_f32_16x16x32_bf16 v[0:3], v[4:7], v[16:19], v[0:3]
    v_mov_b64 v[16:17], 0
    v_mov_b64 v[18:19], 0
    s_waitcnt vmcnt(2)
    v_bitop3_b32 v77, v77, v20, s69 bitop3:0xf6
    v_mfma_f32_16x16x32_bf16 v[0:3], v[4:7], v[20:23], v[0:3]
    v_and_b32 v77, 1, v77
    v_cmp_ne_u32 vcc, 0, v77
    v_mov_b64 v[20:21], 0
    v_mov_b64 v[22:23], 0
    buffer_load_dwordx4 v[60:63], v65, s[4:7], s14 offen offset:0 sc1
    buffer_load_dwordx4 v[56:59], v66, s[4:7], s14 offen offset:0 sc1
    s_cmp_eq_u64 vcc, 0
    s_cselect_b64 s[42:43], -1, 0
    v_add_f32_dpp v0, v0, v0 row_ror:8 row_mask:0xf bank_mask:0xf
    v_add_f32_dpp v1, v1, v1 row_ror:8 row_mask:0xf bank_mask:0xf
    s_mov_b64 exec, s[42:43]
    v_cvt_pk_bf16_f32 v72, v0, v1
    v_bfi_b32 v72, v79, s70, v72
    buffer_store_dword v72, v75, s[4:7], s17 offen offset:0 sc1
    s_mov_b64 exec, -1
    s_cbranch_scc0 cs_f1_retry
cs_f1_go:
    v_mov_b64 v[0:1], 0
    v_mov_b64 v[2:3], 0
    v_mov_b64 v[4:5], 0
    v_mov_b64 v[6:7], 0
    s_nop 2
    v_mov_b32 v79, v79
    s_nop 2
    v_mov_b32 v79, v79
    s_nop 2
    v_mov_b32 v79, v79
    s_nop 2
    v_mov_b32 v79, v79
    s_nop 2
    v_mov_b32 v79, v79
    s_nop 2
    v_mov_b32 v79, v79
    s_nop 2
    v_mov_b32 v79, v79
    s_nop 2
    v_mov_b32 v79, v79
    s_nop 2
    v_mov_b32 v79, v79
    s_nop 2
    v_mov_b32 v79, v79
    s_nop 2
    v_mov_b32 v79, v79
    s_nop 2
    v_mov_b32 v79, v79
    s_nop 2
    v_mov_b32 v79, v79
    s_nop 2
    v_mov_b32 v79, v79
    s_nop 2
    v_mov_b32 v79, v79
    s_nop 2
    v_mov_b32 v79, v79
    s_nop 2
    v_mov_b32 v79, v79
    s_nop 2
    v_mov_b32 v79, v79
    s_nop 2
    v_mov_b32 v79, v79
    s_nop 2
    v_mov_b32 v79, v79
    s_nop 2
    v_mov_b32 v79, v79
    s_nop 2
    v_mov_b32 v79, v79
    s_nop 2
    v_mov_b32 v79, v79
    s_nop 2
    v_mov_b32 v79, v79
    s_nop 2
    v_mov_b32 v79, v79
    s_branch cs_loop
cs_f3:
    v_and_b32 v77, 255, v69
    ds_read_b128 v[4:7], v77 offset:15872
    ds_read_b128 v[40:43], v70 offset:0
    ds_read_b128 v[44:47], v70 offset:1024
    ds_read_b128 v[48:51], v70 offset:2048
    ds_read_b128 v[52:55], v70 offset:3072
    ds_read_b128 v[24:27], v70 offset:4096
    ds_read_b128 v[28:31], v70 offset:5120
    ds_read_b128 v[32:35], v70 offset:6144
    ds_read_b128 v[36:39], v70 offset:7168
    s_mov_b32 s31, 65536
    s_add_u32 s24, s24, 524288
    s_add_u32 s26, s26, 524288
    s_add_u32 s55, s55, s57
    s_mov_b32 s14, 67633152
    s_mov_b32 s15, 67637248
    s_mov_b32 s16, 67641344
    s_mov_b32 s36, 1
    v_mov_b32 v60, s69
    v_mov_b32 v56, s69
    v_and_b32 v79, 12, v75
    v_cmp_eq_u32 vcc, 0, v79
    s_nop 1
    v_cndmask_b32 v79, 0, 1, vcc
    s_add_u32 s40, s30, s95
    v_mov_b32 v72, s40
    s_waitcnt lgkmcnt(0)
    v_mov_b64 v[0:1], 0
    v_mov_b64 v[2:3], 0
    v_mov_b64 v[4:5], 0
    v_mov_b64 v[6:7], 0
    v_mov_b64 v[8:9], 0
    v_mov_b64 v[10:11], 0
    v_mov_b64 v[12:13], 0
    v_mov_b64 v[14:15], 0
    v_mov_b64 v[16:17], 0
    v_mov_b64 v[18:19], 0
    v_mov_b64 v[20:21], 0
    v_mov_b64 v[22:23], 0
    s_nop 2
    v_mov_b32 v79, v79
    s_nop 2
    v_mov_b32 v79, v79
    s_nop 2
    v_mov_b32 v79, v79
    s_nop 2
    v_mov_b32 v79, v79
    s_nop 2
    v_mov_b32 v79, v79
    s_nop 2
    v_mov_b32 v79, v79
    s_nop 2
    v_mov_b32 v79, v79
    s_nop 2
    v_mov_b32 v79, v79
    s_nop 2
    v_mov_b32 v79, v79
    s_nop 2
    v_mov_b32 v79, v79
    s_nop 2
    v_mov_b32 v79, v79
    s_nop 2
    v_mov_b32 v79, v79
    s_nop 2
    v_mov_b32 v79, v79
    s_nop 2
    v_mov_b32 v79, v79
    s_nop 2
    v_mov_b32 v79, v79
    s_nop 2
    v_mov_b32 v79, v79
    s_nop 2
    v_mov_b32 v79, v79
    s_nop 2
    v_mov_b32 v79, v79
    s_nop 2
    v_mov_b32 v79, v79
    s_nop 2
    v_mov_b32 v79, v79
    s_nop 2
    v_mov_b32 v79, v79
    s_nop 2
    v_mov_b32 v79, v79
    s_nop 2
    v_mov_b32 v79, v79
    s_nop 2
    v_mov_b32 v79, v79
    s_nop 2
    v_mov_b32 v79, v79
    s_nop 2
    v_mov_b32 v79, v79
    s_nop 2
    v_mov_b32 v79, v79
    s_nop 2
    v_mov_b32 v79, v79
    s_nop 2
    v_mov_b32 v79, v79
    s_nop 2
    v_mov_b32 v79, v79
    s_nop 2
    v_mov_b32 v79, v79
    s_nop 2
    v_mov_b32 v79, v79
    s_nop 2
    v_mov_b32 v79, v79
    s_nop 2
    v_mov_b32 v79, v79
    s_nop 2
    v_mov_b32 v79, v79
    s_nop 2
    v_mov_b32 v79, v79
    s_nop 2
    v_mov_b32 v79, v79
    s_nop 2
    v_mov_b32 v79, v79
    s_nop 2
    v_mov_b32 v79, v79
    s_nop 2
    v_mov_b32 v79, v79
    s_nop 2
    v_mov_b32 v79, v79
    s_nop 2
    v_mov_b32 v79, v79
    s_nop 2
    v_mov_b32 v79, v79
    s_nop 2
    v_mov_b32 v79, v79
    s_nop 2
    v_mov_b32 v79, v79
    s_nop 2
    v_mov_b32 v79, v79
    s_nop 2
    v_mov_b32 v79, v79
    s_nop 2
    v_mov_b32 v79, v79
    s_nop 2
    v_mov_b32 v79, v79
    s_nop 2
    v_mov_b32 v79, v79
    s_nop 2
    v_mov_b32 v79, v79
    s_nop 2
    v_mov_b32 v79, v79
    s_nop 2
    v_mov_b32 v79, v79
    s_nop 2
    v_mov_b32 v79, v79
    s_nop 2
    v_mov_b32 v79, v79
    s_nop 2
    v_mov_b32 v79, v79
    s_nop 2
    v_mov_b32 v79, v79
    s_nop 2
    v_mov_b32 v79, v79
    s_nop 2
    v_mov_b32 v79, v79
    s_nop 2
    v_mov_b32 v79, v79
    s_nop 2
    v_mov_b32 v79, v79
    s_nop 2
    v_mov_b32 v79, v79
    s_nop 2
    v_mov_b32 v79, v79
    s_nop 2
    v_mov_b32 v79, v79
    s_nop 2
    v_mov_b32 v79, v79
    s_waitcnt vmcnt(0)
    s_cmp_lt_u32 s97, s93
    s_cbranch_scc1 cs_kvwait
    s_nop 2
    v_mov_b32 v79, v79
    s_nop 2
    v_mov_b32 v79, v79
    s_nop 2
    v_mov_b32 v79, v79
    s_nop 2
    v_mov_b32 v79, v79
    s_nop 2
    v_mov_b32 v79, v79
    s_nop 2
    v_mov_b32 v79, v79
    s_nop 2
    v_mov_b32 v79, v79
    s_nop 2
    v_mov_b32 v79, v79
cs_kvok:
    s_branch cs_loop
cs_f0_retry:
cs_f0_spin:
    s_nop 0
    buffer_load_dwordx4 v[8:11], v65, s[4:7], s18 offen sc1
    buffer_load_dwordx4 v[12:15], v65, s[4:7], s19 offen sc1
    buffer_load_dwordx4 v[16:19], v65, s[4:7], s20 offen sc1
    buffer_load_dwordx4 v[20:23], v65, s[4:7], s21 offen sc1
    s_nop 2
    v_mov_b32 v79, v79
    s_nop 2
    v_mov_b32 v79, v79
    s_nop 2
    v_mov_b32 v79, v79
    s_nop 2
    v_mov_b32 v79, v79
    s_nop 2
    v_mov_b32 v79, v79
    s_nop 2
    v_mov_b32 v79, v79
    buffer_load_dwordx4 v[60:63], v65, s[4:7], s14 offen offset:0 sc1
    buffer_load_dwordx4 v[56:59], v66, s[4:7], s14 offen offset:0 sc1
    s_waitcnt vmcnt(5)
    v_xor_b32 v77, s69, v8
    v_mfma_f32_16x16x32_bf16 v[0:3], v[4:7], v[8:11], 0
    v_mov_b64 v[8:9], 0
    v_mov_b64 v[10:11], 0
    s_waitcnt vmcnt(4)
    v_bitop3_b32 v77, v77, v12, s69 bitop3:0xf6
    v_mfma_f32_16x16x32_bf16 v[0:3], v[4:7], v[12:15], v[0:3]
    v_mov_b64 v[12:13], 0
    v_mov_b64 v[14:15], 0
    s_waitcnt vmcnt(3)
    v_bitop3_b32 v77, v77, v16, s69 bitop3:0xf6
    v_mfma_f32_16x16x32_bf16 v[0:3], v[4:7], v[16:19], v[0:3]
    v_mov_b64 v[16:17], 0
    v_mov_b64 v[18:19], 0
    s_waitcnt vmcnt(2)
    v_bitop3_b32 v77, v77, v20, s69 bitop3:0xf6
    v_mfma_f32_16x16x32_bf16 v[0:3], v[4:7], v[20:23], v[0:3]
    v_and_b32 v77, 1, v77
    v_cmp_ne_u32 vcc, 0, v77
    v_mov_b64 v[20:21], 0
    v_mov_b64 v[22:23], 0
    buffer_load_dwordx4 v[60:63], v65, s[4:7], s14 offen offset:0 sc1
    buffer_load_dwordx4 v[56:59], v66, s[4:7], s14 offen offset:0 sc1
    s_cmp_eq_u64 vcc, 0
    s_cselect_b64 s[42:43], -1, 0
    v_add_f32_dpp v0, v0, v0 row_ror:8 row_mask:0xf bank_mask:0xf
    v_add_f32_dpp v1, v1, v1 row_ror:8 row_mask:0xf bank_mask:0xf
    s_mov_b64 exec, s[42:43]
    v_cvt_pk_bf16_f32 v72, v0, v1
    v_bfi_b32 v72, v79, s70, v72
    buffer_store_dword v72, v75, s[4:7], s17 offen offset:0 sc1
    s_mov_b64 exec, -1
    s_cbranch_scc1 cs_f0_rx
    s_sub_u32 s31, s31, 1
    s_cbranch_scc0 cs_f0_spin
cs_f0_rx:
    v_mov_b64 v[0:1], 0
    v_mov_b64 v[2:3], 0
    v_mov_b64 v[4:5], 0
    v_mov_b64 v[6:7], 0
    s_branch cs_loop
cs_f1_retry:
cs_f1_spin:
    s_nop 0
    buffer_load_dwordx4 v[8:11], v65, s[4:7], s18 offen sc1
    buffer_load_dwordx4 v[12:15], v65, s[4:7], s19 offen sc1
    buffer_load_dwordx4 v[16:19], v65, s[4:7], s20 offen sc1
    buffer_load_dwordx4 v[20:23], v65, s[4:7], s21 offen sc1
    s_nop 2
    v_mov_b32 v79, v79
    s_nop 2
    v_mov_b32 v79, v79
    s_nop 2
    v_mov_b32 v79, v79
    s_nop 2
    v_mov_b32 v79, v79
    s_nop 2
    v_mov_b32 v79, v79
    s_nop 2
    v_mov_b32 v79, v79
    buffer_load_dwordx4 v[60:63], v65, s[4:7], s14 offen offset:0 sc1
    buffer_load_dwordx4 v[56:59], v66, s[4:7], s14 offen offset:0 sc1
    s_waitcnt vmcnt(5)
    v_xor_b32 v77, s69, v8
    v_mfma_f32_16x16x32_bf16 v[0:3], v[4:7], v[8:11], 0
    v_mov_b64 v[8:9], 0
    v_mov_b64 v[10:11], 0
    s_waitcnt vmcnt(4)
    v_bitop3_b32 v77, v77, v12, s69 bitop3:0xf6
    v_mfma_f32_16x16x32_bf16 v[0:3], v[4:7], v[12:15], v[0:3]
    v_mov_b64 v[12:13], 0
    v_mov_b64 v[14:15], 0
    s_waitcnt vmcnt(3)
    v_bitop3_b32 v77, v77, v16, s69 bitop3:0xf6
    v_mfma_f32_16x16x32_bf16 v[0:3], v[4:7], v[16:19], v[0:3]
    v_mov_b64 v[16:17], 0
    v_mov_b64 v[18:19], 0
    s_waitcnt vmcnt(2)
    v_bitop3_b32 v77, v77, v20, s69 bitop3:0xf6
    v_mfma_f32_16x16x32_bf16 v[0:3], v[4:7], v[20:23], v[0:3]
    v_and_b32 v77, 1, v77
    v_cmp_ne_u32 vcc, 0, v77
    v_mov_b64 v[20:21], 0
    v_mov_b64 v[22:23], 0
    buffer_load_dwordx4 v[60:63], v65, s[4:7], s14 offen offset:0 sc1
    buffer_load_dwordx4 v[56:59], v66, s[4:7], s14 offen offset:0 sc1
    s_cmp_eq_u64 vcc, 0
    s_cselect_b64 s[42:43], -1, 0
    v_add_f32_dpp v0, v0, v0 row_ror:8 row_mask:0xf bank_mask:0xf
    v_add_f32_dpp v1, v1, v1 row_ror:8 row_mask:0xf bank_mask:0xf
    s_mov_b64 exec, s[42:43]
    v_cvt_pk_bf16_f32 v72, v0, v1
    v_bfi_b32 v72, v79, s70, v72
    buffer_store_dword v72, v75, s[4:7], s17 offen offset:0 sc1
    s_mov_b64 exec, -1
    s_cbranch_scc1 cs_f1_rx
    s_sub_u32 s31, s31, 1
    s_cbranch_scc0 cs_f1_spin
cs_f1_rx:
    v_mov_b64 v[0:1], 0
    v_mov_b64 v[2:3], 0
    v_mov_b64 v[4:5], 0
    v_mov_b64 v[6:7], 0
    s_branch cs_loop
cs_f2_retry:
cs_f2_spin:
    s_nop 0
    buffer_load_dwordx4 v[8:11], v65, s[4:7], s18 offen sc1
    buffer_load_dwordx4 v[12:15], v65, s[4:7], s19 offen sc1
    buffer_load_dwordx4 v[16:19], v65, s[4:7], s20 offen sc1
    buffer_load_dwordx4 v[20:23], v65, s[4:7], s21 offen sc1
    s_nop 2
    v_mov_b32 v79, v79
    s_nop 2
    v_mov_b32 v79, v79
    s_nop 2
    v_mov_b32 v79, v79
    s_nop 2
    v_mov_b32 v79, v79
    s_nop 2
    v_mov_b32 v79, v79
    s_nop 2
    v_mov_b32 v79, v79
    buffer_load_dwordx4 v[60:63], v65, s[4:7], s14 offen offset:0 sc1
    buffer_load_dwordx4 v[56:59], v66, s[4:7], s14 offen offset:0 sc1
    s_waitcnt vmcnt(5)
    v_xor_b32 v77, s69, v8
    v_bitop3_b32 v77, v77, v10, s69 bitop3:0xf6
    v_mfma_f32_16x16x32_bf16 v[0:3], v[4:7], v[8:11], 0
    v_mov_b64 v[8:9], 0
    v_mov_b64 v[10:11], 0
    s_waitcnt vmcnt(4)
    v_bitop3_b32 v77, v77, v12, s69 bitop3:0xf6
    v_bitop3_b32 v77, v77, v14, s69 bitop3:0xf6
    v_mfma_f32_16x16x32_bf16 v[0:3], v[4:7], v[12:15], v[0:3]
    v_mov_b64 v[12:13], 0
    v_mov_b64 v[14:15], 0
    s_waitcnt vmcnt(3)
    v_bitop3_b32 v77, v77, v16, s69 bitop3:0xf6
    v_bitop3_b32 v77, v77, v18, s69 bitop3:0xf6
    v_mfma_f32_16x16x32_bf16 v[0:3], v[4:7], v[16:19], v[0:3]
    v_mov_b64 v[16:17], 0
    v_mov_b64 v[18:19], 0
    s_waitcnt vmcnt(2)
    v_bitop3_b32 v77, v77, v20, s69 bitop3:0xf6
    v_bitop3_b32 v77, v77, v22, s69 bitop3:0xf6
    v_mfma_f32_16x16x32_bf16 v[0:3], v[4:7], v[20:23], v[0:3]
    v_and_b32 v77, 1, v77
    v_cmp_ne_u32 vcc, 0, v77
    v_mov_b64 v[20:21], 0
    v_mov_b64 v[22:23], 0
    buffer_load_dwordx4 v[60:63], v65, s[4:7], s14 offen offset:0 sc1
    buffer_load_dwordx4 v[56:59], v66, s[4:7], s14 offen offset:0 sc1
    s_cmp_eq_u64 vcc, 0
    s_cselect_b64 s[42:43], -1, 0
    v_add_f32 v2, v0, v1
    s_nop 1
    v_add_f32_dpp v2, v2, v2 row_ror:8 row_mask:0xf bank_mask:0xf
    s_nop 1
    v_mov_b32_dpp v0, v2 quad_perm:[0,0,2,2] row_mask:0xf bank_mask:0xf
    v_mov_b32_dpp v1, v2 quad_perm:[1,1,3,3] row_mask:0xf bank_mask:0xf
    s_mov_b64 exec, s[42:43]
    v_cvt_pk_bf16_f32 v72, v0, v1
    v_bfi_b32 v72, v79, s70, v72
    buffer_store_dword v72, v75, s[4:7], s17 offen offset:0 sc1
    buffer_store_dword v72, v75, s[4:7], s17 offen offset:1024 sc1
    buffer_store_dword v72, v75, s[4:7], s17 offen offset:2048 sc1
    buffer_store_dword v72, v75, s[4:7], s17 offen offset:3072 sc1
    s_mov_b64 exec, -1
    s_cbranch_scc1 cs_f2_rx
    s_sub_u32 s31, s31, 1
    s_cbranch_scc0 cs_f2_spin
cs_f2_rx:
    v_mov_b64 v[0:1], 0
    v_mov_b64 v[2:3], 0
    v_mov_b64 v[4:5], 0
    v_mov_b64 v[6:7], 0
    s_branch cs_loop
cs_spinB:
    buffer_load_dwordx4 v[40:43], v65, s[4:7], s15 offen sc1
cs_spinB_l:
    v_and_b32 v77, s36, v40
    v_cmp_ne_u32 vcc, s70, v77
    s_cbranch_vccz cs_spinB_x
    s_nop 15
    s_nop 15
    s_nop 15
    s_nop 11
    v_and_b32 v77, s36, v40
    v_cmp_ne_u32 vcc, s70, v77
    s_cbranch_vccz cs_spinB_x
    s_nop 15
    s_nop 15
    s_nop 15
    s_nop 11
    v_and_b32 v77, s36, v40
    v_cmp_ne_u32 vcc, s70, v77
    s_cbranch_vccz cs_spinB_x
    s_nop 15
    s_nop 15
    s_nop 15
    s_nop 11
    buffer_load_dwordx4 v[40:43], v65, s[4:7], s15 offen sc1
    s_sub_u32 s31, s31, 16
    s_cbranch_scc0 cs_spinB_l
cs_spinB_x:
    ds_write_b128 v65, v[40:43] offset:4096
    s_waitcnt lgkmcnt(0)
    s_branch cs_backB
cs_spin8:
    buffer_load_dwordx4 v[60:63], v65, s[4:7], s16 offen sc1
cs_spin8_l:
    v_and_b32 v77, s36, v60
    v_cmp_ne_u32 vcc, s70, v77
    s_cbranch_vccz cs_spin8_x
    s_nop 15
    s_nop 15
    s_nop 15
    s_nop 11
    v_and_b32 v77, s36, v60
    v_cmp_ne_u32 vcc, s70, v77
    s_cbranch_vccz cs_spin8_x
    s_nop 15
    s_nop 15
    s_nop 15
    s_nop 11
    v_and_b32 v77, s36, v60
    v_cmp_ne_u32 vcc, s70, v77
    s_cbranch_vccz cs_spin8_x
    s_nop 15
    s_nop 15
    s_nop 15
    s_nop 11
    buffer_load_dwordx4 v[60:63], v65, s[4:7], s16 offen sc1
    s_sub_u32 s31, s31, 16
    s_cbranch_scc0 cs_spin8_l
cs_spin8_x:
    s_branch cs_back8
cs_rare:
    s_mov_b64 exec, s[34:35]
    buffer_store_dwordx4 v[0:3], v65, s[4:7], s28 offen sc1
    s_mov_b64 exec, -1
    s_nop 3
    v_cvt_pk_bf16_f32 v48, v16, v17
    v_cvt_pk_bf16_f32 v49, v18, v19
    v_cvt_pk_bf16_f32 v50, v20, v21
    v_cvt_pk_bf16_f32 v51, v22, v23
    buffer_store_dwordx4 v[48:51], v65, s[4:7], s27 offen sc1
    s_add_u32 s28, s28, 131072
    s_add_u32 s27, s27, 131072
    s_cmp_eq_u32 s30, 63
    s_cbranch_scc1 cs_last
    s_branch cs_rare_x
cs_kvwait:
    s_mov_b32 s41, s97
    v_bfe_u32 v78, v65, 2, 5
    v_mov_b32 v77, v76
    s_nop 1
    v_permlane32_swap_b32 v76, v77
    v_subrev_u32 v77, s95, v77
    v_cmp_lt_u32 vcc, 16, v77
    s_nop 1
    v_cndmask_b32 v77, v77, 0, vcc
    v_bfe_u32 v79, v78, 2, 2
    v_lshl_add_u32 v77, v77, 2, v79
    s_nop 1
    v_min_u32_dpp v77, v77, v77 row_ror:1 row_mask:0xf bank_mask:0xf
    s_nop 1
    v_min_u32_dpp v77, v77, v77 row_ror:2 row_mask:0xf bank_mask:0xf
    s_nop 1
    v_min_u32_dpp v77, v77, v77 row_ror:4 row_mask:0xf bank_mask:0xf
    s_nop 0
    v_readfirstlane_b32 s97, v77
    s_nop 0
    s_max_u32 s97, s97, s41
    s_add_u32 s40, s30, 3
    s_min_u32 s40, s40, 64
    s_cmp_le_u32 s40, s97
    s_cbranch_scc1 cs_kvw_x
    v_bfe_u32 v78, v65, 2, 5
    s_mov_b32 s31, 4194304
cs_kvw:
    buffer_load_dword v77, v78, s[4:7], s96 offen offset:16 sc1
    s_waitcnt vmcnt(0)
    v_subrev_u32 v77, s95, v77
    v_cmp_lt_u32 vcc, 16, v77
    s_nop 1
    v_cndmask_b32 v77, v77, 0, vcc
    v_bfe_u32 v79, v78, 2, 2
    v_lshl_add_u32 v77, v77, 2, v79
    s_nop 1
    v_min_u32_dpp v77, v77, v77 row_ror:1 row_mask:0xf bank_mask:0xf
    s_nop 1
    v_min_u32_dpp v77, v77, v77 row_ror:2 row_mask:0xf bank_mask:0xf
    s_nop 1
    v_min_u32_dpp v77, v77, v77 row_ror:4 row_mask:0xf bank_mask:0xf
    s_nop 0
    v_readfirstlane_b32 s97, v77
    s_sub_u32 s31, s31, 1
    s_cbranch_scc1 cs_kvw_x
    s_cmp_le_u32 s40, s97
    s_cbranch_scc1 cs_kvw_x
    s_sleep 2
    s_branch cs_kvw
cs_kvw_x:
    s_branch cs_kvok
cs_last:
    s_add_u32 s40, s95, 64
    v_mov_b32 v78, s40
    s_waitcnt vmcnt(0)
    s_barrier
    s_mov_b64 exec, s[100:101]
    buffer_store_dword v78, off, s[4:7], s29 sc1
    s_mov_b64 exec, -1
cs_end:
    s_endpgm
L_xform:
    v_and_b32 v1, 63, v0
    v_and_b32 v2, 15, v1
    v_lshrrev_b32 v3, 4, v1
    v_mov_b32 v7, 0x05040100
    v_mov_b32 v8, 0x07060302
    v_lshrrev_b32 v9, 6, v0
    v_lshlrev_b32 v9, 14, v9
    v_lshlrev_b32 v10, 4, v1
    v_add_u32 v11, v9, v10
    s_mov_b32 s10, 4718592
    s_mov_b32 s11, 0x20000
    s_mov_b64 s[8:9], s[58:59]
xf_f:
    s_sub_u32 s17, s16, 1504
    s_and_b32 s18, s17, 127
    s_lshr_b32 s17, s17, 7
    s_lshl_b32 s19, s17, 4
    v_add_u32 v6, s19, v2
    v_mul_u32_u24 v4, 9216, v3
    v_lshl_add_u32 v4, v6, 4, v4
    v_lshrrev_b32 v5, 2, v2
    v_lshlrev_b32 v5, 11, v5
    v_lshl_add_u32 v5, v3, 8, v5
    v_and_b32 v1, 3, v6
    v_lshl_add_u32 v5, v1, 6, v5
    v_add_u32 v5, v5, v9
    v_cmp_gt_u32 vcc, 72, v6
    s_nop 0
    s_mov_b64 exec, vcc
    s_mul_i32 s20, s18, 36864
    s_add_u32 s21, s20, 0
    buffer_load_dwordx4 v[12:15], v4, s[8:11], s21 offen
    s_add_u32 s21, s20, 1152
    buffer_load_dwordx4 v[16:19], v4, s[8:11], s21 offen
    s_add_u32 s21, s20, 2304
    buffer_load_dwordx4 v[20:23], v4, s[8:11], s21 offen
    s_add_u32 s21, s20, 3456
    buffer_load_dwordx4 v[24:27], v4, s[8:11], s21 offen
    s_add_u32 s21, s20, 4608
    buffer_load_dwordx4 v[28:31], v4, s[8:11], s21 offen
    s_add_u32 s21, s20, 5760
    buffer_load_dwordx4 v[32:35], v4, s[8:11], s21 offen
    s_add_u32 s21, s20, 6912
    buffer_load_dwordx4 v[36:39], v4, s[8:11], s21 offen
    s_add_u32 s21, s20, 8064
    buffer_load_dwordx4 v[40:43], v4, s[8:11], s21 offen
    s_lshl_b32 s20, s18, 11
    s_add_u32 s20, s20, 130023424
    s_waitcnt vmcnt(0)
    v_perm_b32 v76, v16, v12, v7
    v_perm_b32 v77, v24, v20, v7
    v_perm_b32 v78, v32, v28, v7
    v_perm_b32 v79, v40, v36, v7
    ds_write_b128 v5, v[76:79] offset:0
    v_perm_b32 v80, v17, v13, v7
    v_perm_b32 v81, v25, v21, v7
    v_perm_b32 v82, v33, v29, v7
    v_perm_b32 v83, v41, v37, v7
    ds_write_b128 v5, v[80:83] offset:16
    v_perm_b32 v84, v18, v14, v7
    v_perm_b32 v85, v26, v22, v7
    v_perm_b32 v86, v34, v30, v7
    v_perm_b32 v87, v42, v38, v7
    ds_write_b128 v5, v[84:87] offset:32
    v_perm_b32 v88, v19, v15, v7
    v_perm_b32 v89, v27, v23, v7
    v_perm_b32 v90, v35, v31, v7
    v_perm_b32 v91, v43, v39, v7
    ds_write_b128 v5, v[88:91] offset:48
    v_perm_b32 v92, v16, v12, v8
    v_perm_b32 v93, v24, v20, v8
    v_perm_b32 v94, v32, v28, v8
    v_perm_b32 v95, v40, v36, v8
    ds_write_b128 v5, v[92:95] offset:1024
    v_perm_b32 v96, v17, v13, v8
    v_perm_b32 v97, v25, v21, v8
    v_perm_b32 v98, v33, v29, v8
    v_perm_b32 v99, v41, v37, v8
    ds_write_b128 v5, v[96:99] offset:1040
    v_perm_b32 v100, v18, v14, v8
    v_perm_b32 v101, v26, v22, v8
    v_perm_b32 v102, v34, v30, v8
    v_perm_b32 v103, v42, v38, v8
    ds_write_b128 v5, v[100:103] offset:1056
    v_perm_b32 v104, v19, v15, v8
    v_perm_b32 v105, v27, v23, v8
    v_perm_b32 v106, v35, v31, v8
    v_perm_b32 v107, v43, v39, v8
    ds_write_b128 v5, v[104:107] offset:1072
    s_mov_b64 exec, -1
    s_lshl_b32 s21, s17, 20
    s_add_u32 s20, s20, s21
    s_waitcnt lgkmcnt(0)
    ds_read_b128 v[76:79], v11 offset:0
    ds_read_b128 v[80:83], v11 offset:1024
    ds_read_b128 v[84:87], v11 offset:2048
    ds_read_b128 v[88:91], v11 offset:3072
    ds_read_b128 v[92:95], v11 offset:4096
    ds_read_b128 v[96:99], v11 offset:5120
    ds_read_b128 v[100:103], v11 offset:6144
    ds_read_b128 v[104:107], v11 offset:7168
    s_add_u32 s19, s20, 0
    s_waitcnt lgkmcnt(7)
    buffer_store_dwordx4 v[76:79], v10, s[4:7], s19 offen sc1
    s_add_u32 s19, s20, 1024
    s_waitcnt lgkmcnt(6)
    buffer_store_dwordx4 v[80:83], v10, s[4:7], s19 offen sc1
    s_add_u32 s19, s20, 262144
    s_waitcnt lgkmcnt(5)
    buffer_store_dwordx4 v[84:87], v10, s[4:7], s19 offen sc1
    s_add_u32 s19, s20, 263168
    s_waitcnt lgkmcnt(4)
    buffer_store_dwordx4 v[88:91], v10, s[4:7], s19 offen sc1
    s_add_u32 s19, s20, 524288
    s_waitcnt lgkmcnt(3)
    buffer_store_dwordx4 v[92:95], v10, s[4:7], s19 offen sc1
    s_add_u32 s19, s20, 525312
    s_waitcnt lgkmcnt(2)
    buffer_store_dwordx4 v[96:99], v10, s[4:7], s19 offen sc1
    s_add_u32 s19, s20, 786432
    s_waitcnt lgkmcnt(1)
    buffer_store_dwordx4 v[100:103], v10, s[4:7], s19 offen sc1
    s_add_u32 s19, s20, 787456
    s_waitcnt lgkmcnt(0)
    buffer_store_dwordx4 v[104:107], v10, s[4:7], s19 offen sc1
xf_done:
    s_nop 1
    s_setpc_b64 s[46:47]
L_helper:
    s_load_dwordx16 s[64:79], s[0:1], 64
    s_waitcnt lgkmcnt(0)
    s_mov_b32 s93, 1000
    s_cmp_lg_u32 s3, 2
    s_cbranch_scc1 L_qkv_next
    s_mov_b32 s37, 24
    v_mov_b32 v250, 1
    v_mov_b32 v251, 163832
    v_cmp_eq_u32 vcc, 0, v0
    s_nop 0
    s_and_saveexec_b64 s[38:39], vcc
    s_cbranch_execz tk3
    buffer_atomic_add v250, off, s[84:87], s37 sc0
    s_waitcnt vmcnt(0)
    ds_write_b32 v251, v250
    s_waitcnt lgkmcnt(0)
tk3:
    s_mov_b64 exec, -1
    s_barrier
    ds_read_b32 v252, v251
    s_waitcnt lgkmcnt(0)
    v_readfirstlane_b32 s36, v252
    s_barrier
    s_nop 3
    s_cmp_ge_u32 s36, 32
    s_cbranch_scc1 L_qkv_next
    s_mov_b32 s93, 2
    s_mov_b32 s88, 4194304
gn4:
    buffer_load_dword v250, off, s[84:87], 0 offset:216 sc1
    s_waitcnt vmcnt(0)
    v_readfirstlane_b32 s95, v250
    s_sub_u32 s88, s88, 1
    s_cbranch_scc1 gn4x
    s_cmp_eq_u32 s95, 0
    s_cbranch_scc1 gn4
gn4x:
    s_cmp_eq_u32 s36, 0
    s_cbranch_scc1 L_relay
    s_branch L_ssm_next
L_qkv_next:
    s_mov_b32 s37, 4
    v_mov_b32 v250, 1
    v_mov_b32 v251, 163832
    v_cmp_eq_u32 vcc, 0, v0
    s_nop 0
    s_and_saveexec_b64 s[38:39], vcc
    s_cbranch_execz tk5
    buffer_atomic_add v250, off, s[84:87], s37 sc0
    s_waitcnt vmcnt(0)
    ds_write_b32 v251, v250
    s_waitcnt lgkmcnt(0)
tk5:
    s_mov_b64 exec, -1
    s_barrier
    ds_read_b32 v252, v251
    s_waitcnt lgkmcnt(0)
    v_readfirstlane_b32 s36, v252
    s_barrier
    s_nop 3
    s_or_b32 s37, s36, s32
    s_cbranch_scc1 L_non
    s_memrealtime s[90:91]
    s_waitcnt lgkmcnt(0)
    s_lshl_b32 s90, s90, 8
    s_or_b32 s90, s90, 1
    v_mov_b32 v250, s90
    s_mov_b64 exec, 1
    buffer_store_dword v250, off, s[84:87], 0 offset:216 sc1
    s_mov_b64 exec, -1
L_non:
    s_cmp_lt_u32 s36, 192
    s_cbranch_scc1 L_qkv
    s_mov_b32 s88, 4194304
gn6:
    buffer_load_dword v250, off, s[84:87], 0 offset:216 sc1
    s_waitcnt vmcnt(0)
    v_readfirstlane_b32 s95, v250
    s_sub_u32 s88, s88, 1
    s_cbranch_scc1 gn6x
    s_cmp_eq_u32 s95, 0
    s_cbranch_scc1 gn6
gn6x:
    s_cmp_lg_u32 s36, 192
    s_cbranch_scc1 L_ssm_next
    s_mov_b32 s37, 24
    v_mov_b32 v250, 1
    v_mov_b32 v251, 163832
    v_cmp_eq_u32 vcc, 0, v0
    s_nop 0
    s_and_saveexec_b64 s[38:39], vcc
    s_cbranch_execz tk7
    buffer_atomic_add v250, off, s[84:87], s37 sc0
    s_waitcnt vmcnt(0)
    ds_write_b32 v251, v250
    s_waitcnt lgkmcnt(0)
tk7:
    s_mov_b64 exec, -1
    s_barrier
    ds_read_b32 v252, v251
    s_waitcnt lgkmcnt(0)
    v_readfirstlane_b32 s36, v252
    s_barrier
    s_nop 3
    s_cmp_lg_u32 s36, 0
    s_cbranch_scc1 L_ssm_next
L_relay:
    s_cmp_lg_u32 s32, 0
    s_cbranch_scc1 L_exit
    v_and_b32 v3, 31, v0
    v_lshlrev_b32 v3, 7, v3
    s_mov_b32 s17, 0
    s_mov_b32 s23, 125845504
    s_mov_b32 s24, 125853696
    s_mov_b32 s21, 16777216
rl_rwait:
    buffer_load_dword v4, v3, s[4:7], s23 offen sc1
    s_waitcnt vmcnt(0)
    v_subrev_u32 v4, s95, v4
    v_cmp_lt_u32 vcc, 64, v4
    s_nop 1
    v_cndmask_b32 v4, v4, 0, vcc
    s_nop 1
    v_min_u32_dpp v4, v4, v4 row_ror:1 row_mask:0xf bank_mask:0xf
    s_nop 1
    v_min_u32_dpp v4, v4, v4 row_ror:2 row_mask:0xf bank_mask:0xf
    s_nop 1
    v_min_u32_dpp v4, v4, v4 row_ror:4 row_mask:0xf bank_mask:0xf
    s_nop 1
    v_min_u32_dpp v4, v4, v4 row_ror:8 row_mask:0xf bank_mask:0xf
    s_nop 0
    v_readlane_b32 s16, v4, 0
    v_readlane_b32 s22, v4, 16
    s_nop 0
    s_min_u32 s16, s16, s22
    s_sub_u32 s21, s21, 1
    s_cbranch_scc1 rl_x
    s_cmp_gt_u32 s16, s17
    s_cbranch_scc1 rl_rpub
    s_sleep 2
    s_branch rl_rwait
rl_rpub:
    s_mov_b32 s17, s16
    s_add_u32 s22, s16, s95
    v_mov_b32 v4, s22
    s_mov_b64 exec, 1
    buffer_store_dword v4, off, s[4:7], s24 sc1
    s_mov_b64 exec, -1
    s_cmp_lt_u32 s16, 64
    s_cbranch_scc1 rl_rwait
rl_x:
    s_endpgm
L_qkv:
    s_and_b32 s17, s36, 15
    s_lshl_b32 s17, s17, 1
    s_lshr_b32 s36, s36, 4
    s_and_b32 s16, s36, 1
    s_add_u32 s16, s16, 1
    s_lshr_b32 s19, s36, 1
    s_and_b32 s37, s36, 3
    s_cmp_ge_u32 s36, 8
    s_cselect_b32 s16, 0, s16
    s_cselect_b32 s19, s37, s19
    v_lshrrev_b32 v4, 6, v0
    s_nop 0
    v_readfirstlane_b32 s18, v4
    v_lshlrev_b32 v7, 4, v0
    s_cmp_eq_u32 s16, 1
    s_cselect_b64 s[12:13], s[54:55], s[52:53]
    s_cmp_eq_u32 s16, 2
    s_cselect_b64 s[12:13], s[56:57], s[12:13]
    s_mov_b32 s14, 4718592
    s_mov_b32 s15, 0x20000
    v_bfe_u32 v4, v0, 5, 1
    v_lshlrev_b32 v5, 2, v4
    v_and_b32 v8, 31, v0
    v_xor_b32 v8, v8, v5
    v_lshlrev_b32 v8, 4, v8
    v_lshl_add_u32 v8, v4, 13, v8
    v_xor_b32 v9, 128, v8
    s_lshl_b32 s21, s17, 8
    s_lshl_b32 s42, s18, 16
    s_add_u32 s42, s42, s21
    s_lshl_b32 s44, s18, 12
    s_barrier
    s_add_u32 m0, s44, 73728
    s_add_u32 s22, s42, 0
    buffer_load_dwordx4 v8, s[12:15], s22 offen offset:0 lds
    s_add_u32 s22, s42, 15360
    buffer_load_dwordx4 v9, s[12:15], s22 offen offset:1024 lds
    s_add_u32 s22, s42, 30720
    buffer_load_dwordx4 v8, s[12:15], s22 offen offset:2048 lds
    s_add_u32 s22, s42, 46080
    buffer_load_dwordx4 v9, s[12:15], s22 offen offset:3072 lds
    s_add_u32 m0, s44, 90112
    s_add_u32 s22, s42, 262144
    buffer_load_dwordx4 v8, s[12:15], s22 offen offset:0 lds
    s_add_u32 s22, s42, 277504
    buffer_load_dwordx4 v9, s[12:15], s22 offen offset:1024 lds
    s_add_u32 s22, s42, 292864
    buffer_load_dwordx4 v8, s[12:15], s22 offen offset:2048 lds
    s_add_u32 s22, s42, 308224
    buffer_load_dwordx4 v9, s[12:15], s22 offen offset:3072 lds
    s_add_u32 m0, s44, 106496
    s_add_u32 s22, s42, 524288
    buffer_load_dwordx4 v8, s[12:15], s22 offen offset:0 lds
    s_add_u32 s22, s42, 539648
    buffer_load_dwordx4 v9, s[12:15], s22 offen offset:1024 lds
    s_add_u32 s22, s42, 555008
    buffer_load_dwordx4 v8, s[12:15], s22 offen offset:2048 lds
    s_add_u32 s22, s42, 570368
    buffer_load_dwordx4 v9, s[12:15], s22 offen offset:3072 lds
    s_add_u32 m0, s44, 122880
    s_add_u32 s22, s42, 786432
    buffer_load_dwordx4 v8, s[12:15], s22 offen offset:0 lds
    s_add_u32 s22, s42, 801792
    buffer_load_dwordx4 v9, s[12:15], s22 offen offset:1024 lds
    s_add_u32 s22, s42, 817152
    buffer_load_dwordx4 v8, s[12:15], s22 offen offset:2048 lds
    s_add_u32 s22, s42, 832512
    buffer_load_dwordx4 v9, s[12:15], s22 offen offset:3072 lds
    v_bfe_u32 v4, v0, 2, 2
    v_xor_b32 v5, s18, v4
    v_lshlrev_b32 v10, 6, v5
    v_lshl_add_u32 v10, v4, 9, v10
    v_and_b32 v4, 3, v0
    v_lshl_add_u32 v10, v4, 4, v10
    v_bfe_u32 v4, v0, 4, 2
    v_lshl_add_u32 v10, v4, 12, v10
    v_add_u32 v10, 73728, v10
    v_add_u32 v11, 49152, v10
    v_and_b32 v4, 63, v0
    v_and_b32 v5, 15, v4
    v_lshrrev_b32 v3, 4, v4
    v_lshrrev_b32 v2, 2, v5
    v_xor_b32 v3, v3, v2
    v_lshl_add_u32 v3, v5, 2, v3
    v_lshlrev_b32 v1, 4, v3
    v_lshrrev_b32 v5, 2, v4
    v_lshrrev_b32 v3, 4, v4
    v_and_b32 v4, 3, v4
    v_xor_b32 v4, v4, v3
    v_lshlrev_b32 v3, 3, v3
    v_and_b32 v5, 3, v5
    v_add_u32 v3, v3, v5
    v_mul_u32_u24 v2, 1152, v3
    v_lshl_add_u32 v2, v4, 4, v2
    s_mov_b32 s8, s48
    s_mov_b32 s9, s49
    s_mov_b32 s10, 2359296
    s_mov_b32 s11, 0x20000
    s_lshr_b32 s22, s18, 1
    s_mul_i32 s24, s22, 4608
    s_mul_i32 s25, s22, 18432
    s_and_b32 s22, s18, 1
    s_mul_i32 s23, s22, 576
    s_add_u32 s24, s24, s23
    s_mul_i32 s25, s18, 9216
    s_mul_i32 s22, s19, 36864
    s_add_u32 s24, s24, s22
    s_mov_b32 s20, 64
    s_lshl_b32 s22, s19, 5
    s_add_u32 s22, s22, s17
    s_lshl_b32 s26, s22, 14
    s_mul_i32 s23, s18, 3072
    s_add_u32 s26, s26, s23
    s_lshl_b32 s23, s16, 11
    s_add_u32 s26, s26, s23
    s_add_u32 s26, s26, -2048
    s_lshl_b32 s22, s22, 13
    s_add_u32 s22, s22, 33554432
    s_cmp_eq_u32 s16, 0
    s_cselect_b32 s26, s22, s26
    s_cselect_b32 s40, 4096, 64
    s_cselect_b32 s41, 1, 2
    s_max_u32 s40, s40, 1024
    s_lshl_b32 s41, s41, 18
    s_lshl_b32 s29, s17, 7
    s_lshl_b32 s22, s16, 4
    s_add_u32 s29, s29, s22
    s_lshl_b32 s22, s19, 2
    s_add_u32 s29, s29, s22
    s_add_u32 s29, s29, 125829120
    s_mov_b32 s27, 0
    s_add_u32 s23, s27, s25
    s_add_u32 m0, s23, 0
    s_nop 0
    buffer_load_dwordx4 v2, s[8:11], s24 offen offset:0 lds
    s_add_u32 m0, s23, 960
    s_nop 0
    buffer_load_dwordx4 v2, s[8:11], s24 offen offset:64 lds
    s_add_u32 m0, s23, 1920
    s_nop 0
    buffer_load_dwordx4 v2, s[8:11], s24 offen offset:128 lds
    s_add_u32 m0, s23, 2880
    s_nop 0
    buffer_load_dwordx4 v2, s[8:11], s24 offen offset:192 lds
    s_add_u32 m0, s23, 3840
    s_nop 0
    buffer_load_dwordx4 v2, s[8:11], s24 offen offset:256 lds
    s_add_u32 m0, s23, 4800
    s_nop 0
    buffer_load_dwordx4 v2, s[8:11], s24 offen offset:320 lds
    s_add_u32 m0, s23, 5760
    s_nop 0
    buffer_load_dwordx4 v2, s[8:11], s24 offen offset:384 lds
    s_add_u32 m0, s23, 6720
    s_nop 0
    buffer_load_dwordx4 v2, s[8:11], s24 offen offset:448 lds
    s_add_u32 m0, s23, 7680
    s_nop 0
    buffer_load_dwordx4 v2, s[8:11], s24 offen offset:512 lds
    s_add_u32 s24, s24, 147456
    s_waitcnt vmcnt(21) lgkmcnt(0)
    s_barrier
    s_add_u32 m0, s44, 139264
    s_add_u32 s22, s42, 1048576
    buffer_load_dwordx4 v8, s[12:15], s22 offen offset:0 lds
    s_add_u32 s22, s42, 1063936
    buffer_load_dwordx4 v9, s[12:15], s22 offen offset:1024 lds
    s_add_u32 s22, s42, 1079296
    buffer_load_dwordx4 v8, s[12:15], s22 offen offset:2048 lds
    s_add_u32 s22, s42, 1094656
    buffer_load_dwordx4 v9, s[12:15], s22 offen offset:3072 lds
    ds_read_b64_tr_b16 v[64:65], v10 offset:0
    ds_read_b64_tr_b16 v[66:67], v10 offset:2048
    ds_read_b64_tr_b16 v[136:137], v10 offset:8
    ds_read_b64_tr_b16 v[138:139], v10 offset:2056
    ds_read_b64_tr_b16 a[0:1], v10 offset:256
    ds_read_b64_tr_b16 a[2:3], v10 offset:2304
    ds_read_b64_tr_b16 a[72:73], v10 offset:264
    ds_read_b64_tr_b16 a[74:75], v10 offset:2312
    s_waitcnt vmcnt(21) lgkmcnt(0)
    s_barrier
    s_add_u32 m0, s44, 73728
    s_add_u32 s22, s42, 1310720
    buffer_load_dwordx4 v8, s[12:15], s22 offen offset:0 lds
    s_add_u32 s22, s42, 1326080
    buffer_load_dwordx4 v9, s[12:15], s22 offen offset:1024 lds
    s_add_u32 s22, s42, 1341440
    buffer_load_dwordx4 v8, s[12:15], s22 offen offset:2048 lds
    s_add_u32 s22, s42, 1356800
    buffer_load_dwordx4 v9, s[12:15], s22 offen offset:3072 lds
    ds_read_b64_tr_b16 v[68:69], v10 offset:16384
    ds_read_b64_tr_b16 v[70:71], v10 offset:18432
    ds_read_b64_tr_b16 v[140:141], v10 offset:16392
    ds_read_b64_tr_b16 v[142:143], v10 offset:18440
    ds_read_b64_tr_b16 a[4:5], v10 offset:16640
    ds_read_b64_tr_b16 a[6:7], v10 offset:18688
    ds_read_b64_tr_b16 a[76:77], v10 offset:16648
    ds_read_b64_tr_b16 a[78:79], v10 offset:18696
    s_waitcnt vmcnt(21) lgkmcnt(0)
    s_barrier
    s_add_u32 m0, s44, 90112
    s_add_u32 s22, s42, 1572864
    buffer_load_dwordx4 v8, s[12:15], s22 offen offset:0 lds
    s_add_u32 s22, s42, 1588224
    buffer_load_dwordx4 v9, s[12:15], s22 offen offset:1024 lds
    s_add_u32 s22, s42, 1603584
    buffer_load_dwordx4 v8, s[12:15], s22 offen offset:2048 lds
    s_add_u32 s22, s42, 1618944
    buffer_load_dwordx4 v9, s[12:15], s22 offen offset:3072 lds
    ds_read_b64_tr_b16 v[72:73], v10 offset:32768
    ds_read_b64_tr_b16 v[74:75], v10 offset:34816
    ds_read_b64_tr_b16 v[144:145], v10 offset:32776
    ds_read_b64_tr_b16 v[146:147], v10 offset:34824
    ds_read_b64_tr_b16 a[8:9], v10 offset:33024
    ds_read_b64_tr_b16 a[10:11], v10 offset:35072
    ds_read_b64_tr_b16 a[80:81], v10 offset:33032
    ds_read_b64_tr_b16 a[82:83], v10 offset:35080
    s_waitcnt vmcnt(21) lgkmcnt(0)
    s_barrier
    s_add_u32 m0, s44, 106496
    s_add_u32 s22, s42, 1835008
    buffer_load_dwordx4 v8, s[12:15], s22 offen offset:0 lds
    s_add_u32 s22, s42, 1850368
    buffer_load_dwordx4 v9, s[12:15], s22 offen offset:1024 lds
    s_add_u32 s22, s42, 1865728
    buffer_load_dwordx4 v8, s[12:15], s22 offen offset:2048 lds
    s_add_u32 s22, s42, 1881088
    buffer_load_dwordx4 v9, s[12:15], s22 offen offset:3072 lds
    ds_read_b64_tr_b16 v[76:77], v11 offset:0
    ds_read_b64_tr_b16 v[78:79], v11 offset:2048
    ds_read_b64_tr_b16 v[148:149], v11 offset:8
    ds_read_b64_tr_b16 v[150:151], v11 offset:2056
    ds_read_b64_tr_b16 a[12:13], v11 offset:256
    ds_read_b64_tr_b16 a[14:15], v11 offset:2304
    ds_read_b64_tr_b16 a[84:85], v11 offset:264
    ds_read_b64_tr_b16 a[86:87], v11 offset:2312
    s_waitcnt vmcnt(12) lgkmcnt(0)
    s_barrier
    s_add_u32 m0, s44, 122880
    s_add_u32 s22, s42, 2097152
    buffer_load_dwordx4 v8, s[12:15], s22 offen offset:0 lds
    s_add_u32 s22, s42, 2112512
    buffer_load_dwordx4 v9, s[12:15], s22 offen offset:1024 lds
    s_add_u32 s22, s42, 2127872
    buffer_load_dwordx4 v8, s[12:15], s22 offen offset:2048 lds
    s_add_u32 s22, s42, 2143232
    buffer_load_dwordx4 v9, s[12:15], s22 offen offset:3072 lds
    ds_read_b64_tr_b16 v[80:81], v11 offset:16384
    ds_read_b64_tr_b16 v[82:83], v11 offset:18432
    ds_read_b64_tr_b16 v[152:153], v11 offset:16392
    ds_read_b64_tr_b16 v[154:155], v11 offset:18440
    ds_read_b64_tr_b16 a[16:17], v11 offset:16640
    ds_read_b64_tr_b16 a[18:19], v11 offset:18688
    ds_read_b64_tr_b16 a[88:89], v11 offset:16648
    ds_read_b64_tr_b16 a[90:91], v11 offset:18696
    s_waitcnt vmcnt(12) lgkmcnt(0)
    s_barrier
    s_add_u32 m0, s44, 139264
    s_add_u32 s22, s42, 2359296
    buffer_load_dwordx4 v8, s[12:15], s22 offen offset:0 lds
    s_add_u32 s22, s42, 2374656
    buffer_load_dwordx4 v9, s[12:15], s22 offen offset:1024 lds
    s_add_u32 s22, s42, 2390016
    buffer_load_dwordx4 v8, s[12:15], s22 offen offset:2048 lds
    s_add_u32 s22, s42, 2405376
    buffer_load_dwordx4 v9, s[12:15], s22 offen offset:3072 lds
    ds_read_b64_tr_b16 v[84:85], v10 offset:0
    ds_read_b64_tr_b16 v[86:87], v10 offset:2048
    ds_read_b64_tr_b16 v[156:157], v10 offset:8
    ds_read_b64_tr_b16 v[158:159], v10 offset:2056
    ds_read_b64_tr_b16 a[20:21], v10 offset:256
    ds_read_b64_tr_b16 a[22:23], v10 offset:2304
    ds_read_b64_tr_b16 a[92:93], v10 offset:264
    ds_read_b64_tr_b16 a[94:95], v10 offset:2312
    s_waitcnt vmcnt(12) lgkmcnt(0)
    s_barrier
    s_add_u32 m0, s44, 73728
    s_add_u32 s22, s42, 2621440
    buffer_load_dwordx4 v8, s[12:15], s22 offen offset:0 lds
    s_add_u32 s22, s42, 2636800
    buffer_load_dwordx4 v9, s[12:15], s22 offen offset:1024 lds
    s_add_u32 s22, s42, 2652160
    buffer_load_dwordx4 v8, s[12:15], s22 offen offset:2048 lds
    s_add_u32 s22, s42, 2667520
    buffer_load_dwordx4 v9, s[12:15], s22 offen offset:3072 lds
    ds_read_b64_tr_b16 v[88:89], v10 offset:16384
    ds_read_b64_tr_b16 v[90:91], v10 offset:18432
    ds_read_b64_tr_b16 v[160:161], v10 offset:16392
    ds_read_b64_tr_b16 v[162:163], v10 offset:18440
    ds_read_b64_tr_b16 a[24:25], v10 offset:16640
    ds_read_b64_tr_b16 a[26:27], v10 offset:18688
    ds_read_b64_tr_b16 a[96:97], v10 offset:16648
    ds_read_b64_tr_b16 a[98:99], v10 offset:18696
    s_waitcnt vmcnt(12) lgkmcnt(0)
    s_barrier
    s_add_u32 m0, s44, 90112
    s_add_u32 s22, s42, 2883584
    buffer_load_dwordx4 v8, s[12:15], s22 offen offset:0 lds
    s_add_u32 s22, s42, 2898944
    buffer_load_dwordx4 v9, s[12:15], s22 offen offset:1024 lds
    s_add_u32 s22, s42, 2914304
    buffer_load_dwordx4 v8, s[12:15], s22 offen offset:2048 lds
    s_add_u32 s22, s42, 2929664
    buffer_load_dwordx4 v9, s[12:15], s22 offen offset:3072 lds
    ds_read_b64_tr_b16 v[92:93], v10 offset:32768
    ds_read_b64_tr_b16 v[94:95], v10 offset:34816
    ds_read_b64_tr_b16 v[164:165], v10 offset:32776
    ds_read_b64_tr_b16 v[166:167], v10 offset:34824
    ds_read_b64_tr_b16 a[28:29], v10 offset:33024
    ds_read_b64_tr_b16 a[30:31], v10 offset:35072
    ds_read_b64_tr_b16 a[100:101], v10 offset:33032
    ds_read_b64_tr_b16 a[102:103], v10 offset:35080
    s_waitcnt vmcnt(12) lgkmcnt(0)
    s_barrier
    s_add_u32 m0, s44, 106496
    s_add_u32 s22, s42, 3145728
    buffer_load_dwordx4 v8, s[12:15], s22 offen offset:0 lds
    s_add_u32 s22, s42, 3161088
    buffer_load_dwordx4 v9, s[12:15], s22 offen offset:1024 lds
    s_add_u32 s22, s42, 3176448
    buffer_load_dwordx4 v8, s[12:15], s22 offen offset:2048 lds
    s_add_u32 s22, s42, 3191808
    buffer_load_dwordx4 v9, s[12:15], s22 offen offset:3072 lds
    ds_read_b64_tr_b16 v[96:97], v11 offset:0
    ds_read_b64_tr_b16 v[98:99], v11 offset:2048
    ds_read_b64_tr_b16 v[168:169], v11 offset:8
    ds_read_b64_tr_b16 v[170:171], v11 offset:2056
    ds_read_b64_tr_b16 a[32:33], v11 offset:256
    ds_read_b64_tr_b16 a[34:35], v11 offset:2304
    ds_read_b64_tr_b16 a[104:105], v11 offset:264
    ds_read_b64_tr_b16 a[106:107], v11 offset:2312
    s_waitcnt vmcnt(12) lgkmcnt(0)
    s_barrier
    s_add_u32 m0, s44, 122880
    s_add_u32 s22, s42, 3407872
    buffer_load_dwordx4 v8, s[12:15], s22 offen offset:0 lds
    s_add_u32 s22, s42, 3423232
    buffer_load_dwordx4 v9, s[12:15], s22 offen offset:1024 lds
    s_add_u32 s22, s42, 3438592
    buffer_load_dwordx4 v8, s[12:15], s22 offen offset:2048 lds
    s_add_u32 s22, s42, 3453952
    buffer_load_dwordx4 v9, s[12:15], s22 offen offset:3072 lds
    ds_read_b64_tr_b16 v[100:101], v11 offset:16384
    ds_read_b64_tr_b16 v[102:103], v11 offset:18432
    ds_read_b64_tr_b16 v[172:173], v11 offset:16392
    ds_read_b64_tr_b16 v[174:175], v11 offset:18440
    ds_read_b64_tr_b16 a[36:37], v11 offset:16640
    ds_read_b64_tr_b16 a[38:39], v11 offset:18688
    ds_read_b64_tr_b16 a[108:109], v11 offset:16648
    ds_read_b64_tr_b16 a[110:111], v11 offset:18696
    s_waitcnt vmcnt(12) lgkmcnt(0)
    s_barrier
    s_add_u32 m0, s44, 139264
    s_add_u32 s22, s42, 3670016
    buffer_load_dwordx4 v8, s[12:15], s22 offen offset:0 lds
    s_add_u32 s22, s42, 3685376
    buffer_load_dwordx4 v9, s[12:15], s22 offen offset:1024 lds
    s_add_u32 s22, s42, 3700736
    buffer_load_dwordx4 v8, s[12:15], s22 offen offset:2048 lds
    s_add_u32 s22, s42, 3716096
    buffer_load_dwordx4 v9, s[12:15], s22 offen offset:3072 lds
    ds_read_b64_tr_b16 v[104:105], v10 offset:0
    ds_read_b64_tr_b16 v[106:107], v10 offset:2048
    ds_read_b64_tr_b16 v[176:177], v10 offset:8
    ds_read_b64_tr_b16 v[178:179], v10 offset:2056
    ds_read_b64_tr_b16 a[40:41], v10 offset:256
    ds_read_b64_tr_b16 a[42:43], v10 offset:2304
    ds_read_b64_tr_b16 a[112:113], v10 offset:264
    ds_read_b64_tr_b16 a[114:115], v10 offset:2312
    s_waitcnt vmcnt(12) lgkmcnt(0)
    s_barrier
    s_add_u32 m0, s44, 73728
    s_add_u32 s22, s42, 3932160
    buffer_load_dwordx4 v8, s[12:15], s22 offen offset:0 lds
    s_add_u32 s22, s42, 3947520
    buffer_load_dwordx4 v9, s[12:15], s22 offen offset:1024 lds
    s_add_u32 s22, s42, 3962880
    buffer_load_dwordx4 v8, s[12:15], s22 offen offset:2048 lds
    s_add_u32 s22, s42, 3978240
    buffer_load_dwordx4 v9, s[12:15], s22 offen offset:3072 lds
    ds_read_b64_tr_b16 v[108:109], v10 offset:16384
    ds_read_b64_tr_b16 v[110:111], v10 offset:18432
    ds_read_b64_tr_b16 v[180:181], v10 offset:16392
    ds_read_b64_tr_b16 v[182:183], v10 offset:18440
    ds_read_b64_tr_b16 a[44:45], v10 offset:16640
    ds_read_b64_tr_b16 a[46:47], v10 offset:18688
    ds_read_b64_tr_b16 a[116:117], v10 offset:16648
    ds_read_b64_tr_b16 a[118:119], v10 offset:18696
    s_waitcnt vmcnt(12) lgkmcnt(0)
    s_barrier
    s_add_u32 m0, s44, 90112
    s_add_u32 s22, s42, 4194304
    buffer_load_dwordx4 v8, s[12:15], s22 offen offset:0 lds
    s_add_u32 s22, s42, 4209664
    buffer_load_dwordx4 v9, s[12:15], s22 offen offset:1024 lds
    s_add_u32 s22, s42, 4225024
    buffer_load_dwordx4 v8, s[12:15], s22 offen offset:2048 lds
    s_add_u32 s22, s42, 4240384
    buffer_load_dwordx4 v9, s[12:15], s22 offen offset:3072 lds
    ds_read_b64_tr_b16 v[112:113], v10 offset:32768
    ds_read_b64_tr_b16 v[114:115], v10 offset:34816
    ds_read_b64_tr_b16 v[184:185], v10 offset:32776
    ds_read_b64_tr_b16 v[186:187], v10 offset:34824
    ds_read_b64_tr_b16 a[48:49], v10 offset:33024
    ds_read_b64_tr_b16 a[50:51], v10 offset:35072
    ds_read_b64_tr_b16 a[120:121], v10 offset:33032
    ds_read_b64_tr_b16 a[122:123], v10 offset:35080
    s_waitcnt vmcnt(12) lgkmcnt(0)
    s_barrier
    s_add_u32 m0, s44, 106496
    s_add_u32 s22, s42, 4456448
    buffer_load_dwordx4 v8, s[12:15], s22 offen offset:0 lds
    s_add_u32 s22, s42, 4471808
    buffer_load_dwordx4 v9, s[12:15], s22 offen offset:1024 lds
    s_add_u32 s22, s42, 4487168
    buffer_load_dwordx4 v8, s[12:15], s22 offen offset:2048 lds
    s_add_u32 s22, s42, 4502528
    buffer_load_dwordx4 v9, s[12:15], s22 offen offset:3072 lds
    ds_read_b64_tr_b16 v[116:117], v11 offset:0
    ds_read_b64_tr_b16 v[118:119], v11 offset:2048
    ds_read_b64_tr_b16 v[188:189], v11 offset:8
    ds_read_b64_tr_b16 v[190:191], v11 offset:2056
    ds_read_b64_tr_b16 a[52:53], v11 offset:256
    ds_read_b64_tr_b16 a[54:55], v11 offset:2304
    ds_read_b64_tr_b16 a[124:125], v11 offset:264
    ds_read_b64_tr_b16 a[126:127], v11 offset:2312
    s_waitcnt vmcnt(12) lgkmcnt(0)
    s_barrier
    s_mov_b32 s27, 36864
    s_add_u32 s23, s27, s25
    s_add_u32 m0, s23, 0
    s_nop 0
    buffer_load_dwordx4 v2, s[8:11], s24 offen offset:0 lds
    s_add_u32 m0, s23, 960
    s_nop 0
    buffer_load_dwordx4 v2, s[8:11], s24 offen offset:64 lds
    s_add_u32 m0, s23, 1920
    s_nop 0
    buffer_load_dwordx4 v2, s[8:11], s24 offen offset:128 lds
    s_add_u32 m0, s23, 2880
    s_nop 0
    buffer_load_dwordx4 v2, s[8:11], s24 offen offset:192 lds
    s_add_u32 m0, s23, 3840
    s_nop 0
    buffer_load_dwordx4 v2, s[8:11], s24 offen offset:256 lds
    s_add_u32 m0, s23, 4800
    s_nop 0
    buffer_load_dwordx4 v2, s[8:11], s24 offen offset:320 lds
    s_add_u32 m0, s23, 5760
    s_nop 0
    buffer_load_dwordx4 v2, s[8:11], s24 offen offset:384 lds
    s_add_u32 m0, s23, 6720
    s_nop 0
    buffer_load_dwordx4 v2, s[8:11], s24 offen offset:448 lds
    s_add_u32 m0, s23, 7680
    s_nop 0
    buffer_load_dwordx4 v2, s[8:11], s24 offen offset:512 lds
    s_add_u32 s24, s24, 147456
    ds_read_b64_tr_b16 v[120:121], v11 offset:16384
    ds_read_b64_tr_b16 v[122:123], v11 offset:18432
    ds_read_b64_tr_b16 v[192:193], v11 offset:16392
    ds_read_b64_tr_b16 v[194:195], v11 offset:18440
    ds_read_b64_tr_b16 a[56:57], v11 offset:16640
    ds_read_b64_tr_b16 a[58:59], v11 offset:18688
    ds_read_b64_tr_b16 a[128:129], v11 offset:16648
    ds_read_b64_tr_b16 a[130:131], v11 offset:18696
    s_waitcnt vmcnt(17) lgkmcnt(0)
    s_barrier
    ds_read_b64_tr_b16 v[124:125], v10 offset:0
    ds_read_b64_tr_b16 v[126:127], v10 offset:2048
    ds_read_b64_tr_b16 v[196:197], v10 offset:8
    ds_read_b64_tr_b16 v[198:199], v10 offset:2056
    ds_read_b64_tr_b16 a[60:61], v10 offset:256
    ds_read_b64_tr_b16 a[62:63], v10 offset:2304
    ds_read_b64_tr_b16 a[132:133], v10 offset:264
    ds_read_b64_tr_b16 a[134:135], v10 offset:2312
    s_waitcnt vmcnt(13) lgkmcnt(0)
    s_barrier
    ds_read_b64_tr_b16 v[128:129], v10 offset:16384
    ds_read_b64_tr_b16 v[130:131], v10 offset:18432
    ds_read_b64_tr_b16 v[200:201], v10 offset:16392
    ds_read_b64_tr_b16 v[202:203], v10 offset:18440
    ds_read_b64_tr_b16 a[64:65], v10 offset:16640
    ds_read_b64_tr_b16 a[66:67], v10 offset:18688
    ds_read_b64_tr_b16 a[136:137], v10 offset:16648
    ds_read_b64_tr_b16 a[138:139], v10 offset:18696
    s_waitcnt vmcnt(9) lgkmcnt(0)
    s_barrier
    ds_read_b64_tr_b16 v[132:133], v10 offset:32768
    ds_read_b64_tr_b16 v[134:135], v10 offset:34816
    ds_read_b64_tr_b16 v[204:205], v10 offset:32776
    ds_read_b64_tr_b16 v[206:207], v10 offset:34824
    ds_read_b64_tr_b16 a[68:69], v10 offset:33024
    ds_read_b64_tr_b16 a[70:71], v10 offset:35072
    ds_read_b64_tr_b16 a[140:141], v10 offset:33032
    ds_read_b64_tr_b16 a[142:143], v10 offset:35080
    s_mov_b32 s88, 4194304
gn8:
    buffer_load_dword v250, off, s[84:87], 0 offset:216 sc1
    s_waitcnt vmcnt(0)
    v_readfirstlane_b32 s95, v250
    s_sub_u32 s88, s88, 1
    s_cbranch_scc1 gn8x
    s_cmp_eq_u32 s95, 0
    s_cbranch_scc1 gn8
gn8x:
    s_waitcnt lgkmcnt(0)
    s_mov_b32 s45, 0
    s_mov_b32 s27, 0
    s_cmp_eq_u32 s18, 0
    s_cselect_b32 s34, 1, 0
    s_mov_b32 s35, 0
    s_cmp_eq_u32 s16, 2
    s_cbranch_scc1 qk_vloop
qk_loop:
    s_barrier
    v_add_u32 v3, s27, v1
    ds_read_b128 v[32:35], v3 offset:0
    ds_read_b128 v[36:39], v3 offset:18432
    ds_read_b128 v[40:43], v3 offset:1024
    ds_read_b128 v[44:47], v3 offset:19456
    ds_read_b128 v[48:51], v3 offset:2048
    ds_read_b128 v[52:55], v3 offset:20480
    s_add_u32 s23, s45, s95
    v_mov_b32 v4, s23
    s_mov_b64 exec, s[34:35]
    buffer_store_dword v4, off, s[4:7], s29 sc1
    buffer_store_dword v4, off, s[4:7], s29 offset:128 sc1
    s_mov_b64 exec, -1
    s_add_u32 s22, s27, 73728
    s_sub_u32 s21, s22, 110592
    s_cselect_b32 s22, s22, s21
    ds_read_b128 v[56:59], v3 offset:3072
    ds_read_b128 v[60:63], v3 offset:21504
    s_add_u32 s23, s22, s25
    s_add_u32 m0, s23, 0
    s_nop 0
    buffer_load_dwordx4 v2, s[8:11], s24 offen offset:0 lds
    s_waitcnt lgkmcnt(6)
    v_mfma_f32_16x16x32_bf16 v[208:211], v[64:67], v[32:35], 0
    v_mfma_f32_16x16x32_bf16 v[212:215], v[136:139], v[32:35], 0
    v_mfma_f32_16x16x32_bf16 v[216:219], v[64:67], v[36:39], 0
    v_mfma_f32_16x16x32_bf16 v[220:223], v[136:139], v[36:39], 0
    v_mfma_f32_16x16x32_bf16 v[224:227], a[0:3], v[32:35], 0
    v_mfma_f32_16x16x32_bf16 v[228:231], a[72:75], v[32:35], 0
    v_mfma_f32_16x16x32_bf16 v[232:235], a[0:3], v[36:39], 0
    v_mfma_f32_16x16x32_bf16 v[236:239], a[72:75], v[36:39], 0
    ds_read_b128 v[32:35], v3 offset:4096
    ds_read_b128 v[36:39], v3 offset:22528
    s_add_u32 m0, s23, 960
    s_nop 0
    buffer_load_dwordx4 v2, s[8:11], s24 offen offset:64 lds
    s_waitcnt lgkmcnt(6)
    v_mfma_f32_16x16x32_bf16 v[208:211], v[68:71], v[40:43], v[208:211]
    v_mfma_f32_16x16x32_bf16 v[212:215], v[140:143], v[40:43], v[212:215]
    v_mfma_f32_16x16x32_bf16 v[216:219], v[68:71], v[44:47], v[216:219]
    v_mfma_f32_16x16x32_bf16 v[220:223], v[140:143], v[44:47], v[220:223]
    v_mfma_f32_16x16x32_bf16 v[224:227], a[4:7], v[40:43], v[224:227]
    v_mfma_f32_16x16x32_bf16 v[228:231], a[76:79], v[40:43], v[228:231]
    v_mfma_f32_16x16x32_bf16 v[232:235], a[4:7], v[44:47], v[232:235]
    v_mfma_f32_16x16x32_bf16 v[236:239], a[76:79], v[44:47], v[236:239]
    ds_read_b128 v[40:43], v3 offset:5120
    ds_read_b128 v[44:47], v3 offset:23552
    s_add_u32 m0, s23, 1920
    s_nop 0
    buffer_load_dwordx4 v2, s[8:11], s24 offen offset:128 lds
    s_waitcnt lgkmcnt(6)
    v_mfma_f32_16x16x32_bf16 v[208:211], v[72:75], v[48:51], v[208:211]
    v_mfma_f32_16x16x32_bf16 v[212:215], v[144:147], v[48:51], v[212:215]
    v_mfma_f32_16x16x32_bf16 v[216:219], v[72:75], v[52:55], v[216:219]
    v_mfma_f32_16x16x32_bf16 v[220:223], v[144:147], v[52:55], v[220:223]
    v_mfma_f32_16x16x32_bf16 v[224:227], a[8:11], v[48:51], v[224:227]
    v_mfma_f32_16x16x32_bf16 v[228:231], a[80:83], v[48:51], v[228:231]
    v_mfma_f32_16x16x32_bf16 v[232:235], a[8:11], v[52:55], v[232:235]
    v_mfma_f32_16x16x32_bf16 v[236:239], a[80:83], v[52:55], v[236:239]
    ds_read_b128 v[48:51], v3 offset:6144
    ds_read_b128 v[52:55], v3 offset:24576
    s_add_u32 m0, s23, 2880
    s_nop 0
    buffer_load_dwordx4 v2, s[8:11], s24 offen offset:192 lds
    s_waitcnt lgkmcnt(6)
    v_mfma_f32_16x16x32_bf16 v[208:211], v[76:79], v[56:59], v[208:211]
    v_mfma_f32_16x16x32_bf16 v[212:215], v[148:151], v[56:59], v[212:215]
    v_mfma_f32_16x16x32_bf16 v[216:219], v[76:79], v[60:63], v[216:219]
    v_mfma_f32_16x16x32_bf16 v[220:223], v[148:151], v[60:63], v[220:223]
    v_mfma_f32_16x16x32_bf16 v[224:227], a[12:15], v[56:59], v[224:227]
    v_mfma_f32_16x16x32_bf16 v[228:231], a[84:87], v[56:59], v[228:231]
    v_mfma_f32_16x16x32_bf16 v[232:235], a[12:15], v[60:63], v[232:235]
    v_mfma_f32_16x16x32_bf16 v[236:239], a[84:87], v[60:63], v[236:239]
    ds_read_b128 v[56:59], v3 offset:7168
    ds_read_b128 v[60:63], v3 offset:25600
    s_add_u32 m0, s23, 3840
    s_nop 0
    buffer_load_dwordx4 v2, s[8:11], s24 offen offset:256 lds
    s_waitcnt lgkmcnt(6)
    v_mfma_f32_16x16x32_bf16 v[208:211], v[80:83], v[32:35], v[208:211]
    v_mfma_f32_16x16x32_bf16 v[212:215], v[152:155], v[32:35], v[212:215]
    v_mfma_f32_16x16x32_bf16 v[216:219], v[80:83], v[36:39], v[216:219]
    v_mfma_f32_16x16x32_bf16 v[220:223], v[152:155], v[36:39], v[220:223]
    v_mfma_f32_16x16x32_bf16 v[224:227], a[16:19], v[32:35], v[224:227]
    v_mfma_f32_16x16x32_bf16 v[228:231], a[88:91], v[32:35], v[228:231]
    v_mfma_f32_16x16x32_bf16 v[232:235], a[16:19], v[36:39], v[232:235]
    v_mfma_f32_16x16x32_bf16 v[236:239], a[88:91], v[36:39], v[236:239]
    ds_read_b128 v[32:35], v3 offset:8192
    ds_read_b128 v[36:39], v3 offset:26624
    s_add_u32 m0, s23, 4800
    s_nop 0
    buffer_load_dwordx4 v2, s[8:11], s24 offen offset:320 lds
    s_waitcnt lgkmcnt(6)
    v_mfma_f32_16x16x32_bf16 v[208:211], v[84:87], v[40:43], v[208:211]
    v_mfma_f32_16x16x32_bf16 v[212:215], v[156:159], v[40:43], v[212:215]
    v_mfma_f32_16x16x32_bf16 v[216:219], v[84:87], v[44:47], v[216:219]
    v_mfma_f32_16x16x32_bf16 v[220:223], v[156:159], v[44:47], v[220:223]
    v_mfma_f32_16x16x32_bf16 v[224:227], a[20:23], v[40:43], v[224:227]
    v_mfma_f32_16x16x32_bf16 v[228:231], a[92:95], v[40:43], v[228:231]
    v_mfma_f32_16x16x32_bf16 v[232:235], a[20:23], v[44:47], v[232:235]
    v_mfma_f32_16x16x32_bf16 v[236:239], a[92:95], v[44:47], v[236:239]
    ds_read_b128 v[40:43], v3 offset:9216
    ds_read_b128 v[44:47], v3 offset:27648
    s_add_u32 m0, s23, 5760
    s_nop 0
    buffer_load_dwordx4 v2, s[8:11], s24 offen offset:384 lds
    s_waitcnt lgkmcnt(6)
    v_mfma_f32_16x16x32_bf16 v[208:211], v[88:91], v[48:51], v[208:211]
    v_mfma_f32_16x16x32_bf16 v[212:215], v[160:163], v[48:51], v[212:215]
    v_mfma_f32_16x16x32_bf16 v[216:219], v[88:91], v[52:55], v[216:219]
    v_mfma_f32_16x16x32_bf16 v[220:223], v[160:163], v[52:55], v[220:223]
    v_mfma_f32_16x16x32_bf16 v[224:227], a[24:27], v[48:51], v[224:227]
    v_mfma_f32_16x16x32_bf16 v[228:231], a[96:99], v[48:51], v[228:231]
    v_mfma_f32_16x16x32_bf16 v[232:235], a[24:27], v[52:55], v[232:235]
    v_mfma_f32_16x16x32_bf16 v[236:239], a[96:99], v[52:55], v[236:239]
    ds_read_b128 v[48:51], v3 offset:10240
    ds_read_b128 v[52:55], v3 offset:28672
    s_add_u32 m0, s23, 6720
    s_nop 0
    buffer_load_dwordx4 v2, s[8:11], s24 offen offset:448 lds
    s_waitcnt lgkmcnt(6)
    v_mfma_f32_16x16x32_bf16 v[208:211], v[92:95], v[56:59], v[208:211]
    v_mfma_f32_16x16x32_bf16 v[212:215], v[164:167], v[56:59], v[212:215]
    v_mfma_f32_16x16x32_bf16 v[216:219], v[92:95], v[60:63], v[216:219]
    v_mfma_f32_16x16x32_bf16 v[220:223], v[164:167], v[60:63], v[220:223]
    v_mfma_f32_16x16x32_bf16 v[224:227], a[28:31], v[56:59], v[224:227]
    v_mfma_f32_16x16x32_bf16 v[228:231], a[100:103], v[56:59], v[228:231]
    v_mfma_f32_16x16x32_bf16 v[232:235], a[28:31], v[60:63], v[232:235]
    v_mfma_f32_16x16x32_bf16 v[236:239], a[100:103], v[60:63], v[236:239]
    ds_read_b128 v[56:59], v3 offset:11264
    ds_read_b128 v[60:63], v3 offset:29696
    s_add_u32 m0, s23, 7680
    s_nop 0
    buffer_load_dwordx4 v2, s[8:11], s24 offen offset:512 lds
    s_add_u32 s24, s24, 147456
    s_waitcnt lgkmcnt(6)
    v_mfma_f32_16x16x32_bf16 v[208:211], v[96:99], v[32:35], v[208:211]
    v_mfma_f32_16x16x32_bf16 v[212:215], v[168:171], v[32:35], v[212:215]
    v_mfma_f32_16x16x32_bf16 v[216:219], v[96:99], v[36:39], v[216:219]
    v_mfma_f32_16x16x32_bf16 v[220:223], v[168:171], v[36:39], v[220:223]
    v_mfma_f32_16x16x32_bf16 v[224:227], a[32:35], v[32:35], v[224:227]
    v_mfma_f32_16x16x32_bf16 v[228:231], a[104:107], v[32:35], v[228:231]
    v_mfma_f32_16x16x32_bf16 v[232:235], a[32:35], v[36:39], v[232:235]
    v_mfma_f32_16x16x32_bf16 v[236:239], a[104:107], v[36:39], v[236:239]
    ds_read_b128 v[32:35], v3 offset:12288
    ds_read_b128 v[36:39], v3 offset:30720
    s_waitcnt lgkmcnt(6)
    v_mfma_f32_16x16x32_bf16 v[208:211], v[100:103], v[40:43], v[208:211]
    v_mfma_f32_16x16x32_bf16 v[212:215], v[172:175], v[40:43], v[212:215]
    v_mfma_f32_16x16x32_bf16 v[216:219], v[100:103], v[44:47], v[216:219]
    v_mfma_f32_16x16x32_bf16 v[220:223], v[172:175], v[44:47], v[220:223]
    v_mfma_f32_16x16x32_bf16 v[224:227], a[36:39], v[40:43], v[224:227]
    v_mfma_f32_16x16x32_bf16 v[228:231], a[108:111], v[40:43], v[228:231]
    v_mfma_f32_16x16x32_bf16 v[232:235], a[36:39], v[44:47], v[232:235]
    v_mfma_f32_16x16x32_bf16 v[236:239], a[108:111], v[44:47], v[236:239]
    ds_read_b128 v[40:43], v3 offset:13312
    ds_read_b128 v[44:47], v3 offset:31744
    s_waitcnt lgkmcnt(6)
    v_mfma_f32_16x16x32_bf16 v[208:211], v[104:107], v[48:51], v[208:211]
    v_mfma_f32_16x16x32_bf16 v[212:215], v[176:179], v[48:51], v[212:215]
    v_mfma_f32_16x16x32_bf16 v[216:219], v[104:107], v[52:55], v[216:219]
    v_mfma_f32_16x16x32_bf16 v[220:223], v[176:179], v[52:55], v[220:223]
    v_mfma_f32_16x16x32_bf16 v[224:227], a[40:43], v[48:51], v[224:227]
    v_mfma_f32_16x16x32_bf16 v[228:231], a[112:115], v[48:51], v[228:231]
    v_mfma_f32_16x16x32_bf16 v[232:235], a[40:43], v[52:55], v[232:235]
    v_mfma_f32_16x16x32_bf16 v[236:239], a[112:115], v[52:55], v[236:239]
    ds_read_b128 v[48:51], v3 offset:14336
    ds_read_b128 v[52:55], v3 offset:32768
    s_waitcnt lgkmcnt(6)
    v_mfma_f32_16x16x32_bf16 v[208:211], v[108:111], v[56:59], v[208:211]
    v_mfma_f32_16x16x32_bf16 v[212:215], v[180:183], v[56:59], v[212:215]
    v_mfma_f32_16x16x32_bf16 v[216:219], v[108:111], v[60:63], v[216:219]
    v_mfma_f32_16x16x32_bf16 v[220:223], v[180:183], v[60:63], v[220:223]
    v_mfma_f32_16x16x32_bf16 v[224:227], a[44:47], v[56:59], v[224:227]
    v_mfma_f32_16x16x32_bf16 v[228:231], a[116:119], v[56:59], v[228:231]
    v_mfma_f32_16x16x32_bf16 v[232:235], a[44:47], v[60:63], v[232:235]
    v_mfma_f32_16x16x32_bf16 v[236:239], a[116:119], v[60:63], v[236:239]
    ds_read_b128 v[56:59], v3 offset:15360
    ds_read_b128 v[60:63], v3 offset:33792
    s_waitcnt lgkmcnt(6)
    v_mfma_f32_16x16x32_bf16 v[208:211], v[112:115], v[32:35], v[208:211]
    v_mfma_f32_16x16x32_bf16 v[212:215], v[184:187], v[32:35], v[212:215]
    v_mfma_f32_16x16x32_bf16 v[216:219], v[112:115], v[36:39], v[216:219]
    v_mfma_f32_16x16x32_bf16 v[220:223], v[184:187], v[36:39], v[220:223]
    v_mfma_f32_16x16x32_bf16 v[224:227], a[48:51], v[32:35], v[224:227]
    v_mfma_f32_16x16x32_bf16 v[228:231], a[120:123], v[32:35], v[228:231]
    v_mfma_f32_16x16x32_bf16 v[232:235], a[48:51], v[36:39], v[232:235]
    v_mfma_f32_16x16x32_bf16 v[236:239], a[120:123], v[36:39], v[236:239]
    ds_read_b128 v[32:35], v3 offset:16384
    ds_read_b128 v[36:39], v3 offset:34816
    s_waitcnt lgkmcnt(6)
    v_mfma_f32_16x16x32_bf16 v[208:211], v[116:119], v[40:43], v[208:211]
    v_mfma_f32_16x16x32_bf16 v[212:215], v[188:191], v[40:43], v[212:215]
    v_mfma_f32_16x16x32_bf16 v[216:219], v[116:119], v[44:47], v[216:219]
    v_mfma_f32_16x16x32_bf16 v[220:223], v[188:191], v[44:47], v[220:223]
    v_mfma_f32_16x16x32_bf16 v[224:227], a[52:55], v[40:43], v[224:227]
    v_mfma_f32_16x16x32_bf16 v[228:231], a[124:127], v[40:43], v[228:231]
    v_mfma_f32_16x16x32_bf16 v[232:235], a[52:55], v[44:47], v[232:235]
    v_mfma_f32_16x16x32_bf16 v[236:239], a[124:127], v[44:47], v[236:239]
    ds_read_b128 v[40:43], v3 offset:17408
    ds_read_b128 v[44:47], v3 offset:35840
    s_waitcnt lgkmcnt(6)
    v_mfma_f32_16x16x32_bf16 v[208:211], v[120:123], v[48:51], v[208:211]
    v_mfma_f32_16x16x32_bf16 v[212:215], v[192:195], v[48:51], v[212:215]
    v_mfma_f32_16x16x32_bf16 v[216:219], v[120:123], v[52:55], v[216:219]
    v_mfma_f32_16x16x32_bf16 v[220:223], v[192:195], v[52:55], v[220:223]
    v_mfma_f32_16x16x32_bf16 v[224:227], a[56:59], v[48:51], v[224:227]
    v_mfma_f32_16x16x32_bf16 v[228:231], a[128:131], v[48:51], v[228:231]
    v_mfma_f32_16x16x32_bf16 v[232:235], a[56:59], v[52:55], v[232:235]
    v_mfma_f32_16x16x32_bf16 v[236:239], a[128:131], v[52:55], v[236:239]
    s_waitcnt lgkmcnt(4)
    v_mfma_f32_16x16x32_bf16 v[208:211], v[124:127], v[56:59], v[208:211]
    v_mfma_f32_16x16x32_bf16 v[212:215], v[196:199], v[56:59], v[212:215]
    v_mfma_f32_16x16x32_bf16 v[216:219], v[124:127], v[60:63], v[216:219]
    v_mfma_f32_16x16x32_bf16 v[220:223], v[196:199], v[60:63], v[220:223]
    v_mfma_f32_16x16x32_bf16 v[224:227], a[60:63], v[56:59], v[224:227]
    v_mfma_f32_16x16x32_bf16 v[228:231], a[132:135], v[56:59], v[228:231]
    v_mfma_f32_16x16x32_bf16 v[232:235], a[60:63], v[60:63], v[232:235]
    v_mfma_f32_16x16x32_bf16 v[236:239], a[132:135], v[60:63], v[236:239]
    s_waitcnt lgkmcnt(2)
    v_mfma_f32_16x16x32_bf16 v[208:211], v[128:131], v[32:35], v[208:211]
    v_mfma_f32_16x16x32_bf16 v[212:215], v[200:203], v[32:35], v[212:215]
    v_mfma_f32_16x16x32_bf16 v[216:219], v[128:131], v[36:39], v[216:219]
    v_mfma_f32_16x16x32_bf16 v[220:223], v[200:203], v[36:39], v[220:223]
    v_mfma_f32_16x16x32_bf16 v[224:227], a[64:67], v[32:35], v[224:227]
    v_mfma_f32_16x16x32_bf16 v[228:231], a[136:139], v[32:35], v[228:231]
    v_mfma_f32_16x16x32_bf16 v[232:235], a[64:67], v[36:39], v[232:235]
    v_mfma_f32_16x16x32_bf16 v[236:239], a[136:139], v[36:39], v[236:239]
    s_waitcnt lgkmcnt(0)
    v_mfma_f32_16x16x32_bf16 v[208:211], v[132:135], v[40:43], v[208:211]
    v_mfma_f32_16x16x32_bf16 v[212:215], v[204:207], v[40:43], v[212:215]
    v_mfma_f32_16x16x32_bf16 v[216:219], v[132:135], v[44:47], v[216:219]
    v_mfma_f32_16x16x32_bf16 v[220:223], v[204:207], v[44:47], v[220:223]
    v_mfma_f32_16x16x32_bf16 v[224:227], a[68:71], v[40:43], v[224:227]
    v_mfma_f32_16x16x32_bf16 v[228:231], a[140:143], v[40:43], v[228:231]
    v_mfma_f32_16x16x32_bf16 v[232:235], a[68:71], v[44:47], v[232:235]
    v_mfma_f32_16x16x32_bf16 v[236:239], a[140:143], v[44:47], v[236:239]
    s_waitcnt vmcnt(0)
    v_cvt_pk_bf16_f32 v8, v208, v209
    v_cvt_pk_bf16_f32 v9, v210, v211
    v_cvt_pk_bf16_f32 v10, v212, v213
    v_cvt_pk_bf16_f32 v11, v214, v215
    s_lshr_b32 s22, s41, 5
    s_mul_i32 s22, s22, 0
    s_add_u32 s28, s26, s22
    buffer_store_dwordx4 v[8:11], v7, s[4:7], s28 offen sc1
    v_cvt_pk_bf16_f32 v12, v216, v217
    v_cvt_pk_bf16_f32 v13, v218, v219
    v_cvt_pk_bf16_f32 v14, v220, v221
    v_cvt_pk_bf16_f32 v15, v222, v223
    s_lshr_b32 s22, s41, 5
    s_mul_i32 s22, s22, 0
    s_add_u32 s28, s26, s22
    s_add_u32 s28, s28, s40
    buffer_store_dwordx4 v[12:15], v7, s[4:7], s28 offen sc1
    v_cvt_pk_bf16_f32 v16, v224, v225
    v_cvt_pk_bf16_f32 v17, v226, v227
    v_cvt_pk_bf16_f32 v18, v228, v229
    v_cvt_pk_bf16_f32 v19, v230, v231
    s_lshr_b32 s22, s41, 5
    s_mul_i32 s22, s22, 1
    s_add_u32 s28, s26, s22
    buffer_store_dwordx4 v[16:19], v7, s[4:7], s28 offen sc1
    v_cvt_pk_bf16_f32 v20, v232, v233
    v_cvt_pk_bf16_f32 v21, v234, v235
    v_cvt_pk_bf16_f32 v22, v236, v237
    v_cvt_pk_bf16_f32 v23, v238, v239
    s_lshr_b32 s22, s41, 5
    s_mul_i32 s22, s22, 1
    s_add_u32 s28, s26, s22
    s_add_u32 s28, s28, s40
    buffer_store_dwordx4 v[20:23], v7, s[4:7], s28 offen sc1
    s_lshl_b32 s22, s41, 2
    s_add_u32 s26, s26, s22
    s_lshr_b32 s45, s19, 2
    s_cbranch_scc1 qk_loop_nf
    s_waitcnt vmcnt(0)
    s_mov_b32 s45, 1
qk_loop_nf:
    s_add_u32 s27, s27, 36864
    s_cmp_eq_u32 s27, 110592
    s_cselect_b32 s27, 0, s27
    s_add_u32 s19, s19, 4
    s_cmp_lt_u32 s19, s20
    s_cbranch_scc1 qk_loop
    s_branch qk_done
qk_vloop:
    s_barrier
    v_add_u32 v3, s27, v1
    ds_read_b128 v[32:35], v3 offset:0
    ds_read_b128 v[36:39], v3 offset:18432
    ds_read_b128 v[40:43], v3 offset:1024
    ds_read_b128 v[44:47], v3 offset:19456
    ds_read_b128 v[48:51], v3 offset:2048
    ds_read_b128 v[52:55], v3 offset:20480
    s_add_u32 s23, s45, s95
    v_mov_b32 v4, s23
    s_mov_b64 exec, s[34:35]
    buffer_store_dword v4, off, s[4:7], s29 sc1
    buffer_store_dword v4, off, s[4:7], s29 offset:128 sc1
    s_mov_b64 exec, -1
    s_add_u32 s22, s27, 73728
    s_sub_u32 s21, s22, 110592
    s_cselect_b32 s22, s22, s21
    ds_read_b128 v[56:59], v3 offset:3072
    ds_read_b128 v[60:63], v3 offset:21504
    s_add_u32 s23, s22, s25
    s_add_u32 m0, s23, 0
    s_nop 0
    buffer_load_dwordx4 v2, s[8:11], s24 offen offset:0 lds
    s_waitcnt lgkmcnt(6)
    v_mfma_f32_16x16x32_bf16 v[208:211], v[32:35], v[64:67], 0
    v_mfma_f32_16x16x32_bf16 v[212:215], v[32:35], v[136:139], 0
    v_mfma_f32_16x16x32_bf16 v[216:219], v[36:39], v[64:67], 0
    v_mfma_f32_16x16x32_bf16 v[220:223], v[36:39], v[136:139], 0
    v_mfma_f32_16x16x32_bf16 v[224:227], v[32:35], a[0:3], 0
    v_mfma_f32_16x16x32_bf16 v[228:231], v[32:35], a[72:75], 0
    v_mfma_f32_16x16x32_bf16 v[232:235], v[36:39], a[0:3], 0
    v_mfma_f32_16x16x32_bf16 v[236:239], v[36:39], a[72:75], 0
    ds_read_b128 v[32:35], v3 offset:4096
    ds_read_b128 v[36:39], v3 offset:22528
    s_add_u32 m0, s23, 960
    s_nop 0
    buffer_load_dwordx4 v2, s[8:11], s24 offen offset:64 lds
    s_waitcnt lgkmcnt(6)
    v_mfma_f32_16x16x32_bf16 v[208:211], v[40:43], v[68:71], v[208:211]
    v_mfma_f32_16x16x32_bf16 v[212:215], v[40:43], v[140:143], v[212:215]
    v_mfma_f32_16x16x32_bf16 v[216:219], v[44:47], v[68:71], v[216:219]
    v_mfma_f32_16x16x32_bf16 v[220:223], v[44:47], v[140:143], v[220:223]
    v_mfma_f32_16x16x32_bf16 v[224:227], v[40:43], a[4:7], v[224:227]
    v_mfma_f32_16x16x32_bf16 v[228:231], v[40:43], a[76:79], v[228:231]
    v_mfma_f32_16x16x32_bf16 v[232:235], v[44:47], a[4:7], v[232:235]
    v_mfma_f32_16x16x32_bf16 v[236:239], v[44:47], a[76:79], v[236:239]
    ds_read_b128 v[40:43], v3 offset:5120
    ds_read_b128 v[44:47], v3 offset:23552
    s_add_u32 m0, s23, 1920
    s_nop 0
    buffer_load_dwordx4 v2, s[8:11], s24 offen offset:128 lds
    s_waitcnt lgkmcnt(6)
    v_mfma_f32_16x16x32_bf16 v[208:211], v[48:51], v[72:75], v[208:211]
    v_mfma_f32_16x16x32_bf16 v[212:215], v[48:51], v[144:147], v[212:215]
    v_mfma_f32_16x16x32_bf16 v[216:219], v[52:55], v[72:75], v[216:219]
    v_mfma_f32_16x16x32_bf16 v[220:223], v[52:55], v[144:147], v[220:223]
    v_mfma_f32_16x16x32_bf16 v[224:227], v[48:51], a[8:11], v[224:227]
    v_mfma_f32_16x16x32_bf16 v[228:231], v[48:51], a[80:83], v[228:231]
    v_mfma_f32_16x16x32_bf16 v[232:235], v[52:55], a[8:11], v[232:235]
    v_mfma_f32_16x16x32_bf16 v[236:239], v[52:55], a[80:83], v[236:239]
    ds_read_b128 v[48:51], v3 offset:6144
    ds_read_b128 v[52:55], v3 offset:24576
    s_add_u32 m0, s23, 2880
    s_nop 0
    buffer_load_dwordx4 v2, s[8:11], s24 offen offset:192 lds
    s_waitcnt lgkmcnt(6)
    v_mfma_f32_16x16x32_bf16 v[208:211], v[56:59], v[76:79], v[208:211]
    v_mfma_f32_16x16x32_bf16 v[212:215], v[56:59], v[148:151], v[212:215]
    v_mfma_f32_16x16x32_bf16 v[216:219], v[60:63], v[76:79], v[216:219]
    v_mfma_f32_16x16x32_bf16 v[220:223], v[60:63], v[148:151], v[220:223]
    v_mfma_f32_16x16x32_bf16 v[224:227], v[56:59], a[12:15], v[224:227]
    v_mfma_f32_16x16x32_bf16 v[228:231], v[56:59], a[84:87], v[228:231]
    v_mfma_f32_16x16x32_bf16 v[232:235], v[60:63], a[12:15], v[232:235]
    v_mfma_f32_16x16x32_bf16 v[236:239], v[60:63], a[84:87], v[236:239]
    ds_read_b128 v[56:59], v3 offset:7168
    ds_read_b128 v[60:63], v3 offset:25600
    s_add_u32 m0, s23, 3840
    s_nop 0
    buffer_load_dwordx4 v2, s[8:11], s24 offen offset:256 lds
    s_waitcnt lgkmcnt(6)
    v_mfma_f32_16x16x32_bf16 v[208:211], v[32:35], v[80:83], v[208:211]
    v_mfma_f32_16x16x32_bf16 v[212:215], v[32:35], v[152:155], v[212:215]
    v_mfma_f32_16x16x32_bf16 v[216:219], v[36:39], v[80:83], v[216:219]
    v_mfma_f32_16x16x32_bf16 v[220:223], v[36:39], v[152:155], v[220:223]
    v_mfma_f32_16x16x32_bf16 v[224:227], v[32:35], a[16:19], v[224:227]
    v_mfma_f32_16x16x32_bf16 v[228:231], v[32:35], a[88:91], v[228:231]
    v_mfma_f32_16x16x32_bf16 v[232:235], v[36:39], a[16:19], v[232:235]
    v_mfma_f32_16x16x32_bf16 v[236:239], v[36:39], a[88:91], v[236:239]
    ds_read_b128 v[32:35], v3 offset:8192
    ds_read_b128 v[36:39], v3 offset:26624
    s_add_u32 m0, s23, 4800
    s_nop 0
    buffer_load_dwordx4 v2, s[8:11], s24 offen offset:320 lds
    s_waitcnt lgkmcnt(6)
    v_mfma_f32_16x16x32_bf16 v[208:211], v[40:43], v[84:87], v[208:211]
    v_mfma_f32_16x16x32_bf16 v[212:215], v[40:43], v[156:159], v[212:215]
    v_mfma_f32_16x16x32_bf16 v[216:219], v[44:47], v[84:87], v[216:219]
    v_mfma_f32_16x16x32_bf16 v[220:223], v[44:47], v[156:159], v[220:223]
    v_mfma_f32_16x16x32_bf16 v[224:227], v[40:43], a[20:23], v[224:227]
    v_mfma_f32_16x16x32_bf16 v[228:231], v[40:43], a[92:95], v[228:231]
    v_mfma_f32_16x16x32_bf16 v[232:235], v[44:47], a[20:23], v[232:235]
    v_mfma_f32_16x16x32_bf16 v[236:239], v[44:47], a[92:95], v[236:239]
    ds_read_b128 v[40:43], v3 offset:9216
    ds_read_b128 v[44:47], v3 offset:27648
    s_add_u32 m0, s23, 5760
    s_nop 0
    buffer_load_dwordx4 v2, s[8:11], s24 offen offset:384 lds
    s_waitcnt lgkmcnt(6)
    v_mfma_f32_16x16x32_bf16 v[208:211], v[48:51], v[88:91], v[208:211]
    v_mfma_f32_16x16x32_bf16 v[212:215], v[48:51], v[160:163], v[212:215]
    v_mfma_f32_16x16x32_bf16 v[216:219], v[52:55], v[88:91], v[216:219]
    v_mfma_f32_16x16x32_bf16 v[220:223], v[52:55], v[160:163], v[220:223]
    v_mfma_f32_16x16x32_bf16 v[224:227], v[48:51], a[24:27], v[224:227]
    v_mfma_f32_16x16x32_bf16 v[228:231], v[48:51], a[96:99], v[228:231]
    v_mfma_f32_16x16x32_bf16 v[232:235], v[52:55], a[24:27], v[232:235]
    v_mfma_f32_16x16x32_bf16 v[236:239], v[52:55], a[96:99], v[236:239]
    ds_read_b128 v[48:51], v3 offset:10240
    ds_read_b128 v[52:55], v3 offset:28672
    s_add_u32 m0, s23, 6720
    s_nop 0
    buffer_load_dwordx4 v2, s[8:11], s24 offen offset:448 lds
    s_waitcnt lgkmcnt(6)
    v_mfma_f32_16x16x32_bf16 v[208:211], v[56:59], v[92:95], v[208:211]
    v_mfma_f32_16x16x32_bf16 v[212:215], v[56:59], v[164:167], v[212:215]
    v_mfma_f32_16x16x32_bf16 v[216:219], v[60:63], v[92:95], v[216:219]
    v_mfma_f32_16x16x32_bf16 v[220:223], v[60:63], v[164:167], v[220:223]
    v_mfma_f32_16x16x32_bf16 v[224:227], v[56:59], a[28:31], v[224:227]
    v_mfma_f32_16x16x32_bf16 v[228:231], v[56:59], a[100:103], v[228:231]
    v_mfma_f32_16x16x32_bf16 v[232:235], v[60:63], a[28:31], v[232:235]
    v_mfma_f32_16x16x32_bf16 v[236:239], v[60:63], a[100:103], v[236:239]
    ds_read_b128 v[56:59], v3 offset:11264
    ds_read_b128 v[60:63], v3 offset:29696
    s_add_u32 m0, s23, 7680
    s_nop 0
    buffer_load_dwordx4 v2, s[8:11], s24 offen offset:512 lds
    s_add_u32 s24, s24, 147456
    s_waitcnt lgkmcnt(6)
    v_mfma_f32_16x16x32_bf16 v[208:211], v[32:35], v[96:99], v[208:211]
    v_mfma_f32_16x16x32_bf16 v[212:215], v[32:35], v[168:171], v[212:215]
    v_mfma_f32_16x16x32_bf16 v[216:219], v[36:39], v[96:99], v[216:219]
    v_mfma_f32_16x16x32_bf16 v[220:223], v[36:39], v[168:171], v[220:223]
    v_mfma_f32_16x16x32_bf16 v[224:227], v[32:35], a[32:35], v[224:227]
    v_mfma_f32_16x16x32_bf16 v[228:231], v[32:35], a[104:107], v[228:231]
    v_mfma_f32_16x16x32_bf16 v[232:235], v[36:39], a[32:35], v[232:235]
    v_mfma_f32_16x16x32_bf16 v[236:239], v[36:39], a[104:107], v[236:239]
    ds_read_b128 v[32:35], v3 offset:12288
    ds_read_b128 v[36:39], v3 offset:30720
    s_waitcnt lgkmcnt(6)
    v_mfma_f32_16x16x32_bf16 v[208:211], v[40:43], v[100:103], v[208:211]
    v_mfma_f32_16x16x32_bf16 v[212:215], v[40:43], v[172:175], v[212:215]
    v_mfma_f32_16x16x32_bf16 v[216:219], v[44:47], v[100:103], v[216:219]
    v_mfma_f32_16x16x32_bf16 v[220:223], v[44:47], v[172:175], v[220:223]
    v_mfma_f32_16x16x32_bf16 v[224:227], v[40:43], a[36:39], v[224:227]
    v_mfma_f32_16x16x32_bf16 v[228:231], v[40:43], a[108:111], v[228:231]
    v_mfma_f32_16x16x32_bf16 v[232:235], v[44:47], a[36:39], v[232:235]
    v_mfma_f32_16x16x32_bf16 v[236:239], v[44:47], a[108:111], v[236:239]
    ds_read_b128 v[40:43], v3 offset:13312
    ds_read_b128 v[44:47], v3 offset:31744
    s_waitcnt lgkmcnt(6)
    v_mfma_f32_16x16x32_bf16 v[208:211], v[48:51], v[104:107], v[208:211]
    v_mfma_f32_16x16x32_bf16 v[212:215], v[48:51], v[176:179], v[212:215]
    v_mfma_f32_16x16x32_bf16 v[216:219], v[52:55], v[104:107], v[216:219]
    v_mfma_f32_16x16x32_bf16 v[220:223], v[52:55], v[176:179], v[220:223]
    v_mfma_f32_16x16x32_bf16 v[224:227], v[48:51], a[40:43], v[224:227]
    v_mfma_f32_16x16x32_bf16 v[228:231], v[48:51], a[112:115], v[228:231]
    v_mfma_f32_16x16x32_bf16 v[232:235], v[52:55], a[40:43], v[232:235]
    v_mfma_f32_16x16x32_bf16 v[236:239], v[52:55], a[112:115], v[236:239]
    ds_read_b128 v[48:51], v3 offset:14336
    ds_read_b128 v[52:55], v3 offset:32768
    s_waitcnt lgkmcnt(6)
    v_mfma_f32_16x16x32_bf16 v[208:211], v[56:59], v[108:111], v[208:211]
    v_mfma_f32_16x16x32_bf16 v[212:215], v[56:59], v[180:183], v[212:215]
    v_mfma_f32_16x16x32_bf16 v[216:219], v[60:63], v[108:111], v[216:219]
    v_mfma_f32_16x16x32_bf16 v[220:223], v[60:63], v[180:183], v[220:223]
    v_mfma_f32_16x16x32_bf16 v[224:227], v[56:59], a[44:47], v[224:227]
    v_mfma_f32_16x16x32_bf16 v[228:231], v[56:59], a[116:119], v[228:231]
    v_mfma_f32_16x16x32_bf16 v[232:235], v[60:63], a[44:47], v[232:235]
    v_mfma_f32_16x16x32_bf16 v[236:239], v[60:63], a[116:119], v[236:239]
    ds_read_b128 v[56:59], v3 offset:15360
    ds_read_b128 v[60:63], v3 offset:33792
    s_waitcnt lgkmcnt(6)
    v_mfma_f32_16x16x32_bf16 v[208:211], v[32:35], v[112:115], v[208:211]
    v_mfma_f32_16x16x32_bf16 v[212:215], v[32:35], v[184:187], v[212:215]
    v_mfma_f32_16x16x32_bf16 v[216:219], v[36:39], v[112:115], v[216:219]
    v_mfma_f32_16x16x32_bf16 v[220:223], v[36:39], v[184:187], v[220:223]
    v_mfma_f32_16x16x32_bf16 v[224:227], v[32:35], a[48:51], v[224:227]
    v_mfma_f32_16x16x32_bf16 v[228:231], v[32:35], a[120:123], v[228:231]
    v_mfma_f32_16x16x32_bf16 v[232:235], v[36:39], a[48:51], v[232:235]
    v_mfma_f32_16x16x32_bf16 v[236:239], v[36:39], a[120:123], v[236:239]
    ds_read_b128 v[32:35], v3 offset:16384
    ds_read_b128 v[36:39], v3 offset:34816
    s_waitcnt lgkmcnt(6)
    v_mfma_f32_16x16x32_bf16 v[208:211], v[40:43], v[116:119], v[208:211]
    v_mfma_f32_16x16x32_bf16 v[212:215], v[40:43], v[188:191], v[212:215]
    v_mfma_f32_16x16x32_bf16 v[216:219], v[44:47], v[116:119], v[216:219]
    v_mfma_f32_16x16x32_bf16 v[220:223], v[44:47], v[188:191], v[220:223]
    v_mfma_f32_16x16x32_bf16 v[224:227], v[40:43], a[52:55], v[224:227]
    v_mfma_f32_16x16x32_bf16 v[228:231], v[40:43], a[124:127], v[228:231]
    v_mfma_f32_16x16x32_bf16 v[232:235], v[44:47], a[52:55], v[232:235]
    v_mfma_f32_16x16x32_bf16 v[236:239], v[44:47], a[124:127], v[236:239]
    ds_read_b128 v[40:43], v3 offset:17408
    ds_read_b128 v[44:47], v3 offset:35840
    s_waitcnt lgkmcnt(6)
    v_mfma_f32_16x16x32_bf16 v[208:211], v[48:51], v[120:123], v[208:211]
    v_mfma_f32_16x16x32_bf16 v[212:215], v[48:51], v[192:195], v[212:215]
    v_mfma_f32_16x16x32_bf16 v[216:219], v[52:55], v[120:123], v[216:219]
    v_mfma_f32_16x16x32_bf16 v[220:223], v[52:55], v[192:195], v[220:223]
    v_mfma_f32_16x16x32_bf16 v[224:227], v[48:51], a[56:59], v[224:227]
    v_mfma_f32_16x16x32_bf16 v[228:231], v[48:51], a[128:131], v[228:231]
    v_mfma_f32_16x16x32_bf16 v[232:235], v[52:55], a[56:59], v[232:235]
    v_mfma_f32_16x16x32_bf16 v[236:239], v[52:55], a[128:131], v[236:239]
    s_waitcnt lgkmcnt(4)
    v_mfma_f32_16x16x32_bf16 v[208:211], v[56:59], v[124:127], v[208:211]
    v_mfma_f32_16x16x32_bf16 v[212:215], v[56:59], v[196:199], v[212:215]
    v_mfma_f32_16x16x32_bf16 v[216:219], v[60:63], v[124:127], v[216:219]
    v_mfma_f32_16x16x32_bf16 v[220:223], v[60:63], v[196:199], v[220:223]
    v_mfma_f32_16x16x32_bf16 v[224:227], v[56:59], a[60:63], v[224:227]
    v_mfma_f32_16x16x32_bf16 v[228:231], v[56:59], a[132:135], v[228:231]
    v_mfma_f32_16x16x32_bf16 v[232:235], v[60:63], a[60:63], v[232:235]
    v_mfma_f32_16x16x32_bf16 v[236:239], v[60:63], a[132:135], v[236:239]
    s_waitcnt lgkmcnt(2)
    v_mfma_f32_16x16x32_bf16 v[208:211], v[32:35], v[128:131], v[208:211]
    v_mfma_f32_16x16x32_bf16 v[212:215], v[32:35], v[200:203], v[212:215]
    v_mfma_f32_16x16x32_bf16 v[216:219], v[36:39], v[128:131], v[216:219]
    v_mfma_f32_16x16x32_bf16 v[220:223], v[36:39], v[200:203], v[220:223]
    v_mfma_f32_16x16x32_bf16 v[224:227], v[32:35], a[64:67], v[224:227]
    v_mfma_f32_16x16x32_bf16 v[228:231], v[32:35], a[136:139], v[228:231]
    v_mfma_f32_16x16x32_bf16 v[232:235], v[36:39], a[64:67], v[232:235]
    v_mfma_f32_16x16x32_bf16 v[236:239], v[36:39], a[136:139], v[236:239]
    s_waitcnt lgkmcnt(0)
    v_mfma_f32_16x16x32_bf16 v[208:211], v[40:43], v[132:135], v[208:211]
    v_mfma_f32_16x16x32_bf16 v[212:215], v[40:43], v[204:207], v[212:215]
    v_mfma_f32_16x16x32_bf16 v[216:219], v[44:47], v[132:135], v[216:219]
    v_mfma_f32_16x16x32_bf16 v[220:223], v[44:47], v[204:207], v[220:223]
    v_mfma_f32_16x16x32_bf16 v[224:227], v[40:43], a[68:71], v[224:227]
    v_mfma_f32_16x16x32_bf16 v[228:231], v[40:43], a[140:143], v[228:231]
    v_mfma_f32_16x16x32_bf16 v[232:235], v[44:47], a[68:71], v[232:235]
    v_mfma_f32_16x16x32_bf16 v[236:239], v[44:47], a[140:143], v[236:239]
    s_waitcnt vmcnt(0)
    v_cvt_pk_bf16_f32 v8, v208, v209
    v_cvt_pk_bf16_f32 v9, v210, v211
    v_cvt_pk_bf16_f32 v10, v216, v217
    v_cvt_pk_bf16_f32 v11, v218, v219
    s_lshr_b32 s22, s41, 5
    s_mul_i32 s22, s22, 0
    s_add_u32 s28, s26, s22
    buffer_store_dwordx4 v[8:11], v7, s[4:7], s28 offen sc1
    v_cvt_pk_bf16_f32 v12, v212, v213
    v_cvt_pk_bf16_f32 v13, v214, v215
    v_cvt_pk_bf16_f32 v14, v220, v221
    v_cvt_pk_bf16_f32 v15, v222, v223
    s_lshr_b32 s22, s41, 5
    s_mul_i32 s22, s22, 0
    s_add_u32 s28, s26, s22
    s_add_u32 s28, s28, s40
    buffer_store_dwordx4 v[12:15], v7, s[4:7], s28 offen sc1
    v_cvt_pk_bf16_f32 v16, v224, v225
    v_cvt_pk_bf16_f32 v17, v226, v227
    v_cvt_pk_bf16_f32 v18, v232, v233
    v_cvt_pk_bf16_f32 v19, v234, v235
    s_lshr_b32 s22, s41, 5
    s_mul_i32 s22, s22, 1
    s_add_u32 s28, s26, s22
    buffer_store_dwordx4 v[16:19], v7, s[4:7], s28 offen sc1
    v_cvt_pk_bf16_f32 v20, v228, v229
    v_cvt_pk_bf16_f32 v21, v230, v231
    v_cvt_pk_bf16_f32 v22, v236, v237
    v_cvt_pk_bf16_f32 v23, v238, v239
    s_lshr_b32 s22, s41, 5
    s_mul_i32 s22, s22, 1
    s_add_u32 s28, s26, s22
    s_add_u32 s28, s28, s40
    buffer_store_dwordx4 v[20:23], v7, s[4:7], s28 offen sc1
    s_lshl_b32 s22, s41, 2
    s_add_u32 s26, s26, s22
    s_lshr_b32 s45, s19, 2
    s_cbranch_scc1 qk_vloop_nf
    s_waitcnt vmcnt(0)
    s_mov_b32 s45, 1
qk_vloop_nf:
    s_add_u32 s27, s27, 36864
    s_cmp_eq_u32 s27, 110592
    s_cselect_b32 s27, 0, s27
    s_add_u32 s19, s19, 4
    s_cmp_lt_u32 s19, s20
    s_cbranch_scc1 qk_vloop
qk_done:
    s_waitcnt vmcnt(0)
    s_barrier
    s_mov_b32 s45, 16
    s_add_u32 s23, s45, s95
    v_mov_b32 v4, s23
    s_mov_b64 exec, s[34:35]
    buffer_store_dword v4, off, s[4:7], s29 sc1
    buffer_store_dword v4, off, s[4:7], s29 offset:128 sc1
    s_mov_b64 exec, -1
    s_cmp_eq_u32 s16, 0
    s_cbranch_scc1 L_qkv_next
    s_cmp_lg_u32 s19, 64
    s_cbranch_scc1 L_qkv_next
    v_and_b32 v4, 63, v0
    v_and_b32 v2, 7, v4
    v_lshrrev_b32 v5, 4, v4
    v_lshl_add_u32 v2, v5, 3, v2
    v_lshlrev_b32 v2, 4, v2
    v_bfe_u32 v3, v4, 3, 1
    v_mul_u32_u24 v5, 9216, v3
    v_add_u32 v2, v2, v5
    v_mov_b32 v240, 0x05040100
    v_mov_b32 v241, 0x07060302
    v_lshrrev_b32 v5, 5, v4
    v_and_b32 v1, 0xdff, v7
    s_cmp_eq_u32 s16, 2
    s_cbranch_scc1 mk_isv
    v_mov_b32 v5, v3
    v_or_b32 v1, 128, v7
mk_isv:
    v_lshl_add_u32 v1, v5, 17, v1
    s_mov_b32 s28, 0
    s_mov_b32 s19, 2
    s_mov_b32 s24, 138412032
    s_lshl_b32 s26, s17, 12
    s_mov_b32 s21, 69206016
    s_cmp_eq_u32 s16, 2
    s_cselect_b32 s21, 77594624, s21
    s_add_u32 s26, s26, s21
    s_lshl_b32 s29, s17, 7
    s_lshl_b32 s21, s16, 2
    s_add_u32 s29, s29, s21
    s_add_u32 s29, s29, 125829164
mk_loop:
    s_cmp_lg_u32 s18, 0
    s_cbranch_scc1 mk_go
    s_cmp_le_u32 s19, s28
    s_cbranch_scc1 mk_go
    s_mov_b32 s23, 125853696
    s_mov_b32 s21, 4194304
mk_wait:
    buffer_load_dword v4, off, s[4:7], s23 sc1
    s_sub_u32 s21, s21, 1
    s_cbranch_scc1 mk_go
    s_waitcnt vmcnt(0)
    v_readfirstlane_b32 s28, v4
    s_nop 0
    s_sub_u32 s28, s28, s95
    s_cmp_gt_u32 s28, 64
    s_cselect_b32 s28, 0, s28
    s_cmp_le_u32 s19, s28
    s_cbranch_scc1 mk_go
    s_sleep 4
    s_branch mk_wait
mk_go:
    s_barrier
    s_add_u32 s21, s24, 4096
    s_add_u32 s23, s24, 8192
    buffer_load_dwordx4 v[24:27], v2, s[4:7], s24 offen offset:0 sc1
    buffer_load_dwordx4 v[28:31], v2, s[4:7], s24 offen offset:512 sc1
    buffer_load_dwordx4 v[32:35], v2, s[4:7], s21 offen offset:0 sc1
    buffer_load_dwordx4 v[36:39], v2, s[4:7], s21 offen offset:512 sc1
    buffer_load_dwordx4 v[40:43], v2, s[4:7], s24 offen offset:1024 sc1
    buffer_load_dwordx4 v[44:47], v2, s[4:7], s24 offen offset:1536 sc1
    buffer_load_dwordx4 v[48:51], v2, s[4:7], s21 offen offset:1024 sc1
    buffer_load_dwordx4 v[52:55], v2, s[4:7], s21 offen offset:1536 sc1
    buffer_load_dwordx4 v[56:59], v2, s[4:7], s24 offen offset:2048 sc1
    buffer_load_dwordx4 v[60:63], v2, s[4:7], s24 offen offset:2560 sc1
    buffer_load_dwordx4 v[208:211], v2, s[4:7], s21 offen offset:2048 sc1
    buffer_load_dwordx4 v[212:215], v2, s[4:7], s21 offen offset:2560 sc1
    buffer_load_dwordx4 v[216:219], v2, s[4:7], s24 offen offset:3072 sc1
    buffer_load_dwordx4 v[220:223], v2, s[4:7], s24 offen offset:3584 sc1
    buffer_load_dwordx4 v[224:227], v2, s[4:7], s21 offen offset:3072 sc1
    buffer_load_dwordx4 v[228:231], v2, s[4:7], s21 offen offset:3584 sc1
    buffer_load_dwordx4 v[232:235], v2, s[4:7], s23 offen offset:0 sc1
    buffer_load_dwordx4 v[236:239], v2, s[4:7], s23 offen offset:512 sc1
    s_add_u32 s24, s24, 18432
    s_cmp_eq_u32 s16, 2
    s_cbranch_scc1 mk_v
    s_waitcnt vmcnt(17)
    v_perm_b32 v244, v25, v24, v240
    v_perm_b32 v245, v27, v26, v240
    v_perm_b32 v246, v25, v24, v241
    v_perm_b32 v247, v27, v26, v241
    s_waitcnt vmcnt(16)
    v_perm_b32 v248, v29, v28, v240
    v_perm_b32 v249, v31, v30, v240
    v_perm_b32 v250, v29, v28, v241
    v_perm_b32 v251, v31, v30, v241
    v_mfma_f32_16x16x32_bf16 v[8:11], v[64:67], v[244:247], 0
    v_mfma_f32_16x16x32_bf16 v[12:15], v[136:139], v[244:247], 0
    v_mfma_f32_16x16x32_bf16 v[16:19], a[0:3], v[244:247], 0
    v_mfma_f32_16x16x32_bf16 v[20:23], a[72:75], v[244:247], 0
    s_waitcnt vmcnt(15)
    v_perm_b32 v244, v33, v32, v240
    v_perm_b32 v245, v35, v34, v240
    v_perm_b32 v246, v33, v32, v241
    v_perm_b32 v247, v35, v34, v241
    v_mfma_f32_16x16x32_bf16 v[8:11], v[68:71], v[248:251], v[8:11]
    v_mfma_f32_16x16x32_bf16 v[12:15], v[140:143], v[248:251], v[12:15]
    v_mfma_f32_16x16x32_bf16 v[16:19], a[4:7], v[248:251], v[16:19]
    v_mfma_f32_16x16x32_bf16 v[20:23], a[76:79], v[248:251], v[20:23]
    s_waitcnt vmcnt(14)
    v_perm_b32 v248, v37, v36, v240
    v_perm_b32 v249, v39, v38, v240
    v_perm_b32 v250, v37, v36, v241
    v_perm_b32 v251, v39, v38, v241
    v_mfma_f32_16x16x32_bf16 v[8:11], v[72:75], v[244:247], v[8:11]
    v_mfma_f32_16x16x32_bf16 v[12:15], v[144:147], v[244:247], v[12:15]
    v_mfma_f32_16x16x32_bf16 v[16:19], a[8:11], v[244:247], v[16:19]
    v_mfma_f32_16x16x32_bf16 v[20:23], a[80:83], v[244:247], v[20:23]
    s_waitcnt vmcnt(13)
    v_perm_b32 v244, v41, v40, v240
    v_perm_b32 v245, v43, v42, v240
    v_perm_b32 v246, v41, v40, v241
    v_perm_b32 v247, v43, v42, v241
    v_mfma_f32_16x16x32_bf16 v[8:11], v[76:79], v[248:251], v[8:11]
    v_mfma_f32_16x16x32_bf16 v[12:15], v[148:151], v[248:251], v[12:15]
    v_mfma_f32_16x16x32_bf16 v[16:19], a[12:15], v[248:251], v[16:19]
    v_mfma_f32_16x16x32_bf16 v[20:23], a[84:87], v[248:251], v[20:23]
    s_waitcnt vmcnt(12)
    v_perm_b32 v248, v45, v44, v240
    v_perm_b32 v249, v47, v46, v240
    v_perm_b32 v250, v45, v44, v241
    v_perm_b32 v251, v47, v46, v241
    v_mfma_f32_16x16x32_bf16 v[8:11], v[80:83], v[244:247], v[8:11]
    v_mfma_f32_16x16x32_bf16 v[12:15], v[152:155], v[244:247], v[12:15]
    v_mfma_f32_16x16x32_bf16 v[16:19], a[16:19], v[244:247], v[16:19]
    v_mfma_f32_16x16x32_bf16 v[20:23], a[88:91], v[244:247], v[20:23]
    s_waitcnt vmcnt(11)
    v_perm_b32 v244, v49, v48, v240
    v_perm_b32 v245, v51, v50, v240
    v_perm_b32 v246, v49, v48, v241
    v_perm_b32 v247, v51, v50, v241
    v_mfma_f32_16x16x32_bf16 v[8:11], v[84:87], v[248:251], v[8:11]
    v_mfma_f32_16x16x32_bf16 v[12:15], v[156:159], v[248:251], v[12:15]
    v_mfma_f32_16x16x32_bf16 v[16:19], a[20:23], v[248:251], v[16:19]
    v_mfma_f32_16x16x32_bf16 v[20:23], a[92:95], v[248:251], v[20:23]
    s_waitcnt vmcnt(10)
    v_perm_b32 v248, v53, v52, v240
    v_perm_b32 v249, v55, v54, v240
    v_perm_b32 v250, v53, v52, v241
    v_perm_b32 v251, v55, v54, v241
    v_mfma_f32_16x16x32_bf16 v[8:11], v[88:91], v[244:247], v[8:11]
    v_mfma_f32_16x16x32_bf16 v[12:15], v[160:163], v[244:247], v[12:15]
    v_mfma_f32_16x16x32_bf16 v[16:19], a[24:27], v[244:247], v[16:19]
    v_mfma_f32_16x16x32_bf16 v[20:23], a[96:99], v[244:247], v[20:23]
    s_waitcnt vmcnt(9)
    v_perm_b32 v244, v57, v56, v240
    v_perm_b32 v245, v59, v58, v240
    v_perm_b32 v246, v57, v56, v241
    v_perm_b32 v247, v59, v58, v241
    v_mfma_f32_16x16x32_bf16 v[8:11], v[92:95], v[248:251], v[8:11]
    v_mfma_f32_16x16x32_bf16 v[12:15], v[164:167], v[248:251], v[12:15]
    v_mfma_f32_16x16x32_bf16 v[16:19], a[28:31], v[248:251], v[16:19]
    v_mfma_f32_16x16x32_bf16 v[20:23], a[100:103], v[248:251], v[20:23]
    s_waitcnt vmcnt(8)
    v_perm_b32 v248, v61, v60, v240
    v_perm_b32 v249, v63, v62, v240
    v_perm_b32 v250, v61, v60, v241
    v_perm_b32 v251, v63, v62, v241
    v_mfma_f32_16x16x32_bf16 v[8:11], v[96:99], v[244:247], v[8:11]
    v_mfma_f32_16x16x32_bf16 v[12:15], v[168:171], v[244:247], v[12:15]
    v_mfma_f32_16x16x32_bf16 v[16:19], a[32:35], v[244:247], v[16:19]
    v_mfma_f32_16x16x32_bf16 v[20:23], a[104:107], v[244:247], v[20:23]
    s_waitcnt vmcnt(7)
    v_perm_b32 v244, v209, v208, v240
    v_perm_b32 v245, v211, v210, v240
    v_perm_b32 v246, v209, v208, v241
    v_perm_b32 v247, v211, v210, v241
    v_mfma_f32_16x16x32_bf16 v[8:11], v[100:103], v[248:251], v[8:11]
    v_mfma_f32_16x16x32_bf16 v[12:15], v[172:175], v[248:251], v[12:15]
    v_mfma_f32_16x16x32_bf16 v[16:19], a[36:39], v[248:251], v[16:19]
    v_mfma_f32_16x16x32_bf16 v[20:23], a[108:111], v[248:251], v[20:23]
    s_waitcnt vmcnt(6)
    v_perm_b32 v248, v213, v212, v240
    v_perm_b32 v249, v215, v214, v240
    v_perm_b32 v250, v213, v212, v241
    v_perm_b32 v251, v215, v214, v241
    v_mfma_f32_16x16x32_bf16 v[8:11], v[104:107], v[244:247], v[8:11]
    v_mfma_f32_16x16x32_bf16 v[12:15], v[176:179], v[244:247], v[12:15]
    v_mfma_f32_16x16x32_bf16 v[16:19], a[40:43], v[244:247], v[16:19]
    v_mfma_f32_16x16x32_bf16 v[20:23], a[112:115], v[244:247], v[20:23]
    s_waitcnt vmcnt(5)
    v_perm_b32 v244, v217, v216, v240
    v_perm_b32 v245, v219, v218, v240
    v_perm_b32 v246, v217, v216, v241
    v_perm_b32 v247, v219, v218, v241
    v_mfma_f32_16x16x32_bf16 v[8:11], v[108:111], v[248:251], v[8:11]
    v_mfma_f32_16x16x32_bf16 v[12:15], v[180:183], v[248:251], v[12:15]
    v_mfma_f32_16x16x32_bf16 v[16:19], a[44:47], v[248:251], v[16:19]
    v_mfma_f32_16x16x32_bf16 v[20:23], a[116:119], v[248:251], v[20:23]
    s_waitcnt vmcnt(4)
    v_perm_b32 v248, v221, v220, v240
    v_perm_b32 v249, v223, v222, v240
    v_perm_b32 v250, v221, v220, v241
    v_perm_b32 v251, v223, v222, v241
    v_mfma_f32_16x16x32_bf16 v[8:11], v[112:115], v[244:247], v[8:11]
    v_mfma_f32_16x16x32_bf16 v[12:15], v[184:187], v[244:247], v[12:15]
    v_mfma_f32_16x16x32_bf16 v[16:19], a[48:51], v[244:247], v[16:19]
    v_mfma_f32_16x16x32_bf16 v[20:23], a[120:123], v[244:247], v[20:23]
    s_waitcnt vmcnt(3)
    v_perm_b32 v244, v225, v224, v240
    v_perm_b32 v245, v227, v226, v240
    v_perm_b32 v246, v225, v224, v241
    v_perm_b32 v247, v227, v226, v241
    v_mfma_f32_16x16x32_bf16 v[8:11], v[116:119], v[248:251], v[8:11]
    v_mfma_f32_16x16x32_bf16 v[12:15], v[188:191], v[248:251], v[12:15]
    v_mfma_f32_16x16x32_bf16 v[16:19], a[52:55], v[248:251], v[16:19]
    v_mfma_f32_16x16x32_bf16 v[20:23], a[124:127], v[248:251], v[20:23]
    s_waitcnt vmcnt(2)
    v_perm_b32 v248, v229, v228, v240
    v_perm_b32 v249, v231, v230, v240
    v_perm_b32 v250, v229, v228, v241
    v_perm_b32 v251, v231, v230, v241
    v_mfma_f32_16x16x32_bf16 v[8:11], v[120:123], v[244:247], v[8:11]
    v_mfma_f32_16x16x32_bf16 v[12:15], v[192:195], v[244:247], v[12:15]
    v_mfma_f32_16x16x32_bf16 v[16:19], a[56:59], v[244:247], v[16:19]
    v_mfma_f32_16x16x32_bf16 v[20:23], a[128:131], v[244:247], v[20:23]
    s_waitcnt vmcnt(1)
    v_mfma_f32_16x16x32_bf16 v[8:11], v[124:127], v[248:251], v[8:11]
    v_mfma_f32_16x16x32_bf16 v[12:15], v[196:199], v[248:251], v[12:15]
    v_mfma_f32_16x16x32_bf16 v[16:19], a[60:63], v[248:251], v[16:19]
    v_mfma_f32_16x16x32_bf16 v[20:23], a[132:135], v[248:251], v[20:23]
    s_waitcnt vmcnt(0)
    v_mfma_f32_16x16x32_bf16 v[8:11], v[128:131], v[232:235], v[8:11]
    v_mfma_f32_16x16x32_bf16 v[12:15], v[200:203], v[232:235], v[12:15]
    v_mfma_f32_16x16x32_bf16 v[16:19], a[64:67], v[232:235], v[16:19]
    v_mfma_f32_16x16x32_bf16 v[20:23], a[136:139], v[232:235], v[20:23]
    v_mfma_f32_16x16x32_bf16 v[8:11], v[132:135], v[236:239], v[8:11]
    v_mfma_f32_16x16x32_bf16 v[12:15], v[204:207], v[236:239], v[12:15]
    v_mfma_f32_16x16x32_bf16 v[16:19], a[68:71], v[236:239], v[16:19]
    v_mfma_f32_16x16x32_bf16 v[20:23], a[140:143], v[236:239], v[20:23]
    s_nop 7
    s_branch mk_st
mk_v:
    s_waitcnt vmcnt(17)
    v_perm_b32 v244, v25, v24, v240
    v_perm_b32 v245, v27, v26, v240
    v_perm_b32 v246, v25, v24, v241
    v_perm_b32 v247, v27, v26, v241
    s_waitcnt vmcnt(16)
    v_perm_b32 v248, v29, v28, v240
    v_perm_b32 v249, v31, v30, v240
    v_perm_b32 v250, v29, v28, v241
    v_perm_b32 v251, v31, v30, v241
    v_mfma_f32_16x16x32_bf16 v[8:11], v[244:247], v[64:67], 0
    v_mfma_f32_16x16x32_bf16 v[12:15], v[244:247], v[136:139], 0
    v_mfma_f32_16x16x32_bf16 v[16:19], v[244:247], a[0:3], 0
    v_mfma_f32_16x16x32_bf16 v[20:23], v[244:247], a[72:75], 0
    s_waitcnt vmcnt(15)
    v_perm_b32 v244, v33, v32, v240
    v_perm_b32 v245, v35, v34, v240
    v_perm_b32 v246, v33, v32, v241
    v_perm_b32 v247, v35, v34, v241
    v_mfma_f32_16x16x32_bf16 v[8:11], v[248:251], v[68:71], v[8:11]
    v_mfma_f32_16x16x32_bf16 v[12:15], v[248:251], v[140:143], v[12:15]
    v_mfma_f32_16x16x32_bf16 v[16:19], v[248:251], a[4:7], v[16:19]
    v_mfma_f32_16x16x32_bf16 v[20:23], v[248:251], a[76:79], v[20:23]
    s_waitcnt vmcnt(14)
    v_perm_b32 v248, v37, v36, v240
    v_perm_b32 v249, v39, v38, v240
    v_perm_b32 v250, v37, v36, v241
    v_perm_b32 v251, v39, v38, v241
    v_mfma_f32_16x16x32_bf16 v[8:11], v[244:247], v[72:75], v[8:11]
    v_mfma_f32_16x16x32_bf16 v[12:15], v[244:247], v[144:147], v[12:15]
    v_mfma_f32_16x16x32_bf16 v[16:19], v[244:247], a[8:11], v[16:19]
    v_mfma_f32_16x16x32_bf16 v[20:23], v[244:247], a[80:83], v[20:23]
    s_waitcnt vmcnt(13)
    v_perm_b32 v244, v41, v40, v240
    v_perm_b32 v245, v43, v42, v240
    v_perm_b32 v246, v41, v40, v241
    v_perm_b32 v247, v43, v42, v241
    v_mfma_f32_16x16x32_bf16 v[8:11], v[248:251], v[76:79], v[8:11]
    v_mfma_f32_16x16x32_bf16 v[12:15], v[248:251], v[148:151], v[12:15]
    v_mfma_f32_16x16x32_bf16 v[16:19], v[248:251], a[12:15], v[16:19]
    v_mfma_f32_16x16x32_bf16 v[20:23], v[248:251], a[84:87], v[20:23]
    s_waitcnt vmcnt(12)
    v_perm_b32 v248, v45, v44, v240
    v_perm_b32 v249, v47, v46, v240
    v_perm_b32 v250, v45, v44, v241
    v_perm_b32 v251, v47, v46, v241
    v_mfma_f32_16x16x32_bf16 v[8:11], v[244:247], v[80:83], v[8:11]
    v_mfma_f32_16x16x32_bf16 v[12:15], v[244:247], v[152:155], v[12:15]
    v_mfma_f32_16x16x32_bf16 v[16:19], v[244:247], a[16:19], v[16:19]
    v_mfma_f32_16x16x32_bf16 v[20:23], v[244:247], a[88:91], v[20:23]
    s_waitcnt vmcnt(11)
    v_perm_b32 v244, v49, v48, v240
    v_perm_b32 v245, v51, v50, v240
    v_perm_b32 v246, v49, v48, v241
    v_perm_b32 v247, v51, v50, v241
    v_mfma_f32_16x16x32_bf16 v[8:11], v[248:251], v[84:87], v[8:11]
    v_mfma_f32_16x16x32_bf16 v[12:15], v[248:251], v[156:159], v[12:15]
    v_mfma_f32_16x16x32_bf16 v[16:19], v[248:251], a[20:23], v[16:19]
    v_mfma_f32_16x16x32_bf16 v[20:23], v[248:251], a[92:95], v[20:23]
    s_waitcnt vmcnt(10)
    v_perm_b32 v248, v53, v52, v240
    v_perm_b32 v249, v55, v54, v240
    v_perm_b32 v250, v53, v52, v241
    v_perm_b32 v251, v55, v54, v241
    v_mfma_f32_16x16x32_bf16 v[8:11], v[244:247], v[88:91], v[8:11]
    v_mfma_f32_16x16x32_bf16 v[12:15], v[244:247], v[160:163], v[12:15]
    v_mfma_f32_16x16x32_bf16 v[16:19], v[244:247], a[24:27], v[16:19]
    v_mfma_f32_16x16x32_bf16 v[20:23], v[244:247], a[96:99], v[20:23]
    s_waitcnt vmcnt(9)
    v_perm_b32 v244, v57, v56, v240
    v_perm_b32 v245, v59, v58, v240
    v_perm_b32 v246, v57, v56, v241
    v_perm_b32 v247, v59, v58, v241
    v_mfma_f32_16x16x32_bf16 v[8:11], v[248:251], v[92:95], v[8:11]
    v_mfma_f32_16x16x32_bf16 v[12:15], v[248:251], v[164:167], v[12:15]
    v_mfma_f32_16x16x32_bf16 v[16:19], v[248:251], a[28:31], v[16:19]
    v_mfma_f32_16x16x32_bf16 v[20:23], v[248:251], a[100:103], v[20:23]
    s_waitcnt vmcnt(8)
    v_perm_b32 v248, v61, v60, v240
    v_perm_b32 v249, v63, v62, v240
    v_perm_b32 v250, v61, v60, v241
    v_perm_b32 v251, v63, v62, v241
    v_mfma_f32_16x16x32_bf16 v[8:11], v[244:247], v[96:99], v[8:11]
    v_mfma_f32_16x16x32_bf16 v[12:15], v[244:247], v[168:171], v[12:15]
    v_mfma_f32_16x16x32_bf16 v[16:19], v[244:247], a[32:35], v[16:19]
    v_mfma_f32_16x16x32_bf16 v[20:23], v[244:247], a[104:107], v[20:23]
    s_waitcnt vmcnt(7)
    v_perm_b32 v244, v209, v208, v240
    v_perm_b32 v245, v211, v210, v240
    v_perm_b32 v246, v209, v208, v241
    v_perm_b32 v247, v211, v210, v241
    v_mfma_f32_16x16x32_bf16 v[8:11], v[248:251], v[100:103], v[8:11]
    v_mfma_f32_16x16x32_bf16 v[12:15], v[248:251], v[172:175], v[12:15]
    v_mfma_f32_16x16x32_bf16 v[16:19], v[248:251], a[36:39], v[16:19]
    v_mfma_f32_16x16x32_bf16 v[20:23], v[248:251], a[108:111], v[20:23]
    s_waitcnt vmcnt(6)
    v_perm_b32 v248, v213, v212, v240
    v_perm_b32 v249, v215, v214, v240
    v_perm_b32 v250, v213, v212, v241
    v_perm_b32 v251, v215, v214, v241
    v_mfma_f32_16x16x32_bf16 v[8:11], v[244:247], v[104:107], v[8:11]
    v_mfma_f32_16x16x32_bf16 v[12:15], v[244:247], v[176:179], v[12:15]
    v_mfma_f32_16x16x32_bf16 v[16:19], v[244:247], a[40:43], v[16:19]
    v_mfma_f32_16x16x32_bf16 v[20:23], v[244:247], a[112:115], v[20:23]
    s_waitcnt vmcnt(5)
    v_perm_b32 v244, v217, v216, v240
    v_perm_b32 v245, v219, v218, v240
    v_perm_b32 v246, v217, v216, v241
    v_perm_b32 v247, v219, v218, v241
    v_mfma_f32_16x16x32_bf16 v[8:11], v[248:251], v[108:111], v[8:11]
    v_mfma_f32_16x16x32_bf16 v[12:15], v[248:251], v[180:183], v[12:15]
    v_mfma_f32_16x16x32_bf16 v[16:19], v[248:251], a[44:47], v[16:19]
    v_mfma_f32_16x16x32_bf16 v[20:23], v[248:251], a[116:119], v[20:23]
    s_waitcnt vmcnt(4)
    v_perm_b32 v248, v221, v220, v240
    v_perm_b32 v249, v223, v222, v240
    v_perm_b32 v250, v221, v220, v241
    v_perm_b32 v251, v223, v222, v241
    v_mfma_f32_16x16x32_bf16 v[8:11], v[244:247], v[112:115], v[8:11]
    v_mfma_f32_16x16x32_bf16 v[12:15], v[244:247], v[184:187], v[12:15]
    v_mfma_f32_16x16x32_bf16 v[16:19], v[244:247], a[48:51], v[16:19]
    v_mfma_f32_16x16x32_bf16 v[20:23], v[244:247], a[120:123], v[20:23]
    s_waitcnt vmcnt(3)
    v_perm_b32 v244, v225, v224, v240
    v_perm_b32 v245, v227, v226, v240
    v_perm_b32 v246, v225, v224, v241
    v_perm_b32 v247, v227, v226, v241
    v_mfma_f32_16x16x32_bf16 v[8:11], v[248:251], v[116:119], v[8:11]
    v_mfma_f32_16x16x32_bf16 v[12:15], v[248:251], v[188:191], v[12:15]
    v_mfma_f32_16x16x32_bf16 v[16:19], v[248:251], a[52:55], v[16:19]
    v_mfma_f32_16x16x32_bf16 v[20:23], v[248:251], a[124:127], v[20:23]
    s_waitcnt vmcnt(2)
    v_perm_b32 v248, v229, v228, v240
    v_perm_b32 v249, v231, v230, v240
    v_perm_b32 v250, v229, v228, v241
    v_perm_b32 v251, v231, v230, v241
    v_mfma_f32_16x16x32_bf16 v[8:11], v[244:247], v[120:123], v[8:11]
    v_mfma_f32_16x16x32_bf16 v[12:15], v[244:247], v[192:195], v[12:15]
    v_mfma_f32_16x16x32_bf16 v[16:19], v[244:247], a[56:59], v[16:19]
    v_mfma_f32_16x16x32_bf16 v[20:23], v[244:247], a[128:131], v[20:23]
    s_waitcnt vmcnt(1)
    v_mfma_f32_16x16x32_bf16 v[8:11], v[248:251], v[124:127], v[8:11]
    v_mfma_f32_16x16x32_bf16 v[12:15], v[248:251], v[196:199], v[12:15]
    v_mfma_f32_16x16x32_bf16 v[16:19], v[248:251], a[60:63], v[16:19]
    v_mfma_f32_16x16x32_bf16 v[20:23], v[248:251], a[132:135], v[20:23]
    s_waitcnt vmcnt(0)
    v_mfma_f32_16x16x32_bf16 v[8:11], v[232:235], v[128:131], v[8:11]
    v_mfma_f32_16x16x32_bf16 v[12:15], v[232:235], v[200:203], v[12:15]
    v_mfma_f32_16x16x32_bf16 v[16:19], v[232:235], a[64:67], v[16:19]
    v_mfma_f32_16x16x32_bf16 v[20:23], v[232:235], a[136:139], v[20:23]
    v_mfma_f32_16x16x32_bf16 v[8:11], v[236:239], v[132:135], v[8:11]
    v_mfma_f32_16x16x32_bf16 v[12:15], v[236:239], v[204:207], v[12:15]
    v_mfma_f32_16x16x32_bf16 v[16:19], v[236:239], a[68:71], v[16:19]
    v_mfma_f32_16x16x32_bf16 v[20:23], v[236:239], a[140:143], v[20:23]
    s_nop 4
    v_pk_mul_f32 v[8:9], v[8:9], 0.5 op_sel_hi:[1,0]
    v_pk_mul_f32 v[10:11], v[10:11], 0.5 op_sel_hi:[1,0]
    v_pk_mul_f32 v[12:13], v[12:13], 0.5 op_sel_hi:[1,0]
    v_pk_mul_f32 v[14:15], v[14:15], 0.5 op_sel_hi:[1,0]
    v_pk_mul_f32 v[16:17], v[16:17], 0.5 op_sel_hi:[1,0]
    v_pk_mul_f32 v[18:19], v[18:19], 0.5 op_sel_hi:[1,0]
    v_pk_mul_f32 v[20:21], v[20:21], 0.5 op_sel_hi:[1,0]
    v_pk_mul_f32 v[22:23], v[22:23], 0.5 op_sel_hi:[1,0]
mk_st:
    s_nop 1
    v_cvt_pk_bf16_f32 v24, v8, v9
    v_cvt_pk_bf16_f32 v25, v10, v11
    v_cvt_pk_bf16_f32 v26, v12, v13
    v_cvt_pk_bf16_f32 v27, v14, v15
    v_cvt_pk_bf16_f32 v28, v16, v17
    v_cvt_pk_bf16_f32 v29, v18, v19
    v_cvt_pk_bf16_f32 v30, v20, v21
    v_cvt_pk_bf16_f32 v31, v22, v23
    s_add_u32 s21, s26, 4096
    buffer_store_dwordx4 v[24:27], v1, s[4:7], s26 offen sc1
    buffer_store_dwordx4 v[28:31], v1, s[4:7], s21 offen sc1
    s_add_u32 s22, s19, s95
    s_waitcnt vmcnt(0)
    s_barrier
    v_mov_b32 v4, s22
    s_mov_b64 exec, s[34:35]
    buffer_store_dword v4, off, s[4:7], s29 sc1
    buffer_store_dword v4, off, s[4:7], s29 offset:128 sc1
    s_mov_b64 exec, -1
    s_add_u32 s19, s19, 2
    s_add_u32 s26, s26, 262144
    s_cmp_le_u32 s19, 58
    s_cbranch_scc1 mk_loop
    s_endpgm
L_ssm_next:
    s_sub_u32 s93, s93, 1
    s_cbranch_scc1 L_exit
    s_mov_b32 s37, 8
    v_mov_b32 v250, 1
    v_mov_b32 v251, 163832
    v_cmp_eq_u32 vcc, 0, v0
    s_nop 0
    s_and_saveexec_b64 s[38:39], vcc
    s_cbranch_execz tk9
    buffer_atomic_add v250, off, s[84:87], s37 sc0
    s_waitcnt vmcnt(0)
    ds_write_b32 v251, v250
    s_waitcnt lgkmcnt(0)
tk9:
    s_mov_b64 exec, -1
    s_barrier
    ds_read_b32 v252, v251
    s_waitcnt lgkmcnt(0)
    v_readfirstlane_b32 s20, v252
    s_barrier
    s_nop 3
    s_cmp_ge_u32 s20, 144
    s_cbranch_scc1 L_wf_next
    s_lshl_b32 s20, s20, 2
    v_lshrrev_b32 v5, 6, v0
    s_nop 0
    v_readfirstlane_b32 s21, v5
    v_and_b32 v1, 63, v0
    v_and_b32 v2, 15, v1
    v_lshrrev_b32 v3, 4, v1
    v_lshlrev_b32 v4, 14, v5
    s_mov_b32 s8, s62
    s_mov_b32 s9, s63
    s_mov_b32 s10, 2359296
    s_mov_b32 s11, 0x20000
    s_mov_b32 s16, s76
    s_mov_b32 s17, s77
    s_mov_b32 s18, 4718592
    s_mov_b32 s19, 0x20000
    v_mul_u32_u24 v5, 9216, v0
    s_lshl_b32 s22, s20, 1
    s_add_u32 s23, s22, 0
    buffer_load_dwordx2 v[8:9], v5, s[8:11], s23 offen
    s_add_u32 s23, s22, 1152
    buffer_load_dwordx2 v[10:11], v5, s[8:11], s23 offen
    s_add_u32 s23, s22, 2304
    buffer_load_dwordx2 v[12:13], v5, s[8:11], s23 offen
    s_add_u32 s23, s22, 3456
    buffer_load_dwordx2 v[14:15], v5, s[8:11], s23 offen
    s_add_u32 s23, s22, 4608
    buffer_load_dwordx2 v[16:17], v5, s[8:11], s23 offen
    s_add_u32 s23, s22, 5760
    buffer_load_dwordx2 v[18:19], v5, s[8:11], s23 offen
    s_add_u32 s23, s22, 6912
    buffer_load_dwordx2 v[20:21], v5, s[8:11], s23 offen
    s_add_u32 s23, s22, 8064
    buffer_load_dwordx2 v[22:23], v5, s[8:11], s23 offen
    s_add_u32 s22, s20, s21
    s_lshl_b32 s23, s22, 8
    v_lshlrev_b32 v6, 3, v2
    v_lshl_add_u32 v6, v3, 1, v6
    s_mov_b32 s12, s64
    s_mov_b32 s13, s65
    s_mov_b32 s14, 147456
    s_mov_b32 s15, 0x20000
    buffer_load_ushort v24, v6, s[12:15], s23 offen offset:0
    buffer_load_ushort v28, v6, s[12:15], s23 offen offset:128
    s_mov_b32 s12, s66
    s_mov_b32 s13, s67
    s_mov_b32 s14, 147456
    s_mov_b32 s15, 0x20000
    buffer_load_ushort v25, v6, s[12:15], s23 offen offset:0
    buffer_load_ushort v29, v6, s[12:15], s23 offen offset:128
    s_mov_b32 s12, s68
    s_mov_b32 s13, s69
    s_mov_b32 s14, 147456
    s_mov_b32 s15, 0x20000
    buffer_load_ushort v26, v6, s[12:15], s23 offen offset:0
    buffer_load_ushort v30, v6, s[12:15], s23 offen offset:128
    s_mov_b32 s12, s70
    s_mov_b32 s13, s71
    s_mov_b32 s14, 147456
    s_mov_b32 s15, 0x20000
    buffer_load_ushort v27, v6, s[12:15], s23 offen offset:0
    buffer_load_ushort v31, v6, s[12:15], s23 offen offset:128
    s_mov_b32 s12, s72
    s_mov_b32 s13, s73
    s_mov_b32 s14, 1152
    s_mov_b32 s15, 0x20000
    s_lshl_b32 s23, s22, 1
    buffer_load_ushort v32, off, s[12:15], s23
    s_mov_b32 s26, 0x3fb8aa3b
    s_mov_b32 s27, 0x3e22f983
    v_mov_b32 v34, 0
    v_mov_b32 v35, 0
    v_lshl_add_u32 v6, v1, 3, v4
    ds_write_b64 v6, v[34:35] offset:0
    s_waitcnt vmcnt(0)
    v_mov_b32 v36, 0x05040100
    v_mov_b32 v37, 0x07060302
    v_lshlrev_b32 v6, 4, v0
    v_perm_b32 v40, v10, v8, v36
    v_perm_b32 v41, v14, v12, v36
    v_perm_b32 v42, v18, v16, v36
    v_perm_b32 v43, v22, v20, v36
    ds_write_b128 v6, v[40:43] offset:512
    s_nop 1
    v_perm_b32 v40, v10, v8, v37
    v_perm_b32 v41, v14, v12, v37
    v_perm_b32 v42, v18, v16, v37
    v_perm_b32 v43, v22, v20, v37
    ds_write_b128 v6, v[40:43] offset:16896
    s_nop 1
    v_perm_b32 v40, v11, v9, v36
    v_perm_b32 v41, v15, v13, v36
    v_perm_b32 v42, v19, v17, v36
    v_perm_b32 v43, v23, v21, v36
    ds_write_b128 v6, v[40:43] offset:33280
    s_nop 1
    v_perm_b32 v40, v11, v9, v37
    v_perm_b32 v41, v15, v13, v37
    v_perm_b32 v42, v19, v17, v37
    v_perm_b32 v43, v23, v21, v37
    ds_write_b128 v6, v[40:43] offset:49664
    s_nop 1
    v_lshlrev_b32 v32, 16, v32
    v_mul_f32 v32, s26, v32
    v_exp_f32 v32, v32
    s_nop 0
    v_cvt_pk_bf16_f32 v32, v32, v32
    v_and_b32 v32, 0xffff0000, v32
    v_add_f32 v33, v32, v32
    v_lshlrev_b32 v24, 16, v24
    v_mul_f32 v24, s26, v24
    v_exp_f32 v24, v24
    s_nop 0
    v_cvt_pk_bf16_f32 v24, v24, v24
    v_and_b32 v24, 0xffff0000, v24
    v_mul_f32 v24, v24, v32
    v_mul_f32 v24, s26, v24
    v_sub_f32 v24, 0, v24
    v_lshlrev_b32 v25, 16, v25
    v_mul_f32 v25, v25, v32
    v_mul_f32 v25, s27, v25
    v_lshlrev_b32 v26, 16, v26
    v_mul_f32 v26, v26, v33
    v_lshlrev_b32 v27, 16, v27
    v_mul_f32 v27, v27, v33
    v_lshlrev_b32 v28, 16, v28
    v_mul_f32 v28, s26, v28
    v_exp_f32 v28, v28
    s_nop 0
    v_cvt_pk_bf16_f32 v28, v28, v28
    v_and_b32 v28, 0xffff0000, v28
    v_mul_f32 v28, v28, v32
    v_mul_f32 v28, s26, v28
    v_sub_f32 v28, 0, v28
    v_lshlrev_b32 v29, 16, v29
    v_mul_f32 v29, v29, v32
    v_mul_f32 v29, s27, v29
    v_lshlrev_b32 v30, 16, v30
    v_mul_f32 v30, v30, v33
    v_lshlrev_b32 v31, 16, v31
    v_mul_f32 v31, v31, v33
    v_cvt_f32_u32 v47, v2
    v_mul_f32 v44, 0x41800000, v47
    v_and_b32 v5, 7, v2
    v_add_u32 v5, 8, v5
    v_cvt_f32_u32 v5, v5
    v_mul_f32 v45, 0x42000000, v5
    v_mul_f32 v6, 0x42800000, v5
    v_cmp_lt_u32 vcc, 7, v2
    s_nop 1
    v_cndmask_b32 v45, v45, v6, vcc
    v_add_f32 v5, 0x41000000, v47
    v_mul_f32 v46, 0x43000000, v5
    v_mov_b32 v48, 0
    v_mov_b32 v49, 0
    v_mov_b32 v50, 0
    v_mov_b32 v51, 0
    v_mov_b32 v52, 0
    v_mov_b32 v53, 0
    v_mov_b32 v54, 0
    v_mov_b32 v55, 0
    v_mov_b32 v56, 0
    v_mov_b32 v57, 0
    v_mov_b32 v58, 0
    v_mov_b32 v59, 0
    v_mov_b32 v60, 0
    v_mov_b32 v61, 0
    v_mov_b32 v62, 0
    v_mov_b32 v63, 0
    v_mov_b32_dpp v64, v24 row_newbcast:0 row_mask:0xf bank_mask:0xf
    v_mov_b32_dpp v65, v25 row_newbcast:0 row_mask:0xf bank_mask:0xf
    v_mov_b32_dpp v66, v26 row_newbcast:0 row_mask:0xf bank_mask:0xf
    v_mov_b32_dpp v67, v27 row_newbcast:0 row_mask:0xf bank_mask:0xf
    v_mul_f32 v82, v64, v47
    v_mul_f32 v83, v65, v47
    v_exp_f32 v82, v82
    v_fract_f32 v83, v83
    v_cos_f32 v74, v83
    v_sin_f32 v75, v83
    v_mul_f32 v74, v74, v82
    v_mul_f32 v75, v75, v82
    v_mul_f32 v84, v75, v75
    v_add_f32 v85, v74, v74
    v_fma_f32 v76, v74, v74, -v84
    v_mul_f32 v77, v85, v75
    v_mul_f32 v84, v77, v77
    v_add_f32 v85, v76, v76
    v_fma_f32 v78, v76, v76, -v84
    v_mul_f32 v79, v85, v77
    v_mul_f32 v84, v79, v79
    v_add_f32 v85, v78, v78
    v_fma_f32 v80, v78, v78, -v84
    v_mul_f32 v81, v85, v79
    v_mul_f32 v82, v64, v44
    v_mul_f32 v83, v65, v44
    v_exp_f32 v82, v82
    v_fract_f32 v83, v83
    v_cos_f32 v68, v83
    v_sin_f32 v69, v83
    v_mul_f32 v68, v68, v82
    v_mul_f32 v69, v69, v82
    v_mul_f32 v84, v67, v69
    v_mul_f32 v85, v67, v68
    v_fma_f32 v68, v66, v68, -v84
    v_fma_f32 v69, -v66, v69, -v85
    v_mul_f32 v82, v64, v45
    v_mul_f32 v83, v65, v45
    v_exp_f32 v82, v82
    v_fract_f32 v83, v83
    v_cos_f32 v70, v83
    v_sin_f32 v71, v83
    v_mul_f32 v70, v70, v82
    v_mul_f32 v71, v71, v82
    v_mul_f32 v84, v67, v71
    v_mul_f32 v85, v67, v70
    v_fma_f32 v70, v66, v70, -v84
    v_fma_f32 v71, -v66, v71, -v85
    v_mul_f32 v82, v64, v46
    v_mul_f32 v83, v65, v46
    v_exp_f32 v82, v82
    v_fract_f32 v83, v83
    v_cos_f32 v72, v83
    v_sin_f32 v73, v83
    v_mul_f32 v72, v72, v82
    v_mul_f32 v73, v73, v82
    v_mul_f32 v84, v67, v73
    v_mul_f32 v85, v67, v72
    v_fma_f32 v72, v66, v72, -v84
    v_fma_f32 v73, -v66, v73, -v85
    v_mfma_f32_16x16x4_f32 v[48:51], v68, v74, v[48:51]
    v_mfma_f32_16x16x4_f32 v[52:55], v70, v76, v[52:55]
    v_mfma_f32_16x16x4_f32 v[56:59], v70, v78, v[56:59]
    v_mfma_f32_16x16x4_f32 v[60:63], v72, v80, v[60:63]
    v_mfma_f32_16x16x4_f32 v[48:51], v69, v75, v[48:51]
    v_mfma_f32_16x16x4_f32 v[52:55], v71, v77, v[52:55]
    v_mfma_f32_16x16x4_f32 v[56:59], v71, v79, v[56:59]
    v_mfma_f32_16x16x4_f32 v[60:63], v73, v81, v[60:63]
    v_mov_b32_dpp v64, v24 row_newbcast:1 row_mask:0xf bank_mask:0xf
    v_mov_b32_dpp v65, v25 row_newbcast:1 row_mask:0xf bank_mask:0xf
    v_mov_b32_dpp v66, v26 row_newbcast:1 row_mask:0xf bank_mask:0xf
    v_mov_b32_dpp v67, v27 row_newbcast:1 row_mask:0xf bank_mask:0xf
    v_mul_f32 v82, v64, v47
    v_mul_f32 v83, v65, v47
    v_exp_f32 v82, v82
    v_fract_f32 v83, v83
    v_cos_f32 v74, v83
    v_sin_f32 v75, v83
    v_mul_f32 v74, v74, v82
    v_mul_f32 v75, v75, v82
    v_mul_f32 v84, v75, v75
    v_add_f32 v85, v74, v74
    v_fma_f32 v76, v74, v74, -v84
    v_mul_f32 v77, v85, v75
    v_mul_f32 v84, v77, v77
    v_add_f32 v85, v76, v76
    v_fma_f32 v78, v76, v76, -v84
    v_mul_f32 v79, v85, v77
    v_mul_f32 v84, v79, v79
    v_add_f32 v85, v78, v78
    v_fma_f32 v80, v78, v78, -v84
    v_mul_f32 v81, v85, v79
    v_mul_f32 v82, v64, v44
    v_mul_f32 v83, v65, v44
    v_exp_f32 v82, v82
    v_fract_f32 v83, v83
    v_cos_f32 v68, v83
    v_sin_f32 v69, v83
    v_mul_f32 v68, v68, v82
    v_mul_f32 v69, v69, v82
    v_mul_f32 v84, v67, v69
    v_mul_f32 v85, v67, v68
    v_fma_f32 v68, v66, v68, -v84
    v_fma_f32 v69, -v66, v69, -v85
    v_mul_f32 v82, v64, v45
    v_mul_f32 v83, v65, v45
    v_exp_f32 v82, v82
    v_fract_f32 v83, v83
    v_cos_f32 v70, v83
    v_sin_f32 v71, v83
    v_mul_f32 v70, v70, v82
    v_mul_f32 v71, v71, v82
    v_mul_f32 v84, v67, v71
    v_mul_f32 v85, v67, v70
    v_fma_f32 v70, v66, v70, -v84
    v_fma_f32 v71, -v66, v71, -v85
    v_mul_f32 v82, v64, v46
    v_mul_f32 v83, v65, v46
    v_exp_f32 v82, v82
    v_fract_f32 v83, v83
    v_cos_f32 v72, v83
    v_sin_f32 v73, v83
    v_mul_f32 v72, v72, v82
    v_mul_f32 v73, v73, v82
    v_mul_f32 v84, v67, v73
    v_mul_f32 v85, v67, v72
    v_fma_f32 v72, v66, v72, -v84
    v_fma_f32 v73, -v66, v73, -v85
    v_mfma_f32_16x16x4_f32 v[48:51], v68, v74, v[48:51]
    v_mfma_f32_16x16x4_f32 v[52:55], v70, v76, v[52:55]
    v_mfma_f32_16x16x4_f32 v[56:59], v70, v78, v[56:59]
    v_mfma_f32_16x16x4_f32 v[60:63], v72, v80, v[60:63]
    v_mfma_f32_16x16x4_f32 v[48:51], v69, v75, v[48:51]
    v_mfma_f32_16x16x4_f32 v[52:55], v71, v77, v[52:55]
    v_mfma_f32_16x16x4_f32 v[56:59], v71, v79, v[56:59]
    v_mfma_f32_16x16x4_f32 v[60:63], v73, v81, v[60:63]
    v_mov_b32_dpp v64, v24 row_newbcast:2 row_mask:0xf bank_mask:0xf
    v_mov_b32_dpp v65, v25 row_newbcast:2 row_mask:0xf bank_mask:0xf
    v_mov_b32_dpp v66, v26 row_newbcast:2 row_mask:0xf bank_mask:0xf
    v_mov_b32_dpp v67, v27 row_newbcast:2 row_mask:0xf bank_mask:0xf
    v_mul_f32 v82, v64, v47
    v_mul_f32 v83, v65, v47
    v_exp_f32 v82, v82
    v_fract_f32 v83, v83
    v_cos_f32 v74, v83
    v_sin_f32 v75, v83
    v_mul_f32 v74, v74, v82
    v_mul_f32 v75, v75, v82
    v_mul_f32 v84, v75, v75
    v_add_f32 v85, v74, v74
    v_fma_f32 v76, v74, v74, -v84
    v_mul_f32 v77, v85, v75
    v_mul_f32 v84, v77, v77
    v_add_f32 v85, v76, v76
    v_fma_f32 v78, v76, v76, -v84
    v_mul_f32 v79, v85, v77
    v_mul_f32 v84, v79, v79
    v_add_f32 v85, v78, v78
    v_fma_f32 v80, v78, v78, -v84
    v_mul_f32 v81, v85, v79
    v_mul_f32 v82, v64, v44
    v_mul_f32 v83, v65, v44
    v_exp_f32 v82, v82
    v_fract_f32 v83, v83
    v_cos_f32 v68, v83
    v_sin_f32 v69, v83
    v_mul_f32 v68, v68, v82
    v_mul_f32 v69, v69, v82
    v_mul_f32 v84, v67, v69
    v_mul_f32 v85, v67, v68
    v_fma_f32 v68, v66, v68, -v84
    v_fma_f32 v69, -v66, v69, -v85
    v_mul_f32 v82, v64, v45
    v_mul_f32 v83, v65, v45
    v_exp_f32 v82, v82
    v_fract_f32 v83, v83
    v_cos_f32 v70, v83
    v_sin_f32 v71, v83
    v_mul_f32 v70, v70, v82
    v_mul_f32 v71, v71, v82
    v_mul_f32 v84, v67, v71
    v_mul_f32 v85, v67, v70
    v_fma_f32 v70, v66, v70, -v84
    v_fma_f32 v71, -v66, v71, -v85
    v_mul_f32 v82, v64, v46
    v_mul_f32 v83, v65, v46
    v_exp_f32 v82, v82
    v_fract_f32 v83, v83
    v_cos_f32 v72, v83
    v_sin_f32 v73, v83
    v_mul_f32 v72, v72, v82
    v_mul_f32 v73, v73, v82
    v_mul_f32 v84, v67, v73
    v_mul_f32 v85, v67, v72
    v_fma_f32 v72, v66, v72, -v84
    v_fma_f32 v73, -v66, v73, -v85
    v_mfma_f32_16x16x4_f32 v[48:51], v68, v74, v[48:51]
    v_mfma_f32_16x16x4_f32 v[52:55], v70, v76, v[52:55]
    v_mfma_f32_16x16x4_f32 v[56:59], v70, v78, v[56:59]
    v_mfma_f32_16x16x4_f32 v[60:63], v72, v80, v[60:63]
    v_mfma_f32_16x16x4_f32 v[48:51], v69, v75, v[48:51]
    v_mfma_f32_16x16x4_f32 v[52:55], v71, v77, v[52:55]
    v_mfma_f32_16x16x4_f32 v[56:59], v71, v79, v[56:59]
    v_mfma_f32_16x16x4_f32 v[60:63], v73, v81, v[60:63]
    v_mov_b32_dpp v64, v24 row_newbcast:3 row_mask:0xf bank_mask:0xf
    v_mov_b32_dpp v65, v25 row_newbcast:3 row_mask:0xf bank_mask:0xf
    v_mov_b32_dpp v66, v26 row_newbcast:3 row_mask:0xf bank_mask:0xf
    v_mov_b32_dpp v67, v27 row_newbcast:3 row_mask:0xf bank_mask:0xf
    v_mul_f32 v82, v64, v47
    v_mul_f32 v83, v65, v47
    v_exp_f32 v82, v82
    v_fract_f32 v83, v83
    v_cos_f32 v74, v83
    v_sin_f32 v75, v83
    v_mul_f32 v74, v74, v82
    v_mul_f32 v75, v75, v82
    v_mul_f32 v84, v75, v75
    v_add_f32 v85, v74, v74
    v_fma_f32 v76, v74, v74, -v84
    v_mul_f32 v77, v85, v75
    v_mul_f32 v84, v77, v77
    v_add_f32 v85, v76, v76
    v_fma_f32 v78, v76, v76, -v84
    v_mul_f32 v79, v85, v77
    v_mul_f32 v84, v79, v79
    v_add_f32 v85, v78, v78
    v_fma_f32 v80, v78, v78, -v84
    v_mul_f32 v81, v85, v79
    v_mul_f32 v82, v64, v44
    v_mul_f32 v83, v65, v44
    v_exp_f32 v82, v82
    v_fract_f32 v83, v83
    v_cos_f32 v68, v83
    v_sin_f32 v69, v83
    v_mul_f32 v68, v68, v82
    v_mul_f32 v69, v69, v82
    v_mul_f32 v84, v67, v69
    v_mul_f32 v85, v67, v68
    v_fma_f32 v68, v66, v68, -v84
    v_fma_f32 v69, -v66, v69, -v85
    v_mul_f32 v82, v64, v45
    v_mul_f32 v83, v65, v45
    v_exp_f32 v82, v82
    v_fract_f32 v83, v83
    v_cos_f32 v70, v83
    v_sin_f32 v71, v83
    v_mul_f32 v70, v70, v82
    v_mul_f32 v71, v71, v82
    v_mul_f32 v84, v67, v71
    v_mul_f32 v85, v67, v70
    v_fma_f32 v70, v66, v70, -v84
    v_fma_f32 v71, -v66, v71, -v85
    v_mul_f32 v82, v64, v46
    v_mul_f32 v83, v65, v46
    v_exp_f32 v82, v82
    v_fract_f32 v83, v83
    v_cos_f32 v72, v83
    v_sin_f32 v73, v83
    v_mul_f32 v72, v72, v82
    v_mul_f32 v73, v73, v82
    v_mul_f32 v84, v67, v73
    v_mul_f32 v85, v67, v72
    v_fma_f32 v72, v66, v72, -v84
    v_fma_f32 v73, -v66, v73, -v85
    v_mfma_f32_16x16x4_f32 v[48:51], v68, v74, v[48:51]
    v_mfma_f32_16x16x4_f32 v[52:55], v70, v76, v[52:55]
    v_mfma_f32_16x16x4_f32 v[56:59], v70, v78, v[56:59]
    v_mfma_f32_16x16x4_f32 v[60:63], v72, v80, v[60:63]
    v_mfma_f32_16x16x4_f32 v[48:51], v69, v75, v[48:51]
    v_mfma_f32_16x16x4_f32 v[52:55], v71, v77, v[52:55]
    v_mfma_f32_16x16x4_f32 v[56:59], v71, v79, v[56:59]
    v_mfma_f32_16x16x4_f32 v[60:63], v73, v81, v[60:63]
    v_mov_b32_dpp v64, v24 row_newbcast:4 row_mask:0xf bank_mask:0xf
    v_mov_b32_dpp v65, v25 row_newbcast:4 row_mask:0xf bank_mask:0xf
    v_mov_b32_dpp v66, v26 row_newbcast:4 row_mask:0xf bank_mask:0xf
    v_mov_b32_dpp v67, v27 row_newbcast:4 row_mask:0xf bank_mask:0xf
    v_mul_f32 v82, v64, v47
    v_mul_f32 v83, v65, v47
    v_exp_f32 v82, v82
    v_fract_f32 v83, v83
    v_cos_f32 v74, v83
    v_sin_f32 v75, v83
    v_mul_f32 v74, v74, v82
    v_mul_f32 v75, v75, v82
    v_mul_f32 v84, v75, v75
    v_add_f32 v85, v74, v74
    v_fma_f32 v76, v74, v74, -v84
    v_mul_f32 v77, v85, v75
    v_mul_f32 v84, v77, v77
    v_add_f32 v85, v76, v76
    v_fma_f32 v78, v76, v76, -v84
    v_mul_f32 v79, v85, v77
    v_mul_f32 v84, v79, v79
    v_add_f32 v85, v78, v78
    v_fma_f32 v80, v78, v78, -v84
    v_mul_f32 v81, v85, v79
    v_mul_f32 v82, v64, v44
    v_mul_f32 v83, v65, v44
    v_exp_f32 v82, v82
    v_fract_f32 v83, v83
    v_cos_f32 v68, v83
    v_sin_f32 v69, v83
    v_mul_f32 v68, v68, v82
    v_mul_f32 v69, v69, v82
    v_mul_f32 v84, v67, v69
    v_mul_f32 v85, v67, v68
    v_fma_f32 v68, v66, v68, -v84
    v_fma_f32 v69, -v66, v69, -v85
    v_mul_f32 v82, v64, v45
    v_mul_f32 v83, v65, v45
    v_exp_f32 v82, v82
    v_fract_f32 v83, v83
    v_cos_f32 v70, v83
    v_sin_f32 v71, v83
    v_mul_f32 v70, v70, v82
    v_mul_f32 v71, v71, v82
    v_mul_f32 v84, v67, v71
    v_mul_f32 v85, v67, v70
    v_fma_f32 v70, v66, v70, -v84
    v_fma_f32 v71, -v66, v71, -v85
    v_mul_f32 v82, v64, v46
    v_mul_f32 v83, v65, v46
    v_exp_f32 v82, v82
    v_fract_f32 v83, v83
    v_cos_f32 v72, v83
    v_sin_f32 v73, v83
    v_mul_f32 v72, v72, v82
    v_mul_f32 v73, v73, v82
    v_mul_f32 v84, v67, v73
    v_mul_f32 v85, v67, v72
    v_fma_f32 v72, v66, v72, -v84
    v_fma_f32 v73, -v66, v73, -v85
    v_mfma_f32_16x16x4_f32 v[48:51], v68, v74, v[48:51]
    v_mfma_f32_16x16x4_f32 v[52:55], v70, v76, v[52:55]
    v_mfma_f32_16x16x4_f32 v[56:59], v70, v78, v[56:59]
    v_mfma_f32_16x16x4_f32 v[60:63], v72, v80, v[60:63]
    v_mfma_f32_16x16x4_f32 v[48:51], v69, v75, v[48:51]
    v_mfma_f32_16x16x4_f32 v[52:55], v71, v77, v[52:55]
    v_mfma_f32_16x16x4_f32 v[56:59], v71, v79, v[56:59]
    v_mfma_f32_16x16x4_f32 v[60:63], v73, v81, v[60:63]
    v_mov_b32_dpp v64, v24 row_newbcast:5 row_mask:0xf bank_mask:0xf
    v_mov_b32_dpp v65, v25 row_newbcast:5 row_mask:0xf bank_mask:0xf
    v_mov_b32_dpp v66, v26 row_newbcast:5 row_mask:0xf bank_mask:0xf
    v_mov_b32_dpp v67, v27 row_newbcast:5 row_mask:0xf bank_mask:0xf
    v_mul_f32 v82, v64, v47
    v_mul_f32 v83, v65, v47
    v_exp_f32 v82, v82
    v_fract_f32 v83, v83
    v_cos_f32 v74, v83
    v_sin_f32 v75, v83
    v_mul_f32 v74, v74, v82
    v_mul_f32 v75, v75, v82
    v_mul_f32 v84, v75, v75
    v_add_f32 v85, v74, v74
    v_fma_f32 v76, v74, v74, -v84
    v_mul_f32 v77, v85, v75
    v_mul_f32 v84, v77, v77
    v_add_f32 v85, v76, v76
    v_fma_f32 v78, v76, v76, -v84
    v_mul_f32 v79, v85, v77
    v_mul_f32 v84, v79, v79
    v_add_f32 v85, v78, v78
    v_fma_f32 v80, v78, v78, -v84
    v_mul_f32 v81, v85, v79
    v_mul_f32 v82, v64, v44
    v_mul_f32 v83, v65, v44
    v_exp_f32 v82, v82
    v_fract_f32 v83, v83
    v_cos_f32 v68, v83
    v_sin_f32 v69, v83
    v_mul_f32 v68, v68, v82
    v_mul_f32 v69, v69, v82
    v_mul_f32 v84, v67, v69
    v_mul_f32 v85, v67, v68
    v_fma_f32 v68, v66, v68, -v84
    v_fma_f32 v69, -v66, v69, -v85
    v_mul_f32 v82, v64, v45
    v_mul_f32 v83, v65, v45
    v_exp_f32 v82, v82
    v_fract_f32 v83, v83
    v_cos_f32 v70, v83
    v_sin_f32 v71, v83
    v_mul_f32 v70, v70, v82
    v_mul_f32 v71, v71, v82
    v_mul_f32 v84, v67, v71
    v_mul_f32 v85, v67, v70
    v_fma_f32 v70, v66, v70, -v84
    v_fma_f32 v71, -v66, v71, -v85
    v_mul_f32 v82, v64, v46
    v_mul_f32 v83, v65, v46
    v_exp_f32 v82, v82
    v_fract_f32 v83, v83
    v_cos_f32 v72, v83
    v_sin_f32 v73, v83
    v_mul_f32 v72, v72, v82
    v_mul_f32 v73, v73, v82
    v_mul_f32 v84, v67, v73
    v_mul_f32 v85, v67, v72
    v_fma_f32 v72, v66, v72, -v84
    v_fma_f32 v73, -v66, v73, -v85
    v_mfma_f32_16x16x4_f32 v[48:51], v68, v74, v[48:51]
    v_mfma_f32_16x16x4_f32 v[52:55], v70, v76, v[52:55]
    v_mfma_f32_16x16x4_f32 v[56:59], v70, v78, v[56:59]
    v_mfma_f32_16x16x4_f32 v[60:63], v72, v80, v[60:63]
    v_mfma_f32_16x16x4_f32 v[48:51], v69, v75, v[48:51]
    v_mfma_f32_16x16x4_f32 v[52:55], v71, v77, v[52:55]
    v_mfma_f32_16x16x4_f32 v[56:59], v71, v79, v[56:59]
    v_mfma_f32_16x16x4_f32 v[60:63], v73, v81, v[60:63]
    v_mov_b32_dpp v64, v24 row_newbcast:6 row_mask:0xf bank_mask:0xf
    v_mov_b32_dpp v65, v25 row_newbcast:6 row_mask:0xf bank_mask:0xf
    v_mov_b32_dpp v66, v26 row_newbcast:6 row_mask:0xf bank_mask:0xf
    v_mov_b32_dpp v67, v27 row_newbcast:6 row_mask:0xf bank_mask:0xf
    v_mul_f32 v82, v64, v47
    v_mul_f32 v83, v65, v47
    v_exp_f32 v82, v82
    v_fract_f32 v83, v83
    v_cos_f32 v74, v83
    v_sin_f32 v75, v83
    v_mul_f32 v74, v74, v82
    v_mul_f32 v75, v75, v82
    v_mul_f32 v84, v75, v75
    v_add_f32 v85, v74, v74
    v_fma_f32 v76, v74, v74, -v84
    v_mul_f32 v77, v85, v75
    v_mul_f32 v84, v77, v77
    v_add_f32 v85, v76, v76
    v_fma_f32 v78, v76, v76, -v84
    v_mul_f32 v79, v85, v77
    v_mul_f32 v84, v79, v79
    v_add_f32 v85, v78, v78
    v_fma_f32 v80, v78, v78, -v84
    v_mul_f32 v81, v85, v79
    v_mul_f32 v82, v64, v44
    v_mul_f32 v83, v65, v44
    v_exp_f32 v82, v82
    v_fract_f32 v83, v83
    v_cos_f32 v68, v83
    v_sin_f32 v69, v83
    v_mul_f32 v68, v68, v82
    v_mul_f32 v69, v69, v82
    v_mul_f32 v84, v67, v69
    v_mul_f32 v85, v67, v68
    v_fma_f32 v68, v66, v68, -v84
    v_fma_f32 v69, -v66, v69, -v85
    v_mul_f32 v82, v64, v45
    v_mul_f32 v83, v65, v45
    v_exp_f32 v82, v82
    v_fract_f32 v83, v83
    v_cos_f32 v70, v83
    v_sin_f32 v71, v83
    v_mul_f32 v70, v70, v82
    v_mul_f32 v71, v71, v82
    v_mul_f32 v84, v67, v71
    v_mul_f32 v85, v67, v70
    v_fma_f32 v70, v66, v70, -v84
    v_fma_f32 v71, -v66, v71, -v85
    v_mul_f32 v82, v64, v46
    v_mul_f32 v83, v65, v46
    v_exp_f32 v82, v82
    v_fract_f32 v83, v83
    v_cos_f32 v72, v83
    v_sin_f32 v73, v83
    v_mul_f32 v72, v72, v82
    v_mul_f32 v73, v73, v82
    v_mul_f32 v84, v67, v73
    v_mul_f32 v85, v67, v72
    v_fma_f32 v72, v66, v72, -v84
    v_fma_f32 v73, -v66, v73, -v85
    v_mfma_f32_16x16x4_f32 v[48:51], v68, v74, v[48:51]
    v_mfma_f32_16x16x4_f32 v[52:55], v70, v76, v[52:55]
    v_mfma_f32_16x16x4_f32 v[56:59], v70, v78, v[56:59]
    v_mfma_f32_16x16x4_f32 v[60:63], v72, v80, v[60:63]
    v_mfma_f32_16x16x4_f32 v[48:51], v69, v75, v[48:51]
    v_mfma_f32_16x16x4_f32 v[52:55], v71, v77, v[52:55]
    v_mfma_f32_16x16x4_f32 v[56:59], v71, v79, v[56:59]
    v_mfma_f32_16x16x4_f32 v[60:63], v73, v81, v[60:63]
    v_mov_b32_dpp v64, v24 row_newbcast:7 row_mask:0xf bank_mask:0xf
    v_mov_b32_dpp v65, v25 row_newbcast:7 row_mask:0xf bank_mask:0xf
    v_mov_b32_dpp v66, v26 row_newbcast:7 row_mask:0xf bank_mask:0xf
    v_mov_b32_dpp v67, v27 row_newbcast:7 row_mask:0xf bank_mask:0xf
    v_mul_f32 v82, v64, v47
    v_mul_f32 v83, v65, v47
    v_exp_f32 v82, v82
    v_fract_f32 v83, v83
    v_cos_f32 v74, v83
    v_sin_f32 v75, v83
    v_mul_f32 v74, v74, v82
    v_mul_f32 v75, v75, v82
    v_mul_f32 v84, v75, v75
    v_add_f32 v85, v74, v74
    v_fma_f32 v76, v74, v74, -v84
    v_mul_f32 v77, v85, v75
    v_mul_f32 v84, v77, v77
    v_add_f32 v85, v76, v76
    v_fma_f32 v78, v76, v76, -v84
    v_mul_f32 v79, v85, v77
    v_mul_f32 v84, v79, v79
    v_add_f32 v85, v78, v78
    v_fma_f32 v80, v78, v78, -v84
    v_mul_f32 v81, v85, v79
    v_mul_f32 v82, v64, v44
    v_mul_f32 v83, v65, v44
    v_exp_f32 v82, v82
    v_fract_f32 v83, v83
    v_cos_f32 v68, v83
    v_sin_f32 v69, v83
    v_mul_f32 v68, v68, v82
    v_mul_f32 v69, v69, v82
    v_mul_f32 v84, v67, v69
    v_mul_f32 v85, v67, v68
    v_fma_f32 v68, v66, v68, -v84
    v_fma_f32 v69, -v66, v69, -v85
    v_mul_f32 v82, v64, v45
    v_mul_f32 v83, v65, v45
    v_exp_f32 v82, v82
    v_fract_f32 v83, v83
    v_cos_f32 v70, v83
    v_sin_f32 v71, v83
    v_mul_f32 v70, v70, v82
    v_mul_f32 v71, v71, v82
    v_mul_f32 v84, v67, v71
    v_mul_f32 v85, v67, v70
    v_fma_f32 v70, v66, v70, -v84
    v_fma_f32 v71, -v66, v71, -v85
    v_mul_f32 v82, v64, v46
    v_mul_f32 v83, v65, v46
    v_exp_f32 v82, v82
    v_fract_f32 v83, v83
    v_cos_f32 v72, v83
    v_sin_f32 v73, v83
    v_mul_f32 v72, v72, v82
    v_mul_f32 v73, v73, v82
    v_mul_f32 v84, v67, v73
    v_mul_f32 v85, v67, v72
    v_fma_f32 v72, v66, v72, -v84
    v_fma_f32 v73, -v66, v73, -v85
    v_mfma_f32_16x16x4_f32 v[48:51], v68, v74, v[48:51]
    v_mfma_f32_16x16x4_f32 v[52:55], v70, v76, v[52:55]
    v_mfma_f32_16x16x4_f32 v[56:59], v70, v78, v[56:59]
    v_mfma_f32_16x16x4_f32 v[60:63], v72, v80, v[60:63]
    v_mfma_f32_16x16x4_f32 v[48:51], v69, v75, v[48:51]
    v_mfma_f32_16x16x4_f32 v[52:55], v71, v77, v[52:55]
    v_mfma_f32_16x16x4_f32 v[56:59], v71, v79, v[56:59]
    v_mfma_f32_16x16x4_f32 v[60:63], v73, v81, v[60:63]
    v_mov_b32_dpp v64, v24 row_newbcast:8 row_mask:0xf bank_mask:0xf
    v_mov_b32_dpp v65, v25 row_newbcast:8 row_mask:0xf bank_mask:0xf
    v_mov_b32_dpp v66, v26 row_newbcast:8 row_mask:0xf bank_mask:0xf
    v_mov_b32_dpp v67, v27 row_newbcast:8 row_mask:0xf bank_mask:0xf
    v_mul_f32 v82, v64, v47
    v_mul_f32 v83, v65, v47
    v_exp_f32 v82, v82
    v_fract_f32 v83, v83
    v_cos_f32 v74, v83
    v_sin_f32 v75, v83
    v_mul_f32 v74, v74, v82
    v_mul_f32 v75, v75, v82
    v_mul_f32 v84, v75, v75
    v_add_f32 v85, v74, v74
    v_fma_f32 v76, v74, v74, -v84
    v_mul_f32 v77, v85, v75
    v_mul_f32 v84, v77, v77
    v_add_f32 v85, v76, v76
    v_fma_f32 v78, v76, v76, -v84
    v_mul_f32 v79, v85, v77
    v_mul_f32 v84, v79, v79
    v_add_f32 v85, v78, v78
    v_fma_f32 v80, v78, v78, -v84
    v_mul_f32 v81, v85, v79
    v_mul_f32 v82, v64, v44
    v_mul_f32 v83, v65, v44
    v_exp_f32 v82, v82
    v_fract_f32 v83, v83
    v_cos_f32 v68, v83
    v_sin_f32 v69, v83
    v_mul_f32 v68, v68, v82
    v_mul_f32 v69, v69, v82
    v_mul_f32 v84, v67, v69
    v_mul_f32 v85, v67, v68
    v_fma_f32 v68, v66, v68, -v84
    v_fma_f32 v69, -v66, v69, -v85
    v_mul_f32 v82, v64, v45
    v_mul_f32 v83, v65, v45
    v_exp_f32 v82, v82
    v_fract_f32 v83, v83
    v_cos_f32 v70, v83
    v_sin_f32 v71, v83
    v_mul_f32 v70, v70, v82
    v_mul_f32 v71, v71, v82
    v_mul_f32 v84, v67, v71
    v_mul_f32 v85, v67, v70
    v_fma_f32 v70, v66, v70, -v84
    v_fma_f32 v71, -v66, v71, -v85
    v_mul_f32 v82, v64, v46
    v_mul_f32 v83, v65, v46
    v_exp_f32 v82, v82
    v_fract_f32 v83, v83
    v_cos_f32 v72, v83
    v_sin_f32 v73, v83
    v_mul_f32 v72, v72, v82
    v_mul_f32 v73, v73, v82
    v_mul_f32 v84, v67, v73
    v_mul_f32 v85, v67, v72
    v_fma_f32 v72, v66, v72, -v84
    v_fma_f32 v73, -v66, v73, -v85
    v_mfma_f32_16x16x4_f32 v[48:51], v68, v74, v[48:51]
    v_mfma_f32_16x16x4_f32 v[52:55], v70, v76, v[52:55]
    v_mfma_f32_16x16x4_f32 v[56:59], v70, v78, v[56:59]
    v_mfma_f32_16x16x4_f32 v[60:63], v72, v80, v[60:63]
    v_mfma_f32_16x16x4_f32 v[48:51], v69, v75, v[48:51]
    v_mfma_f32_16x16x4_f32 v[52:55], v71, v77, v[52:55]
    v_mfma_f32_16x16x4_f32 v[56:59], v71, v79, v[56:59]
    v_mfma_f32_16x16x4_f32 v[60:63], v73, v81, v[60:63]
    v_mov_b32_dpp v64, v24 row_newbcast:9 row_mask:0xf bank_mask:0xf
    v_mov_b32_dpp v65, v25 row_newbcast:9 row_mask:0xf bank_mask:0xf
    v_mov_b32_dpp v66, v26 row_newbcast:9 row_mask:0xf bank_mask:0xf
    v_mov_b32_dpp v67, v27 row_newbcast:9 row_mask:0xf bank_mask:0xf
    v_mul_f32 v82, v64, v47
    v_mul_f32 v83, v65, v47
    v_exp_f32 v82, v82
    v_fract_f32 v83, v83
    v_cos_f32 v74, v83
    v_sin_f32 v75, v83
    v_mul_f32 v74, v74, v82
    v_mul_f32 v75, v75, v82
    v_mul_f32 v84, v75, v75
    v_add_f32 v85, v74, v74
    v_fma_f32 v76, v74, v74, -v84
    v_mul_f32 v77, v85, v75
    v_mul_f32 v84, v77, v77
    v_add_f32 v85, v76, v76
    v_fma_f32 v78, v76, v76, -v84
    v_mul_f32 v79, v85, v77
    v_mul_f32 v84, v79, v79
    v_add_f32 v85, v78, v78
    v_fma_f32 v80, v78, v78, -v84
    v_mul_f32 v81, v85, v79
    v_mul_f32 v82, v64, v44
    v_mul_f32 v83, v65, v44
    v_exp_f32 v82, v82
    v_fract_f32 v83, v83
    v_cos_f32 v68, v83
    v_sin_f32 v69, v83
    v_mul_f32 v68, v68, v82
    v_mul_f32 v69, v69, v82
    v_mul_f32 v84, v67, v69
    v_mul_f32 v85, v67, v68
    v_fma_f32 v68, v66, v68, -v84
    v_fma_f32 v69, -v66, v69, -v85
    v_mul_f32 v82, v64, v45
    v_mul_f32 v83, v65, v45
    v_exp_f32 v82, v82
    v_fract_f32 v83, v83
    v_cos_f32 v70, v83
    v_sin_f32 v71, v83
    v_mul_f32 v70, v70, v82
    v_mul_f32 v71, v71, v82
    v_mul_f32 v84, v67, v71
    v_mul_f32 v85, v67, v70
    v_fma_f32 v70, v66, v70, -v84
    v_fma_f32 v71, -v66, v71, -v85
    v_mul_f32 v82, v64, v46
    v_mul_f32 v83, v65, v46
    v_exp_f32 v82, v82
    v_fract_f32 v83, v83
    v_cos_f32 v72, v83
    v_sin_f32 v73, v83
    v_mul_f32 v72, v72, v82
    v_mul_f32 v73, v73, v82
    v_mul_f32 v84, v67, v73
    v_mul_f32 v85, v67, v72
    v_fma_f32 v72, v66, v72, -v84
    v_fma_f32 v73, -v66, v73, -v85
    v_mfma_f32_16x16x4_f32 v[48:51], v68, v74, v[48:51]
    v_mfma_f32_16x16x4_f32 v[52:55], v70, v76, v[52:55]
    v_mfma_f32_16x16x4_f32 v[56:59], v70, v78, v[56:59]
    v_mfma_f32_16x16x4_f32 v[60:63], v72, v80, v[60:63]
    v_mfma_f32_16x16x4_f32 v[48:51], v69, v75, v[48:51]
    v_mfma_f32_16x16x4_f32 v[52:55], v71, v77, v[52:55]
    v_mfma_f32_16x16x4_f32 v[56:59], v71, v79, v[56:59]
    v_mfma_f32_16x16x4_f32 v[60:63], v73, v81, v[60:63]
    v_mov_b32_dpp v64, v24 row_newbcast:10 row_mask:0xf bank_mask:0xf
    v_mov_b32_dpp v65, v25 row_newbcast:10 row_mask:0xf bank_mask:0xf
    v_mov_b32_dpp v66, v26 row_newbcast:10 row_mask:0xf bank_mask:0xf
    v_mov_b32_dpp v67, v27 row_newbcast:10 row_mask:0xf bank_mask:0xf
    v_mul_f32 v82, v64, v47
    v_mul_f32 v83, v65, v47
    v_exp_f32 v82, v82
    v_fract_f32 v83, v83
    v_cos_f32 v74, v83
    v_sin_f32 v75, v83
    v_mul_f32 v74, v74, v82
    v_mul_f32 v75, v75, v82
    v_mul_f32 v84, v75, v75
    v_add_f32 v85, v74, v74
    v_fma_f32 v76, v74, v74, -v84
    v_mul_f32 v77, v85, v75
    v_mul_f32 v84, v77, v77
    v_add_f32 v85, v76, v76
    v_fma_f32 v78, v76, v76, -v84
    v_mul_f32 v79, v85, v77
    v_mul_f32 v84, v79, v79
    v_add_f32 v85, v78, v78
    v_fma_f32 v80, v78, v78, -v84
    v_mul_f32 v81, v85, v79
    v_mul_f32 v82, v64, v44
    v_mul_f32 v83, v65, v44
    v_exp_f32 v82, v82
    v_fract_f32 v83, v83
    v_cos_f32 v68, v83
    v_sin_f32 v69, v83
    v_mul_f32 v68, v68, v82
    v_mul_f32 v69, v69, v82
    v_mul_f32 v84, v67, v69
    v_mul_f32 v85, v67, v68
    v_fma_f32 v68, v66, v68, -v84
    v_fma_f32 v69, -v66, v69, -v85
    v_mul_f32 v82, v64, v45
    v_mul_f32 v83, v65, v45
    v_exp_f32 v82, v82
    v_fract_f32 v83, v83
    v_cos_f32 v70, v83
    v_sin_f32 v71, v83
    v_mul_f32 v70, v70, v82
    v_mul_f32 v71, v71, v82
    v_mul_f32 v84, v67, v71
    v_mul_f32 v85, v67, v70
    v_fma_f32 v70, v66, v70, -v84
    v_fma_f32 v71, -v66, v71, -v85
    v_mul_f32 v82, v64, v46
    v_mul_f32 v83, v65, v46
    v_exp_f32 v82, v82
    v_fract_f32 v83, v83
    v_cos_f32 v72, v83
    v_sin_f32 v73, v83
    v_mul_f32 v72, v72, v82
    v_mul_f32 v73, v73, v82
    v_mul_f32 v84, v67, v73
    v_mul_f32 v85, v67, v72
    v_fma_f32 v72, v66, v72, -v84
    v_fma_f32 v73, -v66, v73, -v85
    v_mfma_f32_16x16x4_f32 v[48:51], v68, v74, v[48:51]
    v_mfma_f32_16x16x4_f32 v[52:55], v70, v76, v[52:55]
    v_mfma_f32_16x16x4_f32 v[56:59], v70, v78, v[56:59]
    v_mfma_f32_16x16x4_f32 v[60:63], v72, v80, v[60:63]
    v_mfma_f32_16x16x4_f32 v[48:51], v69, v75, v[48:51]
    v_mfma_f32_16x16x4_f32 v[52:55], v71, v77, v[52:55]
    v_mfma_f32_16x16x4_f32 v[56:59], v71, v79, v[56:59]
    v_mfma_f32_16x16x4_f32 v[60:63], v73, v81, v[60:63]
    v_mov_b32_dpp v64, v24 row_newbcast:11 row_mask:0xf bank_mask:0xf
    v_mov_b32_dpp v65, v25 row_newbcast:11 row_mask:0xf bank_mask:0xf
    v_mov_b32_dpp v66, v26 row_newbcast:11 row_mask:0xf bank_mask:0xf
    v_mov_b32_dpp v67, v27 row_newbcast:11 row_mask:0xf bank_mask:0xf
    v_mul_f32 v82, v64, v47
    v_mul_f32 v83, v65, v47
    v_exp_f32 v82, v82
    v_fract_f32 v83, v83
    v_cos_f32 v74, v83
    v_sin_f32 v75, v83
    v_mul_f32 v74, v74, v82
    v_mul_f32 v75, v75, v82
    v_mul_f32 v84, v75, v75
    v_add_f32 v85, v74, v74
    v_fma_f32 v76, v74, v74, -v84
    v_mul_f32 v77, v85, v75
    v_mul_f32 v84, v77, v77
    v_add_f32 v85, v76, v76
    v_fma_f32 v78, v76, v76, -v84
    v_mul_f32 v79, v85, v77
    v_mul_f32 v84, v79, v79
    v_add_f32 v85, v78, v78
    v_fma_f32 v80, v78, v78, -v84
    v_mul_f32 v81, v85, v79
    v_mul_f32 v82, v64, v44
    v_mul_f32 v83, v65, v44
    v_exp_f32 v82, v82
    v_fract_f32 v83, v83
    v_cos_f32 v68, v83
    v_sin_f32 v69, v83
    v_mul_f32 v68, v68, v82
    v_mul_f32 v69, v69, v82
    v_mul_f32 v84, v67, v69
    v_mul_f32 v85, v67, v68
    v_fma_f32 v68, v66, v68, -v84
    v_fma_f32 v69, -v66, v69, -v85
    v_mul_f32 v82, v64, v45
    v_mul_f32 v83, v65, v45
    v_exp_f32 v82, v82
    v_fract_f32 v83, v83
    v_cos_f32 v70, v83
    v_sin_f32 v71, v83
    v_mul_f32 v70, v70, v82
    v_mul_f32 v71, v71, v82
    v_mul_f32 v84, v67, v71
    v_mul_f32 v85, v67, v70
    v_fma_f32 v70, v66, v70, -v84
    v_fma_f32 v71, -v66, v71, -v85
    v_mul_f32 v82, v64, v46
    v_mul_f32 v83, v65, v46
    v_exp_f32 v82, v82
    v_fract_f32 v83, v83
    v_cos_f32 v72, v83
    v_sin_f32 v73, v83
    v_mul_f32 v72, v72, v82
    v_mul_f32 v73, v73, v82
    v_mul_f32 v84, v67, v73
    v_mul_f32 v85, v67, v72
    v_fma_f32 v72, v66, v72, -v84
    v_fma_f32 v73, -v66, v73, -v85
    v_mfma_f32_16x16x4_f32 v[48:51], v68, v74, v[48:51]
    v_mfma_f32_16x16x4_f32 v[52:55], v70, v76, v[52:55]
    v_mfma_f32_16x16x4_f32 v[56:59], v70, v78, v[56:59]
    v_mfma_f32_16x16x4_f32 v[60:63], v72, v80, v[60:63]
    v_mfma_f32_16x16x4_f32 v[48:51], v69, v75, v[48:51]
    v_mfma_f32_16x16x4_f32 v[52:55], v71, v77, v[52:55]
    v_mfma_f32_16x16x4_f32 v[56:59], v71, v79, v[56:59]
    v_mfma_f32_16x16x4_f32 v[60:63], v73, v81, v[60:63]
    v_mov_b32_dpp v64, v24 row_newbcast:12 row_mask:0xf bank_mask:0xf
    v_mov_b32_dpp v65, v25 row_newbcast:12 row_mask:0xf bank_mask:0xf
    v_mov_b32_dpp v66, v26 row_newbcast:12 row_mask:0xf bank_mask:0xf
    v_mov_b32_dpp v67, v27 row_newbcast:12 row_mask:0xf bank_mask:0xf
    v_mul_f32 v82, v64, v47
    v_mul_f32 v83, v65, v47
    v_exp_f32 v82, v82
    v_fract_f32 v83, v83
    v_cos_f32 v74, v83
    v_sin_f32 v75, v83
    v_mul_f32 v74, v74, v82
    v_mul_f32 v75, v75, v82
    v_mul_f32 v84, v75, v75
    v_add_f32 v85, v74, v74
    v_fma_f32 v76, v74, v74, -v84
    v_mul_f32 v77, v85, v75
    v_mul_f32 v84, v77, v77
    v_add_f32 v85, v76, v76
    v_fma_f32 v78, v76, v76, -v84
    v_mul_f32 v79, v85, v77
    v_mul_f32 v84, v79, v79
    v_add_f32 v85, v78, v78
    v_fma_f32 v80, v78, v78, -v84
    v_mul_f32 v81, v85, v79
    v_mul_f32 v82, v64, v44
    v_mul_f32 v83, v65, v44
    v_exp_f32 v82, v82
    v_fract_f32 v83, v83
    v_cos_f32 v68, v83
    v_sin_f32 v69, v83
    v_mul_f32 v68, v68, v82
    v_mul_f32 v69, v69, v82
    v_mul_f32 v84, v67, v69
    v_mul_f32 v85, v67, v68
    v_fma_f32 v68, v66, v68, -v84
    v_fma_f32 v69, -v66, v69, -v85
    v_mul_f32 v82, v64, v45
    v_mul_f32 v83, v65, v45
    v_exp_f32 v82, v82
    v_fract_f32 v83, v83
    v_cos_f32 v70, v83
    v_sin_f32 v71, v83
    v_mul_f32 v70, v70, v82
    v_mul_f32 v71, v71, v82
    v_mul_f32 v84, v67, v71
    v_mul_f32 v85, v67, v70
    v_fma_f32 v70, v66, v70, -v84
    v_fma_f32 v71, -v66, v71, -v85
    v_mul_f32 v82, v64, v46
    v_mul_f32 v83, v65, v46
    v_exp_f32 v82, v82
    v_fract_f32 v83, v83
    v_cos_f32 v72, v83
    v_sin_f32 v73, v83
    v_mul_f32 v72, v72, v82
    v_mul_f32 v73, v73, v82
    v_mul_f32 v84, v67, v73
    v_mul_f32 v85, v67, v72
    v_fma_f32 v72, v66, v72, -v84
    v_fma_f32 v73, -v66, v73, -v85
    v_mfma_f32_16x16x4_f32 v[48:51], v68, v74, v[48:51]
    v_mfma_f32_16x16x4_f32 v[52:55], v70, v76, v[52:55]
    v_mfma_f32_16x16x4_f32 v[56:59], v70, v78, v[56:59]
    v_mfma_f32_16x16x4_f32 v[60:63], v72, v80, v[60:63]
    v_mfma_f32_16x16x4_f32 v[48:51], v69, v75, v[48:51]
    v_mfma_f32_16x16x4_f32 v[52:55], v71, v77, v[52:55]
    v_mfma_f32_16x16x4_f32 v[56:59], v71, v79, v[56:59]
    v_mfma_f32_16x16x4_f32 v[60:63], v73, v81, v[60:63]
    v_mov_b32_dpp v64, v24 row_newbcast:13 row_mask:0xf bank_mask:0xf
    v_mov_b32_dpp v65, v25 row_newbcast:13 row_mask:0xf bank_mask:0xf
    v_mov_b32_dpp v66, v26 row_newbcast:13 row_mask:0xf bank_mask:0xf
    v_mov_b32_dpp v67, v27 row_newbcast:13 row_mask:0xf bank_mask:0xf
    v_mul_f32 v82, v64, v47
    v_mul_f32 v83, v65, v47
    v_exp_f32 v82, v82
    v_fract_f32 v83, v83
    v_cos_f32 v74, v83
    v_sin_f32 v75, v83
    v_mul_f32 v74, v74, v82
    v_mul_f32 v75, v75, v82
    v_mul_f32 v84, v75, v75
    v_add_f32 v85, v74, v74
    v_fma_f32 v76, v74, v74, -v84
    v_mul_f32 v77, v85, v75
    v_mul_f32 v84, v77, v77
    v_add_f32 v85, v76, v76
    v_fma_f32 v78, v76, v76, -v84
    v_mul_f32 v79, v85, v77
    v_mul_f32 v84, v79, v79
    v_add_f32 v85, v78, v78
    v_fma_f32 v80, v78, v78, -v84
    v_mul_f32 v81, v85, v79
    v_mul_f32 v82, v64, v44
    v_mul_f32 v83, v65, v44
    v_exp_f32 v82, v82
    v_fract_f32 v83, v83
    v_cos_f32 v68, v83
    v_sin_f32 v69, v83
    v_mul_f32 v68, v68, v82
    v_mul_f32 v69, v69, v82
    v_mul_f32 v84, v67, v69
    v_mul_f32 v85, v67, v68
    v_fma_f32 v68, v66, v68, -v84
    v_fma_f32 v69, -v66, v69, -v85
    v_mul_f32 v82, v64, v45
    v_mul_f32 v83, v65, v45
    v_exp_f32 v82, v82
    v_fract_f32 v83, v83
    v_cos_f32 v70, v83
    v_sin_f32 v71, v83
    v_mul_f32 v70, v70, v82
    v_mul_f32 v71, v71, v82
    v_mul_f32 v84, v67, v71
    v_mul_f32 v85, v67, v70
    v_fma_f32 v70, v66, v70, -v84
    v_fma_f32 v71, -v66, v71, -v85
    v_mul_f32 v82, v64, v46
    v_mul_f32 v83, v65, v46
    v_exp_f32 v82, v82
    v_fract_f32 v83, v83
    v_cos_f32 v72, v83
    v_sin_f32 v73, v83
    v_mul_f32 v72, v72, v82
    v_mul_f32 v73, v73, v82
    v_mul_f32 v84, v67, v73
    v_mul_f32 v85, v67, v72
    v_fma_f32 v72, v66, v72, -v84
    v_fma_f32 v73, -v66, v73, -v85
    v_mfma_f32_16x16x4_f32 v[48:51], v68, v74, v[48:51]
    v_mfma_f32_16x16x4_f32 v[52:55], v70, v76, v[52:55]
    v_mfma_f32_16x16x4_f32 v[56:59], v70, v78, v[56:59]
    v_mfma_f32_16x16x4_f32 v[60:63], v72, v80, v[60:63]
    v_mfma_f32_16x16x4_f32 v[48:51], v69, v75, v[48:51]
    v_mfma_f32_16x16x4_f32 v[52:55], v71, v77, v[52:55]
    v_mfma_f32_16x16x4_f32 v[56:59], v71, v79, v[56:59]
    v_mfma_f32_16x16x4_f32 v[60:63], v73, v81, v[60:63]
    v_mov_b32_dpp v64, v24 row_newbcast:14 row_mask:0xf bank_mask:0xf
    v_mov_b32_dpp v65, v25 row_newbcast:14 row_mask:0xf bank_mask:0xf
    v_mov_b32_dpp v66, v26 row_newbcast:14 row_mask:0xf bank_mask:0xf
    v_mov_b32_dpp v67, v27 row_newbcast:14 row_mask:0xf bank_mask:0xf
    v_mul_f32 v82, v64, v47
    v_mul_f32 v83, v65, v47
    v_exp_f32 v82, v82
    v_fract_f32 v83, v83
    v_cos_f32 v74, v83
    v_sin_f32 v75, v83
    v_mul_f32 v74, v74, v82
    v_mul_f32 v75, v75, v82
    v_mul_f32 v84, v75, v75
    v_add_f32 v85, v74, v74
    v_fma_f32 v76, v74, v74, -v84
    v_mul_f32 v77, v85, v75
    v_mul_f32 v84, v77, v77
    v_add_f32 v85, v76, v76
    v_fma_f32 v78, v76, v76, -v84
    v_mul_f32 v79, v85, v77
    v_mul_f32 v84, v79, v79
    v_add_f32 v85, v78, v78
    v_fma_f32 v80, v78, v78, -v84
    v_mul_f32 v81, v85, v79
    v_mul_f32 v82, v64, v44
    v_mul_f32 v83, v65, v44
    v_exp_f32 v82, v82
    v_fract_f32 v83, v83
    v_cos_f32 v68, v83
    v_sin_f32 v69, v83
    v_mul_f32 v68, v68, v82
    v_mul_f32 v69, v69, v82
    v_mul_f32 v84, v67, v69
    v_mul_f32 v85, v67, v68
    v_fma_f32 v68, v66, v68, -v84
    v_fma_f32 v69, -v66, v69, -v85
    v_mul_f32 v82, v64, v45
    v_mul_f32 v83, v65, v45
    v_exp_f32 v82, v82
    v_fract_f32 v83, v83
    v_cos_f32 v70, v83
    v_sin_f32 v71, v83
    v_mul_f32 v70, v70, v82
    v_mul_f32 v71, v71, v82
    v_mul_f32 v84, v67, v71
    v_mul_f32 v85, v67, v70
    v_fma_f32 v70, v66, v70, -v84
    v_fma_f32 v71, -v66, v71, -v85
    v_mul_f32 v82, v64, v46
    v_mul_f32 v83, v65, v46
    v_exp_f32 v82, v82
    v_fract_f32 v83, v83
    v_cos_f32 v72, v83
    v_sin_f32 v73, v83
    v_mul_f32 v72, v72, v82
    v_mul_f32 v73, v73, v82
    v_mul_f32 v84, v67, v73
    v_mul_f32 v85, v67, v72
    v_fma_f32 v72, v66, v72, -v84
    v_fma_f32 v73, -v66, v73, -v85
    v_mfma_f32_16x16x4_f32 v[48:51], v68, v74, v[48:51]
    v_mfma_f32_16x16x4_f32 v[52:55], v70, v76, v[52:55]
    v_mfma_f32_16x16x4_f32 v[56:59], v70, v78, v[56:59]
    v_mfma_f32_16x16x4_f32 v[60:63], v72, v80, v[60:63]
    v_mfma_f32_16x16x4_f32 v[48:51], v69, v75, v[48:51]
    v_mfma_f32_16x16x4_f32 v[52:55], v71, v77, v[52:55]
    v_mfma_f32_16x16x4_f32 v[56:59], v71, v79, v[56:59]
    v_mfma_f32_16x16x4_f32 v[60:63], v73, v81, v[60:63]
    v_mov_b32_dpp v64, v24 row_newbcast:15 row_mask:0xf bank_mask:0xf
    v_mov_b32_dpp v65, v25 row_newbcast:15 row_mask:0xf bank_mask:0xf
    v_mov_b32_dpp v66, v26 row_newbcast:15 row_mask:0xf bank_mask:0xf
    v_mov_b32_dpp v67, v27 row_newbcast:15 row_mask:0xf bank_mask:0xf
    v_mul_f32 v82, v64, v47
    v_mul_f32 v83, v65, v47
    v_exp_f32 v82, v82
    v_fract_f32 v83, v83
    v_cos_f32 v74, v83
    v_sin_f32 v75, v83
    v_mul_f32 v74, v74, v82
    v_mul_f32 v75, v75, v82
    v_mul_f32 v84, v75, v75
    v_add_f32 v85, v74, v74
    v_fma_f32 v76, v74, v74, -v84
    v_mul_f32 v77, v85, v75
    v_mul_f32 v84, v77, v77
    v_add_f32 v85, v76, v76
    v_fma_f32 v78, v76, v76, -v84
    v_mul_f32 v79, v85, v77
    v_mul_f32 v84, v79, v79
    v_add_f32 v85, v78, v78
    v_fma_f32 v80, v78, v78, -v84
    v_mul_f32 v81, v85, v79
    v_mul_f32 v82, v64, v44
    v_mul_f32 v83, v65, v44
    v_exp_f32 v82, v82
    v_fract_f32 v83, v83
    v_cos_f32 v68, v83
    v_sin_f32 v69, v83
    v_mul_f32 v68, v68, v82
    v_mul_f32 v69, v69, v82
    v_mul_f32 v84, v67, v69
    v_mul_f32 v85, v67, v68
    v_fma_f32 v68, v66, v68, -v84
    v_fma_f32 v69, -v66, v69, -v85
    v_mul_f32 v82, v64, v45
    v_mul_f32 v83, v65, v45
    v_exp_f32 v82, v82
    v_fract_f32 v83, v83
    v_cos_f32 v70, v83
    v_sin_f32 v71, v83
    v_mul_f32 v70, v70, v82
    v_mul_f32 v71, v71, v82
    v_mul_f32 v84, v67, v71
    v_mul_f32 v85, v67, v70
    v_fma_f32 v70, v66, v70, -v84
    v_fma_f32 v71, -v66, v71, -v85
    v_mul_f32 v82, v64, v46
    v_mul_f32 v83, v65, v46
    v_exp_f32 v82, v82
    v_fract_f32 v83, v83
    v_cos_f32 v72, v83
    v_sin_f32 v73, v83
    v_mul_f32 v72, v72, v82
    v_mul_f32 v73, v73, v82
    v_mul_f32 v84, v67, v73
    v_mul_f32 v85, v67, v72
    v_fma_f32 v72, v66, v72, -v84
    v_fma_f32 v73, -v66, v73, -v85
    v_mfma_f32_16x16x4_f32 v[48:51], v68, v74, v[48:51]
    v_mfma_f32_16x16x4_f32 v[52:55], v70, v76, v[52:55]
    v_mfma_f32_16x16x4_f32 v[56:59], v70, v78, v[56:59]
    v_mfma_f32_16x16x4_f32 v[60:63], v72, v80, v[60:63]
    v_mfma_f32_16x16x4_f32 v[48:51], v69, v75, v[48:51]
    v_mfma_f32_16x16x4_f32 v[52:55], v71, v77, v[52:55]
    v_mfma_f32_16x16x4_f32 v[56:59], v71, v79, v[56:59]
    v_mfma_f32_16x16x4_f32 v[60:63], v73, v81, v[60:63]
    v_mov_b32_dpp v64, v28 row_newbcast:0 row_mask:0xf bank_mask:0xf
    v_mov_b32_dpp v65, v29 row_newbcast:0 row_mask:0xf bank_mask:0xf
    v_mov_b32_dpp v66, v30 row_newbcast:0 row_mask:0xf bank_mask:0xf
    v_mov_b32_dpp v67, v31 row_newbcast:0 row_mask:0xf bank_mask:0xf
    v_mul_f32 v82, v64, v47
    v_mul_f32 v83, v65, v47
    v_exp_f32 v82, v82
    v_fract_f32 v83, v83
    v_cos_f32 v74, v83
    v_sin_f32 v75, v83
    v_mul_f32 v74, v74, v82
    v_mul_f32 v75, v75, v82
    v_mul_f32 v84, v75, v75
    v_add_f32 v85, v74, v74
    v_fma_f32 v76, v74, v74, -v84
    v_mul_f32 v77, v85, v75
    v_mul_f32 v84, v77, v77
    v_add_f32 v85, v76, v76
    v_fma_f32 v78, v76, v76, -v84
    v_mul_f32 v79, v85, v77
    v_mul_f32 v84, v79, v79
    v_add_f32 v85, v78, v78
    v_fma_f32 v80, v78, v78, -v84
    v_mul_f32 v81, v85, v79
    v_mul_f32 v82, v64, v44
    v_mul_f32 v83, v65, v44
    v_exp_f32 v82, v82
    v_fract_f32 v83, v83
    v_cos_f32 v68, v83
    v_sin_f32 v69, v83
    v_mul_f32 v68, v68, v82
    v_mul_f32 v69, v69, v82
    v_mul_f32 v84, v67, v69
    v_mul_f32 v85, v67, v68
    v_fma_f32 v68, v66, v68, -v84
    v_fma_f32 v69, -v66, v69, -v85
    v_mul_f32 v82, v64, v45
    v_mul_f32 v83, v65, v45
    v_exp_f32 v82, v82
    v_fract_f32 v83, v83
    v_cos_f32 v70, v83
    v_sin_f32 v71, v83
    v_mul_f32 v70, v70, v82
    v_mul_f32 v71, v71, v82
    v_mul_f32 v84, v67, v71
    v_mul_f32 v85, v67, v70
    v_fma_f32 v70, v66, v70, -v84
    v_fma_f32 v71, -v66, v71, -v85
    v_mul_f32 v82, v64, v46
    v_mul_f32 v83, v65, v46
    v_exp_f32 v82, v82
    v_fract_f32 v83, v83
    v_cos_f32 v72, v83
    v_sin_f32 v73, v83
    v_mul_f32 v72, v72, v82
    v_mul_f32 v73, v73, v82
    v_mul_f32 v84, v67, v73
    v_mul_f32 v85, v67, v72
    v_fma_f32 v72, v66, v72, -v84
    v_fma_f32 v73, -v66, v73, -v85
    v_mfma_f32_16x16x4_f32 v[48:51], v68, v74, v[48:51]
    v_mfma_f32_16x16x4_f32 v[52:55], v70, v76, v[52:55]
    v_mfma_f32_16x16x4_f32 v[56:59], v70, v78, v[56:59]
    v_mfma_f32_16x16x4_f32 v[60:63], v72, v80, v[60:63]
    v_mfma_f32_16x16x4_f32 v[48:51], v69, v75, v[48:51]
    v_mfma_f32_16x16x4_f32 v[52:55], v71, v77, v[52:55]
    v_mfma_f32_16x16x4_f32 v[56:59], v71, v79, v[56:59]
    v_mfma_f32_16x16x4_f32 v[60:63], v73, v81, v[60:63]
    v_mov_b32_dpp v64, v28 row_newbcast:1 row_mask:0xf bank_mask:0xf
    v_mov_b32_dpp v65, v29 row_newbcast:1 row_mask:0xf bank_mask:0xf
    v_mov_b32_dpp v66, v30 row_newbcast:1 row_mask:0xf bank_mask:0xf
    v_mov_b32_dpp v67, v31 row_newbcast:1 row_mask:0xf bank_mask:0xf
    v_mul_f32 v82, v64, v47
    v_mul_f32 v83, v65, v47
    v_exp_f32 v82, v82
    v_fract_f32 v83, v83
    v_cos_f32 v74, v83
    v_sin_f32 v75, v83
    v_mul_f32 v74, v74, v82
    v_mul_f32 v75, v75, v82
    v_mul_f32 v84, v75, v75
    v_add_f32 v85, v74, v74
    v_fma_f32 v76, v74, v74, -v84
    v_mul_f32 v77, v85, v75
    v_mul_f32 v84, v77, v77
    v_add_f32 v85, v76, v76
    v_fma_f32 v78, v76, v76, -v84
    v_mul_f32 v79, v85, v77
    v_mul_f32 v84, v79, v79
    v_add_f32 v85, v78, v78
    v_fma_f32 v80, v78, v78, -v84
    v_mul_f32 v81, v85, v79
    v_mul_f32 v82, v64, v44
    v_mul_f32 v83, v65, v44
    v_exp_f32 v82, v82
    v_fract_f32 v83, v83
    v_cos_f32 v68, v83
    v_sin_f32 v69, v83
    v_mul_f32 v68, v68, v82
    v_mul_f32 v69, v69, v82
    v_mul_f32 v84, v67, v69
    v_mul_f32 v85, v67, v68
    v_fma_f32 v68, v66, v68, -v84
    v_fma_f32 v69, -v66, v69, -v85
    v_mul_f32 v82, v64, v45
    v_mul_f32 v83, v65, v45
    v_exp_f32 v82, v82
    v_fract_f32 v83, v83
    v_cos_f32 v70, v83
    v_sin_f32 v71, v83
    v_mul_f32 v70, v70, v82
    v_mul_f32 v71, v71, v82
    v_mul_f32 v84, v67, v71
    v_mul_f32 v85, v67, v70
    v_fma_f32 v70, v66, v70, -v84
    v_fma_f32 v71, -v66, v71, -v85
    v_mul_f32 v82, v64, v46
    v_mul_f32 v83, v65, v46
    v_exp_f32 v82, v82
    v_fract_f32 v83, v83
    v_cos_f32 v72, v83
    v_sin_f32 v73, v83
    v_mul_f32 v72, v72, v82
    v_mul_f32 v73, v73, v82
    v_mul_f32 v84, v67, v73
    v_mul_f32 v85, v67, v72
    v_fma_f32 v72, v66, v72, -v84
    v_fma_f32 v73, -v66, v73, -v85
    v_mfma_f32_16x16x4_f32 v[48:51], v68, v74, v[48:51]
    v_mfma_f32_16x16x4_f32 v[52:55], v70, v76, v[52:55]
    v_mfma_f32_16x16x4_f32 v[56:59], v70, v78, v[56:59]
    v_mfma_f32_16x16x4_f32 v[60:63], v72, v80, v[60:63]
    v_mfma_f32_16x16x4_f32 v[48:51], v69, v75, v[48:51]
    v_mfma_f32_16x16x4_f32 v[52:55], v71, v77, v[52:55]
    v_mfma_f32_16x16x4_f32 v[56:59], v71, v79, v[56:59]
    v_mfma_f32_16x16x4_f32 v[60:63], v73, v81, v[60:63]
    v_mov_b32_dpp v64, v28 row_newbcast:2 row_mask:0xf bank_mask:0xf
    v_mov_b32_dpp v65, v29 row_newbcast:2 row_mask:0xf bank_mask:0xf
    v_mov_b32_dpp v66, v30 row_newbcast:2 row_mask:0xf bank_mask:0xf
    v_mov_b32_dpp v67, v31 row_newbcast:2 row_mask:0xf bank_mask:0xf
    v_mul_f32 v82, v64, v47
    v_mul_f32 v83, v65, v47
    v_exp_f32 v82, v82
    v_fract_f32 v83, v83
    v_cos_f32 v74, v83
    v_sin_f32 v75, v83
    v_mul_f32 v74, v74, v82
    v_mul_f32 v75, v75, v82
    v_mul_f32 v84, v75, v75
    v_add_f32 v85, v74, v74
    v_fma_f32 v76, v74, v74, -v84
    v_mul_f32 v77, v85, v75
    v_mul_f32 v84, v77, v77
    v_add_f32 v85, v76, v76
    v_fma_f32 v78, v76, v76, -v84
    v_mul_f32 v79, v85, v77
    v_mul_f32 v84, v79, v79
    v_add_f32 v85, v78, v78
    v_fma_f32 v80, v78, v78, -v84
    v_mul_f32 v81, v85, v79
    v_mul_f32 v82, v64, v44
    v_mul_f32 v83, v65, v44
    v_exp_f32 v82, v82
    v_fract_f32 v83, v83
    v_cos_f32 v68, v83
    v_sin_f32 v69, v83
    v_mul_f32 v68, v68, v82
    v_mul_f32 v69, v69, v82
    v_mul_f32 v84, v67, v69
    v_mul_f32 v85, v67, v68
    v_fma_f32 v68, v66, v68, -v84
    v_fma_f32 v69, -v66, v69, -v85
    v_mul_f32 v82, v64, v45
    v_mul_f32 v83, v65, v45
    v_exp_f32 v82, v82
    v_fract_f32 v83, v83
    v_cos_f32 v70, v83
    v_sin_f32 v71, v83
    v_mul_f32 v70, v70, v82
    v_mul_f32 v71, v71, v82
    v_mul_f32 v84, v67, v71
    v_mul_f32 v85, v67, v70
    v_fma_f32 v70, v66, v70, -v84
    v_fma_f32 v71, -v66, v71, -v85
    v_mul_f32 v82, v64, v46
    v_mul_f32 v83, v65, v46
    v_exp_f32 v82, v82
    v_fract_f32 v83, v83
    v_cos_f32 v72, v83
    v_sin_f32 v73, v83
    v_mul_f32 v72, v72, v82
    v_mul_f32 v73, v73, v82
    v_mul_f32 v84, v67, v73
    v_mul_f32 v85, v67, v72
    v_fma_f32 v72, v66, v72, -v84
    v_fma_f32 v73, -v66, v73, -v85
    v_mfma_f32_16x16x4_f32 v[48:51], v68, v74, v[48:51]
    v_mfma_f32_16x16x4_f32 v[52:55], v70, v76, v[52:55]
    v_mfma_f32_16x16x4_f32 v[56:59], v70, v78, v[56:59]
    v_mfma_f32_16x16x4_f32 v[60:63], v72, v80, v[60:63]
    v_mfma_f32_16x16x4_f32 v[48:51], v69, v75, v[48:51]
    v_mfma_f32_16x16x4_f32 v[52:55], v71, v77, v[52:55]
    v_mfma_f32_16x16x4_f32 v[56:59], v71, v79, v[56:59]
    v_mfma_f32_16x16x4_f32 v[60:63], v73, v81, v[60:63]
    v_mov_b32_dpp v64, v28 row_newbcast:3 row_mask:0xf bank_mask:0xf
    v_mov_b32_dpp v65, v29 row_newbcast:3 row_mask:0xf bank_mask:0xf
    v_mov_b32_dpp v66, v30 row_newbcast:3 row_mask:0xf bank_mask:0xf
    v_mov_b32_dpp v67, v31 row_newbcast:3 row_mask:0xf bank_mask:0xf
    v_mul_f32 v82, v64, v47
    v_mul_f32 v83, v65, v47
    v_exp_f32 v82, v82
    v_fract_f32 v83, v83
    v_cos_f32 v74, v83
    v_sin_f32 v75, v83
    v_mul_f32 v74, v74, v82
    v_mul_f32 v75, v75, v82
    v_mul_f32 v84, v75, v75
    v_add_f32 v85, v74, v74
    v_fma_f32 v76, v74, v74, -v84
    v_mul_f32 v77, v85, v75
    v_mul_f32 v84, v77, v77
    v_add_f32 v85, v76, v76
    v_fma_f32 v78, v76, v76, -v84
    v_mul_f32 v79, v85, v77
    v_mul_f32 v84, v79, v79
    v_add_f32 v85, v78, v78
    v_fma_f32 v80, v78, v78, -v84
    v_mul_f32 v81, v85, v79
    v_mul_f32 v82, v64, v44
    v_mul_f32 v83, v65, v44
    v_exp_f32 v82, v82
    v_fract_f32 v83, v83
    v_cos_f32 v68, v83
    v_sin_f32 v69, v83
    v_mul_f32 v68, v68, v82
    v_mul_f32 v69, v69, v82
    v_mul_f32 v84, v67, v69
    v_mul_f32 v85, v67, v68
    v_fma_f32 v68, v66, v68, -v84
    v_fma_f32 v69, -v66, v69, -v85
    v_mul_f32 v82, v64, v45
    v_mul_f32 v83, v65, v45
    v_exp_f32 v82, v82
    v_fract_f32 v83, v83
    v_cos_f32 v70, v83
    v_sin_f32 v71, v83
    v_mul_f32 v70, v70, v82
    v_mul_f32 v71, v71, v82
    v_mul_f32 v84, v67, v71
    v_mul_f32 v85, v67, v70
    v_fma_f32 v70, v66, v70, -v84
    v_fma_f32 v71, -v66, v71, -v85
    v_mul_f32 v82, v64, v46
    v_mul_f32 v83, v65, v46
    v_exp_f32 v82, v82
    v_fract_f32 v83, v83
    v_cos_f32 v72, v83
    v_sin_f32 v73, v83
    v_mul_f32 v72, v72, v82
    v_mul_f32 v73, v73, v82
    v_mul_f32 v84, v67, v73
    v_mul_f32 v85, v67, v72
    v_fma_f32 v72, v66, v72, -v84
    v_fma_f32 v73, -v66, v73, -v85
    v_mfma_f32_16x16x4_f32 v[48:51], v68, v74, v[48:51]
    v_mfma_f32_16x16x4_f32 v[52:55], v70, v76, v[52:55]
    v_mfma_f32_16x16x4_f32 v[56:59], v70, v78, v[56:59]
    v_mfma_f32_16x16x4_f32 v[60:63], v72, v80, v[60:63]
    v_mfma_f32_16x16x4_f32 v[48:51], v69, v75, v[48:51]
    v_mfma_f32_16x16x4_f32 v[52:55], v71, v77, v[52:55]
    v_mfma_f32_16x16x4_f32 v[56:59], v71, v79, v[56:59]
    v_mfma_f32_16x16x4_f32 v[60:63], v73, v81, v[60:63]
    v_mov_b32_dpp v64, v28 row_newbcast:4 row_mask:0xf bank_mask:0xf
    v_mov_b32_dpp v65, v29 row_newbcast:4 row_mask:0xf bank_mask:0xf
    v_mov_b32_dpp v66, v30 row_newbcast:4 row_mask:0xf bank_mask:0xf
    v_mov_b32_dpp v67, v31 row_newbcast:4 row_mask:0xf bank_mask:0xf
    v_mul_f32 v82, v64, v47
    v_mul_f32 v83, v65, v47
    v_exp_f32 v82, v82
    v_fract_f32 v83, v83
    v_cos_f32 v74, v83
    v_sin_f32 v75, v83
    v_mul_f32 v74, v74, v82
    v_mul_f32 v75, v75, v82
    v_mul_f32 v84, v75, v75
    v_add_f32 v85, v74, v74
    v_fma_f32 v76, v74, v74, -v84
    v_mul_f32 v77, v85, v75
    v_mul_f32 v84, v77, v77
    v_add_f32 v85, v76, v76
    v_fma_f32 v78, v76, v76, -v84
    v_mul_f32 v79, v85, v77
    v_mul_f32 v84, v79, v79
    v_add_f32 v85, v78, v78
    v_fma_f32 v80, v78, v78, -v84
    v_mul_f32 v81, v85, v79
    v_mul_f32 v82, v64, v44
    v_mul_f32 v83, v65, v44
    v_exp_f32 v82, v82
    v_fract_f32 v83, v83
    v_cos_f32 v68, v83
    v_sin_f32 v69, v83
    v_mul_f32 v68, v68, v82
    v_mul_f32 v69, v69, v82
    v_mul_f32 v84, v67, v69
    v_mul_f32 v85, v67, v68
    v_fma_f32 v68, v66, v68, -v84
    v_fma_f32 v69, -v66, v69, -v85
    v_mul_f32 v82, v64, v45
    v_mul_f32 v83, v65, v45
    v_exp_f32 v82, v82
    v_fract_f32 v83, v83
    v_cos_f32 v70, v83
    v_sin_f32 v71, v83
    v_mul_f32 v70, v70, v82
    v_mul_f32 v71, v71, v82
    v_mul_f32 v84, v67, v71
    v_mul_f32 v85, v67, v70
    v_fma_f32 v70, v66, v70, -v84
    v_fma_f32 v71, -v66, v71, -v85
    v_mul_f32 v82, v64, v46
    v_mul_f32 v83, v65, v46
    v_exp_f32 v82, v82
    v_fract_f32 v83, v83
    v_cos_f32 v72, v83
    v_sin_f32 v73, v83
    v_mul_f32 v72, v72, v82
    v_mul_f32 v73, v73, v82
    v_mul_f32 v84, v67, v73
    v_mul_f32 v85, v67, v72
    v_fma_f32 v72, v66, v72, -v84
    v_fma_f32 v73, -v66, v73, -v85
    v_mfma_f32_16x16x4_f32 v[48:51], v68, v74, v[48:51]
    v_mfma_f32_16x16x4_f32 v[52:55], v70, v76, v[52:55]
    v_mfma_f32_16x16x4_f32 v[56:59], v70, v78, v[56:59]
    v_mfma_f32_16x16x4_f32 v[60:63], v72, v80, v[60:63]
    v_mfma_f32_16x16x4_f32 v[48:51], v69, v75, v[48:51]
    v_mfma_f32_16x16x4_f32 v[52:55], v71, v77, v[52:55]
    v_mfma_f32_16x16x4_f32 v[56:59], v71, v79, v[56:59]
    v_mfma_f32_16x16x4_f32 v[60:63], v73, v81, v[60:63]
    v_mov_b32_dpp v64, v28 row_newbcast:5 row_mask:0xf bank_mask:0xf
    v_mov_b32_dpp v65, v29 row_newbcast:5 row_mask:0xf bank_mask:0xf
    v_mov_b32_dpp v66, v30 row_newbcast:5 row_mask:0xf bank_mask:0xf
    v_mov_b32_dpp v67, v31 row_newbcast:5 row_mask:0xf bank_mask:0xf
    v_mul_f32 v82, v64, v47
    v_mul_f32 v83, v65, v47
    v_exp_f32 v82, v82
    v_fract_f32 v83, v83
    v_cos_f32 v74, v83
    v_sin_f32 v75, v83
    v_mul_f32 v74, v74, v82
    v_mul_f32 v75, v75, v82
    v_mul_f32 v84, v75, v75
    v_add_f32 v85, v74, v74
    v_fma_f32 v76, v74, v74, -v84
    v_mul_f32 v77, v85, v75
    v_mul_f32 v84, v77, v77
    v_add_f32 v85, v76, v76
    v_fma_f32 v78, v76, v76, -v84
    v_mul_f32 v79, v85, v77
    v_mul_f32 v84, v79, v79
    v_add_f32 v85, v78, v78
    v_fma_f32 v80, v78, v78, -v84
    v_mul_f32 v81, v85, v79
    v_mul_f32 v82, v64, v44
    v_mul_f32 v83, v65, v44
    v_exp_f32 v82, v82
    v_fract_f32 v83, v83
    v_cos_f32 v68, v83
    v_sin_f32 v69, v83
    v_mul_f32 v68, v68, v82
    v_mul_f32 v69, v69, v82
    v_mul_f32 v84, v67, v69
    v_mul_f32 v85, v67, v68
    v_fma_f32 v68, v66, v68, -v84
    v_fma_f32 v69, -v66, v69, -v85
    v_mul_f32 v82, v64, v45
    v_mul_f32 v83, v65, v45
    v_exp_f32 v82, v82
    v_fract_f32 v83, v83
    v_cos_f32 v70, v83
    v_sin_f32 v71, v83
    v_mul_f32 v70, v70, v82
    v_mul_f32 v71, v71, v82
    v_mul_f32 v84, v67, v71
    v_mul_f32 v85, v67, v70
    v_fma_f32 v70, v66, v70, -v84
    v_fma_f32 v71, -v66, v71, -v85
    v_mul_f32 v82, v64, v46
    v_mul_f32 v83, v65, v46
    v_exp_f32 v82, v82
    v_fract_f32 v83, v83
    v_cos_f32 v72, v83
    v_sin_f32 v73, v83
    v_mul_f32 v72, v72, v82
    v_mul_f32 v73, v73, v82
    v_mul_f32 v84, v67, v73
    v_mul_f32 v85, v67, v72
    v_fma_f32 v72, v66, v72, -v84
    v_fma_f32 v73, -v66, v73, -v85
    v_mfma_f32_16x16x4_f32 v[48:51], v68, v74, v[48:51]
    v_mfma_f32_16x16x4_f32 v[52:55], v70, v76, v[52:55]
    v_mfma_f32_16x16x4_f32 v[56:59], v70, v78, v[56:59]
    v_mfma_f32_16x16x4_f32 v[60:63], v72, v80, v[60:63]
    v_mfma_f32_16x16x4_f32 v[48:51], v69, v75, v[48:51]
    v_mfma_f32_16x16x4_f32 v[52:55], v71, v77, v[52:55]
    v_mfma_f32_16x16x4_f32 v[56:59], v71, v79, v[56:59]
    v_mfma_f32_16x16x4_f32 v[60:63], v73, v81, v[60:63]
    v_mov_b32_dpp v64, v28 row_newbcast:6 row_mask:0xf bank_mask:0xf
    v_mov_b32_dpp v65, v29 row_newbcast:6 row_mask:0xf bank_mask:0xf
    v_mov_b32_dpp v66, v30 row_newbcast:6 row_mask:0xf bank_mask:0xf
    v_mov_b32_dpp v67, v31 row_newbcast:6 row_mask:0xf bank_mask:0xf
    v_mul_f32 v82, v64, v47
    v_mul_f32 v83, v65, v47
    v_exp_f32 v82, v82
    v_fract_f32 v83, v83
    v_cos_f32 v74, v83
    v_sin_f32 v75, v83
    v_mul_f32 v74, v74, v82
    v_mul_f32 v75, v75, v82
    v_mul_f32 v84, v75, v75
    v_add_f32 v85, v74, v74
    v_fma_f32 v76, v74, v74, -v84
    v_mul_f32 v77, v85, v75
    v_mul_f32 v84, v77, v77
    v_add_f32 v85, v76, v76
    v_fma_f32 v78, v76, v76, -v84
    v_mul_f32 v79, v85, v77
    v_mul_f32 v84, v79, v79
    v_add_f32 v85, v78, v78
    v_fma_f32 v80, v78, v78, -v84
    v_mul_f32 v81, v85, v79
    v_mul_f32 v82, v64, v44
    v_mul_f32 v83, v65, v44
    v_exp_f32 v82, v82
    v_fract_f32 v83, v83
    v_cos_f32 v68, v83
    v_sin_f32 v69, v83
    v_mul_f32 v68, v68, v82
    v_mul_f32 v69, v69, v82
    v_mul_f32 v84, v67, v69
    v_mul_f32 v85, v67, v68
    v_fma_f32 v68, v66, v68, -v84
    v_fma_f32 v69, -v66, v69, -v85
    v_mul_f32 v82, v64, v45
    v_mul_f32 v83, v65, v45
    v_exp_f32 v82, v82
    v_fract_f32 v83, v83
    v_cos_f32 v70, v83
    v_sin_f32 v71, v83
    v_mul_f32 v70, v70, v82
    v_mul_f32 v71, v71, v82
    v_mul_f32 v84, v67, v71
    v_mul_f32 v85, v67, v70
    v_fma_f32 v70, v66, v70, -v84
    v_fma_f32 v71, -v66, v71, -v85
    v_mul_f32 v82, v64, v46
    v_mul_f32 v83, v65, v46
    v_exp_f32 v82, v82
    v_fract_f32 v83, v83
    v_cos_f32 v72, v83
    v_sin_f32 v73, v83
    v_mul_f32 v72, v72, v82
    v_mul_f32 v73, v73, v82
    v_mul_f32 v84, v67, v73
    v_mul_f32 v85, v67, v72
    v_fma_f32 v72, v66, v72, -v84
    v_fma_f32 v73, -v66, v73, -v85
    v_mfma_f32_16x16x4_f32 v[48:51], v68, v74, v[48:51]
    v_mfma_f32_16x16x4_f32 v[52:55], v70, v76, v[52:55]
    v_mfma_f32_16x16x4_f32 v[56:59], v70, v78, v[56:59]
    v_mfma_f32_16x16x4_f32 v[60:63], v72, v80, v[60:63]
    v_mfma_f32_16x16x4_f32 v[48:51], v69, v75, v[48:51]
    v_mfma_f32_16x16x4_f32 v[52:55], v71, v77, v[52:55]
    v_mfma_f32_16x16x4_f32 v[56:59], v71, v79, v[56:59]
    v_mfma_f32_16x16x4_f32 v[60:63], v73, v81, v[60:63]
    v_mov_b32_dpp v64, v28 row_newbcast:7 row_mask:0xf bank_mask:0xf
    v_mov_b32_dpp v65, v29 row_newbcast:7 row_mask:0xf bank_mask:0xf
    v_mov_b32_dpp v66, v30 row_newbcast:7 row_mask:0xf bank_mask:0xf
    v_mov_b32_dpp v67, v31 row_newbcast:7 row_mask:0xf bank_mask:0xf
    v_mul_f32 v82, v64, v47
    v_mul_f32 v83, v65, v47
    v_exp_f32 v82, v82
    v_fract_f32 v83, v83
    v_cos_f32 v74, v83
    v_sin_f32 v75, v83
    v_mul_f32 v74, v74, v82
    v_mul_f32 v75, v75, v82
    v_mul_f32 v84, v75, v75
    v_add_f32 v85, v74, v74
    v_fma_f32 v76, v74, v74, -v84
    v_mul_f32 v77, v85, v75
    v_mul_f32 v84, v77, v77
    v_add_f32 v85, v76, v76
    v_fma_f32 v78, v76, v76, -v84
    v_mul_f32 v79, v85, v77
    v_mul_f32 v84, v79, v79
    v_add_f32 v85, v78, v78
    v_fma_f32 v80, v78, v78, -v84
    v_mul_f32 v81, v85, v79
    v_mul_f32 v82, v64, v44
    v_mul_f32 v83, v65, v44
    v_exp_f32 v82, v82
    v_fract_f32 v83, v83
    v_cos_f32 v68, v83
    v_sin_f32 v69, v83
    v_mul_f32 v68, v68, v82
    v_mul_f32 v69, v69, v82
    v_mul_f32 v84, v67, v69
    v_mul_f32 v85, v67, v68
    v_fma_f32 v68, v66, v68, -v84
    v_fma_f32 v69, -v66, v69, -v85
    v_mul_f32 v82, v64, v45
    v_mul_f32 v83, v65, v45
    v_exp_f32 v82, v82
    v_fract_f32 v83, v83
    v_cos_f32 v70, v83
    v_sin_f32 v71, v83
    v_mul_f32 v70, v70, v82
    v_mul_f32 v71, v71, v82
    v_mul_f32 v84, v67, v71
    v_mul_f32 v85, v67, v70
    v_fma_f32 v70, v66, v70, -v84
    v_fma_f32 v71, -v66, v71, -v85
    v_mul_f32 v82, v64, v46
    v_mul_f32 v83, v65, v46
    v_exp_f32 v82, v82
    v_fract_f32 v83, v83
    v_cos_f32 v72, v83
    v_sin_f32 v73, v83
    v_mul_f32 v72, v72, v82
    v_mul_f32 v73, v73, v82
    v_mul_f32 v84, v67, v73
    v_mul_f32 v85, v67, v72
    v_fma_f32 v72, v66, v72, -v84
    v_fma_f32 v73, -v66, v73, -v85
    v_mfma_f32_16x16x4_f32 v[48:51], v68, v74, v[48:51]
    v_mfma_f32_16x16x4_f32 v[52:55], v70, v76, v[52:55]
    v_mfma_f32_16x16x4_f32 v[56:59], v70, v78, v[56:59]
    v_mfma_f32_16x16x4_f32 v[60:63], v72, v80, v[60:63]
    v_mfma_f32_16x16x4_f32 v[48:51], v69, v75, v[48:51]
    v_mfma_f32_16x16x4_f32 v[52:55], v71, v77, v[52:55]
    v_mfma_f32_16x16x4_f32 v[56:59], v71, v79, v[56:59]
    v_mfma_f32_16x16x4_f32 v[60:63], v73, v81, v[60:63]
    v_mov_b32_dpp v64, v28 row_newbcast:8 row_mask:0xf bank_mask:0xf
    v_mov_b32_dpp v65, v29 row_newbcast:8 row_mask:0xf bank_mask:0xf
    v_mov_b32_dpp v66, v30 row_newbcast:8 row_mask:0xf bank_mask:0xf
    v_mov_b32_dpp v67, v31 row_newbcast:8 row_mask:0xf bank_mask:0xf
    v_mul_f32 v82, v64, v47
    v_mul_f32 v83, v65, v47
    v_exp_f32 v82, v82
    v_fract_f32 v83, v83
    v_cos_f32 v74, v83
    v_sin_f32 v75, v83
    v_mul_f32 v74, v74, v82
    v_mul_f32 v75, v75, v82
    v_mul_f32 v84, v75, v75
    v_add_f32 v85, v74, v74
    v_fma_f32 v76, v74, v74, -v84
    v_mul_f32 v77, v85, v75
    v_mul_f32 v84, v77, v77
    v_add_f32 v85, v76, v76
    v_fma_f32 v78, v76, v76, -v84
    v_mul_f32 v79, v85, v77
    v_mul_f32 v84, v79, v79
    v_add_f32 v85, v78, v78
    v_fma_f32 v80, v78, v78, -v84
    v_mul_f32 v81, v85, v79
    v_mul_f32 v82, v64, v44
    v_mul_f32 v83, v65, v44
    v_exp_f32 v82, v82
    v_fract_f32 v83, v83
    v_cos_f32 v68, v83
    v_sin_f32 v69, v83
    v_mul_f32 v68, v68, v82
    v_mul_f32 v69, v69, v82
    v_mul_f32 v84, v67, v69
    v_mul_f32 v85, v67, v68
    v_fma_f32 v68, v66, v68, -v84
    v_fma_f32 v69, -v66, v69, -v85
    v_mul_f32 v82, v64, v45
    v_mul_f32 v83, v65, v45
    v_exp_f32 v82, v82
    v_fract_f32 v83, v83
    v_cos_f32 v70, v83
    v_sin_f32 v71, v83
    v_mul_f32 v70, v70, v82
    v_mul_f32 v71, v71, v82
    v_mul_f32 v84, v67, v71
    v_mul_f32 v85, v67, v70
    v_fma_f32 v70, v66, v70, -v84
    v_fma_f32 v71, -v66, v71, -v85
    v_mul_f32 v82, v64, v46
    v_mul_f32 v83, v65, v46
    v_exp_f32 v82, v82
    v_fract_f32 v83, v83
    v_cos_f32 v72, v83
    v_sin_f32 v73, v83
    v_mul_f32 v72, v72, v82
    v_mul_f32 v73, v73, v82
    v_mul_f32 v84, v67, v73
    v_mul_f32 v85, v67, v72
    v_fma_f32 v72, v66, v72, -v84
    v_fma_f32 v73, -v66, v73, -v85
    v_mfma_f32_16x16x4_f32 v[48:51], v68, v74, v[48:51]
    v_mfma_f32_16x16x4_f32 v[52:55], v70, v76, v[52:55]
    v_mfma_f32_16x16x4_f32 v[56:59], v70, v78, v[56:59]
    v_mfma_f32_16x16x4_f32 v[60:63], v72, v80, v[60:63]
    v_mfma_f32_16x16x4_f32 v[48:51], v69, v75, v[48:51]
    v_mfma_f32_16x16x4_f32 v[52:55], v71, v77, v[52:55]
    v_mfma_f32_16x16x4_f32 v[56:59], v71, v79, v[56:59]
    v_mfma_f32_16x16x4_f32 v[60:63], v73, v81, v[60:63]
    v_mov_b32_dpp v64, v28 row_newbcast:9 row_mask:0xf bank_mask:0xf
    v_mov_b32_dpp v65, v29 row_newbcast:9 row_mask:0xf bank_mask:0xf
    v_mov_b32_dpp v66, v30 row_newbcast:9 row_mask:0xf bank_mask:0xf
    v_mov_b32_dpp v67, v31 row_newbcast:9 row_mask:0xf bank_mask:0xf
    v_mul_f32 v82, v64, v47
    v_mul_f32 v83, v65, v47
    v_exp_f32 v82, v82
    v_fract_f32 v83, v83
    v_cos_f32 v74, v83
    v_sin_f32 v75, v83
    v_mul_f32 v74, v74, v82
    v_mul_f32 v75, v75, v82
    v_mul_f32 v84, v75, v75
    v_add_f32 v85, v74, v74
    v_fma_f32 v76, v74, v74, -v84
    v_mul_f32 v77, v85, v75
    v_mul_f32 v84, v77, v77
    v_add_f32 v85, v76, v76
    v_fma_f32 v78, v76, v76, -v84
    v_mul_f32 v79, v85, v77
    v_mul_f32 v84, v79, v79
    v_add_f32 v85, v78, v78
    v_fma_f32 v80, v78, v78, -v84
    v_mul_f32 v81, v85, v79
    v_mul_f32 v82, v64, v44
    v_mul_f32 v83, v65, v44
    v_exp_f32 v82, v82
    v_fract_f32 v83, v83
    v_cos_f32 v68, v83
    v_sin_f32 v69, v83
    v_mul_f32 v68, v68, v82
    v_mul_f32 v69, v69, v82
    v_mul_f32 v84, v67, v69
    v_mul_f32 v85, v67, v68
    v_fma_f32 v68, v66, v68, -v84
    v_fma_f32 v69, -v66, v69, -v85
    v_mul_f32 v82, v64, v45
    v_mul_f32 v83, v65, v45
    v_exp_f32 v82, v82
    v_fract_f32 v83, v83
    v_cos_f32 v70, v83
    v_sin_f32 v71, v83
    v_mul_f32 v70, v70, v82
    v_mul_f32 v71, v71, v82
    v_mul_f32 v84, v67, v71
    v_mul_f32 v85, v67, v70
    v_fma_f32 v70, v66, v70, -v84
    v_fma_f32 v71, -v66, v71, -v85
    v_mul_f32 v82, v64, v46
    v_mul_f32 v83, v65, v46
    v_exp_f32 v82, v82
    v_fract_f32 v83, v83
    v_cos_f32 v72, v83
    v_sin_f32 v73, v83
    v_mul_f32 v72, v72, v82
    v_mul_f32 v73, v73, v82
    v_mul_f32 v84, v67, v73
    v_mul_f32 v85, v67, v72
    v_fma_f32 v72, v66, v72, -v84
    v_fma_f32 v73, -v66, v73, -v85
    v_mfma_f32_16x16x4_f32 v[48:51], v68, v74, v[48:51]
    v_mfma_f32_16x16x4_f32 v[52:55], v70, v76, v[52:55]
    v_mfma_f32_16x16x4_f32 v[56:59], v70, v78, v[56:59]
    v_mfma_f32_16x16x4_f32 v[60:63], v72, v80, v[60:63]
    v_mfma_f32_16x16x4_f32 v[48:51], v69, v75, v[48:51]
    v_mfma_f32_16x16x4_f32 v[52:55], v71, v77, v[52:55]
    v_mfma_f32_16x16x4_f32 v[56:59], v71, v79, v[56:59]
    v_mfma_f32_16x16x4_f32 v[60:63], v73, v81, v[60:63]
    v_mov_b32_dpp v64, v28 row_newbcast:10 row_mask:0xf bank_mask:0xf
    v_mov_b32_dpp v65, v29 row_newbcast:10 row_mask:0xf bank_mask:0xf
    v_mov_b32_dpp v66, v30 row_newbcast:10 row_mask:0xf bank_mask:0xf
    v_mov_b32_dpp v67, v31 row_newbcast:10 row_mask:0xf bank_mask:0xf
    v_mul_f32 v82, v64, v47
    v_mul_f32 v83, v65, v47
    v_exp_f32 v82, v82
    v_fract_f32 v83, v83
    v_cos_f32 v74, v83
    v_sin_f32 v75, v83
    v_mul_f32 v74, v74, v82
    v_mul_f32 v75, v75, v82
    v_mul_f32 v84, v75, v75
    v_add_f32 v85, v74, v74
    v_fma_f32 v76, v74, v74, -v84
    v_mul_f32 v77, v85, v75
    v_mul_f32 v84, v77, v77
    v_add_f32 v85, v76, v76
    v_fma_f32 v78, v76, v76, -v84
    v_mul_f32 v79, v85, v77
    v_mul_f32 v84, v79, v79
    v_add_f32 v85, v78, v78
    v_fma_f32 v80, v78, v78, -v84
    v_mul_f32 v81, v85, v79
    v_mul_f32 v82, v64, v44
    v_mul_f32 v83, v65, v44
    v_exp_f32 v82, v82
    v_fract_f32 v83, v83
    v_cos_f32 v68, v83
    v_sin_f32 v69, v83
    v_mul_f32 v68, v68, v82
    v_mul_f32 v69, v69, v82
    v_mul_f32 v84, v67, v69
    v_mul_f32 v85, v67, v68
    v_fma_f32 v68, v66, v68, -v84
    v_fma_f32 v69, -v66, v69, -v85
    v_mul_f32 v82, v64, v45
    v_mul_f32 v83, v65, v45
    v_exp_f32 v82, v82
    v_fract_f32 v83, v83
    v_cos_f32 v70, v83
    v_sin_f32 v71, v83
    v_mul_f32 v70, v70, v82
    v_mul_f32 v71, v71, v82
    v_mul_f32 v84, v67, v71
    v_mul_f32 v85, v67, v70
    v_fma_f32 v70, v66, v70, -v84
    v_fma_f32 v71, -v66, v71, -v85
    v_mul_f32 v82, v64, v46
    v_mul_f32 v83, v65, v46
    v_exp_f32 v82, v82
    v_fract_f32 v83, v83
    v_cos_f32 v72, v83
    v_sin_f32 v73, v83
    v_mul_f32 v72, v72, v82
    v_mul_f32 v73, v73, v82
    v_mul_f32 v84, v67, v73
    v_mul_f32 v85, v67, v72
    v_fma_f32 v72, v66, v72, -v84
    v_fma_f32 v73, -v66, v73, -v85
    v_mfma_f32_16x16x4_f32 v[48:51], v68, v74, v[48:51]
    v_mfma_f32_16x16x4_f32 v[52:55], v70, v76, v[52:55]
    v_mfma_f32_16x16x4_f32 v[56:59], v70, v78, v[56:59]
    v_mfma_f32_16x16x4_f32 v[60:63], v72, v80, v[60:63]
    v_mfma_f32_16x16x4_f32 v[48:51], v69, v75, v[48:51]
    v_mfma_f32_16x16x4_f32 v[52:55], v71, v77, v[52:55]
    v_mfma_f32_16x16x4_f32 v[56:59], v71, v79, v[56:59]
    v_mfma_f32_16x16x4_f32 v[60:63], v73, v81, v[60:63]
    v_mov_b32_dpp v64, v28 row_newbcast:11 row_mask:0xf bank_mask:0xf
    v_mov_b32_dpp v65, v29 row_newbcast:11 row_mask:0xf bank_mask:0xf
    v_mov_b32_dpp v66, v30 row_newbcast:11 row_mask:0xf bank_mask:0xf
    v_mov_b32_dpp v67, v31 row_newbcast:11 row_mask:0xf bank_mask:0xf
    v_mul_f32 v82, v64, v47
    v_mul_f32 v83, v65, v47
    v_exp_f32 v82, v82
    v_fract_f32 v83, v83
    v_cos_f32 v74, v83
    v_sin_f32 v75, v83
    v_mul_f32 v74, v74, v82
    v_mul_f32 v75, v75, v82
    v_mul_f32 v84, v75, v75
    v_add_f32 v85, v74, v74
    v_fma_f32 v76, v74, v74, -v84
    v_mul_f32 v77, v85, v75
    v_mul_f32 v84, v77, v77
    v_add_f32 v85, v76, v76
    v_fma_f32 v78, v76, v76, -v84
    v_mul_f32 v79, v85, v77
    v_mul_f32 v84, v79, v79
    v_add_f32 v85, v78, v78
    v_fma_f32 v80, v78, v78, -v84
    v_mul_f32 v81, v85, v79
    v_mul_f32 v82, v64, v44
    v_mul_f32 v83, v65, v44
    v_exp_f32 v82, v82
    v_fract_f32 v83, v83
    v_cos_f32 v68, v83
    v_sin_f32 v69, v83
    v_mul_f32 v68, v68, v82
    v_mul_f32 v69, v69, v82
    v_mul_f32 v84, v67, v69
    v_mul_f32 v85, v67, v68
    v_fma_f32 v68, v66, v68, -v84
    v_fma_f32 v69, -v66, v69, -v85
    v_mul_f32 v82, v64, v45
    v_mul_f32 v83, v65, v45
    v_exp_f32 v82, v82
    v_fract_f32 v83, v83
    v_cos_f32 v70, v83
    v_sin_f32 v71, v83
    v_mul_f32 v70, v70, v82
    v_mul_f32 v71, v71, v82
    v_mul_f32 v84, v67, v71
    v_mul_f32 v85, v67, v70
    v_fma_f32 v70, v66, v70, -v84
    v_fma_f32 v71, -v66, v71, -v85
    v_mul_f32 v82, v64, v46
    v_mul_f32 v83, v65, v46
    v_exp_f32 v82, v82
    v_fract_f32 v83, v83
    v_cos_f32 v72, v83
    v_sin_f32 v73, v83
    v_mul_f32 v72, v72, v82
    v_mul_f32 v73, v73, v82
    v_mul_f32 v84, v67, v73
    v_mul_f32 v85, v67, v72
    v_fma_f32 v72, v66, v72, -v84
    v_fma_f32 v73, -v66, v73, -v85
    v_mfma_f32_16x16x4_f32 v[48:51], v68, v74, v[48:51]
    v_mfma_f32_16x16x4_f32 v[52:55], v70, v76, v[52:55]
    v_mfma_f32_16x16x4_f32 v[56:59], v70, v78, v[56:59]
    v_mfma_f32_16x16x4_f32 v[60:63], v72, v80, v[60:63]
    v_mfma_f32_16x16x4_f32 v[48:51], v69, v75, v[48:51]
    v_mfma_f32_16x16x4_f32 v[52:55], v71, v77, v[52:55]
    v_mfma_f32_16x16x4_f32 v[56:59], v71, v79, v[56:59]
    v_mfma_f32_16x16x4_f32 v[60:63], v73, v81, v[60:63]
    v_mov_b32_dpp v64, v28 row_newbcast:12 row_mask:0xf bank_mask:0xf
    v_mov_b32_dpp v65, v29 row_newbcast:12 row_mask:0xf bank_mask:0xf
    v_mov_b32_dpp v66, v30 row_newbcast:12 row_mask:0xf bank_mask:0xf
    v_mov_b32_dpp v67, v31 row_newbcast:12 row_mask:0xf bank_mask:0xf
    v_mul_f32 v82, v64, v47
    v_mul_f32 v83, v65, v47
    v_exp_f32 v82, v82
    v_fract_f32 v83, v83
    v_cos_f32 v74, v83
    v_sin_f32 v75, v83
    v_mul_f32 v74, v74, v82
    v_mul_f32 v75, v75, v82
    v_mul_f32 v84, v75, v75
    v_add_f32 v85, v74, v74
    v_fma_f32 v76, v74, v74, -v84
    v_mul_f32 v77, v85, v75
    v_mul_f32 v84, v77, v77
    v_add_f32 v85, v76, v76
    v_fma_f32 v78, v76, v76, -v84
    v_mul_f32 v79, v85, v77
    v_mul_f32 v84, v79, v79
    v_add_f32 v85, v78, v78
    v_fma_f32 v80, v78, v78, -v84
    v_mul_f32 v81, v85, v79
    v_mul_f32 v82, v64, v44
    v_mul_f32 v83, v65, v44
    v_exp_f32 v82, v82
    v_fract_f32 v83, v83
    v_cos_f32 v68, v83
    v_sin_f32 v69, v83
    v_mul_f32 v68, v68, v82
    v_mul_f32 v69, v69, v82
    v_mul_f32 v84, v67, v69
    v_mul_f32 v85, v67, v68
    v_fma_f32 v68, v66, v68, -v84
    v_fma_f32 v69, -v66, v69, -v85
    v_mul_f32 v82, v64, v45
    v_mul_f32 v83, v65, v45
    v_exp_f32 v82, v82
    v_fract_f32 v83, v83
    v_cos_f32 v70, v83
    v_sin_f32 v71, v83
    v_mul_f32 v70, v70, v82
    v_mul_f32 v71, v71, v82
    v_mul_f32 v84, v67, v71
    v_mul_f32 v85, v67, v70
    v_fma_f32 v70, v66, v70, -v84
    v_fma_f32 v71, -v66, v71, -v85
    v_mul_f32 v82, v64, v46
    v_mul_f32 v83, v65, v46
    v_exp_f32 v82, v82
    v_fract_f32 v83, v83
    v_cos_f32 v72, v83
    v_sin_f32 v73, v83
    v_mul_f32 v72, v72, v82
    v_mul_f32 v73, v73, v82
    v_mul_f32 v84, v67, v73
    v_mul_f32 v85, v67, v72
    v_fma_f32 v72, v66, v72, -v84
    v_fma_f32 v73, -v66, v73, -v85
    v_mfma_f32_16x16x4_f32 v[48:51], v68, v74, v[48:51]
    v_mfma_f32_16x16x4_f32 v[52:55], v70, v76, v[52:55]
    v_mfma_f32_16x16x4_f32 v[56:59], v70, v78, v[56:59]
    v_mfma_f32_16x16x4_f32 v[60:63], v72, v80, v[60:63]
    v_mfma_f32_16x16x4_f32 v[48:51], v69, v75, v[48:51]
    v_mfma_f32_16x16x4_f32 v[52:55], v71, v77, v[52:55]
    v_mfma_f32_16x16x4_f32 v[56:59], v71, v79, v[56:59]
    v_mfma_f32_16x16x4_f32 v[60:63], v73, v81, v[60:63]
    v_mov_b32_dpp v64, v28 row_newbcast:13 row_mask:0xf bank_mask:0xf
    v_mov_b32_dpp v65, v29 row_newbcast:13 row_mask:0xf bank_mask:0xf
    v_mov_b32_dpp v66, v30 row_newbcast:13 row_mask:0xf bank_mask:0xf
    v_mov_b32_dpp v67, v31 row_newbcast:13 row_mask:0xf bank_mask:0xf
    v_mul_f32 v82, v64, v47
    v_mul_f32 v83, v65, v47
    v_exp_f32 v82, v82
    v_fract_f32 v83, v83
    v_cos_f32 v74, v83
    v_sin_f32 v75, v83
    v_mul_f32 v74, v74, v82
    v_mul_f32 v75, v75, v82
    v_mul_f32 v84, v75, v75
    v_add_f32 v85, v74, v74
    v_fma_f32 v76, v74, v74, -v84
    v_mul_f32 v77, v85, v75
    v_mul_f32 v84, v77, v77
    v_add_f32 v85, v76, v76
    v_fma_f32 v78, v76, v76, -v84
    v_mul_f32 v79, v85, v77
    v_mul_f32 v84, v79, v79
    v_add_f32 v85, v78, v78
    v_fma_f32 v80, v78, v78, -v84
    v_mul_f32 v81, v85, v79
    v_mul_f32 v82, v64, v44
    v_mul_f32 v83, v65, v44
    v_exp_f32 v82, v82
    v_fract_f32 v83, v83
    v_cos_f32 v68, v83
    v_sin_f32 v69, v83
    v_mul_f32 v68, v68, v82
    v_mul_f32 v69, v69, v82
    v_mul_f32 v84, v67, v69
    v_mul_f32 v85, v67, v68
    v_fma_f32 v68, v66, v68, -v84
    v_fma_f32 v69, -v66, v69, -v85
    v_mul_f32 v82, v64, v45
    v_mul_f32 v83, v65, v45
    v_exp_f32 v82, v82
    v_fract_f32 v83, v83
    v_cos_f32 v70, v83
    v_sin_f32 v71, v83
    v_mul_f32 v70, v70, v82
    v_mul_f32 v71, v71, v82
    v_mul_f32 v84, v67, v71
    v_mul_f32 v85, v67, v70
    v_fma_f32 v70, v66, v70, -v84
    v_fma_f32 v71, -v66, v71, -v85
    v_mul_f32 v82, v64, v46
    v_mul_f32 v83, v65, v46
    v_exp_f32 v82, v82
    v_fract_f32 v83, v83
    v_cos_f32 v72, v83
    v_sin_f32 v73, v83
    v_mul_f32 v72, v72, v82
    v_mul_f32 v73, v73, v82
    v_mul_f32 v84, v67, v73
    v_mul_f32 v85, v67, v72
    v_fma_f32 v72, v66, v72, -v84
    v_fma_f32 v73, -v66, v73, -v85
    v_mfma_f32_16x16x4_f32 v[48:51], v68, v74, v[48:51]
    v_mfma_f32_16x16x4_f32 v[52:55], v70, v76, v[52:55]
    v_mfma_f32_16x16x4_f32 v[56:59], v70, v78, v[56:59]
    v_mfma_f32_16x16x4_f32 v[60:63], v72, v80, v[60:63]
    v_mfma_f32_16x16x4_f32 v[48:51], v69, v75, v[48:51]
    v_mfma_f32_16x16x4_f32 v[52:55], v71, v77, v[52:55]
    v_mfma_f32_16x16x4_f32 v[56:59], v71, v79, v[56:59]
    v_mfma_f32_16x16x4_f32 v[60:63], v73, v81, v[60:63]
    v_mov_b32_dpp v64, v28 row_newbcast:14 row_mask:0xf bank_mask:0xf
    v_mov_b32_dpp v65, v29 row_newbcast:14 row_mask:0xf bank_mask:0xf
    v_mov_b32_dpp v66, v30 row_newbcast:14 row_mask:0xf bank_mask:0xf
    v_mov_b32_dpp v67, v31 row_newbcast:14 row_mask:0xf bank_mask:0xf
    v_mul_f32 v82, v64, v47
    v_mul_f32 v83, v65, v47
    v_exp_f32 v82, v82
    v_fract_f32 v83, v83
    v_cos_f32 v74, v83
    v_sin_f32 v75, v83
    v_mul_f32 v74, v74, v82
    v_mul_f32 v75, v75, v82
    v_mul_f32 v84, v75, v75
    v_add_f32 v85, v74, v74
    v_fma_f32 v76, v74, v74, -v84
    v_mul_f32 v77, v85, v75
    v_mul_f32 v84, v77, v77
    v_add_f32 v85, v76, v76
    v_fma_f32 v78, v76, v76, -v84
    v_mul_f32 v79, v85, v77
    v_mul_f32 v84, v79, v79
    v_add_f32 v85, v78, v78
    v_fma_f32 v80, v78, v78, -v84
    v_mul_f32 v81, v85, v79
    v_mul_f32 v82, v64, v44
    v_mul_f32 v83, v65, v44
    v_exp_f32 v82, v82
    v_fract_f32 v83, v83
    v_cos_f32 v68, v83
    v_sin_f32 v69, v83
    v_mul_f32 v68, v68, v82
    v_mul_f32 v69, v69, v82
    v_mul_f32 v84, v67, v69
    v_mul_f32 v85, v67, v68
    v_fma_f32 v68, v66, v68, -v84
    v_fma_f32 v69, -v66, v69, -v85
    v_mul_f32 v82, v64, v45
    v_mul_f32 v83, v65, v45
    v_exp_f32 v82, v82
    v_fract_f32 v83, v83
    v_cos_f32 v70, v83
    v_sin_f32 v71, v83
    v_mul_f32 v70, v70, v82
    v_mul_f32 v71, v71, v82
    v_mul_f32 v84, v67, v71
    v_mul_f32 v85, v67, v70
    v_fma_f32 v70, v66, v70, -v84
    v_fma_f32 v71, -v66, v71, -v85
    v_mul_f32 v82, v64, v46
    v_mul_f32 v83, v65, v46
    v_exp_f32 v82, v82
    v_fract_f32 v83, v83
    v_cos_f32 v72, v83
    v_sin_f32 v73, v83
    v_mul_f32 v72, v72, v82
    v_mul_f32 v73, v73, v82
    v_mul_f32 v84, v67, v73
    v_mul_f32 v85, v67, v72
    v_fma_f32 v72, v66, v72, -v84
    v_fma_f32 v73, -v66, v73, -v85
    v_mfma_f32_16x16x4_f32 v[48:51], v68, v74, v[48:51]
    v_mfma_f32_16x16x4_f32 v[52:55], v70, v76, v[52:55]
    v_mfma_f32_16x16x4_f32 v[56:59], v70, v78, v[56:59]
    v_mfma_f32_16x16x4_f32 v[60:63], v72, v80, v[60:63]
    v_mfma_f32_16x16x4_f32 v[48:51], v69, v75, v[48:51]
    v_mfma_f32_16x16x4_f32 v[52:55], v71, v77, v[52:55]
    v_mfma_f32_16x16x4_f32 v[56:59], v71, v79, v[56:59]
    v_mfma_f32_16x16x4_f32 v[60:63], v73, v81, v[60:63]
    v_mov_b32_dpp v64, v28 row_newbcast:15 row_mask:0xf bank_mask:0xf
    v_mov_b32_dpp v65, v29 row_newbcast:15 row_mask:0xf bank_mask:0xf
    v_mov_b32_dpp v66, v30 row_newbcast:15 row_mask:0xf bank_mask:0xf
    v_mov_b32_dpp v67, v31 row_newbcast:15 row_mask:0xf bank_mask:0xf
    v_mul_f32 v82, v64, v47
    v_mul_f32 v83, v65, v47
    v_exp_f32 v82, v82
    v_fract_f32 v83, v83
    v_cos_f32 v74, v83
    v_sin_f32 v75, v83
    v_mul_f32 v74, v74, v82
    v_mul_f32 v75, v75, v82
    v_mul_f32 v84, v75, v75
    v_add_f32 v85, v74, v74
    v_fma_f32 v76, v74, v74, -v84
    v_mul_f32 v77, v85, v75
    v_mul_f32 v84, v77, v77
    v_add_f32 v85, v76, v76
    v_fma_f32 v78, v76, v76, -v84
    v_mul_f32 v79, v85, v77
    v_mul_f32 v84, v79, v79
    v_add_f32 v85, v78, v78
    v_fma_f32 v80, v78, v78, -v84
    v_mul_f32 v81, v85, v79
    v_mul_f32 v82, v64, v44
    v_mul_f32 v83, v65, v44
    v_exp_f32 v82, v82
    v_fract_f32 v83, v83
    v_cos_f32 v68, v83
    v_sin_f32 v69, v83
    v_mul_f32 v68, v68, v82
    v_mul_f32 v69, v69, v82
    v_mul_f32 v84, v67, v69
    v_mul_f32 v85, v67, v68
    v_fma_f32 v68, v66, v68, -v84
    v_fma_f32 v69, -v66, v69, -v85
    v_mul_f32 v82, v64, v45
    v_mul_f32 v83, v65, v45
    v_exp_f32 v82, v82
    v_fract_f32 v83, v83
    v_cos_f32 v70, v83
    v_sin_f32 v71, v83
    v_mul_f32 v70, v70, v82
    v_mul_f32 v71, v71, v82
    v_mul_f32 v84, v67, v71
    v_mul_f32 v85, v67, v70
    v_fma_f32 v70, v66, v70, -v84
    v_fma_f32 v71, -v66, v71, -v85
    v_mul_f32 v82, v64, v46
    v_mul_f32 v83, v65, v46
    v_exp_f32 v82, v82
    v_fract_f32 v83, v83
    v_cos_f32 v72, v83
    v_sin_f32 v73, v83
    v_mul_f32 v72, v72, v82
    v_mul_f32 v73, v73, v82
    v_mul_f32 v84, v67, v73
    v_mul_f32 v85, v67, v72
    v_fma_f32 v72, v66, v72, -v84
    v_fma_f32 v73, -v66, v73, -v85
    v_mfma_f32_16x16x4_f32 v[48:51], v68, v74, v[48:51]
    v_mfma_f32_16x16x4_f32 v[52:55], v70, v76, v[52:55]
    v_mfma_f32_16x16x4_f32 v[56:59], v70, v78, v[56:59]
    v_mfma_f32_16x16x4_f32 v[60:63], v72, v80, v[60:63]
    v_mfma_f32_16x16x4_f32 v[48:51], v69, v75, v[48:51]
    v_mfma_f32_16x16x4_f32 v[52:55], v71, v77, v[52:55]
    v_mfma_f32_16x16x4_f32 v[56:59], v71, v79, v[56:59]
    v_mfma_f32_16x16x4_f32 v[60:63], v73, v81, v[60:63]
    v_lshlrev_b32 v5, 8, v3
    v_lshl_add_u32 v5, v2, 2, v5
    v_add_u32 v5, v5, v4
    s_nop 5
    ds_write_b32 v5, v48 offset:4608
    ds_write_b32 v5, v49 offset:4672
    ds_write_b32 v5, v50 offset:4736
    ds_write_b32 v5, v51 offset:4800
    v_cmp_gt_u32 vcc, 2, v3
    s_nop 0
    s_mov_b64 exec, vcc
    ds_write_b32 v5, v52 offset:5632
    ds_write_b32 v5, v53 offset:5696
    ds_write_b32 v5, v54 offset:5760
    ds_write_b32 v5, v55 offset:5824
    ds_write_b32 v5, v60 offset:6656
    ds_write_b32 v5, v61 offset:6720
    ds_write_b32 v5, v62 offset:6784
    ds_write_b32 v5, v63 offset:6848
    s_not_b64 exec, exec
    ds_write_b32 v5, v56 offset:5632
    ds_write_b32 v5, v57 offset:5696
    ds_write_b32 v5, v58 offset:5760
    ds_write_b32 v5, v59 offset:5824
    s_mov_b32 exec_lo, 0
    s_mov_b32 exec_hi, 3
    v_cmp_eq_u32 vcc, 0, v2
    s_nop 1
    v_cndmask_b32 v6, 0, v60, vcc
    ds_write_b32 v5, v6 offset:6656
    s_mov_b64 exec, -1
    s_waitcnt lgkmcnt(0)
    v_lshlrev_b32 v7, 1, v1
    v_sub_u32 v7, 2065, v7
    v_lshl_add_u32 v64, v1, 2, v4
    v_mov_b32 v65, 641
    s_mov_b32 s25, 17
ss_exp:
    v_subrev_u32 v66, 0, v7
    v_cvt_f32_u32 v70, v66
    v_cvt_pk_bf16_f32 v70, v70, v70
    v_and_b32 v70, 0xffff, v70
    v_subrev_u32 v70, 0x4280, v70
    v_cmp_gt_u32 vcc, 256, v66
    s_nop 1
    v_cndmask_b32 v70, v70, v66, vcc
    v_cmp_gt_u32 vcc, 2048, v66
    s_nop 1
    v_cndmask_b32 v70, v65, v70, vcc
    v_lshl_add_u32 v70, v70, 2, v4
    ds_read_b32 v74, v70 offset:4608
    v_subrev_u32 v67, 1, v7
    v_cvt_f32_u32 v71, v67
    v_cvt_pk_bf16_f32 v71, v71, v71
    v_and_b32 v71, 0xffff, v71
    v_subrev_u32 v71, 0x4280, v71
    v_cmp_gt_u32 vcc, 256, v67
    s_nop 1
    v_cndmask_b32 v71, v71, v67, vcc
    v_cmp_gt_u32 vcc, 2048, v67
    s_nop 1
    v_cndmask_b32 v71, v65, v71, vcc
    v_lshl_add_u32 v71, v71, 2, v4
    ds_read_b32 v75, v71 offset:4608
    v_subrev_u32 v68, 2, v7
    v_cvt_f32_u32 v72, v68
    v_cvt_pk_bf16_f32 v72, v72, v72
    v_and_b32 v72, 0xffff, v72
    v_subrev_u32 v72, 0x4280, v72
    v_cmp_gt_u32 vcc, 256, v68
    s_nop 1
    v_cndmask_b32 v72, v72, v68, vcc
    v_cmp_gt_u32 vcc, 2048, v68
    s_nop 1
    v_cndmask_b32 v72, v65, v72, vcc
    v_lshl_add_u32 v72, v72, 2, v4
    ds_read_b32 v76, v72 offset:4608
    s_waitcnt lgkmcnt(0)
    v_cvt_pk_bf16_f32 v78, v75, v76
    v_cvt_pk_bf16_f32 v79, v74, v75
    ds_write_b32 v64, v78 offset:7424
    ds_write_b32 v64, v79 offset:11776
    v_subrev_u32 v7, 128, v7
    v_add_u32 v64, 256, v64
    s_sub_u32 s25, s25, 1
    s_cmp_lg_u32 s25, 0
    s_cbranch_scc1 ss_exp
    s_waitcnt lgkmcnt(0)
    s_barrier
    v_and_b32 v5, 1, v2
    v_mul_u32_u24 v64, 4352, v5
    v_sub_u32 v5, v5, v2
    v_lshl_add_u32 v5, v3, 3, v5
    v_lshl_add_u32 v64, v5, 1, v64
    v_add_u32 v64, 11520, v64
    v_add_u32 v64, v64, v4
    v_lshlrev_b32 v65, 5, v2
    v_lshl_add_u32 v65, v3, 4, v65
    v_add_u32 v65, 480, v65
    v_add_u32 v65, v65, v4
    v_mov_b32 v96, 0
    v_mov_b32 v97, 0
    v_mov_b32 v98, 0
    v_mov_b32 v99, 0
    v_mov_b32 v100, 0
    v_mov_b32 v101, 0
    v_mov_b32 v102, 0
    v_mov_b32 v103, 0
    v_mov_b32 v104, 0
    v_mov_b32 v105, 0
    v_mov_b32 v106, 0
    v_mov_b32 v107, 0
    v_mov_b32 v108, 0
    v_mov_b32 v109, 0
    v_mov_b32 v110, 0
    v_mov_b32 v111, 0
    v_mov_b32 v112, 0
    v_mov_b32 v113, 0
    v_mov_b32 v114, 0
    v_mov_b32 v115, 0
    v_mov_b32 v116, 0
    v_mov_b32 v117, 0
    v_mov_b32 v118, 0
    v_mov_b32 v119, 0
    v_mov_b32 v120, 0
    v_mov_b32 v121, 0
    v_mov_b32 v122, 0
    v_mov_b32 v123, 0
    v_mov_b32 v124, 0
    v_mov_b32 v125, 0
    v_mov_b32 v126, 0
    v_mov_b32 v127, 0
    s_mov_b32 s25, 8
ss_cv0:
    ds_read2_b32 v[68:69], v64 offset0:0 offset1:1
    ds_read2_b32 v[70:71], v64 offset0:2 offset1:3
    ds_read_b128 v[128:131], v65 offset:0
    ds_read_b128 v[132:135], v65 offset:512
    ds_read_b128 v[136:139], v65 offset:1024
    ds_read_b128 v[140:143], v65 offset:1536
    ds_read_b128 v[144:147], v65 offset:2048
    ds_read_b128 v[148:151], v65 offset:2560
    ds_read_b128 v[152:155], v65 offset:3072
    ds_read_b128 v[156:159], v65 offset:3584
    v_subrev_u32 v64, 64, v64
    v_subrev_u32 v65, 64, v65
    s_waitcnt lgkmcnt(7)
    v_mfma_f32_16x16x32_bf16 v[96:99], v[68:71], v[128:131], v[96:99]
    s_waitcnt lgkmcnt(6)
    v_mfma_f32_16x16x32_bf16 v[100:103], v[68:71], v[132:135], v[100:103]
    s_waitcnt lgkmcnt(5)
    v_mfma_f32_16x16x32_bf16 v[104:107], v[68:71], v[136:139], v[104:107]
    s_waitcnt lgkmcnt(4)
    v_mfma_f32_16x16x32_bf16 v[108:111], v[68:71], v[140:143], v[108:111]
    s_waitcnt lgkmcnt(3)
    v_mfma_f32_16x16x32_bf16 v[112:115], v[68:71], v[144:147], v[112:115]
    s_waitcnt lgkmcnt(2)
    v_mfma_f32_16x16x32_bf16 v[116:119], v[68:71], v[148:151], v[116:119]
    s_waitcnt lgkmcnt(1)
    v_mfma_f32_16x16x32_bf16 v[120:123], v[68:71], v[152:155], v[120:123]
    s_waitcnt lgkmcnt(0)
    v_mfma_f32_16x16x32_bf16 v[124:127], v[68:71], v[156:159], v[124:127]
    s_sub_u32 s25, s25, 1
    s_cmp_lg_u32 s25, 0
    s_cbranch_scc1 ss_cv0
    v_add_u32 v65, 512, v65
    s_mov_b32 s25, 8
ss_cv1:
    ds_read2_b32 v[68:69], v64 offset0:0 offset1:1
    ds_read2_b32 v[70:71], v64 offset0:2 offset1:3
    ds_read_b128 v[132:135], v65 offset:0
    ds_read_b128 v[136:139], v65 offset:512
    ds_read_b128 v[140:143], v65 offset:1024
    ds_read_b128 v[144:147], v65 offset:1536
    ds_read_b128 v[148:151], v65 offset:2048
    ds_read_b128 v[152:155], v65 offset:2560
    ds_read_b128 v[156:159], v65 offset:3072
    v_subrev_u32 v64, 64, v64
    v_subrev_u32 v65, 64, v65
    s_waitcnt lgkmcnt(6)
    v_mfma_f32_16x16x32_bf16 v[100:103], v[68:71], v[132:135], v[100:103]
    s_waitcnt lgkmcnt(5)
    v_mfma_f32_16x16x32_bf16 v[104:107], v[68:71], v[136:139], v[104:107]
    s_waitcnt lgkmcnt(4)
    v_mfma_f32_16x16x32_bf16 v[108:111], v[68:71], v[140:143], v[108:111]
    s_waitcnt lgkmcnt(3)
    v_mfma_f32_16x16x32_bf16 v[112:115], v[68:71], v[144:147], v[112:115]
    s_waitcnt lgkmcnt(2)
    v_mfma_f32_16x16x32_bf16 v[116:119], v[68:71], v[148:151], v[116:119]
    s_waitcnt lgkmcnt(1)
    v_mfma_f32_16x16x32_bf16 v[120:123], v[68:71], v[152:155], v[120:123]
    s_waitcnt lgkmcnt(0)
    v_mfma_f32_16x16x32_bf16 v[124:127], v[68:71], v[156:159], v[124:127]
    s_sub_u32 s25, s25, 1
    s_cmp_lg_u32 s25, 0
    s_cbranch_scc1 ss_cv1
    v_add_u32 v65, 512, v65
    s_mov_b32 s25, 8
ss_cv2:
    ds_read2_b32 v[68:69], v64 offset0:0 offset1:1
    ds_read2_b32 v[70:71], v64 offset0:2 offset1:3
    ds_read_b128 v[136:139], v65 offset:0
    ds_read_b128 v[140:143], v65 offset:512
    ds_read_b128 v[144:147], v65 offset:1024
    ds_read_b128 v[148:151], v65 offset:1536
    ds_read_b128 v[152:155], v65 offset:2048
    ds_read_b128 v[156:159], v65 offset:2560
    v_subrev_u32 v64, 64, v64
    v_subrev_u32 v65, 64, v65
    s_waitcnt lgkmcnt(5)
    v_mfma_f32_16x16x32_bf16 v[104:107], v[68:71], v[136:139], v[104:107]
    s_waitcnt lgkmcnt(4)
    v_mfma_f32_16x16x32_bf16 v[108:111], v[68:71], v[140:143], v[108:111]
    s_waitcnt lgkmcnt(3)
    v_mfma_f32_16x16x32_bf16 v[112:115], v[68:71], v[144:147], v[112:115]
    s_waitcnt lgkmcnt(2)
    v_mfma_f32_16x16x32_bf16 v[116:119], v[68:71], v[148:151], v[116:119]
    s_waitcnt lgkmcnt(1)
    v_mfma_f32_16x16x32_bf16 v[120:123], v[68:71], v[152:155], v[120:123]
    s_waitcnt lgkmcnt(0)
    v_mfma_f32_16x16x32_bf16 v[124:127], v[68:71], v[156:159], v[124:127]
    s_sub_u32 s25, s25, 1
    s_cmp_lg_u32 s25, 0
    s_cbranch_scc1 ss_cv2
    v_add_u32 v65, 512, v65
    s_mov_b32 s25, 8
ss_cv3:
    ds_read2_b32 v[68:69], v64 offset0:0 offset1:1
    ds_read2_b32 v[70:71], v64 offset0:2 offset1:3
    ds_read_b128 v[140:143], v65 offset:0
    ds_read_b128 v[144:147], v65 offset:512
    ds_read_b128 v[148:151], v65 offset:1024
    ds_read_b128 v[152:155], v65 offset:1536
    ds_read_b128 v[156:159], v65 offset:2048
    v_subrev_u32 v64, 64, v64
    v_subrev_u32 v65, 64, v65
    s_waitcnt lgkmcnt(4)
    v_mfma_f32_16x16x32_bf16 v[108:111], v[68:71], v[140:143], v[108:111]
    s_waitcnt lgkmcnt(3)
    v_mfma_f32_16x16x32_bf16 v[112:115], v[68:71], v[144:147], v[112:115]
    s_waitcnt lgkmcnt(2)
    v_mfma_f32_16x16x32_bf16 v[116:119], v[68:71], v[148:151], v[116:119]
    s_waitcnt lgkmcnt(1)
    v_mfma_f32_16x16x32_bf16 v[120:123], v[68:71], v[152:155], v[120:123]
    s_waitcnt lgkmcnt(0)
    v_mfma_f32_16x16x32_bf16 v[124:127], v[68:71], v[156:159], v[124:127]
    s_sub_u32 s25, s25, 1
    s_cmp_lg_u32 s25, 0
    s_cbranch_scc1 ss_cv3
    v_add_u32 v65, 512, v65
    s_mov_b32 s25, 8
ss_cv4:
    ds_read2_b32 v[68:69], v64 offset0:0 offset1:1
    ds_read2_b32 v[70:71], v64 offset0:2 offset1:3
    ds_read_b128 v[144:147], v65 offset:0
    ds_read_b128 v[148:151], v65 offset:512
    ds_read_b128 v[152:155], v65 offset:1024
    ds_read_b128 v[156:159], v65 offset:1536
    v_subrev_u32 v64, 64, v64
    v_subrev_u32 v65, 64, v65
    s_waitcnt lgkmcnt(3)
    v_mfma_f32_16x16x32_bf16 v[112:115], v[68:71], v[144:147], v[112:115]
    s_waitcnt lgkmcnt(2)
    v_mfma_f32_16x16x32_bf16 v[116:119], v[68:71], v[148:151], v[116:119]
    s_waitcnt lgkmcnt(1)
    v_mfma_f32_16x16x32_bf16 v[120:123], v[68:71], v[152:155], v[120:123]
    s_waitcnt lgkmcnt(0)
    v_mfma_f32_16x16x32_bf16 v[124:127], v[68:71], v[156:159], v[124:127]
    s_sub_u32 s25, s25, 1
    s_cmp_lg_u32 s25, 0
    s_cbranch_scc1 ss_cv4
    v_add_u32 v65, 512, v65
    s_mov_b32 s25, 8
ss_cv5:
    ds_read2_b32 v[68:69], v64 offset0:0 offset1:1
    ds_read2_b32 v[70:71], v64 offset0:2 offset1:3
    ds_read_b128 v[148:151], v65 offset:0
    ds_read_b128 v[152:155], v65 offset:512
    ds_read_b128 v[156:159], v65 offset:1024
    v_subrev_u32 v64, 64, v64
    v_subrev_u32 v65, 64, v65
    s_waitcnt lgkmcnt(2)
    v_mfma_f32_16x16x32_bf16 v[116:119], v[68:71], v[148:151], v[116:119]
    s_waitcnt lgkmcnt(1)
    v_mfma_f32_16x16x32_bf16 v[120:123], v[68:71], v[152:155], v[120:123]
    s_waitcnt lgkmcnt(0)
    v_mfma_f32_16x16x32_bf16 v[124:127], v[68:71], v[156:159], v[124:127]
    s_sub_u32 s25, s25, 1
    s_cmp_lg_u32 s25, 0
    s_cbranch_scc1 ss_cv5
    v_add_u32 v65, 512, v65
    s_mov_b32 s25, 8
ss_cv6:
    ds_read2_b32 v[68:69], v64 offset0:0 offset1:1
    ds_read2_b32 v[70:71], v64 offset0:2 offset1:3
    ds_read_b128 v[152:155], v65 offset:0
    ds_read_b128 v[156:159], v65 offset:512
    v_subrev_u32 v64, 64, v64
    v_subrev_u32 v65, 64, v65
    s_waitcnt lgkmcnt(1)
    v_mfma_f32_16x16x32_bf16 v[120:123], v[68:71], v[152:155], v[120:123]
    s_waitcnt lgkmcnt(0)
    v_mfma_f32_16x16x32_bf16 v[124:127], v[68:71], v[156:159], v[124:127]
    s_sub_u32 s25, s25, 1
    s_cmp_lg_u32 s25, 0
    s_cbranch_scc1 ss_cv6
    v_add_u32 v65, 512, v65
    s_mov_b32 s25, 8
ss_cv7:
    ds_read2_b32 v[68:69], v64 offset0:0 offset1:1
    ds_read2_b32 v[70:71], v64 offset0:2 offset1:3
    ds_read_b128 v[156:159], v65 offset:0
    v_subrev_u32 v64, 64, v64
    v_subrev_u32 v65, 64, v65
    s_waitcnt lgkmcnt(0)
    v_mfma_f32_16x16x32_bf16 v[124:127], v[68:71], v[156:159], v[124:127]
    s_sub_u32 s25, s25, 1
    s_cmp_lg_u32 s25, 0
    s_cbranch_scc1 ss_cv7
    v_add_u32 v65, 512, v65
    s_nop 3
    v_lshlrev_b32 v5, 6, v2
    v_lshl_add_u32 v5, v3, 4, v5
    v_add_u32 v5, v5, v4
    ds_write_b128 v5, v[96:99] offset:7424
    ds_write_b128 v5, v[100:103] offset:8448
    ds_write_b128 v5, v[104:107] offset:9472
    ds_write_b128 v5, v[108:111] offset:10496
    ds_write_b128 v5, v[112:115] offset:11520
    ds_write_b128 v5, v[116:119] offset:12544
    ds_write_b128 v5, v[120:123] offset:13568
    ds_write_b128 v5, v[124:127] offset:14592
    s_mov_b32 s12, s74
    s_mov_b32 s13, s75
    s_mov_b32 s14, 1152
    s_mov_b32 s15, 0x20000
    s_lshl_b32 s23, s20, 1
    buffer_load_dwordx2 v[24:25], off, s[12:15], s23
    s_waitcnt vmcnt(0) lgkmcnt(0)
    s_barrier
    v_lshlrev_b32 v26, 16, v24
    v_and_b32 v27, 0xffff0000, v24
    v_lshlrev_b32 v28, 16, v25
    v_and_b32 v29, 0xffff0000, v25
    v_lshlrev_b32 v5, 5, v0
    ds_read_b128 v[64:67], v5 offset:7424
    ds_read_b128 v[68:71], v5 offset:7440
    ds_read_b128 v[72:75], v5 offset:23808
    ds_read_b128 v[76:79], v5 offset:23824
    ds_read_b128 v[80:83], v5 offset:40192
    ds_read_b128 v[84:87], v5 offset:40208
    ds_read_b128 v[88:91], v5 offset:56576
    ds_read_b128 v[92:95], v5 offset:56592
    s_waitcnt lgkmcnt(0)
    v_mul_u32_u24 v5, 18432, v0
    s_lshl_b32 s22, s20, 1
    s_add_u32 s22, s22, 1152
    v_lshlrev_b32 v6, 16, v8
    v_fmac_f32 v64, v6, v26
    v_and_b32 v6, 0xffff0000, v8
    v_fmac_f32 v72, v6, v27
    v_lshlrev_b32 v6, 16, v9
    v_fmac_f32 v80, v6, v28
    v_and_b32 v6, 0xffff0000, v9
    v_fmac_f32 v88, v6, v29
    v_cvt_pk_bf16_f32 v8, v64, v72
    v_cvt_pk_bf16_f32 v9, v80, v88
    s_add_u32 s23, s22, 0
    buffer_store_dwordx2 v[8:9], v5, s[16:19], s23 offen
    v_lshlrev_b32 v6, 16, v10
    v_fmac_f32 v65, v6, v26
    v_and_b32 v6, 0xffff0000, v10
    v_fmac_f32 v73, v6, v27
    v_lshlrev_b32 v6, 16, v11
    v_fmac_f32 v81, v6, v28
    v_and_b32 v6, 0xffff0000, v11
    v_fmac_f32 v89, v6, v29
    v_cvt_pk_bf16_f32 v10, v65, v73
    v_cvt_pk_bf16_f32 v11, v81, v89
    s_add_u32 s23, s22, 2304
    buffer_store_dwordx2 v[10:11], v5, s[16:19], s23 offen
    v_lshlrev_b32 v6, 16, v12
    v_fmac_f32 v66, v6, v26
    v_and_b32 v6, 0xffff0000, v12
    v_fmac_f32 v74, v6, v27
    v_lshlrev_b32 v6, 16, v13
    v_fmac_f32 v82, v6, v28
    v_and_b32 v6, 0xffff0000, v13
    v_fmac_f32 v90, v6, v29
    v_cvt_pk_bf16_f32 v12, v66, v74
    v_cvt_pk_bf16_f32 v13, v82, v90
    s_add_u32 s23, s22, 4608
    buffer_store_dwordx2 v[12:13], v5, s[16:19], s23 offen
    v_lshlrev_b32 v6, 16, v14
    v_fmac_f32 v67, v6, v26
    v_and_b32 v6, 0xffff0000, v14
    v_fmac_f32 v75, v6, v27
    v_lshlrev_b32 v6, 16, v15
    v_fmac_f32 v83, v6, v28
    v_and_b32 v6, 0xffff0000, v15
    v_fmac_f32 v91, v6, v29
    v_cvt_pk_bf16_f32 v14, v67, v75
    v_cvt_pk_bf16_f32 v15, v83, v91
    s_add_u32 s23, s22, 6912
    buffer_store_dwordx2 v[14:15], v5, s[16:19], s23 offen
    v_lshlrev_b32 v6, 16, v16
    v_fmac_f32 v68, v6, v26
    v_and_b32 v6, 0xffff0000, v16
    v_fmac_f32 v76, v6, v27
    v_lshlrev_b32 v6, 16, v17
    v_fmac_f32 v84, v6, v28
    v_and_b32 v6, 0xffff0000, v17
    v_fmac_f32 v92, v6, v29
    v_cvt_pk_bf16_f32 v16, v68, v76
    v_cvt_pk_bf16_f32 v17, v84, v92
    s_add_u32 s23, s22, 9216
    buffer_store_dwordx2 v[16:17], v5, s[16:19], s23 offen
    v_lshlrev_b32 v6, 16, v18
    v_fmac_f32 v69, v6, v26
    v_and_b32 v6, 0xffff0000, v18
    v_fmac_f32 v77, v6, v27
    v_lshlrev_b32 v6, 16, v19
    v_fmac_f32 v85, v6, v28
    v_and_b32 v6, 0xffff0000, v19
    v_fmac_f32 v93, v6, v29
    v_cvt_pk_bf16_f32 v18, v69, v77
    v_cvt_pk_bf16_f32 v19, v85, v93
    s_add_u32 s23, s22, 11520
    buffer_store_dwordx2 v[18:19], v5, s[16:19], s23 offen
    v_lshlrev_b32 v6, 16, v20
    v_fmac_f32 v70, v6, v26
    v_and_b32 v6, 0xffff0000, v20
    v_fmac_f32 v78, v6, v27
    v_lshlrev_b32 v6, 16, v21
    v_fmac_f32 v86, v6, v28
    v_and_b32 v6, 0xffff0000, v21
    v_fmac_f32 v94, v6, v29
    v_cvt_pk_bf16_f32 v20, v70, v78
    v_cvt_pk_bf16_f32 v21, v86, v94
    s_add_u32 s23, s22, 13824
    buffer_store_dwordx2 v[20:21], v5, s[16:19], s23 offen
    v_lshlrev_b32 v6, 16, v22
    v_fmac_f32 v71, v6, v26
    v_and_b32 v6, 0xffff0000, v22
    v_fmac_f32 v79, v6, v27
    v_lshlrev_b32 v6, 16, v23
    v_fmac_f32 v87, v6, v28
    v_and_b32 v6, 0xffff0000, v23
    v_fmac_f32 v95, v6, v29
    v_cvt_pk_bf16_f32 v22, v71, v79
    v_cvt_pk_bf16_f32 v23, v87, v95
    s_add_u32 s23, s22, 16128
    buffer_store_dwordx2 v[22:23], v5, s[16:19], s23 offen
    s_branch L_ssm_next
L_wf_next:
    s_cmp_lt_u32 s93, 100
    s_cbranch_scc1 L_exit
    s_mov_b32 s37, 20
    v_mov_b32 v250, 1
    v_mov_b32 v251, 163832
    v_cmp_eq_u32 vcc, 0, v0
    s_nop 0
    s_and_saveexec_b64 s[38:39], vcc
    s_cbranch_execz tk10
    buffer_atomic_add v250, off, s[84:87], s37 sc0
    s_waitcnt vmcnt(0)
    ds_write_b32 v251, v250
    s_waitcnt lgkmcnt(0)
tk10:
    s_mov_b64 exec, -1
    s_barrier
    ds_read_b32 v252, v251
    s_waitcnt lgkmcnt(0)
    v_readfirstlane_b32 s33, v252
    s_barrier
    s_nop 3
    s_cmp_ge_u32 s33, 160
    s_cbranch_scc1 L_phase2
    s_lshl_b32 s16, s33, 2
    s_add_u32 s16, s16, s32
    s_add_u32 s16, s16, 1504
    s_call_b64 s[46:47], L_xform
    s_lshl_b32 s40, s33, 2
    s_add_u32 s40, s40, 125841408
    s_waitcnt vmcnt(0)
    s_barrier
    v_mov_b32 v250, s95
    v_cmp_eq_u32 vcc, 0, v0
    s_nop 0
    s_and_saveexec_b64 s[38:39], vcc
    s_cbranch_execz fs11
    buffer_store_dword v250, off, s[4:7], s40 sc1
fs11:
    s_mov_b64 exec, -1
    s_branch L_wf_next
L_phase2:
    s_mov_b32 s40, 524288
mc2_w:
    buffer_load_dword v250, off, s[84:87], 0 offset:28 sc1
    s_waitcnt vmcnt(0)
    v_readfirstlane_b32 s41, v250
    s_nop 0
    s_cmp_lg_u32 s41, 0
    s_cbranch_scc1 mc2_known
    s_sub_u32 s40, s40, 1
    s_cbranch_scc1 mc2_force
    s_sleep 2
    s_branch mc2_w
mc2_force:
    v_mov_b32 v250, 2
    v_mov_b32 v251, 0
    s_mov_b64 exec, 1
    buffer_atomic_cmpswap v[250:251], off, s[84:87], 0 offset:28
    s_mov_b64 exec, -1
    s_waitcnt vmcnt(0)
    s_mov_b32 s40, 524288
    s_branch mc2_w
mc2_known:
    s_cmp_eq_u32 s41, 1
    s_cbranch_scc1 L_phase2b
    s_mov_b32 s37, 208
    v_mov_b32 v250, 1
    v_mov_b32 v251, 163832
    v_cmp_eq_u32 vcc, 0, v0
    s_nop 0
    s_and_saveexec_b64 s[38:39], vcc
    s_cbranch_execz tk12
    buffer_atomic_add v250, off, s[84:87], s37 sc0
    s_waitcnt vmcnt(0)
    ds_write_b32 v251, v250
    s_waitcnt lgkmcnt(0)
tk12:
    s_mov_b64 exec, -1
    s_barrier
    ds_read_b32 v252, v251
    s_waitcnt lgkmcnt(0)
    v_readfirstlane_b32 s12, v252
    s_barrier
    s_nop 3
    s_cmp_lt_u32 s12, 32
    s_cbranch_scc1 L_chain_safe
L_phase2b:
    s_mov_b32 s8, s76
    s_mov_b32 s9, s77
    s_mov_b32 s10, 4718592
    s_mov_b32 s11, 0x20000
    s_mov_b32 s37, 12
    v_mov_b32 v250, 1
    v_mov_b32 v251, 163832
    v_cmp_eq_u32 vcc, 0, v0
    s_nop 0
    s_and_saveexec_b64 s[38:39], vcc
    s_cbranch_execz tk13
    buffer_atomic_add v250, off, s[84:87], s37 sc0
    s_waitcnt vmcnt(0)
    ds_write_b32 v251, v250
    s_waitcnt lgkmcnt(0)
tk13:
    s_mov_b64 exec, -1
    s_barrier
    ds_read_b32 v252, v251
    s_waitcnt lgkmcnt(0)
    v_readfirstlane_b32 s36, v252
    s_barrier
    s_nop 3
    s_mul_hi_u32 s37, s36, 0x55555556
    s_mul_i32 s40, s37, 3
    s_sub_u32 s33, s36, s37
    s_mul_hi_u32 s41, s33, 0x0e38e38f
    s_mul_i32 s41, s41, 18
    s_sub_u32 s33, s33, s41
    s_cmp_lg_u32 s40, s36
    s_cbranch_scc1 L_op_start
L_att_next:
    s_mov_b32 s37, 16
    v_mov_b32 v250, 1
    v_mov_b32 v251, 163832
    v_cmp_eq_u32 vcc, 0, v0
    s_nop 0
    s_and_saveexec_b64 s[38:39], vcc
    s_cbranch_execz tk14
    buffer_atomic_add v250, off, s[84:87], s37 sc0
    s_waitcnt vmcnt(0)
    ds_write_b32 v251, v250
    s_waitcnt lgkmcnt(0)
tk14:
    s_mov_b64 exec, -1
    s_barrier
    ds_read_b32 v252, v251
    s_waitcnt lgkmcnt(0)
    v_readfirstlane_b32 s34, v252
    s_barrier
    s_nop 3
    s_cmp_ge_u32 s34, 512
    s_cbranch_scc1 L_op_nextcb
    s_lshr_b32 s16, s34, 3
    s_and_b32 s17, s34, 7
    s_lshl_b32 s17, s17, 2
    s_add_u32 s17, s17, s32
    s_lshl_b32 s36, s17, 7
    s_add_u32 s36, s36, 125829120
    s_lshr_b32 s41, s16, 2
    s_add_u32 s41, s41, s95
    s_add_u32 s41, s41, 1
    v_and_b32 v1, 3, v0
    v_min_u32 v1, 2, v1
    v_lshlrev_b32 v2, 4, v1
    s_and_b32 s37, s16, 3
    s_lshl_b32 s37, s37, 2
    v_add_u32 v2, s37, v2
    s_mov_b32 s40, 4194304
L_aw1:
    buffer_load_dword v3, v2, s[4:7], s36 offen sc1
    s_sub_u32 s40, s40, 1
    s_cbranch_scc1 L_aw1_go
    s_waitcnt vmcnt(0)
    v_subrev_u32 v3, s41, v3
    v_cmp_lt_u32 vcc, 64, v3
    s_cbranch_vccz L_aw1_go
    s_sleep 4
    s_branch L_aw1
L_aw1_go:
    v_and_b32 v5, 63, v0
    v_lshlrev_b32 v1, 4, v5
    s_cmp_ge_u32 s16, 58
    s_cselect_b32 s18, -1, 511
    v_and_b32 v2, s18, v1
    v_or_b32 v3, 128, v1
    v_lshrrev_b32 v4, 4, v5
    v_bfe_u32 v6, v5, 2, 2
    v_sub_u32 v4, v6, v4
    v_lshlrev_b32 v4, 3, v4
    v_and_b32 v6, 3, v5
    v_add_u32 v4, v4, v6
    v_mov_b32 v6, 0xf149f2ca
    s_mov_b32 s22, 0x3e0293ee
    s_lshl_b32 s18, s16, 5
    s_add_u32 s18, s18, s17
    s_lshl_b32 s19, s18, 13
    s_add_u32 s20, s19, 33554432
    buffer_load_dwordx4 v[8:11], v1, s[4:7], s20 offen offset:0 sc1
    s_add_u32 s20, s19, 33554432
    buffer_load_dwordx4 v[12:15], v1, s[4:7], s20 offen offset:1024 sc1
    s_add_u32 s20, s19, 33554432
    buffer_load_dwordx4 v[16:19], v1, s[4:7], s20 offen offset:2048 sc1
    s_add_u32 s20, s19, 33554432
    buffer_load_dwordx4 v[20:23], v1, s[4:7], s20 offen offset:3072 sc1
    s_add_u32 s20, s19, 33558528
    buffer_load_dwordx4 v[24:27], v1, s[4:7], s20 offen offset:0 sc1
    s_add_u32 s20, s19, 33558528
    buffer_load_dwordx4 v[28:31], v1, s[4:7], s20 offen offset:1024 sc1
    s_add_u32 s20, s19, 33558528
    buffer_load_dwordx4 v[32:35], v1, s[4:7], s20 offen offset:2048 sc1
    s_add_u32 s20, s19, 33558528
    buffer_load_dwordx4 v[36:39], v1, s[4:7], s20 offen offset:3072 sc1
    s_lshl_b32 s21, s18, 14
    s_add_u32 s20, s21, 0
    buffer_load_dwordx4 v[40:43], v1, s[4:7], s20 offen offset:0 sc1
    s_add_u32 s20, s21, 4096
    buffer_load_dwordx4 v[44:47], v1, s[4:7], s20 offen offset:0 sc1
    s_add_u32 s20, s21, 8192
    buffer_load_dwordx4 v[48:51], v1, s[4:7], s20 offen offset:0 sc1
    s_add_u32 s20, s21, 12288
    buffer_load_dwordx4 v[52:55], v1, s[4:7], s20 offen offset:0 sc1
    s_add_u32 s20, s21, 0
    buffer_load_dwordx4 v[56:59], v1, s[4:7], s20 offen offset:1024 sc1
    s_add_u32 s20, s21, 4096
    buffer_load_dwordx4 v[60:63], v1, s[4:7], s20 offen offset:1024 sc1
    s_add_u32 s20, s21, 8192
    buffer_load_dwordx4 v[64:67], v1, s[4:7], s20 offen offset:1024 sc1
    s_add_u32 s20, s21, 12288
    buffer_load_dwordx4 v[68:71], v1, s[4:7], s20 offen offset:1024 sc1
    s_add_u32 s20, s21, 0
    buffer_load_dwordx4 v[88:91], v1, s[4:7], s20 offen offset:2048 sc1
    s_add_u32 s20, s21, 4096
    buffer_load_dwordx4 v[92:95], v1, s[4:7], s20 offen offset:2048 sc1
    s_add_u32 s20, s21, 8192
    buffer_load_dwordx4 v[96:99], v1, s[4:7], s20 offen offset:2048 sc1
    s_add_u32 s20, s21, 12288
    buffer_load_dwordx4 v[100:103], v1, s[4:7], s20 offen offset:2048 sc1
    s_add_u32 s20, s21, 0
    buffer_load_dwordx4 v[104:107], v1, s[4:7], s20 offen offset:3072 sc1
    s_add_u32 s20, s21, 4096
    buffer_load_dwordx4 v[108:111], v1, s[4:7], s20 offen offset:3072 sc1
    s_add_u32 s20, s21, 8192
    buffer_load_dwordx4 v[112:115], v1, s[4:7], s20 offen offset:3072 sc1
    s_add_u32 s20, s21, 12288
    buffer_load_dwordx4 v[116:119], v1, s[4:7], s20 offen offset:3072 sc1
    v_mov_b32 v172, 0x3f803f80
    v_mov_b32 v173, 0x3f803f80
    v_mov_b32 v174, 0x3f803f80
    v_mov_b32 v175, 0x3f803f80
    v_mov_b32 v176, 0x3f003f00
    v_mov_b32 v177, 0x3f003f00
    s_waitcnt vmcnt(8)
    v_mfma_f32_16x16x32_bf16 v[136:139], v[40:43], v[8:11], 0
    v_mfma_f32_16x16x32_bf16 v[140:143], v[56:59], v[8:11], 0
    v_mfma_f32_16x16x32_bf16 v[148:151], v[40:43], v[24:27], 0
    v_mfma_f32_16x16x32_bf16 v[152:155], v[56:59], v[24:27], 0
    v_mfma_f32_16x16x32_bf16 v[136:139], v[44:47], v[12:15], v[136:139]
    v_mfma_f32_16x16x32_bf16 v[140:143], v[60:63], v[12:15], v[140:143]
    v_mfma_f32_16x16x32_bf16 v[148:151], v[44:47], v[28:31], v[148:151]
    v_mfma_f32_16x16x32_bf16 v[152:155], v[60:63], v[28:31], v[152:155]
    v_mfma_f32_16x16x32_bf16 v[136:139], v[48:51], v[16:19], v[136:139]
    v_mfma_f32_16x16x32_bf16 v[140:143], v[64:67], v[16:19], v[140:143]
    v_mfma_f32_16x16x32_bf16 v[148:151], v[48:51], v[32:35], v[148:151]
    v_mfma_f32_16x16x32_bf16 v[152:155], v[64:67], v[32:35], v[152:155]
    v_mfma_f32_16x16x32_bf16 v[136:139], v[52:55], v[20:23], v[136:139]
    v_mfma_f32_16x16x32_bf16 v[140:143], v[68:71], v[20:23], v[140:143]
    v_mfma_f32_16x16x32_bf16 v[148:151], v[52:55], v[36:39], v[148:151]
    v_mfma_f32_16x16x32_bf16 v[152:155], v[68:71], v[36:39], v[152:155]
    v_cmp_le_i32 vcc, 0, v4
    s_nop 3
    v_cndmask_b32 v136, v6, v136, vcc
    v_cmp_le_i32 vcc, 1, v4
    s_nop 1
    v_cndmask_b32 v137, v6, v137, vcc
    v_cmp_le_i32 vcc, 2, v4
    s_nop 1
    v_cndmask_b32 v138, v6, v138, vcc
    v_cmp_le_i32 vcc, 3, v4
    s_nop 1
    v_cndmask_b32 v139, v6, v139, vcc
    v_cmp_le_i32 vcc, 4, v4
    s_nop 1
    v_cndmask_b32 v140, v6, v140, vcc
    v_cmp_le_i32 vcc, 5, v4
    s_nop 1
    v_cndmask_b32 v141, v6, v141, vcc
    v_cmp_le_i32 vcc, 6, v4
    s_nop 1
    v_cndmask_b32 v142, v6, v142, vcc
    v_cmp_le_i32 vcc, 7, v4
    s_nop 1
    v_cndmask_b32 v143, v6, v143, vcc
    v_cmp_le_i32 vcc, -4, v4
    s_nop 1
    v_cndmask_b32 v148, v6, v148, vcc
    v_cmp_le_i32 vcc, -3, v4
    s_nop 1
    v_cndmask_b32 v149, v6, v149, vcc
    v_cmp_le_i32 vcc, -2, v4
    s_nop 1
    v_cndmask_b32 v150, v6, v150, vcc
    v_cmp_le_i32 vcc, -1, v4
    s_nop 1
    v_cndmask_b32 v151, v6, v151, vcc
    v_cmp_le_i32 vcc, 0, v4
    s_nop 1
    v_cndmask_b32 v152, v6, v152, vcc
    v_cmp_le_i32 vcc, 1, v4
    s_nop 1
    v_cndmask_b32 v153, v6, v153, vcc
    v_cmp_le_i32 vcc, 2, v4
    s_nop 1
    v_cndmask_b32 v154, v6, v154, vcc
    v_cmp_le_i32 vcc, 3, v4
    s_nop 1
    v_cndmask_b32 v155, v6, v155, vcc
    s_nop 1
    v_and_b32 v198, 1, v0
    v_lshlrev_b32 v198, 2, v198
    v_add_u32 v198, 48, v198
    s_add_u32 s41, s16, s95
    s_add_u32 s41, s41, 1
    s_cmp_lt_u32 s16, 58
    s_cbranch_scc1 L_amk
    v_mov_b32 v198, 16384
L_amk:
    s_nop 1
    s_mov_b32 s88, 65536
    s_mov_b32 s89, 125853696
cw15:
    buffer_load_dword v199, off, s[4:7], s89 sc1
    s_waitcnt vmcnt(0)
    v_readfirstlane_b32 s42, v199
    s_nop 0
    s_sub_u32 s42, s42, s95
    s_cmp_gt_u32 s42, 64
    s_cselect_b32 s42, 0, s42
    s_add_u32 s42, s42, 1
    s_cmp_ge_u32 s42, s16
    s_cbranch_scc1 cw15x
    s_sub_u32 s88, s88, 1
    s_cbranch_scc1 cw15x
    s_sub_u32 s42, s16, s42
    s_min_u32 s42, s42, 6
cw15s:
    s_sleep 24
    s_sub_u32 s42, s42, 1
    s_cmp_lg_u32 s42, 0
    s_cbranch_scc1 cw15s
    s_branch cw15
cw15x:
    s_mov_b32 s40, 4194304
L_aw2:
    buffer_load_dword v199, v198, s[4:7], s36 offen sc1
    s_sub_u32 s40, s40, 1
    s_cbranch_scc1 L_aw2_go
    s_waitcnt vmcnt(0)
    v_subrev_u32 v199, s41, v199
    v_cmp_lt_u32 vcc, 64, v199
    s_cbranch_vccz L_aw2_go
    s_sleep 1
    s_branch L_aw2
L_aw2_go:
    s_lshl_b32 s20, s18, 12
    s_add_u32 s20, s20, 69206016
    buffer_load_dwordx4 v[72:75], v3, s[4:7], s20 offen offset:0 sc1
    buffer_load_dwordx4 v[76:79], v3, s[4:7], s20 offen offset:1024 sc1
    buffer_load_dwordx4 v[80:83], v3, s[4:7], s20 offen offset:2048 sc1
    buffer_load_dwordx4 v[84:87], v3, s[4:7], s20 offen offset:3072 sc1
    s_lshl_b32 s20, s18, 12
    s_add_u32 s20, s20, 77594624
    buffer_load_dwordx4 v[120:123], v2, s[4:7], s20 offen offset:0 sc1
    buffer_load_dwordx4 v[124:127], v2, s[4:7], s20 offen offset:1024 sc1
    buffer_load_dwordx4 v[128:131], v2, s[4:7], s20 offen offset:2048 sc1
    buffer_load_dwordx4 v[132:135], v2, s[4:7], s20 offen offset:3072 sc1
    s_waitcnt vmcnt(4)
    v_mfma_f32_16x16x32_bf16 v[144:147], v[72:75], v[8:11], 0
    v_mfma_f32_16x16x32_bf16 v[156:159], v[72:75], v[24:27], 0
    v_mfma_f32_16x16x32_bf16 v[144:147], v[76:79], v[12:15], v[144:147]
    v_mfma_f32_16x16x32_bf16 v[156:159], v[76:79], v[28:31], v[156:159]
    v_mfma_f32_16x16x32_bf16 v[144:147], v[80:83], v[16:19], v[144:147]
    v_mfma_f32_16x16x32_bf16 v[156:159], v[80:83], v[32:35], v[156:159]
    v_mfma_f32_16x16x32_bf16 v[144:147], v[84:87], v[20:23], v[144:147]
    v_mfma_f32_16x16x32_bf16 v[156:159], v[84:87], v[36:39], v[156:159]
    v_max3_f32 v196, v136, v137, v138
    v_max3_f32 v197, v139, v140, v141
    v_max3_f32 v196, v196, v142, v143
    s_nop 3
    v_max3_f32 v197, v197, v144, v145
    v_max3_f32 v196, v196, v146, v147
    v_max_f32 v196, v196, v197
    v_mov_b32 v197, v196
    s_nop 1
    v_permlane32_swap_b32 v196, v197
    v_max_f32 v196, v196, v197
    v_mov_b32 v197, v196
    s_nop 1
    v_permlane16_swap_b32 v196, v197
    v_max_f32 v196, v196, v197
    v_mul_f32 v196, s22, v196
    v_sub_f32 v196, 0, v196
    v_fma_f32 v136, v136, s22, v196
    v_fma_f32 v137, v137, s22, v196
    v_fma_f32 v138, v138, s22, v196
    v_fma_f32 v139, v139, s22, v196
    v_fma_f32 v140, v140, s22, v196
    v_fma_f32 v141, v141, s22, v196
    v_fma_f32 v142, v142, s22, v196
    v_fma_f32 v143, v143, s22, v196
    v_fma_f32 v144, v144, s22, v196
    v_fma_f32 v145, v145, s22, v196
    v_fma_f32 v146, v146, s22, v196
    v_fma_f32 v147, v147, s22, v196
    v_exp_f32 v136, v136
    v_exp_f32 v137, v137
    v_exp_f32 v138, v138
    v_exp_f32 v139, v139
    v_exp_f32 v140, v140
    v_exp_f32 v141, v141
    v_exp_f32 v142, v142
    v_exp_f32 v143, v143
    v_exp_f32 v144, v144
    v_exp_f32 v145, v145
    v_exp_f32 v146, v146
    v_exp_f32 v147, v147
    v_cvt_pk_bf16_f32 v160, v136, v137
    v_cvt_pk_bf16_f32 v161, v138, v139
    v_cvt_pk_bf16_f32 v162, v140, v141
    v_cvt_pk_bf16_f32 v163, v142, v143
    v_cvt_pk_bf16_f32 v164, v144, v145
    v_cvt_pk_bf16_f32 v165, v146, v147
    v_max3_f32 v196, v148, v149, v150
    v_max3_f32 v197, v151, v152, v153
    v_max3_f32 v196, v196, v154, v155
    v_max3_f32 v197, v197, v156, v157
    v_max3_f32 v196, v196, v158, v159
    v_max_f32 v196, v196, v197
    v_mov_b32 v197, v196
    s_nop 1
    v_permlane32_swap_b32 v196, v197
    v_max_f32 v196, v196, v197
    v_mov_b32 v197, v196
    s_nop 1
    v_permlane16_swap_b32 v196, v197
    v_max_f32 v196, v196, v197
    v_mul_f32 v196, s22, v196
    v_sub_f32 v196, 0, v196
    v_fma_f32 v148, v148, s22, v196
    v_fma_f32 v149, v149, s22, v196
    v_fma_f32 v150, v150, s22, v196
    v_fma_f32 v151, v151, s22, v196
    v_fma_f32 v152, v152, s22, v196
    v_fma_f32 v153, v153, s22, v196
    v_fma_f32 v154, v154, s22, v196
    v_fma_f32 v155, v155, s22, v196
    v_fma_f32 v156, v156, s22, v196
    v_fma_f32 v157, v157, s22, v196
    v_fma_f32 v158, v158, s22, v196
    v_fma_f32 v159, v159, s22, v196
    v_exp_f32 v148, v148
    v_exp_f32 v149, v149
    v_exp_f32 v150, v150
    v_exp_f32 v151, v151
    v_exp_f32 v152, v152
    v_exp_f32 v153, v153
    v_exp_f32 v154, v154
    v_exp_f32 v155, v155
    v_exp_f32 v156, v156
    v_exp_f32 v157, v157
    v_exp_f32 v158, v158
    v_exp_f32 v159, v159
    v_cvt_pk_bf16_f32 v166, v148, v149
    v_cvt_pk_bf16_f32 v167, v150, v151
    v_cvt_pk_bf16_f32 v168, v152, v153
    v_cvt_pk_bf16_f32 v169, v154, v155
    v_cvt_pk_bf16_f32 v170, v156, v157
    v_cvt_pk_bf16_f32 v171, v158, v159
    v_mfma_f32_16x16x32_bf16 v[180:183], v[172:175], v[160:163], 0
    v_mfma_f32_16x16x32_bf16 v[184:187], v[172:175], v[166:169], 0
    s_nop 4
    v_mfma_f32_16x16x16_bf16 v[180:183], v[176:177], v[164:165], v[180:183]
    v_mfma_f32_16x16x16_bf16 v[184:187], v[176:177], v[170:171], v[184:187]
    s_nop 6
    v_rcp_f32 v180, v180
    v_rcp_f32 v184, v184
    s_waitcnt vmcnt(0)
    s_lshl_b32 s18, s16, 18
    s_lshl_b32 s19, s17, 12
    s_add_u32 s18, s18, s19
    s_add_u32 s18, s18, 50331648
    s_add_u32 s19, s18, 131072
    v_mfma_f32_16x16x32_bf16 v[8:11], v[88:91], v[160:163], 0
    v_mfma_f32_16x16x32_bf16 v[12:15], v[104:107], v[160:163], 0
    v_mfma_f32_16x16x32_bf16 v[16:19], v[88:91], v[166:169], 0
    v_mfma_f32_16x16x32_bf16 v[20:23], v[104:107], v[166:169], 0
    v_mfma_f32_16x16x32_bf16 v[24:27], v[92:95], v[160:163], 0
    v_mfma_f32_16x16x32_bf16 v[28:31], v[108:111], v[160:163], 0
    v_mfma_f32_16x16x32_bf16 v[32:35], v[92:95], v[166:169], 0
    v_mfma_f32_16x16x32_bf16 v[36:39], v[108:111], v[166:169], 0
    v_mfma_f32_16x16x32_bf16 v[40:43], v[96:99], v[160:163], 0
    v_mfma_f32_16x16x32_bf16 v[44:47], v[112:115], v[160:163], 0
    v_mfma_f32_16x16x32_bf16 v[48:51], v[96:99], v[166:169], 0
    v_mfma_f32_16x16x32_bf16 v[52:55], v[112:115], v[166:169], 0
    v_mfma_f32_16x16x32_bf16 v[56:59], v[100:103], v[160:163], 0
    v_mfma_f32_16x16x32_bf16 v[60:63], v[116:119], v[160:163], 0
    v_mfma_f32_16x16x32_bf16 v[64:67], v[100:103], v[166:169], 0
    v_mfma_f32_16x16x32_bf16 v[68:71], v[116:119], v[166:169], 0
    v_mfma_f32_16x16x16_bf16 v[8:11], v[120:121], v[164:165], v[8:11]
    v_mfma_f32_16x16x16_bf16 v[12:15], v[122:123], v[164:165], v[12:15]
    v_mfma_f32_16x16x16_bf16 v[16:19], v[120:121], v[170:171], v[16:19]
    v_mfma_f32_16x16x16_bf16 v[20:23], v[122:123], v[170:171], v[20:23]
    v_mfma_f32_16x16x16_bf16 v[24:27], v[124:125], v[164:165], v[24:27]
    v_mfma_f32_16x16x16_bf16 v[28:31], v[126:127], v[164:165], v[28:31]
    v_mfma_f32_16x16x16_bf16 v[32:35], v[124:125], v[170:171], v[32:35]
    v_mfma_f32_16x16x16_bf16 v[36:39], v[126:127], v[170:171], v[36:39]
    v_mfma_f32_16x16x16_bf16 v[40:43], v[128:129], v[164:165], v[40:43]
    v_mfma_f32_16x16x16_bf16 v[44:47], v[130:131], v[164:165], v[44:47]
    v_mfma_f32_16x16x16_bf16 v[48:51], v[128:129], v[170:171], v[48:51]
    v_mfma_f32_16x16x16_bf16 v[52:55], v[130:131], v[170:171], v[52:55]
    v_mfma_f32_16x16x16_bf16 v[56:59], v[132:133], v[164:165], v[56:59]
    v_mfma_f32_16x16x16_bf16 v[60:63], v[134:135], v[164:165], v[60:63]
    v_mfma_f32_16x16x16_bf16 v[64:67], v[132:133], v[170:171], v[64:67]
    v_mfma_f32_16x16x16_bf16 v[68:71], v[134:135], v[170:171], v[68:71]
    v_mul_f32 v8, v8, v180
    v_mul_f32 v12, v12, v180
    v_mul_f32 v9, v9, v180
    v_mul_f32 v13, v13, v180
    v_mul_f32 v10, v10, v180
    v_mul_f32 v14, v14, v180
    v_mul_f32 v11, v11, v180
    v_mul_f32 v15, v15, v180
    v_cvt_pk_bf16_f32 v8, v8, v9
    v_cvt_pk_bf16_f32 v9, v10, v11
    v_cvt_pk_bf16_f32 v10, v12, v13
    v_cvt_pk_bf16_f32 v11, v14, v15
    buffer_store_dwordx4 v[8:11], v1, s[4:7], s18 offen offset:0 sc1
    v_mul_f32 v16, v16, v184
    v_mul_f32 v20, v20, v184
    v_mul_f32 v17, v17, v184
    v_mul_f32 v21, v21, v184
    v_mul_f32 v18, v18, v184
    v_mul_f32 v22, v22, v184
    v_mul_f32 v19, v19, v184
    v_mul_f32 v23, v23, v184
    v_cvt_pk_bf16_f32 v16, v16, v17
    v_cvt_pk_bf16_f32 v17, v18, v19
    v_cvt_pk_bf16_f32 v18, v20, v21
    v_cvt_pk_bf16_f32 v19, v22, v23
    buffer_store_dwordx4 v[16:19], v1, s[4:7], s19 offen offset:0 sc1
    v_mul_f32 v24, v24, v180
    v_mul_f32 v28, v28, v180
    v_mul_f32 v25, v25, v180
    v_mul_f32 v29, v29, v180
    v_mul_f32 v26, v26, v180
    v_mul_f32 v30, v30, v180
    v_mul_f32 v27, v27, v180
    v_mul_f32 v31, v31, v180
    v_cvt_pk_bf16_f32 v24, v24, v25
    v_cvt_pk_bf16_f32 v25, v26, v27
    v_cvt_pk_bf16_f32 v26, v28, v29
    v_cvt_pk_bf16_f32 v27, v30, v31
    buffer_store_dwordx4 v[24:27], v1, s[4:7], s18 offen offset:1024 sc1
    v_mul_f32 v32, v32, v184
    v_mul_f32 v36, v36, v184
    v_mul_f32 v33, v33, v184
    v_mul_f32 v37, v37, v184
    v_mul_f32 v34, v34, v184
    v_mul_f32 v38, v38, v184
    v_mul_f32 v35, v35, v184
    v_mul_f32 v39, v39, v184
    v_cvt_pk_bf16_f32 v32, v32, v33
    v_cvt_pk_bf16_f32 v33, v34, v35
    v_cvt_pk_bf16_f32 v34, v36, v37
    v_cvt_pk_bf16_f32 v35, v38, v39
    buffer_store_dwordx4 v[32:35], v1, s[4:7], s19 offen offset:1024 sc1
    v_mul_f32 v40, v40, v180
    v_mul_f32 v44, v44, v180
    v_mul_f32 v41, v41, v180
    v_mul_f32 v45, v45, v180
    v_mul_f32 v42, v42, v180
    v_mul_f32 v46, v46, v180
    v_mul_f32 v43, v43, v180
    v_mul_f32 v47, v47, v180
    v_cvt_pk_bf16_f32 v40, v40, v41
    v_cvt_pk_bf16_f32 v41, v42, v43
    v_cvt_pk_bf16_f32 v42, v44, v45
    v_cvt_pk_bf16_f32 v43, v46, v47
    buffer_store_dwordx4 v[40:43], v1, s[4:7], s18 offen offset:2048 sc1
    v_mul_f32 v48, v48, v184
    v_mul_f32 v52, v52, v184
    v_mul_f32 v49, v49, v184
    v_mul_f32 v53, v53, v184
    v_mul_f32 v50, v50, v184
    v_mul_f32 v54, v54, v184
    v_mul_f32 v51, v51, v184
    v_mul_f32 v55, v55, v184
    v_cvt_pk_bf16_f32 v48, v48, v49
    v_cvt_pk_bf16_f32 v49, v50, v51
    v_cvt_pk_bf16_f32 v50, v52, v53
    v_cvt_pk_bf16_f32 v51, v54, v55
    buffer_store_dwordx4 v[48:51], v1, s[4:7], s19 offen offset:2048 sc1
    v_mul_f32 v56, v56, v180
    v_mul_f32 v60, v60, v180
    v_mul_f32 v57, v57, v180
    v_mul_f32 v61, v61, v180
    v_mul_f32 v58, v58, v180
    v_mul_f32 v62, v62, v180
    v_mul_f32 v59, v59, v180
    v_mul_f32 v63, v63, v180
    v_cvt_pk_bf16_f32 v56, v56, v57
    v_cvt_pk_bf16_f32 v57, v58, v59
    v_cvt_pk_bf16_f32 v58, v60, v61
    v_cvt_pk_bf16_f32 v59, v62, v63
    buffer_store_dwordx4 v[56:59], v1, s[4:7], s18 offen offset:3072 sc1
    v_mul_f32 v64, v64, v184
    v_mul_f32 v68, v68, v184
    v_mul_f32 v65, v65, v184
    v_mul_f32 v69, v69, v184
    v_mul_f32 v66, v66, v184
    v_mul_f32 v70, v70, v184
    v_mul_f32 v67, v67, v184
    v_mul_f32 v71, v71, v184
    v_cvt_pk_bf16_f32 v64, v64, v65
    v_cvt_pk_bf16_f32 v65, v66, v67
    v_cvt_pk_bf16_f32 v66, v68, v69
    v_cvt_pk_bf16_f32 v67, v70, v71
    buffer_store_dwordx4 v[64:67], v1, s[4:7], s19 offen offset:3072 sc1
    s_lshr_b32 s40, s34, 1
    s_lshl_b32 s40, s40, 7
    s_and_b32 s41, s34, 1
    s_lshl_b32 s41, s41, 2
    s_add_u32 s40, s40, s41
    s_add_u32 s40, s40, 125894656
    s_waitcnt vmcnt(0)
    s_barrier
    v_mov_b32 v250, s95
    v_cmp_eq_u32 vcc, 0, v0
    s_nop 0
    s_and_saveexec_b64 s[38:39], vcc
    s_cbranch_execz fs16
    buffer_store_dword v250, off, s[4:7], s40 sc1
fs16:
    s_mov_b64 exec, -1
    s_branch L_att_next
L_op_start:
    s_lshl_b32 s35, s33, 2
    s_add_u32 s35, s35, 136
    s_lshr_b32 s89, s33, 2
    s_lshl_b32 s89, s89, 7
    s_add_u32 s89, s89, 125841408
    v_mbcnt_lo_u32_b32 v2, -1, 0
    v_mbcnt_hi_u32_b32 v2, -1, v2
    v_min_u32 v2, 31, v2
    v_lshlrev_b32 v2, 2, v2
    s_mov_b32 s88, 4194304
fw17:
    buffer_load_dword v3, v2, s[4:7], s89 offen offset:0 sc1
    s_sub_u32 s88, s88, 1
    s_cbranch_scc1 fw17x
    s_waitcnt vmcnt(0)
    v_cmp_ne_u32 vcc, s95, v3
    s_cbranch_vccz fw17x
    s_sleep 4
    s_branch fw17
fw17x:
    v_and_b32 v1, 63, v0
    v_lshlrev_b32 v1, 4, v1
    s_lshl_b32 s18, s33, 18
    s_lshl_b32 s19, s32, 16
    s_add_u32 s18, s18, s19
    s_add_u32 s18, s18, 130023424
    buffer_load_dwordx4 a[0:3], v1, s[4:7], s18 offen offset:0 sc1
    buffer_load_dwordx4 a[4:7], v1, s[4:7], s18 offen offset:1024 sc1
    buffer_load_dwordx4 a[8:11], v1, s[4:7], s18 offen offset:2048 sc1
    buffer_load_dwordx4 a[12:15], v1, s[4:7], s18 offen offset:3072 sc1
    s_add_u32 s18, s18, 4096
    buffer_load_dwordx4 a[16:19], v1, s[4:7], s18 offen offset:0 sc1
    buffer_load_dwordx4 a[20:23], v1, s[4:7], s18 offen offset:1024 sc1
    buffer_load_dwordx4 a[24:27], v1, s[4:7], s18 offen offset:2048 sc1
    buffer_load_dwordx4 a[28:31], v1, s[4:7], s18 offen offset:3072 sc1
    s_add_u32 s18, s18, 4096
    buffer_load_dwordx4 a[32:35], v1, s[4:7], s18 offen offset:0 sc1
    buffer_load_dwordx4 a[36:39], v1, s[4:7], s18 offen offset:1024 sc1
    buffer_load_dwordx4 a[40:43], v1, s[4:7], s18 offen offset:2048 sc1
    buffer_load_dwordx4 a[44:47], v1, s[4:7], s18 offen offset:3072 sc1
    s_add_u32 s18, s18, 4096
    buffer_load_dwordx4 a[48:51], v1, s[4:7], s18 offen offset:0 sc1
    buffer_load_dwordx4 a[52:55], v1, s[4:7], s18 offen offset:1024 sc1
    buffer_load_dwordx4 a[56:59], v1, s[4:7], s18 offen offset:2048 sc1
    buffer_load_dwordx4 a[60:63], v1, s[4:7], s18 offen offset:3072 sc1
    s_add_u32 s18, s18, 4096
    buffer_load_dwordx4 a[64:67], v1, s[4:7], s18 offen offset:0 sc1
    buffer_load_dwordx4 a[68:71], v1, s[4:7], s18 offen offset:1024 sc1
    buffer_load_dwordx4 a[72:75], v1, s[4:7], s18 offen offset:2048 sc1
    buffer_load_dwordx4 a[76:79], v1, s[4:7], s18 offen offset:3072 sc1
    s_add_u32 s18, s18, 4096
    buffer_load_dwordx4 a[80:83], v1, s[4:7], s18 offen offset:0 sc1
    buffer_load_dwordx4 a[84:87], v1, s[4:7], s18 offen offset:1024 sc1
    buffer_load_dwordx4 a[88:91], v1, s[4:7], s18 offen offset:2048 sc1
    buffer_load_dwordx4 a[92:95], v1, s[4:7], s18 offen offset:3072 sc1
    s_add_u32 s18, s18, 4096
    buffer_load_dwordx4 a[96:99], v1, s[4:7], s18 offen offset:0 sc1
    buffer_load_dwordx4 a[100:103], v1, s[4:7], s18 offen offset:1024 sc1
    buffer_load_dwordx4 a[104:107], v1, s[4:7], s18 offen offset:2048 sc1
    buffer_load_dwordx4 a[108:111], v1, s[4:7], s18 offen offset:3072 sc1
    s_add_u32 s18, s18, 4096
    buffer_load_dwordx4 a[112:115], v1, s[4:7], s18 offen offset:0 sc1
    buffer_load_dwordx4 a[116:119], v1, s[4:7], s18 offen offset:1024 sc1
    buffer_load_dwordx4 a[120:123], v1, s[4:7], s18 offen offset:2048 sc1
    buffer_load_dwordx4 a[124:127], v1, s[4:7], s18 offen offset:3072 sc1
    s_add_u32 s18, s18, 4096
    buffer_load_dwordx4 a[128:131], v1, s[4:7], s18 offen offset:0 sc1
    buffer_load_dwordx4 a[132:135], v1, s[4:7], s18 offen offset:1024 sc1
    buffer_load_dwordx4 a[136:139], v1, s[4:7], s18 offen offset:2048 sc1
    buffer_load_dwordx4 a[140:143], v1, s[4:7], s18 offen offset:3072 sc1
    s_add_u32 s18, s18, 4096
    buffer_load_dwordx4 a[144:147], v1, s[4:7], s18 offen offset:0 sc1
    buffer_load_dwordx4 a[148:151], v1, s[4:7], s18 offen offset:1024 sc1
    buffer_load_dwordx4 a[152:155], v1, s[4:7], s18 offen offset:2048 sc1
    buffer_load_dwordx4 a[156:159], v1, s[4:7], s18 offen offset:3072 sc1
    s_add_u32 s18, s18, 4096
    buffer_load_dwordx4 a[160:163], v1, s[4:7], s18 offen offset:0 sc1
    s_waitcnt vmcnt(20)
    buffer_load_dwordx4 a[164:167], v1, s[4:7], s18 offen offset:1024 sc1
    buffer_load_dwordx4 a[168:171], v1, s[4:7], s18 offen offset:2048 sc1
    buffer_load_dwordx4 a[172:175], v1, s[4:7], s18 offen offset:3072 sc1
    s_add_u32 s18, s18, 4096
    buffer_load_dwordx4 a[176:179], v1, s[4:7], s18 offen offset:0 sc1
    buffer_load_dwordx4 a[180:183], v1, s[4:7], s18 offen offset:1024 sc1
    buffer_load_dwordx4 a[184:187], v1, s[4:7], s18 offen offset:2048 sc1
    buffer_load_dwordx4 a[188:191], v1, s[4:7], s18 offen offset:3072 sc1
    s_add_u32 s18, s18, 4096
    buffer_load_dwordx4 a[192:195], v1, s[4:7], s18 offen offset:0 sc1
    buffer_load_dwordx4 a[196:199], v1, s[4:7], s18 offen offset:1024 sc1
    buffer_load_dwordx4 a[200:203], v1, s[4:7], s18 offen offset:2048 sc1
    buffer_load_dwordx4 a[204:207], v1, s[4:7], s18 offen offset:3072 sc1
    s_add_u32 s18, s18, 4096
    buffer_load_dwordx4 a[208:211], v1, s[4:7], s18 offen offset:0 sc1
    buffer_load_dwordx4 a[212:215], v1, s[4:7], s18 offen offset:1024 sc1
    buffer_load_dwordx4 a[216:219], v1, s[4:7], s18 offen offset:2048 sc1
    buffer_load_dwordx4 a[220:223], v1, s[4:7], s18 offen offset:3072 sc1
    s_add_u32 s18, s18, 4096
    buffer_load_dwordx4 a[224:227], v1, s[4:7], s18 offen offset:0 sc1
    buffer_load_dwordx4 a[228:231], v1, s[4:7], s18 offen offset:1024 sc1
    buffer_load_dwordx4 a[232:235], v1, s[4:7], s18 offen offset:2048 sc1
    buffer_load_dwordx4 a[236:239], v1, s[4:7], s18 offen offset:3072 sc1
    s_add_u32 s18, s18, 4096
    buffer_load_dwordx4 a[240:243], v1, s[4:7], s18 offen offset:0 sc1
    buffer_load_dwordx4 a[244:247], v1, s[4:7], s18 offen offset:1024 sc1
    buffer_load_dwordx4 a[248:251], v1, s[4:7], s18 offen offset:2048 sc1
    buffer_load_dwordx4 a[252:255], v1, s[4:7], s18 offen offset:3072 sc1
    s_waitcnt vmcnt(0)
    s_mov_b32 s44, 0
    s_mov_b32 s37, s35
    v_mov_b32 v250, 1
    v_mov_b32 v251, 163832
    v_cmp_eq_u32 vcc, 0, v0
    s_nop 0
    s_and_saveexec_b64 s[38:39], vcc
    s_cbranch_execz tk18
    buffer_atomic_add v250, off, s[84:87], s37 sc0
    s_waitcnt vmcnt(0)
    ds_write_b32 v251, v250
    s_waitcnt lgkmcnt(0)
tk18:
    s_mov_b64 exec, -1
    s_barrier
    ds_read_b32 v252, v251
    s_waitcnt lgkmcnt(0)
    v_readfirstlane_b32 s16, v252
    s_barrier
    s_nop 3
    s_cmp_ge_u32 s16, 128
    s_cbranch_scc1 L_op_nextcb
L_op_seg:
    s_lshr_b32 s43, s16, 1
    s_add_u32 s43, s43, 2
    s_min_u32 s43, s43, 63
    s_lshl_b32 s94, s33, 7
    s_add_u32 s94, s94, s16
    s_mov_b32 s88, 65536
    s_mov_b32 s89, 125853696
cw19:
    buffer_load_dword v3, off, s[4:7], s89 sc1
    s_waitcnt vmcnt(0)
    v_readfirstlane_b32 s42, v3
    s_nop 0
    s_sub_u32 s42, s42, s95
    s_cmp_gt_u32 s42, 64
    s_cselect_b32 s42, 0, s42
    s_add_u32 s42, s42, 1
    s_cmp_ge_u32 s42, s43
    s_cbranch_scc1 cw19x
    s_sub_u32 s88, s88, 1
    s_cbranch_scc1 cw19x
    s_sub_u32 s42, s43, s42
    s_min_u32 s42, s42, 6
cw19s:
    s_sleep 24
    s_sub_u32 s42, s42, 1
    s_cmp_lg_u32 s42, 0
    s_cbranch_scc1 cw19s
    s_branch cw19
cw19x:
    s_lshr_b32 s89, s16, 1
    s_lshl_b32 s89, s89, 2
    s_add_u32 s89, s89, s32
    s_lshl_b32 s89, s89, 7
    s_add_u32 s89, s89, 125894656
    v_mbcnt_lo_u32_b32 v2, -1, 0
    v_mbcnt_hi_u32_b32 v2, -1, v2
    v_min_u32 v2, 1, v2
    v_lshlrev_b32 v2, 2, v2
    s_mov_b32 s88, 4194304
fw20:
    buffer_load_dword v3, v2, s[4:7], s89 offen offset:0 sc1
    s_sub_u32 s88, s88, 1
    s_cbranch_scc1 fw20x
    s_waitcnt vmcnt(0)
    v_cmp_ne_u32 vcc, s95, v3
    s_cbranch_vccz fw20x
    s_sleep 2
    s_branch fw20
fw20x:
    v_mov_b32 v250, 1
    v_lshrrev_b32 v252, 2, v1
    v_min_u32 v252, 68, v252
    s_cmp_lg_u32 s32, 0
    s_cbranch_scc1 L_op_na
    s_mov_b64 exec, 1
    buffer_atomic_add v250, off, s[84:87], s35 sc0
    s_mov_b64 exec, -1
    s_cmp_lg_u32 s44, 0
    s_cbranch_scc1 L_op_na
    buffer_load_dword v253, v252, s[84:87], 0 offen offset:136 sc1
L_op_na:
    s_lshl_b32 s18, s16, 17
    s_lshl_b32 s19, s32, 15
    s_add_u32 s18, s18, s19
    s_add_u32 s18, s18, 50331648
    buffer_load_dwordx4 v[32:35], v1, s[4:7], s18 offen offset:0 sc1
    buffer_load_dwordx4 v[36:39], v1, s[4:7], s18 offen offset:1024 sc1
    buffer_load_dwordx4 v[40:43], v1, s[4:7], s18 offen offset:2048 sc1
    buffer_load_dwordx4 v[44:47], v1, s[4:7], s18 offen offset:3072 sc1
    s_add_u32 s18, s18, 4096
    buffer_load_dwordx4 v[48:51], v1, s[4:7], s18 offen offset:0 sc1
    buffer_load_dwordx4 v[52:55], v1, s[4:7], s18 offen offset:1024 sc1
    buffer_load_dwordx4 v[56:59], v1, s[4:7], s18 offen offset:2048 sc1
    buffer_load_dwordx4 v[60:63], v1, s[4:7], s18 offen offset:3072 sc1
    s_add_u32 s18, s18, 4096
    buffer_load_dwordx4 v[64:67], v1, s[4:7], s18 offen offset:0 sc1
    buffer_load_dwordx4 v[68:71], v1, s[4:7], s18 offen offset:1024 sc1
    buffer_load_dwordx4 v[72:75], v1, s[4:7], s18 offen offset:2048 sc1
    buffer_load_dwordx4 v[76:79], v1, s[4:7], s18 offen offset:3072 sc1
    s_add_u32 s18, s18, 4096
    buffer_load_dwordx4 v[80:83], v1, s[4:7], s18 offen offset:0 sc1
    buffer_load_dwordx4 v[84:87], v1, s[4:7], s18 offen offset:1024 sc1
    buffer_load_dwordx4 v[88:91], v1, s[4:7], s18 offen offset:2048 sc1
    buffer_load_dwordx4 v[92:95], v1, s[4:7], s18 offen offset:3072 sc1
    s_add_u32 s18, s18, 4096
    buffer_load_dwordx4 v[96:99], v1, s[4:7], s18 offen offset:0 sc1
    buffer_load_dwordx4 v[100:103], v1, s[4:7], s18 offen offset:1024 sc1
    buffer_load_dwordx4 v[104:107], v1, s[4:7], s18 offen offset:2048 sc1
    buffer_load_dwordx4 v[108:111], v1, s[4:7], s18 offen offset:3072 sc1
    s_add_u32 s18, s18, 4096
    buffer_load_dwordx4 v[112:115], v1, s[4:7], s18 offen offset:0 sc1
    buffer_load_dwordx4 v[116:119], v1, s[4:7], s18 offen offset:1024 sc1
    buffer_load_dwordx4 v[120:123], v1, s[4:7], s18 offen offset:2048 sc1
    buffer_load_dwordx4 v[124:127], v1, s[4:7], s18 offen offset:3072 sc1
    s_add_u32 s18, s18, 4096
    buffer_load_dwordx4 v[128:131], v1, s[4:7], s18 offen offset:0 sc1
    buffer_load_dwordx4 v[132:135], v1, s[4:7], s18 offen offset:1024 sc1
    buffer_load_dwordx4 v[136:139], v1, s[4:7], s18 offen offset:2048 sc1
    buffer_load_dwordx4 v[140:143], v1, s[4:7], s18 offen offset:3072 sc1
    s_add_u32 s18, s18, 4096
    buffer_load_dwordx4 v[144:147], v1, s[4:7], s18 offen offset:0 sc1
    buffer_load_dwordx4 v[148:151], v1, s[4:7], s18 offen offset:1024 sc1
    buffer_load_dwordx4 v[152:155], v1, s[4:7], s18 offen offset:2048 sc1
    buffer_load_dwordx4 v[156:159], v1, s[4:7], s18 offen offset:3072 sc1
    v_lshlrev_b32 v2, 4, v0
    v_and_b32 v3, 3072, v2
    v_lshl_add_u32 v2, v3, 1, v1
    s_waitcnt vmcnt(31)
    v_mfma_f32_16x16x32_bf16 v[8:11], a[0:3], v[32:35], 0
    v_mfma_f32_16x16x32_bf16 v[12:15], a[4:7], v[32:35], 0
    s_waitcnt vmcnt(30)
    v_mfma_f32_16x16x32_bf16 v[8:11], a[8:11], v[36:39], v[8:11]
    v_mfma_f32_16x16x32_bf16 v[12:15], a[12:15], v[36:39], v[12:15]
    s_waitcnt vmcnt(29)
    v_mfma_f32_16x16x32_bf16 v[8:11], a[16:19], v[40:43], v[8:11]
    v_mfma_f32_16x16x32_bf16 v[12:15], a[20:23], v[40:43], v[12:15]
    s_waitcnt vmcnt(28)
    v_mfma_f32_16x16x32_bf16 v[8:11], a[24:27], v[44:47], v[8:11]
    v_mfma_f32_16x16x32_bf16 v[12:15], a[28:31], v[44:47], v[12:15]
    s_waitcnt vmcnt(27)
    v_mfma_f32_16x16x32_bf16 v[8:11], a[32:35], v[48:51], v[8:11]
    v_mfma_f32_16x16x32_bf16 v[12:15], a[36:39], v[48:51], v[12:15]
    s_waitcnt vmcnt(26)
    v_mfma_f32_16x16x32_bf16 v[8:11], a[40:43], v[52:55], v[8:11]
    v_mfma_f32_16x16x32_bf16 v[12:15], a[44:47], v[52:55], v[12:15]
    s_waitcnt vmcnt(25)
    v_mfma_f32_16x16x32_bf16 v[8:11], a[48:51], v[56:59], v[8:11]
    v_mfma_f32_16x16x32_bf16 v[12:15], a[52:55], v[56:59], v[12:15]
    s_waitcnt vmcnt(24)
    v_mfma_f32_16x16x32_bf16 v[8:11], a[56:59], v[60:63], v[8:11]
    v_mfma_f32_16x16x32_bf16 v[12:15], a[60:63], v[60:63], v[12:15]
    s_waitcnt vmcnt(23)
    v_mfma_f32_16x16x32_bf16 v[8:11], a[64:67], v[64:67], v[8:11]
    v_mfma_f32_16x16x32_bf16 v[12:15], a[68:71], v[64:67], v[12:15]
    s_waitcnt vmcnt(22)
    v_mfma_f32_16x16x32_bf16 v[8:11], a[72:75], v[68:71], v[8:11]
    v_mfma_f32_16x16x32_bf16 v[12:15], a[76:79], v[68:71], v[12:15]
    s_waitcnt vmcnt(21)
    v_mfma_f32_16x16x32_bf16 v[8:11], a[80:83], v[72:75], v[8:11]
    v_mfma_f32_16x16x32_bf16 v[12:15], a[84:87], v[72:75], v[12:15]
    s_waitcnt vmcnt(20)
    v_mfma_f32_16x16x32_bf16 v[8:11], a[88:91], v[76:79], v[8:11]
    v_mfma_f32_16x16x32_bf16 v[12:15], a[92:95], v[76:79], v[12:15]
    s_waitcnt vmcnt(19)
    v_mfma_f32_16x16x32_bf16 v[8:11], a[96:99], v[80:83], v[8:11]
    v_mfma_f32_16x16x32_bf16 v[12:15], a[100:103], v[80:83], v[12:15]
    s_waitcnt vmcnt(18)
    v_mfma_f32_16x16x32_bf16 v[8:11], a[104:107], v[84:87], v[8:11]
    v_mfma_f32_16x16x32_bf16 v[12:15], a[108:111], v[84:87], v[12:15]
    s_waitcnt vmcnt(17)
    v_mfma_f32_16x16x32_bf16 v[8:11], a[112:115], v[88:91], v[8:11]
    v_mfma_f32_16x16x32_bf16 v[12:15], a[116:119], v[88:91], v[12:15]
    s_waitcnt vmcnt(16)
    v_mfma_f32_16x16x32_bf16 v[8:11], a[120:123], v[92:95], v[8:11]
    v_mfma_f32_16x16x32_bf16 v[12:15], a[124:127], v[92:95], v[12:15]
    s_waitcnt vmcnt(15)
    v_mfma_f32_16x16x32_bf16 v[8:11], a[128:131], v[96:99], v[8:11]
    v_mfma_f32_16x16x32_bf16 v[12:15], a[132:135], v[96:99], v[12:15]
    s_waitcnt vmcnt(14)
    v_mfma_f32_16x16x32_bf16 v[8:11], a[136:139], v[100:103], v[8:11]
    v_mfma_f32_16x16x32_bf16 v[12:15], a[140:143], v[100:103], v[12:15]
    s_waitcnt vmcnt(13)
    v_mfma_f32_16x16x32_bf16 v[8:11], a[144:147], v[104:107], v[8:11]
    v_mfma_f32_16x16x32_bf16 v[12:15], a[148:151], v[104:107], v[12:15]
    s_waitcnt vmcnt(12)
    v_mfma_f32_16x16x32_bf16 v[8:11], a[152:155], v[108:111], v[8:11]
    v_mfma_f32_16x16x32_bf16 v[12:15], a[156:159], v[108:111], v[12:15]
    s_waitcnt vmcnt(11)
    v_mfma_f32_16x16x32_bf16 v[8:11], a[160:163], v[112:115], v[8:11]
    v_mfma_f32_16x16x32_bf16 v[12:15], a[164:167], v[112:115], v[12:15]
    s_waitcnt vmcnt(10)
    v_mfma_f32_16x16x32_bf16 v[8:11], a[168:171], v[116:119], v[8:11]
    v_mfma_f32_16x16x32_bf16 v[12:15], a[172:175], v[116:119], v[12:15]
    s_waitcnt vmcnt(9)
    v_mfma_f32_16x16x32_bf16 v[8:11], a[176:179], v[120:123], v[8:11]
    v_mfma_f32_16x16x32_bf16 v[12:15], a[180:183], v[120:123], v[12:15]
    s_waitcnt vmcnt(8)
    v_mfma_f32_16x16x32_bf16 v[8:11], a[184:187], v[124:127], v[8:11]
    v_mfma_f32_16x16x32_bf16 v[12:15], a[188:191], v[124:127], v[12:15]
    s_waitcnt vmcnt(7)
    v_mfma_f32_16x16x32_bf16 v[8:11], a[192:195], v[128:131], v[8:11]
    v_mfma_f32_16x16x32_bf16 v[12:15], a[196:199], v[128:131], v[12:15]
    s_waitcnt vmcnt(6)
    v_mfma_f32_16x16x32_bf16 v[8:11], a[200:203], v[132:135], v[8:11]
    v_mfma_f32_16x16x32_bf16 v[12:15], a[204:207], v[132:135], v[12:15]
    s_waitcnt vmcnt(5)
    v_mfma_f32_16x16x32_bf16 v[8:11], a[208:211], v[136:139], v[8:11]
    v_mfma_f32_16x16x32_bf16 v[12:15], a[212:215], v[136:139], v[12:15]
    s_waitcnt vmcnt(4)
    v_mfma_f32_16x16x32_bf16 v[8:11], a[216:219], v[140:143], v[8:11]
    v_mfma_f32_16x16x32_bf16 v[12:15], a[220:223], v[140:143], v[12:15]
    s_waitcnt vmcnt(3)
    v_mfma_f32_16x16x32_bf16 v[8:11], a[224:227], v[144:147], v[8:11]
    v_mfma_f32_16x16x32_bf16 v[12:15], a[228:231], v[144:147], v[12:15]
    s_waitcnt vmcnt(2)
    v_mfma_f32_16x16x32_bf16 v[8:11], a[232:235], v[148:151], v[8:11]
    v_mfma_f32_16x16x32_bf16 v[12:15], a[236:239], v[148:151], v[12:15]
    s_waitcnt vmcnt(1)
    v_mfma_f32_16x16x32_bf16 v[8:11], a[240:243], v[152:155], v[8:11]
    v_mfma_f32_16x16x32_bf16 v[12:15], a[244:247], v[152:155], v[12:15]
    s_waitcnt vmcnt(0)
    v_mfma_f32_16x16x32_bf16 v[8:11], a[248:251], v[156:159], v[8:11]
    v_mfma_f32_16x16x32_bf16 v[12:15], a[252:255], v[156:159], v[12:15]
    s_nop 6
    ds_write_b128 v2, v[8:11] offset:0
    ds_write_b128 v2, v[12:15] offset:1024
    s_cmp_lg_u32 s32, 0
    s_cbranch_scc1 L_op_nb
    v_cmp_eq_u32 vcc, 0, v253
    s_nop 0
    s_cmp_eq_u64 vcc, 0
    s_cselect_b32 s44, 65536, 0
    v_or_b32 v250, s44, v250
    v_mov_b32 v251, 163832
    s_mov_b64 exec, 1
    ds_write_b32 v251, v250
    s_mov_b64 exec, -1
L_op_nb:
    s_waitcnt lgkmcnt(0)
    s_barrier
    s_cmp_lg_u32 s32, 0
    s_cbranch_scc1 os_skip
    ds_read_b128 v[40:43], v1 offset:2048
    ds_read_b128 v[44:47], v1 offset:3072
    ds_read_b128 v[48:51], v1 offset:4096
    ds_read_b128 v[52:55], v1 offset:5120
    ds_read_b128 v[56:59], v1 offset:6144
    ds_read_b128 v[60:63], v1 offset:7168
    v_lshrrev_b32 v3, 4, v1
    v_bfe_u32 v4, v3, 2, 2
    v_lshlrev_b32 v4, 3, v4
    v_and_b32 v2, 3, v3
    v_add_u32 v4, v4, v2
    v_mul_u32_u24 v4, 2304, v4
    v_lshrrev_b32 v3, 4, v3
    v_lshl_add_u32 v4, v3, 4, v4
    s_lshr_b32 s18, s16, 1
    s_lshl_b32 s18, s18, 3
    s_and_b32 s19, s16, 1
    s_add_u32 s18, s18, s19
    s_mul_i32 s18, s18, 9216
    s_lshl_b32 s19, s33, 6
    s_add_u32 s18, s18, s19
    s_waitcnt lgkmcnt(0)
    v_pk_add_f32 v[8:9], v[8:9], v[40:41]
    v_pk_add_f32 v[48:49], v[48:49], v[56:57]
    v_pk_add_f32 v[8:9], v[8:9], v[48:49]
    v_pk_add_f32 v[10:11], v[10:11], v[42:43]
    v_pk_add_f32 v[50:51], v[50:51], v[58:59]
    v_pk_add_f32 v[10:11], v[10:11], v[50:51]
    v_pk_add_f32 v[12:13], v[12:13], v[44:45]
    v_pk_add_f32 v[52:53], v[52:53], v[60:61]
    v_pk_add_f32 v[12:13], v[12:13], v[52:53]
    v_pk_add_f32 v[14:15], v[14:15], v[46:47]
    v_pk_add_f32 v[54:55], v[54:55], v[62:63]
    v_pk_add_f32 v[14:15], v[14:15], v[54:55]
    v_cvt_pk_bf16_f32 v32, v8, v12
    v_cvt_pk_bf16_f32 v33, v9, v13
    v_cvt_pk_bf16_f32 v34, v10, v14
    v_cvt_pk_bf16_f32 v35, v11, v15
    buffer_store_dwordx4 v[32:35], v4, s[8:11], s18 offen
os_skip:
    s_nop 1
    v_mov_b32 v251, 163832
    ds_read_b32 v252, v251
    s_waitcnt lgkmcnt(0)
    v_readfirstlane_b32 s40, v252
    s_nop 1
    s_cmp_ge_u32 s40, 65664
    s_cbranch_scc1 L_done
    s_barrier
    s_and_b32 s16, s40, 0xffff
    s_cmp_lt_u32 s16, 128
    s_cbranch_scc1 L_op_seg
L_op_nextcb:
    s_mov_b32 s40, -1
    s_cmp_lg_u32 s32, 0
    s_cbranch_scc1 L_op_dec
    v_and_b32 v1, 63, v0
    v_min_u32 v1, 17, v1
    v_lshlrev_b32 v2, 2, v1
    buffer_load_dword v3, v2, s[84:87], 0 offen offset:136 sc1
    s_waitcnt vmcnt(0)
    v_cmp_gt_u32 vcc, 100, v3
    s_nop 0
    s_ff1_i32_b64 s40, vcc
L_op_dec:
    v_mov_b32 v250, s40
    v_mov_b32 v251, 163832
    s_cmp_lg_u32 s32, 0
    s_cbranch_scc1 L_op_nw
    ds_write_b32 v251, v250
    s_waitcnt lgkmcnt(0)
L_op_nw:
    s_barrier
    ds_read_b32 v252, v251
    s_waitcnt lgkmcnt(0)
    v_readfirstlane_b32 s33, v252
    s_barrier
    s_nop 1
    s_cmp_lt_u32 s33, 18
    s_cbranch_scc1 L_op_start
L_done:
L_exit:
    s_endpgm
.section .rodata,"a"
.p2align 6
.amdhsa_kernel concat_heads__memory_aug_recurrent_mem_tr__ssm_conv_s4d__prompt_kernel
  .amdhsa_next_free_vgpr 512
  .amdhsa_next_free_sgpr 102
  .amdhsa_accum_offset 256
  .amdhsa_group_segment_fixed_size 0
  .amdhsa_kernarg_size 136
  .amdhsa_user_sgpr_count 2
  .amdhsa_user_sgpr_kernarg_segment_ptr 1
  .amdhsa_system_sgpr_workgroup_id_x 1
.end_amdhsa_kernel
.text
```

```asm
; @launch grid=(256,1,1) block=(256,1,1) lds=163840
.amdgcn_target "amdgcn-amd-amdhsa--gfx950"
.text
.globl concat_heads__memory_aug_recurrent_mem_tr__ssm_conv_s4d__prompt_kernel
.p2align 8
.type concat_heads__memory_aug_recurrent_mem_tr__ssm_conv_s4d__prompt_kernel,@function
concat_heads__memory_aug_recurrent_mem_tr__ssm_conv_s4d__prompt_kernel:
    s_cmp_ge_u32 s2, 256
    s_cbranch_scc1 L_exit
    s_load_dwordx4 s[80:83], s[0:1], 120
    s_load_dwordx16 s[48:63], s[0:1], 0
    s_memrealtime s[90:91]
    v_lshrrev_b32 v1, 6, v0
    s_nop 0
    v_readfirstlane_b32 s32, v1
    s_waitcnt lgkmcnt(0)
    s_mov_b32 s4, s82
    s_mov_b32 s5, s83
    s_mov_b32 s6, 268435456
    s_mov_b32 s7, 0x20000
    s_mov_b32 s84, s80
    s_mov_b32 s85, s81
    s_mov_b32 s86, 256
    s_mov_b32 s87, 0x20000
    s_cmp_lg_u32 s32, 0
    s_cbranch_scc1 L_nod0
L_nod0:
    s_cmp_lg_u32 s32, 3
    s_cbranch_scc1 L_nowarm
    s_getpc_b64 s[44:45]
L_pcw:
    v_and_b32 v1, 63, v0
    v_lshlrev_b32 v1, 7, v1
    v_min_u32 v2, L_exit-L_pcw, v1
    global_load_dword v240, v2, s[44:45]
    v_add_u32 v1, 8192, v1
    v_min_u32 v2, L_exit-L_pcw, v1
    global_load_dword v241, v2, s[44:45]
    v_add_u32 v1, 8192, v1
    v_min_u32 v2, L_exit-L_pcw, v1
    global_load_dword v242, v2, s[44:45]
    v_add_u32 v1, 8192, v1
    v_min_u32 v2, L_exit-L_pcw, v1
    global_load_dword v243, v2, s[44:45]
    v_add_u32 v1, 8192, v1
    v_min_u32 v2, L_exit-L_pcw, v1
    global_load_dword v244, v2, s[44:45]
    v_add_u32 v1, 8192, v1
    v_min_u32 v2, L_exit-L_pcw, v1
    global_load_dword v245, v2, s[44:45]
    v_add_u32 v1, 8192, v1
    v_min_u32 v2, L_exit-L_pcw, v1
    global_load_dword v246, v2, s[44:45]
    v_add_u32 v1, 8192, v1
    v_min_u32 v2, L_exit-L_pcw, v1
    global_load_dword v247, v2, s[44:45]
    v_add_u32 v1, 8192, v1
    v_min_u32 v2, L_exit-L_pcw, v1
    global_load_dword v248, v2, s[44:45]
    v_add_u32 v1, 8192, v1
L_nowarm:
    s_getreg_b32 s3, hwreg(HW_REG_XCC_ID)
    s_and_b32 s3, s3, 15
    s_cmp_lg_u32 s3, 3
    s_cbranch_scc1 L_helper
    s_mov_b32 s37, 128
    v_mov_b32 v250, 1
    v_mov_b32 v251, 163832
    v_cmp_eq_u32 vcc, 0, v0
    s_nop 0
    s_and_saveexec_b64 s[38:39], vcc
    s_cbranch_execz tk1
    buffer_atomic_add v250, off, s[84:87], s37 sc0
    s_waitcnt vmcnt(0)
    ds_write_b32 v251, v250
    s_waitcnt lgkmcnt(0)
tk1:
    s_mov_b64 exec, -1
    s_barrier
    ds_read_b32 v252, v251
    s_waitcnt lgkmcnt(0)
    v_readfirstlane_b32 s12, v252
    s_barrier
    s_nop 3
    s_cmp_ge_u32 s12, 32
    s_cbranch_scc1 L_helper
L_chain:
    s_load_dwordx8 s[48:55], s[0:1], 8
    s_load_dwordx2 s[56:57], s[0:1], 40
    s_waitcnt lgkmcnt(0)
    v_lshrrev_b32 v77, 6, v0
    s_nop 0
    v_readfirstlane_b32 s13, v77
    v_lshlrev_b32 v65, 4, v0
    v_and_b32 v48, 63, v0
    s_mov_b32 s10, 4718592
    s_mov_b32 s11, 0x20000
    v_lshrrev_b32 v49, 3, v48
    v_mul_u32_u24 v18, 1152, v49
    v_and_b32 v49, 7, v48
    v_lshl_add_u32 v18, v49, 4, v18
    s_mul_i32 s40, s12, 147456
    s_lshl_b32 s41, s13, 8
    s_add_u32 s40, s40, s41
    s_mov_b32 s42, s40
    s_xor_b32 s41, s13, 0
    s_mul_i32 s41, s41, 36864
    s_add_u32 s60, s41, s40
    s_xor_b32 s41, s13, 1
    s_mul_i32 s41, s41, 36864
    s_add_u32 s61, s41, s40
    s_xor_b32 s41, s13, 2
    s_mul_i32 s41, s41, 36864
    s_add_u32 s62, s41, s40
    s_xor_b32 s41, s13, 3
    s_mul_i32 s41, s41, 36864
    s_add_u32 s63, s41, s40
    s_lshl_b32 s43, s13, 12
    s_mov_b64 s[8:9], s[56:57]
    s_add_u32 m0, s43, 0
    s_add_u32 s41, s60, 0
    buffer_load_dwordx4 v18, s[8:11], s41 offen offset:0 nt lds
    s_add_u32 s41, s60, 8192
    buffer_load_dwordx4 v18, s[8:11], s41 offen offset:1024 nt lds
    s_add_u32 s41, s60, 16384
    buffer_load_dwordx4 v18, s[8:11], s41 offen offset:2048 nt lds
    s_add_u32 s41, s60, 24576
    buffer_load_dwordx4 v18, s[8:11], s41 offen offset:3072 nt lds
    s_add_u32 m0, s43, 36864
    s_add_u32 s41, s61, 0
    buffer_load_dwordx4 v18, s[8:11], s41 offen offset:0 nt lds
    s_add_u32 s41, s61, 8192
    buffer_load_dwordx4 v18, s[8:11], s41 offen offset:1024 nt lds
    s_add_u32 s41, s61, 16384
    buffer_load_dwordx4 v18, s[8:11], s41 offen offset:2048 nt lds
    s_add_u32 s41, s61, 24576
    buffer_load_dwordx4 v18, s[8:11], s41 offen offset:3072 nt lds
    s_add_u32 m0, s43, 73728
    s_add_u32 s41, s62, 0
    buffer_load_dwordx4 v18, s[8:11], s41 offen offset:0 nt lds
    s_add_u32 s41, s62, 8192
    buffer_load_dwordx4 v18, s[8:11], s41 offen offset:1024 nt lds
    s_add_u32 s41, s62, 16384
    buffer_load_dwordx4 v18, s[8:11], s41 offen offset:2048 nt lds
    s_add_u32 s41, s62, 24576
    buffer_load_dwordx4 v18, s[8:11], s41 offen offset:3072 nt lds
    s_add_u32 m0, s43, 110592
    s_add_u32 s41, s63, 0
    buffer_load_dwordx4 v18, s[8:11], s41 offen offset:0 nt lds
    s_add_u32 s41, s63, 8192
    buffer_load_dwordx4 v18, s[8:11], s41 offen offset:1024 nt lds
    s_add_u32 s41, s63, 16384
    buffer_load_dwordx4 v18, s[8:11], s41 offen offset:2048 nt lds
    s_add_u32 s41, s63, 24576
    buffer_load_dwordx4 v18, s[8:11], s41 offen offset:3072 nt lds
    v_lshrrev_b32 v49, 1, v48
    v_mul_u32_u24 v19, 1152, v49
    v_and_b32 v49, 1, v48
    v_lshl_add_u32 v19, v49, 4, v19
    s_mul_i32 s41, s13, 224
    s_sub_u32 s41, 1024, s41
    v_add_u32 v19, s41, v19
    v_lshrrev_b32 v49, 4, v48
    v_lshlrev_b32 v50, 2, v49
    v_and_b32 v51, 15, v48
    v_xor_b32 v51, v51, v50
    v_lshlrev_b32 v51, 4, v51
    v_lshl_add_u32 v16, v49, 15, v51
    v_lshrrev_b32 v50, 1, v49
    v_lshl_add_u32 v17, v50, 16, v51
    v_and_b32 v50, 1, v49
    v_lshl_add_u32 v17, v50, 13, v17
    s_lshl_b32 s40, s12, 8
    s_mul_i32 s58, s13, 1048576
    s_add_u32 s58, s58, s40
    s_lshr_b32 s41, s13, 1
    s_mul_i32 s59, s41, 262144
    s_and_b32 s41, s13, 1
    s_lshl_b32 s41, s41, 14
    s_add_u32 s59, s59, s41
    s_add_u32 s59, s59, s40
    s_add_u32 s59, s59, 4194304
    v_bfe_u32 v50, v48, 2, 2
    v_xor_b32 v51, s13, v50
    v_lshlrev_b32 v20, 6, v51
    v_and_b32 v51, 3, v48
    v_lshl_add_u32 v20, v51, 4, v20
    v_lshrrev_b32 v23, 2, v48
    v_lshl_add_u32 v20, v23, 8, v20
    s_xor_b32 s41, s43, 0
    v_add_u32 v24, s41, v20
    s_xor_b32 s41, s43, 4096
    v_add_u32 v25, s41, v20
    s_xor_b32 s41, s43, 8192
    v_add_u32 v26, s41, v20
    s_xor_b32 s41, s43, 12288
    v_add_u32 v27, s41, v20
    v_and_b32 v23, 1, v50
    v_lshl_add_u32 v23, v49, 2, v23
    v_lshrrev_b32 v50, 1, v50
    v_lshlrev_b32 v21, 7, v23
    v_lshl_add_u32 v21, v50, 6, v21
    v_lshl_add_u32 v21, v51, 4, v21
    v_add_u32 v21, s43, v21
    v_lshlrev_b32 v22, 9, v50
    v_xor_b32 v22, v22, v21
    v_lshlrev_b32 v23, 5, v23
    v_lshl_add_u32 v23, v50, 10, v23
    v_lshl_add_u32 v23, v51, 3, v23
    v_add_u32 v23, s43, v23
    v_bfe_u32 v60, v65, 4, 6
    v_and_b32 v61, 15, v60
    v_lshrrev_b32 v62, 4, v60
    v_mov_b32 v64, 0x4444
    v_mov_b32 v77, 0xeeee
    v_cmp_lt_u32 vcc, 7, v61
    s_nop 1
    v_cndmask_b32 v64, v64, v77, vcc
    v_xor_b32 v66, 1024, v65
    v_xor_b32 v67, 2048, v65
    v_xor_b32 v68, 3072, v65
    v_and_b32 v69, 511, v65
    s_mul_i32 s96, s13, 36864
    s_add_u32 s96, s96, 16384
    v_lshlrev_b32 v70, 4, v60
    v_add_u32 v70, s96, v70
    v_lshrrev_b32 v79, 1, v69
    s_lshl_b32 s96, s13, 8
    s_add_u32 s96, s96, 14336
    s_lshl_b32 s33, s13, 10
    s_add_u32 s97, s33, 8192
    v_mov_b32 v77, s97
    v_mov_b32 v78, s96
    v_cmp_lt_u32 vcc, 31, v60
    s_nop 1
    v_cndmask_b32 v71, v77, v78, vcc
    v_add_u32 v71, v71, v79
    v_and_b32 v77, 7, v61
    v_lshrrev_b32 v78, 3, v61
    v_lshlrev_b32 v74, 4, v77
    v_lshl_add_u32 v73, v62, 7, v74
    v_lshl_add_u32 v73, v78, 3, v73
    s_lshl_b32 s96, s13, 9
    v_add_u32 v73, s96, v73
    v_lshl_add_u32 v74, v78, 14, v74
    v_lshl_add_u32 v74, v62, 15, v74
    s_lshl_b32 s96, s13, 17
    v_add_u32 v74, s96, v74
    v_bfe_u32 v77, v61, 2, 1
    v_and_b32 v78, 3, v61
    v_bfe_u32 v79, v61, 1, 2
    s_cmp_lt_u32 s13, 2
    s_cselect_b64 vcc, -1, 0
    v_cndmask_b32 v77, 0, v77, vcc
    v_cndmask_b32 v78, v79, v78, vcc
    v_lshlrev_b32 v75, 7, v77
    v_lshl_add_u32 v75, v62, 4, v75
    v_lshl_add_u32 v75, v78, 2, v75
    v_lshl_add_u32 v58, v77, 3, v78
    v_lshlrev_b32 v79, 1, v78
    v_cndmask_b32 v58, v79, v58, vcc
    s_bfe_u32 s97, s12, 0x10001
    s_lshl_b32 s68, s97, 6
    s_lshl_b32 s97, s97, 2
    v_add_u32 v59, s97, v62
    s_bfe_u32 s96, s12, 0x10002
    s_and_b32 s40, s12, 1
    s_lshl_b32 s96, s96, 1
    s_add_u32 s96, s96, s40
    s_lshr_b32 s97, s12, 3
    s_lshl_b32 s98, s13, 2
    s_add_u32 s98, s98, s97
    s_lshl_b32 s98, s98, 2
    s_add_u32 s98, s98, s96
    s_lshl_b32 s98, s98, 8
    s_lshl_b32 s99, s13, 2
    s_add_u32 s99, s99, s96
    s_lshl_b32 s99, s99, 4
    s_lshl_b32 s41, s97, 1
    s_add_u32 s41, s41, s40
    s_lshl_b32 s41, s41, 7
    s_add_u32 s41, s41, 8192
    s_lshl_b32 s40, s40, 3
    s_add_u32 s40, s40, 512
    s_cmp_lt_u32 s13, 2
    s_cselect_b32 s96, 7, 4
    s_cselect_b32 s98, s98, s41
    s_cselect_b32 s99, s99, s40
    s_cselect_b32 s32, 1, 0
    s_add_u32 s68, s68, s98
    s_lshl_b32 s97, s97, s96
    s_add_u32 s99, s99, s97
    v_add_u32 v58, s99, v58
    s_and_b32 s97, s12, 4
    s_or_b32 s97, s97, s13
    s_cmp_eq_u32 s97, 2
    s_cselect_b32 s32, 2, s32
    s_mov_b32 s8, s48
    s_mov_b32 s9, s49
    s_mov_b32 s10, 9216
    s_cmp_lt_u32 s13, 2
    s_cselect_b32 s96, 8, 2
    v_mul_u32_u24 v77, 1152, v59
    v_lshl_add_u32 v77, v58, 1, v77
    buffer_load_ushort v72, v77, s[8:11], 0 offen
    buffer_load_ushort v76, v77, s[8:11], s96 offen
    s_mov_b32 s10, 4718592
    s_waitcnt vmcnt(12) lgkmcnt(0)
    s_barrier
    s_mov_b64 s[8:9], s[56:57]
    s_add_u32 m0, s43, 147456
    s_add_u32 s41, s42, 0
    buffer_load_dwordx4 v19, s[8:11], s41 offen offset:0 nt lds
    s_add_u32 s41, s42, 35840
    buffer_load_dwordx4 v19, s[8:11], s41 offen offset:1024 nt lds
    s_add_u32 s41, s42, 71680
    buffer_load_dwordx4 v19, s[8:11], s41 offen offset:2048 nt lds
    s_add_u32 s41, s42, 107520
    buffer_load_dwordx4 v19, s[8:11], s41 offen offset:3072 nt lds
    v_mov_b32 v78, v21
    v_mov_b32 v79, v22
    v_add_u32 v77, 0, v79
    ds_read_b64_tr_b16 v[80:81], v77 offset:0
    ds_read_b64_tr_b16 v[82:83], v77 offset:256
    ds_read_b64_tr_b16 v[84:85], v77 offset:2048
    ds_read_b64_tr_b16 v[86:87], v77 offset:2304
    ds_read_b64_tr_b16 v[112:113], v77 offset:8
    ds_read_b64_tr_b16 v[114:115], v77 offset:264
    ds_read_b64_tr_b16 v[116:117], v77 offset:2056
    ds_read_b64_tr_b16 v[118:119], v77 offset:2312
    s_waitcnt vmcnt(12) lgkmcnt(0)
    s_barrier
    s_mov_b64 s[8:9], s[52:53]
    s_add_u32 m0, s43, 0
    s_add_u32 s41, s58, 0
    buffer_load_dwordx4 v16, s[8:11], s41 offen offset:0 nt lds
    s_add_u32 s41, s58, 15360
    buffer_load_dwordx4 v16, s[8:11], s41 offen offset:1024 nt lds
    s_add_u32 s41, s58, 129024
    buffer_load_dwordx4 v16, s[8:11], s41 offen offset:2048 nt lds
    s_add_u32 s41, s58, 144384
    buffer_load_dwordx4 v16, s[8:11], s41 offen offset:3072 nt lds
    v_add_u32 v77, 36864, v78
    ds_read_b64_tr_b16 v[88:89], v77 offset:0
    ds_read_b64_tr_b16 v[90:91], v77 offset:256
    ds_read_b64_tr_b16 v[92:93], v77 offset:2048
    ds_read_b64_tr_b16 v[94:95], v77 offset:2304
    ds_read_b64_tr_b16 v[120:121], v77 offset:8
    ds_read_b64_tr_b16 v[122:123], v77 offset:264
    ds_read_b64_tr_b16 v[124:125], v77 offset:2056
    ds_read_b64_tr_b16 v[126:127], v77 offset:2312
    s_waitcnt vmcnt(12) lgkmcnt(0)
    s_barrier
    s_add_u32 m0, s43, 36864
    s_add_u32 s41, s58, 8192
    buffer_load_dwordx4 v16, s[8:11], s41 offen offset:0 nt lds
    s_add_u32 s41, s58, 23552
    buffer_load_dwordx4 v16, s[8:11], s41 offen offset:1024 nt lds
    s_add_u32 s41, s58, 137216
    buffer_load_dwordx4 v16, s[8:11], s41 offen offset:2048 nt lds
    s_add_u32 s41, s58, 152576
    buffer_load_dwordx4 v16, s[8:11], s41 offen offset:3072 nt lds
    v_add_u32 v77, 73728, v78
    ds_read_b64_tr_b16 v[96:97], v77 offset:0
    ds_read_b64_tr_b16 v[98:99], v77 offset:256
    ds_read_b64_tr_b16 v[100:101], v77 offset:2048
    ds_read_b64_tr_b16 v[102:103], v77 offset:2304
    ds_read_b64_tr_b16 v[128:129], v77 offset:8
    ds_read_b64_tr_b16 v[130:131], v77 offset:264
    ds_read_b64_tr_b16 v[132:133], v77 offset:2056
    ds_read_b64_tr_b16 v[134:135], v77 offset:2312
    s_waitcnt vmcnt(12) lgkmcnt(0)
    s_barrier
    s_add_u32 m0, s43, 73728
    s_add_u32 s41, s58, 262144
    buffer_load_dwordx4 v16, s[8:11], s41 offen offset:0 nt lds
    s_add_u32 s41, s58, 277504
    buffer_load_dwordx4 v16, s[8:11], s41 offen offset:1024 nt lds
    s_add_u32 s41, s58, 391168
    buffer_load_dwordx4 v16, s[8:11], s41 offen offset:2048 nt lds
    s_add_u32 s41, s58, 406528
    buffer_load_dwordx4 v16, s[8:11], s41 offen offset:3072 nt lds
    v_add_u32 v77, 110592, v78
    ds_read_b64_tr_b16 v[104:105], v77 offset:0
    ds_read_b64_tr_b16 v[106:107], v77 offset:256
    ds_read_b64_tr_b16 v[108:109], v77 offset:2048
    ds_read_b64_tr_b16 v[110:111], v77 offset:2304
    ds_read_b64_tr_b16 v[136:137], v77 offset:8
    ds_read_b64_tr_b16 v[138:139], v77 offset:264
    ds_read_b64_tr_b16 v[140:141], v77 offset:2056
    ds_read_b64_tr_b16 v[142:143], v77 offset:2312
    s_waitcnt vmcnt(12) lgkmcnt(0)
    s_barrier
    s_add_u32 m0, s43, 110592
    s_add_u32 s41, s58, 270336
    buffer_load_dwordx4 v16, s[8:11], s41 offen offset:0 nt lds
    s_add_u32 s41, s58, 285696
    buffer_load_dwordx4 v16, s[8:11], s41 offen offset:1024 nt lds
    s_add_u32 s41, s58, 399360
    buffer_load_dwordx4 v16, s[8:11], s41 offen offset:2048 nt lds
    s_add_u32 s41, s58, 414720
    buffer_load_dwordx4 v16, s[8:11], s41 offen offset:3072 nt lds
    v_add_u32 v77, 147456, v23
    ds_read_b64_tr_b16 v[0:1], v77 offset:0
    ds_read_b64_tr_b16 v[2:3], v77 offset:64
    ds_read_b64_tr_b16 v[4:5], v77 offset:512
    ds_read_b64_tr_b16 v[6:7], v77 offset:576
    ds_read_b64_tr_b16 v[8:9], v77 offset:2048
    ds_read_b64_tr_b16 v[10:11], v77 offset:2112
    ds_read_b64_tr_b16 v[12:13], v77 offset:2560
    ds_read_b64_tr_b16 v[14:15], v77 offset:2624
    s_waitcnt vmcnt(12) lgkmcnt(0)
    s_barrier
    s_add_u32 m0, s43, 147456
    s_add_u32 s41, s58, 524288
    buffer_load_dwordx4 v16, s[8:11], s41 offen offset:0 nt lds
    s_add_u32 s41, s58, 539648
    buffer_load_dwordx4 v16, s[8:11], s41 offen offset:1024 nt lds
    s_add_u32 s41, s58, 653312
    buffer_load_dwordx4 v16, s[8:11], s41 offen offset:2048 nt lds
    s_add_u32 s41, s58, 668672
    buffer_load_dwordx4 v16, s[8:11], s41 offen offset:3072 nt lds
    s_cmp_eq_u32 s32, 0
    s_cbranch_scc1 cf_init_done
    v_mov_b32 v52, 1
    v_mov_b32 v53, 1
    v_mov_b32 v54, 1
    v_mov_b32 v55, 1
    v_mov_b32 v56, 0
    v_lshl_or_b32 v72, v76, 16, v72
    s_lshl_b32 s96, s12, 14
    s_add_u32 s96, s96, 68157440
    s_add_u32 s97, s96, 0
    buffer_store_dwordx4 v[52:55], v65, s[4:7], s97 offen
    buffer_load_dwordx4 v[60:63], v65, s[4:7], s97 offen sc1
    s_add_u32 s97, s96, 4096
    buffer_store_dwordx4 v[52:55], v65, s[4:7], s97 offen
    buffer_load_dwordx4 v[60:63], v65, s[4:7], s97 offen sc1
    s_add_u32 s97, s96, 8192
    buffer_store_dwordx4 v[52:55], v65, s[4:7], s97 offen
    buffer_load_dwordx4 v[60:63], v65, s[4:7], s97 offen sc1
    s_add_u32 s97, s96, 12288
    buffer_store_dwordx4 v[52:55], v65, s[4:7], s97 offen
    buffer_load_dwordx4 v[60:63], v65, s[4:7], s97 offen sc1
    s_add_u32 s96, s68, 67108864
    s_add_u32 s97, s96, 16384
    buffer_store_dword v56, v75, s[4:7], s96 offen offset:0
    buffer_store_dword v72, v75, s[4:7], s97 offen offset:0
    buffer_load_dword v60, v75, s[4:7], s96 offen offset:0 sc1
    buffer_load_dword v60, v75, s[4:7], s97 offen offset:0 sc1
    s_cmp_lg_u32 s32, 2
    s_cbranch_scc1 cf_init_done
    buffer_store_dword v56, v75, s[4:7], s96 offen offset:1024
    buffer_store_dword v72, v75, s[4:7], s97 offen offset:1024
    buffer_load_dword v60, v75, s[4:7], s96 offen offset:1024 sc1
    buffer_load_dword v60, v75, s[4:7], s97 offen offset:1024 sc1
    buffer_store_dword v56, v75, s[4:7], s96 offen offset:2048
    buffer_store_dword v72, v75, s[4:7], s97 offen offset:2048
    buffer_load_dword v60, v75, s[4:7], s96 offen offset:2048 sc1
    buffer_load_dword v60, v75, s[4:7], s97 offen offset:2048 sc1
    buffer_store_dword v56, v75, s[4:7], s96 offen offset:3072
    buffer_store_dword v72, v75, s[4:7], s97 offen offset:3072
    buffer_load_dword v60, v75, s[4:7], s96 offen offset:3072 sc1
    buffer_load_dword v60, v75, s[4:7], s97 offen offset:3072 sc1
cf_init_done:
    ds_write_b64 v70, v[0:1] offset:16384
    ds_write_b64 v70, v[2:3] offset:16392
    ds_write_b64 v70, v[4:5] offset:17408
    ds_write_b64 v70, v[6:7] offset:17416
    ds_write_b64 v70, v[8:9] offset:18432
    ds_write_b64 v70, v[10:11] offset:18440
    ds_write_b64 v70, v[12:13] offset:19456
    ds_write_b64 v70, v[14:15] offset:19464
    v_add_u32 v28, 0, v24
    v_add_u32 v29, 0, v25
    v_add_u32 v30, 0, v26
    v_add_u32 v31, 0, v27
    ds_read_b64_tr_b16 a[96:97], v28 offset:0
    ds_read_b64_tr_b16 a[104:105], v28 offset:8
    ds_read_b64_tr_b16 a[112:113], v29 offset:0
    ds_read_b64_tr_b16 a[120:121], v29 offset:8
    ds_read_b64_tr_b16 a[128:129], v30 offset:0
    ds_read_b64_tr_b16 a[136:137], v30 offset:8
    ds_read_b64_tr_b16 a[144:145], v31 offset:0
    ds_read_b64_tr_b16 v[32:33], v31 offset:8
    s_waitcnt vmcnt(12) lgkmcnt(0)
    s_barrier
    s_add_u32 m0, s43, 0
    s_add_u32 s41, s58, 532480
    buffer_load_dwordx4 v16, s[8:11], s41 offen offset:0 nt lds
    s_add_u32 s41, s58, 547840
    buffer_load_dwordx4 v16, s[8:11], s41 offen offset:1024 nt lds
    s_add_u32 s41, s58, 661504
    buffer_load_dwordx4 v16, s[8:11], s41 offen offset:2048 nt lds
    s_add_u32 s41, s58, 676864
    buffer_load_dwordx4 v16, s[8:11], s41 offen offset:3072 nt lds
    ds_write_b64 v70, v[32:33] offset:12288
    v_add_u32 v28, 36864, v24
    v_add_u32 v29, 36864, v25
    v_add_u32 v30, 36864, v26
    v_add_u32 v31, 36864, v27
    ds_read_b64_tr_b16 a[98:99], v28 offset:0
    ds_read_b64_tr_b16 a[106:107], v28 offset:8
    ds_read_b64_tr_b16 a[114:115], v29 offset:0
    ds_read_b64_tr_b16 a[122:123], v29 offset:8
    ds_read_b64_tr_b16 a[130:131], v30 offset:0
    ds_read_b64_tr_b16 a[138:139], v30 offset:8
    ds_read_b64_tr_b16 a[146:147], v31 offset:0
    ds_read_b64_tr_b16 v[0:1], v31 offset:8
    s_waitcnt vmcnt(12) lgkmcnt(0)
    s_barrier
    s_add_u32 m0, s43, 36864
    s_add_u32 s41, s58, 786432
    buffer_load_dwordx4 v16, s[8:11], s41 offen offset:0 nt lds
    s_add_u32 s41, s58, 801792
    buffer_load_dwordx4 v16, s[8:11], s41 offen offset:1024 nt lds
    s_add_u32 s41, s58, 915456
    buffer_load_dwordx4 v16, s[8:11], s41 offen offset:2048 nt lds
    s_add_u32 s41, s58, 930816
    buffer_load_dwordx4 v16, s[8:11], s41 offen offset:3072 nt lds
    ds_write_b64 v70, v[0:1] offset:12296
    v_add_u32 v28, 73728, v24
    v_add_u32 v29, 73728, v25
    v_add_u32 v30, 73728, v26
    v_add_u32 v31, 73728, v27
    ds_read_b64_tr_b16 a[100:101], v28 offset:0
    ds_read_b64_tr_b16 a[108:109], v28 offset:8
    ds_read_b64_tr_b16 a[116:117], v29 offset:0
    ds_read_b64_tr_b16 a[124:125], v29 offset:8
    ds_read_b64_tr_b16 a[132:133], v30 offset:0
    ds_read_b64_tr_b16 a[140:141], v30 offset:8
    ds_read_b64_tr_b16 a[148:149], v31 offset:0
    ds_read_b64_tr_b16 v[32:33], v31 offset:8
    s_waitcnt vmcnt(12) lgkmcnt(0)
    s_barrier
    s_add_u32 m0, s43, 73728
    s_add_u32 s41, s58, 794624
    buffer_load_dwordx4 v16, s[8:11], s41 offen offset:0 nt lds
    s_add_u32 s41, s58, 809984
    buffer_load_dwordx4 v16, s[8:11], s41 offen offset:1024 nt lds
    s_add_u32 s41, s58, 923648
    buffer_load_dwordx4 v16, s[8:11], s41 offen offset:2048 nt lds
    s_add_u32 s41, s58, 939008
    buffer_load_dwordx4 v16, s[8:11], s41 offen offset:3072 nt lds
    ds_write_b64 v70, v[32:33] offset:13312
    v_add_u32 v28, 110592, v24
    v_add_u32 v29, 110592, v25
    v_add_u32 v30, 110592, v26
    v_add_u32 v31, 110592, v27
    ds_read_b64_tr_b16 a[102:103], v28 offset:0
    ds_read_b64_tr_b16 a[110:111], v28 offset:8
    ds_read_b64_tr_b16 a[118:119], v29 offset:0
    ds_read_b64_tr_b16 a[126:127], v29 offset:8
    ds_read_b64_tr_b16 a[134:135], v30 offset:0
    ds_read_b64_tr_b16 a[142:143], v30 offset:8
    ds_read_b64_tr_b16 a[150:151], v31 offset:0
    ds_read_b64_tr_b16 v[0:1], v31 offset:8
    s_waitcnt vmcnt(12) lgkmcnt(0)
    s_barrier
    s_add_u32 m0, s43, 110592
    s_add_u32 s41, s59, 0
    buffer_load_dwordx4 v17, s[8:11], s41 offen offset:0 nt lds
    s_add_u32 s41, s59, 31744
    buffer_load_dwordx4 v17, s[8:11], s41 offen offset:1024 nt lds
    s_add_u32 s41, s59, 129024
    buffer_load_dwordx4 v17, s[8:11], s41 offen offset:2048 nt lds
    s_add_u32 s41, s59, 160768
    buffer_load_dwordx4 v17, s[8:11], s41 offen offset:3072 nt lds
    ds_write_b64 v70, v[0:1] offset:13320
    v_add_u32 v28, 147456, v24
    v_add_u32 v29, 147456, v25
    v_add_u32 v30, 147456, v26
    v_add_u32 v31, 147456, v27
    ds_read_b64_tr_b16 a[152:153], v28 offset:0
    ds_read_b64_tr_b16 a[160:161], v28 offset:8
    ds_read_b64_tr_b16 a[168:169], v29 offset:0
    ds_read_b64_tr_b16 a[176:177], v29 offset:8
    ds_read_b64_tr_b16 a[184:185], v30 offset:0
    ds_read_b64_tr_b16 a[192:193], v30 offset:8
    ds_read_b64_tr_b16 a[200:201], v31 offset:0
    ds_read_b64_tr_b16 a[208:209], v31 offset:8
    s_waitcnt vmcnt(12) lgkmcnt(0)
    s_barrier
    s_mov_b64 s[8:9], s[50:51]
    s_add_u32 m0, s43, 147456
    s_add_u32 s41, s58, 0
    buffer_load_dwordx4 v16, s[8:11], s41 offen offset:0 nt lds
    s_add_u32 s41, s58, 15360
    buffer_load_dwordx4 v16, s[8:11], s41 offen offset:1024 nt lds
    s_add_u32 s41, s58, 129024
    buffer_load_dwordx4 v16, s[8:11], s41 offen offset:2048 nt lds
    s_add_u32 s41, s58, 144384
    buffer_load_dwordx4 v16, s[8:11], s41 offen offset:3072 nt lds
    s_cmp_lg_u32 s13, 0
    s_cbranch_scc1 cf_ma
    v_mov_b32 v54, 1
    s_mov_b64 exec, 1
    buffer_atomic_add v54, off, s[84:87], 0 offset:132
    s_mov_b64 exec, -1
cf_ma:
    v_add_u32 v28, 0, v24
    v_add_u32 v29, 0, v25
    v_add_u32 v30, 0, v26
    v_add_u32 v31, 0, v27
    ds_read_b64_tr_b16 a[154:155], v28 offset:0
    ds_read_b64_tr_b16 a[162:163], v28 offset:8
    ds_read_b64_tr_b16 a[170:171], v29 offset:0
    ds_read_b64_tr_b16 a[178:179], v29 offset:8
    ds_read_b64_tr_b16 a[186:187], v30 offset:0
    ds_read_b64_tr_b16 a[194:195], v30 offset:8
    ds_read_b64_tr_b16 a[202:203], v31 offset:0
    ds_read_b64_tr_b16 a[210:211], v31 offset:8
    s_waitcnt vmcnt(12) lgkmcnt(0)
    s_barrier
    s_add_u32 m0, s43, 0
    s_add_u32 s41, s58, 8192
    buffer_load_dwordx4 v16, s[8:11], s41 offen offset:0 nt lds
    s_add_u32 s41, s58, 23552
    buffer_load_dwordx4 v16, s[8:11], s41 offen offset:1024 nt lds
    s_add_u32 s41, s58, 137216
    buffer_load_dwordx4 v16, s[8:11], s41 offen offset:2048 nt lds
    s_add_u32 s41, s58, 152576
    buffer_load_dwordx4 v16, s[8:11], s41 offen offset:3072 nt lds
    v_add_u32 v28, 36864, v24
    v_add_u32 v29, 36864, v25
    v_add_u32 v30, 36864, v26
    v_add_u32 v31, 36864, v27
    ds_read_b64_tr_b16 a[156:157], v28 offset:0
    ds_read_b64_tr_b16 a[164:165], v28 offset:8
    ds_read_b64_tr_b16 a[172:173], v29 offset:0
    ds_read_b64_tr_b16 a[180:181], v29 offset:8
    ds_read_b64_tr_b16 a[188:189], v30 offset:0
    ds_read_b64_tr_b16 a[196:197], v30 offset:8
    ds_read_b64_tr_b16 a[204:205], v31 offset:0
    ds_read_b64_tr_b16 a[212:213], v31 offset:8
    s_waitcnt vmcnt(12) lgkmcnt(0)
    s_barrier
    s_add_u32 m0, s43, 36864
    s_add_u32 s41, s58, 262144
    buffer_load_dwordx4 v16, s[8:11], s41 offen offset:0 nt lds
    s_add_u32 s41, s58, 277504
    buffer_load_dwordx4 v16, s[8:11], s41 offen offset:1024 nt lds
    s_add_u32 s41, s58, 391168
    buffer_load_dwordx4 v16, s[8:11], s41 offen offset:2048 nt lds
    s_add_u32 s41, s58, 406528
    buffer_load_dwordx4 v16, s[8:11], s41 offen offset:3072 nt lds
    v_add_u32 v28, 73728, v24
    v_add_u32 v29, 73728, v25
    v_add_u32 v30, 73728, v26
    v_add_u32 v31, 73728, v27
    ds_read_b64_tr_b16 a[158:159], v28 offset:0
    ds_read_b64_tr_b16 a[166:167], v28 offset:8
    ds_read_b64_tr_b16 a[174:175], v29 offset:0
    ds_read_b64_tr_b16 a[182:183], v29 offset:8
    ds_read_b64_tr_b16 a[190:191], v30 offset:0
    ds_read_b64_tr_b16 a[198:199], v30 offset:8
    ds_read_b64_tr_b16 a[206:207], v31 offset:0
    ds_read_b64_tr_b16 a[214:215], v31 offset:8
    s_waitcnt vmcnt(12) lgkmcnt(0)
    s_barrier
    s_add_u32 m0, s43, 73728
    s_add_u32 s41, s58, 270336
    buffer_load_dwordx4 v16, s[8:11], s41 offen offset:0 nt lds
    s_add_u32 s41, s58, 285696
    buffer_load_dwordx4 v16, s[8:11], s41 offen offset:1024 nt lds
    s_add_u32 s41, s58, 399360
    buffer_load_dwordx4 v16, s[8:11], s41 offen offset:2048 nt lds
    s_add_u32 s41, s58, 414720
    buffer_load_dwordx4 v16, s[8:11], s41 offen offset:3072 nt lds
    v_add_u32 v77, 110592, v20
    ds_read_b64_tr_b16 a[216:217], v77 offset:0
    ds_read_b64_tr_b16 a[218:219], v77 offset:4096
    ds_read_b64_tr_b16 a[220:221], v77 offset:8192
    ds_read_b64_tr_b16 a[222:223], v77 offset:12288
    ds_read_b64_tr_b16 a[224:225], v77 offset:8
    ds_read_b64_tr_b16 a[226:227], v77 offset:4104
    ds_read_b64_tr_b16 a[228:229], v77 offset:8200
    ds_read_b64_tr_b16 a[230:231], v77 offset:12296
    s_waitcnt vmcnt(12) lgkmcnt(0)
    s_barrier
    s_add_u32 m0, s43, 110592
    s_add_u32 s41, s58, 524288
    buffer_load_dwordx4 v16, s[8:11], s41 offen offset:0 nt lds
    s_add_u32 s41, s58, 539648
    buffer_load_dwordx4 v16, s[8:11], s41 offen offset:1024 nt lds
    s_add_u32 s41, s58, 653312
    buffer_load_dwordx4 v16, s[8:11], s41 offen offset:2048 nt lds
    s_add_u32 s41, s58, 668672
    buffer_load_dwordx4 v16, s[8:11], s41 offen offset:3072 nt lds
    v_add_u32 v28, 147456, v24
    v_add_u32 v29, 147456, v25
    v_add_u32 v30, 147456, v26
    v_add_u32 v31, 147456, v27
    ds_read_b64_tr_b16 v[0:1], v28 offset:0
    ds_read_b64_tr_b16 v[2:3], v28 offset:8
    ds_read_b64_tr_b16 v[4:5], v29 offset:0
    ds_read_b64_tr_b16 v[6:7], v29 offset:8
    ds_read_b64_tr_b16 a[0:1], v30 offset:0
    ds_read_b64_tr_b16 v[8:9], v30 offset:8
    ds_read_b64_tr_b16 a[8:9], v31 offset:0
    ds_read_b64_tr_b16 v[10:11], v31 offset:8
    s_waitcnt vmcnt(12) lgkmcnt(0)
    s_barrier
    s_add_u32 m0, s43, 147456
    s_add_u32 s41, s58, 532480
    buffer_load_dwordx4 v16, s[8:11], s41 offen offset:0 nt lds
    s_add_u32 s41, s58, 547840
    buffer_load_dwordx4 v16, s[8:11], s41 offen offset:1024 nt lds
    s_add_u32 s41, s58, 661504
    buffer_load_dwordx4 v16, s[8:11], s41 offen offset:2048 nt lds
    s_add_u32 s41, s58, 676864
    buffer_load_dwordx4 v16, s[8:11], s41 offen offset:3072 nt lds
    ds_write_b64 v70, v[0:1] offset:0
    ds_write_b64 v70, v[2:3] offset:2048
    ds_write_b64 v70, v[4:5] offset:4096
    ds_write_b64 v70, v[6:7] offset:6144
    ds_write_b64 v70, v[8:9] offset:10240
    ds_write_b64 v70, v[10:11] offset:14336
    v_add_u32 v28, 0, v24
    v_add_u32 v29, 0, v25
    v_add_u32 v30, 0, v26
    v_add_u32 v31, 0, v27
    ds_read_b64_tr_b16 v[32:33], v28 offset:0
    ds_read_b64_tr_b16 v[34:35], v28 offset:8
    ds_read_b64_tr_b16 v[36:37], v29 offset:0
    ds_read_b64_tr_b16 v[38:39], v29 offset:8
    ds_read_b64_tr_b16 a[2:3], v30 offset:0
    ds_read_b64_tr_b16 v[40:41], v30 offset:8
    ds_read_b64_tr_b16 a[10:11], v31 offset:0
    ds_read_b64_tr_b16 v[42:43], v31 offset:8
    s_waitcnt vmcnt(12) lgkmcnt(0)
    s_barrier
    s_add_u32 m0, s43, 0
    s_add_u32 s41, s58, 786432
    buffer_load_dwordx4 v16, s[8:11], s41 offen offset:0 nt lds
    s_add_u32 s41, s58, 801792
    buffer_load_dwordx4 v16, s[8:11], s41 offen offset:1024 nt lds
    s_add_u32 s41, s58, 915456
    buffer_load_dwordx4 v16, s[8:11], s41 offen offset:2048 nt lds
    s_add_u32 s41, s58, 930816
    buffer_load_dwordx4 v16, s[8:11], s41 offen offset:3072 nt lds
    ds_write_b64 v70, v[32:33] offset:8
    ds_write_b64 v70, v[34:35] offset:2056
    ds_write_b64 v70, v[36:37] offset:4104
    ds_write_b64 v70, v[38:39] offset:6152
    ds_write_b64 v70, v[40:41] offset:10248
    ds_write_b64 v70, v[42:43] offset:14344
    v_add_u32 v28, 36864, v24
    v_add_u32 v29, 36864, v25
    v_add_u32 v30, 36864, v26
    v_add_u32 v31, 36864, v27
    ds_read_b64_tr_b16 v[0:1], v28 offset:0
    ds_read_b64_tr_b16 v[2:3], v28 offset:8
    ds_read_b64_tr_b16 v[4:5], v29 offset:0
    ds_read_b64_tr_b16 v[6:7], v29 offset:8
    ds_read_b64_tr_b16 a[4:5], v30 offset:0
    ds_read_b64_tr_b16 v[8:9], v30 offset:8
    ds_read_b64_tr_b16 a[12:13], v31 offset:0
    ds_read_b64_tr_b16 v[10:11], v31 offset:8
    s_waitcnt vmcnt(12) lgkmcnt(0)
    s_barrier
    s_add_u32 m0, s43, 36864
    s_add_u32 s41, s58, 794624
    buffer_load_dwordx4 v16, s[8:11], s41 offen offset:0 nt lds
    s_add_u32 s41, s58, 809984
    buffer_load_dwordx4 v16, s[8:11], s41 offen offset:1024 nt lds
    s_add_u32 s41, s58, 923648
    buffer_load_dwordx4 v16, s[8:11], s41 offen offset:2048 nt lds
    s_add_u32 s41, s58, 939008
    buffer_load_dwordx4 v16, s[8:11], s41 offen offset:3072 nt lds
    ds_write_b64 v70, v[0:1] offset:1024
    ds_write_b64 v70, v[2:3] offset:3072
    ds_write_b64 v70, v[4:5] offset:5120
    ds_write_b64 v70, v[6:7] offset:7168
    ds_write_b64 v70, v[8:9] offset:11264
    ds_write_b64 v70, v[10:11] offset:15360
    v_add_u32 v28, 73728, v24
    v_add_u32 v29, 73728, v25
    v_add_u32 v30, 73728, v26
    v_add_u32 v31, 73728, v27
    ds_read_b64_tr_b16 v[32:33], v28 offset:0
    ds_read_b64_tr_b16 v[34:35], v28 offset:8
    ds_read_b64_tr_b16 v[36:37], v29 offset:0
    ds_read_b64_tr_b16 v[38:39], v29 offset:8
    ds_read_b64_tr_b16 a[6:7], v30 offset:0
    ds_read_b64_tr_b16 v[40:41], v30 offset:8
    ds_read_b64_tr_b16 a[14:15], v31 offset:0
    ds_read_b64_tr_b16 v[42:43], v31 offset:8
    s_waitcnt vmcnt(12) lgkmcnt(0)
    s_barrier
    s_add_u32 m0, s43, 73728
    s_add_u32 s41, s59, 0
    buffer_load_dwordx4 v17, s[8:11], s41 offen offset:0 nt lds
    s_add_u32 s41, s59, 31744
    buffer_load_dwordx4 v17, s[8:11], s41 offen offset:1024 nt lds
    s_add_u32 s41, s59, 129024
    buffer_load_dwordx4 v17, s[8:11], s41 offen offset:2048 nt lds
    s_add_u32 s41, s59, 160768
    buffer_load_dwordx4 v17, s[8:11], s41 offen offset:3072 nt lds
    ds_write_b64 v70, v[32:33] offset:1032
    ds_write_b64 v70, v[34:35] offset:3080
    ds_write_b64 v70, v[36:37] offset:5128
    ds_write_b64 v70, v[38:39] offset:7176
    ds_write_b64 v70, v[40:41] offset:11272
    ds_write_b64 v70, v[42:43] offset:15368
    v_add_u32 v28, 110592, v24
    v_add_u32 v29, 110592, v25
    v_add_u32 v30, 110592, v26
    v_add_u32 v31, 110592, v27
    ds_read_b64_tr_b16 a[16:17], v28 offset:0
    ds_read_b64_tr_b16 a[24:25], v28 offset:8
    ds_read_b64_tr_b16 a[32:33], v29 offset:0
    ds_read_b64_tr_b16 a[40:41], v29 offset:8
    ds_read_b64_tr_b16 a[48:49], v30 offset:0
    ds_read_b64_tr_b16 a[56:57], v30 offset:8
    ds_read_b64_tr_b16 a[64:65], v31 offset:0
    ds_read_b64_tr_b16 a[72:73], v31 offset:8
    s_waitcnt vmcnt(12) lgkmcnt(0)
    s_barrier
    s_mov_b64 s[8:9], s[54:55]
    s_add_u32 m0, s43, 110592
    s_add_u32 s41, s58, 0
    buffer_load_dwordx4 v16, s[8:11], s41 offen offset:0 nt lds
    s_add_u32 s41, s58, 15360
    buffer_load_dwordx4 v16, s[8:11], s41 offen offset:1024 nt lds
    s_add_u32 s41, s58, 129024
    buffer_load_dwordx4 v16, s[8:11], s41 offen offset:2048 nt lds
    s_add_u32 s41, s58, 144384
    buffer_load_dwordx4 v16, s[8:11], s41 offen offset:3072 nt lds
    v_add_u32 v28, 147456, v24
    v_add_u32 v29, 147456, v25
    v_add_u32 v30, 147456, v26
    v_add_u32 v31, 147456, v27
    ds_read_b64_tr_b16 a[18:19], v28 offset:0
    ds_read_b64_tr_b16 a[26:27], v28 offset:8
    ds_read_b64_tr_b16 a[34:35], v29 offset:0
    ds_read_b64_tr_b16 a[42:43], v29 offset:8
    ds_read_b64_tr_b16 a[50:51], v30 offset:0
    ds_read_b64_tr_b16 a[58:59], v30 offset:8
    ds_read_b64_tr_b16 a[66:67], v31 offset:0
    ds_read_b64_tr_b16 a[74:75], v31 offset:8
    s_waitcnt vmcnt(12) lgkmcnt(0)
    s_barrier
    s_add_u32 m0, s43, 147456
    s_add_u32 s41, s58, 8192
    buffer_load_dwordx4 v16, s[8:11], s41 offen offset:0 nt lds
    s_add_u32 s41, s58, 23552
    buffer_load_dwordx4 v16, s[8:11], s41 offen offset:1024 nt lds
    s_add_u32 s41, s58, 137216
    buffer_load_dwordx4 v16, s[8:11], s41 offen offset:2048 nt lds
    s_add_u32 s41, s58, 152576
    buffer_load_dwordx4 v16, s[8:11], s41 offen offset:3072 nt lds
    v_add_u32 v28, 0, v24
    v_add_u32 v29, 0, v25
    v_add_u32 v30, 0, v26
    v_add_u32 v31, 0, v27
    ds_read_b64_tr_b16 a[20:21], v28 offset:0
    ds_read_b64_tr_b16 a[28:29], v28 offset:8
    ds_read_b64_tr_b16 a[36:37], v29 offset:0
    ds_read_b64_tr_b16 a[44:45], v29 offset:8
    ds_read_b64_tr_b16 a[52:53], v30 offset:0
    ds_read_b64_tr_b16 a[60:61], v30 offset:8
    ds_read_b64_tr_b16 a[68:69], v31 offset:0
    ds_read_b64_tr_b16 a[76:77], v31 offset:8
    s_waitcnt vmcnt(12) lgkmcnt(0)
    s_barrier
    s_add_u32 m0, s43, 0
    s_add_u32 s41, s58, 262144
    buffer_load_dwordx4 v16, s[8:11], s41 offen offset:0 nt lds
    s_add_u32 s41, s58, 277504
    buffer_load_dwordx4 v16, s[8:11], s41 offen offset:1024 nt lds
    s_add_u32 s41, s58, 391168
    buffer_load_dwordx4 v16, s[8:11], s41 offen offset:2048 nt lds
    s_add_u32 s41, s58, 406528
    buffer_load_dwordx4 v16, s[8:11], s41 offen offset:3072 nt lds
    v_add_u32 v28, 36864, v24
    v_add_u32 v29, 36864, v25
    v_add_u32 v30, 36864, v26
    v_add_u32 v31, 36864, v27
    ds_read_b64_tr_b16 a[22:23], v28 offset:0
    ds_read_b64_tr_b16 a[30:31], v28 offset:8
    ds_read_b64_tr_b16 a[38:39], v29 offset:0
    ds_read_b64_tr_b16 a[46:47], v29 offset:8
    ds_read_b64_tr_b16 a[54:55], v30 offset:0
    ds_read_b64_tr_b16 a[62:63], v30 offset:8
    ds_read_b64_tr_b16 a[70:71], v31 offset:0
    ds_read_b64_tr_b16 a[78:79], v31 offset:8
    s_waitcnt vmcnt(12) lgkmcnt(0)
    s_barrier
    s_add_u32 m0, s43, 36864
    s_add_u32 s41, s58, 270336
    buffer_load_dwordx4 v16, s[8:11], s41 offen offset:0 nt lds
    s_add_u32 s41, s58, 285696
    buffer_load_dwordx4 v16, s[8:11], s41 offen offset:1024 nt lds
    s_add_u32 s41, s58, 399360
    buffer_load_dwordx4 v16, s[8:11], s41 offen offset:2048 nt lds
    s_add_u32 s41, s58, 414720
    buffer_load_dwordx4 v16, s[8:11], s41 offen offset:3072 nt lds
    s_lshl_b32 s26, s12, 14
    s_add_u32 s26, s26, 0
    s_mul_i32 s40, s13, 3072
    s_add_u32 s24, s26, s40
    s_lshl_b32 s96, s12, 7
    s_add_u32 s29, s96, 125845504
    s_add_u32 s96, s96, 125829120
    v_bfe_u32 v78, v65, 2, 5
    buffer_load_dword v54, off, s[84:87], 0 offset:132 sc1
    buffer_load_dword v55, off, s[84:87], 0 offset:216 sc1
    buffer_load_dword v56, v78, s[4:7], s96 offen offset:16 sc1
    v_add_u32 v77, 73728, v20
    ds_read_b64_tr_b16 a[80:81], v77 offset:0
    ds_read_b64_tr_b16 a[82:83], v77 offset:4096
    ds_read_b64_tr_b16 a[84:85], v77 offset:8192
    ds_read_b64_tr_b16 a[86:87], v77 offset:12288
    ds_read_b64_tr_b16 a[88:89], v77 offset:8
    ds_read_b64_tr_b16 a[90:91], v77 offset:4104
    ds_read_b64_tr_b16 a[92:93], v77 offset:8200
    ds_read_b64_tr_b16 a[94:95], v77 offset:12296
    s_waitcnt vmcnt(12) lgkmcnt(0)
    s_barrier
    s_add_u32 m0, s43, 73728
    s_add_u32 s41, s58, 524288
    buffer_load_dwordx4 v16, s[8:11], s41 offen offset:0 nt lds
    s_add_u32 s41, s58, 539648
    buffer_load_dwordx4 v16, s[8:11], s41 offen offset:1024 nt lds
    s_add_u32 s41, s58, 653312
    buffer_load_dwordx4 v16, s[8:11], s41 offen offset:2048 nt lds
    s_add_u32 s41, s58, 668672
    buffer_load_dwordx4 v16, s[8:11], s41 offen offset:3072 nt lds
    v_add_u32 v28, 110592, v24
    v_add_u32 v29, 110592, v25
    v_add_u32 v30, 110592, v26
    v_add_u32 v31, 110592, v27
    ds_read_b64_tr_b16 a[232:233], v28 offset:0
    ds_read_b64_tr_b16 v[32:33], v28 offset:8
    ds_read_b64_tr_b16 a[240:241], v29 offset:0
    ds_read_b64_tr_b16 a[248:249], v29 offset:8
    ds_read_b64_tr_b16 v[144:145], v30 offset:0
    ds_read_b64_tr_b16 v[152:153], v30 offset:8
    ds_read_b64_tr_b16 v[160:161], v31 offset:0
    ds_read_b64_tr_b16 v[168:169], v31 offset:8
    s_waitcnt vmcnt(12) lgkmcnt(0)
    s_barrier
    s_add_u32 m0, s43, 110592
    s_add_u32 s41, s58, 532480
    buffer_load_dwordx4 v16, s[8:11], s41 offen offset:0 nt lds
    s_add_u32 s41, s58, 547840
    buffer_load_dwordx4 v16, s[8:11], s41 offen offset:1024 nt lds
    s_add_u32 s41, s58, 661504
    buffer_load_dwordx4 v16, s[8:11], s41 offen offset:2048 nt lds
    s_add_u32 s41, s58, 676864
    buffer_load_dwordx4 v16, s[8:11], s41 offen offset:3072 nt lds
    ds_write_b64 v70, v[32:33] offset:8192
    v_add_u32 v28, 147456, v24
    v_add_u32 v29, 147456, v25
    v_add_u32 v30, 147456, v26
    v_add_u32 v31, 147456, v27
    ds_read_b64_tr_b16 a[234:235], v28 offset:0
    ds_read_b64_tr_b16 v[0:1], v28 offset:8
    ds_read_b64_tr_b16 a[242:243], v29 offset:0
    ds_read_b64_tr_b16 a[250:251], v29 offset:8
    ds_read_b64_tr_b16 v[146:147], v30 offset:0
    ds_read_b64_tr_b16 v[154:155], v30 offset:8
    ds_read_b64_tr_b16 v[162:163], v31 offset:0
    ds_read_b64_tr_b16 v[170:171], v31 offset:8
    s_waitcnt vmcnt(12) lgkmcnt(0)
    s_barrier
    s_add_u32 m0, s43, 147456
    s_add_u32 s41, s58, 786432
    buffer_load_dwordx4 v16, s[8:11], s41 offen offset:0 nt lds
    s_add_u32 s41, s58, 801792
    buffer_load_dwordx4 v16, s[8:11], s41 offen offset:1024 nt lds
    s_add_u32 s41, s58, 915456
    buffer_load_dwordx4 v16, s[8:11], s41 offen offset:2048 nt lds
    s_add_u32 s41, s58, 930816
    buffer_load_dwordx4 v16, s[8:11], s41 offen offset:3072 nt lds
    ds_write_b64 v70, v[0:1] offset:8200
    v_add_u32 v28, 0, v24
    v_add_u32 v29, 0, v25
    v_add_u32 v30, 0, v26
    v_add_u32 v31, 0, v27
    ds_read_b64_tr_b16 a[236:237], v28 offset:0
    ds_read_b64_tr_b16 v[32:33], v28 offset:8
    ds_read_b64_tr_b16 a[244:245], v29 offset:0
    ds_read_b64_tr_b16 a[252:253], v29 offset:8
    ds_read_b64_tr_b16 v[148:149], v30 offset:0
    ds_read_b64_tr_b16 v[156:157], v30 offset:8
    ds_read_b64_tr_b16 v[164:165], v31 offset:0
    ds_read_b64_tr_b16 v[172:173], v31 offset:8
    s_waitcnt vmcnt(12) lgkmcnt(0)
    s_barrier
    s_add_u32 m0, s43, 0
    s_add_u32 s41, s58, 794624
    buffer_load_dwordx4 v16, s[8:11], s41 offen offset:0 nt lds
    s_add_u32 s41, s58, 809984
    buffer_load_dwordx4 v16, s[8:11], s41 offen offset:1024 nt lds
    s_add_u32 s41, s58, 923648
    buffer_load_dwordx4 v16, s[8:11], s41 offen offset:2048 nt lds
    s_add_u32 s41, s58, 939008
    buffer_load_dwordx4 v16, s[8:11], s41 offen offset:3072 nt lds
    ds_write_b64 v70, v[32:33] offset:9216
    v_add_u32 v28, 36864, v24
    v_add_u32 v29, 36864, v25
    v_add_u32 v30, 36864, v26
    v_add_u32 v31, 36864, v27
    ds_read_b64_tr_b16 a[238:239], v28 offset:0
    ds_read_b64_tr_b16 v[0:1], v28 offset:8
    ds_read_b64_tr_b16 a[246:247], v29 offset:0
    ds_read_b64_tr_b16 a[254:255], v29 offset:8
    ds_read_b64_tr_b16 v[150:151], v30 offset:0
    ds_read_b64_tr_b16 v[158:159], v30 offset:8
    ds_read_b64_tr_b16 v[166:167], v31 offset:0
    ds_read_b64_tr_b16 v[174:175], v31 offset:8
    s_waitcnt vmcnt(12) lgkmcnt(0)
    s_barrier
    s_add_u32 m0, s43, 36864
    s_add_u32 s41, s59, 0
    buffer_load_dwordx4 v17, s[8:11], s41 offen offset:0 nt lds
    s_add_u32 s41, s59, 31744
    buffer_load_dwordx4 v17, s[8:11], s41 offen offset:1024 nt lds
    s_add_u32 s41, s59, 129024
    buffer_load_dwordx4 v17, s[8:11], s41 offen offset:2048 nt lds
    s_add_u32 s41, s59, 160768
    buffer_load_dwordx4 v17, s[8:11], s41 offen offset:3072 nt lds
    v_readfirstlane_b32 s94, v54
    v_readfirstlane_b32 s95, v55
    v_mov_b32 v77, v56
    s_nop 0
    v_subrev_u32 v77, s95, v77
    v_cmp_lt_u32 vcc, 16, v77
    s_nop 1
    v_cndmask_b32 v77, v77, 0, vcc
    v_bfe_u32 v79, v78, 2, 2
    v_lshl_add_u32 v77, v77, 2, v79
    s_nop 1
    v_min_u32_dpp v77, v77, v77 row_ror:1 row_mask:0xf bank_mask:0xf
    s_nop 1
    v_min_u32_dpp v77, v77, v77 row_ror:2 row_mask:0xf bank_mask:0xf
    s_nop 1
    v_min_u32_dpp v77, v77, v77 row_ror:4 row_mask:0xf bank_mask:0xf
    s_nop 0
    v_readfirstlane_b32 s97, v77
    s_cmp_eq_u32 s95, 0
    s_cselect_b32 s97, 0, s97
    s_cmp_lt_u32 s97, 3
    s_cbranch_scc1 cf_mb
    s_add_u32 s40, s24, 0
    s_add_u32 s40, s40, s33
    s_sub_u32 s41, s96, s40
    v_bfe_u32 v77, v65, 2, 5
    v_add3_u32 v77, v77, s41, 16
    v_lshlrev_b32 v78, 3, v69
    s_nop 0
    v_mov_b32_dpp v78, v77 quad_perm:[0,1,2,3] row_mask:0xc bank_mask:0xf
    buffer_load_dword v58, v78, s[4:7], s40 offen sc1
    s_add_u32 s40, s24, 524288
    s_add_u32 s40, s40, s33
    s_sub_u32 s41, s96, s40
    v_bfe_u32 v77, v65, 2, 5
    v_add3_u32 v77, v77, s41, 16
    v_lshlrev_b32 v78, 3, v69
    s_nop 0
    v_mov_b32_dpp v78, v77 quad_perm:[0,1,2,3] row_mask:0xc bank_mask:0xf
    buffer_load_dword v58, v78, s[4:7], s40 offen sc1
cf_mb:
    s_cmp_lt_u32 s94, 32
    s_cbranch_scc1 cf_mc
    s_cmp_lg_u32 s13, 0
    s_cbranch_scc1 cf_mc
    v_mov_b32 v76, 1
    v_mov_b32 v77, 0
    s_mov_b64 exec, 1
    buffer_atomic_cmpswap v[76:77], off, s[84:87], 0 offset:28 sc0
    s_mov_b64 exec, -1
cf_mc:
    s_nop 1
    ds_write_b64 v70, v[0:1] offset:9224
    v_add_u32 v28, 73728, v24
    v_add_u32 v29, 73728, v25
    v_add_u32 v30, 73728, v26
    v_add_u32 v31, 73728, v27
    ds_read_b64_tr_b16 v[176:177], v28 offset:0
    ds_read_b64_tr_b16 v[184:185], v28 offset:8
    ds_read_b64_tr_b16 v[192:193], v29 offset:0
    ds_read_b64_tr_b16 v[200:201], v29 offset:8
    ds_read_b64_tr_b16 v[208:209], v30 offset:0
    ds_read_b64_tr_b16 v[216:217], v30 offset:8
    ds_read_b64_tr_b16 v[224:225], v31 offset:0
    ds_read_b64_tr_b16 v[232:233], v31 offset:8
    s_waitcnt vmcnt(12) lgkmcnt(0)
    s_barrier
    s_mov_b64 s[8:9], s[56:57]
    s_add_u32 m0, s43, 73728
    s_add_u32 s41, s60, 128
    buffer_load_dwordx4 v18, s[8:11], s41 offen offset:0 nt lds
    s_add_u32 s41, s60, 8320
    buffer_load_dwordx4 v18, s[8:11], s41 offen offset:1024 nt lds
    s_add_u32 s41, s60, 16512
    buffer_load_dwordx4 v18, s[8:11], s41 offen offset:2048 nt lds
    s_add_u32 s41, s60, 24704
    buffer_load_dwordx4 v18, s[8:11], s41 offen offset:3072 nt lds
    v_add_u32 v28, 110592, v24
    v_add_u32 v29, 110592, v25
    v_add_u32 v30, 110592, v26
    v_add_u32 v31, 110592, v27
    ds_read_b64_tr_b16 v[178:179], v28 offset:0
    ds_read_b64_tr_b16 v[186:187], v28 offset:8
    ds_read_b64_tr_b16 v[194:195], v29 offset:0
    ds_read_b64_tr_b16 v[202:203], v29 offset:8
    ds_read_b64_tr_b16 v[210:211], v30 offset:0
    ds_read_b64_tr_b16 v[218:219], v30 offset:8
    ds_read_b64_tr_b16 v[226:227], v31 offset:0
    ds_read_b64_tr_b16 v[234:235], v31 offset:8
    s_waitcnt vmcnt(12) lgkmcnt(0)
    s_barrier
    s_add_u32 m0, s43, 110592
    s_add_u32 s41, s61, 128
    buffer_load_dwordx4 v18, s[8:11], s41 offen offset:0 nt lds
    s_add_u32 s41, s61, 8320
    buffer_load_dwordx4 v18, s[8:11], s41 offen offset:1024 nt lds
    s_add_u32 s41, s61, 16512
    buffer_load_dwordx4 v18, s[8:11], s41 offen offset:2048 nt lds
    s_add_u32 s41, s61, 24704
    buffer_load_dwordx4 v18, s[8:11], s41 offen offset:3072 nt lds
    v_add_u32 v28, 147456, v24
    v_add_u32 v29, 147456, v25
    v_add_u32 v30, 147456, v26
    v_add_u32 v31, 147456, v27
    ds_read_b64_tr_b16 v[180:181], v28 offset:0
    ds_read_b64_tr_b16 v[188:189], v28 offset:8
    ds_read_b64_tr_b16 v[196:197], v29 offset:0
    ds_read_b64_tr_b16 v[204:205], v29 offset:8
    ds_read_b64_tr_b16 v[212:213], v30 offset:0
    ds_read_b64_tr_b16 v[220:221], v30 offset:8
    ds_read_b64_tr_b16 v[228:229], v31 offset:0
    ds_read_b64_tr_b16 v[236:237], v31 offset:8
    s_waitcnt vmcnt(12) lgkmcnt(0)
    s_barrier
    s_add_u32 m0, s43, 147456
    s_add_u32 s41, s62, 128
    buffer_load_dwordx4 v18, s[8:11], s41 offen offset:0 nt lds
    s_add_u32 s41, s62, 8320
    buffer_load_dwordx4 v18, s[8:11], s41 offen offset:1024 nt lds
    s_add_u32 s41, s62, 16512
    buffer_load_dwordx4 v18, s[8:11], s41 offen offset:2048 nt lds
    s_add_u32 s41, s62, 24704
    buffer_load_dwordx4 v18, s[8:11], s41 offen offset:3072 nt lds
    v_add_u32 v28, 0, v24
    v_add_u32 v29, 0, v25
    v_add_u32 v30, 0, v26
    v_add_u32 v31, 0, v27
    ds_read_b64_tr_b16 v[182:183], v28 offset:0
    ds_read_b64_tr_b16 v[190:191], v28 offset:8
    ds_read_b64_tr_b16 v[198:199], v29 offset:0
    ds_read_b64_tr_b16 v[206:207], v29 offset:8
    ds_read_b64_tr_b16 v[214:215], v30 offset:0
    ds_read_b64_tr_b16 v[222:223], v30 offset:8
    ds_read_b64_tr_b16 v[230:231], v31 offset:0
    ds_read_b64_tr_b16 v[238:239], v31 offset:8
    s_waitcnt vmcnt(12) lgkmcnt(0)
    s_barrier
    s_add_u32 m0, s43, 0
    s_add_u32 s41, s63, 128
    buffer_load_dwordx4 v18, s[8:11], s41 offen offset:0 nt lds
    s_add_u32 s41, s63, 8320
    buffer_load_dwordx4 v18, s[8:11], s41 offen offset:1024 nt lds
    s_add_u32 s41, s63, 16512
    buffer_load_dwordx4 v18, s[8:11], s41 offen offset:2048 nt lds
    s_add_u32 s41, s63, 24704
    buffer_load_dwordx4 v18, s[8:11], s41 offen offset:3072 nt lds
    v_mov_b32 v78, v21
    v_mov_b32 v79, v22
    v_add_u32 v77, 36864, v20
    ds_read_b64_tr_b16 v[240:241], v77 offset:0
    ds_read_b64_tr_b16 v[242:243], v77 offset:4096
    ds_read_b64_tr_b16 v[244:245], v77 offset:8192
    ds_read_b64_tr_b16 v[246:247], v77 offset:12288
    ds_read_b64_tr_b16 v[248:249], v77 offset:8
    ds_read_b64_tr_b16 v[250:251], v77 offset:4104
    ds_read_b64_tr_b16 v[252:253], v77 offset:8200
    ds_read_b64_tr_b16 v[254:255], v77 offset:12296
    s_waitcnt vmcnt(12) lgkmcnt(0)
    s_barrier
    v_add_u32 v77, 73728, v79
    s_waitcnt lgkmcnt(0)
    ds_read_b64_tr_b16 v[0:1], v77 offset:0
    ds_read_b64_tr_b16 v[2:3], v77 offset:256
    ds_read_b64_tr_b16 v[4:5], v77 offset:2048
    ds_read_b64_tr_b16 v[6:7], v77 offset:2304
    ds_read_b64_tr_b16 v[8:9], v77 offset:8
    ds_read_b64_tr_b16 v[10:11], v77 offset:264
    ds_read_b64_tr_b16 v[12:13], v77 offset:2056
    ds_read_b64_tr_b16 v[14:15], v77 offset:2312
    s_waitcnt vmcnt(8) lgkmcnt(0)
    s_barrier
    v_add_u32 v77, 110592, v78
    ds_read_b64_tr_b16 v[16:17], v77 offset:0
    ds_read_b64_tr_b16 v[18:19], v77 offset:256
    ds_read_b64_tr_b16 v[20:21], v77 offset:2048
    ds_read_b64_tr_b16 v[22:23], v77 offset:2304
    ds_read_b64_tr_b16 v[24:25], v77 offset:8
    ds_read_b64_tr_b16 v[26:27], v77 offset:264
    ds_read_b64_tr_b16 v[28:29], v77 offset:2056
    ds_read_b64_tr_b16 v[30:31], v77 offset:2312
    s_waitcnt vmcnt(4) lgkmcnt(0)
    s_barrier
    v_add_u32 v77, 147456, v78
    ds_read_b64_tr_b16 v[32:33], v77 offset:0
    ds_read_b64_tr_b16 v[34:35], v77 offset:256
    ds_read_b64_tr_b16 v[36:37], v77 offset:2048
    ds_read_b64_tr_b16 v[38:39], v77 offset:2304
    ds_read_b64_tr_b16 v[40:41], v77 offset:8
    ds_read_b64_tr_b16 v[42:43], v77 offset:264
    ds_read_b64_tr_b16 v[44:45], v77 offset:2056
    ds_read_b64_tr_b16 v[46:47], v77 offset:2312
    s_waitcnt vmcnt(0) lgkmcnt(0)
    s_barrier
    v_add_u32 v77, 0, v78
    ds_read_b64_tr_b16 v[48:49], v77 offset:0
    ds_read_b64_tr_b16 v[50:51], v77 offset:256
    ds_read_b64_tr_b16 v[52:53], v77 offset:2048
    ds_read_b64_tr_b16 v[54:55], v77 offset:2304
    ds_read_b64_tr_b16 v[56:57], v77 offset:8
    ds_read_b64_tr_b16 v[58:59], v77 offset:264
    ds_read_b64_tr_b16 v[60:61], v77 offset:2056
    ds_read_b64_tr_b16 v[62:63], v77 offset:2312
    s_waitcnt lgkmcnt(0)
    s_barrier
    ds_write_b128 v70, v[0:3] offset:20480
    ds_write_b128 v70, v[4:7] offset:21504
    ds_write_b128 v70, v[8:11] offset:22528
    ds_write_b128 v70, v[12:15] offset:23552
    ds_write_b128 v70, v[16:19] offset:24576
    ds_write_b128 v70, v[20:23] offset:25600
    ds_write_b128 v70, v[24:27] offset:26624
    ds_write_b128 v70, v[28:31] offset:27648
    ds_write_b128 v70, v[32:35] offset:28672
    ds_write_b128 v70, v[36:39] offset:29696
    ds_write_b128 v70, v[40:43] offset:30720
    ds_write_b128 v70, v[44:47] offset:31744
    ds_write_b128 v70, v[48:51] offset:32768
    ds_write_b128 v70, v[52:55] offset:33792
    ds_write_b128 v70, v[56:59] offset:34816
    ds_write_b128 v70, v[60:63] offset:35840
    s_waitcnt lgkmcnt(0)
    v_bfe_u32 v60, v65, 4, 6
    v_and_b32 v61, 15, v60
    v_lshrrev_b32 v62, 4, v60
    v_mov_b32 v50, 0x3f80
    v_mov_b32 v51, 0x3f800000
    v_and_b32 v77, 1, v62
    v_lshlrev_b32 v77, 2, v77
    v_sub_u32 v77, v61, v77
    v_and_b32 v78, 3, v61
    v_lshlrev_b32 v78, 2, v78
    v_lshrrev_b32 v79, 2, v61
    v_add_u32 v78, v78, v79
    v_cmp_eq_u32 vcc, 0, v77
    s_nop 1
    v_cndmask_b32 v8, 0, v50, vcc
    v_cmp_eq_u32 vcc, 1, v77
    s_nop 1
    v_cndmask_b32 v8, v8, v51, vcc
    v_cmp_eq_u32 vcc, 0, v78
    s_nop 1
    v_cndmask_b32 v12, 0, v50, vcc
    v_cmp_eq_u32 vcc, 1, v78
    s_nop 1
    v_cndmask_b32 v12, v12, v51, vcc
    v_cmp_eq_u32 vcc, 2, v77
    s_nop 1
    v_cndmask_b32 v9, 0, v50, vcc
    v_cmp_eq_u32 vcc, 3, v77
    s_nop 1
    v_cndmask_b32 v9, v9, v51, vcc
    v_cmp_eq_u32 vcc, 2, v78
    s_nop 1
    v_cndmask_b32 v13, 0, v50, vcc
    v_cmp_eq_u32 vcc, 3, v78
    s_nop 1
    v_cndmask_b32 v13, v13, v51, vcc
    v_cmp_eq_u32 vcc, 8, v77
    s_nop 1
    v_cndmask_b32 v10, 0, v50, vcc
    v_cmp_eq_u32 vcc, 9, v77
    s_nop 1
    v_cndmask_b32 v10, v10, v51, vcc
    v_cmp_eq_u32 vcc, 4, v78
    s_nop 1
    v_cndmask_b32 v14, 0, v50, vcc
    v_cmp_eq_u32 vcc, 5, v78
    s_nop 1
    v_cndmask_b32 v14, v14, v51, vcc
    v_cmp_eq_u32 vcc, 10, v77
    s_nop 1
    v_cndmask_b32 v11, 0, v50, vcc
    v_cmp_eq_u32 vcc, 11, v77
    s_nop 1
    v_cndmask_b32 v11, v11, v51, vcc
    v_cmp_eq_u32 vcc, 6, v78
    s_nop 1
    v_cndmask_b32 v15, 0, v50, vcc
    v_cmp_eq_u32 vcc, 7, v78
    s_nop 1
    v_cndmask_b32 v15, v15, v51, vcc
    v_lshlrev_b32 v77, 4, v61
    ds_write_b128 v69, v[8:11] offset:15360
    ds_write_b128 v77, v[12:15] offset:15872
    s_waitcnt vmcnt(0) lgkmcnt(0)
    s_cmp_lg_u32 s95, 0
    s_cbranch_scc1 cf_hn
    s_mov_b32 s88, 4194304
gn2:
    buffer_load_dword v2, off, s[84:87], 0 offset:216 sc1
    s_waitcnt vmcnt(0)
    v_readfirstlane_b32 s95, v2
    s_sub_u32 s88, s88, 1
    s_cbranch_scc1 gn2x
    s_cmp_eq_u32 s95, 0
    s_cbranch_scc1 gn2
gn2x:
cf_hn:
    v_mov_b32 v2, 1
    s_cmp_lg_u32 s13, 0
    s_cbranch_scc1 cf_noarr
    s_mov_b64 exec, 1
    s_mov_b32 s42, 1
    v_mov_b32 v4, v76
    s_cmp_ge_u32 s94, 32
    s_cbranch_scc1 cf_have
    s_mov_b32 s40, 131072
    s_mov_b32 s42, 2
cf_startpoll:
    buffer_load_dword v3, off, s[84:87], 0 offset:132 sc1
    s_sub_u32 s40, s40, 1
    s_cbranch_scc1 cf_decide
    s_waitcnt vmcnt(0)
    v_readfirstlane_b32 s41, v3
    s_nop 1
    s_cmp_lt_u32 s41, 32
    s_cbranch_scc1 cf_startpoll
    s_mov_b32 s42, 1
cf_decide:
    v_mov_b32 v4, s42
    v_mov_b32 v5, 0
    buffer_atomic_cmpswap v[4:5], off, s[84:87], 0 offset:28 sc0
    s_waitcnt vmcnt(0)
cf_have:
    v_mov_b32 v5, s42
    v_cmp_eq_u32 vcc, 0, v4
    s_nop 1
    v_cndmask_b32 v4, v4, v5, vcc
    v_mov_b32 v5, 16192
    ds_write_b32 v5, v4
    s_waitcnt lgkmcnt(0)
    s_mov_b64 exec, -1
cf_noarr:
    s_barrier
    v_mov_b32 v5, 16192
    ds_read_b32 v4, v5
    s_waitcnt lgkmcnt(0)
    v_readfirstlane_b32 s41, v4
    s_nop 1
    s_cmp_eq_u32 s41, 1
    s_cbranch_scc1 cf_run
    v_lshrrev_b32 v0, 4, v65
    s_mov_b32 s32, s13
    s_load_dwordx16 s[48:63], s[0:1], 0
    s_waitcnt lgkmcnt(0)
    s_branch L_helper
cf_run:
    s_mov_b32 s44, 0x3e0293ee
    s_mov_b32 s45, s44
    s_or_b32 s66, s44, 0x80000000
    s_mov_b32 s48, 0x3f003f00
    s_mov_b32 s49, 0
    s_mov_b32 s50, 0x3f803f80
    s_mov_b32 s51, 0x3f803f80
    s_mov_b32 s52, 512
    s_mov_b32 s53, 1024
    s_mov_b32 s54, 1536
    s_mov_b32 s30, 0
    s_mov_b32 s37, 0
    s_lshl_b32 s47, s13, 9
    s_cmp_lg_u32 s32, 0
    s_cselect_b32 s71, s13, 3
    s_add_u32 s46, s71, 1
    s_lshr_b32 s46, s46, 1
    s_mov_b32 s14, 67125248
    s_mov_b32 s15, 67129344
    s_mov_b32 s16, 67133440
    s_mov_b32 s36, 0
    s_add_u32 s17, s68, 67108864
    s_mov_b32 s69, 0
    s_mov_b32 s70, 0
    s_lshl_b32 s26, s12, 14
    s_add_u32 s26, s26, 0
    s_mul_i32 s40, s13, 3072
    s_add_u32 s24, s26, s40
    s_lshl_b32 s96, s12, 7
    s_add_u32 s29, s96, 125845504
    s_add_u32 s96, s96, 125829120
    s_lshl_b32 s40, s12, 14
    s_add_u32 s40, s40, 68157440
    s_add_u32 s18, s40, 0
    s_add_u32 s19, s40, 4096
    s_add_u32 s20, s40, 8192
    s_add_u32 s21, s40, 12288
    s_lshr_b32 s40, s12, 3
    s_lshl_b32 s40, s40, 12
    s_and_b32 s41, s12, 7
    s_lshl_b32 s41, s41, 7
    s_add_u32 s40, s40, s41
    s_add_u32 s22, s40, 68157440
    s_add_u32 s23, s22, 1024
    s_add_u32 s25, s22, 2048
    s_mov_b32 s56, -65528
    s_cmp_lg_u32 s32, 0
    s_cselect_b64 s[38:39], -1, 0
    s_add_u32 s55, s68, 138412032
    s_cmp_eq_u32 s13, 3
    s_cselect_b64 s[100:101], 1, 0
    s_cselect_b64 s[38:39], 1, s[38:39]
    s_cselect_b32 s93, 64, 0
    s_cselect_b32 s55, s29, s55
    s_cselect_b32 s57, 0, 9216
    s_mov_b64 exec, s[100:101]
    v_mov_b32 v72, s95
    s_mov_b64 exec, -1
    s_mov_b32 s34, 0xff00ff00
    s_mov_b32 s35, 0xff00ff00
    s_lshl_b32 s28, s12, 12
    s_add_u32 s28, s28, 7602176
    s_add_u32 s27, s28, 77594624
    s_add_u32 s28, s28, 69206016
    s_cmp_ge_u32 s97, 3
    s_cbranch_scc1 cf_kvdone
    s_mov_b32 s40, 3
    v_bfe_u32 v78, v65, 2, 5
    s_mov_b32 s31, 4194304
cf_kv0:
    buffer_load_dword v77, v78, s[4:7], s96 offen offset:16 sc1
    s_waitcnt vmcnt(0)
    v_subrev_u32 v77, s95, v77
    v_cmp_lt_u32 vcc, 16, v77
    s_nop 1
    v_cndmask_b32 v77, v77, 0, vcc
    v_bfe_u32 v79, v78, 2, 2
    v_lshl_add_u32 v77, v77, 2, v79
    s_nop 1
    v_min_u32_dpp v77, v77, v77 row_ror:1 row_mask:0xf bank_mask:0xf
    s_nop 1
    v_min_u32_dpp v77, v77, v77 row_ror:2 row_mask:0xf bank_mask:0xf
    s_nop 1
    v_min_u32_dpp v77, v77, v77 row_ror:4 row_mask:0xf bank_mask:0xf
    s_nop 0
    v_readfirstlane_b32 s97, v77
    s_sub_u32 s31, s31, 1
    s_cbranch_scc1 cf_kv0_x
    s_cmp_le_u32 s40, s97
    s_cbranch_scc1 cf_kv0_x
    s_sleep 2
    s_branch cf_kv0
cf_kv0_x:
    s_add_u32 s40, s24, 0
    s_add_u32 s40, s40, s33
    s_sub_u32 s41, s96, s40
    v_bfe_u32 v77, v65, 2, 5
    v_add3_u32 v77, v77, s41, 16
    v_lshlrev_b32 v78, 3, v69
    s_nop 0
    v_mov_b32_dpp v78, v77 quad_perm:[0,1,2,3] row_mask:0xc bank_mask:0xf
    buffer_load_dword v76, v78, s[4:7], s40 offen sc1
    s_add_u32 s40, s24, 524288
    s_add_u32 s40, s40, s33
    s_sub_u32 s41, s96, s40
    v_bfe_u32 v77, v65, 2, 5
    v_add3_u32 v77, v77, s41, 16
    v_lshlrev_b32 v78, 3, v69
    s_nop 0
    v_mov_b32_dpp v78, v77 quad_perm:[0,1,2,3] row_mask:0xc bank_mask:0xf
    buffer_load_dword v76, v78, s[4:7], s40 offen sc1
cf_kvdone:
    v_mov_b64 v[0:1], 0
    v_mov_b64 v[2:3], 0
    v_mov_b64 v[4:5], 0
    v_mov_b64 v[6:7], 0
    v_mov_b64 v[8:9], 0
    v_mov_b64 v[10:11], 0
    v_mov_b64 v[12:13], 0
    v_mov_b64 v[14:15], 0
    v_mov_b64 v[16:17], 0
    v_mov_b64 v[18:19], 0
    v_mov_b64 v[20:21], 0
    v_mov_b64 v[22:23], 0
    ds_read_b128 v[44:47], v70 offset:0
    ds_read_b128 v[48:51], v70 offset:1024
    ds_read_b128 v[52:55], v70 offset:2048
    ds_read_b128 v[56:59], v70 offset:3072
    ds_read_b128 v[24:27], v70 offset:4096
    ds_read_b128 v[28:31], v70 offset:5120
    ds_read_b128 v[32:35], v70 offset:6144
    ds_read_b128 v[36:39], v70 offset:7168
    buffer_load_dwordx4 v[40:43], v65, s[4:7], s14 offen offset:0 nt
    buffer_load_dwordx4 v[60:63], v66, s[4:7], s14 offen offset:0 nt
    s_mov_b32 s31, 1048576
    s_waitcnt vmcnt(0) lgkmcnt(0)
    s_branch cf_goA
cf_loop:
    s_mov_b32 s31, 1048576
    s_mov_b32 s69, s70
    s_waitcnt lgkmcnt(0)
cf_cA:
    buffer_load_dwordx4 v[40:43], v65, s[4:7], s14 offen offset:0 nt
    buffer_load_dwordx4 v[60:63], v66, s[4:7], s14 offen offset:0 nt
cf_cA1:
    v_bitop3_b32 v77, v40, v60, s70 bitop3:0x7e
    v_and_b32 v77, 1, v77
    v_cmp_ne_u32 vcc, 0, v77
    s_cbranch_vccz cf_goA
    v_bitop3_b32 v77, v40, v60, s70 bitop3:0x7e
    v_and_b32 v77, 1, v77
    v_cmp_ne_u32 vcc, 0, v77
    s_cbranch_vccz cf_goA
    v_bitop3_b32 v77, v40, v60, s70 bitop3:0x7e
    v_and_b32 v77, 1, v77
    v_cmp_ne_u32 vcc, 0, v77
    s_cbranch_vccz cf_goA
    v_bitop3_b32 v77, v40, v60, s70 bitop3:0x7e
    v_and_b32 v77, 1, v77
    v_cmp_ne_u32 vcc, 0, v77
    s_cbranch_vccz cf_goA
    v_bitop3_b32 v77, v40, v60, s70 bitop3:0x7e
    v_and_b32 v77, 1, v77
    v_cmp_ne_u32 vcc, 0, v77
    s_cbranch_vccz cf_goA
    buffer_load_dwordx4 v[40:43], v65, s[4:7], s14 offen offset:0 nt
    buffer_load_dwordx4 v[60:63], v66, s[4:7], s14 offen offset:0 nt
    v_bitop3_b32 v77, v40, v60, s70 bitop3:0x7e
    v_and_b32 v77, 1, v77
    v_cmp_ne_u32 vcc, 0, v77
    s_cbranch_vccz cf_goA
    v_bitop3_b32 v77, v40, v60, s70 bitop3:0x7e
    v_and_b32 v77, 1, v77
    v_cmp_ne_u32 vcc, 0, v77
    s_cbranch_vccz cf_goA
    v_bitop3_b32 v77, v40, v60, s70 bitop3:0x7e
    v_and_b32 v77, 1, v77
    v_cmp_ne_u32 vcc, 0, v77
    s_cbranch_vccz cf_goA
    v_bitop3_b32 v77, v40, v60, s70 bitop3:0x7e
    v_and_b32 v77, 1, v77
    v_cmp_ne_u32 vcc, 0, v77
    s_cbranch_vccz cf_goA
    v_bitop3_b32 v77, v40, v60, s70 bitop3:0x7e
    v_and_b32 v77, 1, v77
    v_cmp_ne_u32 vcc, 0, v77
    s_cbranch_vccz cf_goA
    buffer_load_dwordx4 v[40:43], v65, s[4:7], s14 offen offset:0 nt
    buffer_load_dwordx4 v[60:63], v66, s[4:7], s14 offen offset:0 nt
    v_bitop3_b32 v77, v40, v60, s70 bitop3:0x7e
    v_and_b32 v77, 1, v77
    v_cmp_ne_u32 vcc, 0, v77
    s_cbranch_vccz cf_goA
    v_bitop3_b32 v77, v40, v60, s70 bitop3:0x7e
    v_and_b32 v77, 1, v77
    v_cmp_ne_u32 vcc, 0, v77
    s_cbranch_vccz cf_goA
    v_bitop3_b32 v77, v40, v60, s70 bitop3:0x7e
    v_and_b32 v77, 1, v77
    v_cmp_ne_u32 vcc, 0, v77
    s_cbranch_vccz cf_goA
    v_bitop3_b32 v77, v40, v60, s70 bitop3:0x7e
    v_and_b32 v77, 1, v77
    v_cmp_ne_u32 vcc, 0, v77
    s_cbranch_vccz cf_goA
    v_bitop3_b32 v77, v40, v60, s70 bitop3:0x7e
    v_and_b32 v77, 1, v77
    v_cmp_ne_u32 vcc, 0, v77
    s_cbranch_vccz cf_goA
    buffer_load_dwordx4 v[40:43], v65, s[4:7], s14 offen offset:0 nt
    buffer_load_dwordx4 v[60:63], v66, s[4:7], s14 offen offset:0 nt
    v_bitop3_b32 v77, v40, v60, s70 bitop3:0x7e
    v_and_b32 v77, 1, v77
    v_cmp_ne_u32 vcc, 0, v77
    s_cbranch_vccz cf_goA
    v_bitop3_b32 v77, v40, v60, s70 bitop3:0x7e
    v_and_b32 v77, 1, v77
    v_cmp_ne_u32 vcc, 0, v77
    s_cbranch_vccz cf_goA
    v_bitop3_b32 v77, v40, v60, s70 bitop3:0x7e
    v_and_b32 v77, 1, v77
    v_cmp_ne_u32 vcc, 0, v77
    s_cbranch_vccz cf_goA
    v_bitop3_b32 v77, v40, v60, s70 bitop3:0x7e
    v_and_b32 v77, 1, v77
    v_cmp_ne_u32 vcc, 0, v77
    s_cbranch_vccz cf_goA
    v_bitop3_b32 v77, v40, v60, s70 bitop3:0x7e
    v_and_b32 v77, 1, v77
    v_cmp_ne_u32 vcc, 0, v77
    s_cbranch_vccz cf_goA
    s_sub_u32 s31, s31, 64
    s_cbranch_scc0 cf_cA
cf_goA:
    ds_write_b128 v65, v[40:43] offset:0
    v_smfmac_f32_16x16x64_bf16 v[0:3], v[40:43], v[44:51], v64
    v_smfmac_f32_16x16x64_bf16 v[4:7], v[40:43], v[52:59], v64
    buffer_load_dwordx4 v[44:47], v65, s[4:7], s15 offen offset:0 nt
    v_smfmac_f32_16x16x64_bf16 v[0:3], v[60:63], v[24:31], v64
    s_add_u32 s40, s24, 1048576
    s_add_u32 s40, s40, s33
    s_sub_u32 s41, s96, s40
    v_smfmac_f32_16x16x64_bf16 v[4:7], v[60:63], v[32:39], v64
    ds_read_b128 v[24:27], v70 offset:8192
    s_cmp_lt_u32 s97, s93
    s_cselect_b32 s41, s41, 0
    v_smfmac_f32_16x16x64_bf16 v[8:11], v[40:43], a[96:103], v64
    ds_read_b128 v[28:31], v70 offset:9216
    v_smfmac_f32_16x16x64_bf16 v[12:15], v[40:43], a[104:111], v64
    ds_read_b128 v[32:35], v70 offset:10240
    s_waitcnt lgkmcnt(3)
    s_barrier
    ds_read_b128 v[48:51], v67 offset:0
    v_smfmac_f32_16x16x64_bf16 v[8:11], v[60:63], a[112:119], v64
    ds_read_b128 v[36:39], v70 offset:11264
    v_bitop3_b32 v79, v73, -9, s54 bitop3:0x6a
    v_smfmac_f32_16x16x64_bf16 v[12:15], v[60:63], a[120:127], v64
    ds_read_b128 v[52:55], v68 offset:0
    v_bfe_u32 v77, v65, 2, 5
    v_smfmac_f32_16x16x64_bf16 v[16:19], v[40:43], a[232:239], v64
    buffer_load_dwordx4 v[44:47], v65, s[4:7], s15 offen offset:0 nt
    s_waitcnt lgkmcnt(4)
    v_smfmac_f32_16x16x64_bf16 v[20:23], v[40:43], v[24:31], v64
    ds_read_b128 v[24:27], v70 offset:12288
    s_waitcnt lgkmcnt(3)
    v_smfmac_f32_16x16x64_bf16 v[0:3], v[48:51], a[0:7], v64
    ds_read_b128 v[28:31], v70 offset:13312
    s_waitcnt lgkmcnt(3)
    v_smfmac_f32_16x16x64_bf16 v[4:7], v[48:51], v[32:39], v64
    ds_read_b128 v[32:35], v70 offset:14336
    v_add3_u32 v77, v77, s41, 16
    v_smfmac_f32_16x16x64_bf16 v[16:19], v[60:63], a[240:247], v64
    ds_read_b128 v[36:39], v70 offset:15360
    v_lshlrev_b32 v78, 3, v69
    v_smfmac_f32_16x16x64_bf16 v[20:23], v[60:63], a[248:255], v64
    buffer_load_dwordx4 v[40:43], v65, s[4:7], s16 offen offset:0 nt
    v_smfmac_f32_16x16x64_bf16 v[8:11], v[48:51], a[128:135], v64
    v_mov_b32_dpp v78, v77 quad_perm:[0,1,2,3] row_mask:0xc bank_mask:0xf
    v_smfmac_f32_16x16x64_bf16 v[12:15], v[48:51], a[136:143], v64
    s_waitcnt lgkmcnt(2)
    s_waitcnt vmcnt(2)
    v_and_b32 v77, s36, v44
    v_smfmac_f32_16x16x64_bf16 v[12:15], v[52:55], v[24:31], v64
    ds_write_b128 v65, v[44:47] offset:4096
    v_smfmac_f32_16x16x64_bf16 v[0:3], v[52:55], a[8:15], v64
    buffer_load_dwordx4 v[58:61], v65, s[4:7], s24 offen offset:3072 sc1
    s_waitcnt lgkmcnt(1)
    v_cmp_ne_u32 vcc, s70, v77
    v_smfmac_f32_16x16x64_bf16 v[4:7], v[52:55], v[32:39], v64
    v_smfmac_f32_16x16x64_bf16 v[8:11], v[52:55], a[144:151], v64
    s_cbranch_vccnz cf_spinB
cf_backB:
    v_smfmac_f32_16x16x64_bf16 v[16:19], v[44:47], v[176:183], v64
    buffer_load_dwordx4 v[24:27], v65, s[4:7], s24 offen offset:0 sc1
    s_waitcnt lgkmcnt(0)
    s_barrier
    ds_read_b128 v[48:51], v66 offset:4096
    v_smfmac_f32_16x16x64_bf16 v[12:15], v[44:47], a[160:167], v64
    ds_read_b128 v[52:55], v67 offset:4096
    v_smfmac_f32_16x16x64_bf16 v[0:3], v[44:47], a[16:23], v64
    buffer_load_dwordx4 v[28:31], v65, s[4:7], s24 offen offset:1024 sc1
    v_smfmac_f32_16x16x64_bf16 v[8:11], v[44:47], a[152:159], v64
    v_smfmac_f32_16x16x64_bf16 v[4:7], v[44:47], a[24:31], v64
    s_waitcnt vmcnt(4)
    v_smfmac_f32_16x16x64_bf16 v[20:23], v[44:47], v[184:191], v64
    ds_read_b128 v[44:47], v68 offset:4096
    s_waitcnt lgkmcnt(2)
    v_smfmac_f32_16x16x64_bf16 v[0:3], v[48:51], a[32:39], v64
    buffer_load_dwordx4 v[34:37], v65, s[4:7], s24 offen offset:2048 sc1
    v_smfmac_f32_16x16x64_bf16 v[8:11], v[48:51], a[168:175], v64
    v_smfmac_f32_16x16x64_bf16 v[4:7], v[48:51], a[40:47], v64
    v_smfmac_f32_16x16x64_bf16 v[12:15], v[48:51], a[176:183], v64
    ds_read_b128 v[48:51], v69 offset:15360
    s_waitcnt lgkmcnt(1)
    v_smfmac_f32_16x16x64_bf16 v[0:3], v[52:55], a[48:55], v64
    buffer_load_dword v76, v78, s[4:7], s40 offen sc1
    s_waitcnt vmcnt(5)
    v_and_b32 v77, s36, v40
    v_smfmac_f32_16x16x64_bf16 v[8:11], v[52:55], a[184:191], v64
    v_cmp_ne_u32 vcc, s70, v77
    v_smfmac_f32_16x16x64_bf16 v[0:3], v[44:47], a[64:71], v64
    v_smfmac_f32_16x16x64_bf16 v[8:11], v[44:47], a[200:207], v64
    s_cbranch_vccnz cf_spin8
cf_back8:
    v_smfmac_f32_16x16x64_bf16 v[0:3], v[40:43], a[80:87], v64
    s_nop 1
    v_smfmac_f32_16x16x64_bf16 v[8:11], v[40:43], a[216:223], v64
    s_nop 1
    v_lshrrev_b32 v77, 1, v69
    v_smfmac_f32_16x16x64_bf16 v[4:7], v[52:55], a[56:63], v64
    s_nop 1
    v_cvt_pk_bf16_f32 v0, v0, v1
    v_smfmac_f32_16x16x64_bf16 v[12:15], v[52:55], a[192:199], v64
    s_nop 1
    v_cvt_pk_bf16_f32 v1, v2, v3
    v_smfmac_f32_16x16x64_bf16 v[4:7], v[44:47], a[72:79], v64
    s_nop 1
    v_cvt_pk_bf16_f32 v2, v8, v9
    v_smfmac_f32_16x16x64_bf16 v[12:15], v[44:47], a[208:215], v64
    s_nop 1
    v_cvt_pk_bf16_f32 v3, v10, v11
    v_smfmac_f32_16x16x64_bf16 v[4:7], v[40:43], a[88:95], v64
    s_waitcnt lgkmcnt(0)
    s_nop 1
    v_smfmac_f32_16x16x64_bf16 v[12:15], v[40:43], a[224:231], v64
    s_nop 1
    v_mfma_f32_16x16x32_bf16 v[8:11], v[0:3], v[48:51], 0
    s_nop 0
    v_cvt_pk_bf16_f32 v4, v4, v5
    v_cvt_pk_bf16_f32 v5, v6, v7
    s_nop 1
    v_cvt_pk_bf16_f32 v6, v12, v13
    v_cvt_pk_bf16_f32 v7, v14, v15
    s_nop 1
    v_mfma_f32_16x16x32_bf16 v[12:15], v[4:7], v[48:51], 0
    ds_read_b128 v[48:51], v66 offset:4096
    v_cvt_pk_bf16_f32 v0, v8, v9
    v_cvt_pk_bf16_f32 v1, v10, v11
    v_smfmac_f32_16x16x64_bf16 v[16:19], v[52:55], v[208:215], v64
    s_waitcnt vmcnt(2)
    s_nop 2
    v_cvt_pk_bf16_f32 v2, v12, v13
    v_cvt_pk_bf16_f32 v3, v14, v15
    s_nop 1
    v_mfma_f32_16x16x32_bf16 v[12:15], v[0:3], v[0:3], 0
    s_nop 1
    v_bitop3_b32 v78, v73, -9, s53 bitop3:0x6a
    v_mfma_f32_16x16x32_bf16 v[4:7], v[24:27], v[0:3], 0
    ds_read_b128 v[24:27], v67 offset:0
    s_nop 1
    v_mfma_f32_16x16x32_bf16 v[8:11], v[28:31], v[0:3], 0
    s_nop 0
    v_mov_b32_dpp v12, v14 row_ror:8 row_mask:0xf bank_mask:0xc
    v_mov_b32_dpp v13, v15 row_ror:8 row_mask:0xf bank_mask:0xc
    v_smfmac_f32_16x16x64_bf16 v[20:23], v[52:55], v[216:223], v64
    ds_write_b64 v71, v[12:13]
    ds_read_b128 v[52:55], v68 offset:0
    s_nop 1
    v_mov_b32_dpp v4, v8 row_ror:8 row_mask:0xf bank_mask:0xc
    v_mov_b32_dpp v5, v9 row_ror:8 row_mask:0xf bank_mask:0xc
    v_mov_b32_dpp v6, v10 row_ror:8 row_mask:0xf bank_mask:0xc
    v_mov_b32_dpp v7, v11 row_ror:8 row_mask:0xf bank_mask:0xc
    v_smfmac_f32_16x16x64_bf16 v[16:19], v[44:47], v[224:231], v64
    ds_write_b128 v65, v[4:7] offset:8192
    v_smfmac_f32_16x16x64_bf16 v[20:23], v[44:47], v[232:239], v64
    s_waitcnt lgkmcnt(3)
    v_smfmac_f32_16x16x64_bf16 v[16:19], v[24:27], v[144:151], v64
    s_waitcnt vmcnt(1)
    v_smfmac_f32_16x16x64_bf16 v[20:23], v[24:27], v[152:159], v64
    s_mov_b64 exec, s[38:39]
    buffer_store_dword v72, v75, s[4:7], s55 offen sc1
    s_mov_b64 exec, -1
    v_smfmac_f32_16x16x64_bf16 v[16:19], v[40:43], v[240:247], v64
    s_cmp_ge_u32 s30, 58
    s_waitcnt lgkmcnt(0)
    s_barrier
    ds_read_b128 v[8:11], v66 offset:8192
    v_smfmac_f32_16x16x64_bf16 v[20:23], v[40:43], v[248:255], v64
    ds_read_b128 v[12:15], v67 offset:8192
    v_smfmac_f32_16x16x64_bf16 v[16:19], v[48:51], v[192:199], v64
    ds_read_b128 v[44:47], v68 offset:8192
    v_smfmac_f32_16x16x64_bf16 v[20:23], v[48:51], v[200:207], v64
    ds_read_b64 v[24:25], v77 offset:14336
    ds_read_b64 v[26:27], v77 offset:14592
    v_smfmac_f32_16x16x64_bf16 v[16:19], v[52:55], v[160:167], v64
    ds_read_b64 v[28:29], v77 offset:14848
    ds_read_b64 v[30:31], v77 offset:15104
    v_bitop3_b32 v77, v73, -9, s52 bitop3:0x6a
    v_smfmac_f32_16x16x64_bf16 v[20:23], v[52:55], v[168:175], v64
    s_cbranch_scc1 cf_rare
cf_rare_x:
    ds_read_b128 v[48:51], v70 offset:22528
    ds_read_b128 v[52:55], v70 offset:23552
    s_waitcnt lgkmcnt(6)
    v_pk_add_f32 v[4:5], v[4:5], v[8:9]
    v_pk_add_f32 v[6:7], v[6:7], v[10:11]
    v_pk_add_f32 v[12:13], v[12:13], v[44:45]
    v_pk_add_f32 v[14:15], v[14:15], v[46:47]
    v_pk_add_f32 v[4:5], v[4:5], v[12:13]
    v_pk_add_f32 v[6:7], v[6:7], v[14:15]
    s_waitcnt lgkmcnt(2)
    v_pk_add_f32 v[24:25], v[24:25], v[26:27]
    v_pk_add_f32 v[28:29], v[28:29], v[30:31]
    v_max3_f32 v8, v4, v5, v6
    v_pk_add_f32 v[24:25], v[24:25], v[28:29]
    v_max_f32 v8, v8, v7
    v_max3_f32 v8, v8, v24, v25
    v_cvt_pk_bf16_f32 v32, v16, v17
    v_cvt_pk_bf16_f32 v38, v18, v19
    v_max_f32_dpp v8, v8, v8 row_ror:8 row_mask:0xf bank_mask:0xf
    v_mov_b32 v9, v8
    v_cvt_pk_bf16_f32 v56, v20, v21
    v_cvt_pk_bf16_f32 v62, v22, v23
    v_permlane32_swap_b32 v8, v9
    v_max_f32 v8, v8, v9
    v_mov_b32 v9, v8
    v_mov_b32 v11, 0
    v_mov_b32 v15, 0
    v_permlane16_swap_b32 v8, v9
    v_max_f32 v8, v8, v9
    v_mul_f32 v8, s66, v8
    v_pk_fma_f32 v[4:5], v[4:5], s[44:45], v[8:9] op_sel_hi:[1,1,0]
    v_pk_fma_f32 v[6:7], v[6:7], s[44:45], v[8:9] op_sel_hi:[1,1,0]
    v_pk_fma_f32 v[24:25], v[24:25], s[44:45], v[8:9] op_sel_hi:[1,1,0]
    v_exp_f32 v4, v4
    v_exp_f32 v5, v5
    v_exp_f32 v6, v6
    v_exp_f32 v7, v7
    v_exp_f32 v24, v24
    v_exp_f32 v25, v25
    v_cvt_pk_bf16_f32 v12, v4, v5
    v_cvt_pk_bf16_f32 v13, v6, v7
    v_cvt_pk_bf16_f32 v10, v24, v25
    v_cvt_pk_bf16_f32 v14, v24, v25
    v_mov_b64 v[0:1], s[48:49]
    v_mfma_f32_16x16x32_bf16 v[4:7], v[32:35], v[10:13], 0
    ds_read_b128 v[40:43], v70 offset:20480
    v_mov_b64 v[2:3], s[50:51]
    v_mfma_f32_16x16x32_bf16 v[24:27], v[36:39], v[12:15], 0
    ds_read_b128 v[44:47], v70 offset:21504
    v_mov_b64 v[8:9], 0
    v_mfma_f32_16x16x32_bf16 v[28:31], v[0:3], v[10:13], 0
    ds_read_b128 v[32:35], v70 offset:24576
    v_mov_b64 v[0:1], 0
    v_mfma_f32_16x16x32_bf16 v[16:19], v[56:59], v[10:13], 0
    ds_read_b128 v[36:39], v70 offset:25600
    v_mov_b64 v[2:3], 0
    v_mfma_f32_16x16x32_bf16 v[20:23], v[60:63], v[12:15], 0
    ds_read_b128 v[56:59], v70 offset:26624
    v_add_f32_dpp v4, v24, v4 row_ror:8 row_mask:0xf bank_mask:0xf
    v_add_f32_dpp v5, v25, v5 row_ror:8 row_mask:0xf bank_mask:0xf
    v_add_f32_dpp v6, v26, v6 row_ror:8 row_mask:0xf bank_mask:0xf
    v_add_f32_dpp v7, v27, v7 row_ror:8 row_mask:0xf bank_mask:0xf
    v_add_f32_dpp v29, v28, v28 row_ror:8 row_mask:0xf bank_mask:0xf
    v_rcp_f32 v28, v29
    v_mov_b64 v[10:11], 0
    v_add_f32_dpp v4, v16, v20 row_ror:8 row_mask:0xf bank_mask:0xc
    v_add_f32_dpp v5, v17, v21 row_ror:8 row_mask:0xf bank_mask:0xc
    v_add_f32_dpp v6, v18, v22 row_ror:8 row_mask:0xf bank_mask:0xc
    v_add_f32_dpp v7, v19, v23 row_ror:8 row_mask:0xf bank_mask:0xc
    v_pk_mul_f32 v[4:5], v[4:5], v[28:29] op_sel_hi:[1,0]
    v_pk_mul_f32 v[6:7], v[6:7], v[28:29] op_sel_hi:[1,0]
    v_cvt_pk_bf16_f32 v4, v4, v5
    v_cvt_pk_bf16_f32 v5, v6, v7
    ds_write_b64 v73, v[4:5] offset:12288
    v_mov_b32_dpp v6, v4 row_ror:8 row_mask:0xf bank_mask:0xf
    v_mov_b32_dpp v7, v5 row_ror:8 row_mask:0xf bank_mask:0xf
    v_mov_b64 v[12:13], 0
    v_mov_b64 v[14:15], 0
    v_smfmac_f32_16x16x64_bf16 v[8:11], v[4:7], v[80:87], v64
    s_waitcnt lgkmcnt(4)
    v_mov_b64 v[24:25], 0
    v_smfmac_f32_16x16x64_bf16 v[0:3], v[4:7], v[40:47], v64
    ds_read_b128 v[60:63], v70 offset:27648
    v_mov_b64 v[26:27], 0
    v_smfmac_f32_16x16x64_bf16 v[12:15], v[4:7], v[112:119], v64
    s_waitcnt lgkmcnt(1)
    s_barrier
    ds_read_b128 v[16:19], v77 offset:12288
    v_smfmac_f32_16x16x64_bf16 v[24:27], v[4:7], v[48:55], v64
    ds_read_b128 v[20:23], v78 offset:12288
    ds_read_b128 v[28:31], v79 offset:12288
    v_mov_b64 v[4:5], 0
    v_mov_b64 v[6:7], 0
    v_bfe_u32 v77, v74, 16, 1
    v_mad_i32_i24 v77, v77, s56, v74
    s_waitcnt lgkmcnt(2)
    v_smfmac_f32_16x16x64_bf16 v[8:11], v[16:19], v[88:95], v64
    ds_read_b128 v[48:51], v70 offset:28672
    v_and_b32 v72, 8, v73
    v_smfmac_f32_16x16x64_bf16 v[12:15], v[16:19], v[120:127], v64
    ds_read_b128 v[52:55], v70 offset:29696
    s_waitcnt lgkmcnt(3)
    v_mad_u32_u24 v72, v72, 63, v73
    v_smfmac_f32_16x16x64_bf16 v[8:11], v[20:23], v[96:103], v64
    ds_read_b128 v[40:43], v70 offset:30720
    v_subrev_u32 v72, s47, v72
    v_smfmac_f32_16x16x64_bf16 v[12:15], v[20:23], v[128:135], v64
    ds_read_b128 v[44:47], v70 offset:31744
    s_waitcnt lgkmcnt(4)
    v_smfmac_f32_16x16x64_bf16 v[8:11], v[28:31], v[104:111], v64
    s_add_u32 s30, s30, 1
    s_xor_b32 s70, s70, 1
    s_cmp_lg_u32 s71, 0
    v_smfmac_f32_16x16x64_bf16 v[12:15], v[28:31], v[136:143], v64
    s_nop 2
    v_smfmac_f32_16x16x64_bf16 v[0:3], v[16:19], v[32:39], v64
    ds_read_b128 v[32:35], v70 offset:32768
    ds_read_b128 v[36:39], v70 offset:33792
    v_cvt_pk_bf16_f32 v8, v8, v9
    v_cvt_pk_bf16_f32 v9, v10, v11
    v_and_or_b32 v8, v8, -2, s69
    v_cvt_pk_bf16_f32 v10, v12, v13
    v_cvt_pk_bf16_f32 v11, v14, v15
    v_smfmac_f32_16x16x64_bf16 v[24:27], v[16:19], v[56:63], v64
    buffer_store_dwordx4 v[8:11], v74, s[4:7], s22 offen
    ds_read_b128 v[56:59], v70 offset:34816
    s_waitcnt lgkmcnt(3)
    v_smfmac_f32_16x16x64_bf16 v[24:27], v[20:23], v[40:47], v64
    ds_read_b128 v[60:63], v70 offset:35840
    ds_read_b128 v[40:43], v70 offset:16384
    v_smfmac_f32_16x16x64_bf16 v[0:3], v[20:23], v[48:55], v64
    ds_read_b128 v[44:47], v70 offset:17408
    s_waitcnt lgkmcnt(4)
    v_smfmac_f32_16x16x64_bf16 v[0:3], v[28:31], v[32:39], v64
    ds_read_b128 v[48:51], v72 offset:12288
    s_waitcnt lgkmcnt(3)
    s_nop 0
    v_smfmac_f32_16x16x64_bf16 v[24:27], v[28:31], v[56:63], v64
    ds_read_b128 v[32:35], v70 offset:18432
    ds_read_b128 v[36:39], v70 offset:19456
    ds_read_b128 v[52:55], v72 offset:13312
    s_nop 0
    v_cvt_pk_bf16_f32 v0, v0, v1
    v_cvt_pk_bf16_f32 v1, v2, v3
    v_and_or_b32 v0, v0, -2, s69
    s_nop 0
    v_cvt_pk_bf16_f32 v2, v24, v25
    v_cvt_pk_bf16_f32 v3, v26, v27
    s_waitcnt lgkmcnt(3)
    v_smfmac_f32_16x16x64_bf16 v[4:7], v[48:51], v[40:47], v64
    buffer_store_dwordx4 v[0:3], v74, s[4:7], s23 offen
    s_waitcnt lgkmcnt(0)
    v_smfmac_f32_16x16x64_bf16 v[4:7], v[52:55], v[32:39], v64
    s_nop 7
    v_cvt_pk_bf16_f32 v4, v4, v5
    v_cvt_pk_bf16_f32 v5, v6, v7
    v_and_or_b32 v4, v4, -2, s69
    buffer_store_dwordx2 v[4:5], v77, s[4:7], s25 offen
    s_cbranch_scc1 cf_e1
    s_cmp_lg_u32 s37, 0
    s_cbranch_scc1 cf_f0_xt
cf_f0_xtx:
    s_nop 2
    v_mov_b32 v79, v79
    s_nop 2
    v_mov_b32 v79, v79
    s_nop 2
    v_mov_b32 v79, v79
    s_nop 2
    v_mov_b32 v79, v79
    s_nop 2
    v_mov_b32 v79, v79
    s_nop 2
    v_mov_b32 v79, v79
    s_nop 2
    v_mov_b32 v79, v79
    s_nop 2
    v_mov_b32 v79, v79
    s_nop 2
    v_mov_b32 v79, v79
    s_nop 2
    v_mov_b32 v79, v79
    s_nop 2
    v_mov_b32 v79, v79
    s_nop 2
    v_mov_b32 v79, v79
    s_nop 2
    v_mov_b32 v79, v79
    buffer_load_dwordx4 v[8:11], v65, s[4:7], s18 offen nt
    buffer_load_dwordx4 v[12:15], v65, s[4:7], s19 offen nt
    buffer_load_dwordx4 v[16:19], v65, s[4:7], s20 offen nt
    buffer_load_dwordx4 v[20:23], v65, s[4:7], s21 offen nt
    v_and_b32 v77, 255, v69
    ds_read_b128 v[4:7], v77 offset:15872
    ds_read_b128 v[44:47], v70 offset:0
    ds_read_b128 v[48:51], v70 offset:1024
    ds_read_b128 v[52:55], v70 offset:2048
    ds_read_b128 v[56:59], v70 offset:3072
    ds_read_b128 v[24:27], v70 offset:4096
    ds_read_b128 v[28:31], v70 offset:5120
    ds_read_b128 v[32:35], v70 offset:6144
    ds_read_b128 v[36:39], v70 offset:7168
    s_mov_b32 s31, 65536
    s_add_u32 s24, s24, 524288
    s_add_u32 s26, s26, 524288
    s_add_u32 s55, s55, s57
    s_mov_b32 s14, 67108864
    s_mov_b32 s15, 67112960
    s_mov_b32 s16, 67117056
    s_mov_b32 s36, 1
    v_mov_b32 v40, s69
    v_mov_b32 v60, s69
    v_and_b32 v79, 12, v75
    v_cmp_eq_u32 vcc, 0, v79
    s_nop 1
    v_cndmask_b32 v79, 0, 1, vcc
    s_waitcnt lgkmcnt(0)
    s_waitcnt vmcnt(3)
    v_xor_b32 v77, s69, v8
    v_mfma_f32_16x16x32_bf16 v[0:3], v[4:7], v[8:11], 0
    v_mov_b64 v[8:9], 0
    v_mov_b64 v[10:11], 0
    s_waitcnt vmcnt(2)
    v_bitop3_b32 v77, v77, v12, s69 bitop3:0xf6
    v_mfma_f32_16x16x32_bf16 v[0:3], v[4:7], v[12:15], v[0:3]
    v_mov_b64 v[12:13], 0
    v_mov_b64 v[14:15], 0
    s_waitcnt vmcnt(1)
    v_bitop3_b32 v77, v77, v16, s69 bitop3:0xf6
    v_mfma_f32_16x16x32_bf16 v[0:3], v[4:7], v[16:19], v[0:3]
    v_mov_b64 v[16:17], 0
    v_mov_b64 v[18:19], 0
    s_waitcnt vmcnt(0)
    v_bitop3_b32 v77, v77, v20, s69 bitop3:0xf6
    v_mfma_f32_16x16x32_bf16 v[0:3], v[4:7], v[20:23], v[0:3]
    v_and_b32 v77, 1, v77
    v_cmp_ne_u32 vcc, 0, v77
    v_mov_b64 v[20:21], 0
    v_mov_b64 v[22:23], 0
    s_cmp_eq_u64 vcc, 0
    s_cselect_b64 s[42:43], -1, 0
    s_nop 1
    v_add_f32_dpp v0, v0, v0 row_ror:8 row_mask:0xf bank_mask:0xf
    v_add_f32_dpp v1, v1, v1 row_ror:8 row_mask:0xf bank_mask:0xf
    s_mov_b64 exec, s[42:43]
    v_cvt_pk_bf16_f32 v72, v0, v1
    v_bfi_b32 v72, v79, s70, v72
    buffer_store_dword v72, v75, s[4:7], s17 offen offset:0
    s_mov_b64 exec, -1
    s_cbranch_scc0 cf_f0_retry
cf_f0_go:
    v_mov_b64 v[0:1], 0
    v_mov_b64 v[2:3], 0
    v_mov_b64 v[4:5], 0
    v_mov_b64 v[6:7], 0
    s_nop 2
    v_mov_b32 v79, v79
    s_nop 2
    v_mov_b32 v79, v79
    s_nop 2
    v_mov_b32 v79, v79
    s_nop 2
    v_mov_b32 v79, v79
    s_branch cf_loop
cf_e1:
    s_cmp_lg_u32 s71, 2
    s_cbranch_scc1 cf_f1
    v_and_b32 v77, 255, v69
    ds_read_b128 v[4:7], v77 offset:15872
    ds_read_b128 v[44:47], v70 offset:0
    ds_read_b128 v[48:51], v70 offset:1024
    ds_read_b128 v[52:55], v70 offset:2048
    ds_read_b128 v[56:59], v70 offset:3072
    ds_read_b128 v[24:27], v70 offset:4096
    ds_read_b128 v[28:31], v70 offset:5120
    ds_read_b128 v[32:35], v70 offset:6144
    ds_read_b128 v[36:39], v70 offset:7168
    s_mov_b32 s31, 65536
    s_add_u32 s24, s24, 524288
    s_add_u32 s26, s26, 524288
    s_add_u32 s55, s55, s57
    s_mov_b32 s14, 67108864
    s_mov_b32 s15, 67112960
    s_mov_b32 s16, 67117056
    s_mov_b32 s36, 1
    v_mov_b32 v40, s69
    v_mov_b32 v60, s69
    v_and_b32 v79, 12, v75
    v_cmp_eq_u32 vcc, 0, v79
    s_nop 1
    v_cndmask_b32 v79, 0, 1, vcc
    s_cmp_lg_u32 s37, 0
    s_cbranch_scc1 cf_f2_xt
cf_f2_xtx:
    s_nop 2
    v_mov_b32 v79, v79
    s_nop 2
    v_mov_b32 v79, v79
    s_nop 2
    v_mov_b32 v79, v79
    s_nop 2
    v_mov_b32 v79, v79
    s_nop 2
    v_mov_b32 v79, v79
    s_nop 2
    v_mov_b32 v79, v79
    s_nop 2
    v_mov_b32 v79, v79
    s_nop 2
    v_mov_b32 v79, v79
    s_nop 2
    v_mov_b32 v79, v79
    s_nop 2
    v_mov_b32 v79, v79
    s_nop 2
    v_mov_b32 v79, v79
    s_nop 2
    v_mov_b32 v79, v79
    s_nop 2
    v_mov_b32 v79, v79
    s_nop 2
    v_mov_b32 v79, v79
    s_nop 2
    v_mov_b32 v79, v79
    s_waitcnt vmcnt(0)
    buffer_load_dwordx4 v[8:11], v65, s[4:7], s18 offen nt
    buffer_load_dwordx4 v[12:15], v65, s[4:7], s19 offen nt
    buffer_load_dwordx4 v[16:19], v65, s[4:7], s20 offen nt
    buffer_load_dwordx4 v[20:23], v65, s[4:7], s21 offen nt
    s_nop 2
    v_mov_b32 v79, v79
    s_nop 2
    v_mov_b32 v79, v79
    s_nop 2
    v_mov_b32 v79, v79
    s_nop 2
    v_mov_b32 v79, v79
    s_nop 2
    v_mov_b32 v79, v79
    s_nop 2
    v_mov_b32 v79, v79
    s_nop 2
    v_mov_b32 v79, v79
    s_nop 2
    v_mov_b32 v79, v79
    s_nop 2
    v_mov_b32 v79, v79
    s_nop 2
    v_mov_b32 v79, v79
    buffer_load_dwordx4 v[40:43], v65, s[4:7], s14 offen offset:0 nt
    buffer_load_dwordx4 v[60:63], v66, s[4:7], s14 offen offset:0 nt
    s_waitcnt lgkmcnt(0)
    s_waitcnt vmcnt(5)
    v_xor_b32 v77, s69, v8
    v_bitop3_b32 v77, v77, v10, s69 bitop3:0xf6
    v_mfma_f32_16x16x32_bf16 v[0:3], v[4:7], v[8:11], 0
    v_mov_b64 v[8:9], 0
    v_mov_b64 v[10:11], 0
    s_waitcnt vmcnt(4)
    v_bitop3_b32 v77, v77, v12, s69 bitop3:0xf6
    v_bitop3_b32 v77, v77, v14, s69 bitop3:0xf6
    v_mfma_f32_16x16x32_bf16 v[0:3], v[4:7], v[12:15], v[0:3]
    v_mov_b64 v[12:13], 0
    v_mov_b64 v[14:15], 0
    s_waitcnt vmcnt(3)
    v_bitop3_b32 v77, v77, v16, s69 bitop3:0xf6
    v_bitop3_b32 v77, v77, v18, s69 bitop3:0xf6
    v_mfma_f32_16x16x32_bf16 v[0:3], v[4:7], v[16:19], v[0:3]
    v_mov_b64 v[16:17], 0
    v_mov_b64 v[18:19], 0
    s_waitcnt vmcnt(2)
    v_bitop3_b32 v77, v77, v20, s69 bitop3:0xf6
    v_bitop3_b32 v77, v77, v22, s69 bitop3:0xf6
    v_mfma_f32_16x16x32_bf16 v[0:3], v[4:7], v[20:23], v[0:3]
    v_and_b32 v77, 1, v77
    v_cmp_ne_u32 vcc, 0, v77
    v_mov_b64 v[20:21], 0
    v_mov_b64 v[22:23], 0
    buffer_load_dwordx4 v[40:43], v65, s[4:7], s14 offen offset:0 nt
    buffer_load_dwordx4 v[60:63], v66, s[4:7], s14 offen offset:0 nt
    s_cmp_eq_u64 vcc, 0
    s_cselect_b64 s[42:43], -1, 0
    v_add_f32 v2, v0, v1
    s_nop 1
    v_add_f32_dpp v2, v2, v2 row_ror:8 row_mask:0xf bank_mask:0xf
    s_nop 1
    v_mov_b32_dpp v0, v2 quad_perm:[0,0,2,2] row_mask:0xf bank_mask:0xf
    v_mov_b32_dpp v1, v2 quad_perm:[1,1,3,3] row_mask:0xf bank_mask:0xf
    s_mov_b64 exec, s[42:43]
    v_cvt_pk_bf16_f32 v72, v0, v1
    v_bfi_b32 v72, v79, s70, v72
    buffer_store_dword v72, v75, s[4:7], s17 offen offset:0
    buffer_store_dword v72, v75, s[4:7], s17 offen offset:1024
    buffer_store_dword v72, v75, s[4:7], s17 offen offset:2048
    buffer_store_dword v72, v75, s[4:7], s17 offen offset:3072
    s_mov_b64 exec, -1
    s_cbranch_scc0 cf_f2_retry
cf_f2_go:
    v_mov_b64 v[0:1], 0
    v_mov_b64 v[2:3], 0
    v_mov_b64 v[4:5], 0
    v_mov_b64 v[6:7], 0
    s_branch cf_loop
cf_f1:
    s_cmp_lg_u32 s32, 1
    s_cbranch_scc1 cf_f3
    v_and_b32 v77, 255, v69
    ds_read_b128 v[4:7], v77 offset:15872
    ds_read_b128 v[44:47], v70 offset:0
    ds_read_b128 v[48:51], v70 offset:1024
    ds_read_b128 v[52:55], v70 offset:2048
    ds_read_b128 v[56:59], v70 offset:3072
    ds_read_b128 v[24:27], v70 offset:4096
    ds_read_b128 v[28:31], v70 offset:5120
    ds_read_b128 v[32:35], v70 offset:6144
    ds_read_b128 v[36:39], v70 offset:7168
    s_mov_b32 s31, 65536
    s_add_u32 s24, s24, 524288
    s_add_u32 s26, s26, 524288
    s_add_u32 s55, s55, s57
    s_mov_b32 s14, 67108864
    s_mov_b32 s15, 67112960
    s_mov_b32 s16, 67117056
    s_mov_b32 s36, 1
    v_mov_b32 v40, s69
    v_mov_b32 v60, s69
    v_and_b32 v79, 12, v75
    v_cmp_eq_u32 vcc, 0, v79
    s_nop 1
    v_cndmask_b32 v79, 0, 1, vcc
    s_cmp_lg_u32 s37, 0
    s_cbranch_scc1 cf_f1_xt
cf_f1_xtx:
    s_nop 2
    v_mov_b32 v79, v79
    s_nop 2
    v_mov_b32 v79, v79
    s_nop 2
    v_mov_b32 v79, v79
    s_nop 2
    v_mov_b32 v79, v79
    s_nop 2
    v_mov_b32 v79, v79
    s_nop 2
    v_mov_b32 v79, v79
    s_nop 2
    v_mov_b32 v79, v79
    s_nop 2
    v_mov_b32 v79, v79
    s_nop 2
    v_mov_b32 v79, v79
    s_nop 2
    v_mov_b32 v79, v79
    s_nop 2
    v_mov_b32 v79, v79
    s_waitcnt vmcnt(0)
    buffer_load_dwordx4 v[8:11], v65, s[4:7], s18 offen nt
    buffer_load_dwordx4 v[12:15], v65, s[4:7], s19 offen nt
    buffer_load_dwordx4 v[16:19], v65, s[4:7], s20 offen nt
    buffer_load_dwordx4 v[20:23], v65, s[4:7], s21 offen nt
    s_nop 2
    v_mov_b32 v79, v79
    s_nop 2
    v_mov_b32 v79, v79
    s_nop 2
    v_mov_b32 v79, v79
    s_nop 2
    v_mov_b32 v79, v79
    s_nop 2
    v_mov_b32 v79, v79
    s_nop 2
    v_mov_b32 v79, v79
    s_nop 2
    v_mov_b32 v79, v79
    s_nop 2
    v_mov_b32 v79, v79
    s_nop 2
    v_mov_b32 v79, v79
    s_nop 2
    v_mov_b32 v79, v79
    buffer_load_dwordx4 v[40:43], v65, s[4:7], s14 offen offset:0 nt
    buffer_load_dwordx4 v[60:63], v66, s[4:7], s14 offen offset:0 nt
    s_waitcnt lgkmcnt(0)
    s_waitcnt vmcnt(5)
    v_xor_b32 v77, s69, v8
    v_mfma_f32_16x16x32_bf16 v[0:3], v[4:7], v[8:11], 0
    v_mov_b64 v[8:9], 0
    v_mov_b64 v[10:11], 0
    s_waitcnt vmcnt(4)
    v_bitop3_b32 v77, v77, v12, s69 bitop3:0xf6
    v_mfma_f32_16x16x32_bf16 v[0:3], v[4:7], v[12:15], v[0:3]
    v_mov_b64 v[12:13], 0
    v_mov_b64 v[14:15], 0
    s_waitcnt vmcnt(3)
    v_bitop3_b32 v77, v77, v16, s69 bitop3:0xf6
    v_mfma_f32_16x16x32_bf16 v[0:3], v[4:7], v[16:19], v[0:3]
    v_mov_b64 v[16:17], 0
    v_mov_b64 v[18:19], 0
    s_waitcnt vmcnt(2)
    v_bitop3_b32 v77, v77, v20, s69 bitop3:0xf6
    v_mfma_f32_16x16x32_bf16 v[0:3], v[4:7], v[20:23], v[0:3]
    v_and_b32 v77, 1, v77
    v_cmp_ne_u32 vcc, 0, v77
    v_mov_b64 v[20:21], 0
    v_mov_b64 v[22:23], 0
    buffer_load_dwordx4 v[40:43], v65, s[4:7], s14 offen offset:0 nt
    buffer_load_dwordx4 v[60:63], v66, s[4:7], s14 offen offset:0 nt
    s_cmp_eq_u64 vcc, 0
    s_cselect_b64 s[42:43], -1, 0
    v_add_f32_dpp v0, v0, v0 row_ror:8 row_mask:0xf bank_mask:0xf
    v_add_f32_dpp v1, v1, v1 row_ror:8 row_mask:0xf bank_mask:0xf
    s_mov_b64 exec, s[42:43]
    v_cvt_pk_bf16_f32 v72, v0, v1
    v_bfi_b32 v72, v79, s70, v72
    buffer_store_dword v72, v75, s[4:7], s17 offen offset:0
    s_mov_b64 exec, -1
    s_cbranch_scc0 cf_f1_retry
cf_f1_go:
    v_mov_b64 v[0:1], 0
    v_mov_b64 v[2:3], 0
    v_mov_b64 v[4:5], 0
    v_mov_b64 v[6:7], 0
    s_branch cf_loop
cf_f3:
    v_and_b32 v77, 255, v69
    ds_read_b128 v[4:7], v77 offset:15872
    ds_read_b128 v[44:47], v70 offset:0
    ds_read_b128 v[48:51], v70 offset:1024
    ds_read_b128 v[52:55], v70 offset:2048
    ds_read_b128 v[56:59], v70 offset:3072
    ds_read_b128 v[24:27], v70 offset:4096
    ds_read_b128 v[28:31], v70 offset:5120
    ds_read_b128 v[32:35], v70 offset:6144
    ds_read_b128 v[36:39], v70 offset:7168
    s_mov_b32 s31, 65536
    s_add_u32 s24, s24, 524288
    s_add_u32 s26, s26, 524288
    s_add_u32 s55, s55, s57
    s_mov_b32 s14, 67108864
    s_mov_b32 s15, 67112960
    s_mov_b32 s16, 67117056
    s_mov_b32 s36, 1
    v_mov_b32 v40, s69
    v_mov_b32 v60, s69
    v_and_b32 v79, 12, v75
    v_cmp_eq_u32 vcc, 0, v79
    s_nop 1
    v_cndmask_b32 v79, 0, 1, vcc
    s_add_u32 s40, s30, s95
    v_mov_b32 v72, s40
    s_waitcnt lgkmcnt(0)
    v_mov_b64 v[0:1], 0
    v_mov_b64 v[2:3], 0
    v_mov_b64 v[4:5], 0
    v_mov_b64 v[6:7], 0
    v_mov_b64 v[8:9], 0
    v_mov_b64 v[10:11], 0
    v_mov_b64 v[12:13], 0
    v_mov_b64 v[14:15], 0
    v_mov_b64 v[16:17], 0
    v_mov_b64 v[18:19], 0
    v_mov_b64 v[20:21], 0
    v_mov_b64 v[22:23], 0
    s_nop 2
    v_mov_b32 v79, v79
    s_nop 2
    v_mov_b32 v79, v79
    s_nop 2
    v_mov_b32 v79, v79
    s_nop 2
    v_mov_b32 v79, v79
    s_nop 2
    v_mov_b32 v79, v79
    s_nop 2
    v_mov_b32 v79, v79
    s_nop 2
    v_mov_b32 v79, v79
    s_nop 2
    v_mov_b32 v79, v79
    s_nop 2
    v_mov_b32 v79, v79
    s_nop 2
    v_mov_b32 v79, v79
    s_nop 2
    v_mov_b32 v79, v79
    s_nop 2
    v_mov_b32 v79, v79
    s_nop 2
    v_mov_b32 v79, v79
    s_nop 2
    v_mov_b32 v79, v79
    s_nop 2
    v_mov_b32 v79, v79
    s_nop 2
    v_mov_b32 v79, v79
    s_nop 2
    v_mov_b32 v79, v79
    s_nop 2
    v_mov_b32 v79, v79
    s_waitcnt vmcnt(0)
    s_cmp_lt_u32 s97, s93
    s_cbranch_scc1 cf_kvwait
    s_nop 2
    v_mov_b32 v79, v79
    s_nop 2
    v_mov_b32 v79, v79
    s_nop 2
    v_mov_b32 v79, v79
    s_nop 2
    v_mov_b32 v79, v79
    s_nop 2
    v_mov_b32 v79, v79
    s_nop 2
    v_mov_b32 v79, v79
    s_nop 2
    v_mov_b32 v79, v79
    s_nop 2
    v_mov_b32 v79, v79
cf_kvok:
    s_branch cf_loop
cf_f0_xt:
    s_mov_b32 s37, 0
    s_nop 2
    v_mov_b32 v79, v79
    s_nop 2
    v_mov_b32 v79, v79
    s_nop 2
    v_mov_b32 v79, v79
    s_nop 2
    v_mov_b32 v79, v79
    s_nop 2
    v_mov_b32 v79, v79
    s_nop 2
    v_mov_b32 v79, v79
    s_branch cf_f0_xtx
cf_f0_retry:
    s_mov_b32 s37, 1
cf_f0_spin:
    buffer_load_dwordx4 v[8:11], v65, s[4:7], s18 offen nt
    buffer_load_dwordx4 v[12:15], v65, s[4:7], s19 offen nt
    buffer_load_dwordx4 v[16:19], v65, s[4:7], s20 offen nt
    buffer_load_dwordx4 v[20:23], v65, s[4:7], s21 offen nt
    s_nop 2
    v_mov_b32 v79, v79
    s_nop 2
    v_mov_b32 v79, v79
    s_nop 2
    v_mov_b32 v79, v79
    s_nop 2
    v_mov_b32 v79, v79
    s_nop 2
    v_mov_b32 v79, v79
    s_nop 2
    v_mov_b32 v79, v79
    buffer_load_dwordx4 v[40:43], v65, s[4:7], s14 offen offset:0 nt
    buffer_load_dwordx4 v[60:63], v66, s[4:7], s14 offen offset:0 nt
    s_waitcnt vmcnt(5)
    v_xor_b32 v77, s69, v8
    v_mfma_f32_16x16x32_bf16 v[0:3], v[4:7], v[8:11], 0
    v_mov_b64 v[8:9], 0
    v_mov_b64 v[10:11], 0
    s_waitcnt vmcnt(4)
    v_bitop3_b32 v77, v77, v12, s69 bitop3:0xf6
    v_mfma_f32_16x16x32_bf16 v[0:3], v[4:7], v[12:15], v[0:3]
    v_mov_b64 v[12:13], 0
    v_mov_b64 v[14:15], 0
    s_waitcnt vmcnt(3)
    v_bitop3_b32 v77, v77, v16, s69 bitop3:0xf6
    v_mfma_f32_16x16x32_bf16 v[0:3], v[4:7], v[16:19], v[0:3]
    v_mov_b64 v[16:17], 0
    v_mov_b64 v[18:19], 0
    s_waitcnt vmcnt(2)
    v_bitop3_b32 v77, v77, v20, s69 bitop3:0xf6
    v_mfma_f32_16x16x32_bf16 v[0:3], v[4:7], v[20:23], v[0:3]
    v_and_b32 v77, 1, v77
    v_cmp_ne_u32 vcc, 0, v77
    v_mov_b64 v[20:21], 0
    v_mov_b64 v[22:23], 0
    buffer_load_dwordx4 v[40:43], v65, s[4:7], s14 offen offset:0 nt
    buffer_load_dwordx4 v[60:63], v66, s[4:7], s14 offen offset:0 nt
    s_cmp_eq_u64 vcc, 0
    s_cselect_b64 s[42:43], -1, 0
    v_add_f32_dpp v0, v0, v0 row_ror:8 row_mask:0xf bank_mask:0xf
    v_add_f32_dpp v1, v1, v1 row_ror:8 row_mask:0xf bank_mask:0xf
    s_mov_b64 exec, s[42:43]
    v_cvt_pk_bf16_f32 v72, v0, v1
    v_bfi_b32 v72, v79, s70, v72
    buffer_store_dword v72, v75, s[4:7], s17 offen offset:0
    s_mov_b64 exec, -1
    s_cbranch_scc1 cf_f0_rx
    s_sub_u32 s31, s31, 1
    s_cbranch_scc0 cf_f0_spin
cf_f0_rx:
    v_mov_b64 v[0:1], 0
    v_mov_b64 v[2:3], 0
    v_mov_b64 v[4:5], 0
    v_mov_b64 v[6:7], 0
    s_branch cf_loop
cf_f1_xt:
    s_mov_b32 s37, 0
    s_nop 2
    v_mov_b32 v79, v79
    s_nop 2
    v_mov_b32 v79, v79
    s_nop 2
    v_mov_b32 v79, v79
    s_nop 2
    v_mov_b32 v79, v79
    s_nop 2
    v_mov_b32 v79, v79
    s_nop 2
    v_mov_b32 v79, v79
    s_branch cf_f1_xtx
cf_f1_retry:
    s_mov_b32 s37, 1
cf_f1_spin:
    buffer_load_dwordx4 v[8:11], v65, s[4:7], s18 offen nt
    buffer_load_dwordx4 v[12:15], v65, s[4:7], s19 offen nt
    buffer_load_dwordx4 v[16:19], v65, s[4:7], s20 offen nt
    buffer_load_dwordx4 v[20:23], v65, s[4:7], s21 offen nt
    s_nop 2
    v_mov_b32 v79, v79
    s_nop 2
    v_mov_b32 v79, v79
    s_nop 2
    v_mov_b32 v79, v79
    s_nop 2
    v_mov_b32 v79, v79
    s_nop 2
    v_mov_b32 v79, v79
    s_nop 2
    v_mov_b32 v79, v79
    buffer_load_dwordx4 v[40:43], v65, s[4:7], s14 offen offset:0 nt
    buffer_load_dwordx4 v[60:63], v66, s[4:7], s14 offen offset:0 nt
    s_waitcnt vmcnt(5)
    v_xor_b32 v77, s69, v8
    v_mfma_f32_16x16x32_bf16 v[0:3], v[4:7], v[8:11], 0
    v_mov_b64 v[8:9], 0
    v_mov_b64 v[10:11], 0
    s_waitcnt vmcnt(4)
    v_bitop3_b32 v77, v77, v12, s69 bitop3:0xf6
    v_mfma_f32_16x16x32_bf16 v[0:3], v[4:7], v[12:15], v[0:3]
    v_mov_b64 v[12:13], 0
    v_mov_b64 v[14:15], 0
    s_waitcnt vmcnt(3)
    v_bitop3_b32 v77, v77, v16, s69 bitop3:0xf6
    v_mfma_f32_16x16x32_bf16 v[0:3], v[4:7], v[16:19], v[0:3]
    v_mov_b64 v[16:17], 0
    v_mov_b64 v[18:19], 0
    s_waitcnt vmcnt(2)
    v_bitop3_b32 v77, v77, v20, s69 bitop3:0xf6
    v_mfma_f32_16x16x32_bf16 v[0:3], v[4:7], v[20:23], v[0:3]
    v_and_b32 v77, 1, v77
    v_cmp_ne_u32 vcc, 0, v77
    v_mov_b64 v[20:21], 0
    v_mov_b64 v[22:23], 0
    buffer_load_dwordx4 v[40:43], v65, s[4:7], s14 offen offset:0 nt
    buffer_load_dwordx4 v[60:63], v66, s[4:7], s14 offen offset:0 nt
    s_cmp_eq_u64 vcc, 0
    s_cselect_b64 s[42:43], -1, 0
    v_add_f32_dpp v0, v0, v0 row_ror:8 row_mask:0xf bank_mask:0xf
    v_add_f32_dpp v1, v1, v1 row_ror:8 row_mask:0xf bank_mask:0xf
    s_mov_b64 exec, s[42:43]
    v_cvt_pk_bf16_f32 v72, v0, v1
    v_bfi_b32 v72, v79, s70, v72
    buffer_store_dword v72, v75, s[4:7], s17 offen offset:0
    s_mov_b64 exec, -1
    s_cbranch_scc1 cf_f1_rx
    s_sub_u32 s31, s31, 1
    s_cbranch_scc0 cf_f1_spin
cf_f1_rx:
    v_mov_b64 v[0:1], 0
    v_mov_b64 v[2:3], 0
    v_mov_b64 v[4:5], 0
    v_mov_b64 v[6:7], 0
    s_branch cf_loop
cf_f2_xt:
    s_mov_b32 s37, 0
    s_nop 2
    v_mov_b32 v79, v79
    s_nop 2
    v_mov_b32 v79, v79
    s_nop 2
    v_mov_b32 v79, v79
    s_nop 2
    v_mov_b32 v79, v79
    s_nop 2
    v_mov_b32 v79, v79
    s_nop 2
    v_mov_b32 v79, v79
    s_branch cf_f2_xtx
cf_f2_retry:
    s_mov_b32 s37, 1
cf_f2_spin:
    buffer_load_dwordx4 v[8:11], v65, s[4:7], s18 offen nt
    buffer_load_dwordx4 v[12:15], v65, s[4:7], s19 offen nt
    buffer_load_dwordx4 v[16:19], v65, s[4:7], s20 offen nt
    buffer_load_dwordx4 v[20:23], v65, s[4:7], s21 offen nt
    s_nop 2
    v_mov_b32 v79, v79
    s_nop 2
    v_mov_b32 v79, v79
    s_nop 2
    v_mov_b32 v79, v79
    s_nop 2
    v_mov_b32 v79, v79
    s_nop 2
    v_mov_b32 v79, v79
    s_nop 2
    v_mov_b32 v79, v79
    buffer_load_dwordx4 v[40:43], v65, s[4:7], s14 offen offset:0 nt
    buffer_load_dwordx4 v[60:63], v66, s[4:7], s14 offen offset:0 nt
    s_waitcnt vmcnt(5)
    v_xor_b32 v77, s69, v8
    v_bitop3_b32 v77, v77, v10, s69 bitop3:0xf6
    v_mfma_f32_16x16x32_bf16 v[0:3], v[4:7], v[8:11], 0
    v_mov_b64 v[8:9], 0
    v_mov_b64 v[10:11], 0
    s_waitcnt vmcnt(4)
    v_bitop3_b32 v77, v77, v12, s69 bitop3:0xf6
    v_bitop3_b32 v77, v77, v14, s69 bitop3:0xf6
    v_mfma_f32_16x16x32_bf16 v[0:3], v[4:7], v[12:15], v[0:3]
    v_mov_b64 v[12:13], 0
    v_mov_b64 v[14:15], 0
    s_waitcnt vmcnt(3)
    v_bitop3_b32 v77, v77, v16, s69 bitop3:0xf6
    v_bitop3_b32 v77, v77, v18, s69 bitop3:0xf6
    v_mfma_f32_16x16x32_bf16 v[0:3], v[4:7], v[16:19], v[0:3]
    v_mov_b64 v[16:17], 0
    v_mov_b64 v[18:19], 0
    s_waitcnt vmcnt(2)
    v_bitop3_b32 v77, v77, v20, s69 bitop3:0xf6
    v_bitop3_b32 v77, v77, v22, s69 bitop3:0xf6
    v_mfma_f32_16x16x32_bf16 v[0:3], v[4:7], v[20:23], v[0:3]
    v_and_b32 v77, 1, v77
    v_cmp_ne_u32 vcc, 0, v77
    v_mov_b64 v[20:21], 0
    v_mov_b64 v[22:23], 0
    buffer_load_dwordx4 v[40:43], v65, s[4:7], s14 offen offset:0 nt
    buffer_load_dwordx4 v[60:63], v66, s[4:7], s14 offen offset:0 nt
    s_cmp_eq_u64 vcc, 0
    s_cselect_b64 s[42:43], -1, 0
    v_add_f32 v2, v0, v1
    s_nop 1
    v_add_f32_dpp v2, v2, v2 row_ror:8 row_mask:0xf bank_mask:0xf
    s_nop 1
    v_mov_b32_dpp v0, v2 quad_perm:[0,0,2,2] row_mask:0xf bank_mask:0xf
    v_mov_b32_dpp v1, v2 quad_perm:[1,1,3,3] row_mask:0xf bank_mask:0xf
    s_mov_b64 exec, s[42:43]
    v_cvt_pk_bf16_f32 v72, v0, v1
    v_bfi_b32 v72, v79, s70, v72
    buffer_store_dword v72, v75, s[4:7], s17 offen offset:0
    buffer_store_dword v72, v75, s[4:7], s17 offen offset:1024
    buffer_store_dword v72, v75, s[4:7], s17 offen offset:2048
    buffer_store_dword v72, v75, s[4:7], s17 offen offset:3072
    s_mov_b64 exec, -1
    s_cbranch_scc1 cf_f2_rx
    s_sub_u32 s31, s31, 1
    s_cbranch_scc0 cf_f2_spin
cf_f2_rx:
    v_mov_b64 v[0:1], 0
    v_mov_b64 v[2:3], 0
    v_mov_b64 v[4:5], 0
    v_mov_b64 v[6:7], 0
    s_branch cf_loop
cf_spinB:
    s_waitcnt vmcnt(2)
cf_spinB_l:
    v_and_b32 v77, s36, v44
    v_cmp_ne_u32 vcc, s70, v77
    s_cbranch_vccz cf_spinB_x
    buffer_load_dwordx4 v[44:47], v65, s[4:7], s15 offen nt
    s_sub_u32 s31, s31, 16
    s_waitcnt vmcnt(0)
    s_cbranch_scc0 cf_spinB_l
cf_spinB_x:
    ds_write_b128 v65, v[44:47] offset:4096
    s_waitcnt lgkmcnt(0)
    s_branch cf_backB
cf_spin8:
    buffer_load_dwordx4 v[40:43], v65, s[4:7], s16 offen nt
cf_spin8_l:
    v_and_b32 v77, s36, v40
    v_cmp_ne_u32 vcc, s70, v77
    s_cbranch_vccz cf_spin8_x
    s_nop 1
    v_and_b32 v77, s36, v40
    v_cmp_ne_u32 vcc, s70, v77
    s_cbranch_vccz cf_spin8_x
    s_nop 1
    v_and_b32 v77, s36, v40
    v_cmp_ne_u32 vcc, s70, v77
    s_cbranch_vccz cf_spin8_x
    s_nop 1
    buffer_load_dwordx4 v[40:43], v65, s[4:7], s16 offen nt
    s_sub_u32 s31, s31, 16
    s_cbranch_scc0 cf_spin8_l
cf_spin8_x:
    s_branch cf_back8
cf_rare:
    s_mov_b64 exec, s[34:35]
    buffer_store_dwordx4 v[0:3], v65, s[4:7], s28 offen sc1
    s_mov_b64 exec, -1
    s_nop 3
    v_cvt_pk_bf16_f32 v52, v16, v17
    v_cvt_pk_bf16_f32 v53, v18, v19
    v_cvt_pk_bf16_f32 v54, v20, v21
    v_cvt_pk_bf16_f32 v55, v22, v23
    buffer_store_dwordx4 v[52:55], v65, s[4:7], s27 offen sc1
    s_add_u32 s28, s28, 131072
    s_add_u32 s27, s27, 131072
    s_cmp_eq_u32 s30, 63
    s_cbranch_scc1 cf_last
    s_branch cf_rare_x
cf_kvwait:
    s_mov_b32 s41, s97
    v_bfe_u32 v78, v65, 2, 5
    v_mov_b32 v77, v76
    s_nop 1
    v_permlane32_swap_b32 v76, v77
    v_subrev_u32 v77, s95, v77
    v_cmp_lt_u32 vcc, 16, v77
    s_nop 1
    v_cndmask_b32 v77, v77, 0, vcc
    v_bfe_u32 v79, v78, 2, 2
    v_lshl_add_u32 v77, v77, 2, v79
    s_nop 1
    v_min_u32_dpp v77, v77, v77 row_ror:1 row_mask:0xf bank_mask:0xf
    s_nop 1
    v_min_u32_dpp v77, v77, v77 row_ror:2 row_mask:0xf bank_mask:0xf
    s_nop 1
    v_min_u32_dpp v77, v77, v77 row_ror:4 row_mask:0xf bank_mask:0xf
    s_nop 0
    v_readfirstlane_b32 s97, v77
    s_nop 0
    s_max_u32 s97, s97, s41
    s_add_u32 s40, s30, 3
    s_min_u32 s40, s40, 64
    s_cmp_le_u32 s40, s97
    s_cbranch_scc1 cf_kvw_x
    v_bfe_u32 v78, v65, 2, 5
    s_mov_b32 s31, 4194304
cf_kvw:
    buffer_load_dword v77, v78, s[4:7], s96 offen offset:16 sc1
    s_waitcnt vmcnt(0)
    v_subrev_u32 v77, s95, v77
    v_cmp_lt_u32 vcc, 16, v77
    s_nop 1
    v_cndmask_b32 v77, v77, 0, vcc
    v_bfe_u32 v79, v78, 2, 2
    v_lshl_add_u32 v77, v77, 2, v79
    s_nop 1
    v_min_u32_dpp v77, v77, v77 row_ror:1 row_mask:0xf bank_mask:0xf
    s_nop 1
    v_min_u32_dpp v77, v77, v77 row_ror:2 row_mask:0xf bank_mask:0xf
    s_nop 1
    v_min_u32_dpp v77, v77, v77 row_ror:4 row_mask:0xf bank_mask:0xf
    s_nop 0
    v_readfirstlane_b32 s97, v77
    s_sub_u32 s31, s31, 1
    s_cbranch_scc1 cf_kvw_x
    s_cmp_le_u32 s40, s97
    s_cbranch_scc1 cf_kvw_x
    s_sleep 2
    s_branch cf_kvw
cf_kvw_x:
    s_branch cf_kvok
cf_last:
    s_add_u32 s40, s95, 64
    v_mov_b32 v78, s40
    s_waitcnt vmcnt(0)
    s_barrier
    s_mov_b64 exec, s[100:101]
    buffer_store_dword v78, off, s[4:7], s29 sc1
    s_mov_b64 exec, -1
cf_end:
    s_endpgm
L_chain_safe:
    s_load_dwordx8 s[48:55], s[0:1], 8
    s_load_dwordx2 s[56:57], s[0:1], 40
    s_waitcnt lgkmcnt(0)
    v_lshrrev_b32 v77, 6, v0
    s_nop 0
    v_readfirstlane_b32 s13, v77
    v_lshlrev_b32 v65, 4, v0
    v_and_b32 v48, 63, v0
    s_mov_b32 s10, 4718592
    s_mov_b32 s11, 0x20000
    v_lshrrev_b32 v49, 3, v48
    v_mul_u32_u24 v18, 1152, v49
    v_and_b32 v49, 7, v48
    v_lshl_add_u32 v18, v49, 4, v18
    s_mul_i32 s40, s12, 147456
    s_lshl_b32 s41, s13, 8
    s_add_u32 s40, s40, s41
    s_mov_b32 s42, s40
    s_xor_b32 s41, s13, 0
    s_mul_i32 s41, s41, 36864
    s_add_u32 s60, s41, s40
    s_xor_b32 s41, s13, 1
    s_mul_i32 s41, s41, 36864
    s_add_u32 s61, s41, s40
    s_xor_b32 s41, s13, 2
    s_mul_i32 s41, s41, 36864
    s_add_u32 s62, s41, s40
    s_xor_b32 s41, s13, 3
    s_mul_i32 s41, s41, 36864
    s_add_u32 s63, s41, s40
    s_lshl_b32 s43, s13, 12
    s_mov_b64 s[8:9], s[56:57]
    s_add_u32 m0, s43, 0
    s_add_u32 s41, s60, 0
    buffer_load_dwordx4 v18, s[8:11], s41 offen offset:0 nt lds
    s_add_u32 s41, s60, 8192
    buffer_load_dwordx4 v18, s[8:11], s41 offen offset:1024 nt lds
    s_add_u32 s41, s60, 16384
    buffer_load_dwordx4 v18, s[8:11], s41 offen offset:2048 nt lds
    s_add_u32 s41, s60, 24576
    buffer_load_dwordx4 v18, s[8:11], s41 offen offset:3072 nt lds
    s_add_u32 m0, s43, 36864
    s_add_u32 s41, s61, 0
    buffer_load_dwordx4 v18, s[8:11], s41 offen offset:0 nt lds
    s_add_u32 s41, s61, 8192
    buffer_load_dwordx4 v18, s[8:11], s41 offen offset:1024 nt lds
    s_add_u32 s41, s61, 16384
    buffer_load_dwordx4 v18, s[8:11], s41 offen offset:2048 nt lds
    s_add_u32 s41, s61, 24576
    buffer_load_dwordx4 v18, s[8:11], s41 offen offset:3072 nt lds
    s_add_u32 m0, s43, 73728
    s_add_u32 s41, s62, 0
    buffer_load_dwordx4 v18, s[8:11], s41 offen offset:0 nt lds
    s_add_u32 s41, s62, 8192
    buffer_load_dwordx4 v18, s[8:11], s41 offen offset:1024 nt lds
    s_add_u32 s41, s62, 16384
    buffer_load_dwordx4 v18, s[8:11], s41 offen offset:2048 nt lds
    s_add_u32 s41, s62, 24576
    buffer_load_dwordx4 v18, s[8:11], s41 offen offset:3072 nt lds
    s_add_u32 m0, s43, 110592
    s_add_u32 s41, s63, 0
    buffer_load_dwordx4 v18, s[8:11], s41 offen offset:0 nt lds
    s_add_u32 s41, s63, 8192
    buffer_load_dwordx4 v18, s[8:11], s41 offen offset:1024 nt lds
    s_add_u32 s41, s63, 16384
    buffer_load_dwordx4 v18, s[8:11], s41 offen offset:2048 nt lds
    s_add_u32 s41, s63, 24576
    buffer_load_dwordx4 v18, s[8:11], s41 offen offset:3072 nt lds
    v_lshrrev_b32 v49, 1, v48
    v_mul_u32_u24 v19, 1152, v49
    v_and_b32 v49, 1, v48
    v_lshl_add_u32 v19, v49, 4, v19
    s_mul_i32 s41, s13, 224
    s_sub_u32 s41, 1024, s41
    v_add_u32 v19, s41, v19
    v_lshrrev_b32 v49, 4, v48
    v_lshlrev_b32 v50, 2, v49
    v_and_b32 v51, 15, v48
    v_xor_b32 v51, v51, v50
    v_lshlrev_b32 v51, 4, v51
    v_lshl_add_u32 v16, v49, 15, v51
    v_lshrrev_b32 v50, 1, v49
    v_lshl_add_u32 v17, v50, 16, v51
    v_and_b32 v50, 1, v49
    v_lshl_add_u32 v17, v50, 13, v17
    s_lshl_b32 s40, s12, 8
    s_mul_i32 s58, s13, 1048576
    s_add_u32 s58, s58, s40
    s_lshr_b32 s41, s13, 1
    s_mul_i32 s59, s41, 262144
    s_and_b32 s41, s13, 1
    s_lshl_b32 s41, s41, 14
    s_add_u32 s59, s59, s41
    s_add_u32 s59, s59, s40
    s_add_u32 s59, s59, 4194304
    v_bfe_u32 v50, v48, 2, 2
    v_xor_b32 v51, s13, v50
    v_lshlrev_b32 v20, 6, v51
    v_and_b32 v51, 3, v48
    v_lshl_add_u32 v20, v51, 4, v20
    v_lshrrev_b32 v23, 2, v48
    v_lshl_add_u32 v20, v23, 8, v20
    s_xor_b32 s41, s43, 0
    v_add_u32 v24, s41, v20
    s_xor_b32 s41, s43, 4096
    v_add_u32 v25, s41, v20
    s_xor_b32 s41, s43, 8192
    v_add_u32 v26, s41, v20
    s_xor_b32 s41, s43, 12288
    v_add_u32 v27, s41, v20
    v_and_b32 v23, 1, v50
    v_lshl_add_u32 v23, v49, 2, v23
    v_lshrrev_b32 v50, 1, v50
    v_lshlrev_b32 v21, 7, v23
    v_lshl_add_u32 v21, v50, 6, v21
    v_lshl_add_u32 v21, v51, 4, v21
    v_add_u32 v21, s43, v21
    v_lshlrev_b32 v22, 9, v50
    v_xor_b32 v22, v22, v21
    v_lshlrev_b32 v23, 5, v23
    v_lshl_add_u32 v23, v50, 10, v23
    v_lshl_add_u32 v23, v51, 3, v23
    v_add_u32 v23, s43, v23
    v_bfe_u32 v60, v65, 4, 6
    v_and_b32 v61, 15, v60
    v_lshrrev_b32 v62, 4, v60
    v_mov_b32 v64, 0x4444
    v_mov_b32 v77, 0xeeee
    v_cmp_lt_u32 vcc, 7, v61
    s_nop 1
    v_cndmask_b32 v64, v64, v77, vcc
    v_xor_b32 v66, 1024, v65
    v_xor_b32 v67, 2048, v65
    v_xor_b32 v68, 3072, v65
    v_and_b32 v69, 511, v65
    s_mul_i32 s96, s13, 36864
    s_add_u32 s96, s96, 16384
    v_lshlrev_b32 v70, 4, v60
    v_add_u32 v70, s96, v70
    v_lshrrev_b32 v79, 1, v69
    s_lshl_b32 s96, s13, 8
    s_add_u32 s96, s96, 14336
    s_lshl_b32 s33, s13, 10
    s_add_u32 s97, s33, 8192
    v_mov_b32 v77, s97
    v_mov_b32 v78, s96
    v_cmp_lt_u32 vcc, 31, v60
    s_nop 1
    v_cndmask_b32 v71, v77, v78, vcc
    v_add_u32 v71, v71, v79
    v_and_b32 v77, 7, v61
    v_lshrrev_b32 v78, 3, v61
    v_lshlrev_b32 v74, 4, v77
    v_lshl_add_u32 v73, v62, 7, v74
    v_lshl_add_u32 v73, v78, 3, v73
    s_lshl_b32 s96, s13, 9
    v_add_u32 v73, s96, v73
    v_lshl_add_u32 v74, v78, 14, v74
    v_lshl_add_u32 v74, v62, 15, v74
    s_lshl_b32 s96, s13, 17
    v_add_u32 v74, s96, v74
    v_bfe_u32 v77, v61, 2, 1
    v_and_b32 v78, 3, v61
    v_bfe_u32 v79, v61, 1, 2
    s_cmp_lt_u32 s13, 2
    s_cselect_b64 vcc, -1, 0
    v_cndmask_b32 v77, 0, v77, vcc
    v_cndmask_b32 v78, v79, v78, vcc
    v_lshlrev_b32 v75, 7, v77
    v_lshl_add_u32 v75, v62, 4, v75
    v_lshl_add_u32 v75, v78, 2, v75
    v_lshl_add_u32 v58, v77, 3, v78
    v_lshlrev_b32 v79, 1, v78
    v_cndmask_b32 v58, v79, v58, vcc
    s_bfe_u32 s97, s12, 0x10001
    s_lshl_b32 s68, s97, 6
    s_lshl_b32 s97, s97, 2
    v_add_u32 v59, s97, v62
    s_bfe_u32 s96, s12, 0x10002
    s_and_b32 s40, s12, 1
    s_lshl_b32 s96, s96, 1
    s_add_u32 s96, s96, s40
    s_lshr_b32 s97, s12, 3
    s_lshl_b32 s98, s13, 2
    s_add_u32 s98, s98, s97
    s_lshl_b32 s98, s98, 2
    s_add_u32 s98, s98, s96
    s_lshl_b32 s98, s98, 8
    s_lshl_b32 s99, s13, 2
    s_add_u32 s99, s99, s96
    s_lshl_b32 s99, s99, 4
    s_lshl_b32 s41, s97, 1
    s_add_u32 s41, s41, s40
    s_lshl_b32 s41, s41, 7
    s_add_u32 s41, s41, 8192
    s_lshl_b32 s40, s40, 3
    s_add_u32 s40, s40, 512
    s_cmp_lt_u32 s13, 2
    s_cselect_b32 s96, 7, 4
    s_cselect_b32 s98, s98, s41
    s_cselect_b32 s99, s99, s40
    s_cselect_b32 s32, 1, 0
    s_add_u32 s68, s68, s98
    s_lshl_b32 s97, s97, s96
    s_add_u32 s99, s99, s97
    v_add_u32 v58, s99, v58
    s_and_b32 s97, s12, 4
    s_or_b32 s97, s97, s13
    s_cmp_eq_u32 s97, 2
    s_cselect_b32 s32, 2, s32
    s_mov_b32 s8, s48
    s_mov_b32 s9, s49
    s_mov_b32 s10, 9216
    s_cmp_lt_u32 s13, 2
    s_cselect_b32 s96, 8, 2
    v_mul_u32_u24 v77, 1152, v59
    v_lshl_add_u32 v77, v58, 1, v77
    buffer_load_ushort v72, v77, s[8:11], 0 offen
    buffer_load_ushort v76, v77, s[8:11], s96 offen
    s_mov_b32 s10, 4718592
    s_waitcnt vmcnt(12) lgkmcnt(0)
    s_barrier
    s_mov_b64 s[8:9], s[56:57]
    s_add_u32 m0, s43, 147456
    s_add_u32 s41, s42, 0
    buffer_load_dwordx4 v19, s[8:11], s41 offen offset:0 nt lds
    s_add_u32 s41, s42, 35840
    buffer_load_dwordx4 v19, s[8:11], s41 offen offset:1024 nt lds
    s_add_u32 s41, s42, 71680
    buffer_load_dwordx4 v19, s[8:11], s41 offen offset:2048 nt lds
    s_add_u32 s41, s42, 107520
    buffer_load_dwordx4 v19, s[8:11], s41 offen offset:3072 nt lds
    v_mov_b32 v78, v21
    v_mov_b32 v79, v22
    v_add_u32 v77, 0, v79
    ds_read_b64_tr_b16 v[80:81], v77 offset:0
    ds_read_b64_tr_b16 v[82:83], v77 offset:256
    ds_read_b64_tr_b16 v[84:85], v77 offset:2048
    ds_read_b64_tr_b16 v[86:87], v77 offset:2304
    ds_read_b64_tr_b16 v[112:113], v77 offset:8
    ds_read_b64_tr_b16 v[114:115], v77 offset:264
    ds_read_b64_tr_b16 v[116:117], v77 offset:2056
    ds_read_b64_tr_b16 v[118:119], v77 offset:2312
    s_waitcnt vmcnt(12) lgkmcnt(0)
    s_barrier
    s_mov_b64 s[8:9], s[52:53]
    s_add_u32 m0, s43, 0
    s_add_u32 s41, s58, 0
    buffer_load_dwordx4 v16, s[8:11], s41 offen offset:0 nt lds
    s_add_u32 s41, s58, 15360
    buffer_load_dwordx4 v16, s[8:11], s41 offen offset:1024 nt lds
    s_add_u32 s41, s58, 129024
    buffer_load_dwordx4 v16, s[8:11], s41 offen offset:2048 nt lds
    s_add_u32 s41, s58, 144384
    buffer_load_dwordx4 v16, s[8:11], s41 offen offset:3072 nt lds
    v_add_u32 v77, 36864, v78
    ds_read_b64_tr_b16 v[88:89], v77 offset:0
    ds_read_b64_tr_b16 v[90:91], v77 offset:256
    ds_read_b64_tr_b16 v[92:93], v77 offset:2048
    ds_read_b64_tr_b16 v[94:95], v77 offset:2304
    ds_read_b64_tr_b16 v[120:121], v77 offset:8
    ds_read_b64_tr_b16 v[122:123], v77 offset:264
    ds_read_b64_tr_b16 v[124:125], v77 offset:2056
    ds_read_b64_tr_b16 v[126:127], v77 offset:2312
    s_waitcnt vmcnt(12) lgkmcnt(0)
    s_barrier
    s_add_u32 m0, s43, 36864
    s_add_u32 s41, s58, 8192
    buffer_load_dwordx4 v16, s[8:11], s41 offen offset:0 nt lds
    s_add_u32 s41, s58, 23552
    buffer_load_dwordx4 v16, s[8:11], s41 offen offset:1024 nt lds
    s_add_u32 s41, s58, 137216
    buffer_load_dwordx4 v16, s[8:11], s41 offen offset:2048 nt lds
    s_add_u32 s41, s58, 152576
    buffer_load_dwordx4 v16, s[8:11], s41 offen offset:3072 nt lds
    v_add_u32 v77, 73728, v78
    ds_read_b64_tr_b16 v[96:97], v77 offset:0
    ds_read_b64_tr_b16 v[98:99], v77 offset:256
    ds_read_b64_tr_b16 v[100:101], v77 offset:2048
    ds_read_b64_tr_b16 v[102:103], v77 offset:2304
    ds_read_b64_tr_b16 v[128:129], v77 offset:8
    ds_read_b64_tr_b16 v[130:131], v77 offset:264
    ds_read_b64_tr_b16 v[132:133], v77 offset:2056
    ds_read_b64_tr_b16 v[134:135], v77 offset:2312
    s_waitcnt vmcnt(12) lgkmcnt(0)
    s_barrier
    s_add_u32 m0, s43, 73728
    s_add_u32 s41, s58, 262144
    buffer_load_dwordx4 v16, s[8:11], s41 offen offset:0 nt lds
    s_add_u32 s41, s58, 277504
    buffer_load_dwordx4 v16, s[8:11], s41 offen offset:1024 nt lds
    s_add_u32 s41, s58, 391168
    buffer_load_dwordx4 v16, s[8:11], s41 offen offset:2048 nt lds
    s_add_u32 s41, s58, 406528
    buffer_load_dwordx4 v16, s[8:11], s41 offen offset:3072 nt lds
    v_add_u32 v77, 110592, v78
    ds_read_b64_tr_b16 v[104:105], v77 offset:0
    ds_read_b64_tr_b16 v[106:107], v77 offset:256
    ds_read_b64_tr_b16 v[108:109], v77 offset:2048
    ds_read_b64_tr_b16 v[110:111], v77 offset:2304
    ds_read_b64_tr_b16 v[136:137], v77 offset:8
    ds_read_b64_tr_b16 v[138:139], v77 offset:264
    ds_read_b64_tr_b16 v[140:141], v77 offset:2056
    ds_read_b64_tr_b16 v[142:143], v77 offset:2312
    s_waitcnt vmcnt(12) lgkmcnt(0)
    s_barrier
    s_add_u32 m0, s43, 110592
    s_add_u32 s41, s58, 270336
    buffer_load_dwordx4 v16, s[8:11], s41 offen offset:0 nt lds
    s_add_u32 s41, s58, 285696
    buffer_load_dwordx4 v16, s[8:11], s41 offen offset:1024 nt lds
    s_add_u32 s41, s58, 399360
    buffer_load_dwordx4 v16, s[8:11], s41 offen offset:2048 nt lds
    s_add_u32 s41, s58, 414720
    buffer_load_dwordx4 v16, s[8:11], s41 offen offset:3072 nt lds
    v_add_u32 v77, 147456, v23
    ds_read_b64_tr_b16 v[0:1], v77 offset:0
    ds_read_b64_tr_b16 v[2:3], v77 offset:64
    ds_read_b64_tr_b16 v[4:5], v77 offset:512
    ds_read_b64_tr_b16 v[6:7], v77 offset:576
    ds_read_b64_tr_b16 v[8:9], v77 offset:2048
    ds_read_b64_tr_b16 v[10:11], v77 offset:2112
    ds_read_b64_tr_b16 v[12:13], v77 offset:2560
    ds_read_b64_tr_b16 v[14:15], v77 offset:2624
    s_waitcnt vmcnt(12) lgkmcnt(0)
    s_barrier
    s_add_u32 m0, s43, 147456
    s_add_u32 s41, s58, 524288
    buffer_load_dwordx4 v16, s[8:11], s41 offen offset:0 nt lds
    s_add_u32 s41, s58, 539648
    buffer_load_dwordx4 v16, s[8:11], s41 offen offset:1024 nt lds
    s_add_u32 s41, s58, 653312
    buffer_load_dwordx4 v16, s[8:11], s41 offen offset:2048 nt lds
    s_add_u32 s41, s58, 668672
    buffer_load_dwordx4 v16, s[8:11], s41 offen offset:3072 nt lds
    s_cmp_eq_u32 s32, 0
    s_cbranch_scc1 cs_init_done
    v_mov_b32 v52, 1
    v_mov_b32 v53, 1
    v_mov_b32 v54, 1
    v_mov_b32 v55, 1
    v_mov_b32 v56, 0
    v_lshl_or_b32 v72, v76, 16, v72
    s_lshl_b32 s96, s12, 14
    s_add_u32 s96, s96, 68681728
    s_add_u32 s97, s96, 0
    buffer_store_dwordx4 v[52:55], v65, s[4:7], s97 offen sc1
    s_add_u32 s97, s96, 4096
    buffer_store_dwordx4 v[52:55], v65, s[4:7], s97 offen sc1
    s_add_u32 s97, s96, 8192
    buffer_store_dwordx4 v[52:55], v65, s[4:7], s97 offen sc1
    s_add_u32 s97, s96, 12288
    buffer_store_dwordx4 v[52:55], v65, s[4:7], s97 offen sc1
    s_add_u32 s96, s68, 67633152
    s_add_u32 s97, s96, 16384
    buffer_store_dword v56, v75, s[4:7], s96 offen offset:0 sc1
    buffer_store_dword v72, v75, s[4:7], s97 offen offset:0 sc1
    s_cmp_lg_u32 s32, 2
    s_cbranch_scc1 cs_init_done
    buffer_store_dword v56, v75, s[4:7], s96 offen offset:1024 sc1
    buffer_store_dword v72, v75, s[4:7], s97 offen offset:1024 sc1
    buffer_store_dword v56, v75, s[4:7], s96 offen offset:2048 sc1
    buffer_store_dword v72, v75, s[4:7], s97 offen offset:2048 sc1
    buffer_store_dword v56, v75, s[4:7], s96 offen offset:3072 sc1
    buffer_store_dword v72, v75, s[4:7], s97 offen offset:3072 sc1
cs_init_done:
    ds_write_b64 v70, v[0:1] offset:16384
    ds_write_b64 v70, v[2:3] offset:16392
    ds_write_b64 v70, v[4:5] offset:17408
    ds_write_b64 v70, v[6:7] offset:17416
    ds_write_b64 v70, v[8:9] offset:18432
    ds_write_b64 v70, v[10:11] offset:18440
    ds_write_b64 v70, v[12:13] offset:19456
    ds_write_b64 v70, v[14:15] offset:19464
    v_add_u32 v28, 0, v24
    v_add_u32 v29, 0, v25
    v_add_u32 v30, 0, v26
    v_add_u32 v31, 0, v27
    ds_read_b64_tr_b16 a[96:97], v28 offset:0
    ds_read_b64_tr_b16 a[104:105], v28 offset:8
    ds_read_b64_tr_b16 a[112:113], v29 offset:0
    ds_read_b64_tr_b16 a[120:121], v29 offset:8
    ds_read_b64_tr_b16 a[128:129], v30 offset:0
    ds_read_b64_tr_b16 a[136:137], v30 offset:8
    ds_read_b64_tr_b16 a[144:145], v31 offset:0
    ds_read_b64_tr_b16 v[32:33], v31 offset:8
    s_waitcnt vmcnt(12) lgkmcnt(0)
    s_barrier
    s_add_u32 m0, s43, 0
    s_add_u32 s41, s58, 532480
    buffer_load_dwordx4 v16, s[8:11], s41 offen offset:0 nt lds
    s_add_u32 s41, s58, 547840
    buffer_load_dwordx4 v16, s[8:11], s41 offen offset:1024 nt lds
    s_add_u32 s41, s58, 661504
    buffer_load_dwordx4 v16, s[8:11], s41 offen offset:2048 nt lds
    s_add_u32 s41, s58, 676864
    buffer_load_dwordx4 v16, s[8:11], s41 offen offset:3072 nt lds
    ds_write_b64 v70, v[32:33] offset:12288
    v_add_u32 v28, 36864, v24
    v_add_u32 v29, 36864, v25
    v_add_u32 v30, 36864, v26
    v_add_u32 v31, 36864, v27
    ds_read_b64_tr_b16 a[98:99], v28 offset:0
    ds_read_b64_tr_b16 a[106:107], v28 offset:8
    ds_read_b64_tr_b16 a[114:115], v29 offset:0
    ds_read_b64_tr_b16 a[122:123], v29 offset:8
    ds_read_b64_tr_b16 a[130:131], v30 offset:0
    ds_read_b64_tr_b16 a[138:139], v30 offset:8
    ds_read_b64_tr_b16 a[146:147], v31 offset:0
    ds_read_b64_tr_b16 v[0:1], v31 offset:8
    s_waitcnt vmcnt(12) lgkmcnt(0)
    s_barrier
    s_add_u32 m0, s43, 36864
    s_add_u32 s41, s58, 786432
    buffer_load_dwordx4 v16, s[8:11], s41 offen offset:0 nt lds
    s_add_u32 s41, s58, 801792
    buffer_load_dwordx4 v16, s[8:11], s41 offen offset:1024 nt lds
    s_add_u32 s41, s58, 915456
    buffer_load_dwordx4 v16, s[8:11], s41 offen offset:2048 nt lds
    s_add_u32 s41, s58, 930816
    buffer_load_dwordx4 v16, s[8:11], s41 offen offset:3072 nt lds
    ds_write_b64 v70, v[0:1] offset:12296
    v_add_u32 v28, 73728, v24
    v_add_u32 v29, 73728, v25
    v_add_u32 v30, 73728, v26
    v_add_u32 v31, 73728, v27
    ds_read_b64_tr_b16 a[100:101], v28 offset:0
    ds_read_b64_tr_b16 a[108:109], v28 offset:8
    ds_read_b64_tr_b16 a[116:117], v29 offset:0
    ds_read_b64_tr_b16 a[124:125], v29 offset:8
    ds_read_b64_tr_b16 a[132:133], v30 offset:0
    ds_read_b64_tr_b16 a[140:141], v30 offset:8
    ds_read_b64_tr_b16 a[148:149], v31 offset:0
    ds_read_b64_tr_b16 v[32:33], v31 offset:8
    s_waitcnt vmcnt(12) lgkmcnt(0)
    s_barrier
    s_add_u32 m0, s43, 73728
    s_add_u32 s41, s58, 794624
    buffer_load_dwordx4 v16, s[8:11], s41 offen offset:0 nt lds
    s_add_u32 s41, s58, 809984
    buffer_load_dwordx4 v16, s[8:11], s41 offen offset:1024 nt lds
    s_add_u32 s41, s58, 923648
    buffer_load_dwordx4 v16, s[8:11], s41 offen offset:2048 nt lds
    s_add_u32 s41, s58, 939008
    buffer_load_dwordx4 v16, s[8:11], s41 offen offset:3072 nt lds
    ds_write_b64 v70, v[32:33] offset:13312
    v_add_u32 v28, 110592, v24
    v_add_u32 v29, 110592, v25
    v_add_u32 v30, 110592, v26
    v_add_u32 v31, 110592, v27
    ds_read_b64_tr_b16 a[102:103], v28 offset:0
    ds_read_b64_tr_b16 a[110:111], v28 offset:8
    ds_read_b64_tr_b16 a[118:119], v29 offset:0
    ds_read_b64_tr_b16 a[126:127], v29 offset:8
    ds_read_b64_tr_b16 a[134:135], v30 offset:0
    ds_read_b64_tr_b16 a[142:143], v30 offset:8
    ds_read_b64_tr_b16 a[150:151], v31 offset:0
    ds_read_b64_tr_b16 v[0:1], v31 offset:8
    s_waitcnt vmcnt(12) lgkmcnt(0)
    s_barrier
    s_add_u32 m0, s43, 110592
    s_add_u32 s41, s59, 0
    buffer_load_dwordx4 v17, s[8:11], s41 offen offset:0 nt lds
    s_add_u32 s41, s59, 31744
    buffer_load_dwordx4 v17, s[8:11], s41 offen offset:1024 nt lds
    s_add_u32 s41, s59, 129024
    buffer_load_dwordx4 v17, s[8:11], s41 offen offset:2048 nt lds
    s_add_u32 s41, s59, 160768
    buffer_load_dwordx4 v17, s[8:11], s41 offen offset:3072 nt lds
    ds_write_b64 v70, v[0:1] offset:13320
    v_add_u32 v28, 147456, v24
    v_add_u32 v29, 147456, v25
    v_add_u32 v30, 147456, v26
    v_add_u32 v31, 147456, v27
    ds_read_b64_tr_b16 a[152:153], v28 offset:0
    ds_read_b64_tr_b16 a[160:161], v28 offset:8
    ds_read_b64_tr_b16 a[168:169], v29 offset:0
    ds_read_b64_tr_b16 a[176:177], v29 offset:8
    ds_read_b64_tr_b16 a[184:185], v30 offset:0
    ds_read_b64_tr_b16 a[192:193], v30 offset:8
    ds_read_b64_tr_b16 a[200:201], v31 offset:0
    ds_read_b64_tr_b16 a[208:209], v31 offset:8
    s_waitcnt vmcnt(12) lgkmcnt(0)
    s_barrier
    s_mov_b64 s[8:9], s[50:51]
    s_add_u32 m0, s43, 147456
    s_add_u32 s41, s58, 0
    buffer_load_dwordx4 v16, s[8:11], s41 offen offset:0 nt lds
    s_add_u32 s41, s58, 15360
    buffer_load_dwordx4 v16, s[8:11], s41 offen offset:1024 nt lds
    s_add_u32 s41, s58, 129024
    buffer_load_dwordx4 v16, s[8:11], s41 offen offset:2048 nt lds
    s_add_u32 s41, s58, 144384
    buffer_load_dwordx4 v16, s[8:11], s41 offen offset:3072 nt lds
    v_add_u32 v28, 0, v24
    v_add_u32 v29, 0, v25
    v_add_u32 v30, 0, v26
    v_add_u32 v31, 0, v27
    ds_read_b64_tr_b16 a[154:155], v28 offset:0
    ds_read_b64_tr_b16 a[162:163], v28 offset:8
    ds_read_b64_tr_b16 a[170:171], v29 offset:0
    ds_read_b64_tr_b16 a[178:179], v29 offset:8
    ds_read_b64_tr_b16 a[186:187], v30 offset:0
    ds_read_b64_tr_b16 a[194:195], v30 offset:8
    ds_read_b64_tr_b16 a[202:203], v31 offset:0
    ds_read_b64_tr_b16 a[210:211], v31 offset:8
    s_waitcnt vmcnt(12) lgkmcnt(0)
    s_barrier
    s_add_u32 m0, s43, 0
    s_add_u32 s41, s58, 8192
    buffer_load_dwordx4 v16, s[8:11], s41 offen offset:0 nt lds
    s_add_u32 s41, s58, 23552
    buffer_load_dwordx4 v16, s[8:11], s41 offen offset:1024 nt lds
    s_add_u32 s41, s58, 137216
    buffer_load_dwordx4 v16, s[8:11], s41 offen offset:2048 nt lds
    s_add_u32 s41, s58, 152576
    buffer_load_dwordx4 v16, s[8:11], s41 offen offset:3072 nt lds
    v_add_u32 v28, 36864, v24
    v_add_u32 v29, 36864, v25
    v_add_u32 v30, 36864, v26
    v_add_u32 v31, 36864, v27
    ds_read_b64_tr_b16 a[156:157], v28 offset:0
    ds_read_b64_tr_b16 a[164:165], v28 offset:8
    ds_read_b64_tr_b16 a[172:173], v29 offset:0
    ds_read_b64_tr_b16 a[180:181], v29 offset:8
    ds_read_b64_tr_b16 a[188:189], v30 offset:0
    ds_read_b64_tr_b16 a[196:197], v30 offset:8
    ds_read_b64_tr_b16 a[204:205], v31 offset:0
    ds_read_b64_tr_b16 a[212:213], v31 offset:8
    s_waitcnt vmcnt(12) lgkmcnt(0)
    s_barrier
    s_add_u32 m0, s43, 36864
    s_add_u32 s41, s58, 262144
    buffer_load_dwordx4 v16, s[8:11], s41 offen offset:0 nt lds
    s_add_u32 s41, s58, 277504
    buffer_load_dwordx4 v16, s[8:11], s41 offen offset:1024 nt lds
    s_add_u32 s41, s58, 391168
    buffer_load_dwordx4 v16, s[8:11], s41 offen offset:2048 nt lds
    s_add_u32 s41, s58, 406528
    buffer_load_dwordx4 v16, s[8:11], s41 offen offset:3072 nt lds
    v_add_u32 v28, 73728, v24
    v_add_u32 v29, 73728, v25
    v_add_u32 v30, 73728, v26
    v_add_u32 v31, 73728, v27
    ds_read_b64_tr_b16 a[158:159], v28 offset:0
    ds_read_b64_tr_b16 a[166:167], v28 offset:8
    ds_read_b64_tr_b16 a[174:175], v29 offset:0
    ds_read_b64_tr_b16 a[182:183], v29 offset:8
    ds_read_b64_tr_b16 a[190:191], v30 offset:0
    ds_read_b64_tr_b16 a[198:199], v30 offset:8
    ds_read_b64_tr_b16 a[206:207], v31 offset:0
    ds_read_b64_tr_b16 a[214:215], v31 offset:8
    s_waitcnt vmcnt(12) lgkmcnt(0)
    s_barrier
    s_add_u32 m0, s43, 73728
    s_add_u32 s41, s58, 270336
    buffer_load_dwordx4 v16, s[8:11], s41 offen offset:0 nt lds
    s_add_u32 s41, s58, 285696
    buffer_load_dwordx4 v16, s[8:11], s41 offen offset:1024 nt lds
    s_add_u32 s41, s58, 399360
    buffer_load_dwordx4 v16, s[8:11], s41 offen offset:2048 nt lds
    s_add_u32 s41, s58, 414720
    buffer_load_dwordx4 v16, s[8:11], s41 offen offset:3072 nt lds
    v_add_u32 v77, 110592, v20
    ds_read_b64_tr_b16 a[216:217], v77 offset:0
    ds_read_b64_tr_b16 a[218:219], v77 offset:4096
    ds_read_b64_tr_b16 a[220:221], v77 offset:8192
    ds_read_b64_tr_b16 a[222:223], v77 offset:12288
    ds_read_b64_tr_b16 a[224:225], v77 offset:8
    ds_read_b64_tr_b16 a[226:227], v77 offset:4104
    ds_read_b64_tr_b16 a[228:229], v77 offset:8200
    ds_read_b64_tr_b16 a[230:231], v77 offset:12296
    s_waitcnt vmcnt(12) lgkmcnt(0)
    s_barrier
    s_add_u32 m0, s43, 110592
    s_add_u32 s41, s58, 524288
    buffer_load_dwordx4 v16, s[8:11], s41 offen offset:0 nt lds
    s_add_u32 s41, s58, 539648
    buffer_load_dwordx4 v16, s[8:11], s41 offen offset:1024 nt lds
    s_add_u32 s41, s58, 653312
    buffer_load_dwordx4 v16, s[8:11], s41 offen offset:2048 nt lds
    s_add_u32 s41, s58, 668672
    buffer_load_dwordx4 v16, s[8:11], s41 offen offset:3072 nt lds
    v_add_u32 v28, 147456, v24
    v_add_u32 v29, 147456, v25
    v_add_u32 v30, 147456, v26
    v_add_u32 v31, 147456, v27
    ds_read_b64_tr_b16 v[0:1], v28 offset:0
    ds_read_b64_tr_b16 v[2:3], v28 offset:8
    ds_read_b64_tr_b16 v[4:5], v29 offset:0
    ds_read_b64_tr_b16 v[6:7], v29 offset:8
    ds_read_b64_tr_b16 a[0:1], v30 offset:0
    ds_read_b64_tr_b16 v[8:9], v30 offset:8
    ds_read_b64_tr_b16 a[8:9], v31 offset:0
    ds_read_b64_tr_b16 v[10:11], v31 offset:8
    s_waitcnt vmcnt(12) lgkmcnt(0)
    s_barrier
    s_add_u32 m0, s43, 147456
    s_add_u32 s41, s58, 532480
    buffer_load_dwordx4 v16, s[8:11], s41 offen offset:0 nt lds
    s_add_u32 s41, s58, 547840
    buffer_load_dwordx4 v16, s[8:11], s41 offen offset:1024 nt lds
    s_add_u32 s41, s58, 661504
    buffer_load_dwordx4 v16, s[8:11], s41 offen offset:2048 nt lds
    s_add_u32 s41, s58, 676864
    buffer_load_dwordx4 v16, s[8:11], s41 offen offset:3072 nt lds
    ds_write_b64 v70, v[0:1] offset:0
    ds_write_b64 v70, v[2:3] offset:2048
    ds_write_b64 v70, v[4:5] offset:4096
    ds_write_b64 v70, v[6:7] offset:6144
    ds_write_b64 v70, v[8:9] offset:10240
    ds_write_b64 v70, v[10:11] offset:14336
    v_add_u32 v28, 0, v24
    v_add_u32 v29, 0, v25
    v_add_u32 v30, 0, v26
    v_add_u32 v31, 0, v27
    ds_read_b64_tr_b16 v[32:33], v28 offset:0
    ds_read_b64_tr_b16 v[34:35], v28 offset:8
    ds_read_b64_tr_b16 v[36:37], v29 offset:0
    ds_read_b64_tr_b16 v[38:39], v29 offset:8
    ds_read_b64_tr_b16 a[2:3], v30 offset:0
    ds_read_b64_tr_b16 v[40:41], v30 offset:8
    ds_read_b64_tr_b16 a[10:11], v31 offset:0
    ds_read_b64_tr_b16 v[42:43], v31 offset:8
    s_waitcnt vmcnt(12) lgkmcnt(0)
    s_barrier
    s_add_u32 m0, s43, 0
    s_add_u32 s41, s58, 786432
    buffer_load_dwordx4 v16, s[8:11], s41 offen offset:0 nt lds
    s_add_u32 s41, s58, 801792
    buffer_load_dwordx4 v16, s[8:11], s41 offen offset:1024 nt lds
    s_add_u32 s41, s58, 915456
    buffer_load_dwordx4 v16, s[8:11], s41 offen offset:2048 nt lds
    s_add_u32 s41, s58, 930816
    buffer_load_dwordx4 v16, s[8:11], s41 offen offset:3072 nt lds
    ds_write_b64 v70, v[32:33] offset:8
    ds_write_b64 v70, v[34:35] offset:2056
    ds_write_b64 v70, v[36:37] offset:4104
    ds_write_b64 v70, v[38:39] offset:6152
    ds_write_b64 v70, v[40:41] offset:10248
    ds_write_b64 v70, v[42:43] offset:14344
    v_add_u32 v28, 36864, v24
    v_add_u32 v29, 36864, v25
    v_add_u32 v30, 36864, v26
    v_add_u32 v31, 36864, v27
    ds_read_b64_tr_b16 v[0:1], v28 offset:0
    ds_read_b64_tr_b16 v[2:3], v28 offset:8
    ds_read_b64_tr_b16 v[4:5], v29 offset:0
    ds_read_b64_tr_b16 v[6:7], v29 offset:8
    ds_read_b64_tr_b16 a[4:5], v30 offset:0
    ds_read_b64_tr_b16 v[8:9], v30 offset:8
    ds_read_b64_tr_b16 a[12:13], v31 offset:0
    ds_read_b64_tr_b16 v[10:11], v31 offset:8
    s_waitcnt vmcnt(12) lgkmcnt(0)
    s_barrier
    s_add_u32 m0, s43, 36864
    s_add_u32 s41, s58, 794624
    buffer_load_dwordx4 v16, s[8:11], s41 offen offset:0 nt lds
    s_add_u32 s41, s58, 809984
    buffer_load_dwordx4 v16, s[8:11], s41 offen offset:1024 nt lds
    s_add_u32 s41, s58, 923648
    buffer_load_dwordx4 v16, s[8:11], s41 offen offset:2048 nt lds
    s_add_u32 s41, s58, 939008
    buffer_load_dwordx4 v16, s[8:11], s41 offen offset:3072 nt lds
    ds_write_b64 v70, v[0:1] offset:1024
    ds_write_b64 v70, v[2:3] offset:3072
    ds_write_b64 v70, v[4:5] offset:5120
    ds_write_b64 v70, v[6:7] offset:7168
    ds_write_b64 v70, v[8:9] offset:11264
    ds_write_b64 v70, v[10:11] offset:15360
    v_add_u32 v28, 73728, v24
    v_add_u32 v29, 73728, v25
    v_add_u32 v30, 73728, v26
    v_add_u32 v31, 73728, v27
    ds_read_b64_tr_b16 v[32:33], v28 offset:0
    ds_read_b64_tr_b16 v[34:35], v28 offset:8
    ds_read_b64_tr_b16 v[36:37], v29 offset:0
    ds_read_b64_tr_b16 v[38:39], v29 offset:8
    ds_read_b64_tr_b16 a[6:7], v30 offset:0
    ds_read_b64_tr_b16 v[40:41], v30 offset:8
    ds_read_b64_tr_b16 a[14:15], v31 offset:0
    ds_read_b64_tr_b16 v[42:43], v31 offset:8
    s_waitcnt vmcnt(12) lgkmcnt(0)
    s_barrier
    s_add_u32 m0, s43, 73728
    s_add_u32 s41, s59, 0
    buffer_load_dwordx4 v17, s[8:11], s41 offen offset:0 nt lds
    s_add_u32 s41, s59, 31744
    buffer_load_dwordx4 v17, s[8:11], s41 offen offset:1024 nt lds
    s_add_u32 s41, s59, 129024
    buffer_load_dwordx4 v17, s[8:11], s41 offen offset:2048 nt lds
    s_add_u32 s41, s59, 160768
    buffer_load_dwordx4 v17, s[8:11], s41 offen offset:3072 nt lds
    ds_write_b64 v70, v[32:33] offset:1032
    ds_write_b64 v70, v[34:35] offset:3080
    ds_write_b64 v70, v[36:37] offset:5128
    ds_write_b64 v70, v[38:39] offset:7176
    ds_write_b64 v70, v[40:41] offset:11272
    ds_write_b64 v70, v[42:43] offset:15368
    v_add_u32 v28, 110592, v24
    v_add_u32 v29, 110592, v25
    v_add_u32 v30, 110592, v26
    v_add_u32 v31, 110592, v27
    ds_read_b64_tr_b16 a[16:17], v28 offset:0
    ds_read_b64_tr_b16 a[24:25], v28 offset:8
    ds_read_b64_tr_b16 a[32:33], v29 offset:0
    ds_read_b64_tr_b16 a[40:41], v29 offset:8
    ds_read_b64_tr_b16 a[48:49], v30 offset:0
    ds_read_b64_tr_b16 a[56:57], v30 offset:8
    ds_read_b64_tr_b16 a[64:65], v31 offset:0
    ds_read_b64_tr_b16 a[72:73], v31 offset:8
    s_waitcnt vmcnt(12) lgkmcnt(0)
    s_barrier
    s_mov_b64 s[8:9], s[54:55]
    s_add_u32 m0, s43, 110592
    s_add_u32 s41, s58, 0
    buffer_load_dwordx4 v16, s[8:11], s41 offen offset:0 nt lds
    s_add_u32 s41, s58, 15360
    buffer_load_dwordx4 v16, s[8:11], s41 offen offset:1024 nt lds
    s_add_u32 s41, s58, 129024
    buffer_load_dwordx4 v16, s[8:11], s41 offen offset:2048 nt lds
    s_add_u32 s41, s58, 144384
    buffer_load_dwordx4 v16, s[8:11], s41 offen offset:3072 nt lds
    v_add_u32 v28, 147456, v24
    v_add_u32 v29, 147456, v25
    v_add_u32 v30, 147456, v26
    v_add_u32 v31, 147456, v27
    ds_read_b64_tr_b16 a[18:19], v28 offset:0
    ds_read_b64_tr_b16 a[26:27], v28 offset:8
    ds_read_b64_tr_b16 a[34:35], v29 offset:0
    ds_read_b64_tr_b16 a[42:43], v29 offset:8
    ds_read_b64_tr_b16 a[50:51], v30 offset:0
    ds_read_b64_tr_b16 a[58:59], v30 offset:8
    ds_read_b64_tr_b16 a[66:67], v31 offset:0
    ds_read_b64_tr_b16 a[74:75], v31 offset:8
    s_waitcnt vmcnt(12) lgkmcnt(0)
    s_barrier
    s_add_u32 m0, s43, 147456
    s_add_u32 s41, s58, 8192
    buffer_load_dwordx4 v16, s[8:11], s41 offen offset:0 nt lds
    s_add_u32 s41, s58, 23552
    buffer_load_dwordx4 v16, s[8:11], s41 offen offset:1024 nt lds
    s_add_u32 s41, s58, 137216
    buffer_load_dwordx4 v16, s[8:11], s41 offen offset:2048 nt lds
    s_add_u32 s41, s58, 152576
    buffer_load_dwordx4 v16, s[8:11], s41 offen offset:3072 nt lds
    v_add_u32 v28, 0, v24
    v_add_u32 v29, 0, v25
    v_add_u32 v30, 0, v26
    v_add_u32 v31, 0, v27
    ds_read_b64_tr_b16 a[20:21], v28 offset:0
    ds_read_b64_tr_b16 a[28:29], v28 offset:8
    ds_read_b64_tr_b16 a[36:37], v29 offset:0
    ds_read_b64_tr_b16 a[44:45], v29 offset:8
    ds_read_b64_tr_b16 a[52:53], v30 offset:0
    ds_read_b64_tr_b16 a[60:61], v30 offset:8
    ds_read_b64_tr_b16 a[68:69], v31 offset:0
    ds_read_b64_tr_b16 a[76:77], v31 offset:8
    s_waitcnt vmcnt(12) lgkmcnt(0)
    s_barrier
    s_add_u32 m0, s43, 0
    s_add_u32 s41, s58, 262144
    buffer_load_dwordx4 v16, s[8:11], s41 offen offset:0 nt lds
    s_add_u32 s41, s58, 277504
    buffer_load_dwordx4 v16, s[8:11], s41 offen offset:1024 nt lds
    s_add_u32 s41, s58, 391168
    buffer_load_dwordx4 v16, s[8:11], s41 offen offset:2048 nt lds
    s_add_u32 s41, s58, 406528
    buffer_load_dwordx4 v16, s[8:11], s41 offen offset:3072 nt lds
    v_add_u32 v28, 36864, v24
    v_add_u32 v29, 36864, v25
    v_add_u32 v30, 36864, v26
    v_add_u32 v31, 36864, v27
    ds_read_b64_tr_b16 a[22:23], v28 offset:0
    ds_read_b64_tr_b16 a[30:31], v28 offset:8
    ds_read_b64_tr_b16 a[38:39], v29 offset:0
    ds_read_b64_tr_b16 a[46:47], v29 offset:8
    ds_read_b64_tr_b16 a[54:55], v30 offset:0
    ds_read_b64_tr_b16 a[62:63], v30 offset:8
    ds_read_b64_tr_b16 a[70:71], v31 offset:0
    ds_read_b64_tr_b16 a[78:79], v31 offset:8
    s_waitcnt vmcnt(12) lgkmcnt(0)
    s_barrier
    s_add_u32 m0, s43, 36864
    s_add_u32 s41, s58, 270336
    buffer_load_dwordx4 v16, s[8:11], s41 offen offset:0 nt lds
    s_add_u32 s41, s58, 285696
    buffer_load_dwordx4 v16, s[8:11], s41 offen offset:1024 nt lds
    s_add_u32 s41, s58, 399360
    buffer_load_dwordx4 v16, s[8:11], s41 offen offset:2048 nt lds
    s_add_u32 s41, s58, 414720
    buffer_load_dwordx4 v16, s[8:11], s41 offen offset:3072 nt lds
    v_add_u32 v77, 73728, v20
    ds_read_b64_tr_b16 a[80:81], v77 offset:0
    ds_read_b64_tr_b16 a[82:83], v77 offset:4096
    ds_read_b64_tr_b16 a[84:85], v77 offset:8192
    ds_read_b64_tr_b16 a[86:87], v77 offset:12288
    ds_read_b64_tr_b16 a[88:89], v77 offset:8
    ds_read_b64_tr_b16 a[90:91], v77 offset:4104
    ds_read_b64_tr_b16 a[92:93], v77 offset:8200
    ds_read_b64_tr_b16 a[94:95], v77 offset:12296
    s_waitcnt vmcnt(12) lgkmcnt(0)
    s_barrier
    s_add_u32 m0, s43, 73728
    s_add_u32 s41, s58, 524288
    buffer_load_dwordx4 v16, s[8:11], s41 offen offset:0 nt lds
    s_add_u32 s41, s58, 539648
    buffer_load_dwordx4 v16, s[8:11], s41 offen offset:1024 nt lds
    s_add_u32 s41, s58, 653312
    buffer_load_dwordx4 v16, s[8:11], s41 offen offset:2048 nt lds
    s_add_u32 s41, s58, 668672
    buffer_load_dwordx4 v16, s[8:11], s41 offen offset:3072 nt lds
    v_add_u32 v28, 110592, v24
    v_add_u32 v29, 110592, v25
    v_add_u32 v30, 110592, v26
    v_add_u32 v31, 110592, v27
    ds_read_b64_tr_b16 a[232:233], v28 offset:0
    ds_read_b64_tr_b16 v[32:33], v28 offset:8
    ds_read_b64_tr_b16 a[240:241], v29 offset:0
    ds_read_b64_tr_b16 a[248:249], v29 offset:8
    ds_read_b64_tr_b16 v[144:145], v30 offset:0
    ds_read_b64_tr_b16 v[152:153], v30 offset:8
    ds_read_b64_tr_b16 v[160:161], v31 offset:0
    ds_read_b64_tr_b16 v[168:169], v31 offset:8
    s_waitcnt vmcnt(12) lgkmcnt(0)
    s_barrier
    s_add_u32 m0, s43, 110592
    s_add_u32 s41, s58, 532480
    buffer_load_dwordx4 v16, s[8:11], s41 offen offset:0 nt lds
    s_add_u32 s41, s58, 547840
    buffer_load_dwordx4 v16, s[8:11], s41 offen offset:1024 nt lds
    s_add_u32 s41, s58, 661504
    buffer_load_dwordx4 v16, s[8:11], s41 offen offset:2048 nt lds
    s_add_u32 s41, s58, 676864
    buffer_load_dwordx4 v16, s[8:11], s41 offen offset:3072 nt lds
    ds_write_b64 v70, v[32:33] offset:8192
    v_add_u32 v28, 147456, v24
    v_add_u32 v29, 147456, v25
    v_add_u32 v30, 147456, v26
    v_add_u32 v31, 147456, v27
    ds_read_b64_tr_b16 a[234:235], v28 offset:0
    ds_read_b64_tr_b16 v[0:1], v28 offset:8
    ds_read_b64_tr_b16 a[242:243], v29 offset:0
    ds_read_b64_tr_b16 a[250:251], v29 offset:8
    ds_read_b64_tr_b16 v[146:147], v30 offset:0
    ds_read_b64_tr_b16 v[154:155], v30 offset:8
    ds_read_b64_tr_b16 v[162:163], v31 offset:0
    ds_read_b64_tr_b16 v[170:171], v31 offset:8
    s_waitcnt vmcnt(12) lgkmcnt(0)
    s_barrier
    s_add_u32 m0, s43, 147456
    s_add_u32 s41, s58, 786432
    buffer_load_dwordx4 v16, s[8:11], s41 offen offset:0 nt lds
    s_add_u32 s41, s58, 801792
    buffer_load_dwordx4 v16, s[8:11], s41 offen offset:1024 nt lds
    s_add_u32 s41, s58, 915456
    buffer_load_dwordx4 v16, s[8:11], s41 offen offset:2048 nt lds
    s_add_u32 s41, s58, 930816
    buffer_load_dwordx4 v16, s[8:11], s41 offen offset:3072 nt lds
    ds_write_b64 v70, v[0:1] offset:8200
    v_add_u32 v28, 0, v24
    v_add_u32 v29, 0, v25
    v_add_u32 v30, 0, v26
    v_add_u32 v31, 0, v27
    ds_read_b64_tr_b16 a[236:237], v28 offset:0
    ds_read_b64_tr_b16 v[32:33], v28 offset:8
    ds_read_b64_tr_b16 a[244:245], v29 offset:0
    ds_read_b64_tr_b16 a[252:253], v29 offset:8
    ds_read_b64_tr_b16 v[148:149], v30 offset:0
    ds_read_b64_tr_b16 v[156:157], v30 offset:8
    ds_read_b64_tr_b16 v[164:165], v31 offset:0
    ds_read_b64_tr_b16 v[172:173], v31 offset:8
    s_waitcnt vmcnt(12) lgkmcnt(0)
    s_barrier
    s_add_u32 m0, s43, 0
    s_add_u32 s41, s58, 794624
    buffer_load_dwordx4 v16, s[8:11], s41 offen offset:0 nt lds
    s_add_u32 s41, s58, 809984
    buffer_load_dwordx4 v16, s[8:11], s41 offen offset:1024 nt lds
    s_add_u32 s41, s58, 923648
    buffer_load_dwordx4 v16, s[8:11], s41 offen offset:2048 nt lds
    s_add_u32 s41, s58, 939008
    buffer_load_dwordx4 v16, s[8:11], s41 offen offset:3072 nt lds
    ds_write_b64 v70, v[32:33] offset:9216
    v_add_u32 v28, 36864, v24
    v_add_u32 v29, 36864, v25
    v_add_u32 v30, 36864, v26
    v_add_u32 v31, 36864, v27
    ds_read_b64_tr_b16 a[238:239], v28 offset:0
    ds_read_b64_tr_b16 v[0:1], v28 offset:8
    ds_read_b64_tr_b16 a[246:247], v29 offset:0
    ds_read_b64_tr_b16 a[254:255], v29 offset:8
    ds_read_b64_tr_b16 v[150:151], v30 offset:0
    ds_read_b64_tr_b16 v[158:159], v30 offset:8
    ds_read_b64_tr_b16 v[166:167], v31 offset:0
    ds_read_b64_tr_b16 v[174:175], v31 offset:8
    s_waitcnt vmcnt(12) lgkmcnt(0)
    s_barrier
    s_add_u32 m0, s43, 36864
    s_add_u32 s41, s59, 0
    buffer_load_dwordx4 v17, s[8:11], s41 offen offset:0 nt lds
    s_add_u32 s41, s59, 31744
    buffer_load_dwordx4 v17, s[8:11], s41 offen offset:1024 nt lds
    s_add_u32 s41, s59, 129024
    buffer_load_dwordx4 v17, s[8:11], s41 offen offset:2048 nt lds
    s_add_u32 s41, s59, 160768
    buffer_load_dwordx4 v17, s[8:11], s41 offen offset:3072 nt lds
    ds_write_b64 v70, v[0:1] offset:9224
    v_add_u32 v28, 73728, v24
    v_add_u32 v29, 73728, v25
    v_add_u32 v30, 73728, v26
    v_add_u32 v31, 73728, v27
    ds_read_b64_tr_b16 v[176:177], v28 offset:0
    ds_read_b64_tr_b16 v[184:185], v28 offset:8
    ds_read_b64_tr_b16 v[192:193], v29 offset:0
    ds_read_b64_tr_b16 v[200:201], v29 offset:8
    ds_read_b64_tr_b16 v[208:209], v30 offset:0
    ds_read_b64_tr_b16 v[216:217], v30 offset:8
    ds_read_b64_tr_b16 v[224:225], v31 offset:0
    ds_read_b64_tr_b16 v[232:233], v31 offset:8
    s_waitcnt vmcnt(12) lgkmcnt(0)
    s_barrier
    s_mov_b64 s[8:9], s[56:57]
    s_add_u32 m0, s43, 73728
    s_add_u32 s41, s60, 128
    buffer_load_dwordx4 v18, s[8:11], s41 offen offset:0 nt lds
    s_add_u32 s41, s60, 8320
    buffer_load_dwordx4 v18, s[8:11], s41 offen offset:1024 nt lds
    s_add_u32 s41, s60, 16512
    buffer_load_dwordx4 v18, s[8:11], s41 offen offset:2048 nt lds
    s_add_u32 s41, s60, 24704
    buffer_load_dwordx4 v18, s[8:11], s41 offen offset:3072 nt lds
    v_add_u32 v28, 110592, v24
    v_add_u32 v29, 110592, v25
    v_add_u32 v30, 110592, v26
    v_add_u32 v31, 110592, v27
    ds_read_b64_tr_b16 v[178:179], v28 offset:0
    ds_read_b64_tr_b16 v[186:187], v28 offset:8
    ds_read_b64_tr_b16 v[194:195], v29 offset:0
    ds_read_b64_tr_b16 v[202:203], v29 offset:8
    ds_read_b64_tr_b16 v[210:211], v30 offset:0
    ds_read_b64_tr_b16 v[218:219], v30 offset:8
    ds_read_b64_tr_b16 v[226:227], v31 offset:0
    ds_read_b64_tr_b16 v[234:235], v31 offset:8
    s_waitcnt vmcnt(12) lgkmcnt(0)
    s_barrier
    s_add_u32 m0, s43, 110592
    s_add_u32 s41, s61, 128
    buffer_load_dwordx4 v18, s[8:11], s41 offen offset:0 nt lds
    s_add_u32 s41, s61, 8320
    buffer_load_dwordx4 v18, s[8:11], s41 offen offset:1024 nt lds
    s_add_u32 s41, s61, 16512
    buffer_load_dwordx4 v18, s[8:11], s41 offen offset:2048 nt lds
    s_add_u32 s41, s61, 24704
    buffer_load_dwordx4 v18, s[8:11], s41 offen offset:3072 nt lds
    v_add_u32 v28, 147456, v24
    v_add_u32 v29, 147456, v25
    v_add_u32 v30, 147456, v26
    v_add_u32 v31, 147456, v27
    ds_read_b64_tr_b16 v[180:181], v28 offset:0
    ds_read_b64_tr_b16 v[188:189], v28 offset:8
    ds_read_b64_tr_b16 v[196:197], v29 offset:0
    ds_read_b64_tr_b16 v[204:205], v29 offset:8
    ds_read_b64_tr_b16 v[212:213], v30 offset:0
    ds_read_b64_tr_b16 v[220:221], v30 offset:8
    ds_read_b64_tr_b16 v[228:229], v31 offset:0
    ds_read_b64_tr_b16 v[236:237], v31 offset:8
    s_waitcnt vmcnt(12) lgkmcnt(0)
    s_barrier
    s_add_u32 m0, s43, 147456
    s_add_u32 s41, s62, 128
    buffer_load_dwordx4 v18, s[8:11], s41 offen offset:0 nt lds
    s_add_u32 s41, s62, 8320
    buffer_load_dwordx4 v18, s[8:11], s41 offen offset:1024 nt lds
    s_add_u32 s41, s62, 16512
    buffer_load_dwordx4 v18, s[8:11], s41 offen offset:2048 nt lds
    s_add_u32 s41, s62, 24704
    buffer_load_dwordx4 v18, s[8:11], s41 offen offset:3072 nt lds
    v_add_u32 v28, 0, v24
    v_add_u32 v29, 0, v25
    v_add_u32 v30, 0, v26
    v_add_u32 v31, 0, v27
    ds_read_b64_tr_b16 v[182:183], v28 offset:0
    ds_read_b64_tr_b16 v[190:191], v28 offset:8
    ds_read_b64_tr_b16 v[198:199], v29 offset:0
    ds_read_b64_tr_b16 v[206:207], v29 offset:8
    ds_read_b64_tr_b16 v[214:215], v30 offset:0
    ds_read_b64_tr_b16 v[222:223], v30 offset:8
    ds_read_b64_tr_b16 v[230:231], v31 offset:0
    ds_read_b64_tr_b16 v[238:239], v31 offset:8
    s_waitcnt vmcnt(12) lgkmcnt(0)
    s_barrier
    s_add_u32 m0, s43, 0
    s_add_u32 s41, s63, 128
    buffer_load_dwordx4 v18, s[8:11], s41 offen offset:0 nt lds
    s_add_u32 s41, s63, 8320
    buffer_load_dwordx4 v18, s[8:11], s41 offen offset:1024 nt lds
    s_add_u32 s41, s63, 16512
    buffer_load_dwordx4 v18, s[8:11], s41 offen offset:2048 nt lds
    s_add_u32 s41, s63, 24704
    buffer_load_dwordx4 v18, s[8:11], s41 offen offset:3072 nt lds
    v_mov_b32 v78, v21
    v_mov_b32 v79, v22
    v_add_u32 v77, 36864, v20
    ds_read_b64_tr_b16 v[240:241], v77 offset:0
    ds_read_b64_tr_b16 v[242:243], v77 offset:4096
    ds_read_b64_tr_b16 v[244:245], v77 offset:8192
    ds_read_b64_tr_b16 v[246:247], v77 offset:12288
    ds_read_b64_tr_b16 v[248:249], v77 offset:8
    ds_read_b64_tr_b16 v[250:251], v77 offset:4104
    ds_read_b64_tr_b16 v[252:253], v77 offset:8200
    ds_read_b64_tr_b16 v[254:255], v77 offset:12296
    s_waitcnt vmcnt(12) lgkmcnt(0)
    s_barrier
    v_add_u32 v77, 73728, v79
    s_waitcnt lgkmcnt(0)
    ds_read_b64_tr_b16 v[0:1], v77 offset:0
    ds_read_b64_tr_b16 v[2:3], v77 offset:256
    ds_read_b64_tr_b16 v[4:5], v77 offset:2048
    ds_read_b64_tr_b16 v[6:7], v77 offset:2304
    ds_read_b64_tr_b16 v[8:9], v77 offset:8
    ds_read_b64_tr_b16 v[10:11], v77 offset:264
    ds_read_b64_tr_b16 v[12:13], v77 offset:2056
    ds_read_b64_tr_b16 v[14:15], v77 offset:2312
    s_waitcnt vmcnt(8) lgkmcnt(0)
    s_barrier
    v_add_u32 v77, 110592, v78
    ds_read_b64_tr_b16 v[16:17], v77 offset:0
    ds_read_b64_tr_b16 v[18:19], v77 offset:256
    ds_read_b64_tr_b16 v[20:21], v77 offset:2048
    ds_read_b64_tr_b16 v[22:23], v77 offset:2304
    ds_read_b64_tr_b16 v[24:25], v77 offset:8
    ds_read_b64_tr_b16 v[26:27], v77 offset:264
    ds_read_b64_tr_b16 v[28:29], v77 offset:2056
    ds_read_b64_tr_b16 v[30:31], v77 offset:2312
    s_waitcnt vmcnt(4) lgkmcnt(0)
    s_barrier
    v_add_u32 v77, 147456, v78
    ds_read_b64_tr_b16 v[32:33], v77 offset:0
    ds_read_b64_tr_b16 v[34:35], v77 offset:256
    ds_read_b64_tr_b16 v[36:37], v77 offset:2048
    ds_read_b64_tr_b16 v[38:39], v77 offset:2304
    ds_read_b64_tr_b16 v[40:41], v77 offset:8
    ds_read_b64_tr_b16 v[42:43], v77 offset:264
    ds_read_b64_tr_b16 v[44:45], v77 offset:2056
    ds_read_b64_tr_b16 v[46:47], v77 offset:2312
    s_waitcnt vmcnt(0) lgkmcnt(0)
    s_barrier
    v_add_u32 v77, 0, v78
    ds_read_b64_tr_b16 v[48:49], v77 offset:0
    ds_read_b64_tr_b16 v[50:51], v77 offset:256
    ds_read_b64_tr_b16 v[52:53], v77 offset:2048
    ds_read_b64_tr_b16 v[54:55], v77 offset:2304
    ds_read_b64_tr_b16 v[56:57], v77 offset:8
    ds_read_b64_tr_b16 v[58:59], v77 offset:264
    ds_read_b64_tr_b16 v[60:61], v77 offset:2056
    ds_read_b64_tr_b16 v[62:63], v77 offset:2312
    s_waitcnt lgkmcnt(0)
    s_barrier
    ds_write_b128 v70, v[0:3] offset:20480
    ds_write_b128 v70, v[4:7] offset:21504
    ds_write_b128 v70, v[8:11] offset:22528
    ds_write_b128 v70, v[12:15] offset:23552
    ds_write_b128 v70, v[16:19] offset:24576
    ds_write_b128 v70, v[20:23] offset:25600
    ds_write_b128 v70, v[24:27] offset:26624
    ds_write_b128 v70, v[28:31] offset:27648
    ds_write_b128 v70, v[32:35] offset:28672
    ds_write_b128 v70, v[36:39] offset:29696
    ds_write_b128 v70, v[40:43] offset:30720
    ds_write_b128 v70, v[44:47] offset:31744
    ds_write_b128 v70, v[48:51] offset:32768
    ds_write_b128 v70, v[52:55] offset:33792
    ds_write_b128 v70, v[56:59] offset:34816
    ds_write_b128 v70, v[60:63] offset:35840
    s_waitcnt lgkmcnt(0)
    v_bfe_u32 v60, v65, 4, 6
    v_and_b32 v61, 15, v60
    v_lshrrev_b32 v62, 4, v60
    v_mov_b32 v50, 0x3f80
    v_mov_b32 v51, 0x3f800000
    v_and_b32 v77, 1, v62
    v_lshlrev_b32 v77, 2, v77
    v_sub_u32 v77, v61, v77
    v_and_b32 v78, 3, v61
    v_lshlrev_b32 v78, 2, v78
    v_lshrrev_b32 v79, 2, v61
    v_add_u32 v78, v78, v79
    v_cmp_eq_u32 vcc, 0, v77
    s_nop 1
    v_cndmask_b32 v8, 0, v50, vcc
    v_cmp_eq_u32 vcc, 1, v77
    s_nop 1
    v_cndmask_b32 v8, v8, v51, vcc
    v_cmp_eq_u32 vcc, 0, v78
    s_nop 1
    v_cndmask_b32 v12, 0, v50, vcc
    v_cmp_eq_u32 vcc, 1, v78
    s_nop 1
    v_cndmask_b32 v12, v12, v51, vcc
    v_cmp_eq_u32 vcc, 2, v77
    s_nop 1
    v_cndmask_b32 v9, 0, v50, vcc
    v_cmp_eq_u32 vcc, 3, v77
    s_nop 1
    v_cndmask_b32 v9, v9, v51, vcc
    v_cmp_eq_u32 vcc, 2, v78
    s_nop 1
    v_cndmask_b32 v13, 0, v50, vcc
    v_cmp_eq_u32 vcc, 3, v78
    s_nop 1
    v_cndmask_b32 v13, v13, v51, vcc
    v_cmp_eq_u32 vcc, 8, v77
    s_nop 1
    v_cndmask_b32 v10, 0, v50, vcc
    v_cmp_eq_u32 vcc, 9, v77
    s_nop 1
    v_cndmask_b32 v10, v10, v51, vcc
    v_cmp_eq_u32 vcc, 4, v78
    s_nop 1
    v_cndmask_b32 v14, 0, v50, vcc
    v_cmp_eq_u32 vcc, 5, v78
    s_nop 1
    v_cndmask_b32 v14, v14, v51, vcc
    v_cmp_eq_u32 vcc, 10, v77
    s_nop 1
    v_cndmask_b32 v11, 0, v50, vcc
    v_cmp_eq_u32 vcc, 11, v77
    s_nop 1
    v_cndmask_b32 v11, v11, v51, vcc
    v_cmp_eq_u32 vcc, 6, v78
    s_nop 1
    v_cndmask_b32 v15, 0, v50, vcc
    v_cmp_eq_u32 vcc, 7, v78
    s_nop 1
    v_cndmask_b32 v15, v15, v51, vcc
    v_lshlrev_b32 v77, 4, v61
    ds_write_b128 v69, v[8:11] offset:15360
    ds_write_b128 v77, v[12:15] offset:15872
    s_waitcnt vmcnt(0) lgkmcnt(0)
    s_barrier
    v_mov_b32 v2, 1
    s_cmp_lg_u32 s13, 0
    s_cbranch_scc1 cs_noarr
    s_mov_b64 exec, 1
    buffer_atomic_add v2, off, s[84:87], 0 offset:212
    s_mov_b32 s40, 16777216
    s_mov_b32 s42, 2
cs_startpoll:
    buffer_load_dword v3, off, s[84:87], 0 offset:212 sc1
    s_sub_u32 s40, s40, 1
    s_cbranch_scc1 cs_decide
    s_waitcnt vmcnt(0)
    v_readfirstlane_b32 s41, v3
    s_nop 1
    s_cmp_lt_u32 s41, 32
    s_cbranch_scc1 cs_startpoll
    s_mov_b32 s42, 1
cs_decide:
    s_mov_b64 exec, -1
cs_noarr:
    s_barrier
    s_mov_b32 s44, 0x3e0293ee
    s_mov_b32 s45, s44
    s_or_b32 s66, s44, 0x80000000
    s_mov_b32 s48, 0x3f003f00
    s_mov_b32 s49, 0
    s_mov_b32 s50, 0x3f803f80
    s_mov_b32 s51, 0x3f803f80
    s_mov_b32 s52, 512
    s_mov_b32 s53, 1024
    s_mov_b32 s54, 1536
    s_mov_b32 s30, 0
    s_mov_b32 s37, 0
    s_lshl_b32 s47, s13, 9
    s_cmp_lg_u32 s32, 0
    s_cselect_b32 s71, s13, 3
    s_add_u32 s46, s71, 1
    s_lshr_b32 s46, s46, 1
    s_mov_b32 s14, 67649536
    s_mov_b32 s15, 67653632
    s_mov_b32 s16, 67657728
    s_mov_b32 s36, 0
    s_add_u32 s17, s68, 67633152
    s_mov_b32 s69, 0
    s_mov_b32 s70, 0
    s_lshl_b32 s26, s12, 14
    s_add_u32 s26, s26, 0
    s_mul_i32 s40, s13, 3072
    s_add_u32 s24, s26, s40
    s_lshl_b32 s96, s12, 7
    s_add_u32 s29, s96, 125845504
    s_add_u32 s96, s96, 125829120
    s_lshl_b32 s40, s12, 14
    s_add_u32 s40, s40, 68681728
    s_add_u32 s18, s40, 0
    s_add_u32 s19, s40, 4096
    s_add_u32 s20, s40, 8192
    s_add_u32 s21, s40, 12288
    s_lshr_b32 s40, s12, 3
    s_lshl_b32 s40, s40, 12
    s_and_b32 s41, s12, 7
    s_lshl_b32 s41, s41, 7
    s_add_u32 s40, s40, s41
    s_add_u32 s22, s40, 68681728
    s_add_u32 s23, s22, 1024
    s_add_u32 s25, s22, 2048
    s_mov_b32 s56, -65528
    s_cmp_lg_u32 s32, 0
    s_cselect_b64 s[38:39], -1, 0
    s_add_u32 s55, s68, 138412032
    s_cmp_eq_u32 s13, 3
    s_cselect_b64 s[100:101], 1, 0
    s_cselect_b64 s[38:39], 1, s[38:39]
    s_cselect_b32 s93, 64, 0
    s_cselect_b32 s55, s29, s55
    s_cselect_b32 s57, 0, 9216
    s_mov_b64 exec, s[100:101]
    v_mov_b32 v72, s95
    s_mov_b64 exec, -1
    s_mov_b32 s34, 0xff00ff00
    s_mov_b32 s35, 0xff00ff00
    s_lshl_b32 s28, s12, 12
    s_add_u32 s28, s28, 7602176
    s_add_u32 s27, s28, 77594624
    s_add_u32 s28, s28, 69206016
    s_mov_b32 s40, 3
    v_bfe_u32 v78, v65, 2, 5
    s_mov_b32 s31, 4194304
cs_kv0:
    buffer_load_dword v77, v78, s[4:7], s96 offen offset:16 sc1
    s_waitcnt vmcnt(0)
    v_subrev_u32 v77, s95, v77
    v_cmp_lt_u32 vcc, 16, v77
    s_nop 1
    v_cndmask_b32 v77, v77, 0, vcc
    v_bfe_u32 v79, v78, 2, 2
    v_lshl_add_u32 v77, v77, 2, v79
    s_nop 1
    v_min_u32_dpp v77, v77, v77 row_ror:1 row_mask:0xf bank_mask:0xf
    s_nop 1
    v_min_u32_dpp v77, v77, v77 row_ror:2 row_mask:0xf bank_mask:0xf
    s_nop 1
    v_min_u32_dpp v77, v77, v77 row_ror:4 row_mask:0xf bank_mask:0xf
    s_nop 0
    v_readfirstlane_b32 s97, v77
    s_sub_u32 s31, s31, 1
    s_cbranch_scc1 cs_kv0_x
    s_cmp_le_u32 s40, s97
    s_cbranch_scc1 cs_kv0_x
    s_sleep 2
    s_branch cs_kv0
cs_kv0_x:
    s_add_u32 s40, s24, 0
    s_add_u32 s40, s40, s33
    s_sub_u32 s41, s96, s40
    v_bfe_u32 v77, v65, 2, 5
    v_add3_u32 v77, v77, s41, 16
    v_lshlrev_b32 v78, 3, v69
    s_nop 0
    v_mov_b32_dpp v78, v77 quad_perm:[0,1,2,3] row_mask:0xc bank_mask:0xf
    buffer_load_dword v76, v78, s[4:7], s40 offen sc1
    s_add_u32 s40, s24, 524288
    s_add_u32 s40, s40, s33
    s_sub_u32 s41, s96, s40
    v_bfe_u32 v77, v65, 2, 5
    v_add3_u32 v77, v77, s41, 16
    v_lshlrev_b32 v78, 3, v69
    s_nop 0
    v_mov_b32_dpp v78, v77 quad_perm:[0,1,2,3] row_mask:0xc bank_mask:0xf
    buffer_load_dword v76, v78, s[4:7], s40 offen sc1
cs_kvdone:
    v_mov_b64 v[0:1], 0
    v_mov_b64 v[2:3], 0
    v_mov_b64 v[4:5], 0
    v_mov_b64 v[6:7], 0
    v_mov_b64 v[8:9], 0
    v_mov_b64 v[10:11], 0
    v_mov_b64 v[12:13], 0
    v_mov_b64 v[14:15], 0
    v_mov_b64 v[16:17], 0
    v_mov_b64 v[18:19], 0
    v_mov_b64 v[20:21], 0
    v_mov_b64 v[22:23], 0
    ds_read_b128 v[44:47], v70 offset:0
    ds_read_b128 v[48:51], v70 offset:1024
    ds_read_b128 v[52:55], v70 offset:2048
    ds_read_b128 v[56:59], v70 offset:3072
    ds_read_b128 v[24:27], v70 offset:4096
    ds_read_b128 v[28:31], v70 offset:5120
    ds_read_b128 v[32:35], v70 offset:6144
    ds_read_b128 v[36:39], v70 offset:7168
    buffer_load_dwordx4 v[40:43], v65, s[4:7], s14 offen offset:0 sc1
    buffer_load_dwordx4 v[60:63], v66, s[4:7], s14 offen offset:0 sc1
    s_mov_b32 s31, 1048576
    s_waitcnt vmcnt(0) lgkmcnt(0)
    s_branch cs_goA
cs_loop:
    s_mov_b32 s31, 1048576
    s_mov_b32 s69, s70
    s_waitcnt lgkmcnt(0)
cs_cA:
    buffer_load_dwordx4 v[40:43], v65, s[4:7], s14 offen offset:0 sc1
    buffer_load_dwordx4 v[60:63], v66, s[4:7], s14 offen offset:0 sc1
cs_cA1:
    v_bitop3_b32 v77, v40, v60, s70 bitop3:0x7e
    v_and_b32 v77, 1, v77
    v_cmp_ne_u32 vcc, 0, v77
    s_cbranch_vccz cs_goA
    s_nop 15
    s_nop 15
    s_nop 7
    v_bitop3_b32 v77, v40, v60, s70 bitop3:0x7e
    v_and_b32 v77, 1, v77
    v_cmp_ne_u32 vcc, 0, v77
    s_cbranch_vccz cs_goA
    s_nop 15
    s_nop 15
    s_nop 7
    v_bitop3_b32 v77, v40, v60, s70 bitop3:0x7e
    v_and_b32 v77, 1, v77
    v_cmp_ne_u32 vcc, 0, v77
    s_cbranch_vccz cs_goA
    s_nop 15
    s_nop 15
    s_nop 7
    v_bitop3_b32 v77, v40, v60, s70 bitop3:0x7e
    v_and_b32 v77, 1, v77
    v_cmp_ne_u32 vcc, 0, v77
    s_cbranch_vccz cs_goA
    s_nop 15
    s_nop 15
    s_nop 7
    v_bitop3_b32 v77, v40, v60, s70 bitop3:0x7e
    v_and_b32 v77, 1, v77
    v_cmp_ne_u32 vcc, 0, v77
    s_cbranch_vccz cs_goA
    s_nop 15
    s_nop 15
    s_nop 7
    buffer_load_dwordx4 v[40:43], v65, s[4:7], s14 offen offset:0 sc1
    buffer_load_dwordx4 v[60:63], v66, s[4:7], s14 offen offset:0 sc1
    v_bitop3_b32 v77, v40, v60, s70 bitop3:0x7e
    v_and_b32 v77, 1, v77
    v_cmp_ne_u32 vcc, 0, v77
    s_cbranch_vccz cs_goA
    s_nop 15
    s_nop 15
    s_nop 7
    v_bitop3_b32 v77, v40, v60, s70 bitop3:0x7e
    v_and_b32 v77, 1, v77
    v_cmp_ne_u32 vcc, 0, v77
    s_cbranch_vccz cs_goA
    s_nop 15
    s_nop 15
    s_nop 7
    v_bitop3_b32 v77, v40, v60, s70 bitop3:0x7e
    v_and_b32 v77, 1, v77
    v_cmp_ne_u32 vcc, 0, v77
    s_cbranch_vccz cs_goA
    s_nop 15
    s_nop 15
    s_nop 7
    v_bitop3_b32 v77, v40, v60, s70 bitop3:0x7e
    v_and_b32 v77, 1, v77
    v_cmp_ne_u32 vcc, 0, v77
    s_cbranch_vccz cs_goA
    s_nop 15
    s_nop 15
    s_nop 7
    v_bitop3_b32 v77, v40, v60, s70 bitop3:0x7e
    v_and_b32 v77, 1, v77
    v_cmp_ne_u32 vcc, 0, v77
    s_cbranch_vccz cs_goA
    s_nop 15
    s_nop 15
    s_nop 7
    buffer_load_dwordx4 v[40:43], v65, s[4:7], s14 offen offset:0 sc1
    buffer_load_dwordx4 v[60:63], v66, s[4:7], s14 offen offset:0 sc1
    v_bitop3_b32 v77, v40, v60, s70 bitop3:0x7e
    v_and_b32 v77, 1, v77
    v_cmp_ne_u32 vcc, 0, v77
    s_cbranch_vccz cs_goA
    s_nop 15
    s_nop 15
    s_nop 7
    v_bitop3_b32 v77, v40, v60, s70 bitop3:0x7e
    v_and_b32 v77, 1, v77
    v_cmp_ne_u32 vcc, 0, v77
    s_cbranch_vccz cs_goA
    s_nop 15
    s_nop 15
    s_nop 7
    v_bitop3_b32 v77, v40, v60, s70 bitop3:0x7e
    v_and_b32 v77, 1, v77
    v_cmp_ne_u32 vcc, 0, v77
    s_cbranch_vccz cs_goA
    s_nop 15
    s_nop 15
    s_nop 7
    v_bitop3_b32 v77, v40, v60, s70 bitop3:0x7e
    v_and_b32 v77, 1, v77
    v_cmp_ne_u32 vcc, 0, v77
    s_cbranch_vccz cs_goA
    s_nop 15
    s_nop 15
    s_nop 7
    v_bitop3_b32 v77, v40, v60, s70 bitop3:0x7e
    v_and_b32 v77, 1, v77
    v_cmp_ne_u32 vcc, 0, v77
    s_cbranch_vccz cs_goA
    s_nop 15
    s_nop 15
    s_nop 7
    buffer_load_dwordx4 v[40:43], v65, s[4:7], s14 offen offset:0 sc1
    buffer_load_dwordx4 v[60:63], v66, s[4:7], s14 offen offset:0 sc1
    v_bitop3_b32 v77, v40, v60, s70 bitop3:0x7e
    v_and_b32 v77, 1, v77
    v_cmp_ne_u32 vcc, 0, v77
    s_cbranch_vccz cs_goA
    s_nop 15
    s_nop 15
    s_nop 7
    v_bitop3_b32 v77, v40, v60, s70 bitop3:0x7e
    v_and_b32 v77, 1, v77
    v_cmp_ne_u32 vcc, 0, v77
    s_cbranch_vccz cs_goA
    s_nop 15
    s_nop 15
    s_nop 7
    v_bitop3_b32 v77, v40, v60, s70 bitop3:0x7e
    v_and_b32 v77, 1, v77
    v_cmp_ne_u32 vcc, 0, v77
    s_cbranch_vccz cs_goA
    s_nop 15
    s_nop 15
    s_nop 7
    v_bitop3_b32 v77, v40, v60, s70 bitop3:0x7e
    v_and_b32 v77, 1, v77
    v_cmp_ne_u32 vcc, 0, v77
    s_cbranch_vccz cs_goA
    s_nop 15
    s_nop 15
    s_nop 7
    v_bitop3_b32 v77, v40, v60, s70 bitop3:0x7e
    v_and_b32 v77, 1, v77
    v_cmp_ne_u32 vcc, 0, v77
    s_cbranch_vccz cs_goA
    s_nop 15
    s_nop 15
    s_nop 7
    s_sub_u32 s31, s31, 64
    s_cbranch_scc0 cs_cA
cs_goA:
    ds_write_b128 v65, v[40:43] offset:0
    v_smfmac_f32_16x16x64_bf16 v[0:3], v[40:43], v[44:51], v64
    v_smfmac_f32_16x16x64_bf16 v[4:7], v[40:43], v[52:59], v64
    buffer_load_dwordx4 v[44:47], v65, s[4:7], s15 offen offset:0 sc1
    v_smfmac_f32_16x16x64_bf16 v[0:3], v[60:63], v[24:31], v64
    s_add_u32 s40, s24, 1048576
    s_add_u32 s40, s40, s33
    s_sub_u32 s41, s96, s40
    v_smfmac_f32_16x16x64_bf16 v[4:7], v[60:63], v[32:39], v64
    ds_read_b128 v[24:27], v70 offset:8192
    s_cmp_lt_u32 s97, s93
    s_cselect_b32 s41, s41, 0
    v_smfmac_f32_16x16x64_bf16 v[8:11], v[40:43], a[96:103], v64
    ds_read_b128 v[28:31], v70 offset:9216
    v_smfmac_f32_16x16x64_bf16 v[12:15], v[40:43], a[104:111], v64
    ds_read_b128 v[32:35], v70 offset:10240
    s_waitcnt lgkmcnt(3)
    s_barrier
    ds_read_b128 v[48:51], v67 offset:0
    v_smfmac_f32_16x16x64_bf16 v[8:11], v[60:63], a[112:119], v64
    ds_read_b128 v[36:39], v70 offset:11264
    v_bitop3_b32 v79, v73, -9, s54 bitop3:0x6a
    v_smfmac_f32_16x16x64_bf16 v[12:15], v[60:63], a[120:127], v64
    ds_read_b128 v[52:55], v68 offset:0
    v_bfe_u32 v77, v65, 2, 5
    v_smfmac_f32_16x16x64_bf16 v[16:19], v[40:43], a[232:239], v64
    buffer_load_dwordx4 v[44:47], v65, s[4:7], s15 offen offset:0 sc1
    s_waitcnt lgkmcnt(4)
    v_smfmac_f32_16x16x64_bf16 v[20:23], v[40:43], v[24:31], v64
    ds_read_b128 v[24:27], v70 offset:12288
    s_waitcnt lgkmcnt(3)
    v_smfmac_f32_16x16x64_bf16 v[0:3], v[48:51], a[0:7], v64
    ds_read_b128 v[28:31], v70 offset:13312
    s_waitcnt lgkmcnt(3)
    v_smfmac_f32_16x16x64_bf16 v[4:7], v[48:51], v[32:39], v64
    ds_read_b128 v[32:35], v70 offset:14336
    v_add3_u32 v77, v77, s41, 16
    v_smfmac_f32_16x16x64_bf16 v[16:19], v[60:63], a[240:247], v64
    ds_read_b128 v[36:39], v70 offset:15360
    v_lshlrev_b32 v78, 3, v69
    v_smfmac_f32_16x16x64_bf16 v[20:23], v[60:63], a[248:255], v64
    buffer_load_dwordx4 v[40:43], v65, s[4:7], s16 offen offset:0 sc1
    v_smfmac_f32_16x16x64_bf16 v[8:11], v[48:51], a[128:135], v64
    v_mov_b32_dpp v78, v77 quad_perm:[0,1,2,3] row_mask:0xc bank_mask:0xf
    v_smfmac_f32_16x16x64_bf16 v[12:15], v[48:51], a[136:143], v64
    s_waitcnt lgkmcnt(2)
    s_waitcnt vmcnt(2)
    v_and_b32 v77, s36, v44
    v_smfmac_f32_16x16x64_bf16 v[12:15], v[52:55], v[24:31], v64
    ds_write_b128 v65, v[44:47] offset:4096
    v_smfmac_f32_16x16x64_bf16 v[0:3], v[52:55], a[8:15], v64
    buffer_load_dwordx4 v[58:61], v65, s[4:7], s24 offen offset:3072 sc1
    s_waitcnt lgkmcnt(1)
    v_cmp_ne_u32 vcc, s70, v77
    v_smfmac_f32_16x16x64_bf16 v[4:7], v[52:55], v[32:39], v64
    v_smfmac_f32_16x16x64_bf16 v[8:11], v[52:55], a[144:151], v64
    s_cbranch_vccnz cs_spinB
cs_backB:
    v_smfmac_f32_16x16x64_bf16 v[16:19], v[44:47], v[176:183], v64
    buffer_load_dwordx4 v[24:27], v65, s[4:7], s24 offen offset:0 sc1
    s_waitcnt lgkmcnt(0)
    s_barrier
    ds_read_b128 v[48:51], v66 offset:4096
    v_smfmac_f32_16x16x64_bf16 v[12:15], v[44:47], a[160:167], v64
    ds_read_b128 v[52:55], v67 offset:4096
    v_smfmac_f32_16x16x64_bf16 v[0:3], v[44:47], a[16:23], v64
    buffer_load_dwordx4 v[28:31], v65, s[4:7], s24 offen offset:1024 sc1
    v_smfmac_f32_16x16x64_bf16 v[8:11], v[44:47], a[152:159], v64
    v_smfmac_f32_16x16x64_bf16 v[4:7], v[44:47], a[24:31], v64
    s_waitcnt vmcnt(4)
    v_smfmac_f32_16x16x64_bf16 v[20:23], v[44:47], v[184:191], v64
    ds_read_b128 v[44:47], v68 offset:4096
    s_waitcnt lgkmcnt(2)
    v_smfmac_f32_16x16x64_bf16 v[0:3], v[48:51], a[32:39], v64
    buffer_load_dwordx4 v[34:37], v65, s[4:7], s24 offen offset:2048 sc1
    v_smfmac_f32_16x16x64_bf16 v[8:11], v[48:51], a[168:175], v64
    v_smfmac_f32_16x16x64_bf16 v[4:7], v[48:51], a[40:47], v64
    v_smfmac_f32_16x16x64_bf16 v[12:15], v[48:51], a[176:183], v64
    ds_read_b128 v[48:51], v69 offset:15360
    s_waitcnt lgkmcnt(1)
    v_smfmac_f32_16x16x64_bf16 v[0:3], v[52:55], a[48:55], v64
    buffer_load_dword v76, v78, s[4:7], s40 offen sc1
    s_waitcnt vmcnt(5)
    v_and_b32 v77, s36, v40
    v_smfmac_f32_16x16x64_bf16 v[8:11], v[52:55], a[184:191], v64
    v_cmp_ne_u32 vcc, s70, v77
    v_smfmac_f32_16x16x64_bf16 v[0:3], v[44:47], a[64:71], v64
    v_smfmac_f32_16x16x64_bf16 v[8:11], v[44:47], a[200:207], v64
    s_cbranch_vccnz cs_spin8
cs_back8:
    v_smfmac_f32_16x16x64_bf16 v[0:3], v[40:43], a[80:87], v64
    s_nop 1
    v_smfmac_f32_16x16x64_bf16 v[8:11], v[40:43], a[216:223], v64
    s_nop 1
    v_lshrrev_b32 v77, 1, v69
    v_smfmac_f32_16x16x64_bf16 v[4:7], v[52:55], a[56:63], v64
    s_nop 1
    v_cvt_pk_bf16_f32 v0, v0, v1
    v_smfmac_f32_16x16x64_bf16 v[12:15], v[52:55], a[192:199], v64
    s_nop 1
    v_cvt_pk_bf16_f32 v1, v2, v3
    v_smfmac_f32_16x16x64_bf16 v[4:7], v[44:47], a[72:79], v64
    s_nop 1
    v_cvt_pk_bf16_f32 v2, v8, v9
    v_smfmac_f32_16x16x64_bf16 v[12:15], v[44:47], a[208:215], v64
    s_nop 1
    v_cvt_pk_bf16_f32 v3, v10, v11
    v_smfmac_f32_16x16x64_bf16 v[4:7], v[40:43], a[88:95], v64
    s_waitcnt lgkmcnt(0)
    s_nop 1
    v_smfmac_f32_16x16x64_bf16 v[12:15], v[40:43], a[224:231], v64
    s_nop 1
    v_mfma_f32_16x16x32_bf16 v[8:11], v[0:3], v[48:51], 0
    s_nop 0
    v_cvt_pk_bf16_f32 v4, v4, v5
    v_cvt_pk_bf16_f32 v5, v6, v7
    s_nop 1
    v_cvt_pk_bf16_f32 v6, v12, v13
    v_cvt_pk_bf16_f32 v7, v14, v15
    s_nop 1
    v_mfma_f32_16x16x32_bf16 v[12:15], v[4:7], v[48:51], 0
    ds_read_b128 v[48:51], v66 offset:4096
    v_cvt_pk_bf16_f32 v0, v8, v9
    v_cvt_pk_bf16_f32 v1, v10, v11
    v_smfmac_f32_16x16x64_bf16 v[16:19], v[52:55], v[208:215], v64
    s_waitcnt vmcnt(2)
    s_nop 2
    v_cvt_pk_bf16_f32 v2, v12, v13
    v_cvt_pk_bf16_f32 v3, v14, v15
    s_nop 1
    v_mfma_f32_16x16x32_bf16 v[12:15], v[0:3], v[0:3], 0
    s_nop 1
    v_bitop3_b32 v78, v73, -9, s53 bitop3:0x6a
    v_mfma_f32_16x16x32_bf16 v[4:7], v[24:27], v[0:3], 0
    ds_read_b128 v[24:27], v67 offset:0
    s_nop 1
    v_mfma_f32_16x16x32_bf16 v[8:11], v[28:31], v[0:3], 0
    s_nop 0
    v_mov_b32_dpp v12, v14 row_ror:8 row_mask:0xf bank_mask:0xc
    v_mov_b32_dpp v13, v15 row_ror:8 row_mask:0xf bank_mask:0xc
    v_smfmac_f32_16x16x64_bf16 v[20:23], v[52:55], v[216:223], v64
    ds_write_b64 v71, v[12:13]
    ds_read_b128 v[52:55], v68 offset:0
    s_nop 1
    v_mov_b32_dpp v4, v8 row_ror:8 row_mask:0xf bank_mask:0xc
    v_mov_b32_dpp v5, v9 row_ror:8 row_mask:0xf bank_mask:0xc
    v_mov_b32_dpp v6, v10 row_ror:8 row_mask:0xf bank_mask:0xc
    v_mov_b32_dpp v7, v11 row_ror:8 row_mask:0xf bank_mask:0xc
    v_smfmac_f32_16x16x64_bf16 v[16:19], v[44:47], v[224:231], v64
    ds_write_b128 v65, v[4:7] offset:8192
    v_smfmac_f32_16x16x64_bf16 v[20:23], v[44:47], v[232:239], v64
    s_waitcnt lgkmcnt(3)
    v_smfmac_f32_16x16x64_bf16 v[16:19], v[24:27], v[144:151], v64
    s_waitcnt vmcnt(1)
    v_smfmac_f32_16x16x64_bf16 v[20:23], v[24:27], v[152:159], v64
    s_mov_b64 exec, s[38:39]
    buffer_store_dword v72, v75, s[4:7], s55 offen sc1
    s_mov_b64 exec, -1
    v_smfmac_f32_16x16x64_bf16 v[16:19], v[40:43], v[240:247], v64
    s_cmp_ge_u32 s30, 58
    s_waitcnt lgkmcnt(0)
    s_barrier
    ds_read_b128 v[8:11], v66 offset:8192
    v_smfmac_f32_16x16x64_bf16 v[20:23], v[40:43], v[248:255], v64
    ds_read_b128 v[12:15], v67 offset:8192
    v_smfmac_f32_16x16x64_bf16 v[16:19], v[48:51], v[192:199], v64
    ds_read_b128 v[44:47], v68 offset:8192
    v_smfmac_f32_16x16x64_bf16 v[20:23], v[48:51], v[200:207], v64
    ds_read_b64 v[24:25], v77 offset:14336
    ds_read_b64 v[26:27], v77 offset:14592
    v_smfmac_f32_16x16x64_bf16 v[16:19], v[52:55], v[160:167], v64
    ds_read_b64 v[28:29], v77 offset:14848
    ds_read_b64 v[30:31], v77 offset:15104
    v_bitop3_b32 v77, v73, -9, s52 bitop3:0x6a
    v_smfmac_f32_16x16x64_bf16 v[20:23], v[52:55], v[168:175], v64
    s_cbranch_scc1 cs_rare
cs_rare_x:
    ds_read_b128 v[48:51], v70 offset:22528
    ds_read_b128 v[52:55], v70 offset:23552
    s_waitcnt lgkmcnt(6)
    v_pk_add_f32 v[4:5], v[4:5], v[8:9]
    v_pk_add_f32 v[6:7], v[6:7], v[10:11]
    v_pk_add_f32 v[12:13], v[12:13], v[44:45]
    v_pk_add_f32 v[14:15], v[14:15], v[46:47]
    v_pk_add_f32 v[4:5], v[4:5], v[12:13]
    v_pk_add_f32 v[6:7], v[6:7], v[14:15]
    s_waitcnt lgkmcnt(2)
    v_pk_add_f32 v[24:25], v[24:25], v[26:27]
    v_pk_add_f32 v[28:29], v[28:29], v[30:31]
    v_max3_f32 v8, v4, v5, v6
    v_pk_add_f32 v[24:25], v[24:25], v[28:29]
    v_max_f32 v8, v8, v7
    v_max3_f32 v8, v8, v24, v25
    v_cvt_pk_bf16_f32 v32, v16, v17
    v_cvt_pk_bf16_f32 v38, v18, v19
    v_max_f32_dpp v8, v8, v8 row_ror:8 row_mask:0xf bank_mask:0xf
    v_mov_b32 v9, v8
    v_cvt_pk_bf16_f32 v56, v20, v21
    v_cvt_pk_bf16_f32 v62, v22, v23
    v_permlane32_swap_b32 v8, v9
    v_max_f32 v8, v8, v9
    v_mov_b32 v9, v8
    v_mov_b32 v11, 0
    v_mov_b32 v15, 0
    v_permlane16_swap_b32 v8, v9
    v_max_f32 v8, v8, v9
    v_mul_f32 v8, s66, v8
    v_pk_fma_f32 v[4:5], v[4:5], s[44:45], v[8:9] op_sel_hi:[1,1,0]
    v_pk_fma_f32 v[6:7], v[6:7], s[44:45], v[8:9] op_sel_hi:[1,1,0]
    v_pk_fma_f32 v[24:25], v[24:25], s[44:45], v[8:9] op_sel_hi:[1,1,0]
    v_exp_f32 v4, v4
    v_exp_f32 v5, v5
    v_exp_f32 v6, v6
    v_exp_f32 v7, v7
    v_exp_f32 v24, v24
    v_exp_f32 v25, v25
    v_cvt_pk_bf16_f32 v12, v4, v5
    v_cvt_pk_bf16_f32 v13, v6, v7
    v_cvt_pk_bf16_f32 v10, v24, v25
    v_cvt_pk_bf16_f32 v14, v24, v25
    v_mov_b64 v[0:1], s[48:49]
    v_mfma_f32_16x16x32_bf16 v[4:7], v[32:35], v[10:13], 0
    ds_read_b128 v[40:43], v70 offset:20480
    v_mov_b64 v[2:3], s[50:51]
    v_mfma_f32_16x16x32_bf16 v[24:27], v[36:39], v[12:15], 0
    ds_read_b128 v[44:47], v70 offset:21504
    v_mov_b64 v[8:9], 0
    v_mfma_f32_16x16x32_bf16 v[28:31], v[0:3], v[10:13], 0
    ds_read_b128 v[32:35], v70 offset:24576
    v_mov_b64 v[0:1], 0
    v_mfma_f32_16x16x32_bf16 v[16:19], v[56:59], v[10:13], 0
    ds_read_b128 v[36:39], v70 offset:25600
    v_mov_b64 v[2:3], 0
    v_mfma_f32_16x16x32_bf16 v[20:23], v[60:63], v[12:15], 0
    ds_read_b128 v[56:59], v70 offset:26624
    v_add_f32_dpp v4, v24, v4 row_ror:8 row_mask:0xf bank_mask:0xf
    v_add_f32_dpp v5, v25, v5 row_ror:8 row_mask:0xf bank_mask:0xf
    v_add_f32_dpp v6, v26, v6 row_ror:8 row_mask:0xf bank_mask:0xf
    v_add_f32_dpp v7, v27, v7 row_ror:8 row_mask:0xf bank_mask:0xf
    v_add_f32_dpp v29, v28, v28 row_ror:8 row_mask:0xf bank_mask:0xf
    v_rcp_f32 v28, v29
    v_mov_b64 v[10:11], 0
    v_add_f32_dpp v4, v16, v20 row_ror:8 row_mask:0xf bank_mask:0xc
    v_add_f32_dpp v5, v17, v21 row_ror:8 row_mask:0xf bank_mask:0xc
    v_add_f32_dpp v6, v18, v22 row_ror:8 row_mask:0xf bank_mask:0xc
    v_add_f32_dpp v7, v19, v23 row_ror:8 row_mask:0xf bank_mask:0xc
    v_pk_mul_f32 v[4:5], v[4:5], v[28:29] op_sel_hi:[1,0]
    v_pk_mul_f32 v[6:7], v[6:7], v[28:29] op_sel_hi:[1,0]
    v_cvt_pk_bf16_f32 v4, v4, v5
    v_cvt_pk_bf16_f32 v5, v6, v7
    ds_write_b64 v73, v[4:5] offset:12288
    v_mov_b32_dpp v6, v4 row_ror:8 row_mask:0xf bank_mask:0xf
    v_mov_b32_dpp v7, v5 row_ror:8 row_mask:0xf bank_mask:0xf
    v_mov_b64 v[12:13], 0
    v_mov_b64 v[14:15], 0
    v_smfmac_f32_16x16x64_bf16 v[8:11], v[4:7], v[80:87], v64
    s_waitcnt lgkmcnt(4)
    v_mov_b64 v[24:25], 0
    v_smfmac_f32_16x16x64_bf16 v[0:3], v[4:7], v[40:47], v64
    ds_read_b128 v[60:63], v70 offset:27648
    v_mov_b64 v[26:27], 0
    v_smfmac_f32_16x16x64_bf16 v[12:15], v[4:7], v[112:119], v64
    s_waitcnt lgkmcnt(1)
    s_barrier
    ds_read_b128 v[16:19], v77 offset:12288
    v_smfmac_f32_16x16x64_bf16 v[24:27], v[4:7], v[48:55], v64
    ds_read_b128 v[20:23], v78 offset:12288
    ds_read_b128 v[28:31], v79 offset:12288
    v_mov_b64 v[4:5], 0
    v_mov_b64 v[6:7], 0
    v_bfe_u32 v77, v74, 16, 1
    v_mad_i32_i24 v77, v77, s56, v74
    s_waitcnt lgkmcnt(2)
    v_smfmac_f32_16x16x64_bf16 v[8:11], v[16:19], v[88:95], v64
    ds_read_b128 v[48:51], v70 offset:28672
    v_and_b32 v72, 8, v73
    v_smfmac_f32_16x16x64_bf16 v[12:15], v[16:19], v[120:127], v64
    ds_read_b128 v[52:55], v70 offset:29696
    s_waitcnt lgkmcnt(3)
    v_mad_u32_u24 v72, v72, 63, v73
    v_smfmac_f32_16x16x64_bf16 v[8:11], v[20:23], v[96:103], v64
    ds_read_b128 v[40:43], v70 offset:30720
    v_subrev_u32 v72, s47, v72
    v_smfmac_f32_16x16x64_bf16 v[12:15], v[20:23], v[128:135], v64
    ds_read_b128 v[44:47], v70 offset:31744
    s_waitcnt lgkmcnt(4)
    v_smfmac_f32_16x16x64_bf16 v[8:11], v[28:31], v[104:111], v64
    s_add_u32 s30, s30, 1
    s_xor_b32 s70, s70, 1
    s_cmp_lg_u32 s71, 0
    v_smfmac_f32_16x16x64_bf16 v[12:15], v[28:31], v[136:143], v64
    s_nop 2
    v_smfmac_f32_16x16x64_bf16 v[0:3], v[16:19], v[32:39], v64
    ds_read_b128 v[32:35], v70 offset:32768
    ds_read_b128 v[36:39], v70 offset:33792
    v_cvt_pk_bf16_f32 v8, v8, v9
    v_cvt_pk_bf16_f32 v9, v10, v11
    v_and_or_b32 v8, v8, -2, s69
    v_cvt_pk_bf16_f32 v10, v12, v13
    v_cvt_pk_bf16_f32 v11, v14, v15
    v_smfmac_f32_16x16x64_bf16 v[24:27], v[16:19], v[56:63], v64
    buffer_store_dwordx4 v[8:11], v74, s[4:7], s22 offen sc1
    ds_read_b128 v[56:59], v70 offset:34816
    s_waitcnt lgkmcnt(3)
    v_smfmac_f32_16x16x64_bf16 v[24:27], v[20:23], v[40:47], v64
    ds_read_b128 v[60:63], v70 offset:35840
    ds_read_b128 v[40:43], v70 offset:16384
    v_smfmac_f32_16x16x64_bf16 v[0:3], v[20:23], v[48:55], v64
    ds_read_b128 v[44:47], v70 offset:17408
    s_waitcnt lgkmcnt(4)
    v_smfmac_f32_16x16x64_bf16 v[0:3], v[28:31], v[32:39], v64
    ds_read_b128 v[48:51], v72 offset:12288
    s_waitcnt lgkmcnt(3)
    s_nop 0
    v_smfmac_f32_16x16x64_bf16 v[24:27], v[28:31], v[56:63], v64
    ds_read_b128 v[32:35], v70 offset:18432
    ds_read_b128 v[36:39], v70 offset:19456
    ds_read_b128 v[52:55], v72 offset:13312
    s_nop 0
    v_cvt_pk_bf16_f32 v0, v0, v1
    v_cvt_pk_bf16_f32 v1, v2, v3
    v_and_or_b32 v0, v0, -2, s69
    s_nop 0
    v_cvt_pk_bf16_f32 v2, v24, v25
    v_cvt_pk_bf16_f32 v3, v26, v27
    s_waitcnt lgkmcnt(3)
    v_smfmac_f32_16x16x64_bf16 v[4:7], v[48:51], v[40:47], v64
    buffer_store_dwordx4 v[0:3], v74, s[4:7], s23 offen sc1
    s_waitcnt lgkmcnt(0)
    v_smfmac_f32_16x16x64_bf16 v[4:7], v[52:55], v[32:39], v64
    s_nop 7
    v_cvt_pk_bf16_f32 v4, v4, v5
    v_cvt_pk_bf16_f32 v5, v6, v7
    v_and_or_b32 v4, v4, -2, s69
    buffer_store_dwordx2 v[4:5], v77, s[4:7], s25 offen sc1
    s_cbranch_scc1 cs_e1
    s_cmp_lg_u32 s37, 0
    s_cbranch_scc1 cs_f0_xt
cs_f0_xtx:
    s_nop 2
    v_mov_b32 v79, v79
    s_nop 2
    v_mov_b32 v79, v79
    s_nop 2
    v_mov_b32 v79, v79
    s_nop 2
    v_mov_b32 v79, v79
    s_nop 2
    v_mov_b32 v79, v79
    s_nop 2
    v_mov_b32 v79, v79
    s_nop 2
    v_mov_b32 v79, v79
    s_nop 2
    v_mov_b32 v79, v79
    s_nop 2
    v_mov_b32 v79, v79
    s_nop 2
    v_mov_b32 v79, v79
    s_nop 2
    v_mov_b32 v79, v79
    s_nop 2
    v_mov_b32 v79, v79
    s_nop 2
    v_mov_b32 v79, v79
    s_nop 2
    v_mov_b32 v79, v79
    s_nop 2
    v_mov_b32 v79, v79
    s_nop 2
    v_mov_b32 v79, v79
    s_nop 2
    v_mov_b32 v79, v79
    s_nop 2
    v_mov_b32 v79, v79
    s_nop 2
    v_mov_b32 v79, v79
    s_nop 2
    v_mov_b32 v79, v79
    s_nop 2
    v_mov_b32 v79, v79
    s_nop 2
    v_mov_b32 v79, v79
    s_nop 2
    v_mov_b32 v79, v79
    s_nop 2
    v_mov_b32 v79, v79
    s_nop 2
    v_mov_b32 v79, v79
    s_nop 2
    v_mov_b32 v79, v79
    s_nop 2
    v_mov_b32 v79, v79
    s_nop 2
    v_mov_b32 v79, v79
    s_nop 2
    v_mov_b32 v79, v79
    s_nop 2
    v_mov_b32 v79, v79
    s_nop 2
    v_mov_b32 v79, v79
    s_nop 2
    v_mov_b32 v79, v79
    s_nop 2
    v_mov_b32 v79, v79
    s_nop 2
    v_mov_b32 v79, v79
    s_nop 2
    v_mov_b32 v79, v79
    s_nop 2
    v_mov_b32 v79, v79
    s_nop 0
    v_mov_b32 v79, v79
    buffer_load_dwordx4 v[8:11], v65, s[4:7], s18 offen sc1
    buffer_load_dwordx4 v[12:15], v65, s[4:7], s19 offen sc1
    buffer_load_dwordx4 v[16:19], v65, s[4:7], s20 offen sc1
    buffer_load_dwordx4 v[20:23], v65, s[4:7], s21 offen sc1
    v_and_b32 v77, 255, v69
    ds_read_b128 v[4:7], v77 offset:15872
    ds_read_b128 v[44:47], v70 offset:0
    ds_read_b128 v[48:51], v70 offset:1024
    ds_read_b128 v[52:55], v70 offset:2048
    ds_read_b128 v[56:59], v70 offset:3072
    ds_read_b128 v[24:27], v70 offset:4096
    ds_read_b128 v[28:31], v70 offset:5120
    ds_read_b128 v[32:35], v70 offset:6144
    ds_read_b128 v[36:39], v70 offset:7168
    s_mov_b32 s31, 65536
    s_add_u32 s24, s24, 524288
    s_add_u32 s26, s26, 524288
    s_add_u32 s55, s55, s57
    s_mov_b32 s14, 67633152
    s_mov_b32 s15, 67637248
    s_mov_b32 s16, 67641344
    s_mov_b32 s36, 1
    v_mov_b32 v40, s69
    v_mov_b32 v60, s69
    v_and_b32 v79, 12, v75
    v_cmp_eq_u32 vcc, 0, v79
    s_nop 1
    v_cndmask_b32 v79, 0, 1, vcc
    s_waitcnt lgkmcnt(0)
    s_waitcnt vmcnt(3)
    v_xor_b32 v77, s69, v8
    v_mfma_f32_16x16x32_bf16 v[0:3], v[4:7], v[8:11], 0
    v_mov_b64 v[8:9], 0
    v_mov_b64 v[10:11], 0
    s_waitcnt vmcnt(2)
    v_bitop3_b32 v77, v77, v12, s69 bitop3:0xf6
    v_mfma_f32_16x16x32_bf16 v[0:3], v[4:7], v[12:15], v[0:3]
    v_mov_b64 v[12:13], 0
    v_mov_b64 v[14:15], 0
    s_waitcnt vmcnt(1)
    v_bitop3_b32 v77, v77, v16, s69 bitop3:0xf6
    v_mfma_f32_16x16x32_bf16 v[0:3], v[4:7], v[16:19], v[0:3]
    v_mov_b64 v[16:17], 0
    v_mov_b64 v[18:19], 0
    s_waitcnt vmcnt(0)
    v_bitop3_b32 v77, v77, v20, s69 bitop3:0xf6
    v_mfma_f32_16x16x32_bf16 v[0:3], v[4:7], v[20:23], v[0:3]
    v_and_b32 v77, 1, v77
    v_cmp_ne_u32 vcc, 0, v77
    v_mov_b64 v[20:21], 0
    v_mov_b64 v[22:23], 0
    s_cmp_eq_u64 vcc, 0
    s_cselect_b64 s[42:43], -1, 0
    s_nop 1
    v_add_f32_dpp v0, v0, v0 row_ror:8 row_mask:0xf bank_mask:0xf
    v_add_f32_dpp v1, v1, v1 row_ror:8 row_mask:0xf bank_mask:0xf
    s_mov_b64 exec, s[42:43]
    v_cvt_pk_bf16_f32 v72, v0, v1
    v_bfi_b32 v72, v79, s70, v72
    buffer_store_dword v72, v75, s[4:7], s17 offen offset:0 sc1
    s_mov_b64 exec, -1
    s_cbranch_scc0 cs_f0_retry
cs_f0_go:
    v_mov_b64 v[0:1], 0
    v_mov_b64 v[2:3], 0
    v_mov_b64 v[4:5], 0
    v_mov_b64 v[6:7], 0
    s_nop 2
    v_mov_b32 v79, v79
    s_nop 2
    v_mov_b32 v79, v79
    s_nop 2
    v_mov_b32 v79, v79
    s_nop 2
    v_mov_b32 v79, v79
    s_nop 2
    v_mov_b32 v79, v79
    s_nop 2
    v_mov_b32 v79, v79
    s_nop 2
    v_mov_b32 v79, v79
    s_nop 2
    v_mov_b32 v79, v79
    s_nop 2
    v_mov_b32 v79, v79
    s_nop 2
    v_mov_b32 v79, v79
    s_nop 2
    v_mov_b32 v79, v79
    s_nop 2
    v_mov_b32 v79, v79
    s_nop 2
    v_mov_b32 v79, v79
    s_nop 2
    v_mov_b32 v79, v79
    s_nop 2
    v_mov_b32 v79, v79
    s_nop 2
    v_mov_b32 v79, v79
    s_nop 2
    v_mov_b32 v79, v79
    s_nop 2
    v_mov_b32 v79, v79
    s_nop 2
    v_mov_b32 v79, v79
    s_nop 2
    v_mov_b32 v79, v79
    s_nop 2
    v_mov_b32 v79, v79
    s_nop 2
    v_mov_b32 v79, v79
    s_nop 2
    v_mov_b32 v79, v79
    s_nop 2
    v_mov_b32 v79, v79
    s_nop 2
    v_mov_b32 v79, v79
    s_branch cs_loop
cs_e1:
    s_cmp_lg_u32 s71, 2
    s_cbranch_scc1 cs_f1
    v_and_b32 v77, 255, v69
    ds_read_b128 v[4:7], v77 offset:15872
    ds_read_b128 v[44:47], v70 offset:0
    ds_read_b128 v[48:51], v70 offset:1024
    ds_read_b128 v[52:55], v70 offset:2048
    ds_read_b128 v[56:59], v70 offset:3072
    ds_read_b128 v[24:27], v70 offset:4096
    ds_read_b128 v[28:31], v70 offset:5120
    ds_read_b128 v[32:35], v70 offset:6144
    ds_read_b128 v[36:39], v70 offset:7168
    s_mov_b32 s31, 65536
    s_add_u32 s24, s24, 524288
    s_add_u32 s26, s26, 524288
    s_add_u32 s55, s55, s57
    s_mov_b32 s14, 67633152
    s_mov_b32 s15, 67637248
    s_mov_b32 s16, 67641344
    s_mov_b32 s36, 1
    v_mov_b32 v40, s69
    v_mov_b32 v60, s69
    v_and_b32 v79, 12, v75
    v_cmp_eq_u32 vcc, 0, v79
    s_nop 1
    v_cndmask_b32 v79, 0, 1, vcc
    s_cmp_lg_u32 s37, 0
    s_cbranch_scc1 cs_f2_xt
cs_f2_xtx:
    s_nop 2
    v_mov_b32 v79, v79
    s_nop 2
    v_mov_b32 v79, v79
    s_nop 2
    v_mov_b32 v79, v79
    s_nop 2
    v_mov_b32 v79, v79
    s_nop 2
    v_mov_b32 v79, v79
    s_nop 2
    v_mov_b32 v79, v79
    s_nop 2
    v_mov_b32 v79, v79
    s_nop 2
    v_mov_b32 v79, v79
    s_nop 2
    v_mov_b32 v79, v79
    s_nop 2
    v_mov_b32 v79, v79
    s_nop 2
    v_mov_b32 v79, v79
    s_nop 2
    v_mov_b32 v79, v79
    s_nop 2
    v_mov_b32 v79, v79
    s_nop 2
    v_mov_b32 v79, v79
    s_nop 2
    v_mov_b32 v79, v79
    s_nop 2
    v_mov_b32 v79, v79
    s_nop 2
    v_mov_b32 v79, v79
    s_nop 2
    v_mov_b32 v79, v79
    s_nop 2
    v_mov_b32 v79, v79
    s_nop 2
    v_mov_b32 v79, v79
    s_nop 2
    v_mov_b32 v79, v79
    s_nop 2
    v_mov_b32 v79, v79
    s_nop 2
    v_mov_b32 v79, v79
    s_nop 2
    v_mov_b32 v79, v79
    s_nop 2
    v_mov_b32 v79, v79
    s_nop 2
    v_mov_b32 v79, v79
    s_nop 2
    v_mov_b32 v79, v79
    s_nop 2
    v_mov_b32 v79, v79
    s_nop 2
    v_mov_b32 v79, v79
    s_nop 2
    v_mov_b32 v79, v79
    s_nop 2
    v_mov_b32 v79, v79
    s_nop 2
    v_mov_b32 v79, v79
    s_nop 2
    v_mov_b32 v79, v79
    s_nop 2
    v_mov_b32 v79, v79
    s_nop 2
    v_mov_b32 v79, v79
    s_nop 2
    v_mov_b32 v79, v79
    s_nop 0
    v_mov_b32 v79, v79
    s_waitcnt vmcnt(0)
    buffer_load_dwordx4 v[8:11], v65, s[4:7], s18 offen sc1
    buffer_load_dwordx4 v[12:15], v65, s[4:7], s19 offen sc1
    buffer_load_dwordx4 v[16:19], v65, s[4:7], s20 offen sc1
    buffer_load_dwordx4 v[20:23], v65, s[4:7], s21 offen sc1
    s_nop 2
    v_mov_b32 v79, v79
    s_nop 2
    v_mov_b32 v79, v79
    s_nop 2
    v_mov_b32 v79, v79
    s_nop 2
    v_mov_b32 v79, v79
    s_nop 2
    v_mov_b32 v79, v79
    s_nop 2
    v_mov_b32 v79, v79
    s_nop 2
    v_mov_b32 v79, v79
    s_nop 2
    v_mov_b32 v79, v79
    s_nop 2
    v_mov_b32 v79, v79
    s_nop 2
    v_mov_b32 v79, v79
    buffer_load_dwordx4 v[40:43], v65, s[4:7], s14 offen offset:0 sc1
    buffer_load_dwordx4 v[60:63], v66, s[4:7], s14 offen offset:0 sc1
    s_waitcnt lgkmcnt(0)
    s_waitcnt vmcnt(5)
    v_xor_b32 v77, s69, v8
    v_bitop3_b32 v77, v77, v10, s69 bitop3:0xf6
    v_mfma_f32_16x16x32_bf16 v[0:3], v[4:7], v[8:11], 0
    v_mov_b64 v[8:9], 0
    v_mov_b64 v[10:11], 0
    s_waitcnt vmcnt(4)
    v_bitop3_b32 v77, v77, v12, s69 bitop3:0xf6
    v_bitop3_b32 v77, v77, v14, s69 bitop3:0xf6
    v_mfma_f32_16x16x32_bf16 v[0:3], v[4:7], v[12:15], v[0:3]
    v_mov_b64 v[12:13], 0
    v_mov_b64 v[14:15], 0
    s_waitcnt vmcnt(3)
    v_bitop3_b32 v77, v77, v16, s69 bitop3:0xf6
    v_bitop3_b32 v77, v77, v18, s69 bitop3:0xf6
    v_mfma_f32_16x16x32_bf16 v[0:3], v[4:7], v[16:19], v[0:3]
    v_mov_b64 v[16:17], 0
    v_mov_b64 v[18:19], 0
    s_waitcnt vmcnt(2)
    v_bitop3_b32 v77, v77, v20, s69 bitop3:0xf6
    v_bitop3_b32 v77, v77, v22, s69 bitop3:0xf6
    v_mfma_f32_16x16x32_bf16 v[0:3], v[4:7], v[20:23], v[0:3]
    v_and_b32 v77, 1, v77
    v_cmp_ne_u32 vcc, 0, v77
    v_mov_b64 v[20:21], 0
    v_mov_b64 v[22:23], 0
    buffer_load_dwordx4 v[40:43], v65, s[4:7], s14 offen offset:0 sc1
    buffer_load_dwordx4 v[60:63], v66, s[4:7], s14 offen offset:0 sc1
    s_cmp_eq_u64 vcc, 0
    s_cselect_b64 s[42:43], -1, 0
    v_add_f32 v2, v0, v1
    s_nop 1
    v_add_f32_dpp v2, v2, v2 row_ror:8 row_mask:0xf bank_mask:0xf
    s_nop 1
    v_mov_b32_dpp v0, v2 quad_perm:[0,0,2,2] row_mask:0xf bank_mask:0xf
    v_mov_b32_dpp v1, v2 quad_perm:[1,1,3,3] row_mask:0xf bank_mask:0xf
    s_mov_b64 exec, s[42:43]
    v_cvt_pk_bf16_f32 v72, v0, v1
    v_bfi_b32 v72, v79, s70, v72
    buffer_store_dword v72, v75, s[4:7], s17 offen offset:0 sc1
    buffer_store_dword v72, v75, s[4:7], s17 offen offset:1024 sc1
    buffer_store_dword v72, v75, s[4:7], s17 offen offset:2048 sc1
    buffer_store_dword v72, v75, s[4:7], s17 offen offset:3072 sc1
    s_mov_b64 exec, -1
    s_cbranch_scc0 cs_f2_retry
cs_f2_go:
    v_mov_b64 v[0:1], 0
    v_mov_b64 v[2:3], 0
    v_mov_b64 v[4:5], 0
    v_mov_b64 v[6:7], 0
    s_nop 2
    v_mov_b32 v79, v79
    s_nop 2
    v_mov_b32 v79, v79
    s_nop 2
    v_mov_b32 v79, v79
    s_nop 2
    v_mov_b32 v79, v79
    s_nop 2
    v_mov_b32 v79, v79
    s_nop 2
    v_mov_b32 v79, v79
    s_nop 2
    v_mov_b32 v79, v79
    s_nop 2
    v_mov_b32 v79, v79
    s_nop 2
    v_mov_b32 v79, v79
    s_nop 2
    v_mov_b32 v79, v79
    s_nop 2
    v_mov_b32 v79, v79
    s_nop 2
    v_mov_b32 v79, v79
    s_nop 2
    v_mov_b32 v79, v79
    s_nop 2
    v_mov_b32 v79, v79
    s_nop 2
    v_mov_b32 v79, v79
    s_nop 2
    v_mov_b32 v79, v79
    s_nop 2
    v_mov_b32 v79, v79
    s_nop 2
    v_mov_b32 v79, v79
    s_nop 2
    v_mov_b32 v79, v79
    s_nop 2
    v_mov_b32 v79, v79
    s_nop 2
    v_mov_b32 v79, v79
    s_nop 2
    v_mov_b32 v79, v79
    s_nop 2
    v_mov_b32 v79, v79
    s_nop 2
    v_mov_b32 v79, v79
    s_nop 2
    v_mov_b32 v79, v79
    s_branch cs_loop
cs_f1:
    s_cmp_lg_u32 s32, 1
    s_cbranch_scc1 cs_f3
    v_and_b32 v77, 255, v69
    ds_read_b128 v[4:7], v77 offset:15872
    ds_read_b128 v[44:47], v70 offset:0
    ds_read_b128 v[48:51], v70 offset:1024
    ds_read_b128 v[52:55], v70 offset:2048
    ds_read_b128 v[56:59], v70 offset:3072
    ds_read_b128 v[24:27], v70 offset:4096
    ds_read_b128 v[28:31], v70 offset:5120
    ds_read_b128 v[32:35], v70 offset:6144
    ds_read_b128 v[36:39], v70 offset:7168
    s_mov_b32 s31, 65536
    s_add_u32 s24, s24, 524288
    s_add_u32 s26, s26, 524288
    s_add_u32 s55, s55, s57
    s_mov_b32 s14, 67633152
    s_mov_b32 s15, 67637248
    s_mov_b32 s16, 67641344
    s_mov_b32 s36, 1
    v_mov_b32 v40, s69
    v_mov_b32 v60, s69
    v_and_b32 v79, 12, v75
    v_cmp_eq_u32 vcc, 0, v79
    s_nop 1
    v_cndmask_b32 v79, 0, 1, vcc
    s_cmp_lg_u32 s37, 0
    s_cbranch_scc1 cs_f1_xt
cs_f1_xtx:
    s_nop 2
    v_mov_b32 v79, v79
    s_nop 2
    v_mov_b32 v79, v79
    s_nop 2
    v_mov_b32 v79, v79
    s_nop 2
    v_mov_b32 v79, v79
    s_nop 2
    v_mov_b32 v79, v79
    s_nop 2
    v_mov_b32 v79, v79
    s_nop 2
    v_mov_b32 v79, v79
    s_nop 2
    v_mov_b32 v79, v79
    s_nop 2
    v_mov_b32 v79, v79
    s_nop 2
    v_mov_b32 v79, v79
    s_nop 2
    v_mov_b32 v79, v79
    s_nop 2
    v_mov_b32 v79, v79
    s_nop 2
    v_mov_b32 v79, v79
    s_nop 2
    v_mov_b32 v79, v79
    s_nop 2
    v_mov_b32 v79, v79
    s_nop 2
    v_mov_b32 v79, v79
    s_nop 2
    v_mov_b32 v79, v79
    s_nop 2
    v_mov_b32 v79, v79
    s_nop 2
    v_mov_b32 v79, v79
    s_nop 2
    v_mov_b32 v79, v79
    s_nop 2
    v_mov_b32 v79, v79
    s_nop 2
    v_mov_b32 v79, v79
    s_nop 2
    v_mov_b32 v79, v79
    s_nop 2
    v_mov_b32 v79, v79
    s_nop 2
    v_mov_b32 v79, v79
    s_nop 2
    v_mov_b32 v79, v79
    s_nop 2
    v_mov_b32 v79, v79
    s_nop 2
    v_mov_b32 v79, v79
    s_nop 2
    v_mov_b32 v79, v79
    s_nop 2
    v_mov_b32 v79, v79
    s_nop 2
    v_mov_b32 v79, v79
    s_nop 2
    v_mov_b32 v79, v79
    s_nop 2
    v_mov_b32 v79, v79
    s_nop 2
    v_mov_b32 v79, v79
    s_nop 2
    v_mov_b32 v79, v79
    s_nop 2
    v_mov_b32 v79, v79
    s_nop 0
    v_mov_b32 v79, v79
    s_waitcnt vmcnt(0)
    buffer_load_dwordx4 v[8:11], v65, s[4:7], s18 offen sc1
    buffer_load_dwordx4 v[12:15], v65, s[4:7], s19 offen sc1
    buffer_load_dwordx4 v[16:19], v65, s[4:7], s20 offen sc1
    buffer_load_dwordx4 v[20:23], v65, s[4:7], s21 offen sc1
    s_nop 2
    v_mov_b32 v79, v79
    s_nop 2
    v_mov_b32 v79, v79
    s_nop 2
    v_mov_b32 v79, v79
    s_nop 2
    v_mov_b32 v79, v79
    s_nop 2
    v_mov_b32 v79, v79
    s_nop 2
    v_mov_b32 v79, v79
    s_nop 2
    v_mov_b32 v79, v79
    s_nop 2
    v_mov_b32 v79, v79
    s_nop 2
    v_mov_b32 v79, v79
    s_nop 2
    v_mov_b32 v79, v79
    buffer_load_dwordx4 v[40:43], v65, s[4:7], s14 offen offset:0 sc1
    buffer_load_dwordx4 v[60:63], v66, s[4:7], s14 offen offset:0 sc1
    s_waitcnt lgkmcnt(0)
    s_waitcnt vmcnt(5)
    v_xor_b32 v77, s69, v8
    v_mfma_f32_16x16x32_bf16 v[0:3], v[4:7], v[8:11], 0
    v_mov_b64 v[8:9], 0
    v_mov_b64 v[10:11], 0
    s_waitcnt vmcnt(4)
    v_bitop3_b32 v77, v77, v12, s69 bitop3:0xf6
    v_mfma_f32_16x16x32_bf16 v[0:3], v[4:7], v[12:15], v[0:3]
    v_mov_b64 v[12:13], 0
    v_mov_b64 v[14:15], 0
    s_waitcnt vmcnt(3)
    v_bitop3_b32 v77, v77, v16, s69 bitop3:0xf6
    v_mfma_f32_16x16x32_bf16 v[0:3], v[4:7], v[16:19], v[0:3]
    v_mov_b64 v[16:17], 0
    v_mov_b64 v[18:19], 0
    s_waitcnt vmcnt(2)
    v_bitop3_b32 v77, v77, v20, s69 bitop3:0xf6
    v_mfma_f32_16x16x32_bf16 v[0:3], v[4:7], v[20:23], v[0:3]
    v_and_b32 v77, 1, v77
    v_cmp_ne_u32 vcc, 0, v77
    v_mov_b64 v[20:21], 0
    v_mov_b64 v[22:23], 0
    buffer_load_dwordx4 v[40:43], v65, s[4:7], s14 offen offset:0 sc1
    buffer_load_dwordx4 v[60:63], v66, s[4:7], s14 offen offset:0 sc1
    s_cmp_eq_u64 vcc, 0
    s_cselect_b64 s[42:43], -1, 0
    v_add_f32_dpp v0, v0, v0 row_ror:8 row_mask:0xf bank_mask:0xf
    v_add_f32_dpp v1, v1, v1 row_ror:8 row_mask:0xf bank_mask:0xf
    s_mov_b64 exec, s[42:43]
    v_cvt_pk_bf16_f32 v72, v0, v1
    v_bfi_b32 v72, v79, s70, v72
    buffer_store_dword v72, v75, s[4:7], s17 offen offset:0 sc1
    s_mov_b64 exec, -1
    s_cbranch_scc0 cs_f1_retry
cs_f1_go:
    v_mov_b64 v[0:1], 0
    v_mov_b64 v[2:3], 0
    v_mov_b64 v[4:5], 0
    v_mov_b64 v[6:7], 0
    s_nop 2
    v_mov_b32 v79, v79
    s_nop 2
    v_mov_b32 v79, v79
    s_nop 2
    v_mov_b32 v79, v79
    s_nop 2
    v_mov_b32 v79, v79
    s_nop 2
    v_mov_b32 v79, v79
    s_nop 2
    v_mov_b32 v79, v79
    s_nop 2
    v_mov_b32 v79, v79
    s_nop 2
    v_mov_b32 v79, v79
    s_nop 2
    v_mov_b32 v79, v79
    s_nop 2
    v_mov_b32 v79, v79
    s_nop 2
    v_mov_b32 v79, v79
    s_nop 2
    v_mov_b32 v79, v79
    s_nop 2
    v_mov_b32 v79, v79
    s_nop 2
    v_mov_b32 v79, v79
    s_nop 2
    v_mov_b32 v79, v79
    s_nop 2
    v_mov_b32 v79, v79
    s_nop 2
    v_mov_b32 v79, v79
    s_nop 2
    v_mov_b32 v79, v79
    s_nop 2
    v_mov_b32 v79, v79
    s_nop 2
    v_mov_b32 v79, v79
    s_nop 2
    v_mov_b32 v79, v79
    s_nop 2
    v_mov_b32 v79, v79
    s_nop 2
    v_mov_b32 v79, v79
    s_nop 2
    v_mov_b32 v79, v79
    s_nop 2
    v_mov_b32 v79, v79
    s_branch cs_loop
cs_f3:
    v_and_b32 v77, 255, v69
    ds_read_b128 v[4:7], v77 offset:15872
    ds_read_b128 v[44:47], v70 offset:0
    ds_read_b128 v[48:51], v70 offset:1024
    ds_read_b128 v[52:55], v70 offset:2048
    ds_read_b128 v[56:59], v70 offset:3072
    ds_read_b128 v[24:27], v70 offset:4096
    ds_read_b128 v[28:31], v70 offset:5120
    ds_read_b128 v[32:35], v70 offset:6144
    ds_read_b128 v[36:39], v70 offset:7168
    s_mov_b32 s31, 65536
    s_add_u32 s24, s24, 524288
    s_add_u32 s26, s26, 524288
    s_add_u32 s55, s55, s57
    s_mov_b32 s14, 67633152
    s_mov_b32 s15, 67637248
    s_mov_b32 s16, 67641344
    s_mov_b32 s36, 1
    v_mov_b32 v40, s69
    v_mov_b32 v60, s69
    v_and_b32 v79, 12, v75
    v_cmp_eq_u32 vcc, 0, v79
    s_nop 1
    v_cndmask_b32 v79, 0, 1, vcc
    s_add_u32 s40, s30, s95
    v_mov_b32 v72, s40
    s_waitcnt lgkmcnt(0)
    v_mov_b64 v[0:1], 0
    v_mov_b64 v[2:3], 0
    v_mov_b64 v[4:5], 0
    v_mov_b64 v[6:7], 0
    v_mov_b64 v[8:9], 0
    v_mov_b64 v[10:11], 0
    v_mov_b64 v[12:13], 0
    v_mov_b64 v[14:15], 0
    v_mov_b64 v[16:17], 0
    v_mov_b64 v[18:19], 0
    v_mov_b64 v[20:21], 0
    v_mov_b64 v[22:23], 0
    s_nop 2
    v_mov_b32 v79, v79
    s_nop 2
    v_mov_b32 v79, v79
    s_nop 2
    v_mov_b32 v79, v79
    s_nop 2
    v_mov_b32 v79, v79
    s_nop 2
    v_mov_b32 v79, v79
    s_nop 2
    v_mov_b32 v79, v79
    s_nop 2
    v_mov_b32 v79, v79
    s_nop 2
    v_mov_b32 v79, v79
    s_nop 2
    v_mov_b32 v79, v79
    s_nop 2
    v_mov_b32 v79, v79
    s_nop 2
    v_mov_b32 v79, v79
    s_nop 2
    v_mov_b32 v79, v79
    s_nop 2
    v_mov_b32 v79, v79
    s_nop 2
    v_mov_b32 v79, v79
    s_nop 2
    v_mov_b32 v79, v79
    s_nop 2
    v_mov_b32 v79, v79
    s_nop 2
    v_mov_b32 v79, v79
    s_nop 2
    v_mov_b32 v79, v79
    s_nop 2
    v_mov_b32 v79, v79
    s_nop 2
    v_mov_b32 v79, v79
    s_nop 2
    v_mov_b32 v79, v79
    s_nop 2
    v_mov_b32 v79, v79
    s_nop 2
    v_mov_b32 v79, v79
    s_nop 2
    v_mov_b32 v79, v79
    s_nop 2
    v_mov_b32 v79, v79
    s_nop 2
    v_mov_b32 v79, v79
    s_nop 2
    v_mov_b32 v79, v79
    s_nop 2
    v_mov_b32 v79, v79
    s_nop 2
    v_mov_b32 v79, v79
    s_nop 2
    v_mov_b32 v79, v79
    s_nop 2
    v_mov_b32 v79, v79
    s_nop 2
    v_mov_b32 v79, v79
    s_nop 2
    v_mov_b32 v79, v79
    s_nop 2
    v_mov_b32 v79, v79
    s_nop 2
    v_mov_b32 v79, v79
    s_nop 2
    v_mov_b32 v79, v79
    s_nop 2
    v_mov_b32 v79, v79
    s_nop 2
    v_mov_b32 v79, v79
    s_nop 2
    v_mov_b32 v79, v79
    s_nop 2
    v_mov_b32 v79, v79
    s_nop 2
    v_mov_b32 v79, v79
    s_nop 2
    v_mov_b32 v79, v79
    s_nop 2
    v_mov_b32 v79, v79
    s_nop 2
    v_mov_b32 v79, v79
    s_nop 2
    v_mov_b32 v79, v79
    s_nop 2
    v_mov_b32 v79, v79
    s_nop 2
    v_mov_b32 v79, v79
    s_nop 2
    v_mov_b32 v79, v79
    s_nop 2
    v_mov_b32 v79, v79
    s_nop 2
    v_mov_b32 v79, v79
    s_nop 2
    v_mov_b32 v79, v79
    s_nop 2
    v_mov_b32 v79, v79
    s_nop 2
    v_mov_b32 v79, v79
    s_nop 2
    v_mov_b32 v79, v79
    s_nop 2
    v_mov_b32 v79, v79
    s_nop 2
    v_mov_b32 v79, v79
    s_nop 2
    v_mov_b32 v79, v79
    s_nop 2
    v_mov_b32 v79, v79
    s_nop 2
    v_mov_b32 v79, v79
    s_nop 2
    v_mov_b32 v79, v79
    s_nop 2
    v_mov_b32 v79, v79
    s_nop 2
    v_mov_b32 v79, v79
    s_nop 2
    v_mov_b32 v79, v79
    s_nop 2
    v_mov_b32 v79, v79
    s_nop 2
    v_mov_b32 v79, v79
    s_waitcnt vmcnt(0)
    s_cmp_lt_u32 s97, s93
    s_cbranch_scc1 cs_kvwait
    s_nop 2
    v_mov_b32 v79, v79
    s_nop 2
    v_mov_b32 v79, v79
    s_nop 2
    v_mov_b32 v79, v79
    s_nop 2
    v_mov_b32 v79, v79
    s_nop 2
    v_mov_b32 v79, v79
    s_nop 2
    v_mov_b32 v79, v79
    s_nop 2
    v_mov_b32 v79, v79
    s_nop 2
    v_mov_b32 v79, v79
cs_kvok:
    s_branch cs_loop
cs_f0_xt:
    s_mov_b32 s37, 0
    s_nop 2
    v_mov_b32 v79, v79
    s_nop 2
    v_mov_b32 v79, v79
    s_nop 2
    v_mov_b32 v79, v79
    s_nop 2
    v_mov_b32 v79, v79
    s_nop 2
    v_mov_b32 v79, v79
    s_nop 2
    v_mov_b32 v79, v79
    s_branch cs_f0_xtx
cs_f0_retry:
    s_mov_b32 s37, 1
cs_f0_spin:
    buffer_load_dwordx4 v[8:11], v65, s[4:7], s18 offen sc1
    buffer_load_dwordx4 v[12:15], v65, s[4:7], s19 offen sc1
    buffer_load_dwordx4 v[16:19], v65, s[4:7], s20 offen sc1
    buffer_load_dwordx4 v[20:23], v65, s[4:7], s21 offen sc1
    s_nop 2
    v_mov_b32 v79, v79
    s_nop 2
    v_mov_b32 v79, v79
    s_nop 2
    v_mov_b32 v79, v79
    s_nop 2
    v_mov_b32 v79, v79
    s_nop 2
    v_mov_b32 v79, v79
    s_nop 2
    v_mov_b32 v79, v79
    buffer_load_dwordx4 v[40:43], v65, s[4:7], s14 offen offset:0 sc1
    buffer_load_dwordx4 v[60:63], v66, s[4:7], s14 offen offset:0 sc1
    s_waitcnt vmcnt(5)
    v_xor_b32 v77, s69, v8
    v_mfma_f32_16x16x32_bf16 v[0:3], v[4:7], v[8:11], 0
    v_mov_b64 v[8:9], 0
    v_mov_b64 v[10:11], 0
    s_waitcnt vmcnt(4)
    v_bitop3_b32 v77, v77, v12, s69 bitop3:0xf6
    v_mfma_f32_16x16x32_bf16 v[0:3], v[4:7], v[12:15], v[0:3]
    v_mov_b64 v[12:13], 0
    v_mov_b64 v[14:15], 0
    s_waitcnt vmcnt(3)
    v_bitop3_b32 v77, v77, v16, s69 bitop3:0xf6
    v_mfma_f32_16x16x32_bf16 v[0:3], v[4:7], v[16:19], v[0:3]
    v_mov_b64 v[16:17], 0
    v_mov_b64 v[18:19], 0
    s_waitcnt vmcnt(2)
    v_bitop3_b32 v77, v77, v20, s69 bitop3:0xf6
    v_mfma_f32_16x16x32_bf16 v[0:3], v[4:7], v[20:23], v[0:3]
    v_and_b32 v77, 1, v77
    v_cmp_ne_u32 vcc, 0, v77
    v_mov_b64 v[20:21], 0
    v_mov_b64 v[22:23], 0
    buffer_load_dwordx4 v[40:43], v65, s[4:7], s14 offen offset:0 sc1
    buffer_load_dwordx4 v[60:63], v66, s[4:7], s14 offen offset:0 sc1
    s_cmp_eq_u64 vcc, 0
    s_cselect_b64 s[42:43], -1, 0
    v_add_f32_dpp v0, v0, v0 row_ror:8 row_mask:0xf bank_mask:0xf
    v_add_f32_dpp v1, v1, v1 row_ror:8 row_mask:0xf bank_mask:0xf
    s_mov_b64 exec, s[42:43]
    v_cvt_pk_bf16_f32 v72, v0, v1
    v_bfi_b32 v72, v79, s70, v72
    buffer_store_dword v72, v75, s[4:7], s17 offen offset:0 sc1
    s_mov_b64 exec, -1
    s_cbranch_scc1 cs_f0_rx
    s_sub_u32 s31, s31, 1
    s_cbranch_scc0 cs_f0_spin
cs_f0_rx:
    v_mov_b64 v[0:1], 0
    v_mov_b64 v[2:3], 0
    v_mov_b64 v[4:5], 0
    v_mov_b64 v[6:7], 0
    s_branch cs_loop
cs_f1_xt:
    s_mov_b32 s37, 0
    s_nop 2
    v_mov_b32 v79, v79
    s_nop 2
    v_mov_b32 v79, v79
    s_nop 2
    v_mov_b32 v79, v79
    s_nop 2
    v_mov_b32 v79, v79
    s_nop 2
    v_mov_b32 v79, v79
    s_nop 2
    v_mov_b32 v79, v79
    s_branch cs_f1_xtx
cs_f1_retry:
    s_mov_b32 s37, 1
cs_f1_spin:
    buffer_load_dwordx4 v[8:11], v65, s[4:7], s18 offen sc1
    buffer_load_dwordx4 v[12:15], v65, s[4:7], s19 offen sc1
    buffer_load_dwordx4 v[16:19], v65, s[4:7], s20 offen sc1
    buffer_load_dwordx4 v[20:23], v65, s[4:7], s21 offen sc1
    s_nop 2
    v_mov_b32 v79, v79
    s_nop 2
    v_mov_b32 v79, v79
    s_nop 2
    v_mov_b32 v79, v79
    s_nop 2
    v_mov_b32 v79, v79
    s_nop 2
    v_mov_b32 v79, v79
    s_nop 2
    v_mov_b32 v79, v79
    buffer_load_dwordx4 v[40:43], v65, s[4:7], s14 offen offset:0 sc1
    buffer_load_dwordx4 v[60:63], v66, s[4:7], s14 offen offset:0 sc1
    s_waitcnt vmcnt(5)
    v_xor_b32 v77, s69, v8
    v_mfma_f32_16x16x32_bf16 v[0:3], v[4:7], v[8:11], 0
    v_mov_b64 v[8:9], 0
    v_mov_b64 v[10:11], 0
    s_waitcnt vmcnt(4)
    v_bitop3_b32 v77, v77, v12, s69 bitop3:0xf6
    v_mfma_f32_16x16x32_bf16 v[0:3], v[4:7], v[12:15], v[0:3]
    v_mov_b64 v[12:13], 0
    v_mov_b64 v[14:15], 0
    s_waitcnt vmcnt(3)
    v_bitop3_b32 v77, v77, v16, s69 bitop3:0xf6
    v_mfma_f32_16x16x32_bf16 v[0:3], v[4:7], v[16:19], v[0:3]
    v_mov_b64 v[16:17], 0
    v_mov_b64 v[18:19], 0
    s_waitcnt vmcnt(2)
    v_bitop3_b32 v77, v77, v20, s69 bitop3:0xf6
    v_mfma_f32_16x16x32_bf16 v[0:3], v[4:7], v[20:23], v[0:3]
    v_and_b32 v77, 1, v77
    v_cmp_ne_u32 vcc, 0, v77
    v_mov_b64 v[20:21], 0
    v_mov_b64 v[22:23], 0
    buffer_load_dwordx4 v[40:43], v65, s[4:7], s14 offen offset:0 sc1
    buffer_load_dwordx4 v[60:63], v66, s[4:7], s14 offen offset:0 sc1
    s_cmp_eq_u64 vcc, 0
    s_cselect_b64 s[42:43], -1, 0
    v_add_f32_dpp v0, v0, v0 row_ror:8 row_mask:0xf bank_mask:0xf
    v_add_f32_dpp v1, v1, v1 row_ror:8 row_mask:0xf bank_mask:0xf
    s_mov_b64 exec, s[42:43]
    v_cvt_pk_bf16_f32 v72, v0, v1
    v_bfi_b32 v72, v79, s70, v72
    buffer_store_dword v72, v75, s[4:7], s17 offen offset:0 sc1
    s_mov_b64 exec, -1
    s_cbranch_scc1 cs_f1_rx
    s_sub_u32 s31, s31, 1
    s_cbranch_scc0 cs_f1_spin
cs_f1_rx:
    v_mov_b64 v[0:1], 0
    v_mov_b64 v[2:3], 0
    v_mov_b64 v[4:5], 0
    v_mov_b64 v[6:7], 0
    s_branch cs_loop
cs_f2_xt:
    s_mov_b32 s37, 0
    s_nop 2
    v_mov_b32 v79, v79
    s_nop 2
    v_mov_b32 v79, v79
    s_nop 2
    v_mov_b32 v79, v79
    s_nop 2
    v_mov_b32 v79, v79
    s_nop 2
    v_mov_b32 v79, v79
    s_nop 2
    v_mov_b32 v79, v79
    s_branch cs_f2_xtx
cs_f2_retry:
    s_mov_b32 s37, 1
cs_f2_spin:
    buffer_load_dwordx4 v[8:11], v65, s[4:7], s18 offen sc1
    buffer_load_dwordx4 v[12:15], v65, s[4:7], s19 offen sc1
    buffer_load_dwordx4 v[16:19], v65, s[4:7], s20 offen sc1
    buffer_load_dwordx4 v[20:23], v65, s[4:7], s21 offen sc1
    s_nop 2
    v_mov_b32 v79, v79
    s_nop 2
    v_mov_b32 v79, v79
    s_nop 2
    v_mov_b32 v79, v79
    s_nop 2
    v_mov_b32 v79, v79
    s_nop 2
    v_mov_b32 v79, v79
    s_nop 2
    v_mov_b32 v79, v79
    buffer_load_dwordx4 v[40:43], v65, s[4:7], s14 offen offset:0 sc1
    buffer_load_dwordx4 v[60:63], v66, s[4:7], s14 offen offset:0 sc1
    s_waitcnt vmcnt(5)
    v_xor_b32 v77, s69, v8
    v_bitop3_b32 v77, v77, v10, s69 bitop3:0xf6
    v_mfma_f32_16x16x32_bf16 v[0:3], v[4:7], v[8:11], 0
    v_mov_b64 v[8:9], 0
    v_mov_b64 v[10:11], 0
    s_waitcnt vmcnt(4)
    v_bitop3_b32 v77, v77, v12, s69 bitop3:0xf6
    v_bitop3_b32 v77, v77, v14, s69 bitop3:0xf6
    v_mfma_f32_16x16x32_bf16 v[0:3], v[4:7], v[12:15], v[0:3]
    v_mov_b64 v[12:13], 0
    v_mov_b64 v[14:15], 0
    s_waitcnt vmcnt(3)
    v_bitop3_b32 v77, v77, v16, s69 bitop3:0xf6
    v_bitop3_b32 v77, v77, v18, s69 bitop3:0xf6
    v_mfma_f32_16x16x32_bf16 v[0:3], v[4:7], v[16:19], v[0:3]
    v_mov_b64 v[16:17], 0
    v_mov_b64 v[18:19], 0
    s_waitcnt vmcnt(2)
    v_bitop3_b32 v77, v77, v20, s69 bitop3:0xf6
    v_bitop3_b32 v77, v77, v22, s69 bitop3:0xf6
    v_mfma_f32_16x16x32_bf16 v[0:3], v[4:7], v[20:23], v[0:3]
    v_and_b32 v77, 1, v77
    v_cmp_ne_u32 vcc, 0, v77
    v_mov_b64 v[20:21], 0
    v_mov_b64 v[22:23], 0
    buffer_load_dwordx4 v[40:43], v65, s[4:7], s14 offen offset:0 sc1
    buffer_load_dwordx4 v[60:63], v66, s[4:7], s14 offen offset:0 sc1
    s_cmp_eq_u64 vcc, 0
    s_cselect_b64 s[42:43], -1, 0
    v_add_f32 v2, v0, v1
    s_nop 1
    v_add_f32_dpp v2, v2, v2 row_ror:8 row_mask:0xf bank_mask:0xf
    s_nop 1
    v_mov_b32_dpp v0, v2 quad_perm:[0,0,2,2] row_mask:0xf bank_mask:0xf
    v_mov_b32_dpp v1, v2 quad_perm:[1,1,3,3] row_mask:0xf bank_mask:0xf
    s_mov_b64 exec, s[42:43]
    v_cvt_pk_bf16_f32 v72, v0, v1
    v_bfi_b32 v72, v79, s70, v72
    buffer_store_dword v72, v75, s[4:7], s17 offen offset:0 sc1
    buffer_store_dword v72, v75, s[4:7], s17 offen offset:1024 sc1
    buffer_store_dword v72, v75, s[4:7], s17 offen offset:2048 sc1
    buffer_store_dword v72, v75, s[4:7], s17 offen offset:3072 sc1
    s_mov_b64 exec, -1
    s_cbranch_scc1 cs_f2_rx
    s_sub_u32 s31, s31, 1
    s_cbranch_scc0 cs_f2_spin
cs_f2_rx:
    v_mov_b64 v[0:1], 0
    v_mov_b64 v[2:3], 0
    v_mov_b64 v[4:5], 0
    v_mov_b64 v[6:7], 0
    s_branch cs_loop
cs_spinB:
    s_waitcnt vmcnt(2)
cs_spinB_l:
    v_and_b32 v77, s36, v44
    v_cmp_ne_u32 vcc, s70, v77
    s_cbranch_vccz cs_spinB_x
    buffer_load_dwordx4 v[44:47], v65, s[4:7], s15 offen sc1
    s_sub_u32 s31, s31, 16
    s_waitcnt vmcnt(0)
    s_cbranch_scc0 cs_spinB_l
cs_spinB_x:
    ds_write_b128 v65, v[44:47] offset:4096
    s_waitcnt lgkmcnt(0)
    s_branch cs_backB
cs_spin8:
    buffer_load_dwordx4 v[40:43], v65, s[4:7], s16 offen sc1
cs_spin8_l:
    v_and_b32 v77, s36, v40
    v_cmp_ne_u32 vcc, s70, v77
    s_cbranch_vccz cs_spin8_x
    s_nop 15
    s_nop 15
    s_nop 15
    s_nop 11
    v_and_b32 v77, s36, v40
    v_cmp_ne_u32 vcc, s70, v77
    s_cbranch_vccz cs_spin8_x
    s_nop 15
    s_nop 15
    s_nop 15
    s_nop 11
    v_and_b32 v77, s36, v40
    v_cmp_ne_u32 vcc, s70, v77
    s_cbranch_vccz cs_spin8_x
    s_nop 15
    s_nop 15
    s_nop 15
    s_nop 11
    buffer_load_dwordx4 v[40:43], v65, s[4:7], s16 offen sc1
    s_sub_u32 s31, s31, 16
    s_cbranch_scc0 cs_spin8_l
cs_spin8_x:
    s_branch cs_back8
cs_rare:
    s_mov_b64 exec, s[34:35]
    buffer_store_dwordx4 v[0:3], v65, s[4:7], s28 offen sc1
    s_mov_b64 exec, -1
    s_nop 3
    v_cvt_pk_bf16_f32 v52, v16, v17
    v_cvt_pk_bf16_f32 v53, v18, v19
    v_cvt_pk_bf16_f32 v54, v20, v21
    v_cvt_pk_bf16_f32 v55, v22, v23
    buffer_store_dwordx4 v[52:55], v65, s[4:7], s27 offen sc1
    s_add_u32 s28, s28, 131072
    s_add_u32 s27, s27, 131072
    s_cmp_eq_u32 s30, 63
    s_cbranch_scc1 cs_last
    s_branch cs_rare_x
cs_kvwait:
    s_mov_b32 s41, s97
    v_bfe_u32 v78, v65, 2, 5
    v_mov_b32 v77, v76
    s_nop 1
    v_permlane32_swap_b32 v76, v77
    v_subrev_u32 v77, s95, v77
    v_cmp_lt_u32 vcc, 16, v77
    s_nop 1
    v_cndmask_b32 v77, v77, 0, vcc
    v_bfe_u32 v79, v78, 2, 2
    v_lshl_add_u32 v77, v77, 2, v79
    s_nop 1
    v_min_u32_dpp v77, v77, v77 row_ror:1 row_mask:0xf bank_mask:0xf
    s_nop 1
    v_min_u32_dpp v77, v77, v77 row_ror:2 row_mask:0xf bank_mask:0xf
    s_nop 1
    v_min_u32_dpp v77, v77, v77 row_ror:4 row_mask:0xf bank_mask:0xf
    s_nop 0
    v_readfirstlane_b32 s97, v77
    s_nop 0
    s_max_u32 s97, s97, s41
    s_add_u32 s40, s30, 3
    s_min_u32 s40, s40, 64
    s_cmp_le_u32 s40, s97
    s_cbranch_scc1 cs_kvw_x
    v_bfe_u32 v78, v65, 2, 5
    s_mov_b32 s31, 4194304
cs_kvw:
    buffer_load_dword v77, v78, s[4:7], s96 offen offset:16 sc1
    s_waitcnt vmcnt(0)
    v_subrev_u32 v77, s95, v77
    v_cmp_lt_u32 vcc, 16, v77
    s_nop 1
    v_cndmask_b32 v77, v77, 0, vcc
    v_bfe_u32 v79, v78, 2, 2
    v_lshl_add_u32 v77, v77, 2, v79
    s_nop 1
    v_min_u32_dpp v77, v77, v77 row_ror:1 row_mask:0xf bank_mask:0xf
    s_nop 1
    v_min_u32_dpp v77, v77, v77 row_ror:2 row_mask:0xf bank_mask:0xf
    s_nop 1
    v_min_u32_dpp v77, v77, v77 row_ror:4 row_mask:0xf bank_mask:0xf
    s_nop 0
    v_readfirstlane_b32 s97, v77
    s_sub_u32 s31, s31, 1
    s_cbranch_scc1 cs_kvw_x
    s_cmp_le_u32 s40, s97
    s_cbranch_scc1 cs_kvw_x
    s_sleep 2
    s_branch cs_kvw
cs_kvw_x:
    s_branch cs_kvok
cs_last:
    s_add_u32 s40, s95, 64
    v_mov_b32 v78, s40
    s_waitcnt vmcnt(0)
    s_barrier
    s_mov_b64 exec, s[100:101]
    buffer_store_dword v78, off, s[4:7], s29 sc1
    s_mov_b64 exec, -1
cs_end:
    s_endpgm
L_xform:
    v_and_b32 v1, 63, v0
    v_and_b32 v2, 15, v1
    v_lshrrev_b32 v3, 4, v1
    v_mov_b32 v7, 0x05040100
    v_mov_b32 v8, 0x07060302
    v_lshrrev_b32 v9, 6, v0
    v_lshlrev_b32 v9, 14, v9
    v_lshlrev_b32 v10, 4, v1
    v_add_u32 v11, v9, v10
    s_mov_b32 s10, 4718592
    s_mov_b32 s11, 0x20000
    s_mov_b64 s[8:9], s[58:59]
xf_f:
    s_sub_u32 s17, s16, 1504
    s_and_b32 s18, s17, 127
    s_lshr_b32 s17, s17, 7
    s_lshl_b32 s19, s17, 4
    v_add_u32 v6, s19, v2
    v_mul_u32_u24 v4, 9216, v3
    v_lshl_add_u32 v4, v6, 4, v4
    v_lshrrev_b32 v5, 2, v2
    v_lshlrev_b32 v5, 11, v5
    v_lshl_add_u32 v5, v3, 8, v5
    v_and_b32 v1, 3, v6
    v_lshl_add_u32 v5, v1, 6, v5
    v_add_u32 v5, v5, v9
    v_cmp_gt_u32 vcc, 72, v6
    s_nop 0
    s_mov_b64 exec, vcc
    s_mul_i32 s20, s18, 36864
    s_add_u32 s21, s20, 0
    buffer_load_dwordx4 v[12:15], v4, s[8:11], s21 offen
    s_add_u32 s21, s20, 1152
    buffer_load_dwordx4 v[16:19], v4, s[8:11], s21 offen
    s_add_u32 s21, s20, 2304
    buffer_load_dwordx4 v[20:23], v4, s[8:11], s21 offen
    s_add_u32 s21, s20, 3456
    buffer_load_dwordx4 v[24:27], v4, s[8:11], s21 offen
    s_add_u32 s21, s20, 4608
    buffer_load_dwordx4 v[28:31], v4, s[8:11], s21 offen
    s_add_u32 s21, s20, 5760
    buffer_load_dwordx4 v[32:35], v4, s[8:11], s21 offen
    s_add_u32 s21, s20, 6912
    buffer_load_dwordx4 v[36:39], v4, s[8:11], s21 offen
    s_add_u32 s21, s20, 8064
    buffer_load_dwordx4 v[40:43], v4, s[8:11], s21 offen
    s_lshl_b32 s20, s18, 11
    s_add_u32 s20, s20, 130023424
    s_waitcnt vmcnt(0)
    v_perm_b32 v76, v16, v12, v7
    v_perm_b32 v77, v24, v20, v7
    v_perm_b32 v78, v32, v28, v7
    v_perm_b32 v79, v40, v36, v7
    ds_write_b128 v5, v[76:79] offset:0
    v_perm_b32 v80, v17, v13, v7
    v_perm_b32 v81, v25, v21, v7
    v_perm_b32 v82, v33, v29, v7
    v_perm_b32 v83, v41, v37, v7
    ds_write_b128 v5, v[80:83] offset:16
    v_perm_b32 v84, v18, v14, v7
    v_perm_b32 v85, v26, v22, v7
    v_perm_b32 v86, v34, v30, v7
    v_perm_b32 v87, v42, v38, v7
    ds_write_b128 v5, v[84:87] offset:32
    v_perm_b32 v88, v19, v15, v7
    v_perm_b32 v89, v27, v23, v7
    v_perm_b32 v90, v35, v31, v7
    v_perm_b32 v91, v43, v39, v7
    ds_write_b128 v5, v[88:91] offset:48
    v_perm_b32 v92, v16, v12, v8
    v_perm_b32 v93, v24, v20, v8
    v_perm_b32 v94, v32, v28, v8
    v_perm_b32 v95, v40, v36, v8
    ds_write_b128 v5, v[92:95] offset:1024
    v_perm_b32 v96, v17, v13, v8
    v_perm_b32 v97, v25, v21, v8
    v_perm_b32 v98, v33, v29, v8
    v_perm_b32 v99, v41, v37, v8
    ds_write_b128 v5, v[96:99] offset:1040
    v_perm_b32 v100, v18, v14, v8
    v_perm_b32 v101, v26, v22, v8
    v_perm_b32 v102, v34, v30, v8
    v_perm_b32 v103, v42, v38, v8
    ds_write_b128 v5, v[100:103] offset:1056
    v_perm_b32 v104, v19, v15, v8
    v_perm_b32 v105, v27, v23, v8
    v_perm_b32 v106, v35, v31, v8
    v_perm_b32 v107, v43, v39, v8
    ds_write_b128 v5, v[104:107] offset:1072
    s_mov_b64 exec, -1
    s_lshl_b32 s21, s17, 20
    s_add_u32 s20, s20, s21
    s_waitcnt lgkmcnt(0)
    ds_read_b128 v[76:79], v11 offset:0
    ds_read_b128 v[80:83], v11 offset:1024
    ds_read_b128 v[84:87], v11 offset:2048
    ds_read_b128 v[88:91], v11 offset:3072
    ds_read_b128 v[92:95], v11 offset:4096
    ds_read_b128 v[96:99], v11 offset:5120
    ds_read_b128 v[100:103], v11 offset:6144
    ds_read_b128 v[104:107], v11 offset:7168
    s_add_u32 s19, s20, 0
    s_waitcnt lgkmcnt(7)
    buffer_store_dwordx4 v[76:79], v10, s[4:7], s19 offen sc1
    s_add_u32 s19, s20, 1024
    s_waitcnt lgkmcnt(6)
    buffer_store_dwordx4 v[80:83], v10, s[4:7], s19 offen sc1
    s_add_u32 s19, s20, 262144
    s_waitcnt lgkmcnt(5)
    buffer_store_dwordx4 v[84:87], v10, s[4:7], s19 offen sc1
    s_add_u32 s19, s20, 263168
    s_waitcnt lgkmcnt(4)
    buffer_store_dwordx4 v[88:91], v10, s[4:7], s19 offen sc1
    s_add_u32 s19, s20, 524288
    s_waitcnt lgkmcnt(3)
    buffer_store_dwordx4 v[92:95], v10, s[4:7], s19 offen sc1
    s_add_u32 s19, s20, 525312
    s_waitcnt lgkmcnt(2)
    buffer_store_dwordx4 v[96:99], v10, s[4:7], s19 offen sc1
    s_add_u32 s19, s20, 786432
    s_waitcnt lgkmcnt(1)
    buffer_store_dwordx4 v[100:103], v10, s[4:7], s19 offen sc1
    s_add_u32 s19, s20, 787456
    s_waitcnt lgkmcnt(0)
    buffer_store_dwordx4 v[104:107], v10, s[4:7], s19 offen sc1
xf_done:
    s_nop 1
    s_setpc_b64 s[46:47]
L_helper:
    s_load_dwordx16 s[64:79], s[0:1], 64
    s_waitcnt lgkmcnt(0)
    s_mov_b32 s93, 1000
    s_mov_b32 s95, 0
    s_cmp_lg_u32 s3, 2
    s_cbranch_scc1 L_qkv_next
    s_mov_b32 s37, 24
    v_mov_b32 v250, 1
    v_mov_b32 v251, 163832
    v_cmp_eq_u32 vcc, 0, v0
    s_nop 0
    s_and_saveexec_b64 s[38:39], vcc
    s_cbranch_execz tk3
    buffer_atomic_add v250, off, s[84:87], s37 sc0
    s_waitcnt vmcnt(0)
    ds_write_b32 v251, v250
    s_waitcnt lgkmcnt(0)
tk3:
    s_mov_b64 exec, -1
    s_barrier
    ds_read_b32 v252, v251
    s_waitcnt lgkmcnt(0)
    v_readfirstlane_b32 s36, v252
    s_barrier
    s_nop 3
    s_cmp_ge_u32 s36, 32
    s_cbranch_scc1 L_qkv_next
    s_mov_b32 s93, 0
    s_mov_b32 s88, 4194304
gn4:
    buffer_load_dword v250, off, s[84:87], 0 offset:216 sc1
    s_waitcnt vmcnt(0)
    v_readfirstlane_b32 s95, v250
    s_sub_u32 s88, s88, 1
    s_cbranch_scc1 gn4x
    s_cmp_eq_u32 s95, 0
    s_cbranch_scc1 gn4
gn4x:
    s_cmp_eq_u32 s36, 0
    s_cbranch_scc1 L_relay
    s_branch L_wf_next
L_qkv_next:
    s_mov_b32 s37, 4
    v_mov_b32 v250, 1
    v_mov_b32 v251, 163832
    v_cmp_eq_u32 vcc, 0, v0
    s_nop 0
    s_and_saveexec_b64 s[38:39], vcc
    s_cbranch_execz tk5
    buffer_atomic_add v250, off, s[84:87], s37 sc0
    s_waitcnt vmcnt(0)
    ds_write_b32 v251, v250
    s_waitcnt lgkmcnt(0)
tk5:
    s_mov_b64 exec, -1
    s_barrier
    ds_read_b32 v252, v251
    s_waitcnt lgkmcnt(0)
    v_readfirstlane_b32 s36, v252
    s_barrier
    s_nop 3
    s_or_b32 s37, s36, s32
    s_cbranch_scc1 L_non
    s_memrealtime s[90:91]
    s_waitcnt lgkmcnt(0)
    s_lshl_b32 s90, s90, 8
    s_or_b32 s90, s90, 1
    v_mov_b32 v250, s90
    s_mov_b64 exec, 1
    buffer_store_dword v250, off, s[84:87], 0 offset:216 sc1
    s_mov_b64 exec, -1
L_non:
    s_cmp_lt_u32 s36, 192
    s_cbranch_scc1 L_qkv
    s_cmp_lg_u32 s95, 0
    s_cbranch_scc1 L_hn
    s_mov_b32 s88, 4194304
gn6:
    buffer_load_dword v250, off, s[84:87], 0 offset:216 sc1
    s_waitcnt vmcnt(0)
    v_readfirstlane_b32 s95, v250
    s_sub_u32 s88, s88, 1
    s_cbranch_scc1 gn6x
    s_cmp_eq_u32 s95, 0
    s_cbranch_scc1 gn6
gn6x:
L_hn:
    s_sub_u32 s45, s36, 192
    s_cmp_lg_u32 s36, 192
    s_cbranch_scc1 L_phase2
    s_mov_b32 s37, 24
    v_mov_b32 v250, 1
    v_mov_b32 v251, 163832
    v_cmp_eq_u32 vcc, 0, v0
    s_nop 0
    s_and_saveexec_b64 s[38:39], vcc
    s_cbranch_execz tk7
    buffer_atomic_add v250, off, s[84:87], s37 sc0
    s_waitcnt vmcnt(0)
    ds_write_b32 v251, v250
    s_waitcnt lgkmcnt(0)
tk7:
    s_mov_b64 exec, -1
    s_barrier
    ds_read_b32 v252, v251
    s_waitcnt lgkmcnt(0)
    v_readfirstlane_b32 s36, v252
    s_barrier
    s_nop 3
    s_cmp_lg_u32 s36, 0
    s_cbranch_scc1 L_phase2
L_relay:
    s_cmp_lg_u32 s32, 0
    s_cbranch_scc1 L_exit
    v_and_b32 v3, 31, v0
    v_lshlrev_b32 v3, 7, v3
    s_mov_b32 s17, 0
    s_mov_b32 s23, 125845504
    s_mov_b32 s24, 125853696
    s_mov_b32 s21, 16777216
rl_rwait:
    buffer_load_dword v4, v3, s[4:7], s23 offen sc1
    s_waitcnt vmcnt(0)
    v_subrev_u32 v4, s95, v4
    v_cmp_lt_u32 vcc, 64, v4
    s_nop 1
    v_cndmask_b32 v4, v4, 0, vcc
    s_nop 1
    v_min_u32_dpp v4, v4, v4 row_ror:1 row_mask:0xf bank_mask:0xf
    s_nop 1
    v_min_u32_dpp v4, v4, v4 row_ror:2 row_mask:0xf bank_mask:0xf
    s_nop 1
    v_min_u32_dpp v4, v4, v4 row_ror:4 row_mask:0xf bank_mask:0xf
    s_nop 1
    v_min_u32_dpp v4, v4, v4 row_ror:8 row_mask:0xf bank_mask:0xf
    s_nop 0
    v_readlane_b32 s16, v4, 0
    v_readlane_b32 s22, v4, 16
    s_nop 0
    s_min_u32 s16, s16, s22
    s_sub_u32 s21, s21, 1
    s_cbranch_scc1 rl_x
    s_cmp_gt_u32 s16, s17
    s_cbranch_scc1 rl_rpub
    s_sleep 2
    s_branch rl_rwait
rl_rpub:
    s_mov_b32 s17, s16
    s_add_u32 s22, s16, s95
    v_mov_b32 v4, s22
    s_mov_b64 exec, 1
    buffer_store_dword v4, off, s[4:7], s24 sc1
    s_mov_b64 exec, -1
    s_cmp_lt_u32 s16, 64
    s_cbranch_scc1 rl_rwait
rl_x:
    s_endpgm
L_qkv:
    s_sub_u32 s33, s36, 32
    s_and_b32 s17, s36, 15
    s_lshl_b32 s17, s17, 1
    s_lshr_b32 s36, s36, 4
    s_and_b32 s16, s36, 1
    s_add_u32 s16, s16, 1
    s_lshr_b32 s19, s36, 1
    s_and_b32 s37, s36, 3
    s_cmp_ge_u32 s36, 8
    s_cselect_b32 s16, 0, s16
    s_cselect_b32 s19, s37, s19
    v_lshrrev_b32 v4, 6, v0
    s_nop 0
    v_readfirstlane_b32 s18, v4
    v_lshlrev_b32 v7, 4, v0
    s_cmp_eq_u32 s16, 1
    s_cselect_b64 s[12:13], s[54:55], s[52:53]
    s_cmp_eq_u32 s16, 2
    s_cselect_b64 s[12:13], s[56:57], s[12:13]
    s_mov_b32 s14, 4718592
    s_mov_b32 s15, 0x20000
    v_bfe_u32 v4, v0, 5, 1
    v_lshlrev_b32 v5, 2, v4
    v_and_b32 v8, 31, v0
    v_xor_b32 v8, v8, v5
    v_lshlrev_b32 v8, 4, v8
    v_lshl_add_u32 v8, v4, 13, v8
    v_xor_b32 v9, 128, v8
    s_lshl_b32 s21, s17, 8
    s_lshl_b32 s42, s18, 16
    s_add_u32 s42, s42, s21
    s_lshl_b32 s44, s18, 12
    s_barrier
    s_add_u32 m0, s44, 73728
    s_add_u32 s22, s42, 0
    buffer_load_dwordx4 v8, s[12:15], s22 offen offset:0 lds
    s_add_u32 s22, s42, 15360
    buffer_load_dwordx4 v9, s[12:15], s22 offen offset:1024 lds
    s_add_u32 s22, s42, 30720
    buffer_load_dwordx4 v8, s[12:15], s22 offen offset:2048 lds
    s_add_u32 s22, s42, 46080
    buffer_load_dwordx4 v9, s[12:15], s22 offen offset:3072 lds
    s_add_u32 m0, s44, 90112
    s_add_u32 s22, s42, 262144
    buffer_load_dwordx4 v8, s[12:15], s22 offen offset:0 lds
    s_add_u32 s22, s42, 277504
    buffer_load_dwordx4 v9, s[12:15], s22 offen offset:1024 lds
    s_add_u32 s22, s42, 292864
    buffer_load_dwordx4 v8, s[12:15], s22 offen offset:2048 lds
    s_add_u32 s22, s42, 308224
    buffer_load_dwordx4 v9, s[12:15], s22 offen offset:3072 lds
    s_add_u32 m0, s44, 106496
    s_add_u32 s22, s42, 524288
    buffer_load_dwordx4 v8, s[12:15], s22 offen offset:0 lds
    s_add_u32 s22, s42, 539648
    buffer_load_dwordx4 v9, s[12:15], s22 offen offset:1024 lds
    s_add_u32 s22, s42, 555008
    buffer_load_dwordx4 v8, s[12:15], s22 offen offset:2048 lds
    s_add_u32 s22, s42, 570368
    buffer_load_dwordx4 v9, s[12:15], s22 offen offset:3072 lds
    s_add_u32 m0, s44, 122880
    s_add_u32 s22, s42, 786432
    buffer_load_dwordx4 v8, s[12:15], s22 offen offset:0 lds
    s_add_u32 s22, s42, 801792
    buffer_load_dwordx4 v9, s[12:15], s22 offen offset:1024 lds
    s_add_u32 s22, s42, 817152
    buffer_load_dwordx4 v8, s[12:15], s22 offen offset:2048 lds
    s_add_u32 s22, s42, 832512
    buffer_load_dwordx4 v9, s[12:15], s22 offen offset:3072 lds
    v_bfe_u32 v4, v0, 2, 2
    v_xor_b32 v5, s18, v4
    v_lshlrev_b32 v10, 6, v5
    v_lshl_add_u32 v10, v4, 9, v10
    v_and_b32 v4, 3, v0
    v_lshl_add_u32 v10, v4, 4, v10
    v_bfe_u32 v4, v0, 4, 2
    v_lshl_add_u32 v10, v4, 12, v10
    v_add_u32 v10, 73728, v10
    v_add_u32 v11, 49152, v10
    v_and_b32 v4, 63, v0
    v_and_b32 v5, 15, v4
    v_lshrrev_b32 v3, 4, v4
    v_lshrrev_b32 v2, 2, v5
    v_xor_b32 v3, v3, v2
    v_lshl_add_u32 v3, v5, 2, v3
    v_lshlrev_b32 v1, 4, v3
    v_lshrrev_b32 v5, 2, v4
    v_lshrrev_b32 v3, 4, v4
    v_and_b32 v4, 3, v4
    v_xor_b32 v4, v4, v3
    v_lshlrev_b32 v3, 3, v3
    v_and_b32 v5, 3, v5
    v_add_u32 v3, v3, v5
    v_mul_u32_u24 v2, 1152, v3
    v_lshl_add_u32 v2, v4, 4, v2
    s_mov_b32 s8, s48
    s_mov_b32 s9, s49
    s_mov_b32 s10, 2359296
    s_mov_b32 s11, 0x20000
    s_lshr_b32 s22, s18, 1
    s_mul_i32 s24, s22, 4608
    s_mul_i32 s25, s22, 18432
    s_and_b32 s22, s18, 1
    s_mul_i32 s23, s22, 576
    s_add_u32 s24, s24, s23
    s_mul_i32 s25, s18, 9216
    s_mul_i32 s22, s19, 36864
    s_add_u32 s24, s24, s22
    s_mov_b32 s20, 64
    s_lshl_b32 s22, s19, 5
    s_add_u32 s22, s22, s17
    s_lshl_b32 s26, s22, 14
    s_mul_i32 s23, s18, 3072
    s_add_u32 s26, s26, s23
    s_lshl_b32 s23, s16, 11
    s_add_u32 s26, s26, s23
    s_add_u32 s26, s26, -2048
    s_lshl_b32 s22, s22, 13
    s_add_u32 s22, s22, 33554432
    s_cmp_eq_u32 s16, 0
    s_cselect_b32 s26, s22, s26
    s_cselect_b32 s40, 4096, 64
    s_cselect_b32 s41, 1, 2
    s_max_u32 s40, s40, 1024
    s_lshl_b32 s41, s41, 18
    s_lshl_b32 s29, s17, 7
    s_lshl_b32 s22, s16, 4
    s_add_u32 s29, s29, s22
    s_lshl_b32 s22, s19, 2
    s_add_u32 s29, s29, s22
    s_add_u32 s29, s29, 125829120
    s_mov_b32 s27, 0
    s_add_u32 s23, s27, s25
    s_add_u32 m0, s23, 0
    s_nop 0
    buffer_load_dwordx4 v2, s[8:11], s24 offen offset:0 lds
    s_add_u32 m0, s23, 960
    s_nop 0
    buffer_load_dwordx4 v2, s[8:11], s24 offen offset:64 lds
    s_add_u32 m0, s23, 1920
    s_nop 0
    buffer_load_dwordx4 v2, s[8:11], s24 offen offset:128 lds
    s_add_u32 m0, s23, 2880
    s_nop 0
    buffer_load_dwordx4 v2, s[8:11], s24 offen offset:192 lds
    s_add_u32 m0, s23, 3840
    s_nop 0
    buffer_load_dwordx4 v2, s[8:11], s24 offen offset:256 lds
    s_add_u32 m0, s23, 4800
    s_nop 0
    buffer_load_dwordx4 v2, s[8:11], s24 offen offset:320 lds
    s_add_u32 m0, s23, 5760
    s_nop 0
    buffer_load_dwordx4 v2, s[8:11], s24 offen offset:384 lds
    s_add_u32 m0, s23, 6720
    s_nop 0
    buffer_load_dwordx4 v2, s[8:11], s24 offen offset:448 lds
    s_add_u32 m0, s23, 7680
    s_nop 0
    buffer_load_dwordx4 v2, s[8:11], s24 offen offset:512 lds
    s_add_u32 s24, s24, 147456
    s_waitcnt vmcnt(21) lgkmcnt(0)
    s_barrier
    s_add_u32 m0, s44, 139264
    s_add_u32 s22, s42, 1048576
    buffer_load_dwordx4 v8, s[12:15], s22 offen offset:0 lds
    s_add_u32 s22, s42, 1063936
    buffer_load_dwordx4 v9, s[12:15], s22 offen offset:1024 lds
    s_add_u32 s22, s42, 1079296
    buffer_load_dwordx4 v8, s[12:15], s22 offen offset:2048 lds
    s_add_u32 s22, s42, 1094656
    buffer_load_dwordx4 v9, s[12:15], s22 offen offset:3072 lds
    ds_read_b64_tr_b16 v[64:65], v10 offset:0
    ds_read_b64_tr_b16 v[66:67], v10 offset:2048
    ds_read_b64_tr_b16 v[136:137], v10 offset:8
    ds_read_b64_tr_b16 v[138:139], v10 offset:2056
    ds_read_b64_tr_b16 a[0:1], v10 offset:256
    ds_read_b64_tr_b16 a[2:3], v10 offset:2304
    ds_read_b64_tr_b16 a[72:73], v10 offset:264
    ds_read_b64_tr_b16 a[74:75], v10 offset:2312
    s_waitcnt vmcnt(21) lgkmcnt(0)
    s_barrier
    s_add_u32 m0, s44, 73728
    s_add_u32 s22, s42, 1310720
    buffer_load_dwordx4 v8, s[12:15], s22 offen offset:0 lds
    s_add_u32 s22, s42, 1326080
    buffer_load_dwordx4 v9, s[12:15], s22 offen offset:1024 lds
    s_add_u32 s22, s42, 1341440
    buffer_load_dwordx4 v8, s[12:15], s22 offen offset:2048 lds
    s_add_u32 s22, s42, 1356800
    buffer_load_dwordx4 v9, s[12:15], s22 offen offset:3072 lds
    ds_read_b64_tr_b16 v[68:69], v10 offset:16384
    ds_read_b64_tr_b16 v[70:71], v10 offset:18432
    ds_read_b64_tr_b16 v[140:141], v10 offset:16392
    ds_read_b64_tr_b16 v[142:143], v10 offset:18440
    ds_read_b64_tr_b16 a[4:5], v10 offset:16640
    ds_read_b64_tr_b16 a[6:7], v10 offset:18688
    ds_read_b64_tr_b16 a[76:77], v10 offset:16648
    ds_read_b64_tr_b16 a[78:79], v10 offset:18696
    s_waitcnt vmcnt(21) lgkmcnt(0)
    s_barrier
    s_add_u32 m0, s44, 90112
    s_add_u32 s22, s42, 1572864
    buffer_load_dwordx4 v8, s[12:15], s22 offen offset:0 lds
    s_add_u32 s22, s42, 1588224
    buffer_load_dwordx4 v9, s[12:15], s22 offen offset:1024 lds
    s_add_u32 s22, s42, 1603584
    buffer_load_dwordx4 v8, s[12:15], s22 offen offset:2048 lds
    s_add_u32 s22, s42, 1618944
    buffer_load_dwordx4 v9, s[12:15], s22 offen offset:3072 lds
    ds_read_b64_tr_b16 v[72:73], v10 offset:32768
    ds_read_b64_tr_b16 v[74:75], v10 offset:34816
    ds_read_b64_tr_b16 v[144:145], v10 offset:32776
    ds_read_b64_tr_b16 v[146:147], v10 offset:34824
    ds_read_b64_tr_b16 a[8:9], v10 offset:33024
    ds_read_b64_tr_b16 a[10:11], v10 offset:35072
    ds_read_b64_tr_b16 a[80:81], v10 offset:33032
    ds_read_b64_tr_b16 a[82:83], v10 offset:35080
    s_waitcnt vmcnt(21) lgkmcnt(0)
    s_barrier
    s_add_u32 m0, s44, 106496
    s_add_u32 s22, s42, 1835008
    buffer_load_dwordx4 v8, s[12:15], s22 offen offset:0 lds
    s_add_u32 s22, s42, 1850368
    buffer_load_dwordx4 v9, s[12:15], s22 offen offset:1024 lds
    s_add_u32 s22, s42, 1865728
    buffer_load_dwordx4 v8, s[12:15], s22 offen offset:2048 lds
    s_add_u32 s22, s42, 1881088
    buffer_load_dwordx4 v9, s[12:15], s22 offen offset:3072 lds
    ds_read_b64_tr_b16 v[76:77], v11 offset:0
    ds_read_b64_tr_b16 v[78:79], v11 offset:2048
    ds_read_b64_tr_b16 v[148:149], v11 offset:8
    ds_read_b64_tr_b16 v[150:151], v11 offset:2056
    ds_read_b64_tr_b16 a[12:13], v11 offset:256
    ds_read_b64_tr_b16 a[14:15], v11 offset:2304
    ds_read_b64_tr_b16 a[84:85], v11 offset:264
    ds_read_b64_tr_b16 a[86:87], v11 offset:2312
    s_waitcnt vmcnt(12) lgkmcnt(0)
    s_barrier
    s_add_u32 m0, s44, 122880
    s_add_u32 s22, s42, 2097152
    buffer_load_dwordx4 v8, s[12:15], s22 offen offset:0 lds
    s_add_u32 s22, s42, 2112512
    buffer_load_dwordx4 v9, s[12:15], s22 offen offset:1024 lds
    s_add_u32 s22, s42, 2127872
    buffer_load_dwordx4 v8, s[12:15], s22 offen offset:2048 lds
    s_add_u32 s22, s42, 2143232
    buffer_load_dwordx4 v9, s[12:15], s22 offen offset:3072 lds
    ds_read_b64_tr_b16 v[80:81], v11 offset:16384
    ds_read_b64_tr_b16 v[82:83], v11 offset:18432
    ds_read_b64_tr_b16 v[152:153], v11 offset:16392
    ds_read_b64_tr_b16 v[154:155], v11 offset:18440
    ds_read_b64_tr_b16 a[16:17], v11 offset:16640
    ds_read_b64_tr_b16 a[18:19], v11 offset:18688
    ds_read_b64_tr_b16 a[88:89], v11 offset:16648
    ds_read_b64_tr_b16 a[90:91], v11 offset:18696
    s_waitcnt vmcnt(12) lgkmcnt(0)
    s_barrier
    s_add_u32 m0, s44, 139264
    s_add_u32 s22, s42, 2359296
    buffer_load_dwordx4 v8, s[12:15], s22 offen offset:0 lds
    s_add_u32 s22, s42, 2374656
    buffer_load_dwordx4 v9, s[12:15], s22 offen offset:1024 lds
    s_add_u32 s22, s42, 2390016
    buffer_load_dwordx4 v8, s[12:15], s22 offen offset:2048 lds
    s_add_u32 s22, s42, 2405376
    buffer_load_dwordx4 v9, s[12:15], s22 offen offset:3072 lds
    ds_read_b64_tr_b16 v[84:85], v10 offset:0
    ds_read_b64_tr_b16 v[86:87], v10 offset:2048
    ds_read_b64_tr_b16 v[156:157], v10 offset:8
    ds_read_b64_tr_b16 v[158:159], v10 offset:2056
    ds_read_b64_tr_b16 a[20:21], v10 offset:256
    ds_read_b64_tr_b16 a[22:23], v10 offset:2304
    ds_read_b64_tr_b16 a[92:93], v10 offset:264
    ds_read_b64_tr_b16 a[94:95], v10 offset:2312
    s_waitcnt vmcnt(12) lgkmcnt(0)
    s_barrier
    s_add_u32 m0, s44, 73728
    s_add_u32 s22, s42, 2621440
    buffer_load_dwordx4 v8, s[12:15], s22 offen offset:0 lds
    s_add_u32 s22, s42, 2636800
    buffer_load_dwordx4 v9, s[12:15], s22 offen offset:1024 lds
    s_add_u32 s22, s42, 2652160
    buffer_load_dwordx4 v8, s[12:15], s22 offen offset:2048 lds
    s_add_u32 s22, s42, 2667520
    buffer_load_dwordx4 v9, s[12:15], s22 offen offset:3072 lds
    ds_read_b64_tr_b16 v[88:89], v10 offset:16384
    ds_read_b64_tr_b16 v[90:91], v10 offset:18432
    ds_read_b64_tr_b16 v[160:161], v10 offset:16392
    ds_read_b64_tr_b16 v[162:163], v10 offset:18440
    ds_read_b64_tr_b16 a[24:25], v10 offset:16640
    ds_read_b64_tr_b16 a[26:27], v10 offset:18688
    ds_read_b64_tr_b16 a[96:97], v10 offset:16648
    ds_read_b64_tr_b16 a[98:99], v10 offset:18696
    s_waitcnt vmcnt(12) lgkmcnt(0)
    s_barrier
    s_add_u32 m0, s44, 90112
    s_add_u32 s22, s42, 2883584
    buffer_load_dwordx4 v8, s[12:15], s22 offen offset:0 lds
    s_add_u32 s22, s42, 2898944
    buffer_load_dwordx4 v9, s[12:15], s22 offen offset:1024 lds
    s_add_u32 s22, s42, 2914304
    buffer_load_dwordx4 v8, s[12:15], s22 offen offset:2048 lds
    s_add_u32 s22, s42, 2929664
    buffer_load_dwordx4 v9, s[12:15], s22 offen offset:3072 lds
    ds_read_b64_tr_b16 v[92:93], v10 offset:32768
    ds_read_b64_tr_b16 v[94:95], v10 offset:34816
    ds_read_b64_tr_b16 v[164:165], v10 offset:32776
    ds_read_b64_tr_b16 v[166:167], v10 offset:34824
    ds_read_b64_tr_b16 a[28:29], v10 offset:33024
    ds_read_b64_tr_b16 a[30:31], v10 offset:35072
    ds_read_b64_tr_b16 a[100:101], v10 offset:33032
    ds_read_b64_tr_b16 a[102:103], v10 offset:35080
    s_waitcnt vmcnt(12) lgkmcnt(0)
    s_barrier
    s_add_u32 m0, s44, 106496
    s_add_u32 s22, s42, 3145728
    buffer_load_dwordx4 v8, s[12:15], s22 offen offset:0 lds
    s_add_u32 s22, s42, 3161088
    buffer_load_dwordx4 v9, s[12:15], s22 offen offset:1024 lds
    s_add_u32 s22, s42, 3176448
    buffer_load_dwordx4 v8, s[12:15], s22 offen offset:2048 lds
    s_add_u32 s22, s42, 3191808
    buffer_load_dwordx4 v9, s[12:15], s22 offen offset:3072 lds
    ds_read_b64_tr_b16 v[96:97], v11 offset:0
    ds_read_b64_tr_b16 v[98:99], v11 offset:2048
    ds_read_b64_tr_b16 v[168:169], v11 offset:8
    ds_read_b64_tr_b16 v[170:171], v11 offset:2056
    ds_read_b64_tr_b16 a[32:33], v11 offset:256
    ds_read_b64_tr_b16 a[34:35], v11 offset:2304
    ds_read_b64_tr_b16 a[104:105], v11 offset:264
    ds_read_b64_tr_b16 a[106:107], v11 offset:2312
    s_waitcnt vmcnt(12) lgkmcnt(0)
    s_barrier
    s_add_u32 m0, s44, 122880
    s_add_u32 s22, s42, 3407872
    buffer_load_dwordx4 v8, s[12:15], s22 offen offset:0 lds
    s_add_u32 s22, s42, 3423232
    buffer_load_dwordx4 v9, s[12:15], s22 offen offset:1024 lds
    s_add_u32 s22, s42, 3438592
    buffer_load_dwordx4 v8, s[12:15], s22 offen offset:2048 lds
    s_add_u32 s22, s42, 3453952
    buffer_load_dwordx4 v9, s[12:15], s22 offen offset:3072 lds
    ds_read_b64_tr_b16 v[100:101], v11 offset:16384
    ds_read_b64_tr_b16 v[102:103], v11 offset:18432
    ds_read_b64_tr_b16 v[172:173], v11 offset:16392
    ds_read_b64_tr_b16 v[174:175], v11 offset:18440
    ds_read_b64_tr_b16 a[36:37], v11 offset:16640
    ds_read_b64_tr_b16 a[38:39], v11 offset:18688
    ds_read_b64_tr_b16 a[108:109], v11 offset:16648
    ds_read_b64_tr_b16 a[110:111], v11 offset:18696
    s_waitcnt vmcnt(12) lgkmcnt(0)
    s_barrier
    s_add_u32 m0, s44, 139264
    s_add_u32 s22, s42, 3670016
    buffer_load_dwordx4 v8, s[12:15], s22 offen offset:0 lds
    s_add_u32 s22, s42, 3685376
    buffer_load_dwordx4 v9, s[12:15], s22 offen offset:1024 lds
    s_add_u32 s22, s42, 3700736
    buffer_load_dwordx4 v8, s[12:15], s22 offen offset:2048 lds
    s_add_u32 s22, s42, 3716096
    buffer_load_dwordx4 v9, s[12:15], s22 offen offset:3072 lds
    ds_read_b64_tr_b16 v[104:105], v10 offset:0
    ds_read_b64_tr_b16 v[106:107], v10 offset:2048
    ds_read_b64_tr_b16 v[176:177], v10 offset:8
    ds_read_b64_tr_b16 v[178:179], v10 offset:2056
    ds_read_b64_tr_b16 a[40:41], v10 offset:256
    ds_read_b64_tr_b16 a[42:43], v10 offset:2304
    ds_read_b64_tr_b16 a[112:113], v10 offset:264
    ds_read_b64_tr_b16 a[114:115], v10 offset:2312
    s_waitcnt vmcnt(12) lgkmcnt(0)
    s_barrier
    s_add_u32 m0, s44, 73728
    s_add_u32 s22, s42, 3932160
    buffer_load_dwordx4 v8, s[12:15], s22 offen offset:0 lds
    s_add_u32 s22, s42, 3947520
    buffer_load_dwordx4 v9, s[12:15], s22 offen offset:1024 lds
    s_add_u32 s22, s42, 3962880
    buffer_load_dwordx4 v8, s[12:15], s22 offen offset:2048 lds
    s_add_u32 s22, s42, 3978240
    buffer_load_dwordx4 v9, s[12:15], s22 offen offset:3072 lds
    ds_read_b64_tr_b16 v[108:109], v10 offset:16384
    ds_read_b64_tr_b16 v[110:111], v10 offset:18432
    ds_read_b64_tr_b16 v[180:181], v10 offset:16392
    ds_read_b64_tr_b16 v[182:183], v10 offset:18440
    ds_read_b64_tr_b16 a[44:45], v10 offset:16640
    ds_read_b64_tr_b16 a[46:47], v10 offset:18688
    ds_read_b64_tr_b16 a[116:117], v10 offset:16648
    ds_read_b64_tr_b16 a[118:119], v10 offset:18696
    s_waitcnt vmcnt(12) lgkmcnt(0)
    s_barrier
    s_add_u32 m0, s44, 90112
    s_add_u32 s22, s42, 4194304
    buffer_load_dwordx4 v8, s[12:15], s22 offen offset:0 lds
    s_add_u32 s22, s42, 4209664
    buffer_load_dwordx4 v9, s[12:15], s22 offen offset:1024 lds
    s_add_u32 s22, s42, 4225024
    buffer_load_dwordx4 v8, s[12:15], s22 offen offset:2048 lds
    s_add_u32 s22, s42, 4240384
    buffer_load_dwordx4 v9, s[12:15], s22 offen offset:3072 lds
    ds_read_b64_tr_b16 v[112:113], v10 offset:32768
    ds_read_b64_tr_b16 v[114:115], v10 offset:34816
    ds_read_b64_tr_b16 v[184:185], v10 offset:32776
    ds_read_b64_tr_b16 v[186:187], v10 offset:34824
    ds_read_b64_tr_b16 a[48:49], v10 offset:33024
    ds_read_b64_tr_b16 a[50:51], v10 offset:35072
    ds_read_b64_tr_b16 a[120:121], v10 offset:33032
    ds_read_b64_tr_b16 a[122:123], v10 offset:35080
    s_waitcnt vmcnt(12) lgkmcnt(0)
    s_barrier
    s_add_u32 m0, s44, 106496
    s_add_u32 s22, s42, 4456448
    buffer_load_dwordx4 v8, s[12:15], s22 offen offset:0 lds
    s_add_u32 s22, s42, 4471808
    buffer_load_dwordx4 v9, s[12:15], s22 offen offset:1024 lds
    s_add_u32 s22, s42, 4487168
    buffer_load_dwordx4 v8, s[12:15], s22 offen offset:2048 lds
    s_add_u32 s22, s42, 4502528
    buffer_load_dwordx4 v9, s[12:15], s22 offen offset:3072 lds
    ds_read_b64_tr_b16 v[116:117], v11 offset:0
    ds_read_b64_tr_b16 v[118:119], v11 offset:2048
    ds_read_b64_tr_b16 v[188:189], v11 offset:8
    ds_read_b64_tr_b16 v[190:191], v11 offset:2056
    ds_read_b64_tr_b16 a[52:53], v11 offset:256
    ds_read_b64_tr_b16 a[54:55], v11 offset:2304
    ds_read_b64_tr_b16 a[124:125], v11 offset:264
    ds_read_b64_tr_b16 a[126:127], v11 offset:2312
    s_waitcnt vmcnt(12) lgkmcnt(0)
    s_barrier
    s_mov_b32 s27, 36864
    s_add_u32 s23, s27, s25
    s_add_u32 m0, s23, 0
    s_nop 0
    buffer_load_dwordx4 v2, s[8:11], s24 offen offset:0 lds
    s_add_u32 m0, s23, 960
    s_nop 0
    buffer_load_dwordx4 v2, s[8:11], s24 offen offset:64 lds
    s_add_u32 m0, s23, 1920
    s_nop 0
    buffer_load_dwordx4 v2, s[8:11], s24 offen offset:128 lds
    s_add_u32 m0, s23, 2880
    s_nop 0
    buffer_load_dwordx4 v2, s[8:11], s24 offen offset:192 lds
    s_add_u32 m0, s23, 3840
    s_nop 0
    buffer_load_dwordx4 v2, s[8:11], s24 offen offset:256 lds
    s_add_u32 m0, s23, 4800
    s_nop 0
    buffer_load_dwordx4 v2, s[8:11], s24 offen offset:320 lds
    s_add_u32 m0, s23, 5760
    s_nop 0
    buffer_load_dwordx4 v2, s[8:11], s24 offen offset:384 lds
    s_add_u32 m0, s23, 6720
    s_nop 0
    buffer_load_dwordx4 v2, s[8:11], s24 offen offset:448 lds
    s_add_u32 m0, s23, 7680
    s_nop 0
    buffer_load_dwordx4 v2, s[8:11], s24 offen offset:512 lds
    s_add_u32 s24, s24, 147456
    ds_read_b64_tr_b16 v[120:121], v11 offset:16384
    ds_read_b64_tr_b16 v[122:123], v11 offset:18432
    ds_read_b64_tr_b16 v[192:193], v11 offset:16392
    ds_read_b64_tr_b16 v[194:195], v11 offset:18440
    ds_read_b64_tr_b16 a[56:57], v11 offset:16640
    ds_read_b64_tr_b16 a[58:59], v11 offset:18688
    ds_read_b64_tr_b16 a[128:129], v11 offset:16648
    ds_read_b64_tr_b16 a[130:131], v11 offset:18696
    s_waitcnt vmcnt(17) lgkmcnt(0)
    s_barrier
    ds_read_b64_tr_b16 v[124:125], v10 offset:0
    ds_read_b64_tr_b16 v[126:127], v10 offset:2048
    ds_read_b64_tr_b16 v[196:197], v10 offset:8
    ds_read_b64_tr_b16 v[198:199], v10 offset:2056
    ds_read_b64_tr_b16 a[60:61], v10 offset:256
    ds_read_b64_tr_b16 a[62:63], v10 offset:2304
    ds_read_b64_tr_b16 a[132:133], v10 offset:264
    ds_read_b64_tr_b16 a[134:135], v10 offset:2312
    s_waitcnt vmcnt(13) lgkmcnt(0)
    s_barrier
    ds_read_b64_tr_b16 v[128:129], v10 offset:16384
    ds_read_b64_tr_b16 v[130:131], v10 offset:18432
    ds_read_b64_tr_b16 v[200:201], v10 offset:16392
    ds_read_b64_tr_b16 v[202:203], v10 offset:18440
    ds_read_b64_tr_b16 a[64:65], v10 offset:16640
    ds_read_b64_tr_b16 a[66:67], v10 offset:18688
    ds_read_b64_tr_b16 a[136:137], v10 offset:16648
    ds_read_b64_tr_b16 a[138:139], v10 offset:18696
    s_waitcnt vmcnt(9) lgkmcnt(0)
    s_barrier
    ds_read_b64_tr_b16 v[132:133], v10 offset:32768
    ds_read_b64_tr_b16 v[134:135], v10 offset:34816
    ds_read_b64_tr_b16 v[204:205], v10 offset:32776
    ds_read_b64_tr_b16 v[206:207], v10 offset:34824
    ds_read_b64_tr_b16 a[68:69], v10 offset:33024
    ds_read_b64_tr_b16 a[70:71], v10 offset:35072
    ds_read_b64_tr_b16 a[140:141], v10 offset:33032
    ds_read_b64_tr_b16 a[142:143], v10 offset:35080
    s_mov_b32 s88, 4194304
gn8:
    buffer_load_dword v250, off, s[84:87], 0 offset:216 sc1
    s_waitcnt vmcnt(0)
    v_readfirstlane_b32 s95, v250
    s_sub_u32 s88, s88, 1
    s_cbranch_scc1 gn8x
    s_cmp_eq_u32 s95, 0
    s_cbranch_scc1 gn8
gn8x:
    s_waitcnt lgkmcnt(0)
    s_mov_b32 s45, 0
    s_mov_b32 s27, 0
    s_mov_b64 s[36:37], 0
    s_mov_b32 s12, 0
    s_mov_b32 s13, s40
    s_lshr_b32 s14, s41, 5
    s_add_u32 s15, s14, s40
    s_lshl_b32 s41, s41, 2
    s_sub_u32 s26, s26, s41
    v_mov_b32 v3, v1
    s_waitcnt vmcnt(0)
    s_barrier
    ds_read_b128 v[32:35], v3 offset:0
    ds_read_b128 v[36:39], v3 offset:18432
    ds_read_b128 v[40:43], v3 offset:1024
    ds_read_b128 v[44:47], v3 offset:19456
    s_cmp_eq_u32 s18, 0
    s_cselect_b32 s34, 1, 0
    s_mov_b32 s35, 0
    s_cmp_eq_u32 s16, 2
    s_cbranch_scc1 qk_vloop
qk_loop:
    s_barrier
    s_add_u32 s22, s27, 73728
    s_sub_u32 s21, s22, 110592
    s_cselect_b32 s22, s22, s21
    s_waitcnt lgkmcnt(2)
    v_mfma_f32_16x16x32_bf16 v[208:211], v[64:67], v[32:35], 0
    ds_read_b128 v[48:51], v3 offset:2048
    v_mfma_f32_16x16x32_bf16 v[212:215], v[136:139], v[32:35], 0
    ds_read_b128 v[52:55], v3 offset:20480
    v_mfma_f32_16x16x32_bf16 v[216:219], v[64:67], v[36:39], 0
    v_mfma_f32_16x16x32_bf16 v[220:223], v[136:139], v[36:39], 0
    v_mfma_f32_16x16x32_bf16 v[224:227], a[0:3], v[32:35], 0
    v_mfma_f32_16x16x32_bf16 v[228:231], a[72:75], v[32:35], 0
    v_mfma_f32_16x16x32_bf16 v[232:235], a[0:3], v[36:39], 0
    v_mfma_f32_16x16x32_bf16 v[236:239], a[72:75], v[36:39], 0
    s_waitcnt lgkmcnt(2)
    v_mfma_f32_16x16x32_bf16 v[208:211], v[68:71], v[40:43], v[208:211]
    ds_read_b128 v[32:35], v3 offset:3072
    v_mfma_f32_16x16x32_bf16 v[212:215], v[140:143], v[40:43], v[212:215]
    ds_read_b128 v[36:39], v3 offset:21504
    v_mfma_f32_16x16x32_bf16 v[216:219], v[68:71], v[44:47], v[216:219]
    s_add_u32 s23, s22, s25
    s_add_u32 m0, s23, 0
    s_nop 0
    buffer_load_dwordx4 v2, s[8:11], s24 offen offset:0 lds
    v_mfma_f32_16x16x32_bf16 v[220:223], v[140:143], v[44:47], v[220:223]
    v_mfma_f32_16x16x32_bf16 v[224:227], a[4:7], v[40:43], v[224:227]
    v_mfma_f32_16x16x32_bf16 v[228:231], a[76:79], v[40:43], v[228:231]
    v_mfma_f32_16x16x32_bf16 v[232:235], a[4:7], v[44:47], v[232:235]
    s_add_u32 m0, s23, 960
    s_nop 0
    buffer_load_dwordx4 v2, s[8:11], s24 offen offset:64 lds
    v_mfma_f32_16x16x32_bf16 v[236:239], a[76:79], v[44:47], v[236:239]
    s_waitcnt lgkmcnt(2)
    v_mfma_f32_16x16x32_bf16 v[208:211], v[72:75], v[48:51], v[208:211]
    ds_read_b128 v[40:43], v3 offset:4096
    v_mfma_f32_16x16x32_bf16 v[212:215], v[144:147], v[48:51], v[212:215]
    ds_read_b128 v[44:47], v3 offset:22528
    v_mfma_f32_16x16x32_bf16 v[216:219], v[72:75], v[52:55], v[216:219]
    s_add_u32 m0, s23, 1920
    s_nop 0
    buffer_load_dwordx4 v2, s[8:11], s24 offen offset:128 lds
    v_mfma_f32_16x16x32_bf16 v[220:223], v[144:147], v[52:55], v[220:223]
    v_mfma_f32_16x16x32_bf16 v[224:227], a[8:11], v[48:51], v[224:227]
    v_mfma_f32_16x16x32_bf16 v[228:231], a[80:83], v[48:51], v[228:231]
    v_mfma_f32_16x16x32_bf16 v[232:235], a[8:11], v[52:55], v[232:235]
    s_add_u32 m0, s23, 2880
    s_nop 0
    buffer_load_dwordx4 v2, s[8:11], s24 offen offset:192 lds
    v_mfma_f32_16x16x32_bf16 v[236:239], a[80:83], v[52:55], v[236:239]
    s_waitcnt lgkmcnt(2)
    v_mfma_f32_16x16x32_bf16 v[208:211], v[76:79], v[32:35], v[208:211]
    ds_read_b128 v[48:51], v3 offset:5120
    v_mfma_f32_16x16x32_bf16 v[212:215], v[148:151], v[32:35], v[212:215]
    ds_read_b128 v[52:55], v3 offset:23552
    v_mfma_f32_16x16x32_bf16 v[216:219], v[76:79], v[36:39], v[216:219]
    s_add_u32 m0, s23, 3840
    s_nop 0
    buffer_load_dwordx4 v2, s[8:11], s24 offen offset:256 lds
    v_mfma_f32_16x16x32_bf16 v[220:223], v[148:151], v[36:39], v[220:223]
    v_mfma_f32_16x16x32_bf16 v[224:227], a[12:15], v[32:35], v[224:227]
    v_mfma_f32_16x16x32_bf16 v[228:231], a[84:87], v[32:35], v[228:231]
    v_mfma_f32_16x16x32_bf16 v[232:235], a[12:15], v[36:39], v[232:235]
    s_add_u32 m0, s23, 4800
    s_nop 0
    buffer_load_dwordx4 v2, s[8:11], s24 offen offset:320 lds
    v_mfma_f32_16x16x32_bf16 v[236:239], a[84:87], v[36:39], v[236:239]
    s_waitcnt lgkmcnt(2)
    v_mfma_f32_16x16x32_bf16 v[208:211], v[80:83], v[40:43], v[208:211]
    ds_read_b128 v[32:35], v3 offset:6144
    v_mfma_f32_16x16x32_bf16 v[212:215], v[152:155], v[40:43], v[212:215]
    ds_read_b128 v[36:39], v3 offset:24576
    v_mfma_f32_16x16x32_bf16 v[216:219], v[80:83], v[44:47], v[216:219]
    s_add_u32 m0, s23, 5760
    s_nop 0
    buffer_load_dwordx4 v2, s[8:11], s24 offen offset:384 lds
    v_mfma_f32_16x16x32_bf16 v[220:223], v[152:155], v[44:47], v[220:223]
    v_mfma_f32_16x16x32_bf16 v[224:227], a[16:19], v[40:43], v[224:227]
    v_mfma_f32_16x16x32_bf16 v[228:231], a[88:91], v[40:43], v[228:231]
    v_mfma_f32_16x16x32_bf16 v[232:235], a[16:19], v[44:47], v[232:235]
    s_add_u32 m0, s23, 6720
    s_nop 0
    buffer_load_dwordx4 v2, s[8:11], s24 offen offset:448 lds
    v_mfma_f32_16x16x32_bf16 v[236:239], a[88:91], v[44:47], v[236:239]
    s_waitcnt lgkmcnt(2)
    v_mfma_f32_16x16x32_bf16 v[208:211], v[84:87], v[48:51], v[208:211]
    ds_read_b128 v[40:43], v3 offset:7168
    v_mfma_f32_16x16x32_bf16 v[212:215], v[156:159], v[48:51], v[212:215]
    ds_read_b128 v[44:47], v3 offset:25600
    v_mfma_f32_16x16x32_bf16 v[216:219], v[84:87], v[52:55], v[216:219]
    s_add_u32 m0, s23, 7680
    s_nop 0
    buffer_load_dwordx4 v2, s[8:11], s24 offen offset:512 lds
    s_add_u32 s24, s24, 147456
    v_mfma_f32_16x16x32_bf16 v[220:223], v[156:159], v[52:55], v[220:223]
    v_mfma_f32_16x16x32_bf16 v[224:227], a[20:23], v[48:51], v[224:227]
    v_mfma_f32_16x16x32_bf16 v[228:231], a[92:95], v[48:51], v[228:231]
    v_mfma_f32_16x16x32_bf16 v[232:235], a[20:23], v[52:55], v[232:235]
    v_mfma_f32_16x16x32_bf16 v[236:239], a[92:95], v[52:55], v[236:239]
    s_waitcnt lgkmcnt(2)
    v_mfma_f32_16x16x32_bf16 v[208:211], v[88:91], v[32:35], v[208:211]
    ds_read_b128 v[48:51], v3 offset:8192
    v_mfma_f32_16x16x32_bf16 v[212:215], v[160:163], v[32:35], v[212:215]
    ds_read_b128 v[52:55], v3 offset:26624
    v_mfma_f32_16x16x32_bf16 v[216:219], v[88:91], v[36:39], v[216:219]
    v_mfma_f32_16x16x32_bf16 v[220:223], v[160:163], v[36:39], v[220:223]
    v_mfma_f32_16x16x32_bf16 v[224:227], a[24:27], v[32:35], v[224:227]
    v_mfma_f32_16x16x32_bf16 v[228:231], a[96:99], v[32:35], v[228:231]
    v_mfma_f32_16x16x32_bf16 v[232:235], a[24:27], v[36:39], v[232:235]
    v_mfma_f32_16x16x32_bf16 v[236:239], a[96:99], v[36:39], v[236:239]
    s_waitcnt lgkmcnt(2)
    v_mfma_f32_16x16x32_bf16 v[208:211], v[92:95], v[40:43], v[208:211]
    ds_read_b128 v[32:35], v3 offset:9216
    v_mfma_f32_16x16x32_bf16 v[212:215], v[164:167], v[40:43], v[212:215]
    ds_read_b128 v[36:39], v3 offset:27648
    v_mfma_f32_16x16x32_bf16 v[216:219], v[92:95], v[44:47], v[216:219]
    s_add_u32 s23, s45, s95
    v_mov_b32 v4, s23
    s_mov_b64 exec, s[34:35]
    buffer_store_dword v4, off, s[4:7], s29 sc1
    buffer_store_dword v4, off, s[4:7], s29 offset:128 sc1
    s_mov_b64 exec, -1
    v_mfma_f32_16x16x32_bf16 v[220:223], v[164:167], v[44:47], v[220:223]
    v_mfma_f32_16x16x32_bf16 v[224:227], a[28:31], v[40:43], v[224:227]
    v_mfma_f32_16x16x32_bf16 v[228:231], a[100:103], v[40:43], v[228:231]
    v_mfma_f32_16x16x32_bf16 v[232:235], a[28:31], v[44:47], v[232:235]
    v_mfma_f32_16x16x32_bf16 v[236:239], a[100:103], v[44:47], v[236:239]
    s_waitcnt lgkmcnt(2)
    v_mfma_f32_16x16x32_bf16 v[208:211], v[96:99], v[48:51], v[208:211]
    ds_read_b128 v[40:43], v3 offset:10240
    v_mfma_f32_16x16x32_bf16 v[212:215], v[168:171], v[48:51], v[212:215]
    ds_read_b128 v[44:47], v3 offset:28672
    v_mfma_f32_16x16x32_bf16 v[216:219], v[96:99], v[52:55], v[216:219]
    s_cmp_lt_u32 s19, 60
    s_cbranch_scc1 lt9
    buffer_load_dwordx4 v[244:247], off, s[84:87], 0 offset:16 sc1
    buffer_load_dword v248, off, s[84:87], 0 offset:4 sc1
lt9:
    v_mfma_f32_16x16x32_bf16 v[220:223], v[168:171], v[52:55], v[220:223]
    v_mfma_f32_16x16x32_bf16 v[224:227], a[32:35], v[48:51], v[224:227]
    v_mfma_f32_16x16x32_bf16 v[228:231], a[104:107], v[48:51], v[228:231]
    v_mfma_f32_16x16x32_bf16 v[232:235], a[32:35], v[52:55], v[232:235]
    v_mfma_f32_16x16x32_bf16 v[236:239], a[104:107], v[52:55], v[236:239]
    s_waitcnt lgkmcnt(2)
    v_mfma_f32_16x16x32_bf16 v[208:211], v[100:103], v[32:35], v[208:211]
    ds_read_b128 v[48:51], v3 offset:11264
    v_mfma_f32_16x16x32_bf16 v[212:215], v[172:175], v[32:35], v[212:215]
    ds_read_b128 v[52:55], v3 offset:29696
    v_mfma_f32_16x16x32_bf16 v[216:219], v[100:103], v[36:39], v[216:219]
    v_mfma_f32_16x16x32_bf16 v[220:223], v[172:175], v[36:39], v[220:223]
    v_mfma_f32_16x16x32_bf16 v[224:227], a[36:39], v[32:35], v[224:227]
    v_mfma_f32_16x16x32_bf16 v[228:231], a[108:111], v[32:35], v[228:231]
    v_mfma_f32_16x16x32_bf16 v[232:235], a[36:39], v[36:39], v[232:235]
    v_mfma_f32_16x16x32_bf16 v[236:239], a[108:111], v[36:39], v[236:239]
    s_waitcnt lgkmcnt(2)
    v_mfma_f32_16x16x32_bf16 v[208:211], v[104:107], v[40:43], v[208:211]
    ds_read_b128 v[32:35], v3 offset:12288
    v_mfma_f32_16x16x32_bf16 v[212:215], v[176:179], v[40:43], v[212:215]
    ds_read_b128 v[36:39], v3 offset:30720
    v_mfma_f32_16x16x32_bf16 v[216:219], v[104:107], v[44:47], v[216:219]
    v_mfma_f32_16x16x32_bf16 v[220:223], v[176:179], v[44:47], v[220:223]
    v_mfma_f32_16x16x32_bf16 v[224:227], a[40:43], v[40:43], v[224:227]
    v_mfma_f32_16x16x32_bf16 v[228:231], a[112:115], v[40:43], v[228:231]
    v_mfma_f32_16x16x32_bf16 v[232:235], a[40:43], v[44:47], v[232:235]
    v_mfma_f32_16x16x32_bf16 v[236:239], a[112:115], v[44:47], v[236:239]
    s_waitcnt lgkmcnt(2)
    v_mfma_f32_16x16x32_bf16 v[208:211], v[108:111], v[48:51], v[208:211]
    ds_read_b128 v[40:43], v3 offset:13312
    v_mfma_f32_16x16x32_bf16 v[212:215], v[180:183], v[48:51], v[212:215]
    ds_read_b128 v[44:47], v3 offset:31744
    v_mfma_f32_16x16x32_bf16 v[216:219], v[108:111], v[52:55], v[216:219]
    v_mfma_f32_16x16x32_bf16 v[220:223], v[180:183], v[52:55], v[220:223]
    v_mfma_f32_16x16x32_bf16 v[224:227], a[44:47], v[48:51], v[224:227]
    v_mfma_f32_16x16x32_bf16 v[228:231], a[116:119], v[48:51], v[228:231]
    v_mfma_f32_16x16x32_bf16 v[232:235], a[44:47], v[52:55], v[232:235]
    v_mfma_f32_16x16x32_bf16 v[236:239], a[116:119], v[52:55], v[236:239]
    s_waitcnt lgkmcnt(2)
    v_mfma_f32_16x16x32_bf16 v[208:211], v[112:115], v[32:35], v[208:211]
    ds_read_b128 v[48:51], v3 offset:14336
    v_mfma_f32_16x16x32_bf16 v[212:215], v[184:187], v[32:35], v[212:215]
    ds_read_b128 v[52:55], v3 offset:32768
    v_mfma_f32_16x16x32_bf16 v[216:219], v[112:115], v[36:39], v[216:219]
    v_mfma_f32_16x16x32_bf16 v[220:223], v[184:187], v[36:39], v[220:223]
    v_mfma_f32_16x16x32_bf16 v[224:227], a[48:51], v[32:35], v[224:227]
    v_mfma_f32_16x16x32_bf16 v[228:231], a[120:123], v[32:35], v[228:231]
    v_mfma_f32_16x16x32_bf16 v[232:235], a[48:51], v[36:39], v[232:235]
    v_mfma_f32_16x16x32_bf16 v[236:239], a[120:123], v[36:39], v[236:239]
    s_waitcnt lgkmcnt(2)
    v_mfma_f32_16x16x32_bf16 v[208:211], v[116:119], v[40:43], v[208:211]
    ds_read_b128 v[32:35], v3 offset:15360
    v_mfma_f32_16x16x32_bf16 v[212:215], v[188:191], v[40:43], v[212:215]
    ds_read_b128 v[36:39], v3 offset:33792
    v_mfma_f32_16x16x32_bf16 v[216:219], v[116:119], v[44:47], v[216:219]
    v_mfma_f32_16x16x32_bf16 v[220:223], v[188:191], v[44:47], v[220:223]
    v_mfma_f32_16x16x32_bf16 v[224:227], a[52:55], v[40:43], v[224:227]
    v_mfma_f32_16x16x32_bf16 v[228:231], a[124:127], v[40:43], v[228:231]
    v_mfma_f32_16x16x32_bf16 v[232:235], a[52:55], v[44:47], v[232:235]
    v_mfma_f32_16x16x32_bf16 v[236:239], a[124:127], v[44:47], v[236:239]
    s_waitcnt lgkmcnt(2)
    v_mfma_f32_16x16x32_bf16 v[208:211], v[120:123], v[48:51], v[208:211]
    ds_read_b128 v[40:43], v3 offset:16384
    v_mfma_f32_16x16x32_bf16 v[212:215], v[192:195], v[48:51], v[212:215]
    ds_read_b128 v[44:47], v3 offset:34816
    v_mfma_f32_16x16x32_bf16 v[216:219], v[120:123], v[52:55], v[216:219]
    v_mfma_f32_16x16x32_bf16 v[220:223], v[192:195], v[52:55], v[220:223]
    v_mfma_f32_16x16x32_bf16 v[224:227], a[56:59], v[48:51], v[224:227]
    v_mfma_f32_16x16x32_bf16 v[228:231], a[128:131], v[48:51], v[228:231]
    v_mfma_f32_16x16x32_bf16 v[232:235], a[56:59], v[52:55], v[232:235]
    v_mfma_f32_16x16x32_bf16 v[236:239], a[128:131], v[52:55], v[236:239]
    s_waitcnt lgkmcnt(2)
    v_mfma_f32_16x16x32_bf16 v[208:211], v[124:127], v[32:35], v[208:211]
    ds_read_b128 v[48:51], v3 offset:17408
    v_mfma_f32_16x16x32_bf16 v[212:215], v[196:199], v[32:35], v[212:215]
    ds_read_b128 v[52:55], v3 offset:35840
    v_mfma_f32_16x16x32_bf16 v[216:219], v[124:127], v[36:39], v[216:219]
    v_mfma_f32_16x16x32_bf16 v[220:223], v[196:199], v[36:39], v[220:223]
    v_mfma_f32_16x16x32_bf16 v[224:227], a[60:63], v[32:35], v[224:227]
    s_add_u32 s27, s27, 36864
    s_cmp_eq_u32 s27, 110592
    s_cselect_b32 s27, 0, s27
    v_add_u32 v3, s27, v1
    v_mfma_f32_16x16x32_bf16 v[228:231], a[132:135], v[32:35], v[228:231]
    v_mfma_f32_16x16x32_bf16 v[232:235], a[60:63], v[36:39], v[232:235]
    v_mfma_f32_16x16x32_bf16 v[236:239], a[132:135], v[36:39], v[236:239]
    s_waitcnt lgkmcnt(2)
    v_mfma_f32_16x16x32_bf16 v[208:211], v[128:131], v[40:43], v[208:211]
    ds_read_b128 v[32:35], v3 offset:0
    v_mfma_f32_16x16x32_bf16 v[212:215], v[200:203], v[40:43], v[212:215]
    ds_read_b128 v[36:39], v3 offset:18432
    v_mfma_f32_16x16x32_bf16 v[216:219], v[128:131], v[44:47], v[216:219]
    v_mfma_f32_16x16x32_bf16 v[220:223], v[200:203], v[44:47], v[220:223]
    v_mfma_f32_16x16x32_bf16 v[224:227], a[64:67], v[40:43], v[224:227]
    v_mfma_f32_16x16x32_bf16 v[228:231], a[136:139], v[40:43], v[228:231]
    v_mfma_f32_16x16x32_bf16 v[232:235], a[64:67], v[44:47], v[232:235]
    v_mfma_f32_16x16x32_bf16 v[236:239], a[136:139], v[44:47], v[236:239]
    s_waitcnt lgkmcnt(2)
    v_mfma_f32_16x16x32_bf16 v[208:211], v[132:135], v[48:51], v[208:211]
    ds_read_b128 v[40:43], v3 offset:1024
    v_mfma_f32_16x16x32_bf16 v[212:215], v[204:207], v[48:51], v[212:215]
    ds_read_b128 v[44:47], v3 offset:19456
    v_mfma_f32_16x16x32_bf16 v[216:219], v[132:135], v[52:55], v[216:219]
    v_mfma_f32_16x16x32_bf16 v[220:223], v[204:207], v[52:55], v[220:223]
    v_mfma_f32_16x16x32_bf16 v[224:227], a[68:71], v[48:51], v[224:227]
    v_mfma_f32_16x16x32_bf16 v[228:231], a[140:143], v[48:51], v[228:231]
    v_mfma_f32_16x16x32_bf16 v[232:235], a[68:71], v[52:55], v[232:235]
    v_mfma_f32_16x16x32_bf16 v[236:239], a[140:143], v[52:55], v[236:239]
    s_add_u32 s26, s26, s41
    s_waitcnt vmcnt(0)
    v_cvt_pk_bf16_f32 v8, v208, v209
    v_cvt_pk_bf16_f32 v9, v210, v211
    v_cvt_pk_bf16_f32 v10, v212, v213
    v_cvt_pk_bf16_f32 v11, v214, v215
    v_cvt_pk_bf16_f32 v12, v216, v217
    v_cvt_pk_bf16_f32 v13, v218, v219
    v_cvt_pk_bf16_f32 v14, v220, v221
    v_cvt_pk_bf16_f32 v15, v222, v223
    v_cvt_pk_bf16_f32 v16, v224, v225
    v_cvt_pk_bf16_f32 v17, v226, v227
    v_cvt_pk_bf16_f32 v18, v228, v229
    v_cvt_pk_bf16_f32 v19, v230, v231
    v_cvt_pk_bf16_f32 v20, v232, v233
    v_cvt_pk_bf16_f32 v21, v234, v235
    v_cvt_pk_bf16_f32 v22, v236, v237
    v_cvt_pk_bf16_f32 v23, v238, v239
    s_mov_b64 s[36:37], -1
    s_add_u32 s28, s26, s12
    buffer_store_dwordx4 v[8:11], v7, s[4:7], s28 offen sc1
    s_add_u32 s28, s26, s13
    buffer_store_dwordx4 v[12:15], v7, s[4:7], s28 offen sc1
    s_add_u32 s28, s26, s14
    buffer_store_dwordx4 v[16:19], v7, s[4:7], s28 offen sc1
    s_add_u32 s28, s26, s15
    buffer_store_dwordx4 v[20:23], v7, s[4:7], s28 offen sc1
    s_lshr_b32 s45, s19, 2
    s_cbranch_scc1 qk_loop_nf
    s_mov_b32 s45, 1
    s_mov_b64 s[36:37], 0
    s_waitcnt vmcnt(0)
    s_barrier
    s_add_u32 s23, s45, s95
    v_mov_b32 v4, s23
    s_mov_b64 exec, s[34:35]
    buffer_store_dword v4, off, s[4:7], s29 sc1
    buffer_store_dword v4, off, s[4:7], s29 offset:128 sc1
    s_mov_b64 exec, -1
qk_loop_nf:
    s_add_u32 s19, s19, 4
    s_cmp_lt_u32 s19, s20
    s_cbranch_scc1 qk_loop
    s_branch qk_done
qk_vloop:
    s_barrier
    s_add_u32 s22, s27, 73728
    s_sub_u32 s21, s22, 110592
    s_cselect_b32 s22, s22, s21
    s_waitcnt lgkmcnt(2)
    v_mfma_f32_16x16x32_bf16 v[208:211], v[32:35], v[64:67], 0
    ds_read_b128 v[48:51], v3 offset:2048
    v_mfma_f32_16x16x32_bf16 v[212:215], v[32:35], v[136:139], 0
    ds_read_b128 v[52:55], v3 offset:20480
    v_mfma_f32_16x16x32_bf16 v[216:219], v[36:39], v[64:67], 0
    v_mfma_f32_16x16x32_bf16 v[220:223], v[36:39], v[136:139], 0
    v_mfma_f32_16x16x32_bf16 v[224:227], v[32:35], a[0:3], 0
    v_mfma_f32_16x16x32_bf16 v[228:231], v[32:35], a[72:75], 0
    v_mfma_f32_16x16x32_bf16 v[232:235], v[36:39], a[0:3], 0
    v_mfma_f32_16x16x32_bf16 v[236:239], v[36:39], a[72:75], 0
    s_waitcnt lgkmcnt(2)
    v_mfma_f32_16x16x32_bf16 v[208:211], v[40:43], v[68:71], v[208:211]
    ds_read_b128 v[32:35], v3 offset:3072
    v_mfma_f32_16x16x32_bf16 v[212:215], v[40:43], v[140:143], v[212:215]
    ds_read_b128 v[36:39], v3 offset:21504
    v_mfma_f32_16x16x32_bf16 v[216:219], v[44:47], v[68:71], v[216:219]
    s_add_u32 s23, s22, s25
    s_add_u32 m0, s23, 0
    s_nop 0
    buffer_load_dwordx4 v2, s[8:11], s24 offen offset:0 lds
    v_mfma_f32_16x16x32_bf16 v[220:223], v[44:47], v[140:143], v[220:223]
    v_mfma_f32_16x16x32_bf16 v[224:227], v[40:43], a[4:7], v[224:227]
    v_mfma_f32_16x16x32_bf16 v[228:231], v[40:43], a[76:79], v[228:231]
    v_mfma_f32_16x16x32_bf16 v[232:235], v[44:47], a[4:7], v[232:235]
    s_add_u32 m0, s23, 960
    s_nop 0
    buffer_load_dwordx4 v2, s[8:11], s24 offen offset:64 lds
    v_mfma_f32_16x16x32_bf16 v[236:239], v[44:47], a[76:79], v[236:239]
    s_waitcnt lgkmcnt(2)
    v_mfma_f32_16x16x32_bf16 v[208:211], v[48:51], v[72:75], v[208:211]
    ds_read_b128 v[40:43], v3 offset:4096
    v_mfma_f32_16x16x32_bf16 v[212:215], v[48:51], v[144:147], v[212:215]
    ds_read_b128 v[44:47], v3 offset:22528
    v_mfma_f32_16x16x32_bf16 v[216:219], v[52:55], v[72:75], v[216:219]
    s_add_u32 m0, s23, 1920
    s_nop 0
    buffer_load_dwordx4 v2, s[8:11], s24 offen offset:128 lds
    v_mfma_f32_16x16x32_bf16 v[220:223], v[52:55], v[144:147], v[220:223]
    v_mfma_f32_16x16x32_bf16 v[224:227], v[48:51], a[8:11], v[224:227]
    v_mfma_f32_16x16x32_bf16 v[228:231], v[48:51], a[80:83], v[228:231]
    v_mfma_f32_16x16x32_bf16 v[232:235], v[52:55], a[8:11], v[232:235]
    s_add_u32 m0, s23, 2880
    s_nop 0
    buffer_load_dwordx4 v2, s[8:11], s24 offen offset:192 lds
    v_mfma_f32_16x16x32_bf16 v[236:239], v[52:55], a[80:83], v[236:239]
    s_waitcnt lgkmcnt(2)
    v_mfma_f32_16x16x32_bf16 v[208:211], v[32:35], v[76:79], v[208:211]
    ds_read_b128 v[48:51], v3 offset:5120
    v_mfma_f32_16x16x32_bf16 v[212:215], v[32:35], v[148:151], v[212:215]
    ds_read_b128 v[52:55], v3 offset:23552
    v_mfma_f32_16x16x32_bf16 v[216:219], v[36:39], v[76:79], v[216:219]
    s_add_u32 m0, s23, 3840
    s_nop 0
    buffer_load_dwordx4 v2, s[8:11], s24 offen offset:256 lds
    v_mfma_f32_16x16x32_bf16 v[220:223], v[36:39], v[148:151], v[220:223]
    v_mfma_f32_16x16x32_bf16 v[224:227], v[32:35], a[12:15], v[224:227]
    v_mfma_f32_16x16x32_bf16 v[228:231], v[32:35], a[84:87], v[228:231]
    v_mfma_f32_16x16x32_bf16 v[232:235], v[36:39], a[12:15], v[232:235]
    s_add_u32 m0, s23, 4800
    s_nop 0
    buffer_load_dwordx4 v2, s[8:11], s24 offen offset:320 lds
    v_mfma_f32_16x16x32_bf16 v[236:239], v[36:39], a[84:87], v[236:239]
    s_waitcnt lgkmcnt(2)
    v_mfma_f32_16x16x32_bf16 v[208:211], v[40:43], v[80:83], v[208:211]
    ds_read_b128 v[32:35], v3 offset:6144
    v_mfma_f32_16x16x32_bf16 v[212:215], v[40:43], v[152:155], v[212:215]
    ds_read_b128 v[36:39], v3 offset:24576
    v_mfma_f32_16x16x32_bf16 v[216:219], v[44:47], v[80:83], v[216:219]
    s_add_u32 m0, s23, 5760
    s_nop 0
    buffer_load_dwordx4 v2, s[8:11], s24 offen offset:384 lds
    v_mfma_f32_16x16x32_bf16 v[220:223], v[44:47], v[152:155], v[220:223]
    v_mfma_f32_16x16x32_bf16 v[224:227], v[40:43], a[16:19], v[224:227]
    v_mfma_f32_16x16x32_bf16 v[228:231], v[40:43], a[88:91], v[228:231]
    v_mfma_f32_16x16x32_bf16 v[232:235], v[44:47], a[16:19], v[232:235]
    s_add_u32 m0, s23, 6720
    s_nop 0
    buffer_load_dwordx4 v2, s[8:11], s24 offen offset:448 lds
    v_mfma_f32_16x16x32_bf16 v[236:239], v[44:47], a[88:91], v[236:239]
    s_waitcnt lgkmcnt(2)
    v_mfma_f32_16x16x32_bf16 v[208:211], v[48:51], v[84:87], v[208:211]
    ds_read_b128 v[40:43], v3 offset:7168
    v_mfma_f32_16x16x32_bf16 v[212:215], v[48:51], v[156:159], v[212:215]
    ds_read_b128 v[44:47], v3 offset:25600
    v_mfma_f32_16x16x32_bf16 v[216:219], v[52:55], v[84:87], v[216:219]
    s_add_u32 m0, s23, 7680
    s_nop 0
    buffer_load_dwordx4 v2, s[8:11], s24 offen offset:512 lds
    s_add_u32 s24, s24, 147456
    v_mfma_f32_16x16x32_bf16 v[220:223], v[52:55], v[156:159], v[220:223]
    v_mfma_f32_16x16x32_bf16 v[224:227], v[48:51], a[20:23], v[224:227]
    v_mfma_f32_16x16x32_bf16 v[228:231], v[48:51], a[92:95], v[228:231]
    v_mfma_f32_16x16x32_bf16 v[232:235], v[52:55], a[20:23], v[232:235]
    v_mfma_f32_16x16x32_bf16 v[236:239], v[52:55], a[92:95], v[236:239]
    s_waitcnt lgkmcnt(2)
    v_mfma_f32_16x16x32_bf16 v[208:211], v[32:35], v[88:91], v[208:211]
    ds_read_b128 v[48:51], v3 offset:8192
    v_mfma_f32_16x16x32_bf16 v[212:215], v[32:35], v[160:163], v[212:215]
    ds_read_b128 v[52:55], v3 offset:26624
    v_mfma_f32_16x16x32_bf16 v[216:219], v[36:39], v[88:91], v[216:219]
    v_mfma_f32_16x16x32_bf16 v[220:223], v[36:39], v[160:163], v[220:223]
    v_mfma_f32_16x16x32_bf16 v[224:227], v[32:35], a[24:27], v[224:227]
    v_mfma_f32_16x16x32_bf16 v[228:231], v[32:35], a[96:99], v[228:231]
    v_mfma_f32_16x16x32_bf16 v[232:235], v[36:39], a[24:27], v[232:235]
    v_mfma_f32_16x16x32_bf16 v[236:239], v[36:39], a[96:99], v[236:239]
    s_waitcnt lgkmcnt(2)
    v_mfma_f32_16x16x32_bf16 v[208:211], v[40:43], v[92:95], v[208:211]
    ds_read_b128 v[32:35], v3 offset:9216
    v_mfma_f32_16x16x32_bf16 v[212:215], v[40:43], v[164:167], v[212:215]
    ds_read_b128 v[36:39], v3 offset:27648
    v_mfma_f32_16x16x32_bf16 v[216:219], v[44:47], v[92:95], v[216:219]
    s_add_u32 s23, s45, s95
    v_mov_b32 v4, s23
    s_mov_b64 exec, s[34:35]
    buffer_store_dword v4, off, s[4:7], s29 sc1
    buffer_store_dword v4, off, s[4:7], s29 offset:128 sc1
    s_mov_b64 exec, -1
    v_mfma_f32_16x16x32_bf16 v[220:223], v[44:47], v[164:167], v[220:223]
    v_mfma_f32_16x16x32_bf16 v[224:227], v[40:43], a[28:31], v[224:227]
    v_mfma_f32_16x16x32_bf16 v[228:231], v[40:43], a[100:103], v[228:231]
    v_mfma_f32_16x16x32_bf16 v[232:235], v[44:47], a[28:31], v[232:235]
    v_mfma_f32_16x16x32_bf16 v[236:239], v[44:47], a[100:103], v[236:239]
    s_waitcnt lgkmcnt(2)
    v_mfma_f32_16x16x32_bf16 v[208:211], v[48:51], v[96:99], v[208:211]
    ds_read_b128 v[40:43], v3 offset:10240
    v_mfma_f32_16x16x32_bf16 v[212:215], v[48:51], v[168:171], v[212:215]
    ds_read_b128 v[44:47], v3 offset:28672
    v_mfma_f32_16x16x32_bf16 v[216:219], v[52:55], v[96:99], v[216:219]
    s_cmp_lt_u32 s19, 60
    s_cbranch_scc1 lt10
    buffer_load_dwordx4 v[244:247], off, s[84:87], 0 offset:16 sc1
    buffer_load_dword v248, off, s[84:87], 0 offset:4 sc1
lt10:
    v_mfma_f32_16x16x32_bf16 v[220:223], v[52:55], v[168:171], v[220:223]
    v_mfma_f32_16x16x32_bf16 v[224:227], v[48:51], a[32:35], v[224:227]
    v_mfma_f32_16x16x32_bf16 v[228:231], v[48:51], a[104:107], v[228:231]
    v_mfma_f32_16x16x32_bf16 v[232:235], v[52:55], a[32:35], v[232:235]
    v_mfma_f32_16x16x32_bf16 v[236:239], v[52:55], a[104:107], v[236:239]
    s_waitcnt lgkmcnt(2)
    v_mfma_f32_16x16x32_bf16 v[208:211], v[32:35], v[100:103], v[208:211]
    ds_read_b128 v[48:51], v3 offset:11264
    v_mfma_f32_16x16x32_bf16 v[212:215], v[32:35], v[172:175], v[212:215]
    ds_read_b128 v[52:55], v3 offset:29696
    v_mfma_f32_16x16x32_bf16 v[216:219], v[36:39], v[100:103], v[216:219]
    v_mfma_f32_16x16x32_bf16 v[220:223], v[36:39], v[172:175], v[220:223]
    v_mfma_f32_16x16x32_bf16 v[224:227], v[32:35], a[36:39], v[224:227]
    v_mfma_f32_16x16x32_bf16 v[228:231], v[32:35], a[108:111], v[228:231]
    v_mfma_f32_16x16x32_bf16 v[232:235], v[36:39], a[36:39], v[232:235]
    v_mfma_f32_16x16x32_bf16 v[236:239], v[36:39], a[108:111], v[236:239]
    s_waitcnt lgkmcnt(2)
    v_mfma_f32_16x16x32_bf16 v[208:211], v[40:43], v[104:107], v[208:211]
    ds_read_b128 v[32:35], v3 offset:12288
    v_mfma_f32_16x16x32_bf16 v[212:215], v[40:43], v[176:179], v[212:215]
    ds_read_b128 v[36:39], v3 offset:30720
    v_mfma_f32_16x16x32_bf16 v[216:219], v[44:47], v[104:107], v[216:219]
    v_mfma_f32_16x16x32_bf16 v[220:223], v[44:47], v[176:179], v[220:223]
    v_mfma_f32_16x16x32_bf16 v[224:227], v[40:43], a[40:43], v[224:227]
    v_mfma_f32_16x16x32_bf16 v[228:231], v[40:43], a[112:115], v[228:231]
    v_mfma_f32_16x16x32_bf16 v[232:235], v[44:47], a[40:43], v[232:235]
    v_mfma_f32_16x16x32_bf16 v[236:239], v[44:47], a[112:115], v[236:239]
    s_waitcnt lgkmcnt(2)
    v_mfma_f32_16x16x32_bf16 v[208:211], v[48:51], v[108:111], v[208:211]
    ds_read_b128 v[40:43], v3 offset:13312
    v_mfma_f32_16x16x32_bf16 v[212:215], v[48:51], v[180:183], v[212:215]
    ds_read_b128 v[44:47], v3 offset:31744
    v_mfma_f32_16x16x32_bf16 v[216:219], v[52:55], v[108:111], v[216:219]
    v_mfma_f32_16x16x32_bf16 v[220:223], v[52:55], v[180:183], v[220:223]
    v_mfma_f32_16x16x32_bf16 v[224:227], v[48:51], a[44:47], v[224:227]
    v_mfma_f32_16x16x32_bf16 v[228:231], v[48:51], a[116:119], v[228:231]
    v_mfma_f32_16x16x32_bf16 v[232:235], v[52:55], a[44:47], v[232:235]
    v_mfma_f32_16x16x32_bf16 v[236:239], v[52:55], a[116:119], v[236:239]
    s_waitcnt lgkmcnt(2)
    v_mfma_f32_16x16x32_bf16 v[208:211], v[32:35], v[112:115], v[208:211]
    ds_read_b128 v[48:51], v3 offset:14336
    v_mfma_f32_16x16x32_bf16 v[212:215], v[32:35], v[184:187], v[212:215]
    ds_read_b128 v[52:55], v3 offset:32768
    v_mfma_f32_16x16x32_bf16 v[216:219], v[36:39], v[112:115], v[216:219]
    v_mfma_f32_16x16x32_bf16 v[220:223], v[36:39], v[184:187], v[220:223]
    v_mfma_f32_16x16x32_bf16 v[224:227], v[32:35], a[48:51], v[224:227]
    v_mfma_f32_16x16x32_bf16 v[228:231], v[32:35], a[120:123], v[228:231]
    v_mfma_f32_16x16x32_bf16 v[232:235], v[36:39], a[48:51], v[232:235]
    v_mfma_f32_16x16x32_bf16 v[236:239], v[36:39], a[120:123], v[236:239]
    s_waitcnt lgkmcnt(2)
    v_mfma_f32_16x16x32_bf16 v[208:211], v[40:43], v[116:119], v[208:211]
    ds_read_b128 v[32:35], v3 offset:15360
    v_mfma_f32_16x16x32_bf16 v[212:215], v[40:43], v[188:191], v[212:215]
    ds_read_b128 v[36:39], v3 offset:33792
    v_mfma_f32_16x16x32_bf16 v[216:219], v[44:47], v[116:119], v[216:219]
    v_mfma_f32_16x16x32_bf16 v[220:223], v[44:47], v[188:191], v[220:223]
    v_mfma_f32_16x16x32_bf16 v[224:227], v[40:43], a[52:55], v[224:227]
    v_mfma_f32_16x16x32_bf16 v[228:231], v[40:43], a[124:127], v[228:231]
    v_mfma_f32_16x16x32_bf16 v[232:235], v[44:47], a[52:55], v[232:235]
    v_mfma_f32_16x16x32_bf16 v[236:239], v[44:47], a[124:127], v[236:239]
    s_waitcnt lgkmcnt(2)
    v_mfma_f32_16x16x32_bf16 v[208:211], v[48:51], v[120:123], v[208:211]
    ds_read_b128 v[40:43], v3 offset:16384
    v_mfma_f32_16x16x32_bf16 v[212:215], v[48:51], v[192:195], v[212:215]
    ds_read_b128 v[44:47], v3 offset:34816
    v_mfma_f32_16x16x32_bf16 v[216:219], v[52:55], v[120:123], v[216:219]
    v_mfma_f32_16x16x32_bf16 v[220:223], v[52:55], v[192:195], v[220:223]
    v_mfma_f32_16x16x32_bf16 v[224:227], v[48:51], a[56:59], v[224:227]
    v_mfma_f32_16x16x32_bf16 v[228:231], v[48:51], a[128:131], v[228:231]
    v_mfma_f32_16x16x32_bf16 v[232:235], v[52:55], a[56:59], v[232:235]
    v_mfma_f32_16x16x32_bf16 v[236:239], v[52:55], a[128:131], v[236:239]
    s_waitcnt lgkmcnt(2)
    v_mfma_f32_16x16x32_bf16 v[208:211], v[32:35], v[124:127], v[208:211]
    ds_read_b128 v[48:51], v3 offset:17408
    v_mfma_f32_16x16x32_bf16 v[212:215], v[32:35], v[196:199], v[212:215]
    ds_read_b128 v[52:55], v3 offset:35840
    v_mfma_f32_16x16x32_bf16 v[216:219], v[36:39], v[124:127], v[216:219]
    v_mfma_f32_16x16x32_bf16 v[220:223], v[36:39], v[196:199], v[220:223]
    v_mfma_f32_16x16x32_bf16 v[224:227], v[32:35], a[60:63], v[224:227]
    s_add_u32 s27, s27, 36864
    s_cmp_eq_u32 s27, 110592
    s_cselect_b32 s27, 0, s27
    v_add_u32 v3, s27, v1
    v_mfma_f32_16x16x32_bf16 v[228:231], v[32:35], a[132:135], v[228:231]
    v_mfma_f32_16x16x32_bf16 v[232:235], v[36:39], a[60:63], v[232:235]
    v_mfma_f32_16x16x32_bf16 v[236:239], v[36:39], a[132:135], v[236:239]
    s_waitcnt lgkmcnt(2)
    v_mfma_f32_16x16x32_bf16 v[208:211], v[40:43], v[128:131], v[208:211]
    ds_read_b128 v[32:35], v3 offset:0
    v_mfma_f32_16x16x32_bf16 v[212:215], v[40:43], v[200:203], v[212:215]
    ds_read_b128 v[36:39], v3 offset:18432
    v_mfma_f32_16x16x32_bf16 v[216:219], v[44:47], v[128:131], v[216:219]
    v_mfma_f32_16x16x32_bf16 v[220:223], v[44:47], v[200:203], v[220:223]
    v_mfma_f32_16x16x32_bf16 v[224:227], v[40:43], a[64:67], v[224:227]
    v_mfma_f32_16x16x32_bf16 v[228:231], v[40:43], a[136:139], v[228:231]
    v_mfma_f32_16x16x32_bf16 v[232:235], v[44:47], a[64:67], v[232:235]
    v_mfma_f32_16x16x32_bf16 v[236:239], v[44:47], a[136:139], v[236:239]
    s_waitcnt lgkmcnt(2)
    v_mfma_f32_16x16x32_bf16 v[208:211], v[48:51], v[132:135], v[208:211]
    ds_read_b128 v[40:43], v3 offset:1024
    v_mfma_f32_16x16x32_bf16 v[212:215], v[48:51], v[204:207], v[212:215]
    ds_read_b128 v[44:47], v3 offset:19456
    v_mfma_f32_16x16x32_bf16 v[216:219], v[52:55], v[132:135], v[216:219]
    v_mfma_f32_16x16x32_bf16 v[220:223], v[52:55], v[204:207], v[220:223]
    v_mfma_f32_16x16x32_bf16 v[224:227], v[48:51], a[68:71], v[224:227]
    v_mfma_f32_16x16x32_bf16 v[228:231], v[48:51], a[140:143], v[228:231]
    v_mfma_f32_16x16x32_bf16 v[232:235], v[52:55], a[68:71], v[232:235]
    v_mfma_f32_16x16x32_bf16 v[236:239], v[52:55], a[140:143], v[236:239]
    s_add_u32 s26, s26, s41
    s_waitcnt vmcnt(0)
    v_cvt_pk_bf16_f32 v8, v208, v209
    v_cvt_pk_bf16_f32 v9, v210, v211
    v_cvt_pk_bf16_f32 v10, v216, v217
    v_cvt_pk_bf16_f32 v11, v218, v219
    v_cvt_pk_bf16_f32 v12, v212, v213
    v_cvt_pk_bf16_f32 v13, v214, v215
    v_cvt_pk_bf16_f32 v14, v220, v221
    v_cvt_pk_bf16_f32 v15, v222, v223
    v_cvt_pk_bf16_f32 v16, v224, v225
    v_cvt_pk_bf16_f32 v17, v226, v227
    v_cvt_pk_bf16_f32 v18, v232, v233
    v_cvt_pk_bf16_f32 v19, v234, v235
    v_cvt_pk_bf16_f32 v20, v228, v229
    v_cvt_pk_bf16_f32 v21, v230, v231
    v_cvt_pk_bf16_f32 v22, v236, v237
    v_cvt_pk_bf16_f32 v23, v238, v239
    s_mov_b64 s[36:37], -1
    s_add_u32 s28, s26, s12
    buffer_store_dwordx4 v[8:11], v7, s[4:7], s28 offen sc1
    s_add_u32 s28, s26, s13
    buffer_store_dwordx4 v[12:15], v7, s[4:7], s28 offen sc1
    s_add_u32 s28, s26, s14
    buffer_store_dwordx4 v[16:19], v7, s[4:7], s28 offen sc1
    s_add_u32 s28, s26, s15
    buffer_store_dwordx4 v[20:23], v7, s[4:7], s28 offen sc1
    s_lshr_b32 s45, s19, 2
    s_cbranch_scc1 qk_vloop_nf
    s_mov_b32 s45, 1
    s_mov_b64 s[36:37], 0
    s_waitcnt vmcnt(0)
    s_barrier
    s_add_u32 s23, s45, s95
    v_mov_b32 v4, s23
    s_mov_b64 exec, s[34:35]
    buffer_store_dword v4, off, s[4:7], s29 sc1
    buffer_store_dword v4, off, s[4:7], s29 offset:128 sc1
    s_mov_b64 exec, -1
qk_vloop_nf:
    s_add_u32 s19, s19, 4
    s_cmp_lt_u32 s19, s20
    s_cbranch_scc1 qk_vloop
qk_done:
    s_waitcnt vmcnt(0) lgkmcnt(0)
    s_barrier
    s_mov_b32 s45, 16
    s_add_u32 s23, s45, s95
    v_mov_b32 v4, s23
    s_mov_b64 exec, s[34:35]
    buffer_store_dword v4, off, s[4:7], s29 sc1
    buffer_store_dword v4, off, s[4:7], s29 offset:128 sc1
    s_mov_b64 exec, -1
    s_cmp_lt_i32 s33, 0
    s_cbranch_scc1 L_memkv
    v_readfirstlane_b32 s40, v245
    v_readfirstlane_b32 s41, v246
    v_readfirstlane_b32 s42, v247
    v_readfirstlane_b32 s43, v248
    s_cmp_ge_u32 s40, 160
    s_cselect_b32 s43, s43, 0
    s_cmp_ge_u32 s41, 1
    s_cselect_b32 s43, s43, 0
    s_cmp_eq_u32 s42, 1
    s_cselect_b32 s43, s43, 0
    s_cmp_eq_u32 s93, 1000
    s_cselect_b32 s43, s43, 0
    s_mov_b32 s93, 999
    v_mov_b32 v250, s43
    v_mov_b32 v251, 163832
    s_mov_b64 exec, s[34:35]
    ds_write_b32 v251, v250
    s_mov_b64 exec, -1
    s_waitcnt lgkmcnt(0)
    s_barrier
    ds_read_b32 v252, v251
    s_waitcnt lgkmcnt(0)
    v_readfirstlane_b32 s43, v252
    s_barrier
    s_cmp_lg_u32 s43, 192
    s_cbranch_scc1 L_qkv_next
    s_mov_b32 s45, s33
    s_mov_b32 s93, 500
    s_branch L_phase2b
L_memkv:
    v_and_b32 v4, 63, v0
    v_and_b32 v2, 7, v4
    v_lshrrev_b32 v5, 4, v4
    v_lshl_add_u32 v2, v5, 3, v2
    v_lshlrev_b32 v2, 4, v2
    v_bfe_u32 v3, v4, 3, 1
    v_mul_u32_u24 v5, 9216, v3
    v_add_u32 v2, v2, v5
    v_mov_b32 v240, 0x05040100
    v_mov_b32 v241, 0x07060302
    v_lshrrev_b32 v5, 5, v4
    v_and_b32 v1, 0xdff, v7
    s_cmp_eq_u32 s16, 2
    s_cbranch_scc1 mk_isv
    v_mov_b32 v5, v3
    v_or_b32 v1, 128, v7
mk_isv:
    v_lshl_add_u32 v1, v5, 17, v1
    s_mov_b32 s28, 0
    s_mov_b32 s19, 2
    s_mov_b32 s24, 138412032
    s_lshl_b32 s26, s17, 12
    s_mov_b32 s21, 69206016
    s_cmp_eq_u32 s16, 2
    s_cselect_b32 s21, 77594624, s21
    s_add_u32 s26, s26, s21
    s_lshl_b32 s29, s17, 7
    s_lshl_b32 s21, s16, 2
    s_add_u32 s29, s29, s21
    s_add_u32 s29, s29, 125829164
mk_loop:
    s_cmp_lg_u32 s18, 0
    s_cbranch_scc1 mk_go
    s_cmp_le_u32 s19, s28
    s_cbranch_scc1 mk_go
    s_mov_b32 s23, 125853696
    s_mov_b32 s21, 4194304
mk_wait:
    buffer_load_dword v4, off, s[4:7], s23 sc1
    s_sub_u32 s21, s21, 1
    s_cbranch_scc1 mk_go
    s_waitcnt vmcnt(0)
    v_readfirstlane_b32 s28, v4
    s_nop 0
    s_sub_u32 s28, s28, s95
    s_cmp_gt_u32 s28, 64
    s_cselect_b32 s28, 0, s28
    s_cmp_le_u32 s19, s28
    s_cbranch_scc1 mk_go
    s_sleep 4
    s_branch mk_wait
mk_go:
    s_barrier
    s_add_u32 s21, s24, 4096
    s_add_u32 s23, s24, 8192
    buffer_load_dwordx4 v[24:27], v2, s[4:7], s24 offen offset:0 sc1
    buffer_load_dwordx4 v[28:31], v2, s[4:7], s24 offen offset:512 sc1
    buffer_load_dwordx4 v[32:35], v2, s[4:7], s21 offen offset:0 sc1
    buffer_load_dwordx4 v[36:39], v2, s[4:7], s21 offen offset:512 sc1
    buffer_load_dwordx4 v[40:43], v2, s[4:7], s24 offen offset:1024 sc1
    buffer_load_dwordx4 v[44:47], v2, s[4:7], s24 offen offset:1536 sc1
    buffer_load_dwordx4 v[48:51], v2, s[4:7], s21 offen offset:1024 sc1
    buffer_load_dwordx4 v[52:55], v2, s[4:7], s21 offen offset:1536 sc1
    buffer_load_dwordx4 v[56:59], v2, s[4:7], s24 offen offset:2048 sc1
    buffer_load_dwordx4 v[60:63], v2, s[4:7], s24 offen offset:2560 sc1
    buffer_load_dwordx4 v[208:211], v2, s[4:7], s21 offen offset:2048 sc1
    buffer_load_dwordx4 v[212:215], v2, s[4:7], s21 offen offset:2560 sc1
    buffer_load_dwordx4 v[216:219], v2, s[4:7], s24 offen offset:3072 sc1
    buffer_load_dwordx4 v[220:223], v2, s[4:7], s24 offen offset:3584 sc1
    buffer_load_dwordx4 v[224:227], v2, s[4:7], s21 offen offset:3072 sc1
    buffer_load_dwordx4 v[228:231], v2, s[4:7], s21 offen offset:3584 sc1
    buffer_load_dwordx4 v[232:235], v2, s[4:7], s23 offen offset:0 sc1
    buffer_load_dwordx4 v[236:239], v2, s[4:7], s23 offen offset:512 sc1
    s_add_u32 s24, s24, 18432
    s_cmp_eq_u32 s16, 2
    s_cbranch_scc1 mk_v
    s_waitcnt vmcnt(17)
    v_perm_b32 v244, v25, v24, v240
    v_perm_b32 v245, v27, v26, v240
    v_perm_b32 v246, v25, v24, v241
    v_perm_b32 v247, v27, v26, v241
    s_waitcnt vmcnt(16)
    v_perm_b32 v248, v29, v28, v240
    v_perm_b32 v249, v31, v30, v240
    v_perm_b32 v250, v29, v28, v241
    v_perm_b32 v251, v31, v30, v241
    v_mfma_f32_16x16x32_bf16 v[8:11], v[64:67], v[244:247], 0
    v_mfma_f32_16x16x32_bf16 v[12:15], v[136:139], v[244:247], 0
    v_mfma_f32_16x16x32_bf16 v[16:19], a[0:3], v[244:247], 0
    v_mfma_f32_16x16x32_bf16 v[20:23], a[72:75], v[244:247], 0
    s_waitcnt vmcnt(15)
    v_perm_b32 v244, v33, v32, v240
    v_perm_b32 v245, v35, v34, v240
    v_perm_b32 v246, v33, v32, v241
    v_perm_b32 v247, v35, v34, v241
    v_mfma_f32_16x16x32_bf16 v[8:11], v[68:71], v[248:251], v[8:11]
    v_mfma_f32_16x16x32_bf16 v[12:15], v[140:143], v[248:251], v[12:15]
    v_mfma_f32_16x16x32_bf16 v[16:19], a[4:7], v[248:251], v[16:19]
    v_mfma_f32_16x16x32_bf16 v[20:23], a[76:79], v[248:251], v[20:23]
    s_waitcnt vmcnt(14)
    v_perm_b32 v248, v37, v36, v240
    v_perm_b32 v249, v39, v38, v240
    v_perm_b32 v250, v37, v36, v241
    v_perm_b32 v251, v39, v38, v241
    v_mfma_f32_16x16x32_bf16 v[8:11], v[72:75], v[244:247], v[8:11]
    v_mfma_f32_16x16x32_bf16 v[12:15], v[144:147], v[244:247], v[12:15]
    v_mfma_f32_16x16x32_bf16 v[16:19], a[8:11], v[244:247], v[16:19]
    v_mfma_f32_16x16x32_bf16 v[20:23], a[80:83], v[244:247], v[20:23]
    s_waitcnt vmcnt(13)
    v_perm_b32 v244, v41, v40, v240
    v_perm_b32 v245, v43, v42, v240
    v_perm_b32 v246, v41, v40, v241
    v_perm_b32 v247, v43, v42, v241
    v_mfma_f32_16x16x32_bf16 v[8:11], v[76:79], v[248:251], v[8:11]
    v_mfma_f32_16x16x32_bf16 v[12:15], v[148:151], v[248:251], v[12:15]
    v_mfma_f32_16x16x32_bf16 v[16:19], a[12:15], v[248:251], v[16:19]
    v_mfma_f32_16x16x32_bf16 v[20:23], a[84:87], v[248:251], v[20:23]
    s_waitcnt vmcnt(12)
    v_perm_b32 v248, v45, v44, v240
    v_perm_b32 v249, v47, v46, v240
    v_perm_b32 v250, v45, v44, v241
    v_perm_b32 v251, v47, v46, v241
    v_mfma_f32_16x16x32_bf16 v[8:11], v[80:83], v[244:247], v[8:11]
    v_mfma_f32_16x16x32_bf16 v[12:15], v[152:155], v[244:247], v[12:15]
    v_mfma_f32_16x16x32_bf16 v[16:19], a[16:19], v[244:247], v[16:19]
    v_mfma_f32_16x16x32_bf16 v[20:23], a[88:91], v[244:247], v[20:23]
    s_waitcnt vmcnt(11)
    v_perm_b32 v244, v49, v48, v240
    v_perm_b32 v245, v51, v50, v240
    v_perm_b32 v246, v49, v48, v241
    v_perm_b32 v247, v51, v50, v241
    v_mfma_f32_16x16x32_bf16 v[8:11], v[84:87], v[248:251], v[8:11]
    v_mfma_f32_16x16x32_bf16 v[12:15], v[156:159], v[248:251], v[12:15]
    v_mfma_f32_16x16x32_bf16 v[16:19], a[20:23], v[248:251], v[16:19]
    v_mfma_f32_16x16x32_bf16 v[20:23], a[92:95], v[248:251], v[20:23]
    s_waitcnt vmcnt(10)
    v_perm_b32 v248, v53, v52, v240
    v_perm_b32 v249, v55, v54, v240
    v_perm_b32 v250, v53, v52, v241
    v_perm_b32 v251, v55, v54, v241
    v_mfma_f32_16x16x32_bf16 v[8:11], v[88:91], v[244:247], v[8:11]
    v_mfma_f32_16x16x32_bf16 v[12:15], v[160:163], v[244:247], v[12:15]
    v_mfma_f32_16x16x32_bf16 v[16:19], a[24:27], v[244:247], v[16:19]
    v_mfma_f32_16x16x32_bf16 v[20:23], a[96:99], v[244:247], v[20:23]
    s_waitcnt vmcnt(9)
    v_perm_b32 v244, v57, v56, v240
    v_perm_b32 v245, v59, v58, v240
    v_perm_b32 v246, v57, v56, v241
    v_perm_b32 v247, v59, v58, v241
    v_mfma_f32_16x16x32_bf16 v[8:11], v[92:95], v[248:251], v[8:11]
    v_mfma_f32_16x16x32_bf16 v[12:15], v[164:167], v[248:251], v[12:15]
    v_mfma_f32_16x16x32_bf16 v[16:19], a[28:31], v[248:251], v[16:19]
    v_mfma_f32_16x16x32_bf16 v[20:23], a[100:103], v[248:251], v[20:23]
    s_waitcnt vmcnt(8)
    v_perm_b32 v248, v61, v60, v240
    v_perm_b32 v249, v63, v62, v240
    v_perm_b32 v250, v61, v60, v241
    v_perm_b32 v251, v63, v62, v241
    v_mfma_f32_16x16x32_bf16 v[8:11], v[96:99], v[244:247], v[8:11]
    v_mfma_f32_16x16x32_bf16 v[12:15], v[168:171], v[244:247], v[12:15]
    v_mfma_f32_16x16x32_bf16 v[16:19], a[32:35], v[244:247], v[16:19]
    v_mfma_f32_16x16x32_bf16 v[20:23], a[104:107], v[244:247], v[20:23]
    s_waitcnt vmcnt(7)
    v_perm_b32 v244, v209, v208, v240
    v_perm_b32 v245, v211, v210, v240
    v_perm_b32 v246, v209, v208, v241
    v_perm_b32 v247, v211, v210, v241
    v_mfma_f32_16x16x32_bf16 v[8:11], v[100:103], v[248:251], v[8:11]
    v_mfma_f32_16x16x32_bf16 v[12:15], v[172:175], v[248:251], v[12:15]
    v_mfma_f32_16x16x32_bf16 v[16:19], a[36:39], v[248:251], v[16:19]
    v_mfma_f32_16x16x32_bf16 v[20:23], a[108:111], v[248:251], v[20:23]
    s_waitcnt vmcnt(6)
    v_perm_b32 v248, v213, v212, v240
    v_perm_b32 v249, v215, v214, v240
    v_perm_b32 v250, v213, v212, v241
    v_perm_b32 v251, v215, v214, v241
    v_mfma_f32_16x16x32_bf16 v[8:11], v[104:107], v[244:247], v[8:11]
    v_mfma_f32_16x16x32_bf16 v[12:15], v[176:179], v[244:247], v[12:15]
    v_mfma_f32_16x16x32_bf16 v[16:19], a[40:43], v[244:247], v[16:19]
    v_mfma_f32_16x16x32_bf16 v[20:23], a[112:115], v[244:247], v[20:23]
    s_waitcnt vmcnt(5)
    v_perm_b32 v244, v217, v216, v240
    v_perm_b32 v245, v219, v218, v240
    v_perm_b32 v246, v217, v216, v241
    v_perm_b32 v247, v219, v218, v241
    v_mfma_f32_16x16x32_bf16 v[8:11], v[108:111], v[248:251], v[8:11]
    v_mfma_f32_16x16x32_bf16 v[12:15], v[180:183], v[248:251], v[12:15]
    v_mfma_f32_16x16x32_bf16 v[16:19], a[44:47], v[248:251], v[16:19]
    v_mfma_f32_16x16x32_bf16 v[20:23], a[116:119], v[248:251], v[20:23]
    s_waitcnt vmcnt(4)
    v_perm_b32 v248, v221, v220, v240
    v_perm_b32 v249, v223, v222, v240
    v_perm_b32 v250, v221, v220, v241
    v_perm_b32 v251, v223, v222, v241
    v_mfma_f32_16x16x32_bf16 v[8:11], v[112:115], v[244:247], v[8:11]
    v_mfma_f32_16x16x32_bf16 v[12:15], v[184:187], v[244:247], v[12:15]
    v_mfma_f32_16x16x32_bf16 v[16:19], a[48:51], v[244:247], v[16:19]
    v_mfma_f32_16x16x32_bf16 v[20:23], a[120:123], v[244:247], v[20:23]
    s_waitcnt vmcnt(3)
    v_perm_b32 v244, v225, v224, v240
    v_perm_b32 v245, v227, v226, v240
    v_perm_b32 v246, v225, v224, v241
    v_perm_b32 v247, v227, v226, v241
    v_mfma_f32_16x16x32_bf16 v[8:11], v[116:119], v[248:251], v[8:11]
    v_mfma_f32_16x16x32_bf16 v[12:15], v[188:191], v[248:251], v[12:15]
    v_mfma_f32_16x16x32_bf16 v[16:19], a[52:55], v[248:251], v[16:19]
    v_mfma_f32_16x16x32_bf16 v[20:23], a[124:127], v[248:251], v[20:23]
    s_waitcnt vmcnt(2)
    v_perm_b32 v248, v229, v228, v240
    v_perm_b32 v249, v231, v230, v240
    v_perm_b32 v250, v229, v228, v241
    v_perm_b32 v251, v231, v230, v241
    v_mfma_f32_16x16x32_bf16 v[8:11], v[120:123], v[244:247], v[8:11]
    v_mfma_f32_16x16x32_bf16 v[12:15], v[192:195], v[244:247], v[12:15]
    v_mfma_f32_16x16x32_bf16 v[16:19], a[56:59], v[244:247], v[16:19]
    v_mfma_f32_16x16x32_bf16 v[20:23], a[128:131], v[244:247], v[20:23]
    s_waitcnt vmcnt(1)
    v_mfma_f32_16x16x32_bf16 v[8:11], v[124:127], v[248:251], v[8:11]
    v_mfma_f32_16x16x32_bf16 v[12:15], v[196:199], v[248:251], v[12:15]
    v_mfma_f32_16x16x32_bf16 v[16:19], a[60:63], v[248:251], v[16:19]
    v_mfma_f32_16x16x32_bf16 v[20:23], a[132:135], v[248:251], v[20:23]
    s_waitcnt vmcnt(0)
    v_mfma_f32_16x16x32_bf16 v[8:11], v[128:131], v[232:235], v[8:11]
    v_mfma_f32_16x16x32_bf16 v[12:15], v[200:203], v[232:235], v[12:15]
    v_mfma_f32_16x16x32_bf16 v[16:19], a[64:67], v[232:235], v[16:19]
    v_mfma_f32_16x16x32_bf16 v[20:23], a[136:139], v[232:235], v[20:23]
    v_mfma_f32_16x16x32_bf16 v[8:11], v[132:135], v[236:239], v[8:11]
    v_mfma_f32_16x16x32_bf16 v[12:15], v[204:207], v[236:239], v[12:15]
    v_mfma_f32_16x16x32_bf16 v[16:19], a[68:71], v[236:239], v[16:19]
    v_mfma_f32_16x16x32_bf16 v[20:23], a[140:143], v[236:239], v[20:23]
    s_nop 7
    s_branch mk_st
mk_v:
    s_waitcnt vmcnt(17)
    v_perm_b32 v244, v25, v24, v240
    v_perm_b32 v245, v27, v26, v240
    v_perm_b32 v246, v25, v24, v241
    v_perm_b32 v247, v27, v26, v241
    s_waitcnt vmcnt(16)
    v_perm_b32 v248, v29, v28, v240
    v_perm_b32 v249, v31, v30, v240
    v_perm_b32 v250, v29, v28, v241
    v_perm_b32 v251, v31, v30, v241
    v_mfma_f32_16x16x32_bf16 v[8:11], v[244:247], v[64:67], 0
    v_mfma_f32_16x16x32_bf16 v[12:15], v[244:247], v[136:139], 0
    v_mfma_f32_16x16x32_bf16 v[16:19], v[244:247], a[0:3], 0
    v_mfma_f32_16x16x32_bf16 v[20:23], v[244:247], a[72:75], 0
    s_waitcnt vmcnt(15)
    v_perm_b32 v244, v33, v32, v240
    v_perm_b32 v245, v35, v34, v240
    v_perm_b32 v246, v33, v32, v241
    v_perm_b32 v247, v35, v34, v241
    v_mfma_f32_16x16x32_bf16 v[8:11], v[248:251], v[68:71], v[8:11]
    v_mfma_f32_16x16x32_bf16 v[12:15], v[248:251], v[140:143], v[12:15]
    v_mfma_f32_16x16x32_bf16 v[16:19], v[248:251], a[4:7], v[16:19]
    v_mfma_f32_16x16x32_bf16 v[20:23], v[248:251], a[76:79], v[20:23]
    s_waitcnt vmcnt(14)
    v_perm_b32 v248, v37, v36, v240
    v_perm_b32 v249, v39, v38, v240
    v_perm_b32 v250, v37, v36, v241
    v_perm_b32 v251, v39, v38, v241
    v_mfma_f32_16x16x32_bf16 v[8:11], v[244:247], v[72:75], v[8:11]
    v_mfma_f32_16x16x32_bf16 v[12:15], v[244:247], v[144:147], v[12:15]
    v_mfma_f32_16x16x32_bf16 v[16:19], v[244:247], a[8:11], v[16:19]
    v_mfma_f32_16x16x32_bf16 v[20:23], v[244:247], a[80:83], v[20:23]
    s_waitcnt vmcnt(13)
    v_perm_b32 v244, v41, v40, v240
    v_perm_b32 v245, v43, v42, v240
    v_perm_b32 v246, v41, v40, v241
    v_perm_b32 v247, v43, v42, v241
    v_mfma_f32_16x16x32_bf16 v[8:11], v[248:251], v[76:79], v[8:11]
    v_mfma_f32_16x16x32_bf16 v[12:15], v[248:251], v[148:151], v[12:15]
    v_mfma_f32_16x16x32_bf16 v[16:19], v[248:251], a[12:15], v[16:19]
    v_mfma_f32_16x16x32_bf16 v[20:23], v[248:251], a[84:87], v[20:23]
    s_waitcnt vmcnt(12)
    v_perm_b32 v248, v45, v44, v240
    v_perm_b32 v249, v47, v46, v240
    v_perm_b32 v250, v45, v44, v241
    v_perm_b32 v251, v47, v46, v241
    v_mfma_f32_16x16x32_bf16 v[8:11], v[244:247], v[80:83], v[8:11]
    v_mfma_f32_16x16x32_bf16 v[12:15], v[244:247], v[152:155], v[12:15]
    v_mfma_f32_16x16x32_bf16 v[16:19], v[244:247], a[16:19], v[16:19]
    v_mfma_f32_16x16x32_bf16 v[20:23], v[244:247], a[88:91], v[20:23]
    s_waitcnt vmcnt(11)
    v_perm_b32 v244, v49, v48, v240
    v_perm_b32 v245, v51, v50, v240
    v_perm_b32 v246, v49, v48, v241
    v_perm_b32 v247, v51, v50, v241
    v_mfma_f32_16x16x32_bf16 v[8:11], v[248:251], v[84:87], v[8:11]
    v_mfma_f32_16x16x32_bf16 v[12:15], v[248:251], v[156:159], v[12:15]
    v_mfma_f32_16x16x32_bf16 v[16:19], v[248:251], a[20:23], v[16:19]
    v_mfma_f32_16x16x32_bf16 v[20:23], v[248:251], a[92:95], v[20:23]
    s_waitcnt vmcnt(10)
    v_perm_b32 v248, v53, v52, v240
    v_perm_b32 v249, v55, v54, v240
    v_perm_b32 v250, v53, v52, v241
    v_perm_b32 v251, v55, v54, v241
    v_mfma_f32_16x16x32_bf16 v[8:11], v[244:247], v[88:91], v[8:11]
    v_mfma_f32_16x16x32_bf16 v[12:15], v[244:247], v[160:163], v[12:15]
    v_mfma_f32_16x16x32_bf16 v[16:19], v[244:247], a[24:27], v[16:19]
    v_mfma_f32_16x16x32_bf16 v[20:23], v[244:247], a[96:99], v[20:23]
    s_waitcnt vmcnt(9)
    v_perm_b32 v244, v57, v56, v240
    v_perm_b32 v245, v59, v58, v240
    v_perm_b32 v246, v57, v56, v241
    v_perm_b32 v247, v59, v58, v241
    v_mfma_f32_16x16x32_bf16 v[8:11], v[248:251], v[92:95], v[8:11]
    v_mfma_f32_16x16x32_bf16 v[12:15], v[248:251], v[164:167], v[12:15]
    v_mfma_f32_16x16x32_bf16 v[16:19], v[248:251], a[28:31], v[16:19]
    v_mfma_f32_16x16x32_bf16 v[20:23], v[248:251], a[100:103], v[20:23]
    s_waitcnt vmcnt(8)
    v_perm_b32 v248, v61, v60, v240
    v_perm_b32 v249, v63, v62, v240
    v_perm_b32 v250, v61, v60, v241
    v_perm_b32 v251, v63, v62, v241
    v_mfma_f32_16x16x32_bf16 v[8:11], v[244:247], v[96:99], v[8:11]
    v_mfma_f32_16x16x32_bf16 v[12:15], v[244:247], v[168:171], v[12:15]
    v_mfma_f32_16x16x32_bf16 v[16:19], v[244:247], a[32:35], v[16:19]
    v_mfma_f32_16x16x32_bf16 v[20:23], v[244:247], a[104:107], v[20:23]
    s_waitcnt vmcnt(7)
    v_perm_b32 v244, v209, v208, v240
    v_perm_b32 v245, v211, v210, v240
    v_perm_b32 v246, v209, v208, v241
    v_perm_b32 v247, v211, v210, v241
    v_mfma_f32_16x16x32_bf16 v[8:11], v[248:251], v[100:103], v[8:11]
    v_mfma_f32_16x16x32_bf16 v[12:15], v[248:251], v[172:175], v[12:15]
    v_mfma_f32_16x16x32_bf16 v[16:19], v[248:251], a[36:39], v[16:19]
    v_mfma_f32_16x16x32_bf16 v[20:23], v[248:251], a[108:111], v[20:23]
    s_waitcnt vmcnt(6)
    v_perm_b32 v248, v213, v212, v240
    v_perm_b32 v249, v215, v214, v240
    v_perm_b32 v250, v213, v212, v241
    v_perm_b32 v251, v215, v214, v241
    v_mfma_f32_16x16x32_bf16 v[8:11], v[244:247], v[104:107], v[8:11]
    v_mfma_f32_16x16x32_bf16 v[12:15], v[244:247], v[176:179], v[12:15]
    v_mfma_f32_16x16x32_bf16 v[16:19], v[244:247], a[40:43], v[16:19]
    v_mfma_f32_16x16x32_bf16 v[20:23], v[244:247], a[112:115], v[20:23]
    s_waitcnt vmcnt(5)
    v_perm_b32 v244, v217, v216, v240
    v_perm_b32 v245, v219, v218, v240
    v_perm_b32 v246, v217, v216, v241
    v_perm_b32 v247, v219, v218, v241
    v_mfma_f32_16x16x32_bf16 v[8:11], v[248:251], v[108:111], v[8:11]
    v_mfma_f32_16x16x32_bf16 v[12:15], v[248:251], v[180:183], v[12:15]
    v_mfma_f32_16x16x32_bf16 v[16:19], v[248:251], a[44:47], v[16:19]
    v_mfma_f32_16x16x32_bf16 v[20:23], v[248:251], a[116:119], v[20:23]
    s_waitcnt vmcnt(4)
    v_perm_b32 v248, v221, v220, v240
    v_perm_b32 v249, v223, v222, v240
    v_perm_b32 v250, v221, v220, v241
    v_perm_b32 v251, v223, v222, v241
    v_mfma_f32_16x16x32_bf16 v[8:11], v[244:247], v[112:115], v[8:11]
    v_mfma_f32_16x16x32_bf16 v[12:15], v[244:247], v[184:187], v[12:15]
    v_mfma_f32_16x16x32_bf16 v[16:19], v[244:247], a[48:51], v[16:19]
    v_mfma_f32_16x16x32_bf16 v[20:23], v[244:247], a[120:123], v[20:23]
    s_waitcnt vmcnt(3)
    v_perm_b32 v244, v225, v224, v240
    v_perm_b32 v245, v227, v226, v240
    v_perm_b32 v246, v225, v224, v241
    v_perm_b32 v247, v227, v226, v241
    v_mfma_f32_16x16x32_bf16 v[8:11], v[248:251], v[116:119], v[8:11]
    v_mfma_f32_16x16x32_bf16 v[12:15], v[248:251], v[188:191], v[12:15]
    v_mfma_f32_16x16x32_bf16 v[16:19], v[248:251], a[52:55], v[16:19]
    v_mfma_f32_16x16x32_bf16 v[20:23], v[248:251], a[124:127], v[20:23]
    s_waitcnt vmcnt(2)
    v_perm_b32 v248, v229, v228, v240
    v_perm_b32 v249, v231, v230, v240
    v_perm_b32 v250, v229, v228, v241
    v_perm_b32 v251, v231, v230, v241
    v_mfma_f32_16x16x32_bf16 v[8:11], v[244:247], v[120:123], v[8:11]
    v_mfma_f32_16x16x32_bf16 v[12:15], v[244:247], v[192:195], v[12:15]
    v_mfma_f32_16x16x32_bf16 v[16:19], v[244:247], a[56:59], v[16:19]
    v_mfma_f32_16x16x32_bf16 v[20:23], v[244:247], a[128:131], v[20:23]
    s_waitcnt vmcnt(1)
    v_mfma_f32_16x16x32_bf16 v[8:11], v[248:251], v[124:127], v[8:11]
    v_mfma_f32_16x16x32_bf16 v[12:15], v[248:251], v[196:199], v[12:15]
    v_mfma_f32_16x16x32_bf16 v[16:19], v[248:251], a[60:63], v[16:19]
    v_mfma_f32_16x16x32_bf16 v[20:23], v[248:251], a[132:135], v[20:23]
    s_waitcnt vmcnt(0)
    v_mfma_f32_16x16x32_bf16 v[8:11], v[232:235], v[128:131], v[8:11]
    v_mfma_f32_16x16x32_bf16 v[12:15], v[232:235], v[200:203], v[12:15]
    v_mfma_f32_16x16x32_bf16 v[16:19], v[232:235], a[64:67], v[16:19]
    v_mfma_f32_16x16x32_bf16 v[20:23], v[232:235], a[136:139], v[20:23]
    v_mfma_f32_16x16x32_bf16 v[8:11], v[236:239], v[132:135], v[8:11]
    v_mfma_f32_16x16x32_bf16 v[12:15], v[236:239], v[204:207], v[12:15]
    v_mfma_f32_16x16x32_bf16 v[16:19], v[236:239], a[68:71], v[16:19]
    v_mfma_f32_16x16x32_bf16 v[20:23], v[236:239], a[140:143], v[20:23]
    s_nop 4
    v_pk_mul_f32 v[8:9], v[8:9], 0.5 op_sel_hi:[1,0]
    v_pk_mul_f32 v[10:11], v[10:11], 0.5 op_sel_hi:[1,0]
    v_pk_mul_f32 v[12:13], v[12:13], 0.5 op_sel_hi:[1,0]
    v_pk_mul_f32 v[14:15], v[14:15], 0.5 op_sel_hi:[1,0]
    v_pk_mul_f32 v[16:17], v[16:17], 0.5 op_sel_hi:[1,0]
    v_pk_mul_f32 v[18:19], v[18:19], 0.5 op_sel_hi:[1,0]
    v_pk_mul_f32 v[20:21], v[20:21], 0.5 op_sel_hi:[1,0]
    v_pk_mul_f32 v[22:23], v[22:23], 0.5 op_sel_hi:[1,0]
mk_st:
    s_nop 1
    v_cvt_pk_bf16_f32 v24, v8, v9
    v_cvt_pk_bf16_f32 v25, v10, v11
    v_cvt_pk_bf16_f32 v26, v12, v13
    v_cvt_pk_bf16_f32 v27, v14, v15
    v_cvt_pk_bf16_f32 v28, v16, v17
    v_cvt_pk_bf16_f32 v29, v18, v19
    v_cvt_pk_bf16_f32 v30, v20, v21
    v_cvt_pk_bf16_f32 v31, v22, v23
    s_add_u32 s21, s26, 4096
    buffer_store_dwordx4 v[24:27], v1, s[4:7], s26 offen sc1
    buffer_store_dwordx4 v[28:31], v1, s[4:7], s21 offen sc1
    s_add_u32 s22, s19, s95
    s_waitcnt vmcnt(0)
    s_barrier
    v_mov_b32 v4, s22
    s_mov_b64 exec, s[34:35]
    buffer_store_dword v4, off, s[4:7], s29 sc1
    buffer_store_dword v4, off, s[4:7], s29 offset:128 sc1
    s_mov_b64 exec, -1
    s_add_u32 s19, s19, 2
    s_add_u32 s26, s26, 262144
    s_cmp_le_u32 s19, 58
    s_cbranch_scc1 mk_loop
    s_endpgm
L_ssm_next:
    s_sub_u32 s93, s93, 1
    s_cbranch_scc1 L_exit
    s_mov_b32 s37, 8
    v_mov_b32 v250, 1
    v_mov_b32 v251, 163832
    v_cmp_eq_u32 vcc, 0, v0
    s_nop 0
    s_and_saveexec_b64 s[38:39], vcc
    s_cbranch_execz tk11
    buffer_atomic_add v250, off, s[84:87], s37 sc0
    s_waitcnt vmcnt(0)
    ds_write_b32 v251, v250
    s_waitcnt lgkmcnt(0)
tk11:
    s_mov_b64 exec, -1
    s_barrier
    ds_read_b32 v252, v251
    s_waitcnt lgkmcnt(0)
    v_readfirstlane_b32 s20, v252
    s_barrier
    s_nop 3
    s_cmp_ge_u32 s20, 72
    s_cbranch_scc1 L_ssm_done
    s_lshl_b32 s20, s20, 3
    v_lshrrev_b32 v5, 6, v0
    s_nop 0
    v_readfirstlane_b32 s21, v5
    v_and_b32 v1, 63, v0
    v_and_b32 v2, 15, v1
    v_lshrrev_b32 v3, 4, v1
    v_lshlrev_b32 v4, 14, v5
    s_mov_b32 s8, s62
    s_mov_b32 s9, s63
    s_mov_b32 s10, 2359296
    s_mov_b32 s11, 0x20000
    s_mov_b32 s16, s76
    s_mov_b32 s17, s77
    s_mov_b32 s18, 4718592
    s_mov_b32 s19, 0x20000
    s_add_u32 s22, s20, s21
    s_lshl_b32 s23, s22, 8
    v_lshlrev_b32 v6, 3, v2
    v_lshl_add_u32 v6, v3, 1, v6
    s_mov_b32 s12, s64
    s_mov_b32 s13, s65
    s_mov_b32 s14, 147456
    s_mov_b32 s15, 0x20000
    buffer_load_ushort v8, v6, s[12:15], s23 offen offset:0
    buffer_load_ushort v12, v6, s[12:15], s23 offen offset:128
    buffer_load_ushort v16, v6, s[12:15], s23 offen offset:1024
    buffer_load_ushort v20, v6, s[12:15], s23 offen offset:1152
    s_mov_b32 s12, s66
    s_mov_b32 s13, s67
    s_mov_b32 s14, 147456
    s_mov_b32 s15, 0x20000
    buffer_load_ushort v9, v6, s[12:15], s23 offen offset:0
    buffer_load_ushort v13, v6, s[12:15], s23 offen offset:128
    buffer_load_ushort v17, v6, s[12:15], s23 offen offset:1024
    buffer_load_ushort v21, v6, s[12:15], s23 offen offset:1152
    s_mov_b32 s12, s68
    s_mov_b32 s13, s69
    s_mov_b32 s14, 147456
    s_mov_b32 s15, 0x20000
    buffer_load_ushort v10, v6, s[12:15], s23 offen offset:0
    buffer_load_ushort v14, v6, s[12:15], s23 offen offset:128
    buffer_load_ushort v18, v6, s[12:15], s23 offen offset:1024
    buffer_load_ushort v22, v6, s[12:15], s23 offen offset:1152
    s_mov_b32 s12, s70
    s_mov_b32 s13, s71
    s_mov_b32 s14, 147456
    s_mov_b32 s15, 0x20000
    buffer_load_ushort v11, v6, s[12:15], s23 offen offset:0
    buffer_load_ushort v15, v6, s[12:15], s23 offen offset:128
    buffer_load_ushort v19, v6, s[12:15], s23 offen offset:1024
    buffer_load_ushort v23, v6, s[12:15], s23 offen offset:1152
    s_mov_b32 s12, s72
    s_mov_b32 s13, s73
    s_mov_b32 s14, 1152
    s_mov_b32 s15, 0x20000
    s_lshl_b32 s23, s22, 1
    buffer_load_ushort v24, off, s[12:15], s23
    buffer_load_ushort v25, off, s[12:15], s23 offset:8
    v_mul_u32_u24 v5, 9216, v0
    s_lshl_b32 s22, s20, 1
    s_add_u32 s23, s22, 0
    buffer_load_dwordx4 v[208:211], v5, s[8:11], s23 offen
    s_add_u32 s23, s22, 1152
    buffer_load_dwordx4 v[212:215], v5, s[8:11], s23 offen
    s_add_u32 s23, s22, 2304
    buffer_load_dwordx4 v[216:219], v5, s[8:11], s23 offen
    s_add_u32 s23, s22, 3456
    buffer_load_dwordx4 v[220:223], v5, s[8:11], s23 offen
    s_add_u32 s23, s22, 4608
    buffer_load_dwordx4 v[224:227], v5, s[8:11], s23 offen
    s_add_u32 s23, s22, 5760
    buffer_load_dwordx4 v[228:231], v5, s[8:11], s23 offen
    s_add_u32 s23, s22, 6912
    buffer_load_dwordx4 v[232:235], v5, s[8:11], s23 offen
    s_add_u32 s23, s22, 8064
    buffer_load_dwordx4 v[236:239], v5, s[8:11], s23 offen
    s_mov_b32 s26, 0x3fb8aa3b
    s_mov_b32 s27, 0x3e22f983
    s_mov_b32 s28, 0
    v_cvt_f32_u32 v26, v2
    v_mul_f32 v27, 0x41800000, v26
    s_waitcnt vmcnt(8)
    s_nop 0
ss_pass:
    v_mov_b32 v36, 0
    v_mov_b32 v37, 0
    v_lshl_add_u32 v6, v1, 3, v4
    ds_write_b64 v6, v[36:37] offset:0
    v_lshlrev_b32 v38, 16, v24
    v_mul_f32 v38, s26, v38
    v_exp_f32 v38, v38
    s_nop 0
    v_cvt_pk_bf16_f32 v38, v38, v38
    v_and_b32 v38, 0xffff0000, v38
    v_add_f32 v39, v38, v38
    v_lshlrev_b32 v28, 16, v8
    v_mul_f32 v28, s26, v28
    v_exp_f32 v28, v28
    s_nop 0
    v_cvt_pk_bf16_f32 v28, v28, v28
    v_and_b32 v28, 0xffff0000, v28
    v_mul_f32 v28, v28, v38
    v_mul_f32 v28, s26, v28
    v_sub_f32 v28, 0, v28
    v_lshlrev_b32 v29, 16, v9
    v_mul_f32 v29, v29, v38
    v_mul_f32 v29, s27, v29
    v_lshlrev_b32 v30, 16, v10
    v_mul_f32 v30, v30, v39
    v_lshlrev_b32 v31, 16, v11
    v_mul_f32 v31, v31, v39
    v_lshlrev_b32 v32, 16, v12
    v_mul_f32 v32, s26, v32
    v_exp_f32 v32, v32
    s_nop 0
    v_cvt_pk_bf16_f32 v32, v32, v32
    v_and_b32 v32, 0xffff0000, v32
    v_mul_f32 v32, v32, v38
    v_mul_f32 v32, s26, v32
    v_sub_f32 v32, 0, v32
    v_lshlrev_b32 v33, 16, v13
    v_mul_f32 v33, v33, v38
    v_mul_f32 v33, s27, v33
    v_lshlrev_b32 v34, 16, v14
    v_mul_f32 v34, v34, v39
    v_lshlrev_b32 v35, 16, v15
    v_mul_f32 v35, v35, v39
    v_mov_b64 v[48:49], 0
    v_mov_b64 v[50:51], 0
    v_mov_b64 v[52:53], 0
    v_mov_b64 v[54:55], 0
    v_mov_b64 v[56:57], 0
    v_mov_b64 v[58:59], 0
    v_mov_b64 v[60:61], 0
    v_mov_b64 v[62:63], 0
    s_mov_b32 s25, 0
    s_nop 0
ss_kg:
    v_mov_b64_dpp v[64:65], v[28:29] row_newbcast:0 row_mask:0xf bank_mask:0xf
    v_mov_b64_dpp v[66:67], v[30:31] row_newbcast:0 row_mask:0xf bank_mask:0xf
    v_pk_mul_f32 v[94:95], v[64:65], v[26:27] op_sel_hi:[1,0]
    v_pk_mul_f32 v[96:97], v[64:65], v[26:27] op_sel:[0,1] op_sel_hi:[1,1]
    v_fract_f32 v95, v95
    v_fract_f32 v97, v97
    v_exp_f32 v94, v94
    v_exp_f32 v96, v96
    v_cos_f32 v68, v95
    v_sin_f32 v69, v95
    v_cos_f32 v76, v97
    v_sin_f32 v77, v97
    v_pk_mul_f32 v[68:69], v[68:69], v[94:95] op_sel_hi:[1,0]
    v_pk_mul_f32 v[76:77], v[76:77], v[96:97] op_sel_hi:[1,0]
    v_pk_mul_f32 v[92:93], v[76:77], v[76:77] op_sel:[1,1] op_sel_hi:[0,1]
    v_pk_fma_f32 v[78:79], v[76:77], v[76:77], v[92:93] op_sel:[0,0,0] op_sel_hi:[0,1,1] neg_lo:[0,0,1]
    v_pk_mul_f32 v[94:95], v[68:69], v[68:69] op_sel:[1,1] op_sel_hi:[0,1]
    v_pk_fma_f32 v[70:71], v[68:69], v[68:69], v[94:95] op_sel:[0,0,0] op_sel_hi:[0,1,1] neg_lo:[0,0,1]
    v_pk_mul_f32 v[92:93], v[78:79], v[78:79] op_sel:[1,1] op_sel_hi:[0,1]
    v_pk_fma_f32 v[80:81], v[78:79], v[78:79], v[92:93] op_sel:[0,0,0] op_sel_hi:[0,1,1] neg_lo:[0,0,1]
    v_pk_mul_f32 v[94:95], v[70:71], v[70:71] op_sel:[1,1] op_sel_hi:[0,1]
    v_pk_fma_f32 v[72:73], v[70:71], v[70:71], v[94:95] op_sel:[0,0,0] op_sel_hi:[0,1,1] neg_lo:[0,0,1]
    v_pk_mul_f32 v[92:93], v[80:81], v[80:81] op_sel:[1,1] op_sel_hi:[0,1]
    v_pk_fma_f32 v[82:83], v[80:81], v[80:81], v[92:93] op_sel:[0,0,0] op_sel_hi:[0,1,1] neg_lo:[0,0,1]
    v_pk_mul_f32 v[94:95], v[72:73], v[72:73] op_sel:[1,1] op_sel_hi:[0,1]
    v_pk_fma_f32 v[74:75], v[72:73], v[72:73], v[94:95] op_sel:[0,0,0] op_sel_hi:[0,1,1] neg_lo:[0,0,1]
    v_pk_mul_f32 v[92:93], v[82:83], v[82:83] op_sel:[1,1] op_sel_hi:[0,1]
    v_pk_fma_f32 v[84:85], v[82:83], v[82:83], v[92:93] op_sel:[0,0,0] op_sel_hi:[0,1,1] neg_lo:[0,0,1]
    v_pk_mul_f32 v[94:95], v[66:67], v[76:77] op_sel:[1,1] op_sel_hi:[1,0]
    v_pk_fma_f32 v[86:87], v[66:67], v[76:77], v[94:95] op_sel:[0,0,0] op_sel_hi:[0,1,1] neg_lo:[0,0,1] neg_hi:[1,0,1]
    v_mov_b32_dpp v80, v78 row_ror:8 row_mask:0xf bank_mask:0x3
    v_mov_b32_dpp v81, v79 row_ror:8 row_mask:0xf bank_mask:0x3
    v_mov_b32_dpp v82, v84 row_ror:8 row_mask:0xf bank_mask:0x3
    v_mov_b32_dpp v83, v85 row_ror:8 row_mask:0xf bank_mask:0x3
    v_pk_mul_f32 v[92:93], v[66:67], v[80:81] op_sel:[1,1] op_sel_hi:[1,0]
    v_pk_fma_f32 v[88:89], v[66:67], v[80:81], v[92:93] op_sel:[0,0,0] op_sel_hi:[0,1,1] neg_lo:[0,0,1] neg_hi:[1,0,1]
    v_pk_mul_f32 v[94:95], v[66:67], v[82:83] op_sel:[1,1] op_sel_hi:[1,0]
    v_pk_fma_f32 v[90:91], v[66:67], v[82:83], v[94:95] op_sel:[0,0,0] op_sel_hi:[0,1,1] neg_lo:[0,0,1] neg_hi:[1,0,1]
    v_mfma_f32_16x16x4_f32 v[48:51], v86, v68, v[48:51]
    v_mfma_f32_16x16x4_f32 v[52:55], v88, v70, v[52:55]
    v_mfma_f32_16x16x4_f32 v[56:59], v88, v72, v[56:59]
    v_mfma_f32_16x16x4_f32 v[60:63], v90, v74, v[60:63]
    v_mfma_f32_16x16x4_f32 v[48:51], v87, v69, v[48:51]
    v_mfma_f32_16x16x4_f32 v[52:55], v89, v71, v[52:55]
    v_mfma_f32_16x16x4_f32 v[56:59], v89, v73, v[56:59]
    v_mfma_f32_16x16x4_f32 v[60:63], v91, v75, v[60:63]
    v_mov_b64_dpp v[64:65], v[28:29] row_newbcast:1 row_mask:0xf bank_mask:0xf
    v_mov_b64_dpp v[66:67], v[30:31] row_newbcast:1 row_mask:0xf bank_mask:0xf
    v_pk_mul_f32 v[94:95], v[64:65], v[26:27] op_sel_hi:[1,0]
    v_pk_mul_f32 v[96:97], v[64:65], v[26:27] op_sel:[0,1] op_sel_hi:[1,1]
    v_fract_f32 v95, v95
    v_fract_f32 v97, v97
    v_exp_f32 v94, v94
    v_exp_f32 v96, v96
    v_cos_f32 v68, v95
    v_sin_f32 v69, v95
    v_cos_f32 v76, v97
    v_sin_f32 v77, v97
    v_pk_mul_f32 v[68:69], v[68:69], v[94:95] op_sel_hi:[1,0]
    v_pk_mul_f32 v[76:77], v[76:77], v[96:97] op_sel_hi:[1,0]
    v_pk_mul_f32 v[92:93], v[76:77], v[76:77] op_sel:[1,1] op_sel_hi:[0,1]
    v_pk_fma_f32 v[78:79], v[76:77], v[76:77], v[92:93] op_sel:[0,0,0] op_sel_hi:[0,1,1] neg_lo:[0,0,1]
    v_pk_mul_f32 v[94:95], v[68:69], v[68:69] op_sel:[1,1] op_sel_hi:[0,1]
    v_pk_fma_f32 v[70:71], v[68:69], v[68:69], v[94:95] op_sel:[0,0,0] op_sel_hi:[0,1,1] neg_lo:[0,0,1]
    v_pk_mul_f32 v[92:93], v[78:79], v[78:79] op_sel:[1,1] op_sel_hi:[0,1]
    v_pk_fma_f32 v[80:81], v[78:79], v[78:79], v[92:93] op_sel:[0,0,0] op_sel_hi:[0,1,1] neg_lo:[0,0,1]
    v_pk_mul_f32 v[94:95], v[70:71], v[70:71] op_sel:[1,1] op_sel_hi:[0,1]
    v_pk_fma_f32 v[72:73], v[70:71], v[70:71], v[94:95] op_sel:[0,0,0] op_sel_hi:[0,1,1] neg_lo:[0,0,1]
    v_pk_mul_f32 v[92:93], v[80:81], v[80:81] op_sel:[1,1] op_sel_hi:[0,1]
    v_pk_fma_f32 v[82:83], v[80:81], v[80:81], v[92:93] op_sel:[0,0,0] op_sel_hi:[0,1,1] neg_lo:[0,0,1]
    v_pk_mul_f32 v[94:95], v[72:73], v[72:73] op_sel:[1,1] op_sel_hi:[0,1]
    v_pk_fma_f32 v[74:75], v[72:73], v[72:73], v[94:95] op_sel:[0,0,0] op_sel_hi:[0,1,1] neg_lo:[0,0,1]
    v_pk_mul_f32 v[92:93], v[82:83], v[82:83] op_sel:[1,1] op_sel_hi:[0,1]
    v_pk_fma_f32 v[84:85], v[82:83], v[82:83], v[92:93] op_sel:[0,0,0] op_sel_hi:[0,1,1] neg_lo:[0,0,1]
    v_pk_mul_f32 v[94:95], v[66:67], v[76:77] op_sel:[1,1] op_sel_hi:[1,0]
    v_pk_fma_f32 v[86:87], v[66:67], v[76:77], v[94:95] op_sel:[0,0,0] op_sel_hi:[0,1,1] neg_lo:[0,0,1] neg_hi:[1,0,1]
    v_mov_b32_dpp v80, v78 row_ror:8 row_mask:0xf bank_mask:0x3
    v_mov_b32_dpp v81, v79 row_ror:8 row_mask:0xf bank_mask:0x3
    v_mov_b32_dpp v82, v84 row_ror:8 row_mask:0xf bank_mask:0x3
    v_mov_b32_dpp v83, v85 row_ror:8 row_mask:0xf bank_mask:0x3
    v_pk_mul_f32 v[92:93], v[66:67], v[80:81] op_sel:[1,1] op_sel_hi:[1,0]
    v_pk_fma_f32 v[88:89], v[66:67], v[80:81], v[92:93] op_sel:[0,0,0] op_sel_hi:[0,1,1] neg_lo:[0,0,1] neg_hi:[1,0,1]
    v_pk_mul_f32 v[94:95], v[66:67], v[82:83] op_sel:[1,1] op_sel_hi:[1,0]
    v_pk_fma_f32 v[90:91], v[66:67], v[82:83], v[94:95] op_sel:[0,0,0] op_sel_hi:[0,1,1] neg_lo:[0,0,1] neg_hi:[1,0,1]
    v_mfma_f32_16x16x4_f32 v[48:51], v86, v68, v[48:51]
    v_mfma_f32_16x16x4_f32 v[52:55], v88, v70, v[52:55]
    v_mfma_f32_16x16x4_f32 v[56:59], v88, v72, v[56:59]
    v_mfma_f32_16x16x4_f32 v[60:63], v90, v74, v[60:63]
    v_mfma_f32_16x16x4_f32 v[48:51], v87, v69, v[48:51]
    v_mfma_f32_16x16x4_f32 v[52:55], v89, v71, v[52:55]
    v_mfma_f32_16x16x4_f32 v[56:59], v89, v73, v[56:59]
    v_mfma_f32_16x16x4_f32 v[60:63], v91, v75, v[60:63]
    v_mov_b64_dpp v[64:65], v[28:29] row_newbcast:2 row_mask:0xf bank_mask:0xf
    v_mov_b64_dpp v[66:67], v[30:31] row_newbcast:2 row_mask:0xf bank_mask:0xf
    v_pk_mul_f32 v[94:95], v[64:65], v[26:27] op_sel_hi:[1,0]
    v_pk_mul_f32 v[96:97], v[64:65], v[26:27] op_sel:[0,1] op_sel_hi:[1,1]
    v_fract_f32 v95, v95
    v_fract_f32 v97, v97
    v_exp_f32 v94, v94
    v_exp_f32 v96, v96
    v_cos_f32 v68, v95
    v_sin_f32 v69, v95
    v_cos_f32 v76, v97
    v_sin_f32 v77, v97
    v_pk_mul_f32 v[68:69], v[68:69], v[94:95] op_sel_hi:[1,0]
    v_pk_mul_f32 v[76:77], v[76:77], v[96:97] op_sel_hi:[1,0]
    v_pk_mul_f32 v[92:93], v[76:77], v[76:77] op_sel:[1,1] op_sel_hi:[0,1]
    v_pk_fma_f32 v[78:79], v[76:77], v[76:77], v[92:93] op_sel:[0,0,0] op_sel_hi:[0,1,1] neg_lo:[0,0,1]
    v_pk_mul_f32 v[94:95], v[68:69], v[68:69] op_sel:[1,1] op_sel_hi:[0,1]
    v_pk_fma_f32 v[70:71], v[68:69], v[68:69], v[94:95] op_sel:[0,0,0] op_sel_hi:[0,1,1] neg_lo:[0,0,1]
    v_pk_mul_f32 v[92:93], v[78:79], v[78:79] op_sel:[1,1] op_sel_hi:[0,1]
    v_pk_fma_f32 v[80:81], v[78:79], v[78:79], v[92:93] op_sel:[0,0,0] op_sel_hi:[0,1,1] neg_lo:[0,0,1]
    v_pk_mul_f32 v[94:95], v[70:71], v[70:71] op_sel:[1,1] op_sel_hi:[0,1]
    v_pk_fma_f32 v[72:73], v[70:71], v[70:71], v[94:95] op_sel:[0,0,0] op_sel_hi:[0,1,1] neg_lo:[0,0,1]
    v_pk_mul_f32 v[92:93], v[80:81], v[80:81] op_sel:[1,1] op_sel_hi:[0,1]
    v_pk_fma_f32 v[82:83], v[80:81], v[80:81], v[92:93] op_sel:[0,0,0] op_sel_hi:[0,1,1] neg_lo:[0,0,1]
    v_pk_mul_f32 v[94:95], v[72:73], v[72:73] op_sel:[1,1] op_sel_hi:[0,1]
    v_pk_fma_f32 v[74:75], v[72:73], v[72:73], v[94:95] op_sel:[0,0,0] op_sel_hi:[0,1,1] neg_lo:[0,0,1]
    v_pk_mul_f32 v[92:93], v[82:83], v[82:83] op_sel:[1,1] op_sel_hi:[0,1]
    v_pk_fma_f32 v[84:85], v[82:83], v[82:83], v[92:93] op_sel:[0,0,0] op_sel_hi:[0,1,1] neg_lo:[0,0,1]
    v_pk_mul_f32 v[94:95], v[66:67], v[76:77] op_sel:[1,1] op_sel_hi:[1,0]
    v_pk_fma_f32 v[86:87], v[66:67], v[76:77], v[94:95] op_sel:[0,0,0] op_sel_hi:[0,1,1] neg_lo:[0,0,1] neg_hi:[1,0,1]
    v_mov_b32_dpp v80, v78 row_ror:8 row_mask:0xf bank_mask:0x3
    v_mov_b32_dpp v81, v79 row_ror:8 row_mask:0xf bank_mask:0x3
    v_mov_b32_dpp v82, v84 row_ror:8 row_mask:0xf bank_mask:0x3
    v_mov_b32_dpp v83, v85 row_ror:8 row_mask:0xf bank_mask:0x3
    v_pk_mul_f32 v[92:93], v[66:67], v[80:81] op_sel:[1,1] op_sel_hi:[1,0]
    v_pk_fma_f32 v[88:89], v[66:67], v[80:81], v[92:93] op_sel:[0,0,0] op_sel_hi:[0,1,1] neg_lo:[0,0,1] neg_hi:[1,0,1]
    v_pk_mul_f32 v[94:95], v[66:67], v[82:83] op_sel:[1,1] op_sel_hi:[1,0]
    v_pk_fma_f32 v[90:91], v[66:67], v[82:83], v[94:95] op_sel:[0,0,0] op_sel_hi:[0,1,1] neg_lo:[0,0,1] neg_hi:[1,0,1]
    v_mfma_f32_16x16x4_f32 v[48:51], v86, v68, v[48:51]
    v_mfma_f32_16x16x4_f32 v[52:55], v88, v70, v[52:55]
    v_mfma_f32_16x16x4_f32 v[56:59], v88, v72, v[56:59]
    v_mfma_f32_16x16x4_f32 v[60:63], v90, v74, v[60:63]
    v_mfma_f32_16x16x4_f32 v[48:51], v87, v69, v[48:51]
    v_mfma_f32_16x16x4_f32 v[52:55], v89, v71, v[52:55]
    v_mfma_f32_16x16x4_f32 v[56:59], v89, v73, v[56:59]
    v_mfma_f32_16x16x4_f32 v[60:63], v91, v75, v[60:63]
    v_mov_b64_dpp v[64:65], v[28:29] row_newbcast:3 row_mask:0xf bank_mask:0xf
    v_mov_b64_dpp v[66:67], v[30:31] row_newbcast:3 row_mask:0xf bank_mask:0xf
    v_pk_mul_f32 v[94:95], v[64:65], v[26:27] op_sel_hi:[1,0]
    v_pk_mul_f32 v[96:97], v[64:65], v[26:27] op_sel:[0,1] op_sel_hi:[1,1]
    v_fract_f32 v95, v95
    v_fract_f32 v97, v97
    v_exp_f32 v94, v94
    v_exp_f32 v96, v96
    v_cos_f32 v68, v95
    v_sin_f32 v69, v95
    v_cos_f32 v76, v97
    v_sin_f32 v77, v97
    v_pk_mul_f32 v[68:69], v[68:69], v[94:95] op_sel_hi:[1,0]
    v_pk_mul_f32 v[76:77], v[76:77], v[96:97] op_sel_hi:[1,0]
    v_pk_mul_f32 v[92:93], v[76:77], v[76:77] op_sel:[1,1] op_sel_hi:[0,1]
    v_pk_fma_f32 v[78:79], v[76:77], v[76:77], v[92:93] op_sel:[0,0,0] op_sel_hi:[0,1,1] neg_lo:[0,0,1]
    v_pk_mul_f32 v[94:95], v[68:69], v[68:69] op_sel:[1,1] op_sel_hi:[0,1]
    v_pk_fma_f32 v[70:71], v[68:69], v[68:69], v[94:95] op_sel:[0,0,0] op_sel_hi:[0,1,1] neg_lo:[0,0,1]
    v_pk_mul_f32 v[92:93], v[78:79], v[78:79] op_sel:[1,1] op_sel_hi:[0,1]
    v_pk_fma_f32 v[80:81], v[78:79], v[78:79], v[92:93] op_sel:[0,0,0] op_sel_hi:[0,1,1] neg_lo:[0,0,1]
    v_pk_mul_f32 v[94:95], v[70:71], v[70:71] op_sel:[1,1] op_sel_hi:[0,1]
    v_pk_fma_f32 v[72:73], v[70:71], v[70:71], v[94:95] op_sel:[0,0,0] op_sel_hi:[0,1,1] neg_lo:[0,0,1]
    v_pk_mul_f32 v[92:93], v[80:81], v[80:81] op_sel:[1,1] op_sel_hi:[0,1]
    v_pk_fma_f32 v[82:83], v[80:81], v[80:81], v[92:93] op_sel:[0,0,0] op_sel_hi:[0,1,1] neg_lo:[0,0,1]
    v_pk_mul_f32 v[94:95], v[72:73], v[72:73] op_sel:[1,1] op_sel_hi:[0,1]
    v_pk_fma_f32 v[74:75], v[72:73], v[72:73], v[94:95] op_sel:[0,0,0] op_sel_hi:[0,1,1] neg_lo:[0,0,1]
    v_pk_mul_f32 v[92:93], v[82:83], v[82:83] op_sel:[1,1] op_sel_hi:[0,1]
    v_pk_fma_f32 v[84:85], v[82:83], v[82:83], v[92:93] op_sel:[0,0,0] op_sel_hi:[0,1,1] neg_lo:[0,0,1]
    v_pk_mul_f32 v[94:95], v[66:67], v[76:77] op_sel:[1,1] op_sel_hi:[1,0]
    v_pk_fma_f32 v[86:87], v[66:67], v[76:77], v[94:95] op_sel:[0,0,0] op_sel_hi:[0,1,1] neg_lo:[0,0,1] neg_hi:[1,0,1]
    v_mov_b32_dpp v80, v78 row_ror:8 row_mask:0xf bank_mask:0x3
    v_mov_b32_dpp v81, v79 row_ror:8 row_mask:0xf bank_mask:0x3
    v_mov_b32_dpp v82, v84 row_ror:8 row_mask:0xf bank_mask:0x3
    v_mov_b32_dpp v83, v85 row_ror:8 row_mask:0xf bank_mask:0x3
    v_pk_mul_f32 v[92:93], v[66:67], v[80:81] op_sel:[1,1] op_sel_hi:[1,0]
    v_pk_fma_f32 v[88:89], v[66:67], v[80:81], v[92:93] op_sel:[0,0,0] op_sel_hi:[0,1,1] neg_lo:[0,0,1] neg_hi:[1,0,1]
    v_pk_mul_f32 v[94:95], v[66:67], v[82:83] op_sel:[1,1] op_sel_hi:[1,0]
    v_pk_fma_f32 v[90:91], v[66:67], v[82:83], v[94:95] op_sel:[0,0,0] op_sel_hi:[0,1,1] neg_lo:[0,0,1] neg_hi:[1,0,1]
    v_mfma_f32_16x16x4_f32 v[48:51], v86, v68, v[48:51]
    v_mfma_f32_16x16x4_f32 v[52:55], v88, v70, v[52:55]
    v_mfma_f32_16x16x4_f32 v[56:59], v88, v72, v[56:59]
    v_mfma_f32_16x16x4_f32 v[60:63], v90, v74, v[60:63]
    v_mfma_f32_16x16x4_f32 v[48:51], v87, v69, v[48:51]
    v_mfma_f32_16x16x4_f32 v[52:55], v89, v71, v[52:55]
    v_mfma_f32_16x16x4_f32 v[56:59], v89, v73, v[56:59]
    v_mfma_f32_16x16x4_f32 v[60:63], v91, v75, v[60:63]
    v_mov_b64_dpp v[64:65], v[28:29] row_newbcast:4 row_mask:0xf bank_mask:0xf
    v_mov_b64_dpp v[66:67], v[30:31] row_newbcast:4 row_mask:0xf bank_mask:0xf
    v_pk_mul_f32 v[94:95], v[64:65], v[26:27] op_sel_hi:[1,0]
    v_pk_mul_f32 v[96:97], v[64:65], v[26:27] op_sel:[0,1] op_sel_hi:[1,1]
    v_fract_f32 v95, v95
    v_fract_f32 v97, v97
    v_exp_f32 v94, v94
    v_exp_f32 v96, v96
    v_cos_f32 v68, v95
    v_sin_f32 v69, v95
    v_cos_f32 v76, v97
    v_sin_f32 v77, v97
    v_pk_mul_f32 v[68:69], v[68:69], v[94:95] op_sel_hi:[1,0]
    v_pk_mul_f32 v[76:77], v[76:77], v[96:97] op_sel_hi:[1,0]
    v_pk_mul_f32 v[92:93], v[76:77], v[76:77] op_sel:[1,1] op_sel_hi:[0,1]
    v_pk_fma_f32 v[78:79], v[76:77], v[76:77], v[92:93] op_sel:[0,0,0] op_sel_hi:[0,1,1] neg_lo:[0,0,1]
    v_pk_mul_f32 v[94:95], v[68:69], v[68:69] op_sel:[1,1] op_sel_hi:[0,1]
    v_pk_fma_f32 v[70:71], v[68:69], v[68:69], v[94:95] op_sel:[0,0,0] op_sel_hi:[0,1,1] neg_lo:[0,0,1]
    v_pk_mul_f32 v[92:93], v[78:79], v[78:79] op_sel:[1,1] op_sel_hi:[0,1]
    v_pk_fma_f32 v[80:81], v[78:79], v[78:79], v[92:93] op_sel:[0,0,0] op_sel_hi:[0,1,1] neg_lo:[0,0,1]
    v_pk_mul_f32 v[94:95], v[70:71], v[70:71] op_sel:[1,1] op_sel_hi:[0,1]
    v_pk_fma_f32 v[72:73], v[70:71], v[70:71], v[94:95] op_sel:[0,0,0] op_sel_hi:[0,1,1] neg_lo:[0,0,1]
    v_pk_mul_f32 v[92:93], v[80:81], v[80:81] op_sel:[1,1] op_sel_hi:[0,1]
    v_pk_fma_f32 v[82:83], v[80:81], v[80:81], v[92:93] op_sel:[0,0,0] op_sel_hi:[0,1,1] neg_lo:[0,0,1]
    v_pk_mul_f32 v[94:95], v[72:73], v[72:73] op_sel:[1,1] op_sel_hi:[0,1]
    v_pk_fma_f32 v[74:75], v[72:73], v[72:73], v[94:95] op_sel:[0,0,0] op_sel_hi:[0,1,1] neg_lo:[0,0,1]
    v_pk_mul_f32 v[92:93], v[82:83], v[82:83] op_sel:[1,1] op_sel_hi:[0,1]
    v_pk_fma_f32 v[84:85], v[82:83], v[82:83], v[92:93] op_sel:[0,0,0] op_sel_hi:[0,1,1] neg_lo:[0,0,1]
    v_pk_mul_f32 v[94:95], v[66:67], v[76:77] op_sel:[1,1] op_sel_hi:[1,0]
    v_pk_fma_f32 v[86:87], v[66:67], v[76:77], v[94:95] op_sel:[0,0,0] op_sel_hi:[0,1,1] neg_lo:[0,0,1] neg_hi:[1,0,1]
    v_mov_b32_dpp v80, v78 row_ror:8 row_mask:0xf bank_mask:0x3
    v_mov_b32_dpp v81, v79 row_ror:8 row_mask:0xf bank_mask:0x3
    v_mov_b32_dpp v82, v84 row_ror:8 row_mask:0xf bank_mask:0x3
    v_mov_b32_dpp v83, v85 row_ror:8 row_mask:0xf bank_mask:0x3
    v_pk_mul_f32 v[92:93], v[66:67], v[80:81] op_sel:[1,1] op_sel_hi:[1,0]
    v_pk_fma_f32 v[88:89], v[66:67], v[80:81], v[92:93] op_sel:[0,0,0] op_sel_hi:[0,1,1] neg_lo:[0,0,1] neg_hi:[1,0,1]
    v_pk_mul_f32 v[94:95], v[66:67], v[82:83] op_sel:[1,1] op_sel_hi:[1,0]
    v_pk_fma_f32 v[90:91], v[66:67], v[82:83], v[94:95] op_sel:[0,0,0] op_sel_hi:[0,1,1] neg_lo:[0,0,1] neg_hi:[1,0,1]
    v_mfma_f32_16x16x4_f32 v[48:51], v86, v68, v[48:51]
    v_mfma_f32_16x16x4_f32 v[52:55], v88, v70, v[52:55]
    v_mfma_f32_16x16x4_f32 v[56:59], v88, v72, v[56:59]
    v_mfma_f32_16x16x4_f32 v[60:63], v90, v74, v[60:63]
    v_mfma_f32_16x16x4_f32 v[48:51], v87, v69, v[48:51]
    v_mfma_f32_16x16x4_f32 v[52:55], v89, v71, v[52:55]
    v_mfma_f32_16x16x4_f32 v[56:59], v89, v73, v[56:59]
    v_mfma_f32_16x16x4_f32 v[60:63], v91, v75, v[60:63]
    v_mov_b64_dpp v[64:65], v[28:29] row_newbcast:5 row_mask:0xf bank_mask:0xf
    v_mov_b64_dpp v[66:67], v[30:31] row_newbcast:5 row_mask:0xf bank_mask:0xf
    v_pk_mul_f32 v[94:95], v[64:65], v[26:27] op_sel_hi:[1,0]
    v_pk_mul_f32 v[96:97], v[64:65], v[26:27] op_sel:[0,1] op_sel_hi:[1,1]
    v_fract_f32 v95, v95
    v_fract_f32 v97, v97
    v_exp_f32 v94, v94
    v_exp_f32 v96, v96
    v_cos_f32 v68, v95
    v_sin_f32 v69, v95
    v_cos_f32 v76, v97
    v_sin_f32 v77, v97
    v_pk_mul_f32 v[68:69], v[68:69], v[94:95] op_sel_hi:[1,0]
    v_pk_mul_f32 v[76:77], v[76:77], v[96:97] op_sel_hi:[1,0]
    v_pk_mul_f32 v[92:93], v[76:77], v[76:77] op_sel:[1,1] op_sel_hi:[0,1]
    v_pk_fma_f32 v[78:79], v[76:77], v[76:77], v[92:93] op_sel:[0,0,0] op_sel_hi:[0,1,1] neg_lo:[0,0,1]
    v_pk_mul_f32 v[94:95], v[68:69], v[68:69] op_sel:[1,1] op_sel_hi:[0,1]
    v_pk_fma_f32 v[70:71], v[68:69], v[68:69], v[94:95] op_sel:[0,0,0] op_sel_hi:[0,1,1] neg_lo:[0,0,1]
    v_pk_mul_f32 v[92:93], v[78:79], v[78:79] op_sel:[1,1] op_sel_hi:[0,1]
    v_pk_fma_f32 v[80:81], v[78:79], v[78:79], v[92:93] op_sel:[0,0,0] op_sel_hi:[0,1,1] neg_lo:[0,0,1]
    v_pk_mul_f32 v[94:95], v[70:71], v[70:71] op_sel:[1,1] op_sel_hi:[0,1]
    v_pk_fma_f32 v[72:73], v[70:71], v[70:71], v[94:95] op_sel:[0,0,0] op_sel_hi:[0,1,1] neg_lo:[0,0,1]
    v_pk_mul_f32 v[92:93], v[80:81], v[80:81] op_sel:[1,1] op_sel_hi:[0,1]
    v_pk_fma_f32 v[82:83], v[80:81], v[80:81], v[92:93] op_sel:[0,0,0] op_sel_hi:[0,1,1] neg_lo:[0,0,1]
    v_pk_mul_f32 v[94:95], v[72:73], v[72:73] op_sel:[1,1] op_sel_hi:[0,1]
    v_pk_fma_f32 v[74:75], v[72:73], v[72:73], v[94:95] op_sel:[0,0,0] op_sel_hi:[0,1,1] neg_lo:[0,0,1]
    v_pk_mul_f32 v[92:93], v[82:83], v[82:83] op_sel:[1,1] op_sel_hi:[0,1]
    v_pk_fma_f32 v[84:85], v[82:83], v[82:83], v[92:93] op_sel:[0,0,0] op_sel_hi:[0,1,1] neg_lo:[0,0,1]
    v_pk_mul_f32 v[94:95], v[66:67], v[76:77] op_sel:[1,1] op_sel_hi:[1,0]
    v_pk_fma_f32 v[86:87], v[66:67], v[76:77], v[94:95] op_sel:[0,0,0] op_sel_hi:[0,1,1] neg_lo:[0,0,1] neg_hi:[1,0,1]
    v_mov_b32_dpp v80, v78 row_ror:8 row_mask:0xf bank_mask:0x3
    v_mov_b32_dpp v81, v79 row_ror:8 row_mask:0xf bank_mask:0x3
    v_mov_b32_dpp v82, v84 row_ror:8 row_mask:0xf bank_mask:0x3
    v_mov_b32_dpp v83, v85 row_ror:8 row_mask:0xf bank_mask:0x3
    v_pk_mul_f32 v[92:93], v[66:67], v[80:81] op_sel:[1,1] op_sel_hi:[1,0]
    v_pk_fma_f32 v[88:89], v[66:67], v[80:81], v[92:93] op_sel:[0,0,0] op_sel_hi:[0,1,1] neg_lo:[0,0,1] neg_hi:[1,0,1]
    v_pk_mul_f32 v[94:95], v[66:67], v[82:83] op_sel:[1,1] op_sel_hi:[1,0]
    v_pk_fma_f32 v[90:91], v[66:67], v[82:83], v[94:95] op_sel:[0,0,0] op_sel_hi:[0,1,1] neg_lo:[0,0,1] neg_hi:[1,0,1]
    v_mfma_f32_16x16x4_f32 v[48:51], v86, v68, v[48:51]
    v_mfma_f32_16x16x4_f32 v[52:55], v88, v70, v[52:55]
    v_mfma_f32_16x16x4_f32 v[56:59], v88, v72, v[56:59]
    v_mfma_f32_16x16x4_f32 v[60:63], v90, v74, v[60:63]
    v_mfma_f32_16x16x4_f32 v[48:51], v87, v69, v[48:51]
    v_mfma_f32_16x16x4_f32 v[52:55], v89, v71, v[52:55]
    v_mfma_f32_16x16x4_f32 v[56:59], v89, v73, v[56:59]
    v_mfma_f32_16x16x4_f32 v[60:63], v91, v75, v[60:63]
    v_mov_b64_dpp v[64:65], v[28:29] row_newbcast:6 row_mask:0xf bank_mask:0xf
    v_mov_b64_dpp v[66:67], v[30:31] row_newbcast:6 row_mask:0xf bank_mask:0xf
    v_pk_mul_f32 v[94:95], v[64:65], v[26:27] op_sel_hi:[1,0]
    v_pk_mul_f32 v[96:97], v[64:65], v[26:27] op_sel:[0,1] op_sel_hi:[1,1]
    v_fract_f32 v95, v95
    v_fract_f32 v97, v97
    v_exp_f32 v94, v94
    v_exp_f32 v96, v96
    v_cos_f32 v68, v95
    v_sin_f32 v69, v95
    v_cos_f32 v76, v97
    v_sin_f32 v77, v97
    v_pk_mul_f32 v[68:69], v[68:69], v[94:95] op_sel_hi:[1,0]
    v_pk_mul_f32 v[76:77], v[76:77], v[96:97] op_sel_hi:[1,0]
    v_pk_mul_f32 v[92:93], v[76:77], v[76:77] op_sel:[1,1] op_sel_hi:[0,1]
    v_pk_fma_f32 v[78:79], v[76:77], v[76:77], v[92:93] op_sel:[0,0,0] op_sel_hi:[0,1,1] neg_lo:[0,0,1]
    v_pk_mul_f32 v[94:95], v[68:69], v[68:69] op_sel:[1,1] op_sel_hi:[0,1]
    v_pk_fma_f32 v[70:71], v[68:69], v[68:69], v[94:95] op_sel:[0,0,0] op_sel_hi:[0,1,1] neg_lo:[0,0,1]
    v_pk_mul_f32 v[92:93], v[78:79], v[78:79] op_sel:[1,1] op_sel_hi:[0,1]
    v_pk_fma_f32 v[80:81], v[78:79], v[78:79], v[92:93] op_sel:[0,0,0] op_sel_hi:[0,1,1] neg_lo:[0,0,1]
    v_pk_mul_f32 v[94:95], v[70:71], v[70:71] op_sel:[1,1] op_sel_hi:[0,1]
    v_pk_fma_f32 v[72:73], v[70:71], v[70:71], v[94:95] op_sel:[0,0,0] op_sel_hi:[0,1,1] neg_lo:[0,0,1]
    v_pk_mul_f32 v[92:93], v[80:81], v[80:81] op_sel:[1,1] op_sel_hi:[0,1]
    v_pk_fma_f32 v[82:83], v[80:81], v[80:81], v[92:93] op_sel:[0,0,0] op_sel_hi:[0,1,1] neg_lo:[0,0,1]
    v_pk_mul_f32 v[94:95], v[72:73], v[72:73] op_sel:[1,1] op_sel_hi:[0,1]
    v_pk_fma_f32 v[74:75], v[72:73], v[72:73], v[94:95] op_sel:[0,0,0] op_sel_hi:[0,1,1] neg_lo:[0,0,1]
    v_pk_mul_f32 v[92:93], v[82:83], v[82:83] op_sel:[1,1] op_sel_hi:[0,1]
    v_pk_fma_f32 v[84:85], v[82:83], v[82:83], v[92:93] op_sel:[0,0,0] op_sel_hi:[0,1,1] neg_lo:[0,0,1]
    v_pk_mul_f32 v[94:95], v[66:67], v[76:77] op_sel:[1,1] op_sel_hi:[1,0]
    v_pk_fma_f32 v[86:87], v[66:67], v[76:77], v[94:95] op_sel:[0,0,0] op_sel_hi:[0,1,1] neg_lo:[0,0,1] neg_hi:[1,0,1]
    v_mov_b32_dpp v80, v78 row_ror:8 row_mask:0xf bank_mask:0x3
    v_mov_b32_dpp v81, v79 row_ror:8 row_mask:0xf bank_mask:0x3
    v_mov_b32_dpp v82, v84 row_ror:8 row_mask:0xf bank_mask:0x3
    v_mov_b32_dpp v83, v85 row_ror:8 row_mask:0xf bank_mask:0x3
    v_pk_mul_f32 v[92:93], v[66:67], v[80:81] op_sel:[1,1] op_sel_hi:[1,0]
    v_pk_fma_f32 v[88:89], v[66:67], v[80:81], v[92:93] op_sel:[0,0,0] op_sel_hi:[0,1,1] neg_lo:[0,0,1] neg_hi:[1,0,1]
    v_pk_mul_f32 v[94:95], v[66:67], v[82:83] op_sel:[1,1] op_sel_hi:[1,0]
    v_pk_fma_f32 v[90:91], v[66:67], v[82:83], v[94:95] op_sel:[0,0,0] op_sel_hi:[0,1,1] neg_lo:[0,0,1] neg_hi:[1,0,1]
    v_mfma_f32_16x16x4_f32 v[48:51], v86, v68, v[48:51]
    v_mfma_f32_16x16x4_f32 v[52:55], v88, v70, v[52:55]
    v_mfma_f32_16x16x4_f32 v[56:59], v88, v72, v[56:59]
    v_mfma_f32_16x16x4_f32 v[60:63], v90, v74, v[60:63]
    v_mfma_f32_16x16x4_f32 v[48:51], v87, v69, v[48:51]
    v_mfma_f32_16x16x4_f32 v[52:55], v89, v71, v[52:55]
    v_mfma_f32_16x16x4_f32 v[56:59], v89, v73, v[56:59]
    v_mfma_f32_16x16x4_f32 v[60:63], v91, v75, v[60:63]
    v_mov_b64_dpp v[64:65], v[28:29] row_newbcast:7 row_mask:0xf bank_mask:0xf
    v_mov_b64_dpp v[66:67], v[30:31] row_newbcast:7 row_mask:0xf bank_mask:0xf
    v_pk_mul_f32 v[94:95], v[64:65], v[26:27] op_sel_hi:[1,0]
    v_pk_mul_f32 v[96:97], v[64:65], v[26:27] op_sel:[0,1] op_sel_hi:[1,1]
    v_fract_f32 v95, v95
    v_fract_f32 v97, v97
    v_exp_f32 v94, v94
    v_exp_f32 v96, v96
    v_cos_f32 v68, v95
    v_sin_f32 v69, v95
    v_cos_f32 v76, v97
    v_sin_f32 v77, v97
    v_pk_mul_f32 v[68:69], v[68:69], v[94:95] op_sel_hi:[1,0]
    v_pk_mul_f32 v[76:77], v[76:77], v[96:97] op_sel_hi:[1,0]
    v_pk_mul_f32 v[92:93], v[76:77], v[76:77] op_sel:[1,1] op_sel_hi:[0,1]
    v_pk_fma_f32 v[78:79], v[76:77], v[76:77], v[92:93] op_sel:[0,0,0] op_sel_hi:[0,1,1] neg_lo:[0,0,1]
    v_pk_mul_f32 v[94:95], v[68:69], v[68:69] op_sel:[1,1] op_sel_hi:[0,1]
    v_pk_fma_f32 v[70:71], v[68:69], v[68:69], v[94:95] op_sel:[0,0,0] op_sel_hi:[0,1,1] neg_lo:[0,0,1]
    v_pk_mul_f32 v[92:93], v[78:79], v[78:79] op_sel:[1,1] op_sel_hi:[0,1]
    v_pk_fma_f32 v[80:81], v[78:79], v[78:79], v[92:93] op_sel:[0,0,0] op_sel_hi:[0,1,1] neg_lo:[0,0,1]
    v_pk_mul_f32 v[94:95], v[70:71], v[70:71] op_sel:[1,1] op_sel_hi:[0,1]
    v_pk_fma_f32 v[72:73], v[70:71], v[70:71], v[94:95] op_sel:[0,0,0] op_sel_hi:[0,1,1] neg_lo:[0,0,1]
    v_pk_mul_f32 v[92:93], v[80:81], v[80:81] op_sel:[1,1] op_sel_hi:[0,1]
    v_pk_fma_f32 v[82:83], v[80:81], v[80:81], v[92:93] op_sel:[0,0,0] op_sel_hi:[0,1,1] neg_lo:[0,0,1]
    v_pk_mul_f32 v[94:95], v[72:73], v[72:73] op_sel:[1,1] op_sel_hi:[0,1]
    v_pk_fma_f32 v[74:75], v[72:73], v[72:73], v[94:95] op_sel:[0,0,0] op_sel_hi:[0,1,1] neg_lo:[0,0,1]
    v_pk_mul_f32 v[92:93], v[82:83], v[82:83] op_sel:[1,1] op_sel_hi:[0,1]
    v_pk_fma_f32 v[84:85], v[82:83], v[82:83], v[92:93] op_sel:[0,0,0] op_sel_hi:[0,1,1] neg_lo:[0,0,1]
    v_pk_mul_f32 v[94:95], v[66:67], v[76:77] op_sel:[1,1] op_sel_hi:[1,0]
    v_pk_fma_f32 v[86:87], v[66:67], v[76:77], v[94:95] op_sel:[0,0,0] op_sel_hi:[0,1,1] neg_lo:[0,0,1] neg_hi:[1,0,1]
    v_mov_b32_dpp v80, v78 row_ror:8 row_mask:0xf bank_mask:0x3
    v_mov_b32_dpp v81, v79 row_ror:8 row_mask:0xf bank_mask:0x3
    v_mov_b32_dpp v82, v84 row_ror:8 row_mask:0xf bank_mask:0x3
    v_mov_b32_dpp v83, v85 row_ror:8 row_mask:0xf bank_mask:0x3
    v_pk_mul_f32 v[92:93], v[66:67], v[80:81] op_sel:[1,1] op_sel_hi:[1,0]
    v_pk_fma_f32 v[88:89], v[66:67], v[80:81], v[92:93] op_sel:[0,0,0] op_sel_hi:[0,1,1] neg_lo:[0,0,1] neg_hi:[1,0,1]
    v_pk_mul_f32 v[94:95], v[66:67], v[82:83] op_sel:[1,1] op_sel_hi:[1,0]
    v_pk_fma_f32 v[90:91], v[66:67], v[82:83], v[94:95] op_sel:[0,0,0] op_sel_hi:[0,1,1] neg_lo:[0,0,1] neg_hi:[1,0,1]
    v_mfma_f32_16x16x4_f32 v[48:51], v86, v68, v[48:51]
    v_mfma_f32_16x16x4_f32 v[52:55], v88, v70, v[52:55]
    v_mfma_f32_16x16x4_f32 v[56:59], v88, v72, v[56:59]
    v_mfma_f32_16x16x4_f32 v[60:63], v90, v74, v[60:63]
    v_mfma_f32_16x16x4_f32 v[48:51], v87, v69, v[48:51]
    v_mfma_f32_16x16x4_f32 v[52:55], v89, v71, v[52:55]
    v_mfma_f32_16x16x4_f32 v[56:59], v89, v73, v[56:59]
    v_mfma_f32_16x16x4_f32 v[60:63], v91, v75, v[60:63]
    v_mov_b64_dpp v[64:65], v[28:29] row_newbcast:8 row_mask:0xf bank_mask:0xf
    v_mov_b64_dpp v[66:67], v[30:31] row_newbcast:8 row_mask:0xf bank_mask:0xf
    v_pk_mul_f32 v[94:95], v[64:65], v[26:27] op_sel_hi:[1,0]
    v_pk_mul_f32 v[96:97], v[64:65], v[26:27] op_sel:[0,1] op_sel_hi:[1,1]
    v_fract_f32 v95, v95
    v_fract_f32 v97, v97
    v_exp_f32 v94, v94
    v_exp_f32 v96, v96
    v_cos_f32 v68, v95
    v_sin_f32 v69, v95
    v_cos_f32 v76, v97
    v_sin_f32 v77, v97
    v_pk_mul_f32 v[68:69], v[68:69], v[94:95] op_sel_hi:[1,0]
    v_pk_mul_f32 v[76:77], v[76:77], v[96:97] op_sel_hi:[1,0]
    v_pk_mul_f32 v[92:93], v[76:77], v[76:77] op_sel:[1,1] op_sel_hi:[0,1]
    v_pk_fma_f32 v[78:79], v[76:77], v[76:77], v[92:93] op_sel:[0,0,0] op_sel_hi:[0,1,1] neg_lo:[0,0,1]
    v_pk_mul_f32 v[94:95], v[68:69], v[68:69] op_sel:[1,1] op_sel_hi:[0,1]
    v_pk_fma_f32 v[70:71], v[68:69], v[68:69], v[94:95] op_sel:[0,0,0] op_sel_hi:[0,1,1] neg_lo:[0,0,1]
    v_pk_mul_f32 v[92:93], v[78:79], v[78:79] op_sel:[1,1] op_sel_hi:[0,1]
    v_pk_fma_f32 v[80:81], v[78:79], v[78:79], v[92:93] op_sel:[0,0,0] op_sel_hi:[0,1,1] neg_lo:[0,0,1]
    v_pk_mul_f32 v[94:95], v[70:71], v[70:71] op_sel:[1,1] op_sel_hi:[0,1]
    v_pk_fma_f32 v[72:73], v[70:71], v[70:71], v[94:95] op_sel:[0,0,0] op_sel_hi:[0,1,1] neg_lo:[0,0,1]
    v_pk_mul_f32 v[92:93], v[80:81], v[80:81] op_sel:[1,1] op_sel_hi:[0,1]
    v_pk_fma_f32 v[82:83], v[80:81], v[80:81], v[92:93] op_sel:[0,0,0] op_sel_hi:[0,1,1] neg_lo:[0,0,1]
    v_pk_mul_f32 v[94:95], v[72:73], v[72:73] op_sel:[1,1] op_sel_hi:[0,1]
    v_pk_fma_f32 v[74:75], v[72:73], v[72:73], v[94:95] op_sel:[0,0,0] op_sel_hi:[0,1,1] neg_lo:[0,0,1]
    v_pk_mul_f32 v[92:93], v[82:83], v[82:83] op_sel:[1,1] op_sel_hi:[0,1]
    v_pk_fma_f32 v[84:85], v[82:83], v[82:83], v[92:93] op_sel:[0,0,0] op_sel_hi:[0,1,1] neg_lo:[0,0,1]
    v_pk_mul_f32 v[94:95], v[66:67], v[76:77] op_sel:[1,1] op_sel_hi:[1,0]
    v_pk_fma_f32 v[86:87], v[66:67], v[76:77], v[94:95] op_sel:[0,0,0] op_sel_hi:[0,1,1] neg_lo:[0,0,1] neg_hi:[1,0,1]
    v_mov_b32_dpp v80, v78 row_ror:8 row_mask:0xf bank_mask:0x3
    v_mov_b32_dpp v81, v79 row_ror:8 row_mask:0xf bank_mask:0x3
    v_mov_b32_dpp v82, v84 row_ror:8 row_mask:0xf bank_mask:0x3
    v_mov_b32_dpp v83, v85 row_ror:8 row_mask:0xf bank_mask:0x3
    v_pk_mul_f32 v[92:93], v[66:67], v[80:81] op_sel:[1,1] op_sel_hi:[1,0]
    v_pk_fma_f32 v[88:89], v[66:67], v[80:81], v[92:93] op_sel:[0,0,0] op_sel_hi:[0,1,1] neg_lo:[0,0,1] neg_hi:[1,0,1]
    v_pk_mul_f32 v[94:95], v[66:67], v[82:83] op_sel:[1,1] op_sel_hi:[1,0]
    v_pk_fma_f32 v[90:91], v[66:67], v[82:83], v[94:95] op_sel:[0,0,0] op_sel_hi:[0,1,1] neg_lo:[0,0,1] neg_hi:[1,0,1]
    v_mfma_f32_16x16x4_f32 v[48:51], v86, v68, v[48:51]
    v_mfma_f32_16x16x4_f32 v[52:55], v88, v70, v[52:55]
    v_mfma_f32_16x16x4_f32 v[56:59], v88, v72, v[56:59]
    v_mfma_f32_16x16x4_f32 v[60:63], v90, v74, v[60:63]
    v_mfma_f32_16x16x4_f32 v[48:51], v87, v69, v[48:51]
    v_mfma_f32_16x16x4_f32 v[52:55], v89, v71, v[52:55]
    v_mfma_f32_16x16x4_f32 v[56:59], v89, v73, v[56:59]
    v_mfma_f32_16x16x4_f32 v[60:63], v91, v75, v[60:63]
    v_mov_b64_dpp v[64:65], v[28:29] row_newbcast:9 row_mask:0xf bank_mask:0xf
    v_mov_b64_dpp v[66:67], v[30:31] row_newbcast:9 row_mask:0xf bank_mask:0xf
    v_pk_mul_f32 v[94:95], v[64:65], v[26:27] op_sel_hi:[1,0]
    v_pk_mul_f32 v[96:97], v[64:65], v[26:27] op_sel:[0,1] op_sel_hi:[1,1]
    v_fract_f32 v95, v95
    v_fract_f32 v97, v97
    v_exp_f32 v94, v94
    v_exp_f32 v96, v96
    v_cos_f32 v68, v95
    v_sin_f32 v69, v95
    v_cos_f32 v76, v97
    v_sin_f32 v77, v97
    v_pk_mul_f32 v[68:69], v[68:69], v[94:95] op_sel_hi:[1,0]
    v_pk_mul_f32 v[76:77], v[76:77], v[96:97] op_sel_hi:[1,0]
    v_pk_mul_f32 v[92:93], v[76:77], v[76:77] op_sel:[1,1] op_sel_hi:[0,1]
    v_pk_fma_f32 v[78:79], v[76:77], v[76:77], v[92:93] op_sel:[0,0,0] op_sel_hi:[0,1,1] neg_lo:[0,0,1]
    v_pk_mul_f32 v[94:95], v[68:69], v[68:69] op_sel:[1,1] op_sel_hi:[0,1]
    v_pk_fma_f32 v[70:71], v[68:69], v[68:69], v[94:95] op_sel:[0,0,0] op_sel_hi:[0,1,1] neg_lo:[0,0,1]
    v_pk_mul_f32 v[92:93], v[78:79], v[78:79] op_sel:[1,1] op_sel_hi:[0,1]
    v_pk_fma_f32 v[80:81], v[78:79], v[78:79], v[92:93] op_sel:[0,0,0] op_sel_hi:[0,1,1] neg_lo:[0,0,1]
    v_pk_mul_f32 v[94:95], v[70:71], v[70:71] op_sel:[1,1] op_sel_hi:[0,1]
    v_pk_fma_f32 v[72:73], v[70:71], v[70:71], v[94:95] op_sel:[0,0,0] op_sel_hi:[0,1,1] neg_lo:[0,0,1]
    v_pk_mul_f32 v[92:93], v[80:81], v[80:81] op_sel:[1,1] op_sel_hi:[0,1]
    v_pk_fma_f32 v[82:83], v[80:81], v[80:81], v[92:93] op_sel:[0,0,0] op_sel_hi:[0,1,1] neg_lo:[0,0,1]
    v_pk_mul_f32 v[94:95], v[72:73], v[72:73] op_sel:[1,1] op_sel_hi:[0,1]
    v_pk_fma_f32 v[74:75], v[72:73], v[72:73], v[94:95] op_sel:[0,0,0] op_sel_hi:[0,1,1] neg_lo:[0,0,1]
    v_pk_mul_f32 v[92:93], v[82:83], v[82:83] op_sel:[1,1] op_sel_hi:[0,1]
    v_pk_fma_f32 v[84:85], v[82:83], v[82:83], v[92:93] op_sel:[0,0,0] op_sel_hi:[0,1,1] neg_lo:[0,0,1]
    v_pk_mul_f32 v[94:95], v[66:67], v[76:77] op_sel:[1,1] op_sel_hi:[1,0]
    v_pk_fma_f32 v[86:87], v[66:67], v[76:77], v[94:95] op_sel:[0,0,0] op_sel_hi:[0,1,1] neg_lo:[0,0,1] neg_hi:[1,0,1]
    v_mov_b32_dpp v80, v78 row_ror:8 row_mask:0xf bank_mask:0x3
    v_mov_b32_dpp v81, v79 row_ror:8 row_mask:0xf bank_mask:0x3
    v_mov_b32_dpp v82, v84 row_ror:8 row_mask:0xf bank_mask:0x3
    v_mov_b32_dpp v83, v85 row_ror:8 row_mask:0xf bank_mask:0x3
    v_pk_mul_f32 v[92:93], v[66:67], v[80:81] op_sel:[1,1] op_sel_hi:[1,0]
    v_pk_fma_f32 v[88:89], v[66:67], v[80:81], v[92:93] op_sel:[0,0,0] op_sel_hi:[0,1,1] neg_lo:[0,0,1] neg_hi:[1,0,1]
    v_pk_mul_f32 v[94:95], v[66:67], v[82:83] op_sel:[1,1] op_sel_hi:[1,0]
    v_pk_fma_f32 v[90:91], v[66:67], v[82:83], v[94:95] op_sel:[0,0,0] op_sel_hi:[0,1,1] neg_lo:[0,0,1] neg_hi:[1,0,1]
    v_mfma_f32_16x16x4_f32 v[48:51], v86, v68, v[48:51]
    v_mfma_f32_16x16x4_f32 v[52:55], v88, v70, v[52:55]
    v_mfma_f32_16x16x4_f32 v[56:59], v88, v72, v[56:59]
    v_mfma_f32_16x16x4_f32 v[60:63], v90, v74, v[60:63]
    v_mfma_f32_16x16x4_f32 v[48:51], v87, v69, v[48:51]
    v_mfma_f32_16x16x4_f32 v[52:55], v89, v71, v[52:55]
    v_mfma_f32_16x16x4_f32 v[56:59], v89, v73, v[56:59]
    v_mfma_f32_16x16x4_f32 v[60:63], v91, v75, v[60:63]
    v_mov_b64_dpp v[64:65], v[28:29] row_newbcast:10 row_mask:0xf bank_mask:0xf
    v_mov_b64_dpp v[66:67], v[30:31] row_newbcast:10 row_mask:0xf bank_mask:0xf
    v_pk_mul_f32 v[94:95], v[64:65], v[26:27] op_sel_hi:[1,0]
    v_pk_mul_f32 v[96:97], v[64:65], v[26:27] op_sel:[0,1] op_sel_hi:[1,1]
    v_fract_f32 v95, v95
    v_fract_f32 v97, v97
    v_exp_f32 v94, v94
    v_exp_f32 v96, v96
    v_cos_f32 v68, v95
    v_sin_f32 v69, v95
    v_cos_f32 v76, v97
    v_sin_f32 v77, v97
    v_pk_mul_f32 v[68:69], v[68:69], v[94:95] op_sel_hi:[1,0]
    v_pk_mul_f32 v[76:77], v[76:77], v[96:97] op_sel_hi:[1,0]
    v_pk_mul_f32 v[92:93], v[76:77], v[76:77] op_sel:[1,1] op_sel_hi:[0,1]
    v_pk_fma_f32 v[78:79], v[76:77], v[76:77], v[92:93] op_sel:[0,0,0] op_sel_hi:[0,1,1] neg_lo:[0,0,1]
    v_pk_mul_f32 v[94:95], v[68:69], v[68:69] op_sel:[1,1] op_sel_hi:[0,1]
    v_pk_fma_f32 v[70:71], v[68:69], v[68:69], v[94:95] op_sel:[0,0,0] op_sel_hi:[0,1,1] neg_lo:[0,0,1]
    v_pk_mul_f32 v[92:93], v[78:79], v[78:79] op_sel:[1,1] op_sel_hi:[0,1]
    v_pk_fma_f32 v[80:81], v[78:79], v[78:79], v[92:93] op_sel:[0,0,0] op_sel_hi:[0,1,1] neg_lo:[0,0,1]
    v_pk_mul_f32 v[94:95], v[70:71], v[70:71] op_sel:[1,1] op_sel_hi:[0,1]
    v_pk_fma_f32 v[72:73], v[70:71], v[70:71], v[94:95] op_sel:[0,0,0] op_sel_hi:[0,1,1] neg_lo:[0,0,1]
    v_pk_mul_f32 v[92:93], v[80:81], v[80:81] op_sel:[1,1] op_sel_hi:[0,1]
    v_pk_fma_f32 v[82:83], v[80:81], v[80:81], v[92:93] op_sel:[0,0,0] op_sel_hi:[0,1,1] neg_lo:[0,0,1]
    v_pk_mul_f32 v[94:95], v[72:73], v[72:73] op_sel:[1,1] op_sel_hi:[0,1]
    v_pk_fma_f32 v[74:75], v[72:73], v[72:73], v[94:95] op_sel:[0,0,0] op_sel_hi:[0,1,1] neg_lo:[0,0,1]
    v_pk_mul_f32 v[92:93], v[82:83], v[82:83] op_sel:[1,1] op_sel_hi:[0,1]
    v_pk_fma_f32 v[84:85], v[82:83], v[82:83], v[92:93] op_sel:[0,0,0] op_sel_hi:[0,1,1] neg_lo:[0,0,1]
    v_pk_mul_f32 v[94:95], v[66:67], v[76:77] op_sel:[1,1] op_sel_hi:[1,0]
    v_pk_fma_f32 v[86:87], v[66:67], v[76:77], v[94:95] op_sel:[0,0,0] op_sel_hi:[0,1,1] neg_lo:[0,0,1] neg_hi:[1,0,1]
    v_mov_b32_dpp v80, v78 row_ror:8 row_mask:0xf bank_mask:0x3
    v_mov_b32_dpp v81, v79 row_ror:8 row_mask:0xf bank_mask:0x3
    v_mov_b32_dpp v82, v84 row_ror:8 row_mask:0xf bank_mask:0x3
    v_mov_b32_dpp v83, v85 row_ror:8 row_mask:0xf bank_mask:0x3
    v_pk_mul_f32 v[92:93], v[66:67], v[80:81] op_sel:[1,1] op_sel_hi:[1,0]
    v_pk_fma_f32 v[88:89], v[66:67], v[80:81], v[92:93] op_sel:[0,0,0] op_sel_hi:[0,1,1] neg_lo:[0,0,1] neg_hi:[1,0,1]
    v_pk_mul_f32 v[94:95], v[66:67], v[82:83] op_sel:[1,1] op_sel_hi:[1,0]
    v_pk_fma_f32 v[90:91], v[66:67], v[82:83], v[94:95] op_sel:[0,0,0] op_sel_hi:[0,1,1] neg_lo:[0,0,1] neg_hi:[1,0,1]
    v_mfma_f32_16x16x4_f32 v[48:51], v86, v68, v[48:51]
    v_mfma_f32_16x16x4_f32 v[52:55], v88, v70, v[52:55]
    v_mfma_f32_16x16x4_f32 v[56:59], v88, v72, v[56:59]
    v_mfma_f32_16x16x4_f32 v[60:63], v90, v74, v[60:63]
    v_mfma_f32_16x16x4_f32 v[48:51], v87, v69, v[48:51]
    v_mfma_f32_16x16x4_f32 v[52:55], v89, v71, v[52:55]
    v_mfma_f32_16x16x4_f32 v[56:59], v89, v73, v[56:59]
    v_mfma_f32_16x16x4_f32 v[60:63], v91, v75, v[60:63]
    v_mov_b64_dpp v[64:65], v[28:29] row_newbcast:11 row_mask:0xf bank_mask:0xf
    v_mov_b64_dpp v[66:67], v[30:31] row_newbcast:11 row_mask:0xf bank_mask:0xf
    v_pk_mul_f32 v[94:95], v[64:65], v[26:27] op_sel_hi:[1,0]
    v_pk_mul_f32 v[96:97], v[64:65], v[26:27] op_sel:[0,1] op_sel_hi:[1,1]
    v_fract_f32 v95, v95
    v_fract_f32 v97, v97
    v_exp_f32 v94, v94
    v_exp_f32 v96, v96
    v_cos_f32 v68, v95
    v_sin_f32 v69, v95
    v_cos_f32 v76, v97
    v_sin_f32 v77, v97
    v_pk_mul_f32 v[68:69], v[68:69], v[94:95] op_sel_hi:[1,0]
    v_pk_mul_f32 v[76:77], v[76:77], v[96:97] op_sel_hi:[1,0]
    v_pk_mul_f32 v[92:93], v[76:77], v[76:77] op_sel:[1,1] op_sel_hi:[0,1]
    v_pk_fma_f32 v[78:79], v[76:77], v[76:77], v[92:93] op_sel:[0,0,0] op_sel_hi:[0,1,1] neg_lo:[0,0,1]
    v_pk_mul_f32 v[94:95], v[68:69], v[68:69] op_sel:[1,1] op_sel_hi:[0,1]
    v_pk_fma_f32 v[70:71], v[68:69], v[68:69], v[94:95] op_sel:[0,0,0] op_sel_hi:[0,1,1] neg_lo:[0,0,1]
    v_pk_mul_f32 v[92:93], v[78:79], v[78:79] op_sel:[1,1] op_sel_hi:[0,1]
    v_pk_fma_f32 v[80:81], v[78:79], v[78:79], v[92:93] op_sel:[0,0,0] op_sel_hi:[0,1,1] neg_lo:[0,0,1]
    v_pk_mul_f32 v[94:95], v[70:71], v[70:71] op_sel:[1,1] op_sel_hi:[0,1]
    v_pk_fma_f32 v[72:73], v[70:71], v[70:71], v[94:95] op_sel:[0,0,0] op_sel_hi:[0,1,1] neg_lo:[0,0,1]
    v_pk_mul_f32 v[92:93], v[80:81], v[80:81] op_sel:[1,1] op_sel_hi:[0,1]
    v_pk_fma_f32 v[82:83], v[80:81], v[80:81], v[92:93] op_sel:[0,0,0] op_sel_hi:[0,1,1] neg_lo:[0,0,1]
    v_pk_mul_f32 v[94:95], v[72:73], v[72:73] op_sel:[1,1] op_sel_hi:[0,1]
    v_pk_fma_f32 v[74:75], v[72:73], v[72:73], v[94:95] op_sel:[0,0,0] op_sel_hi:[0,1,1] neg_lo:[0,0,1]
    v_pk_mul_f32 v[92:93], v[82:83], v[82:83] op_sel:[1,1] op_sel_hi:[0,1]
    v_pk_fma_f32 v[84:85], v[82:83], v[82:83], v[92:93] op_sel:[0,0,0] op_sel_hi:[0,1,1] neg_lo:[0,0,1]
    v_pk_mul_f32 v[94:95], v[66:67], v[76:77] op_sel:[1,1] op_sel_hi:[1,0]
    v_pk_fma_f32 v[86:87], v[66:67], v[76:77], v[94:95] op_sel:[0,0,0] op_sel_hi:[0,1,1] neg_lo:[0,0,1] neg_hi:[1,0,1]
    v_mov_b32_dpp v80, v78 row_ror:8 row_mask:0xf bank_mask:0x3
    v_mov_b32_dpp v81, v79 row_ror:8 row_mask:0xf bank_mask:0x3
    v_mov_b32_dpp v82, v84 row_ror:8 row_mask:0xf bank_mask:0x3
    v_mov_b32_dpp v83, v85 row_ror:8 row_mask:0xf bank_mask:0x3
    v_pk_mul_f32 v[92:93], v[66:67], v[80:81] op_sel:[1,1] op_sel_hi:[1,0]
    v_pk_fma_f32 v[88:89], v[66:67], v[80:81], v[92:93] op_sel:[0,0,0] op_sel_hi:[0,1,1] neg_lo:[0,0,1] neg_hi:[1,0,1]
    v_pk_mul_f32 v[94:95], v[66:67], v[82:83] op_sel:[1,1] op_sel_hi:[1,0]
    v_pk_fma_f32 v[90:91], v[66:67], v[82:83], v[94:95] op_sel:[0,0,0] op_sel_hi:[0,1,1] neg_lo:[0,0,1] neg_hi:[1,0,1]
    v_mfma_f32_16x16x4_f32 v[48:51], v86, v68, v[48:51]
    v_mfma_f32_16x16x4_f32 v[52:55], v88, v70, v[52:55]
    v_mfma_f32_16x16x4_f32 v[56:59], v88, v72, v[56:59]
    v_mfma_f32_16x16x4_f32 v[60:63], v90, v74, v[60:63]
    v_mfma_f32_16x16x4_f32 v[48:51], v87, v69, v[48:51]
    v_mfma_f32_16x16x4_f32 v[52:55], v89, v71, v[52:55]
    v_mfma_f32_16x16x4_f32 v[56:59], v89, v73, v[56:59]
    v_mfma_f32_16x16x4_f32 v[60:63], v91, v75, v[60:63]
    v_mov_b64_dpp v[64:65], v[28:29] row_newbcast:12 row_mask:0xf bank_mask:0xf
    v_mov_b64_dpp v[66:67], v[30:31] row_newbcast:12 row_mask:0xf bank_mask:0xf
    v_pk_mul_f32 v[94:95], v[64:65], v[26:27] op_sel_hi:[1,0]
    v_pk_mul_f32 v[96:97], v[64:65], v[26:27] op_sel:[0,1] op_sel_hi:[1,1]
    v_fract_f32 v95, v95
    v_fract_f32 v97, v97
    v_exp_f32 v94, v94
    v_exp_f32 v96, v96
    v_cos_f32 v68, v95
    v_sin_f32 v69, v95
    v_cos_f32 v76, v97
    v_sin_f32 v77, v97
    v_pk_mul_f32 v[68:69], v[68:69], v[94:95] op_sel_hi:[1,0]
    v_pk_mul_f32 v[76:77], v[76:77], v[96:97] op_sel_hi:[1,0]
    v_pk_mul_f32 v[92:93], v[76:77], v[76:77] op_sel:[1,1] op_sel_hi:[0,1]
    v_pk_fma_f32 v[78:79], v[76:77], v[76:77], v[92:93] op_sel:[0,0,0] op_sel_hi:[0,1,1] neg_lo:[0,0,1]
    v_pk_mul_f32 v[94:95], v[68:69], v[68:69] op_sel:[1,1] op_sel_hi:[0,1]
    v_pk_fma_f32 v[70:71], v[68:69], v[68:69], v[94:95] op_sel:[0,0,0] op_sel_hi:[0,1,1] neg_lo:[0,0,1]
    v_pk_mul_f32 v[92:93], v[78:79], v[78:79] op_sel:[1,1] op_sel_hi:[0,1]
    v_pk_fma_f32 v[80:81], v[78:79], v[78:79], v[92:93] op_sel:[0,0,0] op_sel_hi:[0,1,1] neg_lo:[0,0,1]
    v_pk_mul_f32 v[94:95], v[70:71], v[70:71] op_sel:[1,1] op_sel_hi:[0,1]
    v_pk_fma_f32 v[72:73], v[70:71], v[70:71], v[94:95] op_sel:[0,0,0] op_sel_hi:[0,1,1] neg_lo:[0,0,1]
    v_pk_mul_f32 v[92:93], v[80:81], v[80:81] op_sel:[1,1] op_sel_hi:[0,1]
    v_pk_fma_f32 v[82:83], v[80:81], v[80:81], v[92:93] op_sel:[0,0,0] op_sel_hi:[0,1,1] neg_lo:[0,0,1]
    v_pk_mul_f32 v[94:95], v[72:73], v[72:73] op_sel:[1,1] op_sel_hi:[0,1]
    v_pk_fma_f32 v[74:75], v[72:73], v[72:73], v[94:95] op_sel:[0,0,0] op_sel_hi:[0,1,1] neg_lo:[0,0,1]
    v_pk_mul_f32 v[92:93], v[82:83], v[82:83] op_sel:[1,1] op_sel_hi:[0,1]
    v_pk_fma_f32 v[84:85], v[82:83], v[82:83], v[92:93] op_sel:[0,0,0] op_sel_hi:[0,1,1] neg_lo:[0,0,1]
    v_pk_mul_f32 v[94:95], v[66:67], v[76:77] op_sel:[1,1] op_sel_hi:[1,0]
    v_pk_fma_f32 v[86:87], v[66:67], v[76:77], v[94:95] op_sel:[0,0,0] op_sel_hi:[0,1,1] neg_lo:[0,0,1] neg_hi:[1,0,1]
    v_mov_b32_dpp v80, v78 row_ror:8 row_mask:0xf bank_mask:0x3
    v_mov_b32_dpp v81, v79 row_ror:8 row_mask:0xf bank_mask:0x3
    v_mov_b32_dpp v82, v84 row_ror:8 row_mask:0xf bank_mask:0x3
    v_mov_b32_dpp v83, v85 row_ror:8 row_mask:0xf bank_mask:0x3
    v_pk_mul_f32 v[92:93], v[66:67], v[80:81] op_sel:[1,1] op_sel_hi:[1,0]
    v_pk_fma_f32 v[88:89], v[66:67], v[80:81], v[92:93] op_sel:[0,0,0] op_sel_hi:[0,1,1] neg_lo:[0,0,1] neg_hi:[1,0,1]
    v_pk_mul_f32 v[94:95], v[66:67], v[82:83] op_sel:[1,1] op_sel_hi:[1,0]
    v_pk_fma_f32 v[90:91], v[66:67], v[82:83], v[94:95] op_sel:[0,0,0] op_sel_hi:[0,1,1] neg_lo:[0,0,1] neg_hi:[1,0,1]
    v_mfma_f32_16x16x4_f32 v[48:51], v86, v68, v[48:51]
    v_mfma_f32_16x16x4_f32 v[52:55], v88, v70, v[52:55]
    v_mfma_f32_16x16x4_f32 v[56:59], v88, v72, v[56:59]
    v_mfma_f32_16x16x4_f32 v[60:63], v90, v74, v[60:63]
    v_mfma_f32_16x16x4_f32 v[48:51], v87, v69, v[48:51]
    v_mfma_f32_16x16x4_f32 v[52:55], v89, v71, v[52:55]
    v_mfma_f32_16x16x4_f32 v[56:59], v89, v73, v[56:59]
    v_mfma_f32_16x16x4_f32 v[60:63], v91, v75, v[60:63]
    v_mov_b64_dpp v[64:65], v[28:29] row_newbcast:13 row_mask:0xf bank_mask:0xf
    v_mov_b64_dpp v[66:67], v[30:31] row_newbcast:13 row_mask:0xf bank_mask:0xf
    v_pk_mul_f32 v[94:95], v[64:65], v[26:27] op_sel_hi:[1,0]
    v_pk_mul_f32 v[96:97], v[64:65], v[26:27] op_sel:[0,1] op_sel_hi:[1,1]
    v_fract_f32 v95, v95
    v_fract_f32 v97, v97
    v_exp_f32 v94, v94
    v_exp_f32 v96, v96
    v_cos_f32 v68, v95
    v_sin_f32 v69, v95
    v_cos_f32 v76, v97
    v_sin_f32 v77, v97
    v_pk_mul_f32 v[68:69], v[68:69], v[94:95] op_sel_hi:[1,0]
    v_pk_mul_f32 v[76:77], v[76:77], v[96:97] op_sel_hi:[1,0]
    v_pk_mul_f32 v[92:93], v[76:77], v[76:77] op_sel:[1,1] op_sel_hi:[0,1]
    v_pk_fma_f32 v[78:79], v[76:77], v[76:77], v[92:93] op_sel:[0,0,0] op_sel_hi:[0,1,1] neg_lo:[0,0,1]
    v_pk_mul_f32 v[94:95], v[68:69], v[68:69] op_sel:[1,1] op_sel_hi:[0,1]
    v_pk_fma_f32 v[70:71], v[68:69], v[68:69], v[94:95] op_sel:[0,0,0] op_sel_hi:[0,1,1] neg_lo:[0,0,1]
    v_pk_mul_f32 v[92:93], v[78:79], v[78:79] op_sel:[1,1] op_sel_hi:[0,1]
    v_pk_fma_f32 v[80:81], v[78:79], v[78:79], v[92:93] op_sel:[0,0,0] op_sel_hi:[0,1,1] neg_lo:[0,0,1]
    v_pk_mul_f32 v[94:95], v[70:71], v[70:71] op_sel:[1,1] op_sel_hi:[0,1]
    v_pk_fma_f32 v[72:73], v[70:71], v[70:71], v[94:95] op_sel:[0,0,0] op_sel_hi:[0,1,1] neg_lo:[0,0,1]
    v_pk_mul_f32 v[92:93], v[80:81], v[80:81] op_sel:[1,1] op_sel_hi:[0,1]
    v_pk_fma_f32 v[82:83], v[80:81], v[80:81], v[92:93] op_sel:[0,0,0] op_sel_hi:[0,1,1] neg_lo:[0,0,1]
    v_pk_mul_f32 v[94:95], v[72:73], v[72:73] op_sel:[1,1] op_sel_hi:[0,1]
    v_pk_fma_f32 v[74:75], v[72:73], v[72:73], v[94:95] op_sel:[0,0,0] op_sel_hi:[0,1,1] neg_lo:[0,0,1]
    v_pk_mul_f32 v[92:93], v[82:83], v[82:83] op_sel:[1,1] op_sel_hi:[0,1]
    v_pk_fma_f32 v[84:85], v[82:83], v[82:83], v[92:93] op_sel:[0,0,0] op_sel_hi:[0,1,1] neg_lo:[0,0,1]
    v_pk_mul_f32 v[94:95], v[66:67], v[76:77] op_sel:[1,1] op_sel_hi:[1,0]
    v_pk_fma_f32 v[86:87], v[66:67], v[76:77], v[94:95] op_sel:[0,0,0] op_sel_hi:[0,1,1] neg_lo:[0,0,1] neg_hi:[1,0,1]
    v_mov_b32_dpp v80, v78 row_ror:8 row_mask:0xf bank_mask:0x3
    v_mov_b32_dpp v81, v79 row_ror:8 row_mask:0xf bank_mask:0x3
    v_mov_b32_dpp v82, v84 row_ror:8 row_mask:0xf bank_mask:0x3
    v_mov_b32_dpp v83, v85 row_ror:8 row_mask:0xf bank_mask:0x3
    v_pk_mul_f32 v[92:93], v[66:67], v[80:81] op_sel:[1,1] op_sel_hi:[1,0]
    v_pk_fma_f32 v[88:89], v[66:67], v[80:81], v[92:93] op_sel:[0,0,0] op_sel_hi:[0,1,1] neg_lo:[0,0,1] neg_hi:[1,0,1]
    v_pk_mul_f32 v[94:95], v[66:67], v[82:83] op_sel:[1,1] op_sel_hi:[1,0]
    v_pk_fma_f32 v[90:91], v[66:67], v[82:83], v[94:95] op_sel:[0,0,0] op_sel_hi:[0,1,1] neg_lo:[0,0,1] neg_hi:[1,0,1]
    v_mfma_f32_16x16x4_f32 v[48:51], v86, v68, v[48:51]
    v_mfma_f32_16x16x4_f32 v[52:55], v88, v70, v[52:55]
    v_mfma_f32_16x16x4_f32 v[56:59], v88, v72, v[56:59]
    v_mfma_f32_16x16x4_f32 v[60:63], v90, v74, v[60:63]
    v_mfma_f32_16x16x4_f32 v[48:51], v87, v69, v[48:51]
    v_mfma_f32_16x16x4_f32 v[52:55], v89, v71, v[52:55]
    v_mfma_f32_16x16x4_f32 v[56:59], v89, v73, v[56:59]
    v_mfma_f32_16x16x4_f32 v[60:63], v91, v75, v[60:63]
    v_mov_b64_dpp v[64:65], v[28:29] row_newbcast:14 row_mask:0xf bank_mask:0xf
    v_mov_b64_dpp v[66:67], v[30:31] row_newbcast:14 row_mask:0xf bank_mask:0xf
    v_pk_mul_f32 v[94:95], v[64:65], v[26:27] op_sel_hi:[1,0]
    v_pk_mul_f32 v[96:97], v[64:65], v[26:27] op_sel:[0,1] op_sel_hi:[1,1]
    v_fract_f32 v95, v95
    v_fract_f32 v97, v97
    v_exp_f32 v94, v94
    v_exp_f32 v96, v96
    v_cos_f32 v68, v95
    v_sin_f32 v69, v95
    v_cos_f32 v76, v97
    v_sin_f32 v77, v97
    v_pk_mul_f32 v[68:69], v[68:69], v[94:95] op_sel_hi:[1,0]
    v_pk_mul_f32 v[76:77], v[76:77], v[96:97] op_sel_hi:[1,0]
    v_pk_mul_f32 v[92:93], v[76:77], v[76:77] op_sel:[1,1] op_sel_hi:[0,1]
    v_pk_fma_f32 v[78:79], v[76:77], v[76:77], v[92:93] op_sel:[0,0,0] op_sel_hi:[0,1,1] neg_lo:[0,0,1]
    v_pk_mul_f32 v[94:95], v[68:69], v[68:69] op_sel:[1,1] op_sel_hi:[0,1]
    v_pk_fma_f32 v[70:71], v[68:69], v[68:69], v[94:95] op_sel:[0,0,0] op_sel_hi:[0,1,1] neg_lo:[0,0,1]
    v_pk_mul_f32 v[92:93], v[78:79], v[78:79] op_sel:[1,1] op_sel_hi:[0,1]
    v_pk_fma_f32 v[80:81], v[78:79], v[78:79], v[92:93] op_sel:[0,0,0] op_sel_hi:[0,1,1] neg_lo:[0,0,1]
    v_pk_mul_f32 v[94:95], v[70:71], v[70:71] op_sel:[1,1] op_sel_hi:[0,1]
    v_pk_fma_f32 v[72:73], v[70:71], v[70:71], v[94:95] op_sel:[0,0,0] op_sel_hi:[0,1,1] neg_lo:[0,0,1]
    v_pk_mul_f32 v[92:93], v[80:81], v[80:81] op_sel:[1,1] op_sel_hi:[0,1]
    v_pk_fma_f32 v[82:83], v[80:81], v[80:81], v[92:93] op_sel:[0,0,0] op_sel_hi:[0,1,1] neg_lo:[0,0,1]
    v_pk_mul_f32 v[94:95], v[72:73], v[72:73] op_sel:[1,1] op_sel_hi:[0,1]
    v_pk_fma_f32 v[74:75], v[72:73], v[72:73], v[94:95] op_sel:[0,0,0] op_sel_hi:[0,1,1] neg_lo:[0,0,1]
    v_pk_mul_f32 v[92:93], v[82:83], v[82:83] op_sel:[1,1] op_sel_hi:[0,1]
    v_pk_fma_f32 v[84:85], v[82:83], v[82:83], v[92:93] op_sel:[0,0,0] op_sel_hi:[0,1,1] neg_lo:[0,0,1]
    v_pk_mul_f32 v[94:95], v[66:67], v[76:77] op_sel:[1,1] op_sel_hi:[1,0]
    v_pk_fma_f32 v[86:87], v[66:67], v[76:77], v[94:95] op_sel:[0,0,0] op_sel_hi:[0,1,1] neg_lo:[0,0,1] neg_hi:[1,0,1]
    v_mov_b32_dpp v80, v78 row_ror:8 row_mask:0xf bank_mask:0x3
    v_mov_b32_dpp v81, v79 row_ror:8 row_mask:0xf bank_mask:0x3
    v_mov_b32_dpp v82, v84 row_ror:8 row_mask:0xf bank_mask:0x3
    v_mov_b32_dpp v83, v85 row_ror:8 row_mask:0xf bank_mask:0x3
    v_pk_mul_f32 v[92:93], v[66:67], v[80:81] op_sel:[1,1] op_sel_hi:[1,0]
    v_pk_fma_f32 v[88:89], v[66:67], v[80:81], v[92:93] op_sel:[0,0,0] op_sel_hi:[0,1,1] neg_lo:[0,0,1] neg_hi:[1,0,1]
    v_pk_mul_f32 v[94:95], v[66:67], v[82:83] op_sel:[1,1] op_sel_hi:[1,0]
    v_pk_fma_f32 v[90:91], v[66:67], v[82:83], v[94:95] op_sel:[0,0,0] op_sel_hi:[0,1,1] neg_lo:[0,0,1] neg_hi:[1,0,1]
    v_mfma_f32_16x16x4_f32 v[48:51], v86, v68, v[48:51]
    v_mfma_f32_16x16x4_f32 v[52:55], v88, v70, v[52:55]
    v_mfma_f32_16x16x4_f32 v[56:59], v88, v72, v[56:59]
    v_mfma_f32_16x16x4_f32 v[60:63], v90, v74, v[60:63]
    v_mfma_f32_16x16x4_f32 v[48:51], v87, v69, v[48:51]
    v_mfma_f32_16x16x4_f32 v[52:55], v89, v71, v[52:55]
    v_mfma_f32_16x16x4_f32 v[56:59], v89, v73, v[56:59]
    v_mfma_f32_16x16x4_f32 v[60:63], v91, v75, v[60:63]
    v_mov_b64_dpp v[64:65], v[28:29] row_newbcast:15 row_mask:0xf bank_mask:0xf
    v_mov_b64_dpp v[66:67], v[30:31] row_newbcast:15 row_mask:0xf bank_mask:0xf
    v_pk_mul_f32 v[94:95], v[64:65], v[26:27] op_sel_hi:[1,0]
    v_pk_mul_f32 v[96:97], v[64:65], v[26:27] op_sel:[0,1] op_sel_hi:[1,1]
    v_fract_f32 v95, v95
    v_fract_f32 v97, v97
    v_exp_f32 v94, v94
    v_exp_f32 v96, v96
    v_cos_f32 v68, v95
    v_sin_f32 v69, v95
    v_cos_f32 v76, v97
    v_sin_f32 v77, v97
    v_pk_mul_f32 v[68:69], v[68:69], v[94:95] op_sel_hi:[1,0]
    v_pk_mul_f32 v[76:77], v[76:77], v[96:97] op_sel_hi:[1,0]
    v_pk_mul_f32 v[92:93], v[76:77], v[76:77] op_sel:[1,1] op_sel_hi:[0,1]
    v_pk_fma_f32 v[78:79], v[76:77], v[76:77], v[92:93] op_sel:[0,0,0] op_sel_hi:[0,1,1] neg_lo:[0,0,1]
    v_pk_mul_f32 v[94:95], v[68:69], v[68:69] op_sel:[1,1] op_sel_hi:[0,1]
    v_pk_fma_f32 v[70:71], v[68:69], v[68:69], v[94:95] op_sel:[0,0,0] op_sel_hi:[0,1,1] neg_lo:[0,0,1]
    v_pk_mul_f32 v[92:93], v[78:79], v[78:79] op_sel:[1,1] op_sel_hi:[0,1]
    v_pk_fma_f32 v[80:81], v[78:79], v[78:79], v[92:93] op_sel:[0,0,0] op_sel_hi:[0,1,1] neg_lo:[0,0,1]
    v_pk_mul_f32 v[94:95], v[70:71], v[70:71] op_sel:[1,1] op_sel_hi:[0,1]
    v_pk_fma_f32 v[72:73], v[70:71], v[70:71], v[94:95] op_sel:[0,0,0] op_sel_hi:[0,1,1] neg_lo:[0,0,1]
    v_pk_mul_f32 v[92:93], v[80:81], v[80:81] op_sel:[1,1] op_sel_hi:[0,1]
    v_pk_fma_f32 v[82:83], v[80:81], v[80:81], v[92:93] op_sel:[0,0,0] op_sel_hi:[0,1,1] neg_lo:[0,0,1]
    v_pk_mul_f32 v[94:95], v[72:73], v[72:73] op_sel:[1,1] op_sel_hi:[0,1]
    v_pk_fma_f32 v[74:75], v[72:73], v[72:73], v[94:95] op_sel:[0,0,0] op_sel_hi:[0,1,1] neg_lo:[0,0,1]
    v_pk_mul_f32 v[92:93], v[82:83], v[82:83] op_sel:[1,1] op_sel_hi:[0,1]
    v_pk_fma_f32 v[84:85], v[82:83], v[82:83], v[92:93] op_sel:[0,0,0] op_sel_hi:[0,1,1] neg_lo:[0,0,1]
    v_pk_mul_f32 v[94:95], v[66:67], v[76:77] op_sel:[1,1] op_sel_hi:[1,0]
    v_pk_fma_f32 v[86:87], v[66:67], v[76:77], v[94:95] op_sel:[0,0,0] op_sel_hi:[0,1,1] neg_lo:[0,0,1] neg_hi:[1,0,1]
    v_mov_b32_dpp v80, v78 row_ror:8 row_mask:0xf bank_mask:0x3
    v_mov_b32_dpp v81, v79 row_ror:8 row_mask:0xf bank_mask:0x3
    v_mov_b32_dpp v82, v84 row_ror:8 row_mask:0xf bank_mask:0x3
    v_mov_b32_dpp v83, v85 row_ror:8 row_mask:0xf bank_mask:0x3
    v_pk_mul_f32 v[92:93], v[66:67], v[80:81] op_sel:[1,1] op_sel_hi:[1,0]
    v_pk_fma_f32 v[88:89], v[66:67], v[80:81], v[92:93] op_sel:[0,0,0] op_sel_hi:[0,1,1] neg_lo:[0,0,1] neg_hi:[1,0,1]
    v_pk_mul_f32 v[94:95], v[66:67], v[82:83] op_sel:[1,1] op_sel_hi:[1,0]
    v_pk_fma_f32 v[90:91], v[66:67], v[82:83], v[94:95] op_sel:[0,0,0] op_sel_hi:[0,1,1] neg_lo:[0,0,1] neg_hi:[1,0,1]
    v_mfma_f32_16x16x4_f32 v[48:51], v86, v68, v[48:51]
    v_mfma_f32_16x16x4_f32 v[52:55], v88, v70, v[52:55]
    v_mfma_f32_16x16x4_f32 v[56:59], v88, v72, v[56:59]
    v_mfma_f32_16x16x4_f32 v[60:63], v90, v74, v[60:63]
    v_mfma_f32_16x16x4_f32 v[48:51], v87, v69, v[48:51]
    v_mfma_f32_16x16x4_f32 v[52:55], v89, v71, v[52:55]
    v_mfma_f32_16x16x4_f32 v[56:59], v89, v73, v[56:59]
    v_mfma_f32_16x16x4_f32 v[60:63], v91, v75, v[60:63]
    v_mov_b64 v[28:29], v[32:33]
    v_mov_b64 v[30:31], v[34:35]
    s_add_u32 s25, s25, 1
    s_cmp_lt_u32 s25, 2
    s_cbranch_scc1 ss_kg
    s_cmp_lg_u32 s28, 0
    s_cbranch_scc1 ss_nostage
    s_waitcnt vmcnt(0)
    v_mov_b32 v36, 0x05040100
    v_mov_b32 v37, 0x07060302
    v_lshlrev_b32 v6, 4, v0
    v_add_u32 v7, 65536, v6
    v_perm_b32 v40, v212, v208, v36
    v_perm_b32 v41, v220, v216, v36
    v_perm_b32 v42, v228, v224, v36
    v_perm_b32 v43, v236, v232, v36
    ds_write_b128 v6, v[40:43] offset:512
    v_perm_b32 v44, v212, v208, v37
    v_perm_b32 v45, v220, v216, v37
    v_perm_b32 v46, v228, v224, v37
    v_perm_b32 v47, v236, v232, v37
    ds_write_b128 v6, v[44:47] offset:16896
    v_perm_b32 v40, v213, v209, v36
    v_perm_b32 v41, v221, v217, v36
    v_perm_b32 v42, v229, v225, v36
    v_perm_b32 v43, v237, v233, v36
    ds_write_b128 v6, v[40:43] offset:33280
    v_perm_b32 v44, v213, v209, v37
    v_perm_b32 v45, v221, v217, v37
    v_perm_b32 v46, v229, v225, v37
    v_perm_b32 v47, v237, v233, v37
    ds_write_b128 v6, v[44:47] offset:49664
    v_perm_b32 v40, v214, v210, v36
    v_perm_b32 v41, v222, v218, v36
    v_perm_b32 v42, v230, v226, v36
    v_perm_b32 v43, v238, v234, v36
    ds_write_b128 v7, v[40:43] offset:512
    v_perm_b32 v44, v214, v210, v37
    v_perm_b32 v45, v222, v218, v37
    v_perm_b32 v46, v230, v226, v37
    v_perm_b32 v47, v238, v234, v37
    ds_write_b128 v7, v[44:47] offset:16896
    v_perm_b32 v40, v215, v211, v36
    v_perm_b32 v41, v223, v219, v36
    v_perm_b32 v42, v231, v227, v36
    v_perm_b32 v43, v239, v235, v36
    ds_write_b128 v7, v[40:43] offset:33280
    v_perm_b32 v44, v215, v211, v37
    v_perm_b32 v45, v223, v219, v37
    v_perm_b32 v46, v231, v227, v37
    v_perm_b32 v47, v239, v235, v37
    ds_write_b128 v7, v[44:47] offset:49664
ss_nostage:
    s_nop 11
    v_lshlrev_b32 v5, 8, v3
    v_lshl_add_u32 v5, v2, 2, v5
    v_add_u32 v5, v5, v4
    ds_write_b32 v5, v48 offset:4608
    ds_write_b32 v5, v49 offset:4672
    ds_write_b32 v5, v50 offset:4736
    ds_write_b32 v5, v51 offset:4800
    s_mov_b32 exec_hi, 0
    ds_write_b32 v5, v52 offset:5632
    ds_write_b32 v5, v53 offset:5696
    ds_write_b32 v5, v54 offset:5760
    ds_write_b32 v5, v55 offset:5824
    s_not_b64 exec, exec
    ds_write_b32 v5, v56 offset:5632
    ds_write_b32 v5, v57 offset:5696
    ds_write_b32 v5, v58 offset:5760
    ds_write_b32 v5, v59 offset:5824
    ds_write_b32 v5, v60 offset:6144
    ds_write_b32 v5, v61 offset:6208
    ds_write_b32 v5, v62 offset:6272
    ds_write_b32 v5, v63 offset:6336
    s_mov_b64 exec, 3
    v_cmp_eq_u32 vcc, 0, v2
    s_nop 1
    v_cndmask_b32 v6, 0, v60, vcc
    ds_write_b32 v5, v6 offset:7168
    s_mov_b64 exec, -1
    s_waitcnt lgkmcnt(0)
    v_lshlrev_b32 v7, 1, v1
    v_sub_u32 v7, 2065, v7
    v_lshl_add_u32 v64, v1, 2, v4
    v_mov_b32 v65, 641
    s_mov_b32 s25, 9
    s_mov_b32 s22, 256
    s_mov_b32 s23, 2048
ss_exp:
    v_subrev_u32 v66, 0, v7
    v_cvt_f32_u32 v72, v66
    v_cmp_gt_u32 vcc, s22, v66
    v_cvt_pk_bf16_f32 v72, v72, 0
    v_subrev_u32 v72, 0x4280, v72
    v_cndmask_b32 v72, v72, v66, vcc
    v_cmp_gt_u32 vcc, s23, v66
    s_nop 1
    v_cndmask_b32 v72, v65, v72, vcc
    v_lshl_add_u32 v72, v72, 2, v4
    v_subrev_u32 v67, 1, v7
    v_cvt_f32_u32 v73, v67
    v_cmp_gt_u32 vcc, s22, v67
    v_cvt_pk_bf16_f32 v73, v73, 0
    v_subrev_u32 v73, 0x4280, v73
    v_cndmask_b32 v73, v73, v67, vcc
    v_cmp_gt_u32 vcc, s23, v67
    ds_read_b32 v78, v72 offset:4608
    s_nop 0
    v_cndmask_b32 v73, v65, v73, vcc
    v_lshl_add_u32 v73, v73, 2, v4
    v_subrev_u32 v68, 2, v7
    v_cvt_f32_u32 v74, v68
    v_cmp_gt_u32 vcc, s22, v68
    v_cvt_pk_bf16_f32 v74, v74, 0
    v_subrev_u32 v74, 0x4280, v74
    v_cndmask_b32 v74, v74, v68, vcc
    v_cmp_gt_u32 vcc, s23, v68
    ds_read_b32 v79, v73 offset:4608
    s_nop 0
    v_cndmask_b32 v74, v65, v74, vcc
    v_lshl_add_u32 v74, v74, 2, v4
    v_subrev_u32 v69, 128, v7
    v_cvt_f32_u32 v75, v69
    v_cmp_gt_u32 vcc, s22, v69
    v_cvt_pk_bf16_f32 v75, v75, 0
    v_subrev_u32 v75, 0x4280, v75
    v_cndmask_b32 v75, v75, v69, vcc
    v_cmp_gt_u32 vcc, s23, v69
    ds_read_b32 v80, v74 offset:4608
    s_nop 0
    v_cndmask_b32 v75, v65, v75, vcc
    v_lshl_add_u32 v75, v75, 2, v4
    v_subrev_u32 v70, 129, v7
    v_cvt_f32_u32 v76, v70
    v_cmp_gt_u32 vcc, s22, v70
    v_cvt_pk_bf16_f32 v76, v76, 0
    v_subrev_u32 v76, 0x4280, v76
    v_cndmask_b32 v76, v76, v70, vcc
    v_cmp_gt_u32 vcc, s23, v70
    ds_read_b32 v81, v75 offset:4608
    s_nop 0
    v_cndmask_b32 v76, v65, v76, vcc
    v_lshl_add_u32 v76, v76, 2, v4
    v_subrev_u32 v71, 130, v7
    v_cvt_f32_u32 v77, v71
    v_cmp_gt_u32 vcc, s22, v71
    v_cvt_pk_bf16_f32 v77, v77, 0
    v_subrev_u32 v77, 0x4280, v77
    v_cndmask_b32 v77, v77, v71, vcc
    v_cmp_gt_u32 vcc, s23, v71
    ds_read_b32 v82, v76 offset:4608
    s_nop 0
    v_cndmask_b32 v77, v65, v77, vcc
    v_lshl_add_u32 v77, v77, 2, v4
    ds_read_b32 v83, v77 offset:4608
    v_subrev_u32 v7, 256, v7
    s_sub_u32 s25, s25, 1
    s_waitcnt lgkmcnt(0)
    v_cvt_pk_bf16_f32 v84, v79, v80
    v_cvt_pk_bf16_f32 v85, v78, v79
    v_cvt_pk_bf16_f32 v86, v82, v83
    v_cvt_pk_bf16_f32 v87, v81, v82
    ds_write_b32 v64, v84 offset:7424
    ds_write_b32 v64, v85 offset:11776
    s_cmp_eq_u32 s25, 0
    s_cbranch_scc1 ss_expx
    ds_write_b32 v64, v86 offset:7680
    ds_write_b32 v64, v87 offset:12032
    v_add_u32 v64, 512, v64
    s_nop 1
    s_branch ss_exp
ss_expx:
    s_waitcnt lgkmcnt(0)
    s_barrier
    v_and_b32 v5, 1, v2
    v_mul_u32_u24 v36, 4352, v5
    v_sub_u32 v5, v5, v2
    v_lshl_add_u32 v5, v3, 3, v5
    v_lshl_add_u32 v36, v5, 1, v36
    v_add_u32 v36, 11072, v36
    v_add_u32 v36, v36, v4
    v_subrev_u32 v37, 512, v36
    v_subrev_u32 v38, 1024, v36
    v_subrev_u32 v39, 1536, v36
    v_subrev_u32 v40, 2048, v36
    v_subrev_u32 v41, 2560, v36
    v_subrev_u32 v42, 3072, v36
    v_subrev_u32 v43, 3584, v36
    v_lshlrev_b32 v44, 5, v2
    v_lshl_add_u32 v44, v3, 4, v44
    v_add_u32 v44, 32, v44
    v_add_u32 v44, v44, v4
    ds_read_b128 v[112:115], v44 offset:448
    ds_read2_b32 v[80:81], v36 offset0:112 offset1:113
    ds_read2_b32 v[82:83], v36 offset0:114 offset1:115
    ds_read_b128 v[116:119], v44 offset:960
    ds_read2_b32 v[84:85], v37 offset0:112 offset1:113
    ds_read2_b32 v[86:87], v37 offset0:114 offset1:115
    ds_read_b128 v[120:123], v44 offset:1472
    ds_read2_b32 v[88:89], v38 offset0:112 offset1:113
    ds_read2_b32 v[90:91], v38 offset0:114 offset1:115
    ds_read_b128 v[124:127], v44 offset:1984
    ds_read2_b32 v[92:93], v39 offset0:112 offset1:113
    ds_read2_b32 v[94:95], v39 offset0:114 offset1:115
    ds_read_b128 v[128:131], v44 offset:2496
    ds_read2_b32 v[96:97], v40 offset0:112 offset1:113
    ds_read2_b32 v[98:99], v40 offset0:114 offset1:115
    ds_read_b128 v[132:135], v44 offset:3008
    ds_read2_b32 v[100:101], v41 offset0:112 offset1:113
    ds_read2_b32 v[102:103], v41 offset0:114 offset1:115
    ds_read_b128 v[136:139], v44 offset:3520
    ds_read2_b32 v[104:105], v42 offset0:112 offset1:113
    ds_read2_b32 v[106:107], v42 offset0:114 offset1:115
    ds_read_b128 v[140:143], v44 offset:4032
    ds_read2_b32 v[108:109], v43 offset0:112 offset1:113
    ds_read2_b32 v[110:111], v43 offset0:114 offset1:115
    s_waitcnt lgkmcnt(0)
    v_mfma_f32_16x16x32_bf16 v[48:51], v[80:83], v[112:115], 0
    ds_read_b128 v[176:179], v44 offset:384
    v_mfma_f32_16x16x32_bf16 v[52:55], v[80:83], v[116:119], 0
    ds_read2_b32 v[144:145], v36 offset0:96 offset1:97
    v_mfma_f32_16x16x32_bf16 v[56:59], v[80:83], v[120:123], 0
    ds_read2_b32 v[146:147], v36 offset0:98 offset1:99
    v_mfma_f32_16x16x32_bf16 v[60:63], v[80:83], v[124:127], 0
    ds_read_b128 v[180:183], v44 offset:896
    v_mfma_f32_16x16x32_bf16 v[64:67], v[80:83], v[128:131], 0
    ds_read2_b32 v[148:149], v37 offset0:96 offset1:97
    v_mfma_f32_16x16x32_bf16 v[68:71], v[80:83], v[132:135], 0
    ds_read2_b32 v[150:151], v37 offset0:98 offset1:99
    v_mfma_f32_16x16x32_bf16 v[72:75], v[80:83], v[136:139], 0
    ds_read_b128 v[184:187], v44 offset:1408
    v_mfma_f32_16x16x32_bf16 v[76:79], v[80:83], v[140:143], 0
    ds_read2_b32 v[152:153], v38 offset0:96 offset1:97
    v_mfma_f32_16x16x32_bf16 v[52:55], v[84:87], v[112:115], v[52:55]
    ds_read2_b32 v[154:155], v38 offset0:98 offset1:99
    v_mfma_f32_16x16x32_bf16 v[56:59], v[84:87], v[116:119], v[56:59]
    ds_read_b128 v[188:191], v44 offset:1920
    v_mfma_f32_16x16x32_bf16 v[60:63], v[84:87], v[120:123], v[60:63]
    ds_read2_b32 v[156:157], v39 offset0:96 offset1:97
    v_mfma_f32_16x16x32_bf16 v[64:67], v[84:87], v[124:127], v[64:67]
    ds_read2_b32 v[158:159], v39 offset0:98 offset1:99
    v_mfma_f32_16x16x32_bf16 v[68:71], v[84:87], v[128:131], v[68:71]
    ds_read_b128 v[192:195], v44 offset:2432
    v_mfma_f32_16x16x32_bf16 v[72:75], v[84:87], v[132:135], v[72:75]
    ds_read2_b32 v[160:161], v40 offset0:96 offset1:97
    v_mfma_f32_16x16x32_bf16 v[76:79], v[84:87], v[136:139], v[76:79]
    ds_read2_b32 v[162:163], v40 offset0:98 offset1:99
    v_mfma_f32_16x16x32_bf16 v[56:59], v[88:91], v[112:115], v[56:59]
    ds_read_b128 v[196:199], v44 offset:2944
    v_mfma_f32_16x16x32_bf16 v[60:63], v[88:91], v[116:119], v[60:63]
    ds_read2_b32 v[164:165], v41 offset0:96 offset1:97
    v_mfma_f32_16x16x32_bf16 v[64:67], v[88:91], v[120:123], v[64:67]
    ds_read2_b32 v[166:167], v41 offset0:98 offset1:99
    v_mfma_f32_16x16x32_bf16 v[68:71], v[88:91], v[124:127], v[68:71]
    ds_read_b128 v[200:203], v44 offset:3456
    v_mfma_f32_16x16x32_bf16 v[72:75], v[88:91], v[128:131], v[72:75]
    ds_read2_b32 v[168:169], v42 offset0:96 offset1:97
    v_mfma_f32_16x16x32_bf16 v[76:79], v[88:91], v[132:135], v[76:79]
    ds_read2_b32 v[170:171], v42 offset0:98 offset1:99
    v_mfma_f32_16x16x32_bf16 v[60:63], v[92:95], v[112:115], v[60:63]
    ds_read_b128 v[204:207], v44 offset:3968
    v_mfma_f32_16x16x32_bf16 v[64:67], v[92:95], v[116:119], v[64:67]
    ds_read2_b32 v[172:173], v43 offset0:96 offset1:97
    v_mfma_f32_16x16x32_bf16 v[68:71], v[92:95], v[120:123], v[68:71]
    ds_read2_b32 v[174:175], v43 offset0:98 offset1:99
    v_mfma_f32_16x16x32_bf16 v[72:75], v[92:95], v[124:127], v[72:75]
    v_mfma_f32_16x16x32_bf16 v[76:79], v[92:95], v[128:131], v[76:79]
    v_mfma_f32_16x16x32_bf16 v[64:67], v[96:99], v[112:115], v[64:67]
    v_mfma_f32_16x16x32_bf16 v[68:71], v[96:99], v[116:119], v[68:71]
    v_mfma_f32_16x16x32_bf16 v[72:75], v[96:99], v[120:123], v[72:75]
    v_mfma_f32_16x16x32_bf16 v[76:79], v[96:99], v[124:127], v[76:79]
    v_mfma_f32_16x16x32_bf16 v[68:71], v[100:103], v[112:115], v[68:71]
    v_mfma_f32_16x16x32_bf16 v[72:75], v[100:103], v[116:119], v[72:75]
    v_mfma_f32_16x16x32_bf16 v[76:79], v[100:103], v[120:123], v[76:79]
    v_mfma_f32_16x16x32_bf16 v[72:75], v[104:107], v[112:115], v[72:75]
    v_mfma_f32_16x16x32_bf16 v[76:79], v[104:107], v[116:119], v[76:79]
    v_mfma_f32_16x16x32_bf16 v[76:79], v[108:111], v[112:115], v[76:79]
    s_waitcnt lgkmcnt(0)
    v_mfma_f32_16x16x32_bf16 v[48:51], v[144:147], v[176:179], v[48:51]
    ds_read_b128 v[112:115], v44 offset:320
    v_mfma_f32_16x16x32_bf16 v[52:55], v[144:147], v[180:183], v[52:55]
    ds_read2_b32 v[80:81], v36 offset0:80 offset1:81
    v_mfma_f32_16x16x32_bf16 v[56:59], v[144:147], v[184:187], v[56:59]
    ds_read2_b32 v[82:83], v36 offset0:82 offset1:83
    v_mfma_f32_16x16x32_bf16 v[60:63], v[144:147], v[188:191], v[60:63]
    ds_read_b128 v[116:119], v44 offset:832
    v_mfma_f32_16x16x32_bf16 v[64:67], v[144:147], v[192:195], v[64:67]
    ds_read2_b32 v[84:85], v37 offset0:80 offset1:81
    v_mfma_f32_16x16x32_bf16 v[68:71], v[144:147], v[196:199], v[68:71]
    ds_read2_b32 v[86:87], v37 offset0:82 offset1:83
    v_mfma_f32_16x16x32_bf16 v[72:75], v[144:147], v[200:203], v[72:75]
    ds_read_b128 v[120:123], v44 offset:1344
    v_mfma_f32_16x16x32_bf16 v[76:79], v[144:147], v[204:207], v[76:79]
    ds_read2_b32 v[88:89], v38 offset0:80 offset1:81
    v_mfma_f32_16x16x32_bf16 v[52:55], v[148:151], v[176:179], v[52:55]
    ds_read2_b32 v[90:91], v38 offset0:82 offset1:83
    v_mfma_f32_16x16x32_bf16 v[56:59], v[148:151], v[180:183], v[56:59]
    ds_read_b128 v[124:127], v44 offset:1856
    v_mfma_f32_16x16x32_bf16 v[60:63], v[148:151], v[184:187], v[60:63]
    ds_read2_b32 v[92:93], v39 offset0:80 offset1:81
    v_mfma_f32_16x16x32_bf16 v[64:67], v[148:151], v[188:191], v[64:67]
    ds_read2_b32 v[94:95], v39 offset0:82 offset1:83
    v_mfma_f32_16x16x32_bf16 v[68:71], v[148:151], v[192:195], v[68:71]
    ds_read_b128 v[128:131], v44 offset:2368
    v_mfma_f32_16x16x32_bf16 v[72:75], v[148:151], v[196:199], v[72:75]
    ds_read2_b32 v[96:97], v40 offset0:80 offset1:81
    v_mfma_f32_16x16x32_bf16 v[76:79], v[148:151], v[200:203], v[76:79]
    ds_read2_b32 v[98:99], v40 offset0:82 offset1:83
    v_mfma_f32_16x16x32_bf16 v[56:59], v[152:155], v[176:179], v[56:59]
    ds_read_b128 v[132:135], v44 offset:2880
    v_mfma_f32_16x16x32_bf16 v[60:63], v[152:155], v[180:183], v[60:63]
    ds_read2_b32 v[100:101], v41 offset0:80 offset1:81
    v_mfma_f32_16x16x32_bf16 v[64:67], v[152:155], v[184:187], v[64:67]
    ds_read2_b32 v[102:103], v41 offset0:82 offset1:83
    v_mfma_f32_16x16x32_bf16 v[68:71], v[152:155], v[188:191], v[68:71]
    ds_read_b128 v[136:139], v44 offset:3392
    v_mfma_f32_16x16x32_bf16 v[72:75], v[152:155], v[192:195], v[72:75]
    ds_read2_b32 v[104:105], v42 offset0:80 offset1:81
    v_mfma_f32_16x16x32_bf16 v[76:79], v[152:155], v[196:199], v[76:79]
    ds_read2_b32 v[106:107], v42 offset0:82 offset1:83
    v_mfma_f32_16x16x32_bf16 v[60:63], v[156:159], v[176:179], v[60:63]
    ds_read_b128 v[140:143], v44 offset:3904
    v_mfma_f32_16x16x32_bf16 v[64:67], v[156:159], v[180:183], v[64:67]
    ds_read2_b32 v[108:109], v43 offset0:80 offset1:81
    v_mfma_f32_16x16x32_bf16 v[68:71], v[156:159], v[184:187], v[68:71]
    ds_read2_b32 v[110:111], v43 offset0:82 offset1:83
    v_mfma_f32_16x16x32_bf16 v[72:75], v[156:159], v[188:191], v[72:75]
    v_mfma_f32_16x16x32_bf16 v[76:79], v[156:159], v[192:195], v[76:79]
    v_mfma_f32_16x16x32_bf16 v[64:67], v[160:163], v[176:179], v[64:67]
    v_mfma_f32_16x16x32_bf16 v[68:71], v[160:163], v[180:183], v[68:71]
    v_mfma_f32_16x16x32_bf16 v[72:75], v[160:163], v[184:187], v[72:75]
    v_mfma_f32_16x16x32_bf16 v[76:79], v[160:163], v[188:191], v[76:79]
    v_mfma_f32_16x16x32_bf16 v[68:71], v[164:167], v[176:179], v[68:71]
    v_mfma_f32_16x16x32_bf16 v[72:75], v[164:167], v[180:183], v[72:75]
    v_mfma_f32_16x16x32_bf16 v[76:79], v[164:167], v[184:187], v[76:79]
    v_mfma_f32_16x16x32_bf16 v[72:75], v[168:171], v[176:179], v[72:75]
    v_mfma_f32_16x16x32_bf16 v[76:79], v[168:171], v[180:183], v[76:79]
    v_mfma_f32_16x16x32_bf16 v[76:79], v[172:175], v[176:179], v[76:79]
    s_waitcnt lgkmcnt(0)
    v_mfma_f32_16x16x32_bf16 v[48:51], v[80:83], v[112:115], v[48:51]
    ds_read_b128 v[176:179], v44 offset:256
    v_mfma_f32_16x16x32_bf16 v[52:55], v[80:83], v[116:119], v[52:55]
    ds_read2_b32 v[144:145], v36 offset0:64 offset1:65
    v_mfma_f32_16x16x32_bf16 v[56:59], v[80:83], v[120:123], v[56:59]
    ds_read2_b32 v[146:147], v36 offset0:66 offset1:67
    v_mfma_f32_16x16x32_bf16 v[60:63], v[80:83], v[124:127], v[60:63]
    ds_read_b128 v[180:183], v44 offset:768
    v_mfma_f32_16x16x32_bf16 v[64:67], v[80:83], v[128:131], v[64:67]
    ds_read2_b32 v[148:149], v37 offset0:64 offset1:65
    v_mfma_f32_16x16x32_bf16 v[68:71], v[80:83], v[132:135], v[68:71]
    ds_read2_b32 v[150:151], v37 offset0:66 offset1:67
    v_mfma_f32_16x16x32_bf16 v[72:75], v[80:83], v[136:139], v[72:75]
    ds_read_b128 v[184:187], v44 offset:1280
    v_mfma_f32_16x16x32_bf16 v[76:79], v[80:83], v[140:143], v[76:79]
    ds_read2_b32 v[152:153], v38 offset0:64 offset1:65
    v_mfma_f32_16x16x32_bf16 v[52:55], v[84:87], v[112:115], v[52:55]
    ds_read2_b32 v[154:155], v38 offset0:66 offset1:67
    v_mfma_f32_16x16x32_bf16 v[56:59], v[84:87], v[116:119], v[56:59]
    ds_read_b128 v[188:191], v44 offset:1792
    v_mfma_f32_16x16x32_bf16 v[60:63], v[84:87], v[120:123], v[60:63]
    ds_read2_b32 v[156:157], v39 offset0:64 offset1:65
    v_mfma_f32_16x16x32_bf16 v[64:67], v[84:87], v[124:127], v[64:67]
    ds_read2_b32 v[158:159], v39 offset0:66 offset1:67
    v_mfma_f32_16x16x32_bf16 v[68:71], v[84:87], v[128:131], v[68:71]
    ds_read_b128 v[192:195], v44 offset:2304
    v_mfma_f32_16x16x32_bf16 v[72:75], v[84:87], v[132:135], v[72:75]
    ds_read2_b32 v[160:161], v40 offset0:64 offset1:65
    v_mfma_f32_16x16x32_bf16 v[76:79], v[84:87], v[136:139], v[76:79]
    ds_read2_b32 v[162:163], v40 offset0:66 offset1:67
    v_mfma_f32_16x16x32_bf16 v[56:59], v[88:91], v[112:115], v[56:59]
    ds_read_b128 v[196:199], v44 offset:2816
    v_mfma_f32_16x16x32_bf16 v[60:63], v[88:91], v[116:119], v[60:63]
    ds_read2_b32 v[164:165], v41 offset0:64 offset1:65
    v_mfma_f32_16x16x32_bf16 v[64:67], v[88:91], v[120:123], v[64:67]
    ds_read2_b32 v[166:167], v41 offset0:66 offset1:67
    v_mfma_f32_16x16x32_bf16 v[68:71], v[88:91], v[124:127], v[68:71]
    ds_read_b128 v[200:203], v44 offset:3328
    v_mfma_f32_16x16x32_bf16 v[72:75], v[88:91], v[128:131], v[72:75]
    ds_read2_b32 v[168:169], v42 offset0:64 offset1:65
    v_mfma_f32_16x16x32_bf16 v[76:79], v[88:91], v[132:135], v[76:79]
    ds_read2_b32 v[170:171], v42 offset0:66 offset1:67
    v_mfma_f32_16x16x32_bf16 v[60:63], v[92:95], v[112:115], v[60:63]
    ds_read_b128 v[204:207], v44 offset:3840
    v_mfma_f32_16x16x32_bf16 v[64:67], v[92:95], v[116:119], v[64:67]
    ds_read2_b32 v[172:173], v43 offset0:64 offset1:65
    v_mfma_f32_16x16x32_bf16 v[68:71], v[92:95], v[120:123], v[68:71]
    ds_read2_b32 v[174:175], v43 offset0:66 offset1:67
    v_mfma_f32_16x16x32_bf16 v[72:75], v[92:95], v[124:127], v[72:75]
    v_mfma_f32_16x16x32_bf16 v[76:79], v[92:95], v[128:131], v[76:79]
    v_mfma_f32_16x16x32_bf16 v[64:67], v[96:99], v[112:115], v[64:67]
    v_mfma_f32_16x16x32_bf16 v[68:71], v[96:99], v[116:119], v[68:71]
    v_mfma_f32_16x16x32_bf16 v[72:75], v[96:99], v[120:123], v[72:75]
    v_mfma_f32_16x16x32_bf16 v[76:79], v[96:99], v[124:127], v[76:79]
    v_mfma_f32_16x16x32_bf16 v[68:71], v[100:103], v[112:115], v[68:71]
    v_mfma_f32_16x16x32_bf16 v[72:75], v[100:103], v[116:119], v[72:75]
    v_mfma_f32_16x16x32_bf16 v[76:79], v[100:103], v[120:123], v[76:79]
    v_mfma_f32_16x16x32_bf16 v[72:75], v[104:107], v[112:115], v[72:75]
    v_mfma_f32_16x16x32_bf16 v[76:79], v[104:107], v[116:119], v[76:79]
    v_mfma_f32_16x16x32_bf16 v[76:79], v[108:111], v[112:115], v[76:79]
    s_waitcnt lgkmcnt(0)
    v_mfma_f32_16x16x32_bf16 v[48:51], v[144:147], v[176:179], v[48:51]
    ds_read_b128 v[112:115], v44 offset:192
    v_mfma_f32_16x16x32_bf16 v[52:55], v[144:147], v[180:183], v[52:55]
    ds_read2_b32 v[80:81], v36 offset0:48 offset1:49
    v_mfma_f32_16x16x32_bf16 v[56:59], v[144:147], v[184:187], v[56:59]
    ds_read2_b32 v[82:83], v36 offset0:50 offset1:51
    v_mfma_f32_16x16x32_bf16 v[60:63], v[144:147], v[188:191], v[60:63]
    ds_read_b128 v[116:119], v44 offset:704
    v_mfma_f32_16x16x32_bf16 v[64:67], v[144:147], v[192:195], v[64:67]
    ds_read2_b32 v[84:85], v37 offset0:48 offset1:49
    v_mfma_f32_16x16x32_bf16 v[68:71], v[144:147], v[196:199], v[68:71]
    ds_read2_b32 v[86:87], v37 offset0:50 offset1:51
    v_mfma_f32_16x16x32_bf16 v[72:75], v[144:147], v[200:203], v[72:75]
    ds_read_b128 v[120:123], v44 offset:1216
    v_mfma_f32_16x16x32_bf16 v[76:79], v[144:147], v[204:207], v[76:79]
    ds_read2_b32 v[88:89], v38 offset0:48 offset1:49
    v_mfma_f32_16x16x32_bf16 v[52:55], v[148:151], v[176:179], v[52:55]
    ds_read2_b32 v[90:91], v38 offset0:50 offset1:51
    v_mfma_f32_16x16x32_bf16 v[56:59], v[148:151], v[180:183], v[56:59]
    ds_read_b128 v[124:127], v44 offset:1728
    v_mfma_f32_16x16x32_bf16 v[60:63], v[148:151], v[184:187], v[60:63]
    ds_read2_b32 v[92:93], v39 offset0:48 offset1:49
    v_mfma_f32_16x16x32_bf16 v[64:67], v[148:151], v[188:191], v[64:67]
    ds_read2_b32 v[94:95], v39 offset0:50 offset1:51
    v_mfma_f32_16x16x32_bf16 v[68:71], v[148:151], v[192:195], v[68:71]
    ds_read_b128 v[128:131], v44 offset:2240
    v_mfma_f32_16x16x32_bf16 v[72:75], v[148:151], v[196:199], v[72:75]
    ds_read2_b32 v[96:97], v40 offset0:48 offset1:49
    v_mfma_f32_16x16x32_bf16 v[76:79], v[148:151], v[200:203], v[76:79]
    ds_read2_b32 v[98:99], v40 offset0:50 offset1:51
    v_mfma_f32_16x16x32_bf16 v[56:59], v[152:155], v[176:179], v[56:59]
    ds_read_b128 v[132:135], v44 offset:2752
    v_mfma_f32_16x16x32_bf16 v[60:63], v[152:155], v[180:183], v[60:63]
    ds_read2_b32 v[100:101], v41 offset0:48 offset1:49
    v_mfma_f32_16x16x32_bf16 v[64:67], v[152:155], v[184:187], v[64:67]
    ds_read2_b32 v[102:103], v41 offset0:50 offset1:51
    v_mfma_f32_16x16x32_bf16 v[68:71], v[152:155], v[188:191], v[68:71]
    ds_read_b128 v[136:139], v44 offset:3264
    v_mfma_f32_16x16x32_bf16 v[72:75], v[152:155], v[192:195], v[72:75]
    ds_read2_b32 v[104:105], v42 offset0:48 offset1:49
    v_mfma_f32_16x16x32_bf16 v[76:79], v[152:155], v[196:199], v[76:79]
    ds_read2_b32 v[106:107], v42 offset0:50 offset1:51
    v_mfma_f32_16x16x32_bf16 v[60:63], v[156:159], v[176:179], v[60:63]
    ds_read_b128 v[140:143], v44 offset:3776
    v_mfma_f32_16x16x32_bf16 v[64:67], v[156:159], v[180:183], v[64:67]
    ds_read2_b32 v[108:109], v43 offset0:48 offset1:49
    v_mfma_f32_16x16x32_bf16 v[68:71], v[156:159], v[184:187], v[68:71]
    ds_read2_b32 v[110:111], v43 offset0:50 offset1:51
    v_mfma_f32_16x16x32_bf16 v[72:75], v[156:159], v[188:191], v[72:75]
    v_mfma_f32_16x16x32_bf16 v[76:79], v[156:159], v[192:195], v[76:79]
    v_mfma_f32_16x16x32_bf16 v[64:67], v[160:163], v[176:179], v[64:67]
    v_mfma_f32_16x16x32_bf16 v[68:71], v[160:163], v[180:183], v[68:71]
    v_mfma_f32_16x16x32_bf16 v[72:75], v[160:163], v[184:187], v[72:75]
    v_mfma_f32_16x16x32_bf16 v[76:79], v[160:163], v[188:191], v[76:79]
    v_mfma_f32_16x16x32_bf16 v[68:71], v[164:167], v[176:179], v[68:71]
    v_mfma_f32_16x16x32_bf16 v[72:75], v[164:167], v[180:183], v[72:75]
    v_mfma_f32_16x16x32_bf16 v[76:79], v[164:167], v[184:187], v[76:79]
    v_mfma_f32_16x16x32_bf16 v[72:75], v[168:171], v[176:179], v[72:75]
    v_mfma_f32_16x16x32_bf16 v[76:79], v[168:171], v[180:183], v[76:79]
    v_mfma_f32_16x16x32_bf16 v[76:79], v[172:175], v[176:179], v[76:79]
    s_waitcnt lgkmcnt(0)
    v_mfma_f32_16x16x32_bf16 v[48:51], v[80:83], v[112:115], v[48:51]
    ds_read_b128 v[176:179], v44 offset:128
    v_mfma_f32_16x16x32_bf16 v[52:55], v[80:83], v[116:119], v[52:55]
    ds_read2_b32 v[144:145], v36 offset0:32 offset1:33
    v_mfma_f32_16x16x32_bf16 v[56:59], v[80:83], v[120:123], v[56:59]
    ds_read2_b32 v[146:147], v36 offset0:34 offset1:35
    v_mfma_f32_16x16x32_bf16 v[60:63], v[80:83], v[124:127], v[60:63]
    ds_read_b128 v[180:183], v44 offset:640
    v_mfma_f32_16x16x32_bf16 v[64:67], v[80:83], v[128:131], v[64:67]
    ds_read2_b32 v[148:149], v37 offset0:32 offset1:33
    v_mfma_f32_16x16x32_bf16 v[68:71], v[80:83], v[132:135], v[68:71]
    ds_read2_b32 v[150:151], v37 offset0:34 offset1:35
    v_mfma_f32_16x16x32_bf16 v[72:75], v[80:83], v[136:139], v[72:75]
    ds_read_b128 v[184:187], v44 offset:1152
    v_mfma_f32_16x16x32_bf16 v[76:79], v[80:83], v[140:143], v[76:79]
    ds_read2_b32 v[152:153], v38 offset0:32 offset1:33
    v_mfma_f32_16x16x32_bf16 v[52:55], v[84:87], v[112:115], v[52:55]
    ds_read2_b32 v[154:155], v38 offset0:34 offset1:35
    v_mfma_f32_16x16x32_bf16 v[56:59], v[84:87], v[116:119], v[56:59]
    ds_read_b128 v[188:191], v44 offset:1664
    v_mfma_f32_16x16x32_bf16 v[60:63], v[84:87], v[120:123], v[60:63]
    ds_read2_b32 v[156:157], v39 offset0:32 offset1:33
    v_mfma_f32_16x16x32_bf16 v[64:67], v[84:87], v[124:127], v[64:67]
    ds_read2_b32 v[158:159], v39 offset0:34 offset1:35
    v_mfma_f32_16x16x32_bf16 v[68:71], v[84:87], v[128:131], v[68:71]
    ds_read_b128 v[192:195], v44 offset:2176
    v_mfma_f32_16x16x32_bf16 v[72:75], v[84:87], v[132:135], v[72:75]
    ds_read2_b32 v[160:161], v40 offset0:32 offset1:33
    v_mfma_f32_16x16x32_bf16 v[76:79], v[84:87], v[136:139], v[76:79]
    ds_read2_b32 v[162:163], v40 offset0:34 offset1:35
    v_mfma_f32_16x16x32_bf16 v[56:59], v[88:91], v[112:115], v[56:59]
    ds_read_b128 v[196:199], v44 offset:2688
    v_mfma_f32_16x16x32_bf16 v[60:63], v[88:91], v[116:119], v[60:63]
    ds_read2_b32 v[164:165], v41 offset0:32 offset1:33
    v_mfma_f32_16x16x32_bf16 v[64:67], v[88:91], v[120:123], v[64:67]
    ds_read2_b32 v[166:167], v41 offset0:34 offset1:35
    v_mfma_f32_16x16x32_bf16 v[68:71], v[88:91], v[124:127], v[68:71]
    ds_read_b128 v[200:203], v44 offset:3200
    v_mfma_f32_16x16x32_bf16 v[72:75], v[88:91], v[128:131], v[72:75]
    ds_read2_b32 v[168:169], v42 offset0:32 offset1:33
    v_mfma_f32_16x16x32_bf16 v[76:79], v[88:91], v[132:135], v[76:79]
    ds_read2_b32 v[170:171], v42 offset0:34 offset1:35
    v_mfma_f32_16x16x32_bf16 v[60:63], v[92:95], v[112:115], v[60:63]
    ds_read_b128 v[204:207], v44 offset:3712
    v_mfma_f32_16x16x32_bf16 v[64:67], v[92:95], v[116:119], v[64:67]
    ds_read2_b32 v[172:173], v43 offset0:32 offset1:33
    v_mfma_f32_16x16x32_bf16 v[68:71], v[92:95], v[120:123], v[68:71]
    ds_read2_b32 v[174:175], v43 offset0:34 offset1:35
    v_mfma_f32_16x16x32_bf16 v[72:75], v[92:95], v[124:127], v[72:75]
    v_mfma_f32_16x16x32_bf16 v[76:79], v[92:95], v[128:131], v[76:79]
    v_mfma_f32_16x16x32_bf16 v[64:67], v[96:99], v[112:115], v[64:67]
    v_mfma_f32_16x16x32_bf16 v[68:71], v[96:99], v[116:119], v[68:71]
    v_mfma_f32_16x16x32_bf16 v[72:75], v[96:99], v[120:123], v[72:75]
    v_mfma_f32_16x16x32_bf16 v[76:79], v[96:99], v[124:127], v[76:79]
    v_mfma_f32_16x16x32_bf16 v[68:71], v[100:103], v[112:115], v[68:71]
    v_mfma_f32_16x16x32_bf16 v[72:75], v[100:103], v[116:119], v[72:75]
    v_mfma_f32_16x16x32_bf16 v[76:79], v[100:103], v[120:123], v[76:79]
    v_mfma_f32_16x16x32_bf16 v[72:75], v[104:107], v[112:115], v[72:75]
    v_mfma_f32_16x16x32_bf16 v[76:79], v[104:107], v[116:119], v[76:79]
    v_mfma_f32_16x16x32_bf16 v[76:79], v[108:111], v[112:115], v[76:79]
    s_waitcnt lgkmcnt(0)
    v_mfma_f32_16x16x32_bf16 v[48:51], v[144:147], v[176:179], v[48:51]
    ds_read_b128 v[112:115], v44 offset:64
    v_mfma_f32_16x16x32_bf16 v[52:55], v[144:147], v[180:183], v[52:55]
    ds_read2_b32 v[80:81], v36 offset0:16 offset1:17
    v_mfma_f32_16x16x32_bf16 v[56:59], v[144:147], v[184:187], v[56:59]
    ds_read2_b32 v[82:83], v36 offset0:18 offset1:19
    v_mfma_f32_16x16x32_bf16 v[60:63], v[144:147], v[188:191], v[60:63]
    ds_read_b128 v[116:119], v44 offset:576
    v_mfma_f32_16x16x32_bf16 v[64:67], v[144:147], v[192:195], v[64:67]
    ds_read2_b32 v[84:85], v37 offset0:16 offset1:17
    v_mfma_f32_16x16x32_bf16 v[68:71], v[144:147], v[196:199], v[68:71]
    ds_read2_b32 v[86:87], v37 offset0:18 offset1:19
    v_mfma_f32_16x16x32_bf16 v[72:75], v[144:147], v[200:203], v[72:75]
    ds_read_b128 v[120:123], v44 offset:1088
    v_mfma_f32_16x16x32_bf16 v[76:79], v[144:147], v[204:207], v[76:79]
    ds_read2_b32 v[88:89], v38 offset0:16 offset1:17
    v_mfma_f32_16x16x32_bf16 v[52:55], v[148:151], v[176:179], v[52:55]
    ds_read2_b32 v[90:91], v38 offset0:18 offset1:19
    v_mfma_f32_16x16x32_bf16 v[56:59], v[148:151], v[180:183], v[56:59]
    ds_read_b128 v[124:127], v44 offset:1600
    v_mfma_f32_16x16x32_bf16 v[60:63], v[148:151], v[184:187], v[60:63]
    ds_read2_b32 v[92:93], v39 offset0:16 offset1:17
    v_mfma_f32_16x16x32_bf16 v[64:67], v[148:151], v[188:191], v[64:67]
    ds_read2_b32 v[94:95], v39 offset0:18 offset1:19
    v_mfma_f32_16x16x32_bf16 v[68:71], v[148:151], v[192:195], v[68:71]
    ds_read_b128 v[128:131], v44 offset:2112
    v_mfma_f32_16x16x32_bf16 v[72:75], v[148:151], v[196:199], v[72:75]
    ds_read2_b32 v[96:97], v40 offset0:16 offset1:17
    v_mfma_f32_16x16x32_bf16 v[76:79], v[148:151], v[200:203], v[76:79]
    ds_read2_b32 v[98:99], v40 offset0:18 offset1:19
    v_mfma_f32_16x16x32_bf16 v[56:59], v[152:155], v[176:179], v[56:59]
    ds_read_b128 v[132:135], v44 offset:2624
    v_mfma_f32_16x16x32_bf16 v[60:63], v[152:155], v[180:183], v[60:63]
    ds_read2_b32 v[100:101], v41 offset0:16 offset1:17
    v_mfma_f32_16x16x32_bf16 v[64:67], v[152:155], v[184:187], v[64:67]
    ds_read2_b32 v[102:103], v41 offset0:18 offset1:19
    v_mfma_f32_16x16x32_bf16 v[68:71], v[152:155], v[188:191], v[68:71]
    ds_read_b128 v[136:139], v44 offset:3136
    v_mfma_f32_16x16x32_bf16 v[72:75], v[152:155], v[192:195], v[72:75]
    ds_read2_b32 v[104:105], v42 offset0:16 offset1:17
    v_mfma_f32_16x16x32_bf16 v[76:79], v[152:155], v[196:199], v[76:79]
    ds_read2_b32 v[106:107], v42 offset0:18 offset1:19
    v_mfma_f32_16x16x32_bf16 v[60:63], v[156:159], v[176:179], v[60:63]
    ds_read_b128 v[140:143], v44 offset:3648
    v_mfma_f32_16x16x32_bf16 v[64:67], v[156:159], v[180:183], v[64:67]
    ds_read2_b32 v[108:109], v43 offset0:16 offset1:17
    v_mfma_f32_16x16x32_bf16 v[68:71], v[156:159], v[184:187], v[68:71]
    ds_read2_b32 v[110:111], v43 offset0:18 offset1:19
    v_mfma_f32_16x16x32_bf16 v[72:75], v[156:159], v[188:191], v[72:75]
    v_mfma_f32_16x16x32_bf16 v[76:79], v[156:159], v[192:195], v[76:79]
    v_mfma_f32_16x16x32_bf16 v[64:67], v[160:163], v[176:179], v[64:67]
    v_mfma_f32_16x16x32_bf16 v[68:71], v[160:163], v[180:183], v[68:71]
    v_mfma_f32_16x16x32_bf16 v[72:75], v[160:163], v[184:187], v[72:75]
    v_mfma_f32_16x16x32_bf16 v[76:79], v[160:163], v[188:191], v[76:79]
    v_mfma_f32_16x16x32_bf16 v[68:71], v[164:167], v[176:179], v[68:71]
    v_mfma_f32_16x16x32_bf16 v[72:75], v[164:167], v[180:183], v[72:75]
    v_mfma_f32_16x16x32_bf16 v[76:79], v[164:167], v[184:187], v[76:79]
    v_mfma_f32_16x16x32_bf16 v[72:75], v[168:171], v[176:179], v[72:75]
    v_mfma_f32_16x16x32_bf16 v[76:79], v[168:171], v[180:183], v[76:79]
    v_mfma_f32_16x16x32_bf16 v[76:79], v[172:175], v[176:179], v[76:79]
    s_waitcnt lgkmcnt(0)
    v_mfma_f32_16x16x32_bf16 v[48:51], v[80:83], v[112:115], v[48:51]
    ds_read_b128 v[176:179], v44 offset:0
    v_mfma_f32_16x16x32_bf16 v[52:55], v[80:83], v[116:119], v[52:55]
    ds_read2_b32 v[144:145], v36 offset0:0 offset1:1
    v_mfma_f32_16x16x32_bf16 v[56:59], v[80:83], v[120:123], v[56:59]
    ds_read2_b32 v[146:147], v36 offset0:2 offset1:3
    v_mfma_f32_16x16x32_bf16 v[60:63], v[80:83], v[124:127], v[60:63]
    ds_read_b128 v[180:183], v44 offset:512
    v_mfma_f32_16x16x32_bf16 v[64:67], v[80:83], v[128:131], v[64:67]
    ds_read2_b32 v[148:149], v37 offset0:0 offset1:1
    v_mfma_f32_16x16x32_bf16 v[68:71], v[80:83], v[132:135], v[68:71]
    ds_read2_b32 v[150:151], v37 offset0:2 offset1:3
    v_mfma_f32_16x16x32_bf16 v[72:75], v[80:83], v[136:139], v[72:75]
    ds_read_b128 v[184:187], v44 offset:1024
    v_mfma_f32_16x16x32_bf16 v[76:79], v[80:83], v[140:143], v[76:79]
    ds_read2_b32 v[152:153], v38 offset0:0 offset1:1
    v_mfma_f32_16x16x32_bf16 v[52:55], v[84:87], v[112:115], v[52:55]
    ds_read2_b32 v[154:155], v38 offset0:2 offset1:3
    v_mfma_f32_16x16x32_bf16 v[56:59], v[84:87], v[116:119], v[56:59]
    ds_read_b128 v[188:191], v44 offset:1536
    v_mfma_f32_16x16x32_bf16 v[60:63], v[84:87], v[120:123], v[60:63]
    ds_read2_b32 v[156:157], v39 offset0:0 offset1:1
    v_mfma_f32_16x16x32_bf16 v[64:67], v[84:87], v[124:127], v[64:67]
    ds_read2_b32 v[158:159], v39 offset0:2 offset1:3
    v_mfma_f32_16x16x32_bf16 v[68:71], v[84:87], v[128:131], v[68:71]
    ds_read_b128 v[192:195], v44 offset:2048
    v_mfma_f32_16x16x32_bf16 v[72:75], v[84:87], v[132:135], v[72:75]
    ds_read2_b32 v[160:161], v40 offset0:0 offset1:1
    v_mfma_f32_16x16x32_bf16 v[76:79], v[84:87], v[136:139], v[76:79]
    ds_read2_b32 v[162:163], v40 offset0:2 offset1:3
    v_mfma_f32_16x16x32_bf16 v[56:59], v[88:91], v[112:115], v[56:59]
    ds_read_b128 v[196:199], v44 offset:2560
    v_mfma_f32_16x16x32_bf16 v[60:63], v[88:91], v[116:119], v[60:63]
    ds_read2_b32 v[164:165], v41 offset0:0 offset1:1
    v_mfma_f32_16x16x32_bf16 v[64:67], v[88:91], v[120:123], v[64:67]
    ds_read2_b32 v[166:167], v41 offset0:2 offset1:3
    v_mfma_f32_16x16x32_bf16 v[68:71], v[88:91], v[124:127], v[68:71]
    ds_read_b128 v[200:203], v44 offset:3072
    v_mfma_f32_16x16x32_bf16 v[72:75], v[88:91], v[128:131], v[72:75]
    ds_read2_b32 v[168:169], v42 offset0:0 offset1:1
    v_mfma_f32_16x16x32_bf16 v[76:79], v[88:91], v[132:135], v[76:79]
    ds_read2_b32 v[170:171], v42 offset0:2 offset1:3
    v_mfma_f32_16x16x32_bf16 v[60:63], v[92:95], v[112:115], v[60:63]
    ds_read_b128 v[204:207], v44 offset:3584
    v_mfma_f32_16x16x32_bf16 v[64:67], v[92:95], v[116:119], v[64:67]
    ds_read2_b32 v[172:173], v43 offset0:0 offset1:1
    v_mfma_f32_16x16x32_bf16 v[68:71], v[92:95], v[120:123], v[68:71]
    ds_read2_b32 v[174:175], v43 offset0:2 offset1:3
    v_mfma_f32_16x16x32_bf16 v[72:75], v[92:95], v[124:127], v[72:75]
    v_mfma_f32_16x16x32_bf16 v[76:79], v[92:95], v[128:131], v[76:79]
    v_mfma_f32_16x16x32_bf16 v[64:67], v[96:99], v[112:115], v[64:67]
    v_mfma_f32_16x16x32_bf16 v[68:71], v[96:99], v[116:119], v[68:71]
    v_mfma_f32_16x16x32_bf16 v[72:75], v[96:99], v[120:123], v[72:75]
    v_mfma_f32_16x16x32_bf16 v[76:79], v[96:99], v[124:127], v[76:79]
    v_mfma_f32_16x16x32_bf16 v[68:71], v[100:103], v[112:115], v[68:71]
    v_mfma_f32_16x16x32_bf16 v[72:75], v[100:103], v[116:119], v[72:75]
    v_mfma_f32_16x16x32_bf16 v[76:79], v[100:103], v[120:123], v[76:79]
    v_mfma_f32_16x16x32_bf16 v[72:75], v[104:107], v[112:115], v[72:75]
    v_mfma_f32_16x16x32_bf16 v[76:79], v[104:107], v[116:119], v[76:79]
    v_mfma_f32_16x16x32_bf16 v[76:79], v[108:111], v[112:115], v[76:79]
    s_waitcnt lgkmcnt(0)
    v_mfma_f32_16x16x32_bf16 v[48:51], v[144:147], v[176:179], v[48:51]
    v_mfma_f32_16x16x32_bf16 v[52:55], v[144:147], v[180:183], v[52:55]
    v_mfma_f32_16x16x32_bf16 v[56:59], v[144:147], v[184:187], v[56:59]
    v_mfma_f32_16x16x32_bf16 v[60:63], v[144:147], v[188:191], v[60:63]
    v_mfma_f32_16x16x32_bf16 v[64:67], v[144:147], v[192:195], v[64:67]
    v_mfma_f32_16x16x32_bf16 v[68:71], v[144:147], v[196:199], v[68:71]
    v_mfma_f32_16x16x32_bf16 v[72:75], v[144:147], v[200:203], v[72:75]
    v_mfma_f32_16x16x32_bf16 v[76:79], v[144:147], v[204:207], v[76:79]
    v_mfma_f32_16x16x32_bf16 v[52:55], v[148:151], v[176:179], v[52:55]
    v_mfma_f32_16x16x32_bf16 v[56:59], v[148:151], v[180:183], v[56:59]
    v_mfma_f32_16x16x32_bf16 v[60:63], v[148:151], v[184:187], v[60:63]
    v_mfma_f32_16x16x32_bf16 v[64:67], v[148:151], v[188:191], v[64:67]
    v_mfma_f32_16x16x32_bf16 v[68:71], v[148:151], v[192:195], v[68:71]
    v_mfma_f32_16x16x32_bf16 v[72:75], v[148:151], v[196:199], v[72:75]
    v_mfma_f32_16x16x32_bf16 v[76:79], v[148:151], v[200:203], v[76:79]
    v_mfma_f32_16x16x32_bf16 v[56:59], v[152:155], v[176:179], v[56:59]
    v_mfma_f32_16x16x32_bf16 v[60:63], v[152:155], v[180:183], v[60:63]
    v_mfma_f32_16x16x32_bf16 v[64:67], v[152:155], v[184:187], v[64:67]
    v_mfma_f32_16x16x32_bf16 v[68:71], v[152:155], v[188:191], v[68:71]
    v_mfma_f32_16x16x32_bf16 v[72:75], v[152:155], v[192:195], v[72:75]
    v_mfma_f32_16x16x32_bf16 v[76:79], v[152:155], v[196:199], v[76:79]
    v_mfma_f32_16x16x32_bf16 v[60:63], v[156:159], v[176:179], v[60:63]
    v_mfma_f32_16x16x32_bf16 v[64:67], v[156:159], v[180:183], v[64:67]
    v_mfma_f32_16x16x32_bf16 v[68:71], v[156:159], v[184:187], v[68:71]
    v_mfma_f32_16x16x32_bf16 v[72:75], v[156:159], v[188:191], v[72:75]
    v_mfma_f32_16x16x32_bf16 v[76:79], v[156:159], v[192:195], v[76:79]
    v_mfma_f32_16x16x32_bf16 v[64:67], v[160:163], v[176:179], v[64:67]
    v_mfma_f32_16x16x32_bf16 v[68:71], v[160:163], v[180:183], v[68:71]
    v_mfma_f32_16x16x32_bf16 v[72:75], v[160:163], v[184:187], v[72:75]
    v_mfma_f32_16x16x32_bf16 v[76:79], v[160:163], v[188:191], v[76:79]
    v_mfma_f32_16x16x32_bf16 v[68:71], v[164:167], v[176:179], v[68:71]
    v_mfma_f32_16x16x32_bf16 v[72:75], v[164:167], v[180:183], v[72:75]
    v_mfma_f32_16x16x32_bf16 v[76:79], v[164:167], v[184:187], v[76:79]
    v_mfma_f32_16x16x32_bf16 v[72:75], v[168:171], v[176:179], v[72:75]
    v_mfma_f32_16x16x32_bf16 v[76:79], v[168:171], v[180:183], v[76:79]
    v_mfma_f32_16x16x32_bf16 v[76:79], v[172:175], v[176:179], v[76:79]
    s_nop 7
    v_lshlrev_b32 v5, 6, v2
    v_lshl_add_u32 v5, v3, 4, v5
    v_add_u32 v5, v5, v4
    ds_write_b128 v5, v[48:51] offset:7424
    ds_write_b128 v5, v[52:55] offset:8448
    ds_write_b128 v5, v[56:59] offset:9472
    ds_write_b128 v5, v[60:63] offset:10496
    ds_write_b128 v5, v[64:67] offset:11520
    ds_write_b128 v5, v[68:71] offset:12544
    ds_write_b128 v5, v[72:75] offset:13568
    ds_write_b128 v5, v[76:79] offset:14592
    v_mov_b64 v[8:9], v[16:17]
    v_mov_b64 v[10:11], v[18:19]
    v_mov_b64 v[12:13], v[20:21]
    v_mov_b64 v[14:15], v[22:23]
    v_mov_b32 v24, v25
    v_add_u32 v4, 65536, v4
    s_add_u32 s28, s28, 1
    s_cmp_lt_u32 s28, 2
    s_waitcnt lgkmcnt(0)
    s_cbranch_scc1 ss_pass
    s_mov_b32 s12, s74
    s_mov_b32 s13, s75
    s_mov_b32 s14, 1152
    s_mov_b32 s15, 0x20000
    s_lshl_b32 s23, s20, 1
    buffer_load_dwordx4 v[8:11], off, s[12:15], s23
    s_barrier
    v_lshlrev_b32 v5, 5, v0
    v_add_u32 v7, 65536, v5
    ds_read_b128 v[64:67], v5 offset:7424
    ds_read_b128 v[68:71], v5 offset:7440
    ds_read_b128 v[72:75], v5 offset:23808
    ds_read_b128 v[76:79], v5 offset:23824
    ds_read_b128 v[80:83], v5 offset:40192
    ds_read_b128 v[84:87], v5 offset:40208
    ds_read_b128 v[88:91], v5 offset:56576
    ds_read_b128 v[92:95], v5 offset:56592
    ds_read_b128 v[96:99], v7 offset:7424
    ds_read_b128 v[100:103], v7 offset:7440
    ds_read_b128 v[104:107], v7 offset:23808
    ds_read_b128 v[108:111], v7 offset:23824
    ds_read_b128 v[112:115], v7 offset:40192
    ds_read_b128 v[116:119], v7 offset:40208
    ds_read_b128 v[120:123], v7 offset:56576
    ds_read_b128 v[124:127], v7 offset:56592
    s_waitcnt vmcnt(0)
    v_lshlrev_b32 v12, 16, v8
    v_and_b32 v13, 0xffff0000, v8
    v_lshlrev_b32 v14, 16, v9
    v_and_b32 v15, 0xffff0000, v9
    v_lshlrev_b32 v16, 16, v10
    v_and_b32 v17, 0xffff0000, v10
    v_lshlrev_b32 v18, 16, v11
    v_and_b32 v19, 0xffff0000, v11
    v_mul_u32_u24 v5, 18432, v0
    s_lshl_b32 s22, s20, 1
    s_add_u32 s22, s22, 1152
    s_waitcnt lgkmcnt(0)
    v_lshlrev_b32 v6, 16, v208
    v_fmac_f32 v64, v6, v12
    v_and_b32 v6, 0xffff0000, v208
    v_fmac_f32 v72, v6, v13
    v_lshlrev_b32 v6, 16, v209
    v_fmac_f32 v80, v6, v14
    v_and_b32 v6, 0xffff0000, v209
    v_fmac_f32 v88, v6, v15
    v_lshlrev_b32 v6, 16, v210
    v_fmac_f32 v96, v6, v16
    v_and_b32 v6, 0xffff0000, v210
    v_fmac_f32 v104, v6, v17
    v_lshlrev_b32 v6, 16, v211
    v_fmac_f32 v112, v6, v18
    v_and_b32 v6, 0xffff0000, v211
    v_fmac_f32 v120, v6, v19
    v_cvt_pk_bf16_f32 v208, v64, v72
    v_cvt_pk_bf16_f32 v209, v80, v88
    v_cvt_pk_bf16_f32 v210, v96, v104
    v_cvt_pk_bf16_f32 v211, v112, v120
    s_add_u32 s23, s22, 0
    buffer_store_dwordx4 v[208:211], v5, s[16:19], s23 offen
    v_lshlrev_b32 v6, 16, v212
    v_fmac_f32 v65, v6, v12
    v_and_b32 v6, 0xffff0000, v212
    v_fmac_f32 v73, v6, v13
    v_lshlrev_b32 v6, 16, v213
    v_fmac_f32 v81, v6, v14
    v_and_b32 v6, 0xffff0000, v213
    v_fmac_f32 v89, v6, v15
    v_lshlrev_b32 v6, 16, v214
    v_fmac_f32 v97, v6, v16
    v_and_b32 v6, 0xffff0000, v214
    v_fmac_f32 v105, v6, v17
    v_lshlrev_b32 v6, 16, v215
    v_fmac_f32 v113, v6, v18
    v_and_b32 v6, 0xffff0000, v215
    v_fmac_f32 v121, v6, v19
    v_cvt_pk_bf16_f32 v212, v65, v73
    v_cvt_pk_bf16_f32 v213, v81, v89
    v_cvt_pk_bf16_f32 v214, v97, v105
    v_cvt_pk_bf16_f32 v215, v113, v121
    s_add_u32 s23, s22, 2304
    buffer_store_dwordx4 v[212:215], v5, s[16:19], s23 offen
    v_lshlrev_b32 v6, 16, v216
    v_fmac_f32 v66, v6, v12
    v_and_b32 v6, 0xffff0000, v216
    v_fmac_f32 v74, v6, v13
    v_lshlrev_b32 v6, 16, v217
    v_fmac_f32 v82, v6, v14
    v_and_b32 v6, 0xffff0000, v217
    v_fmac_f32 v90, v6, v15
    v_lshlrev_b32 v6, 16, v218
    v_fmac_f32 v98, v6, v16
    v_and_b32 v6, 0xffff0000, v218
    v_fmac_f32 v106, v6, v17
    v_lshlrev_b32 v6, 16, v219
    v_fmac_f32 v114, v6, v18
    v_and_b32 v6, 0xffff0000, v219
    v_fmac_f32 v122, v6, v19
    v_cvt_pk_bf16_f32 v216, v66, v74
    v_cvt_pk_bf16_f32 v217, v82, v90
    v_cvt_pk_bf16_f32 v218, v98, v106
    v_cvt_pk_bf16_f32 v219, v114, v122
    s_add_u32 s23, s22, 4608
    buffer_store_dwordx4 v[216:219], v5, s[16:19], s23 offen
    v_lshlrev_b32 v6, 16, v220
    v_fmac_f32 v67, v6, v12
    v_and_b32 v6, 0xffff0000, v220
    v_fmac_f32 v75, v6, v13
    v_lshlrev_b32 v6, 16, v221
    v_fmac_f32 v83, v6, v14
    v_and_b32 v6, 0xffff0000, v221
    v_fmac_f32 v91, v6, v15
    v_lshlrev_b32 v6, 16, v222
    v_fmac_f32 v99, v6, v16
    v_and_b32 v6, 0xffff0000, v222
    v_fmac_f32 v107, v6, v17
    v_lshlrev_b32 v6, 16, v223
    v_fmac_f32 v115, v6, v18
    v_and_b32 v6, 0xffff0000, v223
    v_fmac_f32 v123, v6, v19
    v_cvt_pk_bf16_f32 v220, v67, v75
    v_cvt_pk_bf16_f32 v221, v83, v91
    v_cvt_pk_bf16_f32 v222, v99, v107
    v_cvt_pk_bf16_f32 v223, v115, v123
    s_add_u32 s23, s22, 6912
    buffer_store_dwordx4 v[220:223], v5, s[16:19], s23 offen
    v_lshlrev_b32 v6, 16, v224
    v_fmac_f32 v68, v6, v12
    v_and_b32 v6, 0xffff0000, v224
    v_fmac_f32 v76, v6, v13
    v_lshlrev_b32 v6, 16, v225
    v_fmac_f32 v84, v6, v14
    v_and_b32 v6, 0xffff0000, v225
    v_fmac_f32 v92, v6, v15
    v_lshlrev_b32 v6, 16, v226
    v_fmac_f32 v100, v6, v16
    v_and_b32 v6, 0xffff0000, v226
    v_fmac_f32 v108, v6, v17
    v_lshlrev_b32 v6, 16, v227
    v_fmac_f32 v116, v6, v18
    v_and_b32 v6, 0xffff0000, v227
    v_fmac_f32 v124, v6, v19
    v_cvt_pk_bf16_f32 v224, v68, v76
    v_cvt_pk_bf16_f32 v225, v84, v92
    v_cvt_pk_bf16_f32 v226, v100, v108
    v_cvt_pk_bf16_f32 v227, v116, v124
    s_add_u32 s23, s22, 9216
    buffer_store_dwordx4 v[224:227], v5, s[16:19], s23 offen
    v_lshlrev_b32 v6, 16, v228
    v_fmac_f32 v69, v6, v12
    v_and_b32 v6, 0xffff0000, v228
    v_fmac_f32 v77, v6, v13
    v_lshlrev_b32 v6, 16, v229
    v_fmac_f32 v85, v6, v14
    v_and_b32 v6, 0xffff0000, v229
    v_fmac_f32 v93, v6, v15
    v_lshlrev_b32 v6, 16, v230
    v_fmac_f32 v101, v6, v16
    v_and_b32 v6, 0xffff0000, v230
    v_fmac_f32 v109, v6, v17
    v_lshlrev_b32 v6, 16, v231
    v_fmac_f32 v117, v6, v18
    v_and_b32 v6, 0xffff0000, v231
    v_fmac_f32 v125, v6, v19
    v_cvt_pk_bf16_f32 v228, v69, v77
    v_cvt_pk_bf16_f32 v229, v85, v93
    v_cvt_pk_bf16_f32 v230, v101, v109
    v_cvt_pk_bf16_f32 v231, v117, v125
    s_add_u32 s23, s22, 11520
    buffer_store_dwordx4 v[228:231], v5, s[16:19], s23 offen
    v_lshlrev_b32 v6, 16, v232
    v_fmac_f32 v70, v6, v12
    v_and_b32 v6, 0xffff0000, v232
    v_fmac_f32 v78, v6, v13
    v_lshlrev_b32 v6, 16, v233
    v_fmac_f32 v86, v6, v14
    v_and_b32 v6, 0xffff0000, v233
    v_fmac_f32 v94, v6, v15
    v_lshlrev_b32 v6, 16, v234
    v_fmac_f32 v102, v6, v16
    v_and_b32 v6, 0xffff0000, v234
    v_fmac_f32 v110, v6, v17
    v_lshlrev_b32 v6, 16, v235
    v_fmac_f32 v118, v6, v18
    v_and_b32 v6, 0xffff0000, v235
    v_fmac_f32 v126, v6, v19
    v_cvt_pk_bf16_f32 v232, v70, v78
    v_cvt_pk_bf16_f32 v233, v86, v94
    v_cvt_pk_bf16_f32 v234, v102, v110
    v_cvt_pk_bf16_f32 v235, v118, v126
    s_add_u32 s23, s22, 13824
    buffer_store_dwordx4 v[232:235], v5, s[16:19], s23 offen
    v_lshlrev_b32 v6, 16, v236
    v_fmac_f32 v71, v6, v12
    v_and_b32 v6, 0xffff0000, v236
    v_fmac_f32 v79, v6, v13
    v_lshlrev_b32 v6, 16, v237
    v_fmac_f32 v87, v6, v14
    v_and_b32 v6, 0xffff0000, v237
    v_fmac_f32 v95, v6, v15
    v_lshlrev_b32 v6, 16, v238
    v_fmac_f32 v103, v6, v16
    v_and_b32 v6, 0xffff0000, v238
    v_fmac_f32 v111, v6, v17
    v_lshlrev_b32 v6, 16, v239
    v_fmac_f32 v119, v6, v18
    v_and_b32 v6, 0xffff0000, v239
    v_fmac_f32 v127, v6, v19
    v_cvt_pk_bf16_f32 v236, v71, v79
    v_cvt_pk_bf16_f32 v237, v87, v95
    v_cvt_pk_bf16_f32 v238, v103, v111
    v_cvt_pk_bf16_f32 v239, v119, v127
    s_add_u32 s23, s22, 16128
    buffer_store_dwordx4 v[236:239], v5, s[16:19], s23 offen
    s_branch L_ssm_next
L_ssm_done:
    s_cmp_lt_u32 s93, 100
    s_cbranch_scc1 L_exit
    s_mov_b32 s8, s76
    s_mov_b32 s9, s77
    s_mov_b32 s10, 4718592
    s_mov_b32 s11, 0x20000
    s_cmp_le_u32 s45, 1
    s_cbranch_scc1 L_att_next
    s_branch L_op_nextcb
L_wf_next:
    s_mov_b32 s37, 20
    v_mov_b32 v250, 1
    v_mov_b32 v251, 163832
    v_cmp_eq_u32 vcc, 0, v0
    s_nop 0
    s_and_saveexec_b64 s[38:39], vcc
    s_cbranch_execz tk12
    buffer_atomic_add v250, off, s[84:87], s37 sc0
    s_waitcnt vmcnt(0)
    ds_write_b32 v251, v250
    s_waitcnt lgkmcnt(0)
tk12:
    s_mov_b64 exec, -1
    s_barrier
    ds_read_b32 v252, v251
    s_waitcnt lgkmcnt(0)
    v_readfirstlane_b32 s33, v252
    s_barrier
    s_nop 3
    s_cmp_ge_u32 s33, 160
    s_cbranch_scc1 L_ssm_next
    s_lshl_b32 s16, s33, 2
    s_add_u32 s16, s16, s32
    s_add_u32 s16, s16, 1504
    s_call_b64 s[46:47], L_xform
    s_lshl_b32 s40, s33, 2
    s_add_u32 s40, s40, 125841408
    s_waitcnt vmcnt(0)
    s_barrier
    v_mov_b32 v250, s95
    v_cmp_eq_u32 vcc, 0, v0
    s_nop 0
    s_and_saveexec_b64 s[38:39], vcc
    s_cbranch_execz fs13
    buffer_store_dword v250, off, s[4:7], s40 sc1
fs13:
    s_mov_b64 exec, -1
    s_branch L_wf_next
L_phase2:
    s_mov_b32 s40, 524288
mc2_w:
    buffer_load_dword v250, off, s[84:87], 0 offset:28 sc1
    s_waitcnt vmcnt(0)
    v_readfirstlane_b32 s41, v250
    s_nop 0
    s_cmp_lg_u32 s41, 0
    s_cbranch_scc1 mc2_known
    s_sub_u32 s40, s40, 1
    s_cbranch_scc1 mc2_force
    s_sleep 2
    s_branch mc2_w
mc2_force:
    v_mov_b32 v250, 2
    v_mov_b32 v251, 0
    s_mov_b64 exec, 1
    buffer_atomic_cmpswap v[250:251], off, s[84:87], 0 offset:28
    s_mov_b64 exec, -1
    s_waitcnt vmcnt(0)
    s_mov_b32 s40, 524288
    s_branch mc2_w
mc2_known:
    s_cmp_eq_u32 s41, 1
    s_cbranch_scc1 L_phase2b
    s_mov_b32 s37, 208
    v_mov_b32 v250, 1
    v_mov_b32 v251, 163832
    v_cmp_eq_u32 vcc, 0, v0
    s_nop 0
    s_and_saveexec_b64 s[38:39], vcc
    s_cbranch_execz tk14
    buffer_atomic_add v250, off, s[84:87], s37 sc0
    s_waitcnt vmcnt(0)
    ds_write_b32 v251, v250
    s_waitcnt lgkmcnt(0)
tk14:
    s_mov_b64 exec, -1
    s_barrier
    ds_read_b32 v252, v251
    s_waitcnt lgkmcnt(0)
    v_readfirstlane_b32 s12, v252
    s_barrier
    s_nop 3
    s_cmp_lt_u32 s12, 32
    s_cbranch_scc1 L_chain_safe
    s_sub_u32 s45, s12, 32
L_phase2b:
    s_mov_b32 s8, s76
    s_mov_b32 s9, s77
    s_mov_b32 s10, 4718592
    s_mov_b32 s11, 0x20000
    s_and_b32 s36, s45, 15
    s_bitcmp1_b32 42315, s36
    s_cbranch_scc0 L_nots
    s_cmp_eq_u32 s93, 500
    s_cbranch_scc1 L_ssm_next
    s_branch L_wf_next
L_nots:
    s_bitcmp1_b32 18576, s36
    s_cbranch_scc0 L_att_next
    s_bfm_b32 s37, s36, 0
    s_and_b32 s37, s37, 18576
    s_bcnt1_i32_b32 s37, s37
    s_lshr_b32 s40, s45, 4
    s_mul_i32 s40, s40, 4
    s_add_u32 s33, s40, s37
L_op_mod:
    s_mul_hi_u32 s41, s33, 0x0e38e38f
    s_mul_i32 s41, s41, 18
    s_sub_u32 s33, s33, s41
    s_branch L_op_start
L_att_next:
    s_mov_b32 s37, 16
    v_mov_b32 v250, 1
    v_mov_b32 v251, 163832
    v_cmp_eq_u32 vcc, 0, v0
    s_nop 0
    s_and_saveexec_b64 s[38:39], vcc
    s_cbranch_execz tk15
    buffer_atomic_add v250, off, s[84:87], s37 sc0
    s_waitcnt vmcnt(0)
    ds_write_b32 v251, v250
    s_waitcnt lgkmcnt(0)
tk15:
    s_mov_b64 exec, -1
    s_barrier
    ds_read_b32 v252, v251
    s_waitcnt lgkmcnt(0)
    v_readfirstlane_b32 s34, v252
    s_barrier
    s_nop 3
    s_cmp_ge_u32 s34, 512
    s_cbranch_scc1 L_op_nextcb
    s_lshr_b32 s16, s34, 3
    s_and_b32 s17, s34, 7
    s_lshl_b32 s17, s17, 2
    s_add_u32 s17, s17, s32
    s_lshl_b32 s36, s17, 7
    s_add_u32 s36, s36, 125829120
    s_lshr_b32 s41, s16, 2
    s_add_u32 s41, s41, s95
    s_add_u32 s41, s41, 1
    v_and_b32 v1, 3, v0
    v_min_u32 v1, 2, v1
    v_lshlrev_b32 v2, 4, v1
    s_and_b32 s37, s16, 3
    s_lshl_b32 s37, s37, 2
    v_add_u32 v2, s37, v2
    s_mov_b32 s40, 4194304
L_aw1:
    buffer_load_dword v3, v2, s[4:7], s36 offen sc1
    s_sub_u32 s40, s40, 1
    s_cbranch_scc1 L_aw1_go
    s_waitcnt vmcnt(0)
    v_subrev_u32 v3, s41, v3
    v_cmp_lt_u32 vcc, 64, v3
    s_cbranch_vccz L_aw1_go
    s_sleep 4
    s_branch L_aw1
L_aw1_go:
    v_and_b32 v5, 63, v0
    v_lshlrev_b32 v1, 4, v5
    s_cmp_ge_u32 s16, 58
    s_cselect_b32 s18, -1, 511
    v_and_b32 v2, s18, v1
    v_or_b32 v3, 128, v1
    v_lshrrev_b32 v4, 4, v5
    v_bfe_u32 v6, v5, 2, 2
    v_sub_u32 v4, v6, v4
    v_lshlrev_b32 v4, 3, v4
    v_and_b32 v6, 3, v5
    v_add_u32 v4, v4, v6
    v_mov_b32 v6, 0xf149f2ca
    s_mov_b32 s22, 0x3e0293ee
    s_lshl_b32 s18, s16, 5
    s_add_u32 s18, s18, s17
    s_lshl_b32 s19, s18, 13
    s_add_u32 s20, s19, 33554432
    buffer_load_dwordx4 v[8:11], v1, s[4:7], s20 offen offset:0 sc1
    s_add_u32 s20, s19, 33554432
    buffer_load_dwordx4 v[12:15], v1, s[4:7], s20 offen offset:1024 sc1
    s_add_u32 s20, s19, 33554432
    buffer_load_dwordx4 v[16:19], v1, s[4:7], s20 offen offset:2048 sc1
    s_add_u32 s20, s19, 33554432
    buffer_load_dwordx4 v[20:23], v1, s[4:7], s20 offen offset:3072 sc1
    s_add_u32 s20, s19, 33558528
    buffer_load_dwordx4 v[24:27], v1, s[4:7], s20 offen offset:0 sc1
    s_add_u32 s20, s19, 33558528
    buffer_load_dwordx4 v[28:31], v1, s[4:7], s20 offen offset:1024 sc1
    s_add_u32 s20, s19, 33558528
    buffer_load_dwordx4 v[32:35], v1, s[4:7], s20 offen offset:2048 sc1
    s_add_u32 s20, s19, 33558528
    buffer_load_dwordx4 v[36:39], v1, s[4:7], s20 offen offset:3072 sc1
    s_lshl_b32 s21, s18, 14
    s_add_u32 s20, s21, 0
    buffer_load_dwordx4 v[40:43], v1, s[4:7], s20 offen offset:0 sc1
    s_add_u32 s20, s21, 4096
    buffer_load_dwordx4 v[44:47], v1, s[4:7], s20 offen offset:0 sc1
    s_add_u32 s20, s21, 8192
    buffer_load_dwordx4 v[48:51], v1, s[4:7], s20 offen offset:0 sc1
    s_add_u32 s20, s21, 12288
    buffer_load_dwordx4 v[52:55], v1, s[4:7], s20 offen offset:0 sc1
    s_add_u32 s20, s21, 0
    buffer_load_dwordx4 v[56:59], v1, s[4:7], s20 offen offset:1024 sc1
    s_add_u32 s20, s21, 4096
    buffer_load_dwordx4 v[60:63], v1, s[4:7], s20 offen offset:1024 sc1
    s_add_u32 s20, s21, 8192
    buffer_load_dwordx4 v[64:67], v1, s[4:7], s20 offen offset:1024 sc1
    s_add_u32 s20, s21, 12288
    buffer_load_dwordx4 v[68:71], v1, s[4:7], s20 offen offset:1024 sc1
    s_add_u32 s20, s21, 0
    buffer_load_dwordx4 v[88:91], v1, s[4:7], s20 offen offset:2048 sc1
    s_add_u32 s20, s21, 4096
    buffer_load_dwordx4 v[92:95], v1, s[4:7], s20 offen offset:2048 sc1
    s_add_u32 s20, s21, 8192
    buffer_load_dwordx4 v[96:99], v1, s[4:7], s20 offen offset:2048 sc1
    s_add_u32 s20, s21, 12288
    buffer_load_dwordx4 v[100:103], v1, s[4:7], s20 offen offset:2048 sc1
    s_add_u32 s20, s21, 0
    buffer_load_dwordx4 v[104:107], v1, s[4:7], s20 offen offset:3072 sc1
    s_add_u32 s20, s21, 4096
    buffer_load_dwordx4 v[108:111], v1, s[4:7], s20 offen offset:3072 sc1
    s_add_u32 s20, s21, 8192
    buffer_load_dwordx4 v[112:115], v1, s[4:7], s20 offen offset:3072 sc1
    s_add_u32 s20, s21, 12288
    buffer_load_dwordx4 v[116:119], v1, s[4:7], s20 offen offset:3072 sc1
    v_mov_b32 v172, 0x3f803f80
    v_mov_b32 v173, 0x3f803f80
    v_mov_b32 v174, 0x3f803f80
    v_mov_b32 v175, 0x3f803f80
    v_mov_b32 v176, 0x3f003f00
    v_mov_b32 v177, 0x3f003f00
    s_waitcnt vmcnt(8)
    v_mfma_f32_16x16x32_bf16 v[136:139], v[40:43], v[8:11], 0
    v_mfma_f32_16x16x32_bf16 v[140:143], v[56:59], v[8:11], 0
    v_mfma_f32_16x16x32_bf16 v[148:151], v[40:43], v[24:27], 0
    v_mfma_f32_16x16x32_bf16 v[152:155], v[56:59], v[24:27], 0
    v_mfma_f32_16x16x32_bf16 v[136:139], v[44:47], v[12:15], v[136:139]
    v_mfma_f32_16x16x32_bf16 v[140:143], v[60:63], v[12:15], v[140:143]
    v_mfma_f32_16x16x32_bf16 v[148:151], v[44:47], v[28:31], v[148:151]
    v_mfma_f32_16x16x32_bf16 v[152:155], v[60:63], v[28:31], v[152:155]
    v_mfma_f32_16x16x32_bf16 v[136:139], v[48:51], v[16:19], v[136:139]
    v_mfma_f32_16x16x32_bf16 v[140:143], v[64:67], v[16:19], v[140:143]
    v_mfma_f32_16x16x32_bf16 v[148:151], v[48:51], v[32:35], v[148:151]
    v_mfma_f32_16x16x32_bf16 v[152:155], v[64:67], v[32:35], v[152:155]
    v_mfma_f32_16x16x32_bf16 v[136:139], v[52:55], v[20:23], v[136:139]
    v_mfma_f32_16x16x32_bf16 v[140:143], v[68:71], v[20:23], v[140:143]
    v_mfma_f32_16x16x32_bf16 v[148:151], v[52:55], v[36:39], v[148:151]
    v_mfma_f32_16x16x32_bf16 v[152:155], v[68:71], v[36:39], v[152:155]
    v_cmp_le_i32 vcc, 0, v4
    s_nop 3
    v_cndmask_b32 v136, v6, v136, vcc
    v_cmp_le_i32 vcc, 1, v4
    s_nop 1
    v_cndmask_b32 v137, v6, v137, vcc
    v_cmp_le_i32 vcc, 2, v4
    s_nop 1
    v_cndmask_b32 v138, v6, v138, vcc
    v_cmp_le_i32 vcc, 3, v4
    s_nop 1
    v_cndmask_b32 v139, v6, v139, vcc
    v_cmp_le_i32 vcc, 4, v4
    s_nop 1
    v_cndmask_b32 v140, v6, v140, vcc
    v_cmp_le_i32 vcc, 5, v4
    s_nop 1
    v_cndmask_b32 v141, v6, v141, vcc
    v_cmp_le_i32 vcc, 6, v4
    s_nop 1
    v_cndmask_b32 v142, v6, v142, vcc
    v_cmp_le_i32 vcc, 7, v4
    s_nop 1
    v_cndmask_b32 v143, v6, v143, vcc
    v_cmp_le_i32 vcc, -4, v4
    s_nop 1
    v_cndmask_b32 v148, v6, v148, vcc
    v_cmp_le_i32 vcc, -3, v4
    s_nop 1
    v_cndmask_b32 v149, v6, v149, vcc
    v_cmp_le_i32 vcc, -2, v4
    s_nop 1
    v_cndmask_b32 v150, v6, v150, vcc
    v_cmp_le_i32 vcc, -1, v4
    s_nop 1
    v_cndmask_b32 v151, v6, v151, vcc
    v_cmp_le_i32 vcc, 0, v4
    s_nop 1
    v_cndmask_b32 v152, v6, v152, vcc
    v_cmp_le_i32 vcc, 1, v4
    s_nop 1
    v_cndmask_b32 v153, v6, v153, vcc
    v_cmp_le_i32 vcc, 2, v4
    s_nop 1
    v_cndmask_b32 v154, v6, v154, vcc
    v_cmp_le_i32 vcc, 3, v4
    s_nop 1
    v_cndmask_b32 v155, v6, v155, vcc
    s_nop 1
    v_and_b32 v198, 1, v0
    v_lshlrev_b32 v198, 2, v198
    v_add_u32 v198, 48, v198
    s_add_u32 s41, s16, s95
    s_add_u32 s41, s41, 1
    s_cmp_lt_u32 s16, 58
    s_cbranch_scc1 L_amk
    v_mov_b32 v198, 16384
L_amk:
    s_nop 1
    s_mov_b32 s88, 65536
    s_mov_b32 s89, 125853696
cw16:
    buffer_load_dword v199, off, s[4:7], s89 sc1
    s_waitcnt vmcnt(0)
    v_readfirstlane_b32 s42, v199
    s_nop 0
    s_sub_u32 s42, s42, s95
    s_cmp_gt_u32 s42, 64
    s_cselect_b32 s42, 0, s42
    s_add_u32 s42, s42, 1
    s_cmp_ge_u32 s42, s16
    s_cbranch_scc1 cw16x
    s_sub_u32 s88, s88, 1
    s_cbranch_scc1 cw16x
    s_sub_u32 s42, s16, s42
    s_min_u32 s42, s42, 6
cw16s:
    s_sleep 24
    s_sub_u32 s42, s42, 1
    s_cmp_lg_u32 s42, 0
    s_cbranch_scc1 cw16s
    s_branch cw16
cw16x:
    s_mov_b32 s40, 4194304
L_aw2:
    buffer_load_dword v199, v198, s[4:7], s36 offen sc1
    s_sub_u32 s40, s40, 1
    s_cbranch_scc1 L_aw2_go
    s_waitcnt vmcnt(0)
    v_subrev_u32 v199, s41, v199
    v_cmp_lt_u32 vcc, 64, v199
    s_cbranch_vccz L_aw2_go
    s_sleep 1
    s_branch L_aw2
L_aw2_go:
    s_lshl_b32 s20, s18, 12
    s_add_u32 s20, s20, 69206016
    buffer_load_dwordx4 v[72:75], v3, s[4:7], s20 offen offset:0 sc1
    buffer_load_dwordx4 v[76:79], v3, s[4:7], s20 offen offset:1024 sc1
    buffer_load_dwordx4 v[80:83], v3, s[4:7], s20 offen offset:2048 sc1
    buffer_load_dwordx4 v[84:87], v3, s[4:7], s20 offen offset:3072 sc1
    s_lshl_b32 s20, s18, 12
    s_add_u32 s20, s20, 77594624
    buffer_load_dwordx4 v[120:123], v2, s[4:7], s20 offen offset:0 sc1
    buffer_load_dwordx4 v[124:127], v2, s[4:7], s20 offen offset:1024 sc1
    buffer_load_dwordx4 v[128:131], v2, s[4:7], s20 offen offset:2048 sc1
    buffer_load_dwordx4 v[132:135], v2, s[4:7], s20 offen offset:3072 sc1
    s_waitcnt vmcnt(4)
    v_mfma_f32_16x16x32_bf16 v[144:147], v[72:75], v[8:11], 0
    v_mfma_f32_16x16x32_bf16 v[156:159], v[72:75], v[24:27], 0
    v_mfma_f32_16x16x32_bf16 v[144:147], v[76:79], v[12:15], v[144:147]
    v_mfma_f32_16x16x32_bf16 v[156:159], v[76:79], v[28:31], v[156:159]
    v_mfma_f32_16x16x32_bf16 v[144:147], v[80:83], v[16:19], v[144:147]
    v_mfma_f32_16x16x32_bf16 v[156:159], v[80:83], v[32:35], v[156:159]
    v_mfma_f32_16x16x32_bf16 v[144:147], v[84:87], v[20:23], v[144:147]
    v_mfma_f32_16x16x32_bf16 v[156:159], v[84:87], v[36:39], v[156:159]
    v_max3_f32 v196, v136, v137, v138
    v_max3_f32 v197, v139, v140, v141
    v_max3_f32 v196, v196, v142, v143
    s_nop 3
    v_max3_f32 v197, v197, v144, v145
    v_max3_f32 v196, v196, v146, v147
    v_max_f32 v196, v196, v197
    v_mov_b32 v197, v196
    s_nop 1
    v_permlane32_swap_b32 v196, v197
    v_max_f32 v196, v196, v197
    v_mov_b32 v197, v196
    s_nop 1
    v_permlane16_swap_b32 v196, v197
    v_max_f32 v196, v196, v197
    v_mul_f32 v196, s22, v196
    v_sub_f32 v196, 0, v196
    v_fma_f32 v136, v136, s22, v196
    v_fma_f32 v137, v137, s22, v196
    v_fma_f32 v138, v138, s22, v196
    v_fma_f32 v139, v139, s22, v196
    v_fma_f32 v140, v140, s22, v196
    v_fma_f32 v141, v141, s22, v196
    v_fma_f32 v142, v142, s22, v196
    v_fma_f32 v143, v143, s22, v196
    v_fma_f32 v144, v144, s22, v196
    v_fma_f32 v145, v145, s22, v196
    v_fma_f32 v146, v146, s22, v196
    v_fma_f32 v147, v147, s22, v196
    v_exp_f32 v136, v136
    v_exp_f32 v137, v137
    v_exp_f32 v138, v138
    v_exp_f32 v139, v139
    v_exp_f32 v140, v140
    v_exp_f32 v141, v141
    v_exp_f32 v142, v142
    v_exp_f32 v143, v143
    v_exp_f32 v144, v144
    v_exp_f32 v145, v145
    v_exp_f32 v146, v146
    v_exp_f32 v147, v147
    v_cvt_pk_bf16_f32 v160, v136, v137
    v_cvt_pk_bf16_f32 v161, v138, v139
    v_cvt_pk_bf16_f32 v162, v140, v141
    v_cvt_pk_bf16_f32 v163, v142, v143
    v_cvt_pk_bf16_f32 v164, v144, v145
    v_cvt_pk_bf16_f32 v165, v146, v147
    v_max3_f32 v196, v148, v149, v150
    v_max3_f32 v197, v151, v152, v153
    v_max3_f32 v196, v196, v154, v155
    v_max3_f32 v197, v197, v156, v157
    v_max3_f32 v196, v196, v158, v159
    v_max_f32 v196, v196, v197
    v_mov_b32 v197, v196
    s_nop 1
    v_permlane32_swap_b32 v196, v197
    v_max_f32 v196, v196, v197
    v_mov_b32 v197, v196
    s_nop 1
    v_permlane16_swap_b32 v196, v197
    v_max_f32 v196, v196, v197
    v_mul_f32 v196, s22, v196
    v_sub_f32 v196, 0, v196
    v_fma_f32 v148, v148, s22, v196
    v_fma_f32 v149, v149, s22, v196
    v_fma_f32 v150, v150, s22, v196
    v_fma_f32 v151, v151, s22, v196
    v_fma_f32 v152, v152, s22, v196
    v_fma_f32 v153, v153, s22, v196
    v_fma_f32 v154, v154, s22, v196
    v_fma_f32 v155, v155, s22, v196
    v_fma_f32 v156, v156, s22, v196
    v_fma_f32 v157, v157, s22, v196
    v_fma_f32 v158, v158, s22, v196
    v_fma_f32 v159, v159, s22, v196
    v_exp_f32 v148, v148
    v_exp_f32 v149, v149
    v_exp_f32 v150, v150
    v_exp_f32 v151, v151
    v_exp_f32 v152, v152
    v_exp_f32 v153, v153
    v_exp_f32 v154, v154
    v_exp_f32 v155, v155
    v_exp_f32 v156, v156
    v_exp_f32 v157, v157
    v_exp_f32 v158, v158
    v_exp_f32 v159, v159
    v_cvt_pk_bf16_f32 v166, v148, v149
    v_cvt_pk_bf16_f32 v167, v150, v151
    v_cvt_pk_bf16_f32 v168, v152, v153
    v_cvt_pk_bf16_f32 v169, v154, v155
    v_cvt_pk_bf16_f32 v170, v156, v157
    v_cvt_pk_bf16_f32 v171, v158, v159
    v_mfma_f32_16x16x32_bf16 v[180:183], v[172:175], v[160:163], 0
    v_mfma_f32_16x16x32_bf16 v[184:187], v[172:175], v[166:169], 0
    s_nop 4
    v_mfma_f32_16x16x16_bf16 v[180:183], v[176:177], v[164:165], v[180:183]
    v_mfma_f32_16x16x16_bf16 v[184:187], v[176:177], v[170:171], v[184:187]
    s_nop 6
    v_rcp_f32 v180, v180
    v_rcp_f32 v184, v184
    s_waitcnt vmcnt(0)
    s_lshl_b32 s18, s16, 18
    s_lshl_b32 s19, s17, 12
    s_add_u32 s18, s18, s19
    s_add_u32 s18, s18, 50331648
    s_add_u32 s19, s18, 131072
    v_mfma_f32_16x16x32_bf16 v[8:11], v[88:91], v[160:163], 0
    v_mfma_f32_16x16x32_bf16 v[12:15], v[104:107], v[160:163], 0
    v_mfma_f32_16x16x32_bf16 v[16:19], v[88:91], v[166:169], 0
    v_mfma_f32_16x16x32_bf16 v[20:23], v[104:107], v[166:169], 0
    v_mfma_f32_16x16x32_bf16 v[24:27], v[92:95], v[160:163], 0
    v_mfma_f32_16x16x32_bf16 v[28:31], v[108:111], v[160:163], 0
    v_mfma_f32_16x16x32_bf16 v[32:35], v[92:95], v[166:169], 0
    v_mfma_f32_16x16x32_bf16 v[36:39], v[108:111], v[166:169], 0
    v_mfma_f32_16x16x32_bf16 v[40:43], v[96:99], v[160:163], 0
    v_mfma_f32_16x16x32_bf16 v[44:47], v[112:115], v[160:163], 0
    v_mfma_f32_16x16x32_bf16 v[48:51], v[96:99], v[166:169], 0
    v_mfma_f32_16x16x32_bf16 v[52:55], v[112:115], v[166:169], 0
    v_mfma_f32_16x16x32_bf16 v[56:59], v[100:103], v[160:163], 0
    v_mfma_f32_16x16x32_bf16 v[60:63], v[116:119], v[160:163], 0
    v_mfma_f32_16x16x32_bf16 v[64:67], v[100:103], v[166:169], 0
    v_mfma_f32_16x16x32_bf16 v[68:71], v[116:119], v[166:169], 0
    v_mfma_f32_16x16x16_bf16 v[8:11], v[120:121], v[164:165], v[8:11]
    v_mfma_f32_16x16x16_bf16 v[12:15], v[122:123], v[164:165], v[12:15]
    v_mfma_f32_16x16x16_bf16 v[16:19], v[120:121], v[170:171], v[16:19]
    v_mfma_f32_16x16x16_bf16 v[20:23], v[122:123], v[170:171], v[20:23]
    v_mfma_f32_16x16x16_bf16 v[24:27], v[124:125], v[164:165], v[24:27]
    v_mfma_f32_16x16x16_bf16 v[28:31], v[126:127], v[164:165], v[28:31]
    v_mfma_f32_16x16x16_bf16 v[32:35], v[124:125], v[170:171], v[32:35]
    v_mfma_f32_16x16x16_bf16 v[36:39], v[126:127], v[170:171], v[36:39]
    v_mfma_f32_16x16x16_bf16 v[40:43], v[128:129], v[164:165], v[40:43]
    v_mfma_f32_16x16x16_bf16 v[44:47], v[130:131], v[164:165], v[44:47]
    v_mfma_f32_16x16x16_bf16 v[48:51], v[128:129], v[170:171], v[48:51]
    v_mfma_f32_16x16x16_bf16 v[52:55], v[130:131], v[170:171], v[52:55]
    v_mfma_f32_16x16x16_bf16 v[56:59], v[132:133], v[164:165], v[56:59]
    v_mfma_f32_16x16x16_bf16 v[60:63], v[134:135], v[164:165], v[60:63]
    v_mfma_f32_16x16x16_bf16 v[64:67], v[132:133], v[170:171], v[64:67]
    v_mfma_f32_16x16x16_bf16 v[68:71], v[134:135], v[170:171], v[68:71]
    v_mul_f32 v8, v8, v180
    v_mul_f32 v12, v12, v180
    v_mul_f32 v9, v9, v180
    v_mul_f32 v13, v13, v180
    v_mul_f32 v10, v10, v180
    v_mul_f32 v14, v14, v180
    v_mul_f32 v11, v11, v180
    v_mul_f32 v15, v15, v180
    v_cvt_pk_bf16_f32 v8, v8, v9
    v_cvt_pk_bf16_f32 v9, v10, v11
    v_cvt_pk_bf16_f32 v10, v12, v13
    v_cvt_pk_bf16_f32 v11, v14, v15
    buffer_store_dwordx4 v[8:11], v1, s[4:7], s18 offen offset:0 sc1
    v_mul_f32 v16, v16, v184
    v_mul_f32 v20, v20, v184
    v_mul_f32 v17, v17, v184
    v_mul_f32 v21, v21, v184
    v_mul_f32 v18, v18, v184
    v_mul_f32 v22, v22, v184
    v_mul_f32 v19, v19, v184
    v_mul_f32 v23, v23, v184
    v_cvt_pk_bf16_f32 v16, v16, v17
    v_cvt_pk_bf16_f32 v17, v18, v19
    v_cvt_pk_bf16_f32 v18, v20, v21
    v_cvt_pk_bf16_f32 v19, v22, v23
    buffer_store_dwordx4 v[16:19], v1, s[4:7], s19 offen offset:0 sc1
    v_mul_f32 v24, v24, v180
    v_mul_f32 v28, v28, v180
    v_mul_f32 v25, v25, v180
    v_mul_f32 v29, v29, v180
    v_mul_f32 v26, v26, v180
    v_mul_f32 v30, v30, v180
    v_mul_f32 v27, v27, v180
    v_mul_f32 v31, v31, v180
    v_cvt_pk_bf16_f32 v24, v24, v25
    v_cvt_pk_bf16_f32 v25, v26, v27
    v_cvt_pk_bf16_f32 v26, v28, v29
    v_cvt_pk_bf16_f32 v27, v30, v31
    buffer_store_dwordx4 v[24:27], v1, s[4:7], s18 offen offset:1024 sc1
    v_mul_f32 v32, v32, v184
    v_mul_f32 v36, v36, v184
    v_mul_f32 v33, v33, v184
    v_mul_f32 v37, v37, v184
    v_mul_f32 v34, v34, v184
    v_mul_f32 v38, v38, v184
    v_mul_f32 v35, v35, v184
    v_mul_f32 v39, v39, v184
    v_cvt_pk_bf16_f32 v32, v32, v33
    v_cvt_pk_bf16_f32 v33, v34, v35
    v_cvt_pk_bf16_f32 v34, v36, v37
    v_cvt_pk_bf16_f32 v35, v38, v39
    buffer_store_dwordx4 v[32:35], v1, s[4:7], s19 offen offset:1024 sc1
    v_mul_f32 v40, v40, v180
    v_mul_f32 v44, v44, v180
    v_mul_f32 v41, v41, v180
    v_mul_f32 v45, v45, v180
    v_mul_f32 v42, v42, v180
    v_mul_f32 v46, v46, v180
    v_mul_f32 v43, v43, v180
    v_mul_f32 v47, v47, v180
    v_cvt_pk_bf16_f32 v40, v40, v41
    v_cvt_pk_bf16_f32 v41, v42, v43
    v_cvt_pk_bf16_f32 v42, v44, v45
    v_cvt_pk_bf16_f32 v43, v46, v47
    buffer_store_dwordx4 v[40:43], v1, s[4:7], s18 offen offset:2048 sc1
    v_mul_f32 v48, v48, v184
    v_mul_f32 v52, v52, v184
    v_mul_f32 v49, v49, v184
    v_mul_f32 v53, v53, v184
    v_mul_f32 v50, v50, v184
    v_mul_f32 v54, v54, v184
    v_mul_f32 v51, v51, v184
    v_mul_f32 v55, v55, v184
    v_cvt_pk_bf16_f32 v48, v48, v49
    v_cvt_pk_bf16_f32 v49, v50, v51
    v_cvt_pk_bf16_f32 v50, v52, v53
    v_cvt_pk_bf16_f32 v51, v54, v55
    buffer_store_dwordx4 v[48:51], v1, s[4:7], s19 offen offset:2048 sc1
    v_mul_f32 v56, v56, v180
    v_mul_f32 v60, v60, v180
    v_mul_f32 v57, v57, v180
    v_mul_f32 v61, v61, v180
    v_mul_f32 v58, v58, v180
    v_mul_f32 v62, v62, v180
    v_mul_f32 v59, v59, v180
    v_mul_f32 v63, v63, v180
    v_cvt_pk_bf16_f32 v56, v56, v57
    v_cvt_pk_bf16_f32 v57, v58, v59
    v_cvt_pk_bf16_f32 v58, v60, v61
    v_cvt_pk_bf16_f32 v59, v62, v63
    buffer_store_dwordx4 v[56:59], v1, s[4:7], s18 offen offset:3072 sc1
    v_mul_f32 v64, v64, v184
    v_mul_f32 v68, v68, v184
    v_mul_f32 v65, v65, v184
    v_mul_f32 v69, v69, v184
    v_mul_f32 v66, v66, v184
    v_mul_f32 v70, v70, v184
    v_mul_f32 v67, v67, v184
    v_mul_f32 v71, v71, v184
    v_cvt_pk_bf16_f32 v64, v64, v65
    v_cvt_pk_bf16_f32 v65, v66, v67
    v_cvt_pk_bf16_f32 v66, v68, v69
    v_cvt_pk_bf16_f32 v67, v70, v71
    buffer_store_dwordx4 v[64:67], v1, s[4:7], s19 offen offset:3072 sc1
    s_lshr_b32 s40, s34, 1
    s_lshl_b32 s40, s40, 7
    s_and_b32 s41, s34, 1
    s_lshl_b32 s41, s41, 2
    s_add_u32 s40, s40, s41
    s_add_u32 s40, s40, 125894656
    s_waitcnt vmcnt(0)
    s_barrier
    v_mov_b32 v250, s95
    v_cmp_eq_u32 vcc, 0, v0
    s_nop 0
    s_and_saveexec_b64 s[38:39], vcc
    s_cbranch_execz fs17
    buffer_store_dword v250, off, s[4:7], s40 sc1
fs17:
    s_mov_b64 exec, -1
    s_branch L_att_next
L_op_start:
    s_lshl_b32 s35, s33, 2
    s_add_u32 s35, s35, 136
    s_lshr_b32 s89, s33, 2
    s_lshl_b32 s89, s89, 7
    s_add_u32 s89, s89, 125841408
    v_mbcnt_lo_u32_b32 v2, -1, 0
    v_mbcnt_hi_u32_b32 v2, -1, v2
    v_min_u32 v2, 31, v2
    v_lshlrev_b32 v2, 2, v2
    s_mov_b32 s88, 4194304
fw18:
    buffer_load_dword v3, v2, s[4:7], s89 offen offset:0 sc1
    s_sub_u32 s88, s88, 1
    s_cbranch_scc1 fw18x
    s_waitcnt vmcnt(0)
    v_cmp_ne_u32 vcc, s95, v3
    s_cbranch_vccz fw18x
    s_sleep 4
    s_branch fw18
fw18x:
    v_and_b32 v1, 63, v0
    v_lshlrev_b32 v1, 4, v1
    s_lshl_b32 s18, s33, 18
    s_lshl_b32 s19, s32, 16
    s_add_u32 s18, s18, s19
    s_add_u32 s18, s18, 130023424
    buffer_load_dwordx4 a[0:3], v1, s[4:7], s18 offen offset:0 sc1
    buffer_load_dwordx4 a[4:7], v1, s[4:7], s18 offen offset:1024 sc1
    buffer_load_dwordx4 a[8:11], v1, s[4:7], s18 offen offset:2048 sc1
    buffer_load_dwordx4 a[12:15], v1, s[4:7], s18 offen offset:3072 sc1
    s_add_u32 s18, s18, 4096
    buffer_load_dwordx4 a[16:19], v1, s[4:7], s18 offen offset:0 sc1
    buffer_load_dwordx4 a[20:23], v1, s[4:7], s18 offen offset:1024 sc1
    buffer_load_dwordx4 a[24:27], v1, s[4:7], s18 offen offset:2048 sc1
    buffer_load_dwordx4 a[28:31], v1, s[4:7], s18 offen offset:3072 sc1
    s_add_u32 s18, s18, 4096
    buffer_load_dwordx4 a[32:35], v1, s[4:7], s18 offen offset:0 sc1
    buffer_load_dwordx4 a[36:39], v1, s[4:7], s18 offen offset:1024 sc1
    buffer_load_dwordx4 a[40:43], v1, s[4:7], s18 offen offset:2048 sc1
    buffer_load_dwordx4 a[44:47], v1, s[4:7], s18 offen offset:3072 sc1
    s_add_u32 s18, s18, 4096
    buffer_load_dwordx4 a[48:51], v1, s[4:7], s18 offen offset:0 sc1
    buffer_load_dwordx4 a[52:55], v1, s[4:7], s18 offen offset:1024 sc1
    buffer_load_dwordx4 a[56:59], v1, s[4:7], s18 offen offset:2048 sc1
    buffer_load_dwordx4 a[60:63], v1, s[4:7], s18 offen offset:3072 sc1
    s_add_u32 s18, s18, 4096
    buffer_load_dwordx4 a[64:67], v1, s[4:7], s18 offen offset:0 sc1
    buffer_load_dwordx4 a[68:71], v1, s[4:7], s18 offen offset:1024 sc1
    buffer_load_dwordx4 a[72:75], v1, s[4:7], s18 offen offset:2048 sc1
    buffer_load_dwordx4 a[76:79], v1, s[4:7], s18 offen offset:3072 sc1
    s_add_u32 s18, s18, 4096
    buffer_load_dwordx4 a[80:83], v1, s[4:7], s18 offen offset:0 sc1
    buffer_load_dwordx4 a[84:87], v1, s[4:7], s18 offen offset:1024 sc1
    buffer_load_dwordx4 a[88:91], v1, s[4:7], s18 offen offset:2048 sc1
    buffer_load_dwordx4 a[92:95], v1, s[4:7], s18 offen offset:3072 sc1
    s_add_u32 s18, s18, 4096
    buffer_load_dwordx4 a[96:99], v1, s[4:7], s18 offen offset:0 sc1
    buffer_load_dwordx4 a[100:103], v1, s[4:7], s18 offen offset:1024 sc1
    buffer_load_dwordx4 a[104:107], v1, s[4:7], s18 offen offset:2048 sc1
    buffer_load_dwordx4 a[108:111], v1, s[4:7], s18 offen offset:3072 sc1
    s_add_u32 s18, s18, 4096
    buffer_load_dwordx4 a[112:115], v1, s[4:7], s18 offen offset:0 sc1
    buffer_load_dwordx4 a[116:119], v1, s[4:7], s18 offen offset:1024 sc1
    buffer_load_dwordx4 a[120:123], v1, s[4:7], s18 offen offset:2048 sc1
    buffer_load_dwordx4 a[124:127], v1, s[4:7], s18 offen offset:3072 sc1
    s_add_u32 s18, s18, 4096
    buffer_load_dwordx4 a[128:131], v1, s[4:7], s18 offen offset:0 sc1
    buffer_load_dwordx4 a[132:135], v1, s[4:7], s18 offen offset:1024 sc1
    buffer_load_dwordx4 a[136:139], v1, s[4:7], s18 offen offset:2048 sc1
    buffer_load_dwordx4 a[140:143], v1, s[4:7], s18 offen offset:3072 sc1
    s_add_u32 s18, s18, 4096
    buffer_load_dwordx4 a[144:147], v1, s[4:7], s18 offen offset:0 sc1
    buffer_load_dwordx4 a[148:151], v1, s[4:7], s18 offen offset:1024 sc1
    buffer_load_dwordx4 a[152:155], v1, s[4:7], s18 offen offset:2048 sc1
    buffer_load_dwordx4 a[156:159], v1, s[4:7], s18 offen offset:3072 sc1
    s_add_u32 s18, s18, 4096
    buffer_load_dwordx4 a[160:163], v1, s[4:7], s18 offen offset:0 sc1
    s_waitcnt vmcnt(20)
    buffer_load_dwordx4 a[164:167], v1, s[4:7], s18 offen offset:1024 sc1
    buffer_load_dwordx4 a[168:171], v1, s[4:7], s18 offen offset:2048 sc1
    buffer_load_dwordx4 a[172:175], v1, s[4:7], s18 offen offset:3072 sc1
    s_add_u32 s18, s18, 4096
    buffer_load_dwordx4 a[176:179], v1, s[4:7], s18 offen offset:0 sc1
    buffer_load_dwordx4 a[180:183], v1, s[4:7], s18 offen offset:1024 sc1
    buffer_load_dwordx4 a[184:187], v1, s[4:7], s18 offen offset:2048 sc1
    buffer_load_dwordx4 a[188:191], v1, s[4:7], s18 offen offset:3072 sc1
    s_add_u32 s18, s18, 4096
    buffer_load_dwordx4 a[192:195], v1, s[4:7], s18 offen offset:0 sc1
    buffer_load_dwordx4 a[196:199], v1, s[4:7], s18 offen offset:1024 sc1
    buffer_load_dwordx4 a[200:203], v1, s[4:7], s18 offen offset:2048 sc1
    buffer_load_dwordx4 a[204:207], v1, s[4:7], s18 offen offset:3072 sc1
    s_add_u32 s18, s18, 4096
    buffer_load_dwordx4 a[208:211], v1, s[4:7], s18 offen offset:0 sc1
    buffer_load_dwordx4 a[212:215], v1, s[4:7], s18 offen offset:1024 sc1
    buffer_load_dwordx4 a[216:219], v1, s[4:7], s18 offen offset:2048 sc1
    buffer_load_dwordx4 a[220:223], v1, s[4:7], s18 offen offset:3072 sc1
    s_add_u32 s18, s18, 4096
    buffer_load_dwordx4 a[224:227], v1, s[4:7], s18 offen offset:0 sc1
    buffer_load_dwordx4 a[228:231], v1, s[4:7], s18 offen offset:1024 sc1
    buffer_load_dwordx4 a[232:235], v1, s[4:7], s18 offen offset:2048 sc1
    buffer_load_dwordx4 a[236:239], v1, s[4:7], s18 offen offset:3072 sc1
    s_add_u32 s18, s18, 4096
    buffer_load_dwordx4 a[240:243], v1, s[4:7], s18 offen offset:0 sc1
    buffer_load_dwordx4 a[244:247], v1, s[4:7], s18 offen offset:1024 sc1
    buffer_load_dwordx4 a[248:251], v1, s[4:7], s18 offen offset:2048 sc1
    buffer_load_dwordx4 a[252:255], v1, s[4:7], s18 offen offset:3072 sc1
    s_waitcnt vmcnt(0)
    s_mov_b32 s44, 0
    s_mov_b32 s37, s35
    v_mov_b32 v250, 1
    v_mov_b32 v251, 163832
    v_cmp_eq_u32 vcc, 0, v0
    s_nop 0
    s_and_saveexec_b64 s[38:39], vcc
    s_cbranch_execz tk19
    buffer_atomic_add v250, off, s[84:87], s37 sc0
    s_waitcnt vmcnt(0)
    ds_write_b32 v251, v250
    s_waitcnt lgkmcnt(0)
tk19:
    s_mov_b64 exec, -1
    s_barrier
    ds_read_b32 v252, v251
    s_waitcnt lgkmcnt(0)
    v_readfirstlane_b32 s16, v252
    s_barrier
    s_nop 3
    s_cmp_ge_u32 s16, 72
    s_cbranch_scc1 L_op_nextcb
L_op_seg:
    s_min_u32 s43, s16, 56
    s_add_u32 s16, s16, s43
    s_lshr_b32 s43, s16, 1
    s_add_u32 s43, s43, 2
    s_min_u32 s43, s43, 63
    s_lshl_b32 s94, s33, 7
    s_add_u32 s94, s94, s16
    s_mov_b32 s88, 65536
    s_mov_b32 s89, 125853696
cw20:
    buffer_load_dword v3, off, s[4:7], s89 sc1
    s_waitcnt vmcnt(0)
    v_readfirstlane_b32 s42, v3
    s_nop 0
    s_sub_u32 s42, s42, s95
    s_cmp_gt_u32 s42, 64
    s_cselect_b32 s42, 0, s42
    s_add_u32 s42, s42, 1
    s_cmp_ge_u32 s42, s43
    s_cbranch_scc1 cw20x
    s_sub_u32 s88, s88, 1
    s_cbranch_scc1 cw20x
    s_sub_u32 s42, s43, s42
    s_min_u32 s42, s42, 6
cw20s:
    s_sleep 24
    s_sub_u32 s42, s42, 1
    s_cmp_lg_u32 s42, 0
    s_cbranch_scc1 cw20s
    s_branch cw20
cw20x:
    s_lshr_b32 s89, s16, 1
    s_lshl_b32 s89, s89, 2
    s_add_u32 s89, s89, s32
    s_lshl_b32 s89, s89, 7
    s_add_u32 s89, s89, 125894656
    v_mbcnt_lo_u32_b32 v2, -1, 0
    v_mbcnt_hi_u32_b32 v2, -1, v2
    v_min_u32 v2, 1, v2
    v_lshlrev_b32 v2, 2, v2
    s_mov_b32 s88, 4194304
fw21:
    buffer_load_dword v3, v2, s[4:7], s89 offen offset:0 sc1
    s_sub_u32 s88, s88, 1
    s_cbranch_scc1 fw21x
    s_waitcnt vmcnt(0)
    v_cmp_ne_u32 vcc, s95, v3
    s_cbranch_vccz fw21x
    s_sleep 2
    s_branch fw21
fw21x:
    v_mov_b32 v250, 1
    v_lshrrev_b32 v252, 2, v1
    v_min_u32 v252, 68, v252
    s_cmp_lg_u32 s32, 0
    s_cbranch_scc1 L_op_na
    s_mov_b64 exec, 1
    buffer_atomic_add v250, off, s[84:87], s35 sc0
    s_mov_b64 exec, -1
    s_cmp_lg_u32 s44, 0
    s_cbranch_scc1 L_op_na
    buffer_load_dword v253, v252, s[84:87], 0 offen offset:136 sc1
L_op_na:
    s_cmp_ge_u32 s16, 112
    s_cbranch_scc1 L_op_one
    s_lshl_b32 s18, s16, 17
    s_lshl_b32 s19, s32, 15
    s_add_u32 s18, s18, s19
    s_add_u32 s18, s18, 50331648
    buffer_load_dwordx4 v[24:27], v1, s[4:7], s18 offen offset:0 sc1
    buffer_load_dwordx4 v[28:31], v1, s[4:7], s18 offen offset:1024 sc1
    buffer_load_dwordx4 v[32:35], v1, s[4:7], s18 offen offset:2048 sc1
    buffer_load_dwordx4 v[36:39], v1, s[4:7], s18 offen offset:3072 sc1
    s_add_u32 s18, s18, 4096
    buffer_load_dwordx4 v[40:43], v1, s[4:7], s18 offen offset:0 sc1
    buffer_load_dwordx4 v[44:47], v1, s[4:7], s18 offen offset:1024 sc1
    buffer_load_dwordx4 v[48:51], v1, s[4:7], s18 offen offset:2048 sc1
    buffer_load_dwordx4 v[52:55], v1, s[4:7], s18 offen offset:3072 sc1
    s_add_u32 s18, s18, 4096
    buffer_load_dwordx4 v[56:59], v1, s[4:7], s18 offen offset:0 sc1
    buffer_load_dwordx4 v[60:63], v1, s[4:7], s18 offen offset:1024 sc1
    buffer_load_dwordx4 v[64:67], v1, s[4:7], s18 offen offset:2048 sc1
    buffer_load_dwordx4 v[68:71], v1, s[4:7], s18 offen offset:3072 sc1
    s_add_u32 s18, s18, 4096
    buffer_load_dwordx4 v[72:75], v1, s[4:7], s18 offen offset:0 sc1
    buffer_load_dwordx4 v[76:79], v1, s[4:7], s18 offen offset:1024 sc1
    buffer_load_dwordx4 v[80:83], v1, s[4:7], s18 offen offset:2048 sc1
    buffer_load_dwordx4 v[84:87], v1, s[4:7], s18 offen offset:3072 sc1
    s_add_u32 s18, s18, 4096
    buffer_load_dwordx4 v[88:91], v1, s[4:7], s18 offen offset:0 sc1
    buffer_load_dwordx4 v[92:95], v1, s[4:7], s18 offen offset:1024 sc1
    buffer_load_dwordx4 v[96:99], v1, s[4:7], s18 offen offset:2048 sc1
    buffer_load_dwordx4 v[100:103], v1, s[4:7], s18 offen offset:3072 sc1
    s_add_u32 s18, s18, 4096
    buffer_load_dwordx4 v[104:107], v1, s[4:7], s18 offen offset:0 sc1
    buffer_load_dwordx4 v[108:111], v1, s[4:7], s18 offen offset:1024 sc1
    buffer_load_dwordx4 v[112:115], v1, s[4:7], s18 offen offset:2048 sc1
    buffer_load_dwordx4 v[116:119], v1, s[4:7], s18 offen offset:3072 sc1
    s_add_u32 s18, s18, 4096
    buffer_load_dwordx4 v[120:123], v1, s[4:7], s18 offen offset:0 sc1
    buffer_load_dwordx4 v[124:127], v1, s[4:7], s18 offen offset:1024 sc1
    buffer_load_dwordx4 v[128:131], v1, s[4:7], s18 offen offset:2048 sc1
    buffer_load_dwordx4 v[132:135], v1, s[4:7], s18 offen offset:3072 sc1
    s_add_u32 s18, s18, 4096
    buffer_load_dwordx4 v[136:139], v1, s[4:7], s18 offen offset:0 sc1
    buffer_load_dwordx4 v[140:143], v1, s[4:7], s18 offen offset:1024 sc1
    buffer_load_dwordx4 v[144:147], v1, s[4:7], s18 offen offset:2048 sc1
    buffer_load_dwordx4 v[148:151], v1, s[4:7], s18 offen offset:3072 sc1
    s_add_u32 s18, s18, 102400
    buffer_load_dwordx4 v[152:155], v1, s[4:7], s18 offen offset:0 sc1
    buffer_load_dwordx4 v[156:159], v1, s[4:7], s18 offen offset:1024 sc1
    buffer_load_dwordx4 v[160:163], v1, s[4:7], s18 offen offset:2048 sc1
    buffer_load_dwordx4 v[164:167], v1, s[4:7], s18 offen offset:3072 sc1
    s_add_u32 s18, s18, 4096
    buffer_load_dwordx4 v[168:171], v1, s[4:7], s18 offen offset:0 sc1
    buffer_load_dwordx4 v[172:175], v1, s[4:7], s18 offen offset:1024 sc1
    buffer_load_dwordx4 v[176:179], v1, s[4:7], s18 offen offset:2048 sc1
    buffer_load_dwordx4 v[180:183], v1, s[4:7], s18 offen offset:3072 sc1
    s_add_u32 s18, s18, 4096
    buffer_load_dwordx4 v[184:187], v1, s[4:7], s18 offen offset:0 sc1
    buffer_load_dwordx4 v[188:191], v1, s[4:7], s18 offen offset:1024 sc1
    buffer_load_dwordx4 v[192:195], v1, s[4:7], s18 offen offset:2048 sc1
    buffer_load_dwordx4 v[196:199], v1, s[4:7], s18 offen offset:3072 sc1
    s_add_u32 s18, s18, 4096
    buffer_load_dwordx4 v[200:203], v1, s[4:7], s18 offen offset:0 sc1
    buffer_load_dwordx4 v[204:207], v1, s[4:7], s18 offen offset:1024 sc1
    buffer_load_dwordx4 v[208:211], v1, s[4:7], s18 offen offset:2048 sc1
    buffer_load_dwordx4 v[212:215], v1, s[4:7], s18 offen offset:3072 sc1
    s_add_u32 s18, s18, 4096
    buffer_load_dwordx4 v[216:219], v1, s[4:7], s18 offen offset:0 sc1
    buffer_load_dwordx4 v[220:223], v1, s[4:7], s18 offen offset:1024 sc1
    buffer_load_dwordx4 v[224:227], v1, s[4:7], s18 offen offset:2048 sc1
    buffer_load_dwordx4 v[228:231], v1, s[4:7], s18 offen offset:3072 sc1
    s_add_u32 s18, s18, 4096
    buffer_load_dwordx4 v[232:235], v1, s[4:7], s18 offen offset:0 sc1
    buffer_load_dwordx4 v[236:239], v1, s[4:7], s18 offen offset:1024 sc1
    buffer_load_dwordx4 v[240:243], v1, s[4:7], s18 offen offset:2048 sc1
    buffer_load_dwordx4 v[244:247], v1, s[4:7], s18 offen offset:3072 sc1
    v_lshlrev_b32 v2, 4, v0
    v_and_b32 v3, 3072, v2
    v_lshl_add_u32 v2, v3, 1, v1
    s_waitcnt vmcnt(55)
    v_mfma_f32_16x16x32_bf16 v[8:11], a[0:3], v[24:27], 0
    v_mfma_f32_16x16x32_bf16 v[12:15], a[4:7], v[24:27], 0
    s_add_u32 s18, s18, 4096
    buffer_load_dwordx4 v[24:27], v1, s[4:7], s18 offen offset:0 sc1
    s_waitcnt vmcnt(55)
    v_mfma_f32_16x16x32_bf16 v[8:11], a[8:11], v[28:31], v[8:11]
    v_mfma_f32_16x16x32_bf16 v[12:15], a[12:15], v[28:31], v[12:15]
    buffer_load_dwordx4 v[28:31], v1, s[4:7], s18 offen offset:1024 sc1
    s_waitcnt vmcnt(55)
    v_mfma_f32_16x16x32_bf16 v[8:11], a[16:19], v[32:35], v[8:11]
    v_mfma_f32_16x16x32_bf16 v[12:15], a[20:23], v[32:35], v[12:15]
    buffer_load_dwordx4 v[32:35], v1, s[4:7], s18 offen offset:2048 sc1
    s_waitcnt vmcnt(55)
    v_mfma_f32_16x16x32_bf16 v[8:11], a[24:27], v[36:39], v[8:11]
    v_mfma_f32_16x16x32_bf16 v[12:15], a[28:31], v[36:39], v[12:15]
    buffer_load_dwordx4 v[36:39], v1, s[4:7], s18 offen offset:3072 sc1
    s_waitcnt vmcnt(55)
    v_mfma_f32_16x16x32_bf16 v[8:11], a[32:35], v[40:43], v[8:11]
    v_mfma_f32_16x16x32_bf16 v[12:15], a[36:39], v[40:43], v[12:15]
    s_add_u32 s18, s18, 4096
    buffer_load_dwordx4 v[40:43], v1, s[4:7], s18 offen offset:0 sc1
    s_waitcnt vmcnt(55)
    v_mfma_f32_16x16x32_bf16 v[8:11], a[40:43], v[44:47], v[8:11]
    v_mfma_f32_16x16x32_bf16 v[12:15], a[44:47], v[44:47], v[12:15]
    buffer_load_dwordx4 v[44:47], v1, s[4:7], s18 offen offset:1024 sc1
    s_waitcnt vmcnt(55)
    v_mfma_f32_16x16x32_bf16 v[8:11], a[48:51], v[48:51], v[8:11]
    v_mfma_f32_16x16x32_bf16 v[12:15], a[52:55], v[48:51], v[12:15]
    buffer_load_dwordx4 v[48:51], v1, s[4:7], s18 offen offset:2048 sc1
    s_waitcnt vmcnt(55)
    v_mfma_f32_16x16x32_bf16 v[8:11], a[56:59], v[52:55], v[8:11]
    v_mfma_f32_16x16x32_bf16 v[12:15], a[60:63], v[52:55], v[12:15]
    buffer_load_dwordx4 v[52:55], v1, s[4:7], s18 offen offset:3072 sc1
    s_waitcnt vmcnt(55)
    v_mfma_f32_16x16x32_bf16 v[8:11], a[64:67], v[56:59], v[8:11]
    v_mfma_f32_16x16x32_bf16 v[12:15], a[68:71], v[56:59], v[12:15]
    s_waitcnt vmcnt(54)
    v_mfma_f32_16x16x32_bf16 v[8:11], a[72:75], v[60:63], v[8:11]
    v_mfma_f32_16x16x32_bf16 v[12:15], a[76:79], v[60:63], v[12:15]
    s_waitcnt vmcnt(53)
    v_mfma_f32_16x16x32_bf16 v[8:11], a[80:83], v[64:67], v[8:11]
    v_mfma_f32_16x16x32_bf16 v[12:15], a[84:87], v[64:67], v[12:15]
    s_waitcnt vmcnt(52)
    v_mfma_f32_16x16x32_bf16 v[8:11], a[88:91], v[68:71], v[8:11]
    v_mfma_f32_16x16x32_bf16 v[12:15], a[92:95], v[68:71], v[12:15]
    s_waitcnt vmcnt(51)
    v_mfma_f32_16x16x32_bf16 v[8:11], a[96:99], v[72:75], v[8:11]
    v_mfma_f32_16x16x32_bf16 v[12:15], a[100:103], v[72:75], v[12:15]
    s_waitcnt vmcnt(50)
    v_mfma_f32_16x16x32_bf16 v[8:11], a[104:107], v[76:79], v[8:11]
    v_mfma_f32_16x16x32_bf16 v[12:15], a[108:111], v[76:79], v[12:15]
    s_waitcnt vmcnt(49)
    v_mfma_f32_16x16x32_bf16 v[8:11], a[112:115], v[80:83], v[8:11]
    v_mfma_f32_16x16x32_bf16 v[12:15], a[116:119], v[80:83], v[12:15]
    s_waitcnt vmcnt(48)
    v_mfma_f32_16x16x32_bf16 v[8:11], a[120:123], v[84:87], v[8:11]
    v_mfma_f32_16x16x32_bf16 v[12:15], a[124:127], v[84:87], v[12:15]
    s_waitcnt vmcnt(47)
    v_mfma_f32_16x16x32_bf16 v[8:11], a[128:131], v[88:91], v[8:11]
    v_mfma_f32_16x16x32_bf16 v[12:15], a[132:135], v[88:91], v[12:15]
    s_waitcnt vmcnt(46)
    v_mfma_f32_16x16x32_bf16 v[8:11], a[136:139], v[92:95], v[8:11]
    v_mfma_f32_16x16x32_bf16 v[12:15], a[140:143], v[92:95], v[12:15]
    s_waitcnt vmcnt(45)
    v_mfma_f32_16x16x32_bf16 v[8:11], a[144:147], v[96:99], v[8:11]
    v_mfma_f32_16x16x32_bf16 v[12:15], a[148:151], v[96:99], v[12:15]
    s_waitcnt vmcnt(44)
    v_mfma_f32_16x16x32_bf16 v[8:11], a[152:155], v[100:103], v[8:11]
    v_mfma_f32_16x16x32_bf16 v[12:15], a[156:159], v[100:103], v[12:15]
    s_waitcnt vmcnt(43)
    v_mfma_f32_16x16x32_bf16 v[8:11], a[160:163], v[104:107], v[8:11]
    v_mfma_f32_16x16x32_bf16 v[12:15], a[164:167], v[104:107], v[12:15]
    s_waitcnt vmcnt(42)
    v_mfma_f32_16x16x32_bf16 v[8:11], a[168:171], v[108:111], v[8:11]
    v_mfma_f32_16x16x32_bf16 v[12:15], a[172:175], v[108:111], v[12:15]
    s_waitcnt vmcnt(41)
    v_mfma_f32_16x16x32_bf16 v[8:11], a[176:179], v[112:115], v[8:11]
    v_mfma_f32_16x16x32_bf16 v[12:15], a[180:183], v[112:115], v[12:15]
    s_waitcnt vmcnt(40)
    v_mfma_f32_16x16x32_bf16 v[8:11], a[184:187], v[116:119], v[8:11]
    v_mfma_f32_16x16x32_bf16 v[12:15], a[188:191], v[116:119], v[12:15]
    s_waitcnt vmcnt(39)
    v_mfma_f32_16x16x32_bf16 v[8:11], a[192:195], v[120:123], v[8:11]
    v_mfma_f32_16x16x32_bf16 v[12:15], a[196:199], v[120:123], v[12:15]
    s_waitcnt vmcnt(38)
    v_mfma_f32_16x16x32_bf16 v[8:11], a[200:203], v[124:127], v[8:11]
    v_mfma_f32_16x16x32_bf16 v[12:15], a[204:207], v[124:127], v[12:15]
    s_waitcnt vmcnt(37)
    v_mfma_f32_16x16x32_bf16 v[8:11], a[208:211], v[128:131], v[8:11]
    v_mfma_f32_16x16x32_bf16 v[12:15], a[212:215], v[128:131], v[12:15]
    s_waitcnt vmcnt(36)
    v_mfma_f32_16x16x32_bf16 v[8:11], a[216:219], v[132:135], v[8:11]
    v_mfma_f32_16x16x32_bf16 v[12:15], a[220:223], v[132:135], v[12:15]
    s_waitcnt vmcnt(35)
    v_mfma_f32_16x16x32_bf16 v[8:11], a[224:227], v[136:139], v[8:11]
    v_mfma_f32_16x16x32_bf16 v[12:15], a[228:231], v[136:139], v[12:15]
    s_waitcnt vmcnt(34)
    v_mfma_f32_16x16x32_bf16 v[8:11], a[232:235], v[140:143], v[8:11]
    v_mfma_f32_16x16x32_bf16 v[12:15], a[236:239], v[140:143], v[12:15]
    s_waitcnt vmcnt(33)
    v_mfma_f32_16x16x32_bf16 v[8:11], a[240:243], v[144:147], v[8:11]
    v_mfma_f32_16x16x32_bf16 v[12:15], a[244:247], v[144:147], v[12:15]
    s_waitcnt vmcnt(32)
    v_mfma_f32_16x16x32_bf16 v[8:11], a[248:251], v[148:151], v[8:11]
    v_mfma_f32_16x16x32_bf16 v[12:15], a[252:255], v[148:151], v[12:15]
    s_waitcnt vmcnt(31)
    v_mfma_f32_16x16x32_bf16 v[16:19], a[0:3], v[152:155], 0
    v_mfma_f32_16x16x32_bf16 v[20:23], a[4:7], v[152:155], 0
    s_waitcnt vmcnt(30)
    v_mfma_f32_16x16x32_bf16 v[16:19], a[8:11], v[156:159], v[16:19]
    v_mfma_f32_16x16x32_bf16 v[20:23], a[12:15], v[156:159], v[20:23]
    s_waitcnt vmcnt(29)
    v_mfma_f32_16x16x32_bf16 v[16:19], a[16:19], v[160:163], v[16:19]
    v_mfma_f32_16x16x32_bf16 v[20:23], a[20:23], v[160:163], v[20:23]
    s_waitcnt vmcnt(28)
    v_mfma_f32_16x16x32_bf16 v[16:19], a[24:27], v[164:167], v[16:19]
    v_mfma_f32_16x16x32_bf16 v[20:23], a[28:31], v[164:167], v[20:23]
    s_waitcnt vmcnt(27)
    v_mfma_f32_16x16x32_bf16 v[16:19], a[32:35], v[168:171], v[16:19]
    v_mfma_f32_16x16x32_bf16 v[20:23], a[36:39], v[168:171], v[20:23]
    s_waitcnt vmcnt(26)
    v_mfma_f32_16x16x32_bf16 v[16:19], a[40:43], v[172:175], v[16:19]
    v_mfma_f32_16x16x32_bf16 v[20:23], a[44:47], v[172:175], v[20:23]
    s_waitcnt vmcnt(25)
    v_mfma_f32_16x16x32_bf16 v[16:19], a[48:51], v[176:179], v[16:19]
    v_mfma_f32_16x16x32_bf16 v[20:23], a[52:55], v[176:179], v[20:23]
    s_waitcnt vmcnt(24)
    v_mfma_f32_16x16x32_bf16 v[16:19], a[56:59], v[180:183], v[16:19]
    v_mfma_f32_16x16x32_bf16 v[20:23], a[60:63], v[180:183], v[20:23]
    s_waitcnt vmcnt(23)
    v_mfma_f32_16x16x32_bf16 v[16:19], a[64:67], v[184:187], v[16:19]
    v_mfma_f32_16x16x32_bf16 v[20:23], a[68:71], v[184:187], v[20:23]
    s_waitcnt vmcnt(22)
    v_mfma_f32_16x16x32_bf16 v[16:19], a[72:75], v[188:191], v[16:19]
    v_mfma_f32_16x16x32_bf16 v[20:23], a[76:79], v[188:191], v[20:23]
    s_waitcnt vmcnt(21)
    v_mfma_f32_16x16x32_bf16 v[16:19], a[80:83], v[192:195], v[16:19]
    v_mfma_f32_16x16x32_bf16 v[20:23], a[84:87], v[192:195], v[20:23]
    s_waitcnt vmcnt(20)
    v_mfma_f32_16x16x32_bf16 v[16:19], a[88:91], v[196:199], v[16:19]
    v_mfma_f32_16x16x32_bf16 v[20:23], a[92:95], v[196:199], v[20:23]
    s_waitcnt vmcnt(19)
    v_mfma_f32_16x16x32_bf16 v[16:19], a[96:99], v[200:203], v[16:19]
    v_mfma_f32_16x16x32_bf16 v[20:23], a[100:103], v[200:203], v[20:23]
    s_waitcnt vmcnt(18)
    v_mfma_f32_16x16x32_bf16 v[16:19], a[104:107], v[204:207], v[16:19]
    v_mfma_f32_16x16x32_bf16 v[20:23], a[108:111], v[204:207], v[20:23]
    s_waitcnt vmcnt(17)
    v_mfma_f32_16x16x32_bf16 v[16:19], a[112:115], v[208:211], v[16:19]
    v_mfma_f32_16x16x32_bf16 v[20:23], a[116:119], v[208:211], v[20:23]
    s_waitcnt vmcnt(16)
    v_mfma_f32_16x16x32_bf16 v[16:19], a[120:123], v[212:215], v[16:19]
    v_mfma_f32_16x16x32_bf16 v[20:23], a[124:127], v[212:215], v[20:23]
    s_waitcnt vmcnt(15)
    v_mfma_f32_16x16x32_bf16 v[16:19], a[128:131], v[216:219], v[16:19]
    v_mfma_f32_16x16x32_bf16 v[20:23], a[132:135], v[216:219], v[20:23]
    s_waitcnt vmcnt(14)
    v_mfma_f32_16x16x32_bf16 v[16:19], a[136:139], v[220:223], v[16:19]
    v_mfma_f32_16x16x32_bf16 v[20:23], a[140:143], v[220:223], v[20:23]
    s_waitcnt vmcnt(13)
    v_mfma_f32_16x16x32_bf16 v[16:19], a[144:147], v[224:227], v[16:19]
    v_mfma_f32_16x16x32_bf16 v[20:23], a[148:151], v[224:227], v[20:23]
    s_waitcnt vmcnt(12)
    v_mfma_f32_16x16x32_bf16 v[16:19], a[152:155], v[228:231], v[16:19]
    v_mfma_f32_16x16x32_bf16 v[20:23], a[156:159], v[228:231], v[20:23]
    s_waitcnt vmcnt(11)
    v_mfma_f32_16x16x32_bf16 v[16:19], a[160:163], v[232:235], v[16:19]
    v_mfma_f32_16x16x32_bf16 v[20:23], a[164:167], v[232:235], v[20:23]
    s_waitcnt vmcnt(10)
    v_mfma_f32_16x16x32_bf16 v[16:19], a[168:171], v[236:239], v[16:19]
    v_mfma_f32_16x16x32_bf16 v[20:23], a[172:175], v[236:239], v[20:23]
    s_waitcnt vmcnt(9)
    v_mfma_f32_16x16x32_bf16 v[16:19], a[176:179], v[240:243], v[16:19]
    v_mfma_f32_16x16x32_bf16 v[20:23], a[180:183], v[240:243], v[20:23]
    s_waitcnt vmcnt(8)
    v_mfma_f32_16x16x32_bf16 v[16:19], a[184:187], v[244:247], v[16:19]
    v_mfma_f32_16x16x32_bf16 v[20:23], a[188:191], v[244:247], v[20:23]
    s_waitcnt vmcnt(7)
    v_mfma_f32_16x16x32_bf16 v[16:19], a[192:195], v[24:27], v[16:19]
    v_mfma_f32_16x16x32_bf16 v[20:23], a[196:199], v[24:27], v[20:23]
    s_waitcnt vmcnt(6)
    v_mfma_f32_16x16x32_bf16 v[16:19], a[200:203], v[28:31], v[16:19]
    v_mfma_f32_16x16x32_bf16 v[20:23], a[204:207], v[28:31], v[20:23]
    s_waitcnt vmcnt(5)
    v_mfma_f32_16x16x32_bf16 v[16:19], a[208:211], v[32:35], v[16:19]
    v_mfma_f32_16x16x32_bf16 v[20:23], a[212:215], v[32:35], v[20:23]
    s_waitcnt vmcnt(4)
    v_mfma_f32_16x16x32_bf16 v[16:19], a[216:219], v[36:39], v[16:19]
    v_mfma_f32_16x16x32_bf16 v[20:23], a[220:223], v[36:39], v[20:23]
    s_waitcnt vmcnt(3)
    v_mfma_f32_16x16x32_bf16 v[16:19], a[224:227], v[40:43], v[16:19]
    v_mfma_f32_16x16x32_bf16 v[20:23], a[228:231], v[40:43], v[20:23]
    s_waitcnt vmcnt(2)
    v_mfma_f32_16x16x32_bf16 v[16:19], a[232:235], v[44:47], v[16:19]
    v_mfma_f32_16x16x32_bf16 v[20:23], a[236:239], v[44:47], v[20:23]
    s_waitcnt vmcnt(1)
    v_mfma_f32_16x16x32_bf16 v[16:19], a[240:243], v[48:51], v[16:19]
    v_mfma_f32_16x16x32_bf16 v[20:23], a[244:247], v[48:51], v[20:23]
    s_waitcnt vmcnt(0)
    v_mfma_f32_16x16x32_bf16 v[16:19], a[248:251], v[52:55], v[16:19]
    v_mfma_f32_16x16x32_bf16 v[20:23], a[252:255], v[52:55], v[20:23]
    ds_write_b128 v2, v[8:11] offset:0
    ds_write_b128 v2, v[12:15] offset:1024
    s_nop 4
    ds_write_b128 v2, v[16:19] offset:8192
    ds_write_b128 v2, v[20:23] offset:9216
    s_cmp_lg_u32 s32, 0
    s_cbranch_scc1 o2_nb
    v_cmp_eq_u32 vcc, 0, v253
    s_nop 0
    s_cmp_eq_u64 vcc, 0
    s_cselect_b32 s44, 65536, 0
    v_or_b32 v250, s44, v250
    v_mov_b32 v251, 163832
    s_mov_b64 exec, 1
    ds_write_b32 v251, v250
    s_mov_b64 exec, -1
o2_nb:
    s_waitcnt lgkmcnt(0)
    s_barrier
    s_cmp_gt_u32 s32, 1
    s_cbranch_scc1 o2_skip
    s_lshl_b32 s18, s32, 13
    v_add_u32 v2, s18, v1
    ds_read_b128 v[24:27], v2 offset:0
    ds_read_b128 v[28:31], v2 offset:1024
    ds_read_b128 v[32:35], v2 offset:2048
    ds_read_b128 v[36:39], v2 offset:3072
    ds_read_b128 v[40:43], v2 offset:4096
    ds_read_b128 v[44:47], v2 offset:5120
    ds_read_b128 v[48:51], v2 offset:6144
    ds_read_b128 v[52:55], v2 offset:7168
    v_lshrrev_b32 v3, 4, v1
    v_bfe_u32 v4, v3, 2, 2
    v_lshlrev_b32 v4, 3, v4
    v_and_b32 v2, 3, v3
    v_add_u32 v4, v4, v2
    v_mul_u32_u24 v4, 2304, v4
    v_lshrrev_b32 v3, 4, v3
    v_lshl_add_u32 v4, v3, 4, v4
    s_add_u32 s20, s16, s32
    s_lshr_b32 s18, s20, 1
    s_lshl_b32 s18, s18, 3
    s_and_b32 s19, s20, 1
    s_add_u32 s18, s18, s19
    s_mul_i32 s18, s18, 9216
    s_lshl_b32 s19, s33, 6
    s_add_u32 s18, s18, s19
    s_waitcnt lgkmcnt(0)
    v_pk_add_f32 v[24:25], v[24:25], v[32:33]
    v_pk_add_f32 v[40:41], v[40:41], v[48:49]
    v_pk_add_f32 v[24:25], v[24:25], v[40:41]
    v_pk_add_f32 v[26:27], v[26:27], v[34:35]
    v_pk_add_f32 v[42:43], v[42:43], v[50:51]
    v_pk_add_f32 v[26:27], v[26:27], v[42:43]
    v_pk_add_f32 v[28:29], v[28:29], v[36:37]
    v_pk_add_f32 v[44:45], v[44:45], v[52:53]
    v_pk_add_f32 v[28:29], v[28:29], v[44:45]
    v_pk_add_f32 v[30:31], v[30:31], v[38:39]
    v_pk_add_f32 v[46:47], v[46:47], v[54:55]
    v_pk_add_f32 v[30:31], v[30:31], v[46:47]
    v_cvt_pk_bf16_f32 v8, v24, v28
    v_cvt_pk_bf16_f32 v9, v25, v29
    v_cvt_pk_bf16_f32 v10, v26, v30
    v_cvt_pk_bf16_f32 v11, v27, v31
    buffer_store_dwordx4 v[8:11], v4, s[8:11], s18 offen
o2_skip:
    s_nop 1
    s_branch L_op_fin
L_op_one:
    s_lshl_b32 s18, s16, 17
    s_lshl_b32 s19, s32, 15
    s_add_u32 s18, s18, s19
    s_add_u32 s18, s18, 50331648
    buffer_load_dwordx4 v[24:27], v1, s[4:7], s18 offen offset:0 sc1
    buffer_load_dwordx4 v[28:31], v1, s[4:7], s18 offen offset:1024 sc1
    buffer_load_dwordx4 v[32:35], v1, s[4:7], s18 offen offset:2048 sc1
    buffer_load_dwordx4 v[36:39], v1, s[4:7], s18 offen offset:3072 sc1
    s_add_u32 s18, s18, 4096
    buffer_load_dwordx4 v[40:43], v1, s[4:7], s18 offen offset:0 sc1
    buffer_load_dwordx4 v[44:47], v1, s[4:7], s18 offen offset:1024 sc1
    buffer_load_dwordx4 v[48:51], v1, s[4:7], s18 offen offset:2048 sc1
    buffer_load_dwordx4 v[52:55], v1, s[4:7], s18 offen offset:3072 sc1
    s_add_u32 s18, s18, 4096
    buffer_load_dwordx4 v[56:59], v1, s[4:7], s18 offen offset:0 sc1
    buffer_load_dwordx4 v[60:63], v1, s[4:7], s18 offen offset:1024 sc1
    buffer_load_dwordx4 v[64:67], v1, s[4:7], s18 offen offset:2048 sc1
    buffer_load_dwordx4 v[68:71], v1, s[4:7], s18 offen offset:3072 sc1
    s_add_u32 s18, s18, 4096
    buffer_load_dwordx4 v[72:75], v1, s[4:7], s18 offen offset:0 sc1
    buffer_load_dwordx4 v[76:79], v1, s[4:7], s18 offen offset:1024 sc1
    buffer_load_dwordx4 v[80:83], v1, s[4:7], s18 offen offset:2048 sc1
    buffer_load_dwordx4 v[84:87], v1, s[4:7], s18 offen offset:3072 sc1
    s_add_u32 s18, s18, 4096
    buffer_load_dwordx4 v[88:91], v1, s[4:7], s18 offen offset:0 sc1
    buffer_load_dwordx4 v[92:95], v1, s[4:7], s18 offen offset:1024 sc1
    buffer_load_dwordx4 v[96:99], v1, s[4:7], s18 offen offset:2048 sc1
    buffer_load_dwordx4 v[100:103], v1, s[4:7], s18 offen offset:3072 sc1
    s_add_u32 s18, s18, 4096
    buffer_load_dwordx4 v[104:107], v1, s[4:7], s18 offen offset:0 sc1
    buffer_load_dwordx4 v[108:111], v1, s[4:7], s18 offen offset:1024 sc1
    buffer_load_dwordx4 v[112:115], v1, s[4:7], s18 offen offset:2048 sc1
    buffer_load_dwordx4 v[116:119], v1, s[4:7], s18 offen offset:3072 sc1
    s_add_u32 s18, s18, 4096
    buffer_load_dwordx4 v[120:123], v1, s[4:7], s18 offen offset:0 sc1
    buffer_load_dwordx4 v[124:127], v1, s[4:7], s18 offen offset:1024 sc1
    buffer_load_dwordx4 v[128:131], v1, s[4:7], s18 offen offset:2048 sc1
    buffer_load_dwordx4 v[132:135], v1, s[4:7], s18 offen offset:3072 sc1
    s_add_u32 s18, s18, 4096
    buffer_load_dwordx4 v[136:139], v1, s[4:7], s18 offen offset:0 sc1
    buffer_load_dwordx4 v[140:143], v1, s[4:7], s18 offen offset:1024 sc1
    buffer_load_dwordx4 v[144:147], v1, s[4:7], s18 offen offset:2048 sc1
    buffer_load_dwordx4 v[148:151], v1, s[4:7], s18 offen offset:3072 sc1
    v_lshlrev_b32 v2, 4, v0
    v_and_b32 v3, 3072, v2
    v_lshl_add_u32 v2, v3, 1, v1
    s_waitcnt vmcnt(31)
    v_mfma_f32_16x16x32_bf16 v[8:11], a[0:3], v[24:27], 0
    v_mfma_f32_16x16x32_bf16 v[12:15], a[4:7], v[24:27], 0
    s_waitcnt vmcnt(30)
    v_mfma_f32_16x16x32_bf16 v[8:11], a[8:11], v[28:31], v[8:11]
    v_mfma_f32_16x16x32_bf16 v[12:15], a[12:15], v[28:31], v[12:15]
    s_waitcnt vmcnt(29)
    v_mfma_f32_16x16x32_bf16 v[8:11], a[16:19], v[32:35], v[8:11]
    v_mfma_f32_16x16x32_bf16 v[12:15], a[20:23], v[32:35], v[12:15]
    s_waitcnt vmcnt(28)
    v_mfma_f32_16x16x32_bf16 v[8:11], a[24:27], v[36:39], v[8:11]
    v_mfma_f32_16x16x32_bf16 v[12:15], a[28:31], v[36:39], v[12:15]
    s_waitcnt vmcnt(27)
    v_mfma_f32_16x16x32_bf16 v[8:11], a[32:35], v[40:43], v[8:11]
    v_mfma_f32_16x16x32_bf16 v[12:15], a[36:39], v[40:43], v[12:15]
    s_waitcnt vmcnt(26)
    v_mfma_f32_16x16x32_bf16 v[8:11], a[40:43], v[44:47], v[8:11]
    v_mfma_f32_16x16x32_bf16 v[12:15], a[44:47], v[44:47], v[12:15]
    s_waitcnt vmcnt(25)
    v_mfma_f32_16x16x32_bf16 v[8:11], a[48:51], v[48:51], v[8:11]
    v_mfma_f32_16x16x32_bf16 v[12:15], a[52:55], v[48:51], v[12:15]
    s_waitcnt vmcnt(24)
    v_mfma_f32_16x16x32_bf16 v[8:11], a[56:59], v[52:55], v[8:11]
    v_mfma_f32_16x16x32_bf16 v[12:15], a[60:63], v[52:55], v[12:15]
    s_waitcnt vmcnt(23)
    v_mfma_f32_16x16x32_bf16 v[8:11], a[64:67], v[56:59], v[8:11]
    v_mfma_f32_16x16x32_bf16 v[12:15], a[68:71], v[56:59], v[12:15]
    s_waitcnt vmcnt(22)
    v_mfma_f32_16x16x32_bf16 v[8:11], a[72:75], v[60:63], v[8:11]
    v_mfma_f32_16x16x32_bf16 v[12:15], a[76:79], v[60:63], v[12:15]
    s_waitcnt vmcnt(21)
    v_mfma_f32_16x16x32_bf16 v[8:11], a[80:83], v[64:67], v[8:11]
    v_mfma_f32_16x16x32_bf16 v[12:15], a[84:87], v[64:67], v[12:15]
    s_waitcnt vmcnt(20)
    v_mfma_f32_16x16x32_bf16 v[8:11], a[88:91], v[68:71], v[8:11]
    v_mfma_f32_16x16x32_bf16 v[12:15], a[92:95], v[68:71], v[12:15]
    s_waitcnt vmcnt(19)
    v_mfma_f32_16x16x32_bf16 v[8:11], a[96:99], v[72:75], v[8:11]
    v_mfma_f32_16x16x32_bf16 v[12:15], a[100:103], v[72:75], v[12:15]
    s_waitcnt vmcnt(18)
    v_mfma_f32_16x16x32_bf16 v[8:11], a[104:107], v[76:79], v[8:11]
    v_mfma_f32_16x16x32_bf16 v[12:15], a[108:111], v[76:79], v[12:15]
    s_waitcnt vmcnt(17)
    v_mfma_f32_16x16x32_bf16 v[8:11], a[112:115], v[80:83], v[8:11]
    v_mfma_f32_16x16x32_bf16 v[12:15], a[116:119], v[80:83], v[12:15]
    s_waitcnt vmcnt(16)
    v_mfma_f32_16x16x32_bf16 v[8:11], a[120:123], v[84:87], v[8:11]
    v_mfma_f32_16x16x32_bf16 v[12:15], a[124:127], v[84:87], v[12:15]
    s_waitcnt vmcnt(15)
    v_mfma_f32_16x16x32_bf16 v[8:11], a[128:131], v[88:91], v[8:11]
    v_mfma_f32_16x16x32_bf16 v[12:15], a[132:135], v[88:91], v[12:15]
    s_waitcnt vmcnt(14)
    v_mfma_f32_16x16x32_bf16 v[8:11], a[136:139], v[92:95], v[8:11]
    v_mfma_f32_16x16x32_bf16 v[12:15], a[140:143], v[92:95], v[12:15]
    s_waitcnt vmcnt(13)
    v_mfma_f32_16x16x32_bf16 v[8:11], a[144:147], v[96:99], v[8:11]
    v_mfma_f32_16x16x32_bf16 v[12:15], a[148:151], v[96:99], v[12:15]
    s_waitcnt vmcnt(12)
    v_mfma_f32_16x16x32_bf16 v[8:11], a[152:155], v[100:103], v[8:11]
    v_mfma_f32_16x16x32_bf16 v[12:15], a[156:159], v[100:103], v[12:15]
    s_waitcnt vmcnt(11)
    v_mfma_f32_16x16x32_bf16 v[8:11], a[160:163], v[104:107], v[8:11]
    v_mfma_f32_16x16x32_bf16 v[12:15], a[164:167], v[104:107], v[12:15]
    s_waitcnt vmcnt(10)
    v_mfma_f32_16x16x32_bf16 v[8:11], a[168:171], v[108:111], v[8:11]
    v_mfma_f32_16x16x32_bf16 v[12:15], a[172:175], v[108:111], v[12:15]
    s_waitcnt vmcnt(9)
    v_mfma_f32_16x16x32_bf16 v[8:11], a[176:179], v[112:115], v[8:11]
    v_mfma_f32_16x16x32_bf16 v[12:15], a[180:183], v[112:115], v[12:15]
    s_waitcnt vmcnt(8)
    v_mfma_f32_16x16x32_bf16 v[8:11], a[184:187], v[116:119], v[8:11]
    v_mfma_f32_16x16x32_bf16 v[12:15], a[188:191], v[116:119], v[12:15]
    s_waitcnt vmcnt(7)
    v_mfma_f32_16x16x32_bf16 v[8:11], a[192:195], v[120:123], v[8:11]
    v_mfma_f32_16x16x32_bf16 v[12:15], a[196:199], v[120:123], v[12:15]
    s_waitcnt vmcnt(6)
    v_mfma_f32_16x16x32_bf16 v[8:11], a[200:203], v[124:127], v[8:11]
    v_mfma_f32_16x16x32_bf16 v[12:15], a[204:207], v[124:127], v[12:15]
    s_waitcnt vmcnt(5)
    v_mfma_f32_16x16x32_bf16 v[8:11], a[208:211], v[128:131], v[8:11]
    v_mfma_f32_16x16x32_bf16 v[12:15], a[212:215], v[128:131], v[12:15]
    s_waitcnt vmcnt(4)
    v_mfma_f32_16x16x32_bf16 v[8:11], a[216:219], v[132:135], v[8:11]
    v_mfma_f32_16x16x32_bf16 v[12:15], a[220:223], v[132:135], v[12:15]
    s_waitcnt vmcnt(3)
    v_mfma_f32_16x16x32_bf16 v[8:11], a[224:227], v[136:139], v[8:11]
    v_mfma_f32_16x16x32_bf16 v[12:15], a[228:231], v[136:139], v[12:15]
    s_waitcnt vmcnt(2)
    v_mfma_f32_16x16x32_bf16 v[8:11], a[232:235], v[140:143], v[8:11]
    v_mfma_f32_16x16x32_bf16 v[12:15], a[236:239], v[140:143], v[12:15]
    s_waitcnt vmcnt(1)
    v_mfma_f32_16x16x32_bf16 v[8:11], a[240:243], v[144:147], v[8:11]
    v_mfma_f32_16x16x32_bf16 v[12:15], a[244:247], v[144:147], v[12:15]
    s_waitcnt vmcnt(0)
    v_mfma_f32_16x16x32_bf16 v[8:11], a[248:251], v[148:151], v[8:11]
    v_mfma_f32_16x16x32_bf16 v[12:15], a[252:255], v[148:151], v[12:15]
    s_nop 6
    ds_write_b128 v2, v[8:11] offset:0
    ds_write_b128 v2, v[12:15] offset:1024
    s_cmp_lg_u32 s32, 0
    s_cbranch_scc1 o1_nb
    v_cmp_eq_u32 vcc, 0, v253
    s_nop 0
    s_cmp_eq_u64 vcc, 0
    s_cselect_b32 s44, 65536, 0
    v_or_b32 v250, s44, v250
    v_mov_b32 v251, 163832
    s_mov_b64 exec, 1
    ds_write_b32 v251, v250
    s_mov_b64 exec, -1
o1_nb:
    s_waitcnt lgkmcnt(0)
    s_barrier
    s_cmp_gt_u32 s32, 0
    s_cbranch_scc1 o1_skip
    s_lshl_b32 s18, s32, 13
    v_add_u32 v2, s18, v1
    ds_read_b128 v[24:27], v2 offset:0
    ds_read_b128 v[28:31], v2 offset:1024
    ds_read_b128 v[32:35], v2 offset:2048
    ds_read_b128 v[36:39], v2 offset:3072
    ds_read_b128 v[40:43], v2 offset:4096
    ds_read_b128 v[44:47], v2 offset:5120
    ds_read_b128 v[48:51], v2 offset:6144
    ds_read_b128 v[52:55], v2 offset:7168
    v_lshrrev_b32 v3, 4, v1
    v_bfe_u32 v4, v3, 2, 2
    v_lshlrev_b32 v4, 3, v4
    v_and_b32 v2, 3, v3
    v_add_u32 v4, v4, v2
    v_mul_u32_u24 v4, 2304, v4
    v_lshrrev_b32 v3, 4, v3
    v_lshl_add_u32 v4, v3, 4, v4
    s_add_u32 s20, s16, s32
    s_lshr_b32 s18, s20, 1
    s_lshl_b32 s18, s18, 3
    s_and_b32 s19, s20, 1
    s_add_u32 s18, s18, s19
    s_mul_i32 s18, s18, 9216
    s_lshl_b32 s19, s33, 6
    s_add_u32 s18, s18, s19
    s_waitcnt lgkmcnt(0)
    v_pk_add_f32 v[24:25], v[24:25], v[32:33]
    v_pk_add_f32 v[40:41], v[40:41], v[48:49]
    v_pk_add_f32 v[24:25], v[24:25], v[40:41]
    v_pk_add_f32 v[26:27], v[26:27], v[34:35]
    v_pk_add_f32 v[42:43], v[42:43], v[50:51]
    v_pk_add_f32 v[26:27], v[26:27], v[42:43]
    v_pk_add_f32 v[28:29], v[28:29], v[36:37]
    v_pk_add_f32 v[44:45], v[44:45], v[52:53]
    v_pk_add_f32 v[28:29], v[28:29], v[44:45]
    v_pk_add_f32 v[30:31], v[30:31], v[38:39]
    v_pk_add_f32 v[46:47], v[46:47], v[54:55]
    v_pk_add_f32 v[30:31], v[30:31], v[46:47]
    v_cvt_pk_bf16_f32 v8, v24, v28
    v_cvt_pk_bf16_f32 v9, v25, v29
    v_cvt_pk_bf16_f32 v10, v26, v30
    v_cvt_pk_bf16_f32 v11, v27, v31
    buffer_store_dwordx4 v[8:11], v4, s[8:11], s18 offen
o1_skip:
    s_nop 1
L_op_fin:
    v_mov_b32 v251, 163832
    ds_read_b32 v252, v251
    s_waitcnt lgkmcnt(0)
    v_readfirstlane_b32 s40, v252
    s_nop 1
    s_cmp_ge_u32 s40, 65608
    s_cbranch_scc1 L_done
    s_barrier
    s_and_b32 s16, s40, 0xffff
    s_cmp_lt_u32 s16, 72
    s_cbranch_scc1 L_op_seg
L_op_nextcb:
    s_mov_b32 s40, -1
    s_cmp_lg_u32 s32, 0
    s_cbranch_scc1 L_op_dec
    v_and_b32 v1, 63, v0
    v_min_u32 v1, 17, v1
    v_lshlrev_b32 v2, 2, v1
    buffer_load_dword v3, v2, s[84:87], 0 offen offset:136 sc1
    s_waitcnt vmcnt(0)
    v_cmp_gt_u32 vcc, 52, v3
    s_nop 0
    s_and_b32 s40, vcc_lo, 262143
    s_lshl_b32 s41, s40, 18
    s_lshr_b32 s43, s40, 14
    s_or_b32 s42, s40, s41
    s_and_b32 s36, s45, 15
    s_bfm_b32 s37, s36, 0
    s_and_b32 s37, s37, 42315
    s_bcnt1_i32_b32 s37, s37
    s_lshr_b32 s36, s45, 4
    s_mul_i32 s36, s36, 8
    s_add_u32 s36, s36, s37
    s_add_u32 s36, s36, 38
    s_mul_hi_u32 s41, s36, 0x0e38e38f
    s_mul_i32 s41, s41, 18
    s_sub_u32 s41, s36, s41
    s_lshr_b64 s[42:43], s[42:43], s41
    s_ff1_i32_b64 s40, s[42:43]
    s_cmp_lt_i32 s40, 0
    s_cbranch_scc1 L_op_dec
    s_add_u32 s40, s40, s41
    s_sub_u32 s41, s40, 18
    s_cselect_b32 s40, s40, s41
L_op_dec:
    v_mov_b32 v250, s40
    v_mov_b32 v251, 163832
    s_cmp_lg_u32 s32, 0
    s_cbranch_scc1 L_op_nw
    ds_write_b32 v251, v250
    s_waitcnt lgkmcnt(0)
L_op_nw:
    s_barrier
    ds_read_b32 v252, v251
    s_waitcnt lgkmcnt(0)
    v_readfirstlane_b32 s33, v252
    s_barrier
    s_nop 1
    s_cmp_lt_u32 s33, 18
    s_cbranch_scc1 L_op_start
L_done:
L_exit:
    s_endpgm
.section .rodata,"a"
.p2align 6
.amdhsa_kernel concat_heads__memory_aug_recurrent_mem_tr__ssm_conv_s4d__prompt_kernel
  .amdhsa_next_free_vgpr 512
  .amdhsa_next_free_sgpr 102
  .amdhsa_accum_offset 256
  .amdhsa_group_segment_fixed_size 0
  .amdhsa_kernarg_size 136
  .amdhsa_user_sgpr_count 2
  .amdhsa_user_sgpr_kernarg_segment_ptr 1
  .amdhsa_system_sgpr_workgroup_id_x 1
.end_amdhsa_kernel
.text
```

```asm
; @launch grid=(256,1,1) block=(256,1,1) lds=163840
.amdgcn_target "amdgcn-amd-amdhsa--gfx950"
.text
.globl concat_heads__memory_aug_recurrent_mem_tr__ssm_conv_s4d__prompt_kernel
.p2align 8
.type concat_heads__memory_aug_recurrent_mem_tr__ssm_conv_s4d__prompt_kernel,@function
concat_heads__memory_aug_recurrent_mem_tr__ssm_conv_s4d__prompt_kernel:
    s_cmp_ge_u32 s2, 256
    s_cbranch_scc1 L_exit
    s_load_dwordx4 s[80:83], s[0:1], 120
    s_load_dwordx16 s[48:63], s[0:1], 0
    s_memrealtime s[90:91]
    v_lshrrev_b32 v1, 6, v0
    s_nop 0
    v_readfirstlane_b32 s32, v1
    s_waitcnt lgkmcnt(0)
    s_mov_b32 s4, s82
    s_mov_b32 s5, s83
    s_mov_b32 s6, 268435456
    s_mov_b32 s7, 0x20000
    s_mov_b32 s84, s80
    s_mov_b32 s85, s81
    s_mov_b32 s86, 256
    s_mov_b32 s87, 0x20000
    s_cmp_lg_u32 s32, 0
    s_cbranch_scc1 L_nod0
L_nod0:
    s_cmp_lg_u32 s32, 3
    s_cbranch_scc1 L_nowarm
    s_getpc_b64 s[44:45]
L_pcw:
    v_and_b32 v1, 63, v0
    v_lshlrev_b32 v1, 7, v1
    v_min_u32 v2, L_exit-L_pcw, v1
    global_load_dword v240, v2, s[44:45]
    v_add_u32 v1, 8192, v1
    v_min_u32 v2, L_exit-L_pcw, v1
    global_load_dword v241, v2, s[44:45]
    v_add_u32 v1, 8192, v1
    v_min_u32 v2, L_exit-L_pcw, v1
    global_load_dword v242, v2, s[44:45]
    v_add_u32 v1, 8192, v1
    v_min_u32 v2, L_exit-L_pcw, v1
    global_load_dword v243, v2, s[44:45]
    v_add_u32 v1, 8192, v1
    v_min_u32 v2, L_exit-L_pcw, v1
    global_load_dword v244, v2, s[44:45]
    v_add_u32 v1, 8192, v1
    v_min_u32 v2, L_exit-L_pcw, v1
    global_load_dword v245, v2, s[44:45]
    v_add_u32 v1, 8192, v1
    v_min_u32 v2, L_exit-L_pcw, v1
    global_load_dword v246, v2, s[44:45]
    v_add_u32 v1, 8192, v1
    v_min_u32 v2, L_exit-L_pcw, v1
    global_load_dword v247, v2, s[44:45]
    v_add_u32 v1, 8192, v1
    v_min_u32 v2, L_exit-L_pcw, v1
    global_load_dword v248, v2, s[44:45]
    v_add_u32 v1, 8192, v1
L_nowarm:
    s_getreg_b32 s3, hwreg(HW_REG_XCC_ID)
    s_and_b32 s3, s3, 15
    s_cmp_lg_u32 s3, 3
    s_cbranch_scc1 L_helper
    s_mov_b32 s37, 128
    v_mov_b32 v250, 1
    v_mov_b32 v251, 163832
    v_cmp_eq_u32 vcc, 0, v0
    s_nop 0
    s_and_saveexec_b64 s[38:39], vcc
    s_cbranch_execz tk1
    buffer_atomic_add v250, off, s[84:87], s37 sc0
    s_waitcnt vmcnt(0)
    ds_write_b32 v251, v250
    s_waitcnt lgkmcnt(0)
tk1:
    s_mov_b64 exec, -1
    s_barrier
    ds_read_b32 v252, v251
    s_waitcnt lgkmcnt(0)
    v_readfirstlane_b32 s12, v252
    s_barrier
    s_nop 3
    s_cmp_ge_u32 s12, 32
    s_cbranch_scc1 L_helper
L_chain:
    s_load_dwordx8 s[48:55], s[0:1], 8
    s_load_dwordx2 s[56:57], s[0:1], 40
    s_waitcnt lgkmcnt(0)
    v_lshrrev_b32 v77, 6, v0
    s_nop 0
    v_readfirstlane_b32 s13, v77
    v_lshlrev_b32 v65, 4, v0
    v_and_b32 v48, 63, v0
    s_mov_b32 s10, 4718592
    s_mov_b32 s11, 0x20000
    v_lshrrev_b32 v49, 3, v48
    v_mul_u32_u24 v18, 1152, v49
    v_and_b32 v49, 7, v48
    v_lshl_add_u32 v18, v49, 4, v18
    s_mul_i32 s40, s12, 147456
    s_lshl_b32 s41, s13, 8
    s_add_u32 s40, s40, s41
    s_mov_b32 s42, s40
    s_xor_b32 s41, s13, 0
    s_mul_i32 s41, s41, 36864
    s_add_u32 s60, s41, s40
    s_xor_b32 s41, s13, 1
    s_mul_i32 s41, s41, 36864
    s_add_u32 s61, s41, s40
    s_xor_b32 s41, s13, 2
    s_mul_i32 s41, s41, 36864
    s_add_u32 s62, s41, s40
    s_xor_b32 s41, s13, 3
    s_mul_i32 s41, s41, 36864
    s_add_u32 s63, s41, s40
    s_lshl_b32 s43, s13, 12
    s_mov_b64 s[8:9], s[56:57]
    s_add_u32 m0, s43, 0
    s_add_u32 s41, s60, 0
    buffer_load_dwordx4 v18, s[8:11], s41 offen offset:0 nt lds
    s_add_u32 s41, s60, 8192
    buffer_load_dwordx4 v18, s[8:11], s41 offen offset:1024 nt lds
    s_add_u32 s41, s60, 16384
    buffer_load_dwordx4 v18, s[8:11], s41 offen offset:2048 nt lds
    s_add_u32 s41, s60, 24576
    buffer_load_dwordx4 v18, s[8:11], s41 offen offset:3072 nt lds
    s_add_u32 m0, s43, 36864
    s_add_u32 s41, s61, 0
    buffer_load_dwordx4 v18, s[8:11], s41 offen offset:0 nt lds
    s_add_u32 s41, s61, 8192
    buffer_load_dwordx4 v18, s[8:11], s41 offen offset:1024 nt lds
    s_add_u32 s41, s61, 16384
    buffer_load_dwordx4 v18, s[8:11], s41 offen offset:2048 nt lds
    s_add_u32 s41, s61, 24576
    buffer_load_dwordx4 v18, s[8:11], s41 offen offset:3072 nt lds
    s_add_u32 m0, s43, 73728
    s_add_u32 s41, s62, 0
    buffer_load_dwordx4 v18, s[8:11], s41 offen offset:0 nt lds
    s_add_u32 s41, s62, 8192
    buffer_load_dwordx4 v18, s[8:11], s41 offen offset:1024 nt lds
    s_add_u32 s41, s62, 16384
    buffer_load_dwordx4 v18, s[8:11], s41 offen offset:2048 nt lds
    s_add_u32 s41, s62, 24576
    buffer_load_dwordx4 v18, s[8:11], s41 offen offset:3072 nt lds
    s_add_u32 m0, s43, 110592
    s_add_u32 s41, s63, 0
    buffer_load_dwordx4 v18, s[8:11], s41 offen offset:0 nt lds
    s_add_u32 s41, s63, 8192
    buffer_load_dwordx4 v18, s[8:11], s41 offen offset:1024 nt lds
    s_add_u32 s41, s63, 16384
    buffer_load_dwordx4 v18, s[8:11], s41 offen offset:2048 nt lds
    s_add_u32 s41, s63, 24576
    buffer_load_dwordx4 v18, s[8:11], s41 offen offset:3072 nt lds
    v_lshrrev_b32 v49, 1, v48
    v_mul_u32_u24 v19, 1152, v49
    v_and_b32 v49, 1, v48
    v_lshl_add_u32 v19, v49, 4, v19
    s_mul_i32 s41, s13, 224
    s_sub_u32 s41, 1024, s41
    v_add_u32 v19, s41, v19
    v_lshrrev_b32 v49, 4, v48
    v_lshlrev_b32 v50, 2, v49
    v_and_b32 v51, 15, v48
    v_xor_b32 v51, v51, v50
    v_lshlrev_b32 v51, 4, v51
    v_lshl_add_u32 v16, v49, 15, v51
    v_lshrrev_b32 v50, 1, v49
    v_lshl_add_u32 v17, v50, 16, v51
    v_and_b32 v50, 1, v49
    v_lshl_add_u32 v17, v50, 13, v17
    s_lshl_b32 s40, s12, 8
    s_mul_i32 s58, s13, 1048576
    s_add_u32 s58, s58, s40
    s_lshr_b32 s41, s13, 1
    s_mul_i32 s59, s41, 262144
    s_and_b32 s41, s13, 1
    s_lshl_b32 s41, s41, 14
    s_add_u32 s59, s59, s41
    s_add_u32 s59, s59, s40
    s_add_u32 s59, s59, 4194304
    v_bfe_u32 v50, v48, 2, 2
    v_xor_b32 v51, s13, v50
    v_lshlrev_b32 v20, 6, v51
    v_and_b32 v51, 3, v48
    v_lshl_add_u32 v20, v51, 4, v20
    v_lshrrev_b32 v23, 2, v48
    v_lshl_add_u32 v20, v23, 8, v20
    s_xor_b32 s41, s43, 0
    v_add_u32 v24, s41, v20
    s_xor_b32 s41, s43, 4096
    v_add_u32 v25, s41, v20
    s_xor_b32 s41, s43, 8192
    v_add_u32 v26, s41, v20
    s_xor_b32 s41, s43, 12288
    v_add_u32 v27, s41, v20
    v_and_b32 v23, 1, v50
    v_lshl_add_u32 v23, v49, 2, v23
    v_lshrrev_b32 v50, 1, v50
    v_lshlrev_b32 v21, 7, v23
    v_lshl_add_u32 v21, v50, 6, v21
    v_lshl_add_u32 v21, v51, 4, v21
    v_add_u32 v21, s43, v21
    v_lshlrev_b32 v22, 9, v50
    v_xor_b32 v22, v22, v21
    v_lshlrev_b32 v23, 5, v23
    v_lshl_add_u32 v23, v50, 10, v23
    v_lshl_add_u32 v23, v51, 3, v23
    v_add_u32 v23, s43, v23
    v_bfe_u32 v60, v65, 4, 6
    v_and_b32 v61, 15, v60
    v_lshrrev_b32 v62, 4, v60
    v_mov_b32 v64, 0x4444
    v_mov_b32 v77, 0xeeee
    v_cmp_lt_u32 vcc, 7, v61
    s_nop 1
    v_cndmask_b32 v64, v64, v77, vcc
    v_xor_b32 v66, 1024, v65
    v_xor_b32 v67, 2048, v65
    v_xor_b32 v68, 3072, v65
    v_and_b32 v69, 511, v65
    s_mul_i32 s96, s13, 36864
    s_add_u32 s96, s96, 16384
    v_lshlrev_b32 v70, 4, v60
    v_add_u32 v70, s96, v70
    v_lshrrev_b32 v79, 1, v69
    s_lshl_b32 s96, s13, 8
    s_add_u32 s96, s96, 14336
    s_lshl_b32 s33, s13, 10
    s_add_u32 s97, s33, 8192
    v_mov_b32 v77, s97
    v_mov_b32 v78, s96
    v_cmp_lt_u32 vcc, 31, v60
    s_nop 1
    v_cndmask_b32 v71, v77, v78, vcc
    v_add_u32 v71, v71, v79
    v_and_b32 v77, 7, v61
    v_lshrrev_b32 v78, 3, v61
    v_lshlrev_b32 v74, 4, v77
    v_lshl_add_u32 v73, v62, 7, v74
    v_lshl_add_u32 v73, v78, 3, v73
    s_lshl_b32 s96, s13, 9
    v_add_u32 v73, s96, v73
    v_lshl_add_u32 v74, v78, 14, v74
    v_lshl_add_u32 v74, v62, 15, v74
    s_lshl_b32 s96, s13, 17
    v_add_u32 v74, s96, v74
    v_bfe_u32 v77, v61, 2, 1
    v_and_b32 v78, 3, v61
    v_bfe_u32 v79, v61, 1, 2
    s_cmp_lt_u32 s13, 2
    s_cselect_b64 vcc, -1, 0
    v_cndmask_b32 v77, 0, v77, vcc
    v_cndmask_b32 v78, v79, v78, vcc
    v_lshlrev_b32 v75, 7, v77
    v_lshl_add_u32 v75, v62, 4, v75
    v_lshl_add_u32 v75, v78, 2, v75
    v_lshl_add_u32 v58, v77, 3, v78
    v_lshlrev_b32 v79, 1, v78
    v_cndmask_b32 v58, v79, v58, vcc
    s_bfe_u32 s97, s12, 0x10001
    s_lshl_b32 s68, s97, 6
    s_lshl_b32 s97, s97, 2
    v_add_u32 v59, s97, v62
    s_bfe_u32 s96, s12, 0x10002
    s_and_b32 s40, s12, 1
    s_lshl_b32 s96, s96, 1
    s_add_u32 s96, s96, s40
    s_lshr_b32 s97, s12, 3
    s_lshl_b32 s98, s13, 2
    s_add_u32 s98, s98, s97
    s_lshl_b32 s98, s98, 2
    s_add_u32 s98, s98, s96
    s_lshl_b32 s98, s98, 8
    s_lshl_b32 s99, s13, 2
    s_add_u32 s99, s99, s96
    s_lshl_b32 s99, s99, 4
    s_lshl_b32 s41, s97, 1
    s_add_u32 s41, s41, s40
    s_lshl_b32 s41, s41, 7
    s_add_u32 s41, s41, 8192
    s_lshl_b32 s40, s40, 3
    s_add_u32 s40, s40, 512
    s_cmp_lt_u32 s13, 2
    s_cselect_b32 s96, 7, 4
    s_cselect_b32 s98, s98, s41
    s_cselect_b32 s99, s99, s40
    s_cselect_b32 s32, 1, 0
    s_add_u32 s68, s68, s98
    s_lshl_b32 s97, s97, s96
    s_add_u32 s99, s99, s97
    v_add_u32 v58, s99, v58
    s_and_b32 s97, s12, 4
    s_or_b32 s97, s97, s13
    s_cmp_eq_u32 s97, 2
    s_cselect_b32 s32, 2, s32
    s_mov_b32 s8, s48
    s_mov_b32 s9, s49
    s_mov_b32 s10, 9216
    s_cmp_lt_u32 s13, 2
    s_cselect_b32 s96, 8, 2
    v_mul_u32_u24 v77, 1152, v59
    v_lshl_add_u32 v77, v58, 1, v77
    buffer_load_ushort v72, v77, s[8:11], 0 offen
    buffer_load_ushort v76, v77, s[8:11], s96 offen
    s_mov_b32 s10, 4718592
    s_waitcnt vmcnt(12) lgkmcnt(0)
    s_barrier
    s_mov_b64 s[8:9], s[56:57]
    s_add_u32 m0, s43, 147456
    s_add_u32 s41, s42, 0
    buffer_load_dwordx4 v19, s[8:11], s41 offen offset:0 nt lds
    s_add_u32 s41, s42, 35840
    buffer_load_dwordx4 v19, s[8:11], s41 offen offset:1024 nt lds
    s_add_u32 s41, s42, 71680
    buffer_load_dwordx4 v19, s[8:11], s41 offen offset:2048 nt lds
    s_add_u32 s41, s42, 107520
    buffer_load_dwordx4 v19, s[8:11], s41 offen offset:3072 nt lds
    v_mov_b32 v78, v21
    v_mov_b32 v79, v22
    v_add_u32 v77, 0, v79
    ds_read_b64_tr_b16 v[80:81], v77 offset:0
    ds_read_b64_tr_b16 v[82:83], v77 offset:256
    ds_read_b64_tr_b16 v[84:85], v77 offset:2048
    ds_read_b64_tr_b16 v[86:87], v77 offset:2304
    ds_read_b64_tr_b16 v[112:113], v77 offset:8
    ds_read_b64_tr_b16 v[114:115], v77 offset:264
    ds_read_b64_tr_b16 v[116:117], v77 offset:2056
    ds_read_b64_tr_b16 v[118:119], v77 offset:2312
    s_waitcnt vmcnt(12) lgkmcnt(0)
    s_barrier
    s_mov_b64 s[8:9], s[52:53]
    s_add_u32 m0, s43, 0
    s_add_u32 s41, s58, 0
    buffer_load_dwordx4 v16, s[8:11], s41 offen offset:0 nt lds
    s_add_u32 s41, s58, 15360
    buffer_load_dwordx4 v16, s[8:11], s41 offen offset:1024 nt lds
    s_add_u32 s41, s58, 129024
    buffer_load_dwordx4 v16, s[8:11], s41 offen offset:2048 nt lds
    s_add_u32 s41, s58, 144384
    buffer_load_dwordx4 v16, s[8:11], s41 offen offset:3072 nt lds
    v_add_u32 v77, 36864, v78
    ds_read_b64_tr_b16 v[88:89], v77 offset:0
    ds_read_b64_tr_b16 v[90:91], v77 offset:256
    ds_read_b64_tr_b16 v[92:93], v77 offset:2048
    ds_read_b64_tr_b16 v[94:95], v77 offset:2304
    ds_read_b64_tr_b16 v[120:121], v77 offset:8
    ds_read_b64_tr_b16 v[122:123], v77 offset:264
    ds_read_b64_tr_b16 v[124:125], v77 offset:2056
    ds_read_b64_tr_b16 v[126:127], v77 offset:2312
    s_waitcnt vmcnt(12) lgkmcnt(0)
    s_barrier
    s_add_u32 m0, s43, 36864
    s_add_u32 s41, s58, 8192
    buffer_load_dwordx4 v16, s[8:11], s41 offen offset:0 nt lds
    s_add_u32 s41, s58, 23552
    buffer_load_dwordx4 v16, s[8:11], s41 offen offset:1024 nt lds
    s_add_u32 s41, s58, 137216
    buffer_load_dwordx4 v16, s[8:11], s41 offen offset:2048 nt lds
    s_add_u32 s41, s58, 152576
    buffer_load_dwordx4 v16, s[8:11], s41 offen offset:3072 nt lds
    v_add_u32 v77, 73728, v78
    ds_read_b64_tr_b16 v[96:97], v77 offset:0
    ds_read_b64_tr_b16 v[98:99], v77 offset:256
    ds_read_b64_tr_b16 v[100:101], v77 offset:2048
    ds_read_b64_tr_b16 v[102:103], v77 offset:2304
    ds_read_b64_tr_b16 v[128:129], v77 offset:8
    ds_read_b64_tr_b16 v[130:131], v77 offset:264
    ds_read_b64_tr_b16 v[132:133], v77 offset:2056
    ds_read_b64_tr_b16 v[134:135], v77 offset:2312
    s_waitcnt vmcnt(12) lgkmcnt(0)
    s_barrier
    s_add_u32 m0, s43, 73728
    s_add_u32 s41, s58, 262144
    buffer_load_dwordx4 v16, s[8:11], s41 offen offset:0 nt lds
    s_add_u32 s41, s58, 277504
    buffer_load_dwordx4 v16, s[8:11], s41 offen offset:1024 nt lds
    s_add_u32 s41, s58, 391168
    buffer_load_dwordx4 v16, s[8:11], s41 offen offset:2048 nt lds
    s_add_u32 s41, s58, 406528
    buffer_load_dwordx4 v16, s[8:11], s41 offen offset:3072 nt lds
    v_add_u32 v77, 110592, v78
    ds_read_b64_tr_b16 v[104:105], v77 offset:0
    ds_read_b64_tr_b16 v[106:107], v77 offset:256
    ds_read_b64_tr_b16 v[108:109], v77 offset:2048
    ds_read_b64_tr_b16 v[110:111], v77 offset:2304
    ds_read_b64_tr_b16 v[136:137], v77 offset:8
    ds_read_b64_tr_b16 v[138:139], v77 offset:264
    ds_read_b64_tr_b16 v[140:141], v77 offset:2056
    ds_read_b64_tr_b16 v[142:143], v77 offset:2312
    s_waitcnt vmcnt(12) lgkmcnt(0)
    s_barrier
    s_add_u32 m0, s43, 110592
    s_add_u32 s41, s58, 270336
    buffer_load_dwordx4 v16, s[8:11], s41 offen offset:0 nt lds
    s_add_u32 s41, s58, 285696
    buffer_load_dwordx4 v16, s[8:11], s41 offen offset:1024 nt lds
    s_add_u32 s41, s58, 399360
    buffer_load_dwordx4 v16, s[8:11], s41 offen offset:2048 nt lds
    s_add_u32 s41, s58, 414720
    buffer_load_dwordx4 v16, s[8:11], s41 offen offset:3072 nt lds
    v_add_u32 v77, 147456, v23
    ds_read_b64_tr_b16 v[0:1], v77 offset:0
    ds_read_b64_tr_b16 v[2:3], v77 offset:64
    ds_read_b64_tr_b16 v[4:5], v77 offset:512
    ds_read_b64_tr_b16 v[6:7], v77 offset:576
    ds_read_b64_tr_b16 v[8:9], v77 offset:2048
    ds_read_b64_tr_b16 v[10:11], v77 offset:2112
    ds_read_b64_tr_b16 v[12:13], v77 offset:2560
    ds_read_b64_tr_b16 v[14:15], v77 offset:2624
    s_waitcnt vmcnt(12) lgkmcnt(0)
    s_barrier
    s_add_u32 m0, s43, 147456
    s_add_u32 s41, s58, 524288
    buffer_load_dwordx4 v16, s[8:11], s41 offen offset:0 nt lds
    s_add_u32 s41, s58, 539648
    buffer_load_dwordx4 v16, s[8:11], s41 offen offset:1024 nt lds
    s_add_u32 s41, s58, 653312
    buffer_load_dwordx4 v16, s[8:11], s41 offen offset:2048 nt lds
    s_add_u32 s41, s58, 668672
    buffer_load_dwordx4 v16, s[8:11], s41 offen offset:3072 nt lds
    s_cmp_eq_u32 s32, 0
    s_cbranch_scc1 cf_init_done
    v_mov_b32 v52, 1
    v_mov_b32 v53, 1
    v_mov_b32 v54, 1
    v_mov_b32 v55, 1
    v_mov_b32 v56, 0
    v_lshl_or_b32 v72, v76, 16, v72
    s_lshl_b32 s96, s12, 14
    s_add_u32 s96, s96, 68157440
    s_add_u32 s97, s96, 0
    buffer_store_dwordx4 v[52:55], v65, s[4:7], s97 offen
    buffer_load_dwordx4 v[60:63], v65, s[4:7], s97 offen sc1
    s_add_u32 s97, s96, 4096
    buffer_store_dwordx4 v[52:55], v65, s[4:7], s97 offen
    buffer_load_dwordx4 v[60:63], v65, s[4:7], s97 offen sc1
    s_add_u32 s97, s96, 8192
    buffer_store_dwordx4 v[52:55], v65, s[4:7], s97 offen
    buffer_load_dwordx4 v[60:63], v65, s[4:7], s97 offen sc1
    s_add_u32 s97, s96, 12288
    buffer_store_dwordx4 v[52:55], v65, s[4:7], s97 offen
    buffer_load_dwordx4 v[60:63], v65, s[4:7], s97 offen sc1
    s_add_u32 s96, s68, 67108864
    s_add_u32 s97, s96, 16384
    buffer_store_dword v56, v75, s[4:7], s96 offen offset:0
    buffer_store_dword v72, v75, s[4:7], s97 offen offset:0
    buffer_load_dword v60, v75, s[4:7], s96 offen offset:0 sc1
    buffer_load_dword v60, v75, s[4:7], s97 offen offset:0 sc1
    s_cmp_lg_u32 s32, 2
    s_cbranch_scc1 cf_init_done
    buffer_store_dword v56, v75, s[4:7], s96 offen offset:1024
    buffer_store_dword v72, v75, s[4:7], s97 offen offset:1024
    buffer_load_dword v60, v75, s[4:7], s96 offen offset:1024 sc1
    buffer_load_dword v60, v75, s[4:7], s97 offen offset:1024 sc1
    buffer_store_dword v56, v75, s[4:7], s96 offen offset:2048
    buffer_store_dword v72, v75, s[4:7], s97 offen offset:2048
    buffer_load_dword v60, v75, s[4:7], s96 offen offset:2048 sc1
    buffer_load_dword v60, v75, s[4:7], s97 offen offset:2048 sc1
    buffer_store_dword v56, v75, s[4:7], s96 offen offset:3072
    buffer_store_dword v72, v75, s[4:7], s97 offen offset:3072
    buffer_load_dword v60, v75, s[4:7], s96 offen offset:3072 sc1
    buffer_load_dword v60, v75, s[4:7], s97 offen offset:3072 sc1
cf_init_done:
    ds_write_b64 v70, v[0:1] offset:16384
    ds_write_b64 v70, v[2:3] offset:16392
    ds_write_b64 v70, v[4:5] offset:17408
    ds_write_b64 v70, v[6:7] offset:17416
    ds_write_b64 v70, v[8:9] offset:18432
    ds_write_b64 v70, v[10:11] offset:18440
    ds_write_b64 v70, v[12:13] offset:19456
    ds_write_b64 v70, v[14:15] offset:19464
    v_add_u32 v28, 0, v24
    v_add_u32 v29, 0, v25
    v_add_u32 v30, 0, v26
    v_add_u32 v31, 0, v27
    ds_read_b64_tr_b16 a[96:97], v28 offset:0
    ds_read_b64_tr_b16 a[104:105], v28 offset:8
    ds_read_b64_tr_b16 a[112:113], v29 offset:0
    ds_read_b64_tr_b16 a[120:121], v29 offset:8
    ds_read_b64_tr_b16 a[128:129], v30 offset:0
    ds_read_b64_tr_b16 a[136:137], v30 offset:8
    ds_read_b64_tr_b16 a[144:145], v31 offset:0
    ds_read_b64_tr_b16 v[32:33], v31 offset:8
    s_waitcnt vmcnt(12) lgkmcnt(0)
    s_barrier
    s_add_u32 m0, s43, 0
    s_add_u32 s41, s58, 532480
    buffer_load_dwordx4 v16, s[8:11], s41 offen offset:0 nt lds
    s_add_u32 s41, s58, 547840
    buffer_load_dwordx4 v16, s[8:11], s41 offen offset:1024 nt lds
    s_add_u32 s41, s58, 661504
    buffer_load_dwordx4 v16, s[8:11], s41 offen offset:2048 nt lds
    s_add_u32 s41, s58, 676864
    buffer_load_dwordx4 v16, s[8:11], s41 offen offset:3072 nt lds
    ds_write_b64 v70, v[32:33] offset:12288
    v_add_u32 v28, 36864, v24
    v_add_u32 v29, 36864, v25
    v_add_u32 v30, 36864, v26
    v_add_u32 v31, 36864, v27
    ds_read_b64_tr_b16 a[98:99], v28 offset:0
    ds_read_b64_tr_b16 a[106:107], v28 offset:8
    ds_read_b64_tr_b16 a[114:115], v29 offset:0
    ds_read_b64_tr_b16 a[122:123], v29 offset:8
    ds_read_b64_tr_b16 a[130:131], v30 offset:0
    ds_read_b64_tr_b16 a[138:139], v30 offset:8
    ds_read_b64_tr_b16 a[146:147], v31 offset:0
    ds_read_b64_tr_b16 v[0:1], v31 offset:8
    s_waitcnt vmcnt(12) lgkmcnt(0)
    s_barrier
    s_add_u32 m0, s43, 36864
    s_add_u32 s41, s58, 786432
    buffer_load_dwordx4 v16, s[8:11], s41 offen offset:0 nt lds
    s_add_u32 s41, s58, 801792
    buffer_load_dwordx4 v16, s[8:11], s41 offen offset:1024 nt lds
    s_add_u32 s41, s58, 915456
    buffer_load_dwordx4 v16, s[8:11], s41 offen offset:2048 nt lds
    s_add_u32 s41, s58, 930816
    buffer_load_dwordx4 v16, s[8:11], s41 offen offset:3072 nt lds
    ds_write_b64 v70, v[0:1] offset:12296
    v_add_u32 v28, 73728, v24
    v_add_u32 v29, 73728, v25
    v_add_u32 v30, 73728, v26
    v_add_u32 v31, 73728, v27
    ds_read_b64_tr_b16 a[100:101], v28 offset:0
    ds_read_b64_tr_b16 a[108:109], v28 offset:8
    ds_read_b64_tr_b16 a[116:117], v29 offset:0
    ds_read_b64_tr_b16 a[124:125], v29 offset:8
    ds_read_b64_tr_b16 a[132:133], v30 offset:0
    ds_read_b64_tr_b16 a[140:141], v30 offset:8
    ds_read_b64_tr_b16 a[148:149], v31 offset:0
    ds_read_b64_tr_b16 v[32:33], v31 offset:8
    s_waitcnt vmcnt(12) lgkmcnt(0)
    s_barrier
    s_add_u32 m0, s43, 73728
    s_add_u32 s41, s58, 794624
    buffer_load_dwordx4 v16, s[8:11], s41 offen offset:0 nt lds
    s_add_u32 s41, s58, 809984
    buffer_load_dwordx4 v16, s[8:11], s41 offen offset:1024 nt lds
    s_add_u32 s41, s58, 923648
    buffer_load_dwordx4 v16, s[8:11], s41 offen offset:2048 nt lds
    s_add_u32 s41, s58, 939008
    buffer_load_dwordx4 v16, s[8:11], s41 offen offset:3072 nt lds
    ds_write_b64 v70, v[32:33] offset:13312
    v_add_u32 v28, 110592, v24
    v_add_u32 v29, 110592, v25
    v_add_u32 v30, 110592, v26
    v_add_u32 v31, 110592, v27
    ds_read_b64_tr_b16 a[102:103], v28 offset:0
    ds_read_b64_tr_b16 a[110:111], v28 offset:8
    ds_read_b64_tr_b16 a[118:119], v29 offset:0
    ds_read_b64_tr_b16 a[126:127], v29 offset:8
    ds_read_b64_tr_b16 a[134:135], v30 offset:0
    ds_read_b64_tr_b16 a[142:143], v30 offset:8
    ds_read_b64_tr_b16 a[150:151], v31 offset:0
    ds_read_b64_tr_b16 v[0:1], v31 offset:8
    s_waitcnt vmcnt(12) lgkmcnt(0)
    s_barrier
    s_add_u32 m0, s43, 110592
    s_add_u32 s41, s59, 0
    buffer_load_dwordx4 v17, s[8:11], s41 offen offset:0 nt lds
    s_add_u32 s41, s59, 31744
    buffer_load_dwordx4 v17, s[8:11], s41 offen offset:1024 nt lds
    s_add_u32 s41, s59, 129024
    buffer_load_dwordx4 v17, s[8:11], s41 offen offset:2048 nt lds
    s_add_u32 s41, s59, 160768
    buffer_load_dwordx4 v17, s[8:11], s41 offen offset:3072 nt lds
    ds_write_b64 v70, v[0:1] offset:13320
    v_add_u32 v28, 147456, v24
    v_add_u32 v29, 147456, v25
    v_add_u32 v30, 147456, v26
    v_add_u32 v31, 147456, v27
    ds_read_b64_tr_b16 a[152:153], v28 offset:0
    ds_read_b64_tr_b16 a[160:161], v28 offset:8
    ds_read_b64_tr_b16 a[168:169], v29 offset:0
    ds_read_b64_tr_b16 a[176:177], v29 offset:8
    ds_read_b64_tr_b16 a[184:185], v30 offset:0
    ds_read_b64_tr_b16 a[192:193], v30 offset:8
    ds_read_b64_tr_b16 a[200:201], v31 offset:0
    ds_read_b64_tr_b16 a[208:209], v31 offset:8
    s_waitcnt vmcnt(12) lgkmcnt(0)
    s_barrier
    s_mov_b64 s[8:9], s[50:51]
    s_add_u32 m0, s43, 147456
    s_add_u32 s41, s58, 0
    buffer_load_dwordx4 v16, s[8:11], s41 offen offset:0 nt lds
    s_add_u32 s41, s58, 15360
    buffer_load_dwordx4 v16, s[8:11], s41 offen offset:1024 nt lds
    s_add_u32 s41, s58, 129024
    buffer_load_dwordx4 v16, s[8:11], s41 offen offset:2048 nt lds
    s_add_u32 s41, s58, 144384
    buffer_load_dwordx4 v16, s[8:11], s41 offen offset:3072 nt lds
    s_cmp_lg_u32 s13, 0
    s_cbranch_scc1 cf_ma
    v_mov_b32 v54, 1
    s_mov_b64 exec, 1
    buffer_atomic_add v54, off, s[84:87], 0 offset:132
    s_mov_b64 exec, -1
cf_ma:
    v_add_u32 v28, 0, v24
    v_add_u32 v29, 0, v25
    v_add_u32 v30, 0, v26
    v_add_u32 v31, 0, v27
    ds_read_b64_tr_b16 a[154:155], v28 offset:0
    ds_read_b64_tr_b16 a[162:163], v28 offset:8
    ds_read_b64_tr_b16 a[170:171], v29 offset:0
    ds_read_b64_tr_b16 a[178:179], v29 offset:8
    ds_read_b64_tr_b16 a[186:187], v30 offset:0
    ds_read_b64_tr_b16 a[194:195], v30 offset:8
    ds_read_b64_tr_b16 a[202:203], v31 offset:0
    ds_read_b64_tr_b16 a[210:211], v31 offset:8
    s_waitcnt vmcnt(12) lgkmcnt(0)
    s_barrier
    s_add_u32 m0, s43, 0
    s_add_u32 s41, s58, 8192
    buffer_load_dwordx4 v16, s[8:11], s41 offen offset:0 nt lds
    s_add_u32 s41, s58, 23552
    buffer_load_dwordx4 v16, s[8:11], s41 offen offset:1024 nt lds
    s_add_u32 s41, s58, 137216
    buffer_load_dwordx4 v16, s[8:11], s41 offen offset:2048 nt lds
    s_add_u32 s41, s58, 152576
    buffer_load_dwordx4 v16, s[8:11], s41 offen offset:3072 nt lds
    v_add_u32 v28, 36864, v24
    v_add_u32 v29, 36864, v25
    v_add_u32 v30, 36864, v26
    v_add_u32 v31, 36864, v27
    ds_read_b64_tr_b16 a[156:157], v28 offset:0
    ds_read_b64_tr_b16 a[164:165], v28 offset:8
    ds_read_b64_tr_b16 a[172:173], v29 offset:0
    ds_read_b64_tr_b16 a[180:181], v29 offset:8
    ds_read_b64_tr_b16 a[188:189], v30 offset:0
    ds_read_b64_tr_b16 a[196:197], v30 offset:8
    ds_read_b64_tr_b16 a[204:205], v31 offset:0
    ds_read_b64_tr_b16 a[212:213], v31 offset:8
    s_waitcnt vmcnt(12) lgkmcnt(0)
    s_barrier
    s_add_u32 m0, s43, 36864
    s_add_u32 s41, s58, 262144
    buffer_load_dwordx4 v16, s[8:11], s41 offen offset:0 nt lds
    s_add_u32 s41, s58, 277504
    buffer_load_dwordx4 v16, s[8:11], s41 offen offset:1024 nt lds
    s_add_u32 s41, s58, 391168
    buffer_load_dwordx4 v16, s[8:11], s41 offen offset:2048 nt lds
    s_add_u32 s41, s58, 406528
    buffer_load_dwordx4 v16, s[8:11], s41 offen offset:3072 nt lds
    v_add_u32 v28, 73728, v24
    v_add_u32 v29, 73728, v25
    v_add_u32 v30, 73728, v26
    v_add_u32 v31, 73728, v27
    ds_read_b64_tr_b16 a[158:159], v28 offset:0
    ds_read_b64_tr_b16 a[166:167], v28 offset:8
    ds_read_b64_tr_b16 a[174:175], v29 offset:0
    ds_read_b64_tr_b16 a[182:183], v29 offset:8
    ds_read_b64_tr_b16 a[190:191], v30 offset:0
    ds_read_b64_tr_b16 a[198:199], v30 offset:8
    ds_read_b64_tr_b16 a[206:207], v31 offset:0
    ds_read_b64_tr_b16 a[214:215], v31 offset:8
    s_waitcnt vmcnt(12) lgkmcnt(0)
    s_barrier
    s_add_u32 m0, s43, 73728
    s_add_u32 s41, s58, 270336
    buffer_load_dwordx4 v16, s[8:11], s41 offen offset:0 nt lds
    s_add_u32 s41, s58, 285696
    buffer_load_dwordx4 v16, s[8:11], s41 offen offset:1024 nt lds
    s_add_u32 s41, s58, 399360
    buffer_load_dwordx4 v16, s[8:11], s41 offen offset:2048 nt lds
    s_add_u32 s41, s58, 414720
    buffer_load_dwordx4 v16, s[8:11], s41 offen offset:3072 nt lds
    v_add_u32 v77, 110592, v20
    ds_read_b64_tr_b16 a[216:217], v77 offset:0
    ds_read_b64_tr_b16 a[218:219], v77 offset:4096
    ds_read_b64_tr_b16 a[220:221], v77 offset:8192
    ds_read_b64_tr_b16 a[222:223], v77 offset:12288
    ds_read_b64_tr_b16 a[224:225], v77 offset:8
    ds_read_b64_tr_b16 a[226:227], v77 offset:4104
    ds_read_b64_tr_b16 a[228:229], v77 offset:8200
    ds_read_b64_tr_b16 a[230:231], v77 offset:12296
    s_waitcnt vmcnt(12) lgkmcnt(0)
    s_barrier
    s_add_u32 m0, s43, 110592
    s_add_u32 s41, s58, 524288
    buffer_load_dwordx4 v16, s[8:11], s41 offen offset:0 nt lds
    s_add_u32 s41, s58, 539648
    buffer_load_dwordx4 v16, s[8:11], s41 offen offset:1024 nt lds
    s_add_u32 s41, s58, 653312
    buffer_load_dwordx4 v16, s[8:11], s41 offen offset:2048 nt lds
    s_add_u32 s41, s58, 668672
    buffer_load_dwordx4 v16, s[8:11], s41 offen offset:3072 nt lds
    v_add_u32 v28, 147456, v24
    v_add_u32 v29, 147456, v25
    v_add_u32 v30, 147456, v26
    v_add_u32 v31, 147456, v27
    ds_read_b64_tr_b16 v[0:1], v28 offset:0
    ds_read_b64_tr_b16 v[2:3], v28 offset:8
    ds_read_b64_tr_b16 v[4:5], v29 offset:0
    ds_read_b64_tr_b16 v[6:7], v29 offset:8
    ds_read_b64_tr_b16 a[0:1], v30 offset:0
    ds_read_b64_tr_b16 v[8:9], v30 offset:8
    ds_read_b64_tr_b16 a[8:9], v31 offset:0
    ds_read_b64_tr_b16 v[10:11], v31 offset:8
    s_waitcnt vmcnt(12) lgkmcnt(0)
    s_barrier
    s_add_u32 m0, s43, 147456
    s_add_u32 s41, s58, 532480
    buffer_load_dwordx4 v16, s[8:11], s41 offen offset:0 nt lds
    s_add_u32 s41, s58, 547840
    buffer_load_dwordx4 v16, s[8:11], s41 offen offset:1024 nt lds
    s_add_u32 s41, s58, 661504
    buffer_load_dwordx4 v16, s[8:11], s41 offen offset:2048 nt lds
    s_add_u32 s41, s58, 676864
    buffer_load_dwordx4 v16, s[8:11], s41 offen offset:3072 nt lds
    ds_write_b64 v70, v[0:1] offset:0
    ds_write_b64 v70, v[2:3] offset:2048
    ds_write_b64 v70, v[4:5] offset:4096
    ds_write_b64 v70, v[6:7] offset:6144
    ds_write_b64 v70, v[8:9] offset:10240
    ds_write_b64 v70, v[10:11] offset:14336
    v_add_u32 v28, 0, v24
    v_add_u32 v29, 0, v25
    v_add_u32 v30, 0, v26
    v_add_u32 v31, 0, v27
    ds_read_b64_tr_b16 v[32:33], v28 offset:0
    ds_read_b64_tr_b16 v[34:35], v28 offset:8
    ds_read_b64_tr_b16 v[36:37], v29 offset:0
    ds_read_b64_tr_b16 v[38:39], v29 offset:8
    ds_read_b64_tr_b16 a[2:3], v30 offset:0
    ds_read_b64_tr_b16 v[40:41], v30 offset:8
    ds_read_b64_tr_b16 a[10:11], v31 offset:0
    ds_read_b64_tr_b16 v[42:43], v31 offset:8
    s_waitcnt vmcnt(12) lgkmcnt(0)
    s_barrier
    s_add_u32 m0, s43, 0
    s_add_u32 s41, s58, 786432
    buffer_load_dwordx4 v16, s[8:11], s41 offen offset:0 nt lds
    s_add_u32 s41, s58, 801792
    buffer_load_dwordx4 v16, s[8:11], s41 offen offset:1024 nt lds
    s_add_u32 s41, s58, 915456
    buffer_load_dwordx4 v16, s[8:11], s41 offen offset:2048 nt lds
    s_add_u32 s41, s58, 930816
    buffer_load_dwordx4 v16, s[8:11], s41 offen offset:3072 nt lds
    ds_write_b64 v70, v[32:33] offset:8
    ds_write_b64 v70, v[34:35] offset:2056
    ds_write_b64 v70, v[36:37] offset:4104
    ds_write_b64 v70, v[38:39] offset:6152
    ds_write_b64 v70, v[40:41] offset:10248
    ds_write_b64 v70, v[42:43] offset:14344
    v_add_u32 v28, 36864, v24
    v_add_u32 v29, 36864, v25
    v_add_u32 v30, 36864, v26
    v_add_u32 v31, 36864, v27
    ds_read_b64_tr_b16 v[0:1], v28 offset:0
    ds_read_b64_tr_b16 v[2:3], v28 offset:8
    ds_read_b64_tr_b16 v[4:5], v29 offset:0
    ds_read_b64_tr_b16 v[6:7], v29 offset:8
    ds_read_b64_tr_b16 a[4:5], v30 offset:0
    ds_read_b64_tr_b16 v[8:9], v30 offset:8
    ds_read_b64_tr_b16 a[12:13], v31 offset:0
    ds_read_b64_tr_b16 v[10:11], v31 offset:8
    s_waitcnt vmcnt(12) lgkmcnt(0)
    s_barrier
    s_add_u32 m0, s43, 36864
    s_add_u32 s41, s58, 794624
    buffer_load_dwordx4 v16, s[8:11], s41 offen offset:0 nt lds
    s_add_u32 s41, s58, 809984
    buffer_load_dwordx4 v16, s[8:11], s41 offen offset:1024 nt lds
    s_add_u32 s41, s58, 923648
    buffer_load_dwordx4 v16, s[8:11], s41 offen offset:2048 nt lds
    s_add_u32 s41, s58, 939008
    buffer_load_dwordx4 v16, s[8:11], s41 offen offset:3072 nt lds
    ds_write_b64 v70, v[0:1] offset:1024
    ds_write_b64 v70, v[2:3] offset:3072
    ds_write_b64 v70, v[4:5] offset:5120
    ds_write_b64 v70, v[6:7] offset:7168
    ds_write_b64 v70, v[8:9] offset:11264
    ds_write_b64 v70, v[10:11] offset:15360
    v_add_u32 v28, 73728, v24
    v_add_u32 v29, 73728, v25
    v_add_u32 v30, 73728, v26
    v_add_u32 v31, 73728, v27
    ds_read_b64_tr_b16 v[32:33], v28 offset:0
    ds_read_b64_tr_b16 v[34:35], v28 offset:8
    ds_read_b64_tr_b16 v[36:37], v29 offset:0
    ds_read_b64_tr_b16 v[38:39], v29 offset:8
    ds_read_b64_tr_b16 a[6:7], v30 offset:0
    ds_read_b64_tr_b16 v[40:41], v30 offset:8
    ds_read_b64_tr_b16 a[14:15], v31 offset:0
    ds_read_b64_tr_b16 v[42:43], v31 offset:8
    s_waitcnt vmcnt(12) lgkmcnt(0)
    s_barrier
    s_add_u32 m0, s43, 73728
    s_add_u32 s41, s59, 0
    buffer_load_dwordx4 v17, s[8:11], s41 offen offset:0 nt lds
    s_add_u32 s41, s59, 31744
    buffer_load_dwordx4 v17, s[8:11], s41 offen offset:1024 nt lds
    s_add_u32 s41, s59, 129024
    buffer_load_dwordx4 v17, s[8:11], s41 offen offset:2048 nt lds
    s_add_u32 s41, s59, 160768
    buffer_load_dwordx4 v17, s[8:11], s41 offen offset:3072 nt lds
    ds_write_b64 v70, v[32:33] offset:1032
    ds_write_b64 v70, v[34:35] offset:3080
    ds_write_b64 v70, v[36:37] offset:5128
    ds_write_b64 v70, v[38:39] offset:7176
    ds_write_b64 v70, v[40:41] offset:11272
    ds_write_b64 v70, v[42:43] offset:15368
    v_add_u32 v28, 110592, v24
    v_add_u32 v29, 110592, v25
    v_add_u32 v30, 110592, v26
    v_add_u32 v31, 110592, v27
    ds_read_b64_tr_b16 a[16:17], v28 offset:0
    ds_read_b64_tr_b16 a[24:25], v28 offset:8
    ds_read_b64_tr_b16 a[32:33], v29 offset:0
    ds_read_b64_tr_b16 a[40:41], v29 offset:8
    ds_read_b64_tr_b16 a[48:49], v30 offset:0
    ds_read_b64_tr_b16 a[56:57], v30 offset:8
    ds_read_b64_tr_b16 a[64:65], v31 offset:0
    ds_read_b64_tr_b16 a[72:73], v31 offset:8
    s_waitcnt vmcnt(12) lgkmcnt(0)
    s_barrier
    s_mov_b64 s[8:9], s[54:55]
    s_add_u32 m0, s43, 110592
    s_add_u32 s41, s58, 0
    buffer_load_dwordx4 v16, s[8:11], s41 offen offset:0 nt lds
    s_add_u32 s41, s58, 15360
    buffer_load_dwordx4 v16, s[8:11], s41 offen offset:1024 nt lds
    s_add_u32 s41, s58, 129024
    buffer_load_dwordx4 v16, s[8:11], s41 offen offset:2048 nt lds
    s_add_u32 s41, s58, 144384
    buffer_load_dwordx4 v16, s[8:11], s41 offen offset:3072 nt lds
    v_add_u32 v28, 147456, v24
    v_add_u32 v29, 147456, v25
    v_add_u32 v30, 147456, v26
    v_add_u32 v31, 147456, v27
    ds_read_b64_tr_b16 a[18:19], v28 offset:0
    ds_read_b64_tr_b16 a[26:27], v28 offset:8
    ds_read_b64_tr_b16 a[34:35], v29 offset:0
    ds_read_b64_tr_b16 a[42:43], v29 offset:8
    ds_read_b64_tr_b16 a[50:51], v30 offset:0
    ds_read_b64_tr_b16 a[58:59], v30 offset:8
    ds_read_b64_tr_b16 a[66:67], v31 offset:0
    ds_read_b64_tr_b16 a[74:75], v31 offset:8
    s_waitcnt vmcnt(12) lgkmcnt(0)
    s_barrier
    s_add_u32 m0, s43, 147456
    s_add_u32 s41, s58, 8192
    buffer_load_dwordx4 v16, s[8:11], s41 offen offset:0 nt lds
    s_add_u32 s41, s58, 23552
    buffer_load_dwordx4 v16, s[8:11], s41 offen offset:1024 nt lds
    s_add_u32 s41, s58, 137216
    buffer_load_dwordx4 v16, s[8:11], s41 offen offset:2048 nt lds
    s_add_u32 s41, s58, 152576
    buffer_load_dwordx4 v16, s[8:11], s41 offen offset:3072 nt lds
    v_add_u32 v28, 0, v24
    v_add_u32 v29, 0, v25
    v_add_u32 v30, 0, v26
    v_add_u32 v31, 0, v27
    ds_read_b64_tr_b16 a[20:21], v28 offset:0
    ds_read_b64_tr_b16 a[28:29], v28 offset:8
    ds_read_b64_tr_b16 a[36:37], v29 offset:0
    ds_read_b64_tr_b16 a[44:45], v29 offset:8
    ds_read_b64_tr_b16 a[52:53], v30 offset:0
    ds_read_b64_tr_b16 a[60:61], v30 offset:8
    ds_read_b64_tr_b16 a[68:69], v31 offset:0
    ds_read_b64_tr_b16 a[76:77], v31 offset:8
    s_waitcnt vmcnt(12) lgkmcnt(0)
    s_barrier
    s_add_u32 m0, s43, 0
    s_add_u32 s41, s58, 262144
    buffer_load_dwordx4 v16, s[8:11], s41 offen offset:0 nt lds
    s_add_u32 s41, s58, 277504
    buffer_load_dwordx4 v16, s[8:11], s41 offen offset:1024 nt lds
    s_add_u32 s41, s58, 391168
    buffer_load_dwordx4 v16, s[8:11], s41 offen offset:2048 nt lds
    s_add_u32 s41, s58, 406528
    buffer_load_dwordx4 v16, s[8:11], s41 offen offset:3072 nt lds
    v_add_u32 v28, 36864, v24
    v_add_u32 v29, 36864, v25
    v_add_u32 v30, 36864, v26
    v_add_u32 v31, 36864, v27
    ds_read_b64_tr_b16 a[22:23], v28 offset:0
    ds_read_b64_tr_b16 a[30:31], v28 offset:8
    ds_read_b64_tr_b16 a[38:39], v29 offset:0
    ds_read_b64_tr_b16 a[46:47], v29 offset:8
    ds_read_b64_tr_b16 a[54:55], v30 offset:0
    ds_read_b64_tr_b16 a[62:63], v30 offset:8
    ds_read_b64_tr_b16 a[70:71], v31 offset:0
    ds_read_b64_tr_b16 a[78:79], v31 offset:8
    s_waitcnt vmcnt(12) lgkmcnt(0)
    s_barrier
    s_add_u32 m0, s43, 36864
    s_add_u32 s41, s58, 270336
    buffer_load_dwordx4 v16, s[8:11], s41 offen offset:0 nt lds
    s_add_u32 s41, s58, 285696
    buffer_load_dwordx4 v16, s[8:11], s41 offen offset:1024 nt lds
    s_add_u32 s41, s58, 399360
    buffer_load_dwordx4 v16, s[8:11], s41 offen offset:2048 nt lds
    s_add_u32 s41, s58, 414720
    buffer_load_dwordx4 v16, s[8:11], s41 offen offset:3072 nt lds
    s_lshl_b32 s26, s12, 14
    s_add_u32 s26, s26, 0
    s_mul_i32 s40, s13, 3072
    s_add_u32 s24, s26, s40
    s_lshl_b32 s96, s12, 7
    s_add_u32 s29, s96, 125845504
    s_add_u32 s96, s96, 125829120
    v_bfe_u32 v78, v65, 2, 5
    buffer_load_dword v54, off, s[84:87], 0 offset:132 sc1
    buffer_load_dword v55, off, s[84:87], 0 offset:216 sc1
    buffer_load_dword v56, v78, s[4:7], s96 offen offset:16 sc1
    v_add_u32 v77, 73728, v20
    ds_read_b64_tr_b16 a[80:81], v77 offset:0
    ds_read_b64_tr_b16 a[82:83], v77 offset:4096
    ds_read_b64_tr_b16 a[84:85], v77 offset:8192
    ds_read_b64_tr_b16 a[86:87], v77 offset:12288
    ds_read_b64_tr_b16 a[88:89], v77 offset:8
    ds_read_b64_tr_b16 a[90:91], v77 offset:4104
    ds_read_b64_tr_b16 a[92:93], v77 offset:8200
    ds_read_b64_tr_b16 a[94:95], v77 offset:12296
    s_waitcnt vmcnt(12) lgkmcnt(0)
    s_barrier
    s_add_u32 m0, s43, 73728
    s_add_u32 s41, s58, 524288
    buffer_load_dwordx4 v16, s[8:11], s41 offen offset:0 nt lds
    s_add_u32 s41, s58, 539648
    buffer_load_dwordx4 v16, s[8:11], s41 offen offset:1024 nt lds
    s_add_u32 s41, s58, 653312
    buffer_load_dwordx4 v16, s[8:11], s41 offen offset:2048 nt lds
    s_add_u32 s41, s58, 668672
    buffer_load_dwordx4 v16, s[8:11], s41 offen offset:3072 nt lds
    v_add_u32 v28, 110592, v24
    v_add_u32 v29, 110592, v25
    v_add_u32 v30, 110592, v26
    v_add_u32 v31, 110592, v27
    ds_read_b64_tr_b16 a[232:233], v28 offset:0
    ds_read_b64_tr_b16 v[32:33], v28 offset:8
    ds_read_b64_tr_b16 a[240:241], v29 offset:0
    ds_read_b64_tr_b16 a[248:249], v29 offset:8
    ds_read_b64_tr_b16 v[144:145], v30 offset:0
    ds_read_b64_tr_b16 v[152:153], v30 offset:8
    ds_read_b64_tr_b16 v[160:161], v31 offset:0
    ds_read_b64_tr_b16 v[168:169], v31 offset:8
    s_waitcnt vmcnt(12) lgkmcnt(0)
    s_barrier
    s_add_u32 m0, s43, 110592
    s_add_u32 s41, s58, 532480
    buffer_load_dwordx4 v16, s[8:11], s41 offen offset:0 nt lds
    s_add_u32 s41, s58, 547840
    buffer_load_dwordx4 v16, s[8:11], s41 offen offset:1024 nt lds
    s_add_u32 s41, s58, 661504
    buffer_load_dwordx4 v16, s[8:11], s41 offen offset:2048 nt lds
    s_add_u32 s41, s58, 676864
    buffer_load_dwordx4 v16, s[8:11], s41 offen offset:3072 nt lds
    ds_write_b64 v70, v[32:33] offset:8192
    v_add_u32 v28, 147456, v24
    v_add_u32 v29, 147456, v25
    v_add_u32 v30, 147456, v26
    v_add_u32 v31, 147456, v27
    ds_read_b64_tr_b16 a[234:235], v28 offset:0
    ds_read_b64_tr_b16 v[0:1], v28 offset:8
    ds_read_b64_tr_b16 a[242:243], v29 offset:0
    ds_read_b64_tr_b16 a[250:251], v29 offset:8
    ds_read_b64_tr_b16 v[146:147], v30 offset:0
    ds_read_b64_tr_b16 v[154:155], v30 offset:8
    ds_read_b64_tr_b16 v[162:163], v31 offset:0
    ds_read_b64_tr_b16 v[170:171], v31 offset:8
    s_waitcnt vmcnt(12) lgkmcnt(0)
    s_barrier
    s_add_u32 m0, s43, 147456
    s_add_u32 s41, s58, 786432
    buffer_load_dwordx4 v16, s[8:11], s41 offen offset:0 nt lds
    s_add_u32 s41, s58, 801792
    buffer_load_dwordx4 v16, s[8:11], s41 offen offset:1024 nt lds
    s_add_u32 s41, s58, 915456
    buffer_load_dwordx4 v16, s[8:11], s41 offen offset:2048 nt lds
    s_add_u32 s41, s58, 930816
    buffer_load_dwordx4 v16, s[8:11], s41 offen offset:3072 nt lds
    ds_write_b64 v70, v[0:1] offset:8200
    v_add_u32 v28, 0, v24
    v_add_u32 v29, 0, v25
    v_add_u32 v30, 0, v26
    v_add_u32 v31, 0, v27
    ds_read_b64_tr_b16 a[236:237], v28 offset:0
    ds_read_b64_tr_b16 v[32:33], v28 offset:8
    ds_read_b64_tr_b16 a[244:245], v29 offset:0
    ds_read_b64_tr_b16 a[252:253], v29 offset:8
    ds_read_b64_tr_b16 v[148:149], v30 offset:0
    ds_read_b64_tr_b16 v[156:157], v30 offset:8
    ds_read_b64_tr_b16 v[164:165], v31 offset:0
    ds_read_b64_tr_b16 v[172:173], v31 offset:8
    s_waitcnt vmcnt(12) lgkmcnt(0)
    s_barrier
    s_add_u32 m0, s43, 0
    s_add_u32 s41, s58, 794624
    buffer_load_dwordx4 v16, s[8:11], s41 offen offset:0 nt lds
    s_add_u32 s41, s58, 809984
    buffer_load_dwordx4 v16, s[8:11], s41 offen offset:1024 nt lds
    s_add_u32 s41, s58, 923648
    buffer_load_dwordx4 v16, s[8:11], s41 offen offset:2048 nt lds
    s_add_u32 s41, s58, 939008
    buffer_load_dwordx4 v16, s[8:11], s41 offen offset:3072 nt lds
    ds_write_b64 v70, v[32:33] offset:9216
    v_add_u32 v28, 36864, v24
    v_add_u32 v29, 36864, v25
    v_add_u32 v30, 36864, v26
    v_add_u32 v31, 36864, v27
    ds_read_b64_tr_b16 a[238:239], v28 offset:0
    ds_read_b64_tr_b16 v[0:1], v28 offset:8
    ds_read_b64_tr_b16 a[246:247], v29 offset:0
    ds_read_b64_tr_b16 a[254:255], v29 offset:8
    ds_read_b64_tr_b16 v[150:151], v30 offset:0
    ds_read_b64_tr_b16 v[158:159], v30 offset:8
    ds_read_b64_tr_b16 v[166:167], v31 offset:0
    ds_read_b64_tr_b16 v[174:175], v31 offset:8
    s_waitcnt vmcnt(12) lgkmcnt(0)
    s_barrier
    s_add_u32 m0, s43, 36864
    s_add_u32 s41, s59, 0
    buffer_load_dwordx4 v17, s[8:11], s41 offen offset:0 nt lds
    s_add_u32 s41, s59, 31744
    buffer_load_dwordx4 v17, s[8:11], s41 offen offset:1024 nt lds
    s_add_u32 s41, s59, 129024
    buffer_load_dwordx4 v17, s[8:11], s41 offen offset:2048 nt lds
    s_add_u32 s41, s59, 160768
    buffer_load_dwordx4 v17, s[8:11], s41 offen offset:3072 nt lds
    v_readfirstlane_b32 s94, v54
    v_readfirstlane_b32 s95, v55
    v_mov_b32 v77, v56
    s_nop 0
    v_subrev_u32 v77, s95, v77
    v_cmp_lt_u32 vcc, 16, v77
    s_nop 1
    v_cndmask_b32 v77, v77, 0, vcc
    v_bfe_u32 v79, v78, 2, 2
    v_lshl_add_u32 v77, v77, 2, v79
    s_nop 1
    v_min_u32_dpp v77, v77, v77 row_ror:1 row_mask:0xf bank_mask:0xf
    s_nop 1
    v_min_u32_dpp v77, v77, v77 row_ror:2 row_mask:0xf bank_mask:0xf
    s_nop 1
    v_min_u32_dpp v77, v77, v77 row_ror:4 row_mask:0xf bank_mask:0xf
    s_nop 0
    v_readfirstlane_b32 s97, v77
    s_cmp_eq_u32 s95, 0
    s_cselect_b32 s97, 0, s97
    s_cmp_lt_u32 s97, 3
    s_cbranch_scc1 cf_mb
    s_add_u32 s40, s24, 0
    s_add_u32 s40, s40, s33
    s_sub_u32 s41, s96, s40
    v_bfe_u32 v77, v65, 2, 5
    v_add3_u32 v77, v77, s41, 16
    v_lshlrev_b32 v78, 3, v69
    s_nop 0
    v_mov_b32_dpp v78, v77 quad_perm:[0,1,2,3] row_mask:0xc bank_mask:0xf
    buffer_load_dword v58, v78, s[4:7], s40 offen sc1
    s_add_u32 s40, s24, 524288
    s_add_u32 s40, s40, s33
    s_sub_u32 s41, s96, s40
    v_bfe_u32 v77, v65, 2, 5
    v_add3_u32 v77, v77, s41, 16
    v_lshlrev_b32 v78, 3, v69
    s_nop 0
    v_mov_b32_dpp v78, v77 quad_perm:[0,1,2,3] row_mask:0xc bank_mask:0xf
    buffer_load_dword v58, v78, s[4:7], s40 offen sc1
cf_mb:
    s_cmp_lt_u32 s94, 32
    s_cbranch_scc1 cf_mc
    s_cmp_lg_u32 s13, 0
    s_cbranch_scc1 cf_mc
    v_mov_b32 v76, 1
    v_mov_b32 v77, 0
    s_mov_b64 exec, 1
    buffer_atomic_cmpswap v[76:77], off, s[84:87], 0 offset:28 sc0
    s_mov_b64 exec, -1
cf_mc:
    s_nop 1
    ds_write_b64 v70, v[0:1] offset:9224
    v_add_u32 v28, 73728, v24
    v_add_u32 v29, 73728, v25
    v_add_u32 v30, 73728, v26
    v_add_u32 v31, 73728, v27
    ds_read_b64_tr_b16 v[176:177], v28 offset:0
    ds_read_b64_tr_b16 v[184:185], v28 offset:8
    ds_read_b64_tr_b16 v[192:193], v29 offset:0
    ds_read_b64_tr_b16 v[200:201], v29 offset:8
    ds_read_b64_tr_b16 v[208:209], v30 offset:0
    ds_read_b64_tr_b16 v[216:217], v30 offset:8
    ds_read_b64_tr_b16 v[224:225], v31 offset:0
    ds_read_b64_tr_b16 v[232:233], v31 offset:8
    s_waitcnt vmcnt(12) lgkmcnt(0)
    s_barrier
    s_mov_b64 s[8:9], s[56:57]
    s_add_u32 m0, s43, 73728
    s_add_u32 s41, s60, 128
    buffer_load_dwordx4 v18, s[8:11], s41 offen offset:0 nt lds
    s_add_u32 s41, s60, 8320
    buffer_load_dwordx4 v18, s[8:11], s41 offen offset:1024 nt lds
    s_add_u32 s41, s60, 16512
    buffer_load_dwordx4 v18, s[8:11], s41 offen offset:2048 nt lds
    s_add_u32 s41, s60, 24704
    buffer_load_dwordx4 v18, s[8:11], s41 offen offset:3072 nt lds
    v_add_u32 v28, 110592, v24
    v_add_u32 v29, 110592, v25
    v_add_u32 v30, 110592, v26
    v_add_u32 v31, 110592, v27
    ds_read_b64_tr_b16 v[178:179], v28 offset:0
    ds_read_b64_tr_b16 v[186:187], v28 offset:8
    ds_read_b64_tr_b16 v[194:195], v29 offset:0
    ds_read_b64_tr_b16 v[202:203], v29 offset:8
    ds_read_b64_tr_b16 v[210:211], v30 offset:0
    ds_read_b64_tr_b16 v[218:219], v30 offset:8
    ds_read_b64_tr_b16 v[226:227], v31 offset:0
    ds_read_b64_tr_b16 v[234:235], v31 offset:8
    s_waitcnt vmcnt(12) lgkmcnt(0)
    s_barrier
    s_add_u32 m0, s43, 110592
    s_add_u32 s41, s61, 128
    buffer_load_dwordx4 v18, s[8:11], s41 offen offset:0 nt lds
    s_add_u32 s41, s61, 8320
    buffer_load_dwordx4 v18, s[8:11], s41 offen offset:1024 nt lds
    s_add_u32 s41, s61, 16512
    buffer_load_dwordx4 v18, s[8:11], s41 offen offset:2048 nt lds
    s_add_u32 s41, s61, 24704
    buffer_load_dwordx4 v18, s[8:11], s41 offen offset:3072 nt lds
    v_add_u32 v28, 147456, v24
    v_add_u32 v29, 147456, v25
    v_add_u32 v30, 147456, v26
    v_add_u32 v31, 147456, v27
    ds_read_b64_tr_b16 v[180:181], v28 offset:0
    ds_read_b64_tr_b16 v[188:189], v28 offset:8
    ds_read_b64_tr_b16 v[196:197], v29 offset:0
    ds_read_b64_tr_b16 v[204:205], v29 offset:8
    ds_read_b64_tr_b16 v[212:213], v30 offset:0
    ds_read_b64_tr_b16 v[220:221], v30 offset:8
    ds_read_b64_tr_b16 v[228:229], v31 offset:0
    ds_read_b64_tr_b16 v[236:237], v31 offset:8
    s_waitcnt vmcnt(12) lgkmcnt(0)
    s_barrier
    s_add_u32 m0, s43, 147456
    s_add_u32 s41, s62, 128
    buffer_load_dwordx4 v18, s[8:11], s41 offen offset:0 nt lds
    s_add_u32 s41, s62, 8320
    buffer_load_dwordx4 v18, s[8:11], s41 offen offset:1024 nt lds
    s_add_u32 s41, s62, 16512
    buffer_load_dwordx4 v18, s[8:11], s41 offen offset:2048 nt lds
    s_add_u32 s41, s62, 24704
    buffer_load_dwordx4 v18, s[8:11], s41 offen offset:3072 nt lds
    v_add_u32 v28, 0, v24
    v_add_u32 v29, 0, v25
    v_add_u32 v30, 0, v26
    v_add_u32 v31, 0, v27
    ds_read_b64_tr_b16 v[182:183], v28 offset:0
    ds_read_b64_tr_b16 v[190:191], v28 offset:8
    ds_read_b64_tr_b16 v[198:199], v29 offset:0
    ds_read_b64_tr_b16 v[206:207], v29 offset:8
    ds_read_b64_tr_b16 v[214:215], v30 offset:0
    ds_read_b64_tr_b16 v[222:223], v30 offset:8
    ds_read_b64_tr_b16 v[230:231], v31 offset:0
    ds_read_b64_tr_b16 v[238:239], v31 offset:8
    s_waitcnt vmcnt(12) lgkmcnt(0)
    s_barrier
    s_add_u32 m0, s43, 0
    s_add_u32 s41, s63, 128
    buffer_load_dwordx4 v18, s[8:11], s41 offen offset:0 nt lds
    s_add_u32 s41, s63, 8320
    buffer_load_dwordx4 v18, s[8:11], s41 offen offset:1024 nt lds
    s_add_u32 s41, s63, 16512
    buffer_load_dwordx4 v18, s[8:11], s41 offen offset:2048 nt lds
    s_add_u32 s41, s63, 24704
    buffer_load_dwordx4 v18, s[8:11], s41 offen offset:3072 nt lds
    v_mov_b32 v78, v21
    v_mov_b32 v79, v22
    v_add_u32 v77, 36864, v20
    ds_read_b64_tr_b16 v[240:241], v77 offset:0
    ds_read_b64_tr_b16 v[242:243], v77 offset:4096
    ds_read_b64_tr_b16 v[244:245], v77 offset:8192
    ds_read_b64_tr_b16 v[246:247], v77 offset:12288
    ds_read_b64_tr_b16 v[248:249], v77 offset:8
    ds_read_b64_tr_b16 v[250:251], v77 offset:4104
    ds_read_b64_tr_b16 v[252:253], v77 offset:8200
    ds_read_b64_tr_b16 v[254:255], v77 offset:12296
    s_waitcnt vmcnt(12) lgkmcnt(0)
    s_barrier
    v_add_u32 v77, 73728, v79
    s_waitcnt lgkmcnt(0)
    ds_read_b64_tr_b16 v[0:1], v77 offset:0
    ds_read_b64_tr_b16 v[2:3], v77 offset:256
    ds_read_b64_tr_b16 v[4:5], v77 offset:2048
    ds_read_b64_tr_b16 v[6:7], v77 offset:2304
    ds_read_b64_tr_b16 v[8:9], v77 offset:8
    ds_read_b64_tr_b16 v[10:11], v77 offset:264
    ds_read_b64_tr_b16 v[12:13], v77 offset:2056
    ds_read_b64_tr_b16 v[14:15], v77 offset:2312
    s_waitcnt vmcnt(8) lgkmcnt(0)
    s_barrier
    v_add_u32 v77, 110592, v78
    ds_read_b64_tr_b16 v[16:17], v77 offset:0
    ds_read_b64_tr_b16 v[18:19], v77 offset:256
    ds_read_b64_tr_b16 v[20:21], v77 offset:2048
    ds_read_b64_tr_b16 v[22:23], v77 offset:2304
    ds_read_b64_tr_b16 v[24:25], v77 offset:8
    ds_read_b64_tr_b16 v[26:27], v77 offset:264
    ds_read_b64_tr_b16 v[28:29], v77 offset:2056
    ds_read_b64_tr_b16 v[30:31], v77 offset:2312
    s_waitcnt vmcnt(4) lgkmcnt(0)
    s_barrier
    v_add_u32 v77, 147456, v78
    ds_read_b64_tr_b16 v[32:33], v77 offset:0
    ds_read_b64_tr_b16 v[34:35], v77 offset:256
    ds_read_b64_tr_b16 v[36:37], v77 offset:2048
    ds_read_b64_tr_b16 v[38:39], v77 offset:2304
    ds_read_b64_tr_b16 v[40:41], v77 offset:8
    ds_read_b64_tr_b16 v[42:43], v77 offset:264
    ds_read_b64_tr_b16 v[44:45], v77 offset:2056
    ds_read_b64_tr_b16 v[46:47], v77 offset:2312
    s_waitcnt vmcnt(0) lgkmcnt(0)
    s_barrier
    v_add_u32 v77, 0, v78
    ds_read_b64_tr_b16 v[48:49], v77 offset:0
    ds_read_b64_tr_b16 v[50:51], v77 offset:256
    ds_read_b64_tr_b16 v[52:53], v77 offset:2048
    ds_read_b64_tr_b16 v[54:55], v77 offset:2304
    ds_read_b64_tr_b16 v[56:57], v77 offset:8
    ds_read_b64_tr_b16 v[58:59], v77 offset:264
    ds_read_b64_tr_b16 v[60:61], v77 offset:2056
    ds_read_b64_tr_b16 v[62:63], v77 offset:2312
    s_waitcnt lgkmcnt(0)
    s_barrier
    ds_write_b128 v70, v[0:3] offset:20480
    ds_write_b128 v70, v[4:7] offset:21504
    ds_write_b128 v70, v[8:11] offset:22528
    ds_write_b128 v70, v[12:15] offset:23552
    ds_write_b128 v70, v[16:19] offset:24576
    ds_write_b128 v70, v[20:23] offset:25600
    ds_write_b128 v70, v[24:27] offset:26624
    ds_write_b128 v70, v[28:31] offset:27648
    ds_write_b128 v70, v[32:35] offset:28672
    ds_write_b128 v70, v[36:39] offset:29696
    ds_write_b128 v70, v[40:43] offset:30720
    ds_write_b128 v70, v[44:47] offset:31744
    ds_write_b128 v70, v[48:51] offset:32768
    ds_write_b128 v70, v[52:55] offset:33792
    ds_write_b128 v70, v[56:59] offset:34816
    ds_write_b128 v70, v[60:63] offset:35840
    s_waitcnt lgkmcnt(0)
    v_bfe_u32 v60, v65, 4, 6
    v_and_b32 v61, 15, v60
    v_lshrrev_b32 v62, 4, v60
    v_mov_b32 v50, 0x3f80
    v_mov_b32 v51, 0x3f800000
    v_and_b32 v77, 1, v62
    v_lshlrev_b32 v77, 2, v77
    v_sub_u32 v77, v61, v77
    v_and_b32 v78, 3, v61
    v_lshlrev_b32 v78, 2, v78
    v_lshrrev_b32 v79, 2, v61
    v_add_u32 v78, v78, v79
    v_cmp_eq_u32 vcc, 0, v77
    s_nop 1
    v_cndmask_b32 v8, 0, v50, vcc
    v_cmp_eq_u32 vcc, 1, v77
    s_nop 1
    v_cndmask_b32 v8, v8, v51, vcc
    v_cmp_eq_u32 vcc, 0, v78
    s_nop 1
    v_cndmask_b32 v12, 0, v50, vcc
    v_cmp_eq_u32 vcc, 1, v78
    s_nop 1
    v_cndmask_b32 v12, v12, v51, vcc
    v_cmp_eq_u32 vcc, 2, v77
    s_nop 1
    v_cndmask_b32 v9, 0, v50, vcc
    v_cmp_eq_u32 vcc, 3, v77
    s_nop 1
    v_cndmask_b32 v9, v9, v51, vcc
    v_cmp_eq_u32 vcc, 2, v78
    s_nop 1
    v_cndmask_b32 v13, 0, v50, vcc
    v_cmp_eq_u32 vcc, 3, v78
    s_nop 1
    v_cndmask_b32 v13, v13, v51, vcc
    v_cmp_eq_u32 vcc, 8, v77
    s_nop 1
    v_cndmask_b32 v10, 0, v50, vcc
    v_cmp_eq_u32 vcc, 9, v77
    s_nop 1
    v_cndmask_b32 v10, v10, v51, vcc
    v_cmp_eq_u32 vcc, 4, v78
    s_nop 1
    v_cndmask_b32 v14, 0, v50, vcc
    v_cmp_eq_u32 vcc, 5, v78
    s_nop 1
    v_cndmask_b32 v14, v14, v51, vcc
    v_cmp_eq_u32 vcc, 10, v77
    s_nop 1
    v_cndmask_b32 v11, 0, v50, vcc
    v_cmp_eq_u32 vcc, 11, v77
    s_nop 1
    v_cndmask_b32 v11, v11, v51, vcc
    v_cmp_eq_u32 vcc, 6, v78
    s_nop 1
    v_cndmask_b32 v15, 0, v50, vcc
    v_cmp_eq_u32 vcc, 7, v78
    s_nop 1
    v_cndmask_b32 v15, v15, v51, vcc
    v_lshlrev_b32 v77, 4, v61
    ds_write_b128 v69, v[8:11] offset:15360
    ds_write_b128 v77, v[12:15] offset:15872
    s_waitcnt vmcnt(0) lgkmcnt(0)
    s_cmp_lg_u32 s95, 0
    s_cbranch_scc1 cf_hn
    s_mov_b32 s88, 4194304
gn2:
    buffer_load_dword v2, off, s[84:87], 0 offset:216 sc1
    s_waitcnt vmcnt(0)
    v_readfirstlane_b32 s95, v2
    s_sub_u32 s88, s88, 1
    s_cbranch_scc1 gn2x
    s_cmp_eq_u32 s95, 0
    s_cbranch_scc1 gn2
gn2x:
cf_hn:
    v_mov_b32 v2, 1
    s_cmp_lg_u32 s13, 0
    s_cbranch_scc1 cf_noarr
    s_mov_b64 exec, 1
    s_mov_b32 s42, 1
    v_mov_b32 v4, v76
    s_cmp_ge_u32 s94, 32
    s_cbranch_scc1 cf_have
    s_mov_b32 s40, 131072
    s_mov_b32 s42, 2
cf_startpoll:
    buffer_load_dword v3, off, s[84:87], 0 offset:132 sc1
    s_sub_u32 s40, s40, 1
    s_cbranch_scc1 cf_decide
    s_waitcnt vmcnt(0)
    v_readfirstlane_b32 s41, v3
    s_nop 1
    s_cmp_lt_u32 s41, 32
    s_cbranch_scc1 cf_startpoll
    s_mov_b32 s42, 1
cf_decide:
    v_mov_b32 v4, s42
    v_mov_b32 v5, 0
    buffer_atomic_cmpswap v[4:5], off, s[84:87], 0 offset:28 sc0
    s_waitcnt vmcnt(0)
cf_have:
    v_mov_b32 v5, s42
    v_cmp_eq_u32 vcc, 0, v4
    s_nop 1
    v_cndmask_b32 v4, v4, v5, vcc
    v_mov_b32 v5, 16192
    ds_write_b32 v5, v4
    s_waitcnt lgkmcnt(0)
    s_mov_b64 exec, -1
cf_noarr:
    s_barrier
    v_mov_b32 v5, 16192
    ds_read_b32 v4, v5
    s_waitcnt lgkmcnt(0)
    v_readfirstlane_b32 s41, v4
    s_nop 1
    s_cmp_eq_u32 s41, 1
    s_cbranch_scc1 cf_run
    v_lshrrev_b32 v0, 4, v65
    s_mov_b32 s32, s13
    s_load_dwordx16 s[48:63], s[0:1], 0
    s_waitcnt lgkmcnt(0)
    s_branch L_helper
cf_run:
    s_mov_b32 s44, 0x3e0293ee
    s_mov_b32 s45, s44
    s_or_b32 s66, s44, 0x80000000
    s_mov_b32 s48, 0x3f003f00
    s_mov_b32 s49, 0
    s_mov_b32 s50, 0x3f803f80
    s_mov_b32 s51, 0x3f803f80
    s_mov_b32 s52, 512
    s_mov_b32 s53, 1024
    s_mov_b32 s54, 1536
    s_mov_b32 s30, 0
    s_mov_b32 s37, 0
    s_lshl_b32 s47, s13, 9
    s_cmp_lg_u32 s32, 0
    s_cselect_b32 s71, s13, 3
    s_add_u32 s46, s71, 1
    s_lshr_b32 s46, s46, 1
    s_mov_b32 s14, 67125248
    s_mov_b32 s15, 67129344
    s_mov_b32 s16, 67133440
    s_mov_b32 s36, 0
    s_add_u32 s17, s68, 67108864
    s_mov_b32 s69, 0
    s_mov_b32 s70, 0
    s_lshl_b32 s26, s12, 14
    s_add_u32 s26, s26, 0
    s_mul_i32 s40, s13, 3072
    s_add_u32 s24, s26, s40
    s_lshl_b32 s96, s12, 7
    s_add_u32 s29, s96, 125845504
    s_add_u32 s96, s96, 125829120
    s_lshl_b32 s40, s12, 14
    s_add_u32 s40, s40, 68157440
    s_add_u32 s18, s40, 0
    s_add_u32 s19, s40, 4096
    s_add_u32 s20, s40, 8192
    s_add_u32 s21, s40, 12288
    s_lshr_b32 s40, s12, 3
    s_lshl_b32 s40, s40, 12
    s_and_b32 s41, s12, 7
    s_lshl_b32 s41, s41, 7
    s_add_u32 s40, s40, s41
    s_add_u32 s22, s40, 68157440
    s_add_u32 s23, s22, 1024
    s_add_u32 s25, s22, 2048
    s_mov_b32 s56, -65528
    s_cmp_lg_u32 s32, 0
    s_cselect_b64 s[38:39], -1, 0
    s_add_u32 s55, s68, 138412032
    s_cmp_eq_u32 s13, 3
    s_cselect_b64 s[100:101], 1, 0
    s_cselect_b64 s[38:39], 1, s[38:39]
    s_cselect_b32 s93, 64, 0
    s_cselect_b32 s55, s29, s55
    s_cselect_b32 s57, 0, 9216
    s_mov_b64 exec, s[100:101]
    v_mov_b32 v72, s95
    s_mov_b64 exec, -1
    s_mov_b32 s34, 0xff00ff00
    s_mov_b32 s35, 0xff00ff00
    s_lshl_b32 s28, s12, 12
    s_add_u32 s28, s28, 7340032
    s_add_u32 s27, s28, 77594624
    s_add_u32 s28, s28, 69206016
    s_cmp_ge_u32 s97, 3
    s_cbranch_scc1 cf_kvdone
    s_mov_b32 s40, 3
    v_bfe_u32 v78, v65, 2, 5
    s_mov_b32 s31, 4194304
cf_kv0:
    buffer_load_dword v77, v78, s[4:7], s96 offen offset:16 sc1
    s_waitcnt vmcnt(0)
    v_subrev_u32 v77, s95, v77
    v_cmp_lt_u32 vcc, 16, v77
    s_nop 1
    v_cndmask_b32 v77, v77, 0, vcc
    v_bfe_u32 v79, v78, 2, 2
    v_lshl_add_u32 v77, v77, 2, v79
    s_nop 1
    v_min_u32_dpp v77, v77, v77 row_ror:1 row_mask:0xf bank_mask:0xf
    s_nop 1
    v_min_u32_dpp v77, v77, v77 row_ror:2 row_mask:0xf bank_mask:0xf
    s_nop 1
    v_min_u32_dpp v77, v77, v77 row_ror:4 row_mask:0xf bank_mask:0xf
    s_nop 0
    v_readfirstlane_b32 s97, v77
    s_sub_u32 s31, s31, 1
    s_cbranch_scc1 cf_kv0_x
    s_cmp_le_u32 s40, s97
    s_cbranch_scc1 cf_kv0_x
    s_sleep 2
    s_branch cf_kv0
cf_kv0_x:
    s_add_u32 s40, s24, 0
    s_add_u32 s40, s40, s33
    s_sub_u32 s41, s96, s40
    v_bfe_u32 v77, v65, 2, 5
    v_add3_u32 v77, v77, s41, 16
    v_lshlrev_b32 v78, 3, v69
    s_nop 0
    v_mov_b32_dpp v78, v77 quad_perm:[0,1,2,3] row_mask:0xc bank_mask:0xf
    buffer_load_dword v76, v78, s[4:7], s40 offen sc1
    s_add_u32 s40, s24, 524288
    s_add_u32 s40, s40, s33
    s_sub_u32 s41, s96, s40
    v_bfe_u32 v77, v65, 2, 5
    v_add3_u32 v77, v77, s41, 16
    v_lshlrev_b32 v78, 3, v69
    s_nop 0
    v_mov_b32_dpp v78, v77 quad_perm:[0,1,2,3] row_mask:0xc bank_mask:0xf
    buffer_load_dword v76, v78, s[4:7], s40 offen sc1
cf_kvdone:
    v_mov_b64 v[0:1], 0
    v_mov_b64 v[2:3], 0
    v_mov_b64 v[4:5], 0
    v_mov_b64 v[6:7], 0
    v_mov_b64 v[8:9], 0
    v_mov_b64 v[10:11], 0
    v_mov_b64 v[12:13], 0
    v_mov_b64 v[14:15], 0
    v_mov_b64 v[16:17], 0
    v_mov_b64 v[18:19], 0
    v_mov_b64 v[20:21], 0
    v_mov_b64 v[22:23], 0
    ds_read_b128 v[44:47], v70 offset:0
    ds_read_b128 v[48:51], v70 offset:1024
    ds_read_b128 v[52:55], v70 offset:2048
    ds_read_b128 v[56:59], v70 offset:3072
    ds_read_b128 v[24:27], v70 offset:4096
    ds_read_b128 v[28:31], v70 offset:5120
    ds_read_b128 v[32:35], v70 offset:6144
    ds_read_b128 v[36:39], v70 offset:7168
    buffer_load_dwordx4 v[40:43], v65, s[4:7], s14 offen offset:0 nt
    buffer_load_dwordx4 v[60:63], v66, s[4:7], s14 offen offset:0 nt
    s_mov_b32 s31, 1048576
    s_waitcnt vmcnt(0) lgkmcnt(0)
    s_branch cf_goA
cf_loop:
    s_mov_b32 s31, 1048576
    s_mov_b32 s69, s70
    s_waitcnt lgkmcnt(0)
cf_cA:
    buffer_load_dwordx4 v[40:43], v65, s[4:7], s14 offen offset:0 nt
    buffer_load_dwordx4 v[60:63], v66, s[4:7], s14 offen offset:0 nt
cf_cA1:
    v_bitop3_b32 v77, v40, v60, s70 bitop3:0x7e
    v_and_b32 v77, 1, v77
    v_cmp_ne_u32 vcc, 0, v77
    s_cbranch_vccz cf_goA
    v_bitop3_b32 v77, v40, v60, s70 bitop3:0x7e
    v_and_b32 v77, 1, v77
    v_cmp_ne_u32 vcc, 0, v77
    s_cbranch_vccz cf_goA
    v_bitop3_b32 v77, v40, v60, s70 bitop3:0x7e
    v_and_b32 v77, 1, v77
    v_cmp_ne_u32 vcc, 0, v77
    s_cbranch_vccz cf_goA
    v_bitop3_b32 v77, v40, v60, s70 bitop3:0x7e
    v_and_b32 v77, 1, v77
    v_cmp_ne_u32 vcc, 0, v77
    s_cbranch_vccz cf_goA
    buffer_load_dwordx4 v[40:43], v65, s[4:7], s14 offen offset:0 nt
    buffer_load_dwordx4 v[60:63], v66, s[4:7], s14 offen offset:0 nt
    v_bitop3_b32 v77, v40, v60, s70 bitop3:0x7e
    v_and_b32 v77, 1, v77
    v_cmp_ne_u32 vcc, 0, v77
    s_cbranch_vccz cf_goA
    v_bitop3_b32 v77, v40, v60, s70 bitop3:0x7e
    v_and_b32 v77, 1, v77
    v_cmp_ne_u32 vcc, 0, v77
    s_cbranch_vccz cf_goA
    v_bitop3_b32 v77, v40, v60, s70 bitop3:0x7e
    v_and_b32 v77, 1, v77
    v_cmp_ne_u32 vcc, 0, v77
    s_cbranch_vccz cf_goA
    v_bitop3_b32 v77, v40, v60, s70 bitop3:0x7e
    v_and_b32 v77, 1, v77
    v_cmp_ne_u32 vcc, 0, v77
    s_cbranch_vccz cf_goA
    buffer_load_dwordx4 v[40:43], v65, s[4:7], s14 offen offset:0 nt
    buffer_load_dwordx4 v[60:63], v66, s[4:7], s14 offen offset:0 nt
    v_bitop3_b32 v77, v40, v60, s70 bitop3:0x7e
    v_and_b32 v77, 1, v77
    v_cmp_ne_u32 vcc, 0, v77
    s_cbranch_vccz cf_goA
    v_bitop3_b32 v77, v40, v60, s70 bitop3:0x7e
    v_and_b32 v77, 1, v77
    v_cmp_ne_u32 vcc, 0, v77
    s_cbranch_vccz cf_goA
    v_bitop3_b32 v77, v40, v60, s70 bitop3:0x7e
    v_and_b32 v77, 1, v77
    v_cmp_ne_u32 vcc, 0, v77
    s_cbranch_vccz cf_goA
    v_bitop3_b32 v77, v40, v60, s70 bitop3:0x7e
    v_and_b32 v77, 1, v77
    v_cmp_ne_u32 vcc, 0, v77
    s_cbranch_vccz cf_goA
    buffer_load_dwordx4 v[40:43], v65, s[4:7], s14 offen offset:0 nt
    buffer_load_dwordx4 v[60:63], v66, s[4:7], s14 offen offset:0 nt
    v_bitop3_b32 v77, v40, v60, s70 bitop3:0x7e
    v_and_b32 v77, 1, v77
    v_cmp_ne_u32 vcc, 0, v77
    s_cbranch_vccz cf_goA
    v_bitop3_b32 v77, v40, v60, s70 bitop3:0x7e
    v_and_b32 v77, 1, v77
    v_cmp_ne_u32 vcc, 0, v77
    s_cbranch_vccz cf_goA
    v_bitop3_b32 v77, v40, v60, s70 bitop3:0x7e
    v_and_b32 v77, 1, v77
    v_cmp_ne_u32 vcc, 0, v77
    s_cbranch_vccz cf_goA
    v_bitop3_b32 v77, v40, v60, s70 bitop3:0x7e
    v_and_b32 v77, 1, v77
    v_cmp_ne_u32 vcc, 0, v77
    s_cbranch_vccz cf_goA
    s_sub_u32 s31, s31, 64
    s_cbranch_scc0 cf_cA
cf_goA:
    ds_write_b128 v65, v[40:43] offset:0
    v_smfmac_f32_16x16x64_bf16 v[0:3], v[40:43], v[44:51], v64
    v_smfmac_f32_16x16x64_bf16 v[4:7], v[40:43], v[52:59], v64
    buffer_load_dwordx4 v[44:47], v65, s[4:7], s15 offen offset:0 nt
    v_smfmac_f32_16x16x64_bf16 v[0:3], v[60:63], v[24:31], v64
    s_add_u32 s40, s24, 1048576
    s_add_u32 s40, s40, s33
    s_sub_u32 s41, s96, s40
    v_smfmac_f32_16x16x64_bf16 v[4:7], v[60:63], v[32:39], v64
    ds_read_b128 v[24:27], v70 offset:8192
    s_cmp_lt_u32 s97, s93
    s_cselect_b32 s41, s41, 0
    v_smfmac_f32_16x16x64_bf16 v[8:11], v[40:43], a[96:103], v64
    ds_read_b128 v[28:31], v70 offset:9216
    v_smfmac_f32_16x16x64_bf16 v[12:15], v[40:43], a[104:111], v64
    ds_read_b128 v[32:35], v70 offset:10240
    s_waitcnt lgkmcnt(3)
    s_barrier
    ds_read_b128 v[48:51], v67 offset:0
    v_smfmac_f32_16x16x64_bf16 v[8:11], v[60:63], a[112:119], v64
    ds_read_b128 v[36:39], v70 offset:11264
    v_bitop3_b32 v79, v73, -9, s54 bitop3:0x6a
    v_smfmac_f32_16x16x64_bf16 v[12:15], v[60:63], a[120:127], v64
    buffer_load_dwordx4 v[44:47], v65, s[4:7], s15 offen offset:0 nt
    v_smfmac_f32_16x16x64_bf16 v[16:19], v[40:43], a[232:239], v64
    ds_read_b128 v[52:55], v68 offset:0
    s_waitcnt lgkmcnt(4)
    v_bfe_u32 v77, v65, 2, 5
    v_smfmac_f32_16x16x64_bf16 v[20:23], v[40:43], v[24:31], v64
    ds_read_b128 v[24:27], v70 offset:12288
    s_waitcnt lgkmcnt(3)
    v_smfmac_f32_16x16x64_bf16 v[0:3], v[48:51], a[0:7], v64
    ds_read_b128 v[28:31], v70 offset:13312
    s_waitcnt lgkmcnt(3)
    v_add3_u32 v77, v77, s41, 16
    v_smfmac_f32_16x16x64_bf16 v[4:7], v[48:51], v[32:39], v64
    buffer_load_dwordx4 v[40:43], v65, s[4:7], s16 offen offset:0 nt
    v_smfmac_f32_16x16x64_bf16 v[16:19], v[60:63], a[240:247], v64
    ds_read_b128 v[32:35], v70 offset:14336
    v_lshlrev_b32 v78, 3, v69
    v_smfmac_f32_16x16x64_bf16 v[20:23], v[60:63], a[248:255], v64
    ds_read_b128 v[36:39], v70 offset:15360
    v_smfmac_f32_16x16x64_bf16 v[8:11], v[48:51], a[128:135], v64
    s_waitcnt vmcnt(2)
    v_mov_b32_dpp v78, v77 quad_perm:[0,1,2,3] row_mask:0xc bank_mask:0xf
    v_smfmac_f32_16x16x64_bf16 v[12:15], v[48:51], a[136:143], v64
    buffer_load_dwordx4 v[58:61], v65, s[4:7], s24 offen offset:3072 sc1
    s_waitcnt lgkmcnt(2)
    v_and_b32 v77, s36, v44
    v_smfmac_f32_16x16x64_bf16 v[12:15], v[52:55], v[24:31], v64
    ds_write_b128 v65, v[44:47] offset:4096
    v_smfmac_f32_16x16x64_bf16 v[0:3], v[52:55], a[8:15], v64
    v_cmp_ne_u32 vcc, s70, v77
    v_smfmac_f32_16x16x64_bf16 v[8:11], v[52:55], a[144:151], v64
    s_waitcnt lgkmcnt(1)
    v_smfmac_f32_16x16x64_bf16 v[4:7], v[52:55], v[32:39], v64
    s_cbranch_vccnz cf_spinB
cf_backB:
    v_smfmac_f32_16x16x64_bf16 v[16:19], v[44:47], v[176:183], v64
    buffer_load_dwordx4 v[24:27], v65, s[4:7], s24 offen offset:0 sc1
    s_waitcnt lgkmcnt(0)
    s_barrier
    ds_read_b128 v[48:51], v66 offset:4096
    v_smfmac_f32_16x16x64_bf16 v[12:15], v[44:47], a[160:167], v64
    ds_read_b128 v[52:55], v67 offset:4096
    v_smfmac_f32_16x16x64_bf16 v[0:3], v[44:47], a[16:23], v64
    v_smfmac_f32_16x16x64_bf16 v[8:11], v[44:47], a[152:159], v64
    buffer_load_dwordx4 v[28:31], v65, s[4:7], s24 offen offset:1024 sc1
    v_smfmac_f32_16x16x64_bf16 v[4:7], v[44:47], a[24:31], v64
    s_waitcnt vmcnt(4)
    v_smfmac_f32_16x16x64_bf16 v[20:23], v[44:47], v[184:191], v64
    ds_read_b128 v[44:47], v68 offset:4096
    s_waitcnt lgkmcnt(2)
    v_smfmac_f32_16x16x64_bf16 v[0:3], v[48:51], a[32:39], v64
    v_smfmac_f32_16x16x64_bf16 v[8:11], v[48:51], a[168:175], v64
    buffer_load_dwordx4 v[34:37], v65, s[4:7], s24 offen offset:2048 sc1
    v_smfmac_f32_16x16x64_bf16 v[4:7], v[48:51], a[40:47], v64
    s_waitcnt vmcnt(4)
    v_and_b32 v77, s36, v40
    v_smfmac_f32_16x16x64_bf16 v[12:15], v[48:51], a[176:183], v64
    ds_read_b128 v[48:51], v69 offset:15360
    v_cmp_ne_u32 vcc, s70, v77
    v_smfmac_f32_16x16x64_bf16 v[0:3], v[52:55], a[48:55], v64
    s_waitcnt lgkmcnt(1)
    v_smfmac_f32_16x16x64_bf16 v[8:11], v[52:55], a[184:191], v64
    s_cbranch_vccnz cf_spin8
cf_back8:
    v_smfmac_f32_16x16x64_bf16 v[0:3], v[44:47], a[64:71], v64
    buffer_load_dword v76, v78, s[4:7], s40 offen sc1
    v_smfmac_f32_16x16x64_bf16 v[8:11], v[44:47], a[200:207], v64
    v_smfmac_f32_16x16x64_bf16 v[0:3], v[40:43], a[80:87], v64
    s_nop 1
    v_smfmac_f32_16x16x64_bf16 v[8:11], v[40:43], a[216:223], v64
    s_nop 1
    v_lshrrev_b32 v77, 1, v69
    v_smfmac_f32_16x16x64_bf16 v[4:7], v[52:55], a[56:63], v64
    s_nop 1
    v_cvt_pk_bf16_f32 v0, v0, v1
    v_smfmac_f32_16x16x64_bf16 v[12:15], v[52:55], a[192:199], v64
    s_nop 1
    v_cvt_pk_bf16_f32 v1, v2, v3
    v_smfmac_f32_16x16x64_bf16 v[4:7], v[44:47], a[72:79], v64
    s_nop 1
    v_cvt_pk_bf16_f32 v2, v8, v9
    v_smfmac_f32_16x16x64_bf16 v[12:15], v[44:47], a[208:215], v64
    s_nop 1
    v_cvt_pk_bf16_f32 v3, v10, v11
    v_smfmac_f32_16x16x64_bf16 v[4:7], v[40:43], a[88:95], v64
    s_waitcnt lgkmcnt(0)
    s_nop 1
    v_smfmac_f32_16x16x64_bf16 v[12:15], v[40:43], a[224:231], v64
    s_nop 1
    v_mfma_f32_16x16x32_bf16 v[8:11], v[0:3], v[48:51], 0
    s_nop 0
    v_cvt_pk_bf16_f32 v4, v4, v5
    v_cvt_pk_bf16_f32 v5, v6, v7
    s_nop 1
    v_cvt_pk_bf16_f32 v6, v12, v13
    v_cvt_pk_bf16_f32 v7, v14, v15
    s_nop 1
    v_mfma_f32_16x16x32_bf16 v[12:15], v[4:7], v[48:51], 0
    ds_read_b128 v[48:51], v66 offset:4096
    v_cvt_pk_bf16_f32 v0, v8, v9
    v_cvt_pk_bf16_f32 v1, v10, v11
    v_smfmac_f32_16x16x64_bf16 v[16:19], v[52:55], v[208:215], v64
    s_waitcnt vmcnt(2)
    s_nop 2
    v_cvt_pk_bf16_f32 v2, v12, v13
    v_cvt_pk_bf16_f32 v3, v14, v15
    s_nop 1
    v_mfma_f32_16x16x32_bf16 v[12:15], v[0:3], v[0:3], 0
    s_nop 1
    v_bitop3_b32 v78, v73, -9, s53 bitop3:0x6a
    v_mfma_f32_16x16x32_bf16 v[4:7], v[24:27], v[0:3], 0
    ds_read_b128 v[24:27], v67 offset:0
    s_nop 1
    v_mfma_f32_16x16x32_bf16 v[8:11], v[28:31], v[0:3], 0
    s_nop 0
    v_mov_b32_dpp v12, v14 row_ror:8 row_mask:0xf bank_mask:0xc
    v_mov_b32_dpp v13, v15 row_ror:8 row_mask:0xf bank_mask:0xc
    v_smfmac_f32_16x16x64_bf16 v[20:23], v[52:55], v[216:223], v64
    ds_write_b64 v71, v[12:13]
    ds_read_b128 v[52:55], v68 offset:0
    s_nop 1
    v_mov_b32_dpp v4, v8 row_ror:8 row_mask:0xf bank_mask:0xc
    v_mov_b32_dpp v5, v9 row_ror:8 row_mask:0xf bank_mask:0xc
    v_mov_b32_dpp v6, v10 row_ror:8 row_mask:0xf bank_mask:0xc
    v_mov_b32_dpp v7, v11 row_ror:8 row_mask:0xf bank_mask:0xc
    v_smfmac_f32_16x16x64_bf16 v[16:19], v[44:47], v[224:231], v64
    ds_write_b128 v65, v[4:7] offset:8192
    v_smfmac_f32_16x16x64_bf16 v[20:23], v[44:47], v[232:239], v64
    s_waitcnt lgkmcnt(3)
    v_smfmac_f32_16x16x64_bf16 v[16:19], v[24:27], v[144:151], v64
    s_waitcnt vmcnt(1)
    v_smfmac_f32_16x16x64_bf16 v[20:23], v[24:27], v[152:159], v64
    s_mov_b64 exec, s[38:39]
    buffer_store_dword v72, v75, s[4:7], s55 offen sc1
    s_mov_b64 exec, -1
    v_smfmac_f32_16x16x64_bf16 v[16:19], v[40:43], v[240:247], v64
    s_cmp_ge_u32 s30, 56
    s_waitcnt lgkmcnt(0)
    s_barrier
    ds_read_b128 v[8:11], v66 offset:8192
    v_smfmac_f32_16x16x64_bf16 v[20:23], v[40:43], v[248:255], v64
    ds_read_b128 v[12:15], v67 offset:8192
    v_smfmac_f32_16x16x64_bf16 v[16:19], v[48:51], v[192:199], v64
    ds_read_b128 v[44:47], v68 offset:8192
    v_smfmac_f32_16x16x64_bf16 v[20:23], v[48:51], v[200:207], v64
    ds_read_b64 v[24:25], v77 offset:14336
    ds_read_b64 v[26:27], v77 offset:14592
    v_smfmac_f32_16x16x64_bf16 v[16:19], v[52:55], v[160:167], v64
    ds_read_b64 v[28:29], v77 offset:14848
    ds_read_b64 v[30:31], v77 offset:15104
    v_bitop3_b32 v77, v73, -9, s52 bitop3:0x6a
    v_smfmac_f32_16x16x64_bf16 v[20:23], v[52:55], v[168:175], v64
    s_cbranch_scc1 cf_rare
cf_rare_x:
    ds_read_b128 v[48:51], v70 offset:22528
    ds_read_b128 v[52:55], v70 offset:23552
    s_waitcnt lgkmcnt(6)
    v_pk_add_f32 v[4:5], v[4:5], v[8:9]
    v_pk_add_f32 v[6:7], v[6:7], v[10:11]
    v_pk_add_f32 v[12:13], v[12:13], v[44:45]
    v_pk_add_f32 v[14:15], v[14:15], v[46:47]
    v_pk_add_f32 v[4:5], v[4:5], v[12:13]
    v_pk_add_f32 v[6:7], v[6:7], v[14:15]
    s_waitcnt lgkmcnt(2)
    v_pk_add_f32 v[24:25], v[24:25], v[26:27]
    v_pk_add_f32 v[28:29], v[28:29], v[30:31]
    v_max3_f32 v8, v4, v5, v6
    v_pk_add_f32 v[24:25], v[24:25], v[28:29]
    v_max_f32 v8, v8, v7
    v_max3_f32 v8, v8, v24, v25
    v_cvt_pk_bf16_f32 v32, v16, v17
    v_cvt_pk_bf16_f32 v38, v18, v19
    v_max_f32_dpp v8, v8, v8 row_ror:8 row_mask:0xf bank_mask:0xf
    v_mov_b32 v9, v8
    v_cvt_pk_bf16_f32 v56, v20, v21
    v_cvt_pk_bf16_f32 v62, v22, v23
    v_permlane32_swap_b32 v8, v9
    v_max_f32 v8, v8, v9
    v_mov_b32 v9, v8
    v_mov_b32 v11, 0
    v_mov_b32 v15, 0
    v_permlane16_swap_b32 v8, v9
    v_max_f32 v8, v8, v9
    v_mul_f32 v8, s66, v8
    v_pk_fma_f32 v[4:5], v[4:5], s[44:45], v[8:9] op_sel_hi:[1,1,0]
    v_pk_fma_f32 v[6:7], v[6:7], s[44:45], v[8:9] op_sel_hi:[1,1,0]
    v_pk_fma_f32 v[24:25], v[24:25], s[44:45], v[8:9] op_sel_hi:[1,1,0]
    v_exp_f32 v4, v4
    v_exp_f32 v5, v5
    v_exp_f32 v6, v6
    v_exp_f32 v7, v7
    v_exp_f32 v24, v24
    v_exp_f32 v25, v25
    v_cvt_pk_bf16_f32 v12, v4, v5
    v_cvt_pk_bf16_f32 v13, v6, v7
    v_cvt_pk_bf16_f32 v10, v24, v25
    v_cvt_pk_bf16_f32 v14, v24, v25
    v_mov_b64 v[0:1], s[48:49]
    v_mfma_f32_16x16x32_bf16 v[4:7], v[32:35], v[10:13], 0
    ds_read_b128 v[40:43], v70 offset:20480
    v_mov_b64 v[2:3], s[50:51]
    v_mfma_f32_16x16x32_bf16 v[24:27], v[36:39], v[12:15], 0
    ds_read_b128 v[44:47], v70 offset:21504
    v_mov_b64 v[8:9], 0
    v_mfma_f32_16x16x32_bf16 v[28:31], v[0:3], v[10:13], 0
    ds_read_b128 v[32:35], v70 offset:24576
    v_mov_b64 v[0:1], 0
    v_mfma_f32_16x16x32_bf16 v[16:19], v[56:59], v[10:13], 0
    ds_read_b128 v[36:39], v70 offset:25600
    v_mov_b64 v[2:3], 0
    v_mfma_f32_16x16x32_bf16 v[20:23], v[60:63], v[12:15], 0
    ds_read_b128 v[56:59], v70 offset:26624
    v_add_f32_dpp v4, v24, v4 row_ror:8 row_mask:0xf bank_mask:0xf
    v_add_f32_dpp v5, v25, v5 row_ror:8 row_mask:0xf bank_mask:0xf
    v_add_f32_dpp v6, v26, v6 row_ror:8 row_mask:0xf bank_mask:0xf
    v_add_f32_dpp v7, v27, v7 row_ror:8 row_mask:0xf bank_mask:0xf
    v_add_f32_dpp v29, v28, v28 row_ror:8 row_mask:0xf bank_mask:0xf
    v_rcp_f32 v28, v29
    v_mov_b64 v[10:11], 0
    v_add_f32_dpp v4, v16, v20 row_ror:8 row_mask:0xf bank_mask:0xc
    v_add_f32_dpp v5, v17, v21 row_ror:8 row_mask:0xf bank_mask:0xc
    v_add_f32_dpp v6, v18, v22 row_ror:8 row_mask:0xf bank_mask:0xc
    v_add_f32_dpp v7, v19, v23 row_ror:8 row_mask:0xf bank_mask:0xc
    v_pk_mul_f32 v[4:5], v[4:5], v[28:29] op_sel_hi:[1,0]
    v_pk_mul_f32 v[6:7], v[6:7], v[28:29] op_sel_hi:[1,0]
    v_cvt_pk_bf16_f32 v4, v4, v5
    v_cvt_pk_bf16_f32 v5, v6, v7
    ds_write_b64 v73, v[4:5] offset:12288
    v_mov_b32_dpp v6, v4 row_ror:8 row_mask:0xf bank_mask:0xf
    v_mov_b32_dpp v7, v5 row_ror:8 row_mask:0xf bank_mask:0xf
    v_mov_b64 v[12:13], 0
    v_mov_b64 v[14:15], 0
    v_smfmac_f32_16x16x64_bf16 v[8:11], v[4:7], v[80:87], v64
    s_waitcnt lgkmcnt(4)
    v_mov_b64 v[24:25], 0
    v_smfmac_f32_16x16x64_bf16 v[0:3], v[4:7], v[40:47], v64
    ds_read_b128 v[60:63], v70 offset:27648
    v_mov_b64 v[26:27], 0
    v_smfmac_f32_16x16x64_bf16 v[12:15], v[4:7], v[112:119], v64
    s_waitcnt lgkmcnt(1)
    s_barrier
    ds_read_b128 v[16:19], v77 offset:12288
    v_smfmac_f32_16x16x64_bf16 v[24:27], v[4:7], v[48:55], v64
    ds_read_b128 v[20:23], v78 offset:12288
    ds_read_b128 v[28:31], v79 offset:12288
    v_mov_b64 v[4:5], 0
    v_mov_b64 v[6:7], 0
    v_bfe_u32 v77, v74, 16, 1
    v_mad_i32_i24 v77, v77, s56, v74
    s_waitcnt lgkmcnt(2)
    v_smfmac_f32_16x16x64_bf16 v[8:11], v[16:19], v[88:95], v64
    ds_read_b128 v[48:51], v70 offset:28672
    v_and_b32 v72, 8, v73
    v_smfmac_f32_16x16x64_bf16 v[12:15], v[16:19], v[120:127], v64
    ds_read_b128 v[52:55], v70 offset:29696
    s_waitcnt lgkmcnt(3)
    v_mad_u32_u24 v72, v72, 63, v73
    v_smfmac_f32_16x16x64_bf16 v[8:11], v[20:23], v[96:103], v64
    ds_read_b128 v[40:43], v70 offset:30720
    v_subrev_u32 v72, s47, v72
    v_smfmac_f32_16x16x64_bf16 v[12:15], v[20:23], v[128:135], v64
    ds_read_b128 v[44:47], v70 offset:31744
    s_waitcnt lgkmcnt(4)
    v_smfmac_f32_16x16x64_bf16 v[8:11], v[28:31], v[104:111], v64
    s_add_u32 s30, s30, 1
    s_xor_b32 s70, s70, 1
    s_cmp_lg_u32 s71, 0
    v_smfmac_f32_16x16x64_bf16 v[12:15], v[28:31], v[136:143], v64
    s_nop 2
    v_smfmac_f32_16x16x64_bf16 v[0:3], v[16:19], v[32:39], v64
    ds_read_b128 v[32:35], v70 offset:32768
    ds_read_b128 v[36:39], v70 offset:33792
    v_cvt_pk_bf16_f32 v8, v8, v9
    v_cvt_pk_bf16_f32 v9, v10, v11
    v_and_or_b32 v8, v8, -2, s69
    v_cvt_pk_bf16_f32 v10, v12, v13
    v_cvt_pk_bf16_f32 v11, v14, v15
    v_smfmac_f32_16x16x64_bf16 v[24:27], v[16:19], v[56:63], v64
    buffer_store_dwordx4 v[8:11], v74, s[4:7], s22 offen
    ds_read_b128 v[56:59], v70 offset:34816
    s_waitcnt lgkmcnt(3)
    v_smfmac_f32_16x16x64_bf16 v[24:27], v[20:23], v[40:47], v64
    ds_read_b128 v[60:63], v70 offset:35840
    ds_read_b128 v[40:43], v70 offset:16384
    v_smfmac_f32_16x16x64_bf16 v[0:3], v[20:23], v[48:55], v64
    ds_read_b128 v[44:47], v70 offset:17408
    s_waitcnt lgkmcnt(4)
    v_smfmac_f32_16x16x64_bf16 v[0:3], v[28:31], v[32:39], v64
    ds_read_b128 v[48:51], v72 offset:12288
    s_waitcnt lgkmcnt(3)
    s_nop 0
    v_smfmac_f32_16x16x64_bf16 v[24:27], v[28:31], v[56:63], v64
    ds_read_b128 v[32:35], v70 offset:18432
    ds_read_b128 v[36:39], v70 offset:19456
    ds_read_b128 v[52:55], v72 offset:13312
    s_nop 0
    v_cvt_pk_bf16_f32 v0, v0, v1
    v_cvt_pk_bf16_f32 v1, v2, v3
    v_and_or_b32 v0, v0, -2, s69
    s_nop 0
    v_cvt_pk_bf16_f32 v2, v24, v25
    v_cvt_pk_bf16_f32 v3, v26, v27
    s_waitcnt lgkmcnt(3)
    v_smfmac_f32_16x16x64_bf16 v[4:7], v[48:51], v[40:47], v64
    buffer_store_dwordx4 v[0:3], v74, s[4:7], s23 offen
    s_waitcnt lgkmcnt(0)
    v_smfmac_f32_16x16x64_bf16 v[4:7], v[52:55], v[32:39], v64
    s_nop 7
    v_cvt_pk_bf16_f32 v4, v4, v5
    v_cvt_pk_bf16_f32 v5, v6, v7
    v_and_or_b32 v4, v4, -2, s69
    buffer_store_dwordx2 v[4:5], v77, s[4:7], s25 offen
    s_cbranch_scc1 cf_e1
    s_cmp_lg_u32 s37, 0
    s_cbranch_scc1 cf_f0_xt
cf_f0_xtx:
    s_nop 2
    v_mov_b32 v79, v79
    s_nop 2
    v_mov_b32 v79, v79
    s_nop 2
    v_mov_b32 v79, v79
    s_nop 2
    v_mov_b32 v79, v79
    s_nop 2
    v_mov_b32 v79, v79
    s_nop 2
    v_mov_b32 v79, v79
    s_nop 2
    v_mov_b32 v79, v79
    s_nop 2
    v_mov_b32 v79, v79
    s_nop 2
    v_mov_b32 v79, v79
    s_nop 2
    v_mov_b32 v79, v79
    buffer_load_dwordx4 v[8:11], v65, s[4:7], s18 offen nt
    buffer_load_dwordx4 v[12:15], v65, s[4:7], s19 offen nt
    buffer_load_dwordx4 v[16:19], v65, s[4:7], s20 offen nt
    buffer_load_dwordx4 v[20:23], v65, s[4:7], s21 offen nt
    v_and_b32 v77, 255, v69
    ds_read_b128 v[4:7], v77 offset:15872
    ds_read_b128 v[44:47], v70 offset:0
    ds_read_b128 v[48:51], v70 offset:1024
    ds_read_b128 v[52:55], v70 offset:2048
    ds_read_b128 v[56:59], v70 offset:3072
    ds_read_b128 v[24:27], v70 offset:4096
    ds_read_b128 v[28:31], v70 offset:5120
    ds_read_b128 v[32:35], v70 offset:6144
    ds_read_b128 v[36:39], v70 offset:7168
    s_mov_b32 s31, 65536
    s_add_u32 s24, s24, 524288
    s_add_u32 s26, s26, 524288
    s_add_u32 s55, s55, s57
    s_mov_b32 s14, 67108864
    s_mov_b32 s15, 67112960
    s_mov_b32 s16, 67117056
    s_mov_b32 s36, 1
    v_mov_b32 v40, s69
    v_mov_b32 v60, s69
    v_and_b32 v79, 12, v75
    v_cmp_eq_u32 vcc, 0, v79
    s_nop 1
    v_cndmask_b32 v79, 0, 1, vcc
    s_waitcnt lgkmcnt(0)
    s_waitcnt vmcnt(3)
    v_xor_b32 v77, s69, v8
    v_mfma_f32_16x16x32_bf16 v[0:3], v[4:7], v[8:11], 0
    v_mov_b64 v[8:9], 0
    v_mov_b64 v[10:11], 0
    s_waitcnt vmcnt(2)
    v_bitop3_b32 v77, v77, v12, s69 bitop3:0xf6
    v_mfma_f32_16x16x32_bf16 v[0:3], v[4:7], v[12:15], v[0:3]
    v_mov_b64 v[12:13], 0
    v_mov_b64 v[14:15], 0
    s_waitcnt vmcnt(1)
    v_bitop3_b32 v77, v77, v16, s69 bitop3:0xf6
    v_mfma_f32_16x16x32_bf16 v[0:3], v[4:7], v[16:19], v[0:3]
    v_mov_b64 v[16:17], 0
    v_mov_b64 v[18:19], 0
    s_waitcnt vmcnt(0)
    v_bitop3_b32 v77, v77, v20, s69 bitop3:0xf6
    v_mfma_f32_16x16x32_bf16 v[0:3], v[4:7], v[20:23], v[0:3]
    v_and_b32 v77, 1, v77
    v_cmp_ne_u32 vcc, 0, v77
    v_mov_b64 v[20:21], 0
    v_mov_b64 v[22:23], 0
    s_cmp_eq_u64 vcc, 0
    s_cselect_b64 s[42:43], -1, 0
    s_nop 1
    v_add_f32_dpp v0, v0, v0 row_ror:8 row_mask:0xf bank_mask:0xf
    v_add_f32_dpp v1, v1, v1 row_ror:8 row_mask:0xf bank_mask:0xf
    s_mov_b64 exec, s[42:43]
    v_cvt_pk_bf16_f32 v72, v0, v1
    v_bfi_b32 v72, v79, s70, v72
    buffer_store_dword v72, v75, s[4:7], s17 offen offset:0
    s_mov_b64 exec, -1
    s_cbranch_scc0 cf_f0_retry
cf_f0_go:
    v_mov_b64 v[0:1], 0
    v_mov_b64 v[2:3], 0
    v_mov_b64 v[4:5], 0
    v_mov_b64 v[6:7], 0
    s_nop 2
    v_mov_b32 v79, v79
    s_nop 2
    v_mov_b32 v79, v79
    s_nop 2
    v_mov_b32 v79, v79
    s_nop 2
    v_mov_b32 v79, v79
    s_branch cf_loop
cf_e1:
    s_cmp_lg_u32 s71, 2
    s_cbranch_scc1 cf_f1
    v_and_b32 v77, 255, v69
    ds_read_b128 v[4:7], v77 offset:15872
    ds_read_b128 v[44:47], v70 offset:0
    ds_read_b128 v[48:51], v70 offset:1024
    ds_read_b128 v[52:55], v70 offset:2048
    ds_read_b128 v[56:59], v70 offset:3072
    ds_read_b128 v[24:27], v70 offset:4096
    ds_read_b128 v[28:31], v70 offset:5120
    ds_read_b128 v[32:35], v70 offset:6144
    ds_read_b128 v[36:39], v70 offset:7168
    s_mov_b32 s31, 65536
    s_add_u32 s24, s24, 524288
    s_add_u32 s26, s26, 524288
    s_add_u32 s55, s55, s57
    s_mov_b32 s14, 67108864
    s_mov_b32 s15, 67112960
    s_mov_b32 s16, 67117056
    s_mov_b32 s36, 1
    v_mov_b32 v40, s69
    v_mov_b32 v60, s69
    v_and_b32 v79, 12, v75
    v_cmp_eq_u32 vcc, 0, v79
    s_nop 1
    v_cndmask_b32 v79, 0, 1, vcc
    s_cmp_lg_u32 s37, 0
    s_cbranch_scc1 cf_f2_xt
cf_f2_xtx:
    s_nop 2
    v_mov_b32 v79, v79
    s_nop 2
    v_mov_b32 v79, v79
    s_nop 2
    v_mov_b32 v79, v79
    s_nop 2
    v_mov_b32 v79, v79
    s_nop 2
    v_mov_b32 v79, v79
    s_nop 2
    v_mov_b32 v79, v79
    s_nop 2
    v_mov_b32 v79, v79
    s_nop 2
    v_mov_b32 v79, v79
    s_nop 2
    v_mov_b32 v79, v79
    s_nop 2
    v_mov_b32 v79, v79
    s_nop 2
    v_mov_b32 v79, v79
    s_nop 2
    v_mov_b32 v79, v79
    s_nop 2
    v_mov_b32 v79, v79
    s_waitcnt vmcnt(0)
    buffer_load_dwordx4 v[8:11], v65, s[4:7], s18 offen nt
    buffer_load_dwordx4 v[12:15], v65, s[4:7], s19 offen nt
    buffer_load_dwordx4 v[16:19], v65, s[4:7], s20 offen nt
    buffer_load_dwordx4 v[20:23], v65, s[4:7], s21 offen nt
    s_nop 2
    v_mov_b32 v79, v79
    s_nop 2
    v_mov_b32 v79, v79
    s_nop 2
    v_mov_b32 v79, v79
    s_nop 2
    v_mov_b32 v79, v79
    s_nop 2
    v_mov_b32 v79, v79
    s_nop 2
    v_mov_b32 v79, v79
    s_nop 2
    v_mov_b32 v79, v79
    s_nop 2
    v_mov_b32 v79, v79
    s_nop 2
    v_mov_b32 v79, v79
    s_nop 2
    v_mov_b32 v79, v79
    buffer_load_dwordx4 v[40:43], v65, s[4:7], s14 offen offset:0 nt
    buffer_load_dwordx4 v[60:63], v66, s[4:7], s14 offen offset:0 nt
    s_waitcnt lgkmcnt(0)
    s_waitcnt vmcnt(5)
    v_xor_b32 v77, s69, v8
    v_bitop3_b32 v77, v77, v10, s69 bitop3:0xf6
    v_mfma_f32_16x16x32_bf16 v[0:3], v[4:7], v[8:11], 0
    v_mov_b64 v[8:9], 0
    v_mov_b64 v[10:11], 0
    s_waitcnt vmcnt(4)
    v_bitop3_b32 v77, v77, v12, s69 bitop3:0xf6
    v_bitop3_b32 v77, v77, v14, s69 bitop3:0xf6
    v_mfma_f32_16x16x32_bf16 v[0:3], v[4:7], v[12:15], v[0:3]
    v_mov_b64 v[12:13], 0
    v_mov_b64 v[14:15], 0
    s_waitcnt vmcnt(3)
    v_bitop3_b32 v77, v77, v16, s69 bitop3:0xf6
    v_bitop3_b32 v77, v77, v18, s69 bitop3:0xf6
    v_mfma_f32_16x16x32_bf16 v[0:3], v[4:7], v[16:19], v[0:3]
    v_mov_b64 v[16:17], 0
    v_mov_b64 v[18:19], 0
    s_waitcnt vmcnt(2)
    v_bitop3_b32 v77, v77, v20, s69 bitop3:0xf6
    v_bitop3_b32 v77, v77, v22, s69 bitop3:0xf6
    v_mfma_f32_16x16x32_bf16 v[0:3], v[4:7], v[20:23], v[0:3]
    v_and_b32 v77, 1, v77
    v_cmp_ne_u32 vcc, 0, v77
    v_mov_b64 v[20:21], 0
    v_mov_b64 v[22:23], 0
    buffer_load_dwordx4 v[40:43], v65, s[4:7], s14 offen offset:0 nt
    buffer_load_dwordx4 v[60:63], v66, s[4:7], s14 offen offset:0 nt
    s_cmp_eq_u64 vcc, 0
    s_cselect_b64 s[42:43], -1, 0
    v_add_f32 v2, v0, v1
    s_nop 1
    v_add_f32_dpp v2, v2, v2 row_ror:8 row_mask:0xf bank_mask:0xf
    s_nop 1
    v_mov_b32_dpp v0, v2 quad_perm:[0,0,2,2] row_mask:0xf bank_mask:0xf
    v_mov_b32_dpp v1, v2 quad_perm:[1,1,3,3] row_mask:0xf bank_mask:0xf
    s_mov_b64 exec, s[42:43]
    v_cvt_pk_bf16_f32 v72, v0, v1
    v_bfi_b32 v72, v79, s70, v72
    buffer_store_dword v72, v75, s[4:7], s17 offen offset:0
    buffer_store_dword v72, v75, s[4:7], s17 offen offset:1024
    buffer_store_dword v72, v75, s[4:7], s17 offen offset:2048
    buffer_store_dword v72, v75, s[4:7], s17 offen offset:3072
    s_mov_b64 exec, -1
    s_cbranch_scc0 cf_f2_retry
cf_f2_go:
    v_mov_b64 v[0:1], 0
    v_mov_b64 v[2:3], 0
    v_mov_b64 v[4:5], 0
    v_mov_b64 v[6:7], 0
    s_branch cf_loop
cf_f1:
    s_cmp_lg_u32 s32, 1
    s_cbranch_scc1 cf_f3
    v_and_b32 v77, 255, v69
    ds_read_b128 v[4:7], v77 offset:15872
    ds_read_b128 v[44:47], v70 offset:0
    ds_read_b128 v[48:51], v70 offset:1024
    ds_read_b128 v[52:55], v70 offset:2048
    ds_read_b128 v[56:59], v70 offset:3072
    ds_read_b128 v[24:27], v70 offset:4096
    ds_read_b128 v[28:31], v70 offset:5120
    ds_read_b128 v[32:35], v70 offset:6144
    ds_read_b128 v[36:39], v70 offset:7168
    s_mov_b32 s31, 65536
    s_add_u32 s24, s24, 524288
    s_add_u32 s26, s26, 524288
    s_add_u32 s55, s55, s57
    s_mov_b32 s14, 67108864
    s_mov_b32 s15, 67112960
    s_mov_b32 s16, 67117056
    s_mov_b32 s36, 1
    v_mov_b32 v40, s69
    v_mov_b32 v60, s69
    v_and_b32 v79, 12, v75
    v_cmp_eq_u32 vcc, 0, v79
    s_nop 1
    v_cndmask_b32 v79, 0, 1, vcc
    s_cmp_lg_u32 s37, 0
    s_cbranch_scc1 cf_f1_xt
cf_f1_xtx:
    s_nop 2
    v_mov_b32 v79, v79
    s_nop 2
    v_mov_b32 v79, v79
    s_nop 2
    v_mov_b32 v79, v79
    s_nop 2
    v_mov_b32 v79, v79
    s_nop 2
    v_mov_b32 v79, v79
    s_nop 2
    v_mov_b32 v79, v79
    s_nop 2
    v_mov_b32 v79, v79
    s_nop 2
    v_mov_b32 v79, v79
    s_nop 2
    v_mov_b32 v79, v79
    s_waitcnt vmcnt(0)
    buffer_load_dwordx4 v[8:11], v65, s[4:7], s18 offen nt
    buffer_load_dwordx4 v[12:15], v65, s[4:7], s19 offen nt
    buffer_load_dwordx4 v[16:19], v65, s[4:7], s20 offen nt
    buffer_load_dwordx4 v[20:23], v65, s[4:7], s21 offen nt
    s_nop 2
    v_mov_b32 v79, v79
    s_nop 2
    v_mov_b32 v79, v79
    s_nop 2
    v_mov_b32 v79, v79
    s_nop 2
    v_mov_b32 v79, v79
    s_nop 2
    v_mov_b32 v79, v79
    s_nop 2
    v_mov_b32 v79, v79
    s_nop 2
    v_mov_b32 v79, v79
    s_nop 2
    v_mov_b32 v79, v79
    s_nop 2
    v_mov_b32 v79, v79
    s_nop 2
    v_mov_b32 v79, v79
    buffer_load_dwordx4 v[40:43], v65, s[4:7], s14 offen offset:0 nt
    buffer_load_dwordx4 v[60:63], v66, s[4:7], s14 offen offset:0 nt
    s_waitcnt lgkmcnt(0)
    s_waitcnt vmcnt(5)
    v_xor_b32 v77, s69, v8
    v_mfma_f32_16x16x32_bf16 v[0:3], v[4:7], v[8:11], 0
    v_mov_b64 v[8:9], 0
    v_mov_b64 v[10:11], 0
    s_waitcnt vmcnt(4)
    v_bitop3_b32 v77, v77, v12, s69 bitop3:0xf6
    v_mfma_f32_16x16x32_bf16 v[0:3], v[4:7], v[12:15], v[0:3]
    v_mov_b64 v[12:13], 0
    v_mov_b64 v[14:15], 0
    s_waitcnt vmcnt(3)
    v_bitop3_b32 v77, v77, v16, s69 bitop3:0xf6
    v_mfma_f32_16x16x32_bf16 v[0:3], v[4:7], v[16:19], v[0:3]
    v_mov_b64 v[16:17], 0
    v_mov_b64 v[18:19], 0
    s_waitcnt vmcnt(2)
    v_bitop3_b32 v77, v77, v20, s69 bitop3:0xf6
    v_mfma_f32_16x16x32_bf16 v[0:3], v[4:7], v[20:23], v[0:3]
    v_and_b32 v77, 1, v77
    v_cmp_ne_u32 vcc, 0, v77
    v_mov_b64 v[20:21], 0
    v_mov_b64 v[22:23], 0
    buffer_load_dwordx4 v[40:43], v65, s[4:7], s14 offen offset:0 nt
    buffer_load_dwordx4 v[60:63], v66, s[4:7], s14 offen offset:0 nt
    s_cmp_eq_u64 vcc, 0
    s_cselect_b64 s[42:43], -1, 0
    v_add_f32_dpp v0, v0, v0 row_ror:8 row_mask:0xf bank_mask:0xf
    v_add_f32_dpp v1, v1, v1 row_ror:8 row_mask:0xf bank_mask:0xf
    s_mov_b64 exec, s[42:43]
    v_cvt_pk_bf16_f32 v72, v0, v1
    v_bfi_b32 v72, v79, s70, v72
    buffer_store_dword v72, v75, s[4:7], s17 offen offset:0
    s_mov_b64 exec, -1
    s_cbranch_scc0 cf_f1_retry
cf_f1_go:
    v_mov_b64 v[0:1], 0
    v_mov_b64 v[2:3], 0
    v_mov_b64 v[4:5], 0
    v_mov_b64 v[6:7], 0
    s_branch cf_loop
cf_f3:
    v_and_b32 v77, 255, v69
    ds_read_b128 v[4:7], v77 offset:15872
    ds_read_b128 v[44:47], v70 offset:0
    ds_read_b128 v[48:51], v70 offset:1024
    ds_read_b128 v[52:55], v70 offset:2048
    ds_read_b128 v[56:59], v70 offset:3072
    ds_read_b128 v[24:27], v70 offset:4096
    ds_read_b128 v[28:31], v70 offset:5120
    ds_read_b128 v[32:35], v70 offset:6144
    ds_read_b128 v[36:39], v70 offset:7168
    s_mov_b32 s31, 65536
    s_add_u32 s24, s24, 524288
    s_add_u32 s26, s26, 524288
    s_add_u32 s55, s55, s57
    s_mov_b32 s14, 67108864
    s_mov_b32 s15, 67112960
    s_mov_b32 s16, 67117056
    s_mov_b32 s36, 1
    v_mov_b32 v40, s69
    v_mov_b32 v60, s69
    v_and_b32 v79, 12, v75
    v_cmp_eq_u32 vcc, 0, v79
    s_nop 1
    v_cndmask_b32 v79, 0, 1, vcc
    s_add_u32 s40, s30, s95
    v_mov_b32 v72, s40
    s_waitcnt lgkmcnt(0)
    v_mov_b64 v[0:1], 0
    v_mov_b64 v[2:3], 0
    v_mov_b64 v[4:5], 0
    v_mov_b64 v[6:7], 0
    v_mov_b64 v[8:9], 0
    v_mov_b64 v[10:11], 0
    v_mov_b64 v[12:13], 0
    v_mov_b64 v[14:15], 0
    v_mov_b64 v[16:17], 0
    v_mov_b64 v[18:19], 0
    v_mov_b64 v[20:21], 0
    v_mov_b64 v[22:23], 0
    s_nop 2
    v_mov_b32 v79, v79
    s_nop 2
    v_mov_b32 v79, v79
    s_nop 2
    v_mov_b32 v79, v79
    s_nop 2
    v_mov_b32 v79, v79
    s_nop 2
    v_mov_b32 v79, v79
    s_nop 2
    v_mov_b32 v79, v79
    s_nop 2
    v_mov_b32 v79, v79
    s_nop 2
    v_mov_b32 v79, v79
    s_nop 2
    v_mov_b32 v79, v79
    s_nop 2
    v_mov_b32 v79, v79
    s_nop 2
    v_mov_b32 v79, v79
    s_nop 2
    v_mov_b32 v79, v79
    s_nop 2
    v_mov_b32 v79, v79
    s_nop 2
    v_mov_b32 v79, v79
    s_nop 2
    v_mov_b32 v79, v79
    s_waitcnt vmcnt(0)
    s_cmp_lt_u32 s97, s93
    s_cbranch_scc1 cf_kvwait
    s_nop 2
    v_mov_b32 v79, v79
    s_nop 2
    v_mov_b32 v79, v79
    s_nop 2
    v_mov_b32 v79, v79
    s_nop 2
    v_mov_b32 v79, v79
    s_nop 2
    v_mov_b32 v79, v79
    s_nop 2
    v_mov_b32 v79, v79
    s_nop 2
    v_mov_b32 v79, v79
    s_nop 2
    v_mov_b32 v79, v79
cf_kvok:
    s_branch cf_loop
cf_f0_xt:
    s_mov_b32 s37, 0
    s_nop 2
    v_mov_b32 v79, v79
    s_nop 2
    v_mov_b32 v79, v79
    s_nop 2
    v_mov_b32 v79, v79
    s_nop 2
    v_mov_b32 v79, v79
    s_nop 2
    v_mov_b32 v79, v79
    s_nop 2
    v_mov_b32 v79, v79
    s_branch cf_f0_xtx
cf_f0_retry:
    s_mov_b32 s37, 1
cf_f0_spin:
    buffer_load_dwordx4 v[8:11], v65, s[4:7], s18 offen nt
    buffer_load_dwordx4 v[12:15], v65, s[4:7], s19 offen nt
    buffer_load_dwordx4 v[16:19], v65, s[4:7], s20 offen nt
    buffer_load_dwordx4 v[20:23], v65, s[4:7], s21 offen nt
    s_nop 2
    v_mov_b32 v79, v79
    s_nop 2
    v_mov_b32 v79, v79
    s_nop 2
    v_mov_b32 v79, v79
    buffer_load_dwordx4 v[40:43], v65, s[4:7], s14 offen offset:0 nt
    buffer_load_dwordx4 v[60:63], v66, s[4:7], s14 offen offset:0 nt
    s_waitcnt vmcnt(5)
    v_xor_b32 v77, s69, v8
    v_mfma_f32_16x16x32_bf16 v[0:3], v[4:7], v[8:11], 0
    v_mov_b64 v[8:9], 0
    v_mov_b64 v[10:11], 0
    s_waitcnt vmcnt(4)
    v_bitop3_b32 v77, v77, v12, s69 bitop3:0xf6
    v_mfma_f32_16x16x32_bf16 v[0:3], v[4:7], v[12:15], v[0:3]
    v_mov_b64 v[12:13], 0
    v_mov_b64 v[14:15], 0
    s_waitcnt vmcnt(3)
    v_bitop3_b32 v77, v77, v16, s69 bitop3:0xf6
    v_mfma_f32_16x16x32_bf16 v[0:3], v[4:7], v[16:19], v[0:3]
    v_mov_b64 v[16:17], 0
    v_mov_b64 v[18:19], 0
    s_waitcnt vmcnt(2)
    v_bitop3_b32 v77, v77, v20, s69 bitop3:0xf6
    v_mfma_f32_16x16x32_bf16 v[0:3], v[4:7], v[20:23], v[0:3]
    v_and_b32 v77, 1, v77
    v_cmp_ne_u32 vcc, 0, v77
    v_mov_b64 v[20:21], 0
    v_mov_b64 v[22:23], 0
    buffer_load_dwordx4 v[40:43], v65, s[4:7], s14 offen offset:0 nt
    buffer_load_dwordx4 v[60:63], v66, s[4:7], s14 offen offset:0 nt
    s_cmp_eq_u64 vcc, 0
    s_cselect_b64 s[42:43], -1, 0
    v_add_f32_dpp v0, v0, v0 row_ror:8 row_mask:0xf bank_mask:0xf
    v_add_f32_dpp v1, v1, v1 row_ror:8 row_mask:0xf bank_mask:0xf
    s_mov_b64 exec, s[42:43]
    v_cvt_pk_bf16_f32 v72, v0, v1
    v_bfi_b32 v72, v79, s70, v72
    buffer_store_dword v72, v75, s[4:7], s17 offen offset:0
    s_mov_b64 exec, -1
    s_cbranch_scc1 cf_f0_rx
    s_sub_u32 s31, s31, 1
    s_cbranch_scc0 cf_f0_spin
cf_f0_rx:
    v_mov_b64 v[0:1], 0
    v_mov_b64 v[2:3], 0
    v_mov_b64 v[4:5], 0
    v_mov_b64 v[6:7], 0
    s_branch cf_loop
cf_f1_xt:
    s_mov_b32 s37, 0
    s_nop 2
    v_mov_b32 v79, v79
    s_nop 2
    v_mov_b32 v79, v79
    s_nop 2
    v_mov_b32 v79, v79
    s_nop 2
    v_mov_b32 v79, v79
    s_nop 2
    v_mov_b32 v79, v79
    s_nop 2
    v_mov_b32 v79, v79
    s_branch cf_f1_xtx
cf_f1_retry:
    s_mov_b32 s37, 1
cf_f1_spin:
    buffer_load_dwordx4 v[8:11], v65, s[4:7], s18 offen nt
    buffer_load_dwordx4 v[12:15], v65, s[4:7], s19 offen nt
    buffer_load_dwordx4 v[16:19], v65, s[4:7], s20 offen nt
    buffer_load_dwordx4 v[20:23], v65, s[4:7], s21 offen nt
    s_nop 2
    v_mov_b32 v79, v79
    s_nop 2
    v_mov_b32 v79, v79
    s_nop 2
    v_mov_b32 v79, v79
    buffer_load_dwordx4 v[40:43], v65, s[4:7], s14 offen offset:0 nt
    buffer_load_dwordx4 v[60:63], v66, s[4:7], s14 offen offset:0 nt
    s_waitcnt vmcnt(5)
    v_xor_b32 v77, s69, v8
    v_mfma_f32_16x16x32_bf16 v[0:3], v[4:7], v[8:11], 0
    v_mov_b64 v[8:9], 0
    v_mov_b64 v[10:11], 0
    s_waitcnt vmcnt(4)
    v_bitop3_b32 v77, v77, v12, s69 bitop3:0xf6
    v_mfma_f32_16x16x32_bf16 v[0:3], v[4:7], v[12:15], v[0:3]
    v_mov_b64 v[12:13], 0
    v_mov_b64 v[14:15], 0
    s_waitcnt vmcnt(3)
    v_bitop3_b32 v77, v77, v16, s69 bitop3:0xf6
    v_mfma_f32_16x16x32_bf16 v[0:3], v[4:7], v[16:19], v[0:3]
    v_mov_b64 v[16:17], 0
    v_mov_b64 v[18:19], 0
    s_waitcnt vmcnt(2)
    v_bitop3_b32 v77, v77, v20, s69 bitop3:0xf6
    v_mfma_f32_16x16x32_bf16 v[0:3], v[4:7], v[20:23], v[0:3]
    v_and_b32 v77, 1, v77
    v_cmp_ne_u32 vcc, 0, v77
    v_mov_b64 v[20:21], 0
    v_mov_b64 v[22:23], 0
    buffer_load_dwordx4 v[40:43], v65, s[4:7], s14 offen offset:0 nt
    buffer_load_dwordx4 v[60:63], v66, s[4:7], s14 offen offset:0 nt
    s_cmp_eq_u64 vcc, 0
    s_cselect_b64 s[42:43], -1, 0
    v_add_f32_dpp v0, v0, v0 row_ror:8 row_mask:0xf bank_mask:0xf
    v_add_f32_dpp v1, v1, v1 row_ror:8 row_mask:0xf bank_mask:0xf
    s_mov_b64 exec, s[42:43]
    v_cvt_pk_bf16_f32 v72, v0, v1
    v_bfi_b32 v72, v79, s70, v72
    buffer_store_dword v72, v75, s[4:7], s17 offen offset:0
    s_mov_b64 exec, -1
    s_cbranch_scc1 cf_f1_rx
    s_sub_u32 s31, s31, 1
    s_cbranch_scc0 cf_f1_spin
cf_f1_rx:
    v_mov_b64 v[0:1], 0
    v_mov_b64 v[2:3], 0
    v_mov_b64 v[4:5], 0
    v_mov_b64 v[6:7], 0
    s_branch cf_loop
cf_f2_xt:
    s_mov_b32 s37, 0
    s_nop 2
    v_mov_b32 v79, v79
    s_nop 2
    v_mov_b32 v79, v79
    s_nop 2
    v_mov_b32 v79, v79
    s_nop 2
    v_mov_b32 v79, v79
    s_nop 2
    v_mov_b32 v79, v79
    s_nop 2
    v_mov_b32 v79, v79
    s_branch cf_f2_xtx
cf_f2_retry:
    s_mov_b32 s37, 1
cf_f2_spin:
    buffer_load_dwordx4 v[8:11], v65, s[4:7], s18 offen nt
    buffer_load_dwordx4 v[12:15], v65, s[4:7], s19 offen nt
    buffer_load_dwordx4 v[16:19], v65, s[4:7], s20 offen nt
    buffer_load_dwordx4 v[20:23], v65, s[4:7], s21 offen nt
    s_nop 2
    v_mov_b32 v79, v79
    s_nop 2
    v_mov_b32 v79, v79
    s_nop 2
    v_mov_b32 v79, v79
    buffer_load_dwordx4 v[40:43], v65, s[4:7], s14 offen offset:0 nt
    buffer_load_dwordx4 v[60:63], v66, s[4:7], s14 offen offset:0 nt
    s_waitcnt vmcnt(5)
    v_xor_b32 v77, s69, v8
    v_bitop3_b32 v77, v77, v10, s69 bitop3:0xf6
    v_mfma_f32_16x16x32_bf16 v[0:3], v[4:7], v[8:11], 0
    v_mov_b64 v[8:9], 0
    v_mov_b64 v[10:11], 0
    s_waitcnt vmcnt(4)
    v_bitop3_b32 v77, v77, v12, s69 bitop3:0xf6
    v_bitop3_b32 v77, v77, v14, s69 bitop3:0xf6
    v_mfma_f32_16x16x32_bf16 v[0:3], v[4:7], v[12:15], v[0:3]
    v_mov_b64 v[12:13], 0
    v_mov_b64 v[14:15], 0
    s_waitcnt vmcnt(3)
    v_bitop3_b32 v77, v77, v16, s69 bitop3:0xf6
    v_bitop3_b32 v77, v77, v18, s69 bitop3:0xf6
    v_mfma_f32_16x16x32_bf16 v[0:3], v[4:7], v[16:19], v[0:3]
    v_mov_b64 v[16:17], 0
    v_mov_b64 v[18:19], 0
    s_waitcnt vmcnt(2)
    v_bitop3_b32 v77, v77, v20, s69 bitop3:0xf6
    v_bitop3_b32 v77, v77, v22, s69 bitop3:0xf6
    v_mfma_f32_16x16x32_bf16 v[0:3], v[4:7], v[20:23], v[0:3]
    v_and_b32 v77, 1, v77
    v_cmp_ne_u32 vcc, 0, v77
    v_mov_b64 v[20:21], 0
    v_mov_b64 v[22:23], 0
    buffer_load_dwordx4 v[40:43], v65, s[4:7], s14 offen offset:0 nt
    buffer_load_dwordx4 v[60:63], v66, s[4:7], s14 offen offset:0 nt
    s_cmp_eq_u64 vcc, 0
    s_cselect_b64 s[42:43], -1, 0
    v_add_f32 v2, v0, v1
    s_nop 1
    v_add_f32_dpp v2, v2, v2 row_ror:8 row_mask:0xf bank_mask:0xf
    s_nop 1
    v_mov_b32_dpp v0, v2 quad_perm:[0,0,2,2] row_mask:0xf bank_mask:0xf
    v_mov_b32_dpp v1, v2 quad_perm:[1,1,3,3] row_mask:0xf bank_mask:0xf
    s_mov_b64 exec, s[42:43]
    v_cvt_pk_bf16_f32 v72, v0, v1
    v_bfi_b32 v72, v79, s70, v72
    buffer_store_dword v72, v75, s[4:7], s17 offen offset:0
    buffer_store_dword v72, v75, s[4:7], s17 offen offset:1024
    buffer_store_dword v72, v75, s[4:7], s17 offen offset:2048
    buffer_store_dword v72, v75, s[4:7], s17 offen offset:3072
    s_mov_b64 exec, -1
    s_cbranch_scc1 cf_f2_rx
    s_sub_u32 s31, s31, 1
    s_cbranch_scc0 cf_f2_spin
cf_f2_rx:
    v_mov_b64 v[0:1], 0
    v_mov_b64 v[2:3], 0
    v_mov_b64 v[4:5], 0
    v_mov_b64 v[6:7], 0
    s_branch cf_loop
cf_spinB:
    s_waitcnt vmcnt(2)
cf_spinB_l:
    v_and_b32 v77, s36, v44
    v_cmp_ne_u32 vcc, s70, v77
    s_cbranch_vccz cf_spinB_x
    buffer_load_dwordx4 v[44:47], v65, s[4:7], s15 offen nt
    s_sub_u32 s31, s31, 16
    s_waitcnt vmcnt(0)
    s_cbranch_scc0 cf_spinB_l
cf_spinB_x:
    ds_write_b128 v65, v[44:47] offset:4096
    s_waitcnt lgkmcnt(0)
    s_branch cf_backB
cf_spin8:
    buffer_load_dwordx4 v[40:43], v65, s[4:7], s16 offen nt
cf_spin8_l:
    v_and_b32 v77, s36, v40
    v_cmp_ne_u32 vcc, s70, v77
    s_cbranch_vccz cf_spin8_x
    s_nop 1
    v_and_b32 v77, s36, v40
    v_cmp_ne_u32 vcc, s70, v77
    s_cbranch_vccz cf_spin8_x
    s_nop 1
    v_and_b32 v77, s36, v40
    v_cmp_ne_u32 vcc, s70, v77
    s_cbranch_vccz cf_spin8_x
    s_nop 1
    buffer_load_dwordx4 v[40:43], v65, s[4:7], s16 offen nt
    s_sub_u32 s31, s31, 16
    s_cbranch_scc0 cf_spin8_l
cf_spin8_x:
    s_branch cf_back8
cf_rare:
    s_mov_b64 exec, s[34:35]
    buffer_store_dwordx4 v[0:3], v65, s[4:7], s28 offen sc1
    s_mov_b64 exec, -1
    s_nop 3
    v_cvt_pk_bf16_f32 v52, v16, v17
    v_cvt_pk_bf16_f32 v53, v18, v19
    v_cvt_pk_bf16_f32 v54, v20, v21
    v_cvt_pk_bf16_f32 v55, v22, v23
    buffer_store_dwordx4 v[52:55], v65, s[4:7], s27 offen sc1
    s_add_u32 s28, s28, 131072
    s_add_u32 s27, s27, 131072
    s_cmp_eq_u32 s30, 63
    s_cbranch_scc1 cf_last
    s_branch cf_rare_x
cf_kvwait:
    s_mov_b32 s41, s97
    v_bfe_u32 v78, v65, 2, 5
    v_mov_b32 v77, v76
    s_nop 1
    v_permlane32_swap_b32 v76, v77
    v_subrev_u32 v77, s95, v77
    v_cmp_lt_u32 vcc, 16, v77
    s_nop 1
    v_cndmask_b32 v77, v77, 0, vcc
    v_bfe_u32 v79, v78, 2, 2
    v_lshl_add_u32 v77, v77, 2, v79
    s_nop 1
    v_min_u32_dpp v77, v77, v77 row_ror:1 row_mask:0xf bank_mask:0xf
    s_nop 1
    v_min_u32_dpp v77, v77, v77 row_ror:2 row_mask:0xf bank_mask:0xf
    s_nop 1
    v_min_u32_dpp v77, v77, v77 row_ror:4 row_mask:0xf bank_mask:0xf
    s_nop 0
    v_readfirstlane_b32 s97, v77
    s_nop 0
    s_max_u32 s97, s97, s41
    s_add_u32 s40, s30, 3
    s_min_u32 s40, s40, 64
    s_cmp_le_u32 s40, s97
    s_cbranch_scc1 cf_kvw_x
    v_bfe_u32 v78, v65, 2, 5
    s_mov_b32 s31, 4194304
cf_kvw:
    buffer_load_dword v77, v78, s[4:7], s96 offen offset:16 sc1
    s_waitcnt vmcnt(0)
    v_subrev_u32 v77, s95, v77
    v_cmp_lt_u32 vcc, 16, v77
    s_nop 1
    v_cndmask_b32 v77, v77, 0, vcc
    v_bfe_u32 v79, v78, 2, 2
    v_lshl_add_u32 v77, v77, 2, v79
    s_nop 1
    v_min_u32_dpp v77, v77, v77 row_ror:1 row_mask:0xf bank_mask:0xf
    s_nop 1
    v_min_u32_dpp v77, v77, v77 row_ror:2 row_mask:0xf bank_mask:0xf
    s_nop 1
    v_min_u32_dpp v77, v77, v77 row_ror:4 row_mask:0xf bank_mask:0xf
    s_nop 0
    v_readfirstlane_b32 s97, v77
    s_sub_u32 s31, s31, 1
    s_cbranch_scc1 cf_kvw_x
    s_cmp_le_u32 s40, s97
    s_cbranch_scc1 cf_kvw_x
    s_sleep 2
    s_branch cf_kvw
cf_kvw_x:
    s_branch cf_kvok
cf_last:
    s_add_u32 s40, s95, 64
    v_mov_b32 v78, s40
    s_waitcnt vmcnt(0)
    s_barrier
    s_mov_b64 exec, s[100:101]
    buffer_store_dword v78, off, s[4:7], s29 sc1
    s_mov_b64 exec, -1
cf_end:
    s_endpgm
L_chain_safe:
    s_load_dwordx8 s[48:55], s[0:1], 8
    s_load_dwordx2 s[56:57], s[0:1], 40
    s_waitcnt lgkmcnt(0)
    v_lshrrev_b32 v77, 6, v0
    s_nop 0
    v_readfirstlane_b32 s13, v77
    v_lshlrev_b32 v65, 4, v0
    v_and_b32 v48, 63, v0
    s_mov_b32 s10, 4718592
    s_mov_b32 s11, 0x20000
    v_lshrrev_b32 v49, 3, v48
    v_mul_u32_u24 v18, 1152, v49
    v_and_b32 v49, 7, v48
    v_lshl_add_u32 v18, v49, 4, v18
    s_mul_i32 s40, s12, 147456
    s_lshl_b32 s41, s13, 8
    s_add_u32 s40, s40, s41
    s_mov_b32 s42, s40
    s_xor_b32 s41, s13, 0
    s_mul_i32 s41, s41, 36864
    s_add_u32 s60, s41, s40
    s_xor_b32 s41, s13, 1
    s_mul_i32 s41, s41, 36864
    s_add_u32 s61, s41, s40
    s_xor_b32 s41, s13, 2
    s_mul_i32 s41, s41, 36864
    s_add_u32 s62, s41, s40
    s_xor_b32 s41, s13, 3
    s_mul_i32 s41, s41, 36864
    s_add_u32 s63, s41, s40
    s_lshl_b32 s43, s13, 12
    s_mov_b64 s[8:9], s[56:57]
    s_add_u32 m0, s43, 0
    s_add_u32 s41, s60, 0
    buffer_load_dwordx4 v18, s[8:11], s41 offen offset:0 nt lds
    s_add_u32 s41, s60, 8192
    buffer_load_dwordx4 v18, s[8:11], s41 offen offset:1024 nt lds
    s_add_u32 s41, s60, 16384
    buffer_load_dwordx4 v18, s[8:11], s41 offen offset:2048 nt lds
    s_add_u32 s41, s60, 24576
    buffer_load_dwordx4 v18, s[8:11], s41 offen offset:3072 nt lds
    s_add_u32 m0, s43, 36864
    s_add_u32 s41, s61, 0
    buffer_load_dwordx4 v18, s[8:11], s41 offen offset:0 nt lds
    s_add_u32 s41, s61, 8192
    buffer_load_dwordx4 v18, s[8:11], s41 offen offset:1024 nt lds
    s_add_u32 s41, s61, 16384
    buffer_load_dwordx4 v18, s[8:11], s41 offen offset:2048 nt lds
    s_add_u32 s41, s61, 24576
    buffer_load_dwordx4 v18, s[8:11], s41 offen offset:3072 nt lds
    s_add_u32 m0, s43, 73728
    s_add_u32 s41, s62, 0
    buffer_load_dwordx4 v18, s[8:11], s41 offen offset:0 nt lds
    s_add_u32 s41, s62, 8192
    buffer_load_dwordx4 v18, s[8:11], s41 offen offset:1024 nt lds
    s_add_u32 s41, s62, 16384
    buffer_load_dwordx4 v18, s[8:11], s41 offen offset:2048 nt lds
    s_add_u32 s41, s62, 24576
    buffer_load_dwordx4 v18, s[8:11], s41 offen offset:3072 nt lds
    s_add_u32 m0, s43, 110592
    s_add_u32 s41, s63, 0
    buffer_load_dwordx4 v18, s[8:11], s41 offen offset:0 nt lds
    s_add_u32 s41, s63, 8192
    buffer_load_dwordx4 v18, s[8:11], s41 offen offset:1024 nt lds
    s_add_u32 s41, s63, 16384
    buffer_load_dwordx4 v18, s[8:11], s41 offen offset:2048 nt lds
    s_add_u32 s41, s63, 24576
    buffer_load_dwordx4 v18, s[8:11], s41 offen offset:3072 nt lds
    v_lshrrev_b32 v49, 1, v48
    v_mul_u32_u24 v19, 1152, v49
    v_and_b32 v49, 1, v48
    v_lshl_add_u32 v19, v49, 4, v19
    s_mul_i32 s41, s13, 224
    s_sub_u32 s41, 1024, s41
    v_add_u32 v19, s41, v19
    v_lshrrev_b32 v49, 4, v48
    v_lshlrev_b32 v50, 2, v49
    v_and_b32 v51, 15, v48
    v_xor_b32 v51, v51, v50
    v_lshlrev_b32 v51, 4, v51
    v_lshl_add_u32 v16, v49, 15, v51
    v_lshrrev_b32 v50, 1, v49
    v_lshl_add_u32 v17, v50, 16, v51
    v_and_b32 v50, 1, v49
    v_lshl_add_u32 v17, v50, 13, v17
    s_lshl_b32 s40, s12, 8
    s_mul_i32 s58, s13, 1048576
    s_add_u32 s58, s58, s40
    s_lshr_b32 s41, s13, 1
    s_mul_i32 s59, s41, 262144
    s_and_b32 s41, s13, 1
    s_lshl_b32 s41, s41, 14
    s_add_u32 s59, s59, s41
    s_add_u32 s59, s59, s40
    s_add_u32 s59, s59, 4194304
    v_bfe_u32 v50, v48, 2, 2
    v_xor_b32 v51, s13, v50
    v_lshlrev_b32 v20, 6, v51
    v_and_b32 v51, 3, v48
    v_lshl_add_u32 v20, v51, 4, v20
    v_lshrrev_b32 v23, 2, v48
    v_lshl_add_u32 v20, v23, 8, v20
    s_xor_b32 s41, s43, 0
    v_add_u32 v24, s41, v20
    s_xor_b32 s41, s43, 4096
    v_add_u32 v25, s41, v20
    s_xor_b32 s41, s43, 8192
    v_add_u32 v26, s41, v20
    s_xor_b32 s41, s43, 12288
    v_add_u32 v27, s41, v20
    v_and_b32 v23, 1, v50
    v_lshl_add_u32 v23, v49, 2, v23
    v_lshrrev_b32 v50, 1, v50
    v_lshlrev_b32 v21, 7, v23
    v_lshl_add_u32 v21, v50, 6, v21
    v_lshl_add_u32 v21, v51, 4, v21
    v_add_u32 v21, s43, v21
    v_lshlrev_b32 v22, 9, v50
    v_xor_b32 v22, v22, v21
    v_lshlrev_b32 v23, 5, v23
    v_lshl_add_u32 v23, v50, 10, v23
    v_lshl_add_u32 v23, v51, 3, v23
    v_add_u32 v23, s43, v23
    v_bfe_u32 v60, v65, 4, 6
    v_and_b32 v61, 15, v60
    v_lshrrev_b32 v62, 4, v60
    v_mov_b32 v64, 0x4444
    v_mov_b32 v77, 0xeeee
    v_cmp_lt_u32 vcc, 7, v61
    s_nop 1
    v_cndmask_b32 v64, v64, v77, vcc
    v_xor_b32 v66, 1024, v65
    v_xor_b32 v67, 2048, v65
    v_xor_b32 v68, 3072, v65
    v_and_b32 v69, 511, v65
    s_mul_i32 s96, s13, 36864
    s_add_u32 s96, s96, 16384
    v_lshlrev_b32 v70, 4, v60
    v_add_u32 v70, s96, v70
    v_lshrrev_b32 v79, 1, v69
    s_lshl_b32 s96, s13, 8
    s_add_u32 s96, s96, 14336
    s_lshl_b32 s33, s13, 10
    s_add_u32 s97, s33, 8192
    v_mov_b32 v77, s97
    v_mov_b32 v78, s96
    v_cmp_lt_u32 vcc, 31, v60
    s_nop 1
    v_cndmask_b32 v71, v77, v78, vcc
    v_add_u32 v71, v71, v79
    v_and_b32 v77, 7, v61
    v_lshrrev_b32 v78, 3, v61
    v_lshlrev_b32 v74, 4, v77
    v_lshl_add_u32 v73, v62, 7, v74
    v_lshl_add_u32 v73, v78, 3, v73
    s_lshl_b32 s96, s13, 9
    v_add_u32 v73, s96, v73
    v_lshl_add_u32 v74, v78, 14, v74
    v_lshl_add_u32 v74, v62, 15, v74
    s_lshl_b32 s96, s13, 17
    v_add_u32 v74, s96, v74
    v_bfe_u32 v77, v61, 2, 1
    v_and_b32 v78, 3, v61
    v_bfe_u32 v79, v61, 1, 2
    s_cmp_lt_u32 s13, 2
    s_cselect_b64 vcc, -1, 0
    v_cndmask_b32 v77, 0, v77, vcc
    v_cndmask_b32 v78, v79, v78, vcc
    v_lshlrev_b32 v75, 7, v77
    v_lshl_add_u32 v75, v62, 4, v75
    v_lshl_add_u32 v75, v78, 2, v75
    v_lshl_add_u32 v58, v77, 3, v78
    v_lshlrev_b32 v79, 1, v78
    v_cndmask_b32 v58, v79, v58, vcc
    s_bfe_u32 s97, s12, 0x10001
    s_lshl_b32 s68, s97, 6
    s_lshl_b32 s97, s97, 2
    v_add_u32 v59, s97, v62
    s_bfe_u32 s96, s12, 0x10002
    s_and_b32 s40, s12, 1
    s_lshl_b32 s96, s96, 1
    s_add_u32 s96, s96, s40
    s_lshr_b32 s97, s12, 3
    s_lshl_b32 s98, s13, 2
    s_add_u32 s98, s98, s97
    s_lshl_b32 s98, s98, 2
    s_add_u32 s98, s98, s96
    s_lshl_b32 s98, s98, 8
    s_lshl_b32 s99, s13, 2
    s_add_u32 s99, s99, s96
    s_lshl_b32 s99, s99, 4
    s_lshl_b32 s41, s97, 1
    s_add_u32 s41, s41, s40
    s_lshl_b32 s41, s41, 7
    s_add_u32 s41, s41, 8192
    s_lshl_b32 s40, s40, 3
    s_add_u32 s40, s40, 512
    s_cmp_lt_u32 s13, 2
    s_cselect_b32 s96, 7, 4
    s_cselect_b32 s98, s98, s41
    s_cselect_b32 s99, s99, s40
    s_cselect_b32 s32, 1, 0
    s_add_u32 s68, s68, s98
    s_lshl_b32 s97, s97, s96
    s_add_u32 s99, s99, s97
    v_add_u32 v58, s99, v58
    s_and_b32 s97, s12, 4
    s_or_b32 s97, s97, s13
    s_cmp_eq_u32 s97, 2
    s_cselect_b32 s32, 2, s32
    s_mov_b32 s8, s48
    s_mov_b32 s9, s49
    s_mov_b32 s10, 9216
    s_cmp_lt_u32 s13, 2
    s_cselect_b32 s96, 8, 2
    v_mul_u32_u24 v77, 1152, v59
    v_lshl_add_u32 v77, v58, 1, v77
    buffer_load_ushort v72, v77, s[8:11], 0 offen
    buffer_load_ushort v76, v77, s[8:11], s96 offen
    s_mov_b32 s10, 4718592
    s_waitcnt vmcnt(12) lgkmcnt(0)
    s_barrier
    s_mov_b64 s[8:9], s[56:57]
    s_add_u32 m0, s43, 147456
    s_add_u32 s41, s42, 0
    buffer_load_dwordx4 v19, s[8:11], s41 offen offset:0 nt lds
    s_add_u32 s41, s42, 35840
    buffer_load_dwordx4 v19, s[8:11], s41 offen offset:1024 nt lds
    s_add_u32 s41, s42, 71680
    buffer_load_dwordx4 v19, s[8:11], s41 offen offset:2048 nt lds
    s_add_u32 s41, s42, 107520
    buffer_load_dwordx4 v19, s[8:11], s41 offen offset:3072 nt lds
    v_mov_b32 v78, v21
    v_mov_b32 v79, v22
    v_add_u32 v77, 0, v79
    ds_read_b64_tr_b16 v[80:81], v77 offset:0
    ds_read_b64_tr_b16 v[82:83], v77 offset:256
    ds_read_b64_tr_b16 v[84:85], v77 offset:2048
    ds_read_b64_tr_b16 v[86:87], v77 offset:2304
    ds_read_b64_tr_b16 v[112:113], v77 offset:8
    ds_read_b64_tr_b16 v[114:115], v77 offset:264
    ds_read_b64_tr_b16 v[116:117], v77 offset:2056
    ds_read_b64_tr_b16 v[118:119], v77 offset:2312
    s_waitcnt vmcnt(12) lgkmcnt(0)
    s_barrier
    s_mov_b64 s[8:9], s[52:53]
    s_add_u32 m0, s43, 0
    s_add_u32 s41, s58, 0
    buffer_load_dwordx4 v16, s[8:11], s41 offen offset:0 nt lds
    s_add_u32 s41, s58, 15360
    buffer_load_dwordx4 v16, s[8:11], s41 offen offset:1024 nt lds
    s_add_u32 s41, s58, 129024
    buffer_load_dwordx4 v16, s[8:11], s41 offen offset:2048 nt lds
    s_add_u32 s41, s58, 144384
    buffer_load_dwordx4 v16, s[8:11], s41 offen offset:3072 nt lds
    v_add_u32 v77, 36864, v78
    ds_read_b64_tr_b16 v[88:89], v77 offset:0
    ds_read_b64_tr_b16 v[90:91], v77 offset:256
    ds_read_b64_tr_b16 v[92:93], v77 offset:2048
    ds_read_b64_tr_b16 v[94:95], v77 offset:2304
    ds_read_b64_tr_b16 v[120:121], v77 offset:8
    ds_read_b64_tr_b16 v[122:123], v77 offset:264
    ds_read_b64_tr_b16 v[124:125], v77 offset:2056
    ds_read_b64_tr_b16 v[126:127], v77 offset:2312
    s_waitcnt vmcnt(12) lgkmcnt(0)
    s_barrier
    s_add_u32 m0, s43, 36864
    s_add_u32 s41, s58, 8192
    buffer_load_dwordx4 v16, s[8:11], s41 offen offset:0 nt lds
    s_add_u32 s41, s58, 23552
    buffer_load_dwordx4 v16, s[8:11], s41 offen offset:1024 nt lds
    s_add_u32 s41, s58, 137216
    buffer_load_dwordx4 v16, s[8:11], s41 offen offset:2048 nt lds
    s_add_u32 s41, s58, 152576
    buffer_load_dwordx4 v16, s[8:11], s41 offen offset:3072 nt lds
    v_add_u32 v77, 73728, v78
    ds_read_b64_tr_b16 v[96:97], v77 offset:0
    ds_read_b64_tr_b16 v[98:99], v77 offset:256
    ds_read_b64_tr_b16 v[100:101], v77 offset:2048
    ds_read_b64_tr_b16 v[102:103], v77 offset:2304
    ds_read_b64_tr_b16 v[128:129], v77 offset:8
    ds_read_b64_tr_b16 v[130:131], v77 offset:264
    ds_read_b64_tr_b16 v[132:133], v77 offset:2056
    ds_read_b64_tr_b16 v[134:135], v77 offset:2312
    s_waitcnt vmcnt(12) lgkmcnt(0)
    s_barrier
    s_add_u32 m0, s43, 73728
    s_add_u32 s41, s58, 262144
    buffer_load_dwordx4 v16, s[8:11], s41 offen offset:0 nt lds
    s_add_u32 s41, s58, 277504
    buffer_load_dwordx4 v16, s[8:11], s41 offen offset:1024 nt lds
    s_add_u32 s41, s58, 391168
    buffer_load_dwordx4 v16, s[8:11], s41 offen offset:2048 nt lds
    s_add_u32 s41, s58, 406528
    buffer_load_dwordx4 v16, s[8:11], s41 offen offset:3072 nt lds
    v_add_u32 v77, 110592, v78
    ds_read_b64_tr_b16 v[104:105], v77 offset:0
    ds_read_b64_tr_b16 v[106:107], v77 offset:256
    ds_read_b64_tr_b16 v[108:109], v77 offset:2048
    ds_read_b64_tr_b16 v[110:111], v77 offset:2304
    ds_read_b64_tr_b16 v[136:137], v77 offset:8
    ds_read_b64_tr_b16 v[138:139], v77 offset:264
    ds_read_b64_tr_b16 v[140:141], v77 offset:2056
    ds_read_b64_tr_b16 v[142:143], v77 offset:2312
    s_waitcnt vmcnt(12) lgkmcnt(0)
    s_barrier
    s_add_u32 m0, s43, 110592
    s_add_u32 s41, s58, 270336
    buffer_load_dwordx4 v16, s[8:11], s41 offen offset:0 nt lds
    s_add_u32 s41, s58, 285696
    buffer_load_dwordx4 v16, s[8:11], s41 offen offset:1024 nt lds
    s_add_u32 s41, s58, 399360
    buffer_load_dwordx4 v16, s[8:11], s41 offen offset:2048 nt lds
    s_add_u32 s41, s58, 414720
    buffer_load_dwordx4 v16, s[8:11], s41 offen offset:3072 nt lds
    v_add_u32 v77, 147456, v23
    ds_read_b64_tr_b16 v[0:1], v77 offset:0
    ds_read_b64_tr_b16 v[2:3], v77 offset:64
    ds_read_b64_tr_b16 v[4:5], v77 offset:512
    ds_read_b64_tr_b16 v[6:7], v77 offset:576
    ds_read_b64_tr_b16 v[8:9], v77 offset:2048
    ds_read_b64_tr_b16 v[10:11], v77 offset:2112
    ds_read_b64_tr_b16 v[12:13], v77 offset:2560
    ds_read_b64_tr_b16 v[14:15], v77 offset:2624
    s_waitcnt vmcnt(12) lgkmcnt(0)
    s_barrier
    s_add_u32 m0, s43, 147456
    s_add_u32 s41, s58, 524288
    buffer_load_dwordx4 v16, s[8:11], s41 offen offset:0 nt lds
    s_add_u32 s41, s58, 539648
    buffer_load_dwordx4 v16, s[8:11], s41 offen offset:1024 nt lds
    s_add_u32 s41, s58, 653312
    buffer_load_dwordx4 v16, s[8:11], s41 offen offset:2048 nt lds
    s_add_u32 s41, s58, 668672
    buffer_load_dwordx4 v16, s[8:11], s41 offen offset:3072 nt lds
    s_cmp_eq_u32 s32, 0
    s_cbranch_scc1 cs_init_done
    v_mov_b32 v52, 1
    v_mov_b32 v53, 1
    v_mov_b32 v54, 1
    v_mov_b32 v55, 1
    v_mov_b32 v56, 0
    v_lshl_or_b32 v72, v76, 16, v72
    s_lshl_b32 s96, s12, 14
    s_add_u32 s96, s96, 68681728
    s_add_u32 s97, s96, 0
    buffer_store_dwordx4 v[52:55], v65, s[4:7], s97 offen sc1
    s_add_u32 s97, s96, 4096
    buffer_store_dwordx4 v[52:55], v65, s[4:7], s97 offen sc1
    s_add_u32 s97, s96, 8192
    buffer_store_dwordx4 v[52:55], v65, s[4:7], s97 offen sc1
    s_add_u32 s97, s96, 12288
    buffer_store_dwordx4 v[52:55], v65, s[4:7], s97 offen sc1
    s_add_u32 s96, s68, 67633152
    s_add_u32 s97, s96, 16384
    buffer_store_dword v56, v75, s[4:7], s96 offen offset:0 sc1
    buffer_store_dword v72, v75, s[4:7], s97 offen offset:0 sc1
    s_cmp_lg_u32 s32, 2
    s_cbranch_scc1 cs_init_done
    buffer_store_dword v56, v75, s[4:7], s96 offen offset:1024 sc1
    buffer_store_dword v72, v75, s[4:7], s97 offen offset:1024 sc1
    buffer_store_dword v56, v75, s[4:7], s96 offen offset:2048 sc1
    buffer_store_dword v72, v75, s[4:7], s97 offen offset:2048 sc1
    buffer_store_dword v56, v75, s[4:7], s96 offen offset:3072 sc1
    buffer_store_dword v72, v75, s[4:7], s97 offen offset:3072 sc1
cs_init_done:
    ds_write_b64 v70, v[0:1] offset:16384
    ds_write_b64 v70, v[2:3] offset:16392
    ds_write_b64 v70, v[4:5] offset:17408
    ds_write_b64 v70, v[6:7] offset:17416
    ds_write_b64 v70, v[8:9] offset:18432
    ds_write_b64 v70, v[10:11] offset:18440
    ds_write_b64 v70, v[12:13] offset:19456
    ds_write_b64 v70, v[14:15] offset:19464
    v_add_u32 v28, 0, v24
    v_add_u32 v29, 0, v25
    v_add_u32 v30, 0, v26
    v_add_u32 v31, 0, v27
    ds_read_b64_tr_b16 a[96:97], v28 offset:0
    ds_read_b64_tr_b16 a[104:105], v28 offset:8
    ds_read_b64_tr_b16 a[112:113], v29 offset:0
    ds_read_b64_tr_b16 a[120:121], v29 offset:8
    ds_read_b64_tr_b16 a[128:129], v30 offset:0
    ds_read_b64_tr_b16 a[136:137], v30 offset:8
    ds_read_b64_tr_b16 a[144:145], v31 offset:0
    ds_read_b64_tr_b16 v[32:33], v31 offset:8
    s_waitcnt vmcnt(12) lgkmcnt(0)
    s_barrier
    s_add_u32 m0, s43, 0
    s_add_u32 s41, s58, 532480
    buffer_load_dwordx4 v16, s[8:11], s41 offen offset:0 nt lds
    s_add_u32 s41, s58, 547840
    buffer_load_dwordx4 v16, s[8:11], s41 offen offset:1024 nt lds
    s_add_u32 s41, s58, 661504
    buffer_load_dwordx4 v16, s[8:11], s41 offen offset:2048 nt lds
    s_add_u32 s41, s58, 676864
    buffer_load_dwordx4 v16, s[8:11], s41 offen offset:3072 nt lds
    ds_write_b64 v70, v[32:33] offset:12288
    v_add_u32 v28, 36864, v24
    v_add_u32 v29, 36864, v25
    v_add_u32 v30, 36864, v26
    v_add_u32 v31, 36864, v27
    ds_read_b64_tr_b16 a[98:99], v28 offset:0
    ds_read_b64_tr_b16 a[106:107], v28 offset:8
    ds_read_b64_tr_b16 a[114:115], v29 offset:0
    ds_read_b64_tr_b16 a[122:123], v29 offset:8
    ds_read_b64_tr_b16 a[130:131], v30 offset:0
    ds_read_b64_tr_b16 a[138:139], v30 offset:8
    ds_read_b64_tr_b16 a[146:147], v31 offset:0
    ds_read_b64_tr_b16 v[0:1], v31 offset:8
    s_waitcnt vmcnt(12) lgkmcnt(0)
    s_barrier
    s_add_u32 m0, s43, 36864
    s_add_u32 s41, s58, 786432
    buffer_load_dwordx4 v16, s[8:11], s41 offen offset:0 nt lds
    s_add_u32 s41, s58, 801792
    buffer_load_dwordx4 v16, s[8:11], s41 offen offset:1024 nt lds
    s_add_u32 s41, s58, 915456
    buffer_load_dwordx4 v16, s[8:11], s41 offen offset:2048 nt lds
    s_add_u32 s41, s58, 930816
    buffer_load_dwordx4 v16, s[8:11], s41 offen offset:3072 nt lds
    ds_write_b64 v70, v[0:1] offset:12296
    v_add_u32 v28, 73728, v24
    v_add_u32 v29, 73728, v25
    v_add_u32 v30, 73728, v26
    v_add_u32 v31, 73728, v27
    ds_read_b64_tr_b16 a[100:101], v28 offset:0
    ds_read_b64_tr_b16 a[108:109], v28 offset:8
    ds_read_b64_tr_b16 a[116:117], v29 offset:0
    ds_read_b64_tr_b16 a[124:125], v29 offset:8
    ds_read_b64_tr_b16 a[132:133], v30 offset:0
    ds_read_b64_tr_b16 a[140:141], v30 offset:8
    ds_read_b64_tr_b16 a[148:149], v31 offset:0
    ds_read_b64_tr_b16 v[32:33], v31 offset:8
    s_waitcnt vmcnt(12) lgkmcnt(0)
    s_barrier
    s_add_u32 m0, s43, 73728
    s_add_u32 s41, s58, 794624
    buffer_load_dwordx4 v16, s[8:11], s41 offen offset:0 nt lds
    s_add_u32 s41, s58, 809984
    buffer_load_dwordx4 v16, s[8:11], s41 offen offset:1024 nt lds
    s_add_u32 s41, s58, 923648
    buffer_load_dwordx4 v16, s[8:11], s41 offen offset:2048 nt lds
    s_add_u32 s41, s58, 939008
    buffer_load_dwordx4 v16, s[8:11], s41 offen offset:3072 nt lds
    ds_write_b64 v70, v[32:33] offset:13312
    v_add_u32 v28, 110592, v24
    v_add_u32 v29, 110592, v25
    v_add_u32 v30, 110592, v26
    v_add_u32 v31, 110592, v27
    ds_read_b64_tr_b16 a[102:103], v28 offset:0
    ds_read_b64_tr_b16 a[110:111], v28 offset:8
    ds_read_b64_tr_b16 a[118:119], v29 offset:0
    ds_read_b64_tr_b16 a[126:127], v29 offset:8
    ds_read_b64_tr_b16 a[134:135], v30 offset:0
    ds_read_b64_tr_b16 a[142:143], v30 offset:8
    ds_read_b64_tr_b16 a[150:151], v31 offset:0
    ds_read_b64_tr_b16 v[0:1], v31 offset:8
    s_waitcnt vmcnt(12) lgkmcnt(0)
    s_barrier
    s_add_u32 m0, s43, 110592
    s_add_u32 s41, s59, 0
    buffer_load_dwordx4 v17, s[8:11], s41 offen offset:0 nt lds
    s_add_u32 s41, s59, 31744
    buffer_load_dwordx4 v17, s[8:11], s41 offen offset:1024 nt lds
    s_add_u32 s41, s59, 129024
    buffer_load_dwordx4 v17, s[8:11], s41 offen offset:2048 nt lds
    s_add_u32 s41, s59, 160768
    buffer_load_dwordx4 v17, s[8:11], s41 offen offset:3072 nt lds
    ds_write_b64 v70, v[0:1] offset:13320
    v_add_u32 v28, 147456, v24
    v_add_u32 v29, 147456, v25
    v_add_u32 v30, 147456, v26
    v_add_u32 v31, 147456, v27
    ds_read_b64_tr_b16 a[152:153], v28 offset:0
    ds_read_b64_tr_b16 a[160:161], v28 offset:8
    ds_read_b64_tr_b16 a[168:169], v29 offset:0
    ds_read_b64_tr_b16 a[176:177], v29 offset:8
    ds_read_b64_tr_b16 a[184:185], v30 offset:0
    ds_read_b64_tr_b16 a[192:193], v30 offset:8
    ds_read_b64_tr_b16 a[200:201], v31 offset:0
    ds_read_b64_tr_b16 a[208:209], v31 offset:8
    s_waitcnt vmcnt(12) lgkmcnt(0)
    s_barrier
    s_mov_b64 s[8:9], s[50:51]
    s_add_u32 m0, s43, 147456
    s_add_u32 s41, s58, 0
    buffer_load_dwordx4 v16, s[8:11], s41 offen offset:0 nt lds
    s_add_u32 s41, s58, 15360
    buffer_load_dwordx4 v16, s[8:11], s41 offen offset:1024 nt lds
    s_add_u32 s41, s58, 129024
    buffer_load_dwordx4 v16, s[8:11], s41 offen offset:2048 nt lds
    s_add_u32 s41, s58, 144384
    buffer_load_dwordx4 v16, s[8:11], s41 offen offset:3072 nt lds
    v_add_u32 v28, 0, v24
    v_add_u32 v29, 0, v25
    v_add_u32 v30, 0, v26
    v_add_u32 v31, 0, v27
    ds_read_b64_tr_b16 a[154:155], v28 offset:0
    ds_read_b64_tr_b16 a[162:163], v28 offset:8
    ds_read_b64_tr_b16 a[170:171], v29 offset:0
    ds_read_b64_tr_b16 a[178:179], v29 offset:8
    ds_read_b64_tr_b16 a[186:187], v30 offset:0
    ds_read_b64_tr_b16 a[194:195], v30 offset:8
    ds_read_b64_tr_b16 a[202:203], v31 offset:0
    ds_read_b64_tr_b16 a[210:211], v31 offset:8
    s_waitcnt vmcnt(12) lgkmcnt(0)
    s_barrier
    s_add_u32 m0, s43, 0
    s_add_u32 s41, s58, 8192
    buffer_load_dwordx4 v16, s[8:11], s41 offen offset:0 nt lds
    s_add_u32 s41, s58, 23552
    buffer_load_dwordx4 v16, s[8:11], s41 offen offset:1024 nt lds
    s_add_u32 s41, s58, 137216
    buffer_load_dwordx4 v16, s[8:11], s41 offen offset:2048 nt lds
    s_add_u32 s41, s58, 152576
    buffer_load_dwordx4 v16, s[8:11], s41 offen offset:3072 nt lds
    v_add_u32 v28, 36864, v24
    v_add_u32 v29, 36864, v25
    v_add_u32 v30, 36864, v26
    v_add_u32 v31, 36864, v27
    ds_read_b64_tr_b16 a[156:157], v28 offset:0
    ds_read_b64_tr_b16 a[164:165], v28 offset:8
    ds_read_b64_tr_b16 a[172:173], v29 offset:0
    ds_read_b64_tr_b16 a[180:181], v29 offset:8
    ds_read_b64_tr_b16 a[188:189], v30 offset:0
    ds_read_b64_tr_b16 a[196:197], v30 offset:8
    ds_read_b64_tr_b16 a[204:205], v31 offset:0
    ds_read_b64_tr_b16 a[212:213], v31 offset:8
    s_waitcnt vmcnt(12) lgkmcnt(0)
    s_barrier
    s_add_u32 m0, s43, 36864
    s_add_u32 s41, s58, 262144
    buffer_load_dwordx4 v16, s[8:11], s41 offen offset:0 nt lds
    s_add_u32 s41, s58, 277504
    buffer_load_dwordx4 v16, s[8:11], s41 offen offset:1024 nt lds
    s_add_u32 s41, s58, 391168
    buffer_load_dwordx4 v16, s[8:11], s41 offen offset:2048 nt lds
    s_add_u32 s41, s58, 406528
    buffer_load_dwordx4 v16, s[8:11], s41 offen offset:3072 nt lds
    v_add_u32 v28, 73728, v24
    v_add_u32 v29, 73728, v25
    v_add_u32 v30, 73728, v26
    v_add_u32 v31, 73728, v27
    ds_read_b64_tr_b16 a[158:159], v28 offset:0
    ds_read_b64_tr_b16 a[166:167], v28 offset:8
    ds_read_b64_tr_b16 a[174:175], v29 offset:0
    ds_read_b64_tr_b16 a[182:183], v29 offset:8
    ds_read_b64_tr_b16 a[190:191], v30 offset:0
    ds_read_b64_tr_b16 a[198:199], v30 offset:8
    ds_read_b64_tr_b16 a[206:207], v31 offset:0
    ds_read_b64_tr_b16 a[214:215], v31 offset:8
    s_waitcnt vmcnt(12) lgkmcnt(0)
    s_barrier
    s_add_u32 m0, s43, 73728
    s_add_u32 s41, s58, 270336
    buffer_load_dwordx4 v16, s[8:11], s41 offen offset:0 nt lds
    s_add_u32 s41, s58, 285696
    buffer_load_dwordx4 v16, s[8:11], s41 offen offset:1024 nt lds
    s_add_u32 s41, s58, 399360
    buffer_load_dwordx4 v16, s[8:11], s41 offen offset:2048 nt lds
    s_add_u32 s41, s58, 414720
    buffer_load_dwordx4 v16, s[8:11], s41 offen offset:3072 nt lds
    v_add_u32 v77, 110592, v20
    ds_read_b64_tr_b16 a[216:217], v77 offset:0
    ds_read_b64_tr_b16 a[218:219], v77 offset:4096
    ds_read_b64_tr_b16 a[220:221], v77 offset:8192
    ds_read_b64_tr_b16 a[222:223], v77 offset:12288
    ds_read_b64_tr_b16 a[224:225], v77 offset:8
    ds_read_b64_tr_b16 a[226:227], v77 offset:4104
    ds_read_b64_tr_b16 a[228:229], v77 offset:8200
    ds_read_b64_tr_b16 a[230:231], v77 offset:12296
    s_waitcnt vmcnt(12) lgkmcnt(0)
    s_barrier
    s_add_u32 m0, s43, 110592
    s_add_u32 s41, s58, 524288
    buffer_load_dwordx4 v16, s[8:11], s41 offen offset:0 nt lds
    s_add_u32 s41, s58, 539648
    buffer_load_dwordx4 v16, s[8:11], s41 offen offset:1024 nt lds
    s_add_u32 s41, s58, 653312
    buffer_load_dwordx4 v16, s[8:11], s41 offen offset:2048 nt lds
    s_add_u32 s41, s58, 668672
    buffer_load_dwordx4 v16, s[8:11], s41 offen offset:3072 nt lds
    v_add_u32 v28, 147456, v24
    v_add_u32 v29, 147456, v25
    v_add_u32 v30, 147456, v26
    v_add_u32 v31, 147456, v27
    ds_read_b64_tr_b16 v[0:1], v28 offset:0
    ds_read_b64_tr_b16 v[2:3], v28 offset:8
    ds_read_b64_tr_b16 v[4:5], v29 offset:0
    ds_read_b64_tr_b16 v[6:7], v29 offset:8
    ds_read_b64_tr_b16 a[0:1], v30 offset:0
    ds_read_b64_tr_b16 v[8:9], v30 offset:8
    ds_read_b64_tr_b16 a[8:9], v31 offset:0
    ds_read_b64_tr_b16 v[10:11], v31 offset:8
    s_waitcnt vmcnt(12) lgkmcnt(0)
    s_barrier
    s_add_u32 m0, s43, 147456
    s_add_u32 s41, s58, 532480
    buffer_load_dwordx4 v16, s[8:11], s41 offen offset:0 nt lds
    s_add_u32 s41, s58, 547840
    buffer_load_dwordx4 v16, s[8:11], s41 offen offset:1024 nt lds
    s_add_u32 s41, s58, 661504
    buffer_load_dwordx4 v16, s[8:11], s41 offen offset:2048 nt lds
    s_add_u32 s41, s58, 676864
    buffer_load_dwordx4 v16, s[8:11], s41 offen offset:3072 nt lds
    ds_write_b64 v70, v[0:1] offset:0
    ds_write_b64 v70, v[2:3] offset:2048
    ds_write_b64 v70, v[4:5] offset:4096
    ds_write_b64 v70, v[6:7] offset:6144
    ds_write_b64 v70, v[8:9] offset:10240
    ds_write_b64 v70, v[10:11] offset:14336
    v_add_u32 v28, 0, v24
    v_add_u32 v29, 0, v25
    v_add_u32 v30, 0, v26
    v_add_u32 v31, 0, v27
    ds_read_b64_tr_b16 v[32:33], v28 offset:0
    ds_read_b64_tr_b16 v[34:35], v28 offset:8
    ds_read_b64_tr_b16 v[36:37], v29 offset:0
    ds_read_b64_tr_b16 v[38:39], v29 offset:8
    ds_read_b64_tr_b16 a[2:3], v30 offset:0
    ds_read_b64_tr_b16 v[40:41], v30 offset:8
    ds_read_b64_tr_b16 a[10:11], v31 offset:0
    ds_read_b64_tr_b16 v[42:43], v31 offset:8
    s_waitcnt vmcnt(12) lgkmcnt(0)
    s_barrier
    s_add_u32 m0, s43, 0
    s_add_u32 s41, s58, 786432
    buffer_load_dwordx4 v16, s[8:11], s41 offen offset:0 nt lds
    s_add_u32 s41, s58, 801792
    buffer_load_dwordx4 v16, s[8:11], s41 offen offset:1024 nt lds
    s_add_u32 s41, s58, 915456
    buffer_load_dwordx4 v16, s[8:11], s41 offen offset:2048 nt lds
    s_add_u32 s41, s58, 930816
    buffer_load_dwordx4 v16, s[8:11], s41 offen offset:3072 nt lds
    ds_write_b64 v70, v[32:33] offset:8
    ds_write_b64 v70, v[34:35] offset:2056
    ds_write_b64 v70, v[36:37] offset:4104
    ds_write_b64 v70, v[38:39] offset:6152
    ds_write_b64 v70, v[40:41] offset:10248
    ds_write_b64 v70, v[42:43] offset:14344
    v_add_u32 v28, 36864, v24
    v_add_u32 v29, 36864, v25
    v_add_u32 v30, 36864, v26
    v_add_u32 v31, 36864, v27
    ds_read_b64_tr_b16 v[0:1], v28 offset:0
    ds_read_b64_tr_b16 v[2:3], v28 offset:8
    ds_read_b64_tr_b16 v[4:5], v29 offset:0
    ds_read_b64_tr_b16 v[6:7], v29 offset:8
    ds_read_b64_tr_b16 a[4:5], v30 offset:0
    ds_read_b64_tr_b16 v[8:9], v30 offset:8
    ds_read_b64_tr_b16 a[12:13], v31 offset:0
    ds_read_b64_tr_b16 v[10:11], v31 offset:8
    s_waitcnt vmcnt(12) lgkmcnt(0)
    s_barrier
    s_add_u32 m0, s43, 36864
    s_add_u32 s41, s58, 794624
    buffer_load_dwordx4 v16, s[8:11], s41 offen offset:0 nt lds
    s_add_u32 s41, s58, 809984
    buffer_load_dwordx4 v16, s[8:11], s41 offen offset:1024 nt lds
    s_add_u32 s41, s58, 923648
    buffer_load_dwordx4 v16, s[8:11], s41 offen offset:2048 nt lds
    s_add_u32 s41, s58, 939008
    buffer_load_dwordx4 v16, s[8:11], s41 offen offset:3072 nt lds
    ds_write_b64 v70, v[0:1] offset:1024
    ds_write_b64 v70, v[2:3] offset:3072
    ds_write_b64 v70, v[4:5] offset:5120
    ds_write_b64 v70, v[6:7] offset:7168
    ds_write_b64 v70, v[8:9] offset:11264
    ds_write_b64 v70, v[10:11] offset:15360
    v_add_u32 v28, 73728, v24
    v_add_u32 v29, 73728, v25
    v_add_u32 v30, 73728, v26
    v_add_u32 v31, 73728, v27
    ds_read_b64_tr_b16 v[32:33], v28 offset:0
    ds_read_b64_tr_b16 v[34:35], v28 offset:8
    ds_read_b64_tr_b16 v[36:37], v29 offset:0
    ds_read_b64_tr_b16 v[38:39], v29 offset:8
    ds_read_b64_tr_b16 a[6:7], v30 offset:0
    ds_read_b64_tr_b16 v[40:41], v30 offset:8
    ds_read_b64_tr_b16 a[14:15], v31 offset:0
    ds_read_b64_tr_b16 v[42:43], v31 offset:8
    s_waitcnt vmcnt(12) lgkmcnt(0)
    s_barrier
    s_add_u32 m0, s43, 73728
    s_add_u32 s41, s59, 0
    buffer_load_dwordx4 v17, s[8:11], s41 offen offset:0 nt lds
    s_add_u32 s41, s59, 31744
    buffer_load_dwordx4 v17, s[8:11], s41 offen offset:1024 nt lds
    s_add_u32 s41, s59, 129024
    buffer_load_dwordx4 v17, s[8:11], s41 offen offset:2048 nt lds
    s_add_u32 s41, s59, 160768
    buffer_load_dwordx4 v17, s[8:11], s41 offen offset:3072 nt lds
    ds_write_b64 v70, v[32:33] offset:1032
    ds_write_b64 v70, v[34:35] offset:3080
    ds_write_b64 v70, v[36:37] offset:5128
    ds_write_b64 v70, v[38:39] offset:7176
    ds_write_b64 v70, v[40:41] offset:11272
    ds_write_b64 v70, v[42:43] offset:15368
    v_add_u32 v28, 110592, v24
    v_add_u32 v29, 110592, v25
    v_add_u32 v30, 110592, v26
    v_add_u32 v31, 110592, v27
    ds_read_b64_tr_b16 a[16:17], v28 offset:0
    ds_read_b64_tr_b16 a[24:25], v28 offset:8
    ds_read_b64_tr_b16 a[32:33], v29 offset:0
    ds_read_b64_tr_b16 a[40:41], v29 offset:8
    ds_read_b64_tr_b16 a[48:49], v30 offset:0
    ds_read_b64_tr_b16 a[56:57], v30 offset:8
    ds_read_b64_tr_b16 a[64:65], v31 offset:0
    ds_read_b64_tr_b16 a[72:73], v31 offset:8
    s_waitcnt vmcnt(12) lgkmcnt(0)
    s_barrier
    s_mov_b64 s[8:9], s[54:55]
    s_add_u32 m0, s43, 110592
    s_add_u32 s41, s58, 0
    buffer_load_dwordx4 v16, s[8:11], s41 offen offset:0 nt lds
    s_add_u32 s41, s58, 15360
    buffer_load_dwordx4 v16, s[8:11], s41 offen offset:1024 nt lds
    s_add_u32 s41, s58, 129024
    buffer_load_dwordx4 v16, s[8:11], s41 offen offset:2048 nt lds
    s_add_u32 s41, s58, 144384
    buffer_load_dwordx4 v16, s[8:11], s41 offen offset:3072 nt lds
    v_add_u32 v28, 147456, v24
    v_add_u32 v29, 147456, v25
    v_add_u32 v30, 147456, v26
    v_add_u32 v31, 147456, v27
    ds_read_b64_tr_b16 a[18:19], v28 offset:0
    ds_read_b64_tr_b16 a[26:27], v28 offset:8
    ds_read_b64_tr_b16 a[34:35], v29 offset:0
    ds_read_b64_tr_b16 a[42:43], v29 offset:8
    ds_read_b64_tr_b16 a[50:51], v30 offset:0
    ds_read_b64_tr_b16 a[58:59], v30 offset:8
    ds_read_b64_tr_b16 a[66:67], v31 offset:0
    ds_read_b64_tr_b16 a[74:75], v31 offset:8
    s_waitcnt vmcnt(12) lgkmcnt(0)
    s_barrier
    s_add_u32 m0, s43, 147456
    s_add_u32 s41, s58, 8192
    buffer_load_dwordx4 v16, s[8:11], s41 offen offset:0 nt lds
    s_add_u32 s41, s58, 23552
    buffer_load_dwordx4 v16, s[8:11], s41 offen offset:1024 nt lds
    s_add_u32 s41, s58, 137216
    buffer_load_dwordx4 v16, s[8:11], s41 offen offset:2048 nt lds
    s_add_u32 s41, s58, 152576
    buffer_load_dwordx4 v16, s[8:11], s41 offen offset:3072 nt lds
    v_add_u32 v28, 0, v24
    v_add_u32 v29, 0, v25
    v_add_u32 v30, 0, v26
    v_add_u32 v31, 0, v27
    ds_read_b64_tr_b16 a[20:21], v28 offset:0
    ds_read_b64_tr_b16 a[28:29], v28 offset:8
    ds_read_b64_tr_b16 a[36:37], v29 offset:0
    ds_read_b64_tr_b16 a[44:45], v29 offset:8
    ds_read_b64_tr_b16 a[52:53], v30 offset:0
    ds_read_b64_tr_b16 a[60:61], v30 offset:8
    ds_read_b64_tr_b16 a[68:69], v31 offset:0
    ds_read_b64_tr_b16 a[76:77], v31 offset:8
    s_waitcnt vmcnt(12) lgkmcnt(0)
    s_barrier
    s_add_u32 m0, s43, 0
    s_add_u32 s41, s58, 262144
    buffer_load_dwordx4 v16, s[8:11], s41 offen offset:0 nt lds
    s_add_u32 s41, s58, 277504
    buffer_load_dwordx4 v16, s[8:11], s41 offen offset:1024 nt lds
    s_add_u32 s41, s58, 391168
    buffer_load_dwordx4 v16, s[8:11], s41 offen offset:2048 nt lds
    s_add_u32 s41, s58, 406528
    buffer_load_dwordx4 v16, s[8:11], s41 offen offset:3072 nt lds
    v_add_u32 v28, 36864, v24
    v_add_u32 v29, 36864, v25
    v_add_u32 v30, 36864, v26
    v_add_u32 v31, 36864, v27
    ds_read_b64_tr_b16 a[22:23], v28 offset:0
    ds_read_b64_tr_b16 a[30:31], v28 offset:8
    ds_read_b64_tr_b16 a[38:39], v29 offset:0
    ds_read_b64_tr_b16 a[46:47], v29 offset:8
    ds_read_b64_tr_b16 a[54:55], v30 offset:0
    ds_read_b64_tr_b16 a[62:63], v30 offset:8
    ds_read_b64_tr_b16 a[70:71], v31 offset:0
    ds_read_b64_tr_b16 a[78:79], v31 offset:8
    s_waitcnt vmcnt(12) lgkmcnt(0)
    s_barrier
    s_add_u32 m0, s43, 36864
    s_add_u32 s41, s58, 270336
    buffer_load_dwordx4 v16, s[8:11], s41 offen offset:0 nt lds
    s_add_u32 s41, s58, 285696
    buffer_load_dwordx4 v16, s[8:11], s41 offen offset:1024 nt lds
    s_add_u32 s41, s58, 399360
    buffer_load_dwordx4 v16, s[8:11], s41 offen offset:2048 nt lds
    s_add_u32 s41, s58, 414720
    buffer_load_dwordx4 v16, s[8:11], s41 offen offset:3072 nt lds
    v_add_u32 v77, 73728, v20
    ds_read_b64_tr_b16 a[80:81], v77 offset:0
    ds_read_b64_tr_b16 a[82:83], v77 offset:4096
    ds_read_b64_tr_b16 a[84:85], v77 offset:8192
    ds_read_b64_tr_b16 a[86:87], v77 offset:12288
    ds_read_b64_tr_b16 a[88:89], v77 offset:8
    ds_read_b64_tr_b16 a[90:91], v77 offset:4104
    ds_read_b64_tr_b16 a[92:93], v77 offset:8200
    ds_read_b64_tr_b16 a[94:95], v77 offset:12296
    s_waitcnt vmcnt(12) lgkmcnt(0)
    s_barrier
    s_add_u32 m0, s43, 73728
    s_add_u32 s41, s58, 524288
    buffer_load_dwordx4 v16, s[8:11], s41 offen offset:0 nt lds
    s_add_u32 s41, s58, 539648
    buffer_load_dwordx4 v16, s[8:11], s41 offen offset:1024 nt lds
    s_add_u32 s41, s58, 653312
    buffer_load_dwordx4 v16, s[8:11], s41 offen offset:2048 nt lds
    s_add_u32 s41, s58, 668672
    buffer_load_dwordx4 v16, s[8:11], s41 offen offset:3072 nt lds
    v_add_u32 v28, 110592, v24
    v_add_u32 v29, 110592, v25
    v_add_u32 v30, 110592, v26
    v_add_u32 v31, 110592, v27
    ds_read_b64_tr_b16 a[232:233], v28 offset:0
    ds_read_b64_tr_b16 v[32:33], v28 offset:8
    ds_read_b64_tr_b16 a[240:241], v29 offset:0
    ds_read_b64_tr_b16 a[248:249], v29 offset:8
    ds_read_b64_tr_b16 v[144:145], v30 offset:0
    ds_read_b64_tr_b16 v[152:153], v30 offset:8
    ds_read_b64_tr_b16 v[160:161], v31 offset:0
    ds_read_b64_tr_b16 v[168:169], v31 offset:8
    s_waitcnt vmcnt(12) lgkmcnt(0)
    s_barrier
    s_add_u32 m0, s43, 110592
    s_add_u32 s41, s58, 532480
    buffer_load_dwordx4 v16, s[8:11], s41 offen offset:0 nt lds
    s_add_u32 s41, s58, 547840
    buffer_load_dwordx4 v16, s[8:11], s41 offen offset:1024 nt lds
    s_add_u32 s41, s58, 661504
    buffer_load_dwordx4 v16, s[8:11], s41 offen offset:2048 nt lds
    s_add_u32 s41, s58, 676864
    buffer_load_dwordx4 v16, s[8:11], s41 offen offset:3072 nt lds
    ds_write_b64 v70, v[32:33] offset:8192
    v_add_u32 v28, 147456, v24
    v_add_u32 v29, 147456, v25
    v_add_u32 v30, 147456, v26
    v_add_u32 v31, 147456, v27
    ds_read_b64_tr_b16 a[234:235], v28 offset:0
    ds_read_b64_tr_b16 v[0:1], v28 offset:8
    ds_read_b64_tr_b16 a[242:243], v29 offset:0
    ds_read_b64_tr_b16 a[250:251], v29 offset:8
    ds_read_b64_tr_b16 v[146:147], v30 offset:0
    ds_read_b64_tr_b16 v[154:155], v30 offset:8
    ds_read_b64_tr_b16 v[162:163], v31 offset:0
    ds_read_b64_tr_b16 v[170:171], v31 offset:8
    s_waitcnt vmcnt(12) lgkmcnt(0)
    s_barrier
    s_add_u32 m0, s43, 147456
    s_add_u32 s41, s58, 786432
    buffer_load_dwordx4 v16, s[8:11], s41 offen offset:0 nt lds
    s_add_u32 s41, s58, 801792
    buffer_load_dwordx4 v16, s[8:11], s41 offen offset:1024 nt lds
    s_add_u32 s41, s58, 915456
    buffer_load_dwordx4 v16, s[8:11], s41 offen offset:2048 nt lds
    s_add_u32 s41, s58, 930816
    buffer_load_dwordx4 v16, s[8:11], s41 offen offset:3072 nt lds
    ds_write_b64 v70, v[0:1] offset:8200
    v_add_u32 v28, 0, v24
    v_add_u32 v29, 0, v25
    v_add_u32 v30, 0, v26
    v_add_u32 v31, 0, v27
    ds_read_b64_tr_b16 a[236:237], v28 offset:0
    ds_read_b64_tr_b16 v[32:33], v28 offset:8
    ds_read_b64_tr_b16 a[244:245], v29 offset:0
    ds_read_b64_tr_b16 a[252:253], v29 offset:8
    ds_read_b64_tr_b16 v[148:149], v30 offset:0
    ds_read_b64_tr_b16 v[156:157], v30 offset:8
    ds_read_b64_tr_b16 v[164:165], v31 offset:0
    ds_read_b64_tr_b16 v[172:173], v31 offset:8
    s_waitcnt vmcnt(12) lgkmcnt(0)
    s_barrier
    s_add_u32 m0, s43, 0
    s_add_u32 s41, s58, 794624
    buffer_load_dwordx4 v16, s[8:11], s41 offen offset:0 nt lds
    s_add_u32 s41, s58, 809984
    buffer_load_dwordx4 v16, s[8:11], s41 offen offset:1024 nt lds
    s_add_u32 s41, s58, 923648
    buffer_load_dwordx4 v16, s[8:11], s41 offen offset:2048 nt lds
    s_add_u32 s41, s58, 939008
    buffer_load_dwordx4 v16, s[8:11], s41 offen offset:3072 nt lds
    ds_write_b64 v70, v[32:33] offset:9216
    v_add_u32 v28, 36864, v24
    v_add_u32 v29, 36864, v25
    v_add_u32 v30, 36864, v26
    v_add_u32 v31, 36864, v27
    ds_read_b64_tr_b16 a[238:239], v28 offset:0
    ds_read_b64_tr_b16 v[0:1], v28 offset:8
    ds_read_b64_tr_b16 a[246:247], v29 offset:0
    ds_read_b64_tr_b16 a[254:255], v29 offset:8
    ds_read_b64_tr_b16 v[150:151], v30 offset:0
    ds_read_b64_tr_b16 v[158:159], v30 offset:8
    ds_read_b64_tr_b16 v[166:167], v31 offset:0
    ds_read_b64_tr_b16 v[174:175], v31 offset:8
    s_waitcnt vmcnt(12) lgkmcnt(0)
    s_barrier
    s_add_u32 m0, s43, 36864
    s_add_u32 s41, s59, 0
    buffer_load_dwordx4 v17, s[8:11], s41 offen offset:0 nt lds
    s_add_u32 s41, s59, 31744
    buffer_load_dwordx4 v17, s[8:11], s41 offen offset:1024 nt lds
    s_add_u32 s41, s59, 129024
    buffer_load_dwordx4 v17, s[8:11], s41 offen offset:2048 nt lds
    s_add_u32 s41, s59, 160768
    buffer_load_dwordx4 v17, s[8:11], s41 offen offset:3072 nt lds
    ds_write_b64 v70, v[0:1] offset:9224
    v_add_u32 v28, 73728, v24
    v_add_u32 v29, 73728, v25
    v_add_u32 v30, 73728, v26
    v_add_u32 v31, 73728, v27
    ds_read_b64_tr_b16 v[176:177], v28 offset:0
    ds_read_b64_tr_b16 v[184:185], v28 offset:8
    ds_read_b64_tr_b16 v[192:193], v29 offset:0
    ds_read_b64_tr_b16 v[200:201], v29 offset:8
    ds_read_b64_tr_b16 v[208:209], v30 offset:0
    ds_read_b64_tr_b16 v[216:217], v30 offset:8
    ds_read_b64_tr_b16 v[224:225], v31 offset:0
    ds_read_b64_tr_b16 v[232:233], v31 offset:8
    s_waitcnt vmcnt(12) lgkmcnt(0)
    s_barrier
    s_mov_b64 s[8:9], s[56:57]
    s_add_u32 m0, s43, 73728
    s_add_u32 s41, s60, 128
    buffer_load_dwordx4 v18, s[8:11], s41 offen offset:0 nt lds
    s_add_u32 s41, s60, 8320
    buffer_load_dwordx4 v18, s[8:11], s41 offen offset:1024 nt lds
    s_add_u32 s41, s60, 16512
    buffer_load_dwordx4 v18, s[8:11], s41 offen offset:2048 nt lds
    s_add_u32 s41, s60, 24704
    buffer_load_dwordx4 v18, s[8:11], s41 offen offset:3072 nt lds
    v_add_u32 v28, 110592, v24
    v_add_u32 v29, 110592, v25
    v_add_u32 v30, 110592, v26
    v_add_u32 v31, 110592, v27
    ds_read_b64_tr_b16 v[178:179], v28 offset:0
    ds_read_b64_tr_b16 v[186:187], v28 offset:8
    ds_read_b64_tr_b16 v[194:195], v29 offset:0
    ds_read_b64_tr_b16 v[202:203], v29 offset:8
    ds_read_b64_tr_b16 v[210:211], v30 offset:0
    ds_read_b64_tr_b16 v[218:219], v30 offset:8
    ds_read_b64_tr_b16 v[226:227], v31 offset:0
    ds_read_b64_tr_b16 v[234:235], v31 offset:8
    s_waitcnt vmcnt(12) lgkmcnt(0)
    s_barrier
    s_add_u32 m0, s43, 110592
    s_add_u32 s41, s61, 128
    buffer_load_dwordx4 v18, s[8:11], s41 offen offset:0 nt lds
    s_add_u32 s41, s61, 8320
    buffer_load_dwordx4 v18, s[8:11], s41 offen offset:1024 nt lds
    s_add_u32 s41, s61, 16512
    buffer_load_dwordx4 v18, s[8:11], s41 offen offset:2048 nt lds
    s_add_u32 s41, s61, 24704
    buffer_load_dwordx4 v18, s[8:11], s41 offen offset:3072 nt lds
    v_add_u32 v28, 147456, v24
    v_add_u32 v29, 147456, v25
    v_add_u32 v30, 147456, v26
    v_add_u32 v31, 147456, v27
    ds_read_b64_tr_b16 v[180:181], v28 offset:0
    ds_read_b64_tr_b16 v[188:189], v28 offset:8
    ds_read_b64_tr_b16 v[196:197], v29 offset:0
    ds_read_b64_tr_b16 v[204:205], v29 offset:8
    ds_read_b64_tr_b16 v[212:213], v30 offset:0
    ds_read_b64_tr_b16 v[220:221], v30 offset:8
    ds_read_b64_tr_b16 v[228:229], v31 offset:0
    ds_read_b64_tr_b16 v[236:237], v31 offset:8
    s_waitcnt vmcnt(12) lgkmcnt(0)
    s_barrier
    s_add_u32 m0, s43, 147456
    s_add_u32 s41, s62, 128
    buffer_load_dwordx4 v18, s[8:11], s41 offen offset:0 nt lds
    s_add_u32 s41, s62, 8320
    buffer_load_dwordx4 v18, s[8:11], s41 offen offset:1024 nt lds
    s_add_u32 s41, s62, 16512
    buffer_load_dwordx4 v18, s[8:11], s41 offen offset:2048 nt lds
    s_add_u32 s41, s62, 24704
    buffer_load_dwordx4 v18, s[8:11], s41 offen offset:3072 nt lds
    v_add_u32 v28, 0, v24
    v_add_u32 v29, 0, v25
    v_add_u32 v30, 0, v26
    v_add_u32 v31, 0, v27
    ds_read_b64_tr_b16 v[182:183], v28 offset:0
    ds_read_b64_tr_b16 v[190:191], v28 offset:8
    ds_read_b64_tr_b16 v[198:199], v29 offset:0
    ds_read_b64_tr_b16 v[206:207], v29 offset:8
    ds_read_b64_tr_b16 v[214:215], v30 offset:0
    ds_read_b64_tr_b16 v[222:223], v30 offset:8
    ds_read_b64_tr_b16 v[230:231], v31 offset:0
    ds_read_b64_tr_b16 v[238:239], v31 offset:8
    s_waitcnt vmcnt(12) lgkmcnt(0)
    s_barrier
    s_add_u32 m0, s43, 0
    s_add_u32 s41, s63, 128
    buffer_load_dwordx4 v18, s[8:11], s41 offen offset:0 nt lds
    s_add_u32 s41, s63, 8320
    buffer_load_dwordx4 v18, s[8:11], s41 offen offset:1024 nt lds
    s_add_u32 s41, s63, 16512
    buffer_load_dwordx4 v18, s[8:11], s41 offen offset:2048 nt lds
    s_add_u32 s41, s63, 24704
    buffer_load_dwordx4 v18, s[8:11], s41 offen offset:3072 nt lds
    v_mov_b32 v78, v21
    v_mov_b32 v79, v22
    v_add_u32 v77, 36864, v20
    ds_read_b64_tr_b16 v[240:241], v77 offset:0
    ds_read_b64_tr_b16 v[242:243], v77 offset:4096
    ds_read_b64_tr_b16 v[244:245], v77 offset:8192
    ds_read_b64_tr_b16 v[246:247], v77 offset:12288
    ds_read_b64_tr_b16 v[248:249], v77 offset:8
    ds_read_b64_tr_b16 v[250:251], v77 offset:4104
    ds_read_b64_tr_b16 v[252:253], v77 offset:8200
    ds_read_b64_tr_b16 v[254:255], v77 offset:12296
    s_waitcnt vmcnt(12) lgkmcnt(0)
    s_barrier
    v_add_u32 v77, 73728, v79
    s_waitcnt lgkmcnt(0)
    ds_read_b64_tr_b16 v[0:1], v77 offset:0
    ds_read_b64_tr_b16 v[2:3], v77 offset:256
    ds_read_b64_tr_b16 v[4:5], v77 offset:2048
    ds_read_b64_tr_b16 v[6:7], v77 offset:2304
    ds_read_b64_tr_b16 v[8:9], v77 offset:8
    ds_read_b64_tr_b16 v[10:11], v77 offset:264
    ds_read_b64_tr_b16 v[12:13], v77 offset:2056
    ds_read_b64_tr_b16 v[14:15], v77 offset:2312
    s_waitcnt vmcnt(8) lgkmcnt(0)
    s_barrier
    v_add_u32 v77, 110592, v78
    ds_read_b64_tr_b16 v[16:17], v77 offset:0
    ds_read_b64_tr_b16 v[18:19], v77 offset:256
    ds_read_b64_tr_b16 v[20:21], v77 offset:2048
    ds_read_b64_tr_b16 v[22:23], v77 offset:2304
    ds_read_b64_tr_b16 v[24:25], v77 offset:8
    ds_read_b64_tr_b16 v[26:27], v77 offset:264
    ds_read_b64_tr_b16 v[28:29], v77 offset:2056
    ds_read_b64_tr_b16 v[30:31], v77 offset:2312
    s_waitcnt vmcnt(4) lgkmcnt(0)
    s_barrier
    v_add_u32 v77, 147456, v78
    ds_read_b64_tr_b16 v[32:33], v77 offset:0
    ds_read_b64_tr_b16 v[34:35], v77 offset:256
    ds_read_b64_tr_b16 v[36:37], v77 offset:2048
    ds_read_b64_tr_b16 v[38:39], v77 offset:2304
    ds_read_b64_tr_b16 v[40:41], v77 offset:8
    ds_read_b64_tr_b16 v[42:43], v77 offset:264
    ds_read_b64_tr_b16 v[44:45], v77 offset:2056
    ds_read_b64_tr_b16 v[46:47], v77 offset:2312
    s_waitcnt vmcnt(0) lgkmcnt(0)
    s_barrier
    v_add_u32 v77, 0, v78
    ds_read_b64_tr_b16 v[48:49], v77 offset:0
    ds_read_b64_tr_b16 v[50:51], v77 offset:256
    ds_read_b64_tr_b16 v[52:53], v77 offset:2048
    ds_read_b64_tr_b16 v[54:55], v77 offset:2304
    ds_read_b64_tr_b16 v[56:57], v77 offset:8
    ds_read_b64_tr_b16 v[58:59], v77 offset:264
    ds_read_b64_tr_b16 v[60:61], v77 offset:2056
    ds_read_b64_tr_b16 v[62:63], v77 offset:2312
    s_waitcnt lgkmcnt(0)
    s_barrier
    ds_write_b128 v70, v[0:3] offset:20480
    ds_write_b128 v70, v[4:7] offset:21504
    ds_write_b128 v70, v[8:11] offset:22528
    ds_write_b128 v70, v[12:15] offset:23552
    ds_write_b128 v70, v[16:19] offset:24576
    ds_write_b128 v70, v[20:23] offset:25600
    ds_write_b128 v70, v[24:27] offset:26624
    ds_write_b128 v70, v[28:31] offset:27648
    ds_write_b128 v70, v[32:35] offset:28672
    ds_write_b128 v70, v[36:39] offset:29696
    ds_write_b128 v70, v[40:43] offset:30720
    ds_write_b128 v70, v[44:47] offset:31744
    ds_write_b128 v70, v[48:51] offset:32768
    ds_write_b128 v70, v[52:55] offset:33792
    ds_write_b128 v70, v[56:59] offset:34816
    ds_write_b128 v70, v[60:63] offset:35840
    s_waitcnt lgkmcnt(0)
    v_bfe_u32 v60, v65, 4, 6
    v_and_b32 v61, 15, v60
    v_lshrrev_b32 v62, 4, v60
    v_mov_b32 v50, 0x3f80
    v_mov_b32 v51, 0x3f800000
    v_and_b32 v77, 1, v62
    v_lshlrev_b32 v77, 2, v77
    v_sub_u32 v77, v61, v77
    v_and_b32 v78, 3, v61
    v_lshlrev_b32 v78, 2, v78
    v_lshrrev_b32 v79, 2, v61
    v_add_u32 v78, v78, v79
    v_cmp_eq_u32 vcc, 0, v77
    s_nop 1
    v_cndmask_b32 v8, 0, v50, vcc
    v_cmp_eq_u32 vcc, 1, v77
    s_nop 1
    v_cndmask_b32 v8, v8, v51, vcc
    v_cmp_eq_u32 vcc, 0, v78
    s_nop 1
    v_cndmask_b32 v12, 0, v50, vcc
    v_cmp_eq_u32 vcc, 1, v78
    s_nop 1
    v_cndmask_b32 v12, v12, v51, vcc
    v_cmp_eq_u32 vcc, 2, v77
    s_nop 1
    v_cndmask_b32 v9, 0, v50, vcc
    v_cmp_eq_u32 vcc, 3, v77
    s_nop 1
    v_cndmask_b32 v9, v9, v51, vcc
    v_cmp_eq_u32 vcc, 2, v78
    s_nop 1
    v_cndmask_b32 v13, 0, v50, vcc
    v_cmp_eq_u32 vcc, 3, v78
    s_nop 1
    v_cndmask_b32 v13, v13, v51, vcc
    v_cmp_eq_u32 vcc, 8, v77
    s_nop 1
    v_cndmask_b32 v10, 0, v50, vcc
    v_cmp_eq_u32 vcc, 9, v77
    s_nop 1
    v_cndmask_b32 v10, v10, v51, vcc
    v_cmp_eq_u32 vcc, 4, v78
    s_nop 1
    v_cndmask_b32 v14, 0, v50, vcc
    v_cmp_eq_u32 vcc, 5, v78
    s_nop 1
    v_cndmask_b32 v14, v14, v51, vcc
    v_cmp_eq_u32 vcc, 10, v77
    s_nop 1
    v_cndmask_b32 v11, 0, v50, vcc
    v_cmp_eq_u32 vcc, 11, v77
    s_nop 1
    v_cndmask_b32 v11, v11, v51, vcc
    v_cmp_eq_u32 vcc, 6, v78
    s_nop 1
    v_cndmask_b32 v15, 0, v50, vcc
    v_cmp_eq_u32 vcc, 7, v78
    s_nop 1
    v_cndmask_b32 v15, v15, v51, vcc
    v_lshlrev_b32 v77, 4, v61
    ds_write_b128 v69, v[8:11] offset:15360
    ds_write_b128 v77, v[12:15] offset:15872
    s_waitcnt vmcnt(0) lgkmcnt(0)
    s_barrier
    v_mov_b32 v2, 1
    s_cmp_lg_u32 s13, 0
    s_cbranch_scc1 cs_noarr
    s_mov_b64 exec, 1
    buffer_atomic_add v2, off, s[84:87], 0 offset:212
    s_mov_b32 s40, 16777216
    s_mov_b32 s42, 2
cs_startpoll:
    buffer_load_dword v3, off, s[84:87], 0 offset:212 sc1
    s_sub_u32 s40, s40, 1
    s_cbranch_scc1 cs_decide
    s_waitcnt vmcnt(0)
    v_readfirstlane_b32 s41, v3
    s_nop 1
    s_cmp_lt_u32 s41, 32
    s_cbranch_scc1 cs_startpoll
    s_mov_b32 s42, 1
cs_decide:
    s_mov_b64 exec, -1
cs_noarr:
    s_barrier
    s_mov_b32 s44, 0x3e0293ee
    s_mov_b32 s45, s44
    s_or_b32 s66, s44, 0x80000000
    s_mov_b32 s48, 0x3f003f00
    s_mov_b32 s49, 0
    s_mov_b32 s50, 0x3f803f80
    s_mov_b32 s51, 0x3f803f80
    s_mov_b32 s52, 512
    s_mov_b32 s53, 1024
    s_mov_b32 s54, 1536
    s_mov_b32 s30, 0
    s_mov_b32 s37, 0
    s_lshl_b32 s47, s13, 9
    s_cmp_lg_u32 s32, 0
    s_cselect_b32 s71, s13, 3
    s_add_u32 s46, s71, 1
    s_lshr_b32 s46, s46, 1
    s_mov_b32 s14, 67649536
    s_mov_b32 s15, 67653632
    s_mov_b32 s16, 67657728
    s_mov_b32 s36, 0
    s_add_u32 s17, s68, 67633152
    s_mov_b32 s69, 0
    s_mov_b32 s70, 0
    s_lshl_b32 s26, s12, 14
    s_add_u32 s26, s26, 0
    s_mul_i32 s40, s13, 3072
    s_add_u32 s24, s26, s40
    s_lshl_b32 s96, s12, 7
    s_add_u32 s29, s96, 125845504
    s_add_u32 s96, s96, 125829120
    s_lshl_b32 s40, s12, 14
    s_add_u32 s40, s40, 68681728
    s_add_u32 s18, s40, 0
    s_add_u32 s19, s40, 4096
    s_add_u32 s20, s40, 8192
    s_add_u32 s21, s40, 12288
    s_lshr_b32 s40, s12, 3
    s_lshl_b32 s40, s40, 12
    s_and_b32 s41, s12, 7
    s_lshl_b32 s41, s41, 7
    s_add_u32 s40, s40, s41
    s_add_u32 s22, s40, 68681728
    s_add_u32 s23, s22, 1024
    s_add_u32 s25, s22, 2048
    s_mov_b32 s56, -65528
    s_cmp_lg_u32 s32, 0
    s_cselect_b64 s[38:39], -1, 0
    s_add_u32 s55, s68, 138412032
    s_cmp_eq_u32 s13, 3
    s_cselect_b64 s[100:101], 1, 0
    s_cselect_b64 s[38:39], 1, s[38:39]
    s_cselect_b32 s93, 64, 0
    s_cselect_b32 s55, s29, s55
    s_cselect_b32 s57, 0, 9216
    s_mov_b64 exec, s[100:101]
    v_mov_b32 v72, s95
    s_mov_b64 exec, -1
    s_mov_b32 s34, 0xff00ff00
    s_mov_b32 s35, 0xff00ff00
    s_lshl_b32 s28, s12, 12
    s_add_u32 s28, s28, 7340032
    s_add_u32 s27, s28, 77594624
    s_add_u32 s28, s28, 69206016
    s_mov_b32 s40, 3
    v_bfe_u32 v78, v65, 2, 5
    s_mov_b32 s31, 4194304
cs_kv0:
    buffer_load_dword v77, v78, s[4:7], s96 offen offset:16 sc1
    s_waitcnt vmcnt(0)
    v_subrev_u32 v77, s95, v77
    v_cmp_lt_u32 vcc, 16, v77
    s_nop 1
    v_cndmask_b32 v77, v77, 0, vcc
    v_bfe_u32 v79, v78, 2, 2
    v_lshl_add_u32 v77, v77, 2, v79
    s_nop 1
    v_min_u32_dpp v77, v77, v77 row_ror:1 row_mask:0xf bank_mask:0xf
    s_nop 1
    v_min_u32_dpp v77, v77, v77 row_ror:2 row_mask:0xf bank_mask:0xf
    s_nop 1
    v_min_u32_dpp v77, v77, v77 row_ror:4 row_mask:0xf bank_mask:0xf
    s_nop 0
    v_readfirstlane_b32 s97, v77
    s_sub_u32 s31, s31, 1
    s_cbranch_scc1 cs_kv0_x
    s_cmp_le_u32 s40, s97
    s_cbranch_scc1 cs_kv0_x
    s_sleep 2
    s_branch cs_kv0
cs_kv0_x:
    s_add_u32 s40, s24, 0
    s_add_u32 s40, s40, s33
    s_sub_u32 s41, s96, s40
    v_bfe_u32 v77, v65, 2, 5
    v_add3_u32 v77, v77, s41, 16
    v_lshlrev_b32 v78, 3, v69
    s_nop 0
    v_mov_b32_dpp v78, v77 quad_perm:[0,1,2,3] row_mask:0xc bank_mask:0xf
    buffer_load_dword v76, v78, s[4:7], s40 offen sc1
    s_add_u32 s40, s24, 524288
    s_add_u32 s40, s40, s33
    s_sub_u32 s41, s96, s40
    v_bfe_u32 v77, v65, 2, 5
    v_add3_u32 v77, v77, s41, 16
    v_lshlrev_b32 v78, 3, v69
    s_nop 0
    v_mov_b32_dpp v78, v77 quad_perm:[0,1,2,3] row_mask:0xc bank_mask:0xf
    buffer_load_dword v76, v78, s[4:7], s40 offen sc1
cs_kvdone:
    v_mov_b64 v[0:1], 0
    v_mov_b64 v[2:3], 0
    v_mov_b64 v[4:5], 0
    v_mov_b64 v[6:7], 0
    v_mov_b64 v[8:9], 0
    v_mov_b64 v[10:11], 0
    v_mov_b64 v[12:13], 0
    v_mov_b64 v[14:15], 0
    v_mov_b64 v[16:17], 0
    v_mov_b64 v[18:19], 0
    v_mov_b64 v[20:21], 0
    v_mov_b64 v[22:23], 0
    ds_read_b128 v[44:47], v70 offset:0
    ds_read_b128 v[48:51], v70 offset:1024
    ds_read_b128 v[52:55], v70 offset:2048
    ds_read_b128 v[56:59], v70 offset:3072
    ds_read_b128 v[24:27], v70 offset:4096
    ds_read_b128 v[28:31], v70 offset:5120
    ds_read_b128 v[32:35], v70 offset:6144
    ds_read_b128 v[36:39], v70 offset:7168
    buffer_load_dwordx4 v[40:43], v65, s[4:7], s14 offen offset:0 sc1
    buffer_load_dwordx4 v[60:63], v66, s[4:7], s14 offen offset:0 sc1
    s_mov_b32 s31, 1048576
    s_waitcnt vmcnt(0) lgkmcnt(0)
    s_branch cs_goA
cs_loop:
    s_mov_b32 s31, 1048576
    s_mov_b32 s69, s70
    s_waitcnt lgkmcnt(0)
cs_cA:
    buffer_load_dwordx4 v[40:43], v65, s[4:7], s14 offen offset:0 sc1
    buffer_load_dwordx4 v[60:63], v66, s[4:7], s14 offen offset:0 sc1
cs_cA1:
    v_bitop3_b32 v77, v40, v60, s70 bitop3:0x7e
    v_and_b32 v77, 1, v77
    v_cmp_ne_u32 vcc, 0, v77
    s_cbranch_vccz cs_goA
    s_nop 15
    s_nop 15
    s_nop 7
    v_bitop3_b32 v77, v40, v60, s70 bitop3:0x7e
    v_and_b32 v77, 1, v77
    v_cmp_ne_u32 vcc, 0, v77
    s_cbranch_vccz cs_goA
    s_nop 15
    s_nop 15
    s_nop 7
    v_bitop3_b32 v77, v40, v60, s70 bitop3:0x7e
    v_and_b32 v77, 1, v77
    v_cmp_ne_u32 vcc, 0, v77
    s_cbranch_vccz cs_goA
    s_nop 15
    s_nop 15
    s_nop 7
    v_bitop3_b32 v77, v40, v60, s70 bitop3:0x7e
    v_and_b32 v77, 1, v77
    v_cmp_ne_u32 vcc, 0, v77
    s_cbranch_vccz cs_goA
    s_nop 15
    s_nop 15
    s_nop 7
    buffer_load_dwordx4 v[40:43], v65, s[4:7], s14 offen offset:0 sc1
    buffer_load_dwordx4 v[60:63], v66, s[4:7], s14 offen offset:0 sc1
    v_bitop3_b32 v77, v40, v60, s70 bitop3:0x7e
    v_and_b32 v77, 1, v77
    v_cmp_ne_u32 vcc, 0, v77
    s_cbranch_vccz cs_goA
    s_nop 15
    s_nop 15
    s_nop 7
    v_bitop3_b32 v77, v40, v60, s70 bitop3:0x7e
    v_and_b32 v77, 1, v77
    v_cmp_ne_u32 vcc, 0, v77
    s_cbranch_vccz cs_goA
    s_nop 15
    s_nop 15
    s_nop 7
    v_bitop3_b32 v77, v40, v60, s70 bitop3:0x7e
    v_and_b32 v77, 1, v77
    v_cmp_ne_u32 vcc, 0, v77
    s_cbranch_vccz cs_goA
    s_nop 15
    s_nop 15
    s_nop 7
    v_bitop3_b32 v77, v40, v60, s70 bitop3:0x7e
    v_and_b32 v77, 1, v77
    v_cmp_ne_u32 vcc, 0, v77
    s_cbranch_vccz cs_goA
    s_nop 15
    s_nop 15
    s_nop 7
    buffer_load_dwordx4 v[40:43], v65, s[4:7], s14 offen offset:0 sc1
    buffer_load_dwordx4 v[60:63], v66, s[4:7], s14 offen offset:0 sc1
    v_bitop3_b32 v77, v40, v60, s70 bitop3:0x7e
    v_and_b32 v77, 1, v77
    v_cmp_ne_u32 vcc, 0, v77
    s_cbranch_vccz cs_goA
    s_nop 15
    s_nop 15
    s_nop 7
    v_bitop3_b32 v77, v40, v60, s70 bitop3:0x7e
    v_and_b32 v77, 1, v77
    v_cmp_ne_u32 vcc, 0, v77
    s_cbranch_vccz cs_goA
    s_nop 15
    s_nop 15
    s_nop 7
    v_bitop3_b32 v77, v40, v60, s70 bitop3:0x7e
    v_and_b32 v77, 1, v77
    v_cmp_ne_u32 vcc, 0, v77
    s_cbranch_vccz cs_goA
    s_nop 15
    s_nop 15
    s_nop 7
    v_bitop3_b32 v77, v40, v60, s70 bitop3:0x7e
    v_and_b32 v77, 1, v77
    v_cmp_ne_u32 vcc, 0, v77
    s_cbranch_vccz cs_goA
    s_nop 15
    s_nop 15
    s_nop 7
    buffer_load_dwordx4 v[40:43], v65, s[4:7], s14 offen offset:0 sc1
    buffer_load_dwordx4 v[60:63], v66, s[4:7], s14 offen offset:0 sc1
    v_bitop3_b32 v77, v40, v60, s70 bitop3:0x7e
    v_and_b32 v77, 1, v77
    v_cmp_ne_u32 vcc, 0, v77
    s_cbranch_vccz cs_goA
    s_nop 15
    s_nop 15
    s_nop 7
    v_bitop3_b32 v77, v40, v60, s70 bitop3:0x7e
    v_and_b32 v77, 1, v77
    v_cmp_ne_u32 vcc, 0, v77
    s_cbranch_vccz cs_goA
    s_nop 15
    s_nop 15
    s_nop 7
    v_bitop3_b32 v77, v40, v60, s70 bitop3:0x7e
    v_and_b32 v77, 1, v77
    v_cmp_ne_u32 vcc, 0, v77
    s_cbranch_vccz cs_goA
    s_nop 15
    s_nop 15
    s_nop 7
    v_bitop3_b32 v77, v40, v60, s70 bitop3:0x7e
    v_and_b32 v77, 1, v77
    v_cmp_ne_u32 vcc, 0, v77
    s_cbranch_vccz cs_goA
    s_nop 15
    s_nop 15
    s_nop 7
    s_sub_u32 s31, s31, 64
    s_cbranch_scc0 cs_cA
cs_goA:
    ds_write_b128 v65, v[40:43] offset:0
    v_smfmac_f32_16x16x64_bf16 v[0:3], v[40:43], v[44:51], v64
    v_smfmac_f32_16x16x64_bf16 v[4:7], v[40:43], v[52:59], v64
    buffer_load_dwordx4 v[44:47], v65, s[4:7], s15 offen offset:0 sc1
    v_smfmac_f32_16x16x64_bf16 v[0:3], v[60:63], v[24:31], v64
    s_add_u32 s40, s24, 1048576
    s_add_u32 s40, s40, s33
    s_sub_u32 s41, s96, s40
    v_smfmac_f32_16x16x64_bf16 v[4:7], v[60:63], v[32:39], v64
    ds_read_b128 v[24:27], v70 offset:8192
    s_cmp_lt_u32 s97, s93
    s_cselect_b32 s41, s41, 0
    v_smfmac_f32_16x16x64_bf16 v[8:11], v[40:43], a[96:103], v64
    ds_read_b128 v[28:31], v70 offset:9216
    v_smfmac_f32_16x16x64_bf16 v[12:15], v[40:43], a[104:111], v64
    ds_read_b128 v[32:35], v70 offset:10240
    s_waitcnt lgkmcnt(3)
    s_barrier
    ds_read_b128 v[48:51], v67 offset:0
    v_smfmac_f32_16x16x64_bf16 v[8:11], v[60:63], a[112:119], v64
    ds_read_b128 v[36:39], v70 offset:11264
    v_bitop3_b32 v79, v73, -9, s54 bitop3:0x6a
    v_smfmac_f32_16x16x64_bf16 v[12:15], v[60:63], a[120:127], v64
    buffer_load_dwordx4 v[44:47], v65, s[4:7], s15 offen offset:0 sc1
    v_smfmac_f32_16x16x64_bf16 v[16:19], v[40:43], a[232:239], v64
    ds_read_b128 v[52:55], v68 offset:0
    s_waitcnt lgkmcnt(4)
    v_bfe_u32 v77, v65, 2, 5
    v_smfmac_f32_16x16x64_bf16 v[20:23], v[40:43], v[24:31], v64
    ds_read_b128 v[24:27], v70 offset:12288
    s_waitcnt lgkmcnt(3)
    v_smfmac_f32_16x16x64_bf16 v[0:3], v[48:51], a[0:7], v64
    ds_read_b128 v[28:31], v70 offset:13312
    s_waitcnt lgkmcnt(3)
    v_add3_u32 v77, v77, s41, 16
    v_smfmac_f32_16x16x64_bf16 v[4:7], v[48:51], v[32:39], v64
    buffer_load_dwordx4 v[40:43], v65, s[4:7], s16 offen offset:0 sc1
    v_smfmac_f32_16x16x64_bf16 v[16:19], v[60:63], a[240:247], v64
    ds_read_b128 v[32:35], v70 offset:14336
    v_lshlrev_b32 v78, 3, v69
    v_smfmac_f32_16x16x64_bf16 v[20:23], v[60:63], a[248:255], v64
    ds_read_b128 v[36:39], v70 offset:15360
    v_smfmac_f32_16x16x64_bf16 v[8:11], v[48:51], a[128:135], v64
    s_waitcnt vmcnt(2)
    v_mov_b32_dpp v78, v77 quad_perm:[0,1,2,3] row_mask:0xc bank_mask:0xf
    v_smfmac_f32_16x16x64_bf16 v[12:15], v[48:51], a[136:143], v64
    buffer_load_dwordx4 v[58:61], v65, s[4:7], s24 offen offset:3072 sc1
    s_waitcnt lgkmcnt(2)
    v_and_b32 v77, s36, v44
    v_smfmac_f32_16x16x64_bf16 v[12:15], v[52:55], v[24:31], v64
    ds_write_b128 v65, v[44:47] offset:4096
    v_smfmac_f32_16x16x64_bf16 v[0:3], v[52:55], a[8:15], v64
    v_cmp_ne_u32 vcc, s70, v77
    v_smfmac_f32_16x16x64_bf16 v[8:11], v[52:55], a[144:151], v64
    s_waitcnt lgkmcnt(1)
    v_smfmac_f32_16x16x64_bf16 v[4:7], v[52:55], v[32:39], v64
    s_cbranch_vccnz cs_spinB
cs_backB:
    v_smfmac_f32_16x16x64_bf16 v[16:19], v[44:47], v[176:183], v64
    buffer_load_dwordx4 v[24:27], v65, s[4:7], s24 offen offset:0 sc1
    s_waitcnt lgkmcnt(0)
    s_barrier
    ds_read_b128 v[48:51], v66 offset:4096
    v_smfmac_f32_16x16x64_bf16 v[12:15], v[44:47], a[160:167], v64
    ds_read_b128 v[52:55], v67 offset:4096
    v_smfmac_f32_16x16x64_bf16 v[0:3], v[44:47], a[16:23], v64
    v_smfmac_f32_16x16x64_bf16 v[8:11], v[44:47], a[152:159], v64
    buffer_load_dwordx4 v[28:31], v65, s[4:7], s24 offen offset:1024 sc1
    v_smfmac_f32_16x16x64_bf16 v[4:7], v[44:47], a[24:31], v64
    s_waitcnt vmcnt(4)
    v_smfmac_f32_16x16x64_bf16 v[20:23], v[44:47], v[184:191], v64
    ds_read_b128 v[44:47], v68 offset:4096
    s_waitcnt lgkmcnt(2)
    v_smfmac_f32_16x16x64_bf16 v[0:3], v[48:51], a[32:39], v64
    v_smfmac_f32_16x16x64_bf16 v[8:11], v[48:51], a[168:175], v64
    buffer_load_dwordx4 v[34:37], v65, s[4:7], s24 offen offset:2048 sc1
    v_smfmac_f32_16x16x64_bf16 v[4:7], v[48:51], a[40:47], v64
    s_waitcnt vmcnt(4)
    v_and_b32 v77, s36, v40
    v_smfmac_f32_16x16x64_bf16 v[12:15], v[48:51], a[176:183], v64
    ds_read_b128 v[48:51], v69 offset:15360
    v_cmp_ne_u32 vcc, s70, v77
    v_smfmac_f32_16x16x64_bf16 v[0:3], v[52:55], a[48:55], v64
    s_waitcnt lgkmcnt(1)
    v_smfmac_f32_16x16x64_bf16 v[8:11], v[52:55], a[184:191], v64
    s_cbranch_vccnz cs_spin8
cs_back8:
    v_smfmac_f32_16x16x64_bf16 v[0:3], v[44:47], a[64:71], v64
    buffer_load_dword v76, v78, s[4:7], s40 offen sc1
    v_smfmac_f32_16x16x64_bf16 v[8:11], v[44:47], a[200:207], v64
    v_smfmac_f32_16x16x64_bf16 v[0:3], v[40:43], a[80:87], v64
    s_nop 1
    v_smfmac_f32_16x16x64_bf16 v[8:11], v[40:43], a[216:223], v64
    s_nop 1
    v_lshrrev_b32 v77, 1, v69
    v_smfmac_f32_16x16x64_bf16 v[4:7], v[52:55], a[56:63], v64
    s_nop 1
    v_cvt_pk_bf16_f32 v0, v0, v1
    v_smfmac_f32_16x16x64_bf16 v[12:15], v[52:55], a[192:199], v64
    s_nop 1
    v_cvt_pk_bf16_f32 v1, v2, v3
    v_smfmac_f32_16x16x64_bf16 v[4:7], v[44:47], a[72:79], v64
    s_nop 1
    v_cvt_pk_bf16_f32 v2, v8, v9
    v_smfmac_f32_16x16x64_bf16 v[12:15], v[44:47], a[208:215], v64
    s_nop 1
    v_cvt_pk_bf16_f32 v3, v10, v11
    v_smfmac_f32_16x16x64_bf16 v[4:7], v[40:43], a[88:95], v64
    s_waitcnt lgkmcnt(0)
    s_nop 1
    v_smfmac_f32_16x16x64_bf16 v[12:15], v[40:43], a[224:231], v64
    s_nop 1
    v_mfma_f32_16x16x32_bf16 v[8:11], v[0:3], v[48:51], 0
    s_nop 0
    v_cvt_pk_bf16_f32 v4, v4, v5
    v_cvt_pk_bf16_f32 v5, v6, v7
    s_nop 1
    v_cvt_pk_bf16_f32 v6, v12, v13
    v_cvt_pk_bf16_f32 v7, v14, v15
    s_nop 1
    v_mfma_f32_16x16x32_bf16 v[12:15], v[4:7], v[48:51], 0
    ds_read_b128 v[48:51], v66 offset:4096
    v_cvt_pk_bf16_f32 v0, v8, v9
    v_cvt_pk_bf16_f32 v1, v10, v11
    v_smfmac_f32_16x16x64_bf16 v[16:19], v[52:55], v[208:215], v64
    s_waitcnt vmcnt(2)
    s_nop 2
    v_cvt_pk_bf16_f32 v2, v12, v13
    v_cvt_pk_bf16_f32 v3, v14, v15
    s_nop 1
    v_mfma_f32_16x16x32_bf16 v[12:15], v[0:3], v[0:3], 0
    s_nop 1
    v_bitop3_b32 v78, v73, -9, s53 bitop3:0x6a
    v_mfma_f32_16x16x32_bf16 v[4:7], v[24:27], v[0:3], 0
    ds_read_b128 v[24:27], v67 offset:0
    s_nop 1
    v_mfma_f32_16x16x32_bf16 v[8:11], v[28:31], v[0:3], 0
    s_nop 0
    v_mov_b32_dpp v12, v14 row_ror:8 row_mask:0xf bank_mask:0xc
    v_mov_b32_dpp v13, v15 row_ror:8 row_mask:0xf bank_mask:0xc
    v_smfmac_f32_16x16x64_bf16 v[20:23], v[52:55], v[216:223], v64
    ds_write_b64 v71, v[12:13]
    ds_read_b128 v[52:55], v68 offset:0
    s_nop 1
    v_mov_b32_dpp v4, v8 row_ror:8 row_mask:0xf bank_mask:0xc
    v_mov_b32_dpp v5, v9 row_ror:8 row_mask:0xf bank_mask:0xc
    v_mov_b32_dpp v6, v10 row_ror:8 row_mask:0xf bank_mask:0xc
    v_mov_b32_dpp v7, v11 row_ror:8 row_mask:0xf bank_mask:0xc
    v_smfmac_f32_16x16x64_bf16 v[16:19], v[44:47], v[224:231], v64
    ds_write_b128 v65, v[4:7] offset:8192
    v_smfmac_f32_16x16x64_bf16 v[20:23], v[44:47], v[232:239], v64
    s_waitcnt lgkmcnt(3)
    v_smfmac_f32_16x16x64_bf16 v[16:19], v[24:27], v[144:151], v64
    s_waitcnt vmcnt(1)
    v_smfmac_f32_16x16x64_bf16 v[20:23], v[24:27], v[152:159], v64
    s_mov_b64 exec, s[38:39]
    buffer_store_dword v72, v75, s[4:7], s55 offen sc1
    s_mov_b64 exec, -1
    v_smfmac_f32_16x16x64_bf16 v[16:19], v[40:43], v[240:247], v64
    s_cmp_ge_u32 s30, 56
    s_waitcnt lgkmcnt(0)
    s_barrier
    ds_read_b128 v[8:11], v66 offset:8192
    v_smfmac_f32_16x16x64_bf16 v[20:23], v[40:43], v[248:255], v64
    ds_read_b128 v[12:15], v67 offset:8192
    v_smfmac_f32_16x16x64_bf16 v[16:19], v[48:51], v[192:199], v64
    ds_read_b128 v[44:47], v68 offset:8192
    v_smfmac_f32_16x16x64_bf16 v[20:23], v[48:51], v[200:207], v64
    ds_read_b64 v[24:25], v77 offset:14336
    ds_read_b64 v[26:27], v77 offset:14592
    v_smfmac_f32_16x16x64_bf16 v[16:19], v[52:55], v[160:167], v64
    ds_read_b64 v[28:29], v77 offset:14848
    ds_read_b64 v[30:31], v77 offset:15104
    v_bitop3_b32 v77, v73, -9, s52 bitop3:0x6a
    v_smfmac_f32_16x16x64_bf16 v[20:23], v[52:55], v[168:175], v64
    s_cbranch_scc1 cs_rare
cs_rare_x:
    ds_read_b128 v[48:51], v70 offset:22528
    ds_read_b128 v[52:55], v70 offset:23552
    s_waitcnt lgkmcnt(6)
    v_pk_add_f32 v[4:5], v[4:5], v[8:9]
    v_pk_add_f32 v[6:7], v[6:7], v[10:11]
    v_pk_add_f32 v[12:13], v[12:13], v[44:45]
    v_pk_add_f32 v[14:15], v[14:15], v[46:47]
    v_pk_add_f32 v[4:5], v[4:5], v[12:13]
    v_pk_add_f32 v[6:7], v[6:7], v[14:15]
    s_waitcnt lgkmcnt(2)
    v_pk_add_f32 v[24:25], v[24:25], v[26:27]
    v_pk_add_f32 v[28:29], v[28:29], v[30:31]
    v_max3_f32 v8, v4, v5, v6
    v_pk_add_f32 v[24:25], v[24:25], v[28:29]
    v_max_f32 v8, v8, v7
    v_max3_f32 v8, v8, v24, v25
    v_cvt_pk_bf16_f32 v32, v16, v17
    v_cvt_pk_bf16_f32 v38, v18, v19
    v_max_f32_dpp v8, v8, v8 row_ror:8 row_mask:0xf bank_mask:0xf
    v_mov_b32 v9, v8
    v_cvt_pk_bf16_f32 v56, v20, v21
    v_cvt_pk_bf16_f32 v62, v22, v23
    v_permlane32_swap_b32 v8, v9
    v_max_f32 v8, v8, v9
    v_mov_b32 v9, v8
    v_mov_b32 v11, 0
    v_mov_b32 v15, 0
    v_permlane16_swap_b32 v8, v9
    v_max_f32 v8, v8, v9
    v_mul_f32 v8, s66, v8
    v_pk_fma_f32 v[4:5], v[4:5], s[44:45], v[8:9] op_sel_hi:[1,1,0]
    v_pk_fma_f32 v[6:7], v[6:7], s[44:45], v[8:9] op_sel_hi:[1,1,0]
    v_pk_fma_f32 v[24:25], v[24:25], s[44:45], v[8:9] op_sel_hi:[1,1,0]
    v_exp_f32 v4, v4
    v_exp_f32 v5, v5
    v_exp_f32 v6, v6
    v_exp_f32 v7, v7
    v_exp_f32 v24, v24
    v_exp_f32 v25, v25
    v_cvt_pk_bf16_f32 v12, v4, v5
    v_cvt_pk_bf16_f32 v13, v6, v7
    v_cvt_pk_bf16_f32 v10, v24, v25
    v_cvt_pk_bf16_f32 v14, v24, v25
    v_mov_b64 v[0:1], s[48:49]
    v_mfma_f32_16x16x32_bf16 v[4:7], v[32:35], v[10:13], 0
    ds_read_b128 v[40:43], v70 offset:20480
    v_mov_b64 v[2:3], s[50:51]
    v_mfma_f32_16x16x32_bf16 v[24:27], v[36:39], v[12:15], 0
    ds_read_b128 v[44:47], v70 offset:21504
    v_mov_b64 v[8:9], 0
    v_mfma_f32_16x16x32_bf16 v[28:31], v[0:3], v[10:13], 0
    ds_read_b128 v[32:35], v70 offset:24576
    v_mov_b64 v[0:1], 0
    v_mfma_f32_16x16x32_bf16 v[16:19], v[56:59], v[10:13], 0
    ds_read_b128 v[36:39], v70 offset:25600
    v_mov_b64 v[2:3], 0
    v_mfma_f32_16x16x32_bf16 v[20:23], v[60:63], v[12:15], 0
    ds_read_b128 v[56:59], v70 offset:26624
    v_add_f32_dpp v4, v24, v4 row_ror:8 row_mask:0xf bank_mask:0xf
    v_add_f32_dpp v5, v25, v5 row_ror:8 row_mask:0xf bank_mask:0xf
    v_add_f32_dpp v6, v26, v6 row_ror:8 row_mask:0xf bank_mask:0xf
    v_add_f32_dpp v7, v27, v7 row_ror:8 row_mask:0xf bank_mask:0xf
    v_add_f32_dpp v29, v28, v28 row_ror:8 row_mask:0xf bank_mask:0xf
    v_rcp_f32 v28, v29
    v_mov_b64 v[10:11], 0
    v_add_f32_dpp v4, v16, v20 row_ror:8 row_mask:0xf bank_mask:0xc
    v_add_f32_dpp v5, v17, v21 row_ror:8 row_mask:0xf bank_mask:0xc
    v_add_f32_dpp v6, v18, v22 row_ror:8 row_mask:0xf bank_mask:0xc
    v_add_f32_dpp v7, v19, v23 row_ror:8 row_mask:0xf bank_mask:0xc
    v_pk_mul_f32 v[4:5], v[4:5], v[28:29] op_sel_hi:[1,0]
    v_pk_mul_f32 v[6:7], v[6:7], v[28:29] op_sel_hi:[1,0]
    v_cvt_pk_bf16_f32 v4, v4, v5
    v_cvt_pk_bf16_f32 v5, v6, v7
    ds_write_b64 v73, v[4:5] offset:12288
    v_mov_b32_dpp v6, v4 row_ror:8 row_mask:0xf bank_mask:0xf
    v_mov_b32_dpp v7, v5 row_ror:8 row_mask:0xf bank_mask:0xf
    v_mov_b64 v[12:13], 0
    v_mov_b64 v[14:15], 0
    v_smfmac_f32_16x16x64_bf16 v[8:11], v[4:7], v[80:87], v64
    s_waitcnt lgkmcnt(4)
    v_mov_b64 v[24:25], 0
    v_smfmac_f32_16x16x64_bf16 v[0:3], v[4:7], v[40:47], v64
    ds_read_b128 v[60:63], v70 offset:27648
    v_mov_b64 v[26:27], 0
    v_smfmac_f32_16x16x64_bf16 v[12:15], v[4:7], v[112:119], v64
    s_waitcnt lgkmcnt(1)
    s_barrier
    ds_read_b128 v[16:19], v77 offset:12288
    v_smfmac_f32_16x16x64_bf16 v[24:27], v[4:7], v[48:55], v64
    ds_read_b128 v[20:23], v78 offset:12288
    ds_read_b128 v[28:31], v79 offset:12288
    v_mov_b64 v[4:5], 0
    v_mov_b64 v[6:7], 0
    v_bfe_u32 v77, v74, 16, 1
    v_mad_i32_i24 v77, v77, s56, v74
    s_waitcnt lgkmcnt(2)
    v_smfmac_f32_16x16x64_bf16 v[8:11], v[16:19], v[88:95], v64
    ds_read_b128 v[48:51], v70 offset:28672
    v_and_b32 v72, 8, v73
    v_smfmac_f32_16x16x64_bf16 v[12:15], v[16:19], v[120:127], v64
    ds_read_b128 v[52:55], v70 offset:29696
    s_waitcnt lgkmcnt(3)
    v_mad_u32_u24 v72, v72, 63, v73
    v_smfmac_f32_16x16x64_bf16 v[8:11], v[20:23], v[96:103], v64
    ds_read_b128 v[40:43], v70 offset:30720
    v_subrev_u32 v72, s47, v72
    v_smfmac_f32_16x16x64_bf16 v[12:15], v[20:23], v[128:135], v64
    ds_read_b128 v[44:47], v70 offset:31744
    s_waitcnt lgkmcnt(4)
    v_smfmac_f32_16x16x64_bf16 v[8:11], v[28:31], v[104:111], v64
    s_add_u32 s30, s30, 1
    s_xor_b32 s70, s70, 1
    s_cmp_lg_u32 s71, 0
    v_smfmac_f32_16x16x64_bf16 v[12:15], v[28:31], v[136:143], v64
    s_nop 2
    v_smfmac_f32_16x16x64_bf16 v[0:3], v[16:19], v[32:39], v64
    ds_read_b128 v[32:35], v70 offset:32768
    ds_read_b128 v[36:39], v70 offset:33792
    v_cvt_pk_bf16_f32 v8, v8, v9
    v_cvt_pk_bf16_f32 v9, v10, v11
    v_and_or_b32 v8, v8, -2, s69
    v_cvt_pk_bf16_f32 v10, v12, v13
    v_cvt_pk_bf16_f32 v11, v14, v15
    v_smfmac_f32_16x16x64_bf16 v[24:27], v[16:19], v[56:63], v64
    buffer_store_dwordx4 v[8:11], v74, s[4:7], s22 offen sc1
    ds_read_b128 v[56:59], v70 offset:34816
    s_waitcnt lgkmcnt(3)
    v_smfmac_f32_16x16x64_bf16 v[24:27], v[20:23], v[40:47], v64
    ds_read_b128 v[60:63], v70 offset:35840
    ds_read_b128 v[40:43], v70 offset:16384
    v_smfmac_f32_16x16x64_bf16 v[0:3], v[20:23], v[48:55], v64
    ds_read_b128 v[44:47], v70 offset:17408
    s_waitcnt lgkmcnt(4)
    v_smfmac_f32_16x16x64_bf16 v[0:3], v[28:31], v[32:39], v64
    ds_read_b128 v[48:51], v72 offset:12288
    s_waitcnt lgkmcnt(3)
    s_nop 0
    v_smfmac_f32_16x16x64_bf16 v[24:27], v[28:31], v[56:63], v64
    ds_read_b128 v[32:35], v70 offset:18432
    ds_read_b128 v[36:39], v70 offset:19456
    ds_read_b128 v[52:55], v72 offset:13312
    s_nop 0
    v_cvt_pk_bf16_f32 v0, v0, v1
    v_cvt_pk_bf16_f32 v1, v2, v3
    v_and_or_b32 v0, v0, -2, s69
    s_nop 0
    v_cvt_pk_bf16_f32 v2, v24, v25
    v_cvt_pk_bf16_f32 v3, v26, v27
    s_waitcnt lgkmcnt(3)
    v_smfmac_f32_16x16x64_bf16 v[4:7], v[48:51], v[40:47], v64
    buffer_store_dwordx4 v[0:3], v74, s[4:7], s23 offen sc1
    s_waitcnt lgkmcnt(0)
    v_smfmac_f32_16x16x64_bf16 v[4:7], v[52:55], v[32:39], v64
    s_nop 7
    v_cvt_pk_bf16_f32 v4, v4, v5
    v_cvt_pk_bf16_f32 v5, v6, v7
    v_and_or_b32 v4, v4, -2, s69
    buffer_store_dwordx2 v[4:5], v77, s[4:7], s25 offen sc1
    s_cbranch_scc1 cs_e1
    s_cmp_lg_u32 s37, 0
    s_cbranch_scc1 cs_f0_xt
cs_f0_xtx:
    s_nop 2
    v_mov_b32 v79, v79
    s_nop 2
    v_mov_b32 v79, v79
    s_nop 2
    v_mov_b32 v79, v79
    s_nop 2
    v_mov_b32 v79, v79
    s_nop 2
    v_mov_b32 v79, v79
    s_nop 2
    v_mov_b32 v79, v79
    s_nop 2
    v_mov_b32 v79, v79
    s_nop 2
    v_mov_b32 v79, v79
    s_nop 2
    v_mov_b32 v79, v79
    s_nop 2
    v_mov_b32 v79, v79
    s_nop 2
    v_mov_b32 v79, v79
    s_nop 2
    v_mov_b32 v79, v79
    s_nop 2
    v_mov_b32 v79, v79
    s_nop 2
    v_mov_b32 v79, v79
    s_nop 2
    v_mov_b32 v79, v79
    s_nop 2
    v_mov_b32 v79, v79
    s_nop 2
    v_mov_b32 v79, v79
    s_nop 2
    v_mov_b32 v79, v79
    s_nop 2
    v_mov_b32 v79, v79
    s_nop 2
    v_mov_b32 v79, v79
    s_nop 2
    v_mov_b32 v79, v79
    s_nop 2
    v_mov_b32 v79, v79
    s_nop 2
    v_mov_b32 v79, v79
    s_nop 2
    v_mov_b32 v79, v79
    s_nop 2
    v_mov_b32 v79, v79
    s_nop 2
    v_mov_b32 v79, v79
    s_nop 2
    v_mov_b32 v79, v79
    s_nop 2
    v_mov_b32 v79, v79
    s_nop 2
    v_mov_b32 v79, v79
    s_nop 2
    v_mov_b32 v79, v79
    s_nop 2
    v_mov_b32 v79, v79
    s_nop 2
    v_mov_b32 v79, v79
    s_nop 2
    v_mov_b32 v79, v79
    s_nop 2
    v_mov_b32 v79, v79
    s_nop 2
    v_mov_b32 v79, v79
    s_nop 2
    v_mov_b32 v79, v79
    s_nop 0
    v_mov_b32 v79, v79
    buffer_load_dwordx4 v[8:11], v65, s[4:7], s18 offen sc1
    buffer_load_dwordx4 v[12:15], v65, s[4:7], s19 offen sc1
    buffer_load_dwordx4 v[16:19], v65, s[4:7], s20 offen sc1
    buffer_load_dwordx4 v[20:23], v65, s[4:7], s21 offen sc1
    v_and_b32 v77, 255, v69
    ds_read_b128 v[4:7], v77 offset:15872
    ds_read_b128 v[44:47], v70 offset:0
    ds_read_b128 v[48:51], v70 offset:1024
    ds_read_b128 v[52:55], v70 offset:2048
    ds_read_b128 v[56:59], v70 offset:3072
    ds_read_b128 v[24:27], v70 offset:4096
    ds_read_b128 v[28:31], v70 offset:5120
    ds_read_b128 v[32:35], v70 offset:6144
    ds_read_b128 v[36:39], v70 offset:7168
    s_mov_b32 s31, 65536
    s_add_u32 s24, s24, 524288
    s_add_u32 s26, s26, 524288
    s_add_u32 s55, s55, s57
    s_mov_b32 s14, 67633152
    s_mov_b32 s15, 67637248
    s_mov_b32 s16, 67641344
    s_mov_b32 s36, 1
    v_mov_b32 v40, s69
    v_mov_b32 v60, s69
    v_and_b32 v79, 12, v75
    v_cmp_eq_u32 vcc, 0, v79
    s_nop 1
    v_cndmask_b32 v79, 0, 1, vcc
    s_waitcnt lgkmcnt(0)
    s_waitcnt vmcnt(3)
    v_xor_b32 v77, s69, v8
    v_mfma_f32_16x16x32_bf16 v[0:3], v[4:7], v[8:11], 0
    v_mov_b64 v[8:9], 0
    v_mov_b64 v[10:11], 0
    s_waitcnt vmcnt(2)
    v_bitop3_b32 v77, v77, v12, s69 bitop3:0xf6
    v_mfma_f32_16x16x32_bf16 v[0:3], v[4:7], v[12:15], v[0:3]
    v_mov_b64 v[12:13], 0
    v_mov_b64 v[14:15], 0
    s_waitcnt vmcnt(1)
    v_bitop3_b32 v77, v77, v16, s69 bitop3:0xf6
    v_mfma_f32_16x16x32_bf16 v[0:3], v[4:7], v[16:19], v[0:3]
    v_mov_b64 v[16:17], 0
    v_mov_b64 v[18:19], 0
    s_waitcnt vmcnt(0)
    v_bitop3_b32 v77, v77, v20, s69 bitop3:0xf6
    v_mfma_f32_16x16x32_bf16 v[0:3], v[4:7], v[20:23], v[0:3]
    v_and_b32 v77, 1, v77
    v_cmp_ne_u32 vcc, 0, v77
    v_mov_b64 v[20:21], 0
    v_mov_b64 v[22:23], 0
    s_cmp_eq_u64 vcc, 0
    s_cselect_b64 s[42:43], -1, 0
    s_nop 1
    v_add_f32_dpp v0, v0, v0 row_ror:8 row_mask:0xf bank_mask:0xf
    v_add_f32_dpp v1, v1, v1 row_ror:8 row_mask:0xf bank_mask:0xf
    s_mov_b64 exec, s[42:43]
    v_cvt_pk_bf16_f32 v72, v0, v1
    v_bfi_b32 v72, v79, s70, v72
    buffer_store_dword v72, v75, s[4:7], s17 offen offset:0 sc1
    s_mov_b64 exec, -1
    s_cbranch_scc0 cs_f0_retry
cs_f0_go:
    v_mov_b64 v[0:1], 0
    v_mov_b64 v[2:3], 0
    v_mov_b64 v[4:5], 0
    v_mov_b64 v[6:7], 0
    s_nop 2
    v_mov_b32 v79, v79
    s_nop 2
    v_mov_b32 v79, v79
    s_nop 2
    v_mov_b32 v79, v79
    s_nop 2
    v_mov_b32 v79, v79
    s_nop 2
    v_mov_b32 v79, v79
    s_nop 2
    v_mov_b32 v79, v79
    s_nop 2
    v_mov_b32 v79, v79
    s_nop 2
    v_mov_b32 v79, v79
    s_nop 2
    v_mov_b32 v79, v79
    s_nop 2
    v_mov_b32 v79, v79
    s_nop 2
    v_mov_b32 v79, v79
    s_nop 2
    v_mov_b32 v79, v79
    s_nop 2
    v_mov_b32 v79, v79
    s_nop 2
    v_mov_b32 v79, v79
    s_nop 2
    v_mov_b32 v79, v79
    s_nop 2
    v_mov_b32 v79, v79
    s_nop 2
    v_mov_b32 v79, v79
    s_nop 2
    v_mov_b32 v79, v79
    s_nop 2
    v_mov_b32 v79, v79
    s_nop 2
    v_mov_b32 v79, v79
    s_nop 2
    v_mov_b32 v79, v79
    s_nop 2
    v_mov_b32 v79, v79
    s_nop 2
    v_mov_b32 v79, v79
    s_nop 2
    v_mov_b32 v79, v79
    s_nop 2
    v_mov_b32 v79, v79
    s_branch cs_loop
cs_e1:
    s_cmp_lg_u32 s71, 2
    s_cbranch_scc1 cs_f1
    v_and_b32 v77, 255, v69
    ds_read_b128 v[4:7], v77 offset:15872
    ds_read_b128 v[44:47], v70 offset:0
    ds_read_b128 v[48:51], v70 offset:1024
    ds_read_b128 v[52:55], v70 offset:2048
    ds_read_b128 v[56:59], v70 offset:3072
    ds_read_b128 v[24:27], v70 offset:4096
    ds_read_b128 v[28:31], v70 offset:5120
    ds_read_b128 v[32:35], v70 offset:6144
    ds_read_b128 v[36:39], v70 offset:7168
    s_mov_b32 s31, 65536
    s_add_u32 s24, s24, 524288
    s_add_u32 s26, s26, 524288
    s_add_u32 s55, s55, s57
    s_mov_b32 s14, 67633152
    s_mov_b32 s15, 67637248
    s_mov_b32 s16, 67641344
    s_mov_b32 s36, 1
    v_mov_b32 v40, s69
    v_mov_b32 v60, s69
    v_and_b32 v79, 12, v75
    v_cmp_eq_u32 vcc, 0, v79
    s_nop 1
    v_cndmask_b32 v79, 0, 1, vcc
    s_cmp_lg_u32 s37, 0
    s_cbranch_scc1 cs_f2_xt
cs_f2_xtx:
    s_nop 2
    v_mov_b32 v79, v79
    s_nop 2
    v_mov_b32 v79, v79
    s_nop 2
    v_mov_b32 v79, v79
    s_nop 2
    v_mov_b32 v79, v79
    s_nop 2
    v_mov_b32 v79, v79
    s_nop 2
    v_mov_b32 v79, v79
    s_nop 2
    v_mov_b32 v79, v79
    s_nop 2
    v_mov_b32 v79, v79
    s_nop 2
    v_mov_b32 v79, v79
    s_nop 2
    v_mov_b32 v79, v79
    s_nop 2
    v_mov_b32 v79, v79
    s_nop 2
    v_mov_b32 v79, v79
    s_nop 2
    v_mov_b32 v79, v79
    s_nop 2
    v_mov_b32 v79, v79
    s_nop 2
    v_mov_b32 v79, v79
    s_nop 2
    v_mov_b32 v79, v79
    s_nop 2
    v_mov_b32 v79, v79
    s_nop 2
    v_mov_b32 v79, v79
    s_nop 2
    v_mov_b32 v79, v79
    s_nop 2
    v_mov_b32 v79, v79
    s_nop 2
    v_mov_b32 v79, v79
    s_nop 2
    v_mov_b32 v79, v79
    s_nop 2
    v_mov_b32 v79, v79
    s_nop 2
    v_mov_b32 v79, v79
    s_nop 2
    v_mov_b32 v79, v79
    s_nop 2
    v_mov_b32 v79, v79
    s_nop 2
    v_mov_b32 v79, v79
    s_nop 2
    v_mov_b32 v79, v79
    s_nop 2
    v_mov_b32 v79, v79
    s_nop 2
    v_mov_b32 v79, v79
    s_nop 2
    v_mov_b32 v79, v79
    s_nop 2
    v_mov_b32 v79, v79
    s_nop 2
    v_mov_b32 v79, v79
    s_nop 2
    v_mov_b32 v79, v79
    s_nop 2
    v_mov_b32 v79, v79
    s_nop 2
    v_mov_b32 v79, v79
    s_nop 0
    v_mov_b32 v79, v79
    s_waitcnt vmcnt(0)
    buffer_load_dwordx4 v[8:11], v65, s[4:7], s18 offen sc1
    buffer_load_dwordx4 v[12:15], v65, s[4:7], s19 offen sc1
    buffer_load_dwordx4 v[16:19], v65, s[4:7], s20 offen sc1
    buffer_load_dwordx4 v[20:23], v65, s[4:7], s21 offen sc1
    s_nop 2
    v_mov_b32 v79, v79
    s_nop 2
    v_mov_b32 v79, v79
    s_nop 2
    v_mov_b32 v79, v79
    s_nop 2
    v_mov_b32 v79, v79
    s_nop 2
    v_mov_b32 v79, v79
    s_nop 2
    v_mov_b32 v79, v79
    s_nop 2
    v_mov_b32 v79, v79
    s_nop 2
    v_mov_b32 v79, v79
    s_nop 2
    v_mov_b32 v79, v79
    s_nop 2
    v_mov_b32 v79, v79
    buffer_load_dwordx4 v[40:43], v65, s[4:7], s14 offen offset:0 sc1
    buffer_load_dwordx4 v[60:63], v66, s[4:7], s14 offen offset:0 sc1
    s_waitcnt lgkmcnt(0)
    s_waitcnt vmcnt(5)
    v_xor_b32 v77, s69, v8
    v_bitop3_b32 v77, v77, v10, s69 bitop3:0xf6
    v_mfma_f32_16x16x32_bf16 v[0:3], v[4:7], v[8:11], 0
    v_mov_b64 v[8:9], 0
    v_mov_b64 v[10:11], 0
    s_waitcnt vmcnt(4)
    v_bitop3_b32 v77, v77, v12, s69 bitop3:0xf6
    v_bitop3_b32 v77, v77, v14, s69 bitop3:0xf6
    v_mfma_f32_16x16x32_bf16 v[0:3], v[4:7], v[12:15], v[0:3]
    v_mov_b64 v[12:13], 0
    v_mov_b64 v[14:15], 0
    s_waitcnt vmcnt(3)
    v_bitop3_b32 v77, v77, v16, s69 bitop3:0xf6
    v_bitop3_b32 v77, v77, v18, s69 bitop3:0xf6
    v_mfma_f32_16x16x32_bf16 v[0:3], v[4:7], v[16:19], v[0:3]
    v_mov_b64 v[16:17], 0
    v_mov_b64 v[18:19], 0
    s_waitcnt vmcnt(2)
    v_bitop3_b32 v77, v77, v20, s69 bitop3:0xf6
    v_bitop3_b32 v77, v77, v22, s69 bitop3:0xf6
    v_mfma_f32_16x16x32_bf16 v[0:3], v[4:7], v[20:23], v[0:3]
    v_and_b32 v77, 1, v77
    v_cmp_ne_u32 vcc, 0, v77
    v_mov_b64 v[20:21], 0
    v_mov_b64 v[22:23], 0
    buffer_load_dwordx4 v[40:43], v65, s[4:7], s14 offen offset:0 sc1
    buffer_load_dwordx4 v[60:63], v66, s[4:7], s14 offen offset:0 sc1
    s_cmp_eq_u64 vcc, 0
    s_cselect_b64 s[42:43], -1, 0
    v_add_f32 v2, v0, v1
    s_nop 1
    v_add_f32_dpp v2, v2, v2 row_ror:8 row_mask:0xf bank_mask:0xf
    s_nop 1
    v_mov_b32_dpp v0, v2 quad_perm:[0,0,2,2] row_mask:0xf bank_mask:0xf
    v_mov_b32_dpp v1, v2 quad_perm:[1,1,3,3] row_mask:0xf bank_mask:0xf
    s_mov_b64 exec, s[42:43]
    v_cvt_pk_bf16_f32 v72, v0, v1
    v_bfi_b32 v72, v79, s70, v72
    buffer_store_dword v72, v75, s[4:7], s17 offen offset:0 sc1
    buffer_store_dword v72, v75, s[4:7], s17 offen offset:1024 sc1
    buffer_store_dword v72, v75, s[4:7], s17 offen offset:2048 sc1
    buffer_store_dword v72, v75, s[4:7], s17 offen offset:3072 sc1
    s_mov_b64 exec, -1
    s_cbranch_scc0 cs_f2_retry
cs_f2_go:
    v_mov_b64 v[0:1], 0
    v_mov_b64 v[2:3], 0
    v_mov_b64 v[4:5], 0
    v_mov_b64 v[6:7], 0
    s_nop 2
    v_mov_b32 v79, v79
    s_nop 2
    v_mov_b32 v79, v79
    s_nop 2
    v_mov_b32 v79, v79
    s_nop 2
    v_mov_b32 v79, v79
    s_nop 2
    v_mov_b32 v79, v79
    s_nop 2
    v_mov_b32 v79, v79
    s_nop 2
    v_mov_b32 v79, v79
    s_nop 2
    v_mov_b32 v79, v79
    s_nop 2
    v_mov_b32 v79, v79
    s_nop 2
    v_mov_b32 v79, v79
    s_nop 2
    v_mov_b32 v79, v79
    s_nop 2
    v_mov_b32 v79, v79
    s_nop 2
    v_mov_b32 v79, v79
    s_nop 2
    v_mov_b32 v79, v79
    s_nop 2
    v_mov_b32 v79, v79
    s_nop 2
    v_mov_b32 v79, v79
    s_nop 2
    v_mov_b32 v79, v79
    s_nop 2
    v_mov_b32 v79, v79
    s_nop 2
    v_mov_b32 v79, v79
    s_nop 2
    v_mov_b32 v79, v79
    s_nop 2
    v_mov_b32 v79, v79
    s_nop 2
    v_mov_b32 v79, v79
    s_nop 2
    v_mov_b32 v79, v79
    s_nop 2
    v_mov_b32 v79, v79
    s_nop 2
    v_mov_b32 v79, v79
    s_branch cs_loop
cs_f1:
    s_cmp_lg_u32 s32, 1
    s_cbranch_scc1 cs_f3
    v_and_b32 v77, 255, v69
    ds_read_b128 v[4:7], v77 offset:15872
    ds_read_b128 v[44:47], v70 offset:0
    ds_read_b128 v[48:51], v70 offset:1024
    ds_read_b128 v[52:55], v70 offset:2048
    ds_read_b128 v[56:59], v70 offset:3072
    ds_read_b128 v[24:27], v70 offset:4096
    ds_read_b128 v[28:31], v70 offset:5120
    ds_read_b128 v[32:35], v70 offset:6144
    ds_read_b128 v[36:39], v70 offset:7168
    s_mov_b32 s31, 65536
    s_add_u32 s24, s24, 524288
    s_add_u32 s26, s26, 524288
    s_add_u32 s55, s55, s57
    s_mov_b32 s14, 67633152
    s_mov_b32 s15, 67637248
    s_mov_b32 s16, 67641344
    s_mov_b32 s36, 1
    v_mov_b32 v40, s69
    v_mov_b32 v60, s69
    v_and_b32 v79, 12, v75
    v_cmp_eq_u32 vcc, 0, v79
    s_nop 1
    v_cndmask_b32 v79, 0, 1, vcc
    s_cmp_lg_u32 s37, 0
    s_cbranch_scc1 cs_f1_xt
cs_f1_xtx:
    s_nop 2
    v_mov_b32 v79, v79
    s_nop 2
    v_mov_b32 v79, v79
    s_nop 2
    v_mov_b32 v79, v79
    s_nop 2
    v_mov_b32 v79, v79
    s_nop 2
    v_mov_b32 v79, v79
    s_nop 2
    v_mov_b32 v79, v79
    s_nop 2
    v_mov_b32 v79, v79
    s_nop 2
    v_mov_b32 v79, v79
    s_nop 2
    v_mov_b32 v79, v79
    s_nop 2
    v_mov_b32 v79, v79
    s_nop 2
    v_mov_b32 v79, v79
    s_nop 2
    v_mov_b32 v79, v79
    s_nop 2
    v_mov_b32 v79, v79
    s_nop 2
    v_mov_b32 v79, v79
    s_nop 2
    v_mov_b32 v79, v79
    s_nop 2
    v_mov_b32 v79, v79
    s_nop 2
    v_mov_b32 v79, v79
    s_nop 2
    v_mov_b32 v79, v79
    s_nop 2
    v_mov_b32 v79, v79
    s_nop 2
    v_mov_b32 v79, v79
    s_nop 2
    v_mov_b32 v79, v79
    s_nop 2
    v_mov_b32 v79, v79
    s_nop 2
    v_mov_b32 v79, v79
    s_nop 2
    v_mov_b32 v79, v79
    s_nop 2
    v_mov_b32 v79, v79
    s_nop 2
    v_mov_b32 v79, v79
    s_nop 2
    v_mov_b32 v79, v79
    s_nop 2
    v_mov_b32 v79, v79
    s_nop 2
    v_mov_b32 v79, v79
    s_nop 2
    v_mov_b32 v79, v79
    s_nop 2
    v_mov_b32 v79, v79
    s_nop 2
    v_mov_b32 v79, v79
    s_nop 2
    v_mov_b32 v79, v79
    s_nop 2
    v_mov_b32 v79, v79
    s_nop 2
    v_mov_b32 v79, v79
    s_nop 2
    v_mov_b32 v79, v79
    s_nop 0
    v_mov_b32 v79, v79
    s_waitcnt vmcnt(0)
    buffer_load_dwordx4 v[8:11], v65, s[4:7], s18 offen sc1
    buffer_load_dwordx4 v[12:15], v65, s[4:7], s19 offen sc1
    buffer_load_dwordx4 v[16:19], v65, s[4:7], s20 offen sc1
    buffer_load_dwordx4 v[20:23], v65, s[4:7], s21 offen sc1
    s_nop 2
    v_mov_b32 v79, v79
    s_nop 2
    v_mov_b32 v79, v79
    s_nop 2
    v_mov_b32 v79, v79
    s_nop 2
    v_mov_b32 v79, v79
    s_nop 2
    v_mov_b32 v79, v79
    s_nop 2
    v_mov_b32 v79, v79
    s_nop 2
    v_mov_b32 v79, v79
    s_nop 2
    v_mov_b32 v79, v79
    s_nop 2
    v_mov_b32 v79, v79
    s_nop 2
    v_mov_b32 v79, v79
    buffer_load_dwordx4 v[40:43], v65, s[4:7], s14 offen offset:0 sc1
    buffer_load_dwordx4 v[60:63], v66, s[4:7], s14 offen offset:0 sc1
    s_waitcnt lgkmcnt(0)
    s_waitcnt vmcnt(5)
    v_xor_b32 v77, s69, v8
    v_mfma_f32_16x16x32_bf16 v[0:3], v[4:7], v[8:11], 0
    v_mov_b64 v[8:9], 0
    v_mov_b64 v[10:11], 0
    s_waitcnt vmcnt(4)
    v_bitop3_b32 v77, v77, v12, s69 bitop3:0xf6
    v_mfma_f32_16x16x32_bf16 v[0:3], v[4:7], v[12:15], v[0:3]
    v_mov_b64 v[12:13], 0
    v_mov_b64 v[14:15], 0
    s_waitcnt vmcnt(3)
    v_bitop3_b32 v77, v77, v16, s69 bitop3:0xf6
    v_mfma_f32_16x16x32_bf16 v[0:3], v[4:7], v[16:19], v[0:3]
    v_mov_b64 v[16:17], 0
    v_mov_b64 v[18:19], 0
    s_waitcnt vmcnt(2)
    v_bitop3_b32 v77, v77, v20, s69 bitop3:0xf6
    v_mfma_f32_16x16x32_bf16 v[0:3], v[4:7], v[20:23], v[0:3]
    v_and_b32 v77, 1, v77
    v_cmp_ne_u32 vcc, 0, v77
    v_mov_b64 v[20:21], 0
    v_mov_b64 v[22:23], 0
    buffer_load_dwordx4 v[40:43], v65, s[4:7], s14 offen offset:0 sc1
    buffer_load_dwordx4 v[60:63], v66, s[4:7], s14 offen offset:0 sc1
    s_cmp_eq_u64 vcc, 0
    s_cselect_b64 s[42:43], -1, 0
    v_add_f32_dpp v0, v0, v0 row_ror:8 row_mask:0xf bank_mask:0xf
    v_add_f32_dpp v1, v1, v1 row_ror:8 row_mask:0xf bank_mask:0xf
    s_mov_b64 exec, s[42:43]
    v_cvt_pk_bf16_f32 v72, v0, v1
    v_bfi_b32 v72, v79, s70, v72
    buffer_store_dword v72, v75, s[4:7], s17 offen offset:0 sc1
    s_mov_b64 exec, -1
    s_cbranch_scc0 cs_f1_retry
cs_f1_go:
    v_mov_b64 v[0:1], 0
    v_mov_b64 v[2:3], 0
    v_mov_b64 v[4:5], 0
    v_mov_b64 v[6:7], 0
    s_nop 2
    v_mov_b32 v79, v79
    s_nop 2
    v_mov_b32 v79, v79
    s_nop 2
    v_mov_b32 v79, v79
    s_nop 2
    v_mov_b32 v79, v79
    s_nop 2
    v_mov_b32 v79, v79
    s_nop 2
    v_mov_b32 v79, v79
    s_nop 2
    v_mov_b32 v79, v79
    s_nop 2
    v_mov_b32 v79, v79
    s_nop 2
    v_mov_b32 v79, v79
    s_nop 2
    v_mov_b32 v79, v79
    s_nop 2
    v_mov_b32 v79, v79
    s_nop 2
    v_mov_b32 v79, v79
    s_nop 2
    v_mov_b32 v79, v79
    s_nop 2
    v_mov_b32 v79, v79
    s_nop 2
    v_mov_b32 v79, v79
    s_nop 2
    v_mov_b32 v79, v79
    s_nop 2
    v_mov_b32 v79, v79
    s_nop 2
    v_mov_b32 v79, v79
    s_nop 2
    v_mov_b32 v79, v79
    s_nop 2
    v_mov_b32 v79, v79
    s_nop 2
    v_mov_b32 v79, v79
    s_nop 2
    v_mov_b32 v79, v79
    s_nop 2
    v_mov_b32 v79, v79
    s_nop 2
    v_mov_b32 v79, v79
    s_nop 2
    v_mov_b32 v79, v79
    s_branch cs_loop
cs_f3:
    v_and_b32 v77, 255, v69
    ds_read_b128 v[4:7], v77 offset:15872
    ds_read_b128 v[44:47], v70 offset:0
    ds_read_b128 v[48:51], v70 offset:1024
    ds_read_b128 v[52:55], v70 offset:2048
    ds_read_b128 v[56:59], v70 offset:3072
    ds_read_b128 v[24:27], v70 offset:4096
    ds_read_b128 v[28:31], v70 offset:5120
    ds_read_b128 v[32:35], v70 offset:6144
    ds_read_b128 v[36:39], v70 offset:7168
    s_mov_b32 s31, 65536
    s_add_u32 s24, s24, 524288
    s_add_u32 s26, s26, 524288
    s_add_u32 s55, s55, s57
    s_mov_b32 s14, 67633152
    s_mov_b32 s15, 67637248
    s_mov_b32 s16, 67641344
    s_mov_b32 s36, 1
    v_mov_b32 v40, s69
    v_mov_b32 v60, s69
    v_and_b32 v79, 12, v75
    v_cmp_eq_u32 vcc, 0, v79
    s_nop 1
    v_cndmask_b32 v79, 0, 1, vcc
    s_add_u32 s40, s30, s95
    v_mov_b32 v72, s40
    s_waitcnt lgkmcnt(0)
    v_mov_b64 v[0:1], 0
    v_mov_b64 v[2:3], 0
    v_mov_b64 v[4:5], 0
    v_mov_b64 v[6:7], 0
    v_mov_b64 v[8:9], 0
    v_mov_b64 v[10:11], 0
    v_mov_b64 v[12:13], 0
    v_mov_b64 v[14:15], 0
    v_mov_b64 v[16:17], 0
    v_mov_b64 v[18:19], 0
    v_mov_b64 v[20:21], 0
    v_mov_b64 v[22:23], 0
    s_nop 2
    v_mov_b32 v79, v79
    s_nop 2
    v_mov_b32 v79, v79
    s_nop 2
    v_mov_b32 v79, v79
    s_nop 2
    v_mov_b32 v79, v79
    s_nop 2
    v_mov_b32 v79, v79
    s_nop 2
    v_mov_b32 v79, v79
    s_nop 2
    v_mov_b32 v79, v79
    s_nop 2
    v_mov_b32 v79, v79
    s_nop 2
    v_mov_b32 v79, v79
    s_nop 2
    v_mov_b32 v79, v79
    s_nop 2
    v_mov_b32 v79, v79
    s_nop 2
    v_mov_b32 v79, v79
    s_nop 2
    v_mov_b32 v79, v79
    s_nop 2
    v_mov_b32 v79, v79
    s_nop 2
    v_mov_b32 v79, v79
    s_nop 2
    v_mov_b32 v79, v79
    s_nop 2
    v_mov_b32 v79, v79
    s_nop 2
    v_mov_b32 v79, v79
    s_nop 2
    v_mov_b32 v79, v79
    s_nop 2
    v_mov_b32 v79, v79
    s_nop 2
    v_mov_b32 v79, v79
    s_nop 2
    v_mov_b32 v79, v79
    s_nop 2
    v_mov_b32 v79, v79
    s_nop 2
    v_mov_b32 v79, v79
    s_nop 2
    v_mov_b32 v79, v79
    s_nop 2
    v_mov_b32 v79, v79
    s_nop 2
    v_mov_b32 v79, v79
    s_nop 2
    v_mov_b32 v79, v79
    s_nop 2
    v_mov_b32 v79, v79
    s_nop 2
    v_mov_b32 v79, v79
    s_nop 2
    v_mov_b32 v79, v79
    s_nop 2
    v_mov_b32 v79, v79
    s_nop 2
    v_mov_b32 v79, v79
    s_nop 2
    v_mov_b32 v79, v79
    s_nop 2
    v_mov_b32 v79, v79
    s_nop 2
    v_mov_b32 v79, v79
    s_nop 2
    v_mov_b32 v79, v79
    s_nop 2
    v_mov_b32 v79, v79
    s_nop 2
    v_mov_b32 v79, v79
    s_nop 2
    v_mov_b32 v79, v79
    s_nop 2
    v_mov_b32 v79, v79
    s_nop 2
    v_mov_b32 v79, v79
    s_nop 2
    v_mov_b32 v79, v79
    s_nop 2
    v_mov_b32 v79, v79
    s_nop 2
    v_mov_b32 v79, v79
    s_nop 2
    v_mov_b32 v79, v79
    s_nop 2
    v_mov_b32 v79, v79
    s_nop 2
    v_mov_b32 v79, v79
    s_nop 2
    v_mov_b32 v79, v79
    s_nop 2
    v_mov_b32 v79, v79
    s_nop 2
    v_mov_b32 v79, v79
    s_nop 2
    v_mov_b32 v79, v79
    s_nop 2
    v_mov_b32 v79, v79
    s_nop 2
    v_mov_b32 v79, v79
    s_nop 2
    v_mov_b32 v79, v79
    s_nop 2
    v_mov_b32 v79, v79
    s_nop 2
    v_mov_b32 v79, v79
    s_nop 2
    v_mov_b32 v79, v79
    s_nop 2
    v_mov_b32 v79, v79
    s_nop 2
    v_mov_b32 v79, v79
    s_nop 2
    v_mov_b32 v79, v79
    s_nop 2
    v_mov_b32 v79, v79
    s_nop 2
    v_mov_b32 v79, v79
    s_nop 2
    v_mov_b32 v79, v79
    s_nop 2
    v_mov_b32 v79, v79
    s_waitcnt vmcnt(0)
    s_cmp_lt_u32 s97, s93
    s_cbranch_scc1 cs_kvwait
    s_nop 2
    v_mov_b32 v79, v79
    s_nop 2
    v_mov_b32 v79, v79
    s_nop 2
    v_mov_b32 v79, v79
    s_nop 2
    v_mov_b32 v79, v79
    s_nop 2
    v_mov_b32 v79, v79
    s_nop 2
    v_mov_b32 v79, v79
    s_nop 2
    v_mov_b32 v79, v79
    s_nop 2
    v_mov_b32 v79, v79
cs_kvok:
    s_branch cs_loop
cs_f0_xt:
    s_mov_b32 s37, 0
    s_nop 2
    v_mov_b32 v79, v79
    s_nop 2
    v_mov_b32 v79, v79
    s_nop 2
    v_mov_b32 v79, v79
    s_nop 2
    v_mov_b32 v79, v79
    s_nop 2
    v_mov_b32 v79, v79
    s_nop 2
    v_mov_b32 v79, v79
    s_branch cs_f0_xtx
cs_f0_retry:
    s_mov_b32 s37, 1
cs_f0_spin:
    buffer_load_dwordx4 v[8:11], v65, s[4:7], s18 offen sc1
    buffer_load_dwordx4 v[12:15], v65, s[4:7], s19 offen sc1
    buffer_load_dwordx4 v[16:19], v65, s[4:7], s20 offen sc1
    buffer_load_dwordx4 v[20:23], v65, s[4:7], s21 offen sc1
    s_nop 2
    v_mov_b32 v79, v79
    s_nop 2
    v_mov_b32 v79, v79
    s_nop 2
    v_mov_b32 v79, v79
    buffer_load_dwordx4 v[40:43], v65, s[4:7], s14 offen offset:0 sc1
    buffer_load_dwordx4 v[60:63], v66, s[4:7], s14 offen offset:0 sc1
    s_waitcnt vmcnt(5)
    v_xor_b32 v77, s69, v8
    v_mfma_f32_16x16x32_bf16 v[0:3], v[4:7], v[8:11], 0
    v_mov_b64 v[8:9], 0
    v_mov_b64 v[10:11], 0
    s_waitcnt vmcnt(4)
    v_bitop3_b32 v77, v77, v12, s69 bitop3:0xf6
    v_mfma_f32_16x16x32_bf16 v[0:3], v[4:7], v[12:15], v[0:3]
    v_mov_b64 v[12:13], 0
    v_mov_b64 v[14:15], 0
    s_waitcnt vmcnt(3)
    v_bitop3_b32 v77, v77, v16, s69 bitop3:0xf6
    v_mfma_f32_16x16x32_bf16 v[0:3], v[4:7], v[16:19], v[0:3]
    v_mov_b64 v[16:17], 0
    v_mov_b64 v[18:19], 0
    s_waitcnt vmcnt(2)
    v_bitop3_b32 v77, v77, v20, s69 bitop3:0xf6
    v_mfma_f32_16x16x32_bf16 v[0:3], v[4:7], v[20:23], v[0:3]
    v_and_b32 v77, 1, v77
    v_cmp_ne_u32 vcc, 0, v77
    v_mov_b64 v[20:21], 0
    v_mov_b64 v[22:23], 0
    buffer_load_dwordx4 v[40:43], v65, s[4:7], s14 offen offset:0 sc1
    buffer_load_dwordx4 v[60:63], v66, s[4:7], s14 offen offset:0 sc1
    s_cmp_eq_u64 vcc, 0
    s_cselect_b64 s[42:43], -1, 0
    v_add_f32_dpp v0, v0, v0 row_ror:8 row_mask:0xf bank_mask:0xf
    v_add_f32_dpp v1, v1, v1 row_ror:8 row_mask:0xf bank_mask:0xf
    s_mov_b64 exec, s[42:43]
    v_cvt_pk_bf16_f32 v72, v0, v1
    v_bfi_b32 v72, v79, s70, v72
    buffer_store_dword v72, v75, s[4:7], s17 offen offset:0 sc1
    s_mov_b64 exec, -1
    s_cbranch_scc1 cs_f0_rx
    s_sub_u32 s31, s31, 1
    s_cbranch_scc0 cs_f0_spin
cs_f0_rx:
    v_mov_b64 v[0:1], 0
    v_mov_b64 v[2:3], 0
    v_mov_b64 v[4:5], 0
    v_mov_b64 v[6:7], 0
    s_branch cs_loop
cs_f1_xt:
    s_mov_b32 s37, 0
    s_nop 2
    v_mov_b32 v79, v79
    s_nop 2
    v_mov_b32 v79, v79
    s_nop 2
    v_mov_b32 v79, v79
    s_nop 2
    v_mov_b32 v79, v79
    s_nop 2
    v_mov_b32 v79, v79
    s_nop 2
    v_mov_b32 v79, v79
    s_branch cs_f1_xtx
cs_f1_retry:
    s_mov_b32 s37, 1
cs_f1_spin:
    buffer_load_dwordx4 v[8:11], v65, s[4:7], s18 offen sc1
    buffer_load_dwordx4 v[12:15], v65, s[4:7], s19 offen sc1
    buffer_load_dwordx4 v[16:19], v65, s[4:7], s20 offen sc1
    buffer_load_dwordx4 v[20:23], v65, s[4:7], s21 offen sc1
    s_nop 2
    v_mov_b32 v79, v79
    s_nop 2
    v_mov_b32 v79, v79
    s_nop 2
    v_mov_b32 v79, v79
    buffer_load_dwordx4 v[40:43], v65, s[4:7], s14 offen offset:0 sc1
    buffer_load_dwordx4 v[60:63], v66, s[4:7], s14 offen offset:0 sc1
    s_waitcnt vmcnt(5)
    v_xor_b32 v77, s69, v8
    v_mfma_f32_16x16x32_bf16 v[0:3], v[4:7], v[8:11], 0
    v_mov_b64 v[8:9], 0
    v_mov_b64 v[10:11], 0
    s_waitcnt vmcnt(4)
    v_bitop3_b32 v77, v77, v12, s69 bitop3:0xf6
    v_mfma_f32_16x16x32_bf16 v[0:3], v[4:7], v[12:15], v[0:3]
    v_mov_b64 v[12:13], 0
    v_mov_b64 v[14:15], 0
    s_waitcnt vmcnt(3)
    v_bitop3_b32 v77, v77, v16, s69 bitop3:0xf6
    v_mfma_f32_16x16x32_bf16 v[0:3], v[4:7], v[16:19], v[0:3]
    v_mov_b64 v[16:17], 0
    v_mov_b64 v[18:19], 0
    s_waitcnt vmcnt(2)
    v_bitop3_b32 v77, v77, v20, s69 bitop3:0xf6
    v_mfma_f32_16x16x32_bf16 v[0:3], v[4:7], v[20:23], v[0:3]
    v_and_b32 v77, 1, v77
    v_cmp_ne_u32 vcc, 0, v77
    v_mov_b64 v[20:21], 0
    v_mov_b64 v[22:23], 0
    buffer_load_dwordx4 v[40:43], v65, s[4:7], s14 offen offset:0 sc1
    buffer_load_dwordx4 v[60:63], v66, s[4:7], s14 offen offset:0 sc1
    s_cmp_eq_u64 vcc, 0
    s_cselect_b64 s[42:43], -1, 0
    v_add_f32_dpp v0, v0, v0 row_ror:8 row_mask:0xf bank_mask:0xf
    v_add_f32_dpp v1, v1, v1 row_ror:8 row_mask:0xf bank_mask:0xf
    s_mov_b64 exec, s[42:43]
    v_cvt_pk_bf16_f32 v72, v0, v1
    v_bfi_b32 v72, v79, s70, v72
    buffer_store_dword v72, v75, s[4:7], s17 offen offset:0 sc1
    s_mov_b64 exec, -1
    s_cbranch_scc1 cs_f1_rx
    s_sub_u32 s31, s31, 1
    s_cbranch_scc0 cs_f1_spin
cs_f1_rx:
    v_mov_b64 v[0:1], 0
    v_mov_b64 v[2:3], 0
    v_mov_b64 v[4:5], 0
    v_mov_b64 v[6:7], 0
    s_branch cs_loop
cs_f2_xt:
    s_mov_b32 s37, 0
    s_nop 2
    v_mov_b32 v79, v79
    s_nop 2
    v_mov_b32 v79, v79
    s_nop 2
    v_mov_b32 v79, v79
    s_nop 2
    v_mov_b32 v79, v79
    s_nop 2
    v_mov_b32 v79, v79
    s_nop 2
    v_mov_b32 v79, v79
    s_branch cs_f2_xtx
cs_f2_retry:
    s_mov_b32 s37, 1
cs_f2_spin:
    buffer_load_dwordx4 v[8:11], v65, s[4:7], s18 offen sc1
    buffer_load_dwordx4 v[12:15], v65, s[4:7], s19 offen sc1
    buffer_load_dwordx4 v[16:19], v65, s[4:7], s20 offen sc1
    buffer_load_dwordx4 v[20:23], v65, s[4:7], s21 offen sc1
    s_nop 2
    v_mov_b32 v79, v79
    s_nop 2
    v_mov_b32 v79, v79
    s_nop 2
    v_mov_b32 v79, v79
    buffer_load_dwordx4 v[40:43], v65, s[4:7], s14 offen offset:0 sc1
    buffer_load_dwordx4 v[60:63], v66, s[4:7], s14 offen offset:0 sc1
    s_waitcnt vmcnt(5)
    v_xor_b32 v77, s69, v8
    v_bitop3_b32 v77, v77, v10, s69 bitop3:0xf6
    v_mfma_f32_16x16x32_bf16 v[0:3], v[4:7], v[8:11], 0
    v_mov_b64 v[8:9], 0
    v_mov_b64 v[10:11], 0
    s_waitcnt vmcnt(4)
    v_bitop3_b32 v77, v77, v12, s69 bitop3:0xf6
    v_bitop3_b32 v77, v77, v14, s69 bitop3:0xf6
    v_mfma_f32_16x16x32_bf16 v[0:3], v[4:7], v[12:15], v[0:3]
    v_mov_b64 v[12:13], 0
    v_mov_b64 v[14:15], 0
    s_waitcnt vmcnt(3)
    v_bitop3_b32 v77, v77, v16, s69 bitop3:0xf6
    v_bitop3_b32 v77, v77, v18, s69 bitop3:0xf6
    v_mfma_f32_16x16x32_bf16 v[0:3], v[4:7], v[16:19], v[0:3]
    v_mov_b64 v[16:17], 0
    v_mov_b64 v[18:19], 0
    s_waitcnt vmcnt(2)
    v_bitop3_b32 v77, v77, v20, s69 bitop3:0xf6
    v_bitop3_b32 v77, v77, v22, s69 bitop3:0xf6
    v_mfma_f32_16x16x32_bf16 v[0:3], v[4:7], v[20:23], v[0:3]
    v_and_b32 v77, 1, v77
    v_cmp_ne_u32 vcc, 0, v77
    v_mov_b64 v[20:21], 0
    v_mov_b64 v[22:23], 0
    buffer_load_dwordx4 v[40:43], v65, s[4:7], s14 offen offset:0 sc1
    buffer_load_dwordx4 v[60:63], v66, s[4:7], s14 offen offset:0 sc1
    s_cmp_eq_u64 vcc, 0
    s_cselect_b64 s[42:43], -1, 0
    v_add_f32 v2, v0, v1
    s_nop 1
    v_add_f32_dpp v2, v2, v2 row_ror:8 row_mask:0xf bank_mask:0xf
    s_nop 1
    v_mov_b32_dpp v0, v2 quad_perm:[0,0,2,2] row_mask:0xf bank_mask:0xf
    v_mov_b32_dpp v1, v2 quad_perm:[1,1,3,3] row_mask:0xf bank_mask:0xf
    s_mov_b64 exec, s[42:43]
    v_cvt_pk_bf16_f32 v72, v0, v1
    v_bfi_b32 v72, v79, s70, v72
    buffer_store_dword v72, v75, s[4:7], s17 offen offset:0 sc1
    buffer_store_dword v72, v75, s[4:7], s17 offen offset:1024 sc1
    buffer_store_dword v72, v75, s[4:7], s17 offen offset:2048 sc1
    buffer_store_dword v72, v75, s[4:7], s17 offen offset:3072 sc1
    s_mov_b64 exec, -1
    s_cbranch_scc1 cs_f2_rx
    s_sub_u32 s31, s31, 1
    s_cbranch_scc0 cs_f2_spin
cs_f2_rx:
    v_mov_b64 v[0:1], 0
    v_mov_b64 v[2:3], 0
    v_mov_b64 v[4:5], 0
    v_mov_b64 v[6:7], 0
    s_branch cs_loop
cs_spinB:
    s_waitcnt vmcnt(2)
cs_spinB_l:
    v_and_b32 v77, s36, v44
    v_cmp_ne_u32 vcc, s70, v77
    s_cbranch_vccz cs_spinB_x
    buffer_load_dwordx4 v[44:47], v65, s[4:7], s15 offen sc1
    s_sub_u32 s31, s31, 16
    s_waitcnt vmcnt(0)
    s_cbranch_scc0 cs_spinB_l
cs_spinB_x:
    ds_write_b128 v65, v[44:47] offset:4096
    s_waitcnt lgkmcnt(0)
    s_branch cs_backB
cs_spin8:
    buffer_load_dwordx4 v[40:43], v65, s[4:7], s16 offen sc1
cs_spin8_l:
    v_and_b32 v77, s36, v40
    v_cmp_ne_u32 vcc, s70, v77
    s_cbranch_vccz cs_spin8_x
    s_nop 15
    s_nop 15
    s_nop 15
    s_nop 11
    v_and_b32 v77, s36, v40
    v_cmp_ne_u32 vcc, s70, v77
    s_cbranch_vccz cs_spin8_x
    s_nop 15
    s_nop 15
    s_nop 15
    s_nop 11
    v_and_b32 v77, s36, v40
    v_cmp_ne_u32 vcc, s70, v77
    s_cbranch_vccz cs_spin8_x
    s_nop 15
    s_nop 15
    s_nop 15
    s_nop 11
    buffer_load_dwordx4 v[40:43], v65, s[4:7], s16 offen sc1
    s_sub_u32 s31, s31, 16
    s_cbranch_scc0 cs_spin8_l
cs_spin8_x:
    s_branch cs_back8
cs_rare:
    s_mov_b64 exec, s[34:35]
    buffer_store_dwordx4 v[0:3], v65, s[4:7], s28 offen sc1
    s_mov_b64 exec, -1
    s_nop 3
    v_cvt_pk_bf16_f32 v52, v16, v17
    v_cvt_pk_bf16_f32 v53, v18, v19
    v_cvt_pk_bf16_f32 v54, v20, v21
    v_cvt_pk_bf16_f32 v55, v22, v23
    buffer_store_dwordx4 v[52:55], v65, s[4:7], s27 offen sc1
    s_add_u32 s28, s28, 131072
    s_add_u32 s27, s27, 131072
    s_cmp_eq_u32 s30, 63
    s_cbranch_scc1 cs_last
    s_branch cs_rare_x
cs_kvwait:
    s_mov_b32 s41, s97
    v_bfe_u32 v78, v65, 2, 5
    v_mov_b32 v77, v76
    s_nop 1
    v_permlane32_swap_b32 v76, v77
    v_subrev_u32 v77, s95, v77
    v_cmp_lt_u32 vcc, 16, v77
    s_nop 1
    v_cndmask_b32 v77, v77, 0, vcc
    v_bfe_u32 v79, v78, 2, 2
    v_lshl_add_u32 v77, v77, 2, v79
    s_nop 1
    v_min_u32_dpp v77, v77, v77 row_ror:1 row_mask:0xf bank_mask:0xf
    s_nop 1
    v_min_u32_dpp v77, v77, v77 row_ror:2 row_mask:0xf bank_mask:0xf
    s_nop 1
    v_min_u32_dpp v77, v77, v77 row_ror:4 row_mask:0xf bank_mask:0xf
    s_nop 0
    v_readfirstlane_b32 s97, v77
    s_nop 0
    s_max_u32 s97, s97, s41
    s_add_u32 s40, s30, 3
    s_min_u32 s40, s40, 64
    s_cmp_le_u32 s40, s97
    s_cbranch_scc1 cs_kvw_x
    v_bfe_u32 v78, v65, 2, 5
    s_mov_b32 s31, 4194304
cs_kvw:
    buffer_load_dword v77, v78, s[4:7], s96 offen offset:16 sc1
    s_waitcnt vmcnt(0)
    v_subrev_u32 v77, s95, v77
    v_cmp_lt_u32 vcc, 16, v77
    s_nop 1
    v_cndmask_b32 v77, v77, 0, vcc
    v_bfe_u32 v79, v78, 2, 2
    v_lshl_add_u32 v77, v77, 2, v79
    s_nop 1
    v_min_u32_dpp v77, v77, v77 row_ror:1 row_mask:0xf bank_mask:0xf
    s_nop 1
    v_min_u32_dpp v77, v77, v77 row_ror:2 row_mask:0xf bank_mask:0xf
    s_nop 1
    v_min_u32_dpp v77, v77, v77 row_ror:4 row_mask:0xf bank_mask:0xf
    s_nop 0
    v_readfirstlane_b32 s97, v77
    s_sub_u32 s31, s31, 1
    s_cbranch_scc1 cs_kvw_x
    s_cmp_le_u32 s40, s97
    s_cbranch_scc1 cs_kvw_x
    s_sleep 2
    s_branch cs_kvw
cs_kvw_x:
    s_branch cs_kvok
cs_last:
    s_add_u32 s40, s95, 64
    v_mov_b32 v78, s40
    s_waitcnt vmcnt(0)
    s_barrier
    s_mov_b64 exec, s[100:101]
    buffer_store_dword v78, off, s[4:7], s29 sc1
    s_mov_b64 exec, -1
cs_end:
    s_endpgm
L_xform:
    v_and_b32 v1, 63, v0
    v_and_b32 v2, 15, v1
    v_lshrrev_b32 v3, 4, v1
    v_mov_b32 v7, 0x05040100
    v_mov_b32 v8, 0x07060302
    v_lshrrev_b32 v9, 6, v0
    v_lshlrev_b32 v9, 14, v9
    v_lshlrev_b32 v10, 4, v1
    v_add_u32 v11, v9, v10
    s_mov_b32 s10, 4718592
    s_mov_b32 s11, 0x20000
    s_mov_b64 s[8:9], s[58:59]
xf_f:
    s_sub_u32 s17, s16, 1504
    s_and_b32 s18, s17, 127
    s_lshr_b32 s17, s17, 7
    s_lshl_b32 s19, s17, 4
    v_add_u32 v6, s19, v2
    v_mul_u32_u24 v4, 9216, v3
    v_lshl_add_u32 v4, v6, 4, v4
    v_lshrrev_b32 v5, 2, v2
    v_lshlrev_b32 v5, 11, v5
    v_lshl_add_u32 v5, v3, 8, v5
    v_and_b32 v1, 3, v6
    v_lshl_add_u32 v5, v1, 6, v5
    v_add_u32 v5, v5, v9
    v_cmp_gt_u32 vcc, 72, v6
    s_nop 0
    s_mov_b64 exec, vcc
    s_mul_i32 s20, s18, 36864
    s_add_u32 s21, s20, 0
    buffer_load_dwordx4 v[12:15], v4, s[8:11], s21 offen
    s_add_u32 s21, s20, 1152
    buffer_load_dwordx4 v[16:19], v4, s[8:11], s21 offen
    s_add_u32 s21, s20, 2304
    buffer_load_dwordx4 v[20:23], v4, s[8:11], s21 offen
    s_add_u32 s21, s20, 3456
    buffer_load_dwordx4 v[24:27], v4, s[8:11], s21 offen
    s_add_u32 s21, s20, 4608
    buffer_load_dwordx4 v[28:31], v4, s[8:11], s21 offen
    s_add_u32 s21, s20, 5760
    buffer_load_dwordx4 v[32:35], v4, s[8:11], s21 offen
    s_add_u32 s21, s20, 6912
    buffer_load_dwordx4 v[36:39], v4, s[8:11], s21 offen
    s_add_u32 s21, s20, 8064
    buffer_load_dwordx4 v[40:43], v4, s[8:11], s21 offen
    s_lshl_b32 s20, s18, 11
    s_add_u32 s20, s20, 130023424
    s_waitcnt vmcnt(0)
    v_perm_b32 v76, v16, v12, v7
    v_perm_b32 v77, v24, v20, v7
    v_perm_b32 v78, v32, v28, v7
    v_perm_b32 v79, v40, v36, v7
    ds_write_b128 v5, v[76:79] offset:0
    v_perm_b32 v80, v17, v13, v7
    v_perm_b32 v81, v25, v21, v7
    v_perm_b32 v82, v33, v29, v7
    v_perm_b32 v83, v41, v37, v7
    ds_write_b128 v5, v[80:83] offset:16
    v_perm_b32 v84, v18, v14, v7
    v_perm_b32 v85, v26, v22, v7
    v_perm_b32 v86, v34, v30, v7
    v_perm_b32 v87, v42, v38, v7
    ds_write_b128 v5, v[84:87] offset:32
    v_perm_b32 v88, v19, v15, v7
    v_perm_b32 v89, v27, v23, v7
    v_perm_b32 v90, v35, v31, v7
    v_perm_b32 v91, v43, v39, v7
    ds_write_b128 v5, v[88:91] offset:48
    v_perm_b32 v92, v16, v12, v8
    v_perm_b32 v93, v24, v20, v8
    v_perm_b32 v94, v32, v28, v8
    v_perm_b32 v95, v40, v36, v8
    ds_write_b128 v5, v[92:95] offset:1024
    v_perm_b32 v96, v17, v13, v8
    v_perm_b32 v97, v25, v21, v8
    v_perm_b32 v98, v33, v29, v8
    v_perm_b32 v99, v41, v37, v8
    ds_write_b128 v5, v[96:99] offset:1040
    v_perm_b32 v100, v18, v14, v8
    v_perm_b32 v101, v26, v22, v8
    v_perm_b32 v102, v34, v30, v8
    v_perm_b32 v103, v42, v38, v8
    ds_write_b128 v5, v[100:103] offset:1056
    v_perm_b32 v104, v19, v15, v8
    v_perm_b32 v105, v27, v23, v8
    v_perm_b32 v106, v35, v31, v8
    v_perm_b32 v107, v43, v39, v8
    ds_write_b128 v5, v[104:107] offset:1072
    s_mov_b64 exec, -1
    s_lshl_b32 s21, s17, 20
    s_add_u32 s20, s20, s21
    s_waitcnt lgkmcnt(0)
    ds_read_b128 v[76:79], v11 offset:0
    ds_read_b128 v[80:83], v11 offset:1024
    ds_read_b128 v[84:87], v11 offset:2048
    ds_read_b128 v[88:91], v11 offset:3072
    ds_read_b128 v[92:95], v11 offset:4096
    ds_read_b128 v[96:99], v11 offset:5120
    ds_read_b128 v[100:103], v11 offset:6144
    ds_read_b128 v[104:107], v11 offset:7168
    s_add_u32 s19, s20, 0
    s_waitcnt lgkmcnt(7)
    buffer_store_dwordx4 v[76:79], v10, s[4:7], s19 offen sc1
    s_add_u32 s19, s20, 1024
    s_waitcnt lgkmcnt(6)
    buffer_store_dwordx4 v[80:83], v10, s[4:7], s19 offen sc1
    s_add_u32 s19, s20, 262144
    s_waitcnt lgkmcnt(5)
    buffer_store_dwordx4 v[84:87], v10, s[4:7], s19 offen sc1
    s_add_u32 s19, s20, 263168
    s_waitcnt lgkmcnt(4)
    buffer_store_dwordx4 v[88:91], v10, s[4:7], s19 offen sc1
    s_add_u32 s19, s20, 524288
    s_waitcnt lgkmcnt(3)
    buffer_store_dwordx4 v[92:95], v10, s[4:7], s19 offen sc1
    s_add_u32 s19, s20, 525312
    s_waitcnt lgkmcnt(2)
    buffer_store_dwordx4 v[96:99], v10, s[4:7], s19 offen sc1
    s_add_u32 s19, s20, 786432
    s_waitcnt lgkmcnt(1)
    buffer_store_dwordx4 v[100:103], v10, s[4:7], s19 offen sc1
    s_add_u32 s19, s20, 787456
    s_waitcnt lgkmcnt(0)
    buffer_store_dwordx4 v[104:107], v10, s[4:7], s19 offen sc1
xf_done:
    s_nop 1
    s_setpc_b64 s[46:47]
L_helper:
    s_load_dwordx16 s[64:79], s[0:1], 64
    s_waitcnt lgkmcnt(0)
    s_mov_b32 s93, 1000
    s_mov_b32 s95, 0
    s_cmp_lg_u32 s3, 2
    s_cbranch_scc1 L_qkv_next
    s_mov_b32 s37, 24
    v_mov_b32 v250, 1
    v_mov_b32 v251, 163832
    v_cmp_eq_u32 vcc, 0, v0
    s_nop 0
    s_and_saveexec_b64 s[38:39], vcc
    s_cbranch_execz tk3
    buffer_atomic_add v250, off, s[84:87], s37 sc0
    s_waitcnt vmcnt(0)
    ds_write_b32 v251, v250
    s_waitcnt lgkmcnt(0)
tk3:
    s_mov_b64 exec, -1
    s_barrier
    ds_read_b32 v252, v251
    s_waitcnt lgkmcnt(0)
    v_readfirstlane_b32 s36, v252
    s_barrier
    s_nop 3
    s_cmp_ge_u32 s36, 32
    s_cbranch_scc1 L_qkv_next
    s_mov_b32 s93, 0
    s_mov_b32 s88, 4194304
gn4:
    buffer_load_dword v250, off, s[84:87], 0 offset:216 sc1
    s_waitcnt vmcnt(0)
    v_readfirstlane_b32 s95, v250
    s_sub_u32 s88, s88, 1
    s_cbranch_scc1 gn4x
    s_cmp_eq_u32 s95, 0
    s_cbranch_scc1 gn4
gn4x:
    s_cmp_eq_u32 s36, 0
    s_cbranch_scc1 L_relay
    s_branch L_wf_next
L_qkv_next:
    s_mov_b32 s37, 4
    v_mov_b32 v250, 1
    v_mov_b32 v251, 163832
    v_cmp_eq_u32 vcc, 0, v0
    s_nop 0
    s_and_saveexec_b64 s[38:39], vcc
    s_cbranch_execz tk5
    buffer_atomic_add v250, off, s[84:87], s37 sc0
    s_waitcnt vmcnt(0)
    ds_write_b32 v251, v250
    s_waitcnt lgkmcnt(0)
tk5:
    s_mov_b64 exec, -1
    s_barrier
    ds_read_b32 v252, v251
    s_waitcnt lgkmcnt(0)
    v_readfirstlane_b32 s36, v252
    s_barrier
    s_nop 3
    s_or_b32 s37, s36, s32
    s_cbranch_scc1 L_non
    s_memrealtime s[90:91]
    s_waitcnt lgkmcnt(0)
    s_lshl_b32 s90, s90, 8
    s_or_b32 s90, s90, 1
    v_mov_b32 v250, s90
    s_mov_b64 exec, 1
    buffer_store_dword v250, off, s[84:87], 0 offset:216 sc1
    s_mov_b64 exec, -1
L_non:
    s_cmp_lt_u32 s36, 192
    s_cbranch_scc1 L_qkv
    s_cmp_lg_u32 s95, 0
    s_cbranch_scc1 L_hn
    s_mov_b32 s88, 4194304
gn6:
    buffer_load_dword v250, off, s[84:87], 0 offset:216 sc1
    s_waitcnt vmcnt(0)
    v_readfirstlane_b32 s95, v250
    s_sub_u32 s88, s88, 1
    s_cbranch_scc1 gn6x
    s_cmp_eq_u32 s95, 0
    s_cbranch_scc1 gn6
gn6x:
L_hn:
    s_sub_u32 s45, s36, 192
    s_cmp_lg_u32 s36, 192
    s_cbranch_scc1 L_phase2
    s_mov_b32 s37, 24
    v_mov_b32 v250, 1
    v_mov_b32 v251, 163832
    v_cmp_eq_u32 vcc, 0, v0
    s_nop 0
    s_and_saveexec_b64 s[38:39], vcc
    s_cbranch_execz tk7
    buffer_atomic_add v250, off, s[84:87], s37 sc0
    s_waitcnt vmcnt(0)
    ds_write_b32 v251, v250
    s_waitcnt lgkmcnt(0)
tk7:
    s_mov_b64 exec, -1
    s_barrier
    ds_read_b32 v252, v251
    s_waitcnt lgkmcnt(0)
    v_readfirstlane_b32 s36, v252
    s_barrier
    s_nop 3
    s_cmp_lg_u32 s36, 0
    s_cbranch_scc1 L_phase2
L_relay:
    s_cmp_lg_u32 s32, 0
    s_cbranch_scc1 L_exit
    v_and_b32 v3, 31, v0
    v_lshlrev_b32 v3, 7, v3
    s_mov_b32 s17, 0
    s_mov_b32 s23, 125845504
    s_mov_b32 s24, 125853696
    s_mov_b32 s21, 16777216
rl_rwait:
    buffer_load_dword v4, v3, s[4:7], s23 offen sc1
    s_waitcnt vmcnt(0)
    v_subrev_u32 v4, s95, v4
    v_cmp_lt_u32 vcc, 64, v4
    s_nop 1
    v_cndmask_b32 v4, v4, 0, vcc
    s_nop 1
    v_min_u32_dpp v4, v4, v4 row_ror:1 row_mask:0xf bank_mask:0xf
    s_nop 1
    v_min_u32_dpp v4, v4, v4 row_ror:2 row_mask:0xf bank_mask:0xf
    s_nop 1
    v_min_u32_dpp v4, v4, v4 row_ror:4 row_mask:0xf bank_mask:0xf
    s_nop 1
    v_min_u32_dpp v4, v4, v4 row_ror:8 row_mask:0xf bank_mask:0xf
    s_nop 0
    v_readlane_b32 s16, v4, 0
    v_readlane_b32 s22, v4, 16
    s_nop 0
    s_min_u32 s16, s16, s22
    s_sub_u32 s21, s21, 1
    s_cbranch_scc1 rl_x
    s_cmp_gt_u32 s16, s17
    s_cbranch_scc1 rl_rpub
    s_sleep 2
    s_branch rl_rwait
rl_rpub:
    s_mov_b32 s17, s16
    s_add_u32 s22, s16, s95
    v_mov_b32 v4, s22
    s_mov_b64 exec, 1
    buffer_store_dword v4, off, s[4:7], s24 sc1
    s_mov_b64 exec, -1
    s_cmp_lt_u32 s16, 64
    s_cbranch_scc1 rl_rwait
rl_x:
    s_endpgm
L_qkv:
    s_sub_u32 s33, s36, 32
    s_and_b32 s17, s36, 15
    s_lshl_b32 s17, s17, 1
    s_lshr_b32 s36, s36, 4
    s_and_b32 s16, s36, 1
    s_add_u32 s16, s16, 1
    s_lshr_b32 s19, s36, 1
    s_and_b32 s37, s36, 3
    s_cmp_ge_u32 s36, 8
    s_cselect_b32 s16, 0, s16
    s_cselect_b32 s19, s37, s19
    v_lshrrev_b32 v4, 6, v0
    s_nop 0
    v_readfirstlane_b32 s18, v4
    v_lshlrev_b32 v7, 4, v0
    s_cmp_eq_u32 s16, 1
    s_cselect_b64 s[12:13], s[54:55], s[52:53]
    s_cmp_eq_u32 s16, 2
    s_cselect_b64 s[12:13], s[56:57], s[12:13]
    s_mov_b32 s14, 4718592
    s_mov_b32 s15, 0x20000
    v_bfe_u32 v4, v0, 5, 1
    v_lshlrev_b32 v5, 2, v4
    v_and_b32 v8, 31, v0
    v_xor_b32 v8, v8, v5
    v_lshlrev_b32 v8, 4, v8
    v_lshl_add_u32 v8, v4, 13, v8
    v_xor_b32 v9, 128, v8
    s_lshl_b32 s21, s17, 8
    s_lshl_b32 s42, s18, 16
    s_add_u32 s42, s42, s21
    s_lshl_b32 s44, s18, 12
    s_barrier
    s_add_u32 m0, s44, 73728
    s_add_u32 s22, s42, 0
    buffer_load_dwordx4 v8, s[12:15], s22 offen offset:0 lds
    s_add_u32 s22, s42, 15360
    buffer_load_dwordx4 v9, s[12:15], s22 offen offset:1024 lds
    s_add_u32 s22, s42, 30720
    buffer_load_dwordx4 v8, s[12:15], s22 offen offset:2048 lds
    s_add_u32 s22, s42, 46080
    buffer_load_dwordx4 v9, s[12:15], s22 offen offset:3072 lds
    s_add_u32 m0, s44, 90112
    s_add_u32 s22, s42, 262144
    buffer_load_dwordx4 v8, s[12:15], s22 offen offset:0 lds
    s_add_u32 s22, s42, 277504
    buffer_load_dwordx4 v9, s[12:15], s22 offen offset:1024 lds
    s_add_u32 s22, s42, 292864
    buffer_load_dwordx4 v8, s[12:15], s22 offen offset:2048 lds
    s_add_u32 s22, s42, 308224
    buffer_load_dwordx4 v9, s[12:15], s22 offen offset:3072 lds
    s_add_u32 m0, s44, 106496
    s_add_u32 s22, s42, 524288
    buffer_load_dwordx4 v8, s[12:15], s22 offen offset:0 lds
    s_add_u32 s22, s42, 539648
    buffer_load_dwordx4 v9, s[12:15], s22 offen offset:1024 lds
    s_add_u32 s22, s42, 555008
    buffer_load_dwordx4 v8, s[12:15], s22 offen offset:2048 lds
    s_add_u32 s22, s42, 570368
    buffer_load_dwordx4 v9, s[12:15], s22 offen offset:3072 lds
    s_add_u32 m0, s44, 122880
    s_add_u32 s22, s42, 786432
    buffer_load_dwordx4 v8, s[12:15], s22 offen offset:0 lds
    s_add_u32 s22, s42, 801792
    buffer_load_dwordx4 v9, s[12:15], s22 offen offset:1024 lds
    s_add_u32 s22, s42, 817152
    buffer_load_dwordx4 v8, s[12:15], s22 offen offset:2048 lds
    s_add_u32 s22, s42, 832512
    buffer_load_dwordx4 v9, s[12:15], s22 offen offset:3072 lds
    v_bfe_u32 v4, v0, 2, 2
    v_xor_b32 v5, s18, v4
    v_lshlrev_b32 v10, 6, v5
    v_lshl_add_u32 v10, v4, 9, v10
    v_and_b32 v4, 3, v0
    v_lshl_add_u32 v10, v4, 4, v10
    v_bfe_u32 v4, v0, 4, 2
    v_lshl_add_u32 v10, v4, 12, v10
    v_add_u32 v10, 73728, v10
    v_add_u32 v11, 49152, v10
    v_and_b32 v4, 63, v0
    v_and_b32 v5, 15, v4
    v_lshrrev_b32 v3, 4, v4
    v_lshrrev_b32 v2, 2, v5
    v_xor_b32 v3, v3, v2
    v_lshl_add_u32 v3, v5, 2, v3
    v_lshlrev_b32 v1, 4, v3
    v_lshrrev_b32 v5, 2, v4
    v_lshrrev_b32 v3, 4, v4
    v_and_b32 v4, 3, v4
    v_xor_b32 v4, v4, v3
    v_lshlrev_b32 v3, 3, v3
    v_and_b32 v5, 3, v5
    v_add_u32 v3, v3, v5
    v_mul_u32_u24 v2, 1152, v3
    v_lshl_add_u32 v2, v4, 4, v2
    s_mov_b32 s8, s48
    s_mov_b32 s9, s49
    s_mov_b32 s10, 2359296
    s_mov_b32 s11, 0x20000
    s_lshr_b32 s22, s18, 1
    s_mul_i32 s24, s22, 4608
    s_mul_i32 s25, s22, 18432
    s_and_b32 s22, s18, 1
    s_mul_i32 s23, s22, 576
    s_add_u32 s24, s24, s23
    s_mul_i32 s25, s18, 9216
    s_mul_i32 s22, s19, 36864
    s_add_u32 s24, s24, s22
    s_mov_b32 s20, 64
    s_lshl_b32 s22, s19, 5
    s_add_u32 s22, s22, s17
    s_lshl_b32 s26, s22, 14
    s_mul_i32 s23, s18, 3072
    s_add_u32 s26, s26, s23
    s_lshl_b32 s23, s16, 11
    s_add_u32 s26, s26, s23
    s_add_u32 s26, s26, -2048
    s_lshl_b32 s22, s22, 13
    s_add_u32 s22, s22, 33554432
    s_cmp_eq_u32 s16, 0
    s_cselect_b32 s26, s22, s26
    s_cselect_b32 s40, 4096, 64
    s_cselect_b32 s41, 1, 2
    s_max_u32 s40, s40, 1024
    s_lshl_b32 s41, s41, 18
    s_lshl_b32 s29, s17, 7
    s_lshl_b32 s22, s16, 4
    s_add_u32 s29, s29, s22
    s_lshl_b32 s22, s19, 2
    s_add_u32 s29, s29, s22
    s_add_u32 s29, s29, 125829120
    s_mov_b32 s27, 0
    s_add_u32 s23, s27, s25
    s_add_u32 m0, s23, 0
    s_nop 0
    buffer_load_dwordx4 v2, s[8:11], s24 offen offset:0 lds
    s_add_u32 m0, s23, 960
    s_nop 0
    buffer_load_dwordx4 v2, s[8:11], s24 offen offset:64 lds
    s_add_u32 m0, s23, 1920
    s_nop 0
    buffer_load_dwordx4 v2, s[8:11], s24 offen offset:128 lds
    s_add_u32 m0, s23, 2880
    s_nop 0
    buffer_load_dwordx4 v2, s[8:11], s24 offen offset:192 lds
    s_add_u32 m0, s23, 3840
    s_nop 0
    buffer_load_dwordx4 v2, s[8:11], s24 offen offset:256 lds
    s_add_u32 m0, s23, 4800
    s_nop 0
    buffer_load_dwordx4 v2, s[8:11], s24 offen offset:320 lds
    s_add_u32 m0, s23, 5760
    s_nop 0
    buffer_load_dwordx4 v2, s[8:11], s24 offen offset:384 lds
    s_add_u32 m0, s23, 6720
    s_nop 0
    buffer_load_dwordx4 v2, s[8:11], s24 offen offset:448 lds
    s_add_u32 m0, s23, 7680
    s_nop 0
    buffer_load_dwordx4 v2, s[8:11], s24 offen offset:512 lds
    s_add_u32 s24, s24, 147456
    s_waitcnt vmcnt(21) lgkmcnt(0)
    s_barrier
    s_add_u32 m0, s44, 139264
    s_add_u32 s22, s42, 1048576
    buffer_load_dwordx4 v8, s[12:15], s22 offen offset:0 lds
    s_add_u32 s22, s42, 1063936
    buffer_load_dwordx4 v9, s[12:15], s22 offen offset:1024 lds
    s_add_u32 s22, s42, 1079296
    buffer_load_dwordx4 v8, s[12:15], s22 offen offset:2048 lds
    s_add_u32 s22, s42, 1094656
    buffer_load_dwordx4 v9, s[12:15], s22 offen offset:3072 lds
    ds_read_b64_tr_b16 v[64:65], v10 offset:0
    ds_read_b64_tr_b16 v[66:67], v10 offset:2048
    ds_read_b64_tr_b16 v[136:137], v10 offset:8
    ds_read_b64_tr_b16 v[138:139], v10 offset:2056
    ds_read_b64_tr_b16 a[0:1], v10 offset:256
    ds_read_b64_tr_b16 a[2:3], v10 offset:2304
    ds_read_b64_tr_b16 a[72:73], v10 offset:264
    ds_read_b64_tr_b16 a[74:75], v10 offset:2312
    s_waitcnt vmcnt(21) lgkmcnt(0)
    s_barrier
    s_add_u32 m0, s44, 73728
    s_add_u32 s22, s42, 1310720
    buffer_load_dwordx4 v8, s[12:15], s22 offen offset:0 lds
    s_add_u32 s22, s42, 1326080
    buffer_load_dwordx4 v9, s[12:15], s22 offen offset:1024 lds
    s_add_u32 s22, s42, 1341440
    buffer_load_dwordx4 v8, s[12:15], s22 offen offset:2048 lds
    s_add_u32 s22, s42, 1356800
    buffer_load_dwordx4 v9, s[12:15], s22 offen offset:3072 lds
    ds_read_b64_tr_b16 v[68:69], v10 offset:16384
    ds_read_b64_tr_b16 v[70:71], v10 offset:18432
    ds_read_b64_tr_b16 v[140:141], v10 offset:16392
    ds_read_b64_tr_b16 v[142:143], v10 offset:18440
    ds_read_b64_tr_b16 a[4:5], v10 offset:16640
    ds_read_b64_tr_b16 a[6:7], v10 offset:18688
    ds_read_b64_tr_b16 a[76:77], v10 offset:16648
    ds_read_b64_tr_b16 a[78:79], v10 offset:18696
    s_waitcnt vmcnt(21) lgkmcnt(0)
    s_barrier
    s_add_u32 m0, s44, 90112
    s_add_u32 s22, s42, 1572864
    buffer_load_dwordx4 v8, s[12:15], s22 offen offset:0 lds
    s_add_u32 s22, s42, 1588224
    buffer_load_dwordx4 v9, s[12:15], s22 offen offset:1024 lds
    s_add_u32 s22, s42, 1603584
    buffer_load_dwordx4 v8, s[12:15], s22 offen offset:2048 lds
    s_add_u32 s22, s42, 1618944
    buffer_load_dwordx4 v9, s[12:15], s22 offen offset:3072 lds
    ds_read_b64_tr_b16 v[72:73], v10 offset:32768
    ds_read_b64_tr_b16 v[74:75], v10 offset:34816
    ds_read_b64_tr_b16 v[144:145], v10 offset:32776
    ds_read_b64_tr_b16 v[146:147], v10 offset:34824
    ds_read_b64_tr_b16 a[8:9], v10 offset:33024
    ds_read_b64_tr_b16 a[10:11], v10 offset:35072
    ds_read_b64_tr_b16 a[80:81], v10 offset:33032
    ds_read_b64_tr_b16 a[82:83], v10 offset:35080
    s_waitcnt vmcnt(21) lgkmcnt(0)
    s_barrier
    s_add_u32 m0, s44, 106496
    s_add_u32 s22, s42, 1835008
    buffer_load_dwordx4 v8, s[12:15], s22 offen offset:0 lds
    s_add_u32 s22, s42, 1850368
    buffer_load_dwordx4 v9, s[12:15], s22 offen offset:1024 lds
    s_add_u32 s22, s42, 1865728
    buffer_load_dwordx4 v8, s[12:15], s22 offen offset:2048 lds
    s_add_u32 s22, s42, 1881088
    buffer_load_dwordx4 v9, s[12:15], s22 offen offset:3072 lds
    ds_read_b64_tr_b16 v[76:77], v11 offset:0
    ds_read_b64_tr_b16 v[78:79], v11 offset:2048
    ds_read_b64_tr_b16 v[148:149], v11 offset:8
    ds_read_b64_tr_b16 v[150:151], v11 offset:2056
    ds_read_b64_tr_b16 a[12:13], v11 offset:256
    ds_read_b64_tr_b16 a[14:15], v11 offset:2304
    ds_read_b64_tr_b16 a[84:85], v11 offset:264
    ds_read_b64_tr_b16 a[86:87], v11 offset:2312
    s_waitcnt vmcnt(12) lgkmcnt(0)
    s_barrier
    s_add_u32 m0, s44, 122880
    s_add_u32 s22, s42, 2097152
    buffer_load_dwordx4 v8, s[12:15], s22 offen offset:0 lds
    s_add_u32 s22, s42, 2112512
    buffer_load_dwordx4 v9, s[12:15], s22 offen offset:1024 lds
    s_add_u32 s22, s42, 2127872
    buffer_load_dwordx4 v8, s[12:15], s22 offen offset:2048 lds
    s_add_u32 s22, s42, 2143232
    buffer_load_dwordx4 v9, s[12:15], s22 offen offset:3072 lds
    ds_read_b64_tr_b16 v[80:81], v11 offset:16384
    ds_read_b64_tr_b16 v[82:83], v11 offset:18432
    ds_read_b64_tr_b16 v[152:153], v11 offset:16392
    ds_read_b64_tr_b16 v[154:155], v11 offset:18440
    ds_read_b64_tr_b16 a[16:17], v11 offset:16640
    ds_read_b64_tr_b16 a[18:19], v11 offset:18688
    ds_read_b64_tr_b16 a[88:89], v11 offset:16648
    ds_read_b64_tr_b16 a[90:91], v11 offset:18696
    s_waitcnt vmcnt(12) lgkmcnt(0)
    s_barrier
    s_add_u32 m0, s44, 139264
    s_add_u32 s22, s42, 2359296
    buffer_load_dwordx4 v8, s[12:15], s22 offen offset:0 lds
    s_add_u32 s22, s42, 2374656
    buffer_load_dwordx4 v9, s[12:15], s22 offen offset:1024 lds
    s_add_u32 s22, s42, 2390016
    buffer_load_dwordx4 v8, s[12:15], s22 offen offset:2048 lds
    s_add_u32 s22, s42, 2405376
    buffer_load_dwordx4 v9, s[12:15], s22 offen offset:3072 lds
    ds_read_b64_tr_b16 v[84:85], v10 offset:0
    ds_read_b64_tr_b16 v[86:87], v10 offset:2048
    ds_read_b64_tr_b16 v[156:157], v10 offset:8
    ds_read_b64_tr_b16 v[158:159], v10 offset:2056
    ds_read_b64_tr_b16 a[20:21], v10 offset:256
    ds_read_b64_tr_b16 a[22:23], v10 offset:2304
    ds_read_b64_tr_b16 a[92:93], v10 offset:264
    ds_read_b64_tr_b16 a[94:95], v10 offset:2312
    s_waitcnt vmcnt(12) lgkmcnt(0)
    s_barrier
    s_add_u32 m0, s44, 73728
    s_add_u32 s22, s42, 2621440
    buffer_load_dwordx4 v8, s[12:15], s22 offen offset:0 lds
    s_add_u32 s22, s42, 2636800
    buffer_load_dwordx4 v9, s[12:15], s22 offen offset:1024 lds
    s_add_u32 s22, s42, 2652160
    buffer_load_dwordx4 v8, s[12:15], s22 offen offset:2048 lds
    s_add_u32 s22, s42, 2667520
    buffer_load_dwordx4 v9, s[12:15], s22 offen offset:3072 lds
    ds_read_b64_tr_b16 v[88:89], v10 offset:16384
    ds_read_b64_tr_b16 v[90:91], v10 offset:18432
    ds_read_b64_tr_b16 v[160:161], v10 offset:16392
    ds_read_b64_tr_b16 v[162:163], v10 offset:18440
    ds_read_b64_tr_b16 a[24:25], v10 offset:16640
    ds_read_b64_tr_b16 a[26:27], v10 offset:18688
    ds_read_b64_tr_b16 a[96:97], v10 offset:16648
    ds_read_b64_tr_b16 a[98:99], v10 offset:18696
    s_waitcnt vmcnt(12) lgkmcnt(0)
    s_barrier
    s_add_u32 m0, s44, 90112
    s_add_u32 s22, s42, 2883584
    buffer_load_dwordx4 v8, s[12:15], s22 offen offset:0 lds
    s_add_u32 s22, s42, 2898944
    buffer_load_dwordx4 v9, s[12:15], s22 offen offset:1024 lds
    s_add_u32 s22, s42, 2914304
    buffer_load_dwordx4 v8, s[12:15], s22 offen offset:2048 lds
    s_add_u32 s22, s42, 2929664
    buffer_load_dwordx4 v9, s[12:15], s22 offen offset:3072 lds
    ds_read_b64_tr_b16 v[92:93], v10 offset:32768
    ds_read_b64_tr_b16 v[94:95], v10 offset:34816
    ds_read_b64_tr_b16 v[164:165], v10 offset:32776
    ds_read_b64_tr_b16 v[166:167], v10 offset:34824
    ds_read_b64_tr_b16 a[28:29], v10 offset:33024
    ds_read_b64_tr_b16 a[30:31], v10 offset:35072
    ds_read_b64_tr_b16 a[100:101], v10 offset:33032
    ds_read_b64_tr_b16 a[102:103], v10 offset:35080
    s_waitcnt vmcnt(12) lgkmcnt(0)
    s_barrier
    s_add_u32 m0, s44, 106496
    s_add_u32 s22, s42, 3145728
    buffer_load_dwordx4 v8, s[12:15], s22 offen offset:0 lds
    s_add_u32 s22, s42, 3161088
    buffer_load_dwordx4 v9, s[12:15], s22 offen offset:1024 lds
    s_add_u32 s22, s42, 3176448
    buffer_load_dwordx4 v8, s[12:15], s22 offen offset:2048 lds
    s_add_u32 s22, s42, 3191808
    buffer_load_dwordx4 v9, s[12:15], s22 offen offset:3072 lds
    ds_read_b64_tr_b16 v[96:97], v11 offset:0
    ds_read_b64_tr_b16 v[98:99], v11 offset:2048
    ds_read_b64_tr_b16 v[168:169], v11 offset:8
    ds_read_b64_tr_b16 v[170:171], v11 offset:2056
    ds_read_b64_tr_b16 a[32:33], v11 offset:256
    ds_read_b64_tr_b16 a[34:35], v11 offset:2304
    ds_read_b64_tr_b16 a[104:105], v11 offset:264
    ds_read_b64_tr_b16 a[106:107], v11 offset:2312
    s_waitcnt vmcnt(12) lgkmcnt(0)
    s_barrier
    s_add_u32 m0, s44, 122880
    s_add_u32 s22, s42, 3407872
    buffer_load_dwordx4 v8, s[12:15], s22 offen offset:0 lds
    s_add_u32 s22, s42, 3423232
    buffer_load_dwordx4 v9, s[12:15], s22 offen offset:1024 lds
    s_add_u32 s22, s42, 3438592
    buffer_load_dwordx4 v8, s[12:15], s22 offen offset:2048 lds
    s_add_u32 s22, s42, 3453952
    buffer_load_dwordx4 v9, s[12:15], s22 offen offset:3072 lds
    ds_read_b64_tr_b16 v[100:101], v11 offset:16384
    ds_read_b64_tr_b16 v[102:103], v11 offset:18432
    ds_read_b64_tr_b16 v[172:173], v11 offset:16392
    ds_read_b64_tr_b16 v[174:175], v11 offset:18440
    ds_read_b64_tr_b16 a[36:37], v11 offset:16640
    ds_read_b64_tr_b16 a[38:39], v11 offset:18688
    ds_read_b64_tr_b16 a[108:109], v11 offset:16648
    ds_read_b64_tr_b16 a[110:111], v11 offset:18696
    s_waitcnt vmcnt(12) lgkmcnt(0)
    s_barrier
    s_add_u32 m0, s44, 139264
    s_add_u32 s22, s42, 3670016
    buffer_load_dwordx4 v8, s[12:15], s22 offen offset:0 lds
    s_add_u32 s22, s42, 3685376
    buffer_load_dwordx4 v9, s[12:15], s22 offen offset:1024 lds
    s_add_u32 s22, s42, 3700736
    buffer_load_dwordx4 v8, s[12:15], s22 offen offset:2048 lds
    s_add_u32 s22, s42, 3716096
    buffer_load_dwordx4 v9, s[12:15], s22 offen offset:3072 lds
    ds_read_b64_tr_b16 v[104:105], v10 offset:0
    ds_read_b64_tr_b16 v[106:107], v10 offset:2048
    ds_read_b64_tr_b16 v[176:177], v10 offset:8
    ds_read_b64_tr_b16 v[178:179], v10 offset:2056
    ds_read_b64_tr_b16 a[40:41], v10 offset:256
    ds_read_b64_tr_b16 a[42:43], v10 offset:2304
    ds_read_b64_tr_b16 a[112:113], v10 offset:264
    ds_read_b64_tr_b16 a[114:115], v10 offset:2312
    s_waitcnt vmcnt(12) lgkmcnt(0)
    s_barrier
    s_add_u32 m0, s44, 73728
    s_add_u32 s22, s42, 3932160
    buffer_load_dwordx4 v8, s[12:15], s22 offen offset:0 lds
    s_add_u32 s22, s42, 3947520
    buffer_load_dwordx4 v9, s[12:15], s22 offen offset:1024 lds
    s_add_u32 s22, s42, 3962880
    buffer_load_dwordx4 v8, s[12:15], s22 offen offset:2048 lds
    s_add_u32 s22, s42, 3978240
    buffer_load_dwordx4 v9, s[12:15], s22 offen offset:3072 lds
    ds_read_b64_tr_b16 v[108:109], v10 offset:16384
    ds_read_b64_tr_b16 v[110:111], v10 offset:18432
    ds_read_b64_tr_b16 v[180:181], v10 offset:16392
    ds_read_b64_tr_b16 v[182:183], v10 offset:18440
    ds_read_b64_tr_b16 a[44:45], v10 offset:16640
    ds_read_b64_tr_b16 a[46:47], v10 offset:18688
    ds_read_b64_tr_b16 a[116:117], v10 offset:16648
    ds_read_b64_tr_b16 a[118:119], v10 offset:18696
    s_waitcnt vmcnt(12) lgkmcnt(0)
    s_barrier
    s_add_u32 m0, s44, 90112
    s_add_u32 s22, s42, 4194304
    buffer_load_dwordx4 v8, s[12:15], s22 offen offset:0 lds
    s_add_u32 s22, s42, 4209664
    buffer_load_dwordx4 v9, s[12:15], s22 offen offset:1024 lds
    s_add_u32 s22, s42, 4225024
    buffer_load_dwordx4 v8, s[12:15], s22 offen offset:2048 lds
    s_add_u32 s22, s42, 4240384
    buffer_load_dwordx4 v9, s[12:15], s22 offen offset:3072 lds
    ds_read_b64_tr_b16 v[112:113], v10 offset:32768
    ds_read_b64_tr_b16 v[114:115], v10 offset:34816
    ds_read_b64_tr_b16 v[184:185], v10 offset:32776
    ds_read_b64_tr_b16 v[186:187], v10 offset:34824
    ds_read_b64_tr_b16 a[48:49], v10 offset:33024
    ds_read_b64_tr_b16 a[50:51], v10 offset:35072
    ds_read_b64_tr_b16 a[120:121], v10 offset:33032
    ds_read_b64_tr_b16 a[122:123], v10 offset:35080
    s_waitcnt vmcnt(12) lgkmcnt(0)
    s_barrier
    s_add_u32 m0, s44, 106496
    s_add_u32 s22, s42, 4456448
    buffer_load_dwordx4 v8, s[12:15], s22 offen offset:0 lds
    s_add_u32 s22, s42, 4471808
    buffer_load_dwordx4 v9, s[12:15], s22 offen offset:1024 lds
    s_add_u32 s22, s42, 4487168
    buffer_load_dwordx4 v8, s[12:15], s22 offen offset:2048 lds
    s_add_u32 s22, s42, 4502528
    buffer_load_dwordx4 v9, s[12:15], s22 offen offset:3072 lds
    ds_read_b64_tr_b16 v[116:117], v11 offset:0
    ds_read_b64_tr_b16 v[118:119], v11 offset:2048
    ds_read_b64_tr_b16 v[188:189], v11 offset:8
    ds_read_b64_tr_b16 v[190:191], v11 offset:2056
    ds_read_b64_tr_b16 a[52:53], v11 offset:256
    ds_read_b64_tr_b16 a[54:55], v11 offset:2304
    ds_read_b64_tr_b16 a[124:125], v11 offset:264
    ds_read_b64_tr_b16 a[126:127], v11 offset:2312
    s_waitcnt vmcnt(12) lgkmcnt(0)
    s_barrier
    s_mov_b32 s27, 36864
    s_add_u32 s23, s27, s25
    s_add_u32 m0, s23, 0
    s_nop 0
    buffer_load_dwordx4 v2, s[8:11], s24 offen offset:0 lds
    s_add_u32 m0, s23, 960
    s_nop 0
    buffer_load_dwordx4 v2, s[8:11], s24 offen offset:64 lds
    s_add_u32 m0, s23, 1920
    s_nop 0
    buffer_load_dwordx4 v2, s[8:11], s24 offen offset:128 lds
    s_add_u32 m0, s23, 2880
    s_nop 0
    buffer_load_dwordx4 v2, s[8:11], s24 offen offset:192 lds
    s_add_u32 m0, s23, 3840
    s_nop 0
    buffer_load_dwordx4 v2, s[8:11], s24 offen offset:256 lds
    s_add_u32 m0, s23, 4800
    s_nop 0
    buffer_load_dwordx4 v2, s[8:11], s24 offen offset:320 lds
    s_add_u32 m0, s23, 5760
    s_nop 0
    buffer_load_dwordx4 v2, s[8:11], s24 offen offset:384 lds
    s_add_u32 m0, s23, 6720
    s_nop 0
    buffer_load_dwordx4 v2, s[8:11], s24 offen offset:448 lds
    s_add_u32 m0, s23, 7680
    s_nop 0
    buffer_load_dwordx4 v2, s[8:11], s24 offen offset:512 lds
    s_add_u32 s24, s24, 147456
    ds_read_b64_tr_b16 v[120:121], v11 offset:16384
    ds_read_b64_tr_b16 v[122:123], v11 offset:18432
    ds_read_b64_tr_b16 v[192:193], v11 offset:16392
    ds_read_b64_tr_b16 v[194:195], v11 offset:18440
    ds_read_b64_tr_b16 a[56:57], v11 offset:16640
    ds_read_b64_tr_b16 a[58:59], v11 offset:18688
    ds_read_b64_tr_b16 a[128:129], v11 offset:16648
    ds_read_b64_tr_b16 a[130:131], v11 offset:18696
    s_waitcnt vmcnt(17) lgkmcnt(0)
    s_barrier
    ds_read_b64_tr_b16 v[124:125], v10 offset:0
    ds_read_b64_tr_b16 v[126:127], v10 offset:2048
    ds_read_b64_tr_b16 v[196:197], v10 offset:8
    ds_read_b64_tr_b16 v[198:199], v10 offset:2056
    ds_read_b64_tr_b16 a[60:61], v10 offset:256
    ds_read_b64_tr_b16 a[62:63], v10 offset:2304
    ds_read_b64_tr_b16 a[132:133], v10 offset:264
    ds_read_b64_tr_b16 a[134:135], v10 offset:2312
    s_waitcnt vmcnt(13) lgkmcnt(0)
    s_barrier
    ds_read_b64_tr_b16 v[128:129], v10 offset:16384
    ds_read_b64_tr_b16 v[130:131], v10 offset:18432
    ds_read_b64_tr_b16 v[200:201], v10 offset:16392
    ds_read_b64_tr_b16 v[202:203], v10 offset:18440
    ds_read_b64_tr_b16 a[64:65], v10 offset:16640
    ds_read_b64_tr_b16 a[66:67], v10 offset:18688
    ds_read_b64_tr_b16 a[136:137], v10 offset:16648
    ds_read_b64_tr_b16 a[138:139], v10 offset:18696
    s_waitcnt vmcnt(9) lgkmcnt(0)
    s_barrier
    ds_read_b64_tr_b16 v[132:133], v10 offset:32768
    ds_read_b64_tr_b16 v[134:135], v10 offset:34816
    ds_read_b64_tr_b16 v[204:205], v10 offset:32776
    ds_read_b64_tr_b16 v[206:207], v10 offset:34824
    ds_read_b64_tr_b16 a[68:69], v10 offset:33024
    ds_read_b64_tr_b16 a[70:71], v10 offset:35072
    ds_read_b64_tr_b16 a[140:141], v10 offset:33032
    ds_read_b64_tr_b16 a[142:143], v10 offset:35080
    s_mov_b32 s88, 4194304
gn8:
    buffer_load_dword v250, off, s[84:87], 0 offset:216 sc1
    s_waitcnt vmcnt(0)
    v_readfirstlane_b32 s95, v250
    s_sub_u32 s88, s88, 1
    s_cbranch_scc1 gn8x
    s_cmp_eq_u32 s95, 0
    s_cbranch_scc1 gn8
gn8x:
    s_waitcnt lgkmcnt(0)
    s_mov_b32 s45, 0
    s_mov_b32 s27, 0
    s_mov_b64 s[36:37], 0
    s_mov_b32 s12, 0
    s_mov_b32 s13, s40
    s_lshr_b32 s14, s41, 5
    s_add_u32 s15, s14, s40
    s_lshl_b32 s41, s41, 2
    s_sub_u32 s26, s26, s41
    v_mov_b32 v3, v1
    s_waitcnt vmcnt(0)
    s_barrier
    ds_read_b128 v[32:35], v3 offset:0
    ds_read_b128 v[36:39], v3 offset:18432
    ds_read_b128 v[40:43], v3 offset:1024
    ds_read_b128 v[44:47], v3 offset:19456
    s_cmp_eq_u32 s18, 0
    s_cselect_b32 s34, 1, 0
    s_mov_b32 s35, 0
    s_cmp_eq_u32 s16, 2
    s_cbranch_scc1 qk_vloop
qk_loop:
    s_barrier
    s_add_u32 s22, s27, 73728
    s_sub_u32 s21, s22, 110592
    s_cselect_b32 s22, s22, s21
    s_waitcnt lgkmcnt(2)
    v_mfma_f32_16x16x32_bf16 v[208:211], v[64:67], v[32:35], 0
    ds_read_b128 v[48:51], v3 offset:2048
    v_mfma_f32_16x16x32_bf16 v[212:215], v[136:139], v[32:35], 0
    ds_read_b128 v[52:55], v3 offset:20480
    v_mfma_f32_16x16x32_bf16 v[216:219], v[64:67], v[36:39], 0
    v_mfma_f32_16x16x32_bf16 v[220:223], v[136:139], v[36:39], 0
    v_mfma_f32_16x16x32_bf16 v[224:227], a[0:3], v[32:35], 0
    v_mfma_f32_16x16x32_bf16 v[228:231], a[72:75], v[32:35], 0
    v_mfma_f32_16x16x32_bf16 v[232:235], a[0:3], v[36:39], 0
    v_mfma_f32_16x16x32_bf16 v[236:239], a[72:75], v[36:39], 0
    s_waitcnt lgkmcnt(2)
    v_mfma_f32_16x16x32_bf16 v[208:211], v[68:71], v[40:43], v[208:211]
    ds_read_b128 v[32:35], v3 offset:3072
    v_mfma_f32_16x16x32_bf16 v[212:215], v[140:143], v[40:43], v[212:215]
    ds_read_b128 v[36:39], v3 offset:21504
    v_mfma_f32_16x16x32_bf16 v[216:219], v[68:71], v[44:47], v[216:219]
    s_add_u32 s23, s22, s25
    s_add_u32 m0, s23, 0
    s_nop 0
    buffer_load_dwordx4 v2, s[8:11], s24 offen offset:0 lds
    v_mfma_f32_16x16x32_bf16 v[220:223], v[140:143], v[44:47], v[220:223]
    v_mfma_f32_16x16x32_bf16 v[224:227], a[4:7], v[40:43], v[224:227]
    v_mfma_f32_16x16x32_bf16 v[228:231], a[76:79], v[40:43], v[228:231]
    v_mfma_f32_16x16x32_bf16 v[232:235], a[4:7], v[44:47], v[232:235]
    s_add_u32 m0, s23, 960
    s_nop 0
    buffer_load_dwordx4 v2, s[8:11], s24 offen offset:64 lds
    v_mfma_f32_16x16x32_bf16 v[236:239], a[76:79], v[44:47], v[236:239]
    s_waitcnt lgkmcnt(2)
    v_mfma_f32_16x16x32_bf16 v[208:211], v[72:75], v[48:51], v[208:211]
    ds_read_b128 v[40:43], v3 offset:4096
    v_mfma_f32_16x16x32_bf16 v[212:215], v[144:147], v[48:51], v[212:215]
    ds_read_b128 v[44:47], v3 offset:22528
    v_mfma_f32_16x16x32_bf16 v[216:219], v[72:75], v[52:55], v[216:219]
    s_add_u32 m0, s23, 1920
    s_nop 0
    buffer_load_dwordx4 v2, s[8:11], s24 offen offset:128 lds
    v_mfma_f32_16x16x32_bf16 v[220:223], v[144:147], v[52:55], v[220:223]
    v_mfma_f32_16x16x32_bf16 v[224:227], a[8:11], v[48:51], v[224:227]
    v_mfma_f32_16x16x32_bf16 v[228:231], a[80:83], v[48:51], v[228:231]
    v_mfma_f32_16x16x32_bf16 v[232:235], a[8:11], v[52:55], v[232:235]
    s_add_u32 m0, s23, 2880
    s_nop 0
    buffer_load_dwordx4 v2, s[8:11], s24 offen offset:192 lds
    v_mfma_f32_16x16x32_bf16 v[236:239], a[80:83], v[52:55], v[236:239]
    s_waitcnt lgkmcnt(2)
    v_mfma_f32_16x16x32_bf16 v[208:211], v[76:79], v[32:35], v[208:211]
    ds_read_b128 v[48:51], v3 offset:5120
    v_mfma_f32_16x16x32_bf16 v[212:215], v[148:151], v[32:35], v[212:215]
    ds_read_b128 v[52:55], v3 offset:23552
    v_mfma_f32_16x16x32_bf16 v[216:219], v[76:79], v[36:39], v[216:219]
    s_add_u32 m0, s23, 3840
    s_nop 0
    buffer_load_dwordx4 v2, s[8:11], s24 offen offset:256 lds
    v_mfma_f32_16x16x32_bf16 v[220:223], v[148:151], v[36:39], v[220:223]
    v_mfma_f32_16x16x32_bf16 v[224:227], a[12:15], v[32:35], v[224:227]
    v_mfma_f32_16x16x32_bf16 v[228:231], a[84:87], v[32:35], v[228:231]
    v_mfma_f32_16x16x32_bf16 v[232:235], a[12:15], v[36:39], v[232:235]
    s_add_u32 m0, s23, 4800
    s_nop 0
    buffer_load_dwordx4 v2, s[8:11], s24 offen offset:320 lds
    v_mfma_f32_16x16x32_bf16 v[236:239], a[84:87], v[36:39], v[236:239]
    s_waitcnt lgkmcnt(2)
    v_mfma_f32_16x16x32_bf16 v[208:211], v[80:83], v[40:43], v[208:211]
    ds_read_b128 v[32:35], v3 offset:6144
    v_mfma_f32_16x16x32_bf16 v[212:215], v[152:155], v[40:43], v[212:215]
    ds_read_b128 v[36:39], v3 offset:24576
    v_mfma_f32_16x16x32_bf16 v[216:219], v[80:83], v[44:47], v[216:219]
    s_add_u32 m0, s23, 5760
    s_nop 0
    buffer_load_dwordx4 v2, s[8:11], s24 offen offset:384 lds
    v_mfma_f32_16x16x32_bf16 v[220:223], v[152:155], v[44:47], v[220:223]
    v_mfma_f32_16x16x32_bf16 v[224:227], a[16:19], v[40:43], v[224:227]
    v_mfma_f32_16x16x32_bf16 v[228:231], a[88:91], v[40:43], v[228:231]
    v_mfma_f32_16x16x32_bf16 v[232:235], a[16:19], v[44:47], v[232:235]
    s_add_u32 m0, s23, 6720
    s_nop 0
    buffer_load_dwordx4 v2, s[8:11], s24 offen offset:448 lds
    v_mfma_f32_16x16x32_bf16 v[236:239], a[88:91], v[44:47], v[236:239]
    s_waitcnt lgkmcnt(2)
    v_mfma_f32_16x16x32_bf16 v[208:211], v[84:87], v[48:51], v[208:211]
    ds_read_b128 v[40:43], v3 offset:7168
    v_mfma_f32_16x16x32_bf16 v[212:215], v[156:159], v[48:51], v[212:215]
    ds_read_b128 v[44:47], v3 offset:25600
    v_mfma_f32_16x16x32_bf16 v[216:219], v[84:87], v[52:55], v[216:219]
    s_add_u32 m0, s23, 7680
    s_nop 0
    buffer_load_dwordx4 v2, s[8:11], s24 offen offset:512 lds
    s_add_u32 s24, s24, 147456
    v_mfma_f32_16x16x32_bf16 v[220:223], v[156:159], v[52:55], v[220:223]
    v_mfma_f32_16x16x32_bf16 v[224:227], a[20:23], v[48:51], v[224:227]
    v_mfma_f32_16x16x32_bf16 v[228:231], a[92:95], v[48:51], v[228:231]
    v_mfma_f32_16x16x32_bf16 v[232:235], a[20:23], v[52:55], v[232:235]
    v_mfma_f32_16x16x32_bf16 v[236:239], a[92:95], v[52:55], v[236:239]
    s_waitcnt lgkmcnt(2)
    v_mfma_f32_16x16x32_bf16 v[208:211], v[88:91], v[32:35], v[208:211]
    ds_read_b128 v[48:51], v3 offset:8192
    v_mfma_f32_16x16x32_bf16 v[212:215], v[160:163], v[32:35], v[212:215]
    ds_read_b128 v[52:55], v3 offset:26624
    v_mfma_f32_16x16x32_bf16 v[216:219], v[88:91], v[36:39], v[216:219]
    v_mfma_f32_16x16x32_bf16 v[220:223], v[160:163], v[36:39], v[220:223]
    v_mfma_f32_16x16x32_bf16 v[224:227], a[24:27], v[32:35], v[224:227]
    v_mfma_f32_16x16x32_bf16 v[228:231], a[96:99], v[32:35], v[228:231]
    v_mfma_f32_16x16x32_bf16 v[232:235], a[24:27], v[36:39], v[232:235]
    v_mfma_f32_16x16x32_bf16 v[236:239], a[96:99], v[36:39], v[236:239]
    s_waitcnt lgkmcnt(2)
    v_mfma_f32_16x16x32_bf16 v[208:211], v[92:95], v[40:43], v[208:211]
    ds_read_b128 v[32:35], v3 offset:9216
    v_mfma_f32_16x16x32_bf16 v[212:215], v[164:167], v[40:43], v[212:215]
    ds_read_b128 v[36:39], v3 offset:27648
    v_mfma_f32_16x16x32_bf16 v[216:219], v[92:95], v[44:47], v[216:219]
    s_add_u32 s23, s45, s95
    v_mov_b32 v4, s23
    s_mov_b64 exec, s[34:35]
    buffer_store_dword v4, off, s[4:7], s29 sc1
    buffer_store_dword v4, off, s[4:7], s29 offset:128 sc1
    s_mov_b64 exec, -1
    v_mfma_f32_16x16x32_bf16 v[220:223], v[164:167], v[44:47], v[220:223]
    v_mfma_f32_16x16x32_bf16 v[224:227], a[28:31], v[40:43], v[224:227]
    v_mfma_f32_16x16x32_bf16 v[228:231], a[100:103], v[40:43], v[228:231]
    v_mfma_f32_16x16x32_bf16 v[232:235], a[28:31], v[44:47], v[232:235]
    v_mfma_f32_16x16x32_bf16 v[236:239], a[100:103], v[44:47], v[236:239]
    s_waitcnt lgkmcnt(2)
    v_mfma_f32_16x16x32_bf16 v[208:211], v[96:99], v[48:51], v[208:211]
    ds_read_b128 v[40:43], v3 offset:10240
    v_mfma_f32_16x16x32_bf16 v[212:215], v[168:171], v[48:51], v[212:215]
    ds_read_b128 v[44:47], v3 offset:28672
    v_mfma_f32_16x16x32_bf16 v[216:219], v[96:99], v[52:55], v[216:219]
    s_cmp_lt_u32 s19, 60
    s_cbranch_scc1 lt9
    buffer_load_dwordx4 v[244:247], off, s[84:87], 0 offset:16 sc1
    buffer_load_dword v248, off, s[84:87], 0 offset:4 sc1
lt9:
    v_mfma_f32_16x16x32_bf16 v[220:223], v[168:171], v[52:55], v[220:223]
    v_mfma_f32_16x16x32_bf16 v[224:227], a[32:35], v[48:51], v[224:227]
    v_mfma_f32_16x16x32_bf16 v[228:231], a[104:107], v[48:51], v[228:231]
    v_mfma_f32_16x16x32_bf16 v[232:235], a[32:35], v[52:55], v[232:235]
    v_mfma_f32_16x16x32_bf16 v[236:239], a[104:107], v[52:55], v[236:239]
    s_waitcnt lgkmcnt(2)
    v_mfma_f32_16x16x32_bf16 v[208:211], v[100:103], v[32:35], v[208:211]
    ds_read_b128 v[48:51], v3 offset:11264
    v_mfma_f32_16x16x32_bf16 v[212:215], v[172:175], v[32:35], v[212:215]
    ds_read_b128 v[52:55], v3 offset:29696
    v_mfma_f32_16x16x32_bf16 v[216:219], v[100:103], v[36:39], v[216:219]
    v_mfma_f32_16x16x32_bf16 v[220:223], v[172:175], v[36:39], v[220:223]
    v_mfma_f32_16x16x32_bf16 v[224:227], a[36:39], v[32:35], v[224:227]
    v_mfma_f32_16x16x32_bf16 v[228:231], a[108:111], v[32:35], v[228:231]
    v_mfma_f32_16x16x32_bf16 v[232:235], a[36:39], v[36:39], v[232:235]
    v_mfma_f32_16x16x32_bf16 v[236:239], a[108:111], v[36:39], v[236:239]
    s_waitcnt lgkmcnt(2)
    v_mfma_f32_16x16x32_bf16 v[208:211], v[104:107], v[40:43], v[208:211]
    ds_read_b128 v[32:35], v3 offset:12288
    v_mfma_f32_16x16x32_bf16 v[212:215], v[176:179], v[40:43], v[212:215]
    ds_read_b128 v[36:39], v3 offset:30720
    v_mfma_f32_16x16x32_bf16 v[216:219], v[104:107], v[44:47], v[216:219]
    v_mfma_f32_16x16x32_bf16 v[220:223], v[176:179], v[44:47], v[220:223]
    v_mfma_f32_16x16x32_bf16 v[224:227], a[40:43], v[40:43], v[224:227]
    v_mfma_f32_16x16x32_bf16 v[228:231], a[112:115], v[40:43], v[228:231]
    v_mfma_f32_16x16x32_bf16 v[232:235], a[40:43], v[44:47], v[232:235]
    v_mfma_f32_16x16x32_bf16 v[236:239], a[112:115], v[44:47], v[236:239]
    s_waitcnt lgkmcnt(2)
    v_mfma_f32_16x16x32_bf16 v[208:211], v[108:111], v[48:51], v[208:211]
    ds_read_b128 v[40:43], v3 offset:13312
    v_mfma_f32_16x16x32_bf16 v[212:215], v[180:183], v[48:51], v[212:215]
    ds_read_b128 v[44:47], v3 offset:31744
    v_mfma_f32_16x16x32_bf16 v[216:219], v[108:111], v[52:55], v[216:219]
    v_mfma_f32_16x16x32_bf16 v[220:223], v[180:183], v[52:55], v[220:223]
    v_mfma_f32_16x16x32_bf16 v[224:227], a[44:47], v[48:51], v[224:227]
    v_mfma_f32_16x16x32_bf16 v[228:231], a[116:119], v[48:51], v[228:231]
    v_mfma_f32_16x16x32_bf16 v[232:235], a[44:47], v[52:55], v[232:235]
    v_mfma_f32_16x16x32_bf16 v[236:239], a[116:119], v[52:55], v[236:239]
    s_waitcnt lgkmcnt(2)
    v_mfma_f32_16x16x32_bf16 v[208:211], v[112:115], v[32:35], v[208:211]
    ds_read_b128 v[48:51], v3 offset:14336
    v_mfma_f32_16x16x32_bf16 v[212:215], v[184:187], v[32:35], v[212:215]
    ds_read_b128 v[52:55], v3 offset:32768
    v_mfma_f32_16x16x32_bf16 v[216:219], v[112:115], v[36:39], v[216:219]
    v_mfma_f32_16x16x32_bf16 v[220:223], v[184:187], v[36:39], v[220:223]
    v_mfma_f32_16x16x32_bf16 v[224:227], a[48:51], v[32:35], v[224:227]
    v_mfma_f32_16x16x32_bf16 v[228:231], a[120:123], v[32:35], v[228:231]
    v_mfma_f32_16x16x32_bf16 v[232:235], a[48:51], v[36:39], v[232:235]
    v_mfma_f32_16x16x32_bf16 v[236:239], a[120:123], v[36:39], v[236:239]
    s_waitcnt lgkmcnt(2)
    v_mfma_f32_16x16x32_bf16 v[208:211], v[116:119], v[40:43], v[208:211]
    ds_read_b128 v[32:35], v3 offset:15360
    v_mfma_f32_16x16x32_bf16 v[212:215], v[188:191], v[40:43], v[212:215]
    ds_read_b128 v[36:39], v3 offset:33792
    v_mfma_f32_16x16x32_bf16 v[216:219], v[116:119], v[44:47], v[216:219]
    v_mfma_f32_16x16x32_bf16 v[220:223], v[188:191], v[44:47], v[220:223]
    v_mfma_f32_16x16x32_bf16 v[224:227], a[52:55], v[40:43], v[224:227]
    v_mfma_f32_16x16x32_bf16 v[228:231], a[124:127], v[40:43], v[228:231]
    v_mfma_f32_16x16x32_bf16 v[232:235], a[52:55], v[44:47], v[232:235]
    v_mfma_f32_16x16x32_bf16 v[236:239], a[124:127], v[44:47], v[236:239]
    s_waitcnt lgkmcnt(2)
    v_mfma_f32_16x16x32_bf16 v[208:211], v[120:123], v[48:51], v[208:211]
    ds_read_b128 v[40:43], v3 offset:16384
    v_mfma_f32_16x16x32_bf16 v[212:215], v[192:195], v[48:51], v[212:215]
    ds_read_b128 v[44:47], v3 offset:34816
    v_mfma_f32_16x16x32_bf16 v[216:219], v[120:123], v[52:55], v[216:219]
    v_mfma_f32_16x16x32_bf16 v[220:223], v[192:195], v[52:55], v[220:223]
    v_mfma_f32_16x16x32_bf16 v[224:227], a[56:59], v[48:51], v[224:227]
    v_mfma_f32_16x16x32_bf16 v[228:231], a[128:131], v[48:51], v[228:231]
    v_mfma_f32_16x16x32_bf16 v[232:235], a[56:59], v[52:55], v[232:235]
    v_mfma_f32_16x16x32_bf16 v[236:239], a[128:131], v[52:55], v[236:239]
    s_waitcnt lgkmcnt(2)
    v_mfma_f32_16x16x32_bf16 v[208:211], v[124:127], v[32:35], v[208:211]
    ds_read_b128 v[48:51], v3 offset:17408
    v_mfma_f32_16x16x32_bf16 v[212:215], v[196:199], v[32:35], v[212:215]
    ds_read_b128 v[52:55], v3 offset:35840
    v_mfma_f32_16x16x32_bf16 v[216:219], v[124:127], v[36:39], v[216:219]
    v_mfma_f32_16x16x32_bf16 v[220:223], v[196:199], v[36:39], v[220:223]
    v_mfma_f32_16x16x32_bf16 v[224:227], a[60:63], v[32:35], v[224:227]
    s_add_u32 s27, s27, 36864
    s_cmp_eq_u32 s27, 110592
    s_cselect_b32 s27, 0, s27
    v_add_u32 v3, s27, v1
    v_mfma_f32_16x16x32_bf16 v[228:231], a[132:135], v[32:35], v[228:231]
    v_mfma_f32_16x16x32_bf16 v[232:235], a[60:63], v[36:39], v[232:235]
    v_mfma_f32_16x16x32_bf16 v[236:239], a[132:135], v[36:39], v[236:239]
    s_waitcnt lgkmcnt(2)
    v_mfma_f32_16x16x32_bf16 v[208:211], v[128:131], v[40:43], v[208:211]
    ds_read_b128 v[32:35], v3 offset:0
    v_mfma_f32_16x16x32_bf16 v[212:215], v[200:203], v[40:43], v[212:215]
    ds_read_b128 v[36:39], v3 offset:18432
    v_mfma_f32_16x16x32_bf16 v[216:219], v[128:131], v[44:47], v[216:219]
    v_mfma_f32_16x16x32_bf16 v[220:223], v[200:203], v[44:47], v[220:223]
    v_mfma_f32_16x16x32_bf16 v[224:227], a[64:67], v[40:43], v[224:227]
    v_mfma_f32_16x16x32_bf16 v[228:231], a[136:139], v[40:43], v[228:231]
    v_mfma_f32_16x16x32_bf16 v[232:235], a[64:67], v[44:47], v[232:235]
    v_mfma_f32_16x16x32_bf16 v[236:239], a[136:139], v[44:47], v[236:239]
    s_waitcnt lgkmcnt(2)
    v_mfma_f32_16x16x32_bf16 v[208:211], v[132:135], v[48:51], v[208:211]
    ds_read_b128 v[40:43], v3 offset:1024
    v_mfma_f32_16x16x32_bf16 v[212:215], v[204:207], v[48:51], v[212:215]
    ds_read_b128 v[44:47], v3 offset:19456
    v_mfma_f32_16x16x32_bf16 v[216:219], v[132:135], v[52:55], v[216:219]
    v_mfma_f32_16x16x32_bf16 v[220:223], v[204:207], v[52:55], v[220:223]
    v_mfma_f32_16x16x32_bf16 v[224:227], a[68:71], v[48:51], v[224:227]
    v_mfma_f32_16x16x32_bf16 v[228:231], a[140:143], v[48:51], v[228:231]
    v_mfma_f32_16x16x32_bf16 v[232:235], a[68:71], v[52:55], v[232:235]
    v_mfma_f32_16x16x32_bf16 v[236:239], a[140:143], v[52:55], v[236:239]
    s_add_u32 s26, s26, s41
    s_waitcnt vmcnt(0)
    v_cvt_pk_bf16_f32 v8, v208, v209
    v_cvt_pk_bf16_f32 v9, v210, v211
    v_cvt_pk_bf16_f32 v10, v212, v213
    v_cvt_pk_bf16_f32 v11, v214, v215
    v_cvt_pk_bf16_f32 v12, v216, v217
    v_cvt_pk_bf16_f32 v13, v218, v219
    v_cvt_pk_bf16_f32 v14, v220, v221
    v_cvt_pk_bf16_f32 v15, v222, v223
    v_cvt_pk_bf16_f32 v16, v224, v225
    v_cvt_pk_bf16_f32 v17, v226, v227
    v_cvt_pk_bf16_f32 v18, v228, v229
    v_cvt_pk_bf16_f32 v19, v230, v231
    v_cvt_pk_bf16_f32 v20, v232, v233
    v_cvt_pk_bf16_f32 v21, v234, v235
    v_cvt_pk_bf16_f32 v22, v236, v237
    v_cvt_pk_bf16_f32 v23, v238, v239
    s_mov_b64 s[36:37], -1
    s_add_u32 s28, s26, s12
    buffer_store_dwordx4 v[8:11], v7, s[4:7], s28 offen sc1
    s_add_u32 s28, s26, s13
    buffer_store_dwordx4 v[12:15], v7, s[4:7], s28 offen sc1
    s_add_u32 s28, s26, s14
    buffer_store_dwordx4 v[16:19], v7, s[4:7], s28 offen sc1
    s_add_u32 s28, s26, s15
    buffer_store_dwordx4 v[20:23], v7, s[4:7], s28 offen sc1
    s_lshr_b32 s45, s19, 2
    s_cbranch_scc1 qk_loop_nf
    s_mov_b32 s45, 1
    s_mov_b64 s[36:37], 0
    s_waitcnt vmcnt(0)
    s_barrier
    s_add_u32 s23, s45, s95
    v_mov_b32 v4, s23
    s_mov_b64 exec, s[34:35]
    buffer_store_dword v4, off, s[4:7], s29 sc1
    buffer_store_dword v4, off, s[4:7], s29 offset:128 sc1
    s_mov_b64 exec, -1
qk_loop_nf:
    s_add_u32 s19, s19, 4
    s_cmp_lt_u32 s19, s20
    s_cbranch_scc1 qk_loop
    s_branch qk_done
qk_vloop:
    s_barrier
    s_add_u32 s22, s27, 73728
    s_sub_u32 s21, s22, 110592
    s_cselect_b32 s22, s22, s21
    s_waitcnt lgkmcnt(2)
    v_mfma_f32_16x16x32_bf16 v[208:211], v[32:35], v[64:67], 0
    ds_read_b128 v[48:51], v3 offset:2048
    v_mfma_f32_16x16x32_bf16 v[212:215], v[32:35], v[136:139], 0
    ds_read_b128 v[52:55], v3 offset:20480
    v_mfma_f32_16x16x32_bf16 v[216:219], v[36:39], v[64:67], 0
    v_mfma_f32_16x16x32_bf16 v[220:223], v[36:39], v[136:139], 0
    v_mfma_f32_16x16x32_bf16 v[224:227], v[32:35], a[0:3], 0
    v_mfma_f32_16x16x32_bf16 v[228:231], v[32:35], a[72:75], 0
    v_mfma_f32_16x16x32_bf16 v[232:235], v[36:39], a[0:3], 0
    v_mfma_f32_16x16x32_bf16 v[236:239], v[36:39], a[72:75], 0
    s_waitcnt lgkmcnt(2)
    v_mfma_f32_16x16x32_bf16 v[208:211], v[40:43], v[68:71], v[208:211]
    ds_read_b128 v[32:35], v3 offset:3072
    v_mfma_f32_16x16x32_bf16 v[212:215], v[40:43], v[140:143], v[212:215]
    ds_read_b128 v[36:39], v3 offset:21504
    v_mfma_f32_16x16x32_bf16 v[216:219], v[44:47], v[68:71], v[216:219]
    s_add_u32 s23, s22, s25
    s_add_u32 m0, s23, 0
    s_nop 0
    buffer_load_dwordx4 v2, s[8:11], s24 offen offset:0 lds
    v_mfma_f32_16x16x32_bf16 v[220:223], v[44:47], v[140:143], v[220:223]
    v_mfma_f32_16x16x32_bf16 v[224:227], v[40:43], a[4:7], v[224:227]
    v_mfma_f32_16x16x32_bf16 v[228:231], v[40:43], a[76:79], v[228:231]
    v_mfma_f32_16x16x32_bf16 v[232:235], v[44:47], a[4:7], v[232:235]
    s_add_u32 m0, s23, 960
    s_nop 0
    buffer_load_dwordx4 v2, s[8:11], s24 offen offset:64 lds
    v_mfma_f32_16x16x32_bf16 v[236:239], v[44:47], a[76:79], v[236:239]
    s_waitcnt lgkmcnt(2)
    v_mfma_f32_16x16x32_bf16 v[208:211], v[48:51], v[72:75], v[208:211]
    ds_read_b128 v[40:43], v3 offset:4096
    v_mfma_f32_16x16x32_bf16 v[212:215], v[48:51], v[144:147], v[212:215]
    ds_read_b128 v[44:47], v3 offset:22528
    v_mfma_f32_16x16x32_bf16 v[216:219], v[52:55], v[72:75], v[216:219]
    s_add_u32 m0, s23, 1920
    s_nop 0
    buffer_load_dwordx4 v2, s[8:11], s24 offen offset:128 lds
    v_mfma_f32_16x16x32_bf16 v[220:223], v[52:55], v[144:147], v[220:223]
    v_mfma_f32_16x16x32_bf16 v[224:227], v[48:51], a[8:11], v[224:227]
    v_mfma_f32_16x16x32_bf16 v[228:231], v[48:51], a[80:83], v[228:231]
    v_mfma_f32_16x16x32_bf16 v[232:235], v[52:55], a[8:11], v[232:235]
    s_add_u32 m0, s23, 2880
    s_nop 0
    buffer_load_dwordx4 v2, s[8:11], s24 offen offset:192 lds
    v_mfma_f32_16x16x32_bf16 v[236:239], v[52:55], a[80:83], v[236:239]
    s_waitcnt lgkmcnt(2)
    v_mfma_f32_16x16x32_bf16 v[208:211], v[32:35], v[76:79], v[208:211]
    ds_read_b128 v[48:51], v3 offset:5120
    v_mfma_f32_16x16x32_bf16 v[212:215], v[32:35], v[148:151], v[212:215]
    ds_read_b128 v[52:55], v3 offset:23552
    v_mfma_f32_16x16x32_bf16 v[216:219], v[36:39], v[76:79], v[216:219]
    s_add_u32 m0, s23, 3840
    s_nop 0
    buffer_load_dwordx4 v2, s[8:11], s24 offen offset:256 lds
    v_mfma_f32_16x16x32_bf16 v[220:223], v[36:39], v[148:151], v[220:223]
    v_mfma_f32_16x16x32_bf16 v[224:227], v[32:35], a[12:15], v[224:227]
    v_mfma_f32_16x16x32_bf16 v[228:231], v[32:35], a[84:87], v[228:231]
    v_mfma_f32_16x16x32_bf16 v[232:235], v[36:39], a[12:15], v[232:235]
    s_add_u32 m0, s23, 4800
    s_nop 0
    buffer_load_dwordx4 v2, s[8:11], s24 offen offset:320 lds
    v_mfma_f32_16x16x32_bf16 v[236:239], v[36:39], a[84:87], v[236:239]
    s_waitcnt lgkmcnt(2)
    v_mfma_f32_16x16x32_bf16 v[208:211], v[40:43], v[80:83], v[208:211]
    ds_read_b128 v[32:35], v3 offset:6144
    v_mfma_f32_16x16x32_bf16 v[212:215], v[40:43], v[152:155], v[212:215]
    ds_read_b128 v[36:39], v3 offset:24576
    v_mfma_f32_16x16x32_bf16 v[216:219], v[44:47], v[80:83], v[216:219]
    s_add_u32 m0, s23, 5760
    s_nop 0
    buffer_load_dwordx4 v2, s[8:11], s24 offen offset:384 lds
    v_mfma_f32_16x16x32_bf16 v[220:223], v[44:47], v[152:155], v[220:223]
    v_mfma_f32_16x16x32_bf16 v[224:227], v[40:43], a[16:19], v[224:227]
    v_mfma_f32_16x16x32_bf16 v[228:231], v[40:43], a[88:91], v[228:231]
    v_mfma_f32_16x16x32_bf16 v[232:235], v[44:47], a[16:19], v[232:235]
    s_add_u32 m0, s23, 6720
    s_nop 0
    buffer_load_dwordx4 v2, s[8:11], s24 offen offset:448 lds
    v_mfma_f32_16x16x32_bf16 v[236:239], v[44:47], a[88:91], v[236:239]
    s_waitcnt lgkmcnt(2)
    v_mfma_f32_16x16x32_bf16 v[208:211], v[48:51], v[84:87], v[208:211]
    ds_read_b128 v[40:43], v3 offset:7168
    v_mfma_f32_16x16x32_bf16 v[212:215], v[48:51], v[156:159], v[212:215]
    ds_read_b128 v[44:47], v3 offset:25600
    v_mfma_f32_16x16x32_bf16 v[216:219], v[52:55], v[84:87], v[216:219]
    s_add_u32 m0, s23, 7680
    s_nop 0
    buffer_load_dwordx4 v2, s[8:11], s24 offen offset:512 lds
    s_add_u32 s24, s24, 147456
    v_mfma_f32_16x16x32_bf16 v[220:223], v[52:55], v[156:159], v[220:223]
    v_mfma_f32_16x16x32_bf16 v[224:227], v[48:51], a[20:23], v[224:227]
    v_mfma_f32_16x16x32_bf16 v[228:231], v[48:51], a[92:95], v[228:231]
    v_mfma_f32_16x16x32_bf16 v[232:235], v[52:55], a[20:23], v[232:235]
    v_mfma_f32_16x16x32_bf16 v[236:239], v[52:55], a[92:95], v[236:239]
    s_waitcnt lgkmcnt(2)
    v_mfma_f32_16x16x32_bf16 v[208:211], v[32:35], v[88:91], v[208:211]
    ds_read_b128 v[48:51], v3 offset:8192
    v_mfma_f32_16x16x32_bf16 v[212:215], v[32:35], v[160:163], v[212:215]
    ds_read_b128 v[52:55], v3 offset:26624
    v_mfma_f32_16x16x32_bf16 v[216:219], v[36:39], v[88:91], v[216:219]
    v_mfma_f32_16x16x32_bf16 v[220:223], v[36:39], v[160:163], v[220:223]
    v_mfma_f32_16x16x32_bf16 v[224:227], v[32:35], a[24:27], v[224:227]
    v_mfma_f32_16x16x32_bf16 v[228:231], v[32:35], a[96:99], v[228:231]
    v_mfma_f32_16x16x32_bf16 v[232:235], v[36:39], a[24:27], v[232:235]
    v_mfma_f32_16x16x32_bf16 v[236:239], v[36:39], a[96:99], v[236:239]
    s_waitcnt lgkmcnt(2)
    v_mfma_f32_16x16x32_bf16 v[208:211], v[40:43], v[92:95], v[208:211]
    ds_read_b128 v[32:35], v3 offset:9216
    v_mfma_f32_16x16x32_bf16 v[212:215], v[40:43], v[164:167], v[212:215]
    ds_read_b128 v[36:39], v3 offset:27648
    v_mfma_f32_16x16x32_bf16 v[216:219], v[44:47], v[92:95], v[216:219]
    s_add_u32 s23, s45, s95
    v_mov_b32 v4, s23
    s_mov_b64 exec, s[34:35]
    buffer_store_dword v4, off, s[4:7], s29 sc1
    buffer_store_dword v4, off, s[4:7], s29 offset:128 sc1
    s_mov_b64 exec, -1
    v_mfma_f32_16x16x32_bf16 v[220:223], v[44:47], v[164:167], v[220:223]
    v_mfma_f32_16x16x32_bf16 v[224:227], v[40:43], a[28:31], v[224:227]
    v_mfma_f32_16x16x32_bf16 v[228:231], v[40:43], a[100:103], v[228:231]
    v_mfma_f32_16x16x32_bf16 v[232:235], v[44:47], a[28:31], v[232:235]
    v_mfma_f32_16x16x32_bf16 v[236:239], v[44:47], a[100:103], v[236:239]
    s_waitcnt lgkmcnt(2)
    v_mfma_f32_16x16x32_bf16 v[208:211], v[48:51], v[96:99], v[208:211]
    ds_read_b128 v[40:43], v3 offset:10240
    v_mfma_f32_16x16x32_bf16 v[212:215], v[48:51], v[168:171], v[212:215]
    ds_read_b128 v[44:47], v3 offset:28672
    v_mfma_f32_16x16x32_bf16 v[216:219], v[52:55], v[96:99], v[216:219]
    s_cmp_lt_u32 s19, 60
    s_cbranch_scc1 lt10
    buffer_load_dwordx4 v[244:247], off, s[84:87], 0 offset:16 sc1
    buffer_load_dword v248, off, s[84:87], 0 offset:4 sc1
lt10:
    v_mfma_f32_16x16x32_bf16 v[220:223], v[52:55], v[168:171], v[220:223]
    v_mfma_f32_16x16x32_bf16 v[224:227], v[48:51], a[32:35], v[224:227]
    v_mfma_f32_16x16x32_bf16 v[228:231], v[48:51], a[104:107], v[228:231]
    v_mfma_f32_16x16x32_bf16 v[232:235], v[52:55], a[32:35], v[232:235]
    v_mfma_f32_16x16x32_bf16 v[236:239], v[52:55], a[104:107], v[236:239]
    s_waitcnt lgkmcnt(2)
    v_mfma_f32_16x16x32_bf16 v[208:211], v[32:35], v[100:103], v[208:211]
    ds_read_b128 v[48:51], v3 offset:11264
    v_mfma_f32_16x16x32_bf16 v[212:215], v[32:35], v[172:175], v[212:215]
    ds_read_b128 v[52:55], v3 offset:29696
    v_mfma_f32_16x16x32_bf16 v[216:219], v[36:39], v[100:103], v[216:219]
    v_mfma_f32_16x16x32_bf16 v[220:223], v[36:39], v[172:175], v[220:223]
    v_mfma_f32_16x16x32_bf16 v[224:227], v[32:35], a[36:39], v[224:227]
    v_mfma_f32_16x16x32_bf16 v[228:231], v[32:35], a[108:111], v[228:231]
    v_mfma_f32_16x16x32_bf16 v[232:235], v[36:39], a[36:39], v[232:235]
    v_mfma_f32_16x16x32_bf16 v[236:239], v[36:39], a[108:111], v[236:239]
    s_waitcnt lgkmcnt(2)
    v_mfma_f32_16x16x32_bf16 v[208:211], v[40:43], v[104:107], v[208:211]
    ds_read_b128 v[32:35], v3 offset:12288
    v_mfma_f32_16x16x32_bf16 v[212:215], v[40:43], v[176:179], v[212:215]
    ds_read_b128 v[36:39], v3 offset:30720
    v_mfma_f32_16x16x32_bf16 v[216:219], v[44:47], v[104:107], v[216:219]
    v_mfma_f32_16x16x32_bf16 v[220:223], v[44:47], v[176:179], v[220:223]
    v_mfma_f32_16x16x32_bf16 v[224:227], v[40:43], a[40:43], v[224:227]
    v_mfma_f32_16x16x32_bf16 v[228:231], v[40:43], a[112:115], v[228:231]
    v_mfma_f32_16x16x32_bf16 v[232:235], v[44:47], a[40:43], v[232:235]
    v_mfma_f32_16x16x32_bf16 v[236:239], v[44:47], a[112:115], v[236:239]
    s_waitcnt lgkmcnt(2)
    v_mfma_f32_16x16x32_bf16 v[208:211], v[48:51], v[108:111], v[208:211]
    ds_read_b128 v[40:43], v3 offset:13312
    v_mfma_f32_16x16x32_bf16 v[212:215], v[48:51], v[180:183], v[212:215]
    ds_read_b128 v[44:47], v3 offset:31744
    v_mfma_f32_16x16x32_bf16 v[216:219], v[52:55], v[108:111], v[216:219]
    v_mfma_f32_16x16x32_bf16 v[220:223], v[52:55], v[180:183], v[220:223]
    v_mfma_f32_16x16x32_bf16 v[224:227], v[48:51], a[44:47], v[224:227]
    v_mfma_f32_16x16x32_bf16 v[228:231], v[48:51], a[116:119], v[228:231]
    v_mfma_f32_16x16x32_bf16 v[232:235], v[52:55], a[44:47], v[232:235]
    v_mfma_f32_16x16x32_bf16 v[236:239], v[52:55], a[116:119], v[236:239]
    s_waitcnt lgkmcnt(2)
    v_mfma_f32_16x16x32_bf16 v[208:211], v[32:35], v[112:115], v[208:211]
    ds_read_b128 v[48:51], v3 offset:14336
    v_mfma_f32_16x16x32_bf16 v[212:215], v[32:35], v[184:187], v[212:215]
    ds_read_b128 v[52:55], v3 offset:32768
    v_mfma_f32_16x16x32_bf16 v[216:219], v[36:39], v[112:115], v[216:219]
    v_mfma_f32_16x16x32_bf16 v[220:223], v[36:39], v[184:187], v[220:223]
    v_mfma_f32_16x16x32_bf16 v[224:227], v[32:35], a[48:51], v[224:227]
    v_mfma_f32_16x16x32_bf16 v[228:231], v[32:35], a[120:123], v[228:231]
    v_mfma_f32_16x16x32_bf16 v[232:235], v[36:39], a[48:51], v[232:235]
    v_mfma_f32_16x16x32_bf16 v[236:239], v[36:39], a[120:123], v[236:239]
    s_waitcnt lgkmcnt(2)
    v_mfma_f32_16x16x32_bf16 v[208:211], v[40:43], v[116:119], v[208:211]
    ds_read_b128 v[32:35], v3 offset:15360
    v_mfma_f32_16x16x32_bf16 v[212:215], v[40:43], v[188:191], v[212:215]
    ds_read_b128 v[36:39], v3 offset:33792
    v_mfma_f32_16x16x32_bf16 v[216:219], v[44:47], v[116:119], v[216:219]
    v_mfma_f32_16x16x32_bf16 v[220:223], v[44:47], v[188:191], v[220:223]
    v_mfma_f32_16x16x32_bf16 v[224:227], v[40:43], a[52:55], v[224:227]
    v_mfma_f32_16x16x32_bf16 v[228:231], v[40:43], a[124:127], v[228:231]
    v_mfma_f32_16x16x32_bf16 v[232:235], v[44:47], a[52:55], v[232:235]
    v_mfma_f32_16x16x32_bf16 v[236:239], v[44:47], a[124:127], v[236:239]
    s_waitcnt lgkmcnt(2)
    v_mfma_f32_16x16x32_bf16 v[208:211], v[48:51], v[120:123], v[208:211]
    ds_read_b128 v[40:43], v3 offset:16384
    v_mfma_f32_16x16x32_bf16 v[212:215], v[48:51], v[192:195], v[212:215]
    ds_read_b128 v[44:47], v3 offset:34816
    v_mfma_f32_16x16x32_bf16 v[216:219], v[52:55], v[120:123], v[216:219]
    v_mfma_f32_16x16x32_bf16 v[220:223], v[52:55], v[192:195], v[220:223]
    v_mfma_f32_16x16x32_bf16 v[224:227], v[48:51], a[56:59], v[224:227]
    v_mfma_f32_16x16x32_bf16 v[228:231], v[48:51], a[128:131], v[228:231]
    v_mfma_f32_16x16x32_bf16 v[232:235], v[52:55], a[56:59], v[232:235]
    v_mfma_f32_16x16x32_bf16 v[236:239], v[52:55], a[128:131], v[236:239]
    s_waitcnt lgkmcnt(2)
    v_mfma_f32_16x16x32_bf16 v[208:211], v[32:35], v[124:127], v[208:211]
    ds_read_b128 v[48:51], v3 offset:17408
    v_mfma_f32_16x16x32_bf16 v[212:215], v[32:35], v[196:199], v[212:215]
    ds_read_b128 v[52:55], v3 offset:35840
    v_mfma_f32_16x16x32_bf16 v[216:219], v[36:39], v[124:127], v[216:219]
    v_mfma_f32_16x16x32_bf16 v[220:223], v[36:39], v[196:199], v[220:223]
    v_mfma_f32_16x16x32_bf16 v[224:227], v[32:35], a[60:63], v[224:227]
    s_add_u32 s27, s27, 36864
    s_cmp_eq_u32 s27, 110592
    s_cselect_b32 s27, 0, s27
    v_add_u32 v3, s27, v1
    v_mfma_f32_16x16x32_bf16 v[228:231], v[32:35], a[132:135], v[228:231]
    v_mfma_f32_16x16x32_bf16 v[232:235], v[36:39], a[60:63], v[232:235]
    v_mfma_f32_16x16x32_bf16 v[236:239], v[36:39], a[132:135], v[236:239]
    s_waitcnt lgkmcnt(2)
    v_mfma_f32_16x16x32_bf16 v[208:211], v[40:43], v[128:131], v[208:211]
    ds_read_b128 v[32:35], v3 offset:0
    v_mfma_f32_16x16x32_bf16 v[212:215], v[40:43], v[200:203], v[212:215]
    ds_read_b128 v[36:39], v3 offset:18432
    v_mfma_f32_16x16x32_bf16 v[216:219], v[44:47], v[128:131], v[216:219]
    v_mfma_f32_16x16x32_bf16 v[220:223], v[44:47], v[200:203], v[220:223]
    v_mfma_f32_16x16x32_bf16 v[224:227], v[40:43], a[64:67], v[224:227]
    v_mfma_f32_16x16x32_bf16 v[228:231], v[40:43], a[136:139], v[228:231]
    v_mfma_f32_16x16x32_bf16 v[232:235], v[44:47], a[64:67], v[232:235]
    v_mfma_f32_16x16x32_bf16 v[236:239], v[44:47], a[136:139], v[236:239]
    s_waitcnt lgkmcnt(2)
    v_mfma_f32_16x16x32_bf16 v[208:211], v[48:51], v[132:135], v[208:211]
    ds_read_b128 v[40:43], v3 offset:1024
    v_mfma_f32_16x16x32_bf16 v[212:215], v[48:51], v[204:207], v[212:215]
    ds_read_b128 v[44:47], v3 offset:19456
    v_mfma_f32_16x16x32_bf16 v[216:219], v[52:55], v[132:135], v[216:219]
    v_mfma_f32_16x16x32_bf16 v[220:223], v[52:55], v[204:207], v[220:223]
    v_mfma_f32_16x16x32_bf16 v[224:227], v[48:51], a[68:71], v[224:227]
    v_mfma_f32_16x16x32_bf16 v[228:231], v[48:51], a[140:143], v[228:231]
    v_mfma_f32_16x16x32_bf16 v[232:235], v[52:55], a[68:71], v[232:235]
    v_mfma_f32_16x16x32_bf16 v[236:239], v[52:55], a[140:143], v[236:239]
    s_add_u32 s26, s26, s41
    s_waitcnt vmcnt(0)
    v_cvt_pk_bf16_f32 v8, v208, v209
    v_cvt_pk_bf16_f32 v9, v210, v211
    v_cvt_pk_bf16_f32 v10, v216, v217
    v_cvt_pk_bf16_f32 v11, v218, v219
    v_cvt_pk_bf16_f32 v12, v212, v213
    v_cvt_pk_bf16_f32 v13, v214, v215
    v_cvt_pk_bf16_f32 v14, v220, v221
    v_cvt_pk_bf16_f32 v15, v222, v223
    v_cvt_pk_bf16_f32 v16, v224, v225
    v_cvt_pk_bf16_f32 v17, v226, v227
    v_cvt_pk_bf16_f32 v18, v232, v233
    v_cvt_pk_bf16_f32 v19, v234, v235
    v_cvt_pk_bf16_f32 v20, v228, v229
    v_cvt_pk_bf16_f32 v21, v230, v231
    v_cvt_pk_bf16_f32 v22, v236, v237
    v_cvt_pk_bf16_f32 v23, v238, v239
    s_mov_b64 s[36:37], -1
    s_add_u32 s28, s26, s12
    buffer_store_dwordx4 v[8:11], v7, s[4:7], s28 offen sc1
    s_add_u32 s28, s26, s13
    buffer_store_dwordx4 v[12:15], v7, s[4:7], s28 offen sc1
    s_add_u32 s28, s26, s14
    buffer_store_dwordx4 v[16:19], v7, s[4:7], s28 offen sc1
    s_add_u32 s28, s26, s15
    buffer_store_dwordx4 v[20:23], v7, s[4:7], s28 offen sc1
    s_lshr_b32 s45, s19, 2
    s_cbranch_scc1 qk_vloop_nf
    s_mov_b32 s45, 1
    s_mov_b64 s[36:37], 0
    s_waitcnt vmcnt(0)
    s_barrier
    s_add_u32 s23, s45, s95
    v_mov_b32 v4, s23
    s_mov_b64 exec, s[34:35]
    buffer_store_dword v4, off, s[4:7], s29 sc1
    buffer_store_dword v4, off, s[4:7], s29 offset:128 sc1
    s_mov_b64 exec, -1
qk_vloop_nf:
    s_add_u32 s19, s19, 4
    s_cmp_lt_u32 s19, s20
    s_cbranch_scc1 qk_vloop
qk_done:
    s_waitcnt vmcnt(0) lgkmcnt(0)
    s_barrier
    s_mov_b32 s45, 16
    s_add_u32 s23, s45, s95
    v_mov_b32 v4, s23
    s_mov_b64 exec, s[34:35]
    buffer_store_dword v4, off, s[4:7], s29 sc1
    buffer_store_dword v4, off, s[4:7], s29 offset:128 sc1
    s_mov_b64 exec, -1
    s_cmp_lt_i32 s33, 0
    s_cbranch_scc1 L_memkv
    v_readfirstlane_b32 s40, v245
    v_readfirstlane_b32 s41, v246
    v_readfirstlane_b32 s42, v247
    v_readfirstlane_b32 s43, v248
    s_cmp_ge_u32 s40, 160
    s_cselect_b32 s43, s43, 0
    s_cmp_ge_u32 s41, 1
    s_cselect_b32 s43, s43, 0
    s_cmp_eq_u32 s42, 1
    s_cselect_b32 s43, s43, 0
    s_cmp_eq_u32 s93, 1000
    s_cselect_b32 s43, s43, 0
    s_mov_b32 s93, 999
    v_mov_b32 v250, s43
    v_mov_b32 v251, 163832
    s_mov_b64 exec, s[34:35]
    ds_write_b32 v251, v250
    s_mov_b64 exec, -1
    s_waitcnt lgkmcnt(0)
    s_barrier
    ds_read_b32 v252, v251
    s_waitcnt lgkmcnt(0)
    v_readfirstlane_b32 s43, v252
    s_barrier
    s_cmp_lg_u32 s43, 192
    s_cbranch_scc1 L_qkv_next
    s_mov_b32 s45, s33
    s_mov_b32 s93, 500
    s_branch L_phase2b
L_memkv:
    v_and_b32 v4, 63, v0
    v_and_b32 v2, 7, v4
    v_lshrrev_b32 v5, 4, v4
    v_lshl_add_u32 v2, v5, 3, v2
    v_lshlrev_b32 v2, 4, v2
    v_bfe_u32 v3, v4, 3, 1
    v_mul_u32_u24 v5, 9216, v3
    v_add_u32 v2, v2, v5
    v_mov_b32 v240, 0x05040100
    v_mov_b32 v241, 0x07060302
    v_lshrrev_b32 v5, 5, v4
    v_and_b32 v1, 0xdff, v7
    s_cmp_eq_u32 s16, 2
    s_cbranch_scc1 mk_isv
    v_mov_b32 v5, v3
    v_or_b32 v1, 128, v7
mk_isv:
    v_lshl_add_u32 v1, v5, 17, v1
    s_mov_b32 s28, 0
    s_mov_b32 s19, 2
    s_mov_b32 s24, 138412032
    s_lshl_b32 s26, s17, 12
    s_mov_b32 s21, 69206016
    s_cmp_eq_u32 s16, 2
    s_cselect_b32 s21, 77594624, s21
    s_add_u32 s26, s26, s21
    s_lshl_b32 s29, s17, 7
    s_lshl_b32 s21, s16, 2
    s_add_u32 s29, s29, s21
    s_add_u32 s29, s29, 125829164
mk_loop:
    s_cmp_lg_u32 s18, 0
    s_cbranch_scc1 mk_go
    s_cmp_le_u32 s19, s28
    s_cbranch_scc1 mk_go
    s_mov_b32 s23, 125853696
    s_mov_b32 s21, 4194304
mk_wait:
    buffer_load_dword v4, off, s[4:7], s23 sc1
    s_sub_u32 s21, s21, 1
    s_cbranch_scc1 mk_go
    s_waitcnt vmcnt(0)
    v_readfirstlane_b32 s28, v4
    s_nop 0
    s_sub_u32 s28, s28, s95
    s_cmp_gt_u32 s28, 64
    s_cselect_b32 s28, 0, s28
    s_cmp_le_u32 s19, s28
    s_cbranch_scc1 mk_go
    s_sleep 4
    s_branch mk_wait
mk_go:
    s_barrier
    s_add_u32 s21, s24, 4096
    s_add_u32 s23, s24, 8192
    buffer_load_dwordx4 v[24:27], v2, s[4:7], s24 offen offset:0 sc1
    buffer_load_dwordx4 v[28:31], v2, s[4:7], s24 offen offset:512 sc1
    buffer_load_dwordx4 v[32:35], v2, s[4:7], s21 offen offset:0 sc1
    buffer_load_dwordx4 v[36:39], v2, s[4:7], s21 offen offset:512 sc1
    buffer_load_dwordx4 v[40:43], v2, s[4:7], s24 offen offset:1024 sc1
    buffer_load_dwordx4 v[44:47], v2, s[4:7], s24 offen offset:1536 sc1
    buffer_load_dwordx4 v[48:51], v2, s[4:7], s21 offen offset:1024 sc1
    buffer_load_dwordx4 v[52:55], v2, s[4:7], s21 offen offset:1536 sc1
    buffer_load_dwordx4 v[56:59], v2, s[4:7], s24 offen offset:2048 sc1
    buffer_load_dwordx4 v[60:63], v2, s[4:7], s24 offen offset:2560 sc1
    buffer_load_dwordx4 v[208:211], v2, s[4:7], s21 offen offset:2048 sc1
    buffer_load_dwordx4 v[212:215], v2, s[4:7], s21 offen offset:2560 sc1
    buffer_load_dwordx4 v[216:219], v2, s[4:7], s24 offen offset:3072 sc1
    buffer_load_dwordx4 v[220:223], v2, s[4:7], s24 offen offset:3584 sc1
    buffer_load_dwordx4 v[224:227], v2, s[4:7], s21 offen offset:3072 sc1
    buffer_load_dwordx4 v[228:231], v2, s[4:7], s21 offen offset:3584 sc1
    buffer_load_dwordx4 v[232:235], v2, s[4:7], s23 offen offset:0 sc1
    buffer_load_dwordx4 v[236:239], v2, s[4:7], s23 offen offset:512 sc1
    s_add_u32 s24, s24, 18432
    s_cmp_eq_u32 s16, 2
    s_cbranch_scc1 mk_v
    s_waitcnt vmcnt(17)
    v_perm_b32 v244, v25, v24, v240
    v_perm_b32 v245, v27, v26, v240
    v_perm_b32 v246, v25, v24, v241
    v_perm_b32 v247, v27, v26, v241
    s_waitcnt vmcnt(16)
    v_perm_b32 v248, v29, v28, v240
    v_perm_b32 v249, v31, v30, v240
    v_perm_b32 v250, v29, v28, v241
    v_perm_b32 v251, v31, v30, v241
    v_mfma_f32_16x16x32_bf16 v[8:11], v[64:67], v[244:247], 0
    v_mfma_f32_16x16x32_bf16 v[12:15], v[136:139], v[244:247], 0
    v_mfma_f32_16x16x32_bf16 v[16:19], a[0:3], v[244:247], 0
    v_mfma_f32_16x16x32_bf16 v[20:23], a[72:75], v[244:247], 0
    s_waitcnt vmcnt(15)
    v_perm_b32 v244, v33, v32, v240
    v_perm_b32 v245, v35, v34, v240
    v_perm_b32 v246, v33, v32, v241
    v_perm_b32 v247, v35, v34, v241
    v_mfma_f32_16x16x32_bf16 v[8:11], v[68:71], v[248:251], v[8:11]
    v_mfma_f32_16x16x32_bf16 v[12:15], v[140:143], v[248:251], v[12:15]
    v_mfma_f32_16x16x32_bf16 v[16:19], a[4:7], v[248:251], v[16:19]
    v_mfma_f32_16x16x32_bf16 v[20:23], a[76:79], v[248:251], v[20:23]
    s_waitcnt vmcnt(14)
    v_perm_b32 v248, v37, v36, v240
    v_perm_b32 v249, v39, v38, v240
    v_perm_b32 v250, v37, v36, v241
    v_perm_b32 v251, v39, v38, v241
    v_mfma_f32_16x16x32_bf16 v[8:11], v[72:75], v[244:247], v[8:11]
    v_mfma_f32_16x16x32_bf16 v[12:15], v[144:147], v[244:247], v[12:15]
    v_mfma_f32_16x16x32_bf16 v[16:19], a[8:11], v[244:247], v[16:19]
    v_mfma_f32_16x16x32_bf16 v[20:23], a[80:83], v[244:247], v[20:23]
    s_waitcnt vmcnt(13)
    v_perm_b32 v244, v41, v40, v240
    v_perm_b32 v245, v43, v42, v240
    v_perm_b32 v246, v41, v40, v241
    v_perm_b32 v247, v43, v42, v241
    v_mfma_f32_16x16x32_bf16 v[8:11], v[76:79], v[248:251], v[8:11]
    v_mfma_f32_16x16x32_bf16 v[12:15], v[148:151], v[248:251], v[12:15]
    v_mfma_f32_16x16x32_bf16 v[16:19], a[12:15], v[248:251], v[16:19]
    v_mfma_f32_16x16x32_bf16 v[20:23], a[84:87], v[248:251], v[20:23]
    s_waitcnt vmcnt(12)
    v_perm_b32 v248, v45, v44, v240
    v_perm_b32 v249, v47, v46, v240
    v_perm_b32 v250, v45, v44, v241
    v_perm_b32 v251, v47, v46, v241
    v_mfma_f32_16x16x32_bf16 v[8:11], v[80:83], v[244:247], v[8:11]
    v_mfma_f32_16x16x32_bf16 v[12:15], v[152:155], v[244:247], v[12:15]
    v_mfma_f32_16x16x32_bf16 v[16:19], a[16:19], v[244:247], v[16:19]
    v_mfma_f32_16x16x32_bf16 v[20:23], a[88:91], v[244:247], v[20:23]
    s_waitcnt vmcnt(11)
    v_perm_b32 v244, v49, v48, v240
    v_perm_b32 v245, v51, v50, v240
    v_perm_b32 v246, v49, v48, v241
    v_perm_b32 v247, v51, v50, v241
    v_mfma_f32_16x16x32_bf16 v[8:11], v[84:87], v[248:251], v[8:11]
    v_mfma_f32_16x16x32_bf16 v[12:15], v[156:159], v[248:251], v[12:15]
    v_mfma_f32_16x16x32_bf16 v[16:19], a[20:23], v[248:251], v[16:19]
    v_mfma_f32_16x16x32_bf16 v[20:23], a[92:95], v[248:251], v[20:23]
    s_waitcnt vmcnt(10)
    v_perm_b32 v248, v53, v52, v240
    v_perm_b32 v249, v55, v54, v240
    v_perm_b32 v250, v53, v52, v241
    v_perm_b32 v251, v55, v54, v241
    v_mfma_f32_16x16x32_bf16 v[8:11], v[88:91], v[244:247], v[8:11]
    v_mfma_f32_16x16x32_bf16 v[12:15], v[160:163], v[244:247], v[12:15]
    v_mfma_f32_16x16x32_bf16 v[16:19], a[24:27], v[244:247], v[16:19]
    v_mfma_f32_16x16x32_bf16 v[20:23], a[96:99], v[244:247], v[20:23]
    s_waitcnt vmcnt(9)
    v_perm_b32 v244, v57, v56, v240
    v_perm_b32 v245, v59, v58, v240
    v_perm_b32 v246, v57, v56, v241
    v_perm_b32 v247, v59, v58, v241
    v_mfma_f32_16x16x32_bf16 v[8:11], v[92:95], v[248:251], v[8:11]
    v_mfma_f32_16x16x32_bf16 v[12:15], v[164:167], v[248:251], v[12:15]
    v_mfma_f32_16x16x32_bf16 v[16:19], a[28:31], v[248:251], v[16:19]
    v_mfma_f32_16x16x32_bf16 v[20:23], a[100:103], v[248:251], v[20:23]
    s_waitcnt vmcnt(8)
    v_perm_b32 v248, v61, v60, v240
    v_perm_b32 v249, v63, v62, v240
    v_perm_b32 v250, v61, v60, v241
    v_perm_b32 v251, v63, v62, v241
    v_mfma_f32_16x16x32_bf16 v[8:11], v[96:99], v[244:247], v[8:11]
    v_mfma_f32_16x16x32_bf16 v[12:15], v[168:171], v[244:247], v[12:15]
    v_mfma_f32_16x16x32_bf16 v[16:19], a[32:35], v[244:247], v[16:19]
    v_mfma_f32_16x16x32_bf16 v[20:23], a[104:107], v[244:247], v[20:23]
    s_waitcnt vmcnt(7)
    v_perm_b32 v244, v209, v208, v240
    v_perm_b32 v245, v211, v210, v240
    v_perm_b32 v246, v209, v208, v241
    v_perm_b32 v247, v211, v210, v241
    v_mfma_f32_16x16x32_bf16 v[8:11], v[100:103], v[248:251], v[8:11]
    v_mfma_f32_16x16x32_bf16 v[12:15], v[172:175], v[248:251], v[12:15]
    v_mfma_f32_16x16x32_bf16 v[16:19], a[36:39], v[248:251], v[16:19]
    v_mfma_f32_16x16x32_bf16 v[20:23], a[108:111], v[248:251], v[20:23]
    s_waitcnt vmcnt(6)
    v_perm_b32 v248, v213, v212, v240
    v_perm_b32 v249, v215, v214, v240
    v_perm_b32 v250, v213, v212, v241
    v_perm_b32 v251, v215, v214, v241
    v_mfma_f32_16x16x32_bf16 v[8:11], v[104:107], v[244:247], v[8:11]
    v_mfma_f32_16x16x32_bf16 v[12:15], v[176:179], v[244:247], v[12:15]
    v_mfma_f32_16x16x32_bf16 v[16:19], a[40:43], v[244:247], v[16:19]
    v_mfma_f32_16x16x32_bf16 v[20:23], a[112:115], v[244:247], v[20:23]
    s_waitcnt vmcnt(5)
    v_perm_b32 v244, v217, v216, v240
    v_perm_b32 v245, v219, v218, v240
    v_perm_b32 v246, v217, v216, v241
    v_perm_b32 v247, v219, v218, v241
    v_mfma_f32_16x16x32_bf16 v[8:11], v[108:111], v[248:251], v[8:11]
    v_mfma_f32_16x16x32_bf16 v[12:15], v[180:183], v[248:251], v[12:15]
    v_mfma_f32_16x16x32_bf16 v[16:19], a[44:47], v[248:251], v[16:19]
    v_mfma_f32_16x16x32_bf16 v[20:23], a[116:119], v[248:251], v[20:23]
    s_waitcnt vmcnt(4)
    v_perm_b32 v248, v221, v220, v240
    v_perm_b32 v249, v223, v222, v240
    v_perm_b32 v250, v221, v220, v241
    v_perm_b32 v251, v223, v222, v241
    v_mfma_f32_16x16x32_bf16 v[8:11], v[112:115], v[244:247], v[8:11]
    v_mfma_f32_16x16x32_bf16 v[12:15], v[184:187], v[244:247], v[12:15]
    v_mfma_f32_16x16x32_bf16 v[16:19], a[48:51], v[244:247], v[16:19]
    v_mfma_f32_16x16x32_bf16 v[20:23], a[120:123], v[244:247], v[20:23]
    s_waitcnt vmcnt(3)
    v_perm_b32 v244, v225, v224, v240
    v_perm_b32 v245, v227, v226, v240
    v_perm_b32 v246, v225, v224, v241
    v_perm_b32 v247, v227, v226, v241
    v_mfma_f32_16x16x32_bf16 v[8:11], v[116:119], v[248:251], v[8:11]
    v_mfma_f32_16x16x32_bf16 v[12:15], v[188:191], v[248:251], v[12:15]
    v_mfma_f32_16x16x32_bf16 v[16:19], a[52:55], v[248:251], v[16:19]
    v_mfma_f32_16x16x32_bf16 v[20:23], a[124:127], v[248:251], v[20:23]
    s_waitcnt vmcnt(2)
    v_perm_b32 v248, v229, v228, v240
    v_perm_b32 v249, v231, v230, v240
    v_perm_b32 v250, v229, v228, v241
    v_perm_b32 v251, v231, v230, v241
    v_mfma_f32_16x16x32_bf16 v[8:11], v[120:123], v[244:247], v[8:11]
    v_mfma_f32_16x16x32_bf16 v[12:15], v[192:195], v[244:247], v[12:15]
    v_mfma_f32_16x16x32_bf16 v[16:19], a[56:59], v[244:247], v[16:19]
    v_mfma_f32_16x16x32_bf16 v[20:23], a[128:131], v[244:247], v[20:23]
    s_waitcnt vmcnt(1)
    v_mfma_f32_16x16x32_bf16 v[8:11], v[124:127], v[248:251], v[8:11]
    v_mfma_f32_16x16x32_bf16 v[12:15], v[196:199], v[248:251], v[12:15]
    v_mfma_f32_16x16x32_bf16 v[16:19], a[60:63], v[248:251], v[16:19]
    v_mfma_f32_16x16x32_bf16 v[20:23], a[132:135], v[248:251], v[20:23]
    s_waitcnt vmcnt(0)
    v_mfma_f32_16x16x32_bf16 v[8:11], v[128:131], v[232:235], v[8:11]
    v_mfma_f32_16x16x32_bf16 v[12:15], v[200:203], v[232:235], v[12:15]
    v_mfma_f32_16x16x32_bf16 v[16:19], a[64:67], v[232:235], v[16:19]
    v_mfma_f32_16x16x32_bf16 v[20:23], a[136:139], v[232:235], v[20:23]
    v_mfma_f32_16x16x32_bf16 v[8:11], v[132:135], v[236:239], v[8:11]
    v_mfma_f32_16x16x32_bf16 v[12:15], v[204:207], v[236:239], v[12:15]
    v_mfma_f32_16x16x32_bf16 v[16:19], a[68:71], v[236:239], v[16:19]
    v_mfma_f32_16x16x32_bf16 v[20:23], a[140:143], v[236:239], v[20:23]
    s_nop 7
    s_branch mk_st
mk_v:
    s_waitcnt vmcnt(17)
    v_perm_b32 v244, v25, v24, v240
    v_perm_b32 v245, v27, v26, v240
    v_perm_b32 v246, v25, v24, v241
    v_perm_b32 v247, v27, v26, v241
    s_waitcnt vmcnt(16)
    v_perm_b32 v248, v29, v28, v240
    v_perm_b32 v249, v31, v30, v240
    v_perm_b32 v250, v29, v28, v241
    v_perm_b32 v251, v31, v30, v241
    v_mfma_f32_16x16x32_bf16 v[8:11], v[244:247], v[64:67], 0
    v_mfma_f32_16x16x32_bf16 v[12:15], v[244:247], v[136:139], 0
    v_mfma_f32_16x16x32_bf16 v[16:19], v[244:247], a[0:3], 0
    v_mfma_f32_16x16x32_bf16 v[20:23], v[244:247], a[72:75], 0
    s_waitcnt vmcnt(15)
    v_perm_b32 v244, v33, v32, v240
    v_perm_b32 v245, v35, v34, v240
    v_perm_b32 v246, v33, v32, v241
    v_perm_b32 v247, v35, v34, v241
    v_mfma_f32_16x16x32_bf16 v[8:11], v[248:251], v[68:71], v[8:11]
    v_mfma_f32_16x16x32_bf16 v[12:15], v[248:251], v[140:143], v[12:15]
    v_mfma_f32_16x16x32_bf16 v[16:19], v[248:251], a[4:7], v[16:19]
    v_mfma_f32_16x16x32_bf16 v[20:23], v[248:251], a[76:79], v[20:23]
    s_waitcnt vmcnt(14)
    v_perm_b32 v248, v37, v36, v240
    v_perm_b32 v249, v39, v38, v240
    v_perm_b32 v250, v37, v36, v241
    v_perm_b32 v251, v39, v38, v241
    v_mfma_f32_16x16x32_bf16 v[8:11], v[244:247], v[72:75], v[8:11]
    v_mfma_f32_16x16x32_bf16 v[12:15], v[244:247], v[144:147], v[12:15]
    v_mfma_f32_16x16x32_bf16 v[16:19], v[244:247], a[8:11], v[16:19]
    v_mfma_f32_16x16x32_bf16 v[20:23], v[244:247], a[80:83], v[20:23]
    s_waitcnt vmcnt(13)
    v_perm_b32 v244, v41, v40, v240
    v_perm_b32 v245, v43, v42, v240
    v_perm_b32 v246, v41, v40, v241
    v_perm_b32 v247, v43, v42, v241
    v_mfma_f32_16x16x32_bf16 v[8:11], v[248:251], v[76:79], v[8:11]
    v_mfma_f32_16x16x32_bf16 v[12:15], v[248:251], v[148:151], v[12:15]
    v_mfma_f32_16x16x32_bf16 v[16:19], v[248:251], a[12:15], v[16:19]
    v_mfma_f32_16x16x32_bf16 v[20:23], v[248:251], a[84:87], v[20:23]
    s_waitcnt vmcnt(12)
    v_perm_b32 v248, v45, v44, v240
    v_perm_b32 v249, v47, v46, v240
    v_perm_b32 v250, v45, v44, v241
    v_perm_b32 v251, v47, v46, v241
    v_mfma_f32_16x16x32_bf16 v[8:11], v[244:247], v[80:83], v[8:11]
    v_mfma_f32_16x16x32_bf16 v[12:15], v[244:247], v[152:155], v[12:15]
    v_mfma_f32_16x16x32_bf16 v[16:19], v[244:247], a[16:19], v[16:19]
    v_mfma_f32_16x16x32_bf16 v[20:23], v[244:247], a[88:91], v[20:23]
    s_waitcnt vmcnt(11)
    v_perm_b32 v244, v49, v48, v240
    v_perm_b32 v245, v51, v50, v240
    v_perm_b32 v246, v49, v48, v241
    v_perm_b32 v247, v51, v50, v241
    v_mfma_f32_16x16x32_bf16 v[8:11], v[248:251], v[84:87], v[8:11]
    v_mfma_f32_16x16x32_bf16 v[12:15], v[248:251], v[156:159], v[12:15]
    v_mfma_f32_16x16x32_bf16 v[16:19], v[248:251], a[20:23], v[16:19]
    v_mfma_f32_16x16x32_bf16 v[20:23], v[248:251], a[92:95], v[20:23]
    s_waitcnt vmcnt(10)
    v_perm_b32 v248, v53, v52, v240
    v_perm_b32 v249, v55, v54, v240
    v_perm_b32 v250, v53, v52, v241
    v_perm_b32 v251, v55, v54, v241
    v_mfma_f32_16x16x32_bf16 v[8:11], v[244:247], v[88:91], v[8:11]
    v_mfma_f32_16x16x32_bf16 v[12:15], v[244:247], v[160:163], v[12:15]
    v_mfma_f32_16x16x32_bf16 v[16:19], v[244:247], a[24:27], v[16:19]
    v_mfma_f32_16x16x32_bf16 v[20:23], v[244:247], a[96:99], v[20:23]
    s_waitcnt vmcnt(9)
    v_perm_b32 v244, v57, v56, v240
    v_perm_b32 v245, v59, v58, v240
    v_perm_b32 v246, v57, v56, v241
    v_perm_b32 v247, v59, v58, v241
    v_mfma_f32_16x16x32_bf16 v[8:11], v[248:251], v[92:95], v[8:11]
    v_mfma_f32_16x16x32_bf16 v[12:15], v[248:251], v[164:167], v[12:15]
    v_mfma_f32_16x16x32_bf16 v[16:19], v[248:251], a[28:31], v[16:19]
    v_mfma_f32_16x16x32_bf16 v[20:23], v[248:251], a[100:103], v[20:23]
    s_waitcnt vmcnt(8)
    v_perm_b32 v248, v61, v60, v240
    v_perm_b32 v249, v63, v62, v240
    v_perm_b32 v250, v61, v60, v241
    v_perm_b32 v251, v63, v62, v241
    v_mfma_f32_16x16x32_bf16 v[8:11], v[244:247], v[96:99], v[8:11]
    v_mfma_f32_16x16x32_bf16 v[12:15], v[244:247], v[168:171], v[12:15]
    v_mfma_f32_16x16x32_bf16 v[16:19], v[244:247], a[32:35], v[16:19]
    v_mfma_f32_16x16x32_bf16 v[20:23], v[244:247], a[104:107], v[20:23]
    s_waitcnt vmcnt(7)
    v_perm_b32 v244, v209, v208, v240
    v_perm_b32 v245, v211, v210, v240
    v_perm_b32 v246, v209, v208, v241
    v_perm_b32 v247, v211, v210, v241
    v_mfma_f32_16x16x32_bf16 v[8:11], v[248:251], v[100:103], v[8:11]
    v_mfma_f32_16x16x32_bf16 v[12:15], v[248:251], v[172:175], v[12:15]
    v_mfma_f32_16x16x32_bf16 v[16:19], v[248:251], a[36:39], v[16:19]
    v_mfma_f32_16x16x32_bf16 v[20:23], v[248:251], a[108:111], v[20:23]
    s_waitcnt vmcnt(6)
    v_perm_b32 v248, v213, v212, v240
    v_perm_b32 v249, v215, v214, v240
    v_perm_b32 v250, v213, v212, v241
    v_perm_b32 v251, v215, v214, v241
    v_mfma_f32_16x16x32_bf16 v[8:11], v[244:247], v[104:107], v[8:11]
    v_mfma_f32_16x16x32_bf16 v[12:15], v[244:247], v[176:179], v[12:15]
    v_mfma_f32_16x16x32_bf16 v[16:19], v[244:247], a[40:43], v[16:19]
    v_mfma_f32_16x16x32_bf16 v[20:23], v[244:247], a[112:115], v[20:23]
    s_waitcnt vmcnt(5)
    v_perm_b32 v244, v217, v216, v240
    v_perm_b32 v245, v219, v218, v240
    v_perm_b32 v246, v217, v216, v241
    v_perm_b32 v247, v219, v218, v241
    v_mfma_f32_16x16x32_bf16 v[8:11], v[248:251], v[108:111], v[8:11]
    v_mfma_f32_16x16x32_bf16 v[12:15], v[248:251], v[180:183], v[12:15]
    v_mfma_f32_16x16x32_bf16 v[16:19], v[248:251], a[44:47], v[16:19]
    v_mfma_f32_16x16x32_bf16 v[20:23], v[248:251], a[116:119], v[20:23]
    s_waitcnt vmcnt(4)
    v_perm_b32 v248, v221, v220, v240
    v_perm_b32 v249, v223, v222, v240
    v_perm_b32 v250, v221, v220, v241
    v_perm_b32 v251, v223, v222, v241
    v_mfma_f32_16x16x32_bf16 v[8:11], v[244:247], v[112:115], v[8:11]
    v_mfma_f32_16x16x32_bf16 v[12:15], v[244:247], v[184:187], v[12:15]
    v_mfma_f32_16x16x32_bf16 v[16:19], v[244:247], a[48:51], v[16:19]
    v_mfma_f32_16x16x32_bf16 v[20:23], v[244:247], a[120:123], v[20:23]
    s_waitcnt vmcnt(3)
    v_perm_b32 v244, v225, v224, v240
    v_perm_b32 v245, v227, v226, v240
    v_perm_b32 v246, v225, v224, v241
    v_perm_b32 v247, v227, v226, v241
    v_mfma_f32_16x16x32_bf16 v[8:11], v[248:251], v[116:119], v[8:11]
    v_mfma_f32_16x16x32_bf16 v[12:15], v[248:251], v[188:191], v[12:15]
    v_mfma_f32_16x16x32_bf16 v[16:19], v[248:251], a[52:55], v[16:19]
    v_mfma_f32_16x16x32_bf16 v[20:23], v[248:251], a[124:127], v[20:23]
    s_waitcnt vmcnt(2)
    v_perm_b32 v248, v229, v228, v240
    v_perm_b32 v249, v231, v230, v240
    v_perm_b32 v250, v229, v228, v241
    v_perm_b32 v251, v231, v230, v241
    v_mfma_f32_16x16x32_bf16 v[8:11], v[244:247], v[120:123], v[8:11]
    v_mfma_f32_16x16x32_bf16 v[12:15], v[244:247], v[192:195], v[12:15]
    v_mfma_f32_16x16x32_bf16 v[16:19], v[244:247], a[56:59], v[16:19]
    v_mfma_f32_16x16x32_bf16 v[20:23], v[244:247], a[128:131], v[20:23]
    s_waitcnt vmcnt(1)
    v_mfma_f32_16x16x32_bf16 v[8:11], v[248:251], v[124:127], v[8:11]
    v_mfma_f32_16x16x32_bf16 v[12:15], v[248:251], v[196:199], v[12:15]
    v_mfma_f32_16x16x32_bf16 v[16:19], v[248:251], a[60:63], v[16:19]
    v_mfma_f32_16x16x32_bf16 v[20:23], v[248:251], a[132:135], v[20:23]
    s_waitcnt vmcnt(0)
    v_mfma_f32_16x16x32_bf16 v[8:11], v[232:235], v[128:131], v[8:11]
    v_mfma_f32_16x16x32_bf16 v[12:15], v[232:235], v[200:203], v[12:15]
    v_mfma_f32_16x16x32_bf16 v[16:19], v[232:235], a[64:67], v[16:19]
    v_mfma_f32_16x16x32_bf16 v[20:23], v[232:235], a[136:139], v[20:23]
    v_mfma_f32_16x16x32_bf16 v[8:11], v[236:239], v[132:135], v[8:11]
    v_mfma_f32_16x16x32_bf16 v[12:15], v[236:239], v[204:207], v[12:15]
    v_mfma_f32_16x16x32_bf16 v[16:19], v[236:239], a[68:71], v[16:19]
    v_mfma_f32_16x16x32_bf16 v[20:23], v[236:239], a[140:143], v[20:23]
    s_nop 4
    v_pk_mul_f32 v[8:9], v[8:9], 0.5 op_sel_hi:[1,0]
    v_pk_mul_f32 v[10:11], v[10:11], 0.5 op_sel_hi:[1,0]
    v_pk_mul_f32 v[12:13], v[12:13], 0.5 op_sel_hi:[1,0]
    v_pk_mul_f32 v[14:15], v[14:15], 0.5 op_sel_hi:[1,0]
    v_pk_mul_f32 v[16:17], v[16:17], 0.5 op_sel_hi:[1,0]
    v_pk_mul_f32 v[18:19], v[18:19], 0.5 op_sel_hi:[1,0]
    v_pk_mul_f32 v[20:21], v[20:21], 0.5 op_sel_hi:[1,0]
    v_pk_mul_f32 v[22:23], v[22:23], 0.5 op_sel_hi:[1,0]
mk_st:
    s_nop 1
    v_cvt_pk_bf16_f32 v24, v8, v9
    v_cvt_pk_bf16_f32 v25, v10, v11
    v_cvt_pk_bf16_f32 v26, v12, v13
    v_cvt_pk_bf16_f32 v27, v14, v15
    v_cvt_pk_bf16_f32 v28, v16, v17
    v_cvt_pk_bf16_f32 v29, v18, v19
    v_cvt_pk_bf16_f32 v30, v20, v21
    v_cvt_pk_bf16_f32 v31, v22, v23
    s_add_u32 s21, s26, 4096
    buffer_store_dwordx4 v[24:27], v1, s[4:7], s26 offen sc1
    buffer_store_dwordx4 v[28:31], v1, s[4:7], s21 offen sc1
    s_add_u32 s22, s19, s95
    s_waitcnt vmcnt(0)
    s_barrier
    v_mov_b32 v4, s22
    s_mov_b64 exec, s[34:35]
    buffer_store_dword v4, off, s[4:7], s29 sc1
    buffer_store_dword v4, off, s[4:7], s29 offset:128 sc1
    s_mov_b64 exec, -1
    s_add_u32 s19, s19, 2
    s_add_u32 s26, s26, 262144
    s_cmp_le_u32 s19, 56
    s_cbranch_scc1 mk_loop
    s_mov_b32 s45, 2
    s_mov_b32 s8, s76
    s_mov_b32 s9, s77
    s_mov_b32 s10, 4718592
    s_mov_b32 s11, 0x20000
    s_branch L_att_next
L_ssm_next:
    s_sub_u32 s93, s93, 1
    s_cbranch_scc1 L_exit
    s_mov_b32 s37, 8
    v_mov_b32 v250, 1
    v_mov_b32 v251, 163832
    v_cmp_eq_u32 vcc, 0, v0
    s_nop 0
    s_and_saveexec_b64 s[38:39], vcc
    s_cbranch_execz tk11
    buffer_atomic_add v250, off, s[84:87], s37 sc0
    s_waitcnt vmcnt(0)
    ds_write_b32 v251, v250
    s_waitcnt lgkmcnt(0)
tk11:
    s_mov_b64 exec, -1
    s_barrier
    ds_read_b32 v252, v251
    s_waitcnt lgkmcnt(0)
    v_readfirstlane_b32 s20, v252
    s_barrier
    s_nop 3
    s_cmp_ge_u32 s20, 72
    s_cbranch_scc1 L_ssm_done
    s_lshl_b32 s20, s20, 3
    v_lshrrev_b32 v5, 6, v0
    s_nop 0
    v_readfirstlane_b32 s21, v5
    v_and_b32 v1, 63, v0
    v_and_b32 v2, 15, v1
    v_lshrrev_b32 v3, 4, v1
    v_lshlrev_b32 v4, 14, v5
    s_mov_b32 s8, s62
    s_mov_b32 s9, s63
    s_mov_b32 s10, 2359296
    s_mov_b32 s11, 0x20000
    s_mov_b32 s16, s76
    s_mov_b32 s17, s77
    s_mov_b32 s18, 4718592
    s_mov_b32 s19, 0x20000
    s_add_u32 s22, s20, s21
    s_lshl_b32 s23, s22, 8
    v_lshlrev_b32 v6, 3, v2
    v_lshl_add_u32 v6, v3, 1, v6
    s_mov_b32 s12, s64
    s_mov_b32 s13, s65
    s_mov_b32 s14, 147456
    s_mov_b32 s15, 0x20000
    buffer_load_ushort v8, v6, s[12:15], s23 offen offset:0
    buffer_load_ushort v12, v6, s[12:15], s23 offen offset:128
    buffer_load_ushort v16, v6, s[12:15], s23 offen offset:1024
    buffer_load_ushort v20, v6, s[12:15], s23 offen offset:1152
    s_mov_b32 s12, s66
    s_mov_b32 s13, s67
    s_mov_b32 s14, 147456
    s_mov_b32 s15, 0x20000
    buffer_load_ushort v9, v6, s[12:15], s23 offen offset:0
    buffer_load_ushort v13, v6, s[12:15], s23 offen offset:128
    buffer_load_ushort v17, v6, s[12:15], s23 offen offset:1024
    buffer_load_ushort v21, v6, s[12:15], s23 offen offset:1152
    s_mov_b32 s12, s68
    s_mov_b32 s13, s69
    s_mov_b32 s14, 147456
    s_mov_b32 s15, 0x20000
    buffer_load_ushort v10, v6, s[12:15], s23 offen offset:0
    buffer_load_ushort v14, v6, s[12:15], s23 offen offset:128
    buffer_load_ushort v18, v6, s[12:15], s23 offen offset:1024
    buffer_load_ushort v22, v6, s[12:15], s23 offen offset:1152
    s_mov_b32 s12, s70
    s_mov_b32 s13, s71
    s_mov_b32 s14, 147456
    s_mov_b32 s15, 0x20000
    buffer_load_ushort v11, v6, s[12:15], s23 offen offset:0
    buffer_load_ushort v15, v6, s[12:15], s23 offen offset:128
    buffer_load_ushort v19, v6, s[12:15], s23 offen offset:1024
    buffer_load_ushort v23, v6, s[12:15], s23 offen offset:1152
    s_mov_b32 s12, s72
    s_mov_b32 s13, s73
    s_mov_b32 s14, 1152
    s_mov_b32 s15, 0x20000
    s_lshl_b32 s23, s22, 1
    buffer_load_ushort v24, off, s[12:15], s23
    buffer_load_ushort v25, off, s[12:15], s23 offset:8
    v_mul_u32_u24 v5, 9216, v0
    s_lshl_b32 s22, s20, 1
    s_add_u32 s23, s22, 0
    buffer_load_dwordx4 v[208:211], v5, s[8:11], s23 offen
    s_add_u32 s23, s22, 1152
    buffer_load_dwordx4 v[212:215], v5, s[8:11], s23 offen
    s_add_u32 s23, s22, 2304
    buffer_load_dwordx4 v[216:219], v5, s[8:11], s23 offen
    s_add_u32 s23, s22, 3456
    buffer_load_dwordx4 v[220:223], v5, s[8:11], s23 offen
    s_add_u32 s23, s22, 4608
    buffer_load_dwordx4 v[224:227], v5, s[8:11], s23 offen
    s_add_u32 s23, s22, 5760
    buffer_load_dwordx4 v[228:231], v5, s[8:11], s23 offen
    s_add_u32 s23, s22, 6912
    buffer_load_dwordx4 v[232:235], v5, s[8:11], s23 offen
    s_add_u32 s23, s22, 8064
    buffer_load_dwordx4 v[236:239], v5, s[8:11], s23 offen
    s_mov_b32 s26, 0x3fb8aa3b
    s_mov_b32 s27, 0x3e22f983
    s_mov_b32 s28, 0
    v_cvt_f32_u32 v26, v2
    v_mul_f32 v27, 0x41800000, v26
    s_waitcnt vmcnt(8)
    s_nop 0
ss_pass:
    v_mov_b32 v36, 0
    v_mov_b32 v37, 0
    v_lshl_add_u32 v6, v1, 3, v4
    ds_write_b64 v6, v[36:37] offset:0
    v_lshlrev_b32 v38, 16, v24
    v_mul_f32 v38, s26, v38
    v_exp_f32 v38, v38
    s_nop 0
    v_cvt_pk_bf16_f32 v38, v38, v38
    v_and_b32 v38, 0xffff0000, v38
    v_add_f32 v39, v38, v38
    v_lshlrev_b32 v28, 16, v8
    v_mul_f32 v28, s26, v28
    v_exp_f32 v28, v28
    s_nop 0
    v_cvt_pk_bf16_f32 v28, v28, v28
    v_and_b32 v28, 0xffff0000, v28
    v_mul_f32 v28, v28, v38
    v_mul_f32 v28, s26, v28
    v_sub_f32 v28, 0, v28
    v_lshlrev_b32 v29, 16, v9
    v_mul_f32 v29, v29, v38
    v_mul_f32 v29, s27, v29
    v_lshlrev_b32 v30, 16, v10
    v_mul_f32 v30, v30, v39
    v_lshlrev_b32 v31, 16, v11
    v_mul_f32 v31, v31, v39
    v_lshlrev_b32 v32, 16, v12
    v_mul_f32 v32, s26, v32
    v_exp_f32 v32, v32
    s_nop 0
    v_cvt_pk_bf16_f32 v32, v32, v32
    v_and_b32 v32, 0xffff0000, v32
    v_mul_f32 v32, v32, v38
    v_mul_f32 v32, s26, v32
    v_sub_f32 v32, 0, v32
    v_lshlrev_b32 v33, 16, v13
    v_mul_f32 v33, v33, v38
    v_mul_f32 v33, s27, v33
    v_lshlrev_b32 v34, 16, v14
    v_mul_f32 v34, v34, v39
    v_lshlrev_b32 v35, 16, v15
    v_mul_f32 v35, v35, v39
    v_mov_b64 v[48:49], 0
    v_mov_b64 v[50:51], 0
    v_mov_b64 v[52:53], 0
    v_mov_b64 v[54:55], 0
    v_mov_b64 v[56:57], 0
    v_mov_b64 v[58:59], 0
    v_mov_b64 v[60:61], 0
    v_mov_b64 v[62:63], 0
    s_mov_b32 s25, 0
    s_nop 0
ss_kg:
    v_mov_b64_dpp v[64:65], v[28:29] row_newbcast:0 row_mask:0xf bank_mask:0xf
    v_mov_b64_dpp v[66:67], v[30:31] row_newbcast:0 row_mask:0xf bank_mask:0xf
    v_pk_mul_f32 v[94:95], v[64:65], v[26:27] op_sel_hi:[1,0]
    v_pk_mul_f32 v[96:97], v[64:65], v[26:27] op_sel:[0,1] op_sel_hi:[1,1]
    v_fract_f32 v95, v95
    v_fract_f32 v97, v97
    v_exp_f32 v94, v94
    v_exp_f32 v96, v96
    v_cos_f32 v68, v95
    v_sin_f32 v69, v95
    v_cos_f32 v76, v97
    v_sin_f32 v77, v97
    v_pk_mul_f32 v[68:69], v[68:69], v[94:95] op_sel_hi:[1,0]
    v_pk_mul_f32 v[76:77], v[76:77], v[96:97] op_sel_hi:[1,0]
    v_pk_mul_f32 v[92:93], v[76:77], v[76:77] op_sel:[1,1] op_sel_hi:[0,1]
    v_pk_fma_f32 v[78:79], v[76:77], v[76:77], v[92:93] op_sel:[0,0,0] op_sel_hi:[0,1,1] neg_lo:[0,0,1]
    v_pk_mul_f32 v[94:95], v[68:69], v[68:69] op_sel:[1,1] op_sel_hi:[0,1]
    v_pk_fma_f32 v[70:71], v[68:69], v[68:69], v[94:95] op_sel:[0,0,0] op_sel_hi:[0,1,1] neg_lo:[0,0,1]
    v_pk_mul_f32 v[92:93], v[78:79], v[78:79] op_sel:[1,1] op_sel_hi:[0,1]
    v_pk_fma_f32 v[80:81], v[78:79], v[78:79], v[92:93] op_sel:[0,0,0] op_sel_hi:[0,1,1] neg_lo:[0,0,1]
    v_pk_mul_f32 v[94:95], v[70:71], v[70:71] op_sel:[1,1] op_sel_hi:[0,1]
    v_pk_fma_f32 v[72:73], v[70:71], v[70:71], v[94:95] op_sel:[0,0,0] op_sel_hi:[0,1,1] neg_lo:[0,0,1]
    v_pk_mul_f32 v[92:93], v[80:81], v[80:81] op_sel:[1,1] op_sel_hi:[0,1]
    v_pk_fma_f32 v[82:83], v[80:81], v[80:81], v[92:93] op_sel:[0,0,0] op_sel_hi:[0,1,1] neg_lo:[0,0,1]
    v_pk_mul_f32 v[94:95], v[72:73], v[72:73] op_sel:[1,1] op_sel_hi:[0,1]
    v_pk_fma_f32 v[74:75], v[72:73], v[72:73], v[94:95] op_sel:[0,0,0] op_sel_hi:[0,1,1] neg_lo:[0,0,1]
    v_pk_mul_f32 v[92:93], v[82:83], v[82:83] op_sel:[1,1] op_sel_hi:[0,1]
    v_pk_fma_f32 v[84:85], v[82:83], v[82:83], v[92:93] op_sel:[0,0,0] op_sel_hi:[0,1,1] neg_lo:[0,0,1]
    v_pk_mul_f32 v[94:95], v[66:67], v[76:77] op_sel:[1,1] op_sel_hi:[1,0]
    v_pk_fma_f32 v[86:87], v[66:67], v[76:77], v[94:95] op_sel:[0,0,0] op_sel_hi:[0,1,1] neg_lo:[0,0,1] neg_hi:[1,0,1]
    v_mov_b32_dpp v80, v78 row_ror:8 row_mask:0xf bank_mask:0x3
    v_mov_b32_dpp v81, v79 row_ror:8 row_mask:0xf bank_mask:0x3
    v_mov_b32_dpp v82, v84 row_ror:8 row_mask:0xf bank_mask:0x3
    v_mov_b32_dpp v83, v85 row_ror:8 row_mask:0xf bank_mask:0x3
    v_pk_mul_f32 v[92:93], v[66:67], v[80:81] op_sel:[1,1] op_sel_hi:[1,0]
    v_pk_fma_f32 v[88:89], v[66:67], v[80:81], v[92:93] op_sel:[0,0,0] op_sel_hi:[0,1,1] neg_lo:[0,0,1] neg_hi:[1,0,1]
    v_pk_mul_f32 v[94:95], v[66:67], v[82:83] op_sel:[1,1] op_sel_hi:[1,0]
    v_pk_fma_f32 v[90:91], v[66:67], v[82:83], v[94:95] op_sel:[0,0,0] op_sel_hi:[0,1,1] neg_lo:[0,0,1] neg_hi:[1,0,1]
    v_mfma_f32_16x16x4_f32 v[48:51], v86, v68, v[48:51]
    v_mfma_f32_16x16x4_f32 v[52:55], v88, v70, v[52:55]
    v_mfma_f32_16x16x4_f32 v[56:59], v88, v72, v[56:59]
    v_mfma_f32_16x16x4_f32 v[60:63], v90, v74, v[60:63]
    v_mfma_f32_16x16x4_f32 v[48:51], v87, v69, v[48:51]
    v_mfma_f32_16x16x4_f32 v[52:55], v89, v71, v[52:55]
    v_mfma_f32_16x16x4_f32 v[56:59], v89, v73, v[56:59]
    v_mfma_f32_16x16x4_f32 v[60:63], v91, v75, v[60:63]
    v_mov_b64_dpp v[64:65], v[28:29] row_newbcast:1 row_mask:0xf bank_mask:0xf
    v_mov_b64_dpp v[66:67], v[30:31] row_newbcast:1 row_mask:0xf bank_mask:0xf
    v_pk_mul_f32 v[94:95], v[64:65], v[26:27] op_sel_hi:[1,0]
    v_pk_mul_f32 v[96:97], v[64:65], v[26:27] op_sel:[0,1] op_sel_hi:[1,1]
    v_fract_f32 v95, v95
    v_fract_f32 v97, v97
    v_exp_f32 v94, v94
    v_exp_f32 v96, v96
    v_cos_f32 v68, v95
    v_sin_f32 v69, v95
    v_cos_f32 v76, v97
    v_sin_f32 v77, v97
    v_pk_mul_f32 v[68:69], v[68:69], v[94:95] op_sel_hi:[1,0]
    v_pk_mul_f32 v[76:77], v[76:77], v[96:97] op_sel_hi:[1,0]
    v_pk_mul_f32 v[92:93], v[76:77], v[76:77] op_sel:[1,1] op_sel_hi:[0,1]
    v_pk_fma_f32 v[78:79], v[76:77], v[76:77], v[92:93] op_sel:[0,0,0] op_sel_hi:[0,1,1] neg_lo:[0,0,1]
    v_pk_mul_f32 v[94:95], v[68:69], v[68:69] op_sel:[1,1] op_sel_hi:[0,1]
    v_pk_fma_f32 v[70:71], v[68:69], v[68:69], v[94:95] op_sel:[0,0,0] op_sel_hi:[0,1,1] neg_lo:[0,0,1]
    v_pk_mul_f32 v[92:93], v[78:79], v[78:79] op_sel:[1,1] op_sel_hi:[0,1]
    v_pk_fma_f32 v[80:81], v[78:79], v[78:79], v[92:93] op_sel:[0,0,0] op_sel_hi:[0,1,1] neg_lo:[0,0,1]
    v_pk_mul_f32 v[94:95], v[70:71], v[70:71] op_sel:[1,1] op_sel_hi:[0,1]
    v_pk_fma_f32 v[72:73], v[70:71], v[70:71], v[94:95] op_sel:[0,0,0] op_sel_hi:[0,1,1] neg_lo:[0,0,1]
    v_pk_mul_f32 v[92:93], v[80:81], v[80:81] op_sel:[1,1] op_sel_hi:[0,1]
    v_pk_fma_f32 v[82:83], v[80:81], v[80:81], v[92:93] op_sel:[0,0,0] op_sel_hi:[0,1,1] neg_lo:[0,0,1]
    v_pk_mul_f32 v[94:95], v[72:73], v[72:73] op_sel:[1,1] op_sel_hi:[0,1]
    v_pk_fma_f32 v[74:75], v[72:73], v[72:73], v[94:95] op_sel:[0,0,0] op_sel_hi:[0,1,1] neg_lo:[0,0,1]
    v_pk_mul_f32 v[92:93], v[82:83], v[82:83] op_sel:[1,1] op_sel_hi:[0,1]
    v_pk_fma_f32 v[84:85], v[82:83], v[82:83], v[92:93] op_sel:[0,0,0] op_sel_hi:[0,1,1] neg_lo:[0,0,1]
    v_pk_mul_f32 v[94:95], v[66:67], v[76:77] op_sel:[1,1] op_sel_hi:[1,0]
    v_pk_fma_f32 v[86:87], v[66:67], v[76:77], v[94:95] op_sel:[0,0,0] op_sel_hi:[0,1,1] neg_lo:[0,0,1] neg_hi:[1,0,1]
    v_mov_b32_dpp v80, v78 row_ror:8 row_mask:0xf bank_mask:0x3
    v_mov_b32_dpp v81, v79 row_ror:8 row_mask:0xf bank_mask:0x3
    v_mov_b32_dpp v82, v84 row_ror:8 row_mask:0xf bank_mask:0x3
    v_mov_b32_dpp v83, v85 row_ror:8 row_mask:0xf bank_mask:0x3
    v_pk_mul_f32 v[92:93], v[66:67], v[80:81] op_sel:[1,1] op_sel_hi:[1,0]
    v_pk_fma_f32 v[88:89], v[66:67], v[80:81], v[92:93] op_sel:[0,0,0] op_sel_hi:[0,1,1] neg_lo:[0,0,1] neg_hi:[1,0,1]
    v_pk_mul_f32 v[94:95], v[66:67], v[82:83] op_sel:[1,1] op_sel_hi:[1,0]
    v_pk_fma_f32 v[90:91], v[66:67], v[82:83], v[94:95] op_sel:[0,0,0] op_sel_hi:[0,1,1] neg_lo:[0,0,1] neg_hi:[1,0,1]
    v_mfma_f32_16x16x4_f32 v[48:51], v86, v68, v[48:51]
    v_mfma_f32_16x16x4_f32 v[52:55], v88, v70, v[52:55]
    v_mfma_f32_16x16x4_f32 v[56:59], v88, v72, v[56:59]
    v_mfma_f32_16x16x4_f32 v[60:63], v90, v74, v[60:63]
    v_mfma_f32_16x16x4_f32 v[48:51], v87, v69, v[48:51]
    v_mfma_f32_16x16x4_f32 v[52:55], v89, v71, v[52:55]
    v_mfma_f32_16x16x4_f32 v[56:59], v89, v73, v[56:59]
    v_mfma_f32_16x16x4_f32 v[60:63], v91, v75, v[60:63]
    v_mov_b64_dpp v[64:65], v[28:29] row_newbcast:2 row_mask:0xf bank_mask:0xf
    v_mov_b64_dpp v[66:67], v[30:31] row_newbcast:2 row_mask:0xf bank_mask:0xf
    v_pk_mul_f32 v[94:95], v[64:65], v[26:27] op_sel_hi:[1,0]
    v_pk_mul_f32 v[96:97], v[64:65], v[26:27] op_sel:[0,1] op_sel_hi:[1,1]
    v_fract_f32 v95, v95
    v_fract_f32 v97, v97
    v_exp_f32 v94, v94
    v_exp_f32 v96, v96
    v_cos_f32 v68, v95
    v_sin_f32 v69, v95
    v_cos_f32 v76, v97
    v_sin_f32 v77, v97
    v_pk_mul_f32 v[68:69], v[68:69], v[94:95] op_sel_hi:[1,0]
    v_pk_mul_f32 v[76:77], v[76:77], v[96:97] op_sel_hi:[1,0]
    v_pk_mul_f32 v[92:93], v[76:77], v[76:77] op_sel:[1,1] op_sel_hi:[0,1]
    v_pk_fma_f32 v[78:79], v[76:77], v[76:77], v[92:93] op_sel:[0,0,0] op_sel_hi:[0,1,1] neg_lo:[0,0,1]
    v_pk_mul_f32 v[94:95], v[68:69], v[68:69] op_sel:[1,1] op_sel_hi:[0,1]
    v_pk_fma_f32 v[70:71], v[68:69], v[68:69], v[94:95] op_sel:[0,0,0] op_sel_hi:[0,1,1] neg_lo:[0,0,1]
    v_pk_mul_f32 v[92:93], v[78:79], v[78:79] op_sel:[1,1] op_sel_hi:[0,1]
    v_pk_fma_f32 v[80:81], v[78:79], v[78:79], v[92:93] op_sel:[0,0,0] op_sel_hi:[0,1,1] neg_lo:[0,0,1]
    v_pk_mul_f32 v[94:95], v[70:71], v[70:71] op_sel:[1,1] op_sel_hi:[0,1]
    v_pk_fma_f32 v[72:73], v[70:71], v[70:71], v[94:95] op_sel:[0,0,0] op_sel_hi:[0,1,1] neg_lo:[0,0,1]
    v_pk_mul_f32 v[92:93], v[80:81], v[80:81] op_sel:[1,1] op_sel_hi:[0,1]
    v_pk_fma_f32 v[82:83], v[80:81], v[80:81], v[92:93] op_sel:[0,0,0] op_sel_hi:[0,1,1] neg_lo:[0,0,1]
    v_pk_mul_f32 v[94:95], v[72:73], v[72:73] op_sel:[1,1] op_sel_hi:[0,1]
    v_pk_fma_f32 v[74:75], v[72:73], v[72:73], v[94:95] op_sel:[0,0,0] op_sel_hi:[0,1,1] neg_lo:[0,0,1]
    v_pk_mul_f32 v[92:93], v[82:83], v[82:83] op_sel:[1,1] op_sel_hi:[0,1]
    v_pk_fma_f32 v[84:85], v[82:83], v[82:83], v[92:93] op_sel:[0,0,0] op_sel_hi:[0,1,1] neg_lo:[0,0,1]
    v_pk_mul_f32 v[94:95], v[66:67], v[76:77] op_sel:[1,1] op_sel_hi:[1,0]
    v_pk_fma_f32 v[86:87], v[66:67], v[76:77], v[94:95] op_sel:[0,0,0] op_sel_hi:[0,1,1] neg_lo:[0,0,1] neg_hi:[1,0,1]
    v_mov_b32_dpp v80, v78 row_ror:8 row_mask:0xf bank_mask:0x3
    v_mov_b32_dpp v81, v79 row_ror:8 row_mask:0xf bank_mask:0x3
    v_mov_b32_dpp v82, v84 row_ror:8 row_mask:0xf bank_mask:0x3
    v_mov_b32_dpp v83, v85 row_ror:8 row_mask:0xf bank_mask:0x3
    v_pk_mul_f32 v[92:93], v[66:67], v[80:81] op_sel:[1,1] op_sel_hi:[1,0]
    v_pk_fma_f32 v[88:89], v[66:67], v[80:81], v[92:93] op_sel:[0,0,0] op_sel_hi:[0,1,1] neg_lo:[0,0,1] neg_hi:[1,0,1]
    v_pk_mul_f32 v[94:95], v[66:67], v[82:83] op_sel:[1,1] op_sel_hi:[1,0]
    v_pk_fma_f32 v[90:91], v[66:67], v[82:83], v[94:95] op_sel:[0,0,0] op_sel_hi:[0,1,1] neg_lo:[0,0,1] neg_hi:[1,0,1]
    v_mfma_f32_16x16x4_f32 v[48:51], v86, v68, v[48:51]
    v_mfma_f32_16x16x4_f32 v[52:55], v88, v70, v[52:55]
    v_mfma_f32_16x16x4_f32 v[56:59], v88, v72, v[56:59]
    v_mfma_f32_16x16x4_f32 v[60:63], v90, v74, v[60:63]
    v_mfma_f32_16x16x4_f32 v[48:51], v87, v69, v[48:51]
    v_mfma_f32_16x16x4_f32 v[52:55], v89, v71, v[52:55]
    v_mfma_f32_16x16x4_f32 v[56:59], v89, v73, v[56:59]
    v_mfma_f32_16x16x4_f32 v[60:63], v91, v75, v[60:63]
    v_mov_b64_dpp v[64:65], v[28:29] row_newbcast:3 row_mask:0xf bank_mask:0xf
    v_mov_b64_dpp v[66:67], v[30:31] row_newbcast:3 row_mask:0xf bank_mask:0xf
    v_pk_mul_f32 v[94:95], v[64:65], v[26:27] op_sel_hi:[1,0]
    v_pk_mul_f32 v[96:97], v[64:65], v[26:27] op_sel:[0,1] op_sel_hi:[1,1]
    v_fract_f32 v95, v95
    v_fract_f32 v97, v97
    v_exp_f32 v94, v94
    v_exp_f32 v96, v96
    v_cos_f32 v68, v95
    v_sin_f32 v69, v95
    v_cos_f32 v76, v97
    v_sin_f32 v77, v97
    v_pk_mul_f32 v[68:69], v[68:69], v[94:95] op_sel_hi:[1,0]
    v_pk_mul_f32 v[76:77], v[76:77], v[96:97] op_sel_hi:[1,0]
    v_pk_mul_f32 v[92:93], v[76:77], v[76:77] op_sel:[1,1] op_sel_hi:[0,1]
    v_pk_fma_f32 v[78:79], v[76:77], v[76:77], v[92:93] op_sel:[0,0,0] op_sel_hi:[0,1,1] neg_lo:[0,0,1]
    v_pk_mul_f32 v[94:95], v[68:69], v[68:69] op_sel:[1,1] op_sel_hi:[0,1]
    v_pk_fma_f32 v[70:71], v[68:69], v[68:69], v[94:95] op_sel:[0,0,0] op_sel_hi:[0,1,1] neg_lo:[0,0,1]
    v_pk_mul_f32 v[92:93], v[78:79], v[78:79] op_sel:[1,1] op_sel_hi:[0,1]
    v_pk_fma_f32 v[80:81], v[78:79], v[78:79], v[92:93] op_sel:[0,0,0] op_sel_hi:[0,1,1] neg_lo:[0,0,1]
    v_pk_mul_f32 v[94:95], v[70:71], v[70:71] op_sel:[1,1] op_sel_hi:[0,1]
    v_pk_fma_f32 v[72:73], v[70:71], v[70:71], v[94:95] op_sel:[0,0,0] op_sel_hi:[0,1,1] neg_lo:[0,0,1]
    v_pk_mul_f32 v[92:93], v[80:81], v[80:81] op_sel:[1,1] op_sel_hi:[0,1]
    v_pk_fma_f32 v[82:83], v[80:81], v[80:81], v[92:93] op_sel:[0,0,0] op_sel_hi:[0,1,1] neg_lo:[0,0,1]
    v_pk_mul_f32 v[94:95], v[72:73], v[72:73] op_sel:[1,1] op_sel_hi:[0,1]
    v_pk_fma_f32 v[74:75], v[72:73], v[72:73], v[94:95] op_sel:[0,0,0] op_sel_hi:[0,1,1] neg_lo:[0,0,1]
    v_pk_mul_f32 v[92:93], v[82:83], v[82:83] op_sel:[1,1] op_sel_hi:[0,1]
    v_pk_fma_f32 v[84:85], v[82:83], v[82:83], v[92:93] op_sel:[0,0,0] op_sel_hi:[0,1,1] neg_lo:[0,0,1]
    v_pk_mul_f32 v[94:95], v[66:67], v[76:77] op_sel:[1,1] op_sel_hi:[1,0]
    v_pk_fma_f32 v[86:87], v[66:67], v[76:77], v[94:95] op_sel:[0,0,0] op_sel_hi:[0,1,1] neg_lo:[0,0,1] neg_hi:[1,0,1]
    v_mov_b32_dpp v80, v78 row_ror:8 row_mask:0xf bank_mask:0x3
    v_mov_b32_dpp v81, v79 row_ror:8 row_mask:0xf bank_mask:0x3
    v_mov_b32_dpp v82, v84 row_ror:8 row_mask:0xf bank_mask:0x3
    v_mov_b32_dpp v83, v85 row_ror:8 row_mask:0xf bank_mask:0x3
    v_pk_mul_f32 v[92:93], v[66:67], v[80:81] op_sel:[1,1] op_sel_hi:[1,0]
    v_pk_fma_f32 v[88:89], v[66:67], v[80:81], v[92:93] op_sel:[0,0,0] op_sel_hi:[0,1,1] neg_lo:[0,0,1] neg_hi:[1,0,1]
    v_pk_mul_f32 v[94:95], v[66:67], v[82:83] op_sel:[1,1] op_sel_hi:[1,0]
    v_pk_fma_f32 v[90:91], v[66:67], v[82:83], v[94:95] op_sel:[0,0,0] op_sel_hi:[0,1,1] neg_lo:[0,0,1] neg_hi:[1,0,1]
    v_mfma_f32_16x16x4_f32 v[48:51], v86, v68, v[48:51]
    v_mfma_f32_16x16x4_f32 v[52:55], v88, v70, v[52:55]
    v_mfma_f32_16x16x4_f32 v[56:59], v88, v72, v[56:59]
    v_mfma_f32_16x16x4_f32 v[60:63], v90, v74, v[60:63]
    v_mfma_f32_16x16x4_f32 v[48:51], v87, v69, v[48:51]
    v_mfma_f32_16x16x4_f32 v[52:55], v89, v71, v[52:55]
    v_mfma_f32_16x16x4_f32 v[56:59], v89, v73, v[56:59]
    v_mfma_f32_16x16x4_f32 v[60:63], v91, v75, v[60:63]
    v_mov_b64_dpp v[64:65], v[28:29] row_newbcast:4 row_mask:0xf bank_mask:0xf
    v_mov_b64_dpp v[66:67], v[30:31] row_newbcast:4 row_mask:0xf bank_mask:0xf
    v_pk_mul_f32 v[94:95], v[64:65], v[26:27] op_sel_hi:[1,0]
    v_pk_mul_f32 v[96:97], v[64:65], v[26:27] op_sel:[0,1] op_sel_hi:[1,1]
    v_fract_f32 v95, v95
    v_fract_f32 v97, v97
    v_exp_f32 v94, v94
    v_exp_f32 v96, v96
    v_cos_f32 v68, v95
    v_sin_f32 v69, v95
    v_cos_f32 v76, v97
    v_sin_f32 v77, v97
    v_pk_mul_f32 v[68:69], v[68:69], v[94:95] op_sel_hi:[1,0]
    v_pk_mul_f32 v[76:77], v[76:77], v[96:97] op_sel_hi:[1,0]
    v_pk_mul_f32 v[92:93], v[76:77], v[76:77] op_sel:[1,1] op_sel_hi:[0,1]
    v_pk_fma_f32 v[78:79], v[76:77], v[76:77], v[92:93] op_sel:[0,0,0] op_sel_hi:[0,1,1] neg_lo:[0,0,1]
    v_pk_mul_f32 v[94:95], v[68:69], v[68:69] op_sel:[1,1] op_sel_hi:[0,1]
    v_pk_fma_f32 v[70:71], v[68:69], v[68:69], v[94:95] op_sel:[0,0,0] op_sel_hi:[0,1,1] neg_lo:[0,0,1]
    v_pk_mul_f32 v[92:93], v[78:79], v[78:79] op_sel:[1,1] op_sel_hi:[0,1]
    v_pk_fma_f32 v[80:81], v[78:79], v[78:79], v[92:93] op_sel:[0,0,0] op_sel_hi:[0,1,1] neg_lo:[0,0,1]
    v_pk_mul_f32 v[94:95], v[70:71], v[70:71] op_sel:[1,1] op_sel_hi:[0,1]
    v_pk_fma_f32 v[72:73], v[70:71], v[70:71], v[94:95] op_sel:[0,0,0] op_sel_hi:[0,1,1] neg_lo:[0,0,1]
    v_pk_mul_f32 v[92:93], v[80:81], v[80:81] op_sel:[1,1] op_sel_hi:[0,1]
    v_pk_fma_f32 v[82:83], v[80:81], v[80:81], v[92:93] op_sel:[0,0,0] op_sel_hi:[0,1,1] neg_lo:[0,0,1]
    v_pk_mul_f32 v[94:95], v[72:73], v[72:73] op_sel:[1,1] op_sel_hi:[0,1]
    v_pk_fma_f32 v[74:75], v[72:73], v[72:73], v[94:95] op_sel:[0,0,0] op_sel_hi:[0,1,1] neg_lo:[0,0,1]
    v_pk_mul_f32 v[92:93], v[82:83], v[82:83] op_sel:[1,1] op_sel_hi:[0,1]
    v_pk_fma_f32 v[84:85], v[82:83], v[82:83], v[92:93] op_sel:[0,0,0] op_sel_hi:[0,1,1] neg_lo:[0,0,1]
    v_pk_mul_f32 v[94:95], v[66:67], v[76:77] op_sel:[1,1] op_sel_hi:[1,0]
    v_pk_fma_f32 v[86:87], v[66:67], v[76:77], v[94:95] op_sel:[0,0,0] op_sel_hi:[0,1,1] neg_lo:[0,0,1] neg_hi:[1,0,1]
    v_mov_b32_dpp v80, v78 row_ror:8 row_mask:0xf bank_mask:0x3
    v_mov_b32_dpp v81, v79 row_ror:8 row_mask:0xf bank_mask:0x3
    v_mov_b32_dpp v82, v84 row_ror:8 row_mask:0xf bank_mask:0x3
    v_mov_b32_dpp v83, v85 row_ror:8 row_mask:0xf bank_mask:0x3
    v_pk_mul_f32 v[92:93], v[66:67], v[80:81] op_sel:[1,1] op_sel_hi:[1,0]
    v_pk_fma_f32 v[88:89], v[66:67], v[80:81], v[92:93] op_sel:[0,0,0] op_sel_hi:[0,1,1] neg_lo:[0,0,1] neg_hi:[1,0,1]
    v_pk_mul_f32 v[94:95], v[66:67], v[82:83] op_sel:[1,1] op_sel_hi:[1,0]
    v_pk_fma_f32 v[90:91], v[66:67], v[82:83], v[94:95] op_sel:[0,0,0] op_sel_hi:[0,1,1] neg_lo:[0,0,1] neg_hi:[1,0,1]
    v_mfma_f32_16x16x4_f32 v[48:51], v86, v68, v[48:51]
    v_mfma_f32_16x16x4_f32 v[52:55], v88, v70, v[52:55]
    v_mfma_f32_16x16x4_f32 v[56:59], v88, v72, v[56:59]
    v_mfma_f32_16x16x4_f32 v[60:63], v90, v74, v[60:63]
    v_mfma_f32_16x16x4_f32 v[48:51], v87, v69, v[48:51]
    v_mfma_f32_16x16x4_f32 v[52:55], v89, v71, v[52:55]
    v_mfma_f32_16x16x4_f32 v[56:59], v89, v73, v[56:59]
    v_mfma_f32_16x16x4_f32 v[60:63], v91, v75, v[60:63]
    v_mov_b64_dpp v[64:65], v[28:29] row_newbcast:5 row_mask:0xf bank_mask:0xf
    v_mov_b64_dpp v[66:67], v[30:31] row_newbcast:5 row_mask:0xf bank_mask:0xf
    v_pk_mul_f32 v[94:95], v[64:65], v[26:27] op_sel_hi:[1,0]
    v_pk_mul_f32 v[96:97], v[64:65], v[26:27] op_sel:[0,1] op_sel_hi:[1,1]
    v_fract_f32 v95, v95
    v_fract_f32 v97, v97
    v_exp_f32 v94, v94
    v_exp_f32 v96, v96
    v_cos_f32 v68, v95
    v_sin_f32 v69, v95
    v_cos_f32 v76, v97
    v_sin_f32 v77, v97
    v_pk_mul_f32 v[68:69], v[68:69], v[94:95] op_sel_hi:[1,0]
    v_pk_mul_f32 v[76:77], v[76:77], v[96:97] op_sel_hi:[1,0]
    v_pk_mul_f32 v[92:93], v[76:77], v[76:77] op_sel:[1,1] op_sel_hi:[0,1]
    v_pk_fma_f32 v[78:79], v[76:77], v[76:77], v[92:93] op_sel:[0,0,0] op_sel_hi:[0,1,1] neg_lo:[0,0,1]
    v_pk_mul_f32 v[94:95], v[68:69], v[68:69] op_sel:[1,1] op_sel_hi:[0,1]
    v_pk_fma_f32 v[70:71], v[68:69], v[68:69], v[94:95] op_sel:[0,0,0] op_sel_hi:[0,1,1] neg_lo:[0,0,1]
    v_pk_mul_f32 v[92:93], v[78:79], v[78:79] op_sel:[1,1] op_sel_hi:[0,1]
    v_pk_fma_f32 v[80:81], v[78:79], v[78:79], v[92:93] op_sel:[0,0,0] op_sel_hi:[0,1,1] neg_lo:[0,0,1]
    v_pk_mul_f32 v[94:95], v[70:71], v[70:71] op_sel:[1,1] op_sel_hi:[0,1]
    v_pk_fma_f32 v[72:73], v[70:71], v[70:71], v[94:95] op_sel:[0,0,0] op_sel_hi:[0,1,1] neg_lo:[0,0,1]
    v_pk_mul_f32 v[92:93], v[80:81], v[80:81] op_sel:[1,1] op_sel_hi:[0,1]
    v_pk_fma_f32 v[82:83], v[80:81], v[80:81], v[92:93] op_sel:[0,0,0] op_sel_hi:[0,1,1] neg_lo:[0,0,1]
    v_pk_mul_f32 v[94:95], v[72:73], v[72:73] op_sel:[1,1] op_sel_hi:[0,1]
    v_pk_fma_f32 v[74:75], v[72:73], v[72:73], v[94:95] op_sel:[0,0,0] op_sel_hi:[0,1,1] neg_lo:[0,0,1]
    v_pk_mul_f32 v[92:93], v[82:83], v[82:83] op_sel:[1,1] op_sel_hi:[0,1]
    v_pk_fma_f32 v[84:85], v[82:83], v[82:83], v[92:93] op_sel:[0,0,0] op_sel_hi:[0,1,1] neg_lo:[0,0,1]
    v_pk_mul_f32 v[94:95], v[66:67], v[76:77] op_sel:[1,1] op_sel_hi:[1,0]
    v_pk_fma_f32 v[86:87], v[66:67], v[76:77], v[94:95] op_sel:[0,0,0] op_sel_hi:[0,1,1] neg_lo:[0,0,1] neg_hi:[1,0,1]
    v_mov_b32_dpp v80, v78 row_ror:8 row_mask:0xf bank_mask:0x3
    v_mov_b32_dpp v81, v79 row_ror:8 row_mask:0xf bank_mask:0x3
    v_mov_b32_dpp v82, v84 row_ror:8 row_mask:0xf bank_mask:0x3
    v_mov_b32_dpp v83, v85 row_ror:8 row_mask:0xf bank_mask:0x3
    v_pk_mul_f32 v[92:93], v[66:67], v[80:81] op_sel:[1,1] op_sel_hi:[1,0]
    v_pk_fma_f32 v[88:89], v[66:67], v[80:81], v[92:93] op_sel:[0,0,0] op_sel_hi:[0,1,1] neg_lo:[0,0,1] neg_hi:[1,0,1]
    v_pk_mul_f32 v[94:95], v[66:67], v[82:83] op_sel:[1,1] op_sel_hi:[1,0]
    v_pk_fma_f32 v[90:91], v[66:67], v[82:83], v[94:95] op_sel:[0,0,0] op_sel_hi:[0,1,1] neg_lo:[0,0,1] neg_hi:[1,0,1]
    v_mfma_f32_16x16x4_f32 v[48:51], v86, v68, v[48:51]
    v_mfma_f32_16x16x4_f32 v[52:55], v88, v70, v[52:55]
    v_mfma_f32_16x16x4_f32 v[56:59], v88, v72, v[56:59]
    v_mfma_f32_16x16x4_f32 v[60:63], v90, v74, v[60:63]
    v_mfma_f32_16x16x4_f32 v[48:51], v87, v69, v[48:51]
    v_mfma_f32_16x16x4_f32 v[52:55], v89, v71, v[52:55]
    v_mfma_f32_16x16x4_f32 v[56:59], v89, v73, v[56:59]
    v_mfma_f32_16x16x4_f32 v[60:63], v91, v75, v[60:63]
    v_mov_b64_dpp v[64:65], v[28:29] row_newbcast:6 row_mask:0xf bank_mask:0xf
    v_mov_b64_dpp v[66:67], v[30:31] row_newbcast:6 row_mask:0xf bank_mask:0xf
    v_pk_mul_f32 v[94:95], v[64:65], v[26:27] op_sel_hi:[1,0]
    v_pk_mul_f32 v[96:97], v[64:65], v[26:27] op_sel:[0,1] op_sel_hi:[1,1]
    v_fract_f32 v95, v95
    v_fract_f32 v97, v97
    v_exp_f32 v94, v94
    v_exp_f32 v96, v96
    v_cos_f32 v68, v95
    v_sin_f32 v69, v95
    v_cos_f32 v76, v97
    v_sin_f32 v77, v97
    v_pk_mul_f32 v[68:69], v[68:69], v[94:95] op_sel_hi:[1,0]
    v_pk_mul_f32 v[76:77], v[76:77], v[96:97] op_sel_hi:[1,0]
    v_pk_mul_f32 v[92:93], v[76:77], v[76:77] op_sel:[1,1] op_sel_hi:[0,1]
    v_pk_fma_f32 v[78:79], v[76:77], v[76:77], v[92:93] op_sel:[0,0,0] op_sel_hi:[0,1,1] neg_lo:[0,0,1]
    v_pk_mul_f32 v[94:95], v[68:69], v[68:69] op_sel:[1,1] op_sel_hi:[0,1]
    v_pk_fma_f32 v[70:71], v[68:69], v[68:69], v[94:95] op_sel:[0,0,0] op_sel_hi:[0,1,1] neg_lo:[0,0,1]
    v_pk_mul_f32 v[92:93], v[78:79], v[78:79] op_sel:[1,1] op_sel_hi:[0,1]
    v_pk_fma_f32 v[80:81], v[78:79], v[78:79], v[92:93] op_sel:[0,0,0] op_sel_hi:[0,1,1] neg_lo:[0,0,1]
    v_pk_mul_f32 v[94:95], v[70:71], v[70:71] op_sel:[1,1] op_sel_hi:[0,1]
    v_pk_fma_f32 v[72:73], v[70:71], v[70:71], v[94:95] op_sel:[0,0,0] op_sel_hi:[0,1,1] neg_lo:[0,0,1]
    v_pk_mul_f32 v[92:93], v[80:81], v[80:81] op_sel:[1,1] op_sel_hi:[0,1]
    v_pk_fma_f32 v[82:83], v[80:81], v[80:81], v[92:93] op_sel:[0,0,0] op_sel_hi:[0,1,1] neg_lo:[0,0,1]
    v_pk_mul_f32 v[94:95], v[72:73], v[72:73] op_sel:[1,1] op_sel_hi:[0,1]
    v_pk_fma_f32 v[74:75], v[72:73], v[72:73], v[94:95] op_sel:[0,0,0] op_sel_hi:[0,1,1] neg_lo:[0,0,1]
    v_pk_mul_f32 v[92:93], v[82:83], v[82:83] op_sel:[1,1] op_sel_hi:[0,1]
    v_pk_fma_f32 v[84:85], v[82:83], v[82:83], v[92:93] op_sel:[0,0,0] op_sel_hi:[0,1,1] neg_lo:[0,0,1]
    v_pk_mul_f32 v[94:95], v[66:67], v[76:77] op_sel:[1,1] op_sel_hi:[1,0]
    v_pk_fma_f32 v[86:87], v[66:67], v[76:77], v[94:95] op_sel:[0,0,0] op_sel_hi:[0,1,1] neg_lo:[0,0,1] neg_hi:[1,0,1]
    v_mov_b32_dpp v80, v78 row_ror:8 row_mask:0xf bank_mask:0x3
    v_mov_b32_dpp v81, v79 row_ror:8 row_mask:0xf bank_mask:0x3
    v_mov_b32_dpp v82, v84 row_ror:8 row_mask:0xf bank_mask:0x3
    v_mov_b32_dpp v83, v85 row_ror:8 row_mask:0xf bank_mask:0x3
    v_pk_mul_f32 v[92:93], v[66:67], v[80:81] op_sel:[1,1] op_sel_hi:[1,0]
    v_pk_fma_f32 v[88:89], v[66:67], v[80:81], v[92:93] op_sel:[0,0,0] op_sel_hi:[0,1,1] neg_lo:[0,0,1] neg_hi:[1,0,1]
    v_pk_mul_f32 v[94:95], v[66:67], v[82:83] op_sel:[1,1] op_sel_hi:[1,0]
    v_pk_fma_f32 v[90:91], v[66:67], v[82:83], v[94:95] op_sel:[0,0,0] op_sel_hi:[0,1,1] neg_lo:[0,0,1] neg_hi:[1,0,1]
    v_mfma_f32_16x16x4_f32 v[48:51], v86, v68, v[48:51]
    v_mfma_f32_16x16x4_f32 v[52:55], v88, v70, v[52:55]
    v_mfma_f32_16x16x4_f32 v[56:59], v88, v72, v[56:59]
    v_mfma_f32_16x16x4_f32 v[60:63], v90, v74, v[60:63]
    v_mfma_f32_16x16x4_f32 v[48:51], v87, v69, v[48:51]
    v_mfma_f32_16x16x4_f32 v[52:55], v89, v71, v[52:55]
    v_mfma_f32_16x16x4_f32 v[56:59], v89, v73, v[56:59]
    v_mfma_f32_16x16x4_f32 v[60:63], v91, v75, v[60:63]
    v_mov_b64_dpp v[64:65], v[28:29] row_newbcast:7 row_mask:0xf bank_mask:0xf
    v_mov_b64_dpp v[66:67], v[30:31] row_newbcast:7 row_mask:0xf bank_mask:0xf
    v_pk_mul_f32 v[94:95], v[64:65], v[26:27] op_sel_hi:[1,0]
    v_pk_mul_f32 v[96:97], v[64:65], v[26:27] op_sel:[0,1] op_sel_hi:[1,1]
    v_fract_f32 v95, v95
    v_fract_f32 v97, v97
    v_exp_f32 v94, v94
    v_exp_f32 v96, v96
    v_cos_f32 v68, v95
    v_sin_f32 v69, v95
    v_cos_f32 v76, v97
    v_sin_f32 v77, v97
    v_pk_mul_f32 v[68:69], v[68:69], v[94:95] op_sel_hi:[1,0]
    v_pk_mul_f32 v[76:77], v[76:77], v[96:97] op_sel_hi:[1,0]
    v_pk_mul_f32 v[92:93], v[76:77], v[76:77] op_sel:[1,1] op_sel_hi:[0,1]
    v_pk_fma_f32 v[78:79], v[76:77], v[76:77], v[92:93] op_sel:[0,0,0] op_sel_hi:[0,1,1] neg_lo:[0,0,1]
    v_pk_mul_f32 v[94:95], v[68:69], v[68:69] op_sel:[1,1] op_sel_hi:[0,1]
    v_pk_fma_f32 v[70:71], v[68:69], v[68:69], v[94:95] op_sel:[0,0,0] op_sel_hi:[0,1,1] neg_lo:[0,0,1]
    v_pk_mul_f32 v[92:93], v[78:79], v[78:79] op_sel:[1,1] op_sel_hi:[0,1]
    v_pk_fma_f32 v[80:81], v[78:79], v[78:79], v[92:93] op_sel:[0,0,0] op_sel_hi:[0,1,1] neg_lo:[0,0,1]
    v_pk_mul_f32 v[94:95], v[70:71], v[70:71] op_sel:[1,1] op_sel_hi:[0,1]
    v_pk_fma_f32 v[72:73], v[70:71], v[70:71], v[94:95] op_sel:[0,0,0] op_sel_hi:[0,1,1] neg_lo:[0,0,1]
    v_pk_mul_f32 v[92:93], v[80:81], v[80:81] op_sel:[1,1] op_sel_hi:[0,1]
    v_pk_fma_f32 v[82:83], v[80:81], v[80:81], v[92:93] op_sel:[0,0,0] op_sel_hi:[0,1,1] neg_lo:[0,0,1]
    v_pk_mul_f32 v[94:95], v[72:73], v[72:73] op_sel:[1,1] op_sel_hi:[0,1]
    v_pk_fma_f32 v[74:75], v[72:73], v[72:73], v[94:95] op_sel:[0,0,0] op_sel_hi:[0,1,1] neg_lo:[0,0,1]
    v_pk_mul_f32 v[92:93], v[82:83], v[82:83] op_sel:[1,1] op_sel_hi:[0,1]
    v_pk_fma_f32 v[84:85], v[82:83], v[82:83], v[92:93] op_sel:[0,0,0] op_sel_hi:[0,1,1] neg_lo:[0,0,1]
    v_pk_mul_f32 v[94:95], v[66:67], v[76:77] op_sel:[1,1] op_sel_hi:[1,0]
    v_pk_fma_f32 v[86:87], v[66:67], v[76:77], v[94:95] op_sel:[0,0,0] op_sel_hi:[0,1,1] neg_lo:[0,0,1] neg_hi:[1,0,1]
    v_mov_b32_dpp v80, v78 row_ror:8 row_mask:0xf bank_mask:0x3
    v_mov_b32_dpp v81, v79 row_ror:8 row_mask:0xf bank_mask:0x3
    v_mov_b32_dpp v82, v84 row_ror:8 row_mask:0xf bank_mask:0x3
    v_mov_b32_dpp v83, v85 row_ror:8 row_mask:0xf bank_mask:0x3
    v_pk_mul_f32 v[92:93], v[66:67], v[80:81] op_sel:[1,1] op_sel_hi:[1,0]
    v_pk_fma_f32 v[88:89], v[66:67], v[80:81], v[92:93] op_sel:[0,0,0] op_sel_hi:[0,1,1] neg_lo:[0,0,1] neg_hi:[1,0,1]
    v_pk_mul_f32 v[94:95], v[66:67], v[82:83] op_sel:[1,1] op_sel_hi:[1,0]
    v_pk_fma_f32 v[90:91], v[66:67], v[82:83], v[94:95] op_sel:[0,0,0] op_sel_hi:[0,1,1] neg_lo:[0,0,1] neg_hi:[1,0,1]
    v_mfma_f32_16x16x4_f32 v[48:51], v86, v68, v[48:51]
    v_mfma_f32_16x16x4_f32 v[52:55], v88, v70, v[52:55]
    v_mfma_f32_16x16x4_f32 v[56:59], v88, v72, v[56:59]
    v_mfma_f32_16x16x4_f32 v[60:63], v90, v74, v[60:63]
    v_mfma_f32_16x16x4_f32 v[48:51], v87, v69, v[48:51]
    v_mfma_f32_16x16x4_f32 v[52:55], v89, v71, v[52:55]
    v_mfma_f32_16x16x4_f32 v[56:59], v89, v73, v[56:59]
    v_mfma_f32_16x16x4_f32 v[60:63], v91, v75, v[60:63]
    v_mov_b64_dpp v[64:65], v[28:29] row_newbcast:8 row_mask:0xf bank_mask:0xf
    v_mov_b64_dpp v[66:67], v[30:31] row_newbcast:8 row_mask:0xf bank_mask:0xf
    v_pk_mul_f32 v[94:95], v[64:65], v[26:27] op_sel_hi:[1,0]
    v_pk_mul_f32 v[96:97], v[64:65], v[26:27] op_sel:[0,1] op_sel_hi:[1,1]
    v_fract_f32 v95, v95
    v_fract_f32 v97, v97
    v_exp_f32 v94, v94
    v_exp_f32 v96, v96
    v_cos_f32 v68, v95
    v_sin_f32 v69, v95
    v_cos_f32 v76, v97
    v_sin_f32 v77, v97
    v_pk_mul_f32 v[68:69], v[68:69], v[94:95] op_sel_hi:[1,0]
    v_pk_mul_f32 v[76:77], v[76:77], v[96:97] op_sel_hi:[1,0]
    v_pk_mul_f32 v[92:93], v[76:77], v[76:77] op_sel:[1,1] op_sel_hi:[0,1]
    v_pk_fma_f32 v[78:79], v[76:77], v[76:77], v[92:93] op_sel:[0,0,0] op_sel_hi:[0,1,1] neg_lo:[0,0,1]
    v_pk_mul_f32 v[94:95], v[68:69], v[68:69] op_sel:[1,1] op_sel_hi:[0,1]
    v_pk_fma_f32 v[70:71], v[68:69], v[68:69], v[94:95] op_sel:[0,0,0] op_sel_hi:[0,1,1] neg_lo:[0,0,1]
    v_pk_mul_f32 v[92:93], v[78:79], v[78:79] op_sel:[1,1] op_sel_hi:[0,1]
    v_pk_fma_f32 v[80:81], v[78:79], v[78:79], v[92:93] op_sel:[0,0,0] op_sel_hi:[0,1,1] neg_lo:[0,0,1]
    v_pk_mul_f32 v[94:95], v[70:71], v[70:71] op_sel:[1,1] op_sel_hi:[0,1]
    v_pk_fma_f32 v[72:73], v[70:71], v[70:71], v[94:95] op_sel:[0,0,0] op_sel_hi:[0,1,1] neg_lo:[0,0,1]
    v_pk_mul_f32 v[92:93], v[80:81], v[80:81] op_sel:[1,1] op_sel_hi:[0,1]
    v_pk_fma_f32 v[82:83], v[80:81], v[80:81], v[92:93] op_sel:[0,0,0] op_sel_hi:[0,1,1] neg_lo:[0,0,1]
    v_pk_mul_f32 v[94:95], v[72:73], v[72:73] op_sel:[1,1] op_sel_hi:[0,1]
    v_pk_fma_f32 v[74:75], v[72:73], v[72:73], v[94:95] op_sel:[0,0,0] op_sel_hi:[0,1,1] neg_lo:[0,0,1]
    v_pk_mul_f32 v[92:93], v[82:83], v[82:83] op_sel:[1,1] op_sel_hi:[0,1]
    v_pk_fma_f32 v[84:85], v[82:83], v[82:83], v[92:93] op_sel:[0,0,0] op_sel_hi:[0,1,1] neg_lo:[0,0,1]
    v_pk_mul_f32 v[94:95], v[66:67], v[76:77] op_sel:[1,1] op_sel_hi:[1,0]
    v_pk_fma_f32 v[86:87], v[66:67], v[76:77], v[94:95] op_sel:[0,0,0] op_sel_hi:[0,1,1] neg_lo:[0,0,1] neg_hi:[1,0,1]
    v_mov_b32_dpp v80, v78 row_ror:8 row_mask:0xf bank_mask:0x3
    v_mov_b32_dpp v81, v79 row_ror:8 row_mask:0xf bank_mask:0x3
    v_mov_b32_dpp v82, v84 row_ror:8 row_mask:0xf bank_mask:0x3
    v_mov_b32_dpp v83, v85 row_ror:8 row_mask:0xf bank_mask:0x3
    v_pk_mul_f32 v[92:93], v[66:67], v[80:81] op_sel:[1,1] op_sel_hi:[1,0]
    v_pk_fma_f32 v[88:89], v[66:67], v[80:81], v[92:93] op_sel:[0,0,0] op_sel_hi:[0,1,1] neg_lo:[0,0,1] neg_hi:[1,0,1]
    v_pk_mul_f32 v[94:95], v[66:67], v[82:83] op_sel:[1,1] op_sel_hi:[1,0]
    v_pk_fma_f32 v[90:91], v[66:67], v[82:83], v[94:95] op_sel:[0,0,0] op_sel_hi:[0,1,1] neg_lo:[0,0,1] neg_hi:[1,0,1]
    v_mfma_f32_16x16x4_f32 v[48:51], v86, v68, v[48:51]
    v_mfma_f32_16x16x4_f32 v[52:55], v88, v70, v[52:55]
    v_mfma_f32_16x16x4_f32 v[56:59], v88, v72, v[56:59]
    v_mfma_f32_16x16x4_f32 v[60:63], v90, v74, v[60:63]
    v_mfma_f32_16x16x4_f32 v[48:51], v87, v69, v[48:51]
    v_mfma_f32_16x16x4_f32 v[52:55], v89, v71, v[52:55]
    v_mfma_f32_16x16x4_f32 v[56:59], v89, v73, v[56:59]
    v_mfma_f32_16x16x4_f32 v[60:63], v91, v75, v[60:63]
    v_mov_b64_dpp v[64:65], v[28:29] row_newbcast:9 row_mask:0xf bank_mask:0xf
    v_mov_b64_dpp v[66:67], v[30:31] row_newbcast:9 row_mask:0xf bank_mask:0xf
    v_pk_mul_f32 v[94:95], v[64:65], v[26:27] op_sel_hi:[1,0]
    v_pk_mul_f32 v[96:97], v[64:65], v[26:27] op_sel:[0,1] op_sel_hi:[1,1]
    v_fract_f32 v95, v95
    v_fract_f32 v97, v97
    v_exp_f32 v94, v94
    v_exp_f32 v96, v96
    v_cos_f32 v68, v95
    v_sin_f32 v69, v95
    v_cos_f32 v76, v97
    v_sin_f32 v77, v97
    v_pk_mul_f32 v[68:69], v[68:69], v[94:95] op_sel_hi:[1,0]
    v_pk_mul_f32 v[76:77], v[76:77], v[96:97] op_sel_hi:[1,0]
    v_pk_mul_f32 v[92:93], v[76:77], v[76:77] op_sel:[1,1] op_sel_hi:[0,1]
    v_pk_fma_f32 v[78:79], v[76:77], v[76:77], v[92:93] op_sel:[0,0,0] op_sel_hi:[0,1,1] neg_lo:[0,0,1]
    v_pk_mul_f32 v[94:95], v[68:69], v[68:69] op_sel:[1,1] op_sel_hi:[0,1]
    v_pk_fma_f32 v[70:71], v[68:69], v[68:69], v[94:95] op_sel:[0,0,0] op_sel_hi:[0,1,1] neg_lo:[0,0,1]
    v_pk_mul_f32 v[92:93], v[78:79], v[78:79] op_sel:[1,1] op_sel_hi:[0,1]
    v_pk_fma_f32 v[80:81], v[78:79], v[78:79], v[92:93] op_sel:[0,0,0] op_sel_hi:[0,1,1] neg_lo:[0,0,1]
    v_pk_mul_f32 v[94:95], v[70:71], v[70:71] op_sel:[1,1] op_sel_hi:[0,1]
    v_pk_fma_f32 v[72:73], v[70:71], v[70:71], v[94:95] op_sel:[0,0,0] op_sel_hi:[0,1,1] neg_lo:[0,0,1]
    v_pk_mul_f32 v[92:93], v[80:81], v[80:81] op_sel:[1,1] op_sel_hi:[0,1]
    v_pk_fma_f32 v[82:83], v[80:81], v[80:81], v[92:93] op_sel:[0,0,0] op_sel_hi:[0,1,1] neg_lo:[0,0,1]
    v_pk_mul_f32 v[94:95], v[72:73], v[72:73] op_sel:[1,1] op_sel_hi:[0,1]
    v_pk_fma_f32 v[74:75], v[72:73], v[72:73], v[94:95] op_sel:[0,0,0] op_sel_hi:[0,1,1] neg_lo:[0,0,1]
    v_pk_mul_f32 v[92:93], v[82:83], v[82:83] op_sel:[1,1] op_sel_hi:[0,1]
    v_pk_fma_f32 v[84:85], v[82:83], v[82:83], v[92:93] op_sel:[0,0,0] op_sel_hi:[0,1,1] neg_lo:[0,0,1]
    v_pk_mul_f32 v[94:95], v[66:67], v[76:77] op_sel:[1,1] op_sel_hi:[1,0]
    v_pk_fma_f32 v[86:87], v[66:67], v[76:77], v[94:95] op_sel:[0,0,0] op_sel_hi:[0,1,1] neg_lo:[0,0,1] neg_hi:[1,0,1]
    v_mov_b32_dpp v80, v78 row_ror:8 row_mask:0xf bank_mask:0x3
    v_mov_b32_dpp v81, v79 row_ror:8 row_mask:0xf bank_mask:0x3
    v_mov_b32_dpp v82, v84 row_ror:8 row_mask:0xf bank_mask:0x3
    v_mov_b32_dpp v83, v85 row_ror:8 row_mask:0xf bank_mask:0x3
    v_pk_mul_f32 v[92:93], v[66:67], v[80:81] op_sel:[1,1] op_sel_hi:[1,0]
    v_pk_fma_f32 v[88:89], v[66:67], v[80:81], v[92:93] op_sel:[0,0,0] op_sel_hi:[0,1,1] neg_lo:[0,0,1] neg_hi:[1,0,1]
    v_pk_mul_f32 v[94:95], v[66:67], v[82:83] op_sel:[1,1] op_sel_hi:[1,0]
    v_pk_fma_f32 v[90:91], v[66:67], v[82:83], v[94:95] op_sel:[0,0,0] op_sel_hi:[0,1,1] neg_lo:[0,0,1] neg_hi:[1,0,1]
    v_mfma_f32_16x16x4_f32 v[48:51], v86, v68, v[48:51]
    v_mfma_f32_16x16x4_f32 v[52:55], v88, v70, v[52:55]
    v_mfma_f32_16x16x4_f32 v[56:59], v88, v72, v[56:59]
    v_mfma_f32_16x16x4_f32 v[60:63], v90, v74, v[60:63]
    v_mfma_f32_16x16x4_f32 v[48:51], v87, v69, v[48:51]
    v_mfma_f32_16x16x4_f32 v[52:55], v89, v71, v[52:55]
    v_mfma_f32_16x16x4_f32 v[56:59], v89, v73, v[56:59]
    v_mfma_f32_16x16x4_f32 v[60:63], v91, v75, v[60:63]
    v_mov_b64_dpp v[64:65], v[28:29] row_newbcast:10 row_mask:0xf bank_mask:0xf
    v_mov_b64_dpp v[66:67], v[30:31] row_newbcast:10 row_mask:0xf bank_mask:0xf
    v_pk_mul_f32 v[94:95], v[64:65], v[26:27] op_sel_hi:[1,0]
    v_pk_mul_f32 v[96:97], v[64:65], v[26:27] op_sel:[0,1] op_sel_hi:[1,1]
    v_fract_f32 v95, v95
    v_fract_f32 v97, v97
    v_exp_f32 v94, v94
    v_exp_f32 v96, v96
    v_cos_f32 v68, v95
    v_sin_f32 v69, v95
    v_cos_f32 v76, v97
    v_sin_f32 v77, v97
    v_pk_mul_f32 v[68:69], v[68:69], v[94:95] op_sel_hi:[1,0]
    v_pk_mul_f32 v[76:77], v[76:77], v[96:97] op_sel_hi:[1,0]
    v_pk_mul_f32 v[92:93], v[76:77], v[76:77] op_sel:[1,1] op_sel_hi:[0,1]
    v_pk_fma_f32 v[78:79], v[76:77], v[76:77], v[92:93] op_sel:[0,0,0] op_sel_hi:[0,1,1] neg_lo:[0,0,1]
    v_pk_mul_f32 v[94:95], v[68:69], v[68:69] op_sel:[1,1] op_sel_hi:[0,1]
    v_pk_fma_f32 v[70:71], v[68:69], v[68:69], v[94:95] op_sel:[0,0,0] op_sel_hi:[0,1,1] neg_lo:[0,0,1]
    v_pk_mul_f32 v[92:93], v[78:79], v[78:79] op_sel:[1,1] op_sel_hi:[0,1]
    v_pk_fma_f32 v[80:81], v[78:79], v[78:79], v[92:93] op_sel:[0,0,0] op_sel_hi:[0,1,1] neg_lo:[0,0,1]
    v_pk_mul_f32 v[94:95], v[70:71], v[70:71] op_sel:[1,1] op_sel_hi:[0,1]
    v_pk_fma_f32 v[72:73], v[70:71], v[70:71], v[94:95] op_sel:[0,0,0] op_sel_hi:[0,1,1] neg_lo:[0,0,1]
    v_pk_mul_f32 v[92:93], v[80:81], v[80:81] op_sel:[1,1] op_sel_hi:[0,1]
    v_pk_fma_f32 v[82:83], v[80:81], v[80:81], v[92:93] op_sel:[0,0,0] op_sel_hi:[0,1,1] neg_lo:[0,0,1]
    v_pk_mul_f32 v[94:95], v[72:73], v[72:73] op_sel:[1,1] op_sel_hi:[0,1]
    v_pk_fma_f32 v[74:75], v[72:73], v[72:73], v[94:95] op_sel:[0,0,0] op_sel_hi:[0,1,1] neg_lo:[0,0,1]
    v_pk_mul_f32 v[92:93], v[82:83], v[82:83] op_sel:[1,1] op_sel_hi:[0,1]
    v_pk_fma_f32 v[84:85], v[82:83], v[82:83], v[92:93] op_sel:[0,0,0] op_sel_hi:[0,1,1] neg_lo:[0,0,1]
    v_pk_mul_f32 v[94:95], v[66:67], v[76:77] op_sel:[1,1] op_sel_hi:[1,0]
    v_pk_fma_f32 v[86:87], v[66:67], v[76:77], v[94:95] op_sel:[0,0,0] op_sel_hi:[0,1,1] neg_lo:[0,0,1] neg_hi:[1,0,1]
    v_mov_b32_dpp v80, v78 row_ror:8 row_mask:0xf bank_mask:0x3
    v_mov_b32_dpp v81, v79 row_ror:8 row_mask:0xf bank_mask:0x3
    v_mov_b32_dpp v82, v84 row_ror:8 row_mask:0xf bank_mask:0x3
    v_mov_b32_dpp v83, v85 row_ror:8 row_mask:0xf bank_mask:0x3
    v_pk_mul_f32 v[92:93], v[66:67], v[80:81] op_sel:[1,1] op_sel_hi:[1,0]
    v_pk_fma_f32 v[88:89], v[66:67], v[80:81], v[92:93] op_sel:[0,0,0] op_sel_hi:[0,1,1] neg_lo:[0,0,1] neg_hi:[1,0,1]
    v_pk_mul_f32 v[94:95], v[66:67], v[82:83] op_sel:[1,1] op_sel_hi:[1,0]
    v_pk_fma_f32 v[90:91], v[66:67], v[82:83], v[94:95] op_sel:[0,0,0] op_sel_hi:[0,1,1] neg_lo:[0,0,1] neg_hi:[1,0,1]
    v_mfma_f32_16x16x4_f32 v[48:51], v86, v68, v[48:51]
    v_mfma_f32_16x16x4_f32 v[52:55], v88, v70, v[52:55]
    v_mfma_f32_16x16x4_f32 v[56:59], v88, v72, v[56:59]
    v_mfma_f32_16x16x4_f32 v[60:63], v90, v74, v[60:63]
    v_mfma_f32_16x16x4_f32 v[48:51], v87, v69, v[48:51]
    v_mfma_f32_16x16x4_f32 v[52:55], v89, v71, v[52:55]
    v_mfma_f32_16x16x4_f32 v[56:59], v89, v73, v[56:59]
    v_mfma_f32_16x16x4_f32 v[60:63], v91, v75, v[60:63]
    v_mov_b64_dpp v[64:65], v[28:29] row_newbcast:11 row_mask:0xf bank_mask:0xf
    v_mov_b64_dpp v[66:67], v[30:31] row_newbcast:11 row_mask:0xf bank_mask:0xf
    v_pk_mul_f32 v[94:95], v[64:65], v[26:27] op_sel_hi:[1,0]
    v_pk_mul_f32 v[96:97], v[64:65], v[26:27] op_sel:[0,1] op_sel_hi:[1,1]
    v_fract_f32 v95, v95
    v_fract_f32 v97, v97
    v_exp_f32 v94, v94
    v_exp_f32 v96, v96
    v_cos_f32 v68, v95
    v_sin_f32 v69, v95
    v_cos_f32 v76, v97
    v_sin_f32 v77, v97
    v_pk_mul_f32 v[68:69], v[68:69], v[94:95] op_sel_hi:[1,0]
    v_pk_mul_f32 v[76:77], v[76:77], v[96:97] op_sel_hi:[1,0]
    v_pk_mul_f32 v[92:93], v[76:77], v[76:77] op_sel:[1,1] op_sel_hi:[0,1]
    v_pk_fma_f32 v[78:79], v[76:77], v[76:77], v[92:93] op_sel:[0,0,0] op_sel_hi:[0,1,1] neg_lo:[0,0,1]
    v_pk_mul_f32 v[94:95], v[68:69], v[68:69] op_sel:[1,1] op_sel_hi:[0,1]
    v_pk_fma_f32 v[70:71], v[68:69], v[68:69], v[94:95] op_sel:[0,0,0] op_sel_hi:[0,1,1] neg_lo:[0,0,1]
    v_pk_mul_f32 v[92:93], v[78:79], v[78:79] op_sel:[1,1] op_sel_hi:[0,1]
    v_pk_fma_f32 v[80:81], v[78:79], v[78:79], v[92:93] op_sel:[0,0,0] op_sel_hi:[0,1,1] neg_lo:[0,0,1]
    v_pk_mul_f32 v[94:95], v[70:71], v[70:71] op_sel:[1,1] op_sel_hi:[0,1]
    v_pk_fma_f32 v[72:73], v[70:71], v[70:71], v[94:95] op_sel:[0,0,0] op_sel_hi:[0,1,1] neg_lo:[0,0,1]
    v_pk_mul_f32 v[92:93], v[80:81], v[80:81] op_sel:[1,1] op_sel_hi:[0,1]
    v_pk_fma_f32 v[82:83], v[80:81], v[80:81], v[92:93] op_sel:[0,0,0] op_sel_hi:[0,1,1] neg_lo:[0,0,1]
    v_pk_mul_f32 v[94:95], v[72:73], v[72:73] op_sel:[1,1] op_sel_hi:[0,1]
    v_pk_fma_f32 v[74:75], v[72:73], v[72:73], v[94:95] op_sel:[0,0,0] op_sel_hi:[0,1,1] neg_lo:[0,0,1]
    v_pk_mul_f32 v[92:93], v[82:83], v[82:83] op_sel:[1,1] op_sel_hi:[0,1]
    v_pk_fma_f32 v[84:85], v[82:83], v[82:83], v[92:93] op_sel:[0,0,0] op_sel_hi:[0,1,1] neg_lo:[0,0,1]
    v_pk_mul_f32 v[94:95], v[66:67], v[76:77] op_sel:[1,1] op_sel_hi:[1,0]
    v_pk_fma_f32 v[86:87], v[66:67], v[76:77], v[94:95] op_sel:[0,0,0] op_sel_hi:[0,1,1] neg_lo:[0,0,1] neg_hi:[1,0,1]
    v_mov_b32_dpp v80, v78 row_ror:8 row_mask:0xf bank_mask:0x3
    v_mov_b32_dpp v81, v79 row_ror:8 row_mask:0xf bank_mask:0x3
    v_mov_b32_dpp v82, v84 row_ror:8 row_mask:0xf bank_mask:0x3
    v_mov_b32_dpp v83, v85 row_ror:8 row_mask:0xf bank_mask:0x3
    v_pk_mul_f32 v[92:93], v[66:67], v[80:81] op_sel:[1,1] op_sel_hi:[1,0]
    v_pk_fma_f32 v[88:89], v[66:67], v[80:81], v[92:93] op_sel:[0,0,0] op_sel_hi:[0,1,1] neg_lo:[0,0,1] neg_hi:[1,0,1]
    v_pk_mul_f32 v[94:95], v[66:67], v[82:83] op_sel:[1,1] op_sel_hi:[1,0]
    v_pk_fma_f32 v[90:91], v[66:67], v[82:83], v[94:95] op_sel:[0,0,0] op_sel_hi:[0,1,1] neg_lo:[0,0,1] neg_hi:[1,0,1]
    v_mfma_f32_16x16x4_f32 v[48:51], v86, v68, v[48:51]
    v_mfma_f32_16x16x4_f32 v[52:55], v88, v70, v[52:55]
    v_mfma_f32_16x16x4_f32 v[56:59], v88, v72, v[56:59]
    v_mfma_f32_16x16x4_f32 v[60:63], v90, v74, v[60:63]
    v_mfma_f32_16x16x4_f32 v[48:51], v87, v69, v[48:51]
    v_mfma_f32_16x16x4_f32 v[52:55], v89, v71, v[52:55]
    v_mfma_f32_16x16x4_f32 v[56:59], v89, v73, v[56:59]
    v_mfma_f32_16x16x4_f32 v[60:63], v91, v75, v[60:63]
    v_mov_b64_dpp v[64:65], v[28:29] row_newbcast:12 row_mask:0xf bank_mask:0xf
    v_mov_b64_dpp v[66:67], v[30:31] row_newbcast:12 row_mask:0xf bank_mask:0xf
    v_pk_mul_f32 v[94:95], v[64:65], v[26:27] op_sel_hi:[1,0]
    v_pk_mul_f32 v[96:97], v[64:65], v[26:27] op_sel:[0,1] op_sel_hi:[1,1]
    v_fract_f32 v95, v95
    v_fract_f32 v97, v97
    v_exp_f32 v94, v94
    v_exp_f32 v96, v96
    v_cos_f32 v68, v95
    v_sin_f32 v69, v95
    v_cos_f32 v76, v97
    v_sin_f32 v77, v97
    v_pk_mul_f32 v[68:69], v[68:69], v[94:95] op_sel_hi:[1,0]
    v_pk_mul_f32 v[76:77], v[76:77], v[96:97] op_sel_hi:[1,0]
    v_pk_mul_f32 v[92:93], v[76:77], v[76:77] op_sel:[1,1] op_sel_hi:[0,1]
    v_pk_fma_f32 v[78:79], v[76:77], v[76:77], v[92:93] op_sel:[0,0,0] op_sel_hi:[0,1,1] neg_lo:[0,0,1]
    v_pk_mul_f32 v[94:95], v[68:69], v[68:69] op_sel:[1,1] op_sel_hi:[0,1]
    v_pk_fma_f32 v[70:71], v[68:69], v[68:69], v[94:95] op_sel:[0,0,0] op_sel_hi:[0,1,1] neg_lo:[0,0,1]
    v_pk_mul_f32 v[92:93], v[78:79], v[78:79] op_sel:[1,1] op_sel_hi:[0,1]
    v_pk_fma_f32 v[80:81], v[78:79], v[78:79], v[92:93] op_sel:[0,0,0] op_sel_hi:[0,1,1] neg_lo:[0,0,1]
    v_pk_mul_f32 v[94:95], v[70:71], v[70:71] op_sel:[1,1] op_sel_hi:[0,1]
    v_pk_fma_f32 v[72:73], v[70:71], v[70:71], v[94:95] op_sel:[0,0,0] op_sel_hi:[0,1,1] neg_lo:[0,0,1]
    v_pk_mul_f32 v[92:93], v[80:81], v[80:81] op_sel:[1,1] op_sel_hi:[0,1]
    v_pk_fma_f32 v[82:83], v[80:81], v[80:81], v[92:93] op_sel:[0,0,0] op_sel_hi:[0,1,1] neg_lo:[0,0,1]
    v_pk_mul_f32 v[94:95], v[72:73], v[72:73] op_sel:[1,1] op_sel_hi:[0,1]
    v_pk_fma_f32 v[74:75], v[72:73], v[72:73], v[94:95] op_sel:[0,0,0] op_sel_hi:[0,1,1] neg_lo:[0,0,1]
    v_pk_mul_f32 v[92:93], v[82:83], v[82:83] op_sel:[1,1] op_sel_hi:[0,1]
    v_pk_fma_f32 v[84:85], v[82:83], v[82:83], v[92:93] op_sel:[0,0,0] op_sel_hi:[0,1,1] neg_lo:[0,0,1]
    v_pk_mul_f32 v[94:95], v[66:67], v[76:77] op_sel:[1,1] op_sel_hi:[1,0]
    v_pk_fma_f32 v[86:87], v[66:67], v[76:77], v[94:95] op_sel:[0,0,0] op_sel_hi:[0,1,1] neg_lo:[0,0,1] neg_hi:[1,0,1]
    v_mov_b32_dpp v80, v78 row_ror:8 row_mask:0xf bank_mask:0x3
    v_mov_b32_dpp v81, v79 row_ror:8 row_mask:0xf bank_mask:0x3
    v_mov_b32_dpp v82, v84 row_ror:8 row_mask:0xf bank_mask:0x3
    v_mov_b32_dpp v83, v85 row_ror:8 row_mask:0xf bank_mask:0x3
    v_pk_mul_f32 v[92:93], v[66:67], v[80:81] op_sel:[1,1] op_sel_hi:[1,0]
    v_pk_fma_f32 v[88:89], v[66:67], v[80:81], v[92:93] op_sel:[0,0,0] op_sel_hi:[0,1,1] neg_lo:[0,0,1] neg_hi:[1,0,1]
    v_pk_mul_f32 v[94:95], v[66:67], v[82:83] op_sel:[1,1] op_sel_hi:[1,0]
    v_pk_fma_f32 v[90:91], v[66:67], v[82:83], v[94:95] op_sel:[0,0,0] op_sel_hi:[0,1,1] neg_lo:[0,0,1] neg_hi:[1,0,1]
    v_mfma_f32_16x16x4_f32 v[48:51], v86, v68, v[48:51]
    v_mfma_f32_16x16x4_f32 v[52:55], v88, v70, v[52:55]
    v_mfma_f32_16x16x4_f32 v[56:59], v88, v72, v[56:59]
    v_mfma_f32_16x16x4_f32 v[60:63], v90, v74, v[60:63]
    v_mfma_f32_16x16x4_f32 v[48:51], v87, v69, v[48:51]
    v_mfma_f32_16x16x4_f32 v[52:55], v89, v71, v[52:55]
    v_mfma_f32_16x16x4_f32 v[56:59], v89, v73, v[56:59]
    v_mfma_f32_16x16x4_f32 v[60:63], v91, v75, v[60:63]
    v_mov_b64_dpp v[64:65], v[28:29] row_newbcast:13 row_mask:0xf bank_mask:0xf
    v_mov_b64_dpp v[66:67], v[30:31] row_newbcast:13 row_mask:0xf bank_mask:0xf
    v_pk_mul_f32 v[94:95], v[64:65], v[26:27] op_sel_hi:[1,0]
    v_pk_mul_f32 v[96:97], v[64:65], v[26:27] op_sel:[0,1] op_sel_hi:[1,1]
    v_fract_f32 v95, v95
    v_fract_f32 v97, v97
    v_exp_f32 v94, v94
    v_exp_f32 v96, v96
    v_cos_f32 v68, v95
    v_sin_f32 v69, v95
    v_cos_f32 v76, v97
    v_sin_f32 v77, v97
    v_pk_mul_f32 v[68:69], v[68:69], v[94:95] op_sel_hi:[1,0]
    v_pk_mul_f32 v[76:77], v[76:77], v[96:97] op_sel_hi:[1,0]
    v_pk_mul_f32 v[92:93], v[76:77], v[76:77] op_sel:[1,1] op_sel_hi:[0,1]
    v_pk_fma_f32 v[78:79], v[76:77], v[76:77], v[92:93] op_sel:[0,0,0] op_sel_hi:[0,1,1] neg_lo:[0,0,1]
    v_pk_mul_f32 v[94:95], v[68:69], v[68:69] op_sel:[1,1] op_sel_hi:[0,1]
    v_pk_fma_f32 v[70:71], v[68:69], v[68:69], v[94:95] op_sel:[0,0,0] op_sel_hi:[0,1,1] neg_lo:[0,0,1]
    v_pk_mul_f32 v[92:93], v[78:79], v[78:79] op_sel:[1,1] op_sel_hi:[0,1]
    v_pk_fma_f32 v[80:81], v[78:79], v[78:79], v[92:93] op_sel:[0,0,0] op_sel_hi:[0,1,1] neg_lo:[0,0,1]
    v_pk_mul_f32 v[94:95], v[70:71], v[70:71] op_sel:[1,1] op_sel_hi:[0,1]
    v_pk_fma_f32 v[72:73], v[70:71], v[70:71], v[94:95] op_sel:[0,0,0] op_sel_hi:[0,1,1] neg_lo:[0,0,1]
    v_pk_mul_f32 v[92:93], v[80:81], v[80:81] op_sel:[1,1] op_sel_hi:[0,1]
    v_pk_fma_f32 v[82:83], v[80:81], v[80:81], v[92:93] op_sel:[0,0,0] op_sel_hi:[0,1,1] neg_lo:[0,0,1]
    v_pk_mul_f32 v[94:95], v[72:73], v[72:73] op_sel:[1,1] op_sel_hi:[0,1]
    v_pk_fma_f32 v[74:75], v[72:73], v[72:73], v[94:95] op_sel:[0,0,0] op_sel_hi:[0,1,1] neg_lo:[0,0,1]
    v_pk_mul_f32 v[92:93], v[82:83], v[82:83] op_sel:[1,1] op_sel_hi:[0,1]
    v_pk_fma_f32 v[84:85], v[82:83], v[82:83], v[92:93] op_sel:[0,0,0] op_sel_hi:[0,1,1] neg_lo:[0,0,1]
    v_pk_mul_f32 v[94:95], v[66:67], v[76:77] op_sel:[1,1] op_sel_hi:[1,0]
    v_pk_fma_f32 v[86:87], v[66:67], v[76:77], v[94:95] op_sel:[0,0,0] op_sel_hi:[0,1,1] neg_lo:[0,0,1] neg_hi:[1,0,1]
    v_mov_b32_dpp v80, v78 row_ror:8 row_mask:0xf bank_mask:0x3
    v_mov_b32_dpp v81, v79 row_ror:8 row_mask:0xf bank_mask:0x3
    v_mov_b32_dpp v82, v84 row_ror:8 row_mask:0xf bank_mask:0x3
    v_mov_b32_dpp v83, v85 row_ror:8 row_mask:0xf bank_mask:0x3
    v_pk_mul_f32 v[92:93], v[66:67], v[80:81] op_sel:[1,1] op_sel_hi:[1,0]
    v_pk_fma_f32 v[88:89], v[66:67], v[80:81], v[92:93] op_sel:[0,0,0] op_sel_hi:[0,1,1] neg_lo:[0,0,1] neg_hi:[1,0,1]
    v_pk_mul_f32 v[94:95], v[66:67], v[82:83] op_sel:[1,1] op_sel_hi:[1,0]
    v_pk_fma_f32 v[90:91], v[66:67], v[82:83], v[94:95] op_sel:[0,0,0] op_sel_hi:[0,1,1] neg_lo:[0,0,1] neg_hi:[1,0,1]
    v_mfma_f32_16x16x4_f32 v[48:51], v86, v68, v[48:51]
    v_mfma_f32_16x16x4_f32 v[52:55], v88, v70, v[52:55]
    v_mfma_f32_16x16x4_f32 v[56:59], v88, v72, v[56:59]
    v_mfma_f32_16x16x4_f32 v[60:63], v90, v74, v[60:63]
    v_mfma_f32_16x16x4_f32 v[48:51], v87, v69, v[48:51]
    v_mfma_f32_16x16x4_f32 v[52:55], v89, v71, v[52:55]
    v_mfma_f32_16x16x4_f32 v[56:59], v89, v73, v[56:59]
    v_mfma_f32_16x16x4_f32 v[60:63], v91, v75, v[60:63]
    v_mov_b64_dpp v[64:65], v[28:29] row_newbcast:14 row_mask:0xf bank_mask:0xf
    v_mov_b64_dpp v[66:67], v[30:31] row_newbcast:14 row_mask:0xf bank_mask:0xf
    v_pk_mul_f32 v[94:95], v[64:65], v[26:27] op_sel_hi:[1,0]
    v_pk_mul_f32 v[96:97], v[64:65], v[26:27] op_sel:[0,1] op_sel_hi:[1,1]
    v_fract_f32 v95, v95
    v_fract_f32 v97, v97
    v_exp_f32 v94, v94
    v_exp_f32 v96, v96
    v_cos_f32 v68, v95
    v_sin_f32 v69, v95
    v_cos_f32 v76, v97
    v_sin_f32 v77, v97
    v_pk_mul_f32 v[68:69], v[68:69], v[94:95] op_sel_hi:[1,0]
    v_pk_mul_f32 v[76:77], v[76:77], v[96:97] op_sel_hi:[1,0]
    v_pk_mul_f32 v[92:93], v[76:77], v[76:77] op_sel:[1,1] op_sel_hi:[0,1]
    v_pk_fma_f32 v[78:79], v[76:77], v[76:77], v[92:93] op_sel:[0,0,0] op_sel_hi:[0,1,1] neg_lo:[0,0,1]
    v_pk_mul_f32 v[94:95], v[68:69], v[68:69] op_sel:[1,1] op_sel_hi:[0,1]
    v_pk_fma_f32 v[70:71], v[68:69], v[68:69], v[94:95] op_sel:[0,0,0] op_sel_hi:[0,1,1] neg_lo:[0,0,1]
    v_pk_mul_f32 v[92:93], v[78:79], v[78:79] op_sel:[1,1] op_sel_hi:[0,1]
    v_pk_fma_f32 v[80:81], v[78:79], v[78:79], v[92:93] op_sel:[0,0,0] op_sel_hi:[0,1,1] neg_lo:[0,0,1]
    v_pk_mul_f32 v[94:95], v[70:71], v[70:71] op_sel:[1,1] op_sel_hi:[0,1]
    v_pk_fma_f32 v[72:73], v[70:71], v[70:71], v[94:95] op_sel:[0,0,0] op_sel_hi:[0,1,1] neg_lo:[0,0,1]
    v_pk_mul_f32 v[92:93], v[80:81], v[80:81] op_sel:[1,1] op_sel_hi:[0,1]
    v_pk_fma_f32 v[82:83], v[80:81], v[80:81], v[92:93] op_sel:[0,0,0] op_sel_hi:[0,1,1] neg_lo:[0,0,1]
    v_pk_mul_f32 v[94:95], v[72:73], v[72:73] op_sel:[1,1] op_sel_hi:[0,1]
    v_pk_fma_f32 v[74:75], v[72:73], v[72:73], v[94:95] op_sel:[0,0,0] op_sel_hi:[0,1,1] neg_lo:[0,0,1]
    v_pk_mul_f32 v[92:93], v[82:83], v[82:83] op_sel:[1,1] op_sel_hi:[0,1]
    v_pk_fma_f32 v[84:85], v[82:83], v[82:83], v[92:93] op_sel:[0,0,0] op_sel_hi:[0,1,1] neg_lo:[0,0,1]
    v_pk_mul_f32 v[94:95], v[66:67], v[76:77] op_sel:[1,1] op_sel_hi:[1,0]
    v_pk_fma_f32 v[86:87], v[66:67], v[76:77], v[94:95] op_sel:[0,0,0] op_sel_hi:[0,1,1] neg_lo:[0,0,1] neg_hi:[1,0,1]
    v_mov_b32_dpp v80, v78 row_ror:8 row_mask:0xf bank_mask:0x3
    v_mov_b32_dpp v81, v79 row_ror:8 row_mask:0xf bank_mask:0x3
    v_mov_b32_dpp v82, v84 row_ror:8 row_mask:0xf bank_mask:0x3
    v_mov_b32_dpp v83, v85 row_ror:8 row_mask:0xf bank_mask:0x3
    v_pk_mul_f32 v[92:93], v[66:67], v[80:81] op_sel:[1,1] op_sel_hi:[1,0]
    v_pk_fma_f32 v[88:89], v[66:67], v[80:81], v[92:93] op_sel:[0,0,0] op_sel_hi:[0,1,1] neg_lo:[0,0,1] neg_hi:[1,0,1]
    v_pk_mul_f32 v[94:95], v[66:67], v[82:83] op_sel:[1,1] op_sel_hi:[1,0]
    v_pk_fma_f32 v[90:91], v[66:67], v[82:83], v[94:95] op_sel:[0,0,0] op_sel_hi:[0,1,1] neg_lo:[0,0,1] neg_hi:[1,0,1]
    v_mfma_f32_16x16x4_f32 v[48:51], v86, v68, v[48:51]
    v_mfma_f32_16x16x4_f32 v[52:55], v88, v70, v[52:55]
    v_mfma_f32_16x16x4_f32 v[56:59], v88, v72, v[56:59]
    v_mfma_f32_16x16x4_f32 v[60:63], v90, v74, v[60:63]
    v_mfma_f32_16x16x4_f32 v[48:51], v87, v69, v[48:51]
    v_mfma_f32_16x16x4_f32 v[52:55], v89, v71, v[52:55]
    v_mfma_f32_16x16x4_f32 v[56:59], v89, v73, v[56:59]
    v_mfma_f32_16x16x4_f32 v[60:63], v91, v75, v[60:63]
    v_mov_b64_dpp v[64:65], v[28:29] row_newbcast:15 row_mask:0xf bank_mask:0xf
    v_mov_b64_dpp v[66:67], v[30:31] row_newbcast:15 row_mask:0xf bank_mask:0xf
    v_pk_mul_f32 v[94:95], v[64:65], v[26:27] op_sel_hi:[1,0]
    v_pk_mul_f32 v[96:97], v[64:65], v[26:27] op_sel:[0,1] op_sel_hi:[1,1]
    v_fract_f32 v95, v95
    v_fract_f32 v97, v97
    v_exp_f32 v94, v94
    v_exp_f32 v96, v96
    v_cos_f32 v68, v95
    v_sin_f32 v69, v95
    v_cos_f32 v76, v97
    v_sin_f32 v77, v97
    v_pk_mul_f32 v[68:69], v[68:69], v[94:95] op_sel_hi:[1,0]
    v_pk_mul_f32 v[76:77], v[76:77], v[96:97] op_sel_hi:[1,0]
    v_pk_mul_f32 v[92:93], v[76:77], v[76:77] op_sel:[1,1] op_sel_hi:[0,1]
    v_pk_fma_f32 v[78:79], v[76:77], v[76:77], v[92:93] op_sel:[0,0,0] op_sel_hi:[0,1,1] neg_lo:[0,0,1]
    v_pk_mul_f32 v[94:95], v[68:69], v[68:69] op_sel:[1,1] op_sel_hi:[0,1]
    v_pk_fma_f32 v[70:71], v[68:69], v[68:69], v[94:95] op_sel:[0,0,0] op_sel_hi:[0,1,1] neg_lo:[0,0,1]
    v_pk_mul_f32 v[92:93], v[78:79], v[78:79] op_sel:[1,1] op_sel_hi:[0,1]
    v_pk_fma_f32 v[80:81], v[78:79], v[78:79], v[92:93] op_sel:[0,0,0] op_sel_hi:[0,1,1] neg_lo:[0,0,1]
    v_pk_mul_f32 v[94:95], v[70:71], v[70:71] op_sel:[1,1] op_sel_hi:[0,1]
    v_pk_fma_f32 v[72:73], v[70:71], v[70:71], v[94:95] op_sel:[0,0,0] op_sel_hi:[0,1,1] neg_lo:[0,0,1]
    v_pk_mul_f32 v[92:93], v[80:81], v[80:81] op_sel:[1,1] op_sel_hi:[0,1]
    v_pk_fma_f32 v[82:83], v[80:81], v[80:81], v[92:93] op_sel:[0,0,0] op_sel_hi:[0,1,1] neg_lo:[0,0,1]
    v_pk_mul_f32 v[94:95], v[72:73], v[72:73] op_sel:[1,1] op_sel_hi:[0,1]
    v_pk_fma_f32 v[74:75], v[72:73], v[72:73], v[94:95] op_sel:[0,0,0] op_sel_hi:[0,1,1] neg_lo:[0,0,1]
    v_pk_mul_f32 v[92:93], v[82:83], v[82:83] op_sel:[1,1] op_sel_hi:[0,1]
    v_pk_fma_f32 v[84:85], v[82:83], v[82:83], v[92:93] op_sel:[0,0,0] op_sel_hi:[0,1,1] neg_lo:[0,0,1]
    v_pk_mul_f32 v[94:95], v[66:67], v[76:77] op_sel:[1,1] op_sel_hi:[1,0]
    v_pk_fma_f32 v[86:87], v[66:67], v[76:77], v[94:95] op_sel:[0,0,0] op_sel_hi:[0,1,1] neg_lo:[0,0,1] neg_hi:[1,0,1]
    v_mov_b32_dpp v80, v78 row_ror:8 row_mask:0xf bank_mask:0x3
    v_mov_b32_dpp v81, v79 row_ror:8 row_mask:0xf bank_mask:0x3
    v_mov_b32_dpp v82, v84 row_ror:8 row_mask:0xf bank_mask:0x3
    v_mov_b32_dpp v83, v85 row_ror:8 row_mask:0xf bank_mask:0x3
    v_pk_mul_f32 v[92:93], v[66:67], v[80:81] op_sel:[1,1] op_sel_hi:[1,0]
    v_pk_fma_f32 v[88:89], v[66:67], v[80:81], v[92:93] op_sel:[0,0,0] op_sel_hi:[0,1,1] neg_lo:[0,0,1] neg_hi:[1,0,1]
    v_pk_mul_f32 v[94:95], v[66:67], v[82:83] op_sel:[1,1] op_sel_hi:[1,0]
    v_pk_fma_f32 v[90:91], v[66:67], v[82:83], v[94:95] op_sel:[0,0,0] op_sel_hi:[0,1,1] neg_lo:[0,0,1] neg_hi:[1,0,1]
    v_mfma_f32_16x16x4_f32 v[48:51], v86, v68, v[48:51]
    v_mfma_f32_16x16x4_f32 v[52:55], v88, v70, v[52:55]
    v_mfma_f32_16x16x4_f32 v[56:59], v88, v72, v[56:59]
    v_mfma_f32_16x16x4_f32 v[60:63], v90, v74, v[60:63]
    v_mfma_f32_16x16x4_f32 v[48:51], v87, v69, v[48:51]
    v_mfma_f32_16x16x4_f32 v[52:55], v89, v71, v[52:55]
    v_mfma_f32_16x16x4_f32 v[56:59], v89, v73, v[56:59]
    v_mfma_f32_16x16x4_f32 v[60:63], v91, v75, v[60:63]
    v_mov_b64 v[28:29], v[32:33]
    v_mov_b64 v[30:31], v[34:35]
    s_add_u32 s25, s25, 1
    s_cmp_lt_u32 s25, 2
    s_cbranch_scc1 ss_kg
    s_cmp_lg_u32 s28, 0
    s_cbranch_scc1 ss_nostage
    s_waitcnt vmcnt(0)
    v_mov_b32 v36, 0x05040100
    v_mov_b32 v37, 0x07060302
    v_lshlrev_b32 v6, 4, v0
    v_add_u32 v7, 65536, v6
    v_perm_b32 v40, v212, v208, v36
    v_perm_b32 v41, v220, v216, v36
    v_perm_b32 v42, v228, v224, v36
    v_perm_b32 v43, v236, v232, v36
    ds_write_b128 v6, v[40:43] offset:512
    v_perm_b32 v44, v212, v208, v37
    v_perm_b32 v45, v220, v216, v37
    v_perm_b32 v46, v228, v224, v37
    v_perm_b32 v47, v236, v232, v37
    ds_write_b128 v6, v[44:47] offset:16896
    v_perm_b32 v40, v213, v209, v36
    v_perm_b32 v41, v221, v217, v36
    v_perm_b32 v42, v229, v225, v36
    v_perm_b32 v43, v237, v233, v36
    ds_write_b128 v6, v[40:43] offset:33280
    v_perm_b32 v44, v213, v209, v37
    v_perm_b32 v45, v221, v217, v37
    v_perm_b32 v46, v229, v225, v37
    v_perm_b32 v47, v237, v233, v37
    ds_write_b128 v6, v[44:47] offset:49664
    v_perm_b32 v40, v214, v210, v36
    v_perm_b32 v41, v222, v218, v36
    v_perm_b32 v42, v230, v226, v36
    v_perm_b32 v43, v238, v234, v36
    ds_write_b128 v7, v[40:43] offset:512
    v_perm_b32 v44, v214, v210, v37
    v_perm_b32 v45, v222, v218, v37
    v_perm_b32 v46, v230, v226, v37
    v_perm_b32 v47, v238, v234, v37
    ds_write_b128 v7, v[44:47] offset:16896
    v_perm_b32 v40, v215, v211, v36
    v_perm_b32 v41, v223, v219, v36
    v_perm_b32 v42, v231, v227, v36
    v_perm_b32 v43, v239, v235, v36
    ds_write_b128 v7, v[40:43] offset:33280
    v_perm_b32 v44, v215, v211, v37
    v_perm_b32 v45, v223, v219, v37
    v_perm_b32 v46, v231, v227, v37
    v_perm_b32 v47, v239, v235, v37
    ds_write_b128 v7, v[44:47] offset:49664
ss_nostage:
    s_nop 11
    v_lshlrev_b32 v5, 8, v3
    v_lshl_add_u32 v5, v2, 2, v5
    v_add_u32 v5, v5, v4
    ds_write_b32 v5, v48 offset:4608
    ds_write_b32 v5, v49 offset:4672
    ds_write_b32 v5, v50 offset:4736
    ds_write_b32 v5, v51 offset:4800
    s_mov_b32 exec_hi, 0
    ds_write_b32 v5, v52 offset:5632
    ds_write_b32 v5, v53 offset:5696
    ds_write_b32 v5, v54 offset:5760
    ds_write_b32 v5, v55 offset:5824
    s_not_b64 exec, exec
    ds_write_b32 v5, v56 offset:5632
    ds_write_b32 v5, v57 offset:5696
    ds_write_b32 v5, v58 offset:5760
    ds_write_b32 v5, v59 offset:5824
    ds_write_b32 v5, v60 offset:6144
    ds_write_b32 v5, v61 offset:6208
    ds_write_b32 v5, v62 offset:6272
    ds_write_b32 v5, v63 offset:6336
    s_mov_b64 exec, 3
    v_cmp_eq_u32 vcc, 0, v2
    s_nop 1
    v_cndmask_b32 v6, 0, v60, vcc
    ds_write_b32 v5, v6 offset:7168
    s_mov_b64 exec, -1
    s_waitcnt lgkmcnt(0)
    v_lshlrev_b32 v7, 1, v1
    v_sub_u32 v7, 2065, v7
    v_lshl_add_u32 v64, v1, 2, v4
    v_mov_b32 v65, 641
    s_mov_b32 s25, 9
    s_mov_b32 s22, 256
    s_mov_b32 s23, 2048
ss_exp:
    v_subrev_u32 v66, 0, v7
    v_cvt_f32_u32 v72, v66
    v_cmp_gt_u32 vcc, s22, v66
    v_cvt_pk_bf16_f32 v72, v72, 0
    v_subrev_u32 v72, 0x4280, v72
    v_cndmask_b32 v72, v72, v66, vcc
    v_cmp_gt_u32 vcc, s23, v66
    s_nop 1
    v_cndmask_b32 v72, v65, v72, vcc
    v_lshl_add_u32 v72, v72, 2, v4
    v_subrev_u32 v67, 1, v7
    v_cvt_f32_u32 v73, v67
    v_cmp_gt_u32 vcc, s22, v67
    v_cvt_pk_bf16_f32 v73, v73, 0
    v_subrev_u32 v73, 0x4280, v73
    v_cndmask_b32 v73, v73, v67, vcc
    v_cmp_gt_u32 vcc, s23, v67
    ds_read_b32 v78, v72 offset:4608
    s_nop 0
    v_cndmask_b32 v73, v65, v73, vcc
    v_lshl_add_u32 v73, v73, 2, v4
    v_subrev_u32 v68, 2, v7
    v_cvt_f32_u32 v74, v68
    v_cmp_gt_u32 vcc, s22, v68
    v_cvt_pk_bf16_f32 v74, v74, 0
    v_subrev_u32 v74, 0x4280, v74
    v_cndmask_b32 v74, v74, v68, vcc
    v_cmp_gt_u32 vcc, s23, v68
    ds_read_b32 v79, v73 offset:4608
    s_nop 0
    v_cndmask_b32 v74, v65, v74, vcc
    v_lshl_add_u32 v74, v74, 2, v4
    v_subrev_u32 v69, 128, v7
    v_cvt_f32_u32 v75, v69
    v_cmp_gt_u32 vcc, s22, v69
    v_cvt_pk_bf16_f32 v75, v75, 0
    v_subrev_u32 v75, 0x4280, v75
    v_cndmask_b32 v75, v75, v69, vcc
    v_cmp_gt_u32 vcc, s23, v69
    ds_read_b32 v80, v74 offset:4608
    s_nop 0
    v_cndmask_b32 v75, v65, v75, vcc
    v_lshl_add_u32 v75, v75, 2, v4
    v_subrev_u32 v70, 129, v7
    v_cvt_f32_u32 v76, v70
    v_cmp_gt_u32 vcc, s22, v70
    v_cvt_pk_bf16_f32 v76, v76, 0
    v_subrev_u32 v76, 0x4280, v76
    v_cndmask_b32 v76, v76, v70, vcc
    v_cmp_gt_u32 vcc, s23, v70
    ds_read_b32 v81, v75 offset:4608
    s_nop 0
    v_cndmask_b32 v76, v65, v76, vcc
    v_lshl_add_u32 v76, v76, 2, v4
    v_subrev_u32 v71, 130, v7
    v_cvt_f32_u32 v77, v71
    v_cmp_gt_u32 vcc, s22, v71
    v_cvt_pk_bf16_f32 v77, v77, 0
    v_subrev_u32 v77, 0x4280, v77
    v_cndmask_b32 v77, v77, v71, vcc
    v_cmp_gt_u32 vcc, s23, v71
    ds_read_b32 v82, v76 offset:4608
    s_nop 0
    v_cndmask_b32 v77, v65, v77, vcc
    v_lshl_add_u32 v77, v77, 2, v4
    ds_read_b32 v83, v77 offset:4608
    v_subrev_u32 v7, 256, v7
    s_sub_u32 s25, s25, 1
    s_waitcnt lgkmcnt(0)
    v_cvt_pk_bf16_f32 v84, v79, v80
    v_cvt_pk_bf16_f32 v85, v78, v79
    v_cvt_pk_bf16_f32 v86, v82, v83
    v_cvt_pk_bf16_f32 v87, v81, v82
    ds_write_b32 v64, v84 offset:7424
    ds_write_b32 v64, v85 offset:11776
    s_cmp_eq_u32 s25, 0
    s_cbranch_scc1 ss_expx
    ds_write_b32 v64, v86 offset:7680
    ds_write_b32 v64, v87 offset:12032
    v_add_u32 v64, 512, v64
    s_nop 1
    s_branch ss_exp
ss_expx:
    s_waitcnt lgkmcnt(0)
    s_barrier
    v_and_b32 v5, 1, v2
    v_mul_u32_u24 v36, 4352, v5
    v_sub_u32 v5, v5, v2
    v_lshl_add_u32 v5, v3, 3, v5
    v_lshl_add_u32 v36, v5, 1, v36
    v_add_u32 v36, 11072, v36
    v_add_u32 v36, v36, v4
    v_subrev_u32 v37, 512, v36
    v_subrev_u32 v38, 1024, v36
    v_subrev_u32 v39, 1536, v36
    v_subrev_u32 v40, 2048, v36
    v_subrev_u32 v41, 2560, v36
    v_subrev_u32 v42, 3072, v36
    v_subrev_u32 v43, 3584, v36
    v_lshlrev_b32 v44, 5, v2
    v_lshl_add_u32 v44, v3, 4, v44
    v_add_u32 v44, 32, v44
    v_add_u32 v44, v44, v4
    ds_read_b128 v[112:115], v44 offset:448
    ds_read2_b32 v[80:81], v36 offset0:112 offset1:113
    ds_read2_b32 v[82:83], v36 offset0:114 offset1:115
    ds_read_b128 v[116:119], v44 offset:960
    ds_read2_b32 v[84:85], v37 offset0:112 offset1:113
    ds_read2_b32 v[86:87], v37 offset0:114 offset1:115
    ds_read_b128 v[120:123], v44 offset:1472
    ds_read2_b32 v[88:89], v38 offset0:112 offset1:113
    ds_read2_b32 v[90:91], v38 offset0:114 offset1:115
    ds_read_b128 v[124:127], v44 offset:1984
    ds_read2_b32 v[92:93], v39 offset0:112 offset1:113
    ds_read2_b32 v[94:95], v39 offset0:114 offset1:115
    ds_read_b128 v[128:131], v44 offset:2496
    ds_read2_b32 v[96:97], v40 offset0:112 offset1:113
    ds_read2_b32 v[98:99], v40 offset0:114 offset1:115
    ds_read_b128 v[132:135], v44 offset:3008
    ds_read2_b32 v[100:101], v41 offset0:112 offset1:113
    ds_read2_b32 v[102:103], v41 offset0:114 offset1:115
    ds_read_b128 v[136:139], v44 offset:3520
    ds_read2_b32 v[104:105], v42 offset0:112 offset1:113
    ds_read2_b32 v[106:107], v42 offset0:114 offset1:115
    ds_read_b128 v[140:143], v44 offset:4032
    ds_read2_b32 v[108:109], v43 offset0:112 offset1:113
    ds_read2_b32 v[110:111], v43 offset0:114 offset1:115
    s_waitcnt lgkmcnt(0)
    v_mfma_f32_16x16x32_bf16 v[48:51], v[80:83], v[112:115], 0
    ds_read_b128 v[176:179], v44 offset:384
    v_mfma_f32_16x16x32_bf16 v[52:55], v[80:83], v[116:119], 0
    ds_read2_b32 v[144:145], v36 offset0:96 offset1:97
    v_mfma_f32_16x16x32_bf16 v[56:59], v[80:83], v[120:123], 0
    ds_read2_b32 v[146:147], v36 offset0:98 offset1:99
    v_mfma_f32_16x16x32_bf16 v[60:63], v[80:83], v[124:127], 0
    ds_read_b128 v[180:183], v44 offset:896
    v_mfma_f32_16x16x32_bf16 v[64:67], v[80:83], v[128:131], 0
    ds_read2_b32 v[148:149], v37 offset0:96 offset1:97
    v_mfma_f32_16x16x32_bf16 v[68:71], v[80:83], v[132:135], 0
    ds_read2_b32 v[150:151], v37 offset0:98 offset1:99
    v_mfma_f32_16x16x32_bf16 v[72:75], v[80:83], v[136:139], 0
    ds_read_b128 v[184:187], v44 offset:1408
    v_mfma_f32_16x16x32_bf16 v[76:79], v[80:83], v[140:143], 0
    ds_read2_b32 v[152:153], v38 offset0:96 offset1:97
    v_mfma_f32_16x16x32_bf16 v[52:55], v[84:87], v[112:115], v[52:55]
    ds_read2_b32 v[154:155], v38 offset0:98 offset1:99
    v_mfma_f32_16x16x32_bf16 v[56:59], v[84:87], v[116:119], v[56:59]
    ds_read_b128 v[188:191], v44 offset:1920
    v_mfma_f32_16x16x32_bf16 v[60:63], v[84:87], v[120:123], v[60:63]
    ds_read2_b32 v[156:157], v39 offset0:96 offset1:97
    v_mfma_f32_16x16x32_bf16 v[64:67], v[84:87], v[124:127], v[64:67]
    ds_read2_b32 v[158:159], v39 offset0:98 offset1:99
    v_mfma_f32_16x16x32_bf16 v[68:71], v[84:87], v[128:131], v[68:71]
    ds_read_b128 v[192:195], v44 offset:2432
    v_mfma_f32_16x16x32_bf16 v[72:75], v[84:87], v[132:135], v[72:75]
    ds_read2_b32 v[160:161], v40 offset0:96 offset1:97
    v_mfma_f32_16x16x32_bf16 v[76:79], v[84:87], v[136:139], v[76:79]
    ds_read2_b32 v[162:163], v40 offset0:98 offset1:99
    v_mfma_f32_16x16x32_bf16 v[56:59], v[88:91], v[112:115], v[56:59]
    ds_read_b128 v[196:199], v44 offset:2944
    v_mfma_f32_16x16x32_bf16 v[60:63], v[88:91], v[116:119], v[60:63]
    ds_read2_b32 v[164:165], v41 offset0:96 offset1:97
    v_mfma_f32_16x16x32_bf16 v[64:67], v[88:91], v[120:123], v[64:67]
    ds_read2_b32 v[166:167], v41 offset0:98 offset1:99
    v_mfma_f32_16x16x32_bf16 v[68:71], v[88:91], v[124:127], v[68:71]
    ds_read_b128 v[200:203], v44 offset:3456
    v_mfma_f32_16x16x32_bf16 v[72:75], v[88:91], v[128:131], v[72:75]
    ds_read2_b32 v[168:169], v42 offset0:96 offset1:97
    v_mfma_f32_16x16x32_bf16 v[76:79], v[88:91], v[132:135], v[76:79]
    ds_read2_b32 v[170:171], v42 offset0:98 offset1:99
    v_mfma_f32_16x16x32_bf16 v[60:63], v[92:95], v[112:115], v[60:63]
    ds_read_b128 v[204:207], v44 offset:3968
    v_mfma_f32_16x16x32_bf16 v[64:67], v[92:95], v[116:119], v[64:67]
    ds_read2_b32 v[172:173], v43 offset0:96 offset1:97
    v_mfma_f32_16x16x32_bf16 v[68:71], v[92:95], v[120:123], v[68:71]
    ds_read2_b32 v[174:175], v43 offset0:98 offset1:99
    v_mfma_f32_16x16x32_bf16 v[72:75], v[92:95], v[124:127], v[72:75]
    v_mfma_f32_16x16x32_bf16 v[76:79], v[92:95], v[128:131], v[76:79]
    v_mfma_f32_16x16x32_bf16 v[64:67], v[96:99], v[112:115], v[64:67]
    v_mfma_f32_16x16x32_bf16 v[68:71], v[96:99], v[116:119], v[68:71]
    v_mfma_f32_16x16x32_bf16 v[72:75], v[96:99], v[120:123], v[72:75]
    v_mfma_f32_16x16x32_bf16 v[76:79], v[96:99], v[124:127], v[76:79]
    v_mfma_f32_16x16x32_bf16 v[68:71], v[100:103], v[112:115], v[68:71]
    v_mfma_f32_16x16x32_bf16 v[72:75], v[100:103], v[116:119], v[72:75]
    v_mfma_f32_16x16x32_bf16 v[76:79], v[100:103], v[120:123], v[76:79]
    v_mfma_f32_16x16x32_bf16 v[72:75], v[104:107], v[112:115], v[72:75]
    v_mfma_f32_16x16x32_bf16 v[76:79], v[104:107], v[116:119], v[76:79]
    v_mfma_f32_16x16x32_bf16 v[76:79], v[108:111], v[112:115], v[76:79]
    s_waitcnt lgkmcnt(0)
    v_mfma_f32_16x16x32_bf16 v[48:51], v[144:147], v[176:179], v[48:51]
    ds_read_b128 v[112:115], v44 offset:320
    v_mfma_f32_16x16x32_bf16 v[52:55], v[144:147], v[180:183], v[52:55]
    ds_read2_b32 v[80:81], v36 offset0:80 offset1:81
    v_mfma_f32_16x16x32_bf16 v[56:59], v[144:147], v[184:187], v[56:59]
    ds_read2_b32 v[82:83], v36 offset0:82 offset1:83
    v_mfma_f32_16x16x32_bf16 v[60:63], v[144:147], v[188:191], v[60:63]
    ds_read_b128 v[116:119], v44 offset:832
    v_mfma_f32_16x16x32_bf16 v[64:67], v[144:147], v[192:195], v[64:67]
    ds_read2_b32 v[84:85], v37 offset0:80 offset1:81
    v_mfma_f32_16x16x32_bf16 v[68:71], v[144:147], v[196:199], v[68:71]
    ds_read2_b32 v[86:87], v37 offset0:82 offset1:83
    v_mfma_f32_16x16x32_bf16 v[72:75], v[144:147], v[200:203], v[72:75]
    ds_read_b128 v[120:123], v44 offset:1344
    v_mfma_f32_16x16x32_bf16 v[76:79], v[144:147], v[204:207], v[76:79]
    ds_read2_b32 v[88:89], v38 offset0:80 offset1:81
    v_mfma_f32_16x16x32_bf16 v[52:55], v[148:151], v[176:179], v[52:55]
    ds_read2_b32 v[90:91], v38 offset0:82 offset1:83
    v_mfma_f32_16x16x32_bf16 v[56:59], v[148:151], v[180:183], v[56:59]
    ds_read_b128 v[124:127], v44 offset:1856
    v_mfma_f32_16x16x32_bf16 v[60:63], v[148:151], v[184:187], v[60:63]
    ds_read2_b32 v[92:93], v39 offset0:80 offset1:81
    v_mfma_f32_16x16x32_bf16 v[64:67], v[148:151], v[188:191], v[64:67]
    ds_read2_b32 v[94:95], v39 offset0:82 offset1:83
    v_mfma_f32_16x16x32_bf16 v[68:71], v[148:151], v[192:195], v[68:71]
    ds_read_b128 v[128:131], v44 offset:2368
    v_mfma_f32_16x16x32_bf16 v[72:75], v[148:151], v[196:199], v[72:75]
    ds_read2_b32 v[96:97], v40 offset0:80 offset1:81
    v_mfma_f32_16x16x32_bf16 v[76:79], v[148:151], v[200:203], v[76:79]
    ds_read2_b32 v[98:99], v40 offset0:82 offset1:83
    v_mfma_f32_16x16x32_bf16 v[56:59], v[152:155], v[176:179], v[56:59]
    ds_read_b128 v[132:135], v44 offset:2880
    v_mfma_f32_16x16x32_bf16 v[60:63], v[152:155], v[180:183], v[60:63]
    ds_read2_b32 v[100:101], v41 offset0:80 offset1:81
    v_mfma_f32_16x16x32_bf16 v[64:67], v[152:155], v[184:187], v[64:67]
    ds_read2_b32 v[102:103], v41 offset0:82 offset1:83
    v_mfma_f32_16x16x32_bf16 v[68:71], v[152:155], v[188:191], v[68:71]
    ds_read_b128 v[136:139], v44 offset:3392
    v_mfma_f32_16x16x32_bf16 v[72:75], v[152:155], v[192:195], v[72:75]
    ds_read2_b32 v[104:105], v42 offset0:80 offset1:81
    v_mfma_f32_16x16x32_bf16 v[76:79], v[152:155], v[196:199], v[76:79]
    ds_read2_b32 v[106:107], v42 offset0:82 offset1:83
    v_mfma_f32_16x16x32_bf16 v[60:63], v[156:159], v[176:179], v[60:63]
    ds_read_b128 v[140:143], v44 offset:3904
    v_mfma_f32_16x16x32_bf16 v[64:67], v[156:159], v[180:183], v[64:67]
    ds_read2_b32 v[108:109], v43 offset0:80 offset1:81
    v_mfma_f32_16x16x32_bf16 v[68:71], v[156:159], v[184:187], v[68:71]
    ds_read2_b32 v[110:111], v43 offset0:82 offset1:83
    v_mfma_f32_16x16x32_bf16 v[72:75], v[156:159], v[188:191], v[72:75]
    v_mfma_f32_16x16x32_bf16 v[76:79], v[156:159], v[192:195], v[76:79]
    v_mfma_f32_16x16x32_bf16 v[64:67], v[160:163], v[176:179], v[64:67]
    v_mfma_f32_16x16x32_bf16 v[68:71], v[160:163], v[180:183], v[68:71]
    v_mfma_f32_16x16x32_bf16 v[72:75], v[160:163], v[184:187], v[72:75]
    v_mfma_f32_16x16x32_bf16 v[76:79], v[160:163], v[188:191], v[76:79]
    v_mfma_f32_16x16x32_bf16 v[68:71], v[164:167], v[176:179], v[68:71]
    v_mfma_f32_16x16x32_bf16 v[72:75], v[164:167], v[180:183], v[72:75]
    v_mfma_f32_16x16x32_bf16 v[76:79], v[164:167], v[184:187], v[76:79]
    v_mfma_f32_16x16x32_bf16 v[72:75], v[168:171], v[176:179], v[72:75]
    v_mfma_f32_16x16x32_bf16 v[76:79], v[168:171], v[180:183], v[76:79]
    v_mfma_f32_16x16x32_bf16 v[76:79], v[172:175], v[176:179], v[76:79]
    s_waitcnt lgkmcnt(0)
    v_mfma_f32_16x16x32_bf16 v[48:51], v[80:83], v[112:115], v[48:51]
    ds_read_b128 v[176:179], v44 offset:256
    v_mfma_f32_16x16x32_bf16 v[52:55], v[80:83], v[116:119], v[52:55]
    ds_read2_b32 v[144:145], v36 offset0:64 offset1:65
    v_mfma_f32_16x16x32_bf16 v[56:59], v[80:83], v[120:123], v[56:59]
    ds_read2_b32 v[146:147], v36 offset0:66 offset1:67
    v_mfma_f32_16x16x32_bf16 v[60:63], v[80:83], v[124:127], v[60:63]
    ds_read_b128 v[180:183], v44 offset:768
    v_mfma_f32_16x16x32_bf16 v[64:67], v[80:83], v[128:131], v[64:67]
    ds_read2_b32 v[148:149], v37 offset0:64 offset1:65
    v_mfma_f32_16x16x32_bf16 v[68:71], v[80:83], v[132:135], v[68:71]
    ds_read2_b32 v[150:151], v37 offset0:66 offset1:67
    v_mfma_f32_16x16x32_bf16 v[72:75], v[80:83], v[136:139], v[72:75]
    ds_read_b128 v[184:187], v44 offset:1280
    v_mfma_f32_16x16x32_bf16 v[76:79], v[80:83], v[140:143], v[76:79]
    ds_read2_b32 v[152:153], v38 offset0:64 offset1:65
    v_mfma_f32_16x16x32_bf16 v[52:55], v[84:87], v[112:115], v[52:55]
    ds_read2_b32 v[154:155], v38 offset0:66 offset1:67
    v_mfma_f32_16x16x32_bf16 v[56:59], v[84:87], v[116:119], v[56:59]
    ds_read_b128 v[188:191], v44 offset:1792
    v_mfma_f32_16x16x32_bf16 v[60:63], v[84:87], v[120:123], v[60:63]
    ds_read2_b32 v[156:157], v39 offset0:64 offset1:65
    v_mfma_f32_16x16x32_bf16 v[64:67], v[84:87], v[124:127], v[64:67]
    ds_read2_b32 v[158:159], v39 offset0:66 offset1:67
    v_mfma_f32_16x16x32_bf16 v[68:71], v[84:87], v[128:131], v[68:71]
    ds_read_b128 v[192:195], v44 offset:2304
    v_mfma_f32_16x16x32_bf16 v[72:75], v[84:87], v[132:135], v[72:75]
    ds_read2_b32 v[160:161], v40 offset0:64 offset1:65
    v_mfma_f32_16x16x32_bf16 v[76:79], v[84:87], v[136:139], v[76:79]
    ds_read2_b32 v[162:163], v40 offset0:66 offset1:67
    v_mfma_f32_16x16x32_bf16 v[56:59], v[88:91], v[112:115], v[56:59]
    ds_read_b128 v[196:199], v44 offset:2816
    v_mfma_f32_16x16x32_bf16 v[60:63], v[88:91], v[116:119], v[60:63]
    ds_read2_b32 v[164:165], v41 offset0:64 offset1:65
    v_mfma_f32_16x16x32_bf16 v[64:67], v[88:91], v[120:123], v[64:67]
    ds_read2_b32 v[166:167], v41 offset0:66 offset1:67
    v_mfma_f32_16x16x32_bf16 v[68:71], v[88:91], v[124:127], v[68:71]
    ds_read_b128 v[200:203], v44 offset:3328
    v_mfma_f32_16x16x32_bf16 v[72:75], v[88:91], v[128:131], v[72:75]
    ds_read2_b32 v[168:169], v42 offset0:64 offset1:65
    v_mfma_f32_16x16x32_bf16 v[76:79], v[88:91], v[132:135], v[76:79]
    ds_read2_b32 v[170:171], v42 offset0:66 offset1:67
    v_mfma_f32_16x16x32_bf16 v[60:63], v[92:95], v[112:115], v[60:63]
    ds_read_b128 v[204:207], v44 offset:3840
    v_mfma_f32_16x16x32_bf16 v[64:67], v[92:95], v[116:119], v[64:67]
    ds_read2_b32 v[172:173], v43 offset0:64 offset1:65
    v_mfma_f32_16x16x32_bf16 v[68:71], v[92:95], v[120:123], v[68:71]
    ds_read2_b32 v[174:175], v43 offset0:66 offset1:67
    v_mfma_f32_16x16x32_bf16 v[72:75], v[92:95], v[124:127], v[72:75]
    v_mfma_f32_16x16x32_bf16 v[76:79], v[92:95], v[128:131], v[76:79]
    v_mfma_f32_16x16x32_bf16 v[64:67], v[96:99], v[112:115], v[64:67]
    v_mfma_f32_16x16x32_bf16 v[68:71], v[96:99], v[116:119], v[68:71]
    v_mfma_f32_16x16x32_bf16 v[72:75], v[96:99], v[120:123], v[72:75]
    v_mfma_f32_16x16x32_bf16 v[76:79], v[96:99], v[124:127], v[76:79]
    v_mfma_f32_16x16x32_bf16 v[68:71], v[100:103], v[112:115], v[68:71]
    v_mfma_f32_16x16x32_bf16 v[72:75], v[100:103], v[116:119], v[72:75]
    v_mfma_f32_16x16x32_bf16 v[76:79], v[100:103], v[120:123], v[76:79]
    v_mfma_f32_16x16x32_bf16 v[72:75], v[104:107], v[112:115], v[72:75]
    v_mfma_f32_16x16x32_bf16 v[76:79], v[104:107], v[116:119], v[76:79]
    v_mfma_f32_16x16x32_bf16 v[76:79], v[108:111], v[112:115], v[76:79]
    s_waitcnt lgkmcnt(0)
    v_mfma_f32_16x16x32_bf16 v[48:51], v[144:147], v[176:179], v[48:51]
    ds_read_b128 v[112:115], v44 offset:192
    v_mfma_f32_16x16x32_bf16 v[52:55], v[144:147], v[180:183], v[52:55]
    ds_read2_b32 v[80:81], v36 offset0:48 offset1:49
    v_mfma_f32_16x16x32_bf16 v[56:59], v[144:147], v[184:187], v[56:59]
    ds_read2_b32 v[82:83], v36 offset0:50 offset1:51
    v_mfma_f32_16x16x32_bf16 v[60:63], v[144:147], v[188:191], v[60:63]
    ds_read_b128 v[116:119], v44 offset:704
    v_mfma_f32_16x16x32_bf16 v[64:67], v[144:147], v[192:195], v[64:67]
    ds_read2_b32 v[84:85], v37 offset0:48 offset1:49
    v_mfma_f32_16x16x32_bf16 v[68:71], v[144:147], v[196:199], v[68:71]
    ds_read2_b32 v[86:87], v37 offset0:50 offset1:51
    v_mfma_f32_16x16x32_bf16 v[72:75], v[144:147], v[200:203], v[72:75]
    ds_read_b128 v[120:123], v44 offset:1216
    v_mfma_f32_16x16x32_bf16 v[76:79], v[144:147], v[204:207], v[76:79]
    ds_read2_b32 v[88:89], v38 offset0:48 offset1:49
    v_mfma_f32_16x16x32_bf16 v[52:55], v[148:151], v[176:179], v[52:55]
    ds_read2_b32 v[90:91], v38 offset0:50 offset1:51
    v_mfma_f32_16x16x32_bf16 v[56:59], v[148:151], v[180:183], v[56:59]
    ds_read_b128 v[124:127], v44 offset:1728
    v_mfma_f32_16x16x32_bf16 v[60:63], v[148:151], v[184:187], v[60:63]
    ds_read2_b32 v[92:93], v39 offset0:48 offset1:49
    v_mfma_f32_16x16x32_bf16 v[64:67], v[148:151], v[188:191], v[64:67]
    ds_read2_b32 v[94:95], v39 offset0:50 offset1:51
    v_mfma_f32_16x16x32_bf16 v[68:71], v[148:151], v[192:195], v[68:71]
    ds_read_b128 v[128:131], v44 offset:2240
    v_mfma_f32_16x16x32_bf16 v[72:75], v[148:151], v[196:199], v[72:75]
    ds_read2_b32 v[96:97], v40 offset0:48 offset1:49
    v_mfma_f32_16x16x32_bf16 v[76:79], v[148:151], v[200:203], v[76:79]
    ds_read2_b32 v[98:99], v40 offset0:50 offset1:51
    v_mfma_f32_16x16x32_bf16 v[56:59], v[152:155], v[176:179], v[56:59]
    ds_read_b128 v[132:135], v44 offset:2752
    v_mfma_f32_16x16x32_bf16 v[60:63], v[152:155], v[180:183], v[60:63]
    ds_read2_b32 v[100:101], v41 offset0:48 offset1:49
    v_mfma_f32_16x16x32_bf16 v[64:67], v[152:155], v[184:187], v[64:67]
    ds_read2_b32 v[102:103], v41 offset0:50 offset1:51
    v_mfma_f32_16x16x32_bf16 v[68:71], v[152:155], v[188:191], v[68:71]
    ds_read_b128 v[136:139], v44 offset:3264
    v_mfma_f32_16x16x32_bf16 v[72:75], v[152:155], v[192:195], v[72:75]
    ds_read2_b32 v[104:105], v42 offset0:48 offset1:49
    v_mfma_f32_16x16x32_bf16 v[76:79], v[152:155], v[196:199], v[76:79]
    ds_read2_b32 v[106:107], v42 offset0:50 offset1:51
    v_mfma_f32_16x16x32_bf16 v[60:63], v[156:159], v[176:179], v[60:63]
    ds_read_b128 v[140:143], v44 offset:3776
    v_mfma_f32_16x16x32_bf16 v[64:67], v[156:159], v[180:183], v[64:67]
    ds_read2_b32 v[108:109], v43 offset0:48 offset1:49
    v_mfma_f32_16x16x32_bf16 v[68:71], v[156:159], v[184:187], v[68:71]
    ds_read2_b32 v[110:111], v43 offset0:50 offset1:51
    v_mfma_f32_16x16x32_bf16 v[72:75], v[156:159], v[188:191], v[72:75]
    v_mfma_f32_16x16x32_bf16 v[76:79], v[156:159], v[192:195], v[76:79]
    v_mfma_f32_16x16x32_bf16 v[64:67], v[160:163], v[176:179], v[64:67]
    v_mfma_f32_16x16x32_bf16 v[68:71], v[160:163], v[180:183], v[68:71]
    v_mfma_f32_16x16x32_bf16 v[72:75], v[160:163], v[184:187], v[72:75]
    v_mfma_f32_16x16x32_bf16 v[76:79], v[160:163], v[188:191], v[76:79]
    v_mfma_f32_16x16x32_bf16 v[68:71], v[164:167], v[176:179], v[68:71]
    v_mfma_f32_16x16x32_bf16 v[72:75], v[164:167], v[180:183], v[72:75]
    v_mfma_f32_16x16x32_bf16 v[76:79], v[164:167], v[184:187], v[76:79]
    v_mfma_f32_16x16x32_bf16 v[72:75], v[168:171], v[176:179], v[72:75]
    v_mfma_f32_16x16x32_bf16 v[76:79], v[168:171], v[180:183], v[76:79]
    v_mfma_f32_16x16x32_bf16 v[76:79], v[172:175], v[176:179], v[76:79]
    s_waitcnt lgkmcnt(0)
    v_mfma_f32_16x16x32_bf16 v[48:51], v[80:83], v[112:115], v[48:51]
    ds_read_b128 v[176:179], v44 offset:128
    v_mfma_f32_16x16x32_bf16 v[52:55], v[80:83], v[116:119], v[52:55]
    ds_read2_b32 v[144:145], v36 offset0:32 offset1:33
    v_mfma_f32_16x16x32_bf16 v[56:59], v[80:83], v[120:123], v[56:59]
    ds_read2_b32 v[146:147], v36 offset0:34 offset1:35
    v_mfma_f32_16x16x32_bf16 v[60:63], v[80:83], v[124:127], v[60:63]
    ds_read_b128 v[180:183], v44 offset:640
    v_mfma_f32_16x16x32_bf16 v[64:67], v[80:83], v[128:131], v[64:67]
    ds_read2_b32 v[148:149], v37 offset0:32 offset1:33
    v_mfma_f32_16x16x32_bf16 v[68:71], v[80:83], v[132:135], v[68:71]
    ds_read2_b32 v[150:151], v37 offset0:34 offset1:35
    v_mfma_f32_16x16x32_bf16 v[72:75], v[80:83], v[136:139], v[72:75]
    ds_read_b128 v[184:187], v44 offset:1152
    v_mfma_f32_16x16x32_bf16 v[76:79], v[80:83], v[140:143], v[76:79]
    ds_read2_b32 v[152:153], v38 offset0:32 offset1:33
    v_mfma_f32_16x16x32_bf16 v[52:55], v[84:87], v[112:115], v[52:55]
    ds_read2_b32 v[154:155], v38 offset0:34 offset1:35
    v_mfma_f32_16x16x32_bf16 v[56:59], v[84:87], v[116:119], v[56:59]
    ds_read_b128 v[188:191], v44 offset:1664
    v_mfma_f32_16x16x32_bf16 v[60:63], v[84:87], v[120:123], v[60:63]
    ds_read2_b32 v[156:157], v39 offset0:32 offset1:33
    v_mfma_f32_16x16x32_bf16 v[64:67], v[84:87], v[124:127], v[64:67]
    ds_read2_b32 v[158:159], v39 offset0:34 offset1:35
    v_mfma_f32_16x16x32_bf16 v[68:71], v[84:87], v[128:131], v[68:71]
    ds_read_b128 v[192:195], v44 offset:2176
    v_mfma_f32_16x16x32_bf16 v[72:75], v[84:87], v[132:135], v[72:75]
    ds_read2_b32 v[160:161], v40 offset0:32 offset1:33
    v_mfma_f32_16x16x32_bf16 v[76:79], v[84:87], v[136:139], v[76:79]
    ds_read2_b32 v[162:163], v40 offset0:34 offset1:35
    v_mfma_f32_16x16x32_bf16 v[56:59], v[88:91], v[112:115], v[56:59]
    ds_read_b128 v[196:199], v44 offset:2688
    v_mfma_f32_16x16x32_bf16 v[60:63], v[88:91], v[116:119], v[60:63]
    ds_read2_b32 v[164:165], v41 offset0:32 offset1:33
    v_mfma_f32_16x16x32_bf16 v[64:67], v[88:91], v[120:123], v[64:67]
    ds_read2_b32 v[166:167], v41 offset0:34 offset1:35
    v_mfma_f32_16x16x32_bf16 v[68:71], v[88:91], v[124:127], v[68:71]
    ds_read_b128 v[200:203], v44 offset:3200
    v_mfma_f32_16x16x32_bf16 v[72:75], v[88:91], v[128:131], v[72:75]
    ds_read2_b32 v[168:169], v42 offset0:32 offset1:33
    v_mfma_f32_16x16x32_bf16 v[76:79], v[88:91], v[132:135], v[76:79]
    ds_read2_b32 v[170:171], v42 offset0:34 offset1:35
    v_mfma_f32_16x16x32_bf16 v[60:63], v[92:95], v[112:115], v[60:63]
    ds_read_b128 v[204:207], v44 offset:3712
    v_mfma_f32_16x16x32_bf16 v[64:67], v[92:95], v[116:119], v[64:67]
    ds_read2_b32 v[172:173], v43 offset0:32 offset1:33
    v_mfma_f32_16x16x32_bf16 v[68:71], v[92:95], v[120:123], v[68:71]
    ds_read2_b32 v[174:175], v43 offset0:34 offset1:35
    v_mfma_f32_16x16x32_bf16 v[72:75], v[92:95], v[124:127], v[72:75]
    v_mfma_f32_16x16x32_bf16 v[76:79], v[92:95], v[128:131], v[76:79]
    v_mfma_f32_16x16x32_bf16 v[64:67], v[96:99], v[112:115], v[64:67]
    v_mfma_f32_16x16x32_bf16 v[68:71], v[96:99], v[116:119], v[68:71]
    v_mfma_f32_16x16x32_bf16 v[72:75], v[96:99], v[120:123], v[72:75]
    v_mfma_f32_16x16x32_bf16 v[76:79], v[96:99], v[124:127], v[76:79]
    v_mfma_f32_16x16x32_bf16 v[68:71], v[100:103], v[112:115], v[68:71]
    v_mfma_f32_16x16x32_bf16 v[72:75], v[100:103], v[116:119], v[72:75]
    v_mfma_f32_16x16x32_bf16 v[76:79], v[100:103], v[120:123], v[76:79]
    v_mfma_f32_16x16x32_bf16 v[72:75], v[104:107], v[112:115], v[72:75]
    v_mfma_f32_16x16x32_bf16 v[76:79], v[104:107], v[116:119], v[76:79]
    v_mfma_f32_16x16x32_bf16 v[76:79], v[108:111], v[112:115], v[76:79]
    s_waitcnt lgkmcnt(0)
    v_mfma_f32_16x16x32_bf16 v[48:51], v[144:147], v[176:179], v[48:51]
    ds_read_b128 v[112:115], v44 offset:64
    v_mfma_f32_16x16x32_bf16 v[52:55], v[144:147], v[180:183], v[52:55]
    ds_read2_b32 v[80:81], v36 offset0:16 offset1:17
    v_mfma_f32_16x16x32_bf16 v[56:59], v[144:147], v[184:187], v[56:59]
    ds_read2_b32 v[82:83], v36 offset0:18 offset1:19
    v_mfma_f32_16x16x32_bf16 v[60:63], v[144:147], v[188:191], v[60:63]
    ds_read_b128 v[116:119], v44 offset:576
    v_mfma_f32_16x16x32_bf16 v[64:67], v[144:147], v[192:195], v[64:67]
    ds_read2_b32 v[84:85], v37 offset0:16 offset1:17
    v_mfma_f32_16x16x32_bf16 v[68:71], v[144:147], v[196:199], v[68:71]
    ds_read2_b32 v[86:87], v37 offset0:18 offset1:19
    v_mfma_f32_16x16x32_bf16 v[72:75], v[144:147], v[200:203], v[72:75]
    ds_read_b128 v[120:123], v44 offset:1088
    v_mfma_f32_16x16x32_bf16 v[76:79], v[144:147], v[204:207], v[76:79]
    ds_read2_b32 v[88:89], v38 offset0:16 offset1:17
    v_mfma_f32_16x16x32_bf16 v[52:55], v[148:151], v[176:179], v[52:55]
    ds_read2_b32 v[90:91], v38 offset0:18 offset1:19
    v_mfma_f32_16x16x32_bf16 v[56:59], v[148:151], v[180:183], v[56:59]
    ds_read_b128 v[124:127], v44 offset:1600
    v_mfma_f32_16x16x32_bf16 v[60:63], v[148:151], v[184:187], v[60:63]
    ds_read2_b32 v[92:93], v39 offset0:16 offset1:17
    v_mfma_f32_16x16x32_bf16 v[64:67], v[148:151], v[188:191], v[64:67]
    ds_read2_b32 v[94:95], v39 offset0:18 offset1:19
    v_mfma_f32_16x16x32_bf16 v[68:71], v[148:151], v[192:195], v[68:71]
    ds_read_b128 v[128:131], v44 offset:2112
    v_mfma_f32_16x16x32_bf16 v[72:75], v[148:151], v[196:199], v[72:75]
    ds_read2_b32 v[96:97], v40 offset0:16 offset1:17
    v_mfma_f32_16x16x32_bf16 v[76:79], v[148:151], v[200:203], v[76:79]
    ds_read2_b32 v[98:99], v40 offset0:18 offset1:19
    v_mfma_f32_16x16x32_bf16 v[56:59], v[152:155], v[176:179], v[56:59]
    ds_read_b128 v[132:135], v44 offset:2624
    v_mfma_f32_16x16x32_bf16 v[60:63], v[152:155], v[180:183], v[60:63]
    ds_read2_b32 v[100:101], v41 offset0:16 offset1:17
    v_mfma_f32_16x16x32_bf16 v[64:67], v[152:155], v[184:187], v[64:67]
    ds_read2_b32 v[102:103], v41 offset0:18 offset1:19
    v_mfma_f32_16x16x32_bf16 v[68:71], v[152:155], v[188:191], v[68:71]
    ds_read_b128 v[136:139], v44 offset:3136
    v_mfma_f32_16x16x32_bf16 v[72:75], v[152:155], v[192:195], v[72:75]
    ds_read2_b32 v[104:105], v42 offset0:16 offset1:17
    v_mfma_f32_16x16x32_bf16 v[76:79], v[152:155], v[196:199], v[76:79]
    ds_read2_b32 v[106:107], v42 offset0:18 offset1:19
    v_mfma_f32_16x16x32_bf16 v[60:63], v[156:159], v[176:179], v[60:63]
    ds_read_b128 v[140:143], v44 offset:3648
    v_mfma_f32_16x16x32_bf16 v[64:67], v[156:159], v[180:183], v[64:67]
    ds_read2_b32 v[108:109], v43 offset0:16 offset1:17
    v_mfma_f32_16x16x32_bf16 v[68:71], v[156:159], v[184:187], v[68:71]
    ds_read2_b32 v[110:111], v43 offset0:18 offset1:19
    v_mfma_f32_16x16x32_bf16 v[72:75], v[156:159], v[188:191], v[72:75]
    v_mfma_f32_16x16x32_bf16 v[76:79], v[156:159], v[192:195], v[76:79]
    v_mfma_f32_16x16x32_bf16 v[64:67], v[160:163], v[176:179], v[64:67]
    v_mfma_f32_16x16x32_bf16 v[68:71], v[160:163], v[180:183], v[68:71]
    v_mfma_f32_16x16x32_bf16 v[72:75], v[160:163], v[184:187], v[72:75]
    v_mfma_f32_16x16x32_bf16 v[76:79], v[160:163], v[188:191], v[76:79]
    v_mfma_f32_16x16x32_bf16 v[68:71], v[164:167], v[176:179], v[68:71]
    v_mfma_f32_16x16x32_bf16 v[72:75], v[164:167], v[180:183], v[72:75]
    v_mfma_f32_16x16x32_bf16 v[76:79], v[164:167], v[184:187], v[76:79]
    v_mfma_f32_16x16x32_bf16 v[72:75], v[168:171], v[176:179], v[72:75]
    v_mfma_f32_16x16x32_bf16 v[76:79], v[168:171], v[180:183], v[76:79]
    v_mfma_f32_16x16x32_bf16 v[76:79], v[172:175], v[176:179], v[76:79]
    s_waitcnt lgkmcnt(0)
    v_mfma_f32_16x16x32_bf16 v[48:51], v[80:83], v[112:115], v[48:51]
    ds_read_b128 v[176:179], v44 offset:0
    v_mfma_f32_16x16x32_bf16 v[52:55], v[80:83], v[116:119], v[52:55]
    ds_read2_b32 v[144:145], v36 offset0:0 offset1:1
    v_mfma_f32_16x16x32_bf16 v[56:59], v[80:83], v[120:123], v[56:59]
    ds_read2_b32 v[146:147], v36 offset0:2 offset1:3
    v_mfma_f32_16x16x32_bf16 v[60:63], v[80:83], v[124:127], v[60:63]
    ds_read_b128 v[180:183], v44 offset:512
    v_mfma_f32_16x16x32_bf16 v[64:67], v[80:83], v[128:131], v[64:67]
    ds_read2_b32 v[148:149], v37 offset0:0 offset1:1
    v_mfma_f32_16x16x32_bf16 v[68:71], v[80:83], v[132:135], v[68:71]
    ds_read2_b32 v[150:151], v37 offset0:2 offset1:3
    v_mfma_f32_16x16x32_bf16 v[72:75], v[80:83], v[136:139], v[72:75]
    ds_read_b128 v[184:187], v44 offset:1024
    v_mfma_f32_16x16x32_bf16 v[76:79], v[80:83], v[140:143], v[76:79]
    ds_read2_b32 v[152:153], v38 offset0:0 offset1:1
    v_mfma_f32_16x16x32_bf16 v[52:55], v[84:87], v[112:115], v[52:55]
    ds_read2_b32 v[154:155], v38 offset0:2 offset1:3
    v_mfma_f32_16x16x32_bf16 v[56:59], v[84:87], v[116:119], v[56:59]
    ds_read_b128 v[188:191], v44 offset:1536
    v_mfma_f32_16x16x32_bf16 v[60:63], v[84:87], v[120:123], v[60:63]
    ds_read2_b32 v[156:157], v39 offset0:0 offset1:1
    v_mfma_f32_16x16x32_bf16 v[64:67], v[84:87], v[124:127], v[64:67]
    ds_read2_b32 v[158:159], v39 offset0:2 offset1:3
    v_mfma_f32_16x16x32_bf16 v[68:71], v[84:87], v[128:131], v[68:71]
    ds_read_b128 v[192:195], v44 offset:2048
    v_mfma_f32_16x16x32_bf16 v[72:75], v[84:87], v[132:135], v[72:75]
    ds_read2_b32 v[160:161], v40 offset0:0 offset1:1
    v_mfma_f32_16x16x32_bf16 v[76:79], v[84:87], v[136:139], v[76:79]
    ds_read2_b32 v[162:163], v40 offset0:2 offset1:3
    v_mfma_f32_16x16x32_bf16 v[56:59], v[88:91], v[112:115], v[56:59]
    ds_read_b128 v[196:199], v44 offset:2560
    v_mfma_f32_16x16x32_bf16 v[60:63], v[88:91], v[116:119], v[60:63]
    ds_read2_b32 v[164:165], v41 offset0:0 offset1:1
    v_mfma_f32_16x16x32_bf16 v[64:67], v[88:91], v[120:123], v[64:67]
    ds_read2_b32 v[166:167], v41 offset0:2 offset1:3
    v_mfma_f32_16x16x32_bf16 v[68:71], v[88:91], v[124:127], v[68:71]
    ds_read_b128 v[200:203], v44 offset:3072
    v_mfma_f32_16x16x32_bf16 v[72:75], v[88:91], v[128:131], v[72:75]
    ds_read2_b32 v[168:169], v42 offset0:0 offset1:1
    v_mfma_f32_16x16x32_bf16 v[76:79], v[88:91], v[132:135], v[76:79]
    ds_read2_b32 v[170:171], v42 offset0:2 offset1:3
    v_mfma_f32_16x16x32_bf16 v[60:63], v[92:95], v[112:115], v[60:63]
    ds_read_b128 v[204:207], v44 offset:3584
    v_mfma_f32_16x16x32_bf16 v[64:67], v[92:95], v[116:119], v[64:67]
    ds_read2_b32 v[172:173], v43 offset0:0 offset1:1
    v_mfma_f32_16x16x32_bf16 v[68:71], v[92:95], v[120:123], v[68:71]
    ds_read2_b32 v[174:175], v43 offset0:2 offset1:3
    v_mfma_f32_16x16x32_bf16 v[72:75], v[92:95], v[124:127], v[72:75]
    v_mfma_f32_16x16x32_bf16 v[76:79], v[92:95], v[128:131], v[76:79]
    v_mfma_f32_16x16x32_bf16 v[64:67], v[96:99], v[112:115], v[64:67]
    v_mfma_f32_16x16x32_bf16 v[68:71], v[96:99], v[116:119], v[68:71]
    v_mfma_f32_16x16x32_bf16 v[72:75], v[96:99], v[120:123], v[72:75]
    v_mfma_f32_16x16x32_bf16 v[76:79], v[96:99], v[124:127], v[76:79]
    v_mfma_f32_16x16x32_bf16 v[68:71], v[100:103], v[112:115], v[68:71]
    v_mfma_f32_16x16x32_bf16 v[72:75], v[100:103], v[116:119], v[72:75]
    v_mfma_f32_16x16x32_bf16 v[76:79], v[100:103], v[120:123], v[76:79]
    v_mfma_f32_16x16x32_bf16 v[72:75], v[104:107], v[112:115], v[72:75]
    v_mfma_f32_16x16x32_bf16 v[76:79], v[104:107], v[116:119], v[76:79]
    v_mfma_f32_16x16x32_bf16 v[76:79], v[108:111], v[112:115], v[76:79]
    s_waitcnt lgkmcnt(0)
    v_mfma_f32_16x16x32_bf16 v[48:51], v[144:147], v[176:179], v[48:51]
    v_mfma_f32_16x16x32_bf16 v[52:55], v[144:147], v[180:183], v[52:55]
    v_mfma_f32_16x16x32_bf16 v[56:59], v[144:147], v[184:187], v[56:59]
    v_mfma_f32_16x16x32_bf16 v[60:63], v[144:147], v[188:191], v[60:63]
    v_mfma_f32_16x16x32_bf16 v[64:67], v[144:147], v[192:195], v[64:67]
    v_mfma_f32_16x16x32_bf16 v[68:71], v[144:147], v[196:199], v[68:71]
    v_mfma_f32_16x16x32_bf16 v[72:75], v[144:147], v[200:203], v[72:75]
    v_mfma_f32_16x16x32_bf16 v[76:79], v[144:147], v[204:207], v[76:79]
    v_mfma_f32_16x16x32_bf16 v[52:55], v[148:151], v[176:179], v[52:55]
    v_mfma_f32_16x16x32_bf16 v[56:59], v[148:151], v[180:183], v[56:59]
    v_mfma_f32_16x16x32_bf16 v[60:63], v[148:151], v[184:187], v[60:63]
    v_mfma_f32_16x16x32_bf16 v[64:67], v[148:151], v[188:191], v[64:67]
    v_mfma_f32_16x16x32_bf16 v[68:71], v[148:151], v[192:195], v[68:71]
    v_mfma_f32_16x16x32_bf16 v[72:75], v[148:151], v[196:199], v[72:75]
    v_mfma_f32_16x16x32_bf16 v[76:79], v[148:151], v[200:203], v[76:79]
    v_mfma_f32_16x16x32_bf16 v[56:59], v[152:155], v[176:179], v[56:59]
    v_mfma_f32_16x16x32_bf16 v[60:63], v[152:155], v[180:183], v[60:63]
    v_mfma_f32_16x16x32_bf16 v[64:67], v[152:155], v[184:187], v[64:67]
    v_mfma_f32_16x16x32_bf16 v[68:71], v[152:155], v[188:191], v[68:71]
    v_mfma_f32_16x16x32_bf16 v[72:75], v[152:155], v[192:195], v[72:75]
    v_mfma_f32_16x16x32_bf16 v[76:79], v[152:155], v[196:199], v[76:79]
    v_mfma_f32_16x16x32_bf16 v[60:63], v[156:159], v[176:179], v[60:63]
    v_mfma_f32_16x16x32_bf16 v[64:67], v[156:159], v[180:183], v[64:67]
    v_mfma_f32_16x16x32_bf16 v[68:71], v[156:159], v[184:187], v[68:71]
    v_mfma_f32_16x16x32_bf16 v[72:75], v[156:159], v[188:191], v[72:75]
    v_mfma_f32_16x16x32_bf16 v[76:79], v[156:159], v[192:195], v[76:79]
    v_mfma_f32_16x16x32_bf16 v[64:67], v[160:163], v[176:179], v[64:67]
    v_mfma_f32_16x16x32_bf16 v[68:71], v[160:163], v[180:183], v[68:71]
    v_mfma_f32_16x16x32_bf16 v[72:75], v[160:163], v[184:187], v[72:75]
    v_mfma_f32_16x16x32_bf16 v[76:79], v[160:163], v[188:191], v[76:79]
    v_mfma_f32_16x16x32_bf16 v[68:71], v[164:167], v[176:179], v[68:71]
    v_mfma_f32_16x16x32_bf16 v[72:75], v[164:167], v[180:183], v[72:75]
    v_mfma_f32_16x16x32_bf16 v[76:79], v[164:167], v[184:187], v[76:79]
    v_mfma_f32_16x16x32_bf16 v[72:75], v[168:171], v[176:179], v[72:75]
    v_mfma_f32_16x16x32_bf16 v[76:79], v[168:171], v[180:183], v[76:79]
    v_mfma_f32_16x16x32_bf16 v[76:79], v[172:175], v[176:179], v[76:79]
    s_nop 7
    v_lshlrev_b32 v5, 6, v2
    v_lshl_add_u32 v5, v3, 4, v5
    v_add_u32 v5, v5, v4
    ds_write_b128 v5, v[48:51] offset:7424
    ds_write_b128 v5, v[52:55] offset:8448
    ds_write_b128 v5, v[56:59] offset:9472
    ds_write_b128 v5, v[60:63] offset:10496
    ds_write_b128 v5, v[64:67] offset:11520
    ds_write_b128 v5, v[68:71] offset:12544
    ds_write_b128 v5, v[72:75] offset:13568
    ds_write_b128 v5, v[76:79] offset:14592
    v_mov_b64 v[8:9], v[16:17]
    v_mov_b64 v[10:11], v[18:19]
    v_mov_b64 v[12:13], v[20:21]
    v_mov_b64 v[14:15], v[22:23]
    v_mov_b32 v24, v25
    v_add_u32 v4, 65536, v4
    s_add_u32 s28, s28, 1
    s_cmp_lt_u32 s28, 2
    s_waitcnt lgkmcnt(0)
    s_cbranch_scc1 ss_pass
    s_mov_b32 s12, s74
    s_mov_b32 s13, s75
    s_mov_b32 s14, 1152
    s_mov_b32 s15, 0x20000
    s_lshl_b32 s23, s20, 1
    buffer_load_dwordx4 v[8:11], off, s[12:15], s23
    s_barrier
    v_lshlrev_b32 v5, 5, v0
    v_add_u32 v7, 65536, v5
    ds_read_b128 v[64:67], v5 offset:7424
    ds_read_b128 v[68:71], v5 offset:7440
    ds_read_b128 v[72:75], v5 offset:23808
    ds_read_b128 v[76:79], v5 offset:23824
    ds_read_b128 v[80:83], v5 offset:40192
    ds_read_b128 v[84:87], v5 offset:40208
    ds_read_b128 v[88:91], v5 offset:56576
    ds_read_b128 v[92:95], v5 offset:56592
    ds_read_b128 v[96:99], v7 offset:7424
    ds_read_b128 v[100:103], v7 offset:7440
    ds_read_b128 v[104:107], v7 offset:23808
    ds_read_b128 v[108:111], v7 offset:23824
    ds_read_b128 v[112:115], v7 offset:40192
    ds_read_b128 v[116:119], v7 offset:40208
    ds_read_b128 v[120:123], v7 offset:56576
    ds_read_b128 v[124:127], v7 offset:56592
    s_waitcnt vmcnt(0)
    v_lshlrev_b32 v12, 16, v8
    v_and_b32 v13, 0xffff0000, v8
    v_lshlrev_b32 v14, 16, v9
    v_and_b32 v15, 0xffff0000, v9
    v_lshlrev_b32 v16, 16, v10
    v_and_b32 v17, 0xffff0000, v10
    v_lshlrev_b32 v18, 16, v11
    v_and_b32 v19, 0xffff0000, v11
    v_mul_u32_u24 v5, 18432, v0
    s_lshl_b32 s22, s20, 1
    s_add_u32 s22, s22, 1152
    s_waitcnt lgkmcnt(0)
    v_lshlrev_b32 v6, 16, v208
    v_fmac_f32 v64, v6, v12
    v_and_b32 v6, 0xffff0000, v208
    v_fmac_f32 v72, v6, v13
    v_lshlrev_b32 v6, 16, v209
    v_fmac_f32 v80, v6, v14
    v_and_b32 v6, 0xffff0000, v209
    v_fmac_f32 v88, v6, v15
    v_lshlrev_b32 v6, 16, v210
    v_fmac_f32 v96, v6, v16
    v_and_b32 v6, 0xffff0000, v210
    v_fmac_f32 v104, v6, v17
    v_lshlrev_b32 v6, 16, v211
    v_fmac_f32 v112, v6, v18
    v_and_b32 v6, 0xffff0000, v211
    v_fmac_f32 v120, v6, v19
    v_cvt_pk_bf16_f32 v208, v64, v72
    v_cvt_pk_bf16_f32 v209, v80, v88
    v_cvt_pk_bf16_f32 v210, v96, v104
    v_cvt_pk_bf16_f32 v211, v112, v120
    s_add_u32 s23, s22, 0
    buffer_store_dwordx4 v[208:211], v5, s[16:19], s23 offen
    v_lshlrev_b32 v6, 16, v212
    v_fmac_f32 v65, v6, v12
    v_and_b32 v6, 0xffff0000, v212
    v_fmac_f32 v73, v6, v13
    v_lshlrev_b32 v6, 16, v213
    v_fmac_f32 v81, v6, v14
    v_and_b32 v6, 0xffff0000, v213
    v_fmac_f32 v89, v6, v15
    v_lshlrev_b32 v6, 16, v214
    v_fmac_f32 v97, v6, v16
    v_and_b32 v6, 0xffff0000, v214
    v_fmac_f32 v105, v6, v17
    v_lshlrev_b32 v6, 16, v215
    v_fmac_f32 v113, v6, v18
    v_and_b32 v6, 0xffff0000, v215
    v_fmac_f32 v121, v6, v19
    v_cvt_pk_bf16_f32 v212, v65, v73
    v_cvt_pk_bf16_f32 v213, v81, v89
    v_cvt_pk_bf16_f32 v214, v97, v105
    v_cvt_pk_bf16_f32 v215, v113, v121
    s_add_u32 s23, s22, 2304
    buffer_store_dwordx4 v[212:215], v5, s[16:19], s23 offen
    v_lshlrev_b32 v6, 16, v216
    v_fmac_f32 v66, v6, v12
    v_and_b32 v6, 0xffff0000, v216
    v_fmac_f32 v74, v6, v13
    v_lshlrev_b32 v6, 16, v217
    v_fmac_f32 v82, v6, v14
    v_and_b32 v6, 0xffff0000, v217
    v_fmac_f32 v90, v6, v15
    v_lshlrev_b32 v6, 16, v218
    v_fmac_f32 v98, v6, v16
    v_and_b32 v6, 0xffff0000, v218
    v_fmac_f32 v106, v6, v17
    v_lshlrev_b32 v6, 16, v219
    v_fmac_f32 v114, v6, v18
    v_and_b32 v6, 0xffff0000, v219
    v_fmac_f32 v122, v6, v19
    v_cvt_pk_bf16_f32 v216, v66, v74
    v_cvt_pk_bf16_f32 v217, v82, v90
    v_cvt_pk_bf16_f32 v218, v98, v106
    v_cvt_pk_bf16_f32 v219, v114, v122
    s_add_u32 s23, s22, 4608
    buffer_store_dwordx4 v[216:219], v5, s[16:19], s23 offen
    v_lshlrev_b32 v6, 16, v220
    v_fmac_f32 v67, v6, v12
    v_and_b32 v6, 0xffff0000, v220
    v_fmac_f32 v75, v6, v13
    v_lshlrev_b32 v6, 16, v221
    v_fmac_f32 v83, v6, v14
    v_and_b32 v6, 0xffff0000, v221
    v_fmac_f32 v91, v6, v15
    v_lshlrev_b32 v6, 16, v222
    v_fmac_f32 v99, v6, v16
    v_and_b32 v6, 0xffff0000, v222
    v_fmac_f32 v107, v6, v17
    v_lshlrev_b32 v6, 16, v223
    v_fmac_f32 v115, v6, v18
    v_and_b32 v6, 0xffff0000, v223
    v_fmac_f32 v123, v6, v19
    v_cvt_pk_bf16_f32 v220, v67, v75
    v_cvt_pk_bf16_f32 v221, v83, v91
    v_cvt_pk_bf16_f32 v222, v99, v107
    v_cvt_pk_bf16_f32 v223, v115, v123
    s_add_u32 s23, s22, 6912
    buffer_store_dwordx4 v[220:223], v5, s[16:19], s23 offen
    v_lshlrev_b32 v6, 16, v224
    v_fmac_f32 v68, v6, v12
    v_and_b32 v6, 0xffff0000, v224
    v_fmac_f32 v76, v6, v13
    v_lshlrev_b32 v6, 16, v225
    v_fmac_f32 v84, v6, v14
    v_and_b32 v6, 0xffff0000, v225
    v_fmac_f32 v92, v6, v15
    v_lshlrev_b32 v6, 16, v226
    v_fmac_f32 v100, v6, v16
    v_and_b32 v6, 0xffff0000, v226
    v_fmac_f32 v108, v6, v17
    v_lshlrev_b32 v6, 16, v227
    v_fmac_f32 v116, v6, v18
    v_and_b32 v6, 0xffff0000, v227
    v_fmac_f32 v124, v6, v19
    v_cvt_pk_bf16_f32 v224, v68, v76
    v_cvt_pk_bf16_f32 v225, v84, v92
    v_cvt_pk_bf16_f32 v226, v100, v108
    v_cvt_pk_bf16_f32 v227, v116, v124
    s_add_u32 s23, s22, 9216
    buffer_store_dwordx4 v[224:227], v5, s[16:19], s23 offen
    v_lshlrev_b32 v6, 16, v228
    v_fmac_f32 v69, v6, v12
    v_and_b32 v6, 0xffff0000, v228
    v_fmac_f32 v77, v6, v13
    v_lshlrev_b32 v6, 16, v229
    v_fmac_f32 v85, v6, v14
    v_and_b32 v6, 0xffff0000, v229
    v_fmac_f32 v93, v6, v15
    v_lshlrev_b32 v6, 16, v230
    v_fmac_f32 v101, v6, v16
    v_and_b32 v6, 0xffff0000, v230
    v_fmac_f32 v109, v6, v17
    v_lshlrev_b32 v6, 16, v231
    v_fmac_f32 v117, v6, v18
    v_and_b32 v6, 0xffff0000, v231
    v_fmac_f32 v125, v6, v19
    v_cvt_pk_bf16_f32 v228, v69, v77
    v_cvt_pk_bf16_f32 v229, v85, v93
    v_cvt_pk_bf16_f32 v230, v101, v109
    v_cvt_pk_bf16_f32 v231, v117, v125
    s_add_u32 s23, s22, 11520
    buffer_store_dwordx4 v[228:231], v5, s[16:19], s23 offen
    v_lshlrev_b32 v6, 16, v232
    v_fmac_f32 v70, v6, v12
    v_and_b32 v6, 0xffff0000, v232
    v_fmac_f32 v78, v6, v13
    v_lshlrev_b32 v6, 16, v233
    v_fmac_f32 v86, v6, v14
    v_and_b32 v6, 0xffff0000, v233
    v_fmac_f32 v94, v6, v15
    v_lshlrev_b32 v6, 16, v234
    v_fmac_f32 v102, v6, v16
    v_and_b32 v6, 0xffff0000, v234
    v_fmac_f32 v110, v6, v17
    v_lshlrev_b32 v6, 16, v235
    v_fmac_f32 v118, v6, v18
    v_and_b32 v6, 0xffff0000, v235
    v_fmac_f32 v126, v6, v19
    v_cvt_pk_bf16_f32 v232, v70, v78
    v_cvt_pk_bf16_f32 v233, v86, v94
    v_cvt_pk_bf16_f32 v234, v102, v110
    v_cvt_pk_bf16_f32 v235, v118, v126
    s_add_u32 s23, s22, 13824
    buffer_store_dwordx4 v[232:235], v5, s[16:19], s23 offen
    v_lshlrev_b32 v6, 16, v236
    v_fmac_f32 v71, v6, v12
    v_and_b32 v6, 0xffff0000, v236
    v_fmac_f32 v79, v6, v13
    v_lshlrev_b32 v6, 16, v237
    v_fmac_f32 v87, v6, v14
    v_and_b32 v6, 0xffff0000, v237
    v_fmac_f32 v95, v6, v15
    v_lshlrev_b32 v6, 16, v238
    v_fmac_f32 v103, v6, v16
    v_and_b32 v6, 0xffff0000, v238
    v_fmac_f32 v111, v6, v17
    v_lshlrev_b32 v6, 16, v239
    v_fmac_f32 v119, v6, v18
    v_and_b32 v6, 0xffff0000, v239
    v_fmac_f32 v127, v6, v19
    v_cvt_pk_bf16_f32 v236, v71, v79
    v_cvt_pk_bf16_f32 v237, v87, v95
    v_cvt_pk_bf16_f32 v238, v103, v111
    v_cvt_pk_bf16_f32 v239, v119, v127
    s_add_u32 s23, s22, 16128
    buffer_store_dwordx4 v[236:239], v5, s[16:19], s23 offen
    s_branch L_ssm_next
L_ssm_done:
    s_cmp_lt_u32 s93, 100
    s_cbranch_scc1 L_exit
    s_mov_b32 s8, s76
    s_mov_b32 s9, s77
    s_mov_b32 s10, 4718592
    s_mov_b32 s11, 0x20000
    s_cmp_le_u32 s45, 1
    s_cbranch_scc1 L_att_next
    s_branch L_op_nextcb
L_wf_next:
    s_mov_b32 s37, 20
    v_mov_b32 v250, 1
    v_mov_b32 v251, 163832
    v_cmp_eq_u32 vcc, 0, v0
    s_nop 0
    s_and_saveexec_b64 s[38:39], vcc
    s_cbranch_execz tk12
    buffer_atomic_add v250, off, s[84:87], s37 sc0
    s_waitcnt vmcnt(0)
    ds_write_b32 v251, v250
    s_waitcnt lgkmcnt(0)
tk12:
    s_mov_b64 exec, -1
    s_barrier
    ds_read_b32 v252, v251
    s_waitcnt lgkmcnt(0)
    v_readfirstlane_b32 s33, v252
    s_barrier
    s_nop 3
    s_cmp_ge_u32 s33, 160
    s_cbranch_scc1 L_ssm_next
    s_lshl_b32 s16, s33, 2
    s_add_u32 s16, s16, s32
    s_add_u32 s16, s16, 1504
    s_call_b64 s[46:47], L_xform
    s_lshl_b32 s40, s33, 2
    s_add_u32 s40, s40, 125841408
    s_waitcnt vmcnt(0)
    s_barrier
    v_mov_b32 v250, s95
    v_cmp_eq_u32 vcc, 0, v0
    s_nop 0
    s_and_saveexec_b64 s[38:39], vcc
    s_cbranch_execz fs13
    buffer_store_dword v250, off, s[4:7], s40 sc1
fs13:
    s_mov_b64 exec, -1
    s_branch L_wf_next
L_phase2:
    s_mov_b32 s40, 524288
mc2_w:
    buffer_load_dword v250, off, s[84:87], 0 offset:28 sc1
    s_waitcnt vmcnt(0)
    v_readfirstlane_b32 s41, v250
    s_nop 0
    s_cmp_lg_u32 s41, 0
    s_cbranch_scc1 mc2_known
    s_sub_u32 s40, s40, 1
    s_cbranch_scc1 mc2_force
    s_sleep 2
    s_branch mc2_w
mc2_force:
    v_mov_b32 v250, 2
    v_mov_b32 v251, 0
    s_mov_b64 exec, 1
    buffer_atomic_cmpswap v[250:251], off, s[84:87], 0 offset:28
    s_mov_b64 exec, -1
    s_waitcnt vmcnt(0)
    s_mov_b32 s40, 524288
    s_branch mc2_w
mc2_known:
    s_cmp_eq_u32 s41, 1
    s_cbranch_scc1 L_phase2b
    s_mov_b32 s37, 208
    v_mov_b32 v250, 1
    v_mov_b32 v251, 163832
    v_cmp_eq_u32 vcc, 0, v0
    s_nop 0
    s_and_saveexec_b64 s[38:39], vcc
    s_cbranch_execz tk14
    buffer_atomic_add v250, off, s[84:87], s37 sc0
    s_waitcnt vmcnt(0)
    ds_write_b32 v251, v250
    s_waitcnt lgkmcnt(0)
tk14:
    s_mov_b64 exec, -1
    s_barrier
    ds_read_b32 v252, v251
    s_waitcnt lgkmcnt(0)
    v_readfirstlane_b32 s12, v252
    s_barrier
    s_nop 3
    s_cmp_lt_u32 s12, 32
    s_cbranch_scc1 L_chain_safe
    s_sub_u32 s45, s12, 32
L_phase2b:
    s_mov_b32 s8, s76
    s_mov_b32 s9, s77
    s_mov_b32 s10, 4718592
    s_mov_b32 s11, 0x20000
    s_and_b32 s36, s45, 15
    s_bitcmp1_b32 42315, s36
    s_cbranch_scc0 L_nots
    s_cmp_eq_u32 s93, 500
    s_cbranch_scc1 L_ssm_next
    s_branch L_wf_next
L_nots:
    s_bitcmp1_b32 18576, s36
    s_cbranch_scc0 L_att_next
    s_bfm_b32 s37, s36, 0
    s_and_b32 s37, s37, 18576
    s_bcnt1_i32_b32 s37, s37
    s_lshr_b32 s40, s45, 4
    s_mul_i32 s40, s40, 4
    s_add_u32 s33, s40, s37
L_op_mod:
    s_mul_hi_u32 s41, s33, 0x0e38e38f
    s_mul_i32 s41, s41, 18
    s_sub_u32 s33, s33, s41
    s_branch L_op_start
L_att_next:
    s_mov_b32 s37, 16
    v_mov_b32 v250, 1
    v_mov_b32 v251, 163832
    v_cmp_eq_u32 vcc, 0, v0
    s_nop 0
    s_and_saveexec_b64 s[38:39], vcc
    s_cbranch_execz tk15
    buffer_atomic_add v250, off, s[84:87], s37 sc0
    s_waitcnt vmcnt(0)
    ds_write_b32 v251, v250
    s_waitcnt lgkmcnt(0)
tk15:
    s_mov_b64 exec, -1
    s_barrier
    ds_read_b32 v252, v251
    s_waitcnt lgkmcnt(0)
    v_readfirstlane_b32 s34, v252
    s_barrier
    s_nop 3
    s_cmp_ge_u32 s34, 512
    s_cbranch_scc1 L_op_nextcb
    s_lshr_b32 s16, s34, 3
    s_and_b32 s17, s34, 7
    s_lshl_b32 s17, s17, 2
    s_add_u32 s17, s17, s32
    s_lshl_b32 s36, s17, 7
    s_add_u32 s36, s36, 125829120
    s_lshr_b32 s41, s16, 2
    s_add_u32 s41, s41, s95
    s_add_u32 s41, s41, 1
    v_and_b32 v1, 3, v0
    v_min_u32 v1, 2, v1
    v_lshlrev_b32 v2, 4, v1
    s_and_b32 s37, s16, 3
    s_lshl_b32 s37, s37, 2
    v_add_u32 v2, s37, v2
    s_mov_b32 s40, 4194304
L_aw1:
    buffer_load_dword v3, v2, s[4:7], s36 offen sc1
    s_sub_u32 s40, s40, 1
    s_cbranch_scc1 L_aw1_go
    s_waitcnt vmcnt(0)
    v_subrev_u32 v3, s41, v3
    v_cmp_lt_u32 vcc, 64, v3
    s_cbranch_vccz L_aw1_go
    s_sleep 4
    s_branch L_aw1
L_aw1_go:
    v_and_b32 v5, 63, v0
    v_lshlrev_b32 v1, 4, v5
    s_cmp_ge_u32 s16, 56
    s_cselect_b32 s18, -1, 511
    v_and_b32 v2, s18, v1
    v_or_b32 v3, 128, v1
    v_lshrrev_b32 v4, 4, v5
    v_bfe_u32 v6, v5, 2, 2
    v_sub_u32 v4, v6, v4
    v_lshlrev_b32 v4, 3, v4
    v_and_b32 v6, 3, v5
    v_add_u32 v4, v4, v6
    v_mov_b32 v6, 0xf149f2ca
    s_mov_b32 s22, 0x3e0293ee
    s_lshl_b32 s18, s16, 5
    s_add_u32 s18, s18, s17
    s_lshl_b32 s19, s18, 13
    s_add_u32 s20, s19, 33554432
    buffer_load_dwordx4 v[8:11], v1, s[4:7], s20 offen offset:0 sc1
    s_add_u32 s20, s19, 33554432
    buffer_load_dwordx4 v[12:15], v1, s[4:7], s20 offen offset:1024 sc1
    s_add_u32 s20, s19, 33554432
    buffer_load_dwordx4 v[16:19], v1, s[4:7], s20 offen offset:2048 sc1
    s_add_u32 s20, s19, 33554432
    buffer_load_dwordx4 v[20:23], v1, s[4:7], s20 offen offset:3072 sc1
    s_add_u32 s20, s19, 33558528
    buffer_load_dwordx4 v[24:27], v1, s[4:7], s20 offen offset:0 sc1
    s_add_u32 s20, s19, 33558528
    buffer_load_dwordx4 v[28:31], v1, s[4:7], s20 offen offset:1024 sc1
    s_add_u32 s20, s19, 33558528
    buffer_load_dwordx4 v[32:35], v1, s[4:7], s20 offen offset:2048 sc1
    s_add_u32 s20, s19, 33558528
    buffer_load_dwordx4 v[36:39], v1, s[4:7], s20 offen offset:3072 sc1
    s_lshl_b32 s21, s18, 14
    s_add_u32 s20, s21, 0
    buffer_load_dwordx4 v[40:43], v1, s[4:7], s20 offen offset:0 sc1
    s_add_u32 s20, s21, 4096
    buffer_load_dwordx4 v[44:47], v1, s[4:7], s20 offen offset:0 sc1
    s_add_u32 s20, s21, 8192
    buffer_load_dwordx4 v[48:51], v1, s[4:7], s20 offen offset:0 sc1
    s_add_u32 s20, s21, 12288
    buffer_load_dwordx4 v[52:55], v1, s[4:7], s20 offen offset:0 sc1
    s_add_u32 s20, s21, 0
    buffer_load_dwordx4 v[56:59], v1, s[4:7], s20 offen offset:1024 sc1
    s_add_u32 s20, s21, 4096
    buffer_load_dwordx4 v[60:63], v1, s[4:7], s20 offen offset:1024 sc1
    s_add_u32 s20, s21, 8192
    buffer_load_dwordx4 v[64:67], v1, s[4:7], s20 offen offset:1024 sc1
    s_add_u32 s20, s21, 12288
    buffer_load_dwordx4 v[68:71], v1, s[4:7], s20 offen offset:1024 sc1
    s_add_u32 s20, s21, 0
    buffer_load_dwordx4 v[88:91], v1, s[4:7], s20 offen offset:2048 sc1
    s_add_u32 s20, s21, 4096
    buffer_load_dwordx4 v[92:95], v1, s[4:7], s20 offen offset:2048 sc1
    s_add_u32 s20, s21, 8192
    buffer_load_dwordx4 v[96:99], v1, s[4:7], s20 offen offset:2048 sc1
    s_add_u32 s20, s21, 12288
    buffer_load_dwordx4 v[100:103], v1, s[4:7], s20 offen offset:2048 sc1
    s_add_u32 s20, s21, 0
    buffer_load_dwordx4 v[104:107], v1, s[4:7], s20 offen offset:3072 sc1
    s_add_u32 s20, s21, 4096
    buffer_load_dwordx4 v[108:111], v1, s[4:7], s20 offen offset:3072 sc1
    s_add_u32 s20, s21, 8192
    buffer_load_dwordx4 v[112:115], v1, s[4:7], s20 offen offset:3072 sc1
    s_add_u32 s20, s21, 12288
    buffer_load_dwordx4 v[116:119], v1, s[4:7], s20 offen offset:3072 sc1
    v_mov_b32 v172, 0x3f803f80
    v_mov_b32 v173, 0x3f803f80
    v_mov_b32 v174, 0x3f803f80
    v_mov_b32 v175, 0x3f803f80
    v_mov_b32 v176, 0x3f003f00
    v_mov_b32 v177, 0x3f003f00
    s_waitcnt vmcnt(8)
    v_mfma_f32_16x16x32_bf16 v[136:139], v[40:43], v[8:11], 0
    v_mfma_f32_16x16x32_bf16 v[140:143], v[56:59], v[8:11], 0
    v_mfma_f32_16x16x32_bf16 v[148:151], v[40:43], v[24:27], 0
    v_mfma_f32_16x16x32_bf16 v[152:155], v[56:59], v[24:27], 0
    v_mfma_f32_16x16x32_bf16 v[136:139], v[44:47], v[12:15], v[136:139]
    v_mfma_f32_16x16x32_bf16 v[140:143], v[60:63], v[12:15], v[140:143]
    v_mfma_f32_16x16x32_bf16 v[148:151], v[44:47], v[28:31], v[148:151]
    v_mfma_f32_16x16x32_bf16 v[152:155], v[60:63], v[28:31], v[152:155]
    v_mfma_f32_16x16x32_bf16 v[136:139], v[48:51], v[16:19], v[136:139]
    v_mfma_f32_16x16x32_bf16 v[140:143], v[64:67], v[16:19], v[140:143]
    v_mfma_f32_16x16x32_bf16 v[148:151], v[48:51], v[32:35], v[148:151]
    v_mfma_f32_16x16x32_bf16 v[152:155], v[64:67], v[32:35], v[152:155]
    v_mfma_f32_16x16x32_bf16 v[136:139], v[52:55], v[20:23], v[136:139]
    v_mfma_f32_16x16x32_bf16 v[140:143], v[68:71], v[20:23], v[140:143]
    v_mfma_f32_16x16x32_bf16 v[148:151], v[52:55], v[36:39], v[148:151]
    v_mfma_f32_16x16x32_bf16 v[152:155], v[68:71], v[36:39], v[152:155]
    v_cmp_le_i32 vcc, 0, v4
    s_nop 3
    v_cndmask_b32 v136, v6, v136, vcc
    v_cmp_le_i32 vcc, 1, v4
    s_nop 1
    v_cndmask_b32 v137, v6, v137, vcc
    v_cmp_le_i32 vcc, 2, v4
    s_nop 1
    v_cndmask_b32 v138, v6, v138, vcc
    v_cmp_le_i32 vcc, 3, v4
    s_nop 1
    v_cndmask_b32 v139, v6, v139, vcc
    v_cmp_le_i32 vcc, 4, v4
    s_nop 1
    v_cndmask_b32 v140, v6, v140, vcc
    v_cmp_le_i32 vcc, 5, v4
    s_nop 1
    v_cndmask_b32 v141, v6, v141, vcc
    v_cmp_le_i32 vcc, 6, v4
    s_nop 1
    v_cndmask_b32 v142, v6, v142, vcc
    v_cmp_le_i32 vcc, 7, v4
    s_nop 1
    v_cndmask_b32 v143, v6, v143, vcc
    v_cmp_le_i32 vcc, -4, v4
    s_nop 1
    v_cndmask_b32 v148, v6, v148, vcc
    v_cmp_le_i32 vcc, -3, v4
    s_nop 1
    v_cndmask_b32 v149, v6, v149, vcc
    v_cmp_le_i32 vcc, -2, v4
    s_nop 1
    v_cndmask_b32 v150, v6, v150, vcc
    v_cmp_le_i32 vcc, -1, v4
    s_nop 1
    v_cndmask_b32 v151, v6, v151, vcc
    v_cmp_le_i32 vcc, 0, v4
    s_nop 1
    v_cndmask_b32 v152, v6, v152, vcc
    v_cmp_le_i32 vcc, 1, v4
    s_nop 1
    v_cndmask_b32 v153, v6, v153, vcc
    v_cmp_le_i32 vcc, 2, v4
    s_nop 1
    v_cndmask_b32 v154, v6, v154, vcc
    v_cmp_le_i32 vcc, 3, v4
    s_nop 1
    v_cndmask_b32 v155, v6, v155, vcc
    s_nop 1
    v_and_b32 v198, 1, v0
    v_lshlrev_b32 v198, 2, v198
    v_add_u32 v198, 48, v198
    s_add_u32 s41, s16, s95
    s_add_u32 s41, s41, 1
    s_cmp_lt_u32 s16, 56
    s_cbranch_scc1 L_amk
    v_mov_b32 v198, 16384
L_amk:
    s_nop 1
    s_mov_b32 s88, 65536
    s_mov_b32 s89, 125853696
cw16:
    buffer_load_dword v199, off, s[4:7], s89 sc1
    s_waitcnt vmcnt(0)
    v_readfirstlane_b32 s42, v199
    s_nop 0
    s_sub_u32 s42, s42, s95
    s_cmp_gt_u32 s42, 64
    s_cselect_b32 s42, 0, s42
    s_add_u32 s42, s42, 1
    s_cmp_ge_u32 s42, s16
    s_cbranch_scc1 cw16x
    s_sub_u32 s88, s88, 1
    s_cbranch_scc1 cw16x
    s_sub_u32 s42, s16, s42
    s_min_u32 s42, s42, 6
cw16s:
    s_sleep 24
    s_sub_u32 s42, s42, 1
    s_cmp_lg_u32 s42, 0
    s_cbranch_scc1 cw16s
    s_branch cw16
cw16x:
    s_mov_b32 s40, 4194304
L_aw2:
    buffer_load_dword v199, v198, s[4:7], s36 offen sc1
    s_sub_u32 s40, s40, 1
    s_cbranch_scc1 L_aw2_go
    s_waitcnt vmcnt(0)
    v_subrev_u32 v199, s41, v199
    v_cmp_lt_u32 vcc, 64, v199
    s_cbranch_vccz L_aw2_go
    s_sleep 1
    s_branch L_aw2
L_aw2_go:
    s_lshl_b32 s20, s18, 12
    s_add_u32 s20, s20, 69206016
    buffer_load_dwordx4 v[72:75], v3, s[4:7], s20 offen offset:0 sc1
    buffer_load_dwordx4 v[76:79], v3, s[4:7], s20 offen offset:1024 sc1
    buffer_load_dwordx4 v[80:83], v3, s[4:7], s20 offen offset:2048 sc1
    buffer_load_dwordx4 v[84:87], v3, s[4:7], s20 offen offset:3072 sc1
    s_lshl_b32 s20, s18, 12
    s_add_u32 s20, s20, 77594624
    buffer_load_dwordx4 v[120:123], v2, s[4:7], s20 offen offset:0 sc1
    buffer_load_dwordx4 v[124:127], v2, s[4:7], s20 offen offset:1024 sc1
    buffer_load_dwordx4 v[128:131], v2, s[4:7], s20 offen offset:2048 sc1
    buffer_load_dwordx4 v[132:135], v2, s[4:7], s20 offen offset:3072 sc1
    s_waitcnt vmcnt(4)
    v_mfma_f32_16x16x32_bf16 v[144:147], v[72:75], v[8:11], 0
    v_mfma_f32_16x16x32_bf16 v[156:159], v[72:75], v[24:27], 0
    v_mfma_f32_16x16x32_bf16 v[144:147], v[76:79], v[12:15], v[144:147]
    v_mfma_f32_16x16x32_bf16 v[156:159], v[76:79], v[28:31], v[156:159]
    v_mfma_f32_16x16x32_bf16 v[144:147], v[80:83], v[16:19], v[144:147]
    v_mfma_f32_16x16x32_bf16 v[156:159], v[80:83], v[32:35], v[156:159]
    v_mfma_f32_16x16x32_bf16 v[144:147], v[84:87], v[20:23], v[144:147]
    v_mfma_f32_16x16x32_bf16 v[156:159], v[84:87], v[36:39], v[156:159]
    v_max3_f32 v196, v136, v137, v138
    v_max3_f32 v197, v139, v140, v141
    v_max3_f32 v196, v196, v142, v143
    s_nop 3
    v_max3_f32 v197, v197, v144, v145
    v_max3_f32 v196, v196, v146, v147
    v_max_f32 v196, v196, v197
    v_mov_b32 v197, v196
    s_nop 1
    v_permlane32_swap_b32 v196, v197
    v_max_f32 v196, v196, v197
    v_mov_b32 v197, v196
    s_nop 1
    v_permlane16_swap_b32 v196, v197
    v_max_f32 v196, v196, v197
    v_mul_f32 v196, s22, v196
    v_sub_f32 v196, 0, v196
    v_fma_f32 v136, v136, s22, v196
    v_fma_f32 v137, v137, s22, v196
    v_fma_f32 v138, v138, s22, v196
    v_fma_f32 v139, v139, s22, v196
    v_fma_f32 v140, v140, s22, v196
    v_fma_f32 v141, v141, s22, v196
    v_fma_f32 v142, v142, s22, v196
    v_fma_f32 v143, v143, s22, v196
    v_fma_f32 v144, v144, s22, v196
    v_fma_f32 v145, v145, s22, v196
    v_fma_f32 v146, v146, s22, v196
    v_fma_f32 v147, v147, s22, v196
    v_exp_f32 v136, v136
    v_exp_f32 v137, v137
    v_exp_f32 v138, v138
    v_exp_f32 v139, v139
    v_exp_f32 v140, v140
    v_exp_f32 v141, v141
    v_exp_f32 v142, v142
    v_exp_f32 v143, v143
    v_exp_f32 v144, v144
    v_exp_f32 v145, v145
    v_exp_f32 v146, v146
    v_exp_f32 v147, v147
    v_cvt_pk_bf16_f32 v160, v136, v137
    v_cvt_pk_bf16_f32 v161, v138, v139
    v_cvt_pk_bf16_f32 v162, v140, v141
    v_cvt_pk_bf16_f32 v163, v142, v143
    v_cvt_pk_bf16_f32 v164, v144, v145
    v_cvt_pk_bf16_f32 v165, v146, v147
    v_max3_f32 v196, v148, v149, v150
    v_max3_f32 v197, v151, v152, v153
    v_max3_f32 v196, v196, v154, v155
    v_max3_f32 v197, v197, v156, v157
    v_max3_f32 v196, v196, v158, v159
    v_max_f32 v196, v196, v197
    v_mov_b32 v197, v196
    s_nop 1
    v_permlane32_swap_b32 v196, v197
    v_max_f32 v196, v196, v197
    v_mov_b32 v197, v196
    s_nop 1
    v_permlane16_swap_b32 v196, v197
    v_max_f32 v196, v196, v197
    v_mul_f32 v196, s22, v196
    v_sub_f32 v196, 0, v196
    v_fma_f32 v148, v148, s22, v196
    v_fma_f32 v149, v149, s22, v196
    v_fma_f32 v150, v150, s22, v196
    v_fma_f32 v151, v151, s22, v196
    v_fma_f32 v152, v152, s22, v196
    v_fma_f32 v153, v153, s22, v196
    v_fma_f32 v154, v154, s22, v196
    v_fma_f32 v155, v155, s22, v196
    v_fma_f32 v156, v156, s22, v196
    v_fma_f32 v157, v157, s22, v196
    v_fma_f32 v158, v158, s22, v196
    v_fma_f32 v159, v159, s22, v196
    v_exp_f32 v148, v148
    v_exp_f32 v149, v149
    v_exp_f32 v150, v150
    v_exp_f32 v151, v151
    v_exp_f32 v152, v152
    v_exp_f32 v153, v153
    v_exp_f32 v154, v154
    v_exp_f32 v155, v155
    v_exp_f32 v156, v156
    v_exp_f32 v157, v157
    v_exp_f32 v158, v158
    v_exp_f32 v159, v159
    v_cvt_pk_bf16_f32 v166, v148, v149
    v_cvt_pk_bf16_f32 v167, v150, v151
    v_cvt_pk_bf16_f32 v168, v152, v153
    v_cvt_pk_bf16_f32 v169, v154, v155
    v_cvt_pk_bf16_f32 v170, v156, v157
    v_cvt_pk_bf16_f32 v171, v158, v159
    v_mfma_f32_16x16x32_bf16 v[180:183], v[172:175], v[160:163], 0
    v_mfma_f32_16x16x32_bf16 v[184:187], v[172:175], v[166:169], 0
    s_nop 4
    v_mfma_f32_16x16x16_bf16 v[180:183], v[176:177], v[164:165], v[180:183]
    v_mfma_f32_16x16x16_bf16 v[184:187], v[176:177], v[170:171], v[184:187]
    s_nop 6
    v_rcp_f32 v180, v180
    v_rcp_f32 v184, v184
    s_waitcnt vmcnt(0)
    s_lshl_b32 s18, s16, 18
    s_lshl_b32 s19, s17, 12
    s_add_u32 s18, s18, s19
    s_add_u32 s18, s18, 50331648
    s_add_u32 s19, s18, 131072
    v_mfma_f32_16x16x32_bf16 v[8:11], v[88:91], v[160:163], 0
    v_mfma_f32_16x16x32_bf16 v[12:15], v[104:107], v[160:163], 0
    v_mfma_f32_16x16x32_bf16 v[16:19], v[88:91], v[166:169], 0
    v_mfma_f32_16x16x32_bf16 v[20:23], v[104:107], v[166:169], 0
    v_mfma_f32_16x16x32_bf16 v[24:27], v[92:95], v[160:163], 0
    v_mfma_f32_16x16x32_bf16 v[28:31], v[108:111], v[160:163], 0
    v_mfma_f32_16x16x32_bf16 v[32:35], v[92:95], v[166:169], 0
    v_mfma_f32_16x16x32_bf16 v[36:39], v[108:111], v[166:169], 0
    v_mfma_f32_16x16x32_bf16 v[40:43], v[96:99], v[160:163], 0
    v_mfma_f32_16x16x32_bf16 v[44:47], v[112:115], v[160:163], 0
    v_mfma_f32_16x16x32_bf16 v[48:51], v[96:99], v[166:169], 0
    v_mfma_f32_16x16x32_bf16 v[52:55], v[112:115], v[166:169], 0
    v_mfma_f32_16x16x32_bf16 v[56:59], v[100:103], v[160:163], 0
    v_mfma_f32_16x16x32_bf16 v[60:63], v[116:119], v[160:163], 0
    v_mfma_f32_16x16x32_bf16 v[64:67], v[100:103], v[166:169], 0
    v_mfma_f32_16x16x32_bf16 v[68:71], v[116:119], v[166:169], 0
    v_mfma_f32_16x16x16_bf16 v[8:11], v[120:121], v[164:165], v[8:11]
    v_mfma_f32_16x16x16_bf16 v[12:15], v[122:123], v[164:165], v[12:15]
    v_mfma_f32_16x16x16_bf16 v[16:19], v[120:121], v[170:171], v[16:19]
    v_mfma_f32_16x16x16_bf16 v[20:23], v[122:123], v[170:171], v[20:23]
    v_mfma_f32_16x16x16_bf16 v[24:27], v[124:125], v[164:165], v[24:27]
    v_mfma_f32_16x16x16_bf16 v[28:31], v[126:127], v[164:165], v[28:31]
    v_mfma_f32_16x16x16_bf16 v[32:35], v[124:125], v[170:171], v[32:35]
    v_mfma_f32_16x16x16_bf16 v[36:39], v[126:127], v[170:171], v[36:39]
    v_mfma_f32_16x16x16_bf16 v[40:43], v[128:129], v[164:165], v[40:43]
    v_mfma_f32_16x16x16_bf16 v[44:47], v[130:131], v[164:165], v[44:47]
    v_mfma_f32_16x16x16_bf16 v[48:51], v[128:129], v[170:171], v[48:51]
    v_mfma_f32_16x16x16_bf16 v[52:55], v[130:131], v[170:171], v[52:55]
    v_mfma_f32_16x16x16_bf16 v[56:59], v[132:133], v[164:165], v[56:59]
    v_mfma_f32_16x16x16_bf16 v[60:63], v[134:135], v[164:165], v[60:63]
    v_mfma_f32_16x16x16_bf16 v[64:67], v[132:133], v[170:171], v[64:67]
    v_mfma_f32_16x16x16_bf16 v[68:71], v[134:135], v[170:171], v[68:71]
    v_mul_f32 v8, v8, v180
    v_mul_f32 v12, v12, v180
    v_mul_f32 v9, v9, v180
    v_mul_f32 v13, v13, v180
    v_mul_f32 v10, v10, v180
    v_mul_f32 v14, v14, v180
    v_mul_f32 v11, v11, v180
    v_mul_f32 v15, v15, v180
    v_cvt_pk_bf16_f32 v8, v8, v9
    v_cvt_pk_bf16_f32 v9, v10, v11
    v_cvt_pk_bf16_f32 v10, v12, v13
    v_cvt_pk_bf16_f32 v11, v14, v15
    buffer_store_dwordx4 v[8:11], v1, s[4:7], s18 offen offset:0 sc1
    v_mul_f32 v16, v16, v184
    v_mul_f32 v20, v20, v184
    v_mul_f32 v17, v17, v184
    v_mul_f32 v21, v21, v184
    v_mul_f32 v18, v18, v184
    v_mul_f32 v22, v22, v184
    v_mul_f32 v19, v19, v184
    v_mul_f32 v23, v23, v184
    v_cvt_pk_bf16_f32 v16, v16, v17
    v_cvt_pk_bf16_f32 v17, v18, v19
    v_cvt_pk_bf16_f32 v18, v20, v21
    v_cvt_pk_bf16_f32 v19, v22, v23
    buffer_store_dwordx4 v[16:19], v1, s[4:7], s19 offen offset:0 sc1
    v_mul_f32 v24, v24, v180
    v_mul_f32 v28, v28, v180
    v_mul_f32 v25, v25, v180
    v_mul_f32 v29, v29, v180
    v_mul_f32 v26, v26, v180
    v_mul_f32 v30, v30, v180
    v_mul_f32 v27, v27, v180
    v_mul_f32 v31, v31, v180
    v_cvt_pk_bf16_f32 v24, v24, v25
    v_cvt_pk_bf16_f32 v25, v26, v27
    v_cvt_pk_bf16_f32 v26, v28, v29
    v_cvt_pk_bf16_f32 v27, v30, v31
    buffer_store_dwordx4 v[24:27], v1, s[4:7], s18 offen offset:1024 sc1
    v_mul_f32 v32, v32, v184
    v_mul_f32 v36, v36, v184
    v_mul_f32 v33, v33, v184
    v_mul_f32 v37, v37, v184
    v_mul_f32 v34, v34, v184
    v_mul_f32 v38, v38, v184
    v_mul_f32 v35, v35, v184
    v_mul_f32 v39, v39, v184
    v_cvt_pk_bf16_f32 v32, v32, v33
    v_cvt_pk_bf16_f32 v33, v34, v35
    v_cvt_pk_bf16_f32 v34, v36, v37
    v_cvt_pk_bf16_f32 v35, v38, v39
    buffer_store_dwordx4 v[32:35], v1, s[4:7], s19 offen offset:1024 sc1
    v_mul_f32 v40, v40, v180
    v_mul_f32 v44, v44, v180
    v_mul_f32 v41, v41, v180
    v_mul_f32 v45, v45, v180
    v_mul_f32 v42, v42, v180
    v_mul_f32 v46, v46, v180
    v_mul_f32 v43, v43, v180
    v_mul_f32 v47, v47, v180
    v_cvt_pk_bf16_f32 v40, v40, v41
    v_cvt_pk_bf16_f32 v41, v42, v43
    v_cvt_pk_bf16_f32 v42, v44, v45
    v_cvt_pk_bf16_f32 v43, v46, v47
    buffer_store_dwordx4 v[40:43], v1, s[4:7], s18 offen offset:2048 sc1
    v_mul_f32 v48, v48, v184
    v_mul_f32 v52, v52, v184
    v_mul_f32 v49, v49, v184
    v_mul_f32 v53, v53, v184
    v_mul_f32 v50, v50, v184
    v_mul_f32 v54, v54, v184
    v_mul_f32 v51, v51, v184
    v_mul_f32 v55, v55, v184
    v_cvt_pk_bf16_f32 v48, v48, v49
    v_cvt_pk_bf16_f32 v49, v50, v51
    v_cvt_pk_bf16_f32 v50, v52, v53
    v_cvt_pk_bf16_f32 v51, v54, v55
    buffer_store_dwordx4 v[48:51], v1, s[4:7], s19 offen offset:2048 sc1
    v_mul_f32 v56, v56, v180
    v_mul_f32 v60, v60, v180
    v_mul_f32 v57, v57, v180
    v_mul_f32 v61, v61, v180
    v_mul_f32 v58, v58, v180
    v_mul_f32 v62, v62, v180
    v_mul_f32 v59, v59, v180
    v_mul_f32 v63, v63, v180
    v_cvt_pk_bf16_f32 v56, v56, v57
    v_cvt_pk_bf16_f32 v57, v58, v59
    v_cvt_pk_bf16_f32 v58, v60, v61
    v_cvt_pk_bf16_f32 v59, v62, v63
    buffer_store_dwordx4 v[56:59], v1, s[4:7], s18 offen offset:3072 sc1
    v_mul_f32 v64, v64, v184
    v_mul_f32 v68, v68, v184
    v_mul_f32 v65, v65, v184
    v_mul_f32 v69, v69, v184
    v_mul_f32 v66, v66, v184
    v_mul_f32 v70, v70, v184
    v_mul_f32 v67, v67, v184
    v_mul_f32 v71, v71, v184
    v_cvt_pk_bf16_f32 v64, v64, v65
    v_cvt_pk_bf16_f32 v65, v66, v67
    v_cvt_pk_bf16_f32 v66, v68, v69
    v_cvt_pk_bf16_f32 v67, v70, v71
    buffer_store_dwordx4 v[64:67], v1, s[4:7], s19 offen offset:3072 sc1
    s_lshr_b32 s40, s34, 1
    s_lshl_b32 s40, s40, 7
    s_and_b32 s41, s34, 1
    s_lshl_b32 s41, s41, 2
    s_add_u32 s40, s40, s41
    s_add_u32 s40, s40, 125894656
    s_waitcnt vmcnt(0)
    s_barrier
    v_mov_b32 v250, s95
    v_cmp_eq_u32 vcc, 0, v0
    s_nop 0
    s_and_saveexec_b64 s[38:39], vcc
    s_cbranch_execz fs17
    buffer_store_dword v250, off, s[4:7], s40 sc1
fs17:
    s_mov_b64 exec, -1
    s_branch L_att_next
L_op_start:
    s_lshl_b32 s35, s33, 2
    s_add_u32 s35, s35, 136
    s_lshr_b32 s89, s33, 2
    s_lshl_b32 s89, s89, 7
    s_add_u32 s89, s89, 125841408
    v_mbcnt_lo_u32_b32 v2, -1, 0
    v_mbcnt_hi_u32_b32 v2, -1, v2
    v_min_u32 v2, 31, v2
    v_lshlrev_b32 v2, 2, v2
    s_mov_b32 s88, 4194304
fw18:
    buffer_load_dword v3, v2, s[4:7], s89 offen offset:0 sc1
    s_sub_u32 s88, s88, 1
    s_cbranch_scc1 fw18x
    s_waitcnt vmcnt(0)
    v_cmp_ne_u32 vcc, s95, v3
    s_cbranch_vccz fw18x
    s_sleep 4
    s_branch fw18
fw18x:
    v_and_b32 v1, 63, v0
    v_lshlrev_b32 v1, 4, v1
    s_lshl_b32 s18, s33, 18
    s_lshl_b32 s19, s32, 16
    s_add_u32 s18, s18, s19
    s_add_u32 s18, s18, 130023424
    buffer_load_dwordx4 a[0:3], v1, s[4:7], s18 offen offset:0 sc1
    buffer_load_dwordx4 a[4:7], v1, s[4:7], s18 offen offset:1024 sc1
    buffer_load_dwordx4 a[8:11], v1, s[4:7], s18 offen offset:2048 sc1
    buffer_load_dwordx4 a[12:15], v1, s[4:7], s18 offen offset:3072 sc1
    s_add_u32 s18, s18, 4096
    buffer_load_dwordx4 a[16:19], v1, s[4:7], s18 offen offset:0 sc1
    buffer_load_dwordx4 a[20:23], v1, s[4:7], s18 offen offset:1024 sc1
    buffer_load_dwordx4 a[24:27], v1, s[4:7], s18 offen offset:2048 sc1
    buffer_load_dwordx4 a[28:31], v1, s[4:7], s18 offen offset:3072 sc1
    s_add_u32 s18, s18, 4096
    buffer_load_dwordx4 a[32:35], v1, s[4:7], s18 offen offset:0 sc1
    buffer_load_dwordx4 a[36:39], v1, s[4:7], s18 offen offset:1024 sc1
    buffer_load_dwordx4 a[40:43], v1, s[4:7], s18 offen offset:2048 sc1
    buffer_load_dwordx4 a[44:47], v1, s[4:7], s18 offen offset:3072 sc1
    s_add_u32 s18, s18, 4096
    buffer_load_dwordx4 a[48:51], v1, s[4:7], s18 offen offset:0 sc1
    buffer_load_dwordx4 a[52:55], v1, s[4:7], s18 offen offset:1024 sc1
    buffer_load_dwordx4 a[56:59], v1, s[4:7], s18 offen offset:2048 sc1
    buffer_load_dwordx4 a[60:63], v1, s[4:7], s18 offen offset:3072 sc1
    s_add_u32 s18, s18, 4096
    buffer_load_dwordx4 a[64:67], v1, s[4:7], s18 offen offset:0 sc1
    buffer_load_dwordx4 a[68:71], v1, s[4:7], s18 offen offset:1024 sc1
    buffer_load_dwordx4 a[72:75], v1, s[4:7], s18 offen offset:2048 sc1
    buffer_load_dwordx4 a[76:79], v1, s[4:7], s18 offen offset:3072 sc1
    s_add_u32 s18, s18, 4096
    buffer_load_dwordx4 a[80:83], v1, s[4:7], s18 offen offset:0 sc1
    buffer_load_dwordx4 a[84:87], v1, s[4:7], s18 offen offset:1024 sc1
    buffer_load_dwordx4 a[88:91], v1, s[4:7], s18 offen offset:2048 sc1
    buffer_load_dwordx4 a[92:95], v1, s[4:7], s18 offen offset:3072 sc1
    s_add_u32 s18, s18, 4096
    buffer_load_dwordx4 a[96:99], v1, s[4:7], s18 offen offset:0 sc1
    buffer_load_dwordx4 a[100:103], v1, s[4:7], s18 offen offset:1024 sc1
    buffer_load_dwordx4 a[104:107], v1, s[4:7], s18 offen offset:2048 sc1
    buffer_load_dwordx4 a[108:111], v1, s[4:7], s18 offen offset:3072 sc1
    s_add_u32 s18, s18, 4096
    buffer_load_dwordx4 a[112:115], v1, s[4:7], s18 offen offset:0 sc1
    buffer_load_dwordx4 a[116:119], v1, s[4:7], s18 offen offset:1024 sc1
    buffer_load_dwordx4 a[120:123], v1, s[4:7], s18 offen offset:2048 sc1
    buffer_load_dwordx4 a[124:127], v1, s[4:7], s18 offen offset:3072 sc1
    s_add_u32 s18, s18, 4096
    buffer_load_dwordx4 a[128:131], v1, s[4:7], s18 offen offset:0 sc1
    buffer_load_dwordx4 a[132:135], v1, s[4:7], s18 offen offset:1024 sc1
    buffer_load_dwordx4 a[136:139], v1, s[4:7], s18 offen offset:2048 sc1
    buffer_load_dwordx4 a[140:143], v1, s[4:7], s18 offen offset:3072 sc1
    s_add_u32 s18, s18, 4096
    buffer_load_dwordx4 a[144:147], v1, s[4:7], s18 offen offset:0 sc1
    buffer_load_dwordx4 a[148:151], v1, s[4:7], s18 offen offset:1024 sc1
    buffer_load_dwordx4 a[152:155], v1, s[4:7], s18 offen offset:2048 sc1
    buffer_load_dwordx4 a[156:159], v1, s[4:7], s18 offen offset:3072 sc1
    s_add_u32 s18, s18, 4096
    buffer_load_dwordx4 a[160:163], v1, s[4:7], s18 offen offset:0 sc1
    s_waitcnt vmcnt(20)
    buffer_load_dwordx4 a[164:167], v1, s[4:7], s18 offen offset:1024 sc1
    buffer_load_dwordx4 a[168:171], v1, s[4:7], s18 offen offset:2048 sc1
    buffer_load_dwordx4 a[172:175], v1, s[4:7], s18 offen offset:3072 sc1
    s_add_u32 s18, s18, 4096
    buffer_load_dwordx4 a[176:179], v1, s[4:7], s18 offen offset:0 sc1
    buffer_load_dwordx4 a[180:183], v1, s[4:7], s18 offen offset:1024 sc1
    buffer_load_dwordx4 a[184:187], v1, s[4:7], s18 offen offset:2048 sc1
    buffer_load_dwordx4 a[188:191], v1, s[4:7], s18 offen offset:3072 sc1
    s_add_u32 s18, s18, 4096
    buffer_load_dwordx4 a[192:195], v1, s[4:7], s18 offen offset:0 sc1
    buffer_load_dwordx4 a[196:199], v1, s[4:7], s18 offen offset:1024 sc1
    buffer_load_dwordx4 a[200:203], v1, s[4:7], s18 offen offset:2048 sc1
    buffer_load_dwordx4 a[204:207], v1, s[4:7], s18 offen offset:3072 sc1
    s_add_u32 s18, s18, 4096
    buffer_load_dwordx4 a[208:211], v1, s[4:7], s18 offen offset:0 sc1
    buffer_load_dwordx4 a[212:215], v1, s[4:7], s18 offen offset:1024 sc1
    buffer_load_dwordx4 a[216:219], v1, s[4:7], s18 offen offset:2048 sc1
    buffer_load_dwordx4 a[220:223], v1, s[4:7], s18 offen offset:3072 sc1
    s_add_u32 s18, s18, 4096
    buffer_load_dwordx4 a[224:227], v1, s[4:7], s18 offen offset:0 sc1
    buffer_load_dwordx4 a[228:231], v1, s[4:7], s18 offen offset:1024 sc1
    buffer_load_dwordx4 a[232:235], v1, s[4:7], s18 offen offset:2048 sc1
    buffer_load_dwordx4 a[236:239], v1, s[4:7], s18 offen offset:3072 sc1
    s_add_u32 s18, s18, 4096
    buffer_load_dwordx4 a[240:243], v1, s[4:7], s18 offen offset:0 sc1
    buffer_load_dwordx4 a[244:247], v1, s[4:7], s18 offen offset:1024 sc1
    buffer_load_dwordx4 a[248:251], v1, s[4:7], s18 offen offset:2048 sc1
    buffer_load_dwordx4 a[252:255], v1, s[4:7], s18 offen offset:3072 sc1
    s_waitcnt vmcnt(0)
    s_mov_b32 s44, 0
    s_mov_b32 s37, s35
    v_mov_b32 v250, 1
    v_mov_b32 v251, 163832
    v_cmp_eq_u32 vcc, 0, v0
    s_nop 0
    s_and_saveexec_b64 s[38:39], vcc
    s_cbranch_execz tk19
    buffer_atomic_add v250, off, s[84:87], s37 sc0
    s_waitcnt vmcnt(0)
    ds_write_b32 v251, v250
    s_waitcnt lgkmcnt(0)
tk19:
    s_mov_b64 exec, -1
    s_barrier
    ds_read_b32 v252, v251
    s_waitcnt lgkmcnt(0)
    v_readfirstlane_b32 s16, v252
    s_barrier
    s_nop 3
    s_cmp_ge_u32 s16, 72
    s_cbranch_scc1 L_op_nextcb
L_op_seg:
    s_min_u32 s43, s16, 56
    s_add_u32 s16, s16, s43
    s_lshr_b32 s43, s16, 1
    s_add_u32 s43, s43, 2
    s_min_u32 s43, s43, 63
    s_lshl_b32 s94, s33, 7
    s_add_u32 s94, s94, s16
    s_mov_b32 s88, 65536
    s_mov_b32 s89, 125853696
cw20:
    buffer_load_dword v3, off, s[4:7], s89 sc1
    s_waitcnt vmcnt(0)
    v_readfirstlane_b32 s42, v3
    s_nop 0
    s_sub_u32 s42, s42, s95
    s_cmp_gt_u32 s42, 64
    s_cselect_b32 s42, 0, s42
    s_add_u32 s42, s42, 1
    s_cmp_ge_u32 s42, s43
    s_cbranch_scc1 cw20x
    s_sub_u32 s88, s88, 1
    s_cbranch_scc1 cw20x
    s_sub_u32 s42, s43, s42
    s_min_u32 s42, s42, 6
cw20s:
    s_sleep 24
    s_sub_u32 s42, s42, 1
    s_cmp_lg_u32 s42, 0
    s_cbranch_scc1 cw20s
    s_branch cw20
cw20x:
    s_lshr_b32 s89, s16, 1
    s_lshl_b32 s89, s89, 2
    s_add_u32 s89, s89, s32
    s_lshl_b32 s89, s89, 7
    s_add_u32 s89, s89, 125894656
    v_mbcnt_lo_u32_b32 v2, -1, 0
    v_mbcnt_hi_u32_b32 v2, -1, v2
    v_min_u32 v2, 1, v2
    v_lshlrev_b32 v2, 2, v2
    s_mov_b32 s88, 4194304
fw21:
    buffer_load_dword v3, v2, s[4:7], s89 offen offset:0 sc1
    s_sub_u32 s88, s88, 1
    s_cbranch_scc1 fw21x
    s_waitcnt vmcnt(0)
    v_cmp_ne_u32 vcc, s95, v3
    s_cbranch_vccz fw21x
    s_sleep 2
    s_branch fw21
fw21x:
    v_mov_b32 v250, 1
    v_lshrrev_b32 v252, 2, v1
    v_min_u32 v252, 68, v252
    s_cmp_lg_u32 s32, 0
    s_cbranch_scc1 L_op_na
    s_mov_b64 exec, 1
    buffer_atomic_add v250, off, s[84:87], s35 sc0
    s_mov_b64 exec, -1
    s_cmp_lg_u32 s44, 0
    s_cbranch_scc1 L_op_na
    buffer_load_dword v253, v252, s[84:87], 0 offen offset:136 sc1
L_op_na:
    s_cmp_ge_u32 s16, 112
    s_cbranch_scc1 L_op_one
    s_lshl_b32 s18, s16, 17
    s_lshl_b32 s19, s32, 15
    s_add_u32 s18, s18, s19
    s_add_u32 s18, s18, 50331648
    buffer_load_dwordx4 v[24:27], v1, s[4:7], s18 offen offset:0 sc1
    buffer_load_dwordx4 v[28:31], v1, s[4:7], s18 offen offset:1024 sc1
    buffer_load_dwordx4 v[32:35], v1, s[4:7], s18 offen offset:2048 sc1
    buffer_load_dwordx4 v[36:39], v1, s[4:7], s18 offen offset:3072 sc1
    s_add_u32 s18, s18, 4096
    buffer_load_dwordx4 v[40:43], v1, s[4:7], s18 offen offset:0 sc1
    buffer_load_dwordx4 v[44:47], v1, s[4:7], s18 offen offset:1024 sc1
    buffer_load_dwordx4 v[48:51], v1, s[4:7], s18 offen offset:2048 sc1
    buffer_load_dwordx4 v[52:55], v1, s[4:7], s18 offen offset:3072 sc1
    s_add_u32 s18, s18, 4096
    buffer_load_dwordx4 v[56:59], v1, s[4:7], s18 offen offset:0 sc1
    buffer_load_dwordx4 v[60:63], v1, s[4:7], s18 offen offset:1024 sc1
    buffer_load_dwordx4 v[64:67], v1, s[4:7], s18 offen offset:2048 sc1
    buffer_load_dwordx4 v[68:71], v1, s[4:7], s18 offen offset:3072 sc1
    s_add_u32 s18, s18, 4096
    buffer_load_dwordx4 v[72:75], v1, s[4:7], s18 offen offset:0 sc1
    buffer_load_dwordx4 v[76:79], v1, s[4:7], s18 offen offset:1024 sc1
    buffer_load_dwordx4 v[80:83], v1, s[4:7], s18 offen offset:2048 sc1
    buffer_load_dwordx4 v[84:87], v1, s[4:7], s18 offen offset:3072 sc1
    s_add_u32 s18, s18, 4096
    buffer_load_dwordx4 v[88:91], v1, s[4:7], s18 offen offset:0 sc1
    buffer_load_dwordx4 v[92:95], v1, s[4:7], s18 offen offset:1024 sc1
    buffer_load_dwordx4 v[96:99], v1, s[4:7], s18 offen offset:2048 sc1
    buffer_load_dwordx4 v[100:103], v1, s[4:7], s18 offen offset:3072 sc1
    s_add_u32 s18, s18, 4096
    buffer_load_dwordx4 v[104:107], v1, s[4:7], s18 offen offset:0 sc1
    buffer_load_dwordx4 v[108:111], v1, s[4:7], s18 offen offset:1024 sc1
    buffer_load_dwordx4 v[112:115], v1, s[4:7], s18 offen offset:2048 sc1
    buffer_load_dwordx4 v[116:119], v1, s[4:7], s18 offen offset:3072 sc1
    s_add_u32 s18, s18, 4096
    buffer_load_dwordx4 v[120:123], v1, s[4:7], s18 offen offset:0 sc1
    buffer_load_dwordx4 v[124:127], v1, s[4:7], s18 offen offset:1024 sc1
    buffer_load_dwordx4 v[128:131], v1, s[4:7], s18 offen offset:2048 sc1
    buffer_load_dwordx4 v[132:135], v1, s[4:7], s18 offen offset:3072 sc1
    s_add_u32 s18, s18, 4096
    buffer_load_dwordx4 v[136:139], v1, s[4:7], s18 offen offset:0 sc1
    buffer_load_dwordx4 v[140:143], v1, s[4:7], s18 offen offset:1024 sc1
    buffer_load_dwordx4 v[144:147], v1, s[4:7], s18 offen offset:2048 sc1
    buffer_load_dwordx4 v[148:151], v1, s[4:7], s18 offen offset:3072 sc1
    s_add_u32 s18, s18, 102400
    buffer_load_dwordx4 v[152:155], v1, s[4:7], s18 offen offset:0 sc1
    buffer_load_dwordx4 v[156:159], v1, s[4:7], s18 offen offset:1024 sc1
    buffer_load_dwordx4 v[160:163], v1, s[4:7], s18 offen offset:2048 sc1
    buffer_load_dwordx4 v[164:167], v1, s[4:7], s18 offen offset:3072 sc1
    s_add_u32 s18, s18, 4096
    buffer_load_dwordx4 v[168:171], v1, s[4:7], s18 offen offset:0 sc1
    buffer_load_dwordx4 v[172:175], v1, s[4:7], s18 offen offset:1024 sc1
    buffer_load_dwordx4 v[176:179], v1, s[4:7], s18 offen offset:2048 sc1
    buffer_load_dwordx4 v[180:183], v1, s[4:7], s18 offen offset:3072 sc1
    s_add_u32 s18, s18, 4096
    buffer_load_dwordx4 v[184:187], v1, s[4:7], s18 offen offset:0 sc1
    buffer_load_dwordx4 v[188:191], v1, s[4:7], s18 offen offset:1024 sc1
    buffer_load_dwordx4 v[192:195], v1, s[4:7], s18 offen offset:2048 sc1
    buffer_load_dwordx4 v[196:199], v1, s[4:7], s18 offen offset:3072 sc1
    s_add_u32 s18, s18, 4096
    buffer_load_dwordx4 v[200:203], v1, s[4:7], s18 offen offset:0 sc1
    buffer_load_dwordx4 v[204:207], v1, s[4:7], s18 offen offset:1024 sc1
    buffer_load_dwordx4 v[208:211], v1, s[4:7], s18 offen offset:2048 sc1
    buffer_load_dwordx4 v[212:215], v1, s[4:7], s18 offen offset:3072 sc1
    s_add_u32 s18, s18, 4096
    buffer_load_dwordx4 v[216:219], v1, s[4:7], s18 offen offset:0 sc1
    buffer_load_dwordx4 v[220:223], v1, s[4:7], s18 offen offset:1024 sc1
    buffer_load_dwordx4 v[224:227], v1, s[4:7], s18 offen offset:2048 sc1
    buffer_load_dwordx4 v[228:231], v1, s[4:7], s18 offen offset:3072 sc1
    s_add_u32 s18, s18, 4096
    buffer_load_dwordx4 v[232:235], v1, s[4:7], s18 offen offset:0 sc1
    buffer_load_dwordx4 v[236:239], v1, s[4:7], s18 offen offset:1024 sc1
    buffer_load_dwordx4 v[240:243], v1, s[4:7], s18 offen offset:2048 sc1
    buffer_load_dwordx4 v[244:247], v1, s[4:7], s18 offen offset:3072 sc1
    v_lshlrev_b32 v2, 4, v0
    v_and_b32 v3, 3072, v2
    v_lshl_add_u32 v2, v3, 1, v1
    s_waitcnt vmcnt(55)
    v_mfma_f32_16x16x32_bf16 v[8:11], a[0:3], v[24:27], 0
    v_mfma_f32_16x16x32_bf16 v[12:15], a[4:7], v[24:27], 0
    s_add_u32 s18, s18, 4096
    buffer_load_dwordx4 v[24:27], v1, s[4:7], s18 offen offset:0 sc1
    s_waitcnt vmcnt(55)
    v_mfma_f32_16x16x32_bf16 v[8:11], a[8:11], v[28:31], v[8:11]
    v_mfma_f32_16x16x32_bf16 v[12:15], a[12:15], v[28:31], v[12:15]
    buffer_load_dwordx4 v[28:31], v1, s[4:7], s18 offen offset:1024 sc1
    s_waitcnt vmcnt(55)
    v_mfma_f32_16x16x32_bf16 v[8:11], a[16:19], v[32:35], v[8:11]
    v_mfma_f32_16x16x32_bf16 v[12:15], a[20:23], v[32:35], v[12:15]
    buffer_load_dwordx4 v[32:35], v1, s[4:7], s18 offen offset:2048 sc1
    s_waitcnt vmcnt(55)
    v_mfma_f32_16x16x32_bf16 v[8:11], a[24:27], v[36:39], v[8:11]
    v_mfma_f32_16x16x32_bf16 v[12:15], a[28:31], v[36:39], v[12:15]
    buffer_load_dwordx4 v[36:39], v1, s[4:7], s18 offen offset:3072 sc1
    s_waitcnt vmcnt(55)
    v_mfma_f32_16x16x32_bf16 v[8:11], a[32:35], v[40:43], v[8:11]
    v_mfma_f32_16x16x32_bf16 v[12:15], a[36:39], v[40:43], v[12:15]
    s_add_u32 s18, s18, 4096
    buffer_load_dwordx4 v[40:43], v1, s[4:7], s18 offen offset:0 sc1
    s_waitcnt vmcnt(55)
    v_mfma_f32_16x16x32_bf16 v[8:11], a[40:43], v[44:47], v[8:11]
    v_mfma_f32_16x16x32_bf16 v[12:15], a[44:47], v[44:47], v[12:15]
    buffer_load_dwordx4 v[44:47], v1, s[4:7], s18 offen offset:1024 sc1
    s_waitcnt vmcnt(55)
    v_mfma_f32_16x16x32_bf16 v[8:11], a[48:51], v[48:51], v[8:11]
    v_mfma_f32_16x16x32_bf16 v[12:15], a[52:55], v[48:51], v[12:15]
    buffer_load_dwordx4 v[48:51], v1, s[4:7], s18 offen offset:2048 sc1
    s_waitcnt vmcnt(55)
    v_mfma_f32_16x16x32_bf16 v[8:11], a[56:59], v[52:55], v[8:11]
    v_mfma_f32_16x16x32_bf16 v[12:15], a[60:63], v[52:55], v[12:15]
    buffer_load_dwordx4 v[52:55], v1, s[4:7], s18 offen offset:3072 sc1
    s_waitcnt vmcnt(55)
    v_mfma_f32_16x16x32_bf16 v[8:11], a[64:67], v[56:59], v[8:11]
    v_mfma_f32_16x16x32_bf16 v[12:15], a[68:71], v[56:59], v[12:15]
    s_waitcnt vmcnt(54)
    v_mfma_f32_16x16x32_bf16 v[8:11], a[72:75], v[60:63], v[8:11]
    v_mfma_f32_16x16x32_bf16 v[12:15], a[76:79], v[60:63], v[12:15]
    s_waitcnt vmcnt(53)
    v_mfma_f32_16x16x32_bf16 v[8:11], a[80:83], v[64:67], v[8:11]
    v_mfma_f32_16x16x32_bf16 v[12:15], a[84:87], v[64:67], v[12:15]
    s_waitcnt vmcnt(52)
    v_mfma_f32_16x16x32_bf16 v[8:11], a[88:91], v[68:71], v[8:11]
    v_mfma_f32_16x16x32_bf16 v[12:15], a[92:95], v[68:71], v[12:15]
    s_waitcnt vmcnt(51)
    v_mfma_f32_16x16x32_bf16 v[8:11], a[96:99], v[72:75], v[8:11]
    v_mfma_f32_16x16x32_bf16 v[12:15], a[100:103], v[72:75], v[12:15]
    s_waitcnt vmcnt(50)
    v_mfma_f32_16x16x32_bf16 v[8:11], a[104:107], v[76:79], v[8:11]
    v_mfma_f32_16x16x32_bf16 v[12:15], a[108:111], v[76:79], v[12:15]
    s_waitcnt vmcnt(49)
    v_mfma_f32_16x16x32_bf16 v[8:11], a[112:115], v[80:83], v[8:11]
    v_mfma_f32_16x16x32_bf16 v[12:15], a[116:119], v[80:83], v[12:15]
    s_waitcnt vmcnt(48)
    v_mfma_f32_16x16x32_bf16 v[8:11], a[120:123], v[84:87], v[8:11]
    v_mfma_f32_16x16x32_bf16 v[12:15], a[124:127], v[84:87], v[12:15]
    s_waitcnt vmcnt(47)
    v_mfma_f32_16x16x32_bf16 v[8:11], a[128:131], v[88:91], v[8:11]
    v_mfma_f32_16x16x32_bf16 v[12:15], a[132:135], v[88:91], v[12:15]
    s_waitcnt vmcnt(46)
    v_mfma_f32_16x16x32_bf16 v[8:11], a[136:139], v[92:95], v[8:11]
    v_mfma_f32_16x16x32_bf16 v[12:15], a[140:143], v[92:95], v[12:15]
    s_waitcnt vmcnt(45)
    v_mfma_f32_16x16x32_bf16 v[8:11], a[144:147], v[96:99], v[8:11]
    v_mfma_f32_16x16x32_bf16 v[12:15], a[148:151], v[96:99], v[12:15]
    s_waitcnt vmcnt(44)
    v_mfma_f32_16x16x32_bf16 v[8:11], a[152:155], v[100:103], v[8:11]
    v_mfma_f32_16x16x32_bf16 v[12:15], a[156:159], v[100:103], v[12:15]
    s_waitcnt vmcnt(43)
    v_mfma_f32_16x16x32_bf16 v[8:11], a[160:163], v[104:107], v[8:11]
    v_mfma_f32_16x16x32_bf16 v[12:15], a[164:167], v[104:107], v[12:15]
    s_waitcnt vmcnt(42)
    v_mfma_f32_16x16x32_bf16 v[8:11], a[168:171], v[108:111], v[8:11]
    v_mfma_f32_16x16x32_bf16 v[12:15], a[172:175], v[108:111], v[12:15]
    s_waitcnt vmcnt(41)
    v_mfma_f32_16x16x32_bf16 v[8:11], a[176:179], v[112:115], v[8:11]
    v_mfma_f32_16x16x32_bf16 v[12:15], a[180:183], v[112:115], v[12:15]
    s_waitcnt vmcnt(40)
    v_mfma_f32_16x16x32_bf16 v[8:11], a[184:187], v[116:119], v[8:11]
    v_mfma_f32_16x16x32_bf16 v[12:15], a[188:191], v[116:119], v[12:15]
    s_waitcnt vmcnt(39)
    v_mfma_f32_16x16x32_bf16 v[8:11], a[192:195], v[120:123], v[8:11]
    v_mfma_f32_16x16x32_bf16 v[12:15], a[196:199], v[120:123], v[12:15]
    s_waitcnt vmcnt(38)
    v_mfma_f32_16x16x32_bf16 v[8:11], a[200:203], v[124:127], v[8:11]
    v_mfma_f32_16x16x32_bf16 v[12:15], a[204:207], v[124:127], v[12:15]
    s_waitcnt vmcnt(37)
    v_mfma_f32_16x16x32_bf16 v[8:11], a[208:211], v[128:131], v[8:11]
    v_mfma_f32_16x16x32_bf16 v[12:15], a[212:215], v[128:131], v[12:15]
    s_waitcnt vmcnt(36)
    v_mfma_f32_16x16x32_bf16 v[8:11], a[216:219], v[132:135], v[8:11]
    v_mfma_f32_16x16x32_bf16 v[12:15], a[220:223], v[132:135], v[12:15]
    s_waitcnt vmcnt(35)
    v_mfma_f32_16x16x32_bf16 v[8:11], a[224:227], v[136:139], v[8:11]
    v_mfma_f32_16x16x32_bf16 v[12:15], a[228:231], v[136:139], v[12:15]
    s_waitcnt vmcnt(34)
    v_mfma_f32_16x16x32_bf16 v[8:11], a[232:235], v[140:143], v[8:11]
    v_mfma_f32_16x16x32_bf16 v[12:15], a[236:239], v[140:143], v[12:15]
    s_waitcnt vmcnt(33)
    v_mfma_f32_16x16x32_bf16 v[8:11], a[240:243], v[144:147], v[8:11]
    v_mfma_f32_16x16x32_bf16 v[12:15], a[244:247], v[144:147], v[12:15]
    s_waitcnt vmcnt(32)
    v_mfma_f32_16x16x32_bf16 v[8:11], a[248:251], v[148:151], v[8:11]
    v_mfma_f32_16x16x32_bf16 v[12:15], a[252:255], v[148:151], v[12:15]
    s_waitcnt vmcnt(31)
    v_mfma_f32_16x16x32_bf16 v[16:19], a[0:3], v[152:155], 0
    v_mfma_f32_16x16x32_bf16 v[20:23], a[4:7], v[152:155], 0
    s_waitcnt vmcnt(30)
    v_mfma_f32_16x16x32_bf16 v[16:19], a[8:11], v[156:159], v[16:19]
    v_mfma_f32_16x16x32_bf16 v[20:23], a[12:15], v[156:159], v[20:23]
    s_waitcnt vmcnt(29)
    v_mfma_f32_16x16x32_bf16 v[16:19], a[16:19], v[160:163], v[16:19]
    v_mfma_f32_16x16x32_bf16 v[20:23], a[20:23], v[160:163], v[20:23]
    s_waitcnt vmcnt(28)
    v_mfma_f32_16x16x32_bf16 v[16:19], a[24:27], v[164:167], v[16:19]
    v_mfma_f32_16x16x32_bf16 v[20:23], a[28:31], v[164:167], v[20:23]
    s_waitcnt vmcnt(27)
    v_mfma_f32_16x16x32_bf16 v[16:19], a[32:35], v[168:171], v[16:19]
    v_mfma_f32_16x16x32_bf16 v[20:23], a[36:39], v[168:171], v[20:23]
    s_waitcnt vmcnt(26)
    v_mfma_f32_16x16x32_bf16 v[16:19], a[40:43], v[172:175], v[16:19]
    v_mfma_f32_16x16x32_bf16 v[20:23], a[44:47], v[172:175], v[20:23]
    s_waitcnt vmcnt(25)
    v_mfma_f32_16x16x32_bf16 v[16:19], a[48:51], v[176:179], v[16:19]
    v_mfma_f32_16x16x32_bf16 v[20:23], a[52:55], v[176:179], v[20:23]
    s_waitcnt vmcnt(24)
    v_mfma_f32_16x16x32_bf16 v[16:19], a[56:59], v[180:183], v[16:19]
    v_mfma_f32_16x16x32_bf16 v[20:23], a[60:63], v[180:183], v[20:23]
    s_waitcnt vmcnt(23)
    v_mfma_f32_16x16x32_bf16 v[16:19], a[64:67], v[184:187], v[16:19]
    v_mfma_f32_16x16x32_bf16 v[20:23], a[68:71], v[184:187], v[20:23]
    s_waitcnt vmcnt(22)
    v_mfma_f32_16x16x32_bf16 v[16:19], a[72:75], v[188:191], v[16:19]
    v_mfma_f32_16x16x32_bf16 v[20:23], a[76:79], v[188:191], v[20:23]
    s_waitcnt vmcnt(21)
    v_mfma_f32_16x16x32_bf16 v[16:19], a[80:83], v[192:195], v[16:19]
    v_mfma_f32_16x16x32_bf16 v[20:23], a[84:87], v[192:195], v[20:23]
    s_waitcnt vmcnt(20)
    v_mfma_f32_16x16x32_bf16 v[16:19], a[88:91], v[196:199], v[16:19]
    v_mfma_f32_16x16x32_bf16 v[20:23], a[92:95], v[196:199], v[20:23]
    s_waitcnt vmcnt(19)
    v_mfma_f32_16x16x32_bf16 v[16:19], a[96:99], v[200:203], v[16:19]
    v_mfma_f32_16x16x32_bf16 v[20:23], a[100:103], v[200:203], v[20:23]
    s_waitcnt vmcnt(18)
    v_mfma_f32_16x16x32_bf16 v[16:19], a[104:107], v[204:207], v[16:19]
    v_mfma_f32_16x16x32_bf16 v[20:23], a[108:111], v[204:207], v[20:23]
    s_waitcnt vmcnt(17)
    v_mfma_f32_16x16x32_bf16 v[16:19], a[112:115], v[208:211], v[16:19]
    v_mfma_f32_16x16x32_bf16 v[20:23], a[116:119], v[208:211], v[20:23]
    s_waitcnt vmcnt(16)
    v_mfma_f32_16x16x32_bf16 v[16:19], a[120:123], v[212:215], v[16:19]
    v_mfma_f32_16x16x32_bf16 v[20:23], a[124:127], v[212:215], v[20:23]
    s_waitcnt vmcnt(15)
    v_mfma_f32_16x16x32_bf16 v[16:19], a[128:131], v[216:219], v[16:19]
    v_mfma_f32_16x16x32_bf16 v[20:23], a[132:135], v[216:219], v[20:23]
    s_waitcnt vmcnt(14)
    v_mfma_f32_16x16x32_bf16 v[16:19], a[136:139], v[220:223], v[16:19]
    v_mfma_f32_16x16x32_bf16 v[20:23], a[140:143], v[220:223], v[20:23]
    s_waitcnt vmcnt(13)
    v_mfma_f32_16x16x32_bf16 v[16:19], a[144:147], v[224:227], v[16:19]
    v_mfma_f32_16x16x32_bf16 v[20:23], a[148:151], v[224:227], v[20:23]
    s_waitcnt vmcnt(12)
    v_mfma_f32_16x16x32_bf16 v[16:19], a[152:155], v[228:231], v[16:19]
    v_mfma_f32_16x16x32_bf16 v[20:23], a[156:159], v[228:231], v[20:23]
    s_waitcnt vmcnt(11)
    v_mfma_f32_16x16x32_bf16 v[16:19], a[160:163], v[232:235], v[16:19]
    v_mfma_f32_16x16x32_bf16 v[20:23], a[164:167], v[232:235], v[20:23]
    s_waitcnt vmcnt(10)
    v_mfma_f32_16x16x32_bf16 v[16:19], a[168:171], v[236:239], v[16:19]
    v_mfma_f32_16x16x32_bf16 v[20:23], a[172:175], v[236:239], v[20:23]
    s_waitcnt vmcnt(9)
    v_mfma_f32_16x16x32_bf16 v[16:19], a[176:179], v[240:243], v[16:19]
    v_mfma_f32_16x16x32_bf16 v[20:23], a[180:183], v[240:243], v[20:23]
    s_waitcnt vmcnt(8)
    v_mfma_f32_16x16x32_bf16 v[16:19], a[184:187], v[244:247], v[16:19]
    v_mfma_f32_16x16x32_bf16 v[20:23], a[188:191], v[244:247], v[20:23]
    s_waitcnt vmcnt(7)
    v_mfma_f32_16x16x32_bf16 v[16:19], a[192:195], v[24:27], v[16:19]
    v_mfma_f32_16x16x32_bf16 v[20:23], a[196:199], v[24:27], v[20:23]
    s_waitcnt vmcnt(6)
    v_mfma_f32_16x16x32_bf16 v[16:19], a[200:203], v[28:31], v[16:19]
    v_mfma_f32_16x16x32_bf16 v[20:23], a[204:207], v[28:31], v[20:23]
    s_waitcnt vmcnt(5)
    v_mfma_f32_16x16x32_bf16 v[16:19], a[208:211], v[32:35], v[16:19]
    v_mfma_f32_16x16x32_bf16 v[20:23], a[212:215], v[32:35], v[20:23]
    s_waitcnt vmcnt(4)
    v_mfma_f32_16x16x32_bf16 v[16:19], a[216:219], v[36:39], v[16:19]
    v_mfma_f32_16x16x32_bf16 v[20:23], a[220:223], v[36:39], v[20:23]
    s_waitcnt vmcnt(3)
    v_mfma_f32_16x16x32_bf16 v[16:19], a[224:227], v[40:43], v[16:19]
    v_mfma_f32_16x16x32_bf16 v[20:23], a[228:231], v[40:43], v[20:23]
    s_waitcnt vmcnt(2)
    v_mfma_f32_16x16x32_bf16 v[16:19], a[232:235], v[44:47], v[16:19]
    v_mfma_f32_16x16x32_bf16 v[20:23], a[236:239], v[44:47], v[20:23]
    s_waitcnt vmcnt(1)
    v_mfma_f32_16x16x32_bf16 v[16:19], a[240:243], v[48:51], v[16:19]
    v_mfma_f32_16x16x32_bf16 v[20:23], a[244:247], v[48:51], v[20:23]
    s_waitcnt vmcnt(0)
    v_mfma_f32_16x16x32_bf16 v[16:19], a[248:251], v[52:55], v[16:19]
    v_mfma_f32_16x16x32_bf16 v[20:23], a[252:255], v[52:55], v[20:23]
    ds_write_b128 v2, v[8:11] offset:0
    ds_write_b128 v2, v[12:15] offset:1024
    s_nop 4
    ds_write_b128 v2, v[16:19] offset:8192
    ds_write_b128 v2, v[20:23] offset:9216
    s_cmp_lg_u32 s32, 0
    s_cbranch_scc1 o2_nb
    v_cmp_eq_u32 vcc, 0, v253
    s_nop 0
    s_cmp_eq_u64 vcc, 0
    s_cselect_b32 s44, 65536, 0
    v_or_b32 v250, s44, v250
    v_mov_b32 v251, 163832
    s_mov_b64 exec, 1
    ds_write_b32 v251, v250
    s_mov_b64 exec, -1
o2_nb:
    s_waitcnt lgkmcnt(0)
    s_barrier
    s_cmp_gt_u32 s32, 1
    s_cbranch_scc1 o2_skip
    s_lshl_b32 s18, s32, 13
    v_add_u32 v2, s18, v1
    ds_read_b128 v[24:27], v2 offset:0
    ds_read_b128 v[28:31], v2 offset:1024
    ds_read_b128 v[32:35], v2 offset:2048
    ds_read_b128 v[36:39], v2 offset:3072
    ds_read_b128 v[40:43], v2 offset:4096
    ds_read_b128 v[44:47], v2 offset:5120
    ds_read_b128 v[48:51], v2 offset:6144
    ds_read_b128 v[52:55], v2 offset:7168
    v_lshrrev_b32 v3, 4, v1
    v_bfe_u32 v4, v3, 2, 2
    v_lshlrev_b32 v4, 3, v4
    v_and_b32 v2, 3, v3
    v_add_u32 v4, v4, v2
    v_mul_u32_u24 v4, 2304, v4
    v_lshrrev_b32 v3, 4, v3
    v_lshl_add_u32 v4, v3, 4, v4
    s_add_u32 s20, s16, s32
    s_lshr_b32 s18, s20, 1
    s_lshl_b32 s18, s18, 3
    s_and_b32 s19, s20, 1
    s_add_u32 s18, s18, s19
    s_mul_i32 s18, s18, 9216
    s_lshl_b32 s19, s33, 6
    s_add_u32 s18, s18, s19
    s_waitcnt lgkmcnt(0)
    v_pk_add_f32 v[24:25], v[24:25], v[32:33]
    v_pk_add_f32 v[40:41], v[40:41], v[48:49]
    v_pk_add_f32 v[24:25], v[24:25], v[40:41]
    v_pk_add_f32 v[26:27], v[26:27], v[34:35]
    v_pk_add_f32 v[42:43], v[42:43], v[50:51]
    v_pk_add_f32 v[26:27], v[26:27], v[42:43]
    v_pk_add_f32 v[28:29], v[28:29], v[36:37]
    v_pk_add_f32 v[44:45], v[44:45], v[52:53]
    v_pk_add_f32 v[28:29], v[28:29], v[44:45]
    v_pk_add_f32 v[30:31], v[30:31], v[38:39]
    v_pk_add_f32 v[46:47], v[46:47], v[54:55]
    v_pk_add_f32 v[30:31], v[30:31], v[46:47]
    v_cvt_pk_bf16_f32 v8, v24, v28
    v_cvt_pk_bf16_f32 v9, v25, v29
    v_cvt_pk_bf16_f32 v10, v26, v30
    v_cvt_pk_bf16_f32 v11, v27, v31
    buffer_store_dwordx4 v[8:11], v4, s[8:11], s18 offen
o2_skip:
    s_nop 1
    s_branch L_op_fin
L_op_one:
    s_lshl_b32 s18, s16, 17
    s_lshl_b32 s19, s32, 15
    s_add_u32 s18, s18, s19
    s_add_u32 s18, s18, 50331648
    buffer_load_dwordx4 v[24:27], v1, s[4:7], s18 offen offset:0 sc1
    buffer_load_dwordx4 v[28:31], v1, s[4:7], s18 offen offset:1024 sc1
    buffer_load_dwordx4 v[32:35], v1, s[4:7], s18 offen offset:2048 sc1
    buffer_load_dwordx4 v[36:39], v1, s[4:7], s18 offen offset:3072 sc1
    s_add_u32 s18, s18, 4096
    buffer_load_dwordx4 v[40:43], v1, s[4:7], s18 offen offset:0 sc1
    buffer_load_dwordx4 v[44:47], v1, s[4:7], s18 offen offset:1024 sc1
    buffer_load_dwordx4 v[48:51], v1, s[4:7], s18 offen offset:2048 sc1
    buffer_load_dwordx4 v[52:55], v1, s[4:7], s18 offen offset:3072 sc1
    s_add_u32 s18, s18, 4096
    buffer_load_dwordx4 v[56:59], v1, s[4:7], s18 offen offset:0 sc1
    buffer_load_dwordx4 v[60:63], v1, s[4:7], s18 offen offset:1024 sc1
    buffer_load_dwordx4 v[64:67], v1, s[4:7], s18 offen offset:2048 sc1
    buffer_load_dwordx4 v[68:71], v1, s[4:7], s18 offen offset:3072 sc1
    s_add_u32 s18, s18, 4096
    buffer_load_dwordx4 v[72:75], v1, s[4:7], s18 offen offset:0 sc1
    buffer_load_dwordx4 v[76:79], v1, s[4:7], s18 offen offset:1024 sc1
    buffer_load_dwordx4 v[80:83], v1, s[4:7], s18 offen offset:2048 sc1
    buffer_load_dwordx4 v[84:87], v1, s[4:7], s18 offen offset:3072 sc1
    s_add_u32 s18, s18, 4096
    buffer_load_dwordx4 v[88:91], v1, s[4:7], s18 offen offset:0 sc1
    buffer_load_dwordx4 v[92:95], v1, s[4:7], s18 offen offset:1024 sc1
    buffer_load_dwordx4 v[96:99], v1, s[4:7], s18 offen offset:2048 sc1
    buffer_load_dwordx4 v[100:103], v1, s[4:7], s18 offen offset:3072 sc1
    s_add_u32 s18, s18, 4096
    buffer_load_dwordx4 v[104:107], v1, s[4:7], s18 offen offset:0 sc1
    buffer_load_dwordx4 v[108:111], v1, s[4:7], s18 offen offset:1024 sc1
    buffer_load_dwordx4 v[112:115], v1, s[4:7], s18 offen offset:2048 sc1
    buffer_load_dwordx4 v[116:119], v1, s[4:7], s18 offen offset:3072 sc1
    s_add_u32 s18, s18, 4096
    buffer_load_dwordx4 v[120:123], v1, s[4:7], s18 offen offset:0 sc1
    buffer_load_dwordx4 v[124:127], v1, s[4:7], s18 offen offset:1024 sc1
    buffer_load_dwordx4 v[128:131], v1, s[4:7], s18 offen offset:2048 sc1
    buffer_load_dwordx4 v[132:135], v1, s[4:7], s18 offen offset:3072 sc1
    s_add_u32 s18, s18, 4096
    buffer_load_dwordx4 v[136:139], v1, s[4:7], s18 offen offset:0 sc1
    buffer_load_dwordx4 v[140:143], v1, s[4:7], s18 offen offset:1024 sc1
    buffer_load_dwordx4 v[144:147], v1, s[4:7], s18 offen offset:2048 sc1
    buffer_load_dwordx4 v[148:151], v1, s[4:7], s18 offen offset:3072 sc1
    v_lshlrev_b32 v2, 4, v0
    v_and_b32 v3, 3072, v2
    v_lshl_add_u32 v2, v3, 1, v1
    s_waitcnt vmcnt(31)
    v_mfma_f32_16x16x32_bf16 v[8:11], a[0:3], v[24:27], 0
    v_mfma_f32_16x16x32_bf16 v[12:15], a[4:7], v[24:27], 0
    s_waitcnt vmcnt(30)
    v_mfma_f32_16x16x32_bf16 v[8:11], a[8:11], v[28:31], v[8:11]
    v_mfma_f32_16x16x32_bf16 v[12:15], a[12:15], v[28:31], v[12:15]
    s_waitcnt vmcnt(29)
    v_mfma_f32_16x16x32_bf16 v[8:11], a[16:19], v[32:35], v[8:11]
    v_mfma_f32_16x16x32_bf16 v[12:15], a[20:23], v[32:35], v[12:15]
    s_waitcnt vmcnt(28)
    v_mfma_f32_16x16x32_bf16 v[8:11], a[24:27], v[36:39], v[8:11]
    v_mfma_f32_16x16x32_bf16 v[12:15], a[28:31], v[36:39], v[12:15]
    s_waitcnt vmcnt(27)
    v_mfma_f32_16x16x32_bf16 v[8:11], a[32:35], v[40:43], v[8:11]
    v_mfma_f32_16x16x32_bf16 v[12:15], a[36:39], v[40:43], v[12:15]
    s_waitcnt vmcnt(26)
    v_mfma_f32_16x16x32_bf16 v[8:11], a[40:43], v[44:47], v[8:11]
    v_mfma_f32_16x16x32_bf16 v[12:15], a[44:47], v[44:47], v[12:15]
    s_waitcnt vmcnt(25)
    v_mfma_f32_16x16x32_bf16 v[8:11], a[48:51], v[48:51], v[8:11]
    v_mfma_f32_16x16x32_bf16 v[12:15], a[52:55], v[48:51], v[12:15]
    s_waitcnt vmcnt(24)
    v_mfma_f32_16x16x32_bf16 v[8:11], a[56:59], v[52:55], v[8:11]
    v_mfma_f32_16x16x32_bf16 v[12:15], a[60:63], v[52:55], v[12:15]
    s_waitcnt vmcnt(23)
    v_mfma_f32_16x16x32_bf16 v[8:11], a[64:67], v[56:59], v[8:11]
    v_mfma_f32_16x16x32_bf16 v[12:15], a[68:71], v[56:59], v[12:15]
    s_waitcnt vmcnt(22)
    v_mfma_f32_16x16x32_bf16 v[8:11], a[72:75], v[60:63], v[8:11]
    v_mfma_f32_16x16x32_bf16 v[12:15], a[76:79], v[60:63], v[12:15]
    s_waitcnt vmcnt(21)
    v_mfma_f32_16x16x32_bf16 v[8:11], a[80:83], v[64:67], v[8:11]
    v_mfma_f32_16x16x32_bf16 v[12:15], a[84:87], v[64:67], v[12:15]
    s_waitcnt vmcnt(20)
    v_mfma_f32_16x16x32_bf16 v[8:11], a[88:91], v[68:71], v[8:11]
    v_mfma_f32_16x16x32_bf16 v[12:15], a[92:95], v[68:71], v[12:15]
    s_waitcnt vmcnt(19)
    v_mfma_f32_16x16x32_bf16 v[8:11], a[96:99], v[72:75], v[8:11]
    v_mfma_f32_16x16x32_bf16 v[12:15], a[100:103], v[72:75], v[12:15]
    s_waitcnt vmcnt(18)
    v_mfma_f32_16x16x32_bf16 v[8:11], a[104:107], v[76:79], v[8:11]
    v_mfma_f32_16x16x32_bf16 v[12:15], a[108:111], v[76:79], v[12:15]
    s_waitcnt vmcnt(17)
    v_mfma_f32_16x16x32_bf16 v[8:11], a[112:115], v[80:83], v[8:11]
    v_mfma_f32_16x16x32_bf16 v[12:15], a[116:119], v[80:83], v[12:15]
    s_waitcnt vmcnt(16)
    v_mfma_f32_16x16x32_bf16 v[8:11], a[120:123], v[84:87], v[8:11]
    v_mfma_f32_16x16x32_bf16 v[12:15], a[124:127], v[84:87], v[12:15]
    s_waitcnt vmcnt(15)
    v_mfma_f32_16x16x32_bf16 v[8:11], a[128:131], v[88:91], v[8:11]
    v_mfma_f32_16x16x32_bf16 v[12:15], a[132:135], v[88:91], v[12:15]
    s_waitcnt vmcnt(14)
    v_mfma_f32_16x16x32_bf16 v[8:11], a[136:139], v[92:95], v[8:11]
    v_mfma_f32_16x16x32_bf16 v[12:15], a[140:143], v[92:95], v[12:15]
    s_waitcnt vmcnt(13)
    v_mfma_f32_16x16x32_bf16 v[8:11], a[144:147], v[96:99], v[8:11]
    v_mfma_f32_16x16x32_bf16 v[12:15], a[148:151], v[96:99], v[12:15]
    s_waitcnt vmcnt(12)
    v_mfma_f32_16x16x32_bf16 v[8:11], a[152:155], v[100:103], v[8:11]
    v_mfma_f32_16x16x32_bf16 v[12:15], a[156:159], v[100:103], v[12:15]
    s_waitcnt vmcnt(11)
    v_mfma_f32_16x16x32_bf16 v[8:11], a[160:163], v[104:107], v[8:11]
    v_mfma_f32_16x16x32_bf16 v[12:15], a[164:167], v[104:107], v[12:15]
    s_waitcnt vmcnt(10)
    v_mfma_f32_16x16x32_bf16 v[8:11], a[168:171], v[108:111], v[8:11]
    v_mfma_f32_16x16x32_bf16 v[12:15], a[172:175], v[108:111], v[12:15]
    s_waitcnt vmcnt(9)
    v_mfma_f32_16x16x32_bf16 v[8:11], a[176:179], v[112:115], v[8:11]
    v_mfma_f32_16x16x32_bf16 v[12:15], a[180:183], v[112:115], v[12:15]
    s_waitcnt vmcnt(8)
    v_mfma_f32_16x16x32_bf16 v[8:11], a[184:187], v[116:119], v[8:11]
    v_mfma_f32_16x16x32_bf16 v[12:15], a[188:191], v[116:119], v[12:15]
    s_waitcnt vmcnt(7)
    v_mfma_f32_16x16x32_bf16 v[8:11], a[192:195], v[120:123], v[8:11]
    v_mfma_f32_16x16x32_bf16 v[12:15], a[196:199], v[120:123], v[12:15]
    s_waitcnt vmcnt(6)
    v_mfma_f32_16x16x32_bf16 v[8:11], a[200:203], v[124:127], v[8:11]
    v_mfma_f32_16x16x32_bf16 v[12:15], a[204:207], v[124:127], v[12:15]
    s_waitcnt vmcnt(5)
    v_mfma_f32_16x16x32_bf16 v[8:11], a[208:211], v[128:131], v[8:11]
    v_mfma_f32_16x16x32_bf16 v[12:15], a[212:215], v[128:131], v[12:15]
    s_waitcnt vmcnt(4)
    v_mfma_f32_16x16x32_bf16 v[8:11], a[216:219], v[132:135], v[8:11]
    v_mfma_f32_16x16x32_bf16 v[12:15], a[220:223], v[132:135], v[12:15]
    s_waitcnt vmcnt(3)
    v_mfma_f32_16x16x32_bf16 v[8:11], a[224:227], v[136:139], v[8:11]
    v_mfma_f32_16x16x32_bf16 v[12:15], a[228:231], v[136:139], v[12:15]
    s_waitcnt vmcnt(2)
    v_mfma_f32_16x16x32_bf16 v[8:11], a[232:235], v[140:143], v[8:11]
    v_mfma_f32_16x16x32_bf16 v[12:15], a[236:239], v[140:143], v[12:15]
    s_waitcnt vmcnt(1)
    v_mfma_f32_16x16x32_bf16 v[8:11], a[240:243], v[144:147], v[8:11]
    v_mfma_f32_16x16x32_bf16 v[12:15], a[244:247], v[144:147], v[12:15]
    s_waitcnt vmcnt(0)
    v_mfma_f32_16x16x32_bf16 v[8:11], a[248:251], v[148:151], v[8:11]
    v_mfma_f32_16x16x32_bf16 v[12:15], a[252:255], v[148:151], v[12:15]
    s_nop 6
    ds_write_b128 v2, v[8:11] offset:0
    ds_write_b128 v2, v[12:15] offset:1024
    s_cmp_lg_u32 s32, 0
    s_cbranch_scc1 o1_nb
    v_cmp_eq_u32 vcc, 0, v253
    s_nop 0
    s_cmp_eq_u64 vcc, 0
    s_cselect_b32 s44, 65536, 0
    v_or_b32 v250, s44, v250
    v_mov_b32 v251, 163832
    s_mov_b64 exec, 1
    ds_write_b32 v251, v250
    s_mov_b64 exec, -1
o1_nb:
    s_waitcnt lgkmcnt(0)
    s_barrier
    s_cmp_gt_u32 s32, 0
    s_cbranch_scc1 o1_skip
    s_lshl_b32 s18, s32, 13
    v_add_u32 v2, s18, v1
    ds_read_b128 v[24:27], v2 offset:0
    ds_read_b128 v[28:31], v2 offset:1024
    ds_read_b128 v[32:35], v2 offset:2048
    ds_read_b128 v[36:39], v2 offset:3072
    ds_read_b128 v[40:43], v2 offset:4096
    ds_read_b128 v[44:47], v2 offset:5120
    ds_read_b128 v[48:51], v2 offset:6144
    ds_read_b128 v[52:55], v2 offset:7168
    v_lshrrev_b32 v3, 4, v1
    v_bfe_u32 v4, v3, 2, 2
    v_lshlrev_b32 v4, 3, v4
    v_and_b32 v2, 3, v3
    v_add_u32 v4, v4, v2
    v_mul_u32_u24 v4, 2304, v4
    v_lshrrev_b32 v3, 4, v3
    v_lshl_add_u32 v4, v3, 4, v4
    s_add_u32 s20, s16, s32
    s_lshr_b32 s18, s20, 1
    s_lshl_b32 s18, s18, 3
    s_and_b32 s19, s20, 1
    s_add_u32 s18, s18, s19
    s_mul_i32 s18, s18, 9216
    s_lshl_b32 s19, s33, 6
    s_add_u32 s18, s18, s19
    s_waitcnt lgkmcnt(0)
    v_pk_add_f32 v[24:25], v[24:25], v[32:33]
    v_pk_add_f32 v[40:41], v[40:41], v[48:49]
    v_pk_add_f32 v[24:25], v[24:25], v[40:41]
    v_pk_add_f32 v[26:27], v[26:27], v[34:35]
    v_pk_add_f32 v[42:43], v[42:43], v[50:51]
    v_pk_add_f32 v[26:27], v[26:27], v[42:43]
    v_pk_add_f32 v[28:29], v[28:29], v[36:37]
    v_pk_add_f32 v[44:45], v[44:45], v[52:53]
    v_pk_add_f32 v[28:29], v[28:29], v[44:45]
    v_pk_add_f32 v[30:31], v[30:31], v[38:39]
    v_pk_add_f32 v[46:47], v[46:47], v[54:55]
    v_pk_add_f32 v[30:31], v[30:31], v[46:47]
    v_cvt_pk_bf16_f32 v8, v24, v28
    v_cvt_pk_bf16_f32 v9, v25, v29
    v_cvt_pk_bf16_f32 v10, v26, v30
    v_cvt_pk_bf16_f32 v11, v27, v31
    buffer_store_dwordx4 v[8:11], v4, s[8:11], s18 offen
o1_skip:
    s_nop 1
L_op_fin:
    v_mov_b32 v251, 163832
    ds_read_b32 v252, v251
    s_waitcnt lgkmcnt(0)
    v_readfirstlane_b32 s40, v252
    s_nop 1
    s_cmp_ge_u32 s40, 65608
    s_cbranch_scc1 L_done
    s_barrier
    s_and_b32 s16, s40, 0xffff
    s_cmp_lt_u32 s16, 72
    s_cbranch_scc1 L_op_seg
L_op_nextcb:
    s_mov_b32 s40, -1
    s_cmp_lg_u32 s32, 0
    s_cbranch_scc1 L_op_dec
    v_and_b32 v1, 63, v0
    v_min_u32 v1, 17, v1
    v_lshlrev_b32 v2, 2, v1
    buffer_load_dword v3, v2, s[84:87], 0 offen offset:136 sc1
    s_waitcnt vmcnt(0)
    v_cmp_gt_u32 vcc, 52, v3
    s_nop 0
    s_and_b32 s40, vcc_lo, 262143
    s_lshl_b32 s41, s40, 18
    s_lshr_b32 s43, s40, 14
    s_or_b32 s42, s40, s41
    s_and_b32 s36, s45, 15
    s_bfm_b32 s37, s36, 0
    s_and_b32 s37, s37, 42315
    s_bcnt1_i32_b32 s37, s37
    s_lshr_b32 s36, s45, 4
    s_mul_i32 s36, s36, 8
    s_add_u32 s36, s36, s37
    s_add_u32 s36, s36, 38
    s_mul_hi_u32 s41, s36, 0x0e38e38f
    s_mul_i32 s41, s41, 18
    s_sub_u32 s41, s36, s41
    s_lshr_b64 s[42:43], s[42:43], s41
    s_ff1_i32_b64 s40, s[42:43]
    s_cmp_lt_i32 s40, 0
    s_cbranch_scc1 L_op_dec
    s_add_u32 s40, s40, s41
    s_sub_u32 s41, s40, 18
    s_cselect_b32 s40, s40, s41
L_op_dec:
    v_mov_b32 v250, s40
    v_mov_b32 v251, 163832
    s_cmp_lg_u32 s32, 0
    s_cbranch_scc1 L_op_nw
    ds_write_b32 v251, v250
    s_waitcnt lgkmcnt(0)
L_op_nw:
    s_barrier
    ds_read_b32 v252, v251
    s_waitcnt lgkmcnt(0)
    v_readfirstlane_b32 s33, v252
    s_barrier
    s_nop 1
    s_cmp_lt_u32 s33, 18
    s_cbranch_scc1 L_op_start
L_done:
L_exit:
    s_endpgm
.section .rodata,"a"
.p2align 6
.amdhsa_kernel concat_heads__memory_aug_recurrent_mem_tr__ssm_conv_s4d__prompt_kernel
  .amdhsa_next_free_vgpr 512
  .amdhsa_next_free_sgpr 102
  .amdhsa_accum_offset 256
  .amdhsa_group_segment_fixed_size 0
  .amdhsa_kernarg_size 136
  .amdhsa_user_sgpr_count 2
  .amdhsa_user_sgpr_kernarg_segment_ptr 1
  .amdhsa_system_sgpr_workgroup_id_x 1
.end_amdhsa_kernel
.text
```

```asm
; @launch grid=(256,1,1) block=(256,1,1) lds=163840
.amdgcn_target "amdgcn-amd-amdhsa--gfx950"
.text
.globl concat_heads__memory_aug_recurrent_mem_tr__ssm_conv_s4d__prompt_kernel
.p2align 8
.type concat_heads__memory_aug_recurrent_mem_tr__ssm_conv_s4d__prompt_kernel,@function
concat_heads__memory_aug_recurrent_mem_tr__ssm_conv_s4d__prompt_kernel:
    s_cmp_ge_u32 s2, 256
    s_cbranch_scc1 L_exit
    s_load_dwordx4 s[80:83], s[0:1], 120
    s_load_dwordx16 s[48:63], s[0:1], 0
    s_memrealtime s[90:91]
    v_lshrrev_b32 v1, 6, v0
    s_nop 0
    v_readfirstlane_b32 s32, v1
    s_waitcnt lgkmcnt(0)
    s_mov_b32 s4, s82
    s_mov_b32 s5, s83
    s_mov_b32 s6, 268435456
    s_mov_b32 s7, 0x20000
    s_mov_b32 s84, s80
    s_mov_b32 s85, s81
    s_mov_b32 s86, 256
    s_mov_b32 s87, 0x20000
    s_cmp_lg_u32 s32, 0
    s_cbranch_scc1 L_nod0
L_nod0:
    s_cmp_lg_u32 s32, 3
    s_cbranch_scc1 L_nowarm
    s_getpc_b64 s[44:45]
L_pcw:
    v_and_b32 v1, 63, v0
    v_lshlrev_b32 v1, 7, v1
    v_min_u32 v2, L_exit-L_pcw, v1
    global_load_dword v240, v2, s[44:45]
    v_add_u32 v1, 8192, v1
    v_min_u32 v2, L_exit-L_pcw, v1
    global_load_dword v241, v2, s[44:45]
    v_add_u32 v1, 8192, v1
    v_min_u32 v2, L_exit-L_pcw, v1
    global_load_dword v242, v2, s[44:45]
    v_add_u32 v1, 8192, v1
    v_min_u32 v2, L_exit-L_pcw, v1
    global_load_dword v243, v2, s[44:45]
    v_add_u32 v1, 8192, v1
    v_min_u32 v2, L_exit-L_pcw, v1
    global_load_dword v244, v2, s[44:45]
    v_add_u32 v1, 8192, v1
    v_min_u32 v2, L_exit-L_pcw, v1
    global_load_dword v245, v2, s[44:45]
    v_add_u32 v1, 8192, v1
    v_min_u32 v2, L_exit-L_pcw, v1
    global_load_dword v246, v2, s[44:45]
    v_add_u32 v1, 8192, v1
    v_min_u32 v2, L_exit-L_pcw, v1
    global_load_dword v247, v2, s[44:45]
    v_add_u32 v1, 8192, v1
    v_min_u32 v2, L_exit-L_pcw, v1
    global_load_dword v248, v2, s[44:45]
    v_add_u32 v1, 8192, v1
L_nowarm:
    s_getreg_b32 s3, hwreg(HW_REG_XCC_ID)
    s_and_b32 s3, s3, 15
    s_cmp_lg_u32 s3, 3
    s_cbranch_scc1 L_helper
    s_mov_b32 s37, 128
    v_mov_b32 v250, 1
    v_mov_b32 v251, 163832
    v_cmp_eq_u32 vcc, 0, v0
    s_nop 0
    s_and_saveexec_b64 s[38:39], vcc
    s_cbranch_execz tk1
    buffer_atomic_add v250, off, s[84:87], s37 sc0
    s_waitcnt vmcnt(0)
    ds_write_b32 v251, v250
    s_waitcnt lgkmcnt(0)
tk1:
    s_mov_b64 exec, -1
    s_barrier
    ds_read_b32 v252, v251
    s_waitcnt lgkmcnt(0)
    v_readfirstlane_b32 s12, v252
    s_barrier
    s_nop 3
    s_cmp_ge_u32 s12, 32
    s_cbranch_scc1 L_helper
L_chain:
    s_load_dwordx8 s[48:55], s[0:1], 8
    s_load_dwordx2 s[56:57], s[0:1], 40
    s_waitcnt lgkmcnt(0)
    v_lshrrev_b32 v77, 6, v0
    s_nop 0
    v_readfirstlane_b32 s13, v77
    v_lshlrev_b32 v65, 4, v0
    v_and_b32 v48, 63, v0
    s_mov_b32 s10, 4718592
    s_mov_b32 s11, 0x20000
    v_lshrrev_b32 v49, 3, v48
    v_mul_u32_u24 v18, 1152, v49
    v_and_b32 v49, 7, v48
    v_lshl_add_u32 v18, v49, 4, v18
    s_mul_i32 s40, s12, 147456
    s_lshl_b32 s41, s13, 8
    s_add_u32 s40, s40, s41
    s_mov_b32 s42, s40
    s_xor_b32 s41, s13, 0
    s_mul_i32 s41, s41, 36864
    s_add_u32 s60, s41, s40
    s_xor_b32 s41, s13, 1
    s_mul_i32 s41, s41, 36864
    s_add_u32 s61, s41, s40
    s_xor_b32 s41, s13, 2
    s_mul_i32 s41, s41, 36864
    s_add_u32 s62, s41, s40
    s_xor_b32 s41, s13, 3
    s_mul_i32 s41, s41, 36864
    s_add_u32 s63, s41, s40
    s_lshl_b32 s43, s13, 12
    s_mov_b64 s[8:9], s[56:57]
    s_add_u32 m0, s43, 0
    s_add_u32 s41, s60, 0
    buffer_load_dwordx4 v18, s[8:11], s41 offen offset:0 nt lds
    s_add_u32 s41, s60, 8192
    buffer_load_dwordx4 v18, s[8:11], s41 offen offset:1024 nt lds
    s_add_u32 s41, s60, 16384
    buffer_load_dwordx4 v18, s[8:11], s41 offen offset:2048 nt lds
    s_add_u32 s41, s60, 24576
    buffer_load_dwordx4 v18, s[8:11], s41 offen offset:3072 nt lds
    s_add_u32 m0, s43, 36864
    s_add_u32 s41, s61, 0
    buffer_load_dwordx4 v18, s[8:11], s41 offen offset:0 nt lds
    s_add_u32 s41, s61, 8192
    buffer_load_dwordx4 v18, s[8:11], s41 offen offset:1024 nt lds
    s_add_u32 s41, s61, 16384
    buffer_load_dwordx4 v18, s[8:11], s41 offen offset:2048 nt lds
    s_add_u32 s41, s61, 24576
    buffer_load_dwordx4 v18, s[8:11], s41 offen offset:3072 nt lds
    s_add_u32 m0, s43, 73728
    s_add_u32 s41, s62, 0
    buffer_load_dwordx4 v18, s[8:11], s41 offen offset:0 nt lds
    s_add_u32 s41, s62, 8192
    buffer_load_dwordx4 v18, s[8:11], s41 offen offset:1024 nt lds
    s_add_u32 s41, s62, 16384
    buffer_load_dwordx4 v18, s[8:11], s41 offen offset:2048 nt lds
    s_add_u32 s41, s62, 24576
    buffer_load_dwordx4 v18, s[8:11], s41 offen offset:3072 nt lds
    s_add_u32 m0, s43, 110592
    s_add_u32 s41, s63, 0
    buffer_load_dwordx4 v18, s[8:11], s41 offen offset:0 nt lds
    s_add_u32 s41, s63, 8192
    buffer_load_dwordx4 v18, s[8:11], s41 offen offset:1024 nt lds
    s_add_u32 s41, s63, 16384
    buffer_load_dwordx4 v18, s[8:11], s41 offen offset:2048 nt lds
    s_add_u32 s41, s63, 24576
    buffer_load_dwordx4 v18, s[8:11], s41 offen offset:3072 nt lds
    v_lshrrev_b32 v49, 1, v48
    v_mul_u32_u24 v19, 1152, v49
    v_and_b32 v49, 1, v48
    v_lshl_add_u32 v19, v49, 4, v19
    s_mul_i32 s41, s13, 224
    s_sub_u32 s41, 1024, s41
    v_add_u32 v19, s41, v19
    v_lshrrev_b32 v49, 4, v48
    v_lshlrev_b32 v50, 2, v49
    v_and_b32 v51, 15, v48
    v_xor_b32 v51, v51, v50
    v_lshlrev_b32 v51, 4, v51
    v_lshl_add_u32 v16, v49, 15, v51
    v_lshrrev_b32 v50, 1, v49
    v_lshl_add_u32 v17, v50, 16, v51
    v_and_b32 v50, 1, v49
    v_lshl_add_u32 v17, v50, 13, v17
    s_lshl_b32 s40, s12, 8
    s_mul_i32 s58, s13, 1048576
    s_add_u32 s58, s58, s40
    s_lshr_b32 s41, s13, 1
    s_mul_i32 s59, s41, 262144
    s_and_b32 s41, s13, 1
    s_lshl_b32 s41, s41, 14
    s_add_u32 s59, s59, s41
    s_add_u32 s59, s59, s40
    s_add_u32 s59, s59, 4194304
    v_bfe_u32 v50, v48, 2, 2
    v_xor_b32 v51, s13, v50
    v_lshlrev_b32 v20, 6, v51
    v_and_b32 v51, 3, v48
    v_lshl_add_u32 v20, v51, 4, v20
    v_lshrrev_b32 v23, 2, v48
    v_lshl_add_u32 v20, v23, 8, v20
    s_xor_b32 s41, s43, 0
    v_add_u32 v24, s41, v20
    s_xor_b32 s41, s43, 4096
    v_add_u32 v25, s41, v20
    s_xor_b32 s41, s43, 8192
    v_add_u32 v26, s41, v20
    s_xor_b32 s41, s43, 12288
    v_add_u32 v27, s41, v20
    v_and_b32 v23, 1, v50
    v_lshl_add_u32 v23, v49, 2, v23
    v_lshrrev_b32 v50, 1, v50
    v_lshlrev_b32 v21, 7, v23
    v_lshl_add_u32 v21, v50, 6, v21
    v_lshrrev_b32 v16, 1, v51
    v_lshl_add_u32 v21, v16, 5, v21
    v_and_b32 v16, 1, v51
    v_lshl_add_u32 v21, v16, 3, v21
    v_add_u32 v21, s43, v21
    v_lshlrev_b32 v22, 9, v50
    v_xor_b32 v22, v22, v21
    v_lshlrev_b32 v23, 5, v23
    v_lshl_add_u32 v23, v50, 10, v23
    v_lshl_add_u32 v23, v51, 3, v23
    v_add_u32 v23, s43, v23
    v_bfe_u32 v60, v65, 4, 6
    v_and_b32 v61, 15, v60
    v_lshrrev_b32 v62, 4, v60
    v_mov_b32 v64, 0x4444
    v_mov_b32 v77, 0xeeee
    v_cmp_lt_u32 vcc, 7, v61
    s_nop 1
    v_cndmask_b32 v64, v64, v77, vcc
    v_xor_b32 v66, 1024, v65
    v_xor_b32 v67, 2048, v65
    v_xor_b32 v68, 3072, v65
    v_and_b32 v69, 511, v65
    s_mul_i32 s96, s13, 36864
    s_add_u32 s96, s96, 16384
    v_lshlrev_b32 v70, 4, v60
    v_add_u32 v70, s96, v70
    v_lshrrev_b32 v79, 1, v69
    s_lshl_b32 s96, s13, 8
    s_add_u32 s96, s96, 14336
    s_lshl_b32 s33, s13, 10
    s_add_u32 s97, s33, 8192
    v_mov_b32 v77, s97
    v_mov_b32 v78, s96
    v_cmp_lt_u32 vcc, 31, v60
    s_nop 1
    v_cndmask_b32 v71, v77, v78, vcc
    v_add_u32 v71, v71, v79
    v_and_b32 v77, 7, v61
    v_lshrrev_b32 v78, 3, v61
    v_lshlrev_b32 v74, 4, v77
    v_lshl_add_u32 v73, v62, 7, v74
    v_lshl_add_u32 v73, v78, 3, v73
    s_lshl_b32 s96, s13, 9
    v_add_u32 v73, s96, v73
    v_lshrrev_b32 v74, 1, v74
    v_lshl_add_u32 v74, v78, 14, v74
    v_lshl_add_u32 v74, v62, 15, v74
    s_lshl_b32 s96, s13, 17
    v_add_u32 v74, s96, v74
    v_bfe_u32 v77, v61, 2, 1
    v_and_b32 v78, 3, v61
    s_cmp_lt_u32 s13, 2
    s_cselect_b64 vcc, -1, 0
    v_cndmask_b32 v77, 0, v77, vcc
    v_lshlrev_b32 v75, 7, v77
    v_lshl_add_u32 v75, v62, 4, v75
    v_lshl_add_u32 v75, v78, 2, v75
    v_lshlrev_b32 v58, 3, v77
    v_lshl_add_u32 v58, v78, 1, v58
    s_bfe_u32 s97, s12, 0x10001
    s_lshl_b32 s68, s97, 6
    s_lshl_b32 s97, s97, 2
    v_add_u32 v59, s97, v62
    s_bfe_u32 s96, s12, 0x10002
    s_and_b32 s40, s12, 1
    s_lshl_b32 s96, s96, 1
    s_add_u32 s96, s96, s40
    s_lshr_b32 s97, s12, 3
    s_lshl_b32 s98, s13, 2
    s_add_u32 s98, s98, s97
    s_lshl_b32 s98, s98, 2
    s_add_u32 s98, s98, s96
    s_lshl_b32 s98, s98, 8
    s_lshl_b32 s99, s13, 2
    s_add_u32 s99, s99, s96
    s_lshl_b32 s99, s99, 4
    s_lshl_b32 s41, s97, 1
    s_add_u32 s41, s41, s40
    s_lshl_b32 s41, s41, 7
    s_add_u32 s41, s41, 8192
    s_lshl_b32 s40, s40, 3
    s_add_u32 s40, s40, 512
    s_cmp_lt_u32 s13, 2
    s_cselect_b32 s96, 7, 4
    s_cselect_b32 s98, s98, s41
    s_cselect_b32 s99, s99, s40
    s_cselect_b32 s32, 1, 0
    s_add_u32 s68, s68, s98
    s_lshl_b32 s97, s97, s96
    s_add_u32 s99, s99, s97
    v_add_u32 v58, s99, v58
    s_and_b32 s97, s12, 4
    s_or_b32 s97, s97, s13
    s_cmp_eq_u32 s97, 2
    s_cselect_b32 s32, 2, s32
    s_mov_b32 s8, s48
    s_mov_b32 s9, s49
    s_mov_b32 s10, 9216
    v_mul_u32_u24 v77, 1152, v59
    v_lshl_add_u32 v77, v58, 1, v77
    buffer_load_dword v72, v77, s[8:11], 0 offen
    s_mov_b32 s10, 4718592
    s_waitcnt vmcnt(12) lgkmcnt(0)
    s_barrier
    s_mov_b64 s[8:9], s[56:57]
    s_add_u32 m0, s43, 147456
    s_add_u32 s41, s42, 0
    buffer_load_dwordx4 v19, s[8:11], s41 offen offset:0 nt lds
    s_add_u32 s41, s42, 35840
    buffer_load_dwordx4 v19, s[8:11], s41 offen offset:1024 nt lds
    s_add_u32 s41, s42, 71680
    buffer_load_dwordx4 v19, s[8:11], s41 offen offset:2048 nt lds
    s_add_u32 s41, s42, 107520
    buffer_load_dwordx4 v19, s[8:11], s41 offen offset:3072 nt lds
    v_mov_b32 v78, v21
    v_mov_b32 v79, v22
    v_add_u32 v77, 0, v79
    ds_read_b64_tr_b16 v[80:81], v77 offset:0
    ds_read_b64_tr_b16 v[82:83], v77 offset:256
    ds_read_b64_tr_b16 v[84:85], v77 offset:2048
    ds_read_b64_tr_b16 v[86:87], v77 offset:2304
    ds_read_b64_tr_b16 v[112:113], v77 offset:16
    ds_read_b64_tr_b16 v[114:115], v77 offset:272
    ds_read_b64_tr_b16 v[116:117], v77 offset:2064
    ds_read_b64_tr_b16 v[118:119], v77 offset:2320
    s_waitcnt vmcnt(12) lgkmcnt(0)
    s_barrier
    s_mov_b64 s[8:9], s[52:53]
    s_add_u32 m0, s43, 0
    s_add_u32 s41, s58, 0
    buffer_load_dwordx4 v17, s[8:11], s41 offen offset:0 nt lds
    s_add_u32 s41, s58, 31744
    buffer_load_dwordx4 v17, s[8:11], s41 offen offset:1024 nt lds
    s_add_u32 s41, s58, 129024
    buffer_load_dwordx4 v17, s[8:11], s41 offen offset:2048 nt lds
    s_add_u32 s41, s58, 160768
    buffer_load_dwordx4 v17, s[8:11], s41 offen offset:3072 nt lds
    v_add_u32 v77, 36864, v78
    ds_read_b64_tr_b16 v[88:89], v77 offset:0
    ds_read_b64_tr_b16 v[90:91], v77 offset:256
    ds_read_b64_tr_b16 v[92:93], v77 offset:2048
    ds_read_b64_tr_b16 v[94:95], v77 offset:2304
    ds_read_b64_tr_b16 v[120:121], v77 offset:16
    ds_read_b64_tr_b16 v[122:123], v77 offset:272
    ds_read_b64_tr_b16 v[124:125], v77 offset:2064
    ds_read_b64_tr_b16 v[126:127], v77 offset:2320
    s_waitcnt vmcnt(12) lgkmcnt(0)
    s_barrier
    s_add_u32 m0, s43, 36864
    s_add_u32 s41, s58, 16384
    buffer_load_dwordx4 v17, s[8:11], s41 offen offset:0 nt lds
    s_add_u32 s41, s58, 48128
    buffer_load_dwordx4 v17, s[8:11], s41 offen offset:1024 nt lds
    s_add_u32 s41, s58, 145408
    buffer_load_dwordx4 v17, s[8:11], s41 offen offset:2048 nt lds
    s_add_u32 s41, s58, 177152
    buffer_load_dwordx4 v17, s[8:11], s41 offen offset:3072 nt lds
    v_add_u32 v77, 73728, v78
    ds_read_b64_tr_b16 v[96:97], v77 offset:0
    ds_read_b64_tr_b16 v[98:99], v77 offset:256
    ds_read_b64_tr_b16 v[100:101], v77 offset:2048
    ds_read_b64_tr_b16 v[102:103], v77 offset:2304
    ds_read_b64_tr_b16 v[128:129], v77 offset:16
    ds_read_b64_tr_b16 v[130:131], v77 offset:272
    ds_read_b64_tr_b16 v[132:133], v77 offset:2064
    ds_read_b64_tr_b16 v[134:135], v77 offset:2320
    s_waitcnt vmcnt(12) lgkmcnt(0)
    s_barrier
    s_add_u32 m0, s43, 73728
    s_add_u32 s41, s58, 262144
    buffer_load_dwordx4 v17, s[8:11], s41 offen offset:0 nt lds
    s_add_u32 s41, s58, 293888
    buffer_load_dwordx4 v17, s[8:11], s41 offen offset:1024 nt lds
    s_add_u32 s41, s58, 391168
    buffer_load_dwordx4 v17, s[8:11], s41 offen offset:2048 nt lds
    s_add_u32 s41, s58, 422912
    buffer_load_dwordx4 v17, s[8:11], s41 offen offset:3072 nt lds
    v_add_u32 v77, 110592, v78
    ds_read_b64_tr_b16 v[104:105], v77 offset:0
    ds_read_b64_tr_b16 v[106:107], v77 offset:256
    ds_read_b64_tr_b16 v[108:109], v77 offset:2048
    ds_read_b64_tr_b16 v[110:111], v77 offset:2304
    ds_read_b64_tr_b16 v[136:137], v77 offset:16
    ds_read_b64_tr_b16 v[138:139], v77 offset:272
    ds_read_b64_tr_b16 v[140:141], v77 offset:2064
    ds_read_b64_tr_b16 v[142:143], v77 offset:2320
    s_waitcnt vmcnt(12) lgkmcnt(0)
    s_barrier
    s_add_u32 m0, s43, 110592
    s_add_u32 s41, s58, 278528
    buffer_load_dwordx4 v17, s[8:11], s41 offen offset:0 nt lds
    s_add_u32 s41, s58, 310272
    buffer_load_dwordx4 v17, s[8:11], s41 offen offset:1024 nt lds
    s_add_u32 s41, s58, 407552
    buffer_load_dwordx4 v17, s[8:11], s41 offen offset:2048 nt lds
    s_add_u32 s41, s58, 439296
    buffer_load_dwordx4 v17, s[8:11], s41 offen offset:3072 nt lds
    v_add_u32 v77, 147456, v23
    ds_read_b64_tr_b16 v[0:1], v77 offset:0
    ds_read_b64_tr_b16 v[2:3], v77 offset:64
    ds_read_b64_tr_b16 v[4:5], v77 offset:512
    ds_read_b64_tr_b16 v[6:7], v77 offset:576
    ds_read_b64_tr_b16 v[8:9], v77 offset:2048
    ds_read_b64_tr_b16 v[10:11], v77 offset:2112
    ds_read_b64_tr_b16 v[12:13], v77 offset:2560
    ds_read_b64_tr_b16 v[14:15], v77 offset:2624
    s_waitcnt vmcnt(12) lgkmcnt(0)
    s_barrier
    s_add_u32 m0, s43, 147456
    s_add_u32 s41, s58, 524288
    buffer_load_dwordx4 v17, s[8:11], s41 offen offset:0 nt lds
    s_add_u32 s41, s58, 556032
    buffer_load_dwordx4 v17, s[8:11], s41 offen offset:1024 nt lds
    s_add_u32 s41, s58, 653312
    buffer_load_dwordx4 v17, s[8:11], s41 offen offset:2048 nt lds
    s_add_u32 s41, s58, 685056
    buffer_load_dwordx4 v17, s[8:11], s41 offen offset:3072 nt lds
    s_cmp_eq_u32 s32, 0
    s_cbranch_scc1 cf_init_done
    v_mov_b32 v52, 1
    v_mov_b32 v53, 1
    v_mov_b32 v54, 1
    v_mov_b32 v55, 1
    v_mov_b32 v56, 0
    s_lshl_b32 s96, s12, 14
    s_add_u32 s96, s96, 68157440
    s_add_u32 s97, s96, 0
    buffer_store_dwordx4 v[52:55], v65, s[4:7], s97 offen
    buffer_load_dwordx4 v[60:63], v65, s[4:7], s97 offen sc1
    s_add_u32 s97, s96, 4096
    buffer_store_dwordx4 v[52:55], v65, s[4:7], s97 offen
    buffer_load_dwordx4 v[60:63], v65, s[4:7], s97 offen sc1
    s_add_u32 s97, s96, 8192
    buffer_store_dwordx4 v[52:55], v65, s[4:7], s97 offen
    buffer_load_dwordx4 v[60:63], v65, s[4:7], s97 offen sc1
    s_add_u32 s97, s96, 12288
    buffer_store_dwordx4 v[52:55], v65, s[4:7], s97 offen
    buffer_load_dwordx4 v[60:63], v65, s[4:7], s97 offen sc1
    s_add_u32 s96, s68, 67108864
    s_add_u32 s97, s96, 16384
    buffer_store_dword v56, v75, s[4:7], s96 offen offset:0
    buffer_store_dword v72, v75, s[4:7], s97 offen offset:0
    buffer_load_dword v60, v75, s[4:7], s96 offen offset:0 sc1
    buffer_load_dword v60, v75, s[4:7], s97 offen offset:0 sc1
    s_cmp_lg_u32 s32, 2
    s_cbranch_scc1 cf_init_done
    buffer_store_dword v56, v75, s[4:7], s96 offen offset:1024
    buffer_store_dword v72, v75, s[4:7], s97 offen offset:1024
    buffer_load_dword v60, v75, s[4:7], s96 offen offset:1024 sc1
    buffer_load_dword v60, v75, s[4:7], s97 offen offset:1024 sc1
    buffer_store_dword v56, v75, s[4:7], s96 offen offset:2048
    buffer_store_dword v72, v75, s[4:7], s97 offen offset:2048
    buffer_load_dword v60, v75, s[4:7], s96 offen offset:2048 sc1
    buffer_load_dword v60, v75, s[4:7], s97 offen offset:2048 sc1
    buffer_store_dword v56, v75, s[4:7], s96 offen offset:3072
    buffer_store_dword v72, v75, s[4:7], s97 offen offset:3072
    buffer_load_dword v60, v75, s[4:7], s96 offen offset:3072 sc1
    buffer_load_dword v60, v75, s[4:7], s97 offen offset:3072 sc1
cf_init_done:
    ds_write_b64 v70, v[0:1] offset:16384
    ds_write_b64 v70, v[2:3] offset:16392
    ds_write_b64 v70, v[4:5] offset:17408
    ds_write_b64 v70, v[6:7] offset:17416
    ds_write_b64 v70, v[8:9] offset:18432
    ds_write_b64 v70, v[10:11] offset:18440
    ds_write_b64 v70, v[12:13] offset:19456
    ds_write_b64 v70, v[14:15] offset:19464
    v_add_u32 v28, 0, v24
    v_add_u32 v29, 0, v25
    v_add_u32 v30, 0, v26
    v_add_u32 v31, 0, v27
    ds_read_b64_tr_b16 a[96:97], v28 offset:0
    ds_read_b64_tr_b16 a[104:105], v28 offset:8
    ds_read_b64_tr_b16 a[112:113], v29 offset:0
    ds_read_b64_tr_b16 a[120:121], v29 offset:8
    ds_read_b64_tr_b16 a[128:129], v30 offset:0
    ds_read_b64_tr_b16 a[136:137], v30 offset:8
    ds_read_b64_tr_b16 a[144:145], v31 offset:0
    ds_read_b64_tr_b16 v[32:33], v31 offset:8
    s_waitcnt vmcnt(12) lgkmcnt(0)
    s_barrier
    s_add_u32 m0, s43, 0
    s_add_u32 s41, s58, 540672
    buffer_load_dwordx4 v17, s[8:11], s41 offen offset:0 nt lds
    s_add_u32 s41, s58, 572416
    buffer_load_dwordx4 v17, s[8:11], s41 offen offset:1024 nt lds
    s_add_u32 s41, s58, 669696
    buffer_load_dwordx4 v17, s[8:11], s41 offen offset:2048 nt lds
    s_add_u32 s41, s58, 701440
    buffer_load_dwordx4 v17, s[8:11], s41 offen offset:3072 nt lds
    ds_write_b64 v70, v[32:33] offset:12288
    v_add_u32 v28, 36864, v24
    v_add_u32 v29, 36864, v25
    v_add_u32 v30, 36864, v26
    v_add_u32 v31, 36864, v27
    ds_read_b64_tr_b16 a[98:99], v28 offset:0
    ds_read_b64_tr_b16 a[106:107], v28 offset:8
    ds_read_b64_tr_b16 a[114:115], v29 offset:0
    ds_read_b64_tr_b16 a[122:123], v29 offset:8
    ds_read_b64_tr_b16 a[130:131], v30 offset:0
    ds_read_b64_tr_b16 a[138:139], v30 offset:8
    ds_read_b64_tr_b16 a[146:147], v31 offset:0
    ds_read_b64_tr_b16 v[0:1], v31 offset:8
    s_waitcnt vmcnt(12) lgkmcnt(0)
    s_barrier
    s_add_u32 m0, s43, 36864
    s_add_u32 s41, s58, 786432
    buffer_load_dwordx4 v17, s[8:11], s41 offen offset:0 nt lds
    s_add_u32 s41, s58, 818176
    buffer_load_dwordx4 v17, s[8:11], s41 offen offset:1024 nt lds
    s_add_u32 s41, s58, 915456
    buffer_load_dwordx4 v17, s[8:11], s41 offen offset:2048 nt lds
    s_add_u32 s41, s58, 947200
    buffer_load_dwordx4 v17, s[8:11], s41 offen offset:3072 nt lds
    ds_write_b64 v70, v[0:1] offset:12296
    v_add_u32 v28, 73728, v24
    v_add_u32 v29, 73728, v25
    v_add_u32 v30, 73728, v26
    v_add_u32 v31, 73728, v27
    ds_read_b64_tr_b16 a[100:101], v28 offset:0
    ds_read_b64_tr_b16 a[108:109], v28 offset:8
    ds_read_b64_tr_b16 a[116:117], v29 offset:0
    ds_read_b64_tr_b16 a[124:125], v29 offset:8
    ds_read_b64_tr_b16 a[132:133], v30 offset:0
    ds_read_b64_tr_b16 a[140:141], v30 offset:8
    ds_read_b64_tr_b16 a[148:149], v31 offset:0
    ds_read_b64_tr_b16 v[32:33], v31 offset:8
    s_waitcnt vmcnt(12) lgkmcnt(0)
    s_barrier
    s_add_u32 m0, s43, 73728
    s_add_u32 s41, s58, 802816
    buffer_load_dwordx4 v17, s[8:11], s41 offen offset:0 nt lds
    s_add_u32 s41, s58, 834560
    buffer_load_dwordx4 v17, s[8:11], s41 offen offset:1024 nt lds
    s_add_u32 s41, s58, 931840
    buffer_load_dwordx4 v17, s[8:11], s41 offen offset:2048 nt lds
    s_add_u32 s41, s58, 963584
    buffer_load_dwordx4 v17, s[8:11], s41 offen offset:3072 nt lds
    ds_write_b64 v70, v[32:33] offset:13312
    v_add_u32 v28, 110592, v24
    v_add_u32 v29, 110592, v25
    v_add_u32 v30, 110592, v26
    v_add_u32 v31, 110592, v27
    ds_read_b64_tr_b16 a[102:103], v28 offset:0
    ds_read_b64_tr_b16 a[110:111], v28 offset:8
    ds_read_b64_tr_b16 a[118:119], v29 offset:0
    ds_read_b64_tr_b16 a[126:127], v29 offset:8
    ds_read_b64_tr_b16 a[134:135], v30 offset:0
    ds_read_b64_tr_b16 a[142:143], v30 offset:8
    ds_read_b64_tr_b16 a[150:151], v31 offset:0
    ds_read_b64_tr_b16 v[0:1], v31 offset:8
    s_waitcnt vmcnt(12) lgkmcnt(0)
    s_barrier
    s_add_u32 m0, s43, 110592
    s_add_u32 s41, s59, 0
    buffer_load_dwordx4 v17, s[8:11], s41 offen offset:0 nt lds
    s_add_u32 s41, s59, 31744
    buffer_load_dwordx4 v17, s[8:11], s41 offen offset:1024 nt lds
    s_add_u32 s41, s59, 129024
    buffer_load_dwordx4 v17, s[8:11], s41 offen offset:2048 nt lds
    s_add_u32 s41, s59, 160768
    buffer_load_dwordx4 v17, s[8:11], s41 offen offset:3072 nt lds
    ds_write_b64 v70, v[0:1] offset:13320
    v_add_u32 v28, 147456, v24
    v_add_u32 v29, 147456, v25
    v_add_u32 v30, 147456, v26
    v_add_u32 v31, 147456, v27
    ds_read_b64_tr_b16 a[152:153], v28 offset:0
    ds_read_b64_tr_b16 a[160:161], v28 offset:8
    ds_read_b64_tr_b16 a[168:169], v29 offset:0
    ds_read_b64_tr_b16 a[176:177], v29 offset:8
    ds_read_b64_tr_b16 a[184:185], v30 offset:0
    ds_read_b64_tr_b16 a[192:193], v30 offset:8
    ds_read_b64_tr_b16 a[200:201], v31 offset:0
    ds_read_b64_tr_b16 a[208:209], v31 offset:8
    s_waitcnt vmcnt(12) lgkmcnt(0)
    s_barrier
    s_mov_b64 s[8:9], s[50:51]
    s_add_u32 m0, s43, 147456
    s_add_u32 s41, s58, 0
    buffer_load_dwordx4 v17, s[8:11], s41 offen offset:0 nt lds
    s_add_u32 s41, s58, 31744
    buffer_load_dwordx4 v17, s[8:11], s41 offen offset:1024 nt lds
    s_add_u32 s41, s58, 129024
    buffer_load_dwordx4 v17, s[8:11], s41 offen offset:2048 nt lds
    s_add_u32 s41, s58, 160768
    buffer_load_dwordx4 v17, s[8:11], s41 offen offset:3072 nt lds
    s_cmp_lg_u32 s13, 0
    s_cbranch_scc1 cf_ma
    v_mov_b32 v54, 1
    s_mov_b64 exec, 1
    buffer_atomic_add v54, off, s[84:87], 0 offset:132
    s_mov_b64 exec, -1
cf_ma:
    v_add_u32 v28, 0, v24
    v_add_u32 v29, 0, v25
    v_add_u32 v30, 0, v26
    v_add_u32 v31, 0, v27
    ds_read_b64_tr_b16 a[154:155], v28 offset:0
    ds_read_b64_tr_b16 a[162:163], v28 offset:8
    ds_read_b64_tr_b16 a[170:171], v29 offset:0
    ds_read_b64_tr_b16 a[178:179], v29 offset:8
    ds_read_b64_tr_b16 a[186:187], v30 offset:0
    ds_read_b64_tr_b16 a[194:195], v30 offset:8
    ds_read_b64_tr_b16 a[202:203], v31 offset:0
    ds_read_b64_tr_b16 a[210:211], v31 offset:8
    s_waitcnt vmcnt(12) lgkmcnt(0)
    s_barrier
    s_add_u32 m0, s43, 0
    s_add_u32 s41, s58, 16384
    buffer_load_dwordx4 v17, s[8:11], s41 offen offset:0 nt lds
    s_add_u32 s41, s58, 48128
    buffer_load_dwordx4 v17, s[8:11], s41 offen offset:1024 nt lds
    s_add_u32 s41, s58, 145408
    buffer_load_dwordx4 v17, s[8:11], s41 offen offset:2048 nt lds
    s_add_u32 s41, s58, 177152
    buffer_load_dwordx4 v17, s[8:11], s41 offen offset:3072 nt lds
    v_add_u32 v28, 36864, v24
    v_add_u32 v29, 36864, v25
    v_add_u32 v30, 36864, v26
    v_add_u32 v31, 36864, v27
    ds_read_b64_tr_b16 a[156:157], v28 offset:0
    ds_read_b64_tr_b16 a[164:165], v28 offset:8
    ds_read_b64_tr_b16 a[172:173], v29 offset:0
    ds_read_b64_tr_b16 a[180:181], v29 offset:8
    ds_read_b64_tr_b16 a[188:189], v30 offset:0
    ds_read_b64_tr_b16 a[196:197], v30 offset:8
    ds_read_b64_tr_b16 a[204:205], v31 offset:0
    ds_read_b64_tr_b16 a[212:213], v31 offset:8
    s_waitcnt vmcnt(12) lgkmcnt(0)
    s_barrier
    s_add_u32 m0, s43, 36864
    s_add_u32 s41, s58, 262144
    buffer_load_dwordx4 v17, s[8:11], s41 offen offset:0 nt lds
    s_add_u32 s41, s58, 293888
    buffer_load_dwordx4 v17, s[8:11], s41 offen offset:1024 nt lds
    s_add_u32 s41, s58, 391168
    buffer_load_dwordx4 v17, s[8:11], s41 offen offset:2048 nt lds
    s_add_u32 s41, s58, 422912
    buffer_load_dwordx4 v17, s[8:11], s41 offen offset:3072 nt lds
    v_add_u32 v28, 73728, v24
    v_add_u32 v29, 73728, v25
    v_add_u32 v30, 73728, v26
    v_add_u32 v31, 73728, v27
    ds_read_b64_tr_b16 a[158:159], v28 offset:0
    ds_read_b64_tr_b16 a[166:167], v28 offset:8
    ds_read_b64_tr_b16 a[174:175], v29 offset:0
    ds_read_b64_tr_b16 a[182:183], v29 offset:8
    ds_read_b64_tr_b16 a[190:191], v30 offset:0
    ds_read_b64_tr_b16 a[198:199], v30 offset:8
    ds_read_b64_tr_b16 a[206:207], v31 offset:0
    ds_read_b64_tr_b16 a[214:215], v31 offset:8
    s_waitcnt vmcnt(12) lgkmcnt(0)
    s_barrier
    s_add_u32 m0, s43, 73728
    s_add_u32 s41, s58, 278528
    buffer_load_dwordx4 v17, s[8:11], s41 offen offset:0 nt lds
    s_add_u32 s41, s58, 310272
    buffer_load_dwordx4 v17, s[8:11], s41 offen offset:1024 nt lds
    s_add_u32 s41, s58, 407552
    buffer_load_dwordx4 v17, s[8:11], s41 offen offset:2048 nt lds
    s_add_u32 s41, s58, 439296
    buffer_load_dwordx4 v17, s[8:11], s41 offen offset:3072 nt lds
    v_add_u32 v77, 110592, v20
    ds_read_b64_tr_b16 a[216:217], v77 offset:0
    ds_read_b64_tr_b16 a[218:219], v77 offset:4096
    ds_read_b64_tr_b16 a[220:221], v77 offset:8192
    ds_read_b64_tr_b16 a[222:223], v77 offset:12288
    ds_read_b64_tr_b16 a[224:225], v77 offset:8
    ds_read_b64_tr_b16 a[226:227], v77 offset:4104
    ds_read_b64_tr_b16 a[228:229], v77 offset:8200
    ds_read_b64_tr_b16 a[230:231], v77 offset:12296
    s_waitcnt vmcnt(12) lgkmcnt(0)
    s_barrier
    s_add_u32 m0, s43, 110592
    s_add_u32 s41, s58, 524288
    buffer_load_dwordx4 v17, s[8:11], s41 offen offset:0 nt lds
    s_add_u32 s41, s58, 556032
    buffer_load_dwordx4 v17, s[8:11], s41 offen offset:1024 nt lds
    s_add_u32 s41, s58, 653312
    buffer_load_dwordx4 v17, s[8:11], s41 offen offset:2048 nt lds
    s_add_u32 s41, s58, 685056
    buffer_load_dwordx4 v17, s[8:11], s41 offen offset:3072 nt lds
    v_add_u32 v28, 147456, v24
    v_add_u32 v29, 147456, v25
    v_add_u32 v30, 147456, v26
    v_add_u32 v31, 147456, v27
    ds_read_b64_tr_b16 v[0:1], v28 offset:0
    ds_read_b64_tr_b16 v[2:3], v28 offset:8
    ds_read_b64_tr_b16 v[4:5], v29 offset:0
    ds_read_b64_tr_b16 v[6:7], v29 offset:8
    ds_read_b64_tr_b16 a[0:1], v30 offset:0
    ds_read_b64_tr_b16 v[8:9], v30 offset:8
    ds_read_b64_tr_b16 a[8:9], v31 offset:0
    ds_read_b64_tr_b16 v[10:11], v31 offset:8
    s_waitcnt vmcnt(12) lgkmcnt(0)
    s_barrier
    s_add_u32 m0, s43, 147456
    s_add_u32 s41, s58, 540672
    buffer_load_dwordx4 v17, s[8:11], s41 offen offset:0 nt lds
    s_add_u32 s41, s58, 572416
    buffer_load_dwordx4 v17, s[8:11], s41 offen offset:1024 nt lds
    s_add_u32 s41, s58, 669696
    buffer_load_dwordx4 v17, s[8:11], s41 offen offset:2048 nt lds
    s_add_u32 s41, s58, 701440
    buffer_load_dwordx4 v17, s[8:11], s41 offen offset:3072 nt lds
    ds_write_b64 v70, v[0:1] offset:0
    ds_write_b64 v70, v[2:3] offset:2048
    ds_write_b64 v70, v[4:5] offset:4096
    ds_write_b64 v70, v[6:7] offset:6144
    ds_write_b64 v70, v[8:9] offset:10240
    ds_write_b64 v70, v[10:11] offset:14336
    v_add_u32 v28, 0, v24
    v_add_u32 v29, 0, v25
    v_add_u32 v30, 0, v26
    v_add_u32 v31, 0, v27
    ds_read_b64_tr_b16 v[32:33], v28 offset:0
    ds_read_b64_tr_b16 v[34:35], v28 offset:8
    ds_read_b64_tr_b16 v[36:37], v29 offset:0
    ds_read_b64_tr_b16 v[38:39], v29 offset:8
    ds_read_b64_tr_b16 a[2:3], v30 offset:0
    ds_read_b64_tr_b16 v[40:41], v30 offset:8
    ds_read_b64_tr_b16 a[10:11], v31 offset:0
    ds_read_b64_tr_b16 v[42:43], v31 offset:8
    s_waitcnt vmcnt(12) lgkmcnt(0)
    s_barrier
    s_add_u32 m0, s43, 0
    s_add_u32 s41, s58, 786432
    buffer_load_dwordx4 v17, s[8:11], s41 offen offset:0 nt lds
    s_add_u32 s41, s58, 818176
    buffer_load_dwordx4 v17, s[8:11], s41 offen offset:1024 nt lds
    s_add_u32 s41, s58, 915456
    buffer_load_dwordx4 v17, s[8:11], s41 offen offset:2048 nt lds
    s_add_u32 s41, s58, 947200
    buffer_load_dwordx4 v17, s[8:11], s41 offen offset:3072 nt lds
    ds_write_b64 v70, v[32:33] offset:8
    ds_write_b64 v70, v[34:35] offset:2056
    ds_write_b64 v70, v[36:37] offset:4104
    ds_write_b64 v70, v[38:39] offset:6152
    ds_write_b64 v70, v[40:41] offset:10248
    ds_write_b64 v70, v[42:43] offset:14344
    v_add_u32 v28, 36864, v24
    v_add_u32 v29, 36864, v25
    v_add_u32 v30, 36864, v26
    v_add_u32 v31, 36864, v27
    ds_read_b64_tr_b16 v[0:1], v28 offset:0
    ds_read_b64_tr_b16 v[2:3], v28 offset:8
    ds_read_b64_tr_b16 v[4:5], v29 offset:0
    ds_read_b64_tr_b16 v[6:7], v29 offset:8
    ds_read_b64_tr_b16 a[4:5], v30 offset:0
    ds_read_b64_tr_b16 v[8:9], v30 offset:8
    ds_read_b64_tr_b16 a[12:13], v31 offset:0
    ds_read_b64_tr_b16 v[10:11], v31 offset:8
    s_waitcnt vmcnt(12) lgkmcnt(0)
    s_barrier
    s_add_u32 m0, s43, 36864
    s_add_u32 s41, s58, 802816
    buffer_load_dwordx4 v17, s[8:11], s41 offen offset:0 nt lds
    s_add_u32 s41, s58, 834560
    buffer_load_dwordx4 v17, s[8:11], s41 offen offset:1024 nt lds
    s_add_u32 s41, s58, 931840
    buffer_load_dwordx4 v17, s[8:11], s41 offen offset:2048 nt lds
    s_add_u32 s41, s58, 963584
    buffer_load_dwordx4 v17, s[8:11], s41 offen offset:3072 nt lds
    ds_write_b64 v70, v[0:1] offset:1024
    ds_write_b64 v70, v[2:3] offset:3072
    ds_write_b64 v70, v[4:5] offset:5120
    ds_write_b64 v70, v[6:7] offset:7168
    ds_write_b64 v70, v[8:9] offset:11264
    ds_write_b64 v70, v[10:11] offset:15360
    v_add_u32 v28, 73728, v24
    v_add_u32 v29, 73728, v25
    v_add_u32 v30, 73728, v26
    v_add_u32 v31, 73728, v27
    ds_read_b64_tr_b16 v[32:33], v28 offset:0
    ds_read_b64_tr_b16 v[34:35], v28 offset:8
    ds_read_b64_tr_b16 v[36:37], v29 offset:0
    ds_read_b64_tr_b16 v[38:39], v29 offset:8
    ds_read_b64_tr_b16 a[6:7], v30 offset:0
    ds_read_b64_tr_b16 v[40:41], v30 offset:8
    ds_read_b64_tr_b16 a[14:15], v31 offset:0
    ds_read_b64_tr_b16 v[42:43], v31 offset:8
    s_waitcnt vmcnt(12) lgkmcnt(0)
    s_barrier
    s_add_u32 m0, s43, 73728
    s_add_u32 s41, s59, 0
    buffer_load_dwordx4 v17, s[8:11], s41 offen offset:0 nt lds
    s_add_u32 s41, s59, 31744
    buffer_load_dwordx4 v17, s[8:11], s41 offen offset:1024 nt lds
    s_add_u32 s41, s59, 129024
    buffer_load_dwordx4 v17, s[8:11], s41 offen offset:2048 nt lds
    s_add_u32 s41, s59, 160768
    buffer_load_dwordx4 v17, s[8:11], s41 offen offset:3072 nt lds
    ds_write_b64 v70, v[32:33] offset:1032
    ds_write_b64 v70, v[34:35] offset:3080
    ds_write_b64 v70, v[36:37] offset:5128
    ds_write_b64 v70, v[38:39] offset:7176
    ds_write_b64 v70, v[40:41] offset:11272
    ds_write_b64 v70, v[42:43] offset:15368
    v_add_u32 v28, 110592, v24
    v_add_u32 v29, 110592, v25
    v_add_u32 v30, 110592, v26
    v_add_u32 v31, 110592, v27
    ds_read_b64_tr_b16 a[16:17], v28 offset:0
    ds_read_b64_tr_b16 a[24:25], v28 offset:8
    ds_read_b64_tr_b16 a[32:33], v29 offset:0
    ds_read_b64_tr_b16 a[40:41], v29 offset:8
    ds_read_b64_tr_b16 a[48:49], v30 offset:0
    ds_read_b64_tr_b16 a[56:57], v30 offset:8
    ds_read_b64_tr_b16 a[64:65], v31 offset:0
    ds_read_b64_tr_b16 a[72:73], v31 offset:8
    s_waitcnt vmcnt(12) lgkmcnt(0)
    s_barrier
    s_mov_b64 s[8:9], s[54:55]
    s_add_u32 m0, s43, 110592
    s_add_u32 s41, s58, 0
    buffer_load_dwordx4 v17, s[8:11], s41 offen offset:0 nt lds
    s_add_u32 s41, s58, 31744
    buffer_load_dwordx4 v17, s[8:11], s41 offen offset:1024 nt lds
    s_add_u32 s41, s58, 129024
    buffer_load_dwordx4 v17, s[8:11], s41 offen offset:2048 nt lds
    s_add_u32 s41, s58, 160768
    buffer_load_dwordx4 v17, s[8:11], s41 offen offset:3072 nt lds
    v_add_u32 v28, 147456, v24
    v_add_u32 v29, 147456, v25
    v_add_u32 v30, 147456, v26
    v_add_u32 v31, 147456, v27
    ds_read_b64_tr_b16 a[18:19], v28 offset:0
    ds_read_b64_tr_b16 a[26:27], v28 offset:8
    ds_read_b64_tr_b16 a[34:35], v29 offset:0
    ds_read_b64_tr_b16 a[42:43], v29 offset:8
    ds_read_b64_tr_b16 a[50:51], v30 offset:0
    ds_read_b64_tr_b16 a[58:59], v30 offset:8
    ds_read_b64_tr_b16 a[66:67], v31 offset:0
    ds_read_b64_tr_b16 a[74:75], v31 offset:8
    s_waitcnt vmcnt(12) lgkmcnt(0)
    s_barrier
    s_add_u32 m0, s43, 147456
    s_add_u32 s41, s58, 16384
    buffer_load_dwordx4 v17, s[8:11], s41 offen offset:0 nt lds
    s_add_u32 s41, s58, 48128
    buffer_load_dwordx4 v17, s[8:11], s41 offen offset:1024 nt lds
    s_add_u32 s41, s58, 145408
    buffer_load_dwordx4 v17, s[8:11], s41 offen offset:2048 nt lds
    s_add_u32 s41, s58, 177152
    buffer_load_dwordx4 v17, s[8:11], s41 offen offset:3072 nt lds
    v_add_u32 v28, 0, v24
    v_add_u32 v29, 0, v25
    v_add_u32 v30, 0, v26
    v_add_u32 v31, 0, v27
    ds_read_b64_tr_b16 a[20:21], v28 offset:0
    ds_read_b64_tr_b16 a[28:29], v28 offset:8
    ds_read_b64_tr_b16 a[36:37], v29 offset:0
    ds_read_b64_tr_b16 a[44:45], v29 offset:8
    ds_read_b64_tr_b16 a[52:53], v30 offset:0
    ds_read_b64_tr_b16 a[60:61], v30 offset:8
    ds_read_b64_tr_b16 a[68:69], v31 offset:0
    ds_read_b64_tr_b16 a[76:77], v31 offset:8
    s_waitcnt vmcnt(12) lgkmcnt(0)
    s_barrier
    s_add_u32 m0, s43, 0
    s_add_u32 s41, s58, 262144
    buffer_load_dwordx4 v17, s[8:11], s41 offen offset:0 nt lds
    s_add_u32 s41, s58, 293888
    buffer_load_dwordx4 v17, s[8:11], s41 offen offset:1024 nt lds
    s_add_u32 s41, s58, 391168
    buffer_load_dwordx4 v17, s[8:11], s41 offen offset:2048 nt lds
    s_add_u32 s41, s58, 422912
    buffer_load_dwordx4 v17, s[8:11], s41 offen offset:3072 nt lds
    v_add_u32 v28, 36864, v24
    v_add_u32 v29, 36864, v25
    v_add_u32 v30, 36864, v26
    v_add_u32 v31, 36864, v27
    ds_read_b64_tr_b16 a[22:23], v28 offset:0
    ds_read_b64_tr_b16 a[30:31], v28 offset:8
    ds_read_b64_tr_b16 a[38:39], v29 offset:0
    ds_read_b64_tr_b16 a[46:47], v29 offset:8
    ds_read_b64_tr_b16 a[54:55], v30 offset:0
    ds_read_b64_tr_b16 a[62:63], v30 offset:8
    ds_read_b64_tr_b16 a[70:71], v31 offset:0
    ds_read_b64_tr_b16 a[78:79], v31 offset:8
    s_waitcnt vmcnt(12) lgkmcnt(0)
    s_barrier
    s_add_u32 m0, s43, 36864
    s_add_u32 s41, s58, 278528
    buffer_load_dwordx4 v17, s[8:11], s41 offen offset:0 nt lds
    s_add_u32 s41, s58, 310272
    buffer_load_dwordx4 v17, s[8:11], s41 offen offset:1024 nt lds
    s_add_u32 s41, s58, 407552
    buffer_load_dwordx4 v17, s[8:11], s41 offen offset:2048 nt lds
    s_add_u32 s41, s58, 439296
    buffer_load_dwordx4 v17, s[8:11], s41 offen offset:3072 nt lds
    s_lshl_b32 s26, s12, 14
    s_add_u32 s26, s26, 0
    s_mul_i32 s40, s13, 3072
    s_add_u32 s24, s26, s40
    s_lshl_b32 s96, s12, 7
    s_add_u32 s29, s96, 125845504
    s_add_u32 s96, s96, 125829120
    v_bfe_u32 v78, v65, 2, 5
    buffer_load_dword v54, off, s[84:87], 0 offset:132 sc1
    buffer_load_dword v55, off, s[84:87], 0 offset:216 sc1
    buffer_load_dword v56, v78, s[4:7], s96 offen offset:16 sc1
    v_add_u32 v77, 73728, v20
    ds_read_b64_tr_b16 a[80:81], v77 offset:0
    ds_read_b64_tr_b16 a[82:83], v77 offset:4096
    ds_read_b64_tr_b16 a[84:85], v77 offset:8192
    ds_read_b64_tr_b16 a[86:87], v77 offset:12288
    ds_read_b64_tr_b16 a[88:89], v77 offset:8
    ds_read_b64_tr_b16 a[90:91], v77 offset:4104
    ds_read_b64_tr_b16 a[92:93], v77 offset:8200
    ds_read_b64_tr_b16 a[94:95], v77 offset:12296
    s_waitcnt vmcnt(12) lgkmcnt(0)
    s_barrier
    s_add_u32 m0, s43, 73728
    s_add_u32 s41, s58, 524288
    buffer_load_dwordx4 v17, s[8:11], s41 offen offset:0 nt lds
    s_add_u32 s41, s58, 556032
    buffer_load_dwordx4 v17, s[8:11], s41 offen offset:1024 nt lds
    s_add_u32 s41, s58, 653312
    buffer_load_dwordx4 v17, s[8:11], s41 offen offset:2048 nt lds
    s_add_u32 s41, s58, 685056
    buffer_load_dwordx4 v17, s[8:11], s41 offen offset:3072 nt lds
    v_add_u32 v28, 110592, v24
    v_add_u32 v29, 110592, v25
    v_add_u32 v30, 110592, v26
    v_add_u32 v31, 110592, v27
    ds_read_b64_tr_b16 a[232:233], v28 offset:0
    ds_read_b64_tr_b16 v[32:33], v28 offset:8
    ds_read_b64_tr_b16 a[240:241], v29 offset:0
    ds_read_b64_tr_b16 a[248:249], v29 offset:8
    ds_read_b64_tr_b16 v[144:145], v30 offset:0
    ds_read_b64_tr_b16 v[152:153], v30 offset:8
    ds_read_b64_tr_b16 v[160:161], v31 offset:0
    ds_read_b64_tr_b16 v[168:169], v31 offset:8
    s_waitcnt vmcnt(12) lgkmcnt(0)
    s_barrier
    s_add_u32 m0, s43, 110592
    s_add_u32 s41, s58, 540672
    buffer_load_dwordx4 v17, s[8:11], s41 offen offset:0 nt lds
    s_add_u32 s41, s58, 572416
    buffer_load_dwordx4 v17, s[8:11], s41 offen offset:1024 nt lds
    s_add_u32 s41, s58, 669696
    buffer_load_dwordx4 v17, s[8:11], s41 offen offset:2048 nt lds
    s_add_u32 s41, s58, 701440
    buffer_load_dwordx4 v17, s[8:11], s41 offen offset:3072 nt lds
    ds_write_b64 v70, v[32:33] offset:8192
    v_add_u32 v28, 147456, v24
    v_add_u32 v29, 147456, v25
    v_add_u32 v30, 147456, v26
    v_add_u32 v31, 147456, v27
    ds_read_b64_tr_b16 a[234:235], v28 offset:0
    ds_read_b64_tr_b16 v[0:1], v28 offset:8
    ds_read_b64_tr_b16 a[242:243], v29 offset:0
    ds_read_b64_tr_b16 a[250:251], v29 offset:8
    ds_read_b64_tr_b16 v[146:147], v30 offset:0
    ds_read_b64_tr_b16 v[154:155], v30 offset:8
    ds_read_b64_tr_b16 v[162:163], v31 offset:0
    ds_read_b64_tr_b16 v[170:171], v31 offset:8
    s_waitcnt vmcnt(12) lgkmcnt(0)
    s_barrier
    s_add_u32 m0, s43, 147456
    s_add_u32 s41, s58, 786432
    buffer_load_dwordx4 v17, s[8:11], s41 offen offset:0 nt lds
    s_add_u32 s41, s58, 818176
    buffer_load_dwordx4 v17, s[8:11], s41 offen offset:1024 nt lds
    s_add_u32 s41, s58, 915456
    buffer_load_dwordx4 v17, s[8:11], s41 offen offset:2048 nt lds
    s_add_u32 s41, s58, 947200
    buffer_load_dwordx4 v17, s[8:11], s41 offen offset:3072 nt lds
    ds_write_b64 v70, v[0:1] offset:8200
    v_add_u32 v28, 0, v24
    v_add_u32 v29, 0, v25
    v_add_u32 v30, 0, v26
    v_add_u32 v31, 0, v27
    ds_read_b64_tr_b16 a[236:237], v28 offset:0
    ds_read_b64_tr_b16 v[32:33], v28 offset:8
    ds_read_b64_tr_b16 a[244:245], v29 offset:0
    ds_read_b64_tr_b16 a[252:253], v29 offset:8
    ds_read_b64_tr_b16 v[148:149], v30 offset:0
    ds_read_b64_tr_b16 v[156:157], v30 offset:8
    ds_read_b64_tr_b16 v[164:165], v31 offset:0
    ds_read_b64_tr_b16 v[172:173], v31 offset:8
    s_waitcnt vmcnt(12) lgkmcnt(0)
    s_barrier
    s_add_u32 m0, s43, 0
    s_add_u32 s41, s58, 802816
    buffer_load_dwordx4 v17, s[8:11], s41 offen offset:0 nt lds
    s_add_u32 s41, s58, 834560
    buffer_load_dwordx4 v17, s[8:11], s41 offen offset:1024 nt lds
    s_add_u32 s41, s58, 931840
    buffer_load_dwordx4 v17, s[8:11], s41 offen offset:2048 nt lds
    s_add_u32 s41, s58, 963584
    buffer_load_dwordx4 v17, s[8:11], s41 offen offset:3072 nt lds
    ds_write_b64 v70, v[32:33] offset:9216
    v_add_u32 v28, 36864, v24
    v_add_u32 v29, 36864, v25
    v_add_u32 v30, 36864, v26
    v_add_u32 v31, 36864, v27
    ds_read_b64_tr_b16 a[238:239], v28 offset:0
    ds_read_b64_tr_b16 v[0:1], v28 offset:8
    ds_read_b64_tr_b16 a[246:247], v29 offset:0
    ds_read_b64_tr_b16 a[254:255], v29 offset:8
    ds_read_b64_tr_b16 v[150:151], v30 offset:0
    ds_read_b64_tr_b16 v[158:159], v30 offset:8
    ds_read_b64_tr_b16 v[166:167], v31 offset:0
    ds_read_b64_tr_b16 v[174:175], v31 offset:8
    s_waitcnt vmcnt(12) lgkmcnt(0)
    s_barrier
    s_add_u32 m0, s43, 36864
    s_add_u32 s41, s59, 0
    buffer_load_dwordx4 v17, s[8:11], s41 offen offset:0 nt lds
    s_add_u32 s41, s59, 31744
    buffer_load_dwordx4 v17, s[8:11], s41 offen offset:1024 nt lds
    s_add_u32 s41, s59, 129024
    buffer_load_dwordx4 v17, s[8:11], s41 offen offset:2048 nt lds
    s_add_u32 s41, s59, 160768
    buffer_load_dwordx4 v17, s[8:11], s41 offen offset:3072 nt lds
    v_readfirstlane_b32 s94, v54
    v_readfirstlane_b32 s95, v55
    v_mov_b32 v77, v56
    s_nop 0
    v_subrev_u32 v77, s95, v77
    v_cmp_lt_u32 vcc, 16, v77
    s_nop 1
    v_cndmask_b32 v77, v77, 0, vcc
    v_bfe_u32 v79, v78, 2, 2
    v_lshl_add_u32 v77, v77, 2, v79
    s_nop 1
    v_min_u32_dpp v77, v77, v77 row_ror:1 row_mask:0xf bank_mask:0xf
    s_nop 1
    v_min_u32_dpp v77, v77, v77 row_ror:2 row_mask:0xf bank_mask:0xf
    s_nop 1
    v_min_u32_dpp v77, v77, v77 row_ror:4 row_mask:0xf bank_mask:0xf
    s_nop 0
    v_readfirstlane_b32 s97, v77
    s_cmp_eq_u32 s95, 0
    s_cselect_b32 s97, 0, s97
    s_cmp_lt_u32 s97, 3
    s_cbranch_scc1 cf_mb
    s_add_u32 s40, s24, 0
    s_add_u32 s40, s40, s33
    s_sub_u32 s41, s96, s40
    v_bfe_u32 v77, v65, 2, 5
    v_add3_u32 v77, v77, s41, 16
    v_lshlrev_b32 v78, 3, v69
    s_nop 0
    v_mov_b32_dpp v78, v77 quad_perm:[0,1,2,3] row_mask:0xc bank_mask:0xf
    buffer_load_dword v58, v78, s[4:7], s40 offen sc1
    s_add_u32 s40, s24, 524288
    s_add_u32 s40, s40, s33
    s_sub_u32 s41, s96, s40
    v_bfe_u32 v77, v65, 2, 5
    v_add3_u32 v77, v77, s41, 16
    v_lshlrev_b32 v78, 3, v69
    s_nop 0
    v_mov_b32_dpp v78, v77 quad_perm:[0,1,2,3] row_mask:0xc bank_mask:0xf
    buffer_load_dword v58, v78, s[4:7], s40 offen sc1
cf_mb:
    s_cmp_lt_u32 s94, 32
    s_cbranch_scc1 cf_mc
    s_cmp_lg_u32 s13, 0
    s_cbranch_scc1 cf_mc
    v_mov_b32 v76, 1
    v_mov_b32 v77, 0
    s_mov_b64 exec, 1
    buffer_atomic_cmpswap v[76:77], off, s[84:87], 0 offset:28 sc0
    s_mov_b64 exec, -1
cf_mc:
    s_nop 1
    ds_write_b64 v70, v[0:1] offset:9224
    v_add_u32 v28, 73728, v24
    v_add_u32 v29, 73728, v25
    v_add_u32 v30, 73728, v26
    v_add_u32 v31, 73728, v27
    ds_read_b64_tr_b16 v[176:177], v28 offset:0
    ds_read_b64_tr_b16 v[184:185], v28 offset:8
    ds_read_b64_tr_b16 v[192:193], v29 offset:0
    ds_read_b64_tr_b16 v[200:201], v29 offset:8
    ds_read_b64_tr_b16 v[208:209], v30 offset:0
    ds_read_b64_tr_b16 v[216:217], v30 offset:8
    ds_read_b64_tr_b16 v[224:225], v31 offset:0
    ds_read_b64_tr_b16 v[232:233], v31 offset:8
    s_waitcnt vmcnt(12) lgkmcnt(0)
    s_barrier
    s_mov_b64 s[8:9], s[56:57]
    s_add_u32 m0, s43, 73728
    s_add_u32 s41, s60, 128
    buffer_load_dwordx4 v18, s[8:11], s41 offen offset:0 nt lds
    s_add_u32 s41, s60, 8320
    buffer_load_dwordx4 v18, s[8:11], s41 offen offset:1024 nt lds
    s_add_u32 s41, s60, 16512
    buffer_load_dwordx4 v18, s[8:11], s41 offen offset:2048 nt lds
    s_add_u32 s41, s60, 24704
    buffer_load_dwordx4 v18, s[8:11], s41 offen offset:3072 nt lds
    v_add_u32 v28, 110592, v24
    v_add_u32 v29, 110592, v25
    v_add_u32 v30, 110592, v26
    v_add_u32 v31, 110592, v27
    ds_read_b64_tr_b16 v[178:179], v28 offset:0
    ds_read_b64_tr_b16 v[186:187], v28 offset:8
    ds_read_b64_tr_b16 v[194:195], v29 offset:0
    ds_read_b64_tr_b16 v[202:203], v29 offset:8
    ds_read_b64_tr_b16 v[210:211], v30 offset:0
    ds_read_b64_tr_b16 v[218:219], v30 offset:8
    ds_read_b64_tr_b16 v[226:227], v31 offset:0
    ds_read_b64_tr_b16 v[234:235], v31 offset:8
    s_waitcnt vmcnt(12) lgkmcnt(0)
    s_barrier
    s_add_u32 m0, s43, 110592
    s_add_u32 s41, s61, 128
    buffer_load_dwordx4 v18, s[8:11], s41 offen offset:0 nt lds
    s_add_u32 s41, s61, 8320
    buffer_load_dwordx4 v18, s[8:11], s41 offen offset:1024 nt lds
    s_add_u32 s41, s61, 16512
    buffer_load_dwordx4 v18, s[8:11], s41 offen offset:2048 nt lds
    s_add_u32 s41, s61, 24704
    buffer_load_dwordx4 v18, s[8:11], s41 offen offset:3072 nt lds
    v_add_u32 v28, 147456, v24
    v_add_u32 v29, 147456, v25
    v_add_u32 v30, 147456, v26
    v_add_u32 v31, 147456, v27
    ds_read_b64_tr_b16 v[180:181], v28 offset:0
    ds_read_b64_tr_b16 v[188:189], v28 offset:8
    ds_read_b64_tr_b16 v[196:197], v29 offset:0
    ds_read_b64_tr_b16 v[204:205], v29 offset:8
    ds_read_b64_tr_b16 v[212:213], v30 offset:0
    ds_read_b64_tr_b16 v[220:221], v30 offset:8
    ds_read_b64_tr_b16 v[228:229], v31 offset:0
    ds_read_b64_tr_b16 v[236:237], v31 offset:8
    s_waitcnt vmcnt(12) lgkmcnt(0)
    s_barrier
    s_add_u32 m0, s43, 147456
    s_add_u32 s41, s62, 128
    buffer_load_dwordx4 v18, s[8:11], s41 offen offset:0 nt lds
    s_add_u32 s41, s62, 8320
    buffer_load_dwordx4 v18, s[8:11], s41 offen offset:1024 nt lds
    s_add_u32 s41, s62, 16512
    buffer_load_dwordx4 v18, s[8:11], s41 offen offset:2048 nt lds
    s_add_u32 s41, s62, 24704
    buffer_load_dwordx4 v18, s[8:11], s41 offen offset:3072 nt lds
    v_add_u32 v28, 0, v24
    v_add_u32 v29, 0, v25
    v_add_u32 v30, 0, v26
    v_add_u32 v31, 0, v27
    ds_read_b64_tr_b16 v[182:183], v28 offset:0
    ds_read_b64_tr_b16 v[190:191], v28 offset:8
    ds_read_b64_tr_b16 v[198:199], v29 offset:0
    ds_read_b64_tr_b16 v[206:207], v29 offset:8
    ds_read_b64_tr_b16 v[214:215], v30 offset:0
    ds_read_b64_tr_b16 v[222:223], v30 offset:8
    ds_read_b64_tr_b16 v[230:231], v31 offset:0
    ds_read_b64_tr_b16 v[238:239], v31 offset:8
    s_waitcnt vmcnt(12) lgkmcnt(0)
    s_barrier
    s_add_u32 m0, s43, 0
    s_add_u32 s41, s63, 128
    buffer_load_dwordx4 v18, s[8:11], s41 offen offset:0 nt lds
    s_add_u32 s41, s63, 8320
    buffer_load_dwordx4 v18, s[8:11], s41 offen offset:1024 nt lds
    s_add_u32 s41, s63, 16512
    buffer_load_dwordx4 v18, s[8:11], s41 offen offset:2048 nt lds
    s_add_u32 s41, s63, 24704
    buffer_load_dwordx4 v18, s[8:11], s41 offen offset:3072 nt lds
    v_mov_b32 v78, v21
    v_mov_b32 v79, v22
    v_add_u32 v77, 36864, v20
    ds_read_b64_tr_b16 v[240:241], v77 offset:0
    ds_read_b64_tr_b16 v[242:243], v77 offset:4096
    ds_read_b64_tr_b16 v[244:245], v77 offset:8192
    ds_read_b64_tr_b16 v[246:247], v77 offset:12288
    ds_read_b64_tr_b16 v[248:249], v77 offset:8
    ds_read_b64_tr_b16 v[250:251], v77 offset:4104
    ds_read_b64_tr_b16 v[252:253], v77 offset:8200
    ds_read_b64_tr_b16 v[254:255], v77 offset:12296
    s_waitcnt vmcnt(12) lgkmcnt(0)
    s_barrier
    v_add_u32 v77, 73728, v79
    s_waitcnt lgkmcnt(0)
    ds_read_b64_tr_b16 v[0:1], v77 offset:0
    ds_read_b64_tr_b16 v[2:3], v77 offset:256
    ds_read_b64_tr_b16 v[4:5], v77 offset:2048
    ds_read_b64_tr_b16 v[6:7], v77 offset:2304
    ds_read_b64_tr_b16 v[8:9], v77 offset:16
    ds_read_b64_tr_b16 v[10:11], v77 offset:272
    ds_read_b64_tr_b16 v[12:13], v77 offset:2064
    ds_read_b64_tr_b16 v[14:15], v77 offset:2320
    s_waitcnt vmcnt(8) lgkmcnt(0)
    s_barrier
    v_add_u32 v77, 110592, v78
    ds_read_b64_tr_b16 v[16:17], v77 offset:0
    ds_read_b64_tr_b16 v[18:19], v77 offset:256
    ds_read_b64_tr_b16 v[20:21], v77 offset:2048
    ds_read_b64_tr_b16 v[22:23], v77 offset:2304
    ds_read_b64_tr_b16 v[24:25], v77 offset:16
    ds_read_b64_tr_b16 v[26:27], v77 offset:272
    ds_read_b64_tr_b16 v[28:29], v77 offset:2064
    ds_read_b64_tr_b16 v[30:31], v77 offset:2320
    s_waitcnt vmcnt(4) lgkmcnt(0)
    s_barrier
    v_add_u32 v77, 147456, v78
    ds_read_b64_tr_b16 v[32:33], v77 offset:0
    ds_read_b64_tr_b16 v[34:35], v77 offset:256
    ds_read_b64_tr_b16 v[36:37], v77 offset:2048
    ds_read_b64_tr_b16 v[38:39], v77 offset:2304
    ds_read_b64_tr_b16 v[40:41], v77 offset:16
    ds_read_b64_tr_b16 v[42:43], v77 offset:272
    ds_read_b64_tr_b16 v[44:45], v77 offset:2064
    ds_read_b64_tr_b16 v[46:47], v77 offset:2320
    s_waitcnt vmcnt(0) lgkmcnt(0)
    s_barrier
    v_add_u32 v77, 0, v78
    ds_read_b64_tr_b16 v[48:49], v77 offset:0
    ds_read_b64_tr_b16 v[50:51], v77 offset:256
    ds_read_b64_tr_b16 v[52:53], v77 offset:2048
    ds_read_b64_tr_b16 v[54:55], v77 offset:2304
    ds_read_b64_tr_b16 v[56:57], v77 offset:16
    ds_read_b64_tr_b16 v[58:59], v77 offset:272
    ds_read_b64_tr_b16 v[60:61], v77 offset:2064
    ds_read_b64_tr_b16 v[62:63], v77 offset:2320
    s_waitcnt lgkmcnt(0)
    s_barrier
    ds_write_b128 v70, v[0:3] offset:20480
    ds_write_b128 v70, v[4:7] offset:21504
    ds_write_b128 v70, v[8:11] offset:22528
    ds_write_b128 v70, v[12:15] offset:23552
    ds_write_b128 v70, v[16:19] offset:24576
    ds_write_b128 v70, v[20:23] offset:25600
    ds_write_b128 v70, v[24:27] offset:26624
    ds_write_b128 v70, v[28:31] offset:27648
    ds_write_b128 v70, v[32:35] offset:28672
    ds_write_b128 v70, v[36:39] offset:29696
    ds_write_b128 v70, v[40:43] offset:30720
    ds_write_b128 v70, v[44:47] offset:31744
    ds_write_b128 v70, v[48:51] offset:32768
    ds_write_b128 v70, v[52:55] offset:33792
    ds_write_b128 v70, v[56:59] offset:34816
    ds_write_b128 v70, v[60:63] offset:35840
    s_waitcnt lgkmcnt(0)
    v_bfe_u32 v60, v65, 4, 6
    v_and_b32 v61, 15, v60
    v_lshrrev_b32 v62, 4, v60
    v_mov_b32 v50, 0x3f80
    v_mov_b32 v51, 0x3f800000
    v_and_b32 v77, 1, v62
    v_lshlrev_b32 v77, 2, v77
    v_sub_u32 v77, v61, v77
    v_and_b32 v78, 3, v61
    v_lshlrev_b32 v78, 2, v78
    v_lshrrev_b32 v79, 2, v61
    v_add_u32 v78, v78, v79
    v_cmp_eq_u32 vcc, 0, v77
    s_nop 1
    v_cndmask_b32 v8, 0, v50, vcc
    v_cmp_eq_u32 vcc, 1, v77
    s_nop 1
    v_cndmask_b32 v8, v8, v51, vcc
    v_cmp_eq_u32 vcc, 0, v78
    s_nop 1
    v_cndmask_b32 v12, 0, v50, vcc
    v_cmp_eq_u32 vcc, 1, v78
    s_nop 1
    v_cndmask_b32 v12, v12, v51, vcc
    v_cmp_eq_u32 vcc, 2, v77
    s_nop 1
    v_cndmask_b32 v9, 0, v50, vcc
    v_cmp_eq_u32 vcc, 3, v77
    s_nop 1
    v_cndmask_b32 v9, v9, v51, vcc
    v_cmp_eq_u32 vcc, 2, v78
    s_nop 1
    v_cndmask_b32 v13, 0, v50, vcc
    v_cmp_eq_u32 vcc, 3, v78
    s_nop 1
    v_cndmask_b32 v13, v13, v51, vcc
    v_cmp_eq_u32 vcc, 8, v77
    s_nop 1
    v_cndmask_b32 v10, 0, v50, vcc
    v_cmp_eq_u32 vcc, 9, v77
    s_nop 1
    v_cndmask_b32 v10, v10, v51, vcc
    v_cmp_eq_u32 vcc, 4, v78
    s_nop 1
    v_cndmask_b32 v14, 0, v50, vcc
    v_cmp_eq_u32 vcc, 5, v78
    s_nop 1
    v_cndmask_b32 v14, v14, v51, vcc
    v_cmp_eq_u32 vcc, 10, v77
    s_nop 1
    v_cndmask_b32 v11, 0, v50, vcc
    v_cmp_eq_u32 vcc, 11, v77
    s_nop 1
    v_cndmask_b32 v11, v11, v51, vcc
    v_cmp_eq_u32 vcc, 6, v78
    s_nop 1
    v_cndmask_b32 v15, 0, v50, vcc
    v_cmp_eq_u32 vcc, 7, v78
    s_nop 1
    v_cndmask_b32 v15, v15, v51, vcc
    v_lshlrev_b32 v77, 4, v61
    ds_write_b128 v69, v[8:11] offset:15360
    ds_write_b128 v77, v[12:15] offset:15872
    s_waitcnt vmcnt(0) lgkmcnt(0)
    s_cmp_lg_u32 s95, 0
    s_cbranch_scc1 cf_hn
    s_mov_b32 s88, 4194304
gn2:
    buffer_load_dword v2, off, s[84:87], 0 offset:216 sc1
    s_waitcnt vmcnt(0)
    v_readfirstlane_b32 s95, v2
    s_sub_u32 s88, s88, 1
    s_cbranch_scc1 gn2x
    s_cmp_eq_u32 s95, 0
    s_cbranch_scc1 gn2
gn2x:
cf_hn:
    v_mov_b32 v2, 1
    s_cmp_lg_u32 s13, 0
    s_cbranch_scc1 cf_noarr
    s_mov_b64 exec, 1
    s_mov_b32 s42, 1
    v_mov_b32 v4, v76
    s_cmp_ge_u32 s94, 32
    s_cbranch_scc1 cf_have
    s_mov_b32 s40, 131072
    s_mov_b32 s42, 2
cf_startpoll:
    buffer_load_dword v3, off, s[84:87], 0 offset:132 sc1
    s_sub_u32 s40, s40, 1
    s_cbranch_scc1 cf_decide
    s_waitcnt vmcnt(0)
    v_readfirstlane_b32 s41, v3
    s_nop 1
    s_cmp_lt_u32 s41, 32
    s_cbranch_scc1 cf_startpoll
    s_mov_b32 s42, 1
cf_decide:
    v_mov_b32 v4, s42
    v_mov_b32 v5, 0
    buffer_atomic_cmpswap v[4:5], off, s[84:87], 0 offset:28 sc0
    s_waitcnt vmcnt(0)
cf_have:
    v_mov_b32 v5, s42
    v_cmp_eq_u32 vcc, 0, v4
    s_nop 1
    v_cndmask_b32 v4, v4, v5, vcc
    v_mov_b32 v5, 16192
    ds_write_b32 v5, v4
    s_waitcnt lgkmcnt(0)
    s_mov_b64 exec, -1
cf_noarr:
    s_barrier
    v_mov_b32 v5, 16192
    ds_read_b32 v4, v5
    s_waitcnt lgkmcnt(0)
    v_readfirstlane_b32 s41, v4
    s_nop 1
    s_cmp_eq_u32 s41, 1
    s_cbranch_scc1 cf_run
    v_lshrrev_b32 v0, 4, v65
    s_mov_b32 s32, s13
    s_load_dwordx16 s[48:63], s[0:1], 0
    s_waitcnt lgkmcnt(0)
    s_branch L_helper
cf_run:
    s_mov_b32 s44, 0x3e0293ee
    s_mov_b32 s45, s44
    s_or_b32 s66, s44, 0x80000000
    s_mov_b32 s48, 0x3f003f00
    s_mov_b32 s49, 0
    s_mov_b32 s50, 0x3f803f80
    s_mov_b32 s51, 0x3f803f80
    s_mov_b32 s52, 512
    s_mov_b32 s53, 1024
    s_mov_b32 s54, 1536
    s_mov_b32 s30, 0
    s_mov_b32 s37, 0
    s_lshl_b32 s47, s13, 9
    s_cmp_lg_u32 s32, 0
    s_cselect_b32 s71, s13, 3
    s_add_u32 s46, s71, 1
    s_lshr_b32 s46, s46, 1
    s_mov_b32 s14, 67125248
    s_mov_b32 s15, 67129344
    s_mov_b32 s16, 67133440
    s_mov_b32 s36, 0
    s_add_u32 s17, s68, 67108864
    s_mov_b32 s69, 0
    s_mov_b32 s70, 0
    s_lshl_b32 s26, s12, 14
    s_add_u32 s26, s26, 0
    s_mul_i32 s40, s13, 3072
    s_add_u32 s24, s26, s40
    s_lshl_b32 s96, s12, 7
    s_add_u32 s29, s96, 125845504
    s_add_u32 s96, s96, 125829120
    s_lshl_b32 s40, s12, 14
    s_add_u32 s40, s40, 68157440
    s_add_u32 s18, s40, 0
    s_add_u32 s19, s40, 4096
    s_add_u32 s20, s40, 8192
    s_add_u32 s21, s40, 12288
    s_lshr_b32 s40, s12, 3
    s_lshl_b32 s40, s40, 12
    s_and_b32 s41, s12, 7
    s_lshl_b32 s41, s41, 7
    s_add_u32 s40, s40, s41
    s_add_u32 s22, s40, 68157440
    s_add_u32 s23, s22, 1024
    s_add_u32 s25, s22, 2048
    s_mov_b32 s56, -65472
    s_cmp_lg_u32 s32, 0
    s_cselect_b64 s[38:39], -1, 0
    s_add_u32 s55, s68, 138412032
    s_cmp_eq_u32 s13, 3
    s_cselect_b64 s[100:101], 1, 0
    s_cselect_b64 s[38:39], 1, s[38:39]
    s_cselect_b32 s93, 64, 0
    s_cselect_b32 s55, s29, s55
    s_cselect_b32 s57, 0, 9216
    s_mov_b64 exec, s[100:101]
    v_mov_b32 v72, s95
    s_mov_b64 exec, -1
    s_mov_b32 s34, 0xff00ff00
    s_mov_b32 s35, 0xff00ff00
    s_lshl_b32 s28, s12, 12
    s_add_u32 s28, s28, 7340032
    s_add_u32 s27, s28, 77594624
    s_add_u32 s28, s28, 69206016
    s_cmp_ge_u32 s97, 3
    s_cbranch_scc1 cf_kvdone
    s_mov_b32 s40, 3
    v_bfe_u32 v78, v65, 2, 5
    s_mov_b32 s31, 4194304
cf_kv0:
    buffer_load_dword v77, v78, s[4:7], s96 offen offset:16 sc1
    s_waitcnt vmcnt(0)
    v_subrev_u32 v77, s95, v77
    v_cmp_lt_u32 vcc, 16, v77
    s_nop 1
    v_cndmask_b32 v77, v77, 0, vcc
    v_bfe_u32 v79, v78, 2, 2
    v_lshl_add_u32 v77, v77, 2, v79
    s_nop 1
    v_min_u32_dpp v77, v77, v77 row_ror:1 row_mask:0xf bank_mask:0xf
    s_nop 1
    v_min_u32_dpp v77, v77, v77 row_ror:2 row_mask:0xf bank_mask:0xf
    s_nop 1
    v_min_u32_dpp v77, v77, v77 row_ror:4 row_mask:0xf bank_mask:0xf
    s_nop 0
    v_readfirstlane_b32 s97, v77
    s_sub_u32 s31, s31, 1
    s_cbranch_scc1 cf_kv0_x
    s_cmp_le_u32 s40, s97
    s_cbranch_scc1 cf_kv0_x
    s_sleep 2
    s_branch cf_kv0
cf_kv0_x:
    s_add_u32 s40, s24, 0
    s_add_u32 s40, s40, s33
    s_sub_u32 s41, s96, s40
    v_bfe_u32 v77, v65, 2, 5
    v_add3_u32 v77, v77, s41, 16
    v_lshlrev_b32 v78, 3, v69
    s_nop 0
    v_mov_b32_dpp v78, v77 quad_perm:[0,1,2,3] row_mask:0xc bank_mask:0xf
    buffer_load_dword v76, v78, s[4:7], s40 offen sc1
    s_add_u32 s40, s24, 524288
    s_add_u32 s40, s40, s33
    s_sub_u32 s41, s96, s40
    v_bfe_u32 v77, v65, 2, 5
    v_add3_u32 v77, v77, s41, 16
    v_lshlrev_b32 v78, 3, v69
    s_nop 0
    v_mov_b32_dpp v78, v77 quad_perm:[0,1,2,3] row_mask:0xc bank_mask:0xf
    buffer_load_dword v76, v78, s[4:7], s40 offen sc1
cf_kvdone:
    v_mov_b64 v[0:1], 0
    v_mov_b64 v[2:3], 0
    v_mov_b64 v[4:5], 0
    v_mov_b64 v[6:7], 0
    v_mov_b64 v[8:9], 0
    v_mov_b64 v[10:11], 0
    v_mov_b64 v[12:13], 0
    v_mov_b64 v[14:15], 0
    v_mov_b64 v[16:17], 0
    v_mov_b64 v[18:19], 0
    v_mov_b64 v[20:21], 0
    v_mov_b64 v[22:23], 0
    ds_read_b128 v[44:47], v70 offset:0
    ds_read_b128 v[48:51], v70 offset:1024
    ds_read_b128 v[52:55], v70 offset:2048
    ds_read_b128 v[56:59], v70 offset:3072
    ds_read_b128 v[24:27], v70 offset:4096
    ds_read_b128 v[28:31], v70 offset:5120
    ds_read_b128 v[32:35], v70 offset:6144
    ds_read_b128 v[36:39], v70 offset:7168
    buffer_load_dwordx4 v[40:43], v65, s[4:7], s14 offen offset:0 nt
    buffer_load_dwordx4 v[60:63], v66, s[4:7], s14 offen offset:0 nt
    s_mov_b32 s31, 1048576
    s_waitcnt vmcnt(0) lgkmcnt(0)
    s_branch cf_goA
cf_loop:
    s_mov_b32 s31, 1048576
    s_mov_b32 s69, s70
    s_waitcnt lgkmcnt(0)
cf_cA:
    buffer_load_dwordx4 v[40:43], v65, s[4:7], s14 offen offset:0 nt
    buffer_load_dwordx4 v[60:63], v66, s[4:7], s14 offen offset:0 nt
cf_cA1:
    v_bitop3_b32 v77, v40, v60, s70 bitop3:0x7e
    v_and_b32 v77, 1, v77
    v_cmp_ne_u32 vcc, 0, v77
    s_cbranch_vccz cf_goA
    v_bitop3_b32 v77, v40, v60, s70 bitop3:0x7e
    v_and_b32 v77, 1, v77
    v_cmp_ne_u32 vcc, 0, v77
    s_cbranch_vccz cf_goA
    v_bitop3_b32 v77, v40, v60, s70 bitop3:0x7e
    v_and_b32 v77, 1, v77
    v_cmp_ne_u32 vcc, 0, v77
    s_cbranch_vccz cf_goA
    v_bitop3_b32 v77, v40, v60, s70 bitop3:0x7e
    v_and_b32 v77, 1, v77
    v_cmp_ne_u32 vcc, 0, v77
    s_cbranch_vccz cf_goA
    buffer_load_dwordx4 v[40:43], v65, s[4:7], s14 offen offset:0 nt
    buffer_load_dwordx4 v[60:63], v66, s[4:7], s14 offen offset:0 nt
    v_bitop3_b32 v77, v40, v60, s70 bitop3:0x7e
    v_and_b32 v77, 1, v77
    v_cmp_ne_u32 vcc, 0, v77
    s_cbranch_vccz cf_goA
    v_bitop3_b32 v77, v40, v60, s70 bitop3:0x7e
    v_and_b32 v77, 1, v77
    v_cmp_ne_u32 vcc, 0, v77
    s_cbranch_vccz cf_goA
    v_bitop3_b32 v77, v40, v60, s70 bitop3:0x7e
    v_and_b32 v77, 1, v77
    v_cmp_ne_u32 vcc, 0, v77
    s_cbranch_vccz cf_goA
    v_bitop3_b32 v77, v40, v60, s70 bitop3:0x7e
    v_and_b32 v77, 1, v77
    v_cmp_ne_u32 vcc, 0, v77
    s_cbranch_vccz cf_goA
    buffer_load_dwordx4 v[40:43], v65, s[4:7], s14 offen offset:0 nt
    buffer_load_dwordx4 v[60:63], v66, s[4:7], s14 offen offset:0 nt
    v_bitop3_b32 v77, v40, v60, s70 bitop3:0x7e
    v_and_b32 v77, 1, v77
    v_cmp_ne_u32 vcc, 0, v77
    s_cbranch_vccz cf_goA
    v_bitop3_b32 v77, v40, v60, s70 bitop3:0x7e
    v_and_b32 v77, 1, v77
    v_cmp_ne_u32 vcc, 0, v77
    s_cbranch_vccz cf_goA
    v_bitop3_b32 v77, v40, v60, s70 bitop3:0x7e
    v_and_b32 v77, 1, v77
    v_cmp_ne_u32 vcc, 0, v77
    s_cbranch_vccz cf_goA
    v_bitop3_b32 v77, v40, v60, s70 bitop3:0x7e
    v_and_b32 v77, 1, v77
    v_cmp_ne_u32 vcc, 0, v77
    s_cbranch_vccz cf_goA
    buffer_load_dwordx4 v[40:43], v65, s[4:7], s14 offen offset:0 nt
    buffer_load_dwordx4 v[60:63], v66, s[4:7], s14 offen offset:0 nt
    v_bitop3_b32 v77, v40, v60, s70 bitop3:0x7e
    v_and_b32 v77, 1, v77
    v_cmp_ne_u32 vcc, 0, v77
    s_cbranch_vccz cf_goA
    v_bitop3_b32 v77, v40, v60, s70 bitop3:0x7e
    v_and_b32 v77, 1, v77
    v_cmp_ne_u32 vcc, 0, v77
    s_cbranch_vccz cf_goA
    v_bitop3_b32 v77, v40, v60, s70 bitop3:0x7e
    v_and_b32 v77, 1, v77
    v_cmp_ne_u32 vcc, 0, v77
    s_cbranch_vccz cf_goA
    v_bitop3_b32 v77, v40, v60, s70 bitop3:0x7e
    v_and_b32 v77, 1, v77
    v_cmp_ne_u32 vcc, 0, v77
    s_cbranch_vccz cf_goA
    s_sub_u32 s31, s31, 64
    s_cbranch_scc0 cf_cA
cf_goA:
    ds_write_b128 v65, v[40:43] offset:0
    v_smfmac_f32_16x16x64_bf16 v[0:3], v[40:43], v[44:51], v64
    v_smfmac_f32_16x16x64_bf16 v[4:7], v[40:43], v[52:59], v64
    buffer_load_dwordx4 v[44:47], v65, s[4:7], s15 offen offset:0 nt
    v_smfmac_f32_16x16x64_bf16 v[0:3], v[60:63], v[24:31], v64
    s_add_u32 s40, s24, 1048576
    s_add_u32 s40, s40, s33
    s_sub_u32 s41, s96, s40
    v_smfmac_f32_16x16x64_bf16 v[4:7], v[60:63], v[32:39], v64
    ds_read_b128 v[24:27], v70 offset:8192
    s_cmp_lt_u32 s97, s93
    s_cselect_b32 s41, s41, 0
    v_smfmac_f32_16x16x64_bf16 v[8:11], v[40:43], a[96:103], v64
    ds_read_b128 v[28:31], v70 offset:9216
    v_smfmac_f32_16x16x64_bf16 v[12:15], v[40:43], a[104:111], v64
    ds_read_b128 v[32:35], v70 offset:10240
    s_waitcnt lgkmcnt(3)
    s_barrier
    ds_read_b128 v[48:51], v67 offset:0
    v_smfmac_f32_16x16x64_bf16 v[8:11], v[60:63], a[112:119], v64
    ds_read_b128 v[36:39], v70 offset:11264
    v_bitop3_b32 v79, v73, -9, s54 bitop3:0x6a
    v_smfmac_f32_16x16x64_bf16 v[12:15], v[60:63], a[120:127], v64
    buffer_load_dwordx4 v[44:47], v65, s[4:7], s15 offen offset:0 nt
    v_smfmac_f32_16x16x64_bf16 v[16:19], v[40:43], a[232:239], v64
    ds_read_b128 v[52:55], v68 offset:0
    s_waitcnt lgkmcnt(4)
    v_bfe_u32 v77, v65, 2, 5
    v_smfmac_f32_16x16x64_bf16 v[20:23], v[40:43], v[24:31], v64
    ds_read_b128 v[24:27], v70 offset:12288
    s_waitcnt lgkmcnt(3)
    v_smfmac_f32_16x16x64_bf16 v[0:3], v[48:51], a[0:7], v64
    ds_read_b128 v[28:31], v70 offset:13312
    s_waitcnt lgkmcnt(3)
    v_add3_u32 v77, v77, s41, 16
    v_smfmac_f32_16x16x64_bf16 v[4:7], v[48:51], v[32:39], v64
    buffer_load_dwordx4 v[40:43], v65, s[4:7], s16 offen offset:0 nt
    v_smfmac_f32_16x16x64_bf16 v[16:19], v[60:63], a[240:247], v64
    ds_read_b128 v[32:35], v70 offset:14336
    v_lshlrev_b32 v78, 3, v69
    v_smfmac_f32_16x16x64_bf16 v[20:23], v[60:63], a[248:255], v64
    ds_read_b128 v[36:39], v70 offset:15360
    v_smfmac_f32_16x16x64_bf16 v[8:11], v[48:51], a[128:135], v64
    s_waitcnt vmcnt(2)
    v_mov_b32_dpp v78, v77 quad_perm:[0,1,2,3] row_mask:0xc bank_mask:0xf
    v_smfmac_f32_16x16x64_bf16 v[12:15], v[48:51], a[136:143], v64
    buffer_load_dwordx4 v[58:61], v65, s[4:7], s24 offen offset:3072 sc1
    s_waitcnt lgkmcnt(2)
    v_and_b32 v77, s36, v44
    v_smfmac_f32_16x16x64_bf16 v[12:15], v[52:55], v[24:31], v64
    ds_write_b128 v65, v[44:47] offset:4096
    v_smfmac_f32_16x16x64_bf16 v[0:3], v[52:55], a[8:15], v64
    v_cmp_ne_u32 vcc, s70, v77
    v_smfmac_f32_16x16x64_bf16 v[8:11], v[52:55], a[144:151], v64
    s_waitcnt lgkmcnt(1)
    v_smfmac_f32_16x16x64_bf16 v[4:7], v[52:55], v[32:39], v64
    s_cbranch_vccnz cf_spinB
cf_backB:
    v_smfmac_f32_16x16x64_bf16 v[16:19], v[44:47], v[176:183], v64
    buffer_load_dwordx4 v[24:27], v65, s[4:7], s24 offen offset:0 sc1
    s_waitcnt lgkmcnt(0)
    s_barrier
    ds_read_b128 v[48:51], v66 offset:4096
    v_smfmac_f32_16x16x64_bf16 v[12:15], v[44:47], a[160:167], v64
    ds_read_b128 v[52:55], v67 offset:4096
    v_smfmac_f32_16x16x64_bf16 v[0:3], v[44:47], a[16:23], v64
    v_smfmac_f32_16x16x64_bf16 v[8:11], v[44:47], a[152:159], v64
    buffer_load_dwordx4 v[28:31], v65, s[4:7], s24 offen offset:1024 sc1
    v_smfmac_f32_16x16x64_bf16 v[4:7], v[44:47], a[24:31], v64
    s_waitcnt vmcnt(4)
    v_smfmac_f32_16x16x64_bf16 v[20:23], v[44:47], v[184:191], v64
    ds_read_b128 v[44:47], v68 offset:4096
    s_waitcnt lgkmcnt(2)
    v_smfmac_f32_16x16x64_bf16 v[0:3], v[48:51], a[32:39], v64
    v_smfmac_f32_16x16x64_bf16 v[8:11], v[48:51], a[168:175], v64
    buffer_load_dwordx4 v[34:37], v65, s[4:7], s24 offen offset:2048 sc1
    v_smfmac_f32_16x16x64_bf16 v[4:7], v[48:51], a[40:47], v64
    s_waitcnt vmcnt(4)
    v_and_b32 v77, s36, v40
    v_smfmac_f32_16x16x64_bf16 v[12:15], v[48:51], a[176:183], v64
    ds_read_b128 v[48:51], v69 offset:15360
    v_cmp_ne_u32 vcc, s70, v77
    v_smfmac_f32_16x16x64_bf16 v[0:3], v[52:55], a[48:55], v64
    s_waitcnt lgkmcnt(1)
    v_smfmac_f32_16x16x64_bf16 v[8:11], v[52:55], a[184:191], v64
    s_cbranch_vccnz cf_spin8
cf_back8:
    v_smfmac_f32_16x16x64_bf16 v[0:3], v[44:47], a[64:71], v64
    buffer_load_dword v76, v78, s[4:7], s40 offen sc1
    v_smfmac_f32_16x16x64_bf16 v[8:11], v[44:47], a[200:207], v64
    v_smfmac_f32_16x16x64_bf16 v[0:3], v[40:43], a[80:87], v64
    s_nop 1
    v_smfmac_f32_16x16x64_bf16 v[8:11], v[40:43], a[216:223], v64
    s_nop 1
    v_lshrrev_b32 v77, 1, v69
    v_smfmac_f32_16x16x64_bf16 v[4:7], v[52:55], a[56:63], v64
    s_nop 1
    v_cvt_pk_bf16_f32 v0, v0, v1
    v_smfmac_f32_16x16x64_bf16 v[12:15], v[52:55], a[192:199], v64
    s_nop 1
    v_cvt_pk_bf16_f32 v1, v2, v3
    v_smfmac_f32_16x16x64_bf16 v[4:7], v[44:47], a[72:79], v64
    s_nop 1
    v_cvt_pk_bf16_f32 v2, v8, v9
    v_smfmac_f32_16x16x64_bf16 v[12:15], v[44:47], a[208:215], v64
    s_nop 1
    v_cvt_pk_bf16_f32 v3, v10, v11
    v_smfmac_f32_16x16x64_bf16 v[4:7], v[40:43], a[88:95], v64
    s_waitcnt lgkmcnt(0)
    s_nop 0
    s_nop 0
    v_smfmac_f32_16x16x64_bf16 v[12:15], v[40:43], a[224:231], v64
    s_nop 2
    v_mfma_f32_16x16x32_bf16 v[8:11], v[0:3], v[48:51], 0
    s_nop 0
    v_cvt_pk_bf16_f32 v4, v4, v5
    v_cvt_pk_bf16_f32 v5, v6, v7
    s_nop 0
    v_cvt_pk_bf16_f32 v6, v12, v13
    v_cvt_pk_bf16_f32 v7, v14, v15
    s_nop 1
    v_mfma_f32_16x16x32_bf16 v[12:15], v[4:7], v[48:51], 0
    ds_read_b128 v[48:51], v66 offset:4096
    v_cvt_pk_bf16_f32 v0, v8, v9
    v_cvt_pk_bf16_f32 v1, v10, v11
    v_smfmac_f32_16x16x64_bf16 v[16:19], v[52:55], v[208:215], v64
    s_waitcnt vmcnt(2)
    s_nop 2
    v_cvt_pk_bf16_f32 v2, v12, v13
    v_cvt_pk_bf16_f32 v3, v14, v15
    s_nop 1
    v_mfma_f32_16x16x32_bf16 v[12:15], v[0:3], v[0:3], 0
    s_nop 1
    v_bitop3_b32 v78, v73, -9, s53 bitop3:0x6a
    v_mfma_f32_16x16x32_bf16 v[4:7], v[24:27], v[0:3], 0
    ds_read_b128 v[24:27], v67 offset:0
    s_nop 1
    v_mfma_f32_16x16x32_bf16 v[8:11], v[28:31], v[0:3], 0
    s_nop 0
    v_mov_b32_dpp v12, v14 row_ror:8 row_mask:0xf bank_mask:0xc
    v_mov_b32_dpp v13, v15 row_ror:8 row_mask:0xf bank_mask:0xc
    v_smfmac_f32_16x16x64_bf16 v[20:23], v[52:55], v[216:223], v64
    ds_write_b64 v71, v[12:13]
    ds_read_b128 v[52:55], v68 offset:0
    s_nop 1
    v_mov_b32_dpp v4, v8 row_ror:8 row_mask:0xf bank_mask:0xc
    v_mov_b32_dpp v5, v9 row_ror:8 row_mask:0xf bank_mask:0xc
    v_mov_b32_dpp v6, v10 row_ror:8 row_mask:0xf bank_mask:0xc
    v_mov_b32_dpp v7, v11 row_ror:8 row_mask:0xf bank_mask:0xc
    v_smfmac_f32_16x16x64_bf16 v[16:19], v[44:47], v[224:231], v64
    ds_write_b128 v65, v[4:7] offset:8192
    v_smfmac_f32_16x16x64_bf16 v[20:23], v[44:47], v[232:239], v64
    s_waitcnt lgkmcnt(3)
    v_smfmac_f32_16x16x64_bf16 v[16:19], v[24:27], v[144:151], v64
    s_waitcnt vmcnt(1)
    v_smfmac_f32_16x16x64_bf16 v[20:23], v[24:27], v[152:159], v64
    s_mov_b64 exec, s[38:39]
    buffer_store_dword v72, v75, s[4:7], s55 offen sc1
    s_mov_b64 exec, -1
    v_smfmac_f32_16x16x64_bf16 v[16:19], v[40:43], v[240:247], v64
    s_cmp_ge_u32 s30, 56
    s_waitcnt lgkmcnt(0)
    s_barrier
    ds_read_b128 v[8:11], v66 offset:8192
    v_smfmac_f32_16x16x64_bf16 v[20:23], v[40:43], v[248:255], v64
    ds_read_b128 v[12:15], v67 offset:8192
    v_smfmac_f32_16x16x64_bf16 v[16:19], v[48:51], v[192:199], v64
    ds_read_b128 v[44:47], v68 offset:8192
    v_smfmac_f32_16x16x64_bf16 v[20:23], v[48:51], v[200:207], v64
    ds_read_b64 v[24:25], v77 offset:14336
    ds_read_b64 v[26:27], v77 offset:14592
    v_smfmac_f32_16x16x64_bf16 v[16:19], v[52:55], v[160:167], v64
    ds_read_b64 v[28:29], v77 offset:14848
    ds_read_b64 v[30:31], v77 offset:15104
    v_bitop3_b32 v77, v73, -9, s52 bitop3:0x6a
    v_smfmac_f32_16x16x64_bf16 v[20:23], v[52:55], v[168:175], v64
    s_cbranch_scc1 cf_rare
cf_rare_x:
    ds_read_b128 v[48:51], v70 offset:22528
    ds_read_b128 v[52:55], v70 offset:23552
    s_waitcnt lgkmcnt(6)
    v_pk_add_f32 v[4:5], v[4:5], v[8:9]
    v_pk_add_f32 v[6:7], v[6:7], v[10:11]
    v_pk_add_f32 v[12:13], v[12:13], v[44:45]
    v_pk_add_f32 v[14:15], v[14:15], v[46:47]
    v_pk_add_f32 v[4:5], v[4:5], v[12:13]
    v_pk_add_f32 v[6:7], v[6:7], v[14:15]
    s_waitcnt lgkmcnt(2)
    v_pk_add_f32 v[24:25], v[24:25], v[26:27]
    v_pk_add_f32 v[28:29], v[28:29], v[30:31]
    v_max3_f32 v8, v4, v5, v6
    v_pk_add_f32 v[24:25], v[24:25], v[28:29]
    v_max_f32 v8, v8, v7
    v_max3_f32 v8, v8, v24, v25
    v_cvt_pk_bf16_f32 v32, v16, v17
    v_cvt_pk_bf16_f32 v38, v18, v19
    v_max_f32_dpp v8, v8, v8 row_ror:8 row_mask:0xf bank_mask:0xf
    v_mov_b32 v9, v8
    v_cvt_pk_bf16_f32 v56, v20, v21
    v_cvt_pk_bf16_f32 v62, v22, v23
    v_permlane32_swap_b32 v8, v9
    v_max_f32 v8, v8, v9
    v_mov_b32 v9, v8
    v_mov_b32 v11, 0
    v_mov_b32 v15, 0
    v_permlane16_swap_b32 v8, v9
    v_max_f32 v8, v8, v9
    v_mul_f32 v8, s66, v8
    v_pk_fma_f32 v[4:5], v[4:5], s[44:45], v[8:9] op_sel_hi:[1,1,0]
    v_pk_fma_f32 v[6:7], v[6:7], s[44:45], v[8:9] op_sel_hi:[1,1,0]
    v_pk_fma_f32 v[24:25], v[24:25], s[44:45], v[8:9] op_sel_hi:[1,1,0]
    v_exp_f32 v4, v4
    v_exp_f32 v5, v5
    v_exp_f32 v6, v6
    v_exp_f32 v7, v7
    v_exp_f32 v24, v24
    v_exp_f32 v25, v25
    v_cvt_pk_bf16_f32 v12, v4, v5
    v_cvt_pk_bf16_f32 v13, v6, v7
    v_cvt_pk_bf16_f32 v10, v24, v25
    v_cvt_pk_bf16_f32 v14, v24, v25
    v_mov_b64 v[0:1], s[48:49]
    v_mfma_f32_16x16x32_bf16 v[4:7], v[32:35], v[10:13], 0
    ds_read_b128 v[40:43], v70 offset:20480
    v_mov_b64 v[2:3], s[50:51]
    v_mfma_f32_16x16x32_bf16 v[24:27], v[36:39], v[12:15], 0
    ds_read_b128 v[44:47], v70 offset:21504
    v_mov_b64 v[8:9], 0
    v_mfma_f32_16x16x32_bf16 v[28:31], v[0:3], v[10:13], 0
    ds_read_b128 v[32:35], v70 offset:24576
    v_mov_b64 v[0:1], 0
    v_mfma_f32_16x16x32_bf16 v[16:19], v[56:59], v[10:13], 0
    ds_read_b128 v[36:39], v70 offset:25600
    v_mov_b64 v[2:3], 0
    v_mfma_f32_16x16x32_bf16 v[20:23], v[60:63], v[12:15], 0
    ds_read_b128 v[56:59], v70 offset:28672
    v_add_f32_dpp v4, v24, v4 row_ror:8 row_mask:0xf bank_mask:0xf
    v_add_f32_dpp v5, v25, v5 row_ror:8 row_mask:0xf bank_mask:0xf
    v_add_f32_dpp v6, v26, v6 row_ror:8 row_mask:0xf bank_mask:0xf
    v_add_f32_dpp v7, v27, v7 row_ror:8 row_mask:0xf bank_mask:0xf
    v_add_f32_dpp v29, v28, v28 row_ror:8 row_mask:0xf bank_mask:0xf
    v_rcp_f32 v28, v29
    v_mov_b64 v[10:11], 0
    v_add_f32_dpp v4, v16, v20 row_ror:8 row_mask:0xf bank_mask:0xc
    v_add_f32_dpp v5, v17, v21 row_ror:8 row_mask:0xf bank_mask:0xc
    v_add_f32_dpp v6, v18, v22 row_ror:8 row_mask:0xf bank_mask:0xc
    v_add_f32_dpp v7, v19, v23 row_ror:8 row_mask:0xf bank_mask:0xc
    v_pk_mul_f32 v[4:5], v[4:5], v[28:29] op_sel_hi:[1,0]
    v_pk_mul_f32 v[6:7], v[6:7], v[28:29] op_sel_hi:[1,0]
    v_cvt_pk_bf16_f32 v4, v4, v5
    v_cvt_pk_bf16_f32 v5, v6, v7
    ds_write_b64 v73, v[4:5] offset:12288
    v_mov_b32_dpp v6, v4 row_ror:8 row_mask:0xf bank_mask:0xf
    v_mov_b32_dpp v7, v5 row_ror:8 row_mask:0xf bank_mask:0xf
    v_mov_b64 v[12:13], 0
    v_mov_b64 v[14:15], 0
    v_smfmac_f32_16x16x64_bf16 v[8:11], v[4:7], v[80:87], v64
    s_waitcnt lgkmcnt(4)
    v_mov_b64 v[24:25], 0
    v_smfmac_f32_16x16x64_bf16 v[0:3], v[4:7], v[40:47], v64
    ds_read_b128 v[60:63], v70 offset:29696
    v_mov_b64 v[26:27], 0
    v_smfmac_f32_16x16x64_bf16 v[12:15], v[4:7], v[112:119], v64
    s_waitcnt lgkmcnt(1)
    s_barrier
    ds_read_b128 v[16:19], v77 offset:12288
    v_smfmac_f32_16x16x64_bf16 v[24:27], v[4:7], v[48:55], v64
    ds_read_b128 v[20:23], v78 offset:12288
    ds_read_b128 v[28:31], v79 offset:12288
    v_mov_b64 v[4:5], 0
    v_mov_b64 v[6:7], 0
    v_bfe_u32 v77, v74, 16, 1
    v_mad_i32_i24 v77, v77, s56, v74
    s_waitcnt lgkmcnt(2)
    v_smfmac_f32_16x16x64_bf16 v[8:11], v[16:19], v[88:95], v64
    ds_read_b128 v[40:43], v70 offset:32768
    s_waitcnt lgkmcnt(2)
    v_smfmac_f32_16x16x64_bf16 v[8:11], v[20:23], v[96:103], v64
    ds_read_b128 v[44:47], v70 offset:33792
    s_waitcnt lgkmcnt(2)
    v_smfmac_f32_16x16x64_bf16 v[8:11], v[28:31], v[104:111], v64
    ds_read_b128 v[48:51], v70 offset:26624
    s_nop 0
    v_and_b32 v72, 8, v73
    v_smfmac_f32_16x16x64_bf16 v[0:3], v[16:19], v[32:39], v64
    ds_read_b128 v[52:55], v70 offset:27648
    s_nop 0
    v_mad_u32_u24 v72, v72, 63, v73
    v_smfmac_f32_16x16x64_bf16 v[12:15], v[16:19], v[120:127], v64
    ds_read_b128 v[32:35], v70 offset:30720
    v_cvt_pk_bf16_f32 v8, v8, v9
    v_cvt_pk_bf16_f32 v9, v10, v11
    v_and_or_b32 v8, v8, -2, s69
    v_smfmac_f32_16x16x64_bf16 v[12:15], v[20:23], v[128:135], v64
    buffer_store_dwordx2 v[8:9], v74, s[4:7], s22 offen offset:0
    ds_read_b128 v[36:39], v70 offset:31744
    v_smfmac_f32_16x16x64_bf16 v[12:15], v[28:31], v[136:143], v64
    s_add_u32 s30, s30, 1
    s_xor_b32 s70, s70, 1
    v_subrev_u32 v72, s47, v72
    v_smfmac_f32_16x16x64_bf16 v[0:3], v[20:23], v[56:63], v64
    ds_read_b128 v[56:59], v70 offset:34816
    s_waitcnt lgkmcnt(3)
    s_nop 0
    v_smfmac_f32_16x16x64_bf16 v[0:3], v[28:31], v[40:47], v64
    ds_read_b128 v[60:63], v70 offset:35840
    v_cvt_pk_bf16_f32 v12, v12, v13
    v_cvt_pk_bf16_f32 v13, v14, v15
    v_and_or_b32 v12, v12, -2, s69
    v_smfmac_f32_16x16x64_bf16 v[24:27], v[16:19], v[48:55], v64
    buffer_store_dwordx2 v[12:13], v74, s[4:7], s22 offen offset:64
    s_waitcnt lgkmcnt(2)
    v_smfmac_f32_16x16x64_bf16 v[24:27], v[20:23], v[32:39], v64
    ds_read_b128 v[40:43], v70 offset:16384
    v_cvt_pk_bf16_f32 v0, v0, v1
    v_cvt_pk_bf16_f32 v1, v2, v3
    v_and_or_b32 v0, v0, -2, s69
    s_waitcnt lgkmcnt(1)
    v_smfmac_f32_16x16x64_bf16 v[24:27], v[28:31], v[56:63], v64
    buffer_store_dwordx2 v[0:1], v74, s[4:7], s23 offen offset:0
    ds_read_b128 v[44:47], v70 offset:17408
    ds_read_b128 v[8:11], v72 offset:12288
    ds_read_b128 v[48:51], v70 offset:18432
    ds_read_b128 v[52:55], v70 offset:19456
    ds_read_b128 v[12:15], v72 offset:13312
    s_cmp_lg_u32 s71, 0
    s_nop 0
    v_cvt_pk_bf16_f32 v24, v24, v25
    v_cvt_pk_bf16_f32 v25, v26, v27
    v_and_or_b32 v24, v24, -2, s69
    buffer_store_dwordx2 v[24:25], v74, s[4:7], s23 offen offset:64
    s_waitcnt lgkmcnt(3)
    v_smfmac_f32_16x16x64_bf16 v[4:7], v[8:11], v[40:47], v64
    s_waitcnt lgkmcnt(0)
    v_smfmac_f32_16x16x64_bf16 v[4:7], v[12:15], v[48:55], v64
    s_nop 7
    v_cvt_pk_bf16_f32 v4, v4, v5
    v_cvt_pk_bf16_f32 v5, v6, v7
    v_and_or_b32 v4, v4, -2, s69
    buffer_store_dwordx2 v[4:5], v77, s[4:7], s25 offen offset:0
    s_nop 0
    s_cbranch_scc1 cf_e1
    s_cmp_lg_u32 s37, 0
    s_cbranch_scc1 cf_f0_xt
cf_f0_xtx:
    s_nop 2
    v_mov_b32 v79, v79
    s_nop 2
    v_mov_b32 v79, v79
    s_nop 2
    v_mov_b32 v79, v79
    s_nop 2
    v_mov_b32 v79, v79
    s_nop 2
    v_mov_b32 v79, v79
    buffer_load_dwordx4 v[8:11], v65, s[4:7], s18 offen nt
    buffer_load_dwordx4 v[12:15], v65, s[4:7], s19 offen nt
    buffer_load_dwordx4 v[16:19], v65, s[4:7], s20 offen nt
    buffer_load_dwordx4 v[20:23], v65, s[4:7], s21 offen nt
    v_and_b32 v77, 255, v69
    ds_read_b128 v[4:7], v77 offset:15872
    ds_read_b128 v[44:47], v70 offset:0
    ds_read_b128 v[48:51], v70 offset:1024
    ds_read_b128 v[52:55], v70 offset:2048
    ds_read_b128 v[56:59], v70 offset:3072
    ds_read_b128 v[24:27], v70 offset:4096
    ds_read_b128 v[28:31], v70 offset:5120
    ds_read_b128 v[32:35], v70 offset:6144
    ds_read_b128 v[36:39], v70 offset:7168
    s_mov_b32 s31, 65536
    s_add_u32 s24, s24, 524288
    s_add_u32 s26, s26, 524288
    s_add_u32 s55, s55, s57
    s_mov_b32 s14, 67108864
    s_mov_b32 s15, 67112960
    s_mov_b32 s16, 67117056
    s_mov_b32 s36, 1
    v_mov_b32 v40, s69
    v_mov_b32 v60, s69
    v_and_b32 v79, 12, v75
    v_cmp_eq_u32 vcc, 0, v79
    s_nop 1
    v_cndmask_b32 v79, 0, 1, vcc
    s_waitcnt lgkmcnt(0)
    s_waitcnt vmcnt(3)
    v_xor_b32 v77, s69, v8
    v_mfma_f32_16x16x32_bf16 v[0:3], v[4:7], v[8:11], 0
    v_mov_b64 v[8:9], 0
    v_mov_b64 v[10:11], 0
    s_waitcnt vmcnt(2)
    v_bitop3_b32 v77, v77, v12, s69 bitop3:0xf6
    v_mfma_f32_16x16x32_bf16 v[0:3], v[4:7], v[12:15], v[0:3]
    v_mov_b64 v[12:13], 0
    v_mov_b64 v[14:15], 0
    s_waitcnt vmcnt(1)
    v_bitop3_b32 v77, v77, v16, s69 bitop3:0xf6
    v_mfma_f32_16x16x32_bf16 v[0:3], v[4:7], v[16:19], v[0:3]
    v_mov_b64 v[16:17], 0
    v_mov_b64 v[18:19], 0
    s_waitcnt vmcnt(0)
    v_bitop3_b32 v77, v77, v20, s69 bitop3:0xf6
    v_mfma_f32_16x16x32_bf16 v[0:3], v[4:7], v[20:23], v[0:3]
    v_and_b32 v77, 1, v77
    v_cmp_ne_u32 vcc, 0, v77
    v_mov_b64 v[20:21], 0
    v_mov_b64 v[22:23], 0
    s_cmp_eq_u64 vcc, 0
    s_cselect_b64 s[42:43], -1, 0
    s_nop 1
    v_add_f32_dpp v0, v0, v0 row_ror:8 row_mask:0xf bank_mask:0xf
    v_add_f32_dpp v1, v1, v1 row_ror:8 row_mask:0xf bank_mask:0xf
    s_mov_b64 exec, s[42:43]
    v_cvt_pk_bf16_f32 v72, v0, v1
    v_bfi_b32 v72, v79, s70, v72
    buffer_store_dword v72, v75, s[4:7], s17 offen offset:0
    s_mov_b64 exec, -1
    s_cbranch_scc0 cf_f0_retry
cf_f0_go:
    v_mov_b64 v[0:1], 0
    v_mov_b64 v[2:3], 0
    v_mov_b64 v[4:5], 0
    v_mov_b64 v[6:7], 0
    s_nop 2
    v_mov_b32 v79, v79
    s_nop 2
    v_mov_b32 v79, v79
    s_nop 2
    v_mov_b32 v79, v79
    s_nop 2
    v_mov_b32 v79, v79
    s_branch cf_loop
cf_e1:
    s_cmp_lg_u32 s71, 2
    s_cbranch_scc1 cf_f1
    v_and_b32 v77, 255, v69
    ds_read_b128 v[4:7], v77 offset:15872
    ds_read_b128 v[44:47], v70 offset:0
    ds_read_b128 v[48:51], v70 offset:1024
    ds_read_b128 v[52:55], v70 offset:2048
    ds_read_b128 v[56:59], v70 offset:3072
    ds_read_b128 v[24:27], v70 offset:4096
    ds_read_b128 v[28:31], v70 offset:5120
    ds_read_b128 v[32:35], v70 offset:6144
    ds_read_b128 v[36:39], v70 offset:7168
    s_mov_b32 s31, 65536
    s_add_u32 s24, s24, 524288
    s_add_u32 s26, s26, 524288
    s_add_u32 s55, s55, s57
    s_mov_b32 s14, 67108864
    s_mov_b32 s15, 67112960
    s_mov_b32 s16, 67117056
    s_mov_b32 s36, 1
    v_mov_b32 v40, s69
    v_mov_b32 v60, s69
    v_and_b32 v79, 12, v75
    v_cmp_eq_u32 vcc, 0, v79
    s_nop 1
    v_cndmask_b32 v79, 0, 1, vcc
    s_cmp_lg_u32 s37, 0
    s_cbranch_scc1 cf_f2_xt
cf_f2_xtx:
    s_nop 2
    v_mov_b32 v79, v79
    s_nop 2
    v_mov_b32 v79, v79
    s_nop 2
    v_mov_b32 v79, v79
    s_nop 2
    v_mov_b32 v79, v79
    s_nop 2
    v_mov_b32 v79, v79
    s_nop 2
    v_mov_b32 v79, v79
    s_nop 2
    v_mov_b32 v79, v79
    s_nop 2
    v_mov_b32 v79, v79
    s_waitcnt vmcnt(0)
    buffer_load_dwordx4 v[8:11], v65, s[4:7], s18 offen nt
    buffer_load_dwordx4 v[12:15], v65, s[4:7], s19 offen nt
    buffer_load_dwordx4 v[16:19], v65, s[4:7], s20 offen nt
    buffer_load_dwordx4 v[20:23], v65, s[4:7], s21 offen nt
    s_nop 2
    v_mov_b32 v79, v79
    s_nop 2
    v_mov_b32 v79, v79
    s_nop 2
    v_mov_b32 v79, v79
    s_nop 2
    v_mov_b32 v79, v79
    s_nop 2
    v_mov_b32 v79, v79
    s_nop 2
    v_mov_b32 v79, v79
    s_nop 2
    v_mov_b32 v79, v79
    s_nop 2
    v_mov_b32 v79, v79
    s_nop 2
    v_mov_b32 v79, v79
    s_nop 2
    v_mov_b32 v79, v79
    buffer_load_dwordx4 v[40:43], v65, s[4:7], s14 offen offset:0 nt
    buffer_load_dwordx4 v[60:63], v66, s[4:7], s14 offen offset:0 nt
    s_waitcnt lgkmcnt(0)
    s_waitcnt vmcnt(5)
    v_xor_b32 v77, s69, v8
    v_mfma_f32_16x16x32_bf16 v[0:3], v[4:7], v[8:11], 0
    v_mov_b64 v[8:9], 0
    v_mov_b64 v[10:11], 0
    s_waitcnt vmcnt(4)
    v_bitop3_b32 v77, v77, v12, s69 bitop3:0xf6
    v_mfma_f32_16x16x32_bf16 v[0:3], v[4:7], v[12:15], v[0:3]
    v_mov_b64 v[12:13], 0
    v_mov_b64 v[14:15], 0
    s_waitcnt vmcnt(3)
    v_bitop3_b32 v77, v77, v16, s69 bitop3:0xf6
    v_mfma_f32_16x16x32_bf16 v[0:3], v[4:7], v[16:19], v[0:3]
    v_mov_b64 v[16:17], 0
    v_mov_b64 v[18:19], 0
    s_waitcnt vmcnt(2)
    v_bitop3_b32 v77, v77, v20, s69 bitop3:0xf6
    v_mfma_f32_16x16x32_bf16 v[0:3], v[4:7], v[20:23], v[0:3]
    v_and_b32 v77, 1, v77
    v_cmp_ne_u32 vcc, 0, v77
    v_mov_b64 v[20:21], 0
    v_mov_b64 v[22:23], 0
    buffer_load_dwordx4 v[40:43], v65, s[4:7], s14 offen offset:0 nt
    buffer_load_dwordx4 v[60:63], v66, s[4:7], s14 offen offset:0 nt
    s_cmp_eq_u64 vcc, 0
    s_cselect_b64 s[42:43], -1, 0
    v_add_f32_dpp v0, v0, v0 row_ror:4 row_mask:0xf bank_mask:0xf
    v_add_f32_dpp v1, v1, v1 row_ror:4 row_mask:0xf bank_mask:0xf
    s_nop 0
    v_add_f32_dpp v0, v0, v0 row_ror:8 row_mask:0xf bank_mask:0xf
    v_add_f32_dpp v1, v1, v1 row_ror:8 row_mask:0xf bank_mask:0xf
    s_mov_b64 exec, s[42:43]
    v_cvt_pk_bf16_f32 v72, v0, v1
    v_bfi_b32 v72, v79, s70, v72
    buffer_store_dword v72, v75, s[4:7], s17 offen offset:0
    buffer_store_dword v72, v75, s[4:7], s17 offen offset:1024
    buffer_store_dword v72, v75, s[4:7], s17 offen offset:2048
    buffer_store_dword v72, v75, s[4:7], s17 offen offset:3072
    s_mov_b64 exec, -1
    s_cbranch_scc0 cf_f2_retry
cf_f2_go:
    v_mov_b64 v[0:1], 0
    v_mov_b64 v[2:3], 0
    v_mov_b64 v[4:5], 0
    v_mov_b64 v[6:7], 0
    s_branch cf_loop
cf_f1:
    s_cmp_lg_u32 s32, 1
    s_cbranch_scc1 cf_f3
    v_and_b32 v77, 255, v69
    ds_read_b128 v[4:7], v77 offset:15872
    ds_read_b128 v[44:47], v70 offset:0
    ds_read_b128 v[48:51], v70 offset:1024
    ds_read_b128 v[52:55], v70 offset:2048
    ds_read_b128 v[56:59], v70 offset:3072
    ds_read_b128 v[24:27], v70 offset:4096
    ds_read_b128 v[28:31], v70 offset:5120
    ds_read_b128 v[32:35], v70 offset:6144
    ds_read_b128 v[36:39], v70 offset:7168
    s_mov_b32 s31, 65536
    s_add_u32 s24, s24, 524288
    s_add_u32 s26, s26, 524288
    s_add_u32 s55, s55, s57
    s_mov_b32 s14, 67108864
    s_mov_b32 s15, 67112960
    s_mov_b32 s16, 67117056
    s_mov_b32 s36, 1
    v_mov_b32 v40, s69
    v_mov_b32 v60, s69
    v_and_b32 v79, 12, v75
    v_cmp_eq_u32 vcc, 0, v79
    s_nop 1
    v_cndmask_b32 v79, 0, 1, vcc
    s_cmp_lg_u32 s37, 0
    s_cbranch_scc1 cf_f1_xt
cf_f1_xtx:
    s_nop 2
    v_mov_b32 v79, v79
    s_waitcnt vmcnt(0)
    buffer_load_dwordx4 v[8:11], v65, s[4:7], s18 offen nt
    buffer_load_dwordx4 v[12:15], v65, s[4:7], s19 offen nt
    buffer_load_dwordx4 v[16:19], v65, s[4:7], s20 offen nt
    buffer_load_dwordx4 v[20:23], v65, s[4:7], s21 offen nt
    s_nop 2
    v_mov_b32 v79, v79
    s_nop 2
    v_mov_b32 v79, v79
    s_nop 2
    v_mov_b32 v79, v79
    s_nop 2
    v_mov_b32 v79, v79
    s_nop 2
    v_mov_b32 v79, v79
    s_nop 2
    v_mov_b32 v79, v79
    s_nop 2
    v_mov_b32 v79, v79
    s_nop 2
    v_mov_b32 v79, v79
    s_nop 2
    v_mov_b32 v79, v79
    s_nop 2
    v_mov_b32 v79, v79
    buffer_load_dwordx4 v[40:43], v65, s[4:7], s14 offen offset:0 nt
    buffer_load_dwordx4 v[60:63], v66, s[4:7], s14 offen offset:0 nt
    s_waitcnt lgkmcnt(0)
    s_waitcnt vmcnt(5)
    v_xor_b32 v77, s69, v8
    v_mfma_f32_16x16x32_bf16 v[0:3], v[4:7], v[8:11], 0
    v_mov_b64 v[8:9], 0
    v_mov_b64 v[10:11], 0
    s_waitcnt vmcnt(4)
    v_bitop3_b32 v77, v77, v12, s69 bitop3:0xf6
    v_mfma_f32_16x16x32_bf16 v[0:3], v[4:7], v[12:15], v[0:3]
    v_mov_b64 v[12:13], 0
    v_mov_b64 v[14:15], 0
    s_waitcnt vmcnt(3)
    v_bitop3_b32 v77, v77, v16, s69 bitop3:0xf6
    v_mfma_f32_16x16x32_bf16 v[0:3], v[4:7], v[16:19], v[0:3]
    v_mov_b64 v[16:17], 0
    v_mov_b64 v[18:19], 0
    s_waitcnt vmcnt(2)
    v_bitop3_b32 v77, v77, v20, s69 bitop3:0xf6
    v_mfma_f32_16x16x32_bf16 v[0:3], v[4:7], v[20:23], v[0:3]
    v_and_b32 v77, 1, v77
    v_cmp_ne_u32 vcc, 0, v77
    v_mov_b64 v[20:21], 0
    v_mov_b64 v[22:23], 0
    buffer_load_dwordx4 v[40:43], v65, s[4:7], s14 offen offset:0 nt
    buffer_load_dwordx4 v[60:63], v66, s[4:7], s14 offen offset:0 nt
    s_cmp_eq_u64 vcc, 0
    s_cselect_b64 s[42:43], -1, 0
    v_add_f32_dpp v0, v0, v0 row_ror:8 row_mask:0xf bank_mask:0xf
    v_add_f32_dpp v1, v1, v1 row_ror:8 row_mask:0xf bank_mask:0xf
    s_mov_b64 exec, s[42:43]
    v_cvt_pk_bf16_f32 v72, v0, v1
    v_bfi_b32 v72, v79, s70, v72
    buffer_store_dword v72, v75, s[4:7], s17 offen offset:0
    s_mov_b64 exec, -1
    s_cbranch_scc0 cf_f1_retry
cf_f1_go:
    v_mov_b64 v[0:1], 0
    v_mov_b64 v[2:3], 0
    v_mov_b64 v[4:5], 0
    v_mov_b64 v[6:7], 0
    s_branch cf_loop
cf_f3:
    v_and_b32 v77, 255, v69
    ds_read_b128 v[4:7], v77 offset:15872
    ds_read_b128 v[44:47], v70 offset:0
    ds_read_b128 v[48:51], v70 offset:1024
    ds_read_b128 v[52:55], v70 offset:2048
    ds_read_b128 v[56:59], v70 offset:3072
    ds_read_b128 v[24:27], v70 offset:4096
    ds_read_b128 v[28:31], v70 offset:5120
    ds_read_b128 v[32:35], v70 offset:6144
    ds_read_b128 v[36:39], v70 offset:7168
    s_mov_b32 s31, 65536
    s_add_u32 s24, s24, 524288
    s_add_u32 s26, s26, 524288
    s_add_u32 s55, s55, s57
    s_mov_b32 s14, 67108864
    s_mov_b32 s15, 67112960
    s_mov_b32 s16, 67117056
    s_mov_b32 s36, 1
    v_mov_b32 v40, s69
    v_mov_b32 v60, s69
    v_and_b32 v79, 12, v75
    v_cmp_eq_u32 vcc, 0, v79
    s_nop 1
    v_cndmask_b32 v79, 0, 1, vcc
    s_add_u32 s40, s30, s95
    v_mov_b32 v72, s40
    s_waitcnt lgkmcnt(0)
    v_mov_b64 v[0:1], 0
    v_mov_b64 v[2:3], 0
    v_mov_b64 v[4:5], 0
    v_mov_b64 v[6:7], 0
    v_mov_b64 v[8:9], 0
    v_mov_b64 v[10:11], 0
    v_mov_b64 v[12:13], 0
    v_mov_b64 v[14:15], 0
    v_mov_b64 v[16:17], 0
    v_mov_b64 v[18:19], 0
    v_mov_b64 v[20:21], 0
    v_mov_b64 v[22:23], 0
    s_nop 2
    v_mov_b32 v79, v79
    s_nop 2
    v_mov_b32 v79, v79
    s_nop 2
    v_mov_b32 v79, v79
    s_nop 2
    v_mov_b32 v79, v79
    s_nop 2
    v_mov_b32 v79, v79
    s_nop 2
    v_mov_b32 v79, v79
    s_nop 2
    v_mov_b32 v79, v79
    s_nop 2
    v_mov_b32 v79, v79
    s_nop 2
    v_mov_b32 v79, v79
    s_waitcnt vmcnt(0)
    s_cmp_lt_u32 s97, s93
    s_cbranch_scc1 cf_kvwait
    s_nop 2
    v_mov_b32 v79, v79
    s_nop 2
    v_mov_b32 v79, v79
    s_nop 2
    v_mov_b32 v79, v79
    s_nop 2
    v_mov_b32 v79, v79
    s_nop 2
    v_mov_b32 v79, v79
    s_nop 2
    v_mov_b32 v79, v79
    s_nop 2
    v_mov_b32 v79, v79
    s_nop 2
    v_mov_b32 v79, v79
cf_kvok:
    s_branch cf_loop
cf_f0_xt:
    s_mov_b32 s37, 0
    s_nop 2
    v_mov_b32 v79, v79
    s_nop 2
    v_mov_b32 v79, v79
    s_nop 2
    v_mov_b32 v79, v79
    s_nop 2
    v_mov_b32 v79, v79
    s_nop 2
    v_mov_b32 v79, v79
    s_nop 2
    v_mov_b32 v79, v79
    s_branch cf_f0_xtx
cf_f0_retry:
    s_mov_b32 s37, 1
cf_f0_spin:
    buffer_load_dwordx4 v[8:11], v65, s[4:7], s18 offen nt
    buffer_load_dwordx4 v[12:15], v65, s[4:7], s19 offen nt
    buffer_load_dwordx4 v[16:19], v65, s[4:7], s20 offen nt
    buffer_load_dwordx4 v[20:23], v65, s[4:7], s21 offen nt
    s_nop 2
    v_mov_b32 v79, v79
    s_nop 2
    v_mov_b32 v79, v79
    s_nop 2
    v_mov_b32 v79, v79
    buffer_load_dwordx4 v[40:43], v65, s[4:7], s14 offen offset:0 nt
    buffer_load_dwordx4 v[60:63], v66, s[4:7], s14 offen offset:0 nt
    s_waitcnt vmcnt(5)
    v_xor_b32 v77, s69, v8
    v_mfma_f32_16x16x32_bf16 v[0:3], v[4:7], v[8:11], 0
    v_mov_b64 v[8:9], 0
    v_mov_b64 v[10:11], 0
    s_waitcnt vmcnt(4)
    v_bitop3_b32 v77, v77, v12, s69 bitop3:0xf6
    v_mfma_f32_16x16x32_bf16 v[0:3], v[4:7], v[12:15], v[0:3]
    v_mov_b64 v[12:13], 0
    v_mov_b64 v[14:15], 0
    s_waitcnt vmcnt(3)
    v_bitop3_b32 v77, v77, v16, s69 bitop3:0xf6
    v_mfma_f32_16x16x32_bf16 v[0:3], v[4:7], v[16:19], v[0:3]
    v_mov_b64 v[16:17], 0
    v_mov_b64 v[18:19], 0
    s_waitcnt vmcnt(2)
    v_bitop3_b32 v77, v77, v20, s69 bitop3:0xf6
    v_mfma_f32_16x16x32_bf16 v[0:3], v[4:7], v[20:23], v[0:3]
    v_and_b32 v77, 1, v77
    v_cmp_ne_u32 vcc, 0, v77
    v_mov_b64 v[20:21], 0
    v_mov_b64 v[22:23], 0
    buffer_load_dwordx4 v[40:43], v65, s[4:7], s14 offen offset:0 nt
    buffer_load_dwordx4 v[60:63], v66, s[4:7], s14 offen offset:0 nt
    s_cmp_eq_u64 vcc, 0
    s_cselect_b64 s[42:43], -1, 0
    v_add_f32_dpp v0, v0, v0 row_ror:8 row_mask:0xf bank_mask:0xf
    v_add_f32_dpp v1, v1, v1 row_ror:8 row_mask:0xf bank_mask:0xf
    s_mov_b64 exec, s[42:43]
    v_cvt_pk_bf16_f32 v72, v0, v1
    v_bfi_b32 v72, v79, s70, v72
    buffer_store_dword v72, v75, s[4:7], s17 offen offset:0
    s_mov_b64 exec, -1
    s_cbranch_scc1 cf_f0_rx
    s_sub_u32 s31, s31, 1
    s_cbranch_scc0 cf_f0_spin
cf_f0_rx:
    v_mov_b64 v[0:1], 0
    v_mov_b64 v[2:3], 0
    v_mov_b64 v[4:5], 0
    v_mov_b64 v[6:7], 0
    s_branch cf_loop
cf_f1_xt:
    s_mov_b32 s37, 0
    s_nop 2
    v_mov_b32 v79, v79
    s_nop 2
    v_mov_b32 v79, v79
    s_nop 2
    v_mov_b32 v79, v79
    s_nop 2
    v_mov_b32 v79, v79
    s_nop 2
    v_mov_b32 v79, v79
    s_nop 2
    v_mov_b32 v79, v79
    s_branch cf_f1_xtx
cf_f1_retry:
    s_mov_b32 s37, 1
cf_f1_spin:
    buffer_load_dwordx4 v[8:11], v65, s[4:7], s18 offen nt
    buffer_load_dwordx4 v[12:15], v65, s[4:7], s19 offen nt
    buffer_load_dwordx4 v[16:19], v65, s[4:7], s20 offen nt
    buffer_load_dwordx4 v[20:23], v65, s[4:7], s21 offen nt
    s_nop 2
    v_mov_b32 v79, v79
    s_nop 2
    v_mov_b32 v79, v79
    s_nop 2
    v_mov_b32 v79, v79
    buffer_load_dwordx4 v[40:43], v65, s[4:7], s14 offen offset:0 nt
    buffer_load_dwordx4 v[60:63], v66, s[4:7], s14 offen offset:0 nt
    s_waitcnt vmcnt(5)
    v_xor_b32 v77, s69, v8
    v_mfma_f32_16x16x32_bf16 v[0:3], v[4:7], v[8:11], 0
    v_mov_b64 v[8:9], 0
    v_mov_b64 v[10:11], 0
    s_waitcnt vmcnt(4)
    v_bitop3_b32 v77, v77, v12, s69 bitop3:0xf6
    v_mfma_f32_16x16x32_bf16 v[0:3], v[4:7], v[12:15], v[0:3]
    v_mov_b64 v[12:13], 0
    v_mov_b64 v[14:15], 0
    s_waitcnt vmcnt(3)
    v_bitop3_b32 v77, v77, v16, s69 bitop3:0xf6
    v_mfma_f32_16x16x32_bf16 v[0:3], v[4:7], v[16:19], v[0:3]
    v_mov_b64 v[16:17], 0
    v_mov_b64 v[18:19], 0
    s_waitcnt vmcnt(2)
    v_bitop3_b32 v77, v77, v20, s69 bitop3:0xf6
    v_mfma_f32_16x16x32_bf16 v[0:3], v[4:7], v[20:23], v[0:3]
    v_and_b32 v77, 1, v77
    v_cmp_ne_u32 vcc, 0, v77
    v_mov_b64 v[20:21], 0
    v_mov_b64 v[22:23], 0
    buffer_load_dwordx4 v[40:43], v65, s[4:7], s14 offen offset:0 nt
    buffer_load_dwordx4 v[60:63], v66, s[4:7], s14 offen offset:0 nt
    s_cmp_eq_u64 vcc, 0
    s_cselect_b64 s[42:43], -1, 0
    v_add_f32_dpp v0, v0, v0 row_ror:8 row_mask:0xf bank_mask:0xf
    v_add_f32_dpp v1, v1, v1 row_ror:8 row_mask:0xf bank_mask:0xf
    s_mov_b64 exec, s[42:43]
    v_cvt_pk_bf16_f32 v72, v0, v1
    v_bfi_b32 v72, v79, s70, v72
    buffer_store_dword v72, v75, s[4:7], s17 offen offset:0
    s_mov_b64 exec, -1
    s_cbranch_scc1 cf_f1_rx
    s_sub_u32 s31, s31, 1
    s_cbranch_scc0 cf_f1_spin
cf_f1_rx:
    v_mov_b64 v[0:1], 0
    v_mov_b64 v[2:3], 0
    v_mov_b64 v[4:5], 0
    v_mov_b64 v[6:7], 0
    s_branch cf_loop
cf_f2_xt:
    s_mov_b32 s37, 0
    s_nop 2
    v_mov_b32 v79, v79
    s_nop 2
    v_mov_b32 v79, v79
    s_nop 2
    v_mov_b32 v79, v79
    s_nop 2
    v_mov_b32 v79, v79
    s_nop 2
    v_mov_b32 v79, v79
    s_nop 2
    v_mov_b32 v79, v79
    s_branch cf_f2_xtx
cf_f2_retry:
    s_mov_b32 s37, 1
cf_f2_spin:
    buffer_load_dwordx4 v[8:11], v65, s[4:7], s18 offen nt
    buffer_load_dwordx4 v[12:15], v65, s[4:7], s19 offen nt
    buffer_load_dwordx4 v[16:19], v65, s[4:7], s20 offen nt
    buffer_load_dwordx4 v[20:23], v65, s[4:7], s21 offen nt
    s_nop 2
    v_mov_b32 v79, v79
    s_nop 2
    v_mov_b32 v79, v79
    s_nop 2
    v_mov_b32 v79, v79
    buffer_load_dwordx4 v[40:43], v65, s[4:7], s14 offen offset:0 nt
    buffer_load_dwordx4 v[60:63], v66, s[4:7], s14 offen offset:0 nt
    s_waitcnt vmcnt(5)
    v_xor_b32 v77, s69, v8
    v_mfma_f32_16x16x32_bf16 v[0:3], v[4:7], v[8:11], 0
    v_mov_b64 v[8:9], 0
    v_mov_b64 v[10:11], 0
    s_waitcnt vmcnt(4)
    v_bitop3_b32 v77, v77, v12, s69 bitop3:0xf6
    v_mfma_f32_16x16x32_bf16 v[0:3], v[4:7], v[12:15], v[0:3]
    v_mov_b64 v[12:13], 0
    v_mov_b64 v[14:15], 0
    s_waitcnt vmcnt(3)
    v_bitop3_b32 v77, v77, v16, s69 bitop3:0xf6
    v_mfma_f32_16x16x32_bf16 v[0:3], v[4:7], v[16:19], v[0:3]
    v_mov_b64 v[16:17], 0
    v_mov_b64 v[18:19], 0
    s_waitcnt vmcnt(2)
    v_bitop3_b32 v77, v77, v20, s69 bitop3:0xf6
    v_mfma_f32_16x16x32_bf16 v[0:3], v[4:7], v[20:23], v[0:3]
    v_and_b32 v77, 1, v77
    v_cmp_ne_u32 vcc, 0, v77
    v_mov_b64 v[20:21], 0
    v_mov_b64 v[22:23], 0
    buffer_load_dwordx4 v[40:43], v65, s[4:7], s14 offen offset:0 nt
    buffer_load_dwordx4 v[60:63], v66, s[4:7], s14 offen offset:0 nt
    s_cmp_eq_u64 vcc, 0
    s_cselect_b64 s[42:43], -1, 0
    v_add_f32_dpp v0, v0, v0 row_ror:4 row_mask:0xf bank_mask:0xf
    v_add_f32_dpp v1, v1, v1 row_ror:4 row_mask:0xf bank_mask:0xf
    s_nop 0
    v_add_f32_dpp v0, v0, v0 row_ror:8 row_mask:0xf bank_mask:0xf
    v_add_f32_dpp v1, v1, v1 row_ror:8 row_mask:0xf bank_mask:0xf
    s_mov_b64 exec, s[42:43]
    v_cvt_pk_bf16_f32 v72, v0, v1
    v_bfi_b32 v72, v79, s70, v72
    buffer_store_dword v72, v75, s[4:7], s17 offen offset:0
    buffer_store_dword v72, v75, s[4:7], s17 offen offset:1024
    buffer_store_dword v72, v75, s[4:7], s17 offen offset:2048
    buffer_store_dword v72, v75, s[4:7], s17 offen offset:3072
    s_mov_b64 exec, -1
    s_cbranch_scc1 cf_f2_rx
    s_sub_u32 s31, s31, 1
    s_cbranch_scc0 cf_f2_spin
cf_f2_rx:
    v_mov_b64 v[0:1], 0
    v_mov_b64 v[2:3], 0
    v_mov_b64 v[4:5], 0
    v_mov_b64 v[6:7], 0
    s_branch cf_loop
cf_spinB:
    s_waitcnt vmcnt(2)
cf_spinB_l:
    v_and_b32 v77, s36, v44
    v_cmp_ne_u32 vcc, s70, v77
    s_cbranch_vccz cf_spinB_x
    buffer_load_dwordx4 v[44:47], v65, s[4:7], s15 offen nt
    s_sub_u32 s31, s31, 16
    s_waitcnt vmcnt(0)
    s_cbranch_scc0 cf_spinB_l
cf_spinB_x:
    ds_write_b128 v65, v[44:47] offset:4096
    s_waitcnt lgkmcnt(0)
    s_branch cf_backB
cf_spin8:
    buffer_load_dwordx4 v[40:43], v65, s[4:7], s16 offen nt
cf_spin8_l:
    v_and_b32 v77, s36, v40
    v_cmp_ne_u32 vcc, s70, v77
    s_cbranch_vccz cf_spin8_x
    s_nop 1
    v_and_b32 v77, s36, v40
    v_cmp_ne_u32 vcc, s70, v77
    s_cbranch_vccz cf_spin8_x
    s_nop 1
    v_and_b32 v77, s36, v40
    v_cmp_ne_u32 vcc, s70, v77
    s_cbranch_vccz cf_spin8_x
    s_nop 1
    buffer_load_dwordx4 v[40:43], v65, s[4:7], s16 offen nt
    s_sub_u32 s31, s31, 16
    s_cbranch_scc0 cf_spin8_l
cf_spin8_x:
    s_branch cf_back8
cf_rare:
    s_mov_b64 exec, s[34:35]
    buffer_store_dwordx4 v[0:3], v65, s[4:7], s28 offen sc1
    s_mov_b64 exec, -1
    s_nop 3
    v_cvt_pk_bf16_f32 v52, v16, v17
    v_cvt_pk_bf16_f32 v53, v18, v19
    v_cvt_pk_bf16_f32 v54, v20, v21
    v_cvt_pk_bf16_f32 v55, v22, v23
    buffer_store_dwordx4 v[52:55], v65, s[4:7], s27 offen sc1
    s_add_u32 s28, s28, 131072
    s_add_u32 s27, s27, 131072
    s_cmp_eq_u32 s30, 63
    s_cbranch_scc1 cf_last
    s_branch cf_rare_x
cf_kvwait:
    s_mov_b32 s41, s97
    v_bfe_u32 v78, v65, 2, 5
    v_mov_b32 v77, v76
    s_nop 1
    v_permlane32_swap_b32 v76, v77
    v_subrev_u32 v77, s95, v77
    v_cmp_lt_u32 vcc, 16, v77
    s_nop 1
    v_cndmask_b32 v77, v77, 0, vcc
    v_bfe_u32 v79, v78, 2, 2
    v_lshl_add_u32 v77, v77, 2, v79
    s_nop 1
    v_min_u32_dpp v77, v77, v77 row_ror:1 row_mask:0xf bank_mask:0xf
    s_nop 1
    v_min_u32_dpp v77, v77, v77 row_ror:2 row_mask:0xf bank_mask:0xf
    s_nop 1
    v_min_u32_dpp v77, v77, v77 row_ror:4 row_mask:0xf bank_mask:0xf
    s_nop 0
    v_readfirstlane_b32 s97, v77
    s_nop 0
    s_max_u32 s97, s97, s41
    s_add_u32 s40, s30, 3
    s_min_u32 s40, s40, 64
    s_cmp_le_u32 s40, s97
    s_cbranch_scc1 cf_kvw_x
    v_bfe_u32 v78, v65, 2, 5
    s_mov_b32 s31, 4194304
cf_kvw:
    buffer_load_dword v77, v78, s[4:7], s96 offen offset:16 sc1
    s_waitcnt vmcnt(0)
    v_subrev_u32 v77, s95, v77
    v_cmp_lt_u32 vcc, 16, v77
    s_nop 1
    v_cndmask_b32 v77, v77, 0, vcc
    v_bfe_u32 v79, v78, 2, 2
    v_lshl_add_u32 v77, v77, 2, v79
    s_nop 1
    v_min_u32_dpp v77, v77, v77 row_ror:1 row_mask:0xf bank_mask:0xf
    s_nop 1
    v_min_u32_dpp v77, v77, v77 row_ror:2 row_mask:0xf bank_mask:0xf
    s_nop 1
    v_min_u32_dpp v77, v77, v77 row_ror:4 row_mask:0xf bank_mask:0xf
    s_nop 0
    v_readfirstlane_b32 s97, v77
    s_sub_u32 s31, s31, 1
    s_cbranch_scc1 cf_kvw_x
    s_cmp_le_u32 s40, s97
    s_cbranch_scc1 cf_kvw_x
    s_sleep 2
    s_branch cf_kvw
cf_kvw_x:
    s_branch cf_kvok
cf_last:
    s_add_u32 s40, s95, 64
    v_mov_b32 v78, s40
    s_waitcnt vmcnt(0)
    s_barrier
    s_mov_b64 exec, s[100:101]
    buffer_store_dword v78, off, s[4:7], s29 sc1
    s_mov_b64 exec, -1
cf_end:
    s_endpgm
L_chain_safe:
    s_load_dwordx8 s[48:55], s[0:1], 8
    s_load_dwordx2 s[56:57], s[0:1], 40
    s_waitcnt lgkmcnt(0)
    v_lshrrev_b32 v77, 6, v0
    s_nop 0
    v_readfirstlane_b32 s13, v77
    v_lshlrev_b32 v65, 4, v0
    v_and_b32 v48, 63, v0
    s_mov_b32 s10, 4718592
    s_mov_b32 s11, 0x20000
    v_lshrrev_b32 v49, 3, v48
    v_mul_u32_u24 v18, 1152, v49
    v_and_b32 v49, 7, v48
    v_lshl_add_u32 v18, v49, 4, v18
    s_mul_i32 s40, s12, 147456
    s_lshl_b32 s41, s13, 8
    s_add_u32 s40, s40, s41
    s_mov_b32 s42, s40
    s_xor_b32 s41, s13, 0
    s_mul_i32 s41, s41, 36864
    s_add_u32 s60, s41, s40
    s_xor_b32 s41, s13, 1
    s_mul_i32 s41, s41, 36864
    s_add_u32 s61, s41, s40
    s_xor_b32 s41, s13, 2
    s_mul_i32 s41, s41, 36864
    s_add_u32 s62, s41, s40
    s_xor_b32 s41, s13, 3
    s_mul_i32 s41, s41, 36864
    s_add_u32 s63, s41, s40
    s_lshl_b32 s43, s13, 12
    s_mov_b64 s[8:9], s[56:57]
    s_add_u32 m0, s43, 0
    s_add_u32 s41, s60, 0
    buffer_load_dwordx4 v18, s[8:11], s41 offen offset:0 nt lds
    s_add_u32 s41, s60, 8192
    buffer_load_dwordx4 v18, s[8:11], s41 offen offset:1024 nt lds
    s_add_u32 s41, s60, 16384
    buffer_load_dwordx4 v18, s[8:11], s41 offen offset:2048 nt lds
    s_add_u32 s41, s60, 24576
    buffer_load_dwordx4 v18, s[8:11], s41 offen offset:3072 nt lds
    s_add_u32 m0, s43, 36864
    s_add_u32 s41, s61, 0
    buffer_load_dwordx4 v18, s[8:11], s41 offen offset:0 nt lds
    s_add_u32 s41, s61, 8192
    buffer_load_dwordx4 v18, s[8:11], s41 offen offset:1024 nt lds
    s_add_u32 s41, s61, 16384
    buffer_load_dwordx4 v18, s[8:11], s41 offen offset:2048 nt lds
    s_add_u32 s41, s61, 24576
    buffer_load_dwordx4 v18, s[8:11], s41 offen offset:3072 nt lds
    s_add_u32 m0, s43, 73728
    s_add_u32 s41, s62, 0
    buffer_load_dwordx4 v18, s[8:11], s41 offen offset:0 nt lds
    s_add_u32 s41, s62, 8192
    buffer_load_dwordx4 v18, s[8:11], s41 offen offset:1024 nt lds
    s_add_u32 s41, s62, 16384
    buffer_load_dwordx4 v18, s[8:11], s41 offen offset:2048 nt lds
    s_add_u32 s41, s62, 24576
    buffer_load_dwordx4 v18, s[8:11], s41 offen offset:3072 nt lds
    s_add_u32 m0, s43, 110592
    s_add_u32 s41, s63, 0
    buffer_load_dwordx4 v18, s[8:11], s41 offen offset:0 nt lds
    s_add_u32 s41, s63, 8192
    buffer_load_dwordx4 v18, s[8:11], s41 offen offset:1024 nt lds
    s_add_u32 s41, s63, 16384
    buffer_load_dwordx4 v18, s[8:11], s41 offen offset:2048 nt lds
    s_add_u32 s41, s63, 24576
    buffer_load_dwordx4 v18, s[8:11], s41 offen offset:3072 nt lds
    v_lshrrev_b32 v49, 1, v48
    v_mul_u32_u24 v19, 1152, v49
    v_and_b32 v49, 1, v48
    v_lshl_add_u32 v19, v49, 4, v19
    s_mul_i32 s41, s13, 224
    s_sub_u32 s41, 1024, s41
    v_add_u32 v19, s41, v19
    v_lshrrev_b32 v49, 4, v48
    v_lshlrev_b32 v50, 2, v49
    v_and_b32 v51, 15, v48
    v_xor_b32 v51, v51, v50
    v_lshlrev_b32 v51, 4, v51
    v_lshl_add_u32 v16, v49, 15, v51
    v_lshrrev_b32 v50, 1, v49
    v_lshl_add_u32 v17, v50, 16, v51
    v_and_b32 v50, 1, v49
    v_lshl_add_u32 v17, v50, 13, v17
    s_lshl_b32 s40, s12, 8
    s_mul_i32 s58, s13, 1048576
    s_add_u32 s58, s58, s40
    s_lshr_b32 s41, s13, 1
    s_mul_i32 s59, s41, 262144
    s_and_b32 s41, s13, 1
    s_lshl_b32 s41, s41, 14
    s_add_u32 s59, s59, s41
    s_add_u32 s59, s59, s40
    s_add_u32 s59, s59, 4194304
    v_bfe_u32 v50, v48, 2, 2
    v_xor_b32 v51, s13, v50
    v_lshlrev_b32 v20, 6, v51
    v_and_b32 v51, 3, v48
    v_lshl_add_u32 v20, v51, 4, v20
    v_lshrrev_b32 v23, 2, v48
    v_lshl_add_u32 v20, v23, 8, v20
    s_xor_b32 s41, s43, 0
    v_add_u32 v24, s41, v20
    s_xor_b32 s41, s43, 4096
    v_add_u32 v25, s41, v20
    s_xor_b32 s41, s43, 8192
    v_add_u32 v26, s41, v20
    s_xor_b32 s41, s43, 12288
    v_add_u32 v27, s41, v20
    v_and_b32 v23, 1, v50
    v_lshl_add_u32 v23, v49, 2, v23
    v_lshrrev_b32 v50, 1, v50
    v_lshlrev_b32 v21, 7, v23
    v_lshl_add_u32 v21, v50, 6, v21
    v_lshrrev_b32 v16, 1, v51
    v_lshl_add_u32 v21, v16, 5, v21
    v_and_b32 v16, 1, v51
    v_lshl_add_u32 v21, v16, 3, v21
    v_add_u32 v21, s43, v21
    v_lshlrev_b32 v22, 9, v50
    v_xor_b32 v22, v22, v21
    v_lshlrev_b32 v23, 5, v23
    v_lshl_add_u32 v23, v50, 10, v23
    v_lshl_add_u32 v23, v51, 3, v23
    v_add_u32 v23, s43, v23
    v_bfe_u32 v60, v65, 4, 6
    v_and_b32 v61, 15, v60
    v_lshrrev_b32 v62, 4, v60
    v_mov_b32 v64, 0x4444
    v_mov_b32 v77, 0xeeee
    v_cmp_lt_u32 vcc, 7, v61
    s_nop 1
    v_cndmask_b32 v64, v64, v77, vcc
    v_xor_b32 v66, 1024, v65
    v_xor_b32 v67, 2048, v65
    v_xor_b32 v68, 3072, v65
    v_and_b32 v69, 511, v65
    s_mul_i32 s96, s13, 36864
    s_add_u32 s96, s96, 16384
    v_lshlrev_b32 v70, 4, v60
    v_add_u32 v70, s96, v70
    v_lshrrev_b32 v79, 1, v69
    s_lshl_b32 s96, s13, 8
    s_add_u32 s96, s96, 14336
    s_lshl_b32 s33, s13, 10
    s_add_u32 s97, s33, 8192
    v_mov_b32 v77, s97
    v_mov_b32 v78, s96
    v_cmp_lt_u32 vcc, 31, v60
    s_nop 1
    v_cndmask_b32 v71, v77, v78, vcc
    v_add_u32 v71, v71, v79
    v_and_b32 v77, 7, v61
    v_lshrrev_b32 v78, 3, v61
    v_lshlrev_b32 v74, 4, v77
    v_lshl_add_u32 v73, v62, 7, v74
    v_lshl_add_u32 v73, v78, 3, v73
    s_lshl_b32 s96, s13, 9
    v_add_u32 v73, s96, v73
    v_lshrrev_b32 v74, 1, v74
    v_lshl_add_u32 v74, v78, 14, v74
    v_lshl_add_u32 v74, v62, 15, v74
    s_lshl_b32 s96, s13, 17
    v_add_u32 v74, s96, v74
    v_bfe_u32 v77, v61, 2, 1
    v_and_b32 v78, 3, v61
    s_cmp_lt_u32 s13, 2
    s_cselect_b64 vcc, -1, 0
    v_cndmask_b32 v77, 0, v77, vcc
    v_lshlrev_b32 v75, 7, v77
    v_lshl_add_u32 v75, v62, 4, v75
    v_lshl_add_u32 v75, v78, 2, v75
    v_lshlrev_b32 v58, 3, v77
    v_lshl_add_u32 v58, v78, 1, v58
    s_bfe_u32 s97, s12, 0x10001
    s_lshl_b32 s68, s97, 6
    s_lshl_b32 s97, s97, 2
    v_add_u32 v59, s97, v62
    s_bfe_u32 s96, s12, 0x10002
    s_and_b32 s40, s12, 1
    s_lshl_b32 s96, s96, 1
    s_add_u32 s96, s96, s40
    s_lshr_b32 s97, s12, 3
    s_lshl_b32 s98, s13, 2
    s_add_u32 s98, s98, s97
    s_lshl_b32 s98, s98, 2
    s_add_u32 s98, s98, s96
    s_lshl_b32 s98, s98, 8
    s_lshl_b32 s99, s13, 2
    s_add_u32 s99, s99, s96
    s_lshl_b32 s99, s99, 4
    s_lshl_b32 s41, s97, 1
    s_add_u32 s41, s41, s40
    s_lshl_b32 s41, s41, 7
    s_add_u32 s41, s41, 8192
    s_lshl_b32 s40, s40, 3
    s_add_u32 s40, s40, 512
    s_cmp_lt_u32 s13, 2
    s_cselect_b32 s96, 7, 4
    s_cselect_b32 s98, s98, s41
    s_cselect_b32 s99, s99, s40
    s_cselect_b32 s32, 1, 0
    s_add_u32 s68, s68, s98
    s_lshl_b32 s97, s97, s96
    s_add_u32 s99, s99, s97
    v_add_u32 v58, s99, v58
    s_and_b32 s97, s12, 4
    s_or_b32 s97, s97, s13
    s_cmp_eq_u32 s97, 2
    s_cselect_b32 s32, 2, s32
    s_mov_b32 s8, s48
    s_mov_b32 s9, s49
    s_mov_b32 s10, 9216
    v_mul_u32_u24 v77, 1152, v59
    v_lshl_add_u32 v77, v58, 1, v77
    buffer_load_dword v72, v77, s[8:11], 0 offen
    s_mov_b32 s10, 4718592
    s_waitcnt vmcnt(12) lgkmcnt(0)
    s_barrier
    s_mov_b64 s[8:9], s[56:57]
    s_add_u32 m0, s43, 147456
    s_add_u32 s41, s42, 0
    buffer_load_dwordx4 v19, s[8:11], s41 offen offset:0 nt lds
    s_add_u32 s41, s42, 35840
    buffer_load_dwordx4 v19, s[8:11], s41 offen offset:1024 nt lds
    s_add_u32 s41, s42, 71680
    buffer_load_dwordx4 v19, s[8:11], s41 offen offset:2048 nt lds
    s_add_u32 s41, s42, 107520
    buffer_load_dwordx4 v19, s[8:11], s41 offen offset:3072 nt lds
    v_mov_b32 v78, v21
    v_mov_b32 v79, v22
    v_add_u32 v77, 0, v79
    ds_read_b64_tr_b16 v[80:81], v77 offset:0
    ds_read_b64_tr_b16 v[82:83], v77 offset:256
    ds_read_b64_tr_b16 v[84:85], v77 offset:2048
    ds_read_b64_tr_b16 v[86:87], v77 offset:2304
    ds_read_b64_tr_b16 v[112:113], v77 offset:16
    ds_read_b64_tr_b16 v[114:115], v77 offset:272
    ds_read_b64_tr_b16 v[116:117], v77 offset:2064
    ds_read_b64_tr_b16 v[118:119], v77 offset:2320
    s_waitcnt vmcnt(12) lgkmcnt(0)
    s_barrier
    s_mov_b64 s[8:9], s[52:53]
    s_add_u32 m0, s43, 0
    s_add_u32 s41, s58, 0
    buffer_load_dwordx4 v17, s[8:11], s41 offen offset:0 nt lds
    s_add_u32 s41, s58, 31744
    buffer_load_dwordx4 v17, s[8:11], s41 offen offset:1024 nt lds
    s_add_u32 s41, s58, 129024
    buffer_load_dwordx4 v17, s[8:11], s41 offen offset:2048 nt lds
    s_add_u32 s41, s58, 160768
    buffer_load_dwordx4 v17, s[8:11], s41 offen offset:3072 nt lds
    v_add_u32 v77, 36864, v78
    ds_read_b64_tr_b16 v[88:89], v77 offset:0
    ds_read_b64_tr_b16 v[90:91], v77 offset:256
    ds_read_b64_tr_b16 v[92:93], v77 offset:2048
    ds_read_b64_tr_b16 v[94:95], v77 offset:2304
    ds_read_b64_tr_b16 v[120:121], v77 offset:16
    ds_read_b64_tr_b16 v[122:123], v77 offset:272
    ds_read_b64_tr_b16 v[124:125], v77 offset:2064
    ds_read_b64_tr_b16 v[126:127], v77 offset:2320
    s_waitcnt vmcnt(12) lgkmcnt(0)
    s_barrier
    s_add_u32 m0, s43, 36864
    s_add_u32 s41, s58, 16384
    buffer_load_dwordx4 v17, s[8:11], s41 offen offset:0 nt lds
    s_add_u32 s41, s58, 48128
    buffer_load_dwordx4 v17, s[8:11], s41 offen offset:1024 nt lds
    s_add_u32 s41, s58, 145408
    buffer_load_dwordx4 v17, s[8:11], s41 offen offset:2048 nt lds
    s_add_u32 s41, s58, 177152
    buffer_load_dwordx4 v17, s[8:11], s41 offen offset:3072 nt lds
    v_add_u32 v77, 73728, v78
    ds_read_b64_tr_b16 v[96:97], v77 offset:0
    ds_read_b64_tr_b16 v[98:99], v77 offset:256
    ds_read_b64_tr_b16 v[100:101], v77 offset:2048
    ds_read_b64_tr_b16 v[102:103], v77 offset:2304
    ds_read_b64_tr_b16 v[128:129], v77 offset:16
    ds_read_b64_tr_b16 v[130:131], v77 offset:272
    ds_read_b64_tr_b16 v[132:133], v77 offset:2064
    ds_read_b64_tr_b16 v[134:135], v77 offset:2320
    s_waitcnt vmcnt(12) lgkmcnt(0)
    s_barrier
    s_add_u32 m0, s43, 73728
    s_add_u32 s41, s58, 262144
    buffer_load_dwordx4 v17, s[8:11], s41 offen offset:0 nt lds
    s_add_u32 s41, s58, 293888
    buffer_load_dwordx4 v17, s[8:11], s41 offen offset:1024 nt lds
    s_add_u32 s41, s58, 391168
    buffer_load_dwordx4 v17, s[8:11], s41 offen offset:2048 nt lds
    s_add_u32 s41, s58, 422912
    buffer_load_dwordx4 v17, s[8:11], s41 offen offset:3072 nt lds
    v_add_u32 v77, 110592, v78
    ds_read_b64_tr_b16 v[104:105], v77 offset:0
    ds_read_b64_tr_b16 v[106:107], v77 offset:256
    ds_read_b64_tr_b16 v[108:109], v77 offset:2048
    ds_read_b64_tr_b16 v[110:111], v77 offset:2304
    ds_read_b64_tr_b16 v[136:137], v77 offset:16
    ds_read_b64_tr_b16 v[138:139], v77 offset:272
    ds_read_b64_tr_b16 v[140:141], v77 offset:2064
    ds_read_b64_tr_b16 v[142:143], v77 offset:2320
    s_waitcnt vmcnt(12) lgkmcnt(0)
    s_barrier
    s_add_u32 m0, s43, 110592
    s_add_u32 s41, s58, 278528
    buffer_load_dwordx4 v17, s[8:11], s41 offen offset:0 nt lds
    s_add_u32 s41, s58, 310272
    buffer_load_dwordx4 v17, s[8:11], s41 offen offset:1024 nt lds
    s_add_u32 s41, s58, 407552
    buffer_load_dwordx4 v17, s[8:11], s41 offen offset:2048 nt lds
    s_add_u32 s41, s58, 439296
    buffer_load_dwordx4 v17, s[8:11], s41 offen offset:3072 nt lds
    v_add_u32 v77, 147456, v23
    ds_read_b64_tr_b16 v[0:1], v77 offset:0
    ds_read_b64_tr_b16 v[2:3], v77 offset:64
    ds_read_b64_tr_b16 v[4:5], v77 offset:512
    ds_read_b64_tr_b16 v[6:7], v77 offset:576
    ds_read_b64_tr_b16 v[8:9], v77 offset:2048
    ds_read_b64_tr_b16 v[10:11], v77 offset:2112
    ds_read_b64_tr_b16 v[12:13], v77 offset:2560
    ds_read_b64_tr_b16 v[14:15], v77 offset:2624
    s_waitcnt vmcnt(12) lgkmcnt(0)
    s_barrier
    s_add_u32 m0, s43, 147456
    s_add_u32 s41, s58, 524288
    buffer_load_dwordx4 v17, s[8:11], s41 offen offset:0 nt lds
    s_add_u32 s41, s58, 556032
    buffer_load_dwordx4 v17, s[8:11], s41 offen offset:1024 nt lds
    s_add_u32 s41, s58, 653312
    buffer_load_dwordx4 v17, s[8:11], s41 offen offset:2048 nt lds
    s_add_u32 s41, s58, 685056
    buffer_load_dwordx4 v17, s[8:11], s41 offen offset:3072 nt lds
    s_cmp_eq_u32 s32, 0
    s_cbranch_scc1 cs_init_done
    v_mov_b32 v52, 1
    v_mov_b32 v53, 1
    v_mov_b32 v54, 1
    v_mov_b32 v55, 1
    v_mov_b32 v56, 0
    s_lshl_b32 s96, s12, 14
    s_add_u32 s96, s96, 68681728
    s_add_u32 s97, s96, 0
    buffer_store_dwordx4 v[52:55], v65, s[4:7], s97 offen sc1
    s_add_u32 s97, s96, 4096
    buffer_store_dwordx4 v[52:55], v65, s[4:7], s97 offen sc1
    s_add_u32 s97, s96, 8192
    buffer_store_dwordx4 v[52:55], v65, s[4:7], s97 offen sc1
    s_add_u32 s97, s96, 12288
    buffer_store_dwordx4 v[52:55], v65, s[4:7], s97 offen sc1
    s_add_u32 s96, s68, 67633152
    s_add_u32 s97, s96, 16384
    buffer_store_dword v56, v75, s[4:7], s96 offen offset:0 sc1
    buffer_store_dword v72, v75, s[4:7], s97 offen offset:0 sc1
    s_cmp_lg_u32 s32, 2
    s_cbranch_scc1 cs_init_done
    buffer_store_dword v56, v75, s[4:7], s96 offen offset:1024 sc1
    buffer_store_dword v72, v75, s[4:7], s97 offen offset:1024 sc1
    buffer_store_dword v56, v75, s[4:7], s96 offen offset:2048 sc1
    buffer_store_dword v72, v75, s[4:7], s97 offen offset:2048 sc1
    buffer_store_dword v56, v75, s[4:7], s96 offen offset:3072 sc1
    buffer_store_dword v72, v75, s[4:7], s97 offen offset:3072 sc1
cs_init_done:
    ds_write_b64 v70, v[0:1] offset:16384
    ds_write_b64 v70, v[2:3] offset:16392
    ds_write_b64 v70, v[4:5] offset:17408
    ds_write_b64 v70, v[6:7] offset:17416
    ds_write_b64 v70, v[8:9] offset:18432
    ds_write_b64 v70, v[10:11] offset:18440
    ds_write_b64 v70, v[12:13] offset:19456
    ds_write_b64 v70, v[14:15] offset:19464
    v_add_u32 v28, 0, v24
    v_add_u32 v29, 0, v25
    v_add_u32 v30, 0, v26
    v_add_u32 v31, 0, v27
    ds_read_b64_tr_b16 a[96:97], v28 offset:0
    ds_read_b64_tr_b16 a[104:105], v28 offset:8
    ds_read_b64_tr_b16 a[112:113], v29 offset:0
    ds_read_b64_tr_b16 a[120:121], v29 offset:8
    ds_read_b64_tr_b16 a[128:129], v30 offset:0
    ds_read_b64_tr_b16 a[136:137], v30 offset:8
    ds_read_b64_tr_b16 a[144:145], v31 offset:0
    ds_read_b64_tr_b16 v[32:33], v31 offset:8
    s_waitcnt vmcnt(12) lgkmcnt(0)
    s_barrier
    s_add_u32 m0, s43, 0
    s_add_u32 s41, s58, 540672
    buffer_load_dwordx4 v17, s[8:11], s41 offen offset:0 nt lds
    s_add_u32 s41, s58, 572416
    buffer_load_dwordx4 v17, s[8:11], s41 offen offset:1024 nt lds
    s_add_u32 s41, s58, 669696
    buffer_load_dwordx4 v17, s[8:11], s41 offen offset:2048 nt lds
    s_add_u32 s41, s58, 701440
    buffer_load_dwordx4 v17, s[8:11], s41 offen offset:3072 nt lds
    ds_write_b64 v70, v[32:33] offset:12288
    v_add_u32 v28, 36864, v24
    v_add_u32 v29, 36864, v25
    v_add_u32 v30, 36864, v26
    v_add_u32 v31, 36864, v27
    ds_read_b64_tr_b16 a[98:99], v28 offset:0
    ds_read_b64_tr_b16 a[106:107], v28 offset:8
    ds_read_b64_tr_b16 a[114:115], v29 offset:0
    ds_read_b64_tr_b16 a[122:123], v29 offset:8
    ds_read_b64_tr_b16 a[130:131], v30 offset:0
    ds_read_b64_tr_b16 a[138:139], v30 offset:8
    ds_read_b64_tr_b16 a[146:147], v31 offset:0
    ds_read_b64_tr_b16 v[0:1], v31 offset:8
    s_waitcnt vmcnt(12) lgkmcnt(0)
    s_barrier
    s_add_u32 m0, s43, 36864
    s_add_u32 s41, s58, 786432
    buffer_load_dwordx4 v17, s[8:11], s41 offen offset:0 nt lds
    s_add_u32 s41, s58, 818176
    buffer_load_dwordx4 v17, s[8:11], s41 offen offset:1024 nt lds
    s_add_u32 s41, s58, 915456
    buffer_load_dwordx4 v17, s[8:11], s41 offen offset:2048 nt lds
    s_add_u32 s41, s58, 947200
    buffer_load_dwordx4 v17, s[8:11], s41 offen offset:3072 nt lds
    ds_write_b64 v70, v[0:1] offset:12296
    v_add_u32 v28, 73728, v24
    v_add_u32 v29, 73728, v25
    v_add_u32 v30, 73728, v26
    v_add_u32 v31, 73728, v27
    ds_read_b64_tr_b16 a[100:101], v28 offset:0
    ds_read_b64_tr_b16 a[108:109], v28 offset:8
    ds_read_b64_tr_b16 a[116:117], v29 offset:0
    ds_read_b64_tr_b16 a[124:125], v29 offset:8
    ds_read_b64_tr_b16 a[132:133], v30 offset:0
    ds_read_b64_tr_b16 a[140:141], v30 offset:8
    ds_read_b64_tr_b16 a[148:149], v31 offset:0
    ds_read_b64_tr_b16 v[32:33], v31 offset:8
    s_waitcnt vmcnt(12) lgkmcnt(0)
    s_barrier
    s_add_u32 m0, s43, 73728
    s_add_u32 s41, s58, 802816
    buffer_load_dwordx4 v17, s[8:11], s41 offen offset:0 nt lds
    s_add_u32 s41, s58, 834560
    buffer_load_dwordx4 v17, s[8:11], s41 offen offset:1024 nt lds
    s_add_u32 s41, s58, 931840
    buffer_load_dwordx4 v17, s[8:11], s41 offen offset:2048 nt lds
    s_add_u32 s41, s58, 963584
    buffer_load_dwordx4 v17, s[8:11], s41 offen offset:3072 nt lds
    ds_write_b64 v70, v[32:33] offset:13312
    v_add_u32 v28, 110592, v24
    v_add_u32 v29, 110592, v25
    v_add_u32 v30, 110592, v26
    v_add_u32 v31, 110592, v27
    ds_read_b64_tr_b16 a[102:103], v28 offset:0
    ds_read_b64_tr_b16 a[110:111], v28 offset:8
    ds_read_b64_tr_b16 a[118:119], v29 offset:0
    ds_read_b64_tr_b16 a[126:127], v29 offset:8
    ds_read_b64_tr_b16 a[134:135], v30 offset:0
    ds_read_b64_tr_b16 a[142:143], v30 offset:8
    ds_read_b64_tr_b16 a[150:151], v31 offset:0
    ds_read_b64_tr_b16 v[0:1], v31 offset:8
    s_waitcnt vmcnt(12) lgkmcnt(0)
    s_barrier
    s_add_u32 m0, s43, 110592
    s_add_u32 s41, s59, 0
    buffer_load_dwordx4 v17, s[8:11], s41 offen offset:0 nt lds
    s_add_u32 s41, s59, 31744
    buffer_load_dwordx4 v17, s[8:11], s41 offen offset:1024 nt lds
    s_add_u32 s41, s59, 129024
    buffer_load_dwordx4 v17, s[8:11], s41 offen offset:2048 nt lds
    s_add_u32 s41, s59, 160768
    buffer_load_dwordx4 v17, s[8:11], s41 offen offset:3072 nt lds
    ds_write_b64 v70, v[0:1] offset:13320
    v_add_u32 v28, 147456, v24
    v_add_u32 v29, 147456, v25
    v_add_u32 v30, 147456, v26
    v_add_u32 v31, 147456, v27
    ds_read_b64_tr_b16 a[152:153], v28 offset:0
    ds_read_b64_tr_b16 a[160:161], v28 offset:8
    ds_read_b64_tr_b16 a[168:169], v29 offset:0
    ds_read_b64_tr_b16 a[176:177], v29 offset:8
    ds_read_b64_tr_b16 a[184:185], v30 offset:0
    ds_read_b64_tr_b16 a[192:193], v30 offset:8
    ds_read_b64_tr_b16 a[200:201], v31 offset:0
    ds_read_b64_tr_b16 a[208:209], v31 offset:8
    s_waitcnt vmcnt(12) lgkmcnt(0)
    s_barrier
    s_mov_b64 s[8:9], s[50:51]
    s_add_u32 m0, s43, 147456
    s_add_u32 s41, s58, 0
    buffer_load_dwordx4 v17, s[8:11], s41 offen offset:0 nt lds
    s_add_u32 s41, s58, 31744
    buffer_load_dwordx4 v17, s[8:11], s41 offen offset:1024 nt lds
    s_add_u32 s41, s58, 129024
    buffer_load_dwordx4 v17, s[8:11], s41 offen offset:2048 nt lds
    s_add_u32 s41, s58, 160768
    buffer_load_dwordx4 v17, s[8:11], s41 offen offset:3072 nt lds
    v_add_u32 v28, 0, v24
    v_add_u32 v29, 0, v25
    v_add_u32 v30, 0, v26
    v_add_u32 v31, 0, v27
    ds_read_b64_tr_b16 a[154:155], v28 offset:0
    ds_read_b64_tr_b16 a[162:163], v28 offset:8
    ds_read_b64_tr_b16 a[170:171], v29 offset:0
    ds_read_b64_tr_b16 a[178:179], v29 offset:8
    ds_read_b64_tr_b16 a[186:187], v30 offset:0
    ds_read_b64_tr_b16 a[194:195], v30 offset:8
    ds_read_b64_tr_b16 a[202:203], v31 offset:0
    ds_read_b64_tr_b16 a[210:211], v31 offset:8
    s_waitcnt vmcnt(12) lgkmcnt(0)
    s_barrier
    s_add_u32 m0, s43, 0
    s_add_u32 s41, s58, 16384
    buffer_load_dwordx4 v17, s[8:11], s41 offen offset:0 nt lds
    s_add_u32 s41, s58, 48128
    buffer_load_dwordx4 v17, s[8:11], s41 offen offset:1024 nt lds
    s_add_u32 s41, s58, 145408
    buffer_load_dwordx4 v17, s[8:11], s41 offen offset:2048 nt lds
    s_add_u32 s41, s58, 177152
    buffer_load_dwordx4 v17, s[8:11], s41 offen offset:3072 nt lds
    v_add_u32 v28, 36864, v24
    v_add_u32 v29, 36864, v25
    v_add_u32 v30, 36864, v26
    v_add_u32 v31, 36864, v27
    ds_read_b64_tr_b16 a[156:157], v28 offset:0
    ds_read_b64_tr_b16 a[164:165], v28 offset:8
    ds_read_b64_tr_b16 a[172:173], v29 offset:0
    ds_read_b64_tr_b16 a[180:181], v29 offset:8
    ds_read_b64_tr_b16 a[188:189], v30 offset:0
    ds_read_b64_tr_b16 a[196:197], v30 offset:8
    ds_read_b64_tr_b16 a[204:205], v31 offset:0
    ds_read_b64_tr_b16 a[212:213], v31 offset:8
    s_waitcnt vmcnt(12) lgkmcnt(0)
    s_barrier
    s_add_u32 m0, s43, 36864
    s_add_u32 s41, s58, 262144
    buffer_load_dwordx4 v17, s[8:11], s41 offen offset:0 nt lds
    s_add_u32 s41, s58, 293888
    buffer_load_dwordx4 v17, s[8:11], s41 offen offset:1024 nt lds
    s_add_u32 s41, s58, 391168
    buffer_load_dwordx4 v17, s[8:11], s41 offen offset:2048 nt lds
    s_add_u32 s41, s58, 422912
    buffer_load_dwordx4 v17, s[8:11], s41 offen offset:3072 nt lds
    v_add_u32 v28, 73728, v24
    v_add_u32 v29, 73728, v25
    v_add_u32 v30, 73728, v26
    v_add_u32 v31, 73728, v27
    ds_read_b64_tr_b16 a[158:159], v28 offset:0
    ds_read_b64_tr_b16 a[166:167], v28 offset:8
    ds_read_b64_tr_b16 a[174:175], v29 offset:0
    ds_read_b64_tr_b16 a[182:183], v29 offset:8
    ds_read_b64_tr_b16 a[190:191], v30 offset:0
    ds_read_b64_tr_b16 a[198:199], v30 offset:8
    ds_read_b64_tr_b16 a[206:207], v31 offset:0
    ds_read_b64_tr_b16 a[214:215], v31 offset:8
    s_waitcnt vmcnt(12) lgkmcnt(0)
    s_barrier
    s_add_u32 m0, s43, 73728
    s_add_u32 s41, s58, 278528
    buffer_load_dwordx4 v17, s[8:11], s41 offen offset:0 nt lds
    s_add_u32 s41, s58, 310272
    buffer_load_dwordx4 v17, s[8:11], s41 offen offset:1024 nt lds
    s_add_u32 s41, s58, 407552
    buffer_load_dwordx4 v17, s[8:11], s41 offen offset:2048 nt lds
    s_add_u32 s41, s58, 439296
    buffer_load_dwordx4 v17, s[8:11], s41 offen offset:3072 nt lds
    v_add_u32 v77, 110592, v20
    ds_read_b64_tr_b16 a[216:217], v77 offset:0
    ds_read_b64_tr_b16 a[218:219], v77 offset:4096
    ds_read_b64_tr_b16 a[220:221], v77 offset:8192
    ds_read_b64_tr_b16 a[222:223], v77 offset:12288
    ds_read_b64_tr_b16 a[224:225], v77 offset:8
    ds_read_b64_tr_b16 a[226:227], v77 offset:4104
    ds_read_b64_tr_b16 a[228:229], v77 offset:8200
    ds_read_b64_tr_b16 a[230:231], v77 offset:12296
    s_waitcnt vmcnt(12) lgkmcnt(0)
    s_barrier
    s_add_u32 m0, s43, 110592
    s_add_u32 s41, s58, 524288
    buffer_load_dwordx4 v17, s[8:11], s41 offen offset:0 nt lds
    s_add_u32 s41, s58, 556032
    buffer_load_dwordx4 v17, s[8:11], s41 offen offset:1024 nt lds
    s_add_u32 s41, s58, 653312
    buffer_load_dwordx4 v17, s[8:11], s41 offen offset:2048 nt lds
    s_add_u32 s41, s58, 685056
    buffer_load_dwordx4 v17, s[8:11], s41 offen offset:3072 nt lds
    v_add_u32 v28, 147456, v24
    v_add_u32 v29, 147456, v25
    v_add_u32 v30, 147456, v26
    v_add_u32 v31, 147456, v27
    ds_read_b64_tr_b16 v[0:1], v28 offset:0
    ds_read_b64_tr_b16 v[2:3], v28 offset:8
    ds_read_b64_tr_b16 v[4:5], v29 offset:0
    ds_read_b64_tr_b16 v[6:7], v29 offset:8
    ds_read_b64_tr_b16 a[0:1], v30 offset:0
    ds_read_b64_tr_b16 v[8:9], v30 offset:8
    ds_read_b64_tr_b16 a[8:9], v31 offset:0
    ds_read_b64_tr_b16 v[10:11], v31 offset:8
    s_waitcnt vmcnt(12) lgkmcnt(0)
    s_barrier
    s_add_u32 m0, s43, 147456
    s_add_u32 s41, s58, 540672
    buffer_load_dwordx4 v17, s[8:11], s41 offen offset:0 nt lds
    s_add_u32 s41, s58, 572416
    buffer_load_dwordx4 v17, s[8:11], s41 offen offset:1024 nt lds
    s_add_u32 s41, s58, 669696
    buffer_load_dwordx4 v17, s[8:11], s41 offen offset:2048 nt lds
    s_add_u32 s41, s58, 701440
    buffer_load_dwordx4 v17, s[8:11], s41 offen offset:3072 nt lds
    ds_write_b64 v70, v[0:1] offset:0
    ds_write_b64 v70, v[2:3] offset:2048
    ds_write_b64 v70, v[4:5] offset:4096
    ds_write_b64 v70, v[6:7] offset:6144
    ds_write_b64 v70, v[8:9] offset:10240
    ds_write_b64 v70, v[10:11] offset:14336
    v_add_u32 v28, 0, v24
    v_add_u32 v29, 0, v25
    v_add_u32 v30, 0, v26
    v_add_u32 v31, 0, v27
    ds_read_b64_tr_b16 v[32:33], v28 offset:0
    ds_read_b64_tr_b16 v[34:35], v28 offset:8
    ds_read_b64_tr_b16 v[36:37], v29 offset:0
    ds_read_b64_tr_b16 v[38:39], v29 offset:8
    ds_read_b64_tr_b16 a[2:3], v30 offset:0
    ds_read_b64_tr_b16 v[40:41], v30 offset:8
    ds_read_b64_tr_b16 a[10:11], v31 offset:0
    ds_read_b64_tr_b16 v[42:43], v31 offset:8
    s_waitcnt vmcnt(12) lgkmcnt(0)
    s_barrier
    s_add_u32 m0, s43, 0
    s_add_u32 s41, s58, 786432
    buffer_load_dwordx4 v17, s[8:11], s41 offen offset:0 nt lds
    s_add_u32 s41, s58, 818176
    buffer_load_dwordx4 v17, s[8:11], s41 offen offset:1024 nt lds
    s_add_u32 s41, s58, 915456
    buffer_load_dwordx4 v17, s[8:11], s41 offen offset:2048 nt lds
    s_add_u32 s41, s58, 947200
    buffer_load_dwordx4 v17, s[8:11], s41 offen offset:3072 nt lds
    ds_write_b64 v70, v[32:33] offset:8
    ds_write_b64 v70, v[34:35] offset:2056
    ds_write_b64 v70, v[36:37] offset:4104
    ds_write_b64 v70, v[38:39] offset:6152
    ds_write_b64 v70, v[40:41] offset:10248
    ds_write_b64 v70, v[42:43] offset:14344
    v_add_u32 v28, 36864, v24
    v_add_u32 v29, 36864, v25
    v_add_u32 v30, 36864, v26
    v_add_u32 v31, 36864, v27
    ds_read_b64_tr_b16 v[0:1], v28 offset:0
    ds_read_b64_tr_b16 v[2:3], v28 offset:8
    ds_read_b64_tr_b16 v[4:5], v29 offset:0
    ds_read_b64_tr_b16 v[6:7], v29 offset:8
    ds_read_b64_tr_b16 a[4:5], v30 offset:0
    ds_read_b64_tr_b16 v[8:9], v30 offset:8
    ds_read_b64_tr_b16 a[12:13], v31 offset:0
    ds_read_b64_tr_b16 v[10:11], v31 offset:8
    s_waitcnt vmcnt(12) lgkmcnt(0)
    s_barrier
    s_add_u32 m0, s43, 36864
    s_add_u32 s41, s58, 802816
    buffer_load_dwordx4 v17, s[8:11], s41 offen offset:0 nt lds
    s_add_u32 s41, s58, 834560
    buffer_load_dwordx4 v17, s[8:11], s41 offen offset:1024 nt lds
    s_add_u32 s41, s58, 931840
    buffer_load_dwordx4 v17, s[8:11], s41 offen offset:2048 nt lds
    s_add_u32 s41, s58, 963584
    buffer_load_dwordx4 v17, s[8:11], s41 offen offset:3072 nt lds
    ds_write_b64 v70, v[0:1] offset:1024
    ds_write_b64 v70, v[2:3] offset:3072
    ds_write_b64 v70, v[4:5] offset:5120
    ds_write_b64 v70, v[6:7] offset:7168
    ds_write_b64 v70, v[8:9] offset:11264
    ds_write_b64 v70, v[10:11] offset:15360
    v_add_u32 v28, 73728, v24
    v_add_u32 v29, 73728, v25
    v_add_u32 v30, 73728, v26
    v_add_u32 v31, 73728, v27
    ds_read_b64_tr_b16 v[32:33], v28 offset:0
    ds_read_b64_tr_b16 v[34:35], v28 offset:8
    ds_read_b64_tr_b16 v[36:37], v29 offset:0
    ds_read_b64_tr_b16 v[38:39], v29 offset:8
    ds_read_b64_tr_b16 a[6:7], v30 offset:0
    ds_read_b64_tr_b16 v[40:41], v30 offset:8
    ds_read_b64_tr_b16 a[14:15], v31 offset:0
    ds_read_b64_tr_b16 v[42:43], v31 offset:8
    s_waitcnt vmcnt(12) lgkmcnt(0)
    s_barrier
    s_add_u32 m0, s43, 73728
    s_add_u32 s41, s59, 0
    buffer_load_dwordx4 v17, s[8:11], s41 offen offset:0 nt lds
    s_add_u32 s41, s59, 31744
    buffer_load_dwordx4 v17, s[8:11], s41 offen offset:1024 nt lds
    s_add_u32 s41, s59, 129024
    buffer_load_dwordx4 v17, s[8:11], s41 offen offset:2048 nt lds
    s_add_u32 s41, s59, 160768
    buffer_load_dwordx4 v17, s[8:11], s41 offen offset:3072 nt lds
    ds_write_b64 v70, v[32:33] offset:1032
    ds_write_b64 v70, v[34:35] offset:3080
    ds_write_b64 v70, v[36:37] offset:5128
    ds_write_b64 v70, v[38:39] offset:7176
    ds_write_b64 v70, v[40:41] offset:11272
    ds_write_b64 v70, v[42:43] offset:15368
    v_add_u32 v28, 110592, v24
    v_add_u32 v29, 110592, v25
    v_add_u32 v30, 110592, v26
    v_add_u32 v31, 110592, v27
    ds_read_b64_tr_b16 a[16:17], v28 offset:0
    ds_read_b64_tr_b16 a[24:25], v28 offset:8
    ds_read_b64_tr_b16 a[32:33], v29 offset:0
    ds_read_b64_tr_b16 a[40:41], v29 offset:8
    ds_read_b64_tr_b16 a[48:49], v30 offset:0
    ds_read_b64_tr_b16 a[56:57], v30 offset:8
    ds_read_b64_tr_b16 a[64:65], v31 offset:0
    ds_read_b64_tr_b16 a[72:73], v31 offset:8
    s_waitcnt vmcnt(12) lgkmcnt(0)
    s_barrier
    s_mov_b64 s[8:9], s[54:55]
    s_add_u32 m0, s43, 110592
    s_add_u32 s41, s58, 0
    buffer_load_dwordx4 v17, s[8:11], s41 offen offset:0 nt lds
    s_add_u32 s41, s58, 31744
    buffer_load_dwordx4 v17, s[8:11], s41 offen offset:1024 nt lds
    s_add_u32 s41, s58, 129024
    buffer_load_dwordx4 v17, s[8:11], s41 offen offset:2048 nt lds
    s_add_u32 s41, s58, 160768
    buffer_load_dwordx4 v17, s[8:11], s41 offen offset:3072 nt lds
    v_add_u32 v28, 147456, v24
    v_add_u32 v29, 147456, v25
    v_add_u32 v30, 147456, v26
    v_add_u32 v31, 147456, v27
    ds_read_b64_tr_b16 a[18:19], v28 offset:0
    ds_read_b64_tr_b16 a[26:27], v28 offset:8
    ds_read_b64_tr_b16 a[34:35], v29 offset:0
    ds_read_b64_tr_b16 a[42:43], v29 offset:8
    ds_read_b64_tr_b16 a[50:51], v30 offset:0
    ds_read_b64_tr_b16 a[58:59], v30 offset:8
    ds_read_b64_tr_b16 a[66:67], v31 offset:0
    ds_read_b64_tr_b16 a[74:75], v31 offset:8
    s_waitcnt vmcnt(12) lgkmcnt(0)
    s_barrier
    s_add_u32 m0, s43, 147456
    s_add_u32 s41, s58, 16384
    buffer_load_dwordx4 v17, s[8:11], s41 offen offset:0 nt lds
    s_add_u32 s41, s58, 48128
    buffer_load_dwordx4 v17, s[8:11], s41 offen offset:1024 nt lds
    s_add_u32 s41, s58, 145408
    buffer_load_dwordx4 v17, s[8:11], s41 offen offset:2048 nt lds
    s_add_u32 s41, s58, 177152
    buffer_load_dwordx4 v17, s[8:11], s41 offen offset:3072 nt lds
    v_add_u32 v28, 0, v24
    v_add_u32 v29, 0, v25
    v_add_u32 v30, 0, v26
    v_add_u32 v31, 0, v27
    ds_read_b64_tr_b16 a[20:21], v28 offset:0
    ds_read_b64_tr_b16 a[28:29], v28 offset:8
    ds_read_b64_tr_b16 a[36:37], v29 offset:0
    ds_read_b64_tr_b16 a[44:45], v29 offset:8
    ds_read_b64_tr_b16 a[52:53], v30 offset:0
    ds_read_b64_tr_b16 a[60:61], v30 offset:8
    ds_read_b64_tr_b16 a[68:69], v31 offset:0
    ds_read_b64_tr_b16 a[76:77], v31 offset:8
    s_waitcnt vmcnt(12) lgkmcnt(0)
    s_barrier
    s_add_u32 m0, s43, 0
    s_add_u32 s41, s58, 262144
    buffer_load_dwordx4 v17, s[8:11], s41 offen offset:0 nt lds
    s_add_u32 s41, s58, 293888
    buffer_load_dwordx4 v17, s[8:11], s41 offen offset:1024 nt lds
    s_add_u32 s41, s58, 391168
    buffer_load_dwordx4 v17, s[8:11], s41 offen offset:2048 nt lds
    s_add_u32 s41, s58, 422912
    buffer_load_dwordx4 v17, s[8:11], s41 offen offset:3072 nt lds
    v_add_u32 v28, 36864, v24
    v_add_u32 v29, 36864, v25
    v_add_u32 v30, 36864, v26
    v_add_u32 v31, 36864, v27
    ds_read_b64_tr_b16 a[22:23], v28 offset:0
    ds_read_b64_tr_b16 a[30:31], v28 offset:8
    ds_read_b64_tr_b16 a[38:39], v29 offset:0
    ds_read_b64_tr_b16 a[46:47], v29 offset:8
    ds_read_b64_tr_b16 a[54:55], v30 offset:0
    ds_read_b64_tr_b16 a[62:63], v30 offset:8
    ds_read_b64_tr_b16 a[70:71], v31 offset:0
    ds_read_b64_tr_b16 a[78:79], v31 offset:8
    s_waitcnt vmcnt(12) lgkmcnt(0)
    s_barrier
    s_add_u32 m0, s43, 36864
    s_add_u32 s41, s58, 278528
    buffer_load_dwordx4 v17, s[8:11], s41 offen offset:0 nt lds
    s_add_u32 s41, s58, 310272
    buffer_load_dwordx4 v17, s[8:11], s41 offen offset:1024 nt lds
    s_add_u32 s41, s58, 407552
    buffer_load_dwordx4 v17, s[8:11], s41 offen offset:2048 nt lds
    s_add_u32 s41, s58, 439296
    buffer_load_dwordx4 v17, s[8:11], s41 offen offset:3072 nt lds
    v_add_u32 v77, 73728, v20
    ds_read_b64_tr_b16 a[80:81], v77 offset:0
    ds_read_b64_tr_b16 a[82:83], v77 offset:4096
    ds_read_b64_tr_b16 a[84:85], v77 offset:8192
    ds_read_b64_tr_b16 a[86:87], v77 offset:12288
    ds_read_b64_tr_b16 a[88:89], v77 offset:8
    ds_read_b64_tr_b16 a[90:91], v77 offset:4104
    ds_read_b64_tr_b16 a[92:93], v77 offset:8200
    ds_read_b64_tr_b16 a[94:95], v77 offset:12296
    s_waitcnt vmcnt(12) lgkmcnt(0)
    s_barrier
    s_add_u32 m0, s43, 73728
    s_add_u32 s41, s58, 524288
    buffer_load_dwordx4 v17, s[8:11], s41 offen offset:0 nt lds
    s_add_u32 s41, s58, 556032
    buffer_load_dwordx4 v17, s[8:11], s41 offen offset:1024 nt lds
    s_add_u32 s41, s58, 653312
    buffer_load_dwordx4 v17, s[8:11], s41 offen offset:2048 nt lds
    s_add_u32 s41, s58, 685056
    buffer_load_dwordx4 v17, s[8:11], s41 offen offset:3072 nt lds
    v_add_u32 v28, 110592, v24
    v_add_u32 v29, 110592, v25
    v_add_u32 v30, 110592, v26
    v_add_u32 v31, 110592, v27
    ds_read_b64_tr_b16 a[232:233], v28 offset:0
    ds_read_b64_tr_b16 v[32:33], v28 offset:8
    ds_read_b64_tr_b16 a[240:241], v29 offset:0
    ds_read_b64_tr_b16 a[248:249], v29 offset:8
    ds_read_b64_tr_b16 v[144:145], v30 offset:0
    ds_read_b64_tr_b16 v[152:153], v30 offset:8
    ds_read_b64_tr_b16 v[160:161], v31 offset:0
    ds_read_b64_tr_b16 v[168:169], v31 offset:8
    s_waitcnt vmcnt(12) lgkmcnt(0)
    s_barrier
    s_add_u32 m0, s43, 110592
    s_add_u32 s41, s58, 540672
    buffer_load_dwordx4 v17, s[8:11], s41 offen offset:0 nt lds
    s_add_u32 s41, s58, 572416
    buffer_load_dwordx4 v17, s[8:11], s41 offen offset:1024 nt lds
    s_add_u32 s41, s58, 669696
    buffer_load_dwordx4 v17, s[8:11], s41 offen offset:2048 nt lds
    s_add_u32 s41, s58, 701440
    buffer_load_dwordx4 v17, s[8:11], s41 offen offset:3072 nt lds
    ds_write_b64 v70, v[32:33] offset:8192
    v_add_u32 v28, 147456, v24
    v_add_u32 v29, 147456, v25
    v_add_u32 v30, 147456, v26
    v_add_u32 v31, 147456, v27
    ds_read_b64_tr_b16 a[234:235], v28 offset:0
    ds_read_b64_tr_b16 v[0:1], v28 offset:8
    ds_read_b64_tr_b16 a[242:243], v29 offset:0
    ds_read_b64_tr_b16 a[250:251], v29 offset:8
    ds_read_b64_tr_b16 v[146:147], v30 offset:0
    ds_read_b64_tr_b16 v[154:155], v30 offset:8
    ds_read_b64_tr_b16 v[162:163], v31 offset:0
    ds_read_b64_tr_b16 v[170:171], v31 offset:8
    s_waitcnt vmcnt(12) lgkmcnt(0)
    s_barrier
    s_add_u32 m0, s43, 147456
    s_add_u32 s41, s58, 786432
    buffer_load_dwordx4 v17, s[8:11], s41 offen offset:0 nt lds
    s_add_u32 s41, s58, 818176
    buffer_load_dwordx4 v17, s[8:11], s41 offen offset:1024 nt lds
    s_add_u32 s41, s58, 915456
    buffer_load_dwordx4 v17, s[8:11], s41 offen offset:2048 nt lds
    s_add_u32 s41, s58, 947200
    buffer_load_dwordx4 v17, s[8:11], s41 offen offset:3072 nt lds
    ds_write_b64 v70, v[0:1] offset:8200
    v_add_u32 v28, 0, v24
    v_add_u32 v29, 0, v25
    v_add_u32 v30, 0, v26
    v_add_u32 v31, 0, v27
    ds_read_b64_tr_b16 a[236:237], v28 offset:0
    ds_read_b64_tr_b16 v[32:33], v28 offset:8
    ds_read_b64_tr_b16 a[244:245], v29 offset:0
    ds_read_b64_tr_b16 a[252:253], v29 offset:8
    ds_read_b64_tr_b16 v[148:149], v30 offset:0
    ds_read_b64_tr_b16 v[156:157], v30 offset:8
    ds_read_b64_tr_b16 v[164:165], v31 offset:0
    ds_read_b64_tr_b16 v[172:173], v31 offset:8
    s_waitcnt vmcnt(12) lgkmcnt(0)
    s_barrier
    s_add_u32 m0, s43, 0
    s_add_u32 s41, s58, 802816
    buffer_load_dwordx4 v17, s[8:11], s41 offen offset:0 nt lds
    s_add_u32 s41, s58, 834560
    buffer_load_dwordx4 v17, s[8:11], s41 offen offset:1024 nt lds
    s_add_u32 s41, s58, 931840
    buffer_load_dwordx4 v17, s[8:11], s41 offen offset:2048 nt lds
    s_add_u32 s41, s58, 963584
    buffer_load_dwordx4 v17, s[8:11], s41 offen offset:3072 nt lds
    ds_write_b64 v70, v[32:33] offset:9216
    v_add_u32 v28, 36864, v24
    v_add_u32 v29, 36864, v25
    v_add_u32 v30, 36864, v26
    v_add_u32 v31, 36864, v27
    ds_read_b64_tr_b16 a[238:239], v28 offset:0
    ds_read_b64_tr_b16 v[0:1], v28 offset:8
    ds_read_b64_tr_b16 a[246:247], v29 offset:0
    ds_read_b64_tr_b16 a[254:255], v29 offset:8
    ds_read_b64_tr_b16 v[150:151], v30 offset:0
    ds_read_b64_tr_b16 v[158:159], v30 offset:8
    ds_read_b64_tr_b16 v[166:167], v31 offset:0
    ds_read_b64_tr_b16 v[174:175], v31 offset:8
    s_waitcnt vmcnt(12) lgkmcnt(0)
    s_barrier
    s_add_u32 m0, s43, 36864
    s_add_u32 s41, s59, 0
    buffer_load_dwordx4 v17, s[8:11], s41 offen offset:0 nt lds
    s_add_u32 s41, s59, 31744
    buffer_load_dwordx4 v17, s[8:11], s41 offen offset:1024 nt lds
    s_add_u32 s41, s59, 129024
    buffer_load_dwordx4 v17, s[8:11], s41 offen offset:2048 nt lds
    s_add_u32 s41, s59, 160768
    buffer_load_dwordx4 v17, s[8:11], s41 offen offset:3072 nt lds
    ds_write_b64 v70, v[0:1] offset:9224
    v_add_u32 v28, 73728, v24
    v_add_u32 v29, 73728, v25
    v_add_u32 v30, 73728, v26
    v_add_u32 v31, 73728, v27
    ds_read_b64_tr_b16 v[176:177], v28 offset:0
    ds_read_b64_tr_b16 v[184:185], v28 offset:8
    ds_read_b64_tr_b16 v[192:193], v29 offset:0
    ds_read_b64_tr_b16 v[200:201], v29 offset:8
    ds_read_b64_tr_b16 v[208:209], v30 offset:0
    ds_read_b64_tr_b16 v[216:217], v30 offset:8
    ds_read_b64_tr_b16 v[224:225], v31 offset:0
    ds_read_b64_tr_b16 v[232:233], v31 offset:8
    s_waitcnt vmcnt(12) lgkmcnt(0)
    s_barrier
    s_mov_b64 s[8:9], s[56:57]
    s_add_u32 m0, s43, 73728
    s_add_u32 s41, s60, 128
    buffer_load_dwordx4 v18, s[8:11], s41 offen offset:0 nt lds
    s_add_u32 s41, s60, 8320
    buffer_load_dwordx4 v18, s[8:11], s41 offen offset:1024 nt lds
    s_add_u32 s41, s60, 16512
    buffer_load_dwordx4 v18, s[8:11], s41 offen offset:2048 nt lds
    s_add_u32 s41, s60, 24704
    buffer_load_dwordx4 v18, s[8:11], s41 offen offset:3072 nt lds
    v_add_u32 v28, 110592, v24
    v_add_u32 v29, 110592, v25
    v_add_u32 v30, 110592, v26
    v_add_u32 v31, 110592, v27
    ds_read_b64_tr_b16 v[178:179], v28 offset:0
    ds_read_b64_tr_b16 v[186:187], v28 offset:8
    ds_read_b64_tr_b16 v[194:195], v29 offset:0
    ds_read_b64_tr_b16 v[202:203], v29 offset:8
    ds_read_b64_tr_b16 v[210:211], v30 offset:0
    ds_read_b64_tr_b16 v[218:219], v30 offset:8
    ds_read_b64_tr_b16 v[226:227], v31 offset:0
    ds_read_b64_tr_b16 v[234:235], v31 offset:8
    s_waitcnt vmcnt(12) lgkmcnt(0)
    s_barrier
    s_add_u32 m0, s43, 110592
    s_add_u32 s41, s61, 128
    buffer_load_dwordx4 v18, s[8:11], s41 offen offset:0 nt lds
    s_add_u32 s41, s61, 8320
    buffer_load_dwordx4 v18, s[8:11], s41 offen offset:1024 nt lds
    s_add_u32 s41, s61, 16512
    buffer_load_dwordx4 v18, s[8:11], s41 offen offset:2048 nt lds
    s_add_u32 s41, s61, 24704
    buffer_load_dwordx4 v18, s[8:11], s41 offen offset:3072 nt lds
    v_add_u32 v28, 147456, v24
    v_add_u32 v29, 147456, v25
    v_add_u32 v30, 147456, v26
    v_add_u32 v31, 147456, v27
    ds_read_b64_tr_b16 v[180:181], v28 offset:0
    ds_read_b64_tr_b16 v[188:189], v28 offset:8
    ds_read_b64_tr_b16 v[196:197], v29 offset:0
    ds_read_b64_tr_b16 v[204:205], v29 offset:8
    ds_read_b64_tr_b16 v[212:213], v30 offset:0
    ds_read_b64_tr_b16 v[220:221], v30 offset:8
    ds_read_b64_tr_b16 v[228:229], v31 offset:0
    ds_read_b64_tr_b16 v[236:237], v31 offset:8
    s_waitcnt vmcnt(12) lgkmcnt(0)
    s_barrier
    s_add_u32 m0, s43, 147456
    s_add_u32 s41, s62, 128
    buffer_load_dwordx4 v18, s[8:11], s41 offen offset:0 nt lds
    s_add_u32 s41, s62, 8320
    buffer_load_dwordx4 v18, s[8:11], s41 offen offset:1024 nt lds
    s_add_u32 s41, s62, 16512
    buffer_load_dwordx4 v18, s[8:11], s41 offen offset:2048 nt lds
    s_add_u32 s41, s62, 24704
    buffer_load_dwordx4 v18, s[8:11], s41 offen offset:3072 nt lds
    v_add_u32 v28, 0, v24
    v_add_u32 v29, 0, v25
    v_add_u32 v30, 0, v26
    v_add_u32 v31, 0, v27
    ds_read_b64_tr_b16 v[182:183], v28 offset:0
    ds_read_b64_tr_b16 v[190:191], v28 offset:8
    ds_read_b64_tr_b16 v[198:199], v29 offset:0
    ds_read_b64_tr_b16 v[206:207], v29 offset:8
    ds_read_b64_tr_b16 v[214:215], v30 offset:0
    ds_read_b64_tr_b16 v[222:223], v30 offset:8
    ds_read_b64_tr_b16 v[230:231], v31 offset:0
    ds_read_b64_tr_b16 v[238:239], v31 offset:8
    s_waitcnt vmcnt(12) lgkmcnt(0)
    s_barrier
    s_add_u32 m0, s43, 0
    s_add_u32 s41, s63, 128
    buffer_load_dwordx4 v18, s[8:11], s41 offen offset:0 nt lds
    s_add_u32 s41, s63, 8320
    buffer_load_dwordx4 v18, s[8:11], s41 offen offset:1024 nt lds
    s_add_u32 s41, s63, 16512
    buffer_load_dwordx4 v18, s[8:11], s41 offen offset:2048 nt lds
    s_add_u32 s41, s63, 24704
    buffer_load_dwordx4 v18, s[8:11], s41 offen offset:3072 nt lds
    v_mov_b32 v78, v21
    v_mov_b32 v79, v22
    v_add_u32 v77, 36864, v20
    ds_read_b64_tr_b16 v[240:241], v77 offset:0
    ds_read_b64_tr_b16 v[242:243], v77 offset:4096
    ds_read_b64_tr_b16 v[244:245], v77 offset:8192
    ds_read_b64_tr_b16 v[246:247], v77 offset:12288
    ds_read_b64_tr_b16 v[248:249], v77 offset:8
    ds_read_b64_tr_b16 v[250:251], v77 offset:4104
    ds_read_b64_tr_b16 v[252:253], v77 offset:8200
    ds_read_b64_tr_b16 v[254:255], v77 offset:12296
    s_waitcnt vmcnt(12) lgkmcnt(0)
    s_barrier
    v_add_u32 v77, 73728, v79
    s_waitcnt lgkmcnt(0)
    ds_read_b64_tr_b16 v[0:1], v77 offset:0
    ds_read_b64_tr_b16 v[2:3], v77 offset:256
    ds_read_b64_tr_b16 v[4:5], v77 offset:2048
    ds_read_b64_tr_b16 v[6:7], v77 offset:2304
    ds_read_b64_tr_b16 v[8:9], v77 offset:16
    ds_read_b64_tr_b16 v[10:11], v77 offset:272
    ds_read_b64_tr_b16 v[12:13], v77 offset:2064
    ds_read_b64_tr_b16 v[14:15], v77 offset:2320
    s_waitcnt vmcnt(8) lgkmcnt(0)
    s_barrier
    v_add_u32 v77, 110592, v78
    ds_read_b64_tr_b16 v[16:17], v77 offset:0
    ds_read_b64_tr_b16 v[18:19], v77 offset:256
    ds_read_b64_tr_b16 v[20:21], v77 offset:2048
    ds_read_b64_tr_b16 v[22:23], v77 offset:2304
    ds_read_b64_tr_b16 v[24:25], v77 offset:16
    ds_read_b64_tr_b16 v[26:27], v77 offset:272
    ds_read_b64_tr_b16 v[28:29], v77 offset:2064
    ds_read_b64_tr_b16 v[30:31], v77 offset:2320
    s_waitcnt vmcnt(4) lgkmcnt(0)
    s_barrier
    v_add_u32 v77, 147456, v78
    ds_read_b64_tr_b16 v[32:33], v77 offset:0
    ds_read_b64_tr_b16 v[34:35], v77 offset:256
    ds_read_b64_tr_b16 v[36:37], v77 offset:2048
    ds_read_b64_tr_b16 v[38:39], v77 offset:2304
    ds_read_b64_tr_b16 v[40:41], v77 offset:16
    ds_read_b64_tr_b16 v[42:43], v77 offset:272
    ds_read_b64_tr_b16 v[44:45], v77 offset:2064
    ds_read_b64_tr_b16 v[46:47], v77 offset:2320
    s_waitcnt vmcnt(0) lgkmcnt(0)
    s_barrier
    v_add_u32 v77, 0, v78
    ds_read_b64_tr_b16 v[48:49], v77 offset:0
    ds_read_b64_tr_b16 v[50:51], v77 offset:256
    ds_read_b64_tr_b16 v[52:53], v77 offset:2048
    ds_read_b64_tr_b16 v[54:55], v77 offset:2304
    ds_read_b64_tr_b16 v[56:57], v77 offset:16
    ds_read_b64_tr_b16 v[58:59], v77 offset:272
    ds_read_b64_tr_b16 v[60:61], v77 offset:2064
    ds_read_b64_tr_b16 v[62:63], v77 offset:2320
    s_waitcnt lgkmcnt(0)
    s_barrier
    ds_write_b128 v70, v[0:3] offset:20480
    ds_write_b128 v70, v[4:7] offset:21504
    ds_write_b128 v70, v[8:11] offset:22528
    ds_write_b128 v70, v[12:15] offset:23552
    ds_write_b128 v70, v[16:19] offset:24576
    ds_write_b128 v70, v[20:23] offset:25600
    ds_write_b128 v70, v[24:27] offset:26624
    ds_write_b128 v70, v[28:31] offset:27648
    ds_write_b128 v70, v[32:35] offset:28672
    ds_write_b128 v70, v[36:39] offset:29696
    ds_write_b128 v70, v[40:43] offset:30720
    ds_write_b128 v70, v[44:47] offset:31744
    ds_write_b128 v70, v[48:51] offset:32768
    ds_write_b128 v70, v[52:55] offset:33792
    ds_write_b128 v70, v[56:59] offset:34816
    ds_write_b128 v70, v[60:63] offset:35840
    s_waitcnt lgkmcnt(0)
    v_bfe_u32 v60, v65, 4, 6
    v_and_b32 v61, 15, v60
    v_lshrrev_b32 v62, 4, v60
    v_mov_b32 v50, 0x3f80
    v_mov_b32 v51, 0x3f800000
    v_and_b32 v77, 1, v62
    v_lshlrev_b32 v77, 2, v77
    v_sub_u32 v77, v61, v77
    v_and_b32 v78, 3, v61
    v_lshlrev_b32 v78, 2, v78
    v_lshrrev_b32 v79, 2, v61
    v_add_u32 v78, v78, v79
    v_cmp_eq_u32 vcc, 0, v77
    s_nop 1
    v_cndmask_b32 v8, 0, v50, vcc
    v_cmp_eq_u32 vcc, 1, v77
    s_nop 1
    v_cndmask_b32 v8, v8, v51, vcc
    v_cmp_eq_u32 vcc, 0, v78
    s_nop 1
    v_cndmask_b32 v12, 0, v50, vcc
    v_cmp_eq_u32 vcc, 1, v78
    s_nop 1
    v_cndmask_b32 v12, v12, v51, vcc
    v_cmp_eq_u32 vcc, 2, v77
    s_nop 1
    v_cndmask_b32 v9, 0, v50, vcc
    v_cmp_eq_u32 vcc, 3, v77
    s_nop 1
    v_cndmask_b32 v9, v9, v51, vcc
    v_cmp_eq_u32 vcc, 2, v78
    s_nop 1
    v_cndmask_b32 v13, 0, v50, vcc
    v_cmp_eq_u32 vcc, 3, v78
    s_nop 1
    v_cndmask_b32 v13, v13, v51, vcc
    v_cmp_eq_u32 vcc, 8, v77
    s_nop 1
    v_cndmask_b32 v10, 0, v50, vcc
    v_cmp_eq_u32 vcc, 9, v77
    s_nop 1
    v_cndmask_b32 v10, v10, v51, vcc
    v_cmp_eq_u32 vcc, 4, v78
    s_nop 1
    v_cndmask_b32 v14, 0, v50, vcc
    v_cmp_eq_u32 vcc, 5, v78
    s_nop 1
    v_cndmask_b32 v14, v14, v51, vcc
    v_cmp_eq_u32 vcc, 10, v77
    s_nop 1
    v_cndmask_b32 v11, 0, v50, vcc
    v_cmp_eq_u32 vcc, 11, v77
    s_nop 1
    v_cndmask_b32 v11, v11, v51, vcc
    v_cmp_eq_u32 vcc, 6, v78
    s_nop 1
    v_cndmask_b32 v15, 0, v50, vcc
    v_cmp_eq_u32 vcc, 7, v78
    s_nop 1
    v_cndmask_b32 v15, v15, v51, vcc
    v_lshlrev_b32 v77, 4, v61
    ds_write_b128 v69, v[8:11] offset:15360
    ds_write_b128 v77, v[12:15] offset:15872
    s_waitcnt vmcnt(0) lgkmcnt(0)
    s_barrier
    v_mov_b32 v2, 1
    s_cmp_lg_u32 s13, 0
    s_cbranch_scc1 cs_noarr
    s_mov_b64 exec, 1
    buffer_atomic_add v2, off, s[84:87], 0 offset:212
    s_mov_b32 s40, 16777216
    s_mov_b32 s42, 2
cs_startpoll:
    buffer_load_dword v3, off, s[84:87], 0 offset:212 sc1
    s_sub_u32 s40, s40, 1
    s_cbranch_scc1 cs_decide
    s_waitcnt vmcnt(0)
    v_readfirstlane_b32 s41, v3
    s_nop 1
    s_cmp_lt_u32 s41, 32
    s_cbranch_scc1 cs_startpoll
    s_mov_b32 s42, 1
cs_decide:
    s_mov_b64 exec, -1
cs_noarr:
    s_barrier
    s_mov_b32 s44, 0x3e0293ee
    s_mov_b32 s45, s44
    s_or_b32 s66, s44, 0x80000000
    s_mov_b32 s48, 0x3f003f00
    s_mov_b32 s49, 0
    s_mov_b32 s50, 0x3f803f80
    s_mov_b32 s51, 0x3f803f80
    s_mov_b32 s52, 512
    s_mov_b32 s53, 1024
    s_mov_b32 s54, 1536
    s_mov_b32 s30, 0
    s_mov_b32 s37, 0
    s_lshl_b32 s47, s13, 9
    s_cmp_lg_u32 s32, 0
    s_cselect_b32 s71, s13, 3
    s_add_u32 s46, s71, 1
    s_lshr_b32 s46, s46, 1
    s_mov_b32 s14, 67649536
    s_mov_b32 s15, 67653632
    s_mov_b32 s16, 67657728
    s_mov_b32 s36, 0
    s_add_u32 s17, s68, 67633152
    s_mov_b32 s69, 0
    s_mov_b32 s70, 0
    s_lshl_b32 s26, s12, 14
    s_add_u32 s26, s26, 0
    s_mul_i32 s40, s13, 3072
    s_add_u32 s24, s26, s40
    s_lshl_b32 s96, s12, 7
    s_add_u32 s29, s96, 125845504
    s_add_u32 s96, s96, 125829120
    s_lshl_b32 s40, s12, 14
    s_add_u32 s40, s40, 68681728
    s_add_u32 s18, s40, 0
    s_add_u32 s19, s40, 4096
    s_add_u32 s20, s40, 8192
    s_add_u32 s21, s40, 12288
    s_lshr_b32 s40, s12, 3
    s_lshl_b32 s40, s40, 12
    s_and_b32 s41, s12, 7
    s_lshl_b32 s41, s41, 7
    s_add_u32 s40, s40, s41
    s_add_u32 s22, s40, 68681728
    s_add_u32 s23, s22, 1024
    s_add_u32 s25, s22, 2048
    s_mov_b32 s56, -65472
    s_cmp_lg_u32 s32, 0
    s_cselect_b64 s[38:39], -1, 0
    s_add_u32 s55, s68, 138412032
    s_cmp_eq_u32 s13, 3
    s_cselect_b64 s[100:101], 1, 0
    s_cselect_b64 s[38:39], 1, s[38:39]
    s_cselect_b32 s93, 64, 0
    s_cselect_b32 s55, s29, s55
    s_cselect_b32 s57, 0, 9216
    s_mov_b64 exec, s[100:101]
    v_mov_b32 v72, s95
    s_mov_b64 exec, -1
    s_mov_b32 s34, 0xff00ff00
    s_mov_b32 s35, 0xff00ff00
    s_lshl_b32 s28, s12, 12
    s_add_u32 s28, s28, 7340032
    s_add_u32 s27, s28, 77594624
    s_add_u32 s28, s28, 69206016
    s_mov_b32 s40, 3
    v_bfe_u32 v78, v65, 2, 5
    s_mov_b32 s31, 4194304
cs_kv0:
    buffer_load_dword v77, v78, s[4:7], s96 offen offset:16 sc1
    s_waitcnt vmcnt(0)
    v_subrev_u32 v77, s95, v77
    v_cmp_lt_u32 vcc, 16, v77
    s_nop 1
    v_cndmask_b32 v77, v77, 0, vcc
    v_bfe_u32 v79, v78, 2, 2
    v_lshl_add_u32 v77, v77, 2, v79
    s_nop 1
    v_min_u32_dpp v77, v77, v77 row_ror:1 row_mask:0xf bank_mask:0xf
    s_nop 1
    v_min_u32_dpp v77, v77, v77 row_ror:2 row_mask:0xf bank_mask:0xf
    s_nop 1
    v_min_u32_dpp v77, v77, v77 row_ror:4 row_mask:0xf bank_mask:0xf
    s_nop 0
    v_readfirstlane_b32 s97, v77
    s_sub_u32 s31, s31, 1
    s_cbranch_scc1 cs_kv0_x
    s_cmp_le_u32 s40, s97
    s_cbranch_scc1 cs_kv0_x
    s_sleep 2
    s_branch cs_kv0
cs_kv0_x:
    s_add_u32 s40, s24, 0
    s_add_u32 s40, s40, s33
    s_sub_u32 s41, s96, s40
    v_bfe_u32 v77, v65, 2, 5
    v_add3_u32 v77, v77, s41, 16
    v_lshlrev_b32 v78, 3, v69
    s_nop 0
    v_mov_b32_dpp v78, v77 quad_perm:[0,1,2,3] row_mask:0xc bank_mask:0xf
    buffer_load_dword v76, v78, s[4:7], s40 offen sc1
    s_add_u32 s40, s24, 524288
    s_add_u32 s40, s40, s33
    s_sub_u32 s41, s96, s40
    v_bfe_u32 v77, v65, 2, 5
    v_add3_u32 v77, v77, s41, 16
    v_lshlrev_b32 v78, 3, v69
    s_nop 0
    v_mov_b32_dpp v78, v77 quad_perm:[0,1,2,3] row_mask:0xc bank_mask:0xf
    buffer_load_dword v76, v78, s[4:7], s40 offen sc1
cs_kvdone:
    v_mov_b64 v[0:1], 0
    v_mov_b64 v[2:3], 0
    v_mov_b64 v[4:5], 0
    v_mov_b64 v[6:7], 0
    v_mov_b64 v[8:9], 0
    v_mov_b64 v[10:11], 0
    v_mov_b64 v[12:13], 0
    v_mov_b64 v[14:15], 0
    v_mov_b64 v[16:17], 0
    v_mov_b64 v[18:19], 0
    v_mov_b64 v[20:21], 0
    v_mov_b64 v[22:23], 0
    ds_read_b128 v[44:47], v70 offset:0
    ds_read_b128 v[48:51], v70 offset:1024
    ds_read_b128 v[52:55], v70 offset:2048
    ds_read_b128 v[56:59], v70 offset:3072
    ds_read_b128 v[24:27], v70 offset:4096
    ds_read_b128 v[28:31], v70 offset:5120
    ds_read_b128 v[32:35], v70 offset:6144
    ds_read_b128 v[36:39], v70 offset:7168
    buffer_load_dwordx4 v[40:43], v65, s[4:7], s14 offen offset:0 sc1
    buffer_load_dwordx4 v[60:63], v66, s[4:7], s14 offen offset:0 sc1
    s_mov_b32 s31, 1048576
    s_waitcnt vmcnt(0) lgkmcnt(0)
    s_branch cs_goA
cs_loop:
    s_mov_b32 s31, 1048576
    s_mov_b32 s69, s70
    s_waitcnt lgkmcnt(0)
cs_cA:
    buffer_load_dwordx4 v[40:43], v65, s[4:7], s14 offen offset:0 sc1
    buffer_load_dwordx4 v[60:63], v66, s[4:7], s14 offen offset:0 sc1
cs_cA1:
    v_bitop3_b32 v77, v40, v60, s70 bitop3:0x7e
    v_and_b32 v77, 1, v77
    v_cmp_ne_u32 vcc, 0, v77
    s_cbranch_vccz cs_goA
    s_nop 15
    s_nop 15
    s_nop 7
    v_bitop3_b32 v77, v40, v60, s70 bitop3:0x7e
    v_and_b32 v77, 1, v77
    v_cmp_ne_u32 vcc, 0, v77
    s_cbranch_vccz cs_goA
    s_nop 15
    s_nop 15
    s_nop 7
    v_bitop3_b32 v77, v40, v60, s70 bitop3:0x7e
    v_and_b32 v77, 1, v77
    v_cmp_ne_u32 vcc, 0, v77
    s_cbranch_vccz cs_goA
    s_nop 15
    s_nop 15
    s_nop 7
    v_bitop3_b32 v77, v40, v60, s70 bitop3:0x7e
    v_and_b32 v77, 1, v77
    v_cmp_ne_u32 vcc, 0, v77
    s_cbranch_vccz cs_goA
    s_nop 15
    s_nop 15
    s_nop 7
    buffer_load_dwordx4 v[40:43], v65, s[4:7], s14 offen offset:0 sc1
    buffer_load_dwordx4 v[60:63], v66, s[4:7], s14 offen offset:0 sc1
    v_bitop3_b32 v77, v40, v60, s70 bitop3:0x7e
    v_and_b32 v77, 1, v77
    v_cmp_ne_u32 vcc, 0, v77
    s_cbranch_vccz cs_goA
    s_nop 15
    s_nop 15
    s_nop 7
    v_bitop3_b32 v77, v40, v60, s70 bitop3:0x7e
    v_and_b32 v77, 1, v77
    v_cmp_ne_u32 vcc, 0, v77
    s_cbranch_vccz cs_goA
    s_nop 15
    s_nop 15
    s_nop 7
    v_bitop3_b32 v77, v40, v60, s70 bitop3:0x7e
    v_and_b32 v77, 1, v77
    v_cmp_ne_u32 vcc, 0, v77
    s_cbranch_vccz cs_goA
    s_nop 15
    s_nop 15
    s_nop 7
    v_bitop3_b32 v77, v40, v60, s70 bitop3:0x7e
    v_and_b32 v77, 1, v77
    v_cmp_ne_u32 vcc, 0, v77
    s_cbranch_vccz cs_goA
    s_nop 15
    s_nop 15
    s_nop 7
    buffer_load_dwordx4 v[40:43], v65, s[4:7], s14 offen offset:0 sc1
    buffer_load_dwordx4 v[60:63], v66, s[4:7], s14 offen offset:0 sc1
    v_bitop3_b32 v77, v40, v60, s70 bitop3:0x7e
    v_and_b32 v77, 1, v77
    v_cmp_ne_u32 vcc, 0, v77
    s_cbranch_vccz cs_goA
    s_nop 15
    s_nop 15
    s_nop 7
    v_bitop3_b32 v77, v40, v60, s70 bitop3:0x7e
    v_and_b32 v77, 1, v77
    v_cmp_ne_u32 vcc, 0, v77
    s_cbranch_vccz cs_goA
    s_nop 15
    s_nop 15
    s_nop 7
    v_bitop3_b32 v77, v40, v60, s70 bitop3:0x7e
    v_and_b32 v77, 1, v77
    v_cmp_ne_u32 vcc, 0, v77
    s_cbranch_vccz cs_goA
    s_nop 15
    s_nop 15
    s_nop 7
    v_bitop3_b32 v77, v40, v60, s70 bitop3:0x7e
    v_and_b32 v77, 1, v77
    v_cmp_ne_u32 vcc, 0, v77
    s_cbranch_vccz cs_goA
    s_nop 15
    s_nop 15
    s_nop 7
    buffer_load_dwordx4 v[40:43], v65, s[4:7], s14 offen offset:0 sc1
    buffer_load_dwordx4 v[60:63], v66, s[4:7], s14 offen offset:0 sc1
    v_bitop3_b32 v77, v40, v60, s70 bitop3:0x7e
    v_and_b32 v77, 1, v77
    v_cmp_ne_u32 vcc, 0, v77
    s_cbranch_vccz cs_goA
    s_nop 15
    s_nop 15
    s_nop 7
    v_bitop3_b32 v77, v40, v60, s70 bitop3:0x7e
    v_and_b32 v77, 1, v77
    v_cmp_ne_u32 vcc, 0, v77
    s_cbranch_vccz cs_goA
    s_nop 15
    s_nop 15
    s_nop 7
    v_bitop3_b32 v77, v40, v60, s70 bitop3:0x7e
    v_and_b32 v77, 1, v77
    v_cmp_ne_u32 vcc, 0, v77
    s_cbranch_vccz cs_goA
    s_nop 15
    s_nop 15
    s_nop 7
    v_bitop3_b32 v77, v40, v60, s70 bitop3:0x7e
    v_and_b32 v77, 1, v77
    v_cmp_ne_u32 vcc, 0, v77
    s_cbranch_vccz cs_goA
    s_nop 15
    s_nop 15
    s_nop 7
    s_sub_u32 s31, s31, 64
    s_cbranch_scc0 cs_cA
cs_goA:
    ds_write_b128 v65, v[40:43] offset:0
    v_smfmac_f32_16x16x64_bf16 v[0:3], v[40:43], v[44:51], v64
    v_smfmac_f32_16x16x64_bf16 v[4:7], v[40:43], v[52:59], v64
    buffer_load_dwordx4 v[44:47], v65, s[4:7], s15 offen offset:0 sc1
    v_smfmac_f32_16x16x64_bf16 v[0:3], v[60:63], v[24:31], v64
    s_add_u32 s40, s24, 1048576
    s_add_u32 s40, s40, s33
    s_sub_u32 s41, s96, s40
    v_smfmac_f32_16x16x64_bf16 v[4:7], v[60:63], v[32:39], v64
    ds_read_b128 v[24:27], v70 offset:8192
    s_cmp_lt_u32 s97, s93
    s_cselect_b32 s41, s41, 0
    v_smfmac_f32_16x16x64_bf16 v[8:11], v[40:43], a[96:103], v64
    ds_read_b128 v[28:31], v70 offset:9216
    v_smfmac_f32_16x16x64_bf16 v[12:15], v[40:43], a[104:111], v64
    ds_read_b128 v[32:35], v70 offset:10240
    s_waitcnt lgkmcnt(3)
    s_barrier
    ds_read_b128 v[48:51], v67 offset:0
    v_smfmac_f32_16x16x64_bf16 v[8:11], v[60:63], a[112:119], v64
    ds_read_b128 v[36:39], v70 offset:11264
    v_bitop3_b32 v79, v73, -9, s54 bitop3:0x6a
    v_smfmac_f32_16x16x64_bf16 v[12:15], v[60:63], a[120:127], v64
    buffer_load_dwordx4 v[44:47], v65, s[4:7], s15 offen offset:0 sc1
    v_smfmac_f32_16x16x64_bf16 v[16:19], v[40:43], a[232:239], v64
    ds_read_b128 v[52:55], v68 offset:0
    s_waitcnt lgkmcnt(4)
    v_bfe_u32 v77, v65, 2, 5
    v_smfmac_f32_16x16x64_bf16 v[20:23], v[40:43], v[24:31], v64
    ds_read_b128 v[24:27], v70 offset:12288
    s_waitcnt lgkmcnt(3)
    v_smfmac_f32_16x16x64_bf16 v[0:3], v[48:51], a[0:7], v64
    ds_read_b128 v[28:31], v70 offset:13312
    s_waitcnt lgkmcnt(3)
    v_add3_u32 v77, v77, s41, 16
    v_smfmac_f32_16x16x64_bf16 v[4:7], v[48:51], v[32:39], v64
    buffer_load_dwordx4 v[40:43], v65, s[4:7], s16 offen offset:0 sc1
    v_smfmac_f32_16x16x64_bf16 v[16:19], v[60:63], a[240:247], v64
    ds_read_b128 v[32:35], v70 offset:14336
    v_lshlrev_b32 v78, 3, v69
    v_smfmac_f32_16x16x64_bf16 v[20:23], v[60:63], a[248:255], v64
    ds_read_b128 v[36:39], v70 offset:15360
    v_smfmac_f32_16x16x64_bf16 v[8:11], v[48:51], a[128:135], v64
    s_waitcnt vmcnt(2)
    v_mov_b32_dpp v78, v77 quad_perm:[0,1,2,3] row_mask:0xc bank_mask:0xf
    v_smfmac_f32_16x16x64_bf16 v[12:15], v[48:51], a[136:143], v64
    buffer_load_dwordx4 v[58:61], v65, s[4:7], s24 offen offset:3072 sc1
    s_waitcnt lgkmcnt(2)
    v_and_b32 v77, s36, v44
    v_smfmac_f32_16x16x64_bf16 v[12:15], v[52:55], v[24:31], v64
    ds_write_b128 v65, v[44:47] offset:4096
    v_smfmac_f32_16x16x64_bf16 v[0:3], v[52:55], a[8:15], v64
    v_cmp_ne_u32 vcc, s70, v77
    v_smfmac_f32_16x16x64_bf16 v[8:11], v[52:55], a[144:151], v64
    s_waitcnt lgkmcnt(1)
    v_smfmac_f32_16x16x64_bf16 v[4:7], v[52:55], v[32:39], v64
    s_cbranch_vccnz cs_spinB
cs_backB:
    v_smfmac_f32_16x16x64_bf16 v[16:19], v[44:47], v[176:183], v64
    buffer_load_dwordx4 v[24:27], v65, s[4:7], s24 offen offset:0 sc1
    s_waitcnt lgkmcnt(0)
    s_barrier
    ds_read_b128 v[48:51], v66 offset:4096
    v_smfmac_f32_16x16x64_bf16 v[12:15], v[44:47], a[160:167], v64
    ds_read_b128 v[52:55], v67 offset:4096
    v_smfmac_f32_16x16x64_bf16 v[0:3], v[44:47], a[16:23], v64
    v_smfmac_f32_16x16x64_bf16 v[8:11], v[44:47], a[152:159], v64
    buffer_load_dwordx4 v[28:31], v65, s[4:7], s24 offen offset:1024 sc1
    v_smfmac_f32_16x16x64_bf16 v[4:7], v[44:47], a[24:31], v64
    s_waitcnt vmcnt(4)
    v_smfmac_f32_16x16x64_bf16 v[20:23], v[44:47], v[184:191], v64
    ds_read_b128 v[44:47], v68 offset:4096
    s_waitcnt lgkmcnt(2)
    v_smfmac_f32_16x16x64_bf16 v[0:3], v[48:51], a[32:39], v64
    v_smfmac_f32_16x16x64_bf16 v[8:11], v[48:51], a[168:175], v64
    buffer_load_dwordx4 v[34:37], v65, s[4:7], s24 offen offset:2048 sc1
    v_smfmac_f32_16x16x64_bf16 v[4:7], v[48:51], a[40:47], v64
    s_waitcnt vmcnt(4)
    v_and_b32 v77, s36, v40
    v_smfmac_f32_16x16x64_bf16 v[12:15], v[48:51], a[176:183], v64
    ds_read_b128 v[48:51], v69 offset:15360
    v_cmp_ne_u32 vcc, s70, v77
    v_smfmac_f32_16x16x64_bf16 v[0:3], v[52:55], a[48:55], v64
    s_waitcnt lgkmcnt(1)
    v_smfmac_f32_16x16x64_bf16 v[8:11], v[52:55], a[184:191], v64
    s_cbranch_vccnz cs_spin8
cs_back8:
    v_smfmac_f32_16x16x64_bf16 v[0:3], v[44:47], a[64:71], v64
    buffer_load_dword v76, v78, s[4:7], s40 offen sc1
    v_smfmac_f32_16x16x64_bf16 v[8:11], v[44:47], a[200:207], v64
    v_smfmac_f32_16x16x64_bf16 v[0:3], v[40:43], a[80:87], v64
    s_nop 1
    v_smfmac_f32_16x16x64_bf16 v[8:11], v[40:43], a[216:223], v64
    s_nop 1
    v_lshrrev_b32 v77, 1, v69
    v_smfmac_f32_16x16x64_bf16 v[4:7], v[52:55], a[56:63], v64
    s_nop 1
    v_cvt_pk_bf16_f32 v0, v0, v1
    v_smfmac_f32_16x16x64_bf16 v[12:15], v[52:55], a[192:199], v64
    s_nop 1
    v_cvt_pk_bf16_f32 v1, v2, v3
    v_smfmac_f32_16x16x64_bf16 v[4:7], v[44:47], a[72:79], v64
    s_nop 1
    v_cvt_pk_bf16_f32 v2, v8, v9
    v_smfmac_f32_16x16x64_bf16 v[12:15], v[44:47], a[208:215], v64
    s_nop 1
    v_cvt_pk_bf16_f32 v3, v10, v11
    v_smfmac_f32_16x16x64_bf16 v[4:7], v[40:43], a[88:95], v64
    s_waitcnt lgkmcnt(0)
    s_nop 0
    s_nop 0
    v_smfmac_f32_16x16x64_bf16 v[12:15], v[40:43], a[224:231], v64
    s_nop 2
    v_mfma_f32_16x16x32_bf16 v[8:11], v[0:3], v[48:51], 0
    s_nop 0
    v_cvt_pk_bf16_f32 v4, v4, v5
    v_cvt_pk_bf16_f32 v5, v6, v7
    s_nop 0
    v_cvt_pk_bf16_f32 v6, v12, v13
    v_cvt_pk_bf16_f32 v7, v14, v15
    s_nop 1
    v_mfma_f32_16x16x32_bf16 v[12:15], v[4:7], v[48:51], 0
    ds_read_b128 v[48:51], v66 offset:4096
    v_cvt_pk_bf16_f32 v0, v8, v9
    v_cvt_pk_bf16_f32 v1, v10, v11
    v_smfmac_f32_16x16x64_bf16 v[16:19], v[52:55], v[208:215], v64
    s_waitcnt vmcnt(2)
    s_nop 2
    v_cvt_pk_bf16_f32 v2, v12, v13
    v_cvt_pk_bf16_f32 v3, v14, v15
    s_nop 1
    v_mfma_f32_16x16x32_bf16 v[12:15], v[0:3], v[0:3], 0
    s_nop 1
    v_bitop3_b32 v78, v73, -9, s53 bitop3:0x6a
    v_mfma_f32_16x16x32_bf16 v[4:7], v[24:27], v[0:3], 0
    ds_read_b128 v[24:27], v67 offset:0
    s_nop 1
    v_mfma_f32_16x16x32_bf16 v[8:11], v[28:31], v[0:3], 0
    s_nop 0
    v_mov_b32_dpp v12, v14 row_ror:8 row_mask:0xf bank_mask:0xc
    v_mov_b32_dpp v13, v15 row_ror:8 row_mask:0xf bank_mask:0xc
    v_smfmac_f32_16x16x64_bf16 v[20:23], v[52:55], v[216:223], v64
    ds_write_b64 v71, v[12:13]
    ds_read_b128 v[52:55], v68 offset:0
    s_nop 1
    v_mov_b32_dpp v4, v8 row_ror:8 row_mask:0xf bank_mask:0xc
    v_mov_b32_dpp v5, v9 row_ror:8 row_mask:0xf bank_mask:0xc
    v_mov_b32_dpp v6, v10 row_ror:8 row_mask:0xf bank_mask:0xc
    v_mov_b32_dpp v7, v11 row_ror:8 row_mask:0xf bank_mask:0xc
    v_smfmac_f32_16x16x64_bf16 v[16:19], v[44:47], v[224:231], v64
    ds_write_b128 v65, v[4:7] offset:8192
    v_smfmac_f32_16x16x64_bf16 v[20:23], v[44:47], v[232:239], v64
    s_waitcnt lgkmcnt(3)
    v_smfmac_f32_16x16x64_bf16 v[16:19], v[24:27], v[144:151], v64
    s_waitcnt vmcnt(1)
    v_smfmac_f32_16x16x64_bf16 v[20:23], v[24:27], v[152:159], v64
    s_mov_b64 exec, s[38:39]
    buffer_store_dword v72, v75, s[4:7], s55 offen sc1
    s_mov_b64 exec, -1
    v_smfmac_f32_16x16x64_bf16 v[16:19], v[40:43], v[240:247], v64
    s_cmp_ge_u32 s30, 56
    s_waitcnt lgkmcnt(0)
    s_barrier
    ds_read_b128 v[8:11], v66 offset:8192
    v_smfmac_f32_16x16x64_bf16 v[20:23], v[40:43], v[248:255], v64
    ds_read_b128 v[12:15], v67 offset:8192
    v_smfmac_f32_16x16x64_bf16 v[16:19], v[48:51], v[192:199], v64
    ds_read_b128 v[44:47], v68 offset:8192
    v_smfmac_f32_16x16x64_bf16 v[20:23], v[48:51], v[200:207], v64
    ds_read_b64 v[24:25], v77 offset:14336
    ds_read_b64 v[26:27], v77 offset:14592
    v_smfmac_f32_16x16x64_bf16 v[16:19], v[52:55], v[160:167], v64
    ds_read_b64 v[28:29], v77 offset:14848
    ds_read_b64 v[30:31], v77 offset:15104
    v_bitop3_b32 v77, v73, -9, s52 bitop3:0x6a
    v_smfmac_f32_16x16x64_bf16 v[20:23], v[52:55], v[168:175], v64
    s_cbranch_scc1 cs_rare
cs_rare_x:
    ds_read_b128 v[48:51], v70 offset:22528
    ds_read_b128 v[52:55], v70 offset:23552
    s_waitcnt lgkmcnt(6)
    v_pk_add_f32 v[4:5], v[4:5], v[8:9]
    v_pk_add_f32 v[6:7], v[6:7], v[10:11]
    v_pk_add_f32 v[12:13], v[12:13], v[44:45]
    v_pk_add_f32 v[14:15], v[14:15], v[46:47]
    v_pk_add_f32 v[4:5], v[4:5], v[12:13]
    v_pk_add_f32 v[6:7], v[6:7], v[14:15]
    s_waitcnt lgkmcnt(2)
    v_pk_add_f32 v[24:25], v[24:25], v[26:27]
    v_pk_add_f32 v[28:29], v[28:29], v[30:31]
    v_max3_f32 v8, v4, v5, v6
    v_pk_add_f32 v[24:25], v[24:25], v[28:29]
    v_max_f32 v8, v8, v7
    v_max3_f32 v8, v8, v24, v25
    v_cvt_pk_bf16_f32 v32, v16, v17
    v_cvt_pk_bf16_f32 v38, v18, v19
    v_max_f32_dpp v8, v8, v8 row_ror:8 row_mask:0xf bank_mask:0xf
    v_mov_b32 v9, v8
    v_cvt_pk_bf16_f32 v56, v20, v21
    v_cvt_pk_bf16_f32 v62, v22, v23
    v_permlane32_swap_b32 v8, v9
    v_max_f32 v8, v8, v9
    v_mov_b32 v9, v8
    v_mov_b32 v11, 0
    v_mov_b32 v15, 0
    v_permlane16_swap_b32 v8, v9
    v_max_f32 v8, v8, v9
    v_mul_f32 v8, s66, v8
    v_pk_fma_f32 v[4:5], v[4:5], s[44:45], v[8:9] op_sel_hi:[1,1,0]
    v_pk_fma_f32 v[6:7], v[6:7], s[44:45], v[8:9] op_sel_hi:[1,1,0]
    v_pk_fma_f32 v[24:25], v[24:25], s[44:45], v[8:9] op_sel_hi:[1,1,0]
    v_exp_f32 v4, v4
    v_exp_f32 v5, v5
    v_exp_f32 v6, v6
    v_exp_f32 v7, v7
    v_exp_f32 v24, v24
    v_exp_f32 v25, v25
    v_cvt_pk_bf16_f32 v12, v4, v5
    v_cvt_pk_bf16_f32 v13, v6, v7
    v_cvt_pk_bf16_f32 v10, v24, v25
    v_cvt_pk_bf16_f32 v14, v24, v25
    v_mov_b64 v[0:1], s[48:49]
    v_mfma_f32_16x16x32_bf16 v[4:7], v[32:35], v[10:13], 0
    ds_read_b128 v[40:43], v70 offset:20480
    v_mov_b64 v[2:3], s[50:51]
    v_mfma_f32_16x16x32_bf16 v[24:27], v[36:39], v[12:15], 0
    ds_read_b128 v[44:47], v70 offset:21504
    v_mov_b64 v[8:9], 0
    v_mfma_f32_16x16x32_bf16 v[28:31], v[0:3], v[10:13], 0
    ds_read_b128 v[32:35], v70 offset:24576
    v_mov_b64 v[0:1], 0
    v_mfma_f32_16x16x32_bf16 v[16:19], v[56:59], v[10:13], 0
    ds_read_b128 v[36:39], v70 offset:25600
    v_mov_b64 v[2:3], 0
    v_mfma_f32_16x16x32_bf16 v[20:23], v[60:63], v[12:15], 0
    ds_read_b128 v[56:59], v70 offset:28672
    v_add_f32_dpp v4, v24, v4 row_ror:8 row_mask:0xf bank_mask:0xf
    v_add_f32_dpp v5, v25, v5 row_ror:8 row_mask:0xf bank_mask:0xf
    v_add_f32_dpp v6, v26, v6 row_ror:8 row_mask:0xf bank_mask:0xf
    v_add_f32_dpp v7, v27, v7 row_ror:8 row_mask:0xf bank_mask:0xf
    v_add_f32_dpp v29, v28, v28 row_ror:8 row_mask:0xf bank_mask:0xf
    v_rcp_f32 v28, v29
    v_mov_b64 v[10:11], 0
    v_add_f32_dpp v4, v16, v20 row_ror:8 row_mask:0xf bank_mask:0xc
    v_add_f32_dpp v5, v17, v21 row_ror:8 row_mask:0xf bank_mask:0xc
    v_add_f32_dpp v6, v18, v22 row_ror:8 row_mask:0xf bank_mask:0xc
    v_add_f32_dpp v7, v19, v23 row_ror:8 row_mask:0xf bank_mask:0xc
    v_pk_mul_f32 v[4:5], v[4:5], v[28:29] op_sel_hi:[1,0]
    v_pk_mul_f32 v[6:7], v[6:7], v[28:29] op_sel_hi:[1,0]
    v_cvt_pk_bf16_f32 v4, v4, v5
    v_cvt_pk_bf16_f32 v5, v6, v7
    ds_write_b64 v73, v[4:5] offset:12288
    v_mov_b32_dpp v6, v4 row_ror:8 row_mask:0xf bank_mask:0xf
    v_mov_b32_dpp v7, v5 row_ror:8 row_mask:0xf bank_mask:0xf
    v_mov_b64 v[12:13], 0
    v_mov_b64 v[14:15], 0
    v_smfmac_f32_16x16x64_bf16 v[8:11], v[4:7], v[80:87], v64
    s_waitcnt lgkmcnt(4)
    v_mov_b64 v[24:25], 0
    v_smfmac_f32_16x16x64_bf16 v[0:3], v[4:7], v[40:47], v64
    ds_read_b128 v[60:63], v70 offset:29696
    v_mov_b64 v[26:27], 0
    v_smfmac_f32_16x16x64_bf16 v[12:15], v[4:7], v[112:119], v64
    s_waitcnt lgkmcnt(1)
    s_barrier
    ds_read_b128 v[16:19], v77 offset:12288
    v_smfmac_f32_16x16x64_bf16 v[24:27], v[4:7], v[48:55], v64
    ds_read_b128 v[20:23], v78 offset:12288
    ds_read_b128 v[28:31], v79 offset:12288
    v_mov_b64 v[4:5], 0
    v_mov_b64 v[6:7], 0
    v_bfe_u32 v77, v74, 16, 1
    v_mad_i32_i24 v77, v77, s56, v74
    s_waitcnt lgkmcnt(2)
    v_smfmac_f32_16x16x64_bf16 v[8:11], v[16:19], v[88:95], v64
    ds_read_b128 v[40:43], v70 offset:32768
    s_waitcnt lgkmcnt(2)
    v_smfmac_f32_16x16x64_bf16 v[8:11], v[20:23], v[96:103], v64
    ds_read_b128 v[44:47], v70 offset:33792
    s_waitcnt lgkmcnt(2)
    v_smfmac_f32_16x16x64_bf16 v[8:11], v[28:31], v[104:111], v64
    ds_read_b128 v[48:51], v70 offset:26624
    s_nop 0
    v_and_b32 v72, 8, v73
    v_smfmac_f32_16x16x64_bf16 v[0:3], v[16:19], v[32:39], v64
    ds_read_b128 v[52:55], v70 offset:27648
    s_nop 0
    v_mad_u32_u24 v72, v72, 63, v73
    v_smfmac_f32_16x16x64_bf16 v[12:15], v[16:19], v[120:127], v64
    ds_read_b128 v[32:35], v70 offset:30720
    v_cvt_pk_bf16_f32 v8, v8, v9
    v_cvt_pk_bf16_f32 v9, v10, v11
    v_and_or_b32 v8, v8, -2, s69
    v_smfmac_f32_16x16x64_bf16 v[12:15], v[20:23], v[128:135], v64
    buffer_store_dwordx2 v[8:9], v74, s[4:7], s22 offen offset:0 sc1
    ds_read_b128 v[36:39], v70 offset:31744
    v_smfmac_f32_16x16x64_bf16 v[12:15], v[28:31], v[136:143], v64
    s_add_u32 s30, s30, 1
    s_xor_b32 s70, s70, 1
    v_subrev_u32 v72, s47, v72
    v_smfmac_f32_16x16x64_bf16 v[0:3], v[20:23], v[56:63], v64
    ds_read_b128 v[56:59], v70 offset:34816
    s_waitcnt lgkmcnt(3)
    s_nop 0
    v_smfmac_f32_16x16x64_bf16 v[0:3], v[28:31], v[40:47], v64
    ds_read_b128 v[60:63], v70 offset:35840
    v_cvt_pk_bf16_f32 v12, v12, v13
    v_cvt_pk_bf16_f32 v13, v14, v15
    v_and_or_b32 v12, v12, -2, s69
    v_smfmac_f32_16x16x64_bf16 v[24:27], v[16:19], v[48:55], v64
    buffer_store_dwordx2 v[12:13], v74, s[4:7], s22 offen offset:64 sc1
    s_waitcnt lgkmcnt(2)
    v_smfmac_f32_16x16x64_bf16 v[24:27], v[20:23], v[32:39], v64
    ds_read_b128 v[40:43], v70 offset:16384
    v_cvt_pk_bf16_f32 v0, v0, v1
    v_cvt_pk_bf16_f32 v1, v2, v3
    v_and_or_b32 v0, v0, -2, s69
    s_waitcnt lgkmcnt(1)
    v_smfmac_f32_16x16x64_bf16 v[24:27], v[28:31], v[56:63], v64
    buffer_store_dwordx2 v[0:1], v74, s[4:7], s23 offen offset:0 sc1
    ds_read_b128 v[44:47], v70 offset:17408
    ds_read_b128 v[8:11], v72 offset:12288
    ds_read_b128 v[48:51], v70 offset:18432
    ds_read_b128 v[52:55], v70 offset:19456
    ds_read_b128 v[12:15], v72 offset:13312
    s_cmp_lg_u32 s71, 0
    s_nop 0
    v_cvt_pk_bf16_f32 v24, v24, v25
    v_cvt_pk_bf16_f32 v25, v26, v27
    v_and_or_b32 v24, v24, -2, s69
    buffer_store_dwordx2 v[24:25], v74, s[4:7], s23 offen offset:64 sc1
    s_waitcnt lgkmcnt(3)
    v_smfmac_f32_16x16x64_bf16 v[4:7], v[8:11], v[40:47], v64
    s_waitcnt lgkmcnt(0)
    v_smfmac_f32_16x16x64_bf16 v[4:7], v[12:15], v[48:55], v64
    s_nop 7
    v_cvt_pk_bf16_f32 v4, v4, v5
    v_cvt_pk_bf16_f32 v5, v6, v7
    v_and_or_b32 v4, v4, -2, s69
    buffer_store_dwordx2 v[4:5], v77, s[4:7], s25 offen offset:0 sc1
    s_nop 0
    s_cbranch_scc1 cs_e1
    s_cmp_lg_u32 s37, 0
    s_cbranch_scc1 cs_f0_xt
cs_f0_xtx:
    s_nop 2
    v_mov_b32 v79, v79
    s_nop 2
    v_mov_b32 v79, v79
    s_nop 2
    v_mov_b32 v79, v79
    s_nop 2
    v_mov_b32 v79, v79
    s_nop 2
    v_mov_b32 v79, v79
    s_nop 2
    v_mov_b32 v79, v79
    s_nop 2
    v_mov_b32 v79, v79
    s_nop 2
    v_mov_b32 v79, v79
    s_nop 2
    v_mov_b32 v79, v79
    s_nop 2
    v_mov_b32 v79, v79
    s_nop 2
    v_mov_b32 v79, v79
    s_nop 2
    v_mov_b32 v79, v79
    s_nop 2
    v_mov_b32 v79, v79
    s_nop 2
    v_mov_b32 v79, v79
    s_nop 2
    v_mov_b32 v79, v79
    s_nop 2
    v_mov_b32 v79, v79
    s_nop 2
    v_mov_b32 v79, v79
    s_nop 2
    v_mov_b32 v79, v79
    s_nop 2
    v_mov_b32 v79, v79
    s_nop 2
    v_mov_b32 v79, v79
    s_nop 2
    v_mov_b32 v79, v79
    s_nop 2
    v_mov_b32 v79, v79
    s_nop 2
    v_mov_b32 v79, v79
    s_nop 2
    v_mov_b32 v79, v79
    s_nop 2
    v_mov_b32 v79, v79
    s_nop 2
    v_mov_b32 v79, v79
    s_nop 2
    v_mov_b32 v79, v79
    s_nop 2
    v_mov_b32 v79, v79
    s_nop 2
    v_mov_b32 v79, v79
    s_nop 2
    v_mov_b32 v79, v79
    s_nop 2
    v_mov_b32 v79, v79
    s_nop 2
    v_mov_b32 v79, v79
    s_nop 2
    v_mov_b32 v79, v79
    s_nop 2
    v_mov_b32 v79, v79
    s_nop 2
    v_mov_b32 v79, v79
    s_nop 2
    v_mov_b32 v79, v79
    s_nop 0
    v_mov_b32 v79, v79
    buffer_load_dwordx4 v[8:11], v65, s[4:7], s18 offen sc1
    buffer_load_dwordx4 v[12:15], v65, s[4:7], s19 offen sc1
    buffer_load_dwordx4 v[16:19], v65, s[4:7], s20 offen sc1
    buffer_load_dwordx4 v[20:23], v65, s[4:7], s21 offen sc1
    v_and_b32 v77, 255, v69
    ds_read_b128 v[4:7], v77 offset:15872
    ds_read_b128 v[44:47], v70 offset:0
    ds_read_b128 v[48:51], v70 offset:1024
    ds_read_b128 v[52:55], v70 offset:2048
    ds_read_b128 v[56:59], v70 offset:3072
    ds_read_b128 v[24:27], v70 offset:4096
    ds_read_b128 v[28:31], v70 offset:5120
    ds_read_b128 v[32:35], v70 offset:6144
    ds_read_b128 v[36:39], v70 offset:7168
    s_mov_b32 s31, 65536
    s_add_u32 s24, s24, 524288
    s_add_u32 s26, s26, 524288
    s_add_u32 s55, s55, s57
    s_mov_b32 s14, 67633152
    s_mov_b32 s15, 67637248
    s_mov_b32 s16, 67641344
    s_mov_b32 s36, 1
    v_mov_b32 v40, s69
    v_mov_b32 v60, s69
    v_and_b32 v79, 12, v75
    v_cmp_eq_u32 vcc, 0, v79
    s_nop 1
    v_cndmask_b32 v79, 0, 1, vcc
    s_waitcnt lgkmcnt(0)
    s_waitcnt vmcnt(3)
    v_xor_b32 v77, s69, v8
    v_mfma_f32_16x16x32_bf16 v[0:3], v[4:7], v[8:11], 0
    v_mov_b64 v[8:9], 0
    v_mov_b64 v[10:11], 0
    s_waitcnt vmcnt(2)
    v_bitop3_b32 v77, v77, v12, s69 bitop3:0xf6
    v_mfma_f32_16x16x32_bf16 v[0:3], v[4:7], v[12:15], v[0:3]
    v_mov_b64 v[12:13], 0
    v_mov_b64 v[14:15], 0
    s_waitcnt vmcnt(1)
    v_bitop3_b32 v77, v77, v16, s69 bitop3:0xf6
    v_mfma_f32_16x16x32_bf16 v[0:3], v[4:7], v[16:19], v[0:3]
    v_mov_b64 v[16:17], 0
    v_mov_b64 v[18:19], 0
    s_waitcnt vmcnt(0)
    v_bitop3_b32 v77, v77, v20, s69 bitop3:0xf6
    v_mfma_f32_16x16x32_bf16 v[0:3], v[4:7], v[20:23], v[0:3]
    v_and_b32 v77, 1, v77
    v_cmp_ne_u32 vcc, 0, v77
    v_mov_b64 v[20:21], 0
    v_mov_b64 v[22:23], 0
    s_cmp_eq_u64 vcc, 0
    s_cselect_b64 s[42:43], -1, 0
    s_nop 1
    v_add_f32_dpp v0, v0, v0 row_ror:8 row_mask:0xf bank_mask:0xf
    v_add_f32_dpp v1, v1, v1 row_ror:8 row_mask:0xf bank_mask:0xf
    s_mov_b64 exec, s[42:43]
    v_cvt_pk_bf16_f32 v72, v0, v1
    v_bfi_b32 v72, v79, s70, v72
    buffer_store_dword v72, v75, s[4:7], s17 offen offset:0 sc1
    s_mov_b64 exec, -1
    s_cbranch_scc0 cs_f0_retry
cs_f0_go:
    v_mov_b64 v[0:1], 0
    v_mov_b64 v[2:3], 0
    v_mov_b64 v[4:5], 0
    v_mov_b64 v[6:7], 0
    s_nop 2
    v_mov_b32 v79, v79
    s_nop 2
    v_mov_b32 v79, v79
    s_nop 2
    v_mov_b32 v79, v79
    s_nop 2
    v_mov_b32 v79, v79
    s_nop 2
    v_mov_b32 v79, v79
    s_nop 2
    v_mov_b32 v79, v79
    s_nop 2
    v_mov_b32 v79, v79
    s_nop 2
    v_mov_b32 v79, v79
    s_nop 2
    v_mov_b32 v79, v79
    s_nop 2
    v_mov_b32 v79, v79
    s_nop 2
    v_mov_b32 v79, v79
    s_nop 2
    v_mov_b32 v79, v79
    s_nop 2
    v_mov_b32 v79, v79
    s_nop 2
    v_mov_b32 v79, v79
    s_nop 2
    v_mov_b32 v79, v79
    s_nop 2
    v_mov_b32 v79, v79
    s_nop 2
    v_mov_b32 v79, v79
    s_nop 2
    v_mov_b32 v79, v79
    s_nop 2
    v_mov_b32 v79, v79
    s_nop 2
    v_mov_b32 v79, v79
    s_nop 2
    v_mov_b32 v79, v79
    s_nop 2
    v_mov_b32 v79, v79
    s_nop 2
    v_mov_b32 v79, v79
    s_nop 2
    v_mov_b32 v79, v79
    s_nop 2
    v_mov_b32 v79, v79
    s_branch cs_loop
cs_e1:
    s_cmp_lg_u32 s71, 2
    s_cbranch_scc1 cs_f1
    v_and_b32 v77, 255, v69
    ds_read_b128 v[4:7], v77 offset:15872
    ds_read_b128 v[44:47], v70 offset:0
    ds_read_b128 v[48:51], v70 offset:1024
    ds_read_b128 v[52:55], v70 offset:2048
    ds_read_b128 v[56:59], v70 offset:3072
    ds_read_b128 v[24:27], v70 offset:4096
    ds_read_b128 v[28:31], v70 offset:5120
    ds_read_b128 v[32:35], v70 offset:6144
    ds_read_b128 v[36:39], v70 offset:7168
    s_mov_b32 s31, 65536
    s_add_u32 s24, s24, 524288
    s_add_u32 s26, s26, 524288
    s_add_u32 s55, s55, s57
    s_mov_b32 s14, 67633152
    s_mov_b32 s15, 67637248
    s_mov_b32 s16, 67641344
    s_mov_b32 s36, 1
    v_mov_b32 v40, s69
    v_mov_b32 v60, s69
    v_and_b32 v79, 12, v75
    v_cmp_eq_u32 vcc, 0, v79
    s_nop 1
    v_cndmask_b32 v79, 0, 1, vcc
    s_cmp_lg_u32 s37, 0
    s_cbranch_scc1 cs_f2_xt
cs_f2_xtx:
    s_nop 2
    v_mov_b32 v79, v79
    s_nop 2
    v_mov_b32 v79, v79
    s_nop 2
    v_mov_b32 v79, v79
    s_nop 2
    v_mov_b32 v79, v79
    s_nop 2
    v_mov_b32 v79, v79
    s_nop 2
    v_mov_b32 v79, v79
    s_nop 2
    v_mov_b32 v79, v79
    s_nop 2
    v_mov_b32 v79, v79
    s_nop 2
    v_mov_b32 v79, v79
    s_nop 2
    v_mov_b32 v79, v79
    s_nop 2
    v_mov_b32 v79, v79
    s_nop 2
    v_mov_b32 v79, v79
    s_nop 2
    v_mov_b32 v79, v79
    s_nop 2
    v_mov_b32 v79, v79
    s_nop 2
    v_mov_b32 v79, v79
    s_nop 2
    v_mov_b32 v79, v79
    s_nop 2
    v_mov_b32 v79, v79
    s_nop 2
    v_mov_b32 v79, v79
    s_nop 2
    v_mov_b32 v79, v79
    s_nop 2
    v_mov_b32 v79, v79
    s_nop 2
    v_mov_b32 v79, v79
    s_nop 2
    v_mov_b32 v79, v79
    s_nop 2
    v_mov_b32 v79, v79
    s_nop 2
    v_mov_b32 v79, v79
    s_nop 2
    v_mov_b32 v79, v79
    s_nop 2
    v_mov_b32 v79, v79
    s_nop 2
    v_mov_b32 v79, v79
    s_nop 2
    v_mov_b32 v79, v79
    s_nop 2
    v_mov_b32 v79, v79
    s_nop 2
    v_mov_b32 v79, v79
    s_nop 2
    v_mov_b32 v79, v79
    s_nop 2
    v_mov_b32 v79, v79
    s_nop 2
    v_mov_b32 v79, v79
    s_nop 2
    v_mov_b32 v79, v79
    s_nop 2
    v_mov_b32 v79, v79
    s_nop 2
    v_mov_b32 v79, v79
    s_nop 0
    v_mov_b32 v79, v79
    s_waitcnt vmcnt(0)
    buffer_load_dwordx4 v[8:11], v65, s[4:7], s18 offen sc1
    buffer_load_dwordx4 v[12:15], v65, s[4:7], s19 offen sc1
    buffer_load_dwordx4 v[16:19], v65, s[4:7], s20 offen sc1
    buffer_load_dwordx4 v[20:23], v65, s[4:7], s21 offen sc1
    s_nop 2
    v_mov_b32 v79, v79
    s_nop 2
    v_mov_b32 v79, v79
    s_nop 2
    v_mov_b32 v79, v79
    s_nop 2
    v_mov_b32 v79, v79
    s_nop 2
    v_mov_b32 v79, v79
    s_nop 2
    v_mov_b32 v79, v79
    s_nop 2
    v_mov_b32 v79, v79
    s_nop 2
    v_mov_b32 v79, v79
    s_nop 2
    v_mov_b32 v79, v79
    s_nop 2
    v_mov_b32 v79, v79
    buffer_load_dwordx4 v[40:43], v65, s[4:7], s14 offen offset:0 sc1
    buffer_load_dwordx4 v[60:63], v66, s[4:7], s14 offen offset:0 sc1
    s_waitcnt lgkmcnt(0)
    s_waitcnt vmcnt(5)
    v_xor_b32 v77, s69, v8
    v_mfma_f32_16x16x32_bf16 v[0:3], v[4:7], v[8:11], 0
    v_mov_b64 v[8:9], 0
    v_mov_b64 v[10:11], 0
    s_waitcnt vmcnt(4)
    v_bitop3_b32 v77, v77, v12, s69 bitop3:0xf6
    v_mfma_f32_16x16x32_bf16 v[0:3], v[4:7], v[12:15], v[0:3]
    v_mov_b64 v[12:13], 0
    v_mov_b64 v[14:15], 0
    s_waitcnt vmcnt(3)
    v_bitop3_b32 v77, v77, v16, s69 bitop3:0xf6
    v_mfma_f32_16x16x32_bf16 v[0:3], v[4:7], v[16:19], v[0:3]
    v_mov_b64 v[16:17], 0
    v_mov_b64 v[18:19], 0
    s_waitcnt vmcnt(2)
    v_bitop3_b32 v77, v77, v20, s69 bitop3:0xf6
    v_mfma_f32_16x16x32_bf16 v[0:3], v[4:7], v[20:23], v[0:3]
    v_and_b32 v77, 1, v77
    v_cmp_ne_u32 vcc, 0, v77
    v_mov_b64 v[20:21], 0
    v_mov_b64 v[22:23], 0
    buffer_load_dwordx4 v[40:43], v65, s[4:7], s14 offen offset:0 sc1
    buffer_load_dwordx4 v[60:63], v66, s[4:7], s14 offen offset:0 sc1
    s_cmp_eq_u64 vcc, 0
    s_cselect_b64 s[42:43], -1, 0
    v_add_f32_dpp v0, v0, v0 row_ror:4 row_mask:0xf bank_mask:0xf
    v_add_f32_dpp v1, v1, v1 row_ror:4 row_mask:0xf bank_mask:0xf
    s_nop 0
    v_add_f32_dpp v0, v0, v0 row_ror:8 row_mask:0xf bank_mask:0xf
    v_add_f32_dpp v1, v1, v1 row_ror:8 row_mask:0xf bank_mask:0xf
    s_mov_b64 exec, s[42:43]
    v_cvt_pk_bf16_f32 v72, v0, v1
    v_bfi_b32 v72, v79, s70, v72
    buffer_store_dword v72, v75, s[4:7], s17 offen offset:0 sc1
    buffer_store_dword v72, v75, s[4:7], s17 offen offset:1024 sc1
    buffer_store_dword v72, v75, s[4:7], s17 offen offset:2048 sc1
    buffer_store_dword v72, v75, s[4:7], s17 offen offset:3072 sc1
    s_mov_b64 exec, -1
    s_cbranch_scc0 cs_f2_retry
cs_f2_go:
    v_mov_b64 v[0:1], 0
    v_mov_b64 v[2:3], 0
    v_mov_b64 v[4:5], 0
    v_mov_b64 v[6:7], 0
    s_nop 2
    v_mov_b32 v79, v79
    s_nop 2
    v_mov_b32 v79, v79
    s_nop 2
    v_mov_b32 v79, v79
    s_nop 2
    v_mov_b32 v79, v79
    s_nop 2
    v_mov_b32 v79, v79
    s_nop 2
    v_mov_b32 v79, v79
    s_nop 2
    v_mov_b32 v79, v79
    s_nop 2
    v_mov_b32 v79, v79
    s_nop 2
    v_mov_b32 v79, v79
    s_nop 2
    v_mov_b32 v79, v79
    s_nop 2
    v_mov_b32 v79, v79
    s_nop 2
    v_mov_b32 v79, v79
    s_nop 2
    v_mov_b32 v79, v79
    s_nop 2
    v_mov_b32 v79, v79
    s_nop 2
    v_mov_b32 v79, v79
    s_nop 2
    v_mov_b32 v79, v79
    s_nop 2
    v_mov_b32 v79, v79
    s_nop 2
    v_mov_b32 v79, v79
    s_nop 2
    v_mov_b32 v79, v79
    s_nop 2
    v_mov_b32 v79, v79
    s_nop 2
    v_mov_b32 v79, v79
    s_nop 2
    v_mov_b32 v79, v79
    s_nop 2
    v_mov_b32 v79, v79
    s_nop 2
    v_mov_b32 v79, v79
    s_nop 2
    v_mov_b32 v79, v79
    s_branch cs_loop
cs_f1:
    s_cmp_lg_u32 s32, 1
    s_cbranch_scc1 cs_f3
    v_and_b32 v77, 255, v69
    ds_read_b128 v[4:7], v77 offset:15872
    ds_read_b128 v[44:47], v70 offset:0
    ds_read_b128 v[48:51], v70 offset:1024
    ds_read_b128 v[52:55], v70 offset:2048
    ds_read_b128 v[56:59], v70 offset:3072
    ds_read_b128 v[24:27], v70 offset:4096
    ds_read_b128 v[28:31], v70 offset:5120
    ds_read_b128 v[32:35], v70 offset:6144
    ds_read_b128 v[36:39], v70 offset:7168
    s_mov_b32 s31, 65536
    s_add_u32 s24, s24, 524288
    s_add_u32 s26, s26, 524288
    s_add_u32 s55, s55, s57
    s_mov_b32 s14, 67633152
    s_mov_b32 s15, 67637248
    s_mov_b32 s16, 67641344
    s_mov_b32 s36, 1
    v_mov_b32 v40, s69
    v_mov_b32 v60, s69
    v_and_b32 v79, 12, v75
    v_cmp_eq_u32 vcc, 0, v79
    s_nop 1
    v_cndmask_b32 v79, 0, 1, vcc
    s_cmp_lg_u32 s37, 0
    s_cbranch_scc1 cs_f1_xt
cs_f1_xtx:
    s_nop 2
    v_mov_b32 v79, v79
    s_nop 2
    v_mov_b32 v79, v79
    s_nop 2
    v_mov_b32 v79, v79
    s_nop 2
    v_mov_b32 v79, v79
    s_nop 2
    v_mov_b32 v79, v79
    s_nop 2
    v_mov_b32 v79, v79
    s_nop 2
    v_mov_b32 v79, v79
    s_nop 2
    v_mov_b32 v79, v79
    s_nop 2
    v_mov_b32 v79, v79
    s_nop 2
    v_mov_b32 v79, v79
    s_nop 2
    v_mov_b32 v79, v79
    s_nop 2
    v_mov_b32 v79, v79
    s_nop 2
    v_mov_b32 v79, v79
    s_nop 2
    v_mov_b32 v79, v79
    s_nop 2
    v_mov_b32 v79, v79
    s_nop 2
    v_mov_b32 v79, v79
    s_nop 2
    v_mov_b32 v79, v79
    s_nop 2
    v_mov_b32 v79, v79
    s_nop 2
    v_mov_b32 v79, v79
    s_nop 2
    v_mov_b32 v79, v79
    s_nop 2
    v_mov_b32 v79, v79
    s_nop 2
    v_mov_b32 v79, v79
    s_nop 2
    v_mov_b32 v79, v79
    s_nop 2
    v_mov_b32 v79, v79
    s_nop 2
    v_mov_b32 v79, v79
    s_nop 2
    v_mov_b32 v79, v79
    s_nop 2
    v_mov_b32 v79, v79
    s_nop 2
    v_mov_b32 v79, v79
    s_nop 2
    v_mov_b32 v79, v79
    s_nop 2
    v_mov_b32 v79, v79
    s_nop 2
    v_mov_b32 v79, v79
    s_nop 2
    v_mov_b32 v79, v79
    s_nop 2
    v_mov_b32 v79, v79
    s_nop 2
    v_mov_b32 v79, v79
    s_nop 2
    v_mov_b32 v79, v79
    s_nop 2
    v_mov_b32 v79, v79
    s_nop 0
    v_mov_b32 v79, v79
    s_waitcnt vmcnt(0)
    buffer_load_dwordx4 v[8:11], v65, s[4:7], s18 offen sc1
    buffer_load_dwordx4 v[12:15], v65, s[4:7], s19 offen sc1
    buffer_load_dwordx4 v[16:19], v65, s[4:7], s20 offen sc1
    buffer_load_dwordx4 v[20:23], v65, s[4:7], s21 offen sc1
    s_nop 2
    v_mov_b32 v79, v79
    s_nop 2
    v_mov_b32 v79, v79
    s_nop 2
    v_mov_b32 v79, v79
    s_nop 2
    v_mov_b32 v79, v79
    s_nop 2
    v_mov_b32 v79, v79
    s_nop 2
    v_mov_b32 v79, v79
    s_nop 2
    v_mov_b32 v79, v79
    s_nop 2
    v_mov_b32 v79, v79
    s_nop 2
    v_mov_b32 v79, v79
    s_nop 2
    v_mov_b32 v79, v79
    buffer_load_dwordx4 v[40:43], v65, s[4:7], s14 offen offset:0 sc1
    buffer_load_dwordx4 v[60:63], v66, s[4:7], s14 offen offset:0 sc1
    s_waitcnt lgkmcnt(0)
    s_waitcnt vmcnt(5)
    v_xor_b32 v77, s69, v8
    v_mfma_f32_16x16x32_bf16 v[0:3], v[4:7], v[8:11], 0
    v_mov_b64 v[8:9], 0
    v_mov_b64 v[10:11], 0
    s_waitcnt vmcnt(4)
    v_bitop3_b32 v77, v77, v12, s69 bitop3:0xf6
    v_mfma_f32_16x16x32_bf16 v[0:3], v[4:7], v[12:15], v[0:3]
    v_mov_b64 v[12:13], 0
    v_mov_b64 v[14:15], 0
    s_waitcnt vmcnt(3)
    v_bitop3_b32 v77, v77, v16, s69 bitop3:0xf6
    v_mfma_f32_16x16x32_bf16 v[0:3], v[4:7], v[16:19], v[0:3]
    v_mov_b64 v[16:17], 0
    v_mov_b64 v[18:19], 0
    s_waitcnt vmcnt(2)
    v_bitop3_b32 v77, v77, v20, s69 bitop3:0xf6
    v_mfma_f32_16x16x32_bf16 v[0:3], v[4:7], v[20:23], v[0:3]
    v_and_b32 v77, 1, v77
    v_cmp_ne_u32 vcc, 0, v77
    v_mov_b64 v[20:21], 0
    v_mov_b64 v[22:23], 0
    buffer_load_dwordx4 v[40:43], v65, s[4:7], s14 offen offset:0 sc1
    buffer_load_dwordx4 v[60:63], v66, s[4:7], s14 offen offset:0 sc1
    s_cmp_eq_u64 vcc, 0
    s_cselect_b64 s[42:43], -1, 0
    v_add_f32_dpp v0, v0, v0 row_ror:8 row_mask:0xf bank_mask:0xf
    v_add_f32_dpp v1, v1, v1 row_ror:8 row_mask:0xf bank_mask:0xf
    s_mov_b64 exec, s[42:43]
    v_cvt_pk_bf16_f32 v72, v0, v1
    v_bfi_b32 v72, v79, s70, v72
    buffer_store_dword v72, v75, s[4:7], s17 offen offset:0 sc1
    s_mov_b64 exec, -1
    s_cbranch_scc0 cs_f1_retry
cs_f1_go:
    v_mov_b64 v[0:1], 0
    v_mov_b64 v[2:3], 0
    v_mov_b64 v[4:5], 0
    v_mov_b64 v[6:7], 0
    s_nop 2
    v_mov_b32 v79, v79
    s_nop 2
    v_mov_b32 v79, v79
    s_nop 2
    v_mov_b32 v79, v79
    s_nop 2
    v_mov_b32 v79, v79
    s_nop 2
    v_mov_b32 v79, v79
    s_nop 2
    v_mov_b32 v79, v79
    s_nop 2
    v_mov_b32 v79, v79
    s_nop 2
    v_mov_b32 v79, v79
    s_nop 2
    v_mov_b32 v79, v79
    s_nop 2
    v_mov_b32 v79, v79
    s_nop 2
    v_mov_b32 v79, v79
    s_nop 2
    v_mov_b32 v79, v79
    s_nop 2
    v_mov_b32 v79, v79
    s_nop 2
    v_mov_b32 v79, v79
    s_nop 2
    v_mov_b32 v79, v79
    s_nop 2
    v_mov_b32 v79, v79
    s_nop 2
    v_mov_b32 v79, v79
    s_nop 2
    v_mov_b32 v79, v79
    s_nop 2
    v_mov_b32 v79, v79
    s_nop 2
    v_mov_b32 v79, v79
    s_nop 2
    v_mov_b32 v79, v79
    s_nop 2
    v_mov_b32 v79, v79
    s_nop 2
    v_mov_b32 v79, v79
    s_nop 2
    v_mov_b32 v79, v79
    s_nop 2
    v_mov_b32 v79, v79
    s_branch cs_loop
cs_f3:
    v_and_b32 v77, 255, v69
    ds_read_b128 v[4:7], v77 offset:15872
    ds_read_b128 v[44:47], v70 offset:0
    ds_read_b128 v[48:51], v70 offset:1024
    ds_read_b128 v[52:55], v70 offset:2048
    ds_read_b128 v[56:59], v70 offset:3072
    ds_read_b128 v[24:27], v70 offset:4096
    ds_read_b128 v[28:31], v70 offset:5120
    ds_read_b128 v[32:35], v70 offset:6144
    ds_read_b128 v[36:39], v70 offset:7168
    s_mov_b32 s31, 65536
    s_add_u32 s24, s24, 524288
    s_add_u32 s26, s26, 524288
    s_add_u32 s55, s55, s57
    s_mov_b32 s14, 67633152
    s_mov_b32 s15, 67637248
    s_mov_b32 s16, 67641344
    s_mov_b32 s36, 1
    v_mov_b32 v40, s69
    v_mov_b32 v60, s69
    v_and_b32 v79, 12, v75
    v_cmp_eq_u32 vcc, 0, v79
    s_nop 1
    v_cndmask_b32 v79, 0, 1, vcc
    s_add_u32 s40, s30, s95
    v_mov_b32 v72, s40
    s_waitcnt lgkmcnt(0)
    v_mov_b64 v[0:1], 0
    v_mov_b64 v[2:3], 0
    v_mov_b64 v[4:5], 0
    v_mov_b64 v[6:7], 0
    v_mov_b64 v[8:9], 0
    v_mov_b64 v[10:11], 0
    v_mov_b64 v[12:13], 0
    v_mov_b64 v[14:15], 0
    v_mov_b64 v[16:17], 0
    v_mov_b64 v[18:19], 0
    v_mov_b64 v[20:21], 0
    v_mov_b64 v[22:23], 0
    s_nop 2
    v_mov_b32 v79, v79
    s_nop 2
    v_mov_b32 v79, v79
    s_nop 2
    v_mov_b32 v79, v79
    s_nop 2
    v_mov_b32 v79, v79
    s_nop 2
    v_mov_b32 v79, v79
    s_nop 2
    v_mov_b32 v79, v79
    s_nop 2
    v_mov_b32 v79, v79
    s_nop 2
    v_mov_b32 v79, v79
    s_nop 2
    v_mov_b32 v79, v79
    s_nop 2
    v_mov_b32 v79, v79
    s_nop 2
    v_mov_b32 v79, v79
    s_nop 2
    v_mov_b32 v79, v79
    s_nop 2
    v_mov_b32 v79, v79
    s_nop 2
    v_mov_b32 v79, v79
    s_nop 2
    v_mov_b32 v79, v79
    s_nop 2
    v_mov_b32 v79, v79
    s_nop 2
    v_mov_b32 v79, v79
    s_nop 2
    v_mov_b32 v79, v79
    s_nop 2
    v_mov_b32 v79, v79
    s_nop 2
    v_mov_b32 v79, v79
    s_nop 2
    v_mov_b32 v79, v79
    s_nop 2
    v_mov_b32 v79, v79
    s_nop 2
    v_mov_b32 v79, v79
    s_nop 2
    v_mov_b32 v79, v79
    s_nop 2
    v_mov_b32 v79, v79
    s_nop 2
    v_mov_b32 v79, v79
    s_nop 2
    v_mov_b32 v79, v79
    s_nop 2
    v_mov_b32 v79, v79
    s_nop 2
    v_mov_b32 v79, v79
    s_nop 2
    v_mov_b32 v79, v79
    s_nop 2
    v_mov_b32 v79, v79
    s_nop 2
    v_mov_b32 v79, v79
    s_nop 2
    v_mov_b32 v79, v79
    s_nop 2
    v_mov_b32 v79, v79
    s_nop 2
    v_mov_b32 v79, v79
    s_nop 2
    v_mov_b32 v79, v79
    s_nop 2
    v_mov_b32 v79, v79
    s_nop 2
    v_mov_b32 v79, v79
    s_nop 2
    v_mov_b32 v79, v79
    s_nop 2
    v_mov_b32 v79, v79
    s_nop 2
    v_mov_b32 v79, v79
    s_nop 2
    v_mov_b32 v79, v79
    s_nop 2
    v_mov_b32 v79, v79
    s_nop 2
    v_mov_b32 v79, v79
    s_nop 2
    v_mov_b32 v79, v79
    s_nop 2
    v_mov_b32 v79, v79
    s_nop 2
    v_mov_b32 v79, v79
    s_nop 2
    v_mov_b32 v79, v79
    s_nop 2
    v_mov_b32 v79, v79
    s_nop 2
    v_mov_b32 v79, v79
    s_nop 2
    v_mov_b32 v79, v79
    s_nop 2
    v_mov_b32 v79, v79
    s_nop 2
    v_mov_b32 v79, v79
    s_nop 2
    v_mov_b32 v79, v79
    s_nop 2
    v_mov_b32 v79, v79
    s_nop 2
    v_mov_b32 v79, v79
    s_nop 2
    v_mov_b32 v79, v79
    s_nop 2
    v_mov_b32 v79, v79
    s_nop 2
    v_mov_b32 v79, v79
    s_nop 2
    v_mov_b32 v79, v79
    s_nop 2
    v_mov_b32 v79, v79
    s_nop 2
    v_mov_b32 v79, v79
    s_nop 2
    v_mov_b32 v79, v79
    s_nop 2
    v_mov_b32 v79, v79
    s_nop 2
    v_mov_b32 v79, v79
    s_waitcnt vmcnt(0)
    s_cmp_lt_u32 s97, s93
    s_cbranch_scc1 cs_kvwait
    s_nop 2
    v_mov_b32 v79, v79
    s_nop 2
    v_mov_b32 v79, v79
    s_nop 2
    v_mov_b32 v79, v79
    s_nop 2
    v_mov_b32 v79, v79
    s_nop 2
    v_mov_b32 v79, v79
    s_nop 2
    v_mov_b32 v79, v79
    s_nop 2
    v_mov_b32 v79, v79
    s_nop 2
    v_mov_b32 v79, v79
cs_kvok:
    s_branch cs_loop
cs_f0_xt:
    s_mov_b32 s37, 0
    s_nop 2
    v_mov_b32 v79, v79
    s_nop 2
    v_mov_b32 v79, v79
    s_nop 2
    v_mov_b32 v79, v79
    s_nop 2
    v_mov_b32 v79, v79
    s_nop 2
    v_mov_b32 v79, v79
    s_nop 2
    v_mov_b32 v79, v79
    s_branch cs_f0_xtx
cs_f0_retry:
    s_mov_b32 s37, 1
cs_f0_spin:
    buffer_load_dwordx4 v[8:11], v65, s[4:7], s18 offen sc1
    buffer_load_dwordx4 v[12:15], v65, s[4:7], s19 offen sc1
    buffer_load_dwordx4 v[16:19], v65, s[4:7], s20 offen sc1
    buffer_load_dwordx4 v[20:23], v65, s[4:7], s21 offen sc1
    s_nop 2
    v_mov_b32 v79, v79
    s_nop 2
    v_mov_b32 v79, v79
    s_nop 2
    v_mov_b32 v79, v79
    buffer_load_dwordx4 v[40:43], v65, s[4:7], s14 offen offset:0 sc1
    buffer_load_dwordx4 v[60:63], v66, s[4:7], s14 offen offset:0 sc1
    s_waitcnt vmcnt(5)
    v_xor_b32 v77, s69, v8
    v_mfma_f32_16x16x32_bf16 v[0:3], v[4:7], v[8:11], 0
    v_mov_b64 v[8:9], 0
    v_mov_b64 v[10:11], 0
    s_waitcnt vmcnt(4)
    v_bitop3_b32 v77, v77, v12, s69 bitop3:0xf6
    v_mfma_f32_16x16x32_bf16 v[0:3], v[4:7], v[12:15], v[0:3]
    v_mov_b64 v[12:13], 0
    v_mov_b64 v[14:15], 0
    s_waitcnt vmcnt(3)
    v_bitop3_b32 v77, v77, v16, s69 bitop3:0xf6
    v_mfma_f32_16x16x32_bf16 v[0:3], v[4:7], v[16:19], v[0:3]
    v_mov_b64 v[16:17], 0
    v_mov_b64 v[18:19], 0
    s_waitcnt vmcnt(2)
    v_bitop3_b32 v77, v77, v20, s69 bitop3:0xf6
    v_mfma_f32_16x16x32_bf16 v[0:3], v[4:7], v[20:23], v[0:3]
    v_and_b32 v77, 1, v77
    v_cmp_ne_u32 vcc, 0, v77
    v_mov_b64 v[20:21], 0
    v_mov_b64 v[22:23], 0
    buffer_load_dwordx4 v[40:43], v65, s[4:7], s14 offen offset:0 sc1
    buffer_load_dwordx4 v[60:63], v66, s[4:7], s14 offen offset:0 sc1
    s_cmp_eq_u64 vcc, 0
    s_cselect_b64 s[42:43], -1, 0
    v_add_f32_dpp v0, v0, v0 row_ror:8 row_mask:0xf bank_mask:0xf
    v_add_f32_dpp v1, v1, v1 row_ror:8 row_mask:0xf bank_mask:0xf
    s_mov_b64 exec, s[42:43]
    v_cvt_pk_bf16_f32 v72, v0, v1
    v_bfi_b32 v72, v79, s70, v72
    buffer_store_dword v72, v75, s[4:7], s17 offen offset:0 sc1
    s_mov_b64 exec, -1
    s_cbranch_scc1 cs_f0_rx
    s_sub_u32 s31, s31, 1
    s_cbranch_scc0 cs_f0_spin
cs_f0_rx:
    v_mov_b64 v[0:1], 0
    v_mov_b64 v[2:3], 0
    v_mov_b64 v[4:5], 0
    v_mov_b64 v[6:7], 0
    s_branch cs_loop
cs_f1_xt:
    s_mov_b32 s37, 0
    s_nop 2
    v_mov_b32 v79, v79
    s_nop 2
    v_mov_b32 v79, v79
    s_nop 2
    v_mov_b32 v79, v79
    s_nop 2
    v_mov_b32 v79, v79
    s_nop 2
    v_mov_b32 v79, v79
    s_nop 2
    v_mov_b32 v79, v79
    s_branch cs_f1_xtx
cs_f1_retry:
    s_mov_b32 s37, 1
cs_f1_spin:
    buffer_load_dwordx4 v[8:11], v65, s[4:7], s18 offen sc1
    buffer_load_dwordx4 v[12:15], v65, s[4:7], s19 offen sc1
    buffer_load_dwordx4 v[16:19], v65, s[4:7], s20 offen sc1
    buffer_load_dwordx4 v[20:23], v65, s[4:7], s21 offen sc1
    s_nop 2
    v_mov_b32 v79, v79
    s_nop 2
    v_mov_b32 v79, v79
    s_nop 2
    v_mov_b32 v79, v79
    buffer_load_dwordx4 v[40:43], v65, s[4:7], s14 offen offset:0 sc1
    buffer_load_dwordx4 v[60:63], v66, s[4:7], s14 offen offset:0 sc1
    s_waitcnt vmcnt(5)
    v_xor_b32 v77, s69, v8
    v_mfma_f32_16x16x32_bf16 v[0:3], v[4:7], v[8:11], 0
    v_mov_b64 v[8:9], 0
    v_mov_b64 v[10:11], 0
    s_waitcnt vmcnt(4)
    v_bitop3_b32 v77, v77, v12, s69 bitop3:0xf6
    v_mfma_f32_16x16x32_bf16 v[0:3], v[4:7], v[12:15], v[0:3]
    v_mov_b64 v[12:13], 0
    v_mov_b64 v[14:15], 0
    s_waitcnt vmcnt(3)
    v_bitop3_b32 v77, v77, v16, s69 bitop3:0xf6
    v_mfma_f32_16x16x32_bf16 v[0:3], v[4:7], v[16:19], v[0:3]
    v_mov_b64 v[16:17], 0
    v_mov_b64 v[18:19], 0
    s_waitcnt vmcnt(2)
    v_bitop3_b32 v77, v77, v20, s69 bitop3:0xf6
    v_mfma_f32_16x16x32_bf16 v[0:3], v[4:7], v[20:23], v[0:3]
    v_and_b32 v77, 1, v77
    v_cmp_ne_u32 vcc, 0, v77
    v_mov_b64 v[20:21], 0
    v_mov_b64 v[22:23], 0
    buffer_load_dwordx4 v[40:43], v65, s[4:7], s14 offen offset:0 sc1
    buffer_load_dwordx4 v[60:63], v66, s[4:7], s14 offen offset:0 sc1
    s_cmp_eq_u64 vcc, 0
    s_cselect_b64 s[42:43], -1, 0
    v_add_f32_dpp v0, v0, v0 row_ror:8 row_mask:0xf bank_mask:0xf
    v_add_f32_dpp v1, v1, v1 row_ror:8 row_mask:0xf bank_mask:0xf
    s_mov_b64 exec, s[42:43]
    v_cvt_pk_bf16_f32 v72, v0, v1
    v_bfi_b32 v72, v79, s70, v72
    buffer_store_dword v72, v75, s[4:7], s17 offen offset:0 sc1
    s_mov_b64 exec, -1
    s_cbranch_scc1 cs_f1_rx
    s_sub_u32 s31, s31, 1
    s_cbranch_scc0 cs_f1_spin
cs_f1_rx:
    v_mov_b64 v[0:1], 0
    v_mov_b64 v[2:3], 0
    v_mov_b64 v[4:5], 0
    v_mov_b64 v[6:7], 0
    s_branch cs_loop
cs_f2_xt:
    s_mov_b32 s37, 0
    s_nop 2
    v_mov_b32 v79, v79
    s_nop 2
    v_mov_b32 v79, v79
    s_nop 2
    v_mov_b32 v79, v79
    s_nop 2
    v_mov_b32 v79, v79
    s_nop 2
    v_mov_b32 v79, v79
    s_nop 2
    v_mov_b32 v79, v79
    s_branch cs_f2_xtx
cs_f2_retry:
    s_mov_b32 s37, 1
cs_f2_spin:
    buffer_load_dwordx4 v[8:11], v65, s[4:7], s18 offen sc1
    buffer_load_dwordx4 v[12:15], v65, s[4:7], s19 offen sc1
    buffer_load_dwordx4 v[16:19], v65, s[4:7], s20 offen sc1
    buffer_load_dwordx4 v[20:23], v65, s[4:7], s21 offen sc1
    s_nop 2
    v_mov_b32 v79, v79
    s_nop 2
    v_mov_b32 v79, v79
    s_nop 2
    v_mov_b32 v79, v79
    buffer_load_dwordx4 v[40:43], v65, s[4:7], s14 offen offset:0 sc1
    buffer_load_dwordx4 v[60:63], v66, s[4:7], s14 offen offset:0 sc1
    s_waitcnt vmcnt(5)
    v_xor_b32 v77, s69, v8
    v_mfma_f32_16x16x32_bf16 v[0:3], v[4:7], v[8:11], 0
    v_mov_b64 v[8:9], 0
    v_mov_b64 v[10:11], 0
    s_waitcnt vmcnt(4)
    v_bitop3_b32 v77, v77, v12, s69 bitop3:0xf6
    v_mfma_f32_16x16x32_bf16 v[0:3], v[4:7], v[12:15], v[0:3]
    v_mov_b64 v[12:13], 0
    v_mov_b64 v[14:15], 0
    s_waitcnt vmcnt(3)
    v_bitop3_b32 v77, v77, v16, s69 bitop3:0xf6
    v_mfma_f32_16x16x32_bf16 v[0:3], v[4:7], v[16:19], v[0:3]
    v_mov_b64 v[16:17], 0
    v_mov_b64 v[18:19], 0
    s_waitcnt vmcnt(2)
    v_bitop3_b32 v77, v77, v20, s69 bitop3:0xf6
    v_mfma_f32_16x16x32_bf16 v[0:3], v[4:7], v[20:23], v[0:3]
    v_and_b32 v77, 1, v77
    v_cmp_ne_u32 vcc, 0, v77
    v_mov_b64 v[20:21], 0
    v_mov_b64 v[22:23], 0
    buffer_load_dwordx4 v[40:43], v65, s[4:7], s14 offen offset:0 sc1
    buffer_load_dwordx4 v[60:63], v66, s[4:7], s14 offen offset:0 sc1
    s_cmp_eq_u64 vcc, 0
    s_cselect_b64 s[42:43], -1, 0
    v_add_f32_dpp v0, v0, v0 row_ror:4 row_mask:0xf bank_mask:0xf
    v_add_f32_dpp v1, v1, v1 row_ror:4 row_mask:0xf bank_mask:0xf
    s_nop 0
    v_add_f32_dpp v0, v0, v0 row_ror:8 row_mask:0xf bank_mask:0xf
    v_add_f32_dpp v1, v1, v1 row_ror:8 row_mask:0xf bank_mask:0xf
    s_mov_b64 exec, s[42:43]
    v_cvt_pk_bf16_f32 v72, v0, v1
    v_bfi_b32 v72, v79, s70, v72
    buffer_store_dword v72, v75, s[4:7], s17 offen offset:0 sc1
    buffer_store_dword v72, v75, s[4:7], s17 offen offset:1024 sc1
    buffer_store_dword v72, v75, s[4:7], s17 offen offset:2048 sc1
    buffer_store_dword v72, v75, s[4:7], s17 offen offset:3072 sc1
    s_mov_b64 exec, -1
    s_cbranch_scc1 cs_f2_rx
    s_sub_u32 s31, s31, 1
    s_cbranch_scc0 cs_f2_spin
cs_f2_rx:
    v_mov_b64 v[0:1], 0
    v_mov_b64 v[2:3], 0
    v_mov_b64 v[4:5], 0
    v_mov_b64 v[6:7], 0
    s_branch cs_loop
cs_spinB:
    s_waitcnt vmcnt(2)
cs_spinB_l:
    v_and_b32 v77, s36, v44
    v_cmp_ne_u32 vcc, s70, v77
    s_cbranch_vccz cs_spinB_x
    buffer_load_dwordx4 v[44:47], v65, s[4:7], s15 offen sc1
    s_sub_u32 s31, s31, 16
    s_waitcnt vmcnt(0)
    s_cbranch_scc0 cs_spinB_l
cs_spinB_x:
    ds_write_b128 v65, v[44:47] offset:4096
    s_waitcnt lgkmcnt(0)
    s_branch cs_backB
cs_spin8:
    buffer_load_dwordx4 v[40:43], v65, s[4:7], s16 offen sc1
cs_spin8_l:
    v_and_b32 v77, s36, v40
    v_cmp_ne_u32 vcc, s70, v77
    s_cbranch_vccz cs_spin8_x
    s_nop 15
    s_nop 15
    s_nop 15
    s_nop 11
    v_and_b32 v77, s36, v40
    v_cmp_ne_u32 vcc, s70, v77
    s_cbranch_vccz cs_spin8_x
    s_nop 15
    s_nop 15
    s_nop 15
    s_nop 11
    v_and_b32 v77, s36, v40
    v_cmp_ne_u32 vcc, s70, v77
    s_cbranch_vccz cs_spin8_x
    s_nop 15
    s_nop 15
    s_nop 15
    s_nop 11
    buffer_load_dwordx4 v[40:43], v65, s[4:7], s16 offen sc1
    s_sub_u32 s31, s31, 16
    s_cbranch_scc0 cs_spin8_l
cs_spin8_x:
    s_branch cs_back8
cs_rare:
    s_mov_b64 exec, s[34:35]
    buffer_store_dwordx4 v[0:3], v65, s[4:7], s28 offen sc1
    s_mov_b64 exec, -1
    s_nop 3
    v_cvt_pk_bf16_f32 v52, v16, v17
    v_cvt_pk_bf16_f32 v53, v18, v19
    v_cvt_pk_bf16_f32 v54, v20, v21
    v_cvt_pk_bf16_f32 v55, v22, v23
    buffer_store_dwordx4 v[52:55], v65, s[4:7], s27 offen sc1
    s_add_u32 s28, s28, 131072
    s_add_u32 s27, s27, 131072
    s_cmp_eq_u32 s30, 63
    s_cbranch_scc1 cs_last
    s_branch cs_rare_x
cs_kvwait:
    s_mov_b32 s41, s97
    v_bfe_u32 v78, v65, 2, 5
    v_mov_b32 v77, v76
    s_nop 1
    v_permlane32_swap_b32 v76, v77
    v_subrev_u32 v77, s95, v77
    v_cmp_lt_u32 vcc, 16, v77
    s_nop 1
    v_cndmask_b32 v77, v77, 0, vcc
    v_bfe_u32 v79, v78, 2, 2
    v_lshl_add_u32 v77, v77, 2, v79
    s_nop 1
    v_min_u32_dpp v77, v77, v77 row_ror:1 row_mask:0xf bank_mask:0xf
    s_nop 1
    v_min_u32_dpp v77, v77, v77 row_ror:2 row_mask:0xf bank_mask:0xf
    s_nop 1
    v_min_u32_dpp v77, v77, v77 row_ror:4 row_mask:0xf bank_mask:0xf
    s_nop 0
    v_readfirstlane_b32 s97, v77
    s_nop 0
    s_max_u32 s97, s97, s41
    s_add_u32 s40, s30, 3
    s_min_u32 s40, s40, 64
    s_cmp_le_u32 s40, s97
    s_cbranch_scc1 cs_kvw_x
    v_bfe_u32 v78, v65, 2, 5
    s_mov_b32 s31, 4194304
cs_kvw:
    buffer_load_dword v77, v78, s[4:7], s96 offen offset:16 sc1
    s_waitcnt vmcnt(0)
    v_subrev_u32 v77, s95, v77
    v_cmp_lt_u32 vcc, 16, v77
    s_nop 1
    v_cndmask_b32 v77, v77, 0, vcc
    v_bfe_u32 v79, v78, 2, 2
    v_lshl_add_u32 v77, v77, 2, v79
    s_nop 1
    v_min_u32_dpp v77, v77, v77 row_ror:1 row_mask:0xf bank_mask:0xf
    s_nop 1
    v_min_u32_dpp v77, v77, v77 row_ror:2 row_mask:0xf bank_mask:0xf
    s_nop 1
    v_min_u32_dpp v77, v77, v77 row_ror:4 row_mask:0xf bank_mask:0xf
    s_nop 0
    v_readfirstlane_b32 s97, v77
    s_sub_u32 s31, s31, 1
    s_cbranch_scc1 cs_kvw_x
    s_cmp_le_u32 s40, s97
    s_cbranch_scc1 cs_kvw_x
    s_sleep 2
    s_branch cs_kvw
cs_kvw_x:
    s_branch cs_kvok
cs_last:
    s_add_u32 s40, s95, 64
    v_mov_b32 v78, s40
    s_waitcnt vmcnt(0)
    s_barrier
    s_mov_b64 exec, s[100:101]
    buffer_store_dword v78, off, s[4:7], s29 sc1
    s_mov_b64 exec, -1
cs_end:
    s_endpgm
L_xform:
    v_and_b32 v1, 63, v0
    v_and_b32 v2, 15, v1
    v_lshrrev_b32 v3, 4, v1
    v_mov_b32 v7, 0x05040100
    v_mov_b32 v8, 0x07060302
    v_lshrrev_b32 v9, 6, v0
    v_lshlrev_b32 v9, 14, v9
    v_lshlrev_b32 v10, 4, v1
    v_add_u32 v11, v9, v10
    s_mov_b32 s10, 4718592
    s_mov_b32 s11, 0x20000
    s_mov_b64 s[8:9], s[58:59]
xf_f:
    s_sub_u32 s17, s16, 1504
    s_and_b32 s18, s17, 127
    s_lshr_b32 s17, s17, 7
    s_lshl_b32 s19, s17, 4
    v_add_u32 v6, s19, v2
    v_mul_u32_u24 v4, 9216, v3
    v_lshl_add_u32 v4, v6, 4, v4
    v_lshrrev_b32 v5, 2, v2
    v_lshlrev_b32 v5, 11, v5
    v_lshl_add_u32 v5, v3, 8, v5
    v_and_b32 v1, 3, v6
    v_lshl_add_u32 v5, v1, 6, v5
    v_add_u32 v5, v5, v9
    v_cmp_gt_u32 vcc, 72, v6
    s_nop 0
    s_mov_b64 exec, vcc
    s_mul_i32 s20, s18, 36864
    s_add_u32 s21, s20, 0
    buffer_load_dwordx4 v[12:15], v4, s[8:11], s21 offen
    s_add_u32 s21, s20, 1152
    buffer_load_dwordx4 v[16:19], v4, s[8:11], s21 offen
    s_add_u32 s21, s20, 2304
    buffer_load_dwordx4 v[20:23], v4, s[8:11], s21 offen
    s_add_u32 s21, s20, 3456
    buffer_load_dwordx4 v[24:27], v4, s[8:11], s21 offen
    s_add_u32 s21, s20, 4608
    buffer_load_dwordx4 v[28:31], v4, s[8:11], s21 offen
    s_add_u32 s21, s20, 5760
    buffer_load_dwordx4 v[32:35], v4, s[8:11], s21 offen
    s_add_u32 s21, s20, 6912
    buffer_load_dwordx4 v[36:39], v4, s[8:11], s21 offen
    s_add_u32 s21, s20, 8064
    buffer_load_dwordx4 v[40:43], v4, s[8:11], s21 offen
    s_lshl_b32 s20, s18, 11
    s_add_u32 s20, s20, 130023424
    s_waitcnt vmcnt(0)
    v_perm_b32 v76, v16, v12, v7
    v_perm_b32 v77, v24, v20, v7
    v_perm_b32 v78, v32, v28, v7
    v_perm_b32 v79, v40, v36, v7
    ds_write_b128 v5, v[76:79] offset:0
    v_perm_b32 v80, v17, v13, v7
    v_perm_b32 v81, v25, v21, v7
    v_perm_b32 v82, v33, v29, v7
    v_perm_b32 v83, v41, v37, v7
    ds_write_b128 v5, v[80:83] offset:16
    v_perm_b32 v84, v18, v14, v7
    v_perm_b32 v85, v26, v22, v7
    v_perm_b32 v86, v34, v30, v7
    v_perm_b32 v87, v42, v38, v7
    ds_write_b128 v5, v[84:87] offset:32
    v_perm_b32 v88, v19, v15, v7
    v_perm_b32 v89, v27, v23, v7
    v_perm_b32 v90, v35, v31, v7
    v_perm_b32 v91, v43, v39, v7
    ds_write_b128 v5, v[88:91] offset:48
    v_perm_b32 v92, v16, v12, v8
    v_perm_b32 v93, v24, v20, v8
    v_perm_b32 v94, v32, v28, v8
    v_perm_b32 v95, v40, v36, v8
    ds_write_b128 v5, v[92:95] offset:1024
    v_perm_b32 v96, v17, v13, v8
    v_perm_b32 v97, v25, v21, v8
    v_perm_b32 v98, v33, v29, v8
    v_perm_b32 v99, v41, v37, v8
    ds_write_b128 v5, v[96:99] offset:1040
    v_perm_b32 v100, v18, v14, v8
    v_perm_b32 v101, v26, v22, v8
    v_perm_b32 v102, v34, v30, v8
    v_perm_b32 v103, v42, v38, v8
    ds_write_b128 v5, v[100:103] offset:1056
    v_perm_b32 v104, v19, v15, v8
    v_perm_b32 v105, v27, v23, v8
    v_perm_b32 v106, v35, v31, v8
    v_perm_b32 v107, v43, v39, v8
    ds_write_b128 v5, v[104:107] offset:1072
    s_mov_b64 exec, -1
    s_lshl_b32 s21, s17, 20
    s_add_u32 s20, s20, s21
    s_waitcnt lgkmcnt(0)
    ds_read_b128 v[76:79], v11 offset:0
    ds_read_b128 v[80:83], v11 offset:1024
    ds_read_b128 v[84:87], v11 offset:2048
    ds_read_b128 v[88:91], v11 offset:3072
    ds_read_b128 v[92:95], v11 offset:4096
    ds_read_b128 v[96:99], v11 offset:5120
    ds_read_b128 v[100:103], v11 offset:6144
    ds_read_b128 v[104:107], v11 offset:7168
    s_add_u32 s19, s20, 0
    s_waitcnt lgkmcnt(7)
    buffer_store_dwordx4 v[76:79], v10, s[4:7], s19 offen sc1
    s_add_u32 s19, s20, 1024
    s_waitcnt lgkmcnt(6)
    buffer_store_dwordx4 v[80:83], v10, s[4:7], s19 offen sc1
    s_add_u32 s19, s20, 262144
    s_waitcnt lgkmcnt(5)
    buffer_store_dwordx4 v[84:87], v10, s[4:7], s19 offen sc1
    s_add_u32 s19, s20, 263168
    s_waitcnt lgkmcnt(4)
    buffer_store_dwordx4 v[88:91], v10, s[4:7], s19 offen sc1
    s_add_u32 s19, s20, 524288
    s_waitcnt lgkmcnt(3)
    buffer_store_dwordx4 v[92:95], v10, s[4:7], s19 offen sc1
    s_add_u32 s19, s20, 525312
    s_waitcnt lgkmcnt(2)
    buffer_store_dwordx4 v[96:99], v10, s[4:7], s19 offen sc1
    s_add_u32 s19, s20, 786432
    s_waitcnt lgkmcnt(1)
    buffer_store_dwordx4 v[100:103], v10, s[4:7], s19 offen sc1
    s_add_u32 s19, s20, 787456
    s_waitcnt lgkmcnt(0)
    buffer_store_dwordx4 v[104:107], v10, s[4:7], s19 offen sc1
xf_done:
    s_nop 1
    s_setpc_b64 s[46:47]
L_helper:
    s_load_dwordx16 s[64:79], s[0:1], 64
    s_waitcnt lgkmcnt(0)
    s_mov_b32 s93, 1000
    s_mov_b32 s95, 0
    s_cmp_lg_u32 s3, 2
    s_cbranch_scc1 L_qkv_next
    s_mov_b32 s37, 24
    v_mov_b32 v250, 1
    v_mov_b32 v251, 163832
    v_cmp_eq_u32 vcc, 0, v0
    s_nop 0
    s_and_saveexec_b64 s[38:39], vcc
    s_cbranch_execz tk3
    buffer_atomic_add v250, off, s[84:87], s37 sc0
    s_waitcnt vmcnt(0)
    ds_write_b32 v251, v250
    s_waitcnt lgkmcnt(0)
tk3:
    s_mov_b64 exec, -1
    s_barrier
    ds_read_b32 v252, v251
    s_waitcnt lgkmcnt(0)
    v_readfirstlane_b32 s36, v252
    s_barrier
    s_nop 3
    s_cmp_ge_u32 s36, 32
    s_cbranch_scc1 L_qkv_next
    s_mov_b32 s93, 0
    s_mov_b32 s88, 4194304
gn4:
    buffer_load_dword v250, off, s[84:87], 0 offset:216 sc1
    s_waitcnt vmcnt(0)
    v_readfirstlane_b32 s95, v250
    s_sub_u32 s88, s88, 1
    s_cbranch_scc1 gn4x
    s_cmp_eq_u32 s95, 0
    s_cbranch_scc1 gn4
gn4x:
    s_cmp_eq_u32 s36, 0
    s_cbranch_scc1 L_relay
    s_branch L_wf_next
L_qkv_next:
    s_mov_b32 s37, 4
    v_mov_b32 v250, 1
    v_mov_b32 v251, 163832
    v_cmp_eq_u32 vcc, 0, v0
    s_nop 0
    s_and_saveexec_b64 s[38:39], vcc
    s_cbranch_execz tk5
    buffer_atomic_add v250, off, s[84:87], s37 sc0
    s_waitcnt vmcnt(0)
    ds_write_b32 v251, v250
    s_waitcnt lgkmcnt(0)
tk5:
    s_mov_b64 exec, -1
    s_barrier
    ds_read_b32 v252, v251
    s_waitcnt lgkmcnt(0)
    v_readfirstlane_b32 s36, v252
    s_barrier
    s_nop 3
    s_or_b32 s37, s36, s32
    s_cbranch_scc1 L_non
    s_memrealtime s[90:91]
    s_waitcnt lgkmcnt(0)
    s_lshl_b32 s90, s90, 8
    s_or_b32 s90, s90, 1
    v_mov_b32 v250, s90
    s_mov_b64 exec, 1
    buffer_store_dword v250, off, s[84:87], 0 offset:216 sc1
    s_mov_b64 exec, -1
L_non:
    s_cmp_lt_u32 s36, 192
    s_cbranch_scc1 L_qkv
    s_cmp_lg_u32 s95, 0
    s_cbranch_scc1 L_hn
    s_mov_b32 s88, 4194304
gn6:
    buffer_load_dword v250, off, s[84:87], 0 offset:216 sc1
    s_waitcnt vmcnt(0)
    v_readfirstlane_b32 s95, v250
    s_sub_u32 s88, s88, 1
    s_cbranch_scc1 gn6x
    s_cmp_eq_u32 s95, 0
    s_cbranch_scc1 gn6
gn6x:
L_hn:
    s_sub_u32 s45, s36, 192
    s_cmp_lg_u32 s36, 192
    s_cbranch_scc1 L_phase2
    s_mov_b32 s37, 24
    v_mov_b32 v250, 1
    v_mov_b32 v251, 163832
    v_cmp_eq_u32 vcc, 0, v0
    s_nop 0
    s_and_saveexec_b64 s[38:39], vcc
    s_cbranch_execz tk7
    buffer_atomic_add v250, off, s[84:87], s37 sc0
    s_waitcnt vmcnt(0)
    ds_write_b32 v251, v250
    s_waitcnt lgkmcnt(0)
tk7:
    s_mov_b64 exec, -1
    s_barrier
    ds_read_b32 v252, v251
    s_waitcnt lgkmcnt(0)
    v_readfirstlane_b32 s36, v252
    s_barrier
    s_nop 3
    s_cmp_lg_u32 s36, 0
    s_cbranch_scc1 L_phase2
L_relay:
    s_cmp_lg_u32 s32, 0
    s_cbranch_scc1 L_exit
    v_and_b32 v3, 31, v0
    v_lshlrev_b32 v3, 7, v3
    s_mov_b32 s17, 0
    s_mov_b32 s23, 125845504
    s_mov_b32 s24, 125853696
    s_mov_b32 s21, 16777216
rl_rwait:
    buffer_load_dword v4, v3, s[4:7], s23 offen sc1
    s_waitcnt vmcnt(0)
    v_subrev_u32 v4, s95, v4
    v_cmp_lt_u32 vcc, 64, v4
    s_nop 1
    v_cndmask_b32 v4, v4, 0, vcc
    s_nop 1
    v_min_u32_dpp v4, v4, v4 row_ror:1 row_mask:0xf bank_mask:0xf
    s_nop 1
    v_min_u32_dpp v4, v4, v4 row_ror:2 row_mask:0xf bank_mask:0xf
    s_nop 1
    v_min_u32_dpp v4, v4, v4 row_ror:4 row_mask:0xf bank_mask:0xf
    s_nop 1
    v_min_u32_dpp v4, v4, v4 row_ror:8 row_mask:0xf bank_mask:0xf
    s_nop 0
    v_readlane_b32 s16, v4, 0
    v_readlane_b32 s22, v4, 16
    s_nop 0
    s_min_u32 s16, s16, s22
    s_sub_u32 s21, s21, 1
    s_cbranch_scc1 rl_x
    s_cmp_gt_u32 s16, s17
    s_cbranch_scc1 rl_rpub
    s_sleep 2
    s_branch rl_rwait
rl_rpub:
    s_mov_b32 s17, s16
    s_add_u32 s22, s16, s95
    v_mov_b32 v4, s22
    s_mov_b64 exec, 1
    buffer_store_dword v4, off, s[4:7], s24 sc1
    s_mov_b64 exec, -1
    s_cmp_lt_u32 s16, 64
    s_cbranch_scc1 rl_rwait
rl_x:
    s_endpgm
L_qkv:
    s_sub_u32 s33, s36, 32
    s_and_b32 s17, s36, 15
    s_lshl_b32 s17, s17, 1
    s_lshr_b32 s36, s36, 4
    s_and_b32 s16, s36, 1
    s_add_u32 s16, s16, 1
    s_lshr_b32 s19, s36, 1
    s_and_b32 s37, s36, 3
    s_cmp_ge_u32 s36, 8
    s_cselect_b32 s16, 0, s16
    s_cselect_b32 s19, s37, s19
    v_lshrrev_b32 v4, 6, v0
    s_nop 0
    v_readfirstlane_b32 s18, v4
    v_lshlrev_b32 v7, 4, v0
    s_cmp_eq_u32 s16, 1
    s_cselect_b64 s[12:13], s[54:55], s[52:53]
    s_cmp_eq_u32 s16, 2
    s_cselect_b64 s[12:13], s[56:57], s[12:13]
    s_mov_b32 s14, 4718592
    s_mov_b32 s15, 0x20000
    v_bfe_u32 v4, v0, 5, 1
    v_lshlrev_b32 v5, 2, v4
    v_and_b32 v8, 31, v0
    v_xor_b32 v8, v8, v5
    v_lshlrev_b32 v8, 4, v8
    v_lshl_add_u32 v8, v4, 13, v8
    v_xor_b32 v9, 128, v8
    s_lshl_b32 s21, s17, 8
    s_lshl_b32 s42, s18, 16
    s_add_u32 s42, s42, s21
    s_lshl_b32 s44, s18, 12
    s_barrier
    s_add_u32 m0, s44, 73728
    s_add_u32 s22, s42, 0
    buffer_load_dwordx4 v8, s[12:15], s22 offen offset:0 lds
    s_add_u32 s22, s42, 15360
    buffer_load_dwordx4 v9, s[12:15], s22 offen offset:1024 lds
    s_add_u32 s22, s42, 30720
    buffer_load_dwordx4 v8, s[12:15], s22 offen offset:2048 lds
    s_add_u32 s22, s42, 46080
    buffer_load_dwordx4 v9, s[12:15], s22 offen offset:3072 lds
    s_add_u32 m0, s44, 90112
    s_add_u32 s22, s42, 262144
    buffer_load_dwordx4 v8, s[12:15], s22 offen offset:0 lds
    s_add_u32 s22, s42, 277504
    buffer_load_dwordx4 v9, s[12:15], s22 offen offset:1024 lds
    s_add_u32 s22, s42, 292864
    buffer_load_dwordx4 v8, s[12:15], s22 offen offset:2048 lds
    s_add_u32 s22, s42, 308224
    buffer_load_dwordx4 v9, s[12:15], s22 offen offset:3072 lds
    s_add_u32 m0, s44, 106496
    s_add_u32 s22, s42, 524288
    buffer_load_dwordx4 v8, s[12:15], s22 offen offset:0 lds
    s_add_u32 s22, s42, 539648
    buffer_load_dwordx4 v9, s[12:15], s22 offen offset:1024 lds
    s_add_u32 s22, s42, 555008
    buffer_load_dwordx4 v8, s[12:15], s22 offen offset:2048 lds
    s_add_u32 s22, s42, 570368
    buffer_load_dwordx4 v9, s[12:15], s22 offen offset:3072 lds
    s_add_u32 m0, s44, 122880
    s_add_u32 s22, s42, 786432
    buffer_load_dwordx4 v8, s[12:15], s22 offen offset:0 lds
    s_add_u32 s22, s42, 801792
    buffer_load_dwordx4 v9, s[12:15], s22 offen offset:1024 lds
    s_add_u32 s22, s42, 817152
    buffer_load_dwordx4 v8, s[12:15], s22 offen offset:2048 lds
    s_add_u32 s22, s42, 832512
    buffer_load_dwordx4 v9, s[12:15], s22 offen offset:3072 lds
    v_bfe_u32 v4, v0, 2, 2
    v_xor_b32 v5, s18, v4
    v_lshlrev_b32 v10, 6, v5
    v_lshl_add_u32 v10, v4, 9, v10
    v_and_b32 v4, 3, v0
    v_lshl_add_u32 v10, v4, 4, v10
    v_bfe_u32 v4, v0, 4, 2
    v_lshl_add_u32 v10, v4, 12, v10
    v_add_u32 v10, 73728, v10
    v_add_u32 v11, 49152, v10
    v_and_b32 v4, 63, v0
    v_and_b32 v5, 15, v4
    v_lshrrev_b32 v3, 4, v4
    v_lshrrev_b32 v2, 2, v5
    v_xor_b32 v3, v3, v2
    v_lshl_add_u32 v3, v5, 2, v3
    v_lshlrev_b32 v1, 4, v3
    v_lshrrev_b32 v5, 2, v4
    v_lshrrev_b32 v3, 4, v4
    v_and_b32 v4, 3, v4
    v_xor_b32 v4, v4, v3
    v_lshlrev_b32 v3, 3, v3
    v_and_b32 v5, 3, v5
    v_add_u32 v3, v3, v5
    v_mul_u32_u24 v2, 1152, v3
    v_lshl_add_u32 v2, v4, 4, v2
    s_mov_b32 s8, s48
    s_mov_b32 s9, s49
    s_mov_b32 s10, 2359296
    s_mov_b32 s11, 0x20000
    s_lshr_b32 s22, s18, 1
    s_mul_i32 s24, s22, 4608
    s_mul_i32 s25, s22, 18432
    s_and_b32 s22, s18, 1
    s_mul_i32 s23, s22, 576
    s_add_u32 s24, s24, s23
    s_mul_i32 s25, s18, 9216
    s_mul_i32 s22, s19, 36864
    s_add_u32 s24, s24, s22
    s_mov_b32 s20, 64
    s_lshl_b32 s22, s19, 5
    s_add_u32 s22, s22, s17
    s_lshl_b32 s26, s22, 14
    s_mul_i32 s23, s18, 3072
    s_add_u32 s26, s26, s23
    s_lshl_b32 s23, s16, 11
    s_add_u32 s26, s26, s23
    s_add_u32 s26, s26, -2048
    s_lshl_b32 s22, s22, 13
    s_add_u32 s22, s22, 33554432
    s_cmp_eq_u32 s16, 0
    s_cselect_b32 s26, s22, s26
    s_cselect_b32 s40, 4096, 64
    s_cselect_b32 s41, 1, 2
    s_max_u32 s40, s40, 1024
    s_lshl_b32 s41, s41, 18
    s_lshl_b32 s29, s17, 7
    s_lshl_b32 s22, s16, 4
    s_add_u32 s29, s29, s22
    s_lshl_b32 s22, s19, 2
    s_add_u32 s29, s29, s22
    s_add_u32 s29, s29, 125829120
    s_mov_b32 s27, 0
    s_add_u32 s23, s27, s25
    s_add_u32 m0, s23, 0
    s_nop 0
    buffer_load_dwordx4 v2, s[8:11], s24 offen offset:0 lds
    s_add_u32 m0, s23, 960
    s_nop 0
    buffer_load_dwordx4 v2, s[8:11], s24 offen offset:64 lds
    s_add_u32 m0, s23, 1920
    s_nop 0
    buffer_load_dwordx4 v2, s[8:11], s24 offen offset:128 lds
    s_add_u32 m0, s23, 2880
    s_nop 0
    buffer_load_dwordx4 v2, s[8:11], s24 offen offset:192 lds
    s_add_u32 m0, s23, 3840
    s_nop 0
    buffer_load_dwordx4 v2, s[8:11], s24 offen offset:256 lds
    s_add_u32 m0, s23, 4800
    s_nop 0
    buffer_load_dwordx4 v2, s[8:11], s24 offen offset:320 lds
    s_add_u32 m0, s23, 5760
    s_nop 0
    buffer_load_dwordx4 v2, s[8:11], s24 offen offset:384 lds
    s_add_u32 m0, s23, 6720
    s_nop 0
    buffer_load_dwordx4 v2, s[8:11], s24 offen offset:448 lds
    s_add_u32 m0, s23, 7680
    s_nop 0
    buffer_load_dwordx4 v2, s[8:11], s24 offen offset:512 lds
    s_add_u32 s24, s24, 147456
    s_waitcnt vmcnt(21) lgkmcnt(0)
    s_barrier
    s_add_u32 m0, s44, 139264
    s_add_u32 s22, s42, 1048576
    buffer_load_dwordx4 v8, s[12:15], s22 offen offset:0 lds
    s_add_u32 s22, s42, 1063936
    buffer_load_dwordx4 v9, s[12:15], s22 offen offset:1024 lds
    s_add_u32 s22, s42, 1079296
    buffer_load_dwordx4 v8, s[12:15], s22 offen offset:2048 lds
    s_add_u32 s22, s42, 1094656
    buffer_load_dwordx4 v9, s[12:15], s22 offen offset:3072 lds
    ds_read_b64_tr_b16 v[64:65], v10 offset:0
    ds_read_b64_tr_b16 v[66:67], v10 offset:2048
    ds_read_b64_tr_b16 v[136:137], v10 offset:8
    ds_read_b64_tr_b16 v[138:139], v10 offset:2056
    ds_read_b64_tr_b16 a[0:1], v10 offset:256
    ds_read_b64_tr_b16 a[2:3], v10 offset:2304
    ds_read_b64_tr_b16 a[72:73], v10 offset:264
    ds_read_b64_tr_b16 a[74:75], v10 offset:2312
    s_waitcnt vmcnt(21) lgkmcnt(0)
    s_barrier
    s_add_u32 m0, s44, 73728
    s_add_u32 s22, s42, 1310720
    buffer_load_dwordx4 v8, s[12:15], s22 offen offset:0 lds
    s_add_u32 s22, s42, 1326080
    buffer_load_dwordx4 v9, s[12:15], s22 offen offset:1024 lds
    s_add_u32 s22, s42, 1341440
    buffer_load_dwordx4 v8, s[12:15], s22 offen offset:2048 lds
    s_add_u32 s22, s42, 1356800
    buffer_load_dwordx4 v9, s[12:15], s22 offen offset:3072 lds
    ds_read_b64_tr_b16 v[68:69], v10 offset:16384
    ds_read_b64_tr_b16 v[70:71], v10 offset:18432
    ds_read_b64_tr_b16 v[140:141], v10 offset:16392
    ds_read_b64_tr_b16 v[142:143], v10 offset:18440
    ds_read_b64_tr_b16 a[4:5], v10 offset:16640
    ds_read_b64_tr_b16 a[6:7], v10 offset:18688
    ds_read_b64_tr_b16 a[76:77], v10 offset:16648
    ds_read_b64_tr_b16 a[78:79], v10 offset:18696
    s_waitcnt vmcnt(21) lgkmcnt(0)
    s_barrier
    s_add_u32 m0, s44, 90112
    s_add_u32 s22, s42, 1572864
    buffer_load_dwordx4 v8, s[12:15], s22 offen offset:0 lds
    s_add_u32 s22, s42, 1588224
    buffer_load_dwordx4 v9, s[12:15], s22 offen offset:1024 lds
    s_add_u32 s22, s42, 1603584
    buffer_load_dwordx4 v8, s[12:15], s22 offen offset:2048 lds
    s_add_u32 s22, s42, 1618944
    buffer_load_dwordx4 v9, s[12:15], s22 offen offset:3072 lds
    ds_read_b64_tr_b16 v[72:73], v10 offset:32768
    ds_read_b64_tr_b16 v[74:75], v10 offset:34816
    ds_read_b64_tr_b16 v[144:145], v10 offset:32776
    ds_read_b64_tr_b16 v[146:147], v10 offset:34824
    ds_read_b64_tr_b16 a[8:9], v10 offset:33024
    ds_read_b64_tr_b16 a[10:11], v10 offset:35072
    ds_read_b64_tr_b16 a[80:81], v10 offset:33032
    ds_read_b64_tr_b16 a[82:83], v10 offset:35080
    s_waitcnt vmcnt(21) lgkmcnt(0)
    s_barrier
    s_add_u32 m0, s44, 106496
    s_add_u32 s22, s42, 1835008
    buffer_load_dwordx4 v8, s[12:15], s22 offen offset:0 lds
    s_add_u32 s22, s42, 1850368
    buffer_load_dwordx4 v9, s[12:15], s22 offen offset:1024 lds
    s_add_u32 s22, s42, 1865728
    buffer_load_dwordx4 v8, s[12:15], s22 offen offset:2048 lds
    s_add_u32 s22, s42, 1881088
    buffer_load_dwordx4 v9, s[12:15], s22 offen offset:3072 lds
    ds_read_b64_tr_b16 v[76:77], v11 offset:0
    ds_read_b64_tr_b16 v[78:79], v11 offset:2048
    ds_read_b64_tr_b16 v[148:149], v11 offset:8
    ds_read_b64_tr_b16 v[150:151], v11 offset:2056
    ds_read_b64_tr_b16 a[12:13], v11 offset:256
    ds_read_b64_tr_b16 a[14:15], v11 offset:2304
    ds_read_b64_tr_b16 a[84:85], v11 offset:264
    ds_read_b64_tr_b16 a[86:87], v11 offset:2312
    s_waitcnt vmcnt(12) lgkmcnt(0)
    s_barrier
    s_add_u32 m0, s44, 122880
    s_add_u32 s22, s42, 2097152
    buffer_load_dwordx4 v8, s[12:15], s22 offen offset:0 lds
    s_add_u32 s22, s42, 2112512
    buffer_load_dwordx4 v9, s[12:15], s22 offen offset:1024 lds
    s_add_u32 s22, s42, 2127872
    buffer_load_dwordx4 v8, s[12:15], s22 offen offset:2048 lds
    s_add_u32 s22, s42, 2143232
    buffer_load_dwordx4 v9, s[12:15], s22 offen offset:3072 lds
    ds_read_b64_tr_b16 v[80:81], v11 offset:16384
    ds_read_b64_tr_b16 v[82:83], v11 offset:18432
    ds_read_b64_tr_b16 v[152:153], v11 offset:16392
    ds_read_b64_tr_b16 v[154:155], v11 offset:18440
    ds_read_b64_tr_b16 a[16:17], v11 offset:16640
    ds_read_b64_tr_b16 a[18:19], v11 offset:18688
    ds_read_b64_tr_b16 a[88:89], v11 offset:16648
    ds_read_b64_tr_b16 a[90:91], v11 offset:18696
    s_waitcnt vmcnt(12) lgkmcnt(0)
    s_barrier
    s_add_u32 m0, s44, 139264
    s_add_u32 s22, s42, 2359296
    buffer_load_dwordx4 v8, s[12:15], s22 offen offset:0 lds
    s_add_u32 s22, s42, 2374656
    buffer_load_dwordx4 v9, s[12:15], s22 offen offset:1024 lds
    s_add_u32 s22, s42, 2390016
    buffer_load_dwordx4 v8, s[12:15], s22 offen offset:2048 lds
    s_add_u32 s22, s42, 2405376
    buffer_load_dwordx4 v9, s[12:15], s22 offen offset:3072 lds
    ds_read_b64_tr_b16 v[84:85], v10 offset:0
    ds_read_b64_tr_b16 v[86:87], v10 offset:2048
    ds_read_b64_tr_b16 v[156:157], v10 offset:8
    ds_read_b64_tr_b16 v[158:159], v10 offset:2056
    ds_read_b64_tr_b16 a[20:21], v10 offset:256
    ds_read_b64_tr_b16 a[22:23], v10 offset:2304
    ds_read_b64_tr_b16 a[92:93], v10 offset:264
    ds_read_b64_tr_b16 a[94:95], v10 offset:2312
    s_waitcnt vmcnt(12) lgkmcnt(0)
    s_barrier
    s_add_u32 m0, s44, 73728
    s_add_u32 s22, s42, 2621440
    buffer_load_dwordx4 v8, s[12:15], s22 offen offset:0 lds
    s_add_u32 s22, s42, 2636800
    buffer_load_dwordx4 v9, s[12:15], s22 offen offset:1024 lds
    s_add_u32 s22, s42, 2652160
    buffer_load_dwordx4 v8, s[12:15], s22 offen offset:2048 lds
    s_add_u32 s22, s42, 2667520
    buffer_load_dwordx4 v9, s[12:15], s22 offen offset:3072 lds
    ds_read_b64_tr_b16 v[88:89], v10 offset:16384
    ds_read_b64_tr_b16 v[90:91], v10 offset:18432
    ds_read_b64_tr_b16 v[160:161], v10 offset:16392
    ds_read_b64_tr_b16 v[162:163], v10 offset:18440
    ds_read_b64_tr_b16 a[24:25], v10 offset:16640
    ds_read_b64_tr_b16 a[26:27], v10 offset:18688
    ds_read_b64_tr_b16 a[96:97], v10 offset:16648
    ds_read_b64_tr_b16 a[98:99], v10 offset:18696
    s_waitcnt vmcnt(12) lgkmcnt(0)
    s_barrier
    s_add_u32 m0, s44, 90112
    s_add_u32 s22, s42, 2883584
    buffer_load_dwordx4 v8, s[12:15], s22 offen offset:0 lds
    s_add_u32 s22, s42, 2898944
    buffer_load_dwordx4 v9, s[12:15], s22 offen offset:1024 lds
    s_add_u32 s22, s42, 2914304
    buffer_load_dwordx4 v8, s[12:15], s22 offen offset:2048 lds
    s_add_u32 s22, s42, 2929664
    buffer_load_dwordx4 v9, s[12:15], s22 offen offset:3072 lds
    ds_read_b64_tr_b16 v[92:93], v10 offset:32768
    ds_read_b64_tr_b16 v[94:95], v10 offset:34816
    ds_read_b64_tr_b16 v[164:165], v10 offset:32776
    ds_read_b64_tr_b16 v[166:167], v10 offset:34824
    ds_read_b64_tr_b16 a[28:29], v10 offset:33024
    ds_read_b64_tr_b16 a[30:31], v10 offset:35072
    ds_read_b64_tr_b16 a[100:101], v10 offset:33032
    ds_read_b64_tr_b16 a[102:103], v10 offset:35080
    s_waitcnt vmcnt(12) lgkmcnt(0)
    s_barrier
    s_add_u32 m0, s44, 106496
    s_add_u32 s22, s42, 3145728
    buffer_load_dwordx4 v8, s[12:15], s22 offen offset:0 lds
    s_add_u32 s22, s42, 3161088
    buffer_load_dwordx4 v9, s[12:15], s22 offen offset:1024 lds
    s_add_u32 s22, s42, 3176448
    buffer_load_dwordx4 v8, s[12:15], s22 offen offset:2048 lds
    s_add_u32 s22, s42, 3191808
    buffer_load_dwordx4 v9, s[12:15], s22 offen offset:3072 lds
    ds_read_b64_tr_b16 v[96:97], v11 offset:0
    ds_read_b64_tr_b16 v[98:99], v11 offset:2048
    ds_read_b64_tr_b16 v[168:169], v11 offset:8
    ds_read_b64_tr_b16 v[170:171], v11 offset:2056
    ds_read_b64_tr_b16 a[32:33], v11 offset:256
    ds_read_b64_tr_b16 a[34:35], v11 offset:2304
    ds_read_b64_tr_b16 a[104:105], v11 offset:264
    ds_read_b64_tr_b16 a[106:107], v11 offset:2312
    s_waitcnt vmcnt(12) lgkmcnt(0)
    s_barrier
    s_add_u32 m0, s44, 122880
    s_add_u32 s22, s42, 3407872
    buffer_load_dwordx4 v8, s[12:15], s22 offen offset:0 lds
    s_add_u32 s22, s42, 3423232
    buffer_load_dwordx4 v9, s[12:15], s22 offen offset:1024 lds
    s_add_u32 s22, s42, 3438592
    buffer_load_dwordx4 v8, s[12:15], s22 offen offset:2048 lds
    s_add_u32 s22, s42, 3453952
    buffer_load_dwordx4 v9, s[12:15], s22 offen offset:3072 lds
    ds_read_b64_tr_b16 v[100:101], v11 offset:16384
    ds_read_b64_tr_b16 v[102:103], v11 offset:18432
    ds_read_b64_tr_b16 v[172:173], v11 offset:16392
    ds_read_b64_tr_b16 v[174:175], v11 offset:18440
    ds_read_b64_tr_b16 a[36:37], v11 offset:16640
    ds_read_b64_tr_b16 a[38:39], v11 offset:18688
    ds_read_b64_tr_b16 a[108:109], v11 offset:16648
    ds_read_b64_tr_b16 a[110:111], v11 offset:18696
    s_waitcnt vmcnt(12) lgkmcnt(0)
    s_barrier
    s_add_u32 m0, s44, 139264
    s_add_u32 s22, s42, 3670016
    buffer_load_dwordx4 v8, s[12:15], s22 offen offset:0 lds
    s_add_u32 s22, s42, 3685376
    buffer_load_dwordx4 v9, s[12:15], s22 offen offset:1024 lds
    s_add_u32 s22, s42, 3700736
    buffer_load_dwordx4 v8, s[12:15], s22 offen offset:2048 lds
    s_add_u32 s22, s42, 3716096
    buffer_load_dwordx4 v9, s[12:15], s22 offen offset:3072 lds
    ds_read_b64_tr_b16 v[104:105], v10 offset:0
    ds_read_b64_tr_b16 v[106:107], v10 offset:2048
    ds_read_b64_tr_b16 v[176:177], v10 offset:8
    ds_read_b64_tr_b16 v[178:179], v10 offset:2056
    ds_read_b64_tr_b16 a[40:41], v10 offset:256
    ds_read_b64_tr_b16 a[42:43], v10 offset:2304
    ds_read_b64_tr_b16 a[112:113], v10 offset:264
    ds_read_b64_tr_b16 a[114:115], v10 offset:2312
    s_waitcnt vmcnt(12) lgkmcnt(0)
    s_barrier
    s_add_u32 m0, s44, 73728
    s_add_u32 s22, s42, 3932160
    buffer_load_dwordx4 v8, s[12:15], s22 offen offset:0 lds
    s_add_u32 s22, s42, 3947520
    buffer_load_dwordx4 v9, s[12:15], s22 offen offset:1024 lds
    s_add_u32 s22, s42, 3962880
    buffer_load_dwordx4 v8, s[12:15], s22 offen offset:2048 lds
    s_add_u32 s22, s42, 3978240
    buffer_load_dwordx4 v9, s[12:15], s22 offen offset:3072 lds
    ds_read_b64_tr_b16 v[108:109], v10 offset:16384
    ds_read_b64_tr_b16 v[110:111], v10 offset:18432
    ds_read_b64_tr_b16 v[180:181], v10 offset:16392
    ds_read_b64_tr_b16 v[182:183], v10 offset:18440
    ds_read_b64_tr_b16 a[44:45], v10 offset:16640
    ds_read_b64_tr_b16 a[46:47], v10 offset:18688
    ds_read_b64_tr_b16 a[116:117], v10 offset:16648
    ds_read_b64_tr_b16 a[118:119], v10 offset:18696
    s_waitcnt vmcnt(12) lgkmcnt(0)
    s_barrier
    s_add_u32 m0, s44, 90112
    s_add_u32 s22, s42, 4194304
    buffer_load_dwordx4 v8, s[12:15], s22 offen offset:0 lds
    s_add_u32 s22, s42, 4209664
    buffer_load_dwordx4 v9, s[12:15], s22 offen offset:1024 lds
    s_add_u32 s22, s42, 4225024
    buffer_load_dwordx4 v8, s[12:15], s22 offen offset:2048 lds
    s_add_u32 s22, s42, 4240384
    buffer_load_dwordx4 v9, s[12:15], s22 offen offset:3072 lds
    ds_read_b64_tr_b16 v[112:113], v10 offset:32768
    ds_read_b64_tr_b16 v[114:115], v10 offset:34816
    ds_read_b64_tr_b16 v[184:185], v10 offset:32776
    ds_read_b64_tr_b16 v[186:187], v10 offset:34824
    ds_read_b64_tr_b16 a[48:49], v10 offset:33024
    ds_read_b64_tr_b16 a[50:51], v10 offset:35072
    ds_read_b64_tr_b16 a[120:121], v10 offset:33032
    ds_read_b64_tr_b16 a[122:123], v10 offset:35080
    s_waitcnt vmcnt(12) lgkmcnt(0)
    s_barrier
    s_add_u32 m0, s44, 106496
    s_add_u32 s22, s42, 4456448
    buffer_load_dwordx4 v8, s[12:15], s22 offen offset:0 lds
    s_add_u32 s22, s42, 4471808
    buffer_load_dwordx4 v9, s[12:15], s22 offen offset:1024 lds
    s_add_u32 s22, s42, 4487168
    buffer_load_dwordx4 v8, s[12:15], s22 offen offset:2048 lds
    s_add_u32 s22, s42, 4502528
    buffer_load_dwordx4 v9, s[12:15], s22 offen offset:3072 lds
    ds_read_b64_tr_b16 v[116:117], v11 offset:0
    ds_read_b64_tr_b16 v[118:119], v11 offset:2048
    ds_read_b64_tr_b16 v[188:189], v11 offset:8
    ds_read_b64_tr_b16 v[190:191], v11 offset:2056
    ds_read_b64_tr_b16 a[52:53], v11 offset:256
    ds_read_b64_tr_b16 a[54:55], v11 offset:2304
    ds_read_b64_tr_b16 a[124:125], v11 offset:264
    ds_read_b64_tr_b16 a[126:127], v11 offset:2312
    s_waitcnt vmcnt(12) lgkmcnt(0)
    s_barrier
    s_mov_b32 s27, 36864
    s_add_u32 s23, s27, s25
    s_add_u32 m0, s23, 0
    s_nop 0
    buffer_load_dwordx4 v2, s[8:11], s24 offen offset:0 lds
    s_add_u32 m0, s23, 960
    s_nop 0
    buffer_load_dwordx4 v2, s[8:11], s24 offen offset:64 lds
    s_add_u32 m0, s23, 1920
    s_nop 0
    buffer_load_dwordx4 v2, s[8:11], s24 offen offset:128 lds
    s_add_u32 m0, s23, 2880
    s_nop 0
    buffer_load_dwordx4 v2, s[8:11], s24 offen offset:192 lds
    s_add_u32 m0, s23, 3840
    s_nop 0
    buffer_load_dwordx4 v2, s[8:11], s24 offen offset:256 lds
    s_add_u32 m0, s23, 4800
    s_nop 0
    buffer_load_dwordx4 v2, s[8:11], s24 offen offset:320 lds
    s_add_u32 m0, s23, 5760
    s_nop 0
    buffer_load_dwordx4 v2, s[8:11], s24 offen offset:384 lds
    s_add_u32 m0, s23, 6720
    s_nop 0
    buffer_load_dwordx4 v2, s[8:11], s24 offen offset:448 lds
    s_add_u32 m0, s23, 7680
    s_nop 0
    buffer_load_dwordx4 v2, s[8:11], s24 offen offset:512 lds
    s_add_u32 s24, s24, 147456
    ds_read_b64_tr_b16 v[120:121], v11 offset:16384
    ds_read_b64_tr_b16 v[122:123], v11 offset:18432
    ds_read_b64_tr_b16 v[192:193], v11 offset:16392
    ds_read_b64_tr_b16 v[194:195], v11 offset:18440
    ds_read_b64_tr_b16 a[56:57], v11 offset:16640
    ds_read_b64_tr_b16 a[58:59], v11 offset:18688
    ds_read_b64_tr_b16 a[128:129], v11 offset:16648
    ds_read_b64_tr_b16 a[130:131], v11 offset:18696
    s_waitcnt vmcnt(17) lgkmcnt(0)
    s_barrier
    ds_read_b64_tr_b16 v[124:125], v10 offset:0
    ds_read_b64_tr_b16 v[126:127], v10 offset:2048
    ds_read_b64_tr_b16 v[196:197], v10 offset:8
    ds_read_b64_tr_b16 v[198:199], v10 offset:2056
    ds_read_b64_tr_b16 a[60:61], v10 offset:256
    ds_read_b64_tr_b16 a[62:63], v10 offset:2304
    ds_read_b64_tr_b16 a[132:133], v10 offset:264
    ds_read_b64_tr_b16 a[134:135], v10 offset:2312
    s_waitcnt vmcnt(13) lgkmcnt(0)
    s_barrier
    ds_read_b64_tr_b16 v[128:129], v10 offset:16384
    ds_read_b64_tr_b16 v[130:131], v10 offset:18432
    ds_read_b64_tr_b16 v[200:201], v10 offset:16392
    ds_read_b64_tr_b16 v[202:203], v10 offset:18440
    ds_read_b64_tr_b16 a[64:65], v10 offset:16640
    ds_read_b64_tr_b16 a[66:67], v10 offset:18688
    ds_read_b64_tr_b16 a[136:137], v10 offset:16648
    ds_read_b64_tr_b16 a[138:139], v10 offset:18696
    s_waitcnt vmcnt(9) lgkmcnt(0)
    s_barrier
    ds_read_b64_tr_b16 v[132:133], v10 offset:32768
    ds_read_b64_tr_b16 v[134:135], v10 offset:34816
    ds_read_b64_tr_b16 v[204:205], v10 offset:32776
    ds_read_b64_tr_b16 v[206:207], v10 offset:34824
    ds_read_b64_tr_b16 a[68:69], v10 offset:33024
    ds_read_b64_tr_b16 a[70:71], v10 offset:35072
    ds_read_b64_tr_b16 a[140:141], v10 offset:33032
    ds_read_b64_tr_b16 a[142:143], v10 offset:35080
    s_mov_b32 s88, 4194304
gn8:
    buffer_load_dword v250, off, s[84:87], 0 offset:216 sc1
    s_waitcnt vmcnt(0)
    v_readfirstlane_b32 s95, v250
    s_sub_u32 s88, s88, 1
    s_cbranch_scc1 gn8x
    s_cmp_eq_u32 s95, 0
    s_cbranch_scc1 gn8
gn8x:
    s_waitcnt lgkmcnt(0)
    s_mov_b32 s45, 0
    s_mov_b32 s27, 0
    s_mov_b64 s[36:37], 0
    s_mov_b32 s12, 0
    s_mov_b32 s13, s40
    s_lshr_b32 s14, s41, 5
    s_add_u32 s15, s14, s40
    s_lshl_b32 s41, s41, 2
    s_sub_u32 s26, s26, s41
    v_mov_b32 v3, v1
    s_waitcnt vmcnt(0)
    s_barrier
    ds_read_b128 v[32:35], v3 offset:0
    ds_read_b128 v[36:39], v3 offset:18432
    ds_read_b128 v[40:43], v3 offset:1024
    ds_read_b128 v[44:47], v3 offset:19456
    s_cmp_eq_u32 s18, 0
    s_cselect_b32 s34, 1, 0
    s_mov_b32 s35, 0
    s_cmp_eq_u32 s16, 2
    s_cbranch_scc1 qk_vloop
qk_loop:
    s_barrier
    s_add_u32 s22, s27, 73728
    s_sub_u32 s21, s22, 110592
    s_cselect_b32 s22, s22, s21
    s_waitcnt lgkmcnt(2)
    v_mfma_f32_16x16x32_bf16 v[208:211], v[64:67], v[32:35], 0
    ds_read_b128 v[48:51], v3 offset:2048
    v_mfma_f32_16x16x32_bf16 v[212:215], v[136:139], v[32:35], 0
    ds_read_b128 v[52:55], v3 offset:20480
    v_mfma_f32_16x16x32_bf16 v[216:219], v[64:67], v[36:39], 0
    v_mfma_f32_16x16x32_bf16 v[220:223], v[136:139], v[36:39], 0
    v_mfma_f32_16x16x32_bf16 v[224:227], a[0:3], v[32:35], 0
    v_mfma_f32_16x16x32_bf16 v[228:231], a[72:75], v[32:35], 0
    v_mfma_f32_16x16x32_bf16 v[232:235], a[0:3], v[36:39], 0
    v_mfma_f32_16x16x32_bf16 v[236:239], a[72:75], v[36:39], 0
    s_waitcnt lgkmcnt(2)
    v_mfma_f32_16x16x32_bf16 v[208:211], v[68:71], v[40:43], v[208:211]
    ds_read_b128 v[32:35], v3 offset:3072
    v_mfma_f32_16x16x32_bf16 v[212:215], v[140:143], v[40:43], v[212:215]
    ds_read_b128 v[36:39], v3 offset:21504
    v_mfma_f32_16x16x32_bf16 v[216:219], v[68:71], v[44:47], v[216:219]
    s_add_u32 s23, s22, s25
    s_add_u32 m0, s23, 0
    s_nop 0
    buffer_load_dwordx4 v2, s[8:11], s24 offen offset:0 lds
    v_mfma_f32_16x16x32_bf16 v[220:223], v[140:143], v[44:47], v[220:223]
    v_mfma_f32_16x16x32_bf16 v[224:227], a[4:7], v[40:43], v[224:227]
    v_mfma_f32_16x16x32_bf16 v[228:231], a[76:79], v[40:43], v[228:231]
    v_mfma_f32_16x16x32_bf16 v[232:235], a[4:7], v[44:47], v[232:235]
    s_add_u32 m0, s23, 960
    s_nop 0
    buffer_load_dwordx4 v2, s[8:11], s24 offen offset:64 lds
    v_mfma_f32_16x16x32_bf16 v[236:239], a[76:79], v[44:47], v[236:239]
    s_waitcnt lgkmcnt(2)
    v_mfma_f32_16x16x32_bf16 v[208:211], v[72:75], v[48:51], v[208:211]
    ds_read_b128 v[40:43], v3 offset:4096
    v_mfma_f32_16x16x32_bf16 v[212:215], v[144:147], v[48:51], v[212:215]
    ds_read_b128 v[44:47], v3 offset:22528
    v_mfma_f32_16x16x32_bf16 v[216:219], v[72:75], v[52:55], v[216:219]
    s_add_u32 m0, s23, 1920
    s_nop 0
    buffer_load_dwordx4 v2, s[8:11], s24 offen offset:128 lds
    v_mfma_f32_16x16x32_bf16 v[220:223], v[144:147], v[52:55], v[220:223]
    v_mfma_f32_16x16x32_bf16 v[224:227], a[8:11], v[48:51], v[224:227]
    v_mfma_f32_16x16x32_bf16 v[228:231], a[80:83], v[48:51], v[228:231]
    v_mfma_f32_16x16x32_bf16 v[232:235], a[8:11], v[52:55], v[232:235]
    s_add_u32 m0, s23, 2880
    s_nop 0
    buffer_load_dwordx4 v2, s[8:11], s24 offen offset:192 lds
    v_mfma_f32_16x16x32_bf16 v[236:239], a[80:83], v[52:55], v[236:239]
    s_waitcnt lgkmcnt(2)
    v_mfma_f32_16x16x32_bf16 v[208:211], v[76:79], v[32:35], v[208:211]
    ds_read_b128 v[48:51], v3 offset:5120
    v_mfma_f32_16x16x32_bf16 v[212:215], v[148:151], v[32:35], v[212:215]
    ds_read_b128 v[52:55], v3 offset:23552
    v_mfma_f32_16x16x32_bf16 v[216:219], v[76:79], v[36:39], v[216:219]
    s_add_u32 m0, s23, 3840
    s_nop 0
    buffer_load_dwordx4 v2, s[8:11], s24 offen offset:256 lds
    v_mfma_f32_16x16x32_bf16 v[220:223], v[148:151], v[36:39], v[220:223]
    v_mfma_f32_16x16x32_bf16 v[224:227], a[12:15], v[32:35], v[224:227]
    v_mfma_f32_16x16x32_bf16 v[228:231], a[84:87], v[32:35], v[228:231]
    v_mfma_f32_16x16x32_bf16 v[232:235], a[12:15], v[36:39], v[232:235]
    s_add_u32 m0, s23, 4800
    s_nop 0
    buffer_load_dwordx4 v2, s[8:11], s24 offen offset:320 lds
    v_mfma_f32_16x16x32_bf16 v[236:239], a[84:87], v[36:39], v[236:239]
    s_waitcnt lgkmcnt(2)
    v_mfma_f32_16x16x32_bf16 v[208:211], v[80:83], v[40:43], v[208:211]
    ds_read_b128 v[32:35], v3 offset:6144
    v_mfma_f32_16x16x32_bf16 v[212:215], v[152:155], v[40:43], v[212:215]
    ds_read_b128 v[36:39], v3 offset:24576
    v_mfma_f32_16x16x32_bf16 v[216:219], v[80:83], v[44:47], v[216:219]
    s_add_u32 m0, s23, 5760
    s_nop 0
    buffer_load_dwordx4 v2, s[8:11], s24 offen offset:384 lds
    v_mfma_f32_16x16x32_bf16 v[220:223], v[152:155], v[44:47], v[220:223]
    v_mfma_f32_16x16x32_bf16 v[224:227], a[16:19], v[40:43], v[224:227]
    v_mfma_f32_16x16x32_bf16 v[228:231], a[88:91], v[40:43], v[228:231]
    v_mfma_f32_16x16x32_bf16 v[232:235], a[16:19], v[44:47], v[232:235]
    s_add_u32 m0, s23, 6720
    s_nop 0
    buffer_load_dwordx4 v2, s[8:11], s24 offen offset:448 lds
    v_mfma_f32_16x16x32_bf16 v[236:239], a[88:91], v[44:47], v[236:239]
    s_waitcnt lgkmcnt(2)
    v_mfma_f32_16x16x32_bf16 v[208:211], v[84:87], v[48:51], v[208:211]
    ds_read_b128 v[40:43], v3 offset:7168
    v_mfma_f32_16x16x32_bf16 v[212:215], v[156:159], v[48:51], v[212:215]
    ds_read_b128 v[44:47], v3 offset:25600
    v_mfma_f32_16x16x32_bf16 v[216:219], v[84:87], v[52:55], v[216:219]
    s_add_u32 m0, s23, 7680
    s_nop 0
    buffer_load_dwordx4 v2, s[8:11], s24 offen offset:512 lds
    s_add_u32 s24, s24, 147456
    v_mfma_f32_16x16x32_bf16 v[220:223], v[156:159], v[52:55], v[220:223]
    v_mfma_f32_16x16x32_bf16 v[224:227], a[20:23], v[48:51], v[224:227]
    v_mfma_f32_16x16x32_bf16 v[228:231], a[92:95], v[48:51], v[228:231]
    v_mfma_f32_16x16x32_bf16 v[232:235], a[20:23], v[52:55], v[232:235]
    v_mfma_f32_16x16x32_bf16 v[236:239], a[92:95], v[52:55], v[236:239]
    s_waitcnt lgkmcnt(2)
    v_mfma_f32_16x16x32_bf16 v[208:211], v[88:91], v[32:35], v[208:211]
    ds_read_b128 v[48:51], v3 offset:8192
    v_mfma_f32_16x16x32_bf16 v[212:215], v[160:163], v[32:35], v[212:215]
    ds_read_b128 v[52:55], v3 offset:26624
    v_mfma_f32_16x16x32_bf16 v[216:219], v[88:91], v[36:39], v[216:219]
    v_mfma_f32_16x16x32_bf16 v[220:223], v[160:163], v[36:39], v[220:223]
    v_mfma_f32_16x16x32_bf16 v[224:227], a[24:27], v[32:35], v[224:227]
    v_mfma_f32_16x16x32_bf16 v[228:231], a[96:99], v[32:35], v[228:231]
    v_mfma_f32_16x16x32_bf16 v[232:235], a[24:27], v[36:39], v[232:235]
    v_mfma_f32_16x16x32_bf16 v[236:239], a[96:99], v[36:39], v[236:239]
    s_waitcnt lgkmcnt(2)
    v_mfma_f32_16x16x32_bf16 v[208:211], v[92:95], v[40:43], v[208:211]
    ds_read_b128 v[32:35], v3 offset:9216
    v_mfma_f32_16x16x32_bf16 v[212:215], v[164:167], v[40:43], v[212:215]
    ds_read_b128 v[36:39], v3 offset:27648
    v_mfma_f32_16x16x32_bf16 v[216:219], v[92:95], v[44:47], v[216:219]
    s_add_u32 s23, s45, s95
    v_mov_b32 v4, s23
    s_mov_b64 exec, s[34:35]
    buffer_store_dword v4, off, s[4:7], s29 sc1
    buffer_store_dword v4, off, s[4:7], s29 offset:128 sc1
    s_mov_b64 exec, -1
    v_mfma_f32_16x16x32_bf16 v[220:223], v[164:167], v[44:47], v[220:223]
    v_mfma_f32_16x16x32_bf16 v[224:227], a[28:31], v[40:43], v[224:227]
    v_mfma_f32_16x16x32_bf16 v[228:231], a[100:103], v[40:43], v[228:231]
    v_mfma_f32_16x16x32_bf16 v[232:235], a[28:31], v[44:47], v[232:235]
    v_mfma_f32_16x16x32_bf16 v[236:239], a[100:103], v[44:47], v[236:239]
    s_waitcnt lgkmcnt(2)
    v_mfma_f32_16x16x32_bf16 v[208:211], v[96:99], v[48:51], v[208:211]
    ds_read_b128 v[40:43], v3 offset:10240
    v_mfma_f32_16x16x32_bf16 v[212:215], v[168:171], v[48:51], v[212:215]
    ds_read_b128 v[44:47], v3 offset:28672
    v_mfma_f32_16x16x32_bf16 v[216:219], v[96:99], v[52:55], v[216:219]
    s_cmp_lt_u32 s19, 60
    s_cbranch_scc1 lt9
    buffer_load_dwordx4 v[244:247], off, s[84:87], 0 offset:16 sc1
    buffer_load_dword v248, off, s[84:87], 0 offset:4 sc1
lt9:
    v_mfma_f32_16x16x32_bf16 v[220:223], v[168:171], v[52:55], v[220:223]
    v_mfma_f32_16x16x32_bf16 v[224:227], a[32:35], v[48:51], v[224:227]
    v_mfma_f32_16x16x32_bf16 v[228:231], a[104:107], v[48:51], v[228:231]
    v_mfma_f32_16x16x32_bf16 v[232:235], a[32:35], v[52:55], v[232:235]
    v_mfma_f32_16x16x32_bf16 v[236:239], a[104:107], v[52:55], v[236:239]
    s_waitcnt lgkmcnt(2)
    v_mfma_f32_16x16x32_bf16 v[208:211], v[100:103], v[32:35], v[208:211]
    ds_read_b128 v[48:51], v3 offset:11264
    v_mfma_f32_16x16x32_bf16 v[212:215], v[172:175], v[32:35], v[212:215]
    ds_read_b128 v[52:55], v3 offset:29696
    v_mfma_f32_16x16x32_bf16 v[216:219], v[100:103], v[36:39], v[216:219]
    v_mfma_f32_16x16x32_bf16 v[220:223], v[172:175], v[36:39], v[220:223]
    v_mfma_f32_16x16x32_bf16 v[224:227], a[36:39], v[32:35], v[224:227]
    v_mfma_f32_16x16x32_bf16 v[228:231], a[108:111], v[32:35], v[228:231]
    v_mfma_f32_16x16x32_bf16 v[232:235], a[36:39], v[36:39], v[232:235]
    v_mfma_f32_16x16x32_bf16 v[236:239], a[108:111], v[36:39], v[236:239]
    s_waitcnt lgkmcnt(2)
    v_mfma_f32_16x16x32_bf16 v[208:211], v[104:107], v[40:43], v[208:211]
    ds_read_b128 v[32:35], v3 offset:12288
    v_mfma_f32_16x16x32_bf16 v[212:215], v[176:179], v[40:43], v[212:215]
    ds_read_b128 v[36:39], v3 offset:30720
    v_mfma_f32_16x16x32_bf16 v[216:219], v[104:107], v[44:47], v[216:219]
    v_mfma_f32_16x16x32_bf16 v[220:223], v[176:179], v[44:47], v[220:223]
    v_mfma_f32_16x16x32_bf16 v[224:227], a[40:43], v[40:43], v[224:227]
    v_mfma_f32_16x16x32_bf16 v[228:231], a[112:115], v[40:43], v[228:231]
    v_mfma_f32_16x16x32_bf16 v[232:235], a[40:43], v[44:47], v[232:235]
    v_mfma_f32_16x16x32_bf16 v[236:239], a[112:115], v[44:47], v[236:239]
    s_waitcnt lgkmcnt(2)
    v_mfma_f32_16x16x32_bf16 v[208:211], v[108:111], v[48:51], v[208:211]
    ds_read_b128 v[40:43], v3 offset:13312
    v_mfma_f32_16x16x32_bf16 v[212:215], v[180:183], v[48:51], v[212:215]
    ds_read_b128 v[44:47], v3 offset:31744
    v_mfma_f32_16x16x32_bf16 v[216:219], v[108:111], v[52:55], v[216:219]
    v_mfma_f32_16x16x32_bf16 v[220:223], v[180:183], v[52:55], v[220:223]
    v_mfma_f32_16x16x32_bf16 v[224:227], a[44:47], v[48:51], v[224:227]
    v_mfma_f32_16x16x32_bf16 v[228:231], a[116:119], v[48:51], v[228:231]
    v_mfma_f32_16x16x32_bf16 v[232:235], a[44:47], v[52:55], v[232:235]
    v_mfma_f32_16x16x32_bf16 v[236:239], a[116:119], v[52:55], v[236:239]
    s_waitcnt lgkmcnt(2)
    v_mfma_f32_16x16x32_bf16 v[208:211], v[112:115], v[32:35], v[208:211]
    ds_read_b128 v[48:51], v3 offset:14336
    v_mfma_f32_16x16x32_bf16 v[212:215], v[184:187], v[32:35], v[212:215]
    ds_read_b128 v[52:55], v3 offset:32768
    v_mfma_f32_16x16x32_bf16 v[216:219], v[112:115], v[36:39], v[216:219]
    v_mfma_f32_16x16x32_bf16 v[220:223], v[184:187], v[36:39], v[220:223]
    v_mfma_f32_16x16x32_bf16 v[224:227], a[48:51], v[32:35], v[224:227]
    v_mfma_f32_16x16x32_bf16 v[228:231], a[120:123], v[32:35], v[228:231]
    v_mfma_f32_16x16x32_bf16 v[232:235], a[48:51], v[36:39], v[232:235]
    v_mfma_f32_16x16x32_bf16 v[236:239], a[120:123], v[36:39], v[236:239]
    s_waitcnt lgkmcnt(2)
    v_mfma_f32_16x16x32_bf16 v[208:211], v[116:119], v[40:43], v[208:211]
    ds_read_b128 v[32:35], v3 offset:15360
    v_mfma_f32_16x16x32_bf16 v[212:215], v[188:191], v[40:43], v[212:215]
    ds_read_b128 v[36:39], v3 offset:33792
    v_mfma_f32_16x16x32_bf16 v[216:219], v[116:119], v[44:47], v[216:219]
    v_mfma_f32_16x16x32_bf16 v[220:223], v[188:191], v[44:47], v[220:223]
    v_mfma_f32_16x16x32_bf16 v[224:227], a[52:55], v[40:43], v[224:227]
    v_mfma_f32_16x16x32_bf16 v[228:231], a[124:127], v[40:43], v[228:231]
    v_mfma_f32_16x16x32_bf16 v[232:235], a[52:55], v[44:47], v[232:235]
    v_mfma_f32_16x16x32_bf16 v[236:239], a[124:127], v[44:47], v[236:239]
    s_waitcnt lgkmcnt(2)
    v_mfma_f32_16x16x32_bf16 v[208:211], v[120:123], v[48:51], v[208:211]
    ds_read_b128 v[40:43], v3 offset:16384
    v_mfma_f32_16x16x32_bf16 v[212:215], v[192:195], v[48:51], v[212:215]
    ds_read_b128 v[44:47], v3 offset:34816
    v_mfma_f32_16x16x32_bf16 v[216:219], v[120:123], v[52:55], v[216:219]
    v_mfma_f32_16x16x32_bf16 v[220:223], v[192:195], v[52:55], v[220:223]
    v_mfma_f32_16x16x32_bf16 v[224:227], a[56:59], v[48:51], v[224:227]
    v_mfma_f32_16x16x32_bf16 v[228:231], a[128:131], v[48:51], v[228:231]
    v_mfma_f32_16x16x32_bf16 v[232:235], a[56:59], v[52:55], v[232:235]
    v_mfma_f32_16x16x32_bf16 v[236:239], a[128:131], v[52:55], v[236:239]
    s_waitcnt lgkmcnt(2)
    v_mfma_f32_16x16x32_bf16 v[208:211], v[124:127], v[32:35], v[208:211]
    ds_read_b128 v[48:51], v3 offset:17408
    v_mfma_f32_16x16x32_bf16 v[212:215], v[196:199], v[32:35], v[212:215]
    ds_read_b128 v[52:55], v3 offset:35840
    v_mfma_f32_16x16x32_bf16 v[216:219], v[124:127], v[36:39], v[216:219]
    v_mfma_f32_16x16x32_bf16 v[220:223], v[196:199], v[36:39], v[220:223]
    v_mfma_f32_16x16x32_bf16 v[224:227], a[60:63], v[32:35], v[224:227]
    s_add_u32 s27, s27, 36864
    s_cmp_eq_u32 s27, 110592
    s_cselect_b32 s27, 0, s27
    v_add_u32 v3, s27, v1
    v_mfma_f32_16x16x32_bf16 v[228:231], a[132:135], v[32:35], v[228:231]
    v_mfma_f32_16x16x32_bf16 v[232:235], a[60:63], v[36:39], v[232:235]
    v_mfma_f32_16x16x32_bf16 v[236:239], a[132:135], v[36:39], v[236:239]
    s_waitcnt lgkmcnt(2)
    v_mfma_f32_16x16x32_bf16 v[208:211], v[128:131], v[40:43], v[208:211]
    ds_read_b128 v[32:35], v3 offset:0
    v_mfma_f32_16x16x32_bf16 v[212:215], v[200:203], v[40:43], v[212:215]
    ds_read_b128 v[36:39], v3 offset:18432
    v_mfma_f32_16x16x32_bf16 v[216:219], v[128:131], v[44:47], v[216:219]
    v_mfma_f32_16x16x32_bf16 v[220:223], v[200:203], v[44:47], v[220:223]
    v_mfma_f32_16x16x32_bf16 v[224:227], a[64:67], v[40:43], v[224:227]
    v_mfma_f32_16x16x32_bf16 v[228:231], a[136:139], v[40:43], v[228:231]
    v_mfma_f32_16x16x32_bf16 v[232:235], a[64:67], v[44:47], v[232:235]
    v_mfma_f32_16x16x32_bf16 v[236:239], a[136:139], v[44:47], v[236:239]
    s_waitcnt lgkmcnt(2)
    v_mfma_f32_16x16x32_bf16 v[208:211], v[132:135], v[48:51], v[208:211]
    ds_read_b128 v[40:43], v3 offset:1024
    v_mfma_f32_16x16x32_bf16 v[212:215], v[204:207], v[48:51], v[212:215]
    ds_read_b128 v[44:47], v3 offset:19456
    v_mfma_f32_16x16x32_bf16 v[216:219], v[132:135], v[52:55], v[216:219]
    v_mfma_f32_16x16x32_bf16 v[220:223], v[204:207], v[52:55], v[220:223]
    v_mfma_f32_16x16x32_bf16 v[224:227], a[68:71], v[48:51], v[224:227]
    v_mfma_f32_16x16x32_bf16 v[228:231], a[140:143], v[48:51], v[228:231]
    v_mfma_f32_16x16x32_bf16 v[232:235], a[68:71], v[52:55], v[232:235]
    v_mfma_f32_16x16x32_bf16 v[236:239], a[140:143], v[52:55], v[236:239]
    s_add_u32 s26, s26, s41
    s_waitcnt vmcnt(0)
    v_cvt_pk_bf16_f32 v8, v208, v209
    v_cvt_pk_bf16_f32 v9, v210, v211
    v_cvt_pk_bf16_f32 v10, v212, v213
    v_cvt_pk_bf16_f32 v11, v214, v215
    v_cvt_pk_bf16_f32 v12, v216, v217
    v_cvt_pk_bf16_f32 v13, v218, v219
    v_cvt_pk_bf16_f32 v14, v220, v221
    v_cvt_pk_bf16_f32 v15, v222, v223
    v_cvt_pk_bf16_f32 v16, v224, v225
    v_cvt_pk_bf16_f32 v17, v226, v227
    v_cvt_pk_bf16_f32 v18, v228, v229
    v_cvt_pk_bf16_f32 v19, v230, v231
    v_cvt_pk_bf16_f32 v20, v232, v233
    v_cvt_pk_bf16_f32 v21, v234, v235
    v_cvt_pk_bf16_f32 v22, v236, v237
    v_cvt_pk_bf16_f32 v23, v238, v239
    s_mov_b64 s[36:37], -1
    s_add_u32 s28, s26, s12
    buffer_store_dwordx4 v[8:11], v7, s[4:7], s28 offen sc1
    s_add_u32 s28, s26, s13
    buffer_store_dwordx4 v[12:15], v7, s[4:7], s28 offen sc1
    s_add_u32 s28, s26, s14
    buffer_store_dwordx4 v[16:19], v7, s[4:7], s28 offen sc1
    s_add_u32 s28, s26, s15
    buffer_store_dwordx4 v[20:23], v7, s[4:7], s28 offen sc1
    s_lshr_b32 s45, s19, 2
    s_cbranch_scc1 qk_loop_nf
    s_mov_b32 s45, 1
    s_mov_b64 s[36:37], 0
    s_waitcnt vmcnt(0)
    s_barrier
    s_add_u32 s23, s45, s95
    v_mov_b32 v4, s23
    s_mov_b64 exec, s[34:35]
    buffer_store_dword v4, off, s[4:7], s29 sc1
    buffer_store_dword v4, off, s[4:7], s29 offset:128 sc1
    s_mov_b64 exec, -1
qk_loop_nf:
    s_add_u32 s19, s19, 4
    s_cmp_lt_u32 s19, s20
    s_cbranch_scc1 qk_loop
    s_branch qk_done
qk_vloop:
    s_barrier
    s_add_u32 s22, s27, 73728
    s_sub_u32 s21, s22, 110592
    s_cselect_b32 s22, s22, s21
    s_waitcnt lgkmcnt(2)
    v_mfma_f32_16x16x32_bf16 v[208:211], v[32:35], v[64:67], 0
    ds_read_b128 v[48:51], v3 offset:2048
    v_mfma_f32_16x16x32_bf16 v[212:215], v[32:35], v[136:139], 0
    ds_read_b128 v[52:55], v3 offset:20480
    v_mfma_f32_16x16x32_bf16 v[216:219], v[36:39], v[64:67], 0
    v_mfma_f32_16x16x32_bf16 v[220:223], v[36:39], v[136:139], 0
    v_mfma_f32_16x16x32_bf16 v[224:227], v[32:35], a[0:3], 0
    v_mfma_f32_16x16x32_bf16 v[228:231], v[32:35], a[72:75], 0
    v_mfma_f32_16x16x32_bf16 v[232:235], v[36:39], a[0:3], 0
    v_mfma_f32_16x16x32_bf16 v[236:239], v[36:39], a[72:75], 0
    s_waitcnt lgkmcnt(2)
    v_mfma_f32_16x16x32_bf16 v[208:211], v[40:43], v[68:71], v[208:211]
    ds_read_b128 v[32:35], v3 offset:3072
    v_mfma_f32_16x16x32_bf16 v[212:215], v[40:43], v[140:143], v[212:215]
    ds_read_b128 v[36:39], v3 offset:21504
    v_mfma_f32_16x16x32_bf16 v[216:219], v[44:47], v[68:71], v[216:219]
    s_add_u32 s23, s22, s25
    s_add_u32 m0, s23, 0
    s_nop 0
    buffer_load_dwordx4 v2, s[8:11], s24 offen offset:0 lds
    v_mfma_f32_16x16x32_bf16 v[220:223], v[44:47], v[140:143], v[220:223]
    v_mfma_f32_16x16x32_bf16 v[224:227], v[40:43], a[4:7], v[224:227]
    v_mfma_f32_16x16x32_bf16 v[228:231], v[40:43], a[76:79], v[228:231]
    v_mfma_f32_16x16x32_bf16 v[232:235], v[44:47], a[4:7], v[232:235]
    s_add_u32 m0, s23, 960
    s_nop 0
    buffer_load_dwordx4 v2, s[8:11], s24 offen offset:64 lds
    v_mfma_f32_16x16x32_bf16 v[236:239], v[44:47], a[76:79], v[236:239]
    s_waitcnt lgkmcnt(2)
    v_mfma_f32_16x16x32_bf16 v[208:211], v[48:51], v[72:75], v[208:211]
    ds_read_b128 v[40:43], v3 offset:4096
    v_mfma_f32_16x16x32_bf16 v[212:215], v[48:51], v[144:147], v[212:215]
    ds_read_b128 v[44:47], v3 offset:22528
    v_mfma_f32_16x16x32_bf16 v[216:219], v[52:55], v[72:75], v[216:219]
    s_add_u32 m0, s23, 1920
    s_nop 0
    buffer_load_dwordx4 v2, s[8:11], s24 offen offset:128 lds
    v_mfma_f32_16x16x32_bf16 v[220:223], v[52:55], v[144:147], v[220:223]
    v_mfma_f32_16x16x32_bf16 v[224:227], v[48:51], a[8:11], v[224:227]
    v_mfma_f32_16x16x32_bf16 v[228:231], v[48:51], a[80:83], v[228:231]
    v_mfma_f32_16x16x32_bf16 v[232:235], v[52:55], a[8:11], v[232:235]
    s_add_u32 m0, s23, 2880
    s_nop 0
    buffer_load_dwordx4 v2, s[8:11], s24 offen offset:192 lds
    v_mfma_f32_16x16x32_bf16 v[236:239], v[52:55], a[80:83], v[236:239]
    s_waitcnt lgkmcnt(2)
    v_mfma_f32_16x16x32_bf16 v[208:211], v[32:35], v[76:79], v[208:211]
    ds_read_b128 v[48:51], v3 offset:5120
    v_mfma_f32_16x16x32_bf16 v[212:215], v[32:35], v[148:151], v[212:215]
    ds_read_b128 v[52:55], v3 offset:23552
    v_mfma_f32_16x16x32_bf16 v[216:219], v[36:39], v[76:79], v[216:219]
    s_add_u32 m0, s23, 3840
    s_nop 0
    buffer_load_dwordx4 v2, s[8:11], s24 offen offset:256 lds
    v_mfma_f32_16x16x32_bf16 v[220:223], v[36:39], v[148:151], v[220:223]
    v_mfma_f32_16x16x32_bf16 v[224:227], v[32:35], a[12:15], v[224:227]
    v_mfma_f32_16x16x32_bf16 v[228:231], v[32:35], a[84:87], v[228:231]
    v_mfma_f32_16x16x32_bf16 v[232:235], v[36:39], a[12:15], v[232:235]
    s_add_u32 m0, s23, 4800
    s_nop 0
    buffer_load_dwordx4 v2, s[8:11], s24 offen offset:320 lds
    v_mfma_f32_16x16x32_bf16 v[236:239], v[36:39], a[84:87], v[236:239]
    s_waitcnt lgkmcnt(2)
    v_mfma_f32_16x16x32_bf16 v[208:211], v[40:43], v[80:83], v[208:211]
    ds_read_b128 v[32:35], v3 offset:6144
    v_mfma_f32_16x16x32_bf16 v[212:215], v[40:43], v[152:155], v[212:215]
    ds_read_b128 v[36:39], v3 offset:24576
    v_mfma_f32_16x16x32_bf16 v[216:219], v[44:47], v[80:83], v[216:219]
    s_add_u32 m0, s23, 5760
    s_nop 0
    buffer_load_dwordx4 v2, s[8:11], s24 offen offset:384 lds
    v_mfma_f32_16x16x32_bf16 v[220:223], v[44:47], v[152:155], v[220:223]
    v_mfma_f32_16x16x32_bf16 v[224:227], v[40:43], a[16:19], v[224:227]
    v_mfma_f32_16x16x32_bf16 v[228:231], v[40:43], a[88:91], v[228:231]
    v_mfma_f32_16x16x32_bf16 v[232:235], v[44:47], a[16:19], v[232:235]
    s_add_u32 m0, s23, 6720
    s_nop 0
    buffer_load_dwordx4 v2, s[8:11], s24 offen offset:448 lds
    v_mfma_f32_16x16x32_bf16 v[236:239], v[44:47], a[88:91], v[236:239]
    s_waitcnt lgkmcnt(2)
    v_mfma_f32_16x16x32_bf16 v[208:211], v[48:51], v[84:87], v[208:211]
    ds_read_b128 v[40:43], v3 offset:7168
    v_mfma_f32_16x16x32_bf16 v[212:215], v[48:51], v[156:159], v[212:215]
    ds_read_b128 v[44:47], v3 offset:25600
    v_mfma_f32_16x16x32_bf16 v[216:219], v[52:55], v[84:87], v[216:219]
    s_add_u32 m0, s23, 7680
    s_nop 0
    buffer_load_dwordx4 v2, s[8:11], s24 offen offset:512 lds
    s_add_u32 s24, s24, 147456
    v_mfma_f32_16x16x32_bf16 v[220:223], v[52:55], v[156:159], v[220:223]
    v_mfma_f32_16x16x32_bf16 v[224:227], v[48:51], a[20:23], v[224:227]
    v_mfma_f32_16x16x32_bf16 v[228:231], v[48:51], a[92:95], v[228:231]
    v_mfma_f32_16x16x32_bf16 v[232:235], v[52:55], a[20:23], v[232:235]
    v_mfma_f32_16x16x32_bf16 v[236:239], v[52:55], a[92:95], v[236:239]
    s_waitcnt lgkmcnt(2)
    v_mfma_f32_16x16x32_bf16 v[208:211], v[32:35], v[88:91], v[208:211]
    ds_read_b128 v[48:51], v3 offset:8192
    v_mfma_f32_16x16x32_bf16 v[212:215], v[32:35], v[160:163], v[212:215]
    ds_read_b128 v[52:55], v3 offset:26624
    v_mfma_f32_16x16x32_bf16 v[216:219], v[36:39], v[88:91], v[216:219]
    v_mfma_f32_16x16x32_bf16 v[220:223], v[36:39], v[160:163], v[220:223]
    v_mfma_f32_16x16x32_bf16 v[224:227], v[32:35], a[24:27], v[224:227]
    v_mfma_f32_16x16x32_bf16 v[228:231], v[32:35], a[96:99], v[228:231]
    v_mfma_f32_16x16x32_bf16 v[232:235], v[36:39], a[24:27], v[232:235]
    v_mfma_f32_16x16x32_bf16 v[236:239], v[36:39], a[96:99], v[236:239]
    s_waitcnt lgkmcnt(2)
    v_mfma_f32_16x16x32_bf16 v[208:211], v[40:43], v[92:95], v[208:211]
    ds_read_b128 v[32:35], v3 offset:9216
    v_mfma_f32_16x16x32_bf16 v[212:215], v[40:43], v[164:167], v[212:215]
    ds_read_b128 v[36:39], v3 offset:27648
    v_mfma_f32_16x16x32_bf16 v[216:219], v[44:47], v[92:95], v[216:219]
    s_add_u32 s23, s45, s95
    v_mov_b32 v4, s23
    s_mov_b64 exec, s[34:35]
    buffer_store_dword v4, off, s[4:7], s29 sc1
    buffer_store_dword v4, off, s[4:7], s29 offset:128 sc1
    s_mov_b64 exec, -1
    v_mfma_f32_16x16x32_bf16 v[220:223], v[44:47], v[164:167], v[220:223]
    v_mfma_f32_16x16x32_bf16 v[224:227], v[40:43], a[28:31], v[224:227]
    v_mfma_f32_16x16x32_bf16 v[228:231], v[40:43], a[100:103], v[228:231]
    v_mfma_f32_16x16x32_bf16 v[232:235], v[44:47], a[28:31], v[232:235]
    v_mfma_f32_16x16x32_bf16 v[236:239], v[44:47], a[100:103], v[236:239]
    s_waitcnt lgkmcnt(2)
    v_mfma_f32_16x16x32_bf16 v[208:211], v[48:51], v[96:99], v[208:211]
    ds_read_b128 v[40:43], v3 offset:10240
    v_mfma_f32_16x16x32_bf16 v[212:215], v[48:51], v[168:171], v[212:215]
    ds_read_b128 v[44:47], v3 offset:28672
    v_mfma_f32_16x16x32_bf16 v[216:219], v[52:55], v[96:99], v[216:219]
    s_cmp_lt_u32 s19, 60
    s_cbranch_scc1 lt10
    buffer_load_dwordx4 v[244:247], off, s[84:87], 0 offset:16 sc1
    buffer_load_dword v248, off, s[84:87], 0 offset:4 sc1
lt10:
    v_mfma_f32_16x16x32_bf16 v[220:223], v[52:55], v[168:171], v[220:223]
    v_mfma_f32_16x16x32_bf16 v[224:227], v[48:51], a[32:35], v[224:227]
    v_mfma_f32_16x16x32_bf16 v[228:231], v[48:51], a[104:107], v[228:231]
    v_mfma_f32_16x16x32_bf16 v[232:235], v[52:55], a[32:35], v[232:235]
    v_mfma_f32_16x16x32_bf16 v[236:239], v[52:55], a[104:107], v[236:239]
    s_waitcnt lgkmcnt(2)
    v_mfma_f32_16x16x32_bf16 v[208:211], v[32:35], v[100:103], v[208:211]
    ds_read_b128 v[48:51], v3 offset:11264
    v_mfma_f32_16x16x32_bf16 v[212:215], v[32:35], v[172:175], v[212:215]
    ds_read_b128 v[52:55], v3 offset:29696
    v_mfma_f32_16x16x32_bf16 v[216:219], v[36:39], v[100:103], v[216:219]
    v_mfma_f32_16x16x32_bf16 v[220:223], v[36:39], v[172:175], v[220:223]
    v_mfma_f32_16x16x32_bf16 v[224:227], v[32:35], a[36:39], v[224:227]
    v_mfma_f32_16x16x32_bf16 v[228:231], v[32:35], a[108:111], v[228:231]
    v_mfma_f32_16x16x32_bf16 v[232:235], v[36:39], a[36:39], v[232:235]
    v_mfma_f32_16x16x32_bf16 v[236:239], v[36:39], a[108:111], v[236:239]
    s_waitcnt lgkmcnt(2)
    v_mfma_f32_16x16x32_bf16 v[208:211], v[40:43], v[104:107], v[208:211]
    ds_read_b128 v[32:35], v3 offset:12288
    v_mfma_f32_16x16x32_bf16 v[212:215], v[40:43], v[176:179], v[212:215]
    ds_read_b128 v[36:39], v3 offset:30720
    v_mfma_f32_16x16x32_bf16 v[216:219], v[44:47], v[104:107], v[216:219]
    v_mfma_f32_16x16x32_bf16 v[220:223], v[44:47], v[176:179], v[220:223]
    v_mfma_f32_16x16x32_bf16 v[224:227], v[40:43], a[40:43], v[224:227]
    v_mfma_f32_16x16x32_bf16 v[228:231], v[40:43], a[112:115], v[228:231]
    v_mfma_f32_16x16x32_bf16 v[232:235], v[44:47], a[40:43], v[232:235]
    v_mfma_f32_16x16x32_bf16 v[236:239], v[44:47], a[112:115], v[236:239]
    s_waitcnt lgkmcnt(2)
    v_mfma_f32_16x16x32_bf16 v[208:211], v[48:51], v[108:111], v[208:211]
    ds_read_b128 v[40:43], v3 offset:13312
    v_mfma_f32_16x16x32_bf16 v[212:215], v[48:51], v[180:183], v[212:215]
    ds_read_b128 v[44:47], v3 offset:31744
    v_mfma_f32_16x16x32_bf16 v[216:219], v[52:55], v[108:111], v[216:219]
    v_mfma_f32_16x16x32_bf16 v[220:223], v[52:55], v[180:183], v[220:223]
    v_mfma_f32_16x16x32_bf16 v[224:227], v[48:51], a[44:47], v[224:227]
    v_mfma_f32_16x16x32_bf16 v[228:231], v[48:51], a[116:119], v[228:231]
    v_mfma_f32_16x16x32_bf16 v[232:235], v[52:55], a[44:47], v[232:235]
    v_mfma_f32_16x16x32_bf16 v[236:239], v[52:55], a[116:119], v[236:239]
    s_waitcnt lgkmcnt(2)
    v_mfma_f32_16x16x32_bf16 v[208:211], v[32:35], v[112:115], v[208:211]
    ds_read_b128 v[48:51], v3 offset:14336
    v_mfma_f32_16x16x32_bf16 v[212:215], v[32:35], v[184:187], v[212:215]
    ds_read_b128 v[52:55], v3 offset:32768
    v_mfma_f32_16x16x32_bf16 v[216:219], v[36:39], v[112:115], v[216:219]
    v_mfma_f32_16x16x32_bf16 v[220:223], v[36:39], v[184:187], v[220:223]
    v_mfma_f32_16x16x32_bf16 v[224:227], v[32:35], a[48:51], v[224:227]
    v_mfma_f32_16x16x32_bf16 v[228:231], v[32:35], a[120:123], v[228:231]
    v_mfma_f32_16x16x32_bf16 v[232:235], v[36:39], a[48:51], v[232:235]
    v_mfma_f32_16x16x32_bf16 v[236:239], v[36:39], a[120:123], v[236:239]
    s_waitcnt lgkmcnt(2)
    v_mfma_f32_16x16x32_bf16 v[208:211], v[40:43], v[116:119], v[208:211]
    ds_read_b128 v[32:35], v3 offset:15360
    v_mfma_f32_16x16x32_bf16 v[212:215], v[40:43], v[188:191], v[212:215]
    ds_read_b128 v[36:39], v3 offset:33792
    v_mfma_f32_16x16x32_bf16 v[216:219], v[44:47], v[116:119], v[216:219]
    v_mfma_f32_16x16x32_bf16 v[220:223], v[44:47], v[188:191], v[220:223]
    v_mfma_f32_16x16x32_bf16 v[224:227], v[40:43], a[52:55], v[224:227]
    v_mfma_f32_16x16x32_bf16 v[228:231], v[40:43], a[124:127], v[228:231]
    v_mfma_f32_16x16x32_bf16 v[232:235], v[44:47], a[52:55], v[232:235]
    v_mfma_f32_16x16x32_bf16 v[236:239], v[44:47], a[124:127], v[236:239]
    s_waitcnt lgkmcnt(2)
    v_mfma_f32_16x16x32_bf16 v[208:211], v[48:51], v[120:123], v[208:211]
    ds_read_b128 v[40:43], v3 offset:16384
    v_mfma_f32_16x16x32_bf16 v[212:215], v[48:51], v[192:195], v[212:215]
    ds_read_b128 v[44:47], v3 offset:34816
    v_mfma_f32_16x16x32_bf16 v[216:219], v[52:55], v[120:123], v[216:219]
    v_mfma_f32_16x16x32_bf16 v[220:223], v[52:55], v[192:195], v[220:223]
    v_mfma_f32_16x16x32_bf16 v[224:227], v[48:51], a[56:59], v[224:227]
    v_mfma_f32_16x16x32_bf16 v[228:231], v[48:51], a[128:131], v[228:231]
    v_mfma_f32_16x16x32_bf16 v[232:235], v[52:55], a[56:59], v[232:235]
    v_mfma_f32_16x16x32_bf16 v[236:239], v[52:55], a[128:131], v[236:239]
    s_waitcnt lgkmcnt(2)
    v_mfma_f32_16x16x32_bf16 v[208:211], v[32:35], v[124:127], v[208:211]
    ds_read_b128 v[48:51], v3 offset:17408
    v_mfma_f32_16x16x32_bf16 v[212:215], v[32:35], v[196:199], v[212:215]
    ds_read_b128 v[52:55], v3 offset:35840
    v_mfma_f32_16x16x32_bf16 v[216:219], v[36:39], v[124:127], v[216:219]
    v_mfma_f32_16x16x32_bf16 v[220:223], v[36:39], v[196:199], v[220:223]
    v_mfma_f32_16x16x32_bf16 v[224:227], v[32:35], a[60:63], v[224:227]
    s_add_u32 s27, s27, 36864
    s_cmp_eq_u32 s27, 110592
    s_cselect_b32 s27, 0, s27
    v_add_u32 v3, s27, v1
    v_mfma_f32_16x16x32_bf16 v[228:231], v[32:35], a[132:135], v[228:231]
    v_mfma_f32_16x16x32_bf16 v[232:235], v[36:39], a[60:63], v[232:235]
    v_mfma_f32_16x16x32_bf16 v[236:239], v[36:39], a[132:135], v[236:239]
    s_waitcnt lgkmcnt(2)
    v_mfma_f32_16x16x32_bf16 v[208:211], v[40:43], v[128:131], v[208:211]
    ds_read_b128 v[32:35], v3 offset:0
    v_mfma_f32_16x16x32_bf16 v[212:215], v[40:43], v[200:203], v[212:215]
    ds_read_b128 v[36:39], v3 offset:18432
    v_mfma_f32_16x16x32_bf16 v[216:219], v[44:47], v[128:131], v[216:219]
    v_mfma_f32_16x16x32_bf16 v[220:223], v[44:47], v[200:203], v[220:223]
    v_mfma_f32_16x16x32_bf16 v[224:227], v[40:43], a[64:67], v[224:227]
    v_mfma_f32_16x16x32_bf16 v[228:231], v[40:43], a[136:139], v[228:231]
    v_mfma_f32_16x16x32_bf16 v[232:235], v[44:47], a[64:67], v[232:235]
    v_mfma_f32_16x16x32_bf16 v[236:239], v[44:47], a[136:139], v[236:239]
    s_waitcnt lgkmcnt(2)
    v_mfma_f32_16x16x32_bf16 v[208:211], v[48:51], v[132:135], v[208:211]
    ds_read_b128 v[40:43], v3 offset:1024
    v_mfma_f32_16x16x32_bf16 v[212:215], v[48:51], v[204:207], v[212:215]
    ds_read_b128 v[44:47], v3 offset:19456
    v_mfma_f32_16x16x32_bf16 v[216:219], v[52:55], v[132:135], v[216:219]
    v_mfma_f32_16x16x32_bf16 v[220:223], v[52:55], v[204:207], v[220:223]
    v_mfma_f32_16x16x32_bf16 v[224:227], v[48:51], a[68:71], v[224:227]
    v_mfma_f32_16x16x32_bf16 v[228:231], v[48:51], a[140:143], v[228:231]
    v_mfma_f32_16x16x32_bf16 v[232:235], v[52:55], a[68:71], v[232:235]
    v_mfma_f32_16x16x32_bf16 v[236:239], v[52:55], a[140:143], v[236:239]
    s_add_u32 s26, s26, s41
    s_waitcnt vmcnt(0)
    v_cvt_pk_bf16_f32 v8, v208, v209
    v_cvt_pk_bf16_f32 v9, v210, v211
    v_cvt_pk_bf16_f32 v10, v216, v217
    v_cvt_pk_bf16_f32 v11, v218, v219
    v_cvt_pk_bf16_f32 v12, v212, v213
    v_cvt_pk_bf16_f32 v13, v214, v215
    v_cvt_pk_bf16_f32 v14, v220, v221
    v_cvt_pk_bf16_f32 v15, v222, v223
    v_cvt_pk_bf16_f32 v16, v224, v225
    v_cvt_pk_bf16_f32 v17, v226, v227
    v_cvt_pk_bf16_f32 v18, v232, v233
    v_cvt_pk_bf16_f32 v19, v234, v235
    v_cvt_pk_bf16_f32 v20, v228, v229
    v_cvt_pk_bf16_f32 v21, v230, v231
    v_cvt_pk_bf16_f32 v22, v236, v237
    v_cvt_pk_bf16_f32 v23, v238, v239
    s_mov_b64 s[36:37], -1
    s_add_u32 s28, s26, s12
    buffer_store_dwordx4 v[8:11], v7, s[4:7], s28 offen sc1
    s_add_u32 s28, s26, s13
    buffer_store_dwordx4 v[12:15], v7, s[4:7], s28 offen sc1
    s_add_u32 s28, s26, s14
    buffer_store_dwordx4 v[16:19], v7, s[4:7], s28 offen sc1
    s_add_u32 s28, s26, s15
    buffer_store_dwordx4 v[20:23], v7, s[4:7], s28 offen sc1
    s_lshr_b32 s45, s19, 2
    s_cbranch_scc1 qk_vloop_nf
    s_mov_b32 s45, 1
    s_mov_b64 s[36:37], 0
    s_waitcnt vmcnt(0)
    s_barrier
    s_add_u32 s23, s45, s95
    v_mov_b32 v4, s23
    s_mov_b64 exec, s[34:35]
    buffer_store_dword v4, off, s[4:7], s29 sc1
    buffer_store_dword v4, off, s[4:7], s29 offset:128 sc1
    s_mov_b64 exec, -1
qk_vloop_nf:
    s_add_u32 s19, s19, 4
    s_cmp_lt_u32 s19, s20
    s_cbranch_scc1 qk_vloop
qk_done:
    s_waitcnt vmcnt(0) lgkmcnt(0)
    s_barrier
    s_mov_b32 s45, 16
    s_add_u32 s23, s45, s95
    v_mov_b32 v4, s23
    s_mov_b64 exec, s[34:35]
    buffer_store_dword v4, off, s[4:7], s29 sc1
    buffer_store_dword v4, off, s[4:7], s29 offset:128 sc1
    s_mov_b64 exec, -1
    s_cmp_lt_i32 s33, 0
    s_cbranch_scc1 L_memkv
    v_readfirstlane_b32 s40, v245
    v_readfirstlane_b32 s41, v246
    v_readfirstlane_b32 s42, v247
    v_readfirstlane_b32 s43, v248
    s_cmp_ge_u32 s40, 160
    s_cselect_b32 s43, s43, 0
    s_cmp_ge_u32 s41, 1
    s_cselect_b32 s43, s43, 0
    s_cmp_eq_u32 s42, 1
    s_cselect_b32 s43, s43, 0
    s_cmp_eq_u32 s93, 1000
    s_cselect_b32 s43, s43, 0
    s_mov_b32 s93, 999
    v_mov_b32 v250, s43
    v_mov_b32 v251, 163832
    s_mov_b64 exec, s[34:35]
    ds_write_b32 v251, v250
    s_mov_b64 exec, -1
    s_waitcnt lgkmcnt(0)
    s_barrier
    ds_read_b32 v252, v251
    s_waitcnt lgkmcnt(0)
    v_readfirstlane_b32 s43, v252
    s_barrier
    s_cmp_lg_u32 s43, 192
    s_cbranch_scc1 L_qkv_next
    s_mov_b32 s45, s33
    s_mov_b32 s93, 500
    s_branch L_phase2b
L_memkv:
    v_and_b32 v4, 63, v0
    v_and_b32 v2, 7, v4
    v_lshrrev_b32 v5, 4, v4
    v_lshl_add_u32 v2, v5, 3, v2
    v_lshlrev_b32 v2, 4, v2
    v_bfe_u32 v3, v4, 3, 1
    v_mul_u32_u24 v5, 9216, v3
    v_add_u32 v2, v2, v5
    v_mov_b32 v240, 0x05040100
    v_mov_b32 v241, 0x07060302
    v_lshrrev_b32 v5, 5, v4
    v_and_b32 v1, 0xdff, v7
    s_cmp_eq_u32 s16, 2
    s_cbranch_scc1 mk_isv
    v_mov_b32 v5, v3
    v_or_b32 v1, 128, v7
mk_isv:
    v_lshl_add_u32 v1, v5, 17, v1
    s_mov_b32 s28, 0
    s_mov_b32 s19, 2
    s_mov_b32 s24, 138412032
    s_lshl_b32 s26, s17, 12
    s_mov_b32 s21, 69206016
    s_cmp_eq_u32 s16, 2
    s_cselect_b32 s21, 77594624, s21
    s_add_u32 s26, s26, s21
    s_lshl_b32 s29, s17, 7
    s_lshl_b32 s21, s16, 2
    s_add_u32 s29, s29, s21
    s_add_u32 s29, s29, 125829164
mk_loop:
    s_cmp_lg_u32 s18, 0
    s_cbranch_scc1 mk_go
    s_cmp_le_u32 s19, s28
    s_cbranch_scc1 mk_go
    s_mov_b32 s23, 125853696
    s_mov_b32 s21, 4194304
mk_wait:
    buffer_load_dword v4, off, s[4:7], s23 sc1
    s_sub_u32 s21, s21, 1
    s_cbranch_scc1 mk_go
    s_waitcnt vmcnt(0)
    v_readfirstlane_b32 s28, v4
    s_nop 0
    s_sub_u32 s28, s28, s95
    s_cmp_gt_u32 s28, 64
    s_cselect_b32 s28, 0, s28
    s_cmp_le_u32 s19, s28
    s_cbranch_scc1 mk_go
    s_sleep 4
    s_branch mk_wait
mk_go:
    s_barrier
    s_add_u32 s21, s24, 4096
    s_add_u32 s23, s24, 8192
    buffer_load_dwordx4 v[24:27], v2, s[4:7], s24 offen offset:0 sc1
    buffer_load_dwordx4 v[28:31], v2, s[4:7], s24 offen offset:512 sc1
    buffer_load_dwordx4 v[32:35], v2, s[4:7], s21 offen offset:0 sc1
    buffer_load_dwordx4 v[36:39], v2, s[4:7], s21 offen offset:512 sc1
    buffer_load_dwordx4 v[40:43], v2, s[4:7], s24 offen offset:1024 sc1
    buffer_load_dwordx4 v[44:47], v2, s[4:7], s24 offen offset:1536 sc1
    buffer_load_dwordx4 v[48:51], v2, s[4:7], s21 offen offset:1024 sc1
    buffer_load_dwordx4 v[52:55], v2, s[4:7], s21 offen offset:1536 sc1
    buffer_load_dwordx4 v[56:59], v2, s[4:7], s24 offen offset:2048 sc1
    buffer_load_dwordx4 v[60:63], v2, s[4:7], s24 offen offset:2560 sc1
    buffer_load_dwordx4 v[208:211], v2, s[4:7], s21 offen offset:2048 sc1
    buffer_load_dwordx4 v[212:215], v2, s[4:7], s21 offen offset:2560 sc1
    buffer_load_dwordx4 v[216:219], v2, s[4:7], s24 offen offset:3072 sc1
    buffer_load_dwordx4 v[220:223], v2, s[4:7], s24 offen offset:3584 sc1
    buffer_load_dwordx4 v[224:227], v2, s[4:7], s21 offen offset:3072 sc1
    buffer_load_dwordx4 v[228:231], v2, s[4:7], s21 offen offset:3584 sc1
    buffer_load_dwordx4 v[232:235], v2, s[4:7], s23 offen offset:0 sc1
    buffer_load_dwordx4 v[236:239], v2, s[4:7], s23 offen offset:512 sc1
    s_add_u32 s24, s24, 18432
    s_cmp_eq_u32 s16, 2
    s_cbranch_scc1 mk_v
    s_waitcnt vmcnt(17)
    s_waitcnt vmcnt(16)
    v_mfma_f32_16x16x32_bf16 v[8:11], v[64:67], v[24:27], 0
    v_mfma_f32_16x16x32_bf16 v[12:15], v[136:139], v[24:27], 0
    v_mfma_f32_16x16x32_bf16 v[16:19], a[0:3], v[24:27], 0
    v_mfma_f32_16x16x32_bf16 v[20:23], a[72:75], v[24:27], 0
    s_waitcnt vmcnt(15)
    v_mfma_f32_16x16x32_bf16 v[8:11], v[68:71], v[28:31], v[8:11]
    v_mfma_f32_16x16x32_bf16 v[12:15], v[140:143], v[28:31], v[12:15]
    v_mfma_f32_16x16x32_bf16 v[16:19], a[4:7], v[28:31], v[16:19]
    v_mfma_f32_16x16x32_bf16 v[20:23], a[76:79], v[28:31], v[20:23]
    s_waitcnt vmcnt(14)
    v_mfma_f32_16x16x32_bf16 v[8:11], v[72:75], v[32:35], v[8:11]
    v_mfma_f32_16x16x32_bf16 v[12:15], v[144:147], v[32:35], v[12:15]
    v_mfma_f32_16x16x32_bf16 v[16:19], a[8:11], v[32:35], v[16:19]
    v_mfma_f32_16x16x32_bf16 v[20:23], a[80:83], v[32:35], v[20:23]
    s_waitcnt vmcnt(13)
    v_mfma_f32_16x16x32_bf16 v[8:11], v[76:79], v[36:39], v[8:11]
    v_mfma_f32_16x16x32_bf16 v[12:15], v[148:151], v[36:39], v[12:15]
    v_mfma_f32_16x16x32_bf16 v[16:19], a[12:15], v[36:39], v[16:19]
    v_mfma_f32_16x16x32_bf16 v[20:23], a[84:87], v[36:39], v[20:23]
    s_waitcnt vmcnt(12)
    v_mfma_f32_16x16x32_bf16 v[8:11], v[80:83], v[40:43], v[8:11]
    v_mfma_f32_16x16x32_bf16 v[12:15], v[152:155], v[40:43], v[12:15]
    v_mfma_f32_16x16x32_bf16 v[16:19], a[16:19], v[40:43], v[16:19]
    v_mfma_f32_16x16x32_bf16 v[20:23], a[88:91], v[40:43], v[20:23]
    s_waitcnt vmcnt(11)
    v_mfma_f32_16x16x32_bf16 v[8:11], v[84:87], v[44:47], v[8:11]
    v_mfma_f32_16x16x32_bf16 v[12:15], v[156:159], v[44:47], v[12:15]
    v_mfma_f32_16x16x32_bf16 v[16:19], a[20:23], v[44:47], v[16:19]
    v_mfma_f32_16x16x32_bf16 v[20:23], a[92:95], v[44:47], v[20:23]
    s_waitcnt vmcnt(10)
    v_mfma_f32_16x16x32_bf16 v[8:11], v[88:91], v[48:51], v[8:11]
    v_mfma_f32_16x16x32_bf16 v[12:15], v[160:163], v[48:51], v[12:15]
    v_mfma_f32_16x16x32_bf16 v[16:19], a[24:27], v[48:51], v[16:19]
    v_mfma_f32_16x16x32_bf16 v[20:23], a[96:99], v[48:51], v[20:23]
    s_waitcnt vmcnt(9)
    v_mfma_f32_16x16x32_bf16 v[8:11], v[92:95], v[52:55], v[8:11]
    v_mfma_f32_16x16x32_bf16 v[12:15], v[164:167], v[52:55], v[12:15]
    v_mfma_f32_16x16x32_bf16 v[16:19], a[28:31], v[52:55], v[16:19]
    v_mfma_f32_16x16x32_bf16 v[20:23], a[100:103], v[52:55], v[20:23]
    s_waitcnt vmcnt(8)
    v_mfma_f32_16x16x32_bf16 v[8:11], v[96:99], v[56:59], v[8:11]
    v_mfma_f32_16x16x32_bf16 v[12:15], v[168:171], v[56:59], v[12:15]
    v_mfma_f32_16x16x32_bf16 v[16:19], a[32:35], v[56:59], v[16:19]
    v_mfma_f32_16x16x32_bf16 v[20:23], a[104:107], v[56:59], v[20:23]
    s_waitcnt vmcnt(7)
    v_mfma_f32_16x16x32_bf16 v[8:11], v[100:103], v[60:63], v[8:11]
    v_mfma_f32_16x16x32_bf16 v[12:15], v[172:175], v[60:63], v[12:15]
    v_mfma_f32_16x16x32_bf16 v[16:19], a[36:39], v[60:63], v[16:19]
    v_mfma_f32_16x16x32_bf16 v[20:23], a[108:111], v[60:63], v[20:23]
    s_waitcnt vmcnt(6)
    v_mfma_f32_16x16x32_bf16 v[8:11], v[104:107], v[208:211], v[8:11]
    v_mfma_f32_16x16x32_bf16 v[12:15], v[176:179], v[208:211], v[12:15]
    v_mfma_f32_16x16x32_bf16 v[16:19], a[40:43], v[208:211], v[16:19]
    v_mfma_f32_16x16x32_bf16 v[20:23], a[112:115], v[208:211], v[20:23]
    s_waitcnt vmcnt(5)
    v_mfma_f32_16x16x32_bf16 v[8:11], v[108:111], v[212:215], v[8:11]
    v_mfma_f32_16x16x32_bf16 v[12:15], v[180:183], v[212:215], v[12:15]
    v_mfma_f32_16x16x32_bf16 v[16:19], a[44:47], v[212:215], v[16:19]
    v_mfma_f32_16x16x32_bf16 v[20:23], a[116:119], v[212:215], v[20:23]
    s_waitcnt vmcnt(4)
    v_mfma_f32_16x16x32_bf16 v[8:11], v[112:115], v[216:219], v[8:11]
    v_mfma_f32_16x16x32_bf16 v[12:15], v[184:187], v[216:219], v[12:15]
    v_mfma_f32_16x16x32_bf16 v[16:19], a[48:51], v[216:219], v[16:19]
    v_mfma_f32_16x16x32_bf16 v[20:23], a[120:123], v[216:219], v[20:23]
    s_waitcnt vmcnt(3)
    v_mfma_f32_16x16x32_bf16 v[8:11], v[116:119], v[220:223], v[8:11]
    v_mfma_f32_16x16x32_bf16 v[12:15], v[188:191], v[220:223], v[12:15]
    v_mfma_f32_16x16x32_bf16 v[16:19], a[52:55], v[220:223], v[16:19]
    v_mfma_f32_16x16x32_bf16 v[20:23], a[124:127], v[220:223], v[20:23]
    s_waitcnt vmcnt(2)
    v_mfma_f32_16x16x32_bf16 v[8:11], v[120:123], v[224:227], v[8:11]
    v_mfma_f32_16x16x32_bf16 v[12:15], v[192:195], v[224:227], v[12:15]
    v_mfma_f32_16x16x32_bf16 v[16:19], a[56:59], v[224:227], v[16:19]
    v_mfma_f32_16x16x32_bf16 v[20:23], a[128:131], v[224:227], v[20:23]
    s_waitcnt vmcnt(1)
    v_mfma_f32_16x16x32_bf16 v[8:11], v[124:127], v[228:231], v[8:11]
    v_mfma_f32_16x16x32_bf16 v[12:15], v[196:199], v[228:231], v[12:15]
    v_mfma_f32_16x16x32_bf16 v[16:19], a[60:63], v[228:231], v[16:19]
    v_mfma_f32_16x16x32_bf16 v[20:23], a[132:135], v[228:231], v[20:23]
    s_waitcnt vmcnt(0)
    v_mfma_f32_16x16x32_bf16 v[8:11], v[128:131], v[232:235], v[8:11]
    v_mfma_f32_16x16x32_bf16 v[12:15], v[200:203], v[232:235], v[12:15]
    v_mfma_f32_16x16x32_bf16 v[16:19], a[64:67], v[232:235], v[16:19]
    v_mfma_f32_16x16x32_bf16 v[20:23], a[136:139], v[232:235], v[20:23]
    v_mfma_f32_16x16x32_bf16 v[8:11], v[132:135], v[236:239], v[8:11]
    v_mfma_f32_16x16x32_bf16 v[12:15], v[204:207], v[236:239], v[12:15]
    v_mfma_f32_16x16x32_bf16 v[16:19], a[68:71], v[236:239], v[16:19]
    v_mfma_f32_16x16x32_bf16 v[20:23], a[140:143], v[236:239], v[20:23]
    s_nop 7
    s_branch mk_st
mk_v:
    s_waitcnt vmcnt(17)
    s_waitcnt vmcnt(16)
    v_mfma_f32_16x16x32_bf16 v[8:11], v[24:27], v[64:67], 0
    v_mfma_f32_16x16x32_bf16 v[12:15], v[24:27], v[136:139], 0
    v_mfma_f32_16x16x32_bf16 v[16:19], v[24:27], a[0:3], 0
    v_mfma_f32_16x16x32_bf16 v[20:23], v[24:27], a[72:75], 0
    s_waitcnt vmcnt(15)
    v_mfma_f32_16x16x32_bf16 v[8:11], v[28:31], v[68:71], v[8:11]
    v_mfma_f32_16x16x32_bf16 v[12:15], v[28:31], v[140:143], v[12:15]
    v_mfma_f32_16x16x32_bf16 v[16:19], v[28:31], a[4:7], v[16:19]
    v_mfma_f32_16x16x32_bf16 v[20:23], v[28:31], a[76:79], v[20:23]
    s_waitcnt vmcnt(14)
    v_mfma_f32_16x16x32_bf16 v[8:11], v[32:35], v[72:75], v[8:11]
    v_mfma_f32_16x16x32_bf16 v[12:15], v[32:35], v[144:147], v[12:15]
    v_mfma_f32_16x16x32_bf16 v[16:19], v[32:35], a[8:11], v[16:19]
    v_mfma_f32_16x16x32_bf16 v[20:23], v[32:35], a[80:83], v[20:23]
    s_waitcnt vmcnt(13)
    v_mfma_f32_16x16x32_bf16 v[8:11], v[36:39], v[76:79], v[8:11]
    v_mfma_f32_16x16x32_bf16 v[12:15], v[36:39], v[148:151], v[12:15]
    v_mfma_f32_16x16x32_bf16 v[16:19], v[36:39], a[12:15], v[16:19]
    v_mfma_f32_16x16x32_bf16 v[20:23], v[36:39], a[84:87], v[20:23]
    s_waitcnt vmcnt(12)
    v_mfma_f32_16x16x32_bf16 v[8:11], v[40:43], v[80:83], v[8:11]
    v_mfma_f32_16x16x32_bf16 v[12:15], v[40:43], v[152:155], v[12:15]
    v_mfma_f32_16x16x32_bf16 v[16:19], v[40:43], a[16:19], v[16:19]
    v_mfma_f32_16x16x32_bf16 v[20:23], v[40:43], a[88:91], v[20:23]
    s_waitcnt vmcnt(11)
    v_mfma_f32_16x16x32_bf16 v[8:11], v[44:47], v[84:87], v[8:11]
    v_mfma_f32_16x16x32_bf16 v[12:15], v[44:47], v[156:159], v[12:15]
    v_mfma_f32_16x16x32_bf16 v[16:19], v[44:47], a[20:23], v[16:19]
    v_mfma_f32_16x16x32_bf16 v[20:23], v[44:47], a[92:95], v[20:23]
    s_waitcnt vmcnt(10)
    v_mfma_f32_16x16x32_bf16 v[8:11], v[48:51], v[88:91], v[8:11]
    v_mfma_f32_16x16x32_bf16 v[12:15], v[48:51], v[160:163], v[12:15]
    v_mfma_f32_16x16x32_bf16 v[16:19], v[48:51], a[24:27], v[16:19]
    v_mfma_f32_16x16x32_bf16 v[20:23], v[48:51], a[96:99], v[20:23]
    s_waitcnt vmcnt(9)
    v_mfma_f32_16x16x32_bf16 v[8:11], v[52:55], v[92:95], v[8:11]
    v_mfma_f32_16x16x32_bf16 v[12:15], v[52:55], v[164:167], v[12:15]
    v_mfma_f32_16x16x32_bf16 v[16:19], v[52:55], a[28:31], v[16:19]
    v_mfma_f32_16x16x32_bf16 v[20:23], v[52:55], a[100:103], v[20:23]
    s_waitcnt vmcnt(8)
    v_mfma_f32_16x16x32_bf16 v[8:11], v[56:59], v[96:99], v[8:11]
    v_mfma_f32_16x16x32_bf16 v[12:15], v[56:59], v[168:171], v[12:15]
    v_mfma_f32_16x16x32_bf16 v[16:19], v[56:59], a[32:35], v[16:19]
    v_mfma_f32_16x16x32_bf16 v[20:23], v[56:59], a[104:107], v[20:23]
    s_waitcnt vmcnt(7)
    v_mfma_f32_16x16x32_bf16 v[8:11], v[60:63], v[100:103], v[8:11]
    v_mfma_f32_16x16x32_bf16 v[12:15], v[60:63], v[172:175], v[12:15]
    v_mfma_f32_16x16x32_bf16 v[16:19], v[60:63], a[36:39], v[16:19]
    v_mfma_f32_16x16x32_bf16 v[20:23], v[60:63], a[108:111], v[20:23]
    s_waitcnt vmcnt(6)
    v_mfma_f32_16x16x32_bf16 v[8:11], v[208:211], v[104:107], v[8:11]
    v_mfma_f32_16x16x32_bf16 v[12:15], v[208:211], v[176:179], v[12:15]
    v_mfma_f32_16x16x32_bf16 v[16:19], v[208:211], a[40:43], v[16:19]
    v_mfma_f32_16x16x32_bf16 v[20:23], v[208:211], a[112:115], v[20:23]
    s_waitcnt vmcnt(5)
    v_mfma_f32_16x16x32_bf16 v[8:11], v[212:215], v[108:111], v[8:11]
    v_mfma_f32_16x16x32_bf16 v[12:15], v[212:215], v[180:183], v[12:15]
    v_mfma_f32_16x16x32_bf16 v[16:19], v[212:215], a[44:47], v[16:19]
    v_mfma_f32_16x16x32_bf16 v[20:23], v[212:215], a[116:119], v[20:23]
    s_waitcnt vmcnt(4)
    v_mfma_f32_16x16x32_bf16 v[8:11], v[216:219], v[112:115], v[8:11]
    v_mfma_f32_16x16x32_bf16 v[12:15], v[216:219], v[184:187], v[12:15]
    v_mfma_f32_16x16x32_bf16 v[16:19], v[216:219], a[48:51], v[16:19]
    v_mfma_f32_16x16x32_bf16 v[20:23], v[216:219], a[120:123], v[20:23]
    s_waitcnt vmcnt(3)
    v_mfma_f32_16x16x32_bf16 v[8:11], v[220:223], v[116:119], v[8:11]
    v_mfma_f32_16x16x32_bf16 v[12:15], v[220:223], v[188:191], v[12:15]
    v_mfma_f32_16x16x32_bf16 v[16:19], v[220:223], a[52:55], v[16:19]
    v_mfma_f32_16x16x32_bf16 v[20:23], v[220:223], a[124:127], v[20:23]
    s_waitcnt vmcnt(2)
    v_mfma_f32_16x16x32_bf16 v[8:11], v[224:227], v[120:123], v[8:11]
    v_mfma_f32_16x16x32_bf16 v[12:15], v[224:227], v[192:195], v[12:15]
    v_mfma_f32_16x16x32_bf16 v[16:19], v[224:227], a[56:59], v[16:19]
    v_mfma_f32_16x16x32_bf16 v[20:23], v[224:227], a[128:131], v[20:23]
    s_waitcnt vmcnt(1)
    v_mfma_f32_16x16x32_bf16 v[8:11], v[228:231], v[124:127], v[8:11]
    v_mfma_f32_16x16x32_bf16 v[12:15], v[228:231], v[196:199], v[12:15]
    v_mfma_f32_16x16x32_bf16 v[16:19], v[228:231], a[60:63], v[16:19]
    v_mfma_f32_16x16x32_bf16 v[20:23], v[228:231], a[132:135], v[20:23]
    s_waitcnt vmcnt(0)
    v_mfma_f32_16x16x32_bf16 v[8:11], v[232:235], v[128:131], v[8:11]
    v_mfma_f32_16x16x32_bf16 v[12:15], v[232:235], v[200:203], v[12:15]
    v_mfma_f32_16x16x32_bf16 v[16:19], v[232:235], a[64:67], v[16:19]
    v_mfma_f32_16x16x32_bf16 v[20:23], v[232:235], a[136:139], v[20:23]
    v_mfma_f32_16x16x32_bf16 v[8:11], v[236:239], v[132:135], v[8:11]
    v_mfma_f32_16x16x32_bf16 v[12:15], v[236:239], v[204:207], v[12:15]
    v_mfma_f32_16x16x32_bf16 v[16:19], v[236:239], a[68:71], v[16:19]
    v_mfma_f32_16x16x32_bf16 v[20:23], v[236:239], a[140:143], v[20:23]
    s_nop 4
    v_pk_mul_f32 v[8:9], v[8:9], 0.5 op_sel_hi:[1,0]
    v_pk_mul_f32 v[10:11], v[10:11], 0.5 op_sel_hi:[1,0]
    v_pk_mul_f32 v[12:13], v[12:13], 0.5 op_sel_hi:[1,0]
    v_pk_mul_f32 v[14:15], v[14:15], 0.5 op_sel_hi:[1,0]
    v_pk_mul_f32 v[16:17], v[16:17], 0.5 op_sel_hi:[1,0]
    v_pk_mul_f32 v[18:19], v[18:19], 0.5 op_sel_hi:[1,0]
    v_pk_mul_f32 v[20:21], v[20:21], 0.5 op_sel_hi:[1,0]
    v_pk_mul_f32 v[22:23], v[22:23], 0.5 op_sel_hi:[1,0]
mk_st:
    s_nop 1
    v_cvt_pk_bf16_f32 v24, v8, v9
    v_cvt_pk_bf16_f32 v25, v10, v11
    v_cvt_pk_bf16_f32 v26, v12, v13
    v_cvt_pk_bf16_f32 v27, v14, v15
    v_cvt_pk_bf16_f32 v28, v16, v17
    v_cvt_pk_bf16_f32 v29, v18, v19
    v_cvt_pk_bf16_f32 v30, v20, v21
    v_cvt_pk_bf16_f32 v31, v22, v23
    s_add_u32 s21, s26, 4096
    buffer_store_dwordx4 v[24:27], v1, s[4:7], s26 offen sc1
    buffer_store_dwordx4 v[28:31], v1, s[4:7], s21 offen sc1
    s_add_u32 s22, s19, s95
    s_waitcnt vmcnt(0)
    s_barrier
    v_mov_b32 v4, s22
    s_mov_b64 exec, s[34:35]
    buffer_store_dword v4, off, s[4:7], s29 sc1
    buffer_store_dword v4, off, s[4:7], s29 offset:128 sc1
    s_mov_b64 exec, -1
    s_add_u32 s19, s19, 2
    s_add_u32 s26, s26, 262144
    s_cmp_le_u32 s19, 56
    s_cbranch_scc1 mk_loop
    s_mov_b32 s45, 2
    s_mov_b32 s8, s76
    s_mov_b32 s9, s77
    s_mov_b32 s10, 4718592
    s_mov_b32 s11, 0x20000
    s_branch L_att_next
L_ssm_next:
    s_sub_u32 s93, s93, 1
    s_cbranch_scc1 L_exit
    s_mov_b32 s37, 8
    v_mov_b32 v250, 1
    v_mov_b32 v251, 163832
    v_cmp_eq_u32 vcc, 0, v0
    s_nop 0
    s_and_saveexec_b64 s[38:39], vcc
    s_cbranch_execz tk11
    buffer_atomic_add v250, off, s[84:87], s37 sc0
    s_waitcnt vmcnt(0)
    ds_write_b32 v251, v250
    s_waitcnt lgkmcnt(0)
tk11:
    s_mov_b64 exec, -1
    s_barrier
    ds_read_b32 v252, v251
    s_waitcnt lgkmcnt(0)
    v_readfirstlane_b32 s20, v252
    s_barrier
    s_nop 3
    s_cmp_ge_u32 s20, 72
    s_cbranch_scc1 L_ssm_done
    s_lshl_b32 s20, s20, 3
    v_lshrrev_b32 v5, 6, v0
    s_nop 0
    v_readfirstlane_b32 s21, v5
    v_and_b32 v1, 63, v0
    v_and_b32 v2, 15, v1
    v_lshrrev_b32 v3, 4, v1
    v_lshlrev_b32 v4, 14, v5
    s_mov_b32 s8, s62
    s_mov_b32 s9, s63
    s_mov_b32 s10, 2359296
    s_mov_b32 s11, 0x20000
    s_mov_b32 s16, s76
    s_mov_b32 s17, s77
    s_mov_b32 s18, 4718592
    s_mov_b32 s19, 0x20000
    s_add_u32 s22, s20, s21
    s_lshl_b32 s23, s22, 8
    v_lshlrev_b32 v6, 3, v2
    v_lshl_add_u32 v6, v3, 1, v6
    s_mov_b32 s12, s64
    s_mov_b32 s13, s65
    s_mov_b32 s14, 147456
    s_mov_b32 s15, 0x20000
    buffer_load_ushort v8, v6, s[12:15], s23 offen offset:0
    buffer_load_ushort v12, v6, s[12:15], s23 offen offset:128
    buffer_load_ushort v16, v6, s[12:15], s23 offen offset:1024
    buffer_load_ushort v20, v6, s[12:15], s23 offen offset:1152
    s_mov_b32 s12, s66
    s_mov_b32 s13, s67
    s_mov_b32 s14, 147456
    s_mov_b32 s15, 0x20000
    buffer_load_ushort v9, v6, s[12:15], s23 offen offset:0
    buffer_load_ushort v13, v6, s[12:15], s23 offen offset:128
    buffer_load_ushort v17, v6, s[12:15], s23 offen offset:1024
    buffer_load_ushort v21, v6, s[12:15], s23 offen offset:1152
    s_mov_b32 s12, s68
    s_mov_b32 s13, s69
    s_mov_b32 s14, 147456
    s_mov_b32 s15, 0x20000
    buffer_load_ushort v10, v6, s[12:15], s23 offen offset:0
    buffer_load_ushort v14, v6, s[12:15], s23 offen offset:128
    buffer_load_ushort v18, v6, s[12:15], s23 offen offset:1024
    buffer_load_ushort v22, v6, s[12:15], s23 offen offset:1152
    s_mov_b32 s12, s70
    s_mov_b32 s13, s71
    s_mov_b32 s14, 147456
    s_mov_b32 s15, 0x20000
    buffer_load_ushort v11, v6, s[12:15], s23 offen offset:0
    buffer_load_ushort v15, v6, s[12:15], s23 offen offset:128
    buffer_load_ushort v19, v6, s[12:15], s23 offen offset:1024
    buffer_load_ushort v23, v6, s[12:15], s23 offen offset:1152
    s_mov_b32 s12, s72
    s_mov_b32 s13, s73
    s_mov_b32 s14, 1152
    s_mov_b32 s15, 0x20000
    s_lshl_b32 s23, s22, 1
    buffer_load_ushort v24, off, s[12:15], s23
    buffer_load_ushort v25, off, s[12:15], s23 offset:8
    v_mul_u32_u24 v5, 9216, v0
    s_lshl_b32 s22, s20, 1
    s_add_u32 s23, s22, 0
    buffer_load_dwordx4 v[208:211], v5, s[8:11], s23 offen
    s_add_u32 s23, s22, 1152
    buffer_load_dwordx4 v[212:215], v5, s[8:11], s23 offen
    s_add_u32 s23, s22, 2304
    buffer_load_dwordx4 v[216:219], v5, s[8:11], s23 offen
    s_add_u32 s23, s22, 3456
    buffer_load_dwordx4 v[220:223], v5, s[8:11], s23 offen
    s_add_u32 s23, s22, 4608
    buffer_load_dwordx4 v[224:227], v5, s[8:11], s23 offen
    s_add_u32 s23, s22, 5760
    buffer_load_dwordx4 v[228:231], v5, s[8:11], s23 offen
    s_add_u32 s23, s22, 6912
    buffer_load_dwordx4 v[232:235], v5, s[8:11], s23 offen
    s_add_u32 s23, s22, 8064
    buffer_load_dwordx4 v[236:239], v5, s[8:11], s23 offen
    s_mov_b32 s26, 0x3fb8aa3b
    s_mov_b32 s27, 0x3e22f983
    s_mov_b32 s28, 0
    v_cvt_f32_u32 v26, v2
    v_mul_f32 v27, 0x41800000, v26
    s_waitcnt vmcnt(8)
    s_nop 0
ss_pass:
    v_mov_b32 v36, 0
    v_mov_b32 v37, 0
    v_lshl_add_u32 v6, v1, 3, v4
    ds_write_b64 v6, v[36:37] offset:0
    v_lshlrev_b32 v38, 16, v24
    v_mul_f32 v38, s26, v38
    v_exp_f32 v38, v38
    s_nop 0
    v_cvt_pk_bf16_f32 v38, v38, v38
    v_and_b32 v38, 0xffff0000, v38
    v_add_f32 v39, v38, v38
    v_lshlrev_b32 v28, 16, v8
    v_mul_f32 v28, s26, v28
    v_exp_f32 v28, v28
    s_nop 0
    v_cvt_pk_bf16_f32 v28, v28, v28
    v_and_b32 v28, 0xffff0000, v28
    v_mul_f32 v28, v28, v38
    v_mul_f32 v28, s26, v28
    v_sub_f32 v28, 0, v28
    v_lshlrev_b32 v29, 16, v9
    v_mul_f32 v29, v29, v38
    v_mul_f32 v29, s27, v29
    v_lshlrev_b32 v30, 16, v10
    v_mul_f32 v30, v30, v39
    v_lshlrev_b32 v31, 16, v11
    v_mul_f32 v31, v31, v39
    v_lshlrev_b32 v32, 16, v12
    v_mul_f32 v32, s26, v32
    v_exp_f32 v32, v32
    s_nop 0
    v_cvt_pk_bf16_f32 v32, v32, v32
    v_and_b32 v32, 0xffff0000, v32
    v_mul_f32 v32, v32, v38
    v_mul_f32 v32, s26, v32
    v_sub_f32 v32, 0, v32
    v_lshlrev_b32 v33, 16, v13
    v_mul_f32 v33, v33, v38
    v_mul_f32 v33, s27, v33
    v_lshlrev_b32 v34, 16, v14
    v_mul_f32 v34, v34, v39
    v_lshlrev_b32 v35, 16, v15
    v_mul_f32 v35, v35, v39
    v_mov_b64 v[48:49], 0
    v_mov_b64 v[50:51], 0
    v_mov_b64 v[52:53], 0
    v_mov_b64 v[54:55], 0
    v_mov_b64 v[56:57], 0
    v_mov_b64 v[58:59], 0
    v_mov_b64 v[60:61], 0
    v_mov_b64 v[62:63], 0
    s_mov_b32 s25, 0
    s_nop 0
ss_kg:
    v_mov_b64_dpp v[64:65], v[28:29] row_newbcast:0 row_mask:0xf bank_mask:0xf
    v_mov_b64_dpp v[66:67], v[30:31] row_newbcast:0 row_mask:0xf bank_mask:0xf
    v_pk_mul_f32 v[94:95], v[64:65], v[26:27] op_sel_hi:[1,0]
    v_pk_mul_f32 v[96:97], v[64:65], v[26:27] op_sel:[0,1] op_sel_hi:[1,1]
    v_fract_f32 v95, v95
    v_fract_f32 v97, v97
    v_exp_f32 v94, v94
    v_exp_f32 v96, v96
    v_cos_f32 v68, v95
    v_sin_f32 v69, v95
    v_cos_f32 v76, v97
    v_sin_f32 v77, v97
    v_pk_mul_f32 v[68:69], v[68:69], v[94:95] op_sel_hi:[1,0]
    v_pk_mul_f32 v[76:77], v[76:77], v[96:97] op_sel_hi:[1,0]
    v_pk_mul_f32 v[92:93], v[76:77], v[76:77] op_sel:[1,1] op_sel_hi:[0,1]
    v_pk_fma_f32 v[78:79], v[76:77], v[76:77], v[92:93] op_sel:[0,0,0] op_sel_hi:[0,1,1] neg_lo:[0,0,1]
    v_pk_mul_f32 v[94:95], v[68:69], v[68:69] op_sel:[1,1] op_sel_hi:[0,1]
    v_pk_fma_f32 v[70:71], v[68:69], v[68:69], v[94:95] op_sel:[0,0,0] op_sel_hi:[0,1,1] neg_lo:[0,0,1]
    v_pk_mul_f32 v[92:93], v[78:79], v[78:79] op_sel:[1,1] op_sel_hi:[0,1]
    v_pk_fma_f32 v[80:81], v[78:79], v[78:79], v[92:93] op_sel:[0,0,0] op_sel_hi:[0,1,1] neg_lo:[0,0,1]
    v_pk_mul_f32 v[94:95], v[70:71], v[70:71] op_sel:[1,1] op_sel_hi:[0,1]
    v_pk_fma_f32 v[72:73], v[70:71], v[70:71], v[94:95] op_sel:[0,0,0] op_sel_hi:[0,1,1] neg_lo:[0,0,1]
    v_pk_mul_f32 v[92:93], v[80:81], v[80:81] op_sel:[1,1] op_sel_hi:[0,1]
    v_pk_fma_f32 v[82:83], v[80:81], v[80:81], v[92:93] op_sel:[0,0,0] op_sel_hi:[0,1,1] neg_lo:[0,0,1]
    v_pk_mul_f32 v[94:95], v[72:73], v[72:73] op_sel:[1,1] op_sel_hi:[0,1]
    v_pk_fma_f32 v[74:75], v[72:73], v[72:73], v[94:95] op_sel:[0,0,0] op_sel_hi:[0,1,1] neg_lo:[0,0,1]
    v_pk_mul_f32 v[92:93], v[82:83], v[82:83] op_sel:[1,1] op_sel_hi:[0,1]
    v_pk_fma_f32 v[84:85], v[82:83], v[82:83], v[92:93] op_sel:[0,0,0] op_sel_hi:[0,1,1] neg_lo:[0,0,1]
    v_pk_mul_f32 v[94:95], v[66:67], v[76:77] op_sel:[1,1] op_sel_hi:[1,0]
    v_pk_fma_f32 v[86:87], v[66:67], v[76:77], v[94:95] op_sel:[0,0,0] op_sel_hi:[0,1,1] neg_lo:[0,0,1] neg_hi:[1,0,1]
    v_mov_b32_dpp v80, v78 row_ror:8 row_mask:0xf bank_mask:0x3
    v_mov_b32_dpp v81, v79 row_ror:8 row_mask:0xf bank_mask:0x3
    v_mov_b32_dpp v82, v84 row_ror:8 row_mask:0xf bank_mask:0x3
    v_mov_b32_dpp v83, v85 row_ror:8 row_mask:0xf bank_mask:0x3
    v_pk_mul_f32 v[92:93], v[66:67], v[80:81] op_sel:[1,1] op_sel_hi:[1,0]
    v_pk_fma_f32 v[88:89], v[66:67], v[80:81], v[92:93] op_sel:[0,0,0] op_sel_hi:[0,1,1] neg_lo:[0,0,1] neg_hi:[1,0,1]
    v_pk_mul_f32 v[94:95], v[66:67], v[82:83] op_sel:[1,1] op_sel_hi:[1,0]
    v_pk_fma_f32 v[90:91], v[66:67], v[82:83], v[94:95] op_sel:[0,0,0] op_sel_hi:[0,1,1] neg_lo:[0,0,1] neg_hi:[1,0,1]
    v_mfma_f32_16x16x4_f32 v[48:51], v86, v68, v[48:51]
    v_mfma_f32_16x16x4_f32 v[52:55], v88, v70, v[52:55]
    v_mfma_f32_16x16x4_f32 v[56:59], v88, v72, v[56:59]
    v_mfma_f32_16x16x4_f32 v[60:63], v90, v74, v[60:63]
    v_mfma_f32_16x16x4_f32 v[48:51], v87, v69, v[48:51]
    v_mfma_f32_16x16x4_f32 v[52:55], v89, v71, v[52:55]
    v_mfma_f32_16x16x4_f32 v[56:59], v89, v73, v[56:59]
    v_mfma_f32_16x16x4_f32 v[60:63], v91, v75, v[60:63]
    v_mov_b64_dpp v[64:65], v[28:29] row_newbcast:1 row_mask:0xf bank_mask:0xf
    v_mov_b64_dpp v[66:67], v[30:31] row_newbcast:1 row_mask:0xf bank_mask:0xf
    v_pk_mul_f32 v[94:95], v[64:65], v[26:27] op_sel_hi:[1,0]
    v_pk_mul_f32 v[96:97], v[64:65], v[26:27] op_sel:[0,1] op_sel_hi:[1,1]
    v_fract_f32 v95, v95
    v_fract_f32 v97, v97
    v_exp_f32 v94, v94
    v_exp_f32 v96, v96
    v_cos_f32 v68, v95
    v_sin_f32 v69, v95
    v_cos_f32 v76, v97
    v_sin_f32 v77, v97
    v_pk_mul_f32 v[68:69], v[68:69], v[94:95] op_sel_hi:[1,0]
    v_pk_mul_f32 v[76:77], v[76:77], v[96:97] op_sel_hi:[1,0]
    v_pk_mul_f32 v[92:93], v[76:77], v[76:77] op_sel:[1,1] op_sel_hi:[0,1]
    v_pk_fma_f32 v[78:79], v[76:77], v[76:77], v[92:93] op_sel:[0,0,0] op_sel_hi:[0,1,1] neg_lo:[0,0,1]
    v_pk_mul_f32 v[94:95], v[68:69], v[68:69] op_sel:[1,1] op_sel_hi:[0,1]
    v_pk_fma_f32 v[70:71], v[68:69], v[68:69], v[94:95] op_sel:[0,0,0] op_sel_hi:[0,1,1] neg_lo:[0,0,1]
    v_pk_mul_f32 v[92:93], v[78:79], v[78:79] op_sel:[1,1] op_sel_hi:[0,1]
    v_pk_fma_f32 v[80:81], v[78:79], v[78:79], v[92:93] op_sel:[0,0,0] op_sel_hi:[0,1,1] neg_lo:[0,0,1]
    v_pk_mul_f32 v[94:95], v[70:71], v[70:71] op_sel:[1,1] op_sel_hi:[0,1]
    v_pk_fma_f32 v[72:73], v[70:71], v[70:71], v[94:95] op_sel:[0,0,0] op_sel_hi:[0,1,1] neg_lo:[0,0,1]
    v_pk_mul_f32 v[92:93], v[80:81], v[80:81] op_sel:[1,1] op_sel_hi:[0,1]
    v_pk_fma_f32 v[82:83], v[80:81], v[80:81], v[92:93] op_sel:[0,0,0] op_sel_hi:[0,1,1] neg_lo:[0,0,1]
    v_pk_mul_f32 v[94:95], v[72:73], v[72:73] op_sel:[1,1] op_sel_hi:[0,1]
    v_pk_fma_f32 v[74:75], v[72:73], v[72:73], v[94:95] op_sel:[0,0,0] op_sel_hi:[0,1,1] neg_lo:[0,0,1]
    v_pk_mul_f32 v[92:93], v[82:83], v[82:83] op_sel:[1,1] op_sel_hi:[0,1]
    v_pk_fma_f32 v[84:85], v[82:83], v[82:83], v[92:93] op_sel:[0,0,0] op_sel_hi:[0,1,1] neg_lo:[0,0,1]
    v_pk_mul_f32 v[94:95], v[66:67], v[76:77] op_sel:[1,1] op_sel_hi:[1,0]
    v_pk_fma_f32 v[86:87], v[66:67], v[76:77], v[94:95] op_sel:[0,0,0] op_sel_hi:[0,1,1] neg_lo:[0,0,1] neg_hi:[1,0,1]
    v_mov_b32_dpp v80, v78 row_ror:8 row_mask:0xf bank_mask:0x3
    v_mov_b32_dpp v81, v79 row_ror:8 row_mask:0xf bank_mask:0x3
    v_mov_b32_dpp v82, v84 row_ror:8 row_mask:0xf bank_mask:0x3
    v_mov_b32_dpp v83, v85 row_ror:8 row_mask:0xf bank_mask:0x3
    v_pk_mul_f32 v[92:93], v[66:67], v[80:81] op_sel:[1,1] op_sel_hi:[1,0]
    v_pk_fma_f32 v[88:89], v[66:67], v[80:81], v[92:93] op_sel:[0,0,0] op_sel_hi:[0,1,1] neg_lo:[0,0,1] neg_hi:[1,0,1]
    v_pk_mul_f32 v[94:95], v[66:67], v[82:83] op_sel:[1,1] op_sel_hi:[1,0]
    v_pk_fma_f32 v[90:91], v[66:67], v[82:83], v[94:95] op_sel:[0,0,0] op_sel_hi:[0,1,1] neg_lo:[0,0,1] neg_hi:[1,0,1]
    v_mfma_f32_16x16x4_f32 v[48:51], v86, v68, v[48:51]
    v_mfma_f32_16x16x4_f32 v[52:55], v88, v70, v[52:55]
    v_mfma_f32_16x16x4_f32 v[56:59], v88, v72, v[56:59]
    v_mfma_f32_16x16x4_f32 v[60:63], v90, v74, v[60:63]
    v_mfma_f32_16x16x4_f32 v[48:51], v87, v69, v[48:51]
    v_mfma_f32_16x16x4_f32 v[52:55], v89, v71, v[52:55]
    v_mfma_f32_16x16x4_f32 v[56:59], v89, v73, v[56:59]
    v_mfma_f32_16x16x4_f32 v[60:63], v91, v75, v[60:63]
    v_mov_b64_dpp v[64:65], v[28:29] row_newbcast:2 row_mask:0xf bank_mask:0xf
    v_mov_b64_dpp v[66:67], v[30:31] row_newbcast:2 row_mask:0xf bank_mask:0xf
    v_pk_mul_f32 v[94:95], v[64:65], v[26:27] op_sel_hi:[1,0]
    v_pk_mul_f32 v[96:97], v[64:65], v[26:27] op_sel:[0,1] op_sel_hi:[1,1]
    v_fract_f32 v95, v95
    v_fract_f32 v97, v97
    v_exp_f32 v94, v94
    v_exp_f32 v96, v96
    v_cos_f32 v68, v95
    v_sin_f32 v69, v95
    v_cos_f32 v76, v97
    v_sin_f32 v77, v97
    v_pk_mul_f32 v[68:69], v[68:69], v[94:95] op_sel_hi:[1,0]
    v_pk_mul_f32 v[76:77], v[76:77], v[96:97] op_sel_hi:[1,0]
    v_pk_mul_f32 v[92:93], v[76:77], v[76:77] op_sel:[1,1] op_sel_hi:[0,1]
    v_pk_fma_f32 v[78:79], v[76:77], v[76:77], v[92:93] op_sel:[0,0,0] op_sel_hi:[0,1,1] neg_lo:[0,0,1]
    v_pk_mul_f32 v[94:95], v[68:69], v[68:69] op_sel:[1,1] op_sel_hi:[0,1]
    v_pk_fma_f32 v[70:71], v[68:69], v[68:69], v[94:95] op_sel:[0,0,0] op_sel_hi:[0,1,1] neg_lo:[0,0,1]
    v_pk_mul_f32 v[92:93], v[78:79], v[78:79] op_sel:[1,1] op_sel_hi:[0,1]
    v_pk_fma_f32 v[80:81], v[78:79], v[78:79], v[92:93] op_sel:[0,0,0] op_sel_hi:[0,1,1] neg_lo:[0,0,1]
    v_pk_mul_f32 v[94:95], v[70:71], v[70:71] op_sel:[1,1] op_sel_hi:[0,1]
    v_pk_fma_f32 v[72:73], v[70:71], v[70:71], v[94:95] op_sel:[0,0,0] op_sel_hi:[0,1,1] neg_lo:[0,0,1]
    v_pk_mul_f32 v[92:93], v[80:81], v[80:81] op_sel:[1,1] op_sel_hi:[0,1]
    v_pk_fma_f32 v[82:83], v[80:81], v[80:81], v[92:93] op_sel:[0,0,0] op_sel_hi:[0,1,1] neg_lo:[0,0,1]
    v_pk_mul_f32 v[94:95], v[72:73], v[72:73] op_sel:[1,1] op_sel_hi:[0,1]
    v_pk_fma_f32 v[74:75], v[72:73], v[72:73], v[94:95] op_sel:[0,0,0] op_sel_hi:[0,1,1] neg_lo:[0,0,1]
    v_pk_mul_f32 v[92:93], v[82:83], v[82:83] op_sel:[1,1] op_sel_hi:[0,1]
    v_pk_fma_f32 v[84:85], v[82:83], v[82:83], v[92:93] op_sel:[0,0,0] op_sel_hi:[0,1,1] neg_lo:[0,0,1]
    v_pk_mul_f32 v[94:95], v[66:67], v[76:77] op_sel:[1,1] op_sel_hi:[1,0]
    v_pk_fma_f32 v[86:87], v[66:67], v[76:77], v[94:95] op_sel:[0,0,0] op_sel_hi:[0,1,1] neg_lo:[0,0,1] neg_hi:[1,0,1]
    v_mov_b32_dpp v80, v78 row_ror:8 row_mask:0xf bank_mask:0x3
    v_mov_b32_dpp v81, v79 row_ror:8 row_mask:0xf bank_mask:0x3
    v_mov_b32_dpp v82, v84 row_ror:8 row_mask:0xf bank_mask:0x3
    v_mov_b32_dpp v83, v85 row_ror:8 row_mask:0xf bank_mask:0x3
    v_pk_mul_f32 v[92:93], v[66:67], v[80:81] op_sel:[1,1] op_sel_hi:[1,0]
    v_pk_fma_f32 v[88:89], v[66:67], v[80:81], v[92:93] op_sel:[0,0,0] op_sel_hi:[0,1,1] neg_lo:[0,0,1] neg_hi:[1,0,1]
    v_pk_mul_f32 v[94:95], v[66:67], v[82:83] op_sel:[1,1] op_sel_hi:[1,0]
    v_pk_fma_f32 v[90:91], v[66:67], v[82:83], v[94:95] op_sel:[0,0,0] op_sel_hi:[0,1,1] neg_lo:[0,0,1] neg_hi:[1,0,1]
    v_mfma_f32_16x16x4_f32 v[48:51], v86, v68, v[48:51]
    v_mfma_f32_16x16x4_f32 v[52:55], v88, v70, v[52:55]
    v_mfma_f32_16x16x4_f32 v[56:59], v88, v72, v[56:59]
    v_mfma_f32_16x16x4_f32 v[60:63], v90, v74, v[60:63]
    v_mfma_f32_16x16x4_f32 v[48:51], v87, v69, v[48:51]
    v_mfma_f32_16x16x4_f32 v[52:55], v89, v71, v[52:55]
    v_mfma_f32_16x16x4_f32 v[56:59], v89, v73, v[56:59]
    v_mfma_f32_16x16x4_f32 v[60:63], v91, v75, v[60:63]
    v_mov_b64_dpp v[64:65], v[28:29] row_newbcast:3 row_mask:0xf bank_mask:0xf
    v_mov_b64_dpp v[66:67], v[30:31] row_newbcast:3 row_mask:0xf bank_mask:0xf
    v_pk_mul_f32 v[94:95], v[64:65], v[26:27] op_sel_hi:[1,0]
    v_pk_mul_f32 v[96:97], v[64:65], v[26:27] op_sel:[0,1] op_sel_hi:[1,1]
    v_fract_f32 v95, v95
    v_fract_f32 v97, v97
    v_exp_f32 v94, v94
    v_exp_f32 v96, v96
    v_cos_f32 v68, v95
    v_sin_f32 v69, v95
    v_cos_f32 v76, v97
    v_sin_f32 v77, v97
    v_pk_mul_f32 v[68:69], v[68:69], v[94:95] op_sel_hi:[1,0]
    v_pk_mul_f32 v[76:77], v[76:77], v[96:97] op_sel_hi:[1,0]
    v_pk_mul_f32 v[92:93], v[76:77], v[76:77] op_sel:[1,1] op_sel_hi:[0,1]
    v_pk_fma_f32 v[78:79], v[76:77], v[76:77], v[92:93] op_sel:[0,0,0] op_sel_hi:[0,1,1] neg_lo:[0,0,1]
    v_pk_mul_f32 v[94:95], v[68:69], v[68:69] op_sel:[1,1] op_sel_hi:[0,1]
    v_pk_fma_f32 v[70:71], v[68:69], v[68:69], v[94:95] op_sel:[0,0,0] op_sel_hi:[0,1,1] neg_lo:[0,0,1]
    v_pk_mul_f32 v[92:93], v[78:79], v[78:79] op_sel:[1,1] op_sel_hi:[0,1]
    v_pk_fma_f32 v[80:81], v[78:79], v[78:79], v[92:93] op_sel:[0,0,0] op_sel_hi:[0,1,1] neg_lo:[0,0,1]
    v_pk_mul_f32 v[94:95], v[70:71], v[70:71] op_sel:[1,1] op_sel_hi:[0,1]
    v_pk_fma_f32 v[72:73], v[70:71], v[70:71], v[94:95] op_sel:[0,0,0] op_sel_hi:[0,1,1] neg_lo:[0,0,1]
    v_pk_mul_f32 v[92:93], v[80:81], v[80:81] op_sel:[1,1] op_sel_hi:[0,1]
    v_pk_fma_f32 v[82:83], v[80:81], v[80:81], v[92:93] op_sel:[0,0,0] op_sel_hi:[0,1,1] neg_lo:[0,0,1]
    v_pk_mul_f32 v[94:95], v[72:73], v[72:73] op_sel:[1,1] op_sel_hi:[0,1]
    v_pk_fma_f32 v[74:75], v[72:73], v[72:73], v[94:95] op_sel:[0,0,0] op_sel_hi:[0,1,1] neg_lo:[0,0,1]
    v_pk_mul_f32 v[92:93], v[82:83], v[82:83] op_sel:[1,1] op_sel_hi:[0,1]
    v_pk_fma_f32 v[84:85], v[82:83], v[82:83], v[92:93] op_sel:[0,0,0] op_sel_hi:[0,1,1] neg_lo:[0,0,1]
    v_pk_mul_f32 v[94:95], v[66:67], v[76:77] op_sel:[1,1] op_sel_hi:[1,0]
    v_pk_fma_f32 v[86:87], v[66:67], v[76:77], v[94:95] op_sel:[0,0,0] op_sel_hi:[0,1,1] neg_lo:[0,0,1] neg_hi:[1,0,1]
    v_mov_b32_dpp v80, v78 row_ror:8 row_mask:0xf bank_mask:0x3
    v_mov_b32_dpp v81, v79 row_ror:8 row_mask:0xf bank_mask:0x3
    v_mov_b32_dpp v82, v84 row_ror:8 row_mask:0xf bank_mask:0x3
    v_mov_b32_dpp v83, v85 row_ror:8 row_mask:0xf bank_mask:0x3
    v_pk_mul_f32 v[92:93], v[66:67], v[80:81] op_sel:[1,1] op_sel_hi:[1,0]
    v_pk_fma_f32 v[88:89], v[66:67], v[80:81], v[92:93] op_sel:[0,0,0] op_sel_hi:[0,1,1] neg_lo:[0,0,1] neg_hi:[1,0,1]
    v_pk_mul_f32 v[94:95], v[66:67], v[82:83] op_sel:[1,1] op_sel_hi:[1,0]
    v_pk_fma_f32 v[90:91], v[66:67], v[82:83], v[94:95] op_sel:[0,0,0] op_sel_hi:[0,1,1] neg_lo:[0,0,1] neg_hi:[1,0,1]
    v_mfma_f32_16x16x4_f32 v[48:51], v86, v68, v[48:51]
    v_mfma_f32_16x16x4_f32 v[52:55], v88, v70, v[52:55]
    v_mfma_f32_16x16x4_f32 v[56:59], v88, v72, v[56:59]
    v_mfma_f32_16x16x4_f32 v[60:63], v90, v74, v[60:63]
    v_mfma_f32_16x16x4_f32 v[48:51], v87, v69, v[48:51]
    v_mfma_f32_16x16x4_f32 v[52:55], v89, v71, v[52:55]
    v_mfma_f32_16x16x4_f32 v[56:59], v89, v73, v[56:59]
    v_mfma_f32_16x16x4_f32 v[60:63], v91, v75, v[60:63]
    v_mov_b64_dpp v[64:65], v[28:29] row_newbcast:4 row_mask:0xf bank_mask:0xf
    v_mov_b64_dpp v[66:67], v[30:31] row_newbcast:4 row_mask:0xf bank_mask:0xf
    v_pk_mul_f32 v[94:95], v[64:65], v[26:27] op_sel_hi:[1,0]
    v_pk_mul_f32 v[96:97], v[64:65], v[26:27] op_sel:[0,1] op_sel_hi:[1,1]
    v_fract_f32 v95, v95
    v_fract_f32 v97, v97
    v_exp_f32 v94, v94
    v_exp_f32 v96, v96
    v_cos_f32 v68, v95
    v_sin_f32 v69, v95
    v_cos_f32 v76, v97
    v_sin_f32 v77, v97
    v_pk_mul_f32 v[68:69], v[68:69], v[94:95] op_sel_hi:[1,0]
    v_pk_mul_f32 v[76:77], v[76:77], v[96:97] op_sel_hi:[1,0]
    v_pk_mul_f32 v[92:93], v[76:77], v[76:77] op_sel:[1,1] op_sel_hi:[0,1]
    v_pk_fma_f32 v[78:79], v[76:77], v[76:77], v[92:93] op_sel:[0,0,0] op_sel_hi:[0,1,1] neg_lo:[0,0,1]
    v_pk_mul_f32 v[94:95], v[68:69], v[68:69] op_sel:[1,1] op_sel_hi:[0,1]
    v_pk_fma_f32 v[70:71], v[68:69], v[68:69], v[94:95] op_sel:[0,0,0] op_sel_hi:[0,1,1] neg_lo:[0,0,1]
    v_pk_mul_f32 v[92:93], v[78:79], v[78:79] op_sel:[1,1] op_sel_hi:[0,1]
    v_pk_fma_f32 v[80:81], v[78:79], v[78:79], v[92:93] op_sel:[0,0,0] op_sel_hi:[0,1,1] neg_lo:[0,0,1]
    v_pk_mul_f32 v[94:95], v[70:71], v[70:71] op_sel:[1,1] op_sel_hi:[0,1]
    v_pk_fma_f32 v[72:73], v[70:71], v[70:71], v[94:95] op_sel:[0,0,0] op_sel_hi:[0,1,1] neg_lo:[0,0,1]
    v_pk_mul_f32 v[92:93], v[80:81], v[80:81] op_sel:[1,1] op_sel_hi:[0,1]
    v_pk_fma_f32 v[82:83], v[80:81], v[80:81], v[92:93] op_sel:[0,0,0] op_sel_hi:[0,1,1] neg_lo:[0,0,1]
    v_pk_mul_f32 v[94:95], v[72:73], v[72:73] op_sel:[1,1] op_sel_hi:[0,1]
    v_pk_fma_f32 v[74:75], v[72:73], v[72:73], v[94:95] op_sel:[0,0,0] op_sel_hi:[0,1,1] neg_lo:[0,0,1]
    v_pk_mul_f32 v[92:93], v[82:83], v[82:83] op_sel:[1,1] op_sel_hi:[0,1]
    v_pk_fma_f32 v[84:85], v[82:83], v[82:83], v[92:93] op_sel:[0,0,0] op_sel_hi:[0,1,1] neg_lo:[0,0,1]
    v_pk_mul_f32 v[94:95], v[66:67], v[76:77] op_sel:[1,1] op_sel_hi:[1,0]
    v_pk_fma_f32 v[86:87], v[66:67], v[76:77], v[94:95] op_sel:[0,0,0] op_sel_hi:[0,1,1] neg_lo:[0,0,1] neg_hi:[1,0,1]
    v_mov_b32_dpp v80, v78 row_ror:8 row_mask:0xf bank_mask:0x3
    v_mov_b32_dpp v81, v79 row_ror:8 row_mask:0xf bank_mask:0x3
    v_mov_b32_dpp v82, v84 row_ror:8 row_mask:0xf bank_mask:0x3
    v_mov_b32_dpp v83, v85 row_ror:8 row_mask:0xf bank_mask:0x3
    v_pk_mul_f32 v[92:93], v[66:67], v[80:81] op_sel:[1,1] op_sel_hi:[1,0]
    v_pk_fma_f32 v[88:89], v[66:67], v[80:81], v[92:93] op_sel:[0,0,0] op_sel_hi:[0,1,1] neg_lo:[0,0,1] neg_hi:[1,0,1]
    v_pk_mul_f32 v[94:95], v[66:67], v[82:83] op_sel:[1,1] op_sel_hi:[1,0]
    v_pk_fma_f32 v[90:91], v[66:67], v[82:83], v[94:95] op_sel:[0,0,0] op_sel_hi:[0,1,1] neg_lo:[0,0,1] neg_hi:[1,0,1]
    v_mfma_f32_16x16x4_f32 v[48:51], v86, v68, v[48:51]
    v_mfma_f32_16x16x4_f32 v[52:55], v88, v70, v[52:55]
    v_mfma_f32_16x16x4_f32 v[56:59], v88, v72, v[56:59]
    v_mfma_f32_16x16x4_f32 v[60:63], v90, v74, v[60:63]
    v_mfma_f32_16x16x4_f32 v[48:51], v87, v69, v[48:51]
    v_mfma_f32_16x16x4_f32 v[52:55], v89, v71, v[52:55]
    v_mfma_f32_16x16x4_f32 v[56:59], v89, v73, v[56:59]
    v_mfma_f32_16x16x4_f32 v[60:63], v91, v75, v[60:63]
    v_mov_b64_dpp v[64:65], v[28:29] row_newbcast:5 row_mask:0xf bank_mask:0xf
    v_mov_b64_dpp v[66:67], v[30:31] row_newbcast:5 row_mask:0xf bank_mask:0xf
    v_pk_mul_f32 v[94:95], v[64:65], v[26:27] op_sel_hi:[1,0]
    v_pk_mul_f32 v[96:97], v[64:65], v[26:27] op_sel:[0,1] op_sel_hi:[1,1]
    v_fract_f32 v95, v95
    v_fract_f32 v97, v97
    v_exp_f32 v94, v94
    v_exp_f32 v96, v96
    v_cos_f32 v68, v95
    v_sin_f32 v69, v95
    v_cos_f32 v76, v97
    v_sin_f32 v77, v97
    v_pk_mul_f32 v[68:69], v[68:69], v[94:95] op_sel_hi:[1,0]
    v_pk_mul_f32 v[76:77], v[76:77], v[96:97] op_sel_hi:[1,0]
    v_pk_mul_f32 v[92:93], v[76:77], v[76:77] op_sel:[1,1] op_sel_hi:[0,1]
    v_pk_fma_f32 v[78:79], v[76:77], v[76:77], v[92:93] op_sel:[0,0,0] op_sel_hi:[0,1,1] neg_lo:[0,0,1]
    v_pk_mul_f32 v[94:95], v[68:69], v[68:69] op_sel:[1,1] op_sel_hi:[0,1]
    v_pk_fma_f32 v[70:71], v[68:69], v[68:69], v[94:95] op_sel:[0,0,0] op_sel_hi:[0,1,1] neg_lo:[0,0,1]
    v_pk_mul_f32 v[92:93], v[78:79], v[78:79] op_sel:[1,1] op_sel_hi:[0,1]
    v_pk_fma_f32 v[80:81], v[78:79], v[78:79], v[92:93] op_sel:[0,0,0] op_sel_hi:[0,1,1] neg_lo:[0,0,1]
    v_pk_mul_f32 v[94:95], v[70:71], v[70:71] op_sel:[1,1] op_sel_hi:[0,1]
    v_pk_fma_f32 v[72:73], v[70:71], v[70:71], v[94:95] op_sel:[0,0,0] op_sel_hi:[0,1,1] neg_lo:[0,0,1]
    v_pk_mul_f32 v[92:93], v[80:81], v[80:81] op_sel:[1,1] op_sel_hi:[0,1]
    v_pk_fma_f32 v[82:83], v[80:81], v[80:81], v[92:93] op_sel:[0,0,0] op_sel_hi:[0,1,1] neg_lo:[0,0,1]
    v_pk_mul_f32 v[94:95], v[72:73], v[72:73] op_sel:[1,1] op_sel_hi:[0,1]
    v_pk_fma_f32 v[74:75], v[72:73], v[72:73], v[94:95] op_sel:[0,0,0] op_sel_hi:[0,1,1] neg_lo:[0,0,1]
    v_pk_mul_f32 v[92:93], v[82:83], v[82:83] op_sel:[1,1] op_sel_hi:[0,1]
    v_pk_fma_f32 v[84:85], v[82:83], v[82:83], v[92:93] op_sel:[0,0,0] op_sel_hi:[0,1,1] neg_lo:[0,0,1]
    v_pk_mul_f32 v[94:95], v[66:67], v[76:77] op_sel:[1,1] op_sel_hi:[1,0]
    v_pk_fma_f32 v[86:87], v[66:67], v[76:77], v[94:95] op_sel:[0,0,0] op_sel_hi:[0,1,1] neg_lo:[0,0,1] neg_hi:[1,0,1]
    v_mov_b32_dpp v80, v78 row_ror:8 row_mask:0xf bank_mask:0x3
    v_mov_b32_dpp v81, v79 row_ror:8 row_mask:0xf bank_mask:0x3
    v_mov_b32_dpp v82, v84 row_ror:8 row_mask:0xf bank_mask:0x3
    v_mov_b32_dpp v83, v85 row_ror:8 row_mask:0xf bank_mask:0x3
    v_pk_mul_f32 v[92:93], v[66:67], v[80:81] op_sel:[1,1] op_sel_hi:[1,0]
    v_pk_fma_f32 v[88:89], v[66:67], v[80:81], v[92:93] op_sel:[0,0,0] op_sel_hi:[0,1,1] neg_lo:[0,0,1] neg_hi:[1,0,1]
    v_pk_mul_f32 v[94:95], v[66:67], v[82:83] op_sel:[1,1] op_sel_hi:[1,0]
    v_pk_fma_f32 v[90:91], v[66:67], v[82:83], v[94:95] op_sel:[0,0,0] op_sel_hi:[0,1,1] neg_lo:[0,0,1] neg_hi:[1,0,1]
    v_mfma_f32_16x16x4_f32 v[48:51], v86, v68, v[48:51]
    v_mfma_f32_16x16x4_f32 v[52:55], v88, v70, v[52:55]
    v_mfma_f32_16x16x4_f32 v[56:59], v88, v72, v[56:59]
    v_mfma_f32_16x16x4_f32 v[60:63], v90, v74, v[60:63]
    v_mfma_f32_16x16x4_f32 v[48:51], v87, v69, v[48:51]
    v_mfma_f32_16x16x4_f32 v[52:55], v89, v71, v[52:55]
    v_mfma_f32_16x16x4_f32 v[56:59], v89, v73, v[56:59]
    v_mfma_f32_16x16x4_f32 v[60:63], v91, v75, v[60:63]
    v_mov_b64_dpp v[64:65], v[28:29] row_newbcast:6 row_mask:0xf bank_mask:0xf
    v_mov_b64_dpp v[66:67], v[30:31] row_newbcast:6 row_mask:0xf bank_mask:0xf
    v_pk_mul_f32 v[94:95], v[64:65], v[26:27] op_sel_hi:[1,0]
    v_pk_mul_f32 v[96:97], v[64:65], v[26:27] op_sel:[0,1] op_sel_hi:[1,1]
    v_fract_f32 v95, v95
    v_fract_f32 v97, v97
    v_exp_f32 v94, v94
    v_exp_f32 v96, v96
    v_cos_f32 v68, v95
    v_sin_f32 v69, v95
    v_cos_f32 v76, v97
    v_sin_f32 v77, v97
    v_pk_mul_f32 v[68:69], v[68:69], v[94:95] op_sel_hi:[1,0]
    v_pk_mul_f32 v[76:77], v[76:77], v[96:97] op_sel_hi:[1,0]
    v_pk_mul_f32 v[92:93], v[76:77], v[76:77] op_sel:[1,1] op_sel_hi:[0,1]
    v_pk_fma_f32 v[78:79], v[76:77], v[76:77], v[92:93] op_sel:[0,0,0] op_sel_hi:[0,1,1] neg_lo:[0,0,1]
    v_pk_mul_f32 v[94:95], v[68:69], v[68:69] op_sel:[1,1] op_sel_hi:[0,1]
    v_pk_fma_f32 v[70:71], v[68:69], v[68:69], v[94:95] op_sel:[0,0,0] op_sel_hi:[0,1,1] neg_lo:[0,0,1]
    v_pk_mul_f32 v[92:93], v[78:79], v[78:79] op_sel:[1,1] op_sel_hi:[0,1]
    v_pk_fma_f32 v[80:81], v[78:79], v[78:79], v[92:93] op_sel:[0,0,0] op_sel_hi:[0,1,1] neg_lo:[0,0,1]
    v_pk_mul_f32 v[94:95], v[70:71], v[70:71] op_sel:[1,1] op_sel_hi:[0,1]
    v_pk_fma_f32 v[72:73], v[70:71], v[70:71], v[94:95] op_sel:[0,0,0] op_sel_hi:[0,1,1] neg_lo:[0,0,1]
    v_pk_mul_f32 v[92:93], v[80:81], v[80:81] op_sel:[1,1] op_sel_hi:[0,1]
    v_pk_fma_f32 v[82:83], v[80:81], v[80:81], v[92:93] op_sel:[0,0,0] op_sel_hi:[0,1,1] neg_lo:[0,0,1]
    v_pk_mul_f32 v[94:95], v[72:73], v[72:73] op_sel:[1,1] op_sel_hi:[0,1]
    v_pk_fma_f32 v[74:75], v[72:73], v[72:73], v[94:95] op_sel:[0,0,0] op_sel_hi:[0,1,1] neg_lo:[0,0,1]
    v_pk_mul_f32 v[92:93], v[82:83], v[82:83] op_sel:[1,1] op_sel_hi:[0,1]
    v_pk_fma_f32 v[84:85], v[82:83], v[82:83], v[92:93] op_sel:[0,0,0] op_sel_hi:[0,1,1] neg_lo:[0,0,1]
    v_pk_mul_f32 v[94:95], v[66:67], v[76:77] op_sel:[1,1] op_sel_hi:[1,0]
    v_pk_fma_f32 v[86:87], v[66:67], v[76:77], v[94:95] op_sel:[0,0,0] op_sel_hi:[0,1,1] neg_lo:[0,0,1] neg_hi:[1,0,1]
    v_mov_b32_dpp v80, v78 row_ror:8 row_mask:0xf bank_mask:0x3
    v_mov_b32_dpp v81, v79 row_ror:8 row_mask:0xf bank_mask:0x3
    v_mov_b32_dpp v82, v84 row_ror:8 row_mask:0xf bank_mask:0x3
    v_mov_b32_dpp v83, v85 row_ror:8 row_mask:0xf bank_mask:0x3
    v_pk_mul_f32 v[92:93], v[66:67], v[80:81] op_sel:[1,1] op_sel_hi:[1,0]
    v_pk_fma_f32 v[88:89], v[66:67], v[80:81], v[92:93] op_sel:[0,0,0] op_sel_hi:[0,1,1] neg_lo:[0,0,1] neg_hi:[1,0,1]
    v_pk_mul_f32 v[94:95], v[66:67], v[82:83] op_sel:[1,1] op_sel_hi:[1,0]
    v_pk_fma_f32 v[90:91], v[66:67], v[82:83], v[94:95] op_sel:[0,0,0] op_sel_hi:[0,1,1] neg_lo:[0,0,1] neg_hi:[1,0,1]
    v_mfma_f32_16x16x4_f32 v[48:51], v86, v68, v[48:51]
    v_mfma_f32_16x16x4_f32 v[52:55], v88, v70, v[52:55]
    v_mfma_f32_16x16x4_f32 v[56:59], v88, v72, v[56:59]
    v_mfma_f32_16x16x4_f32 v[60:63], v90, v74, v[60:63]
    v_mfma_f32_16x16x4_f32 v[48:51], v87, v69, v[48:51]
    v_mfma_f32_16x16x4_f32 v[52:55], v89, v71, v[52:55]
    v_mfma_f32_16x16x4_f32 v[56:59], v89, v73, v[56:59]
    v_mfma_f32_16x16x4_f32 v[60:63], v91, v75, v[60:63]
    v_mov_b64_dpp v[64:65], v[28:29] row_newbcast:7 row_mask:0xf bank_mask:0xf
    v_mov_b64_dpp v[66:67], v[30:31] row_newbcast:7 row_mask:0xf bank_mask:0xf
    v_pk_mul_f32 v[94:95], v[64:65], v[26:27] op_sel_hi:[1,0]
    v_pk_mul_f32 v[96:97], v[64:65], v[26:27] op_sel:[0,1] op_sel_hi:[1,1]
    v_fract_f32 v95, v95
    v_fract_f32 v97, v97
    v_exp_f32 v94, v94
    v_exp_f32 v96, v96
    v_cos_f32 v68, v95
    v_sin_f32 v69, v95
    v_cos_f32 v76, v97
    v_sin_f32 v77, v97
    v_pk_mul_f32 v[68:69], v[68:69], v[94:95] op_sel_hi:[1,0]
    v_pk_mul_f32 v[76:77], v[76:77], v[96:97] op_sel_hi:[1,0]
    v_pk_mul_f32 v[92:93], v[76:77], v[76:77] op_sel:[1,1] op_sel_hi:[0,1]
    v_pk_fma_f32 v[78:79], v[76:77], v[76:77], v[92:93] op_sel:[0,0,0] op_sel_hi:[0,1,1] neg_lo:[0,0,1]
    v_pk_mul_f32 v[94:95], v[68:69], v[68:69] op_sel:[1,1] op_sel_hi:[0,1]
    v_pk_fma_f32 v[70:71], v[68:69], v[68:69], v[94:95] op_sel:[0,0,0] op_sel_hi:[0,1,1] neg_lo:[0,0,1]
    v_pk_mul_f32 v[92:93], v[78:79], v[78:79] op_sel:[1,1] op_sel_hi:[0,1]
    v_pk_fma_f32 v[80:81], v[78:79], v[78:79], v[92:93] op_sel:[0,0,0] op_sel_hi:[0,1,1] neg_lo:[0,0,1]
    v_pk_mul_f32 v[94:95], v[70:71], v[70:71] op_sel:[1,1] op_sel_hi:[0,1]
    v_pk_fma_f32 v[72:73], v[70:71], v[70:71], v[94:95] op_sel:[0,0,0] op_sel_hi:[0,1,1] neg_lo:[0,0,1]
    v_pk_mul_f32 v[92:93], v[80:81], v[80:81] op_sel:[1,1] op_sel_hi:[0,1]
    v_pk_fma_f32 v[82:83], v[80:81], v[80:81], v[92:93] op_sel:[0,0,0] op_sel_hi:[0,1,1] neg_lo:[0,0,1]
    v_pk_mul_f32 v[94:95], v[72:73], v[72:73] op_sel:[1,1] op_sel_hi:[0,1]
    v_pk_fma_f32 v[74:75], v[72:73], v[72:73], v[94:95] op_sel:[0,0,0] op_sel_hi:[0,1,1] neg_lo:[0,0,1]
    v_pk_mul_f32 v[92:93], v[82:83], v[82:83] op_sel:[1,1] op_sel_hi:[0,1]
    v_pk_fma_f32 v[84:85], v[82:83], v[82:83], v[92:93] op_sel:[0,0,0] op_sel_hi:[0,1,1] neg_lo:[0,0,1]
    v_pk_mul_f32 v[94:95], v[66:67], v[76:77] op_sel:[1,1] op_sel_hi:[1,0]
    v_pk_fma_f32 v[86:87], v[66:67], v[76:77], v[94:95] op_sel:[0,0,0] op_sel_hi:[0,1,1] neg_lo:[0,0,1] neg_hi:[1,0,1]
    v_mov_b32_dpp v80, v78 row_ror:8 row_mask:0xf bank_mask:0x3
    v_mov_b32_dpp v81, v79 row_ror:8 row_mask:0xf bank_mask:0x3
    v_mov_b32_dpp v82, v84 row_ror:8 row_mask:0xf bank_mask:0x3
    v_mov_b32_dpp v83, v85 row_ror:8 row_mask:0xf bank_mask:0x3
    v_pk_mul_f32 v[92:93], v[66:67], v[80:81] op_sel:[1,1] op_sel_hi:[1,0]
    v_pk_fma_f32 v[88:89], v[66:67], v[80:81], v[92:93] op_sel:[0,0,0] op_sel_hi:[0,1,1] neg_lo:[0,0,1] neg_hi:[1,0,1]
    v_pk_mul_f32 v[94:95], v[66:67], v[82:83] op_sel:[1,1] op_sel_hi:[1,0]
    v_pk_fma_f32 v[90:91], v[66:67], v[82:83], v[94:95] op_sel:[0,0,0] op_sel_hi:[0,1,1] neg_lo:[0,0,1] neg_hi:[1,0,1]
    v_mfma_f32_16x16x4_f32 v[48:51], v86, v68, v[48:51]
    v_mfma_f32_16x16x4_f32 v[52:55], v88, v70, v[52:55]
    v_mfma_f32_16x16x4_f32 v[56:59], v88, v72, v[56:59]
    v_mfma_f32_16x16x4_f32 v[60:63], v90, v74, v[60:63]
    v_mfma_f32_16x16x4_f32 v[48:51], v87, v69, v[48:51]
    v_mfma_f32_16x16x4_f32 v[52:55], v89, v71, v[52:55]
    v_mfma_f32_16x16x4_f32 v[56:59], v89, v73, v[56:59]
    v_mfma_f32_16x16x4_f32 v[60:63], v91, v75, v[60:63]
    v_mov_b64_dpp v[64:65], v[28:29] row_newbcast:8 row_mask:0xf bank_mask:0xf
    v_mov_b64_dpp v[66:67], v[30:31] row_newbcast:8 row_mask:0xf bank_mask:0xf
    v_pk_mul_f32 v[94:95], v[64:65], v[26:27] op_sel_hi:[1,0]
    v_pk_mul_f32 v[96:97], v[64:65], v[26:27] op_sel:[0,1] op_sel_hi:[1,1]
    v_fract_f32 v95, v95
    v_fract_f32 v97, v97
    v_exp_f32 v94, v94
    v_exp_f32 v96, v96
    v_cos_f32 v68, v95
    v_sin_f32 v69, v95
    v_cos_f32 v76, v97
    v_sin_f32 v77, v97
    v_pk_mul_f32 v[68:69], v[68:69], v[94:95] op_sel_hi:[1,0]
    v_pk_mul_f32 v[76:77], v[76:77], v[96:97] op_sel_hi:[1,0]
    v_pk_mul_f32 v[92:93], v[76:77], v[76:77] op_sel:[1,1] op_sel_hi:[0,1]
    v_pk_fma_f32 v[78:79], v[76:77], v[76:77], v[92:93] op_sel:[0,0,0] op_sel_hi:[0,1,1] neg_lo:[0,0,1]
    v_pk_mul_f32 v[94:95], v[68:69], v[68:69] op_sel:[1,1] op_sel_hi:[0,1]
    v_pk_fma_f32 v[70:71], v[68:69], v[68:69], v[94:95] op_sel:[0,0,0] op_sel_hi:[0,1,1] neg_lo:[0,0,1]
    v_pk_mul_f32 v[92:93], v[78:79], v[78:79] op_sel:[1,1] op_sel_hi:[0,1]
    v_pk_fma_f32 v[80:81], v[78:79], v[78:79], v[92:93] op_sel:[0,0,0] op_sel_hi:[0,1,1] neg_lo:[0,0,1]
    v_pk_mul_f32 v[94:95], v[70:71], v[70:71] op_sel:[1,1] op_sel_hi:[0,1]
    v_pk_fma_f32 v[72:73], v[70:71], v[70:71], v[94:95] op_sel:[0,0,0] op_sel_hi:[0,1,1] neg_lo:[0,0,1]
    v_pk_mul_f32 v[92:93], v[80:81], v[80:81] op_sel:[1,1] op_sel_hi:[0,1]
    v_pk_fma_f32 v[82:83], v[80:81], v[80:81], v[92:93] op_sel:[0,0,0] op_sel_hi:[0,1,1] neg_lo:[0,0,1]
    v_pk_mul_f32 v[94:95], v[72:73], v[72:73] op_sel:[1,1] op_sel_hi:[0,1]
    v_pk_fma_f32 v[74:75], v[72:73], v[72:73], v[94:95] op_sel:[0,0,0] op_sel_hi:[0,1,1] neg_lo:[0,0,1]
    v_pk_mul_f32 v[92:93], v[82:83], v[82:83] op_sel:[1,1] op_sel_hi:[0,1]
    v_pk_fma_f32 v[84:85], v[82:83], v[82:83], v[92:93] op_sel:[0,0,0] op_sel_hi:[0,1,1] neg_lo:[0,0,1]
    v_pk_mul_f32 v[94:95], v[66:67], v[76:77] op_sel:[1,1] op_sel_hi:[1,0]
    v_pk_fma_f32 v[86:87], v[66:67], v[76:77], v[94:95] op_sel:[0,0,0] op_sel_hi:[0,1,1] neg_lo:[0,0,1] neg_hi:[1,0,1]
    v_mov_b32_dpp v80, v78 row_ror:8 row_mask:0xf bank_mask:0x3
    v_mov_b32_dpp v81, v79 row_ror:8 row_mask:0xf bank_mask:0x3
    v_mov_b32_dpp v82, v84 row_ror:8 row_mask:0xf bank_mask:0x3
    v_mov_b32_dpp v83, v85 row_ror:8 row_mask:0xf bank_mask:0x3
    v_pk_mul_f32 v[92:93], v[66:67], v[80:81] op_sel:[1,1] op_sel_hi:[1,0]
    v_pk_fma_f32 v[88:89], v[66:67], v[80:81], v[92:93] op_sel:[0,0,0] op_sel_hi:[0,1,1] neg_lo:[0,0,1] neg_hi:[1,0,1]
    v_pk_mul_f32 v[94:95], v[66:67], v[82:83] op_sel:[1,1] op_sel_hi:[1,0]
    v_pk_fma_f32 v[90:91], v[66:67], v[82:83], v[94:95] op_sel:[0,0,0] op_sel_hi:[0,1,1] neg_lo:[0,0,1] neg_hi:[1,0,1]
    v_mfma_f32_16x16x4_f32 v[48:51], v86, v68, v[48:51]
    v_mfma_f32_16x16x4_f32 v[52:55], v88, v70, v[52:55]
    v_mfma_f32_16x16x4_f32 v[56:59], v88, v72, v[56:59]
    v_mfma_f32_16x16x4_f32 v[60:63], v90, v74, v[60:63]
    v_mfma_f32_16x16x4_f32 v[48:51], v87, v69, v[48:51]
    v_mfma_f32_16x16x4_f32 v[52:55], v89, v71, v[52:55]
    v_mfma_f32_16x16x4_f32 v[56:59], v89, v73, v[56:59]
    v_mfma_f32_16x16x4_f32 v[60:63], v91, v75, v[60:63]
    v_mov_b64_dpp v[64:65], v[28:29] row_newbcast:9 row_mask:0xf bank_mask:0xf
    v_mov_b64_dpp v[66:67], v[30:31] row_newbcast:9 row_mask:0xf bank_mask:0xf
    v_pk_mul_f32 v[94:95], v[64:65], v[26:27] op_sel_hi:[1,0]
    v_pk_mul_f32 v[96:97], v[64:65], v[26:27] op_sel:[0,1] op_sel_hi:[1,1]
    v_fract_f32 v95, v95
    v_fract_f32 v97, v97
    v_exp_f32 v94, v94
    v_exp_f32 v96, v96
    v_cos_f32 v68, v95
    v_sin_f32 v69, v95
    v_cos_f32 v76, v97
    v_sin_f32 v77, v97
    v_pk_mul_f32 v[68:69], v[68:69], v[94:95] op_sel_hi:[1,0]
    v_pk_mul_f32 v[76:77], v[76:77], v[96:97] op_sel_hi:[1,0]
    v_pk_mul_f32 v[92:93], v[76:77], v[76:77] op_sel:[1,1] op_sel_hi:[0,1]
    v_pk_fma_f32 v[78:79], v[76:77], v[76:77], v[92:93] op_sel:[0,0,0] op_sel_hi:[0,1,1] neg_lo:[0,0,1]
    v_pk_mul_f32 v[94:95], v[68:69], v[68:69] op_sel:[1,1] op_sel_hi:[0,1]
    v_pk_fma_f32 v[70:71], v[68:69], v[68:69], v[94:95] op_sel:[0,0,0] op_sel_hi:[0,1,1] neg_lo:[0,0,1]
    v_pk_mul_f32 v[92:93], v[78:79], v[78:79] op_sel:[1,1] op_sel_hi:[0,1]
    v_pk_fma_f32 v[80:81], v[78:79], v[78:79], v[92:93] op_sel:[0,0,0] op_sel_hi:[0,1,1] neg_lo:[0,0,1]
    v_pk_mul_f32 v[94:95], v[70:71], v[70:71] op_sel:[1,1] op_sel_hi:[0,1]
    v_pk_fma_f32 v[72:73], v[70:71], v[70:71], v[94:95] op_sel:[0,0,0] op_sel_hi:[0,1,1] neg_lo:[0,0,1]
    v_pk_mul_f32 v[92:93], v[80:81], v[80:81] op_sel:[1,1] op_sel_hi:[0,1]
    v_pk_fma_f32 v[82:83], v[80:81], v[80:81], v[92:93] op_sel:[0,0,0] op_sel_hi:[0,1,1] neg_lo:[0,0,1]
    v_pk_mul_f32 v[94:95], v[72:73], v[72:73] op_sel:[1,1] op_sel_hi:[0,1]
    v_pk_fma_f32 v[74:75], v[72:73], v[72:73], v[94:95] op_sel:[0,0,0] op_sel_hi:[0,1,1] neg_lo:[0,0,1]
    v_pk_mul_f32 v[92:93], v[82:83], v[82:83] op_sel:[1,1] op_sel_hi:[0,1]
    v_pk_fma_f32 v[84:85], v[82:83], v[82:83], v[92:93] op_sel:[0,0,0] op_sel_hi:[0,1,1] neg_lo:[0,0,1]
    v_pk_mul_f32 v[94:95], v[66:67], v[76:77] op_sel:[1,1] op_sel_hi:[1,0]
    v_pk_fma_f32 v[86:87], v[66:67], v[76:77], v[94:95] op_sel:[0,0,0] op_sel_hi:[0,1,1] neg_lo:[0,0,1] neg_hi:[1,0,1]
    v_mov_b32_dpp v80, v78 row_ror:8 row_mask:0xf bank_mask:0x3
    v_mov_b32_dpp v81, v79 row_ror:8 row_mask:0xf bank_mask:0x3
    v_mov_b32_dpp v82, v84 row_ror:8 row_mask:0xf bank_mask:0x3
    v_mov_b32_dpp v83, v85 row_ror:8 row_mask:0xf bank_mask:0x3
    v_pk_mul_f32 v[92:93], v[66:67], v[80:81] op_sel:[1,1] op_sel_hi:[1,0]
    v_pk_fma_f32 v[88:89], v[66:67], v[80:81], v[92:93] op_sel:[0,0,0] op_sel_hi:[0,1,1] neg_lo:[0,0,1] neg_hi:[1,0,1]
    v_pk_mul_f32 v[94:95], v[66:67], v[82:83] op_sel:[1,1] op_sel_hi:[1,0]
    v_pk_fma_f32 v[90:91], v[66:67], v[82:83], v[94:95] op_sel:[0,0,0] op_sel_hi:[0,1,1] neg_lo:[0,0,1] neg_hi:[1,0,1]
    v_mfma_f32_16x16x4_f32 v[48:51], v86, v68, v[48:51]
    v_mfma_f32_16x16x4_f32 v[52:55], v88, v70, v[52:55]
    v_mfma_f32_16x16x4_f32 v[56:59], v88, v72, v[56:59]
    v_mfma_f32_16x16x4_f32 v[60:63], v90, v74, v[60:63]
    v_mfma_f32_16x16x4_f32 v[48:51], v87, v69, v[48:51]
    v_mfma_f32_16x16x4_f32 v[52:55], v89, v71, v[52:55]
    v_mfma_f32_16x16x4_f32 v[56:59], v89, v73, v[56:59]
    v_mfma_f32_16x16x4_f32 v[60:63], v91, v75, v[60:63]
    v_mov_b64_dpp v[64:65], v[28:29] row_newbcast:10 row_mask:0xf bank_mask:0xf
    v_mov_b64_dpp v[66:67], v[30:31] row_newbcast:10 row_mask:0xf bank_mask:0xf
    v_pk_mul_f32 v[94:95], v[64:65], v[26:27] op_sel_hi:[1,0]
    v_pk_mul_f32 v[96:97], v[64:65], v[26:27] op_sel:[0,1] op_sel_hi:[1,1]
    v_fract_f32 v95, v95
    v_fract_f32 v97, v97
    v_exp_f32 v94, v94
    v_exp_f32 v96, v96
    v_cos_f32 v68, v95
    v_sin_f32 v69, v95
    v_cos_f32 v76, v97
    v_sin_f32 v77, v97
    v_pk_mul_f32 v[68:69], v[68:69], v[94:95] op_sel_hi:[1,0]
    v_pk_mul_f32 v[76:77], v[76:77], v[96:97] op_sel_hi:[1,0]
    v_pk_mul_f32 v[92:93], v[76:77], v[76:77] op_sel:[1,1] op_sel_hi:[0,1]
    v_pk_fma_f32 v[78:79], v[76:77], v[76:77], v[92:93] op_sel:[0,0,0] op_sel_hi:[0,1,1] neg_lo:[0,0,1]
    v_pk_mul_f32 v[94:95], v[68:69], v[68:69] op_sel:[1,1] op_sel_hi:[0,1]
    v_pk_fma_f32 v[70:71], v[68:69], v[68:69], v[94:95] op_sel:[0,0,0] op_sel_hi:[0,1,1] neg_lo:[0,0,1]
    v_pk_mul_f32 v[92:93], v[78:79], v[78:79] op_sel:[1,1] op_sel_hi:[0,1]
    v_pk_fma_f32 v[80:81], v[78:79], v[78:79], v[92:93] op_sel:[0,0,0] op_sel_hi:[0,1,1] neg_lo:[0,0,1]
    v_pk_mul_f32 v[94:95], v[70:71], v[70:71] op_sel:[1,1] op_sel_hi:[0,1]
    v_pk_fma_f32 v[72:73], v[70:71], v[70:71], v[94:95] op_sel:[0,0,0] op_sel_hi:[0,1,1] neg_lo:[0,0,1]
    v_pk_mul_f32 v[92:93], v[80:81], v[80:81] op_sel:[1,1] op_sel_hi:[0,1]
    v_pk_fma_f32 v[82:83], v[80:81], v[80:81], v[92:93] op_sel:[0,0,0] op_sel_hi:[0,1,1] neg_lo:[0,0,1]
    v_pk_mul_f32 v[94:95], v[72:73], v[72:73] op_sel:[1,1] op_sel_hi:[0,1]
    v_pk_fma_f32 v[74:75], v[72:73], v[72:73], v[94:95] op_sel:[0,0,0] op_sel_hi:[0,1,1] neg_lo:[0,0,1]
    v_pk_mul_f32 v[92:93], v[82:83], v[82:83] op_sel:[1,1] op_sel_hi:[0,1]
    v_pk_fma_f32 v[84:85], v[82:83], v[82:83], v[92:93] op_sel:[0,0,0] op_sel_hi:[0,1,1] neg_lo:[0,0,1]
    v_pk_mul_f32 v[94:95], v[66:67], v[76:77] op_sel:[1,1] op_sel_hi:[1,0]
    v_pk_fma_f32 v[86:87], v[66:67], v[76:77], v[94:95] op_sel:[0,0,0] op_sel_hi:[0,1,1] neg_lo:[0,0,1] neg_hi:[1,0,1]
    v_mov_b32_dpp v80, v78 row_ror:8 row_mask:0xf bank_mask:0x3
    v_mov_b32_dpp v81, v79 row_ror:8 row_mask:0xf bank_mask:0x3
    v_mov_b32_dpp v82, v84 row_ror:8 row_mask:0xf bank_mask:0x3
    v_mov_b32_dpp v83, v85 row_ror:8 row_mask:0xf bank_mask:0x3
    v_pk_mul_f32 v[92:93], v[66:67], v[80:81] op_sel:[1,1] op_sel_hi:[1,0]
    v_pk_fma_f32 v[88:89], v[66:67], v[80:81], v[92:93] op_sel:[0,0,0] op_sel_hi:[0,1,1] neg_lo:[0,0,1] neg_hi:[1,0,1]
    v_pk_mul_f32 v[94:95], v[66:67], v[82:83] op_sel:[1,1] op_sel_hi:[1,0]
    v_pk_fma_f32 v[90:91], v[66:67], v[82:83], v[94:95] op_sel:[0,0,0] op_sel_hi:[0,1,1] neg_lo:[0,0,1] neg_hi:[1,0,1]
    v_mfma_f32_16x16x4_f32 v[48:51], v86, v68, v[48:51]
    v_mfma_f32_16x16x4_f32 v[52:55], v88, v70, v[52:55]
    v_mfma_f32_16x16x4_f32 v[56:59], v88, v72, v[56:59]
    v_mfma_f32_16x16x4_f32 v[60:63], v90, v74, v[60:63]
    v_mfma_f32_16x16x4_f32 v[48:51], v87, v69, v[48:51]
    v_mfma_f32_16x16x4_f32 v[52:55], v89, v71, v[52:55]
    v_mfma_f32_16x16x4_f32 v[56:59], v89, v73, v[56:59]
    v_mfma_f32_16x16x4_f32 v[60:63], v91, v75, v[60:63]
    v_mov_b64_dpp v[64:65], v[28:29] row_newbcast:11 row_mask:0xf bank_mask:0xf
    v_mov_b64_dpp v[66:67], v[30:31] row_newbcast:11 row_mask:0xf bank_mask:0xf
    v_pk_mul_f32 v[94:95], v[64:65], v[26:27] op_sel_hi:[1,0]
    v_pk_mul_f32 v[96:97], v[64:65], v[26:27] op_sel:[0,1] op_sel_hi:[1,1]
    v_fract_f32 v95, v95
    v_fract_f32 v97, v97
    v_exp_f32 v94, v94
    v_exp_f32 v96, v96
    v_cos_f32 v68, v95
    v_sin_f32 v69, v95
    v_cos_f32 v76, v97
    v_sin_f32 v77, v97
    v_pk_mul_f32 v[68:69], v[68:69], v[94:95] op_sel_hi:[1,0]
    v_pk_mul_f32 v[76:77], v[76:77], v[96:97] op_sel_hi:[1,0]
    v_pk_mul_f32 v[92:93], v[76:77], v[76:77] op_sel:[1,1] op_sel_hi:[0,1]
    v_pk_fma_f32 v[78:79], v[76:77], v[76:77], v[92:93] op_sel:[0,0,0] op_sel_hi:[0,1,1] neg_lo:[0,0,1]
    v_pk_mul_f32 v[94:95], v[68:69], v[68:69] op_sel:[1,1] op_sel_hi:[0,1]
    v_pk_fma_f32 v[70:71], v[68:69], v[68:69], v[94:95] op_sel:[0,0,0] op_sel_hi:[0,1,1] neg_lo:[0,0,1]
    v_pk_mul_f32 v[92:93], v[78:79], v[78:79] op_sel:[1,1] op_sel_hi:[0,1]
    v_pk_fma_f32 v[80:81], v[78:79], v[78:79], v[92:93] op_sel:[0,0,0] op_sel_hi:[0,1,1] neg_lo:[0,0,1]
    v_pk_mul_f32 v[94:95], v[70:71], v[70:71] op_sel:[1,1] op_sel_hi:[0,1]
    v_pk_fma_f32 v[72:73], v[70:71], v[70:71], v[94:95] op_sel:[0,0,0] op_sel_hi:[0,1,1] neg_lo:[0,0,1]
    v_pk_mul_f32 v[92:93], v[80:81], v[80:81] op_sel:[1,1] op_sel_hi:[0,1]
    v_pk_fma_f32 v[82:83], v[80:81], v[80:81], v[92:93] op_sel:[0,0,0] op_sel_hi:[0,1,1] neg_lo:[0,0,1]
    v_pk_mul_f32 v[94:95], v[72:73], v[72:73] op_sel:[1,1] op_sel_hi:[0,1]
    v_pk_fma_f32 v[74:75], v[72:73], v[72:73], v[94:95] op_sel:[0,0,0] op_sel_hi:[0,1,1] neg_lo:[0,0,1]
    v_pk_mul_f32 v[92:93], v[82:83], v[82:83] op_sel:[1,1] op_sel_hi:[0,1]
    v_pk_fma_f32 v[84:85], v[82:83], v[82:83], v[92:93] op_sel:[0,0,0] op_sel_hi:[0,1,1] neg_lo:[0,0,1]
    v_pk_mul_f32 v[94:95], v[66:67], v[76:77] op_sel:[1,1] op_sel_hi:[1,0]
    v_pk_fma_f32 v[86:87], v[66:67], v[76:77], v[94:95] op_sel:[0,0,0] op_sel_hi:[0,1,1] neg_lo:[0,0,1] neg_hi:[1,0,1]
    v_mov_b32_dpp v80, v78 row_ror:8 row_mask:0xf bank_mask:0x3
    v_mov_b32_dpp v81, v79 row_ror:8 row_mask:0xf bank_mask:0x3
    v_mov_b32_dpp v82, v84 row_ror:8 row_mask:0xf bank_mask:0x3
    v_mov_b32_dpp v83, v85 row_ror:8 row_mask:0xf bank_mask:0x3
    v_pk_mul_f32 v[92:93], v[66:67], v[80:81] op_sel:[1,1] op_sel_hi:[1,0]
    v_pk_fma_f32 v[88:89], v[66:67], v[80:81], v[92:93] op_sel:[0,0,0] op_sel_hi:[0,1,1] neg_lo:[0,0,1] neg_hi:[1,0,1]
    v_pk_mul_f32 v[94:95], v[66:67], v[82:83] op_sel:[1,1] op_sel_hi:[1,0]
    v_pk_fma_f32 v[90:91], v[66:67], v[82:83], v[94:95] op_sel:[0,0,0] op_sel_hi:[0,1,1] neg_lo:[0,0,1] neg_hi:[1,0,1]
    v_mfma_f32_16x16x4_f32 v[48:51], v86, v68, v[48:51]
    v_mfma_f32_16x16x4_f32 v[52:55], v88, v70, v[52:55]
    v_mfma_f32_16x16x4_f32 v[56:59], v88, v72, v[56:59]
    v_mfma_f32_16x16x4_f32 v[60:63], v90, v74, v[60:63]
    v_mfma_f32_16x16x4_f32 v[48:51], v87, v69, v[48:51]
    v_mfma_f32_16x16x4_f32 v[52:55], v89, v71, v[52:55]
    v_mfma_f32_16x16x4_f32 v[56:59], v89, v73, v[56:59]
    v_mfma_f32_16x16x4_f32 v[60:63], v91, v75, v[60:63]
    v_mov_b64_dpp v[64:65], v[28:29] row_newbcast:12 row_mask:0xf bank_mask:0xf
    v_mov_b64_dpp v[66:67], v[30:31] row_newbcast:12 row_mask:0xf bank_mask:0xf
    v_pk_mul_f32 v[94:95], v[64:65], v[26:27] op_sel_hi:[1,0]
    v_pk_mul_f32 v[96:97], v[64:65], v[26:27] op_sel:[0,1] op_sel_hi:[1,1]
    v_fract_f32 v95, v95
    v_fract_f32 v97, v97
    v_exp_f32 v94, v94
    v_exp_f32 v96, v96
    v_cos_f32 v68, v95
    v_sin_f32 v69, v95
    v_cos_f32 v76, v97
    v_sin_f32 v77, v97
    v_pk_mul_f32 v[68:69], v[68:69], v[94:95] op_sel_hi:[1,0]
    v_pk_mul_f32 v[76:77], v[76:77], v[96:97] op_sel_hi:[1,0]
    v_pk_mul_f32 v[92:93], v[76:77], v[76:77] op_sel:[1,1] op_sel_hi:[0,1]
    v_pk_fma_f32 v[78:79], v[76:77], v[76:77], v[92:93] op_sel:[0,0,0] op_sel_hi:[0,1,1] neg_lo:[0,0,1]
    v_pk_mul_f32 v[94:95], v[68:69], v[68:69] op_sel:[1,1] op_sel_hi:[0,1]
    v_pk_fma_f32 v[70:71], v[68:69], v[68:69], v[94:95] op_sel:[0,0,0] op_sel_hi:[0,1,1] neg_lo:[0,0,1]
    v_pk_mul_f32 v[92:93], v[78:79], v[78:79] op_sel:[1,1] op_sel_hi:[0,1]
    v_pk_fma_f32 v[80:81], v[78:79], v[78:79], v[92:93] op_sel:[0,0,0] op_sel_hi:[0,1,1] neg_lo:[0,0,1]
    v_pk_mul_f32 v[94:95], v[70:71], v[70:71] op_sel:[1,1] op_sel_hi:[0,1]
    v_pk_fma_f32 v[72:73], v[70:71], v[70:71], v[94:95] op_sel:[0,0,0] op_sel_hi:[0,1,1] neg_lo:[0,0,1]
    v_pk_mul_f32 v[92:93], v[80:81], v[80:81] op_sel:[1,1] op_sel_hi:[0,1]
    v_pk_fma_f32 v[82:83], v[80:81], v[80:81], v[92:93] op_sel:[0,0,0] op_sel_hi:[0,1,1] neg_lo:[0,0,1]
    v_pk_mul_f32 v[94:95], v[72:73], v[72:73] op_sel:[1,1] op_sel_hi:[0,1]
    v_pk_fma_f32 v[74:75], v[72:73], v[72:73], v[94:95] op_sel:[0,0,0] op_sel_hi:[0,1,1] neg_lo:[0,0,1]
    v_pk_mul_f32 v[92:93], v[82:83], v[82:83] op_sel:[1,1] op_sel_hi:[0,1]
    v_pk_fma_f32 v[84:85], v[82:83], v[82:83], v[92:93] op_sel:[0,0,0] op_sel_hi:[0,1,1] neg_lo:[0,0,1]
    v_pk_mul_f32 v[94:95], v[66:67], v[76:77] op_sel:[1,1] op_sel_hi:[1,0]
    v_pk_fma_f32 v[86:87], v[66:67], v[76:77], v[94:95] op_sel:[0,0,0] op_sel_hi:[0,1,1] neg_lo:[0,0,1] neg_hi:[1,0,1]
    v_mov_b32_dpp v80, v78 row_ror:8 row_mask:0xf bank_mask:0x3
    v_mov_b32_dpp v81, v79 row_ror:8 row_mask:0xf bank_mask:0x3
    v_mov_b32_dpp v82, v84 row_ror:8 row_mask:0xf bank_mask:0x3
    v_mov_b32_dpp v83, v85 row_ror:8 row_mask:0xf bank_mask:0x3
    v_pk_mul_f32 v[92:93], v[66:67], v[80:81] op_sel:[1,1] op_sel_hi:[1,0]
    v_pk_fma_f32 v[88:89], v[66:67], v[80:81], v[92:93] op_sel:[0,0,0] op_sel_hi:[0,1,1] neg_lo:[0,0,1] neg_hi:[1,0,1]
    v_pk_mul_f32 v[94:95], v[66:67], v[82:83] op_sel:[1,1] op_sel_hi:[1,0]
    v_pk_fma_f32 v[90:91], v[66:67], v[82:83], v[94:95] op_sel:[0,0,0] op_sel_hi:[0,1,1] neg_lo:[0,0,1] neg_hi:[1,0,1]
    v_mfma_f32_16x16x4_f32 v[48:51], v86, v68, v[48:51]
    v_mfma_f32_16x16x4_f32 v[52:55], v88, v70, v[52:55]
    v_mfma_f32_16x16x4_f32 v[56:59], v88, v72, v[56:59]
    v_mfma_f32_16x16x4_f32 v[60:63], v90, v74, v[60:63]
    v_mfma_f32_16x16x4_f32 v[48:51], v87, v69, v[48:51]
    v_mfma_f32_16x16x4_f32 v[52:55], v89, v71, v[52:55]
    v_mfma_f32_16x16x4_f32 v[56:59], v89, v73, v[56:59]
    v_mfma_f32_16x16x4_f32 v[60:63], v91, v75, v[60:63]
    v_mov_b64_dpp v[64:65], v[28:29] row_newbcast:13 row_mask:0xf bank_mask:0xf
    v_mov_b64_dpp v[66:67], v[30:31] row_newbcast:13 row_mask:0xf bank_mask:0xf
    v_pk_mul_f32 v[94:95], v[64:65], v[26:27] op_sel_hi:[1,0]
    v_pk_mul_f32 v[96:97], v[64:65], v[26:27] op_sel:[0,1] op_sel_hi:[1,1]
    v_fract_f32 v95, v95
    v_fract_f32 v97, v97
    v_exp_f32 v94, v94
    v_exp_f32 v96, v96
    v_cos_f32 v68, v95
    v_sin_f32 v69, v95
    v_cos_f32 v76, v97
    v_sin_f32 v77, v97
    v_pk_mul_f32 v[68:69], v[68:69], v[94:95] op_sel_hi:[1,0]
    v_pk_mul_f32 v[76:77], v[76:77], v[96:97] op_sel_hi:[1,0]
    v_pk_mul_f32 v[92:93], v[76:77], v[76:77] op_sel:[1,1] op_sel_hi:[0,1]
    v_pk_fma_f32 v[78:79], v[76:77], v[76:77], v[92:93] op_sel:[0,0,0] op_sel_hi:[0,1,1] neg_lo:[0,0,1]
    v_pk_mul_f32 v[94:95], v[68:69], v[68:69] op_sel:[1,1] op_sel_hi:[0,1]
    v_pk_fma_f32 v[70:71], v[68:69], v[68:69], v[94:95] op_sel:[0,0,0] op_sel_hi:[0,1,1] neg_lo:[0,0,1]
    v_pk_mul_f32 v[92:93], v[78:79], v[78:79] op_sel:[1,1] op_sel_hi:[0,1]
    v_pk_fma_f32 v[80:81], v[78:79], v[78:79], v[92:93] op_sel:[0,0,0] op_sel_hi:[0,1,1] neg_lo:[0,0,1]
    v_pk_mul_f32 v[94:95], v[70:71], v[70:71] op_sel:[1,1] op_sel_hi:[0,1]
    v_pk_fma_f32 v[72:73], v[70:71], v[70:71], v[94:95] op_sel:[0,0,0] op_sel_hi:[0,1,1] neg_lo:[0,0,1]
    v_pk_mul_f32 v[92:93], v[80:81], v[80:81] op_sel:[1,1] op_sel_hi:[0,1]
    v_pk_fma_f32 v[82:83], v[80:81], v[80:81], v[92:93] op_sel:[0,0,0] op_sel_hi:[0,1,1] neg_lo:[0,0,1]
    v_pk_mul_f32 v[94:95], v[72:73], v[72:73] op_sel:[1,1] op_sel_hi:[0,1]
    v_pk_fma_f32 v[74:75], v[72:73], v[72:73], v[94:95] op_sel:[0,0,0] op_sel_hi:[0,1,1] neg_lo:[0,0,1]
    v_pk_mul_f32 v[92:93], v[82:83], v[82:83] op_sel:[1,1] op_sel_hi:[0,1]
    v_pk_fma_f32 v[84:85], v[82:83], v[82:83], v[92:93] op_sel:[0,0,0] op_sel_hi:[0,1,1] neg_lo:[0,0,1]
    v_pk_mul_f32 v[94:95], v[66:67], v[76:77] op_sel:[1,1] op_sel_hi:[1,0]
    v_pk_fma_f32 v[86:87], v[66:67], v[76:77], v[94:95] op_sel:[0,0,0] op_sel_hi:[0,1,1] neg_lo:[0,0,1] neg_hi:[1,0,1]
    v_mov_b32_dpp v80, v78 row_ror:8 row_mask:0xf bank_mask:0x3
    v_mov_b32_dpp v81, v79 row_ror:8 row_mask:0xf bank_mask:0x3
    v_mov_b32_dpp v82, v84 row_ror:8 row_mask:0xf bank_mask:0x3
    v_mov_b32_dpp v83, v85 row_ror:8 row_mask:0xf bank_mask:0x3
    v_pk_mul_f32 v[92:93], v[66:67], v[80:81] op_sel:[1,1] op_sel_hi:[1,0]
    v_pk_fma_f32 v[88:89], v[66:67], v[80:81], v[92:93] op_sel:[0,0,0] op_sel_hi:[0,1,1] neg_lo:[0,0,1] neg_hi:[1,0,1]
    v_pk_mul_f32 v[94:95], v[66:67], v[82:83] op_sel:[1,1] op_sel_hi:[1,0]
    v_pk_fma_f32 v[90:91], v[66:67], v[82:83], v[94:95] op_sel:[0,0,0] op_sel_hi:[0,1,1] neg_lo:[0,0,1] neg_hi:[1,0,1]
    v_mfma_f32_16x16x4_f32 v[48:51], v86, v68, v[48:51]
    v_mfma_f32_16x16x4_f32 v[52:55], v88, v70, v[52:55]
    v_mfma_f32_16x16x4_f32 v[56:59], v88, v72, v[56:59]
    v_mfma_f32_16x16x4_f32 v[60:63], v90, v74, v[60:63]
    v_mfma_f32_16x16x4_f32 v[48:51], v87, v69, v[48:51]
    v_mfma_f32_16x16x4_f32 v[52:55], v89, v71, v[52:55]
    v_mfma_f32_16x16x4_f32 v[56:59], v89, v73, v[56:59]
    v_mfma_f32_16x16x4_f32 v[60:63], v91, v75, v[60:63]
    v_mov_b64_dpp v[64:65], v[28:29] row_newbcast:14 row_mask:0xf bank_mask:0xf
    v_mov_b64_dpp v[66:67], v[30:31] row_newbcast:14 row_mask:0xf bank_mask:0xf
    v_pk_mul_f32 v[94:95], v[64:65], v[26:27] op_sel_hi:[1,0]
    v_pk_mul_f32 v[96:97], v[64:65], v[26:27] op_sel:[0,1] op_sel_hi:[1,1]
    v_fract_f32 v95, v95
    v_fract_f32 v97, v97
    v_exp_f32 v94, v94
    v_exp_f32 v96, v96
    v_cos_f32 v68, v95
    v_sin_f32 v69, v95
    v_cos_f32 v76, v97
    v_sin_f32 v77, v97
    v_pk_mul_f32 v[68:69], v[68:69], v[94:95] op_sel_hi:[1,0]
    v_pk_mul_f32 v[76:77], v[76:77], v[96:97] op_sel_hi:[1,0]
    v_pk_mul_f32 v[92:93], v[76:77], v[76:77] op_sel:[1,1] op_sel_hi:[0,1]
    v_pk_fma_f32 v[78:79], v[76:77], v[76:77], v[92:93] op_sel:[0,0,0] op_sel_hi:[0,1,1] neg_lo:[0,0,1]
    v_pk_mul_f32 v[94:95], v[68:69], v[68:69] op_sel:[1,1] op_sel_hi:[0,1]
    v_pk_fma_f32 v[70:71], v[68:69], v[68:69], v[94:95] op_sel:[0,0,0] op_sel_hi:[0,1,1] neg_lo:[0,0,1]
    v_pk_mul_f32 v[92:93], v[78:79], v[78:79] op_sel:[1,1] op_sel_hi:[0,1]
    v_pk_fma_f32 v[80:81], v[78:79], v[78:79], v[92:93] op_sel:[0,0,0] op_sel_hi:[0,1,1] neg_lo:[0,0,1]
    v_pk_mul_f32 v[94:95], v[70:71], v[70:71] op_sel:[1,1] op_sel_hi:[0,1]
    v_pk_fma_f32 v[72:73], v[70:71], v[70:71], v[94:95] op_sel:[0,0,0] op_sel_hi:[0,1,1] neg_lo:[0,0,1]
    v_pk_mul_f32 v[92:93], v[80:81], v[80:81] op_sel:[1,1] op_sel_hi:[0,1]
    v_pk_fma_f32 v[82:83], v[80:81], v[80:81], v[92:93] op_sel:[0,0,0] op_sel_hi:[0,1,1] neg_lo:[0,0,1]
    v_pk_mul_f32 v[94:95], v[72:73], v[72:73] op_sel:[1,1] op_sel_hi:[0,1]
    v_pk_fma_f32 v[74:75], v[72:73], v[72:73], v[94:95] op_sel:[0,0,0] op_sel_hi:[0,1,1] neg_lo:[0,0,1]
    v_pk_mul_f32 v[92:93], v[82:83], v[82:83] op_sel:[1,1] op_sel_hi:[0,1]
    v_pk_fma_f32 v[84:85], v[82:83], v[82:83], v[92:93] op_sel:[0,0,0] op_sel_hi:[0,1,1] neg_lo:[0,0,1]
    v_pk_mul_f32 v[94:95], v[66:67], v[76:77] op_sel:[1,1] op_sel_hi:[1,0]
    v_pk_fma_f32 v[86:87], v[66:67], v[76:77], v[94:95] op_sel:[0,0,0] op_sel_hi:[0,1,1] neg_lo:[0,0,1] neg_hi:[1,0,1]
    v_mov_b32_dpp v80, v78 row_ror:8 row_mask:0xf bank_mask:0x3
    v_mov_b32_dpp v81, v79 row_ror:8 row_mask:0xf bank_mask:0x3
    v_mov_b32_dpp v82, v84 row_ror:8 row_mask:0xf bank_mask:0x3
    v_mov_b32_dpp v83, v85 row_ror:8 row_mask:0xf bank_mask:0x3
    v_pk_mul_f32 v[92:93], v[66:67], v[80:81] op_sel:[1,1] op_sel_hi:[1,0]
    v_pk_fma_f32 v[88:89], v[66:67], v[80:81], v[92:93] op_sel:[0,0,0] op_sel_hi:[0,1,1] neg_lo:[0,0,1] neg_hi:[1,0,1]
    v_pk_mul_f32 v[94:95], v[66:67], v[82:83] op_sel:[1,1] op_sel_hi:[1,0]
    v_pk_fma_f32 v[90:91], v[66:67], v[82:83], v[94:95] op_sel:[0,0,0] op_sel_hi:[0,1,1] neg_lo:[0,0,1] neg_hi:[1,0,1]
    v_mfma_f32_16x16x4_f32 v[48:51], v86, v68, v[48:51]
    v_mfma_f32_16x16x4_f32 v[52:55], v88, v70, v[52:55]
    v_mfma_f32_16x16x4_f32 v[56:59], v88, v72, v[56:59]
    v_mfma_f32_16x16x4_f32 v[60:63], v90, v74, v[60:63]
    v_mfma_f32_16x16x4_f32 v[48:51], v87, v69, v[48:51]
    v_mfma_f32_16x16x4_f32 v[52:55], v89, v71, v[52:55]
    v_mfma_f32_16x16x4_f32 v[56:59], v89, v73, v[56:59]
    v_mfma_f32_16x16x4_f32 v[60:63], v91, v75, v[60:63]
    v_mov_b64_dpp v[64:65], v[28:29] row_newbcast:15 row_mask:0xf bank_mask:0xf
    v_mov_b64_dpp v[66:67], v[30:31] row_newbcast:15 row_mask:0xf bank_mask:0xf
    v_pk_mul_f32 v[94:95], v[64:65], v[26:27] op_sel_hi:[1,0]
    v_pk_mul_f32 v[96:97], v[64:65], v[26:27] op_sel:[0,1] op_sel_hi:[1,1]
    v_fract_f32 v95, v95
    v_fract_f32 v97, v97
    v_exp_f32 v94, v94
    v_exp_f32 v96, v96
    v_cos_f32 v68, v95
    v_sin_f32 v69, v95
    v_cos_f32 v76, v97
    v_sin_f32 v77, v97
    v_pk_mul_f32 v[68:69], v[68:69], v[94:95] op_sel_hi:[1,0]
    v_pk_mul_f32 v[76:77], v[76:77], v[96:97] op_sel_hi:[1,0]
    v_pk_mul_f32 v[92:93], v[76:77], v[76:77] op_sel:[1,1] op_sel_hi:[0,1]
    v_pk_fma_f32 v[78:79], v[76:77], v[76:77], v[92:93] op_sel:[0,0,0] op_sel_hi:[0,1,1] neg_lo:[0,0,1]
    v_pk_mul_f32 v[94:95], v[68:69], v[68:69] op_sel:[1,1] op_sel_hi:[0,1]
    v_pk_fma_f32 v[70:71], v[68:69], v[68:69], v[94:95] op_sel:[0,0,0] op_sel_hi:[0,1,1] neg_lo:[0,0,1]
    v_pk_mul_f32 v[92:93], v[78:79], v[78:79] op_sel:[1,1] op_sel_hi:[0,1]
    v_pk_fma_f32 v[80:81], v[78:79], v[78:79], v[92:93] op_sel:[0,0,0] op_sel_hi:[0,1,1] neg_lo:[0,0,1]
    v_pk_mul_f32 v[94:95], v[70:71], v[70:71] op_sel:[1,1] op_sel_hi:[0,1]
    v_pk_fma_f32 v[72:73], v[70:71], v[70:71], v[94:95] op_sel:[0,0,0] op_sel_hi:[0,1,1] neg_lo:[0,0,1]
    v_pk_mul_f32 v[92:93], v[80:81], v[80:81] op_sel:[1,1] op_sel_hi:[0,1]
    v_pk_fma_f32 v[82:83], v[80:81], v[80:81], v[92:93] op_sel:[0,0,0] op_sel_hi:[0,1,1] neg_lo:[0,0,1]
    v_pk_mul_f32 v[94:95], v[72:73], v[72:73] op_sel:[1,1] op_sel_hi:[0,1]
    v_pk_fma_f32 v[74:75], v[72:73], v[72:73], v[94:95] op_sel:[0,0,0] op_sel_hi:[0,1,1] neg_lo:[0,0,1]
    v_pk_mul_f32 v[92:93], v[82:83], v[82:83] op_sel:[1,1] op_sel_hi:[0,1]
    v_pk_fma_f32 v[84:85], v[82:83], v[82:83], v[92:93] op_sel:[0,0,0] op_sel_hi:[0,1,1] neg_lo:[0,0,1]
    v_pk_mul_f32 v[94:95], v[66:67], v[76:77] op_sel:[1,1] op_sel_hi:[1,0]
    v_pk_fma_f32 v[86:87], v[66:67], v[76:77], v[94:95] op_sel:[0,0,0] op_sel_hi:[0,1,1] neg_lo:[0,0,1] neg_hi:[1,0,1]
    v_mov_b32_dpp v80, v78 row_ror:8 row_mask:0xf bank_mask:0x3
    v_mov_b32_dpp v81, v79 row_ror:8 row_mask:0xf bank_mask:0x3
    v_mov_b32_dpp v82, v84 row_ror:8 row_mask:0xf bank_mask:0x3
    v_mov_b32_dpp v83, v85 row_ror:8 row_mask:0xf bank_mask:0x3
    v_pk_mul_f32 v[92:93], v[66:67], v[80:81] op_sel:[1,1] op_sel_hi:[1,0]
    v_pk_fma_f32 v[88:89], v[66:67], v[80:81], v[92:93] op_sel:[0,0,0] op_sel_hi:[0,1,1] neg_lo:[0,0,1] neg_hi:[1,0,1]
    v_pk_mul_f32 v[94:95], v[66:67], v[82:83] op_sel:[1,1] op_sel_hi:[1,0]
    v_pk_fma_f32 v[90:91], v[66:67], v[82:83], v[94:95] op_sel:[0,0,0] op_sel_hi:[0,1,1] neg_lo:[0,0,1] neg_hi:[1,0,1]
    v_mfma_f32_16x16x4_f32 v[48:51], v86, v68, v[48:51]
    v_mfma_f32_16x16x4_f32 v[52:55], v88, v70, v[52:55]
    v_mfma_f32_16x16x4_f32 v[56:59], v88, v72, v[56:59]
    v_mfma_f32_16x16x4_f32 v[60:63], v90, v74, v[60:63]
    v_mfma_f32_16x16x4_f32 v[48:51], v87, v69, v[48:51]
    v_mfma_f32_16x16x4_f32 v[52:55], v89, v71, v[52:55]
    v_mfma_f32_16x16x4_f32 v[56:59], v89, v73, v[56:59]
    v_mfma_f32_16x16x4_f32 v[60:63], v91, v75, v[60:63]
    v_mov_b64 v[28:29], v[32:33]
    v_mov_b64 v[30:31], v[34:35]
    s_add_u32 s25, s25, 1
    s_cmp_lt_u32 s25, 2
    s_cbranch_scc1 ss_kg
    s_cmp_lg_u32 s28, 0
    s_cbranch_scc1 ss_nostage
    s_waitcnt vmcnt(0)
    v_mov_b32 v36, 0x05040100
    v_mov_b32 v37, 0x07060302
    v_lshlrev_b32 v6, 4, v0
    v_add_u32 v7, 65536, v6
    v_perm_b32 v40, v212, v208, v36
    v_perm_b32 v41, v220, v216, v36
    v_perm_b32 v42, v228, v224, v36
    v_perm_b32 v43, v236, v232, v36
    ds_write_b128 v6, v[40:43] offset:512
    v_perm_b32 v44, v212, v208, v37
    v_perm_b32 v45, v220, v216, v37
    v_perm_b32 v46, v228, v224, v37
    v_perm_b32 v47, v236, v232, v37
    ds_write_b128 v6, v[44:47] offset:16896
    v_perm_b32 v40, v213, v209, v36
    v_perm_b32 v41, v221, v217, v36
    v_perm_b32 v42, v229, v225, v36
    v_perm_b32 v43, v237, v233, v36
    ds_write_b128 v6, v[40:43] offset:33280
    v_perm_b32 v44, v213, v209, v37
    v_perm_b32 v45, v221, v217, v37
    v_perm_b32 v46, v229, v225, v37
    v_perm_b32 v47, v237, v233, v37
    ds_write_b128 v6, v[44:47] offset:49664
    v_perm_b32 v40, v214, v210, v36
    v_perm_b32 v41, v222, v218, v36
    v_perm_b32 v42, v230, v226, v36
    v_perm_b32 v43, v238, v234, v36
    ds_write_b128 v7, v[40:43] offset:512
    v_perm_b32 v44, v214, v210, v37
    v_perm_b32 v45, v222, v218, v37
    v_perm_b32 v46, v230, v226, v37
    v_perm_b32 v47, v238, v234, v37
    ds_write_b128 v7, v[44:47] offset:16896
    v_perm_b32 v40, v215, v211, v36
    v_perm_b32 v41, v223, v219, v36
    v_perm_b32 v42, v231, v227, v36
    v_perm_b32 v43, v239, v235, v36
    ds_write_b128 v7, v[40:43] offset:33280
    v_perm_b32 v44, v215, v211, v37
    v_perm_b32 v45, v223, v219, v37
    v_perm_b32 v46, v231, v227, v37
    v_perm_b32 v47, v239, v235, v37
    ds_write_b128 v7, v[44:47] offset:49664
ss_nostage:
    s_nop 11
    v_lshlrev_b32 v5, 8, v3
    v_lshl_add_u32 v5, v2, 2, v5
    v_add_u32 v5, v5, v4
    ds_write_b32 v5, v48 offset:4608
    ds_write_b32 v5, v49 offset:4672
    ds_write_b32 v5, v50 offset:4736
    ds_write_b32 v5, v51 offset:4800
    s_mov_b32 exec_hi, 0
    ds_write_b32 v5, v52 offset:5632
    ds_write_b32 v5, v53 offset:5696
    ds_write_b32 v5, v54 offset:5760
    ds_write_b32 v5, v55 offset:5824
    s_not_b64 exec, exec
    ds_write_b32 v5, v56 offset:5632
    ds_write_b32 v5, v57 offset:5696
    ds_write_b32 v5, v58 offset:5760
    ds_write_b32 v5, v59 offset:5824
    ds_write_b32 v5, v60 offset:6144
    ds_write_b32 v5, v61 offset:6208
    ds_write_b32 v5, v62 offset:6272
    ds_write_b32 v5, v63 offset:6336
    s_mov_b64 exec, 3
    v_cmp_eq_u32 vcc, 0, v2
    s_nop 1
    v_cndmask_b32 v6, 0, v60, vcc
    ds_write_b32 v5, v6 offset:7168
    s_mov_b64 exec, -1
    s_waitcnt lgkmcnt(0)
    v_lshlrev_b32 v7, 1, v1
    v_sub_u32 v7, 2065, v7
    v_lshl_add_u32 v64, v1, 2, v4
    v_mov_b32 v65, 641
    s_mov_b32 s25, 9
    s_mov_b32 s22, 256
    s_mov_b32 s23, 2048
ss_exp:
    v_subrev_u32 v66, 0, v7
    v_cvt_f32_u32 v72, v66
    v_cmp_gt_u32 vcc, s22, v66
    v_cvt_pk_bf16_f32 v72, v72, 0
    v_subrev_u32 v72, 0x4280, v72
    v_cndmask_b32 v72, v72, v66, vcc
    v_cmp_gt_u32 vcc, s23, v66
    s_nop 1
    v_cndmask_b32 v72, v65, v72, vcc
    v_lshl_add_u32 v72, v72, 2, v4
    v_subrev_u32 v67, 1, v7
    v_cvt_f32_u32 v73, v67
    v_cmp_gt_u32 vcc, s22, v67
    v_cvt_pk_bf16_f32 v73, v73, 0
    v_subrev_u32 v73, 0x4280, v73
    v_cndmask_b32 v73, v73, v67, vcc
    v_cmp_gt_u32 vcc, s23, v67
    ds_read_b32 v78, v72 offset:4608
    s_nop 0
    v_cndmask_b32 v73, v65, v73, vcc
    v_lshl_add_u32 v73, v73, 2, v4
    v_subrev_u32 v68, 2, v7
    v_cvt_f32_u32 v74, v68
    v_cmp_gt_u32 vcc, s22, v68
    v_cvt_pk_bf16_f32 v74, v74, 0
    v_subrev_u32 v74, 0x4280, v74
    v_cndmask_b32 v74, v74, v68, vcc
    v_cmp_gt_u32 vcc, s23, v68
    ds_read_b32 v79, v73 offset:4608
    s_nop 0
    v_cndmask_b32 v74, v65, v74, vcc
    v_lshl_add_u32 v74, v74, 2, v4
    v_subrev_u32 v69, 128, v7
    v_cvt_f32_u32 v75, v69
    v_cmp_gt_u32 vcc, s22, v69
    v_cvt_pk_bf16_f32 v75, v75, 0
    v_subrev_u32 v75, 0x4280, v75
    v_cndmask_b32 v75, v75, v69, vcc
    v_cmp_gt_u32 vcc, s23, v69
    ds_read_b32 v80, v74 offset:4608
    s_nop 0
    v_cndmask_b32 v75, v65, v75, vcc
    v_lshl_add_u32 v75, v75, 2, v4
    v_subrev_u32 v70, 129, v7
    v_cvt_f32_u32 v76, v70
    v_cmp_gt_u32 vcc, s22, v70
    v_cvt_pk_bf16_f32 v76, v76, 0
    v_subrev_u32 v76, 0x4280, v76
    v_cndmask_b32 v76, v76, v70, vcc
    v_cmp_gt_u32 vcc, s23, v70
    ds_read_b32 v81, v75 offset:4608
    s_nop 0
    v_cndmask_b32 v76, v65, v76, vcc
    v_lshl_add_u32 v76, v76, 2, v4
    v_subrev_u32 v71, 130, v7
    v_cvt_f32_u32 v77, v71
    v_cmp_gt_u32 vcc, s22, v71
    v_cvt_pk_bf16_f32 v77, v77, 0
    v_subrev_u32 v77, 0x4280, v77
    v_cndmask_b32 v77, v77, v71, vcc
    v_cmp_gt_u32 vcc, s23, v71
    ds_read_b32 v82, v76 offset:4608
    s_nop 0
    v_cndmask_b32 v77, v65, v77, vcc
    v_lshl_add_u32 v77, v77, 2, v4
    ds_read_b32 v83, v77 offset:4608
    v_subrev_u32 v7, 256, v7
    s_sub_u32 s25, s25, 1
    s_waitcnt lgkmcnt(0)
    v_cvt_pk_bf16_f32 v84, v79, v80
    v_cvt_pk_bf16_f32 v85, v78, v79
    v_cvt_pk_bf16_f32 v86, v82, v83
    v_cvt_pk_bf16_f32 v87, v81, v82
    ds_write_b32 v64, v84 offset:7424
    ds_write_b32 v64, v85 offset:11776
    s_cmp_eq_u32 s25, 0
    s_cbranch_scc1 ss_expx
    ds_write_b32 v64, v86 offset:7680
    ds_write_b32 v64, v87 offset:12032
    v_add_u32 v64, 512, v64
    s_nop 1
    s_branch ss_exp
ss_expx:
    s_waitcnt lgkmcnt(0)
    s_barrier
    v_and_b32 v5, 1, v2
    v_mul_u32_u24 v36, 4352, v5
    v_sub_u32 v5, v5, v2
    v_lshl_add_u32 v5, v3, 3, v5
    v_lshl_add_u32 v36, v5, 1, v36
    v_add_u32 v36, 11072, v36
    v_add_u32 v36, v36, v4
    v_subrev_u32 v37, 512, v36
    v_subrev_u32 v38, 1024, v36
    v_subrev_u32 v39, 1536, v36
    v_subrev_u32 v40, 2048, v36
    v_subrev_u32 v41, 2560, v36
    v_subrev_u32 v42, 3072, v36
    v_subrev_u32 v43, 3584, v36
    v_lshlrev_b32 v44, 5, v2
    v_lshl_add_u32 v44, v3, 4, v44
    v_add_u32 v44, 32, v44
    v_add_u32 v44, v44, v4
    ds_read_b128 v[112:115], v44 offset:448
    ds_read2_b32 v[80:81], v36 offset0:112 offset1:113
    ds_read2_b32 v[82:83], v36 offset0:114 offset1:115
    ds_read_b128 v[116:119], v44 offset:960
    ds_read2_b32 v[84:85], v37 offset0:112 offset1:113
    ds_read2_b32 v[86:87], v37 offset0:114 offset1:115
    ds_read_b128 v[120:123], v44 offset:1472
    ds_read2_b32 v[88:89], v38 offset0:112 offset1:113
    ds_read2_b32 v[90:91], v38 offset0:114 offset1:115
    ds_read_b128 v[124:127], v44 offset:1984
    ds_read2_b32 v[92:93], v39 offset0:112 offset1:113
    ds_read2_b32 v[94:95], v39 offset0:114 offset1:115
    ds_read_b128 v[128:131], v44 offset:2496
    ds_read2_b32 v[96:97], v40 offset0:112 offset1:113
    ds_read2_b32 v[98:99], v40 offset0:114 offset1:115
    ds_read_b128 v[132:135], v44 offset:3008
    ds_read2_b32 v[100:101], v41 offset0:112 offset1:113
    ds_read2_b32 v[102:103], v41 offset0:114 offset1:115
    ds_read_b128 v[136:139], v44 offset:3520
    ds_read2_b32 v[104:105], v42 offset0:112 offset1:113
    ds_read2_b32 v[106:107], v42 offset0:114 offset1:115
    ds_read_b128 v[140:143], v44 offset:4032
    ds_read2_b32 v[108:109], v43 offset0:112 offset1:113
    ds_read2_b32 v[110:111], v43 offset0:114 offset1:115
    s_waitcnt lgkmcnt(0)
    v_mfma_f32_16x16x32_bf16 v[48:51], v[80:83], v[112:115], 0
    ds_read_b128 v[176:179], v44 offset:384
    v_mfma_f32_16x16x32_bf16 v[52:55], v[80:83], v[116:119], 0
    ds_read2_b32 v[144:145], v36 offset0:96 offset1:97
    v_mfma_f32_16x16x32_bf16 v[56:59], v[80:83], v[120:123], 0
    ds_read2_b32 v[146:147], v36 offset0:98 offset1:99
    v_mfma_f32_16x16x32_bf16 v[60:63], v[80:83], v[124:127], 0
    ds_read_b128 v[180:183], v44 offset:896
    v_mfma_f32_16x16x32_bf16 v[64:67], v[80:83], v[128:131], 0
    ds_read2_b32 v[148:149], v37 offset0:96 offset1:97
    v_mfma_f32_16x16x32_bf16 v[68:71], v[80:83], v[132:135], 0
    ds_read2_b32 v[150:151], v37 offset0:98 offset1:99
    v_mfma_f32_16x16x32_bf16 v[72:75], v[80:83], v[136:139], 0
    ds_read_b128 v[184:187], v44 offset:1408
    v_mfma_f32_16x16x32_bf16 v[76:79], v[80:83], v[140:143], 0
    ds_read2_b32 v[152:153], v38 offset0:96 offset1:97
    v_mfma_f32_16x16x32_bf16 v[52:55], v[84:87], v[112:115], v[52:55]
    ds_read2_b32 v[154:155], v38 offset0:98 offset1:99
    v_mfma_f32_16x16x32_bf16 v[56:59], v[84:87], v[116:119], v[56:59]
    ds_read_b128 v[188:191], v44 offset:1920
    v_mfma_f32_16x16x32_bf16 v[60:63], v[84:87], v[120:123], v[60:63]
    ds_read2_b32 v[156:157], v39 offset0:96 offset1:97
    v_mfma_f32_16x16x32_bf16 v[64:67], v[84:87], v[124:127], v[64:67]
    ds_read2_b32 v[158:159], v39 offset0:98 offset1:99
    v_mfma_f32_16x16x32_bf16 v[68:71], v[84:87], v[128:131], v[68:71]
    ds_read_b128 v[192:195], v44 offset:2432
    v_mfma_f32_16x16x32_bf16 v[72:75], v[84:87], v[132:135], v[72:75]
    ds_read2_b32 v[160:161], v40 offset0:96 offset1:97
    v_mfma_f32_16x16x32_bf16 v[76:79], v[84:87], v[136:139], v[76:79]
    ds_read2_b32 v[162:163], v40 offset0:98 offset1:99
    v_mfma_f32_16x16x32_bf16 v[56:59], v[88:91], v[112:115], v[56:59]
    ds_read_b128 v[196:199], v44 offset:2944
    v_mfma_f32_16x16x32_bf16 v[60:63], v[88:91], v[116:119], v[60:63]
    ds_read2_b32 v[164:165], v41 offset0:96 offset1:97
    v_mfma_f32_16x16x32_bf16 v[64:67], v[88:91], v[120:123], v[64:67]
    ds_read2_b32 v[166:167], v41 offset0:98 offset1:99
    v_mfma_f32_16x16x32_bf16 v[68:71], v[88:91], v[124:127], v[68:71]
    ds_read_b128 v[200:203], v44 offset:3456
    v_mfma_f32_16x16x32_bf16 v[72:75], v[88:91], v[128:131], v[72:75]
    ds_read2_b32 v[168:169], v42 offset0:96 offset1:97
    v_mfma_f32_16x16x32_bf16 v[76:79], v[88:91], v[132:135], v[76:79]
    ds_read2_b32 v[170:171], v42 offset0:98 offset1:99
    v_mfma_f32_16x16x32_bf16 v[60:63], v[92:95], v[112:115], v[60:63]
    ds_read_b128 v[204:207], v44 offset:3968
    v_mfma_f32_16x16x32_bf16 v[64:67], v[92:95], v[116:119], v[64:67]
    ds_read2_b32 v[172:173], v43 offset0:96 offset1:97
    v_mfma_f32_16x16x32_bf16 v[68:71], v[92:95], v[120:123], v[68:71]
    ds_read2_b32 v[174:175], v43 offset0:98 offset1:99
    v_mfma_f32_16x16x32_bf16 v[72:75], v[92:95], v[124:127], v[72:75]
    v_mfma_f32_16x16x32_bf16 v[76:79], v[92:95], v[128:131], v[76:79]
    v_mfma_f32_16x16x32_bf16 v[64:67], v[96:99], v[112:115], v[64:67]
    v_mfma_f32_16x16x32_bf16 v[68:71], v[96:99], v[116:119], v[68:71]
    v_mfma_f32_16x16x32_bf16 v[72:75], v[96:99], v[120:123], v[72:75]
    v_mfma_f32_16x16x32_bf16 v[76:79], v[96:99], v[124:127], v[76:79]
    v_mfma_f32_16x16x32_bf16 v[68:71], v[100:103], v[112:115], v[68:71]
    v_mfma_f32_16x16x32_bf16 v[72:75], v[100:103], v[116:119], v[72:75]
    v_mfma_f32_16x16x32_bf16 v[76:79], v[100:103], v[120:123], v[76:79]
    v_mfma_f32_16x16x32_bf16 v[72:75], v[104:107], v[112:115], v[72:75]
    v_mfma_f32_16x16x32_bf16 v[76:79], v[104:107], v[116:119], v[76:79]
    v_mfma_f32_16x16x32_bf16 v[76:79], v[108:111], v[112:115], v[76:79]
    s_waitcnt lgkmcnt(0)
    v_mfma_f32_16x16x32_bf16 v[48:51], v[144:147], v[176:179], v[48:51]
    ds_read_b128 v[112:115], v44 offset:320
    v_mfma_f32_16x16x32_bf16 v[52:55], v[144:147], v[180:183], v[52:55]
    ds_read2_b32 v[80:81], v36 offset0:80 offset1:81
    v_mfma_f32_16x16x32_bf16 v[56:59], v[144:147], v[184:187], v[56:59]
    ds_read2_b32 v[82:83], v36 offset0:82 offset1:83
    v_mfma_f32_16x16x32_bf16 v[60:63], v[144:147], v[188:191], v[60:63]
    ds_read_b128 v[116:119], v44 offset:832
    v_mfma_f32_16x16x32_bf16 v[64:67], v[144:147], v[192:195], v[64:67]
    ds_read2_b32 v[84:85], v37 offset0:80 offset1:81
    v_mfma_f32_16x16x32_bf16 v[68:71], v[144:147], v[196:199], v[68:71]
    ds_read2_b32 v[86:87], v37 offset0:82 offset1:83
    v_mfma_f32_16x16x32_bf16 v[72:75], v[144:147], v[200:203], v[72:75]
    ds_read_b128 v[120:123], v44 offset:1344
    v_mfma_f32_16x16x32_bf16 v[76:79], v[144:147], v[204:207], v[76:79]
    ds_read2_b32 v[88:89], v38 offset0:80 offset1:81
    v_mfma_f32_16x16x32_bf16 v[52:55], v[148:151], v[176:179], v[52:55]
    ds_read2_b32 v[90:91], v38 offset0:82 offset1:83
    v_mfma_f32_16x16x32_bf16 v[56:59], v[148:151], v[180:183], v[56:59]
    ds_read_b128 v[124:127], v44 offset:1856
    v_mfma_f32_16x16x32_bf16 v[60:63], v[148:151], v[184:187], v[60:63]
    ds_read2_b32 v[92:93], v39 offset0:80 offset1:81
    v_mfma_f32_16x16x32_bf16 v[64:67], v[148:151], v[188:191], v[64:67]
    ds_read2_b32 v[94:95], v39 offset0:82 offset1:83
    v_mfma_f32_16x16x32_bf16 v[68:71], v[148:151], v[192:195], v[68:71]
    ds_read_b128 v[128:131], v44 offset:2368
    v_mfma_f32_16x16x32_bf16 v[72:75], v[148:151], v[196:199], v[72:75]
    ds_read2_b32 v[96:97], v40 offset0:80 offset1:81
    v_mfma_f32_16x16x32_bf16 v[76:79], v[148:151], v[200:203], v[76:79]
    ds_read2_b32 v[98:99], v40 offset0:82 offset1:83
    v_mfma_f32_16x16x32_bf16 v[56:59], v[152:155], v[176:179], v[56:59]
    ds_read_b128 v[132:135], v44 offset:2880
    v_mfma_f32_16x16x32_bf16 v[60:63], v[152:155], v[180:183], v[60:63]
    ds_read2_b32 v[100:101], v41 offset0:80 offset1:81
    v_mfma_f32_16x16x32_bf16 v[64:67], v[152:155], v[184:187], v[64:67]
    ds_read2_b32 v[102:103], v41 offset0:82 offset1:83
    v_mfma_f32_16x16x32_bf16 v[68:71], v[152:155], v[188:191], v[68:71]
    ds_read_b128 v[136:139], v44 offset:3392
    v_mfma_f32_16x16x32_bf16 v[72:75], v[152:155], v[192:195], v[72:75]
    ds_read2_b32 v[104:105], v42 offset0:80 offset1:81
    v_mfma_f32_16x16x32_bf16 v[76:79], v[152:155], v[196:199], v[76:79]
    ds_read2_b32 v[106:107], v42 offset0:82 offset1:83
    v_mfma_f32_16x16x32_bf16 v[60:63], v[156:159], v[176:179], v[60:63]
    ds_read_b128 v[140:143], v44 offset:3904
    v_mfma_f32_16x16x32_bf16 v[64:67], v[156:159], v[180:183], v[64:67]
    ds_read2_b32 v[108:109], v43 offset0:80 offset1:81
    v_mfma_f32_16x16x32_bf16 v[68:71], v[156:159], v[184:187], v[68:71]
    ds_read2_b32 v[110:111], v43 offset0:82 offset1:83
    v_mfma_f32_16x16x32_bf16 v[72:75], v[156:159], v[188:191], v[72:75]
    v_mfma_f32_16x16x32_bf16 v[76:79], v[156:159], v[192:195], v[76:79]
    v_mfma_f32_16x16x32_bf16 v[64:67], v[160:163], v[176:179], v[64:67]
    v_mfma_f32_16x16x32_bf16 v[68:71], v[160:163], v[180:183], v[68:71]
    v_mfma_f32_16x16x32_bf16 v[72:75], v[160:163], v[184:187], v[72:75]
    v_mfma_f32_16x16x32_bf16 v[76:79], v[160:163], v[188:191], v[76:79]
    v_mfma_f32_16x16x32_bf16 v[68:71], v[164:167], v[176:179], v[68:71]
    v_mfma_f32_16x16x32_bf16 v[72:75], v[164:167], v[180:183], v[72:75]
    v_mfma_f32_16x16x32_bf16 v[76:79], v[164:167], v[184:187], v[76:79]
    v_mfma_f32_16x16x32_bf16 v[72:75], v[168:171], v[176:179], v[72:75]
    v_mfma_f32_16x16x32_bf16 v[76:79], v[168:171], v[180:183], v[76:79]
    v_mfma_f32_16x16x32_bf16 v[76:79], v[172:175], v[176:179], v[76:79]
    s_waitcnt lgkmcnt(0)
    v_mfma_f32_16x16x32_bf16 v[48:51], v[80:83], v[112:115], v[48:51]
    ds_read_b128 v[176:179], v44 offset:256
    v_mfma_f32_16x16x32_bf16 v[52:55], v[80:83], v[116:119], v[52:55]
    ds_read2_b32 v[144:145], v36 offset0:64 offset1:65
    v_mfma_f32_16x16x32_bf16 v[56:59], v[80:83], v[120:123], v[56:59]
    ds_read2_b32 v[146:147], v36 offset0:66 offset1:67
    v_mfma_f32_16x16x32_bf16 v[60:63], v[80:83], v[124:127], v[60:63]
    ds_read_b128 v[180:183], v44 offset:768
    v_mfma_f32_16x16x32_bf16 v[64:67], v[80:83], v[128:131], v[64:67]
    ds_read2_b32 v[148:149], v37 offset0:64 offset1:65
    v_mfma_f32_16x16x32_bf16 v[68:71], v[80:83], v[132:135], v[68:71]
    ds_read2_b32 v[150:151], v37 offset0:66 offset1:67
    v_mfma_f32_16x16x32_bf16 v[72:75], v[80:83], v[136:139], v[72:75]
    ds_read_b128 v[184:187], v44 offset:1280
    v_mfma_f32_16x16x32_bf16 v[76:79], v[80:83], v[140:143], v[76:79]
    ds_read2_b32 v[152:153], v38 offset0:64 offset1:65
    v_mfma_f32_16x16x32_bf16 v[52:55], v[84:87], v[112:115], v[52:55]
    ds_read2_b32 v[154:155], v38 offset0:66 offset1:67
    v_mfma_f32_16x16x32_bf16 v[56:59], v[84:87], v[116:119], v[56:59]
    ds_read_b128 v[188:191], v44 offset:1792
    v_mfma_f32_16x16x32_bf16 v[60:63], v[84:87], v[120:123], v[60:63]
    ds_read2_b32 v[156:157], v39 offset0:64 offset1:65
    v_mfma_f32_16x16x32_bf16 v[64:67], v[84:87], v[124:127], v[64:67]
    ds_read2_b32 v[158:159], v39 offset0:66 offset1:67
    v_mfma_f32_16x16x32_bf16 v[68:71], v[84:87], v[128:131], v[68:71]
    ds_read_b128 v[192:195], v44 offset:2304
    v_mfma_f32_16x16x32_bf16 v[72:75], v[84:87], v[132:135], v[72:75]
    ds_read2_b32 v[160:161], v40 offset0:64 offset1:65
    v_mfma_f32_16x16x32_bf16 v[76:79], v[84:87], v[136:139], v[76:79]
    ds_read2_b32 v[162:163], v40 offset0:66 offset1:67
    v_mfma_f32_16x16x32_bf16 v[56:59], v[88:91], v[112:115], v[56:59]
    ds_read_b128 v[196:199], v44 offset:2816
    v_mfma_f32_16x16x32_bf16 v[60:63], v[88:91], v[116:119], v[60:63]
    ds_read2_b32 v[164:165], v41 offset0:64 offset1:65
    v_mfma_f32_16x16x32_bf16 v[64:67], v[88:91], v[120:123], v[64:67]
    ds_read2_b32 v[166:167], v41 offset0:66 offset1:67
    v_mfma_f32_16x16x32_bf16 v[68:71], v[88:91], v[124:127], v[68:71]
    ds_read_b128 v[200:203], v44 offset:3328
    v_mfma_f32_16x16x32_bf16 v[72:75], v[88:91], v[128:131], v[72:75]
    ds_read2_b32 v[168:169], v42 offset0:64 offset1:65
    v_mfma_f32_16x16x32_bf16 v[76:79], v[88:91], v[132:135], v[76:79]
    ds_read2_b32 v[170:171], v42 offset0:66 offset1:67
    v_mfma_f32_16x16x32_bf16 v[60:63], v[92:95], v[112:115], v[60:63]
    ds_read_b128 v[204:207], v44 offset:3840
    v_mfma_f32_16x16x32_bf16 v[64:67], v[92:95], v[116:119], v[64:67]
    ds_read2_b32 v[172:173], v43 offset0:64 offset1:65
    v_mfma_f32_16x16x32_bf16 v[68:71], v[92:95], v[120:123], v[68:71]
    ds_read2_b32 v[174:175], v43 offset0:66 offset1:67
    v_mfma_f32_16x16x32_bf16 v[72:75], v[92:95], v[124:127], v[72:75]
    v_mfma_f32_16x16x32_bf16 v[76:79], v[92:95], v[128:131], v[76:79]
    v_mfma_f32_16x16x32_bf16 v[64:67], v[96:99], v[112:115], v[64:67]
    v_mfma_f32_16x16x32_bf16 v[68:71], v[96:99], v[116:119], v[68:71]
    v_mfma_f32_16x16x32_bf16 v[72:75], v[96:99], v[120:123], v[72:75]
    v_mfma_f32_16x16x32_bf16 v[76:79], v[96:99], v[124:127], v[76:79]
    v_mfma_f32_16x16x32_bf16 v[68:71], v[100:103], v[112:115], v[68:71]
    v_mfma_f32_16x16x32_bf16 v[72:75], v[100:103], v[116:119], v[72:75]
    v_mfma_f32_16x16x32_bf16 v[76:79], v[100:103], v[120:123], v[76:79]
    v_mfma_f32_16x16x32_bf16 v[72:75], v[104:107], v[112:115], v[72:75]
    v_mfma_f32_16x16x32_bf16 v[76:79], v[104:107], v[116:119], v[76:79]
    v_mfma_f32_16x16x32_bf16 v[76:79], v[108:111], v[112:115], v[76:79]
    s_waitcnt lgkmcnt(0)
    v_mfma_f32_16x16x32_bf16 v[48:51], v[144:147], v[176:179], v[48:51]
    ds_read_b128 v[112:115], v44 offset:192
    v_mfma_f32_16x16x32_bf16 v[52:55], v[144:147], v[180:183], v[52:55]
    ds_read2_b32 v[80:81], v36 offset0:48 offset1:49
    v_mfma_f32_16x16x32_bf16 v[56:59], v[144:147], v[184:187], v[56:59]
    ds_read2_b32 v[82:83], v36 offset0:50 offset1:51
    v_mfma_f32_16x16x32_bf16 v[60:63], v[144:147], v[188:191], v[60:63]
    ds_read_b128 v[116:119], v44 offset:704
    v_mfma_f32_16x16x32_bf16 v[64:67], v[144:147], v[192:195], v[64:67]
    ds_read2_b32 v[84:85], v37 offset0:48 offset1:49
    v_mfma_f32_16x16x32_bf16 v[68:71], v[144:147], v[196:199], v[68:71]
    ds_read2_b32 v[86:87], v37 offset0:50 offset1:51
    v_mfma_f32_16x16x32_bf16 v[72:75], v[144:147], v[200:203], v[72:75]
    ds_read_b128 v[120:123], v44 offset:1216
    v_mfma_f32_16x16x32_bf16 v[76:79], v[144:147], v[204:207], v[76:79]
    ds_read2_b32 v[88:89], v38 offset0:48 offset1:49
    v_mfma_f32_16x16x32_bf16 v[52:55], v[148:151], v[176:179], v[52:55]
    ds_read2_b32 v[90:91], v38 offset0:50 offset1:51
    v_mfma_f32_16x16x32_bf16 v[56:59], v[148:151], v[180:183], v[56:59]
    ds_read_b128 v[124:127], v44 offset:1728
    v_mfma_f32_16x16x32_bf16 v[60:63], v[148:151], v[184:187], v[60:63]
    ds_read2_b32 v[92:93], v39 offset0:48 offset1:49
    v_mfma_f32_16x16x32_bf16 v[64:67], v[148:151], v[188:191], v[64:67]
    ds_read2_b32 v[94:95], v39 offset0:50 offset1:51
    v_mfma_f32_16x16x32_bf16 v[68:71], v[148:151], v[192:195], v[68:71]
    ds_read_b128 v[128:131], v44 offset:2240
    v_mfma_f32_16x16x32_bf16 v[72:75], v[148:151], v[196:199], v[72:75]
    ds_read2_b32 v[96:97], v40 offset0:48 offset1:49
    v_mfma_f32_16x16x32_bf16 v[76:79], v[148:151], v[200:203], v[76:79]
    ds_read2_b32 v[98:99], v40 offset0:50 offset1:51
    v_mfma_f32_16x16x32_bf16 v[56:59], v[152:155], v[176:179], v[56:59]
    ds_read_b128 v[132:135], v44 offset:2752
    v_mfma_f32_16x16x32_bf16 v[60:63], v[152:155], v[180:183], v[60:63]
    ds_read2_b32 v[100:101], v41 offset0:48 offset1:49
    v_mfma_f32_16x16x32_bf16 v[64:67], v[152:155], v[184:187], v[64:67]
    ds_read2_b32 v[102:103], v41 offset0:50 offset1:51
    v_mfma_f32_16x16x32_bf16 v[68:71], v[152:155], v[188:191], v[68:71]
    ds_read_b128 v[136:139], v44 offset:3264
    v_mfma_f32_16x16x32_bf16 v[72:75], v[152:155], v[192:195], v[72:75]
    ds_read2_b32 v[104:105], v42 offset0:48 offset1:49
    v_mfma_f32_16x16x32_bf16 v[76:79], v[152:155], v[196:199], v[76:79]
    ds_read2_b32 v[106:107], v42 offset0:50 offset1:51
    v_mfma_f32_16x16x32_bf16 v[60:63], v[156:159], v[176:179], v[60:63]
    ds_read_b128 v[140:143], v44 offset:3776
    v_mfma_f32_16x16x32_bf16 v[64:67], v[156:159], v[180:183], v[64:67]
    ds_read2_b32 v[108:109], v43 offset0:48 offset1:49
    v_mfma_f32_16x16x32_bf16 v[68:71], v[156:159], v[184:187], v[68:71]
    ds_read2_b32 v[110:111], v43 offset0:50 offset1:51
    v_mfma_f32_16x16x32_bf16 v[72:75], v[156:159], v[188:191], v[72:75]
    v_mfma_f32_16x16x32_bf16 v[76:79], v[156:159], v[192:195], v[76:79]
    v_mfma_f32_16x16x32_bf16 v[64:67], v[160:163], v[176:179], v[64:67]
    v_mfma_f32_16x16x32_bf16 v[68:71], v[160:163], v[180:183], v[68:71]
    v_mfma_f32_16x16x32_bf16 v[72:75], v[160:163], v[184:187], v[72:75]
    v_mfma_f32_16x16x32_bf16 v[76:79], v[160:163], v[188:191], v[76:79]
    v_mfma_f32_16x16x32_bf16 v[68:71], v[164:167], v[176:179], v[68:71]
    v_mfma_f32_16x16x32_bf16 v[72:75], v[164:167], v[180:183], v[72:75]
    v_mfma_f32_16x16x32_bf16 v[76:79], v[164:167], v[184:187], v[76:79]
    v_mfma_f32_16x16x32_bf16 v[72:75], v[168:171], v[176:179], v[72:75]
    v_mfma_f32_16x16x32_bf16 v[76:79], v[168:171], v[180:183], v[76:79]
    v_mfma_f32_16x16x32_bf16 v[76:79], v[172:175], v[176:179], v[76:79]
    s_waitcnt lgkmcnt(0)
    v_mfma_f32_16x16x32_bf16 v[48:51], v[80:83], v[112:115], v[48:51]
    ds_read_b128 v[176:179], v44 offset:128
    v_mfma_f32_16x16x32_bf16 v[52:55], v[80:83], v[116:119], v[52:55]
    ds_read2_b32 v[144:145], v36 offset0:32 offset1:33
    v_mfma_f32_16x16x32_bf16 v[56:59], v[80:83], v[120:123], v[56:59]
    ds_read2_b32 v[146:147], v36 offset0:34 offset1:35
    v_mfma_f32_16x16x32_bf16 v[60:63], v[80:83], v[124:127], v[60:63]
    ds_read_b128 v[180:183], v44 offset:640
    v_mfma_f32_16x16x32_bf16 v[64:67], v[80:83], v[128:131], v[64:67]
    ds_read2_b32 v[148:149], v37 offset0:32 offset1:33
    v_mfma_f32_16x16x32_bf16 v[68:71], v[80:83], v[132:135], v[68:71]
    ds_read2_b32 v[150:151], v37 offset0:34 offset1:35
    v_mfma_f32_16x16x32_bf16 v[72:75], v[80:83], v[136:139], v[72:75]
    ds_read_b128 v[184:187], v44 offset:1152
    v_mfma_f32_16x16x32_bf16 v[76:79], v[80:83], v[140:143], v[76:79]
    ds_read2_b32 v[152:153], v38 offset0:32 offset1:33
    v_mfma_f32_16x16x32_bf16 v[52:55], v[84:87], v[112:115], v[52:55]
    ds_read2_b32 v[154:155], v38 offset0:34 offset1:35
    v_mfma_f32_16x16x32_bf16 v[56:59], v[84:87], v[116:119], v[56:59]
    ds_read_b128 v[188:191], v44 offset:1664
    v_mfma_f32_16x16x32_bf16 v[60:63], v[84:87], v[120:123], v[60:63]
    ds_read2_b32 v[156:157], v39 offset0:32 offset1:33
    v_mfma_f32_16x16x32_bf16 v[64:67], v[84:87], v[124:127], v[64:67]
    ds_read2_b32 v[158:159], v39 offset0:34 offset1:35
    v_mfma_f32_16x16x32_bf16 v[68:71], v[84:87], v[128:131], v[68:71]
    ds_read_b128 v[192:195], v44 offset:2176
    v_mfma_f32_16x16x32_bf16 v[72:75], v[84:87], v[132:135], v[72:75]
    ds_read2_b32 v[160:161], v40 offset0:32 offset1:33
    v_mfma_f32_16x16x32_bf16 v[76:79], v[84:87], v[136:139], v[76:79]
    ds_read2_b32 v[162:163], v40 offset0:34 offset1:35
    v_mfma_f32_16x16x32_bf16 v[56:59], v[88:91], v[112:115], v[56:59]
    ds_read_b128 v[196:199], v44 offset:2688
    v_mfma_f32_16x16x32_bf16 v[60:63], v[88:91], v[116:119], v[60:63]
    ds_read2_b32 v[164:165], v41 offset0:32 offset1:33
    v_mfma_f32_16x16x32_bf16 v[64:67], v[88:91], v[120:123], v[64:67]
    ds_read2_b32 v[166:167], v41 offset0:34 offset1:35
    v_mfma_f32_16x16x32_bf16 v[68:71], v[88:91], v[124:127], v[68:71]
    ds_read_b128 v[200:203], v44 offset:3200
    v_mfma_f32_16x16x32_bf16 v[72:75], v[88:91], v[128:131], v[72:75]
    ds_read2_b32 v[168:169], v42 offset0:32 offset1:33
    v_mfma_f32_16x16x32_bf16 v[76:79], v[88:91], v[132:135], v[76:79]
    ds_read2_b32 v[170:171], v42 offset0:34 offset1:35
    v_mfma_f32_16x16x32_bf16 v[60:63], v[92:95], v[112:115], v[60:63]
    ds_read_b128 v[204:207], v44 offset:3712
    v_mfma_f32_16x16x32_bf16 v[64:67], v[92:95], v[116:119], v[64:67]
    ds_read2_b32 v[172:173], v43 offset0:32 offset1:33
    v_mfma_f32_16x16x32_bf16 v[68:71], v[92:95], v[120:123], v[68:71]
    ds_read2_b32 v[174:175], v43 offset0:34 offset1:35
    v_mfma_f32_16x16x32_bf16 v[72:75], v[92:95], v[124:127], v[72:75]
    v_mfma_f32_16x16x32_bf16 v[76:79], v[92:95], v[128:131], v[76:79]
    v_mfma_f32_16x16x32_bf16 v[64:67], v[96:99], v[112:115], v[64:67]
    v_mfma_f32_16x16x32_bf16 v[68:71], v[96:99], v[116:119], v[68:71]
    v_mfma_f32_16x16x32_bf16 v[72:75], v[96:99], v[120:123], v[72:75]
    v_mfma_f32_16x16x32_bf16 v[76:79], v[96:99], v[124:127], v[76:79]
    v_mfma_f32_16x16x32_bf16 v[68:71], v[100:103], v[112:115], v[68:71]
    v_mfma_f32_16x16x32_bf16 v[72:75], v[100:103], v[116:119], v[72:75]
    v_mfma_f32_16x16x32_bf16 v[76:79], v[100:103], v[120:123], v[76:79]
    v_mfma_f32_16x16x32_bf16 v[72:75], v[104:107], v[112:115], v[72:75]
    v_mfma_f32_16x16x32_bf16 v[76:79], v[104:107], v[116:119], v[76:79]
    v_mfma_f32_16x16x32_bf16 v[76:79], v[108:111], v[112:115], v[76:79]
    s_waitcnt lgkmcnt(0)
    v_mfma_f32_16x16x32_bf16 v[48:51], v[144:147], v[176:179], v[48:51]
    ds_read_b128 v[112:115], v44 offset:64
    v_mfma_f32_16x16x32_bf16 v[52:55], v[144:147], v[180:183], v[52:55]
    ds_read2_b32 v[80:81], v36 offset0:16 offset1:17
    v_mfma_f32_16x16x32_bf16 v[56:59], v[144:147], v[184:187], v[56:59]
    ds_read2_b32 v[82:83], v36 offset0:18 offset1:19
    v_mfma_f32_16x16x32_bf16 v[60:63], v[144:147], v[188:191], v[60:63]
    ds_read_b128 v[116:119], v44 offset:576
    v_mfma_f32_16x16x32_bf16 v[64:67], v[144:147], v[192:195], v[64:67]
    ds_read2_b32 v[84:85], v37 offset0:16 offset1:17
    v_mfma_f32_16x16x32_bf16 v[68:71], v[144:147], v[196:199], v[68:71]
    ds_read2_b32 v[86:87], v37 offset0:18 offset1:19
    v_mfma_f32_16x16x32_bf16 v[72:75], v[144:147], v[200:203], v[72:75]
    ds_read_b128 v[120:123], v44 offset:1088
    v_mfma_f32_16x16x32_bf16 v[76:79], v[144:147], v[204:207], v[76:79]
    ds_read2_b32 v[88:89], v38 offset0:16 offset1:17
    v_mfma_f32_16x16x32_bf16 v[52:55], v[148:151], v[176:179], v[52:55]
    ds_read2_b32 v[90:91], v38 offset0:18 offset1:19
    v_mfma_f32_16x16x32_bf16 v[56:59], v[148:151], v[180:183], v[56:59]
    ds_read_b128 v[124:127], v44 offset:1600
    v_mfma_f32_16x16x32_bf16 v[60:63], v[148:151], v[184:187], v[60:63]
    ds_read2_b32 v[92:93], v39 offset0:16 offset1:17
    v_mfma_f32_16x16x32_bf16 v[64:67], v[148:151], v[188:191], v[64:67]
    ds_read2_b32 v[94:95], v39 offset0:18 offset1:19
    v_mfma_f32_16x16x32_bf16 v[68:71], v[148:151], v[192:195], v[68:71]
    ds_read_b128 v[128:131], v44 offset:2112
    v_mfma_f32_16x16x32_bf16 v[72:75], v[148:151], v[196:199], v[72:75]
    ds_read2_b32 v[96:97], v40 offset0:16 offset1:17
    v_mfma_f32_16x16x32_bf16 v[76:79], v[148:151], v[200:203], v[76:79]
    ds_read2_b32 v[98:99], v40 offset0:18 offset1:19
    v_mfma_f32_16x16x32_bf16 v[56:59], v[152:155], v[176:179], v[56:59]
    ds_read_b128 v[132:135], v44 offset:2624
    v_mfma_f32_16x16x32_bf16 v[60:63], v[152:155], v[180:183], v[60:63]
    ds_read2_b32 v[100:101], v41 offset0:16 offset1:17
    v_mfma_f32_16x16x32_bf16 v[64:67], v[152:155], v[184:187], v[64:67]
    ds_read2_b32 v[102:103], v41 offset0:18 offset1:19
    v_mfma_f32_16x16x32_bf16 v[68:71], v[152:155], v[188:191], v[68:71]
    ds_read_b128 v[136:139], v44 offset:3136
    v_mfma_f32_16x16x32_bf16 v[72:75], v[152:155], v[192:195], v[72:75]
    ds_read2_b32 v[104:105], v42 offset0:16 offset1:17
    v_mfma_f32_16x16x32_bf16 v[76:79], v[152:155], v[196:199], v[76:79]
    ds_read2_b32 v[106:107], v42 offset0:18 offset1:19
    v_mfma_f32_16x16x32_bf16 v[60:63], v[156:159], v[176:179], v[60:63]
    ds_read_b128 v[140:143], v44 offset:3648
    v_mfma_f32_16x16x32_bf16 v[64:67], v[156:159], v[180:183], v[64:67]
    ds_read2_b32 v[108:109], v43 offset0:16 offset1:17
    v_mfma_f32_16x16x32_bf16 v[68:71], v[156:159], v[184:187], v[68:71]
    ds_read2_b32 v[110:111], v43 offset0:18 offset1:19
    v_mfma_f32_16x16x32_bf16 v[72:75], v[156:159], v[188:191], v[72:75]
    v_mfma_f32_16x16x32_bf16 v[76:79], v[156:159], v[192:195], v[76:79]
    v_mfma_f32_16x16x32_bf16 v[64:67], v[160:163], v[176:179], v[64:67]
    v_mfma_f32_16x16x32_bf16 v[68:71], v[160:163], v[180:183], v[68:71]
    v_mfma_f32_16x16x32_bf16 v[72:75], v[160:163], v[184:187], v[72:75]
    v_mfma_f32_16x16x32_bf16 v[76:79], v[160:163], v[188:191], v[76:79]
    v_mfma_f32_16x16x32_bf16 v[68:71], v[164:167], v[176:179], v[68:71]
    v_mfma_f32_16x16x32_bf16 v[72:75], v[164:167], v[180:183], v[72:75]
    v_mfma_f32_16x16x32_bf16 v[76:79], v[164:167], v[184:187], v[76:79]
    v_mfma_f32_16x16x32_bf16 v[72:75], v[168:171], v[176:179], v[72:75]
    v_mfma_f32_16x16x32_bf16 v[76:79], v[168:171], v[180:183], v[76:79]
    v_mfma_f32_16x16x32_bf16 v[76:79], v[172:175], v[176:179], v[76:79]
    s_waitcnt lgkmcnt(0)
    v_mfma_f32_16x16x32_bf16 v[48:51], v[80:83], v[112:115], v[48:51]
    ds_read_b128 v[176:179], v44 offset:0
    v_mfma_f32_16x16x32_bf16 v[52:55], v[80:83], v[116:119], v[52:55]
    ds_read2_b32 v[144:145], v36 offset0:0 offset1:1
    v_mfma_f32_16x16x32_bf16 v[56:59], v[80:83], v[120:123], v[56:59]
    ds_read2_b32 v[146:147], v36 offset0:2 offset1:3
    v_mfma_f32_16x16x32_bf16 v[60:63], v[80:83], v[124:127], v[60:63]
    ds_read_b128 v[180:183], v44 offset:512
    v_mfma_f32_16x16x32_bf16 v[64:67], v[80:83], v[128:131], v[64:67]
    ds_read2_b32 v[148:149], v37 offset0:0 offset1:1
    v_mfma_f32_16x16x32_bf16 v[68:71], v[80:83], v[132:135], v[68:71]
    ds_read2_b32 v[150:151], v37 offset0:2 offset1:3
    v_mfma_f32_16x16x32_bf16 v[72:75], v[80:83], v[136:139], v[72:75]
    ds_read_b128 v[184:187], v44 offset:1024
    v_mfma_f32_16x16x32_bf16 v[76:79], v[80:83], v[140:143], v[76:79]
    ds_read2_b32 v[152:153], v38 offset0:0 offset1:1
    v_mfma_f32_16x16x32_bf16 v[52:55], v[84:87], v[112:115], v[52:55]
    ds_read2_b32 v[154:155], v38 offset0:2 offset1:3
    v_mfma_f32_16x16x32_bf16 v[56:59], v[84:87], v[116:119], v[56:59]
    ds_read_b128 v[188:191], v44 offset:1536
    v_mfma_f32_16x16x32_bf16 v[60:63], v[84:87], v[120:123], v[60:63]
    ds_read2_b32 v[156:157], v39 offset0:0 offset1:1
    v_mfma_f32_16x16x32_bf16 v[64:67], v[84:87], v[124:127], v[64:67]
    ds_read2_b32 v[158:159], v39 offset0:2 offset1:3
    v_mfma_f32_16x16x32_bf16 v[68:71], v[84:87], v[128:131], v[68:71]
    ds_read_b128 v[192:195], v44 offset:2048
    v_mfma_f32_16x16x32_bf16 v[72:75], v[84:87], v[132:135], v[72:75]
    ds_read2_b32 v[160:161], v40 offset0:0 offset1:1
    v_mfma_f32_16x16x32_bf16 v[76:79], v[84:87], v[136:139], v[76:79]
    ds_read2_b32 v[162:163], v40 offset0:2 offset1:3
    v_mfma_f32_16x16x32_bf16 v[56:59], v[88:91], v[112:115], v[56:59]
    ds_read_b128 v[196:199], v44 offset:2560
    v_mfma_f32_16x16x32_bf16 v[60:63], v[88:91], v[116:119], v[60:63]
    ds_read2_b32 v[164:165], v41 offset0:0 offset1:1
    v_mfma_f32_16x16x32_bf16 v[64:67], v[88:91], v[120:123], v[64:67]
    ds_read2_b32 v[166:167], v41 offset0:2 offset1:3
    v_mfma_f32_16x16x32_bf16 v[68:71], v[88:91], v[124:127], v[68:71]
    ds_read_b128 v[200:203], v44 offset:3072
    v_mfma_f32_16x16x32_bf16 v[72:75], v[88:91], v[128:131], v[72:75]
    ds_read2_b32 v[168:169], v42 offset0:0 offset1:1
    v_mfma_f32_16x16x32_bf16 v[76:79], v[88:91], v[132:135], v[76:79]
    ds_read2_b32 v[170:171], v42 offset0:2 offset1:3
    v_mfma_f32_16x16x32_bf16 v[60:63], v[92:95], v[112:115], v[60:63]
    ds_read_b128 v[204:207], v44 offset:3584
    v_mfma_f32_16x16x32_bf16 v[64:67], v[92:95], v[116:119], v[64:67]
    ds_read2_b32 v[172:173], v43 offset0:0 offset1:1
    v_mfma_f32_16x16x32_bf16 v[68:71], v[92:95], v[120:123], v[68:71]
    ds_read2_b32 v[174:175], v43 offset0:2 offset1:3
    v_mfma_f32_16x16x32_bf16 v[72:75], v[92:95], v[124:127], v[72:75]
    v_mfma_f32_16x16x32_bf16 v[76:79], v[92:95], v[128:131], v[76:79]
    v_mfma_f32_16x16x32_bf16 v[64:67], v[96:99], v[112:115], v[64:67]
    v_mfma_f32_16x16x32_bf16 v[68:71], v[96:99], v[116:119], v[68:71]
    v_mfma_f32_16x16x32_bf16 v[72:75], v[96:99], v[120:123], v[72:75]
    v_mfma_f32_16x16x32_bf16 v[76:79], v[96:99], v[124:127], v[76:79]
    v_mfma_f32_16x16x32_bf16 v[68:71], v[100:103], v[112:115], v[68:71]
    v_mfma_f32_16x16x32_bf16 v[72:75], v[100:103], v[116:119], v[72:75]
    v_mfma_f32_16x16x32_bf16 v[76:79], v[100:103], v[120:123], v[76:79]
    v_mfma_f32_16x16x32_bf16 v[72:75], v[104:107], v[112:115], v[72:75]
    v_mfma_f32_16x16x32_bf16 v[76:79], v[104:107], v[116:119], v[76:79]
    v_mfma_f32_16x16x32_bf16 v[76:79], v[108:111], v[112:115], v[76:79]
    s_waitcnt lgkmcnt(0)
    v_mfma_f32_16x16x32_bf16 v[48:51], v[144:147], v[176:179], v[48:51]
    v_mfma_f32_16x16x32_bf16 v[52:55], v[144:147], v[180:183], v[52:55]
    v_mfma_f32_16x16x32_bf16 v[56:59], v[144:147], v[184:187], v[56:59]
    v_mfma_f32_16x16x32_bf16 v[60:63], v[144:147], v[188:191], v[60:63]
    v_mfma_f32_16x16x32_bf16 v[64:67], v[144:147], v[192:195], v[64:67]
    v_mfma_f32_16x16x32_bf16 v[68:71], v[144:147], v[196:199], v[68:71]
    v_mfma_f32_16x16x32_bf16 v[72:75], v[144:147], v[200:203], v[72:75]
    v_mfma_f32_16x16x32_bf16 v[76:79], v[144:147], v[204:207], v[76:79]
    v_mfma_f32_16x16x32_bf16 v[52:55], v[148:151], v[176:179], v[52:55]
    v_mfma_f32_16x16x32_bf16 v[56:59], v[148:151], v[180:183], v[56:59]
    v_mfma_f32_16x16x32_bf16 v[60:63], v[148:151], v[184:187], v[60:63]
    v_mfma_f32_16x16x32_bf16 v[64:67], v[148:151], v[188:191], v[64:67]
    v_mfma_f32_16x16x32_bf16 v[68:71], v[148:151], v[192:195], v[68:71]
    v_mfma_f32_16x16x32_bf16 v[72:75], v[148:151], v[196:199], v[72:75]
    v_mfma_f32_16x16x32_bf16 v[76:79], v[148:151], v[200:203], v[76:79]
    v_mfma_f32_16x16x32_bf16 v[56:59], v[152:155], v[176:179], v[56:59]
    v_mfma_f32_16x16x32_bf16 v[60:63], v[152:155], v[180:183], v[60:63]
    v_mfma_f32_16x16x32_bf16 v[64:67], v[152:155], v[184:187], v[64:67]
    v_mfma_f32_16x16x32_bf16 v[68:71], v[152:155], v[188:191], v[68:71]
    v_mfma_f32_16x16x32_bf16 v[72:75], v[152:155], v[192:195], v[72:75]
    v_mfma_f32_16x16x32_bf16 v[76:79], v[152:155], v[196:199], v[76:79]
    v_mfma_f32_16x16x32_bf16 v[60:63], v[156:159], v[176:179], v[60:63]
    v_mfma_f32_16x16x32_bf16 v[64:67], v[156:159], v[180:183], v[64:67]
    v_mfma_f32_16x16x32_bf16 v[68:71], v[156:159], v[184:187], v[68:71]
    v_mfma_f32_16x16x32_bf16 v[72:75], v[156:159], v[188:191], v[72:75]
    v_mfma_f32_16x16x32_bf16 v[76:79], v[156:159], v[192:195], v[76:79]
    v_mfma_f32_16x16x32_bf16 v[64:67], v[160:163], v[176:179], v[64:67]
    v_mfma_f32_16x16x32_bf16 v[68:71], v[160:163], v[180:183], v[68:71]
    v_mfma_f32_16x16x32_bf16 v[72:75], v[160:163], v[184:187], v[72:75]
    v_mfma_f32_16x16x32_bf16 v[76:79], v[160:163], v[188:191], v[76:79]
    v_mfma_f32_16x16x32_bf16 v[68:71], v[164:167], v[176:179], v[68:71]
    v_mfma_f32_16x16x32_bf16 v[72:75], v[164:167], v[180:183], v[72:75]
    v_mfma_f32_16x16x32_bf16 v[76:79], v[164:167], v[184:187], v[76:79]
    v_mfma_f32_16x16x32_bf16 v[72:75], v[168:171], v[176:179], v[72:75]
    v_mfma_f32_16x16x32_bf16 v[76:79], v[168:171], v[180:183], v[76:79]
    v_mfma_f32_16x16x32_bf16 v[76:79], v[172:175], v[176:179], v[76:79]
    s_nop 7
    v_lshlrev_b32 v5, 6, v2
    v_lshl_add_u32 v5, v3, 4, v5
    v_add_u32 v5, v5, v4
    ds_write_b128 v5, v[48:51] offset:7424
    ds_write_b128 v5, v[52:55] offset:8448
    ds_write_b128 v5, v[56:59] offset:9472
    ds_write_b128 v5, v[60:63] offset:10496
    ds_write_b128 v5, v[64:67] offset:11520
    ds_write_b128 v5, v[68:71] offset:12544
    ds_write_b128 v5, v[72:75] offset:13568
    ds_write_b128 v5, v[76:79] offset:14592
    v_mov_b64 v[8:9], v[16:17]
    v_mov_b64 v[10:11], v[18:19]
    v_mov_b64 v[12:13], v[20:21]
    v_mov_b64 v[14:15], v[22:23]
    v_mov_b32 v24, v25
    v_add_u32 v4, 65536, v4
    s_add_u32 s28, s28, 1
    s_cmp_lt_u32 s28, 2
    s_waitcnt lgkmcnt(0)
    s_cbranch_scc1 ss_pass
    s_mov_b32 s12, s74
    s_mov_b32 s13, s75
    s_mov_b32 s14, 1152
    s_mov_b32 s15, 0x20000
    s_lshl_b32 s23, s20, 1
    buffer_load_dwordx4 v[8:11], off, s[12:15], s23
    s_barrier
    v_lshlrev_b32 v5, 5, v0
    v_add_u32 v7, 65536, v5
    ds_read_b128 v[64:67], v5 offset:7424
    ds_read_b128 v[68:71], v5 offset:7440
    ds_read_b128 v[72:75], v5 offset:23808
    ds_read_b128 v[76:79], v5 offset:23824
    ds_read_b128 v[80:83], v5 offset:40192
    ds_read_b128 v[84:87], v5 offset:40208
    ds_read_b128 v[88:91], v5 offset:56576
    ds_read_b128 v[92:95], v5 offset:56592
    ds_read_b128 v[96:99], v7 offset:7424
    ds_read_b128 v[100:103], v7 offset:7440
    ds_read_b128 v[104:107], v7 offset:23808
    ds_read_b128 v[108:111], v7 offset:23824
    ds_read_b128 v[112:115], v7 offset:40192
    ds_read_b128 v[116:119], v7 offset:40208
    ds_read_b128 v[120:123], v7 offset:56576
    ds_read_b128 v[124:127], v7 offset:56592
    s_waitcnt vmcnt(0)
    v_lshlrev_b32 v12, 16, v8
    v_and_b32 v13, 0xffff0000, v8
    v_lshlrev_b32 v14, 16, v9
    v_and_b32 v15, 0xffff0000, v9
    v_lshlrev_b32 v16, 16, v10
    v_and_b32 v17, 0xffff0000, v10
    v_lshlrev_b32 v18, 16, v11
    v_and_b32 v19, 0xffff0000, v11
    v_mul_u32_u24 v5, 18432, v0
    s_lshl_b32 s22, s20, 1
    s_add_u32 s22, s22, 1152
    s_waitcnt lgkmcnt(0)
    v_lshlrev_b32 v6, 16, v208
    v_fmac_f32 v64, v6, v12
    v_and_b32 v6, 0xffff0000, v208
    v_fmac_f32 v72, v6, v13
    v_lshlrev_b32 v6, 16, v209
    v_fmac_f32 v80, v6, v14
    v_and_b32 v6, 0xffff0000, v209
    v_fmac_f32 v88, v6, v15
    v_lshlrev_b32 v6, 16, v210
    v_fmac_f32 v96, v6, v16
    v_and_b32 v6, 0xffff0000, v210
    v_fmac_f32 v104, v6, v17
    v_lshlrev_b32 v6, 16, v211
    v_fmac_f32 v112, v6, v18
    v_and_b32 v6, 0xffff0000, v211
    v_fmac_f32 v120, v6, v19
    v_cvt_pk_bf16_f32 v208, v64, v72
    v_cvt_pk_bf16_f32 v209, v80, v88
    v_cvt_pk_bf16_f32 v210, v96, v104
    v_cvt_pk_bf16_f32 v211, v112, v120
    s_add_u32 s23, s22, 0
    buffer_store_dwordx4 v[208:211], v5, s[16:19], s23 offen
    v_lshlrev_b32 v6, 16, v212
    v_fmac_f32 v65, v6, v12
    v_and_b32 v6, 0xffff0000, v212
    v_fmac_f32 v73, v6, v13
    v_lshlrev_b32 v6, 16, v213
    v_fmac_f32 v81, v6, v14
    v_and_b32 v6, 0xffff0000, v213
    v_fmac_f32 v89, v6, v15
    v_lshlrev_b32 v6, 16, v214
    v_fmac_f32 v97, v6, v16
    v_and_b32 v6, 0xffff0000, v214
    v_fmac_f32 v105, v6, v17
    v_lshlrev_b32 v6, 16, v215
    v_fmac_f32 v113, v6, v18
    v_and_b32 v6, 0xffff0000, v215
    v_fmac_f32 v121, v6, v19
    v_cvt_pk_bf16_f32 v212, v65, v73
    v_cvt_pk_bf16_f32 v213, v81, v89
    v_cvt_pk_bf16_f32 v214, v97, v105
    v_cvt_pk_bf16_f32 v215, v113, v121
    s_add_u32 s23, s22, 2304
    buffer_store_dwordx4 v[212:215], v5, s[16:19], s23 offen
    v_lshlrev_b32 v6, 16, v216
    v_fmac_f32 v66, v6, v12
    v_and_b32 v6, 0xffff0000, v216
    v_fmac_f32 v74, v6, v13
    v_lshlrev_b32 v6, 16, v217
    v_fmac_f32 v82, v6, v14
    v_and_b32 v6, 0xffff0000, v217
    v_fmac_f32 v90, v6, v15
    v_lshlrev_b32 v6, 16, v218
    v_fmac_f32 v98, v6, v16
    v_and_b32 v6, 0xffff0000, v218
    v_fmac_f32 v106, v6, v17
    v_lshlrev_b32 v6, 16, v219
    v_fmac_f32 v114, v6, v18
    v_and_b32 v6, 0xffff0000, v219
    v_fmac_f32 v122, v6, v19
    v_cvt_pk_bf16_f32 v216, v66, v74
    v_cvt_pk_bf16_f32 v217, v82, v90
    v_cvt_pk_bf16_f32 v218, v98, v106
    v_cvt_pk_bf16_f32 v219, v114, v122
    s_add_u32 s23, s22, 4608
    buffer_store_dwordx4 v[216:219], v5, s[16:19], s23 offen
    v_lshlrev_b32 v6, 16, v220
    v_fmac_f32 v67, v6, v12
    v_and_b32 v6, 0xffff0000, v220
    v_fmac_f32 v75, v6, v13
    v_lshlrev_b32 v6, 16, v221
    v_fmac_f32 v83, v6, v14
    v_and_b32 v6, 0xffff0000, v221
    v_fmac_f32 v91, v6, v15
    v_lshlrev_b32 v6, 16, v222
    v_fmac_f32 v99, v6, v16
    v_and_b32 v6, 0xffff0000, v222
    v_fmac_f32 v107, v6, v17
    v_lshlrev_b32 v6, 16, v223
    v_fmac_f32 v115, v6, v18
    v_and_b32 v6, 0xffff0000, v223
    v_fmac_f32 v123, v6, v19
    v_cvt_pk_bf16_f32 v220, v67, v75
    v_cvt_pk_bf16_f32 v221, v83, v91
    v_cvt_pk_bf16_f32 v222, v99, v107
    v_cvt_pk_bf16_f32 v223, v115, v123
    s_add_u32 s23, s22, 6912
    buffer_store_dwordx4 v[220:223], v5, s[16:19], s23 offen
    v_lshlrev_b32 v6, 16, v224
    v_fmac_f32 v68, v6, v12
    v_and_b32 v6, 0xffff0000, v224
    v_fmac_f32 v76, v6, v13
    v_lshlrev_b32 v6, 16, v225
    v_fmac_f32 v84, v6, v14
    v_and_b32 v6, 0xffff0000, v225
    v_fmac_f32 v92, v6, v15
    v_lshlrev_b32 v6, 16, v226
    v_fmac_f32 v100, v6, v16
    v_and_b32 v6, 0xffff0000, v226
    v_fmac_f32 v108, v6, v17
    v_lshlrev_b32 v6, 16, v227
    v_fmac_f32 v116, v6, v18
    v_and_b32 v6, 0xffff0000, v227
    v_fmac_f32 v124, v6, v19
    v_cvt_pk_bf16_f32 v224, v68, v76
    v_cvt_pk_bf16_f32 v225, v84, v92
    v_cvt_pk_bf16_f32 v226, v100, v108
    v_cvt_pk_bf16_f32 v227, v116, v124
    s_add_u32 s23, s22, 9216
    buffer_store_dwordx4 v[224:227], v5, s[16:19], s23 offen
    v_lshlrev_b32 v6, 16, v228
    v_fmac_f32 v69, v6, v12
    v_and_b32 v6, 0xffff0000, v228
    v_fmac_f32 v77, v6, v13
    v_lshlrev_b32 v6, 16, v229
    v_fmac_f32 v85, v6, v14
    v_and_b32 v6, 0xffff0000, v229
    v_fmac_f32 v93, v6, v15
    v_lshlrev_b32 v6, 16, v230
    v_fmac_f32 v101, v6, v16
    v_and_b32 v6, 0xffff0000, v230
    v_fmac_f32 v109, v6, v17
    v_lshlrev_b32 v6, 16, v231
    v_fmac_f32 v117, v6, v18
    v_and_b32 v6, 0xffff0000, v231
    v_fmac_f32 v125, v6, v19
    v_cvt_pk_bf16_f32 v228, v69, v77
    v_cvt_pk_bf16_f32 v229, v85, v93
    v_cvt_pk_bf16_f32 v230, v101, v109
    v_cvt_pk_bf16_f32 v231, v117, v125
    s_add_u32 s23, s22, 11520
    buffer_store_dwordx4 v[228:231], v5, s[16:19], s23 offen
    v_lshlrev_b32 v6, 16, v232
    v_fmac_f32 v70, v6, v12
    v_and_b32 v6, 0xffff0000, v232
    v_fmac_f32 v78, v6, v13
    v_lshlrev_b32 v6, 16, v233
    v_fmac_f32 v86, v6, v14
    v_and_b32 v6, 0xffff0000, v233
    v_fmac_f32 v94, v6, v15
    v_lshlrev_b32 v6, 16, v234
    v_fmac_f32 v102, v6, v16
    v_and_b32 v6, 0xffff0000, v234
    v_fmac_f32 v110, v6, v17
    v_lshlrev_b32 v6, 16, v235
    v_fmac_f32 v118, v6, v18
    v_and_b32 v6, 0xffff0000, v235
    v_fmac_f32 v126, v6, v19
    v_cvt_pk_bf16_f32 v232, v70, v78
    v_cvt_pk_bf16_f32 v233, v86, v94
    v_cvt_pk_bf16_f32 v234, v102, v110
    v_cvt_pk_bf16_f32 v235, v118, v126
    s_add_u32 s23, s22, 13824
    buffer_store_dwordx4 v[232:235], v5, s[16:19], s23 offen
    v_lshlrev_b32 v6, 16, v236
    v_fmac_f32 v71, v6, v12
    v_and_b32 v6, 0xffff0000, v236
    v_fmac_f32 v79, v6, v13
    v_lshlrev_b32 v6, 16, v237
    v_fmac_f32 v87, v6, v14
    v_and_b32 v6, 0xffff0000, v237
    v_fmac_f32 v95, v6, v15
    v_lshlrev_b32 v6, 16, v238
    v_fmac_f32 v103, v6, v16
    v_and_b32 v6, 0xffff0000, v238
    v_fmac_f32 v111, v6, v17
    v_lshlrev_b32 v6, 16, v239
    v_fmac_f32 v119, v6, v18
    v_and_b32 v6, 0xffff0000, v239
    v_fmac_f32 v127, v6, v19
    v_cvt_pk_bf16_f32 v236, v71, v79
    v_cvt_pk_bf16_f32 v237, v87, v95
    v_cvt_pk_bf16_f32 v238, v103, v111
    v_cvt_pk_bf16_f32 v239, v119, v127
    s_add_u32 s23, s22, 16128
    buffer_store_dwordx4 v[236:239], v5, s[16:19], s23 offen
    s_branch L_ssm_next
L_ssm_done:
    s_cmp_lt_u32 s93, 100
    s_cbranch_scc1 L_exit
    s_mov_b32 s8, s76
    s_mov_b32 s9, s77
    s_mov_b32 s10, 4718592
    s_mov_b32 s11, 0x20000
    s_cmp_le_u32 s45, 1
    s_cbranch_scc1 L_att_next
    s_branch L_op_nextcb
L_wf_next:
    s_mov_b32 s37, 20
    v_mov_b32 v250, 1
    v_mov_b32 v251, 163832
    v_cmp_eq_u32 vcc, 0, v0
    s_nop 0
    s_and_saveexec_b64 s[38:39], vcc
    s_cbranch_execz tk12
    buffer_atomic_add v250, off, s[84:87], s37 sc0
    s_waitcnt vmcnt(0)
    ds_write_b32 v251, v250
    s_waitcnt lgkmcnt(0)
tk12:
    s_mov_b64 exec, -1
    s_barrier
    ds_read_b32 v252, v251
    s_waitcnt lgkmcnt(0)
    v_readfirstlane_b32 s33, v252
    s_barrier
    s_nop 3
    s_cmp_ge_u32 s33, 160
    s_cbranch_scc1 L_ssm_next
    s_lshl_b32 s16, s33, 2
    s_add_u32 s16, s16, s32
    s_add_u32 s16, s16, 1504
    s_call_b64 s[46:47], L_xform
    s_lshl_b32 s40, s33, 2
    s_add_u32 s40, s40, 125841408
    s_waitcnt vmcnt(0)
    s_barrier
    v_mov_b32 v250, s95
    v_cmp_eq_u32 vcc, 0, v0
    s_nop 0
    s_and_saveexec_b64 s[38:39], vcc
    s_cbranch_execz fs13
    buffer_store_dword v250, off, s[4:7], s40 sc1
fs13:
    s_mov_b64 exec, -1
    s_branch L_wf_next
L_phase2:
    s_mov_b32 s40, 524288
mc2_w:
    buffer_load_dword v250, off, s[84:87], 0 offset:28 sc1
    s_waitcnt vmcnt(0)
    v_readfirstlane_b32 s41, v250
    s_nop 0
    s_cmp_lg_u32 s41, 0
    s_cbranch_scc1 mc2_known
    s_sub_u32 s40, s40, 1
    s_cbranch_scc1 mc2_force
    s_sleep 2
    s_branch mc2_w
mc2_force:
    v_mov_b32 v250, 2
    v_mov_b32 v251, 0
    s_mov_b64 exec, 1
    buffer_atomic_cmpswap v[250:251], off, s[84:87], 0 offset:28
    s_mov_b64 exec, -1
    s_waitcnt vmcnt(0)
    s_mov_b32 s40, 524288
    s_branch mc2_w
mc2_known:
    s_cmp_eq_u32 s41, 1
    s_cbranch_scc1 L_phase2b
    s_mov_b32 s37, 208
    v_mov_b32 v250, 1
    v_mov_b32 v251, 163832
    v_cmp_eq_u32 vcc, 0, v0
    s_nop 0
    s_and_saveexec_b64 s[38:39], vcc
    s_cbranch_execz tk14
    buffer_atomic_add v250, off, s[84:87], s37 sc0
    s_waitcnt vmcnt(0)
    ds_write_b32 v251, v250
    s_waitcnt lgkmcnt(0)
tk14:
    s_mov_b64 exec, -1
    s_barrier
    ds_read_b32 v252, v251
    s_waitcnt lgkmcnt(0)
    v_readfirstlane_b32 s12, v252
    s_barrier
    s_nop 3
    s_cmp_lt_u32 s12, 32
    s_cbranch_scc1 L_chain_safe
    s_sub_u32 s45, s12, 32
L_phase2b:
    s_mov_b32 s8, s76
    s_mov_b32 s9, s77
    s_mov_b32 s10, 4718592
    s_mov_b32 s11, 0x20000
    s_and_b32 s36, s45, 15
    s_bitcmp1_b32 42315, s36
    s_cbranch_scc0 L_nots
    s_cmp_eq_u32 s93, 500
    s_cbranch_scc1 L_ssm_next
    s_branch L_wf_next
L_nots:
    s_bitcmp1_b32 18576, s36
    s_cbranch_scc0 L_att_next
    s_bfm_b32 s37, s36, 0
    s_and_b32 s37, s37, 18576
    s_bcnt1_i32_b32 s37, s37
    s_lshr_b32 s40, s45, 4
    s_mul_i32 s40, s40, 4
    s_add_u32 s33, s40, s37
L_op_mod:
    s_mul_hi_u32 s41, s33, 0x0e38e38f
    s_mul_i32 s41, s41, 18
    s_sub_u32 s33, s33, s41
    s_branch L_op_start
L_att_next:
    s_mov_b32 s37, 16
    v_mov_b32 v250, 1
    v_mov_b32 v251, 163832
    v_cmp_eq_u32 vcc, 0, v0
    s_nop 0
    s_and_saveexec_b64 s[38:39], vcc
    s_cbranch_execz tk15
    buffer_atomic_add v250, off, s[84:87], s37 sc0
    s_waitcnt vmcnt(0)
    ds_write_b32 v251, v250
    s_waitcnt lgkmcnt(0)
tk15:
    s_mov_b64 exec, -1
    s_barrier
    ds_read_b32 v252, v251
    s_waitcnt lgkmcnt(0)
    v_readfirstlane_b32 s34, v252
    s_barrier
    s_nop 3
    s_cmp_ge_u32 s34, 512
    s_cbranch_scc1 L_op_nextcb
    s_lshr_b32 s16, s34, 3
    s_and_b32 s17, s34, 7
    s_lshl_b32 s17, s17, 2
    s_add_u32 s17, s17, s32
    s_lshl_b32 s36, s17, 7
    s_add_u32 s36, s36, 125829120
    s_lshr_b32 s41, s16, 2
    s_add_u32 s41, s41, s95
    s_add_u32 s41, s41, 1
    v_and_b32 v1, 3, v0
    v_min_u32 v1, 2, v1
    v_lshlrev_b32 v2, 4, v1
    s_and_b32 s37, s16, 3
    s_lshl_b32 s37, s37, 2
    v_add_u32 v2, s37, v2
    s_mov_b32 s40, 4194304
L_aw1:
    buffer_load_dword v3, v2, s[4:7], s36 offen sc1
    s_sub_u32 s40, s40, 1
    s_cbranch_scc1 L_aw1_go
    s_waitcnt vmcnt(0)
    v_subrev_u32 v3, s41, v3
    v_cmp_lt_u32 vcc, 64, v3
    s_cbranch_vccz L_aw1_go
    s_sleep 4
    s_branch L_aw1
L_aw1_go:
    v_and_b32 v5, 63, v0
    v_lshlrev_b32 v1, 4, v5
    s_cmp_ge_u32 s16, 56
    s_cselect_b32 s18, -1, 511
    v_and_b32 v2, s18, v1
    v_or_b32 v3, 128, v1
    v_lshrrev_b32 v4, 4, v5
    v_bfe_u32 v6, v5, 2, 2
    v_sub_u32 v4, v6, v4
    v_lshlrev_b32 v4, 3, v4
    v_and_b32 v6, 3, v5
    v_add_u32 v4, v4, v6
    v_mov_b32 v6, 0xf149f2ca
    s_mov_b32 s22, 0x3e0293ee
    s_lshl_b32 s18, s16, 5
    s_add_u32 s18, s18, s17
    s_lshl_b32 s19, s18, 13
    s_add_u32 s20, s19, 33554432
    buffer_load_dwordx4 v[8:11], v1, s[4:7], s20 offen offset:0 sc1
    s_add_u32 s20, s19, 33554432
    buffer_load_dwordx4 v[12:15], v1, s[4:7], s20 offen offset:1024 sc1
    s_add_u32 s20, s19, 33554432
    buffer_load_dwordx4 v[16:19], v1, s[4:7], s20 offen offset:2048 sc1
    s_add_u32 s20, s19, 33554432
    buffer_load_dwordx4 v[20:23], v1, s[4:7], s20 offen offset:3072 sc1
    s_add_u32 s20, s19, 33558528
    buffer_load_dwordx4 v[24:27], v1, s[4:7], s20 offen offset:0 sc1
    s_add_u32 s20, s19, 33558528
    buffer_load_dwordx4 v[28:31], v1, s[4:7], s20 offen offset:1024 sc1
    s_add_u32 s20, s19, 33558528
    buffer_load_dwordx4 v[32:35], v1, s[4:7], s20 offen offset:2048 sc1
    s_add_u32 s20, s19, 33558528
    buffer_load_dwordx4 v[36:39], v1, s[4:7], s20 offen offset:3072 sc1
    s_lshl_b32 s21, s18, 14
    s_add_u32 s20, s21, 0
    buffer_load_dwordx4 v[40:43], v1, s[4:7], s20 offen offset:0 sc1
    s_add_u32 s20, s21, 4096
    buffer_load_dwordx4 v[44:47], v1, s[4:7], s20 offen offset:0 sc1
    s_add_u32 s20, s21, 8192
    buffer_load_dwordx4 v[48:51], v1, s[4:7], s20 offen offset:0 sc1
    s_add_u32 s20, s21, 12288
    buffer_load_dwordx4 v[52:55], v1, s[4:7], s20 offen offset:0 sc1
    s_add_u32 s20, s21, 0
    buffer_load_dwordx4 v[56:59], v1, s[4:7], s20 offen offset:1024 sc1
    s_add_u32 s20, s21, 4096
    buffer_load_dwordx4 v[60:63], v1, s[4:7], s20 offen offset:1024 sc1
    s_add_u32 s20, s21, 8192
    buffer_load_dwordx4 v[64:67], v1, s[4:7], s20 offen offset:1024 sc1
    s_add_u32 s20, s21, 12288
    buffer_load_dwordx4 v[68:71], v1, s[4:7], s20 offen offset:1024 sc1
    s_add_u32 s20, s21, 0
    buffer_load_dwordx4 v[88:91], v1, s[4:7], s20 offen offset:2048 sc1
    s_add_u32 s20, s21, 4096
    buffer_load_dwordx4 v[92:95], v1, s[4:7], s20 offen offset:2048 sc1
    s_add_u32 s20, s21, 8192
    buffer_load_dwordx4 v[96:99], v1, s[4:7], s20 offen offset:2048 sc1
    s_add_u32 s20, s21, 12288
    buffer_load_dwordx4 v[100:103], v1, s[4:7], s20 offen offset:2048 sc1
    s_add_u32 s20, s21, 0
    buffer_load_dwordx4 v[104:107], v1, s[4:7], s20 offen offset:3072 sc1
    s_add_u32 s20, s21, 4096
    buffer_load_dwordx4 v[108:111], v1, s[4:7], s20 offen offset:3072 sc1
    s_add_u32 s20, s21, 8192
    buffer_load_dwordx4 v[112:115], v1, s[4:7], s20 offen offset:3072 sc1
    s_add_u32 s20, s21, 12288
    buffer_load_dwordx4 v[116:119], v1, s[4:7], s20 offen offset:3072 sc1
    v_mov_b32 v172, 0x3f803f80
    v_mov_b32 v173, 0x3f803f80
    v_mov_b32 v174, 0x3f803f80
    v_mov_b32 v175, 0x3f803f80
    v_mov_b32 v176, 0x3f003f00
    v_mov_b32 v177, 0x3f003f00
    s_waitcnt vmcnt(8)
    v_mfma_f32_16x16x32_bf16 v[136:139], v[40:43], v[8:11], 0
    v_mfma_f32_16x16x32_bf16 v[140:143], v[56:59], v[8:11], 0
    v_mfma_f32_16x16x32_bf16 v[148:151], v[40:43], v[24:27], 0
    v_mfma_f32_16x16x32_bf16 v[152:155], v[56:59], v[24:27], 0
    v_mfma_f32_16x16x32_bf16 v[136:139], v[44:47], v[12:15], v[136:139]
    v_mfma_f32_16x16x32_bf16 v[140:143], v[60:63], v[12:15], v[140:143]
    v_mfma_f32_16x16x32_bf16 v[148:151], v[44:47], v[28:31], v[148:151]
    v_mfma_f32_16x16x32_bf16 v[152:155], v[60:63], v[28:31], v[152:155]
    v_mfma_f32_16x16x32_bf16 v[136:139], v[48:51], v[16:19], v[136:139]
    v_mfma_f32_16x16x32_bf16 v[140:143], v[64:67], v[16:19], v[140:143]
    v_mfma_f32_16x16x32_bf16 v[148:151], v[48:51], v[32:35], v[148:151]
    v_mfma_f32_16x16x32_bf16 v[152:155], v[64:67], v[32:35], v[152:155]
    v_mfma_f32_16x16x32_bf16 v[136:139], v[52:55], v[20:23], v[136:139]
    v_mfma_f32_16x16x32_bf16 v[140:143], v[68:71], v[20:23], v[140:143]
    v_mfma_f32_16x16x32_bf16 v[148:151], v[52:55], v[36:39], v[148:151]
    v_mfma_f32_16x16x32_bf16 v[152:155], v[68:71], v[36:39], v[152:155]
    v_cmp_le_i32 vcc, 0, v4
    s_nop 3
    v_cndmask_b32 v136, v6, v136, vcc
    v_cmp_le_i32 vcc, 1, v4
    s_nop 1
    v_cndmask_b32 v137, v6, v137, vcc
    v_cmp_le_i32 vcc, 2, v4
    s_nop 1
    v_cndmask_b32 v138, v6, v138, vcc
    v_cmp_le_i32 vcc, 3, v4
    s_nop 1
    v_cndmask_b32 v139, v6, v139, vcc
    v_cmp_le_i32 vcc, 4, v4
    s_nop 1
    v_cndmask_b32 v140, v6, v140, vcc
    v_cmp_le_i32 vcc, 5, v4
    s_nop 1
    v_cndmask_b32 v141, v6, v141, vcc
    v_cmp_le_i32 vcc, 6, v4
    s_nop 1
    v_cndmask_b32 v142, v6, v142, vcc
    v_cmp_le_i32 vcc, 7, v4
    s_nop 1
    v_cndmask_b32 v143, v6, v143, vcc
    v_cmp_le_i32 vcc, -4, v4
    s_nop 1
    v_cndmask_b32 v148, v6, v148, vcc
    v_cmp_le_i32 vcc, -3, v4
    s_nop 1
    v_cndmask_b32 v149, v6, v149, vcc
    v_cmp_le_i32 vcc, -2, v4
    s_nop 1
    v_cndmask_b32 v150, v6, v150, vcc
    v_cmp_le_i32 vcc, -1, v4
    s_nop 1
    v_cndmask_b32 v151, v6, v151, vcc
    v_cmp_le_i32 vcc, 0, v4
    s_nop 1
    v_cndmask_b32 v152, v6, v152, vcc
    v_cmp_le_i32 vcc, 1, v4
    s_nop 1
    v_cndmask_b32 v153, v6, v153, vcc
    v_cmp_le_i32 vcc, 2, v4
    s_nop 1
    v_cndmask_b32 v154, v6, v154, vcc
    v_cmp_le_i32 vcc, 3, v4
    s_nop 1
    v_cndmask_b32 v155, v6, v155, vcc
    s_nop 1
    v_and_b32 v198, 1, v0
    v_lshlrev_b32 v198, 2, v198
    v_add_u32 v198, 48, v198
    s_add_u32 s41, s16, s95
    s_add_u32 s41, s41, 1
    s_cmp_lt_u32 s16, 56
    s_cbranch_scc1 L_amk
    v_mov_b32 v198, 16384
L_amk:
    s_nop 1
    s_mov_b32 s88, 65536
    s_mov_b32 s89, 125853696
cw16:
    buffer_load_dword v199, off, s[4:7], s89 sc1
    s_waitcnt vmcnt(0)
    v_readfirstlane_b32 s42, v199
    s_nop 0
    s_sub_u32 s42, s42, s95
    s_cmp_gt_u32 s42, 64
    s_cselect_b32 s42, 0, s42
    s_add_u32 s42, s42, 1
    s_cmp_ge_u32 s42, s16
    s_cbranch_scc1 cw16x
    s_sub_u32 s88, s88, 1
    s_cbranch_scc1 cw16x
    s_sub_u32 s42, s16, s42
    s_min_u32 s42, s42, 6
cw16s:
    s_sleep 24
    s_sub_u32 s42, s42, 1
    s_cmp_lg_u32 s42, 0
    s_cbranch_scc1 cw16s
    s_branch cw16
cw16x:
    s_mov_b32 s40, 4194304
L_aw2:
    buffer_load_dword v199, v198, s[4:7], s36 offen sc1
    s_sub_u32 s40, s40, 1
    s_cbranch_scc1 L_aw2_go
    s_waitcnt vmcnt(0)
    v_subrev_u32 v199, s41, v199
    v_cmp_lt_u32 vcc, 64, v199
    s_cbranch_vccz L_aw2_go
    s_sleep 1
    s_branch L_aw2
L_aw2_go:
    s_lshl_b32 s20, s18, 12
    s_add_u32 s20, s20, 69206016
    buffer_load_dwordx4 v[72:75], v3, s[4:7], s20 offen offset:0 sc1
    buffer_load_dwordx4 v[76:79], v3, s[4:7], s20 offen offset:1024 sc1
    buffer_load_dwordx4 v[80:83], v3, s[4:7], s20 offen offset:2048 sc1
    buffer_load_dwordx4 v[84:87], v3, s[4:7], s20 offen offset:3072 sc1
    s_lshl_b32 s20, s18, 12
    s_add_u32 s20, s20, 77594624
    buffer_load_dwordx4 v[120:123], v2, s[4:7], s20 offen offset:0 sc1
    buffer_load_dwordx4 v[124:127], v2, s[4:7], s20 offen offset:1024 sc1
    buffer_load_dwordx4 v[128:131], v2, s[4:7], s20 offen offset:2048 sc1
    buffer_load_dwordx4 v[132:135], v2, s[4:7], s20 offen offset:3072 sc1
    s_waitcnt vmcnt(4)
    v_mfma_f32_16x16x32_bf16 v[144:147], v[72:75], v[8:11], 0
    v_mfma_f32_16x16x32_bf16 v[156:159], v[72:75], v[24:27], 0
    v_mfma_f32_16x16x32_bf16 v[144:147], v[76:79], v[12:15], v[144:147]
    v_mfma_f32_16x16x32_bf16 v[156:159], v[76:79], v[28:31], v[156:159]
    v_mfma_f32_16x16x32_bf16 v[144:147], v[80:83], v[16:19], v[144:147]
    v_mfma_f32_16x16x32_bf16 v[156:159], v[80:83], v[32:35], v[156:159]
    v_mfma_f32_16x16x32_bf16 v[144:147], v[84:87], v[20:23], v[144:147]
    v_mfma_f32_16x16x32_bf16 v[156:159], v[84:87], v[36:39], v[156:159]
    v_max3_f32 v196, v136, v137, v138
    v_max3_f32 v197, v139, v140, v141
    v_max3_f32 v196, v196, v142, v143
    s_nop 3
    v_max3_f32 v197, v197, v144, v145
    v_max3_f32 v196, v196, v146, v147
    v_max_f32 v196, v196, v197
    v_mov_b32 v197, v196
    s_nop 1
    v_permlane32_swap_b32 v196, v197
    v_max_f32 v196, v196, v197
    v_mov_b32 v197, v196
    s_nop 1
    v_permlane16_swap_b32 v196, v197
    v_max_f32 v196, v196, v197
    v_mul_f32 v196, s22, v196
    v_sub_f32 v196, 0, v196
    v_fma_f32 v136, v136, s22, v196
    v_fma_f32 v137, v137, s22, v196
    v_fma_f32 v138, v138, s22, v196
    v_fma_f32 v139, v139, s22, v196
    v_fma_f32 v140, v140, s22, v196
    v_fma_f32 v141, v141, s22, v196
    v_fma_f32 v142, v142, s22, v196
    v_fma_f32 v143, v143, s22, v196
    v_fma_f32 v144, v144, s22, v196
    v_fma_f32 v145, v145, s22, v196
    v_fma_f32 v146, v146, s22, v196
    v_fma_f32 v147, v147, s22, v196
    v_exp_f32 v136, v136
    v_exp_f32 v137, v137
    v_exp_f32 v138, v138
    v_exp_f32 v139, v139
    v_exp_f32 v140, v140
    v_exp_f32 v141, v141
    v_exp_f32 v142, v142
    v_exp_f32 v143, v143
    v_exp_f32 v144, v144
    v_exp_f32 v145, v145
    v_exp_f32 v146, v146
    v_exp_f32 v147, v147
    v_cvt_pk_bf16_f32 v160, v136, v137
    v_cvt_pk_bf16_f32 v161, v138, v139
    v_cvt_pk_bf16_f32 v162, v140, v141
    v_cvt_pk_bf16_f32 v163, v142, v143
    v_cvt_pk_bf16_f32 v164, v144, v145
    v_cvt_pk_bf16_f32 v165, v146, v147
    v_max3_f32 v196, v148, v149, v150
    v_max3_f32 v197, v151, v152, v153
    v_max3_f32 v196, v196, v154, v155
    v_max3_f32 v197, v197, v156, v157
    v_max3_f32 v196, v196, v158, v159
    v_max_f32 v196, v196, v197
    v_mov_b32 v197, v196
    s_nop 1
    v_permlane32_swap_b32 v196, v197
    v_max_f32 v196, v196, v197
    v_mov_b32 v197, v196
    s_nop 1
    v_permlane16_swap_b32 v196, v197
    v_max_f32 v196, v196, v197
    v_mul_f32 v196, s22, v196
    v_sub_f32 v196, 0, v196
    v_fma_f32 v148, v148, s22, v196
    v_fma_f32 v149, v149, s22, v196
    v_fma_f32 v150, v150, s22, v196
    v_fma_f32 v151, v151, s22, v196
    v_fma_f32 v152, v152, s22, v196
    v_fma_f32 v153, v153, s22, v196
    v_fma_f32 v154, v154, s22, v196
    v_fma_f32 v155, v155, s22, v196
    v_fma_f32 v156, v156, s22, v196
    v_fma_f32 v157, v157, s22, v196
    v_fma_f32 v158, v158, s22, v196
    v_fma_f32 v159, v159, s22, v196
    v_exp_f32 v148, v148
    v_exp_f32 v149, v149
    v_exp_f32 v150, v150
    v_exp_f32 v151, v151
    v_exp_f32 v152, v152
    v_exp_f32 v153, v153
    v_exp_f32 v154, v154
    v_exp_f32 v155, v155
    v_exp_f32 v156, v156
    v_exp_f32 v157, v157
    v_exp_f32 v158, v158
    v_exp_f32 v159, v159
    v_cvt_pk_bf16_f32 v166, v148, v149
    v_cvt_pk_bf16_f32 v167, v150, v151
    v_cvt_pk_bf16_f32 v168, v152, v153
    v_cvt_pk_bf16_f32 v169, v154, v155
    v_cvt_pk_bf16_f32 v170, v156, v157
    v_cvt_pk_bf16_f32 v171, v158, v159
    v_mfma_f32_16x16x32_bf16 v[180:183], v[172:175], v[160:163], 0
    v_mfma_f32_16x16x32_bf16 v[184:187], v[172:175], v[166:169], 0
    s_nop 4
    v_mfma_f32_16x16x16_bf16 v[180:183], v[176:177], v[164:165], v[180:183]
    v_mfma_f32_16x16x16_bf16 v[184:187], v[176:177], v[170:171], v[184:187]
    s_nop 6
    v_rcp_f32 v180, v180
    v_rcp_f32 v184, v184
    s_waitcnt vmcnt(0)
    s_lshl_b32 s18, s16, 18
    s_lshl_b32 s19, s17, 12
    s_add_u32 s18, s18, s19
    s_add_u32 s18, s18, 50331648
    s_add_u32 s19, s18, 131072
    v_mfma_f32_16x16x32_bf16 v[8:11], v[88:91], v[160:163], 0
    v_mfma_f32_16x16x32_bf16 v[12:15], v[104:107], v[160:163], 0
    v_mfma_f32_16x16x32_bf16 v[16:19], v[88:91], v[166:169], 0
    v_mfma_f32_16x16x32_bf16 v[20:23], v[104:107], v[166:169], 0
    v_mfma_f32_16x16x32_bf16 v[24:27], v[92:95], v[160:163], 0
    v_mfma_f32_16x16x32_bf16 v[28:31], v[108:111], v[160:163], 0
    v_mfma_f32_16x16x32_bf16 v[32:35], v[92:95], v[166:169], 0
    v_mfma_f32_16x16x32_bf16 v[36:39], v[108:111], v[166:169], 0
    v_mfma_f32_16x16x32_bf16 v[40:43], v[96:99], v[160:163], 0
    v_mfma_f32_16x16x32_bf16 v[44:47], v[112:115], v[160:163], 0
    v_mfma_f32_16x16x32_bf16 v[48:51], v[96:99], v[166:169], 0
    v_mfma_f32_16x16x32_bf16 v[52:55], v[112:115], v[166:169], 0
    v_mfma_f32_16x16x32_bf16 v[56:59], v[100:103], v[160:163], 0
    v_mfma_f32_16x16x32_bf16 v[60:63], v[116:119], v[160:163], 0
    v_mfma_f32_16x16x32_bf16 v[64:67], v[100:103], v[166:169], 0
    v_mfma_f32_16x16x32_bf16 v[68:71], v[116:119], v[166:169], 0
    v_mfma_f32_16x16x16_bf16 v[8:11], v[120:121], v[164:165], v[8:11]
    v_mfma_f32_16x16x16_bf16 v[12:15], v[122:123], v[164:165], v[12:15]
    v_mfma_f32_16x16x16_bf16 v[16:19], v[120:121], v[170:171], v[16:19]
    v_mfma_f32_16x16x16_bf16 v[20:23], v[122:123], v[170:171], v[20:23]
    v_mfma_f32_16x16x16_bf16 v[24:27], v[124:125], v[164:165], v[24:27]
    v_mfma_f32_16x16x16_bf16 v[28:31], v[126:127], v[164:165], v[28:31]
    v_mfma_f32_16x16x16_bf16 v[32:35], v[124:125], v[170:171], v[32:35]
    v_mfma_f32_16x16x16_bf16 v[36:39], v[126:127], v[170:171], v[36:39]
    v_mfma_f32_16x16x16_bf16 v[40:43], v[128:129], v[164:165], v[40:43]
    v_mfma_f32_16x16x16_bf16 v[44:47], v[130:131], v[164:165], v[44:47]
    v_mfma_f32_16x16x16_bf16 v[48:51], v[128:129], v[170:171], v[48:51]
    v_mfma_f32_16x16x16_bf16 v[52:55], v[130:131], v[170:171], v[52:55]
    v_mfma_f32_16x16x16_bf16 v[56:59], v[132:133], v[164:165], v[56:59]
    v_mfma_f32_16x16x16_bf16 v[60:63], v[134:135], v[164:165], v[60:63]
    v_mfma_f32_16x16x16_bf16 v[64:67], v[132:133], v[170:171], v[64:67]
    v_mfma_f32_16x16x16_bf16 v[68:71], v[134:135], v[170:171], v[68:71]
    v_mul_f32 v8, v8, v180
    v_mul_f32 v12, v12, v180
    v_mul_f32 v9, v9, v180
    v_mul_f32 v13, v13, v180
    v_mul_f32 v10, v10, v180
    v_mul_f32 v14, v14, v180
    v_mul_f32 v11, v11, v180
    v_mul_f32 v15, v15, v180
    v_cvt_pk_bf16_f32 v8, v8, v9
    v_cvt_pk_bf16_f32 v9, v10, v11
    v_cvt_pk_bf16_f32 v10, v12, v13
    v_cvt_pk_bf16_f32 v11, v14, v15
    buffer_store_dwordx4 v[8:11], v1, s[4:7], s18 offen offset:0 sc1
    v_mul_f32 v16, v16, v184
    v_mul_f32 v20, v20, v184
    v_mul_f32 v17, v17, v184
    v_mul_f32 v21, v21, v184
    v_mul_f32 v18, v18, v184
    v_mul_f32 v22, v22, v184
    v_mul_f32 v19, v19, v184
    v_mul_f32 v23, v23, v184
    v_cvt_pk_bf16_f32 v16, v16, v17
    v_cvt_pk_bf16_f32 v17, v18, v19
    v_cvt_pk_bf16_f32 v18, v20, v21
    v_cvt_pk_bf16_f32 v19, v22, v23
    buffer_store_dwordx4 v[16:19], v1, s[4:7], s19 offen offset:0 sc1
    v_mul_f32 v24, v24, v180
    v_mul_f32 v28, v28, v180
    v_mul_f32 v25, v25, v180
    v_mul_f32 v29, v29, v180
    v_mul_f32 v26, v26, v180
    v_mul_f32 v30, v30, v180
    v_mul_f32 v27, v27, v180
    v_mul_f32 v31, v31, v180
    v_cvt_pk_bf16_f32 v24, v24, v25
    v_cvt_pk_bf16_f32 v25, v26, v27
    v_cvt_pk_bf16_f32 v26, v28, v29
    v_cvt_pk_bf16_f32 v27, v30, v31
    buffer_store_dwordx4 v[24:27], v1, s[4:7], s18 offen offset:1024 sc1
    v_mul_f32 v32, v32, v184
    v_mul_f32 v36, v36, v184
    v_mul_f32 v33, v33, v184
    v_mul_f32 v37, v37, v184
    v_mul_f32 v34, v34, v184
    v_mul_f32 v38, v38, v184
    v_mul_f32 v35, v35, v184
    v_mul_f32 v39, v39, v184
    v_cvt_pk_bf16_f32 v32, v32, v33
    v_cvt_pk_bf16_f32 v33, v34, v35
    v_cvt_pk_bf16_f32 v34, v36, v37
    v_cvt_pk_bf16_f32 v35, v38, v39
    buffer_store_dwordx4 v[32:35], v1, s[4:7], s19 offen offset:1024 sc1
    v_mul_f32 v40, v40, v180
    v_mul_f32 v44, v44, v180
    v_mul_f32 v41, v41, v180
    v_mul_f32 v45, v45, v180
    v_mul_f32 v42, v42, v180
    v_mul_f32 v46, v46, v180
    v_mul_f32 v43, v43, v180
    v_mul_f32 v47, v47, v180
    v_cvt_pk_bf16_f32 v40, v40, v41
    v_cvt_pk_bf16_f32 v41, v42, v43
    v_cvt_pk_bf16_f32 v42, v44, v45
    v_cvt_pk_bf16_f32 v43, v46, v47
    buffer_store_dwordx4 v[40:43], v1, s[4:7], s18 offen offset:2048 sc1
    v_mul_f32 v48, v48, v184
    v_mul_f32 v52, v52, v184
    v_mul_f32 v49, v49, v184
    v_mul_f32 v53, v53, v184
    v_mul_f32 v50, v50, v184
    v_mul_f32 v54, v54, v184
    v_mul_f32 v51, v51, v184
    v_mul_f32 v55, v55, v184
    v_cvt_pk_bf16_f32 v48, v48, v49
    v_cvt_pk_bf16_f32 v49, v50, v51
    v_cvt_pk_bf16_f32 v50, v52, v53
    v_cvt_pk_bf16_f32 v51, v54, v55
    buffer_store_dwordx4 v[48:51], v1, s[4:7], s19 offen offset:2048 sc1
    v_mul_f32 v56, v56, v180
    v_mul_f32 v60, v60, v180
    v_mul_f32 v57, v57, v180
    v_mul_f32 v61, v61, v180
    v_mul_f32 v58, v58, v180
    v_mul_f32 v62, v62, v180
    v_mul_f32 v59, v59, v180
    v_mul_f32 v63, v63, v180
    v_cvt_pk_bf16_f32 v56, v56, v57
    v_cvt_pk_bf16_f32 v57, v58, v59
    v_cvt_pk_bf16_f32 v58, v60, v61
    v_cvt_pk_bf16_f32 v59, v62, v63
    buffer_store_dwordx4 v[56:59], v1, s[4:7], s18 offen offset:3072 sc1
    v_mul_f32 v64, v64, v184
    v_mul_f32 v68, v68, v184
    v_mul_f32 v65, v65, v184
    v_mul_f32 v69, v69, v184
    v_mul_f32 v66, v66, v184
    v_mul_f32 v70, v70, v184
    v_mul_f32 v67, v67, v184
    v_mul_f32 v71, v71, v184
    v_cvt_pk_bf16_f32 v64, v64, v65
    v_cvt_pk_bf16_f32 v65, v66, v67
    v_cvt_pk_bf16_f32 v66, v68, v69
    v_cvt_pk_bf16_f32 v67, v70, v71
    buffer_store_dwordx4 v[64:67], v1, s[4:7], s19 offen offset:3072 sc1
    s_lshr_b32 s40, s34, 1
    s_lshl_b32 s40, s40, 7
    s_and_b32 s41, s34, 1
    s_lshl_b32 s41, s41, 2
    s_add_u32 s40, s40, s41
    s_add_u32 s40, s40, 125894656
    s_waitcnt vmcnt(0)
    s_barrier
    v_mov_b32 v250, s95
    v_cmp_eq_u32 vcc, 0, v0
    s_nop 0
    s_and_saveexec_b64 s[38:39], vcc
    s_cbranch_execz fs17
    buffer_store_dword v250, off, s[4:7], s40 sc1
fs17:
    s_mov_b64 exec, -1
    s_branch L_att_next
L_op_start:
    s_lshl_b32 s35, s33, 2
    s_add_u32 s35, s35, 136
    s_lshr_b32 s89, s33, 2
    s_lshl_b32 s89, s89, 7
    s_add_u32 s89, s89, 125841408
    v_mbcnt_lo_u32_b32 v2, -1, 0
    v_mbcnt_hi_u32_b32 v2, -1, v2
    v_min_u32 v2, 31, v2
    v_lshlrev_b32 v2, 2, v2
    s_mov_b32 s88, 4194304
fw18:
    buffer_load_dword v3, v2, s[4:7], s89 offen offset:0 sc1
    s_sub_u32 s88, s88, 1
    s_cbranch_scc1 fw18x
    s_waitcnt vmcnt(0)
    v_cmp_ne_u32 vcc, s95, v3
    s_cbranch_vccz fw18x
    s_sleep 4
    s_branch fw18
fw18x:
    v_and_b32 v1, 63, v0
    v_lshlrev_b32 v1, 4, v1
    s_lshl_b32 s18, s33, 18
    s_lshl_b32 s19, s32, 16
    s_add_u32 s18, s18, s19
    s_add_u32 s18, s18, 130023424
    buffer_load_dwordx4 a[0:3], v1, s[4:7], s18 offen offset:0 sc1
    buffer_load_dwordx4 a[4:7], v1, s[4:7], s18 offen offset:1024 sc1
    buffer_load_dwordx4 a[8:11], v1, s[4:7], s18 offen offset:2048 sc1
    buffer_load_dwordx4 a[12:15], v1, s[4:7], s18 offen offset:3072 sc1
    s_add_u32 s18, s18, 4096
    buffer_load_dwordx4 a[16:19], v1, s[4:7], s18 offen offset:0 sc1
    buffer_load_dwordx4 a[20:23], v1, s[4:7], s18 offen offset:1024 sc1
    buffer_load_dwordx4 a[24:27], v1, s[4:7], s18 offen offset:2048 sc1
    buffer_load_dwordx4 a[28:31], v1, s[4:7], s18 offen offset:3072 sc1
    s_add_u32 s18, s18, 4096
    buffer_load_dwordx4 a[32:35], v1, s[4:7], s18 offen offset:0 sc1
    buffer_load_dwordx4 a[36:39], v1, s[4:7], s18 offen offset:1024 sc1
    buffer_load_dwordx4 a[40:43], v1, s[4:7], s18 offen offset:2048 sc1
    buffer_load_dwordx4 a[44:47], v1, s[4:7], s18 offen offset:3072 sc1
    s_add_u32 s18, s18, 4096
    buffer_load_dwordx4 a[48:51], v1, s[4:7], s18 offen offset:0 sc1
    buffer_load_dwordx4 a[52:55], v1, s[4:7], s18 offen offset:1024 sc1
    buffer_load_dwordx4 a[56:59], v1, s[4:7], s18 offen offset:2048 sc1
    buffer_load_dwordx4 a[60:63], v1, s[4:7], s18 offen offset:3072 sc1
    s_add_u32 s18, s18, 4096
    buffer_load_dwordx4 a[64:67], v1, s[4:7], s18 offen offset:0 sc1
    buffer_load_dwordx4 a[68:71], v1, s[4:7], s18 offen offset:1024 sc1
    buffer_load_dwordx4 a[72:75], v1, s[4:7], s18 offen offset:2048 sc1
    buffer_load_dwordx4 a[76:79], v1, s[4:7], s18 offen offset:3072 sc1
    s_add_u32 s18, s18, 4096
    buffer_load_dwordx4 a[80:83], v1, s[4:7], s18 offen offset:0 sc1
    buffer_load_dwordx4 a[84:87], v1, s[4:7], s18 offen offset:1024 sc1
    buffer_load_dwordx4 a[88:91], v1, s[4:7], s18 offen offset:2048 sc1
    buffer_load_dwordx4 a[92:95], v1, s[4:7], s18 offen offset:3072 sc1
    s_add_u32 s18, s18, 4096
    buffer_load_dwordx4 a[96:99], v1, s[4:7], s18 offen offset:0 sc1
    buffer_load_dwordx4 a[100:103], v1, s[4:7], s18 offen offset:1024 sc1
    buffer_load_dwordx4 a[104:107], v1, s[4:7], s18 offen offset:2048 sc1
    buffer_load_dwordx4 a[108:111], v1, s[4:7], s18 offen offset:3072 sc1
    s_add_u32 s18, s18, 4096
    buffer_load_dwordx4 a[112:115], v1, s[4:7], s18 offen offset:0 sc1
    buffer_load_dwordx4 a[116:119], v1, s[4:7], s18 offen offset:1024 sc1
    buffer_load_dwordx4 a[120:123], v1, s[4:7], s18 offen offset:2048 sc1
    buffer_load_dwordx4 a[124:127], v1, s[4:7], s18 offen offset:3072 sc1
    s_add_u32 s18, s18, 4096
    buffer_load_dwordx4 a[128:131], v1, s[4:7], s18 offen offset:0 sc1
    buffer_load_dwordx4 a[132:135], v1, s[4:7], s18 offen offset:1024 sc1
    buffer_load_dwordx4 a[136:139], v1, s[4:7], s18 offen offset:2048 sc1
    buffer_load_dwordx4 a[140:143], v1, s[4:7], s18 offen offset:3072 sc1
    s_add_u32 s18, s18, 4096
    buffer_load_dwordx4 a[144:147], v1, s[4:7], s18 offen offset:0 sc1
    buffer_load_dwordx4 a[148:151], v1, s[4:7], s18 offen offset:1024 sc1
    buffer_load_dwordx4 a[152:155], v1, s[4:7], s18 offen offset:2048 sc1
    buffer_load_dwordx4 a[156:159], v1, s[4:7], s18 offen offset:3072 sc1
    s_add_u32 s18, s18, 4096
    buffer_load_dwordx4 a[160:163], v1, s[4:7], s18 offen offset:0 sc1
    s_waitcnt vmcnt(20)
    buffer_load_dwordx4 a[164:167], v1, s[4:7], s18 offen offset:1024 sc1
    buffer_load_dwordx4 a[168:171], v1, s[4:7], s18 offen offset:2048 sc1
    buffer_load_dwordx4 a[172:175], v1, s[4:7], s18 offen offset:3072 sc1
    s_add_u32 s18, s18, 4096
    buffer_load_dwordx4 a[176:179], v1, s[4:7], s18 offen offset:0 sc1
    buffer_load_dwordx4 a[180:183], v1, s[4:7], s18 offen offset:1024 sc1
    buffer_load_dwordx4 a[184:187], v1, s[4:7], s18 offen offset:2048 sc1
    buffer_load_dwordx4 a[188:191], v1, s[4:7], s18 offen offset:3072 sc1
    s_add_u32 s18, s18, 4096
    buffer_load_dwordx4 a[192:195], v1, s[4:7], s18 offen offset:0 sc1
    buffer_load_dwordx4 a[196:199], v1, s[4:7], s18 offen offset:1024 sc1
    buffer_load_dwordx4 a[200:203], v1, s[4:7], s18 offen offset:2048 sc1
    buffer_load_dwordx4 a[204:207], v1, s[4:7], s18 offen offset:3072 sc1
    s_add_u32 s18, s18, 4096
    buffer_load_dwordx4 a[208:211], v1, s[4:7], s18 offen offset:0 sc1
    buffer_load_dwordx4 a[212:215], v1, s[4:7], s18 offen offset:1024 sc1
    buffer_load_dwordx4 a[216:219], v1, s[4:7], s18 offen offset:2048 sc1
    buffer_load_dwordx4 a[220:223], v1, s[4:7], s18 offen offset:3072 sc1
    s_add_u32 s18, s18, 4096
    buffer_load_dwordx4 a[224:227], v1, s[4:7], s18 offen offset:0 sc1
    buffer_load_dwordx4 a[228:231], v1, s[4:7], s18 offen offset:1024 sc1
    buffer_load_dwordx4 a[232:235], v1, s[4:7], s18 offen offset:2048 sc1
    buffer_load_dwordx4 a[236:239], v1, s[4:7], s18 offen offset:3072 sc1
    s_add_u32 s18, s18, 4096
    buffer_load_dwordx4 a[240:243], v1, s[4:7], s18 offen offset:0 sc1
    buffer_load_dwordx4 a[244:247], v1, s[4:7], s18 offen offset:1024 sc1
    buffer_load_dwordx4 a[248:251], v1, s[4:7], s18 offen offset:2048 sc1
    buffer_load_dwordx4 a[252:255], v1, s[4:7], s18 offen offset:3072 sc1
    s_waitcnt vmcnt(0)
    s_mov_b32 s44, 0
    s_mov_b32 s37, s35
    v_mov_b32 v250, 1
    v_mov_b32 v251, 163832
    v_cmp_eq_u32 vcc, 0, v0
    s_nop 0
    s_and_saveexec_b64 s[38:39], vcc
    s_cbranch_execz tk19
    buffer_atomic_add v250, off, s[84:87], s37 sc0
    s_waitcnt vmcnt(0)
    ds_write_b32 v251, v250
    s_waitcnt lgkmcnt(0)
tk19:
    s_mov_b64 exec, -1
    s_barrier
    ds_read_b32 v252, v251
    s_waitcnt lgkmcnt(0)
    v_readfirstlane_b32 s16, v252
    s_barrier
    s_nop 3
    s_cmp_ge_u32 s16, 72
    s_cbranch_scc1 L_op_nextcb
L_op_seg:
    s_min_u32 s43, s16, 56
    s_add_u32 s16, s16, s43
    s_lshr_b32 s43, s16, 1
    s_add_u32 s43, s43, 2
    s_min_u32 s43, s43, 63
    s_lshl_b32 s94, s33, 7
    s_add_u32 s94, s94, s16
    s_mov_b32 s88, 65536
    s_mov_b32 s89, 125853696
cw20:
    buffer_load_dword v3, off, s[4:7], s89 sc1
    s_waitcnt vmcnt(0)
    v_readfirstlane_b32 s42, v3
    s_nop 0
    s_sub_u32 s42, s42, s95
    s_cmp_gt_u32 s42, 64
    s_cselect_b32 s42, 0, s42
    s_add_u32 s42, s42, 1
    s_cmp_ge_u32 s42, s43
    s_cbranch_scc1 cw20x
    s_sub_u32 s88, s88, 1
    s_cbranch_scc1 cw20x
    s_sub_u32 s42, s43, s42
    s_min_u32 s42, s42, 6
cw20s:
    s_sleep 24
    s_sub_u32 s42, s42, 1
    s_cmp_lg_u32 s42, 0
    s_cbranch_scc1 cw20s
    s_branch cw20
cw20x:
    s_lshr_b32 s89, s16, 1
    s_lshl_b32 s89, s89, 2
    s_add_u32 s89, s89, s32
    s_lshl_b32 s89, s89, 7
    s_add_u32 s89, s89, 125894656
    v_mbcnt_lo_u32_b32 v2, -1, 0
    v_mbcnt_hi_u32_b32 v2, -1, v2
    v_min_u32 v2, 1, v2
    v_lshlrev_b32 v2, 2, v2
    s_mov_b32 s88, 4194304
fw21:
    buffer_load_dword v3, v2, s[4:7], s89 offen offset:0 sc1
    s_sub_u32 s88, s88, 1
    s_cbranch_scc1 fw21x
    s_waitcnt vmcnt(0)
    v_cmp_ne_u32 vcc, s95, v3
    s_cbranch_vccz fw21x
    s_sleep 2
    s_branch fw21
fw21x:
    v_mov_b32 v250, 1
    v_lshrrev_b32 v252, 2, v1
    v_min_u32 v252, 68, v252
    s_cmp_lg_u32 s32, 0
    s_cbranch_scc1 L_op_na
    s_mov_b64 exec, 1
    buffer_atomic_add v250, off, s[84:87], s35 sc0
    s_mov_b64 exec, -1
    s_cmp_lg_u32 s44, 0
    s_cbranch_scc1 L_op_na
    buffer_load_dword v253, v252, s[84:87], 0 offen offset:136 sc1
L_op_na:
    s_cmp_ge_u32 s16, 112
    s_cbranch_scc1 L_op_one
    s_lshl_b32 s18, s16, 17
    s_lshl_b32 s19, s32, 15
    s_add_u32 s18, s18, s19
    s_add_u32 s18, s18, 50331648
    buffer_load_dwordx4 v[24:27], v1, s[4:7], s18 offen offset:0 sc1
    buffer_load_dwordx4 v[28:31], v1, s[4:7], s18 offen offset:1024 sc1
    buffer_load_dwordx4 v[32:35], v1, s[4:7], s18 offen offset:2048 sc1
    buffer_load_dwordx4 v[36:39], v1, s[4:7], s18 offen offset:3072 sc1
    s_add_u32 s18, s18, 4096
    buffer_load_dwordx4 v[40:43], v1, s[4:7], s18 offen offset:0 sc1
    buffer_load_dwordx4 v[44:47], v1, s[4:7], s18 offen offset:1024 sc1
    buffer_load_dwordx4 v[48:51], v1, s[4:7], s18 offen offset:2048 sc1
    buffer_load_dwordx4 v[52:55], v1, s[4:7], s18 offen offset:3072 sc1
    s_add_u32 s18, s18, 4096
    buffer_load_dwordx4 v[56:59], v1, s[4:7], s18 offen offset:0 sc1
    buffer_load_dwordx4 v[60:63], v1, s[4:7], s18 offen offset:1024 sc1
    buffer_load_dwordx4 v[64:67], v1, s[4:7], s18 offen offset:2048 sc1
    buffer_load_dwordx4 v[68:71], v1, s[4:7], s18 offen offset:3072 sc1
    s_add_u32 s18, s18, 4096
    buffer_load_dwordx4 v[72:75], v1, s[4:7], s18 offen offset:0 sc1
    buffer_load_dwordx4 v[76:79], v1, s[4:7], s18 offen offset:1024 sc1
    buffer_load_dwordx4 v[80:83], v1, s[4:7], s18 offen offset:2048 sc1
    buffer_load_dwordx4 v[84:87], v1, s[4:7], s18 offen offset:3072 sc1
    s_add_u32 s18, s18, 4096
    buffer_load_dwordx4 v[88:91], v1, s[4:7], s18 offen offset:0 sc1
    buffer_load_dwordx4 v[92:95], v1, s[4:7], s18 offen offset:1024 sc1
    buffer_load_dwordx4 v[96:99], v1, s[4:7], s18 offen offset:2048 sc1
    buffer_load_dwordx4 v[100:103], v1, s[4:7], s18 offen offset:3072 sc1
    s_add_u32 s18, s18, 4096
    buffer_load_dwordx4 v[104:107], v1, s[4:7], s18 offen offset:0 sc1
    buffer_load_dwordx4 v[108:111], v1, s[4:7], s18 offen offset:1024 sc1
    buffer_load_dwordx4 v[112:115], v1, s[4:7], s18 offen offset:2048 sc1
    buffer_load_dwordx4 v[116:119], v1, s[4:7], s18 offen offset:3072 sc1
    s_add_u32 s18, s18, 4096
    buffer_load_dwordx4 v[120:123], v1, s[4:7], s18 offen offset:0 sc1
    buffer_load_dwordx4 v[124:127], v1, s[4:7], s18 offen offset:1024 sc1
    buffer_load_dwordx4 v[128:131], v1, s[4:7], s18 offen offset:2048 sc1
    buffer_load_dwordx4 v[132:135], v1, s[4:7], s18 offen offset:3072 sc1
    s_add_u32 s18, s18, 4096
    buffer_load_dwordx4 v[136:139], v1, s[4:7], s18 offen offset:0 sc1
    buffer_load_dwordx4 v[140:143], v1, s[4:7], s18 offen offset:1024 sc1
    buffer_load_dwordx4 v[144:147], v1, s[4:7], s18 offen offset:2048 sc1
    buffer_load_dwordx4 v[148:151], v1, s[4:7], s18 offen offset:3072 sc1
    s_add_u32 s18, s18, 102400
    buffer_load_dwordx4 v[152:155], v1, s[4:7], s18 offen offset:0 sc1
    buffer_load_dwordx4 v[156:159], v1, s[4:7], s18 offen offset:1024 sc1
    buffer_load_dwordx4 v[160:163], v1, s[4:7], s18 offen offset:2048 sc1
    buffer_load_dwordx4 v[164:167], v1, s[4:7], s18 offen offset:3072 sc1
    s_add_u32 s18, s18, 4096
    buffer_load_dwordx4 v[168:171], v1, s[4:7], s18 offen offset:0 sc1
    buffer_load_dwordx4 v[172:175], v1, s[4:7], s18 offen offset:1024 sc1
    buffer_load_dwordx4 v[176:179], v1, s[4:7], s18 offen offset:2048 sc1
    buffer_load_dwordx4 v[180:183], v1, s[4:7], s18 offen offset:3072 sc1
    s_add_u32 s18, s18, 4096
    buffer_load_dwordx4 v[184:187], v1, s[4:7], s18 offen offset:0 sc1
    buffer_load_dwordx4 v[188:191], v1, s[4:7], s18 offen offset:1024 sc1
    buffer_load_dwordx4 v[192:195], v1, s[4:7], s18 offen offset:2048 sc1
    buffer_load_dwordx4 v[196:199], v1, s[4:7], s18 offen offset:3072 sc1
    s_add_u32 s18, s18, 4096
    buffer_load_dwordx4 v[200:203], v1, s[4:7], s18 offen offset:0 sc1
    buffer_load_dwordx4 v[204:207], v1, s[4:7], s18 offen offset:1024 sc1
    buffer_load_dwordx4 v[208:211], v1, s[4:7], s18 offen offset:2048 sc1
    buffer_load_dwordx4 v[212:215], v1, s[4:7], s18 offen offset:3072 sc1
    s_add_u32 s18, s18, 4096
    buffer_load_dwordx4 v[216:219], v1, s[4:7], s18 offen offset:0 sc1
    buffer_load_dwordx4 v[220:223], v1, s[4:7], s18 offen offset:1024 sc1
    buffer_load_dwordx4 v[224:227], v1, s[4:7], s18 offen offset:2048 sc1
    buffer_load_dwordx4 v[228:231], v1, s[4:7], s18 offen offset:3072 sc1
    s_add_u32 s18, s18, 4096
    buffer_load_dwordx4 v[232:235], v1, s[4:7], s18 offen offset:0 sc1
    buffer_load_dwordx4 v[236:239], v1, s[4:7], s18 offen offset:1024 sc1
    buffer_load_dwordx4 v[240:243], v1, s[4:7], s18 offen offset:2048 sc1
    buffer_load_dwordx4 v[244:247], v1, s[4:7], s18 offen offset:3072 sc1
    v_lshlrev_b32 v2, 4, v0
    v_and_b32 v3, 3072, v2
    v_lshl_add_u32 v2, v3, 1, v1
    s_waitcnt vmcnt(55)
    v_mfma_f32_16x16x32_bf16 v[8:11], a[0:3], v[24:27], 0
    v_mfma_f32_16x16x32_bf16 v[12:15], a[4:7], v[24:27], 0
    s_add_u32 s18, s18, 4096
    buffer_load_dwordx4 v[24:27], v1, s[4:7], s18 offen offset:0 sc1
    s_waitcnt vmcnt(55)
    v_mfma_f32_16x16x32_bf16 v[8:11], a[8:11], v[28:31], v[8:11]
    v_mfma_f32_16x16x32_bf16 v[12:15], a[12:15], v[28:31], v[12:15]
    buffer_load_dwordx4 v[28:31], v1, s[4:7], s18 offen offset:1024 sc1
    s_waitcnt vmcnt(55)
    v_mfma_f32_16x16x32_bf16 v[8:11], a[16:19], v[32:35], v[8:11]
    v_mfma_f32_16x16x32_bf16 v[12:15], a[20:23], v[32:35], v[12:15]
    buffer_load_dwordx4 v[32:35], v1, s[4:7], s18 offen offset:2048 sc1
    s_waitcnt vmcnt(55)
    v_mfma_f32_16x16x32_bf16 v[8:11], a[24:27], v[36:39], v[8:11]
    v_mfma_f32_16x16x32_bf16 v[12:15], a[28:31], v[36:39], v[12:15]
    buffer_load_dwordx4 v[36:39], v1, s[4:7], s18 offen offset:3072 sc1
    s_waitcnt vmcnt(55)
    v_mfma_f32_16x16x32_bf16 v[8:11], a[32:35], v[40:43], v[8:11]
    v_mfma_f32_16x16x32_bf16 v[12:15], a[36:39], v[40:43], v[12:15]
    s_add_u32 s18, s18, 4096
    buffer_load_dwordx4 v[40:43], v1, s[4:7], s18 offen offset:0 sc1
    s_waitcnt vmcnt(55)
    v_mfma_f32_16x16x32_bf16 v[8:11], a[40:43], v[44:47], v[8:11]
    v_mfma_f32_16x16x32_bf16 v[12:15], a[44:47], v[44:47], v[12:15]
    buffer_load_dwordx4 v[44:47], v1, s[4:7], s18 offen offset:1024 sc1
    s_waitcnt vmcnt(55)
    v_mfma_f32_16x16x32_bf16 v[8:11], a[48:51], v[48:51], v[8:11]
    v_mfma_f32_16x16x32_bf16 v[12:15], a[52:55], v[48:51], v[12:15]
    buffer_load_dwordx4 v[48:51], v1, s[4:7], s18 offen offset:2048 sc1
    s_waitcnt vmcnt(55)
    v_mfma_f32_16x16x32_bf16 v[8:11], a[56:59], v[52:55], v[8:11]
    v_mfma_f32_16x16x32_bf16 v[12:15], a[60:63], v[52:55], v[12:15]
    buffer_load_dwordx4 v[52:55], v1, s[4:7], s18 offen offset:3072 sc1
    s_waitcnt vmcnt(55)
    v_mfma_f32_16x16x32_bf16 v[8:11], a[64:67], v[56:59], v[8:11]
    v_mfma_f32_16x16x32_bf16 v[12:15], a[68:71], v[56:59], v[12:15]
    s_waitcnt vmcnt(54)
    v_mfma_f32_16x16x32_bf16 v[8:11], a[72:75], v[60:63], v[8:11]
    v_mfma_f32_16x16x32_bf16 v[12:15], a[76:79], v[60:63], v[12:15]
    s_waitcnt vmcnt(53)
    v_mfma_f32_16x16x32_bf16 v[8:11], a[80:83], v[64:67], v[8:11]
    v_mfma_f32_16x16x32_bf16 v[12:15], a[84:87], v[64:67], v[12:15]
    s_waitcnt vmcnt(52)
    v_mfma_f32_16x16x32_bf16 v[8:11], a[88:91], v[68:71], v[8:11]
    v_mfma_f32_16x16x32_bf16 v[12:15], a[92:95], v[68:71], v[12:15]
    s_waitcnt vmcnt(51)
    v_mfma_f32_16x16x32_bf16 v[8:11], a[96:99], v[72:75], v[8:11]
    v_mfma_f32_16x16x32_bf16 v[12:15], a[100:103], v[72:75], v[12:15]
    s_waitcnt vmcnt(50)
    v_mfma_f32_16x16x32_bf16 v[8:11], a[104:107], v[76:79], v[8:11]
    v_mfma_f32_16x16x32_bf16 v[12:15], a[108:111], v[76:79], v[12:15]
    s_waitcnt vmcnt(49)
    v_mfma_f32_16x16x32_bf16 v[8:11], a[112:115], v[80:83], v[8:11]
    v_mfma_f32_16x16x32_bf16 v[12:15], a[116:119], v[80:83], v[12:15]
    s_waitcnt vmcnt(48)
    v_mfma_f32_16x16x32_bf16 v[8:11], a[120:123], v[84:87], v[8:11]
    v_mfma_f32_16x16x32_bf16 v[12:15], a[124:127], v[84:87], v[12:15]
    s_waitcnt vmcnt(47)
    v_mfma_f32_16x16x32_bf16 v[8:11], a[128:131], v[88:91], v[8:11]
    v_mfma_f32_16x16x32_bf16 v[12:15], a[132:135], v[88:91], v[12:15]
    s_waitcnt vmcnt(46)
    v_mfma_f32_16x16x32_bf16 v[8:11], a[136:139], v[92:95], v[8:11]
    v_mfma_f32_16x16x32_bf16 v[12:15], a[140:143], v[92:95], v[12:15]
    s_waitcnt vmcnt(45)
    v_mfma_f32_16x16x32_bf16 v[8:11], a[144:147], v[96:99], v[8:11]
    v_mfma_f32_16x16x32_bf16 v[12:15], a[148:151], v[96:99], v[12:15]
    s_waitcnt vmcnt(44)
    v_mfma_f32_16x16x32_bf16 v[8:11], a[152:155], v[100:103], v[8:11]
    v_mfma_f32_16x16x32_bf16 v[12:15], a[156:159], v[100:103], v[12:15]
    s_waitcnt vmcnt(43)
    v_mfma_f32_16x16x32_bf16 v[8:11], a[160:163], v[104:107], v[8:11]
    v_mfma_f32_16x16x32_bf16 v[12:15], a[164:167], v[104:107], v[12:15]
    s_waitcnt vmcnt(42)
    v_mfma_f32_16x16x32_bf16 v[8:11], a[168:171], v[108:111], v[8:11]
    v_mfma_f32_16x16x32_bf16 v[12:15], a[172:175], v[108:111], v[12:15]
    s_waitcnt vmcnt(41)
    v_mfma_f32_16x16x32_bf16 v[8:11], a[176:179], v[112:115], v[8:11]
    v_mfma_f32_16x16x32_bf16 v[12:15], a[180:183], v[112:115], v[12:15]
    s_waitcnt vmcnt(40)
    v_mfma_f32_16x16x32_bf16 v[8:11], a[184:187], v[116:119], v[8:11]
    v_mfma_f32_16x16x32_bf16 v[12:15], a[188:191], v[116:119], v[12:15]
    s_waitcnt vmcnt(39)
    v_mfma_f32_16x16x32_bf16 v[8:11], a[192:195], v[120:123], v[8:11]
    v_mfma_f32_16x16x32_bf16 v[12:15], a[196:199], v[120:123], v[12:15]
    s_waitcnt vmcnt(38)
    v_mfma_f32_16x16x32_bf16 v[8:11], a[200:203], v[124:127], v[8:11]
    v_mfma_f32_16x16x32_bf16 v[12:15], a[204:207], v[124:127], v[12:15]
    s_waitcnt vmcnt(37)
    v_mfma_f32_16x16x32_bf16 v[8:11], a[208:211], v[128:131], v[8:11]
    v_mfma_f32_16x16x32_bf16 v[12:15], a[212:215], v[128:131], v[12:15]
    s_waitcnt vmcnt(36)
    v_mfma_f32_16x16x32_bf16 v[8:11], a[216:219], v[132:135], v[8:11]
    v_mfma_f32_16x16x32_bf16 v[12:15], a[220:223], v[132:135], v[12:15]
    s_waitcnt vmcnt(35)
    v_mfma_f32_16x16x32_bf16 v[8:11], a[224:227], v[136:139], v[8:11]
    v_mfma_f32_16x16x32_bf16 v[12:15], a[228:231], v[136:139], v[12:15]
    s_waitcnt vmcnt(34)
    v_mfma_f32_16x16x32_bf16 v[8:11], a[232:235], v[140:143], v[8:11]
    v_mfma_f32_16x16x32_bf16 v[12:15], a[236:239], v[140:143], v[12:15]
    s_waitcnt vmcnt(33)
    v_mfma_f32_16x16x32_bf16 v[8:11], a[240:243], v[144:147], v[8:11]
    v_mfma_f32_16x16x32_bf16 v[12:15], a[244:247], v[144:147], v[12:15]
    s_waitcnt vmcnt(32)
    v_mfma_f32_16x16x32_bf16 v[8:11], a[248:251], v[148:151], v[8:11]
    v_mfma_f32_16x16x32_bf16 v[12:15], a[252:255], v[148:151], v[12:15]
    s_waitcnt vmcnt(31)
    v_mfma_f32_16x16x32_bf16 v[16:19], a[0:3], v[152:155], 0
    v_mfma_f32_16x16x32_bf16 v[20:23], a[4:7], v[152:155], 0
    s_waitcnt vmcnt(30)
    v_mfma_f32_16x16x32_bf16 v[16:19], a[8:11], v[156:159], v[16:19]
    v_mfma_f32_16x16x32_bf16 v[20:23], a[12:15], v[156:159], v[20:23]
    s_waitcnt vmcnt(29)
    v_mfma_f32_16x16x32_bf16 v[16:19], a[16:19], v[160:163], v[16:19]
    v_mfma_f32_16x16x32_bf16 v[20:23], a[20:23], v[160:163], v[20:23]
    s_waitcnt vmcnt(28)
    v_mfma_f32_16x16x32_bf16 v[16:19], a[24:27], v[164:167], v[16:19]
    v_mfma_f32_16x16x32_bf16 v[20:23], a[28:31], v[164:167], v[20:23]
    s_waitcnt vmcnt(27)
    v_mfma_f32_16x16x32_bf16 v[16:19], a[32:35], v[168:171], v[16:19]
    v_mfma_f32_16x16x32_bf16 v[20:23], a[36:39], v[168:171], v[20:23]
    s_waitcnt vmcnt(26)
    v_mfma_f32_16x16x32_bf16 v[16:19], a[40:43], v[172:175], v[16:19]
    v_mfma_f32_16x16x32_bf16 v[20:23], a[44:47], v[172:175], v[20:23]
    s_waitcnt vmcnt(25)
    v_mfma_f32_16x16x32_bf16 v[16:19], a[48:51], v[176:179], v[16:19]
    v_mfma_f32_16x16x32_bf16 v[20:23], a[52:55], v[176:179], v[20:23]
    s_waitcnt vmcnt(24)
    v_mfma_f32_16x16x32_bf16 v[16:19], a[56:59], v[180:183], v[16:19]
    v_mfma_f32_16x16x32_bf16 v[20:23], a[60:63], v[180:183], v[20:23]
    s_waitcnt vmcnt(23)
    v_mfma_f32_16x16x32_bf16 v[16:19], a[64:67], v[184:187], v[16:19]
    v_mfma_f32_16x16x32_bf16 v[20:23], a[68:71], v[184:187], v[20:23]
    s_waitcnt vmcnt(22)
    v_mfma_f32_16x16x32_bf16 v[16:19], a[72:75], v[188:191], v[16:19]
    v_mfma_f32_16x16x32_bf16 v[20:23], a[76:79], v[188:191], v[20:23]
    s_waitcnt vmcnt(21)
    v_mfma_f32_16x16x32_bf16 v[16:19], a[80:83], v[192:195], v[16:19]
    v_mfma_f32_16x16x32_bf16 v[20:23], a[84:87], v[192:195], v[20:23]
    s_waitcnt vmcnt(20)
    v_mfma_f32_16x16x32_bf16 v[16:19], a[88:91], v[196:199], v[16:19]
    v_mfma_f32_16x16x32_bf16 v[20:23], a[92:95], v[196:199], v[20:23]
    s_waitcnt vmcnt(19)
    v_mfma_f32_16x16x32_bf16 v[16:19], a[96:99], v[200:203], v[16:19]
    v_mfma_f32_16x16x32_bf16 v[20:23], a[100:103], v[200:203], v[20:23]
    s_waitcnt vmcnt(18)
    v_mfma_f32_16x16x32_bf16 v[16:19], a[104:107], v[204:207], v[16:19]
    v_mfma_f32_16x16x32_bf16 v[20:23], a[108:111], v[204:207], v[20:23]
    s_waitcnt vmcnt(17)
    v_mfma_f32_16x16x32_bf16 v[16:19], a[112:115], v[208:211], v[16:19]
    v_mfma_f32_16x16x32_bf16 v[20:23], a[116:119], v[208:211], v[20:23]
    s_waitcnt vmcnt(16)
    v_mfma_f32_16x16x32_bf16 v[16:19], a[120:123], v[212:215], v[16:19]
    v_mfma_f32_16x16x32_bf16 v[20:23], a[124:127], v[212:215], v[20:23]
    s_waitcnt vmcnt(15)
    v_mfma_f32_16x16x32_bf16 v[16:19], a[128:131], v[216:219], v[16:19]
    v_mfma_f32_16x16x32_bf16 v[20:23], a[132:135], v[216:219], v[20:23]
    s_waitcnt vmcnt(14)
    v_mfma_f32_16x16x32_bf16 v[16:19], a[136:139], v[220:223], v[16:19]
    v_mfma_f32_16x16x32_bf16 v[20:23], a[140:143], v[220:223], v[20:23]
    s_waitcnt vmcnt(13)
    v_mfma_f32_16x16x32_bf16 v[16:19], a[144:147], v[224:227], v[16:19]
    v_mfma_f32_16x16x32_bf16 v[20:23], a[148:151], v[224:227], v[20:23]
    s_waitcnt vmcnt(12)
    v_mfma_f32_16x16x32_bf16 v[16:19], a[152:155], v[228:231], v[16:19]
    v_mfma_f32_16x16x32_bf16 v[20:23], a[156:159], v[228:231], v[20:23]
    s_waitcnt vmcnt(11)
    v_mfma_f32_16x16x32_bf16 v[16:19], a[160:163], v[232:235], v[16:19]
    v_mfma_f32_16x16x32_bf16 v[20:23], a[164:167], v[232:235], v[20:23]
    s_waitcnt vmcnt(10)
    v_mfma_f32_16x16x32_bf16 v[16:19], a[168:171], v[236:239], v[16:19]
    v_mfma_f32_16x16x32_bf16 v[20:23], a[172:175], v[236:239], v[20:23]
    s_waitcnt vmcnt(9)
    v_mfma_f32_16x16x32_bf16 v[16:19], a[176:179], v[240:243], v[16:19]
    v_mfma_f32_16x16x32_bf16 v[20:23], a[180:183], v[240:243], v[20:23]
    s_waitcnt vmcnt(8)
    v_mfma_f32_16x16x32_bf16 v[16:19], a[184:187], v[244:247], v[16:19]
    v_mfma_f32_16x16x32_bf16 v[20:23], a[188:191], v[244:247], v[20:23]
    s_waitcnt vmcnt(7)
    v_mfma_f32_16x16x32_bf16 v[16:19], a[192:195], v[24:27], v[16:19]
    v_mfma_f32_16x16x32_bf16 v[20:23], a[196:199], v[24:27], v[20:23]
    s_waitcnt vmcnt(6)
    v_mfma_f32_16x16x32_bf16 v[16:19], a[200:203], v[28:31], v[16:19]
    v_mfma_f32_16x16x32_bf16 v[20:23], a[204:207], v[28:31], v[20:23]
    s_waitcnt vmcnt(5)
    v_mfma_f32_16x16x32_bf16 v[16:19], a[208:211], v[32:35], v[16:19]
    v_mfma_f32_16x16x32_bf16 v[20:23], a[212:215], v[32:35], v[20:23]
    s_waitcnt vmcnt(4)
    v_mfma_f32_16x16x32_bf16 v[16:19], a[216:219], v[36:39], v[16:19]
    v_mfma_f32_16x16x32_bf16 v[20:23], a[220:223], v[36:39], v[20:23]
    s_waitcnt vmcnt(3)
    v_mfma_f32_16x16x32_bf16 v[16:19], a[224:227], v[40:43], v[16:19]
    v_mfma_f32_16x16x32_bf16 v[20:23], a[228:231], v[40:43], v[20:23]
    s_waitcnt vmcnt(2)
    v_mfma_f32_16x16x32_bf16 v[16:19], a[232:235], v[44:47], v[16:19]
    v_mfma_f32_16x16x32_bf16 v[20:23], a[236:239], v[44:47], v[20:23]
    s_waitcnt vmcnt(1)
    v_mfma_f32_16x16x32_bf16 v[16:19], a[240:243], v[48:51], v[16:19]
    v_mfma_f32_16x16x32_bf16 v[20:23], a[244:247], v[48:51], v[20:23]
    s_waitcnt vmcnt(0)
    v_mfma_f32_16x16x32_bf16 v[16:19], a[248:251], v[52:55], v[16:19]
    v_mfma_f32_16x16x32_bf16 v[20:23], a[252:255], v[52:55], v[20:23]
    ds_write_b128 v2, v[8:11] offset:0
    ds_write_b128 v2, v[12:15] offset:1024
    s_nop 4
    ds_write_b128 v2, v[16:19] offset:8192
    ds_write_b128 v2, v[20:23] offset:9216
    s_cmp_lg_u32 s32, 0
    s_cbranch_scc1 o2_nb
    v_cmp_eq_u32 vcc, 0, v253
    s_nop 0
    s_cmp_eq_u64 vcc, 0
    s_cselect_b32 s44, 65536, 0
    v_or_b32 v250, s44, v250
    v_mov_b32 v251, 163832
    s_mov_b64 exec, 1
    ds_write_b32 v251, v250
    s_mov_b64 exec, -1
o2_nb:
    s_waitcnt lgkmcnt(0)
    s_barrier
    s_cmp_gt_u32 s32, 1
    s_cbranch_scc1 o2_skip
    s_lshl_b32 s18, s32, 13
    v_add_u32 v2, s18, v1
    ds_read_b128 v[24:27], v2 offset:0
    ds_read_b128 v[28:31], v2 offset:1024
    ds_read_b128 v[32:35], v2 offset:2048
    ds_read_b128 v[36:39], v2 offset:3072
    ds_read_b128 v[40:43], v2 offset:4096
    ds_read_b128 v[44:47], v2 offset:5120
    ds_read_b128 v[48:51], v2 offset:6144
    ds_read_b128 v[52:55], v2 offset:7168
    v_lshrrev_b32 v3, 4, v1
    v_bfe_u32 v4, v3, 2, 2
    v_lshlrev_b32 v4, 3, v4
    v_and_b32 v2, 3, v3
    v_add_u32 v4, v4, v2
    v_mul_u32_u24 v4, 2304, v4
    v_lshrrev_b32 v3, 4, v3
    v_lshl_add_u32 v4, v3, 4, v4
    s_add_u32 s20, s16, s32
    s_lshr_b32 s18, s20, 1
    s_lshl_b32 s18, s18, 3
    s_and_b32 s19, s20, 1
    s_add_u32 s18, s18, s19
    s_mul_i32 s18, s18, 9216
    s_lshl_b32 s19, s33, 6
    s_add_u32 s18, s18, s19
    s_waitcnt lgkmcnt(0)
    v_pk_add_f32 v[24:25], v[24:25], v[32:33]
    v_pk_add_f32 v[40:41], v[40:41], v[48:49]
    v_pk_add_f32 v[24:25], v[24:25], v[40:41]
    v_pk_add_f32 v[26:27], v[26:27], v[34:35]
    v_pk_add_f32 v[42:43], v[42:43], v[50:51]
    v_pk_add_f32 v[26:27], v[26:27], v[42:43]
    v_pk_add_f32 v[28:29], v[28:29], v[36:37]
    v_pk_add_f32 v[44:45], v[44:45], v[52:53]
    v_pk_add_f32 v[28:29], v[28:29], v[44:45]
    v_pk_add_f32 v[30:31], v[30:31], v[38:39]
    v_pk_add_f32 v[46:47], v[46:47], v[54:55]
    v_pk_add_f32 v[30:31], v[30:31], v[46:47]
    v_cvt_pk_bf16_f32 v8, v24, v28
    v_cvt_pk_bf16_f32 v9, v25, v29
    v_cvt_pk_bf16_f32 v10, v26, v30
    v_cvt_pk_bf16_f32 v11, v27, v31
    buffer_store_dwordx4 v[8:11], v4, s[8:11], s18 offen
o2_skip:
    s_nop 1
    s_branch L_op_fin
L_op_one:
    s_lshl_b32 s18, s16, 17
    s_lshl_b32 s19, s32, 15
    s_add_u32 s18, s18, s19
    s_add_u32 s18, s18, 50331648
    buffer_load_dwordx4 v[24:27], v1, s[4:7], s18 offen offset:0 sc1
    buffer_load_dwordx4 v[28:31], v1, s[4:7], s18 offen offset:1024 sc1
    buffer_load_dwordx4 v[32:35], v1, s[4:7], s18 offen offset:2048 sc1
    buffer_load_dwordx4 v[36:39], v1, s[4:7], s18 offen offset:3072 sc1
    s_add_u32 s18, s18, 4096
    buffer_load_dwordx4 v[40:43], v1, s[4:7], s18 offen offset:0 sc1
    buffer_load_dwordx4 v[44:47], v1, s[4:7], s18 offen offset:1024 sc1
    buffer_load_dwordx4 v[48:51], v1, s[4:7], s18 offen offset:2048 sc1
    buffer_load_dwordx4 v[52:55], v1, s[4:7], s18 offen offset:3072 sc1
    s_add_u32 s18, s18, 4096
    buffer_load_dwordx4 v[56:59], v1, s[4:7], s18 offen offset:0 sc1
    buffer_load_dwordx4 v[60:63], v1, s[4:7], s18 offen offset:1024 sc1
    buffer_load_dwordx4 v[64:67], v1, s[4:7], s18 offen offset:2048 sc1
    buffer_load_dwordx4 v[68:71], v1, s[4:7], s18 offen offset:3072 sc1
    s_add_u32 s18, s18, 4096
    buffer_load_dwordx4 v[72:75], v1, s[4:7], s18 offen offset:0 sc1
    buffer_load_dwordx4 v[76:79], v1, s[4:7], s18 offen offset:1024 sc1
    buffer_load_dwordx4 v[80:83], v1, s[4:7], s18 offen offset:2048 sc1
    buffer_load_dwordx4 v[84:87], v1, s[4:7], s18 offen offset:3072 sc1
    s_add_u32 s18, s18, 4096
    buffer_load_dwordx4 v[88:91], v1, s[4:7], s18 offen offset:0 sc1
    buffer_load_dwordx4 v[92:95], v1, s[4:7], s18 offen offset:1024 sc1
    buffer_load_dwordx4 v[96:99], v1, s[4:7], s18 offen offset:2048 sc1
    buffer_load_dwordx4 v[100:103], v1, s[4:7], s18 offen offset:3072 sc1
    s_add_u32 s18, s18, 4096
    buffer_load_dwordx4 v[104:107], v1, s[4:7], s18 offen offset:0 sc1
    buffer_load_dwordx4 v[108:111], v1, s[4:7], s18 offen offset:1024 sc1
    buffer_load_dwordx4 v[112:115], v1, s[4:7], s18 offen offset:2048 sc1
    buffer_load_dwordx4 v[116:119], v1, s[4:7], s18 offen offset:3072 sc1
    s_add_u32 s18, s18, 4096
    buffer_load_dwordx4 v[120:123], v1, s[4:7], s18 offen offset:0 sc1
    buffer_load_dwordx4 v[124:127], v1, s[4:7], s18 offen offset:1024 sc1
    buffer_load_dwordx4 v[128:131], v1, s[4:7], s18 offen offset:2048 sc1
    buffer_load_dwordx4 v[132:135], v1, s[4:7], s18 offen offset:3072 sc1
    s_add_u32 s18, s18, 4096
    buffer_load_dwordx4 v[136:139], v1, s[4:7], s18 offen offset:0 sc1
    buffer_load_dwordx4 v[140:143], v1, s[4:7], s18 offen offset:1024 sc1
    buffer_load_dwordx4 v[144:147], v1, s[4:7], s18 offen offset:2048 sc1
    buffer_load_dwordx4 v[148:151], v1, s[4:7], s18 offen offset:3072 sc1
    v_lshlrev_b32 v2, 4, v0
    v_and_b32 v3, 3072, v2
    v_lshl_add_u32 v2, v3, 1, v1
    s_waitcnt vmcnt(31)
    v_mfma_f32_16x16x32_bf16 v[8:11], a[0:3], v[24:27], 0
    v_mfma_f32_16x16x32_bf16 v[12:15], a[4:7], v[24:27], 0
    s_waitcnt vmcnt(30)
    v_mfma_f32_16x16x32_bf16 v[8:11], a[8:11], v[28:31], v[8:11]
    v_mfma_f32_16x16x32_bf16 v[12:15], a[12:15], v[28:31], v[12:15]
    s_waitcnt vmcnt(29)
    v_mfma_f32_16x16x32_bf16 v[8:11], a[16:19], v[32:35], v[8:11]
    v_mfma_f32_16x16x32_bf16 v[12:15], a[20:23], v[32:35], v[12:15]
    s_waitcnt vmcnt(28)
    v_mfma_f32_16x16x32_bf16 v[8:11], a[24:27], v[36:39], v[8:11]
    v_mfma_f32_16x16x32_bf16 v[12:15], a[28:31], v[36:39], v[12:15]
    s_waitcnt vmcnt(27)
    v_mfma_f32_16x16x32_bf16 v[8:11], a[32:35], v[40:43], v[8:11]
    v_mfma_f32_16x16x32_bf16 v[12:15], a[36:39], v[40:43], v[12:15]
    s_waitcnt vmcnt(26)
    v_mfma_f32_16x16x32_bf16 v[8:11], a[40:43], v[44:47], v[8:11]
    v_mfma_f32_16x16x32_bf16 v[12:15], a[44:47], v[44:47], v[12:15]
    s_waitcnt vmcnt(25)
    v_mfma_f32_16x16x32_bf16 v[8:11], a[48:51], v[48:51], v[8:11]
    v_mfma_f32_16x16x32_bf16 v[12:15], a[52:55], v[48:51], v[12:15]
    s_waitcnt vmcnt(24)
    v_mfma_f32_16x16x32_bf16 v[8:11], a[56:59], v[52:55], v[8:11]
    v_mfma_f32_16x16x32_bf16 v[12:15], a[60:63], v[52:55], v[12:15]
    s_waitcnt vmcnt(23)
    v_mfma_f32_16x16x32_bf16 v[8:11], a[64:67], v[56:59], v[8:11]
    v_mfma_f32_16x16x32_bf16 v[12:15], a[68:71], v[56:59], v[12:15]
    s_waitcnt vmcnt(22)
    v_mfma_f32_16x16x32_bf16 v[8:11], a[72:75], v[60:63], v[8:11]
    v_mfma_f32_16x16x32_bf16 v[12:15], a[76:79], v[60:63], v[12:15]
    s_waitcnt vmcnt(21)
    v_mfma_f32_16x16x32_bf16 v[8:11], a[80:83], v[64:67], v[8:11]
    v_mfma_f32_16x16x32_bf16 v[12:15], a[84:87], v[64:67], v[12:15]
    s_waitcnt vmcnt(20)
    v_mfma_f32_16x16x32_bf16 v[8:11], a[88:91], v[68:71], v[8:11]
    v_mfma_f32_16x16x32_bf16 v[12:15], a[92:95], v[68:71], v[12:15]
    s_waitcnt vmcnt(19)
    v_mfma_f32_16x16x32_bf16 v[8:11], a[96:99], v[72:75], v[8:11]
    v_mfma_f32_16x16x32_bf16 v[12:15], a[100:103], v[72:75], v[12:15]
    s_waitcnt vmcnt(18)
    v_mfma_f32_16x16x32_bf16 v[8:11], a[104:107], v[76:79], v[8:11]
    v_mfma_f32_16x16x32_bf16 v[12:15], a[108:111], v[76:79], v[12:15]
    s_waitcnt vmcnt(17)
    v_mfma_f32_16x16x32_bf16 v[8:11], a[112:115], v[80:83], v[8:11]
    v_mfma_f32_16x16x32_bf16 v[12:15], a[116:119], v[80:83], v[12:15]
    s_waitcnt vmcnt(16)
    v_mfma_f32_16x16x32_bf16 v[8:11], a[120:123], v[84:87], v[8:11]
    v_mfma_f32_16x16x32_bf16 v[12:15], a[124:127], v[84:87], v[12:15]
    s_waitcnt vmcnt(15)
    v_mfma_f32_16x16x32_bf16 v[8:11], a[128:131], v[88:91], v[8:11]
    v_mfma_f32_16x16x32_bf16 v[12:15], a[132:135], v[88:91], v[12:15]
    s_waitcnt vmcnt(14)
    v_mfma_f32_16x16x32_bf16 v[8:11], a[136:139], v[92:95], v[8:11]
    v_mfma_f32_16x16x32_bf16 v[12:15], a[140:143], v[92:95], v[12:15]
    s_waitcnt vmcnt(13)
    v_mfma_f32_16x16x32_bf16 v[8:11], a[144:147], v[96:99], v[8:11]
    v_mfma_f32_16x16x32_bf16 v[12:15], a[148:151], v[96:99], v[12:15]
    s_waitcnt vmcnt(12)
    v_mfma_f32_16x16x32_bf16 v[8:11], a[152:155], v[100:103], v[8:11]
    v_mfma_f32_16x16x32_bf16 v[12:15], a[156:159], v[100:103], v[12:15]
    s_waitcnt vmcnt(11)
    v_mfma_f32_16x16x32_bf16 v[8:11], a[160:163], v[104:107], v[8:11]
    v_mfma_f32_16x16x32_bf16 v[12:15], a[164:167], v[104:107], v[12:15]
    s_waitcnt vmcnt(10)
    v_mfma_f32_16x16x32_bf16 v[8:11], a[168:171], v[108:111], v[8:11]
    v_mfma_f32_16x16x32_bf16 v[12:15], a[172:175], v[108:111], v[12:15]
    s_waitcnt vmcnt(9)
    v_mfma_f32_16x16x32_bf16 v[8:11], a[176:179], v[112:115], v[8:11]
    v_mfma_f32_16x16x32_bf16 v[12:15], a[180:183], v[112:115], v[12:15]
    s_waitcnt vmcnt(8)
    v_mfma_f32_16x16x32_bf16 v[8:11], a[184:187], v[116:119], v[8:11]
    v_mfma_f32_16x16x32_bf16 v[12:15], a[188:191], v[116:119], v[12:15]
    s_waitcnt vmcnt(7)
    v_mfma_f32_16x16x32_bf16 v[8:11], a[192:195], v[120:123], v[8:11]
    v_mfma_f32_16x16x32_bf16 v[12:15], a[196:199], v[120:123], v[12:15]
    s_waitcnt vmcnt(6)
    v_mfma_f32_16x16x32_bf16 v[8:11], a[200:203], v[124:127], v[8:11]
    v_mfma_f32_16x16x32_bf16 v[12:15], a[204:207], v[124:127], v[12:15]
    s_waitcnt vmcnt(5)
    v_mfma_f32_16x16x32_bf16 v[8:11], a[208:211], v[128:131], v[8:11]
    v_mfma_f32_16x16x32_bf16 v[12:15], a[212:215], v[128:131], v[12:15]
    s_waitcnt vmcnt(4)
    v_mfma_f32_16x16x32_bf16 v[8:11], a[216:219], v[132:135], v[8:11]
    v_mfma_f32_16x16x32_bf16 v[12:15], a[220:223], v[132:135], v[12:15]
    s_waitcnt vmcnt(3)
    v_mfma_f32_16x16x32_bf16 v[8:11], a[224:227], v[136:139], v[8:11]
    v_mfma_f32_16x16x32_bf16 v[12:15], a[228:231], v[136:139], v[12:15]
    s_waitcnt vmcnt(2)
    v_mfma_f32_16x16x32_bf16 v[8:11], a[232:235], v[140:143], v[8:11]
    v_mfma_f32_16x16x32_bf16 v[12:15], a[236:239], v[140:143], v[12:15]
    s_waitcnt vmcnt(1)
    v_mfma_f32_16x16x32_bf16 v[8:11], a[240:243], v[144:147], v[8:11]
    v_mfma_f32_16x16x32_bf16 v[12:15], a[244:247], v[144:147], v[12:15]
    s_waitcnt vmcnt(0)
    v_mfma_f32_16x16x32_bf16 v[8:11], a[248:251], v[148:151], v[8:11]
    v_mfma_f32_16x16x32_bf16 v[12:15], a[252:255], v[148:151], v[12:15]
    s_nop 6
    ds_write_b128 v2, v[8:11] offset:0
    ds_write_b128 v2, v[12:15] offset:1024
    s_cmp_lg_u32 s32, 0
    s_cbranch_scc1 o1_nb
    v_cmp_eq_u32 vcc, 0, v253
    s_nop 0
    s_cmp_eq_u64 vcc, 0
    s_cselect_b32 s44, 65536, 0
    v_or_b32 v250, s44, v250
    v_mov_b32 v251, 163832
    s_mov_b64 exec, 1
    ds_write_b32 v251, v250
    s_mov_b64 exec, -1
o1_nb:
    s_waitcnt lgkmcnt(0)
    s_barrier
    s_cmp_gt_u32 s32, 0
    s_cbranch_scc1 o1_skip
    s_lshl_b32 s18, s32, 13
    v_add_u32 v2, s18, v1
    ds_read_b128 v[24:27], v2 offset:0
    ds_read_b128 v[28:31], v2 offset:1024
    ds_read_b128 v[32:35], v2 offset:2048
    ds_read_b128 v[36:39], v2 offset:3072
    ds_read_b128 v[40:43], v2 offset:4096
    ds_read_b128 v[44:47], v2 offset:5120
    ds_read_b128 v[48:51], v2 offset:6144
    ds_read_b128 v[52:55], v2 offset:7168
    v_lshrrev_b32 v3, 4, v1
    v_bfe_u32 v4, v3, 2, 2
    v_lshlrev_b32 v4, 3, v4
    v_and_b32 v2, 3, v3
    v_add_u32 v4, v4, v2
    v_mul_u32_u24 v4, 2304, v4
    v_lshrrev_b32 v3, 4, v3
    v_lshl_add_u32 v4, v3, 4, v4
    s_add_u32 s20, s16, s32
    s_lshr_b32 s18, s20, 1
    s_lshl_b32 s18, s18, 3
    s_and_b32 s19, s20, 1
    s_add_u32 s18, s18, s19
    s_mul_i32 s18, s18, 9216
    s_lshl_b32 s19, s33, 6
    s_add_u32 s18, s18, s19
    s_waitcnt lgkmcnt(0)
    v_pk_add_f32 v[24:25], v[24:25], v[32:33]
    v_pk_add_f32 v[40:41], v[40:41], v[48:49]
    v_pk_add_f32 v[24:25], v[24:25], v[40:41]
    v_pk_add_f32 v[26:27], v[26:27], v[34:35]
    v_pk_add_f32 v[42:43], v[42:43], v[50:51]
    v_pk_add_f32 v[26:27], v[26:27], v[42:43]
    v_pk_add_f32 v[28:29], v[28:29], v[36:37]
    v_pk_add_f32 v[44:45], v[44:45], v[52:53]
    v_pk_add_f32 v[28:29], v[28:29], v[44:45]
    v_pk_add_f32 v[30:31], v[30:31], v[38:39]
    v_pk_add_f32 v[46:47], v[46:47], v[54:55]
    v_pk_add_f32 v[30:31], v[30:31], v[46:47]
    v_cvt_pk_bf16_f32 v8, v24, v28
    v_cvt_pk_bf16_f32 v9, v25, v29
    v_cvt_pk_bf16_f32 v10, v26, v30
    v_cvt_pk_bf16_f32 v11, v27, v31
    buffer_store_dwordx4 v[8:11], v4, s[8:11], s18 offen
o1_skip:
    s_nop 1
L_op_fin:
    v_mov_b32 v251, 163832
    ds_read_b32 v252, v251
    s_waitcnt lgkmcnt(0)
    v_readfirstlane_b32 s40, v252
    s_nop 1
    s_cmp_ge_u32 s40, 65608
    s_cbranch_scc1 L_done
    s_barrier
    s_and_b32 s16, s40, 0xffff
    s_cmp_lt_u32 s16, 72
    s_cbranch_scc1 L_op_seg
L_op_nextcb:
    s_mov_b32 s40, -1
    s_cmp_lg_u32 s32, 0
    s_cbranch_scc1 L_op_dec
    v_and_b32 v1, 63, v0
    v_min_u32 v1, 17, v1
    v_lshlrev_b32 v2, 2, v1
    buffer_load_dword v3, v2, s[84:87], 0 offen offset:136 sc1
    s_waitcnt vmcnt(0)
    v_cmp_gt_u32 vcc, 52, v3
    s_nop 0
    s_and_b32 s40, vcc_lo, 262143
    s_lshl_b32 s41, s40, 18
    s_lshr_b32 s43, s40, 14
    s_or_b32 s42, s40, s41
    s_and_b32 s36, s45, 15
    s_bfm_b32 s37, s36, 0
    s_and_b32 s37, s37, 42315
    s_bcnt1_i32_b32 s37, s37
    s_lshr_b32 s36, s45, 4
    s_mul_i32 s36, s36, 8
    s_add_u32 s36, s36, s37
    s_add_u32 s36, s36, 38
    s_mul_hi_u32 s41, s36, 0x0e38e38f
    s_mul_i32 s41, s41, 18
    s_sub_u32 s41, s36, s41
    s_lshr_b64 s[42:43], s[42:43], s41
    s_ff1_i32_b64 s40, s[42:43]
    s_cmp_lt_i32 s40, 0
    s_cbranch_scc1 L_op_dec
    s_add_u32 s40, s40, s41
    s_sub_u32 s41, s40, 18
    s_cselect_b32 s40, s40, s41
L_op_dec:
    v_mov_b32 v250, s40
    v_mov_b32 v251, 163832
    s_cmp_lg_u32 s32, 0
    s_cbranch_scc1 L_op_nw
    ds_write_b32 v251, v250
    s_waitcnt lgkmcnt(0)
L_op_nw:
    s_barrier
    ds_read_b32 v252, v251
    s_waitcnt lgkmcnt(0)
    v_readfirstlane_b32 s33, v252
    s_barrier
    s_nop 1
    s_cmp_lt_u32 s33, 18
    s_cbranch_scc1 L_op_start
L_done:
L_exit:
    s_endpgm
.section .rodata,"a"
.p2align 6
.amdhsa_kernel concat_heads__memory_aug_recurrent_mem_tr__ssm_conv_s4d__prompt_kernel
  .amdhsa_next_free_vgpr 512
  .amdhsa_next_free_sgpr 102
  .amdhsa_accum_offset 256
  .amdhsa_group_segment_fixed_size 0
  .amdhsa_kernarg_size 136
  .amdhsa_user_sgpr_count 2
  .amdhsa_user_sgpr_kernarg_segment_ptr 1
  .amdhsa_system_sgpr_workgroup_id_x 1
.end_amdhsa_kernel
.text
```

```asm
; @launch grid=(256,1,1) block=(256,1,1) lds=163840
.amdgcn_target "amdgcn-amd-amdhsa--gfx950"
.text
.globl concat_heads__memory_aug_recurrent_mem_tr__ssm_conv_s4d__prompt_kernel
.p2align 8
.type concat_heads__memory_aug_recurrent_mem_tr__ssm_conv_s4d__prompt_kernel,@function
concat_heads__memory_aug_recurrent_mem_tr__ssm_conv_s4d__prompt_kernel:
    s_cmp_ge_u32 s2, 256
    s_cbranch_scc1 L_exit
    s_load_dwordx4 s[80:83], s[0:1], 120
    s_load_dwordx16 s[48:63], s[0:1], 0
    s_memrealtime s[90:91]
    v_lshrrev_b32 v1, 6, v0
    s_nop 0
    v_readfirstlane_b32 s32, v1
    s_waitcnt lgkmcnt(0)
    s_mov_b32 s4, s82
    s_mov_b32 s5, s83
    s_mov_b32 s6, 268435456
    s_mov_b32 s7, 0x20000
    s_mov_b32 s84, s80
    s_mov_b32 s85, s81
    s_mov_b32 s86, 256
    s_mov_b32 s87, 0x20000
    s_cmp_lg_u32 s32, 0
    s_cbranch_scc1 L_nod0
L_nod0:
    s_cmp_lg_u32 s32, 3
    s_cbranch_scc1 L_nowarm
    s_getpc_b64 s[44:45]
L_pcw:
    v_and_b32 v1, 63, v0
    v_lshlrev_b32 v1, 7, v1
    v_min_u32 v2, L_exit-L_pcw, v1
    global_load_dword v240, v2, s[44:45]
    v_add_u32 v1, 8192, v1
    v_min_u32 v2, L_exit-L_pcw, v1
    global_load_dword v241, v2, s[44:45]
    v_add_u32 v1, 8192, v1
    v_min_u32 v2, L_exit-L_pcw, v1
    global_load_dword v242, v2, s[44:45]
    v_add_u32 v1, 8192, v1
    v_min_u32 v2, L_exit-L_pcw, v1
    global_load_dword v243, v2, s[44:45]
    v_add_u32 v1, 8192, v1
    v_min_u32 v2, L_exit-L_pcw, v1
    global_load_dword v244, v2, s[44:45]
    v_add_u32 v1, 8192, v1
    v_min_u32 v2, L_exit-L_pcw, v1
    global_load_dword v245, v2, s[44:45]
    v_add_u32 v1, 8192, v1
    v_min_u32 v2, L_exit-L_pcw, v1
    global_load_dword v246, v2, s[44:45]
    v_add_u32 v1, 8192, v1
    v_min_u32 v2, L_exit-L_pcw, v1
    global_load_dword v247, v2, s[44:45]
    v_add_u32 v1, 8192, v1
    v_min_u32 v2, L_exit-L_pcw, v1
    global_load_dword v248, v2, s[44:45]
    v_add_u32 v1, 8192, v1
L_nowarm:
    s_getreg_b32 s3, hwreg(HW_REG_XCC_ID)
    s_and_b32 s3, s3, 15
    s_cmp_lg_u32 s3, 3
    s_cbranch_scc1 L_helper
    s_mov_b32 s37, 128
    v_mov_b32 v250, 1
    v_mov_b32 v251, 163832
    v_cmp_eq_u32 vcc, 0, v0
    s_nop 0
    s_and_saveexec_b64 s[38:39], vcc
    s_cbranch_execz tk1
    buffer_atomic_add v250, off, s[84:87], s37 sc0
    s_waitcnt vmcnt(0)
    ds_write_b32 v251, v250
    s_waitcnt lgkmcnt(0)
tk1:
    s_mov_b64 exec, -1
    s_barrier
    ds_read_b32 v252, v251
    s_waitcnt lgkmcnt(0)
    v_readfirstlane_b32 s12, v252
    s_barrier
    s_nop 3
    s_cmp_ge_u32 s12, 32
    s_cbranch_scc1 L_helper
L_chain:
    s_load_dwordx8 s[48:55], s[0:1], 8
    s_load_dwordx2 s[56:57], s[0:1], 40
    s_waitcnt lgkmcnt(0)
    v_lshrrev_b32 v77, 6, v0
    s_nop 0
    v_readfirstlane_b32 s13, v77
    v_lshlrev_b32 v65, 4, v0
    v_and_b32 v48, 63, v0
    s_mov_b32 s10, 4718592
    s_mov_b32 s11, 0x20000
    v_lshrrev_b32 v49, 3, v48
    v_mul_u32_u24 v18, 1152, v49
    v_and_b32 v49, 7, v48
    v_lshl_add_u32 v18, v49, 4, v18
    s_mul_i32 s40, s12, 147456
    s_lshl_b32 s41, s13, 8
    s_add_u32 s40, s40, s41
    s_mov_b32 s42, s40
    s_xor_b32 s41, s13, 0
    s_mul_i32 s41, s41, 36864
    s_add_u32 s60, s41, s40
    s_xor_b32 s41, s13, 1
    s_mul_i32 s41, s41, 36864
    s_add_u32 s61, s41, s40
    s_xor_b32 s41, s13, 2
    s_mul_i32 s41, s41, 36864
    s_add_u32 s62, s41, s40
    s_xor_b32 s41, s13, 3
    s_mul_i32 s41, s41, 36864
    s_add_u32 s63, s41, s40
    s_lshl_b32 s43, s13, 12
    s_mov_b64 s[8:9], s[56:57]
    s_add_u32 m0, s43, 0
    s_add_u32 s41, s60, 0
    buffer_load_dwordx4 v18, s[8:11], s41 offen offset:0 nt lds
    s_add_u32 s41, s60, 8192
    buffer_load_dwordx4 v18, s[8:11], s41 offen offset:1024 nt lds
    s_add_u32 s41, s60, 16384
    buffer_load_dwordx4 v18, s[8:11], s41 offen offset:2048 nt lds
    s_add_u32 s41, s60, 24576
    buffer_load_dwordx4 v18, s[8:11], s41 offen offset:3072 nt lds
    s_add_u32 m0, s43, 36864
    s_add_u32 s41, s61, 0
    buffer_load_dwordx4 v18, s[8:11], s41 offen offset:0 nt lds
    s_add_u32 s41, s61, 8192
    buffer_load_dwordx4 v18, s[8:11], s41 offen offset:1024 nt lds
    s_add_u32 s41, s61, 16384
    buffer_load_dwordx4 v18, s[8:11], s41 offen offset:2048 nt lds
    s_add_u32 s41, s61, 24576
    buffer_load_dwordx4 v18, s[8:11], s41 offen offset:3072 nt lds
    s_add_u32 m0, s43, 73728
    s_add_u32 s41, s62, 0
    buffer_load_dwordx4 v18, s[8:11], s41 offen offset:0 nt lds
    s_add_u32 s41, s62, 8192
    buffer_load_dwordx4 v18, s[8:11], s41 offen offset:1024 nt lds
    s_add_u32 s41, s62, 16384
    buffer_load_dwordx4 v18, s[8:11], s41 offen offset:2048 nt lds
    s_add_u32 s41, s62, 24576
    buffer_load_dwordx4 v18, s[8:11], s41 offen offset:3072 nt lds
    s_add_u32 m0, s43, 110592
    s_add_u32 s41, s63, 0
    buffer_load_dwordx4 v18, s[8:11], s41 offen offset:0 nt lds
    s_add_u32 s41, s63, 8192
    buffer_load_dwordx4 v18, s[8:11], s41 offen offset:1024 nt lds
    s_add_u32 s41, s63, 16384
    buffer_load_dwordx4 v18, s[8:11], s41 offen offset:2048 nt lds
    s_add_u32 s41, s63, 24576
    buffer_load_dwordx4 v18, s[8:11], s41 offen offset:3072 nt lds
    v_lshrrev_b32 v49, 1, v48
    v_mul_u32_u24 v19, 1152, v49
    v_and_b32 v49, 1, v48
    v_lshl_add_u32 v19, v49, 4, v19
    s_mul_i32 s41, s13, 224
    s_sub_u32 s41, 1024, s41
    v_add_u32 v19, s41, v19
    v_lshrrev_b32 v49, 4, v48
    v_lshlrev_b32 v50, 2, v49
    v_and_b32 v51, 15, v48
    v_xor_b32 v51, v51, v50
    v_lshlrev_b32 v51, 4, v51
    v_lshl_add_u32 v16, v49, 15, v51
    v_lshrrev_b32 v50, 1, v49
    v_lshl_add_u32 v17, v50, 16, v51
    v_and_b32 v50, 1, v49
    v_lshl_add_u32 v17, v50, 13, v17
    s_lshl_b32 s40, s12, 8
    s_mul_i32 s58, s13, 1048576
    s_add_u32 s58, s58, s40
    s_lshr_b32 s41, s13, 1
    s_mul_i32 s59, s41, 262144
    s_and_b32 s41, s13, 1
    s_lshl_b32 s41, s41, 14
    s_add_u32 s59, s59, s41
    s_add_u32 s59, s59, s40
    s_add_u32 s59, s59, 4194304
    v_bfe_u32 v50, v48, 2, 2
    v_xor_b32 v51, s13, v50
    v_lshlrev_b32 v20, 6, v51
    v_and_b32 v51, 3, v48
    v_lshl_add_u32 v20, v51, 4, v20
    v_lshrrev_b32 v23, 2, v48
    v_lshl_add_u32 v20, v23, 8, v20
    s_xor_b32 s41, s43, 0
    v_add_u32 v24, s41, v20
    s_xor_b32 s41, s43, 4096
    v_add_u32 v25, s41, v20
    s_xor_b32 s41, s43, 8192
    v_add_u32 v26, s41, v20
    s_xor_b32 s41, s43, 12288
    v_add_u32 v27, s41, v20
    v_and_b32 v23, 1, v50
    v_lshl_add_u32 v23, v49, 2, v23
    v_lshrrev_b32 v50, 1, v50
    v_lshlrev_b32 v21, 7, v23
    v_lshl_add_u32 v21, v50, 6, v21
    v_lshrrev_b32 v16, 1, v51
    v_lshl_add_u32 v21, v16, 5, v21
    v_and_b32 v16, 1, v51
    v_lshl_add_u32 v21, v16, 3, v21
    v_add_u32 v21, s43, v21
    v_lshlrev_b32 v22, 9, v50
    v_xor_b32 v22, v22, v21
    v_lshlrev_b32 v23, 5, v23
    v_lshl_add_u32 v23, v50, 10, v23
    v_lshl_add_u32 v23, v51, 3, v23
    v_add_u32 v23, s43, v23
    v_bfe_u32 v60, v65, 4, 6
    v_and_b32 v61, 15, v60
    v_lshrrev_b32 v62, 4, v60
    v_mov_b32 v64, 0x4444
    v_mov_b32 v77, 0xeeee
    v_cmp_lt_u32 vcc, 7, v61
    s_nop 1
    v_cndmask_b32 v64, v64, v77, vcc
    v_xor_b32 v66, 1024, v65
    v_xor_b32 v67, 2048, v65
    v_xor_b32 v68, 3072, v65
    v_and_b32 v69, 511, v65
    s_mul_i32 s96, s13, 36864
    s_add_u32 s96, s96, 16384
    v_lshlrev_b32 v70, 4, v60
    v_add_u32 v70, s96, v70
    v_lshrrev_b32 v79, 1, v69
    s_lshl_b32 s96, s13, 8
    s_add_u32 s96, s96, 14336
    s_lshl_b32 s33, s13, 10
    s_add_u32 s97, s33, 8192
    v_mov_b32 v77, s97
    v_mov_b32 v78, s96
    v_cmp_lt_u32 vcc, 31, v60
    s_nop 1
    v_cndmask_b32 v71, v77, v78, vcc
    v_add_u32 v71, v71, v79
    v_and_b32 v77, 7, v61
    v_lshrrev_b32 v78, 3, v61
    v_lshlrev_b32 v74, 4, v77
    v_lshl_add_u32 v73, v62, 7, v74
    v_lshl_add_u32 v73, v78, 3, v73
    s_lshl_b32 s96, s13, 9
    v_add_u32 v73, s96, v73
    v_lshrrev_b32 v74, 1, v74
    v_lshl_add_u32 v74, v78, 14, v74
    v_lshl_add_u32 v74, v62, 15, v74
    s_lshl_b32 s96, s13, 17
    v_add_u32 v74, s96, v74
    v_bfe_u32 v77, v61, 2, 1
    v_and_b32 v78, 3, v61
    s_cmp_lt_u32 s13, 2
    s_cselect_b64 vcc, -1, 0
    v_cndmask_b32 v77, 0, v77, vcc
    v_lshlrev_b32 v75, 7, v77
    v_lshl_add_u32 v75, v62, 4, v75
    v_lshl_add_u32 v75, v78, 2, v75
    v_lshlrev_b32 v58, 3, v77
    v_lshl_add_u32 v58, v78, 1, v58
    s_bfe_u32 s97, s12, 0x10001
    s_lshl_b32 s68, s97, 6
    s_lshl_b32 s97, s97, 2
    v_add_u32 v59, s97, v62
    s_bfe_u32 s96, s12, 0x10002
    s_and_b32 s40, s12, 1
    s_lshl_b32 s96, s96, 1
    s_add_u32 s96, s96, s40
    s_lshr_b32 s97, s12, 3
    s_lshl_b32 s98, s13, 2
    s_add_u32 s98, s98, s97
    s_lshl_b32 s98, s98, 2
    s_add_u32 s98, s98, s96
    s_lshl_b32 s98, s98, 8
    s_lshl_b32 s99, s13, 2
    s_add_u32 s99, s99, s96
    s_lshl_b32 s99, s99, 4
    s_lshl_b32 s41, s97, 1
    s_add_u32 s41, s41, s40
    s_lshl_b32 s41, s41, 7
    s_add_u32 s41, s41, 8192
    s_lshl_b32 s40, s40, 3
    s_add_u32 s40, s40, 512
    s_cmp_lt_u32 s13, 2
    s_cselect_b32 s96, 7, 4
    s_cselect_b32 s98, s98, s41
    s_cselect_b32 s99, s99, s40
    s_cselect_b32 s32, 1, 0
    s_add_u32 s68, s68, s98
    s_lshl_b32 s97, s97, s96
    s_add_u32 s99, s99, s97
    v_add_u32 v58, s99, v58
    s_and_b32 s97, s12, 4
    s_or_b32 s97, s97, s13
    s_cmp_eq_u32 s97, 2
    s_cselect_b32 s32, 2, s32
    s_mov_b32 s8, s48
    s_mov_b32 s9, s49
    s_mov_b32 s10, 9216
    v_mul_u32_u24 v77, 1152, v59
    v_lshl_add_u32 v77, v58, 1, v77
    buffer_load_dword v72, v77, s[8:11], 0 offen
    s_mov_b32 s10, 4718592
    s_waitcnt vmcnt(12) lgkmcnt(0)
    s_barrier
    s_mov_b64 s[8:9], s[56:57]
    s_add_u32 m0, s43, 147456
    s_add_u32 s41, s42, 0
    buffer_load_dwordx4 v19, s[8:11], s41 offen offset:0 nt lds
    s_add_u32 s41, s42, 35840
    buffer_load_dwordx4 v19, s[8:11], s41 offen offset:1024 nt lds
    s_add_u32 s41, s42, 71680
    buffer_load_dwordx4 v19, s[8:11], s41 offen offset:2048 nt lds
    s_add_u32 s41, s42, 107520
    buffer_load_dwordx4 v19, s[8:11], s41 offen offset:3072 nt lds
    v_mov_b32 v78, v21
    v_mov_b32 v79, v22
    v_add_u32 v77, 0, v79
    ds_read_b64_tr_b16 v[80:81], v77 offset:0
    ds_read_b64_tr_b16 v[82:83], v77 offset:256
    ds_read_b64_tr_b16 v[84:85], v77 offset:2048
    ds_read_b64_tr_b16 v[86:87], v77 offset:2304
    ds_read_b64_tr_b16 v[112:113], v77 offset:16
    ds_read_b64_tr_b16 v[114:115], v77 offset:272
    ds_read_b64_tr_b16 v[116:117], v77 offset:2064
    ds_read_b64_tr_b16 v[118:119], v77 offset:2320
    s_waitcnt vmcnt(12) lgkmcnt(0)
    s_barrier
    s_mov_b64 s[8:9], s[52:53]
    s_add_u32 m0, s43, 0
    s_add_u32 s41, s58, 0
    buffer_load_dwordx4 v17, s[8:11], s41 offen offset:0 nt lds
    s_add_u32 s41, s58, 31744
    buffer_load_dwordx4 v17, s[8:11], s41 offen offset:1024 nt lds
    s_add_u32 s41, s58, 129024
    buffer_load_dwordx4 v17, s[8:11], s41 offen offset:2048 nt lds
    s_add_u32 s41, s58, 160768
    buffer_load_dwordx4 v17, s[8:11], s41 offen offset:3072 nt lds
    v_add_u32 v77, 36864, v78
    ds_read_b64_tr_b16 v[88:89], v77 offset:0
    ds_read_b64_tr_b16 v[90:91], v77 offset:256
    ds_read_b64_tr_b16 v[92:93], v77 offset:2048
    ds_read_b64_tr_b16 v[94:95], v77 offset:2304
    ds_read_b64_tr_b16 v[120:121], v77 offset:16
    ds_read_b64_tr_b16 v[122:123], v77 offset:272
    ds_read_b64_tr_b16 v[124:125], v77 offset:2064
    ds_read_b64_tr_b16 v[126:127], v77 offset:2320
    s_waitcnt vmcnt(12) lgkmcnt(0)
    s_barrier
    s_add_u32 m0, s43, 36864
    s_add_u32 s41, s58, 16384
    buffer_load_dwordx4 v17, s[8:11], s41 offen offset:0 nt lds
    s_add_u32 s41, s58, 48128
    buffer_load_dwordx4 v17, s[8:11], s41 offen offset:1024 nt lds
    s_add_u32 s41, s58, 145408
    buffer_load_dwordx4 v17, s[8:11], s41 offen offset:2048 nt lds
    s_add_u32 s41, s58, 177152
    buffer_load_dwordx4 v17, s[8:11], s41 offen offset:3072 nt lds
    v_add_u32 v77, 73728, v78
    ds_read_b64_tr_b16 v[96:97], v77 offset:0
    ds_read_b64_tr_b16 v[98:99], v77 offset:256
    ds_read_b64_tr_b16 v[100:101], v77 offset:2048
    ds_read_b64_tr_b16 v[102:103], v77 offset:2304
    ds_read_b64_tr_b16 v[128:129], v77 offset:16
    ds_read_b64_tr_b16 v[130:131], v77 offset:272
    ds_read_b64_tr_b16 v[132:133], v77 offset:2064
    ds_read_b64_tr_b16 v[134:135], v77 offset:2320
    s_waitcnt vmcnt(12) lgkmcnt(0)
    s_barrier
    s_add_u32 m0, s43, 73728
    s_add_u32 s41, s58, 262144
    buffer_load_dwordx4 v17, s[8:11], s41 offen offset:0 nt lds
    s_add_u32 s41, s58, 293888
    buffer_load_dwordx4 v17, s[8:11], s41 offen offset:1024 nt lds
    s_add_u32 s41, s58, 391168
    buffer_load_dwordx4 v17, s[8:11], s41 offen offset:2048 nt lds
    s_add_u32 s41, s58, 422912
    buffer_load_dwordx4 v17, s[8:11], s41 offen offset:3072 nt lds
    v_add_u32 v77, 110592, v78
    ds_read_b64_tr_b16 v[104:105], v77 offset:0
    ds_read_b64_tr_b16 v[106:107], v77 offset:256
    ds_read_b64_tr_b16 v[108:109], v77 offset:2048
    ds_read_b64_tr_b16 v[110:111], v77 offset:2304
    ds_read_b64_tr_b16 v[136:137], v77 offset:16
    ds_read_b64_tr_b16 v[138:139], v77 offset:272
    ds_read_b64_tr_b16 v[140:141], v77 offset:2064
    ds_read_b64_tr_b16 v[142:143], v77 offset:2320
    s_waitcnt vmcnt(12) lgkmcnt(0)
    s_barrier
    s_add_u32 m0, s43, 110592
    s_add_u32 s41, s58, 278528
    buffer_load_dwordx4 v17, s[8:11], s41 offen offset:0 nt lds
    s_add_u32 s41, s58, 310272
    buffer_load_dwordx4 v17, s[8:11], s41 offen offset:1024 nt lds
    s_add_u32 s41, s58, 407552
    buffer_load_dwordx4 v17, s[8:11], s41 offen offset:2048 nt lds
    s_add_u32 s41, s58, 439296
    buffer_load_dwordx4 v17, s[8:11], s41 offen offset:3072 nt lds
    v_add_u32 v77, 147456, v23
    ds_read_b64_tr_b16 v[0:1], v77 offset:0
    ds_read_b64_tr_b16 v[2:3], v77 offset:64
    ds_read_b64_tr_b16 v[4:5], v77 offset:512
    ds_read_b64_tr_b16 v[6:7], v77 offset:576
    ds_read_b64_tr_b16 v[8:9], v77 offset:2048
    ds_read_b64_tr_b16 v[10:11], v77 offset:2112
    ds_read_b64_tr_b16 v[12:13], v77 offset:2560
    ds_read_b64_tr_b16 v[14:15], v77 offset:2624
    s_waitcnt vmcnt(12) lgkmcnt(0)
    s_barrier
    s_add_u32 m0, s43, 147456
    s_add_u32 s41, s58, 524288
    buffer_load_dwordx4 v17, s[8:11], s41 offen offset:0 nt lds
    s_add_u32 s41, s58, 556032
    buffer_load_dwordx4 v17, s[8:11], s41 offen offset:1024 nt lds
    s_add_u32 s41, s58, 653312
    buffer_load_dwordx4 v17, s[8:11], s41 offen offset:2048 nt lds
    s_add_u32 s41, s58, 685056
    buffer_load_dwordx4 v17, s[8:11], s41 offen offset:3072 nt lds
    s_cmp_eq_u32 s32, 0
    s_cbranch_scc1 cf_init_done
    v_mov_b32 v52, 1
    v_mov_b32 v53, 1
    v_mov_b32 v54, 1
    v_mov_b32 v55, 1
    v_mov_b32 v56, 0
    s_lshl_b32 s96, s12, 14
    s_add_u32 s96, s96, 68157440
    s_add_u32 s97, s96, 0
    buffer_store_dwordx4 v[52:55], v65, s[4:7], s97 offen
    buffer_load_dwordx4 v[60:63], v65, s[4:7], s97 offen sc1
    s_add_u32 s97, s96, 4096
    buffer_store_dwordx4 v[52:55], v65, s[4:7], s97 offen
    buffer_load_dwordx4 v[60:63], v65, s[4:7], s97 offen sc1
    s_add_u32 s97, s96, 8192
    buffer_store_dwordx4 v[52:55], v65, s[4:7], s97 offen
    buffer_load_dwordx4 v[60:63], v65, s[4:7], s97 offen sc1
    s_add_u32 s97, s96, 12288
    buffer_store_dwordx4 v[52:55], v65, s[4:7], s97 offen
    buffer_load_dwordx4 v[60:63], v65, s[4:7], s97 offen sc1
    s_add_u32 s96, s68, 67108864
    s_add_u32 s97, s96, 16384
    buffer_store_dword v56, v75, s[4:7], s96 offen offset:0
    buffer_store_dword v72, v75, s[4:7], s97 offen offset:0
    buffer_load_dword v60, v75, s[4:7], s96 offen offset:0 sc1
    buffer_load_dword v60, v75, s[4:7], s97 offen offset:0 sc1
    s_cmp_lg_u32 s32, 2
    s_cbranch_scc1 cf_init_done
    buffer_store_dword v56, v75, s[4:7], s96 offen offset:1024
    buffer_store_dword v72, v75, s[4:7], s97 offen offset:1024
    buffer_load_dword v60, v75, s[4:7], s96 offen offset:1024 sc1
    buffer_load_dword v60, v75, s[4:7], s97 offen offset:1024 sc1
    buffer_store_dword v56, v75, s[4:7], s96 offen offset:2048
    buffer_store_dword v72, v75, s[4:7], s97 offen offset:2048
    buffer_load_dword v60, v75, s[4:7], s96 offen offset:2048 sc1
    buffer_load_dword v60, v75, s[4:7], s97 offen offset:2048 sc1
    buffer_store_dword v56, v75, s[4:7], s96 offen offset:3072
    buffer_store_dword v72, v75, s[4:7], s97 offen offset:3072
    buffer_load_dword v60, v75, s[4:7], s96 offen offset:3072 sc1
    buffer_load_dword v60, v75, s[4:7], s97 offen offset:3072 sc1
cf_init_done:
    ds_write_b64 v70, v[0:1] offset:16384
    ds_write_b64 v70, v[2:3] offset:16392
    ds_write_b64 v70, v[4:5] offset:17408
    ds_write_b64 v70, v[6:7] offset:17416
    ds_write_b64 v70, v[8:9] offset:18432
    ds_write_b64 v70, v[10:11] offset:18440
    ds_write_b64 v70, v[12:13] offset:19456
    ds_write_b64 v70, v[14:15] offset:19464
    v_add_u32 v28, 0, v24
    v_add_u32 v29, 0, v25
    v_add_u32 v30, 0, v26
    v_add_u32 v31, 0, v27
    ds_read_b64_tr_b16 a[96:97], v28 offset:0
    ds_read_b64_tr_b16 a[104:105], v28 offset:8
    ds_read_b64_tr_b16 a[112:113], v29 offset:0
    ds_read_b64_tr_b16 a[120:121], v29 offset:8
    ds_read_b64_tr_b16 a[128:129], v30 offset:0
    ds_read_b64_tr_b16 a[136:137], v30 offset:8
    ds_read_b64_tr_b16 a[144:145], v31 offset:0
    ds_read_b64_tr_b16 v[32:33], v31 offset:8
    s_waitcnt vmcnt(12) lgkmcnt(0)
    s_barrier
    s_add_u32 m0, s43, 0
    s_add_u32 s41, s58, 540672
    buffer_load_dwordx4 v17, s[8:11], s41 offen offset:0 nt lds
    s_add_u32 s41, s58, 572416
    buffer_load_dwordx4 v17, s[8:11], s41 offen offset:1024 nt lds
    s_add_u32 s41, s58, 669696
    buffer_load_dwordx4 v17, s[8:11], s41 offen offset:2048 nt lds
    s_add_u32 s41, s58, 701440
    buffer_load_dwordx4 v17, s[8:11], s41 offen offset:3072 nt lds
    ds_write_b64 v70, v[32:33] offset:12288
    v_add_u32 v28, 36864, v24
    v_add_u32 v29, 36864, v25
    v_add_u32 v30, 36864, v26
    v_add_u32 v31, 36864, v27
    ds_read_b64_tr_b16 a[98:99], v28 offset:0
    ds_read_b64_tr_b16 a[106:107], v28 offset:8
    ds_read_b64_tr_b16 a[114:115], v29 offset:0
    ds_read_b64_tr_b16 a[122:123], v29 offset:8
    ds_read_b64_tr_b16 a[130:131], v30 offset:0
    ds_read_b64_tr_b16 a[138:139], v30 offset:8
    ds_read_b64_tr_b16 a[146:147], v31 offset:0
    ds_read_b64_tr_b16 v[0:1], v31 offset:8
    s_waitcnt vmcnt(12) lgkmcnt(0)
    s_barrier
    s_add_u32 m0, s43, 36864
    s_add_u32 s41, s58, 786432
    buffer_load_dwordx4 v17, s[8:11], s41 offen offset:0 nt lds
    s_add_u32 s41, s58, 818176
    buffer_load_dwordx4 v17, s[8:11], s41 offen offset:1024 nt lds
    s_add_u32 s41, s58, 915456
    buffer_load_dwordx4 v17, s[8:11], s41 offen offset:2048 nt lds
    s_add_u32 s41, s58, 947200
    buffer_load_dwordx4 v17, s[8:11], s41 offen offset:3072 nt lds
    ds_write_b64 v70, v[0:1] offset:12296
    v_add_u32 v28, 73728, v24
    v_add_u32 v29, 73728, v25
    v_add_u32 v30, 73728, v26
    v_add_u32 v31, 73728, v27
    ds_read_b64_tr_b16 a[100:101], v28 offset:0
    ds_read_b64_tr_b16 a[108:109], v28 offset:8
    ds_read_b64_tr_b16 a[116:117], v29 offset:0
    ds_read_b64_tr_b16 a[124:125], v29 offset:8
    ds_read_b64_tr_b16 a[132:133], v30 offset:0
    ds_read_b64_tr_b16 a[140:141], v30 offset:8
    ds_read_b64_tr_b16 a[148:149], v31 offset:0
    ds_read_b64_tr_b16 v[32:33], v31 offset:8
    s_waitcnt vmcnt(12) lgkmcnt(0)
    s_barrier
    s_add_u32 m0, s43, 73728
    s_add_u32 s41, s58, 802816
    buffer_load_dwordx4 v17, s[8:11], s41 offen offset:0 nt lds
    s_add_u32 s41, s58, 834560
    buffer_load_dwordx4 v17, s[8:11], s41 offen offset:1024 nt lds
    s_add_u32 s41, s58, 931840
    buffer_load_dwordx4 v17, s[8:11], s41 offen offset:2048 nt lds
    s_add_u32 s41, s58, 963584
    buffer_load_dwordx4 v17, s[8:11], s41 offen offset:3072 nt lds
    ds_write_b64 v70, v[32:33] offset:13312
    v_add_u32 v28, 110592, v24
    v_add_u32 v29, 110592, v25
    v_add_u32 v30, 110592, v26
    v_add_u32 v31, 110592, v27
    ds_read_b64_tr_b16 a[102:103], v28 offset:0
    ds_read_b64_tr_b16 a[110:111], v28 offset:8
    ds_read_b64_tr_b16 a[118:119], v29 offset:0
    ds_read_b64_tr_b16 a[126:127], v29 offset:8
    ds_read_b64_tr_b16 a[134:135], v30 offset:0
    ds_read_b64_tr_b16 a[142:143], v30 offset:8
    ds_read_b64_tr_b16 a[150:151], v31 offset:0
    ds_read_b64_tr_b16 v[0:1], v31 offset:8
    s_waitcnt vmcnt(12) lgkmcnt(0)
    s_barrier
    s_add_u32 m0, s43, 110592
    s_add_u32 s41, s59, 0
    buffer_load_dwordx4 v17, s[8:11], s41 offen offset:0 nt lds
    s_add_u32 s41, s59, 31744
    buffer_load_dwordx4 v17, s[8:11], s41 offen offset:1024 nt lds
    s_add_u32 s41, s59, 129024
    buffer_load_dwordx4 v17, s[8:11], s41 offen offset:2048 nt lds
    s_add_u32 s41, s59, 160768
    buffer_load_dwordx4 v17, s[8:11], s41 offen offset:3072 nt lds
    ds_write_b64 v70, v[0:1] offset:13320
    v_add_u32 v28, 147456, v24
    v_add_u32 v29, 147456, v25
    v_add_u32 v30, 147456, v26
    v_add_u32 v31, 147456, v27
    ds_read_b64_tr_b16 a[152:153], v28 offset:0
    ds_read_b64_tr_b16 a[160:161], v28 offset:8
    ds_read_b64_tr_b16 a[168:169], v29 offset:0
    ds_read_b64_tr_b16 a[176:177], v29 offset:8
    ds_read_b64_tr_b16 a[184:185], v30 offset:0
    ds_read_b64_tr_b16 a[192:193], v30 offset:8
    ds_read_b64_tr_b16 a[200:201], v31 offset:0
    ds_read_b64_tr_b16 a[208:209], v31 offset:8
    s_waitcnt vmcnt(12) lgkmcnt(0)
    s_barrier
    s_mov_b64 s[8:9], s[50:51]
    s_add_u32 m0, s43, 147456
    s_add_u32 s41, s58, 0
    buffer_load_dwordx4 v17, s[8:11], s41 offen offset:0 nt lds
    s_add_u32 s41, s58, 31744
    buffer_load_dwordx4 v17, s[8:11], s41 offen offset:1024 nt lds
    s_add_u32 s41, s58, 129024
    buffer_load_dwordx4 v17, s[8:11], s41 offen offset:2048 nt lds
    s_add_u32 s41, s58, 160768
    buffer_load_dwordx4 v17, s[8:11], s41 offen offset:3072 nt lds
    s_cmp_lg_u32 s13, 0
    s_cbranch_scc1 cf_ma
    v_mov_b32 v54, 1
    s_mov_b64 exec, 1
    buffer_atomic_add v54, off, s[84:87], 0 offset:132
    s_mov_b64 exec, -1
cf_ma:
    v_add_u32 v28, 0, v24
    v_add_u32 v29, 0, v25
    v_add_u32 v30, 0, v26
    v_add_u32 v31, 0, v27
    ds_read_b64_tr_b16 a[154:155], v28 offset:0
    ds_read_b64_tr_b16 a[162:163], v28 offset:8
    ds_read_b64_tr_b16 a[170:171], v29 offset:0
    ds_read_b64_tr_b16 a[178:179], v29 offset:8
    ds_read_b64_tr_b16 a[186:187], v30 offset:0
    ds_read_b64_tr_b16 a[194:195], v30 offset:8
    ds_read_b64_tr_b16 a[202:203], v31 offset:0
    ds_read_b64_tr_b16 a[210:211], v31 offset:8
    s_waitcnt vmcnt(12) lgkmcnt(0)
    s_barrier
    s_add_u32 m0, s43, 0
    s_add_u32 s41, s58, 16384
    buffer_load_dwordx4 v17, s[8:11], s41 offen offset:0 nt lds
    s_add_u32 s41, s58, 48128
    buffer_load_dwordx4 v17, s[8:11], s41 offen offset:1024 nt lds
    s_add_u32 s41, s58, 145408
    buffer_load_dwordx4 v17, s[8:11], s41 offen offset:2048 nt lds
    s_add_u32 s41, s58, 177152
    buffer_load_dwordx4 v17, s[8:11], s41 offen offset:3072 nt lds
    v_add_u32 v28, 36864, v24
    v_add_u32 v29, 36864, v25
    v_add_u32 v30, 36864, v26
    v_add_u32 v31, 36864, v27
    ds_read_b64_tr_b16 a[156:157], v28 offset:0
    ds_read_b64_tr_b16 a[164:165], v28 offset:8
    ds_read_b64_tr_b16 a[172:173], v29 offset:0
    ds_read_b64_tr_b16 a[180:181], v29 offset:8
    ds_read_b64_tr_b16 a[188:189], v30 offset:0
    ds_read_b64_tr_b16 a[196:197], v30 offset:8
    ds_read_b64_tr_b16 a[204:205], v31 offset:0
    ds_read_b64_tr_b16 a[212:213], v31 offset:8
    s_waitcnt vmcnt(12) lgkmcnt(0)
    s_barrier
    s_add_u32 m0, s43, 36864
    s_add_u32 s41, s58, 262144
    buffer_load_dwordx4 v17, s[8:11], s41 offen offset:0 nt lds
    s_add_u32 s41, s58, 293888
    buffer_load_dwordx4 v17, s[8:11], s41 offen offset:1024 nt lds
    s_add_u32 s41, s58, 391168
    buffer_load_dwordx4 v17, s[8:11], s41 offen offset:2048 nt lds
    s_add_u32 s41, s58, 422912
    buffer_load_dwordx4 v17, s[8:11], s41 offen offset:3072 nt lds
    v_add_u32 v28, 73728, v24
    v_add_u32 v29, 73728, v25
    v_add_u32 v30, 73728, v26
    v_add_u32 v31, 73728, v27
    ds_read_b64_tr_b16 a[158:159], v28 offset:0
    ds_read_b64_tr_b16 a[166:167], v28 offset:8
    ds_read_b64_tr_b16 a[174:175], v29 offset:0
    ds_read_b64_tr_b16 a[182:183], v29 offset:8
    ds_read_b64_tr_b16 a[190:191], v30 offset:0
    ds_read_b64_tr_b16 a[198:199], v30 offset:8
    ds_read_b64_tr_b16 a[206:207], v31 offset:0
    ds_read_b64_tr_b16 a[214:215], v31 offset:8
    s_waitcnt vmcnt(12) lgkmcnt(0)
    s_barrier
    s_add_u32 m0, s43, 73728
    s_add_u32 s41, s58, 278528
    buffer_load_dwordx4 v17, s[8:11], s41 offen offset:0 nt lds
    s_add_u32 s41, s58, 310272
    buffer_load_dwordx4 v17, s[8:11], s41 offen offset:1024 nt lds
    s_add_u32 s41, s58, 407552
    buffer_load_dwordx4 v17, s[8:11], s41 offen offset:2048 nt lds
    s_add_u32 s41, s58, 439296
    buffer_load_dwordx4 v17, s[8:11], s41 offen offset:3072 nt lds
    v_add_u32 v77, 110592, v20
    ds_read_b64_tr_b16 a[216:217], v77 offset:0
    ds_read_b64_tr_b16 a[218:219], v77 offset:4096
    ds_read_b64_tr_b16 a[220:221], v77 offset:8192
    ds_read_b64_tr_b16 a[222:223], v77 offset:12288
    ds_read_b64_tr_b16 a[224:225], v77 offset:8
    ds_read_b64_tr_b16 a[226:227], v77 offset:4104
    ds_read_b64_tr_b16 a[228:229], v77 offset:8200
    ds_read_b64_tr_b16 a[230:231], v77 offset:12296
    s_waitcnt vmcnt(12) lgkmcnt(0)
    s_barrier
    s_add_u32 m0, s43, 110592
    s_add_u32 s41, s58, 524288
    buffer_load_dwordx4 v17, s[8:11], s41 offen offset:0 nt lds
    s_add_u32 s41, s58, 556032
    buffer_load_dwordx4 v17, s[8:11], s41 offen offset:1024 nt lds
    s_add_u32 s41, s58, 653312
    buffer_load_dwordx4 v17, s[8:11], s41 offen offset:2048 nt lds
    s_add_u32 s41, s58, 685056
    buffer_load_dwordx4 v17, s[8:11], s41 offen offset:3072 nt lds
    v_add_u32 v28, 147456, v24
    v_add_u32 v29, 147456, v25
    v_add_u32 v30, 147456, v26
    v_add_u32 v31, 147456, v27
    ds_read_b64_tr_b16 v[0:1], v28 offset:0
    ds_read_b64_tr_b16 v[2:3], v28 offset:8
    ds_read_b64_tr_b16 v[4:5], v29 offset:0
    ds_read_b64_tr_b16 v[6:7], v29 offset:8
    ds_read_b64_tr_b16 a[0:1], v30 offset:0
    ds_read_b64_tr_b16 v[8:9], v30 offset:8
    ds_read_b64_tr_b16 a[8:9], v31 offset:0
    ds_read_b64_tr_b16 v[10:11], v31 offset:8
    s_waitcnt vmcnt(12) lgkmcnt(0)
    s_barrier
    s_add_u32 m0, s43, 147456
    s_add_u32 s41, s58, 540672
    buffer_load_dwordx4 v17, s[8:11], s41 offen offset:0 nt lds
    s_add_u32 s41, s58, 572416
    buffer_load_dwordx4 v17, s[8:11], s41 offen offset:1024 nt lds
    s_add_u32 s41, s58, 669696
    buffer_load_dwordx4 v17, s[8:11], s41 offen offset:2048 nt lds
    s_add_u32 s41, s58, 701440
    buffer_load_dwordx4 v17, s[8:11], s41 offen offset:3072 nt lds
    ds_write_b64 v70, v[0:1] offset:0
    ds_write_b64 v70, v[2:3] offset:2048
    ds_write_b64 v70, v[4:5] offset:4096
    ds_write_b64 v70, v[6:7] offset:6144
    ds_write_b64 v70, v[8:9] offset:10240
    ds_write_b64 v70, v[10:11] offset:14336
    v_add_u32 v28, 0, v24
    v_add_u32 v29, 0, v25
    v_add_u32 v30, 0, v26
    v_add_u32 v31, 0, v27
    ds_read_b64_tr_b16 v[32:33], v28 offset:0
    ds_read_b64_tr_b16 v[34:35], v28 offset:8
    ds_read_b64_tr_b16 v[36:37], v29 offset:0
    ds_read_b64_tr_b16 v[38:39], v29 offset:8
    ds_read_b64_tr_b16 a[2:3], v30 offset:0
    ds_read_b64_tr_b16 v[40:41], v30 offset:8
    ds_read_b64_tr_b16 a[10:11], v31 offset:0
    ds_read_b64_tr_b16 v[42:43], v31 offset:8
    s_waitcnt vmcnt(12) lgkmcnt(0)
    s_barrier
    s_add_u32 m0, s43, 0
    s_add_u32 s41, s58, 786432
    buffer_load_dwordx4 v17, s[8:11], s41 offen offset:0 nt lds
    s_add_u32 s41, s58, 818176
    buffer_load_dwordx4 v17, s[8:11], s41 offen offset:1024 nt lds
    s_add_u32 s41, s58, 915456
    buffer_load_dwordx4 v17, s[8:11], s41 offen offset:2048 nt lds
    s_add_u32 s41, s58, 947200
    buffer_load_dwordx4 v17, s[8:11], s41 offen offset:3072 nt lds
    ds_write_b64 v70, v[32:33] offset:8
    ds_write_b64 v70, v[34:35] offset:2056
    ds_write_b64 v70, v[36:37] offset:4104
    ds_write_b64 v70, v[38:39] offset:6152
    ds_write_b64 v70, v[40:41] offset:10248
    ds_write_b64 v70, v[42:43] offset:14344
    v_add_u32 v28, 36864, v24
    v_add_u32 v29, 36864, v25
    v_add_u32 v30, 36864, v26
    v_add_u32 v31, 36864, v27
    ds_read_b64_tr_b16 v[0:1], v28 offset:0
    ds_read_b64_tr_b16 v[2:3], v28 offset:8
    ds_read_b64_tr_b16 v[4:5], v29 offset:0
    ds_read_b64_tr_b16 v[6:7], v29 offset:8
    ds_read_b64_tr_b16 a[4:5], v30 offset:0
    ds_read_b64_tr_b16 v[8:9], v30 offset:8
    ds_read_b64_tr_b16 a[12:13], v31 offset:0
    ds_read_b64_tr_b16 v[10:11], v31 offset:8
    s_waitcnt vmcnt(12) lgkmcnt(0)
    s_barrier
    s_add_u32 m0, s43, 36864
    s_add_u32 s41, s58, 802816
    buffer_load_dwordx4 v17, s[8:11], s41 offen offset:0 nt lds
    s_add_u32 s41, s58, 834560
    buffer_load_dwordx4 v17, s[8:11], s41 offen offset:1024 nt lds
    s_add_u32 s41, s58, 931840
    buffer_load_dwordx4 v17, s[8:11], s41 offen offset:2048 nt lds
    s_add_u32 s41, s58, 963584
    buffer_load_dwordx4 v17, s[8:11], s41 offen offset:3072 nt lds
    ds_write_b64 v70, v[0:1] offset:1024
    ds_write_b64 v70, v[2:3] offset:3072
    ds_write_b64 v70, v[4:5] offset:5120
    ds_write_b64 v70, v[6:7] offset:7168
    ds_write_b64 v70, v[8:9] offset:11264
    ds_write_b64 v70, v[10:11] offset:15360
    v_add_u32 v28, 73728, v24
    v_add_u32 v29, 73728, v25
    v_add_u32 v30, 73728, v26
    v_add_u32 v31, 73728, v27
    ds_read_b64_tr_b16 v[32:33], v28 offset:0
    ds_read_b64_tr_b16 v[34:35], v28 offset:8
    ds_read_b64_tr_b16 v[36:37], v29 offset:0
    ds_read_b64_tr_b16 v[38:39], v29 offset:8
    ds_read_b64_tr_b16 a[6:7], v30 offset:0
    ds_read_b64_tr_b16 v[40:41], v30 offset:8
    ds_read_b64_tr_b16 a[14:15], v31 offset:0
    ds_read_b64_tr_b16 v[42:43], v31 offset:8
    s_waitcnt vmcnt(12) lgkmcnt(0)
    s_barrier
    s_add_u32 m0, s43, 73728
    s_add_u32 s41, s59, 0
    buffer_load_dwordx4 v17, s[8:11], s41 offen offset:0 nt lds
    s_add_u32 s41, s59, 31744
    buffer_load_dwordx4 v17, s[8:11], s41 offen offset:1024 nt lds
    s_add_u32 s41, s59, 129024
    buffer_load_dwordx4 v17, s[8:11], s41 offen offset:2048 nt lds
    s_add_u32 s41, s59, 160768
    buffer_load_dwordx4 v17, s[8:11], s41 offen offset:3072 nt lds
    ds_write_b64 v70, v[32:33] offset:1032
    ds_write_b64 v70, v[34:35] offset:3080
    ds_write_b64 v70, v[36:37] offset:5128
    ds_write_b64 v70, v[38:39] offset:7176
    ds_write_b64 v70, v[40:41] offset:11272
    ds_write_b64 v70, v[42:43] offset:15368
    v_add_u32 v28, 110592, v24
    v_add_u32 v29, 110592, v25
    v_add_u32 v30, 110592, v26
    v_add_u32 v31, 110592, v27
    ds_read_b64_tr_b16 a[16:17], v28 offset:0
    ds_read_b64_tr_b16 a[24:25], v28 offset:8
    ds_read_b64_tr_b16 a[32:33], v29 offset:0
    ds_read_b64_tr_b16 a[40:41], v29 offset:8
    ds_read_b64_tr_b16 a[48:49], v30 offset:0
    ds_read_b64_tr_b16 a[56:57], v30 offset:8
    ds_read_b64_tr_b16 a[64:65], v31 offset:0
    ds_read_b64_tr_b16 a[72:73], v31 offset:8
    s_waitcnt vmcnt(12) lgkmcnt(0)
    s_barrier
    s_mov_b64 s[8:9], s[54:55]
    s_add_u32 m0, s43, 110592
    s_add_u32 s41, s58, 0
    buffer_load_dwordx4 v17, s[8:11], s41 offen offset:0 nt lds
    s_add_u32 s41, s58, 31744
    buffer_load_dwordx4 v17, s[8:11], s41 offen offset:1024 nt lds
    s_add_u32 s41, s58, 129024
    buffer_load_dwordx4 v17, s[8:11], s41 offen offset:2048 nt lds
    s_add_u32 s41, s58, 160768
    buffer_load_dwordx4 v17, s[8:11], s41 offen offset:3072 nt lds
    v_add_u32 v28, 147456, v24
    v_add_u32 v29, 147456, v25
    v_add_u32 v30, 147456, v26
    v_add_u32 v31, 147456, v27
    ds_read_b64_tr_b16 a[18:19], v28 offset:0
    ds_read_b64_tr_b16 a[26:27], v28 offset:8
    ds_read_b64_tr_b16 a[34:35], v29 offset:0
    ds_read_b64_tr_b16 a[42:43], v29 offset:8
    ds_read_b64_tr_b16 a[50:51], v30 offset:0
    ds_read_b64_tr_b16 a[58:59], v30 offset:8
    ds_read_b64_tr_b16 a[66:67], v31 offset:0
    ds_read_b64_tr_b16 a[74:75], v31 offset:8
    s_waitcnt vmcnt(12) lgkmcnt(0)
    s_barrier
    s_add_u32 m0, s43, 147456
    s_add_u32 s41, s58, 16384
    buffer_load_dwordx4 v17, s[8:11], s41 offen offset:0 nt lds
    s_add_u32 s41, s58, 48128
    buffer_load_dwordx4 v17, s[8:11], s41 offen offset:1024 nt lds
    s_add_u32 s41, s58, 145408
    buffer_load_dwordx4 v17, s[8:11], s41 offen offset:2048 nt lds
    s_add_u32 s41, s58, 177152
    buffer_load_dwordx4 v17, s[8:11], s41 offen offset:3072 nt lds
    v_add_u32 v28, 0, v24
    v_add_u32 v29, 0, v25
    v_add_u32 v30, 0, v26
    v_add_u32 v31, 0, v27
    ds_read_b64_tr_b16 a[20:21], v28 offset:0
    ds_read_b64_tr_b16 a[28:29], v28 offset:8
    ds_read_b64_tr_b16 a[36:37], v29 offset:0
    ds_read_b64_tr_b16 a[44:45], v29 offset:8
    ds_read_b64_tr_b16 a[52:53], v30 offset:0
    ds_read_b64_tr_b16 a[60:61], v30 offset:8
    ds_read_b64_tr_b16 a[68:69], v31 offset:0
    ds_read_b64_tr_b16 a[76:77], v31 offset:8
    s_waitcnt vmcnt(12) lgkmcnt(0)
    s_barrier
    s_add_u32 m0, s43, 0
    s_add_u32 s41, s58, 262144
    buffer_load_dwordx4 v17, s[8:11], s41 offen offset:0 nt lds
    s_add_u32 s41, s58, 293888
    buffer_load_dwordx4 v17, s[8:11], s41 offen offset:1024 nt lds
    s_add_u32 s41, s58, 391168
    buffer_load_dwordx4 v17, s[8:11], s41 offen offset:2048 nt lds
    s_add_u32 s41, s58, 422912
    buffer_load_dwordx4 v17, s[8:11], s41 offen offset:3072 nt lds
    v_add_u32 v28, 36864, v24
    v_add_u32 v29, 36864, v25
    v_add_u32 v30, 36864, v26
    v_add_u32 v31, 36864, v27
    ds_read_b64_tr_b16 a[22:23], v28 offset:0
    ds_read_b64_tr_b16 a[30:31], v28 offset:8
    ds_read_b64_tr_b16 a[38:39], v29 offset:0
    ds_read_b64_tr_b16 a[46:47], v29 offset:8
    ds_read_b64_tr_b16 a[54:55], v30 offset:0
    ds_read_b64_tr_b16 a[62:63], v30 offset:8
    ds_read_b64_tr_b16 a[70:71], v31 offset:0
    ds_read_b64_tr_b16 a[78:79], v31 offset:8
    s_waitcnt vmcnt(12) lgkmcnt(0)
    s_barrier
    s_add_u32 m0, s43, 36864
    s_add_u32 s41, s58, 278528
    buffer_load_dwordx4 v17, s[8:11], s41 offen offset:0 nt lds
    s_add_u32 s41, s58, 310272
    buffer_load_dwordx4 v17, s[8:11], s41 offen offset:1024 nt lds
    s_add_u32 s41, s58, 407552
    buffer_load_dwordx4 v17, s[8:11], s41 offen offset:2048 nt lds
    s_add_u32 s41, s58, 439296
    buffer_load_dwordx4 v17, s[8:11], s41 offen offset:3072 nt lds
    s_lshl_b32 s26, s12, 14
    s_add_u32 s26, s26, 0
    s_mul_i32 s40, s13, 3072
    s_add_u32 s24, s26, s40
    s_lshl_b32 s96, s12, 7
    s_add_u32 s29, s96, 125845504
    s_add_u32 s96, s96, 125829120
    v_bfe_u32 v78, v65, 2, 5
    buffer_load_dword v54, off, s[84:87], 0 offset:132 sc1
    buffer_load_dword v55, off, s[84:87], 0 offset:216 sc1
    buffer_load_dword v56, v78, s[4:7], s96 offen offset:16 sc1
    v_add_u32 v77, 73728, v20
    ds_read_b64_tr_b16 a[80:81], v77 offset:0
    ds_read_b64_tr_b16 a[82:83], v77 offset:4096
    ds_read_b64_tr_b16 a[84:85], v77 offset:8192
    ds_read_b64_tr_b16 a[86:87], v77 offset:12288
    ds_read_b64_tr_b16 a[88:89], v77 offset:8
    ds_read_b64_tr_b16 a[90:91], v77 offset:4104
    ds_read_b64_tr_b16 a[92:93], v77 offset:8200
    ds_read_b64_tr_b16 a[94:95], v77 offset:12296
    s_waitcnt vmcnt(12) lgkmcnt(0)
    s_barrier
    s_add_u32 m0, s43, 73728
    s_add_u32 s41, s58, 524288
    buffer_load_dwordx4 v17, s[8:11], s41 offen offset:0 nt lds
    s_add_u32 s41, s58, 556032
    buffer_load_dwordx4 v17, s[8:11], s41 offen offset:1024 nt lds
    s_add_u32 s41, s58, 653312
    buffer_load_dwordx4 v17, s[8:11], s41 offen offset:2048 nt lds
    s_add_u32 s41, s58, 685056
    buffer_load_dwordx4 v17, s[8:11], s41 offen offset:3072 nt lds
    v_add_u32 v28, 110592, v24
    v_add_u32 v29, 110592, v25
    v_add_u32 v30, 110592, v26
    v_add_u32 v31, 110592, v27
    ds_read_b64_tr_b16 a[232:233], v28 offset:0
    ds_read_b64_tr_b16 v[32:33], v28 offset:8
    ds_read_b64_tr_b16 a[240:241], v29 offset:0
    ds_read_b64_tr_b16 a[248:249], v29 offset:8
    ds_read_b64_tr_b16 v[144:145], v30 offset:0
    ds_read_b64_tr_b16 v[152:153], v30 offset:8
    ds_read_b64_tr_b16 v[160:161], v31 offset:0
    ds_read_b64_tr_b16 v[168:169], v31 offset:8
    s_waitcnt vmcnt(12) lgkmcnt(0)
    s_barrier
    s_add_u32 m0, s43, 110592
    s_add_u32 s41, s58, 540672
    buffer_load_dwordx4 v17, s[8:11], s41 offen offset:0 nt lds
    s_add_u32 s41, s58, 572416
    buffer_load_dwordx4 v17, s[8:11], s41 offen offset:1024 nt lds
    s_add_u32 s41, s58, 669696
    buffer_load_dwordx4 v17, s[8:11], s41 offen offset:2048 nt lds
    s_add_u32 s41, s58, 701440
    buffer_load_dwordx4 v17, s[8:11], s41 offen offset:3072 nt lds
    ds_write_b64 v70, v[32:33] offset:8192
    v_add_u32 v28, 147456, v24
    v_add_u32 v29, 147456, v25
    v_add_u32 v30, 147456, v26
    v_add_u32 v31, 147456, v27
    ds_read_b64_tr_b16 a[234:235], v28 offset:0
    ds_read_b64_tr_b16 v[0:1], v28 offset:8
    ds_read_b64_tr_b16 a[242:243], v29 offset:0
    ds_read_b64_tr_b16 a[250:251], v29 offset:8
    ds_read_b64_tr_b16 v[146:147], v30 offset:0
    ds_read_b64_tr_b16 v[154:155], v30 offset:8
    ds_read_b64_tr_b16 v[162:163], v31 offset:0
    ds_read_b64_tr_b16 v[170:171], v31 offset:8
    s_waitcnt vmcnt(12) lgkmcnt(0)
    s_barrier
    s_add_u32 m0, s43, 147456
    s_add_u32 s41, s58, 786432
    buffer_load_dwordx4 v17, s[8:11], s41 offen offset:0 nt lds
    s_add_u32 s41, s58, 818176
    buffer_load_dwordx4 v17, s[8:11], s41 offen offset:1024 nt lds
    s_add_u32 s41, s58, 915456
    buffer_load_dwordx4 v17, s[8:11], s41 offen offset:2048 nt lds
    s_add_u32 s41, s58, 947200
    buffer_load_dwordx4 v17, s[8:11], s41 offen offset:3072 nt lds
    ds_write_b64 v70, v[0:1] offset:8200
    v_add_u32 v28, 0, v24
    v_add_u32 v29, 0, v25
    v_add_u32 v30, 0, v26
    v_add_u32 v31, 0, v27
    ds_read_b64_tr_b16 a[236:237], v28 offset:0
    ds_read_b64_tr_b16 v[32:33], v28 offset:8
    ds_read_b64_tr_b16 a[244:245], v29 offset:0
    ds_read_b64_tr_b16 a[252:253], v29 offset:8
    ds_read_b64_tr_b16 v[148:149], v30 offset:0
    ds_read_b64_tr_b16 v[156:157], v30 offset:8
    ds_read_b64_tr_b16 v[164:165], v31 offset:0
    ds_read_b64_tr_b16 v[172:173], v31 offset:8
    s_waitcnt vmcnt(12) lgkmcnt(0)
    s_barrier
    s_add_u32 m0, s43, 0
    s_add_u32 s41, s58, 802816
    buffer_load_dwordx4 v17, s[8:11], s41 offen offset:0 nt lds
    s_add_u32 s41, s58, 834560
    buffer_load_dwordx4 v17, s[8:11], s41 offen offset:1024 nt lds
    s_add_u32 s41, s58, 931840
    buffer_load_dwordx4 v17, s[8:11], s41 offen offset:2048 nt lds
    s_add_u32 s41, s58, 963584
    buffer_load_dwordx4 v17, s[8:11], s41 offen offset:3072 nt lds
    ds_write_b64 v70, v[32:33] offset:9216
    v_add_u32 v28, 36864, v24
    v_add_u32 v29, 36864, v25
    v_add_u32 v30, 36864, v26
    v_add_u32 v31, 36864, v27
    ds_read_b64_tr_b16 a[238:239], v28 offset:0
    ds_read_b64_tr_b16 v[0:1], v28 offset:8
    ds_read_b64_tr_b16 a[246:247], v29 offset:0
    ds_read_b64_tr_b16 a[254:255], v29 offset:8
    ds_read_b64_tr_b16 v[150:151], v30 offset:0
    ds_read_b64_tr_b16 v[158:159], v30 offset:8
    ds_read_b64_tr_b16 v[166:167], v31 offset:0
    ds_read_b64_tr_b16 v[174:175], v31 offset:8
    s_waitcnt vmcnt(12) lgkmcnt(0)
    s_barrier
    s_add_u32 m0, s43, 36864
    s_add_u32 s41, s59, 0
    buffer_load_dwordx4 v17, s[8:11], s41 offen offset:0 nt lds
    s_add_u32 s41, s59, 31744
    buffer_load_dwordx4 v17, s[8:11], s41 offen offset:1024 nt lds
    s_add_u32 s41, s59, 129024
    buffer_load_dwordx4 v17, s[8:11], s41 offen offset:2048 nt lds
    s_add_u32 s41, s59, 160768
    buffer_load_dwordx4 v17, s[8:11], s41 offen offset:3072 nt lds
    v_readfirstlane_b32 s94, v54
    v_readfirstlane_b32 s95, v55
    v_mov_b32 v77, v56
    s_nop 0
    v_subrev_u32 v77, s95, v77
    v_cmp_lt_u32 vcc, 16, v77
    s_nop 1
    v_cndmask_b32 v77, v77, 0, vcc
    v_bfe_u32 v79, v78, 2, 2
    v_lshl_add_u32 v77, v77, 2, v79
    s_nop 1
    v_min_u32_dpp v77, v77, v77 row_ror:1 row_mask:0xf bank_mask:0xf
    s_nop 1
    v_min_u32_dpp v77, v77, v77 row_ror:2 row_mask:0xf bank_mask:0xf
    s_nop 1
    v_min_u32_dpp v77, v77, v77 row_ror:4 row_mask:0xf bank_mask:0xf
    s_nop 0
    v_readfirstlane_b32 s97, v77
    s_cmp_eq_u32 s95, 0
    s_cselect_b32 s97, 0, s97
    s_cmp_lt_u32 s97, 3
    s_cbranch_scc1 cf_mb
    s_add_u32 s40, s24, 0
    s_add_u32 s40, s40, s33
    s_sub_u32 s41, s96, s40
    v_bfe_u32 v77, v65, 2, 5
    v_add3_u32 v77, v77, s41, 16
    v_lshlrev_b32 v78, 3, v69
    s_nop 0
    v_mov_b32_dpp v78, v77 quad_perm:[0,1,2,3] row_mask:0xc bank_mask:0xf
    buffer_load_dword v58, v78, s[4:7], s40 offen sc1
    s_add_u32 s40, s24, 524288
    s_add_u32 s40, s40, s33
    s_sub_u32 s41, s96, s40
    v_bfe_u32 v77, v65, 2, 5
    v_add3_u32 v77, v77, s41, 16
    v_lshlrev_b32 v78, 3, v69
    s_nop 0
    v_mov_b32_dpp v78, v77 quad_perm:[0,1,2,3] row_mask:0xc bank_mask:0xf
    buffer_load_dword v58, v78, s[4:7], s40 offen sc1
cf_mb:
    s_cmp_lt_u32 s94, 32
    s_cbranch_scc1 cf_mc
    s_cmp_lg_u32 s13, 0
    s_cbranch_scc1 cf_mc
    v_mov_b32 v76, 1
    v_mov_b32 v77, 0
    s_mov_b64 exec, 1
    buffer_atomic_cmpswap v[76:77], off, s[84:87], 0 offset:28 sc0
    s_mov_b64 exec, -1
cf_mc:
    s_nop 1
    ds_write_b64 v70, v[0:1] offset:9224
    v_add_u32 v28, 73728, v24
    v_add_u32 v29, 73728, v25
    v_add_u32 v30, 73728, v26
    v_add_u32 v31, 73728, v27
    ds_read_b64_tr_b16 v[176:177], v28 offset:0
    ds_read_b64_tr_b16 v[184:185], v28 offset:8
    ds_read_b64_tr_b16 v[192:193], v29 offset:0
    ds_read_b64_tr_b16 v[200:201], v29 offset:8
    ds_read_b64_tr_b16 v[208:209], v30 offset:0
    ds_read_b64_tr_b16 v[216:217], v30 offset:8
    ds_read_b64_tr_b16 v[224:225], v31 offset:0
    ds_read_b64_tr_b16 v[232:233], v31 offset:8
    s_waitcnt vmcnt(12) lgkmcnt(0)
    s_barrier
    s_mov_b64 s[8:9], s[56:57]
    s_add_u32 m0, s43, 73728
    s_add_u32 s41, s60, 128
    buffer_load_dwordx4 v18, s[8:11], s41 offen offset:0 nt lds
    s_add_u32 s41, s60, 8320
    buffer_load_dwordx4 v18, s[8:11], s41 offen offset:1024 nt lds
    s_add_u32 s41, s60, 16512
    buffer_load_dwordx4 v18, s[8:11], s41 offen offset:2048 nt lds
    s_add_u32 s41, s60, 24704
    buffer_load_dwordx4 v18, s[8:11], s41 offen offset:3072 nt lds
    v_add_u32 v28, 110592, v24
    v_add_u32 v29, 110592, v25
    v_add_u32 v30, 110592, v26
    v_add_u32 v31, 110592, v27
    ds_read_b64_tr_b16 v[178:179], v28 offset:0
    ds_read_b64_tr_b16 v[186:187], v28 offset:8
    ds_read_b64_tr_b16 v[194:195], v29 offset:0
    ds_read_b64_tr_b16 v[202:203], v29 offset:8
    ds_read_b64_tr_b16 v[210:211], v30 offset:0
    ds_read_b64_tr_b16 v[218:219], v30 offset:8
    ds_read_b64_tr_b16 v[226:227], v31 offset:0
    ds_read_b64_tr_b16 v[234:235], v31 offset:8
    s_waitcnt vmcnt(12) lgkmcnt(0)
    s_barrier
    s_add_u32 m0, s43, 110592
    s_add_u32 s41, s61, 128
    buffer_load_dwordx4 v18, s[8:11], s41 offen offset:0 nt lds
    s_add_u32 s41, s61, 8320
    buffer_load_dwordx4 v18, s[8:11], s41 offen offset:1024 nt lds
    s_add_u32 s41, s61, 16512
    buffer_load_dwordx4 v18, s[8:11], s41 offen offset:2048 nt lds
    s_add_u32 s41, s61, 24704
    buffer_load_dwordx4 v18, s[8:11], s41 offen offset:3072 nt lds
    v_add_u32 v28, 147456, v24
    v_add_u32 v29, 147456, v25
    v_add_u32 v30, 147456, v26
    v_add_u32 v31, 147456, v27
    ds_read_b64_tr_b16 v[180:181], v28 offset:0
    ds_read_b64_tr_b16 v[188:189], v28 offset:8
    ds_read_b64_tr_b16 v[196:197], v29 offset:0
    ds_read_b64_tr_b16 v[204:205], v29 offset:8
    ds_read_b64_tr_b16 v[212:213], v30 offset:0
    ds_read_b64_tr_b16 v[220:221], v30 offset:8
    ds_read_b64_tr_b16 v[228:229], v31 offset:0
    ds_read_b64_tr_b16 v[236:237], v31 offset:8
    s_waitcnt vmcnt(12) lgkmcnt(0)
    s_barrier
    s_add_u32 m0, s43, 147456
    s_add_u32 s41, s62, 128
    buffer_load_dwordx4 v18, s[8:11], s41 offen offset:0 nt lds
    s_add_u32 s41, s62, 8320
    buffer_load_dwordx4 v18, s[8:11], s41 offen offset:1024 nt lds
    s_add_u32 s41, s62, 16512
    buffer_load_dwordx4 v18, s[8:11], s41 offen offset:2048 nt lds
    s_add_u32 s41, s62, 24704
    buffer_load_dwordx4 v18, s[8:11], s41 offen offset:3072 nt lds
    v_add_u32 v28, 0, v24
    v_add_u32 v29, 0, v25
    v_add_u32 v30, 0, v26
    v_add_u32 v31, 0, v27
    ds_read_b64_tr_b16 v[182:183], v28 offset:0
    ds_read_b64_tr_b16 v[190:191], v28 offset:8
    ds_read_b64_tr_b16 v[198:199], v29 offset:0
    ds_read_b64_tr_b16 v[206:207], v29 offset:8
    ds_read_b64_tr_b16 v[214:215], v30 offset:0
    ds_read_b64_tr_b16 v[222:223], v30 offset:8
    ds_read_b64_tr_b16 v[230:231], v31 offset:0
    ds_read_b64_tr_b16 v[238:239], v31 offset:8
    s_waitcnt vmcnt(12) lgkmcnt(0)
    s_barrier
    s_add_u32 m0, s43, 0
    s_add_u32 s41, s63, 128
    buffer_load_dwordx4 v18, s[8:11], s41 offen offset:0 nt lds
    s_add_u32 s41, s63, 8320
    buffer_load_dwordx4 v18, s[8:11], s41 offen offset:1024 nt lds
    s_add_u32 s41, s63, 16512
    buffer_load_dwordx4 v18, s[8:11], s41 offen offset:2048 nt lds
    s_add_u32 s41, s63, 24704
    buffer_load_dwordx4 v18, s[8:11], s41 offen offset:3072 nt lds
    v_mov_b32 v78, v21
    v_mov_b32 v79, v22
    v_add_u32 v77, 36864, v20
    ds_read_b64_tr_b16 v[240:241], v77 offset:0
    ds_read_b64_tr_b16 v[242:243], v77 offset:4096
    ds_read_b64_tr_b16 v[244:245], v77 offset:8192
    ds_read_b64_tr_b16 v[246:247], v77 offset:12288
    ds_read_b64_tr_b16 v[248:249], v77 offset:8
    ds_read_b64_tr_b16 v[250:251], v77 offset:4104
    ds_read_b64_tr_b16 v[252:253], v77 offset:8200
    ds_read_b64_tr_b16 v[254:255], v77 offset:12296
    s_waitcnt vmcnt(12) lgkmcnt(0)
    s_barrier
    v_add_u32 v77, 73728, v79
    s_waitcnt lgkmcnt(0)
    ds_read_b64_tr_b16 v[0:1], v77 offset:0
    ds_read_b64_tr_b16 v[2:3], v77 offset:256
    ds_read_b64_tr_b16 v[4:5], v77 offset:2048
    ds_read_b64_tr_b16 v[6:7], v77 offset:2304
    ds_read_b64_tr_b16 v[8:9], v77 offset:16
    ds_read_b64_tr_b16 v[10:11], v77 offset:272
    ds_read_b64_tr_b16 v[12:13], v77 offset:2064
    ds_read_b64_tr_b16 v[14:15], v77 offset:2320
    s_waitcnt vmcnt(8) lgkmcnt(0)
    s_barrier
    v_add_u32 v77, 110592, v78
    ds_read_b64_tr_b16 v[16:17], v77 offset:0
    ds_read_b64_tr_b16 v[18:19], v77 offset:256
    ds_read_b64_tr_b16 v[20:21], v77 offset:2048
    ds_read_b64_tr_b16 v[22:23], v77 offset:2304
    ds_read_b64_tr_b16 v[24:25], v77 offset:16
    ds_read_b64_tr_b16 v[26:27], v77 offset:272
    ds_read_b64_tr_b16 v[28:29], v77 offset:2064
    ds_read_b64_tr_b16 v[30:31], v77 offset:2320
    s_waitcnt vmcnt(4) lgkmcnt(0)
    s_barrier
    v_add_u32 v77, 147456, v78
    ds_read_b64_tr_b16 v[32:33], v77 offset:0
    ds_read_b64_tr_b16 v[34:35], v77 offset:256
    ds_read_b64_tr_b16 v[36:37], v77 offset:2048
    ds_read_b64_tr_b16 v[38:39], v77 offset:2304
    ds_read_b64_tr_b16 v[40:41], v77 offset:16
    ds_read_b64_tr_b16 v[42:43], v77 offset:272
    ds_read_b64_tr_b16 v[44:45], v77 offset:2064
    ds_read_b64_tr_b16 v[46:47], v77 offset:2320
    s_waitcnt vmcnt(0) lgkmcnt(0)
    s_barrier
    v_add_u32 v77, 0, v78
    ds_read_b64_tr_b16 v[48:49], v77 offset:0
    ds_read_b64_tr_b16 v[50:51], v77 offset:256
    ds_read_b64_tr_b16 v[52:53], v77 offset:2048
    ds_read_b64_tr_b16 v[54:55], v77 offset:2304
    ds_read_b64_tr_b16 v[56:57], v77 offset:16
    ds_read_b64_tr_b16 v[58:59], v77 offset:272
    ds_read_b64_tr_b16 v[60:61], v77 offset:2064
    ds_read_b64_tr_b16 v[62:63], v77 offset:2320
    s_waitcnt lgkmcnt(0)
    s_barrier
    ds_write_b128 v70, v[0:3] offset:20480
    ds_write_b128 v70, v[4:7] offset:21504
    ds_write_b128 v70, v[8:11] offset:22528
    ds_write_b128 v70, v[12:15] offset:23552
    ds_write_b128 v70, v[16:19] offset:24576
    ds_write_b128 v70, v[20:23] offset:25600
    ds_write_b128 v70, v[24:27] offset:26624
    ds_write_b128 v70, v[28:31] offset:27648
    ds_write_b128 v70, v[32:35] offset:28672
    ds_write_b128 v70, v[36:39] offset:29696
    ds_write_b128 v70, v[40:43] offset:30720
    ds_write_b128 v70, v[44:47] offset:31744
    ds_write_b128 v70, v[48:51] offset:32768
    ds_write_b128 v70, v[52:55] offset:33792
    ds_write_b128 v70, v[56:59] offset:34816
    ds_write_b128 v70, v[60:63] offset:35840
    s_waitcnt lgkmcnt(0)
    v_bfe_u32 v60, v65, 4, 6
    v_and_b32 v61, 15, v60
    v_lshrrev_b32 v62, 4, v60
    v_mov_b32 v50, 0x3f80
    v_mov_b32 v51, 0x3f800000
    v_and_b32 v77, 1, v62
    v_lshlrev_b32 v77, 2, v77
    v_sub_u32 v77, v61, v77
    v_and_b32 v78, 3, v61
    v_lshlrev_b32 v78, 2, v78
    v_lshrrev_b32 v79, 2, v61
    v_add_u32 v78, v78, v79
    v_cmp_eq_u32 vcc, 0, v77
    s_nop 1
    v_cndmask_b32 v8, 0, v50, vcc
    v_cmp_eq_u32 vcc, 1, v77
    s_nop 1
    v_cndmask_b32 v8, v8, v51, vcc
    v_cmp_eq_u32 vcc, 0, v78
    s_nop 1
    v_cndmask_b32 v12, 0, v50, vcc
    v_cmp_eq_u32 vcc, 1, v78
    s_nop 1
    v_cndmask_b32 v12, v12, v51, vcc
    v_cmp_eq_u32 vcc, 2, v77
    s_nop 1
    v_cndmask_b32 v9, 0, v50, vcc
    v_cmp_eq_u32 vcc, 3, v77
    s_nop 1
    v_cndmask_b32 v9, v9, v51, vcc
    v_cmp_eq_u32 vcc, 2, v78
    s_nop 1
    v_cndmask_b32 v13, 0, v50, vcc
    v_cmp_eq_u32 vcc, 3, v78
    s_nop 1
    v_cndmask_b32 v13, v13, v51, vcc
    v_cmp_eq_u32 vcc, 8, v77
    s_nop 1
    v_cndmask_b32 v10, 0, v50, vcc
    v_cmp_eq_u32 vcc, 9, v77
    s_nop 1
    v_cndmask_b32 v10, v10, v51, vcc
    v_cmp_eq_u32 vcc, 4, v78
    s_nop 1
    v_cndmask_b32 v14, 0, v50, vcc
    v_cmp_eq_u32 vcc, 5, v78
    s_nop 1
    v_cndmask_b32 v14, v14, v51, vcc
    v_cmp_eq_u32 vcc, 10, v77
    s_nop 1
    v_cndmask_b32 v11, 0, v50, vcc
    v_cmp_eq_u32 vcc, 11, v77
    s_nop 1
    v_cndmask_b32 v11, v11, v51, vcc
    v_cmp_eq_u32 vcc, 6, v78
    s_nop 1
    v_cndmask_b32 v15, 0, v50, vcc
    v_cmp_eq_u32 vcc, 7, v78
    s_nop 1
    v_cndmask_b32 v15, v15, v51, vcc
    v_lshlrev_b32 v77, 4, v61
    ds_write_b128 v69, v[8:11] offset:15360
    ds_write_b128 v77, v[12:15] offset:15872
    s_waitcnt vmcnt(0) lgkmcnt(0)
    s_cmp_lg_u32 s95, 0
    s_cbranch_scc1 cf_hn
    s_mov_b32 s88, 4194304
gn2:
    buffer_load_dword v2, off, s[84:87], 0 offset:216 sc1
    s_waitcnt vmcnt(0)
    v_readfirstlane_b32 s95, v2
    s_sub_u32 s88, s88, 1
    s_cbranch_scc1 gn2x
    s_cmp_eq_u32 s95, 0
    s_cbranch_scc1 gn2
gn2x:
cf_hn:
    v_mov_b32 v2, 1
    s_cmp_lg_u32 s13, 0
    s_cbranch_scc1 cf_noarr
    s_mov_b64 exec, 1
    s_mov_b32 s42, 1
    v_mov_b32 v4, v76
    s_cmp_ge_u32 s94, 32
    s_cbranch_scc1 cf_have
    s_mov_b32 s40, 131072
    s_mov_b32 s42, 2
cf_startpoll:
    buffer_load_dword v3, off, s[84:87], 0 offset:132 sc1
    s_sub_u32 s40, s40, 1
    s_cbranch_scc1 cf_decide
    s_waitcnt vmcnt(0)
    v_readfirstlane_b32 s41, v3
    s_nop 1
    s_cmp_lt_u32 s41, 32
    s_cbranch_scc1 cf_startpoll
    s_mov_b32 s42, 1
cf_decide:
    v_mov_b32 v4, s42
    v_mov_b32 v5, 0
    buffer_atomic_cmpswap v[4:5], off, s[84:87], 0 offset:28 sc0
    s_waitcnt vmcnt(0)
cf_have:
    v_mov_b32 v5, s42
    v_cmp_eq_u32 vcc, 0, v4
    s_nop 1
    v_cndmask_b32 v4, v4, v5, vcc
    v_mov_b32 v5, 16192
    ds_write_b32 v5, v4
    s_waitcnt lgkmcnt(0)
    s_mov_b64 exec, -1
cf_noarr:
    s_barrier
    v_mov_b32 v5, 16192
    ds_read_b32 v4, v5
    s_waitcnt lgkmcnt(0)
    v_readfirstlane_b32 s41, v4
    s_nop 1
    s_cmp_eq_u32 s41, 1
    s_cbranch_scc1 cf_run
    v_lshrrev_b32 v0, 4, v65
    s_mov_b32 s32, s13
    s_load_dwordx16 s[48:63], s[0:1], 0
    s_waitcnt lgkmcnt(0)
    s_branch L_helper
cf_run:
    s_mov_b32 s44, 0x3e0293ee
    s_mov_b32 s45, s44
    s_or_b32 s66, s44, 0x80000000
    s_mov_b32 s48, 0x3f003f00
    s_mov_b32 s49, 0
    s_mov_b32 s50, 0x3f803f80
    s_mov_b32 s51, 0x3f803f80
    s_mov_b32 s52, 512
    s_mov_b32 s53, 1024
    s_mov_b32 s54, 1536
    s_mov_b32 s30, 0
    s_mov_b32 s37, 0
    s_lshl_b32 s47, s13, 9
    s_cmp_lg_u32 s32, 0
    s_cselect_b32 s71, s13, 3
    s_add_u32 s46, s71, 1
    s_lshr_b32 s46, s46, 1
    s_mov_b32 s14, 67125248
    s_mov_b32 s15, 67129344
    s_mov_b32 s16, 67133440
    s_mov_b32 s36, 0
    s_add_u32 s17, s68, 67108864
    s_mov_b32 s69, 0
    s_mov_b32 s70, 0
    s_lshl_b32 s26, s12, 14
    s_add_u32 s26, s26, 0
    s_mul_i32 s40, s13, 3072
    s_add_u32 s24, s26, s40
    s_lshl_b32 s96, s12, 7
    s_add_u32 s29, s96, 125845504
    s_add_u32 s96, s96, 125829120
    s_lshl_b32 s40, s12, 14
    s_add_u32 s40, s40, 68157440
    s_add_u32 s18, s40, 0
    s_add_u32 s19, s40, 4096
    s_add_u32 s20, s40, 8192
    s_add_u32 s21, s40, 12288
    s_lshr_b32 s40, s12, 3
    s_lshl_b32 s40, s40, 12
    s_and_b32 s41, s12, 7
    s_lshl_b32 s41, s41, 7
    s_add_u32 s40, s40, s41
    s_add_u32 s22, s40, 68157440
    s_add_u32 s23, s22, 1024
    s_add_u32 s25, s22, 2048
    s_mov_b32 s56, -65472
    s_cmp_lg_u32 s32, 0
    s_cselect_b64 s[38:39], -1, 0
    s_add_u32 s55, s68, 138412032
    s_cmp_eq_u32 s13, 3
    s_cselect_b64 s[100:101], 1, 0
    s_cselect_b64 s[38:39], 1, s[38:39]
    s_cselect_b32 s93, 64, 0
    s_cselect_b32 s55, s29, s55
    s_cselect_b32 s57, 0, 9216
    s_mov_b64 exec, s[100:101]
    v_mov_b32 v72, s95
    s_mov_b64 exec, -1
    s_mov_b32 s34, 0xff00ff00
    s_mov_b32 s35, 0xff00ff00
    s_lshl_b32 s28, s12, 12
    s_add_u32 s28, s28, 7340032
    s_add_u32 s27, s28, 77594624
    s_add_u32 s28, s28, 69206016
    s_cmp_ge_u32 s97, 3
    s_cbranch_scc1 cf_kvdone
    s_mov_b32 s40, 3
    v_bfe_u32 v78, v65, 2, 5
    s_mov_b32 s31, 4194304
cf_kv0:
    buffer_load_dword v77, v78, s[4:7], s96 offen offset:16 sc1
    s_waitcnt vmcnt(0)
    v_subrev_u32 v77, s95, v77
    v_cmp_lt_u32 vcc, 16, v77
    s_nop 1
    v_cndmask_b32 v77, v77, 0, vcc
    v_bfe_u32 v79, v78, 2, 2
    v_lshl_add_u32 v77, v77, 2, v79
    s_nop 1
    v_min_u32_dpp v77, v77, v77 row_ror:1 row_mask:0xf bank_mask:0xf
    s_nop 1
    v_min_u32_dpp v77, v77, v77 row_ror:2 row_mask:0xf bank_mask:0xf
    s_nop 1
    v_min_u32_dpp v77, v77, v77 row_ror:4 row_mask:0xf bank_mask:0xf
    s_nop 0
    v_readfirstlane_b32 s97, v77
    s_sub_u32 s31, s31, 1
    s_cbranch_scc1 cf_kv0_x
    s_cmp_le_u32 s40, s97
    s_cbranch_scc1 cf_kv0_x
    s_sleep 2
    s_branch cf_kv0
cf_kv0_x:
    s_add_u32 s40, s24, 0
    s_add_u32 s40, s40, s33
    s_sub_u32 s41, s96, s40
    v_bfe_u32 v77, v65, 2, 5
    v_add3_u32 v77, v77, s41, 16
    v_lshlrev_b32 v78, 3, v69
    s_nop 0
    v_mov_b32_dpp v78, v77 quad_perm:[0,1,2,3] row_mask:0xc bank_mask:0xf
    buffer_load_dword v76, v78, s[4:7], s40 offen sc1
    s_add_u32 s40, s24, 524288
    s_add_u32 s40, s40, s33
    s_sub_u32 s41, s96, s40
    v_bfe_u32 v77, v65, 2, 5
    v_add3_u32 v77, v77, s41, 16
    v_lshlrev_b32 v78, 3, v69
    s_nop 0
    v_mov_b32_dpp v78, v77 quad_perm:[0,1,2,3] row_mask:0xc bank_mask:0xf
    buffer_load_dword v76, v78, s[4:7], s40 offen sc1
cf_kvdone:
    v_mov_b64 v[0:1], 0
    v_mov_b64 v[2:3], 0
    v_mov_b64 v[4:5], 0
    v_mov_b64 v[6:7], 0
    v_mov_b64 v[8:9], 0
    v_mov_b64 v[10:11], 0
    v_mov_b64 v[12:13], 0
    v_mov_b64 v[14:15], 0
    v_mov_b64 v[16:17], 0
    v_mov_b64 v[18:19], 0
    v_mov_b64 v[20:21], 0
    v_mov_b64 v[22:23], 0
    ds_read_b128 v[44:47], v70 offset:0
    ds_read_b128 v[48:51], v70 offset:1024
    ds_read_b128 v[52:55], v70 offset:2048
    ds_read_b128 v[56:59], v70 offset:3072
    ds_read_b128 v[24:27], v70 offset:4096
    ds_read_b128 v[28:31], v70 offset:5120
    ds_read_b128 v[32:35], v70 offset:6144
    ds_read_b128 v[36:39], v70 offset:7168
    buffer_load_dwordx4 v[40:43], v65, s[4:7], s14 offen offset:0 nt
    buffer_load_dwordx4 v[60:63], v66, s[4:7], s14 offen offset:0 nt
    s_mov_b32 s31, 1048576
    s_waitcnt vmcnt(0) lgkmcnt(0)
    s_branch cf_goA
cf_loop:
    s_mov_b32 s31, 1048576
    s_mov_b32 s69, s70
    s_waitcnt lgkmcnt(0)
cf_cA:
    buffer_load_dwordx4 v[40:43], v65, s[4:7], s14 offen offset:0 nt
    buffer_load_dwordx4 v[60:63], v66, s[4:7], s14 offen offset:0 nt
cf_cA1:
    v_bitop3_b32 v77, v40, v60, s70 bitop3:0x7e
    v_and_b32 v77, 1, v77
    v_cmp_ne_u32 vcc, 0, v77
    s_cbranch_vccz cf_goA
    v_bitop3_b32 v77, v40, v60, s70 bitop3:0x7e
    v_and_b32 v77, 1, v77
    v_cmp_ne_u32 vcc, 0, v77
    s_cbranch_vccz cf_goA
    v_bitop3_b32 v77, v40, v60, s70 bitop3:0x7e
    v_and_b32 v77, 1, v77
    v_cmp_ne_u32 vcc, 0, v77
    s_cbranch_vccz cf_goA
    v_bitop3_b32 v77, v40, v60, s70 bitop3:0x7e
    v_and_b32 v77, 1, v77
    v_cmp_ne_u32 vcc, 0, v77
    s_cbranch_vccz cf_goA
    buffer_load_dwordx4 v[40:43], v65, s[4:7], s14 offen offset:0 nt
    buffer_load_dwordx4 v[60:63], v66, s[4:7], s14 offen offset:0 nt
    v_bitop3_b32 v77, v40, v60, s70 bitop3:0x7e
    v_and_b32 v77, 1, v77
    v_cmp_ne_u32 vcc, 0, v77
    s_cbranch_vccz cf_goA
    v_bitop3_b32 v77, v40, v60, s70 bitop3:0x7e
    v_and_b32 v77, 1, v77
    v_cmp_ne_u32 vcc, 0, v77
    s_cbranch_vccz cf_goA
    v_bitop3_b32 v77, v40, v60, s70 bitop3:0x7e
    v_and_b32 v77, 1, v77
    v_cmp_ne_u32 vcc, 0, v77
    s_cbranch_vccz cf_goA
    v_bitop3_b32 v77, v40, v60, s70 bitop3:0x7e
    v_and_b32 v77, 1, v77
    v_cmp_ne_u32 vcc, 0, v77
    s_cbranch_vccz cf_goA
    buffer_load_dwordx4 v[40:43], v65, s[4:7], s14 offen offset:0 nt
    buffer_load_dwordx4 v[60:63], v66, s[4:7], s14 offen offset:0 nt
    v_bitop3_b32 v77, v40, v60, s70 bitop3:0x7e
    v_and_b32 v77, 1, v77
    v_cmp_ne_u32 vcc, 0, v77
    s_cbranch_vccz cf_goA
    v_bitop3_b32 v77, v40, v60, s70 bitop3:0x7e
    v_and_b32 v77, 1, v77
    v_cmp_ne_u32 vcc, 0, v77
    s_cbranch_vccz cf_goA
    v_bitop3_b32 v77, v40, v60, s70 bitop3:0x7e
    v_and_b32 v77, 1, v77
    v_cmp_ne_u32 vcc, 0, v77
    s_cbranch_vccz cf_goA
    v_bitop3_b32 v77, v40, v60, s70 bitop3:0x7e
    v_and_b32 v77, 1, v77
    v_cmp_ne_u32 vcc, 0, v77
    s_cbranch_vccz cf_goA
    buffer_load_dwordx4 v[40:43], v65, s[4:7], s14 offen offset:0 nt
    buffer_load_dwordx4 v[60:63], v66, s[4:7], s14 offen offset:0 nt
    v_bitop3_b32 v77, v40, v60, s70 bitop3:0x7e
    v_and_b32 v77, 1, v77
    v_cmp_ne_u32 vcc, 0, v77
    s_cbranch_vccz cf_goA
    v_bitop3_b32 v77, v40, v60, s70 bitop3:0x7e
    v_and_b32 v77, 1, v77
    v_cmp_ne_u32 vcc, 0, v77
    s_cbranch_vccz cf_goA
    v_bitop3_b32 v77, v40, v60, s70 bitop3:0x7e
    v_and_b32 v77, 1, v77
    v_cmp_ne_u32 vcc, 0, v77
    s_cbranch_vccz cf_goA
    v_bitop3_b32 v77, v40, v60, s70 bitop3:0x7e
    v_and_b32 v77, 1, v77
    v_cmp_ne_u32 vcc, 0, v77
    s_cbranch_vccz cf_goA
    s_sub_u32 s31, s31, 64
    s_cbranch_scc0 cf_cA
cf_goA:
    ds_write_b128 v65, v[40:43] offset:0
    v_smfmac_f32_16x16x64_bf16 v[0:3], v[40:43], v[44:51], v64
    v_smfmac_f32_16x16x64_bf16 v[4:7], v[40:43], v[52:59], v64
    buffer_load_dwordx4 v[44:47], v65, s[4:7], s15 offen offset:0 nt
    v_smfmac_f32_16x16x64_bf16 v[0:3], v[60:63], v[24:31], v64
    s_add_u32 s40, s24, 1048576
    s_add_u32 s40, s40, s33
    s_sub_u32 s41, s96, s40
    v_smfmac_f32_16x16x64_bf16 v[4:7], v[60:63], v[32:39], v64
    ds_read_b128 v[24:27], v70 offset:8192
    s_cmp_lt_u32 s97, s93
    s_cselect_b32 s41, s41, 0
    v_smfmac_f32_16x16x64_bf16 v[8:11], v[40:43], a[96:103], v64
    ds_read_b128 v[28:31], v70 offset:9216
    v_smfmac_f32_16x16x64_bf16 v[12:15], v[40:43], a[104:111], v64
    ds_read_b128 v[32:35], v70 offset:10240
    s_waitcnt lgkmcnt(3)
    s_barrier
    ds_read_b128 v[48:51], v67 offset:0
    v_smfmac_f32_16x16x64_bf16 v[8:11], v[60:63], a[112:119], v64
    ds_read_b128 v[36:39], v70 offset:11264
    v_bitop3_b32 v79, v73, -9, s54 bitop3:0x6a
    v_smfmac_f32_16x16x64_bf16 v[12:15], v[60:63], a[120:127], v64
    buffer_load_dwordx4 v[44:47], v65, s[4:7], s15 offen offset:0 nt
    v_smfmac_f32_16x16x64_bf16 v[16:19], v[40:43], a[232:239], v64
    ds_read_b128 v[52:55], v68 offset:0
    s_waitcnt lgkmcnt(4)
    v_bfe_u32 v77, v65, 2, 5
    v_smfmac_f32_16x16x64_bf16 v[20:23], v[40:43], v[24:31], v64
    ds_read_b128 v[24:27], v70 offset:12288
    s_waitcnt lgkmcnt(3)
    v_smfmac_f32_16x16x64_bf16 v[0:3], v[48:51], a[0:7], v64
    ds_read_b128 v[28:31], v70 offset:13312
    s_waitcnt lgkmcnt(3)
    v_add3_u32 v77, v77, s41, 16
    v_smfmac_f32_16x16x64_bf16 v[4:7], v[48:51], v[32:39], v64
    buffer_load_dwordx4 v[40:43], v65, s[4:7], s16 offen offset:0 nt
    v_smfmac_f32_16x16x64_bf16 v[16:19], v[60:63], a[240:247], v64
    ds_read_b128 v[32:35], v70 offset:14336
    v_lshlrev_b32 v78, 3, v69
    v_smfmac_f32_16x16x64_bf16 v[20:23], v[60:63], a[248:255], v64
    ds_read_b128 v[36:39], v70 offset:15360
    v_smfmac_f32_16x16x64_bf16 v[8:11], v[48:51], a[128:135], v64
    s_waitcnt vmcnt(2)
    v_mov_b32_dpp v78, v77 quad_perm:[0,1,2,3] row_mask:0xc bank_mask:0xf
    v_smfmac_f32_16x16x64_bf16 v[12:15], v[48:51], a[136:143], v64
    buffer_load_dwordx4 v[58:61], v65, s[4:7], s24 offen offset:3072 sc1
    s_waitcnt lgkmcnt(2)
    v_and_b32 v77, s36, v44
    v_smfmac_f32_16x16x64_bf16 v[12:15], v[52:55], v[24:31], v64
    ds_write_b128 v65, v[44:47] offset:4096
    v_smfmac_f32_16x16x64_bf16 v[0:3], v[52:55], a[8:15], v64
    v_cmp_ne_u32 vcc, s70, v77
    v_smfmac_f32_16x16x64_bf16 v[8:11], v[52:55], a[144:151], v64
    buffer_load_dwordx4 v[24:27], v65, s[4:7], s24 offen offset:0 sc1
    s_waitcnt lgkmcnt(1)
    v_smfmac_f32_16x16x64_bf16 v[4:7], v[52:55], v[32:39], v64
    s_cbranch_vccnz cf_spinB
cf_backB:
    v_smfmac_f32_16x16x64_bf16 v[16:19], v[44:47], v[176:183], v64
    s_waitcnt lgkmcnt(0)
    s_barrier
    ds_read_b128 v[48:51], v66 offset:4096
    v_smfmac_f32_16x16x64_bf16 v[12:15], v[44:47], a[160:167], v64
    buffer_load_dwordx4 v[28:31], v65, s[4:7], s24 offen offset:1024 sc1
    v_smfmac_f32_16x16x64_bf16 v[0:3], v[44:47], a[16:23], v64
    ds_read_b128 v[52:55], v67 offset:4096
    v_smfmac_f32_16x16x64_bf16 v[8:11], v[44:47], a[152:159], v64
    v_smfmac_f32_16x16x64_bf16 v[4:7], v[44:47], a[24:31], v64
    buffer_load_dwordx4 v[34:37], v65, s[4:7], s24 offen offset:2048 sc1
    s_waitcnt vmcnt(5)
    v_smfmac_f32_16x16x64_bf16 v[20:23], v[44:47], v[184:191], v64
    ds_read_b128 v[44:47], v68 offset:4096
    s_waitcnt lgkmcnt(2)
    v_smfmac_f32_16x16x64_bf16 v[0:3], v[48:51], a[32:39], v64
    v_smfmac_f32_16x16x64_bf16 v[8:11], v[48:51], a[168:175], v64
    buffer_load_dword v76, v78, s[4:7], s40 offen sc1
    v_smfmac_f32_16x16x64_bf16 v[4:7], v[48:51], a[40:47], v64
    s_waitcnt vmcnt(5)
    v_and_b32 v77, s36, v40
    v_smfmac_f32_16x16x64_bf16 v[12:15], v[48:51], a[176:183], v64
    ds_read_b128 v[48:51], v69 offset:15360
    s_waitcnt lgkmcnt(1)
    v_cmp_ne_u32 vcc, s70, v77
    v_smfmac_f32_16x16x64_bf16 v[0:3], v[52:55], a[48:55], v64
    v_smfmac_f32_16x16x64_bf16 v[8:11], v[52:55], a[184:191], v64
    s_cbranch_vccnz cf_spin8
cf_back8:
    v_smfmac_f32_16x16x64_bf16 v[0:3], v[44:47], a[64:71], v64
    v_smfmac_f32_16x16x64_bf16 v[8:11], v[44:47], a[200:207], v64
    v_smfmac_f32_16x16x64_bf16 v[0:3], v[40:43], a[80:87], v64
    s_nop 1
    v_smfmac_f32_16x16x64_bf16 v[8:11], v[40:43], a[216:223], v64
    s_nop 1
    v_lshrrev_b32 v77, 1, v69
    v_smfmac_f32_16x16x64_bf16 v[4:7], v[52:55], a[56:63], v64
    s_nop 1
    v_cvt_pk_bf16_f32 v0, v0, v1
    v_smfmac_f32_16x16x64_bf16 v[12:15], v[52:55], a[192:199], v64
    s_nop 1
    v_cvt_pk_bf16_f32 v1, v2, v3
    v_smfmac_f32_16x16x64_bf16 v[4:7], v[44:47], a[72:79], v64
    s_nop 1
    v_cvt_pk_bf16_f32 v2, v8, v9
    v_smfmac_f32_16x16x64_bf16 v[12:15], v[44:47], a[208:215], v64
    s_nop 1
    v_cvt_pk_bf16_f32 v3, v10, v11
    v_smfmac_f32_16x16x64_bf16 v[4:7], v[40:43], a[88:95], v64
    s_waitcnt lgkmcnt(0)
    s_nop 0
    s_nop 0
    v_smfmac_f32_16x16x64_bf16 v[12:15], v[40:43], a[224:231], v64
    s_nop 2
    v_mfma_f32_16x16x32_bf16 v[8:11], v[0:3], v[48:51], 0
    s_nop 0
    v_cvt_pk_bf16_f32 v4, v4, v5
    v_cvt_pk_bf16_f32 v5, v6, v7
    s_nop 0
    v_cvt_pk_bf16_f32 v6, v12, v13
    v_cvt_pk_bf16_f32 v7, v14, v15
    s_nop 1
    v_mfma_f32_16x16x32_bf16 v[12:15], v[4:7], v[48:51], 0
    ds_read_b128 v[48:51], v66 offset:4096
    v_cvt_pk_bf16_f32 v0, v8, v9
    v_cvt_pk_bf16_f32 v1, v10, v11
    v_smfmac_f32_16x16x64_bf16 v[16:19], v[52:55], v[208:215], v64
    s_waitcnt vmcnt(2)
    s_nop 2
    v_cvt_pk_bf16_f32 v2, v12, v13
    v_cvt_pk_bf16_f32 v3, v14, v15
    s_nop 1
    v_mfma_f32_16x16x32_bf16 v[12:15], v[0:3], v[0:3], 0
    s_nop 1
    v_bitop3_b32 v78, v73, -9, s53 bitop3:0x6a
    v_mfma_f32_16x16x32_bf16 v[4:7], v[24:27], v[0:3], 0
    ds_read_b128 v[24:27], v67 offset:0
    s_nop 1
    v_mfma_f32_16x16x32_bf16 v[8:11], v[28:31], v[0:3], 0
    s_nop 0
    v_mov_b32_dpp v12, v14 row_ror:8 row_mask:0xf bank_mask:0xc
    v_mov_b32_dpp v13, v15 row_ror:8 row_mask:0xf bank_mask:0xc
    v_smfmac_f32_16x16x64_bf16 v[20:23], v[52:55], v[216:223], v64
    ds_write_b64 v71, v[12:13]
    ds_read_b128 v[52:55], v68 offset:0
    s_nop 1
    v_mov_b32_dpp v4, v8 row_ror:8 row_mask:0xf bank_mask:0xc
    v_mov_b32_dpp v5, v9 row_ror:8 row_mask:0xf bank_mask:0xc
    v_mov_b32_dpp v6, v10 row_ror:8 row_mask:0xf bank_mask:0xc
    v_mov_b32_dpp v7, v11 row_ror:8 row_mask:0xf bank_mask:0xc
    v_smfmac_f32_16x16x64_bf16 v[16:19], v[44:47], v[224:231], v64
    ds_write_b128 v65, v[4:7] offset:8192
    v_smfmac_f32_16x16x64_bf16 v[20:23], v[44:47], v[232:239], v64
    s_waitcnt lgkmcnt(3)
    v_smfmac_f32_16x16x64_bf16 v[16:19], v[24:27], v[144:151], v64
    s_waitcnt vmcnt(1)
    v_smfmac_f32_16x16x64_bf16 v[20:23], v[24:27], v[152:159], v64
    s_mov_b64 exec, s[38:39]
    buffer_store_dword v72, v75, s[4:7], s55 offen sc1
    s_mov_b64 exec, -1
    v_smfmac_f32_16x16x64_bf16 v[16:19], v[40:43], v[240:247], v64
    s_cmp_ge_u32 s30, 56
    s_waitcnt lgkmcnt(0)
    s_barrier
    ds_read_b128 v[8:11], v66 offset:8192
    v_smfmac_f32_16x16x64_bf16 v[20:23], v[40:43], v[248:255], v64
    ds_read_b128 v[12:15], v67 offset:8192
    v_smfmac_f32_16x16x64_bf16 v[16:19], v[48:51], v[192:199], v64
    ds_read_b128 v[44:47], v68 offset:8192
    v_smfmac_f32_16x16x64_bf16 v[20:23], v[48:51], v[200:207], v64
    ds_read_b64 v[24:25], v77 offset:14336
    ds_read_b64 v[26:27], v77 offset:14592
    v_smfmac_f32_16x16x64_bf16 v[16:19], v[52:55], v[160:167], v64
    ds_read_b64 v[28:29], v77 offset:14848
    ds_read_b64 v[30:31], v77 offset:15104
    v_bitop3_b32 v77, v73, -9, s52 bitop3:0x6a
    v_smfmac_f32_16x16x64_bf16 v[20:23], v[52:55], v[168:175], v64
    s_cbranch_scc1 cf_rare
cf_rare_x:
    ds_read_b128 v[48:51], v70 offset:22528
    ds_read_b128 v[52:55], v70 offset:23552
    s_waitcnt lgkmcnt(6)
    v_pk_add_f32 v[4:5], v[4:5], v[8:9]
    v_pk_add_f32 v[6:7], v[6:7], v[10:11]
    v_pk_add_f32 v[12:13], v[12:13], v[44:45]
    v_pk_add_f32 v[14:15], v[14:15], v[46:47]
    v_pk_add_f32 v[4:5], v[4:5], v[12:13]
    v_pk_add_f32 v[6:7], v[6:7], v[14:15]
    s_waitcnt lgkmcnt(2)
    v_pk_add_f32 v[24:25], v[24:25], v[26:27]
    v_pk_add_f32 v[28:29], v[28:29], v[30:31]
    v_max3_f32 v8, v4, v5, v6
    v_pk_add_f32 v[24:25], v[24:25], v[28:29]
    v_max_f32 v8, v8, v7
    v_max3_f32 v8, v8, v24, v25
    v_cvt_pk_bf16_f32 v32, v16, v17
    v_cvt_pk_bf16_f32 v38, v18, v19
    v_max_f32_dpp v8, v8, v8 row_ror:8 row_mask:0xf bank_mask:0xf
    v_mov_b32 v9, v8
    v_cvt_pk_bf16_f32 v56, v20, v21
    v_cvt_pk_bf16_f32 v62, v22, v23
    v_permlane32_swap_b32 v8, v9
    v_max_f32 v8, v8, v9
    v_mov_b32 v9, v8
    v_mov_b32 v11, 0
    v_mov_b32 v15, 0
    v_permlane16_swap_b32 v8, v9
    v_max_f32 v8, v8, v9
    v_mul_f32 v8, s66, v8
    v_pk_fma_f32 v[4:5], v[4:5], s[44:45], v[8:9] op_sel_hi:[1,1,0]
    v_pk_fma_f32 v[6:7], v[6:7], s[44:45], v[8:9] op_sel_hi:[1,1,0]
    v_pk_fma_f32 v[24:25], v[24:25], s[44:45], v[8:9] op_sel_hi:[1,1,0]
    v_exp_f32 v4, v4
    v_exp_f32 v5, v5
    v_exp_f32 v6, v6
    v_exp_f32 v7, v7
    v_exp_f32 v24, v24
    v_exp_f32 v25, v25
    v_cvt_pk_bf16_f32 v12, v4, v5
    v_cvt_pk_bf16_f32 v13, v6, v7
    v_cvt_pk_bf16_f32 v10, v24, v25
    v_cvt_pk_bf16_f32 v14, v24, v25
    v_mov_b64 v[0:1], s[48:49]
    v_mfma_f32_16x16x32_bf16 v[4:7], v[32:35], v[10:13], 0
    ds_read_b128 v[40:43], v70 offset:20480
    v_mov_b64 v[2:3], s[50:51]
    v_mfma_f32_16x16x32_bf16 v[24:27], v[36:39], v[12:15], 0
    ds_read_b128 v[44:47], v70 offset:21504
    v_mov_b64 v[8:9], 0
    v_mfma_f32_16x16x32_bf16 v[28:31], v[0:3], v[10:13], 0
    ds_read_b128 v[32:35], v70 offset:24576
    v_mov_b64 v[0:1], 0
    v_mfma_f32_16x16x32_bf16 v[16:19], v[56:59], v[10:13], 0
    ds_read_b128 v[36:39], v70 offset:25600
    v_mov_b64 v[2:3], 0
    v_mfma_f32_16x16x32_bf16 v[20:23], v[60:63], v[12:15], 0
    ds_read_b128 v[56:59], v70 offset:28672
    v_add_f32_dpp v4, v24, v4 row_ror:8 row_mask:0xf bank_mask:0xf
    v_add_f32_dpp v5, v25, v5 row_ror:8 row_mask:0xf bank_mask:0xf
    v_add_f32_dpp v6, v26, v6 row_ror:8 row_mask:0xf bank_mask:0xf
    v_add_f32_dpp v7, v27, v7 row_ror:8 row_mask:0xf bank_mask:0xf
    v_add_f32_dpp v29, v28, v28 row_ror:8 row_mask:0xf bank_mask:0xf
    v_rcp_f32 v28, v29
    v_mov_b64 v[10:11], 0
    v_add_f32_dpp v4, v16, v20 row_ror:8 row_mask:0xf bank_mask:0xc
    v_add_f32_dpp v5, v17, v21 row_ror:8 row_mask:0xf bank_mask:0xc
    v_add_f32_dpp v6, v18, v22 row_ror:8 row_mask:0xf bank_mask:0xc
    v_add_f32_dpp v7, v19, v23 row_ror:8 row_mask:0xf bank_mask:0xc
    v_pk_mul_f32 v[4:5], v[4:5], v[28:29] op_sel_hi:[1,0]
    v_pk_mul_f32 v[6:7], v[6:7], v[28:29] op_sel_hi:[1,0]
    v_cvt_pk_bf16_f32 v4, v4, v5
    v_cvt_pk_bf16_f32 v5, v6, v7
    ds_write_b64 v73, v[4:5] offset:12288
    v_mov_b32_dpp v6, v4 row_ror:8 row_mask:0xf bank_mask:0xf
    v_mov_b32_dpp v7, v5 row_ror:8 row_mask:0xf bank_mask:0xf
    v_mov_b64 v[12:13], 0
    v_mov_b64 v[14:15], 0
    v_smfmac_f32_16x16x64_bf16 v[8:11], v[4:7], v[80:87], v64
    s_waitcnt lgkmcnt(4)
    v_mov_b64 v[24:25], 0
    v_smfmac_f32_16x16x64_bf16 v[0:3], v[4:7], v[40:47], v64
    ds_read_b128 v[60:63], v70 offset:29696
    v_mov_b64 v[26:27], 0
    v_smfmac_f32_16x16x64_bf16 v[12:15], v[4:7], v[112:119], v64
    s_waitcnt lgkmcnt(1)
    s_barrier
    ds_read_b128 v[16:19], v77 offset:12288
    v_smfmac_f32_16x16x64_bf16 v[24:27], v[4:7], v[48:55], v64
    ds_read_b128 v[20:23], v78 offset:12288
    ds_read_b128 v[28:31], v79 offset:12288
    v_mov_b64 v[4:5], 0
    v_mov_b64 v[6:7], 0
    v_bfe_u32 v77, v74, 16, 1
    v_mad_i32_i24 v77, v77, s56, v74
    s_waitcnt lgkmcnt(2)
    v_smfmac_f32_16x16x64_bf16 v[8:11], v[16:19], v[88:95], v64
    ds_read_b128 v[40:43], v70 offset:32768
    s_waitcnt lgkmcnt(2)
    v_smfmac_f32_16x16x64_bf16 v[8:11], v[20:23], v[96:103], v64
    ds_read_b128 v[44:47], v70 offset:33792
    s_waitcnt lgkmcnt(2)
    v_smfmac_f32_16x16x64_bf16 v[8:11], v[28:31], v[104:111], v64
    ds_read_b128 v[48:51], v70 offset:26624
    s_nop 0
    v_and_b32 v72, 8, v73
    v_smfmac_f32_16x16x64_bf16 v[0:3], v[16:19], v[32:39], v64
    ds_read_b128 v[52:55], v70 offset:27648
    s_nop 0
    v_mad_u32_u24 v72, v72, 63, v73
    v_smfmac_f32_16x16x64_bf16 v[12:15], v[16:19], v[120:127], v64
    ds_read_b128 v[32:35], v70 offset:30720
    v_cvt_pk_bf16_f32 v8, v8, v9
    v_cvt_pk_bf16_f32 v9, v10, v11
    v_and_or_b32 v8, v8, -2, s69
    v_smfmac_f32_16x16x64_bf16 v[12:15], v[20:23], v[128:135], v64
    buffer_store_dwordx2 v[8:9], v74, s[4:7], s22 offen offset:0
    ds_read_b128 v[36:39], v70 offset:31744
    v_smfmac_f32_16x16x64_bf16 v[12:15], v[28:31], v[136:143], v64
    s_add_u32 s30, s30, 1
    s_xor_b32 s70, s70, 1
    v_subrev_u32 v72, s47, v72
    v_smfmac_f32_16x16x64_bf16 v[0:3], v[20:23], v[56:63], v64
    ds_read_b128 v[56:59], v70 offset:34816
    s_waitcnt lgkmcnt(3)
    s_nop 0
    v_smfmac_f32_16x16x64_bf16 v[0:3], v[28:31], v[40:47], v64
    ds_read_b128 v[60:63], v70 offset:35840
    v_cvt_pk_bf16_f32 v12, v12, v13
    v_cvt_pk_bf16_f32 v13, v14, v15
    v_and_or_b32 v12, v12, -2, s69
    v_smfmac_f32_16x16x64_bf16 v[24:27], v[16:19], v[48:55], v64
    buffer_store_dwordx2 v[12:13], v74, s[4:7], s22 offen offset:64
    s_waitcnt lgkmcnt(2)
    v_smfmac_f32_16x16x64_bf16 v[24:27], v[20:23], v[32:39], v64
    ds_read_b128 v[40:43], v70 offset:16384
    v_cvt_pk_bf16_f32 v0, v0, v1
    v_cvt_pk_bf16_f32 v1, v2, v3
    v_and_or_b32 v0, v0, -2, s69
    s_waitcnt lgkmcnt(1)
    v_smfmac_f32_16x16x64_bf16 v[24:27], v[28:31], v[56:63], v64
    buffer_store_dwordx2 v[0:1], v74, s[4:7], s23 offen offset:0
    ds_read_b128 v[44:47], v70 offset:17408
    ds_read_b128 v[8:11], v72 offset:12288
    ds_read_b128 v[48:51], v70 offset:18432
    ds_read_b128 v[52:55], v70 offset:19456
    ds_read_b128 v[12:15], v72 offset:13312
    s_cmp_lg_u32 s71, 0
    s_nop 0
    v_cvt_pk_bf16_f32 v24, v24, v25
    v_cvt_pk_bf16_f32 v25, v26, v27
    v_and_or_b32 v24, v24, -2, s69
    buffer_store_dwordx2 v[24:25], v74, s[4:7], s23 offen offset:64
    s_waitcnt lgkmcnt(3)
    v_smfmac_f32_16x16x64_bf16 v[4:7], v[8:11], v[40:47], v64
    s_waitcnt lgkmcnt(0)
    v_smfmac_f32_16x16x64_bf16 v[4:7], v[12:15], v[48:55], v64
    s_nop 7
    v_cvt_pk_bf16_f32 v4, v4, v5
    v_cvt_pk_bf16_f32 v5, v6, v7
    v_and_or_b32 v4, v4, -2, s69
    buffer_store_dwordx2 v[4:5], v77, s[4:7], s25 offen offset:0
    s_nop 0
    s_cbranch_scc1 cf_e1
    s_cmp_lg_u32 s37, 0
    s_cbranch_scc1 cf_f0_xt
cf_f0_xtx:
    s_nop 2
    v_mov_b32 v79, v79
    s_nop 2
    v_mov_b32 v79, v79
    s_nop 2
    v_mov_b32 v79, v79
    s_nop 2
    v_mov_b32 v79, v79
    s_nop 2
    v_mov_b32 v79, v79
    buffer_load_dwordx4 v[8:11], v65, s[4:7], s18 offen nt
    buffer_load_dwordx4 v[12:15], v65, s[4:7], s19 offen nt
    buffer_load_dwordx4 v[16:19], v65, s[4:7], s20 offen nt
    buffer_load_dwordx4 v[20:23], v65, s[4:7], s21 offen nt
    v_and_b32 v77, 255, v69
    ds_read_b128 v[4:7], v77 offset:15872
    ds_read_b128 v[44:47], v70 offset:0
    ds_read_b128 v[48:51], v70 offset:1024
    ds_read_b128 v[52:55], v70 offset:2048
    ds_read_b128 v[56:59], v70 offset:3072
    ds_read_b128 v[24:27], v70 offset:4096
    ds_read_b128 v[28:31], v70 offset:5120
    ds_read_b128 v[32:35], v70 offset:6144
    ds_read_b128 v[36:39], v70 offset:7168
    s_mov_b32 s31, 65536
    s_add_u32 s24, s24, 524288
    s_add_u32 s26, s26, 524288
    s_add_u32 s55, s55, s57
    s_mov_b32 s14, 67108864
    s_mov_b32 s15, 67112960
    s_mov_b32 s16, 67117056
    s_mov_b32 s36, 1
    v_mov_b32 v40, s69
    v_mov_b32 v60, s69
    v_and_b32 v79, 12, v75
    v_cmp_eq_u32 vcc, 0, v79
    s_nop 1
    v_cndmask_b32 v79, 0, 1, vcc
    s_waitcnt lgkmcnt(0)
    s_waitcnt vmcnt(3)
    v_xor_b32 v77, s69, v8
    v_mfma_f32_16x16x32_bf16 v[0:3], v[4:7], v[8:11], 0
    v_mov_b64 v[8:9], 0
    v_mov_b64 v[10:11], 0
    s_waitcnt vmcnt(2)
    v_bitop3_b32 v77, v77, v12, s69 bitop3:0xf6
    v_mfma_f32_16x16x32_bf16 v[0:3], v[4:7], v[12:15], v[0:3]
    v_mov_b64 v[12:13], 0
    v_mov_b64 v[14:15], 0
    s_waitcnt vmcnt(1)
    v_bitop3_b32 v77, v77, v16, s69 bitop3:0xf6
    v_mfma_f32_16x16x32_bf16 v[0:3], v[4:7], v[16:19], v[0:3]
    v_mov_b64 v[16:17], 0
    v_mov_b64 v[18:19], 0
    s_waitcnt vmcnt(0)
    v_bitop3_b32 v77, v77, v20, s69 bitop3:0xf6
    v_mfma_f32_16x16x32_bf16 v[0:3], v[4:7], v[20:23], v[0:3]
    v_and_b32 v77, 1, v77
    v_cmp_ne_u32 vcc, 0, v77
    v_mov_b64 v[20:21], 0
    v_mov_b64 v[22:23], 0
    s_cmp_eq_u64 vcc, 0
    s_cselect_b64 s[42:43], -1, 0
    s_nop 1
    v_add_f32_dpp v0, v0, v0 row_ror:8 row_mask:0xf bank_mask:0xf
    v_add_f32_dpp v1, v1, v1 row_ror:8 row_mask:0xf bank_mask:0xf
    s_mov_b64 exec, s[42:43]
    v_cvt_pk_bf16_f32 v72, v0, v1
    v_bfi_b32 v72, v79, s70, v72
    buffer_store_dword v72, v75, s[4:7], s17 offen offset:0
    s_mov_b64 exec, -1
    s_cbranch_scc0 cf_f0_retry
cf_f0_go:
    v_mov_b64 v[0:1], 0
    v_mov_b64 v[2:3], 0
    v_mov_b64 v[4:5], 0
    v_mov_b64 v[6:7], 0
    s_nop 2
    v_mov_b32 v79, v79
    s_nop 2
    v_mov_b32 v79, v79
    s_nop 2
    v_mov_b32 v79, v79
    s_nop 2
    v_mov_b32 v79, v79
    s_branch cf_loop
cf_e1:
    s_cmp_lg_u32 s71, 2
    s_cbranch_scc1 cf_f1
    v_and_b32 v77, 255, v69
    ds_read_b128 v[4:7], v77 offset:15872
    ds_read_b128 v[44:47], v70 offset:0
    ds_read_b128 v[48:51], v70 offset:1024
    ds_read_b128 v[52:55], v70 offset:2048
    ds_read_b128 v[56:59], v70 offset:3072
    ds_read_b128 v[24:27], v70 offset:4096
    ds_read_b128 v[28:31], v70 offset:5120
    ds_read_b128 v[32:35], v70 offset:6144
    ds_read_b128 v[36:39], v70 offset:7168
    s_mov_b32 s31, 65536
    s_add_u32 s24, s24, 524288
    s_add_u32 s26, s26, 524288
    s_add_u32 s55, s55, s57
    s_mov_b32 s14, 67108864
    s_mov_b32 s15, 67112960
    s_mov_b32 s16, 67117056
    s_mov_b32 s36, 1
    v_mov_b32 v40, s69
    v_mov_b32 v60, s69
    v_and_b32 v79, 12, v75
    v_cmp_eq_u32 vcc, 0, v79
    s_nop 1
    v_cndmask_b32 v79, 0, 1, vcc
    s_cmp_lg_u32 s37, 0
    s_cbranch_scc1 cf_f2_xt
cf_f2_xtx:
    s_nop 2
    v_mov_b32 v79, v79
    s_nop 2
    v_mov_b32 v79, v79
    s_nop 2
    v_mov_b32 v79, v79
    s_nop 2
    v_mov_b32 v79, v79
    s_nop 2
    v_mov_b32 v79, v79
    s_nop 2
    v_mov_b32 v79, v79
    s_nop 2
    v_mov_b32 v79, v79
    s_nop 2
    v_mov_b32 v79, v79
    s_waitcnt vmcnt(0)
    buffer_load_dwordx4 v[8:11], v65, s[4:7], s18 offen nt
    buffer_load_dwordx4 v[12:15], v65, s[4:7], s19 offen nt
    buffer_load_dwordx4 v[16:19], v65, s[4:7], s20 offen nt
    buffer_load_dwordx4 v[20:23], v65, s[4:7], s21 offen nt
    s_nop 2
    v_mov_b32 v79, v79
    s_nop 2
    v_mov_b32 v79, v79
    s_nop 2
    v_mov_b32 v79, v79
    s_nop 2
    v_mov_b32 v79, v79
    s_nop 2
    v_mov_b32 v79, v79
    s_nop 2
    v_mov_b32 v79, v79
    s_nop 2
    v_mov_b32 v79, v79
    s_nop 2
    v_mov_b32 v79, v79
    s_nop 2
    v_mov_b32 v79, v79
    s_nop 2
    v_mov_b32 v79, v79
    buffer_load_dwordx4 v[40:43], v65, s[4:7], s14 offen offset:0 nt
    buffer_load_dwordx4 v[60:63], v66, s[4:7], s14 offen offset:0 nt
    s_waitcnt lgkmcnt(0)
    s_waitcnt vmcnt(5)
    v_xor_b32 v77, s69, v8
    v_mfma_f32_16x16x32_bf16 v[0:3], v[4:7], v[8:11], 0
    v_mov_b64 v[8:9], 0
    v_mov_b64 v[10:11], 0
    s_waitcnt vmcnt(4)
    v_bitop3_b32 v77, v77, v12, s69 bitop3:0xf6
    v_mfma_f32_16x16x32_bf16 v[0:3], v[4:7], v[12:15], v[0:3]
    v_mov_b64 v[12:13], 0
    v_mov_b64 v[14:15], 0
    s_waitcnt vmcnt(3)
    v_bitop3_b32 v77, v77, v16, s69 bitop3:0xf6
    v_mfma_f32_16x16x32_bf16 v[0:3], v[4:7], v[16:19], v[0:3]
    v_mov_b64 v[16:17], 0
    v_mov_b64 v[18:19], 0
    s_waitcnt vmcnt(2)
    v_bitop3_b32 v77, v77, v20, s69 bitop3:0xf6
    v_mfma_f32_16x16x32_bf16 v[0:3], v[4:7], v[20:23], v[0:3]
    v_and_b32 v77, 1, v77
    v_cmp_ne_u32 vcc, 0, v77
    v_mov_b64 v[20:21], 0
    v_mov_b64 v[22:23], 0
    buffer_load_dwordx4 v[40:43], v65, s[4:7], s14 offen offset:0 nt
    buffer_load_dwordx4 v[60:63], v66, s[4:7], s14 offen offset:0 nt
    s_cmp_eq_u64 vcc, 0
    s_cselect_b64 s[42:43], -1, 0
    v_add_f32_dpp v0, v0, v0 row_ror:4 row_mask:0xf bank_mask:0xf
    v_add_f32_dpp v1, v1, v1 row_ror:4 row_mask:0xf bank_mask:0xf
    s_nop 0
    v_add_f32_dpp v0, v0, v0 row_ror:8 row_mask:0xf bank_mask:0xf
    v_add_f32_dpp v1, v1, v1 row_ror:8 row_mask:0xf bank_mask:0xf
    s_mov_b64 exec, s[42:43]
    v_cvt_pk_bf16_f32 v72, v0, v1
    v_bfi_b32 v72, v79, s70, v72
    buffer_store_dword v72, v75, s[4:7], s17 offen offset:0
    buffer_store_dword v72, v75, s[4:7], s17 offen offset:1024
    buffer_store_dword v72, v75, s[4:7], s17 offen offset:2048
    buffer_store_dword v72, v75, s[4:7], s17 offen offset:3072
    s_mov_b64 exec, -1
    s_cbranch_scc0 cf_f2_retry
cf_f2_go:
    v_mov_b64 v[0:1], 0
    v_mov_b64 v[2:3], 0
    v_mov_b64 v[4:5], 0
    v_mov_b64 v[6:7], 0
    s_branch cf_loop
cf_f1:
    s_cmp_lg_u32 s32, 1
    s_cbranch_scc1 cf_f3
    v_and_b32 v77, 255, v69
    ds_read_b128 v[4:7], v77 offset:15872
    ds_read_b128 v[44:47], v70 offset:0
    ds_read_b128 v[48:51], v70 offset:1024
    ds_read_b128 v[52:55], v70 offset:2048
    ds_read_b128 v[56:59], v70 offset:3072
    ds_read_b128 v[24:27], v70 offset:4096
    ds_read_b128 v[28:31], v70 offset:5120
    ds_read_b128 v[32:35], v70 offset:6144
    ds_read_b128 v[36:39], v70 offset:7168
    s_mov_b32 s31, 65536
    s_add_u32 s24, s24, 524288
    s_add_u32 s26, s26, 524288
    s_add_u32 s55, s55, s57
    s_mov_b32 s14, 67108864
    s_mov_b32 s15, 67112960
    s_mov_b32 s16, 67117056
    s_mov_b32 s36, 1
    v_mov_b32 v40, s69
    v_mov_b32 v60, s69
    v_and_b32 v79, 12, v75
    v_cmp_eq_u32 vcc, 0, v79
    s_nop 1
    v_cndmask_b32 v79, 0, 1, vcc
    s_cmp_lg_u32 s37, 0
    s_cbranch_scc1 cf_f1_xt
cf_f1_xtx:
    s_nop 2
    v_mov_b32 v79, v79
    s_waitcnt vmcnt(0)
    buffer_load_dwordx4 v[8:11], v65, s[4:7], s18 offen nt
    buffer_load_dwordx4 v[12:15], v65, s[4:7], s19 offen nt
    buffer_load_dwordx4 v[16:19], v65, s[4:7], s20 offen nt
    buffer_load_dwordx4 v[20:23], v65, s[4:7], s21 offen nt
    s_nop 2
    v_mov_b32 v79, v79
    s_nop 2
    v_mov_b32 v79, v79
    s_nop 2
    v_mov_b32 v79, v79
    s_nop 2
    v_mov_b32 v79, v79
    s_nop 2
    v_mov_b32 v79, v79
    s_nop 2
    v_mov_b32 v79, v79
    s_nop 2
    v_mov_b32 v79, v79
    s_nop 2
    v_mov_b32 v79, v79
    s_nop 2
    v_mov_b32 v79, v79
    s_nop 2
    v_mov_b32 v79, v79
    buffer_load_dwordx4 v[40:43], v65, s[4:7], s14 offen offset:0 nt
    buffer_load_dwordx4 v[60:63], v66, s[4:7], s14 offen offset:0 nt
    s_waitcnt lgkmcnt(0)
    s_waitcnt vmcnt(5)
    v_xor_b32 v77, s69, v8
    v_mfma_f32_16x16x32_bf16 v[0:3], v[4:7], v[8:11], 0
    v_mov_b64 v[8:9], 0
    v_mov_b64 v[10:11], 0
    s_waitcnt vmcnt(4)
    v_bitop3_b32 v77, v77, v12, s69 bitop3:0xf6
    v_mfma_f32_16x16x32_bf16 v[0:3], v[4:7], v[12:15], v[0:3]
    v_mov_b64 v[12:13], 0
    v_mov_b64 v[14:15], 0
    s_waitcnt vmcnt(3)
    v_bitop3_b32 v77, v77, v16, s69 bitop3:0xf6
    v_mfma_f32_16x16x32_bf16 v[0:3], v[4:7], v[16:19], v[0:3]
    v_mov_b64 v[16:17], 0
    v_mov_b64 v[18:19], 0
    s_waitcnt vmcnt(2)
    v_bitop3_b32 v77, v77, v20, s69 bitop3:0xf6
    v_mfma_f32_16x16x32_bf16 v[0:3], v[4:7], v[20:23], v[0:3]
    v_and_b32 v77, 1, v77
    v_cmp_ne_u32 vcc, 0, v77
    v_mov_b64 v[20:21], 0
    v_mov_b64 v[22:23], 0
    buffer_load_dwordx4 v[40:43], v65, s[4:7], s14 offen offset:0 nt
    buffer_load_dwordx4 v[60:63], v66, s[4:7], s14 offen offset:0 nt
    s_cmp_eq_u64 vcc, 0
    s_cselect_b64 s[42:43], -1, 0
    v_add_f32_dpp v0, v0, v0 row_ror:8 row_mask:0xf bank_mask:0xf
    v_add_f32_dpp v1, v1, v1 row_ror:8 row_mask:0xf bank_mask:0xf
    s_mov_b64 exec, s[42:43]
    v_cvt_pk_bf16_f32 v72, v0, v1
    v_bfi_b32 v72, v79, s70, v72
    buffer_store_dword v72, v75, s[4:7], s17 offen offset:0
    s_mov_b64 exec, -1
    s_cbranch_scc0 cf_f1_retry
cf_f1_go:
    v_mov_b64 v[0:1], 0
    v_mov_b64 v[2:3], 0
    v_mov_b64 v[4:5], 0
    v_mov_b64 v[6:7], 0
    s_branch cf_loop
cf_f3:
    v_and_b32 v77, 255, v69
    ds_read_b128 v[4:7], v77 offset:15872
    ds_read_b128 v[44:47], v70 offset:0
    ds_read_b128 v[48:51], v70 offset:1024
    ds_read_b128 v[52:55], v70 offset:2048
    ds_read_b128 v[56:59], v70 offset:3072
    ds_read_b128 v[24:27], v70 offset:4096
    ds_read_b128 v[28:31], v70 offset:5120
    ds_read_b128 v[32:35], v70 offset:6144
    ds_read_b128 v[36:39], v70 offset:7168
    s_mov_b32 s31, 65536
    s_add_u32 s24, s24, 524288
    s_add_u32 s26, s26, 524288
    s_add_u32 s55, s55, s57
    s_mov_b32 s14, 67108864
    s_mov_b32 s15, 67112960
    s_mov_b32 s16, 67117056
    s_mov_b32 s36, 1
    v_mov_b32 v40, s69
    v_mov_b32 v60, s69
    v_and_b32 v79, 12, v75
    v_cmp_eq_u32 vcc, 0, v79
    s_nop 1
    v_cndmask_b32 v79, 0, 1, vcc
    s_add_u32 s40, s30, s95
    v_mov_b32 v72, s40
    s_waitcnt lgkmcnt(0)
    v_mov_b64 v[0:1], 0
    v_mov_b64 v[2:3], 0
    v_mov_b64 v[4:5], 0
    v_mov_b64 v[6:7], 0
    v_mov_b64 v[8:9], 0
    v_mov_b64 v[10:11], 0
    v_mov_b64 v[12:13], 0
    v_mov_b64 v[14:15], 0
    v_mov_b64 v[16:17], 0
    v_mov_b64 v[18:19], 0
    v_mov_b64 v[20:21], 0
    v_mov_b64 v[22:23], 0
    s_nop 2
    v_mov_b32 v79, v79
    s_nop 2
    v_mov_b32 v79, v79
    s_nop 2
    v_mov_b32 v79, v79
    s_nop 2
    v_mov_b32 v79, v79
    s_nop 2
    v_mov_b32 v79, v79
    s_nop 2
    v_mov_b32 v79, v79
    s_nop 2
    v_mov_b32 v79, v79
    s_nop 2
    v_mov_b32 v79, v79
    s_nop 2
    v_mov_b32 v79, v79
    s_waitcnt vmcnt(0)
    s_cmp_lt_u32 s97, s93
    s_cbranch_scc1 cf_kvwait
    s_nop 2
    v_mov_b32 v79, v79
    s_nop 2
    v_mov_b32 v79, v79
    s_nop 2
    v_mov_b32 v79, v79
    s_nop 2
    v_mov_b32 v79, v79
    s_nop 2
    v_mov_b32 v79, v79
    s_nop 2
    v_mov_b32 v79, v79
    s_nop 2
    v_mov_b32 v79, v79
    s_nop 2
    v_mov_b32 v79, v79
cf_kvok:
    s_branch cf_loop
cf_f0_xt:
    s_mov_b32 s37, 0
    s_nop 2
    v_mov_b32 v79, v79
    s_nop 2
    v_mov_b32 v79, v79
    s_nop 2
    v_mov_b32 v79, v79
    s_nop 2
    v_mov_b32 v79, v79
    s_nop 2
    v_mov_b32 v79, v79
    s_nop 2
    v_mov_b32 v79, v79
    s_branch cf_f0_xtx
cf_f0_retry:
    s_mov_b32 s37, 1
cf_f0_spin:
    buffer_load_dwordx4 v[8:11], v65, s[4:7], s18 offen nt
    buffer_load_dwordx4 v[12:15], v65, s[4:7], s19 offen nt
    buffer_load_dwordx4 v[16:19], v65, s[4:7], s20 offen nt
    buffer_load_dwordx4 v[20:23], v65, s[4:7], s21 offen nt
    s_nop 2
    v_mov_b32 v79, v79
    s_nop 2
    v_mov_b32 v79, v79
    s_nop 2
    v_mov_b32 v79, v79
    buffer_load_dwordx4 v[40:43], v65, s[4:7], s14 offen offset:0 nt
    buffer_load_dwordx4 v[60:63], v66, s[4:7], s14 offen offset:0 nt
    s_waitcnt vmcnt(5)
    v_xor_b32 v77, s69, v8
    v_mfma_f32_16x16x32_bf16 v[0:3], v[4:7], v[8:11], 0
    v_mov_b64 v[8:9], 0
    v_mov_b64 v[10:11], 0
    s_waitcnt vmcnt(4)
    v_bitop3_b32 v77, v77, v12, s69 bitop3:0xf6
    v_mfma_f32_16x16x32_bf16 v[0:3], v[4:7], v[12:15], v[0:3]
    v_mov_b64 v[12:13], 0
    v_mov_b64 v[14:15], 0
    s_waitcnt vmcnt(3)
    v_bitop3_b32 v77, v77, v16, s69 bitop3:0xf6
    v_mfma_f32_16x16x32_bf16 v[0:3], v[4:7], v[16:19], v[0:3]
    v_mov_b64 v[16:17], 0
    v_mov_b64 v[18:19], 0
    s_waitcnt vmcnt(2)
    v_bitop3_b32 v77, v77, v20, s69 bitop3:0xf6
    v_mfma_f32_16x16x32_bf16 v[0:3], v[4:7], v[20:23], v[0:3]
    v_and_b32 v77, 1, v77
    v_cmp_ne_u32 vcc, 0, v77
    v_mov_b64 v[20:21], 0
    v_mov_b64 v[22:23], 0
    buffer_load_dwordx4 v[40:43], v65, s[4:7], s14 offen offset:0 nt
    buffer_load_dwordx4 v[60:63], v66, s[4:7], s14 offen offset:0 nt
    s_cmp_eq_u64 vcc, 0
    s_cselect_b64 s[42:43], -1, 0
    v_add_f32_dpp v0, v0, v0 row_ror:8 row_mask:0xf bank_mask:0xf
    v_add_f32_dpp v1, v1, v1 row_ror:8 row_mask:0xf bank_mask:0xf
    s_mov_b64 exec, s[42:43]
    v_cvt_pk_bf16_f32 v72, v0, v1
    v_bfi_b32 v72, v79, s70, v72
    buffer_store_dword v72, v75, s[4:7], s17 offen offset:0
    s_mov_b64 exec, -1
    s_cbranch_scc1 cf_f0_rx
    s_sub_u32 s31, s31, 1
    s_cbranch_scc0 cf_f0_spin
cf_f0_rx:
    v_mov_b64 v[0:1], 0
    v_mov_b64 v[2:3], 0
    v_mov_b64 v[4:5], 0
    v_mov_b64 v[6:7], 0
    s_branch cf_loop
cf_f1_xt:
    s_mov_b32 s37, 0
    s_nop 2
    v_mov_b32 v79, v79
    s_nop 2
    v_mov_b32 v79, v79
    s_nop 2
    v_mov_b32 v79, v79
    s_nop 2
    v_mov_b32 v79, v79
    s_nop 2
    v_mov_b32 v79, v79
    s_nop 2
    v_mov_b32 v79, v79
    s_branch cf_f1_xtx
cf_f1_retry:
    s_mov_b32 s37, 1
cf_f1_spin:
    buffer_load_dwordx4 v[8:11], v65, s[4:7], s18 offen nt
    buffer_load_dwordx4 v[12:15], v65, s[4:7], s19 offen nt
    buffer_load_dwordx4 v[16:19], v65, s[4:7], s20 offen nt
    buffer_load_dwordx4 v[20:23], v65, s[4:7], s21 offen nt
    s_nop 2
    v_mov_b32 v79, v79
    s_nop 2
    v_mov_b32 v79, v79
    s_nop 2
    v_mov_b32 v79, v79
    buffer_load_dwordx4 v[40:43], v65, s[4:7], s14 offen offset:0 nt
    buffer_load_dwordx4 v[60:63], v66, s[4:7], s14 offen offset:0 nt
    s_waitcnt vmcnt(5)
    v_xor_b32 v77, s69, v8
    v_mfma_f32_16x16x32_bf16 v[0:3], v[4:7], v[8:11], 0
    v_mov_b64 v[8:9], 0
    v_mov_b64 v[10:11], 0
    s_waitcnt vmcnt(4)
    v_bitop3_b32 v77, v77, v12, s69 bitop3:0xf6
    v_mfma_f32_16x16x32_bf16 v[0:3], v[4:7], v[12:15], v[0:3]
    v_mov_b64 v[12:13], 0
    v_mov_b64 v[14:15], 0
    s_waitcnt vmcnt(3)
    v_bitop3_b32 v77, v77, v16, s69 bitop3:0xf6
    v_mfma_f32_16x16x32_bf16 v[0:3], v[4:7], v[16:19], v[0:3]
    v_mov_b64 v[16:17], 0
    v_mov_b64 v[18:19], 0
    s_waitcnt vmcnt(2)
    v_bitop3_b32 v77, v77, v20, s69 bitop3:0xf6
    v_mfma_f32_16x16x32_bf16 v[0:3], v[4:7], v[20:23], v[0:3]
    v_and_b32 v77, 1, v77
    v_cmp_ne_u32 vcc, 0, v77
    v_mov_b64 v[20:21], 0
    v_mov_b64 v[22:23], 0
    buffer_load_dwordx4 v[40:43], v65, s[4:7], s14 offen offset:0 nt
    buffer_load_dwordx4 v[60:63], v66, s[4:7], s14 offen offset:0 nt
    s_cmp_eq_u64 vcc, 0
    s_cselect_b64 s[42:43], -1, 0
    v_add_f32_dpp v0, v0, v0 row_ror:8 row_mask:0xf bank_mask:0xf
    v_add_f32_dpp v1, v1, v1 row_ror:8 row_mask:0xf bank_mask:0xf
    s_mov_b64 exec, s[42:43]
    v_cvt_pk_bf16_f32 v72, v0, v1
    v_bfi_b32 v72, v79, s70, v72
    buffer_store_dword v72, v75, s[4:7], s17 offen offset:0
    s_mov_b64 exec, -1
    s_cbranch_scc1 cf_f1_rx
    s_sub_u32 s31, s31, 1
    s_cbranch_scc0 cf_f1_spin
cf_f1_rx:
    v_mov_b64 v[0:1], 0
    v_mov_b64 v[2:3], 0
    v_mov_b64 v[4:5], 0
    v_mov_b64 v[6:7], 0
    s_branch cf_loop
cf_f2_xt:
    s_mov_b32 s37, 0
    s_nop 2
    v_mov_b32 v79, v79
    s_nop 2
    v_mov_b32 v79, v79
    s_nop 2
    v_mov_b32 v79, v79
    s_nop 2
    v_mov_b32 v79, v79
    s_nop 2
    v_mov_b32 v79, v79
    s_nop 2
    v_mov_b32 v79, v79
    s_branch cf_f2_xtx
cf_f2_retry:
    s_mov_b32 s37, 1
cf_f2_spin:
    buffer_load_dwordx4 v[8:11], v65, s[4:7], s18 offen nt
    buffer_load_dwordx4 v[12:15], v65, s[4:7], s19 offen nt
    buffer_load_dwordx4 v[16:19], v65, s[4:7], s20 offen nt
    buffer_load_dwordx4 v[20:23], v65, s[4:7], s21 offen nt
    s_nop 2
    v_mov_b32 v79, v79
    s_nop 2
    v_mov_b32 v79, v79
    s_nop 2
    v_mov_b32 v79, v79
    buffer_load_dwordx4 v[40:43], v65, s[4:7], s14 offen offset:0 nt
    buffer_load_dwordx4 v[60:63], v66, s[4:7], s14 offen offset:0 nt
    s_waitcnt vmcnt(5)
    v_xor_b32 v77, s69, v8
    v_mfma_f32_16x16x32_bf16 v[0:3], v[4:7], v[8:11], 0
    v_mov_b64 v[8:9], 0
    v_mov_b64 v[10:11], 0
    s_waitcnt vmcnt(4)
    v_bitop3_b32 v77, v77, v12, s69 bitop3:0xf6
    v_mfma_f32_16x16x32_bf16 v[0:3], v[4:7], v[12:15], v[0:3]
    v_mov_b64 v[12:13], 0
    v_mov_b64 v[14:15], 0
    s_waitcnt vmcnt(3)
    v_bitop3_b32 v77, v77, v16, s69 bitop3:0xf6
    v_mfma_f32_16x16x32_bf16 v[0:3], v[4:7], v[16:19], v[0:3]
    v_mov_b64 v[16:17], 0
    v_mov_b64 v[18:19], 0
    s_waitcnt vmcnt(2)
    v_bitop3_b32 v77, v77, v20, s69 bitop3:0xf6
    v_mfma_f32_16x16x32_bf16 v[0:3], v[4:7], v[20:23], v[0:3]
    v_and_b32 v77, 1, v77
    v_cmp_ne_u32 vcc, 0, v77
    v_mov_b64 v[20:21], 0
    v_mov_b64 v[22:23], 0
    buffer_load_dwordx4 v[40:43], v65, s[4:7], s14 offen offset:0 nt
    buffer_load_dwordx4 v[60:63], v66, s[4:7], s14 offen offset:0 nt
    s_cmp_eq_u64 vcc, 0
    s_cselect_b64 s[42:43], -1, 0
    v_add_f32_dpp v0, v0, v0 row_ror:4 row_mask:0xf bank_mask:0xf
    v_add_f32_dpp v1, v1, v1 row_ror:4 row_mask:0xf bank_mask:0xf
    s_nop 0
    v_add_f32_dpp v0, v0, v0 row_ror:8 row_mask:0xf bank_mask:0xf
    v_add_f32_dpp v1, v1, v1 row_ror:8 row_mask:0xf bank_mask:0xf
    s_mov_b64 exec, s[42:43]
    v_cvt_pk_bf16_f32 v72, v0, v1
    v_bfi_b32 v72, v79, s70, v72
    buffer_store_dword v72, v75, s[4:7], s17 offen offset:0
    buffer_store_dword v72, v75, s[4:7], s17 offen offset:1024
    buffer_store_dword v72, v75, s[4:7], s17 offen offset:2048
    buffer_store_dword v72, v75, s[4:7], s17 offen offset:3072
    s_mov_b64 exec, -1
    s_cbranch_scc1 cf_f2_rx
    s_sub_u32 s31, s31, 1
    s_cbranch_scc0 cf_f2_spin
cf_f2_rx:
    v_mov_b64 v[0:1], 0
    v_mov_b64 v[2:3], 0
    v_mov_b64 v[4:5], 0
    v_mov_b64 v[6:7], 0
    s_branch cf_loop
cf_spinB:
    s_waitcnt vmcnt(3)
cf_spinB_l:
    v_and_b32 v77, s36, v44
    v_cmp_ne_u32 vcc, s70, v77
    s_cbranch_vccz cf_spinB_x
    buffer_load_dwordx4 v[44:47], v65, s[4:7], s15 offen nt
    s_sub_u32 s31, s31, 16
    s_waitcnt vmcnt(0)
    s_cbranch_scc0 cf_spinB_l
cf_spinB_x:
    ds_write_b128 v65, v[44:47] offset:4096
    s_waitcnt lgkmcnt(0)
    s_branch cf_backB
cf_spin8:
    buffer_load_dwordx4 v[40:43], v65, s[4:7], s16 offen nt
cf_spin8_l:
    v_and_b32 v77, s36, v40
    v_cmp_ne_u32 vcc, s70, v77
    s_cbranch_vccz cf_spin8_x
    s_nop 1
    v_and_b32 v77, s36, v40
    v_cmp_ne_u32 vcc, s70, v77
    s_cbranch_vccz cf_spin8_x
    s_nop 1
    v_and_b32 v77, s36, v40
    v_cmp_ne_u32 vcc, s70, v77
    s_cbranch_vccz cf_spin8_x
    s_nop 1
    buffer_load_dwordx4 v[40:43], v65, s[4:7], s16 offen nt
    s_sub_u32 s31, s31, 16
    s_cbranch_scc0 cf_spin8_l
cf_spin8_x:
    s_branch cf_back8
cf_rare:
    s_mov_b64 exec, s[34:35]
    buffer_store_dwordx4 v[0:3], v65, s[4:7], s28 offen sc1
    s_mov_b64 exec, -1
    s_nop 3
    v_cvt_pk_bf16_f32 v52, v16, v17
    v_cvt_pk_bf16_f32 v53, v18, v19
    v_cvt_pk_bf16_f32 v54, v20, v21
    v_cvt_pk_bf16_f32 v55, v22, v23
    buffer_store_dwordx4 v[52:55], v65, s[4:7], s27 offen sc1
    s_add_u32 s28, s28, 131072
    s_add_u32 s27, s27, 131072
    s_cmp_eq_u32 s30, 63
    s_cbranch_scc1 cf_last
    s_branch cf_rare_x
cf_kvwait:
    s_mov_b32 s41, s97
    v_bfe_u32 v78, v65, 2, 5
    v_mov_b32 v77, v76
    s_nop 1
    v_permlane32_swap_b32 v76, v77
    v_subrev_u32 v77, s95, v77
    v_cmp_lt_u32 vcc, 16, v77
    s_nop 1
    v_cndmask_b32 v77, v77, 0, vcc
    v_bfe_u32 v79, v78, 2, 2
    v_lshl_add_u32 v77, v77, 2, v79
    s_nop 1
    v_min_u32_dpp v77, v77, v77 row_ror:1 row_mask:0xf bank_mask:0xf
    s_nop 1
    v_min_u32_dpp v77, v77, v77 row_ror:2 row_mask:0xf bank_mask:0xf
    s_nop 1
    v_min_u32_dpp v77, v77, v77 row_ror:4 row_mask:0xf bank_mask:0xf
    s_nop 0
    v_readfirstlane_b32 s97, v77
    s_nop 0
    s_max_u32 s97, s97, s41
    s_add_u32 s40, s30, 3
    s_min_u32 s40, s40, 64
    s_cmp_le_u32 s40, s97
    s_cbranch_scc1 cf_kvw_x
    v_bfe_u32 v78, v65, 2, 5
    s_mov_b32 s31, 4194304
cf_kvw:
    buffer_load_dword v77, v78, s[4:7], s96 offen offset:16 sc1
    s_waitcnt vmcnt(0)
    v_subrev_u32 v77, s95, v77
    v_cmp_lt_u32 vcc, 16, v77
    s_nop 1
    v_cndmask_b32 v77, v77, 0, vcc
    v_bfe_u32 v79, v78, 2, 2
    v_lshl_add_u32 v77, v77, 2, v79
    s_nop 1
    v_min_u32_dpp v77, v77, v77 row_ror:1 row_mask:0xf bank_mask:0xf
    s_nop 1
    v_min_u32_dpp v77, v77, v77 row_ror:2 row_mask:0xf bank_mask:0xf
    s_nop 1
    v_min_u32_dpp v77, v77, v77 row_ror:4 row_mask:0xf bank_mask:0xf
    s_nop 0
    v_readfirstlane_b32 s97, v77
    s_sub_u32 s31, s31, 1
    s_cbranch_scc1 cf_kvw_x
    s_cmp_le_u32 s40, s97
    s_cbranch_scc1 cf_kvw_x
    s_sleep 2
    s_branch cf_kvw
cf_kvw_x:
    s_branch cf_kvok
cf_last:
    s_add_u32 s40, s95, 64
    v_mov_b32 v78, s40
    s_waitcnt vmcnt(0)
    s_barrier
    s_mov_b64 exec, s[100:101]
    buffer_store_dword v78, off, s[4:7], s29 sc1
    s_mov_b64 exec, -1
cf_end:
    s_endpgm
L_chain_safe:
    s_load_dwordx8 s[48:55], s[0:1], 8
    s_load_dwordx2 s[56:57], s[0:1], 40
    s_waitcnt lgkmcnt(0)
    v_lshrrev_b32 v77, 6, v0
    s_nop 0
    v_readfirstlane_b32 s13, v77
    v_lshlrev_b32 v65, 4, v0
    v_and_b32 v48, 63, v0
    s_mov_b32 s10, 4718592
    s_mov_b32 s11, 0x20000
    v_lshrrev_b32 v49, 3, v48
    v_mul_u32_u24 v18, 1152, v49
    v_and_b32 v49, 7, v48
    v_lshl_add_u32 v18, v49, 4, v18
    s_mul_i32 s40, s12, 147456
    s_lshl_b32 s41, s13, 8
    s_add_u32 s40, s40, s41
    s_mov_b32 s42, s40
    s_xor_b32 s41, s13, 0
    s_mul_i32 s41, s41, 36864
    s_add_u32 s60, s41, s40
    s_xor_b32 s41, s13, 1
    s_mul_i32 s41, s41, 36864
    s_add_u32 s61, s41, s40
    s_xor_b32 s41, s13, 2
    s_mul_i32 s41, s41, 36864
    s_add_u32 s62, s41, s40
    s_xor_b32 s41, s13, 3
    s_mul_i32 s41, s41, 36864
    s_add_u32 s63, s41, s40
    s_lshl_b32 s43, s13, 12
    s_mov_b64 s[8:9], s[56:57]
    s_add_u32 m0, s43, 0
    s_add_u32 s41, s60, 0
    buffer_load_dwordx4 v18, s[8:11], s41 offen offset:0 nt lds
    s_add_u32 s41, s60, 8192
    buffer_load_dwordx4 v18, s[8:11], s41 offen offset:1024 nt lds
    s_add_u32 s41, s60, 16384
    buffer_load_dwordx4 v18, s[8:11], s41 offen offset:2048 nt lds
    s_add_u32 s41, s60, 24576
    buffer_load_dwordx4 v18, s[8:11], s41 offen offset:3072 nt lds
    s_add_u32 m0, s43, 36864
    s_add_u32 s41, s61, 0
    buffer_load_dwordx4 v18, s[8:11], s41 offen offset:0 nt lds
    s_add_u32 s41, s61, 8192
    buffer_load_dwordx4 v18, s[8:11], s41 offen offset:1024 nt lds
    s_add_u32 s41, s61, 16384
    buffer_load_dwordx4 v18, s[8:11], s41 offen offset:2048 nt lds
    s_add_u32 s41, s61, 24576
    buffer_load_dwordx4 v18, s[8:11], s41 offen offset:3072 nt lds
    s_add_u32 m0, s43, 73728
    s_add_u32 s41, s62, 0
    buffer_load_dwordx4 v18, s[8:11], s41 offen offset:0 nt lds
    s_add_u32 s41, s62, 8192
    buffer_load_dwordx4 v18, s[8:11], s41 offen offset:1024 nt lds
    s_add_u32 s41, s62, 16384
    buffer_load_dwordx4 v18, s[8:11], s41 offen offset:2048 nt lds
    s_add_u32 s41, s62, 24576
    buffer_load_dwordx4 v18, s[8:11], s41 offen offset:3072 nt lds
    s_add_u32 m0, s43, 110592
    s_add_u32 s41, s63, 0
    buffer_load_dwordx4 v18, s[8:11], s41 offen offset:0 nt lds
    s_add_u32 s41, s63, 8192
    buffer_load_dwordx4 v18, s[8:11], s41 offen offset:1024 nt lds
    s_add_u32 s41, s63, 16384
    buffer_load_dwordx4 v18, s[8:11], s41 offen offset:2048 nt lds
    s_add_u32 s41, s63, 24576
    buffer_load_dwordx4 v18, s[8:11], s41 offen offset:3072 nt lds
    v_lshrrev_b32 v49, 1, v48
    v_mul_u32_u24 v19, 1152, v49
    v_and_b32 v49, 1, v48
    v_lshl_add_u32 v19, v49, 4, v19
    s_mul_i32 s41, s13, 224
    s_sub_u32 s41, 1024, s41
    v_add_u32 v19, s41, v19
    v_lshrrev_b32 v49, 4, v48
    v_lshlrev_b32 v50, 2, v49
    v_and_b32 v51, 15, v48
    v_xor_b32 v51, v51, v50
    v_lshlrev_b32 v51, 4, v51
    v_lshl_add_u32 v16, v49, 15, v51
    v_lshrrev_b32 v50, 1, v49
    v_lshl_add_u32 v17, v50, 16, v51
    v_and_b32 v50, 1, v49
    v_lshl_add_u32 v17, v50, 13, v17
    s_lshl_b32 s40, s12, 8
    s_mul_i32 s58, s13, 1048576
    s_add_u32 s58, s58, s40
    s_lshr_b32 s41, s13, 1
    s_mul_i32 s59, s41, 262144
    s_and_b32 s41, s13, 1
    s_lshl_b32 s41, s41, 14
    s_add_u32 s59, s59, s41
    s_add_u32 s59, s59, s40
    s_add_u32 s59, s59, 4194304
    v_bfe_u32 v50, v48, 2, 2
    v_xor_b32 v51, s13, v50
    v_lshlrev_b32 v20, 6, v51
    v_and_b32 v51, 3, v48
    v_lshl_add_u32 v20, v51, 4, v20
    v_lshrrev_b32 v23, 2, v48
    v_lshl_add_u32 v20, v23, 8, v20
    s_xor_b32 s41, s43, 0
    v_add_u32 v24, s41, v20
    s_xor_b32 s41, s43, 4096
    v_add_u32 v25, s41, v20
    s_xor_b32 s41, s43, 8192
    v_add_u32 v26, s41, v20
    s_xor_b32 s41, s43, 12288
    v_add_u32 v27, s41, v20
    v_and_b32 v23, 1, v50
    v_lshl_add_u32 v23, v49, 2, v23
    v_lshrrev_b32 v50, 1, v50
    v_lshlrev_b32 v21, 7, v23
    v_lshl_add_u32 v21, v50, 6, v21
    v_lshrrev_b32 v16, 1, v51
    v_lshl_add_u32 v21, v16, 5, v21
    v_and_b32 v16, 1, v51
    v_lshl_add_u32 v21, v16, 3, v21
    v_add_u32 v21, s43, v21
    v_lshlrev_b32 v22, 9, v50
    v_xor_b32 v22, v22, v21
    v_lshlrev_b32 v23, 5, v23
    v_lshl_add_u32 v23, v50, 10, v23
    v_lshl_add_u32 v23, v51, 3, v23
    v_add_u32 v23, s43, v23
    v_bfe_u32 v60, v65, 4, 6
    v_and_b32 v61, 15, v60
    v_lshrrev_b32 v62, 4, v60
    v_mov_b32 v64, 0x4444
    v_mov_b32 v77, 0xeeee
    v_cmp_lt_u32 vcc, 7, v61
    s_nop 1
    v_cndmask_b32 v64, v64, v77, vcc
    v_xor_b32 v66, 1024, v65
    v_xor_b32 v67, 2048, v65
    v_xor_b32 v68, 3072, v65
    v_and_b32 v69, 511, v65
    s_mul_i32 s96, s13, 36864
    s_add_u32 s96, s96, 16384
    v_lshlrev_b32 v70, 4, v60
    v_add_u32 v70, s96, v70
    v_lshrrev_b32 v79, 1, v69
    s_lshl_b32 s96, s13, 8
    s_add_u32 s96, s96, 14336
    s_lshl_b32 s33, s13, 10
    s_add_u32 s97, s33, 8192
    v_mov_b32 v77, s97
    v_mov_b32 v78, s96
    v_cmp_lt_u32 vcc, 31, v60
    s_nop 1
    v_cndmask_b32 v71, v77, v78, vcc
    v_add_u32 v71, v71, v79
    v_and_b32 v77, 7, v61
    v_lshrrev_b32 v78, 3, v61
    v_lshlrev_b32 v74, 4, v77
    v_lshl_add_u32 v73, v62, 7, v74
    v_lshl_add_u32 v73, v78, 3, v73
    s_lshl_b32 s96, s13, 9
    v_add_u32 v73, s96, v73
    v_lshrrev_b32 v74, 1, v74
    v_lshl_add_u32 v74, v78, 14, v74
    v_lshl_add_u32 v74, v62, 15, v74
    s_lshl_b32 s96, s13, 17
    v_add_u32 v74, s96, v74
    v_bfe_u32 v77, v61, 2, 1
    v_and_b32 v78, 3, v61
    s_cmp_lt_u32 s13, 2
    s_cselect_b64 vcc, -1, 0
    v_cndmask_b32 v77, 0, v77, vcc
    v_lshlrev_b32 v75, 7, v77
    v_lshl_add_u32 v75, v62, 4, v75
    v_lshl_add_u32 v75, v78, 2, v75
    v_lshlrev_b32 v58, 3, v77
    v_lshl_add_u32 v58, v78, 1, v58
    s_bfe_u32 s97, s12, 0x10001
    s_lshl_b32 s68, s97, 6
    s_lshl_b32 s97, s97, 2
    v_add_u32 v59, s97, v62
    s_bfe_u32 s96, s12, 0x10002
    s_and_b32 s40, s12, 1
    s_lshl_b32 s96, s96, 1
    s_add_u32 s96, s96, s40
    s_lshr_b32 s97, s12, 3
    s_lshl_b32 s98, s13, 2
    s_add_u32 s98, s98, s97
    s_lshl_b32 s98, s98, 2
    s_add_u32 s98, s98, s96
    s_lshl_b32 s98, s98, 8
    s_lshl_b32 s99, s13, 2
    s_add_u32 s99, s99, s96
    s_lshl_b32 s99, s99, 4
    s_lshl_b32 s41, s97, 1
    s_add_u32 s41, s41, s40
    s_lshl_b32 s41, s41, 7
    s_add_u32 s41, s41, 8192
    s_lshl_b32 s40, s40, 3
    s_add_u32 s40, s40, 512
    s_cmp_lt_u32 s13, 2
    s_cselect_b32 s96, 7, 4
    s_cselect_b32 s98, s98, s41
    s_cselect_b32 s99, s99, s40
    s_cselect_b32 s32, 1, 0
    s_add_u32 s68, s68, s98
    s_lshl_b32 s97, s97, s96
    s_add_u32 s99, s99, s97
    v_add_u32 v58, s99, v58
    s_and_b32 s97, s12, 4
    s_or_b32 s97, s97, s13
    s_cmp_eq_u32 s97, 2
    s_cselect_b32 s32, 2, s32
    s_mov_b32 s8, s48
    s_mov_b32 s9, s49
    s_mov_b32 s10, 9216
    v_mul_u32_u24 v77, 1152, v59
    v_lshl_add_u32 v77, v58, 1, v77
    buffer_load_dword v72, v77, s[8:11], 0 offen
    s_mov_b32 s10, 4718592
    s_waitcnt vmcnt(12) lgkmcnt(0)
    s_barrier
    s_mov_b64 s[8:9], s[56:57]
    s_add_u32 m0, s43, 147456
    s_add_u32 s41, s42, 0
    buffer_load_dwordx4 v19, s[8:11], s41 offen offset:0 nt lds
    s_add_u32 s41, s42, 35840
    buffer_load_dwordx4 v19, s[8:11], s41 offen offset:1024 nt lds
    s_add_u32 s41, s42, 71680
    buffer_load_dwordx4 v19, s[8:11], s41 offen offset:2048 nt lds
    s_add_u32 s41, s42, 107520
    buffer_load_dwordx4 v19, s[8:11], s41 offen offset:3072 nt lds
    v_mov_b32 v78, v21
    v_mov_b32 v79, v22
    v_add_u32 v77, 0, v79
    ds_read_b64_tr_b16 v[80:81], v77 offset:0
    ds_read_b64_tr_b16 v[82:83], v77 offset:256
    ds_read_b64_tr_b16 v[84:85], v77 offset:2048
    ds_read_b64_tr_b16 v[86:87], v77 offset:2304
    ds_read_b64_tr_b16 v[112:113], v77 offset:16
    ds_read_b64_tr_b16 v[114:115], v77 offset:272
    ds_read_b64_tr_b16 v[116:117], v77 offset:2064
    ds_read_b64_tr_b16 v[118:119], v77 offset:2320
    s_waitcnt vmcnt(12) lgkmcnt(0)
    s_barrier
    s_mov_b64 s[8:9], s[52:53]
    s_add_u32 m0, s43, 0
    s_add_u32 s41, s58, 0
    buffer_load_dwordx4 v17, s[8:11], s41 offen offset:0 nt lds
    s_add_u32 s41, s58, 31744
    buffer_load_dwordx4 v17, s[8:11], s41 offen offset:1024 nt lds
    s_add_u32 s41, s58, 129024
    buffer_load_dwordx4 v17, s[8:11], s41 offen offset:2048 nt lds
    s_add_u32 s41, s58, 160768
    buffer_load_dwordx4 v17, s[8:11], s41 offen offset:3072 nt lds
    v_add_u32 v77, 36864, v78
    ds_read_b64_tr_b16 v[88:89], v77 offset:0
    ds_read_b64_tr_b16 v[90:91], v77 offset:256
    ds_read_b64_tr_b16 v[92:93], v77 offset:2048
    ds_read_b64_tr_b16 v[94:95], v77 offset:2304
    ds_read_b64_tr_b16 v[120:121], v77 offset:16
    ds_read_b64_tr_b16 v[122:123], v77 offset:272
    ds_read_b64_tr_b16 v[124:125], v77 offset:2064
    ds_read_b64_tr_b16 v[126:127], v77 offset:2320
    s_waitcnt vmcnt(12) lgkmcnt(0)
    s_barrier
    s_add_u32 m0, s43, 36864
    s_add_u32 s41, s58, 16384
    buffer_load_dwordx4 v17, s[8:11], s41 offen offset:0 nt lds
    s_add_u32 s41, s58, 48128
    buffer_load_dwordx4 v17, s[8:11], s41 offen offset:1024 nt lds
    s_add_u32 s41, s58, 145408
    buffer_load_dwordx4 v17, s[8:11], s41 offen offset:2048 nt lds
    s_add_u32 s41, s58, 177152
    buffer_load_dwordx4 v17, s[8:11], s41 offen offset:3072 nt lds
    v_add_u32 v77, 73728, v78
    ds_read_b64_tr_b16 v[96:97], v77 offset:0
    ds_read_b64_tr_b16 v[98:99], v77 offset:256
    ds_read_b64_tr_b16 v[100:101], v77 offset:2048
    ds_read_b64_tr_b16 v[102:103], v77 offset:2304
    ds_read_b64_tr_b16 v[128:129], v77 offset:16
    ds_read_b64_tr_b16 v[130:131], v77 offset:272
    ds_read_b64_tr_b16 v[132:133], v77 offset:2064
    ds_read_b64_tr_b16 v[134:135], v77 offset:2320
    s_waitcnt vmcnt(12) lgkmcnt(0)
    s_barrier
    s_add_u32 m0, s43, 73728
    s_add_u32 s41, s58, 262144
    buffer_load_dwordx4 v17, s[8:11], s41 offen offset:0 nt lds
    s_add_u32 s41, s58, 293888
    buffer_load_dwordx4 v17, s[8:11], s41 offen offset:1024 nt lds
    s_add_u32 s41, s58, 391168
    buffer_load_dwordx4 v17, s[8:11], s41 offen offset:2048 nt lds
    s_add_u32 s41, s58, 422912
    buffer_load_dwordx4 v17, s[8:11], s41 offen offset:3072 nt lds
    v_add_u32 v77, 110592, v78
    ds_read_b64_tr_b16 v[104:105], v77 offset:0
    ds_read_b64_tr_b16 v[106:107], v77 offset:256
    ds_read_b64_tr_b16 v[108:109], v77 offset:2048
    ds_read_b64_tr_b16 v[110:111], v77 offset:2304
    ds_read_b64_tr_b16 v[136:137], v77 offset:16
    ds_read_b64_tr_b16 v[138:139], v77 offset:272
    ds_read_b64_tr_b16 v[140:141], v77 offset:2064
    ds_read_b64_tr_b16 v[142:143], v77 offset:2320
    s_waitcnt vmcnt(12) lgkmcnt(0)
    s_barrier
    s_add_u32 m0, s43, 110592
    s_add_u32 s41, s58, 278528
    buffer_load_dwordx4 v17, s[8:11], s41 offen offset:0 nt lds
    s_add_u32 s41, s58, 310272
    buffer_load_dwordx4 v17, s[8:11], s41 offen offset:1024 nt lds
    s_add_u32 s41, s58, 407552
    buffer_load_dwordx4 v17, s[8:11], s41 offen offset:2048 nt lds
    s_add_u32 s41, s58, 439296
    buffer_load_dwordx4 v17, s[8:11], s41 offen offset:3072 nt lds
    v_add_u32 v77, 147456, v23
    ds_read_b64_tr_b16 v[0:1], v77 offset:0
    ds_read_b64_tr_b16 v[2:3], v77 offset:64
    ds_read_b64_tr_b16 v[4:5], v77 offset:512
    ds_read_b64_tr_b16 v[6:7], v77 offset:576
    ds_read_b64_tr_b16 v[8:9], v77 offset:2048
    ds_read_b64_tr_b16 v[10:11], v77 offset:2112
    ds_read_b64_tr_b16 v[12:13], v77 offset:2560
    ds_read_b64_tr_b16 v[14:15], v77 offset:2624
    s_waitcnt vmcnt(12) lgkmcnt(0)
    s_barrier
    s_add_u32 m0, s43, 147456
    s_add_u32 s41, s58, 524288
    buffer_load_dwordx4 v17, s[8:11], s41 offen offset:0 nt lds
    s_add_u32 s41, s58, 556032
    buffer_load_dwordx4 v17, s[8:11], s41 offen offset:1024 nt lds
    s_add_u32 s41, s58, 653312
    buffer_load_dwordx4 v17, s[8:11], s41 offen offset:2048 nt lds
    s_add_u32 s41, s58, 685056
    buffer_load_dwordx4 v17, s[8:11], s41 offen offset:3072 nt lds
    s_cmp_eq_u32 s32, 0
    s_cbranch_scc1 cs_init_done
    v_mov_b32 v52, 1
    v_mov_b32 v53, 1
    v_mov_b32 v54, 1
    v_mov_b32 v55, 1
    v_mov_b32 v56, 0
    s_lshl_b32 s96, s12, 14
    s_add_u32 s96, s96, 68681728
    s_add_u32 s97, s96, 0
    buffer_store_dwordx4 v[52:55], v65, s[4:7], s97 offen sc1
    s_add_u32 s97, s96, 4096
    buffer_store_dwordx4 v[52:55], v65, s[4:7], s97 offen sc1
    s_add_u32 s97, s96, 8192
    buffer_store_dwordx4 v[52:55], v65, s[4:7], s97 offen sc1
    s_add_u32 s97, s96, 12288
    buffer_store_dwordx4 v[52:55], v65, s[4:7], s97 offen sc1
    s_add_u32 s96, s68, 67633152
    s_add_u32 s97, s96, 16384
    buffer_store_dword v56, v75, s[4:7], s96 offen offset:0 sc1
    buffer_store_dword v72, v75, s[4:7], s97 offen offset:0 sc1
    s_cmp_lg_u32 s32, 2
    s_cbranch_scc1 cs_init_done
    buffer_store_dword v56, v75, s[4:7], s96 offen offset:1024 sc1
    buffer_store_dword v72, v75, s[4:7], s97 offen offset:1024 sc1
    buffer_store_dword v56, v75, s[4:7], s96 offen offset:2048 sc1
    buffer_store_dword v72, v75, s[4:7], s97 offen offset:2048 sc1
    buffer_store_dword v56, v75, s[4:7], s96 offen offset:3072 sc1
    buffer_store_dword v72, v75, s[4:7], s97 offen offset:3072 sc1
cs_init_done:
    ds_write_b64 v70, v[0:1] offset:16384
    ds_write_b64 v70, v[2:3] offset:16392
    ds_write_b64 v70, v[4:5] offset:17408
    ds_write_b64 v70, v[6:7] offset:17416
    ds_write_b64 v70, v[8:9] offset:18432
    ds_write_b64 v70, v[10:11] offset:18440
    ds_write_b64 v70, v[12:13] offset:19456
    ds_write_b64 v70, v[14:15] offset:19464
    v_add_u32 v28, 0, v24
    v_add_u32 v29, 0, v25
    v_add_u32 v30, 0, v26
    v_add_u32 v31, 0, v27
    ds_read_b64_tr_b16 a[96:97], v28 offset:0
    ds_read_b64_tr_b16 a[104:105], v28 offset:8
    ds_read_b64_tr_b16 a[112:113], v29 offset:0
    ds_read_b64_tr_b16 a[120:121], v29 offset:8
    ds_read_b64_tr_b16 a[128:129], v30 offset:0
    ds_read_b64_tr_b16 a[136:137], v30 offset:8
    ds_read_b64_tr_b16 a[144:145], v31 offset:0
    ds_read_b64_tr_b16 v[32:33], v31 offset:8
    s_waitcnt vmcnt(12) lgkmcnt(0)
    s_barrier
    s_add_u32 m0, s43, 0
    s_add_u32 s41, s58, 540672
    buffer_load_dwordx4 v17, s[8:11], s41 offen offset:0 nt lds
    s_add_u32 s41, s58, 572416
    buffer_load_dwordx4 v17, s[8:11], s41 offen offset:1024 nt lds
    s_add_u32 s41, s58, 669696
    buffer_load_dwordx4 v17, s[8:11], s41 offen offset:2048 nt lds
    s_add_u32 s41, s58, 701440
    buffer_load_dwordx4 v17, s[8:11], s41 offen offset:3072 nt lds
    ds_write_b64 v70, v[32:33] offset:12288
    v_add_u32 v28, 36864, v24
    v_add_u32 v29, 36864, v25
    v_add_u32 v30, 36864, v26
    v_add_u32 v31, 36864, v27
    ds_read_b64_tr_b16 a[98:99], v28 offset:0
    ds_read_b64_tr_b16 a[106:107], v28 offset:8
    ds_read_b64_tr_b16 a[114:115], v29 offset:0
    ds_read_b64_tr_b16 a[122:123], v29 offset:8
    ds_read_b64_tr_b16 a[130:131], v30 offset:0
    ds_read_b64_tr_b16 a[138:139], v30 offset:8
    ds_read_b64_tr_b16 a[146:147], v31 offset:0
    ds_read_b64_tr_b16 v[0:1], v31 offset:8
    s_waitcnt vmcnt(12) lgkmcnt(0)
    s_barrier
    s_add_u32 m0, s43, 36864
    s_add_u32 s41, s58, 786432
    buffer_load_dwordx4 v17, s[8:11], s41 offen offset:0 nt lds
    s_add_u32 s41, s58, 818176
    buffer_load_dwordx4 v17, s[8:11], s41 offen offset:1024 nt lds
    s_add_u32 s41, s58, 915456
    buffer_load_dwordx4 v17, s[8:11], s41 offen offset:2048 nt lds
    s_add_u32 s41, s58, 947200
    buffer_load_dwordx4 v17, s[8:11], s41 offen offset:3072 nt lds
    ds_write_b64 v70, v[0:1] offset:12296
    v_add_u32 v28, 73728, v24
    v_add_u32 v29, 73728, v25
    v_add_u32 v30, 73728, v26
    v_add_u32 v31, 73728, v27
    ds_read_b64_tr_b16 a[100:101], v28 offset:0
    ds_read_b64_tr_b16 a[108:109], v28 offset:8
    ds_read_b64_tr_b16 a[116:117], v29 offset:0
    ds_read_b64_tr_b16 a[124:125], v29 offset:8
    ds_read_b64_tr_b16 a[132:133], v30 offset:0
    ds_read_b64_tr_b16 a[140:141], v30 offset:8
    ds_read_b64_tr_b16 a[148:149], v31 offset:0
    ds_read_b64_tr_b16 v[32:33], v31 offset:8
    s_waitcnt vmcnt(12) lgkmcnt(0)
    s_barrier
    s_add_u32 m0, s43, 73728
    s_add_u32 s41, s58, 802816
    buffer_load_dwordx4 v17, s[8:11], s41 offen offset:0 nt lds
    s_add_u32 s41, s58, 834560
    buffer_load_dwordx4 v17, s[8:11], s41 offen offset:1024 nt lds
    s_add_u32 s41, s58, 931840
    buffer_load_dwordx4 v17, s[8:11], s41 offen offset:2048 nt lds
    s_add_u32 s41, s58, 963584
    buffer_load_dwordx4 v17, s[8:11], s41 offen offset:3072 nt lds
    ds_write_b64 v70, v[32:33] offset:13312
    v_add_u32 v28, 110592, v24
    v_add_u32 v29, 110592, v25
    v_add_u32 v30, 110592, v26
    v_add_u32 v31, 110592, v27
    ds_read_b64_tr_b16 a[102:103], v28 offset:0
    ds_read_b64_tr_b16 a[110:111], v28 offset:8
    ds_read_b64_tr_b16 a[118:119], v29 offset:0
    ds_read_b64_tr_b16 a[126:127], v29 offset:8
    ds_read_b64_tr_b16 a[134:135], v30 offset:0
    ds_read_b64_tr_b16 a[142:143], v30 offset:8
    ds_read_b64_tr_b16 a[150:151], v31 offset:0
    ds_read_b64_tr_b16 v[0:1], v31 offset:8
    s_waitcnt vmcnt(12) lgkmcnt(0)
    s_barrier
    s_add_u32 m0, s43, 110592
    s_add_u32 s41, s59, 0
    buffer_load_dwordx4 v17, s[8:11], s41 offen offset:0 nt lds
    s_add_u32 s41, s59, 31744
    buffer_load_dwordx4 v17, s[8:11], s41 offen offset:1024 nt lds
    s_add_u32 s41, s59, 129024
    buffer_load_dwordx4 v17, s[8:11], s41 offen offset:2048 nt lds
    s_add_u32 s41, s59, 160768
    buffer_load_dwordx4 v17, s[8:11], s41 offen offset:3072 nt lds
    ds_write_b64 v70, v[0:1] offset:13320
    v_add_u32 v28, 147456, v24
    v_add_u32 v29, 147456, v25
    v_add_u32 v30, 147456, v26
    v_add_u32 v31, 147456, v27
    ds_read_b64_tr_b16 a[152:153], v28 offset:0
    ds_read_b64_tr_b16 a[160:161], v28 offset:8
    ds_read_b64_tr_b16 a[168:169], v29 offset:0
    ds_read_b64_tr_b16 a[176:177], v29 offset:8
    ds_read_b64_tr_b16 a[184:185], v30 offset:0
    ds_read_b64_tr_b16 a[192:193], v30 offset:8
    ds_read_b64_tr_b16 a[200:201], v31 offset:0
    ds_read_b64_tr_b16 a[208:209], v31 offset:8
    s_waitcnt vmcnt(12) lgkmcnt(0)
    s_barrier
    s_mov_b64 s[8:9], s[50:51]
    s_add_u32 m0, s43, 147456
    s_add_u32 s41, s58, 0
    buffer_load_dwordx4 v17, s[8:11], s41 offen offset:0 nt lds
    s_add_u32 s41, s58, 31744
    buffer_load_dwordx4 v17, s[8:11], s41 offen offset:1024 nt lds
    s_add_u32 s41, s58, 129024
    buffer_load_dwordx4 v17, s[8:11], s41 offen offset:2048 nt lds
    s_add_u32 s41, s58, 160768
    buffer_load_dwordx4 v17, s[8:11], s41 offen offset:3072 nt lds
    v_add_u32 v28, 0, v24
    v_add_u32 v29, 0, v25
    v_add_u32 v30, 0, v26
    v_add_u32 v31, 0, v27
    ds_read_b64_tr_b16 a[154:155], v28 offset:0
    ds_read_b64_tr_b16 a[162:163], v28 offset:8
    ds_read_b64_tr_b16 a[170:171], v29 offset:0
    ds_read_b64_tr_b16 a[178:179], v29 offset:8
    ds_read_b64_tr_b16 a[186:187], v30 offset:0
    ds_read_b64_tr_b16 a[194:195], v30 offset:8
    ds_read_b64_tr_b16 a[202:203], v31 offset:0
    ds_read_b64_tr_b16 a[210:211], v31 offset:8
    s_waitcnt vmcnt(12) lgkmcnt(0)
    s_barrier
    s_add_u32 m0, s43, 0
    s_add_u32 s41, s58, 16384
    buffer_load_dwordx4 v17, s[8:11], s41 offen offset:0 nt lds
    s_add_u32 s41, s58, 48128
    buffer_load_dwordx4 v17, s[8:11], s41 offen offset:1024 nt lds
    s_add_u32 s41, s58, 145408
    buffer_load_dwordx4 v17, s[8:11], s41 offen offset:2048 nt lds
    s_add_u32 s41, s58, 177152
    buffer_load_dwordx4 v17, s[8:11], s41 offen offset:3072 nt lds
    v_add_u32 v28, 36864, v24
    v_add_u32 v29, 36864, v25
    v_add_u32 v30, 36864, v26
    v_add_u32 v31, 36864, v27
    ds_read_b64_tr_b16 a[156:157], v28 offset:0
    ds_read_b64_tr_b16 a[164:165], v28 offset:8
    ds_read_b64_tr_b16 a[172:173], v29 offset:0
    ds_read_b64_tr_b16 a[180:181], v29 offset:8
    ds_read_b64_tr_b16 a[188:189], v30 offset:0
    ds_read_b64_tr_b16 a[196:197], v30 offset:8
    ds_read_b64_tr_b16 a[204:205], v31 offset:0
    ds_read_b64_tr_b16 a[212:213], v31 offset:8
    s_waitcnt vmcnt(12) lgkmcnt(0)
    s_barrier
    s_add_u32 m0, s43, 36864
    s_add_u32 s41, s58, 262144
    buffer_load_dwordx4 v17, s[8:11], s41 offen offset:0 nt lds
    s_add_u32 s41, s58, 293888
    buffer_load_dwordx4 v17, s[8:11], s41 offen offset:1024 nt lds
    s_add_u32 s41, s58, 391168
    buffer_load_dwordx4 v17, s[8:11], s41 offen offset:2048 nt lds
    s_add_u32 s41, s58, 422912
    buffer_load_dwordx4 v17, s[8:11], s41 offen offset:3072 nt lds
    v_add_u32 v28, 73728, v24
    v_add_u32 v29, 73728, v25
    v_add_u32 v30, 73728, v26
    v_add_u32 v31, 73728, v27
    ds_read_b64_tr_b16 a[158:159], v28 offset:0
    ds_read_b64_tr_b16 a[166:167], v28 offset:8
    ds_read_b64_tr_b16 a[174:175], v29 offset:0
    ds_read_b64_tr_b16 a[182:183], v29 offset:8
    ds_read_b64_tr_b16 a[190:191], v30 offset:0
    ds_read_b64_tr_b16 a[198:199], v30 offset:8
    ds_read_b64_tr_b16 a[206:207], v31 offset:0
    ds_read_b64_tr_b16 a[214:215], v31 offset:8
    s_waitcnt vmcnt(12) lgkmcnt(0)
    s_barrier
    s_add_u32 m0, s43, 73728
    s_add_u32 s41, s58, 278528
    buffer_load_dwordx4 v17, s[8:11], s41 offen offset:0 nt lds
    s_add_u32 s41, s58, 310272
    buffer_load_dwordx4 v17, s[8:11], s41 offen offset:1024 nt lds
    s_add_u32 s41, s58, 407552
    buffer_load_dwordx4 v17, s[8:11], s41 offen offset:2048 nt lds
    s_add_u32 s41, s58, 439296
    buffer_load_dwordx4 v17, s[8:11], s41 offen offset:3072 nt lds
    v_add_u32 v77, 110592, v20
    ds_read_b64_tr_b16 a[216:217], v77 offset:0
    ds_read_b64_tr_b16 a[218:219], v77 offset:4096
    ds_read_b64_tr_b16 a[220:221], v77 offset:8192
    ds_read_b64_tr_b16 a[222:223], v77 offset:12288
    ds_read_b64_tr_b16 a[224:225], v77 offset:8
    ds_read_b64_tr_b16 a[226:227], v77 offset:4104
    ds_read_b64_tr_b16 a[228:229], v77 offset:8200
    ds_read_b64_tr_b16 a[230:231], v77 offset:12296
    s_waitcnt vmcnt(12) lgkmcnt(0)
    s_barrier
    s_add_u32 m0, s43, 110592
    s_add_u32 s41, s58, 524288
    buffer_load_dwordx4 v17, s[8:11], s41 offen offset:0 nt lds
    s_add_u32 s41, s58, 556032
    buffer_load_dwordx4 v17, s[8:11], s41 offen offset:1024 nt lds
    s_add_u32 s41, s58, 653312
    buffer_load_dwordx4 v17, s[8:11], s41 offen offset:2048 nt lds
    s_add_u32 s41, s58, 685056
    buffer_load_dwordx4 v17, s[8:11], s41 offen offset:3072 nt lds
    v_add_u32 v28, 147456, v24
    v_add_u32 v29, 147456, v25
    v_add_u32 v30, 147456, v26
    v_add_u32 v31, 147456, v27
    ds_read_b64_tr_b16 v[0:1], v28 offset:0
    ds_read_b64_tr_b16 v[2:3], v28 offset:8
    ds_read_b64_tr_b16 v[4:5], v29 offset:0
    ds_read_b64_tr_b16 v[6:7], v29 offset:8
    ds_read_b64_tr_b16 a[0:1], v30 offset:0
    ds_read_b64_tr_b16 v[8:9], v30 offset:8
    ds_read_b64_tr_b16 a[8:9], v31 offset:0
    ds_read_b64_tr_b16 v[10:11], v31 offset:8
    s_waitcnt vmcnt(12) lgkmcnt(0)
    s_barrier
    s_add_u32 m0, s43, 147456
    s_add_u32 s41, s58, 540672
    buffer_load_dwordx4 v17, s[8:11], s41 offen offset:0 nt lds
    s_add_u32 s41, s58, 572416
    buffer_load_dwordx4 v17, s[8:11], s41 offen offset:1024 nt lds
    s_add_u32 s41, s58, 669696
    buffer_load_dwordx4 v17, s[8:11], s41 offen offset:2048 nt lds
    s_add_u32 s41, s58, 701440
    buffer_load_dwordx4 v17, s[8:11], s41 offen offset:3072 nt lds
    ds_write_b64 v70, v[0:1] offset:0
    ds_write_b64 v70, v[2:3] offset:2048
    ds_write_b64 v70, v[4:5] offset:4096
    ds_write_b64 v70, v[6:7] offset:6144
    ds_write_b64 v70, v[8:9] offset:10240
    ds_write_b64 v70, v[10:11] offset:14336
    v_add_u32 v28, 0, v24
    v_add_u32 v29, 0, v25
    v_add_u32 v30, 0, v26
    v_add_u32 v31, 0, v27
    ds_read_b64_tr_b16 v[32:33], v28 offset:0
    ds_read_b64_tr_b16 v[34:35], v28 offset:8
    ds_read_b64_tr_b16 v[36:37], v29 offset:0
    ds_read_b64_tr_b16 v[38:39], v29 offset:8
    ds_read_b64_tr_b16 a[2:3], v30 offset:0
    ds_read_b64_tr_b16 v[40:41], v30 offset:8
    ds_read_b64_tr_b16 a[10:11], v31 offset:0
    ds_read_b64_tr_b16 v[42:43], v31 offset:8
    s_waitcnt vmcnt(12) lgkmcnt(0)
    s_barrier
    s_add_u32 m0, s43, 0
    s_add_u32 s41, s58, 786432
    buffer_load_dwordx4 v17, s[8:11], s41 offen offset:0 nt lds
    s_add_u32 s41, s58, 818176
    buffer_load_dwordx4 v17, s[8:11], s41 offen offset:1024 nt lds
    s_add_u32 s41, s58, 915456
    buffer_load_dwordx4 v17, s[8:11], s41 offen offset:2048 nt lds
    s_add_u32 s41, s58, 947200
    buffer_load_dwordx4 v17, s[8:11], s41 offen offset:3072 nt lds
    ds_write_b64 v70, v[32:33] offset:8
    ds_write_b64 v70, v[34:35] offset:2056
    ds_write_b64 v70, v[36:37] offset:4104
    ds_write_b64 v70, v[38:39] offset:6152
    ds_write_b64 v70, v[40:41] offset:10248
    ds_write_b64 v70, v[42:43] offset:14344
    v_add_u32 v28, 36864, v24
    v_add_u32 v29, 36864, v25
    v_add_u32 v30, 36864, v26
    v_add_u32 v31, 36864, v27
    ds_read_b64_tr_b16 v[0:1], v28 offset:0
    ds_read_b64_tr_b16 v[2:3], v28 offset:8
    ds_read_b64_tr_b16 v[4:5], v29 offset:0
    ds_read_b64_tr_b16 v[6:7], v29 offset:8
    ds_read_b64_tr_b16 a[4:5], v30 offset:0
    ds_read_b64_tr_b16 v[8:9], v30 offset:8
    ds_read_b64_tr_b16 a[12:13], v31 offset:0
    ds_read_b64_tr_b16 v[10:11], v31 offset:8
    s_waitcnt vmcnt(12) lgkmcnt(0)
    s_barrier
    s_add_u32 m0, s43, 36864
    s_add_u32 s41, s58, 802816
    buffer_load_dwordx4 v17, s[8:11], s41 offen offset:0 nt lds
    s_add_u32 s41, s58, 834560
    buffer_load_dwordx4 v17, s[8:11], s41 offen offset:1024 nt lds
    s_add_u32 s41, s58, 931840
    buffer_load_dwordx4 v17, s[8:11], s41 offen offset:2048 nt lds
    s_add_u32 s41, s58, 963584
    buffer_load_dwordx4 v17, s[8:11], s41 offen offset:3072 nt lds
    ds_write_b64 v70, v[0:1] offset:1024
    ds_write_b64 v70, v[2:3] offset:3072
    ds_write_b64 v70, v[4:5] offset:5120
    ds_write_b64 v70, v[6:7] offset:7168
    ds_write_b64 v70, v[8:9] offset:11264
    ds_write_b64 v70, v[10:11] offset:15360
    v_add_u32 v28, 73728, v24
    v_add_u32 v29, 73728, v25
    v_add_u32 v30, 73728, v26
    v_add_u32 v31, 73728, v27
    ds_read_b64_tr_b16 v[32:33], v28 offset:0
    ds_read_b64_tr_b16 v[34:35], v28 offset:8
    ds_read_b64_tr_b16 v[36:37], v29 offset:0
    ds_read_b64_tr_b16 v[38:39], v29 offset:8
    ds_read_b64_tr_b16 a[6:7], v30 offset:0
    ds_read_b64_tr_b16 v[40:41], v30 offset:8
    ds_read_b64_tr_b16 a[14:15], v31 offset:0
    ds_read_b64_tr_b16 v[42:43], v31 offset:8
    s_waitcnt vmcnt(12) lgkmcnt(0)
    s_barrier
    s_add_u32 m0, s43, 73728
    s_add_u32 s41, s59, 0
    buffer_load_dwordx4 v17, s[8:11], s41 offen offset:0 nt lds
    s_add_u32 s41, s59, 31744
    buffer_load_dwordx4 v17, s[8:11], s41 offen offset:1024 nt lds
    s_add_u32 s41, s59, 129024
    buffer_load_dwordx4 v17, s[8:11], s41 offen offset:2048 nt lds
    s_add_u32 s41, s59, 160768
    buffer_load_dwordx4 v17, s[8:11], s41 offen offset:3072 nt lds
    ds_write_b64 v70, v[32:33] offset:1032
    ds_write_b64 v70, v[34:35] offset:3080
    ds_write_b64 v70, v[36:37] offset:5128
    ds_write_b64 v70, v[38:39] offset:7176
    ds_write_b64 v70, v[40:41] offset:11272
    ds_write_b64 v70, v[42:43] offset:15368
    v_add_u32 v28, 110592, v24
    v_add_u32 v29, 110592, v25
    v_add_u32 v30, 110592, v26
    v_add_u32 v31, 110592, v27
    ds_read_b64_tr_b16 a[16:17], v28 offset:0
    ds_read_b64_tr_b16 a[24:25], v28 offset:8
    ds_read_b64_tr_b16 a[32:33], v29 offset:0
    ds_read_b64_tr_b16 a[40:41], v29 offset:8
    ds_read_b64_tr_b16 a[48:49], v30 offset:0
    ds_read_b64_tr_b16 a[56:57], v30 offset:8
    ds_read_b64_tr_b16 a[64:65], v31 offset:0
    ds_read_b64_tr_b16 a[72:73], v31 offset:8
    s_waitcnt vmcnt(12) lgkmcnt(0)
    s_barrier
    s_mov_b64 s[8:9], s[54:55]
    s_add_u32 m0, s43, 110592
    s_add_u32 s41, s58, 0
    buffer_load_dwordx4 v17, s[8:11], s41 offen offset:0 nt lds
    s_add_u32 s41, s58, 31744
    buffer_load_dwordx4 v17, s[8:11], s41 offen offset:1024 nt lds
    s_add_u32 s41, s58, 129024
    buffer_load_dwordx4 v17, s[8:11], s41 offen offset:2048 nt lds
    s_add_u32 s41, s58, 160768
    buffer_load_dwordx4 v17, s[8:11], s41 offen offset:3072 nt lds
    v_add_u32 v28, 147456, v24
    v_add_u32 v29, 147456, v25
    v_add_u32 v30, 147456, v26
    v_add_u32 v31, 147456, v27
    ds_read_b64_tr_b16 a[18:19], v28 offset:0
    ds_read_b64_tr_b16 a[26:27], v28 offset:8
    ds_read_b64_tr_b16 a[34:35], v29 offset:0
    ds_read_b64_tr_b16 a[42:43], v29 offset:8
    ds_read_b64_tr_b16 a[50:51], v30 offset:0
    ds_read_b64_tr_b16 a[58:59], v30 offset:8
    ds_read_b64_tr_b16 a[66:67], v31 offset:0
    ds_read_b64_tr_b16 a[74:75], v31 offset:8
    s_waitcnt vmcnt(12) lgkmcnt(0)
    s_barrier
    s_add_u32 m0, s43, 147456
    s_add_u32 s41, s58, 16384
    buffer_load_dwordx4 v17, s[8:11], s41 offen offset:0 nt lds
    s_add_u32 s41, s58, 48128
    buffer_load_dwordx4 v17, s[8:11], s41 offen offset:1024 nt lds
    s_add_u32 s41, s58, 145408
    buffer_load_dwordx4 v17, s[8:11], s41 offen offset:2048 nt lds
    s_add_u32 s41, s58, 177152
    buffer_load_dwordx4 v17, s[8:11], s41 offen offset:3072 nt lds
    v_add_u32 v28, 0, v24
    v_add_u32 v29, 0, v25
    v_add_u32 v30, 0, v26
    v_add_u32 v31, 0, v27
    ds_read_b64_tr_b16 a[20:21], v28 offset:0
    ds_read_b64_tr_b16 a[28:29], v28 offset:8
    ds_read_b64_tr_b16 a[36:37], v29 offset:0
    ds_read_b64_tr_b16 a[44:45], v29 offset:8
    ds_read_b64_tr_b16 a[52:53], v30 offset:0
    ds_read_b64_tr_b16 a[60:61], v30 offset:8
    ds_read_b64_tr_b16 a[68:69], v31 offset:0
    ds_read_b64_tr_b16 a[76:77], v31 offset:8
    s_waitcnt vmcnt(12) lgkmcnt(0)
    s_barrier
    s_add_u32 m0, s43, 0
    s_add_u32 s41, s58, 262144
    buffer_load_dwordx4 v17, s[8:11], s41 offen offset:0 nt lds
    s_add_u32 s41, s58, 293888
    buffer_load_dwordx4 v17, s[8:11], s41 offen offset:1024 nt lds
    s_add_u32 s41, s58, 391168
    buffer_load_dwordx4 v17, s[8:11], s41 offen offset:2048 nt lds
    s_add_u32 s41, s58, 422912
    buffer_load_dwordx4 v17, s[8:11], s41 offen offset:3072 nt lds
    v_add_u32 v28, 36864, v24
    v_add_u32 v29, 36864, v25
    v_add_u32 v30, 36864, v26
    v_add_u32 v31, 36864, v27
    ds_read_b64_tr_b16 a[22:23], v28 offset:0
    ds_read_b64_tr_b16 a[30:31], v28 offset:8
    ds_read_b64_tr_b16 a[38:39], v29 offset:0
    ds_read_b64_tr_b16 a[46:47], v29 offset:8
    ds_read_b64_tr_b16 a[54:55], v30 offset:0
    ds_read_b64_tr_b16 a[62:63], v30 offset:8
    ds_read_b64_tr_b16 a[70:71], v31 offset:0
    ds_read_b64_tr_b16 a[78:79], v31 offset:8
    s_waitcnt vmcnt(12) lgkmcnt(0)
    s_barrier
    s_add_u32 m0, s43, 36864
    s_add_u32 s41, s58, 278528
    buffer_load_dwordx4 v17, s[8:11], s41 offen offset:0 nt lds
    s_add_u32 s41, s58, 310272
    buffer_load_dwordx4 v17, s[8:11], s41 offen offset:1024 nt lds
    s_add_u32 s41, s58, 407552
    buffer_load_dwordx4 v17, s[8:11], s41 offen offset:2048 nt lds
    s_add_u32 s41, s58, 439296
    buffer_load_dwordx4 v17, s[8:11], s41 offen offset:3072 nt lds
    v_add_u32 v77, 73728, v20
    ds_read_b64_tr_b16 a[80:81], v77 offset:0
    ds_read_b64_tr_b16 a[82:83], v77 offset:4096
    ds_read_b64_tr_b16 a[84:85], v77 offset:8192
    ds_read_b64_tr_b16 a[86:87], v77 offset:12288
    ds_read_b64_tr_b16 a[88:89], v77 offset:8
    ds_read_b64_tr_b16 a[90:91], v77 offset:4104
    ds_read_b64_tr_b16 a[92:93], v77 offset:8200
    ds_read_b64_tr_b16 a[94:95], v77 offset:12296
    s_waitcnt vmcnt(12) lgkmcnt(0)
    s_barrier
    s_add_u32 m0, s43, 73728
    s_add_u32 s41, s58, 524288
    buffer_load_dwordx4 v17, s[8:11], s41 offen offset:0 nt lds
    s_add_u32 s41, s58, 556032
    buffer_load_dwordx4 v17, s[8:11], s41 offen offset:1024 nt lds
    s_add_u32 s41, s58, 653312
    buffer_load_dwordx4 v17, s[8:11], s41 offen offset:2048 nt lds
    s_add_u32 s41, s58, 685056
    buffer_load_dwordx4 v17, s[8:11], s41 offen offset:3072 nt lds
    v_add_u32 v28, 110592, v24
    v_add_u32 v29, 110592, v25
    v_add_u32 v30, 110592, v26
    v_add_u32 v31, 110592, v27
    ds_read_b64_tr_b16 a[232:233], v28 offset:0
    ds_read_b64_tr_b16 v[32:33], v28 offset:8
    ds_read_b64_tr_b16 a[240:241], v29 offset:0
    ds_read_b64_tr_b16 a[248:249], v29 offset:8
    ds_read_b64_tr_b16 v[144:145], v30 offset:0
    ds_read_b64_tr_b16 v[152:153], v30 offset:8
    ds_read_b64_tr_b16 v[160:161], v31 offset:0
    ds_read_b64_tr_b16 v[168:169], v31 offset:8
    s_waitcnt vmcnt(12) lgkmcnt(0)
    s_barrier
    s_add_u32 m0, s43, 110592
    s_add_u32 s41, s58, 540672
    buffer_load_dwordx4 v17, s[8:11], s41 offen offset:0 nt lds
    s_add_u32 s41, s58, 572416
    buffer_load_dwordx4 v17, s[8:11], s41 offen offset:1024 nt lds
    s_add_u32 s41, s58, 669696
    buffer_load_dwordx4 v17, s[8:11], s41 offen offset:2048 nt lds
    s_add_u32 s41, s58, 701440
    buffer_load_dwordx4 v17, s[8:11], s41 offen offset:3072 nt lds
    ds_write_b64 v70, v[32:33] offset:8192
    v_add_u32 v28, 147456, v24
    v_add_u32 v29, 147456, v25
    v_add_u32 v30, 147456, v26
    v_add_u32 v31, 147456, v27
    ds_read_b64_tr_b16 a[234:235], v28 offset:0
    ds_read_b64_tr_b16 v[0:1], v28 offset:8
    ds_read_b64_tr_b16 a[242:243], v29 offset:0
    ds_read_b64_tr_b16 a[250:251], v29 offset:8
    ds_read_b64_tr_b16 v[146:147], v30 offset:0
    ds_read_b64_tr_b16 v[154:155], v30 offset:8
    ds_read_b64_tr_b16 v[162:163], v31 offset:0
    ds_read_b64_tr_b16 v[170:171], v31 offset:8
    s_waitcnt vmcnt(12) lgkmcnt(0)
    s_barrier
    s_add_u32 m0, s43, 147456
    s_add_u32 s41, s58, 786432
    buffer_load_dwordx4 v17, s[8:11], s41 offen offset:0 nt lds
    s_add_u32 s41, s58, 818176
    buffer_load_dwordx4 v17, s[8:11], s41 offen offset:1024 nt lds
    s_add_u32 s41, s58, 915456
    buffer_load_dwordx4 v17, s[8:11], s41 offen offset:2048 nt lds
    s_add_u32 s41, s58, 947200
    buffer_load_dwordx4 v17, s[8:11], s41 offen offset:3072 nt lds
    ds_write_b64 v70, v[0:1] offset:8200
    v_add_u32 v28, 0, v24
    v_add_u32 v29, 0, v25
    v_add_u32 v30, 0, v26
    v_add_u32 v31, 0, v27
    ds_read_b64_tr_b16 a[236:237], v28 offset:0
    ds_read_b64_tr_b16 v[32:33], v28 offset:8
    ds_read_b64_tr_b16 a[244:245], v29 offset:0
    ds_read_b64_tr_b16 a[252:253], v29 offset:8
    ds_read_b64_tr_b16 v[148:149], v30 offset:0
    ds_read_b64_tr_b16 v[156:157], v30 offset:8
    ds_read_b64_tr_b16 v[164:165], v31 offset:0
    ds_read_b64_tr_b16 v[172:173], v31 offset:8
    s_waitcnt vmcnt(12) lgkmcnt(0)
    s_barrier
    s_add_u32 m0, s43, 0
    s_add_u32 s41, s58, 802816
    buffer_load_dwordx4 v17, s[8:11], s41 offen offset:0 nt lds
    s_add_u32 s41, s58, 834560
    buffer_load_dwordx4 v17, s[8:11], s41 offen offset:1024 nt lds
    s_add_u32 s41, s58, 931840
    buffer_load_dwordx4 v17, s[8:11], s41 offen offset:2048 nt lds
    s_add_u32 s41, s58, 963584
    buffer_load_dwordx4 v17, s[8:11], s41 offen offset:3072 nt lds
    ds_write_b64 v70, v[32:33] offset:9216
    v_add_u32 v28, 36864, v24
    v_add_u32 v29, 36864, v25
    v_add_u32 v30, 36864, v26
    v_add_u32 v31, 36864, v27
    ds_read_b64_tr_b16 a[238:239], v28 offset:0
    ds_read_b64_tr_b16 v[0:1], v28 offset:8
    ds_read_b64_tr_b16 a[246:247], v29 offset:0
    ds_read_b64_tr_b16 a[254:255], v29 offset:8
    ds_read_b64_tr_b16 v[150:151], v30 offset:0
    ds_read_b64_tr_b16 v[158:159], v30 offset:8
    ds_read_b64_tr_b16 v[166:167], v31 offset:0
    ds_read_b64_tr_b16 v[174:175], v31 offset:8
    s_waitcnt vmcnt(12) lgkmcnt(0)
    s_barrier
    s_add_u32 m0, s43, 36864
    s_add_u32 s41, s59, 0
    buffer_load_dwordx4 v17, s[8:11], s41 offen offset:0 nt lds
    s_add_u32 s41, s59, 31744
    buffer_load_dwordx4 v17, s[8:11], s41 offen offset:1024 nt lds
    s_add_u32 s41, s59, 129024
    buffer_load_dwordx4 v17, s[8:11], s41 offen offset:2048 nt lds
    s_add_u32 s41, s59, 160768
    buffer_load_dwordx4 v17, s[8:11], s41 offen offset:3072 nt lds
    ds_write_b64 v70, v[0:1] offset:9224
    v_add_u32 v28, 73728, v24
    v_add_u32 v29, 73728, v25
    v_add_u32 v30, 73728, v26
    v_add_u32 v31, 73728, v27
    ds_read_b64_tr_b16 v[176:177], v28 offset:0
    ds_read_b64_tr_b16 v[184:185], v28 offset:8
    ds_read_b64_tr_b16 v[192:193], v29 offset:0
    ds_read_b64_tr_b16 v[200:201], v29 offset:8
    ds_read_b64_tr_b16 v[208:209], v30 offset:0
    ds_read_b64_tr_b16 v[216:217], v30 offset:8
    ds_read_b64_tr_b16 v[224:225], v31 offset:0
    ds_read_b64_tr_b16 v[232:233], v31 offset:8
    s_waitcnt vmcnt(12) lgkmcnt(0)
    s_barrier
    s_mov_b64 s[8:9], s[56:57]
    s_add_u32 m0, s43, 73728
    s_add_u32 s41, s60, 128
    buffer_load_dwordx4 v18, s[8:11], s41 offen offset:0 nt lds
    s_add_u32 s41, s60, 8320
    buffer_load_dwordx4 v18, s[8:11], s41 offen offset:1024 nt lds
    s_add_u32 s41, s60, 16512
    buffer_load_dwordx4 v18, s[8:11], s41 offen offset:2048 nt lds
    s_add_u32 s41, s60, 24704
    buffer_load_dwordx4 v18, s[8:11], s41 offen offset:3072 nt lds
    v_add_u32 v28, 110592, v24
    v_add_u32 v29, 110592, v25
    v_add_u32 v30, 110592, v26
    v_add_u32 v31, 110592, v27
    ds_read_b64_tr_b16 v[178:179], v28 offset:0
    ds_read_b64_tr_b16 v[186:187], v28 offset:8
    ds_read_b64_tr_b16 v[194:195], v29 offset:0
    ds_read_b64_tr_b16 v[202:203], v29 offset:8
    ds_read_b64_tr_b16 v[210:211], v30 offset:0
    ds_read_b64_tr_b16 v[218:219], v30 offset:8
    ds_read_b64_tr_b16 v[226:227], v31 offset:0
    ds_read_b64_tr_b16 v[234:235], v31 offset:8
    s_waitcnt vmcnt(12) lgkmcnt(0)
    s_barrier
    s_add_u32 m0, s43, 110592
    s_add_u32 s41, s61, 128
    buffer_load_dwordx4 v18, s[8:11], s41 offen offset:0 nt lds
    s_add_u32 s41, s61, 8320
    buffer_load_dwordx4 v18, s[8:11], s41 offen offset:1024 nt lds
    s_add_u32 s41, s61, 16512
    buffer_load_dwordx4 v18, s[8:11], s41 offen offset:2048 nt lds
    s_add_u32 s41, s61, 24704
    buffer_load_dwordx4 v18, s[8:11], s41 offen offset:3072 nt lds
    v_add_u32 v28, 147456, v24
    v_add_u32 v29, 147456, v25
    v_add_u32 v30, 147456, v26
    v_add_u32 v31, 147456, v27
    ds_read_b64_tr_b16 v[180:181], v28 offset:0
    ds_read_b64_tr_b16 v[188:189], v28 offset:8
    ds_read_b64_tr_b16 v[196:197], v29 offset:0
    ds_read_b64_tr_b16 v[204:205], v29 offset:8
    ds_read_b64_tr_b16 v[212:213], v30 offset:0
    ds_read_b64_tr_b16 v[220:221], v30 offset:8
    ds_read_b64_tr_b16 v[228:229], v31 offset:0
    ds_read_b64_tr_b16 v[236:237], v31 offset:8
    s_waitcnt vmcnt(12) lgkmcnt(0)
    s_barrier
    s_add_u32 m0, s43, 147456
    s_add_u32 s41, s62, 128
    buffer_load_dwordx4 v18, s[8:11], s41 offen offset:0 nt lds
    s_add_u32 s41, s62, 8320
    buffer_load_dwordx4 v18, s[8:11], s41 offen offset:1024 nt lds
    s_add_u32 s41, s62, 16512
    buffer_load_dwordx4 v18, s[8:11], s41 offen offset:2048 nt lds
    s_add_u32 s41, s62, 24704
    buffer_load_dwordx4 v18, s[8:11], s41 offen offset:3072 nt lds
    v_add_u32 v28, 0, v24
    v_add_u32 v29, 0, v25
    v_add_u32 v30, 0, v26
    v_add_u32 v31, 0, v27
    ds_read_b64_tr_b16 v[182:183], v28 offset:0
    ds_read_b64_tr_b16 v[190:191], v28 offset:8
    ds_read_b64_tr_b16 v[198:199], v29 offset:0
    ds_read_b64_tr_b16 v[206:207], v29 offset:8
    ds_read_b64_tr_b16 v[214:215], v30 offset:0
    ds_read_b64_tr_b16 v[222:223], v30 offset:8
    ds_read_b64_tr_b16 v[230:231], v31 offset:0
    ds_read_b64_tr_b16 v[238:239], v31 offset:8
    s_waitcnt vmcnt(12) lgkmcnt(0)
    s_barrier
    s_add_u32 m0, s43, 0
    s_add_u32 s41, s63, 128
    buffer_load_dwordx4 v18, s[8:11], s41 offen offset:0 nt lds
    s_add_u32 s41, s63, 8320
    buffer_load_dwordx4 v18, s[8:11], s41 offen offset:1024 nt lds
    s_add_u32 s41, s63, 16512
    buffer_load_dwordx4 v18, s[8:11], s41 offen offset:2048 nt lds
    s_add_u32 s41, s63, 24704
    buffer_load_dwordx4 v18, s[8:11], s41 offen offset:3072 nt lds
    v_mov_b32 v78, v21
    v_mov_b32 v79, v22
    v_add_u32 v77, 36864, v20
    ds_read_b64_tr_b16 v[240:241], v77 offset:0
    ds_read_b64_tr_b16 v[242:243], v77 offset:4096
    ds_read_b64_tr_b16 v[244:245], v77 offset:8192
    ds_read_b64_tr_b16 v[246:247], v77 offset:12288
    ds_read_b64_tr_b16 v[248:249], v77 offset:8
    ds_read_b64_tr_b16 v[250:251], v77 offset:4104
    ds_read_b64_tr_b16 v[252:253], v77 offset:8200
    ds_read_b64_tr_b16 v[254:255], v77 offset:12296
    s_waitcnt vmcnt(12) lgkmcnt(0)
    s_barrier
    v_add_u32 v77, 73728, v79
    s_waitcnt lgkmcnt(0)
    ds_read_b64_tr_b16 v[0:1], v77 offset:0
    ds_read_b64_tr_b16 v[2:3], v77 offset:256
    ds_read_b64_tr_b16 v[4:5], v77 offset:2048
    ds_read_b64_tr_b16 v[6:7], v77 offset:2304
    ds_read_b64_tr_b16 v[8:9], v77 offset:16
    ds_read_b64_tr_b16 v[10:11], v77 offset:272
    ds_read_b64_tr_b16 v[12:13], v77 offset:2064
    ds_read_b64_tr_b16 v[14:15], v77 offset:2320
    s_waitcnt vmcnt(8) lgkmcnt(0)
    s_barrier
    v_add_u32 v77, 110592, v78
    ds_read_b64_tr_b16 v[16:17], v77 offset:0
    ds_read_b64_tr_b16 v[18:19], v77 offset:256
    ds_read_b64_tr_b16 v[20:21], v77 offset:2048
    ds_read_b64_tr_b16 v[22:23], v77 offset:2304
    ds_read_b64_tr_b16 v[24:25], v77 offset:16
    ds_read_b64_tr_b16 v[26:27], v77 offset:272
    ds_read_b64_tr_b16 v[28:29], v77 offset:2064
    ds_read_b64_tr_b16 v[30:31], v77 offset:2320
    s_waitcnt vmcnt(4) lgkmcnt(0)
    s_barrier
    v_add_u32 v77, 147456, v78
    ds_read_b64_tr_b16 v[32:33], v77 offset:0
    ds_read_b64_tr_b16 v[34:35], v77 offset:256
    ds_read_b64_tr_b16 v[36:37], v77 offset:2048
    ds_read_b64_tr_b16 v[38:39], v77 offset:2304
    ds_read_b64_tr_b16 v[40:41], v77 offset:16
    ds_read_b64_tr_b16 v[42:43], v77 offset:272
    ds_read_b64_tr_b16 v[44:45], v77 offset:2064
    ds_read_b64_tr_b16 v[46:47], v77 offset:2320
    s_waitcnt vmcnt(0) lgkmcnt(0)
    s_barrier
    v_add_u32 v77, 0, v78
    ds_read_b64_tr_b16 v[48:49], v77 offset:0
    ds_read_b64_tr_b16 v[50:51], v77 offset:256
    ds_read_b64_tr_b16 v[52:53], v77 offset:2048
    ds_read_b64_tr_b16 v[54:55], v77 offset:2304
    ds_read_b64_tr_b16 v[56:57], v77 offset:16
    ds_read_b64_tr_b16 v[58:59], v77 offset:272
    ds_read_b64_tr_b16 v[60:61], v77 offset:2064
    ds_read_b64_tr_b16 v[62:63], v77 offset:2320
    s_waitcnt lgkmcnt(0)
    s_barrier
    ds_write_b128 v70, v[0:3] offset:20480
    ds_write_b128 v70, v[4:7] offset:21504
    ds_write_b128 v70, v[8:11] offset:22528
    ds_write_b128 v70, v[12:15] offset:23552
    ds_write_b128 v70, v[16:19] offset:24576
    ds_write_b128 v70, v[20:23] offset:25600
    ds_write_b128 v70, v[24:27] offset:26624
    ds_write_b128 v70, v[28:31] offset:27648
    ds_write_b128 v70, v[32:35] offset:28672
    ds_write_b128 v70, v[36:39] offset:29696
    ds_write_b128 v70, v[40:43] offset:30720
    ds_write_b128 v70, v[44:47] offset:31744
    ds_write_b128 v70, v[48:51] offset:32768
    ds_write_b128 v70, v[52:55] offset:33792
    ds_write_b128 v70, v[56:59] offset:34816
    ds_write_b128 v70, v[60:63] offset:35840
    s_waitcnt lgkmcnt(0)
    v_bfe_u32 v60, v65, 4, 6
    v_and_b32 v61, 15, v60
    v_lshrrev_b32 v62, 4, v60
    v_mov_b32 v50, 0x3f80
    v_mov_b32 v51, 0x3f800000
    v_and_b32 v77, 1, v62
    v_lshlrev_b32 v77, 2, v77
    v_sub_u32 v77, v61, v77
    v_and_b32 v78, 3, v61
    v_lshlrev_b32 v78, 2, v78
    v_lshrrev_b32 v79, 2, v61
    v_add_u32 v78, v78, v79
    v_cmp_eq_u32 vcc, 0, v77
    s_nop 1
    v_cndmask_b32 v8, 0, v50, vcc
    v_cmp_eq_u32 vcc, 1, v77
    s_nop 1
    v_cndmask_b32 v8, v8, v51, vcc
    v_cmp_eq_u32 vcc, 0, v78
    s_nop 1
    v_cndmask_b32 v12, 0, v50, vcc
    v_cmp_eq_u32 vcc, 1, v78
    s_nop 1
    v_cndmask_b32 v12, v12, v51, vcc
    v_cmp_eq_u32 vcc, 2, v77
    s_nop 1
    v_cndmask_b32 v9, 0, v50, vcc
    v_cmp_eq_u32 vcc, 3, v77
    s_nop 1
    v_cndmask_b32 v9, v9, v51, vcc
    v_cmp_eq_u32 vcc, 2, v78
    s_nop 1
    v_cndmask_b32 v13, 0, v50, vcc
    v_cmp_eq_u32 vcc, 3, v78
    s_nop 1
    v_cndmask_b32 v13, v13, v51, vcc
    v_cmp_eq_u32 vcc, 8, v77
    s_nop 1
    v_cndmask_b32 v10, 0, v50, vcc
    v_cmp_eq_u32 vcc, 9, v77
    s_nop 1
    v_cndmask_b32 v10, v10, v51, vcc
    v_cmp_eq_u32 vcc, 4, v78
    s_nop 1
    v_cndmask_b32 v14, 0, v50, vcc
    v_cmp_eq_u32 vcc, 5, v78
    s_nop 1
    v_cndmask_b32 v14, v14, v51, vcc
    v_cmp_eq_u32 vcc, 10, v77
    s_nop 1
    v_cndmask_b32 v11, 0, v50, vcc
    v_cmp_eq_u32 vcc, 11, v77
    s_nop 1
    v_cndmask_b32 v11, v11, v51, vcc
    v_cmp_eq_u32 vcc, 6, v78
    s_nop 1
    v_cndmask_b32 v15, 0, v50, vcc
    v_cmp_eq_u32 vcc, 7, v78
    s_nop 1
    v_cndmask_b32 v15, v15, v51, vcc
    v_lshlrev_b32 v77, 4, v61
    ds_write_b128 v69, v[8:11] offset:15360
    ds_write_b128 v77, v[12:15] offset:15872
    s_waitcnt vmcnt(0) lgkmcnt(0)
    s_barrier
    v_mov_b32 v2, 1
    s_cmp_lg_u32 s13, 0
    s_cbranch_scc1 cs_noarr
    s_mov_b64 exec, 1
    buffer_atomic_add v2, off, s[84:87], 0 offset:212
    s_mov_b32 s40, 16777216
    s_mov_b32 s42, 2
cs_startpoll:
    buffer_load_dword v3, off, s[84:87], 0 offset:212 sc1
    s_sub_u32 s40, s40, 1
    s_cbranch_scc1 cs_decide
    s_waitcnt vmcnt(0)
    v_readfirstlane_b32 s41, v3
    s_nop 1
    s_cmp_lt_u32 s41, 32
    s_cbranch_scc1 cs_startpoll
    s_mov_b32 s42, 1
cs_decide:
    s_mov_b64 exec, -1
cs_noarr:
    s_barrier
    s_mov_b32 s44, 0x3e0293ee
    s_mov_b32 s45, s44
    s_or_b32 s66, s44, 0x80000000
    s_mov_b32 s48, 0x3f003f00
    s_mov_b32 s49, 0
    s_mov_b32 s50, 0x3f803f80
    s_mov_b32 s51, 0x3f803f80
    s_mov_b32 s52, 512
    s_mov_b32 s53, 1024
    s_mov_b32 s54, 1536
    s_mov_b32 s30, 0
    s_mov_b32 s37, 0
    s_lshl_b32 s47, s13, 9
    s_cmp_lg_u32 s32, 0
    s_cselect_b32 s71, s13, 3
    s_add_u32 s46, s71, 1
    s_lshr_b32 s46, s46, 1
    s_mov_b32 s14, 67649536
    s_mov_b32 s15, 67653632
    s_mov_b32 s16, 67657728
    s_mov_b32 s36, 0
    s_add_u32 s17, s68, 67633152
    s_mov_b32 s69, 0
    s_mov_b32 s70, 0
    s_lshl_b32 s26, s12, 14
    s_add_u32 s26, s26, 0
    s_mul_i32 s40, s13, 3072
    s_add_u32 s24, s26, s40
    s_lshl_b32 s96, s12, 7
    s_add_u32 s29, s96, 125845504
    s_add_u32 s96, s96, 125829120
    s_lshl_b32 s40, s12, 14
    s_add_u32 s40, s40, 68681728
    s_add_u32 s18, s40, 0
    s_add_u32 s19, s40, 4096
    s_add_u32 s20, s40, 8192
    s_add_u32 s21, s40, 12288
    s_lshr_b32 s40, s12, 3
    s_lshl_b32 s40, s40, 12
    s_and_b32 s41, s12, 7
    s_lshl_b32 s41, s41, 7
    s_add_u32 s40, s40, s41
    s_add_u32 s22, s40, 68681728
    s_add_u32 s23, s22, 1024
    s_add_u32 s25, s22, 2048
    s_mov_b32 s56, -65472
    s_cmp_lg_u32 s32, 0
    s_cselect_b64 s[38:39], -1, 0
    s_add_u32 s55, s68, 138412032
    s_cmp_eq_u32 s13, 3
    s_cselect_b64 s[100:101], 1, 0
    s_cselect_b64 s[38:39], 1, s[38:39]
    s_cselect_b32 s93, 64, 0
    s_cselect_b32 s55, s29, s55
    s_cselect_b32 s57, 0, 9216
    s_mov_b64 exec, s[100:101]
    v_mov_b32 v72, s95
    s_mov_b64 exec, -1
    s_mov_b32 s34, 0xff00ff00
    s_mov_b32 s35, 0xff00ff00
    s_lshl_b32 s28, s12, 12
    s_add_u32 s28, s28, 7340032
    s_add_u32 s27, s28, 77594624
    s_add_u32 s28, s28, 69206016
    s_mov_b32 s40, 3
    v_bfe_u32 v78, v65, 2, 5
    s_mov_b32 s31, 4194304
cs_kv0:
    buffer_load_dword v77, v78, s[4:7], s96 offen offset:16 sc1
    s_waitcnt vmcnt(0)
    v_subrev_u32 v77, s95, v77
    v_cmp_lt_u32 vcc, 16, v77
    s_nop 1
    v_cndmask_b32 v77, v77, 0, vcc
    v_bfe_u32 v79, v78, 2, 2
    v_lshl_add_u32 v77, v77, 2, v79
    s_nop 1
    v_min_u32_dpp v77, v77, v77 row_ror:1 row_mask:0xf bank_mask:0xf
    s_nop 1
    v_min_u32_dpp v77, v77, v77 row_ror:2 row_mask:0xf bank_mask:0xf
    s_nop 1
    v_min_u32_dpp v77, v77, v77 row_ror:4 row_mask:0xf bank_mask:0xf
    s_nop 0
    v_readfirstlane_b32 s97, v77
    s_sub_u32 s31, s31, 1
    s_cbranch_scc1 cs_kv0_x
    s_cmp_le_u32 s40, s97
    s_cbranch_scc1 cs_kv0_x
    s_sleep 2
    s_branch cs_kv0
cs_kv0_x:
    s_add_u32 s40, s24, 0
    s_add_u32 s40, s40, s33
    s_sub_u32 s41, s96, s40
    v_bfe_u32 v77, v65, 2, 5
    v_add3_u32 v77, v77, s41, 16
    v_lshlrev_b32 v78, 3, v69
    s_nop 0
    v_mov_b32_dpp v78, v77 quad_perm:[0,1,2,3] row_mask:0xc bank_mask:0xf
    buffer_load_dword v76, v78, s[4:7], s40 offen sc1
    s_add_u32 s40, s24, 524288
    s_add_u32 s40, s40, s33
    s_sub_u32 s41, s96, s40
    v_bfe_u32 v77, v65, 2, 5
    v_add3_u32 v77, v77, s41, 16
    v_lshlrev_b32 v78, 3, v69
    s_nop 0
    v_mov_b32_dpp v78, v77 quad_perm:[0,1,2,3] row_mask:0xc bank_mask:0xf
    buffer_load_dword v76, v78, s[4:7], s40 offen sc1
cs_kvdone:
    v_mov_b64 v[0:1], 0
    v_mov_b64 v[2:3], 0
    v_mov_b64 v[4:5], 0
    v_mov_b64 v[6:7], 0
    v_mov_b64 v[8:9], 0
    v_mov_b64 v[10:11], 0
    v_mov_b64 v[12:13], 0
    v_mov_b64 v[14:15], 0
    v_mov_b64 v[16:17], 0
    v_mov_b64 v[18:19], 0
    v_mov_b64 v[20:21], 0
    v_mov_b64 v[22:23], 0
    ds_read_b128 v[44:47], v70 offset:0
    ds_read_b128 v[48:51], v70 offset:1024
    ds_read_b128 v[52:55], v70 offset:2048
    ds_read_b128 v[56:59], v70 offset:3072
    ds_read_b128 v[24:27], v70 offset:4096
    ds_read_b128 v[28:31], v70 offset:5120
    ds_read_b128 v[32:35], v70 offset:6144
    ds_read_b128 v[36:39], v70 offset:7168
    buffer_load_dwordx4 v[40:43], v65, s[4:7], s14 offen offset:0 sc1
    buffer_load_dwordx4 v[60:63], v66, s[4:7], s14 offen offset:0 sc1
    s_mov_b32 s31, 1048576
    s_waitcnt vmcnt(0) lgkmcnt(0)
    s_branch cs_goA
cs_loop:
    s_mov_b32 s31, 1048576
    s_mov_b32 s69, s70
    s_waitcnt lgkmcnt(0)
cs_cA:
    buffer_load_dwordx4 v[40:43], v65, s[4:7], s14 offen offset:0 sc1
    buffer_load_dwordx4 v[60:63], v66, s[4:7], s14 offen offset:0 sc1
cs_cA1:
    v_bitop3_b32 v77, v40, v60, s70 bitop3:0x7e
    v_and_b32 v77, 1, v77
    v_cmp_ne_u32 vcc, 0, v77
    s_cbranch_vccz cs_goA
    s_nop 15
    s_nop 15
    s_nop 7
    v_bitop3_b32 v77, v40, v60, s70 bitop3:0x7e
    v_and_b32 v77, 1, v77
    v_cmp_ne_u32 vcc, 0, v77
    s_cbranch_vccz cs_goA
    s_nop 15
    s_nop 15
    s_nop 7
    v_bitop3_b32 v77, v40, v60, s70 bitop3:0x7e
    v_and_b32 v77, 1, v77
    v_cmp_ne_u32 vcc, 0, v77
    s_cbranch_vccz cs_goA
    s_nop 15
    s_nop 15
    s_nop 7
    v_bitop3_b32 v77, v40, v60, s70 bitop3:0x7e
    v_and_b32 v77, 1, v77
    v_cmp_ne_u32 vcc, 0, v77
    s_cbranch_vccz cs_goA
    s_nop 15
    s_nop 15
    s_nop 7
    buffer_load_dwordx4 v[40:43], v65, s[4:7], s14 offen offset:0 sc1
    buffer_load_dwordx4 v[60:63], v66, s[4:7], s14 offen offset:0 sc1
    v_bitop3_b32 v77, v40, v60, s70 bitop3:0x7e
    v_and_b32 v77, 1, v77
    v_cmp_ne_u32 vcc, 0, v77
    s_cbranch_vccz cs_goA
    s_nop 15
    s_nop 15
    s_nop 7
    v_bitop3_b32 v77, v40, v60, s70 bitop3:0x7e
    v_and_b32 v77, 1, v77
    v_cmp_ne_u32 vcc, 0, v77
    s_cbranch_vccz cs_goA
    s_nop 15
    s_nop 15
    s_nop 7
    v_bitop3_b32 v77, v40, v60, s70 bitop3:0x7e
    v_and_b32 v77, 1, v77
    v_cmp_ne_u32 vcc, 0, v77
    s_cbranch_vccz cs_goA
    s_nop 15
    s_nop 15
    s_nop 7
    v_bitop3_b32 v77, v40, v60, s70 bitop3:0x7e
    v_and_b32 v77, 1, v77
    v_cmp_ne_u32 vcc, 0, v77
    s_cbranch_vccz cs_goA
    s_nop 15
    s_nop 15
    s_nop 7
    buffer_load_dwordx4 v[40:43], v65, s[4:7], s14 offen offset:0 sc1
    buffer_load_dwordx4 v[60:63], v66, s[4:7], s14 offen offset:0 sc1
    v_bitop3_b32 v77, v40, v60, s70 bitop3:0x7e
    v_and_b32 v77, 1, v77
    v_cmp_ne_u32 vcc, 0, v77
    s_cbranch_vccz cs_goA
    s_nop 15
    s_nop 15
    s_nop 7
    v_bitop3_b32 v77, v40, v60, s70 bitop3:0x7e
    v_and_b32 v77, 1, v77
    v_cmp_ne_u32 vcc, 0, v77
    s_cbranch_vccz cs_goA
    s_nop 15
    s_nop 15
    s_nop 7
    v_bitop3_b32 v77, v40, v60, s70 bitop3:0x7e
    v_and_b32 v77, 1, v77
    v_cmp_ne_u32 vcc, 0, v77
    s_cbranch_vccz cs_goA
    s_nop 15
    s_nop 15
    s_nop 7
    v_bitop3_b32 v77, v40, v60, s70 bitop3:0x7e
    v_and_b32 v77, 1, v77
    v_cmp_ne_u32 vcc, 0, v77
    s_cbranch_vccz cs_goA
    s_nop 15
    s_nop 15
    s_nop 7
    buffer_load_dwordx4 v[40:43], v65, s[4:7], s14 offen offset:0 sc1
    buffer_load_dwordx4 v[60:63], v66, s[4:7], s14 offen offset:0 sc1
    v_bitop3_b32 v77, v40, v60, s70 bitop3:0x7e
    v_and_b32 v77, 1, v77
    v_cmp_ne_u32 vcc, 0, v77
    s_cbranch_vccz cs_goA
    s_nop 15
    s_nop 15
    s_nop 7
    v_bitop3_b32 v77, v40, v60, s70 bitop3:0x7e
    v_and_b32 v77, 1, v77
    v_cmp_ne_u32 vcc, 0, v77
    s_cbranch_vccz cs_goA
    s_nop 15
    s_nop 15
    s_nop 7
    v_bitop3_b32 v77, v40, v60, s70 bitop3:0x7e
    v_and_b32 v77, 1, v77
    v_cmp_ne_u32 vcc, 0, v77
    s_cbranch_vccz cs_goA
    s_nop 15
    s_nop 15
    s_nop 7
    v_bitop3_b32 v77, v40, v60, s70 bitop3:0x7e
    v_and_b32 v77, 1, v77
    v_cmp_ne_u32 vcc, 0, v77
    s_cbranch_vccz cs_goA
    s_nop 15
    s_nop 15
    s_nop 7
    s_sub_u32 s31, s31, 64
    s_cbranch_scc0 cs_cA
cs_goA:
    ds_write_b128 v65, v[40:43] offset:0
    v_smfmac_f32_16x16x64_bf16 v[0:3], v[40:43], v[44:51], v64
    v_smfmac_f32_16x16x64_bf16 v[4:7], v[40:43], v[52:59], v64
    buffer_load_dwordx4 v[44:47], v65, s[4:7], s15 offen offset:0 sc1
    v_smfmac_f32_16x16x64_bf16 v[0:3], v[60:63], v[24:31], v64
    s_add_u32 s40, s24, 1048576
    s_add_u32 s40, s40, s33
    s_sub_u32 s41, s96, s40
    v_smfmac_f32_16x16x64_bf16 v[4:7], v[60:63], v[32:39], v64
    ds_read_b128 v[24:27], v70 offset:8192
    s_cmp_lt_u32 s97, s93
    s_cselect_b32 s41, s41, 0
    v_smfmac_f32_16x16x64_bf16 v[8:11], v[40:43], a[96:103], v64
    ds_read_b128 v[28:31], v70 offset:9216
    v_smfmac_f32_16x16x64_bf16 v[12:15], v[40:43], a[104:111], v64
    ds_read_b128 v[32:35], v70 offset:10240
    s_waitcnt lgkmcnt(3)
    s_barrier
    ds_read_b128 v[48:51], v67 offset:0
    v_smfmac_f32_16x16x64_bf16 v[8:11], v[60:63], a[112:119], v64
    ds_read_b128 v[36:39], v70 offset:11264
    v_bitop3_b32 v79, v73, -9, s54 bitop3:0x6a
    v_smfmac_f32_16x16x64_bf16 v[12:15], v[60:63], a[120:127], v64
    buffer_load_dwordx4 v[44:47], v65, s[4:7], s15 offen offset:0 sc1
    v_smfmac_f32_16x16x64_bf16 v[16:19], v[40:43], a[232:239], v64
    ds_read_b128 v[52:55], v68 offset:0
    s_waitcnt lgkmcnt(4)
    v_bfe_u32 v77, v65, 2, 5
    v_smfmac_f32_16x16x64_bf16 v[20:23], v[40:43], v[24:31], v64
    ds_read_b128 v[24:27], v70 offset:12288
    s_waitcnt lgkmcnt(3)
    v_smfmac_f32_16x16x64_bf16 v[0:3], v[48:51], a[0:7], v64
    ds_read_b128 v[28:31], v70 offset:13312
    s_waitcnt lgkmcnt(3)
    v_add3_u32 v77, v77, s41, 16
    v_smfmac_f32_16x16x64_bf16 v[4:7], v[48:51], v[32:39], v64
    buffer_load_dwordx4 v[40:43], v65, s[4:7], s16 offen offset:0 sc1
    v_smfmac_f32_16x16x64_bf16 v[16:19], v[60:63], a[240:247], v64
    ds_read_b128 v[32:35], v70 offset:14336
    v_lshlrev_b32 v78, 3, v69
    v_smfmac_f32_16x16x64_bf16 v[20:23], v[60:63], a[248:255], v64
    ds_read_b128 v[36:39], v70 offset:15360
    v_smfmac_f32_16x16x64_bf16 v[8:11], v[48:51], a[128:135], v64
    s_waitcnt vmcnt(2)
    v_mov_b32_dpp v78, v77 quad_perm:[0,1,2,3] row_mask:0xc bank_mask:0xf
    v_smfmac_f32_16x16x64_bf16 v[12:15], v[48:51], a[136:143], v64
    buffer_load_dwordx4 v[58:61], v65, s[4:7], s24 offen offset:3072 sc1
    s_waitcnt lgkmcnt(2)
    v_and_b32 v77, s36, v44
    v_smfmac_f32_16x16x64_bf16 v[12:15], v[52:55], v[24:31], v64
    ds_write_b128 v65, v[44:47] offset:4096
    v_smfmac_f32_16x16x64_bf16 v[0:3], v[52:55], a[8:15], v64
    v_cmp_ne_u32 vcc, s70, v77
    v_smfmac_f32_16x16x64_bf16 v[8:11], v[52:55], a[144:151], v64
    buffer_load_dwordx4 v[24:27], v65, s[4:7], s24 offen offset:0 sc1
    s_waitcnt lgkmcnt(1)
    v_smfmac_f32_16x16x64_bf16 v[4:7], v[52:55], v[32:39], v64
    s_cbranch_vccnz cs_spinB
cs_backB:
    v_smfmac_f32_16x16x64_bf16 v[16:19], v[44:47], v[176:183], v64
    s_waitcnt lgkmcnt(0)
    s_barrier
    ds_read_b128 v[48:51], v66 offset:4096
    v_smfmac_f32_16x16x64_bf16 v[12:15], v[44:47], a[160:167], v64
    buffer_load_dwordx4 v[28:31], v65, s[4:7], s24 offen offset:1024 sc1
    v_smfmac_f32_16x16x64_bf16 v[0:3], v[44:47], a[16:23], v64
    ds_read_b128 v[52:55], v67 offset:4096
    v_smfmac_f32_16x16x64_bf16 v[8:11], v[44:47], a[152:159], v64
    v_smfmac_f32_16x16x64_bf16 v[4:7], v[44:47], a[24:31], v64
    buffer_load_dwordx4 v[34:37], v65, s[4:7], s24 offen offset:2048 sc1
    s_waitcnt vmcnt(5)
    v_smfmac_f32_16x16x64_bf16 v[20:23], v[44:47], v[184:191], v64
    ds_read_b128 v[44:47], v68 offset:4096
    s_waitcnt lgkmcnt(2)
    v_smfmac_f32_16x16x64_bf16 v[0:3], v[48:51], a[32:39], v64
    v_smfmac_f32_16x16x64_bf16 v[8:11], v[48:51], a[168:175], v64
    buffer_load_dword v76, v78, s[4:7], s40 offen sc1
    v_smfmac_f32_16x16x64_bf16 v[4:7], v[48:51], a[40:47], v64
    s_waitcnt vmcnt(5)
    v_and_b32 v77, s36, v40
    v_smfmac_f32_16x16x64_bf16 v[12:15], v[48:51], a[176:183], v64
    ds_read_b128 v[48:51], v69 offset:15360
    s_waitcnt lgkmcnt(1)
    v_cmp_ne_u32 vcc, s70, v77
    v_smfmac_f32_16x16x64_bf16 v[0:3], v[52:55], a[48:55], v64
    v_smfmac_f32_16x16x64_bf16 v[8:11], v[52:55], a[184:191], v64
    s_cbranch_vccnz cs_spin8
cs_back8:
    v_smfmac_f32_16x16x64_bf16 v[0:3], v[44:47], a[64:71], v64
    v_smfmac_f32_16x16x64_bf16 v[8:11], v[44:47], a[200:207], v64
    v_smfmac_f32_16x16x64_bf16 v[0:3], v[40:43], a[80:87], v64
    s_nop 1
    v_smfmac_f32_16x16x64_bf16 v[8:11], v[40:43], a[216:223], v64
    s_nop 1
    v_lshrrev_b32 v77, 1, v69
    v_smfmac_f32_16x16x64_bf16 v[4:7], v[52:55], a[56:63], v64
    s_nop 1
    v_cvt_pk_bf16_f32 v0, v0, v1
    v_smfmac_f32_16x16x64_bf16 v[12:15], v[52:55], a[192:199], v64
    s_nop 1
    v_cvt_pk_bf16_f32 v1, v2, v3
    v_smfmac_f32_16x16x64_bf16 v[4:7], v[44:47], a[72:79], v64
    s_nop 1
    v_cvt_pk_bf16_f32 v2, v8, v9
    v_smfmac_f32_16x16x64_bf16 v[12:15], v[44:47], a[208:215], v64
    s_nop 1
    v_cvt_pk_bf16_f32 v3, v10, v11
    v_smfmac_f32_16x16x64_bf16 v[4:7], v[40:43], a[88:95], v64
    s_waitcnt lgkmcnt(0)
    s_nop 0
    s_nop 0
    v_smfmac_f32_16x16x64_bf16 v[12:15], v[40:43], a[224:231], v64
    s_nop 2
    v_mfma_f32_16x16x32_bf16 v[8:11], v[0:3], v[48:51], 0
    s_nop 0
    v_cvt_pk_bf16_f32 v4, v4, v5
    v_cvt_pk_bf16_f32 v5, v6, v7
    s_nop 0
    v_cvt_pk_bf16_f32 v6, v12, v13
    v_cvt_pk_bf16_f32 v7, v14, v15
    s_nop 1
    v_mfma_f32_16x16x32_bf16 v[12:15], v[4:7], v[48:51], 0
    ds_read_b128 v[48:51], v66 offset:4096
    v_cvt_pk_bf16_f32 v0, v8, v9
    v_cvt_pk_bf16_f32 v1, v10, v11
    v_smfmac_f32_16x16x64_bf16 v[16:19], v[52:55], v[208:215], v64
    s_waitcnt vmcnt(2)
    s_nop 2
    v_cvt_pk_bf16_f32 v2, v12, v13
    v_cvt_pk_bf16_f32 v3, v14, v15
    s_nop 1
    v_mfma_f32_16x16x32_bf16 v[12:15], v[0:3], v[0:3], 0
    s_nop 1
    v_bitop3_b32 v78, v73, -9, s53 bitop3:0x6a
    v_mfma_f32_16x16x32_bf16 v[4:7], v[24:27], v[0:3], 0
    ds_read_b128 v[24:27], v67 offset:0
    s_nop 1
    v_mfma_f32_16x16x32_bf16 v[8:11], v[28:31], v[0:3], 0
    s_nop 0
    v_mov_b32_dpp v12, v14 row_ror:8 row_mask:0xf bank_mask:0xc
    v_mov_b32_dpp v13, v15 row_ror:8 row_mask:0xf bank_mask:0xc
    v_smfmac_f32_16x16x64_bf16 v[20:23], v[52:55], v[216:223], v64
    ds_write_b64 v71, v[12:13]
    ds_read_b128 v[52:55], v68 offset:0
    s_nop 1
    v_mov_b32_dpp v4, v8 row_ror:8 row_mask:0xf bank_mask:0xc
    v_mov_b32_dpp v5, v9 row_ror:8 row_mask:0xf bank_mask:0xc
    v_mov_b32_dpp v6, v10 row_ror:8 row_mask:0xf bank_mask:0xc
    v_mov_b32_dpp v7, v11 row_ror:8 row_mask:0xf bank_mask:0xc
    v_smfmac_f32_16x16x64_bf16 v[16:19], v[44:47], v[224:231], v64
    ds_write_b128 v65, v[4:7] offset:8192
    v_smfmac_f32_16x16x64_bf16 v[20:23], v[44:47], v[232:239], v64
    s_waitcnt lgkmcnt(3)
    v_smfmac_f32_16x16x64_bf16 v[16:19], v[24:27], v[144:151], v64
    s_waitcnt vmcnt(1)
    v_smfmac_f32_16x16x64_bf16 v[20:23], v[24:27], v[152:159], v64
    s_mov_b64 exec, s[38:39]
    buffer_store_dword v72, v75, s[4:7], s55 offen sc1
    s_mov_b64 exec, -1
    v_smfmac_f32_16x16x64_bf16 v[16:19], v[40:43], v[240:247], v64
    s_cmp_ge_u32 s30, 56
    s_waitcnt lgkmcnt(0)
    s_barrier
    ds_read_b128 v[8:11], v66 offset:8192
    v_smfmac_f32_16x16x64_bf16 v[20:23], v[40:43], v[248:255], v64
    ds_read_b128 v[12:15], v67 offset:8192
    v_smfmac_f32_16x16x64_bf16 v[16:19], v[48:51], v[192:199], v64
    ds_read_b128 v[44:47], v68 offset:8192
    v_smfmac_f32_16x16x64_bf16 v[20:23], v[48:51], v[200:207], v64
    ds_read_b64 v[24:25], v77 offset:14336
    ds_read_b64 v[26:27], v77 offset:14592
    v_smfmac_f32_16x16x64_bf16 v[16:19], v[52:55], v[160:167], v64
    ds_read_b64 v[28:29], v77 offset:14848
    ds_read_b64 v[30:31], v77 offset:15104
    v_bitop3_b32 v77, v73, -9, s52 bitop3:0x6a
    v_smfmac_f32_16x16x64_bf16 v[20:23], v[52:55], v[168:175], v64
    s_cbranch_scc1 cs_rare
cs_rare_x:
    ds_read_b128 v[48:51], v70 offset:22528
    ds_read_b128 v[52:55], v70 offset:23552
    s_waitcnt lgkmcnt(6)
    v_pk_add_f32 v[4:5], v[4:5], v[8:9]
    v_pk_add_f32 v[6:7], v[6:7], v[10:11]
    v_pk_add_f32 v[12:13], v[12:13], v[44:45]
    v_pk_add_f32 v[14:15], v[14:15], v[46:47]
    v_pk_add_f32 v[4:5], v[4:5], v[12:13]
    v_pk_add_f32 v[6:7], v[6:7], v[14:15]
    s_waitcnt lgkmcnt(2)
    v_pk_add_f32 v[24:25], v[24:25], v[26:27]
    v_pk_add_f32 v[28:29], v[28:29], v[30:31]
    v_max3_f32 v8, v4, v5, v6
    v_pk_add_f32 v[24:25], v[24:25], v[28:29]
    v_max_f32 v8, v8, v7
    v_max3_f32 v8, v8, v24, v25
    v_cvt_pk_bf16_f32 v32, v16, v17
    v_cvt_pk_bf16_f32 v38, v18, v19
    v_max_f32_dpp v8, v8, v8 row_ror:8 row_mask:0xf bank_mask:0xf
    v_mov_b32 v9, v8
    v_cvt_pk_bf16_f32 v56, v20, v21
    v_cvt_pk_bf16_f32 v62, v22, v23
    v_permlane32_swap_b32 v8, v9
    v_max_f32 v8, v8, v9
    v_mov_b32 v9, v8
    v_mov_b32 v11, 0
    v_mov_b32 v15, 0
    v_permlane16_swap_b32 v8, v9
    v_max_f32 v8, v8, v9
    v_mul_f32 v8, s66, v8
    v_pk_fma_f32 v[4:5], v[4:5], s[44:45], v[8:9] op_sel_hi:[1,1,0]
    v_pk_fma_f32 v[6:7], v[6:7], s[44:45], v[8:9] op_sel_hi:[1,1,0]
    v_pk_fma_f32 v[24:25], v[24:25], s[44:45], v[8:9] op_sel_hi:[1,1,0]
    v_exp_f32 v4, v4
    v_exp_f32 v5, v5
    v_exp_f32 v6, v6
    v_exp_f32 v7, v7
    v_exp_f32 v24, v24
    v_exp_f32 v25, v25
    v_cvt_pk_bf16_f32 v12, v4, v5
    v_cvt_pk_bf16_f32 v13, v6, v7
    v_cvt_pk_bf16_f32 v10, v24, v25
    v_cvt_pk_bf16_f32 v14, v24, v25
    v_mov_b64 v[0:1], s[48:49]
    v_mfma_f32_16x16x32_bf16 v[4:7], v[32:35], v[10:13], 0
    ds_read_b128 v[40:43], v70 offset:20480
    v_mov_b64 v[2:3], s[50:51]
    v_mfma_f32_16x16x32_bf16 v[24:27], v[36:39], v[12:15], 0
    ds_read_b128 v[44:47], v70 offset:21504
    v_mov_b64 v[8:9], 0
    v_mfma_f32_16x16x32_bf16 v[28:31], v[0:3], v[10:13], 0
    ds_read_b128 v[32:35], v70 offset:24576
    v_mov_b64 v[0:1], 0
    v_mfma_f32_16x16x32_bf16 v[16:19], v[56:59], v[10:13], 0
    ds_read_b128 v[36:39], v70 offset:25600
    v_mov_b64 v[2:3], 0
    v_mfma_f32_16x16x32_bf16 v[20:23], v[60:63], v[12:15], 0
    ds_read_b128 v[56:59], v70 offset:28672
    v_add_f32_dpp v4, v24, v4 row_ror:8 row_mask:0xf bank_mask:0xf
    v_add_f32_dpp v5, v25, v5 row_ror:8 row_mask:0xf bank_mask:0xf
    v_add_f32_dpp v6, v26, v6 row_ror:8 row_mask:0xf bank_mask:0xf
    v_add_f32_dpp v7, v27, v7 row_ror:8 row_mask:0xf bank_mask:0xf
    v_add_f32_dpp v29, v28, v28 row_ror:8 row_mask:0xf bank_mask:0xf
    v_rcp_f32 v28, v29
    v_mov_b64 v[10:11], 0
    v_add_f32_dpp v4, v16, v20 row_ror:8 row_mask:0xf bank_mask:0xc
    v_add_f32_dpp v5, v17, v21 row_ror:8 row_mask:0xf bank_mask:0xc
    v_add_f32_dpp v6, v18, v22 row_ror:8 row_mask:0xf bank_mask:0xc
    v_add_f32_dpp v7, v19, v23 row_ror:8 row_mask:0xf bank_mask:0xc
    v_pk_mul_f32 v[4:5], v[4:5], v[28:29] op_sel_hi:[1,0]
    v_pk_mul_f32 v[6:7], v[6:7], v[28:29] op_sel_hi:[1,0]
    v_cvt_pk_bf16_f32 v4, v4, v5
    v_cvt_pk_bf16_f32 v5, v6, v7
    ds_write_b64 v73, v[4:5] offset:12288
    v_mov_b32_dpp v6, v4 row_ror:8 row_mask:0xf bank_mask:0xf
    v_mov_b32_dpp v7, v5 row_ror:8 row_mask:0xf bank_mask:0xf
    v_mov_b64 v[12:13], 0
    v_mov_b64 v[14:15], 0
    v_smfmac_f32_16x16x64_bf16 v[8:11], v[4:7], v[80:87], v64
    s_waitcnt lgkmcnt(4)
    v_mov_b64 v[24:25], 0
    v_smfmac_f32_16x16x64_bf16 v[0:3], v[4:7], v[40:47], v64
    ds_read_b128 v[60:63], v70 offset:29696
    v_mov_b64 v[26:27], 0
    v_smfmac_f32_16x16x64_bf16 v[12:15], v[4:7], v[112:119], v64
    s_waitcnt lgkmcnt(1)
    s_barrier
    ds_read_b128 v[16:19], v77 offset:12288
    v_smfmac_f32_16x16x64_bf16 v[24:27], v[4:7], v[48:55], v64
    ds_read_b128 v[20:23], v78 offset:12288
    ds_read_b128 v[28:31], v79 offset:12288
    v_mov_b64 v[4:5], 0
    v_mov_b64 v[6:7], 0
    v_bfe_u32 v77, v74, 16, 1
    v_mad_i32_i24 v77, v77, s56, v74
    s_waitcnt lgkmcnt(2)
    v_smfmac_f32_16x16x64_bf16 v[8:11], v[16:19], v[88:95], v64
    ds_read_b128 v[40:43], v70 offset:32768
    s_waitcnt lgkmcnt(2)
    v_smfmac_f32_16x16x64_bf16 v[8:11], v[20:23], v[96:103], v64
    ds_read_b128 v[44:47], v70 offset:33792
    s_waitcnt lgkmcnt(2)
    v_smfmac_f32_16x16x64_bf16 v[8:11], v[28:31], v[104:111], v64
    ds_read_b128 v[48:51], v70 offset:26624
    s_nop 0
    v_and_b32 v72, 8, v73
    v_smfmac_f32_16x16x64_bf16 v[0:3], v[16:19], v[32:39], v64
    ds_read_b128 v[52:55], v70 offset:27648
    s_nop 0
    v_mad_u32_u24 v72, v72, 63, v73
    v_smfmac_f32_16x16x64_bf16 v[12:15], v[16:19], v[120:127], v64
    ds_read_b128 v[32:35], v70 offset:30720
    v_cvt_pk_bf16_f32 v8, v8, v9
    v_cvt_pk_bf16_f32 v9, v10, v11
    v_and_or_b32 v8, v8, -2, s69
    v_smfmac_f32_16x16x64_bf16 v[12:15], v[20:23], v[128:135], v64
    buffer_store_dwordx2 v[8:9], v74, s[4:7], s22 offen offset:0 sc1
    ds_read_b128 v[36:39], v70 offset:31744
    v_smfmac_f32_16x16x64_bf16 v[12:15], v[28:31], v[136:143], v64
    s_add_u32 s30, s30, 1
    s_xor_b32 s70, s70, 1
    v_subrev_u32 v72, s47, v72
    v_smfmac_f32_16x16x64_bf16 v[0:3], v[20:23], v[56:63], v64
    ds_read_b128 v[56:59], v70 offset:34816
    s_waitcnt lgkmcnt(3)
    s_nop 0
    v_smfmac_f32_16x16x64_bf16 v[0:3], v[28:31], v[40:47], v64
    ds_read_b128 v[60:63], v70 offset:35840
    v_cvt_pk_bf16_f32 v12, v12, v13
    v_cvt_pk_bf16_f32 v13, v14, v15
    v_and_or_b32 v12, v12, -2, s69
    v_smfmac_f32_16x16x64_bf16 v[24:27], v[16:19], v[48:55], v64
    buffer_store_dwordx2 v[12:13], v74, s[4:7], s22 offen offset:64 sc1
    s_waitcnt lgkmcnt(2)
    v_smfmac_f32_16x16x64_bf16 v[24:27], v[20:23], v[32:39], v64
    ds_read_b128 v[40:43], v70 offset:16384
    v_cvt_pk_bf16_f32 v0, v0, v1
    v_cvt_pk_bf16_f32 v1, v2, v3
    v_and_or_b32 v0, v0, -2, s69
    s_waitcnt lgkmcnt(1)
    v_smfmac_f32_16x16x64_bf16 v[24:27], v[28:31], v[56:63], v64
    buffer_store_dwordx2 v[0:1], v74, s[4:7], s23 offen offset:0 sc1
    ds_read_b128 v[44:47], v70 offset:17408
    ds_read_b128 v[8:11], v72 offset:12288
    ds_read_b128 v[48:51], v70 offset:18432
    ds_read_b128 v[52:55], v70 offset:19456
    ds_read_b128 v[12:15], v72 offset:13312
    s_cmp_lg_u32 s71, 0
    s_nop 0
    v_cvt_pk_bf16_f32 v24, v24, v25
    v_cvt_pk_bf16_f32 v25, v26, v27
    v_and_or_b32 v24, v24, -2, s69
    buffer_store_dwordx2 v[24:25], v74, s[4:7], s23 offen offset:64 sc1
    s_waitcnt lgkmcnt(3)
    v_smfmac_f32_16x16x64_bf16 v[4:7], v[8:11], v[40:47], v64
    s_waitcnt lgkmcnt(0)
    v_smfmac_f32_16x16x64_bf16 v[4:7], v[12:15], v[48:55], v64
    s_nop 7
    v_cvt_pk_bf16_f32 v4, v4, v5
    v_cvt_pk_bf16_f32 v5, v6, v7
    v_and_or_b32 v4, v4, -2, s69
    buffer_store_dwordx2 v[4:5], v77, s[4:7], s25 offen offset:0 sc1
    s_nop 0
    s_cbranch_scc1 cs_e1
    s_cmp_lg_u32 s37, 0
    s_cbranch_scc1 cs_f0_xt
cs_f0_xtx:
    s_nop 2
    v_mov_b32 v79, v79
    s_nop 2
    v_mov_b32 v79, v79
    s_nop 2
    v_mov_b32 v79, v79
    s_nop 2
    v_mov_b32 v79, v79
    s_nop 2
    v_mov_b32 v79, v79
    s_nop 2
    v_mov_b32 v79, v79
    s_nop 2
    v_mov_b32 v79, v79
    s_nop 2
    v_mov_b32 v79, v79
    s_nop 2
    v_mov_b32 v79, v79
    s_nop 2
    v_mov_b32 v79, v79
    s_nop 2
    v_mov_b32 v79, v79
    s_nop 2
    v_mov_b32 v79, v79
    s_nop 2
    v_mov_b32 v79, v79
    s_nop 2
    v_mov_b32 v79, v79
    s_nop 2
    v_mov_b32 v79, v79
    s_nop 2
    v_mov_b32 v79, v79
    s_nop 2
    v_mov_b32 v79, v79
    s_nop 2
    v_mov_b32 v79, v79
    s_nop 2
    v_mov_b32 v79, v79
    s_nop 2
    v_mov_b32 v79, v79
    s_nop 2
    v_mov_b32 v79, v79
    s_nop 2
    v_mov_b32 v79, v79
    s_nop 2
    v_mov_b32 v79, v79
    s_nop 2
    v_mov_b32 v79, v79
    s_nop 2
    v_mov_b32 v79, v79
    s_nop 2
    v_mov_b32 v79, v79
    s_nop 2
    v_mov_b32 v79, v79
    s_nop 2
    v_mov_b32 v79, v79
    s_nop 2
    v_mov_b32 v79, v79
    s_nop 2
    v_mov_b32 v79, v79
    s_nop 2
    v_mov_b32 v79, v79
    s_nop 2
    v_mov_b32 v79, v79
    s_nop 2
    v_mov_b32 v79, v79
    s_nop 2
    v_mov_b32 v79, v79
    s_nop 2
    v_mov_b32 v79, v79
    s_nop 2
    v_mov_b32 v79, v79
    s_nop 0
    v_mov_b32 v79, v79
    buffer_load_dwordx4 v[8:11], v65, s[4:7], s18 offen sc1
    buffer_load_dwordx4 v[12:15], v65, s[4:7], s19 offen sc1
    buffer_load_dwordx4 v[16:19], v65, s[4:7], s20 offen sc1
    buffer_load_dwordx4 v[20:23], v65, s[4:7], s21 offen sc1
    v_and_b32 v77, 255, v69
    ds_read_b128 v[4:7], v77 offset:15872
    ds_read_b128 v[44:47], v70 offset:0
    ds_read_b128 v[48:51], v70 offset:1024
    ds_read_b128 v[52:55], v70 offset:2048
    ds_read_b128 v[56:59], v70 offset:3072
    ds_read_b128 v[24:27], v70 offset:4096
    ds_read_b128 v[28:31], v70 offset:5120
    ds_read_b128 v[32:35], v70 offset:6144
    ds_read_b128 v[36:39], v70 offset:7168
    s_mov_b32 s31, 65536
    s_add_u32 s24, s24, 524288
    s_add_u32 s26, s26, 524288
    s_add_u32 s55, s55, s57
    s_mov_b32 s14, 67633152
    s_mov_b32 s15, 67637248
    s_mov_b32 s16, 67641344
    s_mov_b32 s36, 1
    v_mov_b32 v40, s69
    v_mov_b32 v60, s69
    v_and_b32 v79, 12, v75
    v_cmp_eq_u32 vcc, 0, v79
    s_nop 1
    v_cndmask_b32 v79, 0, 1, vcc
    s_waitcnt lgkmcnt(0)
    s_waitcnt vmcnt(3)
    v_xor_b32 v77, s69, v8
    v_mfma_f32_16x16x32_bf16 v[0:3], v[4:7], v[8:11], 0
    v_mov_b64 v[8:9], 0
    v_mov_b64 v[10:11], 0
    s_waitcnt vmcnt(2)
    v_bitop3_b32 v77, v77, v12, s69 bitop3:0xf6
    v_mfma_f32_16x16x32_bf16 v[0:3], v[4:7], v[12:15], v[0:3]
    v_mov_b64 v[12:13], 0
    v_mov_b64 v[14:15], 0
    s_waitcnt vmcnt(1)
    v_bitop3_b32 v77, v77, v16, s69 bitop3:0xf6
    v_mfma_f32_16x16x32_bf16 v[0:3], v[4:7], v[16:19], v[0:3]
    v_mov_b64 v[16:17], 0
    v_mov_b64 v[18:19], 0
    s_waitcnt vmcnt(0)
    v_bitop3_b32 v77, v77, v20, s69 bitop3:0xf6
    v_mfma_f32_16x16x32_bf16 v[0:3], v[4:7], v[20:23], v[0:3]
    v_and_b32 v77, 1, v77
    v_cmp_ne_u32 vcc, 0, v77
    v_mov_b64 v[20:21], 0
    v_mov_b64 v[22:23], 0
    s_cmp_eq_u64 vcc, 0
    s_cselect_b64 s[42:43], -1, 0
    s_nop 1
    v_add_f32_dpp v0, v0, v0 row_ror:8 row_mask:0xf bank_mask:0xf
    v_add_f32_dpp v1, v1, v1 row_ror:8 row_mask:0xf bank_mask:0xf
    s_mov_b64 exec, s[42:43]
    v_cvt_pk_bf16_f32 v72, v0, v1
    v_bfi_b32 v72, v79, s70, v72
    buffer_store_dword v72, v75, s[4:7], s17 offen offset:0 sc1
    s_mov_b64 exec, -1
    s_cbranch_scc0 cs_f0_retry
cs_f0_go:
    v_mov_b64 v[0:1], 0
    v_mov_b64 v[2:3], 0
    v_mov_b64 v[4:5], 0
    v_mov_b64 v[6:7], 0
    s_nop 2
    v_mov_b32 v79, v79
    s_nop 2
    v_mov_b32 v79, v79
    s_nop 2
    v_mov_b32 v79, v79
    s_nop 2
    v_mov_b32 v79, v79
    s_nop 2
    v_mov_b32 v79, v79
    s_nop 2
    v_mov_b32 v79, v79
    s_nop 2
    v_mov_b32 v79, v79
    s_nop 2
    v_mov_b32 v79, v79
    s_nop 2
    v_mov_b32 v79, v79
    s_nop 2
    v_mov_b32 v79, v79
    s_nop 2
    v_mov_b32 v79, v79
    s_nop 2
    v_mov_b32 v79, v79
    s_nop 2
    v_mov_b32 v79, v79
    s_nop 2
    v_mov_b32 v79, v79
    s_nop 2
    v_mov_b32 v79, v79
    s_nop 2
    v_mov_b32 v79, v79
    s_nop 2
    v_mov_b32 v79, v79
    s_nop 2
    v_mov_b32 v79, v79
    s_nop 2
    v_mov_b32 v79, v79
    s_nop 2
    v_mov_b32 v79, v79
    s_nop 2
    v_mov_b32 v79, v79
    s_nop 2
    v_mov_b32 v79, v79
    s_nop 2
    v_mov_b32 v79, v79
    s_nop 2
    v_mov_b32 v79, v79
    s_nop 2
    v_mov_b32 v79, v79
    s_branch cs_loop
cs_e1:
    s_cmp_lg_u32 s71, 2
    s_cbranch_scc1 cs_f1
    v_and_b32 v77, 255, v69
    ds_read_b128 v[4:7], v77 offset:15872
    ds_read_b128 v[44:47], v70 offset:0
    ds_read_b128 v[48:51], v70 offset:1024
    ds_read_b128 v[52:55], v70 offset:2048
    ds_read_b128 v[56:59], v70 offset:3072
    ds_read_b128 v[24:27], v70 offset:4096
    ds_read_b128 v[28:31], v70 offset:5120
    ds_read_b128 v[32:35], v70 offset:6144
    ds_read_b128 v[36:39], v70 offset:7168
    s_mov_b32 s31, 65536
    s_add_u32 s24, s24, 524288
    s_add_u32 s26, s26, 524288
    s_add_u32 s55, s55, s57
    s_mov_b32 s14, 67633152
    s_mov_b32 s15, 67637248
    s_mov_b32 s16, 67641344
    s_mov_b32 s36, 1
    v_mov_b32 v40, s69
    v_mov_b32 v60, s69
    v_and_b32 v79, 12, v75
    v_cmp_eq_u32 vcc, 0, v79
    s_nop 1
    v_cndmask_b32 v79, 0, 1, vcc
    s_cmp_lg_u32 s37, 0
    s_cbranch_scc1 cs_f2_xt
cs_f2_xtx:
    s_nop 2
    v_mov_b32 v79, v79
    s_nop 2
    v_mov_b32 v79, v79
    s_nop 2
    v_mov_b32 v79, v79
    s_nop 2
    v_mov_b32 v79, v79
    s_nop 2
    v_mov_b32 v79, v79
    s_nop 2
    v_mov_b32 v79, v79
    s_nop 2
    v_mov_b32 v79, v79
    s_nop 2
    v_mov_b32 v79, v79
    s_nop 2
    v_mov_b32 v79, v79
    s_nop 2
    v_mov_b32 v79, v79
    s_nop 2
    v_mov_b32 v79, v79
    s_nop 2
    v_mov_b32 v79, v79
    s_nop 2
    v_mov_b32 v79, v79
    s_nop 2
    v_mov_b32 v79, v79
    s_nop 2
    v_mov_b32 v79, v79
    s_nop 2
    v_mov_b32 v79, v79
    s_nop 2
    v_mov_b32 v79, v79
    s_nop 2
    v_mov_b32 v79, v79
    s_nop 2
    v_mov_b32 v79, v79
    s_nop 2
    v_mov_b32 v79, v79
    s_nop 2
    v_mov_b32 v79, v79
    s_nop 2
    v_mov_b32 v79, v79
    s_nop 2
    v_mov_b32 v79, v79
    s_nop 2
    v_mov_b32 v79, v79
    s_nop 2
    v_mov_b32 v79, v79
    s_nop 2
    v_mov_b32 v79, v79
    s_nop 2
    v_mov_b32 v79, v79
    s_nop 2
    v_mov_b32 v79, v79
    s_nop 2
    v_mov_b32 v79, v79
    s_nop 2
    v_mov_b32 v79, v79
    s_nop 2
    v_mov_b32 v79, v79
    s_nop 2
    v_mov_b32 v79, v79
    s_nop 2
    v_mov_b32 v79, v79
    s_nop 2
    v_mov_b32 v79, v79
    s_nop 2
    v_mov_b32 v79, v79
    s_nop 2
    v_mov_b32 v79, v79
    s_nop 0
    v_mov_b32 v79, v79
    s_waitcnt vmcnt(0)
    buffer_load_dwordx4 v[8:11], v65, s[4:7], s18 offen sc1
    buffer_load_dwordx4 v[12:15], v65, s[4:7], s19 offen sc1
    buffer_load_dwordx4 v[16:19], v65, s[4:7], s20 offen sc1
    buffer_load_dwordx4 v[20:23], v65, s[4:7], s21 offen sc1
    s_nop 2
    v_mov_b32 v79, v79
    s_nop 2
    v_mov_b32 v79, v79
    s_nop 2
    v_mov_b32 v79, v79
    s_nop 2
    v_mov_b32 v79, v79
    s_nop 2
    v_mov_b32 v79, v79
    s_nop 2
    v_mov_b32 v79, v79
    s_nop 2
    v_mov_b32 v79, v79
    s_nop 2
    v_mov_b32 v79, v79
    s_nop 2
    v_mov_b32 v79, v79
    s_nop 2
    v_mov_b32 v79, v79
    buffer_load_dwordx4 v[40:43], v65, s[4:7], s14 offen offset:0 sc1
    buffer_load_dwordx4 v[60:63], v66, s[4:7], s14 offen offset:0 sc1
    s_waitcnt lgkmcnt(0)
    s_waitcnt vmcnt(5)
    v_xor_b32 v77, s69, v8
    v_mfma_f32_16x16x32_bf16 v[0:3], v[4:7], v[8:11], 0
    v_mov_b64 v[8:9], 0
    v_mov_b64 v[10:11], 0
    s_waitcnt vmcnt(4)
    v_bitop3_b32 v77, v77, v12, s69 bitop3:0xf6
    v_mfma_f32_16x16x32_bf16 v[0:3], v[4:7], v[12:15], v[0:3]
    v_mov_b64 v[12:13], 0
    v_mov_b64 v[14:15], 0
    s_waitcnt vmcnt(3)
    v_bitop3_b32 v77, v77, v16, s69 bitop3:0xf6
    v_mfma_f32_16x16x32_bf16 v[0:3], v[4:7], v[16:19], v[0:3]
    v_mov_b64 v[16:17], 0
    v_mov_b64 v[18:19], 0
    s_waitcnt vmcnt(2)
    v_bitop3_b32 v77, v77, v20, s69 bitop3:0xf6
    v_mfma_f32_16x16x32_bf16 v[0:3], v[4:7], v[20:23], v[0:3]
    v_and_b32 v77, 1, v77
    v_cmp_ne_u32 vcc, 0, v77
    v_mov_b64 v[20:21], 0
    v_mov_b64 v[22:23], 0
    buffer_load_dwordx4 v[40:43], v65, s[4:7], s14 offen offset:0 sc1
    buffer_load_dwordx4 v[60:63], v66, s[4:7], s14 offen offset:0 sc1
    s_cmp_eq_u64 vcc, 0
    s_cselect_b64 s[42:43], -1, 0
    v_add_f32_dpp v0, v0, v0 row_ror:4 row_mask:0xf bank_mask:0xf
    v_add_f32_dpp v1, v1, v1 row_ror:4 row_mask:0xf bank_mask:0xf
    s_nop 0
    v_add_f32_dpp v0, v0, v0 row_ror:8 row_mask:0xf bank_mask:0xf
    v_add_f32_dpp v1, v1, v1 row_ror:8 row_mask:0xf bank_mask:0xf
    s_mov_b64 exec, s[42:43]
    v_cvt_pk_bf16_f32 v72, v0, v1
    v_bfi_b32 v72, v79, s70, v72
    buffer_store_dword v72, v75, s[4:7], s17 offen offset:0 sc1
    buffer_store_dword v72, v75, s[4:7], s17 offen offset:1024 sc1
    buffer_store_dword v72, v75, s[4:7], s17 offen offset:2048 sc1
    buffer_store_dword v72, v75, s[4:7], s17 offen offset:3072 sc1
    s_mov_b64 exec, -1
    s_cbranch_scc0 cs_f2_retry
cs_f2_go:
    v_mov_b64 v[0:1], 0
    v_mov_b64 v[2:3], 0
    v_mov_b64 v[4:5], 0
    v_mov_b64 v[6:7], 0
    s_nop 2
    v_mov_b32 v79, v79
    s_nop 2
    v_mov_b32 v79, v79
    s_nop 2
    v_mov_b32 v79, v79
    s_nop 2
    v_mov_b32 v79, v79
    s_nop 2
    v_mov_b32 v79, v79
    s_nop 2
    v_mov_b32 v79, v79
    s_nop 2
    v_mov_b32 v79, v79
    s_nop 2
    v_mov_b32 v79, v79
    s_nop 2
    v_mov_b32 v79, v79
    s_nop 2
    v_mov_b32 v79, v79
    s_nop 2
    v_mov_b32 v79, v79
    s_nop 2
    v_mov_b32 v79, v79
    s_nop 2
    v_mov_b32 v79, v79
    s_nop 2
    v_mov_b32 v79, v79
    s_nop 2
    v_mov_b32 v79, v79
    s_nop 2
    v_mov_b32 v79, v79
    s_nop 2
    v_mov_b32 v79, v79
    s_nop 2
    v_mov_b32 v79, v79
    s_nop 2
    v_mov_b32 v79, v79
    s_nop 2
    v_mov_b32 v79, v79
    s_nop 2
    v_mov_b32 v79, v79
    s_nop 2
    v_mov_b32 v79, v79
    s_nop 2
    v_mov_b32 v79, v79
    s_nop 2
    v_mov_b32 v79, v79
    s_nop 2
    v_mov_b32 v79, v79
    s_branch cs_loop
cs_f1:
    s_cmp_lg_u32 s32, 1
    s_cbranch_scc1 cs_f3
    v_and_b32 v77, 255, v69
    ds_read_b128 v[4:7], v77 offset:15872
    ds_read_b128 v[44:47], v70 offset:0
    ds_read_b128 v[48:51], v70 offset:1024
    ds_read_b128 v[52:55], v70 offset:2048
    ds_read_b128 v[56:59], v70 offset:3072
    ds_read_b128 v[24:27], v70 offset:4096
    ds_read_b128 v[28:31], v70 offset:5120
    ds_read_b128 v[32:35], v70 offset:6144
    ds_read_b128 v[36:39], v70 offset:7168
    s_mov_b32 s31, 65536
    s_add_u32 s24, s24, 524288
    s_add_u32 s26, s26, 524288
    s_add_u32 s55, s55, s57
    s_mov_b32 s14, 67633152
    s_mov_b32 s15, 67637248
    s_mov_b32 s16, 67641344
    s_mov_b32 s36, 1
    v_mov_b32 v40, s69
    v_mov_b32 v60, s69
    v_and_b32 v79, 12, v75
    v_cmp_eq_u32 vcc, 0, v79
    s_nop 1
    v_cndmask_b32 v79, 0, 1, vcc
    s_cmp_lg_u32 s37, 0
    s_cbranch_scc1 cs_f1_xt
cs_f1_xtx:
    s_nop 2
    v_mov_b32 v79, v79
    s_nop 2
    v_mov_b32 v79, v79
    s_nop 2
    v_mov_b32 v79, v79
    s_nop 2
    v_mov_b32 v79, v79
    s_nop 2
    v_mov_b32 v79, v79
    s_nop 2
    v_mov_b32 v79, v79
    s_nop 2
    v_mov_b32 v79, v79
    s_nop 2
    v_mov_b32 v79, v79
    s_nop 2
    v_mov_b32 v79, v79
    s_nop 2
    v_mov_b32 v79, v79
    s_nop 2
    v_mov_b32 v79, v79
    s_nop 2
    v_mov_b32 v79, v79
    s_nop 2
    v_mov_b32 v79, v79
    s_nop 2
    v_mov_b32 v79, v79
    s_nop 2
    v_mov_b32 v79, v79
    s_nop 2
    v_mov_b32 v79, v79
    s_nop 2
    v_mov_b32 v79, v79
    s_nop 2
    v_mov_b32 v79, v79
    s_nop 2
    v_mov_b32 v79, v79
    s_nop 2
    v_mov_b32 v79, v79
    s_nop 2
    v_mov_b32 v79, v79
    s_nop 2
    v_mov_b32 v79, v79
    s_nop 2
    v_mov_b32 v79, v79
    s_nop 2
    v_mov_b32 v79, v79
    s_nop 2
    v_mov_b32 v79, v79
    s_nop 2
    v_mov_b32 v79, v79
    s_nop 2
    v_mov_b32 v79, v79
    s_nop 2
    v_mov_b32 v79, v79
    s_nop 2
    v_mov_b32 v79, v79
    s_nop 2
    v_mov_b32 v79, v79
    s_nop 2
    v_mov_b32 v79, v79
    s_nop 2
    v_mov_b32 v79, v79
    s_nop 2
    v_mov_b32 v79, v79
    s_nop 2
    v_mov_b32 v79, v79
    s_nop 2
    v_mov_b32 v79, v79
    s_nop 2
    v_mov_b32 v79, v79
    s_nop 0
    v_mov_b32 v79, v79
    s_waitcnt vmcnt(0)
    buffer_load_dwordx4 v[8:11], v65, s[4:7], s18 offen sc1
    buffer_load_dwordx4 v[12:15], v65, s[4:7], s19 offen sc1
    buffer_load_dwordx4 v[16:19], v65, s[4:7], s20 offen sc1
    buffer_load_dwordx4 v[20:23], v65, s[4:7], s21 offen sc1
    s_nop 2
    v_mov_b32 v79, v79
    s_nop 2
    v_mov_b32 v79, v79
    s_nop 2
    v_mov_b32 v79, v79
    s_nop 2
    v_mov_b32 v79, v79
    s_nop 2
    v_mov_b32 v79, v79
    s_nop 2
    v_mov_b32 v79, v79
    s_nop 2
    v_mov_b32 v79, v79
    s_nop 2
    v_mov_b32 v79, v79
    s_nop 2
    v_mov_b32 v79, v79
    s_nop 2
    v_mov_b32 v79, v79
    buffer_load_dwordx4 v[40:43], v65, s[4:7], s14 offen offset:0 sc1
    buffer_load_dwordx4 v[60:63], v66, s[4:7], s14 offen offset:0 sc1
    s_waitcnt lgkmcnt(0)
    s_waitcnt vmcnt(5)
    v_xor_b32 v77, s69, v8
    v_mfma_f32_16x16x32_bf16 v[0:3], v[4:7], v[8:11], 0
    v_mov_b64 v[8:9], 0
    v_mov_b64 v[10:11], 0
    s_waitcnt vmcnt(4)
    v_bitop3_b32 v77, v77, v12, s69 bitop3:0xf6
    v_mfma_f32_16x16x32_bf16 v[0:3], v[4:7], v[12:15], v[0:3]
    v_mov_b64 v[12:13], 0
    v_mov_b64 v[14:15], 0
    s_waitcnt vmcnt(3)
    v_bitop3_b32 v77, v77, v16, s69 bitop3:0xf6
    v_mfma_f32_16x16x32_bf16 v[0:3], v[4:7], v[16:19], v[0:3]
    v_mov_b64 v[16:17], 0
    v_mov_b64 v[18:19], 0
    s_waitcnt vmcnt(2)
    v_bitop3_b32 v77, v77, v20, s69 bitop3:0xf6
    v_mfma_f32_16x16x32_bf16 v[0:3], v[4:7], v[20:23], v[0:3]
    v_and_b32 v77, 1, v77
    v_cmp_ne_u32 vcc, 0, v77
    v_mov_b64 v[20:21], 0
    v_mov_b64 v[22:23], 0
    buffer_load_dwordx4 v[40:43], v65, s[4:7], s14 offen offset:0 sc1
    buffer_load_dwordx4 v[60:63], v66, s[4:7], s14 offen offset:0 sc1
    s_cmp_eq_u64 vcc, 0
    s_cselect_b64 s[42:43], -1, 0
    v_add_f32_dpp v0, v0, v0 row_ror:8 row_mask:0xf bank_mask:0xf
    v_add_f32_dpp v1, v1, v1 row_ror:8 row_mask:0xf bank_mask:0xf
    s_mov_b64 exec, s[42:43]
    v_cvt_pk_bf16_f32 v72, v0, v1
    v_bfi_b32 v72, v79, s70, v72
    buffer_store_dword v72, v75, s[4:7], s17 offen offset:0 sc1
    s_mov_b64 exec, -1
    s_cbranch_scc0 cs_f1_retry
cs_f1_go:
    v_mov_b64 v[0:1], 0
    v_mov_b64 v[2:3], 0
    v_mov_b64 v[4:5], 0
    v_mov_b64 v[6:7], 0
    s_nop 2
    v_mov_b32 v79, v79
    s_nop 2
    v_mov_b32 v79, v79
    s_nop 2
    v_mov_b32 v79, v79
    s_nop 2
    v_mov_b32 v79, v79
    s_nop 2
    v_mov_b32 v79, v79
    s_nop 2
    v_mov_b32 v79, v79
    s_nop 2
    v_mov_b32 v79, v79
    s_nop 2
    v_mov_b32 v79, v79
    s_nop 2
    v_mov_b32 v79, v79
    s_nop 2
    v_mov_b32 v79, v79
    s_nop 2
    v_mov_b32 v79, v79
    s_nop 2
    v_mov_b32 v79, v79
    s_nop 2
    v_mov_b32 v79, v79
    s_nop 2
    v_mov_b32 v79, v79
    s_nop 2
    v_mov_b32 v79, v79
    s_nop 2
    v_mov_b32 v79, v79
    s_nop 2
    v_mov_b32 v79, v79
    s_nop 2
    v_mov_b32 v79, v79
    s_nop 2
    v_mov_b32 v79, v79
    s_nop 2
    v_mov_b32 v79, v79
    s_nop 2
    v_mov_b32 v79, v79
    s_nop 2
    v_mov_b32 v79, v79
    s_nop 2
    v_mov_b32 v79, v79
    s_nop 2
    v_mov_b32 v79, v79
    s_nop 2
    v_mov_b32 v79, v79
    s_branch cs_loop
cs_f3:
    v_and_b32 v77, 255, v69
    ds_read_b128 v[4:7], v77 offset:15872
    ds_read_b128 v[44:47], v70 offset:0
    ds_read_b128 v[48:51], v70 offset:1024
    ds_read_b128 v[52:55], v70 offset:2048
    ds_read_b128 v[56:59], v70 offset:3072
    ds_read_b128 v[24:27], v70 offset:4096
    ds_read_b128 v[28:31], v70 offset:5120
    ds_read_b128 v[32:35], v70 offset:6144
    ds_read_b128 v[36:39], v70 offset:7168
    s_mov_b32 s31, 65536
    s_add_u32 s24, s24, 524288
    s_add_u32 s26, s26, 524288
    s_add_u32 s55, s55, s57
    s_mov_b32 s14, 67633152
    s_mov_b32 s15, 67637248
    s_mov_b32 s16, 67641344
    s_mov_b32 s36, 1
    v_mov_b32 v40, s69
    v_mov_b32 v60, s69
    v_and_b32 v79, 12, v75
    v_cmp_eq_u32 vcc, 0, v79
    s_nop 1
    v_cndmask_b32 v79, 0, 1, vcc
    s_add_u32 s40, s30, s95
    v_mov_b32 v72, s40
    s_waitcnt lgkmcnt(0)
    v_mov_b64 v[0:1], 0
    v_mov_b64 v[2:3], 0
    v_mov_b64 v[4:5], 0
    v_mov_b64 v[6:7], 0
    v_mov_b64 v[8:9], 0
    v_mov_b64 v[10:11], 0
    v_mov_b64 v[12:13], 0
    v_mov_b64 v[14:15], 0
    v_mov_b64 v[16:17], 0
    v_mov_b64 v[18:19], 0
    v_mov_b64 v[20:21], 0
    v_mov_b64 v[22:23], 0
    s_nop 2
    v_mov_b32 v79, v79
    s_nop 2
    v_mov_b32 v79, v79
    s_nop 2
    v_mov_b32 v79, v79
    s_nop 2
    v_mov_b32 v79, v79
    s_nop 2
    v_mov_b32 v79, v79
    s_nop 2
    v_mov_b32 v79, v79
    s_nop 2
    v_mov_b32 v79, v79
    s_nop 2
    v_mov_b32 v79, v79
    s_nop 2
    v_mov_b32 v79, v79
    s_nop 2
    v_mov_b32 v79, v79
    s_nop 2
    v_mov_b32 v79, v79
    s_nop 2
    v_mov_b32 v79, v79
    s_nop 2
    v_mov_b32 v79, v79
    s_nop 2
    v_mov_b32 v79, v79
    s_nop 2
    v_mov_b32 v79, v79
    s_nop 2
    v_mov_b32 v79, v79
    s_nop 2
    v_mov_b32 v79, v79
    s_nop 2
    v_mov_b32 v79, v79
    s_nop 2
    v_mov_b32 v79, v79
    s_nop 2
    v_mov_b32 v79, v79
    s_nop 2
    v_mov_b32 v79, v79
    s_nop 2
    v_mov_b32 v79, v79
    s_nop 2
    v_mov_b32 v79, v79
    s_nop 2
    v_mov_b32 v79, v79
    s_nop 2
    v_mov_b32 v79, v79
    s_nop 2
    v_mov_b32 v79, v79
    s_nop 2
    v_mov_b32 v79, v79
    s_nop 2
    v_mov_b32 v79, v79
    s_nop 2
    v_mov_b32 v79, v79
    s_nop 2
    v_mov_b32 v79, v79
    s_nop 2
    v_mov_b32 v79, v79
    s_nop 2
    v_mov_b32 v79, v79
    s_nop 2
    v_mov_b32 v79, v79
    s_nop 2
    v_mov_b32 v79, v79
    s_nop 2
    v_mov_b32 v79, v79
    s_nop 2
    v_mov_b32 v79, v79
    s_nop 2
    v_mov_b32 v79, v79
    s_nop 2
    v_mov_b32 v79, v79
    s_nop 2
    v_mov_b32 v79, v79
    s_nop 2
    v_mov_b32 v79, v79
    s_nop 2
    v_mov_b32 v79, v79
    s_nop 2
    v_mov_b32 v79, v79
    s_nop 2
    v_mov_b32 v79, v79
    s_nop 2
    v_mov_b32 v79, v79
    s_nop 2
    v_mov_b32 v79, v79
    s_nop 2
    v_mov_b32 v79, v79
    s_nop 2
    v_mov_b32 v79, v79
    s_nop 2
    v_mov_b32 v79, v79
    s_nop 2
    v_mov_b32 v79, v79
    s_nop 2
    v_mov_b32 v79, v79
    s_nop 2
    v_mov_b32 v79, v79
    s_nop 2
    v_mov_b32 v79, v79
    s_nop 2
    v_mov_b32 v79, v79
    s_nop 2
    v_mov_b32 v79, v79
    s_nop 2
    v_mov_b32 v79, v79
    s_nop 2
    v_mov_b32 v79, v79
    s_nop 2
    v_mov_b32 v79, v79
    s_nop 2
    v_mov_b32 v79, v79
    s_nop 2
    v_mov_b32 v79, v79
    s_nop 2
    v_mov_b32 v79, v79
    s_nop 2
    v_mov_b32 v79, v79
    s_nop 2
    v_mov_b32 v79, v79
    s_nop 2
    v_mov_b32 v79, v79
    s_nop 2
    v_mov_b32 v79, v79
    s_nop 2
    v_mov_b32 v79, v79
    s_waitcnt vmcnt(0)
    s_cmp_lt_u32 s97, s93
    s_cbranch_scc1 cs_kvwait
    s_nop 2
    v_mov_b32 v79, v79
    s_nop 2
    v_mov_b32 v79, v79
    s_nop 2
    v_mov_b32 v79, v79
    s_nop 2
    v_mov_b32 v79, v79
    s_nop 2
    v_mov_b32 v79, v79
    s_nop 2
    v_mov_b32 v79, v79
    s_nop 2
    v_mov_b32 v79, v79
    s_nop 2
    v_mov_b32 v79, v79
cs_kvok:
    s_branch cs_loop
cs_f0_xt:
    s_mov_b32 s37, 0
    s_nop 2
    v_mov_b32 v79, v79
    s_nop 2
    v_mov_b32 v79, v79
    s_nop 2
    v_mov_b32 v79, v79
    s_nop 2
    v_mov_b32 v79, v79
    s_nop 2
    v_mov_b32 v79, v79
    s_nop 2
    v_mov_b32 v79, v79
    s_branch cs_f0_xtx
cs_f0_retry:
    s_mov_b32 s37, 1
cs_f0_spin:
    buffer_load_dwordx4 v[8:11], v65, s[4:7], s18 offen sc1
    buffer_load_dwordx4 v[12:15], v65, s[4:7], s19 offen sc1
    buffer_load_dwordx4 v[16:19], v65, s[4:7], s20 offen sc1
    buffer_load_dwordx4 v[20:23], v65, s[4:7], s21 offen sc1
    s_nop 2
    v_mov_b32 v79, v79
    s_nop 2
    v_mov_b32 v79, v79
    s_nop 2
    v_mov_b32 v79, v79
    buffer_load_dwordx4 v[40:43], v65, s[4:7], s14 offen offset:0 sc1
    buffer_load_dwordx4 v[60:63], v66, s[4:7], s14 offen offset:0 sc1
    s_waitcnt vmcnt(5)
    v_xor_b32 v77, s69, v8
    v_mfma_f32_16x16x32_bf16 v[0:3], v[4:7], v[8:11], 0
    v_mov_b64 v[8:9], 0
    v_mov_b64 v[10:11], 0
    s_waitcnt vmcnt(4)
    v_bitop3_b32 v77, v77, v12, s69 bitop3:0xf6
    v_mfma_f32_16x16x32_bf16 v[0:3], v[4:7], v[12:15], v[0:3]
    v_mov_b64 v[12:13], 0
    v_mov_b64 v[14:15], 0
    s_waitcnt vmcnt(3)
    v_bitop3_b32 v77, v77, v16, s69 bitop3:0xf6
    v_mfma_f32_16x16x32_bf16 v[0:3], v[4:7], v[16:19], v[0:3]
    v_mov_b64 v[16:17], 0
    v_mov_b64 v[18:19], 0
    s_waitcnt vmcnt(2)
    v_bitop3_b32 v77, v77, v20, s69 bitop3:0xf6
    v_mfma_f32_16x16x32_bf16 v[0:3], v[4:7], v[20:23], v[0:3]
    v_and_b32 v77, 1, v77
    v_cmp_ne_u32 vcc, 0, v77
    v_mov_b64 v[20:21], 0
    v_mov_b64 v[22:23], 0
    buffer_load_dwordx4 v[40:43], v65, s[4:7], s14 offen offset:0 sc1
    buffer_load_dwordx4 v[60:63], v66, s[4:7], s14 offen offset:0 sc1
    s_cmp_eq_u64 vcc, 0
    s_cselect_b64 s[42:43], -1, 0
    v_add_f32_dpp v0, v0, v0 row_ror:8 row_mask:0xf bank_mask:0xf
    v_add_f32_dpp v1, v1, v1 row_ror:8 row_mask:0xf bank_mask:0xf
    s_mov_b64 exec, s[42:43]
    v_cvt_pk_bf16_f32 v72, v0, v1
    v_bfi_b32 v72, v79, s70, v72
    buffer_store_dword v72, v75, s[4:7], s17 offen offset:0 sc1
    s_mov_b64 exec, -1
    s_cbranch_scc1 cs_f0_rx
    s_sub_u32 s31, s31, 1
    s_cbranch_scc0 cs_f0_spin
cs_f0_rx:
    v_mov_b64 v[0:1], 0
    v_mov_b64 v[2:3], 0
    v_mov_b64 v[4:5], 0
    v_mov_b64 v[6:7], 0
    s_branch cs_loop
cs_f1_xt:
    s_mov_b32 s37, 0
    s_nop 2
    v_mov_b32 v79, v79
    s_nop 2
    v_mov_b32 v79, v79
    s_nop 2
    v_mov_b32 v79, v79
    s_nop 2
    v_mov_b32 v79, v79
    s_nop 2
    v_mov_b32 v79, v79
    s_nop 2
    v_mov_b32 v79, v79
    s_branch cs_f1_xtx
cs_f1_retry:
    s_mov_b32 s37, 1
cs_f1_spin:
    buffer_load_dwordx4 v[8:11], v65, s[4:7], s18 offen sc1
    buffer_load_dwordx4 v[12:15], v65, s[4:7], s19 offen sc1
    buffer_load_dwordx4 v[16:19], v65, s[4:7], s20 offen sc1
    buffer_load_dwordx4 v[20:23], v65, s[4:7], s21 offen sc1
    s_nop 2
    v_mov_b32 v79, v79
    s_nop 2
    v_mov_b32 v79, v79
    s_nop 2
    v_mov_b32 v79, v79
    buffer_load_dwordx4 v[40:43], v65, s[4:7], s14 offen offset:0 sc1
    buffer_load_dwordx4 v[60:63], v66, s[4:7], s14 offen offset:0 sc1
    s_waitcnt vmcnt(5)
    v_xor_b32 v77, s69, v8
    v_mfma_f32_16x16x32_bf16 v[0:3], v[4:7], v[8:11], 0
    v_mov_b64 v[8:9], 0
    v_mov_b64 v[10:11], 0
    s_waitcnt vmcnt(4)
    v_bitop3_b32 v77, v77, v12, s69 bitop3:0xf6
    v_mfma_f32_16x16x32_bf16 v[0:3], v[4:7], v[12:15], v[0:3]
    v_mov_b64 v[12:13], 0
    v_mov_b64 v[14:15], 0
    s_waitcnt vmcnt(3)
    v_bitop3_b32 v77, v77, v16, s69 bitop3:0xf6
    v_mfma_f32_16x16x32_bf16 v[0:3], v[4:7], v[16:19], v[0:3]
    v_mov_b64 v[16:17], 0
    v_mov_b64 v[18:19], 0
    s_waitcnt vmcnt(2)
    v_bitop3_b32 v77, v77, v20, s69 bitop3:0xf6
    v_mfma_f32_16x16x32_bf16 v[0:3], v[4:7], v[20:23], v[0:3]
    v_and_b32 v77, 1, v77
    v_cmp_ne_u32 vcc, 0, v77
    v_mov_b64 v[20:21], 0
    v_mov_b64 v[22:23], 0
    buffer_load_dwordx4 v[40:43], v65, s[4:7], s14 offen offset:0 sc1
    buffer_load_dwordx4 v[60:63], v66, s[4:7], s14 offen offset:0 sc1
    s_cmp_eq_u64 vcc, 0
    s_cselect_b64 s[42:43], -1, 0
    v_add_f32_dpp v0, v0, v0 row_ror:8 row_mask:0xf bank_mask:0xf
    v_add_f32_dpp v1, v1, v1 row_ror:8 row_mask:0xf bank_mask:0xf
    s_mov_b64 exec, s[42:43]
    v_cvt_pk_bf16_f32 v72, v0, v1
    v_bfi_b32 v72, v79, s70, v72
    buffer_store_dword v72, v75, s[4:7], s17 offen offset:0 sc1
    s_mov_b64 exec, -1
    s_cbranch_scc1 cs_f1_rx
    s_sub_u32 s31, s31, 1
    s_cbranch_scc0 cs_f1_spin
cs_f1_rx:
    v_mov_b64 v[0:1], 0
    v_mov_b64 v[2:3], 0
    v_mov_b64 v[4:5], 0
    v_mov_b64 v[6:7], 0
    s_branch cs_loop
cs_f2_xt:
    s_mov_b32 s37, 0
    s_nop 2
    v_mov_b32 v79, v79
    s_nop 2
    v_mov_b32 v79, v79
    s_nop 2
    v_mov_b32 v79, v79
    s_nop 2
    v_mov_b32 v79, v79
    s_nop 2
    v_mov_b32 v79, v79
    s_nop 2
    v_mov_b32 v79, v79
    s_branch cs_f2_xtx
cs_f2_retry:
    s_mov_b32 s37, 1
cs_f2_spin:
    buffer_load_dwordx4 v[8:11], v65, s[4:7], s18 offen sc1
    buffer_load_dwordx4 v[12:15], v65, s[4:7], s19 offen sc1
    buffer_load_dwordx4 v[16:19], v65, s[4:7], s20 offen sc1
    buffer_load_dwordx4 v[20:23], v65, s[4:7], s21 offen sc1
    s_nop 2
    v_mov_b32 v79, v79
    s_nop 2
    v_mov_b32 v79, v79
    s_nop 2
    v_mov_b32 v79, v79
    buffer_load_dwordx4 v[40:43], v65, s[4:7], s14 offen offset:0 sc1
    buffer_load_dwordx4 v[60:63], v66, s[4:7], s14 offen offset:0 sc1
    s_waitcnt vmcnt(5)
    v_xor_b32 v77, s69, v8
    v_mfma_f32_16x16x32_bf16 v[0:3], v[4:7], v[8:11], 0
    v_mov_b64 v[8:9], 0
    v_mov_b64 v[10:11], 0
    s_waitcnt vmcnt(4)
    v_bitop3_b32 v77, v77, v12, s69 bitop3:0xf6
    v_mfma_f32_16x16x32_bf16 v[0:3], v[4:7], v[12:15], v[0:3]
    v_mov_b64 v[12:13], 0
    v_mov_b64 v[14:15], 0
    s_waitcnt vmcnt(3)
    v_bitop3_b32 v77, v77, v16, s69 bitop3:0xf6
    v_mfma_f32_16x16x32_bf16 v[0:3], v[4:7], v[16:19], v[0:3]
    v_mov_b64 v[16:17], 0
    v_mov_b64 v[18:19], 0
    s_waitcnt vmcnt(2)
    v_bitop3_b32 v77, v77, v20, s69 bitop3:0xf6
    v_mfma_f32_16x16x32_bf16 v[0:3], v[4:7], v[20:23], v[0:3]
    v_and_b32 v77, 1, v77
    v_cmp_ne_u32 vcc, 0, v77
    v_mov_b64 v[20:21], 0
    v_mov_b64 v[22:23], 0
    buffer_load_dwordx4 v[40:43], v65, s[4:7], s14 offen offset:0 sc1
    buffer_load_dwordx4 v[60:63], v66, s[4:7], s14 offen offset:0 sc1
    s_cmp_eq_u64 vcc, 0
    s_cselect_b64 s[42:43], -1, 0
    v_add_f32_dpp v0, v0, v0 row_ror:4 row_mask:0xf bank_mask:0xf
    v_add_f32_dpp v1, v1, v1 row_ror:4 row_mask:0xf bank_mask:0xf
    s_nop 0
    v_add_f32_dpp v0, v0, v0 row_ror:8 row_mask:0xf bank_mask:0xf
    v_add_f32_dpp v1, v1, v1 row_ror:8 row_mask:0xf bank_mask:0xf
    s_mov_b64 exec, s[42:43]
    v_cvt_pk_bf16_f32 v72, v0, v1
    v_bfi_b32 v72, v79, s70, v72
    buffer_store_dword v72, v75, s[4:7], s17 offen offset:0 sc1
    buffer_store_dword v72, v75, s[4:7], s17 offen offset:1024 sc1
    buffer_store_dword v72, v75, s[4:7], s17 offen offset:2048 sc1
    buffer_store_dword v72, v75, s[4:7], s17 offen offset:3072 sc1
    s_mov_b64 exec, -1
    s_cbranch_scc1 cs_f2_rx
    s_sub_u32 s31, s31, 1
    s_cbranch_scc0 cs_f2_spin
cs_f2_rx:
    v_mov_b64 v[0:1], 0
    v_mov_b64 v[2:3], 0
    v_mov_b64 v[4:5], 0
    v_mov_b64 v[6:7], 0
    s_branch cs_loop
cs_spinB:
    s_waitcnt vmcnt(3)
cs_spinB_l:
    v_and_b32 v77, s36, v44
    v_cmp_ne_u32 vcc, s70, v77
    s_cbranch_vccz cs_spinB_x
    buffer_load_dwordx4 v[44:47], v65, s[4:7], s15 offen sc1
    s_sub_u32 s31, s31, 16
    s_waitcnt vmcnt(0)
    s_cbranch_scc0 cs_spinB_l
cs_spinB_x:
    ds_write_b128 v65, v[44:47] offset:4096
    s_waitcnt lgkmcnt(0)
    s_branch cs_backB
cs_spin8:
    buffer_load_dwordx4 v[40:43], v65, s[4:7], s16 offen sc1
cs_spin8_l:
    v_and_b32 v77, s36, v40
    v_cmp_ne_u32 vcc, s70, v77
    s_cbranch_vccz cs_spin8_x
    s_nop 15
    s_nop 15
    s_nop 15
    s_nop 11
    v_and_b32 v77, s36, v40
    v_cmp_ne_u32 vcc, s70, v77
    s_cbranch_vccz cs_spin8_x
    s_nop 15
    s_nop 15
    s_nop 15
    s_nop 11
    v_and_b32 v77, s36, v40
    v_cmp_ne_u32 vcc, s70, v77
    s_cbranch_vccz cs_spin8_x
    s_nop 15
    s_nop 15
    s_nop 15
    s_nop 11
    buffer_load_dwordx4 v[40:43], v65, s[4:7], s16 offen sc1
    s_sub_u32 s31, s31, 16
    s_cbranch_scc0 cs_spin8_l
cs_spin8_x:
    s_branch cs_back8
cs_rare:
    s_mov_b64 exec, s[34:35]
    buffer_store_dwordx4 v[0:3], v65, s[4:7], s28 offen sc1
    s_mov_b64 exec, -1
    s_nop 3
    v_cvt_pk_bf16_f32 v52, v16, v17
    v_cvt_pk_bf16_f32 v53, v18, v19
    v_cvt_pk_bf16_f32 v54, v20, v21
    v_cvt_pk_bf16_f32 v55, v22, v23
    buffer_store_dwordx4 v[52:55], v65, s[4:7], s27 offen sc1
    s_add_u32 s28, s28, 131072
    s_add_u32 s27, s27, 131072
    s_cmp_eq_u32 s30, 63
    s_cbranch_scc1 cs_last
    s_branch cs_rare_x
cs_kvwait:
    s_mov_b32 s41, s97
    v_bfe_u32 v78, v65, 2, 5
    v_mov_b32 v77, v76
    s_nop 1
    v_permlane32_swap_b32 v76, v77
    v_subrev_u32 v77, s95, v77
    v_cmp_lt_u32 vcc, 16, v77
    s_nop 1
    v_cndmask_b32 v77, v77, 0, vcc
    v_bfe_u32 v79, v78, 2, 2
    v_lshl_add_u32 v77, v77, 2, v79
    s_nop 1
    v_min_u32_dpp v77, v77, v77 row_ror:1 row_mask:0xf bank_mask:0xf
    s_nop 1
    v_min_u32_dpp v77, v77, v77 row_ror:2 row_mask:0xf bank_mask:0xf
    s_nop 1
    v_min_u32_dpp v77, v77, v77 row_ror:4 row_mask:0xf bank_mask:0xf
    s_nop 0
    v_readfirstlane_b32 s97, v77
    s_nop 0
    s_max_u32 s97, s97, s41
    s_add_u32 s40, s30, 3
    s_min_u32 s40, s40, 64
    s_cmp_le_u32 s40, s97
    s_cbranch_scc1 cs_kvw_x
    v_bfe_u32 v78, v65, 2, 5
    s_mov_b32 s31, 4194304
cs_kvw:
    buffer_load_dword v77, v78, s[4:7], s96 offen offset:16 sc1
    s_waitcnt vmcnt(0)
    v_subrev_u32 v77, s95, v77
    v_cmp_lt_u32 vcc, 16, v77
    s_nop 1
    v_cndmask_b32 v77, v77, 0, vcc
    v_bfe_u32 v79, v78, 2, 2
    v_lshl_add_u32 v77, v77, 2, v79
    s_nop 1
    v_min_u32_dpp v77, v77, v77 row_ror:1 row_mask:0xf bank_mask:0xf
    s_nop 1
    v_min_u32_dpp v77, v77, v77 row_ror:2 row_mask:0xf bank_mask:0xf
    s_nop 1
    v_min_u32_dpp v77, v77, v77 row_ror:4 row_mask:0xf bank_mask:0xf
    s_nop 0
    v_readfirstlane_b32 s97, v77
    s_sub_u32 s31, s31, 1
    s_cbranch_scc1 cs_kvw_x
    s_cmp_le_u32 s40, s97
    s_cbranch_scc1 cs_kvw_x
    s_sleep 2
    s_branch cs_kvw
cs_kvw_x:
    s_branch cs_kvok
cs_last:
    s_add_u32 s40, s95, 64
    v_mov_b32 v78, s40
    s_waitcnt vmcnt(0)
    s_barrier
    s_mov_b64 exec, s[100:101]
    buffer_store_dword v78, off, s[4:7], s29 sc1
    s_mov_b64 exec, -1
cs_end:
    s_endpgm
L_xform:
    v_and_b32 v1, 63, v0
    v_and_b32 v2, 15, v1
    v_lshrrev_b32 v3, 4, v1
    v_mov_b32 v7, 0x05040100
    v_mov_b32 v8, 0x07060302
    v_lshrrev_b32 v9, 6, v0
    v_lshlrev_b32 v9, 14, v9
    v_lshlrev_b32 v10, 4, v1
    v_add_u32 v11, v9, v10
    s_mov_b32 s10, 4718592
    s_mov_b32 s11, 0x20000
    s_mov_b64 s[8:9], s[58:59]
xf_f:
    s_sub_u32 s17, s16, 1504
    s_and_b32 s18, s17, 127
    s_lshr_b32 s17, s17, 7
    s_lshl_b32 s19, s17, 4
    v_add_u32 v6, s19, v2
    v_mul_u32_u24 v4, 9216, v3
    v_lshl_add_u32 v4, v6, 4, v4
    v_lshrrev_b32 v5, 2, v2
    v_lshlrev_b32 v5, 11, v5
    v_lshl_add_u32 v5, v3, 8, v5
    v_and_b32 v1, 3, v6
    v_lshl_add_u32 v5, v1, 6, v5
    v_add_u32 v5, v5, v9
    v_cmp_gt_u32 vcc, 72, v6
    s_nop 0
    s_mov_b64 exec, vcc
    s_mul_i32 s20, s18, 36864
    s_add_u32 s21, s20, 0
    buffer_load_dwordx4 v[12:15], v4, s[8:11], s21 offen
    s_add_u32 s21, s20, 1152
    buffer_load_dwordx4 v[16:19], v4, s[8:11], s21 offen
    s_add_u32 s21, s20, 2304
    buffer_load_dwordx4 v[20:23], v4, s[8:11], s21 offen
    s_add_u32 s21, s20, 3456
    buffer_load_dwordx4 v[24:27], v4, s[8:11], s21 offen
    s_add_u32 s21, s20, 4608
    buffer_load_dwordx4 v[28:31], v4, s[8:11], s21 offen
    s_add_u32 s21, s20, 5760
    buffer_load_dwordx4 v[32:35], v4, s[8:11], s21 offen
    s_add_u32 s21, s20, 6912
    buffer_load_dwordx4 v[36:39], v4, s[8:11], s21 offen
    s_add_u32 s21, s20, 8064
    buffer_load_dwordx4 v[40:43], v4, s[8:11], s21 offen
    s_lshl_b32 s20, s18, 11
    s_add_u32 s20, s20, 130023424
    s_waitcnt vmcnt(0)
    v_perm_b32 v76, v16, v12, v7
    v_perm_b32 v77, v24, v20, v7
    v_perm_b32 v78, v32, v28, v7
    v_perm_b32 v79, v40, v36, v7
    ds_write_b128 v5, v[76:79] offset:0
    v_perm_b32 v80, v17, v13, v7
    v_perm_b32 v81, v25, v21, v7
    v_perm_b32 v82, v33, v29, v7
    v_perm_b32 v83, v41, v37, v7
    ds_write_b128 v5, v[80:83] offset:16
    v_perm_b32 v84, v18, v14, v7
    v_perm_b32 v85, v26, v22, v7
    v_perm_b32 v86, v34, v30, v7
    v_perm_b32 v87, v42, v38, v7
    ds_write_b128 v5, v[84:87] offset:32
    v_perm_b32 v88, v19, v15, v7
    v_perm_b32 v89, v27, v23, v7
    v_perm_b32 v90, v35, v31, v7
    v_perm_b32 v91, v43, v39, v7
    ds_write_b128 v5, v[88:91] offset:48
    v_perm_b32 v92, v16, v12, v8
    v_perm_b32 v93, v24, v20, v8
    v_perm_b32 v94, v32, v28, v8
    v_perm_b32 v95, v40, v36, v8
    ds_write_b128 v5, v[92:95] offset:1024
    v_perm_b32 v96, v17, v13, v8
    v_perm_b32 v97, v25, v21, v8
    v_perm_b32 v98, v33, v29, v8
    v_perm_b32 v99, v41, v37, v8
    ds_write_b128 v5, v[96:99] offset:1040
    v_perm_b32 v100, v18, v14, v8
    v_perm_b32 v101, v26, v22, v8
    v_perm_b32 v102, v34, v30, v8
    v_perm_b32 v103, v42, v38, v8
    ds_write_b128 v5, v[100:103] offset:1056
    v_perm_b32 v104, v19, v15, v8
    v_perm_b32 v105, v27, v23, v8
    v_perm_b32 v106, v35, v31, v8
    v_perm_b32 v107, v43, v39, v8
    ds_write_b128 v5, v[104:107] offset:1072
    s_mov_b64 exec, -1
    s_lshl_b32 s21, s17, 20
    s_add_u32 s20, s20, s21
    s_waitcnt lgkmcnt(0)
    ds_read_b128 v[76:79], v11 offset:0
    ds_read_b128 v[80:83], v11 offset:1024
    ds_read_b128 v[84:87], v11 offset:2048
    ds_read_b128 v[88:91], v11 offset:3072
    ds_read_b128 v[92:95], v11 offset:4096
    ds_read_b128 v[96:99], v11 offset:5120
    ds_read_b128 v[100:103], v11 offset:6144
    ds_read_b128 v[104:107], v11 offset:7168
    s_add_u32 s19, s20, 0
    s_waitcnt lgkmcnt(7)
    buffer_store_dwordx4 v[76:79], v10, s[4:7], s19 offen sc1
    s_add_u32 s19, s20, 1024
    s_waitcnt lgkmcnt(6)
    buffer_store_dwordx4 v[80:83], v10, s[4:7], s19 offen sc1
    s_add_u32 s19, s20, 262144
    s_waitcnt lgkmcnt(5)
    buffer_store_dwordx4 v[84:87], v10, s[4:7], s19 offen sc1
    s_add_u32 s19, s20, 263168
    s_waitcnt lgkmcnt(4)
    buffer_store_dwordx4 v[88:91], v10, s[4:7], s19 offen sc1
    s_add_u32 s19, s20, 524288
    s_waitcnt lgkmcnt(3)
    buffer_store_dwordx4 v[92:95], v10, s[4:7], s19 offen sc1
    s_add_u32 s19, s20, 525312
    s_waitcnt lgkmcnt(2)
    buffer_store_dwordx4 v[96:99], v10, s[4:7], s19 offen sc1
    s_add_u32 s19, s20, 786432
    s_waitcnt lgkmcnt(1)
    buffer_store_dwordx4 v[100:103], v10, s[4:7], s19 offen sc1
    s_add_u32 s19, s20, 787456
    s_waitcnt lgkmcnt(0)
    buffer_store_dwordx4 v[104:107], v10, s[4:7], s19 offen sc1
xf_done:
    s_nop 1
    s_setpc_b64 s[46:47]
L_helper:
    s_load_dwordx16 s[64:79], s[0:1], 64
    s_waitcnt lgkmcnt(0)
    s_mov_b32 s93, 1000
    s_mov_b32 s95, 0
    s_cmp_lg_u32 s3, 2
    s_cbranch_scc1 L_qkv_next
    s_mov_b32 s37, 24
    v_mov_b32 v250, 1
    v_mov_b32 v251, 163832
    v_cmp_eq_u32 vcc, 0, v0
    s_nop 0
    s_and_saveexec_b64 s[38:39], vcc
    s_cbranch_execz tk3
    buffer_atomic_add v250, off, s[84:87], s37 sc0
    s_waitcnt vmcnt(0)
    ds_write_b32 v251, v250
    s_waitcnt lgkmcnt(0)
tk3:
    s_mov_b64 exec, -1
    s_barrier
    ds_read_b32 v252, v251
    s_waitcnt lgkmcnt(0)
    v_readfirstlane_b32 s36, v252
    s_barrier
    s_nop 3
    s_cmp_ge_u32 s36, 32
    s_cbranch_scc1 L_qkv_next
    s_mov_b32 s93, 0
    s_mov_b32 s88, 4194304
gn4:
    buffer_load_dword v250, off, s[84:87], 0 offset:216 sc1
    s_waitcnt vmcnt(0)
    v_readfirstlane_b32 s95, v250
    s_sub_u32 s88, s88, 1
    s_cbranch_scc1 gn4x
    s_cmp_eq_u32 s95, 0
    s_cbranch_scc1 gn4
gn4x:
    s_cmp_eq_u32 s36, 0
    s_cbranch_scc1 L_relay
    s_branch L_wf_next
L_qkv_next:
    s_mov_b32 s37, 4
    v_mov_b32 v250, 1
    v_mov_b32 v251, 163832
    v_cmp_eq_u32 vcc, 0, v0
    s_nop 0
    s_and_saveexec_b64 s[38:39], vcc
    s_cbranch_execz tk5
    buffer_atomic_add v250, off, s[84:87], s37 sc0
    s_waitcnt vmcnt(0)
    ds_write_b32 v251, v250
    s_waitcnt lgkmcnt(0)
tk5:
    s_mov_b64 exec, -1
    s_barrier
    ds_read_b32 v252, v251
    s_waitcnt lgkmcnt(0)
    v_readfirstlane_b32 s36, v252
    s_barrier
    s_nop 3
    s_or_b32 s37, s36, s32
    s_cbranch_scc1 L_non
    s_memrealtime s[90:91]
    s_waitcnt lgkmcnt(0)
    s_lshl_b32 s90, s90, 8
    s_or_b32 s90, s90, 1
    v_mov_b32 v250, s90
    s_mov_b64 exec, 1
    buffer_store_dword v250, off, s[84:87], 0 offset:216 sc1
    s_mov_b64 exec, -1
L_non:
    s_cmp_lt_u32 s36, 192
    s_cbranch_scc1 L_qkv
    s_cmp_lg_u32 s95, 0
    s_cbranch_scc1 L_hn
    s_mov_b32 s88, 4194304
gn6:
    buffer_load_dword v250, off, s[84:87], 0 offset:216 sc1
    s_waitcnt vmcnt(0)
    v_readfirstlane_b32 s95, v250
    s_sub_u32 s88, s88, 1
    s_cbranch_scc1 gn6x
    s_cmp_eq_u32 s95, 0
    s_cbranch_scc1 gn6
gn6x:
L_hn:
    s_sub_u32 s45, s36, 192
    s_cmp_lg_u32 s36, 192
    s_cbranch_scc1 L_phase2
    s_mov_b32 s37, 24
    v_mov_b32 v250, 1
    v_mov_b32 v251, 163832
    v_cmp_eq_u32 vcc, 0, v0
    s_nop 0
    s_and_saveexec_b64 s[38:39], vcc
    s_cbranch_execz tk7
    buffer_atomic_add v250, off, s[84:87], s37 sc0
    s_waitcnt vmcnt(0)
    ds_write_b32 v251, v250
    s_waitcnt lgkmcnt(0)
tk7:
    s_mov_b64 exec, -1
    s_barrier
    ds_read_b32 v252, v251
    s_waitcnt lgkmcnt(0)
    v_readfirstlane_b32 s36, v252
    s_barrier
    s_nop 3
    s_cmp_lg_u32 s36, 0
    s_cbranch_scc1 L_phase2
L_relay:
    s_cmp_lg_u32 s32, 0
    s_cbranch_scc1 L_exit
    v_and_b32 v3, 31, v0
    v_lshlrev_b32 v3, 7, v3
    s_mov_b32 s17, 0
    s_mov_b32 s23, 125845504
    s_mov_b32 s24, 125853696
    s_mov_b32 s21, 16777216
rl_rwait:
    buffer_load_dword v4, v3, s[4:7], s23 offen sc1
    s_waitcnt vmcnt(0)
    v_subrev_u32 v4, s95, v4
    v_cmp_lt_u32 vcc, 64, v4
    s_nop 1
    v_cndmask_b32 v4, v4, 0, vcc
    s_nop 1
    v_min_u32_dpp v4, v4, v4 row_ror:1 row_mask:0xf bank_mask:0xf
    s_nop 1
    v_min_u32_dpp v4, v4, v4 row_ror:2 row_mask:0xf bank_mask:0xf
    s_nop 1
    v_min_u32_dpp v4, v4, v4 row_ror:4 row_mask:0xf bank_mask:0xf
    s_nop 1
    v_min_u32_dpp v4, v4, v4 row_ror:8 row_mask:0xf bank_mask:0xf
    s_nop 0
    v_readlane_b32 s16, v4, 0
    v_readlane_b32 s22, v4, 16
    s_nop 0
    s_min_u32 s16, s16, s22
    s_sub_u32 s21, s21, 1
    s_cbranch_scc1 rl_x
    s_cmp_gt_u32 s16, s17
    s_cbranch_scc1 rl_rpub
    s_sleep 2
    s_branch rl_rwait
rl_rpub:
    s_mov_b32 s17, s16
    s_add_u32 s22, s16, s95
    v_mov_b32 v4, s22
    s_mov_b64 exec, 1
    buffer_store_dword v4, off, s[4:7], s24 sc1
    s_mov_b64 exec, -1
    s_cmp_lt_u32 s16, 64
    s_cbranch_scc1 rl_rwait
rl_x:
    s_endpgm
L_qkv:
    s_sub_u32 s33, s36, 32
    s_and_b32 s17, s36, 15
    s_lshl_b32 s17, s17, 1
    s_lshr_b32 s36, s36, 4
    s_and_b32 s16, s36, 1
    s_add_u32 s16, s16, 1
    s_lshr_b32 s19, s36, 1
    s_and_b32 s37, s36, 3
    s_cmp_ge_u32 s36, 8
    s_cselect_b32 s16, 0, s16
    s_cselect_b32 s19, s37, s19
    v_lshrrev_b32 v4, 6, v0
    s_nop 0
    v_readfirstlane_b32 s18, v4
    v_lshlrev_b32 v7, 4, v0
    s_cmp_eq_u32 s16, 1
    s_cselect_b64 s[12:13], s[54:55], s[52:53]
    s_cmp_eq_u32 s16, 2
    s_cselect_b64 s[12:13], s[56:57], s[12:13]
    s_mov_b32 s14, 4718592
    s_mov_b32 s15, 0x20000
    v_bfe_u32 v4, v0, 5, 1
    v_lshlrev_b32 v5, 2, v4
    v_and_b32 v8, 31, v0
    v_xor_b32 v8, v8, v5
    v_lshlrev_b32 v8, 4, v8
    v_lshl_add_u32 v8, v4, 13, v8
    v_xor_b32 v9, 128, v8
    s_lshl_b32 s21, s17, 8
    s_lshl_b32 s42, s18, 16
    s_add_u32 s42, s42, s21
    s_lshl_b32 s44, s18, 12
    s_barrier
    s_add_u32 m0, s44, 73728
    s_add_u32 s22, s42, 0
    buffer_load_dwordx4 v8, s[12:15], s22 offen offset:0 lds
    s_add_u32 s22, s42, 15360
    buffer_load_dwordx4 v9, s[12:15], s22 offen offset:1024 lds
    s_add_u32 s22, s42, 30720
    buffer_load_dwordx4 v8, s[12:15], s22 offen offset:2048 lds
    s_add_u32 s22, s42, 46080
    buffer_load_dwordx4 v9, s[12:15], s22 offen offset:3072 lds
    s_add_u32 m0, s44, 90112
    s_add_u32 s22, s42, 262144
    buffer_load_dwordx4 v8, s[12:15], s22 offen offset:0 lds
    s_add_u32 s22, s42, 277504
    buffer_load_dwordx4 v9, s[12:15], s22 offen offset:1024 lds
    s_add_u32 s22, s42, 292864
    buffer_load_dwordx4 v8, s[12:15], s22 offen offset:2048 lds
    s_add_u32 s22, s42, 308224
    buffer_load_dwordx4 v9, s[12:15], s22 offen offset:3072 lds
    s_add_u32 m0, s44, 106496
    s_add_u32 s22, s42, 524288
    buffer_load_dwordx4 v8, s[12:15], s22 offen offset:0 lds
    s_add_u32 s22, s42, 539648
    buffer_load_dwordx4 v9, s[12:15], s22 offen offset:1024 lds
    s_add_u32 s22, s42, 555008
    buffer_load_dwordx4 v8, s[12:15], s22 offen offset:2048 lds
    s_add_u32 s22, s42, 570368
    buffer_load_dwordx4 v9, s[12:15], s22 offen offset:3072 lds
    s_add_u32 m0, s44, 122880
    s_add_u32 s22, s42, 786432
    buffer_load_dwordx4 v8, s[12:15], s22 offen offset:0 lds
    s_add_u32 s22, s42, 801792
    buffer_load_dwordx4 v9, s[12:15], s22 offen offset:1024 lds
    s_add_u32 s22, s42, 817152
    buffer_load_dwordx4 v8, s[12:15], s22 offen offset:2048 lds
    s_add_u32 s22, s42, 832512
    buffer_load_dwordx4 v9, s[12:15], s22 offen offset:3072 lds
    v_bfe_u32 v4, v0, 2, 2
    v_xor_b32 v5, s18, v4
    v_lshlrev_b32 v10, 6, v5
    v_lshl_add_u32 v10, v4, 9, v10
    v_and_b32 v4, 3, v0
    v_lshl_add_u32 v10, v4, 4, v10
    v_bfe_u32 v4, v0, 4, 2
    v_lshl_add_u32 v10, v4, 12, v10
    v_add_u32 v10, 73728, v10
    v_add_u32 v11, 49152, v10
    v_and_b32 v4, 63, v0
    v_and_b32 v5, 15, v4
    v_lshrrev_b32 v3, 4, v4
    v_lshrrev_b32 v2, 2, v5
    v_xor_b32 v3, v3, v2
    v_lshl_add_u32 v3, v5, 2, v3
    v_lshlrev_b32 v1, 4, v3
    v_lshrrev_b32 v5, 2, v4
    v_lshrrev_b32 v3, 4, v4
    v_and_b32 v4, 3, v4
    v_xor_b32 v4, v4, v3
    v_lshlrev_b32 v3, 3, v3
    v_and_b32 v5, 3, v5
    v_add_u32 v3, v3, v5
    v_mul_u32_u24 v2, 1152, v3
    v_lshl_add_u32 v2, v4, 4, v2
    s_mov_b32 s8, s48
    s_mov_b32 s9, s49
    s_mov_b32 s10, 2359296
    s_mov_b32 s11, 0x20000
    s_lshr_b32 s22, s18, 1
    s_mul_i32 s24, s22, 4608
    s_mul_i32 s25, s22, 18432
    s_and_b32 s22, s18, 1
    s_mul_i32 s23, s22, 576
    s_add_u32 s24, s24, s23
    s_mul_i32 s25, s18, 9216
    s_mul_i32 s22, s19, 36864
    s_add_u32 s24, s24, s22
    s_mov_b32 s20, 64
    s_lshl_b32 s22, s19, 5
    s_add_u32 s22, s22, s17
    s_lshl_b32 s26, s22, 14
    s_mul_i32 s23, s18, 3072
    s_add_u32 s26, s26, s23
    s_lshl_b32 s23, s16, 11
    s_add_u32 s26, s26, s23
    s_add_u32 s26, s26, -2048
    s_lshl_b32 s22, s22, 13
    s_add_u32 s22, s22, 33554432
    s_cmp_eq_u32 s16, 0
    s_cselect_b32 s26, s22, s26
    s_cselect_b32 s40, 4096, 64
    s_cselect_b32 s41, 1, 2
    s_max_u32 s40, s40, 1024
    s_lshl_b32 s41, s41, 18
    s_lshl_b32 s29, s17, 7
    s_lshl_b32 s22, s16, 4
    s_add_u32 s29, s29, s22
    s_lshl_b32 s22, s19, 2
    s_add_u32 s29, s29, s22
    s_add_u32 s29, s29, 125829120
    s_mov_b32 s27, 0
    s_add_u32 s23, s27, s25
    s_add_u32 m0, s23, 0
    s_nop 0
    buffer_load_dwordx4 v2, s[8:11], s24 offen offset:0 lds
    s_add_u32 m0, s23, 960
    s_nop 0
    buffer_load_dwordx4 v2, s[8:11], s24 offen offset:64 lds
    s_add_u32 m0, s23, 1920
    s_nop 0
    buffer_load_dwordx4 v2, s[8:11], s24 offen offset:128 lds
    s_add_u32 m0, s23, 2880
    s_nop 0
    buffer_load_dwordx4 v2, s[8:11], s24 offen offset:192 lds
    s_add_u32 m0, s23, 3840
    s_nop 0
    buffer_load_dwordx4 v2, s[8:11], s24 offen offset:256 lds
    s_add_u32 m0, s23, 4800
    s_nop 0
    buffer_load_dwordx4 v2, s[8:11], s24 offen offset:320 lds
    s_add_u32 m0, s23, 5760
    s_nop 0
    buffer_load_dwordx4 v2, s[8:11], s24 offen offset:384 lds
    s_add_u32 m0, s23, 6720
    s_nop 0
    buffer_load_dwordx4 v2, s[8:11], s24 offen offset:448 lds
    s_add_u32 m0, s23, 7680
    s_nop 0
    buffer_load_dwordx4 v2, s[8:11], s24 offen offset:512 lds
    s_add_u32 s24, s24, 147456
    s_waitcnt vmcnt(21) lgkmcnt(0)
    s_barrier
    s_add_u32 m0, s44, 139264
    s_add_u32 s22, s42, 1048576
    buffer_load_dwordx4 v8, s[12:15], s22 offen offset:0 lds
    s_add_u32 s22, s42, 1063936
    buffer_load_dwordx4 v9, s[12:15], s22 offen offset:1024 lds
    s_add_u32 s22, s42, 1079296
    buffer_load_dwordx4 v8, s[12:15], s22 offen offset:2048 lds
    s_add_u32 s22, s42, 1094656
    buffer_load_dwordx4 v9, s[12:15], s22 offen offset:3072 lds
    ds_read_b64_tr_b16 v[64:65], v10 offset:0
    ds_read_b64_tr_b16 v[66:67], v10 offset:2048
    ds_read_b64_tr_b16 v[136:137], v10 offset:8
    ds_read_b64_tr_b16 v[138:139], v10 offset:2056
    ds_read_b64_tr_b16 a[0:1], v10 offset:256
    ds_read_b64_tr_b16 a[2:3], v10 offset:2304
    ds_read_b64_tr_b16 a[72:73], v10 offset:264
    ds_read_b64_tr_b16 a[74:75], v10 offset:2312
    s_waitcnt vmcnt(21) lgkmcnt(0)
    s_barrier
    s_add_u32 m0, s44, 73728
    s_add_u32 s22, s42, 1310720
    buffer_load_dwordx4 v8, s[12:15], s22 offen offset:0 lds
    s_add_u32 s22, s42, 1326080
    buffer_load_dwordx4 v9, s[12:15], s22 offen offset:1024 lds
    s_add_u32 s22, s42, 1341440
    buffer_load_dwordx4 v8, s[12:15], s22 offen offset:2048 lds
    s_add_u32 s22, s42, 1356800
    buffer_load_dwordx4 v9, s[12:15], s22 offen offset:3072 lds
    ds_read_b64_tr_b16 v[68:69], v10 offset:16384
    ds_read_b64_tr_b16 v[70:71], v10 offset:18432
    ds_read_b64_tr_b16 v[140:141], v10 offset:16392
    ds_read_b64_tr_b16 v[142:143], v10 offset:18440
    ds_read_b64_tr_b16 a[4:5], v10 offset:16640
    ds_read_b64_tr_b16 a[6:7], v10 offset:18688
    ds_read_b64_tr_b16 a[76:77], v10 offset:16648
    ds_read_b64_tr_b16 a[78:79], v10 offset:18696
    s_waitcnt vmcnt(21) lgkmcnt(0)
    s_barrier
    s_add_u32 m0, s44, 90112
    s_add_u32 s22, s42, 1572864
    buffer_load_dwordx4 v8, s[12:15], s22 offen offset:0 lds
    s_add_u32 s22, s42, 1588224
    buffer_load_dwordx4 v9, s[12:15], s22 offen offset:1024 lds
    s_add_u32 s22, s42, 1603584
    buffer_load_dwordx4 v8, s[12:15], s22 offen offset:2048 lds
    s_add_u32 s22, s42, 1618944
    buffer_load_dwordx4 v9, s[12:15], s22 offen offset:3072 lds
    ds_read_b64_tr_b16 v[72:73], v10 offset:32768
    ds_read_b64_tr_b16 v[74:75], v10 offset:34816
    ds_read_b64_tr_b16 v[144:145], v10 offset:32776
    ds_read_b64_tr_b16 v[146:147], v10 offset:34824
    ds_read_b64_tr_b16 a[8:9], v10 offset:33024
    ds_read_b64_tr_b16 a[10:11], v10 offset:35072
    ds_read_b64_tr_b16 a[80:81], v10 offset:33032
    ds_read_b64_tr_b16 a[82:83], v10 offset:35080
    s_waitcnt vmcnt(21) lgkmcnt(0)
    s_barrier
    s_add_u32 m0, s44, 106496
    s_add_u32 s22, s42, 1835008
    buffer_load_dwordx4 v8, s[12:15], s22 offen offset:0 lds
    s_add_u32 s22, s42, 1850368
    buffer_load_dwordx4 v9, s[12:15], s22 offen offset:1024 lds
    s_add_u32 s22, s42, 1865728
    buffer_load_dwordx4 v8, s[12:15], s22 offen offset:2048 lds
    s_add_u32 s22, s42, 1881088
    buffer_load_dwordx4 v9, s[12:15], s22 offen offset:3072 lds
    ds_read_b64_tr_b16 v[76:77], v11 offset:0
    ds_read_b64_tr_b16 v[78:79], v11 offset:2048
    ds_read_b64_tr_b16 v[148:149], v11 offset:8
    ds_read_b64_tr_b16 v[150:151], v11 offset:2056
    ds_read_b64_tr_b16 a[12:13], v11 offset:256
    ds_read_b64_tr_b16 a[14:15], v11 offset:2304
    ds_read_b64_tr_b16 a[84:85], v11 offset:264
    ds_read_b64_tr_b16 a[86:87], v11 offset:2312
    s_waitcnt vmcnt(12) lgkmcnt(0)
    s_barrier
    s_add_u32 m0, s44, 122880
    s_add_u32 s22, s42, 2097152
    buffer_load_dwordx4 v8, s[12:15], s22 offen offset:0 lds
    s_add_u32 s22, s42, 2112512
    buffer_load_dwordx4 v9, s[12:15], s22 offen offset:1024 lds
    s_add_u32 s22, s42, 2127872
    buffer_load_dwordx4 v8, s[12:15], s22 offen offset:2048 lds
    s_add_u32 s22, s42, 2143232
    buffer_load_dwordx4 v9, s[12:15], s22 offen offset:3072 lds
    ds_read_b64_tr_b16 v[80:81], v11 offset:16384
    ds_read_b64_tr_b16 v[82:83], v11 offset:18432
    ds_read_b64_tr_b16 v[152:153], v11 offset:16392
    ds_read_b64_tr_b16 v[154:155], v11 offset:18440
    ds_read_b64_tr_b16 a[16:17], v11 offset:16640
    ds_read_b64_tr_b16 a[18:19], v11 offset:18688
    ds_read_b64_tr_b16 a[88:89], v11 offset:16648
    ds_read_b64_tr_b16 a[90:91], v11 offset:18696
    s_waitcnt vmcnt(12) lgkmcnt(0)
    s_barrier
    s_add_u32 m0, s44, 139264
    s_add_u32 s22, s42, 2359296
    buffer_load_dwordx4 v8, s[12:15], s22 offen offset:0 lds
    s_add_u32 s22, s42, 2374656
    buffer_load_dwordx4 v9, s[12:15], s22 offen offset:1024 lds
    s_add_u32 s22, s42, 2390016
    buffer_load_dwordx4 v8, s[12:15], s22 offen offset:2048 lds
    s_add_u32 s22, s42, 2405376
    buffer_load_dwordx4 v9, s[12:15], s22 offen offset:3072 lds
    ds_read_b64_tr_b16 v[84:85], v10 offset:0
    ds_read_b64_tr_b16 v[86:87], v10 offset:2048
    ds_read_b64_tr_b16 v[156:157], v10 offset:8
    ds_read_b64_tr_b16 v[158:159], v10 offset:2056
    ds_read_b64_tr_b16 a[20:21], v10 offset:256
    ds_read_b64_tr_b16 a[22:23], v10 offset:2304
    ds_read_b64_tr_b16 a[92:93], v10 offset:264
    ds_read_b64_tr_b16 a[94:95], v10 offset:2312
    s_waitcnt vmcnt(12) lgkmcnt(0)
    s_barrier
    s_add_u32 m0, s44, 73728
    s_add_u32 s22, s42, 2621440
    buffer_load_dwordx4 v8, s[12:15], s22 offen offset:0 lds
    s_add_u32 s22, s42, 2636800
    buffer_load_dwordx4 v9, s[12:15], s22 offen offset:1024 lds
    s_add_u32 s22, s42, 2652160
    buffer_load_dwordx4 v8, s[12:15], s22 offen offset:2048 lds
    s_add_u32 s22, s42, 2667520
    buffer_load_dwordx4 v9, s[12:15], s22 offen offset:3072 lds
    ds_read_b64_tr_b16 v[88:89], v10 offset:16384
    ds_read_b64_tr_b16 v[90:91], v10 offset:18432
    ds_read_b64_tr_b16 v[160:161], v10 offset:16392
    ds_read_b64_tr_b16 v[162:163], v10 offset:18440
    ds_read_b64_tr_b16 a[24:25], v10 offset:16640
    ds_read_b64_tr_b16 a[26:27], v10 offset:18688
    ds_read_b64_tr_b16 a[96:97], v10 offset:16648
    ds_read_b64_tr_b16 a[98:99], v10 offset:18696
    s_waitcnt vmcnt(12) lgkmcnt(0)
    s_barrier
    s_add_u32 m0, s44, 90112
    s_add_u32 s22, s42, 2883584
    buffer_load_dwordx4 v8, s[12:15], s22 offen offset:0 lds
    s_add_u32 s22, s42, 2898944
    buffer_load_dwordx4 v9, s[12:15], s22 offen offset:1024 lds
    s_add_u32 s22, s42, 2914304
    buffer_load_dwordx4 v8, s[12:15], s22 offen offset:2048 lds
    s_add_u32 s22, s42, 2929664
    buffer_load_dwordx4 v9, s[12:15], s22 offen offset:3072 lds
    ds_read_b64_tr_b16 v[92:93], v10 offset:32768
    ds_read_b64_tr_b16 v[94:95], v10 offset:34816
    ds_read_b64_tr_b16 v[164:165], v10 offset:32776
    ds_read_b64_tr_b16 v[166:167], v10 offset:34824
    ds_read_b64_tr_b16 a[28:29], v10 offset:33024
    ds_read_b64_tr_b16 a[30:31], v10 offset:35072
    ds_read_b64_tr_b16 a[100:101], v10 offset:33032
    ds_read_b64_tr_b16 a[102:103], v10 offset:35080
    s_waitcnt vmcnt(12) lgkmcnt(0)
    s_barrier
    s_add_u32 m0, s44, 106496
    s_add_u32 s22, s42, 3145728
    buffer_load_dwordx4 v8, s[12:15], s22 offen offset:0 lds
    s_add_u32 s22, s42, 3161088
    buffer_load_dwordx4 v9, s[12:15], s22 offen offset:1024 lds
    s_add_u32 s22, s42, 3176448
    buffer_load_dwordx4 v8, s[12:15], s22 offen offset:2048 lds
    s_add_u32 s22, s42, 3191808
    buffer_load_dwordx4 v9, s[12:15], s22 offen offset:3072 lds
    ds_read_b64_tr_b16 v[96:97], v11 offset:0
    ds_read_b64_tr_b16 v[98:99], v11 offset:2048
    ds_read_b64_tr_b16 v[168:169], v11 offset:8
    ds_read_b64_tr_b16 v[170:171], v11 offset:2056
    ds_read_b64_tr_b16 a[32:33], v11 offset:256
    ds_read_b64_tr_b16 a[34:35], v11 offset:2304
    ds_read_b64_tr_b16 a[104:105], v11 offset:264
    ds_read_b64_tr_b16 a[106:107], v11 offset:2312
    s_waitcnt vmcnt(12) lgkmcnt(0)
    s_barrier
    s_add_u32 m0, s44, 122880
    s_add_u32 s22, s42, 3407872
    buffer_load_dwordx4 v8, s[12:15], s22 offen offset:0 lds
    s_add_u32 s22, s42, 3423232
    buffer_load_dwordx4 v9, s[12:15], s22 offen offset:1024 lds
    s_add_u32 s22, s42, 3438592
    buffer_load_dwordx4 v8, s[12:15], s22 offen offset:2048 lds
    s_add_u32 s22, s42, 3453952
    buffer_load_dwordx4 v9, s[12:15], s22 offen offset:3072 lds
    ds_read_b64_tr_b16 v[100:101], v11 offset:16384
    ds_read_b64_tr_b16 v[102:103], v11 offset:18432
    ds_read_b64_tr_b16 v[172:173], v11 offset:16392
    ds_read_b64_tr_b16 v[174:175], v11 offset:18440
    ds_read_b64_tr_b16 a[36:37], v11 offset:16640
    ds_read_b64_tr_b16 a[38:39], v11 offset:18688
    ds_read_b64_tr_b16 a[108:109], v11 offset:16648
    ds_read_b64_tr_b16 a[110:111], v11 offset:18696
    s_waitcnt vmcnt(12) lgkmcnt(0)
    s_barrier
    s_add_u32 m0, s44, 139264
    s_add_u32 s22, s42, 3670016
    buffer_load_dwordx4 v8, s[12:15], s22 offen offset:0 lds
    s_add_u32 s22, s42, 3685376
    buffer_load_dwordx4 v9, s[12:15], s22 offen offset:1024 lds
    s_add_u32 s22, s42, 3700736
    buffer_load_dwordx4 v8, s[12:15], s22 offen offset:2048 lds
    s_add_u32 s22, s42, 3716096
    buffer_load_dwordx4 v9, s[12:15], s22 offen offset:3072 lds
    ds_read_b64_tr_b16 v[104:105], v10 offset:0
    ds_read_b64_tr_b16 v[106:107], v10 offset:2048
    ds_read_b64_tr_b16 v[176:177], v10 offset:8
    ds_read_b64_tr_b16 v[178:179], v10 offset:2056
    ds_read_b64_tr_b16 a[40:41], v10 offset:256
    ds_read_b64_tr_b16 a[42:43], v10 offset:2304
    ds_read_b64_tr_b16 a[112:113], v10 offset:264
    ds_read_b64_tr_b16 a[114:115], v10 offset:2312
    s_waitcnt vmcnt(12) lgkmcnt(0)
    s_barrier
    s_add_u32 m0, s44, 73728
    s_add_u32 s22, s42, 3932160
    buffer_load_dwordx4 v8, s[12:15], s22 offen offset:0 lds
    s_add_u32 s22, s42, 3947520
    buffer_load_dwordx4 v9, s[12:15], s22 offen offset:1024 lds
    s_add_u32 s22, s42, 3962880
    buffer_load_dwordx4 v8, s[12:15], s22 offen offset:2048 lds
    s_add_u32 s22, s42, 3978240
    buffer_load_dwordx4 v9, s[12:15], s22 offen offset:3072 lds
    ds_read_b64_tr_b16 v[108:109], v10 offset:16384
    ds_read_b64_tr_b16 v[110:111], v10 offset:18432
    ds_read_b64_tr_b16 v[180:181], v10 offset:16392
    ds_read_b64_tr_b16 v[182:183], v10 offset:18440
    ds_read_b64_tr_b16 a[44:45], v10 offset:16640
    ds_read_b64_tr_b16 a[46:47], v10 offset:18688
    ds_read_b64_tr_b16 a[116:117], v10 offset:16648
    ds_read_b64_tr_b16 a[118:119], v10 offset:18696
    s_waitcnt vmcnt(12) lgkmcnt(0)
    s_barrier
    s_add_u32 m0, s44, 90112
    s_add_u32 s22, s42, 4194304
    buffer_load_dwordx4 v8, s[12:15], s22 offen offset:0 lds
    s_add_u32 s22, s42, 4209664
    buffer_load_dwordx4 v9, s[12:15], s22 offen offset:1024 lds
    s_add_u32 s22, s42, 4225024
    buffer_load_dwordx4 v8, s[12:15], s22 offen offset:2048 lds
    s_add_u32 s22, s42, 4240384
    buffer_load_dwordx4 v9, s[12:15], s22 offen offset:3072 lds
    ds_read_b64_tr_b16 v[112:113], v10 offset:32768
    ds_read_b64_tr_b16 v[114:115], v10 offset:34816
    ds_read_b64_tr_b16 v[184:185], v10 offset:32776
    ds_read_b64_tr_b16 v[186:187], v10 offset:34824
    ds_read_b64_tr_b16 a[48:49], v10 offset:33024
    ds_read_b64_tr_b16 a[50:51], v10 offset:35072
    ds_read_b64_tr_b16 a[120:121], v10 offset:33032
    ds_read_b64_tr_b16 a[122:123], v10 offset:35080
    s_waitcnt vmcnt(12) lgkmcnt(0)
    s_barrier
    s_add_u32 m0, s44, 106496
    s_add_u32 s22, s42, 4456448
    buffer_load_dwordx4 v8, s[12:15], s22 offen offset:0 lds
    s_add_u32 s22, s42, 4471808
    buffer_load_dwordx4 v9, s[12:15], s22 offen offset:1024 lds
    s_add_u32 s22, s42, 4487168
    buffer_load_dwordx4 v8, s[12:15], s22 offen offset:2048 lds
    s_add_u32 s22, s42, 4502528
    buffer_load_dwordx4 v9, s[12:15], s22 offen offset:3072 lds
    ds_read_b64_tr_b16 v[116:117], v11 offset:0
    ds_read_b64_tr_b16 v[118:119], v11 offset:2048
    ds_read_b64_tr_b16 v[188:189], v11 offset:8
    ds_read_b64_tr_b16 v[190:191], v11 offset:2056
    ds_read_b64_tr_b16 a[52:53], v11 offset:256
    ds_read_b64_tr_b16 a[54:55], v11 offset:2304
    ds_read_b64_tr_b16 a[124:125], v11 offset:264
    ds_read_b64_tr_b16 a[126:127], v11 offset:2312
    s_waitcnt vmcnt(12) lgkmcnt(0)
    s_barrier
    s_mov_b32 s27, 36864
    s_add_u32 s23, s27, s25
    s_add_u32 m0, s23, 0
    s_nop 0
    buffer_load_dwordx4 v2, s[8:11], s24 offen offset:0 lds
    s_add_u32 m0, s23, 960
    s_nop 0
    buffer_load_dwordx4 v2, s[8:11], s24 offen offset:64 lds
    s_add_u32 m0, s23, 1920
    s_nop 0
    buffer_load_dwordx4 v2, s[8:11], s24 offen offset:128 lds
    s_add_u32 m0, s23, 2880
    s_nop 0
    buffer_load_dwordx4 v2, s[8:11], s24 offen offset:192 lds
    s_add_u32 m0, s23, 3840
    s_nop 0
    buffer_load_dwordx4 v2, s[8:11], s24 offen offset:256 lds
    s_add_u32 m0, s23, 4800
    s_nop 0
    buffer_load_dwordx4 v2, s[8:11], s24 offen offset:320 lds
    s_add_u32 m0, s23, 5760
    s_nop 0
    buffer_load_dwordx4 v2, s[8:11], s24 offen offset:384 lds
    s_add_u32 m0, s23, 6720
    s_nop 0
    buffer_load_dwordx4 v2, s[8:11], s24 offen offset:448 lds
    s_add_u32 m0, s23, 7680
    s_nop 0
    buffer_load_dwordx4 v2, s[8:11], s24 offen offset:512 lds
    s_add_u32 s24, s24, 147456
    ds_read_b64_tr_b16 v[120:121], v11 offset:16384
    ds_read_b64_tr_b16 v[122:123], v11 offset:18432
    ds_read_b64_tr_b16 v[192:193], v11 offset:16392
    ds_read_b64_tr_b16 v[194:195], v11 offset:18440
    ds_read_b64_tr_b16 a[56:57], v11 offset:16640
    ds_read_b64_tr_b16 a[58:59], v11 offset:18688
    ds_read_b64_tr_b16 a[128:129], v11 offset:16648
    ds_read_b64_tr_b16 a[130:131], v11 offset:18696
    s_waitcnt vmcnt(17) lgkmcnt(0)
    s_barrier
    ds_read_b64_tr_b16 v[124:125], v10 offset:0
    ds_read_b64_tr_b16 v[126:127], v10 offset:2048
    ds_read_b64_tr_b16 v[196:197], v10 offset:8
    ds_read_b64_tr_b16 v[198:199], v10 offset:2056
    ds_read_b64_tr_b16 a[60:61], v10 offset:256
    ds_read_b64_tr_b16 a[62:63], v10 offset:2304
    ds_read_b64_tr_b16 a[132:133], v10 offset:264
    ds_read_b64_tr_b16 a[134:135], v10 offset:2312
    s_waitcnt vmcnt(13) lgkmcnt(0)
    s_barrier
    ds_read_b64_tr_b16 v[128:129], v10 offset:16384
    ds_read_b64_tr_b16 v[130:131], v10 offset:18432
    ds_read_b64_tr_b16 v[200:201], v10 offset:16392
    ds_read_b64_tr_b16 v[202:203], v10 offset:18440
    ds_read_b64_tr_b16 a[64:65], v10 offset:16640
    ds_read_b64_tr_b16 a[66:67], v10 offset:18688
    ds_read_b64_tr_b16 a[136:137], v10 offset:16648
    ds_read_b64_tr_b16 a[138:139], v10 offset:18696
    s_waitcnt vmcnt(9) lgkmcnt(0)
    s_barrier
    ds_read_b64_tr_b16 v[132:133], v10 offset:32768
    ds_read_b64_tr_b16 v[134:135], v10 offset:34816
    ds_read_b64_tr_b16 v[204:205], v10 offset:32776
    ds_read_b64_tr_b16 v[206:207], v10 offset:34824
    ds_read_b64_tr_b16 a[68:69], v10 offset:33024
    ds_read_b64_tr_b16 a[70:71], v10 offset:35072
    ds_read_b64_tr_b16 a[140:141], v10 offset:33032
    ds_read_b64_tr_b16 a[142:143], v10 offset:35080
    s_mov_b32 s88, 4194304
gn8:
    buffer_load_dword v250, off, s[84:87], 0 offset:216 sc1
    s_waitcnt vmcnt(0)
    v_readfirstlane_b32 s95, v250
    s_sub_u32 s88, s88, 1
    s_cbranch_scc1 gn8x
    s_cmp_eq_u32 s95, 0
    s_cbranch_scc1 gn8
gn8x:
    s_waitcnt lgkmcnt(0)
    s_mov_b32 s45, 0
    s_mov_b32 s27, 0
    s_mov_b64 s[36:37], 0
    s_mov_b32 s12, 0
    s_mov_b32 s13, s40
    s_lshr_b32 s14, s41, 5
    s_add_u32 s15, s14, s40
    s_lshl_b32 s41, s41, 2
    s_sub_u32 s26, s26, s41
    v_mov_b32 v3, v1
    s_waitcnt vmcnt(0)
    s_barrier
    ds_read_b128 v[32:35], v3 offset:0
    ds_read_b128 v[36:39], v3 offset:18432
    ds_read_b128 v[40:43], v3 offset:1024
    ds_read_b128 v[44:47], v3 offset:19456
    s_cmp_eq_u32 s18, 0
    s_cselect_b32 s34, 1, 0
    s_mov_b32 s35, 0
    s_cmp_eq_u32 s16, 2
    s_cbranch_scc1 qk_vloop
qk_loop:
    s_barrier
    s_add_u32 s22, s27, 73728
    s_sub_u32 s21, s22, 110592
    s_cselect_b32 s22, s22, s21
    s_waitcnt lgkmcnt(2)
    v_mfma_f32_16x16x32_bf16 v[208:211], v[64:67], v[32:35], 0
    ds_read_b128 v[48:51], v3 offset:2048
    v_mfma_f32_16x16x32_bf16 v[212:215], v[136:139], v[32:35], 0
    ds_read_b128 v[52:55], v3 offset:20480
    v_mfma_f32_16x16x32_bf16 v[216:219], v[64:67], v[36:39], 0
    v_mfma_f32_16x16x32_bf16 v[220:223], v[136:139], v[36:39], 0
    v_mfma_f32_16x16x32_bf16 v[224:227], a[0:3], v[32:35], 0
    v_mfma_f32_16x16x32_bf16 v[228:231], a[72:75], v[32:35], 0
    v_mfma_f32_16x16x32_bf16 v[232:235], a[0:3], v[36:39], 0
    v_mfma_f32_16x16x32_bf16 v[236:239], a[72:75], v[36:39], 0
    s_waitcnt lgkmcnt(2)
    v_mfma_f32_16x16x32_bf16 v[208:211], v[68:71], v[40:43], v[208:211]
    ds_read_b128 v[32:35], v3 offset:3072
    v_mfma_f32_16x16x32_bf16 v[212:215], v[140:143], v[40:43], v[212:215]
    ds_read_b128 v[36:39], v3 offset:21504
    v_mfma_f32_16x16x32_bf16 v[216:219], v[68:71], v[44:47], v[216:219]
    s_add_u32 s23, s22, s25
    s_add_u32 m0, s23, 0
    s_nop 0
    buffer_load_dwordx4 v2, s[8:11], s24 offen offset:0 lds
    v_mfma_f32_16x16x32_bf16 v[220:223], v[140:143], v[44:47], v[220:223]
    v_mfma_f32_16x16x32_bf16 v[224:227], a[4:7], v[40:43], v[224:227]
    v_mfma_f32_16x16x32_bf16 v[228:231], a[76:79], v[40:43], v[228:231]
    v_mfma_f32_16x16x32_bf16 v[232:235], a[4:7], v[44:47], v[232:235]
    s_add_u32 m0, s23, 960
    s_nop 0
    buffer_load_dwordx4 v2, s[8:11], s24 offen offset:64 lds
    v_mfma_f32_16x16x32_bf16 v[236:239], a[76:79], v[44:47], v[236:239]
    s_waitcnt lgkmcnt(2)
    v_mfma_f32_16x16x32_bf16 v[208:211], v[72:75], v[48:51], v[208:211]
    ds_read_b128 v[40:43], v3 offset:4096
    v_mfma_f32_16x16x32_bf16 v[212:215], v[144:147], v[48:51], v[212:215]
    ds_read_b128 v[44:47], v3 offset:22528
    v_mfma_f32_16x16x32_bf16 v[216:219], v[72:75], v[52:55], v[216:219]
    s_add_u32 m0, s23, 1920
    s_nop 0
    buffer_load_dwordx4 v2, s[8:11], s24 offen offset:128 lds
    v_mfma_f32_16x16x32_bf16 v[220:223], v[144:147], v[52:55], v[220:223]
    v_mfma_f32_16x16x32_bf16 v[224:227], a[8:11], v[48:51], v[224:227]
    v_mfma_f32_16x16x32_bf16 v[228:231], a[80:83], v[48:51], v[228:231]
    v_mfma_f32_16x16x32_bf16 v[232:235], a[8:11], v[52:55], v[232:235]
    s_add_u32 m0, s23, 2880
    s_nop 0
    buffer_load_dwordx4 v2, s[8:11], s24 offen offset:192 lds
    v_mfma_f32_16x16x32_bf16 v[236:239], a[80:83], v[52:55], v[236:239]
    s_waitcnt lgkmcnt(2)
    v_mfma_f32_16x16x32_bf16 v[208:211], v[76:79], v[32:35], v[208:211]
    ds_read_b128 v[48:51], v3 offset:5120
    v_mfma_f32_16x16x32_bf16 v[212:215], v[148:151], v[32:35], v[212:215]
    ds_read_b128 v[52:55], v3 offset:23552
    v_mfma_f32_16x16x32_bf16 v[216:219], v[76:79], v[36:39], v[216:219]
    s_add_u32 m0, s23, 3840
    s_nop 0
    buffer_load_dwordx4 v2, s[8:11], s24 offen offset:256 lds
    v_mfma_f32_16x16x32_bf16 v[220:223], v[148:151], v[36:39], v[220:223]
    v_mfma_f32_16x16x32_bf16 v[224:227], a[12:15], v[32:35], v[224:227]
    v_mfma_f32_16x16x32_bf16 v[228:231], a[84:87], v[32:35], v[228:231]
    v_mfma_f32_16x16x32_bf16 v[232:235], a[12:15], v[36:39], v[232:235]
    s_add_u32 m0, s23, 4800
    s_nop 0
    buffer_load_dwordx4 v2, s[8:11], s24 offen offset:320 lds
    v_mfma_f32_16x16x32_bf16 v[236:239], a[84:87], v[36:39], v[236:239]
    s_waitcnt lgkmcnt(2)
    v_mfma_f32_16x16x32_bf16 v[208:211], v[80:83], v[40:43], v[208:211]
    ds_read_b128 v[32:35], v3 offset:6144
    v_mfma_f32_16x16x32_bf16 v[212:215], v[152:155], v[40:43], v[212:215]
    ds_read_b128 v[36:39], v3 offset:24576
    v_mfma_f32_16x16x32_bf16 v[216:219], v[80:83], v[44:47], v[216:219]
    s_add_u32 m0, s23, 5760
    s_nop 0
    buffer_load_dwordx4 v2, s[8:11], s24 offen offset:384 lds
    v_mfma_f32_16x16x32_bf16 v[220:223], v[152:155], v[44:47], v[220:223]
    v_mfma_f32_16x16x32_bf16 v[224:227], a[16:19], v[40:43], v[224:227]
    v_mfma_f32_16x16x32_bf16 v[228:231], a[88:91], v[40:43], v[228:231]
    v_mfma_f32_16x16x32_bf16 v[232:235], a[16:19], v[44:47], v[232:235]
    s_add_u32 m0, s23, 6720
    s_nop 0
    buffer_load_dwordx4 v2, s[8:11], s24 offen offset:448 lds
    v_mfma_f32_16x16x32_bf16 v[236:239], a[88:91], v[44:47], v[236:239]
    s_waitcnt lgkmcnt(2)
    v_mfma_f32_16x16x32_bf16 v[208:211], v[84:87], v[48:51], v[208:211]
    ds_read_b128 v[40:43], v3 offset:7168
    v_mfma_f32_16x16x32_bf16 v[212:215], v[156:159], v[48:51], v[212:215]
    ds_read_b128 v[44:47], v3 offset:25600
    v_mfma_f32_16x16x32_bf16 v[216:219], v[84:87], v[52:55], v[216:219]
    s_add_u32 m0, s23, 7680
    s_nop 0
    buffer_load_dwordx4 v2, s[8:11], s24 offen offset:512 lds
    s_add_u32 s24, s24, 147456
    v_mfma_f32_16x16x32_bf16 v[220:223], v[156:159], v[52:55], v[220:223]
    v_mfma_f32_16x16x32_bf16 v[224:227], a[20:23], v[48:51], v[224:227]
    v_mfma_f32_16x16x32_bf16 v[228:231], a[92:95], v[48:51], v[228:231]
    v_mfma_f32_16x16x32_bf16 v[232:235], a[20:23], v[52:55], v[232:235]
    v_mfma_f32_16x16x32_bf16 v[236:239], a[92:95], v[52:55], v[236:239]
    s_waitcnt lgkmcnt(2)
    v_mfma_f32_16x16x32_bf16 v[208:211], v[88:91], v[32:35], v[208:211]
    ds_read_b128 v[48:51], v3 offset:8192
    v_mfma_f32_16x16x32_bf16 v[212:215], v[160:163], v[32:35], v[212:215]
    ds_read_b128 v[52:55], v3 offset:26624
    v_mfma_f32_16x16x32_bf16 v[216:219], v[88:91], v[36:39], v[216:219]
    v_mfma_f32_16x16x32_bf16 v[220:223], v[160:163], v[36:39], v[220:223]
    v_mfma_f32_16x16x32_bf16 v[224:227], a[24:27], v[32:35], v[224:227]
    v_mfma_f32_16x16x32_bf16 v[228:231], a[96:99], v[32:35], v[228:231]
    v_mfma_f32_16x16x32_bf16 v[232:235], a[24:27], v[36:39], v[232:235]
    v_mfma_f32_16x16x32_bf16 v[236:239], a[96:99], v[36:39], v[236:239]
    s_waitcnt lgkmcnt(2)
    v_mfma_f32_16x16x32_bf16 v[208:211], v[92:95], v[40:43], v[208:211]
    ds_read_b128 v[32:35], v3 offset:9216
    v_mfma_f32_16x16x32_bf16 v[212:215], v[164:167], v[40:43], v[212:215]
    ds_read_b128 v[36:39], v3 offset:27648
    v_mfma_f32_16x16x32_bf16 v[216:219], v[92:95], v[44:47], v[216:219]
    s_add_u32 s23, s45, s95
    v_mov_b32 v4, s23
    s_mov_b64 exec, s[34:35]
    buffer_store_dword v4, off, s[4:7], s29 sc1
    buffer_store_dword v4, off, s[4:7], s29 offset:128 sc1
    s_mov_b64 exec, -1
    v_mfma_f32_16x16x32_bf16 v[220:223], v[164:167], v[44:47], v[220:223]
    v_mfma_f32_16x16x32_bf16 v[224:227], a[28:31], v[40:43], v[224:227]
    v_mfma_f32_16x16x32_bf16 v[228:231], a[100:103], v[40:43], v[228:231]
    v_mfma_f32_16x16x32_bf16 v[232:235], a[28:31], v[44:47], v[232:235]
    v_mfma_f32_16x16x32_bf16 v[236:239], a[100:103], v[44:47], v[236:239]
    s_waitcnt lgkmcnt(2)
    v_mfma_f32_16x16x32_bf16 v[208:211], v[96:99], v[48:51], v[208:211]
    ds_read_b128 v[40:43], v3 offset:10240
    v_mfma_f32_16x16x32_bf16 v[212:215], v[168:171], v[48:51], v[212:215]
    ds_read_b128 v[44:47], v3 offset:28672
    v_mfma_f32_16x16x32_bf16 v[216:219], v[96:99], v[52:55], v[216:219]
    s_cmp_lt_u32 s19, 60
    s_cbranch_scc1 lt9
    buffer_load_dwordx4 v[244:247], off, s[84:87], 0 offset:16 sc1
    buffer_load_dword v248, off, s[84:87], 0 offset:4 sc1
lt9:
    v_mfma_f32_16x16x32_bf16 v[220:223], v[168:171], v[52:55], v[220:223]
    v_mfma_f32_16x16x32_bf16 v[224:227], a[32:35], v[48:51], v[224:227]
    v_mfma_f32_16x16x32_bf16 v[228:231], a[104:107], v[48:51], v[228:231]
    v_mfma_f32_16x16x32_bf16 v[232:235], a[32:35], v[52:55], v[232:235]
    v_mfma_f32_16x16x32_bf16 v[236:239], a[104:107], v[52:55], v[236:239]
    s_waitcnt lgkmcnt(2)
    v_mfma_f32_16x16x32_bf16 v[208:211], v[100:103], v[32:35], v[208:211]
    ds_read_b128 v[48:51], v3 offset:11264
    v_mfma_f32_16x16x32_bf16 v[212:215], v[172:175], v[32:35], v[212:215]
    ds_read_b128 v[52:55], v3 offset:29696
    v_mfma_f32_16x16x32_bf16 v[216:219], v[100:103], v[36:39], v[216:219]
    v_mfma_f32_16x16x32_bf16 v[220:223], v[172:175], v[36:39], v[220:223]
    v_mfma_f32_16x16x32_bf16 v[224:227], a[36:39], v[32:35], v[224:227]
    v_mfma_f32_16x16x32_bf16 v[228:231], a[108:111], v[32:35], v[228:231]
    v_mfma_f32_16x16x32_bf16 v[232:235], a[36:39], v[36:39], v[232:235]
    v_mfma_f32_16x16x32_bf16 v[236:239], a[108:111], v[36:39], v[236:239]
    s_waitcnt lgkmcnt(2)
    v_mfma_f32_16x16x32_bf16 v[208:211], v[104:107], v[40:43], v[208:211]
    ds_read_b128 v[32:35], v3 offset:12288
    v_mfma_f32_16x16x32_bf16 v[212:215], v[176:179], v[40:43], v[212:215]
    ds_read_b128 v[36:39], v3 offset:30720
    v_mfma_f32_16x16x32_bf16 v[216:219], v[104:107], v[44:47], v[216:219]
    v_mfma_f32_16x16x32_bf16 v[220:223], v[176:179], v[44:47], v[220:223]
    v_mfma_f32_16x16x32_bf16 v[224:227], a[40:43], v[40:43], v[224:227]
    v_mfma_f32_16x16x32_bf16 v[228:231], a[112:115], v[40:43], v[228:231]
    v_mfma_f32_16x16x32_bf16 v[232:235], a[40:43], v[44:47], v[232:235]
    v_mfma_f32_16x16x32_bf16 v[236:239], a[112:115], v[44:47], v[236:239]
    s_waitcnt lgkmcnt(2)
    v_mfma_f32_16x16x32_bf16 v[208:211], v[108:111], v[48:51], v[208:211]
    ds_read_b128 v[40:43], v3 offset:13312
    v_mfma_f32_16x16x32_bf16 v[212:215], v[180:183], v[48:51], v[212:215]
    ds_read_b128 v[44:47], v3 offset:31744
    v_mfma_f32_16x16x32_bf16 v[216:219], v[108:111], v[52:55], v[216:219]
    v_mfma_f32_16x16x32_bf16 v[220:223], v[180:183], v[52:55], v[220:223]
    v_mfma_f32_16x16x32_bf16 v[224:227], a[44:47], v[48:51], v[224:227]
    v_mfma_f32_16x16x32_bf16 v[228:231], a[116:119], v[48:51], v[228:231]
    v_mfma_f32_16x16x32_bf16 v[232:235], a[44:47], v[52:55], v[232:235]
    v_mfma_f32_16x16x32_bf16 v[236:239], a[116:119], v[52:55], v[236:239]
    s_waitcnt lgkmcnt(2)
    v_mfma_f32_16x16x32_bf16 v[208:211], v[112:115], v[32:35], v[208:211]
    ds_read_b128 v[48:51], v3 offset:14336
    v_mfma_f32_16x16x32_bf16 v[212:215], v[184:187], v[32:35], v[212:215]
    ds_read_b128 v[52:55], v3 offset:32768
    v_mfma_f32_16x16x32_bf16 v[216:219], v[112:115], v[36:39], v[216:219]
    v_mfma_f32_16x16x32_bf16 v[220:223], v[184:187], v[36:39], v[220:223]
    v_mfma_f32_16x16x32_bf16 v[224:227], a[48:51], v[32:35], v[224:227]
    v_mfma_f32_16x16x32_bf16 v[228:231], a[120:123], v[32:35], v[228:231]
    v_mfma_f32_16x16x32_bf16 v[232:235], a[48:51], v[36:39], v[232:235]
    v_mfma_f32_16x16x32_bf16 v[236:239], a[120:123], v[36:39], v[236:239]
    s_waitcnt lgkmcnt(2)
    v_mfma_f32_16x16x32_bf16 v[208:211], v[116:119], v[40:43], v[208:211]
    ds_read_b128 v[32:35], v3 offset:15360
    v_mfma_f32_16x16x32_bf16 v[212:215], v[188:191], v[40:43], v[212:215]
    ds_read_b128 v[36:39], v3 offset:33792
    v_mfma_f32_16x16x32_bf16 v[216:219], v[116:119], v[44:47], v[216:219]
    v_mfma_f32_16x16x32_bf16 v[220:223], v[188:191], v[44:47], v[220:223]
    v_mfma_f32_16x16x32_bf16 v[224:227], a[52:55], v[40:43], v[224:227]
    v_mfma_f32_16x16x32_bf16 v[228:231], a[124:127], v[40:43], v[228:231]
    v_mfma_f32_16x16x32_bf16 v[232:235], a[52:55], v[44:47], v[232:235]
    v_mfma_f32_16x16x32_bf16 v[236:239], a[124:127], v[44:47], v[236:239]
    s_waitcnt lgkmcnt(2)
    v_mfma_f32_16x16x32_bf16 v[208:211], v[120:123], v[48:51], v[208:211]
    ds_read_b128 v[40:43], v3 offset:16384
    v_mfma_f32_16x16x32_bf16 v[212:215], v[192:195], v[48:51], v[212:215]
    ds_read_b128 v[44:47], v3 offset:34816
    v_mfma_f32_16x16x32_bf16 v[216:219], v[120:123], v[52:55], v[216:219]
    v_mfma_f32_16x16x32_bf16 v[220:223], v[192:195], v[52:55], v[220:223]
    v_mfma_f32_16x16x32_bf16 v[224:227], a[56:59], v[48:51], v[224:227]
    v_mfma_f32_16x16x32_bf16 v[228:231], a[128:131], v[48:51], v[228:231]
    v_mfma_f32_16x16x32_bf16 v[232:235], a[56:59], v[52:55], v[232:235]
    v_mfma_f32_16x16x32_bf16 v[236:239], a[128:131], v[52:55], v[236:239]
    s_waitcnt lgkmcnt(2)
    v_mfma_f32_16x16x32_bf16 v[208:211], v[124:127], v[32:35], v[208:211]
    ds_read_b128 v[48:51], v3 offset:17408
    v_mfma_f32_16x16x32_bf16 v[212:215], v[196:199], v[32:35], v[212:215]
    ds_read_b128 v[52:55], v3 offset:35840
    v_mfma_f32_16x16x32_bf16 v[216:219], v[124:127], v[36:39], v[216:219]
    v_mfma_f32_16x16x32_bf16 v[220:223], v[196:199], v[36:39], v[220:223]
    v_mfma_f32_16x16x32_bf16 v[224:227], a[60:63], v[32:35], v[224:227]
    s_add_u32 s27, s27, 36864
    s_cmp_eq_u32 s27, 110592
    s_cselect_b32 s27, 0, s27
    v_add_u32 v3, s27, v1
    v_mfma_f32_16x16x32_bf16 v[228:231], a[132:135], v[32:35], v[228:231]
    v_mfma_f32_16x16x32_bf16 v[232:235], a[60:63], v[36:39], v[232:235]
    v_mfma_f32_16x16x32_bf16 v[236:239], a[132:135], v[36:39], v[236:239]
    s_waitcnt lgkmcnt(2)
    v_mfma_f32_16x16x32_bf16 v[208:211], v[128:131], v[40:43], v[208:211]
    ds_read_b128 v[32:35], v3 offset:0
    v_mfma_f32_16x16x32_bf16 v[212:215], v[200:203], v[40:43], v[212:215]
    ds_read_b128 v[36:39], v3 offset:18432
    v_mfma_f32_16x16x32_bf16 v[216:219], v[128:131], v[44:47], v[216:219]
    v_mfma_f32_16x16x32_bf16 v[220:223], v[200:203], v[44:47], v[220:223]
    v_mfma_f32_16x16x32_bf16 v[224:227], a[64:67], v[40:43], v[224:227]
    v_mfma_f32_16x16x32_bf16 v[228:231], a[136:139], v[40:43], v[228:231]
    v_mfma_f32_16x16x32_bf16 v[232:235], a[64:67], v[44:47], v[232:235]
    v_mfma_f32_16x16x32_bf16 v[236:239], a[136:139], v[44:47], v[236:239]
    s_waitcnt lgkmcnt(2)
    v_mfma_f32_16x16x32_bf16 v[208:211], v[132:135], v[48:51], v[208:211]
    ds_read_b128 v[40:43], v3 offset:1024
    v_mfma_f32_16x16x32_bf16 v[212:215], v[204:207], v[48:51], v[212:215]
    ds_read_b128 v[44:47], v3 offset:19456
    v_mfma_f32_16x16x32_bf16 v[216:219], v[132:135], v[52:55], v[216:219]
    v_mfma_f32_16x16x32_bf16 v[220:223], v[204:207], v[52:55], v[220:223]
    v_mfma_f32_16x16x32_bf16 v[224:227], a[68:71], v[48:51], v[224:227]
    v_mfma_f32_16x16x32_bf16 v[228:231], a[140:143], v[48:51], v[228:231]
    v_mfma_f32_16x16x32_bf16 v[232:235], a[68:71], v[52:55], v[232:235]
    v_mfma_f32_16x16x32_bf16 v[236:239], a[140:143], v[52:55], v[236:239]
    s_add_u32 s26, s26, s41
    s_waitcnt vmcnt(0)
    v_cvt_pk_bf16_f32 v8, v208, v209
    v_cvt_pk_bf16_f32 v9, v210, v211
    v_cvt_pk_bf16_f32 v10, v212, v213
    v_cvt_pk_bf16_f32 v11, v214, v215
    v_cvt_pk_bf16_f32 v12, v216, v217
    v_cvt_pk_bf16_f32 v13, v218, v219
    v_cvt_pk_bf16_f32 v14, v220, v221
    v_cvt_pk_bf16_f32 v15, v222, v223
    v_cvt_pk_bf16_f32 v16, v224, v225
    v_cvt_pk_bf16_f32 v17, v226, v227
    v_cvt_pk_bf16_f32 v18, v228, v229
    v_cvt_pk_bf16_f32 v19, v230, v231
    v_cvt_pk_bf16_f32 v20, v232, v233
    v_cvt_pk_bf16_f32 v21, v234, v235
    v_cvt_pk_bf16_f32 v22, v236, v237
    v_cvt_pk_bf16_f32 v23, v238, v239
    s_mov_b64 s[36:37], -1
    s_add_u32 s28, s26, s12
    buffer_store_dwordx4 v[8:11], v7, s[4:7], s28 offen sc1
    s_add_u32 s28, s26, s13
    buffer_store_dwordx4 v[12:15], v7, s[4:7], s28 offen sc1
    s_add_u32 s28, s26, s14
    buffer_store_dwordx4 v[16:19], v7, s[4:7], s28 offen sc1
    s_add_u32 s28, s26, s15
    buffer_store_dwordx4 v[20:23], v7, s[4:7], s28 offen sc1
    s_lshr_b32 s45, s19, 2
    s_cbranch_scc1 qk_loop_nf
    s_mov_b32 s45, 1
    s_mov_b64 s[36:37], 0
    s_waitcnt vmcnt(0)
    s_barrier
    s_add_u32 s23, s45, s95
    v_mov_b32 v4, s23
    s_mov_b64 exec, s[34:35]
    buffer_store_dword v4, off, s[4:7], s29 sc1
    buffer_store_dword v4, off, s[4:7], s29 offset:128 sc1
    s_mov_b64 exec, -1
qk_loop_nf:
    s_add_u32 s19, s19, 4
    s_cmp_lt_u32 s19, s20
    s_cbranch_scc1 qk_loop
    s_branch qk_done
qk_vloop:
    s_barrier
    s_add_u32 s22, s27, 73728
    s_sub_u32 s21, s22, 110592
    s_cselect_b32 s22, s22, s21
    s_waitcnt lgkmcnt(2)
    v_mfma_f32_16x16x32_bf16 v[208:211], v[32:35], v[64:67], 0
    ds_read_b128 v[48:51], v3 offset:2048
    v_mfma_f32_16x16x32_bf16 v[212:215], v[32:35], v[136:139], 0
    ds_read_b128 v[52:55], v3 offset:20480
    v_mfma_f32_16x16x32_bf16 v[216:219], v[36:39], v[64:67], 0
    v_mfma_f32_16x16x32_bf16 v[220:223], v[36:39], v[136:139], 0
    v_mfma_f32_16x16x32_bf16 v[224:227], v[32:35], a[0:3], 0
    v_mfma_f32_16x16x32_bf16 v[228:231], v[32:35], a[72:75], 0
    v_mfma_f32_16x16x32_bf16 v[232:235], v[36:39], a[0:3], 0
    v_mfma_f32_16x16x32_bf16 v[236:239], v[36:39], a[72:75], 0
    s_waitcnt lgkmcnt(2)
    v_mfma_f32_16x16x32_bf16 v[208:211], v[40:43], v[68:71], v[208:211]
    ds_read_b128 v[32:35], v3 offset:3072
    v_mfma_f32_16x16x32_bf16 v[212:215], v[40:43], v[140:143], v[212:215]
    ds_read_b128 v[36:39], v3 offset:21504
    v_mfma_f32_16x16x32_bf16 v[216:219], v[44:47], v[68:71], v[216:219]
    s_add_u32 s23, s22, s25
    s_add_u32 m0, s23, 0
    s_nop 0
    buffer_load_dwordx4 v2, s[8:11], s24 offen offset:0 lds
    v_mfma_f32_16x16x32_bf16 v[220:223], v[44:47], v[140:143], v[220:223]
    v_mfma_f32_16x16x32_bf16 v[224:227], v[40:43], a[4:7], v[224:227]
    v_mfma_f32_16x16x32_bf16 v[228:231], v[40:43], a[76:79], v[228:231]
    v_mfma_f32_16x16x32_bf16 v[232:235], v[44:47], a[4:7], v[232:235]
    s_add_u32 m0, s23, 960
    s_nop 0
    buffer_load_dwordx4 v2, s[8:11], s24 offen offset:64 lds
    v_mfma_f32_16x16x32_bf16 v[236:239], v[44:47], a[76:79], v[236:239]
    s_waitcnt lgkmcnt(2)
    v_mfma_f32_16x16x32_bf16 v[208:211], v[48:51], v[72:75], v[208:211]
    ds_read_b128 v[40:43], v3 offset:4096
    v_mfma_f32_16x16x32_bf16 v[212:215], v[48:51], v[144:147], v[212:215]
    ds_read_b128 v[44:47], v3 offset:22528
    v_mfma_f32_16x16x32_bf16 v[216:219], v[52:55], v[72:75], v[216:219]
    s_add_u32 m0, s23, 1920
    s_nop 0
    buffer_load_dwordx4 v2, s[8:11], s24 offen offset:128 lds
    v_mfma_f32_16x16x32_bf16 v[220:223], v[52:55], v[144:147], v[220:223]
    v_mfma_f32_16x16x32_bf16 v[224:227], v[48:51], a[8:11], v[224:227]
    v_mfma_f32_16x16x32_bf16 v[228:231], v[48:51], a[80:83], v[228:231]
    v_mfma_f32_16x16x32_bf16 v[232:235], v[52:55], a[8:11], v[232:235]
    s_add_u32 m0, s23, 2880
    s_nop 0
    buffer_load_dwordx4 v2, s[8:11], s24 offen offset:192 lds
    v_mfma_f32_16x16x32_bf16 v[236:239], v[52:55], a[80:83], v[236:239]
    s_waitcnt lgkmcnt(2)
    v_mfma_f32_16x16x32_bf16 v[208:211], v[32:35], v[76:79], v[208:211]
    ds_read_b128 v[48:51], v3 offset:5120
    v_mfma_f32_16x16x32_bf16 v[212:215], v[32:35], v[148:151], v[212:215]
    ds_read_b128 v[52:55], v3 offset:23552
    v_mfma_f32_16x16x32_bf16 v[216:219], v[36:39], v[76:79], v[216:219]
    s_add_u32 m0, s23, 3840
    s_nop 0
    buffer_load_dwordx4 v2, s[8:11], s24 offen offset:256 lds
    v_mfma_f32_16x16x32_bf16 v[220:223], v[36:39], v[148:151], v[220:223]
    v_mfma_f32_16x16x32_bf16 v[224:227], v[32:35], a[12:15], v[224:227]
    v_mfma_f32_16x16x32_bf16 v[228:231], v[32:35], a[84:87], v[228:231]
    v_mfma_f32_16x16x32_bf16 v[232:235], v[36:39], a[12:15], v[232:235]
    s_add_u32 m0, s23, 4800
    s_nop 0
    buffer_load_dwordx4 v2, s[8:11], s24 offen offset:320 lds
    v_mfma_f32_16x16x32_bf16 v[236:239], v[36:39], a[84:87], v[236:239]
    s_waitcnt lgkmcnt(2)
    v_mfma_f32_16x16x32_bf16 v[208:211], v[40:43], v[80:83], v[208:211]
    ds_read_b128 v[32:35], v3 offset:6144
    v_mfma_f32_16x16x32_bf16 v[212:215], v[40:43], v[152:155], v[212:215]
    ds_read_b128 v[36:39], v3 offset:24576
    v_mfma_f32_16x16x32_bf16 v[216:219], v[44:47], v[80:83], v[216:219]
    s_add_u32 m0, s23, 5760
    s_nop 0
    buffer_load_dwordx4 v2, s[8:11], s24 offen offset:384 lds
    v_mfma_f32_16x16x32_bf16 v[220:223], v[44:47], v[152:155], v[220:223]
    v_mfma_f32_16x16x32_bf16 v[224:227], v[40:43], a[16:19], v[224:227]
    v_mfma_f32_16x16x32_bf16 v[228:231], v[40:43], a[88:91], v[228:231]
    v_mfma_f32_16x16x32_bf16 v[232:235], v[44:47], a[16:19], v[232:235]
    s_add_u32 m0, s23, 6720
    s_nop 0
    buffer_load_dwordx4 v2, s[8:11], s24 offen offset:448 lds
    v_mfma_f32_16x16x32_bf16 v[236:239], v[44:47], a[88:91], v[236:239]
    s_waitcnt lgkmcnt(2)
    v_mfma_f32_16x16x32_bf16 v[208:211], v[48:51], v[84:87], v[208:211]
    ds_read_b128 v[40:43], v3 offset:7168
    v_mfma_f32_16x16x32_bf16 v[212:215], v[48:51], v[156:159], v[212:215]
    ds_read_b128 v[44:47], v3 offset:25600
    v_mfma_f32_16x16x32_bf16 v[216:219], v[52:55], v[84:87], v[216:219]
    s_add_u32 m0, s23, 7680
    s_nop 0
    buffer_load_dwordx4 v2, s[8:11], s24 offen offset:512 lds
    s_add_u32 s24, s24, 147456
    v_mfma_f32_16x16x32_bf16 v[220:223], v[52:55], v[156:159], v[220:223]
    v_mfma_f32_16x16x32_bf16 v[224:227], v[48:51], a[20:23], v[224:227]
    v_mfma_f32_16x16x32_bf16 v[228:231], v[48:51], a[92:95], v[228:231]
    v_mfma_f32_16x16x32_bf16 v[232:235], v[52:55], a[20:23], v[232:235]
    v_mfma_f32_16x16x32_bf16 v[236:239], v[52:55], a[92:95], v[236:239]
    s_waitcnt lgkmcnt(2)
    v_mfma_f32_16x16x32_bf16 v[208:211], v[32:35], v[88:91], v[208:211]
    ds_read_b128 v[48:51], v3 offset:8192
    v_mfma_f32_16x16x32_bf16 v[212:215], v[32:35], v[160:163], v[212:215]
    ds_read_b128 v[52:55], v3 offset:26624
    v_mfma_f32_16x16x32_bf16 v[216:219], v[36:39], v[88:91], v[216:219]
    v_mfma_f32_16x16x32_bf16 v[220:223], v[36:39], v[160:163], v[220:223]
    v_mfma_f32_16x16x32_bf16 v[224:227], v[32:35], a[24:27], v[224:227]
    v_mfma_f32_16x16x32_bf16 v[228:231], v[32:35], a[96:99], v[228:231]
    v_mfma_f32_16x16x32_bf16 v[232:235], v[36:39], a[24:27], v[232:235]
    v_mfma_f32_16x16x32_bf16 v[236:239], v[36:39], a[96:99], v[236:239]
    s_waitcnt lgkmcnt(2)
    v_mfma_f32_16x16x32_bf16 v[208:211], v[40:43], v[92:95], v[208:211]
    ds_read_b128 v[32:35], v3 offset:9216
    v_mfma_f32_16x16x32_bf16 v[212:215], v[40:43], v[164:167], v[212:215]
    ds_read_b128 v[36:39], v3 offset:27648
    v_mfma_f32_16x16x32_bf16 v[216:219], v[44:47], v[92:95], v[216:219]
    s_add_u32 s23, s45, s95
    v_mov_b32 v4, s23
    s_mov_b64 exec, s[34:35]
    buffer_store_dword v4, off, s[4:7], s29 sc1
    buffer_store_dword v4, off, s[4:7], s29 offset:128 sc1
    s_mov_b64 exec, -1
    v_mfma_f32_16x16x32_bf16 v[220:223], v[44:47], v[164:167], v[220:223]
    v_mfma_f32_16x16x32_bf16 v[224:227], v[40:43], a[28:31], v[224:227]
    v_mfma_f32_16x16x32_bf16 v[228:231], v[40:43], a[100:103], v[228:231]
    v_mfma_f32_16x16x32_bf16 v[232:235], v[44:47], a[28:31], v[232:235]
    v_mfma_f32_16x16x32_bf16 v[236:239], v[44:47], a[100:103], v[236:239]
    s_waitcnt lgkmcnt(2)
    v_mfma_f32_16x16x32_bf16 v[208:211], v[48:51], v[96:99], v[208:211]
    ds_read_b128 v[40:43], v3 offset:10240
    v_mfma_f32_16x16x32_bf16 v[212:215], v[48:51], v[168:171], v[212:215]
    ds_read_b128 v[44:47], v3 offset:28672
    v_mfma_f32_16x16x32_bf16 v[216:219], v[52:55], v[96:99], v[216:219]
    s_cmp_lt_u32 s19, 60
    s_cbranch_scc1 lt10
    buffer_load_dwordx4 v[244:247], off, s[84:87], 0 offset:16 sc1
    buffer_load_dword v248, off, s[84:87], 0 offset:4 sc1
lt10:
    v_mfma_f32_16x16x32_bf16 v[220:223], v[52:55], v[168:171], v[220:223]
    v_mfma_f32_16x16x32_bf16 v[224:227], v[48:51], a[32:35], v[224:227]
    v_mfma_f32_16x16x32_bf16 v[228:231], v[48:51], a[104:107], v[228:231]
    v_mfma_f32_16x16x32_bf16 v[232:235], v[52:55], a[32:35], v[232:235]
    v_mfma_f32_16x16x32_bf16 v[236:239], v[52:55], a[104:107], v[236:239]
    s_waitcnt lgkmcnt(2)
    v_mfma_f32_16x16x32_bf16 v[208:211], v[32:35], v[100:103], v[208:211]
    ds_read_b128 v[48:51], v3 offset:11264
    v_mfma_f32_16x16x32_bf16 v[212:215], v[32:35], v[172:175], v[212:215]
    ds_read_b128 v[52:55], v3 offset:29696
    v_mfma_f32_16x16x32_bf16 v[216:219], v[36:39], v[100:103], v[216:219]
    v_mfma_f32_16x16x32_bf16 v[220:223], v[36:39], v[172:175], v[220:223]
    v_mfma_f32_16x16x32_bf16 v[224:227], v[32:35], a[36:39], v[224:227]
    v_mfma_f32_16x16x32_bf16 v[228:231], v[32:35], a[108:111], v[228:231]
    v_mfma_f32_16x16x32_bf16 v[232:235], v[36:39], a[36:39], v[232:235]
    v_mfma_f32_16x16x32_bf16 v[236:239], v[36:39], a[108:111], v[236:239]
    s_waitcnt lgkmcnt(2)
    v_mfma_f32_16x16x32_bf16 v[208:211], v[40:43], v[104:107], v[208:211]
    ds_read_b128 v[32:35], v3 offset:12288
    v_mfma_f32_16x16x32_bf16 v[212:215], v[40:43], v[176:179], v[212:215]
    ds_read_b128 v[36:39], v3 offset:30720
    v_mfma_f32_16x16x32_bf16 v[216:219], v[44:47], v[104:107], v[216:219]
    v_mfma_f32_16x16x32_bf16 v[220:223], v[44:47], v[176:179], v[220:223]
    v_mfma_f32_16x16x32_bf16 v[224:227], v[40:43], a[40:43], v[224:227]
    v_mfma_f32_16x16x32_bf16 v[228:231], v[40:43], a[112:115], v[228:231]
    v_mfma_f32_16x16x32_bf16 v[232:235], v[44:47], a[40:43], v[232:235]
    v_mfma_f32_16x16x32_bf16 v[236:239], v[44:47], a[112:115], v[236:239]
    s_waitcnt lgkmcnt(2)
    v_mfma_f32_16x16x32_bf16 v[208:211], v[48:51], v[108:111], v[208:211]
    ds_read_b128 v[40:43], v3 offset:13312
    v_mfma_f32_16x16x32_bf16 v[212:215], v[48:51], v[180:183], v[212:215]
    ds_read_b128 v[44:47], v3 offset:31744
    v_mfma_f32_16x16x32_bf16 v[216:219], v[52:55], v[108:111], v[216:219]
    v_mfma_f32_16x16x32_bf16 v[220:223], v[52:55], v[180:183], v[220:223]
    v_mfma_f32_16x16x32_bf16 v[224:227], v[48:51], a[44:47], v[224:227]
    v_mfma_f32_16x16x32_bf16 v[228:231], v[48:51], a[116:119], v[228:231]
    v_mfma_f32_16x16x32_bf16 v[232:235], v[52:55], a[44:47], v[232:235]
    v_mfma_f32_16x16x32_bf16 v[236:239], v[52:55], a[116:119], v[236:239]
    s_waitcnt lgkmcnt(2)
    v_mfma_f32_16x16x32_bf16 v[208:211], v[32:35], v[112:115], v[208:211]
    ds_read_b128 v[48:51], v3 offset:14336
    v_mfma_f32_16x16x32_bf16 v[212:215], v[32:35], v[184:187], v[212:215]
    ds_read_b128 v[52:55], v3 offset:32768
    v_mfma_f32_16x16x32_bf16 v[216:219], v[36:39], v[112:115], v[216:219]
    v_mfma_f32_16x16x32_bf16 v[220:223], v[36:39], v[184:187], v[220:223]
    v_mfma_f32_16x16x32_bf16 v[224:227], v[32:35], a[48:51], v[224:227]
    v_mfma_f32_16x16x32_bf16 v[228:231], v[32:35], a[120:123], v[228:231]
    v_mfma_f32_16x16x32_bf16 v[232:235], v[36:39], a[48:51], v[232:235]
    v_mfma_f32_16x16x32_bf16 v[236:239], v[36:39], a[120:123], v[236:239]
    s_waitcnt lgkmcnt(2)
    v_mfma_f32_16x16x32_bf16 v[208:211], v[40:43], v[116:119], v[208:211]
    ds_read_b128 v[32:35], v3 offset:15360
    v_mfma_f32_16x16x32_bf16 v[212:215], v[40:43], v[188:191], v[212:215]
    ds_read_b128 v[36:39], v3 offset:33792
    v_mfma_f32_16x16x32_bf16 v[216:219], v[44:47], v[116:119], v[216:219]
    v_mfma_f32_16x16x32_bf16 v[220:223], v[44:47], v[188:191], v[220:223]
    v_mfma_f32_16x16x32_bf16 v[224:227], v[40:43], a[52:55], v[224:227]
    v_mfma_f32_16x16x32_bf16 v[228:231], v[40:43], a[124:127], v[228:231]
    v_mfma_f32_16x16x32_bf16 v[232:235], v[44:47], a[52:55], v[232:235]
    v_mfma_f32_16x16x32_bf16 v[236:239], v[44:47], a[124:127], v[236:239]
    s_waitcnt lgkmcnt(2)
    v_mfma_f32_16x16x32_bf16 v[208:211], v[48:51], v[120:123], v[208:211]
    ds_read_b128 v[40:43], v3 offset:16384
    v_mfma_f32_16x16x32_bf16 v[212:215], v[48:51], v[192:195], v[212:215]
    ds_read_b128 v[44:47], v3 offset:34816
    v_mfma_f32_16x16x32_bf16 v[216:219], v[52:55], v[120:123], v[216:219]
    v_mfma_f32_16x16x32_bf16 v[220:223], v[52:55], v[192:195], v[220:223]
    v_mfma_f32_16x16x32_bf16 v[224:227], v[48:51], a[56:59], v[224:227]
    v_mfma_f32_16x16x32_bf16 v[228:231], v[48:51], a[128:131], v[228:231]
    v_mfma_f32_16x16x32_bf16 v[232:235], v[52:55], a[56:59], v[232:235]
    v_mfma_f32_16x16x32_bf16 v[236:239], v[52:55], a[128:131], v[236:239]
    s_waitcnt lgkmcnt(2)
    v_mfma_f32_16x16x32_bf16 v[208:211], v[32:35], v[124:127], v[208:211]
    ds_read_b128 v[48:51], v3 offset:17408
    v_mfma_f32_16x16x32_bf16 v[212:215], v[32:35], v[196:199], v[212:215]
    ds_read_b128 v[52:55], v3 offset:35840
    v_mfma_f32_16x16x32_bf16 v[216:219], v[36:39], v[124:127], v[216:219]
    v_mfma_f32_16x16x32_bf16 v[220:223], v[36:39], v[196:199], v[220:223]
    v_mfma_f32_16x16x32_bf16 v[224:227], v[32:35], a[60:63], v[224:227]
    s_add_u32 s27, s27, 36864
    s_cmp_eq_u32 s27, 110592
    s_cselect_b32 s27, 0, s27
    v_add_u32 v3, s27, v1
    v_mfma_f32_16x16x32_bf16 v[228:231], v[32:35], a[132:135], v[228:231]
    v_mfma_f32_16x16x32_bf16 v[232:235], v[36:39], a[60:63], v[232:235]
    v_mfma_f32_16x16x32_bf16 v[236:239], v[36:39], a[132:135], v[236:239]
    s_waitcnt lgkmcnt(2)
    v_mfma_f32_16x16x32_bf16 v[208:211], v[40:43], v[128:131], v[208:211]
    ds_read_b128 v[32:35], v3 offset:0
    v_mfma_f32_16x16x32_bf16 v[212:215], v[40:43], v[200:203], v[212:215]
    ds_read_b128 v[36:39], v3 offset:18432
    v_mfma_f32_16x16x32_bf16 v[216:219], v[44:47], v[128:131], v[216:219]
    v_mfma_f32_16x16x32_bf16 v[220:223], v[44:47], v[200:203], v[220:223]
    v_mfma_f32_16x16x32_bf16 v[224:227], v[40:43], a[64:67], v[224:227]
    v_mfma_f32_16x16x32_bf16 v[228:231], v[40:43], a[136:139], v[228:231]
    v_mfma_f32_16x16x32_bf16 v[232:235], v[44:47], a[64:67], v[232:235]
    v_mfma_f32_16x16x32_bf16 v[236:239], v[44:47], a[136:139], v[236:239]
    s_waitcnt lgkmcnt(2)
    v_mfma_f32_16x16x32_bf16 v[208:211], v[48:51], v[132:135], v[208:211]
    ds_read_b128 v[40:43], v3 offset:1024
    v_mfma_f32_16x16x32_bf16 v[212:215], v[48:51], v[204:207], v[212:215]
    ds_read_b128 v[44:47], v3 offset:19456
    v_mfma_f32_16x16x32_bf16 v[216:219], v[52:55], v[132:135], v[216:219]
    v_mfma_f32_16x16x32_bf16 v[220:223], v[52:55], v[204:207], v[220:223]
    v_mfma_f32_16x16x32_bf16 v[224:227], v[48:51], a[68:71], v[224:227]
    v_mfma_f32_16x16x32_bf16 v[228:231], v[48:51], a[140:143], v[228:231]
    v_mfma_f32_16x16x32_bf16 v[232:235], v[52:55], a[68:71], v[232:235]
    v_mfma_f32_16x16x32_bf16 v[236:239], v[52:55], a[140:143], v[236:239]
    s_add_u32 s26, s26, s41
    s_waitcnt vmcnt(0)
    v_cvt_pk_bf16_f32 v8, v208, v209
    v_cvt_pk_bf16_f32 v9, v210, v211
    v_cvt_pk_bf16_f32 v10, v216, v217
    v_cvt_pk_bf16_f32 v11, v218, v219
    v_cvt_pk_bf16_f32 v12, v212, v213
    v_cvt_pk_bf16_f32 v13, v214, v215
    v_cvt_pk_bf16_f32 v14, v220, v221
    v_cvt_pk_bf16_f32 v15, v222, v223
    v_cvt_pk_bf16_f32 v16, v224, v225
    v_cvt_pk_bf16_f32 v17, v226, v227
    v_cvt_pk_bf16_f32 v18, v232, v233
    v_cvt_pk_bf16_f32 v19, v234, v235
    v_cvt_pk_bf16_f32 v20, v228, v229
    v_cvt_pk_bf16_f32 v21, v230, v231
    v_cvt_pk_bf16_f32 v22, v236, v237
    v_cvt_pk_bf16_f32 v23, v238, v239
    s_mov_b64 s[36:37], -1
    s_add_u32 s28, s26, s12
    buffer_store_dwordx4 v[8:11], v7, s[4:7], s28 offen sc1
    s_add_u32 s28, s26, s13
    buffer_store_dwordx4 v[12:15], v7, s[4:7], s28 offen sc1
    s_add_u32 s28, s26, s14
    buffer_store_dwordx4 v[16:19], v7, s[4:7], s28 offen sc1
    s_add_u32 s28, s26, s15
    buffer_store_dwordx4 v[20:23], v7, s[4:7], s28 offen sc1
    s_lshr_b32 s45, s19, 2
    s_cbranch_scc1 qk_vloop_nf
    s_mov_b32 s45, 1
    s_mov_b64 s[36:37], 0
    s_waitcnt vmcnt(0)
    s_barrier
    s_add_u32 s23, s45, s95
    v_mov_b32 v4, s23
    s_mov_b64 exec, s[34:35]
    buffer_store_dword v4, off, s[4:7], s29 sc1
    buffer_store_dword v4, off, s[4:7], s29 offset:128 sc1
    s_mov_b64 exec, -1
qk_vloop_nf:
    s_add_u32 s19, s19, 4
    s_cmp_lt_u32 s19, s20
    s_cbranch_scc1 qk_vloop
qk_done:
    s_waitcnt vmcnt(0) lgkmcnt(0)
    s_barrier
    s_mov_b32 s45, 16
    s_add_u32 s23, s45, s95
    v_mov_b32 v4, s23
    s_mov_b64 exec, s[34:35]
    buffer_store_dword v4, off, s[4:7], s29 sc1
    buffer_store_dword v4, off, s[4:7], s29 offset:128 sc1
    s_mov_b64 exec, -1
    s_cmp_lt_i32 s33, 0
    s_cbranch_scc1 L_memkv
    v_readfirstlane_b32 s40, v245
    v_readfirstlane_b32 s41, v246
    v_readfirstlane_b32 s42, v247
    v_readfirstlane_b32 s43, v248
    s_cmp_ge_u32 s40, 160
    s_cselect_b32 s43, s43, 0
    s_cmp_ge_u32 s41, 1
    s_cselect_b32 s43, s43, 0
    s_cmp_eq_u32 s42, 1
    s_cselect_b32 s43, s43, 0
    s_cmp_eq_u32 s93, 1000
    s_cselect_b32 s43, s43, 0
    s_mov_b32 s93, 999
    v_mov_b32 v250, s43
    v_mov_b32 v251, 163832
    s_mov_b64 exec, s[34:35]
    ds_write_b32 v251, v250
    s_mov_b64 exec, -1
    s_waitcnt lgkmcnt(0)
    s_barrier
    ds_read_b32 v252, v251
    s_waitcnt lgkmcnt(0)
    v_readfirstlane_b32 s43, v252
    s_barrier
    s_cmp_lg_u32 s43, 192
    s_cbranch_scc1 L_qkv_next
    s_mov_b32 s45, s33
    s_mov_b32 s93, 500
    s_branch L_phase2b
L_memkv:
    v_and_b32 v4, 63, v0
    v_and_b32 v2, 7, v4
    v_lshrrev_b32 v5, 4, v4
    v_lshl_add_u32 v2, v5, 3, v2
    v_lshlrev_b32 v2, 4, v2
    v_bfe_u32 v3, v4, 3, 1
    v_mul_u32_u24 v5, 9216, v3
    v_add_u32 v2, v2, v5
    v_mov_b32 v240, 0x05040100
    v_mov_b32 v241, 0x07060302
    v_lshrrev_b32 v5, 5, v4
    v_and_b32 v1, 0xdff, v7
    s_cmp_eq_u32 s16, 2
    s_cbranch_scc1 mk_isv
    v_mov_b32 v5, v3
    v_or_b32 v1, 128, v7
mk_isv:
    v_lshl_add_u32 v1, v5, 17, v1
    s_mov_b32 s28, 0
    s_mov_b32 s19, 2
    s_mov_b32 s24, 138412032
    s_lshl_b32 s26, s17, 12
    s_mov_b32 s21, 69206016
    s_cmp_eq_u32 s16, 2
    s_cselect_b32 s21, 77594624, s21
    s_add_u32 s26, s26, s21
    s_lshl_b32 s29, s17, 7
    s_lshl_b32 s21, s16, 2
    s_add_u32 s29, s29, s21
    s_add_u32 s29, s29, 125829164
mk_loop:
    s_cmp_lg_u32 s18, 0
    s_cbranch_scc1 mk_go
    s_cmp_le_u32 s19, s28
    s_cbranch_scc1 mk_go
    s_mov_b32 s23, 125853696
    s_mov_b32 s21, 4194304
mk_wait:
    buffer_load_dword v4, off, s[4:7], s23 sc1
    s_sub_u32 s21, s21, 1
    s_cbranch_scc1 mk_go
    s_waitcnt vmcnt(0)
    v_readfirstlane_b32 s28, v4
    s_nop 0
    s_sub_u32 s28, s28, s95
    s_cmp_gt_u32 s28, 64
    s_cselect_b32 s28, 0, s28
    s_cmp_le_u32 s19, s28
    s_cbranch_scc1 mk_go
    s_sleep 4
    s_branch mk_wait
mk_go:
    s_barrier
    s_add_u32 s21, s24, 4096
    s_add_u32 s23, s24, 8192
    buffer_load_dwordx4 v[24:27], v2, s[4:7], s24 offen offset:0 sc1
    buffer_load_dwordx4 v[28:31], v2, s[4:7], s24 offen offset:512 sc1
    buffer_load_dwordx4 v[32:35], v2, s[4:7], s21 offen offset:0 sc1
    buffer_load_dwordx4 v[36:39], v2, s[4:7], s21 offen offset:512 sc1
    buffer_load_dwordx4 v[40:43], v2, s[4:7], s24 offen offset:1024 sc1
    buffer_load_dwordx4 v[44:47], v2, s[4:7], s24 offen offset:1536 sc1
    buffer_load_dwordx4 v[48:51], v2, s[4:7], s21 offen offset:1024 sc1
    buffer_load_dwordx4 v[52:55], v2, s[4:7], s21 offen offset:1536 sc1
    buffer_load_dwordx4 v[56:59], v2, s[4:7], s24 offen offset:2048 sc1
    buffer_load_dwordx4 v[60:63], v2, s[4:7], s24 offen offset:2560 sc1
    buffer_load_dwordx4 v[208:211], v2, s[4:7], s21 offen offset:2048 sc1
    buffer_load_dwordx4 v[212:215], v2, s[4:7], s21 offen offset:2560 sc1
    buffer_load_dwordx4 v[216:219], v2, s[4:7], s24 offen offset:3072 sc1
    buffer_load_dwordx4 v[220:223], v2, s[4:7], s24 offen offset:3584 sc1
    buffer_load_dwordx4 v[224:227], v2, s[4:7], s21 offen offset:3072 sc1
    buffer_load_dwordx4 v[228:231], v2, s[4:7], s21 offen offset:3584 sc1
    buffer_load_dwordx4 v[232:235], v2, s[4:7], s23 offen offset:0 sc1
    buffer_load_dwordx4 v[236:239], v2, s[4:7], s23 offen offset:512 sc1
    s_add_u32 s24, s24, 18432
    s_cmp_eq_u32 s16, 2
    s_cbranch_scc1 mk_v
    s_waitcnt vmcnt(17)
    s_waitcnt vmcnt(16)
    v_mfma_f32_16x16x32_bf16 v[8:11], v[64:67], v[24:27], 0
    v_mfma_f32_16x16x32_bf16 v[12:15], v[136:139], v[24:27], 0
    v_mfma_f32_16x16x32_bf16 v[16:19], a[0:3], v[24:27], 0
    v_mfma_f32_16x16x32_bf16 v[20:23], a[72:75], v[24:27], 0
    s_waitcnt vmcnt(15)
    v_mfma_f32_16x16x32_bf16 v[8:11], v[68:71], v[28:31], v[8:11]
    v_mfma_f32_16x16x32_bf16 v[12:15], v[140:143], v[28:31], v[12:15]
    v_mfma_f32_16x16x32_bf16 v[16:19], a[4:7], v[28:31], v[16:19]
    v_mfma_f32_16x16x32_bf16 v[20:23], a[76:79], v[28:31], v[20:23]
    s_waitcnt vmcnt(14)
    v_mfma_f32_16x16x32_bf16 v[8:11], v[72:75], v[32:35], v[8:11]
    v_mfma_f32_16x16x32_bf16 v[12:15], v[144:147], v[32:35], v[12:15]
    v_mfma_f32_16x16x32_bf16 v[16:19], a[8:11], v[32:35], v[16:19]
    v_mfma_f32_16x16x32_bf16 v[20:23], a[80:83], v[32:35], v[20:23]
    s_waitcnt vmcnt(13)
    v_mfma_f32_16x16x32_bf16 v[8:11], v[76:79], v[36:39], v[8:11]
    v_mfma_f32_16x16x32_bf16 v[12:15], v[148:151], v[36:39], v[12:15]
    v_mfma_f32_16x16x32_bf16 v[16:19], a[12:15], v[36:39], v[16:19]
    v_mfma_f32_16x16x32_bf16 v[20:23], a[84:87], v[36:39], v[20:23]
    s_waitcnt vmcnt(12)
    v_mfma_f32_16x16x32_bf16 v[8:11], v[80:83], v[40:43], v[8:11]
    v_mfma_f32_16x16x32_bf16 v[12:15], v[152:155], v[40:43], v[12:15]
    v_mfma_f32_16x16x32_bf16 v[16:19], a[16:19], v[40:43], v[16:19]
    v_mfma_f32_16x16x32_bf16 v[20:23], a[88:91], v[40:43], v[20:23]
    s_waitcnt vmcnt(11)
    v_mfma_f32_16x16x32_bf16 v[8:11], v[84:87], v[44:47], v[8:11]
    v_mfma_f32_16x16x32_bf16 v[12:15], v[156:159], v[44:47], v[12:15]
    v_mfma_f32_16x16x32_bf16 v[16:19], a[20:23], v[44:47], v[16:19]
    v_mfma_f32_16x16x32_bf16 v[20:23], a[92:95], v[44:47], v[20:23]
    s_waitcnt vmcnt(10)
    v_mfma_f32_16x16x32_bf16 v[8:11], v[88:91], v[48:51], v[8:11]
    v_mfma_f32_16x16x32_bf16 v[12:15], v[160:163], v[48:51], v[12:15]
    v_mfma_f32_16x16x32_bf16 v[16:19], a[24:27], v[48:51], v[16:19]
    v_mfma_f32_16x16x32_bf16 v[20:23], a[96:99], v[48:51], v[20:23]
    s_waitcnt vmcnt(9)
    v_mfma_f32_16x16x32_bf16 v[8:11], v[92:95], v[52:55], v[8:11]
    v_mfma_f32_16x16x32_bf16 v[12:15], v[164:167], v[52:55], v[12:15]
    v_mfma_f32_16x16x32_bf16 v[16:19], a[28:31], v[52:55], v[16:19]
    v_mfma_f32_16x16x32_bf16 v[20:23], a[100:103], v[52:55], v[20:23]
    s_waitcnt vmcnt(8)
    v_mfma_f32_16x16x32_bf16 v[8:11], v[96:99], v[56:59], v[8:11]
    v_mfma_f32_16x16x32_bf16 v[12:15], v[168:171], v[56:59], v[12:15]
    v_mfma_f32_16x16x32_bf16 v[16:19], a[32:35], v[56:59], v[16:19]
    v_mfma_f32_16x16x32_bf16 v[20:23], a[104:107], v[56:59], v[20:23]
    s_waitcnt vmcnt(7)
    v_mfma_f32_16x16x32_bf16 v[8:11], v[100:103], v[60:63], v[8:11]
    v_mfma_f32_16x16x32_bf16 v[12:15], v[172:175], v[60:63], v[12:15]
    v_mfma_f32_16x16x32_bf16 v[16:19], a[36:39], v[60:63], v[16:19]
    v_mfma_f32_16x16x32_bf16 v[20:23], a[108:111], v[60:63], v[20:23]
    s_waitcnt vmcnt(6)
    v_mfma_f32_16x16x32_bf16 v[8:11], v[104:107], v[208:211], v[8:11]
    v_mfma_f32_16x16x32_bf16 v[12:15], v[176:179], v[208:211], v[12:15]
    v_mfma_f32_16x16x32_bf16 v[16:19], a[40:43], v[208:211], v[16:19]
    v_mfma_f32_16x16x32_bf16 v[20:23], a[112:115], v[208:211], v[20:23]
    s_waitcnt vmcnt(5)
    v_mfma_f32_16x16x32_bf16 v[8:11], v[108:111], v[212:215], v[8:11]
    v_mfma_f32_16x16x32_bf16 v[12:15], v[180:183], v[212:215], v[12:15]
    v_mfma_f32_16x16x32_bf16 v[16:19], a[44:47], v[212:215], v[16:19]
    v_mfma_f32_16x16x32_bf16 v[20:23], a[116:119], v[212:215], v[20:23]
    s_waitcnt vmcnt(4)
    v_mfma_f32_16x16x32_bf16 v[8:11], v[112:115], v[216:219], v[8:11]
    v_mfma_f32_16x16x32_bf16 v[12:15], v[184:187], v[216:219], v[12:15]
    v_mfma_f32_16x16x32_bf16 v[16:19], a[48:51], v[216:219], v[16:19]
    v_mfma_f32_16x16x32_bf16 v[20:23], a[120:123], v[216:219], v[20:23]
    s_waitcnt vmcnt(3)
    v_mfma_f32_16x16x32_bf16 v[8:11], v[116:119], v[220:223], v[8:11]
    v_mfma_f32_16x16x32_bf16 v[12:15], v[188:191], v[220:223], v[12:15]
    v_mfma_f32_16x16x32_bf16 v[16:19], a[52:55], v[220:223], v[16:19]
    v_mfma_f32_16x16x32_bf16 v[20:23], a[124:127], v[220:223], v[20:23]
    s_waitcnt vmcnt(2)
    v_mfma_f32_16x16x32_bf16 v[8:11], v[120:123], v[224:227], v[8:11]
    v_mfma_f32_16x16x32_bf16 v[12:15], v[192:195], v[224:227], v[12:15]
    v_mfma_f32_16x16x32_bf16 v[16:19], a[56:59], v[224:227], v[16:19]
    v_mfma_f32_16x16x32_bf16 v[20:23], a[128:131], v[224:227], v[20:23]
    s_waitcnt vmcnt(1)
    v_mfma_f32_16x16x32_bf16 v[8:11], v[124:127], v[228:231], v[8:11]
    v_mfma_f32_16x16x32_bf16 v[12:15], v[196:199], v[228:231], v[12:15]
    v_mfma_f32_16x16x32_bf16 v[16:19], a[60:63], v[228:231], v[16:19]
    v_mfma_f32_16x16x32_bf16 v[20:23], a[132:135], v[228:231], v[20:23]
    s_waitcnt vmcnt(0)
    v_mfma_f32_16x16x32_bf16 v[8:11], v[128:131], v[232:235], v[8:11]
    v_mfma_f32_16x16x32_bf16 v[12:15], v[200:203], v[232:235], v[12:15]
    v_mfma_f32_16x16x32_bf16 v[16:19], a[64:67], v[232:235], v[16:19]
    v_mfma_f32_16x16x32_bf16 v[20:23], a[136:139], v[232:235], v[20:23]
    v_mfma_f32_16x16x32_bf16 v[8:11], v[132:135], v[236:239], v[8:11]
    v_mfma_f32_16x16x32_bf16 v[12:15], v[204:207], v[236:239], v[12:15]
    v_mfma_f32_16x16x32_bf16 v[16:19], a[68:71], v[236:239], v[16:19]
    v_mfma_f32_16x16x32_bf16 v[20:23], a[140:143], v[236:239], v[20:23]
    s_nop 7
    s_branch mk_st
mk_v:
    s_waitcnt vmcnt(17)
    s_waitcnt vmcnt(16)
    v_mfma_f32_16x16x32_bf16 v[8:11], v[24:27], v[64:67], 0
    v_mfma_f32_16x16x32_bf16 v[12:15], v[24:27], v[136:139], 0
    v_mfma_f32_16x16x32_bf16 v[16:19], v[24:27], a[0:3], 0
    v_mfma_f32_16x16x32_bf16 v[20:23], v[24:27], a[72:75], 0
    s_waitcnt vmcnt(15)
    v_mfma_f32_16x16x32_bf16 v[8:11], v[28:31], v[68:71], v[8:11]
    v_mfma_f32_16x16x32_bf16 v[12:15], v[28:31], v[140:143], v[12:15]
    v_mfma_f32_16x16x32_bf16 v[16:19], v[28:31], a[4:7], v[16:19]
    v_mfma_f32_16x16x32_bf16 v[20:23], v[28:31], a[76:79], v[20:23]
    s_waitcnt vmcnt(14)
    v_mfma_f32_16x16x32_bf16 v[8:11], v[32:35], v[72:75], v[8:11]
    v_mfma_f32_16x16x32_bf16 v[12:15], v[32:35], v[144:147], v[12:15]
    v_mfma_f32_16x16x32_bf16 v[16:19], v[32:35], a[8:11], v[16:19]
    v_mfma_f32_16x16x32_bf16 v[20:23], v[32:35], a[80:83], v[20:23]
    s_waitcnt vmcnt(13)
    v_mfma_f32_16x16x32_bf16 v[8:11], v[36:39], v[76:79], v[8:11]
    v_mfma_f32_16x16x32_bf16 v[12:15], v[36:39], v[148:151], v[12:15]
    v_mfma_f32_16x16x32_bf16 v[16:19], v[36:39], a[12:15], v[16:19]
    v_mfma_f32_16x16x32_bf16 v[20:23], v[36:39], a[84:87], v[20:23]
    s_waitcnt vmcnt(12)
    v_mfma_f32_16x16x32_bf16 v[8:11], v[40:43], v[80:83], v[8:11]
    v_mfma_f32_16x16x32_bf16 v[12:15], v[40:43], v[152:155], v[12:15]
    v_mfma_f32_16x16x32_bf16 v[16:19], v[40:43], a[16:19], v[16:19]
    v_mfma_f32_16x16x32_bf16 v[20:23], v[40:43], a[88:91], v[20:23]
    s_waitcnt vmcnt(11)
    v_mfma_f32_16x16x32_bf16 v[8:11], v[44:47], v[84:87], v[8:11]
    v_mfma_f32_16x16x32_bf16 v[12:15], v[44:47], v[156:159], v[12:15]
    v_mfma_f32_16x16x32_bf16 v[16:19], v[44:47], a[20:23], v[16:19]
    v_mfma_f32_16x16x32_bf16 v[20:23], v[44:47], a[92:95], v[20:23]
    s_waitcnt vmcnt(10)
    v_mfma_f32_16x16x32_bf16 v[8:11], v[48:51], v[88:91], v[8:11]
    v_mfma_f32_16x16x32_bf16 v[12:15], v[48:51], v[160:163], v[12:15]
    v_mfma_f32_16x16x32_bf16 v[16:19], v[48:51], a[24:27], v[16:19]
    v_mfma_f32_16x16x32_bf16 v[20:23], v[48:51], a[96:99], v[20:23]
    s_waitcnt vmcnt(9)
    v_mfma_f32_16x16x32_bf16 v[8:11], v[52:55], v[92:95], v[8:11]
    v_mfma_f32_16x16x32_bf16 v[12:15], v[52:55], v[164:167], v[12:15]
    v_mfma_f32_16x16x32_bf16 v[16:19], v[52:55], a[28:31], v[16:19]
    v_mfma_f32_16x16x32_bf16 v[20:23], v[52:55], a[100:103], v[20:23]
    s_waitcnt vmcnt(8)
    v_mfma_f32_16x16x32_bf16 v[8:11], v[56:59], v[96:99], v[8:11]
    v_mfma_f32_16x16x32_bf16 v[12:15], v[56:59], v[168:171], v[12:15]
    v_mfma_f32_16x16x32_bf16 v[16:19], v[56:59], a[32:35], v[16:19]
    v_mfma_f32_16x16x32_bf16 v[20:23], v[56:59], a[104:107], v[20:23]
    s_waitcnt vmcnt(7)
    v_mfma_f32_16x16x32_bf16 v[8:11], v[60:63], v[100:103], v[8:11]
    v_mfma_f32_16x16x32_bf16 v[12:15], v[60:63], v[172:175], v[12:15]
    v_mfma_f32_16x16x32_bf16 v[16:19], v[60:63], a[36:39], v[16:19]
    v_mfma_f32_16x16x32_bf16 v[20:23], v[60:63], a[108:111], v[20:23]
    s_waitcnt vmcnt(6)
    v_mfma_f32_16x16x32_bf16 v[8:11], v[208:211], v[104:107], v[8:11]
    v_mfma_f32_16x16x32_bf16 v[12:15], v[208:211], v[176:179], v[12:15]
    v_mfma_f32_16x16x32_bf16 v[16:19], v[208:211], a[40:43], v[16:19]
    v_mfma_f32_16x16x32_bf16 v[20:23], v[208:211], a[112:115], v[20:23]
    s_waitcnt vmcnt(5)
    v_mfma_f32_16x16x32_bf16 v[8:11], v[212:215], v[108:111], v[8:11]
    v_mfma_f32_16x16x32_bf16 v[12:15], v[212:215], v[180:183], v[12:15]
    v_mfma_f32_16x16x32_bf16 v[16:19], v[212:215], a[44:47], v[16:19]
    v_mfma_f32_16x16x32_bf16 v[20:23], v[212:215], a[116:119], v[20:23]
    s_waitcnt vmcnt(4)
    v_mfma_f32_16x16x32_bf16 v[8:11], v[216:219], v[112:115], v[8:11]
    v_mfma_f32_16x16x32_bf16 v[12:15], v[216:219], v[184:187], v[12:15]
    v_mfma_f32_16x16x32_bf16 v[16:19], v[216:219], a[48:51], v[16:19]
    v_mfma_f32_16x16x32_bf16 v[20:23], v[216:219], a[120:123], v[20:23]
    s_waitcnt vmcnt(3)
    v_mfma_f32_16x16x32_bf16 v[8:11], v[220:223], v[116:119], v[8:11]
    v_mfma_f32_16x16x32_bf16 v[12:15], v[220:223], v[188:191], v[12:15]
    v_mfma_f32_16x16x32_bf16 v[16:19], v[220:223], a[52:55], v[16:19]
    v_mfma_f32_16x16x32_bf16 v[20:23], v[220:223], a[124:127], v[20:23]
    s_waitcnt vmcnt(2)
    v_mfma_f32_16x16x32_bf16 v[8:11], v[224:227], v[120:123], v[8:11]
    v_mfma_f32_16x16x32_bf16 v[12:15], v[224:227], v[192:195], v[12:15]
    v_mfma_f32_16x16x32_bf16 v[16:19], v[224:227], a[56:59], v[16:19]
    v_mfma_f32_16x16x32_bf16 v[20:23], v[224:227], a[128:131], v[20:23]
    s_waitcnt vmcnt(1)
    v_mfma_f32_16x16x32_bf16 v[8:11], v[228:231], v[124:127], v[8:11]
    v_mfma_f32_16x16x32_bf16 v[12:15], v[228:231], v[196:199], v[12:15]
    v_mfma_f32_16x16x32_bf16 v[16:19], v[228:231], a[60:63], v[16:19]
    v_mfma_f32_16x16x32_bf16 v[20:23], v[228:231], a[132:135], v[20:23]
    s_waitcnt vmcnt(0)
    v_mfma_f32_16x16x32_bf16 v[8:11], v[232:235], v[128:131], v[8:11]
    v_mfma_f32_16x16x32_bf16 v[12:15], v[232:235], v[200:203], v[12:15]
    v_mfma_f32_16x16x32_bf16 v[16:19], v[232:235], a[64:67], v[16:19]
    v_mfma_f32_16x16x32_bf16 v[20:23], v[232:235], a[136:139], v[20:23]
    v_mfma_f32_16x16x32_bf16 v[8:11], v[236:239], v[132:135], v[8:11]
    v_mfma_f32_16x16x32_bf16 v[12:15], v[236:239], v[204:207], v[12:15]
    v_mfma_f32_16x16x32_bf16 v[16:19], v[236:239], a[68:71], v[16:19]
    v_mfma_f32_16x16x32_bf16 v[20:23], v[236:239], a[140:143], v[20:23]
    s_nop 4
    v_pk_mul_f32 v[8:9], v[8:9], 0.5 op_sel_hi:[1,0]
    v_pk_mul_f32 v[10:11], v[10:11], 0.5 op_sel_hi:[1,0]
    v_pk_mul_f32 v[12:13], v[12:13], 0.5 op_sel_hi:[1,0]
    v_pk_mul_f32 v[14:15], v[14:15], 0.5 op_sel_hi:[1,0]
    v_pk_mul_f32 v[16:17], v[16:17], 0.5 op_sel_hi:[1,0]
    v_pk_mul_f32 v[18:19], v[18:19], 0.5 op_sel_hi:[1,0]
    v_pk_mul_f32 v[20:21], v[20:21], 0.5 op_sel_hi:[1,0]
    v_pk_mul_f32 v[22:23], v[22:23], 0.5 op_sel_hi:[1,0]
mk_st:
    s_nop 1
    v_cvt_pk_bf16_f32 v24, v8, v9
    v_cvt_pk_bf16_f32 v25, v10, v11
    v_cvt_pk_bf16_f32 v26, v12, v13
    v_cvt_pk_bf16_f32 v27, v14, v15
    v_cvt_pk_bf16_f32 v28, v16, v17
    v_cvt_pk_bf16_f32 v29, v18, v19
    v_cvt_pk_bf16_f32 v30, v20, v21
    v_cvt_pk_bf16_f32 v31, v22, v23
    s_add_u32 s21, s26, 4096
    buffer_store_dwordx4 v[24:27], v1, s[4:7], s26 offen sc1
    buffer_store_dwordx4 v[28:31], v1, s[4:7], s21 offen sc1
    s_add_u32 s22, s19, s95
    s_waitcnt vmcnt(0)
    s_barrier
    v_mov_b32 v4, s22
    s_mov_b64 exec, s[34:35]
    buffer_store_dword v4, off, s[4:7], s29 sc1
    buffer_store_dword v4, off, s[4:7], s29 offset:128 sc1
    s_mov_b64 exec, -1
    s_add_u32 s19, s19, 2
    s_add_u32 s26, s26, 262144
    s_cmp_le_u32 s19, 56
    s_cbranch_scc1 mk_loop
    s_mov_b32 s45, 2
    s_mov_b32 s8, s76
    s_mov_b32 s9, s77
    s_mov_b32 s10, 4718592
    s_mov_b32 s11, 0x20000
    s_branch L_att_next
L_ssm_next:
    s_sub_u32 s93, s93, 1
    s_cbranch_scc1 L_exit
    s_mov_b32 s37, 8
    v_mov_b32 v250, 1
    v_mov_b32 v251, 163832
    v_cmp_eq_u32 vcc, 0, v0
    s_nop 0
    s_and_saveexec_b64 s[38:39], vcc
    s_cbranch_execz tk11
    buffer_atomic_add v250, off, s[84:87], s37 sc0
    s_waitcnt vmcnt(0)
    ds_write_b32 v251, v250
    s_waitcnt lgkmcnt(0)
tk11:
    s_mov_b64 exec, -1
    s_barrier
    ds_read_b32 v252, v251
    s_waitcnt lgkmcnt(0)
    v_readfirstlane_b32 s20, v252
    s_barrier
    s_nop 3
    s_cmp_ge_u32 s20, 72
    s_cbranch_scc1 L_ssm_done
    s_lshl_b32 s20, s20, 3
    v_lshrrev_b32 v5, 6, v0
    s_nop 0
    v_readfirstlane_b32 s21, v5
    v_and_b32 v1, 63, v0
    v_and_b32 v2, 15, v1
    v_lshrrev_b32 v3, 4, v1
    v_lshlrev_b32 v4, 14, v5
    s_mov_b32 s8, s62
    s_mov_b32 s9, s63
    s_mov_b32 s10, 2359296
    s_mov_b32 s11, 0x20000
    s_mov_b32 s16, s76
    s_mov_b32 s17, s77
    s_mov_b32 s18, 4718592
    s_mov_b32 s19, 0x20000
    s_add_u32 s22, s20, s21
    s_lshl_b32 s23, s22, 8
    v_lshlrev_b32 v6, 3, v2
    v_lshl_add_u32 v6, v3, 1, v6
    s_mov_b32 s12, s64
    s_mov_b32 s13, s65
    s_mov_b32 s14, 147456
    s_mov_b32 s15, 0x20000
    buffer_load_ushort v8, v6, s[12:15], s23 offen offset:0
    buffer_load_ushort v12, v6, s[12:15], s23 offen offset:128
    buffer_load_ushort v16, v6, s[12:15], s23 offen offset:1024
    buffer_load_ushort v20, v6, s[12:15], s23 offen offset:1152
    s_mov_b32 s12, s66
    s_mov_b32 s13, s67
    s_mov_b32 s14, 147456
    s_mov_b32 s15, 0x20000
    buffer_load_ushort v9, v6, s[12:15], s23 offen offset:0
    buffer_load_ushort v13, v6, s[12:15], s23 offen offset:128
    buffer_load_ushort v17, v6, s[12:15], s23 offen offset:1024
    buffer_load_ushort v21, v6, s[12:15], s23 offen offset:1152
    s_mov_b32 s12, s68
    s_mov_b32 s13, s69
    s_mov_b32 s14, 147456
    s_mov_b32 s15, 0x20000
    buffer_load_ushort v10, v6, s[12:15], s23 offen offset:0
    buffer_load_ushort v14, v6, s[12:15], s23 offen offset:128
    buffer_load_ushort v18, v6, s[12:15], s23 offen offset:1024
    buffer_load_ushort v22, v6, s[12:15], s23 offen offset:1152
    s_mov_b32 s12, s70
    s_mov_b32 s13, s71
    s_mov_b32 s14, 147456
    s_mov_b32 s15, 0x20000
    buffer_load_ushort v11, v6, s[12:15], s23 offen offset:0
    buffer_load_ushort v15, v6, s[12:15], s23 offen offset:128
    buffer_load_ushort v19, v6, s[12:15], s23 offen offset:1024
    buffer_load_ushort v23, v6, s[12:15], s23 offen offset:1152
    s_mov_b32 s12, s72
    s_mov_b32 s13, s73
    s_mov_b32 s14, 1152
    s_mov_b32 s15, 0x20000
    s_lshl_b32 s23, s22, 1
    buffer_load_ushort v24, off, s[12:15], s23
    buffer_load_ushort v25, off, s[12:15], s23 offset:8
    v_mul_u32_u24 v5, 9216, v0
    s_lshl_b32 s22, s20, 1
    s_add_u32 s23, s22, 0
    buffer_load_dwordx4 v[208:211], v5, s[8:11], s23 offen
    s_add_u32 s23, s22, 1152
    buffer_load_dwordx4 v[212:215], v5, s[8:11], s23 offen
    s_add_u32 s23, s22, 2304
    buffer_load_dwordx4 v[216:219], v5, s[8:11], s23 offen
    s_add_u32 s23, s22, 3456
    buffer_load_dwordx4 v[220:223], v5, s[8:11], s23 offen
    s_add_u32 s23, s22, 4608
    buffer_load_dwordx4 v[224:227], v5, s[8:11], s23 offen
    s_add_u32 s23, s22, 5760
    buffer_load_dwordx4 v[228:231], v5, s[8:11], s23 offen
    s_add_u32 s23, s22, 6912
    buffer_load_dwordx4 v[232:235], v5, s[8:11], s23 offen
    s_add_u32 s23, s22, 8064
    buffer_load_dwordx4 v[236:239], v5, s[8:11], s23 offen
    s_mov_b32 s26, 0x3fb8aa3b
    s_mov_b32 s27, 0x3e22f983
    s_mov_b32 s28, 0
    v_cvt_f32_u32 v26, v2
    v_mul_f32 v27, 0x41800000, v26
    s_waitcnt vmcnt(8)
    s_nop 0
ss_pass:
    v_mov_b32 v36, 0
    v_mov_b32 v37, 0
    v_lshl_add_u32 v6, v1, 3, v4
    ds_write_b64 v6, v[36:37] offset:0
    v_lshlrev_b32 v38, 16, v24
    v_mul_f32 v38, s26, v38
    v_exp_f32 v38, v38
    s_nop 0
    v_cvt_pk_bf16_f32 v38, v38, v38
    v_and_b32 v38, 0xffff0000, v38
    v_add_f32 v39, v38, v38
    v_lshlrev_b32 v28, 16, v8
    v_mul_f32 v28, s26, v28
    v_exp_f32 v28, v28
    s_nop 0
    v_cvt_pk_bf16_f32 v28, v28, v28
    v_and_b32 v28, 0xffff0000, v28
    v_mul_f32 v28, v28, v38
    v_mul_f32 v28, s26, v28
    v_sub_f32 v28, 0, v28
    v_lshlrev_b32 v29, 16, v9
    v_mul_f32 v29, v29, v38
    v_mul_f32 v29, s27, v29
    v_lshlrev_b32 v30, 16, v10
    v_mul_f32 v30, v30, v39
    v_lshlrev_b32 v31, 16, v11
    v_mul_f32 v31, v31, v39
    v_lshlrev_b32 v32, 16, v12
    v_mul_f32 v32, s26, v32
    v_exp_f32 v32, v32
    s_nop 0
    v_cvt_pk_bf16_f32 v32, v32, v32
    v_and_b32 v32, 0xffff0000, v32
    v_mul_f32 v32, v32, v38
    v_mul_f32 v32, s26, v32
    v_sub_f32 v32, 0, v32
    v_lshlrev_b32 v33, 16, v13
    v_mul_f32 v33, v33, v38
    v_mul_f32 v33, s27, v33
    v_lshlrev_b32 v34, 16, v14
    v_mul_f32 v34, v34, v39
    v_lshlrev_b32 v35, 16, v15
    v_mul_f32 v35, v35, v39
    v_mov_b64 v[48:49], 0
    v_mov_b64 v[50:51], 0
    v_mov_b64 v[52:53], 0
    v_mov_b64 v[54:55], 0
    v_mov_b64 v[56:57], 0
    v_mov_b64 v[58:59], 0
    v_mov_b64 v[60:61], 0
    v_mov_b64 v[62:63], 0
    s_mov_b32 s25, 0
    s_nop 0
ss_kg:
    v_mov_b64_dpp v[64:65], v[28:29] row_newbcast:0 row_mask:0xf bank_mask:0xf
    v_mov_b64_dpp v[66:67], v[30:31] row_newbcast:0 row_mask:0xf bank_mask:0xf
    v_pk_mul_f32 v[94:95], v[64:65], v[26:27] op_sel_hi:[1,0]
    v_pk_mul_f32 v[96:97], v[64:65], v[26:27] op_sel:[0,1] op_sel_hi:[1,1]
    v_fract_f32 v95, v95
    v_fract_f32 v97, v97
    v_exp_f32 v94, v94
    v_exp_f32 v96, v96
    v_cos_f32 v68, v95
    v_sin_f32 v69, v95
    v_cos_f32 v76, v97
    v_sin_f32 v77, v97
    v_pk_mul_f32 v[68:69], v[68:69], v[94:95] op_sel_hi:[1,0]
    v_pk_mul_f32 v[76:77], v[76:77], v[96:97] op_sel_hi:[1,0]
    v_pk_mul_f32 v[92:93], v[76:77], v[76:77] op_sel:[1,1] op_sel_hi:[0,1]
    v_pk_fma_f32 v[78:79], v[76:77], v[76:77], v[92:93] op_sel:[0,0,0] op_sel_hi:[0,1,1] neg_lo:[0,0,1]
    v_pk_mul_f32 v[94:95], v[68:69], v[68:69] op_sel:[1,1] op_sel_hi:[0,1]
    v_pk_fma_f32 v[70:71], v[68:69], v[68:69], v[94:95] op_sel:[0,0,0] op_sel_hi:[0,1,1] neg_lo:[0,0,1]
    v_pk_mul_f32 v[92:93], v[78:79], v[78:79] op_sel:[1,1] op_sel_hi:[0,1]
    v_pk_fma_f32 v[80:81], v[78:79], v[78:79], v[92:93] op_sel:[0,0,0] op_sel_hi:[0,1,1] neg_lo:[0,0,1]
    v_pk_mul_f32 v[94:95], v[70:71], v[70:71] op_sel:[1,1] op_sel_hi:[0,1]
    v_pk_fma_f32 v[72:73], v[70:71], v[70:71], v[94:95] op_sel:[0,0,0] op_sel_hi:[0,1,1] neg_lo:[0,0,1]
    v_pk_mul_f32 v[92:93], v[80:81], v[80:81] op_sel:[1,1] op_sel_hi:[0,1]
    v_pk_fma_f32 v[82:83], v[80:81], v[80:81], v[92:93] op_sel:[0,0,0] op_sel_hi:[0,1,1] neg_lo:[0,0,1]
    v_pk_mul_f32 v[94:95], v[72:73], v[72:73] op_sel:[1,1] op_sel_hi:[0,1]
    v_pk_fma_f32 v[74:75], v[72:73], v[72:73], v[94:95] op_sel:[0,0,0] op_sel_hi:[0,1,1] neg_lo:[0,0,1]
    v_pk_mul_f32 v[92:93], v[82:83], v[82:83] op_sel:[1,1] op_sel_hi:[0,1]
    v_pk_fma_f32 v[84:85], v[82:83], v[82:83], v[92:93] op_sel:[0,0,0] op_sel_hi:[0,1,1] neg_lo:[0,0,1]
    v_pk_mul_f32 v[94:95], v[66:67], v[76:77] op_sel:[1,1] op_sel_hi:[1,0]
    v_pk_fma_f32 v[86:87], v[66:67], v[76:77], v[94:95] op_sel:[0,0,0] op_sel_hi:[0,1,1] neg_lo:[0,0,1] neg_hi:[1,0,1]
    v_mov_b32_dpp v80, v78 row_ror:8 row_mask:0xf bank_mask:0x3
    v_mov_b32_dpp v81, v79 row_ror:8 row_mask:0xf bank_mask:0x3
    v_mov_b32_dpp v82, v84 row_ror:8 row_mask:0xf bank_mask:0x3
    v_mov_b32_dpp v83, v85 row_ror:8 row_mask:0xf bank_mask:0x3
    v_pk_mul_f32 v[92:93], v[66:67], v[80:81] op_sel:[1,1] op_sel_hi:[1,0]
    v_pk_fma_f32 v[88:89], v[66:67], v[80:81], v[92:93] op_sel:[0,0,0] op_sel_hi:[0,1,1] neg_lo:[0,0,1] neg_hi:[1,0,1]
    v_pk_mul_f32 v[94:95], v[66:67], v[82:83] op_sel:[1,1] op_sel_hi:[1,0]
    v_pk_fma_f32 v[90:91], v[66:67], v[82:83], v[94:95] op_sel:[0,0,0] op_sel_hi:[0,1,1] neg_lo:[0,0,1] neg_hi:[1,0,1]
    v_mfma_f32_16x16x4_f32 v[48:51], v86, v68, v[48:51]
    v_mfma_f32_16x16x4_f32 v[52:55], v88, v70, v[52:55]
    v_mfma_f32_16x16x4_f32 v[56:59], v88, v72, v[56:59]
    v_mfma_f32_16x16x4_f32 v[60:63], v90, v74, v[60:63]
    v_mfma_f32_16x16x4_f32 v[48:51], v87, v69, v[48:51]
    v_mfma_f32_16x16x4_f32 v[52:55], v89, v71, v[52:55]
    v_mfma_f32_16x16x4_f32 v[56:59], v89, v73, v[56:59]
    v_mfma_f32_16x16x4_f32 v[60:63], v91, v75, v[60:63]
    v_mov_b64_dpp v[64:65], v[28:29] row_newbcast:1 row_mask:0xf bank_mask:0xf
    v_mov_b64_dpp v[66:67], v[30:31] row_newbcast:1 row_mask:0xf bank_mask:0xf
    v_pk_mul_f32 v[94:95], v[64:65], v[26:27] op_sel_hi:[1,0]
    v_pk_mul_f32 v[96:97], v[64:65], v[26:27] op_sel:[0,1] op_sel_hi:[1,1]
    v_fract_f32 v95, v95
    v_fract_f32 v97, v97
    v_exp_f32 v94, v94
    v_exp_f32 v96, v96
    v_cos_f32 v68, v95
    v_sin_f32 v69, v95
    v_cos_f32 v76, v97
    v_sin_f32 v77, v97
    v_pk_mul_f32 v[68:69], v[68:69], v[94:95] op_sel_hi:[1,0]
    v_pk_mul_f32 v[76:77], v[76:77], v[96:97] op_sel_hi:[1,0]
    v_pk_mul_f32 v[92:93], v[76:77], v[76:77] op_sel:[1,1] op_sel_hi:[0,1]
    v_pk_fma_f32 v[78:79], v[76:77], v[76:77], v[92:93] op_sel:[0,0,0] op_sel_hi:[0,1,1] neg_lo:[0,0,1]
    v_pk_mul_f32 v[94:95], v[68:69], v[68:69] op_sel:[1,1] op_sel_hi:[0,1]
    v_pk_fma_f32 v[70:71], v[68:69], v[68:69], v[94:95] op_sel:[0,0,0] op_sel_hi:[0,1,1] neg_lo:[0,0,1]
    v_pk_mul_f32 v[92:93], v[78:79], v[78:79] op_sel:[1,1] op_sel_hi:[0,1]
    v_pk_fma_f32 v[80:81], v[78:79], v[78:79], v[92:93] op_sel:[0,0,0] op_sel_hi:[0,1,1] neg_lo:[0,0,1]
    v_pk_mul_f32 v[94:95], v[70:71], v[70:71] op_sel:[1,1] op_sel_hi:[0,1]
    v_pk_fma_f32 v[72:73], v[70:71], v[70:71], v[94:95] op_sel:[0,0,0] op_sel_hi:[0,1,1] neg_lo:[0,0,1]
    v_pk_mul_f32 v[92:93], v[80:81], v[80:81] op_sel:[1,1] op_sel_hi:[0,1]
    v_pk_fma_f32 v[82:83], v[80:81], v[80:81], v[92:93] op_sel:[0,0,0] op_sel_hi:[0,1,1] neg_lo:[0,0,1]
    v_pk_mul_f32 v[94:95], v[72:73], v[72:73] op_sel:[1,1] op_sel_hi:[0,1]
    v_pk_fma_f32 v[74:75], v[72:73], v[72:73], v[94:95] op_sel:[0,0,0] op_sel_hi:[0,1,1] neg_lo:[0,0,1]
    v_pk_mul_f32 v[92:93], v[82:83], v[82:83] op_sel:[1,1] op_sel_hi:[0,1]
    v_pk_fma_f32 v[84:85], v[82:83], v[82:83], v[92:93] op_sel:[0,0,0] op_sel_hi:[0,1,1] neg_lo:[0,0,1]
    v_pk_mul_f32 v[94:95], v[66:67], v[76:77] op_sel:[1,1] op_sel_hi:[1,0]
    v_pk_fma_f32 v[86:87], v[66:67], v[76:77], v[94:95] op_sel:[0,0,0] op_sel_hi:[0,1,1] neg_lo:[0,0,1] neg_hi:[1,0,1]
    v_mov_b32_dpp v80, v78 row_ror:8 row_mask:0xf bank_mask:0x3
    v_mov_b32_dpp v81, v79 row_ror:8 row_mask:0xf bank_mask:0x3
    v_mov_b32_dpp v82, v84 row_ror:8 row_mask:0xf bank_mask:0x3
    v_mov_b32_dpp v83, v85 row_ror:8 row_mask:0xf bank_mask:0x3
    v_pk_mul_f32 v[92:93], v[66:67], v[80:81] op_sel:[1,1] op_sel_hi:[1,0]
    v_pk_fma_f32 v[88:89], v[66:67], v[80:81], v[92:93] op_sel:[0,0,0] op_sel_hi:[0,1,1] neg_lo:[0,0,1] neg_hi:[1,0,1]
    v_pk_mul_f32 v[94:95], v[66:67], v[82:83] op_sel:[1,1] op_sel_hi:[1,0]
    v_pk_fma_f32 v[90:91], v[66:67], v[82:83], v[94:95] op_sel:[0,0,0] op_sel_hi:[0,1,1] neg_lo:[0,0,1] neg_hi:[1,0,1]
    v_mfma_f32_16x16x4_f32 v[48:51], v86, v68, v[48:51]
    v_mfma_f32_16x16x4_f32 v[52:55], v88, v70, v[52:55]
    v_mfma_f32_16x16x4_f32 v[56:59], v88, v72, v[56:59]
    v_mfma_f32_16x16x4_f32 v[60:63], v90, v74, v[60:63]
    v_mfma_f32_16x16x4_f32 v[48:51], v87, v69, v[48:51]
    v_mfma_f32_16x16x4_f32 v[52:55], v89, v71, v[52:55]
    v_mfma_f32_16x16x4_f32 v[56:59], v89, v73, v[56:59]
    v_mfma_f32_16x16x4_f32 v[60:63], v91, v75, v[60:63]
    v_mov_b64_dpp v[64:65], v[28:29] row_newbcast:2 row_mask:0xf bank_mask:0xf
    v_mov_b64_dpp v[66:67], v[30:31] row_newbcast:2 row_mask:0xf bank_mask:0xf
    v_pk_mul_f32 v[94:95], v[64:65], v[26:27] op_sel_hi:[1,0]
    v_pk_mul_f32 v[96:97], v[64:65], v[26:27] op_sel:[0,1] op_sel_hi:[1,1]
    v_fract_f32 v95, v95
    v_fract_f32 v97, v97
    v_exp_f32 v94, v94
    v_exp_f32 v96, v96
    v_cos_f32 v68, v95
    v_sin_f32 v69, v95
    v_cos_f32 v76, v97
    v_sin_f32 v77, v97
    v_pk_mul_f32 v[68:69], v[68:69], v[94:95] op_sel_hi:[1,0]
    v_pk_mul_f32 v[76:77], v[76:77], v[96:97] op_sel_hi:[1,0]
    v_pk_mul_f32 v[92:93], v[76:77], v[76:77] op_sel:[1,1] op_sel_hi:[0,1]
    v_pk_fma_f32 v[78:79], v[76:77], v[76:77], v[92:93] op_sel:[0,0,0] op_sel_hi:[0,1,1] neg_lo:[0,0,1]
    v_pk_mul_f32 v[94:95], v[68:69], v[68:69] op_sel:[1,1] op_sel_hi:[0,1]
    v_pk_fma_f32 v[70:71], v[68:69], v[68:69], v[94:95] op_sel:[0,0,0] op_sel_hi:[0,1,1] neg_lo:[0,0,1]
    v_pk_mul_f32 v[92:93], v[78:79], v[78:79] op_sel:[1,1] op_sel_hi:[0,1]
    v_pk_fma_f32 v[80:81], v[78:79], v[78:79], v[92:93] op_sel:[0,0,0] op_sel_hi:[0,1,1] neg_lo:[0,0,1]
    v_pk_mul_f32 v[94:95], v[70:71], v[70:71] op_sel:[1,1] op_sel_hi:[0,1]
    v_pk_fma_f32 v[72:73], v[70:71], v[70:71], v[94:95] op_sel:[0,0,0] op_sel_hi:[0,1,1] neg_lo:[0,0,1]
    v_pk_mul_f32 v[92:93], v[80:81], v[80:81] op_sel:[1,1] op_sel_hi:[0,1]
    v_pk_fma_f32 v[82:83], v[80:81], v[80:81], v[92:93] op_sel:[0,0,0] op_sel_hi:[0,1,1] neg_lo:[0,0,1]
    v_pk_mul_f32 v[94:95], v[72:73], v[72:73] op_sel:[1,1] op_sel_hi:[0,1]
    v_pk_fma_f32 v[74:75], v[72:73], v[72:73], v[94:95] op_sel:[0,0,0] op_sel_hi:[0,1,1] neg_lo:[0,0,1]
    v_pk_mul_f32 v[92:93], v[82:83], v[82:83] op_sel:[1,1] op_sel_hi:[0,1]
    v_pk_fma_f32 v[84:85], v[82:83], v[82:83], v[92:93] op_sel:[0,0,0] op_sel_hi:[0,1,1] neg_lo:[0,0,1]
    v_pk_mul_f32 v[94:95], v[66:67], v[76:77] op_sel:[1,1] op_sel_hi:[1,0]
    v_pk_fma_f32 v[86:87], v[66:67], v[76:77], v[94:95] op_sel:[0,0,0] op_sel_hi:[0,1,1] neg_lo:[0,0,1] neg_hi:[1,0,1]
    v_mov_b32_dpp v80, v78 row_ror:8 row_mask:0xf bank_mask:0x3
    v_mov_b32_dpp v81, v79 row_ror:8 row_mask:0xf bank_mask:0x3
    v_mov_b32_dpp v82, v84 row_ror:8 row_mask:0xf bank_mask:0x3
    v_mov_b32_dpp v83, v85 row_ror:8 row_mask:0xf bank_mask:0x3
    v_pk_mul_f32 v[92:93], v[66:67], v[80:81] op_sel:[1,1] op_sel_hi:[1,0]
    v_pk_fma_f32 v[88:89], v[66:67], v[80:81], v[92:93] op_sel:[0,0,0] op_sel_hi:[0,1,1] neg_lo:[0,0,1] neg_hi:[1,0,1]
    v_pk_mul_f32 v[94:95], v[66:67], v[82:83] op_sel:[1,1] op_sel_hi:[1,0]
    v_pk_fma_f32 v[90:91], v[66:67], v[82:83], v[94:95] op_sel:[0,0,0] op_sel_hi:[0,1,1] neg_lo:[0,0,1] neg_hi:[1,0,1]
    v_mfma_f32_16x16x4_f32 v[48:51], v86, v68, v[48:51]
    v_mfma_f32_16x16x4_f32 v[52:55], v88, v70, v[52:55]
    v_mfma_f32_16x16x4_f32 v[56:59], v88, v72, v[56:59]
    v_mfma_f32_16x16x4_f32 v[60:63], v90, v74, v[60:63]
    v_mfma_f32_16x16x4_f32 v[48:51], v87, v69, v[48:51]
    v_mfma_f32_16x16x4_f32 v[52:55], v89, v71, v[52:55]
    v_mfma_f32_16x16x4_f32 v[56:59], v89, v73, v[56:59]
    v_mfma_f32_16x16x4_f32 v[60:63], v91, v75, v[60:63]
    v_mov_b64_dpp v[64:65], v[28:29] row_newbcast:3 row_mask:0xf bank_mask:0xf
    v_mov_b64_dpp v[66:67], v[30:31] row_newbcast:3 row_mask:0xf bank_mask:0xf
    v_pk_mul_f32 v[94:95], v[64:65], v[26:27] op_sel_hi:[1,0]
    v_pk_mul_f32 v[96:97], v[64:65], v[26:27] op_sel:[0,1] op_sel_hi:[1,1]
    v_fract_f32 v95, v95
    v_fract_f32 v97, v97
    v_exp_f32 v94, v94
    v_exp_f32 v96, v96
    v_cos_f32 v68, v95
    v_sin_f32 v69, v95
    v_cos_f32 v76, v97
    v_sin_f32 v77, v97
    v_pk_mul_f32 v[68:69], v[68:69], v[94:95] op_sel_hi:[1,0]
    v_pk_mul_f32 v[76:77], v[76:77], v[96:97] op_sel_hi:[1,0]
    v_pk_mul_f32 v[92:93], v[76:77], v[76:77] op_sel:[1,1] op_sel_hi:[0,1]
    v_pk_fma_f32 v[78:79], v[76:77], v[76:77], v[92:93] op_sel:[0,0,0] op_sel_hi:[0,1,1] neg_lo:[0,0,1]
    v_pk_mul_f32 v[94:95], v[68:69], v[68:69] op_sel:[1,1] op_sel_hi:[0,1]
    v_pk_fma_f32 v[70:71], v[68:69], v[68:69], v[94:95] op_sel:[0,0,0] op_sel_hi:[0,1,1] neg_lo:[0,0,1]
    v_pk_mul_f32 v[92:93], v[78:79], v[78:79] op_sel:[1,1] op_sel_hi:[0,1]
    v_pk_fma_f32 v[80:81], v[78:79], v[78:79], v[92:93] op_sel:[0,0,0] op_sel_hi:[0,1,1] neg_lo:[0,0,1]
    v_pk_mul_f32 v[94:95], v[70:71], v[70:71] op_sel:[1,1] op_sel_hi:[0,1]
    v_pk_fma_f32 v[72:73], v[70:71], v[70:71], v[94:95] op_sel:[0,0,0] op_sel_hi:[0,1,1] neg_lo:[0,0,1]
    v_pk_mul_f32 v[92:93], v[80:81], v[80:81] op_sel:[1,1] op_sel_hi:[0,1]
    v_pk_fma_f32 v[82:83], v[80:81], v[80:81], v[92:93] op_sel:[0,0,0] op_sel_hi:[0,1,1] neg_lo:[0,0,1]
    v_pk_mul_f32 v[94:95], v[72:73], v[72:73] op_sel:[1,1] op_sel_hi:[0,1]
    v_pk_fma_f32 v[74:75], v[72:73], v[72:73], v[94:95] op_sel:[0,0,0] op_sel_hi:[0,1,1] neg_lo:[0,0,1]
    v_pk_mul_f32 v[92:93], v[82:83], v[82:83] op_sel:[1,1] op_sel_hi:[0,1]
    v_pk_fma_f32 v[84:85], v[82:83], v[82:83], v[92:93] op_sel:[0,0,0] op_sel_hi:[0,1,1] neg_lo:[0,0,1]
    v_pk_mul_f32 v[94:95], v[66:67], v[76:77] op_sel:[1,1] op_sel_hi:[1,0]
    v_pk_fma_f32 v[86:87], v[66:67], v[76:77], v[94:95] op_sel:[0,0,0] op_sel_hi:[0,1,1] neg_lo:[0,0,1] neg_hi:[1,0,1]
    v_mov_b32_dpp v80, v78 row_ror:8 row_mask:0xf bank_mask:0x3
    v_mov_b32_dpp v81, v79 row_ror:8 row_mask:0xf bank_mask:0x3
    v_mov_b32_dpp v82, v84 row_ror:8 row_mask:0xf bank_mask:0x3
    v_mov_b32_dpp v83, v85 row_ror:8 row_mask:0xf bank_mask:0x3
    v_pk_mul_f32 v[92:93], v[66:67], v[80:81] op_sel:[1,1] op_sel_hi:[1,0]
    v_pk_fma_f32 v[88:89], v[66:67], v[80:81], v[92:93] op_sel:[0,0,0] op_sel_hi:[0,1,1] neg_lo:[0,0,1] neg_hi:[1,0,1]
    v_pk_mul_f32 v[94:95], v[66:67], v[82:83] op_sel:[1,1] op_sel_hi:[1,0]
    v_pk_fma_f32 v[90:91], v[66:67], v[82:83], v[94:95] op_sel:[0,0,0] op_sel_hi:[0,1,1] neg_lo:[0,0,1] neg_hi:[1,0,1]
    v_mfma_f32_16x16x4_f32 v[48:51], v86, v68, v[48:51]
    v_mfma_f32_16x16x4_f32 v[52:55], v88, v70, v[52:55]
    v_mfma_f32_16x16x4_f32 v[56:59], v88, v72, v[56:59]
    v_mfma_f32_16x16x4_f32 v[60:63], v90, v74, v[60:63]
    v_mfma_f32_16x16x4_f32 v[48:51], v87, v69, v[48:51]
    v_mfma_f32_16x16x4_f32 v[52:55], v89, v71, v[52:55]
    v_mfma_f32_16x16x4_f32 v[56:59], v89, v73, v[56:59]
    v_mfma_f32_16x16x4_f32 v[60:63], v91, v75, v[60:63]
    v_mov_b64_dpp v[64:65], v[28:29] row_newbcast:4 row_mask:0xf bank_mask:0xf
    v_mov_b64_dpp v[66:67], v[30:31] row_newbcast:4 row_mask:0xf bank_mask:0xf
    v_pk_mul_f32 v[94:95], v[64:65], v[26:27] op_sel_hi:[1,0]
    v_pk_mul_f32 v[96:97], v[64:65], v[26:27] op_sel:[0,1] op_sel_hi:[1,1]
    v_fract_f32 v95, v95
    v_fract_f32 v97, v97
    v_exp_f32 v94, v94
    v_exp_f32 v96, v96
    v_cos_f32 v68, v95
    v_sin_f32 v69, v95
    v_cos_f32 v76, v97
    v_sin_f32 v77, v97
    v_pk_mul_f32 v[68:69], v[68:69], v[94:95] op_sel_hi:[1,0]
    v_pk_mul_f32 v[76:77], v[76:77], v[96:97] op_sel_hi:[1,0]
    v_pk_mul_f32 v[92:93], v[76:77], v[76:77] op_sel:[1,1] op_sel_hi:[0,1]
    v_pk_fma_f32 v[78:79], v[76:77], v[76:77], v[92:93] op_sel:[0,0,0] op_sel_hi:[0,1,1] neg_lo:[0,0,1]
    v_pk_mul_f32 v[94:95], v[68:69], v[68:69] op_sel:[1,1] op_sel_hi:[0,1]
    v_pk_fma_f32 v[70:71], v[68:69], v[68:69], v[94:95] op_sel:[0,0,0] op_sel_hi:[0,1,1] neg_lo:[0,0,1]
    v_pk_mul_f32 v[92:93], v[78:79], v[78:79] op_sel:[1,1] op_sel_hi:[0,1]
    v_pk_fma_f32 v[80:81], v[78:79], v[78:79], v[92:93] op_sel:[0,0,0] op_sel_hi:[0,1,1] neg_lo:[0,0,1]
    v_pk_mul_f32 v[94:95], v[70:71], v[70:71] op_sel:[1,1] op_sel_hi:[0,1]
    v_pk_fma_f32 v[72:73], v[70:71], v[70:71], v[94:95] op_sel:[0,0,0] op_sel_hi:[0,1,1] neg_lo:[0,0,1]
    v_pk_mul_f32 v[92:93], v[80:81], v[80:81] op_sel:[1,1] op_sel_hi:[0,1]
    v_pk_fma_f32 v[82:83], v[80:81], v[80:81], v[92:93] op_sel:[0,0,0] op_sel_hi:[0,1,1] neg_lo:[0,0,1]
    v_pk_mul_f32 v[94:95], v[72:73], v[72:73] op_sel:[1,1] op_sel_hi:[0,1]
    v_pk_fma_f32 v[74:75], v[72:73], v[72:73], v[94:95] op_sel:[0,0,0] op_sel_hi:[0,1,1] neg_lo:[0,0,1]
    v_pk_mul_f32 v[92:93], v[82:83], v[82:83] op_sel:[1,1] op_sel_hi:[0,1]
    v_pk_fma_f32 v[84:85], v[82:83], v[82:83], v[92:93] op_sel:[0,0,0] op_sel_hi:[0,1,1] neg_lo:[0,0,1]
    v_pk_mul_f32 v[94:95], v[66:67], v[76:77] op_sel:[1,1] op_sel_hi:[1,0]
    v_pk_fma_f32 v[86:87], v[66:67], v[76:77], v[94:95] op_sel:[0,0,0] op_sel_hi:[0,1,1] neg_lo:[0,0,1] neg_hi:[1,0,1]
    v_mov_b32_dpp v80, v78 row_ror:8 row_mask:0xf bank_mask:0x3
    v_mov_b32_dpp v81, v79 row_ror:8 row_mask:0xf bank_mask:0x3
    v_mov_b32_dpp v82, v84 row_ror:8 row_mask:0xf bank_mask:0x3
    v_mov_b32_dpp v83, v85 row_ror:8 row_mask:0xf bank_mask:0x3
    v_pk_mul_f32 v[92:93], v[66:67], v[80:81] op_sel:[1,1] op_sel_hi:[1,0]
    v_pk_fma_f32 v[88:89], v[66:67], v[80:81], v[92:93] op_sel:[0,0,0] op_sel_hi:[0,1,1] neg_lo:[0,0,1] neg_hi:[1,0,1]
    v_pk_mul_f32 v[94:95], v[66:67], v[82:83] op_sel:[1,1] op_sel_hi:[1,0]
    v_pk_fma_f32 v[90:91], v[66:67], v[82:83], v[94:95] op_sel:[0,0,0] op_sel_hi:[0,1,1] neg_lo:[0,0,1] neg_hi:[1,0,1]
    v_mfma_f32_16x16x4_f32 v[48:51], v86, v68, v[48:51]
    v_mfma_f32_16x16x4_f32 v[52:55], v88, v70, v[52:55]
    v_mfma_f32_16x16x4_f32 v[56:59], v88, v72, v[56:59]
    v_mfma_f32_16x16x4_f32 v[60:63], v90, v74, v[60:63]
    v_mfma_f32_16x16x4_f32 v[48:51], v87, v69, v[48:51]
    v_mfma_f32_16x16x4_f32 v[52:55], v89, v71, v[52:55]
    v_mfma_f32_16x16x4_f32 v[56:59], v89, v73, v[56:59]
    v_mfma_f32_16x16x4_f32 v[60:63], v91, v75, v[60:63]
    v_mov_b64_dpp v[64:65], v[28:29] row_newbcast:5 row_mask:0xf bank_mask:0xf
    v_mov_b64_dpp v[66:67], v[30:31] row_newbcast:5 row_mask:0xf bank_mask:0xf
    v_pk_mul_f32 v[94:95], v[64:65], v[26:27] op_sel_hi:[1,0]
    v_pk_mul_f32 v[96:97], v[64:65], v[26:27] op_sel:[0,1] op_sel_hi:[1,1]
    v_fract_f32 v95, v95
    v_fract_f32 v97, v97
    v_exp_f32 v94, v94
    v_exp_f32 v96, v96
    v_cos_f32 v68, v95
    v_sin_f32 v69, v95
    v_cos_f32 v76, v97
    v_sin_f32 v77, v97
    v_pk_mul_f32 v[68:69], v[68:69], v[94:95] op_sel_hi:[1,0]
    v_pk_mul_f32 v[76:77], v[76:77], v[96:97] op_sel_hi:[1,0]
    v_pk_mul_f32 v[92:93], v[76:77], v[76:77] op_sel:[1,1] op_sel_hi:[0,1]
    v_pk_fma_f32 v[78:79], v[76:77], v[76:77], v[92:93] op_sel:[0,0,0] op_sel_hi:[0,1,1] neg_lo:[0,0,1]
    v_pk_mul_f32 v[94:95], v[68:69], v[68:69] op_sel:[1,1] op_sel_hi:[0,1]
    v_pk_fma_f32 v[70:71], v[68:69], v[68:69], v[94:95] op_sel:[0,0,0] op_sel_hi:[0,1,1] neg_lo:[0,0,1]
    v_pk_mul_f32 v[92:93], v[78:79], v[78:79] op_sel:[1,1] op_sel_hi:[0,1]
    v_pk_fma_f32 v[80:81], v[78:79], v[78:79], v[92:93] op_sel:[0,0,0] op_sel_hi:[0,1,1] neg_lo:[0,0,1]
    v_pk_mul_f32 v[94:95], v[70:71], v[70:71] op_sel:[1,1] op_sel_hi:[0,1]
    v_pk_fma_f32 v[72:73], v[70:71], v[70:71], v[94:95] op_sel:[0,0,0] op_sel_hi:[0,1,1] neg_lo:[0,0,1]
    v_pk_mul_f32 v[92:93], v[80:81], v[80:81] op_sel:[1,1] op_sel_hi:[0,1]
    v_pk_fma_f32 v[82:83], v[80:81], v[80:81], v[92:93] op_sel:[0,0,0] op_sel_hi:[0,1,1] neg_lo:[0,0,1]
    v_pk_mul_f32 v[94:95], v[72:73], v[72:73] op_sel:[1,1] op_sel_hi:[0,1]
    v_pk_fma_f32 v[74:75], v[72:73], v[72:73], v[94:95] op_sel:[0,0,0] op_sel_hi:[0,1,1] neg_lo:[0,0,1]
    v_pk_mul_f32 v[92:93], v[82:83], v[82:83] op_sel:[1,1] op_sel_hi:[0,1]
    v_pk_fma_f32 v[84:85], v[82:83], v[82:83], v[92:93] op_sel:[0,0,0] op_sel_hi:[0,1,1] neg_lo:[0,0,1]
    v_pk_mul_f32 v[94:95], v[66:67], v[76:77] op_sel:[1,1] op_sel_hi:[1,0]
    v_pk_fma_f32 v[86:87], v[66:67], v[76:77], v[94:95] op_sel:[0,0,0] op_sel_hi:[0,1,1] neg_lo:[0,0,1] neg_hi:[1,0,1]
    v_mov_b32_dpp v80, v78 row_ror:8 row_mask:0xf bank_mask:0x3
    v_mov_b32_dpp v81, v79 row_ror:8 row_mask:0xf bank_mask:0x3
    v_mov_b32_dpp v82, v84 row_ror:8 row_mask:0xf bank_mask:0x3
    v_mov_b32_dpp v83, v85 row_ror:8 row_mask:0xf bank_mask:0x3
    v_pk_mul_f32 v[92:93], v[66:67], v[80:81] op_sel:[1,1] op_sel_hi:[1,0]
    v_pk_fma_f32 v[88:89], v[66:67], v[80:81], v[92:93] op_sel:[0,0,0] op_sel_hi:[0,1,1] neg_lo:[0,0,1] neg_hi:[1,0,1]
    v_pk_mul_f32 v[94:95], v[66:67], v[82:83] op_sel:[1,1] op_sel_hi:[1,0]
    v_pk_fma_f32 v[90:91], v[66:67], v[82:83], v[94:95] op_sel:[0,0,0] op_sel_hi:[0,1,1] neg_lo:[0,0,1] neg_hi:[1,0,1]
    v_mfma_f32_16x16x4_f32 v[48:51], v86, v68, v[48:51]
    v_mfma_f32_16x16x4_f32 v[52:55], v88, v70, v[52:55]
    v_mfma_f32_16x16x4_f32 v[56:59], v88, v72, v[56:59]
    v_mfma_f32_16x16x4_f32 v[60:63], v90, v74, v[60:63]
    v_mfma_f32_16x16x4_f32 v[48:51], v87, v69, v[48:51]
    v_mfma_f32_16x16x4_f32 v[52:55], v89, v71, v[52:55]
    v_mfma_f32_16x16x4_f32 v[56:59], v89, v73, v[56:59]
    v_mfma_f32_16x16x4_f32 v[60:63], v91, v75, v[60:63]
    v_mov_b64_dpp v[64:65], v[28:29] row_newbcast:6 row_mask:0xf bank_mask:0xf
    v_mov_b64_dpp v[66:67], v[30:31] row_newbcast:6 row_mask:0xf bank_mask:0xf
    v_pk_mul_f32 v[94:95], v[64:65], v[26:27] op_sel_hi:[1,0]
    v_pk_mul_f32 v[96:97], v[64:65], v[26:27] op_sel:[0,1] op_sel_hi:[1,1]
    v_fract_f32 v95, v95
    v_fract_f32 v97, v97
    v_exp_f32 v94, v94
    v_exp_f32 v96, v96
    v_cos_f32 v68, v95
    v_sin_f32 v69, v95
    v_cos_f32 v76, v97
    v_sin_f32 v77, v97
    v_pk_mul_f32 v[68:69], v[68:69], v[94:95] op_sel_hi:[1,0]
    v_pk_mul_f32 v[76:77], v[76:77], v[96:97] op_sel_hi:[1,0]
    v_pk_mul_f32 v[92:93], v[76:77], v[76:77] op_sel:[1,1] op_sel_hi:[0,1]
    v_pk_fma_f32 v[78:79], v[76:77], v[76:77], v[92:93] op_sel:[0,0,0] op_sel_hi:[0,1,1] neg_lo:[0,0,1]
    v_pk_mul_f32 v[94:95], v[68:69], v[68:69] op_sel:[1,1] op_sel_hi:[0,1]
    v_pk_fma_f32 v[70:71], v[68:69], v[68:69], v[94:95] op_sel:[0,0,0] op_sel_hi:[0,1,1] neg_lo:[0,0,1]
    v_pk_mul_f32 v[92:93], v[78:79], v[78:79] op_sel:[1,1] op_sel_hi:[0,1]
    v_pk_fma_f32 v[80:81], v[78:79], v[78:79], v[92:93] op_sel:[0,0,0] op_sel_hi:[0,1,1] neg_lo:[0,0,1]
    v_pk_mul_f32 v[94:95], v[70:71], v[70:71] op_sel:[1,1] op_sel_hi:[0,1]
    v_pk_fma_f32 v[72:73], v[70:71], v[70:71], v[94:95] op_sel:[0,0,0] op_sel_hi:[0,1,1] neg_lo:[0,0,1]
    v_pk_mul_f32 v[92:93], v[80:81], v[80:81] op_sel:[1,1] op_sel_hi:[0,1]
    v_pk_fma_f32 v[82:83], v[80:81], v[80:81], v[92:93] op_sel:[0,0,0] op_sel_hi:[0,1,1] neg_lo:[0,0,1]
    v_pk_mul_f32 v[94:95], v[72:73], v[72:73] op_sel:[1,1] op_sel_hi:[0,1]
    v_pk_fma_f32 v[74:75], v[72:73], v[72:73], v[94:95] op_sel:[0,0,0] op_sel_hi:[0,1,1] neg_lo:[0,0,1]
    v_pk_mul_f32 v[92:93], v[82:83], v[82:83] op_sel:[1,1] op_sel_hi:[0,1]
    v_pk_fma_f32 v[84:85], v[82:83], v[82:83], v[92:93] op_sel:[0,0,0] op_sel_hi:[0,1,1] neg_lo:[0,0,1]
    v_pk_mul_f32 v[94:95], v[66:67], v[76:77] op_sel:[1,1] op_sel_hi:[1,0]
    v_pk_fma_f32 v[86:87], v[66:67], v[76:77], v[94:95] op_sel:[0,0,0] op_sel_hi:[0,1,1] neg_lo:[0,0,1] neg_hi:[1,0,1]
    v_mov_b32_dpp v80, v78 row_ror:8 row_mask:0xf bank_mask:0x3
    v_mov_b32_dpp v81, v79 row_ror:8 row_mask:0xf bank_mask:0x3
    v_mov_b32_dpp v82, v84 row_ror:8 row_mask:0xf bank_mask:0x3
    v_mov_b32_dpp v83, v85 row_ror:8 row_mask:0xf bank_mask:0x3
    v_pk_mul_f32 v[92:93], v[66:67], v[80:81] op_sel:[1,1] op_sel_hi:[1,0]
    v_pk_fma_f32 v[88:89], v[66:67], v[80:81], v[92:93] op_sel:[0,0,0] op_sel_hi:[0,1,1] neg_lo:[0,0,1] neg_hi:[1,0,1]
    v_pk_mul_f32 v[94:95], v[66:67], v[82:83] op_sel:[1,1] op_sel_hi:[1,0]
    v_pk_fma_f32 v[90:91], v[66:67], v[82:83], v[94:95] op_sel:[0,0,0] op_sel_hi:[0,1,1] neg_lo:[0,0,1] neg_hi:[1,0,1]
    v_mfma_f32_16x16x4_f32 v[48:51], v86, v68, v[48:51]
    v_mfma_f32_16x16x4_f32 v[52:55], v88, v70, v[52:55]
    v_mfma_f32_16x16x4_f32 v[56:59], v88, v72, v[56:59]
    v_mfma_f32_16x16x4_f32 v[60:63], v90, v74, v[60:63]
    v_mfma_f32_16x16x4_f32 v[48:51], v87, v69, v[48:51]
    v_mfma_f32_16x16x4_f32 v[52:55], v89, v71, v[52:55]
    v_mfma_f32_16x16x4_f32 v[56:59], v89, v73, v[56:59]
    v_mfma_f32_16x16x4_f32 v[60:63], v91, v75, v[60:63]
    v_mov_b64_dpp v[64:65], v[28:29] row_newbcast:7 row_mask:0xf bank_mask:0xf
    v_mov_b64_dpp v[66:67], v[30:31] row_newbcast:7 row_mask:0xf bank_mask:0xf
    v_pk_mul_f32 v[94:95], v[64:65], v[26:27] op_sel_hi:[1,0]
    v_pk_mul_f32 v[96:97], v[64:65], v[26:27] op_sel:[0,1] op_sel_hi:[1,1]
    v_fract_f32 v95, v95
    v_fract_f32 v97, v97
    v_exp_f32 v94, v94
    v_exp_f32 v96, v96
    v_cos_f32 v68, v95
    v_sin_f32 v69, v95
    v_cos_f32 v76, v97
    v_sin_f32 v77, v97
    v_pk_mul_f32 v[68:69], v[68:69], v[94:95] op_sel_hi:[1,0]
    v_pk_mul_f32 v[76:77], v[76:77], v[96:97] op_sel_hi:[1,0]
    v_pk_mul_f32 v[92:93], v[76:77], v[76:77] op_sel:[1,1] op_sel_hi:[0,1]
    v_pk_fma_f32 v[78:79], v[76:77], v[76:77], v[92:93] op_sel:[0,0,0] op_sel_hi:[0,1,1] neg_lo:[0,0,1]
    v_pk_mul_f32 v[94:95], v[68:69], v[68:69] op_sel:[1,1] op_sel_hi:[0,1]
    v_pk_fma_f32 v[70:71], v[68:69], v[68:69], v[94:95] op_sel:[0,0,0] op_sel_hi:[0,1,1] neg_lo:[0,0,1]
    v_pk_mul_f32 v[92:93], v[78:79], v[78:79] op_sel:[1,1] op_sel_hi:[0,1]
    v_pk_fma_f32 v[80:81], v[78:79], v[78:79], v[92:93] op_sel:[0,0,0] op_sel_hi:[0,1,1] neg_lo:[0,0,1]
    v_pk_mul_f32 v[94:95], v[70:71], v[70:71] op_sel:[1,1] op_sel_hi:[0,1]
    v_pk_fma_f32 v[72:73], v[70:71], v[70:71], v[94:95] op_sel:[0,0,0] op_sel_hi:[0,1,1] neg_lo:[0,0,1]
    v_pk_mul_f32 v[92:93], v[80:81], v[80:81] op_sel:[1,1] op_sel_hi:[0,1]
    v_pk_fma_f32 v[82:83], v[80:81], v[80:81], v[92:93] op_sel:[0,0,0] op_sel_hi:[0,1,1] neg_lo:[0,0,1]
    v_pk_mul_f32 v[94:95], v[72:73], v[72:73] op_sel:[1,1] op_sel_hi:[0,1]
    v_pk_fma_f32 v[74:75], v[72:73], v[72:73], v[94:95] op_sel:[0,0,0] op_sel_hi:[0,1,1] neg_lo:[0,0,1]
    v_pk_mul_f32 v[92:93], v[82:83], v[82:83] op_sel:[1,1] op_sel_hi:[0,1]
    v_pk_fma_f32 v[84:85], v[82:83], v[82:83], v[92:93] op_sel:[0,0,0] op_sel_hi:[0,1,1] neg_lo:[0,0,1]
    v_pk_mul_f32 v[94:95], v[66:67], v[76:77] op_sel:[1,1] op_sel_hi:[1,0]
    v_pk_fma_f32 v[86:87], v[66:67], v[76:77], v[94:95] op_sel:[0,0,0] op_sel_hi:[0,1,1] neg_lo:[0,0,1] neg_hi:[1,0,1]
    v_mov_b32_dpp v80, v78 row_ror:8 row_mask:0xf bank_mask:0x3
    v_mov_b32_dpp v81, v79 row_ror:8 row_mask:0xf bank_mask:0x3
    v_mov_b32_dpp v82, v84 row_ror:8 row_mask:0xf bank_mask:0x3
    v_mov_b32_dpp v83, v85 row_ror:8 row_mask:0xf bank_mask:0x3
    v_pk_mul_f32 v[92:93], v[66:67], v[80:81] op_sel:[1,1] op_sel_hi:[1,0]
    v_pk_fma_f32 v[88:89], v[66:67], v[80:81], v[92:93] op_sel:[0,0,0] op_sel_hi:[0,1,1] neg_lo:[0,0,1] neg_hi:[1,0,1]
    v_pk_mul_f32 v[94:95], v[66:67], v[82:83] op_sel:[1,1] op_sel_hi:[1,0]
    v_pk_fma_f32 v[90:91], v[66:67], v[82:83], v[94:95] op_sel:[0,0,0] op_sel_hi:[0,1,1] neg_lo:[0,0,1] neg_hi:[1,0,1]
    v_mfma_f32_16x16x4_f32 v[48:51], v86, v68, v[48:51]
    v_mfma_f32_16x16x4_f32 v[52:55], v88, v70, v[52:55]
    v_mfma_f32_16x16x4_f32 v[56:59], v88, v72, v[56:59]
    v_mfma_f32_16x16x4_f32 v[60:63], v90, v74, v[60:63]
    v_mfma_f32_16x16x4_f32 v[48:51], v87, v69, v[48:51]
    v_mfma_f32_16x16x4_f32 v[52:55], v89, v71, v[52:55]
    v_mfma_f32_16x16x4_f32 v[56:59], v89, v73, v[56:59]
    v_mfma_f32_16x16x4_f32 v[60:63], v91, v75, v[60:63]
    v_mov_b64_dpp v[64:65], v[28:29] row_newbcast:8 row_mask:0xf bank_mask:0xf
    v_mov_b64_dpp v[66:67], v[30:31] row_newbcast:8 row_mask:0xf bank_mask:0xf
    v_pk_mul_f32 v[94:95], v[64:65], v[26:27] op_sel_hi:[1,0]
    v_pk_mul_f32 v[96:97], v[64:65], v[26:27] op_sel:[0,1] op_sel_hi:[1,1]
    v_fract_f32 v95, v95
    v_fract_f32 v97, v97
    v_exp_f32 v94, v94
    v_exp_f32 v96, v96
    v_cos_f32 v68, v95
    v_sin_f32 v69, v95
    v_cos_f32 v76, v97
    v_sin_f32 v77, v97
    v_pk_mul_f32 v[68:69], v[68:69], v[94:95] op_sel_hi:[1,0]
    v_pk_mul_f32 v[76:77], v[76:77], v[96:97] op_sel_hi:[1,0]
    v_pk_mul_f32 v[92:93], v[76:77], v[76:77] op_sel:[1,1] op_sel_hi:[0,1]
    v_pk_fma_f32 v[78:79], v[76:77], v[76:77], v[92:93] op_sel:[0,0,0] op_sel_hi:[0,1,1] neg_lo:[0,0,1]
    v_pk_mul_f32 v[94:95], v[68:69], v[68:69] op_sel:[1,1] op_sel_hi:[0,1]
    v_pk_fma_f32 v[70:71], v[68:69], v[68:69], v[94:95] op_sel:[0,0,0] op_sel_hi:[0,1,1] neg_lo:[0,0,1]
    v_pk_mul_f32 v[92:93], v[78:79], v[78:79] op_sel:[1,1] op_sel_hi:[0,1]
    v_pk_fma_f32 v[80:81], v[78:79], v[78:79], v[92:93] op_sel:[0,0,0] op_sel_hi:[0,1,1] neg_lo:[0,0,1]
    v_pk_mul_f32 v[94:95], v[70:71], v[70:71] op_sel:[1,1] op_sel_hi:[0,1]
    v_pk_fma_f32 v[72:73], v[70:71], v[70:71], v[94:95] op_sel:[0,0,0] op_sel_hi:[0,1,1] neg_lo:[0,0,1]
    v_pk_mul_f32 v[92:93], v[80:81], v[80:81] op_sel:[1,1] op_sel_hi:[0,1]
    v_pk_fma_f32 v[82:83], v[80:81], v[80:81], v[92:93] op_sel:[0,0,0] op_sel_hi:[0,1,1] neg_lo:[0,0,1]
    v_pk_mul_f32 v[94:95], v[72:73], v[72:73] op_sel:[1,1] op_sel_hi:[0,1]
    v_pk_fma_f32 v[74:75], v[72:73], v[72:73], v[94:95] op_sel:[0,0,0] op_sel_hi:[0,1,1] neg_lo:[0,0,1]
    v_pk_mul_f32 v[92:93], v[82:83], v[82:83] op_sel:[1,1] op_sel_hi:[0,1]
    v_pk_fma_f32 v[84:85], v[82:83], v[82:83], v[92:93] op_sel:[0,0,0] op_sel_hi:[0,1,1] neg_lo:[0,0,1]
    v_pk_mul_f32 v[94:95], v[66:67], v[76:77] op_sel:[1,1] op_sel_hi:[1,0]
    v_pk_fma_f32 v[86:87], v[66:67], v[76:77], v[94:95] op_sel:[0,0,0] op_sel_hi:[0,1,1] neg_lo:[0,0,1] neg_hi:[1,0,1]
    v_mov_b32_dpp v80, v78 row_ror:8 row_mask:0xf bank_mask:0x3
    v_mov_b32_dpp v81, v79 row_ror:8 row_mask:0xf bank_mask:0x3
    v_mov_b32_dpp v82, v84 row_ror:8 row_mask:0xf bank_mask:0x3
    v_mov_b32_dpp v83, v85 row_ror:8 row_mask:0xf bank_mask:0x3
    v_pk_mul_f32 v[92:93], v[66:67], v[80:81] op_sel:[1,1] op_sel_hi:[1,0]
    v_pk_fma_f32 v[88:89], v[66:67], v[80:81], v[92:93] op_sel:[0,0,0] op_sel_hi:[0,1,1] neg_lo:[0,0,1] neg_hi:[1,0,1]
    v_pk_mul_f32 v[94:95], v[66:67], v[82:83] op_sel:[1,1] op_sel_hi:[1,0]
    v_pk_fma_f32 v[90:91], v[66:67], v[82:83], v[94:95] op_sel:[0,0,0] op_sel_hi:[0,1,1] neg_lo:[0,0,1] neg_hi:[1,0,1]
    v_mfma_f32_16x16x4_f32 v[48:51], v86, v68, v[48:51]
    v_mfma_f32_16x16x4_f32 v[52:55], v88, v70, v[52:55]
    v_mfma_f32_16x16x4_f32 v[56:59], v88, v72, v[56:59]
    v_mfma_f32_16x16x4_f32 v[60:63], v90, v74, v[60:63]
    v_mfma_f32_16x16x4_f32 v[48:51], v87, v69, v[48:51]
    v_mfma_f32_16x16x4_f32 v[52:55], v89, v71, v[52:55]
    v_mfma_f32_16x16x4_f32 v[56:59], v89, v73, v[56:59]
    v_mfma_f32_16x16x4_f32 v[60:63], v91, v75, v[60:63]
    v_mov_b64_dpp v[64:65], v[28:29] row_newbcast:9 row_mask:0xf bank_mask:0xf
    v_mov_b64_dpp v[66:67], v[30:31] row_newbcast:9 row_mask:0xf bank_mask:0xf
    v_pk_mul_f32 v[94:95], v[64:65], v[26:27] op_sel_hi:[1,0]
    v_pk_mul_f32 v[96:97], v[64:65], v[26:27] op_sel:[0,1] op_sel_hi:[1,1]
    v_fract_f32 v95, v95
    v_fract_f32 v97, v97
    v_exp_f32 v94, v94
    v_exp_f32 v96, v96
    v_cos_f32 v68, v95
    v_sin_f32 v69, v95
    v_cos_f32 v76, v97
    v_sin_f32 v77, v97
    v_pk_mul_f32 v[68:69], v[68:69], v[94:95] op_sel_hi:[1,0]
    v_pk_mul_f32 v[76:77], v[76:77], v[96:97] op_sel_hi:[1,0]
    v_pk_mul_f32 v[92:93], v[76:77], v[76:77] op_sel:[1,1] op_sel_hi:[0,1]
    v_pk_fma_f32 v[78:79], v[76:77], v[76:77], v[92:93] op_sel:[0,0,0] op_sel_hi:[0,1,1] neg_lo:[0,0,1]
    v_pk_mul_f32 v[94:95], v[68:69], v[68:69] op_sel:[1,1] op_sel_hi:[0,1]
    v_pk_fma_f32 v[70:71], v[68:69], v[68:69], v[94:95] op_sel:[0,0,0] op_sel_hi:[0,1,1] neg_lo:[0,0,1]
    v_pk_mul_f32 v[92:93], v[78:79], v[78:79] op_sel:[1,1] op_sel_hi:[0,1]
    v_pk_fma_f32 v[80:81], v[78:79], v[78:79], v[92:93] op_sel:[0,0,0] op_sel_hi:[0,1,1] neg_lo:[0,0,1]
    v_pk_mul_f32 v[94:95], v[70:71], v[70:71] op_sel:[1,1] op_sel_hi:[0,1]
    v_pk_fma_f32 v[72:73], v[70:71], v[70:71], v[94:95] op_sel:[0,0,0] op_sel_hi:[0,1,1] neg_lo:[0,0,1]
    v_pk_mul_f32 v[92:93], v[80:81], v[80:81] op_sel:[1,1] op_sel_hi:[0,1]
    v_pk_fma_f32 v[82:83], v[80:81], v[80:81], v[92:93] op_sel:[0,0,0] op_sel_hi:[0,1,1] neg_lo:[0,0,1]
    v_pk_mul_f32 v[94:95], v[72:73], v[72:73] op_sel:[1,1] op_sel_hi:[0,1]
    v_pk_fma_f32 v[74:75], v[72:73], v[72:73], v[94:95] op_sel:[0,0,0] op_sel_hi:[0,1,1] neg_lo:[0,0,1]
    v_pk_mul_f32 v[92:93], v[82:83], v[82:83] op_sel:[1,1] op_sel_hi:[0,1]
    v_pk_fma_f32 v[84:85], v[82:83], v[82:83], v[92:93] op_sel:[0,0,0] op_sel_hi:[0,1,1] neg_lo:[0,0,1]
    v_pk_mul_f32 v[94:95], v[66:67], v[76:77] op_sel:[1,1] op_sel_hi:[1,0]
    v_pk_fma_f32 v[86:87], v[66:67], v[76:77], v[94:95] op_sel:[0,0,0] op_sel_hi:[0,1,1] neg_lo:[0,0,1] neg_hi:[1,0,1]
    v_mov_b32_dpp v80, v78 row_ror:8 row_mask:0xf bank_mask:0x3
    v_mov_b32_dpp v81, v79 row_ror:8 row_mask:0xf bank_mask:0x3
    v_mov_b32_dpp v82, v84 row_ror:8 row_mask:0xf bank_mask:0x3
    v_mov_b32_dpp v83, v85 row_ror:8 row_mask:0xf bank_mask:0x3
    v_pk_mul_f32 v[92:93], v[66:67], v[80:81] op_sel:[1,1] op_sel_hi:[1,0]
    v_pk_fma_f32 v[88:89], v[66:67], v[80:81], v[92:93] op_sel:[0,0,0] op_sel_hi:[0,1,1] neg_lo:[0,0,1] neg_hi:[1,0,1]
    v_pk_mul_f32 v[94:95], v[66:67], v[82:83] op_sel:[1,1] op_sel_hi:[1,0]
    v_pk_fma_f32 v[90:91], v[66:67], v[82:83], v[94:95] op_sel:[0,0,0] op_sel_hi:[0,1,1] neg_lo:[0,0,1] neg_hi:[1,0,1]
    v_mfma_f32_16x16x4_f32 v[48:51], v86, v68, v[48:51]
    v_mfma_f32_16x16x4_f32 v[52:55], v88, v70, v[52:55]
    v_mfma_f32_16x16x4_f32 v[56:59], v88, v72, v[56:59]
    v_mfma_f32_16x16x4_f32 v[60:63], v90, v74, v[60:63]
    v_mfma_f32_16x16x4_f32 v[48:51], v87, v69, v[48:51]
    v_mfma_f32_16x16x4_f32 v[52:55], v89, v71, v[52:55]
    v_mfma_f32_16x16x4_f32 v[56:59], v89, v73, v[56:59]
    v_mfma_f32_16x16x4_f32 v[60:63], v91, v75, v[60:63]
    v_mov_b64_dpp v[64:65], v[28:29] row_newbcast:10 row_mask:0xf bank_mask:0xf
    v_mov_b64_dpp v[66:67], v[30:31] row_newbcast:10 row_mask:0xf bank_mask:0xf
    v_pk_mul_f32 v[94:95], v[64:65], v[26:27] op_sel_hi:[1,0]
    v_pk_mul_f32 v[96:97], v[64:65], v[26:27] op_sel:[0,1] op_sel_hi:[1,1]
    v_fract_f32 v95, v95
    v_fract_f32 v97, v97
    v_exp_f32 v94, v94
    v_exp_f32 v96, v96
    v_cos_f32 v68, v95
    v_sin_f32 v69, v95
    v_cos_f32 v76, v97
    v_sin_f32 v77, v97
    v_pk_mul_f32 v[68:69], v[68:69], v[94:95] op_sel_hi:[1,0]
    v_pk_mul_f32 v[76:77], v[76:77], v[96:97] op_sel_hi:[1,0]
    v_pk_mul_f32 v[92:93], v[76:77], v[76:77] op_sel:[1,1] op_sel_hi:[0,1]
    v_pk_fma_f32 v[78:79], v[76:77], v[76:77], v[92:93] op_sel:[0,0,0] op_sel_hi:[0,1,1] neg_lo:[0,0,1]
    v_pk_mul_f32 v[94:95], v[68:69], v[68:69] op_sel:[1,1] op_sel_hi:[0,1]
    v_pk_fma_f32 v[70:71], v[68:69], v[68:69], v[94:95] op_sel:[0,0,0] op_sel_hi:[0,1,1] neg_lo:[0,0,1]
    v_pk_mul_f32 v[92:93], v[78:79], v[78:79] op_sel:[1,1] op_sel_hi:[0,1]
    v_pk_fma_f32 v[80:81], v[78:79], v[78:79], v[92:93] op_sel:[0,0,0] op_sel_hi:[0,1,1] neg_lo:[0,0,1]
    v_pk_mul_f32 v[94:95], v[70:71], v[70:71] op_sel:[1,1] op_sel_hi:[0,1]
    v_pk_fma_f32 v[72:73], v[70:71], v[70:71], v[94:95] op_sel:[0,0,0] op_sel_hi:[0,1,1] neg_lo:[0,0,1]
    v_pk_mul_f32 v[92:93], v[80:81], v[80:81] op_sel:[1,1] op_sel_hi:[0,1]
    v_pk_fma_f32 v[82:83], v[80:81], v[80:81], v[92:93] op_sel:[0,0,0] op_sel_hi:[0,1,1] neg_lo:[0,0,1]
    v_pk_mul_f32 v[94:95], v[72:73], v[72:73] op_sel:[1,1] op_sel_hi:[0,1]
    v_pk_fma_f32 v[74:75], v[72:73], v[72:73], v[94:95] op_sel:[0,0,0] op_sel_hi:[0,1,1] neg_lo:[0,0,1]
    v_pk_mul_f32 v[92:93], v[82:83], v[82:83] op_sel:[1,1] op_sel_hi:[0,1]
    v_pk_fma_f32 v[84:85], v[82:83], v[82:83], v[92:93] op_sel:[0,0,0] op_sel_hi:[0,1,1] neg_lo:[0,0,1]
    v_pk_mul_f32 v[94:95], v[66:67], v[76:77] op_sel:[1,1] op_sel_hi:[1,0]
    v_pk_fma_f32 v[86:87], v[66:67], v[76:77], v[94:95] op_sel:[0,0,0] op_sel_hi:[0,1,1] neg_lo:[0,0,1] neg_hi:[1,0,1]
    v_mov_b32_dpp v80, v78 row_ror:8 row_mask:0xf bank_mask:0x3
    v_mov_b32_dpp v81, v79 row_ror:8 row_mask:0xf bank_mask:0x3
    v_mov_b32_dpp v82, v84 row_ror:8 row_mask:0xf bank_mask:0x3
    v_mov_b32_dpp v83, v85 row_ror:8 row_mask:0xf bank_mask:0x3
    v_pk_mul_f32 v[92:93], v[66:67], v[80:81] op_sel:[1,1] op_sel_hi:[1,0]
    v_pk_fma_f32 v[88:89], v[66:67], v[80:81], v[92:93] op_sel:[0,0,0] op_sel_hi:[0,1,1] neg_lo:[0,0,1] neg_hi:[1,0,1]
    v_pk_mul_f32 v[94:95], v[66:67], v[82:83] op_sel:[1,1] op_sel_hi:[1,0]
    v_pk_fma_f32 v[90:91], v[66:67], v[82:83], v[94:95] op_sel:[0,0,0] op_sel_hi:[0,1,1] neg_lo:[0,0,1] neg_hi:[1,0,1]
    v_mfma_f32_16x16x4_f32 v[48:51], v86, v68, v[48:51]
    v_mfma_f32_16x16x4_f32 v[52:55], v88, v70, v[52:55]
    v_mfma_f32_16x16x4_f32 v[56:59], v88, v72, v[56:59]
    v_mfma_f32_16x16x4_f32 v[60:63], v90, v74, v[60:63]
    v_mfma_f32_16x16x4_f32 v[48:51], v87, v69, v[48:51]
    v_mfma_f32_16x16x4_f32 v[52:55], v89, v71, v[52:55]
    v_mfma_f32_16x16x4_f32 v[56:59], v89, v73, v[56:59]
    v_mfma_f32_16x16x4_f32 v[60:63], v91, v75, v[60:63]
    v_mov_b64_dpp v[64:65], v[28:29] row_newbcast:11 row_mask:0xf bank_mask:0xf
    v_mov_b64_dpp v[66:67], v[30:31] row_newbcast:11 row_mask:0xf bank_mask:0xf
    v_pk_mul_f32 v[94:95], v[64:65], v[26:27] op_sel_hi:[1,0]
    v_pk_mul_f32 v[96:97], v[64:65], v[26:27] op_sel:[0,1] op_sel_hi:[1,1]
    v_fract_f32 v95, v95
    v_fract_f32 v97, v97
    v_exp_f32 v94, v94
    v_exp_f32 v96, v96
    v_cos_f32 v68, v95
    v_sin_f32 v69, v95
    v_cos_f32 v76, v97
    v_sin_f32 v77, v97
    v_pk_mul_f32 v[68:69], v[68:69], v[94:95] op_sel_hi:[1,0]
    v_pk_mul_f32 v[76:77], v[76:77], v[96:97] op_sel_hi:[1,0]
    v_pk_mul_f32 v[92:93], v[76:77], v[76:77] op_sel:[1,1] op_sel_hi:[0,1]
    v_pk_fma_f32 v[78:79], v[76:77], v[76:77], v[92:93] op_sel:[0,0,0] op_sel_hi:[0,1,1] neg_lo:[0,0,1]
    v_pk_mul_f32 v[94:95], v[68:69], v[68:69] op_sel:[1,1] op_sel_hi:[0,1]
    v_pk_fma_f32 v[70:71], v[68:69], v[68:69], v[94:95] op_sel:[0,0,0] op_sel_hi:[0,1,1] neg_lo:[0,0,1]
    v_pk_mul_f32 v[92:93], v[78:79], v[78:79] op_sel:[1,1] op_sel_hi:[0,1]
    v_pk_fma_f32 v[80:81], v[78:79], v[78:79], v[92:93] op_sel:[0,0,0] op_sel_hi:[0,1,1] neg_lo:[0,0,1]
    v_pk_mul_f32 v[94:95], v[70:71], v[70:71] op_sel:[1,1] op_sel_hi:[0,1]
    v_pk_fma_f32 v[72:73], v[70:71], v[70:71], v[94:95] op_sel:[0,0,0] op_sel_hi:[0,1,1] neg_lo:[0,0,1]
    v_pk_mul_f32 v[92:93], v[80:81], v[80:81] op_sel:[1,1] op_sel_hi:[0,1]
    v_pk_fma_f32 v[82:83], v[80:81], v[80:81], v[92:93] op_sel:[0,0,0] op_sel_hi:[0,1,1] neg_lo:[0,0,1]
    v_pk_mul_f32 v[94:95], v[72:73], v[72:73] op_sel:[1,1] op_sel_hi:[0,1]
    v_pk_fma_f32 v[74:75], v[72:73], v[72:73], v[94:95] op_sel:[0,0,0] op_sel_hi:[0,1,1] neg_lo:[0,0,1]
    v_pk_mul_f32 v[92:93], v[82:83], v[82:83] op_sel:[1,1] op_sel_hi:[0,1]
    v_pk_fma_f32 v[84:85], v[82:83], v[82:83], v[92:93] op_sel:[0,0,0] op_sel_hi:[0,1,1] neg_lo:[0,0,1]
    v_pk_mul_f32 v[94:95], v[66:67], v[76:77] op_sel:[1,1] op_sel_hi:[1,0]
    v_pk_fma_f32 v[86:87], v[66:67], v[76:77], v[94:95] op_sel:[0,0,0] op_sel_hi:[0,1,1] neg_lo:[0,0,1] neg_hi:[1,0,1]
    v_mov_b32_dpp v80, v78 row_ror:8 row_mask:0xf bank_mask:0x3
    v_mov_b32_dpp v81, v79 row_ror:8 row_mask:0xf bank_mask:0x3
    v_mov_b32_dpp v82, v84 row_ror:8 row_mask:0xf bank_mask:0x3
    v_mov_b32_dpp v83, v85 row_ror:8 row_mask:0xf bank_mask:0x3
    v_pk_mul_f32 v[92:93], v[66:67], v[80:81] op_sel:[1,1] op_sel_hi:[1,0]
    v_pk_fma_f32 v[88:89], v[66:67], v[80:81], v[92:93] op_sel:[0,0,0] op_sel_hi:[0,1,1] neg_lo:[0,0,1] neg_hi:[1,0,1]
    v_pk_mul_f32 v[94:95], v[66:67], v[82:83] op_sel:[1,1] op_sel_hi:[1,0]
    v_pk_fma_f32 v[90:91], v[66:67], v[82:83], v[94:95] op_sel:[0,0,0] op_sel_hi:[0,1,1] neg_lo:[0,0,1] neg_hi:[1,0,1]
    v_mfma_f32_16x16x4_f32 v[48:51], v86, v68, v[48:51]
    v_mfma_f32_16x16x4_f32 v[52:55], v88, v70, v[52:55]
    v_mfma_f32_16x16x4_f32 v[56:59], v88, v72, v[56:59]
    v_mfma_f32_16x16x4_f32 v[60:63], v90, v74, v[60:63]
    v_mfma_f32_16x16x4_f32 v[48:51], v87, v69, v[48:51]
    v_mfma_f32_16x16x4_f32 v[52:55], v89, v71, v[52:55]
    v_mfma_f32_16x16x4_f32 v[56:59], v89, v73, v[56:59]
    v_mfma_f32_16x16x4_f32 v[60:63], v91, v75, v[60:63]
    v_mov_b64_dpp v[64:65], v[28:29] row_newbcast:12 row_mask:0xf bank_mask:0xf
    v_mov_b64_dpp v[66:67], v[30:31] row_newbcast:12 row_mask:0xf bank_mask:0xf
    v_pk_mul_f32 v[94:95], v[64:65], v[26:27] op_sel_hi:[1,0]
    v_pk_mul_f32 v[96:97], v[64:65], v[26:27] op_sel:[0,1] op_sel_hi:[1,1]
    v_fract_f32 v95, v95
    v_fract_f32 v97, v97
    v_exp_f32 v94, v94
    v_exp_f32 v96, v96
    v_cos_f32 v68, v95
    v_sin_f32 v69, v95
    v_cos_f32 v76, v97
    v_sin_f32 v77, v97
    v_pk_mul_f32 v[68:69], v[68:69], v[94:95] op_sel_hi:[1,0]
    v_pk_mul_f32 v[76:77], v[76:77], v[96:97] op_sel_hi:[1,0]
    v_pk_mul_f32 v[92:93], v[76:77], v[76:77] op_sel:[1,1] op_sel_hi:[0,1]
    v_pk_fma_f32 v[78:79], v[76:77], v[76:77], v[92:93] op_sel:[0,0,0] op_sel_hi:[0,1,1] neg_lo:[0,0,1]
    v_pk_mul_f32 v[94:95], v[68:69], v[68:69] op_sel:[1,1] op_sel_hi:[0,1]
    v_pk_fma_f32 v[70:71], v[68:69], v[68:69], v[94:95] op_sel:[0,0,0] op_sel_hi:[0,1,1] neg_lo:[0,0,1]
    v_pk_mul_f32 v[92:93], v[78:79], v[78:79] op_sel:[1,1] op_sel_hi:[0,1]
    v_pk_fma_f32 v[80:81], v[78:79], v[78:79], v[92:93] op_sel:[0,0,0] op_sel_hi:[0,1,1] neg_lo:[0,0,1]
    v_pk_mul_f32 v[94:95], v[70:71], v[70:71] op_sel:[1,1] op_sel_hi:[0,1]
    v_pk_fma_f32 v[72:73], v[70:71], v[70:71], v[94:95] op_sel:[0,0,0] op_sel_hi:[0,1,1] neg_lo:[0,0,1]
    v_pk_mul_f32 v[92:93], v[80:81], v[80:81] op_sel:[1,1] op_sel_hi:[0,1]
    v_pk_fma_f32 v[82:83], v[80:81], v[80:81], v[92:93] op_sel:[0,0,0] op_sel_hi:[0,1,1] neg_lo:[0,0,1]
    v_pk_mul_f32 v[94:95], v[72:73], v[72:73] op_sel:[1,1] op_sel_hi:[0,1]
    v_pk_fma_f32 v[74:75], v[72:73], v[72:73], v[94:95] op_sel:[0,0,0] op_sel_hi:[0,1,1] neg_lo:[0,0,1]
    v_pk_mul_f32 v[92:93], v[82:83], v[82:83] op_sel:[1,1] op_sel_hi:[0,1]
    v_pk_fma_f32 v[84:85], v[82:83], v[82:83], v[92:93] op_sel:[0,0,0] op_sel_hi:[0,1,1] neg_lo:[0,0,1]
    v_pk_mul_f32 v[94:95], v[66:67], v[76:77] op_sel:[1,1] op_sel_hi:[1,0]
    v_pk_fma_f32 v[86:87], v[66:67], v[76:77], v[94:95] op_sel:[0,0,0] op_sel_hi:[0,1,1] neg_lo:[0,0,1] neg_hi:[1,0,1]
    v_mov_b32_dpp v80, v78 row_ror:8 row_mask:0xf bank_mask:0x3
    v_mov_b32_dpp v81, v79 row_ror:8 row_mask:0xf bank_mask:0x3
    v_mov_b32_dpp v82, v84 row_ror:8 row_mask:0xf bank_mask:0x3
    v_mov_b32_dpp v83, v85 row_ror:8 row_mask:0xf bank_mask:0x3
    v_pk_mul_f32 v[92:93], v[66:67], v[80:81] op_sel:[1,1] op_sel_hi:[1,0]
    v_pk_fma_f32 v[88:89], v[66:67], v[80:81], v[92:93] op_sel:[0,0,0] op_sel_hi:[0,1,1] neg_lo:[0,0,1] neg_hi:[1,0,1]
    v_pk_mul_f32 v[94:95], v[66:67], v[82:83] op_sel:[1,1] op_sel_hi:[1,0]
    v_pk_fma_f32 v[90:91], v[66:67], v[82:83], v[94:95] op_sel:[0,0,0] op_sel_hi:[0,1,1] neg_lo:[0,0,1] neg_hi:[1,0,1]
    v_mfma_f32_16x16x4_f32 v[48:51], v86, v68, v[48:51]
    v_mfma_f32_16x16x4_f32 v[52:55], v88, v70, v[52:55]
    v_mfma_f32_16x16x4_f32 v[56:59], v88, v72, v[56:59]
    v_mfma_f32_16x16x4_f32 v[60:63], v90, v74, v[60:63]
    v_mfma_f32_16x16x4_f32 v[48:51], v87, v69, v[48:51]
    v_mfma_f32_16x16x4_f32 v[52:55], v89, v71, v[52:55]
    v_mfma_f32_16x16x4_f32 v[56:59], v89, v73, v[56:59]
    v_mfma_f32_16x16x4_f32 v[60:63], v91, v75, v[60:63]
    v_mov_b64_dpp v[64:65], v[28:29] row_newbcast:13 row_mask:0xf bank_mask:0xf
    v_mov_b64_dpp v[66:67], v[30:31] row_newbcast:13 row_mask:0xf bank_mask:0xf
    v_pk_mul_f32 v[94:95], v[64:65], v[26:27] op_sel_hi:[1,0]
    v_pk_mul_f32 v[96:97], v[64:65], v[26:27] op_sel:[0,1] op_sel_hi:[1,1]
    v_fract_f32 v95, v95
    v_fract_f32 v97, v97
    v_exp_f32 v94, v94
    v_exp_f32 v96, v96
    v_cos_f32 v68, v95
    v_sin_f32 v69, v95
    v_cos_f32 v76, v97
    v_sin_f32 v77, v97
    v_pk_mul_f32 v[68:69], v[68:69], v[94:95] op_sel_hi:[1,0]
    v_pk_mul_f32 v[76:77], v[76:77], v[96:97] op_sel_hi:[1,0]
    v_pk_mul_f32 v[92:93], v[76:77], v[76:77] op_sel:[1,1] op_sel_hi:[0,1]
    v_pk_fma_f32 v[78:79], v[76:77], v[76:77], v[92:93] op_sel:[0,0,0] op_sel_hi:[0,1,1] neg_lo:[0,0,1]
    v_pk_mul_f32 v[94:95], v[68:69], v[68:69] op_sel:[1,1] op_sel_hi:[0,1]
    v_pk_fma_f32 v[70:71], v[68:69], v[68:69], v[94:95] op_sel:[0,0,0] op_sel_hi:[0,1,1] neg_lo:[0,0,1]
    v_pk_mul_f32 v[92:93], v[78:79], v[78:79] op_sel:[1,1] op_sel_hi:[0,1]
    v_pk_fma_f32 v[80:81], v[78:79], v[78:79], v[92:93] op_sel:[0,0,0] op_sel_hi:[0,1,1] neg_lo:[0,0,1]
    v_pk_mul_f32 v[94:95], v[70:71], v[70:71] op_sel:[1,1] op_sel_hi:[0,1]
    v_pk_fma_f32 v[72:73], v[70:71], v[70:71], v[94:95] op_sel:[0,0,0] op_sel_hi:[0,1,1] neg_lo:[0,0,1]
    v_pk_mul_f32 v[92:93], v[80:81], v[80:81] op_sel:[1,1] op_sel_hi:[0,1]
    v_pk_fma_f32 v[82:83], v[80:81], v[80:81], v[92:93] op_sel:[0,0,0] op_sel_hi:[0,1,1] neg_lo:[0,0,1]
    v_pk_mul_f32 v[94:95], v[72:73], v[72:73] op_sel:[1,1] op_sel_hi:[0,1]
    v_pk_fma_f32 v[74:75], v[72:73], v[72:73], v[94:95] op_sel:[0,0,0] op_sel_hi:[0,1,1] neg_lo:[0,0,1]
    v_pk_mul_f32 v[92:93], v[82:83], v[82:83] op_sel:[1,1] op_sel_hi:[0,1]
    v_pk_fma_f32 v[84:85], v[82:83], v[82:83], v[92:93] op_sel:[0,0,0] op_sel_hi:[0,1,1] neg_lo:[0,0,1]
    v_pk_mul_f32 v[94:95], v[66:67], v[76:77] op_sel:[1,1] op_sel_hi:[1,0]
    v_pk_fma_f32 v[86:87], v[66:67], v[76:77], v[94:95] op_sel:[0,0,0] op_sel_hi:[0,1,1] neg_lo:[0,0,1] neg_hi:[1,0,1]
    v_mov_b32_dpp v80, v78 row_ror:8 row_mask:0xf bank_mask:0x3
    v_mov_b32_dpp v81, v79 row_ror:8 row_mask:0xf bank_mask:0x3
    v_mov_b32_dpp v82, v84 row_ror:8 row_mask:0xf bank_mask:0x3
    v_mov_b32_dpp v83, v85 row_ror:8 row_mask:0xf bank_mask:0x3
    v_pk_mul_f32 v[92:93], v[66:67], v[80:81] op_sel:[1,1] op_sel_hi:[1,0]
    v_pk_fma_f32 v[88:89], v[66:67], v[80:81], v[92:93] op_sel:[0,0,0] op_sel_hi:[0,1,1] neg_lo:[0,0,1] neg_hi:[1,0,1]
    v_pk_mul_f32 v[94:95], v[66:67], v[82:83] op_sel:[1,1] op_sel_hi:[1,0]
    v_pk_fma_f32 v[90:91], v[66:67], v[82:83], v[94:95] op_sel:[0,0,0] op_sel_hi:[0,1,1] neg_lo:[0,0,1] neg_hi:[1,0,1]
    v_mfma_f32_16x16x4_f32 v[48:51], v86, v68, v[48:51]
    v_mfma_f32_16x16x4_f32 v[52:55], v88, v70, v[52:55]
    v_mfma_f32_16x16x4_f32 v[56:59], v88, v72, v[56:59]
    v_mfma_f32_16x16x4_f32 v[60:63], v90, v74, v[60:63]
    v_mfma_f32_16x16x4_f32 v[48:51], v87, v69, v[48:51]
    v_mfma_f32_16x16x4_f32 v[52:55], v89, v71, v[52:55]
    v_mfma_f32_16x16x4_f32 v[56:59], v89, v73, v[56:59]
    v_mfma_f32_16x16x4_f32 v[60:63], v91, v75, v[60:63]
    v_mov_b64_dpp v[64:65], v[28:29] row_newbcast:14 row_mask:0xf bank_mask:0xf
    v_mov_b64_dpp v[66:67], v[30:31] row_newbcast:14 row_mask:0xf bank_mask:0xf
    v_pk_mul_f32 v[94:95], v[64:65], v[26:27] op_sel_hi:[1,0]
    v_pk_mul_f32 v[96:97], v[64:65], v[26:27] op_sel:[0,1] op_sel_hi:[1,1]
    v_fract_f32 v95, v95
    v_fract_f32 v97, v97
    v_exp_f32 v94, v94
    v_exp_f32 v96, v96
    v_cos_f32 v68, v95
    v_sin_f32 v69, v95
    v_cos_f32 v76, v97
    v_sin_f32 v77, v97
    v_pk_mul_f32 v[68:69], v[68:69], v[94:95] op_sel_hi:[1,0]
    v_pk_mul_f32 v[76:77], v[76:77], v[96:97] op_sel_hi:[1,0]
    v_pk_mul_f32 v[92:93], v[76:77], v[76:77] op_sel:[1,1] op_sel_hi:[0,1]
    v_pk_fma_f32 v[78:79], v[76:77], v[76:77], v[92:93] op_sel:[0,0,0] op_sel_hi:[0,1,1] neg_lo:[0,0,1]
    v_pk_mul_f32 v[94:95], v[68:69], v[68:69] op_sel:[1,1] op_sel_hi:[0,1]
    v_pk_fma_f32 v[70:71], v[68:69], v[68:69], v[94:95] op_sel:[0,0,0] op_sel_hi:[0,1,1] neg_lo:[0,0,1]
    v_pk_mul_f32 v[92:93], v[78:79], v[78:79] op_sel:[1,1] op_sel_hi:[0,1]
    v_pk_fma_f32 v[80:81], v[78:79], v[78:79], v[92:93] op_sel:[0,0,0] op_sel_hi:[0,1,1] neg_lo:[0,0,1]
    v_pk_mul_f32 v[94:95], v[70:71], v[70:71] op_sel:[1,1] op_sel_hi:[0,1]
    v_pk_fma_f32 v[72:73], v[70:71], v[70:71], v[94:95] op_sel:[0,0,0] op_sel_hi:[0,1,1] neg_lo:[0,0,1]
    v_pk_mul_f32 v[92:93], v[80:81], v[80:81] op_sel:[1,1] op_sel_hi:[0,1]
    v_pk_fma_f32 v[82:83], v[80:81], v[80:81], v[92:93] op_sel:[0,0,0] op_sel_hi:[0,1,1] neg_lo:[0,0,1]
    v_pk_mul_f32 v[94:95], v[72:73], v[72:73] op_sel:[1,1] op_sel_hi:[0,1]
    v_pk_fma_f32 v[74:75], v[72:73], v[72:73], v[94:95] op_sel:[0,0,0] op_sel_hi:[0,1,1] neg_lo:[0,0,1]
    v_pk_mul_f32 v[92:93], v[82:83], v[82:83] op_sel:[1,1] op_sel_hi:[0,1]
    v_pk_fma_f32 v[84:85], v[82:83], v[82:83], v[92:93] op_sel:[0,0,0] op_sel_hi:[0,1,1] neg_lo:[0,0,1]
    v_pk_mul_f32 v[94:95], v[66:67], v[76:77] op_sel:[1,1] op_sel_hi:[1,0]
    v_pk_fma_f32 v[86:87], v[66:67], v[76:77], v[94:95] op_sel:[0,0,0] op_sel_hi:[0,1,1] neg_lo:[0,0,1] neg_hi:[1,0,1]
    v_mov_b32_dpp v80, v78 row_ror:8 row_mask:0xf bank_mask:0x3
    v_mov_b32_dpp v81, v79 row_ror:8 row_mask:0xf bank_mask:0x3
    v_mov_b32_dpp v82, v84 row_ror:8 row_mask:0xf bank_mask:0x3
    v_mov_b32_dpp v83, v85 row_ror:8 row_mask:0xf bank_mask:0x3
    v_pk_mul_f32 v[92:93], v[66:67], v[80:81] op_sel:[1,1] op_sel_hi:[1,0]
    v_pk_fma_f32 v[88:89], v[66:67], v[80:81], v[92:93] op_sel:[0,0,0] op_sel_hi:[0,1,1] neg_lo:[0,0,1] neg_hi:[1,0,1]
    v_pk_mul_f32 v[94:95], v[66:67], v[82:83] op_sel:[1,1] op_sel_hi:[1,0]
    v_pk_fma_f32 v[90:91], v[66:67], v[82:83], v[94:95] op_sel:[0,0,0] op_sel_hi:[0,1,1] neg_lo:[0,0,1] neg_hi:[1,0,1]
    v_mfma_f32_16x16x4_f32 v[48:51], v86, v68, v[48:51]
    v_mfma_f32_16x16x4_f32 v[52:55], v88, v70, v[52:55]
    v_mfma_f32_16x16x4_f32 v[56:59], v88, v72, v[56:59]
    v_mfma_f32_16x16x4_f32 v[60:63], v90, v74, v[60:63]
    v_mfma_f32_16x16x4_f32 v[48:51], v87, v69, v[48:51]
    v_mfma_f32_16x16x4_f32 v[52:55], v89, v71, v[52:55]
    v_mfma_f32_16x16x4_f32 v[56:59], v89, v73, v[56:59]
    v_mfma_f32_16x16x4_f32 v[60:63], v91, v75, v[60:63]
    v_mov_b64_dpp v[64:65], v[28:29] row_newbcast:15 row_mask:0xf bank_mask:0xf
    v_mov_b64_dpp v[66:67], v[30:31] row_newbcast:15 row_mask:0xf bank_mask:0xf
    v_pk_mul_f32 v[94:95], v[64:65], v[26:27] op_sel_hi:[1,0]
    v_pk_mul_f32 v[96:97], v[64:65], v[26:27] op_sel:[0,1] op_sel_hi:[1,1]
    v_fract_f32 v95, v95
    v_fract_f32 v97, v97
    v_exp_f32 v94, v94
    v_exp_f32 v96, v96
    v_cos_f32 v68, v95
    v_sin_f32 v69, v95
    v_cos_f32 v76, v97
    v_sin_f32 v77, v97
    v_pk_mul_f32 v[68:69], v[68:69], v[94:95] op_sel_hi:[1,0]
    v_pk_mul_f32 v[76:77], v[76:77], v[96:97] op_sel_hi:[1,0]
    v_pk_mul_f32 v[92:93], v[76:77], v[76:77] op_sel:[1,1] op_sel_hi:[0,1]
    v_pk_fma_f32 v[78:79], v[76:77], v[76:77], v[92:93] op_sel:[0,0,0] op_sel_hi:[0,1,1] neg_lo:[0,0,1]
    v_pk_mul_f32 v[94:95], v[68:69], v[68:69] op_sel:[1,1] op_sel_hi:[0,1]
    v_pk_fma_f32 v[70:71], v[68:69], v[68:69], v[94:95] op_sel:[0,0,0] op_sel_hi:[0,1,1] neg_lo:[0,0,1]
    v_pk_mul_f32 v[92:93], v[78:79], v[78:79] op_sel:[1,1] op_sel_hi:[0,1]
    v_pk_fma_f32 v[80:81], v[78:79], v[78:79], v[92:93] op_sel:[0,0,0] op_sel_hi:[0,1,1] neg_lo:[0,0,1]
    v_pk_mul_f32 v[94:95], v[70:71], v[70:71] op_sel:[1,1] op_sel_hi:[0,1]
    v_pk_fma_f32 v[72:73], v[70:71], v[70:71], v[94:95] op_sel:[0,0,0] op_sel_hi:[0,1,1] neg_lo:[0,0,1]
    v_pk_mul_f32 v[92:93], v[80:81], v[80:81] op_sel:[1,1] op_sel_hi:[0,1]
    v_pk_fma_f32 v[82:83], v[80:81], v[80:81], v[92:93] op_sel:[0,0,0] op_sel_hi:[0,1,1] neg_lo:[0,0,1]
    v_pk_mul_f32 v[94:95], v[72:73], v[72:73] op_sel:[1,1] op_sel_hi:[0,1]
    v_pk_fma_f32 v[74:75], v[72:73], v[72:73], v[94:95] op_sel:[0,0,0] op_sel_hi:[0,1,1] neg_lo:[0,0,1]
    v_pk_mul_f32 v[92:93], v[82:83], v[82:83] op_sel:[1,1] op_sel_hi:[0,1]
    v_pk_fma_f32 v[84:85], v[82:83], v[82:83], v[92:93] op_sel:[0,0,0] op_sel_hi:[0,1,1] neg_lo:[0,0,1]
    v_pk_mul_f32 v[94:95], v[66:67], v[76:77] op_sel:[1,1] op_sel_hi:[1,0]
    v_pk_fma_f32 v[86:87], v[66:67], v[76:77], v[94:95] op_sel:[0,0,0] op_sel_hi:[0,1,1] neg_lo:[0,0,1] neg_hi:[1,0,1]
    v_mov_b32_dpp v80, v78 row_ror:8 row_mask:0xf bank_mask:0x3
    v_mov_b32_dpp v81, v79 row_ror:8 row_mask:0xf bank_mask:0x3
    v_mov_b32_dpp v82, v84 row_ror:8 row_mask:0xf bank_mask:0x3
    v_mov_b32_dpp v83, v85 row_ror:8 row_mask:0xf bank_mask:0x3
    v_pk_mul_f32 v[92:93], v[66:67], v[80:81] op_sel:[1,1] op_sel_hi:[1,0]
    v_pk_fma_f32 v[88:89], v[66:67], v[80:81], v[92:93] op_sel:[0,0,0] op_sel_hi:[0,1,1] neg_lo:[0,0,1] neg_hi:[1,0,1]
    v_pk_mul_f32 v[94:95], v[66:67], v[82:83] op_sel:[1,1] op_sel_hi:[1,0]
    v_pk_fma_f32 v[90:91], v[66:67], v[82:83], v[94:95] op_sel:[0,0,0] op_sel_hi:[0,1,1] neg_lo:[0,0,1] neg_hi:[1,0,1]
    v_mfma_f32_16x16x4_f32 v[48:51], v86, v68, v[48:51]
    v_mfma_f32_16x16x4_f32 v[52:55], v88, v70, v[52:55]
    v_mfma_f32_16x16x4_f32 v[56:59], v88, v72, v[56:59]
    v_mfma_f32_16x16x4_f32 v[60:63], v90, v74, v[60:63]
    v_mfma_f32_16x16x4_f32 v[48:51], v87, v69, v[48:51]
    v_mfma_f32_16x16x4_f32 v[52:55], v89, v71, v[52:55]
    v_mfma_f32_16x16x4_f32 v[56:59], v89, v73, v[56:59]
    v_mfma_f32_16x16x4_f32 v[60:63], v91, v75, v[60:63]
    v_mov_b64 v[28:29], v[32:33]
    v_mov_b64 v[30:31], v[34:35]
    s_add_u32 s25, s25, 1
    s_cmp_lt_u32 s25, 2
    s_cbranch_scc1 ss_kg
    s_cmp_lg_u32 s28, 0
    s_cbranch_scc1 ss_nostage
    s_waitcnt vmcnt(0)
    v_mov_b32 v36, 0x05040100
    v_mov_b32 v37, 0x07060302
    v_lshlrev_b32 v6, 4, v0
    v_add_u32 v7, 65536, v6
    v_perm_b32 v40, v212, v208, v36
    v_perm_b32 v41, v220, v216, v36
    v_perm_b32 v42, v228, v224, v36
    v_perm_b32 v43, v236, v232, v36
    ds_write_b128 v6, v[40:43] offset:512
    v_perm_b32 v44, v212, v208, v37
    v_perm_b32 v45, v220, v216, v37
    v_perm_b32 v46, v228, v224, v37
    v_perm_b32 v47, v236, v232, v37
    ds_write_b128 v6, v[44:47] offset:16896
    v_perm_b32 v40, v213, v209, v36
    v_perm_b32 v41, v221, v217, v36
    v_perm_b32 v42, v229, v225, v36
    v_perm_b32 v43, v237, v233, v36
    ds_write_b128 v6, v[40:43] offset:33280
    v_perm_b32 v44, v213, v209, v37
    v_perm_b32 v45, v221, v217, v37
    v_perm_b32 v46, v229, v225, v37
    v_perm_b32 v47, v237, v233, v37
    ds_write_b128 v6, v[44:47] offset:49664
    v_perm_b32 v40, v214, v210, v36
    v_perm_b32 v41, v222, v218, v36
    v_perm_b32 v42, v230, v226, v36
    v_perm_b32 v43, v238, v234, v36
    ds_write_b128 v7, v[40:43] offset:512
    v_perm_b32 v44, v214, v210, v37
    v_perm_b32 v45, v222, v218, v37
    v_perm_b32 v46, v230, v226, v37
    v_perm_b32 v47, v238, v234, v37
    ds_write_b128 v7, v[44:47] offset:16896
    v_perm_b32 v40, v215, v211, v36
    v_perm_b32 v41, v223, v219, v36
    v_perm_b32 v42, v231, v227, v36
    v_perm_b32 v43, v239, v235, v36
    ds_write_b128 v7, v[40:43] offset:33280
    v_perm_b32 v44, v215, v211, v37
    v_perm_b32 v45, v223, v219, v37
    v_perm_b32 v46, v231, v227, v37
    v_perm_b32 v47, v239, v235, v37
    ds_write_b128 v7, v[44:47] offset:49664
ss_nostage:
    s_nop 11
    v_lshlrev_b32 v5, 8, v3
    v_lshl_add_u32 v5, v2, 2, v5
    v_add_u32 v5, v5, v4
    ds_write_b32 v5, v48 offset:4608
    ds_write_b32 v5, v49 offset:4672
    ds_write_b32 v5, v50 offset:4736
    ds_write_b32 v5, v51 offset:4800
    s_mov_b32 exec_hi, 0
    ds_write_b32 v5, v52 offset:5632
    ds_write_b32 v5, v53 offset:5696
    ds_write_b32 v5, v54 offset:5760
    ds_write_b32 v5, v55 offset:5824
    s_not_b64 exec, exec
    ds_write_b32 v5, v56 offset:5632
    ds_write_b32 v5, v57 offset:5696
    ds_write_b32 v5, v58 offset:5760
    ds_write_b32 v5, v59 offset:5824
    ds_write_b32 v5, v60 offset:6144
    ds_write_b32 v5, v61 offset:6208
    ds_write_b32 v5, v62 offset:6272
    ds_write_b32 v5, v63 offset:6336
    s_mov_b64 exec, 3
    v_cmp_eq_u32 vcc, 0, v2
    s_nop 1
    v_cndmask_b32 v6, 0, v60, vcc
    ds_write_b32 v5, v6 offset:7168
    s_mov_b64 exec, -1
    s_waitcnt lgkmcnt(0)
    v_lshlrev_b32 v7, 1, v1
    v_sub_u32 v7, 2065, v7
    v_lshl_add_u32 v64, v1, 2, v4
    v_mov_b32 v65, 641
    s_mov_b32 s25, 9
    s_mov_b32 s22, 256
    s_mov_b32 s23, 2048
ss_exp:
    v_subrev_u32 v66, 0, v7
    v_cvt_f32_u32 v72, v66
    v_cmp_gt_u32 vcc, s22, v66
    v_cvt_pk_bf16_f32 v72, v72, 0
    v_subrev_u32 v72, 0x4280, v72
    v_cndmask_b32 v72, v72, v66, vcc
    v_cmp_gt_u32 vcc, s23, v66
    s_nop 1
    v_cndmask_b32 v72, v65, v72, vcc
    v_lshl_add_u32 v72, v72, 2, v4
    v_subrev_u32 v67, 1, v7
    v_cvt_f32_u32 v73, v67
    v_cmp_gt_u32 vcc, s22, v67
    v_cvt_pk_bf16_f32 v73, v73, 0
    v_subrev_u32 v73, 0x4280, v73
    v_cndmask_b32 v73, v73, v67, vcc
    v_cmp_gt_u32 vcc, s23, v67
    ds_read_b32 v78, v72 offset:4608
    s_nop 0
    v_cndmask_b32 v73, v65, v73, vcc
    v_lshl_add_u32 v73, v73, 2, v4
    v_subrev_u32 v68, 2, v7
    v_cvt_f32_u32 v74, v68
    v_cmp_gt_u32 vcc, s22, v68
    v_cvt_pk_bf16_f32 v74, v74, 0
    v_subrev_u32 v74, 0x4280, v74
    v_cndmask_b32 v74, v74, v68, vcc
    v_cmp_gt_u32 vcc, s23, v68
    ds_read_b32 v79, v73 offset:4608
    s_nop 0
    v_cndmask_b32 v74, v65, v74, vcc
    v_lshl_add_u32 v74, v74, 2, v4
    v_subrev_u32 v69, 128, v7
    v_cvt_f32_u32 v75, v69
    v_cmp_gt_u32 vcc, s22, v69
    v_cvt_pk_bf16_f32 v75, v75, 0
    v_subrev_u32 v75, 0x4280, v75
    v_cndmask_b32 v75, v75, v69, vcc
    v_cmp_gt_u32 vcc, s23, v69
    ds_read_b32 v80, v74 offset:4608
    s_nop 0
    v_cndmask_b32 v75, v65, v75, vcc
    v_lshl_add_u32 v75, v75, 2, v4
    v_subrev_u32 v70, 129, v7
    v_cvt_f32_u32 v76, v70
    v_cmp_gt_u32 vcc, s22, v70
    v_cvt_pk_bf16_f32 v76, v76, 0
    v_subrev_u32 v76, 0x4280, v76
    v_cndmask_b32 v76, v76, v70, vcc
    v_cmp_gt_u32 vcc, s23, v70
    ds_read_b32 v81, v75 offset:4608
    s_nop 0
    v_cndmask_b32 v76, v65, v76, vcc
    v_lshl_add_u32 v76, v76, 2, v4
    v_subrev_u32 v71, 130, v7
    v_cvt_f32_u32 v77, v71
    v_cmp_gt_u32 vcc, s22, v71
    v_cvt_pk_bf16_f32 v77, v77, 0
    v_subrev_u32 v77, 0x4280, v77
    v_cndmask_b32 v77, v77, v71, vcc
    v_cmp_gt_u32 vcc, s23, v71
    ds_read_b32 v82, v76 offset:4608
    s_nop 0
    v_cndmask_b32 v77, v65, v77, vcc
    v_lshl_add_u32 v77, v77, 2, v4
    ds_read_b32 v83, v77 offset:4608
    v_subrev_u32 v7, 256, v7
    s_sub_u32 s25, s25, 1
    s_waitcnt lgkmcnt(0)
    v_cvt_pk_bf16_f32 v84, v79, v80
    v_cvt_pk_bf16_f32 v85, v78, v79
    v_cvt_pk_bf16_f32 v86, v82, v83
    v_cvt_pk_bf16_f32 v87, v81, v82
    ds_write_b32 v64, v84 offset:7424
    ds_write_b32 v64, v85 offset:11776
    s_cmp_eq_u32 s25, 0
    s_cbranch_scc1 ss_expx
    ds_write_b32 v64, v86 offset:7680
    ds_write_b32 v64, v87 offset:12032
    v_add_u32 v64, 512, v64
    s_nop 1
    s_branch ss_exp
ss_expx:
    s_waitcnt lgkmcnt(0)
    s_barrier
    v_and_b32 v5, 1, v2
    v_mul_u32_u24 v36, 4352, v5
    v_sub_u32 v5, v5, v2
    v_lshl_add_u32 v5, v3, 3, v5
    v_lshl_add_u32 v36, v5, 1, v36
    v_add_u32 v36, 11072, v36
    v_add_u32 v36, v36, v4
    v_subrev_u32 v37, 512, v36
    v_subrev_u32 v38, 1024, v36
    v_subrev_u32 v39, 1536, v36
    v_subrev_u32 v40, 2048, v36
    v_subrev_u32 v41, 2560, v36
    v_subrev_u32 v42, 3072, v36
    v_subrev_u32 v43, 3584, v36
    v_lshlrev_b32 v44, 5, v2
    v_lshl_add_u32 v44, v3, 4, v44
    v_add_u32 v44, 32, v44
    v_add_u32 v44, v44, v4
    ds_read_b128 v[112:115], v44 offset:448
    ds_read2_b32 v[80:81], v36 offset0:112 offset1:113
    ds_read2_b32 v[82:83], v36 offset0:114 offset1:115
    ds_read_b128 v[116:119], v44 offset:960
    ds_read2_b32 v[84:85], v37 offset0:112 offset1:113
    ds_read2_b32 v[86:87], v37 offset0:114 offset1:115
    ds_read_b128 v[120:123], v44 offset:1472
    ds_read2_b32 v[88:89], v38 offset0:112 offset1:113
    ds_read2_b32 v[90:91], v38 offset0:114 offset1:115
    ds_read_b128 v[124:127], v44 offset:1984
    ds_read2_b32 v[92:93], v39 offset0:112 offset1:113
    ds_read2_b32 v[94:95], v39 offset0:114 offset1:115
    ds_read_b128 v[128:131], v44 offset:2496
    ds_read2_b32 v[96:97], v40 offset0:112 offset1:113
    ds_read2_b32 v[98:99], v40 offset0:114 offset1:115
    ds_read_b128 v[132:135], v44 offset:3008
    ds_read2_b32 v[100:101], v41 offset0:112 offset1:113
    ds_read2_b32 v[102:103], v41 offset0:114 offset1:115
    ds_read_b128 v[136:139], v44 offset:3520
    ds_read2_b32 v[104:105], v42 offset0:112 offset1:113
    ds_read2_b32 v[106:107], v42 offset0:114 offset1:115
    ds_read_b128 v[140:143], v44 offset:4032
    ds_read2_b32 v[108:109], v43 offset0:112 offset1:113
    ds_read2_b32 v[110:111], v43 offset0:114 offset1:115
    s_waitcnt lgkmcnt(0)
    v_mfma_f32_16x16x32_bf16 v[48:51], v[80:83], v[112:115], 0
    ds_read_b128 v[176:179], v44 offset:384
    v_mfma_f32_16x16x32_bf16 v[52:55], v[80:83], v[116:119], 0
    ds_read2_b32 v[144:145], v36 offset0:96 offset1:97
    v_mfma_f32_16x16x32_bf16 v[56:59], v[80:83], v[120:123], 0
    ds_read2_b32 v[146:147], v36 offset0:98 offset1:99
    v_mfma_f32_16x16x32_bf16 v[60:63], v[80:83], v[124:127], 0
    ds_read_b128 v[180:183], v44 offset:896
    v_mfma_f32_16x16x32_bf16 v[64:67], v[80:83], v[128:131], 0
    ds_read2_b32 v[148:149], v37 offset0:96 offset1:97
    v_mfma_f32_16x16x32_bf16 v[68:71], v[80:83], v[132:135], 0
    ds_read2_b32 v[150:151], v37 offset0:98 offset1:99
    v_mfma_f32_16x16x32_bf16 v[72:75], v[80:83], v[136:139], 0
    ds_read_b128 v[184:187], v44 offset:1408
    v_mfma_f32_16x16x32_bf16 v[76:79], v[80:83], v[140:143], 0
    ds_read2_b32 v[152:153], v38 offset0:96 offset1:97
    v_mfma_f32_16x16x32_bf16 v[52:55], v[84:87], v[112:115], v[52:55]
    ds_read2_b32 v[154:155], v38 offset0:98 offset1:99
    v_mfma_f32_16x16x32_bf16 v[56:59], v[84:87], v[116:119], v[56:59]
    ds_read_b128 v[188:191], v44 offset:1920
    v_mfma_f32_16x16x32_bf16 v[60:63], v[84:87], v[120:123], v[60:63]
    ds_read2_b32 v[156:157], v39 offset0:96 offset1:97
    v_mfma_f32_16x16x32_bf16 v[64:67], v[84:87], v[124:127], v[64:67]
    ds_read2_b32 v[158:159], v39 offset0:98 offset1:99
    v_mfma_f32_16x16x32_bf16 v[68:71], v[84:87], v[128:131], v[68:71]
    ds_read_b128 v[192:195], v44 offset:2432
    v_mfma_f32_16x16x32_bf16 v[72:75], v[84:87], v[132:135], v[72:75]
    ds_read2_b32 v[160:161], v40 offset0:96 offset1:97
    v_mfma_f32_16x16x32_bf16 v[76:79], v[84:87], v[136:139], v[76:79]
    ds_read2_b32 v[162:163], v40 offset0:98 offset1:99
    v_mfma_f32_16x16x32_bf16 v[56:59], v[88:91], v[112:115], v[56:59]
    ds_read_b128 v[196:199], v44 offset:2944
    v_mfma_f32_16x16x32_bf16 v[60:63], v[88:91], v[116:119], v[60:63]
    ds_read2_b32 v[164:165], v41 offset0:96 offset1:97
    v_mfma_f32_16x16x32_bf16 v[64:67], v[88:91], v[120:123], v[64:67]
    ds_read2_b32 v[166:167], v41 offset0:98 offset1:99
    v_mfma_f32_16x16x32_bf16 v[68:71], v[88:91], v[124:127], v[68:71]
    ds_read_b128 v[200:203], v44 offset:3456
    v_mfma_f32_16x16x32_bf16 v[72:75], v[88:91], v[128:131], v[72:75]
    ds_read2_b32 v[168:169], v42 offset0:96 offset1:97
    v_mfma_f32_16x16x32_bf16 v[76:79], v[88:91], v[132:135], v[76:79]
    ds_read2_b32 v[170:171], v42 offset0:98 offset1:99
    v_mfma_f32_16x16x32_bf16 v[60:63], v[92:95], v[112:115], v[60:63]
    ds_read_b128 v[204:207], v44 offset:3968
    v_mfma_f32_16x16x32_bf16 v[64:67], v[92:95], v[116:119], v[64:67]
    ds_read2_b32 v[172:173], v43 offset0:96 offset1:97
    v_mfma_f32_16x16x32_bf16 v[68:71], v[92:95], v[120:123], v[68:71]
    ds_read2_b32 v[174:175], v43 offset0:98 offset1:99
    v_mfma_f32_16x16x32_bf16 v[72:75], v[92:95], v[124:127], v[72:75]
    v_mfma_f32_16x16x32_bf16 v[76:79], v[92:95], v[128:131], v[76:79]
    v_mfma_f32_16x16x32_bf16 v[64:67], v[96:99], v[112:115], v[64:67]
    v_mfma_f32_16x16x32_bf16 v[68:71], v[96:99], v[116:119], v[68:71]
    v_mfma_f32_16x16x32_bf16 v[72:75], v[96:99], v[120:123], v[72:75]
    v_mfma_f32_16x16x32_bf16 v[76:79], v[96:99], v[124:127], v[76:79]
    v_mfma_f32_16x16x32_bf16 v[68:71], v[100:103], v[112:115], v[68:71]
    v_mfma_f32_16x16x32_bf16 v[72:75], v[100:103], v[116:119], v[72:75]
    v_mfma_f32_16x16x32_bf16 v[76:79], v[100:103], v[120:123], v[76:79]
    v_mfma_f32_16x16x32_bf16 v[72:75], v[104:107], v[112:115], v[72:75]
    v_mfma_f32_16x16x32_bf16 v[76:79], v[104:107], v[116:119], v[76:79]
    v_mfma_f32_16x16x32_bf16 v[76:79], v[108:111], v[112:115], v[76:79]
    s_waitcnt lgkmcnt(0)
    v_mfma_f32_16x16x32_bf16 v[48:51], v[144:147], v[176:179], v[48:51]
    ds_read_b128 v[112:115], v44 offset:320
    v_mfma_f32_16x16x32_bf16 v[52:55], v[144:147], v[180:183], v[52:55]
    ds_read2_b32 v[80:81], v36 offset0:80 offset1:81
    v_mfma_f32_16x16x32_bf16 v[56:59], v[144:147], v[184:187], v[56:59]
    ds_read2_b32 v[82:83], v36 offset0:82 offset1:83
    v_mfma_f32_16x16x32_bf16 v[60:63], v[144:147], v[188:191], v[60:63]
    ds_read_b128 v[116:119], v44 offset:832
    v_mfma_f32_16x16x32_bf16 v[64:67], v[144:147], v[192:195], v[64:67]
    ds_read2_b32 v[84:85], v37 offset0:80 offset1:81
    v_mfma_f32_16x16x32_bf16 v[68:71], v[144:147], v[196:199], v[68:71]
    ds_read2_b32 v[86:87], v37 offset0:82 offset1:83
    v_mfma_f32_16x16x32_bf16 v[72:75], v[144:147], v[200:203], v[72:75]
    ds_read_b128 v[120:123], v44 offset:1344
    v_mfma_f32_16x16x32_bf16 v[76:79], v[144:147], v[204:207], v[76:79]
    ds_read2_b32 v[88:89], v38 offset0:80 offset1:81
    v_mfma_f32_16x16x32_bf16 v[52:55], v[148:151], v[176:179], v[52:55]
    ds_read2_b32 v[90:91], v38 offset0:82 offset1:83
    v_mfma_f32_16x16x32_bf16 v[56:59], v[148:151], v[180:183], v[56:59]
    ds_read_b128 v[124:127], v44 offset:1856
    v_mfma_f32_16x16x32_bf16 v[60:63], v[148:151], v[184:187], v[60:63]
    ds_read2_b32 v[92:93], v39 offset0:80 offset1:81
    v_mfma_f32_16x16x32_bf16 v[64:67], v[148:151], v[188:191], v[64:67]
    ds_read2_b32 v[94:95], v39 offset0:82 offset1:83
    v_mfma_f32_16x16x32_bf16 v[68:71], v[148:151], v[192:195], v[68:71]
    ds_read_b128 v[128:131], v44 offset:2368
    v_mfma_f32_16x16x32_bf16 v[72:75], v[148:151], v[196:199], v[72:75]
    ds_read2_b32 v[96:97], v40 offset0:80 offset1:81
    v_mfma_f32_16x16x32_bf16 v[76:79], v[148:151], v[200:203], v[76:79]
    ds_read2_b32 v[98:99], v40 offset0:82 offset1:83
    v_mfma_f32_16x16x32_bf16 v[56:59], v[152:155], v[176:179], v[56:59]
    ds_read_b128 v[132:135], v44 offset:2880
    v_mfma_f32_16x16x32_bf16 v[60:63], v[152:155], v[180:183], v[60:63]
    ds_read2_b32 v[100:101], v41 offset0:80 offset1:81
    v_mfma_f32_16x16x32_bf16 v[64:67], v[152:155], v[184:187], v[64:67]
    ds_read2_b32 v[102:103], v41 offset0:82 offset1:83
    v_mfma_f32_16x16x32_bf16 v[68:71], v[152:155], v[188:191], v[68:71]
    ds_read_b128 v[136:139], v44 offset:3392
    v_mfma_f32_16x16x32_bf16 v[72:75], v[152:155], v[192:195], v[72:75]
    ds_read2_b32 v[104:105], v42 offset0:80 offset1:81
    v_mfma_f32_16x16x32_bf16 v[76:79], v[152:155], v[196:199], v[76:79]
    ds_read2_b32 v[106:107], v42 offset0:82 offset1:83
    v_mfma_f32_16x16x32_bf16 v[60:63], v[156:159], v[176:179], v[60:63]
    ds_read_b128 v[140:143], v44 offset:3904
    v_mfma_f32_16x16x32_bf16 v[64:67], v[156:159], v[180:183], v[64:67]
    ds_read2_b32 v[108:109], v43 offset0:80 offset1:81
    v_mfma_f32_16x16x32_bf16 v[68:71], v[156:159], v[184:187], v[68:71]
    ds_read2_b32 v[110:111], v43 offset0:82 offset1:83
    v_mfma_f32_16x16x32_bf16 v[72:75], v[156:159], v[188:191], v[72:75]
    v_mfma_f32_16x16x32_bf16 v[76:79], v[156:159], v[192:195], v[76:79]
    v_mfma_f32_16x16x32_bf16 v[64:67], v[160:163], v[176:179], v[64:67]
    v_mfma_f32_16x16x32_bf16 v[68:71], v[160:163], v[180:183], v[68:71]
    v_mfma_f32_16x16x32_bf16 v[72:75], v[160:163], v[184:187], v[72:75]
    v_mfma_f32_16x16x32_bf16 v[76:79], v[160:163], v[188:191], v[76:79]
    v_mfma_f32_16x16x32_bf16 v[68:71], v[164:167], v[176:179], v[68:71]
    v_mfma_f32_16x16x32_bf16 v[72:75], v[164:167], v[180:183], v[72:75]
    v_mfma_f32_16x16x32_bf16 v[76:79], v[164:167], v[184:187], v[76:79]
    v_mfma_f32_16x16x32_bf16 v[72:75], v[168:171], v[176:179], v[72:75]
    v_mfma_f32_16x16x32_bf16 v[76:79], v[168:171], v[180:183], v[76:79]
    v_mfma_f32_16x16x32_bf16 v[76:79], v[172:175], v[176:179], v[76:79]
    s_waitcnt lgkmcnt(0)
    v_mfma_f32_16x16x32_bf16 v[48:51], v[80:83], v[112:115], v[48:51]
    ds_read_b128 v[176:179], v44 offset:256
    v_mfma_f32_16x16x32_bf16 v[52:55], v[80:83], v[116:119], v[52:55]
    ds_read2_b32 v[144:145], v36 offset0:64 offset1:65
    v_mfma_f32_16x16x32_bf16 v[56:59], v[80:83], v[120:123], v[56:59]
    ds_read2_b32 v[146:147], v36 offset0:66 offset1:67
    v_mfma_f32_16x16x32_bf16 v[60:63], v[80:83], v[124:127], v[60:63]
    ds_read_b128 v[180:183], v44 offset:768
    v_mfma_f32_16x16x32_bf16 v[64:67], v[80:83], v[128:131], v[64:67]
    ds_read2_b32 v[148:149], v37 offset0:64 offset1:65
    v_mfma_f32_16x16x32_bf16 v[68:71], v[80:83], v[132:135], v[68:71]
    ds_read2_b32 v[150:151], v37 offset0:66 offset1:67
    v_mfma_f32_16x16x32_bf16 v[72:75], v[80:83], v[136:139], v[72:75]
    ds_read_b128 v[184:187], v44 offset:1280
    v_mfma_f32_16x16x32_bf16 v[76:79], v[80:83], v[140:143], v[76:79]
    ds_read2_b32 v[152:153], v38 offset0:64 offset1:65
    v_mfma_f32_16x16x32_bf16 v[52:55], v[84:87], v[112:115], v[52:55]
    ds_read2_b32 v[154:155], v38 offset0:66 offset1:67
    v_mfma_f32_16x16x32_bf16 v[56:59], v[84:87], v[116:119], v[56:59]
    ds_read_b128 v[188:191], v44 offset:1792
    v_mfma_f32_16x16x32_bf16 v[60:63], v[84:87], v[120:123], v[60:63]
    ds_read2_b32 v[156:157], v39 offset0:64 offset1:65
    v_mfma_f32_16x16x32_bf16 v[64:67], v[84:87], v[124:127], v[64:67]
    ds_read2_b32 v[158:159], v39 offset0:66 offset1:67
    v_mfma_f32_16x16x32_bf16 v[68:71], v[84:87], v[128:131], v[68:71]
    ds_read_b128 v[192:195], v44 offset:2304
    v_mfma_f32_16x16x32_bf16 v[72:75], v[84:87], v[132:135], v[72:75]
    ds_read2_b32 v[160:161], v40 offset0:64 offset1:65
    v_mfma_f32_16x16x32_bf16 v[76:79], v[84:87], v[136:139], v[76:79]
    ds_read2_b32 v[162:163], v40 offset0:66 offset1:67
    v_mfma_f32_16x16x32_bf16 v[56:59], v[88:91], v[112:115], v[56:59]
    ds_read_b128 v[196:199], v44 offset:2816
    v_mfma_f32_16x16x32_bf16 v[60:63], v[88:91], v[116:119], v[60:63]
    ds_read2_b32 v[164:165], v41 offset0:64 offset1:65
    v_mfma_f32_16x16x32_bf16 v[64:67], v[88:91], v[120:123], v[64:67]
    ds_read2_b32 v[166:167], v41 offset0:66 offset1:67
    v_mfma_f32_16x16x32_bf16 v[68:71], v[88:91], v[124:127], v[68:71]
    ds_read_b128 v[200:203], v44 offset:3328
    v_mfma_f32_16x16x32_bf16 v[72:75], v[88:91], v[128:131], v[72:75]
    ds_read2_b32 v[168:169], v42 offset0:64 offset1:65
    v_mfma_f32_16x16x32_bf16 v[76:79], v[88:91], v[132:135], v[76:79]
    ds_read2_b32 v[170:171], v42 offset0:66 offset1:67
    v_mfma_f32_16x16x32_bf16 v[60:63], v[92:95], v[112:115], v[60:63]
    ds_read_b128 v[204:207], v44 offset:3840
    v_mfma_f32_16x16x32_bf16 v[64:67], v[92:95], v[116:119], v[64:67]
    ds_read2_b32 v[172:173], v43 offset0:64 offset1:65
    v_mfma_f32_16x16x32_bf16 v[68:71], v[92:95], v[120:123], v[68:71]
    ds_read2_b32 v[174:175], v43 offset0:66 offset1:67
    v_mfma_f32_16x16x32_bf16 v[72:75], v[92:95], v[124:127], v[72:75]
    v_mfma_f32_16x16x32_bf16 v[76:79], v[92:95], v[128:131], v[76:79]
    v_mfma_f32_16x16x32_bf16 v[64:67], v[96:99], v[112:115], v[64:67]
    v_mfma_f32_16x16x32_bf16 v[68:71], v[96:99], v[116:119], v[68:71]
    v_mfma_f32_16x16x32_bf16 v[72:75], v[96:99], v[120:123], v[72:75]
    v_mfma_f32_16x16x32_bf16 v[76:79], v[96:99], v[124:127], v[76:79]
    v_mfma_f32_16x16x32_bf16 v[68:71], v[100:103], v[112:115], v[68:71]
    v_mfma_f32_16x16x32_bf16 v[72:75], v[100:103], v[116:119], v[72:75]
    v_mfma_f32_16x16x32_bf16 v[76:79], v[100:103], v[120:123], v[76:79]
    v_mfma_f32_16x16x32_bf16 v[72:75], v[104:107], v[112:115], v[72:75]
    v_mfma_f32_16x16x32_bf16 v[76:79], v[104:107], v[116:119], v[76:79]
    v_mfma_f32_16x16x32_bf16 v[76:79], v[108:111], v[112:115], v[76:79]
    s_waitcnt lgkmcnt(0)
    v_mfma_f32_16x16x32_bf16 v[48:51], v[144:147], v[176:179], v[48:51]
    ds_read_b128 v[112:115], v44 offset:192
    v_mfma_f32_16x16x32_bf16 v[52:55], v[144:147], v[180:183], v[52:55]
    ds_read2_b32 v[80:81], v36 offset0:48 offset1:49
    v_mfma_f32_16x16x32_bf16 v[56:59], v[144:147], v[184:187], v[56:59]
    ds_read2_b32 v[82:83], v36 offset0:50 offset1:51
    v_mfma_f32_16x16x32_bf16 v[60:63], v[144:147], v[188:191], v[60:63]
    ds_read_b128 v[116:119], v44 offset:704
    v_mfma_f32_16x16x32_bf16 v[64:67], v[144:147], v[192:195], v[64:67]
    ds_read2_b32 v[84:85], v37 offset0:48 offset1:49
    v_mfma_f32_16x16x32_bf16 v[68:71], v[144:147], v[196:199], v[68:71]
    ds_read2_b32 v[86:87], v37 offset0:50 offset1:51
    v_mfma_f32_16x16x32_bf16 v[72:75], v[144:147], v[200:203], v[72:75]
    ds_read_b128 v[120:123], v44 offset:1216
    v_mfma_f32_16x16x32_bf16 v[76:79], v[144:147], v[204:207], v[76:79]
    ds_read2_b32 v[88:89], v38 offset0:48 offset1:49
    v_mfma_f32_16x16x32_bf16 v[52:55], v[148:151], v[176:179], v[52:55]
    ds_read2_b32 v[90:91], v38 offset0:50 offset1:51
    v_mfma_f32_16x16x32_bf16 v[56:59], v[148:151], v[180:183], v[56:59]
    ds_read_b128 v[124:127], v44 offset:1728
    v_mfma_f32_16x16x32_bf16 v[60:63], v[148:151], v[184:187], v[60:63]
    ds_read2_b32 v[92:93], v39 offset0:48 offset1:49
    v_mfma_f32_16x16x32_bf16 v[64:67], v[148:151], v[188:191], v[64:67]
    ds_read2_b32 v[94:95], v39 offset0:50 offset1:51
    v_mfma_f32_16x16x32_bf16 v[68:71], v[148:151], v[192:195], v[68:71]
    ds_read_b128 v[128:131], v44 offset:2240
    v_mfma_f32_16x16x32_bf16 v[72:75], v[148:151], v[196:199], v[72:75]
    ds_read2_b32 v[96:97], v40 offset0:48 offset1:49
    v_mfma_f32_16x16x32_bf16 v[76:79], v[148:151], v[200:203], v[76:79]
    ds_read2_b32 v[98:99], v40 offset0:50 offset1:51
    v_mfma_f32_16x16x32_bf16 v[56:59], v[152:155], v[176:179], v[56:59]
    ds_read_b128 v[132:135], v44 offset:2752
    v_mfma_f32_16x16x32_bf16 v[60:63], v[152:155], v[180:183], v[60:63]
    ds_read2_b32 v[100:101], v41 offset0:48 offset1:49
    v_mfma_f32_16x16x32_bf16 v[64:67], v[152:155], v[184:187], v[64:67]
    ds_read2_b32 v[102:103], v41 offset0:50 offset1:51
    v_mfma_f32_16x16x32_bf16 v[68:71], v[152:155], v[188:191], v[68:71]
    ds_read_b128 v[136:139], v44 offset:3264
    v_mfma_f32_16x16x32_bf16 v[72:75], v[152:155], v[192:195], v[72:75]
    ds_read2_b32 v[104:105], v42 offset0:48 offset1:49
    v_mfma_f32_16x16x32_bf16 v[76:79], v[152:155], v[196:199], v[76:79]
    ds_read2_b32 v[106:107], v42 offset0:50 offset1:51
    v_mfma_f32_16x16x32_bf16 v[60:63], v[156:159], v[176:179], v[60:63]
    ds_read_b128 v[140:143], v44 offset:3776
    v_mfma_f32_16x16x32_bf16 v[64:67], v[156:159], v[180:183], v[64:67]
    ds_read2_b32 v[108:109], v43 offset0:48 offset1:49
    v_mfma_f32_16x16x32_bf16 v[68:71], v[156:159], v[184:187], v[68:71]
    ds_read2_b32 v[110:111], v43 offset0:50 offset1:51
    v_mfma_f32_16x16x32_bf16 v[72:75], v[156:159], v[188:191], v[72:75]
    v_mfma_f32_16x16x32_bf16 v[76:79], v[156:159], v[192:195], v[76:79]
    v_mfma_f32_16x16x32_bf16 v[64:67], v[160:163], v[176:179], v[64:67]
    v_mfma_f32_16x16x32_bf16 v[68:71], v[160:163], v[180:183], v[68:71]
    v_mfma_f32_16x16x32_bf16 v[72:75], v[160:163], v[184:187], v[72:75]
    v_mfma_f32_16x16x32_bf16 v[76:79], v[160:163], v[188:191], v[76:79]
    v_mfma_f32_16x16x32_bf16 v[68:71], v[164:167], v[176:179], v[68:71]
    v_mfma_f32_16x16x32_bf16 v[72:75], v[164:167], v[180:183], v[72:75]
    v_mfma_f32_16x16x32_bf16 v[76:79], v[164:167], v[184:187], v[76:79]
    v_mfma_f32_16x16x32_bf16 v[72:75], v[168:171], v[176:179], v[72:75]
    v_mfma_f32_16x16x32_bf16 v[76:79], v[168:171], v[180:183], v[76:79]
    v_mfma_f32_16x16x32_bf16 v[76:79], v[172:175], v[176:179], v[76:79]
    s_waitcnt lgkmcnt(0)
    v_mfma_f32_16x16x32_bf16 v[48:51], v[80:83], v[112:115], v[48:51]
    ds_read_b128 v[176:179], v44 offset:128
    v_mfma_f32_16x16x32_bf16 v[52:55], v[80:83], v[116:119], v[52:55]
    ds_read2_b32 v[144:145], v36 offset0:32 offset1:33
    v_mfma_f32_16x16x32_bf16 v[56:59], v[80:83], v[120:123], v[56:59]
    ds_read2_b32 v[146:147], v36 offset0:34 offset1:35
    v_mfma_f32_16x16x32_bf16 v[60:63], v[80:83], v[124:127], v[60:63]
    ds_read_b128 v[180:183], v44 offset:640
    v_mfma_f32_16x16x32_bf16 v[64:67], v[80:83], v[128:131], v[64:67]
    ds_read2_b32 v[148:149], v37 offset0:32 offset1:33
    v_mfma_f32_16x16x32_bf16 v[68:71], v[80:83], v[132:135], v[68:71]
    ds_read2_b32 v[150:151], v37 offset0:34 offset1:35
    v_mfma_f32_16x16x32_bf16 v[72:75], v[80:83], v[136:139], v[72:75]
    ds_read_b128 v[184:187], v44 offset:1152
    v_mfma_f32_16x16x32_bf16 v[76:79], v[80:83], v[140:143], v[76:79]
    ds_read2_b32 v[152:153], v38 offset0:32 offset1:33
    v_mfma_f32_16x16x32_bf16 v[52:55], v[84:87], v[112:115], v[52:55]
    ds_read2_b32 v[154:155], v38 offset0:34 offset1:35
    v_mfma_f32_16x16x32_bf16 v[56:59], v[84:87], v[116:119], v[56:59]
    ds_read_b128 v[188:191], v44 offset:1664
    v_mfma_f32_16x16x32_bf16 v[60:63], v[84:87], v[120:123], v[60:63]
    ds_read2_b32 v[156:157], v39 offset0:32 offset1:33
    v_mfma_f32_16x16x32_bf16 v[64:67], v[84:87], v[124:127], v[64:67]
    ds_read2_b32 v[158:159], v39 offset0:34 offset1:35
    v_mfma_f32_16x16x32_bf16 v[68:71], v[84:87], v[128:131], v[68:71]
    ds_read_b128 v[192:195], v44 offset:2176
    v_mfma_f32_16x16x32_bf16 v[72:75], v[84:87], v[132:135], v[72:75]
    ds_read2_b32 v[160:161], v40 offset0:32 offset1:33
    v_mfma_f32_16x16x32_bf16 v[76:79], v[84:87], v[136:139], v[76:79]
    ds_read2_b32 v[162:163], v40 offset0:34 offset1:35
    v_mfma_f32_16x16x32_bf16 v[56:59], v[88:91], v[112:115], v[56:59]
    ds_read_b128 v[196:199], v44 offset:2688
    v_mfma_f32_16x16x32_bf16 v[60:63], v[88:91], v[116:119], v[60:63]
    ds_read2_b32 v[164:165], v41 offset0:32 offset1:33
    v_mfma_f32_16x16x32_bf16 v[64:67], v[88:91], v[120:123], v[64:67]
    ds_read2_b32 v[166:167], v41 offset0:34 offset1:35
    v_mfma_f32_16x16x32_bf16 v[68:71], v[88:91], v[124:127], v[68:71]
    ds_read_b128 v[200:203], v44 offset:3200
    v_mfma_f32_16x16x32_bf16 v[72:75], v[88:91], v[128:131], v[72:75]
    ds_read2_b32 v[168:169], v42 offset0:32 offset1:33
    v_mfma_f32_16x16x32_bf16 v[76:79], v[88:91], v[132:135], v[76:79]
    ds_read2_b32 v[170:171], v42 offset0:34 offset1:35
    v_mfma_f32_16x16x32_bf16 v[60:63], v[92:95], v[112:115], v[60:63]
    ds_read_b128 v[204:207], v44 offset:3712
    v_mfma_f32_16x16x32_bf16 v[64:67], v[92:95], v[116:119], v[64:67]
    ds_read2_b32 v[172:173], v43 offset0:32 offset1:33
    v_mfma_f32_16x16x32_bf16 v[68:71], v[92:95], v[120:123], v[68:71]
    ds_read2_b32 v[174:175], v43 offset0:34 offset1:35
    v_mfma_f32_16x16x32_bf16 v[72:75], v[92:95], v[124:127], v[72:75]
    v_mfma_f32_16x16x32_bf16 v[76:79], v[92:95], v[128:131], v[76:79]
    v_mfma_f32_16x16x32_bf16 v[64:67], v[96:99], v[112:115], v[64:67]
    v_mfma_f32_16x16x32_bf16 v[68:71], v[96:99], v[116:119], v[68:71]
    v_mfma_f32_16x16x32_bf16 v[72:75], v[96:99], v[120:123], v[72:75]
    v_mfma_f32_16x16x32_bf16 v[76:79], v[96:99], v[124:127], v[76:79]
    v_mfma_f32_16x16x32_bf16 v[68:71], v[100:103], v[112:115], v[68:71]
    v_mfma_f32_16x16x32_bf16 v[72:75], v[100:103], v[116:119], v[72:75]
    v_mfma_f32_16x16x32_bf16 v[76:79], v[100:103], v[120:123], v[76:79]
    v_mfma_f32_16x16x32_bf16 v[72:75], v[104:107], v[112:115], v[72:75]
    v_mfma_f32_16x16x32_bf16 v[76:79], v[104:107], v[116:119], v[76:79]
    v_mfma_f32_16x16x32_bf16 v[76:79], v[108:111], v[112:115], v[76:79]
    s_waitcnt lgkmcnt(0)
    v_mfma_f32_16x16x32_bf16 v[48:51], v[144:147], v[176:179], v[48:51]
    ds_read_b128 v[112:115], v44 offset:64
    v_mfma_f32_16x16x32_bf16 v[52:55], v[144:147], v[180:183], v[52:55]
    ds_read2_b32 v[80:81], v36 offset0:16 offset1:17
    v_mfma_f32_16x16x32_bf16 v[56:59], v[144:147], v[184:187], v[56:59]
    ds_read2_b32 v[82:83], v36 offset0:18 offset1:19
    v_mfma_f32_16x16x32_bf16 v[60:63], v[144:147], v[188:191], v[60:63]
    ds_read_b128 v[116:119], v44 offset:576
    v_mfma_f32_16x16x32_bf16 v[64:67], v[144:147], v[192:195], v[64:67]
    ds_read2_b32 v[84:85], v37 offset0:16 offset1:17
    v_mfma_f32_16x16x32_bf16 v[68:71], v[144:147], v[196:199], v[68:71]
    ds_read2_b32 v[86:87], v37 offset0:18 offset1:19
    v_mfma_f32_16x16x32_bf16 v[72:75], v[144:147], v[200:203], v[72:75]
    ds_read_b128 v[120:123], v44 offset:1088
    v_mfma_f32_16x16x32_bf16 v[76:79], v[144:147], v[204:207], v[76:79]
    ds_read2_b32 v[88:89], v38 offset0:16 offset1:17
    v_mfma_f32_16x16x32_bf16 v[52:55], v[148:151], v[176:179], v[52:55]
    ds_read2_b32 v[90:91], v38 offset0:18 offset1:19
    v_mfma_f32_16x16x32_bf16 v[56:59], v[148:151], v[180:183], v[56:59]
    ds_read_b128 v[124:127], v44 offset:1600
    v_mfma_f32_16x16x32_bf16 v[60:63], v[148:151], v[184:187], v[60:63]
    ds_read2_b32 v[92:93], v39 offset0:16 offset1:17
    v_mfma_f32_16x16x32_bf16 v[64:67], v[148:151], v[188:191], v[64:67]
    ds_read2_b32 v[94:95], v39 offset0:18 offset1:19
    v_mfma_f32_16x16x32_bf16 v[68:71], v[148:151], v[192:195], v[68:71]
    ds_read_b128 v[128:131], v44 offset:2112
    v_mfma_f32_16x16x32_bf16 v[72:75], v[148:151], v[196:199], v[72:75]
    ds_read2_b32 v[96:97], v40 offset0:16 offset1:17
    v_mfma_f32_16x16x32_bf16 v[76:79], v[148:151], v[200:203], v[76:79]
    ds_read2_b32 v[98:99], v40 offset0:18 offset1:19
    v_mfma_f32_16x16x32_bf16 v[56:59], v[152:155], v[176:179], v[56:59]
    ds_read_b128 v[132:135], v44 offset:2624
    v_mfma_f32_16x16x32_bf16 v[60:63], v[152:155], v[180:183], v[60:63]
    ds_read2_b32 v[100:101], v41 offset0:16 offset1:17
    v_mfma_f32_16x16x32_bf16 v[64:67], v[152:155], v[184:187], v[64:67]
    ds_read2_b32 v[102:103], v41 offset0:18 offset1:19
    v_mfma_f32_16x16x32_bf16 v[68:71], v[152:155], v[188:191], v[68:71]
    ds_read_b128 v[136:139], v44 offset:3136
    v_mfma_f32_16x16x32_bf16 v[72:75], v[152:155], v[192:195], v[72:75]
    ds_read2_b32 v[104:105], v42 offset0:16 offset1:17
    v_mfma_f32_16x16x32_bf16 v[76:79], v[152:155], v[196:199], v[76:79]
    ds_read2_b32 v[106:107], v42 offset0:18 offset1:19
    v_mfma_f32_16x16x32_bf16 v[60:63], v[156:159], v[176:179], v[60:63]
    ds_read_b128 v[140:143], v44 offset:3648
    v_mfma_f32_16x16x32_bf16 v[64:67], v[156:159], v[180:183], v[64:67]
    ds_read2_b32 v[108:109], v43 offset0:16 offset1:17
    v_mfma_f32_16x16x32_bf16 v[68:71], v[156:159], v[184:187], v[68:71]
    ds_read2_b32 v[110:111], v43 offset0:18 offset1:19
    v_mfma_f32_16x16x32_bf16 v[72:75], v[156:159], v[188:191], v[72:75]
    v_mfma_f32_16x16x32_bf16 v[76:79], v[156:159], v[192:195], v[76:79]
    v_mfma_f32_16x16x32_bf16 v[64:67], v[160:163], v[176:179], v[64:67]
    v_mfma_f32_16x16x32_bf16 v[68:71], v[160:163], v[180:183], v[68:71]
    v_mfma_f32_16x16x32_bf16 v[72:75], v[160:163], v[184:187], v[72:75]
    v_mfma_f32_16x16x32_bf16 v[76:79], v[160:163], v[188:191], v[76:79]
    v_mfma_f32_16x16x32_bf16 v[68:71], v[164:167], v[176:179], v[68:71]
    v_mfma_f32_16x16x32_bf16 v[72:75], v[164:167], v[180:183], v[72:75]
    v_mfma_f32_16x16x32_bf16 v[76:79], v[164:167], v[184:187], v[76:79]
    v_mfma_f32_16x16x32_bf16 v[72:75], v[168:171], v[176:179], v[72:75]
    v_mfma_f32_16x16x32_bf16 v[76:79], v[168:171], v[180:183], v[76:79]
    v_mfma_f32_16x16x32_bf16 v[76:79], v[172:175], v[176:179], v[76:79]
    s_waitcnt lgkmcnt(0)
    v_mfma_f32_16x16x32_bf16 v[48:51], v[80:83], v[112:115], v[48:51]
    ds_read_b128 v[176:179], v44 offset:0
    v_mfma_f32_16x16x32_bf16 v[52:55], v[80:83], v[116:119], v[52:55]
    ds_read2_b32 v[144:145], v36 offset0:0 offset1:1
    v_mfma_f32_16x16x32_bf16 v[56:59], v[80:83], v[120:123], v[56:59]
    ds_read2_b32 v[146:147], v36 offset0:2 offset1:3
    v_mfma_f32_16x16x32_bf16 v[60:63], v[80:83], v[124:127], v[60:63]
    ds_read_b128 v[180:183], v44 offset:512
    v_mfma_f32_16x16x32_bf16 v[64:67], v[80:83], v[128:131], v[64:67]
    ds_read2_b32 v[148:149], v37 offset0:0 offset1:1
    v_mfma_f32_16x16x32_bf16 v[68:71], v[80:83], v[132:135], v[68:71]
    ds_read2_b32 v[150:151], v37 offset0:2 offset1:3
    v_mfma_f32_16x16x32_bf16 v[72:75], v[80:83], v[136:139], v[72:75]
    ds_read_b128 v[184:187], v44 offset:1024
    v_mfma_f32_16x16x32_bf16 v[76:79], v[80:83], v[140:143], v[76:79]
    ds_read2_b32 v[152:153], v38 offset0:0 offset1:1
    v_mfma_f32_16x16x32_bf16 v[52:55], v[84:87], v[112:115], v[52:55]
    ds_read2_b32 v[154:155], v38 offset0:2 offset1:3
    v_mfma_f32_16x16x32_bf16 v[56:59], v[84:87], v[116:119], v[56:59]
    ds_read_b128 v[188:191], v44 offset:1536
    v_mfma_f32_16x16x32_bf16 v[60:63], v[84:87], v[120:123], v[60:63]
    ds_read2_b32 v[156:157], v39 offset0:0 offset1:1
    v_mfma_f32_16x16x32_bf16 v[64:67], v[84:87], v[124:127], v[64:67]
    ds_read2_b32 v[158:159], v39 offset0:2 offset1:3
    v_mfma_f32_16x16x32_bf16 v[68:71], v[84:87], v[128:131], v[68:71]
    ds_read_b128 v[192:195], v44 offset:2048
    v_mfma_f32_16x16x32_bf16 v[72:75], v[84:87], v[132:135], v[72:75]
    ds_read2_b32 v[160:161], v40 offset0:0 offset1:1
    v_mfma_f32_16x16x32_bf16 v[76:79], v[84:87], v[136:139], v[76:79]
    ds_read2_b32 v[162:163], v40 offset0:2 offset1:3
    v_mfma_f32_16x16x32_bf16 v[56:59], v[88:91], v[112:115], v[56:59]
    ds_read_b128 v[196:199], v44 offset:2560
    v_mfma_f32_16x16x32_bf16 v[60:63], v[88:91], v[116:119], v[60:63]
    ds_read2_b32 v[164:165], v41 offset0:0 offset1:1
    v_mfma_f32_16x16x32_bf16 v[64:67], v[88:91], v[120:123], v[64:67]
    ds_read2_b32 v[166:167], v41 offset0:2 offset1:3
    v_mfma_f32_16x16x32_bf16 v[68:71], v[88:91], v[124:127], v[68:71]
    ds_read_b128 v[200:203], v44 offset:3072
    v_mfma_f32_16x16x32_bf16 v[72:75], v[88:91], v[128:131], v[72:75]
    ds_read2_b32 v[168:169], v42 offset0:0 offset1:1
    v_mfma_f32_16x16x32_bf16 v[76:79], v[88:91], v[132:135], v[76:79]
    ds_read2_b32 v[170:171], v42 offset0:2 offset1:3
    v_mfma_f32_16x16x32_bf16 v[60:63], v[92:95], v[112:115], v[60:63]
    ds_read_b128 v[204:207], v44 offset:3584
    v_mfma_f32_16x16x32_bf16 v[64:67], v[92:95], v[116:119], v[64:67]
    ds_read2_b32 v[172:173], v43 offset0:0 offset1:1
    v_mfma_f32_16x16x32_bf16 v[68:71], v[92:95], v[120:123], v[68:71]
    ds_read2_b32 v[174:175], v43 offset0:2 offset1:3
    v_mfma_f32_16x16x32_bf16 v[72:75], v[92:95], v[124:127], v[72:75]
    v_mfma_f32_16x16x32_bf16 v[76:79], v[92:95], v[128:131], v[76:79]
    v_mfma_f32_16x16x32_bf16 v[64:67], v[96:99], v[112:115], v[64:67]
    v_mfma_f32_16x16x32_bf16 v[68:71], v[96:99], v[116:119], v[68:71]
    v_mfma_f32_16x16x32_bf16 v[72:75], v[96:99], v[120:123], v[72:75]
    v_mfma_f32_16x16x32_bf16 v[76:79], v[96:99], v[124:127], v[76:79]
    v_mfma_f32_16x16x32_bf16 v[68:71], v[100:103], v[112:115], v[68:71]
    v_mfma_f32_16x16x32_bf16 v[72:75], v[100:103], v[116:119], v[72:75]
    v_mfma_f32_16x16x32_bf16 v[76:79], v[100:103], v[120:123], v[76:79]
    v_mfma_f32_16x16x32_bf16 v[72:75], v[104:107], v[112:115], v[72:75]
    v_mfma_f32_16x16x32_bf16 v[76:79], v[104:107], v[116:119], v[76:79]
    v_mfma_f32_16x16x32_bf16 v[76:79], v[108:111], v[112:115], v[76:79]
    s_waitcnt lgkmcnt(0)
    v_mfma_f32_16x16x32_bf16 v[48:51], v[144:147], v[176:179], v[48:51]
    v_mfma_f32_16x16x32_bf16 v[52:55], v[144:147], v[180:183], v[52:55]
    v_mfma_f32_16x16x32_bf16 v[56:59], v[144:147], v[184:187], v[56:59]
    v_mfma_f32_16x16x32_bf16 v[60:63], v[144:147], v[188:191], v[60:63]
    v_mfma_f32_16x16x32_bf16 v[64:67], v[144:147], v[192:195], v[64:67]
    v_mfma_f32_16x16x32_bf16 v[68:71], v[144:147], v[196:199], v[68:71]
    v_mfma_f32_16x16x32_bf16 v[72:75], v[144:147], v[200:203], v[72:75]
    v_mfma_f32_16x16x32_bf16 v[76:79], v[144:147], v[204:207], v[76:79]
    v_mfma_f32_16x16x32_bf16 v[52:55], v[148:151], v[176:179], v[52:55]
    v_mfma_f32_16x16x32_bf16 v[56:59], v[148:151], v[180:183], v[56:59]
    v_mfma_f32_16x16x32_bf16 v[60:63], v[148:151], v[184:187], v[60:63]
    v_mfma_f32_16x16x32_bf16 v[64:67], v[148:151], v[188:191], v[64:67]
    v_mfma_f32_16x16x32_bf16 v[68:71], v[148:151], v[192:195], v[68:71]
    v_mfma_f32_16x16x32_bf16 v[72:75], v[148:151], v[196:199], v[72:75]
    v_mfma_f32_16x16x32_bf16 v[76:79], v[148:151], v[200:203], v[76:79]
    v_mfma_f32_16x16x32_bf16 v[56:59], v[152:155], v[176:179], v[56:59]
    v_mfma_f32_16x16x32_bf16 v[60:63], v[152:155], v[180:183], v[60:63]
    v_mfma_f32_16x16x32_bf16 v[64:67], v[152:155], v[184:187], v[64:67]
    v_mfma_f32_16x16x32_bf16 v[68:71], v[152:155], v[188:191], v[68:71]
    v_mfma_f32_16x16x32_bf16 v[72:75], v[152:155], v[192:195], v[72:75]
    v_mfma_f32_16x16x32_bf16 v[76:79], v[152:155], v[196:199], v[76:79]
    v_mfma_f32_16x16x32_bf16 v[60:63], v[156:159], v[176:179], v[60:63]
    v_mfma_f32_16x16x32_bf16 v[64:67], v[156:159], v[180:183], v[64:67]
    v_mfma_f32_16x16x32_bf16 v[68:71], v[156:159], v[184:187], v[68:71]
    v_mfma_f32_16x16x32_bf16 v[72:75], v[156:159], v[188:191], v[72:75]
    v_mfma_f32_16x16x32_bf16 v[76:79], v[156:159], v[192:195], v[76:79]
    v_mfma_f32_16x16x32_bf16 v[64:67], v[160:163], v[176:179], v[64:67]
    v_mfma_f32_16x16x32_bf16 v[68:71], v[160:163], v[180:183], v[68:71]
    v_mfma_f32_16x16x32_bf16 v[72:75], v[160:163], v[184:187], v[72:75]
    v_mfma_f32_16x16x32_bf16 v[76:79], v[160:163], v[188:191], v[76:79]
    v_mfma_f32_16x16x32_bf16 v[68:71], v[164:167], v[176:179], v[68:71]
    v_mfma_f32_16x16x32_bf16 v[72:75], v[164:167], v[180:183], v[72:75]
    v_mfma_f32_16x16x32_bf16 v[76:79], v[164:167], v[184:187], v[76:79]
    v_mfma_f32_16x16x32_bf16 v[72:75], v[168:171], v[176:179], v[72:75]
    v_mfma_f32_16x16x32_bf16 v[76:79], v[168:171], v[180:183], v[76:79]
    v_mfma_f32_16x16x32_bf16 v[76:79], v[172:175], v[176:179], v[76:79]
    s_nop 7
    v_lshlrev_b32 v5, 6, v2
    v_lshl_add_u32 v5, v3, 4, v5
    v_add_u32 v5, v5, v4
    ds_write_b128 v5, v[48:51] offset:7424
    ds_write_b128 v5, v[52:55] offset:8448
    ds_write_b128 v5, v[56:59] offset:9472
    ds_write_b128 v5, v[60:63] offset:10496
    ds_write_b128 v5, v[64:67] offset:11520
    ds_write_b128 v5, v[68:71] offset:12544
    ds_write_b128 v5, v[72:75] offset:13568
    ds_write_b128 v5, v[76:79] offset:14592
    v_mov_b64 v[8:9], v[16:17]
    v_mov_b64 v[10:11], v[18:19]
    v_mov_b64 v[12:13], v[20:21]
    v_mov_b64 v[14:15], v[22:23]
    v_mov_b32 v24, v25
    v_add_u32 v4, 65536, v4
    s_add_u32 s28, s28, 1
    s_cmp_lt_u32 s28, 2
    s_waitcnt lgkmcnt(0)
    s_cbranch_scc1 ss_pass
    s_mov_b32 s12, s74
    s_mov_b32 s13, s75
    s_mov_b32 s14, 1152
    s_mov_b32 s15, 0x20000
    s_lshl_b32 s23, s20, 1
    buffer_load_dwordx4 v[8:11], off, s[12:15], s23
    s_barrier
    v_lshlrev_b32 v5, 5, v0
    v_add_u32 v7, 65536, v5
    ds_read_b128 v[64:67], v5 offset:7424
    ds_read_b128 v[68:71], v5 offset:7440
    ds_read_b128 v[72:75], v5 offset:23808
    ds_read_b128 v[76:79], v5 offset:23824
    ds_read_b128 v[80:83], v5 offset:40192
    ds_read_b128 v[84:87], v5 offset:40208
    ds_read_b128 v[88:91], v5 offset:56576
    ds_read_b128 v[92:95], v5 offset:56592
    ds_read_b128 v[96:99], v7 offset:7424
    ds_read_b128 v[100:103], v7 offset:7440
    ds_read_b128 v[104:107], v7 offset:23808
    ds_read_b128 v[108:111], v7 offset:23824
    ds_read_b128 v[112:115], v7 offset:40192
    ds_read_b128 v[116:119], v7 offset:40208
    ds_read_b128 v[120:123], v7 offset:56576
    ds_read_b128 v[124:127], v7 offset:56592
    s_waitcnt vmcnt(0)
    v_lshlrev_b32 v12, 16, v8
    v_and_b32 v13, 0xffff0000, v8
    v_lshlrev_b32 v14, 16, v9
    v_and_b32 v15, 0xffff0000, v9
    v_lshlrev_b32 v16, 16, v10
    v_and_b32 v17, 0xffff0000, v10
    v_lshlrev_b32 v18, 16, v11
    v_and_b32 v19, 0xffff0000, v11
    v_mul_u32_u24 v5, 18432, v0
    s_lshl_b32 s22, s20, 1
    s_add_u32 s22, s22, 1152
    s_waitcnt lgkmcnt(0)
    v_lshlrev_b32 v6, 16, v208
    v_fmac_f32 v64, v6, v12
    v_and_b32 v6, 0xffff0000, v208
    v_fmac_f32 v72, v6, v13
    v_lshlrev_b32 v6, 16, v209
    v_fmac_f32 v80, v6, v14
    v_and_b32 v6, 0xffff0000, v209
    v_fmac_f32 v88, v6, v15
    v_lshlrev_b32 v6, 16, v210
    v_fmac_f32 v96, v6, v16
    v_and_b32 v6, 0xffff0000, v210
    v_fmac_f32 v104, v6, v17
    v_lshlrev_b32 v6, 16, v211
    v_fmac_f32 v112, v6, v18
    v_and_b32 v6, 0xffff0000, v211
    v_fmac_f32 v120, v6, v19
    v_cvt_pk_bf16_f32 v208, v64, v72
    v_cvt_pk_bf16_f32 v209, v80, v88
    v_cvt_pk_bf16_f32 v210, v96, v104
    v_cvt_pk_bf16_f32 v211, v112, v120
    s_add_u32 s23, s22, 0
    buffer_store_dwordx4 v[208:211], v5, s[16:19], s23 offen
    v_lshlrev_b32 v6, 16, v212
    v_fmac_f32 v65, v6, v12
    v_and_b32 v6, 0xffff0000, v212
    v_fmac_f32 v73, v6, v13
    v_lshlrev_b32 v6, 16, v213
    v_fmac_f32 v81, v6, v14
    v_and_b32 v6, 0xffff0000, v213
    v_fmac_f32 v89, v6, v15
    v_lshlrev_b32 v6, 16, v214
    v_fmac_f32 v97, v6, v16
    v_and_b32 v6, 0xffff0000, v214
    v_fmac_f32 v105, v6, v17
    v_lshlrev_b32 v6, 16, v215
    v_fmac_f32 v113, v6, v18
    v_and_b32 v6, 0xffff0000, v215
    v_fmac_f32 v121, v6, v19
    v_cvt_pk_bf16_f32 v212, v65, v73
    v_cvt_pk_bf16_f32 v213, v81, v89
    v_cvt_pk_bf16_f32 v214, v97, v105
    v_cvt_pk_bf16_f32 v215, v113, v121
    s_add_u32 s23, s22, 2304
    buffer_store_dwordx4 v[212:215], v5, s[16:19], s23 offen
    v_lshlrev_b32 v6, 16, v216
    v_fmac_f32 v66, v6, v12
    v_and_b32 v6, 0xffff0000, v216
    v_fmac_f32 v74, v6, v13
    v_lshlrev_b32 v6, 16, v217
    v_fmac_f32 v82, v6, v14
    v_and_b32 v6, 0xffff0000, v217
    v_fmac_f32 v90, v6, v15
    v_lshlrev_b32 v6, 16, v218
    v_fmac_f32 v98, v6, v16
    v_and_b32 v6, 0xffff0000, v218
    v_fmac_f32 v106, v6, v17
    v_lshlrev_b32 v6, 16, v219
    v_fmac_f32 v114, v6, v18
    v_and_b32 v6, 0xffff0000, v219
    v_fmac_f32 v122, v6, v19
    v_cvt_pk_bf16_f32 v216, v66, v74
    v_cvt_pk_bf16_f32 v217, v82, v90
    v_cvt_pk_bf16_f32 v218, v98, v106
    v_cvt_pk_bf16_f32 v219, v114, v122
    s_add_u32 s23, s22, 4608
    buffer_store_dwordx4 v[216:219], v5, s[16:19], s23 offen
    v_lshlrev_b32 v6, 16, v220
    v_fmac_f32 v67, v6, v12
    v_and_b32 v6, 0xffff0000, v220
    v_fmac_f32 v75, v6, v13
    v_lshlrev_b32 v6, 16, v221
    v_fmac_f32 v83, v6, v14
    v_and_b32 v6, 0xffff0000, v221
    v_fmac_f32 v91, v6, v15
    v_lshlrev_b32 v6, 16, v222
    v_fmac_f32 v99, v6, v16
    v_and_b32 v6, 0xffff0000, v222
    v_fmac_f32 v107, v6, v17
    v_lshlrev_b32 v6, 16, v223
    v_fmac_f32 v115, v6, v18
    v_and_b32 v6, 0xffff0000, v223
    v_fmac_f32 v123, v6, v19
    v_cvt_pk_bf16_f32 v220, v67, v75
    v_cvt_pk_bf16_f32 v221, v83, v91
    v_cvt_pk_bf16_f32 v222, v99, v107
    v_cvt_pk_bf16_f32 v223, v115, v123
    s_add_u32 s23, s22, 6912
    buffer_store_dwordx4 v[220:223], v5, s[16:19], s23 offen
    v_lshlrev_b32 v6, 16, v224
    v_fmac_f32 v68, v6, v12
    v_and_b32 v6, 0xffff0000, v224
    v_fmac_f32 v76, v6, v13
    v_lshlrev_b32 v6, 16, v225
    v_fmac_f32 v84, v6, v14
    v_and_b32 v6, 0xffff0000, v225
    v_fmac_f32 v92, v6, v15
    v_lshlrev_b32 v6, 16, v226
    v_fmac_f32 v100, v6, v16
    v_and_b32 v6, 0xffff0000, v226
    v_fmac_f32 v108, v6, v17
    v_lshlrev_b32 v6, 16, v227
    v_fmac_f32 v116, v6, v18
    v_and_b32 v6, 0xffff0000, v227
    v_fmac_f32 v124, v6, v19
    v_cvt_pk_bf16_f32 v224, v68, v76
    v_cvt_pk_bf16_f32 v225, v84, v92
    v_cvt_pk_bf16_f32 v226, v100, v108
    v_cvt_pk_bf16_f32 v227, v116, v124
    s_add_u32 s23, s22, 9216
    buffer_store_dwordx4 v[224:227], v5, s[16:19], s23 offen
    v_lshlrev_b32 v6, 16, v228
    v_fmac_f32 v69, v6, v12
    v_and_b32 v6, 0xffff0000, v228
    v_fmac_f32 v77, v6, v13
    v_lshlrev_b32 v6, 16, v229
    v_fmac_f32 v85, v6, v14
    v_and_b32 v6, 0xffff0000, v229
    v_fmac_f32 v93, v6, v15
    v_lshlrev_b32 v6, 16, v230
    v_fmac_f32 v101, v6, v16
    v_and_b32 v6, 0xffff0000, v230
    v_fmac_f32 v109, v6, v17
    v_lshlrev_b32 v6, 16, v231
    v_fmac_f32 v117, v6, v18
    v_and_b32 v6, 0xffff0000, v231
    v_fmac_f32 v125, v6, v19
    v_cvt_pk_bf16_f32 v228, v69, v77
    v_cvt_pk_bf16_f32 v229, v85, v93
    v_cvt_pk_bf16_f32 v230, v101, v109
    v_cvt_pk_bf16_f32 v231, v117, v125
    s_add_u32 s23, s22, 11520
    buffer_store_dwordx4 v[228:231], v5, s[16:19], s23 offen
    v_lshlrev_b32 v6, 16, v232
    v_fmac_f32 v70, v6, v12
    v_and_b32 v6, 0xffff0000, v232
    v_fmac_f32 v78, v6, v13
    v_lshlrev_b32 v6, 16, v233
    v_fmac_f32 v86, v6, v14
    v_and_b32 v6, 0xffff0000, v233
    v_fmac_f32 v94, v6, v15
    v_lshlrev_b32 v6, 16, v234
    v_fmac_f32 v102, v6, v16
    v_and_b32 v6, 0xffff0000, v234
    v_fmac_f32 v110, v6, v17
    v_lshlrev_b32 v6, 16, v235
    v_fmac_f32 v118, v6, v18
    v_and_b32 v6, 0xffff0000, v235
    v_fmac_f32 v126, v6, v19
    v_cvt_pk_bf16_f32 v232, v70, v78
    v_cvt_pk_bf16_f32 v233, v86, v94
    v_cvt_pk_bf16_f32 v234, v102, v110
    v_cvt_pk_bf16_f32 v235, v118, v126
    s_add_u32 s23, s22, 13824
    buffer_store_dwordx4 v[232:235], v5, s[16:19], s23 offen
    v_lshlrev_b32 v6, 16, v236
    v_fmac_f32 v71, v6, v12
    v_and_b32 v6, 0xffff0000, v236
    v_fmac_f32 v79, v6, v13
    v_lshlrev_b32 v6, 16, v237
    v_fmac_f32 v87, v6, v14
    v_and_b32 v6, 0xffff0000, v237
    v_fmac_f32 v95, v6, v15
    v_lshlrev_b32 v6, 16, v238
    v_fmac_f32 v103, v6, v16
    v_and_b32 v6, 0xffff0000, v238
    v_fmac_f32 v111, v6, v17
    v_lshlrev_b32 v6, 16, v239
    v_fmac_f32 v119, v6, v18
    v_and_b32 v6, 0xffff0000, v239
    v_fmac_f32 v127, v6, v19
    v_cvt_pk_bf16_f32 v236, v71, v79
    v_cvt_pk_bf16_f32 v237, v87, v95
    v_cvt_pk_bf16_f32 v238, v103, v111
    v_cvt_pk_bf16_f32 v239, v119, v127
    s_add_u32 s23, s22, 16128
    buffer_store_dwordx4 v[236:239], v5, s[16:19], s23 offen
    s_branch L_ssm_next
L_ssm_done:
    s_cmp_lt_u32 s93, 100
    s_cbranch_scc1 L_exit
    s_mov_b32 s8, s76
    s_mov_b32 s9, s77
    s_mov_b32 s10, 4718592
    s_mov_b32 s11, 0x20000
    s_cmp_le_u32 s45, 1
    s_cbranch_scc1 L_att_next
    s_branch L_op_nextcb
L_wf_next:
    s_mov_b32 s37, 20
    v_mov_b32 v250, 1
    v_mov_b32 v251, 163832
    v_cmp_eq_u32 vcc, 0, v0
    s_nop 0
    s_and_saveexec_b64 s[38:39], vcc
    s_cbranch_execz tk12
    buffer_atomic_add v250, off, s[84:87], s37 sc0
    s_waitcnt vmcnt(0)
    ds_write_b32 v251, v250
    s_waitcnt lgkmcnt(0)
tk12:
    s_mov_b64 exec, -1
    s_barrier
    ds_read_b32 v252, v251
    s_waitcnt lgkmcnt(0)
    v_readfirstlane_b32 s33, v252
    s_barrier
    s_nop 3
    s_cmp_ge_u32 s33, 160
    s_cbranch_scc1 L_ssm_next
    s_lshl_b32 s16, s33, 2
    s_add_u32 s16, s16, s32
    s_add_u32 s16, s16, 1504
    s_call_b64 s[46:47], L_xform
    s_lshl_b32 s40, s33, 2
    s_add_u32 s40, s40, 125841408
    s_waitcnt vmcnt(0)
    s_barrier
    v_mov_b32 v250, s95
    v_cmp_eq_u32 vcc, 0, v0
    s_nop 0
    s_and_saveexec_b64 s[38:39], vcc
    s_cbranch_execz fs13
    buffer_store_dword v250, off, s[4:7], s40 sc1
fs13:
    s_mov_b64 exec, -1
    s_branch L_wf_next
L_phase2:
    s_mov_b32 s40, 524288
mc2_w:
    buffer_load_dword v250, off, s[84:87], 0 offset:28 sc1
    s_waitcnt vmcnt(0)
    v_readfirstlane_b32 s41, v250
    s_nop 0
    s_cmp_lg_u32 s41, 0
    s_cbranch_scc1 mc2_known
    s_sub_u32 s40, s40, 1
    s_cbranch_scc1 mc2_force
    s_sleep 2
    s_branch mc2_w
mc2_force:
    v_mov_b32 v250, 2
    v_mov_b32 v251, 0
    s_mov_b64 exec, 1
    buffer_atomic_cmpswap v[250:251], off, s[84:87], 0 offset:28
    s_mov_b64 exec, -1
    s_waitcnt vmcnt(0)
    s_mov_b32 s40, 524288
    s_branch mc2_w
mc2_known:
    s_cmp_eq_u32 s41, 1
    s_cbranch_scc1 L_phase2b
    s_mov_b32 s37, 208
    v_mov_b32 v250, 1
    v_mov_b32 v251, 163832
    v_cmp_eq_u32 vcc, 0, v0
    s_nop 0
    s_and_saveexec_b64 s[38:39], vcc
    s_cbranch_execz tk14
    buffer_atomic_add v250, off, s[84:87], s37 sc0
    s_waitcnt vmcnt(0)
    ds_write_b32 v251, v250
    s_waitcnt lgkmcnt(0)
tk14:
    s_mov_b64 exec, -1
    s_barrier
    ds_read_b32 v252, v251
    s_waitcnt lgkmcnt(0)
    v_readfirstlane_b32 s12, v252
    s_barrier
    s_nop 3
    s_cmp_lt_u32 s12, 32
    s_cbranch_scc1 L_chain_safe
    s_sub_u32 s45, s12, 32
L_phase2b:
    s_mov_b32 s8, s76
    s_mov_b32 s9, s77
    s_mov_b32 s10, 4718592
    s_mov_b32 s11, 0x20000
    s_and_b32 s36, s45, 15
    s_bitcmp1_b32 42315, s36
    s_cbranch_scc0 L_nots
    s_cmp_eq_u32 s93, 500
    s_cbranch_scc1 L_ssm_next
    s_branch L_wf_next
L_nots:
    s_bitcmp1_b32 18576, s36
    s_cbranch_scc0 L_att_next
    s_bfm_b32 s37, s36, 0
    s_and_b32 s37, s37, 18576
    s_bcnt1_i32_b32 s37, s37
    s_lshr_b32 s40, s45, 4
    s_mul_i32 s40, s40, 4
    s_add_u32 s33, s40, s37
L_op_mod:
    s_mul_hi_u32 s41, s33, 0x0e38e38f
    s_mul_i32 s41, s41, 18
    s_sub_u32 s33, s33, s41
    s_branch L_op_start
L_att_next:
    s_mov_b32 s37, 16
    v_mov_b32 v250, 1
    v_mov_b32 v251, 163832
    v_cmp_eq_u32 vcc, 0, v0
    s_nop 0
    s_and_saveexec_b64 s[38:39], vcc
    s_cbranch_execz tk15
    buffer_atomic_add v250, off, s[84:87], s37 sc0
    s_waitcnt vmcnt(0)
    ds_write_b32 v251, v250
    s_waitcnt lgkmcnt(0)
tk15:
    s_mov_b64 exec, -1
    s_barrier
    ds_read_b32 v252, v251
    s_waitcnt lgkmcnt(0)
    v_readfirstlane_b32 s34, v252
    s_barrier
    s_nop 3
    s_cmp_ge_u32 s34, 512
    s_cbranch_scc1 L_op_nextcb
    s_lshr_b32 s16, s34, 3
    s_and_b32 s17, s34, 7
    s_lshl_b32 s17, s17, 2
    s_add_u32 s17, s17, s32
    s_lshl_b32 s36, s17, 7
    s_add_u32 s36, s36, 125829120
    s_lshr_b32 s41, s16, 2
    s_add_u32 s41, s41, s95
    s_add_u32 s41, s41, 1
    v_and_b32 v1, 3, v0
    v_min_u32 v1, 2, v1
    v_lshlrev_b32 v2, 4, v1
    s_and_b32 s37, s16, 3
    s_lshl_b32 s37, s37, 2
    v_add_u32 v2, s37, v2
    s_mov_b32 s40, 4194304
L_aw1:
    buffer_load_dword v3, v2, s[4:7], s36 offen sc1
    s_sub_u32 s40, s40, 1
    s_cbranch_scc1 L_aw1_go
    s_waitcnt vmcnt(0)
    v_subrev_u32 v3, s41, v3
    v_cmp_lt_u32 vcc, 64, v3
    s_cbranch_vccz L_aw1_go
    s_sleep 4
    s_branch L_aw1
L_aw1_go:
    v_and_b32 v5, 63, v0
    v_lshlrev_b32 v1, 4, v5
    s_cmp_ge_u32 s16, 56
    s_cselect_b32 s18, -1, 511
    v_and_b32 v2, s18, v1
    v_or_b32 v3, 128, v1
    v_lshrrev_b32 v4, 4, v5
    v_bfe_u32 v6, v5, 2, 2
    v_sub_u32 v4, v6, v4
    v_lshlrev_b32 v4, 3, v4
    v_and_b32 v6, 3, v5
    v_add_u32 v4, v4, v6
    v_mov_b32 v6, 0xf149f2ca
    s_mov_b32 s22, 0x3e0293ee
    s_lshl_b32 s18, s16, 5
    s_add_u32 s18, s18, s17
    s_lshl_b32 s19, s18, 13
    s_add_u32 s20, s19, 33554432
    buffer_load_dwordx4 v[8:11], v1, s[4:7], s20 offen offset:0 sc1
    s_add_u32 s20, s19, 33554432
    buffer_load_dwordx4 v[12:15], v1, s[4:7], s20 offen offset:1024 sc1
    s_add_u32 s20, s19, 33554432
    buffer_load_dwordx4 v[16:19], v1, s[4:7], s20 offen offset:2048 sc1
    s_add_u32 s20, s19, 33554432
    buffer_load_dwordx4 v[20:23], v1, s[4:7], s20 offen offset:3072 sc1
    s_add_u32 s20, s19, 33558528
    buffer_load_dwordx4 v[24:27], v1, s[4:7], s20 offen offset:0 sc1
    s_add_u32 s20, s19, 33558528
    buffer_load_dwordx4 v[28:31], v1, s[4:7], s20 offen offset:1024 sc1
    s_add_u32 s20, s19, 33558528
    buffer_load_dwordx4 v[32:35], v1, s[4:7], s20 offen offset:2048 sc1
    s_add_u32 s20, s19, 33558528
    buffer_load_dwordx4 v[36:39], v1, s[4:7], s20 offen offset:3072 sc1
    s_lshl_b32 s21, s18, 14
    s_add_u32 s20, s21, 0
    buffer_load_dwordx4 v[40:43], v1, s[4:7], s20 offen offset:0 sc1
    s_add_u32 s20, s21, 4096
    buffer_load_dwordx4 v[44:47], v1, s[4:7], s20 offen offset:0 sc1
    s_add_u32 s20, s21, 8192
    buffer_load_dwordx4 v[48:51], v1, s[4:7], s20 offen offset:0 sc1
    s_add_u32 s20, s21, 12288
    buffer_load_dwordx4 v[52:55], v1, s[4:7], s20 offen offset:0 sc1
    s_add_u32 s20, s21, 0
    buffer_load_dwordx4 v[56:59], v1, s[4:7], s20 offen offset:1024 sc1
    s_add_u32 s20, s21, 4096
    buffer_load_dwordx4 v[60:63], v1, s[4:7], s20 offen offset:1024 sc1
    s_add_u32 s20, s21, 8192
    buffer_load_dwordx4 v[64:67], v1, s[4:7], s20 offen offset:1024 sc1
    s_add_u32 s20, s21, 12288
    buffer_load_dwordx4 v[68:71], v1, s[4:7], s20 offen offset:1024 sc1
    s_add_u32 s20, s21, 0
    buffer_load_dwordx4 v[88:91], v1, s[4:7], s20 offen offset:2048 sc1
    s_add_u32 s20, s21, 4096
    buffer_load_dwordx4 v[92:95], v1, s[4:7], s20 offen offset:2048 sc1
    s_add_u32 s20, s21, 8192
    buffer_load_dwordx4 v[96:99], v1, s[4:7], s20 offen offset:2048 sc1
    s_add_u32 s20, s21, 12288
    buffer_load_dwordx4 v[100:103], v1, s[4:7], s20 offen offset:2048 sc1
    s_add_u32 s20, s21, 0
    buffer_load_dwordx4 v[104:107], v1, s[4:7], s20 offen offset:3072 sc1
    s_add_u32 s20, s21, 4096
    buffer_load_dwordx4 v[108:111], v1, s[4:7], s20 offen offset:3072 sc1
    s_add_u32 s20, s21, 8192
    buffer_load_dwordx4 v[112:115], v1, s[4:7], s20 offen offset:3072 sc1
    s_add_u32 s20, s21, 12288
    buffer_load_dwordx4 v[116:119], v1, s[4:7], s20 offen offset:3072 sc1
    v_mov_b32 v172, 0x3f803f80
    v_mov_b32 v173, 0x3f803f80
    v_mov_b32 v174, 0x3f803f80
    v_mov_b32 v175, 0x3f803f80
    v_mov_b32 v176, 0x3f003f00
    v_mov_b32 v177, 0x3f003f00
    s_waitcnt vmcnt(8)
    v_mfma_f32_16x16x32_bf16 v[136:139], v[40:43], v[8:11], 0
    v_mfma_f32_16x16x32_bf16 v[140:143], v[56:59], v[8:11], 0
    v_mfma_f32_16x16x32_bf16 v[148:151], v[40:43], v[24:27], 0
    v_mfma_f32_16x16x32_bf16 v[152:155], v[56:59], v[24:27], 0
    v_mfma_f32_16x16x32_bf16 v[136:139], v[44:47], v[12:15], v[136:139]
    v_mfma_f32_16x16x32_bf16 v[140:143], v[60:63], v[12:15], v[140:143]
    v_mfma_f32_16x16x32_bf16 v[148:151], v[44:47], v[28:31], v[148:151]
    v_mfma_f32_16x16x32_bf16 v[152:155], v[60:63], v[28:31], v[152:155]
    v_mfma_f32_16x16x32_bf16 v[136:139], v[48:51], v[16:19], v[136:139]
    v_mfma_f32_16x16x32_bf16 v[140:143], v[64:67], v[16:19], v[140:143]
    v_mfma_f32_16x16x32_bf16 v[148:151], v[48:51], v[32:35], v[148:151]
    v_mfma_f32_16x16x32_bf16 v[152:155], v[64:67], v[32:35], v[152:155]
    v_mfma_f32_16x16x32_bf16 v[136:139], v[52:55], v[20:23], v[136:139]
    v_mfma_f32_16x16x32_bf16 v[140:143], v[68:71], v[20:23], v[140:143]
    v_mfma_f32_16x16x32_bf16 v[148:151], v[52:55], v[36:39], v[148:151]
    v_mfma_f32_16x16x32_bf16 v[152:155], v[68:71], v[36:39], v[152:155]
    v_cmp_le_i32 vcc, 0, v4
    s_nop 3
    v_cndmask_b32 v136, v6, v136, vcc
    v_cmp_le_i32 vcc, 1, v4
    s_nop 1
    v_cndmask_b32 v137, v6, v137, vcc
    v_cmp_le_i32 vcc, 2, v4
    s_nop 1
    v_cndmask_b32 v138, v6, v138, vcc
    v_cmp_le_i32 vcc, 3, v4
    s_nop 1
    v_cndmask_b32 v139, v6, v139, vcc
    v_cmp_le_i32 vcc, 4, v4
    s_nop 1
    v_cndmask_b32 v140, v6, v140, vcc
    v_cmp_le_i32 vcc, 5, v4
    s_nop 1
    v_cndmask_b32 v141, v6, v141, vcc
    v_cmp_le_i32 vcc, 6, v4
    s_nop 1
    v_cndmask_b32 v142, v6, v142, vcc
    v_cmp_le_i32 vcc, 7, v4
    s_nop 1
    v_cndmask_b32 v143, v6, v143, vcc
    v_cmp_le_i32 vcc, -4, v4
    s_nop 1
    v_cndmask_b32 v148, v6, v148, vcc
    v_cmp_le_i32 vcc, -3, v4
    s_nop 1
    v_cndmask_b32 v149, v6, v149, vcc
    v_cmp_le_i32 vcc, -2, v4
    s_nop 1
    v_cndmask_b32 v150, v6, v150, vcc
    v_cmp_le_i32 vcc, -1, v4
    s_nop 1
    v_cndmask_b32 v151, v6, v151, vcc
    v_cmp_le_i32 vcc, 0, v4
    s_nop 1
    v_cndmask_b32 v152, v6, v152, vcc
    v_cmp_le_i32 vcc, 1, v4
    s_nop 1
    v_cndmask_b32 v153, v6, v153, vcc
    v_cmp_le_i32 vcc, 2, v4
    s_nop 1
    v_cndmask_b32 v154, v6, v154, vcc
    v_cmp_le_i32 vcc, 3, v4
    s_nop 1
    v_cndmask_b32 v155, v6, v155, vcc
    s_nop 1
    v_and_b32 v198, 1, v0
    v_lshlrev_b32 v198, 2, v198
    v_add_u32 v198, 48, v198
    s_add_u32 s41, s16, s95
    s_add_u32 s41, s41, 1
    s_cmp_lt_u32 s16, 56
    s_cbranch_scc1 L_amk
    v_mov_b32 v198, 16384
L_amk:
    s_nop 1
    s_mov_b32 s88, 65536
    s_mov_b32 s89, 125853696
cw16:
    buffer_load_dword v199, off, s[4:7], s89 sc1
    s_waitcnt vmcnt(0)
    v_readfirstlane_b32 s42, v199
    s_nop 0
    s_sub_u32 s42, s42, s95
    s_cmp_gt_u32 s42, 64
    s_cselect_b32 s42, 0, s42
    s_add_u32 s42, s42, 1
    s_cmp_ge_u32 s42, s16
    s_cbranch_scc1 cw16x
    s_sub_u32 s88, s88, 1
    s_cbranch_scc1 cw16x
    s_sub_u32 s42, s16, s42
    s_min_u32 s42, s42, 6
cw16s:
    s_sleep 24
    s_sub_u32 s42, s42, 1
    s_cmp_lg_u32 s42, 0
    s_cbranch_scc1 cw16s
    s_branch cw16
cw16x:
    s_mov_b32 s40, 4194304
L_aw2:
    buffer_load_dword v199, v198, s[4:7], s36 offen sc1
    s_sub_u32 s40, s40, 1
    s_cbranch_scc1 L_aw2_go
    s_waitcnt vmcnt(0)
    v_subrev_u32 v199, s41, v199
    v_cmp_lt_u32 vcc, 64, v199
    s_cbranch_vccz L_aw2_go
    s_sleep 1
    s_branch L_aw2
L_aw2_go:
    s_lshl_b32 s20, s18, 12
    s_add_u32 s20, s20, 69206016
    buffer_load_dwordx4 v[72:75], v3, s[4:7], s20 offen offset:0 sc1
    buffer_load_dwordx4 v[76:79], v3, s[4:7], s20 offen offset:1024 sc1
    buffer_load_dwordx4 v[80:83], v3, s[4:7], s20 offen offset:2048 sc1
    buffer_load_dwordx4 v[84:87], v3, s[4:7], s20 offen offset:3072 sc1
    s_lshl_b32 s20, s18, 12
    s_add_u32 s20, s20, 77594624
    buffer_load_dwordx4 v[120:123], v2, s[4:7], s20 offen offset:0 sc1
    buffer_load_dwordx4 v[124:127], v2, s[4:7], s20 offen offset:1024 sc1
    buffer_load_dwordx4 v[128:131], v2, s[4:7], s20 offen offset:2048 sc1
    buffer_load_dwordx4 v[132:135], v2, s[4:7], s20 offen offset:3072 sc1
    s_waitcnt vmcnt(4)
    v_mfma_f32_16x16x32_bf16 v[144:147], v[72:75], v[8:11], 0
    v_mfma_f32_16x16x32_bf16 v[156:159], v[72:75], v[24:27], 0
    v_mfma_f32_16x16x32_bf16 v[144:147], v[76:79], v[12:15], v[144:147]
    v_mfma_f32_16x16x32_bf16 v[156:159], v[76:79], v[28:31], v[156:159]
    v_mfma_f32_16x16x32_bf16 v[144:147], v[80:83], v[16:19], v[144:147]
    v_mfma_f32_16x16x32_bf16 v[156:159], v[80:83], v[32:35], v[156:159]
    v_mfma_f32_16x16x32_bf16 v[144:147], v[84:87], v[20:23], v[144:147]
    v_mfma_f32_16x16x32_bf16 v[156:159], v[84:87], v[36:39], v[156:159]
    v_max3_f32 v196, v136, v137, v138
    v_max3_f32 v197, v139, v140, v141
    v_max3_f32 v196, v196, v142, v143
    s_nop 3
    v_max3_f32 v197, v197, v144, v145
    v_max3_f32 v196, v196, v146, v147
    v_max_f32 v196, v196, v197
    v_mov_b32 v197, v196
    s_nop 1
    v_permlane32_swap_b32 v196, v197
    v_max_f32 v196, v196, v197
    v_mov_b32 v197, v196
    s_nop 1
    v_permlane16_swap_b32 v196, v197
    v_max_f32 v196, v196, v197
    v_mul_f32 v196, s22, v196
    v_sub_f32 v196, 0, v196
    v_fma_f32 v136, v136, s22, v196
    v_fma_f32 v137, v137, s22, v196
    v_fma_f32 v138, v138, s22, v196
    v_fma_f32 v139, v139, s22, v196
    v_fma_f32 v140, v140, s22, v196
    v_fma_f32 v141, v141, s22, v196
    v_fma_f32 v142, v142, s22, v196
    v_fma_f32 v143, v143, s22, v196
    v_fma_f32 v144, v144, s22, v196
    v_fma_f32 v145, v145, s22, v196
    v_fma_f32 v146, v146, s22, v196
    v_fma_f32 v147, v147, s22, v196
    v_exp_f32 v136, v136
    v_exp_f32 v137, v137
    v_exp_f32 v138, v138
    v_exp_f32 v139, v139
    v_exp_f32 v140, v140
    v_exp_f32 v141, v141
    v_exp_f32 v142, v142
    v_exp_f32 v143, v143
    v_exp_f32 v144, v144
    v_exp_f32 v145, v145
    v_exp_f32 v146, v146
    v_exp_f32 v147, v147
    v_cvt_pk_bf16_f32 v160, v136, v137
    v_cvt_pk_bf16_f32 v161, v138, v139
    v_cvt_pk_bf16_f32 v162, v140, v141
    v_cvt_pk_bf16_f32 v163, v142, v143
    v_cvt_pk_bf16_f32 v164, v144, v145
    v_cvt_pk_bf16_f32 v165, v146, v147
    v_max3_f32 v196, v148, v149, v150
    v_max3_f32 v197, v151, v152, v153
    v_max3_f32 v196, v196, v154, v155
    v_max3_f32 v197, v197, v156, v157
    v_max3_f32 v196, v196, v158, v159
    v_max_f32 v196, v196, v197
    v_mov_b32 v197, v196
    s_nop 1
    v_permlane32_swap_b32 v196, v197
    v_max_f32 v196, v196, v197
    v_mov_b32 v197, v196
    s_nop 1
    v_permlane16_swap_b32 v196, v197
    v_max_f32 v196, v196, v197
    v_mul_f32 v196, s22, v196
    v_sub_f32 v196, 0, v196
    v_fma_f32 v148, v148, s22, v196
    v_fma_f32 v149, v149, s22, v196
    v_fma_f32 v150, v150, s22, v196
    v_fma_f32 v151, v151, s22, v196
    v_fma_f32 v152, v152, s22, v196
    v_fma_f32 v153, v153, s22, v196
    v_fma_f32 v154, v154, s22, v196
    v_fma_f32 v155, v155, s22, v196
    v_fma_f32 v156, v156, s22, v196
    v_fma_f32 v157, v157, s22, v196
    v_fma_f32 v158, v158, s22, v196
    v_fma_f32 v159, v159, s22, v196
    v_exp_f32 v148, v148
    v_exp_f32 v149, v149
    v_exp_f32 v150, v150
    v_exp_f32 v151, v151
    v_exp_f32 v152, v152
    v_exp_f32 v153, v153
    v_exp_f32 v154, v154
    v_exp_f32 v155, v155
    v_exp_f32 v156, v156
    v_exp_f32 v157, v157
    v_exp_f32 v158, v158
    v_exp_f32 v159, v159
    v_cvt_pk_bf16_f32 v166, v148, v149
    v_cvt_pk_bf16_f32 v167, v150, v151
    v_cvt_pk_bf16_f32 v168, v152, v153
    v_cvt_pk_bf16_f32 v169, v154, v155
    v_cvt_pk_bf16_f32 v170, v156, v157
    v_cvt_pk_bf16_f32 v171, v158, v159
    v_mfma_f32_16x16x32_bf16 v[180:183], v[172:175], v[160:163], 0
    v_mfma_f32_16x16x32_bf16 v[184:187], v[172:175], v[166:169], 0
    s_nop 4
    v_mfma_f32_16x16x16_bf16 v[180:183], v[176:177], v[164:165], v[180:183]
    v_mfma_f32_16x16x16_bf16 v[184:187], v[176:177], v[170:171], v[184:187]
    s_nop 6
    v_rcp_f32 v180, v180
    v_rcp_f32 v184, v184
    s_waitcnt vmcnt(0)
    s_lshl_b32 s18, s16, 18
    s_lshl_b32 s19, s17, 12
    s_add_u32 s18, s18, s19
    s_add_u32 s18, s18, 50331648
    s_add_u32 s19, s18, 131072
    v_mfma_f32_16x16x32_bf16 v[8:11], v[88:91], v[160:163], 0
    v_mfma_f32_16x16x32_bf16 v[12:15], v[104:107], v[160:163], 0
    v_mfma_f32_16x16x32_bf16 v[16:19], v[88:91], v[166:169], 0
    v_mfma_f32_16x16x32_bf16 v[20:23], v[104:107], v[166:169], 0
    v_mfma_f32_16x16x32_bf16 v[24:27], v[92:95], v[160:163], 0
    v_mfma_f32_16x16x32_bf16 v[28:31], v[108:111], v[160:163], 0
    v_mfma_f32_16x16x32_bf16 v[32:35], v[92:95], v[166:169], 0
    v_mfma_f32_16x16x32_bf16 v[36:39], v[108:111], v[166:169], 0
    v_mfma_f32_16x16x32_bf16 v[40:43], v[96:99], v[160:163], 0
    v_mfma_f32_16x16x32_bf16 v[44:47], v[112:115], v[160:163], 0
    v_mfma_f32_16x16x32_bf16 v[48:51], v[96:99], v[166:169], 0
    v_mfma_f32_16x16x32_bf16 v[52:55], v[112:115], v[166:169], 0
    v_mfma_f32_16x16x32_bf16 v[56:59], v[100:103], v[160:163], 0
    v_mfma_f32_16x16x32_bf16 v[60:63], v[116:119], v[160:163], 0
    v_mfma_f32_16x16x32_bf16 v[64:67], v[100:103], v[166:169], 0
    v_mfma_f32_16x16x32_bf16 v[68:71], v[116:119], v[166:169], 0
    v_mfma_f32_16x16x16_bf16 v[8:11], v[120:121], v[164:165], v[8:11]
    v_mfma_f32_16x16x16_bf16 v[12:15], v[122:123], v[164:165], v[12:15]
    v_mfma_f32_16x16x16_bf16 v[16:19], v[120:121], v[170:171], v[16:19]
    v_mfma_f32_16x16x16_bf16 v[20:23], v[122:123], v[170:171], v[20:23]
    v_mfma_f32_16x16x16_bf16 v[24:27], v[124:125], v[164:165], v[24:27]
    v_mfma_f32_16x16x16_bf16 v[28:31], v[126:127], v[164:165], v[28:31]
    v_mfma_f32_16x16x16_bf16 v[32:35], v[124:125], v[170:171], v[32:35]
    v_mfma_f32_16x16x16_bf16 v[36:39], v[126:127], v[170:171], v[36:39]
    v_mfma_f32_16x16x16_bf16 v[40:43], v[128:129], v[164:165], v[40:43]
    v_mfma_f32_16x16x16_bf16 v[44:47], v[130:131], v[164:165], v[44:47]
    v_mfma_f32_16x16x16_bf16 v[48:51], v[128:129], v[170:171], v[48:51]
    v_mfma_f32_16x16x16_bf16 v[52:55], v[130:131], v[170:171], v[52:55]
    v_mfma_f32_16x16x16_bf16 v[56:59], v[132:133], v[164:165], v[56:59]
    v_mfma_f32_16x16x16_bf16 v[60:63], v[134:135], v[164:165], v[60:63]
    v_mfma_f32_16x16x16_bf16 v[64:67], v[132:133], v[170:171], v[64:67]
    v_mfma_f32_16x16x16_bf16 v[68:71], v[134:135], v[170:171], v[68:71]
    v_mul_f32 v8, v8, v180
    v_mul_f32 v12, v12, v180
    v_mul_f32 v9, v9, v180
    v_mul_f32 v13, v13, v180
    v_mul_f32 v10, v10, v180
    v_mul_f32 v14, v14, v180
    v_mul_f32 v11, v11, v180
    v_mul_f32 v15, v15, v180
    v_cvt_pk_bf16_f32 v8, v8, v9
    v_cvt_pk_bf16_f32 v9, v10, v11
    v_cvt_pk_bf16_f32 v10, v12, v13
    v_cvt_pk_bf16_f32 v11, v14, v15
    buffer_store_dwordx4 v[8:11], v1, s[4:7], s18 offen offset:0 sc1
    v_mul_f32 v16, v16, v184
    v_mul_f32 v20, v20, v184
    v_mul_f32 v17, v17, v184
    v_mul_f32 v21, v21, v184
    v_mul_f32 v18, v18, v184
    v_mul_f32 v22, v22, v184
    v_mul_f32 v19, v19, v184
    v_mul_f32 v23, v23, v184
    v_cvt_pk_bf16_f32 v16, v16, v17
    v_cvt_pk_bf16_f32 v17, v18, v19
    v_cvt_pk_bf16_f32 v18, v20, v21
    v_cvt_pk_bf16_f32 v19, v22, v23
    buffer_store_dwordx4 v[16:19], v1, s[4:7], s19 offen offset:0 sc1
    v_mul_f32 v24, v24, v180
    v_mul_f32 v28, v28, v180
    v_mul_f32 v25, v25, v180
    v_mul_f32 v29, v29, v180
    v_mul_f32 v26, v26, v180
    v_mul_f32 v30, v30, v180
    v_mul_f32 v27, v27, v180
    v_mul_f32 v31, v31, v180
    v_cvt_pk_bf16_f32 v24, v24, v25
    v_cvt_pk_bf16_f32 v25, v26, v27
    v_cvt_pk_bf16_f32 v26, v28, v29
    v_cvt_pk_bf16_f32 v27, v30, v31
    buffer_store_dwordx4 v[24:27], v1, s[4:7], s18 offen offset:1024 sc1
    v_mul_f32 v32, v32, v184
    v_mul_f32 v36, v36, v184
    v_mul_f32 v33, v33, v184
    v_mul_f32 v37, v37, v184
    v_mul_f32 v34, v34, v184
    v_mul_f32 v38, v38, v184
    v_mul_f32 v35, v35, v184
    v_mul_f32 v39, v39, v184
    v_cvt_pk_bf16_f32 v32, v32, v33
    v_cvt_pk_bf16_f32 v33, v34, v35
    v_cvt_pk_bf16_f32 v34, v36, v37
    v_cvt_pk_bf16_f32 v35, v38, v39
    buffer_store_dwordx4 v[32:35], v1, s[4:7], s19 offen offset:1024 sc1
    v_mul_f32 v40, v40, v180
    v_mul_f32 v44, v44, v180
    v_mul_f32 v41, v41, v180
    v_mul_f32 v45, v45, v180
    v_mul_f32 v42, v42, v180
    v_mul_f32 v46, v46, v180
    v_mul_f32 v43, v43, v180
    v_mul_f32 v47, v47, v180
    v_cvt_pk_bf16_f32 v40, v40, v41
    v_cvt_pk_bf16_f32 v41, v42, v43
    v_cvt_pk_bf16_f32 v42, v44, v45
    v_cvt_pk_bf16_f32 v43, v46, v47
    buffer_store_dwordx4 v[40:43], v1, s[4:7], s18 offen offset:2048 sc1
    v_mul_f32 v48, v48, v184
    v_mul_f32 v52, v52, v184
    v_mul_f32 v49, v49, v184
    v_mul_f32 v53, v53, v184
    v_mul_f32 v50, v50, v184
    v_mul_f32 v54, v54, v184
    v_mul_f32 v51, v51, v184
    v_mul_f32 v55, v55, v184
    v_cvt_pk_bf16_f32 v48, v48, v49
    v_cvt_pk_bf16_f32 v49, v50, v51
    v_cvt_pk_bf16_f32 v50, v52, v53
    v_cvt_pk_bf16_f32 v51, v54, v55
    buffer_store_dwordx4 v[48:51], v1, s[4:7], s19 offen offset:2048 sc1
    v_mul_f32 v56, v56, v180
    v_mul_f32 v60, v60, v180
    v_mul_f32 v57, v57, v180
    v_mul_f32 v61, v61, v180
    v_mul_f32 v58, v58, v180
    v_mul_f32 v62, v62, v180
    v_mul_f32 v59, v59, v180
    v_mul_f32 v63, v63, v180
    v_cvt_pk_bf16_f32 v56, v56, v57
    v_cvt_pk_bf16_f32 v57, v58, v59
    v_cvt_pk_bf16_f32 v58, v60, v61
    v_cvt_pk_bf16_f32 v59, v62, v63
    buffer_store_dwordx4 v[56:59], v1, s[4:7], s18 offen offset:3072 sc1
    v_mul_f32 v64, v64, v184
    v_mul_f32 v68, v68, v184
    v_mul_f32 v65, v65, v184
    v_mul_f32 v69, v69, v184
    v_mul_f32 v66, v66, v184
    v_mul_f32 v70, v70, v184
    v_mul_f32 v67, v67, v184
    v_mul_f32 v71, v71, v184
    v_cvt_pk_bf16_f32 v64, v64, v65
    v_cvt_pk_bf16_f32 v65, v66, v67
    v_cvt_pk_bf16_f32 v66, v68, v69
    v_cvt_pk_bf16_f32 v67, v70, v71
    buffer_store_dwordx4 v[64:67], v1, s[4:7], s19 offen offset:3072 sc1
    s_lshr_b32 s40, s34, 1
    s_lshl_b32 s40, s40, 7
    s_and_b32 s41, s34, 1
    s_lshl_b32 s41, s41, 2
    s_add_u32 s40, s40, s41
    s_add_u32 s40, s40, 125894656
    s_waitcnt vmcnt(0)
    s_barrier
    v_mov_b32 v250, s95
    v_cmp_eq_u32 vcc, 0, v0
    s_nop 0
    s_and_saveexec_b64 s[38:39], vcc
    s_cbranch_execz fs17
    buffer_store_dword v250, off, s[4:7], s40 sc1
fs17:
    s_mov_b64 exec, -1
    s_branch L_att_next
L_op_start:
    s_lshl_b32 s35, s33, 2
    s_add_u32 s35, s35, 136
    s_lshr_b32 s89, s33, 2
    s_lshl_b32 s89, s89, 7
    s_add_u32 s89, s89, 125841408
    v_mbcnt_lo_u32_b32 v2, -1, 0
    v_mbcnt_hi_u32_b32 v2, -1, v2
    v_min_u32 v2, 31, v2
    v_lshlrev_b32 v2, 2, v2
    s_mov_b32 s88, 4194304
fw18:
    buffer_load_dword v3, v2, s[4:7], s89 offen offset:0 sc1
    s_sub_u32 s88, s88, 1
    s_cbranch_scc1 fw18x
    s_waitcnt vmcnt(0)
    v_cmp_ne_u32 vcc, s95, v3
    s_cbranch_vccz fw18x
    s_sleep 4
    s_branch fw18
fw18x:
    v_and_b32 v1, 63, v0
    v_lshlrev_b32 v1, 4, v1
    s_lshl_b32 s18, s33, 18
    s_lshl_b32 s19, s32, 16
    s_add_u32 s18, s18, s19
    s_add_u32 s18, s18, 130023424
    buffer_load_dwordx4 a[0:3], v1, s[4:7], s18 offen offset:0 sc1
    buffer_load_dwordx4 a[4:7], v1, s[4:7], s18 offen offset:1024 sc1
    buffer_load_dwordx4 a[8:11], v1, s[4:7], s18 offen offset:2048 sc1
    buffer_load_dwordx4 a[12:15], v1, s[4:7], s18 offen offset:3072 sc1
    s_add_u32 s18, s18, 4096
    buffer_load_dwordx4 a[16:19], v1, s[4:7], s18 offen offset:0 sc1
    buffer_load_dwordx4 a[20:23], v1, s[4:7], s18 offen offset:1024 sc1
    buffer_load_dwordx4 a[24:27], v1, s[4:7], s18 offen offset:2048 sc1
    buffer_load_dwordx4 a[28:31], v1, s[4:7], s18 offen offset:3072 sc1
    s_add_u32 s18, s18, 4096
    buffer_load_dwordx4 a[32:35], v1, s[4:7], s18 offen offset:0 sc1
    buffer_load_dwordx4 a[36:39], v1, s[4:7], s18 offen offset:1024 sc1
    buffer_load_dwordx4 a[40:43], v1, s[4:7], s18 offen offset:2048 sc1
    buffer_load_dwordx4 a[44:47], v1, s[4:7], s18 offen offset:3072 sc1
    s_add_u32 s18, s18, 4096
    buffer_load_dwordx4 a[48:51], v1, s[4:7], s18 offen offset:0 sc1
    buffer_load_dwordx4 a[52:55], v1, s[4:7], s18 offen offset:1024 sc1
    buffer_load_dwordx4 a[56:59], v1, s[4:7], s18 offen offset:2048 sc1
    buffer_load_dwordx4 a[60:63], v1, s[4:7], s18 offen offset:3072 sc1
    s_add_u32 s18, s18, 4096
    buffer_load_dwordx4 a[64:67], v1, s[4:7], s18 offen offset:0 sc1
    buffer_load_dwordx4 a[68:71], v1, s[4:7], s18 offen offset:1024 sc1
    buffer_load_dwordx4 a[72:75], v1, s[4:7], s18 offen offset:2048 sc1
    buffer_load_dwordx4 a[76:79], v1, s[4:7], s18 offen offset:3072 sc1
    s_add_u32 s18, s18, 4096
    buffer_load_dwordx4 a[80:83], v1, s[4:7], s18 offen offset:0 sc1
    buffer_load_dwordx4 a[84:87], v1, s[4:7], s18 offen offset:1024 sc1
    buffer_load_dwordx4 a[88:91], v1, s[4:7], s18 offen offset:2048 sc1
    buffer_load_dwordx4 a[92:95], v1, s[4:7], s18 offen offset:3072 sc1
    s_add_u32 s18, s18, 4096
    buffer_load_dwordx4 a[96:99], v1, s[4:7], s18 offen offset:0 sc1
    buffer_load_dwordx4 a[100:103], v1, s[4:7], s18 offen offset:1024 sc1
    buffer_load_dwordx4 a[104:107], v1, s[4:7], s18 offen offset:2048 sc1
    buffer_load_dwordx4 a[108:111], v1, s[4:7], s18 offen offset:3072 sc1
    s_add_u32 s18, s18, 4096
    buffer_load_dwordx4 a[112:115], v1, s[4:7], s18 offen offset:0 sc1
    buffer_load_dwordx4 a[116:119], v1, s[4:7], s18 offen offset:1024 sc1
    buffer_load_dwordx4 a[120:123], v1, s[4:7], s18 offen offset:2048 sc1
    buffer_load_dwordx4 a[124:127], v1, s[4:7], s18 offen offset:3072 sc1
    s_add_u32 s18, s18, 4096
    buffer_load_dwordx4 a[128:131], v1, s[4:7], s18 offen offset:0 sc1
    buffer_load_dwordx4 a[132:135], v1, s[4:7], s18 offen offset:1024 sc1
    buffer_load_dwordx4 a[136:139], v1, s[4:7], s18 offen offset:2048 sc1
    buffer_load_dwordx4 a[140:143], v1, s[4:7], s18 offen offset:3072 sc1
    s_add_u32 s18, s18, 4096
    buffer_load_dwordx4 a[144:147], v1, s[4:7], s18 offen offset:0 sc1
    buffer_load_dwordx4 a[148:151], v1, s[4:7], s18 offen offset:1024 sc1
    buffer_load_dwordx4 a[152:155], v1, s[4:7], s18 offen offset:2048 sc1
    buffer_load_dwordx4 a[156:159], v1, s[4:7], s18 offen offset:3072 sc1
    s_add_u32 s18, s18, 4096
    buffer_load_dwordx4 a[160:163], v1, s[4:7], s18 offen offset:0 sc1
    s_waitcnt vmcnt(20)
    buffer_load_dwordx4 a[164:167], v1, s[4:7], s18 offen offset:1024 sc1
    buffer_load_dwordx4 a[168:171], v1, s[4:7], s18 offen offset:2048 sc1
    buffer_load_dwordx4 a[172:175], v1, s[4:7], s18 offen offset:3072 sc1
    s_add_u32 s18, s18, 4096
    buffer_load_dwordx4 a[176:179], v1, s[4:7], s18 offen offset:0 sc1
    buffer_load_dwordx4 a[180:183], v1, s[4:7], s18 offen offset:1024 sc1
    buffer_load_dwordx4 a[184:187], v1, s[4:7], s18 offen offset:2048 sc1
    buffer_load_dwordx4 a[188:191], v1, s[4:7], s18 offen offset:3072 sc1
    s_add_u32 s18, s18, 4096
    buffer_load_dwordx4 a[192:195], v1, s[4:7], s18 offen offset:0 sc1
    buffer_load_dwordx4 a[196:199], v1, s[4:7], s18 offen offset:1024 sc1
    buffer_load_dwordx4 a[200:203], v1, s[4:7], s18 offen offset:2048 sc1
    buffer_load_dwordx4 a[204:207], v1, s[4:7], s18 offen offset:3072 sc1
    s_add_u32 s18, s18, 4096
    buffer_load_dwordx4 a[208:211], v1, s[4:7], s18 offen offset:0 sc1
    buffer_load_dwordx4 a[212:215], v1, s[4:7], s18 offen offset:1024 sc1
    buffer_load_dwordx4 a[216:219], v1, s[4:7], s18 offen offset:2048 sc1
    buffer_load_dwordx4 a[220:223], v1, s[4:7], s18 offen offset:3072 sc1
    s_add_u32 s18, s18, 4096
    buffer_load_dwordx4 a[224:227], v1, s[4:7], s18 offen offset:0 sc1
    buffer_load_dwordx4 a[228:231], v1, s[4:7], s18 offen offset:1024 sc1
    buffer_load_dwordx4 a[232:235], v1, s[4:7], s18 offen offset:2048 sc1
    buffer_load_dwordx4 a[236:239], v1, s[4:7], s18 offen offset:3072 sc1
    s_add_u32 s18, s18, 4096
    buffer_load_dwordx4 a[240:243], v1, s[4:7], s18 offen offset:0 sc1
    buffer_load_dwordx4 a[244:247], v1, s[4:7], s18 offen offset:1024 sc1
    buffer_load_dwordx4 a[248:251], v1, s[4:7], s18 offen offset:2048 sc1
    buffer_load_dwordx4 a[252:255], v1, s[4:7], s18 offen offset:3072 sc1
    s_waitcnt vmcnt(0)
    s_mov_b32 s44, 0
    s_mov_b32 s37, s35
    v_mov_b32 v250, 1
    v_mov_b32 v251, 163832
    v_cmp_eq_u32 vcc, 0, v0
    s_nop 0
    s_and_saveexec_b64 s[38:39], vcc
    s_cbranch_execz tk19
    buffer_atomic_add v250, off, s[84:87], s37 sc0
    s_waitcnt vmcnt(0)
    ds_write_b32 v251, v250
    s_waitcnt lgkmcnt(0)
tk19:
    s_mov_b64 exec, -1
    s_barrier
    ds_read_b32 v252, v251
    s_waitcnt lgkmcnt(0)
    v_readfirstlane_b32 s16, v252
    s_barrier
    s_nop 3
    s_cmp_ge_u32 s16, 72
    s_cbranch_scc1 L_op_nextcb
L_op_seg:
    s_min_u32 s43, s16, 56
    s_add_u32 s16, s16, s43
    s_lshr_b32 s43, s16, 1
    s_add_u32 s43, s43, 2
    s_min_u32 s43, s43, 63
    s_lshl_b32 s94, s33, 7
    s_add_u32 s94, s94, s16
    s_mov_b32 s88, 65536
    s_mov_b32 s89, 125853696
cw20:
    buffer_load_dword v3, off, s[4:7], s89 sc1
    s_waitcnt vmcnt(0)
    v_readfirstlane_b32 s42, v3
    s_nop 0
    s_sub_u32 s42, s42, s95
    s_cmp_gt_u32 s42, 64
    s_cselect_b32 s42, 0, s42
    s_add_u32 s42, s42, 1
    s_cmp_ge_u32 s42, s43
    s_cbranch_scc1 cw20x
    s_sub_u32 s88, s88, 1
    s_cbranch_scc1 cw20x
    s_sub_u32 s42, s43, s42
    s_min_u32 s42, s42, 6
cw20s:
    s_sleep 24
    s_sub_u32 s42, s42, 1
    s_cmp_lg_u32 s42, 0
    s_cbranch_scc1 cw20s
    s_branch cw20
cw20x:
    s_lshr_b32 s89, s16, 1
    s_lshl_b32 s89, s89, 2
    s_add_u32 s89, s89, s32
    s_lshl_b32 s89, s89, 7
    s_add_u32 s89, s89, 125894656
    v_mbcnt_lo_u32_b32 v2, -1, 0
    v_mbcnt_hi_u32_b32 v2, -1, v2
    v_min_u32 v2, 1, v2
    v_lshlrev_b32 v2, 2, v2
    s_mov_b32 s88, 4194304
fw21:
    buffer_load_dword v3, v2, s[4:7], s89 offen offset:0 sc1
    s_sub_u32 s88, s88, 1
    s_cbranch_scc1 fw21x
    s_waitcnt vmcnt(0)
    v_cmp_ne_u32 vcc, s95, v3
    s_cbranch_vccz fw21x
    s_sleep 2
    s_branch fw21
fw21x:
    v_mov_b32 v250, 1
    v_lshrrev_b32 v252, 2, v1
    v_min_u32 v252, 68, v252
    s_cmp_lg_u32 s32, 0
    s_cbranch_scc1 L_op_na
    s_mov_b64 exec, 1
    buffer_atomic_add v250, off, s[84:87], s35 sc0
    s_mov_b64 exec, -1
    s_cmp_lg_u32 s44, 0
    s_cbranch_scc1 L_op_na
    buffer_load_dword v253, v252, s[84:87], 0 offen offset:136 sc1
L_op_na:
    s_cmp_ge_u32 s16, 112
    s_cbranch_scc1 L_op_one
    s_lshl_b32 s18, s16, 17
    s_lshl_b32 s19, s32, 15
    s_add_u32 s18, s18, s19
    s_add_u32 s18, s18, 50331648
    buffer_load_dwordx4 v[24:27], v1, s[4:7], s18 offen offset:0 sc1
    buffer_load_dwordx4 v[28:31], v1, s[4:7], s18 offen offset:1024 sc1
    buffer_load_dwordx4 v[32:35], v1, s[4:7], s18 offen offset:2048 sc1
    buffer_load_dwordx4 v[36:39], v1, s[4:7], s18 offen offset:3072 sc1
    s_add_u32 s18, s18, 4096
    buffer_load_dwordx4 v[40:43], v1, s[4:7], s18 offen offset:0 sc1
    buffer_load_dwordx4 v[44:47], v1, s[4:7], s18 offen offset:1024 sc1
    buffer_load_dwordx4 v[48:51], v1, s[4:7], s18 offen offset:2048 sc1
    buffer_load_dwordx4 v[52:55], v1, s[4:7], s18 offen offset:3072 sc1
    s_add_u32 s18, s18, 4096
    buffer_load_dwordx4 v[56:59], v1, s[4:7], s18 offen offset:0 sc1
    buffer_load_dwordx4 v[60:63], v1, s[4:7], s18 offen offset:1024 sc1
    buffer_load_dwordx4 v[64:67], v1, s[4:7], s18 offen offset:2048 sc1
    buffer_load_dwordx4 v[68:71], v1, s[4:7], s18 offen offset:3072 sc1
    s_add_u32 s18, s18, 4096
    buffer_load_dwordx4 v[72:75], v1, s[4:7], s18 offen offset:0 sc1
    buffer_load_dwordx4 v[76:79], v1, s[4:7], s18 offen offset:1024 sc1
    buffer_load_dwordx4 v[80:83], v1, s[4:7], s18 offen offset:2048 sc1
    buffer_load_dwordx4 v[84:87], v1, s[4:7], s18 offen offset:3072 sc1
    s_add_u32 s18, s18, 4096
    buffer_load_dwordx4 v[88:91], v1, s[4:7], s18 offen offset:0 sc1
    buffer_load_dwordx4 v[92:95], v1, s[4:7], s18 offen offset:1024 sc1
    buffer_load_dwordx4 v[96:99], v1, s[4:7], s18 offen offset:2048 sc1
    buffer_load_dwordx4 v[100:103], v1, s[4:7], s18 offen offset:3072 sc1
    s_add_u32 s18, s18, 4096
    buffer_load_dwordx4 v[104:107], v1, s[4:7], s18 offen offset:0 sc1
    buffer_load_dwordx4 v[108:111], v1, s[4:7], s18 offen offset:1024 sc1
    buffer_load_dwordx4 v[112:115], v1, s[4:7], s18 offen offset:2048 sc1
    buffer_load_dwordx4 v[116:119], v1, s[4:7], s18 offen offset:3072 sc1
    s_add_u32 s18, s18, 4096
    buffer_load_dwordx4 v[120:123], v1, s[4:7], s18 offen offset:0 sc1
    buffer_load_dwordx4 v[124:127], v1, s[4:7], s18 offen offset:1024 sc1
    buffer_load_dwordx4 v[128:131], v1, s[4:7], s18 offen offset:2048 sc1
    buffer_load_dwordx4 v[132:135], v1, s[4:7], s18 offen offset:3072 sc1
    s_add_u32 s18, s18, 4096
    buffer_load_dwordx4 v[136:139], v1, s[4:7], s18 offen offset:0 sc1
    buffer_load_dwordx4 v[140:143], v1, s[4:7], s18 offen offset:1024 sc1
    buffer_load_dwordx4 v[144:147], v1, s[4:7], s18 offen offset:2048 sc1
    buffer_load_dwordx4 v[148:151], v1, s[4:7], s18 offen offset:3072 sc1
    s_add_u32 s18, s18, 102400
    buffer_load_dwordx4 v[152:155], v1, s[4:7], s18 offen offset:0 sc1
    buffer_load_dwordx4 v[156:159], v1, s[4:7], s18 offen offset:1024 sc1
    buffer_load_dwordx4 v[160:163], v1, s[4:7], s18 offen offset:2048 sc1
    buffer_load_dwordx4 v[164:167], v1, s[4:7], s18 offen offset:3072 sc1
    s_add_u32 s18, s18, 4096
    buffer_load_dwordx4 v[168:171], v1, s[4:7], s18 offen offset:0 sc1
    buffer_load_dwordx4 v[172:175], v1, s[4:7], s18 offen offset:1024 sc1
    buffer_load_dwordx4 v[176:179], v1, s[4:7], s18 offen offset:2048 sc1
    buffer_load_dwordx4 v[180:183], v1, s[4:7], s18 offen offset:3072 sc1
    s_add_u32 s18, s18, 4096
    buffer_load_dwordx4 v[184:187], v1, s[4:7], s18 offen offset:0 sc1
    buffer_load_dwordx4 v[188:191], v1, s[4:7], s18 offen offset:1024 sc1
    buffer_load_dwordx4 v[192:195], v1, s[4:7], s18 offen offset:2048 sc1
    buffer_load_dwordx4 v[196:199], v1, s[4:7], s18 offen offset:3072 sc1
    s_add_u32 s18, s18, 4096
    buffer_load_dwordx4 v[200:203], v1, s[4:7], s18 offen offset:0 sc1
    buffer_load_dwordx4 v[204:207], v1, s[4:7], s18 offen offset:1024 sc1
    buffer_load_dwordx4 v[208:211], v1, s[4:7], s18 offen offset:2048 sc1
    buffer_load_dwordx4 v[212:215], v1, s[4:7], s18 offen offset:3072 sc1
    s_add_u32 s18, s18, 4096
    buffer_load_dwordx4 v[216:219], v1, s[4:7], s18 offen offset:0 sc1
    buffer_load_dwordx4 v[220:223], v1, s[4:7], s18 offen offset:1024 sc1
    buffer_load_dwordx4 v[224:227], v1, s[4:7], s18 offen offset:2048 sc1
    buffer_load_dwordx4 v[228:231], v1, s[4:7], s18 offen offset:3072 sc1
    s_add_u32 s18, s18, 4096
    buffer_load_dwordx4 v[232:235], v1, s[4:7], s18 offen offset:0 sc1
    buffer_load_dwordx4 v[236:239], v1, s[4:7], s18 offen offset:1024 sc1
    buffer_load_dwordx4 v[240:243], v1, s[4:7], s18 offen offset:2048 sc1
    buffer_load_dwordx4 v[244:247], v1, s[4:7], s18 offen offset:3072 sc1
    v_lshlrev_b32 v2, 4, v0
    v_and_b32 v3, 3072, v2
    v_lshl_add_u32 v2, v3, 1, v1
    s_waitcnt vmcnt(55)
    v_mfma_f32_16x16x32_bf16 v[8:11], a[0:3], v[24:27], 0
    v_mfma_f32_16x16x32_bf16 v[12:15], a[4:7], v[24:27], 0
    s_add_u32 s18, s18, 4096
    buffer_load_dwordx4 v[24:27], v1, s[4:7], s18 offen offset:0 sc1
    s_waitcnt vmcnt(55)
    v_mfma_f32_16x16x32_bf16 v[8:11], a[8:11], v[28:31], v[8:11]
    v_mfma_f32_16x16x32_bf16 v[12:15], a[12:15], v[28:31], v[12:15]
    buffer_load_dwordx4 v[28:31], v1, s[4:7], s18 offen offset:1024 sc1
    s_waitcnt vmcnt(55)
    v_mfma_f32_16x16x32_bf16 v[8:11], a[16:19], v[32:35], v[8:11]
    v_mfma_f32_16x16x32_bf16 v[12:15], a[20:23], v[32:35], v[12:15]
    buffer_load_dwordx4 v[32:35], v1, s[4:7], s18 offen offset:2048 sc1
    s_waitcnt vmcnt(55)
    v_mfma_f32_16x16x32_bf16 v[8:11], a[24:27], v[36:39], v[8:11]
    v_mfma_f32_16x16x32_bf16 v[12:15], a[28:31], v[36:39], v[12:15]
    buffer_load_dwordx4 v[36:39], v1, s[4:7], s18 offen offset:3072 sc1
    s_waitcnt vmcnt(55)
    v_mfma_f32_16x16x32_bf16 v[8:11], a[32:35], v[40:43], v[8:11]
    v_mfma_f32_16x16x32_bf16 v[12:15], a[36:39], v[40:43], v[12:15]
    s_add_u32 s18, s18, 4096
    buffer_load_dwordx4 v[40:43], v1, s[4:7], s18 offen offset:0 sc1
    s_waitcnt vmcnt(55)
    v_mfma_f32_16x16x32_bf16 v[8:11], a[40:43], v[44:47], v[8:11]
    v_mfma_f32_16x16x32_bf16 v[12:15], a[44:47], v[44:47], v[12:15]
    buffer_load_dwordx4 v[44:47], v1, s[4:7], s18 offen offset:1024 sc1
    s_waitcnt vmcnt(55)
    v_mfma_f32_16x16x32_bf16 v[8:11], a[48:51], v[48:51], v[8:11]
    v_mfma_f32_16x16x32_bf16 v[12:15], a[52:55], v[48:51], v[12:15]
    buffer_load_dwordx4 v[48:51], v1, s[4:7], s18 offen offset:2048 sc1
    s_waitcnt vmcnt(55)
    v_mfma_f32_16x16x32_bf16 v[8:11], a[56:59], v[52:55], v[8:11]
    v_mfma_f32_16x16x32_bf16 v[12:15], a[60:63], v[52:55], v[12:15]
    buffer_load_dwordx4 v[52:55], v1, s[4:7], s18 offen offset:3072 sc1
    s_waitcnt vmcnt(55)
    v_mfma_f32_16x16x32_bf16 v[8:11], a[64:67], v[56:59], v[8:11]
    v_mfma_f32_16x16x32_bf16 v[12:15], a[68:71], v[56:59], v[12:15]
    s_waitcnt vmcnt(54)
    v_mfma_f32_16x16x32_bf16 v[8:11], a[72:75], v[60:63], v[8:11]
    v_mfma_f32_16x16x32_bf16 v[12:15], a[76:79], v[60:63], v[12:15]
    s_waitcnt vmcnt(53)
    v_mfma_f32_16x16x32_bf16 v[8:11], a[80:83], v[64:67], v[8:11]
    v_mfma_f32_16x16x32_bf16 v[12:15], a[84:87], v[64:67], v[12:15]
    s_waitcnt vmcnt(52)
    v_mfma_f32_16x16x32_bf16 v[8:11], a[88:91], v[68:71], v[8:11]
    v_mfma_f32_16x16x32_bf16 v[12:15], a[92:95], v[68:71], v[12:15]
    s_waitcnt vmcnt(51)
    v_mfma_f32_16x16x32_bf16 v[8:11], a[96:99], v[72:75], v[8:11]
    v_mfma_f32_16x16x32_bf16 v[12:15], a[100:103], v[72:75], v[12:15]
    s_waitcnt vmcnt(50)
    v_mfma_f32_16x16x32_bf16 v[8:11], a[104:107], v[76:79], v[8:11]
    v_mfma_f32_16x16x32_bf16 v[12:15], a[108:111], v[76:79], v[12:15]
    s_waitcnt vmcnt(49)
    v_mfma_f32_16x16x32_bf16 v[8:11], a[112:115], v[80:83], v[8:11]
    v_mfma_f32_16x16x32_bf16 v[12:15], a[116:119], v[80:83], v[12:15]
    s_waitcnt vmcnt(48)
    v_mfma_f32_16x16x32_bf16 v[8:11], a[120:123], v[84:87], v[8:11]
    v_mfma_f32_16x16x32_bf16 v[12:15], a[124:127], v[84:87], v[12:15]
    s_waitcnt vmcnt(47)
    v_mfma_f32_16x16x32_bf16 v[8:11], a[128:131], v[88:91], v[8:11]
    v_mfma_f32_16x16x32_bf16 v[12:15], a[132:135], v[88:91], v[12:15]
    s_waitcnt vmcnt(46)
    v_mfma_f32_16x16x32_bf16 v[8:11], a[136:139], v[92:95], v[8:11]
    v_mfma_f32_16x16x32_bf16 v[12:15], a[140:143], v[92:95], v[12:15]
    s_waitcnt vmcnt(45)
    v_mfma_f32_16x16x32_bf16 v[8:11], a[144:147], v[96:99], v[8:11]
    v_mfma_f32_16x16x32_bf16 v[12:15], a[148:151], v[96:99], v[12:15]
    s_waitcnt vmcnt(44)
    v_mfma_f32_16x16x32_bf16 v[8:11], a[152:155], v[100:103], v[8:11]
    v_mfma_f32_16x16x32_bf16 v[12:15], a[156:159], v[100:103], v[12:15]
    s_waitcnt vmcnt(43)
    v_mfma_f32_16x16x32_bf16 v[8:11], a[160:163], v[104:107], v[8:11]
    v_mfma_f32_16x16x32_bf16 v[12:15], a[164:167], v[104:107], v[12:15]
    s_waitcnt vmcnt(42)
    v_mfma_f32_16x16x32_bf16 v[8:11], a[168:171], v[108:111], v[8:11]
    v_mfma_f32_16x16x32_bf16 v[12:15], a[172:175], v[108:111], v[12:15]
    s_waitcnt vmcnt(41)
    v_mfma_f32_16x16x32_bf16 v[8:11], a[176:179], v[112:115], v[8:11]
    v_mfma_f32_16x16x32_bf16 v[12:15], a[180:183], v[112:115], v[12:15]
    s_waitcnt vmcnt(40)
    v_mfma_f32_16x16x32_bf16 v[8:11], a[184:187], v[116:119], v[8:11]
    v_mfma_f32_16x16x32_bf16 v[12:15], a[188:191], v[116:119], v[12:15]
    s_waitcnt vmcnt(39)
    v_mfma_f32_16x16x32_bf16 v[8:11], a[192:195], v[120:123], v[8:11]
    v_mfma_f32_16x16x32_bf16 v[12:15], a[196:199], v[120:123], v[12:15]
    s_waitcnt vmcnt(38)
    v_mfma_f32_16x16x32_bf16 v[8:11], a[200:203], v[124:127], v[8:11]
    v_mfma_f32_16x16x32_bf16 v[12:15], a[204:207], v[124:127], v[12:15]
    s_waitcnt vmcnt(37)
    v_mfma_f32_16x16x32_bf16 v[8:11], a[208:211], v[128:131], v[8:11]
    v_mfma_f32_16x16x32_bf16 v[12:15], a[212:215], v[128:131], v[12:15]
    s_waitcnt vmcnt(36)
    v_mfma_f32_16x16x32_bf16 v[8:11], a[216:219], v[132:135], v[8:11]
    v_mfma_f32_16x16x32_bf16 v[12:15], a[220:223], v[132:135], v[12:15]
    s_waitcnt vmcnt(35)
    v_mfma_f32_16x16x32_bf16 v[8:11], a[224:227], v[136:139], v[8:11]
    v_mfma_f32_16x16x32_bf16 v[12:15], a[228:231], v[136:139], v[12:15]
    s_waitcnt vmcnt(34)
    v_mfma_f32_16x16x32_bf16 v[8:11], a[232:235], v[140:143], v[8:11]
    v_mfma_f32_16x16x32_bf16 v[12:15], a[236:239], v[140:143], v[12:15]
    s_waitcnt vmcnt(33)
    v_mfma_f32_16x16x32_bf16 v[8:11], a[240:243], v[144:147], v[8:11]
    v_mfma_f32_16x16x32_bf16 v[12:15], a[244:247], v[144:147], v[12:15]
    s_waitcnt vmcnt(32)
    v_mfma_f32_16x16x32_bf16 v[8:11], a[248:251], v[148:151], v[8:11]
    v_mfma_f32_16x16x32_bf16 v[12:15], a[252:255], v[148:151], v[12:15]
    s_waitcnt vmcnt(31)
    v_mfma_f32_16x16x32_bf16 v[16:19], a[0:3], v[152:155], 0
    v_mfma_f32_16x16x32_bf16 v[20:23], a[4:7], v[152:155], 0
    s_waitcnt vmcnt(30)
    v_mfma_f32_16x16x32_bf16 v[16:19], a[8:11], v[156:159], v[16:19]
    v_mfma_f32_16x16x32_bf16 v[20:23], a[12:15], v[156:159], v[20:23]
    s_waitcnt vmcnt(29)
    v_mfma_f32_16x16x32_bf16 v[16:19], a[16:19], v[160:163], v[16:19]
    v_mfma_f32_16x16x32_bf16 v[20:23], a[20:23], v[160:163], v[20:23]
    s_waitcnt vmcnt(28)
    v_mfma_f32_16x16x32_bf16 v[16:19], a[24:27], v[164:167], v[16:19]
    v_mfma_f32_16x16x32_bf16 v[20:23], a[28:31], v[164:167], v[20:23]
    s_waitcnt vmcnt(27)
    v_mfma_f32_16x16x32_bf16 v[16:19], a[32:35], v[168:171], v[16:19]
    v_mfma_f32_16x16x32_bf16 v[20:23], a[36:39], v[168:171], v[20:23]
    s_waitcnt vmcnt(26)
    v_mfma_f32_16x16x32_bf16 v[16:19], a[40:43], v[172:175], v[16:19]
    v_mfma_f32_16x16x32_bf16 v[20:23], a[44:47], v[172:175], v[20:23]
    s_waitcnt vmcnt(25)
    v_mfma_f32_16x16x32_bf16 v[16:19], a[48:51], v[176:179], v[16:19]
    v_mfma_f32_16x16x32_bf16 v[20:23], a[52:55], v[176:179], v[20:23]
    s_waitcnt vmcnt(24)
    v_mfma_f32_16x16x32_bf16 v[16:19], a[56:59], v[180:183], v[16:19]
    v_mfma_f32_16x16x32_bf16 v[20:23], a[60:63], v[180:183], v[20:23]
    s_waitcnt vmcnt(23)
    v_mfma_f32_16x16x32_bf16 v[16:19], a[64:67], v[184:187], v[16:19]
    v_mfma_f32_16x16x32_bf16 v[20:23], a[68:71], v[184:187], v[20:23]
    s_waitcnt vmcnt(22)
    v_mfma_f32_16x16x32_bf16 v[16:19], a[72:75], v[188:191], v[16:19]
    v_mfma_f32_16x16x32_bf16 v[20:23], a[76:79], v[188:191], v[20:23]
    s_waitcnt vmcnt(21)
    v_mfma_f32_16x16x32_bf16 v[16:19], a[80:83], v[192:195], v[16:19]
    v_mfma_f32_16x16x32_bf16 v[20:23], a[84:87], v[192:195], v[20:23]
    s_waitcnt vmcnt(20)
    v_mfma_f32_16x16x32_bf16 v[16:19], a[88:91], v[196:199], v[16:19]
    v_mfma_f32_16x16x32_bf16 v[20:23], a[92:95], v[196:199], v[20:23]
    s_waitcnt vmcnt(19)
    v_mfma_f32_16x16x32_bf16 v[16:19], a[96:99], v[200:203], v[16:19]
    v_mfma_f32_16x16x32_bf16 v[20:23], a[100:103], v[200:203], v[20:23]
    s_waitcnt vmcnt(18)
    v_mfma_f32_16x16x32_bf16 v[16:19], a[104:107], v[204:207], v[16:19]
    v_mfma_f32_16x16x32_bf16 v[20:23], a[108:111], v[204:207], v[20:23]
    s_waitcnt vmcnt(17)
    v_mfma_f32_16x16x32_bf16 v[16:19], a[112:115], v[208:211], v[16:19]
    v_mfma_f32_16x16x32_bf16 v[20:23], a[116:119], v[208:211], v[20:23]
    s_waitcnt vmcnt(16)
    v_mfma_f32_16x16x32_bf16 v[16:19], a[120:123], v[212:215], v[16:19]
    v_mfma_f32_16x16x32_bf16 v[20:23], a[124:127], v[212:215], v[20:23]
    s_waitcnt vmcnt(15)
    v_mfma_f32_16x16x32_bf16 v[16:19], a[128:131], v[216:219], v[16:19]
    v_mfma_f32_16x16x32_bf16 v[20:23], a[132:135], v[216:219], v[20:23]
    s_waitcnt vmcnt(14)
    v_mfma_f32_16x16x32_bf16 v[16:19], a[136:139], v[220:223], v[16:19]
    v_mfma_f32_16x16x32_bf16 v[20:23], a[140:143], v[220:223], v[20:23]
    s_waitcnt vmcnt(13)
    v_mfma_f32_16x16x32_bf16 v[16:19], a[144:147], v[224:227], v[16:19]
    v_mfma_f32_16x16x32_bf16 v[20:23], a[148:151], v[224:227], v[20:23]
    s_waitcnt vmcnt(12)
    v_mfma_f32_16x16x32_bf16 v[16:19], a[152:155], v[228:231], v[16:19]
    v_mfma_f32_16x16x32_bf16 v[20:23], a[156:159], v[228:231], v[20:23]
    s_waitcnt vmcnt(11)
    v_mfma_f32_16x16x32_bf16 v[16:19], a[160:163], v[232:235], v[16:19]
    v_mfma_f32_16x16x32_bf16 v[20:23], a[164:167], v[232:235], v[20:23]
    s_waitcnt vmcnt(10)
    v_mfma_f32_16x16x32_bf16 v[16:19], a[168:171], v[236:239], v[16:19]
    v_mfma_f32_16x16x32_bf16 v[20:23], a[172:175], v[236:239], v[20:23]
    s_waitcnt vmcnt(9)
    v_mfma_f32_16x16x32_bf16 v[16:19], a[176:179], v[240:243], v[16:19]
    v_mfma_f32_16x16x32_bf16 v[20:23], a[180:183], v[240:243], v[20:23]
    s_waitcnt vmcnt(8)
    v_mfma_f32_16x16x32_bf16 v[16:19], a[184:187], v[244:247], v[16:19]
    v_mfma_f32_16x16x32_bf16 v[20:23], a[188:191], v[244:247], v[20:23]
    s_waitcnt vmcnt(7)
    v_mfma_f32_16x16x32_bf16 v[16:19], a[192:195], v[24:27], v[16:19]
    v_mfma_f32_16x16x32_bf16 v[20:23], a[196:199], v[24:27], v[20:23]
    s_waitcnt vmcnt(6)
    v_mfma_f32_16x16x32_bf16 v[16:19], a[200:203], v[28:31], v[16:19]
    v_mfma_f32_16x16x32_bf16 v[20:23], a[204:207], v[28:31], v[20:23]
    s_waitcnt vmcnt(5)
    v_mfma_f32_16x16x32_bf16 v[16:19], a[208:211], v[32:35], v[16:19]
    v_mfma_f32_16x16x32_bf16 v[20:23], a[212:215], v[32:35], v[20:23]
    s_waitcnt vmcnt(4)
    v_mfma_f32_16x16x32_bf16 v[16:19], a[216:219], v[36:39], v[16:19]
    v_mfma_f32_16x16x32_bf16 v[20:23], a[220:223], v[36:39], v[20:23]
    s_waitcnt vmcnt(3)
    v_mfma_f32_16x16x32_bf16 v[16:19], a[224:227], v[40:43], v[16:19]
    v_mfma_f32_16x16x32_bf16 v[20:23], a[228:231], v[40:43], v[20:23]
    s_waitcnt vmcnt(2)
    v_mfma_f32_16x16x32_bf16 v[16:19], a[232:235], v[44:47], v[16:19]
    v_mfma_f32_16x16x32_bf16 v[20:23], a[236:239], v[44:47], v[20:23]
    s_waitcnt vmcnt(1)
    v_mfma_f32_16x16x32_bf16 v[16:19], a[240:243], v[48:51], v[16:19]
    v_mfma_f32_16x16x32_bf16 v[20:23], a[244:247], v[48:51], v[20:23]
    s_waitcnt vmcnt(0)
    v_mfma_f32_16x16x32_bf16 v[16:19], a[248:251], v[52:55], v[16:19]
    v_mfma_f32_16x16x32_bf16 v[20:23], a[252:255], v[52:55], v[20:23]
    ds_write_b128 v2, v[8:11] offset:0
    ds_write_b128 v2, v[12:15] offset:1024
    s_nop 4
    ds_write_b128 v2, v[16:19] offset:8192
    ds_write_b128 v2, v[20:23] offset:9216
    s_cmp_lg_u32 s32, 0
    s_cbranch_scc1 o2_nb
    v_cmp_eq_u32 vcc, 0, v253
    s_nop 0
    s_cmp_eq_u64 vcc, 0
    s_cselect_b32 s44, 65536, 0
    v_or_b32 v250, s44, v250
    v_mov_b32 v251, 163832
    s_mov_b64 exec, 1
    ds_write_b32 v251, v250
    s_mov_b64 exec, -1
o2_nb:
    s_waitcnt lgkmcnt(0)
    s_barrier
    s_cmp_gt_u32 s32, 1
    s_cbranch_scc1 o2_skip
    s_lshl_b32 s18, s32, 13
    v_add_u32 v2, s18, v1
    ds_read_b128 v[24:27], v2 offset:0
    ds_read_b128 v[28:31], v2 offset:1024
    ds_read_b128 v[32:35], v2 offset:2048
    ds_read_b128 v[36:39], v2 offset:3072
    ds_read_b128 v[40:43], v2 offset:4096
    ds_read_b128 v[44:47], v2 offset:5120
    ds_read_b128 v[48:51], v2 offset:6144
    ds_read_b128 v[52:55], v2 offset:7168
    v_lshrrev_b32 v3, 4, v1
    v_bfe_u32 v4, v3, 2, 2
    v_lshlrev_b32 v4, 3, v4
    v_and_b32 v2, 3, v3
    v_add_u32 v4, v4, v2
    v_mul_u32_u24 v4, 2304, v4
    v_lshrrev_b32 v3, 4, v3
    v_lshl_add_u32 v4, v3, 4, v4
    s_add_u32 s20, s16, s32
    s_lshr_b32 s18, s20, 1
    s_lshl_b32 s18, s18, 3
    s_and_b32 s19, s20, 1
    s_add_u32 s18, s18, s19
    s_mul_i32 s18, s18, 9216
    s_lshl_b32 s19, s33, 6
    s_add_u32 s18, s18, s19
    s_waitcnt lgkmcnt(0)
    v_pk_add_f32 v[24:25], v[24:25], v[32:33]
    v_pk_add_f32 v[40:41], v[40:41], v[48:49]
    v_pk_add_f32 v[24:25], v[24:25], v[40:41]
    v_pk_add_f32 v[26:27], v[26:27], v[34:35]
    v_pk_add_f32 v[42:43], v[42:43], v[50:51]
    v_pk_add_f32 v[26:27], v[26:27], v[42:43]
    v_pk_add_f32 v[28:29], v[28:29], v[36:37]
    v_pk_add_f32 v[44:45], v[44:45], v[52:53]
    v_pk_add_f32 v[28:29], v[28:29], v[44:45]
    v_pk_add_f32 v[30:31], v[30:31], v[38:39]
    v_pk_add_f32 v[46:47], v[46:47], v[54:55]
    v_pk_add_f32 v[30:31], v[30:31], v[46:47]
    v_cvt_pk_bf16_f32 v8, v24, v28
    v_cvt_pk_bf16_f32 v9, v25, v29
    v_cvt_pk_bf16_f32 v10, v26, v30
    v_cvt_pk_bf16_f32 v11, v27, v31
    buffer_store_dwordx4 v[8:11], v4, s[8:11], s18 offen
o2_skip:
    s_nop 1
    s_branch L_op_fin
L_op_one:
    s_lshl_b32 s18, s16, 17
    s_lshl_b32 s19, s32, 15
    s_add_u32 s18, s18, s19
    s_add_u32 s18, s18, 50331648
    buffer_load_dwordx4 v[24:27], v1, s[4:7], s18 offen offset:0 sc1
    buffer_load_dwordx4 v[28:31], v1, s[4:7], s18 offen offset:1024 sc1
    buffer_load_dwordx4 v[32:35], v1, s[4:7], s18 offen offset:2048 sc1
    buffer_load_dwordx4 v[36:39], v1, s[4:7], s18 offen offset:3072 sc1
    s_add_u32 s18, s18, 4096
    buffer_load_dwordx4 v[40:43], v1, s[4:7], s18 offen offset:0 sc1
    buffer_load_dwordx4 v[44:47], v1, s[4:7], s18 offen offset:1024 sc1
    buffer_load_dwordx4 v[48:51], v1, s[4:7], s18 offen offset:2048 sc1
    buffer_load_dwordx4 v[52:55], v1, s[4:7], s18 offen offset:3072 sc1
    s_add_u32 s18, s18, 4096
    buffer_load_dwordx4 v[56:59], v1, s[4:7], s18 offen offset:0 sc1
    buffer_load_dwordx4 v[60:63], v1, s[4:7], s18 offen offset:1024 sc1
    buffer_load_dwordx4 v[64:67], v1, s[4:7], s18 offen offset:2048 sc1
    buffer_load_dwordx4 v[68:71], v1, s[4:7], s18 offen offset:3072 sc1
    s_add_u32 s18, s18, 4096
    buffer_load_dwordx4 v[72:75], v1, s[4:7], s18 offen offset:0 sc1
    buffer_load_dwordx4 v[76:79], v1, s[4:7], s18 offen offset:1024 sc1
    buffer_load_dwordx4 v[80:83], v1, s[4:7], s18 offen offset:2048 sc1
    buffer_load_dwordx4 v[84:87], v1, s[4:7], s18 offen offset:3072 sc1
    s_add_u32 s18, s18, 4096
    buffer_load_dwordx4 v[88:91], v1, s[4:7], s18 offen offset:0 sc1
    buffer_load_dwordx4 v[92:95], v1, s[4:7], s18 offen offset:1024 sc1
    buffer_load_dwordx4 v[96:99], v1, s[4:7], s18 offen offset:2048 sc1
    buffer_load_dwordx4 v[100:103], v1, s[4:7], s18 offen offset:3072 sc1
    s_add_u32 s18, s18, 4096
    buffer_load_dwordx4 v[104:107], v1, s[4:7], s18 offen offset:0 sc1
    buffer_load_dwordx4 v[108:111], v1, s[4:7], s18 offen offset:1024 sc1
    buffer_load_dwordx4 v[112:115], v1, s[4:7], s18 offen offset:2048 sc1
    buffer_load_dwordx4 v[116:119], v1, s[4:7], s18 offen offset:3072 sc1
    s_add_u32 s18, s18, 4096
    buffer_load_dwordx4 v[120:123], v1, s[4:7], s18 offen offset:0 sc1
    buffer_load_dwordx4 v[124:127], v1, s[4:7], s18 offen offset:1024 sc1
    buffer_load_dwordx4 v[128:131], v1, s[4:7], s18 offen offset:2048 sc1
    buffer_load_dwordx4 v[132:135], v1, s[4:7], s18 offen offset:3072 sc1
    s_add_u32 s18, s18, 4096
    buffer_load_dwordx4 v[136:139], v1, s[4:7], s18 offen offset:0 sc1
    buffer_load_dwordx4 v[140:143], v1, s[4:7], s18 offen offset:1024 sc1
    buffer_load_dwordx4 v[144:147], v1, s[4:7], s18 offen offset:2048 sc1
    buffer_load_dwordx4 v[148:151], v1, s[4:7], s18 offen offset:3072 sc1
    v_lshlrev_b32 v2, 4, v0
    v_and_b32 v3, 3072, v2
    v_lshl_add_u32 v2, v3, 1, v1
    s_waitcnt vmcnt(31)
    v_mfma_f32_16x16x32_bf16 v[8:11], a[0:3], v[24:27], 0
    v_mfma_f32_16x16x32_bf16 v[12:15], a[4:7], v[24:27], 0
    s_waitcnt vmcnt(30)
    v_mfma_f32_16x16x32_bf16 v[8:11], a[8:11], v[28:31], v[8:11]
    v_mfma_f32_16x16x32_bf16 v[12:15], a[12:15], v[28:31], v[12:15]
    s_waitcnt vmcnt(29)
    v_mfma_f32_16x16x32_bf16 v[8:11], a[16:19], v[32:35], v[8:11]
    v_mfma_f32_16x16x32_bf16 v[12:15], a[20:23], v[32:35], v[12:15]
    s_waitcnt vmcnt(28)
    v_mfma_f32_16x16x32_bf16 v[8:11], a[24:27], v[36:39], v[8:11]
    v_mfma_f32_16x16x32_bf16 v[12:15], a[28:31], v[36:39], v[12:15]
    s_waitcnt vmcnt(27)
    v_mfma_f32_16x16x32_bf16 v[8:11], a[32:35], v[40:43], v[8:11]
    v_mfma_f32_16x16x32_bf16 v[12:15], a[36:39], v[40:43], v[12:15]
    s_waitcnt vmcnt(26)
    v_mfma_f32_16x16x32_bf16 v[8:11], a[40:43], v[44:47], v[8:11]
    v_mfma_f32_16x16x32_bf16 v[12:15], a[44:47], v[44:47], v[12:15]
    s_waitcnt vmcnt(25)
    v_mfma_f32_16x16x32_bf16 v[8:11], a[48:51], v[48:51], v[8:11]
    v_mfma_f32_16x16x32_bf16 v[12:15], a[52:55], v[48:51], v[12:15]
    s_waitcnt vmcnt(24)
    v_mfma_f32_16x16x32_bf16 v[8:11], a[56:59], v[52:55], v[8:11]
    v_mfma_f32_16x16x32_bf16 v[12:15], a[60:63], v[52:55], v[12:15]
    s_waitcnt vmcnt(23)
    v_mfma_f32_16x16x32_bf16 v[8:11], a[64:67], v[56:59], v[8:11]
    v_mfma_f32_16x16x32_bf16 v[12:15], a[68:71], v[56:59], v[12:15]
    s_waitcnt vmcnt(22)
    v_mfma_f32_16x16x32_bf16 v[8:11], a[72:75], v[60:63], v[8:11]
    v_mfma_f32_16x16x32_bf16 v[12:15], a[76:79], v[60:63], v[12:15]
    s_waitcnt vmcnt(21)
    v_mfma_f32_16x16x32_bf16 v[8:11], a[80:83], v[64:67], v[8:11]
    v_mfma_f32_16x16x32_bf16 v[12:15], a[84:87], v[64:67], v[12:15]
    s_waitcnt vmcnt(20)
    v_mfma_f32_16x16x32_bf16 v[8:11], a[88:91], v[68:71], v[8:11]
    v_mfma_f32_16x16x32_bf16 v[12:15], a[92:95], v[68:71], v[12:15]
    s_waitcnt vmcnt(19)
    v_mfma_f32_16x16x32_bf16 v[8:11], a[96:99], v[72:75], v[8:11]
    v_mfma_f32_16x16x32_bf16 v[12:15], a[100:103], v[72:75], v[12:15]
    s_waitcnt vmcnt(18)
    v_mfma_f32_16x16x32_bf16 v[8:11], a[104:107], v[76:79], v[8:11]
    v_mfma_f32_16x16x32_bf16 v[12:15], a[108:111], v[76:79], v[12:15]
    s_waitcnt vmcnt(17)
    v_mfma_f32_16x16x32_bf16 v[8:11], a[112:115], v[80:83], v[8:11]
    v_mfma_f32_16x16x32_bf16 v[12:15], a[116:119], v[80:83], v[12:15]
    s_waitcnt vmcnt(16)
    v_mfma_f32_16x16x32_bf16 v[8:11], a[120:123], v[84:87], v[8:11]
    v_mfma_f32_16x16x32_bf16 v[12:15], a[124:127], v[84:87], v[12:15]
    s_waitcnt vmcnt(15)
    v_mfma_f32_16x16x32_bf16 v[8:11], a[128:131], v[88:91], v[8:11]
    v_mfma_f32_16x16x32_bf16 v[12:15], a[132:135], v[88:91], v[12:15]
    s_waitcnt vmcnt(14)
    v_mfma_f32_16x16x32_bf16 v[8:11], a[136:139], v[92:95], v[8:11]
    v_mfma_f32_16x16x32_bf16 v[12:15], a[140:143], v[92:95], v[12:15]
    s_waitcnt vmcnt(13)
    v_mfma_f32_16x16x32_bf16 v[8:11], a[144:147], v[96:99], v[8:11]
    v_mfma_f32_16x16x32_bf16 v[12:15], a[148:151], v[96:99], v[12:15]
    s_waitcnt vmcnt(12)
    v_mfma_f32_16x16x32_bf16 v[8:11], a[152:155], v[100:103], v[8:11]
    v_mfma_f32_16x16x32_bf16 v[12:15], a[156:159], v[100:103], v[12:15]
    s_waitcnt vmcnt(11)
    v_mfma_f32_16x16x32_bf16 v[8:11], a[160:163], v[104:107], v[8:11]
    v_mfma_f32_16x16x32_bf16 v[12:15], a[164:167], v[104:107], v[12:15]
    s_waitcnt vmcnt(10)
    v_mfma_f32_16x16x32_bf16 v[8:11], a[168:171], v[108:111], v[8:11]
    v_mfma_f32_16x16x32_bf16 v[12:15], a[172:175], v[108:111], v[12:15]
    s_waitcnt vmcnt(9)
    v_mfma_f32_16x16x32_bf16 v[8:11], a[176:179], v[112:115], v[8:11]
    v_mfma_f32_16x16x32_bf16 v[12:15], a[180:183], v[112:115], v[12:15]
    s_waitcnt vmcnt(8)
    v_mfma_f32_16x16x32_bf16 v[8:11], a[184:187], v[116:119], v[8:11]
    v_mfma_f32_16x16x32_bf16 v[12:15], a[188:191], v[116:119], v[12:15]
    s_waitcnt vmcnt(7)
    v_mfma_f32_16x16x32_bf16 v[8:11], a[192:195], v[120:123], v[8:11]
    v_mfma_f32_16x16x32_bf16 v[12:15], a[196:199], v[120:123], v[12:15]
    s_waitcnt vmcnt(6)
    v_mfma_f32_16x16x32_bf16 v[8:11], a[200:203], v[124:127], v[8:11]
    v_mfma_f32_16x16x32_bf16 v[12:15], a[204:207], v[124:127], v[12:15]
    s_waitcnt vmcnt(5)
    v_mfma_f32_16x16x32_bf16 v[8:11], a[208:211], v[128:131], v[8:11]
    v_mfma_f32_16x16x32_bf16 v[12:15], a[212:215], v[128:131], v[12:15]
    s_waitcnt vmcnt(4)
    v_mfma_f32_16x16x32_bf16 v[8:11], a[216:219], v[132:135], v[8:11]
    v_mfma_f32_16x16x32_bf16 v[12:15], a[220:223], v[132:135], v[12:15]
    s_waitcnt vmcnt(3)
    v_mfma_f32_16x16x32_bf16 v[8:11], a[224:227], v[136:139], v[8:11]
    v_mfma_f32_16x16x32_bf16 v[12:15], a[228:231], v[136:139], v[12:15]
    s_waitcnt vmcnt(2)
    v_mfma_f32_16x16x32_bf16 v[8:11], a[232:235], v[140:143], v[8:11]
    v_mfma_f32_16x16x32_bf16 v[12:15], a[236:239], v[140:143], v[12:15]
    s_waitcnt vmcnt(1)
    v_mfma_f32_16x16x32_bf16 v[8:11], a[240:243], v[144:147], v[8:11]
    v_mfma_f32_16x16x32_bf16 v[12:15], a[244:247], v[144:147], v[12:15]
    s_waitcnt vmcnt(0)
    v_mfma_f32_16x16x32_bf16 v[8:11], a[248:251], v[148:151], v[8:11]
    v_mfma_f32_16x16x32_bf16 v[12:15], a[252:255], v[148:151], v[12:15]
    s_nop 6
    ds_write_b128 v2, v[8:11] offset:0
    ds_write_b128 v2, v[12:15] offset:1024
    s_cmp_lg_u32 s32, 0
    s_cbranch_scc1 o1_nb
    v_cmp_eq_u32 vcc, 0, v253
    s_nop 0
    s_cmp_eq_u64 vcc, 0
    s_cselect_b32 s44, 65536, 0
    v_or_b32 v250, s44, v250
    v_mov_b32 v251, 163832
    s_mov_b64 exec, 1
    ds_write_b32 v251, v250
    s_mov_b64 exec, -1
o1_nb:
    s_waitcnt lgkmcnt(0)
    s_barrier
    s_cmp_gt_u32 s32, 0
    s_cbranch_scc1 o1_skip
    s_lshl_b32 s18, s32, 13
    v_add_u32 v2, s18, v1
    ds_read_b128 v[24:27], v2 offset:0
    ds_read_b128 v[28:31], v2 offset:1024
    ds_read_b128 v[32:35], v2 offset:2048
    ds_read_b128 v[36:39], v2 offset:3072
    ds_read_b128 v[40:43], v2 offset:4096
    ds_read_b128 v[44:47], v2 offset:5120
    ds_read_b128 v[48:51], v2 offset:6144
    ds_read_b128 v[52:55], v2 offset:7168
    v_lshrrev_b32 v3, 4, v1
    v_bfe_u32 v4, v3, 2, 2
    v_lshlrev_b32 v4, 3, v4
    v_and_b32 v2, 3, v3
    v_add_u32 v4, v4, v2
    v_mul_u32_u24 v4, 2304, v4
    v_lshrrev_b32 v3, 4, v3
    v_lshl_add_u32 v4, v3, 4, v4
    s_add_u32 s20, s16, s32
    s_lshr_b32 s18, s20, 1
    s_lshl_b32 s18, s18, 3
    s_and_b32 s19, s20, 1
    s_add_u32 s18, s18, s19
    s_mul_i32 s18, s18, 9216
    s_lshl_b32 s19, s33, 6
    s_add_u32 s18, s18, s19
    s_waitcnt lgkmcnt(0)
    v_pk_add_f32 v[24:25], v[24:25], v[32:33]
    v_pk_add_f32 v[40:41], v[40:41], v[48:49]
    v_pk_add_f32 v[24:25], v[24:25], v[40:41]
    v_pk_add_f32 v[26:27], v[26:27], v[34:35]
    v_pk_add_f32 v[42:43], v[42:43], v[50:51]
    v_pk_add_f32 v[26:27], v[26:27], v[42:43]
    v_pk_add_f32 v[28:29], v[28:29], v[36:37]
    v_pk_add_f32 v[44:45], v[44:45], v[52:53]
    v_pk_add_f32 v[28:29], v[28:29], v[44:45]
    v_pk_add_f32 v[30:31], v[30:31], v[38:39]
    v_pk_add_f32 v[46:47], v[46:47], v[54:55]
    v_pk_add_f32 v[30:31], v[30:31], v[46:47]
    v_cvt_pk_bf16_f32 v8, v24, v28
    v_cvt_pk_bf16_f32 v9, v25, v29
    v_cvt_pk_bf16_f32 v10, v26, v30
    v_cvt_pk_bf16_f32 v11, v27, v31
    buffer_store_dwordx4 v[8:11], v4, s[8:11], s18 offen
o1_skip:
    s_nop 1
L_op_fin:
    v_mov_b32 v251, 163832
    ds_read_b32 v252, v251
    s_waitcnt lgkmcnt(0)
    v_readfirstlane_b32 s40, v252
    s_nop 1
    s_cmp_ge_u32 s40, 65608
    s_cbranch_scc1 L_done
    s_barrier
    s_and_b32 s16, s40, 0xffff
    s_cmp_lt_u32 s16, 72
    s_cbranch_scc1 L_op_seg
L_op_nextcb:
    s_mov_b32 s40, -1
    s_cmp_lg_u32 s32, 0
    s_cbranch_scc1 L_op_dec
    v_and_b32 v1, 63, v0
    v_min_u32 v1, 17, v1
    v_lshlrev_b32 v2, 2, v1
    buffer_load_dword v3, v2, s[84:87], 0 offen offset:136 sc1
    s_waitcnt vmcnt(0)
    v_cmp_gt_u32 vcc, 52, v3
    s_nop 0
    s_and_b32 s40, vcc_lo, 262143
    s_lshl_b32 s41, s40, 18
    s_lshr_b32 s43, s40, 14
    s_or_b32 s42, s40, s41
    s_and_b32 s36, s45, 15
    s_bfm_b32 s37, s36, 0
    s_and_b32 s37, s37, 42315
    s_bcnt1_i32_b32 s37, s37
    s_lshr_b32 s36, s45, 4
    s_mul_i32 s36, s36, 8
    s_add_u32 s36, s36, s37
    s_add_u32 s36, s36, 38
    s_mul_hi_u32 s41, s36, 0x0e38e38f
    s_mul_i32 s41, s41, 18
    s_sub_u32 s41, s36, s41
    s_lshr_b64 s[42:43], s[42:43], s41
    s_ff1_i32_b64 s40, s[42:43]
    s_cmp_lt_i32 s40, 0
    s_cbranch_scc1 L_op_dec
    s_add_u32 s40, s40, s41
    s_sub_u32 s41, s40, 18
    s_cselect_b32 s40, s40, s41
L_op_dec:
    v_mov_b32 v250, s40
    v_mov_b32 v251, 163832
    s_cmp_lg_u32 s32, 0
    s_cbranch_scc1 L_op_nw
    ds_write_b32 v251, v250
    s_waitcnt lgkmcnt(0)
L_op_nw:
    s_barrier
    ds_read_b32 v252, v251
    s_waitcnt lgkmcnt(0)
    v_readfirstlane_b32 s33, v252
    s_barrier
    s_nop 1
    s_cmp_lt_u32 s33, 18
    s_cbranch_scc1 L_op_start
L_done:
L_exit:
    s_endpgm
.section .rodata,"a"
.p2align 6
.amdhsa_kernel concat_heads__memory_aug_recurrent_mem_tr__ssm_conv_s4d__prompt_kernel
  .amdhsa_next_free_vgpr 512
  .amdhsa_next_free_sgpr 102
  .amdhsa_accum_offset 256
  .amdhsa_group_segment_fixed_size 0
  .amdhsa_kernarg_size 136
  .amdhsa_user_sgpr_count 2
  .amdhsa_user_sgpr_kernarg_segment_ptr 1
  .amdhsa_system_sgpr_workgroup_id_x 1
.end_amdhsa_kernel
.text
```

```asm
; @launch grid=(256,1,1) block=(256,1,1) lds=163840
.amdgcn_target "amdgcn-amd-amdhsa--gfx950"
.text
.globl concat_heads__memory_aug_recurrent_mem_tr__ssm_conv_s4d__prompt_kernel
.p2align 8
.type concat_heads__memory_aug_recurrent_mem_tr__ssm_conv_s4d__prompt_kernel,@function
concat_heads__memory_aug_recurrent_mem_tr__ssm_conv_s4d__prompt_kernel:
    s_cmp_ge_u32 s2, 256
    s_cbranch_scc1 L_exit
    s_load_dwordx4 s[80:83], s[0:1], 120
    s_load_dwordx16 s[48:63], s[0:1], 0
    s_memrealtime s[90:91]
    v_lshrrev_b32 v1, 6, v0
    s_nop 0
    v_readfirstlane_b32 s32, v1
    s_waitcnt lgkmcnt(0)
    s_mov_b32 s4, s82
    s_mov_b32 s5, s83
    s_mov_b32 s6, 268435456
    s_mov_b32 s7, 0x20000
    s_mov_b32 s84, s80
    s_mov_b32 s85, s81
    s_mov_b32 s86, 256
    s_mov_b32 s87, 0x20000
    s_cmp_lg_u32 s32, 0
    s_cbranch_scc1 L_nod0
L_nod0:
    s_cmp_lg_u32 s32, 3
    s_cbranch_scc1 L_nowarm
    s_getpc_b64 s[44:45]
L_pcw:
    v_and_b32 v1, 63, v0
    v_lshlrev_b32 v1, 7, v1
    v_min_u32 v2, L_exit-L_pcw, v1
    global_load_dword v240, v2, s[44:45]
    v_add_u32 v1, 8192, v1
    v_min_u32 v2, L_exit-L_pcw, v1
    global_load_dword v241, v2, s[44:45]
    v_add_u32 v1, 8192, v1
    v_min_u32 v2, L_exit-L_pcw, v1
    global_load_dword v242, v2, s[44:45]
    v_add_u32 v1, 8192, v1
    v_min_u32 v2, L_exit-L_pcw, v1
    global_load_dword v243, v2, s[44:45]
    v_add_u32 v1, 8192, v1
    v_min_u32 v2, L_exit-L_pcw, v1
    global_load_dword v244, v2, s[44:45]
    v_add_u32 v1, 8192, v1
    v_min_u32 v2, L_exit-L_pcw, v1
    global_load_dword v245, v2, s[44:45]
    v_add_u32 v1, 8192, v1
    v_min_u32 v2, L_exit-L_pcw, v1
    global_load_dword v246, v2, s[44:45]
    v_add_u32 v1, 8192, v1
    v_min_u32 v2, L_exit-L_pcw, v1
    global_load_dword v247, v2, s[44:45]
    v_add_u32 v1, 8192, v1
    v_min_u32 v2, L_exit-L_pcw, v1
    global_load_dword v248, v2, s[44:45]
    v_add_u32 v1, 8192, v1
L_nowarm:
    s_getreg_b32 s3, hwreg(HW_REG_XCC_ID)
    s_and_b32 s3, s3, 15
    s_cmp_lg_u32 s3, 3
    s_cbranch_scc1 L_helper
    s_mov_b32 s37, 128
    v_mov_b32 v250, 1
    v_mov_b32 v251, 163832
    v_cmp_eq_u32 vcc, 0, v0
    s_nop 0
    s_and_saveexec_b64 s[38:39], vcc
    s_cbranch_execz tk1
    buffer_atomic_add v250, off, s[84:87], s37 sc0
    s_waitcnt vmcnt(0)
    ds_write_b32 v251, v250
    s_waitcnt lgkmcnt(0)
tk1:
    s_mov_b64 exec, -1
    s_barrier
    ds_read_b32 v252, v251
    s_waitcnt lgkmcnt(0)
    v_readfirstlane_b32 s12, v252
    s_barrier
    s_nop 3
    s_cmp_ge_u32 s12, 32
    s_cbranch_scc1 L_helper
L_chain:
    s_load_dwordx8 s[48:55], s[0:1], 8
    s_load_dwordx2 s[56:57], s[0:1], 40
    s_waitcnt lgkmcnt(0)
    v_lshrrev_b32 v77, 6, v0
    s_nop 0
    v_readfirstlane_b32 s13, v77
    v_lshlrev_b32 v65, 4, v0
    v_and_b32 v48, 63, v0
    s_mov_b32 s10, 4718592
    s_mov_b32 s11, 0x20000
    v_lshrrev_b32 v49, 3, v48
    v_mul_u32_u24 v18, 1152, v49
    v_and_b32 v49, 7, v48
    v_lshl_add_u32 v18, v49, 4, v18
    s_mul_i32 s40, s12, 147456
    s_lshl_b32 s41, s13, 8
    s_add_u32 s40, s40, s41
    s_mov_b32 s42, s40
    s_xor_b32 s41, s13, 0
    s_mul_i32 s41, s41, 36864
    s_add_u32 s60, s41, s40
    s_xor_b32 s41, s13, 1
    s_mul_i32 s41, s41, 36864
    s_add_u32 s61, s41, s40
    s_xor_b32 s41, s13, 2
    s_mul_i32 s41, s41, 36864
    s_add_u32 s62, s41, s40
    s_xor_b32 s41, s13, 3
    s_mul_i32 s41, s41, 36864
    s_add_u32 s63, s41, s40
    s_lshl_b32 s43, s13, 12
    s_mov_b64 s[8:9], s[56:57]
    s_add_u32 m0, s43, 0
    s_add_u32 s41, s60, 0
    buffer_load_dwordx4 v18, s[8:11], s41 offen offset:0 nt lds
    s_add_u32 s41, s60, 8192
    buffer_load_dwordx4 v18, s[8:11], s41 offen offset:1024 nt lds
    s_add_u32 s41, s60, 16384
    buffer_load_dwordx4 v18, s[8:11], s41 offen offset:2048 nt lds
    s_add_u32 s41, s60, 24576
    buffer_load_dwordx4 v18, s[8:11], s41 offen offset:3072 nt lds
    s_add_u32 m0, s43, 36864
    s_add_u32 s41, s61, 0
    buffer_load_dwordx4 v18, s[8:11], s41 offen offset:0 nt lds
    s_add_u32 s41, s61, 8192
    buffer_load_dwordx4 v18, s[8:11], s41 offen offset:1024 nt lds
    s_add_u32 s41, s61, 16384
    buffer_load_dwordx4 v18, s[8:11], s41 offen offset:2048 nt lds
    s_add_u32 s41, s61, 24576
    buffer_load_dwordx4 v18, s[8:11], s41 offen offset:3072 nt lds
    s_add_u32 m0, s43, 73728
    s_add_u32 s41, s62, 0
    buffer_load_dwordx4 v18, s[8:11], s41 offen offset:0 nt lds
    s_add_u32 s41, s62, 8192
    buffer_load_dwordx4 v18, s[8:11], s41 offen offset:1024 nt lds
    s_add_u32 s41, s62, 16384
    buffer_load_dwordx4 v18, s[8:11], s41 offen offset:2048 nt lds
    s_add_u32 s41, s62, 24576
    buffer_load_dwordx4 v18, s[8:11], s41 offen offset:3072 nt lds
    s_add_u32 m0, s43, 110592
    s_add_u32 s41, s63, 0
    buffer_load_dwordx4 v18, s[8:11], s41 offen offset:0 nt lds
    s_add_u32 s41, s63, 8192
    buffer_load_dwordx4 v18, s[8:11], s41 offen offset:1024 nt lds
    s_add_u32 s41, s63, 16384
    buffer_load_dwordx4 v18, s[8:11], s41 offen offset:2048 nt lds
    s_add_u32 s41, s63, 24576
    buffer_load_dwordx4 v18, s[8:11], s41 offen offset:3072 nt lds
    v_lshrrev_b32 v49, 1, v48
    v_mul_u32_u24 v19, 1152, v49
    v_and_b32 v49, 1, v48
    v_lshl_add_u32 v19, v49, 4, v19
    s_mul_i32 s41, s13, 224
    s_sub_u32 s41, 1024, s41
    v_add_u32 v19, s41, v19
    v_lshrrev_b32 v49, 4, v48
    v_lshlrev_b32 v50, 2, v49
    v_and_b32 v51, 15, v48
    v_xor_b32 v51, v51, v50
    v_lshlrev_b32 v51, 4, v51
    v_lshl_add_u32 v16, v49, 15, v51
    v_lshrrev_b32 v50, 1, v49
    v_lshl_add_u32 v17, v50, 16, v51
    v_and_b32 v50, 1, v49
    v_lshl_add_u32 v17, v50, 13, v17
    s_lshl_b32 s40, s12, 8
    s_mul_i32 s58, s13, 1048576
    s_add_u32 s58, s58, s40
    s_lshr_b32 s41, s13, 1
    s_mul_i32 s59, s41, 262144
    s_and_b32 s41, s13, 1
    s_lshl_b32 s41, s41, 14
    s_add_u32 s59, s59, s41
    s_add_u32 s59, s59, s40
    s_add_u32 s59, s59, 4194304
    v_bfe_u32 v50, v48, 2, 2
    v_xor_b32 v51, s13, v50
    v_lshlrev_b32 v20, 6, v51
    v_and_b32 v51, 3, v48
    v_lshl_add_u32 v20, v51, 4, v20
    v_lshrrev_b32 v23, 2, v48
    v_lshl_add_u32 v20, v23, 8, v20
    s_xor_b32 s41, s43, 0
    v_add_u32 v24, s41, v20
    s_xor_b32 s41, s43, 4096
    v_add_u32 v25, s41, v20
    s_xor_b32 s41, s43, 8192
    v_add_u32 v26, s41, v20
    s_xor_b32 s41, s43, 12288
    v_add_u32 v27, s41, v20
    v_and_b32 v23, 1, v50
    v_lshl_add_u32 v23, v49, 2, v23
    v_lshrrev_b32 v50, 1, v50
    v_lshlrev_b32 v21, 7, v23
    v_lshl_add_u32 v21, v50, 6, v21
    v_lshrrev_b32 v16, 1, v51
    v_lshl_add_u32 v21, v16, 5, v21
    v_and_b32 v16, 1, v51
    v_lshl_add_u32 v21, v16, 3, v21
    v_add_u32 v21, s43, v21
    v_lshlrev_b32 v22, 9, v50
    v_xor_b32 v22, v22, v21
    v_lshlrev_b32 v23, 5, v23
    v_lshl_add_u32 v23, v50, 10, v23
    v_lshl_add_u32 v23, v51, 3, v23
    v_add_u32 v23, s43, v23
    v_bfe_u32 v60, v65, 4, 6
    v_and_b32 v61, 15, v60
    v_lshrrev_b32 v62, 4, v60
    v_mov_b32 v64, 0x4444
    v_mov_b32 v77, 0xeeee
    v_cmp_lt_u32 vcc, 7, v61
    s_nop 1
    v_cndmask_b32 v64, v64, v77, vcc
    v_xor_b32 v66, 1024, v65
    v_xor_b32 v67, 2048, v65
    v_xor_b32 v68, 3072, v65
    v_and_b32 v69, 511, v65
    s_mul_i32 s96, s13, 36864
    s_add_u32 s96, s96, 16384
    v_lshlrev_b32 v70, 4, v60
    v_add_u32 v70, s96, v70
    v_lshrrev_b32 v79, 1, v69
    s_lshl_b32 s96, s13, 8
    s_add_u32 s96, s96, 14336
    s_lshl_b32 s33, s13, 10
    s_add_u32 s97, s33, 8192
    v_mov_b32 v77, s97
    v_mov_b32 v78, s96
    v_cmp_lt_u32 vcc, 31, v60
    s_nop 1
    v_cndmask_b32 v71, v77, v78, vcc
    v_add_u32 v71, v71, v79
    v_and_b32 v77, 7, v61
    v_lshrrev_b32 v78, 3, v61
    v_lshlrev_b32 v74, 4, v77
    v_lshl_add_u32 v73, v62, 7, v74
    v_lshl_add_u32 v73, v78, 3, v73
    s_lshl_b32 s96, s13, 9
    v_add_u32 v73, s96, v73
    v_lshrrev_b32 v74, 1, v74
    v_lshl_add_u32 v74, v78, 14, v74
    v_lshl_add_u32 v74, v62, 15, v74
    s_lshl_b32 s96, s13, 17
    v_add_u32 v74, s96, v74
    v_bfe_u32 v77, v61, 2, 1
    v_and_b32 v78, 3, v61
    s_cmp_lt_u32 s13, 2
    s_cselect_b64 vcc, -1, 0
    v_cndmask_b32 v77, 0, v77, vcc
    v_lshlrev_b32 v75, 7, v77
    v_lshl_add_u32 v75, v62, 4, v75
    v_lshl_add_u32 v75, v78, 2, v75
    v_lshlrev_b32 v58, 3, v77
    v_lshl_add_u32 v58, v78, 1, v58
    s_bfe_u32 s97, s12, 0x10001
    s_lshl_b32 s68, s97, 6
    s_lshl_b32 s97, s97, 2
    v_add_u32 v59, s97, v62
    s_bfe_u32 s96, s12, 0x10002
    s_and_b32 s40, s12, 1
    s_lshl_b32 s96, s96, 1
    s_add_u32 s96, s96, s40
    s_lshr_b32 s97, s12, 3
    s_lshl_b32 s98, s13, 2
    s_add_u32 s98, s98, s97
    s_lshl_b32 s98, s98, 2
    s_add_u32 s98, s98, s96
    s_lshl_b32 s98, s98, 8
    s_lshl_b32 s99, s13, 2
    s_add_u32 s99, s99, s96
    s_lshl_b32 s99, s99, 4
    s_lshl_b32 s41, s97, 1
    s_add_u32 s41, s41, s40
    s_lshl_b32 s41, s41, 7
    s_add_u32 s41, s41, 8192
    s_lshl_b32 s40, s40, 3
    s_add_u32 s40, s40, 512
    s_cmp_lt_u32 s13, 2
    s_cselect_b32 s96, 7, 4
    s_cselect_b32 s98, s98, s41
    s_cselect_b32 s99, s99, s40
    s_cselect_b32 s32, 1, 0
    s_add_u32 s68, s68, s98
    s_lshl_b32 s97, s97, s96
    s_add_u32 s99, s99, s97
    v_add_u32 v58, s99, v58
    s_and_b32 s97, s12, 4
    s_or_b32 s97, s97, s13
    s_cmp_eq_u32 s97, 2
    s_cselect_b32 s32, 2, s32
    s_mov_b32 s8, s48
    s_mov_b32 s9, s49
    s_mov_b32 s10, 9216
    v_mul_u32_u24 v77, 1152, v59
    v_lshl_add_u32 v77, v58, 1, v77
    buffer_load_dword v72, v77, s[8:11], 0 offen
    s_mov_b32 s10, 4718592
    s_waitcnt vmcnt(12) lgkmcnt(0)
    s_barrier
    s_mov_b64 s[8:9], s[56:57]
    s_add_u32 m0, s43, 147456
    s_add_u32 s41, s42, 0
    buffer_load_dwordx4 v19, s[8:11], s41 offen offset:0 nt lds
    s_add_u32 s41, s42, 35840
    buffer_load_dwordx4 v19, s[8:11], s41 offen offset:1024 nt lds
    s_add_u32 s41, s42, 71680
    buffer_load_dwordx4 v19, s[8:11], s41 offen offset:2048 nt lds
    s_add_u32 s41, s42, 107520
    buffer_load_dwordx4 v19, s[8:11], s41 offen offset:3072 nt lds
    v_mov_b32 v78, v21
    v_mov_b32 v79, v22
    v_add_u32 v77, 0, v79
    ds_read_b64_tr_b16 v[80:81], v77 offset:0
    ds_read_b64_tr_b16 v[82:83], v77 offset:256
    ds_read_b64_tr_b16 v[84:85], v77 offset:2048
    ds_read_b64_tr_b16 v[86:87], v77 offset:2304
    ds_read_b64_tr_b16 v[112:113], v77 offset:16
    ds_read_b64_tr_b16 v[114:115], v77 offset:272
    ds_read_b64_tr_b16 v[116:117], v77 offset:2064
    ds_read_b64_tr_b16 v[118:119], v77 offset:2320
    s_waitcnt vmcnt(12) lgkmcnt(0)
    s_barrier
    s_mov_b64 s[8:9], s[52:53]
    s_add_u32 m0, s43, 0
    s_add_u32 s41, s58, 0
    buffer_load_dwordx4 v17, s[8:11], s41 offen offset:0 nt lds
    s_add_u32 s41, s58, 31744
    buffer_load_dwordx4 v17, s[8:11], s41 offen offset:1024 nt lds
    s_add_u32 s41, s58, 129024
    buffer_load_dwordx4 v17, s[8:11], s41 offen offset:2048 nt lds
    s_add_u32 s41, s58, 160768
    buffer_load_dwordx4 v17, s[8:11], s41 offen offset:3072 nt lds
    v_add_u32 v77, 36864, v78
    ds_read_b64_tr_b16 v[88:89], v77 offset:0
    ds_read_b64_tr_b16 v[90:91], v77 offset:256
    ds_read_b64_tr_b16 v[92:93], v77 offset:2048
    ds_read_b64_tr_b16 v[94:95], v77 offset:2304
    ds_read_b64_tr_b16 v[120:121], v77 offset:16
    ds_read_b64_tr_b16 v[122:123], v77 offset:272
    ds_read_b64_tr_b16 v[124:125], v77 offset:2064
    ds_read_b64_tr_b16 v[126:127], v77 offset:2320
    s_waitcnt vmcnt(12) lgkmcnt(0)
    s_barrier
    s_add_u32 m0, s43, 36864
    s_add_u32 s41, s58, 16384
    buffer_load_dwordx4 v17, s[8:11], s41 offen offset:0 nt lds
    s_add_u32 s41, s58, 48128
    buffer_load_dwordx4 v17, s[8:11], s41 offen offset:1024 nt lds
    s_add_u32 s41, s58, 145408
    buffer_load_dwordx4 v17, s[8:11], s41 offen offset:2048 nt lds
    s_add_u32 s41, s58, 177152
    buffer_load_dwordx4 v17, s[8:11], s41 offen offset:3072 nt lds
    v_add_u32 v77, 73728, v78
    ds_read_b64_tr_b16 v[96:97], v77 offset:0
    ds_read_b64_tr_b16 v[98:99], v77 offset:256
    ds_read_b64_tr_b16 v[100:101], v77 offset:2048
    ds_read_b64_tr_b16 v[102:103], v77 offset:2304
    ds_read_b64_tr_b16 v[128:129], v77 offset:16
    ds_read_b64_tr_b16 v[130:131], v77 offset:272
    ds_read_b64_tr_b16 v[132:133], v77 offset:2064
    ds_read_b64_tr_b16 v[134:135], v77 offset:2320
    s_waitcnt vmcnt(12) lgkmcnt(0)
    s_barrier
    s_add_u32 m0, s43, 73728
    s_add_u32 s41, s58, 262144
    buffer_load_dwordx4 v17, s[8:11], s41 offen offset:0 nt lds
    s_add_u32 s41, s58, 293888
    buffer_load_dwordx4 v17, s[8:11], s41 offen offset:1024 nt lds
    s_add_u32 s41, s58, 391168
    buffer_load_dwordx4 v17, s[8:11], s41 offen offset:2048 nt lds
    s_add_u32 s41, s58, 422912
    buffer_load_dwordx4 v17, s[8:11], s41 offen offset:3072 nt lds
    v_add_u32 v77, 110592, v78
    ds_read_b64_tr_b16 v[104:105], v77 offset:0
    ds_read_b64_tr_b16 v[106:107], v77 offset:256
    ds_read_b64_tr_b16 v[108:109], v77 offset:2048
    ds_read_b64_tr_b16 v[110:111], v77 offset:2304
    ds_read_b64_tr_b16 v[136:137], v77 offset:16
    ds_read_b64_tr_b16 v[138:139], v77 offset:272
    ds_read_b64_tr_b16 v[140:141], v77 offset:2064
    ds_read_b64_tr_b16 v[142:143], v77 offset:2320
    s_waitcnt vmcnt(12) lgkmcnt(0)
    s_barrier
    s_add_u32 m0, s43, 110592
    s_add_u32 s41, s58, 278528
    buffer_load_dwordx4 v17, s[8:11], s41 offen offset:0 nt lds
    s_add_u32 s41, s58, 310272
    buffer_load_dwordx4 v17, s[8:11], s41 offen offset:1024 nt lds
    s_add_u32 s41, s58, 407552
    buffer_load_dwordx4 v17, s[8:11], s41 offen offset:2048 nt lds
    s_add_u32 s41, s58, 439296
    buffer_load_dwordx4 v17, s[8:11], s41 offen offset:3072 nt lds
    v_add_u32 v77, 147456, v23
    ds_read_b64_tr_b16 v[0:1], v77 offset:0
    ds_read_b64_tr_b16 v[2:3], v77 offset:64
    ds_read_b64_tr_b16 v[4:5], v77 offset:512
    ds_read_b64_tr_b16 v[6:7], v77 offset:576
    ds_read_b64_tr_b16 v[8:9], v77 offset:2048
    ds_read_b64_tr_b16 v[10:11], v77 offset:2112
    ds_read_b64_tr_b16 v[12:13], v77 offset:2560
    ds_read_b64_tr_b16 v[14:15], v77 offset:2624
    s_waitcnt vmcnt(12) lgkmcnt(0)
    s_barrier
    s_add_u32 m0, s43, 147456
    s_add_u32 s41, s58, 524288
    buffer_load_dwordx4 v17, s[8:11], s41 offen offset:0 nt lds
    s_add_u32 s41, s58, 556032
    buffer_load_dwordx4 v17, s[8:11], s41 offen offset:1024 nt lds
    s_add_u32 s41, s58, 653312
    buffer_load_dwordx4 v17, s[8:11], s41 offen offset:2048 nt lds
    s_add_u32 s41, s58, 685056
    buffer_load_dwordx4 v17, s[8:11], s41 offen offset:3072 nt lds
    s_cmp_eq_u32 s32, 0
    s_cbranch_scc1 cf_init_done
    v_mov_b32 v52, 1
    v_mov_b32 v53, 1
    v_mov_b32 v54, 1
    v_mov_b32 v55, 1
    v_mov_b32 v56, 0
    s_lshl_b32 s96, s12, 14
    s_add_u32 s96, s96, 68157440
    s_add_u32 s97, s96, 0
    buffer_store_dwordx4 v[52:55], v65, s[4:7], s97 offen
    buffer_load_dwordx4 v[60:63], v65, s[4:7], s97 offen sc1
    s_add_u32 s97, s96, 4096
    buffer_store_dwordx4 v[52:55], v65, s[4:7], s97 offen
    buffer_load_dwordx4 v[60:63], v65, s[4:7], s97 offen sc1
    s_add_u32 s97, s96, 8192
    buffer_store_dwordx4 v[52:55], v65, s[4:7], s97 offen
    buffer_load_dwordx4 v[60:63], v65, s[4:7], s97 offen sc1
    s_add_u32 s97, s96, 12288
    buffer_store_dwordx4 v[52:55], v65, s[4:7], s97 offen
    buffer_load_dwordx4 v[60:63], v65, s[4:7], s97 offen sc1
    s_add_u32 s96, s68, 67108864
    s_add_u32 s97, s96, 16384
    buffer_store_dword v56, v75, s[4:7], s96 offen offset:0
    buffer_store_dword v72, v75, s[4:7], s97 offen offset:0
    buffer_load_dword v60, v75, s[4:7], s96 offen offset:0 sc1
    buffer_load_dword v60, v75, s[4:7], s97 offen offset:0 sc1
    s_cmp_lg_u32 s32, 2
    s_cbranch_scc1 cf_init_done
    buffer_store_dword v56, v75, s[4:7], s96 offen offset:1024
    buffer_store_dword v72, v75, s[4:7], s97 offen offset:1024
    buffer_load_dword v60, v75, s[4:7], s96 offen offset:1024 sc1
    buffer_load_dword v60, v75, s[4:7], s97 offen offset:1024 sc1
    buffer_store_dword v56, v75, s[4:7], s96 offen offset:2048
    buffer_store_dword v72, v75, s[4:7], s97 offen offset:2048
    buffer_load_dword v60, v75, s[4:7], s96 offen offset:2048 sc1
    buffer_load_dword v60, v75, s[4:7], s97 offen offset:2048 sc1
    buffer_store_dword v56, v75, s[4:7], s96 offen offset:3072
    buffer_store_dword v72, v75, s[4:7], s97 offen offset:3072
    buffer_load_dword v60, v75, s[4:7], s96 offen offset:3072 sc1
    buffer_load_dword v60, v75, s[4:7], s97 offen offset:3072 sc1
cf_init_done:
    ds_write_b64 v70, v[0:1] offset:16384
    ds_write_b64 v70, v[2:3] offset:16392
    ds_write_b64 v70, v[4:5] offset:17408
    ds_write_b64 v70, v[6:7] offset:17416
    ds_write_b64 v70, v[8:9] offset:18432
    ds_write_b64 v70, v[10:11] offset:18440
    ds_write_b64 v70, v[12:13] offset:19456
    ds_write_b64 v70, v[14:15] offset:19464
    v_add_u32 v28, 0, v24
    v_add_u32 v29, 0, v25
    v_add_u32 v30, 0, v26
    v_add_u32 v31, 0, v27
    ds_read_b64_tr_b16 a[96:97], v28 offset:0
    ds_read_b64_tr_b16 a[104:105], v28 offset:8
    ds_read_b64_tr_b16 a[112:113], v29 offset:0
    ds_read_b64_tr_b16 a[120:121], v29 offset:8
    ds_read_b64_tr_b16 a[128:129], v30 offset:0
    ds_read_b64_tr_b16 a[136:137], v30 offset:8
    ds_read_b64_tr_b16 a[144:145], v31 offset:0
    ds_read_b64_tr_b16 v[32:33], v31 offset:8
    s_waitcnt vmcnt(12) lgkmcnt(0)
    s_barrier
    s_add_u32 m0, s43, 0
    s_add_u32 s41, s58, 540672
    buffer_load_dwordx4 v17, s[8:11], s41 offen offset:0 nt lds
    s_add_u32 s41, s58, 572416
    buffer_load_dwordx4 v17, s[8:11], s41 offen offset:1024 nt lds
    s_add_u32 s41, s58, 669696
    buffer_load_dwordx4 v17, s[8:11], s41 offen offset:2048 nt lds
    s_add_u32 s41, s58, 701440
    buffer_load_dwordx4 v17, s[8:11], s41 offen offset:3072 nt lds
    ds_write_b64 v70, v[32:33] offset:12288
    v_add_u32 v28, 36864, v24
    v_add_u32 v29, 36864, v25
    v_add_u32 v30, 36864, v26
    v_add_u32 v31, 36864, v27
    ds_read_b64_tr_b16 a[98:99], v28 offset:0
    ds_read_b64_tr_b16 a[106:107], v28 offset:8
    ds_read_b64_tr_b16 a[114:115], v29 offset:0
    ds_read_b64_tr_b16 a[122:123], v29 offset:8
    ds_read_b64_tr_b16 a[130:131], v30 offset:0
    ds_read_b64_tr_b16 a[138:139], v30 offset:8
    ds_read_b64_tr_b16 a[146:147], v31 offset:0
    ds_read_b64_tr_b16 v[0:1], v31 offset:8
    s_waitcnt vmcnt(12) lgkmcnt(0)
    s_barrier
    s_add_u32 m0, s43, 36864
    s_add_u32 s41, s58, 786432
    buffer_load_dwordx4 v17, s[8:11], s41 offen offset:0 nt lds
    s_add_u32 s41, s58, 818176
    buffer_load_dwordx4 v17, s[8:11], s41 offen offset:1024 nt lds
    s_add_u32 s41, s58, 915456
    buffer_load_dwordx4 v17, s[8:11], s41 offen offset:2048 nt lds
    s_add_u32 s41, s58, 947200
    buffer_load_dwordx4 v17, s[8:11], s41 offen offset:3072 nt lds
    ds_write_b64 v70, v[0:1] offset:12296
    v_add_u32 v28, 73728, v24
    v_add_u32 v29, 73728, v25
    v_add_u32 v30, 73728, v26
    v_add_u32 v31, 73728, v27
    ds_read_b64_tr_b16 a[100:101], v28 offset:0
    ds_read_b64_tr_b16 a[108:109], v28 offset:8
    ds_read_b64_tr_b16 a[116:117], v29 offset:0
    ds_read_b64_tr_b16 a[124:125], v29 offset:8
    ds_read_b64_tr_b16 a[132:133], v30 offset:0
    ds_read_b64_tr_b16 a[140:141], v30 offset:8
    ds_read_b64_tr_b16 a[148:149], v31 offset:0
    ds_read_b64_tr_b16 v[32:33], v31 offset:8
    s_waitcnt vmcnt(12) lgkmcnt(0)
    s_barrier
    s_add_u32 m0, s43, 73728
    s_add_u32 s41, s58, 802816
    buffer_load_dwordx4 v17, s[8:11], s41 offen offset:0 nt lds
    s_add_u32 s41, s58, 834560
    buffer_load_dwordx4 v17, s[8:11], s41 offen offset:1024 nt lds
    s_add_u32 s41, s58, 931840
    buffer_load_dwordx4 v17, s[8:11], s41 offen offset:2048 nt lds
    s_add_u32 s41, s58, 963584
    buffer_load_dwordx4 v17, s[8:11], s41 offen offset:3072 nt lds
    ds_write_b64 v70, v[32:33] offset:13312
    v_add_u32 v28, 110592, v24
    v_add_u32 v29, 110592, v25
    v_add_u32 v30, 110592, v26
    v_add_u32 v31, 110592, v27
    ds_read_b64_tr_b16 a[102:103], v28 offset:0
    ds_read_b64_tr_b16 a[110:111], v28 offset:8
    ds_read_b64_tr_b16 a[118:119], v29 offset:0
    ds_read_b64_tr_b16 a[126:127], v29 offset:8
    ds_read_b64_tr_b16 a[134:135], v30 offset:0
    ds_read_b64_tr_b16 a[142:143], v30 offset:8
    ds_read_b64_tr_b16 a[150:151], v31 offset:0
    ds_read_b64_tr_b16 v[0:1], v31 offset:8
    s_waitcnt vmcnt(12) lgkmcnt(0)
    s_barrier
    s_add_u32 m0, s43, 110592
    s_add_u32 s41, s59, 0
    buffer_load_dwordx4 v17, s[8:11], s41 offen offset:0 nt lds
    s_add_u32 s41, s59, 31744
    buffer_load_dwordx4 v17, s[8:11], s41 offen offset:1024 nt lds
    s_add_u32 s41, s59, 129024
    buffer_load_dwordx4 v17, s[8:11], s41 offen offset:2048 nt lds
    s_add_u32 s41, s59, 160768
    buffer_load_dwordx4 v17, s[8:11], s41 offen offset:3072 nt lds
    ds_write_b64 v70, v[0:1] offset:13320
    v_add_u32 v28, 147456, v24
    v_add_u32 v29, 147456, v25
    v_add_u32 v30, 147456, v26
    v_add_u32 v31, 147456, v27
    ds_read_b64_tr_b16 a[152:153], v28 offset:0
    ds_read_b64_tr_b16 a[160:161], v28 offset:8
    ds_read_b64_tr_b16 a[168:169], v29 offset:0
    ds_read_b64_tr_b16 a[176:177], v29 offset:8
    ds_read_b64_tr_b16 a[184:185], v30 offset:0
    ds_read_b64_tr_b16 a[192:193], v30 offset:8
    ds_read_b64_tr_b16 a[200:201], v31 offset:0
    ds_read_b64_tr_b16 a[208:209], v31 offset:8
    s_waitcnt vmcnt(12) lgkmcnt(0)
    s_barrier
    s_mov_b64 s[8:9], s[50:51]
    s_add_u32 m0, s43, 147456
    s_add_u32 s41, s58, 0
    buffer_load_dwordx4 v17, s[8:11], s41 offen offset:0 nt lds
    s_add_u32 s41, s58, 31744
    buffer_load_dwordx4 v17, s[8:11], s41 offen offset:1024 nt lds
    s_add_u32 s41, s58, 129024
    buffer_load_dwordx4 v17, s[8:11], s41 offen offset:2048 nt lds
    s_add_u32 s41, s58, 160768
    buffer_load_dwordx4 v17, s[8:11], s41 offen offset:3072 nt lds
    s_cmp_lg_u32 s13, 0
    s_cbranch_scc1 cf_ma
    v_mov_b32 v54, 1
    s_mov_b64 exec, 1
    buffer_atomic_add v54, off, s[84:87], 0 offset:132
    s_mov_b64 exec, -1
cf_ma:
    v_add_u32 v28, 0, v24
    v_add_u32 v29, 0, v25
    v_add_u32 v30, 0, v26
    v_add_u32 v31, 0, v27
    ds_read_b64_tr_b16 a[154:155], v28 offset:0
    ds_read_b64_tr_b16 a[162:163], v28 offset:8
    ds_read_b64_tr_b16 a[170:171], v29 offset:0
    ds_read_b64_tr_b16 a[178:179], v29 offset:8
    ds_read_b64_tr_b16 a[186:187], v30 offset:0
    ds_read_b64_tr_b16 a[194:195], v30 offset:8
    ds_read_b64_tr_b16 a[202:203], v31 offset:0
    ds_read_b64_tr_b16 a[210:211], v31 offset:8
    s_waitcnt vmcnt(12) lgkmcnt(0)
    s_barrier
    s_add_u32 m0, s43, 0
    s_add_u32 s41, s58, 16384
    buffer_load_dwordx4 v17, s[8:11], s41 offen offset:0 nt lds
    s_add_u32 s41, s58, 48128
    buffer_load_dwordx4 v17, s[8:11], s41 offen offset:1024 nt lds
    s_add_u32 s41, s58, 145408
    buffer_load_dwordx4 v17, s[8:11], s41 offen offset:2048 nt lds
    s_add_u32 s41, s58, 177152
    buffer_load_dwordx4 v17, s[8:11], s41 offen offset:3072 nt lds
    v_add_u32 v28, 36864, v24
    v_add_u32 v29, 36864, v25
    v_add_u32 v30, 36864, v26
    v_add_u32 v31, 36864, v27
    ds_read_b64_tr_b16 a[156:157], v28 offset:0
    ds_read_b64_tr_b16 a[164:165], v28 offset:8
    ds_read_b64_tr_b16 a[172:173], v29 offset:0
    ds_read_b64_tr_b16 a[180:181], v29 offset:8
    ds_read_b64_tr_b16 a[188:189], v30 offset:0
    ds_read_b64_tr_b16 a[196:197], v30 offset:8
    ds_read_b64_tr_b16 a[204:205], v31 offset:0
    ds_read_b64_tr_b16 a[212:213], v31 offset:8
    s_waitcnt vmcnt(12) lgkmcnt(0)
    s_barrier
    s_add_u32 m0, s43, 36864
    s_add_u32 s41, s58, 262144
    buffer_load_dwordx4 v17, s[8:11], s41 offen offset:0 nt lds
    s_add_u32 s41, s58, 293888
    buffer_load_dwordx4 v17, s[8:11], s41 offen offset:1024 nt lds
    s_add_u32 s41, s58, 391168
    buffer_load_dwordx4 v17, s[8:11], s41 offen offset:2048 nt lds
    s_add_u32 s41, s58, 422912
    buffer_load_dwordx4 v17, s[8:11], s41 offen offset:3072 nt lds
    v_add_u32 v28, 73728, v24
    v_add_u32 v29, 73728, v25
    v_add_u32 v30, 73728, v26
    v_add_u32 v31, 73728, v27
    ds_read_b64_tr_b16 a[158:159], v28 offset:0
    ds_read_b64_tr_b16 a[166:167], v28 offset:8
    ds_read_b64_tr_b16 a[174:175], v29 offset:0
    ds_read_b64_tr_b16 a[182:183], v29 offset:8
    ds_read_b64_tr_b16 a[190:191], v30 offset:0
    ds_read_b64_tr_b16 a[198:199], v30 offset:8
    ds_read_b64_tr_b16 a[206:207], v31 offset:0
    ds_read_b64_tr_b16 a[214:215], v31 offset:8
    s_waitcnt vmcnt(12) lgkmcnt(0)
    s_barrier
    s_add_u32 m0, s43, 73728
    s_add_u32 s41, s58, 278528
    buffer_load_dwordx4 v17, s[8:11], s41 offen offset:0 nt lds
    s_add_u32 s41, s58, 310272
    buffer_load_dwordx4 v17, s[8:11], s41 offen offset:1024 nt lds
    s_add_u32 s41, s58, 407552
    buffer_load_dwordx4 v17, s[8:11], s41 offen offset:2048 nt lds
    s_add_u32 s41, s58, 439296
    buffer_load_dwordx4 v17, s[8:11], s41 offen offset:3072 nt lds
    v_add_u32 v77, 110592, v20
    ds_read_b64_tr_b16 a[216:217], v77 offset:0
    ds_read_b64_tr_b16 a[218:219], v77 offset:4096
    ds_read_b64_tr_b16 a[220:221], v77 offset:8192
    ds_read_b64_tr_b16 a[222:223], v77 offset:12288
    ds_read_b64_tr_b16 a[224:225], v77 offset:8
    ds_read_b64_tr_b16 a[226:227], v77 offset:4104
    ds_read_b64_tr_b16 a[228:229], v77 offset:8200
    ds_read_b64_tr_b16 a[230:231], v77 offset:12296
    s_waitcnt vmcnt(12) lgkmcnt(0)
    s_barrier
    s_add_u32 m0, s43, 110592
    s_add_u32 s41, s58, 524288
    buffer_load_dwordx4 v17, s[8:11], s41 offen offset:0 nt lds
    s_add_u32 s41, s58, 556032
    buffer_load_dwordx4 v17, s[8:11], s41 offen offset:1024 nt lds
    s_add_u32 s41, s58, 653312
    buffer_load_dwordx4 v17, s[8:11], s41 offen offset:2048 nt lds
    s_add_u32 s41, s58, 685056
    buffer_load_dwordx4 v17, s[8:11], s41 offen offset:3072 nt lds
    v_add_u32 v28, 147456, v24
    v_add_u32 v29, 147456, v25
    v_add_u32 v30, 147456, v26
    v_add_u32 v31, 147456, v27
    ds_read_b64_tr_b16 v[0:1], v28 offset:0
    ds_read_b64_tr_b16 v[2:3], v28 offset:8
    ds_read_b64_tr_b16 v[4:5], v29 offset:0
    ds_read_b64_tr_b16 v[6:7], v29 offset:8
    ds_read_b64_tr_b16 a[0:1], v30 offset:0
    ds_read_b64_tr_b16 v[8:9], v30 offset:8
    ds_read_b64_tr_b16 a[8:9], v31 offset:0
    ds_read_b64_tr_b16 v[10:11], v31 offset:8
    s_waitcnt vmcnt(12) lgkmcnt(0)
    s_barrier
    s_add_u32 m0, s43, 147456
    s_add_u32 s41, s58, 540672
    buffer_load_dwordx4 v17, s[8:11], s41 offen offset:0 nt lds
    s_add_u32 s41, s58, 572416
    buffer_load_dwordx4 v17, s[8:11], s41 offen offset:1024 nt lds
    s_add_u32 s41, s58, 669696
    buffer_load_dwordx4 v17, s[8:11], s41 offen offset:2048 nt lds
    s_add_u32 s41, s58, 701440
    buffer_load_dwordx4 v17, s[8:11], s41 offen offset:3072 nt lds
    ds_write_b64 v70, v[0:1] offset:0
    ds_write_b64 v70, v[2:3] offset:2048
    ds_write_b64 v70, v[4:5] offset:4096
    ds_write_b64 v70, v[6:7] offset:6144
    ds_write_b64 v70, v[8:9] offset:10240
    ds_write_b64 v70, v[10:11] offset:14336
    v_add_u32 v28, 0, v24
    v_add_u32 v29, 0, v25
    v_add_u32 v30, 0, v26
    v_add_u32 v31, 0, v27
    ds_read_b64_tr_b16 v[32:33], v28 offset:0
    ds_read_b64_tr_b16 v[34:35], v28 offset:8
    ds_read_b64_tr_b16 v[36:37], v29 offset:0
    ds_read_b64_tr_b16 v[38:39], v29 offset:8
    ds_read_b64_tr_b16 a[2:3], v30 offset:0
    ds_read_b64_tr_b16 v[40:41], v30 offset:8
    ds_read_b64_tr_b16 a[10:11], v31 offset:0
    ds_read_b64_tr_b16 v[42:43], v31 offset:8
    s_waitcnt vmcnt(12) lgkmcnt(0)
    s_barrier
    s_add_u32 m0, s43, 0
    s_add_u32 s41, s58, 786432
    buffer_load_dwordx4 v17, s[8:11], s41 offen offset:0 nt lds
    s_add_u32 s41, s58, 818176
    buffer_load_dwordx4 v17, s[8:11], s41 offen offset:1024 nt lds
    s_add_u32 s41, s58, 915456
    buffer_load_dwordx4 v17, s[8:11], s41 offen offset:2048 nt lds
    s_add_u32 s41, s58, 947200
    buffer_load_dwordx4 v17, s[8:11], s41 offen offset:3072 nt lds
    ds_write_b64 v70, v[32:33] offset:8
    ds_write_b64 v70, v[34:35] offset:2056
    ds_write_b64 v70, v[36:37] offset:4104
    ds_write_b64 v70, v[38:39] offset:6152
    ds_write_b64 v70, v[40:41] offset:10248
    ds_write_b64 v70, v[42:43] offset:14344
    v_add_u32 v28, 36864, v24
    v_add_u32 v29, 36864, v25
    v_add_u32 v30, 36864, v26
    v_add_u32 v31, 36864, v27
    ds_read_b64_tr_b16 v[0:1], v28 offset:0
    ds_read_b64_tr_b16 v[2:3], v28 offset:8
    ds_read_b64_tr_b16 v[4:5], v29 offset:0
    ds_read_b64_tr_b16 v[6:7], v29 offset:8
    ds_read_b64_tr_b16 a[4:5], v30 offset:0
    ds_read_b64_tr_b16 v[8:9], v30 offset:8
    ds_read_b64_tr_b16 a[12:13], v31 offset:0
    ds_read_b64_tr_b16 v[10:11], v31 offset:8
    s_waitcnt vmcnt(12) lgkmcnt(0)
    s_barrier
    s_add_u32 m0, s43, 36864
    s_add_u32 s41, s58, 802816
    buffer_load_dwordx4 v17, s[8:11], s41 offen offset:0 nt lds
    s_add_u32 s41, s58, 834560
    buffer_load_dwordx4 v17, s[8:11], s41 offen offset:1024 nt lds
    s_add_u32 s41, s58, 931840
    buffer_load_dwordx4 v17, s[8:11], s41 offen offset:2048 nt lds
    s_add_u32 s41, s58, 963584
    buffer_load_dwordx4 v17, s[8:11], s41 offen offset:3072 nt lds
    ds_write_b64 v70, v[0:1] offset:1024
    ds_write_b64 v70, v[2:3] offset:3072
    ds_write_b64 v70, v[4:5] offset:5120
    ds_write_b64 v70, v[6:7] offset:7168
    ds_write_b64 v70, v[8:9] offset:11264
    ds_write_b64 v70, v[10:11] offset:15360
    v_add_u32 v28, 73728, v24
    v_add_u32 v29, 73728, v25
    v_add_u32 v30, 73728, v26
    v_add_u32 v31, 73728, v27
    ds_read_b64_tr_b16 v[32:33], v28 offset:0
    ds_read_b64_tr_b16 v[34:35], v28 offset:8
    ds_read_b64_tr_b16 v[36:37], v29 offset:0
    ds_read_b64_tr_b16 v[38:39], v29 offset:8
    ds_read_b64_tr_b16 a[6:7], v30 offset:0
    ds_read_b64_tr_b16 v[40:41], v30 offset:8
    ds_read_b64_tr_b16 a[14:15], v31 offset:0
    ds_read_b64_tr_b16 v[42:43], v31 offset:8
    s_waitcnt vmcnt(12) lgkmcnt(0)
    s_barrier
    s_add_u32 m0, s43, 73728
    s_add_u32 s41, s59, 0
    buffer_load_dwordx4 v17, s[8:11], s41 offen offset:0 nt lds
    s_add_u32 s41, s59, 31744
    buffer_load_dwordx4 v17, s[8:11], s41 offen offset:1024 nt lds
    s_add_u32 s41, s59, 129024
    buffer_load_dwordx4 v17, s[8:11], s41 offen offset:2048 nt lds
    s_add_u32 s41, s59, 160768
    buffer_load_dwordx4 v17, s[8:11], s41 offen offset:3072 nt lds
    ds_write_b64 v70, v[32:33] offset:1032
    ds_write_b64 v70, v[34:35] offset:3080
    ds_write_b64 v70, v[36:37] offset:5128
    ds_write_b64 v70, v[38:39] offset:7176
    ds_write_b64 v70, v[40:41] offset:11272
    ds_write_b64 v70, v[42:43] offset:15368
    v_add_u32 v28, 110592, v24
    v_add_u32 v29, 110592, v25
    v_add_u32 v30, 110592, v26
    v_add_u32 v31, 110592, v27
    ds_read_b64_tr_b16 a[16:17], v28 offset:0
    ds_read_b64_tr_b16 a[24:25], v28 offset:8
    ds_read_b64_tr_b16 a[32:33], v29 offset:0
    ds_read_b64_tr_b16 a[40:41], v29 offset:8
    ds_read_b64_tr_b16 a[48:49], v30 offset:0
    ds_read_b64_tr_b16 a[56:57], v30 offset:8
    ds_read_b64_tr_b16 a[64:65], v31 offset:0
    ds_read_b64_tr_b16 a[72:73], v31 offset:8
    s_waitcnt vmcnt(12) lgkmcnt(0)
    s_barrier
    s_mov_b64 s[8:9], s[54:55]
    s_add_u32 m0, s43, 110592
    s_add_u32 s41, s58, 0
    buffer_load_dwordx4 v17, s[8:11], s41 offen offset:0 nt lds
    s_add_u32 s41, s58, 31744
    buffer_load_dwordx4 v17, s[8:11], s41 offen offset:1024 nt lds
    s_add_u32 s41, s58, 129024
    buffer_load_dwordx4 v17, s[8:11], s41 offen offset:2048 nt lds
    s_add_u32 s41, s58, 160768
    buffer_load_dwordx4 v17, s[8:11], s41 offen offset:3072 nt lds
    v_add_u32 v28, 147456, v24
    v_add_u32 v29, 147456, v25
    v_add_u32 v30, 147456, v26
    v_add_u32 v31, 147456, v27
    ds_read_b64_tr_b16 a[18:19], v28 offset:0
    ds_read_b64_tr_b16 a[26:27], v28 offset:8
    ds_read_b64_tr_b16 a[34:35], v29 offset:0
    ds_read_b64_tr_b16 a[42:43], v29 offset:8
    ds_read_b64_tr_b16 a[50:51], v30 offset:0
    ds_read_b64_tr_b16 a[58:59], v30 offset:8
    ds_read_b64_tr_b16 a[66:67], v31 offset:0
    ds_read_b64_tr_b16 a[74:75], v31 offset:8
    s_waitcnt vmcnt(12) lgkmcnt(0)
    s_barrier
    s_add_u32 m0, s43, 147456
    s_add_u32 s41, s58, 16384
    buffer_load_dwordx4 v17, s[8:11], s41 offen offset:0 nt lds
    s_add_u32 s41, s58, 48128
    buffer_load_dwordx4 v17, s[8:11], s41 offen offset:1024 nt lds
    s_add_u32 s41, s58, 145408
    buffer_load_dwordx4 v17, s[8:11], s41 offen offset:2048 nt lds
    s_add_u32 s41, s58, 177152
    buffer_load_dwordx4 v17, s[8:11], s41 offen offset:3072 nt lds
    v_add_u32 v28, 0, v24
    v_add_u32 v29, 0, v25
    v_add_u32 v30, 0, v26
    v_add_u32 v31, 0, v27
    ds_read_b64_tr_b16 a[20:21], v28 offset:0
    ds_read_b64_tr_b16 a[28:29], v28 offset:8
    ds_read_b64_tr_b16 a[36:37], v29 offset:0
    ds_read_b64_tr_b16 a[44:45], v29 offset:8
    ds_read_b64_tr_b16 a[52:53], v30 offset:0
    ds_read_b64_tr_b16 a[60:61], v30 offset:8
    ds_read_b64_tr_b16 a[68:69], v31 offset:0
    ds_read_b64_tr_b16 a[76:77], v31 offset:8
    s_waitcnt vmcnt(12) lgkmcnt(0)
    s_barrier
    s_add_u32 m0, s43, 0
    s_add_u32 s41, s58, 262144
    buffer_load_dwordx4 v17, s[8:11], s41 offen offset:0 nt lds
    s_add_u32 s41, s58, 293888
    buffer_load_dwordx4 v17, s[8:11], s41 offen offset:1024 nt lds
    s_add_u32 s41, s58, 391168
    buffer_load_dwordx4 v17, s[8:11], s41 offen offset:2048 nt lds
    s_add_u32 s41, s58, 422912
    buffer_load_dwordx4 v17, s[8:11], s41 offen offset:3072 nt lds
    v_add_u32 v28, 36864, v24
    v_add_u32 v29, 36864, v25
    v_add_u32 v30, 36864, v26
    v_add_u32 v31, 36864, v27
    ds_read_b64_tr_b16 a[22:23], v28 offset:0
    ds_read_b64_tr_b16 a[30:31], v28 offset:8
    ds_read_b64_tr_b16 a[38:39], v29 offset:0
    ds_read_b64_tr_b16 a[46:47], v29 offset:8
    ds_read_b64_tr_b16 a[54:55], v30 offset:0
    ds_read_b64_tr_b16 a[62:63], v30 offset:8
    ds_read_b64_tr_b16 a[70:71], v31 offset:0
    ds_read_b64_tr_b16 a[78:79], v31 offset:8
    s_waitcnt vmcnt(12) lgkmcnt(0)
    s_barrier
    s_add_u32 m0, s43, 36864
    s_add_u32 s41, s58, 278528
    buffer_load_dwordx4 v17, s[8:11], s41 offen offset:0 nt lds
    s_add_u32 s41, s58, 310272
    buffer_load_dwordx4 v17, s[8:11], s41 offen offset:1024 nt lds
    s_add_u32 s41, s58, 407552
    buffer_load_dwordx4 v17, s[8:11], s41 offen offset:2048 nt lds
    s_add_u32 s41, s58, 439296
    buffer_load_dwordx4 v17, s[8:11], s41 offen offset:3072 nt lds
    s_lshl_b32 s26, s12, 14
    s_add_u32 s26, s26, 0
    s_mul_i32 s40, s13, 3072
    s_add_u32 s24, s26, s40
    s_lshl_b32 s96, s12, 7
    s_add_u32 s29, s96, 125845504
    s_add_u32 s96, s96, 125829120
    v_bfe_u32 v78, v65, 2, 5
    buffer_load_dword v54, off, s[84:87], 0 offset:132 sc1
    buffer_load_dword v55, off, s[84:87], 0 offset:216 sc1
    buffer_load_dword v56, v78, s[4:7], s96 offen offset:16 sc1
    v_add_u32 v77, 73728, v20
    ds_read_b64_tr_b16 a[80:81], v77 offset:0
    ds_read_b64_tr_b16 a[82:83], v77 offset:4096
    ds_read_b64_tr_b16 a[84:85], v77 offset:8192
    ds_read_b64_tr_b16 a[86:87], v77 offset:12288
    ds_read_b64_tr_b16 a[88:89], v77 offset:8
    ds_read_b64_tr_b16 a[90:91], v77 offset:4104
    ds_read_b64_tr_b16 a[92:93], v77 offset:8200
    ds_read_b64_tr_b16 a[94:95], v77 offset:12296
    s_waitcnt vmcnt(12) lgkmcnt(0)
    s_barrier
    s_add_u32 m0, s43, 73728
    s_add_u32 s41, s58, 524288
    buffer_load_dwordx4 v17, s[8:11], s41 offen offset:0 nt lds
    s_add_u32 s41, s58, 556032
    buffer_load_dwordx4 v17, s[8:11], s41 offen offset:1024 nt lds
    s_add_u32 s41, s58, 653312
    buffer_load_dwordx4 v17, s[8:11], s41 offen offset:2048 nt lds
    s_add_u32 s41, s58, 685056
    buffer_load_dwordx4 v17, s[8:11], s41 offen offset:3072 nt lds
    v_add_u32 v28, 110592, v24
    v_add_u32 v29, 110592, v25
    v_add_u32 v30, 110592, v26
    v_add_u32 v31, 110592, v27
    ds_read_b64_tr_b16 a[232:233], v28 offset:0
    ds_read_b64_tr_b16 v[32:33], v28 offset:8
    ds_read_b64_tr_b16 a[240:241], v29 offset:0
    ds_read_b64_tr_b16 a[248:249], v29 offset:8
    ds_read_b64_tr_b16 v[144:145], v30 offset:0
    ds_read_b64_tr_b16 v[152:153], v30 offset:8
    ds_read_b64_tr_b16 v[160:161], v31 offset:0
    ds_read_b64_tr_b16 v[168:169], v31 offset:8
    s_waitcnt vmcnt(12) lgkmcnt(0)
    s_barrier
    s_add_u32 m0, s43, 110592
    s_add_u32 s41, s58, 540672
    buffer_load_dwordx4 v17, s[8:11], s41 offen offset:0 nt lds
    s_add_u32 s41, s58, 572416
    buffer_load_dwordx4 v17, s[8:11], s41 offen offset:1024 nt lds
    s_add_u32 s41, s58, 669696
    buffer_load_dwordx4 v17, s[8:11], s41 offen offset:2048 nt lds
    s_add_u32 s41, s58, 701440
    buffer_load_dwordx4 v17, s[8:11], s41 offen offset:3072 nt lds
    ds_write_b64 v70, v[32:33] offset:8192
    v_add_u32 v28, 147456, v24
    v_add_u32 v29, 147456, v25
    v_add_u32 v30, 147456, v26
    v_add_u32 v31, 147456, v27
    ds_read_b64_tr_b16 a[234:235], v28 offset:0
    ds_read_b64_tr_b16 v[0:1], v28 offset:8
    ds_read_b64_tr_b16 a[242:243], v29 offset:0
    ds_read_b64_tr_b16 a[250:251], v29 offset:8
    ds_read_b64_tr_b16 v[146:147], v30 offset:0
    ds_read_b64_tr_b16 v[154:155], v30 offset:8
    ds_read_b64_tr_b16 v[162:163], v31 offset:0
    ds_read_b64_tr_b16 v[170:171], v31 offset:8
    s_waitcnt vmcnt(12) lgkmcnt(0)
    s_barrier
    s_add_u32 m0, s43, 147456
    s_add_u32 s41, s58, 786432
    buffer_load_dwordx4 v17, s[8:11], s41 offen offset:0 nt lds
    s_add_u32 s41, s58, 818176
    buffer_load_dwordx4 v17, s[8:11], s41 offen offset:1024 nt lds
    s_add_u32 s41, s58, 915456
    buffer_load_dwordx4 v17, s[8:11], s41 offen offset:2048 nt lds
    s_add_u32 s41, s58, 947200
    buffer_load_dwordx4 v17, s[8:11], s41 offen offset:3072 nt lds
    ds_write_b64 v70, v[0:1] offset:8200
    v_add_u32 v28, 0, v24
    v_add_u32 v29, 0, v25
    v_add_u32 v30, 0, v26
    v_add_u32 v31, 0, v27
    ds_read_b64_tr_b16 a[236:237], v28 offset:0
    ds_read_b64_tr_b16 v[32:33], v28 offset:8
    ds_read_b64_tr_b16 a[244:245], v29 offset:0
    ds_read_b64_tr_b16 a[252:253], v29 offset:8
    ds_read_b64_tr_b16 v[148:149], v30 offset:0
    ds_read_b64_tr_b16 v[156:157], v30 offset:8
    ds_read_b64_tr_b16 v[164:165], v31 offset:0
    ds_read_b64_tr_b16 v[172:173], v31 offset:8
    s_waitcnt vmcnt(12) lgkmcnt(0)
    s_barrier
    s_add_u32 m0, s43, 0
    s_add_u32 s41, s58, 802816
    buffer_load_dwordx4 v17, s[8:11], s41 offen offset:0 nt lds
    s_add_u32 s41, s58, 834560
    buffer_load_dwordx4 v17, s[8:11], s41 offen offset:1024 nt lds
    s_add_u32 s41, s58, 931840
    buffer_load_dwordx4 v17, s[8:11], s41 offen offset:2048 nt lds
    s_add_u32 s41, s58, 963584
    buffer_load_dwordx4 v17, s[8:11], s41 offen offset:3072 nt lds
    ds_write_b64 v70, v[32:33] offset:9216
    v_add_u32 v28, 36864, v24
    v_add_u32 v29, 36864, v25
    v_add_u32 v30, 36864, v26
    v_add_u32 v31, 36864, v27
    ds_read_b64_tr_b16 a[238:239], v28 offset:0
    ds_read_b64_tr_b16 v[0:1], v28 offset:8
    ds_read_b64_tr_b16 a[246:247], v29 offset:0
    ds_read_b64_tr_b16 a[254:255], v29 offset:8
    ds_read_b64_tr_b16 v[150:151], v30 offset:0
    ds_read_b64_tr_b16 v[158:159], v30 offset:8
    ds_read_b64_tr_b16 v[166:167], v31 offset:0
    ds_read_b64_tr_b16 v[174:175], v31 offset:8
    s_waitcnt vmcnt(12) lgkmcnt(0)
    s_barrier
    s_add_u32 m0, s43, 36864
    s_add_u32 s41, s59, 0
    buffer_load_dwordx4 v17, s[8:11], s41 offen offset:0 nt lds
    s_add_u32 s41, s59, 31744
    buffer_load_dwordx4 v17, s[8:11], s41 offen offset:1024 nt lds
    s_add_u32 s41, s59, 129024
    buffer_load_dwordx4 v17, s[8:11], s41 offen offset:2048 nt lds
    s_add_u32 s41, s59, 160768
    buffer_load_dwordx4 v17, s[8:11], s41 offen offset:3072 nt lds
    v_readfirstlane_b32 s94, v54
    v_readfirstlane_b32 s95, v55
    v_mov_b32 v77, v56
    s_nop 0
    v_subrev_u32 v77, s95, v77
    v_cmp_lt_u32 vcc, 16, v77
    s_nop 1
    v_cndmask_b32 v77, v77, 0, vcc
    v_bfe_u32 v79, v78, 2, 2
    v_lshl_add_u32 v77, v77, 2, v79
    s_nop 1
    v_min_u32_dpp v77, v77, v77 row_ror:1 row_mask:0xf bank_mask:0xf
    s_nop 1
    v_min_u32_dpp v77, v77, v77 row_ror:2 row_mask:0xf bank_mask:0xf
    s_nop 1
    v_min_u32_dpp v77, v77, v77 row_ror:4 row_mask:0xf bank_mask:0xf
    s_nop 0
    v_readfirstlane_b32 s97, v77
    s_cmp_eq_u32 s95, 0
    s_cselect_b32 s97, 0, s97
    s_cmp_lt_u32 s97, 3
    s_cbranch_scc1 cf_mb
    s_add_u32 s40, s24, 0
    s_add_u32 s40, s40, s33
    s_sub_u32 s41, s96, s40
    v_bfe_u32 v77, v65, 2, 5
    v_add3_u32 v77, v77, s41, 16
    v_lshlrev_b32 v78, 3, v69
    s_nop 0
    v_mov_b32_dpp v78, v77 quad_perm:[0,1,2,3] row_mask:0xc bank_mask:0xf
    buffer_load_dword v58, v78, s[4:7], s40 offen sc1
    s_add_u32 s40, s24, 524288
    s_add_u32 s40, s40, s33
    s_sub_u32 s41, s96, s40
    v_bfe_u32 v77, v65, 2, 5
    v_add3_u32 v77, v77, s41, 16
    v_lshlrev_b32 v78, 3, v69
    s_nop 0
    v_mov_b32_dpp v78, v77 quad_perm:[0,1,2,3] row_mask:0xc bank_mask:0xf
    buffer_load_dword v58, v78, s[4:7], s40 offen sc1
cf_mb:
    s_cmp_lt_u32 s94, 32
    s_cbranch_scc1 cf_mc
    s_cmp_lg_u32 s13, 0
    s_cbranch_scc1 cf_mc
    v_mov_b32 v76, 1
    v_mov_b32 v77, 0
    s_mov_b64 exec, 1
    buffer_atomic_cmpswap v[76:77], off, s[84:87], 0 offset:28 sc0
    s_mov_b64 exec, -1
cf_mc:
    s_nop 1
    ds_write_b64 v70, v[0:1] offset:9224
    v_add_u32 v28, 73728, v24
    v_add_u32 v29, 73728, v25
    v_add_u32 v30, 73728, v26
    v_add_u32 v31, 73728, v27
    ds_read_b64_tr_b16 v[176:177], v28 offset:0
    ds_read_b64_tr_b16 v[184:185], v28 offset:8
    ds_read_b64_tr_b16 v[192:193], v29 offset:0
    ds_read_b64_tr_b16 v[200:201], v29 offset:8
    ds_read_b64_tr_b16 v[208:209], v30 offset:0
    ds_read_b64_tr_b16 v[216:217], v30 offset:8
    ds_read_b64_tr_b16 v[224:225], v31 offset:0
    ds_read_b64_tr_b16 v[232:233], v31 offset:8
    s_waitcnt vmcnt(12) lgkmcnt(0)
    s_barrier
    s_mov_b64 s[8:9], s[56:57]
    s_add_u32 m0, s43, 73728
    s_add_u32 s41, s60, 128
    buffer_load_dwordx4 v18, s[8:11], s41 offen offset:0 nt lds
    s_add_u32 s41, s60, 8320
    buffer_load_dwordx4 v18, s[8:11], s41 offen offset:1024 nt lds
    s_add_u32 s41, s60, 16512
    buffer_load_dwordx4 v18, s[8:11], s41 offen offset:2048 nt lds
    s_add_u32 s41, s60, 24704
    buffer_load_dwordx4 v18, s[8:11], s41 offen offset:3072 nt lds
    v_add_u32 v28, 110592, v24
    v_add_u32 v29, 110592, v25
    v_add_u32 v30, 110592, v26
    v_add_u32 v31, 110592, v27
    ds_read_b64_tr_b16 v[178:179], v28 offset:0
    ds_read_b64_tr_b16 v[186:187], v28 offset:8
    ds_read_b64_tr_b16 v[194:195], v29 offset:0
    ds_read_b64_tr_b16 v[202:203], v29 offset:8
    ds_read_b64_tr_b16 v[210:211], v30 offset:0
    ds_read_b64_tr_b16 v[218:219], v30 offset:8
    ds_read_b64_tr_b16 v[226:227], v31 offset:0
    ds_read_b64_tr_b16 v[234:235], v31 offset:8
    s_waitcnt vmcnt(12) lgkmcnt(0)
    s_barrier
    s_add_u32 m0, s43, 110592
    s_add_u32 s41, s61, 128
    buffer_load_dwordx4 v18, s[8:11], s41 offen offset:0 nt lds
    s_add_u32 s41, s61, 8320
    buffer_load_dwordx4 v18, s[8:11], s41 offen offset:1024 nt lds
    s_add_u32 s41, s61, 16512
    buffer_load_dwordx4 v18, s[8:11], s41 offen offset:2048 nt lds
    s_add_u32 s41, s61, 24704
    buffer_load_dwordx4 v18, s[8:11], s41 offen offset:3072 nt lds
    v_add_u32 v28, 147456, v24
    v_add_u32 v29, 147456, v25
    v_add_u32 v30, 147456, v26
    v_add_u32 v31, 147456, v27
    ds_read_b64_tr_b16 v[180:181], v28 offset:0
    ds_read_b64_tr_b16 v[188:189], v28 offset:8
    ds_read_b64_tr_b16 v[196:197], v29 offset:0
    ds_read_b64_tr_b16 v[204:205], v29 offset:8
    ds_read_b64_tr_b16 v[212:213], v30 offset:0
    ds_read_b64_tr_b16 v[220:221], v30 offset:8
    ds_read_b64_tr_b16 v[228:229], v31 offset:0
    ds_read_b64_tr_b16 v[236:237], v31 offset:8
    s_waitcnt vmcnt(12) lgkmcnt(0)
    s_barrier
    s_add_u32 m0, s43, 147456
    s_add_u32 s41, s62, 128
    buffer_load_dwordx4 v18, s[8:11], s41 offen offset:0 nt lds
    s_add_u32 s41, s62, 8320
    buffer_load_dwordx4 v18, s[8:11], s41 offen offset:1024 nt lds
    s_add_u32 s41, s62, 16512
    buffer_load_dwordx4 v18, s[8:11], s41 offen offset:2048 nt lds
    s_add_u32 s41, s62, 24704
    buffer_load_dwordx4 v18, s[8:11], s41 offen offset:3072 nt lds
    v_add_u32 v28, 0, v24
    v_add_u32 v29, 0, v25
    v_add_u32 v30, 0, v26
    v_add_u32 v31, 0, v27
    ds_read_b64_tr_b16 v[182:183], v28 offset:0
    ds_read_b64_tr_b16 v[190:191], v28 offset:8
    ds_read_b64_tr_b16 v[198:199], v29 offset:0
    ds_read_b64_tr_b16 v[206:207], v29 offset:8
    ds_read_b64_tr_b16 v[214:215], v30 offset:0
    ds_read_b64_tr_b16 v[222:223], v30 offset:8
    ds_read_b64_tr_b16 v[230:231], v31 offset:0
    ds_read_b64_tr_b16 v[238:239], v31 offset:8
    s_waitcnt vmcnt(12) lgkmcnt(0)
    s_barrier
    s_add_u32 m0, s43, 0
    s_add_u32 s41, s63, 128
    buffer_load_dwordx4 v18, s[8:11], s41 offen offset:0 nt lds
    s_add_u32 s41, s63, 8320
    buffer_load_dwordx4 v18, s[8:11], s41 offen offset:1024 nt lds
    s_add_u32 s41, s63, 16512
    buffer_load_dwordx4 v18, s[8:11], s41 offen offset:2048 nt lds
    s_add_u32 s41, s63, 24704
    buffer_load_dwordx4 v18, s[8:11], s41 offen offset:3072 nt lds
    v_mov_b32 v78, v21
    v_mov_b32 v79, v22
    v_add_u32 v77, 36864, v20
    ds_read_b64_tr_b16 v[240:241], v77 offset:0
    ds_read_b64_tr_b16 v[242:243], v77 offset:4096
    ds_read_b64_tr_b16 v[244:245], v77 offset:8192
    ds_read_b64_tr_b16 v[246:247], v77 offset:12288
    ds_read_b64_tr_b16 v[248:249], v77 offset:8
    ds_read_b64_tr_b16 v[250:251], v77 offset:4104
    ds_read_b64_tr_b16 v[252:253], v77 offset:8200
    ds_read_b64_tr_b16 v[254:255], v77 offset:12296
    s_waitcnt vmcnt(12) lgkmcnt(0)
    s_barrier
    v_add_u32 v77, 73728, v79
    s_waitcnt lgkmcnt(0)
    ds_read_b64_tr_b16 v[0:1], v77 offset:0
    ds_read_b64_tr_b16 v[2:3], v77 offset:256
    ds_read_b64_tr_b16 v[4:5], v77 offset:2048
    ds_read_b64_tr_b16 v[6:7], v77 offset:2304
    ds_read_b64_tr_b16 v[8:9], v77 offset:16
    ds_read_b64_tr_b16 v[10:11], v77 offset:272
    ds_read_b64_tr_b16 v[12:13], v77 offset:2064
    ds_read_b64_tr_b16 v[14:15], v77 offset:2320
    s_waitcnt vmcnt(8) lgkmcnt(0)
    s_barrier
    v_add_u32 v77, 110592, v78
    ds_read_b64_tr_b16 v[16:17], v77 offset:0
    ds_read_b64_tr_b16 v[18:19], v77 offset:256
    ds_read_b64_tr_b16 v[20:21], v77 offset:2048
    ds_read_b64_tr_b16 v[22:23], v77 offset:2304
    ds_read_b64_tr_b16 v[24:25], v77 offset:16
    ds_read_b64_tr_b16 v[26:27], v77 offset:272
    ds_read_b64_tr_b16 v[28:29], v77 offset:2064
    ds_read_b64_tr_b16 v[30:31], v77 offset:2320
    s_waitcnt vmcnt(4) lgkmcnt(0)
    s_barrier
    v_add_u32 v77, 147456, v78
    ds_read_b64_tr_b16 v[32:33], v77 offset:0
    ds_read_b64_tr_b16 v[34:35], v77 offset:256
    ds_read_b64_tr_b16 v[36:37], v77 offset:2048
    ds_read_b64_tr_b16 v[38:39], v77 offset:2304
    ds_read_b64_tr_b16 v[40:41], v77 offset:16
    ds_read_b64_tr_b16 v[42:43], v77 offset:272
    ds_read_b64_tr_b16 v[44:45], v77 offset:2064
    ds_read_b64_tr_b16 v[46:47], v77 offset:2320
    s_waitcnt vmcnt(0) lgkmcnt(0)
    s_barrier
    v_add_u32 v77, 0, v78
    ds_read_b64_tr_b16 v[48:49], v77 offset:0
    ds_read_b64_tr_b16 v[50:51], v77 offset:256
    ds_read_b64_tr_b16 v[52:53], v77 offset:2048
    ds_read_b64_tr_b16 v[54:55], v77 offset:2304
    ds_read_b64_tr_b16 v[56:57], v77 offset:16
    ds_read_b64_tr_b16 v[58:59], v77 offset:272
    ds_read_b64_tr_b16 v[60:61], v77 offset:2064
    ds_read_b64_tr_b16 v[62:63], v77 offset:2320
    s_waitcnt lgkmcnt(0)
    s_barrier
    ds_write_b128 v70, v[0:3] offset:20480
    ds_write_b128 v70, v[4:7] offset:21504
    ds_write_b128 v70, v[8:11] offset:22528
    ds_write_b128 v70, v[12:15] offset:23552
    ds_write_b128 v70, v[16:19] offset:24576
    ds_write_b128 v70, v[20:23] offset:25600
    ds_write_b128 v70, v[24:27] offset:26624
    ds_write_b128 v70, v[28:31] offset:27648
    ds_write_b128 v70, v[32:35] offset:28672
    ds_write_b128 v70, v[36:39] offset:29696
    ds_write_b128 v70, v[40:43] offset:30720
    ds_write_b128 v70, v[44:47] offset:31744
    ds_write_b128 v70, v[48:51] offset:32768
    ds_write_b128 v70, v[52:55] offset:33792
    ds_write_b128 v70, v[56:59] offset:34816
    ds_write_b128 v70, v[60:63] offset:35840
    s_waitcnt lgkmcnt(0)
    v_bfe_u32 v60, v65, 4, 6
    v_and_b32 v61, 15, v60
    v_lshrrev_b32 v62, 4, v60
    v_mov_b32 v50, 0x3f80
    v_mov_b32 v51, 0x3f800000
    v_and_b32 v77, 1, v62
    v_lshlrev_b32 v77, 2, v77
    v_sub_u32 v77, v61, v77
    v_and_b32 v78, 3, v61
    v_lshlrev_b32 v78, 2, v78
    v_lshrrev_b32 v79, 2, v61
    v_add_u32 v78, v78, v79
    v_cmp_eq_u32 vcc, 0, v77
    s_nop 1
    v_cndmask_b32 v8, 0, v50, vcc
    v_cmp_eq_u32 vcc, 1, v77
    s_nop 1
    v_cndmask_b32 v8, v8, v51, vcc
    v_cmp_eq_u32 vcc, 0, v78
    s_nop 1
    v_cndmask_b32 v12, 0, v50, vcc
    v_cmp_eq_u32 vcc, 1, v78
    s_nop 1
    v_cndmask_b32 v12, v12, v51, vcc
    v_cmp_eq_u32 vcc, 2, v77
    s_nop 1
    v_cndmask_b32 v9, 0, v50, vcc
    v_cmp_eq_u32 vcc, 3, v77
    s_nop 1
    v_cndmask_b32 v9, v9, v51, vcc
    v_cmp_eq_u32 vcc, 2, v78
    s_nop 1
    v_cndmask_b32 v13, 0, v50, vcc
    v_cmp_eq_u32 vcc, 3, v78
    s_nop 1
    v_cndmask_b32 v13, v13, v51, vcc
    v_cmp_eq_u32 vcc, 8, v77
    s_nop 1
    v_cndmask_b32 v10, 0, v50, vcc
    v_cmp_eq_u32 vcc, 9, v77
    s_nop 1
    v_cndmask_b32 v10, v10, v51, vcc
    v_cmp_eq_u32 vcc, 4, v78
    s_nop 1
    v_cndmask_b32 v14, 0, v50, vcc
    v_cmp_eq_u32 vcc, 5, v78
    s_nop 1
    v_cndmask_b32 v14, v14, v51, vcc
    v_cmp_eq_u32 vcc, 10, v77
    s_nop 1
    v_cndmask_b32 v11, 0, v50, vcc
    v_cmp_eq_u32 vcc, 11, v77
    s_nop 1
    v_cndmask_b32 v11, v11, v51, vcc
    v_cmp_eq_u32 vcc, 6, v78
    s_nop 1
    v_cndmask_b32 v15, 0, v50, vcc
    v_cmp_eq_u32 vcc, 7, v78
    s_nop 1
    v_cndmask_b32 v15, v15, v51, vcc
    v_lshlrev_b32 v77, 4, v61
    ds_write_b128 v69, v[8:11] offset:15360
    ds_write_b128 v77, v[12:15] offset:15872
    s_waitcnt vmcnt(0) lgkmcnt(0)
    s_cmp_lg_u32 s95, 0
    s_cbranch_scc1 cf_hn
    s_mov_b32 s88, 4194304
gn2:
    buffer_load_dword v2, off, s[84:87], 0 offset:216 sc1
    s_waitcnt vmcnt(0)
    v_readfirstlane_b32 s95, v2
    s_sub_u32 s88, s88, 1
    s_cbranch_scc1 gn2x
    s_cmp_eq_u32 s95, 0
    s_cbranch_scc1 gn2
gn2x:
cf_hn:
    v_mov_b32 v2, 1
    s_cmp_lg_u32 s13, 0
    s_cbranch_scc1 cf_noarr
    s_mov_b64 exec, 1
    s_mov_b32 s42, 1
    v_mov_b32 v4, v76
    s_cmp_ge_u32 s94, 32
    s_cbranch_scc1 cf_have
    s_mov_b32 s40, 131072
    s_mov_b32 s42, 2
cf_startpoll:
    buffer_load_dword v3, off, s[84:87], 0 offset:132 sc1
    s_sub_u32 s40, s40, 1
    s_cbranch_scc1 cf_decide
    s_waitcnt vmcnt(0)
    v_readfirstlane_b32 s41, v3
    s_nop 1
    s_cmp_lt_u32 s41, 32
    s_cbranch_scc1 cf_startpoll
    s_mov_b32 s42, 1
cf_decide:
    v_mov_b32 v4, s42
    v_mov_b32 v5, 0
    buffer_atomic_cmpswap v[4:5], off, s[84:87], 0 offset:28 sc0
    s_waitcnt vmcnt(0)
cf_have:
    v_mov_b32 v5, s42
    v_cmp_eq_u32 vcc, 0, v4
    s_nop 1
    v_cndmask_b32 v4, v4, v5, vcc
    v_mov_b32 v5, 16192
    ds_write_b32 v5, v4
    s_waitcnt lgkmcnt(0)
    s_mov_b64 exec, -1
cf_noarr:
    s_barrier
    v_mov_b32 v5, 16192
    ds_read_b32 v4, v5
    s_waitcnt lgkmcnt(0)
    v_readfirstlane_b32 s41, v4
    s_nop 1
    s_cmp_eq_u32 s41, 1
    s_cbranch_scc1 cf_run
    v_lshrrev_b32 v0, 4, v65
    s_mov_b32 s32, s13
    s_load_dwordx16 s[48:63], s[0:1], 0
    s_waitcnt lgkmcnt(0)
    s_branch L_helper
cf_run:
    s_mov_b32 s44, 0x3e0293ee
    s_mov_b32 s45, s44
    s_or_b32 s66, s44, 0x80000000
    s_mov_b32 s48, 0x3f003f00
    s_mov_b32 s49, 0
    s_mov_b32 s50, 0x3f803f80
    s_mov_b32 s51, 0x3f803f80
    s_mov_b32 s52, 512
    s_mov_b32 s53, 1024
    s_mov_b32 s54, 1536
    s_mov_b32 s30, 0
    s_mov_b32 s37, 0
    s_mov_b32 s98, -100
    s_lshl_b32 s47, s13, 9
    s_cmp_lg_u32 s32, 0
    s_cselect_b32 s71, s13, 3
    s_add_u32 s46, s71, 1
    s_lshr_b32 s46, s46, 1
    s_mov_b32 s14, 67125248
    s_mov_b32 s15, 67129344
    s_mov_b32 s16, 67133440
    s_mov_b32 s36, 0
    s_add_u32 s17, s68, 67108864
    s_mov_b32 s69, 0
    s_mov_b32 s70, 0
    s_lshl_b32 s26, s12, 14
    s_add_u32 s26, s26, 0
    s_mul_i32 s40, s13, 3072
    s_add_u32 s24, s26, s40
    s_lshl_b32 s96, s12, 7
    s_add_u32 s29, s96, 125845504
    s_add_u32 s96, s96, 125829120
    s_lshl_b32 s40, s12, 14
    s_add_u32 s40, s40, 68157440
    s_add_u32 s18, s40, 0
    s_add_u32 s19, s40, 4096
    s_add_u32 s20, s40, 8192
    s_add_u32 s21, s40, 12288
    s_lshr_b32 s40, s12, 3
    s_lshl_b32 s40, s40, 12
    s_and_b32 s41, s12, 7
    s_lshl_b32 s41, s41, 7
    s_add_u32 s40, s40, s41
    s_add_u32 s22, s40, 68157440
    s_add_u32 s23, s22, 1024
    s_add_u32 s25, s22, 2048
    s_mov_b32 s56, -65472
    s_cmp_lg_u32 s32, 0
    s_cselect_b64 s[38:39], -1, 0
    s_add_u32 s55, s68, 138412032
    s_cmp_eq_u32 s13, 3
    s_cselect_b64 s[100:101], 1, 0
    s_cselect_b64 s[38:39], 1, s[38:39]
    s_cselect_b32 s93, 64, 0
    s_cselect_b32 s55, s29, s55
    s_cselect_b32 s57, 0, 9216
    s_mov_b64 exec, s[100:101]
    v_mov_b32 v72, s95
    s_mov_b64 exec, -1
    s_mov_b32 s34, 0xff00ff00
    s_mov_b32 s35, 0xff00ff00
    s_lshl_b32 s28, s12, 12
    s_add_u32 s28, s28, 7340032
    s_add_u32 s27, s28, 77594624
    s_add_u32 s28, s28, 69206016
    s_cmp_ge_u32 s97, 3
    s_cbranch_scc1 cf_kvdone
    s_mov_b32 s40, 3
    v_bfe_u32 v78, v65, 2, 5
    s_mov_b32 s31, 4194304
cf_kv0:
    buffer_load_dword v77, v78, s[4:7], s96 offen offset:16 sc1
    s_waitcnt vmcnt(0)
    v_subrev_u32 v77, s95, v77
    v_cmp_lt_u32 vcc, 16, v77
    s_nop 1
    v_cndmask_b32 v77, v77, 0, vcc
    v_bfe_u32 v79, v78, 2, 2
    v_lshl_add_u32 v77, v77, 2, v79
    s_nop 1
    v_min_u32_dpp v77, v77, v77 row_ror:1 row_mask:0xf bank_mask:0xf
    s_nop 1
    v_min_u32_dpp v77, v77, v77 row_ror:2 row_mask:0xf bank_mask:0xf
    s_nop 1
    v_min_u32_dpp v77, v77, v77 row_ror:4 row_mask:0xf bank_mask:0xf
    s_nop 0
    v_readfirstlane_b32 s97, v77
    s_sub_u32 s31, s31, 1
    s_cbranch_scc1 cf_kv0_x
    s_cmp_le_u32 s40, s97
    s_cbranch_scc1 cf_kv0_x
    s_sleep 2
    s_branch cf_kv0
cf_kv0_x:
    s_add_u32 s40, s24, 0
    s_add_u32 s40, s40, s33
    s_sub_u32 s41, s96, s40
    v_bfe_u32 v77, v65, 2, 5
    v_add3_u32 v77, v77, s41, 16
    v_lshlrev_b32 v78, 3, v69
    s_nop 0
    v_mov_b32_dpp v78, v77 quad_perm:[0,1,2,3] row_mask:0xc bank_mask:0xf
    buffer_load_dword v76, v78, s[4:7], s40 offen sc1
    s_add_u32 s40, s24, 524288
    s_add_u32 s40, s40, s33
    s_sub_u32 s41, s96, s40
    v_bfe_u32 v77, v65, 2, 5
    v_add3_u32 v77, v77, s41, 16
    v_lshlrev_b32 v78, 3, v69
    s_nop 0
    v_mov_b32_dpp v78, v77 quad_perm:[0,1,2,3] row_mask:0xc bank_mask:0xf
    buffer_load_dword v76, v78, s[4:7], s40 offen sc1
cf_kvdone:
    v_mov_b64 v[0:1], 0
    v_mov_b64 v[2:3], 0
    v_mov_b64 v[4:5], 0
    v_mov_b64 v[6:7], 0
    v_mov_b64 v[8:9], 0
    v_mov_b64 v[10:11], 0
    v_mov_b64 v[12:13], 0
    v_mov_b64 v[14:15], 0
    v_mov_b64 v[16:17], 0
    v_mov_b64 v[18:19], 0
    v_mov_b64 v[20:21], 0
    v_mov_b64 v[22:23], 0
    ds_read_b128 v[44:47], v70 offset:0
    ds_read_b128 v[48:51], v70 offset:1024
    ds_read_b128 v[52:55], v70 offset:2048
    ds_read_b128 v[56:59], v70 offset:3072
    ds_read_b128 v[24:27], v70 offset:4096
    ds_read_b128 v[28:31], v70 offset:5120
    ds_read_b128 v[32:35], v70 offset:6144
    ds_read_b128 v[36:39], v70 offset:7168
    buffer_load_dwordx4 v[40:43], v65, s[4:7], s14 offen offset:0 nt
    buffer_load_dwordx4 v[60:63], v66, s[4:7], s14 offen offset:0 nt
    s_mov_b32 s31, 1048576
    s_waitcnt vmcnt(0) lgkmcnt(0)
    s_branch cf_goA
cf_loop:
    s_mov_b32 s31, 1048576
    s_mov_b32 s69, s70
    s_waitcnt lgkmcnt(0)
cf_cA:
    buffer_load_dwordx4 v[40:43], v65, s[4:7], s14 offen offset:0 nt
    buffer_load_dwordx4 v[60:63], v66, s[4:7], s14 offen offset:0 nt
cf_cA1:
    v_bitop3_b32 v77, v40, v60, s70 bitop3:0x7e
    v_and_b32 v77, 1, v77
    v_cmp_ne_u32 vcc, 0, v77
    s_cbranch_vccz cf_goA
    v_bitop3_b32 v77, v40, v60, s70 bitop3:0x7e
    v_and_b32 v77, 1, v77
    v_cmp_ne_u32 vcc, 0, v77
    s_cbranch_vccz cf_goA
    v_bitop3_b32 v77, v40, v60, s70 bitop3:0x7e
    v_and_b32 v77, 1, v77
    v_cmp_ne_u32 vcc, 0, v77
    s_cbranch_vccz cf_goA
    v_bitop3_b32 v77, v40, v60, s70 bitop3:0x7e
    v_and_b32 v77, 1, v77
    v_cmp_ne_u32 vcc, 0, v77
    s_cbranch_vccz cf_goA
    buffer_load_dwordx4 v[40:43], v65, s[4:7], s14 offen offset:0 nt
    buffer_load_dwordx4 v[60:63], v66, s[4:7], s14 offen offset:0 nt
    v_bitop3_b32 v77, v40, v60, s70 bitop3:0x7e
    v_and_b32 v77, 1, v77
    v_cmp_ne_u32 vcc, 0, v77
    s_cbranch_vccz cf_goA
    v_bitop3_b32 v77, v40, v60, s70 bitop3:0x7e
    v_and_b32 v77, 1, v77
    v_cmp_ne_u32 vcc, 0, v77
    s_cbranch_vccz cf_goA
    v_bitop3_b32 v77, v40, v60, s70 bitop3:0x7e
    v_and_b32 v77, 1, v77
    v_cmp_ne_u32 vcc, 0, v77
    s_cbranch_vccz cf_goA
    v_bitop3_b32 v77, v40, v60, s70 bitop3:0x7e
    v_and_b32 v77, 1, v77
    v_cmp_ne_u32 vcc, 0, v77
    s_cbranch_vccz cf_goA
    buffer_load_dwordx4 v[40:43], v65, s[4:7], s14 offen offset:0 nt
    buffer_load_dwordx4 v[60:63], v66, s[4:7], s14 offen offset:0 nt
    v_bitop3_b32 v77, v40, v60, s70 bitop3:0x7e
    v_and_b32 v77, 1, v77
    v_cmp_ne_u32 vcc, 0, v77
    s_cbranch_vccz cf_goA
    v_bitop3_b32 v77, v40, v60, s70 bitop3:0x7e
    v_and_b32 v77, 1, v77
    v_cmp_ne_u32 vcc, 0, v77
    s_cbranch_vccz cf_goA
    v_bitop3_b32 v77, v40, v60, s70 bitop3:0x7e
    v_and_b32 v77, 1, v77
    v_cmp_ne_u32 vcc, 0, v77
    s_cbranch_vccz cf_goA
    v_bitop3_b32 v77, v40, v60, s70 bitop3:0x7e
    v_and_b32 v77, 1, v77
    v_cmp_ne_u32 vcc, 0, v77
    s_cbranch_vccz cf_goA
    buffer_load_dwordx4 v[40:43], v65, s[4:7], s14 offen offset:0 nt
    buffer_load_dwordx4 v[60:63], v66, s[4:7], s14 offen offset:0 nt
    v_bitop3_b32 v77, v40, v60, s70 bitop3:0x7e
    v_and_b32 v77, 1, v77
    v_cmp_ne_u32 vcc, 0, v77
    s_cbranch_vccz cf_goA
    v_bitop3_b32 v77, v40, v60, s70 bitop3:0x7e
    v_and_b32 v77, 1, v77
    v_cmp_ne_u32 vcc, 0, v77
    s_cbranch_vccz cf_goA
    v_bitop3_b32 v77, v40, v60, s70 bitop3:0x7e
    v_and_b32 v77, 1, v77
    v_cmp_ne_u32 vcc, 0, v77
    s_cbranch_vccz cf_goA
    v_bitop3_b32 v77, v40, v60, s70 bitop3:0x7e
    v_and_b32 v77, 1, v77
    v_cmp_ne_u32 vcc, 0, v77
    s_cbranch_vccz cf_goA
    s_sub_u32 s31, s31, 64
    s_cbranch_scc0 cf_cA
cf_goA:
    ds_write_b128 v65, v[40:43] offset:0
    v_smfmac_f32_16x16x64_bf16 v[0:3], v[40:43], v[44:51], v64
    v_smfmac_f32_16x16x64_bf16 v[4:7], v[40:43], v[52:59], v64
    buffer_load_dwordx4 v[44:47], v65, s[4:7], s15 offen offset:0 nt
    v_smfmac_f32_16x16x64_bf16 v[0:3], v[60:63], v[24:31], v64
    s_add_u32 s40, s24, 1048576
    s_add_u32 s40, s40, s33
    s_sub_u32 s41, s96, s40
    v_smfmac_f32_16x16x64_bf16 v[4:7], v[60:63], v[32:39], v64
    ds_read_b128 v[24:27], v70 offset:8192
    s_cmp_lt_u32 s97, s93
    s_cselect_b32 s41, s41, 0
    v_smfmac_f32_16x16x64_bf16 v[8:11], v[40:43], a[96:103], v64
    ds_read_b128 v[28:31], v70 offset:9216
    v_smfmac_f32_16x16x64_bf16 v[12:15], v[40:43], a[104:111], v64
    ds_read_b128 v[32:35], v70 offset:10240
    s_waitcnt lgkmcnt(3)
    s_barrier
    ds_read_b128 v[48:51], v67 offset:0
    v_smfmac_f32_16x16x64_bf16 v[8:11], v[60:63], a[112:119], v64
    ds_read_b128 v[36:39], v70 offset:11264
    v_bitop3_b32 v79, v73, -9, s54 bitop3:0x6a
    v_smfmac_f32_16x16x64_bf16 v[12:15], v[60:63], a[120:127], v64
    buffer_load_dwordx4 v[44:47], v65, s[4:7], s15 offen offset:0 nt
    v_smfmac_f32_16x16x64_bf16 v[16:19], v[40:43], a[232:239], v64
    ds_read_b128 v[52:55], v68 offset:0
    s_waitcnt lgkmcnt(4)
    v_bfe_u32 v77, v65, 2, 5
    v_smfmac_f32_16x16x64_bf16 v[20:23], v[40:43], v[24:31], v64
    ds_read_b128 v[24:27], v70 offset:12288
    s_waitcnt lgkmcnt(3)
    v_smfmac_f32_16x16x64_bf16 v[0:3], v[48:51], a[0:7], v64
    ds_read_b128 v[28:31], v70 offset:13312
    s_waitcnt lgkmcnt(3)
    v_add3_u32 v77, v77, s41, 16
    v_smfmac_f32_16x16x64_bf16 v[4:7], v[48:51], v[32:39], v64
    buffer_load_dwordx4 v[40:43], v65, s[4:7], s16 offen offset:0 nt
    v_smfmac_f32_16x16x64_bf16 v[16:19], v[60:63], a[240:247], v64
    ds_read_b128 v[32:35], v70 offset:14336
    v_lshlrev_b32 v78, 3, v69
    v_smfmac_f32_16x16x64_bf16 v[20:23], v[60:63], a[248:255], v64
    ds_read_b128 v[36:39], v70 offset:15360
    v_smfmac_f32_16x16x64_bf16 v[8:11], v[48:51], a[128:135], v64
    s_waitcnt vmcnt(2)
    v_mov_b32_dpp v78, v77 quad_perm:[0,1,2,3] row_mask:0xc bank_mask:0xf
    v_smfmac_f32_16x16x64_bf16 v[12:15], v[48:51], a[136:143], v64
    buffer_load_dwordx4 v[58:61], v65, s[4:7], s24 offen offset:3072 sc1
    s_waitcnt lgkmcnt(2)
    v_and_b32 v77, s36, v44
    v_smfmac_f32_16x16x64_bf16 v[12:15], v[52:55], v[24:31], v64
    ds_write_b128 v65, v[44:47] offset:4096
    v_smfmac_f32_16x16x64_bf16 v[0:3], v[52:55], a[8:15], v64
    v_cmp_ne_u32 vcc, s70, v77
    v_smfmac_f32_16x16x64_bf16 v[8:11], v[52:55], a[144:151], v64
    buffer_load_dwordx4 v[24:27], v65, s[4:7], s24 offen offset:0 sc1
    s_waitcnt lgkmcnt(1)
    v_smfmac_f32_16x16x64_bf16 v[4:7], v[52:55], v[32:39], v64
    s_cbranch_vccnz cf_spinB
cf_backB:
    v_smfmac_f32_16x16x64_bf16 v[16:19], v[44:47], v[176:183], v64
    s_waitcnt lgkmcnt(0)
    s_barrier
    ds_read_b128 v[48:51], v66 offset:4096
    v_smfmac_f32_16x16x64_bf16 v[12:15], v[44:47], a[160:167], v64
    buffer_load_dwordx4 v[28:31], v65, s[4:7], s24 offen offset:1024 sc1
    v_smfmac_f32_16x16x64_bf16 v[0:3], v[44:47], a[16:23], v64
    ds_read_b128 v[52:55], v67 offset:4096
    v_smfmac_f32_16x16x64_bf16 v[8:11], v[44:47], a[152:159], v64
    v_smfmac_f32_16x16x64_bf16 v[4:7], v[44:47], a[24:31], v64
    buffer_load_dwordx4 v[34:37], v65, s[4:7], s24 offen offset:2048 sc1
    s_waitcnt vmcnt(5)
    v_smfmac_f32_16x16x64_bf16 v[20:23], v[44:47], v[184:191], v64
    ds_read_b128 v[44:47], v68 offset:4096
    s_waitcnt lgkmcnt(2)
    v_smfmac_f32_16x16x64_bf16 v[0:3], v[48:51], a[32:39], v64
    v_smfmac_f32_16x16x64_bf16 v[8:11], v[48:51], a[168:175], v64
    buffer_load_dword v76, v78, s[4:7], s40 offen sc1
    v_smfmac_f32_16x16x64_bf16 v[4:7], v[48:51], a[40:47], v64
    s_waitcnt vmcnt(5)
    v_and_b32 v77, s36, v40
    v_smfmac_f32_16x16x64_bf16 v[12:15], v[48:51], a[176:183], v64
    ds_read_b128 v[48:51], v69 offset:15360
    s_waitcnt lgkmcnt(1)
    v_cmp_ne_u32 vcc, s70, v77
    v_smfmac_f32_16x16x64_bf16 v[0:3], v[52:55], a[48:55], v64
    v_smfmac_f32_16x16x64_bf16 v[8:11], v[52:55], a[184:191], v64
    s_cbranch_vccnz cf_spin8
cf_back8:
    v_smfmac_f32_16x16x64_bf16 v[0:3], v[44:47], a[64:71], v64
    v_smfmac_f32_16x16x64_bf16 v[8:11], v[44:47], a[200:207], v64
    v_smfmac_f32_16x16x64_bf16 v[0:3], v[40:43], a[80:87], v64
    s_nop 1
    v_smfmac_f32_16x16x64_bf16 v[8:11], v[40:43], a[216:223], v64
    s_nop 1
    v_lshrrev_b32 v77, 1, v69
    v_smfmac_f32_16x16x64_bf16 v[4:7], v[52:55], a[56:63], v64
    s_nop 1
    v_cvt_pk_bf16_f32 v0, v0, v1
    v_smfmac_f32_16x16x64_bf16 v[12:15], v[52:55], a[192:199], v64
    s_nop 1
    v_cvt_pk_bf16_f32 v1, v2, v3
    v_smfmac_f32_16x16x64_bf16 v[4:7], v[44:47], a[72:79], v64
    s_nop 1
    v_cvt_pk_bf16_f32 v2, v8, v9
    v_smfmac_f32_16x16x64_bf16 v[12:15], v[44:47], a[208:215], v64
    s_nop 1
    v_cvt_pk_bf16_f32 v3, v10, v11
    v_smfmac_f32_16x16x64_bf16 v[4:7], v[40:43], a[88:95], v64
    s_waitcnt lgkmcnt(0)
    s_nop 0
    s_nop 0
    v_smfmac_f32_16x16x64_bf16 v[12:15], v[40:43], a[224:231], v64
    s_nop 2
    v_mfma_f32_16x16x32_bf16 v[8:11], v[0:3], v[48:51], 0
    s_nop 0
    v_cvt_pk_bf16_f32 v4, v4, v5
    v_cvt_pk_bf16_f32 v5, v6, v7
    s_nop 0
    v_cvt_pk_bf16_f32 v6, v12, v13
    v_cvt_pk_bf16_f32 v7, v14, v15
    s_nop 1
    v_mfma_f32_16x16x32_bf16 v[12:15], v[4:7], v[48:51], 0
    ds_read_b128 v[48:51], v66 offset:4096
    v_cvt_pk_bf16_f32 v0, v8, v9
    v_cvt_pk_bf16_f32 v1, v10, v11
    v_smfmac_f32_16x16x64_bf16 v[16:19], v[52:55], v[208:215], v64
    s_waitcnt vmcnt(2)
    s_nop 2
    v_cvt_pk_bf16_f32 v2, v12, v13
    v_cvt_pk_bf16_f32 v3, v14, v15
    s_nop 1
    v_mfma_f32_16x16x32_bf16 v[12:15], v[0:3], v[0:3], 0
    s_nop 1
    v_bitop3_b32 v78, v73, -9, s53 bitop3:0x6a
    v_mfma_f32_16x16x32_bf16 v[4:7], v[24:27], v[0:3], 0
    ds_read_b128 v[24:27], v67 offset:0
    s_nop 1
    v_mfma_f32_16x16x32_bf16 v[8:11], v[28:31], v[0:3], 0
    s_nop 0
    v_mov_b32_dpp v12, v14 row_ror:8 row_mask:0xf bank_mask:0xc
    v_mov_b32_dpp v13, v15 row_ror:8 row_mask:0xf bank_mask:0xc
    v_smfmac_f32_16x16x64_bf16 v[20:23], v[52:55], v[216:223], v64
    ds_write_b64 v71, v[12:13]
    ds_read_b128 v[52:55], v68 offset:0
    s_nop 1
    v_mov_b32_dpp v4, v8 row_ror:8 row_mask:0xf bank_mask:0xc
    v_mov_b32_dpp v5, v9 row_ror:8 row_mask:0xf bank_mask:0xc
    v_mov_b32_dpp v6, v10 row_ror:8 row_mask:0xf bank_mask:0xc
    v_mov_b32_dpp v7, v11 row_ror:8 row_mask:0xf bank_mask:0xc
    v_smfmac_f32_16x16x64_bf16 v[16:19], v[44:47], v[224:231], v64
    ds_write_b128 v65, v[4:7] offset:8192
    v_smfmac_f32_16x16x64_bf16 v[20:23], v[44:47], v[232:239], v64
    s_waitcnt lgkmcnt(3)
    v_smfmac_f32_16x16x64_bf16 v[16:19], v[24:27], v[144:151], v64
    s_waitcnt vmcnt(1)
    v_smfmac_f32_16x16x64_bf16 v[20:23], v[24:27], v[152:159], v64
    s_mov_b64 exec, s[38:39]
    buffer_store_dword v72, v75, s[4:7], s55 offen sc1
    s_mov_b64 exec, -1
    v_smfmac_f32_16x16x64_bf16 v[16:19], v[40:43], v[240:247], v64
    s_cmp_ge_u32 s30, 56
    s_waitcnt lgkmcnt(0)
    s_barrier
    ds_read_b128 v[8:11], v66 offset:8192
    v_smfmac_f32_16x16x64_bf16 v[20:23], v[40:43], v[248:255], v64
    ds_read_b128 v[12:15], v67 offset:8192
    v_smfmac_f32_16x16x64_bf16 v[16:19], v[48:51], v[192:199], v64
    ds_read_b128 v[44:47], v68 offset:8192
    v_smfmac_f32_16x16x64_bf16 v[20:23], v[48:51], v[200:207], v64
    ds_read_b64 v[24:25], v77 offset:14336
    ds_read_b64 v[26:27], v77 offset:14592
    v_smfmac_f32_16x16x64_bf16 v[16:19], v[52:55], v[160:167], v64
    ds_read_b64 v[28:29], v77 offset:14848
    ds_read_b64 v[30:31], v77 offset:15104
    v_bitop3_b32 v77, v73, -9, s52 bitop3:0x6a
    v_smfmac_f32_16x16x64_bf16 v[20:23], v[52:55], v[168:175], v64
    s_cbranch_scc1 cf_rare
cf_rare_x:
    ds_read_b128 v[48:51], v70 offset:22528
    ds_read_b128 v[52:55], v70 offset:23552
    s_waitcnt lgkmcnt(6)
    v_pk_add_f32 v[4:5], v[4:5], v[8:9]
    v_pk_add_f32 v[6:7], v[6:7], v[10:11]
    v_pk_add_f32 v[12:13], v[12:13], v[44:45]
    v_pk_add_f32 v[14:15], v[14:15], v[46:47]
    v_pk_add_f32 v[4:5], v[4:5], v[12:13]
    v_pk_add_f32 v[6:7], v[6:7], v[14:15]
    s_waitcnt lgkmcnt(2)
    v_pk_add_f32 v[24:25], v[24:25], v[26:27]
    v_pk_add_f32 v[28:29], v[28:29], v[30:31]
    v_max3_f32 v8, v4, v5, v6
    v_pk_add_f32 v[24:25], v[24:25], v[28:29]
    v_max_f32 v8, v8, v7
    v_max3_f32 v8, v8, v24, v25
    v_cvt_pk_bf16_f32 v32, v16, v17
    v_cvt_pk_bf16_f32 v38, v18, v19
    v_max_f32_dpp v8, v8, v8 row_ror:8 row_mask:0xf bank_mask:0xf
    v_mov_b32 v9, v8
    v_cvt_pk_bf16_f32 v56, v20, v21
    v_cvt_pk_bf16_f32 v62, v22, v23
    v_permlane32_swap_b32 v8, v9
    v_max_f32 v8, v8, v9
    v_mov_b32 v9, v8
    v_mov_b32 v11, 0
    v_mov_b32 v15, 0
    v_permlane16_swap_b32 v8, v9
    v_max_f32 v8, v8, v9
    v_mul_f32 v8, s66, v8
    v_pk_fma_f32 v[4:5], v[4:5], s[44:45], v[8:9] op_sel_hi:[1,1,0]
    v_pk_fma_f32 v[6:7], v[6:7], s[44:45], v[8:9] op_sel_hi:[1,1,0]
    v_pk_fma_f32 v[24:25], v[24:25], s[44:45], v[8:9] op_sel_hi:[1,1,0]
    v_exp_f32 v4, v4
    v_exp_f32 v5, v5
    v_exp_f32 v6, v6
    v_exp_f32 v7, v7
    v_exp_f32 v24, v24
    v_exp_f32 v25, v25
    v_cvt_pk_bf16_f32 v12, v4, v5
    v_cvt_pk_bf16_f32 v13, v6, v7
    v_cvt_pk_bf16_f32 v10, v24, v25
    v_cvt_pk_bf16_f32 v14, v24, v25
    v_mov_b64 v[0:1], s[48:49]
    v_mfma_f32_16x16x32_bf16 v[4:7], v[32:35], v[10:13], 0
    ds_read_b128 v[40:43], v70 offset:20480
    v_mov_b64 v[2:3], s[50:51]
    v_mfma_f32_16x16x32_bf16 v[24:27], v[36:39], v[12:15], 0
    ds_read_b128 v[44:47], v70 offset:21504
    v_mov_b64 v[8:9], 0
    v_mfma_f32_16x16x32_bf16 v[28:31], v[0:3], v[10:13], 0
    ds_read_b128 v[32:35], v70 offset:24576
    v_mov_b64 v[0:1], 0
    v_mfma_f32_16x16x32_bf16 v[16:19], v[56:59], v[10:13], 0
    ds_read_b128 v[36:39], v70 offset:25600
    v_mov_b64 v[2:3], 0
    v_mfma_f32_16x16x32_bf16 v[20:23], v[60:63], v[12:15], 0
    ds_read_b128 v[56:59], v70 offset:28672
    v_add_f32_dpp v4, v24, v4 row_ror:8 row_mask:0xf bank_mask:0xf
    v_add_f32_dpp v5, v25, v5 row_ror:8 row_mask:0xf bank_mask:0xf
    v_add_f32_dpp v6, v26, v6 row_ror:8 row_mask:0xf bank_mask:0xf
    v_add_f32_dpp v7, v27, v7 row_ror:8 row_mask:0xf bank_mask:0xf
    v_add_f32_dpp v29, v28, v28 row_ror:8 row_mask:0xf bank_mask:0xf
    v_rcp_f32 v28, v29
    v_mov_b64 v[10:11], 0
    v_add_f32_dpp v4, v16, v20 row_ror:8 row_mask:0xf bank_mask:0xc
    v_add_f32_dpp v5, v17, v21 row_ror:8 row_mask:0xf bank_mask:0xc
    v_add_f32_dpp v6, v18, v22 row_ror:8 row_mask:0xf bank_mask:0xc
    v_add_f32_dpp v7, v19, v23 row_ror:8 row_mask:0xf bank_mask:0xc
    v_pk_mul_f32 v[4:5], v[4:5], v[28:29] op_sel_hi:[1,0]
    v_pk_mul_f32 v[6:7], v[6:7], v[28:29] op_sel_hi:[1,0]
    v_cvt_pk_bf16_f32 v4, v4, v5
    v_cvt_pk_bf16_f32 v5, v6, v7
    ds_write_b64 v73, v[4:5] offset:12288
    v_mov_b32_dpp v6, v4 row_ror:8 row_mask:0xf bank_mask:0xf
    v_mov_b32_dpp v7, v5 row_ror:8 row_mask:0xf bank_mask:0xf
    v_mov_b64 v[12:13], 0
    v_mov_b64 v[14:15], 0
    v_smfmac_f32_16x16x64_bf16 v[8:11], v[4:7], v[80:87], v64
    s_waitcnt lgkmcnt(4)
    v_mov_b64 v[24:25], 0
    v_smfmac_f32_16x16x64_bf16 v[0:3], v[4:7], v[40:47], v64
    ds_read_b128 v[60:63], v70 offset:29696
    v_mov_b64 v[26:27], 0
    v_smfmac_f32_16x16x64_bf16 v[12:15], v[4:7], v[112:119], v64
    s_waitcnt lgkmcnt(1)
    s_barrier
    ds_read_b128 v[16:19], v77 offset:12288
    v_smfmac_f32_16x16x64_bf16 v[24:27], v[4:7], v[48:55], v64
    ds_read_b128 v[20:23], v78 offset:12288
    ds_read_b128 v[28:31], v79 offset:12288
    v_mov_b64 v[4:5], 0
    v_mov_b64 v[6:7], 0
    v_bfe_u32 v77, v74, 16, 1
    v_mad_i32_i24 v77, v77, s56, v74
    s_waitcnt lgkmcnt(2)
    v_smfmac_f32_16x16x64_bf16 v[8:11], v[16:19], v[88:95], v64
    ds_read_b128 v[40:43], v70 offset:32768
    s_waitcnt lgkmcnt(2)
    v_smfmac_f32_16x16x64_bf16 v[8:11], v[20:23], v[96:103], v64
    ds_read_b128 v[44:47], v70 offset:33792
    s_waitcnt lgkmcnt(2)
    v_smfmac_f32_16x16x64_bf16 v[8:11], v[28:31], v[104:111], v64
    ds_read_b128 v[48:51], v70 offset:26624
    s_nop 0
    v_and_b32 v72, 8, v73
    v_smfmac_f32_16x16x64_bf16 v[0:3], v[16:19], v[32:39], v64
    ds_read_b128 v[52:55], v70 offset:27648
    s_nop 0
    v_mad_u32_u24 v72, v72, 63, v73
    v_smfmac_f32_16x16x64_bf16 v[12:15], v[16:19], v[120:127], v64
    ds_read_b128 v[32:35], v70 offset:30720
    v_cvt_pk_bf16_f32 v8, v8, v9
    v_cvt_pk_bf16_f32 v9, v10, v11
    v_and_or_b32 v8, v8, -2, s69
    v_smfmac_f32_16x16x64_bf16 v[12:15], v[20:23], v[128:135], v64
    buffer_store_dwordx2 v[8:9], v74, s[4:7], s22 offen offset:0
    ds_read_b128 v[36:39], v70 offset:31744
    v_smfmac_f32_16x16x64_bf16 v[12:15], v[28:31], v[136:143], v64
    s_add_u32 s30, s30, 1
    s_xor_b32 s70, s70, 1
    v_subrev_u32 v72, s47, v72
    v_smfmac_f32_16x16x64_bf16 v[0:3], v[20:23], v[56:63], v64
    ds_read_b128 v[56:59], v70 offset:34816
    s_waitcnt lgkmcnt(3)
    s_nop 0
    v_smfmac_f32_16x16x64_bf16 v[0:3], v[28:31], v[40:47], v64
    ds_read_b128 v[60:63], v70 offset:35840
    v_cvt_pk_bf16_f32 v12, v12, v13
    v_cvt_pk_bf16_f32 v13, v14, v15
    v_and_or_b32 v12, v12, -2, s69
    v_smfmac_f32_16x16x64_bf16 v[24:27], v[16:19], v[48:55], v64
    buffer_store_dwordx2 v[12:13], v74, s[4:7], s22 offen offset:64
    s_waitcnt lgkmcnt(2)
    v_smfmac_f32_16x16x64_bf16 v[24:27], v[20:23], v[32:39], v64
    ds_read_b128 v[40:43], v70 offset:16384
    v_cvt_pk_bf16_f32 v0, v0, v1
    v_cvt_pk_bf16_f32 v1, v2, v3
    v_and_or_b32 v0, v0, -2, s69
    s_waitcnt lgkmcnt(1)
    v_smfmac_f32_16x16x64_bf16 v[24:27], v[28:31], v[56:63], v64
    buffer_store_dwordx2 v[0:1], v74, s[4:7], s23 offen offset:0
    ds_read_b128 v[44:47], v70 offset:17408
    ds_read_b128 v[8:11], v72 offset:12288
    ds_read_b128 v[48:51], v70 offset:18432
    ds_read_b128 v[52:55], v70 offset:19456
    ds_read_b128 v[12:15], v72 offset:13312
    s_cmp_lg_u32 s71, 0
    s_nop 0
    v_cvt_pk_bf16_f32 v24, v24, v25
    v_cvt_pk_bf16_f32 v25, v26, v27
    v_and_or_b32 v24, v24, -2, s69
    buffer_store_dwordx2 v[24:25], v74, s[4:7], s23 offen offset:64
    s_waitcnt lgkmcnt(3)
    v_smfmac_f32_16x16x64_bf16 v[4:7], v[8:11], v[40:47], v64
    s_waitcnt lgkmcnt(0)
    v_smfmac_f32_16x16x64_bf16 v[4:7], v[12:15], v[48:55], v64
    s_nop 7
    v_cvt_pk_bf16_f32 v4, v4, v5
    v_cvt_pk_bf16_f32 v5, v6, v7
    v_and_or_b32 v4, v4, -2, s69
    buffer_store_dwordx2 v[4:5], v77, s[4:7], s25 offen offset:0
    s_nop 0
    s_cbranch_scc1 cf_e1
    s_cmp_lg_u32 s37, 0
    s_cbranch_scc1 cf_f0_xt
cf_f0_xtx:
    s_nop 2
    v_mov_b32 v79, v79
    s_nop 2
    v_mov_b32 v79, v79
    s_nop 2
    v_mov_b32 v79, v79
    s_nop 2
    v_mov_b32 v79, v79
    s_nop 2
    v_mov_b32 v79, v79
    buffer_load_dwordx4 v[8:11], v65, s[4:7], s18 offen nt
    buffer_load_dwordx4 v[12:15], v65, s[4:7], s19 offen nt
    buffer_load_dwordx4 v[16:19], v65, s[4:7], s20 offen nt
    buffer_load_dwordx4 v[20:23], v65, s[4:7], s21 offen nt
    v_and_b32 v77, 255, v69
    ds_read_b128 v[4:7], v77 offset:15872
    ds_read_b128 v[44:47], v70 offset:0
    ds_read_b128 v[48:51], v70 offset:1024
    ds_read_b128 v[52:55], v70 offset:2048
    ds_read_b128 v[56:59], v70 offset:3072
    ds_read_b128 v[24:27], v70 offset:4096
    ds_read_b128 v[28:31], v70 offset:5120
    ds_read_b128 v[32:35], v70 offset:6144
    ds_read_b128 v[36:39], v70 offset:7168
    s_mov_b32 s31, 65536
    s_add_u32 s24, s24, 524288
    s_add_u32 s26, s26, 524288
    s_add_u32 s55, s55, s57
    s_mov_b32 s14, 67108864
    s_mov_b32 s15, 67112960
    s_mov_b32 s16, 67117056
    s_mov_b32 s36, 1
    v_mov_b32 v40, s69
    v_mov_b32 v60, s69
    v_and_b32 v79, 12, v75
    v_cmp_eq_u32 vcc, 0, v79
    s_nop 1
    v_cndmask_b32 v79, 0, 1, vcc
    s_waitcnt lgkmcnt(0)
    s_waitcnt vmcnt(3)
    v_xor_b32 v77, s69, v8
    v_mfma_f32_16x16x32_bf16 v[0:3], v[4:7], v[8:11], 0
    v_mov_b64 v[8:9], 0
    v_mov_b64 v[10:11], 0
    s_waitcnt vmcnt(2)
    v_bitop3_b32 v77, v77, v12, s69 bitop3:0xf6
    v_mfma_f32_16x16x32_bf16 v[0:3], v[4:7], v[12:15], v[0:3]
    v_mov_b64 v[12:13], 0
    v_mov_b64 v[14:15], 0
    s_waitcnt vmcnt(1)
    v_bitop3_b32 v77, v77, v16, s69 bitop3:0xf6
    v_mfma_f32_16x16x32_bf16 v[0:3], v[4:7], v[16:19], v[0:3]
    v_mov_b64 v[16:17], 0
    v_mov_b64 v[18:19], 0
    s_waitcnt vmcnt(0)
    v_bitop3_b32 v77, v77, v20, s69 bitop3:0xf6
    v_mfma_f32_16x16x32_bf16 v[0:3], v[4:7], v[20:23], v[0:3]
    v_and_b32 v77, 1, v77
    v_cmp_ne_u32 vcc, 0, v77
    v_mov_b64 v[20:21], 0
    v_mov_b64 v[22:23], 0
    s_cmp_eq_u64 vcc, 0
    s_cselect_b64 s[42:43], -1, 0
    s_nop 1
    v_add_f32_dpp v0, v0, v0 row_ror:8 row_mask:0xf bank_mask:0xf
    v_add_f32_dpp v1, v1, v1 row_ror:8 row_mask:0xf bank_mask:0xf
    s_mov_b64 exec, s[42:43]
    v_cvt_pk_bf16_f32 v72, v0, v1
    v_bfi_b32 v72, v79, s70, v72
    buffer_store_dword v72, v75, s[4:7], s17 offen offset:0
    s_mov_b64 exec, -1
    s_cbranch_scc0 cf_f0_retry
cf_f0_go:
    v_mov_b64 v[0:1], 0
    v_mov_b64 v[2:3], 0
    v_mov_b64 v[4:5], 0
    v_mov_b64 v[6:7], 0
    s_nop 2
    v_mov_b32 v79, v79
    s_nop 2
    v_mov_b32 v79, v79
    s_nop 2
    v_mov_b32 v79, v79
    s_nop 2
    v_mov_b32 v79, v79
    s_branch cf_loop
cf_e1:
    s_cmp_lg_u32 s71, 2
    s_cbranch_scc1 cf_f1
    v_and_b32 v77, 255, v69
    ds_read_b128 v[4:7], v77 offset:15872
    ds_read_b128 v[44:47], v70 offset:0
    ds_read_b128 v[48:51], v70 offset:1024
    ds_read_b128 v[52:55], v70 offset:2048
    ds_read_b128 v[56:59], v70 offset:3072
    ds_read_b128 v[24:27], v70 offset:4096
    ds_read_b128 v[28:31], v70 offset:5120
    ds_read_b128 v[32:35], v70 offset:6144
    ds_read_b128 v[36:39], v70 offset:7168
    s_mov_b32 s31, 65536
    s_add_u32 s24, s24, 524288
    s_add_u32 s26, s26, 524288
    s_add_u32 s55, s55, s57
    s_mov_b32 s14, 67108864
    s_mov_b32 s15, 67112960
    s_mov_b32 s16, 67117056
    s_mov_b32 s36, 1
    v_mov_b32 v40, s69
    v_mov_b32 v60, s69
    v_and_b32 v79, 12, v75
    v_cmp_eq_u32 vcc, 0, v79
    s_nop 1
    v_cndmask_b32 v79, 0, 1, vcc
    s_cmp_lg_u32 s37, 0
    s_cbranch_scc1 cf_f2_xt
cf_f2_xtx:
    s_nop 2
    v_mov_b32 v79, v79
    s_nop 2
    v_mov_b32 v79, v79
    s_nop 2
    v_mov_b32 v79, v79
    s_nop 2
    v_mov_b32 v79, v79
    s_nop 2
    v_mov_b32 v79, v79
    s_nop 2
    v_mov_b32 v79, v79
    s_nop 2
    v_mov_b32 v79, v79
    s_nop 2
    v_mov_b32 v79, v79
    s_waitcnt vmcnt(0)
    buffer_load_dwordx4 v[8:11], v65, s[4:7], s18 offen nt
    buffer_load_dwordx4 v[12:15], v65, s[4:7], s19 offen nt
    buffer_load_dwordx4 v[16:19], v65, s[4:7], s20 offen nt
    buffer_load_dwordx4 v[20:23], v65, s[4:7], s21 offen nt
    s_nop 2
    v_mov_b32 v79, v79
    s_nop 2
    v_mov_b32 v79, v79
    s_nop 2
    v_mov_b32 v79, v79
    s_nop 2
    v_mov_b32 v79, v79
    s_nop 2
    v_mov_b32 v79, v79
    s_nop 2
    v_mov_b32 v79, v79
    s_nop 2
    v_mov_b32 v79, v79
    s_nop 2
    v_mov_b32 v79, v79
    s_nop 2
    v_mov_b32 v79, v79
    s_nop 2
    v_mov_b32 v79, v79
    buffer_load_dwordx4 v[40:43], v65, s[4:7], s14 offen offset:0 nt
    buffer_load_dwordx4 v[60:63], v66, s[4:7], s14 offen offset:0 nt
    s_waitcnt lgkmcnt(0)
    s_waitcnt vmcnt(5)
    v_xor_b32 v77, s69, v8
    v_mfma_f32_16x16x32_bf16 v[0:3], v[4:7], v[8:11], 0
    v_mov_b64 v[8:9], 0
    v_mov_b64 v[10:11], 0
    s_waitcnt vmcnt(4)
    v_bitop3_b32 v77, v77, v12, s69 bitop3:0xf6
    v_mfma_f32_16x16x32_bf16 v[0:3], v[4:7], v[12:15], v[0:3]
    v_mov_b64 v[12:13], 0
    v_mov_b64 v[14:15], 0
    s_waitcnt vmcnt(3)
    v_bitop3_b32 v77, v77, v16, s69 bitop3:0xf6
    v_mfma_f32_16x16x32_bf16 v[0:3], v[4:7], v[16:19], v[0:3]
    v_mov_b64 v[16:17], 0
    v_mov_b64 v[18:19], 0
    s_waitcnt vmcnt(2)
    v_bitop3_b32 v77, v77, v20, s69 bitop3:0xf6
    v_mfma_f32_16x16x32_bf16 v[0:3], v[4:7], v[20:23], v[0:3]
    v_and_b32 v77, 1, v77
    v_cmp_ne_u32 vcc, 0, v77
    v_mov_b64 v[20:21], 0
    v_mov_b64 v[22:23], 0
    buffer_load_dwordx4 v[40:43], v65, s[4:7], s14 offen offset:0 nt
    buffer_load_dwordx4 v[60:63], v66, s[4:7], s14 offen offset:0 nt
    s_cmp_eq_u64 vcc, 0
    s_cselect_b64 s[42:43], -1, 0
    v_add_f32_dpp v0, v0, v0 row_ror:4 row_mask:0xf bank_mask:0xf
    v_add_f32_dpp v1, v1, v1 row_ror:4 row_mask:0xf bank_mask:0xf
    s_nop 0
    v_add_f32_dpp v0, v0, v0 row_ror:8 row_mask:0xf bank_mask:0xf
    v_add_f32_dpp v1, v1, v1 row_ror:8 row_mask:0xf bank_mask:0xf
    s_mov_b64 exec, s[42:43]
    v_cvt_pk_bf16_f32 v72, v0, v1
    v_bfi_b32 v72, v79, s70, v72
    buffer_store_dword v72, v75, s[4:7], s17 offen offset:0
    buffer_store_dword v72, v75, s[4:7], s17 offen offset:1024
    buffer_store_dword v72, v75, s[4:7], s17 offen offset:2048
    buffer_store_dword v72, v75, s[4:7], s17 offen offset:3072
    s_mov_b64 exec, -1
    s_cbranch_scc0 cf_f2_retry
cf_f2_go:
    v_mov_b64 v[0:1], 0
    v_mov_b64 v[2:3], 0
    v_mov_b64 v[4:5], 0
    v_mov_b64 v[6:7], 0
    s_branch cf_loop
cf_f1:
    s_cmp_lg_u32 s32, 1
    s_cbranch_scc1 cf_f3
    v_and_b32 v77, 255, v69
    ds_read_b128 v[4:7], v77 offset:15872
    ds_read_b128 v[44:47], v70 offset:0
    ds_read_b128 v[48:51], v70 offset:1024
    ds_read_b128 v[52:55], v70 offset:2048
    ds_read_b128 v[56:59], v70 offset:3072
    ds_read_b128 v[24:27], v70 offset:4096
    ds_read_b128 v[28:31], v70 offset:5120
    ds_read_b128 v[32:35], v70 offset:6144
    ds_read_b128 v[36:39], v70 offset:7168
    s_mov_b32 s31, 65536
    s_add_u32 s24, s24, 524288
    s_add_u32 s26, s26, 524288
    s_add_u32 s55, s55, s57
    s_mov_b32 s14, 67108864
    s_mov_b32 s15, 67112960
    s_mov_b32 s16, 67117056
    s_mov_b32 s36, 1
    v_mov_b32 v40, s69
    v_mov_b32 v60, s69
    v_and_b32 v79, 12, v75
    v_cmp_eq_u32 vcc, 0, v79
    s_nop 1
    v_cndmask_b32 v79, 0, 1, vcc
    s_cmp_lg_u32 s37, 0
    s_cbranch_scc1 cf_f1_xt
cf_f1_xtx:
    s_nop 2
    v_mov_b32 v79, v79
    s_waitcnt vmcnt(0)
    buffer_load_dwordx4 v[8:11], v65, s[4:7], s18 offen nt
    buffer_load_dwordx4 v[12:15], v65, s[4:7], s19 offen nt
    buffer_load_dwordx4 v[16:19], v65, s[4:7], s20 offen nt
    buffer_load_dwordx4 v[20:23], v65, s[4:7], s21 offen nt
    s_nop 2
    v_mov_b32 v79, v79
    s_nop 2
    v_mov_b32 v79, v79
    s_nop 2
    v_mov_b32 v79, v79
    s_nop 2
    v_mov_b32 v79, v79
    s_nop 2
    v_mov_b32 v79, v79
    s_nop 2
    v_mov_b32 v79, v79
    s_nop 2
    v_mov_b32 v79, v79
    s_nop 2
    v_mov_b32 v79, v79
    s_nop 2
    v_mov_b32 v79, v79
    s_nop 2
    v_mov_b32 v79, v79
    buffer_load_dwordx4 v[40:43], v65, s[4:7], s14 offen offset:0 nt
    buffer_load_dwordx4 v[60:63], v66, s[4:7], s14 offen offset:0 nt
    s_waitcnt lgkmcnt(0)
    s_waitcnt vmcnt(5)
    v_xor_b32 v77, s69, v8
    v_mfma_f32_16x16x32_bf16 v[0:3], v[4:7], v[8:11], 0
    v_mov_b64 v[8:9], 0
    v_mov_b64 v[10:11], 0
    s_waitcnt vmcnt(4)
    v_bitop3_b32 v77, v77, v12, s69 bitop3:0xf6
    v_mfma_f32_16x16x32_bf16 v[0:3], v[4:7], v[12:15], v[0:3]
    v_mov_b64 v[12:13], 0
    v_mov_b64 v[14:15], 0
    s_waitcnt vmcnt(3)
    v_bitop3_b32 v77, v77, v16, s69 bitop3:0xf6
    v_mfma_f32_16x16x32_bf16 v[0:3], v[4:7], v[16:19], v[0:3]
    v_mov_b64 v[16:17], 0
    v_mov_b64 v[18:19], 0
    s_waitcnt vmcnt(2)
    v_bitop3_b32 v77, v77, v20, s69 bitop3:0xf6
    v_mfma_f32_16x16x32_bf16 v[0:3], v[4:7], v[20:23], v[0:3]
    v_and_b32 v77, 1, v77
    v_cmp_ne_u32 vcc, 0, v77
    v_mov_b64 v[20:21], 0
    v_mov_b64 v[22:23], 0
    buffer_load_dwordx4 v[40:43], v65, s[4:7], s14 offen offset:0 nt
    buffer_load_dwordx4 v[60:63], v66, s[4:7], s14 offen offset:0 nt
    s_cmp_eq_u64 vcc, 0
    s_cselect_b64 s[42:43], -1, 0
    v_add_f32_dpp v0, v0, v0 row_ror:8 row_mask:0xf bank_mask:0xf
    v_add_f32_dpp v1, v1, v1 row_ror:8 row_mask:0xf bank_mask:0xf
    s_mov_b64 exec, s[42:43]
    v_cvt_pk_bf16_f32 v72, v0, v1
    v_bfi_b32 v72, v79, s70, v72
    buffer_store_dword v72, v75, s[4:7], s17 offen offset:0
    s_mov_b64 exec, -1
    s_cbranch_scc0 cf_f1_retry
cf_f1_go:
    v_mov_b64 v[0:1], 0
    v_mov_b64 v[2:3], 0
    v_mov_b64 v[4:5], 0
    v_mov_b64 v[6:7], 0
    s_branch cf_loop
cf_f3:
    v_and_b32 v77, 255, v69
    ds_read_b128 v[4:7], v77 offset:15872
    ds_read_b128 v[44:47], v70 offset:0
    ds_read_b128 v[48:51], v70 offset:1024
    ds_read_b128 v[52:55], v70 offset:2048
    ds_read_b128 v[56:59], v70 offset:3072
    ds_read_b128 v[24:27], v70 offset:4096
    ds_read_b128 v[28:31], v70 offset:5120
    ds_read_b128 v[32:35], v70 offset:6144
    ds_read_b128 v[36:39], v70 offset:7168
    s_mov_b32 s31, 65536
    s_add_u32 s24, s24, 524288
    s_add_u32 s26, s26, 524288
    s_add_u32 s55, s55, s57
    s_mov_b32 s14, 67108864
    s_mov_b32 s15, 67112960
    s_mov_b32 s16, 67117056
    s_mov_b32 s36, 1
    v_mov_b32 v40, s69
    v_mov_b32 v60, s69
    v_and_b32 v79, 12, v75
    v_cmp_eq_u32 vcc, 0, v79
    s_nop 1
    v_cndmask_b32 v79, 0, 1, vcc
    s_add_u32 s40, s30, s95
    v_mov_b32 v72, s40
    s_waitcnt lgkmcnt(0)
    v_mov_b64 v[0:1], 0
    v_mov_b64 v[2:3], 0
    v_mov_b64 v[4:5], 0
    v_mov_b64 v[6:7], 0
    v_mov_b64 v[8:9], 0
    v_mov_b64 v[10:11], 0
    v_mov_b64 v[12:13], 0
    v_mov_b64 v[14:15], 0
    v_mov_b64 v[16:17], 0
    v_mov_b64 v[18:19], 0
    v_mov_b64 v[20:21], 0
    v_mov_b64 v[22:23], 0
    s_nop 2
    v_mov_b32 v79, v79
    s_nop 2
    v_mov_b32 v79, v79
    s_nop 2
    v_mov_b32 v79, v79
    s_nop 2
    v_mov_b32 v79, v79
    s_nop 2
    v_mov_b32 v79, v79
    s_nop 2
    v_mov_b32 v79, v79
    s_nop 2
    v_mov_b32 v79, v79
    s_nop 2
    v_mov_b32 v79, v79
    s_nop 2
    v_mov_b32 v79, v79
    s_waitcnt vmcnt(0)
    s_cmp_lt_u32 s97, s93
    s_cbranch_scc1 cf_kvwait
    s_nop 2
    v_mov_b32 v79, v79
    s_nop 2
    v_mov_b32 v79, v79
    s_nop 2
    v_mov_b32 v79, v79
    s_nop 2
    v_mov_b32 v79, v79
    s_nop 2
    v_mov_b32 v79, v79
    s_nop 2
    v_mov_b32 v79, v79
    s_nop 2
    v_mov_b32 v79, v79
    s_nop 2
    v_mov_b32 v79, v79
cf_kvok:
    s_branch cf_loop
cf_f0_xt:
    s_sub_u32 s37, s37, 1
    s_nop 2
    v_mov_b32 v79, v79
    s_nop 2
    v_mov_b32 v79, v79
    s_nop 2
    v_mov_b32 v79, v79
    s_nop 2
    v_mov_b32 v79, v79
    s_nop 2
    v_mov_b32 v79, v79
    s_nop 2
    v_mov_b32 v79, v79
    s_branch cf_f0_xtx
cf_f0_retry:
    s_sub_u32 s41, s30, s98
    s_mov_b32 s98, s30
    s_cmp_le_u32 s41, 3
    s_cselect_b32 s37, 1, 1
cf_f0_spin:
    buffer_load_dwordx4 v[8:11], v65, s[4:7], s18 offen nt
    buffer_load_dwordx4 v[12:15], v65, s[4:7], s19 offen nt
    buffer_load_dwordx4 v[16:19], v65, s[4:7], s20 offen nt
    buffer_load_dwordx4 v[20:23], v65, s[4:7], s21 offen nt
    s_nop 2
    v_mov_b32 v79, v79
    s_nop 2
    v_mov_b32 v79, v79
    s_nop 2
    v_mov_b32 v79, v79
    buffer_load_dwordx4 v[40:43], v65, s[4:7], s14 offen offset:0 nt
    buffer_load_dwordx4 v[60:63], v66, s[4:7], s14 offen offset:0 nt
    s_waitcnt vmcnt(5)
    v_xor_b32 v77, s69, v8
    v_mfma_f32_16x16x32_bf16 v[0:3], v[4:7], v[8:11], 0
    v_mov_b64 v[8:9], 0
    v_mov_b64 v[10:11], 0
    s_waitcnt vmcnt(4)
    v_bitop3_b32 v77, v77, v12, s69 bitop3:0xf6
    v_mfma_f32_16x16x32_bf16 v[0:3], v[4:7], v[12:15], v[0:3]
    v_mov_b64 v[12:13], 0
    v_mov_b64 v[14:15], 0
    s_waitcnt vmcnt(3)
    v_bitop3_b32 v77, v77, v16, s69 bitop3:0xf6
    v_mfma_f32_16x16x32_bf16 v[0:3], v[4:7], v[16:19], v[0:3]
    v_mov_b64 v[16:17], 0
    v_mov_b64 v[18:19], 0
    s_waitcnt vmcnt(2)
    v_bitop3_b32 v77, v77, v20, s69 bitop3:0xf6
    v_mfma_f32_16x16x32_bf16 v[0:3], v[4:7], v[20:23], v[0:3]
    v_and_b32 v77, 1, v77
    v_cmp_ne_u32 vcc, 0, v77
    v_mov_b64 v[20:21], 0
    v_mov_b64 v[22:23], 0
    buffer_load_dwordx4 v[40:43], v65, s[4:7], s14 offen offset:0 nt
    buffer_load_dwordx4 v[60:63], v66, s[4:7], s14 offen offset:0 nt
    s_cmp_eq_u64 vcc, 0
    s_cselect_b64 s[42:43], -1, 0
    v_add_f32_dpp v0, v0, v0 row_ror:8 row_mask:0xf bank_mask:0xf
    v_add_f32_dpp v1, v1, v1 row_ror:8 row_mask:0xf bank_mask:0xf
    s_mov_b64 exec, s[42:43]
    v_cvt_pk_bf16_f32 v72, v0, v1
    v_bfi_b32 v72, v79, s70, v72
    buffer_store_dword v72, v75, s[4:7], s17 offen offset:0
    s_mov_b64 exec, -1
    s_cbranch_scc1 cf_f0_rx
    s_sub_u32 s31, s31, 1
    s_cbranch_scc0 cf_f0_spin
cf_f0_rx:
    v_mov_b64 v[0:1], 0
    v_mov_b64 v[2:3], 0
    v_mov_b64 v[4:5], 0
    v_mov_b64 v[6:7], 0
    s_branch cf_loop
cf_f1_xt:
    s_sub_u32 s37, s37, 1
    s_nop 2
    v_mov_b32 v79, v79
    s_nop 2
    v_mov_b32 v79, v79
    s_nop 2
    v_mov_b32 v79, v79
    s_nop 2
    v_mov_b32 v79, v79
    s_nop 2
    v_mov_b32 v79, v79
    s_nop 2
    v_mov_b32 v79, v79
    s_branch cf_f1_xtx
cf_f1_retry:
    s_sub_u32 s41, s30, s98
    s_mov_b32 s98, s30
    s_cmp_le_u32 s41, 3
    s_cselect_b32 s37, 1, 1
cf_f1_spin:
    buffer_load_dwordx4 v[8:11], v65, s[4:7], s18 offen nt
    buffer_load_dwordx4 v[12:15], v65, s[4:7], s19 offen nt
    buffer_load_dwordx4 v[16:19], v65, s[4:7], s20 offen nt
    buffer_load_dwordx4 v[20:23], v65, s[4:7], s21 offen nt
    s_nop 2
    v_mov_b32 v79, v79
    s_nop 2
    v_mov_b32 v79, v79
    s_nop 2
    v_mov_b32 v79, v79
    buffer_load_dwordx4 v[40:43], v65, s[4:7], s14 offen offset:0 nt
    buffer_load_dwordx4 v[60:63], v66, s[4:7], s14 offen offset:0 nt
    s_waitcnt vmcnt(5)
    v_xor_b32 v77, s69, v8
    v_mfma_f32_16x16x32_bf16 v[0:3], v[4:7], v[8:11], 0
    v_mov_b64 v[8:9], 0
    v_mov_b64 v[10:11], 0
    s_waitcnt vmcnt(4)
    v_bitop3_b32 v77, v77, v12, s69 bitop3:0xf6
    v_mfma_f32_16x16x32_bf16 v[0:3], v[4:7], v[12:15], v[0:3]
    v_mov_b64 v[12:13], 0
    v_mov_b64 v[14:15], 0
    s_waitcnt vmcnt(3)
    v_bitop3_b32 v77, v77, v16, s69 bitop3:0xf6
    v_mfma_f32_16x16x32_bf16 v[0:3], v[4:7], v[16:19], v[0:3]
    v_mov_b64 v[16:17], 0
    v_mov_b64 v[18:19], 0
    s_waitcnt vmcnt(2)
    v_bitop3_b32 v77, v77, v20, s69 bitop3:0xf6
    v_mfma_f32_16x16x32_bf16 v[0:3], v[4:7], v[20:23], v[0:3]
    v_and_b32 v77, 1, v77
    v_cmp_ne_u32 vcc, 0, v77
    v_mov_b64 v[20:21], 0
    v_mov_b64 v[22:23], 0
    buffer_load_dwordx4 v[40:43], v65, s[4:7], s14 offen offset:0 nt
    buffer_load_dwordx4 v[60:63], v66, s[4:7], s14 offen offset:0 nt
    s_cmp_eq_u64 vcc, 0
    s_cselect_b64 s[42:43], -1, 0
    v_add_f32_dpp v0, v0, v0 row_ror:8 row_mask:0xf bank_mask:0xf
    v_add_f32_dpp v1, v1, v1 row_ror:8 row_mask:0xf bank_mask:0xf
    s_mov_b64 exec, s[42:43]
    v_cvt_pk_bf16_f32 v72, v0, v1
    v_bfi_b32 v72, v79, s70, v72
    buffer_store_dword v72, v75, s[4:7], s17 offen offset:0
    s_mov_b64 exec, -1
    s_cbranch_scc1 cf_f1_rx
    s_sub_u32 s31, s31, 1
    s_cbranch_scc0 cf_f1_spin
cf_f1_rx:
    v_mov_b64 v[0:1], 0
    v_mov_b64 v[2:3], 0
    v_mov_b64 v[4:5], 0
    v_mov_b64 v[6:7], 0
    s_branch cf_loop
cf_f2_xt:
    s_sub_u32 s37, s37, 1
    s_nop 2
    v_mov_b32 v79, v79
    s_nop 2
    v_mov_b32 v79, v79
    s_nop 2
    v_mov_b32 v79, v79
    s_nop 2
    v_mov_b32 v79, v79
    s_nop 2
    v_mov_b32 v79, v79
    s_nop 2
    v_mov_b32 v79, v79
    s_branch cf_f2_xtx
cf_f2_retry:
    s_sub_u32 s41, s30, s98
    s_mov_b32 s98, s30
    s_cmp_le_u32 s41, 3
    s_cselect_b32 s37, 1, 1
cf_f2_spin:
    buffer_load_dwordx4 v[8:11], v65, s[4:7], s18 offen nt
    buffer_load_dwordx4 v[12:15], v65, s[4:7], s19 offen nt
    buffer_load_dwordx4 v[16:19], v65, s[4:7], s20 offen nt
    buffer_load_dwordx4 v[20:23], v65, s[4:7], s21 offen nt
    s_nop 2
    v_mov_b32 v79, v79
    s_nop 2
    v_mov_b32 v79, v79
    s_nop 2
    v_mov_b32 v79, v79
    buffer_load_dwordx4 v[40:43], v65, s[4:7], s14 offen offset:0 nt
    buffer_load_dwordx4 v[60:63], v66, s[4:7], s14 offen offset:0 nt
    s_waitcnt vmcnt(5)
    v_xor_b32 v77, s69, v8
    v_mfma_f32_16x16x32_bf16 v[0:3], v[4:7], v[8:11], 0
    v_mov_b64 v[8:9], 0
    v_mov_b64 v[10:11], 0
    s_waitcnt vmcnt(4)
    v_bitop3_b32 v77, v77, v12, s69 bitop3:0xf6
    v_mfma_f32_16x16x32_bf16 v[0:3], v[4:7], v[12:15], v[0:3]
    v_mov_b64 v[12:13], 0
    v_mov_b64 v[14:15], 0
    s_waitcnt vmcnt(3)
    v_bitop3_b32 v77, v77, v16, s69 bitop3:0xf6
    v_mfma_f32_16x16x32_bf16 v[0:3], v[4:7], v[16:19], v[0:3]
    v_mov_b64 v[16:17], 0
    v_mov_b64 v[18:19], 0
    s_waitcnt vmcnt(2)
    v_bitop3_b32 v77, v77, v20, s69 bitop3:0xf6
    v_mfma_f32_16x16x32_bf16 v[0:3], v[4:7], v[20:23], v[0:3]
    v_and_b32 v77, 1, v77
    v_cmp_ne_u32 vcc, 0, v77
    v_mov_b64 v[20:21], 0
    v_mov_b64 v[22:23], 0
    buffer_load_dwordx4 v[40:43], v65, s[4:7], s14 offen offset:0 nt
    buffer_load_dwordx4 v[60:63], v66, s[4:7], s14 offen offset:0 nt
    s_cmp_eq_u64 vcc, 0
    s_cselect_b64 s[42:43], -1, 0
    v_add_f32_dpp v0, v0, v0 row_ror:4 row_mask:0xf bank_mask:0xf
    v_add_f32_dpp v1, v1, v1 row_ror:4 row_mask:0xf bank_mask:0xf
    s_nop 0
    v_add_f32_dpp v0, v0, v0 row_ror:8 row_mask:0xf bank_mask:0xf
    v_add_f32_dpp v1, v1, v1 row_ror:8 row_mask:0xf bank_mask:0xf
    s_mov_b64 exec, s[42:43]
    v_cvt_pk_bf16_f32 v72, v0, v1
    v_bfi_b32 v72, v79, s70, v72
    buffer_store_dword v72, v75, s[4:7], s17 offen offset:0
    buffer_store_dword v72, v75, s[4:7], s17 offen offset:1024
    buffer_store_dword v72, v75, s[4:7], s17 offen offset:2048
    buffer_store_dword v72, v75, s[4:7], s17 offen offset:3072
    s_mov_b64 exec, -1
    s_cbranch_scc1 cf_f2_rx
    s_sub_u32 s31, s31, 1
    s_cbranch_scc0 cf_f2_spin
cf_f2_rx:
    v_mov_b64 v[0:1], 0
    v_mov_b64 v[2:3], 0
    v_mov_b64 v[4:5], 0
    v_mov_b64 v[6:7], 0
    s_branch cf_loop
cf_spinB:
    s_waitcnt vmcnt(3)
cf_spinB_l:
    v_and_b32 v77, s36, v44
    v_cmp_ne_u32 vcc, s70, v77
    s_cbranch_vccz cf_spinB_x
    buffer_load_dwordx4 v[44:47], v65, s[4:7], s15 offen nt
    s_sub_u32 s31, s31, 16
    s_waitcnt vmcnt(0)
    s_cbranch_scc0 cf_spinB_l
cf_spinB_x:
    ds_write_b128 v65, v[44:47] offset:4096
    s_waitcnt lgkmcnt(0)
    s_branch cf_backB
cf_spin8:
    buffer_load_dwordx4 v[40:43], v65, s[4:7], s16 offen nt
cf_spin8_l:
    v_and_b32 v77, s36, v40
    v_cmp_ne_u32 vcc, s70, v77
    s_cbranch_vccz cf_spin8_x
    s_nop 1
    v_and_b32 v77, s36, v40
    v_cmp_ne_u32 vcc, s70, v77
    s_cbranch_vccz cf_spin8_x
    s_nop 1
    v_and_b32 v77, s36, v40
    v_cmp_ne_u32 vcc, s70, v77
    s_cbranch_vccz cf_spin8_x
    s_nop 1
    buffer_load_dwordx4 v[40:43], v65, s[4:7], s16 offen nt
    s_sub_u32 s31, s31, 16
    s_cbranch_scc0 cf_spin8_l
cf_spin8_x:
    s_branch cf_back8
cf_rare:
    s_mov_b64 exec, s[34:35]
    buffer_store_dwordx4 v[0:3], v65, s[4:7], s28 offen sc1
    s_mov_b64 exec, -1
    s_nop 3
    v_cvt_pk_bf16_f32 v52, v16, v17
    v_cvt_pk_bf16_f32 v53, v18, v19
    v_cvt_pk_bf16_f32 v54, v20, v21
    v_cvt_pk_bf16_f32 v55, v22, v23
    buffer_store_dwordx4 v[52:55], v65, s[4:7], s27 offen sc1
    s_add_u32 s28, s28, 131072
    s_add_u32 s27, s27, 131072
    s_cmp_eq_u32 s30, 63
    s_cbranch_scc1 cf_last
    s_branch cf_rare_x
cf_kvwait:
    s_mov_b32 s41, s97
    v_bfe_u32 v78, v65, 2, 5
    v_mov_b32 v77, v76
    s_nop 1
    v_permlane32_swap_b32 v76, v77
    v_subrev_u32 v77, s95, v77
    v_cmp_lt_u32 vcc, 16, v77
    s_nop 1
    v_cndmask_b32 v77, v77, 0, vcc
    v_bfe_u32 v79, v78, 2, 2
    v_lshl_add_u32 v77, v77, 2, v79
    s_nop 1
    v_min_u32_dpp v77, v77, v77 row_ror:1 row_mask:0xf bank_mask:0xf
    s_nop 1
    v_min_u32_dpp v77, v77, v77 row_ror:2 row_mask:0xf bank_mask:0xf
    s_nop 1
    v_min_u32_dpp v77, v77, v77 row_ror:4 row_mask:0xf bank_mask:0xf
    s_nop 0
    v_readfirstlane_b32 s97, v77
    s_nop 0
    s_max_u32 s97, s97, s41
    s_add_u32 s40, s30, 3
    s_min_u32 s40, s40, 64
    s_cmp_le_u32 s40, s97
    s_cbranch_scc1 cf_kvw_x
    v_bfe_u32 v78, v65, 2, 5
    s_mov_b32 s31, 4194304
cf_kvw:
    buffer_load_dword v77, v78, s[4:7], s96 offen offset:16 sc1
    s_waitcnt vmcnt(0)
    v_subrev_u32 v77, s95, v77
    v_cmp_lt_u32 vcc, 16, v77
    s_nop 1
    v_cndmask_b32 v77, v77, 0, vcc
    v_bfe_u32 v79, v78, 2, 2
    v_lshl_add_u32 v77, v77, 2, v79
    s_nop 1
    v_min_u32_dpp v77, v77, v77 row_ror:1 row_mask:0xf bank_mask:0xf
    s_nop 1
    v_min_u32_dpp v77, v77, v77 row_ror:2 row_mask:0xf bank_mask:0xf
    s_nop 1
    v_min_u32_dpp v77, v77, v77 row_ror:4 row_mask:0xf bank_mask:0xf
    s_nop 0
    v_readfirstlane_b32 s97, v77
    s_sub_u32 s31, s31, 1
    s_cbranch_scc1 cf_kvw_x
    s_cmp_le_u32 s40, s97
    s_cbranch_scc1 cf_kvw_x
    s_sleep 2
    s_branch cf_kvw
cf_kvw_x:
    s_branch cf_kvok
cf_last:
    s_add_u32 s40, s95, 64
    v_mov_b32 v78, s40
    s_waitcnt vmcnt(0)
    s_barrier
    s_mov_b64 exec, s[100:101]
    buffer_store_dword v78, off, s[4:7], s29 sc1
    s_mov_b64 exec, -1
cf_end:
    s_endpgm
L_chain_safe:
    s_load_dwordx8 s[48:55], s[0:1], 8
    s_load_dwordx2 s[56:57], s[0:1], 40
    s_waitcnt lgkmcnt(0)
    v_lshrrev_b32 v77, 6, v0
    s_nop 0
    v_readfirstlane_b32 s13, v77
    v_lshlrev_b32 v65, 4, v0
    v_and_b32 v48, 63, v0
    s_mov_b32 s10, 4718592
    s_mov_b32 s11, 0x20000
    v_lshrrev_b32 v49, 3, v48
    v_mul_u32_u24 v18, 1152, v49
    v_and_b32 v49, 7, v48
    v_lshl_add_u32 v18, v49, 4, v18
    s_mul_i32 s40, s12, 147456
    s_lshl_b32 s41, s13, 8
    s_add_u32 s40, s40, s41
    s_mov_b32 s42, s40
    s_xor_b32 s41, s13, 0
    s_mul_i32 s41, s41, 36864
    s_add_u32 s60, s41, s40
    s_xor_b32 s41, s13, 1
    s_mul_i32 s41, s41, 36864
    s_add_u32 s61, s41, s40
    s_xor_b32 s41, s13, 2
    s_mul_i32 s41, s41, 36864
    s_add_u32 s62, s41, s40
    s_xor_b32 s41, s13, 3
    s_mul_i32 s41, s41, 36864
    s_add_u32 s63, s41, s40
    s_lshl_b32 s43, s13, 12
    s_mov_b64 s[8:9], s[56:57]
    s_add_u32 m0, s43, 0
    s_add_u32 s41, s60, 0
    buffer_load_dwordx4 v18, s[8:11], s41 offen offset:0 nt lds
    s_add_u32 s41, s60, 8192
    buffer_load_dwordx4 v18, s[8:11], s41 offen offset:1024 nt lds
    s_add_u32 s41, s60, 16384
    buffer_load_dwordx4 v18, s[8:11], s41 offen offset:2048 nt lds
    s_add_u32 s41, s60, 24576
    buffer_load_dwordx4 v18, s[8:11], s41 offen offset:3072 nt lds
    s_add_u32 m0, s43, 36864
    s_add_u32 s41, s61, 0
    buffer_load_dwordx4 v18, s[8:11], s41 offen offset:0 nt lds
    s_add_u32 s41, s61, 8192
    buffer_load_dwordx4 v18, s[8:11], s41 offen offset:1024 nt lds
    s_add_u32 s41, s61, 16384
    buffer_load_dwordx4 v18, s[8:11], s41 offen offset:2048 nt lds
    s_add_u32 s41, s61, 24576
    buffer_load_dwordx4 v18, s[8:11], s41 offen offset:3072 nt lds
    s_add_u32 m0, s43, 73728
    s_add_u32 s41, s62, 0
    buffer_load_dwordx4 v18, s[8:11], s41 offen offset:0 nt lds
    s_add_u32 s41, s62, 8192
    buffer_load_dwordx4 v18, s[8:11], s41 offen offset:1024 nt lds
    s_add_u32 s41, s62, 16384
    buffer_load_dwordx4 v18, s[8:11], s41 offen offset:2048 nt lds
    s_add_u32 s41, s62, 24576
    buffer_load_dwordx4 v18, s[8:11], s41 offen offset:3072 nt lds
    s_add_u32 m0, s43, 110592
    s_add_u32 s41, s63, 0
    buffer_load_dwordx4 v18, s[8:11], s41 offen offset:0 nt lds
    s_add_u32 s41, s63, 8192
    buffer_load_dwordx4 v18, s[8:11], s41 offen offset:1024 nt lds
    s_add_u32 s41, s63, 16384
    buffer_load_dwordx4 v18, s[8:11], s41 offen offset:2048 nt lds
    s_add_u32 s41, s63, 24576
    buffer_load_dwordx4 v18, s[8:11], s41 offen offset:3072 nt lds
    v_lshrrev_b32 v49, 1, v48
    v_mul_u32_u24 v19, 1152, v49
    v_and_b32 v49, 1, v48
    v_lshl_add_u32 v19, v49, 4, v19
    s_mul_i32 s41, s13, 224
    s_sub_u32 s41, 1024, s41
    v_add_u32 v19, s41, v19
    v_lshrrev_b32 v49, 4, v48
    v_lshlrev_b32 v50, 2, v49
    v_and_b32 v51, 15, v48
    v_xor_b32 v51, v51, v50
    v_lshlrev_b32 v51, 4, v51
    v_lshl_add_u32 v16, v49, 15, v51
    v_lshrrev_b32 v50, 1, v49
    v_lshl_add_u32 v17, v50, 16, v51
    v_and_b32 v50, 1, v49
    v_lshl_add_u32 v17, v50, 13, v17
    s_lshl_b32 s40, s12, 8
    s_mul_i32 s58, s13, 1048576
    s_add_u32 s58, s58, s40
    s_lshr_b32 s41, s13, 1
    s_mul_i32 s59, s41, 262144
    s_and_b32 s41, s13, 1
    s_lshl_b32 s41, s41, 14
    s_add_u32 s59, s59, s41
    s_add_u32 s59, s59, s40
    s_add_u32 s59, s59, 4194304
    v_bfe_u32 v50, v48, 2, 2
    v_xor_b32 v51, s13, v50
    v_lshlrev_b32 v20, 6, v51
    v_and_b32 v51, 3, v48
    v_lshl_add_u32 v20, v51, 4, v20
    v_lshrrev_b32 v23, 2, v48
    v_lshl_add_u32 v20, v23, 8, v20
    s_xor_b32 s41, s43, 0
    v_add_u32 v24, s41, v20
    s_xor_b32 s41, s43, 4096
    v_add_u32 v25, s41, v20
    s_xor_b32 s41, s43, 8192
    v_add_u32 v26, s41, v20
    s_xor_b32 s41, s43, 12288
    v_add_u32 v27, s41, v20
    v_and_b32 v23, 1, v50
    v_lshl_add_u32 v23, v49, 2, v23
    v_lshrrev_b32 v50, 1, v50
    v_lshlrev_b32 v21, 7, v23
    v_lshl_add_u32 v21, v50, 6, v21
    v_lshrrev_b32 v16, 1, v51
    v_lshl_add_u32 v21, v16, 5, v21
    v_and_b32 v16, 1, v51
    v_lshl_add_u32 v21, v16, 3, v21
    v_add_u32 v21, s43, v21
    v_lshlrev_b32 v22, 9, v50
    v_xor_b32 v22, v22, v21
    v_lshlrev_b32 v23, 5, v23
    v_lshl_add_u32 v23, v50, 10, v23
    v_lshl_add_u32 v23, v51, 3, v23
    v_add_u32 v23, s43, v23
    v_bfe_u32 v60, v65, 4, 6
    v_and_b32 v61, 15, v60
    v_lshrrev_b32 v62, 4, v60
    v_mov_b32 v64, 0x4444
    v_mov_b32 v77, 0xeeee
    v_cmp_lt_u32 vcc, 7, v61
    s_nop 1
    v_cndmask_b32 v64, v64, v77, vcc
    v_xor_b32 v66, 1024, v65
    v_xor_b32 v67, 2048, v65
    v_xor_b32 v68, 3072, v65
    v_and_b32 v69, 511, v65
    s_mul_i32 s96, s13, 36864
    s_add_u32 s96, s96, 16384
    v_lshlrev_b32 v70, 4, v60
    v_add_u32 v70, s96, v70
    v_lshrrev_b32 v79, 1, v69
    s_lshl_b32 s96, s13, 8
    s_add_u32 s96, s96, 14336
    s_lshl_b32 s33, s13, 10
    s_add_u32 s97, s33, 8192
    v_mov_b32 v77, s97
    v_mov_b32 v78, s96
    v_cmp_lt_u32 vcc, 31, v60
    s_nop 1
    v_cndmask_b32 v71, v77, v78, vcc
    v_add_u32 v71, v71, v79
    v_and_b32 v77, 7, v61
    v_lshrrev_b32 v78, 3, v61
    v_lshlrev_b32 v74, 4, v77
    v_lshl_add_u32 v73, v62, 7, v74
    v_lshl_add_u32 v73, v78, 3, v73
    s_lshl_b32 s96, s13, 9
    v_add_u32 v73, s96, v73
    v_lshrrev_b32 v74, 1, v74
    v_lshl_add_u32 v74, v78, 14, v74
    v_lshl_add_u32 v74, v62, 15, v74
    s_lshl_b32 s96, s13, 17
    v_add_u32 v74, s96, v74
    v_bfe_u32 v77, v61, 2, 1
    v_and_b32 v78, 3, v61
    s_cmp_lt_u32 s13, 2
    s_cselect_b64 vcc, -1, 0
    v_cndmask_b32 v77, 0, v77, vcc
    v_lshlrev_b32 v75, 7, v77
    v_lshl_add_u32 v75, v62, 4, v75
    v_lshl_add_u32 v75, v78, 2, v75
    v_lshlrev_b32 v58, 3, v77
    v_lshl_add_u32 v58, v78, 1, v58
    s_bfe_u32 s97, s12, 0x10001
    s_lshl_b32 s68, s97, 6
    s_lshl_b32 s97, s97, 2
    v_add_u32 v59, s97, v62
    s_bfe_u32 s96, s12, 0x10002
    s_and_b32 s40, s12, 1
    s_lshl_b32 s96, s96, 1
    s_add_u32 s96, s96, s40
    s_lshr_b32 s97, s12, 3
    s_lshl_b32 s98, s13, 2
    s_add_u32 s98, s98, s97
    s_lshl_b32 s98, s98, 2
    s_add_u32 s98, s98, s96
    s_lshl_b32 s98, s98, 8
    s_lshl_b32 s99, s13, 2
    s_add_u32 s99, s99, s96
    s_lshl_b32 s99, s99, 4
    s_lshl_b32 s41, s97, 1
    s_add_u32 s41, s41, s40
    s_lshl_b32 s41, s41, 7
    s_add_u32 s41, s41, 8192
    s_lshl_b32 s40, s40, 3
    s_add_u32 s40, s40, 512
    s_cmp_lt_u32 s13, 2
    s_cselect_b32 s96, 7, 4
    s_cselect_b32 s98, s98, s41
    s_cselect_b32 s99, s99, s40
    s_cselect_b32 s32, 1, 0
    s_add_u32 s68, s68, s98
    s_lshl_b32 s97, s97, s96
    s_add_u32 s99, s99, s97
    v_add_u32 v58, s99, v58
    s_and_b32 s97, s12, 4
    s_or_b32 s97, s97, s13
    s_cmp_eq_u32 s97, 2
    s_cselect_b32 s32, 2, s32
    s_mov_b32 s8, s48
    s_mov_b32 s9, s49
    s_mov_b32 s10, 9216
    v_mul_u32_u24 v77, 1152, v59
    v_lshl_add_u32 v77, v58, 1, v77
    buffer_load_dword v72, v77, s[8:11], 0 offen
    s_mov_b32 s10, 4718592
    s_waitcnt vmcnt(12) lgkmcnt(0)
    s_barrier
    s_mov_b64 s[8:9], s[56:57]
    s_add_u32 m0, s43, 147456
    s_add_u32 s41, s42, 0
    buffer_load_dwordx4 v19, s[8:11], s41 offen offset:0 nt lds
    s_add_u32 s41, s42, 35840
    buffer_load_dwordx4 v19, s[8:11], s41 offen offset:1024 nt lds
    s_add_u32 s41, s42, 71680
    buffer_load_dwordx4 v19, s[8:11], s41 offen offset:2048 nt lds
    s_add_u32 s41, s42, 107520
    buffer_load_dwordx4 v19, s[8:11], s41 offen offset:3072 nt lds
    v_mov_b32 v78, v21
    v_mov_b32 v79, v22
    v_add_u32 v77, 0, v79
    ds_read_b64_tr_b16 v[80:81], v77 offset:0
    ds_read_b64_tr_b16 v[82:83], v77 offset:256
    ds_read_b64_tr_b16 v[84:85], v77 offset:2048
    ds_read_b64_tr_b16 v[86:87], v77 offset:2304
    ds_read_b64_tr_b16 v[112:113], v77 offset:16
    ds_read_b64_tr_b16 v[114:115], v77 offset:272
    ds_read_b64_tr_b16 v[116:117], v77 offset:2064
    ds_read_b64_tr_b16 v[118:119], v77 offset:2320
    s_waitcnt vmcnt(12) lgkmcnt(0)
    s_barrier
    s_mov_b64 s[8:9], s[52:53]
    s_add_u32 m0, s43, 0
    s_add_u32 s41, s58, 0
    buffer_load_dwordx4 v17, s[8:11], s41 offen offset:0 nt lds
    s_add_u32 s41, s58, 31744
    buffer_load_dwordx4 v17, s[8:11], s41 offen offset:1024 nt lds
    s_add_u32 s41, s58, 129024
    buffer_load_dwordx4 v17, s[8:11], s41 offen offset:2048 nt lds
    s_add_u32 s41, s58, 160768
    buffer_load_dwordx4 v17, s[8:11], s41 offen offset:3072 nt lds
    v_add_u32 v77, 36864, v78
    ds_read_b64_tr_b16 v[88:89], v77 offset:0
    ds_read_b64_tr_b16 v[90:91], v77 offset:256
    ds_read_b64_tr_b16 v[92:93], v77 offset:2048
    ds_read_b64_tr_b16 v[94:95], v77 offset:2304
    ds_read_b64_tr_b16 v[120:121], v77 offset:16
    ds_read_b64_tr_b16 v[122:123], v77 offset:272
    ds_read_b64_tr_b16 v[124:125], v77 offset:2064
    ds_read_b64_tr_b16 v[126:127], v77 offset:2320
    s_waitcnt vmcnt(12) lgkmcnt(0)
    s_barrier
    s_add_u32 m0, s43, 36864
    s_add_u32 s41, s58, 16384
    buffer_load_dwordx4 v17, s[8:11], s41 offen offset:0 nt lds
    s_add_u32 s41, s58, 48128
    buffer_load_dwordx4 v17, s[8:11], s41 offen offset:1024 nt lds
    s_add_u32 s41, s58, 145408
    buffer_load_dwordx4 v17, s[8:11], s41 offen offset:2048 nt lds
    s_add_u32 s41, s58, 177152
    buffer_load_dwordx4 v17, s[8:11], s41 offen offset:3072 nt lds
    v_add_u32 v77, 73728, v78
    ds_read_b64_tr_b16 v[96:97], v77 offset:0
    ds_read_b64_tr_b16 v[98:99], v77 offset:256
    ds_read_b64_tr_b16 v[100:101], v77 offset:2048
    ds_read_b64_tr_b16 v[102:103], v77 offset:2304
    ds_read_b64_tr_b16 v[128:129], v77 offset:16
    ds_read_b64_tr_b16 v[130:131], v77 offset:272
    ds_read_b64_tr_b16 v[132:133], v77 offset:2064
    ds_read_b64_tr_b16 v[134:135], v77 offset:2320
    s_waitcnt vmcnt(12) lgkmcnt(0)
    s_barrier
    s_add_u32 m0, s43, 73728
    s_add_u32 s41, s58, 262144
    buffer_load_dwordx4 v17, s[8:11], s41 offen offset:0 nt lds
    s_add_u32 s41, s58, 293888
    buffer_load_dwordx4 v17, s[8:11], s41 offen offset:1024 nt lds
    s_add_u32 s41, s58, 391168
    buffer_load_dwordx4 v17, s[8:11], s41 offen offset:2048 nt lds
    s_add_u32 s41, s58, 422912
    buffer_load_dwordx4 v17, s[8:11], s41 offen offset:3072 nt lds
    v_add_u32 v77, 110592, v78
    ds_read_b64_tr_b16 v[104:105], v77 offset:0
    ds_read_b64_tr_b16 v[106:107], v77 offset:256
    ds_read_b64_tr_b16 v[108:109], v77 offset:2048
    ds_read_b64_tr_b16 v[110:111], v77 offset:2304
    ds_read_b64_tr_b16 v[136:137], v77 offset:16
    ds_read_b64_tr_b16 v[138:139], v77 offset:272
    ds_read_b64_tr_b16 v[140:141], v77 offset:2064
    ds_read_b64_tr_b16 v[142:143], v77 offset:2320
    s_waitcnt vmcnt(12) lgkmcnt(0)
    s_barrier
    s_add_u32 m0, s43, 110592
    s_add_u32 s41, s58, 278528
    buffer_load_dwordx4 v17, s[8:11], s41 offen offset:0 nt lds
    s_add_u32 s41, s58, 310272
    buffer_load_dwordx4 v17, s[8:11], s41 offen offset:1024 nt lds
    s_add_u32 s41, s58, 407552
    buffer_load_dwordx4 v17, s[8:11], s41 offen offset:2048 nt lds
    s_add_u32 s41, s58, 439296
    buffer_load_dwordx4 v17, s[8:11], s41 offen offset:3072 nt lds
    v_add_u32 v77, 147456, v23
    ds_read_b64_tr_b16 v[0:1], v77 offset:0
    ds_read_b64_tr_b16 v[2:3], v77 offset:64
    ds_read_b64_tr_b16 v[4:5], v77 offset:512
    ds_read_b64_tr_b16 v[6:7], v77 offset:576
    ds_read_b64_tr_b16 v[8:9], v77 offset:2048
    ds_read_b64_tr_b16 v[10:11], v77 offset:2112
    ds_read_b64_tr_b16 v[12:13], v77 offset:2560
    ds_read_b64_tr_b16 v[14:15], v77 offset:2624
    s_waitcnt vmcnt(12) lgkmcnt(0)
    s_barrier
    s_add_u32 m0, s43, 147456
    s_add_u32 s41, s58, 524288
    buffer_load_dwordx4 v17, s[8:11], s41 offen offset:0 nt lds
    s_add_u32 s41, s58, 556032
    buffer_load_dwordx4 v17, s[8:11], s41 offen offset:1024 nt lds
    s_add_u32 s41, s58, 653312
    buffer_load_dwordx4 v17, s[8:11], s41 offen offset:2048 nt lds
    s_add_u32 s41, s58, 685056
    buffer_load_dwordx4 v17, s[8:11], s41 offen offset:3072 nt lds
    s_cmp_eq_u32 s32, 0
    s_cbranch_scc1 cs_init_done
    v_mov_b32 v52, 1
    v_mov_b32 v53, 1
    v_mov_b32 v54, 1
    v_mov_b32 v55, 1
    v_mov_b32 v56, 0
    s_lshl_b32 s96, s12, 14
    s_add_u32 s96, s96, 68681728
    s_add_u32 s97, s96, 0
    buffer_store_dwordx4 v[52:55], v65, s[4:7], s97 offen sc1
    s_add_u32 s97, s96, 4096
    buffer_store_dwordx4 v[52:55], v65, s[4:7], s97 offen sc1
    s_add_u32 s97, s96, 8192
    buffer_store_dwordx4 v[52:55], v65, s[4:7], s97 offen sc1
    s_add_u32 s97, s96, 12288
    buffer_store_dwordx4 v[52:55], v65, s[4:7], s97 offen sc1
    s_add_u32 s96, s68, 67633152
    s_add_u32 s97, s96, 16384
    buffer_store_dword v56, v75, s[4:7], s96 offen offset:0 sc1
    buffer_store_dword v72, v75, s[4:7], s97 offen offset:0 sc1
    s_cmp_lg_u32 s32, 2
    s_cbranch_scc1 cs_init_done
    buffer_store_dword v56, v75, s[4:7], s96 offen offset:1024 sc1
    buffer_store_dword v72, v75, s[4:7], s97 offen offset:1024 sc1
    buffer_store_dword v56, v75, s[4:7], s96 offen offset:2048 sc1
    buffer_store_dword v72, v75, s[4:7], s97 offen offset:2048 sc1
    buffer_store_dword v56, v75, s[4:7], s96 offen offset:3072 sc1
    buffer_store_dword v72, v75, s[4:7], s97 offen offset:3072 sc1
cs_init_done:
    ds_write_b64 v70, v[0:1] offset:16384
    ds_write_b64 v70, v[2:3] offset:16392
    ds_write_b64 v70, v[4:5] offset:17408
    ds_write_b64 v70, v[6:7] offset:17416
    ds_write_b64 v70, v[8:9] offset:18432
    ds_write_b64 v70, v[10:11] offset:18440
    ds_write_b64 v70, v[12:13] offset:19456
    ds_write_b64 v70, v[14:15] offset:19464
    v_add_u32 v28, 0, v24
    v_add_u32 v29, 0, v25
    v_add_u32 v30, 0, v26
    v_add_u32 v31, 0, v27
    ds_read_b64_tr_b16 a[96:97], v28 offset:0
    ds_read_b64_tr_b16 a[104:105], v28 offset:8
    ds_read_b64_tr_b16 a[112:113], v29 offset:0
    ds_read_b64_tr_b16 a[120:121], v29 offset:8
    ds_read_b64_tr_b16 a[128:129], v30 offset:0
    ds_read_b64_tr_b16 a[136:137], v30 offset:8
    ds_read_b64_tr_b16 a[144:145], v31 offset:0
    ds_read_b64_tr_b16 v[32:33], v31 offset:8
    s_waitcnt vmcnt(12) lgkmcnt(0)
    s_barrier
    s_add_u32 m0, s43, 0
    s_add_u32 s41, s58, 540672
    buffer_load_dwordx4 v17, s[8:11], s41 offen offset:0 nt lds
    s_add_u32 s41, s58, 572416
    buffer_load_dwordx4 v17, s[8:11], s41 offen offset:1024 nt lds
    s_add_u32 s41, s58, 669696
    buffer_load_dwordx4 v17, s[8:11], s41 offen offset:2048 nt lds
    s_add_u32 s41, s58, 701440
    buffer_load_dwordx4 v17, s[8:11], s41 offen offset:3072 nt lds
    ds_write_b64 v70, v[32:33] offset:12288
    v_add_u32 v28, 36864, v24
    v_add_u32 v29, 36864, v25
    v_add_u32 v30, 36864, v26
    v_add_u32 v31, 36864, v27
    ds_read_b64_tr_b16 a[98:99], v28 offset:0
    ds_read_b64_tr_b16 a[106:107], v28 offset:8
    ds_read_b64_tr_b16 a[114:115], v29 offset:0
    ds_read_b64_tr_b16 a[122:123], v29 offset:8
    ds_read_b64_tr_b16 a[130:131], v30 offset:0
    ds_read_b64_tr_b16 a[138:139], v30 offset:8
    ds_read_b64_tr_b16 a[146:147], v31 offset:0
    ds_read_b64_tr_b16 v[0:1], v31 offset:8
    s_waitcnt vmcnt(12) lgkmcnt(0)
    s_barrier
    s_add_u32 m0, s43, 36864
    s_add_u32 s41, s58, 786432
    buffer_load_dwordx4 v17, s[8:11], s41 offen offset:0 nt lds
    s_add_u32 s41, s58, 818176
    buffer_load_dwordx4 v17, s[8:11], s41 offen offset:1024 nt lds
    s_add_u32 s41, s58, 915456
    buffer_load_dwordx4 v17, s[8:11], s41 offen offset:2048 nt lds
    s_add_u32 s41, s58, 947200
    buffer_load_dwordx4 v17, s[8:11], s41 offen offset:3072 nt lds
    ds_write_b64 v70, v[0:1] offset:12296
    v_add_u32 v28, 73728, v24
    v_add_u32 v29, 73728, v25
    v_add_u32 v30, 73728, v26
    v_add_u32 v31, 73728, v27
    ds_read_b64_tr_b16 a[100:101], v28 offset:0
    ds_read_b64_tr_b16 a[108:109], v28 offset:8
    ds_read_b64_tr_b16 a[116:117], v29 offset:0
    ds_read_b64_tr_b16 a[124:125], v29 offset:8
    ds_read_b64_tr_b16 a[132:133], v30 offset:0
    ds_read_b64_tr_b16 a[140:141], v30 offset:8
    ds_read_b64_tr_b16 a[148:149], v31 offset:0
    ds_read_b64_tr_b16 v[32:33], v31 offset:8
    s_waitcnt vmcnt(12) lgkmcnt(0)
    s_barrier
    s_add_u32 m0, s43, 73728
    s_add_u32 s41, s58, 802816
    buffer_load_dwordx4 v17, s[8:11], s41 offen offset:0 nt lds
    s_add_u32 s41, s58, 834560
    buffer_load_dwordx4 v17, s[8:11], s41 offen offset:1024 nt lds
    s_add_u32 s41, s58, 931840
    buffer_load_dwordx4 v17, s[8:11], s41 offen offset:2048 nt lds
    s_add_u32 s41, s58, 963584
    buffer_load_dwordx4 v17, s[8:11], s41 offen offset:3072 nt lds
    ds_write_b64 v70, v[32:33] offset:13312
    v_add_u32 v28, 110592, v24
    v_add_u32 v29, 110592, v25
    v_add_u32 v30, 110592, v26
    v_add_u32 v31, 110592, v27
    ds_read_b64_tr_b16 a[102:103], v28 offset:0
    ds_read_b64_tr_b16 a[110:111], v28 offset:8
    ds_read_b64_tr_b16 a[118:119], v29 offset:0
    ds_read_b64_tr_b16 a[126:127], v29 offset:8
    ds_read_b64_tr_b16 a[134:135], v30 offset:0
    ds_read_b64_tr_b16 a[142:143], v30 offset:8
    ds_read_b64_tr_b16 a[150:151], v31 offset:0
    ds_read_b64_tr_b16 v[0:1], v31 offset:8
    s_waitcnt vmcnt(12) lgkmcnt(0)
    s_barrier
    s_add_u32 m0, s43, 110592
    s_add_u32 s41, s59, 0
    buffer_load_dwordx4 v17, s[8:11], s41 offen offset:0 nt lds
    s_add_u32 s41, s59, 31744
    buffer_load_dwordx4 v17, s[8:11], s41 offen offset:1024 nt lds
    s_add_u32 s41, s59, 129024
    buffer_load_dwordx4 v17, s[8:11], s41 offen offset:2048 nt lds
    s_add_u32 s41, s59, 160768
    buffer_load_dwordx4 v17, s[8:11], s41 offen offset:3072 nt lds
    ds_write_b64 v70, v[0:1] offset:13320
    v_add_u32 v28, 147456, v24
    v_add_u32 v29, 147456, v25
    v_add_u32 v30, 147456, v26
    v_add_u32 v31, 147456, v27
    ds_read_b64_tr_b16 a[152:153], v28 offset:0
    ds_read_b64_tr_b16 a[160:161], v28 offset:8
    ds_read_b64_tr_b16 a[168:169], v29 offset:0
    ds_read_b64_tr_b16 a[176:177], v29 offset:8
    ds_read_b64_tr_b16 a[184:185], v30 offset:0
    ds_read_b64_tr_b16 a[192:193], v30 offset:8
    ds_read_b64_tr_b16 a[200:201], v31 offset:0
    ds_read_b64_tr_b16 a[208:209], v31 offset:8
    s_waitcnt vmcnt(12) lgkmcnt(0)
    s_barrier
    s_mov_b64 s[8:9], s[50:51]
    s_add_u32 m0, s43, 147456
    s_add_u32 s41, s58, 0
    buffer_load_dwordx4 v17, s[8:11], s41 offen offset:0 nt lds
    s_add_u32 s41, s58, 31744
    buffer_load_dwordx4 v17, s[8:11], s41 offen offset:1024 nt lds
    s_add_u32 s41, s58, 129024
    buffer_load_dwordx4 v17, s[8:11], s41 offen offset:2048 nt lds
    s_add_u32 s41, s58, 160768
    buffer_load_dwordx4 v17, s[8:11], s41 offen offset:3072 nt lds
    v_add_u32 v28, 0, v24
    v_add_u32 v29, 0, v25
    v_add_u32 v30, 0, v26
    v_add_u32 v31, 0, v27
    ds_read_b64_tr_b16 a[154:155], v28 offset:0
    ds_read_b64_tr_b16 a[162:163], v28 offset:8
    ds_read_b64_tr_b16 a[170:171], v29 offset:0
    ds_read_b64_tr_b16 a[178:179], v29 offset:8
    ds_read_b64_tr_b16 a[186:187], v30 offset:0
    ds_read_b64_tr_b16 a[194:195], v30 offset:8
    ds_read_b64_tr_b16 a[202:203], v31 offset:0
    ds_read_b64_tr_b16 a[210:211], v31 offset:8
    s_waitcnt vmcnt(12) lgkmcnt(0)
    s_barrier
    s_add_u32 m0, s43, 0
    s_add_u32 s41, s58, 16384
    buffer_load_dwordx4 v17, s[8:11], s41 offen offset:0 nt lds
    s_add_u32 s41, s58, 48128
    buffer_load_dwordx4 v17, s[8:11], s41 offen offset:1024 nt lds
    s_add_u32 s41, s58, 145408
    buffer_load_dwordx4 v17, s[8:11], s41 offen offset:2048 nt lds
    s_add_u32 s41, s58, 177152
    buffer_load_dwordx4 v17, s[8:11], s41 offen offset:3072 nt lds
    v_add_u32 v28, 36864, v24
    v_add_u32 v29, 36864, v25
    v_add_u32 v30, 36864, v26
    v_add_u32 v31, 36864, v27
    ds_read_b64_tr_b16 a[156:157], v28 offset:0
    ds_read_b64_tr_b16 a[164:165], v28 offset:8
    ds_read_b64_tr_b16 a[172:173], v29 offset:0
    ds_read_b64_tr_b16 a[180:181], v29 offset:8
    ds_read_b64_tr_b16 a[188:189], v30 offset:0
    ds_read_b64_tr_b16 a[196:197], v30 offset:8
    ds_read_b64_tr_b16 a[204:205], v31 offset:0
    ds_read_b64_tr_b16 a[212:213], v31 offset:8
    s_waitcnt vmcnt(12) lgkmcnt(0)
    s_barrier
    s_add_u32 m0, s43, 36864
    s_add_u32 s41, s58, 262144
    buffer_load_dwordx4 v17, s[8:11], s41 offen offset:0 nt lds
    s_add_u32 s41, s58, 293888
    buffer_load_dwordx4 v17, s[8:11], s41 offen offset:1024 nt lds
    s_add_u32 s41, s58, 391168
    buffer_load_dwordx4 v17, s[8:11], s41 offen offset:2048 nt lds
    s_add_u32 s41, s58, 422912
    buffer_load_dwordx4 v17, s[8:11], s41 offen offset:3072 nt lds
    v_add_u32 v28, 73728, v24
    v_add_u32 v29, 73728, v25
    v_add_u32 v30, 73728, v26
    v_add_u32 v31, 73728, v27
    ds_read_b64_tr_b16 a[158:159], v28 offset:0
    ds_read_b64_tr_b16 a[166:167], v28 offset:8
    ds_read_b64_tr_b16 a[174:175], v29 offset:0
    ds_read_b64_tr_b16 a[182:183], v29 offset:8
    ds_read_b64_tr_b16 a[190:191], v30 offset:0
    ds_read_b64_tr_b16 a[198:199], v30 offset:8
    ds_read_b64_tr_b16 a[206:207], v31 offset:0
    ds_read_b64_tr_b16 a[214:215], v31 offset:8
    s_waitcnt vmcnt(12) lgkmcnt(0)
    s_barrier
    s_add_u32 m0, s43, 73728
    s_add_u32 s41, s58, 278528
    buffer_load_dwordx4 v17, s[8:11], s41 offen offset:0 nt lds
    s_add_u32 s41, s58, 310272
    buffer_load_dwordx4 v17, s[8:11], s41 offen offset:1024 nt lds
    s_add_u32 s41, s58, 407552
    buffer_load_dwordx4 v17, s[8:11], s41 offen offset:2048 nt lds
    s_add_u32 s41, s58, 439296
    buffer_load_dwordx4 v17, s[8:11], s41 offen offset:3072 nt lds
    v_add_u32 v77, 110592, v20
    ds_read_b64_tr_b16 a[216:217], v77 offset:0
    ds_read_b64_tr_b16 a[218:219], v77 offset:4096
    ds_read_b64_tr_b16 a[220:221], v77 offset:8192
    ds_read_b64_tr_b16 a[222:223], v77 offset:12288
    ds_read_b64_tr_b16 a[224:225], v77 offset:8
    ds_read_b64_tr_b16 a[226:227], v77 offset:4104
    ds_read_b64_tr_b16 a[228:229], v77 offset:8200
    ds_read_b64_tr_b16 a[230:231], v77 offset:12296
    s_waitcnt vmcnt(12) lgkmcnt(0)
    s_barrier
    s_add_u32 m0, s43, 110592
    s_add_u32 s41, s58, 524288
    buffer_load_dwordx4 v17, s[8:11], s41 offen offset:0 nt lds
    s_add_u32 s41, s58, 556032
    buffer_load_dwordx4 v17, s[8:11], s41 offen offset:1024 nt lds
    s_add_u32 s41, s58, 653312
    buffer_load_dwordx4 v17, s[8:11], s41 offen offset:2048 nt lds
    s_add_u32 s41, s58, 685056
    buffer_load_dwordx4 v17, s[8:11], s41 offen offset:3072 nt lds
    v_add_u32 v28, 147456, v24
    v_add_u32 v29, 147456, v25
    v_add_u32 v30, 147456, v26
    v_add_u32 v31, 147456, v27
    ds_read_b64_tr_b16 v[0:1], v28 offset:0
    ds_read_b64_tr_b16 v[2:3], v28 offset:8
    ds_read_b64_tr_b16 v[4:5], v29 offset:0
    ds_read_b64_tr_b16 v[6:7], v29 offset:8
    ds_read_b64_tr_b16 a[0:1], v30 offset:0
    ds_read_b64_tr_b16 v[8:9], v30 offset:8
    ds_read_b64_tr_b16 a[8:9], v31 offset:0
    ds_read_b64_tr_b16 v[10:11], v31 offset:8
    s_waitcnt vmcnt(12) lgkmcnt(0)
    s_barrier
    s_add_u32 m0, s43, 147456
    s_add_u32 s41, s58, 540672
    buffer_load_dwordx4 v17, s[8:11], s41 offen offset:0 nt lds
    s_add_u32 s41, s58, 572416
    buffer_load_dwordx4 v17, s[8:11], s41 offen offset:1024 nt lds
    s_add_u32 s41, s58, 669696
    buffer_load_dwordx4 v17, s[8:11], s41 offen offset:2048 nt lds
    s_add_u32 s41, s58, 701440
    buffer_load_dwordx4 v17, s[8:11], s41 offen offset:3072 nt lds
    ds_write_b64 v70, v[0:1] offset:0
    ds_write_b64 v70, v[2:3] offset:2048
    ds_write_b64 v70, v[4:5] offset:4096
    ds_write_b64 v70, v[6:7] offset:6144
    ds_write_b64 v70, v[8:9] offset:10240
    ds_write_b64 v70, v[10:11] offset:14336
    v_add_u32 v28, 0, v24
    v_add_u32 v29, 0, v25
    v_add_u32 v30, 0, v26
    v_add_u32 v31, 0, v27
    ds_read_b64_tr_b16 v[32:33], v28 offset:0
    ds_read_b64_tr_b16 v[34:35], v28 offset:8
    ds_read_b64_tr_b16 v[36:37], v29 offset:0
    ds_read_b64_tr_b16 v[38:39], v29 offset:8
    ds_read_b64_tr_b16 a[2:3], v30 offset:0
    ds_read_b64_tr_b16 v[40:41], v30 offset:8
    ds_read_b64_tr_b16 a[10:11], v31 offset:0
    ds_read_b64_tr_b16 v[42:43], v31 offset:8
    s_waitcnt vmcnt(12) lgkmcnt(0)
    s_barrier
    s_add_u32 m0, s43, 0
    s_add_u32 s41, s58, 786432
    buffer_load_dwordx4 v17, s[8:11], s41 offen offset:0 nt lds
    s_add_u32 s41, s58, 818176
    buffer_load_dwordx4 v17, s[8:11], s41 offen offset:1024 nt lds
    s_add_u32 s41, s58, 915456
    buffer_load_dwordx4 v17, s[8:11], s41 offen offset:2048 nt lds
    s_add_u32 s41, s58, 947200
    buffer_load_dwordx4 v17, s[8:11], s41 offen offset:3072 nt lds
    ds_write_b64 v70, v[32:33] offset:8
    ds_write_b64 v70, v[34:35] offset:2056
    ds_write_b64 v70, v[36:37] offset:4104
    ds_write_b64 v70, v[38:39] offset:6152
    ds_write_b64 v70, v[40:41] offset:10248
    ds_write_b64 v70, v[42:43] offset:14344
    v_add_u32 v28, 36864, v24
    v_add_u32 v29, 36864, v25
    v_add_u32 v30, 36864, v26
    v_add_u32 v31, 36864, v27
    ds_read_b64_tr_b16 v[0:1], v28 offset:0
    ds_read_b64_tr_b16 v[2:3], v28 offset:8
    ds_read_b64_tr_b16 v[4:5], v29 offset:0
    ds_read_b64_tr_b16 v[6:7], v29 offset:8
    ds_read_b64_tr_b16 a[4:5], v30 offset:0
    ds_read_b64_tr_b16 v[8:9], v30 offset:8
    ds_read_b64_tr_b16 a[12:13], v31 offset:0
    ds_read_b64_tr_b16 v[10:11], v31 offset:8
    s_waitcnt vmcnt(12) lgkmcnt(0)
    s_barrier
    s_add_u32 m0, s43, 36864
    s_add_u32 s41, s58, 802816
    buffer_load_dwordx4 v17, s[8:11], s41 offen offset:0 nt lds
    s_add_u32 s41, s58, 834560
    buffer_load_dwordx4 v17, s[8:11], s41 offen offset:1024 nt lds
    s_add_u32 s41, s58, 931840
    buffer_load_dwordx4 v17, s[8:11], s41 offen offset:2048 nt lds
    s_add_u32 s41, s58, 963584
    buffer_load_dwordx4 v17, s[8:11], s41 offen offset:3072 nt lds
    ds_write_b64 v70, v[0:1] offset:1024
    ds_write_b64 v70, v[2:3] offset:3072
    ds_write_b64 v70, v[4:5] offset:5120
    ds_write_b64 v70, v[6:7] offset:7168
    ds_write_b64 v70, v[8:9] offset:11264
    ds_write_b64 v70, v[10:11] offset:15360
    v_add_u32 v28, 73728, v24
    v_add_u32 v29, 73728, v25
    v_add_u32 v30, 73728, v26
    v_add_u32 v31, 73728, v27
    ds_read_b64_tr_b16 v[32:33], v28 offset:0
    ds_read_b64_tr_b16 v[34:35], v28 offset:8
    ds_read_b64_tr_b16 v[36:37], v29 offset:0
    ds_read_b64_tr_b16 v[38:39], v29 offset:8
    ds_read_b64_tr_b16 a[6:7], v30 offset:0
    ds_read_b64_tr_b16 v[40:41], v30 offset:8
    ds_read_b64_tr_b16 a[14:15], v31 offset:0
    ds_read_b64_tr_b16 v[42:43], v31 offset:8
    s_waitcnt vmcnt(12) lgkmcnt(0)
    s_barrier
    s_add_u32 m0, s43, 73728
    s_add_u32 s41, s59, 0
    buffer_load_dwordx4 v17, s[8:11], s41 offen offset:0 nt lds
    s_add_u32 s41, s59, 31744
    buffer_load_dwordx4 v17, s[8:11], s41 offen offset:1024 nt lds
    s_add_u32 s41, s59, 129024
    buffer_load_dwordx4 v17, s[8:11], s41 offen offset:2048 nt lds
    s_add_u32 s41, s59, 160768
    buffer_load_dwordx4 v17, s[8:11], s41 offen offset:3072 nt lds
    ds_write_b64 v70, v[32:33] offset:1032
    ds_write_b64 v70, v[34:35] offset:3080
    ds_write_b64 v70, v[36:37] offset:5128
    ds_write_b64 v70, v[38:39] offset:7176
    ds_write_b64 v70, v[40:41] offset:11272
    ds_write_b64 v70, v[42:43] offset:15368
    v_add_u32 v28, 110592, v24
    v_add_u32 v29, 110592, v25
    v_add_u32 v30, 110592, v26
    v_add_u32 v31, 110592, v27
    ds_read_b64_tr_b16 a[16:17], v28 offset:0
    ds_read_b64_tr_b16 a[24:25], v28 offset:8
    ds_read_b64_tr_b16 a[32:33], v29 offset:0
    ds_read_b64_tr_b16 a[40:41], v29 offset:8
    ds_read_b64_tr_b16 a[48:49], v30 offset:0
    ds_read_b64_tr_b16 a[56:57], v30 offset:8
    ds_read_b64_tr_b16 a[64:65], v31 offset:0
    ds_read_b64_tr_b16 a[72:73], v31 offset:8
    s_waitcnt vmcnt(12) lgkmcnt(0)
    s_barrier
    s_mov_b64 s[8:9], s[54:55]
    s_add_u32 m0, s43, 110592
    s_add_u32 s41, s58, 0
    buffer_load_dwordx4 v17, s[8:11], s41 offen offset:0 nt lds
    s_add_u32 s41, s58, 31744
    buffer_load_dwordx4 v17, s[8:11], s41 offen offset:1024 nt lds
    s_add_u32 s41, s58, 129024
    buffer_load_dwordx4 v17, s[8:11], s41 offen offset:2048 nt lds
    s_add_u32 s41, s58, 160768
    buffer_load_dwordx4 v17, s[8:11], s41 offen offset:3072 nt lds
    v_add_u32 v28, 147456, v24
    v_add_u32 v29, 147456, v25
    v_add_u32 v30, 147456, v26
    v_add_u32 v31, 147456, v27
    ds_read_b64_tr_b16 a[18:19], v28 offset:0
    ds_read_b64_tr_b16 a[26:27], v28 offset:8
    ds_read_b64_tr_b16 a[34:35], v29 offset:0
    ds_read_b64_tr_b16 a[42:43], v29 offset:8
    ds_read_b64_tr_b16 a[50:51], v30 offset:0
    ds_read_b64_tr_b16 a[58:59], v30 offset:8
    ds_read_b64_tr_b16 a[66:67], v31 offset:0
    ds_read_b64_tr_b16 a[74:75], v31 offset:8
    s_waitcnt vmcnt(12) lgkmcnt(0)
    s_barrier
    s_add_u32 m0, s43, 147456
    s_add_u32 s41, s58, 16384
    buffer_load_dwordx4 v17, s[8:11], s41 offen offset:0 nt lds
    s_add_u32 s41, s58, 48128
    buffer_load_dwordx4 v17, s[8:11], s41 offen offset:1024 nt lds
    s_add_u32 s41, s58, 145408
    buffer_load_dwordx4 v17, s[8:11], s41 offen offset:2048 nt lds
    s_add_u32 s41, s58, 177152
    buffer_load_dwordx4 v17, s[8:11], s41 offen offset:3072 nt lds
    v_add_u32 v28, 0, v24
    v_add_u32 v29, 0, v25
    v_add_u32 v30, 0, v26
    v_add_u32 v31, 0, v27
    ds_read_b64_tr_b16 a[20:21], v28 offset:0
    ds_read_b64_tr_b16 a[28:29], v28 offset:8
    ds_read_b64_tr_b16 a[36:37], v29 offset:0
    ds_read_b64_tr_b16 a[44:45], v29 offset:8
    ds_read_b64_tr_b16 a[52:53], v30 offset:0
    ds_read_b64_tr_b16 a[60:61], v30 offset:8
    ds_read_b64_tr_b16 a[68:69], v31 offset:0
    ds_read_b64_tr_b16 a[76:77], v31 offset:8
    s_waitcnt vmcnt(12) lgkmcnt(0)
    s_barrier
    s_add_u32 m0, s43, 0
    s_add_u32 s41, s58, 262144
    buffer_load_dwordx4 v17, s[8:11], s41 offen offset:0 nt lds
    s_add_u32 s41, s58, 293888
    buffer_load_dwordx4 v17, s[8:11], s41 offen offset:1024 nt lds
    s_add_u32 s41, s58, 391168
    buffer_load_dwordx4 v17, s[8:11], s41 offen offset:2048 nt lds
    s_add_u32 s41, s58, 422912
    buffer_load_dwordx4 v17, s[8:11], s41 offen offset:3072 nt lds
    v_add_u32 v28, 36864, v24
    v_add_u32 v29, 36864, v25
    v_add_u32 v30, 36864, v26
    v_add_u32 v31, 36864, v27
    ds_read_b64_tr_b16 a[22:23], v28 offset:0
    ds_read_b64_tr_b16 a[30:31], v28 offset:8
    ds_read_b64_tr_b16 a[38:39], v29 offset:0
    ds_read_b64_tr_b16 a[46:47], v29 offset:8
    ds_read_b64_tr_b16 a[54:55], v30 offset:0
    ds_read_b64_tr_b16 a[62:63], v30 offset:8
    ds_read_b64_tr_b16 a[70:71], v31 offset:0
    ds_read_b64_tr_b16 a[78:79], v31 offset:8
    s_waitcnt vmcnt(12) lgkmcnt(0)
    s_barrier
    s_add_u32 m0, s43, 36864
    s_add_u32 s41, s58, 278528
    buffer_load_dwordx4 v17, s[8:11], s41 offen offset:0 nt lds
    s_add_u32 s41, s58, 310272
    buffer_load_dwordx4 v17, s[8:11], s41 offen offset:1024 nt lds
    s_add_u32 s41, s58, 407552
    buffer_load_dwordx4 v17, s[8:11], s41 offen offset:2048 nt lds
    s_add_u32 s41, s58, 439296
    buffer_load_dwordx4 v17, s[8:11], s41 offen offset:3072 nt lds
    v_add_u32 v77, 73728, v20
    ds_read_b64_tr_b16 a[80:81], v77 offset:0
    ds_read_b64_tr_b16 a[82:83], v77 offset:4096
    ds_read_b64_tr_b16 a[84:85], v77 offset:8192
    ds_read_b64_tr_b16 a[86:87], v77 offset:12288
    ds_read_b64_tr_b16 a[88:89], v77 offset:8
    ds_read_b64_tr_b16 a[90:91], v77 offset:4104
    ds_read_b64_tr_b16 a[92:93], v77 offset:8200
    ds_read_b64_tr_b16 a[94:95], v77 offset:12296
    s_waitcnt vmcnt(12) lgkmcnt(0)
    s_barrier
    s_add_u32 m0, s43, 73728
    s_add_u32 s41, s58, 524288
    buffer_load_dwordx4 v17, s[8:11], s41 offen offset:0 nt lds
    s_add_u32 s41, s58, 556032
    buffer_load_dwordx4 v17, s[8:11], s41 offen offset:1024 nt lds
    s_add_u32 s41, s58, 653312
    buffer_load_dwordx4 v17, s[8:11], s41 offen offset:2048 nt lds
    s_add_u32 s41, s58, 685056
    buffer_load_dwordx4 v17, s[8:11], s41 offen offset:3072 nt lds
    v_add_u32 v28, 110592, v24
    v_add_u32 v29, 110592, v25
    v_add_u32 v30, 110592, v26
    v_add_u32 v31, 110592, v27
    ds_read_b64_tr_b16 a[232:233], v28 offset:0
    ds_read_b64_tr_b16 v[32:33], v28 offset:8
    ds_read_b64_tr_b16 a[240:241], v29 offset:0
    ds_read_b64_tr_b16 a[248:249], v29 offset:8
    ds_read_b64_tr_b16 v[144:145], v30 offset:0
    ds_read_b64_tr_b16 v[152:153], v30 offset:8
    ds_read_b64_tr_b16 v[160:161], v31 offset:0
    ds_read_b64_tr_b16 v[168:169], v31 offset:8
    s_waitcnt vmcnt(12) lgkmcnt(0)
    s_barrier
    s_add_u32 m0, s43, 110592
    s_add_u32 s41, s58, 540672
    buffer_load_dwordx4 v17, s[8:11], s41 offen offset:0 nt lds
    s_add_u32 s41, s58, 572416
    buffer_load_dwordx4 v17, s[8:11], s41 offen offset:1024 nt lds
    s_add_u32 s41, s58, 669696
    buffer_load_dwordx4 v17, s[8:11], s41 offen offset:2048 nt lds
    s_add_u32 s41, s58, 701440
    buffer_load_dwordx4 v17, s[8:11], s41 offen offset:3072 nt lds
    ds_write_b64 v70, v[32:33] offset:8192
    v_add_u32 v28, 147456, v24
    v_add_u32 v29, 147456, v25
    v_add_u32 v30, 147456, v26
    v_add_u32 v31, 147456, v27
    ds_read_b64_tr_b16 a[234:235], v28 offset:0
    ds_read_b64_tr_b16 v[0:1], v28 offset:8
    ds_read_b64_tr_b16 a[242:243], v29 offset:0
    ds_read_b64_tr_b16 a[250:251], v29 offset:8
    ds_read_b64_tr_b16 v[146:147], v30 offset:0
    ds_read_b64_tr_b16 v[154:155], v30 offset:8
    ds_read_b64_tr_b16 v[162:163], v31 offset:0
    ds_read_b64_tr_b16 v[170:171], v31 offset:8
    s_waitcnt vmcnt(12) lgkmcnt(0)
    s_barrier
    s_add_u32 m0, s43, 147456
    s_add_u32 s41, s58, 786432
    buffer_load_dwordx4 v17, s[8:11], s41 offen offset:0 nt lds
    s_add_u32 s41, s58, 818176
    buffer_load_dwordx4 v17, s[8:11], s41 offen offset:1024 nt lds
    s_add_u32 s41, s58, 915456
    buffer_load_dwordx4 v17, s[8:11], s41 offen offset:2048 nt lds
    s_add_u32 s41, s58, 947200
    buffer_load_dwordx4 v17, s[8:11], s41 offen offset:3072 nt lds
    ds_write_b64 v70, v[0:1] offset:8200
    v_add_u32 v28, 0, v24
    v_add_u32 v29, 0, v25
    v_add_u32 v30, 0, v26
    v_add_u32 v31, 0, v27
    ds_read_b64_tr_b16 a[236:237], v28 offset:0
    ds_read_b64_tr_b16 v[32:33], v28 offset:8
    ds_read_b64_tr_b16 a[244:245], v29 offset:0
    ds_read_b64_tr_b16 a[252:253], v29 offset:8
    ds_read_b64_tr_b16 v[148:149], v30 offset:0
    ds_read_b64_tr_b16 v[156:157], v30 offset:8
    ds_read_b64_tr_b16 v[164:165], v31 offset:0
    ds_read_b64_tr_b16 v[172:173], v31 offset:8
    s_waitcnt vmcnt(12) lgkmcnt(0)
    s_barrier
    s_add_u32 m0, s43, 0
    s_add_u32 s41, s58, 802816
    buffer_load_dwordx4 v17, s[8:11], s41 offen offset:0 nt lds
    s_add_u32 s41, s58, 834560
    buffer_load_dwordx4 v17, s[8:11], s41 offen offset:1024 nt lds
    s_add_u32 s41, s58, 931840
    buffer_load_dwordx4 v17, s[8:11], s41 offen offset:2048 nt lds
    s_add_u32 s41, s58, 963584
    buffer_load_dwordx4 v17, s[8:11], s41 offen offset:3072 nt lds
    ds_write_b64 v70, v[32:33] offset:9216
    v_add_u32 v28, 36864, v24
    v_add_u32 v29, 36864, v25
    v_add_u32 v30, 36864, v26
    v_add_u32 v31, 36864, v27
    ds_read_b64_tr_b16 a[238:239], v28 offset:0
    ds_read_b64_tr_b16 v[0:1], v28 offset:8
    ds_read_b64_tr_b16 a[246:247], v29 offset:0
    ds_read_b64_tr_b16 a[254:255], v29 offset:8
    ds_read_b64_tr_b16 v[150:151], v30 offset:0
    ds_read_b64_tr_b16 v[158:159], v30 offset:8
    ds_read_b64_tr_b16 v[166:167], v31 offset:0
    ds_read_b64_tr_b16 v[174:175], v31 offset:8
    s_waitcnt vmcnt(12) lgkmcnt(0)
    s_barrier
    s_add_u32 m0, s43, 36864
    s_add_u32 s41, s59, 0
    buffer_load_dwordx4 v17, s[8:11], s41 offen offset:0 nt lds
    s_add_u32 s41, s59, 31744
    buffer_load_dwordx4 v17, s[8:11], s41 offen offset:1024 nt lds
    s_add_u32 s41, s59, 129024
    buffer_load_dwordx4 v17, s[8:11], s41 offen offset:2048 nt lds
    s_add_u32 s41, s59, 160768
    buffer_load_dwordx4 v17, s[8:11], s41 offen offset:3072 nt lds
    ds_write_b64 v70, v[0:1] offset:9224
    v_add_u32 v28, 73728, v24
    v_add_u32 v29, 73728, v25
    v_add_u32 v30, 73728, v26
    v_add_u32 v31, 73728, v27
    ds_read_b64_tr_b16 v[176:177], v28 offset:0
    ds_read_b64_tr_b16 v[184:185], v28 offset:8
    ds_read_b64_tr_b16 v[192:193], v29 offset:0
    ds_read_b64_tr_b16 v[200:201], v29 offset:8
    ds_read_b64_tr_b16 v[208:209], v30 offset:0
    ds_read_b64_tr_b16 v[216:217], v30 offset:8
    ds_read_b64_tr_b16 v[224:225], v31 offset:0
    ds_read_b64_tr_b16 v[232:233], v31 offset:8
    s_waitcnt vmcnt(12) lgkmcnt(0)
    s_barrier
    s_mov_b64 s[8:9], s[56:57]
    s_add_u32 m0, s43, 73728
    s_add_u32 s41, s60, 128
    buffer_load_dwordx4 v18, s[8:11], s41 offen offset:0 nt lds
    s_add_u32 s41, s60, 8320
    buffer_load_dwordx4 v18, s[8:11], s41 offen offset:1024 nt lds
    s_add_u32 s41, s60, 16512
    buffer_load_dwordx4 v18, s[8:11], s41 offen offset:2048 nt lds
    s_add_u32 s41, s60, 24704
    buffer_load_dwordx4 v18, s[8:11], s41 offen offset:3072 nt lds
    v_add_u32 v28, 110592, v24
    v_add_u32 v29, 110592, v25
    v_add_u32 v30, 110592, v26
    v_add_u32 v31, 110592, v27
    ds_read_b64_tr_b16 v[178:179], v28 offset:0
    ds_read_b64_tr_b16 v[186:187], v28 offset:8
    ds_read_b64_tr_b16 v[194:195], v29 offset:0
    ds_read_b64_tr_b16 v[202:203], v29 offset:8
    ds_read_b64_tr_b16 v[210:211], v30 offset:0
    ds_read_b64_tr_b16 v[218:219], v30 offset:8
    ds_read_b64_tr_b16 v[226:227], v31 offset:0
    ds_read_b64_tr_b16 v[234:235], v31 offset:8
    s_waitcnt vmcnt(12) lgkmcnt(0)
    s_barrier
    s_add_u32 m0, s43, 110592
    s_add_u32 s41, s61, 128
    buffer_load_dwordx4 v18, s[8:11], s41 offen offset:0 nt lds
    s_add_u32 s41, s61, 8320
    buffer_load_dwordx4 v18, s[8:11], s41 offen offset:1024 nt lds
    s_add_u32 s41, s61, 16512
    buffer_load_dwordx4 v18, s[8:11], s41 offen offset:2048 nt lds
    s_add_u32 s41, s61, 24704
    buffer_load_dwordx4 v18, s[8:11], s41 offen offset:3072 nt lds
    v_add_u32 v28, 147456, v24
    v_add_u32 v29, 147456, v25
    v_add_u32 v30, 147456, v26
    v_add_u32 v31, 147456, v27
    ds_read_b64_tr_b16 v[180:181], v28 offset:0
    ds_read_b64_tr_b16 v[188:189], v28 offset:8
    ds_read_b64_tr_b16 v[196:197], v29 offset:0
    ds_read_b64_tr_b16 v[204:205], v29 offset:8
    ds_read_b64_tr_b16 v[212:213], v30 offset:0
    ds_read_b64_tr_b16 v[220:221], v30 offset:8
    ds_read_b64_tr_b16 v[228:229], v31 offset:0
    ds_read_b64_tr_b16 v[236:237], v31 offset:8
    s_waitcnt vmcnt(12) lgkmcnt(0)
    s_barrier
    s_add_u32 m0, s43, 147456
    s_add_u32 s41, s62, 128
    buffer_load_dwordx4 v18, s[8:11], s41 offen offset:0 nt lds
    s_add_u32 s41, s62, 8320
    buffer_load_dwordx4 v18, s[8:11], s41 offen offset:1024 nt lds
    s_add_u32 s41, s62, 16512
    buffer_load_dwordx4 v18, s[8:11], s41 offen offset:2048 nt lds
    s_add_u32 s41, s62, 24704
    buffer_load_dwordx4 v18, s[8:11], s41 offen offset:3072 nt lds
    v_add_u32 v28, 0, v24
    v_add_u32 v29, 0, v25
    v_add_u32 v30, 0, v26
    v_add_u32 v31, 0, v27
    ds_read_b64_tr_b16 v[182:183], v28 offset:0
    ds_read_b64_tr_b16 v[190:191], v28 offset:8
    ds_read_b64_tr_b16 v[198:199], v29 offset:0
    ds_read_b64_tr_b16 v[206:207], v29 offset:8
    ds_read_b64_tr_b16 v[214:215], v30 offset:0
    ds_read_b64_tr_b16 v[222:223], v30 offset:8
    ds_read_b64_tr_b16 v[230:231], v31 offset:0
    ds_read_b64_tr_b16 v[238:239], v31 offset:8
    s_waitcnt vmcnt(12) lgkmcnt(0)
    s_barrier
    s_add_u32 m0, s43, 0
    s_add_u32 s41, s63, 128
    buffer_load_dwordx4 v18, s[8:11], s41 offen offset:0 nt lds
    s_add_u32 s41, s63, 8320
    buffer_load_dwordx4 v18, s[8:11], s41 offen offset:1024 nt lds
    s_add_u32 s41, s63, 16512
    buffer_load_dwordx4 v18, s[8:11], s41 offen offset:2048 nt lds
    s_add_u32 s41, s63, 24704
    buffer_load_dwordx4 v18, s[8:11], s41 offen offset:3072 nt lds
    v_mov_b32 v78, v21
    v_mov_b32 v79, v22
    v_add_u32 v77, 36864, v20
    ds_read_b64_tr_b16 v[240:241], v77 offset:0
    ds_read_b64_tr_b16 v[242:243], v77 offset:4096
    ds_read_b64_tr_b16 v[244:245], v77 offset:8192
    ds_read_b64_tr_b16 v[246:247], v77 offset:12288
    ds_read_b64_tr_b16 v[248:249], v77 offset:8
    ds_read_b64_tr_b16 v[250:251], v77 offset:4104
    ds_read_b64_tr_b16 v[252:253], v77 offset:8200
    ds_read_b64_tr_b16 v[254:255], v77 offset:12296
    s_waitcnt vmcnt(12) lgkmcnt(0)
    s_barrier
    v_add_u32 v77, 73728, v79
    s_waitcnt lgkmcnt(0)
    ds_read_b64_tr_b16 v[0:1], v77 offset:0
    ds_read_b64_tr_b16 v[2:3], v77 offset:256
    ds_read_b64_tr_b16 v[4:5], v77 offset:2048
    ds_read_b64_tr_b16 v[6:7], v77 offset:2304
    ds_read_b64_tr_b16 v[8:9], v77 offset:16
    ds_read_b64_tr_b16 v[10:11], v77 offset:272
    ds_read_b64_tr_b16 v[12:13], v77 offset:2064
    ds_read_b64_tr_b16 v[14:15], v77 offset:2320
    s_waitcnt vmcnt(8) lgkmcnt(0)
    s_barrier
    v_add_u32 v77, 110592, v78
    ds_read_b64_tr_b16 v[16:17], v77 offset:0
    ds_read_b64_tr_b16 v[18:19], v77 offset:256
    ds_read_b64_tr_b16 v[20:21], v77 offset:2048
    ds_read_b64_tr_b16 v[22:23], v77 offset:2304
    ds_read_b64_tr_b16 v[24:25], v77 offset:16
    ds_read_b64_tr_b16 v[26:27], v77 offset:272
    ds_read_b64_tr_b16 v[28:29], v77 offset:2064
    ds_read_b64_tr_b16 v[30:31], v77 offset:2320
    s_waitcnt vmcnt(4) lgkmcnt(0)
    s_barrier
    v_add_u32 v77, 147456, v78
    ds_read_b64_tr_b16 v[32:33], v77 offset:0
    ds_read_b64_tr_b16 v[34:35], v77 offset:256
    ds_read_b64_tr_b16 v[36:37], v77 offset:2048
    ds_read_b64_tr_b16 v[38:39], v77 offset:2304
    ds_read_b64_tr_b16 v[40:41], v77 offset:16
    ds_read_b64_tr_b16 v[42:43], v77 offset:272
    ds_read_b64_tr_b16 v[44:45], v77 offset:2064
    ds_read_b64_tr_b16 v[46:47], v77 offset:2320
    s_waitcnt vmcnt(0) lgkmcnt(0)
    s_barrier
    v_add_u32 v77, 0, v78
    ds_read_b64_tr_b16 v[48:49], v77 offset:0
    ds_read_b64_tr_b16 v[50:51], v77 offset:256
    ds_read_b64_tr_b16 v[52:53], v77 offset:2048
    ds_read_b64_tr_b16 v[54:55], v77 offset:2304
    ds_read_b64_tr_b16 v[56:57], v77 offset:16
    ds_read_b64_tr_b16 v[58:59], v77 offset:272
    ds_read_b64_tr_b16 v[60:61], v77 offset:2064
    ds_read_b64_tr_b16 v[62:63], v77 offset:2320
    s_waitcnt lgkmcnt(0)
    s_barrier
    ds_write_b128 v70, v[0:3] offset:20480
    ds_write_b128 v70, v[4:7] offset:21504
    ds_write_b128 v70, v[8:11] offset:22528
    ds_write_b128 v70, v[12:15] offset:23552
    ds_write_b128 v70, v[16:19] offset:24576
    ds_write_b128 v70, v[20:23] offset:25600
    ds_write_b128 v70, v[24:27] offset:26624
    ds_write_b128 v70, v[28:31] offset:27648
    ds_write_b128 v70, v[32:35] offset:28672
    ds_write_b128 v70, v[36:39] offset:29696
    ds_write_b128 v70, v[40:43] offset:30720
    ds_write_b128 v70, v[44:47] offset:31744
    ds_write_b128 v70, v[48:51] offset:32768
    ds_write_b128 v70, v[52:55] offset:33792
    ds_write_b128 v70, v[56:59] offset:34816
    ds_write_b128 v70, v[60:63] offset:35840
    s_waitcnt lgkmcnt(0)
    v_bfe_u32 v60, v65, 4, 6
    v_and_b32 v61, 15, v60
    v_lshrrev_b32 v62, 4, v60
    v_mov_b32 v50, 0x3f80
    v_mov_b32 v51, 0x3f800000
    v_and_b32 v77, 1, v62
    v_lshlrev_b32 v77, 2, v77
    v_sub_u32 v77, v61, v77
    v_and_b32 v78, 3, v61
    v_lshlrev_b32 v78, 2, v78
    v_lshrrev_b32 v79, 2, v61
    v_add_u32 v78, v78, v79
    v_cmp_eq_u32 vcc, 0, v77
    s_nop 1
    v_cndmask_b32 v8, 0, v50, vcc
    v_cmp_eq_u32 vcc, 1, v77
    s_nop 1
    v_cndmask_b32 v8, v8, v51, vcc
    v_cmp_eq_u32 vcc, 0, v78
    s_nop 1
    v_cndmask_b32 v12, 0, v50, vcc
    v_cmp_eq_u32 vcc, 1, v78
    s_nop 1
    v_cndmask_b32 v12, v12, v51, vcc
    v_cmp_eq_u32 vcc, 2, v77
    s_nop 1
    v_cndmask_b32 v9, 0, v50, vcc
    v_cmp_eq_u32 vcc, 3, v77
    s_nop 1
    v_cndmask_b32 v9, v9, v51, vcc
    v_cmp_eq_u32 vcc, 2, v78
    s_nop 1
    v_cndmask_b32 v13, 0, v50, vcc
    v_cmp_eq_u32 vcc, 3, v78
    s_nop 1
    v_cndmask_b32 v13, v13, v51, vcc
    v_cmp_eq_u32 vcc, 8, v77
    s_nop 1
    v_cndmask_b32 v10, 0, v50, vcc
    v_cmp_eq_u32 vcc, 9, v77
    s_nop 1
    v_cndmask_b32 v10, v10, v51, vcc
    v_cmp_eq_u32 vcc, 4, v78
    s_nop 1
    v_cndmask_b32 v14, 0, v50, vcc
    v_cmp_eq_u32 vcc, 5, v78
    s_nop 1
    v_cndmask_b32 v14, v14, v51, vcc
    v_cmp_eq_u32 vcc, 10, v77
    s_nop 1
    v_cndmask_b32 v11, 0, v50, vcc
    v_cmp_eq_u32 vcc, 11, v77
    s_nop 1
    v_cndmask_b32 v11, v11, v51, vcc
    v_cmp_eq_u32 vcc, 6, v78
    s_nop 1
    v_cndmask_b32 v15, 0, v50, vcc
    v_cmp_eq_u32 vcc, 7, v78
    s_nop 1
    v_cndmask_b32 v15, v15, v51, vcc
    v_lshlrev_b32 v77, 4, v61
    ds_write_b128 v69, v[8:11] offset:15360
    ds_write_b128 v77, v[12:15] offset:15872
    s_waitcnt vmcnt(0) lgkmcnt(0)
    s_barrier
    v_mov_b32 v2, 1
    s_cmp_lg_u32 s13, 0
    s_cbranch_scc1 cs_noarr
    s_mov_b64 exec, 1
    buffer_atomic_add v2, off, s[84:87], 0 offset:212
    s_mov_b32 s40, 16777216
    s_mov_b32 s42, 2
cs_startpoll:
    buffer_load_dword v3, off, s[84:87], 0 offset:212 sc1
    s_sub_u32 s40, s40, 1
    s_cbranch_scc1 cs_decide
    s_waitcnt vmcnt(0)
    v_readfirstlane_b32 s41, v3
    s_nop 1
    s_cmp_lt_u32 s41, 32
    s_cbranch_scc1 cs_startpoll
    s_mov_b32 s42, 1
cs_decide:
    s_mov_b64 exec, -1
cs_noarr:
    s_barrier
    s_mov_b32 s44, 0x3e0293ee
    s_mov_b32 s45, s44
    s_or_b32 s66, s44, 0x80000000
    s_mov_b32 s48, 0x3f003f00
    s_mov_b32 s49, 0
    s_mov_b32 s50, 0x3f803f80
    s_mov_b32 s51, 0x3f803f80
    s_mov_b32 s52, 512
    s_mov_b32 s53, 1024
    s_mov_b32 s54, 1536
    s_mov_b32 s30, 0
    s_mov_b32 s37, 0
    s_mov_b32 s98, -100
    s_lshl_b32 s47, s13, 9
    s_cmp_lg_u32 s32, 0
    s_cselect_b32 s71, s13, 3
    s_add_u32 s46, s71, 1
    s_lshr_b32 s46, s46, 1
    s_mov_b32 s14, 67649536
    s_mov_b32 s15, 67653632
    s_mov_b32 s16, 67657728
    s_mov_b32 s36, 0
    s_add_u32 s17, s68, 67633152
    s_mov_b32 s69, 0
    s_mov_b32 s70, 0
    s_lshl_b32 s26, s12, 14
    s_add_u32 s26, s26, 0
    s_mul_i32 s40, s13, 3072
    s_add_u32 s24, s26, s40
    s_lshl_b32 s96, s12, 7
    s_add_u32 s29, s96, 125845504
    s_add_u32 s96, s96, 125829120
    s_lshl_b32 s40, s12, 14
    s_add_u32 s40, s40, 68681728
    s_add_u32 s18, s40, 0
    s_add_u32 s19, s40, 4096
    s_add_u32 s20, s40, 8192
    s_add_u32 s21, s40, 12288
    s_lshr_b32 s40, s12, 3
    s_lshl_b32 s40, s40, 12
    s_and_b32 s41, s12, 7
    s_lshl_b32 s41, s41, 7
    s_add_u32 s40, s40, s41
    s_add_u32 s22, s40, 68681728
    s_add_u32 s23, s22, 1024
    s_add_u32 s25, s22, 2048
    s_mov_b32 s56, -65472
    s_cmp_lg_u32 s32, 0
    s_cselect_b64 s[38:39], -1, 0
    s_add_u32 s55, s68, 138412032
    s_cmp_eq_u32 s13, 3
    s_cselect_b64 s[100:101], 1, 0
    s_cselect_b64 s[38:39], 1, s[38:39]
    s_cselect_b32 s93, 64, 0
    s_cselect_b32 s55, s29, s55
    s_cselect_b32 s57, 0, 9216
    s_mov_b64 exec, s[100:101]
    v_mov_b32 v72, s95
    s_mov_b64 exec, -1
    s_mov_b32 s34, 0xff00ff00
    s_mov_b32 s35, 0xff00ff00
    s_lshl_b32 s28, s12, 12
    s_add_u32 s28, s28, 7340032
    s_add_u32 s27, s28, 77594624
    s_add_u32 s28, s28, 69206016
    s_mov_b32 s40, 3
    v_bfe_u32 v78, v65, 2, 5
    s_mov_b32 s31, 4194304
cs_kv0:
    buffer_load_dword v77, v78, s[4:7], s96 offen offset:16 sc1
    s_waitcnt vmcnt(0)
    v_subrev_u32 v77, s95, v77
    v_cmp_lt_u32 vcc, 16, v77
    s_nop 1
    v_cndmask_b32 v77, v77, 0, vcc
    v_bfe_u32 v79, v78, 2, 2
    v_lshl_add_u32 v77, v77, 2, v79
    s_nop 1
    v_min_u32_dpp v77, v77, v77 row_ror:1 row_mask:0xf bank_mask:0xf
    s_nop 1
    v_min_u32_dpp v77, v77, v77 row_ror:2 row_mask:0xf bank_mask:0xf
    s_nop 1
    v_min_u32_dpp v77, v77, v77 row_ror:4 row_mask:0xf bank_mask:0xf
    s_nop 0
    v_readfirstlane_b32 s97, v77
    s_sub_u32 s31, s31, 1
    s_cbranch_scc1 cs_kv0_x
    s_cmp_le_u32 s40, s97
    s_cbranch_scc1 cs_kv0_x
    s_sleep 2
    s_branch cs_kv0
cs_kv0_x:
    s_add_u32 s40, s24, 0
    s_add_u32 s40, s40, s33
    s_sub_u32 s41, s96, s40
    v_bfe_u32 v77, v65, 2, 5
    v_add3_u32 v77, v77, s41, 16
    v_lshlrev_b32 v78, 3, v69
    s_nop 0
    v_mov_b32_dpp v78, v77 quad_perm:[0,1,2,3] row_mask:0xc bank_mask:0xf
    buffer_load_dword v76, v78, s[4:7], s40 offen sc1
    s_add_u32 s40, s24, 524288
    s_add_u32 s40, s40, s33
    s_sub_u32 s41, s96, s40
    v_bfe_u32 v77, v65, 2, 5
    v_add3_u32 v77, v77, s41, 16
    v_lshlrev_b32 v78, 3, v69
    s_nop 0
    v_mov_b32_dpp v78, v77 quad_perm:[0,1,2,3] row_mask:0xc bank_mask:0xf
    buffer_load_dword v76, v78, s[4:7], s40 offen sc1
cs_kvdone:
    v_mov_b64 v[0:1], 0
    v_mov_b64 v[2:3], 0
    v_mov_b64 v[4:5], 0
    v_mov_b64 v[6:7], 0
    v_mov_b64 v[8:9], 0
    v_mov_b64 v[10:11], 0
    v_mov_b64 v[12:13], 0
    v_mov_b64 v[14:15], 0
    v_mov_b64 v[16:17], 0
    v_mov_b64 v[18:19], 0
    v_mov_b64 v[20:21], 0
    v_mov_b64 v[22:23], 0
    ds_read_b128 v[44:47], v70 offset:0
    ds_read_b128 v[48:51], v70 offset:1024
    ds_read_b128 v[52:55], v70 offset:2048
    ds_read_b128 v[56:59], v70 offset:3072
    ds_read_b128 v[24:27], v70 offset:4096
    ds_read_b128 v[28:31], v70 offset:5120
    ds_read_b128 v[32:35], v70 offset:6144
    ds_read_b128 v[36:39], v70 offset:7168
    buffer_load_dwordx4 v[40:43], v65, s[4:7], s14 offen offset:0 sc1
    buffer_load_dwordx4 v[60:63], v66, s[4:7], s14 offen offset:0 sc1
    s_mov_b32 s31, 1048576
    s_waitcnt vmcnt(0) lgkmcnt(0)
    s_branch cs_goA
cs_loop:
    s_mov_b32 s31, 1048576
    s_mov_b32 s69, s70
    s_waitcnt lgkmcnt(0)
cs_cA:
    buffer_load_dwordx4 v[40:43], v65, s[4:7], s14 offen offset:0 sc1
    buffer_load_dwordx4 v[60:63], v66, s[4:7], s14 offen offset:0 sc1
cs_cA1:
    v_bitop3_b32 v77, v40, v60, s70 bitop3:0x7e
    v_and_b32 v77, 1, v77
    v_cmp_ne_u32 vcc, 0, v77
    s_cbranch_vccz cs_goA
    s_nop 15
    s_nop 15
    s_nop 7
    v_bitop3_b32 v77, v40, v60, s70 bitop3:0x7e
    v_and_b32 v77, 1, v77
    v_cmp_ne_u32 vcc, 0, v77
    s_cbranch_vccz cs_goA
    s_nop 15
    s_nop 15
    s_nop 7
    v_bitop3_b32 v77, v40, v60, s70 bitop3:0x7e
    v_and_b32 v77, 1, v77
    v_cmp_ne_u32 vcc, 0, v77
    s_cbranch_vccz cs_goA
    s_nop 15
    s_nop 15
    s_nop 7
    v_bitop3_b32 v77, v40, v60, s70 bitop3:0x7e
    v_and_b32 v77, 1, v77
    v_cmp_ne_u32 vcc, 0, v77
    s_cbranch_vccz cs_goA
    s_nop 15
    s_nop 15
    s_nop 7
    buffer_load_dwordx4 v[40:43], v65, s[4:7], s14 offen offset:0 sc1
    buffer_load_dwordx4 v[60:63], v66, s[4:7], s14 offen offset:0 sc1
    v_bitop3_b32 v77, v40, v60, s70 bitop3:0x7e
    v_and_b32 v77, 1, v77
    v_cmp_ne_u32 vcc, 0, v77
    s_cbranch_vccz cs_goA
    s_nop 15
    s_nop 15
    s_nop 7
    v_bitop3_b32 v77, v40, v60, s70 bitop3:0x7e
    v_and_b32 v77, 1, v77
    v_cmp_ne_u32 vcc, 0, v77
    s_cbranch_vccz cs_goA
    s_nop 15
    s_nop 15
    s_nop 7
    v_bitop3_b32 v77, v40, v60, s70 bitop3:0x7e
    v_and_b32 v77, 1, v77
    v_cmp_ne_u32 vcc, 0, v77
    s_cbranch_vccz cs_goA
    s_nop 15
    s_nop 15
    s_nop 7
    v_bitop3_b32 v77, v40, v60, s70 bitop3:0x7e
    v_and_b32 v77, 1, v77
    v_cmp_ne_u32 vcc, 0, v77
    s_cbranch_vccz cs_goA
    s_nop 15
    s_nop 15
    s_nop 7
    buffer_load_dwordx4 v[40:43], v65, s[4:7], s14 offen offset:0 sc1
    buffer_load_dwordx4 v[60:63], v66, s[4:7], s14 offen offset:0 sc1
    v_bitop3_b32 v77, v40, v60, s70 bitop3:0x7e
    v_and_b32 v77, 1, v77
    v_cmp_ne_u32 vcc, 0, v77
    s_cbranch_vccz cs_goA
    s_nop 15
    s_nop 15
    s_nop 7
    v_bitop3_b32 v77, v40, v60, s70 bitop3:0x7e
    v_and_b32 v77, 1, v77
    v_cmp_ne_u32 vcc, 0, v77
    s_cbranch_vccz cs_goA
    s_nop 15
    s_nop 15
    s_nop 7
    v_bitop3_b32 v77, v40, v60, s70 bitop3:0x7e
    v_and_b32 v77, 1, v77
    v_cmp_ne_u32 vcc, 0, v77
    s_cbranch_vccz cs_goA
    s_nop 15
    s_nop 15
    s_nop 7
    v_bitop3_b32 v77, v40, v60, s70 bitop3:0x7e
    v_and_b32 v77, 1, v77
    v_cmp_ne_u32 vcc, 0, v77
    s_cbranch_vccz cs_goA
    s_nop 15
    s_nop 15
    s_nop 7
    buffer_load_dwordx4 v[40:43], v65, s[4:7], s14 offen offset:0 sc1
    buffer_load_dwordx4 v[60:63], v66, s[4:7], s14 offen offset:0 sc1
    v_bitop3_b32 v77, v40, v60, s70 bitop3:0x7e
    v_and_b32 v77, 1, v77
    v_cmp_ne_u32 vcc, 0, v77
    s_cbranch_vccz cs_goA
    s_nop 15
    s_nop 15
    s_nop 7
    v_bitop3_b32 v77, v40, v60, s70 bitop3:0x7e
    v_and_b32 v77, 1, v77
    v_cmp_ne_u32 vcc, 0, v77
    s_cbranch_vccz cs_goA
    s_nop 15
    s_nop 15
    s_nop 7
    v_bitop3_b32 v77, v40, v60, s70 bitop3:0x7e
    v_and_b32 v77, 1, v77
    v_cmp_ne_u32 vcc, 0, v77
    s_cbranch_vccz cs_goA
    s_nop 15
    s_nop 15
    s_nop 7
    v_bitop3_b32 v77, v40, v60, s70 bitop3:0x7e
    v_and_b32 v77, 1, v77
    v_cmp_ne_u32 vcc, 0, v77
    s_cbranch_vccz cs_goA
    s_nop 15
    s_nop 15
    s_nop 7
    s_sub_u32 s31, s31, 64
    s_cbranch_scc0 cs_cA
cs_goA:
    ds_write_b128 v65, v[40:43] offset:0
    v_smfmac_f32_16x16x64_bf16 v[0:3], v[40:43], v[44:51], v64
    v_smfmac_f32_16x16x64_bf16 v[4:7], v[40:43], v[52:59], v64
    buffer_load_dwordx4 v[44:47], v65, s[4:7], s15 offen offset:0 sc1
    v_smfmac_f32_16x16x64_bf16 v[0:3], v[60:63], v[24:31], v64
    s_add_u32 s40, s24, 1048576
    s_add_u32 s40, s40, s33
    s_sub_u32 s41, s96, s40
    v_smfmac_f32_16x16x64_bf16 v[4:7], v[60:63], v[32:39], v64
    ds_read_b128 v[24:27], v70 offset:8192
    s_cmp_lt_u32 s97, s93
    s_cselect_b32 s41, s41, 0
    v_smfmac_f32_16x16x64_bf16 v[8:11], v[40:43], a[96:103], v64
    ds_read_b128 v[28:31], v70 offset:9216
    v_smfmac_f32_16x16x64_bf16 v[12:15], v[40:43], a[104:111], v64
    ds_read_b128 v[32:35], v70 offset:10240
    s_waitcnt lgkmcnt(3)
    s_barrier
    ds_read_b128 v[48:51], v67 offset:0
    v_smfmac_f32_16x16x64_bf16 v[8:11], v[60:63], a[112:119], v64
    ds_read_b128 v[36:39], v70 offset:11264
    v_bitop3_b32 v79, v73, -9, s54 bitop3:0x6a
    v_smfmac_f32_16x16x64_bf16 v[12:15], v[60:63], a[120:127], v64
    buffer_load_dwordx4 v[44:47], v65, s[4:7], s15 offen offset:0 sc1
    v_smfmac_f32_16x16x64_bf16 v[16:19], v[40:43], a[232:239], v64
    ds_read_b128 v[52:55], v68 offset:0
    s_waitcnt lgkmcnt(4)
    v_bfe_u32 v77, v65, 2, 5
    v_smfmac_f32_16x16x64_bf16 v[20:23], v[40:43], v[24:31], v64
    ds_read_b128 v[24:27], v70 offset:12288
    s_waitcnt lgkmcnt(3)
    v_smfmac_f32_16x16x64_bf16 v[0:3], v[48:51], a[0:7], v64
    ds_read_b128 v[28:31], v70 offset:13312
    s_waitcnt lgkmcnt(3)
    v_add3_u32 v77, v77, s41, 16
    v_smfmac_f32_16x16x64_bf16 v[4:7], v[48:51], v[32:39], v64
    buffer_load_dwordx4 v[40:43], v65, s[4:7], s16 offen offset:0 sc1
    v_smfmac_f32_16x16x64_bf16 v[16:19], v[60:63], a[240:247], v64
    ds_read_b128 v[32:35], v70 offset:14336
    v_lshlrev_b32 v78, 3, v69
    v_smfmac_f32_16x16x64_bf16 v[20:23], v[60:63], a[248:255], v64
    ds_read_b128 v[36:39], v70 offset:15360
    v_smfmac_f32_16x16x64_bf16 v[8:11], v[48:51], a[128:135], v64
    s_waitcnt vmcnt(2)
    v_mov_b32_dpp v78, v77 quad_perm:[0,1,2,3] row_mask:0xc bank_mask:0xf
    v_smfmac_f32_16x16x64_bf16 v[12:15], v[48:51], a[136:143], v64
    buffer_load_dwordx4 v[58:61], v65, s[4:7], s24 offen offset:3072 sc1
    s_waitcnt lgkmcnt(2)
    v_and_b32 v77, s36, v44
    v_smfmac_f32_16x16x64_bf16 v[12:15], v[52:55], v[24:31], v64
    ds_write_b128 v65, v[44:47] offset:4096
    v_smfmac_f32_16x16x64_bf16 v[0:3], v[52:55], a[8:15], v64
    v_cmp_ne_u32 vcc, s70, v77
    v_smfmac_f32_16x16x64_bf16 v[8:11], v[52:55], a[144:151], v64
    buffer_load_dwordx4 v[24:27], v65, s[4:7], s24 offen offset:0 sc1
    s_waitcnt lgkmcnt(1)
    v_smfmac_f32_16x16x64_bf16 v[4:7], v[52:55], v[32:39], v64
    s_cbranch_vccnz cs_spinB
cs_backB:
    v_smfmac_f32_16x16x64_bf16 v[16:19], v[44:47], v[176:183], v64
    s_waitcnt lgkmcnt(0)
    s_barrier
    ds_read_b128 v[48:51], v66 offset:4096
    v_smfmac_f32_16x16x64_bf16 v[12:15], v[44:47], a[160:167], v64
    buffer_load_dwordx4 v[28:31], v65, s[4:7], s24 offen offset:1024 sc1
    v_smfmac_f32_16x16x64_bf16 v[0:3], v[44:47], a[16:23], v64
    ds_read_b128 v[52:55], v67 offset:4096
    v_smfmac_f32_16x16x64_bf16 v[8:11], v[44:47], a[152:159], v64
    v_smfmac_f32_16x16x64_bf16 v[4:7], v[44:47], a[24:31], v64
    buffer_load_dwordx4 v[34:37], v65, s[4:7], s24 offen offset:2048 sc1
    s_waitcnt vmcnt(5)
    v_smfmac_f32_16x16x64_bf16 v[20:23], v[44:47], v[184:191], v64
    ds_read_b128 v[44:47], v68 offset:4096
    s_waitcnt lgkmcnt(2)
    v_smfmac_f32_16x16x64_bf16 v[0:3], v[48:51], a[32:39], v64
    v_smfmac_f32_16x16x64_bf16 v[8:11], v[48:51], a[168:175], v64
    buffer_load_dword v76, v78, s[4:7], s40 offen sc1
    v_smfmac_f32_16x16x64_bf16 v[4:7], v[48:51], a[40:47], v64
    s_waitcnt vmcnt(5)
    v_and_b32 v77, s36, v40
    v_smfmac_f32_16x16x64_bf16 v[12:15], v[48:51], a[176:183], v64
    ds_read_b128 v[48:51], v69 offset:15360
    s_waitcnt lgkmcnt(1)
    v_cmp_ne_u32 vcc, s70, v77
    v_smfmac_f32_16x16x64_bf16 v[0:3], v[52:55], a[48:55], v64
    v_smfmac_f32_16x16x64_bf16 v[8:11], v[52:55], a[184:191], v64
    s_cbranch_vccnz cs_spin8
cs_back8:
    v_smfmac_f32_16x16x64_bf16 v[0:3], v[44:47], a[64:71], v64
    v_smfmac_f32_16x16x64_bf16 v[8:11], v[44:47], a[200:207], v64
    v_smfmac_f32_16x16x64_bf16 v[0:3], v[40:43], a[80:87], v64
    s_nop 1
    v_smfmac_f32_16x16x64_bf16 v[8:11], v[40:43], a[216:223], v64
    s_nop 1
    v_lshrrev_b32 v77, 1, v69
    v_smfmac_f32_16x16x64_bf16 v[4:7], v[52:55], a[56:63], v64
    s_nop 1
    v_cvt_pk_bf16_f32 v0, v0, v1
    v_smfmac_f32_16x16x64_bf16 v[12:15], v[52:55], a[192:199], v64
    s_nop 1
    v_cvt_pk_bf16_f32 v1, v2, v3
    v_smfmac_f32_16x16x64_bf16 v[4:7], v[44:47], a[72:79], v64
    s_nop 1
    v_cvt_pk_bf16_f32 v2, v8, v9
    v_smfmac_f32_16x16x64_bf16 v[12:15], v[44:47], a[208:215], v64
    s_nop 1
    v_cvt_pk_bf16_f32 v3, v10, v11
    v_smfmac_f32_16x16x64_bf16 v[4:7], v[40:43], a[88:95], v64
    s_waitcnt lgkmcnt(0)
    s_nop 0
    s_nop 0
    v_smfmac_f32_16x16x64_bf16 v[12:15], v[40:43], a[224:231], v64
    s_nop 2
    v_mfma_f32_16x16x32_bf16 v[8:11], v[0:3], v[48:51], 0
    s_nop 0
    v_cvt_pk_bf16_f32 v4, v4, v5
    v_cvt_pk_bf16_f32 v5, v6, v7
    s_nop 0
    v_cvt_pk_bf16_f32 v6, v12, v13
    v_cvt_pk_bf16_f32 v7, v14, v15
    s_nop 1
    v_mfma_f32_16x16x32_bf16 v[12:15], v[4:7], v[48:51], 0
    ds_read_b128 v[48:51], v66 offset:4096
    v_cvt_pk_bf16_f32 v0, v8, v9
    v_cvt_pk_bf16_f32 v1, v10, v11
    v_smfmac_f32_16x16x64_bf16 v[16:19], v[52:55], v[208:215], v64
    s_waitcnt vmcnt(2)
    s_nop 2
    v_cvt_pk_bf16_f32 v2, v12, v13
    v_cvt_pk_bf16_f32 v3, v14, v15
    s_nop 1
    v_mfma_f32_16x16x32_bf16 v[12:15], v[0:3], v[0:3], 0
    s_nop 1
    v_bitop3_b32 v78, v73, -9, s53 bitop3:0x6a
    v_mfma_f32_16x16x32_bf16 v[4:7], v[24:27], v[0:3], 0
    ds_read_b128 v[24:27], v67 offset:0
    s_nop 1
    v_mfma_f32_16x16x32_bf16 v[8:11], v[28:31], v[0:3], 0
    s_nop 0
    v_mov_b32_dpp v12, v14 row_ror:8 row_mask:0xf bank_mask:0xc
    v_mov_b32_dpp v13, v15 row_ror:8 row_mask:0xf bank_mask:0xc
    v_smfmac_f32_16x16x64_bf16 v[20:23], v[52:55], v[216:223], v64
    ds_write_b64 v71, v[12:13]
    ds_read_b128 v[52:55], v68 offset:0
    s_nop 1
    v_mov_b32_dpp v4, v8 row_ror:8 row_mask:0xf bank_mask:0xc
    v_mov_b32_dpp v5, v9 row_ror:8 row_mask:0xf bank_mask:0xc
    v_mov_b32_dpp v6, v10 row_ror:8 row_mask:0xf bank_mask:0xc
    v_mov_b32_dpp v7, v11 row_ror:8 row_mask:0xf bank_mask:0xc
    v_smfmac_f32_16x16x64_bf16 v[16:19], v[44:47], v[224:231], v64
    ds_write_b128 v65, v[4:7] offset:8192
    v_smfmac_f32_16x16x64_bf16 v[20:23], v[44:47], v[232:239], v64
    s_waitcnt lgkmcnt(3)
    v_smfmac_f32_16x16x64_bf16 v[16:19], v[24:27], v[144:151], v64
    s_waitcnt vmcnt(1)
    v_smfmac_f32_16x16x64_bf16 v[20:23], v[24:27], v[152:159], v64
    s_mov_b64 exec, s[38:39]
    buffer_store_dword v72, v75, s[4:7], s55 offen sc1
    s_mov_b64 exec, -1
    v_smfmac_f32_16x16x64_bf16 v[16:19], v[40:43], v[240:247], v64
    s_cmp_ge_u32 s30, 56
    s_waitcnt lgkmcnt(0)
    s_barrier
    ds_read_b128 v[8:11], v66 offset:8192
    v_smfmac_f32_16x16x64_bf16 v[20:23], v[40:43], v[248:255], v64
    ds_read_b128 v[12:15], v67 offset:8192
    v_smfmac_f32_16x16x64_bf16 v[16:19], v[48:51], v[192:199], v64
    ds_read_b128 v[44:47], v68 offset:8192
    v_smfmac_f32_16x16x64_bf16 v[20:23], v[48:51], v[200:207], v64
    ds_read_b64 v[24:25], v77 offset:14336
    ds_read_b64 v[26:27], v77 offset:14592
    v_smfmac_f32_16x16x64_bf16 v[16:19], v[52:55], v[160:167], v64
    ds_read_b64 v[28:29], v77 offset:14848
    ds_read_b64 v[30:31], v77 offset:15104
    v_bitop3_b32 v77, v73, -9, s52 bitop3:0x6a
    v_smfmac_f32_16x16x64_bf16 v[20:23], v[52:55], v[168:175], v64
    s_cbranch_scc1 cs_rare
cs_rare_x:
    ds_read_b128 v[48:51], v70 offset:22528
    ds_read_b128 v[52:55], v70 offset:23552
    s_waitcnt lgkmcnt(6)
    v_pk_add_f32 v[4:5], v[4:5], v[8:9]
    v_pk_add_f32 v[6:7], v[6:7], v[10:11]
    v_pk_add_f32 v[12:13], v[12:13], v[44:45]
    v_pk_add_f32 v[14:15], v[14:15], v[46:47]
    v_pk_add_f32 v[4:5], v[4:5], v[12:13]
    v_pk_add_f32 v[6:7], v[6:7], v[14:15]
    s_waitcnt lgkmcnt(2)
    v_pk_add_f32 v[24:25], v[24:25], v[26:27]
    v_pk_add_f32 v[28:29], v[28:29], v[30:31]
    v_max3_f32 v8, v4, v5, v6
    v_pk_add_f32 v[24:25], v[24:25], v[28:29]
    v_max_f32 v8, v8, v7
    v_max3_f32 v8, v8, v24, v25
    v_cvt_pk_bf16_f32 v32, v16, v17
    v_cvt_pk_bf16_f32 v38, v18, v19
    v_max_f32_dpp v8, v8, v8 row_ror:8 row_mask:0xf bank_mask:0xf
    v_mov_b32 v9, v8
    v_cvt_pk_bf16_f32 v56, v20, v21
    v_cvt_pk_bf16_f32 v62, v22, v23
    v_permlane32_swap_b32 v8, v9
    v_max_f32 v8, v8, v9
    v_mov_b32 v9, v8
    v_mov_b32 v11, 0
    v_mov_b32 v15, 0
    v_permlane16_swap_b32 v8, v9
    v_max_f32 v8, v8, v9
    v_mul_f32 v8, s66, v8
    v_pk_fma_f32 v[4:5], v[4:5], s[44:45], v[8:9] op_sel_hi:[1,1,0]
    v_pk_fma_f32 v[6:7], v[6:7], s[44:45], v[8:9] op_sel_hi:[1,1,0]
    v_pk_fma_f32 v[24:25], v[24:25], s[44:45], v[8:9] op_sel_hi:[1,1,0]
    v_exp_f32 v4, v4
    v_exp_f32 v5, v5
    v_exp_f32 v6, v6
    v_exp_f32 v7, v7
    v_exp_f32 v24, v24
    v_exp_f32 v25, v25
    v_cvt_pk_bf16_f32 v12, v4, v5
    v_cvt_pk_bf16_f32 v13, v6, v7
    v_cvt_pk_bf16_f32 v10, v24, v25
    v_cvt_pk_bf16_f32 v14, v24, v25
    v_mov_b64 v[0:1], s[48:49]
    v_mfma_f32_16x16x32_bf16 v[4:7], v[32:35], v[10:13], 0
    ds_read_b128 v[40:43], v70 offset:20480
    v_mov_b64 v[2:3], s[50:51]
    v_mfma_f32_16x16x32_bf16 v[24:27], v[36:39], v[12:15], 0
    ds_read_b128 v[44:47], v70 offset:21504
    v_mov_b64 v[8:9], 0
    v_mfma_f32_16x16x32_bf16 v[28:31], v[0:3], v[10:13], 0
    ds_read_b128 v[32:35], v70 offset:24576
    v_mov_b64 v[0:1], 0
    v_mfma_f32_16x16x32_bf16 v[16:19], v[56:59], v[10:13], 0
    ds_read_b128 v[36:39], v70 offset:25600
    v_mov_b64 v[2:3], 0
    v_mfma_f32_16x16x32_bf16 v[20:23], v[60:63], v[12:15], 0
    ds_read_b128 v[56:59], v70 offset:28672
    v_add_f32_dpp v4, v24, v4 row_ror:8 row_mask:0xf bank_mask:0xf
    v_add_f32_dpp v5, v25, v5 row_ror:8 row_mask:0xf bank_mask:0xf
    v_add_f32_dpp v6, v26, v6 row_ror:8 row_mask:0xf bank_mask:0xf
    v_add_f32_dpp v7, v27, v7 row_ror:8 row_mask:0xf bank_mask:0xf
    v_add_f32_dpp v29, v28, v28 row_ror:8 row_mask:0xf bank_mask:0xf
    v_rcp_f32 v28, v29
    v_mov_b64 v[10:11], 0
    v_add_f32_dpp v4, v16, v20 row_ror:8 row_mask:0xf bank_mask:0xc
    v_add_f32_dpp v5, v17, v21 row_ror:8 row_mask:0xf bank_mask:0xc
    v_add_f32_dpp v6, v18, v22 row_ror:8 row_mask:0xf bank_mask:0xc
    v_add_f32_dpp v7, v19, v23 row_ror:8 row_mask:0xf bank_mask:0xc
    v_pk_mul_f32 v[4:5], v[4:5], v[28:29] op_sel_hi:[1,0]
    v_pk_mul_f32 v[6:7], v[6:7], v[28:29] op_sel_hi:[1,0]
    v_cvt_pk_bf16_f32 v4, v4, v5
    v_cvt_pk_bf16_f32 v5, v6, v7
    ds_write_b64 v73, v[4:5] offset:12288
    v_mov_b32_dpp v6, v4 row_ror:8 row_mask:0xf bank_mask:0xf
    v_mov_b32_dpp v7, v5 row_ror:8 row_mask:0xf bank_mask:0xf
    v_mov_b64 v[12:13], 0
    v_mov_b64 v[14:15], 0
    v_smfmac_f32_16x16x64_bf16 v[8:11], v[4:7], v[80:87], v64
    s_waitcnt lgkmcnt(4)
    v_mov_b64 v[24:25], 0
    v_smfmac_f32_16x16x64_bf16 v[0:3], v[4:7], v[40:47], v64
    ds_read_b128 v[60:63], v70 offset:29696
    v_mov_b64 v[26:27], 0
    v_smfmac_f32_16x16x64_bf16 v[12:15], v[4:7], v[112:119], v64
    s_waitcnt lgkmcnt(1)
    s_barrier
    ds_read_b128 v[16:19], v77 offset:12288
    v_smfmac_f32_16x16x64_bf16 v[24:27], v[4:7], v[48:55], v64
    ds_read_b128 v[20:23], v78 offset:12288
    ds_read_b128 v[28:31], v79 offset:12288
    v_mov_b64 v[4:5], 0
    v_mov_b64 v[6:7], 0
    v_bfe_u32 v77, v74, 16, 1
    v_mad_i32_i24 v77, v77, s56, v74
    s_waitcnt lgkmcnt(2)
    v_smfmac_f32_16x16x64_bf16 v[8:11], v[16:19], v[88:95], v64
    ds_read_b128 v[40:43], v70 offset:32768
    s_waitcnt lgkmcnt(2)
    v_smfmac_f32_16x16x64_bf16 v[8:11], v[20:23], v[96:103], v64
    ds_read_b128 v[44:47], v70 offset:33792
    s_waitcnt lgkmcnt(2)
    v_smfmac_f32_16x16x64_bf16 v[8:11], v[28:31], v[104:111], v64
    ds_read_b128 v[48:51], v70 offset:26624
    s_nop 0
    v_and_b32 v72, 8, v73
    v_smfmac_f32_16x16x64_bf16 v[0:3], v[16:19], v[32:39], v64
    ds_read_b128 v[52:55], v70 offset:27648
    s_nop 0
    v_mad_u32_u24 v72, v72, 63, v73
    v_smfmac_f32_16x16x64_bf16 v[12:15], v[16:19], v[120:127], v64
    ds_read_b128 v[32:35], v70 offset:30720
    v_cvt_pk_bf16_f32 v8, v8, v9
    v_cvt_pk_bf16_f32 v9, v10, v11
    v_and_or_b32 v8, v8, -2, s69
    v_smfmac_f32_16x16x64_bf16 v[12:15], v[20:23], v[128:135], v64
    buffer_store_dwordx2 v[8:9], v74, s[4:7], s22 offen offset:0 sc1
    ds_read_b128 v[36:39], v70 offset:31744
    v_smfmac_f32_16x16x64_bf16 v[12:15], v[28:31], v[136:143], v64
    s_add_u32 s30, s30, 1
    s_xor_b32 s70, s70, 1
    v_subrev_u32 v72, s47, v72
    v_smfmac_f32_16x16x64_bf16 v[0:3], v[20:23], v[56:63], v64
    ds_read_b128 v[56:59], v70 offset:34816
    s_waitcnt lgkmcnt(3)
    s_nop 0
    v_smfmac_f32_16x16x64_bf16 v[0:3], v[28:31], v[40:47], v64
    ds_read_b128 v[60:63], v70 offset:35840
    v_cvt_pk_bf16_f32 v12, v12, v13
    v_cvt_pk_bf16_f32 v13, v14, v15
    v_and_or_b32 v12, v12, -2, s69
    v_smfmac_f32_16x16x64_bf16 v[24:27], v[16:19], v[48:55], v64
    buffer_store_dwordx2 v[12:13], v74, s[4:7], s22 offen offset:64 sc1
    s_waitcnt lgkmcnt(2)
    v_smfmac_f32_16x16x64_bf16 v[24:27], v[20:23], v[32:39], v64
    ds_read_b128 v[40:43], v70 offset:16384
    v_cvt_pk_bf16_f32 v0, v0, v1
    v_cvt_pk_bf16_f32 v1, v2, v3
    v_and_or_b32 v0, v0, -2, s69
    s_waitcnt lgkmcnt(1)
    v_smfmac_f32_16x16x64_bf16 v[24:27], v[28:31], v[56:63], v64
    buffer_store_dwordx2 v[0:1], v74, s[4:7], s23 offen offset:0 sc1
    ds_read_b128 v[44:47], v70 offset:17408
    ds_read_b128 v[8:11], v72 offset:12288
    ds_read_b128 v[48:51], v70 offset:18432
    ds_read_b128 v[52:55], v70 offset:19456
    ds_read_b128 v[12:15], v72 offset:13312
    s_cmp_lg_u32 s71, 0
    s_nop 0
    v_cvt_pk_bf16_f32 v24, v24, v25
    v_cvt_pk_bf16_f32 v25, v26, v27
    v_and_or_b32 v24, v24, -2, s69
    buffer_store_dwordx2 v[24:25], v74, s[4:7], s23 offen offset:64 sc1
    s_waitcnt lgkmcnt(3)
    v_smfmac_f32_16x16x64_bf16 v[4:7], v[8:11], v[40:47], v64
    s_waitcnt lgkmcnt(0)
    v_smfmac_f32_16x16x64_bf16 v[4:7], v[12:15], v[48:55], v64
    s_nop 7
    v_cvt_pk_bf16_f32 v4, v4, v5
    v_cvt_pk_bf16_f32 v5, v6, v7
    v_and_or_b32 v4, v4, -2, s69
    buffer_store_dwordx2 v[4:5], v77, s[4:7], s25 offen offset:0 sc1
    s_nop 0
    s_cbranch_scc1 cs_e1
    s_cmp_lg_u32 s37, 0
    s_cbranch_scc1 cs_f0_xt
cs_f0_xtx:
    s_nop 2
    v_mov_b32 v79, v79
    s_nop 2
    v_mov_b32 v79, v79
    s_nop 2
    v_mov_b32 v79, v79
    s_nop 2
    v_mov_b32 v79, v79
    s_nop 2
    v_mov_b32 v79, v79
    s_nop 2
    v_mov_b32 v79, v79
    s_nop 2
    v_mov_b32 v79, v79
    s_nop 2
    v_mov_b32 v79, v79
    s_nop 2
    v_mov_b32 v79, v79
    s_nop 2
    v_mov_b32 v79, v79
    s_nop 2
    v_mov_b32 v79, v79
    s_nop 2
    v_mov_b32 v79, v79
    s_nop 2
    v_mov_b32 v79, v79
    s_nop 2
    v_mov_b32 v79, v79
    s_nop 2
    v_mov_b32 v79, v79
    s_nop 2
    v_mov_b32 v79, v79
    s_nop 2
    v_mov_b32 v79, v79
    s_nop 2
    v_mov_b32 v79, v79
    s_nop 2
    v_mov_b32 v79, v79
    s_nop 2
    v_mov_b32 v79, v79
    s_nop 2
    v_mov_b32 v79, v79
    s_nop 2
    v_mov_b32 v79, v79
    s_nop 2
    v_mov_b32 v79, v79
    s_nop 2
    v_mov_b32 v79, v79
    s_nop 2
    v_mov_b32 v79, v79
    s_nop 2
    v_mov_b32 v79, v79
    s_nop 2
    v_mov_b32 v79, v79
    s_nop 2
    v_mov_b32 v79, v79
    s_nop 2
    v_mov_b32 v79, v79
    s_nop 2
    v_mov_b32 v79, v79
    s_nop 2
    v_mov_b32 v79, v79
    s_nop 2
    v_mov_b32 v79, v79
    s_nop 2
    v_mov_b32 v79, v79
    s_nop 2
    v_mov_b32 v79, v79
    s_nop 2
    v_mov_b32 v79, v79
    s_nop 2
    v_mov_b32 v79, v79
    s_nop 0
    v_mov_b32 v79, v79
    buffer_load_dwordx4 v[8:11], v65, s[4:7], s18 offen sc1
    buffer_load_dwordx4 v[12:15], v65, s[4:7], s19 offen sc1
    buffer_load_dwordx4 v[16:19], v65, s[4:7], s20 offen sc1
    buffer_load_dwordx4 v[20:23], v65, s[4:7], s21 offen sc1
    v_and_b32 v77, 255, v69
    ds_read_b128 v[4:7], v77 offset:15872
    ds_read_b128 v[44:47], v70 offset:0
    ds_read_b128 v[48:51], v70 offset:1024
    ds_read_b128 v[52:55], v70 offset:2048
    ds_read_b128 v[56:59], v70 offset:3072
    ds_read_b128 v[24:27], v70 offset:4096
    ds_read_b128 v[28:31], v70 offset:5120
    ds_read_b128 v[32:35], v70 offset:6144
    ds_read_b128 v[36:39], v70 offset:7168
    s_mov_b32 s31, 65536
    s_add_u32 s24, s24, 524288
    s_add_u32 s26, s26, 524288
    s_add_u32 s55, s55, s57
    s_mov_b32 s14, 67633152
    s_mov_b32 s15, 67637248
    s_mov_b32 s16, 67641344
    s_mov_b32 s36, 1
    v_mov_b32 v40, s69
    v_mov_b32 v60, s69
    v_and_b32 v79, 12, v75
    v_cmp_eq_u32 vcc, 0, v79
    s_nop 1
    v_cndmask_b32 v79, 0, 1, vcc
    s_waitcnt lgkmcnt(0)
    s_waitcnt vmcnt(3)
    v_xor_b32 v77, s69, v8
    v_mfma_f32_16x16x32_bf16 v[0:3], v[4:7], v[8:11], 0
    v_mov_b64 v[8:9], 0
    v_mov_b64 v[10:11], 0
    s_waitcnt vmcnt(2)
    v_bitop3_b32 v77, v77, v12, s69 bitop3:0xf6
    v_mfma_f32_16x16x32_bf16 v[0:3], v[4:7], v[12:15], v[0:3]
    v_mov_b64 v[12:13], 0
    v_mov_b64 v[14:15], 0
    s_waitcnt vmcnt(1)
    v_bitop3_b32 v77, v77, v16, s69 bitop3:0xf6
    v_mfma_f32_16x16x32_bf16 v[0:3], v[4:7], v[16:19], v[0:3]
    v_mov_b64 v[16:17], 0
    v_mov_b64 v[18:19], 0
    s_waitcnt vmcnt(0)
    v_bitop3_b32 v77, v77, v20, s69 bitop3:0xf6
    v_mfma_f32_16x16x32_bf16 v[0:3], v[4:7], v[20:23], v[0:3]
    v_and_b32 v77, 1, v77
    v_cmp_ne_u32 vcc, 0, v77
    v_mov_b64 v[20:21], 0
    v_mov_b64 v[22:23], 0
    s_cmp_eq_u64 vcc, 0
    s_cselect_b64 s[42:43], -1, 0
    s_nop 1
    v_add_f32_dpp v0, v0, v0 row_ror:8 row_mask:0xf bank_mask:0xf
    v_add_f32_dpp v1, v1, v1 row_ror:8 row_mask:0xf bank_mask:0xf
    s_mov_b64 exec, s[42:43]
    v_cvt_pk_bf16_f32 v72, v0, v1
    v_bfi_b32 v72, v79, s70, v72
    buffer_store_dword v72, v75, s[4:7], s17 offen offset:0 sc1
    s_mov_b64 exec, -1
    s_cbranch_scc0 cs_f0_retry
cs_f0_go:
    v_mov_b64 v[0:1], 0
    v_mov_b64 v[2:3], 0
    v_mov_b64 v[4:5], 0
    v_mov_b64 v[6:7], 0
    s_nop 2
    v_mov_b32 v79, v79
    s_nop 2
    v_mov_b32 v79, v79
    s_nop 2
    v_mov_b32 v79, v79
    s_nop 2
    v_mov_b32 v79, v79
    s_nop 2
    v_mov_b32 v79, v79
    s_nop 2
    v_mov_b32 v79, v79
    s_nop 2
    v_mov_b32 v79, v79
    s_nop 2
    v_mov_b32 v79, v79
    s_nop 2
    v_mov_b32 v79, v79
    s_nop 2
    v_mov_b32 v79, v79
    s_nop 2
    v_mov_b32 v79, v79
    s_nop 2
    v_mov_b32 v79, v79
    s_nop 2
    v_mov_b32 v79, v79
    s_nop 2
    v_mov_b32 v79, v79
    s_nop 2
    v_mov_b32 v79, v79
    s_nop 2
    v_mov_b32 v79, v79
    s_nop 2
    v_mov_b32 v79, v79
    s_nop 2
    v_mov_b32 v79, v79
    s_nop 2
    v_mov_b32 v79, v79
    s_nop 2
    v_mov_b32 v79, v79
    s_nop 2
    v_mov_b32 v79, v79
    s_nop 2
    v_mov_b32 v79, v79
    s_nop 2
    v_mov_b32 v79, v79
    s_nop 2
    v_mov_b32 v79, v79
    s_nop 2
    v_mov_b32 v79, v79
    s_branch cs_loop
cs_e1:
    s_cmp_lg_u32 s71, 2
    s_cbranch_scc1 cs_f1
    v_and_b32 v77, 255, v69
    ds_read_b128 v[4:7], v77 offset:15872
    ds_read_b128 v[44:47], v70 offset:0
    ds_read_b128 v[48:51], v70 offset:1024
    ds_read_b128 v[52:55], v70 offset:2048
    ds_read_b128 v[56:59], v70 offset:3072
    ds_read_b128 v[24:27], v70 offset:4096
    ds_read_b128 v[28:31], v70 offset:5120
    ds_read_b128 v[32:35], v70 offset:6144
    ds_read_b128 v[36:39], v70 offset:7168
    s_mov_b32 s31, 65536
    s_add_u32 s24, s24, 524288
    s_add_u32 s26, s26, 524288
    s_add_u32 s55, s55, s57
    s_mov_b32 s14, 67633152
    s_mov_b32 s15, 67637248
    s_mov_b32 s16, 67641344
    s_mov_b32 s36, 1
    v_mov_b32 v40, s69
    v_mov_b32 v60, s69
    v_and_b32 v79, 12, v75
    v_cmp_eq_u32 vcc, 0, v79
    s_nop 1
    v_cndmask_b32 v79, 0, 1, vcc
    s_cmp_lg_u32 s37, 0
    s_cbranch_scc1 cs_f2_xt
cs_f2_xtx:
    s_nop 2
    v_mov_b32 v79, v79
    s_nop 2
    v_mov_b32 v79, v79
    s_nop 2
    v_mov_b32 v79, v79
    s_nop 2
    v_mov_b32 v79, v79
    s_nop 2
    v_mov_b32 v79, v79
    s_nop 2
    v_mov_b32 v79, v79
    s_nop 2
    v_mov_b32 v79, v79
    s_nop 2
    v_mov_b32 v79, v79
    s_nop 2
    v_mov_b32 v79, v79
    s_nop 2
    v_mov_b32 v79, v79
    s_nop 2
    v_mov_b32 v79, v79
    s_nop 2
    v_mov_b32 v79, v79
    s_nop 2
    v_mov_b32 v79, v79
    s_nop 2
    v_mov_b32 v79, v79
    s_nop 2
    v_mov_b32 v79, v79
    s_nop 2
    v_mov_b32 v79, v79
    s_nop 2
    v_mov_b32 v79, v79
    s_nop 2
    v_mov_b32 v79, v79
    s_nop 2
    v_mov_b32 v79, v79
    s_nop 2
    v_mov_b32 v79, v79
    s_nop 2
    v_mov_b32 v79, v79
    s_nop 2
    v_mov_b32 v79, v79
    s_nop 2
    v_mov_b32 v79, v79
    s_nop 2
    v_mov_b32 v79, v79
    s_nop 2
    v_mov_b32 v79, v79
    s_nop 2
    v_mov_b32 v79, v79
    s_nop 2
    v_mov_b32 v79, v79
    s_nop 2
    v_mov_b32 v79, v79
    s_nop 2
    v_mov_b32 v79, v79
    s_nop 2
    v_mov_b32 v79, v79
    s_nop 2
    v_mov_b32 v79, v79
    s_nop 2
    v_mov_b32 v79, v79
    s_nop 2
    v_mov_b32 v79, v79
    s_nop 2
    v_mov_b32 v79, v79
    s_nop 2
    v_mov_b32 v79, v79
    s_nop 2
    v_mov_b32 v79, v79
    s_nop 0
    v_mov_b32 v79, v79
    s_waitcnt vmcnt(0)
    buffer_load_dwordx4 v[8:11], v65, s[4:7], s18 offen sc1
    buffer_load_dwordx4 v[12:15], v65, s[4:7], s19 offen sc1
    buffer_load_dwordx4 v[16:19], v65, s[4:7], s20 offen sc1
    buffer_load_dwordx4 v[20:23], v65, s[4:7], s21 offen sc1
    s_nop 2
    v_mov_b32 v79, v79
    s_nop 2
    v_mov_b32 v79, v79
    s_nop 2
    v_mov_b32 v79, v79
    s_nop 2
    v_mov_b32 v79, v79
    s_nop 2
    v_mov_b32 v79, v79
    s_nop 2
    v_mov_b32 v79, v79
    s_nop 2
    v_mov_b32 v79, v79
    s_nop 2
    v_mov_b32 v79, v79
    s_nop 2
    v_mov_b32 v79, v79
    s_nop 2
    v_mov_b32 v79, v79
    buffer_load_dwordx4 v[40:43], v65, s[4:7], s14 offen offset:0 sc1
    buffer_load_dwordx4 v[60:63], v66, s[4:7], s14 offen offset:0 sc1
    s_waitcnt lgkmcnt(0)
    s_waitcnt vmcnt(5)
    v_xor_b32 v77, s69, v8
    v_mfma_f32_16x16x32_bf16 v[0:3], v[4:7], v[8:11], 0
    v_mov_b64 v[8:9], 0
    v_mov_b64 v[10:11], 0
    s_waitcnt vmcnt(4)
    v_bitop3_b32 v77, v77, v12, s69 bitop3:0xf6
    v_mfma_f32_16x16x32_bf16 v[0:3], v[4:7], v[12:15], v[0:3]
    v_mov_b64 v[12:13], 0
    v_mov_b64 v[14:15], 0
    s_waitcnt vmcnt(3)
    v_bitop3_b32 v77, v77, v16, s69 bitop3:0xf6
    v_mfma_f32_16x16x32_bf16 v[0:3], v[4:7], v[16:19], v[0:3]
    v_mov_b64 v[16:17], 0
    v_mov_b64 v[18:19], 0
    s_waitcnt vmcnt(2)
    v_bitop3_b32 v77, v77, v20, s69 bitop3:0xf6
    v_mfma_f32_16x16x32_bf16 v[0:3], v[4:7], v[20:23], v[0:3]
    v_and_b32 v77, 1, v77
    v_cmp_ne_u32 vcc, 0, v77
    v_mov_b64 v[20:21], 0
    v_mov_b64 v[22:23], 0
    buffer_load_dwordx4 v[40:43], v65, s[4:7], s14 offen offset:0 sc1
    buffer_load_dwordx4 v[60:63], v66, s[4:7], s14 offen offset:0 sc1
    s_cmp_eq_u64 vcc, 0
    s_cselect_b64 s[42:43], -1, 0
    v_add_f32_dpp v0, v0, v0 row_ror:4 row_mask:0xf bank_mask:0xf
    v_add_f32_dpp v1, v1, v1 row_ror:4 row_mask:0xf bank_mask:0xf
    s_nop 0
    v_add_f32_dpp v0, v0, v0 row_ror:8 row_mask:0xf bank_mask:0xf
    v_add_f32_dpp v1, v1, v1 row_ror:8 row_mask:0xf bank_mask:0xf
    s_mov_b64 exec, s[42:43]
    v_cvt_pk_bf16_f32 v72, v0, v1
    v_bfi_b32 v72, v79, s70, v72
    buffer_store_dword v72, v75, s[4:7], s17 offen offset:0 sc1
    buffer_store_dword v72, v75, s[4:7], s17 offen offset:1024 sc1
    buffer_store_dword v72, v75, s[4:7], s17 offen offset:2048 sc1
    buffer_store_dword v72, v75, s[4:7], s17 offen offset:3072 sc1
    s_mov_b64 exec, -1
    s_cbranch_scc0 cs_f2_retry
cs_f2_go:
    v_mov_b64 v[0:1], 0
    v_mov_b64 v[2:3], 0
    v_mov_b64 v[4:5], 0
    v_mov_b64 v[6:7], 0
    s_nop 2
    v_mov_b32 v79, v79
    s_nop 2
    v_mov_b32 v79, v79
    s_nop 2
    v_mov_b32 v79, v79
    s_nop 2
    v_mov_b32 v79, v79
    s_nop 2
    v_mov_b32 v79, v79
    s_nop 2
    v_mov_b32 v79, v79
    s_nop 2
    v_mov_b32 v79, v79
    s_nop 2
    v_mov_b32 v79, v79
    s_nop 2
    v_mov_b32 v79, v79
    s_nop 2
    v_mov_b32 v79, v79
    s_nop 2
    v_mov_b32 v79, v79
    s_nop 2
    v_mov_b32 v79, v79
    s_nop 2
    v_mov_b32 v79, v79
    s_nop 2
    v_mov_b32 v79, v79
    s_nop 2
    v_mov_b32 v79, v79
    s_nop 2
    v_mov_b32 v79, v79
    s_nop 2
    v_mov_b32 v79, v79
    s_nop 2
    v_mov_b32 v79, v79
    s_nop 2
    v_mov_b32 v79, v79
    s_nop 2
    v_mov_b32 v79, v79
    s_nop 2
    v_mov_b32 v79, v79
    s_nop 2
    v_mov_b32 v79, v79
    s_nop 2
    v_mov_b32 v79, v79
    s_nop 2
    v_mov_b32 v79, v79
    s_nop 2
    v_mov_b32 v79, v79
    s_branch cs_loop
cs_f1:
    s_cmp_lg_u32 s32, 1
    s_cbranch_scc1 cs_f3
    v_and_b32 v77, 255, v69
    ds_read_b128 v[4:7], v77 offset:15872
    ds_read_b128 v[44:47], v70 offset:0
    ds_read_b128 v[48:51], v70 offset:1024
    ds_read_b128 v[52:55], v70 offset:2048
    ds_read_b128 v[56:59], v70 offset:3072
    ds_read_b128 v[24:27], v70 offset:4096
    ds_read_b128 v[28:31], v70 offset:5120
    ds_read_b128 v[32:35], v70 offset:6144
    ds_read_b128 v[36:39], v70 offset:7168
    s_mov_b32 s31, 65536
    s_add_u32 s24, s24, 524288
    s_add_u32 s26, s26, 524288
    s_add_u32 s55, s55, s57
    s_mov_b32 s14, 67633152
    s_mov_b32 s15, 67637248
    s_mov_b32 s16, 67641344
    s_mov_b32 s36, 1
    v_mov_b32 v40, s69
    v_mov_b32 v60, s69
    v_and_b32 v79, 12, v75
    v_cmp_eq_u32 vcc, 0, v79
    s_nop 1
    v_cndmask_b32 v79, 0, 1, vcc
    s_cmp_lg_u32 s37, 0
    s_cbranch_scc1 cs_f1_xt
cs_f1_xtx:
    s_nop 2
    v_mov_b32 v79, v79
    s_nop 2
    v_mov_b32 v79, v79
    s_nop 2
    v_mov_b32 v79, v79
    s_nop 2
    v_mov_b32 v79, v79
    s_nop 2
    v_mov_b32 v79, v79
    s_nop 2
    v_mov_b32 v79, v79
    s_nop 2
    v_mov_b32 v79, v79
    s_nop 2
    v_mov_b32 v79, v79
    s_nop 2
    v_mov_b32 v79, v79
    s_nop 2
    v_mov_b32 v79, v79
    s_nop 2
    v_mov_b32 v79, v79
    s_nop 2
    v_mov_b32 v79, v79
    s_nop 2
    v_mov_b32 v79, v79
    s_nop 2
    v_mov_b32 v79, v79
    s_nop 2
    v_mov_b32 v79, v79
    s_nop 2
    v_mov_b32 v79, v79
    s_nop 2
    v_mov_b32 v79, v79
    s_nop 2
    v_mov_b32 v79, v79
    s_nop 2
    v_mov_b32 v79, v79
    s_nop 2
    v_mov_b32 v79, v79
    s_nop 2
    v_mov_b32 v79, v79
    s_nop 2
    v_mov_b32 v79, v79
    s_nop 2
    v_mov_b32 v79, v79
    s_nop 2
    v_mov_b32 v79, v79
    s_nop 2
    v_mov_b32 v79, v79
    s_nop 2
    v_mov_b32 v79, v79
    s_nop 2
    v_mov_b32 v79, v79
    s_nop 2
    v_mov_b32 v79, v79
    s_nop 2
    v_mov_b32 v79, v79
    s_nop 2
    v_mov_b32 v79, v79
    s_nop 2
    v_mov_b32 v79, v79
    s_nop 2
    v_mov_b32 v79, v79
    s_nop 2
    v_mov_b32 v79, v79
    s_nop 2
    v_mov_b32 v79, v79
    s_nop 2
    v_mov_b32 v79, v79
    s_nop 2
    v_mov_b32 v79, v79
    s_nop 0
    v_mov_b32 v79, v79
    s_waitcnt vmcnt(0)
    buffer_load_dwordx4 v[8:11], v65, s[4:7], s18 offen sc1
    buffer_load_dwordx4 v[12:15], v65, s[4:7], s19 offen sc1
    buffer_load_dwordx4 v[16:19], v65, s[4:7], s20 offen sc1
    buffer_load_dwordx4 v[20:23], v65, s[4:7], s21 offen sc1
    s_nop 2
    v_mov_b32 v79, v79
    s_nop 2
    v_mov_b32 v79, v79
    s_nop 2
    v_mov_b32 v79, v79
    s_nop 2
    v_mov_b32 v79, v79
    s_nop 2
    v_mov_b32 v79, v79
    s_nop 2
    v_mov_b32 v79, v79
    s_nop 2
    v_mov_b32 v79, v79
    s_nop 2
    v_mov_b32 v79, v79
    s_nop 2
    v_mov_b32 v79, v79
    s_nop 2
    v_mov_b32 v79, v79
    buffer_load_dwordx4 v[40:43], v65, s[4:7], s14 offen offset:0 sc1
    buffer_load_dwordx4 v[60:63], v66, s[4:7], s14 offen offset:0 sc1
    s_waitcnt lgkmcnt(0)
    s_waitcnt vmcnt(5)
    v_xor_b32 v77, s69, v8
    v_mfma_f32_16x16x32_bf16 v[0:3], v[4:7], v[8:11], 0
    v_mov_b64 v[8:9], 0
    v_mov_b64 v[10:11], 0
    s_waitcnt vmcnt(4)
    v_bitop3_b32 v77, v77, v12, s69 bitop3:0xf6
    v_mfma_f32_16x16x32_bf16 v[0:3], v[4:7], v[12:15], v[0:3]
    v_mov_b64 v[12:13], 0
    v_mov_b64 v[14:15], 0
    s_waitcnt vmcnt(3)
    v_bitop3_b32 v77, v77, v16, s69 bitop3:0xf6
    v_mfma_f32_16x16x32_bf16 v[0:3], v[4:7], v[16:19], v[0:3]
    v_mov_b64 v[16:17], 0
    v_mov_b64 v[18:19], 0
    s_waitcnt vmcnt(2)
    v_bitop3_b32 v77, v77, v20, s69 bitop3:0xf6
    v_mfma_f32_16x16x32_bf16 v[0:3], v[4:7], v[20:23], v[0:3]
    v_and_b32 v77, 1, v77
    v_cmp_ne_u32 vcc, 0, v77
    v_mov_b64 v[20:21], 0
    v_mov_b64 v[22:23], 0
    buffer_load_dwordx4 v[40:43], v65, s[4:7], s14 offen offset:0 sc1
    buffer_load_dwordx4 v[60:63], v66, s[4:7], s14 offen offset:0 sc1
    s_cmp_eq_u64 vcc, 0
    s_cselect_b64 s[42:43], -1, 0
    v_add_f32_dpp v0, v0, v0 row_ror:8 row_mask:0xf bank_mask:0xf
    v_add_f32_dpp v1, v1, v1 row_ror:8 row_mask:0xf bank_mask:0xf
    s_mov_b64 exec, s[42:43]
    v_cvt_pk_bf16_f32 v72, v0, v1
    v_bfi_b32 v72, v79, s70, v72
    buffer_store_dword v72, v75, s[4:7], s17 offen offset:0 sc1
    s_mov_b64 exec, -1
    s_cbranch_scc0 cs_f1_retry
cs_f1_go:
    v_mov_b64 v[0:1], 0
    v_mov_b64 v[2:3], 0
    v_mov_b64 v[4:5], 0
    v_mov_b64 v[6:7], 0
    s_nop 2
    v_mov_b32 v79, v79
    s_nop 2
    v_mov_b32 v79, v79
    s_nop 2
    v_mov_b32 v79, v79
    s_nop 2
    v_mov_b32 v79, v79
    s_nop 2
    v_mov_b32 v79, v79
    s_nop 2
    v_mov_b32 v79, v79
    s_nop 2
    v_mov_b32 v79, v79
    s_nop 2
    v_mov_b32 v79, v79
    s_nop 2
    v_mov_b32 v79, v79
    s_nop 2
    v_mov_b32 v79, v79
    s_nop 2
    v_mov_b32 v79, v79
    s_nop 2
    v_mov_b32 v79, v79
    s_nop 2
    v_mov_b32 v79, v79
    s_nop 2
    v_mov_b32 v79, v79
    s_nop 2
    v_mov_b32 v79, v79
    s_nop 2
    v_mov_b32 v79, v79
    s_nop 2
    v_mov_b32 v79, v79
    s_nop 2
    v_mov_b32 v79, v79
    s_nop 2
    v_mov_b32 v79, v79
    s_nop 2
    v_mov_b32 v79, v79
    s_nop 2
    v_mov_b32 v79, v79
    s_nop 2
    v_mov_b32 v79, v79
    s_nop 2
    v_mov_b32 v79, v79
    s_nop 2
    v_mov_b32 v79, v79
    s_nop 2
    v_mov_b32 v79, v79
    s_branch cs_loop
cs_f3:
    v_and_b32 v77, 255, v69
    ds_read_b128 v[4:7], v77 offset:15872
    ds_read_b128 v[44:47], v70 offset:0
    ds_read_b128 v[48:51], v70 offset:1024
    ds_read_b128 v[52:55], v70 offset:2048
    ds_read_b128 v[56:59], v70 offset:3072
    ds_read_b128 v[24:27], v70 offset:4096
    ds_read_b128 v[28:31], v70 offset:5120
    ds_read_b128 v[32:35], v70 offset:6144
    ds_read_b128 v[36:39], v70 offset:7168
    s_mov_b32 s31, 65536
    s_add_u32 s24, s24, 524288
    s_add_u32 s26, s26, 524288
    s_add_u32 s55, s55, s57
    s_mov_b32 s14, 67633152
    s_mov_b32 s15, 67637248
    s_mov_b32 s16, 67641344
    s_mov_b32 s36, 1
    v_mov_b32 v40, s69
    v_mov_b32 v60, s69
    v_and_b32 v79, 12, v75
    v_cmp_eq_u32 vcc, 0, v79
    s_nop 1
    v_cndmask_b32 v79, 0, 1, vcc
    s_add_u32 s40, s30, s95
    v_mov_b32 v72, s40
    s_waitcnt lgkmcnt(0)
    v_mov_b64 v[0:1], 0
    v_mov_b64 v[2:3], 0
    v_mov_b64 v[4:5], 0
    v_mov_b64 v[6:7], 0
    v_mov_b64 v[8:9], 0
    v_mov_b64 v[10:11], 0
    v_mov_b64 v[12:13], 0
    v_mov_b64 v[14:15], 0
    v_mov_b64 v[16:17], 0
    v_mov_b64 v[18:19], 0
    v_mov_b64 v[20:21], 0
    v_mov_b64 v[22:23], 0
    s_nop 2
    v_mov_b32 v79, v79
    s_nop 2
    v_mov_b32 v79, v79
    s_nop 2
    v_mov_b32 v79, v79
    s_nop 2
    v_mov_b32 v79, v79
    s_nop 2
    v_mov_b32 v79, v79
    s_nop 2
    v_mov_b32 v79, v79
    s_nop 2
    v_mov_b32 v79, v79
    s_nop 2
    v_mov_b32 v79, v79
    s_nop 2
    v_mov_b32 v79, v79
    s_nop 2
    v_mov_b32 v79, v79
    s_nop 2
    v_mov_b32 v79, v79
    s_nop 2
    v_mov_b32 v79, v79
    s_nop 2
    v_mov_b32 v79, v79
    s_nop 2
    v_mov_b32 v79, v79
    s_nop 2
    v_mov_b32 v79, v79
    s_nop 2
    v_mov_b32 v79, v79
    s_nop 2
    v_mov_b32 v79, v79
    s_nop 2
    v_mov_b32 v79, v79
    s_nop 2
    v_mov_b32 v79, v79
    s_nop 2
    v_mov_b32 v79, v79
    s_nop 2
    v_mov_b32 v79, v79
    s_nop 2
    v_mov_b32 v79, v79
    s_nop 2
    v_mov_b32 v79, v79
    s_nop 2
    v_mov_b32 v79, v79
    s_nop 2
    v_mov_b32 v79, v79
    s_nop 2
    v_mov_b32 v79, v79
    s_nop 2
    v_mov_b32 v79, v79
    s_nop 2
    v_mov_b32 v79, v79
    s_nop 2
    v_mov_b32 v79, v79
    s_nop 2
    v_mov_b32 v79, v79
    s_nop 2
    v_mov_b32 v79, v79
    s_nop 2
    v_mov_b32 v79, v79
    s_nop 2
    v_mov_b32 v79, v79
    s_nop 2
    v_mov_b32 v79, v79
    s_nop 2
    v_mov_b32 v79, v79
    s_nop 2
    v_mov_b32 v79, v79
    s_nop 2
    v_mov_b32 v79, v79
    s_nop 2
    v_mov_b32 v79, v79
    s_nop 2
    v_mov_b32 v79, v79
    s_nop 2
    v_mov_b32 v79, v79
    s_nop 2
    v_mov_b32 v79, v79
    s_nop 2
    v_mov_b32 v79, v79
    s_nop 2
    v_mov_b32 v79, v79
    s_nop 2
    v_mov_b32 v79, v79
    s_nop 2
    v_mov_b32 v79, v79
    s_nop 2
    v_mov_b32 v79, v79
    s_nop 2
    v_mov_b32 v79, v79
    s_nop 2
    v_mov_b32 v79, v79
    s_nop 2
    v_mov_b32 v79, v79
    s_nop 2
    v_mov_b32 v79, v79
    s_nop 2
    v_mov_b32 v79, v79
    s_nop 2
    v_mov_b32 v79, v79
    s_nop 2
    v_mov_b32 v79, v79
    s_nop 2
    v_mov_b32 v79, v79
    s_nop 2
    v_mov_b32 v79, v79
    s_nop 2
    v_mov_b32 v79, v79
    s_nop 2
    v_mov_b32 v79, v79
    s_nop 2
    v_mov_b32 v79, v79
    s_nop 2
    v_mov_b32 v79, v79
    s_nop 2
    v_mov_b32 v79, v79
    s_nop 2
    v_mov_b32 v79, v79
    s_nop 2
    v_mov_b32 v79, v79
    s_nop 2
    v_mov_b32 v79, v79
    s_nop 2
    v_mov_b32 v79, v79
    s_nop 2
    v_mov_b32 v79, v79
    s_waitcnt vmcnt(0)
    s_cmp_lt_u32 s97, s93
    s_cbranch_scc1 cs_kvwait
    s_nop 2
    v_mov_b32 v79, v79
    s_nop 2
    v_mov_b32 v79, v79
    s_nop 2
    v_mov_b32 v79, v79
    s_nop 2
    v_mov_b32 v79, v79
    s_nop 2
    v_mov_b32 v79, v79
    s_nop 2
    v_mov_b32 v79, v79
    s_nop 2
    v_mov_b32 v79, v79
    s_nop 2
    v_mov_b32 v79, v79
cs_kvok:
    s_branch cs_loop
cs_f0_xt:
    s_sub_u32 s37, s37, 1
    s_nop 2
    v_mov_b32 v79, v79
    s_nop 2
    v_mov_b32 v79, v79
    s_nop 2
    v_mov_b32 v79, v79
    s_nop 2
    v_mov_b32 v79, v79
    s_nop 2
    v_mov_b32 v79, v79
    s_nop 2
    v_mov_b32 v79, v79
    s_branch cs_f0_xtx
cs_f0_retry:
    s_sub_u32 s41, s30, s98
    s_mov_b32 s98, s30
    s_cmp_le_u32 s41, 3
    s_cselect_b32 s37, 1, 1
cs_f0_spin:
    buffer_load_dwordx4 v[8:11], v65, s[4:7], s18 offen sc1
    buffer_load_dwordx4 v[12:15], v65, s[4:7], s19 offen sc1
    buffer_load_dwordx4 v[16:19], v65, s[4:7], s20 offen sc1
    buffer_load_dwordx4 v[20:23], v65, s[4:7], s21 offen sc1
    s_nop 2
    v_mov_b32 v79, v79
    s_nop 2
    v_mov_b32 v79, v79
    s_nop 2
    v_mov_b32 v79, v79
    buffer_load_dwordx4 v[40:43], v65, s[4:7], s14 offen offset:0 sc1
    buffer_load_dwordx4 v[60:63], v66, s[4:7], s14 offen offset:0 sc1
    s_waitcnt vmcnt(5)
    v_xor_b32 v77, s69, v8
    v_mfma_f32_16x16x32_bf16 v[0:3], v[4:7], v[8:11], 0
    v_mov_b64 v[8:9], 0
    v_mov_b64 v[10:11], 0
    s_waitcnt vmcnt(4)
    v_bitop3_b32 v77, v77, v12, s69 bitop3:0xf6
    v_mfma_f32_16x16x32_bf16 v[0:3], v[4:7], v[12:15], v[0:3]
    v_mov_b64 v[12:13], 0
    v_mov_b64 v[14:15], 0
    s_waitcnt vmcnt(3)
    v_bitop3_b32 v77, v77, v16, s69 bitop3:0xf6
    v_mfma_f32_16x16x32_bf16 v[0:3], v[4:7], v[16:19], v[0:3]
    v_mov_b64 v[16:17], 0
    v_mov_b64 v[18:19], 0
    s_waitcnt vmcnt(2)
    v_bitop3_b32 v77, v77, v20, s69 bitop3:0xf6
    v_mfma_f32_16x16x32_bf16 v[0:3], v[4:7], v[20:23], v[0:3]
    v_and_b32 v77, 1, v77
    v_cmp_ne_u32 vcc, 0, v77
    v_mov_b64 v[20:21], 0
    v_mov_b64 v[22:23], 0
    buffer_load_dwordx4 v[40:43], v65, s[4:7], s14 offen offset:0 sc1
    buffer_load_dwordx4 v[60:63], v66, s[4:7], s14 offen offset:0 sc1
    s_cmp_eq_u64 vcc, 0
    s_cselect_b64 s[42:43], -1, 0
    v_add_f32_dpp v0, v0, v0 row_ror:8 row_mask:0xf bank_mask:0xf
    v_add_f32_dpp v1, v1, v1 row_ror:8 row_mask:0xf bank_mask:0xf
    s_mov_b64 exec, s[42:43]
    v_cvt_pk_bf16_f32 v72, v0, v1
    v_bfi_b32 v72, v79, s70, v72
    buffer_store_dword v72, v75, s[4:7], s17 offen offset:0 sc1
    s_mov_b64 exec, -1
    s_cbranch_scc1 cs_f0_rx
    s_sub_u32 s31, s31, 1
    s_cbranch_scc0 cs_f0_spin
cs_f0_rx:
    v_mov_b64 v[0:1], 0
    v_mov_b64 v[2:3], 0
    v_mov_b64 v[4:5], 0
    v_mov_b64 v[6:7], 0
    s_branch cs_loop
cs_f1_xt:
    s_sub_u32 s37, s37, 1
    s_nop 2
    v_mov_b32 v79, v79
    s_nop 2
    v_mov_b32 v79, v79
    s_nop 2
    v_mov_b32 v79, v79
    s_nop 2
    v_mov_b32 v79, v79
    s_nop 2
    v_mov_b32 v79, v79
    s_nop 2
    v_mov_b32 v79, v79
    s_branch cs_f1_xtx
cs_f1_retry:
    s_sub_u32 s41, s30, s98
    s_mov_b32 s98, s30
    s_cmp_le_u32 s41, 3
    s_cselect_b32 s37, 1, 1
cs_f1_spin:
    buffer_load_dwordx4 v[8:11], v65, s[4:7], s18 offen sc1
    buffer_load_dwordx4 v[12:15], v65, s[4:7], s19 offen sc1
    buffer_load_dwordx4 v[16:19], v65, s[4:7], s20 offen sc1
    buffer_load_dwordx4 v[20:23], v65, s[4:7], s21 offen sc1
    s_nop 2
    v_mov_b32 v79, v79
    s_nop 2
    v_mov_b32 v79, v79
    s_nop 2
    v_mov_b32 v79, v79
    buffer_load_dwordx4 v[40:43], v65, s[4:7], s14 offen offset:0 sc1
    buffer_load_dwordx4 v[60:63], v66, s[4:7], s14 offen offset:0 sc1
    s_waitcnt vmcnt(5)
    v_xor_b32 v77, s69, v8
    v_mfma_f32_16x16x32_bf16 v[0:3], v[4:7], v[8:11], 0
    v_mov_b64 v[8:9], 0
    v_mov_b64 v[10:11], 0
    s_waitcnt vmcnt(4)
    v_bitop3_b32 v77, v77, v12, s69 bitop3:0xf6
    v_mfma_f32_16x16x32_bf16 v[0:3], v[4:7], v[12:15], v[0:3]
    v_mov_b64 v[12:13], 0
    v_mov_b64 v[14:15], 0
    s_waitcnt vmcnt(3)
    v_bitop3_b32 v77, v77, v16, s69 bitop3:0xf6
    v_mfma_f32_16x16x32_bf16 v[0:3], v[4:7], v[16:19], v[0:3]
    v_mov_b64 v[16:17], 0
    v_mov_b64 v[18:19], 0
    s_waitcnt vmcnt(2)
    v_bitop3_b32 v77, v77, v20, s69 bitop3:0xf6
    v_mfma_f32_16x16x32_bf16 v[0:3], v[4:7], v[20:23], v[0:3]
    v_and_b32 v77, 1, v77
    v_cmp_ne_u32 vcc, 0, v77
    v_mov_b64 v[20:21], 0
    v_mov_b64 v[22:23], 0
    buffer_load_dwordx4 v[40:43], v65, s[4:7], s14 offen offset:0 sc1
    buffer_load_dwordx4 v[60:63], v66, s[4:7], s14 offen offset:0 sc1
    s_cmp_eq_u64 vcc, 0
    s_cselect_b64 s[42:43], -1, 0
    v_add_f32_dpp v0, v0, v0 row_ror:8 row_mask:0xf bank_mask:0xf
    v_add_f32_dpp v1, v1, v1 row_ror:8 row_mask:0xf bank_mask:0xf
    s_mov_b64 exec, s[42:43]
    v_cvt_pk_bf16_f32 v72, v0, v1
    v_bfi_b32 v72, v79, s70, v72
    buffer_store_dword v72, v75, s[4:7], s17 offen offset:0 sc1
    s_mov_b64 exec, -1
    s_cbranch_scc1 cs_f1_rx
    s_sub_u32 s31, s31, 1
    s_cbranch_scc0 cs_f1_spin
cs_f1_rx:
    v_mov_b64 v[0:1], 0
    v_mov_b64 v[2:3], 0
    v_mov_b64 v[4:5], 0
    v_mov_b64 v[6:7], 0
    s_branch cs_loop
cs_f2_xt:
    s_sub_u32 s37, s37, 1
    s_nop 2
    v_mov_b32 v79, v79
    s_nop 2
    v_mov_b32 v79, v79
    s_nop 2
    v_mov_b32 v79, v79
    s_nop 2
    v_mov_b32 v79, v79
    s_nop 2
    v_mov_b32 v79, v79
    s_nop 2
    v_mov_b32 v79, v79
    s_branch cs_f2_xtx
cs_f2_retry:
    s_sub_u32 s41, s30, s98
    s_mov_b32 s98, s30
    s_cmp_le_u32 s41, 3
    s_cselect_b32 s37, 1, 1
cs_f2_spin:
    buffer_load_dwordx4 v[8:11], v65, s[4:7], s18 offen sc1
    buffer_load_dwordx4 v[12:15], v65, s[4:7], s19 offen sc1
    buffer_load_dwordx4 v[16:19], v65, s[4:7], s20 offen sc1
    buffer_load_dwordx4 v[20:23], v65, s[4:7], s21 offen sc1
    s_nop 2
    v_mov_b32 v79, v79
    s_nop 2
    v_mov_b32 v79, v79
    s_nop 2
    v_mov_b32 v79, v79
    buffer_load_dwordx4 v[40:43], v65, s[4:7], s14 offen offset:0 sc1
    buffer_load_dwordx4 v[60:63], v66, s[4:7], s14 offen offset:0 sc1
    s_waitcnt vmcnt(5)
    v_xor_b32 v77, s69, v8
    v_mfma_f32_16x16x32_bf16 v[0:3], v[4:7], v[8:11], 0
    v_mov_b64 v[8:9], 0
    v_mov_b64 v[10:11], 0
    s_waitcnt vmcnt(4)
    v_bitop3_b32 v77, v77, v12, s69 bitop3:0xf6
    v_mfma_f32_16x16x32_bf16 v[0:3], v[4:7], v[12:15], v[0:3]
    v_mov_b64 v[12:13], 0
    v_mov_b64 v[14:15], 0
    s_waitcnt vmcnt(3)
    v_bitop3_b32 v77, v77, v16, s69 bitop3:0xf6
    v_mfma_f32_16x16x32_bf16 v[0:3], v[4:7], v[16:19], v[0:3]
    v_mov_b64 v[16:17], 0
    v_mov_b64 v[18:19], 0
    s_waitcnt vmcnt(2)
    v_bitop3_b32 v77, v77, v20, s69 bitop3:0xf6
    v_mfma_f32_16x16x32_bf16 v[0:3], v[4:7], v[20:23], v[0:3]
    v_and_b32 v77, 1, v77
    v_cmp_ne_u32 vcc, 0, v77
    v_mov_b64 v[20:21], 0
    v_mov_b64 v[22:23], 0
    buffer_load_dwordx4 v[40:43], v65, s[4:7], s14 offen offset:0 sc1
    buffer_load_dwordx4 v[60:63], v66, s[4:7], s14 offen offset:0 sc1
    s_cmp_eq_u64 vcc, 0
    s_cselect_b64 s[42:43], -1, 0
    v_add_f32_dpp v0, v0, v0 row_ror:4 row_mask:0xf bank_mask:0xf
    v_add_f32_dpp v1, v1, v1 row_ror:4 row_mask:0xf bank_mask:0xf
    s_nop 0
    v_add_f32_dpp v0, v0, v0 row_ror:8 row_mask:0xf bank_mask:0xf
    v_add_f32_dpp v1, v1, v1 row_ror:8 row_mask:0xf bank_mask:0xf
    s_mov_b64 exec, s[42:43]
    v_cvt_pk_bf16_f32 v72, v0, v1
    v_bfi_b32 v72, v79, s70, v72
    buffer_store_dword v72, v75, s[4:7], s17 offen offset:0 sc1
    buffer_store_dword v72, v75, s[4:7], s17 offen offset:1024 sc1
    buffer_store_dword v72, v75, s[4:7], s17 offen offset:2048 sc1
    buffer_store_dword v72, v75, s[4:7], s17 offen offset:3072 sc1
    s_mov_b64 exec, -1
    s_cbranch_scc1 cs_f2_rx
    s_sub_u32 s31, s31, 1
    s_cbranch_scc0 cs_f2_spin
cs_f2_rx:
    v_mov_b64 v[0:1], 0
    v_mov_b64 v[2:3], 0
    v_mov_b64 v[4:5], 0
    v_mov_b64 v[6:7], 0
    s_branch cs_loop
cs_spinB:
    s_waitcnt vmcnt(3)
cs_spinB_l:
    v_and_b32 v77, s36, v44
    v_cmp_ne_u32 vcc, s70, v77
    s_cbranch_vccz cs_spinB_x
    buffer_load_dwordx4 v[44:47], v65, s[4:7], s15 offen sc1
    s_sub_u32 s31, s31, 16
    s_waitcnt vmcnt(0)
    s_cbranch_scc0 cs_spinB_l
cs_spinB_x:
    ds_write_b128 v65, v[44:47] offset:4096
    s_waitcnt lgkmcnt(0)
    s_branch cs_backB
cs_spin8:
    buffer_load_dwordx4 v[40:43], v65, s[4:7], s16 offen sc1
cs_spin8_l:
    v_and_b32 v77, s36, v40
    v_cmp_ne_u32 vcc, s70, v77
    s_cbranch_vccz cs_spin8_x
    s_nop 15
    s_nop 15
    s_nop 15
    s_nop 11
    v_and_b32 v77, s36, v40
    v_cmp_ne_u32 vcc, s70, v77
    s_cbranch_vccz cs_spin8_x
    s_nop 15
    s_nop 15
    s_nop 15
    s_nop 11
    v_and_b32 v77, s36, v40
    v_cmp_ne_u32 vcc, s70, v77
    s_cbranch_vccz cs_spin8_x
    s_nop 15
    s_nop 15
    s_nop 15
    s_nop 11
    buffer_load_dwordx4 v[40:43], v65, s[4:7], s16 offen sc1
    s_sub_u32 s31, s31, 16
    s_cbranch_scc0 cs_spin8_l
cs_spin8_x:
    s_branch cs_back8
cs_rare:
    s_mov_b64 exec, s[34:35]
    buffer_store_dwordx4 v[0:3], v65, s[4:7], s28 offen sc1
    s_mov_b64 exec, -1
    s_nop 3
    v_cvt_pk_bf16_f32 v52, v16, v17
    v_cvt_pk_bf16_f32 v53, v18, v19
    v_cvt_pk_bf16_f32 v54, v20, v21
    v_cvt_pk_bf16_f32 v55, v22, v23
    buffer_store_dwordx4 v[52:55], v65, s[4:7], s27 offen sc1
    s_add_u32 s28, s28, 131072
    s_add_u32 s27, s27, 131072
    s_cmp_eq_u32 s30, 63
    s_cbranch_scc1 cs_last
    s_branch cs_rare_x
cs_kvwait:
    s_mov_b32 s41, s97
    v_bfe_u32 v78, v65, 2, 5
    v_mov_b32 v77, v76
    s_nop 1
    v_permlane32_swap_b32 v76, v77
    v_subrev_u32 v77, s95, v77
    v_cmp_lt_u32 vcc, 16, v77
    s_nop 1
    v_cndmask_b32 v77, v77, 0, vcc
    v_bfe_u32 v79, v78, 2, 2
    v_lshl_add_u32 v77, v77, 2, v79
    s_nop 1
    v_min_u32_dpp v77, v77, v77 row_ror:1 row_mask:0xf bank_mask:0xf
    s_nop 1
    v_min_u32_dpp v77, v77, v77 row_ror:2 row_mask:0xf bank_mask:0xf
    s_nop 1
    v_min_u32_dpp v77, v77, v77 row_ror:4 row_mask:0xf bank_mask:0xf
    s_nop 0
    v_readfirstlane_b32 s97, v77
    s_nop 0
    s_max_u32 s97, s97, s41
    s_add_u32 s40, s30, 3
    s_min_u32 s40, s40, 64
    s_cmp_le_u32 s40, s97
    s_cbranch_scc1 cs_kvw_x
    v_bfe_u32 v78, v65, 2, 5
    s_mov_b32 s31, 4194304
cs_kvw:
    buffer_load_dword v77, v78, s[4:7], s96 offen offset:16 sc1
    s_waitcnt vmcnt(0)
    v_subrev_u32 v77, s95, v77
    v_cmp_lt_u32 vcc, 16, v77
    s_nop 1
    v_cndmask_b32 v77, v77, 0, vcc
    v_bfe_u32 v79, v78, 2, 2
    v_lshl_add_u32 v77, v77, 2, v79
    s_nop 1
    v_min_u32_dpp v77, v77, v77 row_ror:1 row_mask:0xf bank_mask:0xf
    s_nop 1
    v_min_u32_dpp v77, v77, v77 row_ror:2 row_mask:0xf bank_mask:0xf
    s_nop 1
    v_min_u32_dpp v77, v77, v77 row_ror:4 row_mask:0xf bank_mask:0xf
    s_nop 0
    v_readfirstlane_b32 s97, v77
    s_sub_u32 s31, s31, 1
    s_cbranch_scc1 cs_kvw_x
    s_cmp_le_u32 s40, s97
    s_cbranch_scc1 cs_kvw_x
    s_sleep 2
    s_branch cs_kvw
cs_kvw_x:
    s_branch cs_kvok
cs_last:
    s_add_u32 s40, s95, 64
    v_mov_b32 v78, s40
    s_waitcnt vmcnt(0)
    s_barrier
    s_mov_b64 exec, s[100:101]
    buffer_store_dword v78, off, s[4:7], s29 sc1
    s_mov_b64 exec, -1
cs_end:
    s_endpgm
L_xform:
    v_and_b32 v1, 63, v0
    v_and_b32 v2, 15, v1
    v_lshrrev_b32 v3, 4, v1
    v_mov_b32 v7, 0x05040100
    v_mov_b32 v8, 0x07060302
    v_lshrrev_b32 v9, 6, v0
    v_lshlrev_b32 v9, 14, v9
    v_lshlrev_b32 v10, 4, v1
    v_add_u32 v11, v9, v10
    s_mov_b32 s10, 4718592
    s_mov_b32 s11, 0x20000
    s_mov_b64 s[8:9], s[58:59]
xf_f:
    s_sub_u32 s17, s16, 1504
    s_and_b32 s18, s17, 127
    s_lshr_b32 s17, s17, 7
    s_lshl_b32 s19, s17, 4
    v_add_u32 v6, s19, v2
    v_mul_u32_u24 v4, 9216, v3
    v_lshl_add_u32 v4, v6, 4, v4
    v_lshrrev_b32 v5, 2, v2
    v_lshlrev_b32 v5, 11, v5
    v_lshl_add_u32 v5, v3, 8, v5
    v_and_b32 v1, 3, v6
    v_lshl_add_u32 v5, v1, 6, v5
    v_add_u32 v5, v5, v9
    v_cmp_gt_u32 vcc, 72, v6
    s_nop 0
    s_mov_b64 exec, vcc
    s_mul_i32 s20, s18, 36864
    s_add_u32 s21, s20, 0
    buffer_load_dwordx4 v[12:15], v4, s[8:11], s21 offen
    s_add_u32 s21, s20, 1152
    buffer_load_dwordx4 v[16:19], v4, s[8:11], s21 offen
    s_add_u32 s21, s20, 2304
    buffer_load_dwordx4 v[20:23], v4, s[8:11], s21 offen
    s_add_u32 s21, s20, 3456
    buffer_load_dwordx4 v[24:27], v4, s[8:11], s21 offen
    s_add_u32 s21, s20, 4608
    buffer_load_dwordx4 v[28:31], v4, s[8:11], s21 offen
    s_add_u32 s21, s20, 5760
    buffer_load_dwordx4 v[32:35], v4, s[8:11], s21 offen
    s_add_u32 s21, s20, 6912
    buffer_load_dwordx4 v[36:39], v4, s[8:11], s21 offen
    s_add_u32 s21, s20, 8064
    buffer_load_dwordx4 v[40:43], v4, s[8:11], s21 offen
    s_lshl_b32 s20, s18, 11
    s_add_u32 s20, s20, 130023424
    s_waitcnt vmcnt(0)
    v_perm_b32 v76, v16, v12, v7
    v_perm_b32 v77, v24, v20, v7
    v_perm_b32 v78, v32, v28, v7
    v_perm_b32 v79, v40, v36, v7
    ds_write_b128 v5, v[76:79] offset:0
    v_perm_b32 v80, v17, v13, v7
    v_perm_b32 v81, v25, v21, v7
    v_perm_b32 v82, v33, v29, v7
    v_perm_b32 v83, v41, v37, v7
    ds_write_b128 v5, v[80:83] offset:16
    v_perm_b32 v84, v18, v14, v7
    v_perm_b32 v85, v26, v22, v7
    v_perm_b32 v86, v34, v30, v7
    v_perm_b32 v87, v42, v38, v7
    ds_write_b128 v5, v[84:87] offset:32
    v_perm_b32 v88, v19, v15, v7
    v_perm_b32 v89, v27, v23, v7
    v_perm_b32 v90, v35, v31, v7
    v_perm_b32 v91, v43, v39, v7
    ds_write_b128 v5, v[88:91] offset:48
    v_perm_b32 v92, v16, v12, v8
    v_perm_b32 v93, v24, v20, v8
    v_perm_b32 v94, v32, v28, v8
    v_perm_b32 v95, v40, v36, v8
    ds_write_b128 v5, v[92:95] offset:1024
    v_perm_b32 v96, v17, v13, v8
    v_perm_b32 v97, v25, v21, v8
    v_perm_b32 v98, v33, v29, v8
    v_perm_b32 v99, v41, v37, v8
    ds_write_b128 v5, v[96:99] offset:1040
    v_perm_b32 v100, v18, v14, v8
    v_perm_b32 v101, v26, v22, v8
    v_perm_b32 v102, v34, v30, v8
    v_perm_b32 v103, v42, v38, v8
    ds_write_b128 v5, v[100:103] offset:1056
    v_perm_b32 v104, v19, v15, v8
    v_perm_b32 v105, v27, v23, v8
    v_perm_b32 v106, v35, v31, v8
    v_perm_b32 v107, v43, v39, v8
    ds_write_b128 v5, v[104:107] offset:1072
    s_mov_b64 exec, -1
    s_lshl_b32 s21, s17, 20
    s_add_u32 s20, s20, s21
    s_waitcnt lgkmcnt(0)
    ds_read_b128 v[76:79], v11 offset:0
    ds_read_b128 v[80:83], v11 offset:1024
    ds_read_b128 v[84:87], v11 offset:2048
    ds_read_b128 v[88:91], v11 offset:3072
    ds_read_b128 v[92:95], v11 offset:4096
    ds_read_b128 v[96:99], v11 offset:5120
    ds_read_b128 v[100:103], v11 offset:6144
    ds_read_b128 v[104:107], v11 offset:7168
    s_add_u32 s19, s20, 0
    s_waitcnt lgkmcnt(7)
    buffer_store_dwordx4 v[76:79], v10, s[4:7], s19 offen sc1
    s_add_u32 s19, s20, 1024
    s_waitcnt lgkmcnt(6)
    buffer_store_dwordx4 v[80:83], v10, s[4:7], s19 offen sc1
    s_add_u32 s19, s20, 262144
    s_waitcnt lgkmcnt(5)
    buffer_store_dwordx4 v[84:87], v10, s[4:7], s19 offen sc1
    s_add_u32 s19, s20, 263168
    s_waitcnt lgkmcnt(4)
    buffer_store_dwordx4 v[88:91], v10, s[4:7], s19 offen sc1
    s_add_u32 s19, s20, 524288
    s_waitcnt lgkmcnt(3)
    buffer_store_dwordx4 v[92:95], v10, s[4:7], s19 offen sc1
    s_add_u32 s19, s20, 525312
    s_waitcnt lgkmcnt(2)
    buffer_store_dwordx4 v[96:99], v10, s[4:7], s19 offen sc1
    s_add_u32 s19, s20, 786432
    s_waitcnt lgkmcnt(1)
    buffer_store_dwordx4 v[100:103], v10, s[4:7], s19 offen sc1
    s_add_u32 s19, s20, 787456
    s_waitcnt lgkmcnt(0)
    buffer_store_dwordx4 v[104:107], v10, s[4:7], s19 offen sc1
xf_done:
    s_nop 1
    s_setpc_b64 s[46:47]
L_helper:
    s_load_dwordx16 s[64:79], s[0:1], 64
    s_waitcnt lgkmcnt(0)
    s_mov_b32 s93, 1000
    s_mov_b32 s95, 0
    s_cmp_lg_u32 s3, 2
    s_cbranch_scc1 L_qkv_next
    s_mov_b32 s37, 24
    v_mov_b32 v250, 1
    v_mov_b32 v251, 163832
    v_cmp_eq_u32 vcc, 0, v0
    s_nop 0
    s_and_saveexec_b64 s[38:39], vcc
    s_cbranch_execz tk3
    buffer_atomic_add v250, off, s[84:87], s37 sc0
    s_waitcnt vmcnt(0)
    ds_write_b32 v251, v250
    s_waitcnt lgkmcnt(0)
tk3:
    s_mov_b64 exec, -1
    s_barrier
    ds_read_b32 v252, v251
    s_waitcnt lgkmcnt(0)
    v_readfirstlane_b32 s36, v252
    s_barrier
    s_nop 3
    s_cmp_ge_u32 s36, 32
    s_cbranch_scc1 L_qkv_next
    s_mov_b32 s93, 0
    s_mov_b32 s88, 4194304
gn4:
    buffer_load_dword v250, off, s[84:87], 0 offset:216 sc1
    s_waitcnt vmcnt(0)
    v_readfirstlane_b32 s95, v250
    s_sub_u32 s88, s88, 1
    s_cbranch_scc1 gn4x
    s_cmp_eq_u32 s95, 0
    s_cbranch_scc1 gn4
gn4x:
    s_cmp_eq_u32 s36, 0
    s_cbranch_scc1 L_relay
    s_branch L_wf_next
L_qkv_next:
    s_mov_b32 s37, 4
    v_mov_b32 v250, 1
    v_mov_b32 v251, 163832
    v_cmp_eq_u32 vcc, 0, v0
    s_nop 0
    s_and_saveexec_b64 s[38:39], vcc
    s_cbranch_execz tk5
    buffer_atomic_add v250, off, s[84:87], s37 sc0
    s_waitcnt vmcnt(0)
    ds_write_b32 v251, v250
    s_waitcnt lgkmcnt(0)
tk5:
    s_mov_b64 exec, -1
    s_barrier
    ds_read_b32 v252, v251
    s_waitcnt lgkmcnt(0)
    v_readfirstlane_b32 s36, v252
    s_barrier
    s_nop 3
    s_or_b32 s37, s36, s32
    s_cbranch_scc1 L_non
    s_memrealtime s[90:91]
    s_waitcnt lgkmcnt(0)
    s_lshl_b32 s90, s90, 8
    s_or_b32 s90, s90, 1
    v_mov_b32 v250, s90
    s_mov_b64 exec, 1
    buffer_store_dword v250, off, s[84:87], 0 offset:216 sc1
    s_mov_b64 exec, -1
L_non:
    s_cmp_lt_u32 s36, 192
    s_cbranch_scc1 L_qkv
    s_cmp_lg_u32 s95, 0
    s_cbranch_scc1 L_hn
    s_mov_b32 s88, 4194304
gn6:
    buffer_load_dword v250, off, s[84:87], 0 offset:216 sc1
    s_waitcnt vmcnt(0)
    v_readfirstlane_b32 s95, v250
    s_sub_u32 s88, s88, 1
    s_cbranch_scc1 gn6x
    s_cmp_eq_u32 s95, 0
    s_cbranch_scc1 gn6
gn6x:
L_hn:
    s_sub_u32 s45, s36, 192
    s_cmp_lg_u32 s36, 192
    s_cbranch_scc1 L_phase2
    s_mov_b32 s37, 24
    v_mov_b32 v250, 1
    v_mov_b32 v251, 163832
    v_cmp_eq_u32 vcc, 0, v0
    s_nop 0
    s_and_saveexec_b64 s[38:39], vcc
    s_cbranch_execz tk7
    buffer_atomic_add v250, off, s[84:87], s37 sc0
    s_waitcnt vmcnt(0)
    ds_write_b32 v251, v250
    s_waitcnt lgkmcnt(0)
tk7:
    s_mov_b64 exec, -1
    s_barrier
    ds_read_b32 v252, v251
    s_waitcnt lgkmcnt(0)
    v_readfirstlane_b32 s36, v252
    s_barrier
    s_nop 3
    s_cmp_lg_u32 s36, 0
    s_cbranch_scc1 L_phase2
L_relay:
    s_cmp_lg_u32 s32, 0
    s_cbranch_scc1 L_exit
    v_and_b32 v3, 31, v0
    v_lshlrev_b32 v3, 7, v3
    s_mov_b32 s17, 0
    s_mov_b32 s23, 125845504
    s_mov_b32 s24, 125853696
    s_mov_b32 s21, 16777216
rl_rwait:
    buffer_load_dword v4, v3, s[4:7], s23 offen sc1
    s_waitcnt vmcnt(0)
    v_subrev_u32 v4, s95, v4
    v_cmp_lt_u32 vcc, 64, v4
    s_nop 1
    v_cndmask_b32 v4, v4, 0, vcc
    s_nop 1
    v_min_u32_dpp v4, v4, v4 row_ror:1 row_mask:0xf bank_mask:0xf
    s_nop 1
    v_min_u32_dpp v4, v4, v4 row_ror:2 row_mask:0xf bank_mask:0xf
    s_nop 1
    v_min_u32_dpp v4, v4, v4 row_ror:4 row_mask:0xf bank_mask:0xf
    s_nop 1
    v_min_u32_dpp v4, v4, v4 row_ror:8 row_mask:0xf bank_mask:0xf
    s_nop 0
    v_readlane_b32 s16, v4, 0
    v_readlane_b32 s22, v4, 16
    s_nop 0
    s_min_u32 s16, s16, s22
    s_sub_u32 s21, s21, 1
    s_cbranch_scc1 rl_x
    s_cmp_gt_u32 s16, s17
    s_cbranch_scc1 rl_rpub
    s_sleep 2
    s_branch rl_rwait
rl_rpub:
    s_mov_b32 s17, s16
    s_add_u32 s22, s16, s95
    v_mov_b32 v4, s22
    s_mov_b64 exec, 1
    buffer_store_dword v4, off, s[4:7], s24 sc1
    s_mov_b64 exec, -1
    s_cmp_lt_u32 s16, 64
    s_cbranch_scc1 rl_rwait
rl_x:
    s_endpgm
L_qkv:
    s_sub_u32 s33, s36, 32
    s_and_b32 s17, s36, 15
    s_lshl_b32 s17, s17, 1
    s_lshr_b32 s36, s36, 4
    s_and_b32 s16, s36, 1
    s_add_u32 s16, s16, 1
    s_lshr_b32 s19, s36, 1
    s_and_b32 s37, s36, 3
    s_cmp_ge_u32 s36, 8
    s_cselect_b32 s16, 0, s16
    s_cselect_b32 s19, s37, s19
    v_lshrrev_b32 v4, 6, v0
    s_nop 0
    v_readfirstlane_b32 s18, v4
    v_lshlrev_b32 v7, 4, v0
    s_cmp_eq_u32 s16, 1
    s_cselect_b64 s[12:13], s[54:55], s[52:53]
    s_cmp_eq_u32 s16, 2
    s_cselect_b64 s[12:13], s[56:57], s[12:13]
    s_mov_b32 s14, 4718592
    s_mov_b32 s15, 0x20000
    v_bfe_u32 v4, v0, 5, 1
    v_lshlrev_b32 v5, 2, v4
    v_and_b32 v8, 31, v0
    v_xor_b32 v8, v8, v5
    v_lshlrev_b32 v8, 4, v8
    v_lshl_add_u32 v8, v4, 13, v8
    v_xor_b32 v9, 128, v8
    s_lshl_b32 s21, s17, 8
    s_lshl_b32 s42, s18, 16
    s_add_u32 s42, s42, s21
    s_lshl_b32 s44, s18, 12
    s_barrier
    s_add_u32 m0, s44, 73728
    s_add_u32 s22, s42, 0
    buffer_load_dwordx4 v8, s[12:15], s22 offen offset:0 lds
    s_add_u32 s22, s42, 15360
    buffer_load_dwordx4 v9, s[12:15], s22 offen offset:1024 lds
    s_add_u32 s22, s42, 30720
    buffer_load_dwordx4 v8, s[12:15], s22 offen offset:2048 lds
    s_add_u32 s22, s42, 46080
    buffer_load_dwordx4 v9, s[12:15], s22 offen offset:3072 lds
    s_add_u32 m0, s44, 90112
    s_add_u32 s22, s42, 262144
    buffer_load_dwordx4 v8, s[12:15], s22 offen offset:0 lds
    s_add_u32 s22, s42, 277504
    buffer_load_dwordx4 v9, s[12:15], s22 offen offset:1024 lds
    s_add_u32 s22, s42, 292864
    buffer_load_dwordx4 v8, s[12:15], s22 offen offset:2048 lds
    s_add_u32 s22, s42, 308224
    buffer_load_dwordx4 v9, s[12:15], s22 offen offset:3072 lds
    s_add_u32 m0, s44, 106496
    s_add_u32 s22, s42, 524288
    buffer_load_dwordx4 v8, s[12:15], s22 offen offset:0 lds
    s_add_u32 s22, s42, 539648
    buffer_load_dwordx4 v9, s[12:15], s22 offen offset:1024 lds
    s_add_u32 s22, s42, 555008
    buffer_load_dwordx4 v8, s[12:15], s22 offen offset:2048 lds
    s_add_u32 s22, s42, 570368
    buffer_load_dwordx4 v9, s[12:15], s22 offen offset:3072 lds
    s_add_u32 m0, s44, 122880
    s_add_u32 s22, s42, 786432
    buffer_load_dwordx4 v8, s[12:15], s22 offen offset:0 lds
    s_add_u32 s22, s42, 801792
    buffer_load_dwordx4 v9, s[12:15], s22 offen offset:1024 lds
    s_add_u32 s22, s42, 817152
    buffer_load_dwordx4 v8, s[12:15], s22 offen offset:2048 lds
    s_add_u32 s22, s42, 832512
    buffer_load_dwordx4 v9, s[12:15], s22 offen offset:3072 lds
    v_bfe_u32 v4, v0, 2, 2
    v_xor_b32 v5, s18, v4
    v_lshlrev_b32 v10, 6, v5
    v_lshl_add_u32 v10, v4, 9, v10
    v_and_b32 v4, 3, v0
    v_lshl_add_u32 v10, v4, 4, v10
    v_bfe_u32 v4, v0, 4, 2
    v_lshl_add_u32 v10, v4, 12, v10
    v_add_u32 v10, 73728, v10
    v_add_u32 v11, 49152, v10
    v_and_b32 v4, 63, v0
    v_and_b32 v5, 15, v4
    v_lshrrev_b32 v3, 4, v4
    v_lshrrev_b32 v2, 2, v5
    v_xor_b32 v3, v3, v2
    v_lshl_add_u32 v3, v5, 2, v3
    v_lshlrev_b32 v1, 4, v3
    v_lshrrev_b32 v5, 2, v4
    v_lshrrev_b32 v3, 4, v4
    v_and_b32 v4, 3, v4
    v_xor_b32 v4, v4, v3
    v_lshlrev_b32 v3, 3, v3
    v_and_b32 v5, 3, v5
    v_add_u32 v3, v3, v5
    v_mul_u32_u24 v2, 1152, v3
    v_lshl_add_u32 v2, v4, 4, v2
    s_mov_b32 s8, s48
    s_mov_b32 s9, s49
    s_mov_b32 s10, 2359296
    s_mov_b32 s11, 0x20000
    s_lshr_b32 s22, s18, 1
    s_mul_i32 s24, s22, 4608
    s_mul_i32 s25, s22, 18432
    s_and_b32 s22, s18, 1
    s_mul_i32 s23, s22, 576
    s_add_u32 s24, s24, s23
    s_mul_i32 s25, s18, 9216
    s_mul_i32 s22, s19, 36864
    s_add_u32 s24, s24, s22
    s_mov_b32 s20, 64
    s_lshl_b32 s22, s19, 5
    s_add_u32 s22, s22, s17
    s_lshl_b32 s26, s22, 14
    s_mul_i32 s23, s18, 3072
    s_add_u32 s26, s26, s23
    s_lshl_b32 s23, s16, 11
    s_add_u32 s26, s26, s23
    s_add_u32 s26, s26, -2048
    s_lshl_b32 s22, s22, 13
    s_add_u32 s22, s22, 33554432
    s_cmp_eq_u32 s16, 0
    s_cselect_b32 s26, s22, s26
    s_cselect_b32 s40, 4096, 64
    s_cselect_b32 s41, 1, 2
    s_max_u32 s40, s40, 1024
    s_lshl_b32 s41, s41, 18
    s_lshl_b32 s29, s17, 7
    s_lshl_b32 s22, s16, 4
    s_add_u32 s29, s29, s22
    s_lshl_b32 s22, s19, 2
    s_add_u32 s29, s29, s22
    s_add_u32 s29, s29, 125829120
    s_mov_b32 s27, 0
    s_add_u32 s23, s27, s25
    s_add_u32 m0, s23, 0
    s_nop 0
    buffer_load_dwordx4 v2, s[8:11], s24 offen offset:0 lds
    s_add_u32 m0, s23, 960
    s_nop 0
    buffer_load_dwordx4 v2, s[8:11], s24 offen offset:64 lds
    s_add_u32 m0, s23, 1920
    s_nop 0
    buffer_load_dwordx4 v2, s[8:11], s24 offen offset:128 lds
    s_add_u32 m0, s23, 2880
    s_nop 0
    buffer_load_dwordx4 v2, s[8:11], s24 offen offset:192 lds
    s_add_u32 m0, s23, 3840
    s_nop 0
    buffer_load_dwordx4 v2, s[8:11], s24 offen offset:256 lds
    s_add_u32 m0, s23, 4800
    s_nop 0
    buffer_load_dwordx4 v2, s[8:11], s24 offen offset:320 lds
    s_add_u32 m0, s23, 5760
    s_nop 0
    buffer_load_dwordx4 v2, s[8:11], s24 offen offset:384 lds
    s_add_u32 m0, s23, 6720
    s_nop 0
    buffer_load_dwordx4 v2, s[8:11], s24 offen offset:448 lds
    s_add_u32 m0, s23, 7680
    s_nop 0
    buffer_load_dwordx4 v2, s[8:11], s24 offen offset:512 lds
    s_add_u32 s24, s24, 147456
    s_waitcnt vmcnt(21) lgkmcnt(0)
    s_barrier
    s_add_u32 m0, s44, 139264
    s_add_u32 s22, s42, 1048576
    buffer_load_dwordx4 v8, s[12:15], s22 offen offset:0 lds
    s_add_u32 s22, s42, 1063936
    buffer_load_dwordx4 v9, s[12:15], s22 offen offset:1024 lds
    s_add_u32 s22, s42, 1079296
    buffer_load_dwordx4 v8, s[12:15], s22 offen offset:2048 lds
    s_add_u32 s22, s42, 1094656
    buffer_load_dwordx4 v9, s[12:15], s22 offen offset:3072 lds
    ds_read_b64_tr_b16 v[64:65], v10 offset:0
    ds_read_b64_tr_b16 v[66:67], v10 offset:2048
    ds_read_b64_tr_b16 v[136:137], v10 offset:8
    ds_read_b64_tr_b16 v[138:139], v10 offset:2056
    ds_read_b64_tr_b16 a[0:1], v10 offset:256
    ds_read_b64_tr_b16 a[2:3], v10 offset:2304
    ds_read_b64_tr_b16 a[72:73], v10 offset:264
    ds_read_b64_tr_b16 a[74:75], v10 offset:2312
    s_waitcnt vmcnt(21) lgkmcnt(0)
    s_barrier
    s_add_u32 m0, s44, 73728
    s_add_u32 s22, s42, 1310720
    buffer_load_dwordx4 v8, s[12:15], s22 offen offset:0 lds
    s_add_u32 s22, s42, 1326080
    buffer_load_dwordx4 v9, s[12:15], s22 offen offset:1024 lds
    s_add_u32 s22, s42, 1341440
    buffer_load_dwordx4 v8, s[12:15], s22 offen offset:2048 lds
    s_add_u32 s22, s42, 1356800
    buffer_load_dwordx4 v9, s[12:15], s22 offen offset:3072 lds
    ds_read_b64_tr_b16 v[68:69], v10 offset:16384
    ds_read_b64_tr_b16 v[70:71], v10 offset:18432
    ds_read_b64_tr_b16 v[140:141], v10 offset:16392
    ds_read_b64_tr_b16 v[142:143], v10 offset:18440
    ds_read_b64_tr_b16 a[4:5], v10 offset:16640
    ds_read_b64_tr_b16 a[6:7], v10 offset:18688
    ds_read_b64_tr_b16 a[76:77], v10 offset:16648
    ds_read_b64_tr_b16 a[78:79], v10 offset:18696
    s_waitcnt vmcnt(21) lgkmcnt(0)
    s_barrier
    s_add_u32 m0, s44, 90112
    s_add_u32 s22, s42, 1572864
    buffer_load_dwordx4 v8, s[12:15], s22 offen offset:0 lds
    s_add_u32 s22, s42, 1588224
    buffer_load_dwordx4 v9, s[12:15], s22 offen offset:1024 lds
    s_add_u32 s22, s42, 1603584
    buffer_load_dwordx4 v8, s[12:15], s22 offen offset:2048 lds
    s_add_u32 s22, s42, 1618944
    buffer_load_dwordx4 v9, s[12:15], s22 offen offset:3072 lds
    ds_read_b64_tr_b16 v[72:73], v10 offset:32768
    ds_read_b64_tr_b16 v[74:75], v10 offset:34816
    ds_read_b64_tr_b16 v[144:145], v10 offset:32776
    ds_read_b64_tr_b16 v[146:147], v10 offset:34824
    ds_read_b64_tr_b16 a[8:9], v10 offset:33024
    ds_read_b64_tr_b16 a[10:11], v10 offset:35072
    ds_read_b64_tr_b16 a[80:81], v10 offset:33032
    ds_read_b64_tr_b16 a[82:83], v10 offset:35080
    s_waitcnt vmcnt(21) lgkmcnt(0)
    s_barrier
    s_add_u32 m0, s44, 106496
    s_add_u32 s22, s42, 1835008
    buffer_load_dwordx4 v8, s[12:15], s22 offen offset:0 lds
    s_add_u32 s22, s42, 1850368
    buffer_load_dwordx4 v9, s[12:15], s22 offen offset:1024 lds
    s_add_u32 s22, s42, 1865728
    buffer_load_dwordx4 v8, s[12:15], s22 offen offset:2048 lds
    s_add_u32 s22, s42, 1881088
    buffer_load_dwordx4 v9, s[12:15], s22 offen offset:3072 lds
    ds_read_b64_tr_b16 v[76:77], v11 offset:0
    ds_read_b64_tr_b16 v[78:79], v11 offset:2048
    ds_read_b64_tr_b16 v[148:149], v11 offset:8
    ds_read_b64_tr_b16 v[150:151], v11 offset:2056
    ds_read_b64_tr_b16 a[12:13], v11 offset:256
    ds_read_b64_tr_b16 a[14:15], v11 offset:2304
    ds_read_b64_tr_b16 a[84:85], v11 offset:264
    ds_read_b64_tr_b16 a[86:87], v11 offset:2312
    s_waitcnt vmcnt(12) lgkmcnt(0)
    s_barrier
    s_add_u32 m0, s44, 122880
    s_add_u32 s22, s42, 2097152
    buffer_load_dwordx4 v8, s[12:15], s22 offen offset:0 lds
    s_add_u32 s22, s42, 2112512
    buffer_load_dwordx4 v9, s[12:15], s22 offen offset:1024 lds
    s_add_u32 s22, s42, 2127872
    buffer_load_dwordx4 v8, s[12:15], s22 offen offset:2048 lds
    s_add_u32 s22, s42, 2143232
    buffer_load_dwordx4 v9, s[12:15], s22 offen offset:3072 lds
    ds_read_b64_tr_b16 v[80:81], v11 offset:16384
    ds_read_b64_tr_b16 v[82:83], v11 offset:18432
    ds_read_b64_tr_b16 v[152:153], v11 offset:16392
    ds_read_b64_tr_b16 v[154:155], v11 offset:18440
    ds_read_b64_tr_b16 a[16:17], v11 offset:16640
    ds_read_b64_tr_b16 a[18:19], v11 offset:18688
    ds_read_b64_tr_b16 a[88:89], v11 offset:16648
    ds_read_b64_tr_b16 a[90:91], v11 offset:18696
    s_waitcnt vmcnt(12) lgkmcnt(0)
    s_barrier
    s_add_u32 m0, s44, 139264
    s_add_u32 s22, s42, 2359296
    buffer_load_dwordx4 v8, s[12:15], s22 offen offset:0 lds
    s_add_u32 s22, s42, 2374656
    buffer_load_dwordx4 v9, s[12:15], s22 offen offset:1024 lds
    s_add_u32 s22, s42, 2390016
    buffer_load_dwordx4 v8, s[12:15], s22 offen offset:2048 lds
    s_add_u32 s22, s42, 2405376
    buffer_load_dwordx4 v9, s[12:15], s22 offen offset:3072 lds
    ds_read_b64_tr_b16 v[84:85], v10 offset:0
    ds_read_b64_tr_b16 v[86:87], v10 offset:2048
    ds_read_b64_tr_b16 v[156:157], v10 offset:8
    ds_read_b64_tr_b16 v[158:159], v10 offset:2056
    ds_read_b64_tr_b16 a[20:21], v10 offset:256
    ds_read_b64_tr_b16 a[22:23], v10 offset:2304
    ds_read_b64_tr_b16 a[92:93], v10 offset:264
    ds_read_b64_tr_b16 a[94:95], v10 offset:2312
    s_waitcnt vmcnt(12) lgkmcnt(0)
    s_barrier
    s_add_u32 m0, s44, 73728
    s_add_u32 s22, s42, 2621440
    buffer_load_dwordx4 v8, s[12:15], s22 offen offset:0 lds
    s_add_u32 s22, s42, 2636800
    buffer_load_dwordx4 v9, s[12:15], s22 offen offset:1024 lds
    s_add_u32 s22, s42, 2652160
    buffer_load_dwordx4 v8, s[12:15], s22 offen offset:2048 lds
    s_add_u32 s22, s42, 2667520
    buffer_load_dwordx4 v9, s[12:15], s22 offen offset:3072 lds
    ds_read_b64_tr_b16 v[88:89], v10 offset:16384
    ds_read_b64_tr_b16 v[90:91], v10 offset:18432
    ds_read_b64_tr_b16 v[160:161], v10 offset:16392
    ds_read_b64_tr_b16 v[162:163], v10 offset:18440
    ds_read_b64_tr_b16 a[24:25], v10 offset:16640
    ds_read_b64_tr_b16 a[26:27], v10 offset:18688
    ds_read_b64_tr_b16 a[96:97], v10 offset:16648
    ds_read_b64_tr_b16 a[98:99], v10 offset:18696
    s_waitcnt vmcnt(12) lgkmcnt(0)
    s_barrier
    s_add_u32 m0, s44, 90112
    s_add_u32 s22, s42, 2883584
    buffer_load_dwordx4 v8, s[12:15], s22 offen offset:0 lds
    s_add_u32 s22, s42, 2898944
    buffer_load_dwordx4 v9, s[12:15], s22 offen offset:1024 lds
    s_add_u32 s22, s42, 2914304
    buffer_load_dwordx4 v8, s[12:15], s22 offen offset:2048 lds
    s_add_u32 s22, s42, 2929664
    buffer_load_dwordx4 v9, s[12:15], s22 offen offset:3072 lds
    ds_read_b64_tr_b16 v[92:93], v10 offset:32768
    ds_read_b64_tr_b16 v[94:95], v10 offset:34816
    ds_read_b64_tr_b16 v[164:165], v10 offset:32776
    ds_read_b64_tr_b16 v[166:167], v10 offset:34824
    ds_read_b64_tr_b16 a[28:29], v10 offset:33024
    ds_read_b64_tr_b16 a[30:31], v10 offset:35072
    ds_read_b64_tr_b16 a[100:101], v10 offset:33032
    ds_read_b64_tr_b16 a[102:103], v10 offset:35080
    s_waitcnt vmcnt(12) lgkmcnt(0)
    s_barrier
    s_add_u32 m0, s44, 106496
    s_add_u32 s22, s42, 3145728
    buffer_load_dwordx4 v8, s[12:15], s22 offen offset:0 lds
    s_add_u32 s22, s42, 3161088
    buffer_load_dwordx4 v9, s[12:15], s22 offen offset:1024 lds
    s_add_u32 s22, s42, 3176448
    buffer_load_dwordx4 v8, s[12:15], s22 offen offset:2048 lds
    s_add_u32 s22, s42, 3191808
    buffer_load_dwordx4 v9, s[12:15], s22 offen offset:3072 lds
    ds_read_b64_tr_b16 v[96:97], v11 offset:0
    ds_read_b64_tr_b16 v[98:99], v11 offset:2048
    ds_read_b64_tr_b16 v[168:169], v11 offset:8
    ds_read_b64_tr_b16 v[170:171], v11 offset:2056
    ds_read_b64_tr_b16 a[32:33], v11 offset:256
    ds_read_b64_tr_b16 a[34:35], v11 offset:2304
    ds_read_b64_tr_b16 a[104:105], v11 offset:264
    ds_read_b64_tr_b16 a[106:107], v11 offset:2312
    s_waitcnt vmcnt(12) lgkmcnt(0)
    s_barrier
    s_add_u32 m0, s44, 122880
    s_add_u32 s22, s42, 3407872
    buffer_load_dwordx4 v8, s[12:15], s22 offen offset:0 lds
    s_add_u32 s22, s42, 3423232
    buffer_load_dwordx4 v9, s[12:15], s22 offen offset:1024 lds
    s_add_u32 s22, s42, 3438592
    buffer_load_dwordx4 v8, s[12:15], s22 offen offset:2048 lds
    s_add_u32 s22, s42, 3453952
    buffer_load_dwordx4 v9, s[12:15], s22 offen offset:3072 lds
    ds_read_b64_tr_b16 v[100:101], v11 offset:16384
    ds_read_b64_tr_b16 v[102:103], v11 offset:18432
    ds_read_b64_tr_b16 v[172:173], v11 offset:16392
    ds_read_b64_tr_b16 v[174:175], v11 offset:18440
    ds_read_b64_tr_b16 a[36:37], v11 offset:16640
    ds_read_b64_tr_b16 a[38:39], v11 offset:18688
    ds_read_b64_tr_b16 a[108:109], v11 offset:16648
    ds_read_b64_tr_b16 a[110:111], v11 offset:18696
    s_waitcnt vmcnt(12) lgkmcnt(0)
    s_barrier
    s_add_u32 m0, s44, 139264
    s_add_u32 s22, s42, 3670016
    buffer_load_dwordx4 v8, s[12:15], s22 offen offset:0 lds
    s_add_u32 s22, s42, 3685376
    buffer_load_dwordx4 v9, s[12:15], s22 offen offset:1024 lds
    s_add_u32 s22, s42, 3700736
    buffer_load_dwordx4 v8, s[12:15], s22 offen offset:2048 lds
    s_add_u32 s22, s42, 3716096
    buffer_load_dwordx4 v9, s[12:15], s22 offen offset:3072 lds
    ds_read_b64_tr_b16 v[104:105], v10 offset:0
    ds_read_b64_tr_b16 v[106:107], v10 offset:2048
    ds_read_b64_tr_b16 v[176:177], v10 offset:8
    ds_read_b64_tr_b16 v[178:179], v10 offset:2056
    ds_read_b64_tr_b16 a[40:41], v10 offset:256
    ds_read_b64_tr_b16 a[42:43], v10 offset:2304
    ds_read_b64_tr_b16 a[112:113], v10 offset:264
    ds_read_b64_tr_b16 a[114:115], v10 offset:2312
    s_waitcnt vmcnt(12) lgkmcnt(0)
    s_barrier
    s_add_u32 m0, s44, 73728
    s_add_u32 s22, s42, 3932160
    buffer_load_dwordx4 v8, s[12:15], s22 offen offset:0 lds
    s_add_u32 s22, s42, 3947520
    buffer_load_dwordx4 v9, s[12:15], s22 offen offset:1024 lds
    s_add_u32 s22, s42, 3962880
    buffer_load_dwordx4 v8, s[12:15], s22 offen offset:2048 lds
    s_add_u32 s22, s42, 3978240
    buffer_load_dwordx4 v9, s[12:15], s22 offen offset:3072 lds
    ds_read_b64_tr_b16 v[108:109], v10 offset:16384
    ds_read_b64_tr_b16 v[110:111], v10 offset:18432
    ds_read_b64_tr_b16 v[180:181], v10 offset:16392
    ds_read_b64_tr_b16 v[182:183], v10 offset:18440
    ds_read_b64_tr_b16 a[44:45], v10 offset:16640
    ds_read_b64_tr_b16 a[46:47], v10 offset:18688
    ds_read_b64_tr_b16 a[116:117], v10 offset:16648
    ds_read_b64_tr_b16 a[118:119], v10 offset:18696
    s_waitcnt vmcnt(12) lgkmcnt(0)
    s_barrier
    s_add_u32 m0, s44, 90112
    s_add_u32 s22, s42, 4194304
    buffer_load_dwordx4 v8, s[12:15], s22 offen offset:0 lds
    s_add_u32 s22, s42, 4209664
    buffer_load_dwordx4 v9, s[12:15], s22 offen offset:1024 lds
    s_add_u32 s22, s42, 4225024
    buffer_load_dwordx4 v8, s[12:15], s22 offen offset:2048 lds
    s_add_u32 s22, s42, 4240384
    buffer_load_dwordx4 v9, s[12:15], s22 offen offset:3072 lds
    ds_read_b64_tr_b16 v[112:113], v10 offset:32768
    ds_read_b64_tr_b16 v[114:115], v10 offset:34816
    ds_read_b64_tr_b16 v[184:185], v10 offset:32776
    ds_read_b64_tr_b16 v[186:187], v10 offset:34824
    ds_read_b64_tr_b16 a[48:49], v10 offset:33024
    ds_read_b64_tr_b16 a[50:51], v10 offset:35072
    ds_read_b64_tr_b16 a[120:121], v10 offset:33032
    ds_read_b64_tr_b16 a[122:123], v10 offset:35080
    s_waitcnt vmcnt(12) lgkmcnt(0)
    s_barrier
    s_add_u32 m0, s44, 106496
    s_add_u32 s22, s42, 4456448
    buffer_load_dwordx4 v8, s[12:15], s22 offen offset:0 lds
    s_add_u32 s22, s42, 4471808
    buffer_load_dwordx4 v9, s[12:15], s22 offen offset:1024 lds
    s_add_u32 s22, s42, 4487168
    buffer_load_dwordx4 v8, s[12:15], s22 offen offset:2048 lds
    s_add_u32 s22, s42, 4502528
    buffer_load_dwordx4 v9, s[12:15], s22 offen offset:3072 lds
    ds_read_b64_tr_b16 v[116:117], v11 offset:0
    ds_read_b64_tr_b16 v[118:119], v11 offset:2048
    ds_read_b64_tr_b16 v[188:189], v11 offset:8
    ds_read_b64_tr_b16 v[190:191], v11 offset:2056
    ds_read_b64_tr_b16 a[52:53], v11 offset:256
    ds_read_b64_tr_b16 a[54:55], v11 offset:2304
    ds_read_b64_tr_b16 a[124:125], v11 offset:264
    ds_read_b64_tr_b16 a[126:127], v11 offset:2312
    s_waitcnt vmcnt(12) lgkmcnt(0)
    s_barrier
    s_mov_b32 s27, 36864
    s_add_u32 s23, s27, s25
    s_add_u32 m0, s23, 0
    s_nop 0
    buffer_load_dwordx4 v2, s[8:11], s24 offen offset:0 lds
    s_add_u32 m0, s23, 960
    s_nop 0
    buffer_load_dwordx4 v2, s[8:11], s24 offen offset:64 lds
    s_add_u32 m0, s23, 1920
    s_nop 0
    buffer_load_dwordx4 v2, s[8:11], s24 offen offset:128 lds
    s_add_u32 m0, s23, 2880
    s_nop 0
    buffer_load_dwordx4 v2, s[8:11], s24 offen offset:192 lds
    s_add_u32 m0, s23, 3840
    s_nop 0
    buffer_load_dwordx4 v2, s[8:11], s24 offen offset:256 lds
    s_add_u32 m0, s23, 4800
    s_nop 0
    buffer_load_dwordx4 v2, s[8:11], s24 offen offset:320 lds
    s_add_u32 m0, s23, 5760
    s_nop 0
    buffer_load_dwordx4 v2, s[8:11], s24 offen offset:384 lds
    s_add_u32 m0, s23, 6720
    s_nop 0
    buffer_load_dwordx4 v2, s[8:11], s24 offen offset:448 lds
    s_add_u32 m0, s23, 7680
    s_nop 0
    buffer_load_dwordx4 v2, s[8:11], s24 offen offset:512 lds
    s_add_u32 s24, s24, 147456
    ds_read_b64_tr_b16 v[120:121], v11 offset:16384
    ds_read_b64_tr_b16 v[122:123], v11 offset:18432
    ds_read_b64_tr_b16 v[192:193], v11 offset:16392
    ds_read_b64_tr_b16 v[194:195], v11 offset:18440
    ds_read_b64_tr_b16 a[56:57], v11 offset:16640
    ds_read_b64_tr_b16 a[58:59], v11 offset:18688
    ds_read_b64_tr_b16 a[128:129], v11 offset:16648
    ds_read_b64_tr_b16 a[130:131], v11 offset:18696
    s_waitcnt vmcnt(17) lgkmcnt(0)
    s_barrier
    ds_read_b64_tr_b16 v[124:125], v10 offset:0
    ds_read_b64_tr_b16 v[126:127], v10 offset:2048
    ds_read_b64_tr_b16 v[196:197], v10 offset:8
    ds_read_b64_tr_b16 v[198:199], v10 offset:2056
    ds_read_b64_tr_b16 a[60:61], v10 offset:256
    ds_read_b64_tr_b16 a[62:63], v10 offset:2304
    ds_read_b64_tr_b16 a[132:133], v10 offset:264
    ds_read_b64_tr_b16 a[134:135], v10 offset:2312
    s_waitcnt vmcnt(13) lgkmcnt(0)
    s_barrier
    ds_read_b64_tr_b16 v[128:129], v10 offset:16384
    ds_read_b64_tr_b16 v[130:131], v10 offset:18432
    ds_read_b64_tr_b16 v[200:201], v10 offset:16392
    ds_read_b64_tr_b16 v[202:203], v10 offset:18440
    ds_read_b64_tr_b16 a[64:65], v10 offset:16640
    ds_read_b64_tr_b16 a[66:67], v10 offset:18688
    ds_read_b64_tr_b16 a[136:137], v10 offset:16648
    ds_read_b64_tr_b16 a[138:139], v10 offset:18696
    s_waitcnt vmcnt(9) lgkmcnt(0)
    s_barrier
    ds_read_b64_tr_b16 v[132:133], v10 offset:32768
    ds_read_b64_tr_b16 v[134:135], v10 offset:34816
    ds_read_b64_tr_b16 v[204:205], v10 offset:32776
    ds_read_b64_tr_b16 v[206:207], v10 offset:34824
    ds_read_b64_tr_b16 a[68:69], v10 offset:33024
    ds_read_b64_tr_b16 a[70:71], v10 offset:35072
    ds_read_b64_tr_b16 a[140:141], v10 offset:33032
    ds_read_b64_tr_b16 a[142:143], v10 offset:35080
    s_mov_b32 s88, 4194304
gn8:
    buffer_load_dword v250, off, s[84:87], 0 offset:216 sc1
    s_waitcnt vmcnt(0)
    v_readfirstlane_b32 s95, v250
    s_sub_u32 s88, s88, 1
    s_cbranch_scc1 gn8x
    s_cmp_eq_u32 s95, 0
    s_cbranch_scc1 gn8
gn8x:
    s_waitcnt lgkmcnt(0)
    s_mov_b32 s45, 0
    s_mov_b32 s27, 0
    s_mov_b64 s[36:37], 0
    s_mov_b32 s12, 0
    s_mov_b32 s13, s40
    s_lshr_b32 s14, s41, 5
    s_add_u32 s15, s14, s40
    s_lshl_b32 s41, s41, 2
    s_sub_u32 s26, s26, s41
    v_mov_b32 v3, v1
    s_waitcnt vmcnt(0)
    s_barrier
    ds_read_b128 v[32:35], v3 offset:0
    ds_read_b128 v[36:39], v3 offset:18432
    ds_read_b128 v[40:43], v3 offset:1024
    ds_read_b128 v[44:47], v3 offset:19456
    s_cmp_eq_u32 s18, 0
    s_cselect_b32 s34, 1, 0
    s_mov_b32 s35, 0
    s_cmp_eq_u32 s16, 2
    s_cbranch_scc1 qk_vloop
qk_loop:
    s_barrier
    s_add_u32 s22, s27, 73728
    s_sub_u32 s21, s22, 110592
    s_cselect_b32 s22, s22, s21
    s_waitcnt lgkmcnt(2)
    v_mfma_f32_16x16x32_bf16 v[208:211], v[64:67], v[32:35], 0
    ds_read_b128 v[48:51], v3 offset:2048
    v_mfma_f32_16x16x32_bf16 v[212:215], v[136:139], v[32:35], 0
    ds_read_b128 v[52:55], v3 offset:20480
    v_mfma_f32_16x16x32_bf16 v[216:219], v[64:67], v[36:39], 0
    v_mfma_f32_16x16x32_bf16 v[220:223], v[136:139], v[36:39], 0
    v_mfma_f32_16x16x32_bf16 v[224:227], a[0:3], v[32:35], 0
    v_mfma_f32_16x16x32_bf16 v[228:231], a[72:75], v[32:35], 0
    v_mfma_f32_16x16x32_bf16 v[232:235], a[0:3], v[36:39], 0
    v_mfma_f32_16x16x32_bf16 v[236:239], a[72:75], v[36:39], 0
    s_waitcnt lgkmcnt(2)
    v_mfma_f32_16x16x32_bf16 v[208:211], v[68:71], v[40:43], v[208:211]
    ds_read_b128 v[32:35], v3 offset:3072
    v_mfma_f32_16x16x32_bf16 v[212:215], v[140:143], v[40:43], v[212:215]
    ds_read_b128 v[36:39], v3 offset:21504
    v_mfma_f32_16x16x32_bf16 v[216:219], v[68:71], v[44:47], v[216:219]
    s_add_u32 s23, s22, s25
    s_add_u32 m0, s23, 0
    s_nop 0
    buffer_load_dwordx4 v2, s[8:11], s24 offen offset:0 lds
    v_mfma_f32_16x16x32_bf16 v[220:223], v[140:143], v[44:47], v[220:223]
    v_mfma_f32_16x16x32_bf16 v[224:227], a[4:7], v[40:43], v[224:227]
    v_mfma_f32_16x16x32_bf16 v[228:231], a[76:79], v[40:43], v[228:231]
    v_mfma_f32_16x16x32_bf16 v[232:235], a[4:7], v[44:47], v[232:235]
    s_add_u32 m0, s23, 960
    s_nop 0
    buffer_load_dwordx4 v2, s[8:11], s24 offen offset:64 lds
    v_mfma_f32_16x16x32_bf16 v[236:239], a[76:79], v[44:47], v[236:239]
    s_waitcnt lgkmcnt(2)
    v_mfma_f32_16x16x32_bf16 v[208:211], v[72:75], v[48:51], v[208:211]
    ds_read_b128 v[40:43], v3 offset:4096
    v_mfma_f32_16x16x32_bf16 v[212:215], v[144:147], v[48:51], v[212:215]
    ds_read_b128 v[44:47], v3 offset:22528
    v_mfma_f32_16x16x32_bf16 v[216:219], v[72:75], v[52:55], v[216:219]
    s_add_u32 m0, s23, 1920
    s_nop 0
    buffer_load_dwordx4 v2, s[8:11], s24 offen offset:128 lds
    v_mfma_f32_16x16x32_bf16 v[220:223], v[144:147], v[52:55], v[220:223]
    v_mfma_f32_16x16x32_bf16 v[224:227], a[8:11], v[48:51], v[224:227]
    v_mfma_f32_16x16x32_bf16 v[228:231], a[80:83], v[48:51], v[228:231]
    v_mfma_f32_16x16x32_bf16 v[232:235], a[8:11], v[52:55], v[232:235]
    s_add_u32 m0, s23, 2880
    s_nop 0
    buffer_load_dwordx4 v2, s[8:11], s24 offen offset:192 lds
    v_mfma_f32_16x16x32_bf16 v[236:239], a[80:83], v[52:55], v[236:239]
    s_waitcnt lgkmcnt(2)
    v_mfma_f32_16x16x32_bf16 v[208:211], v[76:79], v[32:35], v[208:211]
    ds_read_b128 v[48:51], v3 offset:5120
    v_mfma_f32_16x16x32_bf16 v[212:215], v[148:151], v[32:35], v[212:215]
    ds_read_b128 v[52:55], v3 offset:23552
    v_mfma_f32_16x16x32_bf16 v[216:219], v[76:79], v[36:39], v[216:219]
    s_add_u32 m0, s23, 3840
    s_nop 0
    buffer_load_dwordx4 v2, s[8:11], s24 offen offset:256 lds
    v_mfma_f32_16x16x32_bf16 v[220:223], v[148:151], v[36:39], v[220:223]
    v_mfma_f32_16x16x32_bf16 v[224:227], a[12:15], v[32:35], v[224:227]
    v_mfma_f32_16x16x32_bf16 v[228:231], a[84:87], v[32:35], v[228:231]
    v_mfma_f32_16x16x32_bf16 v[232:235], a[12:15], v[36:39], v[232:235]
    s_add_u32 m0, s23, 4800
    s_nop 0
    buffer_load_dwordx4 v2, s[8:11], s24 offen offset:320 lds
    v_mfma_f32_16x16x32_bf16 v[236:239], a[84:87], v[36:39], v[236:239]
    s_waitcnt lgkmcnt(2)
    v_mfma_f32_16x16x32_bf16 v[208:211], v[80:83], v[40:43], v[208:211]
    ds_read_b128 v[32:35], v3 offset:6144
    v_mfma_f32_16x16x32_bf16 v[212:215], v[152:155], v[40:43], v[212:215]
    ds_read_b128 v[36:39], v3 offset:24576
    v_mfma_f32_16x16x32_bf16 v[216:219], v[80:83], v[44:47], v[216:219]
    s_add_u32 m0, s23, 5760
    s_nop 0
    buffer_load_dwordx4 v2, s[8:11], s24 offen offset:384 lds
    v_mfma_f32_16x16x32_bf16 v[220:223], v[152:155], v[44:47], v[220:223]
    v_mfma_f32_16x16x32_bf16 v[224:227], a[16:19], v[40:43], v[224:227]
    v_mfma_f32_16x16x32_bf16 v[228:231], a[88:91], v[40:43], v[228:231]
    v_mfma_f32_16x16x32_bf16 v[232:235], a[16:19], v[44:47], v[232:235]
    s_add_u32 m0, s23, 6720
    s_nop 0
    buffer_load_dwordx4 v2, s[8:11], s24 offen offset:448 lds
    v_mfma_f32_16x16x32_bf16 v[236:239], a[88:91], v[44:47], v[236:239]
    s_waitcnt lgkmcnt(2)
    v_mfma_f32_16x16x32_bf16 v[208:211], v[84:87], v[48:51], v[208:211]
    ds_read_b128 v[40:43], v3 offset:7168
    v_mfma_f32_16x16x32_bf16 v[212:215], v[156:159], v[48:51], v[212:215]
    ds_read_b128 v[44:47], v3 offset:25600
    v_mfma_f32_16x16x32_bf16 v[216:219], v[84:87], v[52:55], v[216:219]
    s_add_u32 m0, s23, 7680
    s_nop 0
    buffer_load_dwordx4 v2, s[8:11], s24 offen offset:512 lds
    s_add_u32 s24, s24, 147456
    v_mfma_f32_16x16x32_bf16 v[220:223], v[156:159], v[52:55], v[220:223]
    v_mfma_f32_16x16x32_bf16 v[224:227], a[20:23], v[48:51], v[224:227]
    v_mfma_f32_16x16x32_bf16 v[228:231], a[92:95], v[48:51], v[228:231]
    v_mfma_f32_16x16x32_bf16 v[232:235], a[20:23], v[52:55], v[232:235]
    v_mfma_f32_16x16x32_bf16 v[236:239], a[92:95], v[52:55], v[236:239]
    s_waitcnt lgkmcnt(2)
    v_mfma_f32_16x16x32_bf16 v[208:211], v[88:91], v[32:35], v[208:211]
    ds_read_b128 v[48:51], v3 offset:8192
    v_mfma_f32_16x16x32_bf16 v[212:215], v[160:163], v[32:35], v[212:215]
    ds_read_b128 v[52:55], v3 offset:26624
    v_mfma_f32_16x16x32_bf16 v[216:219], v[88:91], v[36:39], v[216:219]
    v_mfma_f32_16x16x32_bf16 v[220:223], v[160:163], v[36:39], v[220:223]
    v_mfma_f32_16x16x32_bf16 v[224:227], a[24:27], v[32:35], v[224:227]
    v_mfma_f32_16x16x32_bf16 v[228:231], a[96:99], v[32:35], v[228:231]
    v_mfma_f32_16x16x32_bf16 v[232:235], a[24:27], v[36:39], v[232:235]
    v_mfma_f32_16x16x32_bf16 v[236:239], a[96:99], v[36:39], v[236:239]
    s_waitcnt lgkmcnt(2)
    v_mfma_f32_16x16x32_bf16 v[208:211], v[92:95], v[40:43], v[208:211]
    ds_read_b128 v[32:35], v3 offset:9216
    v_mfma_f32_16x16x32_bf16 v[212:215], v[164:167], v[40:43], v[212:215]
    ds_read_b128 v[36:39], v3 offset:27648
    v_mfma_f32_16x16x32_bf16 v[216:219], v[92:95], v[44:47], v[216:219]
    s_add_u32 s23, s45, s95
    v_mov_b32 v4, s23
    s_mov_b64 exec, s[34:35]
    buffer_store_dword v4, off, s[4:7], s29 sc1
    buffer_store_dword v4, off, s[4:7], s29 offset:128 sc1
    s_mov_b64 exec, -1
    v_mfma_f32_16x16x32_bf16 v[220:223], v[164:167], v[44:47], v[220:223]
    v_mfma_f32_16x16x32_bf16 v[224:227], a[28:31], v[40:43], v[224:227]
    v_mfma_f32_16x16x32_bf16 v[228:231], a[100:103], v[40:43], v[228:231]
    v_mfma_f32_16x16x32_bf16 v[232:235], a[28:31], v[44:47], v[232:235]
    v_mfma_f32_16x16x32_bf16 v[236:239], a[100:103], v[44:47], v[236:239]
    s_waitcnt lgkmcnt(2)
    v_mfma_f32_16x16x32_bf16 v[208:211], v[96:99], v[48:51], v[208:211]
    ds_read_b128 v[40:43], v3 offset:10240
    v_mfma_f32_16x16x32_bf16 v[212:215], v[168:171], v[48:51], v[212:215]
    ds_read_b128 v[44:47], v3 offset:28672
    v_mfma_f32_16x16x32_bf16 v[216:219], v[96:99], v[52:55], v[216:219]
    s_cmp_lt_u32 s19, 60
    s_cbranch_scc1 lt9
    buffer_load_dwordx4 v[244:247], off, s[84:87], 0 offset:16 sc1
    buffer_load_dword v248, off, s[84:87], 0 offset:4 sc1
lt9:
    s_lshr_b32 s46, s19, 2
    s_cmp_eq_u32 s16, 0
    s_cselect_b32 s46, 0, s46
    s_cmp_lg_u32 s46, 2
    s_cbranch_scc1 lp9
    v_mov_b32 v244, -1
    v_mov_b32 v245, -1
    v_mov_b32 v246, -1
    v_mov_b32 v247, -1
    s_lshl_b32 s46, s19, 5
    s_add_u32 s46, s46, s17
    s_lshl_b32 s46, s46, 12
    s_mul_i32 s47, s16, 8388608
    s_add_u32 s46, s46, s47
    s_add_u32 s47, s46, 67108864
    buffer_store_dwordx4 v[244:247], v7, s[4:7], s47 offen sc1
    s_add_u32 s47, s46, 67112960
    buffer_store_dwordx4 v[244:247], v7, s[4:7], s47 offen sc1
    s_add_u32 s47, s46, 67633152
    buffer_store_dwordx4 v[244:247], v7, s[4:7], s47 offen sc1
    s_add_u32 s47, s46, 67637248
    buffer_store_dwordx4 v[244:247], v7, s[4:7], s47 offen sc1
lp9:
    s_lshl_b32 s46, s16, 6
    s_or_b32 s46, s46, s19
    s_or_b32 s47, s46, 1
    s_cmp_lg_u32 s47, 11
    s_cbranch_scc1 lq9
    v_mov_b32 v244, -1
    v_mov_b32 v245, -1
    v_mov_b32 v246, -1
    v_mov_b32 v247, -1
    s_lshl_b32 s46, s46, 18
    s_lshl_b32 s47, s17, 12
    s_add_u32 s46, s46, s47
    s_add_u32 s47, s46, 63963136
    buffer_store_dwordx4 v[244:247], v7, s[4:7], s47 offen sc1
    s_add_u32 s47, s46, 63967232
    buffer_store_dwordx4 v[244:247], v7, s[4:7], s47 offen sc1
    s_add_u32 s47, s46, 64094208
    buffer_store_dwordx4 v[244:247], v7, s[4:7], s47 offen sc1
    s_add_u32 s47, s46, 64098304
    buffer_store_dwordx4 v[244:247], v7, s[4:7], s47 offen sc1
lq9:
    v_mfma_f32_16x16x32_bf16 v[220:223], v[168:171], v[52:55], v[220:223]
    v_mfma_f32_16x16x32_bf16 v[224:227], a[32:35], v[48:51], v[224:227]
    v_mfma_f32_16x16x32_bf16 v[228:231], a[104:107], v[48:51], v[228:231]
    v_mfma_f32_16x16x32_bf16 v[232:235], a[32:35], v[52:55], v[232:235]
    v_mfma_f32_16x16x32_bf16 v[236:239], a[104:107], v[52:55], v[236:239]
    s_waitcnt lgkmcnt(2)
    v_mfma_f32_16x16x32_bf16 v[208:211], v[100:103], v[32:35], v[208:211]
    ds_read_b128 v[48:51], v3 offset:11264
    v_mfma_f32_16x16x32_bf16 v[212:215], v[172:175], v[32:35], v[212:215]
    ds_read_b128 v[52:55], v3 offset:29696
    v_mfma_f32_16x16x32_bf16 v[216:219], v[100:103], v[36:39], v[216:219]
    v_mfma_f32_16x16x32_bf16 v[220:223], v[172:175], v[36:39], v[220:223]
    v_mfma_f32_16x16x32_bf16 v[224:227], a[36:39], v[32:35], v[224:227]
    v_mfma_f32_16x16x32_bf16 v[228:231], a[108:111], v[32:35], v[228:231]
    v_mfma_f32_16x16x32_bf16 v[232:235], a[36:39], v[36:39], v[232:235]
    v_mfma_f32_16x16x32_bf16 v[236:239], a[108:111], v[36:39], v[236:239]
    s_waitcnt lgkmcnt(2)
    v_mfma_f32_16x16x32_bf16 v[208:211], v[104:107], v[40:43], v[208:211]
    ds_read_b128 v[32:35], v3 offset:12288
    v_mfma_f32_16x16x32_bf16 v[212:215], v[176:179], v[40:43], v[212:215]
    ds_read_b128 v[36:39], v3 offset:30720
    v_mfma_f32_16x16x32_bf16 v[216:219], v[104:107], v[44:47], v[216:219]
    v_mfma_f32_16x16x32_bf16 v[220:223], v[176:179], v[44:47], v[220:223]
    v_mfma_f32_16x16x32_bf16 v[224:227], a[40:43], v[40:43], v[224:227]
    v_mfma_f32_16x16x32_bf16 v[228:231], a[112:115], v[40:43], v[228:231]
    v_mfma_f32_16x16x32_bf16 v[232:235], a[40:43], v[44:47], v[232:235]
    v_mfma_f32_16x16x32_bf16 v[236:239], a[112:115], v[44:47], v[236:239]
    s_waitcnt lgkmcnt(2)
    v_mfma_f32_16x16x32_bf16 v[208:211], v[108:111], v[48:51], v[208:211]
    ds_read_b128 v[40:43], v3 offset:13312
    v_mfma_f32_16x16x32_bf16 v[212:215], v[180:183], v[48:51], v[212:215]
    ds_read_b128 v[44:47], v3 offset:31744
    v_mfma_f32_16x16x32_bf16 v[216:219], v[108:111], v[52:55], v[216:219]
    v_mfma_f32_16x16x32_bf16 v[220:223], v[180:183], v[52:55], v[220:223]
    v_mfma_f32_16x16x32_bf16 v[224:227], a[44:47], v[48:51], v[224:227]
    v_mfma_f32_16x16x32_bf16 v[228:231], a[116:119], v[48:51], v[228:231]
    v_mfma_f32_16x16x32_bf16 v[232:235], a[44:47], v[52:55], v[232:235]
    v_mfma_f32_16x16x32_bf16 v[236:239], a[116:119], v[52:55], v[236:239]
    s_waitcnt lgkmcnt(2)
    v_mfma_f32_16x16x32_bf16 v[208:211], v[112:115], v[32:35], v[208:211]
    ds_read_b128 v[48:51], v3 offset:14336
    v_mfma_f32_16x16x32_bf16 v[212:215], v[184:187], v[32:35], v[212:215]
    ds_read_b128 v[52:55], v3 offset:32768
    v_mfma_f32_16x16x32_bf16 v[216:219], v[112:115], v[36:39], v[216:219]
    v_mfma_f32_16x16x32_bf16 v[220:223], v[184:187], v[36:39], v[220:223]
    v_mfma_f32_16x16x32_bf16 v[224:227], a[48:51], v[32:35], v[224:227]
    v_mfma_f32_16x16x32_bf16 v[228:231], a[120:123], v[32:35], v[228:231]
    v_mfma_f32_16x16x32_bf16 v[232:235], a[48:51], v[36:39], v[232:235]
    v_mfma_f32_16x16x32_bf16 v[236:239], a[120:123], v[36:39], v[236:239]
    s_waitcnt lgkmcnt(2)
    v_mfma_f32_16x16x32_bf16 v[208:211], v[116:119], v[40:43], v[208:211]
    ds_read_b128 v[32:35], v3 offset:15360
    v_mfma_f32_16x16x32_bf16 v[212:215], v[188:191], v[40:43], v[212:215]
    ds_read_b128 v[36:39], v3 offset:33792
    v_mfma_f32_16x16x32_bf16 v[216:219], v[116:119], v[44:47], v[216:219]
    v_mfma_f32_16x16x32_bf16 v[220:223], v[188:191], v[44:47], v[220:223]
    v_mfma_f32_16x16x32_bf16 v[224:227], a[52:55], v[40:43], v[224:227]
    v_mfma_f32_16x16x32_bf16 v[228:231], a[124:127], v[40:43], v[228:231]
    v_mfma_f32_16x16x32_bf16 v[232:235], a[52:55], v[44:47], v[232:235]
    v_mfma_f32_16x16x32_bf16 v[236:239], a[124:127], v[44:47], v[236:239]
    s_waitcnt lgkmcnt(2)
    v_mfma_f32_16x16x32_bf16 v[208:211], v[120:123], v[48:51], v[208:211]
    ds_read_b128 v[40:43], v3 offset:16384
    v_mfma_f32_16x16x32_bf16 v[212:215], v[192:195], v[48:51], v[212:215]
    ds_read_b128 v[44:47], v3 offset:34816
    v_mfma_f32_16x16x32_bf16 v[216:219], v[120:123], v[52:55], v[216:219]
    v_mfma_f32_16x16x32_bf16 v[220:223], v[192:195], v[52:55], v[220:223]
    v_mfma_f32_16x16x32_bf16 v[224:227], a[56:59], v[48:51], v[224:227]
    v_mfma_f32_16x16x32_bf16 v[228:231], a[128:131], v[48:51], v[228:231]
    v_mfma_f32_16x16x32_bf16 v[232:235], a[56:59], v[52:55], v[232:235]
    v_mfma_f32_16x16x32_bf16 v[236:239], a[128:131], v[52:55], v[236:239]
    s_waitcnt lgkmcnt(2)
    v_mfma_f32_16x16x32_bf16 v[208:211], v[124:127], v[32:35], v[208:211]
    ds_read_b128 v[48:51], v3 offset:17408
    v_mfma_f32_16x16x32_bf16 v[212:215], v[196:199], v[32:35], v[212:215]
    ds_read_b128 v[52:55], v3 offset:35840
    v_mfma_f32_16x16x32_bf16 v[216:219], v[124:127], v[36:39], v[216:219]
    v_mfma_f32_16x16x32_bf16 v[220:223], v[196:199], v[36:39], v[220:223]
    v_mfma_f32_16x16x32_bf16 v[224:227], a[60:63], v[32:35], v[224:227]
    s_add_u32 s27, s27, 36864
    s_cmp_eq_u32 s27, 110592
    s_cselect_b32 s27, 0, s27
    v_add_u32 v3, s27, v1
    v_mfma_f32_16x16x32_bf16 v[228:231], a[132:135], v[32:35], v[228:231]
    v_mfma_f32_16x16x32_bf16 v[232:235], a[60:63], v[36:39], v[232:235]
    v_mfma_f32_16x16x32_bf16 v[236:239], a[132:135], v[36:39], v[236:239]
    s_waitcnt lgkmcnt(2)
    v_mfma_f32_16x16x32_bf16 v[208:211], v[128:131], v[40:43], v[208:211]
    ds_read_b128 v[32:35], v3 offset:0
    v_mfma_f32_16x16x32_bf16 v[212:215], v[200:203], v[40:43], v[212:215]
    ds_read_b128 v[36:39], v3 offset:18432
    v_mfma_f32_16x16x32_bf16 v[216:219], v[128:131], v[44:47], v[216:219]
    v_mfma_f32_16x16x32_bf16 v[220:223], v[200:203], v[44:47], v[220:223]
    v_mfma_f32_16x16x32_bf16 v[224:227], a[64:67], v[40:43], v[224:227]
    v_mfma_f32_16x16x32_bf16 v[228:231], a[136:139], v[40:43], v[228:231]
    v_mfma_f32_16x16x32_bf16 v[232:235], a[64:67], v[44:47], v[232:235]
    v_mfma_f32_16x16x32_bf16 v[236:239], a[136:139], v[44:47], v[236:239]
    s_waitcnt lgkmcnt(2)
    v_mfma_f32_16x16x32_bf16 v[208:211], v[132:135], v[48:51], v[208:211]
    ds_read_b128 v[40:43], v3 offset:1024
    v_mfma_f32_16x16x32_bf16 v[212:215], v[204:207], v[48:51], v[212:215]
    ds_read_b128 v[44:47], v3 offset:19456
    v_mfma_f32_16x16x32_bf16 v[216:219], v[132:135], v[52:55], v[216:219]
    v_mfma_f32_16x16x32_bf16 v[220:223], v[204:207], v[52:55], v[220:223]
    v_mfma_f32_16x16x32_bf16 v[224:227], a[68:71], v[48:51], v[224:227]
    v_mfma_f32_16x16x32_bf16 v[228:231], a[140:143], v[48:51], v[228:231]
    v_mfma_f32_16x16x32_bf16 v[232:235], a[68:71], v[52:55], v[232:235]
    v_mfma_f32_16x16x32_bf16 v[236:239], a[140:143], v[52:55], v[236:239]
    s_add_u32 s26, s26, s41
    s_waitcnt vmcnt(0)
    v_cvt_pk_bf16_f32 v8, v208, v209
    v_cvt_pk_bf16_f32 v9, v210, v211
    v_cvt_pk_bf16_f32 v10, v212, v213
    v_cvt_pk_bf16_f32 v11, v214, v215
    v_cvt_pk_bf16_f32 v12, v216, v217
    v_cvt_pk_bf16_f32 v13, v218, v219
    v_cvt_pk_bf16_f32 v14, v220, v221
    v_cvt_pk_bf16_f32 v15, v222, v223
    v_cvt_pk_bf16_f32 v16, v224, v225
    v_cvt_pk_bf16_f32 v17, v226, v227
    v_cvt_pk_bf16_f32 v18, v228, v229
    v_cvt_pk_bf16_f32 v19, v230, v231
    v_cvt_pk_bf16_f32 v20, v232, v233
    v_cvt_pk_bf16_f32 v21, v234, v235
    v_cvt_pk_bf16_f32 v22, v236, v237
    v_cvt_pk_bf16_f32 v23, v238, v239
    s_mov_b64 s[36:37], -1
    s_add_u32 s28, s26, s12
    buffer_store_dwordx4 v[8:11], v7, s[4:7], s28 offen sc1
    s_add_u32 s28, s26, s13
    buffer_store_dwordx4 v[12:15], v7, s[4:7], s28 offen sc1
    s_add_u32 s28, s26, s14
    buffer_store_dwordx4 v[16:19], v7, s[4:7], s28 offen sc1
    s_add_u32 s28, s26, s15
    buffer_store_dwordx4 v[20:23], v7, s[4:7], s28 offen sc1
    s_lshr_b32 s45, s19, 2
    s_cbranch_scc1 qk_loop_nf
    s_mov_b32 s45, 1
    s_mov_b64 s[36:37], 0
    s_waitcnt vmcnt(0)
    s_barrier
    s_add_u32 s23, s45, s95
    v_mov_b32 v4, s23
    s_mov_b64 exec, s[34:35]
    buffer_store_dword v4, off, s[4:7], s29 sc1
    buffer_store_dword v4, off, s[4:7], s29 offset:128 sc1
    s_mov_b64 exec, -1
qk_loop_nf:
    s_add_u32 s19, s19, 4
    s_cmp_lt_u32 s19, s20
    s_cbranch_scc1 qk_loop
    s_branch qk_done
qk_vloop:
    s_barrier
    s_add_u32 s22, s27, 73728
    s_sub_u32 s21, s22, 110592
    s_cselect_b32 s22, s22, s21
    s_waitcnt lgkmcnt(2)
    v_mfma_f32_16x16x32_bf16 v[208:211], v[32:35], v[64:67], 0
    ds_read_b128 v[48:51], v3 offset:2048
    v_mfma_f32_16x16x32_bf16 v[212:215], v[32:35], v[136:139], 0
    ds_read_b128 v[52:55], v3 offset:20480
    v_mfma_f32_16x16x32_bf16 v[216:219], v[36:39], v[64:67], 0
    v_mfma_f32_16x16x32_bf16 v[220:223], v[36:39], v[136:139], 0
    v_mfma_f32_16x16x32_bf16 v[224:227], v[32:35], a[0:3], 0
    v_mfma_f32_16x16x32_bf16 v[228:231], v[32:35], a[72:75], 0
    v_mfma_f32_16x16x32_bf16 v[232:235], v[36:39], a[0:3], 0
    v_mfma_f32_16x16x32_bf16 v[236:239], v[36:39], a[72:75], 0
    s_waitcnt lgkmcnt(2)
    v_mfma_f32_16x16x32_bf16 v[208:211], v[40:43], v[68:71], v[208:211]
    ds_read_b128 v[32:35], v3 offset:3072
    v_mfma_f32_16x16x32_bf16 v[212:215], v[40:43], v[140:143], v[212:215]
    ds_read_b128 v[36:39], v3 offset:21504
    v_mfma_f32_16x16x32_bf16 v[216:219], v[44:47], v[68:71], v[216:219]
    s_add_u32 s23, s22, s25
    s_add_u32 m0, s23, 0
    s_nop 0
    buffer_load_dwordx4 v2, s[8:11], s24 offen offset:0 lds
    v_mfma_f32_16x16x32_bf16 v[220:223], v[44:47], v[140:143], v[220:223]
    v_mfma_f32_16x16x32_bf16 v[224:227], v[40:43], a[4:7], v[224:227]
    v_mfma_f32_16x16x32_bf16 v[228:231], v[40:43], a[76:79], v[228:231]
    v_mfma_f32_16x16x32_bf16 v[232:235], v[44:47], a[4:7], v[232:235]
    s_add_u32 m0, s23, 960
    s_nop 0
    buffer_load_dwordx4 v2, s[8:11], s24 offen offset:64 lds
    v_mfma_f32_16x16x32_bf16 v[236:239], v[44:47], a[76:79], v[236:239]
    s_waitcnt lgkmcnt(2)
    v_mfma_f32_16x16x32_bf16 v[208:211], v[48:51], v[72:75], v[208:211]
    ds_read_b128 v[40:43], v3 offset:4096
    v_mfma_f32_16x16x32_bf16 v[212:215], v[48:51], v[144:147], v[212:215]
    ds_read_b128 v[44:47], v3 offset:22528
    v_mfma_f32_16x16x32_bf16 v[216:219], v[52:55], v[72:75], v[216:219]
    s_add_u32 m0, s23, 1920
    s_nop 0
    buffer_load_dwordx4 v2, s[8:11], s24 offen offset:128 lds
    v_mfma_f32_16x16x32_bf16 v[220:223], v[52:55], v[144:147], v[220:223]
    v_mfma_f32_16x16x32_bf16 v[224:227], v[48:51], a[8:11], v[224:227]
    v_mfma_f32_16x16x32_bf16 v[228:231], v[48:51], a[80:83], v[228:231]
    v_mfma_f32_16x16x32_bf16 v[232:235], v[52:55], a[8:11], v[232:235]
    s_add_u32 m0, s23, 2880
    s_nop 0
    buffer_load_dwordx4 v2, s[8:11], s24 offen offset:192 lds
    v_mfma_f32_16x16x32_bf16 v[236:239], v[52:55], a[80:83], v[236:239]
    s_waitcnt lgkmcnt(2)
    v_mfma_f32_16x16x32_bf16 v[208:211], v[32:35], v[76:79], v[208:211]
    ds_read_b128 v[48:51], v3 offset:5120
    v_mfma_f32_16x16x32_bf16 v[212:215], v[32:35], v[148:151], v[212:215]
    ds_read_b128 v[52:55], v3 offset:23552
    v_mfma_f32_16x16x32_bf16 v[216:219], v[36:39], v[76:79], v[216:219]
    s_add_u32 m0, s23, 3840
    s_nop 0
    buffer_load_dwordx4 v2, s[8:11], s24 offen offset:256 lds
    v_mfma_f32_16x16x32_bf16 v[220:223], v[36:39], v[148:151], v[220:223]
    v_mfma_f32_16x16x32_bf16 v[224:227], v[32:35], a[12:15], v[224:227]
    v_mfma_f32_16x16x32_bf16 v[228:231], v[32:35], a[84:87], v[228:231]
    v_mfma_f32_16x16x32_bf16 v[232:235], v[36:39], a[12:15], v[232:235]
    s_add_u32 m0, s23, 4800
    s_nop 0
    buffer_load_dwordx4 v2, s[8:11], s24 offen offset:320 lds
    v_mfma_f32_16x16x32_bf16 v[236:239], v[36:39], a[84:87], v[236:239]
    s_waitcnt lgkmcnt(2)
    v_mfma_f32_16x16x32_bf16 v[208:211], v[40:43], v[80:83], v[208:211]
    ds_read_b128 v[32:35], v3 offset:6144
    v_mfma_f32_16x16x32_bf16 v[212:215], v[40:43], v[152:155], v[212:215]
    ds_read_b128 v[36:39], v3 offset:24576
    v_mfma_f32_16x16x32_bf16 v[216:219], v[44:47], v[80:83], v[216:219]
    s_add_u32 m0, s23, 5760
    s_nop 0
    buffer_load_dwordx4 v2, s[8:11], s24 offen offset:384 lds
    v_mfma_f32_16x16x32_bf16 v[220:223], v[44:47], v[152:155], v[220:223]
    v_mfma_f32_16x16x32_bf16 v[224:227], v[40:43], a[16:19], v[224:227]
    v_mfma_f32_16x16x32_bf16 v[228:231], v[40:43], a[88:91], v[228:231]
    v_mfma_f32_16x16x32_bf16 v[232:235], v[44:47], a[16:19], v[232:235]
    s_add_u32 m0, s23, 6720
    s_nop 0
    buffer_load_dwordx4 v2, s[8:11], s24 offen offset:448 lds
    v_mfma_f32_16x16x32_bf16 v[236:239], v[44:47], a[88:91], v[236:239]
    s_waitcnt lgkmcnt(2)
    v_mfma_f32_16x16x32_bf16 v[208:211], v[48:51], v[84:87], v[208:211]
    ds_read_b128 v[40:43], v3 offset:7168
    v_mfma_f32_16x16x32_bf16 v[212:215], v[48:51], v[156:159], v[212:215]
    ds_read_b128 v[44:47], v3 offset:25600
    v_mfma_f32_16x16x32_bf16 v[216:219], v[52:55], v[84:87], v[216:219]
    s_add_u32 m0, s23, 7680
    s_nop 0
    buffer_load_dwordx4 v2, s[8:11], s24 offen offset:512 lds
    s_add_u32 s24, s24, 147456
    v_mfma_f32_16x16x32_bf16 v[220:223], v[52:55], v[156:159], v[220:223]
    v_mfma_f32_16x16x32_bf16 v[224:227], v[48:51], a[20:23], v[224:227]
    v_mfma_f32_16x16x32_bf16 v[228:231], v[48:51], a[92:95], v[228:231]
    v_mfma_f32_16x16x32_bf16 v[232:235], v[52:55], a[20:23], v[232:235]
    v_mfma_f32_16x16x32_bf16 v[236:239], v[52:55], a[92:95], v[236:239]
    s_waitcnt lgkmcnt(2)
    v_mfma_f32_16x16x32_bf16 v[208:211], v[32:35], v[88:91], v[208:211]
    ds_read_b128 v[48:51], v3 offset:8192
    v_mfma_f32_16x16x32_bf16 v[212:215], v[32:35], v[160:163], v[212:215]
    ds_read_b128 v[52:55], v3 offset:26624
    v_mfma_f32_16x16x32_bf16 v[216:219], v[36:39], v[88:91], v[216:219]
    v_mfma_f32_16x16x32_bf16 v[220:223], v[36:39], v[160:163], v[220:223]
    v_mfma_f32_16x16x32_bf16 v[224:227], v[32:35], a[24:27], v[224:227]
    v_mfma_f32_16x16x32_bf16 v[228:231], v[32:35], a[96:99], v[228:231]
    v_mfma_f32_16x16x32_bf16 v[232:235], v[36:39], a[24:27], v[232:235]
    v_mfma_f32_16x16x32_bf16 v[236:239], v[36:39], a[96:99], v[236:239]
    s_waitcnt lgkmcnt(2)
    v_mfma_f32_16x16x32_bf16 v[208:211], v[40:43], v[92:95], v[208:211]
    ds_read_b128 v[32:35], v3 offset:9216
    v_mfma_f32_16x16x32_bf16 v[212:215], v[40:43], v[164:167], v[212:215]
    ds_read_b128 v[36:39], v3 offset:27648
    v_mfma_f32_16x16x32_bf16 v[216:219], v[44:47], v[92:95], v[216:219]
    s_add_u32 s23, s45, s95
    v_mov_b32 v4, s23
    s_mov_b64 exec, s[34:35]
    buffer_store_dword v4, off, s[4:7], s29 sc1
    buffer_store_dword v4, off, s[4:7], s29 offset:128 sc1
    s_mov_b64 exec, -1
    v_mfma_f32_16x16x32_bf16 v[220:223], v[44:47], v[164:167], v[220:223]
    v_mfma_f32_16x16x32_bf16 v[224:227], v[40:43], a[28:31], v[224:227]
    v_mfma_f32_16x16x32_bf16 v[228:231], v[40:43], a[100:103], v[228:231]
    v_mfma_f32_16x16x32_bf16 v[232:235], v[44:47], a[28:31], v[232:235]
    v_mfma_f32_16x16x32_bf16 v[236:239], v[44:47], a[100:103], v[236:239]
    s_waitcnt lgkmcnt(2)
    v_mfma_f32_16x16x32_bf16 v[208:211], v[48:51], v[96:99], v[208:211]
    ds_read_b128 v[40:43], v3 offset:10240
    v_mfma_f32_16x16x32_bf16 v[212:215], v[48:51], v[168:171], v[212:215]
    ds_read_b128 v[44:47], v3 offset:28672
    v_mfma_f32_16x16x32_bf16 v[216:219], v[52:55], v[96:99], v[216:219]
    s_cmp_lt_u32 s19, 60
    s_cbranch_scc1 lt10
    buffer_load_dwordx4 v[244:247], off, s[84:87], 0 offset:16 sc1
    buffer_load_dword v248, off, s[84:87], 0 offset:4 sc1
lt10:
    s_lshr_b32 s46, s19, 2
    s_cmp_eq_u32 s16, 0
    s_cselect_b32 s46, 0, s46
    s_cmp_lg_u32 s46, 2
    s_cbranch_scc1 lp10
    v_mov_b32 v244, -1
    v_mov_b32 v245, -1
    v_mov_b32 v246, -1
    v_mov_b32 v247, -1
    s_lshl_b32 s46, s19, 5
    s_add_u32 s46, s46, s17
    s_lshl_b32 s46, s46, 12
    s_mul_i32 s47, s16, 8388608
    s_add_u32 s46, s46, s47
    s_add_u32 s47, s46, 67108864
    buffer_store_dwordx4 v[244:247], v7, s[4:7], s47 offen sc1
    s_add_u32 s47, s46, 67112960
    buffer_store_dwordx4 v[244:247], v7, s[4:7], s47 offen sc1
    s_add_u32 s47, s46, 67633152
    buffer_store_dwordx4 v[244:247], v7, s[4:7], s47 offen sc1
    s_add_u32 s47, s46, 67637248
    buffer_store_dwordx4 v[244:247], v7, s[4:7], s47 offen sc1
lp10:
    s_lshl_b32 s46, s16, 6
    s_or_b32 s46, s46, s19
    s_or_b32 s47, s46, 1
    s_cmp_lg_u32 s47, 11
    s_cbranch_scc1 lq10
    v_mov_b32 v244, -1
    v_mov_b32 v245, -1
    v_mov_b32 v246, -1
    v_mov_b32 v247, -1
    s_lshl_b32 s46, s46, 18
    s_lshl_b32 s47, s17, 12
    s_add_u32 s46, s46, s47
    s_add_u32 s47, s46, 63963136
    buffer_store_dwordx4 v[244:247], v7, s[4:7], s47 offen sc1
    s_add_u32 s47, s46, 63967232
    buffer_store_dwordx4 v[244:247], v7, s[4:7], s47 offen sc1
    s_add_u32 s47, s46, 64094208
    buffer_store_dwordx4 v[244:247], v7, s[4:7], s47 offen sc1
    s_add_u32 s47, s46, 64098304
    buffer_store_dwordx4 v[244:247], v7, s[4:7], s47 offen sc1
lq10:
    v_mfma_f32_16x16x32_bf16 v[220:223], v[52:55], v[168:171], v[220:223]
    v_mfma_f32_16x16x32_bf16 v[224:227], v[48:51], a[32:35], v[224:227]
    v_mfma_f32_16x16x32_bf16 v[228:231], v[48:51], a[104:107], v[228:231]
    v_mfma_f32_16x16x32_bf16 v[232:235], v[52:55], a[32:35], v[232:235]
    v_mfma_f32_16x16x32_bf16 v[236:239], v[52:55], a[104:107], v[236:239]
    s_waitcnt lgkmcnt(2)
    v_mfma_f32_16x16x32_bf16 v[208:211], v[32:35], v[100:103], v[208:211]
    ds_read_b128 v[48:51], v3 offset:11264
    v_mfma_f32_16x16x32_bf16 v[212:215], v[32:35], v[172:175], v[212:215]
    ds_read_b128 v[52:55], v3 offset:29696
    v_mfma_f32_16x16x32_bf16 v[216:219], v[36:39], v[100:103], v[216:219]
    v_mfma_f32_16x16x32_bf16 v[220:223], v[36:39], v[172:175], v[220:223]
    v_mfma_f32_16x16x32_bf16 v[224:227], v[32:35], a[36:39], v[224:227]
    v_mfma_f32_16x16x32_bf16 v[228:231], v[32:35], a[108:111], v[228:231]
    v_mfma_f32_16x16x32_bf16 v[232:235], v[36:39], a[36:39], v[232:235]
    v_mfma_f32_16x16x32_bf16 v[236:239], v[36:39], a[108:111], v[236:239]
    s_waitcnt lgkmcnt(2)
    v_mfma_f32_16x16x32_bf16 v[208:211], v[40:43], v[104:107], v[208:211]
    ds_read_b128 v[32:35], v3 offset:12288
    v_mfma_f32_16x16x32_bf16 v[212:215], v[40:43], v[176:179], v[212:215]
    ds_read_b128 v[36:39], v3 offset:30720
    v_mfma_f32_16x16x32_bf16 v[216:219], v[44:47], v[104:107], v[216:219]
    v_mfma_f32_16x16x32_bf16 v[220:223], v[44:47], v[176:179], v[220:223]
    v_mfma_f32_16x16x32_bf16 v[224:227], v[40:43], a[40:43], v[224:227]
    v_mfma_f32_16x16x32_bf16 v[228:231], v[40:43], a[112:115], v[228:231]
    v_mfma_f32_16x16x32_bf16 v[232:235], v[44:47], a[40:43], v[232:235]
    v_mfma_f32_16x16x32_bf16 v[236:239], v[44:47], a[112:115], v[236:239]
    s_waitcnt lgkmcnt(2)
    v_mfma_f32_16x16x32_bf16 v[208:211], v[48:51], v[108:111], v[208:211]
    ds_read_b128 v[40:43], v3 offset:13312
    v_mfma_f32_16x16x32_bf16 v[212:215], v[48:51], v[180:183], v[212:215]
    ds_read_b128 v[44:47], v3 offset:31744
    v_mfma_f32_16x16x32_bf16 v[216:219], v[52:55], v[108:111], v[216:219]
    v_mfma_f32_16x16x32_bf16 v[220:223], v[52:55], v[180:183], v[220:223]
    v_mfma_f32_16x16x32_bf16 v[224:227], v[48:51], a[44:47], v[224:227]
    v_mfma_f32_16x16x32_bf16 v[228:231], v[48:51], a[116:119], v[228:231]
    v_mfma_f32_16x16x32_bf16 v[232:235], v[52:55], a[44:47], v[232:235]
    v_mfma_f32_16x16x32_bf16 v[236:239], v[52:55], a[116:119], v[236:239]
    s_waitcnt lgkmcnt(2)
    v_mfma_f32_16x16x32_bf16 v[208:211], v[32:35], v[112:115], v[208:211]
    ds_read_b128 v[48:51], v3 offset:14336
    v_mfma_f32_16x16x32_bf16 v[212:215], v[32:35], v[184:187], v[212:215]
    ds_read_b128 v[52:55], v3 offset:32768
    v_mfma_f32_16x16x32_bf16 v[216:219], v[36:39], v[112:115], v[216:219]
    v_mfma_f32_16x16x32_bf16 v[220:223], v[36:39], v[184:187], v[220:223]
    v_mfma_f32_16x16x32_bf16 v[224:227], v[32:35], a[48:51], v[224:227]
    v_mfma_f32_16x16x32_bf16 v[228:231], v[32:35], a[120:123], v[228:231]
    v_mfma_f32_16x16x32_bf16 v[232:235], v[36:39], a[48:51], v[232:235]
    v_mfma_f32_16x16x32_bf16 v[236:239], v[36:39], a[120:123], v[236:239]
    s_waitcnt lgkmcnt(2)
    v_mfma_f32_16x16x32_bf16 v[208:211], v[40:43], v[116:119], v[208:211]
    ds_read_b128 v[32:35], v3 offset:15360
    v_mfma_f32_16x16x32_bf16 v[212:215], v[40:43], v[188:191], v[212:215]
    ds_read_b128 v[36:39], v3 offset:33792
    v_mfma_f32_16x16x32_bf16 v[216:219], v[44:47], v[116:119], v[216:219]
    v_mfma_f32_16x16x32_bf16 v[220:223], v[44:47], v[188:191], v[220:223]
    v_mfma_f32_16x16x32_bf16 v[224:227], v[40:43], a[52:55], v[224:227]
    v_mfma_f32_16x16x32_bf16 v[228:231], v[40:43], a[124:127], v[228:231]
    v_mfma_f32_16x16x32_bf16 v[232:235], v[44:47], a[52:55], v[232:235]
    v_mfma_f32_16x16x32_bf16 v[236:239], v[44:47], a[124:127], v[236:239]
    s_waitcnt lgkmcnt(2)
    v_mfma_f32_16x16x32_bf16 v[208:211], v[48:51], v[120:123], v[208:211]
    ds_read_b128 v[40:43], v3 offset:16384
    v_mfma_f32_16x16x32_bf16 v[212:215], v[48:51], v[192:195], v[212:215]
    ds_read_b128 v[44:47], v3 offset:34816
    v_mfma_f32_16x16x32_bf16 v[216:219], v[52:55], v[120:123], v[216:219]
    v_mfma_f32_16x16x32_bf16 v[220:223], v[52:55], v[192:195], v[220:223]
    v_mfma_f32_16x16x32_bf16 v[224:227], v[48:51], a[56:59], v[224:227]
    v_mfma_f32_16x16x32_bf16 v[228:231], v[48:51], a[128:131], v[228:231]
    v_mfma_f32_16x16x32_bf16 v[232:235], v[52:55], a[56:59], v[232:235]
    v_mfma_f32_16x16x32_bf16 v[236:239], v[52:55], a[128:131], v[236:239]
    s_waitcnt lgkmcnt(2)
    v_mfma_f32_16x16x32_bf16 v[208:211], v[32:35], v[124:127], v[208:211]
    ds_read_b128 v[48:51], v3 offset:17408
    v_mfma_f32_16x16x32_bf16 v[212:215], v[32:35], v[196:199], v[212:215]
    ds_read_b128 v[52:55], v3 offset:35840
    v_mfma_f32_16x16x32_bf16 v[216:219], v[36:39], v[124:127], v[216:219]
    v_mfma_f32_16x16x32_bf16 v[220:223], v[36:39], v[196:199], v[220:223]
    v_mfma_f32_16x16x32_bf16 v[224:227], v[32:35], a[60:63], v[224:227]
    s_add_u32 s27, s27, 36864
    s_cmp_eq_u32 s27, 110592
    s_cselect_b32 s27, 0, s27
    v_add_u32 v3, s27, v1
    v_mfma_f32_16x16x32_bf16 v[228:231], v[32:35], a[132:135], v[228:231]
    v_mfma_f32_16x16x32_bf16 v[232:235], v[36:39], a[60:63], v[232:235]
    v_mfma_f32_16x16x32_bf16 v[236:239], v[36:39], a[132:135], v[236:239]
    s_waitcnt lgkmcnt(2)
    v_mfma_f32_16x16x32_bf16 v[208:211], v[40:43], v[128:131], v[208:211]
    ds_read_b128 v[32:35], v3 offset:0
    v_mfma_f32_16x16x32_bf16 v[212:215], v[40:43], v[200:203], v[212:215]
    ds_read_b128 v[36:39], v3 offset:18432
    v_mfma_f32_16x16x32_bf16 v[216:219], v[44:47], v[128:131], v[216:219]
    v_mfma_f32_16x16x32_bf16 v[220:223], v[44:47], v[200:203], v[220:223]
    v_mfma_f32_16x16x32_bf16 v[224:227], v[40:43], a[64:67], v[224:227]
    v_mfma_f32_16x16x32_bf16 v[228:231], v[40:43], a[136:139], v[228:231]
    v_mfma_f32_16x16x32_bf16 v[232:235], v[44:47], a[64:67], v[232:235]
    v_mfma_f32_16x16x32_bf16 v[236:239], v[44:47], a[136:139], v[236:239]
    s_waitcnt lgkmcnt(2)
    v_mfma_f32_16x16x32_bf16 v[208:211], v[48:51], v[132:135], v[208:211]
    ds_read_b128 v[40:43], v3 offset:1024
    v_mfma_f32_16x16x32_bf16 v[212:215], v[48:51], v[204:207], v[212:215]
    ds_read_b128 v[44:47], v3 offset:19456
    v_mfma_f32_16x16x32_bf16 v[216:219], v[52:55], v[132:135], v[216:219]
    v_mfma_f32_16x16x32_bf16 v[220:223], v[52:55], v[204:207], v[220:223]
    v_mfma_f32_16x16x32_bf16 v[224:227], v[48:51], a[68:71], v[224:227]
    v_mfma_f32_16x16x32_bf16 v[228:231], v[48:51], a[140:143], v[228:231]
    v_mfma_f32_16x16x32_bf16 v[232:235], v[52:55], a[68:71], v[232:235]
    v_mfma_f32_16x16x32_bf16 v[236:239], v[52:55], a[140:143], v[236:239]
    s_add_u32 s26, s26, s41
    s_waitcnt vmcnt(0)
    v_cvt_pk_bf16_f32 v8, v208, v209
    v_cvt_pk_bf16_f32 v9, v210, v211
    v_cvt_pk_bf16_f32 v10, v216, v217
    v_cvt_pk_bf16_f32 v11, v218, v219
    v_cvt_pk_bf16_f32 v12, v212, v213
    v_cvt_pk_bf16_f32 v13, v214, v215
    v_cvt_pk_bf16_f32 v14, v220, v221
    v_cvt_pk_bf16_f32 v15, v222, v223
    v_cvt_pk_bf16_f32 v16, v224, v225
    v_cvt_pk_bf16_f32 v17, v226, v227
    v_cvt_pk_bf16_f32 v18, v232, v233
    v_cvt_pk_bf16_f32 v19, v234, v235
    v_cvt_pk_bf16_f32 v20, v228, v229
    v_cvt_pk_bf16_f32 v21, v230, v231
    v_cvt_pk_bf16_f32 v22, v236, v237
    v_cvt_pk_bf16_f32 v23, v238, v239
    s_mov_b64 s[36:37], -1
    s_add_u32 s28, s26, s12
    buffer_store_dwordx4 v[8:11], v7, s[4:7], s28 offen sc1
    s_add_u32 s28, s26, s13
    buffer_store_dwordx4 v[12:15], v7, s[4:7], s28 offen sc1
    s_add_u32 s28, s26, s14
    buffer_store_dwordx4 v[16:19], v7, s[4:7], s28 offen sc1
    s_add_u32 s28, s26, s15
    buffer_store_dwordx4 v[20:23], v7, s[4:7], s28 offen sc1
    s_lshr_b32 s45, s19, 2
    s_cbranch_scc1 qk_vloop_nf
    s_mov_b32 s45, 1
    s_mov_b64 s[36:37], 0
    s_waitcnt vmcnt(0)
    s_barrier
    s_add_u32 s23, s45, s95
    v_mov_b32 v4, s23
    s_mov_b64 exec, s[34:35]
    buffer_store_dword v4, off, s[4:7], s29 sc1
    buffer_store_dword v4, off, s[4:7], s29 offset:128 sc1
    s_mov_b64 exec, -1
qk_vloop_nf:
    s_add_u32 s19, s19, 4
    s_cmp_lt_u32 s19, s20
    s_cbranch_scc1 qk_vloop
qk_done:
    s_waitcnt vmcnt(0) lgkmcnt(0)
    s_barrier
    s_mov_b32 s45, 16
    s_add_u32 s23, s45, s95
    v_mov_b32 v4, s23
    s_mov_b64 exec, s[34:35]
    buffer_store_dword v4, off, s[4:7], s29 sc1
    buffer_store_dword v4, off, s[4:7], s29 offset:128 sc1
    s_mov_b64 exec, -1
    s_cmp_lt_i32 s33, 0
    s_cbranch_scc1 L_memkv
    v_readfirstlane_b32 s40, v245
    v_readfirstlane_b32 s41, v246
    v_readfirstlane_b32 s42, v247
    v_readfirstlane_b32 s43, v248
    s_cmp_ge_u32 s40, 160
    s_cselect_b32 s43, s43, 0
    s_cmp_ge_u32 s41, 1
    s_cselect_b32 s43, s43, 0
    s_cmp_eq_u32 s42, 1
    s_cselect_b32 s43, s43, 0
    s_cmp_eq_u32 s93, 1000
    s_cselect_b32 s43, s43, 0
    s_mov_b32 s93, 999
    v_mov_b32 v250, s43
    v_mov_b32 v251, 163832
    s_mov_b64 exec, s[34:35]
    ds_write_b32 v251, v250
    s_mov_b64 exec, -1
    s_waitcnt lgkmcnt(0)
    s_barrier
    ds_read_b32 v252, v251
    s_waitcnt lgkmcnt(0)
    v_readfirstlane_b32 s43, v252
    s_barrier
    s_cmp_lg_u32 s43, 192
    s_cbranch_scc1 L_qkv_next
    s_mov_b32 s45, s33
    s_mov_b32 s93, 500
    s_branch L_phase2b
L_memkv:
    v_and_b32 v4, 63, v0
    v_and_b32 v2, 7, v4
    v_lshrrev_b32 v5, 4, v4
    v_lshl_add_u32 v2, v5, 3, v2
    v_lshlrev_b32 v2, 4, v2
    v_bfe_u32 v3, v4, 3, 1
    v_mul_u32_u24 v5, 9216, v3
    v_add_u32 v2, v2, v5
    v_mov_b32 v240, 0x05040100
    v_mov_b32 v241, 0x07060302
    v_lshrrev_b32 v5, 5, v4
    v_and_b32 v1, 0xdff, v7
    s_cmp_eq_u32 s16, 2
    s_cbranch_scc1 mk_isv
    v_mov_b32 v5, v3
    v_or_b32 v1, 128, v7
mk_isv:
    v_lshl_add_u32 v1, v5, 17, v1
    s_mov_b32 s28, 0
    s_mov_b32 s19, 2
    s_mov_b32 s24, 138412032
    s_lshl_b32 s26, s17, 12
    s_mov_b32 s21, 69206016
    s_cmp_eq_u32 s16, 2
    s_cselect_b32 s21, 77594624, s21
    s_add_u32 s26, s26, s21
    s_lshl_b32 s29, s17, 7
    s_lshl_b32 s21, s16, 2
    s_add_u32 s29, s29, s21
    s_add_u32 s29, s29, 125829164
mk_loop:
    s_cmp_lg_u32 s18, 0
    s_cbranch_scc1 mk_go
    s_cmp_le_u32 s19, s28
    s_cbranch_scc1 mk_go
    s_mov_b32 s23, 125853696
    s_mov_b32 s21, 4194304
mk_wait:
    buffer_load_dword v4, off, s[4:7], s23 sc1
    s_sub_u32 s21, s21, 1
    s_cbranch_scc1 mk_go
    s_waitcnt vmcnt(0)
    v_readfirstlane_b32 s28, v4
    s_nop 0
    s_sub_u32 s28, s28, s95
    s_cmp_gt_u32 s28, 64
    s_cselect_b32 s28, 0, s28
    s_cmp_le_u32 s19, s28
    s_cbranch_scc1 mk_go
    s_sleep 4
    s_branch mk_wait
mk_go:
    s_barrier
    s_add_u32 s21, s24, 4096
    s_add_u32 s23, s24, 8192
    buffer_load_dwordx4 v[24:27], v2, s[4:7], s24 offen offset:0 sc1
    buffer_load_dwordx4 v[28:31], v2, s[4:7], s24 offen offset:512 sc1
    buffer_load_dwordx4 v[32:35], v2, s[4:7], s21 offen offset:0 sc1
    buffer_load_dwordx4 v[36:39], v2, s[4:7], s21 offen offset:512 sc1
    buffer_load_dwordx4 v[40:43], v2, s[4:7], s24 offen offset:1024 sc1
    buffer_load_dwordx4 v[44:47], v2, s[4:7], s24 offen offset:1536 sc1
    buffer_load_dwordx4 v[48:51], v2, s[4:7], s21 offen offset:1024 sc1
    buffer_load_dwordx4 v[52:55], v2, s[4:7], s21 offen offset:1536 sc1
    buffer_load_dwordx4 v[56:59], v2, s[4:7], s24 offen offset:2048 sc1
    buffer_load_dwordx4 v[60:63], v2, s[4:7], s24 offen offset:2560 sc1
    buffer_load_dwordx4 v[208:211], v2, s[4:7], s21 offen offset:2048 sc1
    buffer_load_dwordx4 v[212:215], v2, s[4:7], s21 offen offset:2560 sc1
    buffer_load_dwordx4 v[216:219], v2, s[4:7], s24 offen offset:3072 sc1
    buffer_load_dwordx4 v[220:223], v2, s[4:7], s24 offen offset:3584 sc1
    buffer_load_dwordx4 v[224:227], v2, s[4:7], s21 offen offset:3072 sc1
    buffer_load_dwordx4 v[228:231], v2, s[4:7], s21 offen offset:3584 sc1
    buffer_load_dwordx4 v[232:235], v2, s[4:7], s23 offen offset:0 sc1
    buffer_load_dwordx4 v[236:239], v2, s[4:7], s23 offen offset:512 sc1
    s_add_u32 s24, s24, 18432
    s_cmp_eq_u32 s16, 2
    s_cbranch_scc1 mk_v
    s_waitcnt vmcnt(17)
    s_waitcnt vmcnt(16)
    v_mfma_f32_16x16x32_bf16 v[8:11], v[64:67], v[24:27], 0
    v_mfma_f32_16x16x32_bf16 v[12:15], v[136:139], v[24:27], 0
    v_mfma_f32_16x16x32_bf16 v[16:19], a[0:3], v[24:27], 0
    v_mfma_f32_16x16x32_bf16 v[20:23], a[72:75], v[24:27], 0
    s_waitcnt vmcnt(15)
    v_mfma_f32_16x16x32_bf16 v[8:11], v[68:71], v[28:31], v[8:11]
    v_mfma_f32_16x16x32_bf16 v[12:15], v[140:143], v[28:31], v[12:15]
    v_mfma_f32_16x16x32_bf16 v[16:19], a[4:7], v[28:31], v[16:19]
    v_mfma_f32_16x16x32_bf16 v[20:23], a[76:79], v[28:31], v[20:23]
    s_waitcnt vmcnt(14)
    v_mfma_f32_16x16x32_bf16 v[8:11], v[72:75], v[32:35], v[8:11]
    v_mfma_f32_16x16x32_bf16 v[12:15], v[144:147], v[32:35], v[12:15]
    v_mfma_f32_16x16x32_bf16 v[16:19], a[8:11], v[32:35], v[16:19]
    v_mfma_f32_16x16x32_bf16 v[20:23], a[80:83], v[32:35], v[20:23]
    s_waitcnt vmcnt(13)
    v_mfma_f32_16x16x32_bf16 v[8:11], v[76:79], v[36:39], v[8:11]
    v_mfma_f32_16x16x32_bf16 v[12:15], v[148:151], v[36:39], v[12:15]
    v_mfma_f32_16x16x32_bf16 v[16:19], a[12:15], v[36:39], v[16:19]
    v_mfma_f32_16x16x32_bf16 v[20:23], a[84:87], v[36:39], v[20:23]
    s_waitcnt vmcnt(12)
    v_mfma_f32_16x16x32_bf16 v[8:11], v[80:83], v[40:43], v[8:11]
    v_mfma_f32_16x16x32_bf16 v[12:15], v[152:155], v[40:43], v[12:15]
    v_mfma_f32_16x16x32_bf16 v[16:19], a[16:19], v[40:43], v[16:19]
    v_mfma_f32_16x16x32_bf16 v[20:23], a[88:91], v[40:43], v[20:23]
    s_waitcnt vmcnt(11)
    v_mfma_f32_16x16x32_bf16 v[8:11], v[84:87], v[44:47], v[8:11]
    v_mfma_f32_16x16x32_bf16 v[12:15], v[156:159], v[44:47], v[12:15]
    v_mfma_f32_16x16x32_bf16 v[16:19], a[20:23], v[44:47], v[16:19]
    v_mfma_f32_16x16x32_bf16 v[20:23], a[92:95], v[44:47], v[20:23]
    s_waitcnt vmcnt(10)
    v_mfma_f32_16x16x32_bf16 v[8:11], v[88:91], v[48:51], v[8:11]
    v_mfma_f32_16x16x32_bf16 v[12:15], v[160:163], v[48:51], v[12:15]
    v_mfma_f32_16x16x32_bf16 v[16:19], a[24:27], v[48:51], v[16:19]
    v_mfma_f32_16x16x32_bf16 v[20:23], a[96:99], v[48:51], v[20:23]
    s_waitcnt vmcnt(9)
    v_mfma_f32_16x16x32_bf16 v[8:11], v[92:95], v[52:55], v[8:11]
    v_mfma_f32_16x16x32_bf16 v[12:15], v[164:167], v[52:55], v[12:15]
    v_mfma_f32_16x16x32_bf16 v[16:19], a[28:31], v[52:55], v[16:19]
    v_mfma_f32_16x16x32_bf16 v[20:23], a[100:103], v[52:55], v[20:23]
    s_waitcnt vmcnt(8)
    v_mfma_f32_16x16x32_bf16 v[8:11], v[96:99], v[56:59], v[8:11]
    v_mfma_f32_16x16x32_bf16 v[12:15], v[168:171], v[56:59], v[12:15]
    v_mfma_f32_16x16x32_bf16 v[16:19], a[32:35], v[56:59], v[16:19]
    v_mfma_f32_16x16x32_bf16 v[20:23], a[104:107], v[56:59], v[20:23]
    s_waitcnt vmcnt(7)
    v_mfma_f32_16x16x32_bf16 v[8:11], v[100:103], v[60:63], v[8:11]
    v_mfma_f32_16x16x32_bf16 v[12:15], v[172:175], v[60:63], v[12:15]
    v_mfma_f32_16x16x32_bf16 v[16:19], a[36:39], v[60:63], v[16:19]
    v_mfma_f32_16x16x32_bf16 v[20:23], a[108:111], v[60:63], v[20:23]
    s_waitcnt vmcnt(6)
    v_mfma_f32_16x16x32_bf16 v[8:11], v[104:107], v[208:211], v[8:11]
    v_mfma_f32_16x16x32_bf16 v[12:15], v[176:179], v[208:211], v[12:15]
    v_mfma_f32_16x16x32_bf16 v[16:19], a[40:43], v[208:211], v[16:19]
    v_mfma_f32_16x16x32_bf16 v[20:23], a[112:115], v[208:211], v[20:23]
    s_waitcnt vmcnt(5)
    v_mfma_f32_16x16x32_bf16 v[8:11], v[108:111], v[212:215], v[8:11]
    v_mfma_f32_16x16x32_bf16 v[12:15], v[180:183], v[212:215], v[12:15]
    v_mfma_f32_16x16x32_bf16 v[16:19], a[44:47], v[212:215], v[16:19]
    v_mfma_f32_16x16x32_bf16 v[20:23], a[116:119], v[212:215], v[20:23]
    s_waitcnt vmcnt(4)
    v_mfma_f32_16x16x32_bf16 v[8:11], v[112:115], v[216:219], v[8:11]
    v_mfma_f32_16x16x32_bf16 v[12:15], v[184:187], v[216:219], v[12:15]
    v_mfma_f32_16x16x32_bf16 v[16:19], a[48:51], v[216:219], v[16:19]
    v_mfma_f32_16x16x32_bf16 v[20:23], a[120:123], v[216:219], v[20:23]
    s_waitcnt vmcnt(3)
    v_mfma_f32_16x16x32_bf16 v[8:11], v[116:119], v[220:223], v[8:11]
    v_mfma_f32_16x16x32_bf16 v[12:15], v[188:191], v[220:223], v[12:15]
    v_mfma_f32_16x16x32_bf16 v[16:19], a[52:55], v[220:223], v[16:19]
    v_mfma_f32_16x16x32_bf16 v[20:23], a[124:127], v[220:223], v[20:23]
    s_waitcnt vmcnt(2)
    v_mfma_f32_16x16x32_bf16 v[8:11], v[120:123], v[224:227], v[8:11]
    v_mfma_f32_16x16x32_bf16 v[12:15], v[192:195], v[224:227], v[12:15]
    v_mfma_f32_16x16x32_bf16 v[16:19], a[56:59], v[224:227], v[16:19]
    v_mfma_f32_16x16x32_bf16 v[20:23], a[128:131], v[224:227], v[20:23]
    s_waitcnt vmcnt(1)
    v_mfma_f32_16x16x32_bf16 v[8:11], v[124:127], v[228:231], v[8:11]
    v_mfma_f32_16x16x32_bf16 v[12:15], v[196:199], v[228:231], v[12:15]
    v_mfma_f32_16x16x32_bf16 v[16:19], a[60:63], v[228:231], v[16:19]
    v_mfma_f32_16x16x32_bf16 v[20:23], a[132:135], v[228:231], v[20:23]
    s_waitcnt vmcnt(0)
    v_mfma_f32_16x16x32_bf16 v[8:11], v[128:131], v[232:235], v[8:11]
    v_mfma_f32_16x16x32_bf16 v[12:15], v[200:203], v[232:235], v[12:15]
    v_mfma_f32_16x16x32_bf16 v[16:19], a[64:67], v[232:235], v[16:19]
    v_mfma_f32_16x16x32_bf16 v[20:23], a[136:139], v[232:235], v[20:23]
    v_mfma_f32_16x16x32_bf16 v[8:11], v[132:135], v[236:239], v[8:11]
    v_mfma_f32_16x16x32_bf16 v[12:15], v[204:207], v[236:239], v[12:15]
    v_mfma_f32_16x16x32_bf16 v[16:19], a[68:71], v[236:239], v[16:19]
    v_mfma_f32_16x16x32_bf16 v[20:23], a[140:143], v[236:239], v[20:23]
    s_nop 7
    s_branch mk_st
mk_v:
    s_waitcnt vmcnt(17)
    s_waitcnt vmcnt(16)
    v_mfma_f32_16x16x32_bf16 v[8:11], v[24:27], v[64:67], 0
    v_mfma_f32_16x16x32_bf16 v[12:15], v[24:27], v[136:139], 0
    v_mfma_f32_16x16x32_bf16 v[16:19], v[24:27], a[0:3], 0
    v_mfma_f32_16x16x32_bf16 v[20:23], v[24:27], a[72:75], 0
    s_waitcnt vmcnt(15)
    v_mfma_f32_16x16x32_bf16 v[8:11], v[28:31], v[68:71], v[8:11]
    v_mfma_f32_16x16x32_bf16 v[12:15], v[28:31], v[140:143], v[12:15]
    v_mfma_f32_16x16x32_bf16 v[16:19], v[28:31], a[4:7], v[16:19]
    v_mfma_f32_16x16x32_bf16 v[20:23], v[28:31], a[76:79], v[20:23]
    s_waitcnt vmcnt(14)
    v_mfma_f32_16x16x32_bf16 v[8:11], v[32:35], v[72:75], v[8:11]
    v_mfma_f32_16x16x32_bf16 v[12:15], v[32:35], v[144:147], v[12:15]
    v_mfma_f32_16x16x32_bf16 v[16:19], v[32:35], a[8:11], v[16:19]
    v_mfma_f32_16x16x32_bf16 v[20:23], v[32:35], a[80:83], v[20:23]
    s_waitcnt vmcnt(13)
    v_mfma_f32_16x16x32_bf16 v[8:11], v[36:39], v[76:79], v[8:11]
    v_mfma_f32_16x16x32_bf16 v[12:15], v[36:39], v[148:151], v[12:15]
    v_mfma_f32_16x16x32_bf16 v[16:19], v[36:39], a[12:15], v[16:19]
    v_mfma_f32_16x16x32_bf16 v[20:23], v[36:39], a[84:87], v[20:23]
    s_waitcnt vmcnt(12)
    v_mfma_f32_16x16x32_bf16 v[8:11], v[40:43], v[80:83], v[8:11]
    v_mfma_f32_16x16x32_bf16 v[12:15], v[40:43], v[152:155], v[12:15]
    v_mfma_f32_16x16x32_bf16 v[16:19], v[40:43], a[16:19], v[16:19]
    v_mfma_f32_16x16x32_bf16 v[20:23], v[40:43], a[88:91], v[20:23]
    s_waitcnt vmcnt(11)
    v_mfma_f32_16x16x32_bf16 v[8:11], v[44:47], v[84:87], v[8:11]
    v_mfma_f32_16x16x32_bf16 v[12:15], v[44:47], v[156:159], v[12:15]
    v_mfma_f32_16x16x32_bf16 v[16:19], v[44:47], a[20:23], v[16:19]
    v_mfma_f32_16x16x32_bf16 v[20:23], v[44:47], a[92:95], v[20:23]
    s_waitcnt vmcnt(10)
    v_mfma_f32_16x16x32_bf16 v[8:11], v[48:51], v[88:91], v[8:11]
    v_mfma_f32_16x16x32_bf16 v[12:15], v[48:51], v[160:163], v[12:15]
    v_mfma_f32_16x16x32_bf16 v[16:19], v[48:51], a[24:27], v[16:19]
    v_mfma_f32_16x16x32_bf16 v[20:23], v[48:51], a[96:99], v[20:23]
    s_waitcnt vmcnt(9)
    v_mfma_f32_16x16x32_bf16 v[8:11], v[52:55], v[92:95], v[8:11]
    v_mfma_f32_16x16x32_bf16 v[12:15], v[52:55], v[164:167], v[12:15]
    v_mfma_f32_16x16x32_bf16 v[16:19], v[52:55], a[28:31], v[16:19]
    v_mfma_f32_16x16x32_bf16 v[20:23], v[52:55], a[100:103], v[20:23]
    s_waitcnt vmcnt(8)
    v_mfma_f32_16x16x32_bf16 v[8:11], v[56:59], v[96:99], v[8:11]
    v_mfma_f32_16x16x32_bf16 v[12:15], v[56:59], v[168:171], v[12:15]
    v_mfma_f32_16x16x32_bf16 v[16:19], v[56:59], a[32:35], v[16:19]
    v_mfma_f32_16x16x32_bf16 v[20:23], v[56:59], a[104:107], v[20:23]
    s_waitcnt vmcnt(7)
    v_mfma_f32_16x16x32_bf16 v[8:11], v[60:63], v[100:103], v[8:11]
    v_mfma_f32_16x16x32_bf16 v[12:15], v[60:63], v[172:175], v[12:15]
    v_mfma_f32_16x16x32_bf16 v[16:19], v[60:63], a[36:39], v[16:19]
    v_mfma_f32_16x16x32_bf16 v[20:23], v[60:63], a[108:111], v[20:23]
    s_waitcnt vmcnt(6)
    v_mfma_f32_16x16x32_bf16 v[8:11], v[208:211], v[104:107], v[8:11]
    v_mfma_f32_16x16x32_bf16 v[12:15], v[208:211], v[176:179], v[12:15]
    v_mfma_f32_16x16x32_bf16 v[16:19], v[208:211], a[40:43], v[16:19]
    v_mfma_f32_16x16x32_bf16 v[20:23], v[208:211], a[112:115], v[20:23]
    s_waitcnt vmcnt(5)
    v_mfma_f32_16x16x32_bf16 v[8:11], v[212:215], v[108:111], v[8:11]
    v_mfma_f32_16x16x32_bf16 v[12:15], v[212:215], v[180:183], v[12:15]
    v_mfma_f32_16x16x32_bf16 v[16:19], v[212:215], a[44:47], v[16:19]
    v_mfma_f32_16x16x32_bf16 v[20:23], v[212:215], a[116:119], v[20:23]
    s_waitcnt vmcnt(4)
    v_mfma_f32_16x16x32_bf16 v[8:11], v[216:219], v[112:115], v[8:11]
    v_mfma_f32_16x16x32_bf16 v[12:15], v[216:219], v[184:187], v[12:15]
    v_mfma_f32_16x16x32_bf16 v[16:19], v[216:219], a[48:51], v[16:19]
    v_mfma_f32_16x16x32_bf16 v[20:23], v[216:219], a[120:123], v[20:23]
    s_waitcnt vmcnt(3)
    v_mfma_f32_16x16x32_bf16 v[8:11], v[220:223], v[116:119], v[8:11]
    v_mfma_f32_16x16x32_bf16 v[12:15], v[220:223], v[188:191], v[12:15]
    v_mfma_f32_16x16x32_bf16 v[16:19], v[220:223], a[52:55], v[16:19]
    v_mfma_f32_16x16x32_bf16 v[20:23], v[220:223], a[124:127], v[20:23]
    s_waitcnt vmcnt(2)
    v_mfma_f32_16x16x32_bf16 v[8:11], v[224:227], v[120:123], v[8:11]
    v_mfma_f32_16x16x32_bf16 v[12:15], v[224:227], v[192:195], v[12:15]
    v_mfma_f32_16x16x32_bf16 v[16:19], v[224:227], a[56:59], v[16:19]
    v_mfma_f32_16x16x32_bf16 v[20:23], v[224:227], a[128:131], v[20:23]
    s_waitcnt vmcnt(1)
    v_mfma_f32_16x16x32_bf16 v[8:11], v[228:231], v[124:127], v[8:11]
    v_mfma_f32_16x16x32_bf16 v[12:15], v[228:231], v[196:199], v[12:15]
    v_mfma_f32_16x16x32_bf16 v[16:19], v[228:231], a[60:63], v[16:19]
    v_mfma_f32_16x16x32_bf16 v[20:23], v[228:231], a[132:135], v[20:23]
    s_waitcnt vmcnt(0)
    v_mfma_f32_16x16x32_bf16 v[8:11], v[232:235], v[128:131], v[8:11]
    v_mfma_f32_16x16x32_bf16 v[12:15], v[232:235], v[200:203], v[12:15]
    v_mfma_f32_16x16x32_bf16 v[16:19], v[232:235], a[64:67], v[16:19]
    v_mfma_f32_16x16x32_bf16 v[20:23], v[232:235], a[136:139], v[20:23]
    v_mfma_f32_16x16x32_bf16 v[8:11], v[236:239], v[132:135], v[8:11]
    v_mfma_f32_16x16x32_bf16 v[12:15], v[236:239], v[204:207], v[12:15]
    v_mfma_f32_16x16x32_bf16 v[16:19], v[236:239], a[68:71], v[16:19]
    v_mfma_f32_16x16x32_bf16 v[20:23], v[236:239], a[140:143], v[20:23]
    s_nop 4
    v_pk_mul_f32 v[8:9], v[8:9], 0.5 op_sel_hi:[1,0]
    v_pk_mul_f32 v[10:11], v[10:11], 0.5 op_sel_hi:[1,0]
    v_pk_mul_f32 v[12:13], v[12:13], 0.5 op_sel_hi:[1,0]
    v_pk_mul_f32 v[14:15], v[14:15], 0.5 op_sel_hi:[1,0]
    v_pk_mul_f32 v[16:17], v[16:17], 0.5 op_sel_hi:[1,0]
    v_pk_mul_f32 v[18:19], v[18:19], 0.5 op_sel_hi:[1,0]
    v_pk_mul_f32 v[20:21], v[20:21], 0.5 op_sel_hi:[1,0]
    v_pk_mul_f32 v[22:23], v[22:23], 0.5 op_sel_hi:[1,0]
mk_st:
    s_nop 1
    v_cvt_pk_bf16_f32 v24, v8, v9
    v_cvt_pk_bf16_f32 v25, v10, v11
    v_cvt_pk_bf16_f32 v26, v12, v13
    v_cvt_pk_bf16_f32 v27, v14, v15
    v_cvt_pk_bf16_f32 v28, v16, v17
    v_cvt_pk_bf16_f32 v29, v18, v19
    v_cvt_pk_bf16_f32 v30, v20, v21
    v_cvt_pk_bf16_f32 v31, v22, v23
    s_add_u32 s21, s26, 4096
    buffer_store_dwordx4 v[24:27], v1, s[4:7], s26 offen sc1
    buffer_store_dwordx4 v[28:31], v1, s[4:7], s21 offen sc1
    s_add_u32 s22, s19, s95
    s_waitcnt vmcnt(0)
    s_barrier
    v_mov_b32 v4, s22
    s_mov_b64 exec, s[34:35]
    buffer_store_dword v4, off, s[4:7], s29 sc1
    buffer_store_dword v4, off, s[4:7], s29 offset:128 sc1
    s_mov_b64 exec, -1
    s_add_u32 s19, s19, 2
    s_add_u32 s26, s26, 262144
    s_cmp_le_u32 s19, 56
    s_cbranch_scc1 mk_loop
    s_mov_b32 s45, 2
    s_mov_b32 s8, s76
    s_mov_b32 s9, s77
    s_mov_b32 s10, 4718592
    s_mov_b32 s11, 0x20000
    s_branch L_att_next
L_ssm_next:
    s_sub_u32 s93, s93, 1
    s_cbranch_scc1 L_exit
    s_mov_b32 s37, 8
    v_mov_b32 v250, 1
    v_mov_b32 v251, 163832
    v_cmp_eq_u32 vcc, 0, v0
    s_nop 0
    s_and_saveexec_b64 s[38:39], vcc
    s_cbranch_execz tk11
    buffer_atomic_add v250, off, s[84:87], s37 sc0
    s_waitcnt vmcnt(0)
    ds_write_b32 v251, v250
    s_waitcnt lgkmcnt(0)
tk11:
    s_mov_b64 exec, -1
    s_barrier
    ds_read_b32 v252, v251
    s_waitcnt lgkmcnt(0)
    v_readfirstlane_b32 s20, v252
    s_barrier
    s_nop 3
    s_cmp_ge_u32 s20, 72
    s_cbranch_scc1 L_ssm_done
    s_lshl_b32 s20, s20, 3
    v_lshrrev_b32 v5, 6, v0
    s_nop 0
    v_readfirstlane_b32 s21, v5
    v_and_b32 v1, 63, v0
    v_and_b32 v2, 15, v1
    v_lshrrev_b32 v3, 4, v1
    v_lshlrev_b32 v4, 14, v5
    s_mov_b32 s8, s62
    s_mov_b32 s9, s63
    s_mov_b32 s10, 2359296
    s_mov_b32 s11, 0x20000
    s_mov_b32 s16, s76
    s_mov_b32 s17, s77
    s_mov_b32 s18, 4718592
    s_mov_b32 s19, 0x20000
    s_add_u32 s22, s20, s21
    s_lshl_b32 s23, s22, 8
    v_lshlrev_b32 v6, 3, v2
    v_lshl_add_u32 v6, v3, 1, v6
    s_mov_b32 s12, s64
    s_mov_b32 s13, s65
    s_mov_b32 s14, 147456
    s_mov_b32 s15, 0x20000
    buffer_load_ushort v8, v6, s[12:15], s23 offen offset:0
    buffer_load_ushort v12, v6, s[12:15], s23 offen offset:128
    buffer_load_ushort v16, v6, s[12:15], s23 offen offset:1024
    buffer_load_ushort v20, v6, s[12:15], s23 offen offset:1152
    s_mov_b32 s12, s66
    s_mov_b32 s13, s67
    s_mov_b32 s14, 147456
    s_mov_b32 s15, 0x20000
    buffer_load_ushort v9, v6, s[12:15], s23 offen offset:0
    buffer_load_ushort v13, v6, s[12:15], s23 offen offset:128
    buffer_load_ushort v17, v6, s[12:15], s23 offen offset:1024
    buffer_load_ushort v21, v6, s[12:15], s23 offen offset:1152
    s_mov_b32 s12, s68
    s_mov_b32 s13, s69
    s_mov_b32 s14, 147456
    s_mov_b32 s15, 0x20000
    buffer_load_ushort v10, v6, s[12:15], s23 offen offset:0
    buffer_load_ushort v14, v6, s[12:15], s23 offen offset:128
    buffer_load_ushort v18, v6, s[12:15], s23 offen offset:1024
    buffer_load_ushort v22, v6, s[12:15], s23 offen offset:1152
    s_mov_b32 s12, s70
    s_mov_b32 s13, s71
    s_mov_b32 s14, 147456
    s_mov_b32 s15, 0x20000
    buffer_load_ushort v11, v6, s[12:15], s23 offen offset:0
    buffer_load_ushort v15, v6, s[12:15], s23 offen offset:128
    buffer_load_ushort v19, v6, s[12:15], s23 offen offset:1024
    buffer_load_ushort v23, v6, s[12:15], s23 offen offset:1152
    s_mov_b32 s12, s72
    s_mov_b32 s13, s73
    s_mov_b32 s14, 1152
    s_mov_b32 s15, 0x20000
    s_lshl_b32 s23, s22, 1
    buffer_load_ushort v24, off, s[12:15], s23
    buffer_load_ushort v25, off, s[12:15], s23 offset:8
    v_mul_u32_u24 v5, 9216, v0
    s_lshl_b32 s22, s20, 1
    s_add_u32 s23, s22, 0
    buffer_load_dwordx4 v[208:211], v5, s[8:11], s23 offen
    s_add_u32 s23, s22, 1152
    buffer_load_dwordx4 v[212:215], v5, s[8:11], s23 offen
    s_add_u32 s23, s22, 2304
    buffer_load_dwordx4 v[216:219], v5, s[8:11], s23 offen
    s_add_u32 s23, s22, 3456
    buffer_load_dwordx4 v[220:223], v5, s[8:11], s23 offen
    s_add_u32 s23, s22, 4608
    buffer_load_dwordx4 v[224:227], v5, s[8:11], s23 offen
    s_add_u32 s23, s22, 5760
    buffer_load_dwordx4 v[228:231], v5, s[8:11], s23 offen
    s_add_u32 s23, s22, 6912
    buffer_load_dwordx4 v[232:235], v5, s[8:11], s23 offen
    s_add_u32 s23, s22, 8064
    buffer_load_dwordx4 v[236:239], v5, s[8:11], s23 offen
    s_mov_b32 s26, 0x3fb8aa3b
    s_mov_b32 s27, 0x3e22f983
    s_mov_b32 s28, 0
    v_cvt_f32_u32 v26, v2
    v_mul_f32 v27, 0x41800000, v26
    s_waitcnt vmcnt(8)
    s_nop 0
ss_pass:
    v_mov_b32 v36, 0
    v_mov_b32 v37, 0
    v_lshl_add_u32 v6, v1, 3, v4
    ds_write_b64 v6, v[36:37] offset:0
    v_lshlrev_b32 v38, 16, v24
    v_mul_f32 v38, s26, v38
    v_exp_f32 v38, v38
    s_nop 0
    v_cvt_pk_bf16_f32 v38, v38, v38
    v_and_b32 v38, 0xffff0000, v38
    v_add_f32 v39, v38, v38
    v_lshlrev_b32 v28, 16, v8
    v_mul_f32 v28, s26, v28
    v_exp_f32 v28, v28
    s_nop 0
    v_cvt_pk_bf16_f32 v28, v28, v28
    v_and_b32 v28, 0xffff0000, v28
    v_mul_f32 v28, v28, v38
    v_mul_f32 v28, s26, v28
    v_sub_f32 v28, 0, v28
    v_lshlrev_b32 v29, 16, v9
    v_mul_f32 v29, v29, v38
    v_mul_f32 v29, s27, v29
    v_lshlrev_b32 v30, 16, v10
    v_mul_f32 v30, v30, v39
    v_lshlrev_b32 v31, 16, v11
    v_mul_f32 v31, v31, v39
    v_lshlrev_b32 v32, 16, v12
    v_mul_f32 v32, s26, v32
    v_exp_f32 v32, v32
    s_nop 0
    v_cvt_pk_bf16_f32 v32, v32, v32
    v_and_b32 v32, 0xffff0000, v32
    v_mul_f32 v32, v32, v38
    v_mul_f32 v32, s26, v32
    v_sub_f32 v32, 0, v32
    v_lshlrev_b32 v33, 16, v13
    v_mul_f32 v33, v33, v38
    v_mul_f32 v33, s27, v33
    v_lshlrev_b32 v34, 16, v14
    v_mul_f32 v34, v34, v39
    v_lshlrev_b32 v35, 16, v15
    v_mul_f32 v35, v35, v39
    v_mov_b64 v[48:49], 0
    v_mov_b64 v[50:51], 0
    v_mov_b64 v[52:53], 0
    v_mov_b64 v[54:55], 0
    v_mov_b64 v[56:57], 0
    v_mov_b64 v[58:59], 0
    v_mov_b64 v[60:61], 0
    v_mov_b64 v[62:63], 0
    s_mov_b32 s25, 0
    s_nop 0
ss_kg:
    v_mov_b64_dpp v[64:65], v[28:29] row_newbcast:0 row_mask:0xf bank_mask:0xf
    v_mov_b64_dpp v[66:67], v[30:31] row_newbcast:0 row_mask:0xf bank_mask:0xf
    v_pk_mul_f32 v[94:95], v[64:65], v[26:27] op_sel_hi:[1,0]
    v_pk_mul_f32 v[96:97], v[64:65], v[26:27] op_sel:[0,1] op_sel_hi:[1,1]
    v_fract_f32 v95, v95
    v_fract_f32 v97, v97
    v_exp_f32 v94, v94
    v_exp_f32 v96, v96
    v_cos_f32 v68, v95
    v_sin_f32 v69, v95
    v_cos_f32 v76, v97
    v_sin_f32 v77, v97
    v_pk_mul_f32 v[68:69], v[68:69], v[94:95] op_sel_hi:[1,0]
    v_pk_mul_f32 v[76:77], v[76:77], v[96:97] op_sel_hi:[1,0]
    v_pk_mul_f32 v[92:93], v[76:77], v[76:77] op_sel:[1,1] op_sel_hi:[0,1]
    v_pk_fma_f32 v[78:79], v[76:77], v[76:77], v[92:93] op_sel:[0,0,0] op_sel_hi:[0,1,1] neg_lo:[0,0,1]
    v_pk_mul_f32 v[94:95], v[68:69], v[68:69] op_sel:[1,1] op_sel_hi:[0,1]
    v_pk_fma_f32 v[70:71], v[68:69], v[68:69], v[94:95] op_sel:[0,0,0] op_sel_hi:[0,1,1] neg_lo:[0,0,1]
    v_pk_mul_f32 v[92:93], v[78:79], v[78:79] op_sel:[1,1] op_sel_hi:[0,1]
    v_pk_fma_f32 v[80:81], v[78:79], v[78:79], v[92:93] op_sel:[0,0,0] op_sel_hi:[0,1,1] neg_lo:[0,0,1]
    v_pk_mul_f32 v[94:95], v[70:71], v[70:71] op_sel:[1,1] op_sel_hi:[0,1]
    v_pk_fma_f32 v[72:73], v[70:71], v[70:71], v[94:95] op_sel:[0,0,0] op_sel_hi:[0,1,1] neg_lo:[0,0,1]
    v_pk_mul_f32 v[92:93], v[80:81], v[80:81] op_sel:[1,1] op_sel_hi:[0,1]
    v_pk_fma_f32 v[82:83], v[80:81], v[80:81], v[92:93] op_sel:[0,0,0] op_sel_hi:[0,1,1] neg_lo:[0,0,1]
    v_pk_mul_f32 v[94:95], v[72:73], v[72:73] op_sel:[1,1] op_sel_hi:[0,1]
    v_pk_fma_f32 v[74:75], v[72:73], v[72:73], v[94:95] op_sel:[0,0,0] op_sel_hi:[0,1,1] neg_lo:[0,0,1]
    v_pk_mul_f32 v[92:93], v[82:83], v[82:83] op_sel:[1,1] op_sel_hi:[0,1]
    v_pk_fma_f32 v[84:85], v[82:83], v[82:83], v[92:93] op_sel:[0,0,0] op_sel_hi:[0,1,1] neg_lo:[0,0,1]
    v_pk_mul_f32 v[94:95], v[66:67], v[76:77] op_sel:[1,1] op_sel_hi:[1,0]
    v_pk_fma_f32 v[86:87], v[66:67], v[76:77], v[94:95] op_sel:[0,0,0] op_sel_hi:[0,1,1] neg_lo:[0,0,1] neg_hi:[1,0,1]
    v_mov_b32_dpp v80, v78 row_ror:8 row_mask:0xf bank_mask:0x3
    v_mov_b32_dpp v81, v79 row_ror:8 row_mask:0xf bank_mask:0x3
    v_mov_b32_dpp v82, v84 row_ror:8 row_mask:0xf bank_mask:0x3
    v_mov_b32_dpp v83, v85 row_ror:8 row_mask:0xf bank_mask:0x3
    v_pk_mul_f32 v[92:93], v[66:67], v[80:81] op_sel:[1,1] op_sel_hi:[1,0]
    v_pk_fma_f32 v[88:89], v[66:67], v[80:81], v[92:93] op_sel:[0,0,0] op_sel_hi:[0,1,1] neg_lo:[0,0,1] neg_hi:[1,0,1]
    v_pk_mul_f32 v[94:95], v[66:67], v[82:83] op_sel:[1,1] op_sel_hi:[1,0]
    v_pk_fma_f32 v[90:91], v[66:67], v[82:83], v[94:95] op_sel:[0,0,0] op_sel_hi:[0,1,1] neg_lo:[0,0,1] neg_hi:[1,0,1]
    v_mfma_f32_16x16x4_f32 v[48:51], v86, v68, v[48:51]
    v_mfma_f32_16x16x4_f32 v[52:55], v88, v70, v[52:55]
    v_mfma_f32_16x16x4_f32 v[56:59], v88, v72, v[56:59]
    v_mfma_f32_16x16x4_f32 v[60:63], v90, v74, v[60:63]
    v_mfma_f32_16x16x4_f32 v[48:51], v87, v69, v[48:51]
    v_mfma_f32_16x16x4_f32 v[52:55], v89, v71, v[52:55]
    v_mfma_f32_16x16x4_f32 v[56:59], v89, v73, v[56:59]
    v_mfma_f32_16x16x4_f32 v[60:63], v91, v75, v[60:63]
    v_mov_b64_dpp v[64:65], v[28:29] row_newbcast:1 row_mask:0xf bank_mask:0xf
    v_mov_b64_dpp v[66:67], v[30:31] row_newbcast:1 row_mask:0xf bank_mask:0xf
    v_pk_mul_f32 v[94:95], v[64:65], v[26:27] op_sel_hi:[1,0]
    v_pk_mul_f32 v[96:97], v[64:65], v[26:27] op_sel:[0,1] op_sel_hi:[1,1]
    v_fract_f32 v95, v95
    v_fract_f32 v97, v97
    v_exp_f32 v94, v94
    v_exp_f32 v96, v96
    v_cos_f32 v68, v95
    v_sin_f32 v69, v95
    v_cos_f32 v76, v97
    v_sin_f32 v77, v97
    v_pk_mul_f32 v[68:69], v[68:69], v[94:95] op_sel_hi:[1,0]
    v_pk_mul_f32 v[76:77], v[76:77], v[96:97] op_sel_hi:[1,0]
    v_pk_mul_f32 v[92:93], v[76:77], v[76:77] op_sel:[1,1] op_sel_hi:[0,1]
    v_pk_fma_f32 v[78:79], v[76:77], v[76:77], v[92:93] op_sel:[0,0,0] op_sel_hi:[0,1,1] neg_lo:[0,0,1]
    v_pk_mul_f32 v[94:95], v[68:69], v[68:69] op_sel:[1,1] op_sel_hi:[0,1]
    v_pk_fma_f32 v[70:71], v[68:69], v[68:69], v[94:95] op_sel:[0,0,0] op_sel_hi:[0,1,1] neg_lo:[0,0,1]
    v_pk_mul_f32 v[92:93], v[78:79], v[78:79] op_sel:[1,1] op_sel_hi:[0,1]
    v_pk_fma_f32 v[80:81], v[78:79], v[78:79], v[92:93] op_sel:[0,0,0] op_sel_hi:[0,1,1] neg_lo:[0,0,1]
    v_pk_mul_f32 v[94:95], v[70:71], v[70:71] op_sel:[1,1] op_sel_hi:[0,1]
    v_pk_fma_f32 v[72:73], v[70:71], v[70:71], v[94:95] op_sel:[0,0,0] op_sel_hi:[0,1,1] neg_lo:[0,0,1]
    v_pk_mul_f32 v[92:93], v[80:81], v[80:81] op_sel:[1,1] op_sel_hi:[0,1]
    v_pk_fma_f32 v[82:83], v[80:81], v[80:81], v[92:93] op_sel:[0,0,0] op_sel_hi:[0,1,1] neg_lo:[0,0,1]
    v_pk_mul_f32 v[94:95], v[72:73], v[72:73] op_sel:[1,1] op_sel_hi:[0,1]
    v_pk_fma_f32 v[74:75], v[72:73], v[72:73], v[94:95] op_sel:[0,0,0] op_sel_hi:[0,1,1] neg_lo:[0,0,1]
    v_pk_mul_f32 v[92:93], v[82:83], v[82:83] op_sel:[1,1] op_sel_hi:[0,1]
    v_pk_fma_f32 v[84:85], v[82:83], v[82:83], v[92:93] op_sel:[0,0,0] op_sel_hi:[0,1,1] neg_lo:[0,0,1]
    v_pk_mul_f32 v[94:95], v[66:67], v[76:77] op_sel:[1,1] op_sel_hi:[1,0]
    v_pk_fma_f32 v[86:87], v[66:67], v[76:77], v[94:95] op_sel:[0,0,0] op_sel_hi:[0,1,1] neg_lo:[0,0,1] neg_hi:[1,0,1]
    v_mov_b32_dpp v80, v78 row_ror:8 row_mask:0xf bank_mask:0x3
    v_mov_b32_dpp v81, v79 row_ror:8 row_mask:0xf bank_mask:0x3
    v_mov_b32_dpp v82, v84 row_ror:8 row_mask:0xf bank_mask:0x3
    v_mov_b32_dpp v83, v85 row_ror:8 row_mask:0xf bank_mask:0x3
    v_pk_mul_f32 v[92:93], v[66:67], v[80:81] op_sel:[1,1] op_sel_hi:[1,0]
    v_pk_fma_f32 v[88:89], v[66:67], v[80:81], v[92:93] op_sel:[0,0,0] op_sel_hi:[0,1,1] neg_lo:[0,0,1] neg_hi:[1,0,1]
    v_pk_mul_f32 v[94:95], v[66:67], v[82:83] op_sel:[1,1] op_sel_hi:[1,0]
    v_pk_fma_f32 v[90:91], v[66:67], v[82:83], v[94:95] op_sel:[0,0,0] op_sel_hi:[0,1,1] neg_lo:[0,0,1] neg_hi:[1,0,1]
    v_mfma_f32_16x16x4_f32 v[48:51], v86, v68, v[48:51]
    v_mfma_f32_16x16x4_f32 v[52:55], v88, v70, v[52:55]
    v_mfma_f32_16x16x4_f32 v[56:59], v88, v72, v[56:59]
    v_mfma_f32_16x16x4_f32 v[60:63], v90, v74, v[60:63]
    v_mfma_f32_16x16x4_f32 v[48:51], v87, v69, v[48:51]
    v_mfma_f32_16x16x4_f32 v[52:55], v89, v71, v[52:55]
    v_mfma_f32_16x16x4_f32 v[56:59], v89, v73, v[56:59]
    v_mfma_f32_16x16x4_f32 v[60:63], v91, v75, v[60:63]
    v_mov_b64_dpp v[64:65], v[28:29] row_newbcast:2 row_mask:0xf bank_mask:0xf
    v_mov_b64_dpp v[66:67], v[30:31] row_newbcast:2 row_mask:0xf bank_mask:0xf
    v_pk_mul_f32 v[94:95], v[64:65], v[26:27] op_sel_hi:[1,0]
    v_pk_mul_f32 v[96:97], v[64:65], v[26:27] op_sel:[0,1] op_sel_hi:[1,1]
    v_fract_f32 v95, v95
    v_fract_f32 v97, v97
    v_exp_f32 v94, v94
    v_exp_f32 v96, v96
    v_cos_f32 v68, v95
    v_sin_f32 v69, v95
    v_cos_f32 v76, v97
    v_sin_f32 v77, v97
    v_pk_mul_f32 v[68:69], v[68:69], v[94:95] op_sel_hi:[1,0]
    v_pk_mul_f32 v[76:77], v[76:77], v[96:97] op_sel_hi:[1,0]
    v_pk_mul_f32 v[92:93], v[76:77], v[76:77] op_sel:[1,1] op_sel_hi:[0,1]
    v_pk_fma_f32 v[78:79], v[76:77], v[76:77], v[92:93] op_sel:[0,0,0] op_sel_hi:[0,1,1] neg_lo:[0,0,1]
    v_pk_mul_f32 v[94:95], v[68:69], v[68:69] op_sel:[1,1] op_sel_hi:[0,1]
    v_pk_fma_f32 v[70:71], v[68:69], v[68:69], v[94:95] op_sel:[0,0,0] op_sel_hi:[0,1,1] neg_lo:[0,0,1]
    v_pk_mul_f32 v[92:93], v[78:79], v[78:79] op_sel:[1,1] op_sel_hi:[0,1]
    v_pk_fma_f32 v[80:81], v[78:79], v[78:79], v[92:93] op_sel:[0,0,0] op_sel_hi:[0,1,1] neg_lo:[0,0,1]
    v_pk_mul_f32 v[94:95], v[70:71], v[70:71] op_sel:[1,1] op_sel_hi:[0,1]
    v_pk_fma_f32 v[72:73], v[70:71], v[70:71], v[94:95] op_sel:[0,0,0] op_sel_hi:[0,1,1] neg_lo:[0,0,1]
    v_pk_mul_f32 v[92:93], v[80:81], v[80:81] op_sel:[1,1] op_sel_hi:[0,1]
    v_pk_fma_f32 v[82:83], v[80:81], v[80:81], v[92:93] op_sel:[0,0,0] op_sel_hi:[0,1,1] neg_lo:[0,0,1]
    v_pk_mul_f32 v[94:95], v[72:73], v[72:73] op_sel:[1,1] op_sel_hi:[0,1]
    v_pk_fma_f32 v[74:75], v[72:73], v[72:73], v[94:95] op_sel:[0,0,0] op_sel_hi:[0,1,1] neg_lo:[0,0,1]
    v_pk_mul_f32 v[92:93], v[82:83], v[82:83] op_sel:[1,1] op_sel_hi:[0,1]
    v_pk_fma_f32 v[84:85], v[82:83], v[82:83], v[92:93] op_sel:[0,0,0] op_sel_hi:[0,1,1] neg_lo:[0,0,1]
    v_pk_mul_f32 v[94:95], v[66:67], v[76:77] op_sel:[1,1] op_sel_hi:[1,0]
    v_pk_fma_f32 v[86:87], v[66:67], v[76:77], v[94:95] op_sel:[0,0,0] op_sel_hi:[0,1,1] neg_lo:[0,0,1] neg_hi:[1,0,1]
    v_mov_b32_dpp v80, v78 row_ror:8 row_mask:0xf bank_mask:0x3
    v_mov_b32_dpp v81, v79 row_ror:8 row_mask:0xf bank_mask:0x3
    v_mov_b32_dpp v82, v84 row_ror:8 row_mask:0xf bank_mask:0x3
    v_mov_b32_dpp v83, v85 row_ror:8 row_mask:0xf bank_mask:0x3
    v_pk_mul_f32 v[92:93], v[66:67], v[80:81] op_sel:[1,1] op_sel_hi:[1,0]
    v_pk_fma_f32 v[88:89], v[66:67], v[80:81], v[92:93] op_sel:[0,0,0] op_sel_hi:[0,1,1] neg_lo:[0,0,1] neg_hi:[1,0,1]
    v_pk_mul_f32 v[94:95], v[66:67], v[82:83] op_sel:[1,1] op_sel_hi:[1,0]
    v_pk_fma_f32 v[90:91], v[66:67], v[82:83], v[94:95] op_sel:[0,0,0] op_sel_hi:[0,1,1] neg_lo:[0,0,1] neg_hi:[1,0,1]
    v_mfma_f32_16x16x4_f32 v[48:51], v86, v68, v[48:51]
    v_mfma_f32_16x16x4_f32 v[52:55], v88, v70, v[52:55]
    v_mfma_f32_16x16x4_f32 v[56:59], v88, v72, v[56:59]
    v_mfma_f32_16x16x4_f32 v[60:63], v90, v74, v[60:63]
    v_mfma_f32_16x16x4_f32 v[48:51], v87, v69, v[48:51]
    v_mfma_f32_16x16x4_f32 v[52:55], v89, v71, v[52:55]
    v_mfma_f32_16x16x4_f32 v[56:59], v89, v73, v[56:59]
    v_mfma_f32_16x16x4_f32 v[60:63], v91, v75, v[60:63]
    v_mov_b64_dpp v[64:65], v[28:29] row_newbcast:3 row_mask:0xf bank_mask:0xf
    v_mov_b64_dpp v[66:67], v[30:31] row_newbcast:3 row_mask:0xf bank_mask:0xf
    v_pk_mul_f32 v[94:95], v[64:65], v[26:27] op_sel_hi:[1,0]
    v_pk_mul_f32 v[96:97], v[64:65], v[26:27] op_sel:[0,1] op_sel_hi:[1,1]
    v_fract_f32 v95, v95
    v_fract_f32 v97, v97
    v_exp_f32 v94, v94
    v_exp_f32 v96, v96
    v_cos_f32 v68, v95
    v_sin_f32 v69, v95
    v_cos_f32 v76, v97
    v_sin_f32 v77, v97
    v_pk_mul_f32 v[68:69], v[68:69], v[94:95] op_sel_hi:[1,0]
    v_pk_mul_f32 v[76:77], v[76:77], v[96:97] op_sel_hi:[1,0]
    v_pk_mul_f32 v[92:93], v[76:77], v[76:77] op_sel:[1,1] op_sel_hi:[0,1]
    v_pk_fma_f32 v[78:79], v[76:77], v[76:77], v[92:93] op_sel:[0,0,0] op_sel_hi:[0,1,1] neg_lo:[0,0,1]
    v_pk_mul_f32 v[94:95], v[68:69], v[68:69] op_sel:[1,1] op_sel_hi:[0,1]
    v_pk_fma_f32 v[70:71], v[68:69], v[68:69], v[94:95] op_sel:[0,0,0] op_sel_hi:[0,1,1] neg_lo:[0,0,1]
    v_pk_mul_f32 v[92:93], v[78:79], v[78:79] op_sel:[1,1] op_sel_hi:[0,1]
    v_pk_fma_f32 v[80:81], v[78:79], v[78:79], v[92:93] op_sel:[0,0,0] op_sel_hi:[0,1,1] neg_lo:[0,0,1]
    v_pk_mul_f32 v[94:95], v[70:71], v[70:71] op_sel:[1,1] op_sel_hi:[0,1]
    v_pk_fma_f32 v[72:73], v[70:71], v[70:71], v[94:95] op_sel:[0,0,0] op_sel_hi:[0,1,1] neg_lo:[0,0,1]
    v_pk_mul_f32 v[92:93], v[80:81], v[80:81] op_sel:[1,1] op_sel_hi:[0,1]
    v_pk_fma_f32 v[82:83], v[80:81], v[80:81], v[92:93] op_sel:[0,0,0] op_sel_hi:[0,1,1] neg_lo:[0,0,1]
    v_pk_mul_f32 v[94:95], v[72:73], v[72:73] op_sel:[1,1] op_sel_hi:[0,1]
    v_pk_fma_f32 v[74:75], v[72:73], v[72:73], v[94:95] op_sel:[0,0,0] op_sel_hi:[0,1,1] neg_lo:[0,0,1]
    v_pk_mul_f32 v[92:93], v[82:83], v[82:83] op_sel:[1,1] op_sel_hi:[0,1]
    v_pk_fma_f32 v[84:85], v[82:83], v[82:83], v[92:93] op_sel:[0,0,0] op_sel_hi:[0,1,1] neg_lo:[0,0,1]
    v_pk_mul_f32 v[94:95], v[66:67], v[76:77] op_sel:[1,1] op_sel_hi:[1,0]
    v_pk_fma_f32 v[86:87], v[66:67], v[76:77], v[94:95] op_sel:[0,0,0] op_sel_hi:[0,1,1] neg_lo:[0,0,1] neg_hi:[1,0,1]
    v_mov_b32_dpp v80, v78 row_ror:8 row_mask:0xf bank_mask:0x3
    v_mov_b32_dpp v81, v79 row_ror:8 row_mask:0xf bank_mask:0x3
    v_mov_b32_dpp v82, v84 row_ror:8 row_mask:0xf bank_mask:0x3
    v_mov_b32_dpp v83, v85 row_ror:8 row_mask:0xf bank_mask:0x3
    v_pk_mul_f32 v[92:93], v[66:67], v[80:81] op_sel:[1,1] op_sel_hi:[1,0]
    v_pk_fma_f32 v[88:89], v[66:67], v[80:81], v[92:93] op_sel:[0,0,0] op_sel_hi:[0,1,1] neg_lo:[0,0,1] neg_hi:[1,0,1]
    v_pk_mul_f32 v[94:95], v[66:67], v[82:83] op_sel:[1,1] op_sel_hi:[1,0]
    v_pk_fma_f32 v[90:91], v[66:67], v[82:83], v[94:95] op_sel:[0,0,0] op_sel_hi:[0,1,1] neg_lo:[0,0,1] neg_hi:[1,0,1]
    v_mfma_f32_16x16x4_f32 v[48:51], v86, v68, v[48:51]
    v_mfma_f32_16x16x4_f32 v[52:55], v88, v70, v[52:55]
    v_mfma_f32_16x16x4_f32 v[56:59], v88, v72, v[56:59]
    v_mfma_f32_16x16x4_f32 v[60:63], v90, v74, v[60:63]
    v_mfma_f32_16x16x4_f32 v[48:51], v87, v69, v[48:51]
    v_mfma_f32_16x16x4_f32 v[52:55], v89, v71, v[52:55]
    v_mfma_f32_16x16x4_f32 v[56:59], v89, v73, v[56:59]
    v_mfma_f32_16x16x4_f32 v[60:63], v91, v75, v[60:63]
    v_mov_b64_dpp v[64:65], v[28:29] row_newbcast:4 row_mask:0xf bank_mask:0xf
    v_mov_b64_dpp v[66:67], v[30:31] row_newbcast:4 row_mask:0xf bank_mask:0xf
    v_pk_mul_f32 v[94:95], v[64:65], v[26:27] op_sel_hi:[1,0]
    v_pk_mul_f32 v[96:97], v[64:65], v[26:27] op_sel:[0,1] op_sel_hi:[1,1]
    v_fract_f32 v95, v95
    v_fract_f32 v97, v97
    v_exp_f32 v94, v94
    v_exp_f32 v96, v96
    v_cos_f32 v68, v95
    v_sin_f32 v69, v95
    v_cos_f32 v76, v97
    v_sin_f32 v77, v97
    v_pk_mul_f32 v[68:69], v[68:69], v[94:95] op_sel_hi:[1,0]
    v_pk_mul_f32 v[76:77], v[76:77], v[96:97] op_sel_hi:[1,0]
    v_pk_mul_f32 v[92:93], v[76:77], v[76:77] op_sel:[1,1] op_sel_hi:[0,1]
    v_pk_fma_f32 v[78:79], v[76:77], v[76:77], v[92:93] op_sel:[0,0,0] op_sel_hi:[0,1,1] neg_lo:[0,0,1]
    v_pk_mul_f32 v[94:95], v[68:69], v[68:69] op_sel:[1,1] op_sel_hi:[0,1]
    v_pk_fma_f32 v[70:71], v[68:69], v[68:69], v[94:95] op_sel:[0,0,0] op_sel_hi:[0,1,1] neg_lo:[0,0,1]
    v_pk_mul_f32 v[92:93], v[78:79], v[78:79] op_sel:[1,1] op_sel_hi:[0,1]
    v_pk_fma_f32 v[80:81], v[78:79], v[78:79], v[92:93] op_sel:[0,0,0] op_sel_hi:[0,1,1] neg_lo:[0,0,1]
    v_pk_mul_f32 v[94:95], v[70:71], v[70:71] op_sel:[1,1] op_sel_hi:[0,1]
    v_pk_fma_f32 v[72:73], v[70:71], v[70:71], v[94:95] op_sel:[0,0,0] op_sel_hi:[0,1,1] neg_lo:[0,0,1]
    v_pk_mul_f32 v[92:93], v[80:81], v[80:81] op_sel:[1,1] op_sel_hi:[0,1]
    v_pk_fma_f32 v[82:83], v[80:81], v[80:81], v[92:93] op_sel:[0,0,0] op_sel_hi:[0,1,1] neg_lo:[0,0,1]
    v_pk_mul_f32 v[94:95], v[72:73], v[72:73] op_sel:[1,1] op_sel_hi:[0,1]
    v_pk_fma_f32 v[74:75], v[72:73], v[72:73], v[94:95] op_sel:[0,0,0] op_sel_hi:[0,1,1] neg_lo:[0,0,1]
    v_pk_mul_f32 v[92:93], v[82:83], v[82:83] op_sel:[1,1] op_sel_hi:[0,1]
    v_pk_fma_f32 v[84:85], v[82:83], v[82:83], v[92:93] op_sel:[0,0,0] op_sel_hi:[0,1,1] neg_lo:[0,0,1]
    v_pk_mul_f32 v[94:95], v[66:67], v[76:77] op_sel:[1,1] op_sel_hi:[1,0]
    v_pk_fma_f32 v[86:87], v[66:67], v[76:77], v[94:95] op_sel:[0,0,0] op_sel_hi:[0,1,1] neg_lo:[0,0,1] neg_hi:[1,0,1]
    v_mov_b32_dpp v80, v78 row_ror:8 row_mask:0xf bank_mask:0x3
    v_mov_b32_dpp v81, v79 row_ror:8 row_mask:0xf bank_mask:0x3
    v_mov_b32_dpp v82, v84 row_ror:8 row_mask:0xf bank_mask:0x3
    v_mov_b32_dpp v83, v85 row_ror:8 row_mask:0xf bank_mask:0x3
    v_pk_mul_f32 v[92:93], v[66:67], v[80:81] op_sel:[1,1] op_sel_hi:[1,0]
    v_pk_fma_f32 v[88:89], v[66:67], v[80:81], v[92:93] op_sel:[0,0,0] op_sel_hi:[0,1,1] neg_lo:[0,0,1] neg_hi:[1,0,1]
    v_pk_mul_f32 v[94:95], v[66:67], v[82:83] op_sel:[1,1] op_sel_hi:[1,0]
    v_pk_fma_f32 v[90:91], v[66:67], v[82:83], v[94:95] op_sel:[0,0,0] op_sel_hi:[0,1,1] neg_lo:[0,0,1] neg_hi:[1,0,1]
    v_mfma_f32_16x16x4_f32 v[48:51], v86, v68, v[48:51]
    v_mfma_f32_16x16x4_f32 v[52:55], v88, v70, v[52:55]
    v_mfma_f32_16x16x4_f32 v[56:59], v88, v72, v[56:59]
    v_mfma_f32_16x16x4_f32 v[60:63], v90, v74, v[60:63]
    v_mfma_f32_16x16x4_f32 v[48:51], v87, v69, v[48:51]
    v_mfma_f32_16x16x4_f32 v[52:55], v89, v71, v[52:55]
    v_mfma_f32_16x16x4_f32 v[56:59], v89, v73, v[56:59]
    v_mfma_f32_16x16x4_f32 v[60:63], v91, v75, v[60:63]
    v_mov_b64_dpp v[64:65], v[28:29] row_newbcast:5 row_mask:0xf bank_mask:0xf
    v_mov_b64_dpp v[66:67], v[30:31] row_newbcast:5 row_mask:0xf bank_mask:0xf
    v_pk_mul_f32 v[94:95], v[64:65], v[26:27] op_sel_hi:[1,0]
    v_pk_mul_f32 v[96:97], v[64:65], v[26:27] op_sel:[0,1] op_sel_hi:[1,1]
    v_fract_f32 v95, v95
    v_fract_f32 v97, v97
    v_exp_f32 v94, v94
    v_exp_f32 v96, v96
    v_cos_f32 v68, v95
    v_sin_f32 v69, v95
    v_cos_f32 v76, v97
    v_sin_f32 v77, v97
    v_pk_mul_f32 v[68:69], v[68:69], v[94:95] op_sel_hi:[1,0]
    v_pk_mul_f32 v[76:77], v[76:77], v[96:97] op_sel_hi:[1,0]
    v_pk_mul_f32 v[92:93], v[76:77], v[76:77] op_sel:[1,1] op_sel_hi:[0,1]
    v_pk_fma_f32 v[78:79], v[76:77], v[76:77], v[92:93] op_sel:[0,0,0] op_sel_hi:[0,1,1] neg_lo:[0,0,1]
    v_pk_mul_f32 v[94:95], v[68:69], v[68:69] op_sel:[1,1] op_sel_hi:[0,1]
    v_pk_fma_f32 v[70:71], v[68:69], v[68:69], v[94:95] op_sel:[0,0,0] op_sel_hi:[0,1,1] neg_lo:[0,0,1]
    v_pk_mul_f32 v[92:93], v[78:79], v[78:79] op_sel:[1,1] op_sel_hi:[0,1]
    v_pk_fma_f32 v[80:81], v[78:79], v[78:79], v[92:93] op_sel:[0,0,0] op_sel_hi:[0,1,1] neg_lo:[0,0,1]
    v_pk_mul_f32 v[94:95], v[70:71], v[70:71] op_sel:[1,1] op_sel_hi:[0,1]
    v_pk_fma_f32 v[72:73], v[70:71], v[70:71], v[94:95] op_sel:[0,0,0] op_sel_hi:[0,1,1] neg_lo:[0,0,1]
    v_pk_mul_f32 v[92:93], v[80:81], v[80:81] op_sel:[1,1] op_sel_hi:[0,1]
    v_pk_fma_f32 v[82:83], v[80:81], v[80:81], v[92:93] op_sel:[0,0,0] op_sel_hi:[0,1,1] neg_lo:[0,0,1]
    v_pk_mul_f32 v[94:95], v[72:73], v[72:73] op_sel:[1,1] op_sel_hi:[0,1]
    v_pk_fma_f32 v[74:75], v[72:73], v[72:73], v[94:95] op_sel:[0,0,0] op_sel_hi:[0,1,1] neg_lo:[0,0,1]
    v_pk_mul_f32 v[92:93], v[82:83], v[82:83] op_sel:[1,1] op_sel_hi:[0,1]
    v_pk_fma_f32 v[84:85], v[82:83], v[82:83], v[92:93] op_sel:[0,0,0] op_sel_hi:[0,1,1] neg_lo:[0,0,1]
    v_pk_mul_f32 v[94:95], v[66:67], v[76:77] op_sel:[1,1] op_sel_hi:[1,0]
    v_pk_fma_f32 v[86:87], v[66:67], v[76:77], v[94:95] op_sel:[0,0,0] op_sel_hi:[0,1,1] neg_lo:[0,0,1] neg_hi:[1,0,1]
    v_mov_b32_dpp v80, v78 row_ror:8 row_mask:0xf bank_mask:0x3
    v_mov_b32_dpp v81, v79 row_ror:8 row_mask:0xf bank_mask:0x3
    v_mov_b32_dpp v82, v84 row_ror:8 row_mask:0xf bank_mask:0x3
    v_mov_b32_dpp v83, v85 row_ror:8 row_mask:0xf bank_mask:0x3
    v_pk_mul_f32 v[92:93], v[66:67], v[80:81] op_sel:[1,1] op_sel_hi:[1,0]
    v_pk_fma_f32 v[88:89], v[66:67], v[80:81], v[92:93] op_sel:[0,0,0] op_sel_hi:[0,1,1] neg_lo:[0,0,1] neg_hi:[1,0,1]
    v_pk_mul_f32 v[94:95], v[66:67], v[82:83] op_sel:[1,1] op_sel_hi:[1,0]
    v_pk_fma_f32 v[90:91], v[66:67], v[82:83], v[94:95] op_sel:[0,0,0] op_sel_hi:[0,1,1] neg_lo:[0,0,1] neg_hi:[1,0,1]
    v_mfma_f32_16x16x4_f32 v[48:51], v86, v68, v[48:51]
    v_mfma_f32_16x16x4_f32 v[52:55], v88, v70, v[52:55]
    v_mfma_f32_16x16x4_f32 v[56:59], v88, v72, v[56:59]
    v_mfma_f32_16x16x4_f32 v[60:63], v90, v74, v[60:63]
    v_mfma_f32_16x16x4_f32 v[48:51], v87, v69, v[48:51]
    v_mfma_f32_16x16x4_f32 v[52:55], v89, v71, v[52:55]
    v_mfma_f32_16x16x4_f32 v[56:59], v89, v73, v[56:59]
    v_mfma_f32_16x16x4_f32 v[60:63], v91, v75, v[60:63]
    v_mov_b64_dpp v[64:65], v[28:29] row_newbcast:6 row_mask:0xf bank_mask:0xf
    v_mov_b64_dpp v[66:67], v[30:31] row_newbcast:6 row_mask:0xf bank_mask:0xf
    v_pk_mul_f32 v[94:95], v[64:65], v[26:27] op_sel_hi:[1,0]
    v_pk_mul_f32 v[96:97], v[64:65], v[26:27] op_sel:[0,1] op_sel_hi:[1,1]
    v_fract_f32 v95, v95
    v_fract_f32 v97, v97
    v_exp_f32 v94, v94
    v_exp_f32 v96, v96
    v_cos_f32 v68, v95
    v_sin_f32 v69, v95
    v_cos_f32 v76, v97
    v_sin_f32 v77, v97
    v_pk_mul_f32 v[68:69], v[68:69], v[94:95] op_sel_hi:[1,0]
    v_pk_mul_f32 v[76:77], v[76:77], v[96:97] op_sel_hi:[1,0]
    v_pk_mul_f32 v[92:93], v[76:77], v[76:77] op_sel:[1,1] op_sel_hi:[0,1]
    v_pk_fma_f32 v[78:79], v[76:77], v[76:77], v[92:93] op_sel:[0,0,0] op_sel_hi:[0,1,1] neg_lo:[0,0,1]
    v_pk_mul_f32 v[94:95], v[68:69], v[68:69] op_sel:[1,1] op_sel_hi:[0,1]
    v_pk_fma_f32 v[70:71], v[68:69], v[68:69], v[94:95] op_sel:[0,0,0] op_sel_hi:[0,1,1] neg_lo:[0,0,1]
    v_pk_mul_f32 v[92:93], v[78:79], v[78:79] op_sel:[1,1] op_sel_hi:[0,1]
    v_pk_fma_f32 v[80:81], v[78:79], v[78:79], v[92:93] op_sel:[0,0,0] op_sel_hi:[0,1,1] neg_lo:[0,0,1]
    v_pk_mul_f32 v[94:95], v[70:71], v[70:71] op_sel:[1,1] op_sel_hi:[0,1]
    v_pk_fma_f32 v[72:73], v[70:71], v[70:71], v[94:95] op_sel:[0,0,0] op_sel_hi:[0,1,1] neg_lo:[0,0,1]
    v_pk_mul_f32 v[92:93], v[80:81], v[80:81] op_sel:[1,1] op_sel_hi:[0,1]
    v_pk_fma_f32 v[82:83], v[80:81], v[80:81], v[92:93] op_sel:[0,0,0] op_sel_hi:[0,1,1] neg_lo:[0,0,1]
    v_pk_mul_f32 v[94:95], v[72:73], v[72:73] op_sel:[1,1] op_sel_hi:[0,1]
    v_pk_fma_f32 v[74:75], v[72:73], v[72:73], v[94:95] op_sel:[0,0,0] op_sel_hi:[0,1,1] neg_lo:[0,0,1]
    v_pk_mul_f32 v[92:93], v[82:83], v[82:83] op_sel:[1,1] op_sel_hi:[0,1]
    v_pk_fma_f32 v[84:85], v[82:83], v[82:83], v[92:93] op_sel:[0,0,0] op_sel_hi:[0,1,1] neg_lo:[0,0,1]
    v_pk_mul_f32 v[94:95], v[66:67], v[76:77] op_sel:[1,1] op_sel_hi:[1,0]
    v_pk_fma_f32 v[86:87], v[66:67], v[76:77], v[94:95] op_sel:[0,0,0] op_sel_hi:[0,1,1] neg_lo:[0,0,1] neg_hi:[1,0,1]
    v_mov_b32_dpp v80, v78 row_ror:8 row_mask:0xf bank_mask:0x3
    v_mov_b32_dpp v81, v79 row_ror:8 row_mask:0xf bank_mask:0x3
    v_mov_b32_dpp v82, v84 row_ror:8 row_mask:0xf bank_mask:0x3
    v_mov_b32_dpp v83, v85 row_ror:8 row_mask:0xf bank_mask:0x3
    v_pk_mul_f32 v[92:93], v[66:67], v[80:81] op_sel:[1,1] op_sel_hi:[1,0]
    v_pk_fma_f32 v[88:89], v[66:67], v[80:81], v[92:93] op_sel:[0,0,0] op_sel_hi:[0,1,1] neg_lo:[0,0,1] neg_hi:[1,0,1]
    v_pk_mul_f32 v[94:95], v[66:67], v[82:83] op_sel:[1,1] op_sel_hi:[1,0]
    v_pk_fma_f32 v[90:91], v[66:67], v[82:83], v[94:95] op_sel:[0,0,0] op_sel_hi:[0,1,1] neg_lo:[0,0,1] neg_hi:[1,0,1]
    v_mfma_f32_16x16x4_f32 v[48:51], v86, v68, v[48:51]
    v_mfma_f32_16x16x4_f32 v[52:55], v88, v70, v[52:55]
    v_mfma_f32_16x16x4_f32 v[56:59], v88, v72, v[56:59]
    v_mfma_f32_16x16x4_f32 v[60:63], v90, v74, v[60:63]
    v_mfma_f32_16x16x4_f32 v[48:51], v87, v69, v[48:51]
    v_mfma_f32_16x16x4_f32 v[52:55], v89, v71, v[52:55]
    v_mfma_f32_16x16x4_f32 v[56:59], v89, v73, v[56:59]
    v_mfma_f32_16x16x4_f32 v[60:63], v91, v75, v[60:63]
    v_mov_b64_dpp v[64:65], v[28:29] row_newbcast:7 row_mask:0xf bank_mask:0xf
    v_mov_b64_dpp v[66:67], v[30:31] row_newbcast:7 row_mask:0xf bank_mask:0xf
    v_pk_mul_f32 v[94:95], v[64:65], v[26:27] op_sel_hi:[1,0]
    v_pk_mul_f32 v[96:97], v[64:65], v[26:27] op_sel:[0,1] op_sel_hi:[1,1]
    v_fract_f32 v95, v95
    v_fract_f32 v97, v97
    v_exp_f32 v94, v94
    v_exp_f32 v96, v96
    v_cos_f32 v68, v95
    v_sin_f32 v69, v95
    v_cos_f32 v76, v97
    v_sin_f32 v77, v97
    v_pk_mul_f32 v[68:69], v[68:69], v[94:95] op_sel_hi:[1,0]
    v_pk_mul_f32 v[76:77], v[76:77], v[96:97] op_sel_hi:[1,0]
    v_pk_mul_f32 v[92:93], v[76:77], v[76:77] op_sel:[1,1] op_sel_hi:[0,1]
    v_pk_fma_f32 v[78:79], v[76:77], v[76:77], v[92:93] op_sel:[0,0,0] op_sel_hi:[0,1,1] neg_lo:[0,0,1]
    v_pk_mul_f32 v[94:95], v[68:69], v[68:69] op_sel:[1,1] op_sel_hi:[0,1]
    v_pk_fma_f32 v[70:71], v[68:69], v[68:69], v[94:95] op_sel:[0,0,0] op_sel_hi:[0,1,1] neg_lo:[0,0,1]
    v_pk_mul_f32 v[92:93], v[78:79], v[78:79] op_sel:[1,1] op_sel_hi:[0,1]
    v_pk_fma_f32 v[80:81], v[78:79], v[78:79], v[92:93] op_sel:[0,0,0] op_sel_hi:[0,1,1] neg_lo:[0,0,1]
    v_pk_mul_f32 v[94:95], v[70:71], v[70:71] op_sel:[1,1] op_sel_hi:[0,1]
    v_pk_fma_f32 v[72:73], v[70:71], v[70:71], v[94:95] op_sel:[0,0,0] op_sel_hi:[0,1,1] neg_lo:[0,0,1]
    v_pk_mul_f32 v[92:93], v[80:81], v[80:81] op_sel:[1,1] op_sel_hi:[0,1]
    v_pk_fma_f32 v[82:83], v[80:81], v[80:81], v[92:93] op_sel:[0,0,0] op_sel_hi:[0,1,1] neg_lo:[0,0,1]
    v_pk_mul_f32 v[94:95], v[72:73], v[72:73] op_sel:[1,1] op_sel_hi:[0,1]
    v_pk_fma_f32 v[74:75], v[72:73], v[72:73], v[94:95] op_sel:[0,0,0] op_sel_hi:[0,1,1] neg_lo:[0,0,1]
    v_pk_mul_f32 v[92:93], v[82:83], v[82:83] op_sel:[1,1] op_sel_hi:[0,1]
    v_pk_fma_f32 v[84:85], v[82:83], v[82:83], v[92:93] op_sel:[0,0,0] op_sel_hi:[0,1,1] neg_lo:[0,0,1]
    v_pk_mul_f32 v[94:95], v[66:67], v[76:77] op_sel:[1,1] op_sel_hi:[1,0]
    v_pk_fma_f32 v[86:87], v[66:67], v[76:77], v[94:95] op_sel:[0,0,0] op_sel_hi:[0,1,1] neg_lo:[0,0,1] neg_hi:[1,0,1]
    v_mov_b32_dpp v80, v78 row_ror:8 row_mask:0xf bank_mask:0x3
    v_mov_b32_dpp v81, v79 row_ror:8 row_mask:0xf bank_mask:0x3
    v_mov_b32_dpp v82, v84 row_ror:8 row_mask:0xf bank_mask:0x3
    v_mov_b32_dpp v83, v85 row_ror:8 row_mask:0xf bank_mask:0x3
    v_pk_mul_f32 v[92:93], v[66:67], v[80:81] op_sel:[1,1] op_sel_hi:[1,0]
    v_pk_fma_f32 v[88:89], v[66:67], v[80:81], v[92:93] op_sel:[0,0,0] op_sel_hi:[0,1,1] neg_lo:[0,0,1] neg_hi:[1,0,1]
    v_pk_mul_f32 v[94:95], v[66:67], v[82:83] op_sel:[1,1] op_sel_hi:[1,0]
    v_pk_fma_f32 v[90:91], v[66:67], v[82:83], v[94:95] op_sel:[0,0,0] op_sel_hi:[0,1,1] neg_lo:[0,0,1] neg_hi:[1,0,1]
    v_mfma_f32_16x16x4_f32 v[48:51], v86, v68, v[48:51]
    v_mfma_f32_16x16x4_f32 v[52:55], v88, v70, v[52:55]
    v_mfma_f32_16x16x4_f32 v[56:59], v88, v72, v[56:59]
    v_mfma_f32_16x16x4_f32 v[60:63], v90, v74, v[60:63]
    v_mfma_f32_16x16x4_f32 v[48:51], v87, v69, v[48:51]
    v_mfma_f32_16x16x4_f32 v[52:55], v89, v71, v[52:55]
    v_mfma_f32_16x16x4_f32 v[56:59], v89, v73, v[56:59]
    v_mfma_f32_16x16x4_f32 v[60:63], v91, v75, v[60:63]
    v_mov_b64_dpp v[64:65], v[28:29] row_newbcast:8 row_mask:0xf bank_mask:0xf
    v_mov_b64_dpp v[66:67], v[30:31] row_newbcast:8 row_mask:0xf bank_mask:0xf
    v_pk_mul_f32 v[94:95], v[64:65], v[26:27] op_sel_hi:[1,0]
    v_pk_mul_f32 v[96:97], v[64:65], v[26:27] op_sel:[0,1] op_sel_hi:[1,1]
    v_fract_f32 v95, v95
    v_fract_f32 v97, v97
    v_exp_f32 v94, v94
    v_exp_f32 v96, v96
    v_cos_f32 v68, v95
    v_sin_f32 v69, v95
    v_cos_f32 v76, v97
    v_sin_f32 v77, v97
    v_pk_mul_f32 v[68:69], v[68:69], v[94:95] op_sel_hi:[1,0]
    v_pk_mul_f32 v[76:77], v[76:77], v[96:97] op_sel_hi:[1,0]
    v_pk_mul_f32 v[92:93], v[76:77], v[76:77] op_sel:[1,1] op_sel_hi:[0,1]
    v_pk_fma_f32 v[78:79], v[76:77], v[76:77], v[92:93] op_sel:[0,0,0] op_sel_hi:[0,1,1] neg_lo:[0,0,1]
    v_pk_mul_f32 v[94:95], v[68:69], v[68:69] op_sel:[1,1] op_sel_hi:[0,1]
    v_pk_fma_f32 v[70:71], v[68:69], v[68:69], v[94:95] op_sel:[0,0,0] op_sel_hi:[0,1,1] neg_lo:[0,0,1]
    v_pk_mul_f32 v[92:93], v[78:79], v[78:79] op_sel:[1,1] op_sel_hi:[0,1]
    v_pk_fma_f32 v[80:81], v[78:79], v[78:79], v[92:93] op_sel:[0,0,0] op_sel_hi:[0,1,1] neg_lo:[0,0,1]
    v_pk_mul_f32 v[94:95], v[70:71], v[70:71] op_sel:[1,1] op_sel_hi:[0,1]
    v_pk_fma_f32 v[72:73], v[70:71], v[70:71], v[94:95] op_sel:[0,0,0] op_sel_hi:[0,1,1] neg_lo:[0,0,1]
    v_pk_mul_f32 v[92:93], v[80:81], v[80:81] op_sel:[1,1] op_sel_hi:[0,1]
    v_pk_fma_f32 v[82:83], v[80:81], v[80:81], v[92:93] op_sel:[0,0,0] op_sel_hi:[0,1,1] neg_lo:[0,0,1]
    v_pk_mul_f32 v[94:95], v[72:73], v[72:73] op_sel:[1,1] op_sel_hi:[0,1]
    v_pk_fma_f32 v[74:75], v[72:73], v[72:73], v[94:95] op_sel:[0,0,0] op_sel_hi:[0,1,1] neg_lo:[0,0,1]
    v_pk_mul_f32 v[92:93], v[82:83], v[82:83] op_sel:[1,1] op_sel_hi:[0,1]
    v_pk_fma_f32 v[84:85], v[82:83], v[82:83], v[92:93] op_sel:[0,0,0] op_sel_hi:[0,1,1] neg_lo:[0,0,1]
    v_pk_mul_f32 v[94:95], v[66:67], v[76:77] op_sel:[1,1] op_sel_hi:[1,0]
    v_pk_fma_f32 v[86:87], v[66:67], v[76:77], v[94:95] op_sel:[0,0,0] op_sel_hi:[0,1,1] neg_lo:[0,0,1] neg_hi:[1,0,1]
    v_mov_b32_dpp v80, v78 row_ror:8 row_mask:0xf bank_mask:0x3
    v_mov_b32_dpp v81, v79 row_ror:8 row_mask:0xf bank_mask:0x3
    v_mov_b32_dpp v82, v84 row_ror:8 row_mask:0xf bank_mask:0x3
    v_mov_b32_dpp v83, v85 row_ror:8 row_mask:0xf bank_mask:0x3
    v_pk_mul_f32 v[92:93], v[66:67], v[80:81] op_sel:[1,1] op_sel_hi:[1,0]
    v_pk_fma_f32 v[88:89], v[66:67], v[80:81], v[92:93] op_sel:[0,0,0] op_sel_hi:[0,1,1] neg_lo:[0,0,1] neg_hi:[1,0,1]
    v_pk_mul_f32 v[94:95], v[66:67], v[82:83] op_sel:[1,1] op_sel_hi:[1,0]
    v_pk_fma_f32 v[90:91], v[66:67], v[82:83], v[94:95] op_sel:[0,0,0] op_sel_hi:[0,1,1] neg_lo:[0,0,1] neg_hi:[1,0,1]
    v_mfma_f32_16x16x4_f32 v[48:51], v86, v68, v[48:51]
    v_mfma_f32_16x16x4_f32 v[52:55], v88, v70, v[52:55]
    v_mfma_f32_16x16x4_f32 v[56:59], v88, v72, v[56:59]
    v_mfma_f32_16x16x4_f32 v[60:63], v90, v74, v[60:63]
    v_mfma_f32_16x16x4_f32 v[48:51], v87, v69, v[48:51]
    v_mfma_f32_16x16x4_f32 v[52:55], v89, v71, v[52:55]
    v_mfma_f32_16x16x4_f32 v[56:59], v89, v73, v[56:59]
    v_mfma_f32_16x16x4_f32 v[60:63], v91, v75, v[60:63]
    v_mov_b64_dpp v[64:65], v[28:29] row_newbcast:9 row_mask:0xf bank_mask:0xf
    v_mov_b64_dpp v[66:67], v[30:31] row_newbcast:9 row_mask:0xf bank_mask:0xf
    v_pk_mul_f32 v[94:95], v[64:65], v[26:27] op_sel_hi:[1,0]
    v_pk_mul_f32 v[96:97], v[64:65], v[26:27] op_sel:[0,1] op_sel_hi:[1,1]
    v_fract_f32 v95, v95
    v_fract_f32 v97, v97
    v_exp_f32 v94, v94
    v_exp_f32 v96, v96
    v_cos_f32 v68, v95
    v_sin_f32 v69, v95
    v_cos_f32 v76, v97
    v_sin_f32 v77, v97
    v_pk_mul_f32 v[68:69], v[68:69], v[94:95] op_sel_hi:[1,0]
    v_pk_mul_f32 v[76:77], v[76:77], v[96:97] op_sel_hi:[1,0]
    v_pk_mul_f32 v[92:93], v[76:77], v[76:77] op_sel:[1,1] op_sel_hi:[0,1]
    v_pk_fma_f32 v[78:79], v[76:77], v[76:77], v[92:93] op_sel:[0,0,0] op_sel_hi:[0,1,1] neg_lo:[0,0,1]
    v_pk_mul_f32 v[94:95], v[68:69], v[68:69] op_sel:[1,1] op_sel_hi:[0,1]
    v_pk_fma_f32 v[70:71], v[68:69], v[68:69], v[94:95] op_sel:[0,0,0] op_sel_hi:[0,1,1] neg_lo:[0,0,1]
    v_pk_mul_f32 v[92:93], v[78:79], v[78:79] op_sel:[1,1] op_sel_hi:[0,1]
    v_pk_fma_f32 v[80:81], v[78:79], v[78:79], v[92:93] op_sel:[0,0,0] op_sel_hi:[0,1,1] neg_lo:[0,0,1]
    v_pk_mul_f32 v[94:95], v[70:71], v[70:71] op_sel:[1,1] op_sel_hi:[0,1]
    v_pk_fma_f32 v[72:73], v[70:71], v[70:71], v[94:95] op_sel:[0,0,0] op_sel_hi:[0,1,1] neg_lo:[0,0,1]
    v_pk_mul_f32 v[92:93], v[80:81], v[80:81] op_sel:[1,1] op_sel_hi:[0,1]
    v_pk_fma_f32 v[82:83], v[80:81], v[80:81], v[92:93] op_sel:[0,0,0] op_sel_hi:[0,1,1] neg_lo:[0,0,1]
    v_pk_mul_f32 v[94:95], v[72:73], v[72:73] op_sel:[1,1] op_sel_hi:[0,1]
    v_pk_fma_f32 v[74:75], v[72:73], v[72:73], v[94:95] op_sel:[0,0,0] op_sel_hi:[0,1,1] neg_lo:[0,0,1]
    v_pk_mul_f32 v[92:93], v[82:83], v[82:83] op_sel:[1,1] op_sel_hi:[0,1]
    v_pk_fma_f32 v[84:85], v[82:83], v[82:83], v[92:93] op_sel:[0,0,0] op_sel_hi:[0,1,1] neg_lo:[0,0,1]
    v_pk_mul_f32 v[94:95], v[66:67], v[76:77] op_sel:[1,1] op_sel_hi:[1,0]
    v_pk_fma_f32 v[86:87], v[66:67], v[76:77], v[94:95] op_sel:[0,0,0] op_sel_hi:[0,1,1] neg_lo:[0,0,1] neg_hi:[1,0,1]
    v_mov_b32_dpp v80, v78 row_ror:8 row_mask:0xf bank_mask:0x3
    v_mov_b32_dpp v81, v79 row_ror:8 row_mask:0xf bank_mask:0x3
    v_mov_b32_dpp v82, v84 row_ror:8 row_mask:0xf bank_mask:0x3
    v_mov_b32_dpp v83, v85 row_ror:8 row_mask:0xf bank_mask:0x3
    v_pk_mul_f32 v[92:93], v[66:67], v[80:81] op_sel:[1,1] op_sel_hi:[1,0]
    v_pk_fma_f32 v[88:89], v[66:67], v[80:81], v[92:93] op_sel:[0,0,0] op_sel_hi:[0,1,1] neg_lo:[0,0,1] neg_hi:[1,0,1]
    v_pk_mul_f32 v[94:95], v[66:67], v[82:83] op_sel:[1,1] op_sel_hi:[1,0]
    v_pk_fma_f32 v[90:91], v[66:67], v[82:83], v[94:95] op_sel:[0,0,0] op_sel_hi:[0,1,1] neg_lo:[0,0,1] neg_hi:[1,0,1]
    v_mfma_f32_16x16x4_f32 v[48:51], v86, v68, v[48:51]
    v_mfma_f32_16x16x4_f32 v[52:55], v88, v70, v[52:55]
    v_mfma_f32_16x16x4_f32 v[56:59], v88, v72, v[56:59]
    v_mfma_f32_16x16x4_f32 v[60:63], v90, v74, v[60:63]
    v_mfma_f32_16x16x4_f32 v[48:51], v87, v69, v[48:51]
    v_mfma_f32_16x16x4_f32 v[52:55], v89, v71, v[52:55]
    v_mfma_f32_16x16x4_f32 v[56:59], v89, v73, v[56:59]
    v_mfma_f32_16x16x4_f32 v[60:63], v91, v75, v[60:63]
    v_mov_b64_dpp v[64:65], v[28:29] row_newbcast:10 row_mask:0xf bank_mask:0xf
    v_mov_b64_dpp v[66:67], v[30:31] row_newbcast:10 row_mask:0xf bank_mask:0xf
    v_pk_mul_f32 v[94:95], v[64:65], v[26:27] op_sel_hi:[1,0]
    v_pk_mul_f32 v[96:97], v[64:65], v[26:27] op_sel:[0,1] op_sel_hi:[1,1]
    v_fract_f32 v95, v95
    v_fract_f32 v97, v97
    v_exp_f32 v94, v94
    v_exp_f32 v96, v96
    v_cos_f32 v68, v95
    v_sin_f32 v69, v95
    v_cos_f32 v76, v97
    v_sin_f32 v77, v97
    v_pk_mul_f32 v[68:69], v[68:69], v[94:95] op_sel_hi:[1,0]
    v_pk_mul_f32 v[76:77], v[76:77], v[96:97] op_sel_hi:[1,0]
    v_pk_mul_f32 v[92:93], v[76:77], v[76:77] op_sel:[1,1] op_sel_hi:[0,1]
    v_pk_fma_f32 v[78:79], v[76:77], v[76:77], v[92:93] op_sel:[0,0,0] op_sel_hi:[0,1,1] neg_lo:[0,0,1]
    v_pk_mul_f32 v[94:95], v[68:69], v[68:69] op_sel:[1,1] op_sel_hi:[0,1]
    v_pk_fma_f32 v[70:71], v[68:69], v[68:69], v[94:95] op_sel:[0,0,0] op_sel_hi:[0,1,1] neg_lo:[0,0,1]
    v_pk_mul_f32 v[92:93], v[78:79], v[78:79] op_sel:[1,1] op_sel_hi:[0,1]
    v_pk_fma_f32 v[80:81], v[78:79], v[78:79], v[92:93] op_sel:[0,0,0] op_sel_hi:[0,1,1] neg_lo:[0,0,1]
    v_pk_mul_f32 v[94:95], v[70:71], v[70:71] op_sel:[1,1] op_sel_hi:[0,1]
    v_pk_fma_f32 v[72:73], v[70:71], v[70:71], v[94:95] op_sel:[0,0,0] op_sel_hi:[0,1,1] neg_lo:[0,0,1]
    v_pk_mul_f32 v[92:93], v[80:81], v[80:81] op_sel:[1,1] op_sel_hi:[0,1]
    v_pk_fma_f32 v[82:83], v[80:81], v[80:81], v[92:93] op_sel:[0,0,0] op_sel_hi:[0,1,1] neg_lo:[0,0,1]
    v_pk_mul_f32 v[94:95], v[72:73], v[72:73] op_sel:[1,1] op_sel_hi:[0,1]
    v_pk_fma_f32 v[74:75], v[72:73], v[72:73], v[94:95] op_sel:[0,0,0] op_sel_hi:[0,1,1] neg_lo:[0,0,1]
    v_pk_mul_f32 v[92:93], v[82:83], v[82:83] op_sel:[1,1] op_sel_hi:[0,1]
    v_pk_fma_f32 v[84:85], v[82:83], v[82:83], v[92:93] op_sel:[0,0,0] op_sel_hi:[0,1,1] neg_lo:[0,0,1]
    v_pk_mul_f32 v[94:95], v[66:67], v[76:77] op_sel:[1,1] op_sel_hi:[1,0]
    v_pk_fma_f32 v[86:87], v[66:67], v[76:77], v[94:95] op_sel:[0,0,0] op_sel_hi:[0,1,1] neg_lo:[0,0,1] neg_hi:[1,0,1]
    v_mov_b32_dpp v80, v78 row_ror:8 row_mask:0xf bank_mask:0x3
    v_mov_b32_dpp v81, v79 row_ror:8 row_mask:0xf bank_mask:0x3
    v_mov_b32_dpp v82, v84 row_ror:8 row_mask:0xf bank_mask:0x3
    v_mov_b32_dpp v83, v85 row_ror:8 row_mask:0xf bank_mask:0x3
    v_pk_mul_f32 v[92:93], v[66:67], v[80:81] op_sel:[1,1] op_sel_hi:[1,0]
    v_pk_fma_f32 v[88:89], v[66:67], v[80:81], v[92:93] op_sel:[0,0,0] op_sel_hi:[0,1,1] neg_lo:[0,0,1] neg_hi:[1,0,1]
    v_pk_mul_f32 v[94:95], v[66:67], v[82:83] op_sel:[1,1] op_sel_hi:[1,0]
    v_pk_fma_f32 v[90:91], v[66:67], v[82:83], v[94:95] op_sel:[0,0,0] op_sel_hi:[0,1,1] neg_lo:[0,0,1] neg_hi:[1,0,1]
    v_mfma_f32_16x16x4_f32 v[48:51], v86, v68, v[48:51]
    v_mfma_f32_16x16x4_f32 v[52:55], v88, v70, v[52:55]
    v_mfma_f32_16x16x4_f32 v[56:59], v88, v72, v[56:59]
    v_mfma_f32_16x16x4_f32 v[60:63], v90, v74, v[60:63]
    v_mfma_f32_16x16x4_f32 v[48:51], v87, v69, v[48:51]
    v_mfma_f32_16x16x4_f32 v[52:55], v89, v71, v[52:55]
    v_mfma_f32_16x16x4_f32 v[56:59], v89, v73, v[56:59]
    v_mfma_f32_16x16x4_f32 v[60:63], v91, v75, v[60:63]
    v_mov_b64_dpp v[64:65], v[28:29] row_newbcast:11 row_mask:0xf bank_mask:0xf
    v_mov_b64_dpp v[66:67], v[30:31] row_newbcast:11 row_mask:0xf bank_mask:0xf
    v_pk_mul_f32 v[94:95], v[64:65], v[26:27] op_sel_hi:[1,0]
    v_pk_mul_f32 v[96:97], v[64:65], v[26:27] op_sel:[0,1] op_sel_hi:[1,1]
    v_fract_f32 v95, v95
    v_fract_f32 v97, v97
    v_exp_f32 v94, v94
    v_exp_f32 v96, v96
    v_cos_f32 v68, v95
    v_sin_f32 v69, v95
    v_cos_f32 v76, v97
    v_sin_f32 v77, v97
    v_pk_mul_f32 v[68:69], v[68:69], v[94:95] op_sel_hi:[1,0]
    v_pk_mul_f32 v[76:77], v[76:77], v[96:97] op_sel_hi:[1,0]
    v_pk_mul_f32 v[92:93], v[76:77], v[76:77] op_sel:[1,1] op_sel_hi:[0,1]
    v_pk_fma_f32 v[78:79], v[76:77], v[76:77], v[92:93] op_sel:[0,0,0] op_sel_hi:[0,1,1] neg_lo:[0,0,1]
    v_pk_mul_f32 v[94:95], v[68:69], v[68:69] op_sel:[1,1] op_sel_hi:[0,1]
    v_pk_fma_f32 v[70:71], v[68:69], v[68:69], v[94:95] op_sel:[0,0,0] op_sel_hi:[0,1,1] neg_lo:[0,0,1]
    v_pk_mul_f32 v[92:93], v[78:79], v[78:79] op_sel:[1,1] op_sel_hi:[0,1]
    v_pk_fma_f32 v[80:81], v[78:79], v[78:79], v[92:93] op_sel:[0,0,0] op_sel_hi:[0,1,1] neg_lo:[0,0,1]
    v_pk_mul_f32 v[94:95], v[70:71], v[70:71] op_sel:[1,1] op_sel_hi:[0,1]
    v_pk_fma_f32 v[72:73], v[70:71], v[70:71], v[94:95] op_sel:[0,0,0] op_sel_hi:[0,1,1] neg_lo:[0,0,1]
    v_pk_mul_f32 v[92:93], v[80:81], v[80:81] op_sel:[1,1] op_sel_hi:[0,1]
    v_pk_fma_f32 v[82:83], v[80:81], v[80:81], v[92:93] op_sel:[0,0,0] op_sel_hi:[0,1,1] neg_lo:[0,0,1]
    v_pk_mul_f32 v[94:95], v[72:73], v[72:73] op_sel:[1,1] op_sel_hi:[0,1]
    v_pk_fma_f32 v[74:75], v[72:73], v[72:73], v[94:95] op_sel:[0,0,0] op_sel_hi:[0,1,1] neg_lo:[0,0,1]
    v_pk_mul_f32 v[92:93], v[82:83], v[82:83] op_sel:[1,1] op_sel_hi:[0,1]
    v_pk_fma_f32 v[84:85], v[82:83], v[82:83], v[92:93] op_sel:[0,0,0] op_sel_hi:[0,1,1] neg_lo:[0,0,1]
    v_pk_mul_f32 v[94:95], v[66:67], v[76:77] op_sel:[1,1] op_sel_hi:[1,0]
    v_pk_fma_f32 v[86:87], v[66:67], v[76:77], v[94:95] op_sel:[0,0,0] op_sel_hi:[0,1,1] neg_lo:[0,0,1] neg_hi:[1,0,1]
    v_mov_b32_dpp v80, v78 row_ror:8 row_mask:0xf bank_mask:0x3
    v_mov_b32_dpp v81, v79 row_ror:8 row_mask:0xf bank_mask:0x3
    v_mov_b32_dpp v82, v84 row_ror:8 row_mask:0xf bank_mask:0x3
    v_mov_b32_dpp v83, v85 row_ror:8 row_mask:0xf bank_mask:0x3
    v_pk_mul_f32 v[92:93], v[66:67], v[80:81] op_sel:[1,1] op_sel_hi:[1,0]
    v_pk_fma_f32 v[88:89], v[66:67], v[80:81], v[92:93] op_sel:[0,0,0] op_sel_hi:[0,1,1] neg_lo:[0,0,1] neg_hi:[1,0,1]
    v_pk_mul_f32 v[94:95], v[66:67], v[82:83] op_sel:[1,1] op_sel_hi:[1,0]
    v_pk_fma_f32 v[90:91], v[66:67], v[82:83], v[94:95] op_sel:[0,0,0] op_sel_hi:[0,1,1] neg_lo:[0,0,1] neg_hi:[1,0,1]
    v_mfma_f32_16x16x4_f32 v[48:51], v86, v68, v[48:51]
    v_mfma_f32_16x16x4_f32 v[52:55], v88, v70, v[52:55]
    v_mfma_f32_16x16x4_f32 v[56:59], v88, v72, v[56:59]
    v_mfma_f32_16x16x4_f32 v[60:63], v90, v74, v[60:63]
    v_mfma_f32_16x16x4_f32 v[48:51], v87, v69, v[48:51]
    v_mfma_f32_16x16x4_f32 v[52:55], v89, v71, v[52:55]
    v_mfma_f32_16x16x4_f32 v[56:59], v89, v73, v[56:59]
    v_mfma_f32_16x16x4_f32 v[60:63], v91, v75, v[60:63]
    v_mov_b64_dpp v[64:65], v[28:29] row_newbcast:12 row_mask:0xf bank_mask:0xf
    v_mov_b64_dpp v[66:67], v[30:31] row_newbcast:12 row_mask:0xf bank_mask:0xf
    v_pk_mul_f32 v[94:95], v[64:65], v[26:27] op_sel_hi:[1,0]
    v_pk_mul_f32 v[96:97], v[64:65], v[26:27] op_sel:[0,1] op_sel_hi:[1,1]
    v_fract_f32 v95, v95
    v_fract_f32 v97, v97
    v_exp_f32 v94, v94
    v_exp_f32 v96, v96
    v_cos_f32 v68, v95
    v_sin_f32 v69, v95
    v_cos_f32 v76, v97
    v_sin_f32 v77, v97
    v_pk_mul_f32 v[68:69], v[68:69], v[94:95] op_sel_hi:[1,0]
    v_pk_mul_f32 v[76:77], v[76:77], v[96:97] op_sel_hi:[1,0]
    v_pk_mul_f32 v[92:93], v[76:77], v[76:77] op_sel:[1,1] op_sel_hi:[0,1]
    v_pk_fma_f32 v[78:79], v[76:77], v[76:77], v[92:93] op_sel:[0,0,0] op_sel_hi:[0,1,1] neg_lo:[0,0,1]
    v_pk_mul_f32 v[94:95], v[68:69], v[68:69] op_sel:[1,1] op_sel_hi:[0,1]
    v_pk_fma_f32 v[70:71], v[68:69], v[68:69], v[94:95] op_sel:[0,0,0] op_sel_hi:[0,1,1] neg_lo:[0,0,1]
    v_pk_mul_f32 v[92:93], v[78:79], v[78:79] op_sel:[1,1] op_sel_hi:[0,1]
    v_pk_fma_f32 v[80:81], v[78:79], v[78:79], v[92:93] op_sel:[0,0,0] op_sel_hi:[0,1,1] neg_lo:[0,0,1]
    v_pk_mul_f32 v[94:95], v[70:71], v[70:71] op_sel:[1,1] op_sel_hi:[0,1]
    v_pk_fma_f32 v[72:73], v[70:71], v[70:71], v[94:95] op_sel:[0,0,0] op_sel_hi:[0,1,1] neg_lo:[0,0,1]
    v_pk_mul_f32 v[92:93], v[80:81], v[80:81] op_sel:[1,1] op_sel_hi:[0,1]
    v_pk_fma_f32 v[82:83], v[80:81], v[80:81], v[92:93] op_sel:[0,0,0] op_sel_hi:[0,1,1] neg_lo:[0,0,1]
    v_pk_mul_f32 v[94:95], v[72:73], v[72:73] op_sel:[1,1] op_sel_hi:[0,1]
    v_pk_fma_f32 v[74:75], v[72:73], v[72:73], v[94:95] op_sel:[0,0,0] op_sel_hi:[0,1,1] neg_lo:[0,0,1]
    v_pk_mul_f32 v[92:93], v[82:83], v[82:83] op_sel:[1,1] op_sel_hi:[0,1]
    v_pk_fma_f32 v[84:85], v[82:83], v[82:83], v[92:93] op_sel:[0,0,0] op_sel_hi:[0,1,1] neg_lo:[0,0,1]
    v_pk_mul_f32 v[94:95], v[66:67], v[76:77] op_sel:[1,1] op_sel_hi:[1,0]
    v_pk_fma_f32 v[86:87], v[66:67], v[76:77], v[94:95] op_sel:[0,0,0] op_sel_hi:[0,1,1] neg_lo:[0,0,1] neg_hi:[1,0,1]
    v_mov_b32_dpp v80, v78 row_ror:8 row_mask:0xf bank_mask:0x3
    v_mov_b32_dpp v81, v79 row_ror:8 row_mask:0xf bank_mask:0x3
    v_mov_b32_dpp v82, v84 row_ror:8 row_mask:0xf bank_mask:0x3
    v_mov_b32_dpp v83, v85 row_ror:8 row_mask:0xf bank_mask:0x3
    v_pk_mul_f32 v[92:93], v[66:67], v[80:81] op_sel:[1,1] op_sel_hi:[1,0]
    v_pk_fma_f32 v[88:89], v[66:67], v[80:81], v[92:93] op_sel:[0,0,0] op_sel_hi:[0,1,1] neg_lo:[0,0,1] neg_hi:[1,0,1]
    v_pk_mul_f32 v[94:95], v[66:67], v[82:83] op_sel:[1,1] op_sel_hi:[1,0]
    v_pk_fma_f32 v[90:91], v[66:67], v[82:83], v[94:95] op_sel:[0,0,0] op_sel_hi:[0,1,1] neg_lo:[0,0,1] neg_hi:[1,0,1]
    v_mfma_f32_16x16x4_f32 v[48:51], v86, v68, v[48:51]
    v_mfma_f32_16x16x4_f32 v[52:55], v88, v70, v[52:55]
    v_mfma_f32_16x16x4_f32 v[56:59], v88, v72, v[56:59]
    v_mfma_f32_16x16x4_f32 v[60:63], v90, v74, v[60:63]
    v_mfma_f32_16x16x4_f32 v[48:51], v87, v69, v[48:51]
    v_mfma_f32_16x16x4_f32 v[52:55], v89, v71, v[52:55]
    v_mfma_f32_16x16x4_f32 v[56:59], v89, v73, v[56:59]
    v_mfma_f32_16x16x4_f32 v[60:63], v91, v75, v[60:63]
    v_mov_b64_dpp v[64:65], v[28:29] row_newbcast:13 row_mask:0xf bank_mask:0xf
    v_mov_b64_dpp v[66:67], v[30:31] row_newbcast:13 row_mask:0xf bank_mask:0xf
    v_pk_mul_f32 v[94:95], v[64:65], v[26:27] op_sel_hi:[1,0]
    v_pk_mul_f32 v[96:97], v[64:65], v[26:27] op_sel:[0,1] op_sel_hi:[1,1]
    v_fract_f32 v95, v95
    v_fract_f32 v97, v97
    v_exp_f32 v94, v94
    v_exp_f32 v96, v96
    v_cos_f32 v68, v95
    v_sin_f32 v69, v95
    v_cos_f32 v76, v97
    v_sin_f32 v77, v97
    v_pk_mul_f32 v[68:69], v[68:69], v[94:95] op_sel_hi:[1,0]
    v_pk_mul_f32 v[76:77], v[76:77], v[96:97] op_sel_hi:[1,0]
    v_pk_mul_f32 v[92:93], v[76:77], v[76:77] op_sel:[1,1] op_sel_hi:[0,1]
    v_pk_fma_f32 v[78:79], v[76:77], v[76:77], v[92:93] op_sel:[0,0,0] op_sel_hi:[0,1,1] neg_lo:[0,0,1]
    v_pk_mul_f32 v[94:95], v[68:69], v[68:69] op_sel:[1,1] op_sel_hi:[0,1]
    v_pk_fma_f32 v[70:71], v[68:69], v[68:69], v[94:95] op_sel:[0,0,0] op_sel_hi:[0,1,1] neg_lo:[0,0,1]
    v_pk_mul_f32 v[92:93], v[78:79], v[78:79] op_sel:[1,1] op_sel_hi:[0,1]
    v_pk_fma_f32 v[80:81], v[78:79], v[78:79], v[92:93] op_sel:[0,0,0] op_sel_hi:[0,1,1] neg_lo:[0,0,1]
    v_pk_mul_f32 v[94:95], v[70:71], v[70:71] op_sel:[1,1] op_sel_hi:[0,1]
    v_pk_fma_f32 v[72:73], v[70:71], v[70:71], v[94:95] op_sel:[0,0,0] op_sel_hi:[0,1,1] neg_lo:[0,0,1]
    v_pk_mul_f32 v[92:93], v[80:81], v[80:81] op_sel:[1,1] op_sel_hi:[0,1]
    v_pk_fma_f32 v[82:83], v[80:81], v[80:81], v[92:93] op_sel:[0,0,0] op_sel_hi:[0,1,1] neg_lo:[0,0,1]
    v_pk_mul_f32 v[94:95], v[72:73], v[72:73] op_sel:[1,1] op_sel_hi:[0,1]
    v_pk_fma_f32 v[74:75], v[72:73], v[72:73], v[94:95] op_sel:[0,0,0] op_sel_hi:[0,1,1] neg_lo:[0,0,1]
    v_pk_mul_f32 v[92:93], v[82:83], v[82:83] op_sel:[1,1] op_sel_hi:[0,1]
    v_pk_fma_f32 v[84:85], v[82:83], v[82:83], v[92:93] op_sel:[0,0,0] op_sel_hi:[0,1,1] neg_lo:[0,0,1]
    v_pk_mul_f32 v[94:95], v[66:67], v[76:77] op_sel:[1,1] op_sel_hi:[1,0]
    v_pk_fma_f32 v[86:87], v[66:67], v[76:77], v[94:95] op_sel:[0,0,0] op_sel_hi:[0,1,1] neg_lo:[0,0,1] neg_hi:[1,0,1]
    v_mov_b32_dpp v80, v78 row_ror:8 row_mask:0xf bank_mask:0x3
    v_mov_b32_dpp v81, v79 row_ror:8 row_mask:0xf bank_mask:0x3
    v_mov_b32_dpp v82, v84 row_ror:8 row_mask:0xf bank_mask:0x3
    v_mov_b32_dpp v83, v85 row_ror:8 row_mask:0xf bank_mask:0x3
    v_pk_mul_f32 v[92:93], v[66:67], v[80:81] op_sel:[1,1] op_sel_hi:[1,0]
    v_pk_fma_f32 v[88:89], v[66:67], v[80:81], v[92:93] op_sel:[0,0,0] op_sel_hi:[0,1,1] neg_lo:[0,0,1] neg_hi:[1,0,1]
    v_pk_mul_f32 v[94:95], v[66:67], v[82:83] op_sel:[1,1] op_sel_hi:[1,0]
    v_pk_fma_f32 v[90:91], v[66:67], v[82:83], v[94:95] op_sel:[0,0,0] op_sel_hi:[0,1,1] neg_lo:[0,0,1] neg_hi:[1,0,1]
    v_mfma_f32_16x16x4_f32 v[48:51], v86, v68, v[48:51]
    v_mfma_f32_16x16x4_f32 v[52:55], v88, v70, v[52:55]
    v_mfma_f32_16x16x4_f32 v[56:59], v88, v72, v[56:59]
    v_mfma_f32_16x16x4_f32 v[60:63], v90, v74, v[60:63]
    v_mfma_f32_16x16x4_f32 v[48:51], v87, v69, v[48:51]
    v_mfma_f32_16x16x4_f32 v[52:55], v89, v71, v[52:55]
    v_mfma_f32_16x16x4_f32 v[56:59], v89, v73, v[56:59]
    v_mfma_f32_16x16x4_f32 v[60:63], v91, v75, v[60:63]
    v_mov_b64_dpp v[64:65], v[28:29] row_newbcast:14 row_mask:0xf bank_mask:0xf
    v_mov_b64_dpp v[66:67], v[30:31] row_newbcast:14 row_mask:0xf bank_mask:0xf
    v_pk_mul_f32 v[94:95], v[64:65], v[26:27] op_sel_hi:[1,0]
    v_pk_mul_f32 v[96:97], v[64:65], v[26:27] op_sel:[0,1] op_sel_hi:[1,1]
    v_fract_f32 v95, v95
    v_fract_f32 v97, v97
    v_exp_f32 v94, v94
    v_exp_f32 v96, v96
    v_cos_f32 v68, v95
    v_sin_f32 v69, v95
    v_cos_f32 v76, v97
    v_sin_f32 v77, v97
    v_pk_mul_f32 v[68:69], v[68:69], v[94:95] op_sel_hi:[1,0]
    v_pk_mul_f32 v[76:77], v[76:77], v[96:97] op_sel_hi:[1,0]
    v_pk_mul_f32 v[92:93], v[76:77], v[76:77] op_sel:[1,1] op_sel_hi:[0,1]
    v_pk_fma_f32 v[78:79], v[76:77], v[76:77], v[92:93] op_sel:[0,0,0] op_sel_hi:[0,1,1] neg_lo:[0,0,1]
    v_pk_mul_f32 v[94:95], v[68:69], v[68:69] op_sel:[1,1] op_sel_hi:[0,1]
    v_pk_fma_f32 v[70:71], v[68:69], v[68:69], v[94:95] op_sel:[0,0,0] op_sel_hi:[0,1,1] neg_lo:[0,0,1]
    v_pk_mul_f32 v[92:93], v[78:79], v[78:79] op_sel:[1,1] op_sel_hi:[0,1]
    v_pk_fma_f32 v[80:81], v[78:79], v[78:79], v[92:93] op_sel:[0,0,0] op_sel_hi:[0,1,1] neg_lo:[0,0,1]
    v_pk_mul_f32 v[94:95], v[70:71], v[70:71] op_sel:[1,1] op_sel_hi:[0,1]
    v_pk_fma_f32 v[72:73], v[70:71], v[70:71], v[94:95] op_sel:[0,0,0] op_sel_hi:[0,1,1] neg_lo:[0,0,1]
    v_pk_mul_f32 v[92:93], v[80:81], v[80:81] op_sel:[1,1] op_sel_hi:[0,1]
    v_pk_fma_f32 v[82:83], v[80:81], v[80:81], v[92:93] op_sel:[0,0,0] op_sel_hi:[0,1,1] neg_lo:[0,0,1]
    v_pk_mul_f32 v[94:95], v[72:73], v[72:73] op_sel:[1,1] op_sel_hi:[0,1]
    v_pk_fma_f32 v[74:75], v[72:73], v[72:73], v[94:95] op_sel:[0,0,0] op_sel_hi:[0,1,1] neg_lo:[0,0,1]
    v_pk_mul_f32 v[92:93], v[82:83], v[82:83] op_sel:[1,1] op_sel_hi:[0,1]
    v_pk_fma_f32 v[84:85], v[82:83], v[82:83], v[92:93] op_sel:[0,0,0] op_sel_hi:[0,1,1] neg_lo:[0,0,1]
    v_pk_mul_f32 v[94:95], v[66:67], v[76:77] op_sel:[1,1] op_sel_hi:[1,0]
    v_pk_fma_f32 v[86:87], v[66:67], v[76:77], v[94:95] op_sel:[0,0,0] op_sel_hi:[0,1,1] neg_lo:[0,0,1] neg_hi:[1,0,1]
    v_mov_b32_dpp v80, v78 row_ror:8 row_mask:0xf bank_mask:0x3
    v_mov_b32_dpp v81, v79 row_ror:8 row_mask:0xf bank_mask:0x3
    v_mov_b32_dpp v82, v84 row_ror:8 row_mask:0xf bank_mask:0x3
    v_mov_b32_dpp v83, v85 row_ror:8 row_mask:0xf bank_mask:0x3
    v_pk_mul_f32 v[92:93], v[66:67], v[80:81] op_sel:[1,1] op_sel_hi:[1,0]
    v_pk_fma_f32 v[88:89], v[66:67], v[80:81], v[92:93] op_sel:[0,0,0] op_sel_hi:[0,1,1] neg_lo:[0,0,1] neg_hi:[1,0,1]
    v_pk_mul_f32 v[94:95], v[66:67], v[82:83] op_sel:[1,1] op_sel_hi:[1,0]
    v_pk_fma_f32 v[90:91], v[66:67], v[82:83], v[94:95] op_sel:[0,0,0] op_sel_hi:[0,1,1] neg_lo:[0,0,1] neg_hi:[1,0,1]
    v_mfma_f32_16x16x4_f32 v[48:51], v86, v68, v[48:51]
    v_mfma_f32_16x16x4_f32 v[52:55], v88, v70, v[52:55]
    v_mfma_f32_16x16x4_f32 v[56:59], v88, v72, v[56:59]
    v_mfma_f32_16x16x4_f32 v[60:63], v90, v74, v[60:63]
    v_mfma_f32_16x16x4_f32 v[48:51], v87, v69, v[48:51]
    v_mfma_f32_16x16x4_f32 v[52:55], v89, v71, v[52:55]
    v_mfma_f32_16x16x4_f32 v[56:59], v89, v73, v[56:59]
    v_mfma_f32_16x16x4_f32 v[60:63], v91, v75, v[60:63]
    v_mov_b64_dpp v[64:65], v[28:29] row_newbcast:15 row_mask:0xf bank_mask:0xf
    v_mov_b64_dpp v[66:67], v[30:31] row_newbcast:15 row_mask:0xf bank_mask:0xf
    v_pk_mul_f32 v[94:95], v[64:65], v[26:27] op_sel_hi:[1,0]
    v_pk_mul_f32 v[96:97], v[64:65], v[26:27] op_sel:[0,1] op_sel_hi:[1,1]
    v_fract_f32 v95, v95
    v_fract_f32 v97, v97
    v_exp_f32 v94, v94
    v_exp_f32 v96, v96
    v_cos_f32 v68, v95
    v_sin_f32 v69, v95
    v_cos_f32 v76, v97
    v_sin_f32 v77, v97
    v_pk_mul_f32 v[68:69], v[68:69], v[94:95] op_sel_hi:[1,0]
    v_pk_mul_f32 v[76:77], v[76:77], v[96:97] op_sel_hi:[1,0]
    v_pk_mul_f32 v[92:93], v[76:77], v[76:77] op_sel:[1,1] op_sel_hi:[0,1]
    v_pk_fma_f32 v[78:79], v[76:77], v[76:77], v[92:93] op_sel:[0,0,0] op_sel_hi:[0,1,1] neg_lo:[0,0,1]
    v_pk_mul_f32 v[94:95], v[68:69], v[68:69] op_sel:[1,1] op_sel_hi:[0,1]
    v_pk_fma_f32 v[70:71], v[68:69], v[68:69], v[94:95] op_sel:[0,0,0] op_sel_hi:[0,1,1] neg_lo:[0,0,1]
    v_pk_mul_f32 v[92:93], v[78:79], v[78:79] op_sel:[1,1] op_sel_hi:[0,1]
    v_pk_fma_f32 v[80:81], v[78:79], v[78:79], v[92:93] op_sel:[0,0,0] op_sel_hi:[0,1,1] neg_lo:[0,0,1]
    v_pk_mul_f32 v[94:95], v[70:71], v[70:71] op_sel:[1,1] op_sel_hi:[0,1]
    v_pk_fma_f32 v[72:73], v[70:71], v[70:71], v[94:95] op_sel:[0,0,0] op_sel_hi:[0,1,1] neg_lo:[0,0,1]
    v_pk_mul_f32 v[92:93], v[80:81], v[80:81] op_sel:[1,1] op_sel_hi:[0,1]
    v_pk_fma_f32 v[82:83], v[80:81], v[80:81], v[92:93] op_sel:[0,0,0] op_sel_hi:[0,1,1] neg_lo:[0,0,1]
    v_pk_mul_f32 v[94:95], v[72:73], v[72:73] op_sel:[1,1] op_sel_hi:[0,1]
    v_pk_fma_f32 v[74:75], v[72:73], v[72:73], v[94:95] op_sel:[0,0,0] op_sel_hi:[0,1,1] neg_lo:[0,0,1]
    v_pk_mul_f32 v[92:93], v[82:83], v[82:83] op_sel:[1,1] op_sel_hi:[0,1]
    v_pk_fma_f32 v[84:85], v[82:83], v[82:83], v[92:93] op_sel:[0,0,0] op_sel_hi:[0,1,1] neg_lo:[0,0,1]
    v_pk_mul_f32 v[94:95], v[66:67], v[76:77] op_sel:[1,1] op_sel_hi:[1,0]
    v_pk_fma_f32 v[86:87], v[66:67], v[76:77], v[94:95] op_sel:[0,0,0] op_sel_hi:[0,1,1] neg_lo:[0,0,1] neg_hi:[1,0,1]
    v_mov_b32_dpp v80, v78 row_ror:8 row_mask:0xf bank_mask:0x3
    v_mov_b32_dpp v81, v79 row_ror:8 row_mask:0xf bank_mask:0x3
    v_mov_b32_dpp v82, v84 row_ror:8 row_mask:0xf bank_mask:0x3
    v_mov_b32_dpp v83, v85 row_ror:8 row_mask:0xf bank_mask:0x3
    v_pk_mul_f32 v[92:93], v[66:67], v[80:81] op_sel:[1,1] op_sel_hi:[1,0]
    v_pk_fma_f32 v[88:89], v[66:67], v[80:81], v[92:93] op_sel:[0,0,0] op_sel_hi:[0,1,1] neg_lo:[0,0,1] neg_hi:[1,0,1]
    v_pk_mul_f32 v[94:95], v[66:67], v[82:83] op_sel:[1,1] op_sel_hi:[1,0]
    v_pk_fma_f32 v[90:91], v[66:67], v[82:83], v[94:95] op_sel:[0,0,0] op_sel_hi:[0,1,1] neg_lo:[0,0,1] neg_hi:[1,0,1]
    v_mfma_f32_16x16x4_f32 v[48:51], v86, v68, v[48:51]
    v_mfma_f32_16x16x4_f32 v[52:55], v88, v70, v[52:55]
    v_mfma_f32_16x16x4_f32 v[56:59], v88, v72, v[56:59]
    v_mfma_f32_16x16x4_f32 v[60:63], v90, v74, v[60:63]
    v_mfma_f32_16x16x4_f32 v[48:51], v87, v69, v[48:51]
    v_mfma_f32_16x16x4_f32 v[52:55], v89, v71, v[52:55]
    v_mfma_f32_16x16x4_f32 v[56:59], v89, v73, v[56:59]
    v_mfma_f32_16x16x4_f32 v[60:63], v91, v75, v[60:63]
    v_mov_b64 v[28:29], v[32:33]
    v_mov_b64 v[30:31], v[34:35]
    s_add_u32 s25, s25, 1
    s_cmp_lt_u32 s25, 2
    s_cbranch_scc1 ss_kg
    s_cmp_lg_u32 s28, 0
    s_cbranch_scc1 ss_nostage
    s_waitcnt vmcnt(0)
    v_mov_b32 v36, 0x05040100
    v_mov_b32 v37, 0x07060302
    v_lshlrev_b32 v6, 4, v0
    v_add_u32 v7, 65536, v6
    v_perm_b32 v40, v212, v208, v36
    v_perm_b32 v41, v220, v216, v36
    v_perm_b32 v42, v228, v224, v36
    v_perm_b32 v43, v236, v232, v36
    ds_write_b128 v6, v[40:43] offset:512
    v_perm_b32 v44, v212, v208, v37
    v_perm_b32 v45, v220, v216, v37
    v_perm_b32 v46, v228, v224, v37
    v_perm_b32 v47, v236, v232, v37
    ds_write_b128 v6, v[44:47] offset:16896
    v_perm_b32 v40, v213, v209, v36
    v_perm_b32 v41, v221, v217, v36
    v_perm_b32 v42, v229, v225, v36
    v_perm_b32 v43, v237, v233, v36
    ds_write_b128 v6, v[40:43] offset:33280
    v_perm_b32 v44, v213, v209, v37
    v_perm_b32 v45, v221, v217, v37
    v_perm_b32 v46, v229, v225, v37
    v_perm_b32 v47, v237, v233, v37
    ds_write_b128 v6, v[44:47] offset:49664
    v_perm_b32 v40, v214, v210, v36
    v_perm_b32 v41, v222, v218, v36
    v_perm_b32 v42, v230, v226, v36
    v_perm_b32 v43, v238, v234, v36
    ds_write_b128 v7, v[40:43] offset:512
    v_perm_b32 v44, v214, v210, v37
    v_perm_b32 v45, v222, v218, v37
    v_perm_b32 v46, v230, v226, v37
    v_perm_b32 v47, v238, v234, v37
    ds_write_b128 v7, v[44:47] offset:16896
    v_perm_b32 v40, v215, v211, v36
    v_perm_b32 v41, v223, v219, v36
    v_perm_b32 v42, v231, v227, v36
    v_perm_b32 v43, v239, v235, v36
    ds_write_b128 v7, v[40:43] offset:33280
    v_perm_b32 v44, v215, v211, v37
    v_perm_b32 v45, v223, v219, v37
    v_perm_b32 v46, v231, v227, v37
    v_perm_b32 v47, v239, v235, v37
    ds_write_b128 v7, v[44:47] offset:49664
ss_nostage:
    s_nop 11
    v_lshlrev_b32 v5, 8, v3
    v_lshl_add_u32 v5, v2, 2, v5
    v_add_u32 v5, v5, v4
    ds_write_b32 v5, v48 offset:4608
    ds_write_b32 v5, v49 offset:4672
    ds_write_b32 v5, v50 offset:4736
    ds_write_b32 v5, v51 offset:4800
    s_mov_b32 exec_hi, 0
    ds_write_b32 v5, v52 offset:5632
    ds_write_b32 v5, v53 offset:5696
    ds_write_b32 v5, v54 offset:5760
    ds_write_b32 v5, v55 offset:5824
    s_not_b64 exec, exec
    ds_write_b32 v5, v56 offset:5632
    ds_write_b32 v5, v57 offset:5696
    ds_write_b32 v5, v58 offset:5760
    ds_write_b32 v5, v59 offset:5824
    ds_write_b32 v5, v60 offset:6144
    ds_write_b32 v5, v61 offset:6208
    ds_write_b32 v5, v62 offset:6272
    ds_write_b32 v5, v63 offset:6336
    s_mov_b64 exec, 3
    v_cmp_eq_u32 vcc, 0, v2
    s_nop 1
    v_cndmask_b32 v6, 0, v60, vcc
    ds_write_b32 v5, v6 offset:7168
    s_mov_b64 exec, -1
    s_waitcnt lgkmcnt(0)
    v_lshlrev_b32 v7, 1, v1
    v_sub_u32 v7, 2065, v7
    v_lshl_add_u32 v64, v1, 2, v4
    v_mov_b32 v65, 641
    s_mov_b32 s25, 9
    s_mov_b32 s22, 256
    s_mov_b32 s23, 2048
ss_exp:
    v_subrev_u32 v66, 0, v7
    v_cvt_f32_u32 v72, v66
    v_cmp_gt_u32 vcc, s22, v66
    v_cvt_pk_bf16_f32 v72, v72, 0
    v_subrev_u32 v72, 0x4280, v72
    v_cndmask_b32 v72, v72, v66, vcc
    v_cmp_gt_u32 vcc, s23, v66
    s_nop 1
    v_cndmask_b32 v72, v65, v72, vcc
    v_lshl_add_u32 v72, v72, 2, v4
    v_subrev_u32 v67, 1, v7
    v_cvt_f32_u32 v73, v67
    v_cmp_gt_u32 vcc, s22, v67
    v_cvt_pk_bf16_f32 v73, v73, 0
    v_subrev_u32 v73, 0x4280, v73
    v_cndmask_b32 v73, v73, v67, vcc
    v_cmp_gt_u32 vcc, s23, v67
    ds_read_b32 v78, v72 offset:4608
    s_nop 0
    v_cndmask_b32 v73, v65, v73, vcc
    v_lshl_add_u32 v73, v73, 2, v4
    v_subrev_u32 v68, 2, v7
    v_cvt_f32_u32 v74, v68
    v_cmp_gt_u32 vcc, s22, v68
    v_cvt_pk_bf16_f32 v74, v74, 0
    v_subrev_u32 v74, 0x4280, v74
    v_cndmask_b32 v74, v74, v68, vcc
    v_cmp_gt_u32 vcc, s23, v68
    ds_read_b32 v79, v73 offset:4608
    s_nop 0
    v_cndmask_b32 v74, v65, v74, vcc
    v_lshl_add_u32 v74, v74, 2, v4
    v_subrev_u32 v69, 128, v7
    v_cvt_f32_u32 v75, v69
    v_cmp_gt_u32 vcc, s22, v69
    v_cvt_pk_bf16_f32 v75, v75, 0
    v_subrev_u32 v75, 0x4280, v75
    v_cndmask_b32 v75, v75, v69, vcc
    v_cmp_gt_u32 vcc, s23, v69
    ds_read_b32 v80, v74 offset:4608
    s_nop 0
    v_cndmask_b32 v75, v65, v75, vcc
    v_lshl_add_u32 v75, v75, 2, v4
    v_subrev_u32 v70, 129, v7
    v_cvt_f32_u32 v76, v70
    v_cmp_gt_u32 vcc, s22, v70
    v_cvt_pk_bf16_f32 v76, v76, 0
    v_subrev_u32 v76, 0x4280, v76
    v_cndmask_b32 v76, v76, v70, vcc
    v_cmp_gt_u32 vcc, s23, v70
    ds_read_b32 v81, v75 offset:4608
    s_nop 0
    v_cndmask_b32 v76, v65, v76, vcc
    v_lshl_add_u32 v76, v76, 2, v4
    v_subrev_u32 v71, 130, v7
    v_cvt_f32_u32 v77, v71
    v_cmp_gt_u32 vcc, s22, v71
    v_cvt_pk_bf16_f32 v77, v77, 0
    v_subrev_u32 v77, 0x4280, v77
    v_cndmask_b32 v77, v77, v71, vcc
    v_cmp_gt_u32 vcc, s23, v71
    ds_read_b32 v82, v76 offset:4608
    s_nop 0
    v_cndmask_b32 v77, v65, v77, vcc
    v_lshl_add_u32 v77, v77, 2, v4
    ds_read_b32 v83, v77 offset:4608
    v_subrev_u32 v7, 256, v7
    s_sub_u32 s25, s25, 1
    s_waitcnt lgkmcnt(0)
    v_cvt_pk_bf16_f32 v84, v79, v80
    v_cvt_pk_bf16_f32 v85, v78, v79
    v_cvt_pk_bf16_f32 v86, v82, v83
    v_cvt_pk_bf16_f32 v87, v81, v82
    ds_write_b32 v64, v84 offset:7424
    ds_write_b32 v64, v85 offset:11776
    s_cmp_eq_u32 s25, 0
    s_cbranch_scc1 ss_expx
    ds_write_b32 v64, v86 offset:7680
    ds_write_b32 v64, v87 offset:12032
    v_add_u32 v64, 512, v64
    s_nop 1
    s_branch ss_exp
ss_expx:
    s_waitcnt lgkmcnt(0)
    s_barrier
    v_and_b32 v5, 1, v2
    v_mul_u32_u24 v36, 4352, v5
    v_sub_u32 v5, v5, v2
    v_lshl_add_u32 v5, v3, 3, v5
    v_lshl_add_u32 v36, v5, 1, v36
    v_add_u32 v36, 11072, v36
    v_add_u32 v36, v36, v4
    v_subrev_u32 v37, 512, v36
    v_subrev_u32 v38, 1024, v36
    v_subrev_u32 v39, 1536, v36
    v_subrev_u32 v40, 2048, v36
    v_subrev_u32 v41, 2560, v36
    v_subrev_u32 v42, 3072, v36
    v_subrev_u32 v43, 3584, v36
    v_lshlrev_b32 v44, 5, v2
    v_lshl_add_u32 v44, v3, 4, v44
    v_add_u32 v44, 32, v44
    v_add_u32 v44, v44, v4
    ds_read_b128 v[112:115], v44 offset:448
    ds_read2_b32 v[80:81], v36 offset0:112 offset1:113
    ds_read2_b32 v[82:83], v36 offset0:114 offset1:115
    ds_read_b128 v[116:119], v44 offset:960
    ds_read2_b32 v[84:85], v37 offset0:112 offset1:113
    ds_read2_b32 v[86:87], v37 offset0:114 offset1:115
    ds_read_b128 v[120:123], v44 offset:1472
    ds_read2_b32 v[88:89], v38 offset0:112 offset1:113
    ds_read2_b32 v[90:91], v38 offset0:114 offset1:115
    ds_read_b128 v[124:127], v44 offset:1984
    ds_read2_b32 v[92:93], v39 offset0:112 offset1:113
    ds_read2_b32 v[94:95], v39 offset0:114 offset1:115
    ds_read_b128 v[128:131], v44 offset:2496
    ds_read2_b32 v[96:97], v40 offset0:112 offset1:113
    ds_read2_b32 v[98:99], v40 offset0:114 offset1:115
    ds_read_b128 v[132:135], v44 offset:3008
    ds_read2_b32 v[100:101], v41 offset0:112 offset1:113
    ds_read2_b32 v[102:103], v41 offset0:114 offset1:115
    ds_read_b128 v[136:139], v44 offset:3520
    ds_read2_b32 v[104:105], v42 offset0:112 offset1:113
    ds_read2_b32 v[106:107], v42 offset0:114 offset1:115
    ds_read_b128 v[140:143], v44 offset:4032
    ds_read2_b32 v[108:109], v43 offset0:112 offset1:113
    ds_read2_b32 v[110:111], v43 offset0:114 offset1:115
    s_waitcnt lgkmcnt(0)
    v_mfma_f32_16x16x32_bf16 v[48:51], v[80:83], v[112:115], 0
    ds_read_b128 v[176:179], v44 offset:384
    v_mfma_f32_16x16x32_bf16 v[52:55], v[80:83], v[116:119], 0
    ds_read2_b32 v[144:145], v36 offset0:96 offset1:97
    v_mfma_f32_16x16x32_bf16 v[56:59], v[80:83], v[120:123], 0
    ds_read2_b32 v[146:147], v36 offset0:98 offset1:99
    v_mfma_f32_16x16x32_bf16 v[60:63], v[80:83], v[124:127], 0
    ds_read_b128 v[180:183], v44 offset:896
    v_mfma_f32_16x16x32_bf16 v[64:67], v[80:83], v[128:131], 0
    ds_read2_b32 v[148:149], v37 offset0:96 offset1:97
    v_mfma_f32_16x16x32_bf16 v[68:71], v[80:83], v[132:135], 0
    ds_read2_b32 v[150:151], v37 offset0:98 offset1:99
    v_mfma_f32_16x16x32_bf16 v[72:75], v[80:83], v[136:139], 0
    ds_read_b128 v[184:187], v44 offset:1408
    v_mfma_f32_16x16x32_bf16 v[76:79], v[80:83], v[140:143], 0
    ds_read2_b32 v[152:153], v38 offset0:96 offset1:97
    v_mfma_f32_16x16x32_bf16 v[52:55], v[84:87], v[112:115], v[52:55]
    ds_read2_b32 v[154:155], v38 offset0:98 offset1:99
    v_mfma_f32_16x16x32_bf16 v[56:59], v[84:87], v[116:119], v[56:59]
    ds_read_b128 v[188:191], v44 offset:1920
    v_mfma_f32_16x16x32_bf16 v[60:63], v[84:87], v[120:123], v[60:63]
    ds_read2_b32 v[156:157], v39 offset0:96 offset1:97
    v_mfma_f32_16x16x32_bf16 v[64:67], v[84:87], v[124:127], v[64:67]
    ds_read2_b32 v[158:159], v39 offset0:98 offset1:99
    v_mfma_f32_16x16x32_bf16 v[68:71], v[84:87], v[128:131], v[68:71]
    ds_read_b128 v[192:195], v44 offset:2432
    v_mfma_f32_16x16x32_bf16 v[72:75], v[84:87], v[132:135], v[72:75]
    ds_read2_b32 v[160:161], v40 offset0:96 offset1:97
    v_mfma_f32_16x16x32_bf16 v[76:79], v[84:87], v[136:139], v[76:79]
    ds_read2_b32 v[162:163], v40 offset0:98 offset1:99
    v_mfma_f32_16x16x32_bf16 v[56:59], v[88:91], v[112:115], v[56:59]
    ds_read_b128 v[196:199], v44 offset:2944
    v_mfma_f32_16x16x32_bf16 v[60:63], v[88:91], v[116:119], v[60:63]
    ds_read2_b32 v[164:165], v41 offset0:96 offset1:97
    v_mfma_f32_16x16x32_bf16 v[64:67], v[88:91], v[120:123], v[64:67]
    ds_read2_b32 v[166:167], v41 offset0:98 offset1:99
    v_mfma_f32_16x16x32_bf16 v[68:71], v[88:91], v[124:127], v[68:71]
    ds_read_b128 v[200:203], v44 offset:3456
    v_mfma_f32_16x16x32_bf16 v[72:75], v[88:91], v[128:131], v[72:75]
    ds_read2_b32 v[168:169], v42 offset0:96 offset1:97
    v_mfma_f32_16x16x32_bf16 v[76:79], v[88:91], v[132:135], v[76:79]
    ds_read2_b32 v[170:171], v42 offset0:98 offset1:99
    v_mfma_f32_16x16x32_bf16 v[60:63], v[92:95], v[112:115], v[60:63]
    ds_read_b128 v[204:207], v44 offset:3968
    v_mfma_f32_16x16x32_bf16 v[64:67], v[92:95], v[116:119], v[64:67]
    ds_read2_b32 v[172:173], v43 offset0:96 offset1:97
    v_mfma_f32_16x16x32_bf16 v[68:71], v[92:95], v[120:123], v[68:71]
    ds_read2_b32 v[174:175], v43 offset0:98 offset1:99
    v_mfma_f32_16x16x32_bf16 v[72:75], v[92:95], v[124:127], v[72:75]
    v_mfma_f32_16x16x32_bf16 v[76:79], v[92:95], v[128:131], v[76:79]
    v_mfma_f32_16x16x32_bf16 v[64:67], v[96:99], v[112:115], v[64:67]
    v_mfma_f32_16x16x32_bf16 v[68:71], v[96:99], v[116:119], v[68:71]
    v_mfma_f32_16x16x32_bf16 v[72:75], v[96:99], v[120:123], v[72:75]
    v_mfma_f32_16x16x32_bf16 v[76:79], v[96:99], v[124:127], v[76:79]
    v_mfma_f32_16x16x32_bf16 v[68:71], v[100:103], v[112:115], v[68:71]
    v_mfma_f32_16x16x32_bf16 v[72:75], v[100:103], v[116:119], v[72:75]
    v_mfma_f32_16x16x32_bf16 v[76:79], v[100:103], v[120:123], v[76:79]
    v_mfma_f32_16x16x32_bf16 v[72:75], v[104:107], v[112:115], v[72:75]
    v_mfma_f32_16x16x32_bf16 v[76:79], v[104:107], v[116:119], v[76:79]
    v_mfma_f32_16x16x32_bf16 v[76:79], v[108:111], v[112:115], v[76:79]
    s_waitcnt lgkmcnt(0)
    v_mfma_f32_16x16x32_bf16 v[48:51], v[144:147], v[176:179], v[48:51]
    ds_read_b128 v[112:115], v44 offset:320
    v_mfma_f32_16x16x32_bf16 v[52:55], v[144:147], v[180:183], v[52:55]
    ds_read2_b32 v[80:81], v36 offset0:80 offset1:81
    v_mfma_f32_16x16x32_bf16 v[56:59], v[144:147], v[184:187], v[56:59]
    ds_read2_b32 v[82:83], v36 offset0:82 offset1:83
    v_mfma_f32_16x16x32_bf16 v[60:63], v[144:147], v[188:191], v[60:63]
    ds_read_b128 v[116:119], v44 offset:832
    v_mfma_f32_16x16x32_bf16 v[64:67], v[144:147], v[192:195], v[64:67]
    ds_read2_b32 v[84:85], v37 offset0:80 offset1:81
    v_mfma_f32_16x16x32_bf16 v[68:71], v[144:147], v[196:199], v[68:71]
    ds_read2_b32 v[86:87], v37 offset0:82 offset1:83
    v_mfma_f32_16x16x32_bf16 v[72:75], v[144:147], v[200:203], v[72:75]
    ds_read_b128 v[120:123], v44 offset:1344
    v_mfma_f32_16x16x32_bf16 v[76:79], v[144:147], v[204:207], v[76:79]
    ds_read2_b32 v[88:89], v38 offset0:80 offset1:81
    v_mfma_f32_16x16x32_bf16 v[52:55], v[148:151], v[176:179], v[52:55]
    ds_read2_b32 v[90:91], v38 offset0:82 offset1:83
    v_mfma_f32_16x16x32_bf16 v[56:59], v[148:151], v[180:183], v[56:59]
    ds_read_b128 v[124:127], v44 offset:1856
    v_mfma_f32_16x16x32_bf16 v[60:63], v[148:151], v[184:187], v[60:63]
    ds_read2_b32 v[92:93], v39 offset0:80 offset1:81
    v_mfma_f32_16x16x32_bf16 v[64:67], v[148:151], v[188:191], v[64:67]
    ds_read2_b32 v[94:95], v39 offset0:82 offset1:83
    v_mfma_f32_16x16x32_bf16 v[68:71], v[148:151], v[192:195], v[68:71]
    ds_read_b128 v[128:131], v44 offset:2368
    v_mfma_f32_16x16x32_bf16 v[72:75], v[148:151], v[196:199], v[72:75]
    ds_read2_b32 v[96:97], v40 offset0:80 offset1:81
    v_mfma_f32_16x16x32_bf16 v[76:79], v[148:151], v[200:203], v[76:79]
    ds_read2_b32 v[98:99], v40 offset0:82 offset1:83
    v_mfma_f32_16x16x32_bf16 v[56:59], v[152:155], v[176:179], v[56:59]
    ds_read_b128 v[132:135], v44 offset:2880
    v_mfma_f32_16x16x32_bf16 v[60:63], v[152:155], v[180:183], v[60:63]
    ds_read2_b32 v[100:101], v41 offset0:80 offset1:81
    v_mfma_f32_16x16x32_bf16 v[64:67], v[152:155], v[184:187], v[64:67]
    ds_read2_b32 v[102:103], v41 offset0:82 offset1:83
    v_mfma_f32_16x16x32_bf16 v[68:71], v[152:155], v[188:191], v[68:71]
    ds_read_b128 v[136:139], v44 offset:3392
    v_mfma_f32_16x16x32_bf16 v[72:75], v[152:155], v[192:195], v[72:75]
    ds_read2_b32 v[104:105], v42 offset0:80 offset1:81
    v_mfma_f32_16x16x32_bf16 v[76:79], v[152:155], v[196:199], v[76:79]
    ds_read2_b32 v[106:107], v42 offset0:82 offset1:83
    v_mfma_f32_16x16x32_bf16 v[60:63], v[156:159], v[176:179], v[60:63]
    ds_read_b128 v[140:143], v44 offset:3904
    v_mfma_f32_16x16x32_bf16 v[64:67], v[156:159], v[180:183], v[64:67]
    ds_read2_b32 v[108:109], v43 offset0:80 offset1:81
    v_mfma_f32_16x16x32_bf16 v[68:71], v[156:159], v[184:187], v[68:71]
    ds_read2_b32 v[110:111], v43 offset0:82 offset1:83
    v_mfma_f32_16x16x32_bf16 v[72:75], v[156:159], v[188:191], v[72:75]
    v_mfma_f32_16x16x32_bf16 v[76:79], v[156:159], v[192:195], v[76:79]
    v_mfma_f32_16x16x32_bf16 v[64:67], v[160:163], v[176:179], v[64:67]
    v_mfma_f32_16x16x32_bf16 v[68:71], v[160:163], v[180:183], v[68:71]
    v_mfma_f32_16x16x32_bf16 v[72:75], v[160:163], v[184:187], v[72:75]
    v_mfma_f32_16x16x32_bf16 v[76:79], v[160:163], v[188:191], v[76:79]
    v_mfma_f32_16x16x32_bf16 v[68:71], v[164:167], v[176:179], v[68:71]
    v_mfma_f32_16x16x32_bf16 v[72:75], v[164:167], v[180:183], v[72:75]
    v_mfma_f32_16x16x32_bf16 v[76:79], v[164:167], v[184:187], v[76:79]
    v_mfma_f32_16x16x32_bf16 v[72:75], v[168:171], v[176:179], v[72:75]
    v_mfma_f32_16x16x32_bf16 v[76:79], v[168:171], v[180:183], v[76:79]
    v_mfma_f32_16x16x32_bf16 v[76:79], v[172:175], v[176:179], v[76:79]
    s_waitcnt lgkmcnt(0)
    v_mfma_f32_16x16x32_bf16 v[48:51], v[80:83], v[112:115], v[48:51]
    ds_read_b128 v[176:179], v44 offset:256
    v_mfma_f32_16x16x32_bf16 v[52:55], v[80:83], v[116:119], v[52:55]
    ds_read2_b32 v[144:145], v36 offset0:64 offset1:65
    v_mfma_f32_16x16x32_bf16 v[56:59], v[80:83], v[120:123], v[56:59]
    ds_read2_b32 v[146:147], v36 offset0:66 offset1:67
    v_mfma_f32_16x16x32_bf16 v[60:63], v[80:83], v[124:127], v[60:63]
    ds_read_b128 v[180:183], v44 offset:768
    v_mfma_f32_16x16x32_bf16 v[64:67], v[80:83], v[128:131], v[64:67]
    ds_read2_b32 v[148:149], v37 offset0:64 offset1:65
    v_mfma_f32_16x16x32_bf16 v[68:71], v[80:83], v[132:135], v[68:71]
    ds_read2_b32 v[150:151], v37 offset0:66 offset1:67
    v_mfma_f32_16x16x32_bf16 v[72:75], v[80:83], v[136:139], v[72:75]
    ds_read_b128 v[184:187], v44 offset:1280
    v_mfma_f32_16x16x32_bf16 v[76:79], v[80:83], v[140:143], v[76:79]
    ds_read2_b32 v[152:153], v38 offset0:64 offset1:65
    v_mfma_f32_16x16x32_bf16 v[52:55], v[84:87], v[112:115], v[52:55]
    ds_read2_b32 v[154:155], v38 offset0:66 offset1:67
    v_mfma_f32_16x16x32_bf16 v[56:59], v[84:87], v[116:119], v[56:59]
    ds_read_b128 v[188:191], v44 offset:1792
    v_mfma_f32_16x16x32_bf16 v[60:63], v[84:87], v[120:123], v[60:63]
    ds_read2_b32 v[156:157], v39 offset0:64 offset1:65
    v_mfma_f32_16x16x32_bf16 v[64:67], v[84:87], v[124:127], v[64:67]
    ds_read2_b32 v[158:159], v39 offset0:66 offset1:67
    v_mfma_f32_16x16x32_bf16 v[68:71], v[84:87], v[128:131], v[68:71]
    ds_read_b128 v[192:195], v44 offset:2304
    v_mfma_f32_16x16x32_bf16 v[72:75], v[84:87], v[132:135], v[72:75]
    ds_read2_b32 v[160:161], v40 offset0:64 offset1:65
    v_mfma_f32_16x16x32_bf16 v[76:79], v[84:87], v[136:139], v[76:79]
    ds_read2_b32 v[162:163], v40 offset0:66 offset1:67
    v_mfma_f32_16x16x32_bf16 v[56:59], v[88:91], v[112:115], v[56:59]
    ds_read_b128 v[196:199], v44 offset:2816
    v_mfma_f32_16x16x32_bf16 v[60:63], v[88:91], v[116:119], v[60:63]
    ds_read2_b32 v[164:165], v41 offset0:64 offset1:65
    v_mfma_f32_16x16x32_bf16 v[64:67], v[88:91], v[120:123], v[64:67]
    ds_read2_b32 v[166:167], v41 offset0:66 offset1:67
    v_mfma_f32_16x16x32_bf16 v[68:71], v[88:91], v[124:127], v[68:71]
    ds_read_b128 v[200:203], v44 offset:3328
    v_mfma_f32_16x16x32_bf16 v[72:75], v[88:91], v[128:131], v[72:75]
    ds_read2_b32 v[168:169], v42 offset0:64 offset1:65
    v_mfma_f32_16x16x32_bf16 v[76:79], v[88:91], v[132:135], v[76:79]
    ds_read2_b32 v[170:171], v42 offset0:66 offset1:67
    v_mfma_f32_16x16x32_bf16 v[60:63], v[92:95], v[112:115], v[60:63]
    ds_read_b128 v[204:207], v44 offset:3840
    v_mfma_f32_16x16x32_bf16 v[64:67], v[92:95], v[116:119], v[64:67]
    ds_read2_b32 v[172:173], v43 offset0:64 offset1:65
    v_mfma_f32_16x16x32_bf16 v[68:71], v[92:95], v[120:123], v[68:71]
    ds_read2_b32 v[174:175], v43 offset0:66 offset1:67
    v_mfma_f32_16x16x32_bf16 v[72:75], v[92:95], v[124:127], v[72:75]
    v_mfma_f32_16x16x32_bf16 v[76:79], v[92:95], v[128:131], v[76:79]
    v_mfma_f32_16x16x32_bf16 v[64:67], v[96:99], v[112:115], v[64:67]
    v_mfma_f32_16x16x32_bf16 v[68:71], v[96:99], v[116:119], v[68:71]
    v_mfma_f32_16x16x32_bf16 v[72:75], v[96:99], v[120:123], v[72:75]
    v_mfma_f32_16x16x32_bf16 v[76:79], v[96:99], v[124:127], v[76:79]
    v_mfma_f32_16x16x32_bf16 v[68:71], v[100:103], v[112:115], v[68:71]
    v_mfma_f32_16x16x32_bf16 v[72:75], v[100:103], v[116:119], v[72:75]
    v_mfma_f32_16x16x32_bf16 v[76:79], v[100:103], v[120:123], v[76:79]
    v_mfma_f32_16x16x32_bf16 v[72:75], v[104:107], v[112:115], v[72:75]
    v_mfma_f32_16x16x32_bf16 v[76:79], v[104:107], v[116:119], v[76:79]
    v_mfma_f32_16x16x32_bf16 v[76:79], v[108:111], v[112:115], v[76:79]
    s_waitcnt lgkmcnt(0)
    v_mfma_f32_16x16x32_bf16 v[48:51], v[144:147], v[176:179], v[48:51]
    ds_read_b128 v[112:115], v44 offset:192
    v_mfma_f32_16x16x32_bf16 v[52:55], v[144:147], v[180:183], v[52:55]
    ds_read2_b32 v[80:81], v36 offset0:48 offset1:49
    v_mfma_f32_16x16x32_bf16 v[56:59], v[144:147], v[184:187], v[56:59]
    ds_read2_b32 v[82:83], v36 offset0:50 offset1:51
    v_mfma_f32_16x16x32_bf16 v[60:63], v[144:147], v[188:191], v[60:63]
    ds_read_b128 v[116:119], v44 offset:704
    v_mfma_f32_16x16x32_bf16 v[64:67], v[144:147], v[192:195], v[64:67]
    ds_read2_b32 v[84:85], v37 offset0:48 offset1:49
    v_mfma_f32_16x16x32_bf16 v[68:71], v[144:147], v[196:199], v[68:71]
    ds_read2_b32 v[86:87], v37 offset0:50 offset1:51
    v_mfma_f32_16x16x32_bf16 v[72:75], v[144:147], v[200:203], v[72:75]
    ds_read_b128 v[120:123], v44 offset:1216
    v_mfma_f32_16x16x32_bf16 v[76:79], v[144:147], v[204:207], v[76:79]
    ds_read2_b32 v[88:89], v38 offset0:48 offset1:49
    v_mfma_f32_16x16x32_bf16 v[52:55], v[148:151], v[176:179], v[52:55]
    ds_read2_b32 v[90:91], v38 offset0:50 offset1:51
    v_mfma_f32_16x16x32_bf16 v[56:59], v[148:151], v[180:183], v[56:59]
    ds_read_b128 v[124:127], v44 offset:1728
    v_mfma_f32_16x16x32_bf16 v[60:63], v[148:151], v[184:187], v[60:63]
    ds_read2_b32 v[92:93], v39 offset0:48 offset1:49
    v_mfma_f32_16x16x32_bf16 v[64:67], v[148:151], v[188:191], v[64:67]
    ds_read2_b32 v[94:95], v39 offset0:50 offset1:51
    v_mfma_f32_16x16x32_bf16 v[68:71], v[148:151], v[192:195], v[68:71]
    ds_read_b128 v[128:131], v44 offset:2240
    v_mfma_f32_16x16x32_bf16 v[72:75], v[148:151], v[196:199], v[72:75]
    ds_read2_b32 v[96:97], v40 offset0:48 offset1:49
    v_mfma_f32_16x16x32_bf16 v[76:79], v[148:151], v[200:203], v[76:79]
    ds_read2_b32 v[98:99], v40 offset0:50 offset1:51
    v_mfma_f32_16x16x32_bf16 v[56:59], v[152:155], v[176:179], v[56:59]
    ds_read_b128 v[132:135], v44 offset:2752
    v_mfma_f32_16x16x32_bf16 v[60:63], v[152:155], v[180:183], v[60:63]
    ds_read2_b32 v[100:101], v41 offset0:48 offset1:49
    v_mfma_f32_16x16x32_bf16 v[64:67], v[152:155], v[184:187], v[64:67]
    ds_read2_b32 v[102:103], v41 offset0:50 offset1:51
    v_mfma_f32_16x16x32_bf16 v[68:71], v[152:155], v[188:191], v[68:71]
    ds_read_b128 v[136:139], v44 offset:3264
    v_mfma_f32_16x16x32_bf16 v[72:75], v[152:155], v[192:195], v[72:75]
    ds_read2_b32 v[104:105], v42 offset0:48 offset1:49
    v_mfma_f32_16x16x32_bf16 v[76:79], v[152:155], v[196:199], v[76:79]
    ds_read2_b32 v[106:107], v42 offset0:50 offset1:51
    v_mfma_f32_16x16x32_bf16 v[60:63], v[156:159], v[176:179], v[60:63]
    ds_read_b128 v[140:143], v44 offset:3776
    v_mfma_f32_16x16x32_bf16 v[64:67], v[156:159], v[180:183], v[64:67]
    ds_read2_b32 v[108:109], v43 offset0:48 offset1:49
    v_mfma_f32_16x16x32_bf16 v[68:71], v[156:159], v[184:187], v[68:71]
    ds_read2_b32 v[110:111], v43 offset0:50 offset1:51
    v_mfma_f32_16x16x32_bf16 v[72:75], v[156:159], v[188:191], v[72:75]
    v_mfma_f32_16x16x32_bf16 v[76:79], v[156:159], v[192:195], v[76:79]
    v_mfma_f32_16x16x32_bf16 v[64:67], v[160:163], v[176:179], v[64:67]
    v_mfma_f32_16x16x32_bf16 v[68:71], v[160:163], v[180:183], v[68:71]
    v_mfma_f32_16x16x32_bf16 v[72:75], v[160:163], v[184:187], v[72:75]
    v_mfma_f32_16x16x32_bf16 v[76:79], v[160:163], v[188:191], v[76:79]
    v_mfma_f32_16x16x32_bf16 v[68:71], v[164:167], v[176:179], v[68:71]
    v_mfma_f32_16x16x32_bf16 v[72:75], v[164:167], v[180:183], v[72:75]
    v_mfma_f32_16x16x32_bf16 v[76:79], v[164:167], v[184:187], v[76:79]
    v_mfma_f32_16x16x32_bf16 v[72:75], v[168:171], v[176:179], v[72:75]
    v_mfma_f32_16x16x32_bf16 v[76:79], v[168:171], v[180:183], v[76:79]
    v_mfma_f32_16x16x32_bf16 v[76:79], v[172:175], v[176:179], v[76:79]
    s_waitcnt lgkmcnt(0)
    v_mfma_f32_16x16x32_bf16 v[48:51], v[80:83], v[112:115], v[48:51]
    ds_read_b128 v[176:179], v44 offset:128
    v_mfma_f32_16x16x32_bf16 v[52:55], v[80:83], v[116:119], v[52:55]
    ds_read2_b32 v[144:145], v36 offset0:32 offset1:33
    v_mfma_f32_16x16x32_bf16 v[56:59], v[80:83], v[120:123], v[56:59]
    ds_read2_b32 v[146:147], v36 offset0:34 offset1:35
    v_mfma_f32_16x16x32_bf16 v[60:63], v[80:83], v[124:127], v[60:63]
    ds_read_b128 v[180:183], v44 offset:640
    v_mfma_f32_16x16x32_bf16 v[64:67], v[80:83], v[128:131], v[64:67]
    ds_read2_b32 v[148:149], v37 offset0:32 offset1:33
    v_mfma_f32_16x16x32_bf16 v[68:71], v[80:83], v[132:135], v[68:71]
    ds_read2_b32 v[150:151], v37 offset0:34 offset1:35
    v_mfma_f32_16x16x32_bf16 v[72:75], v[80:83], v[136:139], v[72:75]
    ds_read_b128 v[184:187], v44 offset:1152
    v_mfma_f32_16x16x32_bf16 v[76:79], v[80:83], v[140:143], v[76:79]
    ds_read2_b32 v[152:153], v38 offset0:32 offset1:33
    v_mfma_f32_16x16x32_bf16 v[52:55], v[84:87], v[112:115], v[52:55]
    ds_read2_b32 v[154:155], v38 offset0:34 offset1:35
    v_mfma_f32_16x16x32_bf16 v[56:59], v[84:87], v[116:119], v[56:59]
    ds_read_b128 v[188:191], v44 offset:1664
    v_mfma_f32_16x16x32_bf16 v[60:63], v[84:87], v[120:123], v[60:63]
    ds_read2_b32 v[156:157], v39 offset0:32 offset1:33
    v_mfma_f32_16x16x32_bf16 v[64:67], v[84:87], v[124:127], v[64:67]
    ds_read2_b32 v[158:159], v39 offset0:34 offset1:35
    v_mfma_f32_16x16x32_bf16 v[68:71], v[84:87], v[128:131], v[68:71]
    ds_read_b128 v[192:195], v44 offset:2176
    v_mfma_f32_16x16x32_bf16 v[72:75], v[84:87], v[132:135], v[72:75]
    ds_read2_b32 v[160:161], v40 offset0:32 offset1:33
    v_mfma_f32_16x16x32_bf16 v[76:79], v[84:87], v[136:139], v[76:79]
    ds_read2_b32 v[162:163], v40 offset0:34 offset1:35
    v_mfma_f32_16x16x32_bf16 v[56:59], v[88:91], v[112:115], v[56:59]
    ds_read_b128 v[196:199], v44 offset:2688
    v_mfma_f32_16x16x32_bf16 v[60:63], v[88:91], v[116:119], v[60:63]
    ds_read2_b32 v[164:165], v41 offset0:32 offset1:33
    v_mfma_f32_16x16x32_bf16 v[64:67], v[88:91], v[120:123], v[64:67]
    ds_read2_b32 v[166:167], v41 offset0:34 offset1:35
    v_mfma_f32_16x16x32_bf16 v[68:71], v[88:91], v[124:127], v[68:71]
    ds_read_b128 v[200:203], v44 offset:3200
    v_mfma_f32_16x16x32_bf16 v[72:75], v[88:91], v[128:131], v[72:75]
    ds_read2_b32 v[168:169], v42 offset0:32 offset1:33
    v_mfma_f32_16x16x32_bf16 v[76:79], v[88:91], v[132:135], v[76:79]
    ds_read2_b32 v[170:171], v42 offset0:34 offset1:35
    v_mfma_f32_16x16x32_bf16 v[60:63], v[92:95], v[112:115], v[60:63]
    ds_read_b128 v[204:207], v44 offset:3712
    v_mfma_f32_16x16x32_bf16 v[64:67], v[92:95], v[116:119], v[64:67]
    ds_read2_b32 v[172:173], v43 offset0:32 offset1:33
    v_mfma_f32_16x16x32_bf16 v[68:71], v[92:95], v[120:123], v[68:71]
    ds_read2_b32 v[174:175], v43 offset0:34 offset1:35
    v_mfma_f32_16x16x32_bf16 v[72:75], v[92:95], v[124:127], v[72:75]
    v_mfma_f32_16x16x32_bf16 v[76:79], v[92:95], v[128:131], v[76:79]
    v_mfma_f32_16x16x32_bf16 v[64:67], v[96:99], v[112:115], v[64:67]
    v_mfma_f32_16x16x32_bf16 v[68:71], v[96:99], v[116:119], v[68:71]
    v_mfma_f32_16x16x32_bf16 v[72:75], v[96:99], v[120:123], v[72:75]
    v_mfma_f32_16x16x32_bf16 v[76:79], v[96:99], v[124:127], v[76:79]
    v_mfma_f32_16x16x32_bf16 v[68:71], v[100:103], v[112:115], v[68:71]
    v_mfma_f32_16x16x32_bf16 v[72:75], v[100:103], v[116:119], v[72:75]
    v_mfma_f32_16x16x32_bf16 v[76:79], v[100:103], v[120:123], v[76:79]
    v_mfma_f32_16x16x32_bf16 v[72:75], v[104:107], v[112:115], v[72:75]
    v_mfma_f32_16x16x32_bf16 v[76:79], v[104:107], v[116:119], v[76:79]
    v_mfma_f32_16x16x32_bf16 v[76:79], v[108:111], v[112:115], v[76:79]
    s_waitcnt lgkmcnt(0)
    v_mfma_f32_16x16x32_bf16 v[48:51], v[144:147], v[176:179], v[48:51]
    ds_read_b128 v[112:115], v44 offset:64
    v_mfma_f32_16x16x32_bf16 v[52:55], v[144:147], v[180:183], v[52:55]
    ds_read2_b32 v[80:81], v36 offset0:16 offset1:17
    v_mfma_f32_16x16x32_bf16 v[56:59], v[144:147], v[184:187], v[56:59]
    ds_read2_b32 v[82:83], v36 offset0:18 offset1:19
    v_mfma_f32_16x16x32_bf16 v[60:63], v[144:147], v[188:191], v[60:63]
    ds_read_b128 v[116:119], v44 offset:576
    v_mfma_f32_16x16x32_bf16 v[64:67], v[144:147], v[192:195], v[64:67]
    ds_read2_b32 v[84:85], v37 offset0:16 offset1:17
    v_mfma_f32_16x16x32_bf16 v[68:71], v[144:147], v[196:199], v[68:71]
    ds_read2_b32 v[86:87], v37 offset0:18 offset1:19
    v_mfma_f32_16x16x32_bf16 v[72:75], v[144:147], v[200:203], v[72:75]
    ds_read_b128 v[120:123], v44 offset:1088
    v_mfma_f32_16x16x32_bf16 v[76:79], v[144:147], v[204:207], v[76:79]
    ds_read2_b32 v[88:89], v38 offset0:16 offset1:17
    v_mfma_f32_16x16x32_bf16 v[52:55], v[148:151], v[176:179], v[52:55]
    ds_read2_b32 v[90:91], v38 offset0:18 offset1:19
    v_mfma_f32_16x16x32_bf16 v[56:59], v[148:151], v[180:183], v[56:59]
    ds_read_b128 v[124:127], v44 offset:1600
    v_mfma_f32_16x16x32_bf16 v[60:63], v[148:151], v[184:187], v[60:63]
    ds_read2_b32 v[92:93], v39 offset0:16 offset1:17
    v_mfma_f32_16x16x32_bf16 v[64:67], v[148:151], v[188:191], v[64:67]
    ds_read2_b32 v[94:95], v39 offset0:18 offset1:19
    v_mfma_f32_16x16x32_bf16 v[68:71], v[148:151], v[192:195], v[68:71]
    ds_read_b128 v[128:131], v44 offset:2112
    v_mfma_f32_16x16x32_bf16 v[72:75], v[148:151], v[196:199], v[72:75]
    ds_read2_b32 v[96:97], v40 offset0:16 offset1:17
    v_mfma_f32_16x16x32_bf16 v[76:79], v[148:151], v[200:203], v[76:79]
    ds_read2_b32 v[98:99], v40 offset0:18 offset1:19
    v_mfma_f32_16x16x32_bf16 v[56:59], v[152:155], v[176:179], v[56:59]
    ds_read_b128 v[132:135], v44 offset:2624
    v_mfma_f32_16x16x32_bf16 v[60:63], v[152:155], v[180:183], v[60:63]
    ds_read2_b32 v[100:101], v41 offset0:16 offset1:17
    v_mfma_f32_16x16x32_bf16 v[64:67], v[152:155], v[184:187], v[64:67]
    ds_read2_b32 v[102:103], v41 offset0:18 offset1:19
    v_mfma_f32_16x16x32_bf16 v[68:71], v[152:155], v[188:191], v[68:71]
    ds_read_b128 v[136:139], v44 offset:3136
    v_mfma_f32_16x16x32_bf16 v[72:75], v[152:155], v[192:195], v[72:75]
    ds_read2_b32 v[104:105], v42 offset0:16 offset1:17
    v_mfma_f32_16x16x32_bf16 v[76:79], v[152:155], v[196:199], v[76:79]
    ds_read2_b32 v[106:107], v42 offset0:18 offset1:19
    v_mfma_f32_16x16x32_bf16 v[60:63], v[156:159], v[176:179], v[60:63]
    ds_read_b128 v[140:143], v44 offset:3648
    v_mfma_f32_16x16x32_bf16 v[64:67], v[156:159], v[180:183], v[64:67]
    ds_read2_b32 v[108:109], v43 offset0:16 offset1:17
    v_mfma_f32_16x16x32_bf16 v[68:71], v[156:159], v[184:187], v[68:71]
    ds_read2_b32 v[110:111], v43 offset0:18 offset1:19
    v_mfma_f32_16x16x32_bf16 v[72:75], v[156:159], v[188:191], v[72:75]
    v_mfma_f32_16x16x32_bf16 v[76:79], v[156:159], v[192:195], v[76:79]
    v_mfma_f32_16x16x32_bf16 v[64:67], v[160:163], v[176:179], v[64:67]
    v_mfma_f32_16x16x32_bf16 v[68:71], v[160:163], v[180:183], v[68:71]
    v_mfma_f32_16x16x32_bf16 v[72:75], v[160:163], v[184:187], v[72:75]
    v_mfma_f32_16x16x32_bf16 v[76:79], v[160:163], v[188:191], v[76:79]
    v_mfma_f32_16x16x32_bf16 v[68:71], v[164:167], v[176:179], v[68:71]
    v_mfma_f32_16x16x32_bf16 v[72:75], v[164:167], v[180:183], v[72:75]
    v_mfma_f32_16x16x32_bf16 v[76:79], v[164:167], v[184:187], v[76:79]
    v_mfma_f32_16x16x32_bf16 v[72:75], v[168:171], v[176:179], v[72:75]
    v_mfma_f32_16x16x32_bf16 v[76:79], v[168:171], v[180:183], v[76:79]
    v_mfma_f32_16x16x32_bf16 v[76:79], v[172:175], v[176:179], v[76:79]
    s_waitcnt lgkmcnt(0)
    v_mfma_f32_16x16x32_bf16 v[48:51], v[80:83], v[112:115], v[48:51]
    ds_read_b128 v[176:179], v44 offset:0
    v_mfma_f32_16x16x32_bf16 v[52:55], v[80:83], v[116:119], v[52:55]
    ds_read2_b32 v[144:145], v36 offset0:0 offset1:1
    v_mfma_f32_16x16x32_bf16 v[56:59], v[80:83], v[120:123], v[56:59]
    ds_read2_b32 v[146:147], v36 offset0:2 offset1:3
    v_mfma_f32_16x16x32_bf16 v[60:63], v[80:83], v[124:127], v[60:63]
    ds_read_b128 v[180:183], v44 offset:512
    v_mfma_f32_16x16x32_bf16 v[64:67], v[80:83], v[128:131], v[64:67]
    ds_read2_b32 v[148:149], v37 offset0:0 offset1:1
    v_mfma_f32_16x16x32_bf16 v[68:71], v[80:83], v[132:135], v[68:71]
    ds_read2_b32 v[150:151], v37 offset0:2 offset1:3
    v_mfma_f32_16x16x32_bf16 v[72:75], v[80:83], v[136:139], v[72:75]
    ds_read_b128 v[184:187], v44 offset:1024
    v_mfma_f32_16x16x32_bf16 v[76:79], v[80:83], v[140:143], v[76:79]
    ds_read2_b32 v[152:153], v38 offset0:0 offset1:1
    v_mfma_f32_16x16x32_bf16 v[52:55], v[84:87], v[112:115], v[52:55]
    ds_read2_b32 v[154:155], v38 offset0:2 offset1:3
    v_mfma_f32_16x16x32_bf16 v[56:59], v[84:87], v[116:119], v[56:59]
    ds_read_b128 v[188:191], v44 offset:1536
    v_mfma_f32_16x16x32_bf16 v[60:63], v[84:87], v[120:123], v[60:63]
    ds_read2_b32 v[156:157], v39 offset0:0 offset1:1
    v_mfma_f32_16x16x32_bf16 v[64:67], v[84:87], v[124:127], v[64:67]
    ds_read2_b32 v[158:159], v39 offset0:2 offset1:3
    v_mfma_f32_16x16x32_bf16 v[68:71], v[84:87], v[128:131], v[68:71]
    ds_read_b128 v[192:195], v44 offset:2048
    v_mfma_f32_16x16x32_bf16 v[72:75], v[84:87], v[132:135], v[72:75]
    ds_read2_b32 v[160:161], v40 offset0:0 offset1:1
    v_mfma_f32_16x16x32_bf16 v[76:79], v[84:87], v[136:139], v[76:79]
    ds_read2_b32 v[162:163], v40 offset0:2 offset1:3
    v_mfma_f32_16x16x32_bf16 v[56:59], v[88:91], v[112:115], v[56:59]
    ds_read_b128 v[196:199], v44 offset:2560
    v_mfma_f32_16x16x32_bf16 v[60:63], v[88:91], v[116:119], v[60:63]
    ds_read2_b32 v[164:165], v41 offset0:0 offset1:1
    v_mfma_f32_16x16x32_bf16 v[64:67], v[88:91], v[120:123], v[64:67]
    ds_read2_b32 v[166:167], v41 offset0:2 offset1:3
    v_mfma_f32_16x16x32_bf16 v[68:71], v[88:91], v[124:127], v[68:71]
    ds_read_b128 v[200:203], v44 offset:3072
    v_mfma_f32_16x16x32_bf16 v[72:75], v[88:91], v[128:131], v[72:75]
    ds_read2_b32 v[168:169], v42 offset0:0 offset1:1
    v_mfma_f32_16x16x32_bf16 v[76:79], v[88:91], v[132:135], v[76:79]
    ds_read2_b32 v[170:171], v42 offset0:2 offset1:3
    v_mfma_f32_16x16x32_bf16 v[60:63], v[92:95], v[112:115], v[60:63]
    ds_read_b128 v[204:207], v44 offset:3584
    v_mfma_f32_16x16x32_bf16 v[64:67], v[92:95], v[116:119], v[64:67]
    ds_read2_b32 v[172:173], v43 offset0:0 offset1:1
    v_mfma_f32_16x16x32_bf16 v[68:71], v[92:95], v[120:123], v[68:71]
    ds_read2_b32 v[174:175], v43 offset0:2 offset1:3
    v_mfma_f32_16x16x32_bf16 v[72:75], v[92:95], v[124:127], v[72:75]
    v_mfma_f32_16x16x32_bf16 v[76:79], v[92:95], v[128:131], v[76:79]
    v_mfma_f32_16x16x32_bf16 v[64:67], v[96:99], v[112:115], v[64:67]
    v_mfma_f32_16x16x32_bf16 v[68:71], v[96:99], v[116:119], v[68:71]
    v_mfma_f32_16x16x32_bf16 v[72:75], v[96:99], v[120:123], v[72:75]
    v_mfma_f32_16x16x32_bf16 v[76:79], v[96:99], v[124:127], v[76:79]
    v_mfma_f32_16x16x32_bf16 v[68:71], v[100:103], v[112:115], v[68:71]
    v_mfma_f32_16x16x32_bf16 v[72:75], v[100:103], v[116:119], v[72:75]
    v_mfma_f32_16x16x32_bf16 v[76:79], v[100:103], v[120:123], v[76:79]
    v_mfma_f32_16x16x32_bf16 v[72:75], v[104:107], v[112:115], v[72:75]
    v_mfma_f32_16x16x32_bf16 v[76:79], v[104:107], v[116:119], v[76:79]
    v_mfma_f32_16x16x32_bf16 v[76:79], v[108:111], v[112:115], v[76:79]
    s_waitcnt lgkmcnt(0)
    v_mfma_f32_16x16x32_bf16 v[48:51], v[144:147], v[176:179], v[48:51]
    v_mfma_f32_16x16x32_bf16 v[52:55], v[144:147], v[180:183], v[52:55]
    v_mfma_f32_16x16x32_bf16 v[56:59], v[144:147], v[184:187], v[56:59]
    v_mfma_f32_16x16x32_bf16 v[60:63], v[144:147], v[188:191], v[60:63]
    v_mfma_f32_16x16x32_bf16 v[64:67], v[144:147], v[192:195], v[64:67]
    v_mfma_f32_16x16x32_bf16 v[68:71], v[144:147], v[196:199], v[68:71]
    v_mfma_f32_16x16x32_bf16 v[72:75], v[144:147], v[200:203], v[72:75]
    v_mfma_f32_16x16x32_bf16 v[76:79], v[144:147], v[204:207], v[76:79]
    v_mfma_f32_16x16x32_bf16 v[52:55], v[148:151], v[176:179], v[52:55]
    v_mfma_f32_16x16x32_bf16 v[56:59], v[148:151], v[180:183], v[56:59]
    v_mfma_f32_16x16x32_bf16 v[60:63], v[148:151], v[184:187], v[60:63]
    v_mfma_f32_16x16x32_bf16 v[64:67], v[148:151], v[188:191], v[64:67]
    v_mfma_f32_16x16x32_bf16 v[68:71], v[148:151], v[192:195], v[68:71]
    v_mfma_f32_16x16x32_bf16 v[72:75], v[148:151], v[196:199], v[72:75]
    v_mfma_f32_16x16x32_bf16 v[76:79], v[148:151], v[200:203], v[76:79]
    v_mfma_f32_16x16x32_bf16 v[56:59], v[152:155], v[176:179], v[56:59]
    v_mfma_f32_16x16x32_bf16 v[60:63], v[152:155], v[180:183], v[60:63]
    v_mfma_f32_16x16x32_bf16 v[64:67], v[152:155], v[184:187], v[64:67]
    v_mfma_f32_16x16x32_bf16 v[68:71], v[152:155], v[188:191], v[68:71]
    v_mfma_f32_16x16x32_bf16 v[72:75], v[152:155], v[192:195], v[72:75]
    v_mfma_f32_16x16x32_bf16 v[76:79], v[152:155], v[196:199], v[76:79]
    v_mfma_f32_16x16x32_bf16 v[60:63], v[156:159], v[176:179], v[60:63]
    v_mfma_f32_16x16x32_bf16 v[64:67], v[156:159], v[180:183], v[64:67]
    v_mfma_f32_16x16x32_bf16 v[68:71], v[156:159], v[184:187], v[68:71]
    v_mfma_f32_16x16x32_bf16 v[72:75], v[156:159], v[188:191], v[72:75]
    v_mfma_f32_16x16x32_bf16 v[76:79], v[156:159], v[192:195], v[76:79]
    v_mfma_f32_16x16x32_bf16 v[64:67], v[160:163], v[176:179], v[64:67]
    v_mfma_f32_16x16x32_bf16 v[68:71], v[160:163], v[180:183], v[68:71]
    v_mfma_f32_16x16x32_bf16 v[72:75], v[160:163], v[184:187], v[72:75]
    v_mfma_f32_16x16x32_bf16 v[76:79], v[160:163], v[188:191], v[76:79]
    v_mfma_f32_16x16x32_bf16 v[68:71], v[164:167], v[176:179], v[68:71]
    v_mfma_f32_16x16x32_bf16 v[72:75], v[164:167], v[180:183], v[72:75]
    v_mfma_f32_16x16x32_bf16 v[76:79], v[164:167], v[184:187], v[76:79]
    v_mfma_f32_16x16x32_bf16 v[72:75], v[168:171], v[176:179], v[72:75]
    v_mfma_f32_16x16x32_bf16 v[76:79], v[168:171], v[180:183], v[76:79]
    v_mfma_f32_16x16x32_bf16 v[76:79], v[172:175], v[176:179], v[76:79]
    s_nop 7
    v_lshlrev_b32 v5, 6, v2
    v_lshl_add_u32 v5, v3, 4, v5
    v_add_u32 v5, v5, v4
    ds_write_b128 v5, v[48:51] offset:7424
    ds_write_b128 v5, v[52:55] offset:8448
    ds_write_b128 v5, v[56:59] offset:9472
    ds_write_b128 v5, v[60:63] offset:10496
    ds_write_b128 v5, v[64:67] offset:11520
    ds_write_b128 v5, v[68:71] offset:12544
    ds_write_b128 v5, v[72:75] offset:13568
    ds_write_b128 v5, v[76:79] offset:14592
    v_mov_b64 v[8:9], v[16:17]
    v_mov_b64 v[10:11], v[18:19]
    v_mov_b64 v[12:13], v[20:21]
    v_mov_b64 v[14:15], v[22:23]
    v_mov_b32 v24, v25
    v_add_u32 v4, 65536, v4
    s_add_u32 s28, s28, 1
    s_cmp_lt_u32 s28, 2
    s_waitcnt lgkmcnt(0)
    s_cbranch_scc1 ss_pass
    s_mov_b32 s12, s74
    s_mov_b32 s13, s75
    s_mov_b32 s14, 1152
    s_mov_b32 s15, 0x20000
    s_lshl_b32 s23, s20, 1
    buffer_load_dwordx4 v[8:11], off, s[12:15], s23
    s_barrier
    v_lshlrev_b32 v5, 5, v0
    v_add_u32 v7, 65536, v5
    ds_read_b128 v[64:67], v5 offset:7424
    ds_read_b128 v[68:71], v5 offset:7440
    ds_read_b128 v[72:75], v5 offset:23808
    ds_read_b128 v[76:79], v5 offset:23824
    ds_read_b128 v[80:83], v5 offset:40192
    ds_read_b128 v[84:87], v5 offset:40208
    ds_read_b128 v[88:91], v5 offset:56576
    ds_read_b128 v[92:95], v5 offset:56592
    ds_read_b128 v[96:99], v7 offset:7424
    ds_read_b128 v[100:103], v7 offset:7440
    ds_read_b128 v[104:107], v7 offset:23808
    ds_read_b128 v[108:111], v7 offset:23824
    ds_read_b128 v[112:115], v7 offset:40192
    ds_read_b128 v[116:119], v7 offset:40208
    ds_read_b128 v[120:123], v7 offset:56576
    ds_read_b128 v[124:127], v7 offset:56592
    s_waitcnt vmcnt(0)
    v_lshlrev_b32 v12, 16, v8
    v_and_b32 v13, 0xffff0000, v8
    v_lshlrev_b32 v14, 16, v9
    v_and_b32 v15, 0xffff0000, v9
    v_lshlrev_b32 v16, 16, v10
    v_and_b32 v17, 0xffff0000, v10
    v_lshlrev_b32 v18, 16, v11
    v_and_b32 v19, 0xffff0000, v11
    v_mul_u32_u24 v5, 18432, v0
    s_lshl_b32 s22, s20, 1
    s_add_u32 s22, s22, 1152
    s_waitcnt lgkmcnt(0)
    v_lshlrev_b32 v6, 16, v208
    v_fmac_f32 v64, v6, v12
    v_and_b32 v6, 0xffff0000, v208
    v_fmac_f32 v72, v6, v13
    v_lshlrev_b32 v6, 16, v209
    v_fmac_f32 v80, v6, v14
    v_and_b32 v6, 0xffff0000, v209
    v_fmac_f32 v88, v6, v15
    v_lshlrev_b32 v6, 16, v210
    v_fmac_f32 v96, v6, v16
    v_and_b32 v6, 0xffff0000, v210
    v_fmac_f32 v104, v6, v17
    v_lshlrev_b32 v6, 16, v211
    v_fmac_f32 v112, v6, v18
    v_and_b32 v6, 0xffff0000, v211
    v_fmac_f32 v120, v6, v19
    v_cvt_pk_bf16_f32 v208, v64, v72
    v_cvt_pk_bf16_f32 v209, v80, v88
    v_cvt_pk_bf16_f32 v210, v96, v104
    v_cvt_pk_bf16_f32 v211, v112, v120
    s_add_u32 s23, s22, 0
    buffer_store_dwordx4 v[208:211], v5, s[16:19], s23 offen
    v_lshlrev_b32 v6, 16, v212
    v_fmac_f32 v65, v6, v12
    v_and_b32 v6, 0xffff0000, v212
    v_fmac_f32 v73, v6, v13
    v_lshlrev_b32 v6, 16, v213
    v_fmac_f32 v81, v6, v14
    v_and_b32 v6, 0xffff0000, v213
    v_fmac_f32 v89, v6, v15
    v_lshlrev_b32 v6, 16, v214
    v_fmac_f32 v97, v6, v16
    v_and_b32 v6, 0xffff0000, v214
    v_fmac_f32 v105, v6, v17
    v_lshlrev_b32 v6, 16, v215
    v_fmac_f32 v113, v6, v18
    v_and_b32 v6, 0xffff0000, v215
    v_fmac_f32 v121, v6, v19
    v_cvt_pk_bf16_f32 v212, v65, v73
    v_cvt_pk_bf16_f32 v213, v81, v89
    v_cvt_pk_bf16_f32 v214, v97, v105
    v_cvt_pk_bf16_f32 v215, v113, v121
    s_add_u32 s23, s22, 2304
    buffer_store_dwordx4 v[212:215], v5, s[16:19], s23 offen
    v_lshlrev_b32 v6, 16, v216
    v_fmac_f32 v66, v6, v12
    v_and_b32 v6, 0xffff0000, v216
    v_fmac_f32 v74, v6, v13
    v_lshlrev_b32 v6, 16, v217
    v_fmac_f32 v82, v6, v14
    v_and_b32 v6, 0xffff0000, v217
    v_fmac_f32 v90, v6, v15
    v_lshlrev_b32 v6, 16, v218
    v_fmac_f32 v98, v6, v16
    v_and_b32 v6, 0xffff0000, v218
    v_fmac_f32 v106, v6, v17
    v_lshlrev_b32 v6, 16, v219
    v_fmac_f32 v114, v6, v18
    v_and_b32 v6, 0xffff0000, v219
    v_fmac_f32 v122, v6, v19
    v_cvt_pk_bf16_f32 v216, v66, v74
    v_cvt_pk_bf16_f32 v217, v82, v90
    v_cvt_pk_bf16_f32 v218, v98, v106
    v_cvt_pk_bf16_f32 v219, v114, v122
    s_add_u32 s23, s22, 4608
    buffer_store_dwordx4 v[216:219], v5, s[16:19], s23 offen
    v_lshlrev_b32 v6, 16, v220
    v_fmac_f32 v67, v6, v12
    v_and_b32 v6, 0xffff0000, v220
    v_fmac_f32 v75, v6, v13
    v_lshlrev_b32 v6, 16, v221
    v_fmac_f32 v83, v6, v14
    v_and_b32 v6, 0xffff0000, v221
    v_fmac_f32 v91, v6, v15
    v_lshlrev_b32 v6, 16, v222
    v_fmac_f32 v99, v6, v16
    v_and_b32 v6, 0xffff0000, v222
    v_fmac_f32 v107, v6, v17
    v_lshlrev_b32 v6, 16, v223
    v_fmac_f32 v115, v6, v18
    v_and_b32 v6, 0xffff0000, v223
    v_fmac_f32 v123, v6, v19
    v_cvt_pk_bf16_f32 v220, v67, v75
    v_cvt_pk_bf16_f32 v221, v83, v91
    v_cvt_pk_bf16_f32 v222, v99, v107
    v_cvt_pk_bf16_f32 v223, v115, v123
    s_add_u32 s23, s22, 6912
    buffer_store_dwordx4 v[220:223], v5, s[16:19], s23 offen
    v_lshlrev_b32 v6, 16, v224
    v_fmac_f32 v68, v6, v12
    v_and_b32 v6, 0xffff0000, v224
    v_fmac_f32 v76, v6, v13
    v_lshlrev_b32 v6, 16, v225
    v_fmac_f32 v84, v6, v14
    v_and_b32 v6, 0xffff0000, v225
    v_fmac_f32 v92, v6, v15
    v_lshlrev_b32 v6, 16, v226
    v_fmac_f32 v100, v6, v16
    v_and_b32 v6, 0xffff0000, v226
    v_fmac_f32 v108, v6, v17
    v_lshlrev_b32 v6, 16, v227
    v_fmac_f32 v116, v6, v18
    v_and_b32 v6, 0xffff0000, v227
    v_fmac_f32 v124, v6, v19
    v_cvt_pk_bf16_f32 v224, v68, v76
    v_cvt_pk_bf16_f32 v225, v84, v92
    v_cvt_pk_bf16_f32 v226, v100, v108
    v_cvt_pk_bf16_f32 v227, v116, v124
    s_add_u32 s23, s22, 9216
    buffer_store_dwordx4 v[224:227], v5, s[16:19], s23 offen
    v_lshlrev_b32 v6, 16, v228
    v_fmac_f32 v69, v6, v12
    v_and_b32 v6, 0xffff0000, v228
    v_fmac_f32 v77, v6, v13
    v_lshlrev_b32 v6, 16, v229
    v_fmac_f32 v85, v6, v14
    v_and_b32 v6, 0xffff0000, v229
    v_fmac_f32 v93, v6, v15
    v_lshlrev_b32 v6, 16, v230
    v_fmac_f32 v101, v6, v16
    v_and_b32 v6, 0xffff0000, v230
    v_fmac_f32 v109, v6, v17
    v_lshlrev_b32 v6, 16, v231
    v_fmac_f32 v117, v6, v18
    v_and_b32 v6, 0xffff0000, v231
    v_fmac_f32 v125, v6, v19
    v_cvt_pk_bf16_f32 v228, v69, v77
    v_cvt_pk_bf16_f32 v229, v85, v93
    v_cvt_pk_bf16_f32 v230, v101, v109
    v_cvt_pk_bf16_f32 v231, v117, v125
    s_add_u32 s23, s22, 11520
    buffer_store_dwordx4 v[228:231], v5, s[16:19], s23 offen
    v_lshlrev_b32 v6, 16, v232
    v_fmac_f32 v70, v6, v12
    v_and_b32 v6, 0xffff0000, v232
    v_fmac_f32 v78, v6, v13
    v_lshlrev_b32 v6, 16, v233
    v_fmac_f32 v86, v6, v14
    v_and_b32 v6, 0xffff0000, v233
    v_fmac_f32 v94, v6, v15
    v_lshlrev_b32 v6, 16, v234
    v_fmac_f32 v102, v6, v16
    v_and_b32 v6, 0xffff0000, v234
    v_fmac_f32 v110, v6, v17
    v_lshlrev_b32 v6, 16, v235
    v_fmac_f32 v118, v6, v18
    v_and_b32 v6, 0xffff0000, v235
    v_fmac_f32 v126, v6, v19
    v_cvt_pk_bf16_f32 v232, v70, v78
    v_cvt_pk_bf16_f32 v233, v86, v94
    v_cvt_pk_bf16_f32 v234, v102, v110
    v_cvt_pk_bf16_f32 v235, v118, v126
    s_add_u32 s23, s22, 13824
    buffer_store_dwordx4 v[232:235], v5, s[16:19], s23 offen
    v_lshlrev_b32 v6, 16, v236
    v_fmac_f32 v71, v6, v12
    v_and_b32 v6, 0xffff0000, v236
    v_fmac_f32 v79, v6, v13
    v_lshlrev_b32 v6, 16, v237
    v_fmac_f32 v87, v6, v14
    v_and_b32 v6, 0xffff0000, v237
    v_fmac_f32 v95, v6, v15
    v_lshlrev_b32 v6, 16, v238
    v_fmac_f32 v103, v6, v16
    v_and_b32 v6, 0xffff0000, v238
    v_fmac_f32 v111, v6, v17
    v_lshlrev_b32 v6, 16, v239
    v_fmac_f32 v119, v6, v18
    v_and_b32 v6, 0xffff0000, v239
    v_fmac_f32 v127, v6, v19
    v_cvt_pk_bf16_f32 v236, v71, v79
    v_cvt_pk_bf16_f32 v237, v87, v95
    v_cvt_pk_bf16_f32 v238, v103, v111
    v_cvt_pk_bf16_f32 v239, v119, v127
    s_add_u32 s23, s22, 16128
    buffer_store_dwordx4 v[236:239], v5, s[16:19], s23 offen
    s_branch L_ssm_next
L_ssm_done:
    s_cmp_lt_u32 s93, 100
    s_cbranch_scc1 L_exit
    s_mov_b32 s8, s76
    s_mov_b32 s9, s77
    s_mov_b32 s10, 4718592
    s_mov_b32 s11, 0x20000
    s_cmp_le_u32 s45, 1
    s_cbranch_scc1 L_att_next
    s_branch L_op_nextcb
L_wf_next:
    s_mov_b32 s37, 20
    v_mov_b32 v250, 1
    v_mov_b32 v251, 163832
    v_cmp_eq_u32 vcc, 0, v0
    s_nop 0
    s_and_saveexec_b64 s[38:39], vcc
    s_cbranch_execz tk12
    buffer_atomic_add v250, off, s[84:87], s37 sc0
    s_waitcnt vmcnt(0)
    ds_write_b32 v251, v250
    s_waitcnt lgkmcnt(0)
tk12:
    s_mov_b64 exec, -1
    s_barrier
    ds_read_b32 v252, v251
    s_waitcnt lgkmcnt(0)
    v_readfirstlane_b32 s33, v252
    s_barrier
    s_nop 3
    s_cmp_ge_u32 s33, 160
    s_cbranch_scc1 L_ssm_next
    s_lshl_b32 s16, s33, 2
    s_add_u32 s16, s16, s32
    s_add_u32 s16, s16, 1504
    s_call_b64 s[46:47], L_xform
    s_lshl_b32 s40, s33, 2
    s_add_u32 s40, s40, 125841408
    s_waitcnt vmcnt(0)
    s_barrier
    v_mov_b32 v250, s95
    v_cmp_eq_u32 vcc, 0, v0
    s_nop 0
    s_and_saveexec_b64 s[38:39], vcc
    s_cbranch_execz fs13
    buffer_store_dword v250, off, s[4:7], s40 sc1
fs13:
    s_mov_b64 exec, -1
    s_branch L_wf_next
L_phase2:
    s_mov_b32 s40, 524288
mc2_w:
    buffer_load_dword v250, off, s[84:87], 0 offset:28 sc1
    s_waitcnt vmcnt(0)
    v_readfirstlane_b32 s41, v250
    s_nop 0
    s_cmp_lg_u32 s41, 0
    s_cbranch_scc1 mc2_known
    s_sub_u32 s40, s40, 1
    s_cbranch_scc1 mc2_force
    s_sleep 2
    s_branch mc2_w
mc2_force:
    v_mov_b32 v250, 2
    v_mov_b32 v251, 0
    s_mov_b64 exec, 1
    buffer_atomic_cmpswap v[250:251], off, s[84:87], 0 offset:28
    s_mov_b64 exec, -1
    s_waitcnt vmcnt(0)
    s_mov_b32 s40, 524288
    s_branch mc2_w
mc2_known:
    s_cmp_eq_u32 s41, 1
    s_cbranch_scc1 L_phase2b
    s_mov_b32 s37, 208
    v_mov_b32 v250, 1
    v_mov_b32 v251, 163832
    v_cmp_eq_u32 vcc, 0, v0
    s_nop 0
    s_and_saveexec_b64 s[38:39], vcc
    s_cbranch_execz tk14
    buffer_atomic_add v250, off, s[84:87], s37 sc0
    s_waitcnt vmcnt(0)
    ds_write_b32 v251, v250
    s_waitcnt lgkmcnt(0)
tk14:
    s_mov_b64 exec, -1
    s_barrier
    ds_read_b32 v252, v251
    s_waitcnt lgkmcnt(0)
    v_readfirstlane_b32 s12, v252
    s_barrier
    s_nop 3
    s_cmp_lt_u32 s12, 32
    s_cbranch_scc1 L_chain_safe
    s_sub_u32 s45, s12, 32
L_phase2b:
    s_mov_b32 s8, s76
    s_mov_b32 s9, s77
    s_mov_b32 s10, 4718592
    s_mov_b32 s11, 0x20000
    s_and_b32 s36, s45, 15
    s_bitcmp1_b32 42315, s36
    s_cbranch_scc0 L_nots
    s_cmp_eq_u32 s93, 500
    s_cbranch_scc1 L_ssm_next
    s_branch L_wf_next
L_nots:
    s_bitcmp1_b32 18576, s36
    s_cbranch_scc0 L_att_next
    s_bfm_b32 s37, s36, 0
    s_and_b32 s37, s37, 18576
    s_bcnt1_i32_b32 s37, s37
    s_lshr_b32 s40, s45, 4
    s_mul_i32 s40, s40, 4
    s_add_u32 s33, s40, s37
L_op_mod:
    s_mul_hi_u32 s41, s33, 0x0e38e38f
    s_mul_i32 s41, s41, 18
    s_sub_u32 s33, s33, s41
    s_branch L_op_start
L_att_next:
    s_mov_b32 s37, 16
    v_mov_b32 v250, 1
    v_mov_b32 v251, 163832
    v_cmp_eq_u32 vcc, 0, v0
    s_nop 0
    s_and_saveexec_b64 s[38:39], vcc
    s_cbranch_execz tk15
    buffer_atomic_add v250, off, s[84:87], s37 sc0
    s_waitcnt vmcnt(0)
    ds_write_b32 v251, v250
    s_waitcnt lgkmcnt(0)
tk15:
    s_mov_b64 exec, -1
    s_barrier
    ds_read_b32 v252, v251
    s_waitcnt lgkmcnt(0)
    v_readfirstlane_b32 s34, v252
    s_barrier
    s_nop 3
    s_cmp_ge_u32 s34, 512
    s_cbranch_scc1 L_op_nextcb
    s_lshr_b32 s16, s34, 3
    s_and_b32 s17, s34, 7
    s_lshl_b32 s17, s17, 2
    s_add_u32 s17, s17, s32
    s_lshl_b32 s36, s17, 7
    s_add_u32 s36, s36, 125829120
    s_lshr_b32 s41, s16, 2
    s_add_u32 s41, s41, s95
    s_add_u32 s41, s41, 1
    v_and_b32 v1, 3, v0
    v_min_u32 v1, 2, v1
    v_lshlrev_b32 v2, 4, v1
    s_and_b32 s37, s16, 3
    s_lshl_b32 s37, s37, 2
    v_add_u32 v2, s37, v2
    s_mov_b32 s40, 4194304
L_aw1:
    buffer_load_dword v3, v2, s[4:7], s36 offen sc1
    s_sub_u32 s40, s40, 1
    s_cbranch_scc1 L_aw1_go
    s_waitcnt vmcnt(0)
    v_subrev_u32 v3, s41, v3
    v_cmp_lt_u32 vcc, 64, v3
    s_cbranch_vccz L_aw1_go
    s_sleep 4
    s_branch L_aw1
L_aw1_go:
    v_and_b32 v5, 63, v0
    v_lshlrev_b32 v1, 4, v5
    s_cmp_ge_u32 s16, 56
    s_cselect_b32 s18, -1, 511
    v_and_b32 v2, s18, v1
    v_or_b32 v3, 128, v1
    v_lshrrev_b32 v4, 4, v5
    v_bfe_u32 v6, v5, 2, 2
    v_sub_u32 v4, v6, v4
    v_lshlrev_b32 v4, 3, v4
    v_and_b32 v6, 3, v5
    v_add_u32 v4, v4, v6
    v_mov_b32 v6, 0xf149f2ca
    s_mov_b32 s22, 0x3e0293ee
    s_lshl_b32 s18, s16, 5
    s_add_u32 s18, s18, s17
    s_lshl_b32 s19, s18, 13
    s_add_u32 s20, s19, 33554432
    buffer_load_dwordx4 v[8:11], v1, s[4:7], s20 offen offset:0 sc1
    s_add_u32 s20, s19, 33554432
    buffer_load_dwordx4 v[12:15], v1, s[4:7], s20 offen offset:1024 sc1
    s_add_u32 s20, s19, 33554432
    buffer_load_dwordx4 v[16:19], v1, s[4:7], s20 offen offset:2048 sc1
    s_add_u32 s20, s19, 33554432
    buffer_load_dwordx4 v[20:23], v1, s[4:7], s20 offen offset:3072 sc1
    s_add_u32 s20, s19, 33558528
    buffer_load_dwordx4 v[24:27], v1, s[4:7], s20 offen offset:0 sc1
    s_add_u32 s20, s19, 33558528
    buffer_load_dwordx4 v[28:31], v1, s[4:7], s20 offen offset:1024 sc1
    s_add_u32 s20, s19, 33558528
    buffer_load_dwordx4 v[32:35], v1, s[4:7], s20 offen offset:2048 sc1
    s_add_u32 s20, s19, 33558528
    buffer_load_dwordx4 v[36:39], v1, s[4:7], s20 offen offset:3072 sc1
    s_lshl_b32 s21, s18, 14
    s_add_u32 s20, s21, 0
    buffer_load_dwordx4 v[40:43], v1, s[4:7], s20 offen offset:0 sc1
    s_add_u32 s20, s21, 4096
    buffer_load_dwordx4 v[44:47], v1, s[4:7], s20 offen offset:0 sc1
    s_add_u32 s20, s21, 8192
    buffer_load_dwordx4 v[48:51], v1, s[4:7], s20 offen offset:0 sc1
    s_add_u32 s20, s21, 12288
    buffer_load_dwordx4 v[52:55], v1, s[4:7], s20 offen offset:0 sc1
    s_add_u32 s20, s21, 0
    buffer_load_dwordx4 v[56:59], v1, s[4:7], s20 offen offset:1024 sc1
    s_add_u32 s20, s21, 4096
    buffer_load_dwordx4 v[60:63], v1, s[4:7], s20 offen offset:1024 sc1
    s_add_u32 s20, s21, 8192
    buffer_load_dwordx4 v[64:67], v1, s[4:7], s20 offen offset:1024 sc1
    s_add_u32 s20, s21, 12288
    buffer_load_dwordx4 v[68:71], v1, s[4:7], s20 offen offset:1024 sc1
    s_add_u32 s20, s21, 0
    buffer_load_dwordx4 v[88:91], v1, s[4:7], s20 offen offset:2048 sc1
    s_add_u32 s20, s21, 4096
    buffer_load_dwordx4 v[92:95], v1, s[4:7], s20 offen offset:2048 sc1
    s_add_u32 s20, s21, 8192
    buffer_load_dwordx4 v[96:99], v1, s[4:7], s20 offen offset:2048 sc1
    s_add_u32 s20, s21, 12288
    buffer_load_dwordx4 v[100:103], v1, s[4:7], s20 offen offset:2048 sc1
    s_add_u32 s20, s21, 0
    buffer_load_dwordx4 v[104:107], v1, s[4:7], s20 offen offset:3072 sc1
    s_add_u32 s20, s21, 4096
    buffer_load_dwordx4 v[108:111], v1, s[4:7], s20 offen offset:3072 sc1
    s_add_u32 s20, s21, 8192
    buffer_load_dwordx4 v[112:115], v1, s[4:7], s20 offen offset:3072 sc1
    s_add_u32 s20, s21, 12288
    buffer_load_dwordx4 v[116:119], v1, s[4:7], s20 offen offset:3072 sc1
    v_mov_b32 v172, 0x3f803f80
    v_mov_b32 v173, 0x3f803f80
    v_mov_b32 v174, 0x3f803f80
    v_mov_b32 v175, 0x3f803f80
    v_mov_b32 v176, 0x3f003f00
    v_mov_b32 v177, 0x3f003f00
    s_waitcnt vmcnt(8)
    v_mfma_f32_16x16x32_bf16 v[136:139], v[40:43], v[8:11], 0
    v_mfma_f32_16x16x32_bf16 v[140:143], v[56:59], v[8:11], 0
    v_mfma_f32_16x16x32_bf16 v[148:151], v[40:43], v[24:27], 0
    v_mfma_f32_16x16x32_bf16 v[152:155], v[56:59], v[24:27], 0
    v_mfma_f32_16x16x32_bf16 v[136:139], v[44:47], v[12:15], v[136:139]
    v_mfma_f32_16x16x32_bf16 v[140:143], v[60:63], v[12:15], v[140:143]
    v_mfma_f32_16x16x32_bf16 v[148:151], v[44:47], v[28:31], v[148:151]
    v_mfma_f32_16x16x32_bf16 v[152:155], v[60:63], v[28:31], v[152:155]
    v_mfma_f32_16x16x32_bf16 v[136:139], v[48:51], v[16:19], v[136:139]
    v_mfma_f32_16x16x32_bf16 v[140:143], v[64:67], v[16:19], v[140:143]
    v_mfma_f32_16x16x32_bf16 v[148:151], v[48:51], v[32:35], v[148:151]
    v_mfma_f32_16x16x32_bf16 v[152:155], v[64:67], v[32:35], v[152:155]
    v_mfma_f32_16x16x32_bf16 v[136:139], v[52:55], v[20:23], v[136:139]
    v_mfma_f32_16x16x32_bf16 v[140:143], v[68:71], v[20:23], v[140:143]
    v_mfma_f32_16x16x32_bf16 v[148:151], v[52:55], v[36:39], v[148:151]
    v_mfma_f32_16x16x32_bf16 v[152:155], v[68:71], v[36:39], v[152:155]
    v_cmp_le_i32 vcc, 0, v4
    s_nop 3
    v_cndmask_b32 v136, v6, v136, vcc
    v_cmp_le_i32 vcc, 1, v4
    s_nop 1
    v_cndmask_b32 v137, v6, v137, vcc
    v_cmp_le_i32 vcc, 2, v4
    s_nop 1
    v_cndmask_b32 v138, v6, v138, vcc
    v_cmp_le_i32 vcc, 3, v4
    s_nop 1
    v_cndmask_b32 v139, v6, v139, vcc
    v_cmp_le_i32 vcc, 4, v4
    s_nop 1
    v_cndmask_b32 v140, v6, v140, vcc
    v_cmp_le_i32 vcc, 5, v4
    s_nop 1
    v_cndmask_b32 v141, v6, v141, vcc
    v_cmp_le_i32 vcc, 6, v4
    s_nop 1
    v_cndmask_b32 v142, v6, v142, vcc
    v_cmp_le_i32 vcc, 7, v4
    s_nop 1
    v_cndmask_b32 v143, v6, v143, vcc
    v_cmp_le_i32 vcc, -4, v4
    s_nop 1
    v_cndmask_b32 v148, v6, v148, vcc
    v_cmp_le_i32 vcc, -3, v4
    s_nop 1
    v_cndmask_b32 v149, v6, v149, vcc
    v_cmp_le_i32 vcc, -2, v4
    s_nop 1
    v_cndmask_b32 v150, v6, v150, vcc
    v_cmp_le_i32 vcc, -1, v4
    s_nop 1
    v_cndmask_b32 v151, v6, v151, vcc
    v_cmp_le_i32 vcc, 0, v4
    s_nop 1
    v_cndmask_b32 v152, v6, v152, vcc
    v_cmp_le_i32 vcc, 1, v4
    s_nop 1
    v_cndmask_b32 v153, v6, v153, vcc
    v_cmp_le_i32 vcc, 2, v4
    s_nop 1
    v_cndmask_b32 v154, v6, v154, vcc
    v_cmp_le_i32 vcc, 3, v4
    s_nop 1
    v_cndmask_b32 v155, v6, v155, vcc
    s_nop 1
    v_and_b32 v198, 1, v0
    v_lshlrev_b32 v198, 2, v198
    v_add_u32 v198, 48, v198
    s_add_u32 s41, s16, s95
    s_add_u32 s41, s41, 1
    s_cmp_lt_u32 s16, 56
    s_cbranch_scc1 L_amk
    v_mov_b32 v198, 16384
    s_sub_u32 s41, s41, 1
    s_mov_b32 s44, 8
L_amk:
    s_sub_u32 s43, s41, s95
    s_sub_u32 s43, s43, 1
    s_mov_b32 s88, 65536
    s_mov_b32 s89, 125853696
cw16:
    buffer_load_dword v199, off, s[4:7], s89 sc1
    s_waitcnt vmcnt(0)
    v_readfirstlane_b32 s42, v199
    s_nop 0
    s_sub_u32 s42, s42, s95
    s_cmp_gt_u32 s42, 64
    s_cselect_b32 s42, 0, s42
    s_add_u32 s42, s42, 1
    s_cmp_ge_u32 s42, s43
    s_cbranch_scc1 cw16x
    s_sub_u32 s88, s88, 1
    s_cbranch_scc1 cw16x
    s_sub_u32 s42, s43, s42
    s_min_u32 s42, s42, 6
cw16s:
    s_sleep 24
    s_sub_u32 s42, s42, 1
    s_cmp_lg_u32 s42, 0
    s_cbranch_scc1 cw16s
    s_branch cw16
cw16x:
    s_mov_b32 s40, 4194304
L_aw2:
    buffer_load_dword v199, v198, s[4:7], s36 offen sc1
    s_sub_u32 s40, s40, 1
    s_cbranch_scc1 L_aw2_go
    s_waitcnt vmcnt(0)
    v_subrev_u32 v199, s41, v199
    v_cmp_lt_u32 vcc, 64, v199
    s_cbranch_vccz L_aw2_go
    s_sleep 1
    s_branch L_aw2
L_aw2_go:
at_ldm:
    s_lshl_b32 s20, s18, 12
    s_add_u32 s20, s20, 69206016
    buffer_load_dwordx4 v[72:75], v3, s[4:7], s20 offen offset:0 sc1
    buffer_load_dwordx4 v[76:79], v3, s[4:7], s20 offen offset:1024 sc1
    buffer_load_dwordx4 v[80:83], v3, s[4:7], s20 offen offset:2048 sc1
    buffer_load_dwordx4 v[84:87], v3, s[4:7], s20 offen offset:3072 sc1
    s_lshl_b32 s20, s18, 12
    s_add_u32 s20, s20, 77594624
    buffer_load_dwordx4 v[120:123], v2, s[4:7], s20 offen offset:0 sc1
    buffer_load_dwordx4 v[124:127], v2, s[4:7], s20 offen offset:1024 sc1
    buffer_load_dwordx4 v[128:131], v2, s[4:7], s20 offen offset:2048 sc1
    buffer_load_dwordx4 v[132:135], v2, s[4:7], s20 offen offset:3072 sc1
    s_cmp_lt_u32 s16, 56
    s_cbranch_scc1 at_ok
    s_waitcnt vmcnt(0)
    v_and_b32 v196, v72, v73
    v_and_b32 v197, v76, v77
    v_max_u32 v196, v196, v197
    v_and_b32 v197, v80, v81
    v_max_u32 v196, v196, v197
    v_and_b32 v197, v84, v85
    v_max_u32 v196, v196, v197
    v_and_b32 v197, v120, v121
    v_max_u32 v196, v196, v197
    v_and_b32 v197, v124, v125
    v_max_u32 v196, v196, v197
    v_and_b32 v197, v128, v129
    v_max_u32 v196, v196, v197
    v_and_b32 v197, v132, v133
    v_max_u32 v196, v196, v197
    v_cmp_eq_u32 vcc, -1, v196
    s_cbranch_vccz at_ok
    s_sub_u32 s44, s44, 1
    s_cbranch_scc1 at_ok
    s_cmp_lg_u32 s44, 0
    s_cbranch_scc1 at_ldm
    s_add_u32 s41, s41, 1
    s_mov_b32 s40, 4194304
L_aw3:
    buffer_load_dword v199, v198, s[4:7], s36 offen sc1
    s_sub_u32 s40, s40, 1
    s_cbranch_scc1 L_aw3_go
    s_waitcnt vmcnt(0)
    v_subrev_u32 v199, s41, v199
    v_cmp_lt_u32 vcc, 64, v199
    s_cbranch_vccz L_aw3_go
    s_sleep 1
    s_branch L_aw3
L_aw3_go:
    s_branch at_ldm
at_ok:
    s_waitcnt vmcnt(4)
    v_mfma_f32_16x16x32_bf16 v[144:147], v[72:75], v[8:11], 0
    v_mfma_f32_16x16x32_bf16 v[156:159], v[72:75], v[24:27], 0
    v_mfma_f32_16x16x32_bf16 v[144:147], v[76:79], v[12:15], v[144:147]
    v_mfma_f32_16x16x32_bf16 v[156:159], v[76:79], v[28:31], v[156:159]
    v_mfma_f32_16x16x32_bf16 v[144:147], v[80:83], v[16:19], v[144:147]
    v_mfma_f32_16x16x32_bf16 v[156:159], v[80:83], v[32:35], v[156:159]
    v_mfma_f32_16x16x32_bf16 v[144:147], v[84:87], v[20:23], v[144:147]
    v_mfma_f32_16x16x32_bf16 v[156:159], v[84:87], v[36:39], v[156:159]
    v_max3_f32 v196, v136, v137, v138
    v_max3_f32 v197, v139, v140, v141
    v_max3_f32 v196, v196, v142, v143
    s_nop 3
    v_max3_f32 v197, v197, v144, v145
    v_max3_f32 v196, v196, v146, v147
    v_max_f32 v196, v196, v197
    v_mov_b32 v197, v196
    s_nop 1
    v_permlane32_swap_b32 v196, v197
    v_max_f32 v196, v196, v197
    v_mov_b32 v197, v196
    s_nop 1
    v_permlane16_swap_b32 v196, v197
    v_max_f32 v196, v196, v197
    v_mul_f32 v196, s22, v196
    v_sub_f32 v196, 0, v196
    v_fma_f32 v136, v136, s22, v196
    v_fma_f32 v137, v137, s22, v196
    v_fma_f32 v138, v138, s22, v196
    v_fma_f32 v139, v139, s22, v196
    v_fma_f32 v140, v140, s22, v196
    v_fma_f32 v141, v141, s22, v196
    v_fma_f32 v142, v142, s22, v196
    v_fma_f32 v143, v143, s22, v196
    v_fma_f32 v144, v144, s22, v196
    v_fma_f32 v145, v145, s22, v196
    v_fma_f32 v146, v146, s22, v196
    v_fma_f32 v147, v147, s22, v196
    v_exp_f32 v136, v136
    v_exp_f32 v137, v137
    v_exp_f32 v138, v138
    v_exp_f32 v139, v139
    v_exp_f32 v140, v140
    v_exp_f32 v141, v141
    v_exp_f32 v142, v142
    v_exp_f32 v143, v143
    v_exp_f32 v144, v144
    v_exp_f32 v145, v145
    v_exp_f32 v146, v146
    v_exp_f32 v147, v147
    v_cvt_pk_bf16_f32 v160, v136, v137
    v_cvt_pk_bf16_f32 v161, v138, v139
    v_cvt_pk_bf16_f32 v162, v140, v141
    v_cvt_pk_bf16_f32 v163, v142, v143
    v_cvt_pk_bf16_f32 v164, v144, v145
    v_cvt_pk_bf16_f32 v165, v146, v147
    v_max3_f32 v196, v148, v149, v150
    v_max3_f32 v197, v151, v152, v153
    v_max3_f32 v196, v196, v154, v155
    v_max3_f32 v197, v197, v156, v157
    v_max3_f32 v196, v196, v158, v159
    v_max_f32 v196, v196, v197
    v_mov_b32 v197, v196
    s_nop 1
    v_permlane32_swap_b32 v196, v197
    v_max_f32 v196, v196, v197
    v_mov_b32 v197, v196
    s_nop 1
    v_permlane16_swap_b32 v196, v197
    v_max_f32 v196, v196, v197
    v_mul_f32 v196, s22, v196
    v_sub_f32 v196, 0, v196
    v_fma_f32 v148, v148, s22, v196
    v_fma_f32 v149, v149, s22, v196
    v_fma_f32 v150, v150, s22, v196
    v_fma_f32 v151, v151, s22, v196
    v_fma_f32 v152, v152, s22, v196
    v_fma_f32 v153, v153, s22, v196
    v_fma_f32 v154, v154, s22, v196
    v_fma_f32 v155, v155, s22, v196
    v_fma_f32 v156, v156, s22, v196
    v_fma_f32 v157, v157, s22, v196
    v_fma_f32 v158, v158, s22, v196
    v_fma_f32 v159, v159, s22, v196
    v_exp_f32 v148, v148
    v_exp_f32 v149, v149
    v_exp_f32 v150, v150
    v_exp_f32 v151, v151
    v_exp_f32 v152, v152
    v_exp_f32 v153, v153
    v_exp_f32 v154, v154
    v_exp_f32 v155, v155
    v_exp_f32 v156, v156
    v_exp_f32 v157, v157
    v_exp_f32 v158, v158
    v_exp_f32 v159, v159
    v_cvt_pk_bf16_f32 v166, v148, v149
    v_cvt_pk_bf16_f32 v167, v150, v151
    v_cvt_pk_bf16_f32 v168, v152, v153
    v_cvt_pk_bf16_f32 v169, v154, v155
    v_cvt_pk_bf16_f32 v170, v156, v157
    v_cvt_pk_bf16_f32 v171, v158, v159
    v_mfma_f32_16x16x32_bf16 v[180:183], v[172:175], v[160:163], 0
    v_mfma_f32_16x16x32_bf16 v[184:187], v[172:175], v[166:169], 0
    s_nop 4
    v_mfma_f32_16x16x16_bf16 v[180:183], v[176:177], v[164:165], v[180:183]
    v_mfma_f32_16x16x16_bf16 v[184:187], v[176:177], v[170:171], v[184:187]
    s_nop 6
    v_rcp_f32 v180, v180
    v_rcp_f32 v184, v184
    s_waitcnt vmcnt(0)
    s_lshl_b32 s18, s16, 18
    s_lshl_b32 s19, s17, 12
    s_add_u32 s18, s18, s19
    s_add_u32 s18, s18, 50331648
    s_add_u32 s19, s18, 131072
    v_mfma_f32_16x16x32_bf16 v[8:11], v[88:91], v[160:163], 0
    v_mfma_f32_16x16x32_bf16 v[12:15], v[104:107], v[160:163], 0
    v_mfma_f32_16x16x32_bf16 v[16:19], v[88:91], v[166:169], 0
    v_mfma_f32_16x16x32_bf16 v[20:23], v[104:107], v[166:169], 0
    v_mfma_f32_16x16x32_bf16 v[24:27], v[92:95], v[160:163], 0
    v_mfma_f32_16x16x32_bf16 v[28:31], v[108:111], v[160:163], 0
    v_mfma_f32_16x16x32_bf16 v[32:35], v[92:95], v[166:169], 0
    v_mfma_f32_16x16x32_bf16 v[36:39], v[108:111], v[166:169], 0
    v_mfma_f32_16x16x32_bf16 v[40:43], v[96:99], v[160:163], 0
    v_mfma_f32_16x16x32_bf16 v[44:47], v[112:115], v[160:163], 0
    v_mfma_f32_16x16x32_bf16 v[48:51], v[96:99], v[166:169], 0
    v_mfma_f32_16x16x32_bf16 v[52:55], v[112:115], v[166:169], 0
    v_mfma_f32_16x16x32_bf16 v[56:59], v[100:103], v[160:163], 0
    v_mfma_f32_16x16x32_bf16 v[60:63], v[116:119], v[160:163], 0
    v_mfma_f32_16x16x32_bf16 v[64:67], v[100:103], v[166:169], 0
    v_mfma_f32_16x16x32_bf16 v[68:71], v[116:119], v[166:169], 0
    v_mfma_f32_16x16x16_bf16 v[8:11], v[120:121], v[164:165], v[8:11]
    v_mfma_f32_16x16x16_bf16 v[12:15], v[122:123], v[164:165], v[12:15]
    v_mfma_f32_16x16x16_bf16 v[16:19], v[120:121], v[170:171], v[16:19]
    v_mfma_f32_16x16x16_bf16 v[20:23], v[122:123], v[170:171], v[20:23]
    v_mfma_f32_16x16x16_bf16 v[24:27], v[124:125], v[164:165], v[24:27]
    v_mfma_f32_16x16x16_bf16 v[28:31], v[126:127], v[164:165], v[28:31]
    v_mfma_f32_16x16x16_bf16 v[32:35], v[124:125], v[170:171], v[32:35]
    v_mfma_f32_16x16x16_bf16 v[36:39], v[126:127], v[170:171], v[36:39]
    v_mfma_f32_16x16x16_bf16 v[40:43], v[128:129], v[164:165], v[40:43]
    v_mfma_f32_16x16x16_bf16 v[44:47], v[130:131], v[164:165], v[44:47]
    v_mfma_f32_16x16x16_bf16 v[48:51], v[128:129], v[170:171], v[48:51]
    v_mfma_f32_16x16x16_bf16 v[52:55], v[130:131], v[170:171], v[52:55]
    v_mfma_f32_16x16x16_bf16 v[56:59], v[132:133], v[164:165], v[56:59]
    v_mfma_f32_16x16x16_bf16 v[60:63], v[134:135], v[164:165], v[60:63]
    v_mfma_f32_16x16x16_bf16 v[64:67], v[132:133], v[170:171], v[64:67]
    v_mfma_f32_16x16x16_bf16 v[68:71], v[134:135], v[170:171], v[68:71]
    v_mul_f32 v8, v8, v180
    v_mul_f32 v12, v12, v180
    v_mul_f32 v9, v9, v180
    v_mul_f32 v13, v13, v180
    v_mul_f32 v10, v10, v180
    v_mul_f32 v14, v14, v180
    v_mul_f32 v11, v11, v180
    v_mul_f32 v15, v15, v180
    v_cvt_pk_bf16_f32 v8, v8, v9
    v_cvt_pk_bf16_f32 v9, v10, v11
    v_cvt_pk_bf16_f32 v10, v12, v13
    v_cvt_pk_bf16_f32 v11, v14, v15
    buffer_store_dwordx4 v[8:11], v1, s[4:7], s18 offen offset:0 sc1
    v_mul_f32 v16, v16, v184
    v_mul_f32 v20, v20, v184
    v_mul_f32 v17, v17, v184
    v_mul_f32 v21, v21, v184
    v_mul_f32 v18, v18, v184
    v_mul_f32 v22, v22, v184
    v_mul_f32 v19, v19, v184
    v_mul_f32 v23, v23, v184
    v_cvt_pk_bf16_f32 v16, v16, v17
    v_cvt_pk_bf16_f32 v17, v18, v19
    v_cvt_pk_bf16_f32 v18, v20, v21
    v_cvt_pk_bf16_f32 v19, v22, v23
    buffer_store_dwordx4 v[16:19], v1, s[4:7], s19 offen offset:0 sc1
    v_mul_f32 v24, v24, v180
    v_mul_f32 v28, v28, v180
    v_mul_f32 v25, v25, v180
    v_mul_f32 v29, v29, v180
    v_mul_f32 v26, v26, v180
    v_mul_f32 v30, v30, v180
    v_mul_f32 v27, v27, v180
    v_mul_f32 v31, v31, v180
    v_cvt_pk_bf16_f32 v24, v24, v25
    v_cvt_pk_bf16_f32 v25, v26, v27
    v_cvt_pk_bf16_f32 v26, v28, v29
    v_cvt_pk_bf16_f32 v27, v30, v31
    buffer_store_dwordx4 v[24:27], v1, s[4:7], s18 offen offset:1024 sc1
    v_mul_f32 v32, v32, v184
    v_mul_f32 v36, v36, v184
    v_mul_f32 v33, v33, v184
    v_mul_f32 v37, v37, v184
    v_mul_f32 v34, v34, v184
    v_mul_f32 v38, v38, v184
    v_mul_f32 v35, v35, v184
    v_mul_f32 v39, v39, v184
    v_cvt_pk_bf16_f32 v32, v32, v33
    v_cvt_pk_bf16_f32 v33, v34, v35
    v_cvt_pk_bf16_f32 v34, v36, v37
    v_cvt_pk_bf16_f32 v35, v38, v39
    buffer_store_dwordx4 v[32:35], v1, s[4:7], s19 offen offset:1024 sc1
    v_mul_f32 v40, v40, v180
    v_mul_f32 v44, v44, v180
    v_mul_f32 v41, v41, v180
    v_mul_f32 v45, v45, v180
    v_mul_f32 v42, v42, v180
    v_mul_f32 v46, v46, v180
    v_mul_f32 v43, v43, v180
    v_mul_f32 v47, v47, v180
    v_cvt_pk_bf16_f32 v40, v40, v41
    v_cvt_pk_bf16_f32 v41, v42, v43
    v_cvt_pk_bf16_f32 v42, v44, v45
    v_cvt_pk_bf16_f32 v43, v46, v47
    buffer_store_dwordx4 v[40:43], v1, s[4:7], s18 offen offset:2048 sc1
    v_mul_f32 v48, v48, v184
    v_mul_f32 v52, v52, v184
    v_mul_f32 v49, v49, v184
    v_mul_f32 v53, v53, v184
    v_mul_f32 v50, v50, v184
    v_mul_f32 v54, v54, v184
    v_mul_f32 v51, v51, v184
    v_mul_f32 v55, v55, v184
    v_cvt_pk_bf16_f32 v48, v48, v49
    v_cvt_pk_bf16_f32 v49, v50, v51
    v_cvt_pk_bf16_f32 v50, v52, v53
    v_cvt_pk_bf16_f32 v51, v54, v55
    buffer_store_dwordx4 v[48:51], v1, s[4:7], s19 offen offset:2048 sc1
    v_mul_f32 v56, v56, v180
    v_mul_f32 v60, v60, v180
    v_mul_f32 v57, v57, v180
    v_mul_f32 v61, v61, v180
    v_mul_f32 v58, v58, v180
    v_mul_f32 v62, v62, v180
    v_mul_f32 v59, v59, v180
    v_mul_f32 v63, v63, v180
    v_cvt_pk_bf16_f32 v56, v56, v57
    v_cvt_pk_bf16_f32 v57, v58, v59
    v_cvt_pk_bf16_f32 v58, v60, v61
    v_cvt_pk_bf16_f32 v59, v62, v63
    buffer_store_dwordx4 v[56:59], v1, s[4:7], s18 offen offset:3072 sc1
    v_mul_f32 v64, v64, v184
    v_mul_f32 v68, v68, v184
    v_mul_f32 v65, v65, v184
    v_mul_f32 v69, v69, v184
    v_mul_f32 v66, v66, v184
    v_mul_f32 v70, v70, v184
    v_mul_f32 v67, v67, v184
    v_mul_f32 v71, v71, v184
    v_cvt_pk_bf16_f32 v64, v64, v65
    v_cvt_pk_bf16_f32 v65, v66, v67
    v_cvt_pk_bf16_f32 v66, v68, v69
    v_cvt_pk_bf16_f32 v67, v70, v71
    buffer_store_dwordx4 v[64:67], v1, s[4:7], s19 offen offset:3072 sc1
    s_lshr_b32 s40, s34, 1
    s_lshl_b32 s40, s40, 7
    s_and_b32 s41, s34, 1
    s_lshl_b32 s41, s41, 2
    s_add_u32 s40, s40, s41
    s_add_u32 s40, s40, 125894656
    s_cmp_lt_u32 s16, 62
    s_cbranch_scc1 L_noef
    s_lshr_b32 s42, s34, 1
    s_mul_i32 s42, s42, 4096
    s_add_u32 s41, s41, s42
    s_add_u32 s41, s41, 124944384
    s_barrier
    s_cmp_lg_u32 s32, 0
    s_cbranch_scc1 L_noef
    v_mov_b32 v250, s95
    v_lshlrev_b32 v251, 7, v0
    s_mov_b64 exec, 262143
    buffer_store_dword v250, v251, s[4:7], s41 offen sc1
    s_mov_b64 exec, -1
L_noef:
    s_waitcnt vmcnt(0)
    s_barrier
    v_mov_b32 v250, s95
    v_cmp_eq_u32 vcc, 0, v0
    s_nop 0
    s_and_saveexec_b64 s[38:39], vcc
    s_cbranch_execz fs17
    buffer_store_dword v250, off, s[4:7], s40 sc1
fs17:
    s_mov_b64 exec, -1
    s_branch L_att_next
L_op_start:
    s_lshl_b32 s35, s33, 2
    s_add_u32 s35, s35, 136
    s_lshr_b32 s89, s33, 2
    s_lshl_b32 s89, s89, 7
    s_add_u32 s89, s89, 125841408
    v_mbcnt_lo_u32_b32 v2, -1, 0
    v_mbcnt_hi_u32_b32 v2, -1, v2
    v_min_u32 v2, 31, v2
    v_lshlrev_b32 v2, 2, v2
    s_mov_b32 s88, 4194304
fw18:
    buffer_load_dword v3, v2, s[4:7], s89 offen offset:0 sc1
    s_sub_u32 s88, s88, 1
    s_cbranch_scc1 fw18x
    s_waitcnt vmcnt(0)
    v_cmp_ne_u32 vcc, s95, v3
    s_cbranch_vccz fw18x
    s_sleep 4
    s_branch fw18
fw18x:
    v_and_b32 v1, 63, v0
    v_lshlrev_b32 v1, 4, v1
    s_lshl_b32 s18, s33, 18
    s_lshl_b32 s19, s32, 16
    s_add_u32 s18, s18, s19
    s_add_u32 s18, s18, 130023424
    buffer_load_dwordx4 a[0:3], v1, s[4:7], s18 offen offset:0 sc1
    buffer_load_dwordx4 a[4:7], v1, s[4:7], s18 offen offset:1024 sc1
    buffer_load_dwordx4 a[8:11], v1, s[4:7], s18 offen offset:2048 sc1
    buffer_load_dwordx4 a[12:15], v1, s[4:7], s18 offen offset:3072 sc1
    s_add_u32 s18, s18, 4096
    buffer_load_dwordx4 a[16:19], v1, s[4:7], s18 offen offset:0 sc1
    buffer_load_dwordx4 a[20:23], v1, s[4:7], s18 offen offset:1024 sc1
    buffer_load_dwordx4 a[24:27], v1, s[4:7], s18 offen offset:2048 sc1
    buffer_load_dwordx4 a[28:31], v1, s[4:7], s18 offen offset:3072 sc1
    s_add_u32 s18, s18, 4096
    buffer_load_dwordx4 a[32:35], v1, s[4:7], s18 offen offset:0 sc1
    buffer_load_dwordx4 a[36:39], v1, s[4:7], s18 offen offset:1024 sc1
    buffer_load_dwordx4 a[40:43], v1, s[4:7], s18 offen offset:2048 sc1
    buffer_load_dwordx4 a[44:47], v1, s[4:7], s18 offen offset:3072 sc1
    s_add_u32 s18, s18, 4096
    buffer_load_dwordx4 a[48:51], v1, s[4:7], s18 offen offset:0 sc1
    buffer_load_dwordx4 a[52:55], v1, s[4:7], s18 offen offset:1024 sc1
    buffer_load_dwordx4 a[56:59], v1, s[4:7], s18 offen offset:2048 sc1
    buffer_load_dwordx4 a[60:63], v1, s[4:7], s18 offen offset:3072 sc1
    s_add_u32 s18, s18, 4096
    buffer_load_dwordx4 a[64:67], v1, s[4:7], s18 offen offset:0 sc1
    buffer_load_dwordx4 a[68:71], v1, s[4:7], s18 offen offset:1024 sc1
    buffer_load_dwordx4 a[72:75], v1, s[4:7], s18 offen offset:2048 sc1
    buffer_load_dwordx4 a[76:79], v1, s[4:7], s18 offen offset:3072 sc1
    s_add_u32 s18, s18, 4096
    buffer_load_dwordx4 a[80:83], v1, s[4:7], s18 offen offset:0 sc1
    buffer_load_dwordx4 a[84:87], v1, s[4:7], s18 offen offset:1024 sc1
    buffer_load_dwordx4 a[88:91], v1, s[4:7], s18 offen offset:2048 sc1
    buffer_load_dwordx4 a[92:95], v1, s[4:7], s18 offen offset:3072 sc1
    s_add_u32 s18, s18, 4096
    buffer_load_dwordx4 a[96:99], v1, s[4:7], s18 offen offset:0 sc1
    buffer_load_dwordx4 a[100:103], v1, s[4:7], s18 offen offset:1024 sc1
    buffer_load_dwordx4 a[104:107], v1, s[4:7], s18 offen offset:2048 sc1
    buffer_load_dwordx4 a[108:111], v1, s[4:7], s18 offen offset:3072 sc1
    s_add_u32 s18, s18, 4096
    buffer_load_dwordx4 a[112:115], v1, s[4:7], s18 offen offset:0 sc1
    buffer_load_dwordx4 a[116:119], v1, s[4:7], s18 offen offset:1024 sc1
    buffer_load_dwordx4 a[120:123], v1, s[4:7], s18 offen offset:2048 sc1
    buffer_load_dwordx4 a[124:127], v1, s[4:7], s18 offen offset:3072 sc1
    s_add_u32 s18, s18, 4096
    buffer_load_dwordx4 a[128:131], v1, s[4:7], s18 offen offset:0 sc1
    buffer_load_dwordx4 a[132:135], v1, s[4:7], s18 offen offset:1024 sc1
    buffer_load_dwordx4 a[136:139], v1, s[4:7], s18 offen offset:2048 sc1
    buffer_load_dwordx4 a[140:143], v1, s[4:7], s18 offen offset:3072 sc1
    s_add_u32 s18, s18, 4096
    buffer_load_dwordx4 a[144:147], v1, s[4:7], s18 offen offset:0 sc1
    buffer_load_dwordx4 a[148:151], v1, s[4:7], s18 offen offset:1024 sc1
    buffer_load_dwordx4 a[152:155], v1, s[4:7], s18 offen offset:2048 sc1
    buffer_load_dwordx4 a[156:159], v1, s[4:7], s18 offen offset:3072 sc1
    s_add_u32 s18, s18, 4096
    buffer_load_dwordx4 a[160:163], v1, s[4:7], s18 offen offset:0 sc1
    s_waitcnt vmcnt(20)
    buffer_load_dwordx4 a[164:167], v1, s[4:7], s18 offen offset:1024 sc1
    buffer_load_dwordx4 a[168:171], v1, s[4:7], s18 offen offset:2048 sc1
    buffer_load_dwordx4 a[172:175], v1, s[4:7], s18 offen offset:3072 sc1
    s_add_u32 s18, s18, 4096
    buffer_load_dwordx4 a[176:179], v1, s[4:7], s18 offen offset:0 sc1
    buffer_load_dwordx4 a[180:183], v1, s[4:7], s18 offen offset:1024 sc1
    buffer_load_dwordx4 a[184:187], v1, s[4:7], s18 offen offset:2048 sc1
    buffer_load_dwordx4 a[188:191], v1, s[4:7], s18 offen offset:3072 sc1
    s_add_u32 s18, s18, 4096
    buffer_load_dwordx4 a[192:195], v1, s[4:7], s18 offen offset:0 sc1
    buffer_load_dwordx4 a[196:199], v1, s[4:7], s18 offen offset:1024 sc1
    buffer_load_dwordx4 a[200:203], v1, s[4:7], s18 offen offset:2048 sc1
    buffer_load_dwordx4 a[204:207], v1, s[4:7], s18 offen offset:3072 sc1
    s_add_u32 s18, s18, 4096
    buffer_load_dwordx4 a[208:211], v1, s[4:7], s18 offen offset:0 sc1
    buffer_load_dwordx4 a[212:215], v1, s[4:7], s18 offen offset:1024 sc1
    buffer_load_dwordx4 a[216:219], v1, s[4:7], s18 offen offset:2048 sc1
    buffer_load_dwordx4 a[220:223], v1, s[4:7], s18 offen offset:3072 sc1
    s_add_u32 s18, s18, 4096
    buffer_load_dwordx4 a[224:227], v1, s[4:7], s18 offen offset:0 sc1
    buffer_load_dwordx4 a[228:231], v1, s[4:7], s18 offen offset:1024 sc1
    buffer_load_dwordx4 a[232:235], v1, s[4:7], s18 offen offset:2048 sc1
    buffer_load_dwordx4 a[236:239], v1, s[4:7], s18 offen offset:3072 sc1
    s_add_u32 s18, s18, 4096
    buffer_load_dwordx4 a[240:243], v1, s[4:7], s18 offen offset:0 sc1
    buffer_load_dwordx4 a[244:247], v1, s[4:7], s18 offen offset:1024 sc1
    buffer_load_dwordx4 a[248:251], v1, s[4:7], s18 offen offset:2048 sc1
    buffer_load_dwordx4 a[252:255], v1, s[4:7], s18 offen offset:3072 sc1
    s_waitcnt vmcnt(0)
    s_mov_b32 s44, 0
    s_mov_b32 s37, s35
    v_mov_b32 v250, 1
    v_mov_b32 v251, 163832
    v_cmp_eq_u32 vcc, 0, v0
    s_nop 0
    s_and_saveexec_b64 s[38:39], vcc
    s_cbranch_execz tk19
    buffer_atomic_add v250, off, s[84:87], s37 sc0
    s_waitcnt vmcnt(0)
    ds_write_b32 v251, v250
    s_waitcnt lgkmcnt(0)
tk19:
    s_mov_b64 exec, -1
    s_barrier
    ds_read_b32 v252, v251
    s_waitcnt lgkmcnt(0)
    v_readfirstlane_b32 s16, v252
    s_barrier
    s_nop 3
    s_cmp_ge_u32 s16, 72
    s_cbranch_scc1 L_op_nextcb
L_op_seg:
    s_min_u32 s43, s16, 56
    s_add_u32 s16, s16, s43
    s_lshr_b32 s43, s16, 1
    s_add_u32 s43, s43, 2
    s_min_u32 s43, s43, 63
    s_lshl_b32 s94, s33, 7
    s_add_u32 s94, s94, s16
    s_mov_b32 s88, 65536
    s_mov_b32 s89, 125853696
cw20:
    buffer_load_dword v3, off, s[4:7], s89 sc1
    s_waitcnt vmcnt(0)
    v_readfirstlane_b32 s42, v3
    s_nop 0
    s_sub_u32 s42, s42, s95
    s_cmp_gt_u32 s42, 64
    s_cselect_b32 s42, 0, s42
    s_add_u32 s42, s42, 1
    s_cmp_ge_u32 s42, s43
    s_cbranch_scc1 cw20x
    s_sub_u32 s88, s88, 1
    s_cbranch_scc1 cw20x
    s_sub_u32 s42, s43, s42
    s_min_u32 s42, s42, 6
cw20s:
    s_sleep 24
    s_sub_u32 s42, s42, 1
    s_cmp_lg_u32 s42, 0
    s_cbranch_scc1 cw20s
    s_branch cw20
cw20x:
    s_lshr_b32 s89, s16, 1
    s_lshl_b32 s89, s89, 2
    s_add_u32 s89, s89, s32
    s_lshl_b32 s89, s89, 7
    s_add_u32 s89, s89, 125894656
    s_sub_u32 s47, s89, 125894656
    s_lshl_b32 s47, s47, 5
    s_lshl_b32 s46, s33, 7
    s_add_u32 s47, s47, s46
    s_add_u32 s47, s47, 124944384
    s_cmp_ge_u32 s16, 124
    s_cselect_b32 s46, 8, 0
    s_cselect_b32 s47, s47, s89
    v_mbcnt_lo_u32_b32 v2, -1, 0
    v_mbcnt_hi_u32_b32 v2, -1, v2
    v_min_u32 v2, 1, v2
    v_lshlrev_b32 v2, 2, v2
    s_mov_b32 s88, 4194304
fw21:
    buffer_load_dword v3, v2, s[4:7], s47 offen offset:0 sc1
    s_sub_u32 s88, s88, 1
    s_cbranch_scc1 fw21x
    s_waitcnt vmcnt(0)
    v_cmp_ne_u32 vcc, s95, v3
    s_cbranch_vccz fw21x
    s_sleep 1
    s_branch fw21
fw21x:
    v_mov_b32 v250, 1
    v_lshrrev_b32 v252, 2, v1
    v_min_u32 v252, 68, v252
    s_cmp_lg_u32 s32, 0
    s_cbranch_scc1 L_op_na
    s_mov_b64 exec, 1
    buffer_atomic_add v250, off, s[84:87], s35 sc0
    s_mov_b64 exec, -1
    s_cmp_lg_u32 s44, 0
    s_cbranch_scc1 L_op_na
    buffer_load_dword v253, v252, s[84:87], 0 offen offset:136 sc1
L_op_na:
    s_cmp_ge_u32 s16, 112
    s_cbranch_scc1 L_op_one
o2_again:
    s_lshl_b32 s18, s16, 17
    s_lshl_b32 s19, s32, 15
    s_add_u32 s18, s18, s19
    s_add_u32 s18, s18, 50331648
    buffer_load_dwordx4 v[24:27], v1, s[4:7], s18 offen offset:0 sc1
    buffer_load_dwordx4 v[28:31], v1, s[4:7], s18 offen offset:1024 sc1
    buffer_load_dwordx4 v[32:35], v1, s[4:7], s18 offen offset:2048 sc1
    buffer_load_dwordx4 v[36:39], v1, s[4:7], s18 offen offset:3072 sc1
    s_add_u32 s18, s18, 4096
    buffer_load_dwordx4 v[40:43], v1, s[4:7], s18 offen offset:0 sc1
    buffer_load_dwordx4 v[44:47], v1, s[4:7], s18 offen offset:1024 sc1
    buffer_load_dwordx4 v[48:51], v1, s[4:7], s18 offen offset:2048 sc1
    buffer_load_dwordx4 v[52:55], v1, s[4:7], s18 offen offset:3072 sc1
    s_add_u32 s18, s18, 4096
    buffer_load_dwordx4 v[56:59], v1, s[4:7], s18 offen offset:0 sc1
    buffer_load_dwordx4 v[60:63], v1, s[4:7], s18 offen offset:1024 sc1
    buffer_load_dwordx4 v[64:67], v1, s[4:7], s18 offen offset:2048 sc1
    buffer_load_dwordx4 v[68:71], v1, s[4:7], s18 offen offset:3072 sc1
    s_add_u32 s18, s18, 4096
    buffer_load_dwordx4 v[72:75], v1, s[4:7], s18 offen offset:0 sc1
    buffer_load_dwordx4 v[76:79], v1, s[4:7], s18 offen offset:1024 sc1
    buffer_load_dwordx4 v[80:83], v1, s[4:7], s18 offen offset:2048 sc1
    buffer_load_dwordx4 v[84:87], v1, s[4:7], s18 offen offset:3072 sc1
    s_add_u32 s18, s18, 4096
    buffer_load_dwordx4 v[88:91], v1, s[4:7], s18 offen offset:0 sc1
    buffer_load_dwordx4 v[92:95], v1, s[4:7], s18 offen offset:1024 sc1
    buffer_load_dwordx4 v[96:99], v1, s[4:7], s18 offen offset:2048 sc1
    buffer_load_dwordx4 v[100:103], v1, s[4:7], s18 offen offset:3072 sc1
    s_add_u32 s18, s18, 4096
    buffer_load_dwordx4 v[104:107], v1, s[4:7], s18 offen offset:0 sc1
    buffer_load_dwordx4 v[108:111], v1, s[4:7], s18 offen offset:1024 sc1
    buffer_load_dwordx4 v[112:115], v1, s[4:7], s18 offen offset:2048 sc1
    buffer_load_dwordx4 v[116:119], v1, s[4:7], s18 offen offset:3072 sc1
    s_add_u32 s18, s18, 4096
    buffer_load_dwordx4 v[120:123], v1, s[4:7], s18 offen offset:0 sc1
    buffer_load_dwordx4 v[124:127], v1, s[4:7], s18 offen offset:1024 sc1
    buffer_load_dwordx4 v[128:131], v1, s[4:7], s18 offen offset:2048 sc1
    buffer_load_dwordx4 v[132:135], v1, s[4:7], s18 offen offset:3072 sc1
    s_add_u32 s18, s18, 4096
    buffer_load_dwordx4 v[136:139], v1, s[4:7], s18 offen offset:0 sc1
    buffer_load_dwordx4 v[140:143], v1, s[4:7], s18 offen offset:1024 sc1
    buffer_load_dwordx4 v[144:147], v1, s[4:7], s18 offen offset:2048 sc1
    buffer_load_dwordx4 v[148:151], v1, s[4:7], s18 offen offset:3072 sc1
    s_add_u32 s18, s18, 102400
    buffer_load_dwordx4 v[152:155], v1, s[4:7], s18 offen offset:0 sc1
    buffer_load_dwordx4 v[156:159], v1, s[4:7], s18 offen offset:1024 sc1
    buffer_load_dwordx4 v[160:163], v1, s[4:7], s18 offen offset:2048 sc1
    buffer_load_dwordx4 v[164:167], v1, s[4:7], s18 offen offset:3072 sc1
    s_add_u32 s18, s18, 4096
    buffer_load_dwordx4 v[168:171], v1, s[4:7], s18 offen offset:0 sc1
    buffer_load_dwordx4 v[172:175], v1, s[4:7], s18 offen offset:1024 sc1
    buffer_load_dwordx4 v[176:179], v1, s[4:7], s18 offen offset:2048 sc1
    buffer_load_dwordx4 v[180:183], v1, s[4:7], s18 offen offset:3072 sc1
    s_add_u32 s18, s18, 4096
    buffer_load_dwordx4 v[184:187], v1, s[4:7], s18 offen offset:0 sc1
    buffer_load_dwordx4 v[188:191], v1, s[4:7], s18 offen offset:1024 sc1
    buffer_load_dwordx4 v[192:195], v1, s[4:7], s18 offen offset:2048 sc1
    buffer_load_dwordx4 v[196:199], v1, s[4:7], s18 offen offset:3072 sc1
    s_add_u32 s18, s18, 4096
    buffer_load_dwordx4 v[200:203], v1, s[4:7], s18 offen offset:0 sc1
    buffer_load_dwordx4 v[204:207], v1, s[4:7], s18 offen offset:1024 sc1
    buffer_load_dwordx4 v[208:211], v1, s[4:7], s18 offen offset:2048 sc1
    buffer_load_dwordx4 v[212:215], v1, s[4:7], s18 offen offset:3072 sc1
    s_add_u32 s18, s18, 4096
    buffer_load_dwordx4 v[216:219], v1, s[4:7], s18 offen offset:0 sc1
    buffer_load_dwordx4 v[220:223], v1, s[4:7], s18 offen offset:1024 sc1
    buffer_load_dwordx4 v[224:227], v1, s[4:7], s18 offen offset:2048 sc1
    buffer_load_dwordx4 v[228:231], v1, s[4:7], s18 offen offset:3072 sc1
    s_add_u32 s18, s18, 4096
    buffer_load_dwordx4 v[232:235], v1, s[4:7], s18 offen offset:0 sc1
    buffer_load_dwordx4 v[236:239], v1, s[4:7], s18 offen offset:1024 sc1
    buffer_load_dwordx4 v[240:243], v1, s[4:7], s18 offen offset:2048 sc1
    buffer_load_dwordx4 v[244:247], v1, s[4:7], s18 offen offset:3072 sc1
    v_lshlrev_b32 v2, 4, v0
    v_and_b32 v3, 3072, v2
    v_lshl_add_u32 v2, v3, 1, v1
    s_waitcnt vmcnt(55)
    v_mfma_f32_16x16x32_bf16 v[8:11], a[0:3], v[24:27], 0
    v_mfma_f32_16x16x32_bf16 v[12:15], a[4:7], v[24:27], 0
    s_add_u32 s18, s18, 4096
    buffer_load_dwordx4 v[24:27], v1, s[4:7], s18 offen offset:0 sc1
    s_waitcnt vmcnt(55)
    v_mfma_f32_16x16x32_bf16 v[8:11], a[8:11], v[28:31], v[8:11]
    v_mfma_f32_16x16x32_bf16 v[12:15], a[12:15], v[28:31], v[12:15]
    buffer_load_dwordx4 v[28:31], v1, s[4:7], s18 offen offset:1024 sc1
    s_waitcnt vmcnt(55)
    v_mfma_f32_16x16x32_bf16 v[8:11], a[16:19], v[32:35], v[8:11]
    v_mfma_f32_16x16x32_bf16 v[12:15], a[20:23], v[32:35], v[12:15]
    buffer_load_dwordx4 v[32:35], v1, s[4:7], s18 offen offset:2048 sc1
    s_waitcnt vmcnt(55)
    v_mfma_f32_16x16x32_bf16 v[8:11], a[24:27], v[36:39], v[8:11]
    v_mfma_f32_16x16x32_bf16 v[12:15], a[28:31], v[36:39], v[12:15]
    buffer_load_dwordx4 v[36:39], v1, s[4:7], s18 offen offset:3072 sc1
    s_waitcnt vmcnt(55)
    v_mfma_f32_16x16x32_bf16 v[8:11], a[32:35], v[40:43], v[8:11]
    v_mfma_f32_16x16x32_bf16 v[12:15], a[36:39], v[40:43], v[12:15]
    s_add_u32 s18, s18, 4096
    buffer_load_dwordx4 v[40:43], v1, s[4:7], s18 offen offset:0 sc1
    s_waitcnt vmcnt(55)
    v_mfma_f32_16x16x32_bf16 v[8:11], a[40:43], v[44:47], v[8:11]
    v_mfma_f32_16x16x32_bf16 v[12:15], a[44:47], v[44:47], v[12:15]
    buffer_load_dwordx4 v[44:47], v1, s[4:7], s18 offen offset:1024 sc1
    s_waitcnt vmcnt(55)
    v_mfma_f32_16x16x32_bf16 v[8:11], a[48:51], v[48:51], v[8:11]
    v_mfma_f32_16x16x32_bf16 v[12:15], a[52:55], v[48:51], v[12:15]
    buffer_load_dwordx4 v[48:51], v1, s[4:7], s18 offen offset:2048 sc1
    s_waitcnt vmcnt(55)
    v_mfma_f32_16x16x32_bf16 v[8:11], a[56:59], v[52:55], v[8:11]
    v_mfma_f32_16x16x32_bf16 v[12:15], a[60:63], v[52:55], v[12:15]
    buffer_load_dwordx4 v[52:55], v1, s[4:7], s18 offen offset:3072 sc1
    s_waitcnt vmcnt(55)
    v_mfma_f32_16x16x32_bf16 v[8:11], a[64:67], v[56:59], v[8:11]
    v_mfma_f32_16x16x32_bf16 v[12:15], a[68:71], v[56:59], v[12:15]
    s_waitcnt vmcnt(54)
    v_mfma_f32_16x16x32_bf16 v[8:11], a[72:75], v[60:63], v[8:11]
    v_mfma_f32_16x16x32_bf16 v[12:15], a[76:79], v[60:63], v[12:15]
    s_waitcnt vmcnt(53)
    v_mfma_f32_16x16x32_bf16 v[8:11], a[80:83], v[64:67], v[8:11]
    v_mfma_f32_16x16x32_bf16 v[12:15], a[84:87], v[64:67], v[12:15]
    s_waitcnt vmcnt(52)
    v_mfma_f32_16x16x32_bf16 v[8:11], a[88:91], v[68:71], v[8:11]
    v_mfma_f32_16x16x32_bf16 v[12:15], a[92:95], v[68:71], v[12:15]
    s_waitcnt vmcnt(51)
    v_mfma_f32_16x16x32_bf16 v[8:11], a[96:99], v[72:75], v[8:11]
    v_mfma_f32_16x16x32_bf16 v[12:15], a[100:103], v[72:75], v[12:15]
    s_waitcnt vmcnt(50)
    v_mfma_f32_16x16x32_bf16 v[8:11], a[104:107], v[76:79], v[8:11]
    v_mfma_f32_16x16x32_bf16 v[12:15], a[108:111], v[76:79], v[12:15]
    s_waitcnt vmcnt(49)
    v_mfma_f32_16x16x32_bf16 v[8:11], a[112:115], v[80:83], v[8:11]
    v_mfma_f32_16x16x32_bf16 v[12:15], a[116:119], v[80:83], v[12:15]
    s_waitcnt vmcnt(48)
    v_mfma_f32_16x16x32_bf16 v[8:11], a[120:123], v[84:87], v[8:11]
    v_mfma_f32_16x16x32_bf16 v[12:15], a[124:127], v[84:87], v[12:15]
    s_waitcnt vmcnt(47)
    v_mfma_f32_16x16x32_bf16 v[8:11], a[128:131], v[88:91], v[8:11]
    v_mfma_f32_16x16x32_bf16 v[12:15], a[132:135], v[88:91], v[12:15]
    s_waitcnt vmcnt(46)
    v_mfma_f32_16x16x32_bf16 v[8:11], a[136:139], v[92:95], v[8:11]
    v_mfma_f32_16x16x32_bf16 v[12:15], a[140:143], v[92:95], v[12:15]
    s_waitcnt vmcnt(45)
    v_mfma_f32_16x16x32_bf16 v[8:11], a[144:147], v[96:99], v[8:11]
    v_mfma_f32_16x16x32_bf16 v[12:15], a[148:151], v[96:99], v[12:15]
    s_waitcnt vmcnt(44)
    v_mfma_f32_16x16x32_bf16 v[8:11], a[152:155], v[100:103], v[8:11]
    v_mfma_f32_16x16x32_bf16 v[12:15], a[156:159], v[100:103], v[12:15]
    s_waitcnt vmcnt(43)
    v_mfma_f32_16x16x32_bf16 v[8:11], a[160:163], v[104:107], v[8:11]
    v_mfma_f32_16x16x32_bf16 v[12:15], a[164:167], v[104:107], v[12:15]
    s_waitcnt vmcnt(42)
    v_mfma_f32_16x16x32_bf16 v[8:11], a[168:171], v[108:111], v[8:11]
    v_mfma_f32_16x16x32_bf16 v[12:15], a[172:175], v[108:111], v[12:15]
    s_waitcnt vmcnt(41)
    v_mfma_f32_16x16x32_bf16 v[8:11], a[176:179], v[112:115], v[8:11]
    v_mfma_f32_16x16x32_bf16 v[12:15], a[180:183], v[112:115], v[12:15]
    s_waitcnt vmcnt(40)
    v_mfma_f32_16x16x32_bf16 v[8:11], a[184:187], v[116:119], v[8:11]
    v_mfma_f32_16x16x32_bf16 v[12:15], a[188:191], v[116:119], v[12:15]
    s_waitcnt vmcnt(39)
    v_mfma_f32_16x16x32_bf16 v[8:11], a[192:195], v[120:123], v[8:11]
    v_mfma_f32_16x16x32_bf16 v[12:15], a[196:199], v[120:123], v[12:15]
    s_waitcnt vmcnt(38)
    v_mfma_f32_16x16x32_bf16 v[8:11], a[200:203], v[124:127], v[8:11]
    v_mfma_f32_16x16x32_bf16 v[12:15], a[204:207], v[124:127], v[12:15]
    s_waitcnt vmcnt(37)
    v_mfma_f32_16x16x32_bf16 v[8:11], a[208:211], v[128:131], v[8:11]
    v_mfma_f32_16x16x32_bf16 v[12:15], a[212:215], v[128:131], v[12:15]
    s_waitcnt vmcnt(36)
    v_mfma_f32_16x16x32_bf16 v[8:11], a[216:219], v[132:135], v[8:11]
    v_mfma_f32_16x16x32_bf16 v[12:15], a[220:223], v[132:135], v[12:15]
    s_waitcnt vmcnt(35)
    v_mfma_f32_16x16x32_bf16 v[8:11], a[224:227], v[136:139], v[8:11]
    v_mfma_f32_16x16x32_bf16 v[12:15], a[228:231], v[136:139], v[12:15]
    s_waitcnt vmcnt(34)
    v_mfma_f32_16x16x32_bf16 v[8:11], a[232:235], v[140:143], v[8:11]
    v_mfma_f32_16x16x32_bf16 v[12:15], a[236:239], v[140:143], v[12:15]
    s_waitcnt vmcnt(33)
    v_mfma_f32_16x16x32_bf16 v[8:11], a[240:243], v[144:147], v[8:11]
    v_mfma_f32_16x16x32_bf16 v[12:15], a[244:247], v[144:147], v[12:15]
    s_waitcnt vmcnt(32)
    v_mfma_f32_16x16x32_bf16 v[8:11], a[248:251], v[148:151], v[8:11]
    v_mfma_f32_16x16x32_bf16 v[12:15], a[252:255], v[148:151], v[12:15]
    s_waitcnt vmcnt(31)
    v_mfma_f32_16x16x32_bf16 v[16:19], a[0:3], v[152:155], 0
    v_mfma_f32_16x16x32_bf16 v[20:23], a[4:7], v[152:155], 0
    s_waitcnt vmcnt(30)
    v_mfma_f32_16x16x32_bf16 v[16:19], a[8:11], v[156:159], v[16:19]
    v_mfma_f32_16x16x32_bf16 v[20:23], a[12:15], v[156:159], v[20:23]
    s_waitcnt vmcnt(29)
    v_mfma_f32_16x16x32_bf16 v[16:19], a[16:19], v[160:163], v[16:19]
    v_mfma_f32_16x16x32_bf16 v[20:23], a[20:23], v[160:163], v[20:23]
    s_waitcnt vmcnt(28)
    v_mfma_f32_16x16x32_bf16 v[16:19], a[24:27], v[164:167], v[16:19]
    v_mfma_f32_16x16x32_bf16 v[20:23], a[28:31], v[164:167], v[20:23]
    s_waitcnt vmcnt(27)
    v_mfma_f32_16x16x32_bf16 v[16:19], a[32:35], v[168:171], v[16:19]
    v_mfma_f32_16x16x32_bf16 v[20:23], a[36:39], v[168:171], v[20:23]
    s_waitcnt vmcnt(26)
    v_mfma_f32_16x16x32_bf16 v[16:19], a[40:43], v[172:175], v[16:19]
    v_mfma_f32_16x16x32_bf16 v[20:23], a[44:47], v[172:175], v[20:23]
    s_waitcnt vmcnt(25)
    v_mfma_f32_16x16x32_bf16 v[16:19], a[48:51], v[176:179], v[16:19]
    v_mfma_f32_16x16x32_bf16 v[20:23], a[52:55], v[176:179], v[20:23]
    s_waitcnt vmcnt(24)
    v_mfma_f32_16x16x32_bf16 v[16:19], a[56:59], v[180:183], v[16:19]
    v_mfma_f32_16x16x32_bf16 v[20:23], a[60:63], v[180:183], v[20:23]
    s_waitcnt vmcnt(23)
    v_mfma_f32_16x16x32_bf16 v[16:19], a[64:67], v[184:187], v[16:19]
    v_mfma_f32_16x16x32_bf16 v[20:23], a[68:71], v[184:187], v[20:23]
    s_waitcnt vmcnt(22)
    v_mfma_f32_16x16x32_bf16 v[16:19], a[72:75], v[188:191], v[16:19]
    v_mfma_f32_16x16x32_bf16 v[20:23], a[76:79], v[188:191], v[20:23]
    s_waitcnt vmcnt(21)
    v_mfma_f32_16x16x32_bf16 v[16:19], a[80:83], v[192:195], v[16:19]
    v_mfma_f32_16x16x32_bf16 v[20:23], a[84:87], v[192:195], v[20:23]
    s_waitcnt vmcnt(20)
    v_mfma_f32_16x16x32_bf16 v[16:19], a[88:91], v[196:199], v[16:19]
    v_mfma_f32_16x16x32_bf16 v[20:23], a[92:95], v[196:199], v[20:23]
    s_waitcnt vmcnt(19)
    v_mfma_f32_16x16x32_bf16 v[16:19], a[96:99], v[200:203], v[16:19]
    v_mfma_f32_16x16x32_bf16 v[20:23], a[100:103], v[200:203], v[20:23]
    s_waitcnt vmcnt(18)
    v_mfma_f32_16x16x32_bf16 v[16:19], a[104:107], v[204:207], v[16:19]
    v_mfma_f32_16x16x32_bf16 v[20:23], a[108:111], v[204:207], v[20:23]
    s_waitcnt vmcnt(17)
    v_mfma_f32_16x16x32_bf16 v[16:19], a[112:115], v[208:211], v[16:19]
    v_mfma_f32_16x16x32_bf16 v[20:23], a[116:119], v[208:211], v[20:23]
    s_waitcnt vmcnt(16)
    v_mfma_f32_16x16x32_bf16 v[16:19], a[120:123], v[212:215], v[16:19]
    v_mfma_f32_16x16x32_bf16 v[20:23], a[124:127], v[212:215], v[20:23]
    s_waitcnt vmcnt(15)
    v_mfma_f32_16x16x32_bf16 v[16:19], a[128:131], v[216:219], v[16:19]
    v_mfma_f32_16x16x32_bf16 v[20:23], a[132:135], v[216:219], v[20:23]
    s_waitcnt vmcnt(14)
    v_mfma_f32_16x16x32_bf16 v[16:19], a[136:139], v[220:223], v[16:19]
    v_mfma_f32_16x16x32_bf16 v[20:23], a[140:143], v[220:223], v[20:23]
    s_waitcnt vmcnt(13)
    v_mfma_f32_16x16x32_bf16 v[16:19], a[144:147], v[224:227], v[16:19]
    v_mfma_f32_16x16x32_bf16 v[20:23], a[148:151], v[224:227], v[20:23]
    s_waitcnt vmcnt(12)
    v_mfma_f32_16x16x32_bf16 v[16:19], a[152:155], v[228:231], v[16:19]
    v_mfma_f32_16x16x32_bf16 v[20:23], a[156:159], v[228:231], v[20:23]
    s_waitcnt vmcnt(11)
    v_mfma_f32_16x16x32_bf16 v[16:19], a[160:163], v[232:235], v[16:19]
    v_mfma_f32_16x16x32_bf16 v[20:23], a[164:167], v[232:235], v[20:23]
    s_waitcnt vmcnt(10)
    v_mfma_f32_16x16x32_bf16 v[16:19], a[168:171], v[236:239], v[16:19]
    v_mfma_f32_16x16x32_bf16 v[20:23], a[172:175], v[236:239], v[20:23]
    s_waitcnt vmcnt(9)
    v_mfma_f32_16x16x32_bf16 v[16:19], a[176:179], v[240:243], v[16:19]
    v_mfma_f32_16x16x32_bf16 v[20:23], a[180:183], v[240:243], v[20:23]
    s_waitcnt vmcnt(8)
    v_mfma_f32_16x16x32_bf16 v[16:19], a[184:187], v[244:247], v[16:19]
    v_mfma_f32_16x16x32_bf16 v[20:23], a[188:191], v[244:247], v[20:23]
    s_waitcnt vmcnt(7)
    v_mfma_f32_16x16x32_bf16 v[16:19], a[192:195], v[24:27], v[16:19]
    v_mfma_f32_16x16x32_bf16 v[20:23], a[196:199], v[24:27], v[20:23]
    s_waitcnt vmcnt(6)
    v_mfma_f32_16x16x32_bf16 v[16:19], a[200:203], v[28:31], v[16:19]
    v_mfma_f32_16x16x32_bf16 v[20:23], a[204:207], v[28:31], v[20:23]
    s_waitcnt vmcnt(5)
    v_mfma_f32_16x16x32_bf16 v[16:19], a[208:211], v[32:35], v[16:19]
    v_mfma_f32_16x16x32_bf16 v[20:23], a[212:215], v[32:35], v[20:23]
    s_waitcnt vmcnt(4)
    v_mfma_f32_16x16x32_bf16 v[16:19], a[216:219], v[36:39], v[16:19]
    v_mfma_f32_16x16x32_bf16 v[20:23], a[220:223], v[36:39], v[20:23]
    s_waitcnt vmcnt(3)
    v_mfma_f32_16x16x32_bf16 v[16:19], a[224:227], v[40:43], v[16:19]
    v_mfma_f32_16x16x32_bf16 v[20:23], a[228:231], v[40:43], v[20:23]
    s_waitcnt vmcnt(2)
    v_mfma_f32_16x16x32_bf16 v[16:19], a[232:235], v[44:47], v[16:19]
    v_mfma_f32_16x16x32_bf16 v[20:23], a[236:239], v[44:47], v[20:23]
    s_waitcnt vmcnt(1)
    v_mfma_f32_16x16x32_bf16 v[16:19], a[240:243], v[48:51], v[16:19]
    v_mfma_f32_16x16x32_bf16 v[20:23], a[244:247], v[48:51], v[20:23]
    s_waitcnt vmcnt(0)
    v_mfma_f32_16x16x32_bf16 v[16:19], a[248:251], v[52:55], v[16:19]
    v_mfma_f32_16x16x32_bf16 v[20:23], a[252:255], v[52:55], v[20:23]
    ds_write_b128 v2, v[8:11] offset:0
    ds_write_b128 v2, v[12:15] offset:1024
    s_nop 4
    ds_write_b128 v2, v[16:19] offset:8192
    ds_write_b128 v2, v[20:23] offset:9216
    s_cmp_lg_u32 s32, 0
    s_cbranch_scc1 o2_nb
    v_cmp_eq_u32 vcc, 0, v253
    s_nop 0
    s_cmp_eq_u64 vcc, 0
    s_cselect_b32 s44, 65536, 0
    v_or_b32 v250, s44, v250
    v_mov_b32 v251, 163832
    s_mov_b64 exec, 1
    ds_write_b32 v251, v250
    s_mov_b64 exec, -1
o2_nb:
    s_waitcnt lgkmcnt(0)
    s_barrier
    s_cmp_gt_u32 s32, 1
    s_cbranch_scc1 o2_skip
    s_lshl_b32 s18, s32, 13
    v_add_u32 v2, s18, v1
    ds_read_b128 v[24:27], v2 offset:0
    ds_read_b128 v[28:31], v2 offset:1024
    ds_read_b128 v[32:35], v2 offset:2048
    ds_read_b128 v[36:39], v2 offset:3072
    ds_read_b128 v[40:43], v2 offset:4096
    ds_read_b128 v[44:47], v2 offset:5120
    ds_read_b128 v[48:51], v2 offset:6144
    ds_read_b128 v[52:55], v2 offset:7168
    v_lshrrev_b32 v3, 4, v1
    v_bfe_u32 v4, v3, 2, 2
    v_lshlrev_b32 v4, 3, v4
    v_and_b32 v2, 3, v3
    v_add_u32 v4, v4, v2
    v_mul_u32_u24 v4, 2304, v4
    v_lshrrev_b32 v3, 4, v3
    v_lshl_add_u32 v4, v3, 4, v4
    s_add_u32 s20, s16, s32
    s_lshr_b32 s18, s20, 1
    s_lshl_b32 s18, s18, 3
    s_and_b32 s19, s20, 1
    s_add_u32 s18, s18, s19
    s_mul_i32 s18, s18, 9216
    s_lshl_b32 s19, s33, 6
    s_add_u32 s18, s18, s19
    s_waitcnt lgkmcnt(0)
    v_pk_add_f32 v[24:25], v[24:25], v[32:33]
    v_pk_add_f32 v[40:41], v[40:41], v[48:49]
    v_pk_add_f32 v[24:25], v[24:25], v[40:41]
    v_pk_add_f32 v[26:27], v[26:27], v[34:35]
    v_pk_add_f32 v[42:43], v[42:43], v[50:51]
    v_pk_add_f32 v[26:27], v[26:27], v[42:43]
    v_pk_add_f32 v[28:29], v[28:29], v[36:37]
    v_pk_add_f32 v[44:45], v[44:45], v[52:53]
    v_pk_add_f32 v[28:29], v[28:29], v[44:45]
    v_pk_add_f32 v[30:31], v[30:31], v[38:39]
    v_pk_add_f32 v[46:47], v[46:47], v[54:55]
    v_pk_add_f32 v[30:31], v[30:31], v[46:47]
    v_cvt_pk_bf16_f32 v8, v24, v28
    v_cvt_pk_bf16_f32 v9, v25, v29
    v_cvt_pk_bf16_f32 v10, v26, v30
    v_cvt_pk_bf16_f32 v11, v27, v31
    buffer_store_dwordx4 v[8:11], v4, s[8:11], s18 offen
o2_skip:
    s_nop 1
    s_branch L_op_fin
L_op_one:
o1_again:
    s_lshl_b32 s18, s16, 17
    s_lshl_b32 s19, s32, 15
    s_add_u32 s18, s18, s19
    s_add_u32 s18, s18, 50331648
    buffer_load_dwordx4 v[24:27], v1, s[4:7], s18 offen offset:0 sc1
    buffer_load_dwordx4 v[28:31], v1, s[4:7], s18 offen offset:1024 sc1
    buffer_load_dwordx4 v[32:35], v1, s[4:7], s18 offen offset:2048 sc1
    buffer_load_dwordx4 v[36:39], v1, s[4:7], s18 offen offset:3072 sc1
    s_add_u32 s18, s18, 4096
    buffer_load_dwordx4 v[40:43], v1, s[4:7], s18 offen offset:0 sc1
    buffer_load_dwordx4 v[44:47], v1, s[4:7], s18 offen offset:1024 sc1
    buffer_load_dwordx4 v[48:51], v1, s[4:7], s18 offen offset:2048 sc1
    buffer_load_dwordx4 v[52:55], v1, s[4:7], s18 offen offset:3072 sc1
    s_add_u32 s18, s18, 4096
    buffer_load_dwordx4 v[56:59], v1, s[4:7], s18 offen offset:0 sc1
    buffer_load_dwordx4 v[60:63], v1, s[4:7], s18 offen offset:1024 sc1
    buffer_load_dwordx4 v[64:67], v1, s[4:7], s18 offen offset:2048 sc1
    buffer_load_dwordx4 v[68:71], v1, s[4:7], s18 offen offset:3072 sc1
    s_add_u32 s18, s18, 4096
    buffer_load_dwordx4 v[72:75], v1, s[4:7], s18 offen offset:0 sc1
    buffer_load_dwordx4 v[76:79], v1, s[4:7], s18 offen offset:1024 sc1
    buffer_load_dwordx4 v[80:83], v1, s[4:7], s18 offen offset:2048 sc1
    buffer_load_dwordx4 v[84:87], v1, s[4:7], s18 offen offset:3072 sc1
    s_add_u32 s18, s18, 4096
    buffer_load_dwordx4 v[88:91], v1, s[4:7], s18 offen offset:0 sc1
    buffer_load_dwordx4 v[92:95], v1, s[4:7], s18 offen offset:1024 sc1
    buffer_load_dwordx4 v[96:99], v1, s[4:7], s18 offen offset:2048 sc1
    buffer_load_dwordx4 v[100:103], v1, s[4:7], s18 offen offset:3072 sc1
    s_add_u32 s18, s18, 4096
    buffer_load_dwordx4 v[104:107], v1, s[4:7], s18 offen offset:0 sc1
    buffer_load_dwordx4 v[108:111], v1, s[4:7], s18 offen offset:1024 sc1
    buffer_load_dwordx4 v[112:115], v1, s[4:7], s18 offen offset:2048 sc1
    buffer_load_dwordx4 v[116:119], v1, s[4:7], s18 offen offset:3072 sc1
    s_add_u32 s18, s18, 4096
    buffer_load_dwordx4 v[120:123], v1, s[4:7], s18 offen offset:0 sc1
    buffer_load_dwordx4 v[124:127], v1, s[4:7], s18 offen offset:1024 sc1
    buffer_load_dwordx4 v[128:131], v1, s[4:7], s18 offen offset:2048 sc1
    buffer_load_dwordx4 v[132:135], v1, s[4:7], s18 offen offset:3072 sc1
    s_add_u32 s18, s18, 4096
    buffer_load_dwordx4 v[136:139], v1, s[4:7], s18 offen offset:0 sc1
    buffer_load_dwordx4 v[140:143], v1, s[4:7], s18 offen offset:1024 sc1
    buffer_load_dwordx4 v[144:147], v1, s[4:7], s18 offen offset:2048 sc1
    buffer_load_dwordx4 v[148:151], v1, s[4:7], s18 offen offset:3072 sc1
    v_lshlrev_b32 v2, 4, v0
    v_and_b32 v3, 3072, v2
    v_lshl_add_u32 v2, v3, 1, v1
    s_waitcnt vmcnt(31)
    v_mfma_f32_16x16x32_bf16 v[8:11], a[0:3], v[24:27], 0
    v_and_b32 v6, v24, v25
    v_mfma_f32_16x16x32_bf16 v[12:15], a[4:7], v[24:27], 0
    s_waitcnt vmcnt(30)
    v_mfma_f32_16x16x32_bf16 v[8:11], a[8:11], v[28:31], v[8:11]
    v_and_b32 v5, v28, v29
    v_mfma_f32_16x16x32_bf16 v[12:15], a[12:15], v[28:31], v[12:15]
    v_max_u32 v6, v6, v5
    s_waitcnt vmcnt(29)
    v_mfma_f32_16x16x32_bf16 v[8:11], a[16:19], v[32:35], v[8:11]
    v_and_b32 v5, v32, v33
    v_mfma_f32_16x16x32_bf16 v[12:15], a[20:23], v[32:35], v[12:15]
    v_max_u32 v6, v6, v5
    s_waitcnt vmcnt(28)
    v_mfma_f32_16x16x32_bf16 v[8:11], a[24:27], v[36:39], v[8:11]
    v_and_b32 v5, v36, v37
    v_mfma_f32_16x16x32_bf16 v[12:15], a[28:31], v[36:39], v[12:15]
    v_max_u32 v6, v6, v5
    s_waitcnt vmcnt(27)
    v_mfma_f32_16x16x32_bf16 v[8:11], a[32:35], v[40:43], v[8:11]
    v_and_b32 v5, v40, v41
    v_mfma_f32_16x16x32_bf16 v[12:15], a[36:39], v[40:43], v[12:15]
    v_max_u32 v6, v6, v5
    s_waitcnt vmcnt(26)
    v_mfma_f32_16x16x32_bf16 v[8:11], a[40:43], v[44:47], v[8:11]
    v_and_b32 v5, v44, v45
    v_mfma_f32_16x16x32_bf16 v[12:15], a[44:47], v[44:47], v[12:15]
    v_max_u32 v6, v6, v5
    s_waitcnt vmcnt(25)
    v_mfma_f32_16x16x32_bf16 v[8:11], a[48:51], v[48:51], v[8:11]
    v_and_b32 v5, v48, v49
    v_mfma_f32_16x16x32_bf16 v[12:15], a[52:55], v[48:51], v[12:15]
    v_max_u32 v6, v6, v5
    s_waitcnt vmcnt(24)
    v_mfma_f32_16x16x32_bf16 v[8:11], a[56:59], v[52:55], v[8:11]
    v_and_b32 v5, v52, v53
    v_mfma_f32_16x16x32_bf16 v[12:15], a[60:63], v[52:55], v[12:15]
    v_max_u32 v6, v6, v5
    s_waitcnt vmcnt(23)
    v_mfma_f32_16x16x32_bf16 v[8:11], a[64:67], v[56:59], v[8:11]
    v_and_b32 v5, v56, v57
    v_mfma_f32_16x16x32_bf16 v[12:15], a[68:71], v[56:59], v[12:15]
    v_max_u32 v6, v6, v5
    s_waitcnt vmcnt(22)
    v_mfma_f32_16x16x32_bf16 v[8:11], a[72:75], v[60:63], v[8:11]
    v_and_b32 v5, v60, v61
    v_mfma_f32_16x16x32_bf16 v[12:15], a[76:79], v[60:63], v[12:15]
    v_max_u32 v6, v6, v5
    s_waitcnt vmcnt(21)
    v_mfma_f32_16x16x32_bf16 v[8:11], a[80:83], v[64:67], v[8:11]
    v_and_b32 v5, v64, v65
    v_mfma_f32_16x16x32_bf16 v[12:15], a[84:87], v[64:67], v[12:15]
    v_max_u32 v6, v6, v5
    s_waitcnt vmcnt(20)
    v_mfma_f32_16x16x32_bf16 v[8:11], a[88:91], v[68:71], v[8:11]
    v_and_b32 v5, v68, v69
    v_mfma_f32_16x16x32_bf16 v[12:15], a[92:95], v[68:71], v[12:15]
    v_max_u32 v6, v6, v5
    s_waitcnt vmcnt(19)
    v_mfma_f32_16x16x32_bf16 v[8:11], a[96:99], v[72:75], v[8:11]
    v_and_b32 v5, v72, v73
    v_mfma_f32_16x16x32_bf16 v[12:15], a[100:103], v[72:75], v[12:15]
    v_max_u32 v6, v6, v5
    s_waitcnt vmcnt(18)
    v_mfma_f32_16x16x32_bf16 v[8:11], a[104:107], v[76:79], v[8:11]
    v_and_b32 v5, v76, v77
    v_mfma_f32_16x16x32_bf16 v[12:15], a[108:111], v[76:79], v[12:15]
    v_max_u32 v6, v6, v5
    s_waitcnt vmcnt(17)
    v_mfma_f32_16x16x32_bf16 v[8:11], a[112:115], v[80:83], v[8:11]
    v_and_b32 v5, v80, v81
    v_mfma_f32_16x16x32_bf16 v[12:15], a[116:119], v[80:83], v[12:15]
    v_max_u32 v6, v6, v5
    s_waitcnt vmcnt(16)
    v_mfma_f32_16x16x32_bf16 v[8:11], a[120:123], v[84:87], v[8:11]
    v_and_b32 v5, v84, v85
    v_mfma_f32_16x16x32_bf16 v[12:15], a[124:127], v[84:87], v[12:15]
    v_max_u32 v6, v6, v5
    s_waitcnt vmcnt(15)
    v_mfma_f32_16x16x32_bf16 v[8:11], a[128:131], v[88:91], v[8:11]
    v_and_b32 v5, v88, v89
    v_mfma_f32_16x16x32_bf16 v[12:15], a[132:135], v[88:91], v[12:15]
    v_max_u32 v6, v6, v5
    s_waitcnt vmcnt(14)
    v_mfma_f32_16x16x32_bf16 v[8:11], a[136:139], v[92:95], v[8:11]
    v_and_b32 v5, v92, v93
    v_mfma_f32_16x16x32_bf16 v[12:15], a[140:143], v[92:95], v[12:15]
    v_max_u32 v6, v6, v5
    s_waitcnt vmcnt(13)
    v_mfma_f32_16x16x32_bf16 v[8:11], a[144:147], v[96:99], v[8:11]
    v_and_b32 v5, v96, v97
    v_mfma_f32_16x16x32_bf16 v[12:15], a[148:151], v[96:99], v[12:15]
    v_max_u32 v6, v6, v5
    s_waitcnt vmcnt(12)
    v_mfma_f32_16x16x32_bf16 v[8:11], a[152:155], v[100:103], v[8:11]
    v_and_b32 v5, v100, v101
    v_mfma_f32_16x16x32_bf16 v[12:15], a[156:159], v[100:103], v[12:15]
    v_max_u32 v6, v6, v5
    s_waitcnt vmcnt(11)
    v_mfma_f32_16x16x32_bf16 v[8:11], a[160:163], v[104:107], v[8:11]
    v_and_b32 v5, v104, v105
    v_mfma_f32_16x16x32_bf16 v[12:15], a[164:167], v[104:107], v[12:15]
    v_max_u32 v6, v6, v5
    s_waitcnt vmcnt(10)
    v_mfma_f32_16x16x32_bf16 v[8:11], a[168:171], v[108:111], v[8:11]
    v_and_b32 v5, v108, v109
    v_mfma_f32_16x16x32_bf16 v[12:15], a[172:175], v[108:111], v[12:15]
    v_max_u32 v6, v6, v5
    s_waitcnt vmcnt(9)
    v_mfma_f32_16x16x32_bf16 v[8:11], a[176:179], v[112:115], v[8:11]
    v_and_b32 v5, v112, v113
    v_mfma_f32_16x16x32_bf16 v[12:15], a[180:183], v[112:115], v[12:15]
    v_max_u32 v6, v6, v5
    s_waitcnt vmcnt(8)
    v_mfma_f32_16x16x32_bf16 v[8:11], a[184:187], v[116:119], v[8:11]
    v_and_b32 v5, v116, v117
    v_mfma_f32_16x16x32_bf16 v[12:15], a[188:191], v[116:119], v[12:15]
    v_max_u32 v6, v6, v5
    s_waitcnt vmcnt(7)
    v_mfma_f32_16x16x32_bf16 v[8:11], a[192:195], v[120:123], v[8:11]
    v_and_b32 v5, v120, v121
    v_mfma_f32_16x16x32_bf16 v[12:15], a[196:199], v[120:123], v[12:15]
    v_max_u32 v6, v6, v5
    s_waitcnt vmcnt(6)
    v_mfma_f32_16x16x32_bf16 v[8:11], a[200:203], v[124:127], v[8:11]
    v_and_b32 v5, v124, v125
    v_mfma_f32_16x16x32_bf16 v[12:15], a[204:207], v[124:127], v[12:15]
    v_max_u32 v6, v6, v5
    s_waitcnt vmcnt(5)
    v_mfma_f32_16x16x32_bf16 v[8:11], a[208:211], v[128:131], v[8:11]
    v_and_b32 v5, v128, v129
    v_mfma_f32_16x16x32_bf16 v[12:15], a[212:215], v[128:131], v[12:15]
    v_max_u32 v6, v6, v5
    s_waitcnt vmcnt(4)
    v_mfma_f32_16x16x32_bf16 v[8:11], a[216:219], v[132:135], v[8:11]
    v_and_b32 v5, v132, v133
    v_mfma_f32_16x16x32_bf16 v[12:15], a[220:223], v[132:135], v[12:15]
    v_max_u32 v6, v6, v5
    s_waitcnt vmcnt(3)
    v_mfma_f32_16x16x32_bf16 v[8:11], a[224:227], v[136:139], v[8:11]
    v_and_b32 v5, v136, v137
    v_mfma_f32_16x16x32_bf16 v[12:15], a[228:231], v[136:139], v[12:15]
    v_max_u32 v6, v6, v5
    s_waitcnt vmcnt(2)
    v_mfma_f32_16x16x32_bf16 v[8:11], a[232:235], v[140:143], v[8:11]
    v_and_b32 v5, v140, v141
    v_mfma_f32_16x16x32_bf16 v[12:15], a[236:239], v[140:143], v[12:15]
    v_max_u32 v6, v6, v5
    s_waitcnt vmcnt(1)
    v_mfma_f32_16x16x32_bf16 v[8:11], a[240:243], v[144:147], v[8:11]
    v_and_b32 v5, v144, v145
    v_mfma_f32_16x16x32_bf16 v[12:15], a[244:247], v[144:147], v[12:15]
    v_max_u32 v6, v6, v5
    s_waitcnt vmcnt(0)
    v_mfma_f32_16x16x32_bf16 v[8:11], a[248:251], v[148:151], v[8:11]
    v_and_b32 v5, v148, v149
    v_mfma_f32_16x16x32_bf16 v[12:15], a[252:255], v[148:151], v[12:15]
    v_max_u32 v6, v6, v5
    v_cmp_eq_u32 vcc, -1, v6
    s_cbranch_vccz o1_ok
    s_cmp_eq_u32 s46, 0
    s_cbranch_scc1 o1_ok
    s_mov_b32 s46, 0
    s_nop 1
    v_mbcnt_lo_u32_b32 v2, -1, 0
    v_mbcnt_hi_u32_b32 v2, -1, v2
    v_min_u32 v2, 1, v2
    v_lshlrev_b32 v2, 2, v2
    s_mov_b32 s88, 4194304
fw22:
    buffer_load_dword v3, v2, s[4:7], s89 offen offset:0 sc1
    s_sub_u32 s88, s88, 1
    s_cbranch_scc1 fw22x
    s_waitcnt vmcnt(0)
    v_cmp_ne_u32 vcc, s95, v3
    s_cbranch_vccz fw22x
    s_sleep 1
    s_branch fw22
fw22x:
    s_branch o1_again
o1_ok:
    s_nop 7
    ds_write_b128 v2, v[8:11] offset:0
    ds_write_b128 v2, v[12:15] offset:1024
    s_cmp_lg_u32 s32, 0
    s_cbranch_scc1 o1_nb
    v_cmp_eq_u32 vcc, 0, v253
    s_nop 0
    s_cmp_eq_u64 vcc, 0
    s_cselect_b32 s44, 65536, 0
    v_or_b32 v250, s44, v250
    v_mov_b32 v251, 163832
    s_mov_b64 exec, 1
    ds_write_b32 v251, v250
    s_mov_b64 exec, -1
o1_nb:
    s_waitcnt lgkmcnt(0)
    s_barrier
    s_cmp_gt_u32 s32, 0
    s_cbranch_scc1 o1_skip
    s_lshl_b32 s18, s32, 13
    v_add_u32 v2, s18, v1
    ds_read_b128 v[24:27], v2 offset:0
    ds_read_b128 v[28:31], v2 offset:1024
    ds_read_b128 v[32:35], v2 offset:2048
    ds_read_b128 v[36:39], v2 offset:3072
    ds_read_b128 v[40:43], v2 offset:4096
    ds_read_b128 v[44:47], v2 offset:5120
    ds_read_b128 v[48:51], v2 offset:6144
    ds_read_b128 v[52:55], v2 offset:7168
    v_lshrrev_b32 v3, 4, v1
    v_bfe_u32 v4, v3, 2, 2
    v_lshlrev_b32 v4, 3, v4
    v_and_b32 v2, 3, v3
    v_add_u32 v4, v4, v2
    v_mul_u32_u24 v4, 2304, v4
    v_lshrrev_b32 v3, 4, v3
    v_lshl_add_u32 v4, v3, 4, v4
    s_add_u32 s20, s16, s32
    s_lshr_b32 s18, s20, 1
    s_lshl_b32 s18, s18, 3
    s_and_b32 s19, s20, 1
    s_add_u32 s18, s18, s19
    s_mul_i32 s18, s18, 9216
    s_lshl_b32 s19, s33, 6
    s_add_u32 s18, s18, s19
    s_waitcnt lgkmcnt(0)
    v_pk_add_f32 v[24:25], v[24:25], v[32:33]
    v_pk_add_f32 v[40:41], v[40:41], v[48:49]
    v_pk_add_f32 v[24:25], v[24:25], v[40:41]
    v_pk_add_f32 v[26:27], v[26:27], v[34:35]
    v_pk_add_f32 v[42:43], v[42:43], v[50:51]
    v_pk_add_f32 v[26:27], v[26:27], v[42:43]
    v_pk_add_f32 v[28:29], v[28:29], v[36:37]
    v_pk_add_f32 v[44:45], v[44:45], v[52:53]
    v_pk_add_f32 v[28:29], v[28:29], v[44:45]
    v_pk_add_f32 v[30:31], v[30:31], v[38:39]
    v_pk_add_f32 v[46:47], v[46:47], v[54:55]
    v_pk_add_f32 v[30:31], v[30:31], v[46:47]
    v_cvt_pk_bf16_f32 v8, v24, v28
    v_cvt_pk_bf16_f32 v9, v25, v29
    v_cvt_pk_bf16_f32 v10, v26, v30
    v_cvt_pk_bf16_f32 v11, v27, v31
    buffer_store_dwordx4 v[8:11], v4, s[8:11], s18 offen
o1_skip:
    s_nop 1
L_op_fin:
    v_mov_b32 v251, 163832
    ds_read_b32 v252, v251
    s_waitcnt lgkmcnt(0)
    v_readfirstlane_b32 s40, v252
    s_nop 1
    s_cmp_ge_u32 s40, 65608
    s_cbranch_scc1 L_done
    s_barrier
    s_and_b32 s16, s40, 0xffff
    s_cmp_lt_u32 s16, 72
    s_cbranch_scc1 L_op_seg
L_op_nextcb:
    s_mov_b32 s40, -1
    s_cmp_lg_u32 s32, 0
    s_cbranch_scc1 L_op_dec
    v_and_b32 v1, 63, v0
    v_min_u32 v1, 17, v1
    v_lshlrev_b32 v2, 2, v1
    buffer_load_dword v3, v2, s[84:87], 0 offen offset:136 sc1
    s_waitcnt vmcnt(0)
    v_cmp_gt_u32 vcc, 52, v3
    s_nop 0
    s_and_b32 s40, vcc_lo, 262143
    s_lshl_b32 s41, s40, 18
    s_lshr_b32 s43, s40, 14
    s_or_b32 s42, s40, s41
    s_and_b32 s36, s45, 15
    s_bfm_b32 s37, s36, 0
    s_and_b32 s37, s37, 42315
    s_bcnt1_i32_b32 s37, s37
    s_lshr_b32 s36, s45, 4
    s_mul_i32 s36, s36, 8
    s_add_u32 s36, s36, s37
    s_add_u32 s36, s36, 38
    s_mul_hi_u32 s41, s36, 0x0e38e38f
    s_mul_i32 s41, s41, 18
    s_sub_u32 s41, s36, s41
    s_lshr_b64 s[42:43], s[42:43], s41
    s_ff1_i32_b64 s40, s[42:43]
    s_cmp_lt_i32 s40, 0
    s_cbranch_scc1 L_op_dec
    s_add_u32 s40, s40, s41
    s_sub_u32 s41, s40, 18
    s_cselect_b32 s40, s40, s41
L_op_dec:
    v_mov_b32 v250, s40
    v_mov_b32 v251, 163832
    s_cmp_lg_u32 s32, 0
    s_cbranch_scc1 L_op_nw
    ds_write_b32 v251, v250
    s_waitcnt lgkmcnt(0)
L_op_nw:
    s_barrier
    ds_read_b32 v252, v251
    s_waitcnt lgkmcnt(0)
    v_readfirstlane_b32 s33, v252
    s_barrier
    s_nop 1
    s_cmp_lt_u32 s33, 18
    s_cbranch_scc1 L_op_start
L_done:
L_exit:
    s_endpgm
.section .rodata,"a"
.p2align 6
.amdhsa_kernel concat_heads__memory_aug_recurrent_mem_tr__ssm_conv_s4d__prompt_kernel
  .amdhsa_next_free_vgpr 512
  .amdhsa_next_free_sgpr 102
  .amdhsa_accum_offset 256
  .amdhsa_group_segment_fixed_size 0
  .amdhsa_kernarg_size 136
  .amdhsa_user_sgpr_count 2
  .amdhsa_user_sgpr_kernarg_segment_ptr 1
  .amdhsa_system_sgpr_workgroup_id_x 1
.end_amdhsa_kernel
.text
```

```asm
; @launch grid=(256,1,1) block=(256,1,1) lds=163840
.amdgcn_target "amdgcn-amd-amdhsa--gfx950"
.text
.globl concat_heads__memory_aug_recurrent_mem_tr__ssm_conv_s4d__prompt_kernel
.p2align 8
.type concat_heads__memory_aug_recurrent_mem_tr__ssm_conv_s4d__prompt_kernel,@function
concat_heads__memory_aug_recurrent_mem_tr__ssm_conv_s4d__prompt_kernel:
    s_cmp_ge_u32 s2, 256
    s_cbranch_scc1 L_exit
    s_load_dwordx4 s[80:83], s[0:1], 120
    s_load_dwordx16 s[48:63], s[0:1], 0
    s_memrealtime s[90:91]
    v_lshrrev_b32 v1, 6, v0
    s_nop 0
    v_readfirstlane_b32 s32, v1
    s_waitcnt lgkmcnt(0)
    s_mov_b32 s4, s82
    s_mov_b32 s5, s83
    s_mov_b32 s6, 268435456
    s_mov_b32 s7, 0x20000
    s_mov_b32 s84, s80
    s_mov_b32 s85, s81
    s_mov_b32 s86, 256
    s_mov_b32 s87, 0x20000
    s_cmp_lg_u32 s32, 0
    s_cbranch_scc1 L_nod0
L_nod0:
    s_cmp_lg_u32 s32, 3
    s_cbranch_scc1 L_nowarm
    s_getpc_b64 s[44:45]
L_pcw:
    v_and_b32 v1, 63, v0
    v_lshlrev_b32 v1, 7, v1
    v_min_u32 v2, L_exit-L_pcw, v1
    global_load_dword v240, v2, s[44:45]
    v_add_u32 v1, 8192, v1
    v_min_u32 v2, L_exit-L_pcw, v1
    global_load_dword v241, v2, s[44:45]
    v_add_u32 v1, 8192, v1
    v_min_u32 v2, L_exit-L_pcw, v1
    global_load_dword v242, v2, s[44:45]
    v_add_u32 v1, 8192, v1
    v_min_u32 v2, L_exit-L_pcw, v1
    global_load_dword v243, v2, s[44:45]
    v_add_u32 v1, 8192, v1
    v_min_u32 v2, L_exit-L_pcw, v1
    global_load_dword v244, v2, s[44:45]
    v_add_u32 v1, 8192, v1
    v_min_u32 v2, L_exit-L_pcw, v1
    global_load_dword v245, v2, s[44:45]
    v_add_u32 v1, 8192, v1
    v_min_u32 v2, L_exit-L_pcw, v1
    global_load_dword v246, v2, s[44:45]
    v_add_u32 v1, 8192, v1
    v_min_u32 v2, L_exit-L_pcw, v1
    global_load_dword v247, v2, s[44:45]
    v_add_u32 v1, 8192, v1
    v_min_u32 v2, L_exit-L_pcw, v1
    global_load_dword v248, v2, s[44:45]
    v_add_u32 v1, 8192, v1
L_nowarm:
    s_getreg_b32 s3, hwreg(HW_REG_XCC_ID)
    s_and_b32 s3, s3, 15
    s_cmp_lg_u32 s3, 3
    s_cbranch_scc1 L_helper
    s_mov_b32 s37, 128
    v_mov_b32 v250, 1
    v_mov_b32 v251, 163832
    v_cmp_eq_u32 vcc, 0, v0
    s_nop 0
    s_and_saveexec_b64 s[38:39], vcc
    s_cbranch_execz tk1
    buffer_atomic_add v250, off, s[84:87], s37 sc0
    s_waitcnt vmcnt(0)
    ds_write_b32 v251, v250
    s_waitcnt lgkmcnt(0)
tk1:
    s_mov_b64 exec, -1
    s_barrier
    ds_read_b32 v252, v251
    s_waitcnt lgkmcnt(0)
    v_readfirstlane_b32 s12, v252
    s_barrier
    s_nop 3
    s_cmp_ge_u32 s12, 32
    s_cbranch_scc1 L_helper
L_chain:
    s_load_dwordx8 s[48:55], s[0:1], 8
    s_load_dwordx2 s[56:57], s[0:1], 40
    s_waitcnt lgkmcnt(0)
    v_lshrrev_b32 v77, 6, v0
    s_nop 0
    v_readfirstlane_b32 s13, v77
    v_lshlrev_b32 v65, 4, v0
    v_and_b32 v48, 63, v0
    s_mov_b32 s10, 4718592
    s_mov_b32 s11, 0x20000
    v_lshrrev_b32 v49, 3, v48
    v_mul_u32_u24 v18, 1152, v49
    v_and_b32 v49, 7, v48
    v_lshl_add_u32 v18, v49, 4, v18
    s_mul_i32 s40, s12, 147456
    s_lshl_b32 s41, s13, 8
    s_add_u32 s40, s40, s41
    s_mov_b32 s42, s40
    s_xor_b32 s41, s13, 0
    s_mul_i32 s41, s41, 36864
    s_add_u32 s60, s41, s40
    s_xor_b32 s41, s13, 1
    s_mul_i32 s41, s41, 36864
    s_add_u32 s61, s41, s40
    s_xor_b32 s41, s13, 2
    s_mul_i32 s41, s41, 36864
    s_add_u32 s62, s41, s40
    s_xor_b32 s41, s13, 3
    s_mul_i32 s41, s41, 36864
    s_add_u32 s63, s41, s40
    s_lshl_b32 s43, s13, 12
    s_mov_b64 s[8:9], s[56:57]
    s_add_u32 m0, s43, 0
    s_add_u32 s41, s60, 0
    buffer_load_dwordx4 v18, s[8:11], s41 offen offset:0 nt lds
    s_add_u32 s41, s60, 8192
    buffer_load_dwordx4 v18, s[8:11], s41 offen offset:1024 nt lds
    s_add_u32 s41, s60, 16384
    buffer_load_dwordx4 v18, s[8:11], s41 offen offset:2048 nt lds
    s_add_u32 s41, s60, 24576
    buffer_load_dwordx4 v18, s[8:11], s41 offen offset:3072 nt lds
    s_add_u32 m0, s43, 36864
    s_add_u32 s41, s61, 0
    buffer_load_dwordx4 v18, s[8:11], s41 offen offset:0 nt lds
    s_add_u32 s41, s61, 8192
    buffer_load_dwordx4 v18, s[8:11], s41 offen offset:1024 nt lds
    s_add_u32 s41, s61, 16384
    buffer_load_dwordx4 v18, s[8:11], s41 offen offset:2048 nt lds
    s_add_u32 s41, s61, 24576
    buffer_load_dwordx4 v18, s[8:11], s41 offen offset:3072 nt lds
    s_add_u32 m0, s43, 73728
    s_add_u32 s41, s62, 0
    buffer_load_dwordx4 v18, s[8:11], s41 offen offset:0 nt lds
    s_add_u32 s41, s62, 8192
    buffer_load_dwordx4 v18, s[8:11], s41 offen offset:1024 nt lds
    s_add_u32 s41, s62, 16384
    buffer_load_dwordx4 v18, s[8:11], s41 offen offset:2048 nt lds
    s_add_u32 s41, s62, 24576
    buffer_load_dwordx4 v18, s[8:11], s41 offen offset:3072 nt lds
    s_add_u32 m0, s43, 110592
    s_add_u32 s41, s63, 0
    buffer_load_dwordx4 v18, s[8:11], s41 offen offset:0 nt lds
    s_add_u32 s41, s63, 8192
    buffer_load_dwordx4 v18, s[8:11], s41 offen offset:1024 nt lds
    s_add_u32 s41, s63, 16384
    buffer_load_dwordx4 v18, s[8:11], s41 offen offset:2048 nt lds
    s_add_u32 s41, s63, 24576
    buffer_load_dwordx4 v18, s[8:11], s41 offen offset:3072 nt lds
    v_lshrrev_b32 v49, 1, v48
    v_mul_u32_u24 v19, 1152, v49
    v_and_b32 v49, 1, v48
    v_lshl_add_u32 v19, v49, 4, v19
    s_mul_i32 s41, s13, 224
    s_sub_u32 s41, 1024, s41
    v_add_u32 v19, s41, v19
    v_lshrrev_b32 v49, 4, v48
    v_lshlrev_b32 v50, 2, v49
    v_and_b32 v51, 15, v48
    v_xor_b32 v51, v51, v50
    v_lshlrev_b32 v51, 4, v51
    v_lshl_add_u32 v16, v49, 15, v51
    v_lshrrev_b32 v50, 1, v49
    v_lshl_add_u32 v17, v50, 16, v51
    v_and_b32 v50, 1, v49
    v_lshl_add_u32 v17, v50, 13, v17
    s_lshl_b32 s40, s12, 8
    s_mul_i32 s58, s13, 1048576
    s_add_u32 s58, s58, s40
    s_lshr_b32 s41, s13, 1
    s_mul_i32 s59, s41, 262144
    s_and_b32 s41, s13, 1
    s_lshl_b32 s41, s41, 14
    s_add_u32 s59, s59, s41
    s_add_u32 s59, s59, s40
    s_add_u32 s59, s59, 4194304
    v_bfe_u32 v50, v48, 2, 2
    v_xor_b32 v51, s13, v50
    v_lshlrev_b32 v20, 6, v51
    v_and_b32 v51, 3, v48
    v_lshl_add_u32 v20, v51, 4, v20
    v_lshrrev_b32 v23, 2, v48
    v_lshl_add_u32 v20, v23, 8, v20
    s_xor_b32 s41, s43, 0
    v_add_u32 v24, s41, v20
    s_xor_b32 s41, s43, 4096
    v_add_u32 v25, s41, v20
    s_xor_b32 s41, s43, 8192
    v_add_u32 v26, s41, v20
    s_xor_b32 s41, s43, 12288
    v_add_u32 v27, s41, v20
    v_and_b32 v23, 1, v50
    v_lshl_add_u32 v23, v49, 2, v23
    v_lshrrev_b32 v50, 1, v50
    v_lshlrev_b32 v21, 7, v23
    v_lshl_add_u32 v21, v50, 6, v21
    v_lshrrev_b32 v16, 1, v51
    v_lshl_add_u32 v21, v16, 5, v21
    v_and_b32 v16, 1, v51
    v_lshl_add_u32 v21, v16, 3, v21
    v_add_u32 v21, s43, v21
    v_lshlrev_b32 v22, 9, v50
    v_xor_b32 v22, v22, v21
    v_lshlrev_b32 v23, 5, v23
    v_lshl_add_u32 v23, v50, 10, v23
    v_lshl_add_u32 v23, v51, 3, v23
    v_add_u32 v23, s43, v23
    v_bfe_u32 v60, v65, 4, 6
    v_and_b32 v61, 15, v60
    v_lshrrev_b32 v62, 4, v60
    v_mov_b32 v64, 0x4444
    v_mov_b32 v77, 0xeeee
    v_cmp_lt_u32 vcc, 7, v61
    s_nop 1
    v_cndmask_b32 v64, v64, v77, vcc
    v_xor_b32 v66, 1024, v65
    v_xor_b32 v67, 2048, v65
    v_xor_b32 v68, 3072, v65
    v_and_b32 v69, 511, v65
    s_mul_i32 s96, s13, 36864
    s_add_u32 s96, s96, 16384
    v_lshlrev_b32 v70, 4, v60
    v_add_u32 v70, s96, v70
    v_lshrrev_b32 v79, 1, v69
    s_lshl_b32 s96, s13, 8
    s_add_u32 s96, s96, 14336
    s_lshl_b32 s33, s13, 10
    s_add_u32 s97, s33, 8192
    v_mov_b32 v77, s97
    v_mov_b32 v78, s96
    v_cmp_lt_u32 vcc, 31, v60
    s_nop 1
    v_cndmask_b32 v71, v77, v78, vcc
    v_add_u32 v71, v71, v79
    v_and_b32 v77, 7, v61
    v_lshrrev_b32 v78, 3, v61
    v_lshlrev_b32 v74, 4, v77
    v_lshl_add_u32 v73, v62, 7, v74
    v_lshl_add_u32 v73, v78, 3, v73
    s_lshl_b32 s96, s13, 9
    v_add_u32 v73, s96, v73
    v_lshrrev_b32 v74, 1, v74
    v_lshl_add_u32 v74, v78, 14, v74
    v_lshl_add_u32 v74, v62, 15, v74
    s_lshl_b32 s96, s13, 17
    v_add_u32 v74, s96, v74
    v_bfe_u32 v77, v61, 2, 1
    v_and_b32 v78, 3, v61
    s_cmp_lt_u32 s13, 2
    s_cselect_b64 vcc, -1, 0
    v_cndmask_b32 v77, 0, v77, vcc
    v_lshlrev_b32 v75, 7, v77
    v_lshl_add_u32 v75, v62, 4, v75
    v_lshl_add_u32 v75, v78, 2, v75
    v_lshlrev_b32 v58, 3, v77
    v_lshl_add_u32 v58, v78, 1, v58
    s_bfe_u32 s97, s12, 0x10001
    s_lshl_b32 s68, s97, 6
    s_lshl_b32 s97, s97, 2
    v_add_u32 v59, s97, v62
    s_bfe_u32 s96, s12, 0x10002
    s_and_b32 s40, s12, 1
    s_lshl_b32 s96, s96, 1
    s_add_u32 s96, s96, s40
    s_lshr_b32 s97, s12, 3
    s_lshl_b32 s98, s13, 2
    s_add_u32 s98, s98, s97
    s_lshl_b32 s98, s98, 2
    s_add_u32 s98, s98, s96
    s_lshl_b32 s98, s98, 8
    s_lshl_b32 s99, s13, 2
    s_add_u32 s99, s99, s96
    s_lshl_b32 s99, s99, 4
    s_lshl_b32 s41, s97, 1
    s_add_u32 s41, s41, s40
    s_lshl_b32 s41, s41, 7
    s_add_u32 s41, s41, 8192
    s_lshl_b32 s40, s40, 3
    s_add_u32 s40, s40, 512
    s_cmp_lt_u32 s13, 2
    s_cselect_b32 s96, 7, 4
    s_cselect_b32 s98, s98, s41
    s_cselect_b32 s99, s99, s40
    s_cselect_b32 s32, 1, 0
    s_add_u32 s68, s68, s98
    s_lshl_b32 s97, s97, s96
    s_add_u32 s99, s99, s97
    v_add_u32 v58, s99, v58
    s_and_b32 s97, s12, 4
    s_or_b32 s97, s97, s13
    s_cmp_eq_u32 s97, 2
    s_cselect_b32 s32, 2, s32
    s_mov_b32 s8, s48
    s_mov_b32 s9, s49
    s_mov_b32 s10, 9216
    v_mul_u32_u24 v77, 1152, v59
    v_lshl_add_u32 v77, v58, 1, v77
    buffer_load_dword v72, v77, s[8:11], 0 offen
    s_mov_b32 s10, 4718592
    s_waitcnt vmcnt(12) lgkmcnt(0)
    s_barrier
    s_mov_b64 s[8:9], s[56:57]
    s_add_u32 m0, s43, 147456
    s_add_u32 s41, s42, 0
    buffer_load_dwordx4 v19, s[8:11], s41 offen offset:0 nt lds
    s_add_u32 s41, s42, 35840
    buffer_load_dwordx4 v19, s[8:11], s41 offen offset:1024 nt lds
    s_add_u32 s41, s42, 71680
    buffer_load_dwordx4 v19, s[8:11], s41 offen offset:2048 nt lds
    s_add_u32 s41, s42, 107520
    buffer_load_dwordx4 v19, s[8:11], s41 offen offset:3072 nt lds
    v_mov_b32 v78, v21
    v_mov_b32 v79, v22
    v_add_u32 v77, 0, v79
    ds_read_b64_tr_b16 v[80:81], v77 offset:0
    ds_read_b64_tr_b16 v[82:83], v77 offset:256
    ds_read_b64_tr_b16 v[84:85], v77 offset:2048
    ds_read_b64_tr_b16 v[86:87], v77 offset:2304
    ds_read_b64_tr_b16 v[112:113], v77 offset:16
    ds_read_b64_tr_b16 v[114:115], v77 offset:272
    ds_read_b64_tr_b16 v[116:117], v77 offset:2064
    ds_read_b64_tr_b16 v[118:119], v77 offset:2320
    s_waitcnt vmcnt(12) lgkmcnt(0)
    s_barrier
    s_mov_b64 s[8:9], s[52:53]
    s_add_u32 m0, s43, 0
    s_add_u32 s41, s58, 0
    buffer_load_dwordx4 v17, s[8:11], s41 offen offset:0 nt lds
    s_add_u32 s41, s58, 31744
    buffer_load_dwordx4 v17, s[8:11], s41 offen offset:1024 nt lds
    s_add_u32 s41, s58, 129024
    buffer_load_dwordx4 v17, s[8:11], s41 offen offset:2048 nt lds
    s_add_u32 s41, s58, 160768
    buffer_load_dwordx4 v17, s[8:11], s41 offen offset:3072 nt lds
    v_add_u32 v77, 36864, v78
    ds_read_b64_tr_b16 v[88:89], v77 offset:0
    ds_read_b64_tr_b16 v[90:91], v77 offset:256
    ds_read_b64_tr_b16 v[92:93], v77 offset:2048
    ds_read_b64_tr_b16 v[94:95], v77 offset:2304
    ds_read_b64_tr_b16 v[120:121], v77 offset:16
    ds_read_b64_tr_b16 v[122:123], v77 offset:272
    ds_read_b64_tr_b16 v[124:125], v77 offset:2064
    ds_read_b64_tr_b16 v[126:127], v77 offset:2320
    s_waitcnt vmcnt(12) lgkmcnt(0)
    s_barrier
    s_add_u32 m0, s43, 36864
    s_add_u32 s41, s58, 16384
    buffer_load_dwordx4 v17, s[8:11], s41 offen offset:0 nt lds
    s_add_u32 s41, s58, 48128
    buffer_load_dwordx4 v17, s[8:11], s41 offen offset:1024 nt lds
    s_add_u32 s41, s58, 145408
    buffer_load_dwordx4 v17, s[8:11], s41 offen offset:2048 nt lds
    s_add_u32 s41, s58, 177152
    buffer_load_dwordx4 v17, s[8:11], s41 offen offset:3072 nt lds
    v_add_u32 v77, 73728, v78
    ds_read_b64_tr_b16 v[96:97], v77 offset:0
    ds_read_b64_tr_b16 v[98:99], v77 offset:256
    ds_read_b64_tr_b16 v[100:101], v77 offset:2048
    ds_read_b64_tr_b16 v[102:103], v77 offset:2304
    ds_read_b64_tr_b16 v[128:129], v77 offset:16
    ds_read_b64_tr_b16 v[130:131], v77 offset:272
    ds_read_b64_tr_b16 v[132:133], v77 offset:2064
    ds_read_b64_tr_b16 v[134:135], v77 offset:2320
    s_waitcnt vmcnt(12) lgkmcnt(0)
    s_barrier
    s_add_u32 m0, s43, 73728
    s_add_u32 s41, s58, 262144
    buffer_load_dwordx4 v17, s[8:11], s41 offen offset:0 nt lds
    s_add_u32 s41, s58, 293888
    buffer_load_dwordx4 v17, s[8:11], s41 offen offset:1024 nt lds
    s_add_u32 s41, s58, 391168
    buffer_load_dwordx4 v17, s[8:11], s41 offen offset:2048 nt lds
    s_add_u32 s41, s58, 422912
    buffer_load_dwordx4 v17, s[8:11], s41 offen offset:3072 nt lds
    v_add_u32 v77, 110592, v78
    ds_read_b64_tr_b16 v[104:105], v77 offset:0
    ds_read_b64_tr_b16 v[106:107], v77 offset:256
    ds_read_b64_tr_b16 v[108:109], v77 offset:2048
    ds_read_b64_tr_b16 v[110:111], v77 offset:2304
    ds_read_b64_tr_b16 v[136:137], v77 offset:16
    ds_read_b64_tr_b16 v[138:139], v77 offset:272
    ds_read_b64_tr_b16 v[140:141], v77 offset:2064
    ds_read_b64_tr_b16 v[142:143], v77 offset:2320
    s_waitcnt vmcnt(12) lgkmcnt(0)
    s_barrier
    s_add_u32 m0, s43, 110592
    s_add_u32 s41, s58, 278528
    buffer_load_dwordx4 v17, s[8:11], s41 offen offset:0 nt lds
    s_add_u32 s41, s58, 310272
    buffer_load_dwordx4 v17, s[8:11], s41 offen offset:1024 nt lds
    s_add_u32 s41, s58, 407552
    buffer_load_dwordx4 v17, s[8:11], s41 offen offset:2048 nt lds
    s_add_u32 s41, s58, 439296
    buffer_load_dwordx4 v17, s[8:11], s41 offen offset:3072 nt lds
    v_add_u32 v77, 147456, v23
    ds_read_b64_tr_b16 v[0:1], v77 offset:0
    ds_read_b64_tr_b16 v[2:3], v77 offset:64
    ds_read_b64_tr_b16 v[4:5], v77 offset:512
    ds_read_b64_tr_b16 v[6:7], v77 offset:576
    ds_read_b64_tr_b16 v[8:9], v77 offset:2048
    ds_read_b64_tr_b16 v[10:11], v77 offset:2112
    ds_read_b64_tr_b16 v[12:13], v77 offset:2560
    ds_read_b64_tr_b16 v[14:15], v77 offset:2624
    s_waitcnt vmcnt(12) lgkmcnt(0)
    s_barrier
    s_add_u32 m0, s43, 147456
    s_add_u32 s41, s58, 524288
    buffer_load_dwordx4 v17, s[8:11], s41 offen offset:0 nt lds
    s_add_u32 s41, s58, 556032
    buffer_load_dwordx4 v17, s[8:11], s41 offen offset:1024 nt lds
    s_add_u32 s41, s58, 653312
    buffer_load_dwordx4 v17, s[8:11], s41 offen offset:2048 nt lds
    s_add_u32 s41, s58, 685056
    buffer_load_dwordx4 v17, s[8:11], s41 offen offset:3072 nt lds
    s_cmp_eq_u32 s32, 0
    s_cbranch_scc1 cf_init_done
    v_mov_b32 v52, 1
    v_mov_b32 v53, 1
    v_mov_b32 v54, 1
    v_mov_b32 v55, 1
    v_mov_b32 v56, 0
    s_lshl_b32 s96, s12, 14
    s_add_u32 s96, s96, 68157440
    s_add_u32 s97, s96, 0
    buffer_store_dwordx4 v[52:55], v65, s[4:7], s97 offen
    buffer_load_dwordx4 v[60:63], v65, s[4:7], s97 offen sc1
    s_add_u32 s97, s96, 4096
    buffer_store_dwordx4 v[52:55], v65, s[4:7], s97 offen
    buffer_load_dwordx4 v[60:63], v65, s[4:7], s97 offen sc1
    s_add_u32 s97, s96, 8192
    buffer_store_dwordx4 v[52:55], v65, s[4:7], s97 offen
    buffer_load_dwordx4 v[60:63], v65, s[4:7], s97 offen sc1
    s_add_u32 s97, s96, 12288
    buffer_store_dwordx4 v[52:55], v65, s[4:7], s97 offen
    buffer_load_dwordx4 v[60:63], v65, s[4:7], s97 offen sc1
    s_add_u32 s96, s68, 67108864
    s_add_u32 s97, s96, 16384
    buffer_store_dword v56, v75, s[4:7], s96 offen offset:0
    buffer_store_dword v72, v75, s[4:7], s97 offen offset:0
    buffer_load_dword v60, v75, s[4:7], s96 offen offset:0 sc1
    buffer_load_dword v60, v75, s[4:7], s97 offen offset:0 sc1
    s_cmp_lg_u32 s32, 2
    s_cbranch_scc1 cf_init_done
    buffer_store_dword v56, v75, s[4:7], s96 offen offset:1024
    buffer_store_dword v72, v75, s[4:7], s97 offen offset:1024
    buffer_load_dword v60, v75, s[4:7], s96 offen offset:1024 sc1
    buffer_load_dword v60, v75, s[4:7], s97 offen offset:1024 sc1
    buffer_store_dword v56, v75, s[4:7], s96 offen offset:2048
    buffer_store_dword v72, v75, s[4:7], s97 offen offset:2048
    buffer_load_dword v60, v75, s[4:7], s96 offen offset:2048 sc1
    buffer_load_dword v60, v75, s[4:7], s97 offen offset:2048 sc1
    buffer_store_dword v56, v75, s[4:7], s96 offen offset:3072
    buffer_store_dword v72, v75, s[4:7], s97 offen offset:3072
    buffer_load_dword v60, v75, s[4:7], s96 offen offset:3072 sc1
    buffer_load_dword v60, v75, s[4:7], s97 offen offset:3072 sc1
cf_init_done:
    ds_write_b64 v70, v[0:1] offset:16384
    ds_write_b64 v70, v[2:3] offset:16392
    ds_write_b64 v70, v[4:5] offset:17408
    ds_write_b64 v70, v[6:7] offset:17416
    ds_write_b64 v70, v[8:9] offset:18432
    ds_write_b64 v70, v[10:11] offset:18440
    ds_write_b64 v70, v[12:13] offset:19456
    ds_write_b64 v70, v[14:15] offset:19464
    v_add_u32 v28, 0, v24
    v_add_u32 v29, 0, v25
    v_add_u32 v30, 0, v26
    v_add_u32 v31, 0, v27
    ds_read_b64_tr_b16 a[96:97], v28 offset:0
    ds_read_b64_tr_b16 a[104:105], v28 offset:8
    ds_read_b64_tr_b16 a[112:113], v29 offset:0
    ds_read_b64_tr_b16 a[120:121], v29 offset:8
    ds_read_b64_tr_b16 a[128:129], v30 offset:0
    ds_read_b64_tr_b16 a[136:137], v30 offset:8
    ds_read_b64_tr_b16 a[144:145], v31 offset:0
    ds_read_b64_tr_b16 v[32:33], v31 offset:8
    s_waitcnt vmcnt(12) lgkmcnt(0)
    s_barrier
    s_add_u32 m0, s43, 0
    s_add_u32 s41, s58, 540672
    buffer_load_dwordx4 v17, s[8:11], s41 offen offset:0 nt lds
    s_add_u32 s41, s58, 572416
    buffer_load_dwordx4 v17, s[8:11], s41 offen offset:1024 nt lds
    s_add_u32 s41, s58, 669696
    buffer_load_dwordx4 v17, s[8:11], s41 offen offset:2048 nt lds
    s_add_u32 s41, s58, 701440
    buffer_load_dwordx4 v17, s[8:11], s41 offen offset:3072 nt lds
    ds_write_b64 v70, v[32:33] offset:12288
    v_add_u32 v28, 36864, v24
    v_add_u32 v29, 36864, v25
    v_add_u32 v30, 36864, v26
    v_add_u32 v31, 36864, v27
    ds_read_b64_tr_b16 a[98:99], v28 offset:0
    ds_read_b64_tr_b16 a[106:107], v28 offset:8
    ds_read_b64_tr_b16 a[114:115], v29 offset:0
    ds_read_b64_tr_b16 a[122:123], v29 offset:8
    ds_read_b64_tr_b16 a[130:131], v30 offset:0
    ds_read_b64_tr_b16 a[138:139], v30 offset:8
    ds_read_b64_tr_b16 a[146:147], v31 offset:0
    ds_read_b64_tr_b16 v[0:1], v31 offset:8
    s_waitcnt vmcnt(12) lgkmcnt(0)
    s_barrier
    s_add_u32 m0, s43, 36864
    s_add_u32 s41, s58, 786432
    buffer_load_dwordx4 v17, s[8:11], s41 offen offset:0 nt lds
    s_add_u32 s41, s58, 818176
    buffer_load_dwordx4 v17, s[8:11], s41 offen offset:1024 nt lds
    s_add_u32 s41, s58, 915456
    buffer_load_dwordx4 v17, s[8:11], s41 offen offset:2048 nt lds
    s_add_u32 s41, s58, 947200
    buffer_load_dwordx4 v17, s[8:11], s41 offen offset:3072 nt lds
    ds_write_b64 v70, v[0:1] offset:12296
    v_add_u32 v28, 73728, v24
    v_add_u32 v29, 73728, v25
    v_add_u32 v30, 73728, v26
    v_add_u32 v31, 73728, v27
    ds_read_b64_tr_b16 a[100:101], v28 offset:0
    ds_read_b64_tr_b16 a[108:109], v28 offset:8
    ds_read_b64_tr_b16 a[116:117], v29 offset:0
    ds_read_b64_tr_b16 a[124:125], v29 offset:8
    ds_read_b64_tr_b16 a[132:133], v30 offset:0
    ds_read_b64_tr_b16 a[140:141], v30 offset:8
    ds_read_b64_tr_b16 a[148:149], v31 offset:0
    ds_read_b64_tr_b16 v[32:33], v31 offset:8
    s_waitcnt vmcnt(12) lgkmcnt(0)
    s_barrier
    s_add_u32 m0, s43, 73728
    s_add_u32 s41, s58, 802816
    buffer_load_dwordx4 v17, s[8:11], s41 offen offset:0 nt lds
    s_add_u32 s41, s58, 834560
    buffer_load_dwordx4 v17, s[8:11], s41 offen offset:1024 nt lds
    s_add_u32 s41, s58, 931840
    buffer_load_dwordx4 v17, s[8:11], s41 offen offset:2048 nt lds
    s_add_u32 s41, s58, 963584
    buffer_load_dwordx4 v17, s[8:11], s41 offen offset:3072 nt lds
    ds_write_b64 v70, v[32:33] offset:13312
    v_add_u32 v28, 110592, v24
    v_add_u32 v29, 110592, v25
    v_add_u32 v30, 110592, v26
    v_add_u32 v31, 110592, v27
    ds_read_b64_tr_b16 a[102:103], v28 offset:0
    ds_read_b64_tr_b16 a[110:111], v28 offset:8
    ds_read_b64_tr_b16 a[118:119], v29 offset:0
    ds_read_b64_tr_b16 a[126:127], v29 offset:8
    ds_read_b64_tr_b16 a[134:135], v30 offset:0
    ds_read_b64_tr_b16 a[142:143], v30 offset:8
    ds_read_b64_tr_b16 a[150:151], v31 offset:0
    ds_read_b64_tr_b16 v[0:1], v31 offset:8
    s_waitcnt vmcnt(12) lgkmcnt(0)
    s_barrier
    s_add_u32 m0, s43, 110592
    s_add_u32 s41, s59, 0
    buffer_load_dwordx4 v17, s[8:11], s41 offen offset:0 nt lds
    s_add_u32 s41, s59, 31744
    buffer_load_dwordx4 v17, s[8:11], s41 offen offset:1024 nt lds
    s_add_u32 s41, s59, 129024
    buffer_load_dwordx4 v17, s[8:11], s41 offen offset:2048 nt lds
    s_add_u32 s41, s59, 160768
    buffer_load_dwordx4 v17, s[8:11], s41 offen offset:3072 nt lds
    ds_write_b64 v70, v[0:1] offset:13320
    v_add_u32 v28, 147456, v24
    v_add_u32 v29, 147456, v25
    v_add_u32 v30, 147456, v26
    v_add_u32 v31, 147456, v27
    ds_read_b64_tr_b16 a[152:153], v28 offset:0
    ds_read_b64_tr_b16 a[160:161], v28 offset:8
    ds_read_b64_tr_b16 a[168:169], v29 offset:0
    ds_read_b64_tr_b16 a[176:177], v29 offset:8
    ds_read_b64_tr_b16 a[184:185], v30 offset:0
    ds_read_b64_tr_b16 a[192:193], v30 offset:8
    ds_read_b64_tr_b16 a[200:201], v31 offset:0
    ds_read_b64_tr_b16 a[208:209], v31 offset:8
    s_waitcnt vmcnt(12) lgkmcnt(0)
    s_barrier
    s_mov_b64 s[8:9], s[50:51]
    s_add_u32 m0, s43, 147456
    s_add_u32 s41, s58, 0
    buffer_load_dwordx4 v17, s[8:11], s41 offen offset:0 nt lds
    s_add_u32 s41, s58, 31744
    buffer_load_dwordx4 v17, s[8:11], s41 offen offset:1024 nt lds
    s_add_u32 s41, s58, 129024
    buffer_load_dwordx4 v17, s[8:11], s41 offen offset:2048 nt lds
    s_add_u32 s41, s58, 160768
    buffer_load_dwordx4 v17, s[8:11], s41 offen offset:3072 nt lds
    s_cmp_lg_u32 s13, 0
    s_cbranch_scc1 cf_ma
    v_mov_b32 v54, 1
    s_mov_b64 exec, 1
    buffer_atomic_add v54, off, s[84:87], 0 offset:132
    s_mov_b64 exec, -1
cf_ma:
    v_add_u32 v28, 0, v24
    v_add_u32 v29, 0, v25
    v_add_u32 v30, 0, v26
    v_add_u32 v31, 0, v27
    ds_read_b64_tr_b16 a[154:155], v28 offset:0
    ds_read_b64_tr_b16 a[162:163], v28 offset:8
    ds_read_b64_tr_b16 a[170:171], v29 offset:0
    ds_read_b64_tr_b16 a[178:179], v29 offset:8
    ds_read_b64_tr_b16 a[186:187], v30 offset:0
    ds_read_b64_tr_b16 a[194:195], v30 offset:8
    ds_read_b64_tr_b16 a[202:203], v31 offset:0
    ds_read_b64_tr_b16 a[210:211], v31 offset:8
    s_waitcnt vmcnt(12) lgkmcnt(0)
    s_barrier
    s_add_u32 m0, s43, 0
    s_add_u32 s41, s58, 16384
    buffer_load_dwordx4 v17, s[8:11], s41 offen offset:0 nt lds
    s_add_u32 s41, s58, 48128
    buffer_load_dwordx4 v17, s[8:11], s41 offen offset:1024 nt lds
    s_add_u32 s41, s58, 145408
    buffer_load_dwordx4 v17, s[8:11], s41 offen offset:2048 nt lds
    s_add_u32 s41, s58, 177152
    buffer_load_dwordx4 v17, s[8:11], s41 offen offset:3072 nt lds
    v_add_u32 v28, 36864, v24
    v_add_u32 v29, 36864, v25
    v_add_u32 v30, 36864, v26
    v_add_u32 v31, 36864, v27
    ds_read_b64_tr_b16 a[156:157], v28 offset:0
    ds_read_b64_tr_b16 a[164:165], v28 offset:8
    ds_read_b64_tr_b16 a[172:173], v29 offset:0
    ds_read_b64_tr_b16 a[180:181], v29 offset:8
    ds_read_b64_tr_b16 a[188:189], v30 offset:0
    ds_read_b64_tr_b16 a[196:197], v30 offset:8
    ds_read_b64_tr_b16 a[204:205], v31 offset:0
    ds_read_b64_tr_b16 a[212:213], v31 offset:8
    s_waitcnt vmcnt(12) lgkmcnt(0)
    s_barrier
    s_add_u32 m0, s43, 36864
    s_add_u32 s41, s58, 262144
    buffer_load_dwordx4 v17, s[8:11], s41 offen offset:0 nt lds
    s_add_u32 s41, s58, 293888
    buffer_load_dwordx4 v17, s[8:11], s41 offen offset:1024 nt lds
    s_add_u32 s41, s58, 391168
    buffer_load_dwordx4 v17, s[8:11], s41 offen offset:2048 nt lds
    s_add_u32 s41, s58, 422912
    buffer_load_dwordx4 v17, s[8:11], s41 offen offset:3072 nt lds
    v_add_u32 v28, 73728, v24
    v_add_u32 v29, 73728, v25
    v_add_u32 v30, 73728, v26
    v_add_u32 v31, 73728, v27
    ds_read_b64_tr_b16 a[158:159], v28 offset:0
    ds_read_b64_tr_b16 a[166:167], v28 offset:8
    ds_read_b64_tr_b16 a[174:175], v29 offset:0
    ds_read_b64_tr_b16 a[182:183], v29 offset:8
    ds_read_b64_tr_b16 a[190:191], v30 offset:0
    ds_read_b64_tr_b16 a[198:199], v30 offset:8
    ds_read_b64_tr_b16 a[206:207], v31 offset:0
    ds_read_b64_tr_b16 a[214:215], v31 offset:8
    s_waitcnt vmcnt(12) lgkmcnt(0)
    s_barrier
    s_add_u32 m0, s43, 73728
    s_add_u32 s41, s58, 278528
    buffer_load_dwordx4 v17, s[8:11], s41 offen offset:0 nt lds
    s_add_u32 s41, s58, 310272
    buffer_load_dwordx4 v17, s[8:11], s41 offen offset:1024 nt lds
    s_add_u32 s41, s58, 407552
    buffer_load_dwordx4 v17, s[8:11], s41 offen offset:2048 nt lds
    s_add_u32 s41, s58, 439296
    buffer_load_dwordx4 v17, s[8:11], s41 offen offset:3072 nt lds
    v_add_u32 v77, 110592, v20
    ds_read_b64_tr_b16 a[216:217], v77 offset:0
    ds_read_b64_tr_b16 a[218:219], v77 offset:4096
    ds_read_b64_tr_b16 a[220:221], v77 offset:8192
    ds_read_b64_tr_b16 a[222:223], v77 offset:12288
    ds_read_b64_tr_b16 a[224:225], v77 offset:8
    ds_read_b64_tr_b16 a[226:227], v77 offset:4104
    ds_read_b64_tr_b16 a[228:229], v77 offset:8200
    ds_read_b64_tr_b16 a[230:231], v77 offset:12296
    s_waitcnt vmcnt(12) lgkmcnt(0)
    s_barrier
    s_add_u32 m0, s43, 110592
    s_add_u32 s41, s58, 524288
    buffer_load_dwordx4 v17, s[8:11], s41 offen offset:0 nt lds
    s_add_u32 s41, s58, 556032
    buffer_load_dwordx4 v17, s[8:11], s41 offen offset:1024 nt lds
    s_add_u32 s41, s58, 653312
    buffer_load_dwordx4 v17, s[8:11], s41 offen offset:2048 nt lds
    s_add_u32 s41, s58, 685056
    buffer_load_dwordx4 v17, s[8:11], s41 offen offset:3072 nt lds
    v_add_u32 v28, 147456, v24
    v_add_u32 v29, 147456, v25
    v_add_u32 v30, 147456, v26
    v_add_u32 v31, 147456, v27
    ds_read_b64_tr_b16 v[0:1], v28 offset:0
    ds_read_b64_tr_b16 v[2:3], v28 offset:8
    ds_read_b64_tr_b16 v[4:5], v29 offset:0
    ds_read_b64_tr_b16 v[6:7], v29 offset:8
    ds_read_b64_tr_b16 a[0:1], v30 offset:0
    ds_read_b64_tr_b16 v[8:9], v30 offset:8
    ds_read_b64_tr_b16 a[8:9], v31 offset:0
    ds_read_b64_tr_b16 v[10:11], v31 offset:8
    s_waitcnt vmcnt(12) lgkmcnt(0)
    s_barrier
    s_add_u32 m0, s43, 147456
    s_add_u32 s41, s58, 540672
    buffer_load_dwordx4 v17, s[8:11], s41 offen offset:0 nt lds
    s_add_u32 s41, s58, 572416
    buffer_load_dwordx4 v17, s[8:11], s41 offen offset:1024 nt lds
    s_add_u32 s41, s58, 669696
    buffer_load_dwordx4 v17, s[8:11], s41 offen offset:2048 nt lds
    s_add_u32 s41, s58, 701440
    buffer_load_dwordx4 v17, s[8:11], s41 offen offset:3072 nt lds
    ds_write_b64 v70, v[0:1] offset:0
    ds_write_b64 v70, v[2:3] offset:2048
    ds_write_b64 v70, v[4:5] offset:4096
    ds_write_b64 v70, v[6:7] offset:6144
    ds_write_b64 v70, v[8:9] offset:10240
    ds_write_b64 v70, v[10:11] offset:14336
    v_add_u32 v28, 0, v24
    v_add_u32 v29, 0, v25
    v_add_u32 v30, 0, v26
    v_add_u32 v31, 0, v27
    ds_read_b64_tr_b16 v[32:33], v28 offset:0
    ds_read_b64_tr_b16 v[34:35], v28 offset:8
    ds_read_b64_tr_b16 v[36:37], v29 offset:0
    ds_read_b64_tr_b16 v[38:39], v29 offset:8
    ds_read_b64_tr_b16 a[2:3], v30 offset:0
    ds_read_b64_tr_b16 v[40:41], v30 offset:8
    ds_read_b64_tr_b16 a[10:11], v31 offset:0
    ds_read_b64_tr_b16 v[42:43], v31 offset:8
    s_waitcnt vmcnt(12) lgkmcnt(0)
    s_barrier
    s_add_u32 m0, s43, 0
    s_add_u32 s41, s58, 786432
    buffer_load_dwordx4 v17, s[8:11], s41 offen offset:0 nt lds
    s_add_u32 s41, s58, 818176
    buffer_load_dwordx4 v17, s[8:11], s41 offen offset:1024 nt lds
    s_add_u32 s41, s58, 915456
    buffer_load_dwordx4 v17, s[8:11], s41 offen offset:2048 nt lds
    s_add_u32 s41, s58, 947200
    buffer_load_dwordx4 v17, s[8:11], s41 offen offset:3072 nt lds
    ds_write_b64 v70, v[32:33] offset:8
    ds_write_b64 v70, v[34:35] offset:2056
    ds_write_b64 v70, v[36:37] offset:4104
    ds_write_b64 v70, v[38:39] offset:6152
    ds_write_b64 v70, v[40:41] offset:10248
    ds_write_b64 v70, v[42:43] offset:14344
    v_add_u32 v28, 36864, v24
    v_add_u32 v29, 36864, v25
    v_add_u32 v30, 36864, v26
    v_add_u32 v31, 36864, v27
    ds_read_b64_tr_b16 v[0:1], v28 offset:0
    ds_read_b64_tr_b16 v[2:3], v28 offset:8
    ds_read_b64_tr_b16 v[4:5], v29 offset:0
    ds_read_b64_tr_b16 v[6:7], v29 offset:8
    ds_read_b64_tr_b16 a[4:5], v30 offset:0
    ds_read_b64_tr_b16 v[8:9], v30 offset:8
    ds_read_b64_tr_b16 a[12:13], v31 offset:0
    ds_read_b64_tr_b16 v[10:11], v31 offset:8
    s_waitcnt vmcnt(12) lgkmcnt(0)
    s_barrier
    s_add_u32 m0, s43, 36864
    s_add_u32 s41, s58, 802816
    buffer_load_dwordx4 v17, s[8:11], s41 offen offset:0 nt lds
    s_add_u32 s41, s58, 834560
    buffer_load_dwordx4 v17, s[8:11], s41 offen offset:1024 nt lds
    s_add_u32 s41, s58, 931840
    buffer_load_dwordx4 v17, s[8:11], s41 offen offset:2048 nt lds
    s_add_u32 s41, s58, 963584
    buffer_load_dwordx4 v17, s[8:11], s41 offen offset:3072 nt lds
    ds_write_b64 v70, v[0:1] offset:1024
    ds_write_b64 v70, v[2:3] offset:3072
    ds_write_b64 v70, v[4:5] offset:5120
    ds_write_b64 v70, v[6:7] offset:7168
    ds_write_b64 v70, v[8:9] offset:11264
    ds_write_b64 v70, v[10:11] offset:15360
    v_add_u32 v28, 73728, v24
    v_add_u32 v29, 73728, v25
    v_add_u32 v30, 73728, v26
    v_add_u32 v31, 73728, v27
    ds_read_b64_tr_b16 v[32:33], v28 offset:0
    ds_read_b64_tr_b16 v[34:35], v28 offset:8
    ds_read_b64_tr_b16 v[36:37], v29 offset:0
    ds_read_b64_tr_b16 v[38:39], v29 offset:8
    ds_read_b64_tr_b16 a[6:7], v30 offset:0
    ds_read_b64_tr_b16 v[40:41], v30 offset:8
    ds_read_b64_tr_b16 a[14:15], v31 offset:0
    ds_read_b64_tr_b16 v[42:43], v31 offset:8
    s_waitcnt vmcnt(12) lgkmcnt(0)
    s_barrier
    s_add_u32 m0, s43, 73728
    s_add_u32 s41, s59, 0
    buffer_load_dwordx4 v17, s[8:11], s41 offen offset:0 nt lds
    s_add_u32 s41, s59, 31744
    buffer_load_dwordx4 v17, s[8:11], s41 offen offset:1024 nt lds
    s_add_u32 s41, s59, 129024
    buffer_load_dwordx4 v17, s[8:11], s41 offen offset:2048 nt lds
    s_add_u32 s41, s59, 160768
    buffer_load_dwordx4 v17, s[8:11], s41 offen offset:3072 nt lds
    ds_write_b64 v70, v[32:33] offset:1032
    ds_write_b64 v70, v[34:35] offset:3080
    ds_write_b64 v70, v[36:37] offset:5128
    ds_write_b64 v70, v[38:39] offset:7176
    ds_write_b64 v70, v[40:41] offset:11272
    ds_write_b64 v70, v[42:43] offset:15368
    v_add_u32 v28, 110592, v24
    v_add_u32 v29, 110592, v25
    v_add_u32 v30, 110592, v26
    v_add_u32 v31, 110592, v27
    ds_read_b64_tr_b16 a[16:17], v28 offset:0
    ds_read_b64_tr_b16 a[24:25], v28 offset:8
    ds_read_b64_tr_b16 a[32:33], v29 offset:0
    ds_read_b64_tr_b16 a[40:41], v29 offset:8
    ds_read_b64_tr_b16 a[48:49], v30 offset:0
    ds_read_b64_tr_b16 a[56:57], v30 offset:8
    ds_read_b64_tr_b16 a[64:65], v31 offset:0
    ds_read_b64_tr_b16 a[72:73], v31 offset:8
    s_waitcnt vmcnt(12) lgkmcnt(0)
    s_barrier
    s_mov_b64 s[8:9], s[54:55]
    s_add_u32 m0, s43, 110592
    s_add_u32 s41, s58, 0
    buffer_load_dwordx4 v17, s[8:11], s41 offen offset:0 nt lds
    s_add_u32 s41, s58, 31744
    buffer_load_dwordx4 v17, s[8:11], s41 offen offset:1024 nt lds
    s_add_u32 s41, s58, 129024
    buffer_load_dwordx4 v17, s[8:11], s41 offen offset:2048 nt lds
    s_add_u32 s41, s58, 160768
    buffer_load_dwordx4 v17, s[8:11], s41 offen offset:3072 nt lds
    v_add_u32 v28, 147456, v24
    v_add_u32 v29, 147456, v25
    v_add_u32 v30, 147456, v26
    v_add_u32 v31, 147456, v27
    ds_read_b64_tr_b16 a[18:19], v28 offset:0
    ds_read_b64_tr_b16 a[26:27], v28 offset:8
    ds_read_b64_tr_b16 a[34:35], v29 offset:0
    ds_read_b64_tr_b16 a[42:43], v29 offset:8
    ds_read_b64_tr_b16 a[50:51], v30 offset:0
    ds_read_b64_tr_b16 a[58:59], v30 offset:8
    ds_read_b64_tr_b16 a[66:67], v31 offset:0
    ds_read_b64_tr_b16 a[74:75], v31 offset:8
    s_waitcnt vmcnt(12) lgkmcnt(0)
    s_barrier
    s_add_u32 m0, s43, 147456
    s_add_u32 s41, s58, 16384
    buffer_load_dwordx4 v17, s[8:11], s41 offen offset:0 nt lds
    s_add_u32 s41, s58, 48128
    buffer_load_dwordx4 v17, s[8:11], s41 offen offset:1024 nt lds
    s_add_u32 s41, s58, 145408
    buffer_load_dwordx4 v17, s[8:11], s41 offen offset:2048 nt lds
    s_add_u32 s41, s58, 177152
    buffer_load_dwordx4 v17, s[8:11], s41 offen offset:3072 nt lds
    v_add_u32 v28, 0, v24
    v_add_u32 v29, 0, v25
    v_add_u32 v30, 0, v26
    v_add_u32 v31, 0, v27
    ds_read_b64_tr_b16 a[20:21], v28 offset:0
    ds_read_b64_tr_b16 a[28:29], v28 offset:8
    ds_read_b64_tr_b16 a[36:37], v29 offset:0
    ds_read_b64_tr_b16 a[44:45], v29 offset:8
    ds_read_b64_tr_b16 a[52:53], v30 offset:0
    ds_read_b64_tr_b16 a[60:61], v30 offset:8
    ds_read_b64_tr_b16 a[68:69], v31 offset:0
    ds_read_b64_tr_b16 a[76:77], v31 offset:8
    s_waitcnt vmcnt(12) lgkmcnt(0)
    s_barrier
    s_add_u32 m0, s43, 0
    s_add_u32 s41, s58, 262144
    buffer_load_dwordx4 v17, s[8:11], s41 offen offset:0 nt lds
    s_add_u32 s41, s58, 293888
    buffer_load_dwordx4 v17, s[8:11], s41 offen offset:1024 nt lds
    s_add_u32 s41, s58, 391168
    buffer_load_dwordx4 v17, s[8:11], s41 offen offset:2048 nt lds
    s_add_u32 s41, s58, 422912
    buffer_load_dwordx4 v17, s[8:11], s41 offen offset:3072 nt lds
    v_add_u32 v28, 36864, v24
    v_add_u32 v29, 36864, v25
    v_add_u32 v30, 36864, v26
    v_add_u32 v31, 36864, v27
    ds_read_b64_tr_b16 a[22:23], v28 offset:0
    ds_read_b64_tr_b16 a[30:31], v28 offset:8
    ds_read_b64_tr_b16 a[38:39], v29 offset:0
    ds_read_b64_tr_b16 a[46:47], v29 offset:8
    ds_read_b64_tr_b16 a[54:55], v30 offset:0
    ds_read_b64_tr_b16 a[62:63], v30 offset:8
    ds_read_b64_tr_b16 a[70:71], v31 offset:0
    ds_read_b64_tr_b16 a[78:79], v31 offset:8
    s_waitcnt vmcnt(12) lgkmcnt(0)
    s_barrier
    s_add_u32 m0, s43, 36864
    s_add_u32 s41, s58, 278528
    buffer_load_dwordx4 v17, s[8:11], s41 offen offset:0 nt lds
    s_add_u32 s41, s58, 310272
    buffer_load_dwordx4 v17, s[8:11], s41 offen offset:1024 nt lds
    s_add_u32 s41, s58, 407552
    buffer_load_dwordx4 v17, s[8:11], s41 offen offset:2048 nt lds
    s_add_u32 s41, s58, 439296
    buffer_load_dwordx4 v17, s[8:11], s41 offen offset:3072 nt lds
    s_lshl_b32 s26, s12, 14
    s_add_u32 s26, s26, 0
    s_mul_i32 s40, s13, 3072
    s_add_u32 s24, s26, s40
    s_lshl_b32 s96, s12, 7
    s_add_u32 s29, s96, 125845504
    s_add_u32 s96, s96, 125829120
    v_bfe_u32 v78, v65, 2, 5
    buffer_load_dword v54, off, s[84:87], 0 offset:132 sc1
    buffer_load_dword v55, off, s[84:87], 0 offset:216 sc1
    buffer_load_dword v56, v78, s[4:7], s96 offen offset:16 sc1
    v_add_u32 v77, 73728, v20
    ds_read_b64_tr_b16 a[80:81], v77 offset:0
    ds_read_b64_tr_b16 a[82:83], v77 offset:4096
    ds_read_b64_tr_b16 a[84:85], v77 offset:8192
    ds_read_b64_tr_b16 a[86:87], v77 offset:12288
    ds_read_b64_tr_b16 a[88:89], v77 offset:8
    ds_read_b64_tr_b16 a[90:91], v77 offset:4104
    ds_read_b64_tr_b16 a[92:93], v77 offset:8200
    ds_read_b64_tr_b16 a[94:95], v77 offset:12296
    s_waitcnt vmcnt(12) lgkmcnt(0)
    s_barrier
    s_add_u32 m0, s43, 73728
    s_add_u32 s41, s58, 524288
    buffer_load_dwordx4 v17, s[8:11], s41 offen offset:0 nt lds
    s_add_u32 s41, s58, 556032
    buffer_load_dwordx4 v17, s[8:11], s41 offen offset:1024 nt lds
    s_add_u32 s41, s58, 653312
    buffer_load_dwordx4 v17, s[8:11], s41 offen offset:2048 nt lds
    s_add_u32 s41, s58, 685056
    buffer_load_dwordx4 v17, s[8:11], s41 offen offset:3072 nt lds
    v_add_u32 v28, 110592, v24
    v_add_u32 v29, 110592, v25
    v_add_u32 v30, 110592, v26
    v_add_u32 v31, 110592, v27
    ds_read_b64_tr_b16 a[232:233], v28 offset:0
    ds_read_b64_tr_b16 v[32:33], v28 offset:8
    ds_read_b64_tr_b16 a[240:241], v29 offset:0
    ds_read_b64_tr_b16 a[248:249], v29 offset:8
    ds_read_b64_tr_b16 v[144:145], v30 offset:0
    ds_read_b64_tr_b16 v[152:153], v30 offset:8
    ds_read_b64_tr_b16 v[160:161], v31 offset:0
    ds_read_b64_tr_b16 v[168:169], v31 offset:8
    s_waitcnt vmcnt(12) lgkmcnt(0)
    s_barrier
    s_add_u32 m0, s43, 110592
    s_add_u32 s41, s58, 540672
    buffer_load_dwordx4 v17, s[8:11], s41 offen offset:0 nt lds
    s_add_u32 s41, s58, 572416
    buffer_load_dwordx4 v17, s[8:11], s41 offen offset:1024 nt lds
    s_add_u32 s41, s58, 669696
    buffer_load_dwordx4 v17, s[8:11], s41 offen offset:2048 nt lds
    s_add_u32 s41, s58, 701440
    buffer_load_dwordx4 v17, s[8:11], s41 offen offset:3072 nt lds
    ds_write_b64 v70, v[32:33] offset:8192
    v_add_u32 v28, 147456, v24
    v_add_u32 v29, 147456, v25
    v_add_u32 v30, 147456, v26
    v_add_u32 v31, 147456, v27
    ds_read_b64_tr_b16 a[234:235], v28 offset:0
    ds_read_b64_tr_b16 v[0:1], v28 offset:8
    ds_read_b64_tr_b16 a[242:243], v29 offset:0
    ds_read_b64_tr_b16 a[250:251], v29 offset:8
    ds_read_b64_tr_b16 v[146:147], v30 offset:0
    ds_read_b64_tr_b16 v[154:155], v30 offset:8
    ds_read_b64_tr_b16 v[162:163], v31 offset:0
    ds_read_b64_tr_b16 v[170:171], v31 offset:8
    s_waitcnt vmcnt(12) lgkmcnt(0)
    s_barrier
    s_add_u32 m0, s43, 147456
    s_add_u32 s41, s58, 786432
    buffer_load_dwordx4 v17, s[8:11], s41 offen offset:0 nt lds
    s_add_u32 s41, s58, 818176
    buffer_load_dwordx4 v17, s[8:11], s41 offen offset:1024 nt lds
    s_add_u32 s41, s58, 915456
    buffer_load_dwordx4 v17, s[8:11], s41 offen offset:2048 nt lds
    s_add_u32 s41, s58, 947200
    buffer_load_dwordx4 v17, s[8:11], s41 offen offset:3072 nt lds
    ds_write_b64 v70, v[0:1] offset:8200
    v_add_u32 v28, 0, v24
    v_add_u32 v29, 0, v25
    v_add_u32 v30, 0, v26
    v_add_u32 v31, 0, v27
    ds_read_b64_tr_b16 a[236:237], v28 offset:0
    ds_read_b64_tr_b16 v[32:33], v28 offset:8
    ds_read_b64_tr_b16 a[244:245], v29 offset:0
    ds_read_b64_tr_b16 a[252:253], v29 offset:8
    ds_read_b64_tr_b16 v[148:149], v30 offset:0
    ds_read_b64_tr_b16 v[156:157], v30 offset:8
    ds_read_b64_tr_b16 v[164:165], v31 offset:0
    ds_read_b64_tr_b16 v[172:173], v31 offset:8
    s_waitcnt vmcnt(12) lgkmcnt(0)
    s_barrier
    s_add_u32 m0, s43, 0
    s_add_u32 s41, s58, 802816
    buffer_load_dwordx4 v17, s[8:11], s41 offen offset:0 nt lds
    s_add_u32 s41, s58, 834560
    buffer_load_dwordx4 v17, s[8:11], s41 offen offset:1024 nt lds
    s_add_u32 s41, s58, 931840
    buffer_load_dwordx4 v17, s[8:11], s41 offen offset:2048 nt lds
    s_add_u32 s41, s58, 963584
    buffer_load_dwordx4 v17, s[8:11], s41 offen offset:3072 nt lds
    ds_write_b64 v70, v[32:33] offset:9216
    v_add_u32 v28, 36864, v24
    v_add_u32 v29, 36864, v25
    v_add_u32 v30, 36864, v26
    v_add_u32 v31, 36864, v27
    ds_read_b64_tr_b16 a[238:239], v28 offset:0
    ds_read_b64_tr_b16 v[0:1], v28 offset:8
    ds_read_b64_tr_b16 a[246:247], v29 offset:0
    ds_read_b64_tr_b16 a[254:255], v29 offset:8
    ds_read_b64_tr_b16 v[150:151], v30 offset:0
    ds_read_b64_tr_b16 v[158:159], v30 offset:8
    ds_read_b64_tr_b16 v[166:167], v31 offset:0
    ds_read_b64_tr_b16 v[174:175], v31 offset:8
    s_waitcnt vmcnt(12) lgkmcnt(0)
    s_barrier
    s_add_u32 m0, s43, 36864
    s_add_u32 s41, s59, 0
    buffer_load_dwordx4 v17, s[8:11], s41 offen offset:0 nt lds
    s_add_u32 s41, s59, 31744
    buffer_load_dwordx4 v17, s[8:11], s41 offen offset:1024 nt lds
    s_add_u32 s41, s59, 129024
    buffer_load_dwordx4 v17, s[8:11], s41 offen offset:2048 nt lds
    s_add_u32 s41, s59, 160768
    buffer_load_dwordx4 v17, s[8:11], s41 offen offset:3072 nt lds
    v_readfirstlane_b32 s94, v54
    v_readfirstlane_b32 s95, v55
    v_mov_b32 v77, v56
    s_nop 0
    v_subrev_u32 v77, s95, v77
    v_cmp_lt_u32 vcc, 16, v77
    s_nop 1
    v_cndmask_b32 v77, v77, 0, vcc
    v_bfe_u32 v79, v78, 2, 2
    v_lshl_add_u32 v77, v77, 2, v79
    s_nop 1
    v_min_u32_dpp v77, v77, v77 row_ror:1 row_mask:0xf bank_mask:0xf
    s_nop 1
    v_min_u32_dpp v77, v77, v77 row_ror:2 row_mask:0xf bank_mask:0xf
    s_nop 1
    v_min_u32_dpp v77, v77, v77 row_ror:4 row_mask:0xf bank_mask:0xf
    s_nop 0
    v_readfirstlane_b32 s97, v77
    s_cmp_eq_u32 s95, 0
    s_cselect_b32 s97, 0, s97
    s_cmp_lt_u32 s97, 3
    s_cbranch_scc1 cf_mb
    s_add_u32 s40, s24, 0
    s_add_u32 s40, s40, s33
    s_sub_u32 s41, s96, s40
    v_bfe_u32 v77, v65, 2, 5
    v_add3_u32 v77, v77, s41, 16
    v_lshlrev_b32 v78, 3, v69
    s_nop 0
    v_mov_b32_dpp v78, v77 quad_perm:[0,1,2,3] row_mask:0xc bank_mask:0xf
    buffer_load_dword v58, v78, s[4:7], s40 offen sc1
    s_add_u32 s40, s24, 524288
    s_add_u32 s40, s40, s33
    s_sub_u32 s41, s96, s40
    v_bfe_u32 v77, v65, 2, 5
    v_add3_u32 v77, v77, s41, 16
    v_lshlrev_b32 v78, 3, v69
    s_nop 0
    v_mov_b32_dpp v78, v77 quad_perm:[0,1,2,3] row_mask:0xc bank_mask:0xf
    buffer_load_dword v58, v78, s[4:7], s40 offen sc1
cf_mb:
    s_cmp_lt_u32 s94, 32
    s_cbranch_scc1 cf_mc
    s_cmp_lg_u32 s13, 0
    s_cbranch_scc1 cf_mc
    v_mov_b32 v76, 1
    v_mov_b32 v77, 0
    s_mov_b64 exec, 1
    buffer_atomic_cmpswap v[76:77], off, s[84:87], 0 offset:28 sc0
    s_mov_b64 exec, -1
cf_mc:
    s_nop 1
    ds_write_b64 v70, v[0:1] offset:9224
    v_add_u32 v28, 73728, v24
    v_add_u32 v29, 73728, v25
    v_add_u32 v30, 73728, v26
    v_add_u32 v31, 73728, v27
    ds_read_b64_tr_b16 v[176:177], v28 offset:0
    ds_read_b64_tr_b16 v[184:185], v28 offset:8
    ds_read_b64_tr_b16 v[192:193], v29 offset:0
    ds_read_b64_tr_b16 v[200:201], v29 offset:8
    ds_read_b64_tr_b16 v[208:209], v30 offset:0
    ds_read_b64_tr_b16 v[216:217], v30 offset:8
    ds_read_b64_tr_b16 v[224:225], v31 offset:0
    ds_read_b64_tr_b16 v[232:233], v31 offset:8
    s_waitcnt vmcnt(12) lgkmcnt(0)
    s_barrier
    s_mov_b64 s[8:9], s[56:57]
    s_add_u32 m0, s43, 73728
    s_add_u32 s41, s60, 128
    buffer_load_dwordx4 v18, s[8:11], s41 offen offset:0 nt lds
    s_add_u32 s41, s60, 8320
    buffer_load_dwordx4 v18, s[8:11], s41 offen offset:1024 nt lds
    s_add_u32 s41, s60, 16512
    buffer_load_dwordx4 v18, s[8:11], s41 offen offset:2048 nt lds
    s_add_u32 s41, s60, 24704
    buffer_load_dwordx4 v18, s[8:11], s41 offen offset:3072 nt lds
    v_add_u32 v28, 110592, v24
    v_add_u32 v29, 110592, v25
    v_add_u32 v30, 110592, v26
    v_add_u32 v31, 110592, v27
    ds_read_b64_tr_b16 v[178:179], v28 offset:0
    ds_read_b64_tr_b16 v[186:187], v28 offset:8
    ds_read_b64_tr_b16 v[194:195], v29 offset:0
    ds_read_b64_tr_b16 v[202:203], v29 offset:8
    ds_read_b64_tr_b16 v[210:211], v30 offset:0
    ds_read_b64_tr_b16 v[218:219], v30 offset:8
    ds_read_b64_tr_b16 v[226:227], v31 offset:0
    ds_read_b64_tr_b16 v[234:235], v31 offset:8
    s_waitcnt vmcnt(12) lgkmcnt(0)
    s_barrier
    s_add_u32 m0, s43, 110592
    s_add_u32 s41, s61, 128
    buffer_load_dwordx4 v18, s[8:11], s41 offen offset:0 nt lds
    s_add_u32 s41, s61, 8320
    buffer_load_dwordx4 v18, s[8:11], s41 offen offset:1024 nt lds
    s_add_u32 s41, s61, 16512
    buffer_load_dwordx4 v18, s[8:11], s41 offen offset:2048 nt lds
    s_add_u32 s41, s61, 24704
    buffer_load_dwordx4 v18, s[8:11], s41 offen offset:3072 nt lds
    v_add_u32 v28, 147456, v24
    v_add_u32 v29, 147456, v25
    v_add_u32 v30, 147456, v26
    v_add_u32 v31, 147456, v27
    ds_read_b64_tr_b16 v[180:181], v28 offset:0
    ds_read_b64_tr_b16 v[188:189], v28 offset:8
    ds_read_b64_tr_b16 v[196:197], v29 offset:0
    ds_read_b64_tr_b16 v[204:205], v29 offset:8
    ds_read_b64_tr_b16 v[212:213], v30 offset:0
    ds_read_b64_tr_b16 v[220:221], v30 offset:8
    ds_read_b64_tr_b16 v[228:229], v31 offset:0
    ds_read_b64_tr_b16 v[236:237], v31 offset:8
    s_waitcnt vmcnt(12) lgkmcnt(0)
    s_barrier
    s_add_u32 m0, s43, 147456
    s_add_u32 s41, s62, 128
    buffer_load_dwordx4 v18, s[8:11], s41 offen offset:0 nt lds
    s_add_u32 s41, s62, 8320
    buffer_load_dwordx4 v18, s[8:11], s41 offen offset:1024 nt lds
    s_add_u32 s41, s62, 16512
    buffer_load_dwordx4 v18, s[8:11], s41 offen offset:2048 nt lds
    s_add_u32 s41, s62, 24704
    buffer_load_dwordx4 v18, s[8:11], s41 offen offset:3072 nt lds
    v_add_u32 v28, 0, v24
    v_add_u32 v29, 0, v25
    v_add_u32 v30, 0, v26
    v_add_u32 v31, 0, v27
    ds_read_b64_tr_b16 v[182:183], v28 offset:0
    ds_read_b64_tr_b16 v[190:191], v28 offset:8
    ds_read_b64_tr_b16 v[198:199], v29 offset:0
    ds_read_b64_tr_b16 v[206:207], v29 offset:8
    ds_read_b64_tr_b16 v[214:215], v30 offset:0
    ds_read_b64_tr_b16 v[222:223], v30 offset:8
    ds_read_b64_tr_b16 v[230:231], v31 offset:0
    ds_read_b64_tr_b16 v[238:239], v31 offset:8
    s_waitcnt vmcnt(12) lgkmcnt(0)
    s_barrier
    s_add_u32 m0, s43, 0
    s_add_u32 s41, s63, 128
    buffer_load_dwordx4 v18, s[8:11], s41 offen offset:0 nt lds
    s_add_u32 s41, s63, 8320
    buffer_load_dwordx4 v18, s[8:11], s41 offen offset:1024 nt lds
    s_add_u32 s41, s63, 16512
    buffer_load_dwordx4 v18, s[8:11], s41 offen offset:2048 nt lds
    s_add_u32 s41, s63, 24704
    buffer_load_dwordx4 v18, s[8:11], s41 offen offset:3072 nt lds
    v_mov_b32 v78, v21
    v_mov_b32 v79, v22
    v_add_u32 v77, 36864, v20
    ds_read_b64_tr_b16 v[240:241], v77 offset:0
    ds_read_b64_tr_b16 v[242:243], v77 offset:4096
    ds_read_b64_tr_b16 v[244:245], v77 offset:8192
    ds_read_b64_tr_b16 v[246:247], v77 offset:12288
    ds_read_b64_tr_b16 v[248:249], v77 offset:8
    ds_read_b64_tr_b16 v[250:251], v77 offset:4104
    ds_read_b64_tr_b16 v[252:253], v77 offset:8200
    ds_read_b64_tr_b16 v[254:255], v77 offset:12296
    s_waitcnt vmcnt(12) lgkmcnt(0)
    s_barrier
    v_add_u32 v77, 73728, v79
    s_waitcnt lgkmcnt(0)
    ds_read_b64_tr_b16 v[0:1], v77 offset:0
    ds_read_b64_tr_b16 v[2:3], v77 offset:256
    ds_read_b64_tr_b16 v[4:5], v77 offset:2048
    ds_read_b64_tr_b16 v[6:7], v77 offset:2304
    ds_read_b64_tr_b16 v[8:9], v77 offset:16
    ds_read_b64_tr_b16 v[10:11], v77 offset:272
    ds_read_b64_tr_b16 v[12:13], v77 offset:2064
    ds_read_b64_tr_b16 v[14:15], v77 offset:2320
    s_waitcnt vmcnt(8) lgkmcnt(0)
    s_barrier
    v_add_u32 v77, 110592, v78
    ds_read_b64_tr_b16 v[16:17], v77 offset:0
    ds_read_b64_tr_b16 v[18:19], v77 offset:256
    ds_read_b64_tr_b16 v[20:21], v77 offset:2048
    ds_read_b64_tr_b16 v[22:23], v77 offset:2304
    ds_read_b64_tr_b16 v[24:25], v77 offset:16
    ds_read_b64_tr_b16 v[26:27], v77 offset:272
    ds_read_b64_tr_b16 v[28:29], v77 offset:2064
    ds_read_b64_tr_b16 v[30:31], v77 offset:2320
    s_waitcnt vmcnt(4) lgkmcnt(0)
    s_barrier
    v_add_u32 v77, 147456, v78
    ds_read_b64_tr_b16 v[32:33], v77 offset:0
    ds_read_b64_tr_b16 v[34:35], v77 offset:256
    ds_read_b64_tr_b16 v[36:37], v77 offset:2048
    ds_read_b64_tr_b16 v[38:39], v77 offset:2304
    ds_read_b64_tr_b16 v[40:41], v77 offset:16
    ds_read_b64_tr_b16 v[42:43], v77 offset:272
    ds_read_b64_tr_b16 v[44:45], v77 offset:2064
    ds_read_b64_tr_b16 v[46:47], v77 offset:2320
    s_waitcnt vmcnt(0) lgkmcnt(0)
    s_barrier
    v_add_u32 v77, 0, v78
    ds_read_b64_tr_b16 v[48:49], v77 offset:0
    ds_read_b64_tr_b16 v[50:51], v77 offset:256
    ds_read_b64_tr_b16 v[52:53], v77 offset:2048
    ds_read_b64_tr_b16 v[54:55], v77 offset:2304
    ds_read_b64_tr_b16 v[56:57], v77 offset:16
    ds_read_b64_tr_b16 v[58:59], v77 offset:272
    ds_read_b64_tr_b16 v[60:61], v77 offset:2064
    ds_read_b64_tr_b16 v[62:63], v77 offset:2320
    s_waitcnt lgkmcnt(0)
    s_barrier
    ds_write_b128 v70, v[0:3] offset:20480
    ds_write_b128 v70, v[4:7] offset:21504
    ds_write_b128 v70, v[8:11] offset:22528
    ds_write_b128 v70, v[12:15] offset:23552
    ds_write_b128 v70, v[16:19] offset:24576
    ds_write_b128 v70, v[20:23] offset:25600
    ds_write_b128 v70, v[24:27] offset:26624
    ds_write_b128 v70, v[28:31] offset:27648
    ds_write_b128 v70, v[32:35] offset:28672
    ds_write_b128 v70, v[36:39] offset:29696
    ds_write_b128 v70, v[40:43] offset:30720
    ds_write_b128 v70, v[44:47] offset:31744
    ds_write_b128 v70, v[48:51] offset:32768
    ds_write_b128 v70, v[52:55] offset:33792
    ds_write_b128 v70, v[56:59] offset:34816
    ds_write_b128 v70, v[60:63] offset:35840
    s_waitcnt lgkmcnt(0)
    v_bfe_u32 v60, v65, 4, 6
    v_and_b32 v61, 15, v60
    v_lshrrev_b32 v62, 4, v60
    v_mov_b32 v50, 0x3f80
    v_mov_b32 v51, 0x3f800000
    v_and_b32 v77, 1, v62
    v_lshlrev_b32 v77, 2, v77
    v_sub_u32 v77, v61, v77
    v_and_b32 v78, 3, v61
    v_lshlrev_b32 v78, 2, v78
    v_lshrrev_b32 v79, 2, v61
    v_add_u32 v78, v78, v79
    v_cmp_eq_u32 vcc, 0, v77
    s_nop 1
    v_cndmask_b32 v8, 0, v50, vcc
    v_cmp_eq_u32 vcc, 1, v77
    s_nop 1
    v_cndmask_b32 v8, v8, v51, vcc
    v_cmp_eq_u32 vcc, 0, v78
    s_nop 1
    v_cndmask_b32 v12, 0, v50, vcc
    v_cmp_eq_u32 vcc, 1, v78
    s_nop 1
    v_cndmask_b32 v12, v12, v51, vcc
    v_cmp_eq_u32 vcc, 2, v77
    s_nop 1
    v_cndmask_b32 v9, 0, v50, vcc
    v_cmp_eq_u32 vcc, 3, v77
    s_nop 1
    v_cndmask_b32 v9, v9, v51, vcc
    v_cmp_eq_u32 vcc, 2, v78
    s_nop 1
    v_cndmask_b32 v13, 0, v50, vcc
    v_cmp_eq_u32 vcc, 3, v78
    s_nop 1
    v_cndmask_b32 v13, v13, v51, vcc
    v_cmp_eq_u32 vcc, 8, v77
    s_nop 1
    v_cndmask_b32 v10, 0, v50, vcc
    v_cmp_eq_u32 vcc, 9, v77
    s_nop 1
    v_cndmask_b32 v10, v10, v51, vcc
    v_cmp_eq_u32 vcc, 4, v78
    s_nop 1
    v_cndmask_b32 v14, 0, v50, vcc
    v_cmp_eq_u32 vcc, 5, v78
    s_nop 1
    v_cndmask_b32 v14, v14, v51, vcc
    v_cmp_eq_u32 vcc, 10, v77
    s_nop 1
    v_cndmask_b32 v11, 0, v50, vcc
    v_cmp_eq_u32 vcc, 11, v77
    s_nop 1
    v_cndmask_b32 v11, v11, v51, vcc
    v_cmp_eq_u32 vcc, 6, v78
    s_nop 1
    v_cndmask_b32 v15, 0, v50, vcc
    v_cmp_eq_u32 vcc, 7, v78
    s_nop 1
    v_cndmask_b32 v15, v15, v51, vcc
    v_lshlrev_b32 v77, 4, v61
    ds_write_b128 v69, v[8:11] offset:15360
    ds_write_b128 v77, v[12:15] offset:15872
    s_waitcnt vmcnt(0) lgkmcnt(0)
    s_cmp_lg_u32 s95, 0
    s_cbranch_scc1 cf_hn
    s_mov_b32 s88, 4194304
gn2:
    buffer_load_dword v2, off, s[84:87], 0 offset:216 sc1
    s_waitcnt vmcnt(0)
    v_readfirstlane_b32 s95, v2
    s_sub_u32 s88, s88, 1
    s_cbranch_scc1 gn2x
    s_cmp_eq_u32 s95, 0
    s_cbranch_scc1 gn2
gn2x:
cf_hn:
    v_mov_b32 v2, 1
    s_cmp_lg_u32 s13, 0
    s_cbranch_scc1 cf_noarr
    s_mov_b64 exec, 1
    s_mov_b32 s42, 1
    v_mov_b32 v4, v76
    s_cmp_ge_u32 s94, 32
    s_cbranch_scc1 cf_have
    s_mov_b32 s40, 131072
    s_mov_b32 s42, 2
cf_startpoll:
    buffer_load_dword v3, off, s[84:87], 0 offset:132 sc1
    s_sub_u32 s40, s40, 1
    s_cbranch_scc1 cf_decide
    s_waitcnt vmcnt(0)
    v_readfirstlane_b32 s41, v3
    s_nop 1
    s_cmp_lt_u32 s41, 32
    s_cbranch_scc1 cf_startpoll
    s_mov_b32 s42, 1
cf_decide:
    v_mov_b32 v4, s42
    v_mov_b32 v5, 0
    buffer_atomic_cmpswap v[4:5], off, s[84:87], 0 offset:28 sc0
    s_waitcnt vmcnt(0)
cf_have:
    v_mov_b32 v5, s42
    v_cmp_eq_u32 vcc, 0, v4
    s_nop 1
    v_cndmask_b32 v4, v4, v5, vcc
    v_mov_b32 v5, 16192
    ds_write_b32 v5, v4
    s_waitcnt lgkmcnt(0)
    s_mov_b64 exec, -1
cf_noarr:
    s_barrier
    v_mov_b32 v5, 16192
    ds_read_b32 v4, v5
    s_waitcnt lgkmcnt(0)
    v_readfirstlane_b32 s41, v4
    s_nop 1
    s_cmp_eq_u32 s41, 1
    s_cbranch_scc1 cf_run
    v_lshrrev_b32 v0, 4, v65
    s_mov_b32 s32, s13
    s_load_dwordx16 s[48:63], s[0:1], 0
    s_waitcnt lgkmcnt(0)
    s_branch L_helper
cf_run:
    s_mov_b32 s44, 0x3e0293ee
    s_mov_b32 s45, s44
    s_or_b32 s66, s44, 0x80000000
    s_mov_b32 s48, 0x3f003f00
    s_mov_b32 s49, 0
    s_mov_b32 s50, 0x3f803f80
    s_mov_b32 s51, 0x3f803f80
    s_mov_b32 s52, 512
    s_mov_b32 s53, 1024
    s_mov_b32 s54, 1536
    s_mov_b32 s30, 0
    s_mov_b32 s37, 0
    s_mov_b32 s98, -100
    s_lshl_b32 s47, s13, 9
    s_cmp_lg_u32 s32, 0
    s_cselect_b32 s71, s13, 3
    s_add_u32 s46, s71, 1
    s_lshr_b32 s46, s46, 1
    s_mov_b32 s14, 67125248
    s_mov_b32 s15, 67129344
    s_mov_b32 s16, 67133440
    s_mov_b32 s36, 0
    s_add_u32 s17, s68, 67108864
    s_mov_b32 s69, 0
    s_mov_b32 s70, 0
    s_lshl_b32 s26, s12, 14
    s_add_u32 s26, s26, 0
    s_mul_i32 s40, s13, 3072
    s_add_u32 s24, s26, s40
    s_lshl_b32 s96, s12, 7
    s_add_u32 s29, s96, 125845504
    s_add_u32 s96, s96, 125829120
    s_lshl_b32 s40, s12, 14
    s_add_u32 s40, s40, 68157440
    s_add_u32 s18, s40, 0
    s_add_u32 s19, s40, 4096
    s_add_u32 s20, s40, 8192
    s_add_u32 s21, s40, 12288
    s_lshr_b32 s40, s12, 3
    s_lshl_b32 s40, s40, 12
    s_and_b32 s41, s12, 7
    s_lshl_b32 s41, s41, 7
    s_add_u32 s40, s40, s41
    s_add_u32 s22, s40, 68157440
    s_add_u32 s23, s22, 1024
    s_add_u32 s25, s22, 2048
    s_mov_b32 s56, -65472
    s_cmp_lg_u32 s32, 0
    s_cselect_b64 s[38:39], -1, 0
    s_add_u32 s55, s68, 138412032
    s_cmp_eq_u32 s13, 3
    s_cselect_b64 s[100:101], 1, 0
    s_cselect_b64 s[38:39], 1, s[38:39]
    s_cselect_b32 s93, 64, 0
    s_cselect_b32 s55, s29, s55
    s_cselect_b32 s57, 0, 9216
    s_mov_b64 exec, s[100:101]
    v_mov_b32 v72, s95
    s_mov_b64 exec, -1
    s_mov_b32 s34, 0xff00ff00
    s_mov_b32 s35, 0xff00ff00
    s_lshl_b32 s28, s12, 12
    s_add_u32 s28, s28, 7340032
    s_add_u32 s27, s28, 77594624
    s_add_u32 s28, s28, 69206016
    s_cmp_ge_u32 s97, 3
    s_cbranch_scc1 cf_kvdone
    s_mov_b32 s40, 3
    v_bfe_u32 v78, v65, 2, 5
    s_mov_b32 s31, 4194304
cf_kv0:
    buffer_load_dword v77, v78, s[4:7], s96 offen offset:16 sc1
    s_waitcnt vmcnt(0)
    v_subrev_u32 v77, s95, v77
    v_cmp_lt_u32 vcc, 16, v77
    s_nop 1
    v_cndmask_b32 v77, v77, 0, vcc
    v_bfe_u32 v79, v78, 2, 2
    v_lshl_add_u32 v77, v77, 2, v79
    s_nop 1
    v_min_u32_dpp v77, v77, v77 row_ror:1 row_mask:0xf bank_mask:0xf
    s_nop 1
    v_min_u32_dpp v77, v77, v77 row_ror:2 row_mask:0xf bank_mask:0xf
    s_nop 1
    v_min_u32_dpp v77, v77, v77 row_ror:4 row_mask:0xf bank_mask:0xf
    s_nop 0
    v_readfirstlane_b32 s97, v77
    s_sub_u32 s31, s31, 1
    s_cbranch_scc1 cf_kv0_x
    s_cmp_le_u32 s40, s97
    s_cbranch_scc1 cf_kv0_x
    s_sleep 2
    s_branch cf_kv0
cf_kv0_x:
    s_add_u32 s40, s24, 0
    s_add_u32 s40, s40, s33
    s_sub_u32 s41, s96, s40
    v_bfe_u32 v77, v65, 2, 5
    v_add3_u32 v77, v77, s41, 16
    v_lshlrev_b32 v78, 3, v69
    s_nop 0
    v_mov_b32_dpp v78, v77 quad_perm:[0,1,2,3] row_mask:0xc bank_mask:0xf
    buffer_load_dword v76, v78, s[4:7], s40 offen sc1
    s_add_u32 s40, s24, 524288
    s_add_u32 s40, s40, s33
    s_sub_u32 s41, s96, s40
    v_bfe_u32 v77, v65, 2, 5
    v_add3_u32 v77, v77, s41, 16
    v_lshlrev_b32 v78, 3, v69
    s_nop 0
    v_mov_b32_dpp v78, v77 quad_perm:[0,1,2,3] row_mask:0xc bank_mask:0xf
    buffer_load_dword v76, v78, s[4:7], s40 offen sc1
cf_kvdone:
    v_mov_b64 v[0:1], 0
    v_mov_b64 v[2:3], 0
    v_mov_b64 v[4:5], 0
    v_mov_b64 v[6:7], 0
    v_mov_b64 v[8:9], 0
    v_mov_b64 v[10:11], 0
    v_mov_b64 v[12:13], 0
    v_mov_b64 v[14:15], 0
    v_mov_b64 v[16:17], 0
    v_mov_b64 v[18:19], 0
    v_mov_b64 v[20:21], 0
    v_mov_b64 v[22:23], 0
    ds_read_b128 v[44:47], v70 offset:0
    ds_read_b128 v[48:51], v70 offset:1024
    ds_read_b128 v[52:55], v70 offset:2048
    ds_read_b128 v[56:59], v70 offset:3072
    ds_read_b128 v[24:27], v70 offset:4096
    ds_read_b128 v[28:31], v70 offset:5120
    ds_read_b128 v[32:35], v70 offset:6144
    ds_read_b128 v[36:39], v70 offset:7168
    buffer_load_dwordx4 v[40:43], v65, s[4:7], s14 offen offset:0 nt
    buffer_load_dwordx4 v[60:63], v66, s[4:7], s14 offen offset:0 nt
    s_mov_b32 s31, 1048576
    s_waitcnt vmcnt(0) lgkmcnt(0)
    s_branch cf_goA
cf_loop:
    s_mov_b32 s31, 1048576
    s_mov_b32 s69, s70
    s_waitcnt lgkmcnt(0)
cf_cA:
    buffer_load_dwordx4 v[40:43], v65, s[4:7], s14 offen offset:0 nt
    buffer_load_dwordx4 v[60:63], v66, s[4:7], s14 offen offset:0 nt
cf_cA1:
    v_bitop3_b32 v77, v40, v60, s70 bitop3:0x7e
    v_and_b32 v77, 1, v77
    v_cmp_ne_u32 vcc, 0, v77
    s_cbranch_vccz cf_goA
    v_bitop3_b32 v77, v40, v60, s70 bitop3:0x7e
    v_and_b32 v77, 1, v77
    v_cmp_ne_u32 vcc, 0, v77
    s_cbranch_vccz cf_goA
    v_bitop3_b32 v77, v40, v60, s70 bitop3:0x7e
    v_and_b32 v77, 1, v77
    v_cmp_ne_u32 vcc, 0, v77
    s_cbranch_vccz cf_goA
    v_bitop3_b32 v77, v40, v60, s70 bitop3:0x7e
    v_and_b32 v77, 1, v77
    v_cmp_ne_u32 vcc, 0, v77
    s_cbranch_vccz cf_goA
    buffer_load_dwordx4 v[40:43], v65, s[4:7], s14 offen offset:0 nt
    buffer_load_dwordx4 v[60:63], v66, s[4:7], s14 offen offset:0 nt
    v_bitop3_b32 v77, v40, v60, s70 bitop3:0x7e
    v_and_b32 v77, 1, v77
    v_cmp_ne_u32 vcc, 0, v77
    s_cbranch_vccz cf_goA
    v_bitop3_b32 v77, v40, v60, s70 bitop3:0x7e
    v_and_b32 v77, 1, v77
    v_cmp_ne_u32 vcc, 0, v77
    s_cbranch_vccz cf_goA
    v_bitop3_b32 v77, v40, v60, s70 bitop3:0x7e
    v_and_b32 v77, 1, v77
    v_cmp_ne_u32 vcc, 0, v77
    s_cbranch_vccz cf_goA
    v_bitop3_b32 v77, v40, v60, s70 bitop3:0x7e
    v_and_b32 v77, 1, v77
    v_cmp_ne_u32 vcc, 0, v77
    s_cbranch_vccz cf_goA
    buffer_load_dwordx4 v[40:43], v65, s[4:7], s14 offen offset:0 nt
    buffer_load_dwordx4 v[60:63], v66, s[4:7], s14 offen offset:0 nt
    v_bitop3_b32 v77, v40, v60, s70 bitop3:0x7e
    v_and_b32 v77, 1, v77
    v_cmp_ne_u32 vcc, 0, v77
    s_cbranch_vccz cf_goA
    v_bitop3_b32 v77, v40, v60, s70 bitop3:0x7e
    v_and_b32 v77, 1, v77
    v_cmp_ne_u32 vcc, 0, v77
    s_cbranch_vccz cf_goA
    v_bitop3_b32 v77, v40, v60, s70 bitop3:0x7e
    v_and_b32 v77, 1, v77
    v_cmp_ne_u32 vcc, 0, v77
    s_cbranch_vccz cf_goA
    v_bitop3_b32 v77, v40, v60, s70 bitop3:0x7e
    v_and_b32 v77, 1, v77
    v_cmp_ne_u32 vcc, 0, v77
    s_cbranch_vccz cf_goA
    buffer_load_dwordx4 v[40:43], v65, s[4:7], s14 offen offset:0 nt
    buffer_load_dwordx4 v[60:63], v66, s[4:7], s14 offen offset:0 nt
    v_bitop3_b32 v77, v40, v60, s70 bitop3:0x7e
    v_and_b32 v77, 1, v77
    v_cmp_ne_u32 vcc, 0, v77
    s_cbranch_vccz cf_goA
    v_bitop3_b32 v77, v40, v60, s70 bitop3:0x7e
    v_and_b32 v77, 1, v77
    v_cmp_ne_u32 vcc, 0, v77
    s_cbranch_vccz cf_goA
    v_bitop3_b32 v77, v40, v60, s70 bitop3:0x7e
    v_and_b32 v77, 1, v77
    v_cmp_ne_u32 vcc, 0, v77
    s_cbranch_vccz cf_goA
    v_bitop3_b32 v77, v40, v60, s70 bitop3:0x7e
    v_and_b32 v77, 1, v77
    v_cmp_ne_u32 vcc, 0, v77
    s_cbranch_vccz cf_goA
    s_sub_u32 s31, s31, 64
    s_cbranch_scc0 cf_cA
cf_goA:
    ds_write_b128 v65, v[40:43] offset:0
    v_smfmac_f32_16x16x64_bf16 v[0:3], v[40:43], v[44:51], v64
    v_smfmac_f32_16x16x64_bf16 v[4:7], v[40:43], v[52:59], v64
    buffer_load_dwordx4 v[44:47], v65, s[4:7], s15 offen offset:0 nt
    v_smfmac_f32_16x16x64_bf16 v[0:3], v[60:63], v[24:31], v64
    s_add_u32 s40, s24, 1048576
    s_add_u32 s40, s40, s33
    s_sub_u32 s41, s96, s40
    v_smfmac_f32_16x16x64_bf16 v[4:7], v[60:63], v[32:39], v64
    ds_read_b128 v[24:27], v70 offset:8192
    s_cmp_lt_u32 s97, s93
    s_cselect_b32 s41, s41, 0
    v_smfmac_f32_16x16x64_bf16 v[8:11], v[40:43], a[96:103], v64
    ds_read_b128 v[28:31], v70 offset:9216
    v_smfmac_f32_16x16x64_bf16 v[12:15], v[40:43], a[104:111], v64
    ds_read_b128 v[32:35], v70 offset:10240
    s_waitcnt lgkmcnt(3)
    s_barrier
    ds_read_b128 v[48:51], v67 offset:0
    v_smfmac_f32_16x16x64_bf16 v[8:11], v[60:63], a[112:119], v64
    ds_read_b128 v[36:39], v70 offset:11264
    v_bitop3_b32 v79, v73, -9, s54 bitop3:0x6a
    v_smfmac_f32_16x16x64_bf16 v[12:15], v[60:63], a[120:127], v64
    buffer_load_dwordx4 v[44:47], v65, s[4:7], s15 offen offset:0 nt
    v_smfmac_f32_16x16x64_bf16 v[16:19], v[40:43], a[232:239], v64
    ds_read_b128 v[52:55], v68 offset:0
    s_waitcnt lgkmcnt(4)
    v_bfe_u32 v77, v65, 2, 5
    v_smfmac_f32_16x16x64_bf16 v[20:23], v[40:43], v[24:31], v64
    ds_read_b128 v[24:27], v70 offset:12288
    s_waitcnt lgkmcnt(3)
    v_smfmac_f32_16x16x64_bf16 v[0:3], v[48:51], a[0:7], v64
    ds_read_b128 v[28:31], v70 offset:13312
    s_waitcnt lgkmcnt(3)
    v_add3_u32 v77, v77, s41, 16
    v_smfmac_f32_16x16x64_bf16 v[4:7], v[48:51], v[32:39], v64
    buffer_load_dwordx4 v[40:43], v65, s[4:7], s16 offen offset:0 nt
    v_smfmac_f32_16x16x64_bf16 v[16:19], v[60:63], a[240:247], v64
    ds_read_b128 v[32:35], v70 offset:14336
    v_lshlrev_b32 v78, 3, v69
    v_smfmac_f32_16x16x64_bf16 v[20:23], v[60:63], a[248:255], v64
    ds_read_b128 v[36:39], v70 offset:15360
    v_smfmac_f32_16x16x64_bf16 v[8:11], v[48:51], a[128:135], v64
    s_waitcnt vmcnt(2)
    v_mov_b32_dpp v78, v77 quad_perm:[0,1,2,3] row_mask:0xc bank_mask:0xf
    v_smfmac_f32_16x16x64_bf16 v[12:15], v[48:51], a[136:143], v64
    buffer_load_dwordx4 v[58:61], v65, s[4:7], s24 offen offset:3072 sc1
    s_waitcnt lgkmcnt(2)
    v_and_b32 v77, s36, v44
    v_smfmac_f32_16x16x64_bf16 v[12:15], v[52:55], v[24:31], v64
    ds_write_b128 v65, v[44:47] offset:4096
    v_smfmac_f32_16x16x64_bf16 v[0:3], v[52:55], a[8:15], v64
    v_cmp_ne_u32 vcc, s70, v77
    v_smfmac_f32_16x16x64_bf16 v[8:11], v[52:55], a[144:151], v64
    buffer_load_dwordx4 v[24:27], v65, s[4:7], s24 offen offset:0 sc1
    s_waitcnt lgkmcnt(1)
    v_smfmac_f32_16x16x64_bf16 v[4:7], v[52:55], v[32:39], v64
    s_cbranch_vccnz cf_spinB
cf_backB:
    v_smfmac_f32_16x16x64_bf16 v[16:19], v[44:47], v[176:183], v64
    s_waitcnt lgkmcnt(0)
    s_barrier
    ds_read_b128 v[48:51], v66 offset:4096
    v_smfmac_f32_16x16x64_bf16 v[12:15], v[44:47], a[160:167], v64
    buffer_load_dwordx4 v[28:31], v65, s[4:7], s24 offen offset:1024 sc1
    v_smfmac_f32_16x16x64_bf16 v[0:3], v[44:47], a[16:23], v64
    ds_read_b128 v[52:55], v67 offset:4096
    v_smfmac_f32_16x16x64_bf16 v[8:11], v[44:47], a[152:159], v64
    v_smfmac_f32_16x16x64_bf16 v[4:7], v[44:47], a[24:31], v64
    buffer_load_dwordx4 v[34:37], v65, s[4:7], s24 offen offset:2048 sc1
    s_waitcnt vmcnt(5)
    v_smfmac_f32_16x16x64_bf16 v[20:23], v[44:47], v[184:191], v64
    ds_read_b128 v[44:47], v68 offset:4096
    s_waitcnt lgkmcnt(2)
    v_smfmac_f32_16x16x64_bf16 v[0:3], v[48:51], a[32:39], v64
    v_smfmac_f32_16x16x64_bf16 v[8:11], v[48:51], a[168:175], v64
    buffer_load_dword v76, v78, s[4:7], s40 offen sc1
    v_smfmac_f32_16x16x64_bf16 v[4:7], v[48:51], a[40:47], v64
    s_waitcnt vmcnt(5)
    v_and_b32 v77, s36, v40
    v_smfmac_f32_16x16x64_bf16 v[12:15], v[48:51], a[176:183], v64
    ds_read_b128 v[48:51], v69 offset:15360
    s_waitcnt lgkmcnt(1)
    v_cmp_ne_u32 vcc, s70, v77
    v_smfmac_f32_16x16x64_bf16 v[0:3], v[52:55], a[48:55], v64
    v_smfmac_f32_16x16x64_bf16 v[8:11], v[52:55], a[184:191], v64
    s_cbranch_vccnz cf_spin8
cf_back8:
    v_smfmac_f32_16x16x64_bf16 v[0:3], v[44:47], a[64:71], v64
    v_smfmac_f32_16x16x64_bf16 v[8:11], v[44:47], a[200:207], v64
    v_smfmac_f32_16x16x64_bf16 v[0:3], v[40:43], a[80:87], v64
    s_nop 1
    v_smfmac_f32_16x16x64_bf16 v[8:11], v[40:43], a[216:223], v64
    s_nop 1
    v_lshrrev_b32 v77, 1, v69
    v_smfmac_f32_16x16x64_bf16 v[4:7], v[52:55], a[56:63], v64
    s_nop 1
    v_cvt_pk_bf16_f32 v0, v0, v1
    v_smfmac_f32_16x16x64_bf16 v[12:15], v[52:55], a[192:199], v64
    s_nop 1
    v_cvt_pk_bf16_f32 v1, v2, v3
    v_smfmac_f32_16x16x64_bf16 v[4:7], v[44:47], a[72:79], v64
    s_nop 1
    v_cvt_pk_bf16_f32 v2, v8, v9
    v_smfmac_f32_16x16x64_bf16 v[12:15], v[44:47], a[208:215], v64
    s_nop 1
    v_cvt_pk_bf16_f32 v3, v10, v11
    v_smfmac_f32_16x16x64_bf16 v[4:7], v[40:43], a[88:95], v64
    s_waitcnt lgkmcnt(0)
    s_nop 0
    s_nop 0
    v_smfmac_f32_16x16x64_bf16 v[12:15], v[40:43], a[224:231], v64
    s_nop 2
    v_mfma_f32_16x16x32_bf16 v[8:11], v[0:3], v[48:51], 0
    s_nop 0
    v_cvt_pk_bf16_f32 v4, v4, v5
    v_cvt_pk_bf16_f32 v5, v6, v7
    s_nop 0
    v_cvt_pk_bf16_f32 v6, v12, v13
    v_cvt_pk_bf16_f32 v7, v14, v15
    s_nop 1
    v_mfma_f32_16x16x32_bf16 v[12:15], v[4:7], v[48:51], 0
    ds_read_b128 v[48:51], v66 offset:4096
    v_cvt_pk_bf16_f32 v0, v8, v9
    v_cvt_pk_bf16_f32 v1, v10, v11
    v_smfmac_f32_16x16x64_bf16 v[16:19], v[52:55], v[208:215], v64
    s_waitcnt vmcnt(2)
    s_nop 2
    v_cvt_pk_bf16_f32 v2, v12, v13
    v_cvt_pk_bf16_f32 v3, v14, v15
    s_nop 1
    v_mfma_f32_16x16x32_bf16 v[12:15], v[0:3], v[0:3], 0
    s_nop 1
    v_bitop3_b32 v78, v73, -9, s53 bitop3:0x6a
    v_mfma_f32_16x16x32_bf16 v[4:7], v[24:27], v[0:3], 0
    ds_read_b128 v[24:27], v67 offset:0
    s_nop 1
    v_mfma_f32_16x16x32_bf16 v[8:11], v[28:31], v[0:3], 0
    s_nop 0
    v_mov_b32_dpp v12, v14 row_ror:8 row_mask:0xf bank_mask:0xc
    v_mov_b32_dpp v13, v15 row_ror:8 row_mask:0xf bank_mask:0xc
    v_smfmac_f32_16x16x64_bf16 v[20:23], v[52:55], v[216:223], v64
    ds_write_b64 v71, v[12:13]
    ds_read_b128 v[52:55], v68 offset:0
    s_nop 1
    v_mov_b32_dpp v4, v8 row_ror:8 row_mask:0xf bank_mask:0xc
    v_mov_b32_dpp v5, v9 row_ror:8 row_mask:0xf bank_mask:0xc
    v_mov_b32_dpp v6, v10 row_ror:8 row_mask:0xf bank_mask:0xc
    v_mov_b32_dpp v7, v11 row_ror:8 row_mask:0xf bank_mask:0xc
    v_smfmac_f32_16x16x64_bf16 v[16:19], v[44:47], v[224:231], v64
    ds_write_b128 v65, v[4:7] offset:8192
    v_smfmac_f32_16x16x64_bf16 v[20:23], v[44:47], v[232:239], v64
    s_waitcnt lgkmcnt(3)
    v_smfmac_f32_16x16x64_bf16 v[16:19], v[24:27], v[144:151], v64
    s_waitcnt vmcnt(1)
    v_smfmac_f32_16x16x64_bf16 v[20:23], v[24:27], v[152:159], v64
    s_mov_b64 exec, s[38:39]
    buffer_store_dword v72, v75, s[4:7], s55 offen sc1
    s_mov_b64 exec, -1
    v_smfmac_f32_16x16x64_bf16 v[16:19], v[40:43], v[240:247], v64
    s_cmp_ge_u32 s30, 56
    s_waitcnt lgkmcnt(0)
    s_barrier
    ds_read_b128 v[8:11], v66 offset:8192
    v_smfmac_f32_16x16x64_bf16 v[20:23], v[40:43], v[248:255], v64
    ds_read_b128 v[12:15], v67 offset:8192
    v_smfmac_f32_16x16x64_bf16 v[16:19], v[48:51], v[192:199], v64
    ds_read_b128 v[44:47], v68 offset:8192
    v_smfmac_f32_16x16x64_bf16 v[20:23], v[48:51], v[200:207], v64
    ds_read_b64 v[24:25], v77 offset:14336
    ds_read_b64 v[26:27], v77 offset:14592
    v_smfmac_f32_16x16x64_bf16 v[16:19], v[52:55], v[160:167], v64
    ds_read_b64 v[28:29], v77 offset:14848
    ds_read_b64 v[30:31], v77 offset:15104
    v_bitop3_b32 v77, v73, -9, s52 bitop3:0x6a
    v_smfmac_f32_16x16x64_bf16 v[20:23], v[52:55], v[168:175], v64
    s_cbranch_scc1 cf_rare
cf_rare_x:
    ds_read_b128 v[48:51], v70 offset:22528
    ds_read_b128 v[52:55], v70 offset:23552
    s_waitcnt lgkmcnt(6)
    v_pk_add_f32 v[4:5], v[4:5], v[8:9]
    v_pk_add_f32 v[6:7], v[6:7], v[10:11]
    v_pk_add_f32 v[12:13], v[12:13], v[44:45]
    v_pk_add_f32 v[14:15], v[14:15], v[46:47]
    v_pk_add_f32 v[4:5], v[4:5], v[12:13]
    v_pk_add_f32 v[6:7], v[6:7], v[14:15]
    s_waitcnt lgkmcnt(2)
    v_pk_add_f32 v[24:25], v[24:25], v[26:27]
    v_pk_add_f32 v[28:29], v[28:29], v[30:31]
    v_max3_f32 v8, v4, v5, v6
    v_pk_add_f32 v[24:25], v[24:25], v[28:29]
    v_max_f32 v8, v8, v7
    v_max3_f32 v8, v8, v24, v25
    v_cvt_pk_bf16_f32 v32, v16, v17
    v_cvt_pk_bf16_f32 v38, v18, v19
    v_max_f32_dpp v8, v8, v8 row_ror:8 row_mask:0xf bank_mask:0xf
    v_mov_b32 v9, v8
    v_cvt_pk_bf16_f32 v56, v20, v21
    v_cvt_pk_bf16_f32 v62, v22, v23
    v_permlane32_swap_b32 v8, v9
    v_max_f32 v8, v8, v9
    v_mov_b32 v9, v8
    v_mov_b32 v11, 0
    v_mov_b32 v15, 0
    v_permlane16_swap_b32 v8, v9
    v_max_f32 v8, v8, v9
    v_mul_f32 v8, s66, v8
    v_pk_fma_f32 v[4:5], v[4:5], s[44:45], v[8:9] op_sel_hi:[1,1,0]
    v_pk_fma_f32 v[6:7], v[6:7], s[44:45], v[8:9] op_sel_hi:[1,1,0]
    v_pk_fma_f32 v[24:25], v[24:25], s[44:45], v[8:9] op_sel_hi:[1,1,0]
    v_exp_f32 v4, v4
    v_exp_f32 v5, v5
    v_exp_f32 v6, v6
    v_exp_f32 v7, v7
    v_exp_f32 v24, v24
    v_exp_f32 v25, v25
    v_cvt_pk_bf16_f32 v12, v4, v5
    v_cvt_pk_bf16_f32 v13, v6, v7
    v_cvt_pk_bf16_f32 v10, v24, v25
    v_cvt_pk_bf16_f32 v14, v24, v25
    v_mov_b64 v[0:1], s[48:49]
    v_mfma_f32_16x16x32_bf16 v[4:7], v[32:35], v[10:13], 0
    ds_read_b128 v[40:43], v70 offset:20480
    v_mov_b64 v[2:3], s[50:51]
    v_mfma_f32_16x16x32_bf16 v[24:27], v[36:39], v[12:15], 0
    ds_read_b128 v[44:47], v70 offset:21504
    v_mov_b64 v[8:9], 0
    v_mfma_f32_16x16x32_bf16 v[28:31], v[0:3], v[10:13], 0
    ds_read_b128 v[32:35], v70 offset:24576
    v_mov_b64 v[0:1], 0
    v_mfma_f32_16x16x32_bf16 v[16:19], v[56:59], v[10:13], 0
    ds_read_b128 v[36:39], v70 offset:25600
    v_mov_b64 v[2:3], 0
    v_mfma_f32_16x16x32_bf16 v[20:23], v[60:63], v[12:15], 0
    ds_read_b128 v[56:59], v70 offset:28672
    v_add_f32_dpp v4, v24, v4 row_ror:8 row_mask:0xf bank_mask:0xf
    v_add_f32_dpp v5, v25, v5 row_ror:8 row_mask:0xf bank_mask:0xf
    v_add_f32_dpp v6, v26, v6 row_ror:8 row_mask:0xf bank_mask:0xf
    v_add_f32_dpp v7, v27, v7 row_ror:8 row_mask:0xf bank_mask:0xf
    v_add_f32_dpp v29, v28, v28 row_ror:8 row_mask:0xf bank_mask:0xf
    v_rcp_f32 v28, v29
    v_mov_b64 v[10:11], 0
    v_add_f32_dpp v4, v16, v20 row_ror:8 row_mask:0xf bank_mask:0xc
    v_add_f32_dpp v5, v17, v21 row_ror:8 row_mask:0xf bank_mask:0xc
    v_add_f32_dpp v6, v18, v22 row_ror:8 row_mask:0xf bank_mask:0xc
    v_add_f32_dpp v7, v19, v23 row_ror:8 row_mask:0xf bank_mask:0xc
    v_pk_mul_f32 v[4:5], v[4:5], v[28:29] op_sel_hi:[1,0]
    v_pk_mul_f32 v[6:7], v[6:7], v[28:29] op_sel_hi:[1,0]
    v_cvt_pk_bf16_f32 v4, v4, v5
    v_cvt_pk_bf16_f32 v5, v6, v7
    ds_write_b64 v73, v[4:5] offset:12288
    v_mov_b32_dpp v6, v4 row_ror:8 row_mask:0xf bank_mask:0xf
    v_mov_b32_dpp v7, v5 row_ror:8 row_mask:0xf bank_mask:0xf
    v_mov_b64 v[12:13], 0
    v_mov_b64 v[14:15], 0
    v_smfmac_f32_16x16x64_bf16 v[8:11], v[4:7], v[80:87], v64
    s_waitcnt lgkmcnt(4)
    v_mov_b64 v[24:25], 0
    v_smfmac_f32_16x16x64_bf16 v[0:3], v[4:7], v[40:47], v64
    ds_read_b128 v[60:63], v70 offset:29696
    v_mov_b64 v[26:27], 0
    v_smfmac_f32_16x16x64_bf16 v[12:15], v[4:7], v[112:119], v64
    s_waitcnt lgkmcnt(1)
    s_barrier
    ds_read_b128 v[16:19], v77 offset:12288
    v_smfmac_f32_16x16x64_bf16 v[24:27], v[4:7], v[48:55], v64
    ds_read_b128 v[20:23], v78 offset:12288
    ds_read_b128 v[28:31], v79 offset:12288
    v_mov_b64 v[4:5], 0
    v_mov_b64 v[6:7], 0
    v_bfe_u32 v77, v74, 16, 1
    v_mad_i32_i24 v77, v77, s56, v74
    s_waitcnt lgkmcnt(2)
    v_smfmac_f32_16x16x64_bf16 v[8:11], v[16:19], v[88:95], v64
    ds_read_b128 v[40:43], v70 offset:32768
    s_waitcnt lgkmcnt(2)
    v_smfmac_f32_16x16x64_bf16 v[8:11], v[20:23], v[96:103], v64
    ds_read_b128 v[44:47], v70 offset:33792
    s_waitcnt lgkmcnt(2)
    v_smfmac_f32_16x16x64_bf16 v[8:11], v[28:31], v[104:111], v64
    ds_read_b128 v[48:51], v70 offset:26624
    s_nop 0
    v_and_b32 v72, 8, v73
    v_smfmac_f32_16x16x64_bf16 v[0:3], v[16:19], v[32:39], v64
    ds_read_b128 v[52:55], v70 offset:27648
    s_nop 0
    v_mad_u32_u24 v72, v72, 63, v73
    v_smfmac_f32_16x16x64_bf16 v[12:15], v[16:19], v[120:127], v64
    ds_read_b128 v[32:35], v70 offset:30720
    v_cvt_pk_bf16_f32 v8, v8, v9
    v_cvt_pk_bf16_f32 v9, v10, v11
    v_and_or_b32 v8, v8, -2, s69
    v_smfmac_f32_16x16x64_bf16 v[12:15], v[20:23], v[128:135], v64
    buffer_store_dwordx2 v[8:9], v74, s[4:7], s22 offen offset:0
    ds_read_b128 v[36:39], v70 offset:31744
    v_smfmac_f32_16x16x64_bf16 v[12:15], v[28:31], v[136:143], v64
    s_add_u32 s30, s30, 1
    s_xor_b32 s70, s70, 1
    v_subrev_u32 v72, s47, v72
    v_smfmac_f32_16x16x64_bf16 v[0:3], v[20:23], v[56:63], v64
    ds_read_b128 v[56:59], v70 offset:34816
    s_waitcnt lgkmcnt(3)
    s_nop 0
    v_smfmac_f32_16x16x64_bf16 v[0:3], v[28:31], v[40:47], v64
    ds_read_b128 v[60:63], v70 offset:35840
    v_cvt_pk_bf16_f32 v12, v12, v13
    v_cvt_pk_bf16_f32 v13, v14, v15
    v_and_or_b32 v12, v12, -2, s69
    v_smfmac_f32_16x16x64_bf16 v[24:27], v[16:19], v[48:55], v64
    buffer_store_dwordx2 v[12:13], v74, s[4:7], s22 offen offset:64
    s_waitcnt lgkmcnt(2)
    v_smfmac_f32_16x16x64_bf16 v[24:27], v[20:23], v[32:39], v64
    ds_read_b128 v[40:43], v70 offset:16384
    v_cvt_pk_bf16_f32 v0, v0, v1
    v_cvt_pk_bf16_f32 v1, v2, v3
    v_and_or_b32 v0, v0, -2, s69
    s_waitcnt lgkmcnt(1)
    v_smfmac_f32_16x16x64_bf16 v[24:27], v[28:31], v[56:63], v64
    buffer_store_dwordx2 v[0:1], v74, s[4:7], s23 offen offset:0
    ds_read_b128 v[44:47], v70 offset:17408
    ds_read_b128 v[8:11], v72 offset:12288
    ds_read_b128 v[48:51], v70 offset:18432
    ds_read_b128 v[52:55], v70 offset:19456
    ds_read_b128 v[12:15], v72 offset:13312
    s_cmp_lg_u32 s71, 0
    s_nop 0
    v_cvt_pk_bf16_f32 v24, v24, v25
    v_cvt_pk_bf16_f32 v25, v26, v27
    v_and_or_b32 v24, v24, -2, s69
    buffer_store_dwordx2 v[24:25], v74, s[4:7], s23 offen offset:64
    s_waitcnt lgkmcnt(3)
    v_smfmac_f32_16x16x64_bf16 v[4:7], v[8:11], v[40:47], v64
    s_waitcnt lgkmcnt(0)
    v_smfmac_f32_16x16x64_bf16 v[4:7], v[12:15], v[48:55], v64
    s_nop 7
    v_cvt_pk_bf16_f32 v4, v4, v5
    v_cvt_pk_bf16_f32 v5, v6, v7
    v_and_or_b32 v4, v4, -2, s69
    buffer_store_dwordx2 v[4:5], v77, s[4:7], s25 offen offset:0
    s_nop 0
    s_cbranch_scc1 cf_e1
    s_cmp_lg_u32 s37, 0
    s_cbranch_scc1 cf_f0_xt
cf_f0_xtx:
    s_nop 2
    v_mov_b32 v79, v79
    s_nop 2
    v_mov_b32 v79, v79
    s_nop 2
    v_mov_b32 v79, v79
    s_nop 2
    v_mov_b32 v79, v79
    s_nop 2
    v_mov_b32 v79, v79
    buffer_load_dwordx4 v[8:11], v65, s[4:7], s18 offen nt
    buffer_load_dwordx4 v[12:15], v65, s[4:7], s19 offen nt
    buffer_load_dwordx4 v[16:19], v65, s[4:7], s20 offen nt
    buffer_load_dwordx4 v[20:23], v65, s[4:7], s21 offen nt
    v_and_b32 v77, 255, v69
    ds_read_b128 v[4:7], v77 offset:15872
    ds_read_b128 v[44:47], v70 offset:0
    ds_read_b128 v[48:51], v70 offset:1024
    ds_read_b128 v[52:55], v70 offset:2048
    ds_read_b128 v[56:59], v70 offset:3072
    ds_read_b128 v[24:27], v70 offset:4096
    ds_read_b128 v[28:31], v70 offset:5120
    ds_read_b128 v[32:35], v70 offset:6144
    ds_read_b128 v[36:39], v70 offset:7168
    s_mov_b32 s31, 65536
    s_add_u32 s24, s24, 524288
    s_add_u32 s26, s26, 524288
    s_add_u32 s55, s55, s57
    s_mov_b32 s14, 67108864
    s_mov_b32 s15, 67112960
    s_mov_b32 s16, 67117056
    s_mov_b32 s36, 1
    v_mov_b32 v40, s69
    v_mov_b32 v60, s69
    v_and_b32 v79, 12, v75
    v_cmp_eq_u32 vcc, 0, v79
    s_nop 1
    v_cndmask_b32 v79, 0, 1, vcc
    s_waitcnt lgkmcnt(0)
    s_waitcnt vmcnt(3)
    v_bitop3_b32 v77, v8, v10, s69 bitop3:0x7e
    v_mfma_f32_16x16x32_bf16 v[0:3], v[4:7], v[8:11], 0
    v_mov_b64 v[8:9], 0
    v_mov_b64 v[10:11], 0
    s_waitcnt vmcnt(2)
    v_bitop3_b32 v78, v12, v14, s69 bitop3:0x7e
    v_mfma_f32_16x16x32_bf16 v[0:3], v[4:7], v[12:15], v[0:3]
    v_or_b32 v77, v77, v78
    v_mov_b64 v[12:13], 0
    v_mov_b64 v[14:15], 0
    s_waitcnt vmcnt(1)
    v_bitop3_b32 v78, v16, v18, s69 bitop3:0x7e
    v_mfma_f32_16x16x32_bf16 v[0:3], v[4:7], v[16:19], v[0:3]
    v_or_b32 v77, v77, v78
    v_mov_b64 v[16:17], 0
    v_mov_b64 v[18:19], 0
    s_waitcnt vmcnt(0)
    v_bitop3_b32 v78, v20, v22, s69 bitop3:0x7e
    v_mfma_f32_16x16x32_bf16 v[0:3], v[4:7], v[20:23], v[0:3]
    v_bitop3_b32 v77, v77, v78, 1 bitop3:0xa8
    v_cmp_ne_u32 vcc, 0, v77
    v_mov_b64 v[20:21], 0
    v_mov_b64 v[22:23], 0
    s_cmp_eq_u64 vcc, 0
    s_cselect_b64 s[42:43], -1, 0
    s_nop 1
    v_add_f32_dpp v0, v0, v0 row_ror:8 row_mask:0xf bank_mask:0xf
    v_add_f32_dpp v1, v1, v1 row_ror:8 row_mask:0xf bank_mask:0xf
    s_mov_b64 exec, s[42:43]
    v_cvt_pk_bf16_f32 v72, v0, v1
    v_bfi_b32 v72, v79, s70, v72
    buffer_store_dword v72, v75, s[4:7], s17 offen offset:0
    s_mov_b64 exec, -1
    s_cbranch_scc0 cf_f0_retry
cf_f0_go:
    v_mov_b64 v[0:1], 0
    v_mov_b64 v[2:3], 0
    v_mov_b64 v[4:5], 0
    v_mov_b64 v[6:7], 0
    s_nop 2
    v_mov_b32 v79, v79
    s_nop 2
    v_mov_b32 v79, v79
    s_nop 2
    v_mov_b32 v79, v79
    s_nop 2
    v_mov_b32 v79, v79
    s_branch cf_loop
cf_e1:
    s_cmp_lg_u32 s71, 2
    s_cbranch_scc1 cf_f1
    v_and_b32 v77, 255, v69
    ds_read_b128 v[4:7], v77 offset:15872
    ds_read_b128 v[44:47], v70 offset:0
    ds_read_b128 v[48:51], v70 offset:1024
    ds_read_b128 v[52:55], v70 offset:2048
    ds_read_b128 v[56:59], v70 offset:3072
    ds_read_b128 v[24:27], v70 offset:4096
    ds_read_b128 v[28:31], v70 offset:5120
    ds_read_b128 v[32:35], v70 offset:6144
    ds_read_b128 v[36:39], v70 offset:7168
    s_mov_b32 s31, 65536
    s_add_u32 s24, s24, 524288
    s_add_u32 s26, s26, 524288
    s_add_u32 s55, s55, s57
    s_mov_b32 s14, 67108864
    s_mov_b32 s15, 67112960
    s_mov_b32 s16, 67117056
    s_mov_b32 s36, 1
    v_mov_b32 v40, s69
    v_mov_b32 v60, s69
    v_and_b32 v79, 12, v75
    v_cmp_eq_u32 vcc, 0, v79
    s_nop 1
    v_cndmask_b32 v79, 0, 1, vcc
    s_cmp_lg_u32 s37, 0
    s_cbranch_scc1 cf_f2_xt
cf_f2_xtx:
    s_nop 2
    v_mov_b32 v79, v79
    s_nop 2
    v_mov_b32 v79, v79
    s_nop 2
    v_mov_b32 v79, v79
    s_nop 2
    v_mov_b32 v79, v79
    s_nop 2
    v_mov_b32 v79, v79
    s_nop 2
    v_mov_b32 v79, v79
    s_nop 2
    v_mov_b32 v79, v79
    s_nop 2
    v_mov_b32 v79, v79
    s_waitcnt vmcnt(0)
    buffer_load_dwordx4 v[8:11], v65, s[4:7], s18 offen nt
    buffer_load_dwordx4 v[12:15], v65, s[4:7], s19 offen nt
    buffer_load_dwordx4 v[16:19], v65, s[4:7], s20 offen nt
    buffer_load_dwordx4 v[20:23], v65, s[4:7], s21 offen nt
    s_nop 2
    v_mov_b32 v79, v79
    s_nop 2
    v_mov_b32 v79, v79
    s_nop 2
    v_mov_b32 v79, v79
    s_nop 2
    v_mov_b32 v79, v79
    s_nop 2
    v_mov_b32 v79, v79
    s_nop 2
    v_mov_b32 v79, v79
    s_nop 2
    v_mov_b32 v79, v79
    s_nop 2
    v_mov_b32 v79, v79
    s_nop 2
    v_mov_b32 v79, v79
    s_nop 2
    v_mov_b32 v79, v79
    buffer_load_dwordx4 v[40:43], v65, s[4:7], s14 offen offset:0 nt
    buffer_load_dwordx4 v[60:63], v66, s[4:7], s14 offen offset:0 nt
    s_waitcnt lgkmcnt(0)
    s_waitcnt vmcnt(5)
    v_bitop3_b32 v77, v8, v10, s69 bitop3:0x7e
    v_mfma_f32_16x16x32_bf16 v[0:3], v[4:7], v[8:11], 0
    v_mov_b64 v[8:9], 0
    v_mov_b64 v[10:11], 0
    s_waitcnt vmcnt(4)
    v_bitop3_b32 v78, v12, v14, s69 bitop3:0x7e
    v_mfma_f32_16x16x32_bf16 v[0:3], v[4:7], v[12:15], v[0:3]
    v_or_b32 v77, v77, v78
    v_mov_b64 v[12:13], 0
    v_mov_b64 v[14:15], 0
    s_waitcnt vmcnt(3)
    v_bitop3_b32 v78, v16, v18, s69 bitop3:0x7e
    v_mfma_f32_16x16x32_bf16 v[0:3], v[4:7], v[16:19], v[0:3]
    v_or_b32 v77, v77, v78
    v_mov_b64 v[16:17], 0
    v_mov_b64 v[18:19], 0
    s_waitcnt vmcnt(2)
    v_bitop3_b32 v78, v20, v22, s69 bitop3:0x7e
    v_mfma_f32_16x16x32_bf16 v[0:3], v[4:7], v[20:23], v[0:3]
    v_bitop3_b32 v77, v77, v78, 1 bitop3:0xa8
    v_cmp_ne_u32 vcc, 0, v77
    v_mov_b64 v[20:21], 0
    v_mov_b64 v[22:23], 0
    buffer_load_dwordx4 v[40:43], v65, s[4:7], s14 offen offset:0 nt
    buffer_load_dwordx4 v[60:63], v66, s[4:7], s14 offen offset:0 nt
    s_cmp_eq_u64 vcc, 0
    s_cselect_b64 s[42:43], -1, 0
    v_add_f32_dpp v0, v0, v0 row_ror:4 row_mask:0xf bank_mask:0xf
    v_add_f32_dpp v1, v1, v1 row_ror:4 row_mask:0xf bank_mask:0xf
    s_nop 0
    v_add_f32_dpp v0, v0, v0 row_ror:8 row_mask:0xf bank_mask:0xf
    v_add_f32_dpp v1, v1, v1 row_ror:8 row_mask:0xf bank_mask:0xf
    s_mov_b64 exec, s[42:43]
    v_cvt_pk_bf16_f32 v72, v0, v1
    v_bfi_b32 v72, v79, s70, v72
    buffer_store_dword v72, v75, s[4:7], s17 offen offset:0
    buffer_store_dword v72, v75, s[4:7], s17 offen offset:1024
    buffer_store_dword v72, v75, s[4:7], s17 offen offset:2048
    buffer_store_dword v72, v75, s[4:7], s17 offen offset:3072
    s_mov_b64 exec, -1
    s_cbranch_scc0 cf_f2_retry
cf_f2_go:
    v_mov_b64 v[0:1], 0
    v_mov_b64 v[2:3], 0
    v_mov_b64 v[4:5], 0
    v_mov_b64 v[6:7], 0
    s_branch cf_loop
cf_f1:
    s_cmp_lg_u32 s32, 1
    s_cbranch_scc1 cf_f3
    v_and_b32 v77, 255, v69
    ds_read_b128 v[4:7], v77 offset:15872
    ds_read_b128 v[44:47], v70 offset:0
    ds_read_b128 v[48:51], v70 offset:1024
    ds_read_b128 v[52:55], v70 offset:2048
    ds_read_b128 v[56:59], v70 offset:3072
    ds_read_b128 v[24:27], v70 offset:4096
    ds_read_b128 v[28:31], v70 offset:5120
    ds_read_b128 v[32:35], v70 offset:6144
    ds_read_b128 v[36:39], v70 offset:7168
    s_mov_b32 s31, 65536
    s_add_u32 s24, s24, 524288
    s_add_u32 s26, s26, 524288
    s_add_u32 s55, s55, s57
    s_mov_b32 s14, 67108864
    s_mov_b32 s15, 67112960
    s_mov_b32 s16, 67117056
    s_mov_b32 s36, 1
    v_mov_b32 v40, s69
    v_mov_b32 v60, s69
    v_and_b32 v79, 12, v75
    v_cmp_eq_u32 vcc, 0, v79
    s_nop 1
    v_cndmask_b32 v79, 0, 1, vcc
    s_cmp_lg_u32 s37, 0
    s_cbranch_scc1 cf_f1_xt
cf_f1_xtx:
    s_nop 2
    v_mov_b32 v79, v79
    s_waitcnt vmcnt(0)
    buffer_load_dwordx4 v[8:11], v65, s[4:7], s18 offen nt
    buffer_load_dwordx4 v[12:15], v65, s[4:7], s19 offen nt
    buffer_load_dwordx4 v[16:19], v65, s[4:7], s20 offen nt
    buffer_load_dwordx4 v[20:23], v65, s[4:7], s21 offen nt
    s_nop 2
    v_mov_b32 v79, v79
    s_nop 2
    v_mov_b32 v79, v79
    s_nop 2
    v_mov_b32 v79, v79
    s_nop 2
    v_mov_b32 v79, v79
    s_nop 2
    v_mov_b32 v79, v79
    s_nop 2
    v_mov_b32 v79, v79
    s_nop 2
    v_mov_b32 v79, v79
    s_nop 2
    v_mov_b32 v79, v79
    s_nop 2
    v_mov_b32 v79, v79
    s_nop 2
    v_mov_b32 v79, v79
    buffer_load_dwordx4 v[40:43], v65, s[4:7], s14 offen offset:0 nt
    buffer_load_dwordx4 v[60:63], v66, s[4:7], s14 offen offset:0 nt
    s_waitcnt lgkmcnt(0)
    s_waitcnt vmcnt(5)
    v_bitop3_b32 v77, v8, v10, s69 bitop3:0x7e
    v_mfma_f32_16x16x32_bf16 v[0:3], v[4:7], v[8:11], 0
    v_mov_b64 v[8:9], 0
    v_mov_b64 v[10:11], 0
    s_waitcnt vmcnt(4)
    v_bitop3_b32 v78, v12, v14, s69 bitop3:0x7e
    v_mfma_f32_16x16x32_bf16 v[0:3], v[4:7], v[12:15], v[0:3]
    v_or_b32 v77, v77, v78
    v_mov_b64 v[12:13], 0
    v_mov_b64 v[14:15], 0
    s_waitcnt vmcnt(3)
    v_bitop3_b32 v78, v16, v18, s69 bitop3:0x7e
    v_mfma_f32_16x16x32_bf16 v[0:3], v[4:7], v[16:19], v[0:3]
    v_or_b32 v77, v77, v78
    v_mov_b64 v[16:17], 0
    v_mov_b64 v[18:19], 0
    s_waitcnt vmcnt(2)
    v_bitop3_b32 v78, v20, v22, s69 bitop3:0x7e
    v_mfma_f32_16x16x32_bf16 v[0:3], v[4:7], v[20:23], v[0:3]
    v_bitop3_b32 v77, v77, v78, 1 bitop3:0xa8
    v_cmp_ne_u32 vcc, 0, v77
    v_mov_b64 v[20:21], 0
    v_mov_b64 v[22:23], 0
    buffer_load_dwordx4 v[40:43], v65, s[4:7], s14 offen offset:0 nt
    buffer_load_dwordx4 v[60:63], v66, s[4:7], s14 offen offset:0 nt
    s_cmp_eq_u64 vcc, 0
    s_cselect_b64 s[42:43], -1, 0
    v_add_f32_dpp v0, v0, v0 row_ror:8 row_mask:0xf bank_mask:0xf
    v_add_f32_dpp v1, v1, v1 row_ror:8 row_mask:0xf bank_mask:0xf
    s_mov_b64 exec, s[42:43]
    v_cvt_pk_bf16_f32 v72, v0, v1
    v_bfi_b32 v72, v79, s70, v72
    buffer_store_dword v72, v75, s[4:7], s17 offen offset:0
    s_mov_b64 exec, -1
    s_cbranch_scc0 cf_f1_retry
cf_f1_go:
    v_mov_b64 v[0:1], 0
    v_mov_b64 v[2:3], 0
    v_mov_b64 v[4:5], 0
    v_mov_b64 v[6:7], 0
    s_branch cf_loop
cf_f3:
    v_and_b32 v77, 255, v69
    ds_read_b128 v[4:7], v77 offset:15872
    ds_read_b128 v[44:47], v70 offset:0
    ds_read_b128 v[48:51], v70 offset:1024
    ds_read_b128 v[52:55], v70 offset:2048
    ds_read_b128 v[56:59], v70 offset:3072
    ds_read_b128 v[24:27], v70 offset:4096
    ds_read_b128 v[28:31], v70 offset:5120
    ds_read_b128 v[32:35], v70 offset:6144
    ds_read_b128 v[36:39], v70 offset:7168
    s_mov_b32 s31, 65536
    s_add_u32 s24, s24, 524288
    s_add_u32 s26, s26, 524288
    s_add_u32 s55, s55, s57
    s_mov_b32 s14, 67108864
    s_mov_b32 s15, 67112960
    s_mov_b32 s16, 67117056
    s_mov_b32 s36, 1
    v_mov_b32 v40, s69
    v_mov_b32 v60, s69
    v_and_b32 v79, 12, v75
    v_cmp_eq_u32 vcc, 0, v79
    s_nop 1
    v_cndmask_b32 v79, 0, 1, vcc
    s_add_u32 s40, s30, s95
    v_mov_b32 v72, s40
    s_waitcnt lgkmcnt(0)
    v_mov_b64 v[0:1], 0
    v_mov_b64 v[2:3], 0
    v_mov_b64 v[4:5], 0
    v_mov_b64 v[6:7], 0
    v_mov_b64 v[8:9], 0
    v_mov_b64 v[10:11], 0
    v_mov_b64 v[12:13], 0
    v_mov_b64 v[14:15], 0
    v_mov_b64 v[16:17], 0
    v_mov_b64 v[18:19], 0
    v_mov_b64 v[20:21], 0
    v_mov_b64 v[22:23], 0
    s_nop 2
    v_mov_b32 v79, v79
    s_nop 2
    v_mov_b32 v79, v79
    s_nop 2
    v_mov_b32 v79, v79
    s_nop 2
    v_mov_b32 v79, v79
    s_nop 2
    v_mov_b32 v79, v79
    s_nop 2
    v_mov_b32 v79, v79
    s_nop 2
    v_mov_b32 v79, v79
    s_nop 2
    v_mov_b32 v79, v79
    s_nop 2
    v_mov_b32 v79, v79
    s_waitcnt vmcnt(0)
    s_cmp_lt_u32 s97, s93
    s_cbranch_scc1 cf_kvwait
    s_nop 2
    v_mov_b32 v79, v79
    s_nop 2
    v_mov_b32 v79, v79
    s_nop 2
    v_mov_b32 v79, v79
    s_nop 2
    v_mov_b32 v79, v79
    s_nop 2
    v_mov_b32 v79, v79
    s_nop 2
    v_mov_b32 v79, v79
    s_nop 2
    v_mov_b32 v79, v79
    s_nop 2
    v_mov_b32 v79, v79
cf_kvok:
    s_branch cf_loop
cf_f0_xt:
    s_sub_u32 s37, s37, 1
    s_nop 2
    v_mov_b32 v79, v79
    s_nop 2
    v_mov_b32 v79, v79
    s_nop 2
    v_mov_b32 v79, v79
    s_nop 2
    v_mov_b32 v79, v79
    s_nop 2
    v_mov_b32 v79, v79
    s_nop 2
    v_mov_b32 v79, v79
    s_branch cf_f0_xtx
cf_f0_retry:
    s_sub_u32 s41, s30, s98
    s_mov_b32 s98, s30
    s_cmp_le_u32 s41, 3
    s_cselect_b32 s37, 1, 1
cf_f0_spin:
    buffer_load_dwordx4 v[8:11], v65, s[4:7], s18 offen nt
    buffer_load_dwordx4 v[12:15], v65, s[4:7], s19 offen nt
    buffer_load_dwordx4 v[16:19], v65, s[4:7], s20 offen nt
    buffer_load_dwordx4 v[20:23], v65, s[4:7], s21 offen nt
    s_nop 2
    v_mov_b32 v79, v79
    s_nop 2
    v_mov_b32 v79, v79
    s_nop 2
    v_mov_b32 v79, v79
    buffer_load_dwordx4 v[40:43], v65, s[4:7], s14 offen offset:0 nt
    buffer_load_dwordx4 v[60:63], v66, s[4:7], s14 offen offset:0 nt
    s_waitcnt vmcnt(5)
    v_bitop3_b32 v77, v8, v10, s69 bitop3:0x7e
    v_mfma_f32_16x16x32_bf16 v[0:3], v[4:7], v[8:11], 0
    v_mov_b64 v[8:9], 0
    v_mov_b64 v[10:11], 0
    s_waitcnt vmcnt(4)
    v_bitop3_b32 v78, v12, v14, s69 bitop3:0x7e
    v_mfma_f32_16x16x32_bf16 v[0:3], v[4:7], v[12:15], v[0:3]
    v_or_b32 v77, v77, v78
    v_mov_b64 v[12:13], 0
    v_mov_b64 v[14:15], 0
    s_waitcnt vmcnt(3)
    v_bitop3_b32 v78, v16, v18, s69 bitop3:0x7e
    v_mfma_f32_16x16x32_bf16 v[0:3], v[4:7], v[16:19], v[0:3]
    v_or_b32 v77, v77, v78
    v_mov_b64 v[16:17], 0
    v_mov_b64 v[18:19], 0
    s_waitcnt vmcnt(2)
    v_bitop3_b32 v78, v20, v22, s69 bitop3:0x7e
    v_mfma_f32_16x16x32_bf16 v[0:3], v[4:7], v[20:23], v[0:3]
    v_bitop3_b32 v77, v77, v78, 1 bitop3:0xa8
    v_cmp_ne_u32 vcc, 0, v77
    v_mov_b64 v[20:21], 0
    v_mov_b64 v[22:23], 0
    buffer_load_dwordx4 v[40:43], v65, s[4:7], s14 offen offset:0 nt
    buffer_load_dwordx4 v[60:63], v66, s[4:7], s14 offen offset:0 nt
    s_cmp_eq_u64 vcc, 0
    s_cselect_b64 s[42:43], -1, 0
    v_add_f32_dpp v0, v0, v0 row_ror:8 row_mask:0xf bank_mask:0xf
    v_add_f32_dpp v1, v1, v1 row_ror:8 row_mask:0xf bank_mask:0xf
    s_mov_b64 exec, s[42:43]
    v_cvt_pk_bf16_f32 v72, v0, v1
    v_bfi_b32 v72, v79, s70, v72
    buffer_store_dword v72, v75, s[4:7], s17 offen offset:0
    s_mov_b64 exec, -1
    s_cbranch_scc1 cf_f0_rx
    s_sub_u32 s31, s31, 1
    s_cbranch_scc0 cf_f0_spin
cf_f0_rx:
    v_mov_b64 v[0:1], 0
    v_mov_b64 v[2:3], 0
    v_mov_b64 v[4:5], 0
    v_mov_b64 v[6:7], 0
    s_branch cf_loop
cf_f1_xt:
    s_sub_u32 s37, s37, 1
    s_nop 2
    v_mov_b32 v79, v79
    s_nop 2
    v_mov_b32 v79, v79
    s_nop 2
    v_mov_b32 v79, v79
    s_nop 2
    v_mov_b32 v79, v79
    s_nop 2
    v_mov_b32 v79, v79
    s_nop 2
    v_mov_b32 v79, v79
    s_branch cf_f1_xtx
cf_f1_retry:
    s_sub_u32 s41, s30, s98
    s_mov_b32 s98, s30
    s_cmp_le_u32 s41, 3
    s_cselect_b32 s37, 1, 1
cf_f1_spin:
    buffer_load_dwordx4 v[8:11], v65, s[4:7], s18 offen nt
    buffer_load_dwordx4 v[12:15], v65, s[4:7], s19 offen nt
    buffer_load_dwordx4 v[16:19], v65, s[4:7], s20 offen nt
    buffer_load_dwordx4 v[20:23], v65, s[4:7], s21 offen nt
    s_nop 2
    v_mov_b32 v79, v79
    s_nop 2
    v_mov_b32 v79, v79
    s_nop 2
    v_mov_b32 v79, v79
    buffer_load_dwordx4 v[40:43], v65, s[4:7], s14 offen offset:0 nt
    buffer_load_dwordx4 v[60:63], v66, s[4:7], s14 offen offset:0 nt
    s_waitcnt vmcnt(5)
    v_bitop3_b32 v77, v8, v10, s69 bitop3:0x7e
    v_mfma_f32_16x16x32_bf16 v[0:3], v[4:7], v[8:11], 0
    v_mov_b64 v[8:9], 0
    v_mov_b64 v[10:11], 0
    s_waitcnt vmcnt(4)
    v_bitop3_b32 v78, v12, v14, s69 bitop3:0x7e
    v_mfma_f32_16x16x32_bf16 v[0:3], v[4:7], v[12:15], v[0:3]
    v_or_b32 v77, v77, v78
    v_mov_b64 v[12:13], 0
    v_mov_b64 v[14:15], 0
    s_waitcnt vmcnt(3)
    v_bitop3_b32 v78, v16, v18, s69 bitop3:0x7e
    v_mfma_f32_16x16x32_bf16 v[0:3], v[4:7], v[16:19], v[0:3]
    v_or_b32 v77, v77, v78
    v_mov_b64 v[16:17], 0
    v_mov_b64 v[18:19], 0
    s_waitcnt vmcnt(2)
    v_bitop3_b32 v78, v20, v22, s69 bitop3:0x7e
    v_mfma_f32_16x16x32_bf16 v[0:3], v[4:7], v[20:23], v[0:3]
    v_bitop3_b32 v77, v77, v78, 1 bitop3:0xa8
    v_cmp_ne_u32 vcc, 0, v77
    v_mov_b64 v[20:21], 0
    v_mov_b64 v[22:23], 0
    buffer_load_dwordx4 v[40:43], v65, s[4:7], s14 offen offset:0 nt
    buffer_load_dwordx4 v[60:63], v66, s[4:7], s14 offen offset:0 nt
    s_cmp_eq_u64 vcc, 0
    s_cselect_b64 s[42:43], -1, 0
    v_add_f32_dpp v0, v0, v0 row_ror:8 row_mask:0xf bank_mask:0xf
    v_add_f32_dpp v1, v1, v1 row_ror:8 row_mask:0xf bank_mask:0xf
    s_mov_b64 exec, s[42:43]
    v_cvt_pk_bf16_f32 v72, v0, v1
    v_bfi_b32 v72, v79, s70, v72
    buffer_store_dword v72, v75, s[4:7], s17 offen offset:0
    s_mov_b64 exec, -1
    s_cbranch_scc1 cf_f1_rx
    s_sub_u32 s31, s31, 1
    s_cbranch_scc0 cf_f1_spin
cf_f1_rx:
    v_mov_b64 v[0:1], 0
    v_mov_b64 v[2:3], 0
    v_mov_b64 v[4:5], 0
    v_mov_b64 v[6:7], 0
    s_branch cf_loop
cf_f2_xt:
    s_sub_u32 s37, s37, 1
    s_nop 2
    v_mov_b32 v79, v79
    s_nop 2
    v_mov_b32 v79, v79
    s_nop 2
    v_mov_b32 v79, v79
    s_nop 2
    v_mov_b32 v79, v79
    s_nop 2
    v_mov_b32 v79, v79
    s_nop 2
    v_mov_b32 v79, v79
    s_branch cf_f2_xtx
cf_f2_retry:
    s_sub_u32 s41, s30, s98
    s_mov_b32 s98, s30
    s_cmp_le_u32 s41, 3
    s_cselect_b32 s37, 1, 1
cf_f2_spin:
    buffer_load_dwordx4 v[8:11], v65, s[4:7], s18 offen nt
    buffer_load_dwordx4 v[12:15], v65, s[4:7], s19 offen nt
    buffer_load_dwordx4 v[16:19], v65, s[4:7], s20 offen nt
    buffer_load_dwordx4 v[20:23], v65, s[4:7], s21 offen nt
    s_nop 2
    v_mov_b32 v79, v79
    s_nop 2
    v_mov_b32 v79, v79
    s_nop 2
    v_mov_b32 v79, v79
    buffer_load_dwordx4 v[40:43], v65, s[4:7], s14 offen offset:0 nt
    buffer_load_dwordx4 v[60:63], v66, s[4:7], s14 offen offset:0 nt
    s_waitcnt vmcnt(5)
    v_bitop3_b32 v77, v8, v10, s69 bitop3:0x7e
    v_mfma_f32_16x16x32_bf16 v[0:3], v[4:7], v[8:11], 0
    v_mov_b64 v[8:9], 0
    v_mov_b64 v[10:11], 0
    s_waitcnt vmcnt(4)
    v_bitop3_b32 v78, v12, v14, s69 bitop3:0x7e
    v_mfma_f32_16x16x32_bf16 v[0:3], v[4:7], v[12:15], v[0:3]
    v_or_b32 v77, v77, v78
    v_mov_b64 v[12:13], 0
    v_mov_b64 v[14:15], 0
    s_waitcnt vmcnt(3)
    v_bitop3_b32 v78, v16, v18, s69 bitop3:0x7e
    v_mfma_f32_16x16x32_bf16 v[0:3], v[4:7], v[16:19], v[0:3]
    v_or_b32 v77, v77, v78
    v_mov_b64 v[16:17], 0
    v_mov_b64 v[18:19], 0
    s_waitcnt vmcnt(2)
    v_bitop3_b32 v78, v20, v22, s69 bitop3:0x7e
    v_mfma_f32_16x16x32_bf16 v[0:3], v[4:7], v[20:23], v[0:3]
    v_bitop3_b32 v77, v77, v78, 1 bitop3:0xa8
    v_cmp_ne_u32 vcc, 0, v77
    v_mov_b64 v[20:21], 0
    v_mov_b64 v[22:23], 0
    buffer_load_dwordx4 v[40:43], v65, s[4:7], s14 offen offset:0 nt
    buffer_load_dwordx4 v[60:63], v66, s[4:7], s14 offen offset:0 nt
    s_cmp_eq_u64 vcc, 0
    s_cselect_b64 s[42:43], -1, 0
    v_add_f32_dpp v0, v0, v0 row_ror:4 row_mask:0xf bank_mask:0xf
    v_add_f32_dpp v1, v1, v1 row_ror:4 row_mask:0xf bank_mask:0xf
    s_nop 0
    v_add_f32_dpp v0, v0, v0 row_ror:8 row_mask:0xf bank_mask:0xf
    v_add_f32_dpp v1, v1, v1 row_ror:8 row_mask:0xf bank_mask:0xf
    s_mov_b64 exec, s[42:43]
    v_cvt_pk_bf16_f32 v72, v0, v1
    v_bfi_b32 v72, v79, s70, v72
    buffer_store_dword v72, v75, s[4:7], s17 offen offset:0
    buffer_store_dword v72, v75, s[4:7], s17 offen offset:1024
    buffer_store_dword v72, v75, s[4:7], s17 offen offset:2048
    buffer_store_dword v72, v75, s[4:7], s17 offen offset:3072
    s_mov_b64 exec, -1
    s_cbranch_scc1 cf_f2_rx
    s_sub_u32 s31, s31, 1
    s_cbranch_scc0 cf_f2_spin
cf_f2_rx:
    v_mov_b64 v[0:1], 0
    v_mov_b64 v[2:3], 0
    v_mov_b64 v[4:5], 0
    v_mov_b64 v[6:7], 0
    s_branch cf_loop
cf_spinB:
    s_waitcnt vmcnt(3)
cf_spinB_l:
    v_and_b32 v77, s36, v44
    v_cmp_ne_u32 vcc, s70, v77
    s_cbranch_vccz cf_spinB_x
    buffer_load_dwordx4 v[44:47], v65, s[4:7], s15 offen nt
    s_sub_u32 s31, s31, 16
    s_waitcnt vmcnt(0)
    s_cbranch_scc0 cf_spinB_l
cf_spinB_x:
    ds_write_b128 v65, v[44:47] offset:4096
    s_waitcnt lgkmcnt(0)
    s_branch cf_backB
cf_spin8:
    buffer_load_dwordx4 v[40:43], v65, s[4:7], s16 offen nt
cf_spin8_l:
    v_and_b32 v77, s36, v40
    v_cmp_ne_u32 vcc, s70, v77
    s_cbranch_vccz cf_spin8_x
    s_nop 1
    v_and_b32 v77, s36, v40
    v_cmp_ne_u32 vcc, s70, v77
    s_cbranch_vccz cf_spin8_x
    s_nop 1
    v_and_b32 v77, s36, v40
    v_cmp_ne_u32 vcc, s70, v77
    s_cbranch_vccz cf_spin8_x
    s_nop 1
    buffer_load_dwordx4 v[40:43], v65, s[4:7], s16 offen nt
    s_sub_u32 s31, s31, 16
    s_cbranch_scc0 cf_spin8_l
cf_spin8_x:
    s_branch cf_back8
cf_rare:
    s_mov_b64 exec, s[34:35]
    buffer_store_dwordx4 v[0:3], v65, s[4:7], s28 offen sc1
    s_mov_b64 exec, -1
    s_nop 3
    v_cvt_pk_bf16_f32 v52, v16, v17
    v_cvt_pk_bf16_f32 v53, v18, v19
    v_cvt_pk_bf16_f32 v54, v20, v21
    v_cvt_pk_bf16_f32 v55, v22, v23
    buffer_store_dwordx4 v[52:55], v65, s[4:7], s27 offen sc1
    s_add_u32 s28, s28, 131072
    s_add_u32 s27, s27, 131072
    s_cmp_eq_u32 s30, 63
    s_cbranch_scc1 cf_last
    s_branch cf_rare_x
cf_kvwait:
    s_mov_b32 s41, s97
    v_bfe_u32 v78, v65, 2, 5
    v_mov_b32 v77, v76
    s_nop 1
    v_permlane32_swap_b32 v76, v77
    v_subrev_u32 v77, s95, v77
    v_cmp_lt_u32 vcc, 16, v77
    s_nop 1
    v_cndmask_b32 v77, v77, 0, vcc
    v_bfe_u32 v79, v78, 2, 2
    v_lshl_add_u32 v77, v77, 2, v79
    s_nop 1
    v_min_u32_dpp v77, v77, v77 row_ror:1 row_mask:0xf bank_mask:0xf
    s_nop 1
    v_min_u32_dpp v77, v77, v77 row_ror:2 row_mask:0xf bank_mask:0xf
    s_nop 1
    v_min_u32_dpp v77, v77, v77 row_ror:4 row_mask:0xf bank_mask:0xf
    s_nop 0
    v_readfirstlane_b32 s97, v77
    s_nop 0
    s_max_u32 s97, s97, s41
    s_add_u32 s40, s30, 3
    s_min_u32 s40, s40, 64
    s_cmp_le_u32 s40, s97
    s_cbranch_scc1 cf_kvw_x
    v_bfe_u32 v78, v65, 2, 5
    s_mov_b32 s31, 4194304
cf_kvw:
    buffer_load_dword v77, v78, s[4:7], s96 offen offset:16 sc1
    s_waitcnt vmcnt(0)
    v_subrev_u32 v77, s95, v77
    v_cmp_lt_u32 vcc, 16, v77
    s_nop 1
    v_cndmask_b32 v77, v77, 0, vcc
    v_bfe_u32 v79, v78, 2, 2
    v_lshl_add_u32 v77, v77, 2, v79
    s_nop 1
    v_min_u32_dpp v77, v77, v77 row_ror:1 row_mask:0xf bank_mask:0xf
    s_nop 1
    v_min_u32_dpp v77, v77, v77 row_ror:2 row_mask:0xf bank_mask:0xf
    s_nop 1
    v_min_u32_dpp v77, v77, v77 row_ror:4 row_mask:0xf bank_mask:0xf
    s_nop 0
    v_readfirstlane_b32 s97, v77
    s_sub_u32 s31, s31, 1
    s_cbranch_scc1 cf_kvw_x
    s_cmp_le_u32 s40, s97
    s_cbranch_scc1 cf_kvw_x
    s_sleep 2
    s_branch cf_kvw
cf_kvw_x:
    s_branch cf_kvok
cf_last:
    s_add_u32 s40, s95, 64
    v_mov_b32 v78, s40
    s_waitcnt vmcnt(0)
    s_barrier
    s_mov_b64 exec, s[100:101]
    buffer_store_dword v78, off, s[4:7], s29 sc1
    s_mov_b64 exec, -1
cf_end:
    s_endpgm
L_chain_safe:
    s_load_dwordx8 s[48:55], s[0:1], 8
    s_load_dwordx2 s[56:57], s[0:1], 40
    s_waitcnt lgkmcnt(0)
    v_lshrrev_b32 v77, 6, v0
    s_nop 0
    v_readfirstlane_b32 s13, v77
    v_lshlrev_b32 v65, 4, v0
    v_and_b32 v48, 63, v0
    s_mov_b32 s10, 4718592
    s_mov_b32 s11, 0x20000
    v_lshrrev_b32 v49, 3, v48
    v_mul_u32_u24 v18, 1152, v49
    v_and_b32 v49, 7, v48
    v_lshl_add_u32 v18, v49, 4, v18
    s_mul_i32 s40, s12, 147456
    s_lshl_b32 s41, s13, 8
    s_add_u32 s40, s40, s41
    s_mov_b32 s42, s40
    s_xor_b32 s41, s13, 0
    s_mul_i32 s41, s41, 36864
    s_add_u32 s60, s41, s40
    s_xor_b32 s41, s13, 1
    s_mul_i32 s41, s41, 36864
    s_add_u32 s61, s41, s40
    s_xor_b32 s41, s13, 2
    s_mul_i32 s41, s41, 36864
    s_add_u32 s62, s41, s40
    s_xor_b32 s41, s13, 3
    s_mul_i32 s41, s41, 36864
    s_add_u32 s63, s41, s40
    s_lshl_b32 s43, s13, 12
    s_mov_b64 s[8:9], s[56:57]
    s_add_u32 m0, s43, 0
    s_add_u32 s41, s60, 0
    buffer_load_dwordx4 v18, s[8:11], s41 offen offset:0 nt lds
    s_add_u32 s41, s60, 8192
    buffer_load_dwordx4 v18, s[8:11], s41 offen offset:1024 nt lds
    s_add_u32 s41, s60, 16384
    buffer_load_dwordx4 v18, s[8:11], s41 offen offset:2048 nt lds
    s_add_u32 s41, s60, 24576
    buffer_load_dwordx4 v18, s[8:11], s41 offen offset:3072 nt lds
    s_add_u32 m0, s43, 36864
    s_add_u32 s41, s61, 0
    buffer_load_dwordx4 v18, s[8:11], s41 offen offset:0 nt lds
    s_add_u32 s41, s61, 8192
    buffer_load_dwordx4 v18, s[8:11], s41 offen offset:1024 nt lds
    s_add_u32 s41, s61, 16384
    buffer_load_dwordx4 v18, s[8:11], s41 offen offset:2048 nt lds
    s_add_u32 s41, s61, 24576
    buffer_load_dwordx4 v18, s[8:11], s41 offen offset:3072 nt lds
    s_add_u32 m0, s43, 73728
    s_add_u32 s41, s62, 0
    buffer_load_dwordx4 v18, s[8:11], s41 offen offset:0 nt lds
    s_add_u32 s41, s62, 8192
    buffer_load_dwordx4 v18, s[8:11], s41 offen offset:1024 nt lds
    s_add_u32 s41, s62, 16384
    buffer_load_dwordx4 v18, s[8:11], s41 offen offset:2048 nt lds
    s_add_u32 s41, s62, 24576
    buffer_load_dwordx4 v18, s[8:11], s41 offen offset:3072 nt lds
    s_add_u32 m0, s43, 110592
    s_add_u32 s41, s63, 0
    buffer_load_dwordx4 v18, s[8:11], s41 offen offset:0 nt lds
    s_add_u32 s41, s63, 8192
    buffer_load_dwordx4 v18, s[8:11], s41 offen offset:1024 nt lds
    s_add_u32 s41, s63, 16384
    buffer_load_dwordx4 v18, s[8:11], s41 offen offset:2048 nt lds
    s_add_u32 s41, s63, 24576
    buffer_load_dwordx4 v18, s[8:11], s41 offen offset:3072 nt lds
    v_lshrrev_b32 v49, 1, v48
    v_mul_u32_u24 v19, 1152, v49
    v_and_b32 v49, 1, v48
    v_lshl_add_u32 v19, v49, 4, v19
    s_mul_i32 s41, s13, 224
    s_sub_u32 s41, 1024, s41
    v_add_u32 v19, s41, v19
    v_lshrrev_b32 v49, 4, v48
    v_lshlrev_b32 v50, 2, v49
    v_and_b32 v51, 15, v48
    v_xor_b32 v51, v51, v50
    v_lshlrev_b32 v51, 4, v51
    v_lshl_add_u32 v16, v49, 15, v51
    v_lshrrev_b32 v50, 1, v49
    v_lshl_add_u32 v17, v50, 16, v51
    v_and_b32 v50, 1, v49
    v_lshl_add_u32 v17, v50, 13, v17
    s_lshl_b32 s40, s12, 8
    s_mul_i32 s58, s13, 1048576
    s_add_u32 s58, s58, s40
    s_lshr_b32 s41, s13, 1
    s_mul_i32 s59, s41, 262144
    s_and_b32 s41, s13, 1
    s_lshl_b32 s41, s41, 14
    s_add_u32 s59, s59, s41
    s_add_u32 s59, s59, s40
    s_add_u32 s59, s59, 4194304
    v_bfe_u32 v50, v48, 2, 2
    v_xor_b32 v51, s13, v50
    v_lshlrev_b32 v20, 6, v51
    v_and_b32 v51, 3, v48
    v_lshl_add_u32 v20, v51, 4, v20
    v_lshrrev_b32 v23, 2, v48
    v_lshl_add_u32 v20, v23, 8, v20
    s_xor_b32 s41, s43, 0
    v_add_u32 v24, s41, v20
    s_xor_b32 s41, s43, 4096
    v_add_u32 v25, s41, v20
    s_xor_b32 s41, s43, 8192
    v_add_u32 v26, s41, v20
    s_xor_b32 s41, s43, 12288
    v_add_u32 v27, s41, v20
    v_and_b32 v23, 1, v50
    v_lshl_add_u32 v23, v49, 2, v23
    v_lshrrev_b32 v50, 1, v50
    v_lshlrev_b32 v21, 7, v23
    v_lshl_add_u32 v21, v50, 6, v21
    v_lshrrev_b32 v16, 1, v51
    v_lshl_add_u32 v21, v16, 5, v21
    v_and_b32 v16, 1, v51
    v_lshl_add_u32 v21, v16, 3, v21
    v_add_u32 v21, s43, v21
    v_lshlrev_b32 v22, 9, v50
    v_xor_b32 v22, v22, v21
    v_lshlrev_b32 v23, 5, v23
    v_lshl_add_u32 v23, v50, 10, v23
    v_lshl_add_u32 v23, v51, 3, v23
    v_add_u32 v23, s43, v23
    v_bfe_u32 v60, v65, 4, 6
    v_and_b32 v61, 15, v60
    v_lshrrev_b32 v62, 4, v60
    v_mov_b32 v64, 0x4444
    v_mov_b32 v77, 0xeeee
    v_cmp_lt_u32 vcc, 7, v61
    s_nop 1
    v_cndmask_b32 v64, v64, v77, vcc
    v_xor_b32 v66, 1024, v65
    v_xor_b32 v67, 2048, v65
    v_xor_b32 v68, 3072, v65
    v_and_b32 v69, 511, v65
    s_mul_i32 s96, s13, 36864
    s_add_u32 s96, s96, 16384
    v_lshlrev_b32 v70, 4, v60
    v_add_u32 v70, s96, v70
    v_lshrrev_b32 v79, 1, v69
    s_lshl_b32 s96, s13, 8
    s_add_u32 s96, s96, 14336
    s_lshl_b32 s33, s13, 10
    s_add_u32 s97, s33, 8192
    v_mov_b32 v77, s97
    v_mov_b32 v78, s96
    v_cmp_lt_u32 vcc, 31, v60
    s_nop 1
    v_cndmask_b32 v71, v77, v78, vcc
    v_add_u32 v71, v71, v79
    v_and_b32 v77, 7, v61
    v_lshrrev_b32 v78, 3, v61
    v_lshlrev_b32 v74, 4, v77
    v_lshl_add_u32 v73, v62, 7, v74
    v_lshl_add_u32 v73, v78, 3, v73
    s_lshl_b32 s96, s13, 9
    v_add_u32 v73, s96, v73
    v_lshrrev_b32 v74, 1, v74
    v_lshl_add_u32 v74, v78, 14, v74
    v_lshl_add_u32 v74, v62, 15, v74
    s_lshl_b32 s96, s13, 17
    v_add_u32 v74, s96, v74
    v_bfe_u32 v77, v61, 2, 1
    v_and_b32 v78, 3, v61
    s_cmp_lt_u32 s13, 2
    s_cselect_b64 vcc, -1, 0
    v_cndmask_b32 v77, 0, v77, vcc
    v_lshlrev_b32 v75, 7, v77
    v_lshl_add_u32 v75, v62, 4, v75
    v_lshl_add_u32 v75, v78, 2, v75
    v_lshlrev_b32 v58, 3, v77
    v_lshl_add_u32 v58, v78, 1, v58
    s_bfe_u32 s97, s12, 0x10001
    s_lshl_b32 s68, s97, 6
    s_lshl_b32 s97, s97, 2
    v_add_u32 v59, s97, v62
    s_bfe_u32 s96, s12, 0x10002
    s_and_b32 s40, s12, 1
    s_lshl_b32 s96, s96, 1
    s_add_u32 s96, s96, s40
    s_lshr_b32 s97, s12, 3
    s_lshl_b32 s98, s13, 2
    s_add_u32 s98, s98, s97
    s_lshl_b32 s98, s98, 2
    s_add_u32 s98, s98, s96
    s_lshl_b32 s98, s98, 8
    s_lshl_b32 s99, s13, 2
    s_add_u32 s99, s99, s96
    s_lshl_b32 s99, s99, 4
    s_lshl_b32 s41, s97, 1
    s_add_u32 s41, s41, s40
    s_lshl_b32 s41, s41, 7
    s_add_u32 s41, s41, 8192
    s_lshl_b32 s40, s40, 3
    s_add_u32 s40, s40, 512
    s_cmp_lt_u32 s13, 2
    s_cselect_b32 s96, 7, 4
    s_cselect_b32 s98, s98, s41
    s_cselect_b32 s99, s99, s40
    s_cselect_b32 s32, 1, 0
    s_add_u32 s68, s68, s98
    s_lshl_b32 s97, s97, s96
    s_add_u32 s99, s99, s97
    v_add_u32 v58, s99, v58
    s_and_b32 s97, s12, 4
    s_or_b32 s97, s97, s13
    s_cmp_eq_u32 s97, 2
    s_cselect_b32 s32, 2, s32
    s_mov_b32 s8, s48
    s_mov_b32 s9, s49
    s_mov_b32 s10, 9216
    v_mul_u32_u24 v77, 1152, v59
    v_lshl_add_u32 v77, v58, 1, v77
    buffer_load_dword v72, v77, s[8:11], 0 offen
    s_mov_b32 s10, 4718592
    s_waitcnt vmcnt(12) lgkmcnt(0)
    s_barrier
    s_mov_b64 s[8:9], s[56:57]
    s_add_u32 m0, s43, 147456
    s_add_u32 s41, s42, 0
    buffer_load_dwordx4 v19, s[8:11], s41 offen offset:0 nt lds
    s_add_u32 s41, s42, 35840
    buffer_load_dwordx4 v19, s[8:11], s41 offen offset:1024 nt lds
    s_add_u32 s41, s42, 71680
    buffer_load_dwordx4 v19, s[8:11], s41 offen offset:2048 nt lds
    s_add_u32 s41, s42, 107520
    buffer_load_dwordx4 v19, s[8:11], s41 offen offset:3072 nt lds
    v_mov_b32 v78, v21
    v_mov_b32 v79, v22
    v_add_u32 v77, 0, v79
    ds_read_b64_tr_b16 v[80:81], v77 offset:0
    ds_read_b64_tr_b16 v[82:83], v77 offset:256
    ds_read_b64_tr_b16 v[84:85], v77 offset:2048
    ds_read_b64_tr_b16 v[86:87], v77 offset:2304
    ds_read_b64_tr_b16 v[112:113], v77 offset:16
    ds_read_b64_tr_b16 v[114:115], v77 offset:272
    ds_read_b64_tr_b16 v[116:117], v77 offset:2064
    ds_read_b64_tr_b16 v[118:119], v77 offset:2320
    s_waitcnt vmcnt(12) lgkmcnt(0)
    s_barrier
    s_mov_b64 s[8:9], s[52:53]
    s_add_u32 m0, s43, 0
    s_add_u32 s41, s58, 0
    buffer_load_dwordx4 v17, s[8:11], s41 offen offset:0 nt lds
    s_add_u32 s41, s58, 31744
    buffer_load_dwordx4 v17, s[8:11], s41 offen offset:1024 nt lds
    s_add_u32 s41, s58, 129024
    buffer_load_dwordx4 v17, s[8:11], s41 offen offset:2048 nt lds
    s_add_u32 s41, s58, 160768
    buffer_load_dwordx4 v17, s[8:11], s41 offen offset:3072 nt lds
    v_add_u32 v77, 36864, v78
    ds_read_b64_tr_b16 v[88:89], v77 offset:0
    ds_read_b64_tr_b16 v[90:91], v77 offset:256
    ds_read_b64_tr_b16 v[92:93], v77 offset:2048
    ds_read_b64_tr_b16 v[94:95], v77 offset:2304
    ds_read_b64_tr_b16 v[120:121], v77 offset:16
    ds_read_b64_tr_b16 v[122:123], v77 offset:272
    ds_read_b64_tr_b16 v[124:125], v77 offset:2064
    ds_read_b64_tr_b16 v[126:127], v77 offset:2320
    s_waitcnt vmcnt(12) lgkmcnt(0)
    s_barrier
    s_add_u32 m0, s43, 36864
    s_add_u32 s41, s58, 16384
    buffer_load_dwordx4 v17, s[8:11], s41 offen offset:0 nt lds
    s_add_u32 s41, s58, 48128
    buffer_load_dwordx4 v17, s[8:11], s41 offen offset:1024 nt lds
    s_add_u32 s41, s58, 145408
    buffer_load_dwordx4 v17, s[8:11], s41 offen offset:2048 nt lds
    s_add_u32 s41, s58, 177152
    buffer_load_dwordx4 v17, s[8:11], s41 offen offset:3072 nt lds
    v_add_u32 v77, 73728, v78
    ds_read_b64_tr_b16 v[96:97], v77 offset:0
    ds_read_b64_tr_b16 v[98:99], v77 offset:256
    ds_read_b64_tr_b16 v[100:101], v77 offset:2048
    ds_read_b64_tr_b16 v[102:103], v77 offset:2304
    ds_read_b64_tr_b16 v[128:129], v77 offset:16
    ds_read_b64_tr_b16 v[130:131], v77 offset:272
    ds_read_b64_tr_b16 v[132:133], v77 offset:2064
    ds_read_b64_tr_b16 v[134:135], v77 offset:2320
    s_waitcnt vmcnt(12) lgkmcnt(0)
    s_barrier
    s_add_u32 m0, s43, 73728
    s_add_u32 s41, s58, 262144
    buffer_load_dwordx4 v17, s[8:11], s41 offen offset:0 nt lds
    s_add_u32 s41, s58, 293888
    buffer_load_dwordx4 v17, s[8:11], s41 offen offset:1024 nt lds
    s_add_u32 s41, s58, 391168
    buffer_load_dwordx4 v17, s[8:11], s41 offen offset:2048 nt lds
    s_add_u32 s41, s58, 422912
    buffer_load_dwordx4 v17, s[8:11], s41 offen offset:3072 nt lds
    v_add_u32 v77, 110592, v78
    ds_read_b64_tr_b16 v[104:105], v77 offset:0
    ds_read_b64_tr_b16 v[106:107], v77 offset:256
    ds_read_b64_tr_b16 v[108:109], v77 offset:2048
    ds_read_b64_tr_b16 v[110:111], v77 offset:2304
    ds_read_b64_tr_b16 v[136:137], v77 offset:16
    ds_read_b64_tr_b16 v[138:139], v77 offset:272
    ds_read_b64_tr_b16 v[140:141], v77 offset:2064
    ds_read_b64_tr_b16 v[142:143], v77 offset:2320
    s_waitcnt vmcnt(12) lgkmcnt(0)
    s_barrier
    s_add_u32 m0, s43, 110592
    s_add_u32 s41, s58, 278528
    buffer_load_dwordx4 v17, s[8:11], s41 offen offset:0 nt lds
    s_add_u32 s41, s58, 310272
    buffer_load_dwordx4 v17, s[8:11], s41 offen offset:1024 nt lds
    s_add_u32 s41, s58, 407552
    buffer_load_dwordx4 v17, s[8:11], s41 offen offset:2048 nt lds
    s_add_u32 s41, s58, 439296
    buffer_load_dwordx4 v17, s[8:11], s41 offen offset:3072 nt lds
    v_add_u32 v77, 147456, v23
    ds_read_b64_tr_b16 v[0:1], v77 offset:0
    ds_read_b64_tr_b16 v[2:3], v77 offset:64
    ds_read_b64_tr_b16 v[4:5], v77 offset:512
    ds_read_b64_tr_b16 v[6:7], v77 offset:576
    ds_read_b64_tr_b16 v[8:9], v77 offset:2048
    ds_read_b64_tr_b16 v[10:11], v77 offset:2112
    ds_read_b64_tr_b16 v[12:13], v77 offset:2560
    ds_read_b64_tr_b16 v[14:15], v77 offset:2624
    s_waitcnt vmcnt(12) lgkmcnt(0)
    s_barrier
    s_add_u32 m0, s43, 147456
    s_add_u32 s41, s58, 524288
    buffer_load_dwordx4 v17, s[8:11], s41 offen offset:0 nt lds
    s_add_u32 s41, s58, 556032
    buffer_load_dwordx4 v17, s[8:11], s41 offen offset:1024 nt lds
    s_add_u32 s41, s58, 653312
    buffer_load_dwordx4 v17, s[8:11], s41 offen offset:2048 nt lds
    s_add_u32 s41, s58, 685056
    buffer_load_dwordx4 v17, s[8:11], s41 offen offset:3072 nt lds
    s_cmp_eq_u32 s32, 0
    s_cbranch_scc1 cs_init_done
    v_mov_b32 v52, 1
    v_mov_b32 v53, 1
    v_mov_b32 v54, 1
    v_mov_b32 v55, 1
    v_mov_b32 v56, 0
    s_lshl_b32 s96, s12, 14
    s_add_u32 s96, s96, 68681728
    s_add_u32 s97, s96, 0
    buffer_store_dwordx4 v[52:55], v65, s[4:7], s97 offen sc1
    s_add_u32 s97, s96, 4096
    buffer_store_dwordx4 v[52:55], v65, s[4:7], s97 offen sc1
    s_add_u32 s97, s96, 8192
    buffer_store_dwordx4 v[52:55], v65, s[4:7], s97 offen sc1
    s_add_u32 s97, s96, 12288
    buffer_store_dwordx4 v[52:55], v65, s[4:7], s97 offen sc1
    s_add_u32 s96, s68, 67633152
    s_add_u32 s97, s96, 16384
    buffer_store_dword v56, v75, s[4:7], s96 offen offset:0 sc1
    buffer_store_dword v72, v75, s[4:7], s97 offen offset:0 sc1
    s_cmp_lg_u32 s32, 2
    s_cbranch_scc1 cs_init_done
    buffer_store_dword v56, v75, s[4:7], s96 offen offset:1024 sc1
    buffer_store_dword v72, v75, s[4:7], s97 offen offset:1024 sc1
    buffer_store_dword v56, v75, s[4:7], s96 offen offset:2048 sc1
    buffer_store_dword v72, v75, s[4:7], s97 offen offset:2048 sc1
    buffer_store_dword v56, v75, s[4:7], s96 offen offset:3072 sc1
    buffer_store_dword v72, v75, s[4:7], s97 offen offset:3072 sc1
cs_init_done:
    ds_write_b64 v70, v[0:1] offset:16384
    ds_write_b64 v70, v[2:3] offset:16392
    ds_write_b64 v70, v[4:5] offset:17408
    ds_write_b64 v70, v[6:7] offset:17416
    ds_write_b64 v70, v[8:9] offset:18432
    ds_write_b64 v70, v[10:11] offset:18440
    ds_write_b64 v70, v[12:13] offset:19456
    ds_write_b64 v70, v[14:15] offset:19464
    v_add_u32 v28, 0, v24
    v_add_u32 v29, 0, v25
    v_add_u32 v30, 0, v26
    v_add_u32 v31, 0, v27
    ds_read_b64_tr_b16 a[96:97], v28 offset:0
    ds_read_b64_tr_b16 a[104:105], v28 offset:8
    ds_read_b64_tr_b16 a[112:113], v29 offset:0
    ds_read_b64_tr_b16 a[120:121], v29 offset:8
    ds_read_b64_tr_b16 a[128:129], v30 offset:0
    ds_read_b64_tr_b16 a[136:137], v30 offset:8
    ds_read_b64_tr_b16 a[144:145], v31 offset:0
    ds_read_b64_tr_b16 v[32:33], v31 offset:8
    s_waitcnt vmcnt(12) lgkmcnt(0)
    s_barrier
    s_add_u32 m0, s43, 0
    s_add_u32 s41, s58, 540672
    buffer_load_dwordx4 v17, s[8:11], s41 offen offset:0 nt lds
    s_add_u32 s41, s58, 572416
    buffer_load_dwordx4 v17, s[8:11], s41 offen offset:1024 nt lds
    s_add_u32 s41, s58, 669696
    buffer_load_dwordx4 v17, s[8:11], s41 offen offset:2048 nt lds
    s_add_u32 s41, s58, 701440
    buffer_load_dwordx4 v17, s[8:11], s41 offen offset:3072 nt lds
    ds_write_b64 v70, v[32:33] offset:12288
    v_add_u32 v28, 36864, v24
    v_add_u32 v29, 36864, v25
    v_add_u32 v30, 36864, v26
    v_add_u32 v31, 36864, v27
    ds_read_b64_tr_b16 a[98:99], v28 offset:0
    ds_read_b64_tr_b16 a[106:107], v28 offset:8
    ds_read_b64_tr_b16 a[114:115], v29 offset:0
    ds_read_b64_tr_b16 a[122:123], v29 offset:8
    ds_read_b64_tr_b16 a[130:131], v30 offset:0
    ds_read_b64_tr_b16 a[138:139], v30 offset:8
    ds_read_b64_tr_b16 a[146:147], v31 offset:0
    ds_read_b64_tr_b16 v[0:1], v31 offset:8
    s_waitcnt vmcnt(12) lgkmcnt(0)
    s_barrier
    s_add_u32 m0, s43, 36864
    s_add_u32 s41, s58, 786432
    buffer_load_dwordx4 v17, s[8:11], s41 offen offset:0 nt lds
    s_add_u32 s41, s58, 818176
    buffer_load_dwordx4 v17, s[8:11], s41 offen offset:1024 nt lds
    s_add_u32 s41, s58, 915456
    buffer_load_dwordx4 v17, s[8:11], s41 offen offset:2048 nt lds
    s_add_u32 s41, s58, 947200
    buffer_load_dwordx4 v17, s[8:11], s41 offen offset:3072 nt lds
    ds_write_b64 v70, v[0:1] offset:12296
    v_add_u32 v28, 73728, v24
    v_add_u32 v29, 73728, v25
    v_add_u32 v30, 73728, v26
    v_add_u32 v31, 73728, v27
    ds_read_b64_tr_b16 a[100:101], v28 offset:0
    ds_read_b64_tr_b16 a[108:109], v28 offset:8
    ds_read_b64_tr_b16 a[116:117], v29 offset:0
    ds_read_b64_tr_b16 a[124:125], v29 offset:8
    ds_read_b64_tr_b16 a[132:133], v30 offset:0
    ds_read_b64_tr_b16 a[140:141], v30 offset:8
    ds_read_b64_tr_b16 a[148:149], v31 offset:0
    ds_read_b64_tr_b16 v[32:33], v31 offset:8
    s_waitcnt vmcnt(12) lgkmcnt(0)
    s_barrier
    s_add_u32 m0, s43, 73728
    s_add_u32 s41, s58, 802816
    buffer_load_dwordx4 v17, s[8:11], s41 offen offset:0 nt lds
    s_add_u32 s41, s58, 834560
    buffer_load_dwordx4 v17, s[8:11], s41 offen offset:1024 nt lds
    s_add_u32 s41, s58, 931840
    buffer_load_dwordx4 v17, s[8:11], s41 offen offset:2048 nt lds
    s_add_u32 s41, s58, 963584
    buffer_load_dwordx4 v17, s[8:11], s41 offen offset:3072 nt lds
    ds_write_b64 v70, v[32:33] offset:13312
    v_add_u32 v28, 110592, v24
    v_add_u32 v29, 110592, v25
    v_add_u32 v30, 110592, v26
    v_add_u32 v31, 110592, v27
    ds_read_b64_tr_b16 a[102:103], v28 offset:0
    ds_read_b64_tr_b16 a[110:111], v28 offset:8
    ds_read_b64_tr_b16 a[118:119], v29 offset:0
    ds_read_b64_tr_b16 a[126:127], v29 offset:8
    ds_read_b64_tr_b16 a[134:135], v30 offset:0
    ds_read_b64_tr_b16 a[142:143], v30 offset:8
    ds_read_b64_tr_b16 a[150:151], v31 offset:0
    ds_read_b64_tr_b16 v[0:1], v31 offset:8
    s_waitcnt vmcnt(12) lgkmcnt(0)
    s_barrier
    s_add_u32 m0, s43, 110592
    s_add_u32 s41, s59, 0
    buffer_load_dwordx4 v17, s[8:11], s41 offen offset:0 nt lds
    s_add_u32 s41, s59, 31744
    buffer_load_dwordx4 v17, s[8:11], s41 offen offset:1024 nt lds
    s_add_u32 s41, s59, 129024
    buffer_load_dwordx4 v17, s[8:11], s41 offen offset:2048 nt lds
    s_add_u32 s41, s59, 160768
    buffer_load_dwordx4 v17, s[8:11], s41 offen offset:3072 nt lds
    ds_write_b64 v70, v[0:1] offset:13320
    v_add_u32 v28, 147456, v24
    v_add_u32 v29, 147456, v25
    v_add_u32 v30, 147456, v26
    v_add_u32 v31, 147456, v27
    ds_read_b64_tr_b16 a[152:153], v28 offset:0
    ds_read_b64_tr_b16 a[160:161], v28 offset:8
    ds_read_b64_tr_b16 a[168:169], v29 offset:0
    ds_read_b64_tr_b16 a[176:177], v29 offset:8
    ds_read_b64_tr_b16 a[184:185], v30 offset:0
    ds_read_b64_tr_b16 a[192:193], v30 offset:8
    ds_read_b64_tr_b16 a[200:201], v31 offset:0
    ds_read_b64_tr_b16 a[208:209], v31 offset:8
    s_waitcnt vmcnt(12) lgkmcnt(0)
    s_barrier
    s_mov_b64 s[8:9], s[50:51]
    s_add_u32 m0, s43, 147456
    s_add_u32 s41, s58, 0
    buffer_load_dwordx4 v17, s[8:11], s41 offen offset:0 nt lds
    s_add_u32 s41, s58, 31744
    buffer_load_dwordx4 v17, s[8:11], s41 offen offset:1024 nt lds
    s_add_u32 s41, s58, 129024
    buffer_load_dwordx4 v17, s[8:11], s41 offen offset:2048 nt lds
    s_add_u32 s41, s58, 160768
    buffer_load_dwordx4 v17, s[8:11], s41 offen offset:3072 nt lds
    v_add_u32 v28, 0, v24
    v_add_u32 v29, 0, v25
    v_add_u32 v30, 0, v26
    v_add_u32 v31, 0, v27
    ds_read_b64_tr_b16 a[154:155], v28 offset:0
    ds_read_b64_tr_b16 a[162:163], v28 offset:8
    ds_read_b64_tr_b16 a[170:171], v29 offset:0
    ds_read_b64_tr_b16 a[178:179], v29 offset:8
    ds_read_b64_tr_b16 a[186:187], v30 offset:0
    ds_read_b64_tr_b16 a[194:195], v30 offset:8
    ds_read_b64_tr_b16 a[202:203], v31 offset:0
    ds_read_b64_tr_b16 a[210:211], v31 offset:8
    s_waitcnt vmcnt(12) lgkmcnt(0)
    s_barrier
    s_add_u32 m0, s43, 0
    s_add_u32 s41, s58, 16384
    buffer_load_dwordx4 v17, s[8:11], s41 offen offset:0 nt lds
    s_add_u32 s41, s58, 48128
    buffer_load_dwordx4 v17, s[8:11], s41 offen offset:1024 nt lds
    s_add_u32 s41, s58, 145408
    buffer_load_dwordx4 v17, s[8:11], s41 offen offset:2048 nt lds
    s_add_u32 s41, s58, 177152
    buffer_load_dwordx4 v17, s[8:11], s41 offen offset:3072 nt lds
    v_add_u32 v28, 36864, v24
    v_add_u32 v29, 36864, v25
    v_add_u32 v30, 36864, v26
    v_add_u32 v31, 36864, v27
    ds_read_b64_tr_b16 a[156:157], v28 offset:0
    ds_read_b64_tr_b16 a[164:165], v28 offset:8
    ds_read_b64_tr_b16 a[172:173], v29 offset:0
    ds_read_b64_tr_b16 a[180:181], v29 offset:8
    ds_read_b64_tr_b16 a[188:189], v30 offset:0
    ds_read_b64_tr_b16 a[196:197], v30 offset:8
    ds_read_b64_tr_b16 a[204:205], v31 offset:0
    ds_read_b64_tr_b16 a[212:213], v31 offset:8
    s_waitcnt vmcnt(12) lgkmcnt(0)
    s_barrier
    s_add_u32 m0, s43, 36864
    s_add_u32 s41, s58, 262144
    buffer_load_dwordx4 v17, s[8:11], s41 offen offset:0 nt lds
    s_add_u32 s41, s58, 293888
    buffer_load_dwordx4 v17, s[8:11], s41 offen offset:1024 nt lds
    s_add_u32 s41, s58, 391168
    buffer_load_dwordx4 v17, s[8:11], s41 offen offset:2048 nt lds
    s_add_u32 s41, s58, 422912
    buffer_load_dwordx4 v17, s[8:11], s41 offen offset:3072 nt lds
    v_add_u32 v28, 73728, v24
    v_add_u32 v29, 73728, v25
    v_add_u32 v30, 73728, v26
    v_add_u32 v31, 73728, v27
    ds_read_b64_tr_b16 a[158:159], v28 offset:0
    ds_read_b64_tr_b16 a[166:167], v28 offset:8
    ds_read_b64_tr_b16 a[174:175], v29 offset:0
    ds_read_b64_tr_b16 a[182:183], v29 offset:8
    ds_read_b64_tr_b16 a[190:191], v30 offset:0
    ds_read_b64_tr_b16 a[198:199], v30 offset:8
    ds_read_b64_tr_b16 a[206:207], v31 offset:0
    ds_read_b64_tr_b16 a[214:215], v31 offset:8
    s_waitcnt vmcnt(12) lgkmcnt(0)
    s_barrier
    s_add_u32 m0, s43, 73728
    s_add_u32 s41, s58, 278528
    buffer_load_dwordx4 v17, s[8:11], s41 offen offset:0 nt lds
    s_add_u32 s41, s58, 310272
    buffer_load_dwordx4 v17, s[8:11], s41 offen offset:1024 nt lds
    s_add_u32 s41, s58, 407552
    buffer_load_dwordx4 v17, s[8:11], s41 offen offset:2048 nt lds
    s_add_u32 s41, s58, 439296
    buffer_load_dwordx4 v17, s[8:11], s41 offen offset:3072 nt lds
    v_add_u32 v77, 110592, v20
    ds_read_b64_tr_b16 a[216:217], v77 offset:0
    ds_read_b64_tr_b16 a[218:219], v77 offset:4096
    ds_read_b64_tr_b16 a[220:221], v77 offset:8192
    ds_read_b64_tr_b16 a[222:223], v77 offset:12288
    ds_read_b64_tr_b16 a[224:225], v77 offset:8
    ds_read_b64_tr_b16 a[226:227], v77 offset:4104
    ds_read_b64_tr_b16 a[228:229], v77 offset:8200
    ds_read_b64_tr_b16 a[230:231], v77 offset:12296
    s_waitcnt vmcnt(12) lgkmcnt(0)
    s_barrier
    s_add_u32 m0, s43, 110592
    s_add_u32 s41, s58, 524288
    buffer_load_dwordx4 v17, s[8:11], s41 offen offset:0 nt lds
    s_add_u32 s41, s58, 556032
    buffer_load_dwordx4 v17, s[8:11], s41 offen offset:1024 nt lds
    s_add_u32 s41, s58, 653312
    buffer_load_dwordx4 v17, s[8:11], s41 offen offset:2048 nt lds
    s_add_u32 s41, s58, 685056
    buffer_load_dwordx4 v17, s[8:11], s41 offen offset:3072 nt lds
    v_add_u32 v28, 147456, v24
    v_add_u32 v29, 147456, v25
    v_add_u32 v30, 147456, v26
    v_add_u32 v31, 147456, v27
    ds_read_b64_tr_b16 v[0:1], v28 offset:0
    ds_read_b64_tr_b16 v[2:3], v28 offset:8
    ds_read_b64_tr_b16 v[4:5], v29 offset:0
    ds_read_b64_tr_b16 v[6:7], v29 offset:8
    ds_read_b64_tr_b16 a[0:1], v30 offset:0
    ds_read_b64_tr_b16 v[8:9], v30 offset:8
    ds_read_b64_tr_b16 a[8:9], v31 offset:0
    ds_read_b64_tr_b16 v[10:11], v31 offset:8
    s_waitcnt vmcnt(12) lgkmcnt(0)
    s_barrier
    s_add_u32 m0, s43, 147456
    s_add_u32 s41, s58, 540672
    buffer_load_dwordx4 v17, s[8:11], s41 offen offset:0 nt lds
    s_add_u32 s41, s58, 572416
    buffer_load_dwordx4 v17, s[8:11], s41 offen offset:1024 nt lds
    s_add_u32 s41, s58, 669696
    buffer_load_dwordx4 v17, s[8:11], s41 offen offset:2048 nt lds
    s_add_u32 s41, s58, 701440
    buffer_load_dwordx4 v17, s[8:11], s41 offen offset:3072 nt lds
    ds_write_b64 v70, v[0:1] offset:0
    ds_write_b64 v70, v[2:3] offset:2048
    ds_write_b64 v70, v[4:5] offset:4096
    ds_write_b64 v70, v[6:7] offset:6144
    ds_write_b64 v70, v[8:9] offset:10240
    ds_write_b64 v70, v[10:11] offset:14336
    v_add_u32 v28, 0, v24
    v_add_u32 v29, 0, v25
    v_add_u32 v30, 0, v26
    v_add_u32 v31, 0, v27
    ds_read_b64_tr_b16 v[32:33], v28 offset:0
    ds_read_b64_tr_b16 v[34:35], v28 offset:8
    ds_read_b64_tr_b16 v[36:37], v29 offset:0
    ds_read_b64_tr_b16 v[38:39], v29 offset:8
    ds_read_b64_tr_b16 a[2:3], v30 offset:0
    ds_read_b64_tr_b16 v[40:41], v30 offset:8
    ds_read_b64_tr_b16 a[10:11], v31 offset:0
    ds_read_b64_tr_b16 v[42:43], v31 offset:8
    s_waitcnt vmcnt(12) lgkmcnt(0)
    s_barrier
    s_add_u32 m0, s43, 0
    s_add_u32 s41, s58, 786432
    buffer_load_dwordx4 v17, s[8:11], s41 offen offset:0 nt lds
    s_add_u32 s41, s58, 818176
    buffer_load_dwordx4 v17, s[8:11], s41 offen offset:1024 nt lds
    s_add_u32 s41, s58, 915456
    buffer_load_dwordx4 v17, s[8:11], s41 offen offset:2048 nt lds
    s_add_u32 s41, s58, 947200
    buffer_load_dwordx4 v17, s[8:11], s41 offen offset:3072 nt lds
    ds_write_b64 v70, v[32:33] offset:8
    ds_write_b64 v70, v[34:35] offset:2056
    ds_write_b64 v70, v[36:37] offset:4104
    ds_write_b64 v70, v[38:39] offset:6152
    ds_write_b64 v70, v[40:41] offset:10248
    ds_write_b64 v70, v[42:43] offset:14344
    v_add_u32 v28, 36864, v24
    v_add_u32 v29, 36864, v25
    v_add_u32 v30, 36864, v26
    v_add_u32 v31, 36864, v27
    ds_read_b64_tr_b16 v[0:1], v28 offset:0
    ds_read_b64_tr_b16 v[2:3], v28 offset:8
    ds_read_b64_tr_b16 v[4:5], v29 offset:0
    ds_read_b64_tr_b16 v[6:7], v29 offset:8
    ds_read_b64_tr_b16 a[4:5], v30 offset:0
    ds_read_b64_tr_b16 v[8:9], v30 offset:8
    ds_read_b64_tr_b16 a[12:13], v31 offset:0
    ds_read_b64_tr_b16 v[10:11], v31 offset:8
    s_waitcnt vmcnt(12) lgkmcnt(0)
    s_barrier
    s_add_u32 m0, s43, 36864
    s_add_u32 s41, s58, 802816
    buffer_load_dwordx4 v17, s[8:11], s41 offen offset:0 nt lds
    s_add_u32 s41, s58, 834560
    buffer_load_dwordx4 v17, s[8:11], s41 offen offset:1024 nt lds
    s_add_u32 s41, s58, 931840
    buffer_load_dwordx4 v17, s[8:11], s41 offen offset:2048 nt lds
    s_add_u32 s41, s58, 963584
    buffer_load_dwordx4 v17, s[8:11], s41 offen offset:3072 nt lds
    ds_write_b64 v70, v[0:1] offset:1024
    ds_write_b64 v70, v[2:3] offset:3072
    ds_write_b64 v70, v[4:5] offset:5120
    ds_write_b64 v70, v[6:7] offset:7168
    ds_write_b64 v70, v[8:9] offset:11264
    ds_write_b64 v70, v[10:11] offset:15360
    v_add_u32 v28, 73728, v24
    v_add_u32 v29, 73728, v25
    v_add_u32 v30, 73728, v26
    v_add_u32 v31, 73728, v27
    ds_read_b64_tr_b16 v[32:33], v28 offset:0
    ds_read_b64_tr_b16 v[34:35], v28 offset:8
    ds_read_b64_tr_b16 v[36:37], v29 offset:0
    ds_read_b64_tr_b16 v[38:39], v29 offset:8
    ds_read_b64_tr_b16 a[6:7], v30 offset:0
    ds_read_b64_tr_b16 v[40:41], v30 offset:8
    ds_read_b64_tr_b16 a[14:15], v31 offset:0
    ds_read_b64_tr_b16 v[42:43], v31 offset:8
    s_waitcnt vmcnt(12) lgkmcnt(0)
    s_barrier
    s_add_u32 m0, s43, 73728
    s_add_u32 s41, s59, 0
    buffer_load_dwordx4 v17, s[8:11], s41 offen offset:0 nt lds
    s_add_u32 s41, s59, 31744
    buffer_load_dwordx4 v17, s[8:11], s41 offen offset:1024 nt lds
    s_add_u32 s41, s59, 129024
    buffer_load_dwordx4 v17, s[8:11], s41 offen offset:2048 nt lds
    s_add_u32 s41, s59, 160768
    buffer_load_dwordx4 v17, s[8:11], s41 offen offset:3072 nt lds
    ds_write_b64 v70, v[32:33] offset:1032
    ds_write_b64 v70, v[34:35] offset:3080
    ds_write_b64 v70, v[36:37] offset:5128
    ds_write_b64 v70, v[38:39] offset:7176
    ds_write_b64 v70, v[40:41] offset:11272
    ds_write_b64 v70, v[42:43] offset:15368
    v_add_u32 v28, 110592, v24
    v_add_u32 v29, 110592, v25
    v_add_u32 v30, 110592, v26
    v_add_u32 v31, 110592, v27
    ds_read_b64_tr_b16 a[16:17], v28 offset:0
    ds_read_b64_tr_b16 a[24:25], v28 offset:8
    ds_read_b64_tr_b16 a[32:33], v29 offset:0
    ds_read_b64_tr_b16 a[40:41], v29 offset:8
    ds_read_b64_tr_b16 a[48:49], v30 offset:0
    ds_read_b64_tr_b16 a[56:57], v30 offset:8
    ds_read_b64_tr_b16 a[64:65], v31 offset:0
    ds_read_b64_tr_b16 a[72:73], v31 offset:8
    s_waitcnt vmcnt(12) lgkmcnt(0)
    s_barrier
    s_mov_b64 s[8:9], s[54:55]
    s_add_u32 m0, s43, 110592
    s_add_u32 s41, s58, 0
    buffer_load_dwordx4 v17, s[8:11], s41 offen offset:0 nt lds
    s_add_u32 s41, s58, 31744
    buffer_load_dwordx4 v17, s[8:11], s41 offen offset:1024 nt lds
    s_add_u32 s41, s58, 129024
    buffer_load_dwordx4 v17, s[8:11], s41 offen offset:2048 nt lds
    s_add_u32 s41, s58, 160768
    buffer_load_dwordx4 v17, s[8:11], s41 offen offset:3072 nt lds
    v_add_u32 v28, 147456, v24
    v_add_u32 v29, 147456, v25
    v_add_u32 v30, 147456, v26
    v_add_u32 v31, 147456, v27
    ds_read_b64_tr_b16 a[18:19], v28 offset:0
    ds_read_b64_tr_b16 a[26:27], v28 offset:8
    ds_read_b64_tr_b16 a[34:35], v29 offset:0
    ds_read_b64_tr_b16 a[42:43], v29 offset:8
    ds_read_b64_tr_b16 a[50:51], v30 offset:0
    ds_read_b64_tr_b16 a[58:59], v30 offset:8
    ds_read_b64_tr_b16 a[66:67], v31 offset:0
    ds_read_b64_tr_b16 a[74:75], v31 offset:8
    s_waitcnt vmcnt(12) lgkmcnt(0)
    s_barrier
    s_add_u32 m0, s43, 147456
    s_add_u32 s41, s58, 16384
    buffer_load_dwordx4 v17, s[8:11], s41 offen offset:0 nt lds
    s_add_u32 s41, s58, 48128
    buffer_load_dwordx4 v17, s[8:11], s41 offen offset:1024 nt lds
    s_add_u32 s41, s58, 145408
    buffer_load_dwordx4 v17, s[8:11], s41 offen offset:2048 nt lds
    s_add_u32 s41, s58, 177152
    buffer_load_dwordx4 v17, s[8:11], s41 offen offset:3072 nt lds
    v_add_u32 v28, 0, v24
    v_add_u32 v29, 0, v25
    v_add_u32 v30, 0, v26
    v_add_u32 v31, 0, v27
    ds_read_b64_tr_b16 a[20:21], v28 offset:0
    ds_read_b64_tr_b16 a[28:29], v28 offset:8
    ds_read_b64_tr_b16 a[36:37], v29 offset:0
    ds_read_b64_tr_b16 a[44:45], v29 offset:8
    ds_read_b64_tr_b16 a[52:53], v30 offset:0
    ds_read_b64_tr_b16 a[60:61], v30 offset:8
    ds_read_b64_tr_b16 a[68:69], v31 offset:0
    ds_read_b64_tr_b16 a[76:77], v31 offset:8
    s_waitcnt vmcnt(12) lgkmcnt(0)
    s_barrier
    s_add_u32 m0, s43, 0
    s_add_u32 s41, s58, 262144
    buffer_load_dwordx4 v17, s[8:11], s41 offen offset:0 nt lds
    s_add_u32 s41, s58, 293888
    buffer_load_dwordx4 v17, s[8:11], s41 offen offset:1024 nt lds
    s_add_u32 s41, s58, 391168
    buffer_load_dwordx4 v17, s[8:11], s41 offen offset:2048 nt lds
    s_add_u32 s41, s58, 422912
    buffer_load_dwordx4 v17, s[8:11], s41 offen offset:3072 nt lds
    v_add_u32 v28, 36864, v24
    v_add_u32 v29, 36864, v25
    v_add_u32 v30, 36864, v26
    v_add_u32 v31, 36864, v27
    ds_read_b64_tr_b16 a[22:23], v28 offset:0
    ds_read_b64_tr_b16 a[30:31], v28 offset:8
    ds_read_b64_tr_b16 a[38:39], v29 offset:0
    ds_read_b64_tr_b16 a[46:47], v29 offset:8
    ds_read_b64_tr_b16 a[54:55], v30 offset:0
    ds_read_b64_tr_b16 a[62:63], v30 offset:8
    ds_read_b64_tr_b16 a[70:71], v31 offset:0
    ds_read_b64_tr_b16 a[78:79], v31 offset:8
    s_waitcnt vmcnt(12) lgkmcnt(0)
    s_barrier
    s_add_u32 m0, s43, 36864
    s_add_u32 s41, s58, 278528
    buffer_load_dwordx4 v17, s[8:11], s41 offen offset:0 nt lds
    s_add_u32 s41, s58, 310272
    buffer_load_dwordx4 v17, s[8:11], s41 offen offset:1024 nt lds
    s_add_u32 s41, s58, 407552
    buffer_load_dwordx4 v17, s[8:11], s41 offen offset:2048 nt lds
    s_add_u32 s41, s58, 439296
    buffer_load_dwordx4 v17, s[8:11], s41 offen offset:3072 nt lds
    v_add_u32 v77, 73728, v20
    ds_read_b64_tr_b16 a[80:81], v77 offset:0
    ds_read_b64_tr_b16 a[82:83], v77 offset:4096
    ds_read_b64_tr_b16 a[84:85], v77 offset:8192
    ds_read_b64_tr_b16 a[86:87], v77 offset:12288
    ds_read_b64_tr_b16 a[88:89], v77 offset:8
    ds_read_b64_tr_b16 a[90:91], v77 offset:4104
    ds_read_b64_tr_b16 a[92:93], v77 offset:8200
    ds_read_b64_tr_b16 a[94:95], v77 offset:12296
    s_waitcnt vmcnt(12) lgkmcnt(0)
    s_barrier
    s_add_u32 m0, s43, 73728
    s_add_u32 s41, s58, 524288
    buffer_load_dwordx4 v17, s[8:11], s41 offen offset:0 nt lds
    s_add_u32 s41, s58, 556032
    buffer_load_dwordx4 v17, s[8:11], s41 offen offset:1024 nt lds
    s_add_u32 s41, s58, 653312
    buffer_load_dwordx4 v17, s[8:11], s41 offen offset:2048 nt lds
    s_add_u32 s41, s58, 685056
    buffer_load_dwordx4 v17, s[8:11], s41 offen offset:3072 nt lds
    v_add_u32 v28, 110592, v24
    v_add_u32 v29, 110592, v25
    v_add_u32 v30, 110592, v26
    v_add_u32 v31, 110592, v27
    ds_read_b64_tr_b16 a[232:233], v28 offset:0
    ds_read_b64_tr_b16 v[32:33], v28 offset:8
    ds_read_b64_tr_b16 a[240:241], v29 offset:0
    ds_read_b64_tr_b16 a[248:249], v29 offset:8
    ds_read_b64_tr_b16 v[144:145], v30 offset:0
    ds_read_b64_tr_b16 v[152:153], v30 offset:8
    ds_read_b64_tr_b16 v[160:161], v31 offset:0
    ds_read_b64_tr_b16 v[168:169], v31 offset:8
    s_waitcnt vmcnt(12) lgkmcnt(0)
    s_barrier
    s_add_u32 m0, s43, 110592
    s_add_u32 s41, s58, 540672
    buffer_load_dwordx4 v17, s[8:11], s41 offen offset:0 nt lds
    s_add_u32 s41, s58, 572416
    buffer_load_dwordx4 v17, s[8:11], s41 offen offset:1024 nt lds
    s_add_u32 s41, s58, 669696
    buffer_load_dwordx4 v17, s[8:11], s41 offen offset:2048 nt lds
    s_add_u32 s41, s58, 701440
    buffer_load_dwordx4 v17, s[8:11], s41 offen offset:3072 nt lds
    ds_write_b64 v70, v[32:33] offset:8192
    v_add_u32 v28, 147456, v24
    v_add_u32 v29, 147456, v25
    v_add_u32 v30, 147456, v26
    v_add_u32 v31, 147456, v27
    ds_read_b64_tr_b16 a[234:235], v28 offset:0
    ds_read_b64_tr_b16 v[0:1], v28 offset:8
    ds_read_b64_tr_b16 a[242:243], v29 offset:0
    ds_read_b64_tr_b16 a[250:251], v29 offset:8
    ds_read_b64_tr_b16 v[146:147], v30 offset:0
    ds_read_b64_tr_b16 v[154:155], v30 offset:8
    ds_read_b64_tr_b16 v[162:163], v31 offset:0
    ds_read_b64_tr_b16 v[170:171], v31 offset:8
    s_waitcnt vmcnt(12) lgkmcnt(0)
    s_barrier
    s_add_u32 m0, s43, 147456
    s_add_u32 s41, s58, 786432
    buffer_load_dwordx4 v17, s[8:11], s41 offen offset:0 nt lds
    s_add_u32 s41, s58, 818176
    buffer_load_dwordx4 v17, s[8:11], s41 offen offset:1024 nt lds
    s_add_u32 s41, s58, 915456
    buffer_load_dwordx4 v17, s[8:11], s41 offen offset:2048 nt lds
    s_add_u32 s41, s58, 947200
    buffer_load_dwordx4 v17, s[8:11], s41 offen offset:3072 nt lds
    ds_write_b64 v70, v[0:1] offset:8200
    v_add_u32 v28, 0, v24
    v_add_u32 v29, 0, v25
    v_add_u32 v30, 0, v26
    v_add_u32 v31, 0, v27
    ds_read_b64_tr_b16 a[236:237], v28 offset:0
    ds_read_b64_tr_b16 v[32:33], v28 offset:8
    ds_read_b64_tr_b16 a[244:245], v29 offset:0
    ds_read_b64_tr_b16 a[252:253], v29 offset:8
    ds_read_b64_tr_b16 v[148:149], v30 offset:0
    ds_read_b64_tr_b16 v[156:157], v30 offset:8
    ds_read_b64_tr_b16 v[164:165], v31 offset:0
    ds_read_b64_tr_b16 v[172:173], v31 offset:8
    s_waitcnt vmcnt(12) lgkmcnt(0)
    s_barrier
    s_add_u32 m0, s43, 0
    s_add_u32 s41, s58, 802816
    buffer_load_dwordx4 v17, s[8:11], s41 offen offset:0 nt lds
    s_add_u32 s41, s58, 834560
    buffer_load_dwordx4 v17, s[8:11], s41 offen offset:1024 nt lds
    s_add_u32 s41, s58, 931840
    buffer_load_dwordx4 v17, s[8:11], s41 offen offset:2048 nt lds
    s_add_u32 s41, s58, 963584
    buffer_load_dwordx4 v17, s[8:11], s41 offen offset:3072 nt lds
    ds_write_b64 v70, v[32:33] offset:9216
    v_add_u32 v28, 36864, v24
    v_add_u32 v29, 36864, v25
    v_add_u32 v30, 36864, v26
    v_add_u32 v31, 36864, v27
    ds_read_b64_tr_b16 a[238:239], v28 offset:0
    ds_read_b64_tr_b16 v[0:1], v28 offset:8
    ds_read_b64_tr_b16 a[246:247], v29 offset:0
    ds_read_b64_tr_b16 a[254:255], v29 offset:8
    ds_read_b64_tr_b16 v[150:151], v30 offset:0
    ds_read_b64_tr_b16 v[158:159], v30 offset:8
    ds_read_b64_tr_b16 v[166:167], v31 offset:0
    ds_read_b64_tr_b16 v[174:175], v31 offset:8
    s_waitcnt vmcnt(12) lgkmcnt(0)
    s_barrier
    s_add_u32 m0, s43, 36864
    s_add_u32 s41, s59, 0
    buffer_load_dwordx4 v17, s[8:11], s41 offen offset:0 nt lds
    s_add_u32 s41, s59, 31744
    buffer_load_dwordx4 v17, s[8:11], s41 offen offset:1024 nt lds
    s_add_u32 s41, s59, 129024
    buffer_load_dwordx4 v17, s[8:11], s41 offen offset:2048 nt lds
    s_add_u32 s41, s59, 160768
    buffer_load_dwordx4 v17, s[8:11], s41 offen offset:3072 nt lds
    ds_write_b64 v70, v[0:1] offset:9224
    v_add_u32 v28, 73728, v24
    v_add_u32 v29, 73728, v25
    v_add_u32 v30, 73728, v26
    v_add_u32 v31, 73728, v27
    ds_read_b64_tr_b16 v[176:177], v28 offset:0
    ds_read_b64_tr_b16 v[184:185], v28 offset:8
    ds_read_b64_tr_b16 v[192:193], v29 offset:0
    ds_read_b64_tr_b16 v[200:201], v29 offset:8
    ds_read_b64_tr_b16 v[208:209], v30 offset:0
    ds_read_b64_tr_b16 v[216:217], v30 offset:8
    ds_read_b64_tr_b16 v[224:225], v31 offset:0
    ds_read_b64_tr_b16 v[232:233], v31 offset:8
    s_waitcnt vmcnt(12) lgkmcnt(0)
    s_barrier
    s_mov_b64 s[8:9], s[56:57]
    s_add_u32 m0, s43, 73728
    s_add_u32 s41, s60, 128
    buffer_load_dwordx4 v18, s[8:11], s41 offen offset:0 nt lds
    s_add_u32 s41, s60, 8320
    buffer_load_dwordx4 v18, s[8:11], s41 offen offset:1024 nt lds
    s_add_u32 s41, s60, 16512
    buffer_load_dwordx4 v18, s[8:11], s41 offen offset:2048 nt lds
    s_add_u32 s41, s60, 24704
    buffer_load_dwordx4 v18, s[8:11], s41 offen offset:3072 nt lds
    v_add_u32 v28, 110592, v24
    v_add_u32 v29, 110592, v25
    v_add_u32 v30, 110592, v26
    v_add_u32 v31, 110592, v27
    ds_read_b64_tr_b16 v[178:179], v28 offset:0
    ds_read_b64_tr_b16 v[186:187], v28 offset:8
    ds_read_b64_tr_b16 v[194:195], v29 offset:0
    ds_read_b64_tr_b16 v[202:203], v29 offset:8
    ds_read_b64_tr_b16 v[210:211], v30 offset:0
    ds_read_b64_tr_b16 v[218:219], v30 offset:8
    ds_read_b64_tr_b16 v[226:227], v31 offset:0
    ds_read_b64_tr_b16 v[234:235], v31 offset:8
    s_waitcnt vmcnt(12) lgkmcnt(0)
    s_barrier
    s_add_u32 m0, s43, 110592
    s_add_u32 s41, s61, 128
    buffer_load_dwordx4 v18, s[8:11], s41 offen offset:0 nt lds
    s_add_u32 s41, s61, 8320
    buffer_load_dwordx4 v18, s[8:11], s41 offen offset:1024 nt lds
    s_add_u32 s41, s61, 16512
    buffer_load_dwordx4 v18, s[8:11], s41 offen offset:2048 nt lds
    s_add_u32 s41, s61, 24704
    buffer_load_dwordx4 v18, s[8:11], s41 offen offset:3072 nt lds
    v_add_u32 v28, 147456, v24
    v_add_u32 v29, 147456, v25
    v_add_u32 v30, 147456, v26
    v_add_u32 v31, 147456, v27
    ds_read_b64_tr_b16 v[180:181], v28 offset:0
    ds_read_b64_tr_b16 v[188:189], v28 offset:8
    ds_read_b64_tr_b16 v[196:197], v29 offset:0
    ds_read_b64_tr_b16 v[204:205], v29 offset:8
    ds_read_b64_tr_b16 v[212:213], v30 offset:0
    ds_read_b64_tr_b16 v[220:221], v30 offset:8
    ds_read_b64_tr_b16 v[228:229], v31 offset:0
    ds_read_b64_tr_b16 v[236:237], v31 offset:8
    s_waitcnt vmcnt(12) lgkmcnt(0)
    s_barrier
    s_add_u32 m0, s43, 147456
    s_add_u32 s41, s62, 128
    buffer_load_dwordx4 v18, s[8:11], s41 offen offset:0 nt lds
    s_add_u32 s41, s62, 8320
    buffer_load_dwordx4 v18, s[8:11], s41 offen offset:1024 nt lds
    s_add_u32 s41, s62, 16512
    buffer_load_dwordx4 v18, s[8:11], s41 offen offset:2048 nt lds
    s_add_u32 s41, s62, 24704
    buffer_load_dwordx4 v18, s[8:11], s41 offen offset:3072 nt lds
    v_add_u32 v28, 0, v24
    v_add_u32 v29, 0, v25
    v_add_u32 v30, 0, v26
    v_add_u32 v31, 0, v27
    ds_read_b64_tr_b16 v[182:183], v28 offset:0
    ds_read_b64_tr_b16 v[190:191], v28 offset:8
    ds_read_b64_tr_b16 v[198:199], v29 offset:0
    ds_read_b64_tr_b16 v[206:207], v29 offset:8
    ds_read_b64_tr_b16 v[214:215], v30 offset:0
    ds_read_b64_tr_b16 v[222:223], v30 offset:8
    ds_read_b64_tr_b16 v[230:231], v31 offset:0
    ds_read_b64_tr_b16 v[238:239], v31 offset:8
    s_waitcnt vmcnt(12) lgkmcnt(0)
    s_barrier
    s_add_u32 m0, s43, 0
    s_add_u32 s41, s63, 128
    buffer_load_dwordx4 v18, s[8:11], s41 offen offset:0 nt lds
    s_add_u32 s41, s63, 8320
    buffer_load_dwordx4 v18, s[8:11], s41 offen offset:1024 nt lds
    s_add_u32 s41, s63, 16512
    buffer_load_dwordx4 v18, s[8:11], s41 offen offset:2048 nt lds
    s_add_u32 s41, s63, 24704
    buffer_load_dwordx4 v18, s[8:11], s41 offen offset:3072 nt lds
    v_mov_b32 v78, v21
    v_mov_b32 v79, v22
    v_add_u32 v77, 36864, v20
    ds_read_b64_tr_b16 v[240:241], v77 offset:0
    ds_read_b64_tr_b16 v[242:243], v77 offset:4096
    ds_read_b64_tr_b16 v[244:245], v77 offset:8192
    ds_read_b64_tr_b16 v[246:247], v77 offset:12288
    ds_read_b64_tr_b16 v[248:249], v77 offset:8
    ds_read_b64_tr_b16 v[250:251], v77 offset:4104
    ds_read_b64_tr_b16 v[252:253], v77 offset:8200
    ds_read_b64_tr_b16 v[254:255], v77 offset:12296
    s_waitcnt vmcnt(12) lgkmcnt(0)
    s_barrier
    v_add_u32 v77, 73728, v79
    s_waitcnt lgkmcnt(0)
    ds_read_b64_tr_b16 v[0:1], v77 offset:0
    ds_read_b64_tr_b16 v[2:3], v77 offset:256
    ds_read_b64_tr_b16 v[4:5], v77 offset:2048
    ds_read_b64_tr_b16 v[6:7], v77 offset:2304
    ds_read_b64_tr_b16 v[8:9], v77 offset:16
    ds_read_b64_tr_b16 v[10:11], v77 offset:272
    ds_read_b64_tr_b16 v[12:13], v77 offset:2064
    ds_read_b64_tr_b16 v[14:15], v77 offset:2320
    s_waitcnt vmcnt(8) lgkmcnt(0)
    s_barrier
    v_add_u32 v77, 110592, v78
    ds_read_b64_tr_b16 v[16:17], v77 offset:0
    ds_read_b64_tr_b16 v[18:19], v77 offset:256
    ds_read_b64_tr_b16 v[20:21], v77 offset:2048
    ds_read_b64_tr_b16 v[22:23], v77 offset:2304
    ds_read_b64_tr_b16 v[24:25], v77 offset:16
    ds_read_b64_tr_b16 v[26:27], v77 offset:272
    ds_read_b64_tr_b16 v[28:29], v77 offset:2064
    ds_read_b64_tr_b16 v[30:31], v77 offset:2320
    s_waitcnt vmcnt(4) lgkmcnt(0)
    s_barrier
    v_add_u32 v77, 147456, v78
    ds_read_b64_tr_b16 v[32:33], v77 offset:0
    ds_read_b64_tr_b16 v[34:35], v77 offset:256
    ds_read_b64_tr_b16 v[36:37], v77 offset:2048
    ds_read_b64_tr_b16 v[38:39], v77 offset:2304
    ds_read_b64_tr_b16 v[40:41], v77 offset:16
    ds_read_b64_tr_b16 v[42:43], v77 offset:272
    ds_read_b64_tr_b16 v[44:45], v77 offset:2064
    ds_read_b64_tr_b16 v[46:47], v77 offset:2320
    s_waitcnt vmcnt(0) lgkmcnt(0)
    s_barrier
    v_add_u32 v77, 0, v78
    ds_read_b64_tr_b16 v[48:49], v77 offset:0
    ds_read_b64_tr_b16 v[50:51], v77 offset:256
    ds_read_b64_tr_b16 v[52:53], v77 offset:2048
    ds_read_b64_tr_b16 v[54:55], v77 offset:2304
    ds_read_b64_tr_b16 v[56:57], v77 offset:16
    ds_read_b64_tr_b16 v[58:59], v77 offset:272
    ds_read_b64_tr_b16 v[60:61], v77 offset:2064
    ds_read_b64_tr_b16 v[62:63], v77 offset:2320
    s_waitcnt lgkmcnt(0)
    s_barrier
    ds_write_b128 v70, v[0:3] offset:20480
    ds_write_b128 v70, v[4:7] offset:21504
    ds_write_b128 v70, v[8:11] offset:22528
    ds_write_b128 v70, v[12:15] offset:23552
    ds_write_b128 v70, v[16:19] offset:24576
    ds_write_b128 v70, v[20:23] offset:25600
    ds_write_b128 v70, v[24:27] offset:26624
    ds_write_b128 v70, v[28:31] offset:27648
    ds_write_b128 v70, v[32:35] offset:28672
    ds_write_b128 v70, v[36:39] offset:29696
    ds_write_b128 v70, v[40:43] offset:30720
    ds_write_b128 v70, v[44:47] offset:31744
    ds_write_b128 v70, v[48:51] offset:32768
    ds_write_b128 v70, v[52:55] offset:33792
    ds_write_b128 v70, v[56:59] offset:34816
    ds_write_b128 v70, v[60:63] offset:35840
    s_waitcnt lgkmcnt(0)
    v_bfe_u32 v60, v65, 4, 6
    v_and_b32 v61, 15, v60
    v_lshrrev_b32 v62, 4, v60
    v_mov_b32 v50, 0x3f80
    v_mov_b32 v51, 0x3f800000
    v_and_b32 v77, 1, v62
    v_lshlrev_b32 v77, 2, v77
    v_sub_u32 v77, v61, v77
    v_and_b32 v78, 3, v61
    v_lshlrev_b32 v78, 2, v78
    v_lshrrev_b32 v79, 2, v61
    v_add_u32 v78, v78, v79
    v_cmp_eq_u32 vcc, 0, v77
    s_nop 1
    v_cndmask_b32 v8, 0, v50, vcc
    v_cmp_eq_u32 vcc, 1, v77
    s_nop 1
    v_cndmask_b32 v8, v8, v51, vcc
    v_cmp_eq_u32 vcc, 0, v78
    s_nop 1
    v_cndmask_b32 v12, 0, v50, vcc
    v_cmp_eq_u32 vcc, 1, v78
    s_nop 1
    v_cndmask_b32 v12, v12, v51, vcc
    v_cmp_eq_u32 vcc, 2, v77
    s_nop 1
    v_cndmask_b32 v9, 0, v50, vcc
    v_cmp_eq_u32 vcc, 3, v77
    s_nop 1
    v_cndmask_b32 v9, v9, v51, vcc
    v_cmp_eq_u32 vcc, 2, v78
    s_nop 1
    v_cndmask_b32 v13, 0, v50, vcc
    v_cmp_eq_u32 vcc, 3, v78
    s_nop 1
    v_cndmask_b32 v13, v13, v51, vcc
    v_cmp_eq_u32 vcc, 8, v77
    s_nop 1
    v_cndmask_b32 v10, 0, v50, vcc
    v_cmp_eq_u32 vcc, 9, v77
    s_nop 1
    v_cndmask_b32 v10, v10, v51, vcc
    v_cmp_eq_u32 vcc, 4, v78
    s_nop 1
    v_cndmask_b32 v14, 0, v50, vcc
    v_cmp_eq_u32 vcc, 5, v78
    s_nop 1
    v_cndmask_b32 v14, v14, v51, vcc
    v_cmp_eq_u32 vcc, 10, v77
    s_nop 1
    v_cndmask_b32 v11, 0, v50, vcc
    v_cmp_eq_u32 vcc, 11, v77
    s_nop 1
    v_cndmask_b32 v11, v11, v51, vcc
    v_cmp_eq_u32 vcc, 6, v78
    s_nop 1
    v_cndmask_b32 v15, 0, v50, vcc
    v_cmp_eq_u32 vcc, 7, v78
    s_nop 1
    v_cndmask_b32 v15, v15, v51, vcc
    v_lshlrev_b32 v77, 4, v61
    ds_write_b128 v69, v[8:11] offset:15360
    ds_write_b128 v77, v[12:15] offset:15872
    s_waitcnt vmcnt(0) lgkmcnt(0)
    s_barrier
    v_mov_b32 v2, 1
    s_cmp_lg_u32 s13, 0
    s_cbranch_scc1 cs_noarr
    s_mov_b64 exec, 1
    buffer_atomic_add v2, off, s[84:87], 0 offset:212
    s_mov_b32 s40, 16777216
    s_mov_b32 s42, 2
cs_startpoll:
    buffer_load_dword v3, off, s[84:87], 0 offset:212 sc1
    s_sub_u32 s40, s40, 1
    s_cbranch_scc1 cs_decide
    s_waitcnt vmcnt(0)
    v_readfirstlane_b32 s41, v3
    s_nop 1
    s_cmp_lt_u32 s41, 32
    s_cbranch_scc1 cs_startpoll
    s_mov_b32 s42, 1
cs_decide:
    s_mov_b64 exec, -1
cs_noarr:
    s_barrier
    s_mov_b32 s44, 0x3e0293ee
    s_mov_b32 s45, s44
    s_or_b32 s66, s44, 0x80000000
    s_mov_b32 s48, 0x3f003f00
    s_mov_b32 s49, 0
    s_mov_b32 s50, 0x3f803f80
    s_mov_b32 s51, 0x3f803f80
    s_mov_b32 s52, 512
    s_mov_b32 s53, 1024
    s_mov_b32 s54, 1536
    s_mov_b32 s30, 0
    s_mov_b32 s37, 0
    s_mov_b32 s98, -100
    s_lshl_b32 s47, s13, 9
    s_cmp_lg_u32 s32, 0
    s_cselect_b32 s71, s13, 3
    s_add_u32 s46, s71, 1
    s_lshr_b32 s46, s46, 1
    s_mov_b32 s14, 67649536
    s_mov_b32 s15, 67653632
    s_mov_b32 s16, 67657728
    s_mov_b32 s36, 0
    s_add_u32 s17, s68, 67633152
    s_mov_b32 s69, 0
    s_mov_b32 s70, 0
    s_lshl_b32 s26, s12, 14
    s_add_u32 s26, s26, 0
    s_mul_i32 s40, s13, 3072
    s_add_u32 s24, s26, s40
    s_lshl_b32 s96, s12, 7
    s_add_u32 s29, s96, 125845504
    s_add_u32 s96, s96, 125829120
    s_lshl_b32 s40, s12, 14
    s_add_u32 s40, s40, 68681728
    s_add_u32 s18, s40, 0
    s_add_u32 s19, s40, 4096
    s_add_u32 s20, s40, 8192
    s_add_u32 s21, s40, 12288
    s_lshr_b32 s40, s12, 3
    s_lshl_b32 s40, s40, 12
    s_and_b32 s41, s12, 7
    s_lshl_b32 s41, s41, 7
    s_add_u32 s40, s40, s41
    s_add_u32 s22, s40, 68681728
    s_add_u32 s23, s22, 1024
    s_add_u32 s25, s22, 2048
    s_mov_b32 s56, -65472
    s_cmp_lg_u32 s32, 0
    s_cselect_b64 s[38:39], -1, 0
    s_add_u32 s55, s68, 138412032
    s_cmp_eq_u32 s13, 3
    s_cselect_b64 s[100:101], 1, 0
    s_cselect_b64 s[38:39], 1, s[38:39]
    s_cselect_b32 s93, 64, 0
    s_cselect_b32 s55, s29, s55
    s_cselect_b32 s57, 0, 9216
    s_mov_b64 exec, s[100:101]
    v_mov_b32 v72, s95
    s_mov_b64 exec, -1
    s_mov_b32 s34, 0xff00ff00
    s_mov_b32 s35, 0xff00ff00
    s_lshl_b32 s28, s12, 12
    s_add_u32 s28, s28, 7340032
    s_add_u32 s27, s28, 77594624
    s_add_u32 s28, s28, 69206016
    s_mov_b32 s40, 3
    v_bfe_u32 v78, v65, 2, 5
    s_mov_b32 s31, 4194304
cs_kv0:
    buffer_load_dword v77, v78, s[4:7], s96 offen offset:16 sc1
    s_waitcnt vmcnt(0)
    v_subrev_u32 v77, s95, v77
    v_cmp_lt_u32 vcc, 16, v77
    s_nop 1
    v_cndmask_b32 v77, v77, 0, vcc
    v_bfe_u32 v79, v78, 2, 2
    v_lshl_add_u32 v77, v77, 2, v79
    s_nop 1
    v_min_u32_dpp v77, v77, v77 row_ror:1 row_mask:0xf bank_mask:0xf
    s_nop 1
    v_min_u32_dpp v77, v77, v77 row_ror:2 row_mask:0xf bank_mask:0xf
    s_nop 1
    v_min_u32_dpp v77, v77, v77 row_ror:4 row_mask:0xf bank_mask:0xf
    s_nop 0
    v_readfirstlane_b32 s97, v77
    s_sub_u32 s31, s31, 1
    s_cbranch_scc1 cs_kv0_x
    s_cmp_le_u32 s40, s97
    s_cbranch_scc1 cs_kv0_x
    s_sleep 2
    s_branch cs_kv0
cs_kv0_x:
    s_add_u32 s40, s24, 0
    s_add_u32 s40, s40, s33
    s_sub_u32 s41, s96, s40
    v_bfe_u32 v77, v65, 2, 5
    v_add3_u32 v77, v77, s41, 16
    v_lshlrev_b32 v78, 3, v69
    s_nop 0
    v_mov_b32_dpp v78, v77 quad_perm:[0,1,2,3] row_mask:0xc bank_mask:0xf
    buffer_load_dword v76, v78, s[4:7], s40 offen sc1
    s_add_u32 s40, s24, 524288
    s_add_u32 s40, s40, s33
    s_sub_u32 s41, s96, s40
    v_bfe_u32 v77, v65, 2, 5
    v_add3_u32 v77, v77, s41, 16
    v_lshlrev_b32 v78, 3, v69
    s_nop 0
    v_mov_b32_dpp v78, v77 quad_perm:[0,1,2,3] row_mask:0xc bank_mask:0xf
    buffer_load_dword v76, v78, s[4:7], s40 offen sc1
cs_kvdone:
    v_mov_b64 v[0:1], 0
    v_mov_b64 v[2:3], 0
    v_mov_b64 v[4:5], 0
    v_mov_b64 v[6:7], 0
    v_mov_b64 v[8:9], 0
    v_mov_b64 v[10:11], 0
    v_mov_b64 v[12:13], 0
    v_mov_b64 v[14:15], 0
    v_mov_b64 v[16:17], 0
    v_mov_b64 v[18:19], 0
    v_mov_b64 v[20:21], 0
    v_mov_b64 v[22:23], 0
    ds_read_b128 v[44:47], v70 offset:0
    ds_read_b128 v[48:51], v70 offset:1024
    ds_read_b128 v[52:55], v70 offset:2048
    ds_read_b128 v[56:59], v70 offset:3072
    ds_read_b128 v[24:27], v70 offset:4096
    ds_read_b128 v[28:31], v70 offset:5120
    ds_read_b128 v[32:35], v70 offset:6144
    ds_read_b128 v[36:39], v70 offset:7168
    buffer_load_dwordx4 v[40:43], v65, s[4:7], s14 offen offset:0 sc1
    buffer_load_dwordx4 v[60:63], v66, s[4:7], s14 offen offset:0 sc1
    s_mov_b32 s31, 1048576
    s_waitcnt vmcnt(0) lgkmcnt(0)
    s_branch cs_goA
cs_loop:
    s_mov_b32 s31, 1048576
    s_mov_b32 s69, s70
    s_waitcnt lgkmcnt(0)
cs_cA:
    buffer_load_dwordx4 v[40:43], v65, s[4:7], s14 offen offset:0 sc1
    buffer_load_dwordx4 v[60:63], v66, s[4:7], s14 offen offset:0 sc1
cs_cA1:
    v_bitop3_b32 v77, v40, v60, s70 bitop3:0x7e
    v_and_b32 v77, 1, v77
    v_cmp_ne_u32 vcc, 0, v77
    s_cbranch_vccz cs_goA
    s_nop 15
    s_nop 15
    s_nop 7
    v_bitop3_b32 v77, v40, v60, s70 bitop3:0x7e
    v_and_b32 v77, 1, v77
    v_cmp_ne_u32 vcc, 0, v77
    s_cbranch_vccz cs_goA
    s_nop 15
    s_nop 15
    s_nop 7
    v_bitop3_b32 v77, v40, v60, s70 bitop3:0x7e
    v_and_b32 v77, 1, v77
    v_cmp_ne_u32 vcc, 0, v77
    s_cbranch_vccz cs_goA
    s_nop 15
    s_nop 15
    s_nop 7
    v_bitop3_b32 v77, v40, v60, s70 bitop3:0x7e
    v_and_b32 v77, 1, v77
    v_cmp_ne_u32 vcc, 0, v77
    s_cbranch_vccz cs_goA
    s_nop 15
    s_nop 15
    s_nop 7
    buffer_load_dwordx4 v[40:43], v65, s[4:7], s14 offen offset:0 sc1
    buffer_load_dwordx4 v[60:63], v66, s[4:7], s14 offen offset:0 sc1
    v_bitop3_b32 v77, v40, v60, s70 bitop3:0x7e
    v_and_b32 v77, 1, v77
    v_cmp_ne_u32 vcc, 0, v77
    s_cbranch_vccz cs_goA
    s_nop 15
    s_nop 15
    s_nop 7
    v_bitop3_b32 v77, v40, v60, s70 bitop3:0x7e
    v_and_b32 v77, 1, v77
    v_cmp_ne_u32 vcc, 0, v77
    s_cbranch_vccz cs_goA
    s_nop 15
    s_nop 15
    s_nop 7
    v_bitop3_b32 v77, v40, v60, s70 bitop3:0x7e
    v_and_b32 v77, 1, v77
    v_cmp_ne_u32 vcc, 0, v77
    s_cbranch_vccz cs_goA
    s_nop 15
    s_nop 15
    s_nop 7
    v_bitop3_b32 v77, v40, v60, s70 bitop3:0x7e
    v_and_b32 v77, 1, v77
    v_cmp_ne_u32 vcc, 0, v77
    s_cbranch_vccz cs_goA
    s_nop 15
    s_nop 15
    s_nop 7
    buffer_load_dwordx4 v[40:43], v65, s[4:7], s14 offen offset:0 sc1
    buffer_load_dwordx4 v[60:63], v66, s[4:7], s14 offen offset:0 sc1
    v_bitop3_b32 v77, v40, v60, s70 bitop3:0x7e
    v_and_b32 v77, 1, v77
    v_cmp_ne_u32 vcc, 0, v77
    s_cbranch_vccz cs_goA
    s_nop 15
    s_nop 15
    s_nop 7
    v_bitop3_b32 v77, v40, v60, s70 bitop3:0x7e
    v_and_b32 v77, 1, v77
    v_cmp_ne_u32 vcc, 0, v77
    s_cbranch_vccz cs_goA
    s_nop 15
    s_nop 15
    s_nop 7
    v_bitop3_b32 v77, v40, v60, s70 bitop3:0x7e
    v_and_b32 v77, 1, v77
    v_cmp_ne_u32 vcc, 0, v77
    s_cbranch_vccz cs_goA
    s_nop 15
    s_nop 15
    s_nop 7
    v_bitop3_b32 v77, v40, v60, s70 bitop3:0x7e
    v_and_b32 v77, 1, v77
    v_cmp_ne_u32 vcc, 0, v77
    s_cbranch_vccz cs_goA
    s_nop 15
    s_nop 15
    s_nop 7
    buffer_load_dwordx4 v[40:43], v65, s[4:7], s14 offen offset:0 sc1
    buffer_load_dwordx4 v[60:63], v66, s[4:7], s14 offen offset:0 sc1
    v_bitop3_b32 v77, v40, v60, s70 bitop3:0x7e
    v_and_b32 v77, 1, v77
    v_cmp_ne_u32 vcc, 0, v77
    s_cbranch_vccz cs_goA
    s_nop 15
    s_nop 15
    s_nop 7
    v_bitop3_b32 v77, v40, v60, s70 bitop3:0x7e
    v_and_b32 v77, 1, v77
    v_cmp_ne_u32 vcc, 0, v77
    s_cbranch_vccz cs_goA
    s_nop 15
    s_nop 15
    s_nop 7
    v_bitop3_b32 v77, v40, v60, s70 bitop3:0x7e
    v_and_b32 v77, 1, v77
    v_cmp_ne_u32 vcc, 0, v77
    s_cbranch_vccz cs_goA
    s_nop 15
    s_nop 15
    s_nop 7
    v_bitop3_b32 v77, v40, v60, s70 bitop3:0x7e
    v_and_b32 v77, 1, v77
    v_cmp_ne_u32 vcc, 0, v77
    s_cbranch_vccz cs_goA
    s_nop 15
    s_nop 15
    s_nop 7
    s_sub_u32 s31, s31, 64
    s_cbranch_scc0 cs_cA
cs_goA:
    ds_write_b128 v65, v[40:43] offset:0
    v_smfmac_f32_16x16x64_bf16 v[0:3], v[40:43], v[44:51], v64
    v_smfmac_f32_16x16x64_bf16 v[4:7], v[40:43], v[52:59], v64
    buffer_load_dwordx4 v[44:47], v65, s[4:7], s15 offen offset:0 sc1
    v_smfmac_f32_16x16x64_bf16 v[0:3], v[60:63], v[24:31], v64
    s_add_u32 s40, s24, 1048576
    s_add_u32 s40, s40, s33
    s_sub_u32 s41, s96, s40
    v_smfmac_f32_16x16x64_bf16 v[4:7], v[60:63], v[32:39], v64
    ds_read_b128 v[24:27], v70 offset:8192
    s_cmp_lt_u32 s97, s93
    s_cselect_b32 s41, s41, 0
    v_smfmac_f32_16x16x64_bf16 v[8:11], v[40:43], a[96:103], v64
    ds_read_b128 v[28:31], v70 offset:9216
    v_smfmac_f32_16x16x64_bf16 v[12:15], v[40:43], a[104:111], v64
    ds_read_b128 v[32:35], v70 offset:10240
    s_waitcnt lgkmcnt(3)
    s_barrier
    ds_read_b128 v[48:51], v67 offset:0
    v_smfmac_f32_16x16x64_bf16 v[8:11], v[60:63], a[112:119], v64
    ds_read_b128 v[36:39], v70 offset:11264
    v_bitop3_b32 v79, v73, -9, s54 bitop3:0x6a
    v_smfmac_f32_16x16x64_bf16 v[12:15], v[60:63], a[120:127], v64
    buffer_load_dwordx4 v[44:47], v65, s[4:7], s15 offen offset:0 sc1
    v_smfmac_f32_16x16x64_bf16 v[16:19], v[40:43], a[232:239], v64
    ds_read_b128 v[52:55], v68 offset:0
    s_waitcnt lgkmcnt(4)
    v_bfe_u32 v77, v65, 2, 5
    v_smfmac_f32_16x16x64_bf16 v[20:23], v[40:43], v[24:31], v64
    ds_read_b128 v[24:27], v70 offset:12288
    s_waitcnt lgkmcnt(3)
    v_smfmac_f32_16x16x64_bf16 v[0:3], v[48:51], a[0:7], v64
    ds_read_b128 v[28:31], v70 offset:13312
    s_waitcnt lgkmcnt(3)
    v_add3_u32 v77, v77, s41, 16
    v_smfmac_f32_16x16x64_bf16 v[4:7], v[48:51], v[32:39], v64
    buffer_load_dwordx4 v[40:43], v65, s[4:7], s16 offen offset:0 sc1
    v_smfmac_f32_16x16x64_bf16 v[16:19], v[60:63], a[240:247], v64
    ds_read_b128 v[32:35], v70 offset:14336
    v_lshlrev_b32 v78, 3, v69
    v_smfmac_f32_16x16x64_bf16 v[20:23], v[60:63], a[248:255], v64
    ds_read_b128 v[36:39], v70 offset:15360
    v_smfmac_f32_16x16x64_bf16 v[8:11], v[48:51], a[128:135], v64
    s_waitcnt vmcnt(2)
    v_mov_b32_dpp v78, v77 quad_perm:[0,1,2,3] row_mask:0xc bank_mask:0xf
    v_smfmac_f32_16x16x64_bf16 v[12:15], v[48:51], a[136:143], v64
    buffer_load_dwordx4 v[58:61], v65, s[4:7], s24 offen offset:3072 sc1
    s_waitcnt lgkmcnt(2)
    v_and_b32 v77, s36, v44
    v_smfmac_f32_16x16x64_bf16 v[12:15], v[52:55], v[24:31], v64
    ds_write_b128 v65, v[44:47] offset:4096
    v_smfmac_f32_16x16x64_bf16 v[0:3], v[52:55], a[8:15], v64
    v_cmp_ne_u32 vcc, s70, v77
    v_smfmac_f32_16x16x64_bf16 v[8:11], v[52:55], a[144:151], v64
    buffer_load_dwordx4 v[24:27], v65, s[4:7], s24 offen offset:0 sc1
    s_waitcnt lgkmcnt(1)
    v_smfmac_f32_16x16x64_bf16 v[4:7], v[52:55], v[32:39], v64
    s_cbranch_vccnz cs_spinB
cs_backB:
    v_smfmac_f32_16x16x64_bf16 v[16:19], v[44:47], v[176:183], v64
    s_waitcnt lgkmcnt(0)
    s_barrier
    ds_read_b128 v[48:51], v66 offset:4096
    v_smfmac_f32_16x16x64_bf16 v[12:15], v[44:47], a[160:167], v64
    buffer_load_dwordx4 v[28:31], v65, s[4:7], s24 offen offset:1024 sc1
    v_smfmac_f32_16x16x64_bf16 v[0:3], v[44:47], a[16:23], v64
    ds_read_b128 v[52:55], v67 offset:4096
    v_smfmac_f32_16x16x64_bf16 v[8:11], v[44:47], a[152:159], v64
    v_smfmac_f32_16x16x64_bf16 v[4:7], v[44:47], a[24:31], v64
    buffer_load_dwordx4 v[34:37], v65, s[4:7], s24 offen offset:2048 sc1
    s_waitcnt vmcnt(5)
    v_smfmac_f32_16x16x64_bf16 v[20:23], v[44:47], v[184:191], v64
    ds_read_b128 v[44:47], v68 offset:4096
    s_waitcnt lgkmcnt(2)
    v_smfmac_f32_16x16x64_bf16 v[0:3], v[48:51], a[32:39], v64
    v_smfmac_f32_16x16x64_bf16 v[8:11], v[48:51], a[168:175], v64
    buffer_load_dword v76, v78, s[4:7], s40 offen sc1
    v_smfmac_f32_16x16x64_bf16 v[4:7], v[48:51], a[40:47], v64
    s_waitcnt vmcnt(5)
    v_and_b32 v77, s36, v40
    v_smfmac_f32_16x16x64_bf16 v[12:15], v[48:51], a[176:183], v64
    ds_read_b128 v[48:51], v69 offset:15360
    s_waitcnt lgkmcnt(1)
    v_cmp_ne_u32 vcc, s70, v77
    v_smfmac_f32_16x16x64_bf16 v[0:3], v[52:55], a[48:55], v64
    v_smfmac_f32_16x16x64_bf16 v[8:11], v[52:55], a[184:191], v64
    s_cbranch_vccnz cs_spin8
cs_back8:
    v_smfmac_f32_16x16x64_bf16 v[0:3], v[44:47], a[64:71], v64
    v_smfmac_f32_16x16x64_bf16 v[8:11], v[44:47], a[200:207], v64
    v_smfmac_f32_16x16x64_bf16 v[0:3], v[40:43], a[80:87], v64
    s_nop 1
    v_smfmac_f32_16x16x64_bf16 v[8:11], v[40:43], a[216:223], v64
    s_nop 1
    v_lshrrev_b32 v77, 1, v69
    v_smfmac_f32_16x16x64_bf16 v[4:7], v[52:55], a[56:63], v64
    s_nop 1
    v_cvt_pk_bf16_f32 v0, v0, v1
    v_smfmac_f32_16x16x64_bf16 v[12:15], v[52:55], a[192:199], v64
    s_nop 1
    v_cvt_pk_bf16_f32 v1, v2, v3
    v_smfmac_f32_16x16x64_bf16 v[4:7], v[44:47], a[72:79], v64
    s_nop 1
    v_cvt_pk_bf16_f32 v2, v8, v9
    v_smfmac_f32_16x16x64_bf16 v[12:15], v[44:47], a[208:215], v64
    s_nop 1
    v_cvt_pk_bf16_f32 v3, v10, v11
    v_smfmac_f32_16x16x64_bf16 v[4:7], v[40:43], a[88:95], v64
    s_waitcnt lgkmcnt(0)
    s_nop 0
    s_nop 0
    v_smfmac_f32_16x16x64_bf16 v[12:15], v[40:43], a[224:231], v64
    s_nop 2
    v_mfma_f32_16x16x32_bf16 v[8:11], v[0:3], v[48:51], 0
    s_nop 0
    v_cvt_pk_bf16_f32 v4, v4, v5
    v_cvt_pk_bf16_f32 v5, v6, v7
    s_nop 0
    v_cvt_pk_bf16_f32 v6, v12, v13
    v_cvt_pk_bf16_f32 v7, v14, v15
    s_nop 1
    v_mfma_f32_16x16x32_bf16 v[12:15], v[4:7], v[48:51], 0
    ds_read_b128 v[48:51], v66 offset:4096
    v_cvt_pk_bf16_f32 v0, v8, v9
    v_cvt_pk_bf16_f32 v1, v10, v11
    v_smfmac_f32_16x16x64_bf16 v[16:19], v[52:55], v[208:215], v64
    s_waitcnt vmcnt(2)
    s_nop 2
    v_cvt_pk_bf16_f32 v2, v12, v13
    v_cvt_pk_bf16_f32 v3, v14, v15
    s_nop 1
    v_mfma_f32_16x16x32_bf16 v[12:15], v[0:3], v[0:3], 0
    s_nop 1
    v_bitop3_b32 v78, v73, -9, s53 bitop3:0x6a
    v_mfma_f32_16x16x32_bf16 v[4:7], v[24:27], v[0:3], 0
    ds_read_b128 v[24:27], v67 offset:0
    s_nop 1
    v_mfma_f32_16x16x32_bf16 v[8:11], v[28:31], v[0:3], 0
    s_nop 0
    v_mov_b32_dpp v12, v14 row_ror:8 row_mask:0xf bank_mask:0xc
    v_mov_b32_dpp v13, v15 row_ror:8 row_mask:0xf bank_mask:0xc
    v_smfmac_f32_16x16x64_bf16 v[20:23], v[52:55], v[216:223], v64
    ds_write_b64 v71, v[12:13]
    ds_read_b128 v[52:55], v68 offset:0
    s_nop 1
    v_mov_b32_dpp v4, v8 row_ror:8 row_mask:0xf bank_mask:0xc
    v_mov_b32_dpp v5, v9 row_ror:8 row_mask:0xf bank_mask:0xc
    v_mov_b32_dpp v6, v10 row_ror:8 row_mask:0xf bank_mask:0xc
    v_mov_b32_dpp v7, v11 row_ror:8 row_mask:0xf bank_mask:0xc
    v_smfmac_f32_16x16x64_bf16 v[16:19], v[44:47], v[224:231], v64
    ds_write_b128 v65, v[4:7] offset:8192
    v_smfmac_f32_16x16x64_bf16 v[20:23], v[44:47], v[232:239], v64
    s_waitcnt lgkmcnt(3)
    v_smfmac_f32_16x16x64_bf16 v[16:19], v[24:27], v[144:151], v64
    s_waitcnt vmcnt(1)
    v_smfmac_f32_16x16x64_bf16 v[20:23], v[24:27], v[152:159], v64
    s_mov_b64 exec, s[38:39]
    buffer_store_dword v72, v75, s[4:7], s55 offen sc1
    s_mov_b64 exec, -1
    v_smfmac_f32_16x16x64_bf16 v[16:19], v[40:43], v[240:247], v64
    s_cmp_ge_u32 s30, 56
    s_waitcnt lgkmcnt(0)
    s_barrier
    ds_read_b128 v[8:11], v66 offset:8192
    v_smfmac_f32_16x16x64_bf16 v[20:23], v[40:43], v[248:255], v64
    ds_read_b128 v[12:15], v67 offset:8192
    v_smfmac_f32_16x16x64_bf16 v[16:19], v[48:51], v[192:199], v64
    ds_read_b128 v[44:47], v68 offset:8192
    v_smfmac_f32_16x16x64_bf16 v[20:23], v[48:51], v[200:207], v64
    ds_read_b64 v[24:25], v77 offset:14336
    ds_read_b64 v[26:27], v77 offset:14592
    v_smfmac_f32_16x16x64_bf16 v[16:19], v[52:55], v[160:167], v64
    ds_read_b64 v[28:29], v77 offset:14848
    ds_read_b64 v[30:31], v77 offset:15104
    v_bitop3_b32 v77, v73, -9, s52 bitop3:0x6a
    v_smfmac_f32_16x16x64_bf16 v[20:23], v[52:55], v[168:175], v64
    s_cbranch_scc1 cs_rare
cs_rare_x:
    ds_read_b128 v[48:51], v70 offset:22528
    ds_read_b128 v[52:55], v70 offset:23552
    s_waitcnt lgkmcnt(6)
    v_pk_add_f32 v[4:5], v[4:5], v[8:9]
    v_pk_add_f32 v[6:7], v[6:7], v[10:11]
    v_pk_add_f32 v[12:13], v[12:13], v[44:45]
    v_pk_add_f32 v[14:15], v[14:15], v[46:47]
    v_pk_add_f32 v[4:5], v[4:5], v[12:13]
    v_pk_add_f32 v[6:7], v[6:7], v[14:15]
    s_waitcnt lgkmcnt(2)
    v_pk_add_f32 v[24:25], v[24:25], v[26:27]
    v_pk_add_f32 v[28:29], v[28:29], v[30:31]
    v_max3_f32 v8, v4, v5, v6
    v_pk_add_f32 v[24:25], v[24:25], v[28:29]
    v_max_f32 v8, v8, v7
    v_max3_f32 v8, v8, v24, v25
    v_cvt_pk_bf16_f32 v32, v16, v17
    v_cvt_pk_bf16_f32 v38, v18, v19
    v_max_f32_dpp v8, v8, v8 row_ror:8 row_mask:0xf bank_mask:0xf
    v_mov_b32 v9, v8
    v_cvt_pk_bf16_f32 v56, v20, v21
    v_cvt_pk_bf16_f32 v62, v22, v23
    v_permlane32_swap_b32 v8, v9
    v_max_f32 v8, v8, v9
    v_mov_b32 v9, v8
    v_mov_b32 v11, 0
    v_mov_b32 v15, 0
    v_permlane16_swap_b32 v8, v9
    v_max_f32 v8, v8, v9
    v_mul_f32 v8, s66, v8
    v_pk_fma_f32 v[4:5], v[4:5], s[44:45], v[8:9] op_sel_hi:[1,1,0]
    v_pk_fma_f32 v[6:7], v[6:7], s[44:45], v[8:9] op_sel_hi:[1,1,0]
    v_pk_fma_f32 v[24:25], v[24:25], s[44:45], v[8:9] op_sel_hi:[1,1,0]
    v_exp_f32 v4, v4
    v_exp_f32 v5, v5
    v_exp_f32 v6, v6
    v_exp_f32 v7, v7
    v_exp_f32 v24, v24
    v_exp_f32 v25, v25
    v_cvt_pk_bf16_f32 v12, v4, v5
    v_cvt_pk_bf16_f32 v13, v6, v7
    v_cvt_pk_bf16_f32 v10, v24, v25
    v_cvt_pk_bf16_f32 v14, v24, v25
    v_mov_b64 v[0:1], s[48:49]
    v_mfma_f32_16x16x32_bf16 v[4:7], v[32:35], v[10:13], 0
    ds_read_b128 v[40:43], v70 offset:20480
    v_mov_b64 v[2:3], s[50:51]
    v_mfma_f32_16x16x32_bf16 v[24:27], v[36:39], v[12:15], 0
    ds_read_b128 v[44:47], v70 offset:21504
    v_mov_b64 v[8:9], 0
    v_mfma_f32_16x16x32_bf16 v[28:31], v[0:3], v[10:13], 0
    ds_read_b128 v[32:35], v70 offset:24576
    v_mov_b64 v[0:1], 0
    v_mfma_f32_16x16x32_bf16 v[16:19], v[56:59], v[10:13], 0
    ds_read_b128 v[36:39], v70 offset:25600
    v_mov_b64 v[2:3], 0
    v_mfma_f32_16x16x32_bf16 v[20:23], v[60:63], v[12:15], 0
    ds_read_b128 v[56:59], v70 offset:28672
    v_add_f32_dpp v4, v24, v4 row_ror:8 row_mask:0xf bank_mask:0xf
    v_add_f32_dpp v5, v25, v5 row_ror:8 row_mask:0xf bank_mask:0xf
    v_add_f32_dpp v6, v26, v6 row_ror:8 row_mask:0xf bank_mask:0xf
    v_add_f32_dpp v7, v27, v7 row_ror:8 row_mask:0xf bank_mask:0xf
    v_add_f32_dpp v29, v28, v28 row_ror:8 row_mask:0xf bank_mask:0xf
    v_rcp_f32 v28, v29
    v_mov_b64 v[10:11], 0
    v_add_f32_dpp v4, v16, v20 row_ror:8 row_mask:0xf bank_mask:0xc
    v_add_f32_dpp v5, v17, v21 row_ror:8 row_mask:0xf bank_mask:0xc
    v_add_f32_dpp v6, v18, v22 row_ror:8 row_mask:0xf bank_mask:0xc
    v_add_f32_dpp v7, v19, v23 row_ror:8 row_mask:0xf bank_mask:0xc
    v_pk_mul_f32 v[4:5], v[4:5], v[28:29] op_sel_hi:[1,0]
    v_pk_mul_f32 v[6:7], v[6:7], v[28:29] op_sel_hi:[1,0]
    v_cvt_pk_bf16_f32 v4, v4, v5
    v_cvt_pk_bf16_f32 v5, v6, v7
    ds_write_b64 v73, v[4:5] offset:12288
    v_mov_b32_dpp v6, v4 row_ror:8 row_mask:0xf bank_mask:0xf
    v_mov_b32_dpp v7, v5 row_ror:8 row_mask:0xf bank_mask:0xf
    v_mov_b64 v[12:13], 0
    v_mov_b64 v[14:15], 0
    v_smfmac_f32_16x16x64_bf16 v[8:11], v[4:7], v[80:87], v64
    s_waitcnt lgkmcnt(4)
    v_mov_b64 v[24:25], 0
    v_smfmac_f32_16x16x64_bf16 v[0:3], v[4:7], v[40:47], v64
    ds_read_b128 v[60:63], v70 offset:29696
    v_mov_b64 v[26:27], 0
    v_smfmac_f32_16x16x64_bf16 v[12:15], v[4:7], v[112:119], v64
    s_waitcnt lgkmcnt(1)
    s_barrier
    ds_read_b128 v[16:19], v77 offset:12288
    v_smfmac_f32_16x16x64_bf16 v[24:27], v[4:7], v[48:55], v64
    ds_read_b128 v[20:23], v78 offset:12288
    ds_read_b128 v[28:31], v79 offset:12288
    v_mov_b64 v[4:5], 0
    v_mov_b64 v[6:7], 0
    v_bfe_u32 v77, v74, 16, 1
    v_mad_i32_i24 v77, v77, s56, v74
    s_waitcnt lgkmcnt(2)
    v_smfmac_f32_16x16x64_bf16 v[8:11], v[16:19], v[88:95], v64
    ds_read_b128 v[40:43], v70 offset:32768
    s_waitcnt lgkmcnt(2)
    v_smfmac_f32_16x16x64_bf16 v[8:11], v[20:23], v[96:103], v64
    ds_read_b128 v[44:47], v70 offset:33792
    s_waitcnt lgkmcnt(2)
    v_smfmac_f32_16x16x64_bf16 v[8:11], v[28:31], v[104:111], v64
    ds_read_b128 v[48:51], v70 offset:26624
    s_nop 0
    v_and_b32 v72, 8, v73
    v_smfmac_f32_16x16x64_bf16 v[0:3], v[16:19], v[32:39], v64
    ds_read_b128 v[52:55], v70 offset:27648
    s_nop 0
    v_mad_u32_u24 v72, v72, 63, v73
    v_smfmac_f32_16x16x64_bf16 v[12:15], v[16:19], v[120:127], v64
    ds_read_b128 v[32:35], v70 offset:30720
    v_cvt_pk_bf16_f32 v8, v8, v9
    v_cvt_pk_bf16_f32 v9, v10, v11
    v_and_or_b32 v8, v8, -2, s69
    v_smfmac_f32_16x16x64_bf16 v[12:15], v[20:23], v[128:135], v64
    buffer_store_dwordx2 v[8:9], v74, s[4:7], s22 offen offset:0 sc1
    ds_read_b128 v[36:39], v70 offset:31744
    v_smfmac_f32_16x16x64_bf16 v[12:15], v[28:31], v[136:143], v64
    s_add_u32 s30, s30, 1
    s_xor_b32 s70, s70, 1
    v_subrev_u32 v72, s47, v72
    v_smfmac_f32_16x16x64_bf16 v[0:3], v[20:23], v[56:63], v64
    ds_read_b128 v[56:59], v70 offset:34816
    s_waitcnt lgkmcnt(3)
    s_nop 0
    v_smfmac_f32_16x16x64_bf16 v[0:3], v[28:31], v[40:47], v64
    ds_read_b128 v[60:63], v70 offset:35840
    v_cvt_pk_bf16_f32 v12, v12, v13
    v_cvt_pk_bf16_f32 v13, v14, v15
    v_and_or_b32 v12, v12, -2, s69
    v_smfmac_f32_16x16x64_bf16 v[24:27], v[16:19], v[48:55], v64
    buffer_store_dwordx2 v[12:13], v74, s[4:7], s22 offen offset:64 sc1
    s_waitcnt lgkmcnt(2)
    v_smfmac_f32_16x16x64_bf16 v[24:27], v[20:23], v[32:39], v64
    ds_read_b128 v[40:43], v70 offset:16384
    v_cvt_pk_bf16_f32 v0, v0, v1
    v_cvt_pk_bf16_f32 v1, v2, v3
    v_and_or_b32 v0, v0, -2, s69
    s_waitcnt lgkmcnt(1)
    v_smfmac_f32_16x16x64_bf16 v[24:27], v[28:31], v[56:63], v64
    buffer_store_dwordx2 v[0:1], v74, s[4:7], s23 offen offset:0 sc1
    ds_read_b128 v[44:47], v70 offset:17408
    ds_read_b128 v[8:11], v72 offset:12288
    ds_read_b128 v[48:51], v70 offset:18432
    ds_read_b128 v[52:55], v70 offset:19456
    ds_read_b128 v[12:15], v72 offset:13312
    s_cmp_lg_u32 s71, 0
    s_nop 0
    v_cvt_pk_bf16_f32 v24, v24, v25
    v_cvt_pk_bf16_f32 v25, v26, v27
    v_and_or_b32 v24, v24, -2, s69
    buffer_store_dwordx2 v[24:25], v74, s[4:7], s23 offen offset:64 sc1
    s_waitcnt lgkmcnt(3)
    v_smfmac_f32_16x16x64_bf16 v[4:7], v[8:11], v[40:47], v64
    s_waitcnt lgkmcnt(0)
    v_smfmac_f32_16x16x64_bf16 v[4:7], v[12:15], v[48:55], v64
    s_nop 7
    v_cvt_pk_bf16_f32 v4, v4, v5
    v_cvt_pk_bf16_f32 v5, v6, v7
    v_and_or_b32 v4, v4, -2, s69
    buffer_store_dwordx2 v[4:5], v77, s[4:7], s25 offen offset:0 sc1
    s_nop 0
    s_cbranch_scc1 cs_e1
    s_cmp_lg_u32 s37, 0
    s_cbranch_scc1 cs_f0_xt
cs_f0_xtx:
    s_nop 2
    v_mov_b32 v79, v79
    s_nop 2
    v_mov_b32 v79, v79
    s_nop 2
    v_mov_b32 v79, v79
    s_nop 2
    v_mov_b32 v79, v79
    s_nop 2
    v_mov_b32 v79, v79
    s_nop 2
    v_mov_b32 v79, v79
    s_nop 2
    v_mov_b32 v79, v79
    s_nop 2
    v_mov_b32 v79, v79
    s_nop 2
    v_mov_b32 v79, v79
    s_nop 2
    v_mov_b32 v79, v79
    s_nop 2
    v_mov_b32 v79, v79
    s_nop 2
    v_mov_b32 v79, v79
    s_nop 2
    v_mov_b32 v79, v79
    s_nop 2
    v_mov_b32 v79, v79
    s_nop 2
    v_mov_b32 v79, v79
    s_nop 2
    v_mov_b32 v79, v79
    s_nop 2
    v_mov_b32 v79, v79
    s_nop 2
    v_mov_b32 v79, v79
    s_nop 2
    v_mov_b32 v79, v79
    s_nop 2
    v_mov_b32 v79, v79
    s_nop 2
    v_mov_b32 v79, v79
    s_nop 2
    v_mov_b32 v79, v79
    s_nop 2
    v_mov_b32 v79, v79
    s_nop 2
    v_mov_b32 v79, v79
    s_nop 2
    v_mov_b32 v79, v79
    s_nop 2
    v_mov_b32 v79, v79
    s_nop 2
    v_mov_b32 v79, v79
    s_nop 2
    v_mov_b32 v79, v79
    s_nop 2
    v_mov_b32 v79, v79
    s_nop 2
    v_mov_b32 v79, v79
    s_nop 2
    v_mov_b32 v79, v79
    s_nop 2
    v_mov_b32 v79, v79
    s_nop 2
    v_mov_b32 v79, v79
    s_nop 2
    v_mov_b32 v79, v79
    s_nop 2
    v_mov_b32 v79, v79
    s_nop 2
    v_mov_b32 v79, v79
    s_nop 0
    v_mov_b32 v79, v79
    buffer_load_dwordx4 v[8:11], v65, s[4:7], s18 offen sc1
    buffer_load_dwordx4 v[12:15], v65, s[4:7], s19 offen sc1
    buffer_load_dwordx4 v[16:19], v65, s[4:7], s20 offen sc1
    buffer_load_dwordx4 v[20:23], v65, s[4:7], s21 offen sc1
    v_and_b32 v77, 255, v69
    ds_read_b128 v[4:7], v77 offset:15872
    ds_read_b128 v[44:47], v70 offset:0
    ds_read_b128 v[48:51], v70 offset:1024
    ds_read_b128 v[52:55], v70 offset:2048
    ds_read_b128 v[56:59], v70 offset:3072
    ds_read_b128 v[24:27], v70 offset:4096
    ds_read_b128 v[28:31], v70 offset:5120
    ds_read_b128 v[32:35], v70 offset:6144
    ds_read_b128 v[36:39], v70 offset:7168
    s_mov_b32 s31, 65536
    s_add_u32 s24, s24, 524288
    s_add_u32 s26, s26, 524288
    s_add_u32 s55, s55, s57
    s_mov_b32 s14, 67633152
    s_mov_b32 s15, 67637248
    s_mov_b32 s16, 67641344
    s_mov_b32 s36, 1
    v_mov_b32 v40, s69
    v_mov_b32 v60, s69
    v_and_b32 v79, 12, v75
    v_cmp_eq_u32 vcc, 0, v79
    s_nop 1
    v_cndmask_b32 v79, 0, 1, vcc
    s_waitcnt lgkmcnt(0)
    s_waitcnt vmcnt(3)
    v_bitop3_b32 v77, v8, v10, s69 bitop3:0x7e
    v_mfma_f32_16x16x32_bf16 v[0:3], v[4:7], v[8:11], 0
    v_mov_b64 v[8:9], 0
    v_mov_b64 v[10:11], 0
    s_waitcnt vmcnt(2)
    v_bitop3_b32 v78, v12, v14, s69 bitop3:0x7e
    v_mfma_f32_16x16x32_bf16 v[0:3], v[4:7], v[12:15], v[0:3]
    v_or_b32 v77, v77, v78
    v_mov_b64 v[12:13], 0
    v_mov_b64 v[14:15], 0
    s_waitcnt vmcnt(1)
    v_bitop3_b32 v78, v16, v18, s69 bitop3:0x7e
    v_mfma_f32_16x16x32_bf16 v[0:3], v[4:7], v[16:19], v[0:3]
    v_or_b32 v77, v77, v78
    v_mov_b64 v[16:17], 0
    v_mov_b64 v[18:19], 0
    s_waitcnt vmcnt(0)
    v_bitop3_b32 v78, v20, v22, s69 bitop3:0x7e
    v_mfma_f32_16x16x32_bf16 v[0:3], v[4:7], v[20:23], v[0:3]
    v_bitop3_b32 v77, v77, v78, 1 bitop3:0xa8
    v_cmp_ne_u32 vcc, 0, v77
    v_mov_b64 v[20:21], 0
    v_mov_b64 v[22:23], 0
    s_cmp_eq_u64 vcc, 0
    s_cselect_b64 s[42:43], -1, 0
    s_nop 1
    v_add_f32_dpp v0, v0, v0 row_ror:8 row_mask:0xf bank_mask:0xf
    v_add_f32_dpp v1, v1, v1 row_ror:8 row_mask:0xf bank_mask:0xf
    s_mov_b64 exec, s[42:43]
    v_cvt_pk_bf16_f32 v72, v0, v1
    v_bfi_b32 v72, v79, s70, v72
    buffer_store_dword v72, v75, s[4:7], s17 offen offset:0 sc1
    s_mov_b64 exec, -1
    s_cbranch_scc0 cs_f0_retry
cs_f0_go:
    v_mov_b64 v[0:1], 0
    v_mov_b64 v[2:3], 0
    v_mov_b64 v[4:5], 0
    v_mov_b64 v[6:7], 0
    s_nop 2
    v_mov_b32 v79, v79
    s_nop 2
    v_mov_b32 v79, v79
    s_nop 2
    v_mov_b32 v79, v79
    s_nop 2
    v_mov_b32 v79, v79
    s_nop 2
    v_mov_b32 v79, v79
    s_nop 2
    v_mov_b32 v79, v79
    s_nop 2
    v_mov_b32 v79, v79
    s_nop 2
    v_mov_b32 v79, v79
    s_nop 2
    v_mov_b32 v79, v79
    s_nop 2
    v_mov_b32 v79, v79
    s_nop 2
    v_mov_b32 v79, v79
    s_nop 2
    v_mov_b32 v79, v79
    s_nop 2
    v_mov_b32 v79, v79
    s_nop 2
    v_mov_b32 v79, v79
    s_nop 2
    v_mov_b32 v79, v79
    s_nop 2
    v_mov_b32 v79, v79
    s_nop 2
    v_mov_b32 v79, v79
    s_nop 2
    v_mov_b32 v79, v79
    s_nop 2
    v_mov_b32 v79, v79
    s_nop 2
    v_mov_b32 v79, v79
    s_nop 2
    v_mov_b32 v79, v79
    s_nop 2
    v_mov_b32 v79, v79
    s_nop 2
    v_mov_b32 v79, v79
    s_nop 2
    v_mov_b32 v79, v79
    s_nop 2
    v_mov_b32 v79, v79
    s_branch cs_loop
cs_e1:
    s_cmp_lg_u32 s71, 2
    s_cbranch_scc1 cs_f1
    v_and_b32 v77, 255, v69
    ds_read_b128 v[4:7], v77 offset:15872
    ds_read_b128 v[44:47], v70 offset:0
    ds_read_b128 v[48:51], v70 offset:1024
    ds_read_b128 v[52:55], v70 offset:2048
    ds_read_b128 v[56:59], v70 offset:3072
    ds_read_b128 v[24:27], v70 offset:4096
    ds_read_b128 v[28:31], v70 offset:5120
    ds_read_b128 v[32:35], v70 offset:6144
    ds_read_b128 v[36:39], v70 offset:7168
    s_mov_b32 s31, 65536
    s_add_u32 s24, s24, 524288
    s_add_u32 s26, s26, 524288
    s_add_u32 s55, s55, s57
    s_mov_b32 s14, 67633152
    s_mov_b32 s15, 67637248
    s_mov_b32 s16, 67641344
    s_mov_b32 s36, 1
    v_mov_b32 v40, s69
    v_mov_b32 v60, s69
    v_and_b32 v79, 12, v75
    v_cmp_eq_u32 vcc, 0, v79
    s_nop 1
    v_cndmask_b32 v79, 0, 1, vcc
    s_cmp_lg_u32 s37, 0
    s_cbranch_scc1 cs_f2_xt
cs_f2_xtx:
    s_nop 2
    v_mov_b32 v79, v79
    s_nop 2
    v_mov_b32 v79, v79
    s_nop 2
    v_mov_b32 v79, v79
    s_nop 2
    v_mov_b32 v79, v79
    s_nop 2
    v_mov_b32 v79, v79
    s_nop 2
    v_mov_b32 v79, v79
    s_nop 2
    v_mov_b32 v79, v79
    s_nop 2
    v_mov_b32 v79, v79
    s_nop 2
    v_mov_b32 v79, v79
    s_nop 2
    v_mov_b32 v79, v79
    s_nop 2
    v_mov_b32 v79, v79
    s_nop 2
    v_mov_b32 v79, v79
    s_nop 2
    v_mov_b32 v79, v79
    s_nop 2
    v_mov_b32 v79, v79
    s_nop 2
    v_mov_b32 v79, v79
    s_nop 2
    v_mov_b32 v79, v79
    s_nop 2
    v_mov_b32 v79, v79
    s_nop 2
    v_mov_b32 v79, v79
    s_nop 2
    v_mov_b32 v79, v79
    s_nop 2
    v_mov_b32 v79, v79
    s_nop 2
    v_mov_b32 v79, v79
    s_nop 2
    v_mov_b32 v79, v79
    s_nop 2
    v_mov_b32 v79, v79
    s_nop 2
    v_mov_b32 v79, v79
    s_nop 2
    v_mov_b32 v79, v79
    s_nop 2
    v_mov_b32 v79, v79
    s_nop 2
    v_mov_b32 v79, v79
    s_nop 2
    v_mov_b32 v79, v79
    s_nop 2
    v_mov_b32 v79, v79
    s_nop 2
    v_mov_b32 v79, v79
    s_nop 2
    v_mov_b32 v79, v79
    s_nop 2
    v_mov_b32 v79, v79
    s_nop 2
    v_mov_b32 v79, v79
    s_nop 2
    v_mov_b32 v79, v79
    s_nop 2
    v_mov_b32 v79, v79
    s_nop 2
    v_mov_b32 v79, v79
    s_nop 0
    v_mov_b32 v79, v79
    s_waitcnt vmcnt(0)
    buffer_load_dwordx4 v[8:11], v65, s[4:7], s18 offen sc1
    buffer_load_dwordx4 v[12:15], v65, s[4:7], s19 offen sc1
    buffer_load_dwordx4 v[16:19], v65, s[4:7], s20 offen sc1
    buffer_load_dwordx4 v[20:23], v65, s[4:7], s21 offen sc1
    s_nop 2
    v_mov_b32 v79, v79
    s_nop 2
    v_mov_b32 v79, v79
    s_nop 2
    v_mov_b32 v79, v79
    s_nop 2
    v_mov_b32 v79, v79
    s_nop 2
    v_mov_b32 v79, v79
    s_nop 2
    v_mov_b32 v79, v79
    s_nop 2
    v_mov_b32 v79, v79
    s_nop 2
    v_mov_b32 v79, v79
    s_nop 2
    v_mov_b32 v79, v79
    s_nop 2
    v_mov_b32 v79, v79
    buffer_load_dwordx4 v[40:43], v65, s[4:7], s14 offen offset:0 sc1
    buffer_load_dwordx4 v[60:63], v66, s[4:7], s14 offen offset:0 sc1
    s_waitcnt lgkmcnt(0)
    s_waitcnt vmcnt(5)
    v_bitop3_b32 v77, v8, v10, s69 bitop3:0x7e
    v_mfma_f32_16x16x32_bf16 v[0:3], v[4:7], v[8:11], 0
    v_mov_b64 v[8:9], 0
    v_mov_b64 v[10:11], 0
    s_waitcnt vmcnt(4)
    v_bitop3_b32 v78, v12, v14, s69 bitop3:0x7e
    v_mfma_f32_16x16x32_bf16 v[0:3], v[4:7], v[12:15], v[0:3]
    v_or_b32 v77, v77, v78
    v_mov_b64 v[12:13], 0
    v_mov_b64 v[14:15], 0
    s_waitcnt vmcnt(3)
    v_bitop3_b32 v78, v16, v18, s69 bitop3:0x7e
    v_mfma_f32_16x16x32_bf16 v[0:3], v[4:7], v[16:19], v[0:3]
    v_or_b32 v77, v77, v78
    v_mov_b64 v[16:17], 0
    v_mov_b64 v[18:19], 0
    s_waitcnt vmcnt(2)
    v_bitop3_b32 v78, v20, v22, s69 bitop3:0x7e
    v_mfma_f32_16x16x32_bf16 v[0:3], v[4:7], v[20:23], v[0:3]
    v_bitop3_b32 v77, v77, v78, 1 bitop3:0xa8
    v_cmp_ne_u32 vcc, 0, v77
    v_mov_b64 v[20:21], 0
    v_mov_b64 v[22:23], 0
    buffer_load_dwordx4 v[40:43], v65, s[4:7], s14 offen offset:0 sc1
    buffer_load_dwordx4 v[60:63], v66, s[4:7], s14 offen offset:0 sc1
    s_cmp_eq_u64 vcc, 0
    s_cselect_b64 s[42:43], -1, 0
    v_add_f32_dpp v0, v0, v0 row_ror:4 row_mask:0xf bank_mask:0xf
    v_add_f32_dpp v1, v1, v1 row_ror:4 row_mask:0xf bank_mask:0xf
    s_nop 0
    v_add_f32_dpp v0, v0, v0 row_ror:8 row_mask:0xf bank_mask:0xf
    v_add_f32_dpp v1, v1, v1 row_ror:8 row_mask:0xf bank_mask:0xf
    s_mov_b64 exec, s[42:43]
    v_cvt_pk_bf16_f32 v72, v0, v1
    v_bfi_b32 v72, v79, s70, v72
    buffer_store_dword v72, v75, s[4:7], s17 offen offset:0 sc1
    buffer_store_dword v72, v75, s[4:7], s17 offen offset:1024 sc1
    buffer_store_dword v72, v75, s[4:7], s17 offen offset:2048 sc1
    buffer_store_dword v72, v75, s[4:7], s17 offen offset:3072 sc1
    s_mov_b64 exec, -1
    s_cbranch_scc0 cs_f2_retry
cs_f2_go:
    v_mov_b64 v[0:1], 0
    v_mov_b64 v[2:3], 0
    v_mov_b64 v[4:5], 0
    v_mov_b64 v[6:7], 0
    s_nop 2
    v_mov_b32 v79, v79
    s_nop 2
    v_mov_b32 v79, v79
    s_nop 2
    v_mov_b32 v79, v79
    s_nop 2
    v_mov_b32 v79, v79
    s_nop 2
    v_mov_b32 v79, v79
    s_nop 2
    v_mov_b32 v79, v79
    s_nop 2
    v_mov_b32 v79, v79
    s_nop 2
    v_mov_b32 v79, v79
    s_nop 2
    v_mov_b32 v79, v79
    s_nop 2
    v_mov_b32 v79, v79
    s_nop 2
    v_mov_b32 v79, v79
    s_nop 2
    v_mov_b32 v79, v79
    s_nop 2
    v_mov_b32 v79, v79
    s_nop 2
    v_mov_b32 v79, v79
    s_nop 2
    v_mov_b32 v79, v79
    s_nop 2
    v_mov_b32 v79, v79
    s_nop 2
    v_mov_b32 v79, v79
    s_nop 2
    v_mov_b32 v79, v79
    s_nop 2
    v_mov_b32 v79, v79
    s_nop 2
    v_mov_b32 v79, v79
    s_nop 2
    v_mov_b32 v79, v79
    s_nop 2
    v_mov_b32 v79, v79
    s_nop 2
    v_mov_b32 v79, v79
    s_nop 2
    v_mov_b32 v79, v79
    s_nop 2
    v_mov_b32 v79, v79
    s_branch cs_loop
cs_f1:
    s_cmp_lg_u32 s32, 1
    s_cbranch_scc1 cs_f3
    v_and_b32 v77, 255, v69
    ds_read_b128 v[4:7], v77 offset:15872
    ds_read_b128 v[44:47], v70 offset:0
    ds_read_b128 v[48:51], v70 offset:1024
    ds_read_b128 v[52:55], v70 offset:2048
    ds_read_b128 v[56:59], v70 offset:3072
    ds_read_b128 v[24:27], v70 offset:4096
    ds_read_b128 v[28:31], v70 offset:5120
    ds_read_b128 v[32:35], v70 offset:6144
    ds_read_b128 v[36:39], v70 offset:7168
    s_mov_b32 s31, 65536
    s_add_u32 s24, s24, 524288
    s_add_u32 s26, s26, 524288
    s_add_u32 s55, s55, s57
    s_mov_b32 s14, 67633152
    s_mov_b32 s15, 67637248
    s_mov_b32 s16, 67641344
    s_mov_b32 s36, 1
    v_mov_b32 v40, s69
    v_mov_b32 v60, s69
    v_and_b32 v79, 12, v75
    v_cmp_eq_u32 vcc, 0, v79
    s_nop 1
    v_cndmask_b32 v79, 0, 1, vcc
    s_cmp_lg_u32 s37, 0
    s_cbranch_scc1 cs_f1_xt
cs_f1_xtx:
    s_nop 2
    v_mov_b32 v79, v79
    s_nop 2
    v_mov_b32 v79, v79
    s_nop 2
    v_mov_b32 v79, v79
    s_nop 2
    v_mov_b32 v79, v79
    s_nop 2
    v_mov_b32 v79, v79
    s_nop 2
    v_mov_b32 v79, v79
    s_nop 2
    v_mov_b32 v79, v79
    s_nop 2
    v_mov_b32 v79, v79
    s_nop 2
    v_mov_b32 v79, v79
    s_nop 2
    v_mov_b32 v79, v79
    s_nop 2
    v_mov_b32 v79, v79
    s_nop 2
    v_mov_b32 v79, v79
    s_nop 2
    v_mov_b32 v79, v79
    s_nop 2
    v_mov_b32 v79, v79
    s_nop 2
    v_mov_b32 v79, v79
    s_nop 2
    v_mov_b32 v79, v79
    s_nop 2
    v_mov_b32 v79, v79
    s_nop 2
    v_mov_b32 v79, v79
    s_nop 2
    v_mov_b32 v79, v79
    s_nop 2
    v_mov_b32 v79, v79
    s_nop 2
    v_mov_b32 v79, v79
    s_nop 2
    v_mov_b32 v79, v79
    s_nop 2
    v_mov_b32 v79, v79
    s_nop 2
    v_mov_b32 v79, v79
    s_nop 2
    v_mov_b32 v79, v79
    s_nop 2
    v_mov_b32 v79, v79
    s_nop 2
    v_mov_b32 v79, v79
    s_nop 2
    v_mov_b32 v79, v79
    s_nop 2
    v_mov_b32 v79, v79
    s_nop 2
    v_mov_b32 v79, v79
    s_nop 2
    v_mov_b32 v79, v79
    s_nop 2
    v_mov_b32 v79, v79
    s_nop 2
    v_mov_b32 v79, v79
    s_nop 2
    v_mov_b32 v79, v79
    s_nop 2
    v_mov_b32 v79, v79
    s_nop 2
    v_mov_b32 v79, v79
    s_nop 0
    v_mov_b32 v79, v79
    s_waitcnt vmcnt(0)
    buffer_load_dwordx4 v[8:11], v65, s[4:7], s18 offen sc1
    buffer_load_dwordx4 v[12:15], v65, s[4:7], s19 offen sc1
    buffer_load_dwordx4 v[16:19], v65, s[4:7], s20 offen sc1
    buffer_load_dwordx4 v[20:23], v65, s[4:7], s21 offen sc1
    s_nop 2
    v_mov_b32 v79, v79
    s_nop 2
    v_mov_b32 v79, v79
    s_nop 2
    v_mov_b32 v79, v79
    s_nop 2
    v_mov_b32 v79, v79
    s_nop 2
    v_mov_b32 v79, v79
    s_nop 2
    v_mov_b32 v79, v79
    s_nop 2
    v_mov_b32 v79, v79
    s_nop 2
    v_mov_b32 v79, v79
    s_nop 2
    v_mov_b32 v79, v79
    s_nop 2
    v_mov_b32 v79, v79
    buffer_load_dwordx4 v[40:43], v65, s[4:7], s14 offen offset:0 sc1
    buffer_load_dwordx4 v[60:63], v66, s[4:7], s14 offen offset:0 sc1
    s_waitcnt lgkmcnt(0)
    s_waitcnt vmcnt(5)
    v_bitop3_b32 v77, v8, v10, s69 bitop3:0x7e
    v_mfma_f32_16x16x32_bf16 v[0:3], v[4:7], v[8:11], 0
    v_mov_b64 v[8:9], 0
    v_mov_b64 v[10:11], 0
    s_waitcnt vmcnt(4)
    v_bitop3_b32 v78, v12, v14, s69 bitop3:0x7e
    v_mfma_f32_16x16x32_bf16 v[0:3], v[4:7], v[12:15], v[0:3]
    v_or_b32 v77, v77, v78
    v_mov_b64 v[12:13], 0
    v_mov_b64 v[14:15], 0
    s_waitcnt vmcnt(3)
    v_bitop3_b32 v78, v16, v18, s69 bitop3:0x7e
    v_mfma_f32_16x16x32_bf16 v[0:3], v[4:7], v[16:19], v[0:3]
    v_or_b32 v77, v77, v78
    v_mov_b64 v[16:17], 0
    v_mov_b64 v[18:19], 0
    s_waitcnt vmcnt(2)
    v_bitop3_b32 v78, v20, v22, s69 bitop3:0x7e
    v_mfma_f32_16x16x32_bf16 v[0:3], v[4:7], v[20:23], v[0:3]
    v_bitop3_b32 v77, v77, v78, 1 bitop3:0xa8
    v_cmp_ne_u32 vcc, 0, v77
    v_mov_b64 v[20:21], 0
    v_mov_b64 v[22:23], 0
    buffer_load_dwordx4 v[40:43], v65, s[4:7], s14 offen offset:0 sc1
    buffer_load_dwordx4 v[60:63], v66, s[4:7], s14 offen offset:0 sc1
    s_cmp_eq_u64 vcc, 0
    s_cselect_b64 s[42:43], -1, 0
    v_add_f32_dpp v0, v0, v0 row_ror:8 row_mask:0xf bank_mask:0xf
    v_add_f32_dpp v1, v1, v1 row_ror:8 row_mask:0xf bank_mask:0xf
    s_mov_b64 exec, s[42:43]
    v_cvt_pk_bf16_f32 v72, v0, v1
    v_bfi_b32 v72, v79, s70, v72
    buffer_store_dword v72, v75, s[4:7], s17 offen offset:0 sc1
    s_mov_b64 exec, -1
    s_cbranch_scc0 cs_f1_retry
cs_f1_go:
    v_mov_b64 v[0:1], 0
    v_mov_b64 v[2:3], 0
    v_mov_b64 v[4:5], 0
    v_mov_b64 v[6:7], 0
    s_nop 2
    v_mov_b32 v79, v79
    s_nop 2
    v_mov_b32 v79, v79
    s_nop 2
    v_mov_b32 v79, v79
    s_nop 2
    v_mov_b32 v79, v79
    s_nop 2
    v_mov_b32 v79, v79
    s_nop 2
    v_mov_b32 v79, v79
    s_nop 2
    v_mov_b32 v79, v79
    s_nop 2
    v_mov_b32 v79, v79
    s_nop 2
    v_mov_b32 v79, v79
    s_nop 2
    v_mov_b32 v79, v79
    s_nop 2
    v_mov_b32 v79, v79
    s_nop 2
    v_mov_b32 v79, v79
    s_nop 2
    v_mov_b32 v79, v79
    s_nop 2
    v_mov_b32 v79, v79
    s_nop 2
    v_mov_b32 v79, v79
    s_nop 2
    v_mov_b32 v79, v79
    s_nop 2
    v_mov_b32 v79, v79
    s_nop 2
    v_mov_b32 v79, v79
    s_nop 2
    v_mov_b32 v79, v79
    s_nop 2
    v_mov_b32 v79, v79
    s_nop 2
    v_mov_b32 v79, v79
    s_nop 2
    v_mov_b32 v79, v79
    s_nop 2
    v_mov_b32 v79, v79
    s_nop 2
    v_mov_b32 v79, v79
    s_nop 2
    v_mov_b32 v79, v79
    s_branch cs_loop
cs_f3:
    v_and_b32 v77, 255, v69
    ds_read_b128 v[4:7], v77 offset:15872
    ds_read_b128 v[44:47], v70 offset:0
    ds_read_b128 v[48:51], v70 offset:1024
    ds_read_b128 v[52:55], v70 offset:2048
    ds_read_b128 v[56:59], v70 offset:3072
    ds_read_b128 v[24:27], v70 offset:4096
    ds_read_b128 v[28:31], v70 offset:5120
    ds_read_b128 v[32:35], v70 offset:6144
    ds_read_b128 v[36:39], v70 offset:7168
    s_mov_b32 s31, 65536
    s_add_u32 s24, s24, 524288
    s_add_u32 s26, s26, 524288
    s_add_u32 s55, s55, s57
    s_mov_b32 s14, 67633152
    s_mov_b32 s15, 67637248
    s_mov_b32 s16, 67641344
    s_mov_b32 s36, 1
    v_mov_b32 v40, s69
    v_mov_b32 v60, s69
    v_and_b32 v79, 12, v75
    v_cmp_eq_u32 vcc, 0, v79
    s_nop 1
    v_cndmask_b32 v79, 0, 1, vcc
    s_add_u32 s40, s30, s95
    v_mov_b32 v72, s40
    s_waitcnt lgkmcnt(0)
    v_mov_b64 v[0:1], 0
    v_mov_b64 v[2:3], 0
    v_mov_b64 v[4:5], 0
    v_mov_b64 v[6:7], 0
    v_mov_b64 v[8:9], 0
    v_mov_b64 v[10:11], 0
    v_mov_b64 v[12:13], 0
    v_mov_b64 v[14:15], 0
    v_mov_b64 v[16:17], 0
    v_mov_b64 v[18:19], 0
    v_mov_b64 v[20:21], 0
    v_mov_b64 v[22:23], 0
    s_nop 2
    v_mov_b32 v79, v79
    s_nop 2
    v_mov_b32 v79, v79
    s_nop 2
    v_mov_b32 v79, v79
    s_nop 2
    v_mov_b32 v79, v79
    s_nop 2
    v_mov_b32 v79, v79
    s_nop 2
    v_mov_b32 v79, v79
    s_nop 2
    v_mov_b32 v79, v79
    s_nop 2
    v_mov_b32 v79, v79
    s_nop 2
    v_mov_b32 v79, v79
    s_nop 2
    v_mov_b32 v79, v79
    s_nop 2
    v_mov_b32 v79, v79
    s_nop 2
    v_mov_b32 v79, v79
    s_nop 2
    v_mov_b32 v79, v79
    s_nop 2
    v_mov_b32 v79, v79
    s_nop 2
    v_mov_b32 v79, v79
    s_nop 2
    v_mov_b32 v79, v79
    s_nop 2
    v_mov_b32 v79, v79
    s_nop 2
    v_mov_b32 v79, v79
    s_nop 2
    v_mov_b32 v79, v79
    s_nop 2
    v_mov_b32 v79, v79
    s_nop 2
    v_mov_b32 v79, v79
    s_nop 2
    v_mov_b32 v79, v79
    s_nop 2
    v_mov_b32 v79, v79
    s_nop 2
    v_mov_b32 v79, v79
    s_nop 2
    v_mov_b32 v79, v79
    s_nop 2
    v_mov_b32 v79, v79
    s_nop 2
    v_mov_b32 v79, v79
    s_nop 2
    v_mov_b32 v79, v79
    s_nop 2
    v_mov_b32 v79, v79
    s_nop 2
    v_mov_b32 v79, v79
    s_nop 2
    v_mov_b32 v79, v79
    s_nop 2
    v_mov_b32 v79, v79
    s_nop 2
    v_mov_b32 v79, v79
    s_nop 2
    v_mov_b32 v79, v79
    s_nop 2
    v_mov_b32 v79, v79
    s_nop 2
    v_mov_b32 v79, v79
    s_nop 2
    v_mov_b32 v79, v79
    s_nop 2
    v_mov_b32 v79, v79
    s_nop 2
    v_mov_b32 v79, v79
    s_nop 2
    v_mov_b32 v79, v79
    s_nop 2
    v_mov_b32 v79, v79
    s_nop 2
    v_mov_b32 v79, v79
    s_nop 2
    v_mov_b32 v79, v79
    s_nop 2
    v_mov_b32 v79, v79
    s_nop 2
    v_mov_b32 v79, v79
    s_nop 2
    v_mov_b32 v79, v79
    s_nop 2
    v_mov_b32 v79, v79
    s_nop 2
    v_mov_b32 v79, v79
    s_nop 2
    v_mov_b32 v79, v79
    s_nop 2
    v_mov_b32 v79, v79
    s_nop 2
    v_mov_b32 v79, v79
    s_nop 2
    v_mov_b32 v79, v79
    s_nop 2
    v_mov_b32 v79, v79
    s_nop 2
    v_mov_b32 v79, v79
    s_nop 2
    v_mov_b32 v79, v79
    s_nop 2
    v_mov_b32 v79, v79
    s_nop 2
    v_mov_b32 v79, v79
    s_nop 2
    v_mov_b32 v79, v79
    s_nop 2
    v_mov_b32 v79, v79
    s_nop 2
    v_mov_b32 v79, v79
    s_nop 2
    v_mov_b32 v79, v79
    s_nop 2
    v_mov_b32 v79, v79
    s_nop 2
    v_mov_b32 v79, v79
    s_nop 2
    v_mov_b32 v79, v79
    s_nop 2
    v_mov_b32 v79, v79
    s_waitcnt vmcnt(0)
    s_cmp_lt_u32 s97, s93
    s_cbranch_scc1 cs_kvwait
    s_nop 2
    v_mov_b32 v79, v79
    s_nop 2
    v_mov_b32 v79, v79
    s_nop 2
    v_mov_b32 v79, v79
    s_nop 2
    v_mov_b32 v79, v79
    s_nop 2
    v_mov_b32 v79, v79
    s_nop 2
    v_mov_b32 v79, v79
    s_nop 2
    v_mov_b32 v79, v79
    s_nop 2
    v_mov_b32 v79, v79
cs_kvok:
    s_branch cs_loop
cs_f0_xt:
    s_sub_u32 s37, s37, 1
    s_nop 2
    v_mov_b32 v79, v79
    s_nop 2
    v_mov_b32 v79, v79
    s_nop 2
    v_mov_b32 v79, v79
    s_nop 2
    v_mov_b32 v79, v79
    s_nop 2
    v_mov_b32 v79, v79
    s_nop 2
    v_mov_b32 v79, v79
    s_branch cs_f0_xtx
cs_f0_retry:
    s_sub_u32 s41, s30, s98
    s_mov_b32 s98, s30
    s_cmp_le_u32 s41, 3
    s_cselect_b32 s37, 1, 1
cs_f0_spin:
    buffer_load_dwordx4 v[8:11], v65, s[4:7], s18 offen sc1
    buffer_load_dwordx4 v[12:15], v65, s[4:7], s19 offen sc1
    buffer_load_dwordx4 v[16:19], v65, s[4:7], s20 offen sc1
    buffer_load_dwordx4 v[20:23], v65, s[4:7], s21 offen sc1
    s_nop 2
    v_mov_b32 v79, v79
    s_nop 2
    v_mov_b32 v79, v79
    s_nop 2
    v_mov_b32 v79, v79
    buffer_load_dwordx4 v[40:43], v65, s[4:7], s14 offen offset:0 sc1
    buffer_load_dwordx4 v[60:63], v66, s[4:7], s14 offen offset:0 sc1
    s_waitcnt vmcnt(5)
    v_bitop3_b32 v77, v8, v10, s69 bitop3:0x7e
    v_mfma_f32_16x16x32_bf16 v[0:3], v[4:7], v[8:11], 0
    v_mov_b64 v[8:9], 0
    v_mov_b64 v[10:11], 0
    s_waitcnt vmcnt(4)
    v_bitop3_b32 v78, v12, v14, s69 bitop3:0x7e
    v_mfma_f32_16x16x32_bf16 v[0:3], v[4:7], v[12:15], v[0:3]
    v_or_b32 v77, v77, v78
    v_mov_b64 v[12:13], 0
    v_mov_b64 v[14:15], 0
    s_waitcnt vmcnt(3)
    v_bitop3_b32 v78, v16, v18, s69 bitop3:0x7e
    v_mfma_f32_16x16x32_bf16 v[0:3], v[4:7], v[16:19], v[0:3]
    v_or_b32 v77, v77, v78
    v_mov_b64 v[16:17], 0
    v_mov_b64 v[18:19], 0
    s_waitcnt vmcnt(2)
    v_bitop3_b32 v78, v20, v22, s69 bitop3:0x7e
    v_mfma_f32_16x16x32_bf16 v[0:3], v[4:7], v[20:23], v[0:3]
    v_bitop3_b32 v77, v77, v78, 1 bitop3:0xa8
    v_cmp_ne_u32 vcc, 0, v77
    v_mov_b64 v[20:21], 0
    v_mov_b64 v[22:23], 0
    buffer_load_dwordx4 v[40:43], v65, s[4:7], s14 offen offset:0 sc1
    buffer_load_dwordx4 v[60:63], v66, s[4:7], s14 offen offset:0 sc1
    s_cmp_eq_u64 vcc, 0
    s_cselect_b64 s[42:43], -1, 0
    v_add_f32_dpp v0, v0, v0 row_ror:8 row_mask:0xf bank_mask:0xf
    v_add_f32_dpp v1, v1, v1 row_ror:8 row_mask:0xf bank_mask:0xf
    s_mov_b64 exec, s[42:43]
    v_cvt_pk_bf16_f32 v72, v0, v1
    v_bfi_b32 v72, v79, s70, v72
    buffer_store_dword v72, v75, s[4:7], s17 offen offset:0 sc1
    s_mov_b64 exec, -1
    s_cbranch_scc1 cs_f0_rx
    s_sub_u32 s31, s31, 1
    s_cbranch_scc0 cs_f0_spin
cs_f0_rx:
    v_mov_b64 v[0:1], 0
    v_mov_b64 v[2:3], 0
    v_mov_b64 v[4:5], 0
    v_mov_b64 v[6:7], 0
    s_branch cs_loop
cs_f1_xt:
    s_sub_u32 s37, s37, 1
    s_nop 2
    v_mov_b32 v79, v79
    s_nop 2
    v_mov_b32 v79, v79
    s_nop 2
    v_mov_b32 v79, v79
    s_nop 2
    v_mov_b32 v79, v79
    s_nop 2
    v_mov_b32 v79, v79
    s_nop 2
    v_mov_b32 v79, v79
    s_branch cs_f1_xtx
cs_f1_retry:
    s_sub_u32 s41, s30, s98
    s_mov_b32 s98, s30
    s_cmp_le_u32 s41, 3
    s_cselect_b32 s37, 1, 1
cs_f1_spin:
    buffer_load_dwordx4 v[8:11], v65, s[4:7], s18 offen sc1
    buffer_load_dwordx4 v[12:15], v65, s[4:7], s19 offen sc1
    buffer_load_dwordx4 v[16:19], v65, s[4:7], s20 offen sc1
    buffer_load_dwordx4 v[20:23], v65, s[4:7], s21 offen sc1
    s_nop 2
    v_mov_b32 v79, v79
    s_nop 2
    v_mov_b32 v79, v79
    s_nop 2
    v_mov_b32 v79, v79
    buffer_load_dwordx4 v[40:43], v65, s[4:7], s14 offen offset:0 sc1
    buffer_load_dwordx4 v[60:63], v66, s[4:7], s14 offen offset:0 sc1
    s_waitcnt vmcnt(5)
    v_bitop3_b32 v77, v8, v10, s69 bitop3:0x7e
    v_mfma_f32_16x16x32_bf16 v[0:3], v[4:7], v[8:11], 0
    v_mov_b64 v[8:9], 0
    v_mov_b64 v[10:11], 0
    s_waitcnt vmcnt(4)
    v_bitop3_b32 v78, v12, v14, s69 bitop3:0x7e
    v_mfma_f32_16x16x32_bf16 v[0:3], v[4:7], v[12:15], v[0:3]
    v_or_b32 v77, v77, v78
    v_mov_b64 v[12:13], 0
    v_mov_b64 v[14:15], 0
    s_waitcnt vmcnt(3)
    v_bitop3_b32 v78, v16, v18, s69 bitop3:0x7e
    v_mfma_f32_16x16x32_bf16 v[0:3], v[4:7], v[16:19], v[0:3]
    v_or_b32 v77, v77, v78
    v_mov_b64 v[16:17], 0
    v_mov_b64 v[18:19], 0
    s_waitcnt vmcnt(2)
    v_bitop3_b32 v78, v20, v22, s69 bitop3:0x7e
    v_mfma_f32_16x16x32_bf16 v[0:3], v[4:7], v[20:23], v[0:3]
    v_bitop3_b32 v77, v77, v78, 1 bitop3:0xa8
    v_cmp_ne_u32 vcc, 0, v77
    v_mov_b64 v[20:21], 0
    v_mov_b64 v[22:23], 0
    buffer_load_dwordx4 v[40:43], v65, s[4:7], s14 offen offset:0 sc1
    buffer_load_dwordx4 v[60:63], v66, s[4:7], s14 offen offset:0 sc1
    s_cmp_eq_u64 vcc, 0
    s_cselect_b64 s[42:43], -1, 0
    v_add_f32_dpp v0, v0, v0 row_ror:8 row_mask:0xf bank_mask:0xf
    v_add_f32_dpp v1, v1, v1 row_ror:8 row_mask:0xf bank_mask:0xf
    s_mov_b64 exec, s[42:43]
    v_cvt_pk_bf16_f32 v72, v0, v1
    v_bfi_b32 v72, v79, s70, v72
    buffer_store_dword v72, v75, s[4:7], s17 offen offset:0 sc1
    s_mov_b64 exec, -1
    s_cbranch_scc1 cs_f1_rx
    s_sub_u32 s31, s31, 1
    s_cbranch_scc0 cs_f1_spin
cs_f1_rx:
    v_mov_b64 v[0:1], 0
    v_mov_b64 v[2:3], 0
    v_mov_b64 v[4:5], 0
    v_mov_b64 v[6:7], 0
    s_branch cs_loop
cs_f2_xt:
    s_sub_u32 s37, s37, 1
    s_nop 2
    v_mov_b32 v79, v79
    s_nop 2
    v_mov_b32 v79, v79
    s_nop 2
    v_mov_b32 v79, v79
    s_nop 2
    v_mov_b32 v79, v79
    s_nop 2
    v_mov_b32 v79, v79
    s_nop 2
    v_mov_b32 v79, v79
    s_branch cs_f2_xtx
cs_f2_retry:
    s_sub_u32 s41, s30, s98
    s_mov_b32 s98, s30
    s_cmp_le_u32 s41, 3
    s_cselect_b32 s37, 1, 1
cs_f2_spin:
    buffer_load_dwordx4 v[8:11], v65, s[4:7], s18 offen sc1
    buffer_load_dwordx4 v[12:15], v65, s[4:7], s19 offen sc1
    buffer_load_dwordx4 v[16:19], v65, s[4:7], s20 offen sc1
    buffer_load_dwordx4 v[20:23], v65, s[4:7], s21 offen sc1
    s_nop 2
    v_mov_b32 v79, v79
    s_nop 2
    v_mov_b32 v79, v79
    s_nop 2
    v_mov_b32 v79, v79
    buffer_load_dwordx4 v[40:43], v65, s[4:7], s14 offen offset:0 sc1
    buffer_load_dwordx4 v[60:63], v66, s[4:7], s14 offen offset:0 sc1
    s_waitcnt vmcnt(5)
    v_bitop3_b32 v77, v8, v10, s69 bitop3:0x7e
    v_mfma_f32_16x16x32_bf16 v[0:3], v[4:7], v[8:11], 0
    v_mov_b64 v[8:9], 0
    v_mov_b64 v[10:11], 0
    s_waitcnt vmcnt(4)
    v_bitop3_b32 v78, v12, v14, s69 bitop3:0x7e
    v_mfma_f32_16x16x32_bf16 v[0:3], v[4:7], v[12:15], v[0:3]
    v_or_b32 v77, v77, v78
    v_mov_b64 v[12:13], 0
    v_mov_b64 v[14:15], 0
    s_waitcnt vmcnt(3)
    v_bitop3_b32 v78, v16, v18, s69 bitop3:0x7e
    v_mfma_f32_16x16x32_bf16 v[0:3], v[4:7], v[16:19], v[0:3]
    v_or_b32 v77, v77, v78
    v_mov_b64 v[16:17], 0
    v_mov_b64 v[18:19], 0
    s_waitcnt vmcnt(2)
    v_bitop3_b32 v78, v20, v22, s69 bitop3:0x7e
    v_mfma_f32_16x16x32_bf16 v[0:3], v[4:7], v[20:23], v[0:3]
    v_bitop3_b32 v77, v77, v78, 1 bitop3:0xa8
    v_cmp_ne_u32 vcc, 0, v77
    v_mov_b64 v[20:21], 0
    v_mov_b64 v[22:23], 0
    buffer_load_dwordx4 v[40:43], v65, s[4:7], s14 offen offset:0 sc1
    buffer_load_dwordx4 v[60:63], v66, s[4:7], s14 offen offset:0 sc1
    s_cmp_eq_u64 vcc, 0
    s_cselect_b64 s[42:43], -1, 0
    v_add_f32_dpp v0, v0, v0 row_ror:4 row_mask:0xf bank_mask:0xf
    v_add_f32_dpp v1, v1, v1 row_ror:4 row_mask:0xf bank_mask:0xf
    s_nop 0
    v_add_f32_dpp v0, v0, v0 row_ror:8 row_mask:0xf bank_mask:0xf
    v_add_f32_dpp v1, v1, v1 row_ror:8 row_mask:0xf bank_mask:0xf
    s_mov_b64 exec, s[42:43]
    v_cvt_pk_bf16_f32 v72, v0, v1
    v_bfi_b32 v72, v79, s70, v72
    buffer_store_dword v72, v75, s[4:7], s17 offen offset:0 sc1
    buffer_store_dword v72, v75, s[4:7], s17 offen offset:1024 sc1
    buffer_store_dword v72, v75, s[4:7], s17 offen offset:2048 sc1
    buffer_store_dword v72, v75, s[4:7], s17 offen offset:3072 sc1
    s_mov_b64 exec, -1
    s_cbranch_scc1 cs_f2_rx
    s_sub_u32 s31, s31, 1
    s_cbranch_scc0 cs_f2_spin
cs_f2_rx:
    v_mov_b64 v[0:1], 0
    v_mov_b64 v[2:3], 0
    v_mov_b64 v[4:5], 0
    v_mov_b64 v[6:7], 0
    s_branch cs_loop
cs_spinB:
    s_waitcnt vmcnt(3)
cs_spinB_l:
    v_and_b32 v77, s36, v44
    v_cmp_ne_u32 vcc, s70, v77
    s_cbranch_vccz cs_spinB_x
    buffer_load_dwordx4 v[44:47], v65, s[4:7], s15 offen sc1
    s_sub_u32 s31, s31, 16
    s_waitcnt vmcnt(0)
    s_cbranch_scc0 cs_spinB_l
cs_spinB_x:
    ds_write_b128 v65, v[44:47] offset:4096
    s_waitcnt lgkmcnt(0)
    s_branch cs_backB
cs_spin8:
    buffer_load_dwordx4 v[40:43], v65, s[4:7], s16 offen sc1
cs_spin8_l:
    v_and_b32 v77, s36, v40
    v_cmp_ne_u32 vcc, s70, v77
    s_cbranch_vccz cs_spin8_x
    s_nop 15
    s_nop 15
    s_nop 15
    s_nop 11
    v_and_b32 v77, s36, v40
    v_cmp_ne_u32 vcc, s70, v77
    s_cbranch_vccz cs_spin8_x
    s_nop 15
    s_nop 15
    s_nop 15
    s_nop 11
    v_and_b32 v77, s36, v40
    v_cmp_ne_u32 vcc, s70, v77
    s_cbranch_vccz cs_spin8_x
    s_nop 15
    s_nop 15
    s_nop 15
    s_nop 11
    buffer_load_dwordx4 v[40:43], v65, s[4:7], s16 offen sc1
    s_sub_u32 s31, s31, 16
    s_cbranch_scc0 cs_spin8_l
cs_spin8_x:
    s_branch cs_back8
cs_rare:
    s_mov_b64 exec, s[34:35]
    buffer_store_dwordx4 v[0:3], v65, s[4:7], s28 offen sc1
    s_mov_b64 exec, -1
    s_nop 3
    v_cvt_pk_bf16_f32 v52, v16, v17
    v_cvt_pk_bf16_f32 v53, v18, v19
    v_cvt_pk_bf16_f32 v54, v20, v21
    v_cvt_pk_bf16_f32 v55, v22, v23
    buffer_store_dwordx4 v[52:55], v65, s[4:7], s27 offen sc1
    s_add_u32 s28, s28, 131072
    s_add_u32 s27, s27, 131072
    s_cmp_eq_u32 s30, 63
    s_cbranch_scc1 cs_last
    s_branch cs_rare_x
cs_kvwait:
    s_mov_b32 s41, s97
    v_bfe_u32 v78, v65, 2, 5
    v_mov_b32 v77, v76
    s_nop 1
    v_permlane32_swap_b32 v76, v77
    v_subrev_u32 v77, s95, v77
    v_cmp_lt_u32 vcc, 16, v77
    s_nop 1
    v_cndmask_b32 v77, v77, 0, vcc
    v_bfe_u32 v79, v78, 2, 2
    v_lshl_add_u32 v77, v77, 2, v79
    s_nop 1
    v_min_u32_dpp v77, v77, v77 row_ror:1 row_mask:0xf bank_mask:0xf
    s_nop 1
    v_min_u32_dpp v77, v77, v77 row_ror:2 row_mask:0xf bank_mask:0xf
    s_nop 1
    v_min_u32_dpp v77, v77, v77 row_ror:4 row_mask:0xf bank_mask:0xf
    s_nop 0
    v_readfirstlane_b32 s97, v77
    s_nop 0
    s_max_u32 s97, s97, s41
    s_add_u32 s40, s30, 3
    s_min_u32 s40, s40, 64
    s_cmp_le_u32 s40, s97
    s_cbranch_scc1 cs_kvw_x
    v_bfe_u32 v78, v65, 2, 5
    s_mov_b32 s31, 4194304
cs_kvw:
    buffer_load_dword v77, v78, s[4:7], s96 offen offset:16 sc1
    s_waitcnt vmcnt(0)
    v_subrev_u32 v77, s95, v77
    v_cmp_lt_u32 vcc, 16, v77
    s_nop 1
    v_cndmask_b32 v77, v77, 0, vcc
    v_bfe_u32 v79, v78, 2, 2
    v_lshl_add_u32 v77, v77, 2, v79
    s_nop 1
    v_min_u32_dpp v77, v77, v77 row_ror:1 row_mask:0xf bank_mask:0xf
    s_nop 1
    v_min_u32_dpp v77, v77, v77 row_ror:2 row_mask:0xf bank_mask:0xf
    s_nop 1
    v_min_u32_dpp v77, v77, v77 row_ror:4 row_mask:0xf bank_mask:0xf
    s_nop 0
    v_readfirstlane_b32 s97, v77
    s_sub_u32 s31, s31, 1
    s_cbranch_scc1 cs_kvw_x
    s_cmp_le_u32 s40, s97
    s_cbranch_scc1 cs_kvw_x
    s_sleep 2
    s_branch cs_kvw
cs_kvw_x:
    s_branch cs_kvok
cs_last:
    s_add_u32 s40, s95, 64
    v_mov_b32 v78, s40
    s_waitcnt vmcnt(0)
    s_barrier
    s_mov_b64 exec, s[100:101]
    buffer_store_dword v78, off, s[4:7], s29 sc1
    s_mov_b64 exec, -1
cs_end:
    s_endpgm
L_xform:
    v_and_b32 v1, 63, v0
    v_and_b32 v2, 15, v1
    v_lshrrev_b32 v3, 4, v1
    v_mov_b32 v7, 0x05040100
    v_mov_b32 v8, 0x07060302
    v_lshrrev_b32 v9, 6, v0
    v_lshlrev_b32 v9, 14, v9
    v_lshlrev_b32 v10, 4, v1
    v_add_u32 v11, v9, v10
    s_mov_b32 s10, 4718592
    s_mov_b32 s11, 0x20000
    s_mov_b64 s[8:9], s[58:59]
xf_f:
    s_sub_u32 s17, s16, 1504
    s_and_b32 s18, s17, 127
    s_lshr_b32 s17, s17, 7
    s_lshl_b32 s19, s17, 4
    v_add_u32 v6, s19, v2
    v_mul_u32_u24 v4, 9216, v3
    v_lshl_add_u32 v4, v6, 4, v4
    v_lshrrev_b32 v5, 2, v2
    v_lshlrev_b32 v5, 11, v5
    v_lshl_add_u32 v5, v3, 8, v5
    v_and_b32 v1, 3, v6
    v_lshl_add_u32 v5, v1, 6, v5
    v_add_u32 v5, v5, v9
    v_cmp_gt_u32 vcc, 72, v6
    s_nop 0
    s_mov_b64 exec, vcc
    s_mul_i32 s20, s18, 36864
    s_add_u32 s21, s20, 0
    buffer_load_dwordx4 v[12:15], v4, s[8:11], s21 offen
    s_add_u32 s21, s20, 1152
    buffer_load_dwordx4 v[16:19], v4, s[8:11], s21 offen
    s_add_u32 s21, s20, 2304
    buffer_load_dwordx4 v[20:23], v4, s[8:11], s21 offen
    s_add_u32 s21, s20, 3456
    buffer_load_dwordx4 v[24:27], v4, s[8:11], s21 offen
    s_add_u32 s21, s20, 4608
    buffer_load_dwordx4 v[28:31], v4, s[8:11], s21 offen
    s_add_u32 s21, s20, 5760
    buffer_load_dwordx4 v[32:35], v4, s[8:11], s21 offen
    s_add_u32 s21, s20, 6912
    buffer_load_dwordx4 v[36:39], v4, s[8:11], s21 offen
    s_add_u32 s21, s20, 8064
    buffer_load_dwordx4 v[40:43], v4, s[8:11], s21 offen
    s_lshl_b32 s20, s18, 11
    s_add_u32 s20, s20, 130023424
    s_waitcnt vmcnt(0)
    v_perm_b32 v76, v16, v12, v7
    v_perm_b32 v77, v24, v20, v7
    v_perm_b32 v78, v32, v28, v7
    v_perm_b32 v79, v40, v36, v7
    ds_write_b128 v5, v[76:79] offset:0
    v_perm_b32 v80, v17, v13, v7
    v_perm_b32 v81, v25, v21, v7
    v_perm_b32 v82, v33, v29, v7
    v_perm_b32 v83, v41, v37, v7
    ds_write_b128 v5, v[80:83] offset:16
    v_perm_b32 v84, v18, v14, v7
    v_perm_b32 v85, v26, v22, v7
    v_perm_b32 v86, v34, v30, v7
    v_perm_b32 v87, v42, v38, v7
    ds_write_b128 v5, v[84:87] offset:32
    v_perm_b32 v88, v19, v15, v7
    v_perm_b32 v89, v27, v23, v7
    v_perm_b32 v90, v35, v31, v7
    v_perm_b32 v91, v43, v39, v7
    ds_write_b128 v5, v[88:91] offset:48
    v_perm_b32 v92, v16, v12, v8
    v_perm_b32 v93, v24, v20, v8
    v_perm_b32 v94, v32, v28, v8
    v_perm_b32 v95, v40, v36, v8
    ds_write_b128 v5, v[92:95] offset:1024
    v_perm_b32 v96, v17, v13, v8
    v_perm_b32 v97, v25, v21, v8
    v_perm_b32 v98, v33, v29, v8
    v_perm_b32 v99, v41, v37, v8
    ds_write_b128 v5, v[96:99] offset:1040
    v_perm_b32 v100, v18, v14, v8
    v_perm_b32 v101, v26, v22, v8
    v_perm_b32 v102, v34, v30, v8
    v_perm_b32 v103, v42, v38, v8
    ds_write_b128 v5, v[100:103] offset:1056
    v_perm_b32 v104, v19, v15, v8
    v_perm_b32 v105, v27, v23, v8
    v_perm_b32 v106, v35, v31, v8
    v_perm_b32 v107, v43, v39, v8
    ds_write_b128 v5, v[104:107] offset:1072
    s_mov_b64 exec, -1
    s_lshl_b32 s21, s17, 20
    s_add_u32 s20, s20, s21
    s_waitcnt lgkmcnt(0)
    ds_read_b128 v[76:79], v11 offset:0
    ds_read_b128 v[80:83], v11 offset:1024
    ds_read_b128 v[84:87], v11 offset:2048
    ds_read_b128 v[88:91], v11 offset:3072
    ds_read_b128 v[92:95], v11 offset:4096
    ds_read_b128 v[96:99], v11 offset:5120
    ds_read_b128 v[100:103], v11 offset:6144
    ds_read_b128 v[104:107], v11 offset:7168
    s_add_u32 s19, s20, 0
    s_waitcnt lgkmcnt(7)
    buffer_store_dwordx4 v[76:79], v10, s[4:7], s19 offen sc1
    s_add_u32 s19, s20, 1024
    s_waitcnt lgkmcnt(6)
    buffer_store_dwordx4 v[80:83], v10, s[4:7], s19 offen sc1
    s_add_u32 s19, s20, 262144
    s_waitcnt lgkmcnt(5)
    buffer_store_dwordx4 v[84:87], v10, s[4:7], s19 offen sc1
    s_add_u32 s19, s20, 263168
    s_waitcnt lgkmcnt(4)
    buffer_store_dwordx4 v[88:91], v10, s[4:7], s19 offen sc1
    s_add_u32 s19, s20, 524288
    s_waitcnt lgkmcnt(3)
    buffer_store_dwordx4 v[92:95], v10, s[4:7], s19 offen sc1
    s_add_u32 s19, s20, 525312
    s_waitcnt lgkmcnt(2)
    buffer_store_dwordx4 v[96:99], v10, s[4:7], s19 offen sc1
    s_add_u32 s19, s20, 786432
    s_waitcnt lgkmcnt(1)
    buffer_store_dwordx4 v[100:103], v10, s[4:7], s19 offen sc1
    s_add_u32 s19, s20, 787456
    s_waitcnt lgkmcnt(0)
    buffer_store_dwordx4 v[104:107], v10, s[4:7], s19 offen sc1
xf_done:
    s_nop 1
    s_setpc_b64 s[46:47]
L_helper:
    s_load_dwordx16 s[64:79], s[0:1], 64
    s_waitcnt lgkmcnt(0)
    s_mov_b32 s93, 1000
    s_mov_b32 s95, 0
    s_cmp_lg_u32 s3, 2
    s_cbranch_scc1 L_qkv_next
    s_mov_b32 s37, 24
    v_mov_b32 v250, 1
    v_mov_b32 v251, 163832
    v_cmp_eq_u32 vcc, 0, v0
    s_nop 0
    s_and_saveexec_b64 s[38:39], vcc
    s_cbranch_execz tk3
    buffer_atomic_add v250, off, s[84:87], s37 sc0
    s_waitcnt vmcnt(0)
    ds_write_b32 v251, v250
    s_waitcnt lgkmcnt(0)
tk3:
    s_mov_b64 exec, -1
    s_barrier
    ds_read_b32 v252, v251
    s_waitcnt lgkmcnt(0)
    v_readfirstlane_b32 s36, v252
    s_barrier
    s_nop 3
    s_cmp_ge_u32 s36, 32
    s_cbranch_scc1 L_qkv_next
    s_mov_b32 s93, 0
    s_mov_b32 s88, 4194304
gn4:
    buffer_load_dword v250, off, s[84:87], 0 offset:216 sc1
    s_waitcnt vmcnt(0)
    v_readfirstlane_b32 s95, v250
    s_sub_u32 s88, s88, 1
    s_cbranch_scc1 gn4x
    s_cmp_eq_u32 s95, 0
    s_cbranch_scc1 gn4
gn4x:
    s_cmp_eq_u32 s36, 0
    s_cbranch_scc1 L_relay
    s_branch L_wf_next
L_qkv_next:
    s_mov_b32 s37, 4
    v_mov_b32 v250, 1
    v_mov_b32 v251, 163832
    v_cmp_eq_u32 vcc, 0, v0
    s_nop 0
    s_and_saveexec_b64 s[38:39], vcc
    s_cbranch_execz tk5
    buffer_atomic_add v250, off, s[84:87], s37 sc0
    s_waitcnt vmcnt(0)
    ds_write_b32 v251, v250
    s_waitcnt lgkmcnt(0)
tk5:
    s_mov_b64 exec, -1
    s_barrier
    ds_read_b32 v252, v251
    s_waitcnt lgkmcnt(0)
    v_readfirstlane_b32 s36, v252
    s_barrier
    s_nop 3
    s_or_b32 s37, s36, s32
    s_cbranch_scc1 L_non
    s_memrealtime s[90:91]
    s_waitcnt lgkmcnt(0)
    s_lshl_b32 s90, s90, 8
    s_or_b32 s90, s90, 1
    v_mov_b32 v250, s90
    s_mov_b64 exec, 1
    buffer_store_dword v250, off, s[84:87], 0 offset:216 sc1
    s_mov_b64 exec, -1
L_non:
    s_cmp_lt_u32 s36, 192
    s_cbranch_scc1 L_qkv
    s_cmp_lg_u32 s95, 0
    s_cbranch_scc1 L_hn
    s_mov_b32 s88, 4194304
gn6:
    buffer_load_dword v250, off, s[84:87], 0 offset:216 sc1
    s_waitcnt vmcnt(0)
    v_readfirstlane_b32 s95, v250
    s_sub_u32 s88, s88, 1
    s_cbranch_scc1 gn6x
    s_cmp_eq_u32 s95, 0
    s_cbranch_scc1 gn6
gn6x:
L_hn:
    s_sub_u32 s45, s36, 192
    s_cmp_lg_u32 s36, 192
    s_cbranch_scc1 L_phase2
    s_mov_b32 s37, 24
    v_mov_b32 v250, 1
    v_mov_b32 v251, 163832
    v_cmp_eq_u32 vcc, 0, v0
    s_nop 0
    s_and_saveexec_b64 s[38:39], vcc
    s_cbranch_execz tk7
    buffer_atomic_add v250, off, s[84:87], s37 sc0
    s_waitcnt vmcnt(0)
    ds_write_b32 v251, v250
    s_waitcnt lgkmcnt(0)
tk7:
    s_mov_b64 exec, -1
    s_barrier
    ds_read_b32 v252, v251
    s_waitcnt lgkmcnt(0)
    v_readfirstlane_b32 s36, v252
    s_barrier
    s_nop 3
    s_cmp_lg_u32 s36, 0
    s_cbranch_scc1 L_phase2
L_relay:
    s_cmp_lg_u32 s32, 0
    s_cbranch_scc1 L_exit
    v_and_b32 v3, 31, v0
    v_lshlrev_b32 v3, 7, v3
    s_mov_b32 s17, 0
    s_mov_b32 s23, 125845504
    s_mov_b32 s24, 125853696
    s_mov_b32 s21, 16777216
rl_rwait:
    buffer_load_dword v4, v3, s[4:7], s23 offen sc1
    s_waitcnt vmcnt(0)
    v_subrev_u32 v4, s95, v4
    v_cmp_lt_u32 vcc, 64, v4
    s_nop 1
    v_cndmask_b32 v4, v4, 0, vcc
    s_nop 1
    v_min_u32_dpp v4, v4, v4 row_ror:1 row_mask:0xf bank_mask:0xf
    s_nop 1
    v_min_u32_dpp v4, v4, v4 row_ror:2 row_mask:0xf bank_mask:0xf
    s_nop 1
    v_min_u32_dpp v4, v4, v4 row_ror:4 row_mask:0xf bank_mask:0xf
    s_nop 1
    v_min_u32_dpp v4, v4, v4 row_ror:8 row_mask:0xf bank_mask:0xf
    s_nop 0
    v_readlane_b32 s16, v4, 0
    v_readlane_b32 s22, v4, 16
    s_nop 0
    s_min_u32 s16, s16, s22
    s_sub_u32 s21, s21, 1
    s_cbranch_scc1 rl_x
    s_cmp_gt_u32 s16, s17
    s_cbranch_scc1 rl_rpub
    s_sleep 2
    s_branch rl_rwait
rl_rpub:
    s_mov_b32 s17, s16
    s_add_u32 s22, s16, s95
    v_mov_b32 v4, s22
    s_mov_b64 exec, 1
    buffer_store_dword v4, off, s[4:7], s24 sc1
    s_mov_b64 exec, -1
    s_cmp_lt_u32 s16, 64
    s_cbranch_scc1 rl_rwait
rl_x:
    s_endpgm
L_qkv:
    s_sub_u32 s33, s36, 32
    s_and_b32 s17, s36, 15
    s_lshl_b32 s17, s17, 1
    s_lshr_b32 s36, s36, 4
    s_and_b32 s16, s36, 1
    s_add_u32 s16, s16, 1
    s_lshr_b32 s19, s36, 1
    s_and_b32 s37, s36, 3
    s_cmp_ge_u32 s36, 8
    s_cselect_b32 s16, 0, s16
    s_cselect_b32 s19, s37, s19
    v_lshrrev_b32 v4, 6, v0
    s_nop 0
    v_readfirstlane_b32 s18, v4
    v_lshlrev_b32 v7, 4, v0
    s_cmp_eq_u32 s16, 1
    s_cselect_b64 s[12:13], s[54:55], s[52:53]
    s_cmp_eq_u32 s16, 2
    s_cselect_b64 s[12:13], s[56:57], s[12:13]
    s_mov_b32 s14, 4718592
    s_mov_b32 s15, 0x20000
    v_bfe_u32 v4, v0, 5, 1
    v_lshlrev_b32 v5, 2, v4
    v_and_b32 v8, 31, v0
    v_xor_b32 v8, v8, v5
    v_lshlrev_b32 v8, 4, v8
    v_lshl_add_u32 v8, v4, 13, v8
    v_xor_b32 v9, 128, v8
    s_lshl_b32 s21, s17, 8
    s_lshl_b32 s42, s18, 16
    s_add_u32 s42, s42, s21
    s_lshl_b32 s44, s18, 12
    s_barrier
    s_add_u32 m0, s44, 73728
    s_add_u32 s22, s42, 0
    buffer_load_dwordx4 v8, s[12:15], s22 offen offset:0 lds
    s_add_u32 s22, s42, 15360
    buffer_load_dwordx4 v9, s[12:15], s22 offen offset:1024 lds
    s_add_u32 s22, s42, 30720
    buffer_load_dwordx4 v8, s[12:15], s22 offen offset:2048 lds
    s_add_u32 s22, s42, 46080
    buffer_load_dwordx4 v9, s[12:15], s22 offen offset:3072 lds
    s_add_u32 m0, s44, 90112
    s_add_u32 s22, s42, 262144
    buffer_load_dwordx4 v8, s[12:15], s22 offen offset:0 lds
    s_add_u32 s22, s42, 277504
    buffer_load_dwordx4 v9, s[12:15], s22 offen offset:1024 lds
    s_add_u32 s22, s42, 292864
    buffer_load_dwordx4 v8, s[12:15], s22 offen offset:2048 lds
    s_add_u32 s22, s42, 308224
    buffer_load_dwordx4 v9, s[12:15], s22 offen offset:3072 lds
    s_add_u32 m0, s44, 106496
    s_add_u32 s22, s42, 524288
    buffer_load_dwordx4 v8, s[12:15], s22 offen offset:0 lds
    s_add_u32 s22, s42, 539648
    buffer_load_dwordx4 v9, s[12:15], s22 offen offset:1024 lds
    s_add_u32 s22, s42, 555008
    buffer_load_dwordx4 v8, s[12:15], s22 offen offset:2048 lds
    s_add_u32 s22, s42, 570368
    buffer_load_dwordx4 v9, s[12:15], s22 offen offset:3072 lds
    s_add_u32 m0, s44, 122880
    s_add_u32 s22, s42, 786432
    buffer_load_dwordx4 v8, s[12:15], s22 offen offset:0 lds
    s_add_u32 s22, s42, 801792
    buffer_load_dwordx4 v9, s[12:15], s22 offen offset:1024 lds
    s_add_u32 s22, s42, 817152
    buffer_load_dwordx4 v8, s[12:15], s22 offen offset:2048 lds
    s_add_u32 s22, s42, 832512
    buffer_load_dwordx4 v9, s[12:15], s22 offen offset:3072 lds
    v_bfe_u32 v4, v0, 2, 2
    v_xor_b32 v5, s18, v4
    v_lshlrev_b32 v10, 6, v5
    v_lshl_add_u32 v10, v4, 9, v10
    v_and_b32 v4, 3, v0
    v_lshl_add_u32 v10, v4, 4, v10
    v_bfe_u32 v4, v0, 4, 2
    v_lshl_add_u32 v10, v4, 12, v10
    v_add_u32 v10, 73728, v10
    v_add_u32 v11, 49152, v10
    v_and_b32 v4, 63, v0
    v_and_b32 v5, 15, v4
    v_lshrrev_b32 v3, 4, v4
    v_lshrrev_b32 v2, 2, v5
    v_xor_b32 v3, v3, v2
    v_lshl_add_u32 v3, v5, 2, v3
    v_lshlrev_b32 v1, 4, v3
    v_lshrrev_b32 v5, 2, v4
    v_lshrrev_b32 v3, 4, v4
    v_and_b32 v4, 3, v4
    v_xor_b32 v4, v4, v3
    v_lshlrev_b32 v3, 3, v3
    v_and_b32 v5, 3, v5
    v_add_u32 v3, v3, v5
    v_mul_u32_u24 v2, 1152, v3
    v_lshl_add_u32 v2, v4, 4, v2
    s_mov_b32 s8, s48
    s_mov_b32 s9, s49
    s_mov_b32 s10, 2359296
    s_mov_b32 s11, 0x20000
    s_lshr_b32 s22, s18, 1
    s_mul_i32 s24, s22, 4608
    s_mul_i32 s25, s22, 18432
    s_and_b32 s22, s18, 1
    s_mul_i32 s23, s22, 576
    s_add_u32 s24, s24, s23
    s_mul_i32 s25, s18, 9216
    s_mul_i32 s22, s19, 36864
    s_add_u32 s24, s24, s22
    s_mov_b32 s20, 64
    s_lshl_b32 s22, s19, 5
    s_add_u32 s22, s22, s17
    s_lshl_b32 s26, s22, 14
    s_mul_i32 s23, s18, 3072
    s_add_u32 s26, s26, s23
    s_lshl_b32 s23, s16, 11
    s_add_u32 s26, s26, s23
    s_add_u32 s26, s26, -2048
    s_lshl_b32 s22, s22, 13
    s_add_u32 s22, s22, 33554432
    s_cmp_eq_u32 s16, 0
    s_cselect_b32 s26, s22, s26
    s_cselect_b32 s40, 4096, 64
    s_cselect_b32 s41, 1, 2
    s_max_u32 s40, s40, 1024
    s_lshl_b32 s41, s41, 18
    s_lshl_b32 s29, s17, 7
    s_lshl_b32 s22, s16, 4
    s_add_u32 s29, s29, s22
    s_lshl_b32 s22, s19, 2
    s_add_u32 s29, s29, s22
    s_add_u32 s29, s29, 125829120
    s_mov_b32 s27, 0
    s_add_u32 s23, s27, s25
    s_add_u32 m0, s23, 0
    s_nop 0
    buffer_load_dwordx4 v2, s[8:11], s24 offen offset:0 lds
    s_add_u32 m0, s23, 960
    s_nop 0
    buffer_load_dwordx4 v2, s[8:11], s24 offen offset:64 lds
    s_add_u32 m0, s23, 1920
    s_nop 0
    buffer_load_dwordx4 v2, s[8:11], s24 offen offset:128 lds
    s_add_u32 m0, s23, 2880
    s_nop 0
    buffer_load_dwordx4 v2, s[8:11], s24 offen offset:192 lds
    s_add_u32 m0, s23, 3840
    s_nop 0
    buffer_load_dwordx4 v2, s[8:11], s24 offen offset:256 lds
    s_add_u32 m0, s23, 4800
    s_nop 0
    buffer_load_dwordx4 v2, s[8:11], s24 offen offset:320 lds
    s_add_u32 m0, s23, 5760
    s_nop 0
    buffer_load_dwordx4 v2, s[8:11], s24 offen offset:384 lds
    s_add_u32 m0, s23, 6720
    s_nop 0
    buffer_load_dwordx4 v2, s[8:11], s24 offen offset:448 lds
    s_add_u32 m0, s23, 7680
    s_nop 0
    buffer_load_dwordx4 v2, s[8:11], s24 offen offset:512 lds
    s_add_u32 s24, s24, 147456
    s_waitcnt vmcnt(21) lgkmcnt(0)
    s_barrier
    s_add_u32 m0, s44, 139264
    s_add_u32 s22, s42, 1048576
    buffer_load_dwordx4 v8, s[12:15], s22 offen offset:0 lds
    s_add_u32 s22, s42, 1063936
    buffer_load_dwordx4 v9, s[12:15], s22 offen offset:1024 lds
    s_add_u32 s22, s42, 1079296
    buffer_load_dwordx4 v8, s[12:15], s22 offen offset:2048 lds
    s_add_u32 s22, s42, 1094656
    buffer_load_dwordx4 v9, s[12:15], s22 offen offset:3072 lds
    ds_read_b64_tr_b16 v[64:65], v10 offset:0
    ds_read_b64_tr_b16 v[66:67], v10 offset:2048
    ds_read_b64_tr_b16 v[136:137], v10 offset:8
    ds_read_b64_tr_b16 v[138:139], v10 offset:2056
    ds_read_b64_tr_b16 a[0:1], v10 offset:256
    ds_read_b64_tr_b16 a[2:3], v10 offset:2304
    ds_read_b64_tr_b16 a[72:73], v10 offset:264
    ds_read_b64_tr_b16 a[74:75], v10 offset:2312
    s_waitcnt vmcnt(21) lgkmcnt(0)
    s_barrier
    s_add_u32 m0, s44, 73728
    s_add_u32 s22, s42, 1310720
    buffer_load_dwordx4 v8, s[12:15], s22 offen offset:0 lds
    s_add_u32 s22, s42, 1326080
    buffer_load_dwordx4 v9, s[12:15], s22 offen offset:1024 lds
    s_add_u32 s22, s42, 1341440
    buffer_load_dwordx4 v8, s[12:15], s22 offen offset:2048 lds
    s_add_u32 s22, s42, 1356800
    buffer_load_dwordx4 v9, s[12:15], s22 offen offset:3072 lds
    ds_read_b64_tr_b16 v[68:69], v10 offset:16384
    ds_read_b64_tr_b16 v[70:71], v10 offset:18432
    ds_read_b64_tr_b16 v[140:141], v10 offset:16392
    ds_read_b64_tr_b16 v[142:143], v10 offset:18440
    ds_read_b64_tr_b16 a[4:5], v10 offset:16640
    ds_read_b64_tr_b16 a[6:7], v10 offset:18688
    ds_read_b64_tr_b16 a[76:77], v10 offset:16648
    ds_read_b64_tr_b16 a[78:79], v10 offset:18696
    s_waitcnt vmcnt(21) lgkmcnt(0)
    s_barrier
    s_add_u32 m0, s44, 90112
    s_add_u32 s22, s42, 1572864
    buffer_load_dwordx4 v8, s[12:15], s22 offen offset:0 lds
    s_add_u32 s22, s42, 1588224
    buffer_load_dwordx4 v9, s[12:15], s22 offen offset:1024 lds
    s_add_u32 s22, s42, 1603584
    buffer_load_dwordx4 v8, s[12:15], s22 offen offset:2048 lds
    s_add_u32 s22, s42, 1618944
    buffer_load_dwordx4 v9, s[12:15], s22 offen offset:3072 lds
    ds_read_b64_tr_b16 v[72:73], v10 offset:32768
    ds_read_b64_tr_b16 v[74:75], v10 offset:34816
    ds_read_b64_tr_b16 v[144:145], v10 offset:32776
    ds_read_b64_tr_b16 v[146:147], v10 offset:34824
    ds_read_b64_tr_b16 a[8:9], v10 offset:33024
    ds_read_b64_tr_b16 a[10:11], v10 offset:35072
    ds_read_b64_tr_b16 a[80:81], v10 offset:33032
    ds_read_b64_tr_b16 a[82:83], v10 offset:35080
    s_waitcnt vmcnt(21) lgkmcnt(0)
    s_barrier
    s_add_u32 m0, s44, 106496
    s_add_u32 s22, s42, 1835008
    buffer_load_dwordx4 v8, s[12:15], s22 offen offset:0 lds
    s_add_u32 s22, s42, 1850368
    buffer_load_dwordx4 v9, s[12:15], s22 offen offset:1024 lds
    s_add_u32 s22, s42, 1865728
    buffer_load_dwordx4 v8, s[12:15], s22 offen offset:2048 lds
    s_add_u32 s22, s42, 1881088
    buffer_load_dwordx4 v9, s[12:15], s22 offen offset:3072 lds
    ds_read_b64_tr_b16 v[76:77], v11 offset:0
    ds_read_b64_tr_b16 v[78:79], v11 offset:2048
    ds_read_b64_tr_b16 v[148:149], v11 offset:8
    ds_read_b64_tr_b16 v[150:151], v11 offset:2056
    ds_read_b64_tr_b16 a[12:13], v11 offset:256
    ds_read_b64_tr_b16 a[14:15], v11 offset:2304
    ds_read_b64_tr_b16 a[84:85], v11 offset:264
    ds_read_b64_tr_b16 a[86:87], v11 offset:2312
    s_waitcnt vmcnt(12) lgkmcnt(0)
    s_barrier
    s_add_u32 m0, s44, 122880
    s_add_u32 s22, s42, 2097152
    buffer_load_dwordx4 v8, s[12:15], s22 offen offset:0 lds
    s_add_u32 s22, s42, 2112512
    buffer_load_dwordx4 v9, s[12:15], s22 offen offset:1024 lds
    s_add_u32 s22, s42, 2127872
    buffer_load_dwordx4 v8, s[12:15], s22 offen offset:2048 lds
    s_add_u32 s22, s42, 2143232
    buffer_load_dwordx4 v9, s[12:15], s22 offen offset:3072 lds
    ds_read_b64_tr_b16 v[80:81], v11 offset:16384
    ds_read_b64_tr_b16 v[82:83], v11 offset:18432
    ds_read_b64_tr_b16 v[152:153], v11 offset:16392
    ds_read_b64_tr_b16 v[154:155], v11 offset:18440
    ds_read_b64_tr_b16 a[16:17], v11 offset:16640
    ds_read_b64_tr_b16 a[18:19], v11 offset:18688
    ds_read_b64_tr_b16 a[88:89], v11 offset:16648
    ds_read_b64_tr_b16 a[90:91], v11 offset:18696
    s_waitcnt vmcnt(12) lgkmcnt(0)
    s_barrier
    s_add_u32 m0, s44, 139264
    s_add_u32 s22, s42, 2359296
    buffer_load_dwordx4 v8, s[12:15], s22 offen offset:0 lds
    s_add_u32 s22, s42, 2374656
    buffer_load_dwordx4 v9, s[12:15], s22 offen offset:1024 lds
    s_add_u32 s22, s42, 2390016
    buffer_load_dwordx4 v8, s[12:15], s22 offen offset:2048 lds
    s_add_u32 s22, s42, 2405376
    buffer_load_dwordx4 v9, s[12:15], s22 offen offset:3072 lds
    ds_read_b64_tr_b16 v[84:85], v10 offset:0
    ds_read_b64_tr_b16 v[86:87], v10 offset:2048
    ds_read_b64_tr_b16 v[156:157], v10 offset:8
    ds_read_b64_tr_b16 v[158:159], v10 offset:2056
    ds_read_b64_tr_b16 a[20:21], v10 offset:256
    ds_read_b64_tr_b16 a[22:23], v10 offset:2304
    ds_read_b64_tr_b16 a[92:93], v10 offset:264
    ds_read_b64_tr_b16 a[94:95], v10 offset:2312
    s_waitcnt vmcnt(12) lgkmcnt(0)
    s_barrier
    s_add_u32 m0, s44, 73728
    s_add_u32 s22, s42, 2621440
    buffer_load_dwordx4 v8, s[12:15], s22 offen offset:0 lds
    s_add_u32 s22, s42, 2636800
    buffer_load_dwordx4 v9, s[12:15], s22 offen offset:1024 lds
    s_add_u32 s22, s42, 2652160
    buffer_load_dwordx4 v8, s[12:15], s22 offen offset:2048 lds
    s_add_u32 s22, s42, 2667520
    buffer_load_dwordx4 v9, s[12:15], s22 offen offset:3072 lds
    ds_read_b64_tr_b16 v[88:89], v10 offset:16384
    ds_read_b64_tr_b16 v[90:91], v10 offset:18432
    ds_read_b64_tr_b16 v[160:161], v10 offset:16392
    ds_read_b64_tr_b16 v[162:163], v10 offset:18440
    ds_read_b64_tr_b16 a[24:25], v10 offset:16640
    ds_read_b64_tr_b16 a[26:27], v10 offset:18688
    ds_read_b64_tr_b16 a[96:97], v10 offset:16648
    ds_read_b64_tr_b16 a[98:99], v10 offset:18696
    s_waitcnt vmcnt(12) lgkmcnt(0)
    s_barrier
    s_add_u32 m0, s44, 90112
    s_add_u32 s22, s42, 2883584
    buffer_load_dwordx4 v8, s[12:15], s22 offen offset:0 lds
    s_add_u32 s22, s42, 2898944
    buffer_load_dwordx4 v9, s[12:15], s22 offen offset:1024 lds
    s_add_u32 s22, s42, 2914304
    buffer_load_dwordx4 v8, s[12:15], s22 offen offset:2048 lds
    s_add_u32 s22, s42, 2929664
    buffer_load_dwordx4 v9, s[12:15], s22 offen offset:3072 lds
    ds_read_b64_tr_b16 v[92:93], v10 offset:32768
    ds_read_b64_tr_b16 v[94:95], v10 offset:34816
    ds_read_b64_tr_b16 v[164:165], v10 offset:32776
    ds_read_b64_tr_b16 v[166:167], v10 offset:34824
    ds_read_b64_tr_b16 a[28:29], v10 offset:33024
    ds_read_b64_tr_b16 a[30:31], v10 offset:35072
    ds_read_b64_tr_b16 a[100:101], v10 offset:33032
    ds_read_b64_tr_b16 a[102:103], v10 offset:35080
    s_waitcnt vmcnt(12) lgkmcnt(0)
    s_barrier
    s_add_u32 m0, s44, 106496
    s_add_u32 s22, s42, 3145728
    buffer_load_dwordx4 v8, s[12:15], s22 offen offset:0 lds
    s_add_u32 s22, s42, 3161088
    buffer_load_dwordx4 v9, s[12:15], s22 offen offset:1024 lds
    s_add_u32 s22, s42, 3176448
    buffer_load_dwordx4 v8, s[12:15], s22 offen offset:2048 lds
    s_add_u32 s22, s42, 3191808
    buffer_load_dwordx4 v9, s[12:15], s22 offen offset:3072 lds
    ds_read_b64_tr_b16 v[96:97], v11 offset:0
    ds_read_b64_tr_b16 v[98:99], v11 offset:2048
    ds_read_b64_tr_b16 v[168:169], v11 offset:8
    ds_read_b64_tr_b16 v[170:171], v11 offset:2056
    ds_read_b64_tr_b16 a[32:33], v11 offset:256
    ds_read_b64_tr_b16 a[34:35], v11 offset:2304
    ds_read_b64_tr_b16 a[104:105], v11 offset:264
    ds_read_b64_tr_b16 a[106:107], v11 offset:2312
    s_waitcnt vmcnt(12) lgkmcnt(0)
    s_barrier
    s_add_u32 m0, s44, 122880
    s_add_u32 s22, s42, 3407872
    buffer_load_dwordx4 v8, s[12:15], s22 offen offset:0 lds
    s_add_u32 s22, s42, 3423232
    buffer_load_dwordx4 v9, s[12:15], s22 offen offset:1024 lds
    s_add_u32 s22, s42, 3438592
    buffer_load_dwordx4 v8, s[12:15], s22 offen offset:2048 lds
    s_add_u32 s22, s42, 3453952
    buffer_load_dwordx4 v9, s[12:15], s22 offen offset:3072 lds
    ds_read_b64_tr_b16 v[100:101], v11 offset:16384
    ds_read_b64_tr_b16 v[102:103], v11 offset:18432
    ds_read_b64_tr_b16 v[172:173], v11 offset:16392
    ds_read_b64_tr_b16 v[174:175], v11 offset:18440
    ds_read_b64_tr_b16 a[36:37], v11 offset:16640
    ds_read_b64_tr_b16 a[38:39], v11 offset:18688
    ds_read_b64_tr_b16 a[108:109], v11 offset:16648
    ds_read_b64_tr_b16 a[110:111], v11 offset:18696
    s_waitcnt vmcnt(12) lgkmcnt(0)
    s_barrier
    s_add_u32 m0, s44, 139264
    s_add_u32 s22, s42, 3670016
    buffer_load_dwordx4 v8, s[12:15], s22 offen offset:0 lds
    s_add_u32 s22, s42, 3685376
    buffer_load_dwordx4 v9, s[12:15], s22 offen offset:1024 lds
    s_add_u32 s22, s42, 3700736
    buffer_load_dwordx4 v8, s[12:15], s22 offen offset:2048 lds
    s_add_u32 s22, s42, 3716096
    buffer_load_dwordx4 v9, s[12:15], s22 offen offset:3072 lds
    ds_read_b64_tr_b16 v[104:105], v10 offset:0
    ds_read_b64_tr_b16 v[106:107], v10 offset:2048
    ds_read_b64_tr_b16 v[176:177], v10 offset:8
    ds_read_b64_tr_b16 v[178:179], v10 offset:2056
    ds_read_b64_tr_b16 a[40:41], v10 offset:256
    ds_read_b64_tr_b16 a[42:43], v10 offset:2304
    ds_read_b64_tr_b16 a[112:113], v10 offset:264
    ds_read_b64_tr_b16 a[114:115], v10 offset:2312
    s_waitcnt vmcnt(12) lgkmcnt(0)
    s_barrier
    s_add_u32 m0, s44, 73728
    s_add_u32 s22, s42, 3932160
    buffer_load_dwordx4 v8, s[12:15], s22 offen offset:0 lds
    s_add_u32 s22, s42, 3947520
    buffer_load_dwordx4 v9, s[12:15], s22 offen offset:1024 lds
    s_add_u32 s22, s42, 3962880
    buffer_load_dwordx4 v8, s[12:15], s22 offen offset:2048 lds
    s_add_u32 s22, s42, 3978240
    buffer_load_dwordx4 v9, s[12:15], s22 offen offset:3072 lds
    ds_read_b64_tr_b16 v[108:109], v10 offset:16384
    ds_read_b64_tr_b16 v[110:111], v10 offset:18432
    ds_read_b64_tr_b16 v[180:181], v10 offset:16392
    ds_read_b64_tr_b16 v[182:183], v10 offset:18440
    ds_read_b64_tr_b16 a[44:45], v10 offset:16640
    ds_read_b64_tr_b16 a[46:47], v10 offset:18688
    ds_read_b64_tr_b16 a[116:117], v10 offset:16648
    ds_read_b64_tr_b16 a[118:119], v10 offset:18696
    s_waitcnt vmcnt(12) lgkmcnt(0)
    s_barrier
    s_add_u32 m0, s44, 90112
    s_add_u32 s22, s42, 4194304
    buffer_load_dwordx4 v8, s[12:15], s22 offen offset:0 lds
    s_add_u32 s22, s42, 4209664
    buffer_load_dwordx4 v9, s[12:15], s22 offen offset:1024 lds
    s_add_u32 s22, s42, 4225024
    buffer_load_dwordx4 v8, s[12:15], s22 offen offset:2048 lds
    s_add_u32 s22, s42, 4240384
    buffer_load_dwordx4 v9, s[12:15], s22 offen offset:3072 lds
    ds_read_b64_tr_b16 v[112:113], v10 offset:32768
    ds_read_b64_tr_b16 v[114:115], v10 offset:34816
    ds_read_b64_tr_b16 v[184:185], v10 offset:32776
    ds_read_b64_tr_b16 v[186:187], v10 offset:34824
    ds_read_b64_tr_b16 a[48:49], v10 offset:33024
    ds_read_b64_tr_b16 a[50:51], v10 offset:35072
    ds_read_b64_tr_b16 a[120:121], v10 offset:33032
    ds_read_b64_tr_b16 a[122:123], v10 offset:35080
    s_waitcnt vmcnt(12) lgkmcnt(0)
    s_barrier
    s_add_u32 m0, s44, 106496
    s_add_u32 s22, s42, 4456448
    buffer_load_dwordx4 v8, s[12:15], s22 offen offset:0 lds
    s_add_u32 s22, s42, 4471808
    buffer_load_dwordx4 v9, s[12:15], s22 offen offset:1024 lds
    s_add_u32 s22, s42, 4487168
    buffer_load_dwordx4 v8, s[12:15], s22 offen offset:2048 lds
    s_add_u32 s22, s42, 4502528
    buffer_load_dwordx4 v9, s[12:15], s22 offen offset:3072 lds
    ds_read_b64_tr_b16 v[116:117], v11 offset:0
    ds_read_b64_tr_b16 v[118:119], v11 offset:2048
    ds_read_b64_tr_b16 v[188:189], v11 offset:8
    ds_read_b64_tr_b16 v[190:191], v11 offset:2056
    ds_read_b64_tr_b16 a[52:53], v11 offset:256
    ds_read_b64_tr_b16 a[54:55], v11 offset:2304
    ds_read_b64_tr_b16 a[124:125], v11 offset:264
    ds_read_b64_tr_b16 a[126:127], v11 offset:2312
    s_waitcnt vmcnt(12) lgkmcnt(0)
    s_barrier
    s_mov_b32 s27, 36864
    s_add_u32 s23, s27, s25
    s_add_u32 m0, s23, 0
    s_nop 0
    buffer_load_dwordx4 v2, s[8:11], s24 offen offset:0 lds
    s_add_u32 m0, s23, 960
    s_nop 0
    buffer_load_dwordx4 v2, s[8:11], s24 offen offset:64 lds
    s_add_u32 m0, s23, 1920
    s_nop 0
    buffer_load_dwordx4 v2, s[8:11], s24 offen offset:128 lds
    s_add_u32 m0, s23, 2880
    s_nop 0
    buffer_load_dwordx4 v2, s[8:11], s24 offen offset:192 lds
    s_add_u32 m0, s23, 3840
    s_nop 0
    buffer_load_dwordx4 v2, s[8:11], s24 offen offset:256 lds
    s_add_u32 m0, s23, 4800
    s_nop 0
    buffer_load_dwordx4 v2, s[8:11], s24 offen offset:320 lds
    s_add_u32 m0, s23, 5760
    s_nop 0
    buffer_load_dwordx4 v2, s[8:11], s24 offen offset:384 lds
    s_add_u32 m0, s23, 6720
    s_nop 0
    buffer_load_dwordx4 v2, s[8:11], s24 offen offset:448 lds
    s_add_u32 m0, s23, 7680
    s_nop 0
    buffer_load_dwordx4 v2, s[8:11], s24 offen offset:512 lds
    s_add_u32 s24, s24, 147456
    ds_read_b64_tr_b16 v[120:121], v11 offset:16384
    ds_read_b64_tr_b16 v[122:123], v11 offset:18432
    ds_read_b64_tr_b16 v[192:193], v11 offset:16392
    ds_read_b64_tr_b16 v[194:195], v11 offset:18440
    ds_read_b64_tr_b16 a[56:57], v11 offset:16640
    ds_read_b64_tr_b16 a[58:59], v11 offset:18688
    ds_read_b64_tr_b16 a[128:129], v11 offset:16648
    ds_read_b64_tr_b16 a[130:131], v11 offset:18696
    s_waitcnt vmcnt(17) lgkmcnt(0)
    s_barrier
    ds_read_b64_tr_b16 v[124:125], v10 offset:0
    ds_read_b64_tr_b16 v[126:127], v10 offset:2048
    ds_read_b64_tr_b16 v[196:197], v10 offset:8
    ds_read_b64_tr_b16 v[198:199], v10 offset:2056
    ds_read_b64_tr_b16 a[60:61], v10 offset:256
    ds_read_b64_tr_b16 a[62:63], v10 offset:2304
    ds_read_b64_tr_b16 a[132:133], v10 offset:264
    ds_read_b64_tr_b16 a[134:135], v10 offset:2312
    s_waitcnt vmcnt(13) lgkmcnt(0)
    s_barrier
    ds_read_b64_tr_b16 v[128:129], v10 offset:16384
    ds_read_b64_tr_b16 v[130:131], v10 offset:18432
    ds_read_b64_tr_b16 v[200:201], v10 offset:16392
    ds_read_b64_tr_b16 v[202:203], v10 offset:18440
    ds_read_b64_tr_b16 a[64:65], v10 offset:16640
    ds_read_b64_tr_b16 a[66:67], v10 offset:18688
    ds_read_b64_tr_b16 a[136:137], v10 offset:16648
    ds_read_b64_tr_b16 a[138:139], v10 offset:18696
    s_waitcnt vmcnt(9) lgkmcnt(0)
    s_barrier
    ds_read_b64_tr_b16 v[132:133], v10 offset:32768
    ds_read_b64_tr_b16 v[134:135], v10 offset:34816
    ds_read_b64_tr_b16 v[204:205], v10 offset:32776
    ds_read_b64_tr_b16 v[206:207], v10 offset:34824
    ds_read_b64_tr_b16 a[68:69], v10 offset:33024
    ds_read_b64_tr_b16 a[70:71], v10 offset:35072
    ds_read_b64_tr_b16 a[140:141], v10 offset:33032
    ds_read_b64_tr_b16 a[142:143], v10 offset:35080
    s_mov_b32 s88, 4194304
gn8:
    buffer_load_dword v250, off, s[84:87], 0 offset:216 sc1
    s_waitcnt vmcnt(0)
    v_readfirstlane_b32 s95, v250
    s_sub_u32 s88, s88, 1
    s_cbranch_scc1 gn8x
    s_cmp_eq_u32 s95, 0
    s_cbranch_scc1 gn8
gn8x:
    s_waitcnt lgkmcnt(0)
    s_mov_b32 s45, 0
    s_mov_b32 s27, 0
    s_mov_b64 s[36:37], 0
    s_mov_b32 s12, 0
    s_mov_b32 s13, s40
    s_lshr_b32 s14, s41, 5
    s_add_u32 s15, s14, s40
    s_lshl_b32 s41, s41, 2
    s_sub_u32 s26, s26, s41
    v_mov_b32 v3, v1
    s_waitcnt vmcnt(0)
    s_barrier
    ds_read_b128 v[32:35], v3 offset:0
    ds_read_b128 v[36:39], v3 offset:18432
    ds_read_b128 v[40:43], v3 offset:1024
    ds_read_b128 v[44:47], v3 offset:19456
    s_cmp_eq_u32 s18, 0
    s_cselect_b32 s34, 1, 0
    s_mov_b32 s35, 0
    s_cmp_eq_u32 s16, 2
    s_cbranch_scc1 qk_vloop
qk_loop:
    s_barrier
    s_add_u32 s22, s27, 73728
    s_sub_u32 s21, s22, 110592
    s_cselect_b32 s22, s22, s21
    s_waitcnt lgkmcnt(2)
    v_mfma_f32_16x16x32_bf16 v[208:211], v[64:67], v[32:35], 0
    ds_read_b128 v[48:51], v3 offset:2048
    v_mfma_f32_16x16x32_bf16 v[212:215], v[136:139], v[32:35], 0
    ds_read_b128 v[52:55], v3 offset:20480
    v_mfma_f32_16x16x32_bf16 v[216:219], v[64:67], v[36:39], 0
    v_mfma_f32_16x16x32_bf16 v[220:223], v[136:139], v[36:39], 0
    v_mfma_f32_16x16x32_bf16 v[224:227], a[0:3], v[32:35], 0
    v_mfma_f32_16x16x32_bf16 v[228:231], a[72:75], v[32:35], 0
    v_mfma_f32_16x16x32_bf16 v[232:235], a[0:3], v[36:39], 0
    v_mfma_f32_16x16x32_bf16 v[236:239], a[72:75], v[36:39], 0
    s_waitcnt lgkmcnt(2)
    v_mfma_f32_16x16x32_bf16 v[208:211], v[68:71], v[40:43], v[208:211]
    ds_read_b128 v[32:35], v3 offset:3072
    v_mfma_f32_16x16x32_bf16 v[212:215], v[140:143], v[40:43], v[212:215]
    ds_read_b128 v[36:39], v3 offset:21504
    v_mfma_f32_16x16x32_bf16 v[216:219], v[68:71], v[44:47], v[216:219]
    s_add_u32 s23, s22, s25
    s_add_u32 m0, s23, 0
    s_nop 0
    buffer_load_dwordx4 v2, s[8:11], s24 offen offset:0 lds
    v_mfma_f32_16x16x32_bf16 v[220:223], v[140:143], v[44:47], v[220:223]
    v_mfma_f32_16x16x32_bf16 v[224:227], a[4:7], v[40:43], v[224:227]
    v_mfma_f32_16x16x32_bf16 v[228:231], a[76:79], v[40:43], v[228:231]
    v_mfma_f32_16x16x32_bf16 v[232:235], a[4:7], v[44:47], v[232:235]
    s_add_u32 m0, s23, 960
    s_nop 0
    buffer_load_dwordx4 v2, s[8:11], s24 offen offset:64 lds
    v_mfma_f32_16x16x32_bf16 v[236:239], a[76:79], v[44:47], v[236:239]
    s_waitcnt lgkmcnt(2)
    v_mfma_f32_16x16x32_bf16 v[208:211], v[72:75], v[48:51], v[208:211]
    ds_read_b128 v[40:43], v3 offset:4096
    v_mfma_f32_16x16x32_bf16 v[212:215], v[144:147], v[48:51], v[212:215]
    ds_read_b128 v[44:47], v3 offset:22528
    v_mfma_f32_16x16x32_bf16 v[216:219], v[72:75], v[52:55], v[216:219]
    s_add_u32 m0, s23, 1920
    s_nop 0
    buffer_load_dwordx4 v2, s[8:11], s24 offen offset:128 lds
    v_mfma_f32_16x16x32_bf16 v[220:223], v[144:147], v[52:55], v[220:223]
    v_mfma_f32_16x16x32_bf16 v[224:227], a[8:11], v[48:51], v[224:227]
    v_mfma_f32_16x16x32_bf16 v[228:231], a[80:83], v[48:51], v[228:231]
    v_mfma_f32_16x16x32_bf16 v[232:235], a[8:11], v[52:55], v[232:235]
    s_add_u32 m0, s23, 2880
    s_nop 0
    buffer_load_dwordx4 v2, s[8:11], s24 offen offset:192 lds
    v_mfma_f32_16x16x32_bf16 v[236:239], a[80:83], v[52:55], v[236:239]
    s_waitcnt lgkmcnt(2)
    v_mfma_f32_16x16x32_bf16 v[208:211], v[76:79], v[32:35], v[208:211]
    ds_read_b128 v[48:51], v3 offset:5120
    v_mfma_f32_16x16x32_bf16 v[212:215], v[148:151], v[32:35], v[212:215]
    ds_read_b128 v[52:55], v3 offset:23552
    v_mfma_f32_16x16x32_bf16 v[216:219], v[76:79], v[36:39], v[216:219]
    s_add_u32 m0, s23, 3840
    s_nop 0
    buffer_load_dwordx4 v2, s[8:11], s24 offen offset:256 lds
    v_mfma_f32_16x16x32_bf16 v[220:223], v[148:151], v[36:39], v[220:223]
    v_mfma_f32_16x16x32_bf16 v[224:227], a[12:15], v[32:35], v[224:227]
    v_mfma_f32_16x16x32_bf16 v[228:231], a[84:87], v[32:35], v[228:231]
    v_mfma_f32_16x16x32_bf16 v[232:235], a[12:15], v[36:39], v[232:235]
    s_add_u32 m0, s23, 4800
    s_nop 0
    buffer_load_dwordx4 v2, s[8:11], s24 offen offset:320 lds
    v_mfma_f32_16x16x32_bf16 v[236:239], a[84:87], v[36:39], v[236:239]
    s_waitcnt lgkmcnt(2)
    v_mfma_f32_16x16x32_bf16 v[208:211], v[80:83], v[40:43], v[208:211]
    ds_read_b128 v[32:35], v3 offset:6144
    v_mfma_f32_16x16x32_bf16 v[212:215], v[152:155], v[40:43], v[212:215]
    ds_read_b128 v[36:39], v3 offset:24576
    v_mfma_f32_16x16x32_bf16 v[216:219], v[80:83], v[44:47], v[216:219]
    s_add_u32 m0, s23, 5760
    s_nop 0
    buffer_load_dwordx4 v2, s[8:11], s24 offen offset:384 lds
    v_mfma_f32_16x16x32_bf16 v[220:223], v[152:155], v[44:47], v[220:223]
    v_mfma_f32_16x16x32_bf16 v[224:227], a[16:19], v[40:43], v[224:227]
    v_mfma_f32_16x16x32_bf16 v[228:231], a[88:91], v[40:43], v[228:231]
    v_mfma_f32_16x16x32_bf16 v[232:235], a[16:19], v[44:47], v[232:235]
    s_add_u32 m0, s23, 6720
    s_nop 0
    buffer_load_dwordx4 v2, s[8:11], s24 offen offset:448 lds
    v_mfma_f32_16x16x32_bf16 v[236:239], a[88:91], v[44:47], v[236:239]
    s_waitcnt lgkmcnt(2)
    v_mfma_f32_16x16x32_bf16 v[208:211], v[84:87], v[48:51], v[208:211]
    ds_read_b128 v[40:43], v3 offset:7168
    v_mfma_f32_16x16x32_bf16 v[212:215], v[156:159], v[48:51], v[212:215]
    ds_read_b128 v[44:47], v3 offset:25600
    v_mfma_f32_16x16x32_bf16 v[216:219], v[84:87], v[52:55], v[216:219]
    s_add_u32 m0, s23, 7680
    s_nop 0
    buffer_load_dwordx4 v2, s[8:11], s24 offen offset:512 lds
    s_add_u32 s24, s24, 147456
    v_mfma_f32_16x16x32_bf16 v[220:223], v[156:159], v[52:55], v[220:223]
    v_mfma_f32_16x16x32_bf16 v[224:227], a[20:23], v[48:51], v[224:227]
    v_mfma_f32_16x16x32_bf16 v[228:231], a[92:95], v[48:51], v[228:231]
    v_mfma_f32_16x16x32_bf16 v[232:235], a[20:23], v[52:55], v[232:235]
    v_mfma_f32_16x16x32_bf16 v[236:239], a[92:95], v[52:55], v[236:239]
    s_waitcnt lgkmcnt(2)
    v_mfma_f32_16x16x32_bf16 v[208:211], v[88:91], v[32:35], v[208:211]
    ds_read_b128 v[48:51], v3 offset:8192
    v_mfma_f32_16x16x32_bf16 v[212:215], v[160:163], v[32:35], v[212:215]
    ds_read_b128 v[52:55], v3 offset:26624
    v_mfma_f32_16x16x32_bf16 v[216:219], v[88:91], v[36:39], v[216:219]
    v_mfma_f32_16x16x32_bf16 v[220:223], v[160:163], v[36:39], v[220:223]
    v_mfma_f32_16x16x32_bf16 v[224:227], a[24:27], v[32:35], v[224:227]
    v_mfma_f32_16x16x32_bf16 v[228:231], a[96:99], v[32:35], v[228:231]
    v_mfma_f32_16x16x32_bf16 v[232:235], a[24:27], v[36:39], v[232:235]
    v_mfma_f32_16x16x32_bf16 v[236:239], a[96:99], v[36:39], v[236:239]
    s_waitcnt lgkmcnt(2)
    v_mfma_f32_16x16x32_bf16 v[208:211], v[92:95], v[40:43], v[208:211]
    ds_read_b128 v[32:35], v3 offset:9216
    v_mfma_f32_16x16x32_bf16 v[212:215], v[164:167], v[40:43], v[212:215]
    ds_read_b128 v[36:39], v3 offset:27648
    v_mfma_f32_16x16x32_bf16 v[216:219], v[92:95], v[44:47], v[216:219]
    s_add_u32 s23, s45, s95
    v_mov_b32 v4, s23
    s_mov_b64 exec, s[34:35]
    buffer_store_dword v4, off, s[4:7], s29 sc1
    buffer_store_dword v4, off, s[4:7], s29 offset:128 sc1
    s_mov_b64 exec, -1
    v_mfma_f32_16x16x32_bf16 v[220:223], v[164:167], v[44:47], v[220:223]
    v_mfma_f32_16x16x32_bf16 v[224:227], a[28:31], v[40:43], v[224:227]
    v_mfma_f32_16x16x32_bf16 v[228:231], a[100:103], v[40:43], v[228:231]
    v_mfma_f32_16x16x32_bf16 v[232:235], a[28:31], v[44:47], v[232:235]
    v_mfma_f32_16x16x32_bf16 v[236:239], a[100:103], v[44:47], v[236:239]
    s_waitcnt lgkmcnt(2)
    v_mfma_f32_16x16x32_bf16 v[208:211], v[96:99], v[48:51], v[208:211]
    ds_read_b128 v[40:43], v3 offset:10240
    v_mfma_f32_16x16x32_bf16 v[212:215], v[168:171], v[48:51], v[212:215]
    ds_read_b128 v[44:47], v3 offset:28672
    v_mfma_f32_16x16x32_bf16 v[216:219], v[96:99], v[52:55], v[216:219]
    s_cmp_lt_u32 s19, 60
    s_cbranch_scc1 lt9
    buffer_load_dwordx4 v[244:247], off, s[84:87], 0 offset:16 sc1
    buffer_load_dword v248, off, s[84:87], 0 offset:4 sc1
lt9:
    s_lshr_b32 s46, s19, 2
    s_cmp_eq_u32 s16, 0
    s_cselect_b32 s46, 0, s46
    s_cmp_lg_u32 s46, 2
    s_cbranch_scc1 lp9
    v_mov_b32 v244, -1
    v_mov_b32 v245, -1
    v_mov_b32 v246, -1
    v_mov_b32 v247, -1
    s_lshl_b32 s46, s19, 5
    s_add_u32 s46, s46, s17
    s_lshl_b32 s46, s46, 12
    s_mul_i32 s47, s16, 8388608
    s_add_u32 s46, s46, s47
    s_add_u32 s47, s46, 67108864
    buffer_store_dwordx4 v[244:247], v7, s[4:7], s47 offen sc1
    s_add_u32 s47, s46, 67112960
    buffer_store_dwordx4 v[244:247], v7, s[4:7], s47 offen sc1
    s_add_u32 s47, s46, 67633152
    buffer_store_dwordx4 v[244:247], v7, s[4:7], s47 offen sc1
    s_add_u32 s47, s46, 67637248
    buffer_store_dwordx4 v[244:247], v7, s[4:7], s47 offen sc1
lp9:
    s_lshl_b32 s46, s16, 6
    s_or_b32 s46, s46, s19
    s_or_b32 s47, s46, 1
    s_cmp_lg_u32 s47, 11
    s_cbranch_scc1 lq9
    v_mov_b32 v244, -1
    v_mov_b32 v245, -1
    v_mov_b32 v246, -1
    v_mov_b32 v247, -1
    s_lshl_b32 s46, s46, 18
    s_lshl_b32 s47, s17, 12
    s_add_u32 s46, s46, s47
    s_add_u32 s47, s46, 63963136
    buffer_store_dwordx4 v[244:247], v7, s[4:7], s47 offen sc1
    s_add_u32 s47, s46, 63967232
    buffer_store_dwordx4 v[244:247], v7, s[4:7], s47 offen sc1
    s_add_u32 s47, s46, 64094208
    buffer_store_dwordx4 v[244:247], v7, s[4:7], s47 offen sc1
    s_add_u32 s47, s46, 64098304
    buffer_store_dwordx4 v[244:247], v7, s[4:7], s47 offen sc1
lq9:
    v_mfma_f32_16x16x32_bf16 v[220:223], v[168:171], v[52:55], v[220:223]
    v_mfma_f32_16x16x32_bf16 v[224:227], a[32:35], v[48:51], v[224:227]
    v_mfma_f32_16x16x32_bf16 v[228:231], a[104:107], v[48:51], v[228:231]
    v_mfma_f32_16x16x32_bf16 v[232:235], a[32:35], v[52:55], v[232:235]
    v_mfma_f32_16x16x32_bf16 v[236:239], a[104:107], v[52:55], v[236:239]
    s_waitcnt lgkmcnt(2)
    v_mfma_f32_16x16x32_bf16 v[208:211], v[100:103], v[32:35], v[208:211]
    ds_read_b128 v[48:51], v3 offset:11264
    v_mfma_f32_16x16x32_bf16 v[212:215], v[172:175], v[32:35], v[212:215]
    ds_read_b128 v[52:55], v3 offset:29696
    v_mfma_f32_16x16x32_bf16 v[216:219], v[100:103], v[36:39], v[216:219]
    v_mfma_f32_16x16x32_bf16 v[220:223], v[172:175], v[36:39], v[220:223]
    v_mfma_f32_16x16x32_bf16 v[224:227], a[36:39], v[32:35], v[224:227]
    v_mfma_f32_16x16x32_bf16 v[228:231], a[108:111], v[32:35], v[228:231]
    v_mfma_f32_16x16x32_bf16 v[232:235], a[36:39], v[36:39], v[232:235]
    v_mfma_f32_16x16x32_bf16 v[236:239], a[108:111], v[36:39], v[236:239]
    s_waitcnt lgkmcnt(2)
    v_mfma_f32_16x16x32_bf16 v[208:211], v[104:107], v[40:43], v[208:211]
    ds_read_b128 v[32:35], v3 offset:12288
    v_mfma_f32_16x16x32_bf16 v[212:215], v[176:179], v[40:43], v[212:215]
    ds_read_b128 v[36:39], v3 offset:30720
    v_mfma_f32_16x16x32_bf16 v[216:219], v[104:107], v[44:47], v[216:219]
    v_mfma_f32_16x16x32_bf16 v[220:223], v[176:179], v[44:47], v[220:223]
    v_mfma_f32_16x16x32_bf16 v[224:227], a[40:43], v[40:43], v[224:227]
    v_mfma_f32_16x16x32_bf16 v[228:231], a[112:115], v[40:43], v[228:231]
    v_mfma_f32_16x16x32_bf16 v[232:235], a[40:43], v[44:47], v[232:235]
    v_mfma_f32_16x16x32_bf16 v[236:239], a[112:115], v[44:47], v[236:239]
    s_waitcnt lgkmcnt(2)
    v_mfma_f32_16x16x32_bf16 v[208:211], v[108:111], v[48:51], v[208:211]
    ds_read_b128 v[40:43], v3 offset:13312
    v_mfma_f32_16x16x32_bf16 v[212:215], v[180:183], v[48:51], v[212:215]
    ds_read_b128 v[44:47], v3 offset:31744
    v_mfma_f32_16x16x32_bf16 v[216:219], v[108:111], v[52:55], v[216:219]
    v_mfma_f32_16x16x32_bf16 v[220:223], v[180:183], v[52:55], v[220:223]
    v_mfma_f32_16x16x32_bf16 v[224:227], a[44:47], v[48:51], v[224:227]
    v_mfma_f32_16x16x32_bf16 v[228:231], a[116:119], v[48:51], v[228:231]
    v_mfma_f32_16x16x32_bf16 v[232:235], a[44:47], v[52:55], v[232:235]
    v_mfma_f32_16x16x32_bf16 v[236:239], a[116:119], v[52:55], v[236:239]
    s_waitcnt lgkmcnt(2)
    v_mfma_f32_16x16x32_bf16 v[208:211], v[112:115], v[32:35], v[208:211]
    ds_read_b128 v[48:51], v3 offset:14336
    v_mfma_f32_16x16x32_bf16 v[212:215], v[184:187], v[32:35], v[212:215]
    ds_read_b128 v[52:55], v3 offset:32768
    v_mfma_f32_16x16x32_bf16 v[216:219], v[112:115], v[36:39], v[216:219]
    v_mfma_f32_16x16x32_bf16 v[220:223], v[184:187], v[36:39], v[220:223]
    v_mfma_f32_16x16x32_bf16 v[224:227], a[48:51], v[32:35], v[224:227]
    v_mfma_f32_16x16x32_bf16 v[228:231], a[120:123], v[32:35], v[228:231]
    v_mfma_f32_16x16x32_bf16 v[232:235], a[48:51], v[36:39], v[232:235]
    v_mfma_f32_16x16x32_bf16 v[236:239], a[120:123], v[36:39], v[236:239]
    s_waitcnt lgkmcnt(2)
    v_mfma_f32_16x16x32_bf16 v[208:211], v[116:119], v[40:43], v[208:211]
    ds_read_b128 v[32:35], v3 offset:15360
    v_mfma_f32_16x16x32_bf16 v[212:215], v[188:191], v[40:43], v[212:215]
    ds_read_b128 v[36:39], v3 offset:33792
    v_mfma_f32_16x16x32_bf16 v[216:219], v[116:119], v[44:47], v[216:219]
    v_mfma_f32_16x16x32_bf16 v[220:223], v[188:191], v[44:47], v[220:223]
    v_mfma_f32_16x16x32_bf16 v[224:227], a[52:55], v[40:43], v[224:227]
    v_mfma_f32_16x16x32_bf16 v[228:231], a[124:127], v[40:43], v[228:231]
    v_mfma_f32_16x16x32_bf16 v[232:235], a[52:55], v[44:47], v[232:235]
    v_mfma_f32_16x16x32_bf16 v[236:239], a[124:127], v[44:47], v[236:239]
    s_waitcnt lgkmcnt(2)
    v_mfma_f32_16x16x32_bf16 v[208:211], v[120:123], v[48:51], v[208:211]
    ds_read_b128 v[40:43], v3 offset:16384
    v_mfma_f32_16x16x32_bf16 v[212:215], v[192:195], v[48:51], v[212:215]
    ds_read_b128 v[44:47], v3 offset:34816
    v_mfma_f32_16x16x32_bf16 v[216:219], v[120:123], v[52:55], v[216:219]
    v_mfma_f32_16x16x32_bf16 v[220:223], v[192:195], v[52:55], v[220:223]
    v_mfma_f32_16x16x32_bf16 v[224:227], a[56:59], v[48:51], v[224:227]
    v_mfma_f32_16x16x32_bf16 v[228:231], a[128:131], v[48:51], v[228:231]
    v_mfma_f32_16x16x32_bf16 v[232:235], a[56:59], v[52:55], v[232:235]
    v_mfma_f32_16x16x32_bf16 v[236:239], a[128:131], v[52:55], v[236:239]
    s_waitcnt lgkmcnt(2)
    v_mfma_f32_16x16x32_bf16 v[208:211], v[124:127], v[32:35], v[208:211]
    ds_read_b128 v[48:51], v3 offset:17408
    v_mfma_f32_16x16x32_bf16 v[212:215], v[196:199], v[32:35], v[212:215]
    ds_read_b128 v[52:55], v3 offset:35840
    v_mfma_f32_16x16x32_bf16 v[216:219], v[124:127], v[36:39], v[216:219]
    v_mfma_f32_16x16x32_bf16 v[220:223], v[196:199], v[36:39], v[220:223]
    v_mfma_f32_16x16x32_bf16 v[224:227], a[60:63], v[32:35], v[224:227]
    s_add_u32 s27, s27, 36864
    s_cmp_eq_u32 s27, 110592
    s_cselect_b32 s27, 0, s27
    v_add_u32 v3, s27, v1
    v_mfma_f32_16x16x32_bf16 v[228:231], a[132:135], v[32:35], v[228:231]
    v_mfma_f32_16x16x32_bf16 v[232:235], a[60:63], v[36:39], v[232:235]
    v_mfma_f32_16x16x32_bf16 v[236:239], a[132:135], v[36:39], v[236:239]
    s_waitcnt lgkmcnt(2)
    v_mfma_f32_16x16x32_bf16 v[208:211], v[128:131], v[40:43], v[208:211]
    ds_read_b128 v[32:35], v3 offset:0
    v_mfma_f32_16x16x32_bf16 v[212:215], v[200:203], v[40:43], v[212:215]
    ds_read_b128 v[36:39], v3 offset:18432
    v_mfma_f32_16x16x32_bf16 v[216:219], v[128:131], v[44:47], v[216:219]
    v_mfma_f32_16x16x32_bf16 v[220:223], v[200:203], v[44:47], v[220:223]
    v_mfma_f32_16x16x32_bf16 v[224:227], a[64:67], v[40:43], v[224:227]
    v_mfma_f32_16x16x32_bf16 v[228:231], a[136:139], v[40:43], v[228:231]
    v_mfma_f32_16x16x32_bf16 v[232:235], a[64:67], v[44:47], v[232:235]
    v_mfma_f32_16x16x32_bf16 v[236:239], a[136:139], v[44:47], v[236:239]
    s_waitcnt lgkmcnt(2)
    v_mfma_f32_16x16x32_bf16 v[208:211], v[132:135], v[48:51], v[208:211]
    ds_read_b128 v[40:43], v3 offset:1024
    v_mfma_f32_16x16x32_bf16 v[212:215], v[204:207], v[48:51], v[212:215]
    ds_read_b128 v[44:47], v3 offset:19456
    v_mfma_f32_16x16x32_bf16 v[216:219], v[132:135], v[52:55], v[216:219]
    v_mfma_f32_16x16x32_bf16 v[220:223], v[204:207], v[52:55], v[220:223]
    v_mfma_f32_16x16x32_bf16 v[224:227], a[68:71], v[48:51], v[224:227]
    v_mfma_f32_16x16x32_bf16 v[228:231], a[140:143], v[48:51], v[228:231]
    v_mfma_f32_16x16x32_bf16 v[232:235], a[68:71], v[52:55], v[232:235]
    v_mfma_f32_16x16x32_bf16 v[236:239], a[140:143], v[52:55], v[236:239]
    s_add_u32 s26, s26, s41
    s_waitcnt vmcnt(0)
    v_cvt_pk_bf16_f32 v8, v208, v209
    v_cvt_pk_bf16_f32 v9, v210, v211
    v_cvt_pk_bf16_f32 v10, v212, v213
    v_cvt_pk_bf16_f32 v11, v214, v215
    v_cvt_pk_bf16_f32 v12, v216, v217
    v_cvt_pk_bf16_f32 v13, v218, v219
    v_cvt_pk_bf16_f32 v14, v220, v221
    v_cvt_pk_bf16_f32 v15, v222, v223
    v_cvt_pk_bf16_f32 v16, v224, v225
    v_cvt_pk_bf16_f32 v17, v226, v227
    v_cvt_pk_bf16_f32 v18, v228, v229
    v_cvt_pk_bf16_f32 v19, v230, v231
    v_cvt_pk_bf16_f32 v20, v232, v233
    v_cvt_pk_bf16_f32 v21, v234, v235
    v_cvt_pk_bf16_f32 v22, v236, v237
    v_cvt_pk_bf16_f32 v23, v238, v239
    s_mov_b64 s[36:37], -1
    s_add_u32 s28, s26, s12
    buffer_store_dwordx4 v[8:11], v7, s[4:7], s28 offen sc1
    s_add_u32 s28, s26, s13
    buffer_store_dwordx4 v[12:15], v7, s[4:7], s28 offen sc1
    s_add_u32 s28, s26, s14
    buffer_store_dwordx4 v[16:19], v7, s[4:7], s28 offen sc1
    s_add_u32 s28, s26, s15
    buffer_store_dwordx4 v[20:23], v7, s[4:7], s28 offen sc1
    s_lshr_b32 s45, s19, 2
    s_cbranch_scc1 qk_loop_nf
    s_mov_b32 s45, 1
    s_mov_b64 s[36:37], 0
    s_waitcnt vmcnt(0)
    s_barrier
    s_add_u32 s23, s45, s95
    v_mov_b32 v4, s23
    s_mov_b64 exec, s[34:35]
    buffer_store_dword v4, off, s[4:7], s29 sc1
    buffer_store_dword v4, off, s[4:7], s29 offset:128 sc1
    s_mov_b64 exec, -1
qk_loop_nf:
    s_add_u32 s19, s19, 4
    s_cmp_lt_u32 s19, s20
    s_cbranch_scc1 qk_loop
    s_branch qk_done
qk_vloop:
    s_barrier
    s_add_u32 s22, s27, 73728
    s_sub_u32 s21, s22, 110592
    s_cselect_b32 s22, s22, s21
    s_waitcnt lgkmcnt(2)
    v_mfma_f32_16x16x32_bf16 v[208:211], v[32:35], v[64:67], 0
    ds_read_b128 v[48:51], v3 offset:2048
    v_mfma_f32_16x16x32_bf16 v[212:215], v[32:35], v[136:139], 0
    ds_read_b128 v[52:55], v3 offset:20480
    v_mfma_f32_16x16x32_bf16 v[216:219], v[36:39], v[64:67], 0
    v_mfma_f32_16x16x32_bf16 v[220:223], v[36:39], v[136:139], 0
    v_mfma_f32_16x16x32_bf16 v[224:227], v[32:35], a[0:3], 0
    v_mfma_f32_16x16x32_bf16 v[228:231], v[32:35], a[72:75], 0
    v_mfma_f32_16x16x32_bf16 v[232:235], v[36:39], a[0:3], 0
    v_mfma_f32_16x16x32_bf16 v[236:239], v[36:39], a[72:75], 0
    s_waitcnt lgkmcnt(2)
    v_mfma_f32_16x16x32_bf16 v[208:211], v[40:43], v[68:71], v[208:211]
    ds_read_b128 v[32:35], v3 offset:3072
    v_mfma_f32_16x16x32_bf16 v[212:215], v[40:43], v[140:143], v[212:215]
    ds_read_b128 v[36:39], v3 offset:21504
    v_mfma_f32_16x16x32_bf16 v[216:219], v[44:47], v[68:71], v[216:219]
    s_add_u32 s23, s22, s25
    s_add_u32 m0, s23, 0
    s_nop 0
    buffer_load_dwordx4 v2, s[8:11], s24 offen offset:0 lds
    v_mfma_f32_16x16x32_bf16 v[220:223], v[44:47], v[140:143], v[220:223]
    v_mfma_f32_16x16x32_bf16 v[224:227], v[40:43], a[4:7], v[224:227]
    v_mfma_f32_16x16x32_bf16 v[228:231], v[40:43], a[76:79], v[228:231]
    v_mfma_f32_16x16x32_bf16 v[232:235], v[44:47], a[4:7], v[232:235]
    s_add_u32 m0, s23, 960
    s_nop 0
    buffer_load_dwordx4 v2, s[8:11], s24 offen offset:64 lds
    v_mfma_f32_16x16x32_bf16 v[236:239], v[44:47], a[76:79], v[236:239]
    s_waitcnt lgkmcnt(2)
    v_mfma_f32_16x16x32_bf16 v[208:211], v[48:51], v[72:75], v[208:211]
    ds_read_b128 v[40:43], v3 offset:4096
    v_mfma_f32_16x16x32_bf16 v[212:215], v[48:51], v[144:147], v[212:215]
    ds_read_b128 v[44:47], v3 offset:22528
    v_mfma_f32_16x16x32_bf16 v[216:219], v[52:55], v[72:75], v[216:219]
    s_add_u32 m0, s23, 1920
    s_nop 0
    buffer_load_dwordx4 v2, s[8:11], s24 offen offset:128 lds
    v_mfma_f32_16x16x32_bf16 v[220:223], v[52:55], v[144:147], v[220:223]
    v_mfma_f32_16x16x32_bf16 v[224:227], v[48:51], a[8:11], v[224:227]
    v_mfma_f32_16x16x32_bf16 v[228:231], v[48:51], a[80:83], v[228:231]
    v_mfma_f32_16x16x32_bf16 v[232:235], v[52:55], a[8:11], v[232:235]
    s_add_u32 m0, s23, 2880
    s_nop 0
    buffer_load_dwordx4 v2, s[8:11], s24 offen offset:192 lds
    v_mfma_f32_16x16x32_bf16 v[236:239], v[52:55], a[80:83], v[236:239]
    s_waitcnt lgkmcnt(2)
    v_mfma_f32_16x16x32_bf16 v[208:211], v[32:35], v[76:79], v[208:211]
    ds_read_b128 v[48:51], v3 offset:5120
    v_mfma_f32_16x16x32_bf16 v[212:215], v[32:35], v[148:151], v[212:215]
    ds_read_b128 v[52:55], v3 offset:23552
    v_mfma_f32_16x16x32_bf16 v[216:219], v[36:39], v[76:79], v[216:219]
    s_add_u32 m0, s23, 3840
    s_nop 0
    buffer_load_dwordx4 v2, s[8:11], s24 offen offset:256 lds
    v_mfma_f32_16x16x32_bf16 v[220:223], v[36:39], v[148:151], v[220:223]
    v_mfma_f32_16x16x32_bf16 v[224:227], v[32:35], a[12:15], v[224:227]
    v_mfma_f32_16x16x32_bf16 v[228:231], v[32:35], a[84:87], v[228:231]
    v_mfma_f32_16x16x32_bf16 v[232:235], v[36:39], a[12:15], v[232:235]
    s_add_u32 m0, s23, 4800
    s_nop 0
    buffer_load_dwordx4 v2, s[8:11], s24 offen offset:320 lds
    v_mfma_f32_16x16x32_bf16 v[236:239], v[36:39], a[84:87], v[236:239]
    s_waitcnt lgkmcnt(2)
    v_mfma_f32_16x16x32_bf16 v[208:211], v[40:43], v[80:83], v[208:211]
    ds_read_b128 v[32:35], v3 offset:6144
    v_mfma_f32_16x16x32_bf16 v[212:215], v[40:43], v[152:155], v[212:215]
    ds_read_b128 v[36:39], v3 offset:24576
    v_mfma_f32_16x16x32_bf16 v[216:219], v[44:47], v[80:83], v[216:219]
    s_add_u32 m0, s23, 5760
    s_nop 0
    buffer_load_dwordx4 v2, s[8:11], s24 offen offset:384 lds
    v_mfma_f32_16x16x32_bf16 v[220:223], v[44:47], v[152:155], v[220:223]
    v_mfma_f32_16x16x32_bf16 v[224:227], v[40:43], a[16:19], v[224:227]
    v_mfma_f32_16x16x32_bf16 v[228:231], v[40:43], a[88:91], v[228:231]
    v_mfma_f32_16x16x32_bf16 v[232:235], v[44:47], a[16:19], v[232:235]
    s_add_u32 m0, s23, 6720
    s_nop 0
    buffer_load_dwordx4 v2, s[8:11], s24 offen offset:448 lds
    v_mfma_f32_16x16x32_bf16 v[236:239], v[44:47], a[88:91], v[236:239]
    s_waitcnt lgkmcnt(2)
    v_mfma_f32_16x16x32_bf16 v[208:211], v[48:51], v[84:87], v[208:211]
    ds_read_b128 v[40:43], v3 offset:7168
    v_mfma_f32_16x16x32_bf16 v[212:215], v[48:51], v[156:159], v[212:215]
    ds_read_b128 v[44:47], v3 offset:25600
    v_mfma_f32_16x16x32_bf16 v[216:219], v[52:55], v[84:87], v[216:219]
    s_add_u32 m0, s23, 7680
    s_nop 0
    buffer_load_dwordx4 v2, s[8:11], s24 offen offset:512 lds
    s_add_u32 s24, s24, 147456
    v_mfma_f32_16x16x32_bf16 v[220:223], v[52:55], v[156:159], v[220:223]
    v_mfma_f32_16x16x32_bf16 v[224:227], v[48:51], a[20:23], v[224:227]
    v_mfma_f32_16x16x32_bf16 v[228:231], v[48:51], a[92:95], v[228:231]
    v_mfma_f32_16x16x32_bf16 v[232:235], v[52:55], a[20:23], v[232:235]
    v_mfma_f32_16x16x32_bf16 v[236:239], v[52:55], a[92:95], v[236:239]
    s_waitcnt lgkmcnt(2)
    v_mfma_f32_16x16x32_bf16 v[208:211], v[32:35], v[88:91], v[208:211]
    ds_read_b128 v[48:51], v3 offset:8192
    v_mfma_f32_16x16x32_bf16 v[212:215], v[32:35], v[160:163], v[212:215]
    ds_read_b128 v[52:55], v3 offset:26624
    v_mfma_f32_16x16x32_bf16 v[216:219], v[36:39], v[88:91], v[216:219]
    v_mfma_f32_16x16x32_bf16 v[220:223], v[36:39], v[160:163], v[220:223]
    v_mfma_f32_16x16x32_bf16 v[224:227], v[32:35], a[24:27], v[224:227]
    v_mfma_f32_16x16x32_bf16 v[228:231], v[32:35], a[96:99], v[228:231]
    v_mfma_f32_16x16x32_bf16 v[232:235], v[36:39], a[24:27], v[232:235]
    v_mfma_f32_16x16x32_bf16 v[236:239], v[36:39], a[96:99], v[236:239]
    s_waitcnt lgkmcnt(2)
    v_mfma_f32_16x16x32_bf16 v[208:211], v[40:43], v[92:95], v[208:211]
    ds_read_b128 v[32:35], v3 offset:9216
    v_mfma_f32_16x16x32_bf16 v[212:215], v[40:43], v[164:167], v[212:215]
    ds_read_b128 v[36:39], v3 offset:27648
    v_mfma_f32_16x16x32_bf16 v[216:219], v[44:47], v[92:95], v[216:219]
    s_add_u32 s23, s45, s95
    v_mov_b32 v4, s23
    s_mov_b64 exec, s[34:35]
    buffer_store_dword v4, off, s[4:7], s29 sc1
    buffer_store_dword v4, off, s[4:7], s29 offset:128 sc1
    s_mov_b64 exec, -1
    v_mfma_f32_16x16x32_bf16 v[220:223], v[44:47], v[164:167], v[220:223]
    v_mfma_f32_16x16x32_bf16 v[224:227], v[40:43], a[28:31], v[224:227]
    v_mfma_f32_16x16x32_bf16 v[228:231], v[40:43], a[100:103], v[228:231]
    v_mfma_f32_16x16x32_bf16 v[232:235], v[44:47], a[28:31], v[232:235]
    v_mfma_f32_16x16x32_bf16 v[236:239], v[44:47], a[100:103], v[236:239]
    s_waitcnt lgkmcnt(2)
    v_mfma_f32_16x16x32_bf16 v[208:211], v[48:51], v[96:99], v[208:211]
    ds_read_b128 v[40:43], v3 offset:10240
    v_mfma_f32_16x16x32_bf16 v[212:215], v[48:51], v[168:171], v[212:215]
    ds_read_b128 v[44:47], v3 offset:28672
    v_mfma_f32_16x16x32_bf16 v[216:219], v[52:55], v[96:99], v[216:219]
    s_cmp_lt_u32 s19, 60
    s_cbranch_scc1 lt10
    buffer_load_dwordx4 v[244:247], off, s[84:87], 0 offset:16 sc1
    buffer_load_dword v248, off, s[84:87], 0 offset:4 sc1
lt10:
    s_lshr_b32 s46, s19, 2
    s_cmp_eq_u32 s16, 0
    s_cselect_b32 s46, 0, s46
    s_cmp_lg_u32 s46, 2
    s_cbranch_scc1 lp10
    v_mov_b32 v244, -1
    v_mov_b32 v245, -1
    v_mov_b32 v246, -1
    v_mov_b32 v247, -1
    s_lshl_b32 s46, s19, 5
    s_add_u32 s46, s46, s17
    s_lshl_b32 s46, s46, 12
    s_mul_i32 s47, s16, 8388608
    s_add_u32 s46, s46, s47
    s_add_u32 s47, s46, 67108864
    buffer_store_dwordx4 v[244:247], v7, s[4:7], s47 offen sc1
    s_add_u32 s47, s46, 67112960
    buffer_store_dwordx4 v[244:247], v7, s[4:7], s47 offen sc1
    s_add_u32 s47, s46, 67633152
    buffer_store_dwordx4 v[244:247], v7, s[4:7], s47 offen sc1
    s_add_u32 s47, s46, 67637248
    buffer_store_dwordx4 v[244:247], v7, s[4:7], s47 offen sc1
lp10:
    s_lshl_b32 s46, s16, 6
    s_or_b32 s46, s46, s19
    s_or_b32 s47, s46, 1
    s_cmp_lg_u32 s47, 11
    s_cbranch_scc1 lq10
    v_mov_b32 v244, -1
    v_mov_b32 v245, -1
    v_mov_b32 v246, -1
    v_mov_b32 v247, -1
    s_lshl_b32 s46, s46, 18
    s_lshl_b32 s47, s17, 12
    s_add_u32 s46, s46, s47
    s_add_u32 s47, s46, 63963136
    buffer_store_dwordx4 v[244:247], v7, s[4:7], s47 offen sc1
    s_add_u32 s47, s46, 63967232
    buffer_store_dwordx4 v[244:247], v7, s[4:7], s47 offen sc1
    s_add_u32 s47, s46, 64094208
    buffer_store_dwordx4 v[244:247], v7, s[4:7], s47 offen sc1
    s_add_u32 s47, s46, 64098304
    buffer_store_dwordx4 v[244:247], v7, s[4:7], s47 offen sc1
lq10:
    v_mfma_f32_16x16x32_bf16 v[220:223], v[52:55], v[168:171], v[220:223]
    v_mfma_f32_16x16x32_bf16 v[224:227], v[48:51], a[32:35], v[224:227]
    v_mfma_f32_16x16x32_bf16 v[228:231], v[48:51], a[104:107], v[228:231]
    v_mfma_f32_16x16x32_bf16 v[232:235], v[52:55], a[32:35], v[232:235]
    v_mfma_f32_16x16x32_bf16 v[236:239], v[52:55], a[104:107], v[236:239]
    s_waitcnt lgkmcnt(2)
    v_mfma_f32_16x16x32_bf16 v[208:211], v[32:35], v[100:103], v[208:211]
    ds_read_b128 v[48:51], v3 offset:11264
    v_mfma_f32_16x16x32_bf16 v[212:215], v[32:35], v[172:175], v[212:215]
    ds_read_b128 v[52:55], v3 offset:29696
    v_mfma_f32_16x16x32_bf16 v[216:219], v[36:39], v[100:103], v[216:219]
    v_mfma_f32_16x16x32_bf16 v[220:223], v[36:39], v[172:175], v[220:223]
    v_mfma_f32_16x16x32_bf16 v[224:227], v[32:35], a[36:39], v[224:227]
    v_mfma_f32_16x16x32_bf16 v[228:231], v[32:35], a[108:111], v[228:231]
    v_mfma_f32_16x16x32_bf16 v[232:235], v[36:39], a[36:39], v[232:235]
    v_mfma_f32_16x16x32_bf16 v[236:239], v[36:39], a[108:111], v[236:239]
    s_waitcnt lgkmcnt(2)
    v_mfma_f32_16x16x32_bf16 v[208:211], v[40:43], v[104:107], v[208:211]
    ds_read_b128 v[32:35], v3 offset:12288
    v_mfma_f32_16x16x32_bf16 v[212:215], v[40:43], v[176:179], v[212:215]
    ds_read_b128 v[36:39], v3 offset:30720
    v_mfma_f32_16x16x32_bf16 v[216:219], v[44:47], v[104:107], v[216:219]
    v_mfma_f32_16x16x32_bf16 v[220:223], v[44:47], v[176:179], v[220:223]
    v_mfma_f32_16x16x32_bf16 v[224:227], v[40:43], a[40:43], v[224:227]
    v_mfma_f32_16x16x32_bf16 v[228:231], v[40:43], a[112:115], v[228:231]
    v_mfma_f32_16x16x32_bf16 v[232:235], v[44:47], a[40:43], v[232:235]
    v_mfma_f32_16x16x32_bf16 v[236:239], v[44:47], a[112:115], v[236:239]
    s_waitcnt lgkmcnt(2)
    v_mfma_f32_16x16x32_bf16 v[208:211], v[48:51], v[108:111], v[208:211]
    ds_read_b128 v[40:43], v3 offset:13312
    v_mfma_f32_16x16x32_bf16 v[212:215], v[48:51], v[180:183], v[212:215]
    ds_read_b128 v[44:47], v3 offset:31744
    v_mfma_f32_16x16x32_bf16 v[216:219], v[52:55], v[108:111], v[216:219]
    v_mfma_f32_16x16x32_bf16 v[220:223], v[52:55], v[180:183], v[220:223]
    v_mfma_f32_16x16x32_bf16 v[224:227], v[48:51], a[44:47], v[224:227]
    v_mfma_f32_16x16x32_bf16 v[228:231], v[48:51], a[116:119], v[228:231]
    v_mfma_f32_16x16x32_bf16 v[232:235], v[52:55], a[44:47], v[232:235]
    v_mfma_f32_16x16x32_bf16 v[236:239], v[52:55], a[116:119], v[236:239]
    s_waitcnt lgkmcnt(2)
    v_mfma_f32_16x16x32_bf16 v[208:211], v[32:35], v[112:115], v[208:211]
    ds_read_b128 v[48:51], v3 offset:14336
    v_mfma_f32_16x16x32_bf16 v[212:215], v[32:35], v[184:187], v[212:215]
    ds_read_b128 v[52:55], v3 offset:32768
    v_mfma_f32_16x16x32_bf16 v[216:219], v[36:39], v[112:115], v[216:219]
    v_mfma_f32_16x16x32_bf16 v[220:223], v[36:39], v[184:187], v[220:223]
    v_mfma_f32_16x16x32_bf16 v[224:227], v[32:35], a[48:51], v[224:227]
    v_mfma_f32_16x16x32_bf16 v[228:231], v[32:35], a[120:123], v[228:231]
    v_mfma_f32_16x16x32_bf16 v[232:235], v[36:39], a[48:51], v[232:235]
    v_mfma_f32_16x16x32_bf16 v[236:239], v[36:39], a[120:123], v[236:239]
    s_waitcnt lgkmcnt(2)
    v_mfma_f32_16x16x32_bf16 v[208:211], v[40:43], v[116:119], v[208:211]
    ds_read_b128 v[32:35], v3 offset:15360
    v_mfma_f32_16x16x32_bf16 v[212:215], v[40:43], v[188:191], v[212:215]
    ds_read_b128 v[36:39], v3 offset:33792
    v_mfma_f32_16x16x32_bf16 v[216:219], v[44:47], v[116:119], v[216:219]
    v_mfma_f32_16x16x32_bf16 v[220:223], v[44:47], v[188:191], v[220:223]
    v_mfma_f32_16x16x32_bf16 v[224:227], v[40:43], a[52:55], v[224:227]
    v_mfma_f32_16x16x32_bf16 v[228:231], v[40:43], a[124:127], v[228:231]
    v_mfma_f32_16x16x32_bf16 v[232:235], v[44:47], a[52:55], v[232:235]
    v_mfma_f32_16x16x32_bf16 v[236:239], v[44:47], a[124:127], v[236:239]
    s_waitcnt lgkmcnt(2)
    v_mfma_f32_16x16x32_bf16 v[208:211], v[48:51], v[120:123], v[208:211]
    ds_read_b128 v[40:43], v3 offset:16384
    v_mfma_f32_16x16x32_bf16 v[212:215], v[48:51], v[192:195], v[212:215]
    ds_read_b128 v[44:47], v3 offset:34816
    v_mfma_f32_16x16x32_bf16 v[216:219], v[52:55], v[120:123], v[216:219]
    v_mfma_f32_16x16x32_bf16 v[220:223], v[52:55], v[192:195], v[220:223]
    v_mfma_f32_16x16x32_bf16 v[224:227], v[48:51], a[56:59], v[224:227]
    v_mfma_f32_16x16x32_bf16 v[228:231], v[48:51], a[128:131], v[228:231]
    v_mfma_f32_16x16x32_bf16 v[232:235], v[52:55], a[56:59], v[232:235]
    v_mfma_f32_16x16x32_bf16 v[236:239], v[52:55], a[128:131], v[236:239]
    s_waitcnt lgkmcnt(2)
    v_mfma_f32_16x16x32_bf16 v[208:211], v[32:35], v[124:127], v[208:211]
    ds_read_b128 v[48:51], v3 offset:17408
    v_mfma_f32_16x16x32_bf16 v[212:215], v[32:35], v[196:199], v[212:215]
    ds_read_b128 v[52:55], v3 offset:35840
    v_mfma_f32_16x16x32_bf16 v[216:219], v[36:39], v[124:127], v[216:219]
    v_mfma_f32_16x16x32_bf16 v[220:223], v[36:39], v[196:199], v[220:223]
    v_mfma_f32_16x16x32_bf16 v[224:227], v[32:35], a[60:63], v[224:227]
    s_add_u32 s27, s27, 36864
    s_cmp_eq_u32 s27, 110592
    s_cselect_b32 s27, 0, s27
    v_add_u32 v3, s27, v1
    v_mfma_f32_16x16x32_bf16 v[228:231], v[32:35], a[132:135], v[228:231]
    v_mfma_f32_16x16x32_bf16 v[232:235], v[36:39], a[60:63], v[232:235]
    v_mfma_f32_16x16x32_bf16 v[236:239], v[36:39], a[132:135], v[236:239]
    s_waitcnt lgkmcnt(2)
    v_mfma_f32_16x16x32_bf16 v[208:211], v[40:43], v[128:131], v[208:211]
    ds_read_b128 v[32:35], v3 offset:0
    v_mfma_f32_16x16x32_bf16 v[212:215], v[40:43], v[200:203], v[212:215]
    ds_read_b128 v[36:39], v3 offset:18432
    v_mfma_f32_16x16x32_bf16 v[216:219], v[44:47], v[128:131], v[216:219]
    v_mfma_f32_16x16x32_bf16 v[220:223], v[44:47], v[200:203], v[220:223]
    v_mfma_f32_16x16x32_bf16 v[224:227], v[40:43], a[64:67], v[224:227]
    v_mfma_f32_16x16x32_bf16 v[228:231], v[40:43], a[136:139], v[228:231]
    v_mfma_f32_16x16x32_bf16 v[232:235], v[44:47], a[64:67], v[232:235]
    v_mfma_f32_16x16x32_bf16 v[236:239], v[44:47], a[136:139], v[236:239]
    s_waitcnt lgkmcnt(2)
    v_mfma_f32_16x16x32_bf16 v[208:211], v[48:51], v[132:135], v[208:211]
    ds_read_b128 v[40:43], v3 offset:1024
    v_mfma_f32_16x16x32_bf16 v[212:215], v[48:51], v[204:207], v[212:215]
    ds_read_b128 v[44:47], v3 offset:19456
    v_mfma_f32_16x16x32_bf16 v[216:219], v[52:55], v[132:135], v[216:219]
    v_mfma_f32_16x16x32_bf16 v[220:223], v[52:55], v[204:207], v[220:223]
    v_mfma_f32_16x16x32_bf16 v[224:227], v[48:51], a[68:71], v[224:227]
    v_mfma_f32_16x16x32_bf16 v[228:231], v[48:51], a[140:143], v[228:231]
    v_mfma_f32_16x16x32_bf16 v[232:235], v[52:55], a[68:71], v[232:235]
    v_mfma_f32_16x16x32_bf16 v[236:239], v[52:55], a[140:143], v[236:239]
    s_add_u32 s26, s26, s41
    s_waitcnt vmcnt(0)
    v_cvt_pk_bf16_f32 v8, v208, v209
    v_cvt_pk_bf16_f32 v9, v210, v211
    v_cvt_pk_bf16_f32 v10, v216, v217
    v_cvt_pk_bf16_f32 v11, v218, v219
    v_cvt_pk_bf16_f32 v12, v212, v213
    v_cvt_pk_bf16_f32 v13, v214, v215
    v_cvt_pk_bf16_f32 v14, v220, v221
    v_cvt_pk_bf16_f32 v15, v222, v223
    v_cvt_pk_bf16_f32 v16, v224, v225
    v_cvt_pk_bf16_f32 v17, v226, v227
    v_cvt_pk_bf16_f32 v18, v232, v233
    v_cvt_pk_bf16_f32 v19, v234, v235
    v_cvt_pk_bf16_f32 v20, v228, v229
    v_cvt_pk_bf16_f32 v21, v230, v231
    v_cvt_pk_bf16_f32 v22, v236, v237
    v_cvt_pk_bf16_f32 v23, v238, v239
    s_mov_b64 s[36:37], -1
    s_add_u32 s28, s26, s12
    buffer_store_dwordx4 v[8:11], v7, s[4:7], s28 offen sc1
    s_add_u32 s28, s26, s13
    buffer_store_dwordx4 v[12:15], v7, s[4:7], s28 offen sc1
    s_add_u32 s28, s26, s14
    buffer_store_dwordx4 v[16:19], v7, s[4:7], s28 offen sc1
    s_add_u32 s28, s26, s15
    buffer_store_dwordx4 v[20:23], v7, s[4:7], s28 offen sc1
    s_lshr_b32 s45, s19, 2
    s_cbranch_scc1 qk_vloop_nf
    s_mov_b32 s45, 1
    s_mov_b64 s[36:37], 0
    s_waitcnt vmcnt(0)
    s_barrier
    s_add_u32 s23, s45, s95
    v_mov_b32 v4, s23
    s_mov_b64 exec, s[34:35]
    buffer_store_dword v4, off, s[4:7], s29 sc1
    buffer_store_dword v4, off, s[4:7], s29 offset:128 sc1
    s_mov_b64 exec, -1
qk_vloop_nf:
    s_add_u32 s19, s19, 4
    s_cmp_lt_u32 s19, s20
    s_cbranch_scc1 qk_vloop
qk_done:
    s_waitcnt vmcnt(0) lgkmcnt(0)
    s_barrier
    s_mov_b32 s45, 16
    s_add_u32 s23, s45, s95
    v_mov_b32 v4, s23
    s_mov_b64 exec, s[34:35]
    buffer_store_dword v4, off, s[4:7], s29 sc1
    buffer_store_dword v4, off, s[4:7], s29 offset:128 sc1
    s_mov_b64 exec, -1
    s_cmp_lt_i32 s33, 0
    s_cbranch_scc1 L_memkv
    v_readfirstlane_b32 s40, v245
    v_readfirstlane_b32 s41, v246
    v_readfirstlane_b32 s42, v247
    v_readfirstlane_b32 s43, v248
    s_cmp_ge_u32 s40, 160
    s_cselect_b32 s43, s43, 0
    s_cmp_ge_u32 s41, 1
    s_cselect_b32 s43, s43, 0
    s_cmp_eq_u32 s42, 1
    s_cselect_b32 s43, s43, 0
    s_cmp_eq_u32 s93, 1000
    s_cselect_b32 s43, s43, 0
    s_mov_b32 s93, 999
    v_mov_b32 v250, s43
    v_mov_b32 v251, 163832
    s_mov_b64 exec, s[34:35]
    ds_write_b32 v251, v250
    s_mov_b64 exec, -1
    s_waitcnt lgkmcnt(0)
    s_barrier
    ds_read_b32 v252, v251
    s_waitcnt lgkmcnt(0)
    v_readfirstlane_b32 s43, v252
    s_barrier
    s_cmp_lg_u32 s43, 192
    s_cbranch_scc1 L_qkv_next
    s_mov_b32 s45, s33
    s_mov_b32 s93, 500
    s_branch L_phase2b
L_memkv:
    v_and_b32 v4, 63, v0
    v_and_b32 v2, 7, v4
    v_lshrrev_b32 v5, 4, v4
    v_lshl_add_u32 v2, v5, 3, v2
    v_lshlrev_b32 v2, 4, v2
    v_bfe_u32 v3, v4, 3, 1
    v_mul_u32_u24 v5, 9216, v3
    v_add_u32 v2, v2, v5
    v_mov_b32 v240, 0x05040100
    v_mov_b32 v241, 0x07060302
    v_lshrrev_b32 v5, 5, v4
    v_and_b32 v1, 0xdff, v7
    s_cmp_eq_u32 s16, 2
    s_cbranch_scc1 mk_isv
    v_mov_b32 v5, v3
    v_or_b32 v1, 128, v7
mk_isv:
    v_lshl_add_u32 v1, v5, 17, v1
    s_mov_b32 s28, 0
    s_mov_b32 s19, 2
    s_mov_b32 s24, 138412032
    s_lshl_b32 s26, s17, 12
    s_mov_b32 s21, 69206016
    s_cmp_eq_u32 s16, 2
    s_cselect_b32 s21, 77594624, s21
    s_add_u32 s26, s26, s21
    s_lshl_b32 s29, s17, 7
    s_lshl_b32 s21, s16, 2
    s_add_u32 s29, s29, s21
    s_add_u32 s29, s29, 125829164
mk_loop:
    s_cmp_lg_u32 s18, 0
    s_cbranch_scc1 mk_go
    s_cmp_le_u32 s19, s28
    s_cbranch_scc1 mk_go
    s_mov_b32 s23, 125853696
    s_mov_b32 s21, 4194304
mk_wait:
    buffer_load_dword v4, off, s[4:7], s23 sc1
    s_sub_u32 s21, s21, 1
    s_cbranch_scc1 mk_go
    s_waitcnt vmcnt(0)
    v_readfirstlane_b32 s28, v4
    s_nop 0
    s_sub_u32 s28, s28, s95
    s_cmp_gt_u32 s28, 64
    s_cselect_b32 s28, 0, s28
    s_cmp_le_u32 s19, s28
    s_cbranch_scc1 mk_go
    s_sleep 4
    s_branch mk_wait
mk_go:
    s_barrier
    s_add_u32 s21, s24, 4096
    s_add_u32 s23, s24, 8192
    buffer_load_dwordx4 v[24:27], v2, s[4:7], s24 offen offset:0 sc1
    buffer_load_dwordx4 v[28:31], v2, s[4:7], s24 offen offset:512 sc1
    buffer_load_dwordx4 v[32:35], v2, s[4:7], s21 offen offset:0 sc1
    buffer_load_dwordx4 v[36:39], v2, s[4:7], s21 offen offset:512 sc1
    buffer_load_dwordx4 v[40:43], v2, s[4:7], s24 offen offset:1024 sc1
    buffer_load_dwordx4 v[44:47], v2, s[4:7], s24 offen offset:1536 sc1
    buffer_load_dwordx4 v[48:51], v2, s[4:7], s21 offen offset:1024 sc1
    buffer_load_dwordx4 v[52:55], v2, s[4:7], s21 offen offset:1536 sc1
    buffer_load_dwordx4 v[56:59], v2, s[4:7], s24 offen offset:2048 sc1
    buffer_load_dwordx4 v[60:63], v2, s[4:7], s24 offen offset:2560 sc1
    buffer_load_dwordx4 v[208:211], v2, s[4:7], s21 offen offset:2048 sc1
    buffer_load_dwordx4 v[212:215], v2, s[4:7], s21 offen offset:2560 sc1
    buffer_load_dwordx4 v[216:219], v2, s[4:7], s24 offen offset:3072 sc1
    buffer_load_dwordx4 v[220:223], v2, s[4:7], s24 offen offset:3584 sc1
    buffer_load_dwordx4 v[224:227], v2, s[4:7], s21 offen offset:3072 sc1
    buffer_load_dwordx4 v[228:231], v2, s[4:7], s21 offen offset:3584 sc1
    buffer_load_dwordx4 v[232:235], v2, s[4:7], s23 offen offset:0 sc1
    buffer_load_dwordx4 v[236:239], v2, s[4:7], s23 offen offset:512 sc1
    s_add_u32 s24, s24, 18432
    s_cmp_eq_u32 s16, 2
    s_cbranch_scc1 mk_v
    s_waitcnt vmcnt(17)
    s_waitcnt vmcnt(16)
    v_mfma_f32_16x16x32_bf16 v[8:11], v[64:67], v[24:27], 0
    v_mfma_f32_16x16x32_bf16 v[12:15], v[136:139], v[24:27], 0
    v_mfma_f32_16x16x32_bf16 v[16:19], a[0:3], v[24:27], 0
    v_mfma_f32_16x16x32_bf16 v[20:23], a[72:75], v[24:27], 0
    s_waitcnt vmcnt(15)
    v_mfma_f32_16x16x32_bf16 v[8:11], v[68:71], v[28:31], v[8:11]
    v_mfma_f32_16x16x32_bf16 v[12:15], v[140:143], v[28:31], v[12:15]
    v_mfma_f32_16x16x32_bf16 v[16:19], a[4:7], v[28:31], v[16:19]
    v_mfma_f32_16x16x32_bf16 v[20:23], a[76:79], v[28:31], v[20:23]
    s_waitcnt vmcnt(14)
    v_mfma_f32_16x16x32_bf16 v[8:11], v[72:75], v[32:35], v[8:11]
    v_mfma_f32_16x16x32_bf16 v[12:15], v[144:147], v[32:35], v[12:15]
    v_mfma_f32_16x16x32_bf16 v[16:19], a[8:11], v[32:35], v[16:19]
    v_mfma_f32_16x16x32_bf16 v[20:23], a[80:83], v[32:35], v[20:23]
    s_waitcnt vmcnt(13)
    v_mfma_f32_16x16x32_bf16 v[8:11], v[76:79], v[36:39], v[8:11]
    v_mfma_f32_16x16x32_bf16 v[12:15], v[148:151], v[36:39], v[12:15]
    v_mfma_f32_16x16x32_bf16 v[16:19], a[12:15], v[36:39], v[16:19]
    v_mfma_f32_16x16x32_bf16 v[20:23], a[84:87], v[36:39], v[20:23]
    s_waitcnt vmcnt(12)
    v_mfma_f32_16x16x32_bf16 v[8:11], v[80:83], v[40:43], v[8:11]
    v_mfma_f32_16x16x32_bf16 v[12:15], v[152:155], v[40:43], v[12:15]
    v_mfma_f32_16x16x32_bf16 v[16:19], a[16:19], v[40:43], v[16:19]
    v_mfma_f32_16x16x32_bf16 v[20:23], a[88:91], v[40:43], v[20:23]
    s_waitcnt vmcnt(11)
    v_mfma_f32_16x16x32_bf16 v[8:11], v[84:87], v[44:47], v[8:11]
    v_mfma_f32_16x16x32_bf16 v[12:15], v[156:159], v[44:47], v[12:15]
    v_mfma_f32_16x16x32_bf16 v[16:19], a[20:23], v[44:47], v[16:19]
    v_mfma_f32_16x16x32_bf16 v[20:23], a[92:95], v[44:47], v[20:23]
    s_waitcnt vmcnt(10)
    v_mfma_f32_16x16x32_bf16 v[8:11], v[88:91], v[48:51], v[8:11]
    v_mfma_f32_16x16x32_bf16 v[12:15], v[160:163], v[48:51], v[12:15]
    v_mfma_f32_16x16x32_bf16 v[16:19], a[24:27], v[48:51], v[16:19]
    v_mfma_f32_16x16x32_bf16 v[20:23], a[96:99], v[48:51], v[20:23]
    s_waitcnt vmcnt(9)
    v_mfma_f32_16x16x32_bf16 v[8:11], v[92:95], v[52:55], v[8:11]
    v_mfma_f32_16x16x32_bf16 v[12:15], v[164:167], v[52:55], v[12:15]
    v_mfma_f32_16x16x32_bf16 v[16:19], a[28:31], v[52:55], v[16:19]
    v_mfma_f32_16x16x32_bf16 v[20:23], a[100:103], v[52:55], v[20:23]
    s_waitcnt vmcnt(8)
    v_mfma_f32_16x16x32_bf16 v[8:11], v[96:99], v[56:59], v[8:11]
    v_mfma_f32_16x16x32_bf16 v[12:15], v[168:171], v[56:59], v[12:15]
    v_mfma_f32_16x16x32_bf16 v[16:19], a[32:35], v[56:59], v[16:19]
    v_mfma_f32_16x16x32_bf16 v[20:23], a[104:107], v[56:59], v[20:23]
    s_waitcnt vmcnt(7)
    v_mfma_f32_16x16x32_bf16 v[8:11], v[100:103], v[60:63], v[8:11]
    v_mfma_f32_16x16x32_bf16 v[12:15], v[172:175], v[60:63], v[12:15]
    v_mfma_f32_16x16x32_bf16 v[16:19], a[36:39], v[60:63], v[16:19]
    v_mfma_f32_16x16x32_bf16 v[20:23], a[108:111], v[60:63], v[20:23]
    s_waitcnt vmcnt(6)
    v_mfma_f32_16x16x32_bf16 v[8:11], v[104:107], v[208:211], v[8:11]
    v_mfma_f32_16x16x32_bf16 v[12:15], v[176:179], v[208:211], v[12:15]
    v_mfma_f32_16x16x32_bf16 v[16:19], a[40:43], v[208:211], v[16:19]
    v_mfma_f32_16x16x32_bf16 v[20:23], a[112:115], v[208:211], v[20:23]
    s_waitcnt vmcnt(5)
    v_mfma_f32_16x16x32_bf16 v[8:11], v[108:111], v[212:215], v[8:11]
    v_mfma_f32_16x16x32_bf16 v[12:15], v[180:183], v[212:215], v[12:15]
    v_mfma_f32_16x16x32_bf16 v[16:19], a[44:47], v[212:215], v[16:19]
    v_mfma_f32_16x16x32_bf16 v[20:23], a[116:119], v[212:215], v[20:23]
    s_waitcnt vmcnt(4)
    v_mfma_f32_16x16x32_bf16 v[8:11], v[112:115], v[216:219], v[8:11]
    v_mfma_f32_16x16x32_bf16 v[12:15], v[184:187], v[216:219], v[12:15]
    v_mfma_f32_16x16x32_bf16 v[16:19], a[48:51], v[216:219], v[16:19]
    v_mfma_f32_16x16x32_bf16 v[20:23], a[120:123], v[216:219], v[20:23]
    s_waitcnt vmcnt(3)
    v_mfma_f32_16x16x32_bf16 v[8:11], v[116:119], v[220:223], v[8:11]
    v_mfma_f32_16x16x32_bf16 v[12:15], v[188:191], v[220:223], v[12:15]
    v_mfma_f32_16x16x32_bf16 v[16:19], a[52:55], v[220:223], v[16:19]
    v_mfma_f32_16x16x32_bf16 v[20:23], a[124:127], v[220:223], v[20:23]
    s_waitcnt vmcnt(2)
    v_mfma_f32_16x16x32_bf16 v[8:11], v[120:123], v[224:227], v[8:11]
    v_mfma_f32_16x16x32_bf16 v[12:15], v[192:195], v[224:227], v[12:15]
    v_mfma_f32_16x16x32_bf16 v[16:19], a[56:59], v[224:227], v[16:19]
    v_mfma_f32_16x16x32_bf16 v[20:23], a[128:131], v[224:227], v[20:23]
    s_waitcnt vmcnt(1)
    v_mfma_f32_16x16x32_bf16 v[8:11], v[124:127], v[228:231], v[8:11]
    v_mfma_f32_16x16x32_bf16 v[12:15], v[196:199], v[228:231], v[12:15]
    v_mfma_f32_16x16x32_bf16 v[16:19], a[60:63], v[228:231], v[16:19]
    v_mfma_f32_16x16x32_bf16 v[20:23], a[132:135], v[228:231], v[20:23]
    s_waitcnt vmcnt(0)
    v_mfma_f32_16x16x32_bf16 v[8:11], v[128:131], v[232:235], v[8:11]
    v_mfma_f32_16x16x32_bf16 v[12:15], v[200:203], v[232:235], v[12:15]
    v_mfma_f32_16x16x32_bf16 v[16:19], a[64:67], v[232:235], v[16:19]
    v_mfma_f32_16x16x32_bf16 v[20:23], a[136:139], v[232:235], v[20:23]
    v_mfma_f32_16x16x32_bf16 v[8:11], v[132:135], v[236:239], v[8:11]
    v_mfma_f32_16x16x32_bf16 v[12:15], v[204:207], v[236:239], v[12:15]
    v_mfma_f32_16x16x32_bf16 v[16:19], a[68:71], v[236:239], v[16:19]
    v_mfma_f32_16x16x32_bf16 v[20:23], a[140:143], v[236:239], v[20:23]
    s_nop 7
    s_branch mk_st
mk_v:
    s_waitcnt vmcnt(17)
    s_waitcnt vmcnt(16)
    v_mfma_f32_16x16x32_bf16 v[8:11], v[24:27], v[64:67], 0
    v_mfma_f32_16x16x32_bf16 v[12:15], v[24:27], v[136:139], 0
    v_mfma_f32_16x16x32_bf16 v[16:19], v[24:27], a[0:3], 0
    v_mfma_f32_16x16x32_bf16 v[20:23], v[24:27], a[72:75], 0
    s_waitcnt vmcnt(15)
    v_mfma_f32_16x16x32_bf16 v[8:11], v[28:31], v[68:71], v[8:11]
    v_mfma_f32_16x16x32_bf16 v[12:15], v[28:31], v[140:143], v[12:15]
    v_mfma_f32_16x16x32_bf16 v[16:19], v[28:31], a[4:7], v[16:19]
    v_mfma_f32_16x16x32_bf16 v[20:23], v[28:31], a[76:79], v[20:23]
    s_waitcnt vmcnt(14)
    v_mfma_f32_16x16x32_bf16 v[8:11], v[32:35], v[72:75], v[8:11]
    v_mfma_f32_16x16x32_bf16 v[12:15], v[32:35], v[144:147], v[12:15]
    v_mfma_f32_16x16x32_bf16 v[16:19], v[32:35], a[8:11], v[16:19]
    v_mfma_f32_16x16x32_bf16 v[20:23], v[32:35], a[80:83], v[20:23]
    s_waitcnt vmcnt(13)
    v_mfma_f32_16x16x32_bf16 v[8:11], v[36:39], v[76:79], v[8:11]
    v_mfma_f32_16x16x32_bf16 v[12:15], v[36:39], v[148:151], v[12:15]
    v_mfma_f32_16x16x32_bf16 v[16:19], v[36:39], a[12:15], v[16:19]
    v_mfma_f32_16x16x32_bf16 v[20:23], v[36:39], a[84:87], v[20:23]
    s_waitcnt vmcnt(12)
    v_mfma_f32_16x16x32_bf16 v[8:11], v[40:43], v[80:83], v[8:11]
    v_mfma_f32_16x16x32_bf16 v[12:15], v[40:43], v[152:155], v[12:15]
    v_mfma_f32_16x16x32_bf16 v[16:19], v[40:43], a[16:19], v[16:19]
    v_mfma_f32_16x16x32_bf16 v[20:23], v[40:43], a[88:91], v[20:23]
    s_waitcnt vmcnt(11)
    v_mfma_f32_16x16x32_bf16 v[8:11], v[44:47], v[84:87], v[8:11]
    v_mfma_f32_16x16x32_bf16 v[12:15], v[44:47], v[156:159], v[12:15]
    v_mfma_f32_16x16x32_bf16 v[16:19], v[44:47], a[20:23], v[16:19]
    v_mfma_f32_16x16x32_bf16 v[20:23], v[44:47], a[92:95], v[20:23]
    s_waitcnt vmcnt(10)
    v_mfma_f32_16x16x32_bf16 v[8:11], v[48:51], v[88:91], v[8:11]
    v_mfma_f32_16x16x32_bf16 v[12:15], v[48:51], v[160:163], v[12:15]
    v_mfma_f32_16x16x32_bf16 v[16:19], v[48:51], a[24:27], v[16:19]
    v_mfma_f32_16x16x32_bf16 v[20:23], v[48:51], a[96:99], v[20:23]
    s_waitcnt vmcnt(9)
    v_mfma_f32_16x16x32_bf16 v[8:11], v[52:55], v[92:95], v[8:11]
    v_mfma_f32_16x16x32_bf16 v[12:15], v[52:55], v[164:167], v[12:15]
    v_mfma_f32_16x16x32_bf16 v[16:19], v[52:55], a[28:31], v[16:19]
    v_mfma_f32_16x16x32_bf16 v[20:23], v[52:55], a[100:103], v[20:23]
    s_waitcnt vmcnt(8)
    v_mfma_f32_16x16x32_bf16 v[8:11], v[56:59], v[96:99], v[8:11]
    v_mfma_f32_16x16x32_bf16 v[12:15], v[56:59], v[168:171], v[12:15]
    v_mfma_f32_16x16x32_bf16 v[16:19], v[56:59], a[32:35], v[16:19]
    v_mfma_f32_16x16x32_bf16 v[20:23], v[56:59], a[104:107], v[20:23]
    s_waitcnt vmcnt(7)
    v_mfma_f32_16x16x32_bf16 v[8:11], v[60:63], v[100:103], v[8:11]
    v_mfma_f32_16x16x32_bf16 v[12:15], v[60:63], v[172:175], v[12:15]
    v_mfma_f32_16x16x32_bf16 v[16:19], v[60:63], a[36:39], v[16:19]
    v_mfma_f32_16x16x32_bf16 v[20:23], v[60:63], a[108:111], v[20:23]
    s_waitcnt vmcnt(6)
    v_mfma_f32_16x16x32_bf16 v[8:11], v[208:211], v[104:107], v[8:11]
    v_mfma_f32_16x16x32_bf16 v[12:15], v[208:211], v[176:179], v[12:15]
    v_mfma_f32_16x16x32_bf16 v[16:19], v[208:211], a[40:43], v[16:19]
    v_mfma_f32_16x16x32_bf16 v[20:23], v[208:211], a[112:115], v[20:23]
    s_waitcnt vmcnt(5)
    v_mfma_f32_16x16x32_bf16 v[8:11], v[212:215], v[108:111], v[8:11]
    v_mfma_f32_16x16x32_bf16 v[12:15], v[212:215], v[180:183], v[12:15]
    v_mfma_f32_16x16x32_bf16 v[16:19], v[212:215], a[44:47], v[16:19]
    v_mfma_f32_16x16x32_bf16 v[20:23], v[212:215], a[116:119], v[20:23]
    s_waitcnt vmcnt(4)
    v_mfma_f32_16x16x32_bf16 v[8:11], v[216:219], v[112:115], v[8:11]
    v_mfma_f32_16x16x32_bf16 v[12:15], v[216:219], v[184:187], v[12:15]
    v_mfma_f32_16x16x32_bf16 v[16:19], v[216:219], a[48:51], v[16:19]
    v_mfma_f32_16x16x32_bf16 v[20:23], v[216:219], a[120:123], v[20:23]
    s_waitcnt vmcnt(3)
    v_mfma_f32_16x16x32_bf16 v[8:11], v[220:223], v[116:119], v[8:11]
    v_mfma_f32_16x16x32_bf16 v[12:15], v[220:223], v[188:191], v[12:15]
    v_mfma_f32_16x16x32_bf16 v[16:19], v[220:223], a[52:55], v[16:19]
    v_mfma_f32_16x16x32_bf16 v[20:23], v[220:223], a[124:127], v[20:23]
    s_waitcnt vmcnt(2)
    v_mfma_f32_16x16x32_bf16 v[8:11], v[224:227], v[120:123], v[8:11]
    v_mfma_f32_16x16x32_bf16 v[12:15], v[224:227], v[192:195], v[12:15]
    v_mfma_f32_16x16x32_bf16 v[16:19], v[224:227], a[56:59], v[16:19]
    v_mfma_f32_16x16x32_bf16 v[20:23], v[224:227], a[128:131], v[20:23]
    s_waitcnt vmcnt(1)
    v_mfma_f32_16x16x32_bf16 v[8:11], v[228:231], v[124:127], v[8:11]
    v_mfma_f32_16x16x32_bf16 v[12:15], v[228:231], v[196:199], v[12:15]
    v_mfma_f32_16x16x32_bf16 v[16:19], v[228:231], a[60:63], v[16:19]
    v_mfma_f32_16x16x32_bf16 v[20:23], v[228:231], a[132:135], v[20:23]
    s_waitcnt vmcnt(0)
    v_mfma_f32_16x16x32_bf16 v[8:11], v[232:235], v[128:131], v[8:11]
    v_mfma_f32_16x16x32_bf16 v[12:15], v[232:235], v[200:203], v[12:15]
    v_mfma_f32_16x16x32_bf16 v[16:19], v[232:235], a[64:67], v[16:19]
    v_mfma_f32_16x16x32_bf16 v[20:23], v[232:235], a[136:139], v[20:23]
    v_mfma_f32_16x16x32_bf16 v[8:11], v[236:239], v[132:135], v[8:11]
    v_mfma_f32_16x16x32_bf16 v[12:15], v[236:239], v[204:207], v[12:15]
    v_mfma_f32_16x16x32_bf16 v[16:19], v[236:239], a[68:71], v[16:19]
    v_mfma_f32_16x16x32_bf16 v[20:23], v[236:239], a[140:143], v[20:23]
    s_nop 4
    v_pk_mul_f32 v[8:9], v[8:9], 0.5 op_sel_hi:[1,0]
    v_pk_mul_f32 v[10:11], v[10:11], 0.5 op_sel_hi:[1,0]
    v_pk_mul_f32 v[12:13], v[12:13], 0.5 op_sel_hi:[1,0]
    v_pk_mul_f32 v[14:15], v[14:15], 0.5 op_sel_hi:[1,0]
    v_pk_mul_f32 v[16:17], v[16:17], 0.5 op_sel_hi:[1,0]
    v_pk_mul_f32 v[18:19], v[18:19], 0.5 op_sel_hi:[1,0]
    v_pk_mul_f32 v[20:21], v[20:21], 0.5 op_sel_hi:[1,0]
    v_pk_mul_f32 v[22:23], v[22:23], 0.5 op_sel_hi:[1,0]
mk_st:
    s_nop 1
    v_cvt_pk_bf16_f32 v24, v8, v9
    v_cvt_pk_bf16_f32 v25, v10, v11
    v_cvt_pk_bf16_f32 v26, v12, v13
    v_cvt_pk_bf16_f32 v27, v14, v15
    v_cvt_pk_bf16_f32 v28, v16, v17
    v_cvt_pk_bf16_f32 v29, v18, v19
    v_cvt_pk_bf16_f32 v30, v20, v21
    v_cvt_pk_bf16_f32 v31, v22, v23
    s_add_u32 s21, s26, 4096
    buffer_store_dwordx4 v[24:27], v1, s[4:7], s26 offen sc1
    buffer_store_dwordx4 v[28:31], v1, s[4:7], s21 offen sc1
    s_add_u32 s22, s19, s95
    s_waitcnt vmcnt(0)
    s_barrier
    v_mov_b32 v4, s22
    s_mov_b64 exec, s[34:35]
    buffer_store_dword v4, off, s[4:7], s29 sc1
    buffer_store_dword v4, off, s[4:7], s29 offset:128 sc1
    s_mov_b64 exec, -1
    s_add_u32 s19, s19, 2
    s_add_u32 s26, s26, 262144
    s_cmp_le_u32 s19, 56
    s_cbranch_scc1 mk_loop
    s_mov_b32 s45, 2
    s_mov_b32 s8, s76
    s_mov_b32 s9, s77
    s_mov_b32 s10, 4718592
    s_mov_b32 s11, 0x20000
    s_branch L_att_next
L_ssm_next:
    s_sub_u32 s93, s93, 1
    s_cbranch_scc1 L_exit
    s_mov_b32 s37, 8
    v_mov_b32 v250, 1
    v_mov_b32 v251, 163832
    v_cmp_eq_u32 vcc, 0, v0
    s_nop 0
    s_and_saveexec_b64 s[38:39], vcc
    s_cbranch_execz tk11
    buffer_atomic_add v250, off, s[84:87], s37 sc0
    s_waitcnt vmcnt(0)
    ds_write_b32 v251, v250
    s_waitcnt lgkmcnt(0)
tk11:
    s_mov_b64 exec, -1
    s_barrier
    ds_read_b32 v252, v251
    s_waitcnt lgkmcnt(0)
    v_readfirstlane_b32 s20, v252
    s_barrier
    s_nop 3
    s_cmp_ge_u32 s20, 72
    s_cbranch_scc1 L_ssm_done
    s_lshl_b32 s20, s20, 3
    v_lshrrev_b32 v5, 6, v0
    s_nop 0
    v_readfirstlane_b32 s21, v5
    v_and_b32 v1, 63, v0
    v_and_b32 v2, 15, v1
    v_lshrrev_b32 v3, 4, v1
    v_lshlrev_b32 v4, 14, v5
    s_mov_b32 s8, s62
    s_mov_b32 s9, s63
    s_mov_b32 s10, 2359296
    s_mov_b32 s11, 0x20000
    s_mov_b32 s16, s76
    s_mov_b32 s17, s77
    s_mov_b32 s18, 4718592
    s_mov_b32 s19, 0x20000
    s_add_u32 s22, s20, s21
    s_lshl_b32 s23, s22, 8
    v_lshlrev_b32 v6, 3, v2
    v_lshl_add_u32 v6, v3, 1, v6
    s_mov_b32 s12, s64
    s_mov_b32 s13, s65
    s_mov_b32 s14, 147456
    s_mov_b32 s15, 0x20000
    buffer_load_ushort v8, v6, s[12:15], s23 offen offset:0
    buffer_load_ushort v12, v6, s[12:15], s23 offen offset:128
    buffer_load_ushort v16, v6, s[12:15], s23 offen offset:1024
    buffer_load_ushort v20, v6, s[12:15], s23 offen offset:1152
    s_mov_b32 s12, s66
    s_mov_b32 s13, s67
    s_mov_b32 s14, 147456
    s_mov_b32 s15, 0x20000
    buffer_load_ushort v9, v6, s[12:15], s23 offen offset:0
    buffer_load_ushort v13, v6, s[12:15], s23 offen offset:128
    buffer_load_ushort v17, v6, s[12:15], s23 offen offset:1024
    buffer_load_ushort v21, v6, s[12:15], s23 offen offset:1152
    s_mov_b32 s12, s68
    s_mov_b32 s13, s69
    s_mov_b32 s14, 147456
    s_mov_b32 s15, 0x20000
    buffer_load_ushort v10, v6, s[12:15], s23 offen offset:0
    buffer_load_ushort v14, v6, s[12:15], s23 offen offset:128
    buffer_load_ushort v18, v6, s[12:15], s23 offen offset:1024
    buffer_load_ushort v22, v6, s[12:15], s23 offen offset:1152
    s_mov_b32 s12, s70
    s_mov_b32 s13, s71
    s_mov_b32 s14, 147456
    s_mov_b32 s15, 0x20000
    buffer_load_ushort v11, v6, s[12:15], s23 offen offset:0
    buffer_load_ushort v15, v6, s[12:15], s23 offen offset:128
    buffer_load_ushort v19, v6, s[12:15], s23 offen offset:1024
    buffer_load_ushort v23, v6, s[12:15], s23 offen offset:1152
    s_mov_b32 s12, s72
    s_mov_b32 s13, s73
    s_mov_b32 s14, 1152
    s_mov_b32 s15, 0x20000
    s_lshl_b32 s23, s22, 1
    buffer_load_ushort v24, off, s[12:15], s23
    buffer_load_ushort v25, off, s[12:15], s23 offset:8
    v_mul_u32_u24 v5, 9216, v0
    s_lshl_b32 s22, s20, 1
    s_add_u32 s23, s22, 0
    buffer_load_dwordx4 v[208:211], v5, s[8:11], s23 offen
    s_add_u32 s23, s22, 1152
    buffer_load_dwordx4 v[212:215], v5, s[8:11], s23 offen
    s_add_u32 s23, s22, 2304
    buffer_load_dwordx4 v[216:219], v5, s[8:11], s23 offen
    s_add_u32 s23, s22, 3456
    buffer_load_dwordx4 v[220:223], v5, s[8:11], s23 offen
    s_add_u32 s23, s22, 4608
    buffer_load_dwordx4 v[224:227], v5, s[8:11], s23 offen
    s_add_u32 s23, s22, 5760
    buffer_load_dwordx4 v[228:231], v5, s[8:11], s23 offen
    s_add_u32 s23, s22, 6912
    buffer_load_dwordx4 v[232:235], v5, s[8:11], s23 offen
    s_add_u32 s23, s22, 8064
    buffer_load_dwordx4 v[236:239], v5, s[8:11], s23 offen
    s_mov_b32 s26, 0x3fb8aa3b
    s_mov_b32 s27, 0x3e22f983
    s_mov_b32 s28, 0
    v_cvt_f32_u32 v26, v2
    v_mul_f32 v27, 0x41800000, v26
    s_waitcnt vmcnt(8)
    s_nop 0
ss_pass:
    v_mov_b32 v36, 0
    v_mov_b32 v37, 0
    v_lshl_add_u32 v6, v1, 3, v4
    ds_write_b64 v6, v[36:37] offset:0
    v_lshlrev_b32 v38, 16, v24
    v_mul_f32 v38, s26, v38
    v_exp_f32 v38, v38
    s_nop 0
    v_cvt_pk_bf16_f32 v38, v38, v38
    v_and_b32 v38, 0xffff0000, v38
    v_add_f32 v39, v38, v38
    v_lshlrev_b32 v28, 16, v8
    v_mul_f32 v28, s26, v28
    v_exp_f32 v28, v28
    s_nop 0
    v_cvt_pk_bf16_f32 v28, v28, v28
    v_and_b32 v28, 0xffff0000, v28
    v_mul_f32 v28, v28, v38
    v_mul_f32 v28, s26, v28
    v_sub_f32 v28, 0, v28
    v_lshlrev_b32 v29, 16, v9
    v_mul_f32 v29, v29, v38
    v_mul_f32 v29, s27, v29
    v_lshlrev_b32 v30, 16, v10
    v_mul_f32 v30, v30, v39
    v_lshlrev_b32 v31, 16, v11
    v_mul_f32 v31, v31, v39
    v_lshlrev_b32 v32, 16, v12
    v_mul_f32 v32, s26, v32
    v_exp_f32 v32, v32
    s_nop 0
    v_cvt_pk_bf16_f32 v32, v32, v32
    v_and_b32 v32, 0xffff0000, v32
    v_mul_f32 v32, v32, v38
    v_mul_f32 v32, s26, v32
    v_sub_f32 v32, 0, v32
    v_lshlrev_b32 v33, 16, v13
    v_mul_f32 v33, v33, v38
    v_mul_f32 v33, s27, v33
    v_lshlrev_b32 v34, 16, v14
    v_mul_f32 v34, v34, v39
    v_lshlrev_b32 v35, 16, v15
    v_mul_f32 v35, v35, v39
    v_mov_b64 v[48:49], 0
    v_mov_b64 v[50:51], 0
    v_mov_b64 v[52:53], 0
    v_mov_b64 v[54:55], 0
    v_mov_b64 v[56:57], 0
    v_mov_b64 v[58:59], 0
    v_mov_b64 v[60:61], 0
    v_mov_b64 v[62:63], 0
    s_mov_b32 s25, 0
    s_nop 0
ss_kg:
    v_mov_b64_dpp v[64:65], v[28:29] row_newbcast:0 row_mask:0xf bank_mask:0xf
    v_mov_b64_dpp v[66:67], v[30:31] row_newbcast:0 row_mask:0xf bank_mask:0xf
    v_pk_mul_f32 v[94:95], v[64:65], v[26:27] op_sel_hi:[1,0]
    v_pk_mul_f32 v[96:97], v[64:65], v[26:27] op_sel:[0,1] op_sel_hi:[1,1]
    v_fract_f32 v95, v95
    v_fract_f32 v97, v97
    v_exp_f32 v94, v94
    v_exp_f32 v96, v96
    v_cos_f32 v68, v95
    v_sin_f32 v69, v95
    v_cos_f32 v76, v97
    v_sin_f32 v77, v97
    v_pk_mul_f32 v[68:69], v[68:69], v[94:95] op_sel_hi:[1,0]
    v_pk_mul_f32 v[76:77], v[76:77], v[96:97] op_sel_hi:[1,0]
    v_pk_mul_f32 v[92:93], v[76:77], v[76:77] op_sel:[1,1] op_sel_hi:[0,1]
    v_pk_fma_f32 v[78:79], v[76:77], v[76:77], v[92:93] op_sel:[0,0,0] op_sel_hi:[0,1,1] neg_lo:[0,0,1]
    v_pk_mul_f32 v[94:95], v[68:69], v[68:69] op_sel:[1,1] op_sel_hi:[0,1]
    v_pk_fma_f32 v[70:71], v[68:69], v[68:69], v[94:95] op_sel:[0,0,0] op_sel_hi:[0,1,1] neg_lo:[0,0,1]
    v_pk_mul_f32 v[92:93], v[78:79], v[78:79] op_sel:[1,1] op_sel_hi:[0,1]
    v_pk_fma_f32 v[80:81], v[78:79], v[78:79], v[92:93] op_sel:[0,0,0] op_sel_hi:[0,1,1] neg_lo:[0,0,1]
    v_pk_mul_f32 v[94:95], v[70:71], v[70:71] op_sel:[1,1] op_sel_hi:[0,1]
    v_pk_fma_f32 v[72:73], v[70:71], v[70:71], v[94:95] op_sel:[0,0,0] op_sel_hi:[0,1,1] neg_lo:[0,0,1]
    v_pk_mul_f32 v[92:93], v[80:81], v[80:81] op_sel:[1,1] op_sel_hi:[0,1]
    v_pk_fma_f32 v[82:83], v[80:81], v[80:81], v[92:93] op_sel:[0,0,0] op_sel_hi:[0,1,1] neg_lo:[0,0,1]
    v_pk_mul_f32 v[94:95], v[72:73], v[72:73] op_sel:[1,1] op_sel_hi:[0,1]
    v_pk_fma_f32 v[74:75], v[72:73], v[72:73], v[94:95] op_sel:[0,0,0] op_sel_hi:[0,1,1] neg_lo:[0,0,1]
    v_pk_mul_f32 v[92:93], v[82:83], v[82:83] op_sel:[1,1] op_sel_hi:[0,1]
    v_pk_fma_f32 v[84:85], v[82:83], v[82:83], v[92:93] op_sel:[0,0,0] op_sel_hi:[0,1,1] neg_lo:[0,0,1]
    v_pk_mul_f32 v[94:95], v[66:67], v[76:77] op_sel:[1,1] op_sel_hi:[1,0]
    v_pk_fma_f32 v[86:87], v[66:67], v[76:77], v[94:95] op_sel:[0,0,0] op_sel_hi:[0,1,1] neg_lo:[0,0,1] neg_hi:[1,0,1]
    v_mov_b32_dpp v80, v78 row_ror:8 row_mask:0xf bank_mask:0x3
    v_mov_b32_dpp v81, v79 row_ror:8 row_mask:0xf bank_mask:0x3
    v_mov_b32_dpp v82, v84 row_ror:8 row_mask:0xf bank_mask:0x3
    v_mov_b32_dpp v83, v85 row_ror:8 row_mask:0xf bank_mask:0x3
    v_pk_mul_f32 v[92:93], v[66:67], v[80:81] op_sel:[1,1] op_sel_hi:[1,0]
    v_pk_fma_f32 v[88:89], v[66:67], v[80:81], v[92:93] op_sel:[0,0,0] op_sel_hi:[0,1,1] neg_lo:[0,0,1] neg_hi:[1,0,1]
    v_pk_mul_f32 v[94:95], v[66:67], v[82:83] op_sel:[1,1] op_sel_hi:[1,0]
    v_pk_fma_f32 v[90:91], v[66:67], v[82:83], v[94:95] op_sel:[0,0,0] op_sel_hi:[0,1,1] neg_lo:[0,0,1] neg_hi:[1,0,1]
    v_mfma_f32_16x16x4_f32 v[48:51], v86, v68, v[48:51]
    v_mfma_f32_16x16x4_f32 v[52:55], v88, v70, v[52:55]
    v_mfma_f32_16x16x4_f32 v[56:59], v88, v72, v[56:59]
    v_mfma_f32_16x16x4_f32 v[60:63], v90, v74, v[60:63]
    v_mfma_f32_16x16x4_f32 v[48:51], v87, v69, v[48:51]
    v_mfma_f32_16x16x4_f32 v[52:55], v89, v71, v[52:55]
    v_mfma_f32_16x16x4_f32 v[56:59], v89, v73, v[56:59]
    v_mfma_f32_16x16x4_f32 v[60:63], v91, v75, v[60:63]
    v_mov_b64_dpp v[64:65], v[28:29] row_newbcast:1 row_mask:0xf bank_mask:0xf
    v_mov_b64_dpp v[66:67], v[30:31] row_newbcast:1 row_mask:0xf bank_mask:0xf
    v_pk_mul_f32 v[94:95], v[64:65], v[26:27] op_sel_hi:[1,0]
    v_pk_mul_f32 v[96:97], v[64:65], v[26:27] op_sel:[0,1] op_sel_hi:[1,1]
    v_fract_f32 v95, v95
    v_fract_f32 v97, v97
    v_exp_f32 v94, v94
    v_exp_f32 v96, v96
    v_cos_f32 v68, v95
    v_sin_f32 v69, v95
    v_cos_f32 v76, v97
    v_sin_f32 v77, v97
    v_pk_mul_f32 v[68:69], v[68:69], v[94:95] op_sel_hi:[1,0]
    v_pk_mul_f32 v[76:77], v[76:77], v[96:97] op_sel_hi:[1,0]
    v_pk_mul_f32 v[92:93], v[76:77], v[76:77] op_sel:[1,1] op_sel_hi:[0,1]
    v_pk_fma_f32 v[78:79], v[76:77], v[76:77], v[92:93] op_sel:[0,0,0] op_sel_hi:[0,1,1] neg_lo:[0,0,1]
    v_pk_mul_f32 v[94:95], v[68:69], v[68:69] op_sel:[1,1] op_sel_hi:[0,1]
    v_pk_fma_f32 v[70:71], v[68:69], v[68:69], v[94:95] op_sel:[0,0,0] op_sel_hi:[0,1,1] neg_lo:[0,0,1]
    v_pk_mul_f32 v[92:93], v[78:79], v[78:79] op_sel:[1,1] op_sel_hi:[0,1]
    v_pk_fma_f32 v[80:81], v[78:79], v[78:79], v[92:93] op_sel:[0,0,0] op_sel_hi:[0,1,1] neg_lo:[0,0,1]
    v_pk_mul_f32 v[94:95], v[70:71], v[70:71] op_sel:[1,1] op_sel_hi:[0,1]
    v_pk_fma_f32 v[72:73], v[70:71], v[70:71], v[94:95] op_sel:[0,0,0] op_sel_hi:[0,1,1] neg_lo:[0,0,1]
    v_pk_mul_f32 v[92:93], v[80:81], v[80:81] op_sel:[1,1] op_sel_hi:[0,1]
    v_pk_fma_f32 v[82:83], v[80:81], v[80:81], v[92:93] op_sel:[0,0,0] op_sel_hi:[0,1,1] neg_lo:[0,0,1]
    v_pk_mul_f32 v[94:95], v[72:73], v[72:73] op_sel:[1,1] op_sel_hi:[0,1]
    v_pk_fma_f32 v[74:75], v[72:73], v[72:73], v[94:95] op_sel:[0,0,0] op_sel_hi:[0,1,1] neg_lo:[0,0,1]
    v_pk_mul_f32 v[92:93], v[82:83], v[82:83] op_sel:[1,1] op_sel_hi:[0,1]
    v_pk_fma_f32 v[84:85], v[82:83], v[82:83], v[92:93] op_sel:[0,0,0] op_sel_hi:[0,1,1] neg_lo:[0,0,1]
    v_pk_mul_f32 v[94:95], v[66:67], v[76:77] op_sel:[1,1] op_sel_hi:[1,0]
    v_pk_fma_f32 v[86:87], v[66:67], v[76:77], v[94:95] op_sel:[0,0,0] op_sel_hi:[0,1,1] neg_lo:[0,0,1] neg_hi:[1,0,1]
    v_mov_b32_dpp v80, v78 row_ror:8 row_mask:0xf bank_mask:0x3
    v_mov_b32_dpp v81, v79 row_ror:8 row_mask:0xf bank_mask:0x3
    v_mov_b32_dpp v82, v84 row_ror:8 row_mask:0xf bank_mask:0x3
    v_mov_b32_dpp v83, v85 row_ror:8 row_mask:0xf bank_mask:0x3
    v_pk_mul_f32 v[92:93], v[66:67], v[80:81] op_sel:[1,1] op_sel_hi:[1,0]
    v_pk_fma_f32 v[88:89], v[66:67], v[80:81], v[92:93] op_sel:[0,0,0] op_sel_hi:[0,1,1] neg_lo:[0,0,1] neg_hi:[1,0,1]
    v_pk_mul_f32 v[94:95], v[66:67], v[82:83] op_sel:[1,1] op_sel_hi:[1,0]
    v_pk_fma_f32 v[90:91], v[66:67], v[82:83], v[94:95] op_sel:[0,0,0] op_sel_hi:[0,1,1] neg_lo:[0,0,1] neg_hi:[1,0,1]
    v_mfma_f32_16x16x4_f32 v[48:51], v86, v68, v[48:51]
    v_mfma_f32_16x16x4_f32 v[52:55], v88, v70, v[52:55]
    v_mfma_f32_16x16x4_f32 v[56:59], v88, v72, v[56:59]
    v_mfma_f32_16x16x4_f32 v[60:63], v90, v74, v[60:63]
    v_mfma_f32_16x16x4_f32 v[48:51], v87, v69, v[48:51]
    v_mfma_f32_16x16x4_f32 v[52:55], v89, v71, v[52:55]
    v_mfma_f32_16x16x4_f32 v[56:59], v89, v73, v[56:59]
    v_mfma_f32_16x16x4_f32 v[60:63], v91, v75, v[60:63]
    v_mov_b64_dpp v[64:65], v[28:29] row_newbcast:2 row_mask:0xf bank_mask:0xf
    v_mov_b64_dpp v[66:67], v[30:31] row_newbcast:2 row_mask:0xf bank_mask:0xf
    v_pk_mul_f32 v[94:95], v[64:65], v[26:27] op_sel_hi:[1,0]
    v_pk_mul_f32 v[96:97], v[64:65], v[26:27] op_sel:[0,1] op_sel_hi:[1,1]
    v_fract_f32 v95, v95
    v_fract_f32 v97, v97
    v_exp_f32 v94, v94
    v_exp_f32 v96, v96
    v_cos_f32 v68, v95
    v_sin_f32 v69, v95
    v_cos_f32 v76, v97
    v_sin_f32 v77, v97
    v_pk_mul_f32 v[68:69], v[68:69], v[94:95] op_sel_hi:[1,0]
    v_pk_mul_f32 v[76:77], v[76:77], v[96:97] op_sel_hi:[1,0]
    v_pk_mul_f32 v[92:93], v[76:77], v[76:77] op_sel:[1,1] op_sel_hi:[0,1]
    v_pk_fma_f32 v[78:79], v[76:77], v[76:77], v[92:93] op_sel:[0,0,0] op_sel_hi:[0,1,1] neg_lo:[0,0,1]
    v_pk_mul_f32 v[94:95], v[68:69], v[68:69] op_sel:[1,1] op_sel_hi:[0,1]
    v_pk_fma_f32 v[70:71], v[68:69], v[68:69], v[94:95] op_sel:[0,0,0] op_sel_hi:[0,1,1] neg_lo:[0,0,1]
    v_pk_mul_f32 v[92:93], v[78:79], v[78:79] op_sel:[1,1] op_sel_hi:[0,1]
    v_pk_fma_f32 v[80:81], v[78:79], v[78:79], v[92:93] op_sel:[0,0,0] op_sel_hi:[0,1,1] neg_lo:[0,0,1]
    v_pk_mul_f32 v[94:95], v[70:71], v[70:71] op_sel:[1,1] op_sel_hi:[0,1]
    v_pk_fma_f32 v[72:73], v[70:71], v[70:71], v[94:95] op_sel:[0,0,0] op_sel_hi:[0,1,1] neg_lo:[0,0,1]
    v_pk_mul_f32 v[92:93], v[80:81], v[80:81] op_sel:[1,1] op_sel_hi:[0,1]
    v_pk_fma_f32 v[82:83], v[80:81], v[80:81], v[92:93] op_sel:[0,0,0] op_sel_hi:[0,1,1] neg_lo:[0,0,1]
    v_pk_mul_f32 v[94:95], v[72:73], v[72:73] op_sel:[1,1] op_sel_hi:[0,1]
    v_pk_fma_f32 v[74:75], v[72:73], v[72:73], v[94:95] op_sel:[0,0,0] op_sel_hi:[0,1,1] neg_lo:[0,0,1]
    v_pk_mul_f32 v[92:93], v[82:83], v[82:83] op_sel:[1,1] op_sel_hi:[0,1]
    v_pk_fma_f32 v[84:85], v[82:83], v[82:83], v[92:93] op_sel:[0,0,0] op_sel_hi:[0,1,1] neg_lo:[0,0,1]
    v_pk_mul_f32 v[94:95], v[66:67], v[76:77] op_sel:[1,1] op_sel_hi:[1,0]
    v_pk_fma_f32 v[86:87], v[66:67], v[76:77], v[94:95] op_sel:[0,0,0] op_sel_hi:[0,1,1] neg_lo:[0,0,1] neg_hi:[1,0,1]
    v_mov_b32_dpp v80, v78 row_ror:8 row_mask:0xf bank_mask:0x3
    v_mov_b32_dpp v81, v79 row_ror:8 row_mask:0xf bank_mask:0x3
    v_mov_b32_dpp v82, v84 row_ror:8 row_mask:0xf bank_mask:0x3
    v_mov_b32_dpp v83, v85 row_ror:8 row_mask:0xf bank_mask:0x3
    v_pk_mul_f32 v[92:93], v[66:67], v[80:81] op_sel:[1,1] op_sel_hi:[1,0]
    v_pk_fma_f32 v[88:89], v[66:67], v[80:81], v[92:93] op_sel:[0,0,0] op_sel_hi:[0,1,1] neg_lo:[0,0,1] neg_hi:[1,0,1]
    v_pk_mul_f32 v[94:95], v[66:67], v[82:83] op_sel:[1,1] op_sel_hi:[1,0]
    v_pk_fma_f32 v[90:91], v[66:67], v[82:83], v[94:95] op_sel:[0,0,0] op_sel_hi:[0,1,1] neg_lo:[0,0,1] neg_hi:[1,0,1]
    v_mfma_f32_16x16x4_f32 v[48:51], v86, v68, v[48:51]
    v_mfma_f32_16x16x4_f32 v[52:55], v88, v70, v[52:55]
    v_mfma_f32_16x16x4_f32 v[56:59], v88, v72, v[56:59]
    v_mfma_f32_16x16x4_f32 v[60:63], v90, v74, v[60:63]
    v_mfma_f32_16x16x4_f32 v[48:51], v87, v69, v[48:51]
    v_mfma_f32_16x16x4_f32 v[52:55], v89, v71, v[52:55]
    v_mfma_f32_16x16x4_f32 v[56:59], v89, v73, v[56:59]
    v_mfma_f32_16x16x4_f32 v[60:63], v91, v75, v[60:63]
    v_mov_b64_dpp v[64:65], v[28:29] row_newbcast:3 row_mask:0xf bank_mask:0xf
    v_mov_b64_dpp v[66:67], v[30:31] row_newbcast:3 row_mask:0xf bank_mask:0xf
    v_pk_mul_f32 v[94:95], v[64:65], v[26:27] op_sel_hi:[1,0]
    v_pk_mul_f32 v[96:97], v[64:65], v[26:27] op_sel:[0,1] op_sel_hi:[1,1]
    v_fract_f32 v95, v95
    v_fract_f32 v97, v97
    v_exp_f32 v94, v94
    v_exp_f32 v96, v96
    v_cos_f32 v68, v95
    v_sin_f32 v69, v95
    v_cos_f32 v76, v97
    v_sin_f32 v77, v97
    v_pk_mul_f32 v[68:69], v[68:69], v[94:95] op_sel_hi:[1,0]
    v_pk_mul_f32 v[76:77], v[76:77], v[96:97] op_sel_hi:[1,0]
    v_pk_mul_f32 v[92:93], v[76:77], v[76:77] op_sel:[1,1] op_sel_hi:[0,1]
    v_pk_fma_f32 v[78:79], v[76:77], v[76:77], v[92:93] op_sel:[0,0,0] op_sel_hi:[0,1,1] neg_lo:[0,0,1]
    v_pk_mul_f32 v[94:95], v[68:69], v[68:69] op_sel:[1,1] op_sel_hi:[0,1]
    v_pk_fma_f32 v[70:71], v[68:69], v[68:69], v[94:95] op_sel:[0,0,0] op_sel_hi:[0,1,1] neg_lo:[0,0,1]
    v_pk_mul_f32 v[92:93], v[78:79], v[78:79] op_sel:[1,1] op_sel_hi:[0,1]
    v_pk_fma_f32 v[80:81], v[78:79], v[78:79], v[92:93] op_sel:[0,0,0] op_sel_hi:[0,1,1] neg_lo:[0,0,1]
    v_pk_mul_f32 v[94:95], v[70:71], v[70:71] op_sel:[1,1] op_sel_hi:[0,1]
    v_pk_fma_f32 v[72:73], v[70:71], v[70:71], v[94:95] op_sel:[0,0,0] op_sel_hi:[0,1,1] neg_lo:[0,0,1]
    v_pk_mul_f32 v[92:93], v[80:81], v[80:81] op_sel:[1,1] op_sel_hi:[0,1]
    v_pk_fma_f32 v[82:83], v[80:81], v[80:81], v[92:93] op_sel:[0,0,0] op_sel_hi:[0,1,1] neg_lo:[0,0,1]
    v_pk_mul_f32 v[94:95], v[72:73], v[72:73] op_sel:[1,1] op_sel_hi:[0,1]
    v_pk_fma_f32 v[74:75], v[72:73], v[72:73], v[94:95] op_sel:[0,0,0] op_sel_hi:[0,1,1] neg_lo:[0,0,1]
    v_pk_mul_f32 v[92:93], v[82:83], v[82:83] op_sel:[1,1] op_sel_hi:[0,1]
    v_pk_fma_f32 v[84:85], v[82:83], v[82:83], v[92:93] op_sel:[0,0,0] op_sel_hi:[0,1,1] neg_lo:[0,0,1]
    v_pk_mul_f32 v[94:95], v[66:67], v[76:77] op_sel:[1,1] op_sel_hi:[1,0]
    v_pk_fma_f32 v[86:87], v[66:67], v[76:77], v[94:95] op_sel:[0,0,0] op_sel_hi:[0,1,1] neg_lo:[0,0,1] neg_hi:[1,0,1]
    v_mov_b32_dpp v80, v78 row_ror:8 row_mask:0xf bank_mask:0x3
    v_mov_b32_dpp v81, v79 row_ror:8 row_mask:0xf bank_mask:0x3
    v_mov_b32_dpp v82, v84 row_ror:8 row_mask:0xf bank_mask:0x3
    v_mov_b32_dpp v83, v85 row_ror:8 row_mask:0xf bank_mask:0x3
    v_pk_mul_f32 v[92:93], v[66:67], v[80:81] op_sel:[1,1] op_sel_hi:[1,0]
    v_pk_fma_f32 v[88:89], v[66:67], v[80:81], v[92:93] op_sel:[0,0,0] op_sel_hi:[0,1,1] neg_lo:[0,0,1] neg_hi:[1,0,1]
    v_pk_mul_f32 v[94:95], v[66:67], v[82:83] op_sel:[1,1] op_sel_hi:[1,0]
    v_pk_fma_f32 v[90:91], v[66:67], v[82:83], v[94:95] op_sel:[0,0,0] op_sel_hi:[0,1,1] neg_lo:[0,0,1] neg_hi:[1,0,1]
    v_mfma_f32_16x16x4_f32 v[48:51], v86, v68, v[48:51]
    v_mfma_f32_16x16x4_f32 v[52:55], v88, v70, v[52:55]
    v_mfma_f32_16x16x4_f32 v[56:59], v88, v72, v[56:59]
    v_mfma_f32_16x16x4_f32 v[60:63], v90, v74, v[60:63]
    v_mfma_f32_16x16x4_f32 v[48:51], v87, v69, v[48:51]
    v_mfma_f32_16x16x4_f32 v[52:55], v89, v71, v[52:55]
    v_mfma_f32_16x16x4_f32 v[56:59], v89, v73, v[56:59]
    v_mfma_f32_16x16x4_f32 v[60:63], v91, v75, v[60:63]
    v_mov_b64_dpp v[64:65], v[28:29] row_newbcast:4 row_mask:0xf bank_mask:0xf
    v_mov_b64_dpp v[66:67], v[30:31] row_newbcast:4 row_mask:0xf bank_mask:0xf
    v_pk_mul_f32 v[94:95], v[64:65], v[26:27] op_sel_hi:[1,0]
    v_pk_mul_f32 v[96:97], v[64:65], v[26:27] op_sel:[0,1] op_sel_hi:[1,1]
    v_fract_f32 v95, v95
    v_fract_f32 v97, v97
    v_exp_f32 v94, v94
    v_exp_f32 v96, v96
    v_cos_f32 v68, v95
    v_sin_f32 v69, v95
    v_cos_f32 v76, v97
    v_sin_f32 v77, v97
    v_pk_mul_f32 v[68:69], v[68:69], v[94:95] op_sel_hi:[1,0]
    v_pk_mul_f32 v[76:77], v[76:77], v[96:97] op_sel_hi:[1,0]
    v_pk_mul_f32 v[92:93], v[76:77], v[76:77] op_sel:[1,1] op_sel_hi:[0,1]
    v_pk_fma_f32 v[78:79], v[76:77], v[76:77], v[92:93] op_sel:[0,0,0] op_sel_hi:[0,1,1] neg_lo:[0,0,1]
    v_pk_mul_f32 v[94:95], v[68:69], v[68:69] op_sel:[1,1] op_sel_hi:[0,1]
    v_pk_fma_f32 v[70:71], v[68:69], v[68:69], v[94:95] op_sel:[0,0,0] op_sel_hi:[0,1,1] neg_lo:[0,0,1]
    v_pk_mul_f32 v[92:93], v[78:79], v[78:79] op_sel:[1,1] op_sel_hi:[0,1]
    v_pk_fma_f32 v[80:81], v[78:79], v[78:79], v[92:93] op_sel:[0,0,0] op_sel_hi:[0,1,1] neg_lo:[0,0,1]
    v_pk_mul_f32 v[94:95], v[70:71], v[70:71] op_sel:[1,1] op_sel_hi:[0,1]
    v_pk_fma_f32 v[72:73], v[70:71], v[70:71], v[94:95] op_sel:[0,0,0] op_sel_hi:[0,1,1] neg_lo:[0,0,1]
    v_pk_mul_f32 v[92:93], v[80:81], v[80:81] op_sel:[1,1] op_sel_hi:[0,1]
    v_pk_fma_f32 v[82:83], v[80:81], v[80:81], v[92:93] op_sel:[0,0,0] op_sel_hi:[0,1,1] neg_lo:[0,0,1]
    v_pk_mul_f32 v[94:95], v[72:73], v[72:73] op_sel:[1,1] op_sel_hi:[0,1]
    v_pk_fma_f32 v[74:75], v[72:73], v[72:73], v[94:95] op_sel:[0,0,0] op_sel_hi:[0,1,1] neg_lo:[0,0,1]
    v_pk_mul_f32 v[92:93], v[82:83], v[82:83] op_sel:[1,1] op_sel_hi:[0,1]
    v_pk_fma_f32 v[84:85], v[82:83], v[82:83], v[92:93] op_sel:[0,0,0] op_sel_hi:[0,1,1] neg_lo:[0,0,1]
    v_pk_mul_f32 v[94:95], v[66:67], v[76:77] op_sel:[1,1] op_sel_hi:[1,0]
    v_pk_fma_f32 v[86:87], v[66:67], v[76:77], v[94:95] op_sel:[0,0,0] op_sel_hi:[0,1,1] neg_lo:[0,0,1] neg_hi:[1,0,1]
    v_mov_b32_dpp v80, v78 row_ror:8 row_mask:0xf bank_mask:0x3
    v_mov_b32_dpp v81, v79 row_ror:8 row_mask:0xf bank_mask:0x3
    v_mov_b32_dpp v82, v84 row_ror:8 row_mask:0xf bank_mask:0x3
    v_mov_b32_dpp v83, v85 row_ror:8 row_mask:0xf bank_mask:0x3
    v_pk_mul_f32 v[92:93], v[66:67], v[80:81] op_sel:[1,1] op_sel_hi:[1,0]
    v_pk_fma_f32 v[88:89], v[66:67], v[80:81], v[92:93] op_sel:[0,0,0] op_sel_hi:[0,1,1] neg_lo:[0,0,1] neg_hi:[1,0,1]
    v_pk_mul_f32 v[94:95], v[66:67], v[82:83] op_sel:[1,1] op_sel_hi:[1,0]
    v_pk_fma_f32 v[90:91], v[66:67], v[82:83], v[94:95] op_sel:[0,0,0] op_sel_hi:[0,1,1] neg_lo:[0,0,1] neg_hi:[1,0,1]
    v_mfma_f32_16x16x4_f32 v[48:51], v86, v68, v[48:51]
    v_mfma_f32_16x16x4_f32 v[52:55], v88, v70, v[52:55]
    v_mfma_f32_16x16x4_f32 v[56:59], v88, v72, v[56:59]
    v_mfma_f32_16x16x4_f32 v[60:63], v90, v74, v[60:63]
    v_mfma_f32_16x16x4_f32 v[48:51], v87, v69, v[48:51]
    v_mfma_f32_16x16x4_f32 v[52:55], v89, v71, v[52:55]
    v_mfma_f32_16x16x4_f32 v[56:59], v89, v73, v[56:59]
    v_mfma_f32_16x16x4_f32 v[60:63], v91, v75, v[60:63]
    v_mov_b64_dpp v[64:65], v[28:29] row_newbcast:5 row_mask:0xf bank_mask:0xf
    v_mov_b64_dpp v[66:67], v[30:31] row_newbcast:5 row_mask:0xf bank_mask:0xf
    v_pk_mul_f32 v[94:95], v[64:65], v[26:27] op_sel_hi:[1,0]
    v_pk_mul_f32 v[96:97], v[64:65], v[26:27] op_sel:[0,1] op_sel_hi:[1,1]
    v_fract_f32 v95, v95
    v_fract_f32 v97, v97
    v_exp_f32 v94, v94
    v_exp_f32 v96, v96
    v_cos_f32 v68, v95
    v_sin_f32 v69, v95
    v_cos_f32 v76, v97
    v_sin_f32 v77, v97
    v_pk_mul_f32 v[68:69], v[68:69], v[94:95] op_sel_hi:[1,0]
    v_pk_mul_f32 v[76:77], v[76:77], v[96:97] op_sel_hi:[1,0]
    v_pk_mul_f32 v[92:93], v[76:77], v[76:77] op_sel:[1,1] op_sel_hi:[0,1]
    v_pk_fma_f32 v[78:79], v[76:77], v[76:77], v[92:93] op_sel:[0,0,0] op_sel_hi:[0,1,1] neg_lo:[0,0,1]
    v_pk_mul_f32 v[94:95], v[68:69], v[68:69] op_sel:[1,1] op_sel_hi:[0,1]
    v_pk_fma_f32 v[70:71], v[68:69], v[68:69], v[94:95] op_sel:[0,0,0] op_sel_hi:[0,1,1] neg_lo:[0,0,1]
    v_pk_mul_f32 v[92:93], v[78:79], v[78:79] op_sel:[1,1] op_sel_hi:[0,1]
    v_pk_fma_f32 v[80:81], v[78:79], v[78:79], v[92:93] op_sel:[0,0,0] op_sel_hi:[0,1,1] neg_lo:[0,0,1]
    v_pk_mul_f32 v[94:95], v[70:71], v[70:71] op_sel:[1,1] op_sel_hi:[0,1]
    v_pk_fma_f32 v[72:73], v[70:71], v[70:71], v[94:95] op_sel:[0,0,0] op_sel_hi:[0,1,1] neg_lo:[0,0,1]
    v_pk_mul_f32 v[92:93], v[80:81], v[80:81] op_sel:[1,1] op_sel_hi:[0,1]
    v_pk_fma_f32 v[82:83], v[80:81], v[80:81], v[92:93] op_sel:[0,0,0] op_sel_hi:[0,1,1] neg_lo:[0,0,1]
    v_pk_mul_f32 v[94:95], v[72:73], v[72:73] op_sel:[1,1] op_sel_hi:[0,1]
    v_pk_fma_f32 v[74:75], v[72:73], v[72:73], v[94:95] op_sel:[0,0,0] op_sel_hi:[0,1,1] neg_lo:[0,0,1]
    v_pk_mul_f32 v[92:93], v[82:83], v[82:83] op_sel:[1,1] op_sel_hi:[0,1]
    v_pk_fma_f32 v[84:85], v[82:83], v[82:83], v[92:93] op_sel:[0,0,0] op_sel_hi:[0,1,1] neg_lo:[0,0,1]
    v_pk_mul_f32 v[94:95], v[66:67], v[76:77] op_sel:[1,1] op_sel_hi:[1,0]
    v_pk_fma_f32 v[86:87], v[66:67], v[76:77], v[94:95] op_sel:[0,0,0] op_sel_hi:[0,1,1] neg_lo:[0,0,1] neg_hi:[1,0,1]
    v_mov_b32_dpp v80, v78 row_ror:8 row_mask:0xf bank_mask:0x3
    v_mov_b32_dpp v81, v79 row_ror:8 row_mask:0xf bank_mask:0x3
    v_mov_b32_dpp v82, v84 row_ror:8 row_mask:0xf bank_mask:0x3
    v_mov_b32_dpp v83, v85 row_ror:8 row_mask:0xf bank_mask:0x3
    v_pk_mul_f32 v[92:93], v[66:67], v[80:81] op_sel:[1,1] op_sel_hi:[1,0]
    v_pk_fma_f32 v[88:89], v[66:67], v[80:81], v[92:93] op_sel:[0,0,0] op_sel_hi:[0,1,1] neg_lo:[0,0,1] neg_hi:[1,0,1]
    v_pk_mul_f32 v[94:95], v[66:67], v[82:83] op_sel:[1,1] op_sel_hi:[1,0]
    v_pk_fma_f32 v[90:91], v[66:67], v[82:83], v[94:95] op_sel:[0,0,0] op_sel_hi:[0,1,1] neg_lo:[0,0,1] neg_hi:[1,0,1]
    v_mfma_f32_16x16x4_f32 v[48:51], v86, v68, v[48:51]
    v_mfma_f32_16x16x4_f32 v[52:55], v88, v70, v[52:55]
    v_mfma_f32_16x16x4_f32 v[56:59], v88, v72, v[56:59]
    v_mfma_f32_16x16x4_f32 v[60:63], v90, v74, v[60:63]
    v_mfma_f32_16x16x4_f32 v[48:51], v87, v69, v[48:51]
    v_mfma_f32_16x16x4_f32 v[52:55], v89, v71, v[52:55]
    v_mfma_f32_16x16x4_f32 v[56:59], v89, v73, v[56:59]
    v_mfma_f32_16x16x4_f32 v[60:63], v91, v75, v[60:63]
    v_mov_b64_dpp v[64:65], v[28:29] row_newbcast:6 row_mask:0xf bank_mask:0xf
    v_mov_b64_dpp v[66:67], v[30:31] row_newbcast:6 row_mask:0xf bank_mask:0xf
    v_pk_mul_f32 v[94:95], v[64:65], v[26:27] op_sel_hi:[1,0]
    v_pk_mul_f32 v[96:97], v[64:65], v[26:27] op_sel:[0,1] op_sel_hi:[1,1]
    v_fract_f32 v95, v95
    v_fract_f32 v97, v97
    v_exp_f32 v94, v94
    v_exp_f32 v96, v96
    v_cos_f32 v68, v95
    v_sin_f32 v69, v95
    v_cos_f32 v76, v97
    v_sin_f32 v77, v97
    v_pk_mul_f32 v[68:69], v[68:69], v[94:95] op_sel_hi:[1,0]
    v_pk_mul_f32 v[76:77], v[76:77], v[96:97] op_sel_hi:[1,0]
    v_pk_mul_f32 v[92:93], v[76:77], v[76:77] op_sel:[1,1] op_sel_hi:[0,1]
    v_pk_fma_f32 v[78:79], v[76:77], v[76:77], v[92:93] op_sel:[0,0,0] op_sel_hi:[0,1,1] neg_lo:[0,0,1]
    v_pk_mul_f32 v[94:95], v[68:69], v[68:69] op_sel:[1,1] op_sel_hi:[0,1]
    v_pk_fma_f32 v[70:71], v[68:69], v[68:69], v[94:95] op_sel:[0,0,0] op_sel_hi:[0,1,1] neg_lo:[0,0,1]
    v_pk_mul_f32 v[92:93], v[78:79], v[78:79] op_sel:[1,1] op_sel_hi:[0,1]
    v_pk_fma_f32 v[80:81], v[78:79], v[78:79], v[92:93] op_sel:[0,0,0] op_sel_hi:[0,1,1] neg_lo:[0,0,1]
    v_pk_mul_f32 v[94:95], v[70:71], v[70:71] op_sel:[1,1] op_sel_hi:[0,1]
    v_pk_fma_f32 v[72:73], v[70:71], v[70:71], v[94:95] op_sel:[0,0,0] op_sel_hi:[0,1,1] neg_lo:[0,0,1]
    v_pk_mul_f32 v[92:93], v[80:81], v[80:81] op_sel:[1,1] op_sel_hi:[0,1]
    v_pk_fma_f32 v[82:83], v[80:81], v[80:81], v[92:93] op_sel:[0,0,0] op_sel_hi:[0,1,1] neg_lo:[0,0,1]
    v_pk_mul_f32 v[94:95], v[72:73], v[72:73] op_sel:[1,1] op_sel_hi:[0,1]
    v_pk_fma_f32 v[74:75], v[72:73], v[72:73], v[94:95] op_sel:[0,0,0] op_sel_hi:[0,1,1] neg_lo:[0,0,1]
    v_pk_mul_f32 v[92:93], v[82:83], v[82:83] op_sel:[1,1] op_sel_hi:[0,1]
    v_pk_fma_f32 v[84:85], v[82:83], v[82:83], v[92:93] op_sel:[0,0,0] op_sel_hi:[0,1,1] neg_lo:[0,0,1]
    v_pk_mul_f32 v[94:95], v[66:67], v[76:77] op_sel:[1,1] op_sel_hi:[1,0]
    v_pk_fma_f32 v[86:87], v[66:67], v[76:77], v[94:95] op_sel:[0,0,0] op_sel_hi:[0,1,1] neg_lo:[0,0,1] neg_hi:[1,0,1]
    v_mov_b32_dpp v80, v78 row_ror:8 row_mask:0xf bank_mask:0x3
    v_mov_b32_dpp v81, v79 row_ror:8 row_mask:0xf bank_mask:0x3
    v_mov_b32_dpp v82, v84 row_ror:8 row_mask:0xf bank_mask:0x3
    v_mov_b32_dpp v83, v85 row_ror:8 row_mask:0xf bank_mask:0x3
    v_pk_mul_f32 v[92:93], v[66:67], v[80:81] op_sel:[1,1] op_sel_hi:[1,0]
    v_pk_fma_f32 v[88:89], v[66:67], v[80:81], v[92:93] op_sel:[0,0,0] op_sel_hi:[0,1,1] neg_lo:[0,0,1] neg_hi:[1,0,1]
    v_pk_mul_f32 v[94:95], v[66:67], v[82:83] op_sel:[1,1] op_sel_hi:[1,0]
    v_pk_fma_f32 v[90:91], v[66:67], v[82:83], v[94:95] op_sel:[0,0,0] op_sel_hi:[0,1,1] neg_lo:[0,0,1] neg_hi:[1,0,1]
    v_mfma_f32_16x16x4_f32 v[48:51], v86, v68, v[48:51]
    v_mfma_f32_16x16x4_f32 v[52:55], v88, v70, v[52:55]
    v_mfma_f32_16x16x4_f32 v[56:59], v88, v72, v[56:59]
    v_mfma_f32_16x16x4_f32 v[60:63], v90, v74, v[60:63]
    v_mfma_f32_16x16x4_f32 v[48:51], v87, v69, v[48:51]
    v_mfma_f32_16x16x4_f32 v[52:55], v89, v71, v[52:55]
    v_mfma_f32_16x16x4_f32 v[56:59], v89, v73, v[56:59]
    v_mfma_f32_16x16x4_f32 v[60:63], v91, v75, v[60:63]
    v_mov_b64_dpp v[64:65], v[28:29] row_newbcast:7 row_mask:0xf bank_mask:0xf
    v_mov_b64_dpp v[66:67], v[30:31] row_newbcast:7 row_mask:0xf bank_mask:0xf
    v_pk_mul_f32 v[94:95], v[64:65], v[26:27] op_sel_hi:[1,0]
    v_pk_mul_f32 v[96:97], v[64:65], v[26:27] op_sel:[0,1] op_sel_hi:[1,1]
    v_fract_f32 v95, v95
    v_fract_f32 v97, v97
    v_exp_f32 v94, v94
    v_exp_f32 v96, v96
    v_cos_f32 v68, v95
    v_sin_f32 v69, v95
    v_cos_f32 v76, v97
    v_sin_f32 v77, v97
    v_pk_mul_f32 v[68:69], v[68:69], v[94:95] op_sel_hi:[1,0]
    v_pk_mul_f32 v[76:77], v[76:77], v[96:97] op_sel_hi:[1,0]
    v_pk_mul_f32 v[92:93], v[76:77], v[76:77] op_sel:[1,1] op_sel_hi:[0,1]
    v_pk_fma_f32 v[78:79], v[76:77], v[76:77], v[92:93] op_sel:[0,0,0] op_sel_hi:[0,1,1] neg_lo:[0,0,1]
    v_pk_mul_f32 v[94:95], v[68:69], v[68:69] op_sel:[1,1] op_sel_hi:[0,1]
    v_pk_fma_f32 v[70:71], v[68:69], v[68:69], v[94:95] op_sel:[0,0,0] op_sel_hi:[0,1,1] neg_lo:[0,0,1]
    v_pk_mul_f32 v[92:93], v[78:79], v[78:79] op_sel:[1,1] op_sel_hi:[0,1]
    v_pk_fma_f32 v[80:81], v[78:79], v[78:79], v[92:93] op_sel:[0,0,0] op_sel_hi:[0,1,1] neg_lo:[0,0,1]
    v_pk_mul_f32 v[94:95], v[70:71], v[70:71] op_sel:[1,1] op_sel_hi:[0,1]
    v_pk_fma_f32 v[72:73], v[70:71], v[70:71], v[94:95] op_sel:[0,0,0] op_sel_hi:[0,1,1] neg_lo:[0,0,1]
    v_pk_mul_f32 v[92:93], v[80:81], v[80:81] op_sel:[1,1] op_sel_hi:[0,1]
    v_pk_fma_f32 v[82:83], v[80:81], v[80:81], v[92:93] op_sel:[0,0,0] op_sel_hi:[0,1,1] neg_lo:[0,0,1]
    v_pk_mul_f32 v[94:95], v[72:73], v[72:73] op_sel:[1,1] op_sel_hi:[0,1]
    v_pk_fma_f32 v[74:75], v[72:73], v[72:73], v[94:95] op_sel:[0,0,0] op_sel_hi:[0,1,1] neg_lo:[0,0,1]
    v_pk_mul_f32 v[92:93], v[82:83], v[82:83] op_sel:[1,1] op_sel_hi:[0,1]
    v_pk_fma_f32 v[84:85], v[82:83], v[82:83], v[92:93] op_sel:[0,0,0] op_sel_hi:[0,1,1] neg_lo:[0,0,1]
    v_pk_mul_f32 v[94:95], v[66:67], v[76:77] op_sel:[1,1] op_sel_hi:[1,0]
    v_pk_fma_f32 v[86:87], v[66:67], v[76:77], v[94:95] op_sel:[0,0,0] op_sel_hi:[0,1,1] neg_lo:[0,0,1] neg_hi:[1,0,1]
    v_mov_b32_dpp v80, v78 row_ror:8 row_mask:0xf bank_mask:0x3
    v_mov_b32_dpp v81, v79 row_ror:8 row_mask:0xf bank_mask:0x3
    v_mov_b32_dpp v82, v84 row_ror:8 row_mask:0xf bank_mask:0x3
    v_mov_b32_dpp v83, v85 row_ror:8 row_mask:0xf bank_mask:0x3
    v_pk_mul_f32 v[92:93], v[66:67], v[80:81] op_sel:[1,1] op_sel_hi:[1,0]
    v_pk_fma_f32 v[88:89], v[66:67], v[80:81], v[92:93] op_sel:[0,0,0] op_sel_hi:[0,1,1] neg_lo:[0,0,1] neg_hi:[1,0,1]
    v_pk_mul_f32 v[94:95], v[66:67], v[82:83] op_sel:[1,1] op_sel_hi:[1,0]
    v_pk_fma_f32 v[90:91], v[66:67], v[82:83], v[94:95] op_sel:[0,0,0] op_sel_hi:[0,1,1] neg_lo:[0,0,1] neg_hi:[1,0,1]
    v_mfma_f32_16x16x4_f32 v[48:51], v86, v68, v[48:51]
    v_mfma_f32_16x16x4_f32 v[52:55], v88, v70, v[52:55]
    v_mfma_f32_16x16x4_f32 v[56:59], v88, v72, v[56:59]
    v_mfma_f32_16x16x4_f32 v[60:63], v90, v74, v[60:63]
    v_mfma_f32_16x16x4_f32 v[48:51], v87, v69, v[48:51]
    v_mfma_f32_16x16x4_f32 v[52:55], v89, v71, v[52:55]
    v_mfma_f32_16x16x4_f32 v[56:59], v89, v73, v[56:59]
    v_mfma_f32_16x16x4_f32 v[60:63], v91, v75, v[60:63]
    v_mov_b64_dpp v[64:65], v[28:29] row_newbcast:8 row_mask:0xf bank_mask:0xf
    v_mov_b64_dpp v[66:67], v[30:31] row_newbcast:8 row_mask:0xf bank_mask:0xf
    v_pk_mul_f32 v[94:95], v[64:65], v[26:27] op_sel_hi:[1,0]
    v_pk_mul_f32 v[96:97], v[64:65], v[26:27] op_sel:[0,1] op_sel_hi:[1,1]
    v_fract_f32 v95, v95
    v_fract_f32 v97, v97
    v_exp_f32 v94, v94
    v_exp_f32 v96, v96
    v_cos_f32 v68, v95
    v_sin_f32 v69, v95
    v_cos_f32 v76, v97
    v_sin_f32 v77, v97
    v_pk_mul_f32 v[68:69], v[68:69], v[94:95] op_sel_hi:[1,0]
    v_pk_mul_f32 v[76:77], v[76:77], v[96:97] op_sel_hi:[1,0]
    v_pk_mul_f32 v[92:93], v[76:77], v[76:77] op_sel:[1,1] op_sel_hi:[0,1]
    v_pk_fma_f32 v[78:79], v[76:77], v[76:77], v[92:93] op_sel:[0,0,0] op_sel_hi:[0,1,1] neg_lo:[0,0,1]
    v_pk_mul_f32 v[94:95], v[68:69], v[68:69] op_sel:[1,1] op_sel_hi:[0,1]
    v_pk_fma_f32 v[70:71], v[68:69], v[68:69], v[94:95] op_sel:[0,0,0] op_sel_hi:[0,1,1] neg_lo:[0,0,1]
    v_pk_mul_f32 v[92:93], v[78:79], v[78:79] op_sel:[1,1] op_sel_hi:[0,1]
    v_pk_fma_f32 v[80:81], v[78:79], v[78:79], v[92:93] op_sel:[0,0,0] op_sel_hi:[0,1,1] neg_lo:[0,0,1]
    v_pk_mul_f32 v[94:95], v[70:71], v[70:71] op_sel:[1,1] op_sel_hi:[0,1]
    v_pk_fma_f32 v[72:73], v[70:71], v[70:71], v[94:95] op_sel:[0,0,0] op_sel_hi:[0,1,1] neg_lo:[0,0,1]
    v_pk_mul_f32 v[92:93], v[80:81], v[80:81] op_sel:[1,1] op_sel_hi:[0,1]
    v_pk_fma_f32 v[82:83], v[80:81], v[80:81], v[92:93] op_sel:[0,0,0] op_sel_hi:[0,1,1] neg_lo:[0,0,1]
    v_pk_mul_f32 v[94:95], v[72:73], v[72:73] op_sel:[1,1] op_sel_hi:[0,1]
    v_pk_fma_f32 v[74:75], v[72:73], v[72:73], v[94:95] op_sel:[0,0,0] op_sel_hi:[0,1,1] neg_lo:[0,0,1]
    v_pk_mul_f32 v[92:93], v[82:83], v[82:83] op_sel:[1,1] op_sel_hi:[0,1]
    v_pk_fma_f32 v[84:85], v[82:83], v[82:83], v[92:93] op_sel:[0,0,0] op_sel_hi:[0,1,1] neg_lo:[0,0,1]
    v_pk_mul_f32 v[94:95], v[66:67], v[76:77] op_sel:[1,1] op_sel_hi:[1,0]
    v_pk_fma_f32 v[86:87], v[66:67], v[76:77], v[94:95] op_sel:[0,0,0] op_sel_hi:[0,1,1] neg_lo:[0,0,1] neg_hi:[1,0,1]
    v_mov_b32_dpp v80, v78 row_ror:8 row_mask:0xf bank_mask:0x3
    v_mov_b32_dpp v81, v79 row_ror:8 row_mask:0xf bank_mask:0x3
    v_mov_b32_dpp v82, v84 row_ror:8 row_mask:0xf bank_mask:0x3
    v_mov_b32_dpp v83, v85 row_ror:8 row_mask:0xf bank_mask:0x3
    v_pk_mul_f32 v[92:93], v[66:67], v[80:81] op_sel:[1,1] op_sel_hi:[1,0]
    v_pk_fma_f32 v[88:89], v[66:67], v[80:81], v[92:93] op_sel:[0,0,0] op_sel_hi:[0,1,1] neg_lo:[0,0,1] neg_hi:[1,0,1]
    v_pk_mul_f32 v[94:95], v[66:67], v[82:83] op_sel:[1,1] op_sel_hi:[1,0]
    v_pk_fma_f32 v[90:91], v[66:67], v[82:83], v[94:95] op_sel:[0,0,0] op_sel_hi:[0,1,1] neg_lo:[0,0,1] neg_hi:[1,0,1]
    v_mfma_f32_16x16x4_f32 v[48:51], v86, v68, v[48:51]
    v_mfma_f32_16x16x4_f32 v[52:55], v88, v70, v[52:55]
    v_mfma_f32_16x16x4_f32 v[56:59], v88, v72, v[56:59]
    v_mfma_f32_16x16x4_f32 v[60:63], v90, v74, v[60:63]
    v_mfma_f32_16x16x4_f32 v[48:51], v87, v69, v[48:51]
    v_mfma_f32_16x16x4_f32 v[52:55], v89, v71, v[52:55]
    v_mfma_f32_16x16x4_f32 v[56:59], v89, v73, v[56:59]
    v_mfma_f32_16x16x4_f32 v[60:63], v91, v75, v[60:63]
    v_mov_b64_dpp v[64:65], v[28:29] row_newbcast:9 row_mask:0xf bank_mask:0xf
    v_mov_b64_dpp v[66:67], v[30:31] row_newbcast:9 row_mask:0xf bank_mask:0xf
    v_pk_mul_f32 v[94:95], v[64:65], v[26:27] op_sel_hi:[1,0]
    v_pk_mul_f32 v[96:97], v[64:65], v[26:27] op_sel:[0,1] op_sel_hi:[1,1]
    v_fract_f32 v95, v95
    v_fract_f32 v97, v97
    v_exp_f32 v94, v94
    v_exp_f32 v96, v96
    v_cos_f32 v68, v95
    v_sin_f32 v69, v95
    v_cos_f32 v76, v97
    v_sin_f32 v77, v97
    v_pk_mul_f32 v[68:69], v[68:69], v[94:95] op_sel_hi:[1,0]
    v_pk_mul_f32 v[76:77], v[76:77], v[96:97] op_sel_hi:[1,0]
    v_pk_mul_f32 v[92:93], v[76:77], v[76:77] op_sel:[1,1] op_sel_hi:[0,1]
    v_pk_fma_f32 v[78:79], v[76:77], v[76:77], v[92:93] op_sel:[0,0,0] op_sel_hi:[0,1,1] neg_lo:[0,0,1]
    v_pk_mul_f32 v[94:95], v[68:69], v[68:69] op_sel:[1,1] op_sel_hi:[0,1]
    v_pk_fma_f32 v[70:71], v[68:69], v[68:69], v[94:95] op_sel:[0,0,0] op_sel_hi:[0,1,1] neg_lo:[0,0,1]
    v_pk_mul_f32 v[92:93], v[78:79], v[78:79] op_sel:[1,1] op_sel_hi:[0,1]
    v_pk_fma_f32 v[80:81], v[78:79], v[78:79], v[92:93] op_sel:[0,0,0] op_sel_hi:[0,1,1] neg_lo:[0,0,1]
    v_pk_mul_f32 v[94:95], v[70:71], v[70:71] op_sel:[1,1] op_sel_hi:[0,1]
    v_pk_fma_f32 v[72:73], v[70:71], v[70:71], v[94:95] op_sel:[0,0,0] op_sel_hi:[0,1,1] neg_lo:[0,0,1]
    v_pk_mul_f32 v[92:93], v[80:81], v[80:81] op_sel:[1,1] op_sel_hi:[0,1]
    v_pk_fma_f32 v[82:83], v[80:81], v[80:81], v[92:93] op_sel:[0,0,0] op_sel_hi:[0,1,1] neg_lo:[0,0,1]
    v_pk_mul_f32 v[94:95], v[72:73], v[72:73] op_sel:[1,1] op_sel_hi:[0,1]
    v_pk_fma_f32 v[74:75], v[72:73], v[72:73], v[94:95] op_sel:[0,0,0] op_sel_hi:[0,1,1] neg_lo:[0,0,1]
    v_pk_mul_f32 v[92:93], v[82:83], v[82:83] op_sel:[1,1] op_sel_hi:[0,1]
    v_pk_fma_f32 v[84:85], v[82:83], v[82:83], v[92:93] op_sel:[0,0,0] op_sel_hi:[0,1,1] neg_lo:[0,0,1]
    v_pk_mul_f32 v[94:95], v[66:67], v[76:77] op_sel:[1,1] op_sel_hi:[1,0]
    v_pk_fma_f32 v[86:87], v[66:67], v[76:77], v[94:95] op_sel:[0,0,0] op_sel_hi:[0,1,1] neg_lo:[0,0,1] neg_hi:[1,0,1]
    v_mov_b32_dpp v80, v78 row_ror:8 row_mask:0xf bank_mask:0x3
    v_mov_b32_dpp v81, v79 row_ror:8 row_mask:0xf bank_mask:0x3
    v_mov_b32_dpp v82, v84 row_ror:8 row_mask:0xf bank_mask:0x3
    v_mov_b32_dpp v83, v85 row_ror:8 row_mask:0xf bank_mask:0x3
    v_pk_mul_f32 v[92:93], v[66:67], v[80:81] op_sel:[1,1] op_sel_hi:[1,0]
    v_pk_fma_f32 v[88:89], v[66:67], v[80:81], v[92:93] op_sel:[0,0,0] op_sel_hi:[0,1,1] neg_lo:[0,0,1] neg_hi:[1,0,1]
    v_pk_mul_f32 v[94:95], v[66:67], v[82:83] op_sel:[1,1] op_sel_hi:[1,0]
    v_pk_fma_f32 v[90:91], v[66:67], v[82:83], v[94:95] op_sel:[0,0,0] op_sel_hi:[0,1,1] neg_lo:[0,0,1] neg_hi:[1,0,1]
    v_mfma_f32_16x16x4_f32 v[48:51], v86, v68, v[48:51]
    v_mfma_f32_16x16x4_f32 v[52:55], v88, v70, v[52:55]
    v_mfma_f32_16x16x4_f32 v[56:59], v88, v72, v[56:59]
    v_mfma_f32_16x16x4_f32 v[60:63], v90, v74, v[60:63]
    v_mfma_f32_16x16x4_f32 v[48:51], v87, v69, v[48:51]
    v_mfma_f32_16x16x4_f32 v[52:55], v89, v71, v[52:55]
    v_mfma_f32_16x16x4_f32 v[56:59], v89, v73, v[56:59]
    v_mfma_f32_16x16x4_f32 v[60:63], v91, v75, v[60:63]
    v_mov_b64_dpp v[64:65], v[28:29] row_newbcast:10 row_mask:0xf bank_mask:0xf
    v_mov_b64_dpp v[66:67], v[30:31] row_newbcast:10 row_mask:0xf bank_mask:0xf
    v_pk_mul_f32 v[94:95], v[64:65], v[26:27] op_sel_hi:[1,0]
    v_pk_mul_f32 v[96:97], v[64:65], v[26:27] op_sel:[0,1] op_sel_hi:[1,1]
    v_fract_f32 v95, v95
    v_fract_f32 v97, v97
    v_exp_f32 v94, v94
    v_exp_f32 v96, v96
    v_cos_f32 v68, v95
    v_sin_f32 v69, v95
    v_cos_f32 v76, v97
    v_sin_f32 v77, v97
    v_pk_mul_f32 v[68:69], v[68:69], v[94:95] op_sel_hi:[1,0]
    v_pk_mul_f32 v[76:77], v[76:77], v[96:97] op_sel_hi:[1,0]
    v_pk_mul_f32 v[92:93], v[76:77], v[76:77] op_sel:[1,1] op_sel_hi:[0,1]
    v_pk_fma_f32 v[78:79], v[76:77], v[76:77], v[92:93] op_sel:[0,0,0] op_sel_hi:[0,1,1] neg_lo:[0,0,1]
    v_pk_mul_f32 v[94:95], v[68:69], v[68:69] op_sel:[1,1] op_sel_hi:[0,1]
    v_pk_fma_f32 v[70:71], v[68:69], v[68:69], v[94:95] op_sel:[0,0,0] op_sel_hi:[0,1,1] neg_lo:[0,0,1]
    v_pk_mul_f32 v[92:93], v[78:79], v[78:79] op_sel:[1,1] op_sel_hi:[0,1]
    v_pk_fma_f32 v[80:81], v[78:79], v[78:79], v[92:93] op_sel:[0,0,0] op_sel_hi:[0,1,1] neg_lo:[0,0,1]
    v_pk_mul_f32 v[94:95], v[70:71], v[70:71] op_sel:[1,1] op_sel_hi:[0,1]
    v_pk_fma_f32 v[72:73], v[70:71], v[70:71], v[94:95] op_sel:[0,0,0] op_sel_hi:[0,1,1] neg_lo:[0,0,1]
    v_pk_mul_f32 v[92:93], v[80:81], v[80:81] op_sel:[1,1] op_sel_hi:[0,1]
    v_pk_fma_f32 v[82:83], v[80:81], v[80:81], v[92:93] op_sel:[0,0,0] op_sel_hi:[0,1,1] neg_lo:[0,0,1]
    v_pk_mul_f32 v[94:95], v[72:73], v[72:73] op_sel:[1,1] op_sel_hi:[0,1]
    v_pk_fma_f32 v[74:75], v[72:73], v[72:73], v[94:95] op_sel:[0,0,0] op_sel_hi:[0,1,1] neg_lo:[0,0,1]
    v_pk_mul_f32 v[92:93], v[82:83], v[82:83] op_sel:[1,1] op_sel_hi:[0,1]
    v_pk_fma_f32 v[84:85], v[82:83], v[82:83], v[92:93] op_sel:[0,0,0] op_sel_hi:[0,1,1] neg_lo:[0,0,1]
    v_pk_mul_f32 v[94:95], v[66:67], v[76:77] op_sel:[1,1] op_sel_hi:[1,0]
    v_pk_fma_f32 v[86:87], v[66:67], v[76:77], v[94:95] op_sel:[0,0,0] op_sel_hi:[0,1,1] neg_lo:[0,0,1] neg_hi:[1,0,1]
    v_mov_b32_dpp v80, v78 row_ror:8 row_mask:0xf bank_mask:0x3
    v_mov_b32_dpp v81, v79 row_ror:8 row_mask:0xf bank_mask:0x3
    v_mov_b32_dpp v82, v84 row_ror:8 row_mask:0xf bank_mask:0x3
    v_mov_b32_dpp v83, v85 row_ror:8 row_mask:0xf bank_mask:0x3
    v_pk_mul_f32 v[92:93], v[66:67], v[80:81] op_sel:[1,1] op_sel_hi:[1,0]
    v_pk_fma_f32 v[88:89], v[66:67], v[80:81], v[92:93] op_sel:[0,0,0] op_sel_hi:[0,1,1] neg_lo:[0,0,1] neg_hi:[1,0,1]
    v_pk_mul_f32 v[94:95], v[66:67], v[82:83] op_sel:[1,1] op_sel_hi:[1,0]
    v_pk_fma_f32 v[90:91], v[66:67], v[82:83], v[94:95] op_sel:[0,0,0] op_sel_hi:[0,1,1] neg_lo:[0,0,1] neg_hi:[1,0,1]
    v_mfma_f32_16x16x4_f32 v[48:51], v86, v68, v[48:51]
    v_mfma_f32_16x16x4_f32 v[52:55], v88, v70, v[52:55]
    v_mfma_f32_16x16x4_f32 v[56:59], v88, v72, v[56:59]
    v_mfma_f32_16x16x4_f32 v[60:63], v90, v74, v[60:63]
    v_mfma_f32_16x16x4_f32 v[48:51], v87, v69, v[48:51]
    v_mfma_f32_16x16x4_f32 v[52:55], v89, v71, v[52:55]
    v_mfma_f32_16x16x4_f32 v[56:59], v89, v73, v[56:59]
    v_mfma_f32_16x16x4_f32 v[60:63], v91, v75, v[60:63]
    v_mov_b64_dpp v[64:65], v[28:29] row_newbcast:11 row_mask:0xf bank_mask:0xf
    v_mov_b64_dpp v[66:67], v[30:31] row_newbcast:11 row_mask:0xf bank_mask:0xf
    v_pk_mul_f32 v[94:95], v[64:65], v[26:27] op_sel_hi:[1,0]
    v_pk_mul_f32 v[96:97], v[64:65], v[26:27] op_sel:[0,1] op_sel_hi:[1,1]
    v_fract_f32 v95, v95
    v_fract_f32 v97, v97
    v_exp_f32 v94, v94
    v_exp_f32 v96, v96
    v_cos_f32 v68, v95
    v_sin_f32 v69, v95
    v_cos_f32 v76, v97
    v_sin_f32 v77, v97
    v_pk_mul_f32 v[68:69], v[68:69], v[94:95] op_sel_hi:[1,0]
    v_pk_mul_f32 v[76:77], v[76:77], v[96:97] op_sel_hi:[1,0]
    v_pk_mul_f32 v[92:93], v[76:77], v[76:77] op_sel:[1,1] op_sel_hi:[0,1]
    v_pk_fma_f32 v[78:79], v[76:77], v[76:77], v[92:93] op_sel:[0,0,0] op_sel_hi:[0,1,1] neg_lo:[0,0,1]
    v_pk_mul_f32 v[94:95], v[68:69], v[68:69] op_sel:[1,1] op_sel_hi:[0,1]
    v_pk_fma_f32 v[70:71], v[68:69], v[68:69], v[94:95] op_sel:[0,0,0] op_sel_hi:[0,1,1] neg_lo:[0,0,1]
    v_pk_mul_f32 v[92:93], v[78:79], v[78:79] op_sel:[1,1] op_sel_hi:[0,1]
    v_pk_fma_f32 v[80:81], v[78:79], v[78:79], v[92:93] op_sel:[0,0,0] op_sel_hi:[0,1,1] neg_lo:[0,0,1]
    v_pk_mul_f32 v[94:95], v[70:71], v[70:71] op_sel:[1,1] op_sel_hi:[0,1]
    v_pk_fma_f32 v[72:73], v[70:71], v[70:71], v[94:95] op_sel:[0,0,0] op_sel_hi:[0,1,1] neg_lo:[0,0,1]
    v_pk_mul_f32 v[92:93], v[80:81], v[80:81] op_sel:[1,1] op_sel_hi:[0,1]
    v_pk_fma_f32 v[82:83], v[80:81], v[80:81], v[92:93] op_sel:[0,0,0] op_sel_hi:[0,1,1] neg_lo:[0,0,1]
    v_pk_mul_f32 v[94:95], v[72:73], v[72:73] op_sel:[1,1] op_sel_hi:[0,1]
    v_pk_fma_f32 v[74:75], v[72:73], v[72:73], v[94:95] op_sel:[0,0,0] op_sel_hi:[0,1,1] neg_lo:[0,0,1]
    v_pk_mul_f32 v[92:93], v[82:83], v[82:83] op_sel:[1,1] op_sel_hi:[0,1]
    v_pk_fma_f32 v[84:85], v[82:83], v[82:83], v[92:93] op_sel:[0,0,0] op_sel_hi:[0,1,1] neg_lo:[0,0,1]
    v_pk_mul_f32 v[94:95], v[66:67], v[76:77] op_sel:[1,1] op_sel_hi:[1,0]
    v_pk_fma_f32 v[86:87], v[66:67], v[76:77], v[94:95] op_sel:[0,0,0] op_sel_hi:[0,1,1] neg_lo:[0,0,1] neg_hi:[1,0,1]
    v_mov_b32_dpp v80, v78 row_ror:8 row_mask:0xf bank_mask:0x3
    v_mov_b32_dpp v81, v79 row_ror:8 row_mask:0xf bank_mask:0x3
    v_mov_b32_dpp v82, v84 row_ror:8 row_mask:0xf bank_mask:0x3
    v_mov_b32_dpp v83, v85 row_ror:8 row_mask:0xf bank_mask:0x3
    v_pk_mul_f32 v[92:93], v[66:67], v[80:81] op_sel:[1,1] op_sel_hi:[1,0]
    v_pk_fma_f32 v[88:89], v[66:67], v[80:81], v[92:93] op_sel:[0,0,0] op_sel_hi:[0,1,1] neg_lo:[0,0,1] neg_hi:[1,0,1]
    v_pk_mul_f32 v[94:95], v[66:67], v[82:83] op_sel:[1,1] op_sel_hi:[1,0]
    v_pk_fma_f32 v[90:91], v[66:67], v[82:83], v[94:95] op_sel:[0,0,0] op_sel_hi:[0,1,1] neg_lo:[0,0,1] neg_hi:[1,0,1]
    v_mfma_f32_16x16x4_f32 v[48:51], v86, v68, v[48:51]
    v_mfma_f32_16x16x4_f32 v[52:55], v88, v70, v[52:55]
    v_mfma_f32_16x16x4_f32 v[56:59], v88, v72, v[56:59]
    v_mfma_f32_16x16x4_f32 v[60:63], v90, v74, v[60:63]
    v_mfma_f32_16x16x4_f32 v[48:51], v87, v69, v[48:51]
    v_mfma_f32_16x16x4_f32 v[52:55], v89, v71, v[52:55]
    v_mfma_f32_16x16x4_f32 v[56:59], v89, v73, v[56:59]
    v_mfma_f32_16x16x4_f32 v[60:63], v91, v75, v[60:63]
    v_mov_b64_dpp v[64:65], v[28:29] row_newbcast:12 row_mask:0xf bank_mask:0xf
    v_mov_b64_dpp v[66:67], v[30:31] row_newbcast:12 row_mask:0xf bank_mask:0xf
    v_pk_mul_f32 v[94:95], v[64:65], v[26:27] op_sel_hi:[1,0]
    v_pk_mul_f32 v[96:97], v[64:65], v[26:27] op_sel:[0,1] op_sel_hi:[1,1]
    v_fract_f32 v95, v95
    v_fract_f32 v97, v97
    v_exp_f32 v94, v94
    v_exp_f32 v96, v96
    v_cos_f32 v68, v95
    v_sin_f32 v69, v95
    v_cos_f32 v76, v97
    v_sin_f32 v77, v97
    v_pk_mul_f32 v[68:69], v[68:69], v[94:95] op_sel_hi:[1,0]
    v_pk_mul_f32 v[76:77], v[76:77], v[96:97] op_sel_hi:[1,0]
    v_pk_mul_f32 v[92:93], v[76:77], v[76:77] op_sel:[1,1] op_sel_hi:[0,1]
    v_pk_fma_f32 v[78:79], v[76:77], v[76:77], v[92:93] op_sel:[0,0,0] op_sel_hi:[0,1,1] neg_lo:[0,0,1]
    v_pk_mul_f32 v[94:95], v[68:69], v[68:69] op_sel:[1,1] op_sel_hi:[0,1]
    v_pk_fma_f32 v[70:71], v[68:69], v[68:69], v[94:95] op_sel:[0,0,0] op_sel_hi:[0,1,1] neg_lo:[0,0,1]
    v_pk_mul_f32 v[92:93], v[78:79], v[78:79] op_sel:[1,1] op_sel_hi:[0,1]
    v_pk_fma_f32 v[80:81], v[78:79], v[78:79], v[92:93] op_sel:[0,0,0] op_sel_hi:[0,1,1] neg_lo:[0,0,1]
    v_pk_mul_f32 v[94:95], v[70:71], v[70:71] op_sel:[1,1] op_sel_hi:[0,1]
    v_pk_fma_f32 v[72:73], v[70:71], v[70:71], v[94:95] op_sel:[0,0,0] op_sel_hi:[0,1,1] neg_lo:[0,0,1]
    v_pk_mul_f32 v[92:93], v[80:81], v[80:81] op_sel:[1,1] op_sel_hi:[0,1]
    v_pk_fma_f32 v[82:83], v[80:81], v[80:81], v[92:93] op_sel:[0,0,0] op_sel_hi:[0,1,1] neg_lo:[0,0,1]
    v_pk_mul_f32 v[94:95], v[72:73], v[72:73] op_sel:[1,1] op_sel_hi:[0,1]
    v_pk_fma_f32 v[74:75], v[72:73], v[72:73], v[94:95] op_sel:[0,0,0] op_sel_hi:[0,1,1] neg_lo:[0,0,1]
    v_pk_mul_f32 v[92:93], v[82:83], v[82:83] op_sel:[1,1] op_sel_hi:[0,1]
    v_pk_fma_f32 v[84:85], v[82:83], v[82:83], v[92:93] op_sel:[0,0,0] op_sel_hi:[0,1,1] neg_lo:[0,0,1]
    v_pk_mul_f32 v[94:95], v[66:67], v[76:77] op_sel:[1,1] op_sel_hi:[1,0]
    v_pk_fma_f32 v[86:87], v[66:67], v[76:77], v[94:95] op_sel:[0,0,0] op_sel_hi:[0,1,1] neg_lo:[0,0,1] neg_hi:[1,0,1]
    v_mov_b32_dpp v80, v78 row_ror:8 row_mask:0xf bank_mask:0x3
    v_mov_b32_dpp v81, v79 row_ror:8 row_mask:0xf bank_mask:0x3
    v_mov_b32_dpp v82, v84 row_ror:8 row_mask:0xf bank_mask:0x3
    v_mov_b32_dpp v83, v85 row_ror:8 row_mask:0xf bank_mask:0x3
    v_pk_mul_f32 v[92:93], v[66:67], v[80:81] op_sel:[1,1] op_sel_hi:[1,0]
    v_pk_fma_f32 v[88:89], v[66:67], v[80:81], v[92:93] op_sel:[0,0,0] op_sel_hi:[0,1,1] neg_lo:[0,0,1] neg_hi:[1,0,1]
    v_pk_mul_f32 v[94:95], v[66:67], v[82:83] op_sel:[1,1] op_sel_hi:[1,0]
    v_pk_fma_f32 v[90:91], v[66:67], v[82:83], v[94:95] op_sel:[0,0,0] op_sel_hi:[0,1,1] neg_lo:[0,0,1] neg_hi:[1,0,1]
    v_mfma_f32_16x16x4_f32 v[48:51], v86, v68, v[48:51]
    v_mfma_f32_16x16x4_f32 v[52:55], v88, v70, v[52:55]
    v_mfma_f32_16x16x4_f32 v[56:59], v88, v72, v[56:59]
    v_mfma_f32_16x16x4_f32 v[60:63], v90, v74, v[60:63]
    v_mfma_f32_16x16x4_f32 v[48:51], v87, v69, v[48:51]
    v_mfma_f32_16x16x4_f32 v[52:55], v89, v71, v[52:55]
    v_mfma_f32_16x16x4_f32 v[56:59], v89, v73, v[56:59]
    v_mfma_f32_16x16x4_f32 v[60:63], v91, v75, v[60:63]
    v_mov_b64_dpp v[64:65], v[28:29] row_newbcast:13 row_mask:0xf bank_mask:0xf
    v_mov_b64_dpp v[66:67], v[30:31] row_newbcast:13 row_mask:0xf bank_mask:0xf
    v_pk_mul_f32 v[94:95], v[64:65], v[26:27] op_sel_hi:[1,0]
    v_pk_mul_f32 v[96:97], v[64:65], v[26:27] op_sel:[0,1] op_sel_hi:[1,1]
    v_fract_f32 v95, v95
    v_fract_f32 v97, v97
    v_exp_f32 v94, v94
    v_exp_f32 v96, v96
    v_cos_f32 v68, v95
    v_sin_f32 v69, v95
    v_cos_f32 v76, v97
    v_sin_f32 v77, v97
    v_pk_mul_f32 v[68:69], v[68:69], v[94:95] op_sel_hi:[1,0]
    v_pk_mul_f32 v[76:77], v[76:77], v[96:97] op_sel_hi:[1,0]
    v_pk_mul_f32 v[92:93], v[76:77], v[76:77] op_sel:[1,1] op_sel_hi:[0,1]
    v_pk_fma_f32 v[78:79], v[76:77], v[76:77], v[92:93] op_sel:[0,0,0] op_sel_hi:[0,1,1] neg_lo:[0,0,1]
    v_pk_mul_f32 v[94:95], v[68:69], v[68:69] op_sel:[1,1] op_sel_hi:[0,1]
    v_pk_fma_f32 v[70:71], v[68:69], v[68:69], v[94:95] op_sel:[0,0,0] op_sel_hi:[0,1,1] neg_lo:[0,0,1]
    v_pk_mul_f32 v[92:93], v[78:79], v[78:79] op_sel:[1,1] op_sel_hi:[0,1]
    v_pk_fma_f32 v[80:81], v[78:79], v[78:79], v[92:93] op_sel:[0,0,0] op_sel_hi:[0,1,1] neg_lo:[0,0,1]
    v_pk_mul_f32 v[94:95], v[70:71], v[70:71] op_sel:[1,1] op_sel_hi:[0,1]
    v_pk_fma_f32 v[72:73], v[70:71], v[70:71], v[94:95] op_sel:[0,0,0] op_sel_hi:[0,1,1] neg_lo:[0,0,1]
    v_pk_mul_f32 v[92:93], v[80:81], v[80:81] op_sel:[1,1] op_sel_hi:[0,1]
    v_pk_fma_f32 v[82:83], v[80:81], v[80:81], v[92:93] op_sel:[0,0,0] op_sel_hi:[0,1,1] neg_lo:[0,0,1]
    v_pk_mul_f32 v[94:95], v[72:73], v[72:73] op_sel:[1,1] op_sel_hi:[0,1]
    v_pk_fma_f32 v[74:75], v[72:73], v[72:73], v[94:95] op_sel:[0,0,0] op_sel_hi:[0,1,1] neg_lo:[0,0,1]
    v_pk_mul_f32 v[92:93], v[82:83], v[82:83] op_sel:[1,1] op_sel_hi:[0,1]
    v_pk_fma_f32 v[84:85], v[82:83], v[82:83], v[92:93] op_sel:[0,0,0] op_sel_hi:[0,1,1] neg_lo:[0,0,1]
    v_pk_mul_f32 v[94:95], v[66:67], v[76:77] op_sel:[1,1] op_sel_hi:[1,0]
    v_pk_fma_f32 v[86:87], v[66:67], v[76:77], v[94:95] op_sel:[0,0,0] op_sel_hi:[0,1,1] neg_lo:[0,0,1] neg_hi:[1,0,1]
    v_mov_b32_dpp v80, v78 row_ror:8 row_mask:0xf bank_mask:0x3
    v_mov_b32_dpp v81, v79 row_ror:8 row_mask:0xf bank_mask:0x3
    v_mov_b32_dpp v82, v84 row_ror:8 row_mask:0xf bank_mask:0x3
    v_mov_b32_dpp v83, v85 row_ror:8 row_mask:0xf bank_mask:0x3
    v_pk_mul_f32 v[92:93], v[66:67], v[80:81] op_sel:[1,1] op_sel_hi:[1,0]
    v_pk_fma_f32 v[88:89], v[66:67], v[80:81], v[92:93] op_sel:[0,0,0] op_sel_hi:[0,1,1] neg_lo:[0,0,1] neg_hi:[1,0,1]
    v_pk_mul_f32 v[94:95], v[66:67], v[82:83] op_sel:[1,1] op_sel_hi:[1,0]
    v_pk_fma_f32 v[90:91], v[66:67], v[82:83], v[94:95] op_sel:[0,0,0] op_sel_hi:[0,1,1] neg_lo:[0,0,1] neg_hi:[1,0,1]
    v_mfma_f32_16x16x4_f32 v[48:51], v86, v68, v[48:51]
    v_mfma_f32_16x16x4_f32 v[52:55], v88, v70, v[52:55]
    v_mfma_f32_16x16x4_f32 v[56:59], v88, v72, v[56:59]
    v_mfma_f32_16x16x4_f32 v[60:63], v90, v74, v[60:63]
    v_mfma_f32_16x16x4_f32 v[48:51], v87, v69, v[48:51]
    v_mfma_f32_16x16x4_f32 v[52:55], v89, v71, v[52:55]
    v_mfma_f32_16x16x4_f32 v[56:59], v89, v73, v[56:59]
    v_mfma_f32_16x16x4_f32 v[60:63], v91, v75, v[60:63]
    v_mov_b64_dpp v[64:65], v[28:29] row_newbcast:14 row_mask:0xf bank_mask:0xf
    v_mov_b64_dpp v[66:67], v[30:31] row_newbcast:14 row_mask:0xf bank_mask:0xf
    v_pk_mul_f32 v[94:95], v[64:65], v[26:27] op_sel_hi:[1,0]
    v_pk_mul_f32 v[96:97], v[64:65], v[26:27] op_sel:[0,1] op_sel_hi:[1,1]
    v_fract_f32 v95, v95
    v_fract_f32 v97, v97
    v_exp_f32 v94, v94
    v_exp_f32 v96, v96
    v_cos_f32 v68, v95
    v_sin_f32 v69, v95
    v_cos_f32 v76, v97
    v_sin_f32 v77, v97
    v_pk_mul_f32 v[68:69], v[68:69], v[94:95] op_sel_hi:[1,0]
    v_pk_mul_f32 v[76:77], v[76:77], v[96:97] op_sel_hi:[1,0]
    v_pk_mul_f32 v[92:93], v[76:77], v[76:77] op_sel:[1,1] op_sel_hi:[0,1]
    v_pk_fma_f32 v[78:79], v[76:77], v[76:77], v[92:93] op_sel:[0,0,0] op_sel_hi:[0,1,1] neg_lo:[0,0,1]
    v_pk_mul_f32 v[94:95], v[68:69], v[68:69] op_sel:[1,1] op_sel_hi:[0,1]
    v_pk_fma_f32 v[70:71], v[68:69], v[68:69], v[94:95] op_sel:[0,0,0] op_sel_hi:[0,1,1] neg_lo:[0,0,1]
    v_pk_mul_f32 v[92:93], v[78:79], v[78:79] op_sel:[1,1] op_sel_hi:[0,1]
    v_pk_fma_f32 v[80:81], v[78:79], v[78:79], v[92:93] op_sel:[0,0,0] op_sel_hi:[0,1,1] neg_lo:[0,0,1]
    v_pk_mul_f32 v[94:95], v[70:71], v[70:71] op_sel:[1,1] op_sel_hi:[0,1]
    v_pk_fma_f32 v[72:73], v[70:71], v[70:71], v[94:95] op_sel:[0,0,0] op_sel_hi:[0,1,1] neg_lo:[0,0,1]
    v_pk_mul_f32 v[92:93], v[80:81], v[80:81] op_sel:[1,1] op_sel_hi:[0,1]
    v_pk_fma_f32 v[82:83], v[80:81], v[80:81], v[92:93] op_sel:[0,0,0] op_sel_hi:[0,1,1] neg_lo:[0,0,1]
    v_pk_mul_f32 v[94:95], v[72:73], v[72:73] op_sel:[1,1] op_sel_hi:[0,1]
    v_pk_fma_f32 v[74:75], v[72:73], v[72:73], v[94:95] op_sel:[0,0,0] op_sel_hi:[0,1,1] neg_lo:[0,0,1]
    v_pk_mul_f32 v[92:93], v[82:83], v[82:83] op_sel:[1,1] op_sel_hi:[0,1]
    v_pk_fma_f32 v[84:85], v[82:83], v[82:83], v[92:93] op_sel:[0,0,0] op_sel_hi:[0,1,1] neg_lo:[0,0,1]
    v_pk_mul_f32 v[94:95], v[66:67], v[76:77] op_sel:[1,1] op_sel_hi:[1,0]
    v_pk_fma_f32 v[86:87], v[66:67], v[76:77], v[94:95] op_sel:[0,0,0] op_sel_hi:[0,1,1] neg_lo:[0,0,1] neg_hi:[1,0,1]
    v_mov_b32_dpp v80, v78 row_ror:8 row_mask:0xf bank_mask:0x3
    v_mov_b32_dpp v81, v79 row_ror:8 row_mask:0xf bank_mask:0x3
    v_mov_b32_dpp v82, v84 row_ror:8 row_mask:0xf bank_mask:0x3
    v_mov_b32_dpp v83, v85 row_ror:8 row_mask:0xf bank_mask:0x3
    v_pk_mul_f32 v[92:93], v[66:67], v[80:81] op_sel:[1,1] op_sel_hi:[1,0]
    v_pk_fma_f32 v[88:89], v[66:67], v[80:81], v[92:93] op_sel:[0,0,0] op_sel_hi:[0,1,1] neg_lo:[0,0,1] neg_hi:[1,0,1]
    v_pk_mul_f32 v[94:95], v[66:67], v[82:83] op_sel:[1,1] op_sel_hi:[1,0]
    v_pk_fma_f32 v[90:91], v[66:67], v[82:83], v[94:95] op_sel:[0,0,0] op_sel_hi:[0,1,1] neg_lo:[0,0,1] neg_hi:[1,0,1]
    v_mfma_f32_16x16x4_f32 v[48:51], v86, v68, v[48:51]
    v_mfma_f32_16x16x4_f32 v[52:55], v88, v70, v[52:55]
    v_mfma_f32_16x16x4_f32 v[56:59], v88, v72, v[56:59]
    v_mfma_f32_16x16x4_f32 v[60:63], v90, v74, v[60:63]
    v_mfma_f32_16x16x4_f32 v[48:51], v87, v69, v[48:51]
    v_mfma_f32_16x16x4_f32 v[52:55], v89, v71, v[52:55]
    v_mfma_f32_16x16x4_f32 v[56:59], v89, v73, v[56:59]
    v_mfma_f32_16x16x4_f32 v[60:63], v91, v75, v[60:63]
    v_mov_b64_dpp v[64:65], v[28:29] row_newbcast:15 row_mask:0xf bank_mask:0xf
    v_mov_b64_dpp v[66:67], v[30:31] row_newbcast:15 row_mask:0xf bank_mask:0xf
    v_pk_mul_f32 v[94:95], v[64:65], v[26:27] op_sel_hi:[1,0]
    v_pk_mul_f32 v[96:97], v[64:65], v[26:27] op_sel:[0,1] op_sel_hi:[1,1]
    v_fract_f32 v95, v95
    v_fract_f32 v97, v97
    v_exp_f32 v94, v94
    v_exp_f32 v96, v96
    v_cos_f32 v68, v95
    v_sin_f32 v69, v95
    v_cos_f32 v76, v97
    v_sin_f32 v77, v97
    v_pk_mul_f32 v[68:69], v[68:69], v[94:95] op_sel_hi:[1,0]
    v_pk_mul_f32 v[76:77], v[76:77], v[96:97] op_sel_hi:[1,0]
    v_pk_mul_f32 v[92:93], v[76:77], v[76:77] op_sel:[1,1] op_sel_hi:[0,1]
    v_pk_fma_f32 v[78:79], v[76:77], v[76:77], v[92:93] op_sel:[0,0,0] op_sel_hi:[0,1,1] neg_lo:[0,0,1]
    v_pk_mul_f32 v[94:95], v[68:69], v[68:69] op_sel:[1,1] op_sel_hi:[0,1]
    v_pk_fma_f32 v[70:71], v[68:69], v[68:69], v[94:95] op_sel:[0,0,0] op_sel_hi:[0,1,1] neg_lo:[0,0,1]
    v_pk_mul_f32 v[92:93], v[78:79], v[78:79] op_sel:[1,1] op_sel_hi:[0,1]
    v_pk_fma_f32 v[80:81], v[78:79], v[78:79], v[92:93] op_sel:[0,0,0] op_sel_hi:[0,1,1] neg_lo:[0,0,1]
    v_pk_mul_f32 v[94:95], v[70:71], v[70:71] op_sel:[1,1] op_sel_hi:[0,1]
    v_pk_fma_f32 v[72:73], v[70:71], v[70:71], v[94:95] op_sel:[0,0,0] op_sel_hi:[0,1,1] neg_lo:[0,0,1]
    v_pk_mul_f32 v[92:93], v[80:81], v[80:81] op_sel:[1,1] op_sel_hi:[0,1]
    v_pk_fma_f32 v[82:83], v[80:81], v[80:81], v[92:93] op_sel:[0,0,0] op_sel_hi:[0,1,1] neg_lo:[0,0,1]
    v_pk_mul_f32 v[94:95], v[72:73], v[72:73] op_sel:[1,1] op_sel_hi:[0,1]
    v_pk_fma_f32 v[74:75], v[72:73], v[72:73], v[94:95] op_sel:[0,0,0] op_sel_hi:[0,1,1] neg_lo:[0,0,1]
    v_pk_mul_f32 v[92:93], v[82:83], v[82:83] op_sel:[1,1] op_sel_hi:[0,1]
    v_pk_fma_f32 v[84:85], v[82:83], v[82:83], v[92:93] op_sel:[0,0,0] op_sel_hi:[0,1,1] neg_lo:[0,0,1]
    v_pk_mul_f32 v[94:95], v[66:67], v[76:77] op_sel:[1,1] op_sel_hi:[1,0]
    v_pk_fma_f32 v[86:87], v[66:67], v[76:77], v[94:95] op_sel:[0,0,0] op_sel_hi:[0,1,1] neg_lo:[0,0,1] neg_hi:[1,0,1]
    v_mov_b32_dpp v80, v78 row_ror:8 row_mask:0xf bank_mask:0x3
    v_mov_b32_dpp v81, v79 row_ror:8 row_mask:0xf bank_mask:0x3
    v_mov_b32_dpp v82, v84 row_ror:8 row_mask:0xf bank_mask:0x3
    v_mov_b32_dpp v83, v85 row_ror:8 row_mask:0xf bank_mask:0x3
    v_pk_mul_f32 v[92:93], v[66:67], v[80:81] op_sel:[1,1] op_sel_hi:[1,0]
    v_pk_fma_f32 v[88:89], v[66:67], v[80:81], v[92:93] op_sel:[0,0,0] op_sel_hi:[0,1,1] neg_lo:[0,0,1] neg_hi:[1,0,1]
    v_pk_mul_f32 v[94:95], v[66:67], v[82:83] op_sel:[1,1] op_sel_hi:[1,0]
    v_pk_fma_f32 v[90:91], v[66:67], v[82:83], v[94:95] op_sel:[0,0,0] op_sel_hi:[0,1,1] neg_lo:[0,0,1] neg_hi:[1,0,1]
    v_mfma_f32_16x16x4_f32 v[48:51], v86, v68, v[48:51]
    v_mfma_f32_16x16x4_f32 v[52:55], v88, v70, v[52:55]
    v_mfma_f32_16x16x4_f32 v[56:59], v88, v72, v[56:59]
    v_mfma_f32_16x16x4_f32 v[60:63], v90, v74, v[60:63]
    v_mfma_f32_16x16x4_f32 v[48:51], v87, v69, v[48:51]
    v_mfma_f32_16x16x4_f32 v[52:55], v89, v71, v[52:55]
    v_mfma_f32_16x16x4_f32 v[56:59], v89, v73, v[56:59]
    v_mfma_f32_16x16x4_f32 v[60:63], v91, v75, v[60:63]
    v_mov_b64 v[28:29], v[32:33]
    v_mov_b64 v[30:31], v[34:35]
    s_add_u32 s25, s25, 1
    s_cmp_lt_u32 s25, 2
    s_cbranch_scc1 ss_kg
    s_cmp_lg_u32 s28, 0
    s_cbranch_scc1 ss_nostage
    s_waitcnt vmcnt(0)
    v_mov_b32 v36, 0x05040100
    v_mov_b32 v37, 0x07060302
    v_lshlrev_b32 v6, 4, v0
    v_add_u32 v7, 65536, v6
    v_perm_b32 v40, v212, v208, v36
    v_perm_b32 v41, v220, v216, v36
    v_perm_b32 v42, v228, v224, v36
    v_perm_b32 v43, v236, v232, v36
    ds_write_b128 v6, v[40:43] offset:512
    v_perm_b32 v44, v212, v208, v37
    v_perm_b32 v45, v220, v216, v37
    v_perm_b32 v46, v228, v224, v37
    v_perm_b32 v47, v236, v232, v37
    ds_write_b128 v6, v[44:47] offset:16896
    v_perm_b32 v40, v213, v209, v36
    v_perm_b32 v41, v221, v217, v36
    v_perm_b32 v42, v229, v225, v36
    v_perm_b32 v43, v237, v233, v36
    ds_write_b128 v6, v[40:43] offset:33280
    v_perm_b32 v44, v213, v209, v37
    v_perm_b32 v45, v221, v217, v37
    v_perm_b32 v46, v229, v225, v37
    v_perm_b32 v47, v237, v233, v37
    ds_write_b128 v6, v[44:47] offset:49664
    v_perm_b32 v40, v214, v210, v36
    v_perm_b32 v41, v222, v218, v36
    v_perm_b32 v42, v230, v226, v36
    v_perm_b32 v43, v238, v234, v36
    ds_write_b128 v7, v[40:43] offset:512
    v_perm_b32 v44, v214, v210, v37
    v_perm_b32 v45, v222, v218, v37
    v_perm_b32 v46, v230, v226, v37
    v_perm_b32 v47, v238, v234, v37
    ds_write_b128 v7, v[44:47] offset:16896
    v_perm_b32 v40, v215, v211, v36
    v_perm_b32 v41, v223, v219, v36
    v_perm_b32 v42, v231, v227, v36
    v_perm_b32 v43, v239, v235, v36
    ds_write_b128 v7, v[40:43] offset:33280
    v_perm_b32 v44, v215, v211, v37
    v_perm_b32 v45, v223, v219, v37
    v_perm_b32 v46, v231, v227, v37
    v_perm_b32 v47, v239, v235, v37
    ds_write_b128 v7, v[44:47] offset:49664
ss_nostage:
    s_nop 11
    v_lshlrev_b32 v5, 8, v3
    v_lshl_add_u32 v5, v2, 2, v5
    v_add_u32 v5, v5, v4
    ds_write_b32 v5, v48 offset:4608
    ds_write_b32 v5, v49 offset:4672
    ds_write_b32 v5, v50 offset:4736
    ds_write_b32 v5, v51 offset:4800
    s_mov_b32 exec_hi, 0
    ds_write_b32 v5, v52 offset:5632
    ds_write_b32 v5, v53 offset:5696
    ds_write_b32 v5, v54 offset:5760
    ds_write_b32 v5, v55 offset:5824
    s_not_b64 exec, exec
    ds_write_b32 v5, v56 offset:5632
    ds_write_b32 v5, v57 offset:5696
    ds_write_b32 v5, v58 offset:5760
    ds_write_b32 v5, v59 offset:5824
    ds_write_b32 v5, v60 offset:6144
    ds_write_b32 v5, v61 offset:6208
    ds_write_b32 v5, v62 offset:6272
    ds_write_b32 v5, v63 offset:6336
    s_mov_b64 exec, 3
    v_cmp_eq_u32 vcc, 0, v2
    s_nop 1
    v_cndmask_b32 v6, 0, v60, vcc
    ds_write_b32 v5, v6 offset:7168
    s_mov_b64 exec, -1
    s_waitcnt lgkmcnt(0)
    v_lshlrev_b32 v7, 1, v1
    v_sub_u32 v7, 2065, v7
    v_lshl_add_u32 v64, v1, 2, v4
    v_mov_b32 v65, 641
    s_mov_b32 s25, 9
    s_mov_b32 s22, 256
    s_mov_b32 s23, 2048
ss_exp:
    v_subrev_u32 v66, 0, v7
    v_cvt_f32_u32 v72, v66
    v_cmp_gt_u32 vcc, s22, v66
    v_cvt_pk_bf16_f32 v72, v72, 0
    v_subrev_u32 v72, 0x4280, v72
    v_cndmask_b32 v72, v72, v66, vcc
    v_cmp_gt_u32 vcc, s23, v66
    s_nop 1
    v_cndmask_b32 v72, v65, v72, vcc
    v_lshl_add_u32 v72, v72, 2, v4
    v_subrev_u32 v67, 1, v7
    v_cvt_f32_u32 v73, v67
    v_cmp_gt_u32 vcc, s22, v67
    v_cvt_pk_bf16_f32 v73, v73, 0
    v_subrev_u32 v73, 0x4280, v73
    v_cndmask_b32 v73, v73, v67, vcc
    v_cmp_gt_u32 vcc, s23, v67
    ds_read_b32 v78, v72 offset:4608
    s_nop 0
    v_cndmask_b32 v73, v65, v73, vcc
    v_lshl_add_u32 v73, v73, 2, v4
    v_subrev_u32 v68, 2, v7
    v_cvt_f32_u32 v74, v68
    v_cmp_gt_u32 vcc, s22, v68
    v_cvt_pk_bf16_f32 v74, v74, 0
    v_subrev_u32 v74, 0x4280, v74
    v_cndmask_b32 v74, v74, v68, vcc
    v_cmp_gt_u32 vcc, s23, v68
    ds_read_b32 v79, v73 offset:4608
    s_nop 0
    v_cndmask_b32 v74, v65, v74, vcc
    v_lshl_add_u32 v74, v74, 2, v4
    v_subrev_u32 v69, 128, v7
    v_cvt_f32_u32 v75, v69
    v_cmp_gt_u32 vcc, s22, v69
    v_cvt_pk_bf16_f32 v75, v75, 0
    v_subrev_u32 v75, 0x4280, v75
    v_cndmask_b32 v75, v75, v69, vcc
    v_cmp_gt_u32 vcc, s23, v69
    ds_read_b32 v80, v74 offset:4608
    s_nop 0
    v_cndmask_b32 v75, v65, v75, vcc
    v_lshl_add_u32 v75, v75, 2, v4
    v_subrev_u32 v70, 129, v7
    v_cvt_f32_u32 v76, v70
    v_cmp_gt_u32 vcc, s22, v70
    v_cvt_pk_bf16_f32 v76, v76, 0
    v_subrev_u32 v76, 0x4280, v76
    v_cndmask_b32 v76, v76, v70, vcc
    v_cmp_gt_u32 vcc, s23, v70
    ds_read_b32 v81, v75 offset:4608
    s_nop 0
    v_cndmask_b32 v76, v65, v76, vcc
    v_lshl_add_u32 v76, v76, 2, v4
    v_subrev_u32 v71, 130, v7
    v_cvt_f32_u32 v77, v71
    v_cmp_gt_u32 vcc, s22, v71
    v_cvt_pk_bf16_f32 v77, v77, 0
    v_subrev_u32 v77, 0x4280, v77
    v_cndmask_b32 v77, v77, v71, vcc
    v_cmp_gt_u32 vcc, s23, v71
    ds_read_b32 v82, v76 offset:4608
    s_nop 0
    v_cndmask_b32 v77, v65, v77, vcc
    v_lshl_add_u32 v77, v77, 2, v4
    ds_read_b32 v83, v77 offset:4608
    v_subrev_u32 v7, 256, v7
    s_sub_u32 s25, s25, 1
    s_waitcnt lgkmcnt(0)
    v_cvt_pk_bf16_f32 v84, v79, v80
    v_cvt_pk_bf16_f32 v85, v78, v79
    v_cvt_pk_bf16_f32 v86, v82, v83
    v_cvt_pk_bf16_f32 v87, v81, v82
    ds_write_b32 v64, v84 offset:7424
    ds_write_b32 v64, v85 offset:11776
    s_cmp_eq_u32 s25, 0
    s_cbranch_scc1 ss_expx
    ds_write_b32 v64, v86 offset:7680
    ds_write_b32 v64, v87 offset:12032
    v_add_u32 v64, 512, v64
    s_nop 1
    s_branch ss_exp
ss_expx:
    s_waitcnt lgkmcnt(0)
    s_barrier
    v_and_b32 v5, 1, v2
    v_mul_u32_u24 v36, 4352, v5
    v_sub_u32 v5, v5, v2
    v_lshl_add_u32 v5, v3, 3, v5
    v_lshl_add_u32 v36, v5, 1, v36
    v_add_u32 v36, 11072, v36
    v_add_u32 v36, v36, v4
    v_subrev_u32 v37, 512, v36
    v_subrev_u32 v38, 1024, v36
    v_subrev_u32 v39, 1536, v36
    v_subrev_u32 v40, 2048, v36
    v_subrev_u32 v41, 2560, v36
    v_subrev_u32 v42, 3072, v36
    v_subrev_u32 v43, 3584, v36
    v_lshlrev_b32 v44, 5, v2
    v_lshl_add_u32 v44, v3, 4, v44
    v_add_u32 v44, 32, v44
    v_add_u32 v44, v44, v4
    ds_read_b128 v[112:115], v44 offset:448
    ds_read2_b32 v[80:81], v36 offset0:112 offset1:113
    ds_read2_b32 v[82:83], v36 offset0:114 offset1:115
    ds_read_b128 v[116:119], v44 offset:960
    ds_read2_b32 v[84:85], v37 offset0:112 offset1:113
    ds_read2_b32 v[86:87], v37 offset0:114 offset1:115
    ds_read_b128 v[120:123], v44 offset:1472
    ds_read2_b32 v[88:89], v38 offset0:112 offset1:113
    ds_read2_b32 v[90:91], v38 offset0:114 offset1:115
    ds_read_b128 v[124:127], v44 offset:1984
    ds_read2_b32 v[92:93], v39 offset0:112 offset1:113
    ds_read2_b32 v[94:95], v39 offset0:114 offset1:115
    ds_read_b128 v[128:131], v44 offset:2496
    ds_read2_b32 v[96:97], v40 offset0:112 offset1:113
    ds_read2_b32 v[98:99], v40 offset0:114 offset1:115
    ds_read_b128 v[132:135], v44 offset:3008
    ds_read2_b32 v[100:101], v41 offset0:112 offset1:113
    ds_read2_b32 v[102:103], v41 offset0:114 offset1:115
    ds_read_b128 v[136:139], v44 offset:3520
    ds_read2_b32 v[104:105], v42 offset0:112 offset1:113
    ds_read2_b32 v[106:107], v42 offset0:114 offset1:115
    ds_read_b128 v[140:143], v44 offset:4032
    ds_read2_b32 v[108:109], v43 offset0:112 offset1:113
    ds_read2_b32 v[110:111], v43 offset0:114 offset1:115
    s_waitcnt lgkmcnt(0)
    v_mfma_f32_16x16x32_bf16 v[48:51], v[80:83], v[112:115], 0
    ds_read_b128 v[176:179], v44 offset:384
    v_mfma_f32_16x16x32_bf16 v[52:55], v[80:83], v[116:119], 0
    ds_read2_b32 v[144:145], v36 offset0:96 offset1:97
    v_mfma_f32_16x16x32_bf16 v[56:59], v[80:83], v[120:123], 0
    ds_read2_b32 v[146:147], v36 offset0:98 offset1:99
    v_mfma_f32_16x16x32_bf16 v[60:63], v[80:83], v[124:127], 0
    ds_read_b128 v[180:183], v44 offset:896
    v_mfma_f32_16x16x32_bf16 v[64:67], v[80:83], v[128:131], 0
    ds_read2_b32 v[148:149], v37 offset0:96 offset1:97
    v_mfma_f32_16x16x32_bf16 v[68:71], v[80:83], v[132:135], 0
    ds_read2_b32 v[150:151], v37 offset0:98 offset1:99
    v_mfma_f32_16x16x32_bf16 v[72:75], v[80:83], v[136:139], 0
    ds_read_b128 v[184:187], v44 offset:1408
    v_mfma_f32_16x16x32_bf16 v[76:79], v[80:83], v[140:143], 0
    ds_read2_b32 v[152:153], v38 offset0:96 offset1:97
    v_mfma_f32_16x16x32_bf16 v[52:55], v[84:87], v[112:115], v[52:55]
    ds_read2_b32 v[154:155], v38 offset0:98 offset1:99
    v_mfma_f32_16x16x32_bf16 v[56:59], v[84:87], v[116:119], v[56:59]
    ds_read_b128 v[188:191], v44 offset:1920
    v_mfma_f32_16x16x32_bf16 v[60:63], v[84:87], v[120:123], v[60:63]
    ds_read2_b32 v[156:157], v39 offset0:96 offset1:97
    v_mfma_f32_16x16x32_bf16 v[64:67], v[84:87], v[124:127], v[64:67]
    ds_read2_b32 v[158:159], v39 offset0:98 offset1:99
    v_mfma_f32_16x16x32_bf16 v[68:71], v[84:87], v[128:131], v[68:71]
    ds_read_b128 v[192:195], v44 offset:2432
    v_mfma_f32_16x16x32_bf16 v[72:75], v[84:87], v[132:135], v[72:75]
    ds_read2_b32 v[160:161], v40 offset0:96 offset1:97
    v_mfma_f32_16x16x32_bf16 v[76:79], v[84:87], v[136:139], v[76:79]
    ds_read2_b32 v[162:163], v40 offset0:98 offset1:99
    v_mfma_f32_16x16x32_bf16 v[56:59], v[88:91], v[112:115], v[56:59]
    ds_read_b128 v[196:199], v44 offset:2944
    v_mfma_f32_16x16x32_bf16 v[60:63], v[88:91], v[116:119], v[60:63]
    ds_read2_b32 v[164:165], v41 offset0:96 offset1:97
    v_mfma_f32_16x16x32_bf16 v[64:67], v[88:91], v[120:123], v[64:67]
    ds_read2_b32 v[166:167], v41 offset0:98 offset1:99
    v_mfma_f32_16x16x32_bf16 v[68:71], v[88:91], v[124:127], v[68:71]
    ds_read_b128 v[200:203], v44 offset:3456
    v_mfma_f32_16x16x32_bf16 v[72:75], v[88:91], v[128:131], v[72:75]
    ds_read2_b32 v[168:169], v42 offset0:96 offset1:97
    v_mfma_f32_16x16x32_bf16 v[76:79], v[88:91], v[132:135], v[76:79]
    ds_read2_b32 v[170:171], v42 offset0:98 offset1:99
    v_mfma_f32_16x16x32_bf16 v[60:63], v[92:95], v[112:115], v[60:63]
    ds_read_b128 v[204:207], v44 offset:3968
    v_mfma_f32_16x16x32_bf16 v[64:67], v[92:95], v[116:119], v[64:67]
    ds_read2_b32 v[172:173], v43 offset0:96 offset1:97
    v_mfma_f32_16x16x32_bf16 v[68:71], v[92:95], v[120:123], v[68:71]
    ds_read2_b32 v[174:175], v43 offset0:98 offset1:99
    v_mfma_f32_16x16x32_bf16 v[72:75], v[92:95], v[124:127], v[72:75]
    v_mfma_f32_16x16x32_bf16 v[76:79], v[92:95], v[128:131], v[76:79]
    v_mfma_f32_16x16x32_bf16 v[64:67], v[96:99], v[112:115], v[64:67]
    v_mfma_f32_16x16x32_bf16 v[68:71], v[96:99], v[116:119], v[68:71]
    v_mfma_f32_16x16x32_bf16 v[72:75], v[96:99], v[120:123], v[72:75]
    v_mfma_f32_16x16x32_bf16 v[76:79], v[96:99], v[124:127], v[76:79]
    v_mfma_f32_16x16x32_bf16 v[68:71], v[100:103], v[112:115], v[68:71]
    v_mfma_f32_16x16x32_bf16 v[72:75], v[100:103], v[116:119], v[72:75]
    v_mfma_f32_16x16x32_bf16 v[76:79], v[100:103], v[120:123], v[76:79]
    v_mfma_f32_16x16x32_bf16 v[72:75], v[104:107], v[112:115], v[72:75]
    v_mfma_f32_16x16x32_bf16 v[76:79], v[104:107], v[116:119], v[76:79]
    v_mfma_f32_16x16x32_bf16 v[76:79], v[108:111], v[112:115], v[76:79]
    s_waitcnt lgkmcnt(0)
    v_mfma_f32_16x16x32_bf16 v[48:51], v[144:147], v[176:179], v[48:51]
    ds_read_b128 v[112:115], v44 offset:320
    v_mfma_f32_16x16x32_bf16 v[52:55], v[144:147], v[180:183], v[52:55]
    ds_read2_b32 v[80:81], v36 offset0:80 offset1:81
    v_mfma_f32_16x16x32_bf16 v[56:59], v[144:147], v[184:187], v[56:59]
    ds_read2_b32 v[82:83], v36 offset0:82 offset1:83
    v_mfma_f32_16x16x32_bf16 v[60:63], v[144:147], v[188:191], v[60:63]
    ds_read_b128 v[116:119], v44 offset:832
    v_mfma_f32_16x16x32_bf16 v[64:67], v[144:147], v[192:195], v[64:67]
    ds_read2_b32 v[84:85], v37 offset0:80 offset1:81
    v_mfma_f32_16x16x32_bf16 v[68:71], v[144:147], v[196:199], v[68:71]
    ds_read2_b32 v[86:87], v37 offset0:82 offset1:83
    v_mfma_f32_16x16x32_bf16 v[72:75], v[144:147], v[200:203], v[72:75]
    ds_read_b128 v[120:123], v44 offset:1344
    v_mfma_f32_16x16x32_bf16 v[76:79], v[144:147], v[204:207], v[76:79]
    ds_read2_b32 v[88:89], v38 offset0:80 offset1:81
    v_mfma_f32_16x16x32_bf16 v[52:55], v[148:151], v[176:179], v[52:55]
    ds_read2_b32 v[90:91], v38 offset0:82 offset1:83
    v_mfma_f32_16x16x32_bf16 v[56:59], v[148:151], v[180:183], v[56:59]
    ds_read_b128 v[124:127], v44 offset:1856
    v_mfma_f32_16x16x32_bf16 v[60:63], v[148:151], v[184:187], v[60:63]
    ds_read2_b32 v[92:93], v39 offset0:80 offset1:81
    v_mfma_f32_16x16x32_bf16 v[64:67], v[148:151], v[188:191], v[64:67]
    ds_read2_b32 v[94:95], v39 offset0:82 offset1:83
    v_mfma_f32_16x16x32_bf16 v[68:71], v[148:151], v[192:195], v[68:71]
    ds_read_b128 v[128:131], v44 offset:2368
    v_mfma_f32_16x16x32_bf16 v[72:75], v[148:151], v[196:199], v[72:75]
    ds_read2_b32 v[96:97], v40 offset0:80 offset1:81
    v_mfma_f32_16x16x32_bf16 v[76:79], v[148:151], v[200:203], v[76:79]
    ds_read2_b32 v[98:99], v40 offset0:82 offset1:83
    v_mfma_f32_16x16x32_bf16 v[56:59], v[152:155], v[176:179], v[56:59]
    ds_read_b128 v[132:135], v44 offset:2880
    v_mfma_f32_16x16x32_bf16 v[60:63], v[152:155], v[180:183], v[60:63]
    ds_read2_b32 v[100:101], v41 offset0:80 offset1:81
    v_mfma_f32_16x16x32_bf16 v[64:67], v[152:155], v[184:187], v[64:67]
    ds_read2_b32 v[102:103], v41 offset0:82 offset1:83
    v_mfma_f32_16x16x32_bf16 v[68:71], v[152:155], v[188:191], v[68:71]
    ds_read_b128 v[136:139], v44 offset:3392
    v_mfma_f32_16x16x32_bf16 v[72:75], v[152:155], v[192:195], v[72:75]
    ds_read2_b32 v[104:105], v42 offset0:80 offset1:81
    v_mfma_f32_16x16x32_bf16 v[76:79], v[152:155], v[196:199], v[76:79]
    ds_read2_b32 v[106:107], v42 offset0:82 offset1:83
    v_mfma_f32_16x16x32_bf16 v[60:63], v[156:159], v[176:179], v[60:63]
    ds_read_b128 v[140:143], v44 offset:3904
    v_mfma_f32_16x16x32_bf16 v[64:67], v[156:159], v[180:183], v[64:67]
    ds_read2_b32 v[108:109], v43 offset0:80 offset1:81
    v_mfma_f32_16x16x32_bf16 v[68:71], v[156:159], v[184:187], v[68:71]
    ds_read2_b32 v[110:111], v43 offset0:82 offset1:83
    v_mfma_f32_16x16x32_bf16 v[72:75], v[156:159], v[188:191], v[72:75]
    v_mfma_f32_16x16x32_bf16 v[76:79], v[156:159], v[192:195], v[76:79]
    v_mfma_f32_16x16x32_bf16 v[64:67], v[160:163], v[176:179], v[64:67]
    v_mfma_f32_16x16x32_bf16 v[68:71], v[160:163], v[180:183], v[68:71]
    v_mfma_f32_16x16x32_bf16 v[72:75], v[160:163], v[184:187], v[72:75]
    v_mfma_f32_16x16x32_bf16 v[76:79], v[160:163], v[188:191], v[76:79]
    v_mfma_f32_16x16x32_bf16 v[68:71], v[164:167], v[176:179], v[68:71]
    v_mfma_f32_16x16x32_bf16 v[72:75], v[164:167], v[180:183], v[72:75]
    v_mfma_f32_16x16x32_bf16 v[76:79], v[164:167], v[184:187], v[76:79]
    v_mfma_f32_16x16x32_bf16 v[72:75], v[168:171], v[176:179], v[72:75]
    v_mfma_f32_16x16x32_bf16 v[76:79], v[168:171], v[180:183], v[76:79]
    v_mfma_f32_16x16x32_bf16 v[76:79], v[172:175], v[176:179], v[76:79]
    s_waitcnt lgkmcnt(0)
    v_mfma_f32_16x16x32_bf16 v[48:51], v[80:83], v[112:115], v[48:51]
    ds_read_b128 v[176:179], v44 offset:256
    v_mfma_f32_16x16x32_bf16 v[52:55], v[80:83], v[116:119], v[52:55]
    ds_read2_b32 v[144:145], v36 offset0:64 offset1:65
    v_mfma_f32_16x16x32_bf16 v[56:59], v[80:83], v[120:123], v[56:59]
    ds_read2_b32 v[146:147], v36 offset0:66 offset1:67
    v_mfma_f32_16x16x32_bf16 v[60:63], v[80:83], v[124:127], v[60:63]
    ds_read_b128 v[180:183], v44 offset:768
    v_mfma_f32_16x16x32_bf16 v[64:67], v[80:83], v[128:131], v[64:67]
    ds_read2_b32 v[148:149], v37 offset0:64 offset1:65
    v_mfma_f32_16x16x32_bf16 v[68:71], v[80:83], v[132:135], v[68:71]
    ds_read2_b32 v[150:151], v37 offset0:66 offset1:67
    v_mfma_f32_16x16x32_bf16 v[72:75], v[80:83], v[136:139], v[72:75]
    ds_read_b128 v[184:187], v44 offset:1280
    v_mfma_f32_16x16x32_bf16 v[76:79], v[80:83], v[140:143], v[76:79]
    ds_read2_b32 v[152:153], v38 offset0:64 offset1:65
    v_mfma_f32_16x16x32_bf16 v[52:55], v[84:87], v[112:115], v[52:55]
    ds_read2_b32 v[154:155], v38 offset0:66 offset1:67
    v_mfma_f32_16x16x32_bf16 v[56:59], v[84:87], v[116:119], v[56:59]
    ds_read_b128 v[188:191], v44 offset:1792
    v_mfma_f32_16x16x32_bf16 v[60:63], v[84:87], v[120:123], v[60:63]
    ds_read2_b32 v[156:157], v39 offset0:64 offset1:65
    v_mfma_f32_16x16x32_bf16 v[64:67], v[84:87], v[124:127], v[64:67]
    ds_read2_b32 v[158:159], v39 offset0:66 offset1:67
    v_mfma_f32_16x16x32_bf16 v[68:71], v[84:87], v[128:131], v[68:71]
    ds_read_b128 v[192:195], v44 offset:2304
    v_mfma_f32_16x16x32_bf16 v[72:75], v[84:87], v[132:135], v[72:75]
    ds_read2_b32 v[160:161], v40 offset0:64 offset1:65
    v_mfma_f32_16x16x32_bf16 v[76:79], v[84:87], v[136:139], v[76:79]
    ds_read2_b32 v[162:163], v40 offset0:66 offset1:67
    v_mfma_f32_16x16x32_bf16 v[56:59], v[88:91], v[112:115], v[56:59]
    ds_read_b128 v[196:199], v44 offset:2816
    v_mfma_f32_16x16x32_bf16 v[60:63], v[88:91], v[116:119], v[60:63]
    ds_read2_b32 v[164:165], v41 offset0:64 offset1:65
    v_mfma_f32_16x16x32_bf16 v[64:67], v[88:91], v[120:123], v[64:67]
    ds_read2_b32 v[166:167], v41 offset0:66 offset1:67
    v_mfma_f32_16x16x32_bf16 v[68:71], v[88:91], v[124:127], v[68:71]
    ds_read_b128 v[200:203], v44 offset:3328
    v_mfma_f32_16x16x32_bf16 v[72:75], v[88:91], v[128:131], v[72:75]
    ds_read2_b32 v[168:169], v42 offset0:64 offset1:65
    v_mfma_f32_16x16x32_bf16 v[76:79], v[88:91], v[132:135], v[76:79]
    ds_read2_b32 v[170:171], v42 offset0:66 offset1:67
    v_mfma_f32_16x16x32_bf16 v[60:63], v[92:95], v[112:115], v[60:63]
    ds_read_b128 v[204:207], v44 offset:3840
    v_mfma_f32_16x16x32_bf16 v[64:67], v[92:95], v[116:119], v[64:67]
    ds_read2_b32 v[172:173], v43 offset0:64 offset1:65
    v_mfma_f32_16x16x32_bf16 v[68:71], v[92:95], v[120:123], v[68:71]
    ds_read2_b32 v[174:175], v43 offset0:66 offset1:67
    v_mfma_f32_16x16x32_bf16 v[72:75], v[92:95], v[124:127], v[72:75]
    v_mfma_f32_16x16x32_bf16 v[76:79], v[92:95], v[128:131], v[76:79]
    v_mfma_f32_16x16x32_bf16 v[64:67], v[96:99], v[112:115], v[64:67]
    v_mfma_f32_16x16x32_bf16 v[68:71], v[96:99], v[116:119], v[68:71]
    v_mfma_f32_16x16x32_bf16 v[72:75], v[96:99], v[120:123], v[72:75]
    v_mfma_f32_16x16x32_bf16 v[76:79], v[96:99], v[124:127], v[76:79]
    v_mfma_f32_16x16x32_bf16 v[68:71], v[100:103], v[112:115], v[68:71]
    v_mfma_f32_16x16x32_bf16 v[72:75], v[100:103], v[116:119], v[72:75]
    v_mfma_f32_16x16x32_bf16 v[76:79], v[100:103], v[120:123], v[76:79]
    v_mfma_f32_16x16x32_bf16 v[72:75], v[104:107], v[112:115], v[72:75]
    v_mfma_f32_16x16x32_bf16 v[76:79], v[104:107], v[116:119], v[76:79]
    v_mfma_f32_16x16x32_bf16 v[76:79], v[108:111], v[112:115], v[76:79]
    s_waitcnt lgkmcnt(0)
    v_mfma_f32_16x16x32_bf16 v[48:51], v[144:147], v[176:179], v[48:51]
    ds_read_b128 v[112:115], v44 offset:192
    v_mfma_f32_16x16x32_bf16 v[52:55], v[144:147], v[180:183], v[52:55]
    ds_read2_b32 v[80:81], v36 offset0:48 offset1:49
    v_mfma_f32_16x16x32_bf16 v[56:59], v[144:147], v[184:187], v[56:59]
    ds_read2_b32 v[82:83], v36 offset0:50 offset1:51
    v_mfma_f32_16x16x32_bf16 v[60:63], v[144:147], v[188:191], v[60:63]
    ds_read_b128 v[116:119], v44 offset:704
    v_mfma_f32_16x16x32_bf16 v[64:67], v[144:147], v[192:195], v[64:67]
    ds_read2_b32 v[84:85], v37 offset0:48 offset1:49
    v_mfma_f32_16x16x32_bf16 v[68:71], v[144:147], v[196:199], v[68:71]
    ds_read2_b32 v[86:87], v37 offset0:50 offset1:51
    v_mfma_f32_16x16x32_bf16 v[72:75], v[144:147], v[200:203], v[72:75]
    ds_read_b128 v[120:123], v44 offset:1216
    v_mfma_f32_16x16x32_bf16 v[76:79], v[144:147], v[204:207], v[76:79]
    ds_read2_b32 v[88:89], v38 offset0:48 offset1:49
    v_mfma_f32_16x16x32_bf16 v[52:55], v[148:151], v[176:179], v[52:55]
    ds_read2_b32 v[90:91], v38 offset0:50 offset1:51
    v_mfma_f32_16x16x32_bf16 v[56:59], v[148:151], v[180:183], v[56:59]
    ds_read_b128 v[124:127], v44 offset:1728
    v_mfma_f32_16x16x32_bf16 v[60:63], v[148:151], v[184:187], v[60:63]
    ds_read2_b32 v[92:93], v39 offset0:48 offset1:49
    v_mfma_f32_16x16x32_bf16 v[64:67], v[148:151], v[188:191], v[64:67]
    ds_read2_b32 v[94:95], v39 offset0:50 offset1:51
    v_mfma_f32_16x16x32_bf16 v[68:71], v[148:151], v[192:195], v[68:71]
    ds_read_b128 v[128:131], v44 offset:2240
    v_mfma_f32_16x16x32_bf16 v[72:75], v[148:151], v[196:199], v[72:75]
    ds_read2_b32 v[96:97], v40 offset0:48 offset1:49
    v_mfma_f32_16x16x32_bf16 v[76:79], v[148:151], v[200:203], v[76:79]
    ds_read2_b32 v[98:99], v40 offset0:50 offset1:51
    v_mfma_f32_16x16x32_bf16 v[56:59], v[152:155], v[176:179], v[56:59]
    ds_read_b128 v[132:135], v44 offset:2752
    v_mfma_f32_16x16x32_bf16 v[60:63], v[152:155], v[180:183], v[60:63]
    ds_read2_b32 v[100:101], v41 offset0:48 offset1:49
    v_mfma_f32_16x16x32_bf16 v[64:67], v[152:155], v[184:187], v[64:67]
    ds_read2_b32 v[102:103], v41 offset0:50 offset1:51
    v_mfma_f32_16x16x32_bf16 v[68:71], v[152:155], v[188:191], v[68:71]
    ds_read_b128 v[136:139], v44 offset:3264
    v_mfma_f32_16x16x32_bf16 v[72:75], v[152:155], v[192:195], v[72:75]
    ds_read2_b32 v[104:105], v42 offset0:48 offset1:49
    v_mfma_f32_16x16x32_bf16 v[76:79], v[152:155], v[196:199], v[76:79]
    ds_read2_b32 v[106:107], v42 offset0:50 offset1:51
    v_mfma_f32_16x16x32_bf16 v[60:63], v[156:159], v[176:179], v[60:63]
    ds_read_b128 v[140:143], v44 offset:3776
    v_mfma_f32_16x16x32_bf16 v[64:67], v[156:159], v[180:183], v[64:67]
    ds_read2_b32 v[108:109], v43 offset0:48 offset1:49
    v_mfma_f32_16x16x32_bf16 v[68:71], v[156:159], v[184:187], v[68:71]
    ds_read2_b32 v[110:111], v43 offset0:50 offset1:51
    v_mfma_f32_16x16x32_bf16 v[72:75], v[156:159], v[188:191], v[72:75]
    v_mfma_f32_16x16x32_bf16 v[76:79], v[156:159], v[192:195], v[76:79]
    v_mfma_f32_16x16x32_bf16 v[64:67], v[160:163], v[176:179], v[64:67]
    v_mfma_f32_16x16x32_bf16 v[68:71], v[160:163], v[180:183], v[68:71]
    v_mfma_f32_16x16x32_bf16 v[72:75], v[160:163], v[184:187], v[72:75]
    v_mfma_f32_16x16x32_bf16 v[76:79], v[160:163], v[188:191], v[76:79]
    v_mfma_f32_16x16x32_bf16 v[68:71], v[164:167], v[176:179], v[68:71]
    v_mfma_f32_16x16x32_bf16 v[72:75], v[164:167], v[180:183], v[72:75]
    v_mfma_f32_16x16x32_bf16 v[76:79], v[164:167], v[184:187], v[76:79]
    v_mfma_f32_16x16x32_bf16 v[72:75], v[168:171], v[176:179], v[72:75]
    v_mfma_f32_16x16x32_bf16 v[76:79], v[168:171], v[180:183], v[76:79]
    v_mfma_f32_16x16x32_bf16 v[76:79], v[172:175], v[176:179], v[76:79]
    s_waitcnt lgkmcnt(0)
    v_mfma_f32_16x16x32_bf16 v[48:51], v[80:83], v[112:115], v[48:51]
    ds_read_b128 v[176:179], v44 offset:128
    v_mfma_f32_16x16x32_bf16 v[52:55], v[80:83], v[116:119], v[52:55]
    ds_read2_b32 v[144:145], v36 offset0:32 offset1:33
    v_mfma_f32_16x16x32_bf16 v[56:59], v[80:83], v[120:123], v[56:59]
    ds_read2_b32 v[146:147], v36 offset0:34 offset1:35
    v_mfma_f32_16x16x32_bf16 v[60:63], v[80:83], v[124:127], v[60:63]
    ds_read_b128 v[180:183], v44 offset:640
    v_mfma_f32_16x16x32_bf16 v[64:67], v[80:83], v[128:131], v[64:67]
    ds_read2_b32 v[148:149], v37 offset0:32 offset1:33
    v_mfma_f32_16x16x32_bf16 v[68:71], v[80:83], v[132:135], v[68:71]
    ds_read2_b32 v[150:151], v37 offset0:34 offset1:35
    v_mfma_f32_16x16x32_bf16 v[72:75], v[80:83], v[136:139], v[72:75]
    ds_read_b128 v[184:187], v44 offset:1152
    v_mfma_f32_16x16x32_bf16 v[76:79], v[80:83], v[140:143], v[76:79]
    ds_read2_b32 v[152:153], v38 offset0:32 offset1:33
    v_mfma_f32_16x16x32_bf16 v[52:55], v[84:87], v[112:115], v[52:55]
    ds_read2_b32 v[154:155], v38 offset0:34 offset1:35
    v_mfma_f32_16x16x32_bf16 v[56:59], v[84:87], v[116:119], v[56:59]
    ds_read_b128 v[188:191], v44 offset:1664
    v_mfma_f32_16x16x32_bf16 v[60:63], v[84:87], v[120:123], v[60:63]
    ds_read2_b32 v[156:157], v39 offset0:32 offset1:33
    v_mfma_f32_16x16x32_bf16 v[64:67], v[84:87], v[124:127], v[64:67]
    ds_read2_b32 v[158:159], v39 offset0:34 offset1:35
    v_mfma_f32_16x16x32_bf16 v[68:71], v[84:87], v[128:131], v[68:71]
    ds_read_b128 v[192:195], v44 offset:2176
    v_mfma_f32_16x16x32_bf16 v[72:75], v[84:87], v[132:135], v[72:75]
    ds_read2_b32 v[160:161], v40 offset0:32 offset1:33
    v_mfma_f32_16x16x32_bf16 v[76:79], v[84:87], v[136:139], v[76:79]
    ds_read2_b32 v[162:163], v40 offset0:34 offset1:35
    v_mfma_f32_16x16x32_bf16 v[56:59], v[88:91], v[112:115], v[56:59]
    ds_read_b128 v[196:199], v44 offset:2688
    v_mfma_f32_16x16x32_bf16 v[60:63], v[88:91], v[116:119], v[60:63]
    ds_read2_b32 v[164:165], v41 offset0:32 offset1:33
    v_mfma_f32_16x16x32_bf16 v[64:67], v[88:91], v[120:123], v[64:67]
    ds_read2_b32 v[166:167], v41 offset0:34 offset1:35
    v_mfma_f32_16x16x32_bf16 v[68:71], v[88:91], v[124:127], v[68:71]
    ds_read_b128 v[200:203], v44 offset:3200
    v_mfma_f32_16x16x32_bf16 v[72:75], v[88:91], v[128:131], v[72:75]
    ds_read2_b32 v[168:169], v42 offset0:32 offset1:33
    v_mfma_f32_16x16x32_bf16 v[76:79], v[88:91], v[132:135], v[76:79]
    ds_read2_b32 v[170:171], v42 offset0:34 offset1:35
    v_mfma_f32_16x16x32_bf16 v[60:63], v[92:95], v[112:115], v[60:63]
    ds_read_b128 v[204:207], v44 offset:3712
    v_mfma_f32_16x16x32_bf16 v[64:67], v[92:95], v[116:119], v[64:67]
    ds_read2_b32 v[172:173], v43 offset0:32 offset1:33
    v_mfma_f32_16x16x32_bf16 v[68:71], v[92:95], v[120:123], v[68:71]
    ds_read2_b32 v[174:175], v43 offset0:34 offset1:35
    v_mfma_f32_16x16x32_bf16 v[72:75], v[92:95], v[124:127], v[72:75]
    v_mfma_f32_16x16x32_bf16 v[76:79], v[92:95], v[128:131], v[76:79]
    v_mfma_f32_16x16x32_bf16 v[64:67], v[96:99], v[112:115], v[64:67]
    v_mfma_f32_16x16x32_bf16 v[68:71], v[96:99], v[116:119], v[68:71]
    v_mfma_f32_16x16x32_bf16 v[72:75], v[96:99], v[120:123], v[72:75]
    v_mfma_f32_16x16x32_bf16 v[76:79], v[96:99], v[124:127], v[76:79]
    v_mfma_f32_16x16x32_bf16 v[68:71], v[100:103], v[112:115], v[68:71]
    v_mfma_f32_16x16x32_bf16 v[72:75], v[100:103], v[116:119], v[72:75]
    v_mfma_f32_16x16x32_bf16 v[76:79], v[100:103], v[120:123], v[76:79]
    v_mfma_f32_16x16x32_bf16 v[72:75], v[104:107], v[112:115], v[72:75]
    v_mfma_f32_16x16x32_bf16 v[76:79], v[104:107], v[116:119], v[76:79]
    v_mfma_f32_16x16x32_bf16 v[76:79], v[108:111], v[112:115], v[76:79]
    s_waitcnt lgkmcnt(0)
    v_mfma_f32_16x16x32_bf16 v[48:51], v[144:147], v[176:179], v[48:51]
    ds_read_b128 v[112:115], v44 offset:64
    v_mfma_f32_16x16x32_bf16 v[52:55], v[144:147], v[180:183], v[52:55]
    ds_read2_b32 v[80:81], v36 offset0:16 offset1:17
    v_mfma_f32_16x16x32_bf16 v[56:59], v[144:147], v[184:187], v[56:59]
    ds_read2_b32 v[82:83], v36 offset0:18 offset1:19
    v_mfma_f32_16x16x32_bf16 v[60:63], v[144:147], v[188:191], v[60:63]
    ds_read_b128 v[116:119], v44 offset:576
    v_mfma_f32_16x16x32_bf16 v[64:67], v[144:147], v[192:195], v[64:67]
    ds_read2_b32 v[84:85], v37 offset0:16 offset1:17
    v_mfma_f32_16x16x32_bf16 v[68:71], v[144:147], v[196:199], v[68:71]
    ds_read2_b32 v[86:87], v37 offset0:18 offset1:19
    v_mfma_f32_16x16x32_bf16 v[72:75], v[144:147], v[200:203], v[72:75]
    ds_read_b128 v[120:123], v44 offset:1088
    v_mfma_f32_16x16x32_bf16 v[76:79], v[144:147], v[204:207], v[76:79]
    ds_read2_b32 v[88:89], v38 offset0:16 offset1:17
    v_mfma_f32_16x16x32_bf16 v[52:55], v[148:151], v[176:179], v[52:55]
    ds_read2_b32 v[90:91], v38 offset0:18 offset1:19
    v_mfma_f32_16x16x32_bf16 v[56:59], v[148:151], v[180:183], v[56:59]
    ds_read_b128 v[124:127], v44 offset:1600
    v_mfma_f32_16x16x32_bf16 v[60:63], v[148:151], v[184:187], v[60:63]
    ds_read2_b32 v[92:93], v39 offset0:16 offset1:17
    v_mfma_f32_16x16x32_bf16 v[64:67], v[148:151], v[188:191], v[64:67]
    ds_read2_b32 v[94:95], v39 offset0:18 offset1:19
    v_mfma_f32_16x16x32_bf16 v[68:71], v[148:151], v[192:195], v[68:71]
    ds_read_b128 v[128:131], v44 offset:2112
    v_mfma_f32_16x16x32_bf16 v[72:75], v[148:151], v[196:199], v[72:75]
    ds_read2_b32 v[96:97], v40 offset0:16 offset1:17
    v_mfma_f32_16x16x32_bf16 v[76:79], v[148:151], v[200:203], v[76:79]
    ds_read2_b32 v[98:99], v40 offset0:18 offset1:19
    v_mfma_f32_16x16x32_bf16 v[56:59], v[152:155], v[176:179], v[56:59]
    ds_read_b128 v[132:135], v44 offset:2624
    v_mfma_f32_16x16x32_bf16 v[60:63], v[152:155], v[180:183], v[60:63]
    ds_read2_b32 v[100:101], v41 offset0:16 offset1:17
    v_mfma_f32_16x16x32_bf16 v[64:67], v[152:155], v[184:187], v[64:67]
    ds_read2_b32 v[102:103], v41 offset0:18 offset1:19
    v_mfma_f32_16x16x32_bf16 v[68:71], v[152:155], v[188:191], v[68:71]
    ds_read_b128 v[136:139], v44 offset:3136
    v_mfma_f32_16x16x32_bf16 v[72:75], v[152:155], v[192:195], v[72:75]
    ds_read2_b32 v[104:105], v42 offset0:16 offset1:17
    v_mfma_f32_16x16x32_bf16 v[76:79], v[152:155], v[196:199], v[76:79]
    ds_read2_b32 v[106:107], v42 offset0:18 offset1:19
    v_mfma_f32_16x16x32_bf16 v[60:63], v[156:159], v[176:179], v[60:63]
    ds_read_b128 v[140:143], v44 offset:3648
    v_mfma_f32_16x16x32_bf16 v[64:67], v[156:159], v[180:183], v[64:67]
    ds_read2_b32 v[108:109], v43 offset0:16 offset1:17
    v_mfma_f32_16x16x32_bf16 v[68:71], v[156:159], v[184:187], v[68:71]
    ds_read2_b32 v[110:111], v43 offset0:18 offset1:19
    v_mfma_f32_16x16x32_bf16 v[72:75], v[156:159], v[188:191], v[72:75]
    v_mfma_f32_16x16x32_bf16 v[76:79], v[156:159], v[192:195], v[76:79]
    v_mfma_f32_16x16x32_bf16 v[64:67], v[160:163], v[176:179], v[64:67]
    v_mfma_f32_16x16x32_bf16 v[68:71], v[160:163], v[180:183], v[68:71]
    v_mfma_f32_16x16x32_bf16 v[72:75], v[160:163], v[184:187], v[72:75]
    v_mfma_f32_16x16x32_bf16 v[76:79], v[160:163], v[188:191], v[76:79]
    v_mfma_f32_16x16x32_bf16 v[68:71], v[164:167], v[176:179], v[68:71]
    v_mfma_f32_16x16x32_bf16 v[72:75], v[164:167], v[180:183], v[72:75]
    v_mfma_f32_16x16x32_bf16 v[76:79], v[164:167], v[184:187], v[76:79]
    v_mfma_f32_16x16x32_bf16 v[72:75], v[168:171], v[176:179], v[72:75]
    v_mfma_f32_16x16x32_bf16 v[76:79], v[168:171], v[180:183], v[76:79]
    v_mfma_f32_16x16x32_bf16 v[76:79], v[172:175], v[176:179], v[76:79]
    s_waitcnt lgkmcnt(0)
    v_mfma_f32_16x16x32_bf16 v[48:51], v[80:83], v[112:115], v[48:51]
    ds_read_b128 v[176:179], v44 offset:0
    v_mfma_f32_16x16x32_bf16 v[52:55], v[80:83], v[116:119], v[52:55]
    ds_read2_b32 v[144:145], v36 offset0:0 offset1:1
    v_mfma_f32_16x16x32_bf16 v[56:59], v[80:83], v[120:123], v[56:59]
    ds_read2_b32 v[146:147], v36 offset0:2 offset1:3
    v_mfma_f32_16x16x32_bf16 v[60:63], v[80:83], v[124:127], v[60:63]
    ds_read_b128 v[180:183], v44 offset:512
    v_mfma_f32_16x16x32_bf16 v[64:67], v[80:83], v[128:131], v[64:67]
    ds_read2_b32 v[148:149], v37 offset0:0 offset1:1
    v_mfma_f32_16x16x32_bf16 v[68:71], v[80:83], v[132:135], v[68:71]
    ds_read2_b32 v[150:151], v37 offset0:2 offset1:3
    v_mfma_f32_16x16x32_bf16 v[72:75], v[80:83], v[136:139], v[72:75]
    ds_read_b128 v[184:187], v44 offset:1024
    v_mfma_f32_16x16x32_bf16 v[76:79], v[80:83], v[140:143], v[76:79]
    ds_read2_b32 v[152:153], v38 offset0:0 offset1:1
    v_mfma_f32_16x16x32_bf16 v[52:55], v[84:87], v[112:115], v[52:55]
    ds_read2_b32 v[154:155], v38 offset0:2 offset1:3
    v_mfma_f32_16x16x32_bf16 v[56:59], v[84:87], v[116:119], v[56:59]
    ds_read_b128 v[188:191], v44 offset:1536
    v_mfma_f32_16x16x32_bf16 v[60:63], v[84:87], v[120:123], v[60:63]
    ds_read2_b32 v[156:157], v39 offset0:0 offset1:1
    v_mfma_f32_16x16x32_bf16 v[64:67], v[84:87], v[124:127], v[64:67]
    ds_read2_b32 v[158:159], v39 offset0:2 offset1:3
    v_mfma_f32_16x16x32_bf16 v[68:71], v[84:87], v[128:131], v[68:71]
    ds_read_b128 v[192:195], v44 offset:2048
    v_mfma_f32_16x16x32_bf16 v[72:75], v[84:87], v[132:135], v[72:75]
    ds_read2_b32 v[160:161], v40 offset0:0 offset1:1
    v_mfma_f32_16x16x32_bf16 v[76:79], v[84:87], v[136:139], v[76:79]
    ds_read2_b32 v[162:163], v40 offset0:2 offset1:3
    v_mfma_f32_16x16x32_bf16 v[56:59], v[88:91], v[112:115], v[56:59]
    ds_read_b128 v[196:199], v44 offset:2560
    v_mfma_f32_16x16x32_bf16 v[60:63], v[88:91], v[116:119], v[60:63]
    ds_read2_b32 v[164:165], v41 offset0:0 offset1:1
    v_mfma_f32_16x16x32_bf16 v[64:67], v[88:91], v[120:123], v[64:67]
    ds_read2_b32 v[166:167], v41 offset0:2 offset1:3
    v_mfma_f32_16x16x32_bf16 v[68:71], v[88:91], v[124:127], v[68:71]
    ds_read_b128 v[200:203], v44 offset:3072
    v_mfma_f32_16x16x32_bf16 v[72:75], v[88:91], v[128:131], v[72:75]
    ds_read2_b32 v[168:169], v42 offset0:0 offset1:1
    v_mfma_f32_16x16x32_bf16 v[76:79], v[88:91], v[132:135], v[76:79]
    ds_read2_b32 v[170:171], v42 offset0:2 offset1:3
    v_mfma_f32_16x16x32_bf16 v[60:63], v[92:95], v[112:115], v[60:63]
    ds_read_b128 v[204:207], v44 offset:3584
    v_mfma_f32_16x16x32_bf16 v[64:67], v[92:95], v[116:119], v[64:67]
    ds_read2_b32 v[172:173], v43 offset0:0 offset1:1
    v_mfma_f32_16x16x32_bf16 v[68:71], v[92:95], v[120:123], v[68:71]
    ds_read2_b32 v[174:175], v43 offset0:2 offset1:3
    v_mfma_f32_16x16x32_bf16 v[72:75], v[92:95], v[124:127], v[72:75]
    v_mfma_f32_16x16x32_bf16 v[76:79], v[92:95], v[128:131], v[76:79]
    v_mfma_f32_16x16x32_bf16 v[64:67], v[96:99], v[112:115], v[64:67]
    v_mfma_f32_16x16x32_bf16 v[68:71], v[96:99], v[116:119], v[68:71]
    v_mfma_f32_16x16x32_bf16 v[72:75], v[96:99], v[120:123], v[72:75]
    v_mfma_f32_16x16x32_bf16 v[76:79], v[96:99], v[124:127], v[76:79]
    v_mfma_f32_16x16x32_bf16 v[68:71], v[100:103], v[112:115], v[68:71]
    v_mfma_f32_16x16x32_bf16 v[72:75], v[100:103], v[116:119], v[72:75]
    v_mfma_f32_16x16x32_bf16 v[76:79], v[100:103], v[120:123], v[76:79]
    v_mfma_f32_16x16x32_bf16 v[72:75], v[104:107], v[112:115], v[72:75]
    v_mfma_f32_16x16x32_bf16 v[76:79], v[104:107], v[116:119], v[76:79]
    v_mfma_f32_16x16x32_bf16 v[76:79], v[108:111], v[112:115], v[76:79]
    s_waitcnt lgkmcnt(0)
    v_mfma_f32_16x16x32_bf16 v[48:51], v[144:147], v[176:179], v[48:51]
    v_mfma_f32_16x16x32_bf16 v[52:55], v[144:147], v[180:183], v[52:55]
    v_mfma_f32_16x16x32_bf16 v[56:59], v[144:147], v[184:187], v[56:59]
    v_mfma_f32_16x16x32_bf16 v[60:63], v[144:147], v[188:191], v[60:63]
    v_mfma_f32_16x16x32_bf16 v[64:67], v[144:147], v[192:195], v[64:67]
    v_mfma_f32_16x16x32_bf16 v[68:71], v[144:147], v[196:199], v[68:71]
    v_mfma_f32_16x16x32_bf16 v[72:75], v[144:147], v[200:203], v[72:75]
    v_mfma_f32_16x16x32_bf16 v[76:79], v[144:147], v[204:207], v[76:79]
    v_mfma_f32_16x16x32_bf16 v[52:55], v[148:151], v[176:179], v[52:55]
    v_mfma_f32_16x16x32_bf16 v[56:59], v[148:151], v[180:183], v[56:59]
    v_mfma_f32_16x16x32_bf16 v[60:63], v[148:151], v[184:187], v[60:63]
    v_mfma_f32_16x16x32_bf16 v[64:67], v[148:151], v[188:191], v[64:67]
    v_mfma_f32_16x16x32_bf16 v[68:71], v[148:151], v[192:195], v[68:71]
    v_mfma_f32_16x16x32_bf16 v[72:75], v[148:151], v[196:199], v[72:75]
    v_mfma_f32_16x16x32_bf16 v[76:79], v[148:151], v[200:203], v[76:79]
    v_mfma_f32_16x16x32_bf16 v[56:59], v[152:155], v[176:179], v[56:59]
    v_mfma_f32_16x16x32_bf16 v[60:63], v[152:155], v[180:183], v[60:63]
    v_mfma_f32_16x16x32_bf16 v[64:67], v[152:155], v[184:187], v[64:67]
    v_mfma_f32_16x16x32_bf16 v[68:71], v[152:155], v[188:191], v[68:71]
    v_mfma_f32_16x16x32_bf16 v[72:75], v[152:155], v[192:195], v[72:75]
    v_mfma_f32_16x16x32_bf16 v[76:79], v[152:155], v[196:199], v[76:79]
    v_mfma_f32_16x16x32_bf16 v[60:63], v[156:159], v[176:179], v[60:63]
    v_mfma_f32_16x16x32_bf16 v[64:67], v[156:159], v[180:183], v[64:67]
    v_mfma_f32_16x16x32_bf16 v[68:71], v[156:159], v[184:187], v[68:71]
    v_mfma_f32_16x16x32_bf16 v[72:75], v[156:159], v[188:191], v[72:75]
    v_mfma_f32_16x16x32_bf16 v[76:79], v[156:159], v[192:195], v[76:79]
    v_mfma_f32_16x16x32_bf16 v[64:67], v[160:163], v[176:179], v[64:67]
    v_mfma_f32_16x16x32_bf16 v[68:71], v[160:163], v[180:183], v[68:71]
    v_mfma_f32_16x16x32_bf16 v[72:75], v[160:163], v[184:187], v[72:75]
    v_mfma_f32_16x16x32_bf16 v[76:79], v[160:163], v[188:191], v[76:79]
    v_mfma_f32_16x16x32_bf16 v[68:71], v[164:167], v[176:179], v[68:71]
    v_mfma_f32_16x16x32_bf16 v[72:75], v[164:167], v[180:183], v[72:75]
    v_mfma_f32_16x16x32_bf16 v[76:79], v[164:167], v[184:187], v[76:79]
    v_mfma_f32_16x16x32_bf16 v[72:75], v[168:171], v[176:179], v[72:75]
    v_mfma_f32_16x16x32_bf16 v[76:79], v[168:171], v[180:183], v[76:79]
    v_mfma_f32_16x16x32_bf16 v[76:79], v[172:175], v[176:179], v[76:79]
    s_nop 7
    v_lshlrev_b32 v5, 6, v2
    v_lshl_add_u32 v5, v3, 4, v5
    v_add_u32 v5, v5, v4
    ds_write_b128 v5, v[48:51] offset:7424
    ds_write_b128 v5, v[52:55] offset:8448
    ds_write_b128 v5, v[56:59] offset:9472
    ds_write_b128 v5, v[60:63] offset:10496
    ds_write_b128 v5, v[64:67] offset:11520
    ds_write_b128 v5, v[68:71] offset:12544
    ds_write_b128 v5, v[72:75] offset:13568
    ds_write_b128 v5, v[76:79] offset:14592
    v_mov_b64 v[8:9], v[16:17]
    v_mov_b64 v[10:11], v[18:19]
    v_mov_b64 v[12:13], v[20:21]
    v_mov_b64 v[14:15], v[22:23]
    v_mov_b32 v24, v25
    v_add_u32 v4, 65536, v4
    s_add_u32 s28, s28, 1
    s_cmp_lt_u32 s28, 2
    s_waitcnt lgkmcnt(0)
    s_cbranch_scc1 ss_pass
    s_mov_b32 s12, s74
    s_mov_b32 s13, s75
    s_mov_b32 s14, 1152
    s_mov_b32 s15, 0x20000
    s_lshl_b32 s23, s20, 1
    buffer_load_dwordx4 v[8:11], off, s[12:15], s23
    s_barrier
    v_lshlrev_b32 v5, 5, v0
    v_add_u32 v7, 65536, v5
    ds_read_b128 v[64:67], v5 offset:7424
    ds_read_b128 v[68:71], v5 offset:7440
    ds_read_b128 v[72:75], v5 offset:23808
    ds_read_b128 v[76:79], v5 offset:23824
    ds_read_b128 v[80:83], v5 offset:40192
    ds_read_b128 v[84:87], v5 offset:40208
    ds_read_b128 v[88:91], v5 offset:56576
    ds_read_b128 v[92:95], v5 offset:56592
    ds_read_b128 v[96:99], v7 offset:7424
    ds_read_b128 v[100:103], v7 offset:7440
    ds_read_b128 v[104:107], v7 offset:23808
    ds_read_b128 v[108:111], v7 offset:23824
    ds_read_b128 v[112:115], v7 offset:40192
    ds_read_b128 v[116:119], v7 offset:40208
    ds_read_b128 v[120:123], v7 offset:56576
    ds_read_b128 v[124:127], v7 offset:56592
    s_waitcnt vmcnt(0)
    v_lshlrev_b32 v12, 16, v8
    v_and_b32 v13, 0xffff0000, v8
    v_lshlrev_b32 v14, 16, v9
    v_and_b32 v15, 0xffff0000, v9
    v_lshlrev_b32 v16, 16, v10
    v_and_b32 v17, 0xffff0000, v10
    v_lshlrev_b32 v18, 16, v11
    v_and_b32 v19, 0xffff0000, v11
    v_mul_u32_u24 v5, 18432, v0
    s_lshl_b32 s22, s20, 1
    s_add_u32 s22, s22, 1152
    s_waitcnt lgkmcnt(0)
    v_lshlrev_b32 v6, 16, v208
    v_fmac_f32 v64, v6, v12
    v_and_b32 v6, 0xffff0000, v208
    v_fmac_f32 v72, v6, v13
    v_lshlrev_b32 v6, 16, v209
    v_fmac_f32 v80, v6, v14
    v_and_b32 v6, 0xffff0000, v209
    v_fmac_f32 v88, v6, v15
    v_lshlrev_b32 v6, 16, v210
    v_fmac_f32 v96, v6, v16
    v_and_b32 v6, 0xffff0000, v210
    v_fmac_f32 v104, v6, v17
    v_lshlrev_b32 v6, 16, v211
    v_fmac_f32 v112, v6, v18
    v_and_b32 v6, 0xffff0000, v211
    v_fmac_f32 v120, v6, v19
    v_cvt_pk_bf16_f32 v208, v64, v72
    v_cvt_pk_bf16_f32 v209, v80, v88
    v_cvt_pk_bf16_f32 v210, v96, v104
    v_cvt_pk_bf16_f32 v211, v112, v120
    s_add_u32 s23, s22, 0
    buffer_store_dwordx4 v[208:211], v5, s[16:19], s23 offen
    v_lshlrev_b32 v6, 16, v212
    v_fmac_f32 v65, v6, v12
    v_and_b32 v6, 0xffff0000, v212
    v_fmac_f32 v73, v6, v13
    v_lshlrev_b32 v6, 16, v213
    v_fmac_f32 v81, v6, v14
    v_and_b32 v6, 0xffff0000, v213
    v_fmac_f32 v89, v6, v15
    v_lshlrev_b32 v6, 16, v214
    v_fmac_f32 v97, v6, v16
    v_and_b32 v6, 0xffff0000, v214
    v_fmac_f32 v105, v6, v17
    v_lshlrev_b32 v6, 16, v215
    v_fmac_f32 v113, v6, v18
    v_and_b32 v6, 0xffff0000, v215
    v_fmac_f32 v121, v6, v19
    v_cvt_pk_bf16_f32 v212, v65, v73
    v_cvt_pk_bf16_f32 v213, v81, v89
    v_cvt_pk_bf16_f32 v214, v97, v105
    v_cvt_pk_bf16_f32 v215, v113, v121
    s_add_u32 s23, s22, 2304
    buffer_store_dwordx4 v[212:215], v5, s[16:19], s23 offen
    v_lshlrev_b32 v6, 16, v216
    v_fmac_f32 v66, v6, v12
    v_and_b32 v6, 0xffff0000, v216
    v_fmac_f32 v74, v6, v13
    v_lshlrev_b32 v6, 16, v217
    v_fmac_f32 v82, v6, v14
    v_and_b32 v6, 0xffff0000, v217
    v_fmac_f32 v90, v6, v15
    v_lshlrev_b32 v6, 16, v218
    v_fmac_f32 v98, v6, v16
    v_and_b32 v6, 0xffff0000, v218
    v_fmac_f32 v106, v6, v17
    v_lshlrev_b32 v6, 16, v219
    v_fmac_f32 v114, v6, v18
    v_and_b32 v6, 0xffff0000, v219
    v_fmac_f32 v122, v6, v19
    v_cvt_pk_bf16_f32 v216, v66, v74
    v_cvt_pk_bf16_f32 v217, v82, v90
    v_cvt_pk_bf16_f32 v218, v98, v106
    v_cvt_pk_bf16_f32 v219, v114, v122
    s_add_u32 s23, s22, 4608
    buffer_store_dwordx4 v[216:219], v5, s[16:19], s23 offen
    v_lshlrev_b32 v6, 16, v220
    v_fmac_f32 v67, v6, v12
    v_and_b32 v6, 0xffff0000, v220
    v_fmac_f32 v75, v6, v13
    v_lshlrev_b32 v6, 16, v221
    v_fmac_f32 v83, v6, v14
    v_and_b32 v6, 0xffff0000, v221
    v_fmac_f32 v91, v6, v15
    v_lshlrev_b32 v6, 16, v222
    v_fmac_f32 v99, v6, v16
    v_and_b32 v6, 0xffff0000, v222
    v_fmac_f32 v107, v6, v17
    v_lshlrev_b32 v6, 16, v223
    v_fmac_f32 v115, v6, v18
    v_and_b32 v6, 0xffff0000, v223
    v_fmac_f32 v123, v6, v19
    v_cvt_pk_bf16_f32 v220, v67, v75
    v_cvt_pk_bf16_f32 v221, v83, v91
    v_cvt_pk_bf16_f32 v222, v99, v107
    v_cvt_pk_bf16_f32 v223, v115, v123
    s_add_u32 s23, s22, 6912
    buffer_store_dwordx4 v[220:223], v5, s[16:19], s23 offen
    v_lshlrev_b32 v6, 16, v224
    v_fmac_f32 v68, v6, v12
    v_and_b32 v6, 0xffff0000, v224
    v_fmac_f32 v76, v6, v13
    v_lshlrev_b32 v6, 16, v225
    v_fmac_f32 v84, v6, v14
    v_and_b32 v6, 0xffff0000, v225
    v_fmac_f32 v92, v6, v15
    v_lshlrev_b32 v6, 16, v226
    v_fmac_f32 v100, v6, v16
    v_and_b32 v6, 0xffff0000, v226
    v_fmac_f32 v108, v6, v17
    v_lshlrev_b32 v6, 16, v227
    v_fmac_f32 v116, v6, v18
    v_and_b32 v6, 0xffff0000, v227
    v_fmac_f32 v124, v6, v19
    v_cvt_pk_bf16_f32 v224, v68, v76
    v_cvt_pk_bf16_f32 v225, v84, v92
    v_cvt_pk_bf16_f32 v226, v100, v108
    v_cvt_pk_bf16_f32 v227, v116, v124
    s_add_u32 s23, s22, 9216
    buffer_store_dwordx4 v[224:227], v5, s[16:19], s23 offen
    v_lshlrev_b32 v6, 16, v228
    v_fmac_f32 v69, v6, v12
    v_and_b32 v6, 0xffff0000, v228
    v_fmac_f32 v77, v6, v13
    v_lshlrev_b32 v6, 16, v229
    v_fmac_f32 v85, v6, v14
    v_and_b32 v6, 0xffff0000, v229
    v_fmac_f32 v93, v6, v15
    v_lshlrev_b32 v6, 16, v230
    v_fmac_f32 v101, v6, v16
    v_and_b32 v6, 0xffff0000, v230
    v_fmac_f32 v109, v6, v17
    v_lshlrev_b32 v6, 16, v231
    v_fmac_f32 v117, v6, v18
    v_and_b32 v6, 0xffff0000, v231
    v_fmac_f32 v125, v6, v19
    v_cvt_pk_bf16_f32 v228, v69, v77
    v_cvt_pk_bf16_f32 v229, v85, v93
    v_cvt_pk_bf16_f32 v230, v101, v109
    v_cvt_pk_bf16_f32 v231, v117, v125
    s_add_u32 s23, s22, 11520
    buffer_store_dwordx4 v[228:231], v5, s[16:19], s23 offen
    v_lshlrev_b32 v6, 16, v232
    v_fmac_f32 v70, v6, v12
    v_and_b32 v6, 0xffff0000, v232
    v_fmac_f32 v78, v6, v13
    v_lshlrev_b32 v6, 16, v233
    v_fmac_f32 v86, v6, v14
    v_and_b32 v6, 0xffff0000, v233
    v_fmac_f32 v94, v6, v15
    v_lshlrev_b32 v6, 16, v234
    v_fmac_f32 v102, v6, v16
    v_and_b32 v6, 0xffff0000, v234
    v_fmac_f32 v110, v6, v17
    v_lshlrev_b32 v6, 16, v235
    v_fmac_f32 v118, v6, v18
    v_and_b32 v6, 0xffff0000, v235
    v_fmac_f32 v126, v6, v19
    v_cvt_pk_bf16_f32 v232, v70, v78
    v_cvt_pk_bf16_f32 v233, v86, v94
    v_cvt_pk_bf16_f32 v234, v102, v110
    v_cvt_pk_bf16_f32 v235, v118, v126
    s_add_u32 s23, s22, 13824
    buffer_store_dwordx4 v[232:235], v5, s[16:19], s23 offen
    v_lshlrev_b32 v6, 16, v236
    v_fmac_f32 v71, v6, v12
    v_and_b32 v6, 0xffff0000, v236
    v_fmac_f32 v79, v6, v13
    v_lshlrev_b32 v6, 16, v237
    v_fmac_f32 v87, v6, v14
    v_and_b32 v6, 0xffff0000, v237
    v_fmac_f32 v95, v6, v15
    v_lshlrev_b32 v6, 16, v238
    v_fmac_f32 v103, v6, v16
    v_and_b32 v6, 0xffff0000, v238
    v_fmac_f32 v111, v6, v17
    v_lshlrev_b32 v6, 16, v239
    v_fmac_f32 v119, v6, v18
    v_and_b32 v6, 0xffff0000, v239
    v_fmac_f32 v127, v6, v19
    v_cvt_pk_bf16_f32 v236, v71, v79
    v_cvt_pk_bf16_f32 v237, v87, v95
    v_cvt_pk_bf16_f32 v238, v103, v111
    v_cvt_pk_bf16_f32 v239, v119, v127
    s_add_u32 s23, s22, 16128
    buffer_store_dwordx4 v[236:239], v5, s[16:19], s23 offen
    s_branch L_ssm_next
L_ssm_done:
    s_cmp_lt_u32 s93, 100
    s_cbranch_scc1 L_exit
    s_mov_b32 s8, s76
    s_mov_b32 s9, s77
    s_mov_b32 s10, 4718592
    s_mov_b32 s11, 0x20000
    s_cmp_le_u32 s45, 1
    s_cbranch_scc1 L_att_next
    s_branch L_op_nextcb
L_wf_next:
    s_mov_b32 s37, 20
    v_mov_b32 v250, 1
    v_mov_b32 v251, 163832
    v_cmp_eq_u32 vcc, 0, v0
    s_nop 0
    s_and_saveexec_b64 s[38:39], vcc
    s_cbranch_execz tk12
    buffer_atomic_add v250, off, s[84:87], s37 sc0
    s_waitcnt vmcnt(0)
    ds_write_b32 v251, v250
    s_waitcnt lgkmcnt(0)
tk12:
    s_mov_b64 exec, -1
    s_barrier
    ds_read_b32 v252, v251
    s_waitcnt lgkmcnt(0)
    v_readfirstlane_b32 s33, v252
    s_barrier
    s_nop 3
    s_cmp_ge_u32 s33, 160
    s_cbranch_scc1 L_ssm_next
    s_lshl_b32 s16, s33, 2
    s_add_u32 s16, s16, s32
    s_add_u32 s16, s16, 1504
    s_call_b64 s[46:47], L_xform
    s_lshl_b32 s40, s33, 2
    s_add_u32 s40, s40, 125841408
    s_waitcnt vmcnt(0)
    s_barrier
    v_mov_b32 v250, s95
    v_cmp_eq_u32 vcc, 0, v0
    s_nop 0
    s_and_saveexec_b64 s[38:39], vcc
    s_cbranch_execz fs13
    buffer_store_dword v250, off, s[4:7], s40 sc1
fs13:
    s_mov_b64 exec, -1
    s_branch L_wf_next
L_phase2:
    s_mov_b32 s40, 524288
mc2_w:
    buffer_load_dword v250, off, s[84:87], 0 offset:28 sc1
    s_waitcnt vmcnt(0)
    v_readfirstlane_b32 s41, v250
    s_nop 0
    s_cmp_lg_u32 s41, 0
    s_cbranch_scc1 mc2_known
    s_sub_u32 s40, s40, 1
    s_cbranch_scc1 mc2_force
    s_sleep 2
    s_branch mc2_w
mc2_force:
    v_mov_b32 v250, 2
    v_mov_b32 v251, 0
    s_mov_b64 exec, 1
    buffer_atomic_cmpswap v[250:251], off, s[84:87], 0 offset:28
    s_mov_b64 exec, -1
    s_waitcnt vmcnt(0)
    s_mov_b32 s40, 524288
    s_branch mc2_w
mc2_known:
    s_cmp_eq_u32 s41, 1
    s_cbranch_scc1 L_phase2b
    s_mov_b32 s37, 208
    v_mov_b32 v250, 1
    v_mov_b32 v251, 163832
    v_cmp_eq_u32 vcc, 0, v0
    s_nop 0
    s_and_saveexec_b64 s[38:39], vcc
    s_cbranch_execz tk14
    buffer_atomic_add v250, off, s[84:87], s37 sc0
    s_waitcnt vmcnt(0)
    ds_write_b32 v251, v250
    s_waitcnt lgkmcnt(0)
tk14:
    s_mov_b64 exec, -1
    s_barrier
    ds_read_b32 v252, v251
    s_waitcnt lgkmcnt(0)
    v_readfirstlane_b32 s12, v252
    s_barrier
    s_nop 3
    s_cmp_lt_u32 s12, 32
    s_cbranch_scc1 L_chain_safe
    s_sub_u32 s45, s12, 32
L_phase2b:
    s_mov_b32 s8, s76
    s_mov_b32 s9, s77
    s_mov_b32 s10, 4718592
    s_mov_b32 s11, 0x20000
    s_and_b32 s36, s45, 15
    s_bitcmp1_b32 42315, s36
    s_cbranch_scc0 L_nots
    s_cmp_eq_u32 s93, 500
    s_cbranch_scc1 L_ssm_next
    s_branch L_wf_next
L_nots:
    s_bitcmp1_b32 18576, s36
    s_cbranch_scc0 L_att_next
    s_bfm_b32 s37, s36, 0
    s_and_b32 s37, s37, 18576
    s_bcnt1_i32_b32 s37, s37
    s_lshr_b32 s40, s45, 4
    s_mul_i32 s40, s40, 4
    s_add_u32 s33, s40, s37
L_op_mod:
    s_mul_hi_u32 s41, s33, 0x0e38e38f
    s_mul_i32 s41, s41, 18
    s_sub_u32 s33, s33, s41
    s_branch L_op_start
L_att_next:
    s_mov_b32 s37, 16
    v_mov_b32 v250, 1
    v_mov_b32 v251, 163832
    v_cmp_eq_u32 vcc, 0, v0
    s_nop 0
    s_and_saveexec_b64 s[38:39], vcc
    s_cbranch_execz tk15
    buffer_atomic_add v250, off, s[84:87], s37 sc0
    s_waitcnt vmcnt(0)
    ds_write_b32 v251, v250
    s_waitcnt lgkmcnt(0)
tk15:
    s_mov_b64 exec, -1
    s_barrier
    ds_read_b32 v252, v251
    s_waitcnt lgkmcnt(0)
    v_readfirstlane_b32 s34, v252
    s_barrier
    s_nop 3
    s_cmp_ge_u32 s34, 512
    s_cbranch_scc1 L_op_nextcb
    s_lshr_b32 s16, s34, 3
    s_and_b32 s17, s34, 7
    s_lshl_b32 s17, s17, 2
    s_add_u32 s17, s17, s32
    s_lshl_b32 s36, s17, 7
    s_add_u32 s36, s36, 125829120
    s_lshr_b32 s41, s16, 2
    s_add_u32 s41, s41, s95
    s_add_u32 s41, s41, 1
    v_and_b32 v1, 3, v0
    v_min_u32 v1, 2, v1
    v_lshlrev_b32 v2, 4, v1
    s_and_b32 s37, s16, 3
    s_lshl_b32 s37, s37, 2
    v_add_u32 v2, s37, v2
    s_mov_b32 s40, 4194304
L_aw1:
    buffer_load_dword v3, v2, s[4:7], s36 offen sc1
    s_sub_u32 s40, s40, 1
    s_cbranch_scc1 L_aw1_go
    s_waitcnt vmcnt(0)
    v_subrev_u32 v3, s41, v3
    v_cmp_lt_u32 vcc, 64, v3
    s_cbranch_vccz L_aw1_go
    s_sleep 4
    s_branch L_aw1
L_aw1_go:
    v_and_b32 v5, 63, v0
    v_lshlrev_b32 v1, 4, v5
    s_cmp_ge_u32 s16, 56
    s_cselect_b32 s18, -1, 511
    v_and_b32 v2, s18, v1
    v_or_b32 v3, 128, v1
    v_lshrrev_b32 v4, 4, v5
    v_bfe_u32 v6, v5, 2, 2
    v_sub_u32 v4, v6, v4
    v_lshlrev_b32 v4, 3, v4
    v_and_b32 v6, 3, v5
    v_add_u32 v4, v4, v6
    v_mov_b32 v6, 0xf149f2ca
    s_mov_b32 s22, 0x3e0293ee
    s_lshl_b32 s18, s16, 5
    s_add_u32 s18, s18, s17
    s_lshl_b32 s19, s18, 13
    s_add_u32 s20, s19, 33554432
    buffer_load_dwordx4 v[8:11], v1, s[4:7], s20 offen offset:0 sc1
    s_add_u32 s20, s19, 33554432
    buffer_load_dwordx4 v[12:15], v1, s[4:7], s20 offen offset:1024 sc1
    s_add_u32 s20, s19, 33554432
    buffer_load_dwordx4 v[16:19], v1, s[4:7], s20 offen offset:2048 sc1
    s_add_u32 s20, s19, 33554432
    buffer_load_dwordx4 v[20:23], v1, s[4:7], s20 offen offset:3072 sc1
    s_add_u32 s20, s19, 33558528
    buffer_load_dwordx4 v[24:27], v1, s[4:7], s20 offen offset:0 sc1
    s_add_u32 s20, s19, 33558528
    buffer_load_dwordx4 v[28:31], v1, s[4:7], s20 offen offset:1024 sc1
    s_add_u32 s20, s19, 33558528
    buffer_load_dwordx4 v[32:35], v1, s[4:7], s20 offen offset:2048 sc1
    s_add_u32 s20, s19, 33558528
    buffer_load_dwordx4 v[36:39], v1, s[4:7], s20 offen offset:3072 sc1
    s_lshl_b32 s21, s18, 14
    s_add_u32 s20, s21, 0
    buffer_load_dwordx4 v[40:43], v1, s[4:7], s20 offen offset:0 sc1
    s_add_u32 s20, s21, 4096
    buffer_load_dwordx4 v[44:47], v1, s[4:7], s20 offen offset:0 sc1
    s_add_u32 s20, s21, 8192
    buffer_load_dwordx4 v[48:51], v1, s[4:7], s20 offen offset:0 sc1
    s_add_u32 s20, s21, 12288
    buffer_load_dwordx4 v[52:55], v1, s[4:7], s20 offen offset:0 sc1
    s_add_u32 s20, s21, 0
    buffer_load_dwordx4 v[56:59], v1, s[4:7], s20 offen offset:1024 sc1
    s_add_u32 s20, s21, 4096
    buffer_load_dwordx4 v[60:63], v1, s[4:7], s20 offen offset:1024 sc1
    s_add_u32 s20, s21, 8192
    buffer_load_dwordx4 v[64:67], v1, s[4:7], s20 offen offset:1024 sc1
    s_add_u32 s20, s21, 12288
    buffer_load_dwordx4 v[68:71], v1, s[4:7], s20 offen offset:1024 sc1
    s_add_u32 s20, s21, 0
    buffer_load_dwordx4 v[88:91], v1, s[4:7], s20 offen offset:2048 sc1
    s_add_u32 s20, s21, 4096
    buffer_load_dwordx4 v[92:95], v1, s[4:7], s20 offen offset:2048 sc1
    s_add_u32 s20, s21, 8192
    buffer_load_dwordx4 v[96:99], v1, s[4:7], s20 offen offset:2048 sc1
    s_add_u32 s20, s21, 12288
    buffer_load_dwordx4 v[100:103], v1, s[4:7], s20 offen offset:2048 sc1
    s_add_u32 s20, s21, 0
    buffer_load_dwordx4 v[104:107], v1, s[4:7], s20 offen offset:3072 sc1
    s_add_u32 s20, s21, 4096
    buffer_load_dwordx4 v[108:111], v1, s[4:7], s20 offen offset:3072 sc1
    s_add_u32 s20, s21, 8192
    buffer_load_dwordx4 v[112:115], v1, s[4:7], s20 offen offset:3072 sc1
    s_add_u32 s20, s21, 12288
    buffer_load_dwordx4 v[116:119], v1, s[4:7], s20 offen offset:3072 sc1
    v_mov_b32 v172, 0x3f803f80
    v_mov_b32 v173, 0x3f803f80
    v_mov_b32 v174, 0x3f803f80
    v_mov_b32 v175, 0x3f803f80
    v_mov_b32 v176, 0x3f003f00
    v_mov_b32 v177, 0x3f003f00
    s_waitcnt vmcnt(8)
    v_mfma_f32_16x16x32_bf16 v[136:139], v[40:43], v[8:11], 0
    v_mfma_f32_16x16x32_bf16 v[140:143], v[56:59], v[8:11], 0
    v_mfma_f32_16x16x32_bf16 v[148:151], v[40:43], v[24:27], 0
    v_mfma_f32_16x16x32_bf16 v[152:155], v[56:59], v[24:27], 0
    v_mfma_f32_16x16x32_bf16 v[136:139], v[44:47], v[12:15], v[136:139]
    v_mfma_f32_16x16x32_bf16 v[140:143], v[60:63], v[12:15], v[140:143]
    v_mfma_f32_16x16x32_bf16 v[148:151], v[44:47], v[28:31], v[148:151]
    v_mfma_f32_16x16x32_bf16 v[152:155], v[60:63], v[28:31], v[152:155]
    v_mfma_f32_16x16x32_bf16 v[136:139], v[48:51], v[16:19], v[136:139]
    v_mfma_f32_16x16x32_bf16 v[140:143], v[64:67], v[16:19], v[140:143]
    v_mfma_f32_16x16x32_bf16 v[148:151], v[48:51], v[32:35], v[148:151]
    v_mfma_f32_16x16x32_bf16 v[152:155], v[64:67], v[32:35], v[152:155]
    v_mfma_f32_16x16x32_bf16 v[136:139], v[52:55], v[20:23], v[136:139]
    v_mfma_f32_16x16x32_bf16 v[140:143], v[68:71], v[20:23], v[140:143]
    v_mfma_f32_16x16x32_bf16 v[148:151], v[52:55], v[36:39], v[148:151]
    v_mfma_f32_16x16x32_bf16 v[152:155], v[68:71], v[36:39], v[152:155]
    v_cmp_le_i32 vcc, 0, v4
    s_nop 3
    v_cndmask_b32 v136, v6, v136, vcc
    v_cmp_le_i32 vcc, 1, v4
    s_nop 1
    v_cndmask_b32 v137, v6, v137, vcc
    v_cmp_le_i32 vcc, 2, v4
    s_nop 1
    v_cndmask_b32 v138, v6, v138, vcc
    v_cmp_le_i32 vcc, 3, v4
    s_nop 1
    v_cndmask_b32 v139, v6, v139, vcc
    v_cmp_le_i32 vcc, 4, v4
    s_nop 1
    v_cndmask_b32 v140, v6, v140, vcc
    v_cmp_le_i32 vcc, 5, v4
    s_nop 1
    v_cndmask_b32 v141, v6, v141, vcc
    v_cmp_le_i32 vcc, 6, v4
    s_nop 1
    v_cndmask_b32 v142, v6, v142, vcc
    v_cmp_le_i32 vcc, 7, v4
    s_nop 1
    v_cndmask_b32 v143, v6, v143, vcc
    v_cmp_le_i32 vcc, -4, v4
    s_nop 1
    v_cndmask_b32 v148, v6, v148, vcc
    v_cmp_le_i32 vcc, -3, v4
    s_nop 1
    v_cndmask_b32 v149, v6, v149, vcc
    v_cmp_le_i32 vcc, -2, v4
    s_nop 1
    v_cndmask_b32 v150, v6, v150, vcc
    v_cmp_le_i32 vcc, -1, v4
    s_nop 1
    v_cndmask_b32 v151, v6, v151, vcc
    v_cmp_le_i32 vcc, 0, v4
    s_nop 1
    v_cndmask_b32 v152, v6, v152, vcc
    v_cmp_le_i32 vcc, 1, v4
    s_nop 1
    v_cndmask_b32 v153, v6, v153, vcc
    v_cmp_le_i32 vcc, 2, v4
    s_nop 1
    v_cndmask_b32 v154, v6, v154, vcc
    v_cmp_le_i32 vcc, 3, v4
    s_nop 1
    v_cndmask_b32 v155, v6, v155, vcc
    s_nop 1
    v_and_b32 v198, 1, v0
    v_lshlrev_b32 v198, 2, v198
    v_add_u32 v198, 48, v198
    s_add_u32 s41, s16, s95
    s_add_u32 s41, s41, 1
    s_cmp_lt_u32 s16, 56
    s_cbranch_scc1 L_amk
    v_mov_b32 v198, 16384
    s_sub_u32 s41, s41, 1
    s_mov_b32 s44, 8
L_amk:
    s_sub_u32 s43, s41, s95
    s_sub_u32 s43, s43, 1
    s_mov_b32 s88, 65536
    s_mov_b32 s89, 125853696
cw16:
    buffer_load_dword v199, off, s[4:7], s89 sc1
    s_waitcnt vmcnt(0)
    v_readfirstlane_b32 s42, v199
    s_nop 0
    s_sub_u32 s42, s42, s95
    s_cmp_gt_u32 s42, 64
    s_cselect_b32 s42, 0, s42
    s_add_u32 s42, s42, 1
    s_cmp_ge_u32 s42, s43
    s_cbranch_scc1 cw16x
    s_sub_u32 s88, s88, 1
    s_cbranch_scc1 cw16x
    s_sub_u32 s42, s43, s42
    s_min_u32 s42, s42, 6
cw16s:
    s_sleep 24
    s_sub_u32 s42, s42, 1
    s_cmp_lg_u32 s42, 0
    s_cbranch_scc1 cw16s
    s_branch cw16
cw16x:
    s_mov_b32 s40, 4194304
L_aw2:
    buffer_load_dword v199, v198, s[4:7], s36 offen sc1
    s_sub_u32 s40, s40, 1
    s_cbranch_scc1 L_aw2_go
    s_waitcnt vmcnt(0)
    v_subrev_u32 v199, s41, v199
    v_cmp_lt_u32 vcc, 64, v199
    s_cbranch_vccz L_aw2_go
    s_sleep 1
    s_branch L_aw2
L_aw2_go:
at_ldm:
    s_lshl_b32 s20, s18, 12
    s_add_u32 s20, s20, 69206016
    buffer_load_dwordx4 v[72:75], v3, s[4:7], s20 offen offset:0 sc1
    buffer_load_dwordx4 v[76:79], v3, s[4:7], s20 offen offset:1024 sc1
    buffer_load_dwordx4 v[80:83], v3, s[4:7], s20 offen offset:2048 sc1
    buffer_load_dwordx4 v[84:87], v3, s[4:7], s20 offen offset:3072 sc1
    s_lshl_b32 s20, s18, 12
    s_add_u32 s20, s20, 77594624
    buffer_load_dwordx4 v[120:123], v2, s[4:7], s20 offen offset:0 sc1
    buffer_load_dwordx4 v[124:127], v2, s[4:7], s20 offen offset:1024 sc1
    buffer_load_dwordx4 v[128:131], v2, s[4:7], s20 offen offset:2048 sc1
    buffer_load_dwordx4 v[132:135], v2, s[4:7], s20 offen offset:3072 sc1
    s_cmp_lt_u32 s16, 56
    s_cbranch_scc1 at_ok
    s_waitcnt vmcnt(0)
    v_max_u32 v196, v72, v73
    v_max3_u32 v196, v196, v74, v75
    v_max3_u32 v196, v196, v76, v77
    v_max3_u32 v196, v196, v78, v79
    v_max3_u32 v196, v196, v80, v81
    v_max3_u32 v196, v196, v82, v83
    v_max3_u32 v196, v196, v84, v85
    v_max3_u32 v196, v196, v86, v87
    v_max3_u32 v196, v196, v120, v121
    v_max3_u32 v196, v196, v122, v123
    v_max3_u32 v196, v196, v124, v125
    v_max3_u32 v196, v196, v126, v127
    v_max3_u32 v196, v196, v128, v129
    v_max3_u32 v196, v196, v130, v131
    v_max3_u32 v196, v196, v132, v133
    v_max3_u32 v196, v196, v134, v135
    v_cmp_eq_u32 vcc, -1, v196
    s_cbranch_vccz at_ok
    s_sub_u32 s44, s44, 1
    s_cbranch_scc1 at_ok
    s_cmp_lg_u32 s44, 0
    s_cbranch_scc1 at_ldm
    s_add_u32 s41, s41, 1
    s_mov_b32 s40, 4194304
L_aw3:
    buffer_load_dword v199, v198, s[4:7], s36 offen sc1
    s_sub_u32 s40, s40, 1
    s_cbranch_scc1 L_aw3_go
    s_waitcnt vmcnt(0)
    v_subrev_u32 v199, s41, v199
    v_cmp_lt_u32 vcc, 64, v199
    s_cbranch_vccz L_aw3_go
    s_sleep 1
    s_branch L_aw3
L_aw3_go:
    s_branch at_ldm
at_ok:
    s_waitcnt vmcnt(4)
    v_mfma_f32_16x16x32_bf16 v[144:147], v[72:75], v[8:11], 0
    v_mfma_f32_16x16x32_bf16 v[156:159], v[72:75], v[24:27], 0
    v_mfma_f32_16x16x32_bf16 v[144:147], v[76:79], v[12:15], v[144:147]
    v_mfma_f32_16x16x32_bf16 v[156:159], v[76:79], v[28:31], v[156:159]
    v_mfma_f32_16x16x32_bf16 v[144:147], v[80:83], v[16:19], v[144:147]
    v_mfma_f32_16x16x32_bf16 v[156:159], v[80:83], v[32:35], v[156:159]
    v_mfma_f32_16x16x32_bf16 v[144:147], v[84:87], v[20:23], v[144:147]
    v_mfma_f32_16x16x32_bf16 v[156:159], v[84:87], v[36:39], v[156:159]
    v_max3_f32 v196, v136, v137, v138
    v_max3_f32 v197, v139, v140, v141
    v_max3_f32 v196, v196, v142, v143
    s_nop 3
    v_max3_f32 v197, v197, v144, v145
    v_max3_f32 v196, v196, v146, v147
    v_max_f32 v196, v196, v197
    v_mov_b32 v197, v196
    s_nop 1
    v_permlane32_swap_b32 v196, v197
    v_max_f32 v196, v196, v197
    v_mov_b32 v197, v196
    s_nop 1
    v_permlane16_swap_b32 v196, v197
    v_max_f32 v196, v196, v197
    v_mul_f32 v196, s22, v196
    v_sub_f32 v196, 0, v196
    v_fma_f32 v136, v136, s22, v196
    v_fma_f32 v137, v137, s22, v196
    v_fma_f32 v138, v138, s22, v196
    v_fma_f32 v139, v139, s22, v196
    v_fma_f32 v140, v140, s22, v196
    v_fma_f32 v141, v141, s22, v196
    v_fma_f32 v142, v142, s22, v196
    v_fma_f32 v143, v143, s22, v196
    v_fma_f32 v144, v144, s22, v196
    v_fma_f32 v145, v145, s22, v196
    v_fma_f32 v146, v146, s22, v196
    v_fma_f32 v147, v147, s22, v196
    v_exp_f32 v136, v136
    v_exp_f32 v137, v137
    v_exp_f32 v138, v138
    v_exp_f32 v139, v139
    v_exp_f32 v140, v140
    v_exp_f32 v141, v141
    v_exp_f32 v142, v142
    v_exp_f32 v143, v143
    v_exp_f32 v144, v144
    v_exp_f32 v145, v145
    v_exp_f32 v146, v146
    v_exp_f32 v147, v147
    v_cvt_pk_bf16_f32 v160, v136, v137
    v_cvt_pk_bf16_f32 v161, v138, v139
    v_cvt_pk_bf16_f32 v162, v140, v141
    v_cvt_pk_bf16_f32 v163, v142, v143
    v_cvt_pk_bf16_f32 v164, v144, v145
    v_cvt_pk_bf16_f32 v165, v146, v147
    v_max3_f32 v196, v148, v149, v150
    v_max3_f32 v197, v151, v152, v153
    v_max3_f32 v196, v196, v154, v155
    v_max3_f32 v197, v197, v156, v157
    v_max3_f32 v196, v196, v158, v159
    v_max_f32 v196, v196, v197
    v_mov_b32 v197, v196
    s_nop 1
    v_permlane32_swap_b32 v196, v197
    v_max_f32 v196, v196, v197
    v_mov_b32 v197, v196
    s_nop 1
    v_permlane16_swap_b32 v196, v197
    v_max_f32 v196, v196, v197
    v_mul_f32 v196, s22, v196
    v_sub_f32 v196, 0, v196
    v_fma_f32 v148, v148, s22, v196
    v_fma_f32 v149, v149, s22, v196
    v_fma_f32 v150, v150, s22, v196
    v_fma_f32 v151, v151, s22, v196
    v_fma_f32 v152, v152, s22, v196
    v_fma_f32 v153, v153, s22, v196
    v_fma_f32 v154, v154, s22, v196
    v_fma_f32 v155, v155, s22, v196
    v_fma_f32 v156, v156, s22, v196
    v_fma_f32 v157, v157, s22, v196
    v_fma_f32 v158, v158, s22, v196
    v_fma_f32 v159, v159, s22, v196
    v_exp_f32 v148, v148
    v_exp_f32 v149, v149
    v_exp_f32 v150, v150
    v_exp_f32 v151, v151
    v_exp_f32 v152, v152
    v_exp_f32 v153, v153
    v_exp_f32 v154, v154
    v_exp_f32 v155, v155
    v_exp_f32 v156, v156
    v_exp_f32 v157, v157
    v_exp_f32 v158, v158
    v_exp_f32 v159, v159
    v_cvt_pk_bf16_f32 v166, v148, v149
    v_cvt_pk_bf16_f32 v167, v150, v151
    v_cvt_pk_bf16_f32 v168, v152, v153
    v_cvt_pk_bf16_f32 v169, v154, v155
    v_cvt_pk_bf16_f32 v170, v156, v157
    v_cvt_pk_bf16_f32 v171, v158, v159
    v_mfma_f32_16x16x32_bf16 v[180:183], v[172:175], v[160:163], 0
    v_mfma_f32_16x16x32_bf16 v[184:187], v[172:175], v[166:169], 0
    s_nop 4
    v_mfma_f32_16x16x16_bf16 v[180:183], v[176:177], v[164:165], v[180:183]
    v_mfma_f32_16x16x16_bf16 v[184:187], v[176:177], v[170:171], v[184:187]
    s_nop 6
    v_rcp_f32 v180, v180
    v_rcp_f32 v184, v184
    s_waitcnt vmcnt(0)
    s_lshl_b32 s18, s16, 18
    s_lshl_b32 s19, s17, 12
    s_add_u32 s18, s18, s19
    s_add_u32 s18, s18, 50331648
    s_add_u32 s19, s18, 131072
    v_mfma_f32_16x16x32_bf16 v[8:11], v[88:91], v[160:163], 0
    v_mfma_f32_16x16x32_bf16 v[12:15], v[104:107], v[160:163], 0
    v_mfma_f32_16x16x32_bf16 v[16:19], v[88:91], v[166:169], 0
    v_mfma_f32_16x16x32_bf16 v[20:23], v[104:107], v[166:169], 0
    v_mfma_f32_16x16x32_bf16 v[24:27], v[92:95], v[160:163], 0
    v_mfma_f32_16x16x32_bf16 v[28:31], v[108:111], v[160:163], 0
    v_mfma_f32_16x16x32_bf16 v[32:35], v[92:95], v[166:169], 0
    v_mfma_f32_16x16x32_bf16 v[36:39], v[108:111], v[166:169], 0
    v_mfma_f32_16x16x32_bf16 v[40:43], v[96:99], v[160:163], 0
    v_mfma_f32_16x16x32_bf16 v[44:47], v[112:115], v[160:163], 0
    v_mfma_f32_16x16x32_bf16 v[48:51], v[96:99], v[166:169], 0
    v_mfma_f32_16x16x32_bf16 v[52:55], v[112:115], v[166:169], 0
    v_mfma_f32_16x16x32_bf16 v[56:59], v[100:103], v[160:163], 0
    v_mfma_f32_16x16x32_bf16 v[60:63], v[116:119], v[160:163], 0
    v_mfma_f32_16x16x32_bf16 v[64:67], v[100:103], v[166:169], 0
    v_mfma_f32_16x16x32_bf16 v[68:71], v[116:119], v[166:169], 0
    v_mfma_f32_16x16x16_bf16 v[8:11], v[120:121], v[164:165], v[8:11]
    v_mfma_f32_16x16x16_bf16 v[12:15], v[122:123], v[164:165], v[12:15]
    v_mfma_f32_16x16x16_bf16 v[16:19], v[120:121], v[170:171], v[16:19]
    v_mfma_f32_16x16x16_bf16 v[20:23], v[122:123], v[170:171], v[20:23]
    v_mfma_f32_16x16x16_bf16 v[24:27], v[124:125], v[164:165], v[24:27]
    v_mfma_f32_16x16x16_bf16 v[28:31], v[126:127], v[164:165], v[28:31]
    v_mfma_f32_16x16x16_bf16 v[32:35], v[124:125], v[170:171], v[32:35]
    v_mfma_f32_16x16x16_bf16 v[36:39], v[126:127], v[170:171], v[36:39]
    v_mfma_f32_16x16x16_bf16 v[40:43], v[128:129], v[164:165], v[40:43]
    v_mfma_f32_16x16x16_bf16 v[44:47], v[130:131], v[164:165], v[44:47]
    v_mfma_f32_16x16x16_bf16 v[48:51], v[128:129], v[170:171], v[48:51]
    v_mfma_f32_16x16x16_bf16 v[52:55], v[130:131], v[170:171], v[52:55]
    v_mfma_f32_16x16x16_bf16 v[56:59], v[132:133], v[164:165], v[56:59]
    v_mfma_f32_16x16x16_bf16 v[60:63], v[134:135], v[164:165], v[60:63]
    v_mfma_f32_16x16x16_bf16 v[64:67], v[132:133], v[170:171], v[64:67]
    v_mfma_f32_16x16x16_bf16 v[68:71], v[134:135], v[170:171], v[68:71]
    v_mul_f32 v8, v8, v180
    v_mul_f32 v12, v12, v180
    v_mul_f32 v9, v9, v180
    v_mul_f32 v13, v13, v180
    v_mul_f32 v10, v10, v180
    v_mul_f32 v14, v14, v180
    v_mul_f32 v11, v11, v180
    v_mul_f32 v15, v15, v180
    v_cvt_pk_bf16_f32 v8, v8, v9
    v_cvt_pk_bf16_f32 v9, v10, v11
    v_cvt_pk_bf16_f32 v10, v12, v13
    v_cvt_pk_bf16_f32 v11, v14, v15
    buffer_store_dwordx4 v[8:11], v1, s[4:7], s18 offen offset:0 sc1
    v_mul_f32 v16, v16, v184
    v_mul_f32 v20, v20, v184
    v_mul_f32 v17, v17, v184
    v_mul_f32 v21, v21, v184
    v_mul_f32 v18, v18, v184
    v_mul_f32 v22, v22, v184
    v_mul_f32 v19, v19, v184
    v_mul_f32 v23, v23, v184
    v_cvt_pk_bf16_f32 v16, v16, v17
    v_cvt_pk_bf16_f32 v17, v18, v19
    v_cvt_pk_bf16_f32 v18, v20, v21
    v_cvt_pk_bf16_f32 v19, v22, v23
    buffer_store_dwordx4 v[16:19], v1, s[4:7], s19 offen offset:0 sc1
    v_mul_f32 v24, v24, v180
    v_mul_f32 v28, v28, v180
    v_mul_f32 v25, v25, v180
    v_mul_f32 v29, v29, v180
    v_mul_f32 v26, v26, v180
    v_mul_f32 v30, v30, v180
    v_mul_f32 v27, v27, v180
    v_mul_f32 v31, v31, v180
    v_cvt_pk_bf16_f32 v24, v24, v25
    v_cvt_pk_bf16_f32 v25, v26, v27
    v_cvt_pk_bf16_f32 v26, v28, v29
    v_cvt_pk_bf16_f32 v27, v30, v31
    buffer_store_dwordx4 v[24:27], v1, s[4:7], s18 offen offset:1024 sc1
    v_mul_f32 v32, v32, v184
    v_mul_f32 v36, v36, v184
    v_mul_f32 v33, v33, v184
    v_mul_f32 v37, v37, v184
    v_mul_f32 v34, v34, v184
    v_mul_f32 v38, v38, v184
    v_mul_f32 v35, v35, v184
    v_mul_f32 v39, v39, v184
    v_cvt_pk_bf16_f32 v32, v32, v33
    v_cvt_pk_bf16_f32 v33, v34, v35
    v_cvt_pk_bf16_f32 v34, v36, v37
    v_cvt_pk_bf16_f32 v35, v38, v39
    buffer_store_dwordx4 v[32:35], v1, s[4:7], s19 offen offset:1024 sc1
    v_mul_f32 v40, v40, v180
    v_mul_f32 v44, v44, v180
    v_mul_f32 v41, v41, v180
    v_mul_f32 v45, v45, v180
    v_mul_f32 v42, v42, v180
    v_mul_f32 v46, v46, v180
    v_mul_f32 v43, v43, v180
    v_mul_f32 v47, v47, v180
    v_cvt_pk_bf16_f32 v40, v40, v41
    v_cvt_pk_bf16_f32 v41, v42, v43
    v_cvt_pk_bf16_f32 v42, v44, v45
    v_cvt_pk_bf16_f32 v43, v46, v47
    buffer_store_dwordx4 v[40:43], v1, s[4:7], s18 offen offset:2048 sc1
    v_mul_f32 v48, v48, v184
    v_mul_f32 v52, v52, v184
    v_mul_f32 v49, v49, v184
    v_mul_f32 v53, v53, v184
    v_mul_f32 v50, v50, v184
    v_mul_f32 v54, v54, v184
    v_mul_f32 v51, v51, v184
    v_mul_f32 v55, v55, v184
    v_cvt_pk_bf16_f32 v48, v48, v49
    v_cvt_pk_bf16_f32 v49, v50, v51
    v_cvt_pk_bf16_f32 v50, v52, v53
    v_cvt_pk_bf16_f32 v51, v54, v55
    buffer_store_dwordx4 v[48:51], v1, s[4:7], s19 offen offset:2048 sc1
    v_mul_f32 v56, v56, v180
    v_mul_f32 v60, v60, v180
    v_mul_f32 v57, v57, v180
    v_mul_f32 v61, v61, v180
    v_mul_f32 v58, v58, v180
    v_mul_f32 v62, v62, v180
    v_mul_f32 v59, v59, v180
    v_mul_f32 v63, v63, v180
    v_cvt_pk_bf16_f32 v56, v56, v57
    v_cvt_pk_bf16_f32 v57, v58, v59
    v_cvt_pk_bf16_f32 v58, v60, v61
    v_cvt_pk_bf16_f32 v59, v62, v63
    buffer_store_dwordx4 v[56:59], v1, s[4:7], s18 offen offset:3072 sc1
    v_mul_f32 v64, v64, v184
    v_mul_f32 v68, v68, v184
    v_mul_f32 v65, v65, v184
    v_mul_f32 v69, v69, v184
    v_mul_f32 v66, v66, v184
    v_mul_f32 v70, v70, v184
    v_mul_f32 v67, v67, v184
    v_mul_f32 v71, v71, v184
    v_cvt_pk_bf16_f32 v64, v64, v65
    v_cvt_pk_bf16_f32 v65, v66, v67
    v_cvt_pk_bf16_f32 v66, v68, v69
    v_cvt_pk_bf16_f32 v67, v70, v71
    buffer_store_dwordx4 v[64:67], v1, s[4:7], s19 offen offset:3072 sc1
    s_lshr_b32 s40, s34, 1
    s_lshl_b32 s40, s40, 7
    s_and_b32 s41, s34, 1
    s_lshl_b32 s41, s41, 2
    s_add_u32 s40, s40, s41
    s_add_u32 s40, s40, 125894656
    s_cmp_lt_u32 s16, 62
    s_cbranch_scc1 L_noef
    s_lshr_b32 s42, s34, 1
    s_mul_i32 s42, s42, 4096
    s_add_u32 s41, s41, s42
    s_add_u32 s41, s41, 124944384
    s_barrier
    s_cmp_lg_u32 s32, 0
    s_cbranch_scc1 L_noef
    v_mov_b32 v250, s95
    v_lshlrev_b32 v251, 7, v0
    s_mov_b64 exec, 262143
    buffer_store_dword v250, v251, s[4:7], s41 offen sc1
    s_mov_b64 exec, -1
L_noef:
    s_waitcnt vmcnt(0)
    s_barrier
    v_mov_b32 v250, s95
    v_cmp_eq_u32 vcc, 0, v0
    s_nop 0
    s_and_saveexec_b64 s[38:39], vcc
    s_cbranch_execz fs17
    buffer_store_dword v250, off, s[4:7], s40 sc1
fs17:
    s_mov_b64 exec, -1
    s_branch L_att_next
L_op_start:
    s_lshl_b32 s35, s33, 2
    s_add_u32 s35, s35, 136
    s_lshr_b32 s89, s33, 2
    s_lshl_b32 s89, s89, 7
    s_add_u32 s89, s89, 125841408
    v_mbcnt_lo_u32_b32 v2, -1, 0
    v_mbcnt_hi_u32_b32 v2, -1, v2
    v_min_u32 v2, 31, v2
    v_lshlrev_b32 v2, 2, v2
    s_mov_b32 s88, 4194304
fw18:
    buffer_load_dword v3, v2, s[4:7], s89 offen offset:0 sc1
    s_sub_u32 s88, s88, 1
    s_cbranch_scc1 fw18x
    s_waitcnt vmcnt(0)
    v_cmp_ne_u32 vcc, s95, v3
    s_cbranch_vccz fw18x
    s_sleep 4
    s_branch fw18
fw18x:
    v_and_b32 v1, 63, v0
    v_lshlrev_b32 v1, 4, v1
    s_lshl_b32 s18, s33, 18
    s_lshl_b32 s19, s32, 16
    s_add_u32 s18, s18, s19
    s_add_u32 s18, s18, 130023424
    buffer_load_dwordx4 a[0:3], v1, s[4:7], s18 offen offset:0 sc1
    buffer_load_dwordx4 a[4:7], v1, s[4:7], s18 offen offset:1024 sc1
    buffer_load_dwordx4 a[8:11], v1, s[4:7], s18 offen offset:2048 sc1
    buffer_load_dwordx4 a[12:15], v1, s[4:7], s18 offen offset:3072 sc1
    s_add_u32 s18, s18, 4096
    buffer_load_dwordx4 a[16:19], v1, s[4:7], s18 offen offset:0 sc1
    buffer_load_dwordx4 a[20:23], v1, s[4:7], s18 offen offset:1024 sc1
    buffer_load_dwordx4 a[24:27], v1, s[4:7], s18 offen offset:2048 sc1
    buffer_load_dwordx4 a[28:31], v1, s[4:7], s18 offen offset:3072 sc1
    s_add_u32 s18, s18, 4096
    buffer_load_dwordx4 a[32:35], v1, s[4:7], s18 offen offset:0 sc1
    buffer_load_dwordx4 a[36:39], v1, s[4:7], s18 offen offset:1024 sc1
    buffer_load_dwordx4 a[40:43], v1, s[4:7], s18 offen offset:2048 sc1
    buffer_load_dwordx4 a[44:47], v1, s[4:7], s18 offen offset:3072 sc1
    s_add_u32 s18, s18, 4096
    buffer_load_dwordx4 a[48:51], v1, s[4:7], s18 offen offset:0 sc1
    buffer_load_dwordx4 a[52:55], v1, s[4:7], s18 offen offset:1024 sc1
    buffer_load_dwordx4 a[56:59], v1, s[4:7], s18 offen offset:2048 sc1
    buffer_load_dwordx4 a[60:63], v1, s[4:7], s18 offen offset:3072 sc1
    s_add_u32 s18, s18, 4096
    buffer_load_dwordx4 a[64:67], v1, s[4:7], s18 offen offset:0 sc1
    buffer_load_dwordx4 a[68:71], v1, s[4:7], s18 offen offset:1024 sc1
    buffer_load_dwordx4 a[72:75], v1, s[4:7], s18 offen offset:2048 sc1
    buffer_load_dwordx4 a[76:79], v1, s[4:7], s18 offen offset:3072 sc1
    s_add_u32 s18, s18, 4096
    buffer_load_dwordx4 a[80:83], v1, s[4:7], s18 offen offset:0 sc1
    buffer_load_dwordx4 a[84:87], v1, s[4:7], s18 offen offset:1024 sc1
    buffer_load_dwordx4 a[88:91], v1, s[4:7], s18 offen offset:2048 sc1
    buffer_load_dwordx4 a[92:95], v1, s[4:7], s18 offen offset:3072 sc1
    s_add_u32 s18, s18, 4096
    buffer_load_dwordx4 a[96:99], v1, s[4:7], s18 offen offset:0 sc1
    buffer_load_dwordx4 a[100:103], v1, s[4:7], s18 offen offset:1024 sc1
    buffer_load_dwordx4 a[104:107], v1, s[4:7], s18 offen offset:2048 sc1
    buffer_load_dwordx4 a[108:111], v1, s[4:7], s18 offen offset:3072 sc1
    s_add_u32 s18, s18, 4096
    buffer_load_dwordx4 a[112:115], v1, s[4:7], s18 offen offset:0 sc1
    buffer_load_dwordx4 a[116:119], v1, s[4:7], s18 offen offset:1024 sc1
    buffer_load_dwordx4 a[120:123], v1, s[4:7], s18 offen offset:2048 sc1
    buffer_load_dwordx4 a[124:127], v1, s[4:7], s18 offen offset:3072 sc1
    s_add_u32 s18, s18, 4096
    buffer_load_dwordx4 a[128:131], v1, s[4:7], s18 offen offset:0 sc1
    buffer_load_dwordx4 a[132:135], v1, s[4:7], s18 offen offset:1024 sc1
    buffer_load_dwordx4 a[136:139], v1, s[4:7], s18 offen offset:2048 sc1
    buffer_load_dwordx4 a[140:143], v1, s[4:7], s18 offen offset:3072 sc1
    s_add_u32 s18, s18, 4096
    buffer_load_dwordx4 a[144:147], v1, s[4:7], s18 offen offset:0 sc1
    buffer_load_dwordx4 a[148:151], v1, s[4:7], s18 offen offset:1024 sc1
    buffer_load_dwordx4 a[152:155], v1, s[4:7], s18 offen offset:2048 sc1
    buffer_load_dwordx4 a[156:159], v1, s[4:7], s18 offen offset:3072 sc1
    s_add_u32 s18, s18, 4096
    buffer_load_dwordx4 a[160:163], v1, s[4:7], s18 offen offset:0 sc1
    s_waitcnt vmcnt(20)
    buffer_load_dwordx4 a[164:167], v1, s[4:7], s18 offen offset:1024 sc1
    buffer_load_dwordx4 a[168:171], v1, s[4:7], s18 offen offset:2048 sc1
    buffer_load_dwordx4 a[172:175], v1, s[4:7], s18 offen offset:3072 sc1
    s_add_u32 s18, s18, 4096
    buffer_load_dwordx4 a[176:179], v1, s[4:7], s18 offen offset:0 sc1
    buffer_load_dwordx4 a[180:183], v1, s[4:7], s18 offen offset:1024 sc1
    buffer_load_dwordx4 a[184:187], v1, s[4:7], s18 offen offset:2048 sc1
    buffer_load_dwordx4 a[188:191], v1, s[4:7], s18 offen offset:3072 sc1
    s_add_u32 s18, s18, 4096
    buffer_load_dwordx4 a[192:195], v1, s[4:7], s18 offen offset:0 sc1
    buffer_load_dwordx4 a[196:199], v1, s[4:7], s18 offen offset:1024 sc1
    buffer_load_dwordx4 a[200:203], v1, s[4:7], s18 offen offset:2048 sc1
    buffer_load_dwordx4 a[204:207], v1, s[4:7], s18 offen offset:3072 sc1
    s_add_u32 s18, s18, 4096
    buffer_load_dwordx4 a[208:211], v1, s[4:7], s18 offen offset:0 sc1
    buffer_load_dwordx4 a[212:215], v1, s[4:7], s18 offen offset:1024 sc1
    buffer_load_dwordx4 a[216:219], v1, s[4:7], s18 offen offset:2048 sc1
    buffer_load_dwordx4 a[220:223], v1, s[4:7], s18 offen offset:3072 sc1
    s_add_u32 s18, s18, 4096
    buffer_load_dwordx4 a[224:227], v1, s[4:7], s18 offen offset:0 sc1
    buffer_load_dwordx4 a[228:231], v1, s[4:7], s18 offen offset:1024 sc1
    buffer_load_dwordx4 a[232:235], v1, s[4:7], s18 offen offset:2048 sc1
    buffer_load_dwordx4 a[236:239], v1, s[4:7], s18 offen offset:3072 sc1
    s_add_u32 s18, s18, 4096
    buffer_load_dwordx4 a[240:243], v1, s[4:7], s18 offen offset:0 sc1
    buffer_load_dwordx4 a[244:247], v1, s[4:7], s18 offen offset:1024 sc1
    buffer_load_dwordx4 a[248:251], v1, s[4:7], s18 offen offset:2048 sc1
    buffer_load_dwordx4 a[252:255], v1, s[4:7], s18 offen offset:3072 sc1
    s_waitcnt vmcnt(0)
    s_mov_b32 s44, 0
    s_mov_b32 s37, s35
    v_mov_b32 v250, 1
    v_mov_b32 v251, 163832
    v_cmp_eq_u32 vcc, 0, v0
    s_nop 0
    s_and_saveexec_b64 s[38:39], vcc
    s_cbranch_execz tk19
    buffer_atomic_add v250, off, s[84:87], s37 sc0
    s_waitcnt vmcnt(0)
    ds_write_b32 v251, v250
    s_waitcnt lgkmcnt(0)
tk19:
    s_mov_b64 exec, -1
    s_barrier
    ds_read_b32 v252, v251
    s_waitcnt lgkmcnt(0)
    v_readfirstlane_b32 s16, v252
    s_barrier
    s_nop 3
    s_cmp_ge_u32 s16, 72
    s_cbranch_scc1 L_op_nextcb
L_op_seg:
    s_min_u32 s43, s16, 56
    s_add_u32 s16, s16, s43
    s_lshr_b32 s43, s16, 1
    s_add_u32 s43, s43, 2
    s_min_u32 s43, s43, 63
    s_lshl_b32 s94, s33, 7
    s_add_u32 s94, s94, s16
    s_mov_b32 s88, 65536
    s_mov_b32 s89, 125853696
cw20:
    buffer_load_dword v3, off, s[4:7], s89 sc1
    s_waitcnt vmcnt(0)
    v_readfirstlane_b32 s42, v3
    s_nop 0
    s_sub_u32 s42, s42, s95
    s_cmp_gt_u32 s42, 64
    s_cselect_b32 s42, 0, s42
    s_add_u32 s42, s42, 1
    s_cmp_ge_u32 s42, s43
    s_cbranch_scc1 cw20x
    s_sub_u32 s88, s88, 1
    s_cbranch_scc1 cw20x
    s_sub_u32 s42, s43, s42
    s_min_u32 s42, s42, 6
cw20s:
    s_sleep 24
    s_sub_u32 s42, s42, 1
    s_cmp_lg_u32 s42, 0
    s_cbranch_scc1 cw20s
    s_branch cw20
cw20x:
    s_lshr_b32 s89, s16, 1
    s_lshl_b32 s89, s89, 2
    s_add_u32 s89, s89, s32
    s_lshl_b32 s89, s89, 7
    s_add_u32 s89, s89, 125894656
    s_sub_u32 s47, s89, 125894656
    s_lshl_b32 s47, s47, 5
    s_lshl_b32 s46, s33, 7
    s_add_u32 s47, s47, s46
    s_add_u32 s47, s47, 124944384
    s_cmp_ge_u32 s16, 124
    s_cselect_b32 s46, 8, 0
    s_cselect_b32 s47, s47, s89
    v_mbcnt_lo_u32_b32 v2, -1, 0
    v_mbcnt_hi_u32_b32 v2, -1, v2
    v_min_u32 v2, 1, v2
    v_lshlrev_b32 v2, 2, v2
    s_mov_b32 s88, 4194304
fw21:
    buffer_load_dword v3, v2, s[4:7], s47 offen offset:0 sc1
    s_sub_u32 s88, s88, 1
    s_cbranch_scc1 fw21x
    s_waitcnt vmcnt(0)
    v_cmp_ne_u32 vcc, s95, v3
    s_cbranch_vccz fw21x
    s_sleep 1
    s_branch fw21
fw21x:
    v_mov_b32 v250, 1
    v_lshrrev_b32 v252, 2, v1
    v_min_u32 v252, 68, v252
    s_cmp_lg_u32 s32, 0
    s_cbranch_scc1 L_op_na
    s_mov_b64 exec, 1
    buffer_atomic_add v250, off, s[84:87], s35 sc0
    s_mov_b64 exec, -1
    s_cmp_lg_u32 s44, 0
    s_cbranch_scc1 L_op_na
    buffer_load_dword v253, v252, s[84:87], 0 offen offset:136 sc1
L_op_na:
    s_cmp_ge_u32 s16, 112
    s_cbranch_scc1 L_op_one
o2_again:
    s_lshl_b32 s18, s16, 17
    s_lshl_b32 s19, s32, 15
    s_add_u32 s18, s18, s19
    s_add_u32 s18, s18, 50331648
    buffer_load_dwordx4 v[24:27], v1, s[4:7], s18 offen offset:0 sc1
    buffer_load_dwordx4 v[28:31], v1, s[4:7], s18 offen offset:1024 sc1
    buffer_load_dwordx4 v[32:35], v1, s[4:7], s18 offen offset:2048 sc1
    buffer_load_dwordx4 v[36:39], v1, s[4:7], s18 offen offset:3072 sc1
    s_add_u32 s18, s18, 4096
    buffer_load_dwordx4 v[40:43], v1, s[4:7], s18 offen offset:0 sc1
    buffer_load_dwordx4 v[44:47], v1, s[4:7], s18 offen offset:1024 sc1
    buffer_load_dwordx4 v[48:51], v1, s[4:7], s18 offen offset:2048 sc1
    buffer_load_dwordx4 v[52:55], v1, s[4:7], s18 offen offset:3072 sc1
    s_add_u32 s18, s18, 4096
    buffer_load_dwordx4 v[56:59], v1, s[4:7], s18 offen offset:0 sc1
    buffer_load_dwordx4 v[60:63], v1, s[4:7], s18 offen offset:1024 sc1
    buffer_load_dwordx4 v[64:67], v1, s[4:7], s18 offen offset:2048 sc1
    buffer_load_dwordx4 v[68:71], v1, s[4:7], s18 offen offset:3072 sc1
    s_add_u32 s18, s18, 4096
    buffer_load_dwordx4 v[72:75], v1, s[4:7], s18 offen offset:0 sc1
    buffer_load_dwordx4 v[76:79], v1, s[4:7], s18 offen offset:1024 sc1
    buffer_load_dwordx4 v[80:83], v1, s[4:7], s18 offen offset:2048 sc1
    buffer_load_dwordx4 v[84:87], v1, s[4:7], s18 offen offset:3072 sc1
    s_add_u32 s18, s18, 4096
    buffer_load_dwordx4 v[88:91], v1, s[4:7], s18 offen offset:0 sc1
    buffer_load_dwordx4 v[92:95], v1, s[4:7], s18 offen offset:1024 sc1
    buffer_load_dwordx4 v[96:99], v1, s[4:7], s18 offen offset:2048 sc1
    buffer_load_dwordx4 v[100:103], v1, s[4:7], s18 offen offset:3072 sc1
    s_add_u32 s18, s18, 4096
    buffer_load_dwordx4 v[104:107], v1, s[4:7], s18 offen offset:0 sc1
    buffer_load_dwordx4 v[108:111], v1, s[4:7], s18 offen offset:1024 sc1
    buffer_load_dwordx4 v[112:115], v1, s[4:7], s18 offen offset:2048 sc1
    buffer_load_dwordx4 v[116:119], v1, s[4:7], s18 offen offset:3072 sc1
    s_add_u32 s18, s18, 4096
    buffer_load_dwordx4 v[120:123], v1, s[4:7], s18 offen offset:0 sc1
    buffer_load_dwordx4 v[124:127], v1, s[4:7], s18 offen offset:1024 sc1
    buffer_load_dwordx4 v[128:131], v1, s[4:7], s18 offen offset:2048 sc1
    buffer_load_dwordx4 v[132:135], v1, s[4:7], s18 offen offset:3072 sc1
    s_add_u32 s18, s18, 4096
    buffer_load_dwordx4 v[136:139], v1, s[4:7], s18 offen offset:0 sc1
    buffer_load_dwordx4 v[140:143], v1, s[4:7], s18 offen offset:1024 sc1
    buffer_load_dwordx4 v[144:147], v1, s[4:7], s18 offen offset:2048 sc1
    buffer_load_dwordx4 v[148:151], v1, s[4:7], s18 offen offset:3072 sc1
    s_add_u32 s18, s18, 102400
    buffer_load_dwordx4 v[152:155], v1, s[4:7], s18 offen offset:0 sc1
    buffer_load_dwordx4 v[156:159], v1, s[4:7], s18 offen offset:1024 sc1
    buffer_load_dwordx4 v[160:163], v1, s[4:7], s18 offen offset:2048 sc1
    buffer_load_dwordx4 v[164:167], v1, s[4:7], s18 offen offset:3072 sc1
    s_add_u32 s18, s18, 4096
    buffer_load_dwordx4 v[168:171], v1, s[4:7], s18 offen offset:0 sc1
    buffer_load_dwordx4 v[172:175], v1, s[4:7], s18 offen offset:1024 sc1
    buffer_load_dwordx4 v[176:179], v1, s[4:7], s18 offen offset:2048 sc1
    buffer_load_dwordx4 v[180:183], v1, s[4:7], s18 offen offset:3072 sc1
    s_add_u32 s18, s18, 4096
    buffer_load_dwordx4 v[184:187], v1, s[4:7], s18 offen offset:0 sc1
    buffer_load_dwordx4 v[188:191], v1, s[4:7], s18 offen offset:1024 sc1
    buffer_load_dwordx4 v[192:195], v1, s[4:7], s18 offen offset:2048 sc1
    buffer_load_dwordx4 v[196:199], v1, s[4:7], s18 offen offset:3072 sc1
    s_add_u32 s18, s18, 4096
    buffer_load_dwordx4 v[200:203], v1, s[4:7], s18 offen offset:0 sc1
    buffer_load_dwordx4 v[204:207], v1, s[4:7], s18 offen offset:1024 sc1
    buffer_load_dwordx4 v[208:211], v1, s[4:7], s18 offen offset:2048 sc1
    buffer_load_dwordx4 v[212:215], v1, s[4:7], s18 offen offset:3072 sc1
    s_add_u32 s18, s18, 4096
    buffer_load_dwordx4 v[216:219], v1, s[4:7], s18 offen offset:0 sc1
    buffer_load_dwordx4 v[220:223], v1, s[4:7], s18 offen offset:1024 sc1
    buffer_load_dwordx4 v[224:227], v1, s[4:7], s18 offen offset:2048 sc1
    buffer_load_dwordx4 v[228:231], v1, s[4:7], s18 offen offset:3072 sc1
    s_add_u32 s18, s18, 4096
    buffer_load_dwordx4 v[232:235], v1, s[4:7], s18 offen offset:0 sc1
    buffer_load_dwordx4 v[236:239], v1, s[4:7], s18 offen offset:1024 sc1
    buffer_load_dwordx4 v[240:243], v1, s[4:7], s18 offen offset:2048 sc1
    buffer_load_dwordx4 v[244:247], v1, s[4:7], s18 offen offset:3072 sc1
    v_lshlrev_b32 v2, 4, v0
    v_and_b32 v3, 3072, v2
    v_lshl_add_u32 v2, v3, 1, v1
    s_waitcnt vmcnt(55)
    v_mfma_f32_16x16x32_bf16 v[8:11], a[0:3], v[24:27], 0
    v_mfma_f32_16x16x32_bf16 v[12:15], a[4:7], v[24:27], 0
    s_add_u32 s18, s18, 4096
    buffer_load_dwordx4 v[24:27], v1, s[4:7], s18 offen offset:0 sc1
    s_waitcnt vmcnt(55)
    v_mfma_f32_16x16x32_bf16 v[8:11], a[8:11], v[28:31], v[8:11]
    v_mfma_f32_16x16x32_bf16 v[12:15], a[12:15], v[28:31], v[12:15]
    buffer_load_dwordx4 v[28:31], v1, s[4:7], s18 offen offset:1024 sc1
    s_waitcnt vmcnt(55)
    v_mfma_f32_16x16x32_bf16 v[8:11], a[16:19], v[32:35], v[8:11]
    v_mfma_f32_16x16x32_bf16 v[12:15], a[20:23], v[32:35], v[12:15]
    buffer_load_dwordx4 v[32:35], v1, s[4:7], s18 offen offset:2048 sc1
    s_waitcnt vmcnt(55)
    v_mfma_f32_16x16x32_bf16 v[8:11], a[24:27], v[36:39], v[8:11]
    v_mfma_f32_16x16x32_bf16 v[12:15], a[28:31], v[36:39], v[12:15]
    buffer_load_dwordx4 v[36:39], v1, s[4:7], s18 offen offset:3072 sc1
    s_waitcnt vmcnt(55)
    v_mfma_f32_16x16x32_bf16 v[8:11], a[32:35], v[40:43], v[8:11]
    v_mfma_f32_16x16x32_bf16 v[12:15], a[36:39], v[40:43], v[12:15]
    s_add_u32 s18, s18, 4096
    buffer_load_dwordx4 v[40:43], v1, s[4:7], s18 offen offset:0 sc1
    s_waitcnt vmcnt(55)
    v_mfma_f32_16x16x32_bf16 v[8:11], a[40:43], v[44:47], v[8:11]
    v_mfma_f32_16x16x32_bf16 v[12:15], a[44:47], v[44:47], v[12:15]
    buffer_load_dwordx4 v[44:47], v1, s[4:7], s18 offen offset:1024 sc1
    s_waitcnt vmcnt(55)
    v_mfma_f32_16x16x32_bf16 v[8:11], a[48:51], v[48:51], v[8:11]
    v_mfma_f32_16x16x32_bf16 v[12:15], a[52:55], v[48:51], v[12:15]
    buffer_load_dwordx4 v[48:51], v1, s[4:7], s18 offen offset:2048 sc1
    s_waitcnt vmcnt(55)
    v_mfma_f32_16x16x32_bf16 v[8:11], a[56:59], v[52:55], v[8:11]
    v_mfma_f32_16x16x32_bf16 v[12:15], a[60:63], v[52:55], v[12:15]
    buffer_load_dwordx4 v[52:55], v1, s[4:7], s18 offen offset:3072 sc1
    s_waitcnt vmcnt(55)
    v_mfma_f32_16x16x32_bf16 v[8:11], a[64:67], v[56:59], v[8:11]
    v_mfma_f32_16x16x32_bf16 v[12:15], a[68:71], v[56:59], v[12:15]
    s_waitcnt vmcnt(54)
    v_mfma_f32_16x16x32_bf16 v[8:11], a[72:75], v[60:63], v[8:11]
    v_mfma_f32_16x16x32_bf16 v[12:15], a[76:79], v[60:63], v[12:15]
    s_waitcnt vmcnt(53)
    v_mfma_f32_16x16x32_bf16 v[8:11], a[80:83], v[64:67], v[8:11]
    v_mfma_f32_16x16x32_bf16 v[12:15], a[84:87], v[64:67], v[12:15]
    s_waitcnt vmcnt(52)
    v_mfma_f32_16x16x32_bf16 v[8:11], a[88:91], v[68:71], v[8:11]
    v_mfma_f32_16x16x32_bf16 v[12:15], a[92:95], v[68:71], v[12:15]
    s_waitcnt vmcnt(51)
    v_mfma_f32_16x16x32_bf16 v[8:11], a[96:99], v[72:75], v[8:11]
    v_mfma_f32_16x16x32_bf16 v[12:15], a[100:103], v[72:75], v[12:15]
    s_waitcnt vmcnt(50)
    v_mfma_f32_16x16x32_bf16 v[8:11], a[104:107], v[76:79], v[8:11]
    v_mfma_f32_16x16x32_bf16 v[12:15], a[108:111], v[76:79], v[12:15]
    s_waitcnt vmcnt(49)
    v_mfma_f32_16x16x32_bf16 v[8:11], a[112:115], v[80:83], v[8:11]
    v_mfma_f32_16x16x32_bf16 v[12:15], a[116:119], v[80:83], v[12:15]
    s_waitcnt vmcnt(48)
    v_mfma_f32_16x16x32_bf16 v[8:11], a[120:123], v[84:87], v[8:11]
    v_mfma_f32_16x16x32_bf16 v[12:15], a[124:127], v[84:87], v[12:15]
    s_waitcnt vmcnt(47)
    v_mfma_f32_16x16x32_bf16 v[8:11], a[128:131], v[88:91], v[8:11]
    v_mfma_f32_16x16x32_bf16 v[12:15], a[132:135], v[88:91], v[12:15]
    s_waitcnt vmcnt(46)
    v_mfma_f32_16x16x32_bf16 v[8:11], a[136:139], v[92:95], v[8:11]
    v_mfma_f32_16x16x32_bf16 v[12:15], a[140:143], v[92:95], v[12:15]
    s_waitcnt vmcnt(45)
    v_mfma_f32_16x16x32_bf16 v[8:11], a[144:147], v[96:99], v[8:11]
    v_mfma_f32_16x16x32_bf16 v[12:15], a[148:151], v[96:99], v[12:15]
    s_waitcnt vmcnt(44)
    v_mfma_f32_16x16x32_bf16 v[8:11], a[152:155], v[100:103], v[8:11]
    v_mfma_f32_16x16x32_bf16 v[12:15], a[156:159], v[100:103], v[12:15]
    s_waitcnt vmcnt(43)
    v_mfma_f32_16x16x32_bf16 v[8:11], a[160:163], v[104:107], v[8:11]
    v_mfma_f32_16x16x32_bf16 v[12:15], a[164:167], v[104:107], v[12:15]
    s_waitcnt vmcnt(42)
    v_mfma_f32_16x16x32_bf16 v[8:11], a[168:171], v[108:111], v[8:11]
    v_mfma_f32_16x16x32_bf16 v[12:15], a[172:175], v[108:111], v[12:15]
    s_waitcnt vmcnt(41)
    v_mfma_f32_16x16x32_bf16 v[8:11], a[176:179], v[112:115], v[8:11]
    v_mfma_f32_16x16x32_bf16 v[12:15], a[180:183], v[112:115], v[12:15]
    s_waitcnt vmcnt(40)
    v_mfma_f32_16x16x32_bf16 v[8:11], a[184:187], v[116:119], v[8:11]
    v_mfma_f32_16x16x32_bf16 v[12:15], a[188:191], v[116:119], v[12:15]
    s_waitcnt vmcnt(39)
    v_mfma_f32_16x16x32_bf16 v[8:11], a[192:195], v[120:123], v[8:11]
    v_mfma_f32_16x16x32_bf16 v[12:15], a[196:199], v[120:123], v[12:15]
    s_waitcnt vmcnt(38)
    v_mfma_f32_16x16x32_bf16 v[8:11], a[200:203], v[124:127], v[8:11]
    v_mfma_f32_16x16x32_bf16 v[12:15], a[204:207], v[124:127], v[12:15]
    s_waitcnt vmcnt(37)
    v_mfma_f32_16x16x32_bf16 v[8:11], a[208:211], v[128:131], v[8:11]
    v_mfma_f32_16x16x32_bf16 v[12:15], a[212:215], v[128:131], v[12:15]
    s_waitcnt vmcnt(36)
    v_mfma_f32_16x16x32_bf16 v[8:11], a[216:219], v[132:135], v[8:11]
    v_mfma_f32_16x16x32_bf16 v[12:15], a[220:223], v[132:135], v[12:15]
    s_waitcnt vmcnt(35)
    v_mfma_f32_16x16x32_bf16 v[8:11], a[224:227], v[136:139], v[8:11]
    v_mfma_f32_16x16x32_bf16 v[12:15], a[228:231], v[136:139], v[12:15]
    s_waitcnt vmcnt(34)
    v_mfma_f32_16x16x32_bf16 v[8:11], a[232:235], v[140:143], v[8:11]
    v_mfma_f32_16x16x32_bf16 v[12:15], a[236:239], v[140:143], v[12:15]
    s_waitcnt vmcnt(33)
    v_mfma_f32_16x16x32_bf16 v[8:11], a[240:243], v[144:147], v[8:11]
    v_mfma_f32_16x16x32_bf16 v[12:15], a[244:247], v[144:147], v[12:15]
    s_waitcnt vmcnt(32)
    v_mfma_f32_16x16x32_bf16 v[8:11], a[248:251], v[148:151], v[8:11]
    v_mfma_f32_16x16x32_bf16 v[12:15], a[252:255], v[148:151], v[12:15]
    s_waitcnt vmcnt(31)
    v_mfma_f32_16x16x32_bf16 v[16:19], a[0:3], v[152:155], 0
    v_mfma_f32_16x16x32_bf16 v[20:23], a[4:7], v[152:155], 0
    s_waitcnt vmcnt(30)
    v_mfma_f32_16x16x32_bf16 v[16:19], a[8:11], v[156:159], v[16:19]
    v_mfma_f32_16x16x32_bf16 v[20:23], a[12:15], v[156:159], v[20:23]
    s_waitcnt vmcnt(29)
    v_mfma_f32_16x16x32_bf16 v[16:19], a[16:19], v[160:163], v[16:19]
    v_mfma_f32_16x16x32_bf16 v[20:23], a[20:23], v[160:163], v[20:23]
    s_waitcnt vmcnt(28)
    v_mfma_f32_16x16x32_bf16 v[16:19], a[24:27], v[164:167], v[16:19]
    v_mfma_f32_16x16x32_bf16 v[20:23], a[28:31], v[164:167], v[20:23]
    s_waitcnt vmcnt(27)
    v_mfma_f32_16x16x32_bf16 v[16:19], a[32:35], v[168:171], v[16:19]
    v_mfma_f32_16x16x32_bf16 v[20:23], a[36:39], v[168:171], v[20:23]
    s_waitcnt vmcnt(26)
    v_mfma_f32_16x16x32_bf16 v[16:19], a[40:43], v[172:175], v[16:19]
    v_mfma_f32_16x16x32_bf16 v[20:23], a[44:47], v[172:175], v[20:23]
    s_waitcnt vmcnt(25)
    v_mfma_f32_16x16x32_bf16 v[16:19], a[48:51], v[176:179], v[16:19]
    v_mfma_f32_16x16x32_bf16 v[20:23], a[52:55], v[176:179], v[20:23]
    s_waitcnt vmcnt(24)
    v_mfma_f32_16x16x32_bf16 v[16:19], a[56:59], v[180:183], v[16:19]
    v_mfma_f32_16x16x32_bf16 v[20:23], a[60:63], v[180:183], v[20:23]
    s_waitcnt vmcnt(23)
    v_mfma_f32_16x16x32_bf16 v[16:19], a[64:67], v[184:187], v[16:19]
    v_mfma_f32_16x16x32_bf16 v[20:23], a[68:71], v[184:187], v[20:23]
    s_waitcnt vmcnt(22)
    v_mfma_f32_16x16x32_bf16 v[16:19], a[72:75], v[188:191], v[16:19]
    v_mfma_f32_16x16x32_bf16 v[20:23], a[76:79], v[188:191], v[20:23]
    s_waitcnt vmcnt(21)
    v_mfma_f32_16x16x32_bf16 v[16:19], a[80:83], v[192:195], v[16:19]
    v_mfma_f32_16x16x32_bf16 v[20:23], a[84:87], v[192:195], v[20:23]
    s_waitcnt vmcnt(20)
    v_mfma_f32_16x16x32_bf16 v[16:19], a[88:91], v[196:199], v[16:19]
    v_mfma_f32_16x16x32_bf16 v[20:23], a[92:95], v[196:199], v[20:23]
    s_waitcnt vmcnt(19)
    v_mfma_f32_16x16x32_bf16 v[16:19], a[96:99], v[200:203], v[16:19]
    v_mfma_f32_16x16x32_bf16 v[20:23], a[100:103], v[200:203], v[20:23]
    s_waitcnt vmcnt(18)
    v_mfma_f32_16x16x32_bf16 v[16:19], a[104:107], v[204:207], v[16:19]
    v_mfma_f32_16x16x32_bf16 v[20:23], a[108:111], v[204:207], v[20:23]
    s_waitcnt vmcnt(17)
    v_mfma_f32_16x16x32_bf16 v[16:19], a[112:115], v[208:211], v[16:19]
    v_mfma_f32_16x16x32_bf16 v[20:23], a[116:119], v[208:211], v[20:23]
    s_waitcnt vmcnt(16)
    v_mfma_f32_16x16x32_bf16 v[16:19], a[120:123], v[212:215], v[16:19]
    v_mfma_f32_16x16x32_bf16 v[20:23], a[124:127], v[212:215], v[20:23]
    s_waitcnt vmcnt(15)
    v_mfma_f32_16x16x32_bf16 v[16:19], a[128:131], v[216:219], v[16:19]
    v_mfma_f32_16x16x32_bf16 v[20:23], a[132:135], v[216:219], v[20:23]
    s_waitcnt vmcnt(14)
    v_mfma_f32_16x16x32_bf16 v[16:19], a[136:139], v[220:223], v[16:19]
    v_mfma_f32_16x16x32_bf16 v[20:23], a[140:143], v[220:223], v[20:23]
    s_waitcnt vmcnt(13)
    v_mfma_f32_16x16x32_bf16 v[16:19], a[144:147], v[224:227], v[16:19]
    v_mfma_f32_16x16x32_bf16 v[20:23], a[148:151], v[224:227], v[20:23]
    s_waitcnt vmcnt(12)
    v_mfma_f32_16x16x32_bf16 v[16:19], a[152:155], v[228:231], v[16:19]
    v_mfma_f32_16x16x32_bf16 v[20:23], a[156:159], v[228:231], v[20:23]
    s_waitcnt vmcnt(11)
    v_mfma_f32_16x16x32_bf16 v[16:19], a[160:163], v[232:235], v[16:19]
    v_mfma_f32_16x16x32_bf16 v[20:23], a[164:167], v[232:235], v[20:23]
    s_waitcnt vmcnt(10)
    v_mfma_f32_16x16x32_bf16 v[16:19], a[168:171], v[236:239], v[16:19]
    v_mfma_f32_16x16x32_bf16 v[20:23], a[172:175], v[236:239], v[20:23]
    s_waitcnt vmcnt(9)
    v_mfma_f32_16x16x32_bf16 v[16:19], a[176:179], v[240:243], v[16:19]
    v_mfma_f32_16x16x32_bf16 v[20:23], a[180:183], v[240:243], v[20:23]
    s_waitcnt vmcnt(8)
    v_mfma_f32_16x16x32_bf16 v[16:19], a[184:187], v[244:247], v[16:19]
    v_mfma_f32_16x16x32_bf16 v[20:23], a[188:191], v[244:247], v[20:23]
    s_waitcnt vmcnt(7)
    v_mfma_f32_16x16x32_bf16 v[16:19], a[192:195], v[24:27], v[16:19]
    v_mfma_f32_16x16x32_bf16 v[20:23], a[196:199], v[24:27], v[20:23]
    s_waitcnt vmcnt(6)
    v_mfma_f32_16x16x32_bf16 v[16:19], a[200:203], v[28:31], v[16:19]
    v_mfma_f32_16x16x32_bf16 v[20:23], a[204:207], v[28:31], v[20:23]
    s_waitcnt vmcnt(5)
    v_mfma_f32_16x16x32_bf16 v[16:19], a[208:211], v[32:35], v[16:19]
    v_mfma_f32_16x16x32_bf16 v[20:23], a[212:215], v[32:35], v[20:23]
    s_waitcnt vmcnt(4)
    v_mfma_f32_16x16x32_bf16 v[16:19], a[216:219], v[36:39], v[16:19]
    v_mfma_f32_16x16x32_bf16 v[20:23], a[220:223], v[36:39], v[20:23]
    s_waitcnt vmcnt(3)
    v_mfma_f32_16x16x32_bf16 v[16:19], a[224:227], v[40:43], v[16:19]
    v_mfma_f32_16x16x32_bf16 v[20:23], a[228:231], v[40:43], v[20:23]
    s_waitcnt vmcnt(2)
    v_mfma_f32_16x16x32_bf16 v[16:19], a[232:235], v[44:47], v[16:19]
    v_mfma_f32_16x16x32_bf16 v[20:23], a[236:239], v[44:47], v[20:23]
    s_waitcnt vmcnt(1)
    v_mfma_f32_16x16x32_bf16 v[16:19], a[240:243], v[48:51], v[16:19]
    v_mfma_f32_16x16x32_bf16 v[20:23], a[244:247], v[48:51], v[20:23]
    s_waitcnt vmcnt(0)
    v_mfma_f32_16x16x32_bf16 v[16:19], a[248:251], v[52:55], v[16:19]
    v_mfma_f32_16x16x32_bf16 v[20:23], a[252:255], v[52:55], v[20:23]
    ds_write_b128 v2, v[8:11] offset:0
    ds_write_b128 v2, v[12:15] offset:1024
    s_nop 4
    ds_write_b128 v2, v[16:19] offset:8192
    ds_write_b128 v2, v[20:23] offset:9216
    s_cmp_lg_u32 s32, 0
    s_cbranch_scc1 o2_nb
    v_cmp_eq_u32 vcc, 0, v253
    s_nop 0
    s_cmp_eq_u64 vcc, 0
    s_cselect_b32 s44, 65536, 0
    v_or_b32 v250, s44, v250
    v_mov_b32 v251, 163832
    s_mov_b64 exec, 1
    ds_write_b32 v251, v250
    s_mov_b64 exec, -1
o2_nb:
    s_waitcnt lgkmcnt(0)
    s_barrier
    s_cmp_gt_u32 s32, 1
    s_cbranch_scc1 o2_skip
    s_lshl_b32 s18, s32, 13
    v_add_u32 v2, s18, v1
    ds_read_b128 v[24:27], v2 offset:0
    ds_read_b128 v[28:31], v2 offset:1024
    ds_read_b128 v[32:35], v2 offset:2048
    ds_read_b128 v[36:39], v2 offset:3072
    ds_read_b128 v[40:43], v2 offset:4096
    ds_read_b128 v[44:47], v2 offset:5120
    ds_read_b128 v[48:51], v2 offset:6144
    ds_read_b128 v[52:55], v2 offset:7168
    v_lshrrev_b32 v3, 4, v1
    v_bfe_u32 v4, v3, 2, 2
    v_lshlrev_b32 v4, 3, v4
    v_and_b32 v2, 3, v3
    v_add_u32 v4, v4, v2
    v_mul_u32_u24 v4, 2304, v4
    v_lshrrev_b32 v3, 4, v3
    v_lshl_add_u32 v4, v3, 4, v4
    s_add_u32 s20, s16, s32
    s_lshr_b32 s18, s20, 1
    s_lshl_b32 s18, s18, 3
    s_and_b32 s19, s20, 1
    s_add_u32 s18, s18, s19
    s_mul_i32 s18, s18, 9216
    s_lshl_b32 s19, s33, 6
    s_add_u32 s18, s18, s19
    s_waitcnt lgkmcnt(0)
    v_pk_add_f32 v[24:25], v[24:25], v[32:33]
    v_pk_add_f32 v[40:41], v[40:41], v[48:49]
    v_pk_add_f32 v[24:25], v[24:25], v[40:41]
    v_pk_add_f32 v[26:27], v[26:27], v[34:35]
    v_pk_add_f32 v[42:43], v[42:43], v[50:51]
    v_pk_add_f32 v[26:27], v[26:27], v[42:43]
    v_pk_add_f32 v[28:29], v[28:29], v[36:37]
    v_pk_add_f32 v[44:45], v[44:45], v[52:53]
    v_pk_add_f32 v[28:29], v[28:29], v[44:45]
    v_pk_add_f32 v[30:31], v[30:31], v[38:39]
    v_pk_add_f32 v[46:47], v[46:47], v[54:55]
    v_pk_add_f32 v[30:31], v[30:31], v[46:47]
    v_cvt_pk_bf16_f32 v8, v24, v28
    v_cvt_pk_bf16_f32 v9, v25, v29
    v_cvt_pk_bf16_f32 v10, v26, v30
    v_cvt_pk_bf16_f32 v11, v27, v31
    buffer_store_dwordx4 v[8:11], v4, s[8:11], s18 offen
o2_skip:
    s_nop 1
    s_branch L_op_fin
L_op_one:
o1_again:
    s_lshl_b32 s18, s16, 17
    s_lshl_b32 s19, s32, 15
    s_add_u32 s18, s18, s19
    s_add_u32 s18, s18, 50331648
    buffer_load_dwordx4 v[24:27], v1, s[4:7], s18 offen offset:0 sc1
    buffer_load_dwordx4 v[28:31], v1, s[4:7], s18 offen offset:1024 sc1
    buffer_load_dwordx4 v[32:35], v1, s[4:7], s18 offen offset:2048 sc1
    buffer_load_dwordx4 v[36:39], v1, s[4:7], s18 offen offset:3072 sc1
    s_add_u32 s18, s18, 4096
    buffer_load_dwordx4 v[40:43], v1, s[4:7], s18 offen offset:0 sc1
    buffer_load_dwordx4 v[44:47], v1, s[4:7], s18 offen offset:1024 sc1
    buffer_load_dwordx4 v[48:51], v1, s[4:7], s18 offen offset:2048 sc1
    buffer_load_dwordx4 v[52:55], v1, s[4:7], s18 offen offset:3072 sc1
    s_add_u32 s18, s18, 4096
    buffer_load_dwordx4 v[56:59], v1, s[4:7], s18 offen offset:0 sc1
    buffer_load_dwordx4 v[60:63], v1, s[4:7], s18 offen offset:1024 sc1
    buffer_load_dwordx4 v[64:67], v1, s[4:7], s18 offen offset:2048 sc1
    buffer_load_dwordx4 v[68:71], v1, s[4:7], s18 offen offset:3072 sc1
    s_add_u32 s18, s18, 4096
    buffer_load_dwordx4 v[72:75], v1, s[4:7], s18 offen offset:0 sc1
    buffer_load_dwordx4 v[76:79], v1, s[4:7], s18 offen offset:1024 sc1
    buffer_load_dwordx4 v[80:83], v1, s[4:7], s18 offen offset:2048 sc1
    buffer_load_dwordx4 v[84:87], v1, s[4:7], s18 offen offset:3072 sc1
    s_add_u32 s18, s18, 4096
    buffer_load_dwordx4 v[88:91], v1, s[4:7], s18 offen offset:0 sc1
    buffer_load_dwordx4 v[92:95], v1, s[4:7], s18 offen offset:1024 sc1
    buffer_load_dwordx4 v[96:99], v1, s[4:7], s18 offen offset:2048 sc1
    buffer_load_dwordx4 v[100:103], v1, s[4:7], s18 offen offset:3072 sc1
    s_add_u32 s18, s18, 4096
    buffer_load_dwordx4 v[104:107], v1, s[4:7], s18 offen offset:0 sc1
    buffer_load_dwordx4 v[108:111], v1, s[4:7], s18 offen offset:1024 sc1
    buffer_load_dwordx4 v[112:115], v1, s[4:7], s18 offen offset:2048 sc1
    buffer_load_dwordx4 v[116:119], v1, s[4:7], s18 offen offset:3072 sc1
    s_add_u32 s18, s18, 4096
    buffer_load_dwordx4 v[120:123], v1, s[4:7], s18 offen offset:0 sc1
    buffer_load_dwordx4 v[124:127], v1, s[4:7], s18 offen offset:1024 sc1
    buffer_load_dwordx4 v[128:131], v1, s[4:7], s18 offen offset:2048 sc1
    buffer_load_dwordx4 v[132:135], v1, s[4:7], s18 offen offset:3072 sc1
    s_add_u32 s18, s18, 4096
    buffer_load_dwordx4 v[136:139], v1, s[4:7], s18 offen offset:0 sc1
    buffer_load_dwordx4 v[140:143], v1, s[4:7], s18 offen offset:1024 sc1
    buffer_load_dwordx4 v[144:147], v1, s[4:7], s18 offen offset:2048 sc1
    buffer_load_dwordx4 v[148:151], v1, s[4:7], s18 offen offset:3072 sc1
    v_lshlrev_b32 v2, 4, v0
    v_and_b32 v3, 3072, v2
    v_lshl_add_u32 v2, v3, 1, v1
    s_waitcnt vmcnt(31)
    v_mfma_f32_16x16x32_bf16 v[8:11], a[0:3], v[24:27], 0
    v_max_u32 v6, v24, v25
    v_mfma_f32_16x16x32_bf16 v[12:15], a[4:7], v[24:27], 0
    v_max3_u32 v6, v6, v26, v27
    s_waitcnt vmcnt(30)
    v_mfma_f32_16x16x32_bf16 v[8:11], a[8:11], v[28:31], v[8:11]
    v_max3_u32 v6, v6, v28, v29
    v_mfma_f32_16x16x32_bf16 v[12:15], a[12:15], v[28:31], v[12:15]
    v_max3_u32 v6, v6, v30, v31
    s_waitcnt vmcnt(29)
    v_mfma_f32_16x16x32_bf16 v[8:11], a[16:19], v[32:35], v[8:11]
    v_max3_u32 v6, v6, v32, v33
    v_mfma_f32_16x16x32_bf16 v[12:15], a[20:23], v[32:35], v[12:15]
    v_max3_u32 v6, v6, v34, v35
    s_waitcnt vmcnt(28)
    v_mfma_f32_16x16x32_bf16 v[8:11], a[24:27], v[36:39], v[8:11]
    v_max3_u32 v6, v6, v36, v37
    v_mfma_f32_16x16x32_bf16 v[12:15], a[28:31], v[36:39], v[12:15]
    v_max3_u32 v6, v6, v38, v39
    s_waitcnt vmcnt(27)
    v_mfma_f32_16x16x32_bf16 v[8:11], a[32:35], v[40:43], v[8:11]
    v_max3_u32 v6, v6, v40, v41
    v_mfma_f32_16x16x32_bf16 v[12:15], a[36:39], v[40:43], v[12:15]
    v_max3_u32 v6, v6, v42, v43
    s_waitcnt vmcnt(26)
    v_mfma_f32_16x16x32_bf16 v[8:11], a[40:43], v[44:47], v[8:11]
    v_max3_u32 v6, v6, v44, v45
    v_mfma_f32_16x16x32_bf16 v[12:15], a[44:47], v[44:47], v[12:15]
    v_max3_u32 v6, v6, v46, v47
    s_waitcnt vmcnt(25)
    v_mfma_f32_16x16x32_bf16 v[8:11], a[48:51], v[48:51], v[8:11]
    v_max3_u32 v6, v6, v48, v49
    v_mfma_f32_16x16x32_bf16 v[12:15], a[52:55], v[48:51], v[12:15]
    v_max3_u32 v6, v6, v50, v51
    s_waitcnt vmcnt(24)
    v_mfma_f32_16x16x32_bf16 v[8:11], a[56:59], v[52:55], v[8:11]
    v_max3_u32 v6, v6, v52, v53
    v_mfma_f32_16x16x32_bf16 v[12:15], a[60:63], v[52:55], v[12:15]
    v_max3_u32 v6, v6, v54, v55
    s_waitcnt vmcnt(23)
    v_mfma_f32_16x16x32_bf16 v[8:11], a[64:67], v[56:59], v[8:11]
    v_max3_u32 v6, v6, v56, v57
    v_mfma_f32_16x16x32_bf16 v[12:15], a[68:71], v[56:59], v[12:15]
    v_max3_u32 v6, v6, v58, v59
    s_waitcnt vmcnt(22)
    v_mfma_f32_16x16x32_bf16 v[8:11], a[72:75], v[60:63], v[8:11]
    v_max3_u32 v6, v6, v60, v61
    v_mfma_f32_16x16x32_bf16 v[12:15], a[76:79], v[60:63], v[12:15]
    v_max3_u32 v6, v6, v62, v63
    s_waitcnt vmcnt(21)
    v_mfma_f32_16x16x32_bf16 v[8:11], a[80:83], v[64:67], v[8:11]
    v_max3_u32 v6, v6, v64, v65
    v_mfma_f32_16x16x32_bf16 v[12:15], a[84:87], v[64:67], v[12:15]
    v_max3_u32 v6, v6, v66, v67
    s_waitcnt vmcnt(20)
    v_mfma_f32_16x16x32_bf16 v[8:11], a[88:91], v[68:71], v[8:11]
    v_max3_u32 v6, v6, v68, v69
    v_mfma_f32_16x16x32_bf16 v[12:15], a[92:95], v[68:71], v[12:15]
    v_max3_u32 v6, v6, v70, v71
    s_waitcnt vmcnt(19)
    v_mfma_f32_16x16x32_bf16 v[8:11], a[96:99], v[72:75], v[8:11]
    v_max3_u32 v6, v6, v72, v73
    v_mfma_f32_16x16x32_bf16 v[12:15], a[100:103], v[72:75], v[12:15]
    v_max3_u32 v6, v6, v74, v75
    s_waitcnt vmcnt(18)
    v_mfma_f32_16x16x32_bf16 v[8:11], a[104:107], v[76:79], v[8:11]
    v_max3_u32 v6, v6, v76, v77
    v_mfma_f32_16x16x32_bf16 v[12:15], a[108:111], v[76:79], v[12:15]
    v_max3_u32 v6, v6, v78, v79
    s_waitcnt vmcnt(17)
    v_mfma_f32_16x16x32_bf16 v[8:11], a[112:115], v[80:83], v[8:11]
    v_max3_u32 v6, v6, v80, v81
    v_mfma_f32_16x16x32_bf16 v[12:15], a[116:119], v[80:83], v[12:15]
    v_max3_u32 v6, v6, v82, v83
    s_waitcnt vmcnt(16)
    v_mfma_f32_16x16x32_bf16 v[8:11], a[120:123], v[84:87], v[8:11]
    v_max3_u32 v6, v6, v84, v85
    v_mfma_f32_16x16x32_bf16 v[12:15], a[124:127], v[84:87], v[12:15]
    v_max3_u32 v6, v6, v86, v87
    s_waitcnt vmcnt(15)
    v_mfma_f32_16x16x32_bf16 v[8:11], a[128:131], v[88:91], v[8:11]
    v_max3_u32 v6, v6, v88, v89
    v_mfma_f32_16x16x32_bf16 v[12:15], a[132:135], v[88:91], v[12:15]
    v_max3_u32 v6, v6, v90, v91
    s_waitcnt vmcnt(14)
    v_mfma_f32_16x16x32_bf16 v[8:11], a[136:139], v[92:95], v[8:11]
    v_max3_u32 v6, v6, v92, v93
    v_mfma_f32_16x16x32_bf16 v[12:15], a[140:143], v[92:95], v[12:15]
    v_max3_u32 v6, v6, v94, v95
    s_waitcnt vmcnt(13)
    v_mfma_f32_16x16x32_bf16 v[8:11], a[144:147], v[96:99], v[8:11]
    v_max3_u32 v6, v6, v96, v97
    v_mfma_f32_16x16x32_bf16 v[12:15], a[148:151], v[96:99], v[12:15]
    v_max3_u32 v6, v6, v98, v99
    s_waitcnt vmcnt(12)
    v_mfma_f32_16x16x32_bf16 v[8:11], a[152:155], v[100:103], v[8:11]
    v_max3_u32 v6, v6, v100, v101
    v_mfma_f32_16x16x32_bf16 v[12:15], a[156:159], v[100:103], v[12:15]
    v_max3_u32 v6, v6, v102, v103
    s_waitcnt vmcnt(11)
    v_mfma_f32_16x16x32_bf16 v[8:11], a[160:163], v[104:107], v[8:11]
    v_max3_u32 v6, v6, v104, v105
    v_mfma_f32_16x16x32_bf16 v[12:15], a[164:167], v[104:107], v[12:15]
    v_max3_u32 v6, v6, v106, v107
    s_waitcnt vmcnt(10)
    v_mfma_f32_16x16x32_bf16 v[8:11], a[168:171], v[108:111], v[8:11]
    v_max3_u32 v6, v6, v108, v109
    v_mfma_f32_16x16x32_bf16 v[12:15], a[172:175], v[108:111], v[12:15]
    v_max3_u32 v6, v6, v110, v111
    s_waitcnt vmcnt(9)
    v_mfma_f32_16x16x32_bf16 v[8:11], a[176:179], v[112:115], v[8:11]
    v_max3_u32 v6, v6, v112, v113
    v_mfma_f32_16x16x32_bf16 v[12:15], a[180:183], v[112:115], v[12:15]
    v_max3_u32 v6, v6, v114, v115
    s_waitcnt vmcnt(8)
    v_mfma_f32_16x16x32_bf16 v[8:11], a[184:187], v[116:119], v[8:11]
    v_max3_u32 v6, v6, v116, v117
    v_mfma_f32_16x16x32_bf16 v[12:15], a[188:191], v[116:119], v[12:15]
    v_max3_u32 v6, v6, v118, v119
    s_waitcnt vmcnt(7)
    v_mfma_f32_16x16x32_bf16 v[8:11], a[192:195], v[120:123], v[8:11]
    v_max3_u32 v6, v6, v120, v121
    v_mfma_f32_16x16x32_bf16 v[12:15], a[196:199], v[120:123], v[12:15]
    v_max3_u32 v6, v6, v122, v123
    s_waitcnt vmcnt(6)
    v_mfma_f32_16x16x32_bf16 v[8:11], a[200:203], v[124:127], v[8:11]
    v_max3_u32 v6, v6, v124, v125
    v_mfma_f32_16x16x32_bf16 v[12:15], a[204:207], v[124:127], v[12:15]
    v_max3_u32 v6, v6, v126, v127
    s_waitcnt vmcnt(5)
    v_mfma_f32_16x16x32_bf16 v[8:11], a[208:211], v[128:131], v[8:11]
    v_max3_u32 v6, v6, v128, v129
    v_mfma_f32_16x16x32_bf16 v[12:15], a[212:215], v[128:131], v[12:15]
    v_max3_u32 v6, v6, v130, v131
    s_waitcnt vmcnt(4)
    v_mfma_f32_16x16x32_bf16 v[8:11], a[216:219], v[132:135], v[8:11]
    v_max3_u32 v6, v6, v132, v133
    v_mfma_f32_16x16x32_bf16 v[12:15], a[220:223], v[132:135], v[12:15]
    v_max3_u32 v6, v6, v134, v135
    s_waitcnt vmcnt(3)
    v_mfma_f32_16x16x32_bf16 v[8:11], a[224:227], v[136:139], v[8:11]
    v_max3_u32 v6, v6, v136, v137
    v_mfma_f32_16x16x32_bf16 v[12:15], a[228:231], v[136:139], v[12:15]
    v_max3_u32 v6, v6, v138, v139
    s_waitcnt vmcnt(2)
    v_mfma_f32_16x16x32_bf16 v[8:11], a[232:235], v[140:143], v[8:11]
    v_max3_u32 v6, v6, v140, v141
    v_mfma_f32_16x16x32_bf16 v[12:15], a[236:239], v[140:143], v[12:15]
    v_max3_u32 v6, v6, v142, v143
    s_waitcnt vmcnt(1)
    v_mfma_f32_16x16x32_bf16 v[8:11], a[240:243], v[144:147], v[8:11]
    v_max3_u32 v6, v6, v144, v145
    v_mfma_f32_16x16x32_bf16 v[12:15], a[244:247], v[144:147], v[12:15]
    v_max3_u32 v6, v6, v146, v147
    s_waitcnt vmcnt(0)
    v_mfma_f32_16x16x32_bf16 v[8:11], a[248:251], v[148:151], v[8:11]
    v_max3_u32 v6, v6, v148, v149
    v_mfma_f32_16x16x32_bf16 v[12:15], a[252:255], v[148:151], v[12:15]
    v_max3_u32 v6, v6, v150, v151
    v_cmp_eq_u32 vcc, -1, v6
    s_cbranch_vccz o1_ok
    s_cmp_eq_u32 s46, 0
    s_cbranch_scc1 o1_ok
    s_mov_b32 s46, 0
    s_nop 1
    v_mbcnt_lo_u32_b32 v2, -1, 0
    v_mbcnt_hi_u32_b32 v2, -1, v2
    v_min_u32 v2, 1, v2
    v_lshlrev_b32 v2, 2, v2
    s_mov_b32 s88, 4194304
fw22:
    buffer_load_dword v3, v2, s[4:7], s89 offen offset:0 sc1
    s_sub_u32 s88, s88, 1
    s_cbranch_scc1 fw22x
    s_waitcnt vmcnt(0)
    v_cmp_ne_u32 vcc, s95, v3
    s_cbranch_vccz fw22x
    s_sleep 1
    s_branch fw22
fw22x:
    s_branch o1_again
o1_ok:
    s_nop 7
    ds_write_b128 v2, v[8:11] offset:0
    ds_write_b128 v2, v[12:15] offset:1024
    s_cmp_lg_u32 s32, 0
    s_cbranch_scc1 o1_nb
    v_cmp_eq_u32 vcc, 0, v253
    s_nop 0
    s_cmp_eq_u64 vcc, 0
    s_cselect_b32 s44, 65536, 0
    v_or_b32 v250, s44, v250
    v_mov_b32 v251, 163832
    s_mov_b64 exec, 1
    ds_write_b32 v251, v250
    s_mov_b64 exec, -1
o1_nb:
    s_waitcnt lgkmcnt(0)
    s_barrier
    s_cmp_gt_u32 s32, 0
    s_cbranch_scc1 o1_skip
    s_lshl_b32 s18, s32, 13
    v_add_u32 v2, s18, v1
    ds_read_b128 v[24:27], v2 offset:0
    ds_read_b128 v[28:31], v2 offset:1024
    ds_read_b128 v[32:35], v2 offset:2048
    ds_read_b128 v[36:39], v2 offset:3072
    ds_read_b128 v[40:43], v2 offset:4096
    ds_read_b128 v[44:47], v2 offset:5120
    ds_read_b128 v[48:51], v2 offset:6144
    ds_read_b128 v[52:55], v2 offset:7168
    v_lshrrev_b32 v3, 4, v1
    v_bfe_u32 v4, v3, 2, 2
    v_lshlrev_b32 v4, 3, v4
    v_and_b32 v2, 3, v3
    v_add_u32 v4, v4, v2
    v_mul_u32_u24 v4, 2304, v4
    v_lshrrev_b32 v3, 4, v3
    v_lshl_add_u32 v4, v3, 4, v4
    s_add_u32 s20, s16, s32
    s_lshr_b32 s18, s20, 1
    s_lshl_b32 s18, s18, 3
    s_and_b32 s19, s20, 1
    s_add_u32 s18, s18, s19
    s_mul_i32 s18, s18, 9216
    s_lshl_b32 s19, s33, 6
    s_add_u32 s18, s18, s19
    s_waitcnt lgkmcnt(0)
    v_pk_add_f32 v[24:25], v[24:25], v[32:33]
    v_pk_add_f32 v[40:41], v[40:41], v[48:49]
    v_pk_add_f32 v[24:25], v[24:25], v[40:41]
    v_pk_add_f32 v[26:27], v[26:27], v[34:35]
    v_pk_add_f32 v[42:43], v[42:43], v[50:51]
    v_pk_add_f32 v[26:27], v[26:27], v[42:43]
    v_pk_add_f32 v[28:29], v[28:29], v[36:37]
    v_pk_add_f32 v[44:45], v[44:45], v[52:53]
    v_pk_add_f32 v[28:29], v[28:29], v[44:45]
    v_pk_add_f32 v[30:31], v[30:31], v[38:39]
    v_pk_add_f32 v[46:47], v[46:47], v[54:55]
    v_pk_add_f32 v[30:31], v[30:31], v[46:47]
    v_cvt_pk_bf16_f32 v8, v24, v28
    v_cvt_pk_bf16_f32 v9, v25, v29
    v_cvt_pk_bf16_f32 v10, v26, v30
    v_cvt_pk_bf16_f32 v11, v27, v31
    buffer_store_dwordx4 v[8:11], v4, s[8:11], s18 offen
o1_skip:
    s_nop 1
L_op_fin:
    v_mov_b32 v251, 163832
    ds_read_b32 v252, v251
    s_waitcnt lgkmcnt(0)
    v_readfirstlane_b32 s40, v252
    s_nop 1
    s_cmp_ge_u32 s40, 65608
    s_cbranch_scc1 L_done
    s_barrier
    s_and_b32 s16, s40, 0xffff
    s_cmp_lt_u32 s16, 72
    s_cbranch_scc1 L_op_seg
L_op_nextcb:
    s_mov_b32 s40, -1
    s_cmp_lg_u32 s32, 0
    s_cbranch_scc1 L_op_dec
    v_and_b32 v1, 63, v0
    v_min_u32 v1, 17, v1
    v_lshlrev_b32 v2, 2, v1
    buffer_load_dword v3, v2, s[84:87], 0 offen offset:136 sc1
    s_waitcnt vmcnt(0)
    v_cmp_gt_u32 vcc, 52, v3
    s_nop 0
    s_and_b32 s40, vcc_lo, 262143
    s_lshl_b32 s41, s40, 18
    s_lshr_b32 s43, s40, 14
    s_or_b32 s42, s40, s41
    s_and_b32 s36, s45, 15
    s_bfm_b32 s37, s36, 0
    s_and_b32 s37, s37, 42315
    s_bcnt1_i32_b32 s37, s37
    s_lshr_b32 s36, s45, 4
    s_mul_i32 s36, s36, 8
    s_add_u32 s36, s36, s37
    s_add_u32 s36, s36, 38
    s_mul_hi_u32 s41, s36, 0x0e38e38f
    s_mul_i32 s41, s41, 18
    s_sub_u32 s41, s36, s41
    s_lshr_b64 s[42:43], s[42:43], s41
    s_ff1_i32_b64 s40, s[42:43]
    s_cmp_lt_i32 s40, 0
    s_cbranch_scc1 L_op_dec
    s_add_u32 s40, s40, s41
    s_sub_u32 s41, s40, 18
    s_cselect_b32 s40, s40, s41
L_op_dec:
    v_mov_b32 v250, s40
    v_mov_b32 v251, 163832
    s_cmp_lg_u32 s32, 0
    s_cbranch_scc1 L_op_nw
    ds_write_b32 v251, v250
    s_waitcnt lgkmcnt(0)
L_op_nw:
    s_barrier
    ds_read_b32 v252, v251
    s_waitcnt lgkmcnt(0)
    v_readfirstlane_b32 s33, v252
    s_barrier
    s_nop 1
    s_cmp_lt_u32 s33, 18
    s_cbranch_scc1 L_op_start
L_done:
L_exit:
    s_endpgm
.section .rodata,"a"
.p2align 6
.amdhsa_kernel concat_heads__memory_aug_recurrent_mem_tr__ssm_conv_s4d__prompt_kernel
  .amdhsa_next_free_vgpr 512
  .amdhsa_next_free_sgpr 102
  .amdhsa_accum_offset 256
  .amdhsa_group_segment_fixed_size 0
  .amdhsa_kernarg_size 136
  .amdhsa_user_sgpr_count 2
  .amdhsa_user_sgpr_kernarg_segment_ptr 1
  .amdhsa_system_sgpr_workgroup_id_x 1
.end_amdhsa_kernel
.text
```

```asm
; @launch grid=(256,1,1) block=(256,1,1) lds=163840
.amdgcn_target "amdgcn-amd-amdhsa--gfx950"
.text
.globl concat_heads__memory_aug_recurrent_mem_tr__ssm_conv_s4d__prompt_kernel
.p2align 8
.type concat_heads__memory_aug_recurrent_mem_tr__ssm_conv_s4d__prompt_kernel,@function
concat_heads__memory_aug_recurrent_mem_tr__ssm_conv_s4d__prompt_kernel:
    s_cmp_ge_u32 s2, 256
    s_cbranch_scc1 L_exit
    s_load_dwordx4 s[80:83], s[0:1], 120
    s_load_dwordx16 s[48:63], s[0:1], 0
    s_memrealtime s[90:91]
    v_lshrrev_b32 v1, 6, v0
    s_nop 0
    v_readfirstlane_b32 s32, v1
    s_waitcnt lgkmcnt(0)
    s_mov_b32 s4, s82
    s_mov_b32 s5, s83
    s_mov_b32 s6, 268435456
    s_mov_b32 s7, 0x20000
    s_mov_b32 s84, s80
    s_mov_b32 s85, s81
    s_mov_b32 s86, 256
    s_mov_b32 s87, 0x20000
    s_cmp_lg_u32 s32, 0
    s_cbranch_scc1 L_nod0
L_nod0:
    s_cmp_lg_u32 s32, 3
    s_cbranch_scc1 L_nowarm
    s_getpc_b64 s[44:45]
L_pcw:
    v_and_b32 v1, 63, v0
    v_lshlrev_b32 v1, 7, v1
    v_min_u32 v2, L_exit-L_pcw, v1
    global_load_dword v240, v2, s[44:45]
    v_add_u32 v1, 8192, v1
    v_min_u32 v2, L_exit-L_pcw, v1
    global_load_dword v241, v2, s[44:45]
    v_add_u32 v1, 8192, v1
    v_min_u32 v2, L_exit-L_pcw, v1
    global_load_dword v242, v2, s[44:45]
    v_add_u32 v1, 8192, v1
    v_min_u32 v2, L_exit-L_pcw, v1
    global_load_dword v243, v2, s[44:45]
    v_add_u32 v1, 8192, v1
    v_min_u32 v2, L_exit-L_pcw, v1
    global_load_dword v244, v2, s[44:45]
    v_add_u32 v1, 8192, v1
    v_min_u32 v2, L_exit-L_pcw, v1
    global_load_dword v245, v2, s[44:45]
    v_add_u32 v1, 8192, v1
    v_min_u32 v2, L_exit-L_pcw, v1
    global_load_dword v246, v2, s[44:45]
    v_add_u32 v1, 8192, v1
    v_min_u32 v2, L_exit-L_pcw, v1
    global_load_dword v247, v2, s[44:45]
    v_add_u32 v1, 8192, v1
    v_min_u32 v2, L_exit-L_pcw, v1
    global_load_dword v248, v2, s[44:45]
    v_add_u32 v1, 8192, v1
L_nowarm:
    s_getreg_b32 s3, hwreg(HW_REG_XCC_ID)
    s_and_b32 s3, s3, 15
    s_cmp_lg_u32 s3, 3
    s_cbranch_scc1 L_helper
    s_mov_b32 s37, 128
    v_mov_b32 v250, 1
    v_mov_b32 v251, 163832
    v_cmp_eq_u32 vcc, 0, v0
    s_nop 0
    s_and_saveexec_b64 s[38:39], vcc
    s_cbranch_execz tk1
    buffer_atomic_add v250, off, s[84:87], s37 sc0
    s_waitcnt vmcnt(0)
    ds_write_b32 v251, v250
    s_waitcnt lgkmcnt(0)
tk1:
    s_mov_b64 exec, -1
    s_barrier
    ds_read_b32 v252, v251
    s_waitcnt lgkmcnt(0)
    v_readfirstlane_b32 s12, v252
    s_barrier
    s_nop 3
    s_cmp_ge_u32 s12, 32
    s_cbranch_scc1 L_helper
L_chain:
    s_load_dwordx8 s[48:55], s[0:1], 8
    s_load_dwordx2 s[56:57], s[0:1], 40
    s_waitcnt lgkmcnt(0)
    v_lshrrev_b32 v77, 6, v0
    s_nop 0
    v_readfirstlane_b32 s13, v77
    v_lshlrev_b32 v65, 4, v0
    v_and_b32 v48, 63, v0
    s_mov_b32 s10, 4718592
    s_mov_b32 s11, 0x20000
    v_lshrrev_b32 v49, 3, v48
    v_mul_u32_u24 v18, 1152, v49
    v_and_b32 v49, 7, v48
    v_lshl_add_u32 v18, v49, 4, v18
    s_mul_i32 s40, s12, 147456
    s_lshl_b32 s41, s13, 8
    s_add_u32 s40, s40, s41
    s_mov_b32 s42, s40
    s_xor_b32 s41, s13, 0
    s_mul_i32 s41, s41, 36864
    s_add_u32 s60, s41, s40
    s_xor_b32 s41, s13, 1
    s_mul_i32 s41, s41, 36864
    s_add_u32 s61, s41, s40
    s_xor_b32 s41, s13, 2
    s_mul_i32 s41, s41, 36864
    s_add_u32 s62, s41, s40
    s_xor_b32 s41, s13, 3
    s_mul_i32 s41, s41, 36864
    s_add_u32 s63, s41, s40
    s_lshl_b32 s43, s13, 12
    s_mov_b64 s[8:9], s[56:57]
    s_add_u32 m0, s43, 0
    s_add_u32 s41, s60, 0
    buffer_load_dwordx4 v18, s[8:11], s41 offen offset:0 nt lds
    s_add_u32 s41, s60, 8192
    buffer_load_dwordx4 v18, s[8:11], s41 offen offset:1024 nt lds
    s_add_u32 s41, s60, 16384
    buffer_load_dwordx4 v18, s[8:11], s41 offen offset:2048 nt lds
    s_add_u32 s41, s60, 24576
    buffer_load_dwordx4 v18, s[8:11], s41 offen offset:3072 nt lds
    s_add_u32 m0, s43, 36864
    s_add_u32 s41, s61, 0
    buffer_load_dwordx4 v18, s[8:11], s41 offen offset:0 nt lds
    s_add_u32 s41, s61, 8192
    buffer_load_dwordx4 v18, s[8:11], s41 offen offset:1024 nt lds
    s_add_u32 s41, s61, 16384
    buffer_load_dwordx4 v18, s[8:11], s41 offen offset:2048 nt lds
    s_add_u32 s41, s61, 24576
    buffer_load_dwordx4 v18, s[8:11], s41 offen offset:3072 nt lds
    s_add_u32 m0, s43, 73728
    s_add_u32 s41, s62, 0
    buffer_load_dwordx4 v18, s[8:11], s41 offen offset:0 nt lds
    s_add_u32 s41, s62, 8192
    buffer_load_dwordx4 v18, s[8:11], s41 offen offset:1024 nt lds
    s_add_u32 s41, s62, 16384
    buffer_load_dwordx4 v18, s[8:11], s41 offen offset:2048 nt lds
    s_add_u32 s41, s62, 24576
    buffer_load_dwordx4 v18, s[8:11], s41 offen offset:3072 nt lds
    s_add_u32 m0, s43, 110592
    s_add_u32 s41, s63, 0
    buffer_load_dwordx4 v18, s[8:11], s41 offen offset:0 nt lds
    s_add_u32 s41, s63, 8192
    buffer_load_dwordx4 v18, s[8:11], s41 offen offset:1024 nt lds
    s_add_u32 s41, s63, 16384
    buffer_load_dwordx4 v18, s[8:11], s41 offen offset:2048 nt lds
    s_add_u32 s41, s63, 24576
    buffer_load_dwordx4 v18, s[8:11], s41 offen offset:3072 nt lds
    v_lshrrev_b32 v49, 1, v48
    v_mul_u32_u24 v19, 1152, v49
    v_and_b32 v49, 1, v48
    v_lshl_add_u32 v19, v49, 4, v19
    s_mul_i32 s41, s13, 224
    s_sub_u32 s41, 1024, s41
    v_add_u32 v19, s41, v19
    v_lshrrev_b32 v49, 4, v48
    v_lshlrev_b32 v50, 2, v49
    v_and_b32 v51, 15, v48
    v_xor_b32 v51, v51, v50
    v_lshlrev_b32 v51, 4, v51
    v_lshl_add_u32 v16, v49, 15, v51
    v_lshrrev_b32 v50, 1, v49
    v_lshl_add_u32 v17, v50, 16, v51
    v_and_b32 v50, 1, v49
    v_lshl_add_u32 v17, v50, 13, v17
    s_lshl_b32 s40, s12, 8
    s_mul_i32 s58, s13, 1048576
    s_add_u32 s58, s58, s40
    s_lshr_b32 s41, s13, 1
    s_mul_i32 s59, s41, 262144
    s_and_b32 s41, s13, 1
    s_lshl_b32 s41, s41, 14
    s_add_u32 s59, s59, s41
    s_add_u32 s59, s59, s40
    s_add_u32 s59, s59, 4194304
    v_bfe_u32 v50, v48, 2, 2
    v_xor_b32 v51, s13, v50
    v_lshlrev_b32 v20, 6, v51
    v_and_b32 v51, 3, v48
    v_lshl_add_u32 v20, v51, 4, v20
    v_lshrrev_b32 v23, 2, v48
    v_lshl_add_u32 v20, v23, 8, v20
    s_xor_b32 s41, s43, 0
    v_add_u32 v24, s41, v20
    s_xor_b32 s41, s43, 4096
    v_add_u32 v25, s41, v20
    s_xor_b32 s41, s43, 8192
    v_add_u32 v26, s41, v20
    s_xor_b32 s41, s43, 12288
    v_add_u32 v27, s41, v20
    v_and_b32 v23, 1, v50
    v_lshl_add_u32 v23, v49, 2, v23
    v_lshrrev_b32 v50, 1, v50
    v_lshlrev_b32 v21, 7, v23
    v_lshl_add_u32 v21, v50, 6, v21
    v_lshrrev_b32 v16, 1, v51
    v_lshl_add_u32 v21, v16, 5, v21
    v_and_b32 v16, 1, v51
    v_lshl_add_u32 v21, v16, 3, v21
    v_add_u32 v21, s43, v21
    v_lshlrev_b32 v22, 9, v50
    v_xor_b32 v22, v22, v21
    v_lshlrev_b32 v23, 5, v23
    v_lshl_add_u32 v23, v50, 10, v23
    v_lshl_add_u32 v23, v51, 3, v23
    v_add_u32 v23, s43, v23
    v_bfe_u32 v60, v65, 4, 6
    v_and_b32 v61, 15, v60
    v_lshrrev_b32 v62, 4, v60
    v_mov_b32 v64, 0x4444
    v_mov_b32 v77, 0xeeee
    v_cmp_lt_u32 vcc, 7, v61
    s_nop 1
    v_cndmask_b32 v64, v64, v77, vcc
    v_xor_b32 v66, 1024, v65
    v_xor_b32 v67, 2048, v65
    v_xor_b32 v68, 3072, v65
    v_and_b32 v69, 511, v65
    s_mul_i32 s96, s13, 36864
    s_add_u32 s96, s96, 16384
    v_lshlrev_b32 v70, 4, v60
    v_add_u32 v70, s96, v70
    v_lshrrev_b32 v79, 1, v69
    s_lshl_b32 s96, s13, 8
    s_add_u32 s96, s96, 14336
    s_lshl_b32 s33, s13, 10
    s_add_u32 s97, s33, 8192
    v_mov_b32 v77, s97
    v_mov_b32 v78, s96
    v_cmp_lt_u32 vcc, 31, v60
    s_nop 1
    v_cndmask_b32 v71, v77, v78, vcc
    v_add_u32 v71, v71, v79
    v_and_b32 v77, 7, v61
    v_lshrrev_b32 v78, 3, v61
    v_lshlrev_b32 v74, 4, v77
    v_lshl_add_u32 v73, v62, 7, v74
    v_lshl_add_u32 v73, v78, 3, v73
    s_lshl_b32 s96, s13, 9
    v_add_u32 v73, s96, v73
    v_lshrrev_b32 v74, 1, v74
    v_lshl_add_u32 v74, v78, 14, v74
    v_lshl_add_u32 v74, v62, 15, v74
    s_lshl_b32 s96, s13, 17
    v_add_u32 v74, s96, v74
    v_bfe_u32 v77, v61, 2, 1
    v_and_b32 v78, 3, v61
    s_cmp_lt_u32 s13, 2
    s_cselect_b64 vcc, -1, 0
    v_cndmask_b32 v77, 0, v77, vcc
    v_lshlrev_b32 v75, 7, v77
    v_lshl_add_u32 v75, v62, 4, v75
    v_lshl_add_u32 v75, v78, 2, v75
    v_lshlrev_b32 v58, 3, v77
    v_lshl_add_u32 v58, v78, 1, v58
    s_bfe_u32 s97, s12, 0x10001
    s_lshl_b32 s68, s97, 6
    s_lshl_b32 s97, s97, 2
    v_add_u32 v59, s97, v62
    s_bfe_u32 s96, s12, 0x10002
    s_and_b32 s40, s12, 1
    s_lshl_b32 s96, s96, 1
    s_add_u32 s96, s96, s40
    s_lshr_b32 s97, s12, 3
    s_lshl_b32 s98, s13, 2
    s_add_u32 s98, s98, s97
    s_lshl_b32 s98, s98, 2
    s_add_u32 s98, s98, s96
    s_lshl_b32 s98, s98, 8
    s_lshl_b32 s99, s13, 2
    s_add_u32 s99, s99, s96
    s_lshl_b32 s99, s99, 4
    s_lshl_b32 s41, s97, 1
    s_add_u32 s41, s41, s40
    s_lshl_b32 s41, s41, 7
    s_add_u32 s41, s41, 8192
    s_lshl_b32 s40, s40, 3
    s_add_u32 s40, s40, 512
    s_cmp_lt_u32 s13, 2
    s_cselect_b32 s96, 7, 4
    s_cselect_b32 s98, s98, s41
    s_cselect_b32 s99, s99, s40
    s_cselect_b32 s32, 1, 0
    s_add_u32 s68, s68, s98
    s_lshl_b32 s97, s97, s96
    s_add_u32 s99, s99, s97
    v_add_u32 v58, s99, v58
    s_and_b32 s97, s12, 4
    s_or_b32 s97, s97, s13
    s_cmp_eq_u32 s97, 2
    s_cselect_b32 s32, 2, s32
    s_mov_b32 s8, s48
    s_mov_b32 s9, s49
    s_mov_b32 s10, 9216
    v_mul_u32_u24 v77, 1152, v59
    v_lshl_add_u32 v77, v58, 1, v77
    buffer_load_dword v72, v77, s[8:11], 0 offen
    s_mov_b32 s10, 4718592
    s_waitcnt vmcnt(12) lgkmcnt(0)
    s_barrier
    s_mov_b64 s[8:9], s[56:57]
    s_add_u32 m0, s43, 147456
    s_add_u32 s41, s42, 0
    buffer_load_dwordx4 v19, s[8:11], s41 offen offset:0 nt lds
    s_add_u32 s41, s42, 35840
    buffer_load_dwordx4 v19, s[8:11], s41 offen offset:1024 nt lds
    s_add_u32 s41, s42, 71680
    buffer_load_dwordx4 v19, s[8:11], s41 offen offset:2048 nt lds
    s_add_u32 s41, s42, 107520
    buffer_load_dwordx4 v19, s[8:11], s41 offen offset:3072 nt lds
    v_mov_b32 v78, v21
    v_mov_b32 v79, v22
    v_add_u32 v77, 0, v79
    ds_read_b64_tr_b16 v[80:81], v77 offset:0
    ds_read_b64_tr_b16 v[82:83], v77 offset:256
    ds_read_b64_tr_b16 v[84:85], v77 offset:2048
    ds_read_b64_tr_b16 v[86:87], v77 offset:2304
    ds_read_b64_tr_b16 v[112:113], v77 offset:16
    ds_read_b64_tr_b16 v[114:115], v77 offset:272
    ds_read_b64_tr_b16 v[116:117], v77 offset:2064
    ds_read_b64_tr_b16 v[118:119], v77 offset:2320
    s_waitcnt vmcnt(12) lgkmcnt(0)
    s_barrier
    s_mov_b64 s[8:9], s[52:53]
    s_add_u32 m0, s43, 0
    s_add_u32 s41, s58, 0
    buffer_load_dwordx4 v17, s[8:11], s41 offen offset:0 nt lds
    s_add_u32 s41, s58, 31744
    buffer_load_dwordx4 v17, s[8:11], s41 offen offset:1024 nt lds
    s_add_u32 s41, s58, 129024
    buffer_load_dwordx4 v17, s[8:11], s41 offen offset:2048 nt lds
    s_add_u32 s41, s58, 160768
    buffer_load_dwordx4 v17, s[8:11], s41 offen offset:3072 nt lds
    v_add_u32 v77, 36864, v78
    ds_read_b64_tr_b16 v[88:89], v77 offset:0
    ds_read_b64_tr_b16 v[90:91], v77 offset:256
    ds_read_b64_tr_b16 v[92:93], v77 offset:2048
    ds_read_b64_tr_b16 v[94:95], v77 offset:2304
    ds_read_b64_tr_b16 v[120:121], v77 offset:16
    ds_read_b64_tr_b16 v[122:123], v77 offset:272
    ds_read_b64_tr_b16 v[124:125], v77 offset:2064
    ds_read_b64_tr_b16 v[126:127], v77 offset:2320
    s_waitcnt vmcnt(12) lgkmcnt(0)
    s_barrier
    s_add_u32 m0, s43, 36864
    s_add_u32 s41, s58, 16384
    buffer_load_dwordx4 v17, s[8:11], s41 offen offset:0 nt lds
    s_add_u32 s41, s58, 48128
    buffer_load_dwordx4 v17, s[8:11], s41 offen offset:1024 nt lds
    s_add_u32 s41, s58, 145408
    buffer_load_dwordx4 v17, s[8:11], s41 offen offset:2048 nt lds
    s_add_u32 s41, s58, 177152
    buffer_load_dwordx4 v17, s[8:11], s41 offen offset:3072 nt lds
    v_add_u32 v77, 73728, v78
    ds_read_b64_tr_b16 v[96:97], v77 offset:0
    ds_read_b64_tr_b16 v[98:99], v77 offset:256
    ds_read_b64_tr_b16 v[100:101], v77 offset:2048
    ds_read_b64_tr_b16 v[102:103], v77 offset:2304
    ds_read_b64_tr_b16 v[128:129], v77 offset:16
    ds_read_b64_tr_b16 v[130:131], v77 offset:272
    ds_read_b64_tr_b16 v[132:133], v77 offset:2064
    ds_read_b64_tr_b16 v[134:135], v77 offset:2320
    s_waitcnt vmcnt(12) lgkmcnt(0)
    s_barrier
    s_add_u32 m0, s43, 73728
    s_add_u32 s41, s58, 262144
    buffer_load_dwordx4 v17, s[8:11], s41 offen offset:0 nt lds
    s_add_u32 s41, s58, 293888
    buffer_load_dwordx4 v17, s[8:11], s41 offen offset:1024 nt lds
    s_add_u32 s41, s58, 391168
    buffer_load_dwordx4 v17, s[8:11], s41 offen offset:2048 nt lds
    s_add_u32 s41, s58, 422912
    buffer_load_dwordx4 v17, s[8:11], s41 offen offset:3072 nt lds
    v_add_u32 v77, 110592, v78
    ds_read_b64_tr_b16 v[104:105], v77 offset:0
    ds_read_b64_tr_b16 v[106:107], v77 offset:256
    ds_read_b64_tr_b16 v[108:109], v77 offset:2048
    ds_read_b64_tr_b16 v[110:111], v77 offset:2304
    ds_read_b64_tr_b16 v[136:137], v77 offset:16
    ds_read_b64_tr_b16 v[138:139], v77 offset:272
    ds_read_b64_tr_b16 v[140:141], v77 offset:2064
    ds_read_b64_tr_b16 v[142:143], v77 offset:2320
    s_waitcnt vmcnt(12) lgkmcnt(0)
    s_barrier
    s_add_u32 m0, s43, 110592
    s_add_u32 s41, s58, 278528
    buffer_load_dwordx4 v17, s[8:11], s41 offen offset:0 nt lds
    s_add_u32 s41, s58, 310272
    buffer_load_dwordx4 v17, s[8:11], s41 offen offset:1024 nt lds
    s_add_u32 s41, s58, 407552
    buffer_load_dwordx4 v17, s[8:11], s41 offen offset:2048 nt lds
    s_add_u32 s41, s58, 439296
    buffer_load_dwordx4 v17, s[8:11], s41 offen offset:3072 nt lds
    v_add_u32 v77, 147456, v23
    ds_read_b64_tr_b16 v[0:1], v77 offset:0
    ds_read_b64_tr_b16 v[2:3], v77 offset:64
    ds_read_b64_tr_b16 v[4:5], v77 offset:512
    ds_read_b64_tr_b16 v[6:7], v77 offset:576
    ds_read_b64_tr_b16 v[8:9], v77 offset:2048
    ds_read_b64_tr_b16 v[10:11], v77 offset:2112
    ds_read_b64_tr_b16 v[12:13], v77 offset:2560
    ds_read_b64_tr_b16 v[14:15], v77 offset:2624
    s_waitcnt vmcnt(12) lgkmcnt(0)
    s_barrier
    s_add_u32 m0, s43, 147456
    s_add_u32 s41, s58, 524288
    buffer_load_dwordx4 v17, s[8:11], s41 offen offset:0 nt lds
    s_add_u32 s41, s58, 556032
    buffer_load_dwordx4 v17, s[8:11], s41 offen offset:1024 nt lds
    s_add_u32 s41, s58, 653312
    buffer_load_dwordx4 v17, s[8:11], s41 offen offset:2048 nt lds
    s_add_u32 s41, s58, 685056
    buffer_load_dwordx4 v17, s[8:11], s41 offen offset:3072 nt lds
    s_cmp_eq_u32 s32, 0
    s_cbranch_scc1 cf_init_done
    v_mov_b32 v52, 1
    v_mov_b32 v53, 1
    v_mov_b32 v54, 1
    v_mov_b32 v55, 1
    v_mov_b32 v56, 0
    s_lshl_b32 s96, s12, 14
    s_add_u32 s96, s96, 68157440
    s_add_u32 s97, s96, 0
    buffer_store_dwordx4 v[52:55], v65, s[4:7], s97 offen
    buffer_load_dwordx4 v[60:63], v65, s[4:7], s97 offen sc1
    s_add_u32 s97, s96, 4096
    buffer_store_dwordx4 v[52:55], v65, s[4:7], s97 offen
    buffer_load_dwordx4 v[60:63], v65, s[4:7], s97 offen sc1
    s_add_u32 s97, s96, 8192
    buffer_store_dwordx4 v[52:55], v65, s[4:7], s97 offen
    buffer_load_dwordx4 v[60:63], v65, s[4:7], s97 offen sc1
    s_add_u32 s97, s96, 12288
    buffer_store_dwordx4 v[52:55], v65, s[4:7], s97 offen
    buffer_load_dwordx4 v[60:63], v65, s[4:7], s97 offen sc1
    s_add_u32 s96, s68, 67108864
    s_add_u32 s97, s96, 16384
    buffer_store_dword v56, v75, s[4:7], s96 offen offset:0
    buffer_store_dword v72, v75, s[4:7], s97 offen offset:0
    buffer_load_dword v60, v75, s[4:7], s96 offen offset:0 sc1
    buffer_load_dword v60, v75, s[4:7], s97 offen offset:0 sc1
    s_cmp_lg_u32 s32, 2
    s_cbranch_scc1 cf_init_done
    buffer_store_dword v56, v75, s[4:7], s96 offen offset:1024
    buffer_store_dword v72, v75, s[4:7], s97 offen offset:1024
    buffer_load_dword v60, v75, s[4:7], s96 offen offset:1024 sc1
    buffer_load_dword v60, v75, s[4:7], s97 offen offset:1024 sc1
    buffer_store_dword v56, v75, s[4:7], s96 offen offset:2048
    buffer_store_dword v72, v75, s[4:7], s97 offen offset:2048
    buffer_load_dword v60, v75, s[4:7], s96 offen offset:2048 sc1
    buffer_load_dword v60, v75, s[4:7], s97 offen offset:2048 sc1
    buffer_store_dword v56, v75, s[4:7], s96 offen offset:3072
    buffer_store_dword v72, v75, s[4:7], s97 offen offset:3072
    buffer_load_dword v60, v75, s[4:7], s96 offen offset:3072 sc1
    buffer_load_dword v60, v75, s[4:7], s97 offen offset:3072 sc1
cf_init_done:
    ds_write_b64 v70, v[0:1] offset:16384
    ds_write_b64 v70, v[2:3] offset:16392
    ds_write_b64 v70, v[4:5] offset:17408
    ds_write_b64 v70, v[6:7] offset:17416
    ds_write_b64 v70, v[8:9] offset:18432
    ds_write_b64 v70, v[10:11] offset:18440
    ds_write_b64 v70, v[12:13] offset:19456
    ds_write_b64 v70, v[14:15] offset:19464
    v_add_u32 v28, 0, v24
    v_add_u32 v29, 0, v25
    v_add_u32 v30, 0, v26
    v_add_u32 v31, 0, v27
    ds_read_b64_tr_b16 a[96:97], v28 offset:0
    ds_read_b64_tr_b16 a[104:105], v28 offset:8
    ds_read_b64_tr_b16 a[112:113], v29 offset:0
    ds_read_b64_tr_b16 a[120:121], v29 offset:8
    ds_read_b64_tr_b16 a[128:129], v30 offset:0
    ds_read_b64_tr_b16 a[136:137], v30 offset:8
    ds_read_b64_tr_b16 a[144:145], v31 offset:0
    ds_read_b64_tr_b16 v[32:33], v31 offset:8
    s_waitcnt vmcnt(12) lgkmcnt(0)
    s_barrier
    s_add_u32 m0, s43, 0
    s_add_u32 s41, s58, 540672
    buffer_load_dwordx4 v17, s[8:11], s41 offen offset:0 nt lds
    s_add_u32 s41, s58, 572416
    buffer_load_dwordx4 v17, s[8:11], s41 offen offset:1024 nt lds
    s_add_u32 s41, s58, 669696
    buffer_load_dwordx4 v17, s[8:11], s41 offen offset:2048 nt lds
    s_add_u32 s41, s58, 701440
    buffer_load_dwordx4 v17, s[8:11], s41 offen offset:3072 nt lds
    ds_write_b64 v70, v[32:33] offset:12288
    v_add_u32 v28, 36864, v24
    v_add_u32 v29, 36864, v25
    v_add_u32 v30, 36864, v26
    v_add_u32 v31, 36864, v27
    ds_read_b64_tr_b16 a[98:99], v28 offset:0
    ds_read_b64_tr_b16 a[106:107], v28 offset:8
    ds_read_b64_tr_b16 a[114:115], v29 offset:0
    ds_read_b64_tr_b16 a[122:123], v29 offset:8
    ds_read_b64_tr_b16 a[130:131], v30 offset:0
    ds_read_b64_tr_b16 a[138:139], v30 offset:8
    ds_read_b64_tr_b16 a[146:147], v31 offset:0
    ds_read_b64_tr_b16 v[0:1], v31 offset:8
    s_waitcnt vmcnt(12) lgkmcnt(0)
    s_barrier
    s_add_u32 m0, s43, 36864
    s_add_u32 s41, s58, 786432
    buffer_load_dwordx4 v17, s[8:11], s41 offen offset:0 nt lds
    s_add_u32 s41, s58, 818176
    buffer_load_dwordx4 v17, s[8:11], s41 offen offset:1024 nt lds
    s_add_u32 s41, s58, 915456
    buffer_load_dwordx4 v17, s[8:11], s41 offen offset:2048 nt lds
    s_add_u32 s41, s58, 947200
    buffer_load_dwordx4 v17, s[8:11], s41 offen offset:3072 nt lds
    ds_write_b64 v70, v[0:1] offset:12296
    v_add_u32 v28, 73728, v24
    v_add_u32 v29, 73728, v25
    v_add_u32 v30, 73728, v26
    v_add_u32 v31, 73728, v27
    ds_read_b64_tr_b16 a[100:101], v28 offset:0
    ds_read_b64_tr_b16 a[108:109], v28 offset:8
    ds_read_b64_tr_b16 a[116:117], v29 offset:0
    ds_read_b64_tr_b16 a[124:125], v29 offset:8
    ds_read_b64_tr_b16 a[132:133], v30 offset:0
    ds_read_b64_tr_b16 a[140:141], v30 offset:8
    ds_read_b64_tr_b16 a[148:149], v31 offset:0
    ds_read_b64_tr_b16 v[32:33], v31 offset:8
    s_waitcnt vmcnt(12) lgkmcnt(0)
    s_barrier
    s_add_u32 m0, s43, 73728
    s_add_u32 s41, s58, 802816
    buffer_load_dwordx4 v17, s[8:11], s41 offen offset:0 nt lds
    s_add_u32 s41, s58, 834560
    buffer_load_dwordx4 v17, s[8:11], s41 offen offset:1024 nt lds
    s_add_u32 s41, s58, 931840
    buffer_load_dwordx4 v17, s[8:11], s41 offen offset:2048 nt lds
    s_add_u32 s41, s58, 963584
    buffer_load_dwordx4 v17, s[8:11], s41 offen offset:3072 nt lds
    ds_write_b64 v70, v[32:33] offset:13312
    v_add_u32 v28, 110592, v24
    v_add_u32 v29, 110592, v25
    v_add_u32 v30, 110592, v26
    v_add_u32 v31, 110592, v27
    ds_read_b64_tr_b16 a[102:103], v28 offset:0
    ds_read_b64_tr_b16 a[110:111], v28 offset:8
    ds_read_b64_tr_b16 a[118:119], v29 offset:0
    ds_read_b64_tr_b16 a[126:127], v29 offset:8
    ds_read_b64_tr_b16 a[134:135], v30 offset:0
    ds_read_b64_tr_b16 a[142:143], v30 offset:8
    ds_read_b64_tr_b16 a[150:151], v31 offset:0
    ds_read_b64_tr_b16 v[0:1], v31 offset:8
    s_waitcnt vmcnt(12) lgkmcnt(0)
    s_barrier
    s_add_u32 m0, s43, 110592
    s_add_u32 s41, s59, 0
    buffer_load_dwordx4 v17, s[8:11], s41 offen offset:0 nt lds
    s_add_u32 s41, s59, 31744
    buffer_load_dwordx4 v17, s[8:11], s41 offen offset:1024 nt lds
    s_add_u32 s41, s59, 129024
    buffer_load_dwordx4 v17, s[8:11], s41 offen offset:2048 nt lds
    s_add_u32 s41, s59, 160768
    buffer_load_dwordx4 v17, s[8:11], s41 offen offset:3072 nt lds
    ds_write_b64 v70, v[0:1] offset:13320
    v_add_u32 v28, 147456, v24
    v_add_u32 v29, 147456, v25
    v_add_u32 v30, 147456, v26
    v_add_u32 v31, 147456, v27
    ds_read_b64_tr_b16 a[152:153], v28 offset:0
    ds_read_b64_tr_b16 a[160:161], v28 offset:8
    ds_read_b64_tr_b16 a[168:169], v29 offset:0
    ds_read_b64_tr_b16 a[176:177], v29 offset:8
    ds_read_b64_tr_b16 a[184:185], v30 offset:0
    ds_read_b64_tr_b16 a[192:193], v30 offset:8
    ds_read_b64_tr_b16 a[200:201], v31 offset:0
    ds_read_b64_tr_b16 a[208:209], v31 offset:8
    s_waitcnt vmcnt(12) lgkmcnt(0)
    s_barrier
    s_mov_b64 s[8:9], s[50:51]
    s_add_u32 m0, s43, 147456
    s_add_u32 s41, s58, 0
    buffer_load_dwordx4 v17, s[8:11], s41 offen offset:0 nt lds
    s_add_u32 s41, s58, 31744
    buffer_load_dwordx4 v17, s[8:11], s41 offen offset:1024 nt lds
    s_add_u32 s41, s58, 129024
    buffer_load_dwordx4 v17, s[8:11], s41 offen offset:2048 nt lds
    s_add_u32 s41, s58, 160768
    buffer_load_dwordx4 v17, s[8:11], s41 offen offset:3072 nt lds
    s_cmp_lg_u32 s13, 0
    s_cbranch_scc1 cf_ma
    v_mov_b32 v54, 1
    s_mov_b64 exec, 1
    buffer_atomic_add v54, off, s[84:87], 0 offset:132
    s_mov_b64 exec, -1
cf_ma:
    v_add_u32 v28, 0, v24
    v_add_u32 v29, 0, v25
    v_add_u32 v30, 0, v26
    v_add_u32 v31, 0, v27
    ds_read_b64_tr_b16 a[154:155], v28 offset:0
    ds_read_b64_tr_b16 a[162:163], v28 offset:8
    ds_read_b64_tr_b16 a[170:171], v29 offset:0
    ds_read_b64_tr_b16 a[178:179], v29 offset:8
    ds_read_b64_tr_b16 a[186:187], v30 offset:0
    ds_read_b64_tr_b16 a[194:195], v30 offset:8
    ds_read_b64_tr_b16 a[202:203], v31 offset:0
    ds_read_b64_tr_b16 a[210:211], v31 offset:8
    s_waitcnt vmcnt(12) lgkmcnt(0)
    s_barrier
    s_add_u32 m0, s43, 0
    s_add_u32 s41, s58, 16384
    buffer_load_dwordx4 v17, s[8:11], s41 offen offset:0 nt lds
    s_add_u32 s41, s58, 48128
    buffer_load_dwordx4 v17, s[8:11], s41 offen offset:1024 nt lds
    s_add_u32 s41, s58, 145408
    buffer_load_dwordx4 v17, s[8:11], s41 offen offset:2048 nt lds
    s_add_u32 s41, s58, 177152
    buffer_load_dwordx4 v17, s[8:11], s41 offen offset:3072 nt lds
    v_add_u32 v28, 36864, v24
    v_add_u32 v29, 36864, v25
    v_add_u32 v30, 36864, v26
    v_add_u32 v31, 36864, v27
    ds_read_b64_tr_b16 a[156:157], v28 offset:0
    ds_read_b64_tr_b16 a[164:165], v28 offset:8
    ds_read_b64_tr_b16 a[172:173], v29 offset:0
    ds_read_b64_tr_b16 a[180:181], v29 offset:8
    ds_read_b64_tr_b16 a[188:189], v30 offset:0
    ds_read_b64_tr_b16 a[196:197], v30 offset:8
    ds_read_b64_tr_b16 a[204:205], v31 offset:0
    ds_read_b64_tr_b16 a[212:213], v31 offset:8
    s_waitcnt vmcnt(12) lgkmcnt(0)
    s_barrier
    s_add_u32 m0, s43, 36864
    s_add_u32 s41, s58, 262144
    buffer_load_dwordx4 v17, s[8:11], s41 offen offset:0 nt lds
    s_add_u32 s41, s58, 293888
    buffer_load_dwordx4 v17, s[8:11], s41 offen offset:1024 nt lds
    s_add_u32 s41, s58, 391168
    buffer_load_dwordx4 v17, s[8:11], s41 offen offset:2048 nt lds
    s_add_u32 s41, s58, 422912
    buffer_load_dwordx4 v17, s[8:11], s41 offen offset:3072 nt lds
    v_add_u32 v28, 73728, v24
    v_add_u32 v29, 73728, v25
    v_add_u32 v30, 73728, v26
    v_add_u32 v31, 73728, v27
    ds_read_b64_tr_b16 a[158:159], v28 offset:0
    ds_read_b64_tr_b16 a[166:167], v28 offset:8
    ds_read_b64_tr_b16 a[174:175], v29 offset:0
    ds_read_b64_tr_b16 a[182:183], v29 offset:8
    ds_read_b64_tr_b16 a[190:191], v30 offset:0
    ds_read_b64_tr_b16 a[198:199], v30 offset:8
    ds_read_b64_tr_b16 a[206:207], v31 offset:0
    ds_read_b64_tr_b16 a[214:215], v31 offset:8
    s_waitcnt vmcnt(12) lgkmcnt(0)
    s_barrier
    s_add_u32 m0, s43, 73728
    s_add_u32 s41, s58, 278528
    buffer_load_dwordx4 v17, s[8:11], s41 offen offset:0 nt lds
    s_add_u32 s41, s58, 310272
    buffer_load_dwordx4 v17, s[8:11], s41 offen offset:1024 nt lds
    s_add_u32 s41, s58, 407552
    buffer_load_dwordx4 v17, s[8:11], s41 offen offset:2048 nt lds
    s_add_u32 s41, s58, 439296
    buffer_load_dwordx4 v17, s[8:11], s41 offen offset:3072 nt lds
    v_add_u32 v77, 110592, v20
    ds_read_b64_tr_b16 a[216:217], v77 offset:0
    ds_read_b64_tr_b16 a[218:219], v77 offset:4096
    ds_read_b64_tr_b16 a[220:221], v77 offset:8192
    ds_read_b64_tr_b16 a[222:223], v77 offset:12288
    ds_read_b64_tr_b16 a[224:225], v77 offset:8
    ds_read_b64_tr_b16 a[226:227], v77 offset:4104
    ds_read_b64_tr_b16 a[228:229], v77 offset:8200
    ds_read_b64_tr_b16 a[230:231], v77 offset:12296
    s_waitcnt vmcnt(12) lgkmcnt(0)
    s_barrier
    s_add_u32 m0, s43, 110592
    s_add_u32 s41, s58, 524288
    buffer_load_dwordx4 v17, s[8:11], s41 offen offset:0 nt lds
    s_add_u32 s41, s58, 556032
    buffer_load_dwordx4 v17, s[8:11], s41 offen offset:1024 nt lds
    s_add_u32 s41, s58, 653312
    buffer_load_dwordx4 v17, s[8:11], s41 offen offset:2048 nt lds
    s_add_u32 s41, s58, 685056
    buffer_load_dwordx4 v17, s[8:11], s41 offen offset:3072 nt lds
    v_add_u32 v28, 147456, v24
    v_add_u32 v29, 147456, v25
    v_add_u32 v30, 147456, v26
    v_add_u32 v31, 147456, v27
    ds_read_b64_tr_b16 v[0:1], v28 offset:0
    ds_read_b64_tr_b16 v[2:3], v28 offset:8
    ds_read_b64_tr_b16 v[4:5], v29 offset:0
    ds_read_b64_tr_b16 v[6:7], v29 offset:8
    ds_read_b64_tr_b16 a[0:1], v30 offset:0
    ds_read_b64_tr_b16 v[8:9], v30 offset:8
    ds_read_b64_tr_b16 a[8:9], v31 offset:0
    ds_read_b64_tr_b16 v[10:11], v31 offset:8
    s_waitcnt vmcnt(12) lgkmcnt(0)
    s_barrier
    s_add_u32 m0, s43, 147456
    s_add_u32 s41, s58, 540672
    buffer_load_dwordx4 v17, s[8:11], s41 offen offset:0 nt lds
    s_add_u32 s41, s58, 572416
    buffer_load_dwordx4 v17, s[8:11], s41 offen offset:1024 nt lds
    s_add_u32 s41, s58, 669696
    buffer_load_dwordx4 v17, s[8:11], s41 offen offset:2048 nt lds
    s_add_u32 s41, s58, 701440
    buffer_load_dwordx4 v17, s[8:11], s41 offen offset:3072 nt lds
    ds_write_b64 v70, v[0:1] offset:0
    ds_write_b64 v70, v[2:3] offset:2048
    ds_write_b64 v70, v[4:5] offset:4096
    ds_write_b64 v70, v[6:7] offset:6144
    ds_write_b64 v70, v[8:9] offset:10240
    ds_write_b64 v70, v[10:11] offset:14336
    v_add_u32 v28, 0, v24
    v_add_u32 v29, 0, v25
    v_add_u32 v30, 0, v26
    v_add_u32 v31, 0, v27
    ds_read_b64_tr_b16 v[32:33], v28 offset:0
    ds_read_b64_tr_b16 v[34:35], v28 offset:8
    ds_read_b64_tr_b16 v[36:37], v29 offset:0
    ds_read_b64_tr_b16 v[38:39], v29 offset:8
    ds_read_b64_tr_b16 a[2:3], v30 offset:0
    ds_read_b64_tr_b16 v[40:41], v30 offset:8
    ds_read_b64_tr_b16 a[10:11], v31 offset:0
    ds_read_b64_tr_b16 v[42:43], v31 offset:8
    s_waitcnt vmcnt(12) lgkmcnt(0)
    s_barrier
    s_add_u32 m0, s43, 0
    s_add_u32 s41, s58, 786432
    buffer_load_dwordx4 v17, s[8:11], s41 offen offset:0 nt lds
    s_add_u32 s41, s58, 818176
    buffer_load_dwordx4 v17, s[8:11], s41 offen offset:1024 nt lds
    s_add_u32 s41, s58, 915456
    buffer_load_dwordx4 v17, s[8:11], s41 offen offset:2048 nt lds
    s_add_u32 s41, s58, 947200
    buffer_load_dwordx4 v17, s[8:11], s41 offen offset:3072 nt lds
    ds_write_b64 v70, v[32:33] offset:8
    ds_write_b64 v70, v[34:35] offset:2056
    ds_write_b64 v70, v[36:37] offset:4104
    ds_write_b64 v70, v[38:39] offset:6152
    ds_write_b64 v70, v[40:41] offset:10248
    ds_write_b64 v70, v[42:43] offset:14344
    v_add_u32 v28, 36864, v24
    v_add_u32 v29, 36864, v25
    v_add_u32 v30, 36864, v26
    v_add_u32 v31, 36864, v27
    ds_read_b64_tr_b16 v[0:1], v28 offset:0
    ds_read_b64_tr_b16 v[2:3], v28 offset:8
    ds_read_b64_tr_b16 v[4:5], v29 offset:0
    ds_read_b64_tr_b16 v[6:7], v29 offset:8
    ds_read_b64_tr_b16 a[4:5], v30 offset:0
    ds_read_b64_tr_b16 v[8:9], v30 offset:8
    ds_read_b64_tr_b16 a[12:13], v31 offset:0
    ds_read_b64_tr_b16 v[10:11], v31 offset:8
    s_waitcnt vmcnt(12) lgkmcnt(0)
    s_barrier
    s_add_u32 m0, s43, 36864
    s_add_u32 s41, s58, 802816
    buffer_load_dwordx4 v17, s[8:11], s41 offen offset:0 nt lds
    s_add_u32 s41, s58, 834560
    buffer_load_dwordx4 v17, s[8:11], s41 offen offset:1024 nt lds
    s_add_u32 s41, s58, 931840
    buffer_load_dwordx4 v17, s[8:11], s41 offen offset:2048 nt lds
    s_add_u32 s41, s58, 963584
    buffer_load_dwordx4 v17, s[8:11], s41 offen offset:3072 nt lds
    ds_write_b64 v70, v[0:1] offset:1024
    ds_write_b64 v70, v[2:3] offset:3072
    ds_write_b64 v70, v[4:5] offset:5120
    ds_write_b64 v70, v[6:7] offset:7168
    ds_write_b64 v70, v[8:9] offset:11264
    ds_write_b64 v70, v[10:11] offset:15360
    v_add_u32 v28, 73728, v24
    v_add_u32 v29, 73728, v25
    v_add_u32 v30, 73728, v26
    v_add_u32 v31, 73728, v27
    ds_read_b64_tr_b16 v[32:33], v28 offset:0
    ds_read_b64_tr_b16 v[34:35], v28 offset:8
    ds_read_b64_tr_b16 v[36:37], v29 offset:0
    ds_read_b64_tr_b16 v[38:39], v29 offset:8
    ds_read_b64_tr_b16 a[6:7], v30 offset:0
    ds_read_b64_tr_b16 v[40:41], v30 offset:8
    ds_read_b64_tr_b16 a[14:15], v31 offset:0
    ds_read_b64_tr_b16 v[42:43], v31 offset:8
    s_waitcnt vmcnt(12) lgkmcnt(0)
    s_barrier
    s_add_u32 m0, s43, 73728
    s_add_u32 s41, s59, 0
    buffer_load_dwordx4 v17, s[8:11], s41 offen offset:0 nt lds
    s_add_u32 s41, s59, 31744
    buffer_load_dwordx4 v17, s[8:11], s41 offen offset:1024 nt lds
    s_add_u32 s41, s59, 129024
    buffer_load_dwordx4 v17, s[8:11], s41 offen offset:2048 nt lds
    s_add_u32 s41, s59, 160768
    buffer_load_dwordx4 v17, s[8:11], s41 offen offset:3072 nt lds
    ds_write_b64 v70, v[32:33] offset:1032
    ds_write_b64 v70, v[34:35] offset:3080
    ds_write_b64 v70, v[36:37] offset:5128
    ds_write_b64 v70, v[38:39] offset:7176
    ds_write_b64 v70, v[40:41] offset:11272
    ds_write_b64 v70, v[42:43] offset:15368
    v_add_u32 v28, 110592, v24
    v_add_u32 v29, 110592, v25
    v_add_u32 v30, 110592, v26
    v_add_u32 v31, 110592, v27
    ds_read_b64_tr_b16 a[16:17], v28 offset:0
    ds_read_b64_tr_b16 a[24:25], v28 offset:8
    ds_read_b64_tr_b16 a[32:33], v29 offset:0
    ds_read_b64_tr_b16 a[40:41], v29 offset:8
    ds_read_b64_tr_b16 a[48:49], v30 offset:0
    ds_read_b64_tr_b16 a[56:57], v30 offset:8
    ds_read_b64_tr_b16 a[64:65], v31 offset:0
    ds_read_b64_tr_b16 a[72:73], v31 offset:8
    s_waitcnt vmcnt(12) lgkmcnt(0)
    s_barrier
    s_mov_b64 s[8:9], s[54:55]
    s_add_u32 m0, s43, 110592
    s_add_u32 s41, s58, 0
    buffer_load_dwordx4 v17, s[8:11], s41 offen offset:0 nt lds
    s_add_u32 s41, s58, 31744
    buffer_load_dwordx4 v17, s[8:11], s41 offen offset:1024 nt lds
    s_add_u32 s41, s58, 129024
    buffer_load_dwordx4 v17, s[8:11], s41 offen offset:2048 nt lds
    s_add_u32 s41, s58, 160768
    buffer_load_dwordx4 v17, s[8:11], s41 offen offset:3072 nt lds
    v_add_u32 v28, 147456, v24
    v_add_u32 v29, 147456, v25
    v_add_u32 v30, 147456, v26
    v_add_u32 v31, 147456, v27
    ds_read_b64_tr_b16 a[18:19], v28 offset:0
    ds_read_b64_tr_b16 a[26:27], v28 offset:8
    ds_read_b64_tr_b16 a[34:35], v29 offset:0
    ds_read_b64_tr_b16 a[42:43], v29 offset:8
    ds_read_b64_tr_b16 a[50:51], v30 offset:0
    ds_read_b64_tr_b16 a[58:59], v30 offset:8
    ds_read_b64_tr_b16 a[66:67], v31 offset:0
    ds_read_b64_tr_b16 a[74:75], v31 offset:8
    s_waitcnt vmcnt(12) lgkmcnt(0)
    s_barrier
    s_add_u32 m0, s43, 147456
    s_add_u32 s41, s58, 16384
    buffer_load_dwordx4 v17, s[8:11], s41 offen offset:0 nt lds
    s_add_u32 s41, s58, 48128
    buffer_load_dwordx4 v17, s[8:11], s41 offen offset:1024 nt lds
    s_add_u32 s41, s58, 145408
    buffer_load_dwordx4 v17, s[8:11], s41 offen offset:2048 nt lds
    s_add_u32 s41, s58, 177152
    buffer_load_dwordx4 v17, s[8:11], s41 offen offset:3072 nt lds
    v_add_u32 v28, 0, v24
    v_add_u32 v29, 0, v25
    v_add_u32 v30, 0, v26
    v_add_u32 v31, 0, v27
    ds_read_b64_tr_b16 a[20:21], v28 offset:0
    ds_read_b64_tr_b16 a[28:29], v28 offset:8
    ds_read_b64_tr_b16 a[36:37], v29 offset:0
    ds_read_b64_tr_b16 a[44:45], v29 offset:8
    ds_read_b64_tr_b16 a[52:53], v30 offset:0
    ds_read_b64_tr_b16 a[60:61], v30 offset:8
    ds_read_b64_tr_b16 a[68:69], v31 offset:0
    ds_read_b64_tr_b16 a[76:77], v31 offset:8
    s_waitcnt vmcnt(12) lgkmcnt(0)
    s_barrier
    s_add_u32 m0, s43, 0
    s_add_u32 s41, s58, 262144
    buffer_load_dwordx4 v17, s[8:11], s41 offen offset:0 nt lds
    s_add_u32 s41, s58, 293888
    buffer_load_dwordx4 v17, s[8:11], s41 offen offset:1024 nt lds
    s_add_u32 s41, s58, 391168
    buffer_load_dwordx4 v17, s[8:11], s41 offen offset:2048 nt lds
    s_add_u32 s41, s58, 422912
    buffer_load_dwordx4 v17, s[8:11], s41 offen offset:3072 nt lds
    v_add_u32 v28, 36864, v24
    v_add_u32 v29, 36864, v25
    v_add_u32 v30, 36864, v26
    v_add_u32 v31, 36864, v27
    ds_read_b64_tr_b16 a[22:23], v28 offset:0
    ds_read_b64_tr_b16 a[30:31], v28 offset:8
    ds_read_b64_tr_b16 a[38:39], v29 offset:0
    ds_read_b64_tr_b16 a[46:47], v29 offset:8
    ds_read_b64_tr_b16 a[54:55], v30 offset:0
    ds_read_b64_tr_b16 a[62:63], v30 offset:8
    ds_read_b64_tr_b16 a[70:71], v31 offset:0
    ds_read_b64_tr_b16 a[78:79], v31 offset:8
    s_waitcnt vmcnt(12) lgkmcnt(0)
    s_barrier
    s_add_u32 m0, s43, 36864
    s_add_u32 s41, s58, 278528
    buffer_load_dwordx4 v17, s[8:11], s41 offen offset:0 nt lds
    s_add_u32 s41, s58, 310272
    buffer_load_dwordx4 v17, s[8:11], s41 offen offset:1024 nt lds
    s_add_u32 s41, s58, 407552
    buffer_load_dwordx4 v17, s[8:11], s41 offen offset:2048 nt lds
    s_add_u32 s41, s58, 439296
    buffer_load_dwordx4 v17, s[8:11], s41 offen offset:3072 nt lds
    s_lshl_b32 s26, s12, 14
    s_add_u32 s26, s26, 0
    s_mul_i32 s40, s13, 3072
    s_add_u32 s24, s26, s40
    s_add_u32 s26, s24, s33
    s_add_u32 s99, s26, 33030144
    s_lshl_b32 s96, s12, 7
    s_add_u32 s29, s96, 125845504
    s_add_u32 s96, s96, 125829120
    v_bfe_u32 v78, v65, 2, 5
    buffer_load_dword v54, off, s[84:87], 0 offset:132 sc1
    buffer_load_dword v55, off, s[84:87], 0 offset:216 sc1
    buffer_load_dword v56, v78, s[4:7], s96 offen offset:16 sc1
    v_add_u32 v77, 73728, v20
    ds_read_b64_tr_b16 a[80:81], v77 offset:0
    ds_read_b64_tr_b16 a[82:83], v77 offset:4096
    ds_read_b64_tr_b16 a[84:85], v77 offset:8192
    ds_read_b64_tr_b16 a[86:87], v77 offset:12288
    ds_read_b64_tr_b16 a[88:89], v77 offset:8
    ds_read_b64_tr_b16 a[90:91], v77 offset:4104
    ds_read_b64_tr_b16 a[92:93], v77 offset:8200
    ds_read_b64_tr_b16 a[94:95], v77 offset:12296
    s_waitcnt vmcnt(12) lgkmcnt(0)
    s_barrier
    s_add_u32 m0, s43, 73728
    s_add_u32 s41, s58, 524288
    buffer_load_dwordx4 v17, s[8:11], s41 offen offset:0 nt lds
    s_add_u32 s41, s58, 556032
    buffer_load_dwordx4 v17, s[8:11], s41 offen offset:1024 nt lds
    s_add_u32 s41, s58, 653312
    buffer_load_dwordx4 v17, s[8:11], s41 offen offset:2048 nt lds
    s_add_u32 s41, s58, 685056
    buffer_load_dwordx4 v17, s[8:11], s41 offen offset:3072 nt lds
    v_add_u32 v28, 110592, v24
    v_add_u32 v29, 110592, v25
    v_add_u32 v30, 110592, v26
    v_add_u32 v31, 110592, v27
    ds_read_b64_tr_b16 a[232:233], v28 offset:0
    ds_read_b64_tr_b16 v[32:33], v28 offset:8
    ds_read_b64_tr_b16 a[240:241], v29 offset:0
    ds_read_b64_tr_b16 a[248:249], v29 offset:8
    ds_read_b64_tr_b16 v[144:145], v30 offset:0
    ds_read_b64_tr_b16 v[152:153], v30 offset:8
    ds_read_b64_tr_b16 v[160:161], v31 offset:0
    ds_read_b64_tr_b16 v[168:169], v31 offset:8
    s_waitcnt vmcnt(12) lgkmcnt(0)
    s_barrier
    s_add_u32 m0, s43, 110592
    s_add_u32 s41, s58, 540672
    buffer_load_dwordx4 v17, s[8:11], s41 offen offset:0 nt lds
    s_add_u32 s41, s58, 572416
    buffer_load_dwordx4 v17, s[8:11], s41 offen offset:1024 nt lds
    s_add_u32 s41, s58, 669696
    buffer_load_dwordx4 v17, s[8:11], s41 offen offset:2048 nt lds
    s_add_u32 s41, s58, 701440
    buffer_load_dwordx4 v17, s[8:11], s41 offen offset:3072 nt lds
    ds_write_b64 v70, v[32:33] offset:8192
    v_add_u32 v28, 147456, v24
    v_add_u32 v29, 147456, v25
    v_add_u32 v30, 147456, v26
    v_add_u32 v31, 147456, v27
    ds_read_b64_tr_b16 a[234:235], v28 offset:0
    ds_read_b64_tr_b16 v[0:1], v28 offset:8
    ds_read_b64_tr_b16 a[242:243], v29 offset:0
    ds_read_b64_tr_b16 a[250:251], v29 offset:8
    ds_read_b64_tr_b16 v[146:147], v30 offset:0
    ds_read_b64_tr_b16 v[154:155], v30 offset:8
    ds_read_b64_tr_b16 v[162:163], v31 offset:0
    ds_read_b64_tr_b16 v[170:171], v31 offset:8
    s_waitcnt vmcnt(12) lgkmcnt(0)
    s_barrier
    s_add_u32 m0, s43, 147456
    s_add_u32 s41, s58, 786432
    buffer_load_dwordx4 v17, s[8:11], s41 offen offset:0 nt lds
    s_add_u32 s41, s58, 818176
    buffer_load_dwordx4 v17, s[8:11], s41 offen offset:1024 nt lds
    s_add_u32 s41, s58, 915456
    buffer_load_dwordx4 v17, s[8:11], s41 offen offset:2048 nt lds
    s_add_u32 s41, s58, 947200
    buffer_load_dwordx4 v17, s[8:11], s41 offen offset:3072 nt lds
    ds_write_b64 v70, v[0:1] offset:8200
    v_add_u32 v28, 0, v24
    v_add_u32 v29, 0, v25
    v_add_u32 v30, 0, v26
    v_add_u32 v31, 0, v27
    ds_read_b64_tr_b16 a[236:237], v28 offset:0
    ds_read_b64_tr_b16 v[32:33], v28 offset:8
    ds_read_b64_tr_b16 a[244:245], v29 offset:0
    ds_read_b64_tr_b16 a[252:253], v29 offset:8
    ds_read_b64_tr_b16 v[148:149], v30 offset:0
    ds_read_b64_tr_b16 v[156:157], v30 offset:8
    ds_read_b64_tr_b16 v[164:165], v31 offset:0
    ds_read_b64_tr_b16 v[172:173], v31 offset:8
    s_waitcnt vmcnt(12) lgkmcnt(0)
    s_barrier
    s_add_u32 m0, s43, 0
    s_add_u32 s41, s58, 802816
    buffer_load_dwordx4 v17, s[8:11], s41 offen offset:0 nt lds
    s_add_u32 s41, s58, 834560
    buffer_load_dwordx4 v17, s[8:11], s41 offen offset:1024 nt lds
    s_add_u32 s41, s58, 931840
    buffer_load_dwordx4 v17, s[8:11], s41 offen offset:2048 nt lds
    s_add_u32 s41, s58, 963584
    buffer_load_dwordx4 v17, s[8:11], s41 offen offset:3072 nt lds
    ds_write_b64 v70, v[32:33] offset:9216
    v_add_u32 v28, 36864, v24
    v_add_u32 v29, 36864, v25
    v_add_u32 v30, 36864, v26
    v_add_u32 v31, 36864, v27
    ds_read_b64_tr_b16 a[238:239], v28 offset:0
    ds_read_b64_tr_b16 v[0:1], v28 offset:8
    ds_read_b64_tr_b16 a[246:247], v29 offset:0
    ds_read_b64_tr_b16 a[254:255], v29 offset:8
    ds_read_b64_tr_b16 v[150:151], v30 offset:0
    ds_read_b64_tr_b16 v[158:159], v30 offset:8
    ds_read_b64_tr_b16 v[166:167], v31 offset:0
    ds_read_b64_tr_b16 v[174:175], v31 offset:8
    s_waitcnt vmcnt(12) lgkmcnt(0)
    s_barrier
    s_add_u32 m0, s43, 36864
    s_add_u32 s41, s59, 0
    buffer_load_dwordx4 v17, s[8:11], s41 offen offset:0 nt lds
    s_add_u32 s41, s59, 31744
    buffer_load_dwordx4 v17, s[8:11], s41 offen offset:1024 nt lds
    s_add_u32 s41, s59, 129024
    buffer_load_dwordx4 v17, s[8:11], s41 offen offset:2048 nt lds
    s_add_u32 s41, s59, 160768
    buffer_load_dwordx4 v17, s[8:11], s41 offen offset:3072 nt lds
    v_readfirstlane_b32 s94, v54
    v_readfirstlane_b32 s95, v55
    v_mov_b32 v77, v56
    s_nop 0
    v_subrev_u32 v77, s95, v77
    v_cmp_lt_u32 vcc, 16, v77
    s_nop 1
    v_cndmask_b32 v77, v77, 0, vcc
    v_bfe_u32 v79, v78, 2, 2
    v_lshl_add_u32 v77, v77, 2, v79
    s_nop 1
    v_min_u32_dpp v77, v77, v77 row_ror:1 row_mask:0xf bank_mask:0xf
    s_nop 1
    v_min_u32_dpp v77, v77, v77 row_ror:2 row_mask:0xf bank_mask:0xf
    s_nop 1
    v_min_u32_dpp v77, v77, v77 row_ror:4 row_mask:0xf bank_mask:0xf
    s_nop 0
    v_readfirstlane_b32 s97, v77
    s_cmp_eq_u32 s95, 0
    s_cselect_b32 s97, 0, s97
    s_cmp_lt_u32 s97, 3
    s_cbranch_scc1 cf_mb
    s_add_u32 s40, s26, 0
    s_min_u32 s40, s40, s99
    s_sub_u32 s41, s96, s40
    v_bfe_u32 v77, v65, 2, 5
    v_add3_u32 v77, v77, s41, 16
    v_lshlrev_b32 v78, 3, v69
    s_nop 0
    v_mov_b32_dpp v78, v77 quad_perm:[0,1,2,3] row_mask:0xc bank_mask:0xf
    buffer_load_dword v58, v78, s[4:7], s40 offen sc1
    s_add_u32 s40, s26, 524288
    s_min_u32 s40, s40, s99
    s_sub_u32 s41, s96, s40
    v_bfe_u32 v77, v65, 2, 5
    v_add3_u32 v77, v77, s41, 16
    v_lshlrev_b32 v78, 3, v69
    s_nop 0
    v_mov_b32_dpp v78, v77 quad_perm:[0,1,2,3] row_mask:0xc bank_mask:0xf
    buffer_load_dword v58, v78, s[4:7], s40 offen sc1
cf_mb:
    s_cmp_lt_u32 s94, 32
    s_cbranch_scc1 cf_mc
    s_cmp_lg_u32 s13, 0
    s_cbranch_scc1 cf_mc
    v_mov_b32 v76, 1
    v_mov_b32 v77, 0
    s_mov_b64 exec, 1
    buffer_atomic_cmpswap v[76:77], off, s[84:87], 0 offset:28 sc0
    s_mov_b64 exec, -1
cf_mc:
    s_nop 1
    ds_write_b64 v70, v[0:1] offset:9224
    v_add_u32 v28, 73728, v24
    v_add_u32 v29, 73728, v25
    v_add_u32 v30, 73728, v26
    v_add_u32 v31, 73728, v27
    ds_read_b64_tr_b16 v[176:177], v28 offset:0
    ds_read_b64_tr_b16 v[184:185], v28 offset:8
    ds_read_b64_tr_b16 v[192:193], v29 offset:0
    ds_read_b64_tr_b16 v[200:201], v29 offset:8
    ds_read_b64_tr_b16 v[208:209], v30 offset:0
    ds_read_b64_tr_b16 v[216:217], v30 offset:8
    ds_read_b64_tr_b16 v[224:225], v31 offset:0
    ds_read_b64_tr_b16 v[232:233], v31 offset:8
    s_waitcnt vmcnt(12) lgkmcnt(0)
    s_barrier
    s_mov_b64 s[8:9], s[56:57]
    s_add_u32 m0, s43, 73728
    s_add_u32 s41, s60, 128
    buffer_load_dwordx4 v18, s[8:11], s41 offen offset:0 nt lds
    s_add_u32 s41, s60, 8320
    buffer_load_dwordx4 v18, s[8:11], s41 offen offset:1024 nt lds
    s_add_u32 s41, s60, 16512
    buffer_load_dwordx4 v18, s[8:11], s41 offen offset:2048 nt lds
    s_add_u32 s41, s60, 24704
    buffer_load_dwordx4 v18, s[8:11], s41 offen offset:3072 nt lds
    v_add_u32 v28, 110592, v24
    v_add_u32 v29, 110592, v25
    v_add_u32 v30, 110592, v26
    v_add_u32 v31, 110592, v27
    ds_read_b64_tr_b16 v[178:179], v28 offset:0
    ds_read_b64_tr_b16 v[186:187], v28 offset:8
    ds_read_b64_tr_b16 v[194:195], v29 offset:0
    ds_read_b64_tr_b16 v[202:203], v29 offset:8
    ds_read_b64_tr_b16 v[210:211], v30 offset:0
    ds_read_b64_tr_b16 v[218:219], v30 offset:8
    ds_read_b64_tr_b16 v[226:227], v31 offset:0
    ds_read_b64_tr_b16 v[234:235], v31 offset:8
    s_waitcnt vmcnt(12) lgkmcnt(0)
    s_barrier
    s_add_u32 m0, s43, 110592
    s_add_u32 s41, s61, 128
    buffer_load_dwordx4 v18, s[8:11], s41 offen offset:0 nt lds
    s_add_u32 s41, s61, 8320
    buffer_load_dwordx4 v18, s[8:11], s41 offen offset:1024 nt lds
    s_add_u32 s41, s61, 16512
    buffer_load_dwordx4 v18, s[8:11], s41 offen offset:2048 nt lds
    s_add_u32 s41, s61, 24704
    buffer_load_dwordx4 v18, s[8:11], s41 offen offset:3072 nt lds
    v_add_u32 v28, 147456, v24
    v_add_u32 v29, 147456, v25
    v_add_u32 v30, 147456, v26
    v_add_u32 v31, 147456, v27
    ds_read_b64_tr_b16 v[180:181], v28 offset:0
    ds_read_b64_tr_b16 v[188:189], v28 offset:8
    ds_read_b64_tr_b16 v[196:197], v29 offset:0
    ds_read_b64_tr_b16 v[204:205], v29 offset:8
    ds_read_b64_tr_b16 v[212:213], v30 offset:0
    ds_read_b64_tr_b16 v[220:221], v30 offset:8
    ds_read_b64_tr_b16 v[228:229], v31 offset:0
    ds_read_b64_tr_b16 v[236:237], v31 offset:8
    s_waitcnt vmcnt(12) lgkmcnt(0)
    s_barrier
    s_add_u32 m0, s43, 147456
    s_add_u32 s41, s62, 128
    buffer_load_dwordx4 v18, s[8:11], s41 offen offset:0 nt lds
    s_add_u32 s41, s62, 8320
    buffer_load_dwordx4 v18, s[8:11], s41 offen offset:1024 nt lds
    s_add_u32 s41, s62, 16512
    buffer_load_dwordx4 v18, s[8:11], s41 offen offset:2048 nt lds
    s_add_u32 s41, s62, 24704
    buffer_load_dwordx4 v18, s[8:11], s41 offen offset:3072 nt lds
    v_add_u32 v28, 0, v24
    v_add_u32 v29, 0, v25
    v_add_u32 v30, 0, v26
    v_add_u32 v31, 0, v27
    ds_read_b64_tr_b16 v[182:183], v28 offset:0
    ds_read_b64_tr_b16 v[190:191], v28 offset:8
    ds_read_b64_tr_b16 v[198:199], v29 offset:0
    ds_read_b64_tr_b16 v[206:207], v29 offset:8
    ds_read_b64_tr_b16 v[214:215], v30 offset:0
    ds_read_b64_tr_b16 v[222:223], v30 offset:8
    ds_read_b64_tr_b16 v[230:231], v31 offset:0
    ds_read_b64_tr_b16 v[238:239], v31 offset:8
    s_waitcnt vmcnt(12) lgkmcnt(0)
    s_barrier
    s_add_u32 m0, s43, 0
    s_add_u32 s41, s63, 128
    buffer_load_dwordx4 v18, s[8:11], s41 offen offset:0 nt lds
    s_add_u32 s41, s63, 8320
    buffer_load_dwordx4 v18, s[8:11], s41 offen offset:1024 nt lds
    s_add_u32 s41, s63, 16512
    buffer_load_dwordx4 v18, s[8:11], s41 offen offset:2048 nt lds
    s_add_u32 s41, s63, 24704
    buffer_load_dwordx4 v18, s[8:11], s41 offen offset:3072 nt lds
    v_mov_b32 v78, v21
    v_mov_b32 v79, v22
    v_add_u32 v77, 36864, v20
    ds_read_b64_tr_b16 v[240:241], v77 offset:0
    ds_read_b64_tr_b16 v[242:243], v77 offset:4096
    ds_read_b64_tr_b16 v[244:245], v77 offset:8192
    ds_read_b64_tr_b16 v[246:247], v77 offset:12288
    ds_read_b64_tr_b16 v[248:249], v77 offset:8
    ds_read_b64_tr_b16 v[250:251], v77 offset:4104
    ds_read_b64_tr_b16 v[252:253], v77 offset:8200
    ds_read_b64_tr_b16 v[254:255], v77 offset:12296
    s_waitcnt vmcnt(12) lgkmcnt(0)
    s_barrier
    v_add_u32 v77, 73728, v79
    s_waitcnt lgkmcnt(0)
    ds_read_b64_tr_b16 v[0:1], v77 offset:0
    ds_read_b64_tr_b16 v[2:3], v77 offset:256
    ds_read_b64_tr_b16 v[4:5], v77 offset:2048
    ds_read_b64_tr_b16 v[6:7], v77 offset:2304
    ds_read_b64_tr_b16 v[8:9], v77 offset:16
    ds_read_b64_tr_b16 v[10:11], v77 offset:272
    ds_read_b64_tr_b16 v[12:13], v77 offset:2064
    ds_read_b64_tr_b16 v[14:15], v77 offset:2320
    s_waitcnt vmcnt(8) lgkmcnt(0)
    s_barrier
    v_add_u32 v77, 110592, v78
    ds_read_b64_tr_b16 v[16:17], v77 offset:0
    ds_read_b64_tr_b16 v[18:19], v77 offset:256
    ds_read_b64_tr_b16 v[20:21], v77 offset:2048
    ds_read_b64_tr_b16 v[22:23], v77 offset:2304
    ds_read_b64_tr_b16 v[24:25], v77 offset:16
    ds_read_b64_tr_b16 v[26:27], v77 offset:272
    ds_read_b64_tr_b16 v[28:29], v77 offset:2064
    ds_read_b64_tr_b16 v[30:31], v77 offset:2320
    s_waitcnt vmcnt(4) lgkmcnt(0)
    s_barrier
    v_add_u32 v77, 147456, v78
    ds_read_b64_tr_b16 v[32:33], v77 offset:0
    ds_read_b64_tr_b16 v[34:35], v77 offset:256
    ds_read_b64_tr_b16 v[36:37], v77 offset:2048
    ds_read_b64_tr_b16 v[38:39], v77 offset:2304
    ds_read_b64_tr_b16 v[40:41], v77 offset:16
    ds_read_b64_tr_b16 v[42:43], v77 offset:272
    ds_read_b64_tr_b16 v[44:45], v77 offset:2064
    ds_read_b64_tr_b16 v[46:47], v77 offset:2320
    s_waitcnt vmcnt(0) lgkmcnt(0)
    s_barrier
    v_add_u32 v77, 0, v78
    ds_read_b64_tr_b16 v[48:49], v77 offset:0
    ds_read_b64_tr_b16 v[50:51], v77 offset:256
    ds_read_b64_tr_b16 v[52:53], v77 offset:2048
    ds_read_b64_tr_b16 v[54:55], v77 offset:2304
    ds_read_b64_tr_b16 v[56:57], v77 offset:16
    ds_read_b64_tr_b16 v[58:59], v77 offset:272
    ds_read_b64_tr_b16 v[60:61], v77 offset:2064
    ds_read_b64_tr_b16 v[62:63], v77 offset:2320
    s_waitcnt lgkmcnt(0)
    s_barrier
    ds_write_b128 v70, v[0:3] offset:20480
    ds_write_b128 v70, v[4:7] offset:21504
    ds_write_b128 v70, v[8:11] offset:22528
    ds_write_b128 v70, v[12:15] offset:23552
    ds_write_b128 v70, v[16:19] offset:24576
    ds_write_b128 v70, v[20:23] offset:25600
    ds_write_b128 v70, v[24:27] offset:26624
    ds_write_b128 v70, v[28:31] offset:27648
    ds_write_b128 v70, v[32:35] offset:28672
    ds_write_b128 v70, v[36:39] offset:29696
    ds_write_b128 v70, v[40:43] offset:30720
    ds_write_b128 v70, v[44:47] offset:31744
    ds_write_b128 v70, v[48:51] offset:32768
    ds_write_b128 v70, v[52:55] offset:33792
    ds_write_b128 v70, v[56:59] offset:34816
    ds_write_b128 v70, v[60:63] offset:35840
    s_waitcnt lgkmcnt(0)
    v_bfe_u32 v60, v65, 4, 6
    v_and_b32 v61, 15, v60
    v_lshrrev_b32 v62, 4, v60
    v_mov_b32 v50, 0x3f80
    v_mov_b32 v51, 0x3f800000
    v_and_b32 v77, 1, v62
    v_lshlrev_b32 v77, 2, v77
    v_sub_u32 v77, v61, v77
    v_and_b32 v78, 3, v61
    v_lshlrev_b32 v78, 2, v78
    v_lshrrev_b32 v79, 2, v61
    v_add_u32 v78, v78, v79
    v_cmp_eq_u32 vcc, 0, v77
    s_nop 1
    v_cndmask_b32 v8, 0, v50, vcc
    v_cmp_eq_u32 vcc, 1, v77
    s_nop 1
    v_cndmask_b32 v8, v8, v51, vcc
    v_cmp_eq_u32 vcc, 0, v78
    s_nop 1
    v_cndmask_b32 v12, 0, v50, vcc
    v_cmp_eq_u32 vcc, 1, v78
    s_nop 1
    v_cndmask_b32 v12, v12, v51, vcc
    v_cmp_eq_u32 vcc, 2, v77
    s_nop 1
    v_cndmask_b32 v9, 0, v50, vcc
    v_cmp_eq_u32 vcc, 3, v77
    s_nop 1
    v_cndmask_b32 v9, v9, v51, vcc
    v_cmp_eq_u32 vcc, 2, v78
    s_nop 1
    v_cndmask_b32 v13, 0, v50, vcc
    v_cmp_eq_u32 vcc, 3, v78
    s_nop 1
    v_cndmask_b32 v13, v13, v51, vcc
    v_cmp_eq_u32 vcc, 8, v77
    s_nop 1
    v_cndmask_b32 v10, 0, v50, vcc
    v_cmp_eq_u32 vcc, 9, v77
    s_nop 1
    v_cndmask_b32 v10, v10, v51, vcc
    v_cmp_eq_u32 vcc, 4, v78
    s_nop 1
    v_cndmask_b32 v14, 0, v50, vcc
    v_cmp_eq_u32 vcc, 5, v78
    s_nop 1
    v_cndmask_b32 v14, v14, v51, vcc
    v_cmp_eq_u32 vcc, 10, v77
    s_nop 1
    v_cndmask_b32 v11, 0, v50, vcc
    v_cmp_eq_u32 vcc, 11, v77
    s_nop 1
    v_cndmask_b32 v11, v11, v51, vcc
    v_cmp_eq_u32 vcc, 6, v78
    s_nop 1
    v_cndmask_b32 v15, 0, v50, vcc
    v_cmp_eq_u32 vcc, 7, v78
    s_nop 1
    v_cndmask_b32 v15, v15, v51, vcc
    v_lshlrev_b32 v77, 4, v61
    ds_write_b128 v69, v[8:11] offset:15360
    ds_write_b128 v77, v[12:15] offset:15872
    s_waitcnt vmcnt(0) lgkmcnt(0)
    s_cmp_lg_u32 s95, 0
    s_cbranch_scc1 cf_hn
    s_mov_b32 s88, 4194304
gn2:
    buffer_load_dword v2, off, s[84:87], 0 offset:216 sc1
    s_waitcnt vmcnt(0)
    v_readfirstlane_b32 s95, v2
    s_sub_u32 s88, s88, 1
    s_cbranch_scc1 gn2x
    s_cmp_eq_u32 s95, 0
    s_cbranch_scc1 gn2
gn2x:
cf_hn:
    v_mov_b32 v2, 1
    s_cmp_lg_u32 s13, 0
    s_cbranch_scc1 cf_noarr
    s_mov_b64 exec, 1
    s_mov_b32 s42, 1
    v_mov_b32 v4, v76
    s_cmp_ge_u32 s94, 32
    s_cbranch_scc1 cf_have
    s_mov_b32 s40, 131072
    s_mov_b32 s42, 2
cf_startpoll:
    buffer_load_dword v3, off, s[84:87], 0 offset:132 sc1
    s_sub_u32 s40, s40, 1
    s_cbranch_scc1 cf_decide
    s_waitcnt vmcnt(0)
    v_readfirstlane_b32 s41, v3
    s_nop 1
    s_cmp_lt_u32 s41, 32
    s_cbranch_scc1 cf_startpoll
    s_mov_b32 s42, 1
cf_decide:
    v_mov_b32 v4, s42
    v_mov_b32 v5, 0
    buffer_atomic_cmpswap v[4:5], off, s[84:87], 0 offset:28 sc0
    s_waitcnt vmcnt(0)
cf_have:
    v_mov_b32 v5, s42
    v_cmp_eq_u32 vcc, 0, v4
    s_nop 1
    v_cndmask_b32 v4, v4, v5, vcc
    v_mov_b32 v5, 16192
    ds_write_b32 v5, v4
    s_waitcnt lgkmcnt(0)
    s_mov_b64 exec, -1
cf_noarr:
    s_barrier
    v_mov_b32 v5, 16192
    ds_read_b32 v4, v5
    s_waitcnt lgkmcnt(0)
    v_readfirstlane_b32 s41, v4
    s_nop 1
    s_cmp_eq_u32 s41, 1
    s_cbranch_scc1 cf_run
    v_lshrrev_b32 v0, 4, v65
    s_mov_b32 s32, s13
    s_load_dwordx16 s[48:63], s[0:1], 0
    s_waitcnt lgkmcnt(0)
    s_branch L_helper
cf_run:
    s_mov_b32 s44, 0x3e0293ee
    s_mov_b32 s45, s44
    s_or_b32 s66, s44, 0x80000000
    s_mov_b32 s48, 0x3f003f00
    s_mov_b32 s49, 0
    s_mov_b32 s50, 0x3f803f80
    s_mov_b32 s51, 0x3f803f80
    s_mov_b32 s52, 512
    s_mov_b32 s53, 1024
    s_mov_b32 s54, 1536
    s_mov_b32 s30, 0
    s_mov_b32 s37, 0
    s_mov_b32 s98, -100
    s_lshl_b32 s47, s13, 9
    s_cmp_lg_u32 s32, 0
    s_cselect_b32 s71, s13, 3
    s_add_u32 s46, s71, 1
    s_lshr_b32 s46, s46, 1
    s_mov_b32 s14, 67125248
    s_mov_b32 s15, 67129344
    s_mov_b32 s16, 67133440
    s_mov_b32 s36, 0
    s_add_u32 s17, s68, 67108864
    s_mov_b32 s69, 0
    s_mov_b32 s70, 0
    s_lshl_b32 s26, s12, 14
    s_add_u32 s26, s26, 0
    s_mul_i32 s40, s13, 3072
    s_add_u32 s24, s26, s40
    s_add_u32 s26, s24, s33
    s_add_u32 s99, s26, 33030144
    s_lshl_b32 s96, s12, 7
    s_add_u32 s29, s96, 125845504
    s_add_u32 s96, s96, 125829120
    s_lshl_b32 s40, s12, 14
    s_add_u32 s40, s40, 68157440
    s_add_u32 s18, s40, 0
    s_add_u32 s19, s40, 4096
    s_add_u32 s20, s40, 8192
    s_add_u32 s21, s40, 12288
    s_lshr_b32 s40, s12, 3
    s_lshl_b32 s40, s40, 12
    s_and_b32 s41, s12, 7
    s_lshl_b32 s41, s41, 7
    s_add_u32 s40, s40, s41
    s_add_u32 s22, s40, 68157440
    s_add_u32 s23, s22, 1024
    s_add_u32 s25, s22, 2048
    s_mov_b32 s56, -65472
    s_cmp_lg_u32 s32, 0
    s_cselect_b64 s[38:39], -1, 0
    s_add_u32 s55, s68, 138412032
    s_cmp_eq_u32 s13, 3
    s_cselect_b64 s[100:101], 1, 0
    s_cselect_b64 s[38:39], 1, s[38:39]
    s_cselect_b32 s93, 64, 0
    s_cselect_b32 s55, s29, s55
    s_cselect_b32 s57, 0, 9216
    s_mov_b64 exec, s[100:101]
    v_mov_b32 v72, s95
    s_mov_b64 exec, -1
    s_mov_b32 s34, 0xff00ff00
    s_mov_b32 s35, 0xff00ff00
    s_lshl_b32 s28, s12, 12
    s_add_u32 s28, s28, 7340032
    s_add_u32 s27, s28, 77594624
    s_add_u32 s28, s28, 69206016
    s_cmp_ge_u32 s97, 3
    s_cbranch_scc1 cf_kvdone
    s_mov_b32 s40, 3
    v_bfe_u32 v78, v65, 2, 5
    s_mov_b32 s31, 4194304
cf_kv0:
    buffer_load_dword v77, v78, s[4:7], s96 offen offset:16 sc1
    s_waitcnt vmcnt(0)
    v_subrev_u32 v77, s95, v77
    v_cmp_lt_u32 vcc, 16, v77
    s_nop 1
    v_cndmask_b32 v77, v77, 0, vcc
    v_bfe_u32 v79, v78, 2, 2
    v_lshl_add_u32 v77, v77, 2, v79
    s_nop 1
    v_min_u32_dpp v77, v77, v77 row_ror:1 row_mask:0xf bank_mask:0xf
    s_nop 1
    v_min_u32_dpp v77, v77, v77 row_ror:2 row_mask:0xf bank_mask:0xf
    s_nop 1
    v_min_u32_dpp v77, v77, v77 row_ror:4 row_mask:0xf bank_mask:0xf
    s_nop 0
    v_readfirstlane_b32 s97, v77
    s_sub_u32 s31, s31, 1
    s_cbranch_scc1 cf_kv0_x
    s_cmp_le_u32 s40, s97
    s_cbranch_scc1 cf_kv0_x
    s_sleep 2
    s_branch cf_kv0
cf_kv0_x:
    s_add_u32 s40, s26, 0
    s_min_u32 s40, s40, s99
    s_sub_u32 s41, s96, s40
    v_bfe_u32 v77, v65, 2, 5
    v_add3_u32 v77, v77, s41, 16
    v_lshlrev_b32 v78, 3, v69
    s_nop 0
    v_mov_b32_dpp v78, v77 quad_perm:[0,1,2,3] row_mask:0xc bank_mask:0xf
    buffer_load_dword v76, v78, s[4:7], s40 offen sc1
    s_add_u32 s40, s26, 524288
    s_min_u32 s40, s40, s99
    s_sub_u32 s41, s96, s40
    v_bfe_u32 v77, v65, 2, 5
    v_add3_u32 v77, v77, s41, 16
    v_lshlrev_b32 v78, 3, v69
    s_nop 0
    v_mov_b32_dpp v78, v77 quad_perm:[0,1,2,3] row_mask:0xc bank_mask:0xf
    buffer_load_dword v76, v78, s[4:7], s40 offen sc1
cf_kvdone:
    v_mov_b64 v[0:1], 0
    v_mov_b64 v[2:3], 0
    v_mov_b64 v[4:5], 0
    v_mov_b64 v[6:7], 0
    v_mov_b64 v[8:9], 0
    v_mov_b64 v[10:11], 0
    v_mov_b64 v[12:13], 0
    v_mov_b64 v[14:15], 0
    v_mov_b64 v[16:17], 0
    v_mov_b64 v[18:19], 0
    v_mov_b64 v[20:21], 0
    v_mov_b64 v[22:23], 0
    ds_read_b128 v[44:47], v70 offset:0
    ds_read_b128 v[48:51], v70 offset:1024
    ds_read_b128 v[52:55], v70 offset:2048
    ds_read_b128 v[56:59], v70 offset:3072
    ds_read_b128 v[24:27], v70 offset:4096
    ds_read_b128 v[28:31], v70 offset:5120
    ds_read_b128 v[32:35], v70 offset:6144
    ds_read_b128 v[36:39], v70 offset:7168
    buffer_load_dwordx4 v[40:43], v65, s[4:7], s14 offen offset:0 nt
    buffer_load_dwordx4 v[60:63], v66, s[4:7], s14 offen offset:0 nt
    s_mov_b32 s31, 1048576
    s_waitcnt vmcnt(0) lgkmcnt(0)
    s_branch cf_goA
cf_loop:
    s_mov_b32 s31, 1048576
    s_mov_b32 s69, s70
    s_waitcnt lgkmcnt(0)
cf_cA:
    buffer_load_dwordx4 v[40:43], v65, s[4:7], s14 offen offset:0 nt
    buffer_load_dwordx4 v[60:63], v66, s[4:7], s14 offen offset:0 nt
cf_cA1:
    v_bitop3_b32 v77, v40, v60, s70 bitop3:0x7e
    v_and_b32 v77, 1, v77
    v_cmp_ne_u32 vcc, 0, v77
    s_cbranch_vccz cf_goA
    v_bitop3_b32 v77, v40, v60, s70 bitop3:0x7e
    v_and_b32 v77, 1, v77
    v_cmp_ne_u32 vcc, 0, v77
    s_cbranch_vccz cf_goA
    v_bitop3_b32 v77, v40, v60, s70 bitop3:0x7e
    v_and_b32 v77, 1, v77
    v_cmp_ne_u32 vcc, 0, v77
    s_cbranch_vccz cf_goA
    v_bitop3_b32 v77, v40, v60, s70 bitop3:0x7e
    v_and_b32 v77, 1, v77
    v_cmp_ne_u32 vcc, 0, v77
    s_cbranch_vccz cf_goA
    buffer_load_dwordx4 v[40:43], v65, s[4:7], s14 offen offset:0 nt
    buffer_load_dwordx4 v[60:63], v66, s[4:7], s14 offen offset:0 nt
    v_bitop3_b32 v77, v40, v60, s70 bitop3:0x7e
    v_and_b32 v77, 1, v77
    v_cmp_ne_u32 vcc, 0, v77
    s_cbranch_vccz cf_goA
    v_bitop3_b32 v77, v40, v60, s70 bitop3:0x7e
    v_and_b32 v77, 1, v77
    v_cmp_ne_u32 vcc, 0, v77
    s_cbranch_vccz cf_goA
    v_bitop3_b32 v77, v40, v60, s70 bitop3:0x7e
    v_and_b32 v77, 1, v77
    v_cmp_ne_u32 vcc, 0, v77
    s_cbranch_vccz cf_goA
    v_bitop3_b32 v77, v40, v60, s70 bitop3:0x7e
    v_and_b32 v77, 1, v77
    v_cmp_ne_u32 vcc, 0, v77
    s_cbranch_vccz cf_goA
    buffer_load_dwordx4 v[40:43], v65, s[4:7], s14 offen offset:0 nt
    buffer_load_dwordx4 v[60:63], v66, s[4:7], s14 offen offset:0 nt
    v_bitop3_b32 v77, v40, v60, s70 bitop3:0x7e
    v_and_b32 v77, 1, v77
    v_cmp_ne_u32 vcc, 0, v77
    s_cbranch_vccz cf_goA
    v_bitop3_b32 v77, v40, v60, s70 bitop3:0x7e
    v_and_b32 v77, 1, v77
    v_cmp_ne_u32 vcc, 0, v77
    s_cbranch_vccz cf_goA
    v_bitop3_b32 v77, v40, v60, s70 bitop3:0x7e
    v_and_b32 v77, 1, v77
    v_cmp_ne_u32 vcc, 0, v77
    s_cbranch_vccz cf_goA
    v_bitop3_b32 v77, v40, v60, s70 bitop3:0x7e
    v_and_b32 v77, 1, v77
    v_cmp_ne_u32 vcc, 0, v77
    s_cbranch_vccz cf_goA
    buffer_load_dwordx4 v[40:43], v65, s[4:7], s14 offen offset:0 nt
    buffer_load_dwordx4 v[60:63], v66, s[4:7], s14 offen offset:0 nt
    v_bitop3_b32 v77, v40, v60, s70 bitop3:0x7e
    v_and_b32 v77, 1, v77
    v_cmp_ne_u32 vcc, 0, v77
    s_cbranch_vccz cf_goA
    v_bitop3_b32 v77, v40, v60, s70 bitop3:0x7e
    v_and_b32 v77, 1, v77
    v_cmp_ne_u32 vcc, 0, v77
    s_cbranch_vccz cf_goA
    v_bitop3_b32 v77, v40, v60, s70 bitop3:0x7e
    v_and_b32 v77, 1, v77
    v_cmp_ne_u32 vcc, 0, v77
    s_cbranch_vccz cf_goA
    v_bitop3_b32 v77, v40, v60, s70 bitop3:0x7e
    v_and_b32 v77, 1, v77
    v_cmp_ne_u32 vcc, 0, v77
    s_cbranch_vccz cf_goA
    s_sub_u32 s31, s31, 64
    s_cbranch_scc0 cf_cA
cf_goA:
    ds_write_b128 v65, v[40:43] offset:0
    v_smfmac_f32_16x16x64_bf16 v[0:3], v[40:43], v[44:51], v64
    v_smfmac_f32_16x16x64_bf16 v[4:7], v[40:43], v[52:59], v64
    buffer_load_dwordx4 v[44:47], v65, s[4:7], s15 offen offset:0 nt
    v_smfmac_f32_16x16x64_bf16 v[0:3], v[60:63], v[24:31], v64
    s_add_u32 s40, s26, 1048576
    s_min_u32 s40, s40, s99
    s_sub_u32 s41, s96, s40
    v_smfmac_f32_16x16x64_bf16 v[4:7], v[60:63], v[32:39], v64
    ds_read_b128 v[24:27], v70 offset:8192
    s_cmp_lt_u32 s97, s93
    s_cselect_b32 s41, s41, 0
    v_smfmac_f32_16x16x64_bf16 v[8:11], v[40:43], a[96:103], v64
    ds_read_b128 v[28:31], v70 offset:9216
    v_smfmac_f32_16x16x64_bf16 v[12:15], v[40:43], a[104:111], v64
    ds_read_b128 v[32:35], v70 offset:10240
    s_waitcnt lgkmcnt(3)
    s_barrier
    ds_read_b128 v[48:51], v67 offset:0
    v_smfmac_f32_16x16x64_bf16 v[8:11], v[60:63], a[112:119], v64
    ds_read_b128 v[36:39], v70 offset:11264
    v_bitop3_b32 v79, v73, -9, s54 bitop3:0x6a
    v_smfmac_f32_16x16x64_bf16 v[12:15], v[60:63], a[120:127], v64
    buffer_load_dwordx4 v[44:47], v65, s[4:7], s15 offen offset:0 nt
    v_smfmac_f32_16x16x64_bf16 v[16:19], v[40:43], a[232:239], v64
    ds_read_b128 v[52:55], v68 offset:0
    s_waitcnt lgkmcnt(4)
    v_bfe_u32 v77, v65, 2, 5
    v_smfmac_f32_16x16x64_bf16 v[20:23], v[40:43], v[24:31], v64
    ds_read_b128 v[24:27], v70 offset:12288
    s_waitcnt lgkmcnt(3)
    v_smfmac_f32_16x16x64_bf16 v[0:3], v[48:51], a[0:7], v64
    ds_read_b128 v[28:31], v70 offset:13312
    s_waitcnt lgkmcnt(3)
    v_add3_u32 v77, v77, s41, 16
    v_smfmac_f32_16x16x64_bf16 v[4:7], v[48:51], v[32:39], v64
    buffer_load_dwordx4 v[40:43], v65, s[4:7], s16 offen offset:0 nt
    v_smfmac_f32_16x16x64_bf16 v[16:19], v[60:63], a[240:247], v64
    ds_read_b128 v[32:35], v70 offset:14336
    v_lshlrev_b32 v78, 3, v69
    v_smfmac_f32_16x16x64_bf16 v[20:23], v[60:63], a[248:255], v64
    ds_read_b128 v[36:39], v70 offset:15360
    v_smfmac_f32_16x16x64_bf16 v[8:11], v[48:51], a[128:135], v64
    s_waitcnt vmcnt(2)
    v_mov_b32_dpp v78, v77 quad_perm:[0,1,2,3] row_mask:0xc bank_mask:0xf
    v_smfmac_f32_16x16x64_bf16 v[12:15], v[48:51], a[136:143], v64
    buffer_load_dwordx4 v[58:61], v65, s[4:7], s24 offen offset:3072 sc1
    s_waitcnt lgkmcnt(2)
    v_and_b32 v77, s36, v44
    v_smfmac_f32_16x16x64_bf16 v[12:15], v[52:55], v[24:31], v64
    ds_write_b128 v65, v[44:47] offset:4096
    v_smfmac_f32_16x16x64_bf16 v[0:3], v[52:55], a[8:15], v64
    v_cmp_ne_u32 vcc, s70, v77
    v_smfmac_f32_16x16x64_bf16 v[8:11], v[52:55], a[144:151], v64
    buffer_load_dwordx4 v[24:27], v65, s[4:7], s24 offen offset:0 sc1
    s_waitcnt lgkmcnt(1)
    v_smfmac_f32_16x16x64_bf16 v[4:7], v[52:55], v[32:39], v64
    s_cbranch_vccnz cf_spinB
cf_backB:
    v_smfmac_f32_16x16x64_bf16 v[16:19], v[44:47], v[176:183], v64
    s_waitcnt lgkmcnt(0)
    s_barrier
    ds_read_b128 v[48:51], v66 offset:4096
    v_smfmac_f32_16x16x64_bf16 v[12:15], v[44:47], a[160:167], v64
    buffer_load_dwordx4 v[28:31], v65, s[4:7], s24 offen offset:1024 sc1
    v_smfmac_f32_16x16x64_bf16 v[0:3], v[44:47], a[16:23], v64
    ds_read_b128 v[52:55], v67 offset:4096
    v_smfmac_f32_16x16x64_bf16 v[8:11], v[44:47], a[152:159], v64
    v_smfmac_f32_16x16x64_bf16 v[4:7], v[44:47], a[24:31], v64
    buffer_load_dwordx4 v[34:37], v65, s[4:7], s24 offen offset:2048 sc1
    s_waitcnt vmcnt(5)
    v_smfmac_f32_16x16x64_bf16 v[20:23], v[44:47], v[184:191], v64
    ds_read_b128 v[44:47], v68 offset:4096
    s_waitcnt lgkmcnt(2)
    v_smfmac_f32_16x16x64_bf16 v[0:3], v[48:51], a[32:39], v64
    v_smfmac_f32_16x16x64_bf16 v[8:11], v[48:51], a[168:175], v64
    buffer_load_dword v76, v78, s[4:7], s40 offen sc1
    v_smfmac_f32_16x16x64_bf16 v[4:7], v[48:51], a[40:47], v64
    s_waitcnt vmcnt(5)
    v_and_b32 v77, s36, v40
    v_smfmac_f32_16x16x64_bf16 v[12:15], v[48:51], a[176:183], v64
    ds_read_b128 v[48:51], v69 offset:15360
    s_waitcnt lgkmcnt(1)
    v_cmp_ne_u32 vcc, s70, v77
    v_smfmac_f32_16x16x64_bf16 v[0:3], v[52:55], a[48:55], v64
    v_smfmac_f32_16x16x64_bf16 v[8:11], v[52:55], a[184:191], v64
    s_cbranch_vccnz cf_spin8
cf_back8:
    v_smfmac_f32_16x16x64_bf16 v[0:3], v[44:47], a[64:71], v64
    v_smfmac_f32_16x16x64_bf16 v[8:11], v[44:47], a[200:207], v64
    v_smfmac_f32_16x16x64_bf16 v[0:3], v[40:43], a[80:87], v64
    s_nop 1
    v_smfmac_f32_16x16x64_bf16 v[8:11], v[40:43], a[216:223], v64
    s_nop 1
    v_lshrrev_b32 v77, 1, v69
    v_smfmac_f32_16x16x64_bf16 v[4:7], v[52:55], a[56:63], v64
    s_nop 1
    v_cvt_pk_bf16_f32 v0, v0, v1
    v_smfmac_f32_16x16x64_bf16 v[12:15], v[52:55], a[192:199], v64
    s_nop 1
    v_cvt_pk_bf16_f32 v1, v2, v3
    v_smfmac_f32_16x16x64_bf16 v[4:7], v[44:47], a[72:79], v64
    s_nop 1
    v_cvt_pk_bf16_f32 v2, v8, v9
    v_smfmac_f32_16x16x64_bf16 v[12:15], v[44:47], a[208:215], v64
    s_nop 1
    v_cvt_pk_bf16_f32 v3, v10, v11
    v_smfmac_f32_16x16x64_bf16 v[4:7], v[40:43], a[88:95], v64
    s_waitcnt lgkmcnt(0)
    s_nop 0
    s_nop 0
    v_smfmac_f32_16x16x64_bf16 v[12:15], v[40:43], a[224:231], v64
    s_nop 2
    v_mfma_f32_16x16x32_bf16 v[8:11], v[0:3], v[48:51], 0
    s_nop 0
    v_cvt_pk_bf16_f32 v4, v4, v5
    v_cvt_pk_bf16_f32 v5, v6, v7
    s_nop 0
    v_cvt_pk_bf16_f32 v6, v12, v13
    v_cvt_pk_bf16_f32 v7, v14, v15
    s_nop 1
    v_mfma_f32_16x16x32_bf16 v[12:15], v[4:7], v[48:51], 0
    ds_read_b128 v[48:51], v66 offset:4096
    v_cvt_pk_bf16_f32 v0, v8, v9
    v_cvt_pk_bf16_f32 v1, v10, v11
    v_smfmac_f32_16x16x64_bf16 v[16:19], v[52:55], v[208:215], v64
    s_waitcnt vmcnt(2)
    s_nop 2
    v_cvt_pk_bf16_f32 v2, v12, v13
    v_cvt_pk_bf16_f32 v3, v14, v15
    s_nop 1
    v_mfma_f32_16x16x32_bf16 v[12:15], v[0:3], v[0:3], 0
    s_nop 1
    v_bitop3_b32 v78, v73, -9, s53 bitop3:0x6a
    v_mfma_f32_16x16x32_bf16 v[4:7], v[24:27], v[0:3], 0
    ds_read_b128 v[24:27], v67 offset:0
    s_nop 1
    v_mfma_f32_16x16x32_bf16 v[8:11], v[28:31], v[0:3], 0
    s_nop 0
    v_mov_b32_dpp v12, v14 row_ror:8 row_mask:0xf bank_mask:0xc
    v_mov_b32_dpp v13, v15 row_ror:8 row_mask:0xf bank_mask:0xc
    v_smfmac_f32_16x16x64_bf16 v[20:23], v[52:55], v[216:223], v64
    ds_write_b64 v71, v[12:13]
    ds_read_b128 v[52:55], v68 offset:0
    s_nop 1
    v_mov_b32_dpp v4, v8 row_ror:8 row_mask:0xf bank_mask:0xc
    v_mov_b32_dpp v5, v9 row_ror:8 row_mask:0xf bank_mask:0xc
    v_mov_b32_dpp v6, v10 row_ror:8 row_mask:0xf bank_mask:0xc
    v_mov_b32_dpp v7, v11 row_ror:8 row_mask:0xf bank_mask:0xc
    v_smfmac_f32_16x16x64_bf16 v[16:19], v[44:47], v[224:231], v64
    ds_write_b128 v65, v[4:7] offset:8192
    v_smfmac_f32_16x16x64_bf16 v[20:23], v[44:47], v[232:239], v64
    s_waitcnt lgkmcnt(3)
    v_smfmac_f32_16x16x64_bf16 v[16:19], v[24:27], v[144:151], v64
    s_waitcnt vmcnt(1)
    v_smfmac_f32_16x16x64_bf16 v[20:23], v[24:27], v[152:159], v64
    s_mov_b64 exec, s[38:39]
    buffer_store_dword v72, v75, s[4:7], s55 offen sc1
    s_mov_b64 exec, -1
    v_smfmac_f32_16x16x64_bf16 v[16:19], v[40:43], v[240:247], v64
    s_cmp_ge_u32 s30, 56
    s_waitcnt lgkmcnt(0)
    s_barrier
    ds_read_b128 v[8:11], v66 offset:8192
    v_smfmac_f32_16x16x64_bf16 v[20:23], v[40:43], v[248:255], v64
    ds_read_b128 v[12:15], v67 offset:8192
    v_smfmac_f32_16x16x64_bf16 v[16:19], v[48:51], v[192:199], v64
    ds_read_b128 v[44:47], v68 offset:8192
    v_smfmac_f32_16x16x64_bf16 v[20:23], v[48:51], v[200:207], v64
    ds_read_b64 v[24:25], v77 offset:14336
    ds_read_b64 v[26:27], v77 offset:14592
    v_smfmac_f32_16x16x64_bf16 v[16:19], v[52:55], v[160:167], v64
    ds_read_b64 v[28:29], v77 offset:14848
    ds_read_b64 v[30:31], v77 offset:15104
    v_bitop3_b32 v77, v73, -9, s52 bitop3:0x6a
    v_smfmac_f32_16x16x64_bf16 v[20:23], v[52:55], v[168:175], v64
    s_cbranch_scc1 cf_rare
cf_rare_x:
    ds_read_b128 v[48:51], v70 offset:22528
    ds_read_b128 v[52:55], v70 offset:23552
    s_waitcnt lgkmcnt(6)
    v_pk_add_f32 v[4:5], v[4:5], v[8:9]
    v_pk_add_f32 v[6:7], v[6:7], v[10:11]
    v_pk_add_f32 v[12:13], v[12:13], v[44:45]
    v_pk_add_f32 v[14:15], v[14:15], v[46:47]
    v_pk_add_f32 v[4:5], v[4:5], v[12:13]
    v_pk_add_f32 v[6:7], v[6:7], v[14:15]
    s_waitcnt lgkmcnt(2)
    v_pk_add_f32 v[24:25], v[24:25], v[26:27]
    v_pk_add_f32 v[28:29], v[28:29], v[30:31]
    v_max3_f32 v8, v4, v5, v6
    v_pk_add_f32 v[24:25], v[24:25], v[28:29]
    v_max_f32 v8, v8, v7
    v_max3_f32 v8, v8, v24, v25
    v_cvt_pk_bf16_f32 v32, v16, v17
    v_cvt_pk_bf16_f32 v38, v18, v19
    v_max_f32_dpp v8, v8, v8 row_ror:8 row_mask:0xf bank_mask:0xf
    v_mov_b32 v9, v8
    v_cvt_pk_bf16_f32 v56, v20, v21
    v_cvt_pk_bf16_f32 v62, v22, v23
    v_permlane32_swap_b32 v8, v9
    v_max_f32 v8, v8, v9
    v_mov_b32 v9, v8
    v_mov_b32 v11, 0
    v_mov_b32 v15, 0
    v_permlane16_swap_b32 v8, v9
    v_max_f32 v8, v8, v9
    v_mul_f32 v8, s66, v8
    v_pk_fma_f32 v[4:5], v[4:5], s[44:45], v[8:9] op_sel_hi:[1,1,0]
    v_pk_fma_f32 v[6:7], v[6:7], s[44:45], v[8:9] op_sel_hi:[1,1,0]
    v_pk_fma_f32 v[24:25], v[24:25], s[44:45], v[8:9] op_sel_hi:[1,1,0]
    v_exp_f32 v4, v4
    v_exp_f32 v5, v5
    v_exp_f32 v6, v6
    v_exp_f32 v7, v7
    v_exp_f32 v24, v24
    v_exp_f32 v25, v25
    v_cvt_pk_bf16_f32 v12, v4, v5
    v_cvt_pk_bf16_f32 v13, v6, v7
    v_cvt_pk_bf16_f32 v10, v24, v25
    v_cvt_pk_bf16_f32 v14, v24, v25
    v_mov_b64 v[0:1], s[48:49]
    v_mfma_f32_16x16x32_bf16 v[4:7], v[32:35], v[10:13], 0
    ds_read_b128 v[40:43], v70 offset:20480
    v_mov_b64 v[2:3], s[50:51]
    v_mfma_f32_16x16x32_bf16 v[24:27], v[36:39], v[12:15], 0
    ds_read_b128 v[44:47], v70 offset:21504
    v_mov_b64 v[8:9], 0
    v_mfma_f32_16x16x32_bf16 v[28:31], v[0:3], v[10:13], 0
    ds_read_b128 v[32:35], v70 offset:24576
    v_mov_b64 v[0:1], 0
    v_mfma_f32_16x16x32_bf16 v[16:19], v[56:59], v[10:13], 0
    ds_read_b128 v[36:39], v70 offset:25600
    v_mov_b64 v[2:3], 0
    v_mfma_f32_16x16x32_bf16 v[20:23], v[60:63], v[12:15], 0
    ds_read_b128 v[56:59], v70 offset:28672
    v_add_f32_dpp v4, v24, v4 row_ror:8 row_mask:0xf bank_mask:0xf
    v_add_f32_dpp v5, v25, v5 row_ror:8 row_mask:0xf bank_mask:0xf
    v_add_f32_dpp v6, v26, v6 row_ror:8 row_mask:0xf bank_mask:0xf
    v_add_f32_dpp v7, v27, v7 row_ror:8 row_mask:0xf bank_mask:0xf
    v_add_f32_dpp v29, v28, v28 row_ror:8 row_mask:0xf bank_mask:0xf
    v_rcp_f32 v28, v29
    v_mov_b64 v[10:11], 0
    v_add_f32_dpp v4, v16, v20 row_ror:8 row_mask:0xf bank_mask:0xc
    v_add_f32_dpp v5, v17, v21 row_ror:8 row_mask:0xf bank_mask:0xc
    v_add_f32_dpp v6, v18, v22 row_ror:8 row_mask:0xf bank_mask:0xc
    v_add_f32_dpp v7, v19, v23 row_ror:8 row_mask:0xf bank_mask:0xc
    v_pk_mul_f32 v[4:5], v[4:5], v[28:29] op_sel_hi:[1,0]
    v_pk_mul_f32 v[6:7], v[6:7], v[28:29] op_sel_hi:[1,0]
    v_cvt_pk_bf16_f32 v4, v4, v5
    v_cvt_pk_bf16_f32 v5, v6, v7
    ds_write_b64 v73, v[4:5] offset:12288
    v_mov_b32_dpp v6, v4 row_ror:8 row_mask:0xf bank_mask:0xf
    v_mov_b32_dpp v7, v5 row_ror:8 row_mask:0xf bank_mask:0xf
    v_mov_b64 v[12:13], 0
    v_mov_b64 v[14:15], 0
    v_smfmac_f32_16x16x64_bf16 v[8:11], v[4:7], v[80:87], v64
    s_waitcnt lgkmcnt(4)
    v_mov_b64 v[24:25], 0
    v_smfmac_f32_16x16x64_bf16 v[0:3], v[4:7], v[40:47], v64
    ds_read_b128 v[60:63], v70 offset:29696
    v_mov_b64 v[26:27], 0
    v_smfmac_f32_16x16x64_bf16 v[12:15], v[4:7], v[112:119], v64
    s_waitcnt lgkmcnt(1)
    s_barrier
    ds_read_b128 v[16:19], v77 offset:12288
    v_smfmac_f32_16x16x64_bf16 v[24:27], v[4:7], v[48:55], v64
    ds_read_b128 v[20:23], v78 offset:12288
    ds_read_b128 v[28:31], v79 offset:12288
    v_mov_b64 v[4:5], 0
    v_mov_b64 v[6:7], 0
    v_bfe_u32 v77, v74, 16, 1
    v_mad_i32_i24 v77, v77, s56, v74
    s_waitcnt lgkmcnt(2)
    v_smfmac_f32_16x16x64_bf16 v[8:11], v[16:19], v[88:95], v64
    ds_read_b128 v[40:43], v70 offset:32768
    s_waitcnt lgkmcnt(2)
    v_smfmac_f32_16x16x64_bf16 v[8:11], v[20:23], v[96:103], v64
    ds_read_b128 v[44:47], v70 offset:33792
    s_waitcnt lgkmcnt(2)
    v_smfmac_f32_16x16x64_bf16 v[8:11], v[28:31], v[104:111], v64
    ds_read_b128 v[48:51], v70 offset:26624
    s_nop 0
    v_and_b32 v72, 8, v73
    v_smfmac_f32_16x16x64_bf16 v[0:3], v[16:19], v[32:39], v64
    ds_read_b128 v[52:55], v70 offset:27648
    s_nop 0
    v_mad_u32_u24 v72, v72, 63, v73
    v_smfmac_f32_16x16x64_bf16 v[12:15], v[16:19], v[120:127], v64
    ds_read_b128 v[32:35], v70 offset:30720
    v_cvt_pk_bf16_f32 v8, v8, v9
    v_cvt_pk_bf16_f32 v9, v10, v11
    v_and_or_b32 v8, v8, -2, s69
    v_smfmac_f32_16x16x64_bf16 v[12:15], v[20:23], v[128:135], v64
    buffer_store_dwordx2 v[8:9], v74, s[4:7], s22 offen offset:0
    ds_read_b128 v[36:39], v70 offset:31744
    v_smfmac_f32_16x16x64_bf16 v[12:15], v[28:31], v[136:143], v64
    s_add_u32 s30, s30, 1
    s_xor_b32 s70, s70, 1
    v_subrev_u32 v72, s47, v72
    v_smfmac_f32_16x16x64_bf16 v[0:3], v[20:23], v[56:63], v64
    ds_read_b128 v[56:59], v70 offset:34816
    s_waitcnt lgkmcnt(3)
    s_nop 0
    v_smfmac_f32_16x16x64_bf16 v[0:3], v[28:31], v[40:47], v64
    ds_read_b128 v[60:63], v70 offset:35840
    v_cvt_pk_bf16_f32 v12, v12, v13
    v_cvt_pk_bf16_f32 v13, v14, v15
    v_and_or_b32 v12, v12, -2, s69
    v_smfmac_f32_16x16x64_bf16 v[24:27], v[16:19], v[48:55], v64
    buffer_store_dwordx2 v[12:13], v74, s[4:7], s22 offen offset:64
    s_waitcnt lgkmcnt(2)
    v_smfmac_f32_16x16x64_bf16 v[24:27], v[20:23], v[32:39], v64
    ds_read_b128 v[40:43], v70 offset:16384
    v_cvt_pk_bf16_f32 v0, v0, v1
    v_cvt_pk_bf16_f32 v1, v2, v3
    v_and_or_b32 v0, v0, -2, s69
    s_waitcnt lgkmcnt(1)
    v_smfmac_f32_16x16x64_bf16 v[24:27], v[28:31], v[56:63], v64
    buffer_store_dwordx2 v[0:1], v74, s[4:7], s23 offen offset:0
    ds_read_b128 v[44:47], v70 offset:17408
    ds_read_b128 v[8:11], v72 offset:12288
    ds_read_b128 v[48:51], v70 offset:18432
    ds_read_b128 v[52:55], v70 offset:19456
    ds_read_b128 v[12:15], v72 offset:13312
    s_cmp_lg_u32 s71, 0
    s_nop 0
    v_cvt_pk_bf16_f32 v24, v24, v25
    v_cvt_pk_bf16_f32 v25, v26, v27
    v_and_or_b32 v24, v24, -2, s69
    buffer_store_dwordx2 v[24:25], v74, s[4:7], s23 offen offset:64
    s_waitcnt lgkmcnt(3)
    v_smfmac_f32_16x16x64_bf16 v[4:7], v[8:11], v[40:47], v64
    s_waitcnt lgkmcnt(0)
    v_smfmac_f32_16x16x64_bf16 v[4:7], v[12:15], v[48:55], v64
    s_nop 7
    v_cvt_pk_bf16_f32 v4, v4, v5
    v_cvt_pk_bf16_f32 v5, v6, v7
    v_and_or_b32 v4, v4, -2, s69
    buffer_store_dwordx2 v[4:5], v77, s[4:7], s25 offen offset:0
    s_nop 0
    s_cbranch_scc1 cf_e1
    s_cmp_lg_u32 s37, 0
    s_cbranch_scc1 cf_f0_xt
cf_f0_xtx:
    s_nop 2
    v_mov_b32 v79, v79
    s_nop 2
    v_mov_b32 v79, v79
    s_nop 2
    v_mov_b32 v79, v79
    s_nop 2
    v_mov_b32 v79, v79
    s_nop 2
    v_mov_b32 v79, v79
    buffer_load_dwordx4 v[8:11], v65, s[4:7], s18 offen nt
    buffer_load_dwordx4 v[12:15], v65, s[4:7], s19 offen nt
    buffer_load_dwordx4 v[16:19], v65, s[4:7], s20 offen nt
    buffer_load_dwordx4 v[20:23], v65, s[4:7], s21 offen nt
    v_and_b32 v77, 255, v69
    ds_read_b128 v[4:7], v77 offset:15872
    ds_read_b128 v[44:47], v70 offset:0
    ds_read_b128 v[48:51], v70 offset:1024
    ds_read_b128 v[52:55], v70 offset:2048
    ds_read_b128 v[56:59], v70 offset:3072
    ds_read_b128 v[24:27], v70 offset:4096
    ds_read_b128 v[28:31], v70 offset:5120
    ds_read_b128 v[32:35], v70 offset:6144
    ds_read_b128 v[36:39], v70 offset:7168
    s_mov_b32 s31, 65536
    s_add_u32 s24, s24, 524288
    s_add_u32 s26, s26, 524288
    s_add_u32 s55, s55, s57
    s_mov_b32 s14, 67108864
    s_mov_b32 s15, 67112960
    s_mov_b32 s16, 67117056
    s_mov_b32 s36, 1
    v_mov_b32 v40, s69
    v_mov_b32 v60, s69
    v_and_b32 v79, 12, v75
    v_cmp_eq_u32 vcc, 0, v79
    s_nop 1
    v_cndmask_b32 v79, 0, 1, vcc
    s_waitcnt lgkmcnt(0)
    s_waitcnt vmcnt(3)
    v_bitop3_b32 v77, v8, v10, s69 bitop3:0x7e
    v_mfma_f32_16x16x32_bf16 v[0:3], v[4:7], v[8:11], 0
    v_mov_b64 v[8:9], 0
    v_mov_b64 v[10:11], 0
    s_waitcnt vmcnt(2)
    v_bitop3_b32 v78, v12, v14, s69 bitop3:0x7e
    v_mfma_f32_16x16x32_bf16 v[0:3], v[4:7], v[12:15], v[0:3]
    v_or_b32 v77, v77, v78
    v_mov_b64 v[12:13], 0
    v_mov_b64 v[14:15], 0
    s_waitcnt vmcnt(1)
    v_bitop3_b32 v78, v16, v18, s69 bitop3:0x7e
    v_mfma_f32_16x16x32_bf16 v[0:3], v[4:7], v[16:19], v[0:3]
    v_or_b32 v77, v77, v78
    v_mov_b64 v[16:17], 0
    v_mov_b64 v[18:19], 0
    s_waitcnt vmcnt(0)
    v_bitop3_b32 v78, v20, v22, s69 bitop3:0x7e
    v_mfma_f32_16x16x32_bf16 v[0:3], v[4:7], v[20:23], v[0:3]
    v_bitop3_b32 v77, v77, v78, 1 bitop3:0xa8
    v_cmp_ne_u32 vcc, 0, v77
    v_mov_b64 v[20:21], 0
    v_mov_b64 v[22:23], 0
    s_cmp_eq_u64 vcc, 0
    s_cselect_b64 s[42:43], -1, 0
    s_nop 1
    v_add_f32_dpp v0, v0, v0 row_ror:8 row_mask:0xf bank_mask:0xf
    v_add_f32_dpp v1, v1, v1 row_ror:8 row_mask:0xf bank_mask:0xf
    s_mov_b64 exec, s[42:43]
    v_cvt_pk_bf16_f32 v72, v0, v1
    v_bfi_b32 v72, v79, s70, v72
    buffer_store_dword v72, v75, s[4:7], s17 offen offset:0
    s_mov_b64 exec, -1
    s_cbranch_scc0 cf_f0_retry
cf_f0_go:
    v_mov_b64 v[0:1], 0
    v_mov_b64 v[2:3], 0
    v_mov_b64 v[4:5], 0
    v_mov_b64 v[6:7], 0
    s_nop 2
    v_mov_b32 v79, v79
    s_nop 2
    v_mov_b32 v79, v79
    s_nop 2
    v_mov_b32 v79, v79
    s_nop 2
    v_mov_b32 v79, v79
    s_branch cf_loop
cf_e1:
    s_cmp_lg_u32 s71, 2
    s_cbranch_scc1 cf_f1
    v_and_b32 v77, 255, v69
    ds_read_b128 v[4:7], v77 offset:15872
    ds_read_b128 v[44:47], v70 offset:0
    ds_read_b128 v[48:51], v70 offset:1024
    ds_read_b128 v[52:55], v70 offset:2048
    ds_read_b128 v[56:59], v70 offset:3072
    ds_read_b128 v[24:27], v70 offset:4096
    ds_read_b128 v[28:31], v70 offset:5120
    ds_read_b128 v[32:35], v70 offset:6144
    ds_read_b128 v[36:39], v70 offset:7168
    s_mov_b32 s31, 65536
    s_add_u32 s24, s24, 524288
    s_add_u32 s26, s26, 524288
    s_add_u32 s55, s55, s57
    s_mov_b32 s14, 67108864
    s_mov_b32 s15, 67112960
    s_mov_b32 s16, 67117056
    s_mov_b32 s36, 1
    v_mov_b32 v40, s69
    v_mov_b32 v60, s69
    v_and_b32 v79, 12, v75
    v_cmp_eq_u32 vcc, 0, v79
    s_nop 1
    v_cndmask_b32 v79, 0, 1, vcc
    s_cmp_lg_u32 s37, 0
    s_cbranch_scc1 cf_f2_xt
cf_f2_xtx:
    s_nop 2
    v_mov_b32 v79, v79
    s_nop 2
    v_mov_b32 v79, v79
    s_nop 2
    v_mov_b32 v79, v79
    s_nop 2
    v_mov_b32 v79, v79
    s_nop 2
    v_mov_b32 v79, v79
    s_nop 2
    v_mov_b32 v79, v79
    s_nop 2
    v_mov_b32 v79, v79
    s_nop 2
    v_mov_b32 v79, v79
    s_waitcnt vmcnt(0)
    buffer_load_dwordx4 v[8:11], v65, s[4:7], s18 offen nt
    buffer_load_dwordx4 v[12:15], v65, s[4:7], s19 offen nt
    buffer_load_dwordx4 v[16:19], v65, s[4:7], s20 offen nt
    buffer_load_dwordx4 v[20:23], v65, s[4:7], s21 offen nt
    s_nop 2
    v_mov_b32 v79, v79
    s_nop 2
    v_mov_b32 v79, v79
    s_nop 2
    v_mov_b32 v79, v79
    s_nop 2
    v_mov_b32 v79, v79
    s_nop 2
    v_mov_b32 v79, v79
    s_nop 2
    v_mov_b32 v79, v79
    s_nop 2
    v_mov_b32 v79, v79
    s_nop 2
    v_mov_b32 v79, v79
    s_nop 2
    v_mov_b32 v79, v79
    s_nop 2
    v_mov_b32 v79, v79
    buffer_load_dwordx4 v[40:43], v65, s[4:7], s14 offen offset:0 nt
    buffer_load_dwordx4 v[60:63], v66, s[4:7], s14 offen offset:0 nt
    s_waitcnt lgkmcnt(0)
    s_waitcnt vmcnt(5)
    v_bitop3_b32 v77, v8, v10, s69 bitop3:0x7e
    v_mfma_f32_16x16x32_bf16 v[0:3], v[4:7], v[8:11], 0
    v_mov_b64 v[8:9], 0
    v_mov_b64 v[10:11], 0
    s_waitcnt vmcnt(4)
    v_bitop3_b32 v78, v12, v14, s69 bitop3:0x7e
    v_mfma_f32_16x16x32_bf16 v[0:3], v[4:7], v[12:15], v[0:3]
    v_or_b32 v77, v77, v78
    v_mov_b64 v[12:13], 0
    v_mov_b64 v[14:15], 0
    s_waitcnt vmcnt(3)
    v_bitop3_b32 v78, v16, v18, s69 bitop3:0x7e
    v_mfma_f32_16x16x32_bf16 v[0:3], v[4:7], v[16:19], v[0:3]
    v_or_b32 v77, v77, v78
    v_mov_b64 v[16:17], 0
    v_mov_b64 v[18:19], 0
    s_waitcnt vmcnt(2)
    v_bitop3_b32 v78, v20, v22, s69 bitop3:0x7e
    v_mfma_f32_16x16x32_bf16 v[0:3], v[4:7], v[20:23], v[0:3]
    v_bitop3_b32 v77, v77, v78, 1 bitop3:0xa8
    v_cmp_ne_u32 vcc, 0, v77
    v_mov_b64 v[20:21], 0
    v_mov_b64 v[22:23], 0
    buffer_load_dwordx4 v[40:43], v65, s[4:7], s14 offen offset:0 nt
    buffer_load_dwordx4 v[60:63], v66, s[4:7], s14 offen offset:0 nt
    s_cmp_eq_u64 vcc, 0
    s_cselect_b64 s[42:43], -1, 0
    v_add_f32_dpp v0, v0, v0 row_ror:4 row_mask:0xf bank_mask:0xf
    v_add_f32_dpp v1, v1, v1 row_ror:4 row_mask:0xf bank_mask:0xf
    s_nop 0
    v_add_f32_dpp v0, v0, v0 row_ror:8 row_mask:0xf bank_mask:0xf
    v_add_f32_dpp v1, v1, v1 row_ror:8 row_mask:0xf bank_mask:0xf
    s_mov_b64 exec, s[42:43]
    v_cvt_pk_bf16_f32 v72, v0, v1
    v_bfi_b32 v72, v79, s70, v72
    buffer_store_dword v72, v75, s[4:7], s17 offen offset:0
    buffer_store_dword v72, v75, s[4:7], s17 offen offset:1024
    buffer_store_dword v72, v75, s[4:7], s17 offen offset:2048
    buffer_store_dword v72, v75, s[4:7], s17 offen offset:3072
    s_mov_b64 exec, -1
    s_cbranch_scc0 cf_f2_retry
cf_f2_go:
    v_mov_b64 v[0:1], 0
    v_mov_b64 v[2:3], 0
    v_mov_b64 v[4:5], 0
    v_mov_b64 v[6:7], 0
    s_branch cf_loop
cf_f1:
    s_cmp_lg_u32 s32, 1
    s_cbranch_scc1 cf_f3
    v_and_b32 v77, 255, v69
    ds_read_b128 v[4:7], v77 offset:15872
    ds_read_b128 v[44:47], v70 offset:0
    ds_read_b128 v[48:51], v70 offset:1024
    ds_read_b128 v[52:55], v70 offset:2048
    ds_read_b128 v[56:59], v70 offset:3072
    ds_read_b128 v[24:27], v70 offset:4096
    ds_read_b128 v[28:31], v70 offset:5120
    ds_read_b128 v[32:35], v70 offset:6144
    ds_read_b128 v[36:39], v70 offset:7168
    s_mov_b32 s31, 65536
    s_add_u32 s24, s24, 524288
    s_add_u32 s26, s26, 524288
    s_add_u32 s55, s55, s57
    s_mov_b32 s14, 67108864
    s_mov_b32 s15, 67112960
    s_mov_b32 s16, 67117056
    s_mov_b32 s36, 1
    v_mov_b32 v40, s69
    v_mov_b32 v60, s69
    v_and_b32 v79, 12, v75
    v_cmp_eq_u32 vcc, 0, v79
    s_nop 1
    v_cndmask_b32 v79, 0, 1, vcc
    s_cmp_lg_u32 s37, 0
    s_cbranch_scc1 cf_f1_xt
cf_f1_xtx:
    s_nop 2
    v_mov_b32 v79, v79
    s_waitcnt vmcnt(0)
    buffer_load_dwordx4 v[8:11], v65, s[4:7], s18 offen nt
    buffer_load_dwordx4 v[12:15], v65, s[4:7], s19 offen nt
    buffer_load_dwordx4 v[16:19], v65, s[4:7], s20 offen nt
    buffer_load_dwordx4 v[20:23], v65, s[4:7], s21 offen nt
    s_nop 2
    v_mov_b32 v79, v79
    s_nop 2
    v_mov_b32 v79, v79
    s_nop 2
    v_mov_b32 v79, v79
    s_nop 2
    v_mov_b32 v79, v79
    s_nop 2
    v_mov_b32 v79, v79
    s_nop 2
    v_mov_b32 v79, v79
    s_nop 2
    v_mov_b32 v79, v79
    s_nop 2
    v_mov_b32 v79, v79
    s_nop 2
    v_mov_b32 v79, v79
    s_nop 2
    v_mov_b32 v79, v79
    buffer_load_dwordx4 v[40:43], v65, s[4:7], s14 offen offset:0 nt
    buffer_load_dwordx4 v[60:63], v66, s[4:7], s14 offen offset:0 nt
    s_waitcnt lgkmcnt(0)
    s_waitcnt vmcnt(5)
    v_bitop3_b32 v77, v8, v10, s69 bitop3:0x7e
    v_mfma_f32_16x16x32_bf16 v[0:3], v[4:7], v[8:11], 0
    v_mov_b64 v[8:9], 0
    v_mov_b64 v[10:11], 0
    s_waitcnt vmcnt(4)
    v_bitop3_b32 v78, v12, v14, s69 bitop3:0x7e
    v_mfma_f32_16x16x32_bf16 v[0:3], v[4:7], v[12:15], v[0:3]
    v_or_b32 v77, v77, v78
    v_mov_b64 v[12:13], 0
    v_mov_b64 v[14:15], 0
    s_waitcnt vmcnt(3)
    v_bitop3_b32 v78, v16, v18, s69 bitop3:0x7e
    v_mfma_f32_16x16x32_bf16 v[0:3], v[4:7], v[16:19], v[0:3]
    v_or_b32 v77, v77, v78
    v_mov_b64 v[16:17], 0
    v_mov_b64 v[18:19], 0
    s_waitcnt vmcnt(2)
    v_bitop3_b32 v78, v20, v22, s69 bitop3:0x7e
    v_mfma_f32_16x16x32_bf16 v[0:3], v[4:7], v[20:23], v[0:3]
    v_bitop3_b32 v77, v77, v78, 1 bitop3:0xa8
    v_cmp_ne_u32 vcc, 0, v77
    v_mov_b64 v[20:21], 0
    v_mov_b64 v[22:23], 0
    buffer_load_dwordx4 v[40:43], v65, s[4:7], s14 offen offset:0 nt
    buffer_load_dwordx4 v[60:63], v66, s[4:7], s14 offen offset:0 nt
    s_cmp_eq_u64 vcc, 0
    s_cselect_b64 s[42:43], -1, 0
    v_add_f32_dpp v0, v0, v0 row_ror:8 row_mask:0xf bank_mask:0xf
    v_add_f32_dpp v1, v1, v1 row_ror:8 row_mask:0xf bank_mask:0xf
    s_mov_b64 exec, s[42:43]
    v_cvt_pk_bf16_f32 v72, v0, v1
    v_bfi_b32 v72, v79, s70, v72
    buffer_store_dword v72, v75, s[4:7], s17 offen offset:0
    s_mov_b64 exec, -1
    s_cbranch_scc0 cf_f1_retry
cf_f1_go:
    v_mov_b64 v[0:1], 0
    v_mov_b64 v[2:3], 0
    v_mov_b64 v[4:5], 0
    v_mov_b64 v[6:7], 0
    s_branch cf_loop
cf_f3:
    v_and_b32 v77, 255, v69
    ds_read_b128 v[4:7], v77 offset:15872
    ds_read_b128 v[44:47], v70 offset:0
    ds_read_b128 v[48:51], v70 offset:1024
    ds_read_b128 v[52:55], v70 offset:2048
    ds_read_b128 v[56:59], v70 offset:3072
    ds_read_b128 v[24:27], v70 offset:4096
    ds_read_b128 v[28:31], v70 offset:5120
    ds_read_b128 v[32:35], v70 offset:6144
    ds_read_b128 v[36:39], v70 offset:7168
    s_mov_b32 s31, 65536
    s_add_u32 s24, s24, 524288
    s_add_u32 s26, s26, 524288
    s_add_u32 s55, s55, s57
    s_mov_b32 s14, 67108864
    s_mov_b32 s15, 67112960
    s_mov_b32 s16, 67117056
    s_mov_b32 s36, 1
    v_mov_b32 v40, s69
    v_mov_b32 v60, s69
    v_and_b32 v79, 12, v75
    v_cmp_eq_u32 vcc, 0, v79
    s_nop 1
    v_cndmask_b32 v79, 0, 1, vcc
    s_add_u32 s40, s30, s95
    v_mov_b32 v72, s40
    s_waitcnt lgkmcnt(0)
    v_mov_b64 v[0:1], 0
    v_mov_b64 v[2:3], 0
    v_mov_b64 v[4:5], 0
    v_mov_b64 v[6:7], 0
    v_mov_b64 v[8:9], 0
    v_mov_b64 v[10:11], 0
    v_mov_b64 v[12:13], 0
    v_mov_b64 v[14:15], 0
    v_mov_b64 v[16:17], 0
    v_mov_b64 v[18:19], 0
    v_mov_b64 v[20:21], 0
    v_mov_b64 v[22:23], 0
    s_nop 2
    v_mov_b32 v79, v79
    s_nop 2
    v_mov_b32 v79, v79
    s_nop 2
    v_mov_b32 v79, v79
    s_nop 2
    v_mov_b32 v79, v79
    s_nop 2
    v_mov_b32 v79, v79
    s_nop 2
    v_mov_b32 v79, v79
    s_nop 2
    v_mov_b32 v79, v79
    s_nop 2
    v_mov_b32 v79, v79
    s_nop 2
    v_mov_b32 v79, v79
    s_waitcnt vmcnt(0)
    s_cmp_lt_u32 s97, s93
    s_cbranch_scc1 cf_kvwait
    s_nop 2
    v_mov_b32 v79, v79
    s_nop 2
    v_mov_b32 v79, v79
    s_nop 2
    v_mov_b32 v79, v79
    s_nop 2
    v_mov_b32 v79, v79
    s_nop 2
    v_mov_b32 v79, v79
    s_nop 2
    v_mov_b32 v79, v79
    s_nop 2
    v_mov_b32 v79, v79
    s_nop 2
    v_mov_b32 v79, v79
cf_kvok:
    s_branch cf_loop
cf_f0_xt:
    s_sub_u32 s37, s37, 1
    s_nop 2
    v_mov_b32 v79, v79
    s_nop 2
    v_mov_b32 v79, v79
    s_nop 2
    v_mov_b32 v79, v79
    s_nop 2
    v_mov_b32 v79, v79
    s_nop 2
    v_mov_b32 v79, v79
    s_nop 2
    v_mov_b32 v79, v79
    s_branch cf_f0_xtx
cf_f0_retry:
    s_sub_u32 s41, s30, s98
    s_mov_b32 s98, s30
    s_cmp_le_u32 s41, 3
    s_cselect_b32 s37, 1, 1
cf_f0_spin:
    buffer_load_dwordx4 v[8:11], v65, s[4:7], s18 offen nt
    buffer_load_dwordx4 v[12:15], v65, s[4:7], s19 offen nt
    buffer_load_dwordx4 v[16:19], v65, s[4:7], s20 offen nt
    buffer_load_dwordx4 v[20:23], v65, s[4:7], s21 offen nt
    s_nop 2
    v_mov_b32 v79, v79
    s_nop 2
    v_mov_b32 v79, v79
    s_nop 2
    v_mov_b32 v79, v79
    buffer_load_dwordx4 v[40:43], v65, s[4:7], s14 offen offset:0 nt
    buffer_load_dwordx4 v[60:63], v66, s[4:7], s14 offen offset:0 nt
    s_waitcnt vmcnt(5)
    v_bitop3_b32 v77, v8, v10, s69 bitop3:0x7e
    v_mfma_f32_16x16x32_bf16 v[0:3], v[4:7], v[8:11], 0
    v_mov_b64 v[8:9], 0
    v_mov_b64 v[10:11], 0
    s_waitcnt vmcnt(4)
    v_bitop3_b32 v78, v12, v14, s69 bitop3:0x7e
    v_mfma_f32_16x16x32_bf16 v[0:3], v[4:7], v[12:15], v[0:3]
    v_or_b32 v77, v77, v78
    v_mov_b64 v[12:13], 0
    v_mov_b64 v[14:15], 0
    s_waitcnt vmcnt(3)
    v_bitop3_b32 v78, v16, v18, s69 bitop3:0x7e
    v_mfma_f32_16x16x32_bf16 v[0:3], v[4:7], v[16:19], v[0:3]
    v_or_b32 v77, v77, v78
    v_mov_b64 v[16:17], 0
    v_mov_b64 v[18:19], 0
    s_waitcnt vmcnt(2)
    v_bitop3_b32 v78, v20, v22, s69 bitop3:0x7e
    v_mfma_f32_16x16x32_bf16 v[0:3], v[4:7], v[20:23], v[0:3]
    v_bitop3_b32 v77, v77, v78, 1 bitop3:0xa8
    v_cmp_ne_u32 vcc, 0, v77
    v_mov_b64 v[20:21], 0
    v_mov_b64 v[22:23], 0
    buffer_load_dwordx4 v[40:43], v65, s[4:7], s14 offen offset:0 nt
    buffer_load_dwordx4 v[60:63], v66, s[4:7], s14 offen offset:0 nt
    s_cmp_eq_u64 vcc, 0
    s_cselect_b64 s[42:43], -1, 0
    v_add_f32_dpp v0, v0, v0 row_ror:8 row_mask:0xf bank_mask:0xf
    v_add_f32_dpp v1, v1, v1 row_ror:8 row_mask:0xf bank_mask:0xf
    s_mov_b64 exec, s[42:43]
    v_cvt_pk_bf16_f32 v72, v0, v1
    v_bfi_b32 v72, v79, s70, v72
    buffer_store_dword v72, v75, s[4:7], s17 offen offset:0
    s_mov_b64 exec, -1
    s_cbranch_scc1 cf_f0_rx
    s_sub_u32 s31, s31, 1
    s_cbranch_scc0 cf_f0_spin
cf_f0_rx:
    v_mov_b64 v[0:1], 0
    v_mov_b64 v[2:3], 0
    v_mov_b64 v[4:5], 0
    v_mov_b64 v[6:7], 0
    s_branch cf_loop
cf_f1_xt:
    s_sub_u32 s37, s37, 1
    s_nop 2
    v_mov_b32 v79, v79
    s_nop 2
    v_mov_b32 v79, v79
    s_nop 2
    v_mov_b32 v79, v79
    s_nop 2
    v_mov_b32 v79, v79
    s_nop 2
    v_mov_b32 v79, v79
    s_nop 2
    v_mov_b32 v79, v79
    s_branch cf_f1_xtx
cf_f1_retry:
    s_sub_u32 s41, s30, s98
    s_mov_b32 s98, s30
    s_cmp_le_u32 s41, 3
    s_cselect_b32 s37, 1, 1
cf_f1_spin:
    buffer_load_dwordx4 v[8:11], v65, s[4:7], s18 offen nt
    buffer_load_dwordx4 v[12:15], v65, s[4:7], s19 offen nt
    buffer_load_dwordx4 v[16:19], v65, s[4:7], s20 offen nt
    buffer_load_dwordx4 v[20:23], v65, s[4:7], s21 offen nt
    s_nop 2
    v_mov_b32 v79, v79
    s_nop 2
    v_mov_b32 v79, v79
    s_nop 2
    v_mov_b32 v79, v79
    buffer_load_dwordx4 v[40:43], v65, s[4:7], s14 offen offset:0 nt
    buffer_load_dwordx4 v[60:63], v66, s[4:7], s14 offen offset:0 nt
    s_waitcnt vmcnt(5)
    v_bitop3_b32 v77, v8, v10, s69 bitop3:0x7e
    v_mfma_f32_16x16x32_bf16 v[0:3], v[4:7], v[8:11], 0
    v_mov_b64 v[8:9], 0
    v_mov_b64 v[10:11], 0
    s_waitcnt vmcnt(4)
    v_bitop3_b32 v78, v12, v14, s69 bitop3:0x7e
    v_mfma_f32_16x16x32_bf16 v[0:3], v[4:7], v[12:15], v[0:3]
    v_or_b32 v77, v77, v78
    v_mov_b64 v[12:13], 0
    v_mov_b64 v[14:15], 0
    s_waitcnt vmcnt(3)
    v_bitop3_b32 v78, v16, v18, s69 bitop3:0x7e
    v_mfma_f32_16x16x32_bf16 v[0:3], v[4:7], v[16:19], v[0:3]
    v_or_b32 v77, v77, v78
    v_mov_b64 v[16:17], 0
    v_mov_b64 v[18:19], 0
    s_waitcnt vmcnt(2)
    v_bitop3_b32 v78, v20, v22, s69 bitop3:0x7e
    v_mfma_f32_16x16x32_bf16 v[0:3], v[4:7], v[20:23], v[0:3]
    v_bitop3_b32 v77, v77, v78, 1 bitop3:0xa8
    v_cmp_ne_u32 vcc, 0, v77
    v_mov_b64 v[20:21], 0
    v_mov_b64 v[22:23], 0
    buffer_load_dwordx4 v[40:43], v65, s[4:7], s14 offen offset:0 nt
    buffer_load_dwordx4 v[60:63], v66, s[4:7], s14 offen offset:0 nt
    s_cmp_eq_u64 vcc, 0
    s_cselect_b64 s[42:43], -1, 0
    v_add_f32_dpp v0, v0, v0 row_ror:8 row_mask:0xf bank_mask:0xf
    v_add_f32_dpp v1, v1, v1 row_ror:8 row_mask:0xf bank_mask:0xf
    s_mov_b64 exec, s[42:43]
    v_cvt_pk_bf16_f32 v72, v0, v1
    v_bfi_b32 v72, v79, s70, v72
    buffer_store_dword v72, v75, s[4:7], s17 offen offset:0
    s_mov_b64 exec, -1
    s_cbranch_scc1 cf_f1_rx
    s_sub_u32 s31, s31, 1
    s_cbranch_scc0 cf_f1_spin
cf_f1_rx:
    v_mov_b64 v[0:1], 0
    v_mov_b64 v[2:3], 0
    v_mov_b64 v[4:5], 0
    v_mov_b64 v[6:7], 0
    s_branch cf_loop
cf_f2_xt:
    s_sub_u32 s37, s37, 1
    s_nop 2
    v_mov_b32 v79, v79
    s_nop 2
    v_mov_b32 v79, v79
    s_nop 2
    v_mov_b32 v79, v79
    s_nop 2
    v_mov_b32 v79, v79
    s_nop 2
    v_mov_b32 v79, v79
    s_nop 2
    v_mov_b32 v79, v79
    s_branch cf_f2_xtx
cf_f2_retry:
    s_sub_u32 s41, s30, s98
    s_mov_b32 s98, s30
    s_cmp_le_u32 s41, 3
    s_cselect_b32 s37, 1, 1
cf_f2_spin:
    buffer_load_dwordx4 v[8:11], v65, s[4:7], s18 offen nt
    buffer_load_dwordx4 v[12:15], v65, s[4:7], s19 offen nt
    buffer_load_dwordx4 v[16:19], v65, s[4:7], s20 offen nt
    buffer_load_dwordx4 v[20:23], v65, s[4:7], s21 offen nt
    s_nop 2
    v_mov_b32 v79, v79
    s_nop 2
    v_mov_b32 v79, v79
    s_nop 2
    v_mov_b32 v79, v79
    buffer_load_dwordx4 v[40:43], v65, s[4:7], s14 offen offset:0 nt
    buffer_load_dwordx4 v[60:63], v66, s[4:7], s14 offen offset:0 nt
    s_waitcnt vmcnt(5)
    v_bitop3_b32 v77, v8, v10, s69 bitop3:0x7e
    v_mfma_f32_16x16x32_bf16 v[0:3], v[4:7], v[8:11], 0
    v_mov_b64 v[8:9], 0
    v_mov_b64 v[10:11], 0
    s_waitcnt vmcnt(4)
    v_bitop3_b32 v78, v12, v14, s69 bitop3:0x7e
    v_mfma_f32_16x16x32_bf16 v[0:3], v[4:7], v[12:15], v[0:3]
    v_or_b32 v77, v77, v78
    v_mov_b64 v[12:13], 0
    v_mov_b64 v[14:15], 0
    s_waitcnt vmcnt(3)
    v_bitop3_b32 v78, v16, v18, s69 bitop3:0x7e
    v_mfma_f32_16x16x32_bf16 v[0:3], v[4:7], v[16:19], v[0:3]
    v_or_b32 v77, v77, v78
    v_mov_b64 v[16:17], 0
    v_mov_b64 v[18:19], 0
    s_waitcnt vmcnt(2)
    v_bitop3_b32 v78, v20, v22, s69 bitop3:0x7e
    v_mfma_f32_16x16x32_bf16 v[0:3], v[4:7], v[20:23], v[0:3]
    v_bitop3_b32 v77, v77, v78, 1 bitop3:0xa8
    v_cmp_ne_u32 vcc, 0, v77
    v_mov_b64 v[20:21], 0
    v_mov_b64 v[22:23], 0
    buffer_load_dwordx4 v[40:43], v65, s[4:7], s14 offen offset:0 nt
    buffer_load_dwordx4 v[60:63], v66, s[4:7], s14 offen offset:0 nt
    s_cmp_eq_u64 vcc, 0
    s_cselect_b64 s[42:43], -1, 0
    v_add_f32_dpp v0, v0, v0 row_ror:4 row_mask:0xf bank_mask:0xf
    v_add_f32_dpp v1, v1, v1 row_ror:4 row_mask:0xf bank_mask:0xf
    s_nop 0
    v_add_f32_dpp v0, v0, v0 row_ror:8 row_mask:0xf bank_mask:0xf
    v_add_f32_dpp v1, v1, v1 row_ror:8 row_mask:0xf bank_mask:0xf
    s_mov_b64 exec, s[42:43]
    v_cvt_pk_bf16_f32 v72, v0, v1
    v_bfi_b32 v72, v79, s70, v72
    buffer_store_dword v72, v75, s[4:7], s17 offen offset:0
    buffer_store_dword v72, v75, s[4:7], s17 offen offset:1024
    buffer_store_dword v72, v75, s[4:7], s17 offen offset:2048
    buffer_store_dword v72, v75, s[4:7], s17 offen offset:3072
    s_mov_b64 exec, -1
    s_cbranch_scc1 cf_f2_rx
    s_sub_u32 s31, s31, 1
    s_cbranch_scc0 cf_f2_spin
cf_f2_rx:
    v_mov_b64 v[0:1], 0
    v_mov_b64 v[2:3], 0
    v_mov_b64 v[4:5], 0
    v_mov_b64 v[6:7], 0
    s_branch cf_loop
cf_spinB:
    s_waitcnt vmcnt(3)
cf_spinB_l:
    v_and_b32 v77, s36, v44
    v_cmp_ne_u32 vcc, s70, v77
    s_cbranch_vccz cf_spinB_x
    buffer_load_dwordx4 v[44:47], v65, s[4:7], s15 offen nt
    s_sub_u32 s31, s31, 16
    s_waitcnt vmcnt(0)
    s_cbranch_scc0 cf_spinB_l
cf_spinB_x:
    ds_write_b128 v65, v[44:47] offset:4096
    s_waitcnt lgkmcnt(0)
    s_branch cf_backB
cf_spin8:
    buffer_load_dwordx4 v[40:43], v65, s[4:7], s16 offen nt
cf_spin8_l:
    v_and_b32 v77, s36, v40
    v_cmp_ne_u32 vcc, s70, v77
    s_cbranch_vccz cf_spin8_x
    s_nop 1
    v_and_b32 v77, s36, v40
    v_cmp_ne_u32 vcc, s70, v77
    s_cbranch_vccz cf_spin8_x
    s_nop 1
    v_and_b32 v77, s36, v40
    v_cmp_ne_u32 vcc, s70, v77
    s_cbranch_vccz cf_spin8_x
    s_nop 1
    buffer_load_dwordx4 v[40:43], v65, s[4:7], s16 offen nt
    s_sub_u32 s31, s31, 16
    s_cbranch_scc0 cf_spin8_l
cf_spin8_x:
    s_branch cf_back8
cf_rare:
    s_mov_b64 exec, s[34:35]
    buffer_store_dwordx4 v[0:3], v65, s[4:7], s28 offen sc1
    s_mov_b64 exec, -1
    s_nop 3
    v_cvt_pk_bf16_f32 v52, v16, v17
    v_cvt_pk_bf16_f32 v53, v18, v19
    v_cvt_pk_bf16_f32 v54, v20, v21
    v_cvt_pk_bf16_f32 v55, v22, v23
    buffer_store_dwordx4 v[52:55], v65, s[4:7], s27 offen sc1
    s_add_u32 s28, s28, 131072
    s_add_u32 s27, s27, 131072
    s_cmp_eq_u32 s30, 63
    s_cbranch_scc1 cf_last
    s_branch cf_rare_x
cf_kvwait:
    s_mov_b32 s41, s97
    v_bfe_u32 v78, v65, 2, 5
    v_mov_b32 v77, v76
    s_nop 1
    v_permlane32_swap_b32 v76, v77
    v_subrev_u32 v77, s95, v77
    v_cmp_lt_u32 vcc, 16, v77
    s_nop 1
    v_cndmask_b32 v77, v77, 0, vcc
    v_bfe_u32 v79, v78, 2, 2
    v_lshl_add_u32 v77, v77, 2, v79
    s_nop 1
    v_min_u32_dpp v77, v77, v77 row_ror:1 row_mask:0xf bank_mask:0xf
    s_nop 1
    v_min_u32_dpp v77, v77, v77 row_ror:2 row_mask:0xf bank_mask:0xf
    s_nop 1
    v_min_u32_dpp v77, v77, v77 row_ror:4 row_mask:0xf bank_mask:0xf
    s_nop 0
    v_readfirstlane_b32 s97, v77
    s_nop 0
    s_max_u32 s97, s97, s41
    s_add_u32 s40, s30, 3
    s_min_u32 s40, s40, 64
    s_cmp_le_u32 s40, s97
    s_cbranch_scc1 cf_kvw_x
    v_bfe_u32 v78, v65, 2, 5
    s_mov_b32 s31, 4194304
cf_kvw:
    buffer_load_dword v77, v78, s[4:7], s96 offen offset:16 sc1
    s_waitcnt vmcnt(0)
    v_subrev_u32 v77, s95, v77
    v_cmp_lt_u32 vcc, 16, v77
    s_nop 1
    v_cndmask_b32 v77, v77, 0, vcc
    v_bfe_u32 v79, v78, 2, 2
    v_lshl_add_u32 v77, v77, 2, v79
    s_nop 1
    v_min_u32_dpp v77, v77, v77 row_ror:1 row_mask:0xf bank_mask:0xf
    s_nop 1
    v_min_u32_dpp v77, v77, v77 row_ror:2 row_mask:0xf bank_mask:0xf
    s_nop 1
    v_min_u32_dpp v77, v77, v77 row_ror:4 row_mask:0xf bank_mask:0xf
    s_nop 0
    v_readfirstlane_b32 s97, v77
    s_sub_u32 s31, s31, 1
    s_cbranch_scc1 cf_kvw_x
    s_cmp_le_u32 s40, s97
    s_cbranch_scc1 cf_kvw_x
    s_sleep 2
    s_branch cf_kvw
cf_kvw_x:
    s_branch cf_kvok
cf_last:
    s_add_u32 s40, s95, 64
    v_mov_b32 v78, s40
    s_waitcnt vmcnt(0)
    s_barrier
    s_mov_b64 exec, s[100:101]
    buffer_store_dword v78, off, s[4:7], s29 sc1
    s_mov_b64 exec, -1
cf_end:
    s_endpgm
L_chain_safe:
    s_load_dwordx8 s[48:55], s[0:1], 8
    s_load_dwordx2 s[56:57], s[0:1], 40
    s_waitcnt lgkmcnt(0)
    v_lshrrev_b32 v77, 6, v0
    s_nop 0
    v_readfirstlane_b32 s13, v77
    v_lshlrev_b32 v65, 4, v0
    v_and_b32 v48, 63, v0
    s_mov_b32 s10, 4718592
    s_mov_b32 s11, 0x20000
    v_lshrrev_b32 v49, 3, v48
    v_mul_u32_u24 v18, 1152, v49
    v_and_b32 v49, 7, v48
    v_lshl_add_u32 v18, v49, 4, v18
    s_mul_i32 s40, s12, 147456
    s_lshl_b32 s41, s13, 8
    s_add_u32 s40, s40, s41
    s_mov_b32 s42, s40
    s_xor_b32 s41, s13, 0
    s_mul_i32 s41, s41, 36864
    s_add_u32 s60, s41, s40
    s_xor_b32 s41, s13, 1
    s_mul_i32 s41, s41, 36864
    s_add_u32 s61, s41, s40
    s_xor_b32 s41, s13, 2
    s_mul_i32 s41, s41, 36864
    s_add_u32 s62, s41, s40
    s_xor_b32 s41, s13, 3
    s_mul_i32 s41, s41, 36864
    s_add_u32 s63, s41, s40
    s_lshl_b32 s43, s13, 12
    s_mov_b64 s[8:9], s[56:57]
    s_add_u32 m0, s43, 0
    s_add_u32 s41, s60, 0
    buffer_load_dwordx4 v18, s[8:11], s41 offen offset:0 nt lds
    s_add_u32 s41, s60, 8192
    buffer_load_dwordx4 v18, s[8:11], s41 offen offset:1024 nt lds
    s_add_u32 s41, s60, 16384
    buffer_load_dwordx4 v18, s[8:11], s41 offen offset:2048 nt lds
    s_add_u32 s41, s60, 24576
    buffer_load_dwordx4 v18, s[8:11], s41 offen offset:3072 nt lds
    s_add_u32 m0, s43, 36864
    s_add_u32 s41, s61, 0
    buffer_load_dwordx4 v18, s[8:11], s41 offen offset:0 nt lds
    s_add_u32 s41, s61, 8192
    buffer_load_dwordx4 v18, s[8:11], s41 offen offset:1024 nt lds
    s_add_u32 s41, s61, 16384
    buffer_load_dwordx4 v18, s[8:11], s41 offen offset:2048 nt lds
    s_add_u32 s41, s61, 24576
    buffer_load_dwordx4 v18, s[8:11], s41 offen offset:3072 nt lds
    s_add_u32 m0, s43, 73728
    s_add_u32 s41, s62, 0
    buffer_load_dwordx4 v18, s[8:11], s41 offen offset:0 nt lds
    s_add_u32 s41, s62, 8192
    buffer_load_dwordx4 v18, s[8:11], s41 offen offset:1024 nt lds
    s_add_u32 s41, s62, 16384
    buffer_load_dwordx4 v18, s[8:11], s41 offen offset:2048 nt lds
    s_add_u32 s41, s62, 24576
    buffer_load_dwordx4 v18, s[8:11], s41 offen offset:3072 nt lds
    s_add_u32 m0, s43, 110592
    s_add_u32 s41, s63, 0
    buffer_load_dwordx4 v18, s[8:11], s41 offen offset:0 nt lds
    s_add_u32 s41, s63, 8192
    buffer_load_dwordx4 v18, s[8:11], s41 offen offset:1024 nt lds
    s_add_u32 s41, s63, 16384
    buffer_load_dwordx4 v18, s[8:11], s41 offen offset:2048 nt lds
    s_add_u32 s41, s63, 24576
    buffer_load_dwordx4 v18, s[8:11], s41 offen offset:3072 nt lds
    v_lshrrev_b32 v49, 1, v48
    v_mul_u32_u24 v19, 1152, v49
    v_and_b32 v49, 1, v48
    v_lshl_add_u32 v19, v49, 4, v19
    s_mul_i32 s41, s13, 224
    s_sub_u32 s41, 1024, s41
    v_add_u32 v19, s41, v19
    v_lshrrev_b32 v49, 4, v48
    v_lshlrev_b32 v50, 2, v49
    v_and_b32 v51, 15, v48
    v_xor_b32 v51, v51, v50
    v_lshlrev_b32 v51, 4, v51
    v_lshl_add_u32 v16, v49, 15, v51
    v_lshrrev_b32 v50, 1, v49
    v_lshl_add_u32 v17, v50, 16, v51
    v_and_b32 v50, 1, v49
    v_lshl_add_u32 v17, v50, 13, v17
    s_lshl_b32 s40, s12, 8
    s_mul_i32 s58, s13, 1048576
    s_add_u32 s58, s58, s40
    s_lshr_b32 s41, s13, 1
    s_mul_i32 s59, s41, 262144
    s_and_b32 s41, s13, 1
    s_lshl_b32 s41, s41, 14
    s_add_u32 s59, s59, s41
    s_add_u32 s59, s59, s40
    s_add_u32 s59, s59, 4194304
    v_bfe_u32 v50, v48, 2, 2
    v_xor_b32 v51, s13, v50
    v_lshlrev_b32 v20, 6, v51
    v_and_b32 v51, 3, v48
    v_lshl_add_u32 v20, v51, 4, v20
    v_lshrrev_b32 v23, 2, v48
    v_lshl_add_u32 v20, v23, 8, v20
    s_xor_b32 s41, s43, 0
    v_add_u32 v24, s41, v20
    s_xor_b32 s41, s43, 4096
    v_add_u32 v25, s41, v20
    s_xor_b32 s41, s43, 8192
    v_add_u32 v26, s41, v20
    s_xor_b32 s41, s43, 12288
    v_add_u32 v27, s41, v20
    v_and_b32 v23, 1, v50
    v_lshl_add_u32 v23, v49, 2, v23
    v_lshrrev_b32 v50, 1, v50
    v_lshlrev_b32 v21, 7, v23
    v_lshl_add_u32 v21, v50, 6, v21
    v_lshrrev_b32 v16, 1, v51
    v_lshl_add_u32 v21, v16, 5, v21
    v_and_b32 v16, 1, v51
    v_lshl_add_u32 v21, v16, 3, v21
    v_add_u32 v21, s43, v21
    v_lshlrev_b32 v22, 9, v50
    v_xor_b32 v22, v22, v21
    v_lshlrev_b32 v23, 5, v23
    v_lshl_add_u32 v23, v50, 10, v23
    v_lshl_add_u32 v23, v51, 3, v23
    v_add_u32 v23, s43, v23
    v_bfe_u32 v60, v65, 4, 6
    v_and_b32 v61, 15, v60
    v_lshrrev_b32 v62, 4, v60
    v_mov_b32 v64, 0x4444
    v_mov_b32 v77, 0xeeee
    v_cmp_lt_u32 vcc, 7, v61
    s_nop 1
    v_cndmask_b32 v64, v64, v77, vcc
    v_xor_b32 v66, 1024, v65
    v_xor_b32 v67, 2048, v65
    v_xor_b32 v68, 3072, v65
    v_and_b32 v69, 511, v65
    s_mul_i32 s96, s13, 36864
    s_add_u32 s96, s96, 16384
    v_lshlrev_b32 v70, 4, v60
    v_add_u32 v70, s96, v70
    v_lshrrev_b32 v79, 1, v69
    s_lshl_b32 s96, s13, 8
    s_add_u32 s96, s96, 14336
    s_lshl_b32 s33, s13, 10
    s_add_u32 s97, s33, 8192
    v_mov_b32 v77, s97
    v_mov_b32 v78, s96
    v_cmp_lt_u32 vcc, 31, v60
    s_nop 1
    v_cndmask_b32 v71, v77, v78, vcc
    v_add_u32 v71, v71, v79
    v_and_b32 v77, 7, v61
    v_lshrrev_b32 v78, 3, v61
    v_lshlrev_b32 v74, 4, v77
    v_lshl_add_u32 v73, v62, 7, v74
    v_lshl_add_u32 v73, v78, 3, v73
    s_lshl_b32 s96, s13, 9
    v_add_u32 v73, s96, v73
    v_lshrrev_b32 v74, 1, v74
    v_lshl_add_u32 v74, v78, 14, v74
    v_lshl_add_u32 v74, v62, 15, v74
    s_lshl_b32 s96, s13, 17
    v_add_u32 v74, s96, v74
    v_bfe_u32 v77, v61, 2, 1
    v_and_b32 v78, 3, v61
    s_cmp_lt_u32 s13, 2
    s_cselect_b64 vcc, -1, 0
    v_cndmask_b32 v77, 0, v77, vcc
    v_lshlrev_b32 v75, 7, v77
    v_lshl_add_u32 v75, v62, 4, v75
    v_lshl_add_u32 v75, v78, 2, v75
    v_lshlrev_b32 v58, 3, v77
    v_lshl_add_u32 v58, v78, 1, v58
    s_bfe_u32 s97, s12, 0x10001
    s_lshl_b32 s68, s97, 6
    s_lshl_b32 s97, s97, 2
    v_add_u32 v59, s97, v62
    s_bfe_u32 s96, s12, 0x10002
    s_and_b32 s40, s12, 1
    s_lshl_b32 s96, s96, 1
    s_add_u32 s96, s96, s40
    s_lshr_b32 s97, s12, 3
    s_lshl_b32 s98, s13, 2
    s_add_u32 s98, s98, s97
    s_lshl_b32 s98, s98, 2
    s_add_u32 s98, s98, s96
    s_lshl_b32 s98, s98, 8
    s_lshl_b32 s99, s13, 2
    s_add_u32 s99, s99, s96
    s_lshl_b32 s99, s99, 4
    s_lshl_b32 s41, s97, 1
    s_add_u32 s41, s41, s40
    s_lshl_b32 s41, s41, 7
    s_add_u32 s41, s41, 8192
    s_lshl_b32 s40, s40, 3
    s_add_u32 s40, s40, 512
    s_cmp_lt_u32 s13, 2
    s_cselect_b32 s96, 7, 4
    s_cselect_b32 s98, s98, s41
    s_cselect_b32 s99, s99, s40
    s_cselect_b32 s32, 1, 0
    s_add_u32 s68, s68, s98
    s_lshl_b32 s97, s97, s96
    s_add_u32 s99, s99, s97
    v_add_u32 v58, s99, v58
    s_and_b32 s97, s12, 4
    s_or_b32 s97, s97, s13
    s_cmp_eq_u32 s97, 2
    s_cselect_b32 s32, 2, s32
    s_mov_b32 s8, s48
    s_mov_b32 s9, s49
    s_mov_b32 s10, 9216
    v_mul_u32_u24 v77, 1152, v59
    v_lshl_add_u32 v77, v58, 1, v77
    buffer_load_dword v72, v77, s[8:11], 0 offen
    s_mov_b32 s10, 4718592
    s_waitcnt vmcnt(12) lgkmcnt(0)
    s_barrier
    s_mov_b64 s[8:9], s[56:57]
    s_add_u32 m0, s43, 147456
    s_add_u32 s41, s42, 0
    buffer_load_dwordx4 v19, s[8:11], s41 offen offset:0 nt lds
    s_add_u32 s41, s42, 35840
    buffer_load_dwordx4 v19, s[8:11], s41 offen offset:1024 nt lds
    s_add_u32 s41, s42, 71680
    buffer_load_dwordx4 v19, s[8:11], s41 offen offset:2048 nt lds
    s_add_u32 s41, s42, 107520
    buffer_load_dwordx4 v19, s[8:11], s41 offen offset:3072 nt lds
    v_mov_b32 v78, v21
    v_mov_b32 v79, v22
    v_add_u32 v77, 0, v79
    ds_read_b64_tr_b16 v[80:81], v77 offset:0
    ds_read_b64_tr_b16 v[82:83], v77 offset:256
    ds_read_b64_tr_b16 v[84:85], v77 offset:2048
    ds_read_b64_tr_b16 v[86:87], v77 offset:2304
    ds_read_b64_tr_b16 v[112:113], v77 offset:16
    ds_read_b64_tr_b16 v[114:115], v77 offset:272
    ds_read_b64_tr_b16 v[116:117], v77 offset:2064
    ds_read_b64_tr_b16 v[118:119], v77 offset:2320
    s_waitcnt vmcnt(12) lgkmcnt(0)
    s_barrier
    s_mov_b64 s[8:9], s[52:53]
    s_add_u32 m0, s43, 0
    s_add_u32 s41, s58, 0
    buffer_load_dwordx4 v17, s[8:11], s41 offen offset:0 nt lds
    s_add_u32 s41, s58, 31744
    buffer_load_dwordx4 v17, s[8:11], s41 offen offset:1024 nt lds
    s_add_u32 s41, s58, 129024
    buffer_load_dwordx4 v17, s[8:11], s41 offen offset:2048 nt lds
    s_add_u32 s41, s58, 160768
    buffer_load_dwordx4 v17, s[8:11], s41 offen offset:3072 nt lds
    v_add_u32 v77, 36864, v78
    ds_read_b64_tr_b16 v[88:89], v77 offset:0
    ds_read_b64_tr_b16 v[90:91], v77 offset:256
    ds_read_b64_tr_b16 v[92:93], v77 offset:2048
    ds_read_b64_tr_b16 v[94:95], v77 offset:2304
    ds_read_b64_tr_b16 v[120:121], v77 offset:16
    ds_read_b64_tr_b16 v[122:123], v77 offset:272
    ds_read_b64_tr_b16 v[124:125], v77 offset:2064
    ds_read_b64_tr_b16 v[126:127], v77 offset:2320
    s_waitcnt vmcnt(12) lgkmcnt(0)
    s_barrier
    s_add_u32 m0, s43, 36864
    s_add_u32 s41, s58, 16384
    buffer_load_dwordx4 v17, s[8:11], s41 offen offset:0 nt lds
    s_add_u32 s41, s58, 48128
    buffer_load_dwordx4 v17, s[8:11], s41 offen offset:1024 nt lds
    s_add_u32 s41, s58, 145408
    buffer_load_dwordx4 v17, s[8:11], s41 offen offset:2048 nt lds
    s_add_u32 s41, s58, 177152
    buffer_load_dwordx4 v17, s[8:11], s41 offen offset:3072 nt lds
    v_add_u32 v77, 73728, v78
    ds_read_b64_tr_b16 v[96:97], v77 offset:0
    ds_read_b64_tr_b16 v[98:99], v77 offset:256
    ds_read_b64_tr_b16 v[100:101], v77 offset:2048
    ds_read_b64_tr_b16 v[102:103], v77 offset:2304
    ds_read_b64_tr_b16 v[128:129], v77 offset:16
    ds_read_b64_tr_b16 v[130:131], v77 offset:272
    ds_read_b64_tr_b16 v[132:133], v77 offset:2064
    ds_read_b64_tr_b16 v[134:135], v77 offset:2320
    s_waitcnt vmcnt(12) lgkmcnt(0)
    s_barrier
    s_add_u32 m0, s43, 73728
    s_add_u32 s41, s58, 262144
    buffer_load_dwordx4 v17, s[8:11], s41 offen offset:0 nt lds
    s_add_u32 s41, s58, 293888
    buffer_load_dwordx4 v17, s[8:11], s41 offen offset:1024 nt lds
    s_add_u32 s41, s58, 391168
    buffer_load_dwordx4 v17, s[8:11], s41 offen offset:2048 nt lds
    s_add_u32 s41, s58, 422912
    buffer_load_dwordx4 v17, s[8:11], s41 offen offset:3072 nt lds
    v_add_u32 v77, 110592, v78
    ds_read_b64_tr_b16 v[104:105], v77 offset:0
    ds_read_b64_tr_b16 v[106:107], v77 offset:256
    ds_read_b64_tr_b16 v[108:109], v77 offset:2048
    ds_read_b64_tr_b16 v[110:111], v77 offset:2304
    ds_read_b64_tr_b16 v[136:137], v77 offset:16
    ds_read_b64_tr_b16 v[138:139], v77 offset:272
    ds_read_b64_tr_b16 v[140:141], v77 offset:2064
    ds_read_b64_tr_b16 v[142:143], v77 offset:2320
    s_waitcnt vmcnt(12) lgkmcnt(0)
    s_barrier
    s_add_u32 m0, s43, 110592
    s_add_u32 s41, s58, 278528
    buffer_load_dwordx4 v17, s[8:11], s41 offen offset:0 nt lds
    s_add_u32 s41, s58, 310272
    buffer_load_dwordx4 v17, s[8:11], s41 offen offset:1024 nt lds
    s_add_u32 s41, s58, 407552
    buffer_load_dwordx4 v17, s[8:11], s41 offen offset:2048 nt lds
    s_add_u32 s41, s58, 439296
    buffer_load_dwordx4 v17, s[8:11], s41 offen offset:3072 nt lds
    v_add_u32 v77, 147456, v23
    ds_read_b64_tr_b16 v[0:1], v77 offset:0
    ds_read_b64_tr_b16 v[2:3], v77 offset:64
    ds_read_b64_tr_b16 v[4:5], v77 offset:512
    ds_read_b64_tr_b16 v[6:7], v77 offset:576
    ds_read_b64_tr_b16 v[8:9], v77 offset:2048
    ds_read_b64_tr_b16 v[10:11], v77 offset:2112
    ds_read_b64_tr_b16 v[12:13], v77 offset:2560
    ds_read_b64_tr_b16 v[14:15], v77 offset:2624
    s_waitcnt vmcnt(12) lgkmcnt(0)
    s_barrier
    s_add_u32 m0, s43, 147456
    s_add_u32 s41, s58, 524288
    buffer_load_dwordx4 v17, s[8:11], s41 offen offset:0 nt lds
    s_add_u32 s41, s58, 556032
    buffer_load_dwordx4 v17, s[8:11], s41 offen offset:1024 nt lds
    s_add_u32 s41, s58, 653312
    buffer_load_dwordx4 v17, s[8:11], s41 offen offset:2048 nt lds
    s_add_u32 s41, s58, 685056
    buffer_load_dwordx4 v17, s[8:11], s41 offen offset:3072 nt lds
    s_cmp_eq_u32 s32, 0
    s_cbranch_scc1 cs_init_done
    v_mov_b32 v52, 1
    v_mov_b32 v53, 1
    v_mov_b32 v54, 1
    v_mov_b32 v55, 1
    v_mov_b32 v56, 0
    s_lshl_b32 s96, s12, 14
    s_add_u32 s96, s96, 68681728
    s_add_u32 s97, s96, 0
    buffer_store_dwordx4 v[52:55], v65, s[4:7], s97 offen sc1
    s_add_u32 s97, s96, 4096
    buffer_store_dwordx4 v[52:55], v65, s[4:7], s97 offen sc1
    s_add_u32 s97, s96, 8192
    buffer_store_dwordx4 v[52:55], v65, s[4:7], s97 offen sc1
    s_add_u32 s97, s96, 12288
    buffer_store_dwordx4 v[52:55], v65, s[4:7], s97 offen sc1
    s_add_u32 s96, s68, 67633152
    s_add_u32 s97, s96, 16384
    buffer_store_dword v56, v75, s[4:7], s96 offen offset:0 sc1
    buffer_store_dword v72, v75, s[4:7], s97 offen offset:0 sc1
    s_cmp_lg_u32 s32, 2
    s_cbranch_scc1 cs_init_done
    buffer_store_dword v56, v75, s[4:7], s96 offen offset:1024 sc1
    buffer_store_dword v72, v75, s[4:7], s97 offen offset:1024 sc1
    buffer_store_dword v56, v75, s[4:7], s96 offen offset:2048 sc1
    buffer_store_dword v72, v75, s[4:7], s97 offen offset:2048 sc1
    buffer_store_dword v56, v75, s[4:7], s96 offen offset:3072 sc1
    buffer_store_dword v72, v75, s[4:7], s97 offen offset:3072 sc1
cs_init_done:
    ds_write_b64 v70, v[0:1] offset:16384
    ds_write_b64 v70, v[2:3] offset:16392
    ds_write_b64 v70, v[4:5] offset:17408
    ds_write_b64 v70, v[6:7] offset:17416
    ds_write_b64 v70, v[8:9] offset:18432
    ds_write_b64 v70, v[10:11] offset:18440
    ds_write_b64 v70, v[12:13] offset:19456
    ds_write_b64 v70, v[14:15] offset:19464
    v_add_u32 v28, 0, v24
    v_add_u32 v29, 0, v25
    v_add_u32 v30, 0, v26
    v_add_u32 v31, 0, v27
    ds_read_b64_tr_b16 a[96:97], v28 offset:0
    ds_read_b64_tr_b16 a[104:105], v28 offset:8
    ds_read_b64_tr_b16 a[112:113], v29 offset:0
    ds_read_b64_tr_b16 a[120:121], v29 offset:8
    ds_read_b64_tr_b16 a[128:129], v30 offset:0
    ds_read_b64_tr_b16 a[136:137], v30 offset:8
    ds_read_b64_tr_b16 a[144:145], v31 offset:0
    ds_read_b64_tr_b16 v[32:33], v31 offset:8
    s_waitcnt vmcnt(12) lgkmcnt(0)
    s_barrier
    s_add_u32 m0, s43, 0
    s_add_u32 s41, s58, 540672
    buffer_load_dwordx4 v17, s[8:11], s41 offen offset:0 nt lds
    s_add_u32 s41, s58, 572416
    buffer_load_dwordx4 v17, s[8:11], s41 offen offset:1024 nt lds
    s_add_u32 s41, s58, 669696
    buffer_load_dwordx4 v17, s[8:11], s41 offen offset:2048 nt lds
    s_add_u32 s41, s58, 701440
    buffer_load_dwordx4 v17, s[8:11], s41 offen offset:3072 nt lds
    ds_write_b64 v70, v[32:33] offset:12288
    v_add_u32 v28, 36864, v24
    v_add_u32 v29, 36864, v25
    v_add_u32 v30, 36864, v26
    v_add_u32 v31, 36864, v27
    ds_read_b64_tr_b16 a[98:99], v28 offset:0
    ds_read_b64_tr_b16 a[106:107], v28 offset:8
    ds_read_b64_tr_b16 a[114:115], v29 offset:0
    ds_read_b64_tr_b16 a[122:123], v29 offset:8
    ds_read_b64_tr_b16 a[130:131], v30 offset:0
    ds_read_b64_tr_b16 a[138:139], v30 offset:8
    ds_read_b64_tr_b16 a[146:147], v31 offset:0
    ds_read_b64_tr_b16 v[0:1], v31 offset:8
    s_waitcnt vmcnt(12) lgkmcnt(0)
    s_barrier
    s_add_u32 m0, s43, 36864
    s_add_u32 s41, s58, 786432
    buffer_load_dwordx4 v17, s[8:11], s41 offen offset:0 nt lds
    s_add_u32 s41, s58, 818176
    buffer_load_dwordx4 v17, s[8:11], s41 offen offset:1024 nt lds
    s_add_u32 s41, s58, 915456
    buffer_load_dwordx4 v17, s[8:11], s41 offen offset:2048 nt lds
    s_add_u32 s41, s58, 947200
    buffer_load_dwordx4 v17, s[8:11], s41 offen offset:3072 nt lds
    ds_write_b64 v70, v[0:1] offset:12296
    v_add_u32 v28, 73728, v24
    v_add_u32 v29, 73728, v25
    v_add_u32 v30, 73728, v26
    v_add_u32 v31, 73728, v27
    ds_read_b64_tr_b16 a[100:101], v28 offset:0
    ds_read_b64_tr_b16 a[108:109], v28 offset:8
    ds_read_b64_tr_b16 a[116:117], v29 offset:0
    ds_read_b64_tr_b16 a[124:125], v29 offset:8
    ds_read_b64_tr_b16 a[132:133], v30 offset:0
    ds_read_b64_tr_b16 a[140:141], v30 offset:8
    ds_read_b64_tr_b16 a[148:149], v31 offset:0
    ds_read_b64_tr_b16 v[32:33], v31 offset:8
    s_waitcnt vmcnt(12) lgkmcnt(0)
    s_barrier
    s_add_u32 m0, s43, 73728
    s_add_u32 s41, s58, 802816
    buffer_load_dwordx4 v17, s[8:11], s41 offen offset:0 nt lds
    s_add_u32 s41, s58, 834560
    buffer_load_dwordx4 v17, s[8:11], s41 offen offset:1024 nt lds
    s_add_u32 s41, s58, 931840
    buffer_load_dwordx4 v17, s[8:11], s41 offen offset:2048 nt lds
    s_add_u32 s41, s58, 963584
    buffer_load_dwordx4 v17, s[8:11], s41 offen offset:3072 nt lds
    ds_write_b64 v70, v[32:33] offset:13312
    v_add_u32 v28, 110592, v24
    v_add_u32 v29, 110592, v25
    v_add_u32 v30, 110592, v26
    v_add_u32 v31, 110592, v27
    ds_read_b64_tr_b16 a[102:103], v28 offset:0
    ds_read_b64_tr_b16 a[110:111], v28 offset:8
    ds_read_b64_tr_b16 a[118:119], v29 offset:0
    ds_read_b64_tr_b16 a[126:127], v29 offset:8
    ds_read_b64_tr_b16 a[134:135], v30 offset:0
    ds_read_b64_tr_b16 a[142:143], v30 offset:8
    ds_read_b64_tr_b16 a[150:151], v31 offset:0
    ds_read_b64_tr_b16 v[0:1], v31 offset:8
    s_waitcnt vmcnt(12) lgkmcnt(0)
    s_barrier
    s_add_u32 m0, s43, 110592
    s_add_u32 s41, s59, 0
    buffer_load_dwordx4 v17, s[8:11], s41 offen offset:0 nt lds
    s_add_u32 s41, s59, 31744
    buffer_load_dwordx4 v17, s[8:11], s41 offen offset:1024 nt lds
    s_add_u32 s41, s59, 129024
    buffer_load_dwordx4 v17, s[8:11], s41 offen offset:2048 nt lds
    s_add_u32 s41, s59, 160768
    buffer_load_dwordx4 v17, s[8:11], s41 offen offset:3072 nt lds
    ds_write_b64 v70, v[0:1] offset:13320
    v_add_u32 v28, 147456, v24
    v_add_u32 v29, 147456, v25
    v_add_u32 v30, 147456, v26
    v_add_u32 v31, 147456, v27
    ds_read_b64_tr_b16 a[152:153], v28 offset:0
    ds_read_b64_tr_b16 a[160:161], v28 offset:8
    ds_read_b64_tr_b16 a[168:169], v29 offset:0
    ds_read_b64_tr_b16 a[176:177], v29 offset:8
    ds_read_b64_tr_b16 a[184:185], v30 offset:0
    ds_read_b64_tr_b16 a[192:193], v30 offset:8
    ds_read_b64_tr_b16 a[200:201], v31 offset:0
    ds_read_b64_tr_b16 a[208:209], v31 offset:8
    s_waitcnt vmcnt(12) lgkmcnt(0)
    s_barrier
    s_mov_b64 s[8:9], s[50:51]
    s_add_u32 m0, s43, 147456
    s_add_u32 s41, s58, 0
    buffer_load_dwordx4 v17, s[8:11], s41 offen offset:0 nt lds
    s_add_u32 s41, s58, 31744
    buffer_load_dwordx4 v17, s[8:11], s41 offen offset:1024 nt lds
    s_add_u32 s41, s58, 129024
    buffer_load_dwordx4 v17, s[8:11], s41 offen offset:2048 nt lds
    s_add_u32 s41, s58, 160768
    buffer_load_dwordx4 v17, s[8:11], s41 offen offset:3072 nt lds
    v_add_u32 v28, 0, v24
    v_add_u32 v29, 0, v25
    v_add_u32 v30, 0, v26
    v_add_u32 v31, 0, v27
    ds_read_b64_tr_b16 a[154:155], v28 offset:0
    ds_read_b64_tr_b16 a[162:163], v28 offset:8
    ds_read_b64_tr_b16 a[170:171], v29 offset:0
    ds_read_b64_tr_b16 a[178:179], v29 offset:8
    ds_read_b64_tr_b16 a[186:187], v30 offset:0
    ds_read_b64_tr_b16 a[194:195], v30 offset:8
    ds_read_b64_tr_b16 a[202:203], v31 offset:0
    ds_read_b64_tr_b16 a[210:211], v31 offset:8
    s_waitcnt vmcnt(12) lgkmcnt(0)
    s_barrier
    s_add_u32 m0, s43, 0
    s_add_u32 s41, s58, 16384
    buffer_load_dwordx4 v17, s[8:11], s41 offen offset:0 nt lds
    s_add_u32 s41, s58, 48128
    buffer_load_dwordx4 v17, s[8:11], s41 offen offset:1024 nt lds
    s_add_u32 s41, s58, 145408
    buffer_load_dwordx4 v17, s[8:11], s41 offen offset:2048 nt lds
    s_add_u32 s41, s58, 177152
    buffer_load_dwordx4 v17, s[8:11], s41 offen offset:3072 nt lds
    v_add_u32 v28, 36864, v24
    v_add_u32 v29, 36864, v25
    v_add_u32 v30, 36864, v26
    v_add_u32 v31, 36864, v27
    ds_read_b64_tr_b16 a[156:157], v28 offset:0
    ds_read_b64_tr_b16 a[164:165], v28 offset:8
    ds_read_b64_tr_b16 a[172:173], v29 offset:0
    ds_read_b64_tr_b16 a[180:181], v29 offset:8
    ds_read_b64_tr_b16 a[188:189], v30 offset:0
    ds_read_b64_tr_b16 a[196:197], v30 offset:8
    ds_read_b64_tr_b16 a[204:205], v31 offset:0
    ds_read_b64_tr_b16 a[212:213], v31 offset:8
    s_waitcnt vmcnt(12) lgkmcnt(0)
    s_barrier
    s_add_u32 m0, s43, 36864
    s_add_u32 s41, s58, 262144
    buffer_load_dwordx4 v17, s[8:11], s41 offen offset:0 nt lds
    s_add_u32 s41, s58, 293888
    buffer_load_dwordx4 v17, s[8:11], s41 offen offset:1024 nt lds
    s_add_u32 s41, s58, 391168
    buffer_load_dwordx4 v17, s[8:11], s41 offen offset:2048 nt lds
    s_add_u32 s41, s58, 422912
    buffer_load_dwordx4 v17, s[8:11], s41 offen offset:3072 nt lds
    v_add_u32 v28, 73728, v24
    v_add_u32 v29, 73728, v25
    v_add_u32 v30, 73728, v26
    v_add_u32 v31, 73728, v27
    ds_read_b64_tr_b16 a[158:159], v28 offset:0
    ds_read_b64_tr_b16 a[166:167], v28 offset:8
    ds_read_b64_tr_b16 a[174:175], v29 offset:0
    ds_read_b64_tr_b16 a[182:183], v29 offset:8
    ds_read_b64_tr_b16 a[190:191], v30 offset:0
    ds_read_b64_tr_b16 a[198:199], v30 offset:8
    ds_read_b64_tr_b16 a[206:207], v31 offset:0
    ds_read_b64_tr_b16 a[214:215], v31 offset:8
    s_waitcnt vmcnt(12) lgkmcnt(0)
    s_barrier
    s_add_u32 m0, s43, 73728
    s_add_u32 s41, s58, 278528
    buffer_load_dwordx4 v17, s[8:11], s41 offen offset:0 nt lds
    s_add_u32 s41, s58, 310272
    buffer_load_dwordx4 v17, s[8:11], s41 offen offset:1024 nt lds
    s_add_u32 s41, s58, 407552
    buffer_load_dwordx4 v17, s[8:11], s41 offen offset:2048 nt lds
    s_add_u32 s41, s58, 439296
    buffer_load_dwordx4 v17, s[8:11], s41 offen offset:3072 nt lds
    v_add_u32 v77, 110592, v20
    ds_read_b64_tr_b16 a[216:217], v77 offset:0
    ds_read_b64_tr_b16 a[218:219], v77 offset:4096
    ds_read_b64_tr_b16 a[220:221], v77 offset:8192
    ds_read_b64_tr_b16 a[222:223], v77 offset:12288
    ds_read_b64_tr_b16 a[224:225], v77 offset:8
    ds_read_b64_tr_b16 a[226:227], v77 offset:4104
    ds_read_b64_tr_b16 a[228:229], v77 offset:8200
    ds_read_b64_tr_b16 a[230:231], v77 offset:12296
    s_waitcnt vmcnt(12) lgkmcnt(0)
    s_barrier
    s_add_u32 m0, s43, 110592
    s_add_u32 s41, s58, 524288
    buffer_load_dwordx4 v17, s[8:11], s41 offen offset:0 nt lds
    s_add_u32 s41, s58, 556032
    buffer_load_dwordx4 v17, s[8:11], s41 offen offset:1024 nt lds
    s_add_u32 s41, s58, 653312
    buffer_load_dwordx4 v17, s[8:11], s41 offen offset:2048 nt lds
    s_add_u32 s41, s58, 685056
    buffer_load_dwordx4 v17, s[8:11], s41 offen offset:3072 nt lds
    v_add_u32 v28, 147456, v24
    v_add_u32 v29, 147456, v25
    v_add_u32 v30, 147456, v26
    v_add_u32 v31, 147456, v27
    ds_read_b64_tr_b16 v[0:1], v28 offset:0
    ds_read_b64_tr_b16 v[2:3], v28 offset:8
    ds_read_b64_tr_b16 v[4:5], v29 offset:0
    ds_read_b64_tr_b16 v[6:7], v29 offset:8
    ds_read_b64_tr_b16 a[0:1], v30 offset:0
    ds_read_b64_tr_b16 v[8:9], v30 offset:8
    ds_read_b64_tr_b16 a[8:9], v31 offset:0
    ds_read_b64_tr_b16 v[10:11], v31 offset:8
    s_waitcnt vmcnt(12) lgkmcnt(0)
    s_barrier
    s_add_u32 m0, s43, 147456
    s_add_u32 s41, s58, 540672
    buffer_load_dwordx4 v17, s[8:11], s41 offen offset:0 nt lds
    s_add_u32 s41, s58, 572416
    buffer_load_dwordx4 v17, s[8:11], s41 offen offset:1024 nt lds
    s_add_u32 s41, s58, 669696
    buffer_load_dwordx4 v17, s[8:11], s41 offen offset:2048 nt lds
    s_add_u32 s41, s58, 701440
    buffer_load_dwordx4 v17, s[8:11], s41 offen offset:3072 nt lds
    ds_write_b64 v70, v[0:1] offset:0
    ds_write_b64 v70, v[2:3] offset:2048
    ds_write_b64 v70, v[4:5] offset:4096
    ds_write_b64 v70, v[6:7] offset:6144
    ds_write_b64 v70, v[8:9] offset:10240
    ds_write_b64 v70, v[10:11] offset:14336
    v_add_u32 v28, 0, v24
    v_add_u32 v29, 0, v25
    v_add_u32 v30, 0, v26
    v_add_u32 v31, 0, v27
    ds_read_b64_tr_b16 v[32:33], v28 offset:0
    ds_read_b64_tr_b16 v[34:35], v28 offset:8
    ds_read_b64_tr_b16 v[36:37], v29 offset:0
    ds_read_b64_tr_b16 v[38:39], v29 offset:8
    ds_read_b64_tr_b16 a[2:3], v30 offset:0
    ds_read_b64_tr_b16 v[40:41], v30 offset:8
    ds_read_b64_tr_b16 a[10:11], v31 offset:0
    ds_read_b64_tr_b16 v[42:43], v31 offset:8
    s_waitcnt vmcnt(12) lgkmcnt(0)
    s_barrier
    s_add_u32 m0, s43, 0
    s_add_u32 s41, s58, 786432
    buffer_load_dwordx4 v17, s[8:11], s41 offen offset:0 nt lds
    s_add_u32 s41, s58, 818176
    buffer_load_dwordx4 v17, s[8:11], s41 offen offset:1024 nt lds
    s_add_u32 s41, s58, 915456
    buffer_load_dwordx4 v17, s[8:11], s41 offen offset:2048 nt lds
    s_add_u32 s41, s58, 947200
    buffer_load_dwordx4 v17, s[8:11], s41 offen offset:3072 nt lds
    ds_write_b64 v70, v[32:33] offset:8
    ds_write_b64 v70, v[34:35] offset:2056
    ds_write_b64 v70, v[36:37] offset:4104
    ds_write_b64 v70, v[38:39] offset:6152
    ds_write_b64 v70, v[40:41] offset:10248
    ds_write_b64 v70, v[42:43] offset:14344
    v_add_u32 v28, 36864, v24
    v_add_u32 v29, 36864, v25
    v_add_u32 v30, 36864, v26
    v_add_u32 v31, 36864, v27
    ds_read_b64_tr_b16 v[0:1], v28 offset:0
    ds_read_b64_tr_b16 v[2:3], v28 offset:8
    ds_read_b64_tr_b16 v[4:5], v29 offset:0
    ds_read_b64_tr_b16 v[6:7], v29 offset:8
    ds_read_b64_tr_b16 a[4:5], v30 offset:0
    ds_read_b64_tr_b16 v[8:9], v30 offset:8
    ds_read_b64_tr_b16 a[12:13], v31 offset:0
    ds_read_b64_tr_b16 v[10:11], v31 offset:8
    s_waitcnt vmcnt(12) lgkmcnt(0)
    s_barrier
    s_add_u32 m0, s43, 36864
    s_add_u32 s41, s58, 802816
    buffer_load_dwordx4 v17, s[8:11], s41 offen offset:0 nt lds
    s_add_u32 s41, s58, 834560
    buffer_load_dwordx4 v17, s[8:11], s41 offen offset:1024 nt lds
    s_add_u32 s41, s58, 931840
    buffer_load_dwordx4 v17, s[8:11], s41 offen offset:2048 nt lds
    s_add_u32 s41, s58, 963584
    buffer_load_dwordx4 v17, s[8:11], s41 offen offset:3072 nt lds
    ds_write_b64 v70, v[0:1] offset:1024
    ds_write_b64 v70, v[2:3] offset:3072
    ds_write_b64 v70, v[4:5] offset:5120
    ds_write_b64 v70, v[6:7] offset:7168
    ds_write_b64 v70, v[8:9] offset:11264
    ds_write_b64 v70, v[10:11] offset:15360
    v_add_u32 v28, 73728, v24
    v_add_u32 v29, 73728, v25
    v_add_u32 v30, 73728, v26
    v_add_u32 v31, 73728, v27
    ds_read_b64_tr_b16 v[32:33], v28 offset:0
    ds_read_b64_tr_b16 v[34:35], v28 offset:8
    ds_read_b64_tr_b16 v[36:37], v29 offset:0
    ds_read_b64_tr_b16 v[38:39], v29 offset:8
    ds_read_b64_tr_b16 a[6:7], v30 offset:0
    ds_read_b64_tr_b16 v[40:41], v30 offset:8
    ds_read_b64_tr_b16 a[14:15], v31 offset:0
    ds_read_b64_tr_b16 v[42:43], v31 offset:8
    s_waitcnt vmcnt(12) lgkmcnt(0)
    s_barrier
    s_add_u32 m0, s43, 73728
    s_add_u32 s41, s59, 0
    buffer_load_dwordx4 v17, s[8:11], s41 offen offset:0 nt lds
    s_add_u32 s41, s59, 31744
    buffer_load_dwordx4 v17, s[8:11], s41 offen offset:1024 nt lds
    s_add_u32 s41, s59, 129024
    buffer_load_dwordx4 v17, s[8:11], s41 offen offset:2048 nt lds
    s_add_u32 s41, s59, 160768
    buffer_load_dwordx4 v17, s[8:11], s41 offen offset:3072 nt lds
    ds_write_b64 v70, v[32:33] offset:1032
    ds_write_b64 v70, v[34:35] offset:3080
    ds_write_b64 v70, v[36:37] offset:5128
    ds_write_b64 v70, v[38:39] offset:7176
    ds_write_b64 v70, v[40:41] offset:11272
    ds_write_b64 v70, v[42:43] offset:15368
    v_add_u32 v28, 110592, v24
    v_add_u32 v29, 110592, v25
    v_add_u32 v30, 110592, v26
    v_add_u32 v31, 110592, v27
    ds_read_b64_tr_b16 a[16:17], v28 offset:0
    ds_read_b64_tr_b16 a[24:25], v28 offset:8
    ds_read_b64_tr_b16 a[32:33], v29 offset:0
    ds_read_b64_tr_b16 a[40:41], v29 offset:8
    ds_read_b64_tr_b16 a[48:49], v30 offset:0
    ds_read_b64_tr_b16 a[56:57], v30 offset:8
    ds_read_b64_tr_b16 a[64:65], v31 offset:0
    ds_read_b64_tr_b16 a[72:73], v31 offset:8
    s_waitcnt vmcnt(12) lgkmcnt(0)
    s_barrier
    s_mov_b64 s[8:9], s[54:55]
    s_add_u32 m0, s43, 110592
    s_add_u32 s41, s58, 0
    buffer_load_dwordx4 v17, s[8:11], s41 offen offset:0 nt lds
    s_add_u32 s41, s58, 31744
    buffer_load_dwordx4 v17, s[8:11], s41 offen offset:1024 nt lds
    s_add_u32 s41, s58, 129024
    buffer_load_dwordx4 v17, s[8:11], s41 offen offset:2048 nt lds
    s_add_u32 s41, s58, 160768
    buffer_load_dwordx4 v17, s[8:11], s41 offen offset:3072 nt lds
    v_add_u32 v28, 147456, v24
    v_add_u32 v29, 147456, v25
    v_add_u32 v30, 147456, v26
    v_add_u32 v31, 147456, v27
    ds_read_b64_tr_b16 a[18:19], v28 offset:0
    ds_read_b64_tr_b16 a[26:27], v28 offset:8
    ds_read_b64_tr_b16 a[34:35], v29 offset:0
    ds_read_b64_tr_b16 a[42:43], v29 offset:8
    ds_read_b64_tr_b16 a[50:51], v30 offset:0
    ds_read_b64_tr_b16 a[58:59], v30 offset:8
    ds_read_b64_tr_b16 a[66:67], v31 offset:0
    ds_read_b64_tr_b16 a[74:75], v31 offset:8
    s_waitcnt vmcnt(12) lgkmcnt(0)
    s_barrier
    s_add_u32 m0, s43, 147456
    s_add_u32 s41, s58, 16384
    buffer_load_dwordx4 v17, s[8:11], s41 offen offset:0 nt lds
    s_add_u32 s41, s58, 48128
    buffer_load_dwordx4 v17, s[8:11], s41 offen offset:1024 nt lds
    s_add_u32 s41, s58, 145408
    buffer_load_dwordx4 v17, s[8:11], s41 offen offset:2048 nt lds
    s_add_u32 s41, s58, 177152
    buffer_load_dwordx4 v17, s[8:11], s41 offen offset:3072 nt lds
    v_add_u32 v28, 0, v24
    v_add_u32 v29, 0, v25
    v_add_u32 v30, 0, v26
    v_add_u32 v31, 0, v27
    ds_read_b64_tr_b16 a[20:21], v28 offset:0
    ds_read_b64_tr_b16 a[28:29], v28 offset:8
    ds_read_b64_tr_b16 a[36:37], v29 offset:0
    ds_read_b64_tr_b16 a[44:45], v29 offset:8
    ds_read_b64_tr_b16 a[52:53], v30 offset:0
    ds_read_b64_tr_b16 a[60:61], v30 offset:8
    ds_read_b64_tr_b16 a[68:69], v31 offset:0
    ds_read_b64_tr_b16 a[76:77], v31 offset:8
    s_waitcnt vmcnt(12) lgkmcnt(0)
    s_barrier
    s_add_u32 m0, s43, 0
    s_add_u32 s41, s58, 262144
    buffer_load_dwordx4 v17, s[8:11], s41 offen offset:0 nt lds
    s_add_u32 s41, s58, 293888
    buffer_load_dwordx4 v17, s[8:11], s41 offen offset:1024 nt lds
    s_add_u32 s41, s58, 391168
    buffer_load_dwordx4 v17, s[8:11], s41 offen offset:2048 nt lds
    s_add_u32 s41, s58, 422912
    buffer_load_dwordx4 v17, s[8:11], s41 offen offset:3072 nt lds
    v_add_u32 v28, 36864, v24
    v_add_u32 v29, 36864, v25
    v_add_u32 v30, 36864, v26
    v_add_u32 v31, 36864, v27
    ds_read_b64_tr_b16 a[22:23], v28 offset:0
    ds_read_b64_tr_b16 a[30:31], v28 offset:8
    ds_read_b64_tr_b16 a[38:39], v29 offset:0
    ds_read_b64_tr_b16 a[46:47], v29 offset:8
    ds_read_b64_tr_b16 a[54:55], v30 offset:0
    ds_read_b64_tr_b16 a[62:63], v30 offset:8
    ds_read_b64_tr_b16 a[70:71], v31 offset:0
    ds_read_b64_tr_b16 a[78:79], v31 offset:8
    s_waitcnt vmcnt(12) lgkmcnt(0)
    s_barrier
    s_add_u32 m0, s43, 36864
    s_add_u32 s41, s58, 278528
    buffer_load_dwordx4 v17, s[8:11], s41 offen offset:0 nt lds
    s_add_u32 s41, s58, 310272
    buffer_load_dwordx4 v17, s[8:11], s41 offen offset:1024 nt lds
    s_add_u32 s41, s58, 407552
    buffer_load_dwordx4 v17, s[8:11], s41 offen offset:2048 nt lds
    s_add_u32 s41, s58, 439296
    buffer_load_dwordx4 v17, s[8:11], s41 offen offset:3072 nt lds
    v_add_u32 v77, 73728, v20
    ds_read_b64_tr_b16 a[80:81], v77 offset:0
    ds_read_b64_tr_b16 a[82:83], v77 offset:4096
    ds_read_b64_tr_b16 a[84:85], v77 offset:8192
    ds_read_b64_tr_b16 a[86:87], v77 offset:12288
    ds_read_b64_tr_b16 a[88:89], v77 offset:8
    ds_read_b64_tr_b16 a[90:91], v77 offset:4104
    ds_read_b64_tr_b16 a[92:93], v77 offset:8200
    ds_read_b64_tr_b16 a[94:95], v77 offset:12296
    s_waitcnt vmcnt(12) lgkmcnt(0)
    s_barrier
    s_add_u32 m0, s43, 73728
    s_add_u32 s41, s58, 524288
    buffer_load_dwordx4 v17, s[8:11], s41 offen offset:0 nt lds
    s_add_u32 s41, s58, 556032
    buffer_load_dwordx4 v17, s[8:11], s41 offen offset:1024 nt lds
    s_add_u32 s41, s58, 653312
    buffer_load_dwordx4 v17, s[8:11], s41 offen offset:2048 nt lds
    s_add_u32 s41, s58, 685056
    buffer_load_dwordx4 v17, s[8:11], s41 offen offset:3072 nt lds
    v_add_u32 v28, 110592, v24
    v_add_u32 v29, 110592, v25
    v_add_u32 v30, 110592, v26
    v_add_u32 v31, 110592, v27
    ds_read_b64_tr_b16 a[232:233], v28 offset:0
    ds_read_b64_tr_b16 v[32:33], v28 offset:8
    ds_read_b64_tr_b16 a[240:241], v29 offset:0
    ds_read_b64_tr_b16 a[248:249], v29 offset:8
    ds_read_b64_tr_b16 v[144:145], v30 offset:0
    ds_read_b64_tr_b16 v[152:153], v30 offset:8
    ds_read_b64_tr_b16 v[160:161], v31 offset:0
    ds_read_b64_tr_b16 v[168:169], v31 offset:8
    s_waitcnt vmcnt(12) lgkmcnt(0)
    s_barrier
    s_add_u32 m0, s43, 110592
    s_add_u32 s41, s58, 540672
    buffer_load_dwordx4 v17, s[8:11], s41 offen offset:0 nt lds
    s_add_u32 s41, s58, 572416
    buffer_load_dwordx4 v17, s[8:11], s41 offen offset:1024 nt lds
    s_add_u32 s41, s58, 669696
    buffer_load_dwordx4 v17, s[8:11], s41 offen offset:2048 nt lds
    s_add_u32 s41, s58, 701440
    buffer_load_dwordx4 v17, s[8:11], s41 offen offset:3072 nt lds
    ds_write_b64 v70, v[32:33] offset:8192
    v_add_u32 v28, 147456, v24
    v_add_u32 v29, 147456, v25
    v_add_u32 v30, 147456, v26
    v_add_u32 v31, 147456, v27
    ds_read_b64_tr_b16 a[234:235], v28 offset:0
    ds_read_b64_tr_b16 v[0:1], v28 offset:8
    ds_read_b64_tr_b16 a[242:243], v29 offset:0
    ds_read_b64_tr_b16 a[250:251], v29 offset:8
    ds_read_b64_tr_b16 v[146:147], v30 offset:0
    ds_read_b64_tr_b16 v[154:155], v30 offset:8
    ds_read_b64_tr_b16 v[162:163], v31 offset:0
    ds_read_b64_tr_b16 v[170:171], v31 offset:8
    s_waitcnt vmcnt(12) lgkmcnt(0)
    s_barrier
    s_add_u32 m0, s43, 147456
    s_add_u32 s41, s58, 786432
    buffer_load_dwordx4 v17, s[8:11], s41 offen offset:0 nt lds
    s_add_u32 s41, s58, 818176
    buffer_load_dwordx4 v17, s[8:11], s41 offen offset:1024 nt lds
    s_add_u32 s41, s58, 915456
    buffer_load_dwordx4 v17, s[8:11], s41 offen offset:2048 nt lds
    s_add_u32 s41, s58, 947200
    buffer_load_dwordx4 v17, s[8:11], s41 offen offset:3072 nt lds
    ds_write_b64 v70, v[0:1] offset:8200
    v_add_u32 v28, 0, v24
    v_add_u32 v29, 0, v25
    v_add_u32 v30, 0, v26
    v_add_u32 v31, 0, v27
    ds_read_b64_tr_b16 a[236:237], v28 offset:0
    ds_read_b64_tr_b16 v[32:33], v28 offset:8
    ds_read_b64_tr_b16 a[244:245], v29 offset:0
    ds_read_b64_tr_b16 a[252:253], v29 offset:8
    ds_read_b64_tr_b16 v[148:149], v30 offset:0
    ds_read_b64_tr_b16 v[156:157], v30 offset:8
    ds_read_b64_tr_b16 v[164:165], v31 offset:0
    ds_read_b64_tr_b16 v[172:173], v31 offset:8
    s_waitcnt vmcnt(12) lgkmcnt(0)
    s_barrier
    s_add_u32 m0, s43, 0
    s_add_u32 s41, s58, 802816
    buffer_load_dwordx4 v17, s[8:11], s41 offen offset:0 nt lds
    s_add_u32 s41, s58, 834560
    buffer_load_dwordx4 v17, s[8:11], s41 offen offset:1024 nt lds
    s_add_u32 s41, s58, 931840
    buffer_load_dwordx4 v17, s[8:11], s41 offen offset:2048 nt lds
    s_add_u32 s41, s58, 963584
    buffer_load_dwordx4 v17, s[8:11], s41 offen offset:3072 nt lds
    ds_write_b64 v70, v[32:33] offset:9216
    v_add_u32 v28, 36864, v24
    v_add_u32 v29, 36864, v25
    v_add_u32 v30, 36864, v26
    v_add_u32 v31, 36864, v27
    ds_read_b64_tr_b16 a[238:239], v28 offset:0
    ds_read_b64_tr_b16 v[0:1], v28 offset:8
    ds_read_b64_tr_b16 a[246:247], v29 offset:0
    ds_read_b64_tr_b16 a[254:255], v29 offset:8
    ds_read_b64_tr_b16 v[150:151], v30 offset:0
    ds_read_b64_tr_b16 v[158:159], v30 offset:8
    ds_read_b64_tr_b16 v[166:167], v31 offset:0
    ds_read_b64_tr_b16 v[174:175], v31 offset:8
    s_waitcnt vmcnt(12) lgkmcnt(0)
    s_barrier
    s_add_u32 m0, s43, 36864
    s_add_u32 s41, s59, 0
    buffer_load_dwordx4 v17, s[8:11], s41 offen offset:0 nt lds
    s_add_u32 s41, s59, 31744
    buffer_load_dwordx4 v17, s[8:11], s41 offen offset:1024 nt lds
    s_add_u32 s41, s59, 129024
    buffer_load_dwordx4 v17, s[8:11], s41 offen offset:2048 nt lds
    s_add_u32 s41, s59, 160768
    buffer_load_dwordx4 v17, s[8:11], s41 offen offset:3072 nt lds
    ds_write_b64 v70, v[0:1] offset:9224
    v_add_u32 v28, 73728, v24
    v_add_u32 v29, 73728, v25
    v_add_u32 v30, 73728, v26
    v_add_u32 v31, 73728, v27
    ds_read_b64_tr_b16 v[176:177], v28 offset:0
    ds_read_b64_tr_b16 v[184:185], v28 offset:8
    ds_read_b64_tr_b16 v[192:193], v29 offset:0
    ds_read_b64_tr_b16 v[200:201], v29 offset:8
    ds_read_b64_tr_b16 v[208:209], v30 offset:0
    ds_read_b64_tr_b16 v[216:217], v30 offset:8
    ds_read_b64_tr_b16 v[224:225], v31 offset:0
    ds_read_b64_tr_b16 v[232:233], v31 offset:8
    s_waitcnt vmcnt(12) lgkmcnt(0)
    s_barrier
    s_mov_b64 s[8:9], s[56:57]
    s_add_u32 m0, s43, 73728
    s_add_u32 s41, s60, 128
    buffer_load_dwordx4 v18, s[8:11], s41 offen offset:0 nt lds
    s_add_u32 s41, s60, 8320
    buffer_load_dwordx4 v18, s[8:11], s41 offen offset:1024 nt lds
    s_add_u32 s41, s60, 16512
    buffer_load_dwordx4 v18, s[8:11], s41 offen offset:2048 nt lds
    s_add_u32 s41, s60, 24704
    buffer_load_dwordx4 v18, s[8:11], s41 offen offset:3072 nt lds
    v_add_u32 v28, 110592, v24
    v_add_u32 v29, 110592, v25
    v_add_u32 v30, 110592, v26
    v_add_u32 v31, 110592, v27
    ds_read_b64_tr_b16 v[178:179], v28 offset:0
    ds_read_b64_tr_b16 v[186:187], v28 offset:8
    ds_read_b64_tr_b16 v[194:195], v29 offset:0
    ds_read_b64_tr_b16 v[202:203], v29 offset:8
    ds_read_b64_tr_b16 v[210:211], v30 offset:0
    ds_read_b64_tr_b16 v[218:219], v30 offset:8
    ds_read_b64_tr_b16 v[226:227], v31 offset:0
    ds_read_b64_tr_b16 v[234:235], v31 offset:8
    s_waitcnt vmcnt(12) lgkmcnt(0)
    s_barrier
    s_add_u32 m0, s43, 110592
    s_add_u32 s41, s61, 128
    buffer_load_dwordx4 v18, s[8:11], s41 offen offset:0 nt lds
    s_add_u32 s41, s61, 8320
    buffer_load_dwordx4 v18, s[8:11], s41 offen offset:1024 nt lds
    s_add_u32 s41, s61, 16512
    buffer_load_dwordx4 v18, s[8:11], s41 offen offset:2048 nt lds
    s_add_u32 s41, s61, 24704
    buffer_load_dwordx4 v18, s[8:11], s41 offen offset:3072 nt lds
    v_add_u32 v28, 147456, v24
    v_add_u32 v29, 147456, v25
    v_add_u32 v30, 147456, v26
    v_add_u32 v31, 147456, v27
    ds_read_b64_tr_b16 v[180:181], v28 offset:0
    ds_read_b64_tr_b16 v[188:189], v28 offset:8
    ds_read_b64_tr_b16 v[196:197], v29 offset:0
    ds_read_b64_tr_b16 v[204:205], v29 offset:8
    ds_read_b64_tr_b16 v[212:213], v30 offset:0
    ds_read_b64_tr_b16 v[220:221], v30 offset:8
    ds_read_b64_tr_b16 v[228:229], v31 offset:0
    ds_read_b64_tr_b16 v[236:237], v31 offset:8
    s_waitcnt vmcnt(12) lgkmcnt(0)
    s_barrier
    s_add_u32 m0, s43, 147456
    s_add_u32 s41, s62, 128
    buffer_load_dwordx4 v18, s[8:11], s41 offen offset:0 nt lds
    s_add_u32 s41, s62, 8320
    buffer_load_dwordx4 v18, s[8:11], s41 offen offset:1024 nt lds
    s_add_u32 s41, s62, 16512
    buffer_load_dwordx4 v18, s[8:11], s41 offen offset:2048 nt lds
    s_add_u32 s41, s62, 24704
    buffer_load_dwordx4 v18, s[8:11], s41 offen offset:3072 nt lds
    v_add_u32 v28, 0, v24
    v_add_u32 v29, 0, v25
    v_add_u32 v30, 0, v26
    v_add_u32 v31, 0, v27
    ds_read_b64_tr_b16 v[182:183], v28 offset:0
    ds_read_b64_tr_b16 v[190:191], v28 offset:8
    ds_read_b64_tr_b16 v[198:199], v29 offset:0
    ds_read_b64_tr_b16 v[206:207], v29 offset:8
    ds_read_b64_tr_b16 v[214:215], v30 offset:0
    ds_read_b64_tr_b16 v[222:223], v30 offset:8
    ds_read_b64_tr_b16 v[230:231], v31 offset:0
    ds_read_b64_tr_b16 v[238:239], v31 offset:8
    s_waitcnt vmcnt(12) lgkmcnt(0)
    s_barrier
    s_add_u32 m0, s43, 0
    s_add_u32 s41, s63, 128
    buffer_load_dwordx4 v18, s[8:11], s41 offen offset:0 nt lds
    s_add_u32 s41, s63, 8320
    buffer_load_dwordx4 v18, s[8:11], s41 offen offset:1024 nt lds
    s_add_u32 s41, s63, 16512
    buffer_load_dwordx4 v18, s[8:11], s41 offen offset:2048 nt lds
    s_add_u32 s41, s63, 24704
    buffer_load_dwordx4 v18, s[8:11], s41 offen offset:3072 nt lds
    v_mov_b32 v78, v21
    v_mov_b32 v79, v22
    v_add_u32 v77, 36864, v20
    ds_read_b64_tr_b16 v[240:241], v77 offset:0
    ds_read_b64_tr_b16 v[242:243], v77 offset:4096
    ds_read_b64_tr_b16 v[244:245], v77 offset:8192
    ds_read_b64_tr_b16 v[246:247], v77 offset:12288
    ds_read_b64_tr_b16 v[248:249], v77 offset:8
    ds_read_b64_tr_b16 v[250:251], v77 offset:4104
    ds_read_b64_tr_b16 v[252:253], v77 offset:8200
    ds_read_b64_tr_b16 v[254:255], v77 offset:12296
    s_waitcnt vmcnt(12) lgkmcnt(0)
    s_barrier
    v_add_u32 v77, 73728, v79
    s_waitcnt lgkmcnt(0)
    ds_read_b64_tr_b16 v[0:1], v77 offset:0
    ds_read_b64_tr_b16 v[2:3], v77 offset:256
    ds_read_b64_tr_b16 v[4:5], v77 offset:2048
    ds_read_b64_tr_b16 v[6:7], v77 offset:2304
    ds_read_b64_tr_b16 v[8:9], v77 offset:16
    ds_read_b64_tr_b16 v[10:11], v77 offset:272
    ds_read_b64_tr_b16 v[12:13], v77 offset:2064
    ds_read_b64_tr_b16 v[14:15], v77 offset:2320
    s_waitcnt vmcnt(8) lgkmcnt(0)
    s_barrier
    v_add_u32 v77, 110592, v78
    ds_read_b64_tr_b16 v[16:17], v77 offset:0
    ds_read_b64_tr_b16 v[18:19], v77 offset:256
    ds_read_b64_tr_b16 v[20:21], v77 offset:2048
    ds_read_b64_tr_b16 v[22:23], v77 offset:2304
    ds_read_b64_tr_b16 v[24:25], v77 offset:16
    ds_read_b64_tr_b16 v[26:27], v77 offset:272
    ds_read_b64_tr_b16 v[28:29], v77 offset:2064
    ds_read_b64_tr_b16 v[30:31], v77 offset:2320
    s_waitcnt vmcnt(4) lgkmcnt(0)
    s_barrier
    v_add_u32 v77, 147456, v78
    ds_read_b64_tr_b16 v[32:33], v77 offset:0
    ds_read_b64_tr_b16 v[34:35], v77 offset:256
    ds_read_b64_tr_b16 v[36:37], v77 offset:2048
    ds_read_b64_tr_b16 v[38:39], v77 offset:2304
    ds_read_b64_tr_b16 v[40:41], v77 offset:16
    ds_read_b64_tr_b16 v[42:43], v77 offset:272
    ds_read_b64_tr_b16 v[44:45], v77 offset:2064
    ds_read_b64_tr_b16 v[46:47], v77 offset:2320
    s_waitcnt vmcnt(0) lgkmcnt(0)
    s_barrier
    v_add_u32 v77, 0, v78
    ds_read_b64_tr_b16 v[48:49], v77 offset:0
    ds_read_b64_tr_b16 v[50:51], v77 offset:256
    ds_read_b64_tr_b16 v[52:53], v77 offset:2048
    ds_read_b64_tr_b16 v[54:55], v77 offset:2304
    ds_read_b64_tr_b16 v[56:57], v77 offset:16
    ds_read_b64_tr_b16 v[58:59], v77 offset:272
    ds_read_b64_tr_b16 v[60:61], v77 offset:2064
    ds_read_b64_tr_b16 v[62:63], v77 offset:2320
    s_waitcnt lgkmcnt(0)
    s_barrier
    ds_write_b128 v70, v[0:3] offset:20480
    ds_write_b128 v70, v[4:7] offset:21504
    ds_write_b128 v70, v[8:11] offset:22528
    ds_write_b128 v70, v[12:15] offset:23552
    ds_write_b128 v70, v[16:19] offset:24576
    ds_write_b128 v70, v[20:23] offset:25600
    ds_write_b128 v70, v[24:27] offset:26624
    ds_write_b128 v70, v[28:31] offset:27648
    ds_write_b128 v70, v[32:35] offset:28672
    ds_write_b128 v70, v[36:39] offset:29696
    ds_write_b128 v70, v[40:43] offset:30720
    ds_write_b128 v70, v[44:47] offset:31744
    ds_write_b128 v70, v[48:51] offset:32768
    ds_write_b128 v70, v[52:55] offset:33792
    ds_write_b128 v70, v[56:59] offset:34816
    ds_write_b128 v70, v[60:63] offset:35840
    s_waitcnt lgkmcnt(0)
    v_bfe_u32 v60, v65, 4, 6
    v_and_b32 v61, 15, v60
    v_lshrrev_b32 v62, 4, v60
    v_mov_b32 v50, 0x3f80
    v_mov_b32 v51, 0x3f800000
    v_and_b32 v77, 1, v62
    v_lshlrev_b32 v77, 2, v77
    v_sub_u32 v77, v61, v77
    v_and_b32 v78, 3, v61
    v_lshlrev_b32 v78, 2, v78
    v_lshrrev_b32 v79, 2, v61
    v_add_u32 v78, v78, v79
    v_cmp_eq_u32 vcc, 0, v77
    s_nop 1
    v_cndmask_b32 v8, 0, v50, vcc
    v_cmp_eq_u32 vcc, 1, v77
    s_nop 1
    v_cndmask_b32 v8, v8, v51, vcc
    v_cmp_eq_u32 vcc, 0, v78
    s_nop 1
    v_cndmask_b32 v12, 0, v50, vcc
    v_cmp_eq_u32 vcc, 1, v78
    s_nop 1
    v_cndmask_b32 v12, v12, v51, vcc
    v_cmp_eq_u32 vcc, 2, v77
    s_nop 1
    v_cndmask_b32 v9, 0, v50, vcc
    v_cmp_eq_u32 vcc, 3, v77
    s_nop 1
    v_cndmask_b32 v9, v9, v51, vcc
    v_cmp_eq_u32 vcc, 2, v78
    s_nop 1
    v_cndmask_b32 v13, 0, v50, vcc
    v_cmp_eq_u32 vcc, 3, v78
    s_nop 1
    v_cndmask_b32 v13, v13, v51, vcc
    v_cmp_eq_u32 vcc, 8, v77
    s_nop 1
    v_cndmask_b32 v10, 0, v50, vcc
    v_cmp_eq_u32 vcc, 9, v77
    s_nop 1
    v_cndmask_b32 v10, v10, v51, vcc
    v_cmp_eq_u32 vcc, 4, v78
    s_nop 1
    v_cndmask_b32 v14, 0, v50, vcc
    v_cmp_eq_u32 vcc, 5, v78
    s_nop 1
    v_cndmask_b32 v14, v14, v51, vcc
    v_cmp_eq_u32 vcc, 10, v77
    s_nop 1
    v_cndmask_b32 v11, 0, v50, vcc
    v_cmp_eq_u32 vcc, 11, v77
    s_nop 1
    v_cndmask_b32 v11, v11, v51, vcc
    v_cmp_eq_u32 vcc, 6, v78
    s_nop 1
    v_cndmask_b32 v15, 0, v50, vcc
    v_cmp_eq_u32 vcc, 7, v78
    s_nop 1
    v_cndmask_b32 v15, v15, v51, vcc
    v_lshlrev_b32 v77, 4, v61
    ds_write_b128 v69, v[8:11] offset:15360
    ds_write_b128 v77, v[12:15] offset:15872
    s_waitcnt vmcnt(0) lgkmcnt(0)
    s_barrier
    v_mov_b32 v2, 1
    s_cmp_lg_u32 s13, 0
    s_cbranch_scc1 cs_noarr
    s_mov_b64 exec, 1
    buffer_atomic_add v2, off, s[84:87], 0 offset:212
    s_mov_b32 s40, 16777216
    s_mov_b32 s42, 2
cs_startpoll:
    buffer_load_dword v3, off, s[84:87], 0 offset:212 sc1
    s_sub_u32 s40, s40, 1
    s_cbranch_scc1 cs_decide
    s_waitcnt vmcnt(0)
    v_readfirstlane_b32 s41, v3
    s_nop 1
    s_cmp_lt_u32 s41, 32
    s_cbranch_scc1 cs_startpoll
    s_mov_b32 s42, 1
cs_decide:
    s_mov_b64 exec, -1
cs_noarr:
    s_barrier
    s_mov_b32 s44, 0x3e0293ee
    s_mov_b32 s45, s44
    s_or_b32 s66, s44, 0x80000000
    s_mov_b32 s48, 0x3f003f00
    s_mov_b32 s49, 0
    s_mov_b32 s50, 0x3f803f80
    s_mov_b32 s51, 0x3f803f80
    s_mov_b32 s52, 512
    s_mov_b32 s53, 1024
    s_mov_b32 s54, 1536
    s_mov_b32 s30, 0
    s_mov_b32 s37, 0
    s_mov_b32 s98, -100
    s_lshl_b32 s47, s13, 9
    s_cmp_lg_u32 s32, 0
    s_cselect_b32 s71, s13, 3
    s_add_u32 s46, s71, 1
    s_lshr_b32 s46, s46, 1
    s_mov_b32 s14, 67649536
    s_mov_b32 s15, 67653632
    s_mov_b32 s16, 67657728
    s_mov_b32 s36, 0
    s_add_u32 s17, s68, 67633152
    s_mov_b32 s69, 0
    s_mov_b32 s70, 0
    s_lshl_b32 s26, s12, 14
    s_add_u32 s26, s26, 0
    s_mul_i32 s40, s13, 3072
    s_add_u32 s24, s26, s40
    s_add_u32 s26, s24, s33
    s_add_u32 s99, s26, 33030144
    s_lshl_b32 s96, s12, 7
    s_add_u32 s29, s96, 125845504
    s_add_u32 s96, s96, 125829120
    s_lshl_b32 s40, s12, 14
    s_add_u32 s40, s40, 68681728
    s_add_u32 s18, s40, 0
    s_add_u32 s19, s40, 4096
    s_add_u32 s20, s40, 8192
    s_add_u32 s21, s40, 12288
    s_lshr_b32 s40, s12, 3
    s_lshl_b32 s40, s40, 12
    s_and_b32 s41, s12, 7
    s_lshl_b32 s41, s41, 7
    s_add_u32 s40, s40, s41
    s_add_u32 s22, s40, 68681728
    s_add_u32 s23, s22, 1024
    s_add_u32 s25, s22, 2048
    s_mov_b32 s56, -65472
    s_cmp_lg_u32 s32, 0
    s_cselect_b64 s[38:39], -1, 0
    s_add_u32 s55, s68, 138412032
    s_cmp_eq_u32 s13, 3
    s_cselect_b64 s[100:101], 1, 0
    s_cselect_b64 s[38:39], 1, s[38:39]
    s_cselect_b32 s93, 64, 0
    s_cselect_b32 s55, s29, s55
    s_cselect_b32 s57, 0, 9216
    s_mov_b64 exec, s[100:101]
    v_mov_b32 v72, s95
    s_mov_b64 exec, -1
    s_mov_b32 s34, 0xff00ff00
    s_mov_b32 s35, 0xff00ff00
    s_lshl_b32 s28, s12, 12
    s_add_u32 s28, s28, 7340032
    s_add_u32 s27, s28, 77594624
    s_add_u32 s28, s28, 69206016
    s_mov_b32 s40, 3
    v_bfe_u32 v78, v65, 2, 5
    s_mov_b32 s31, 4194304
cs_kv0:
    buffer_load_dword v77, v78, s[4:7], s96 offen offset:16 sc1
    s_waitcnt vmcnt(0)
    v_subrev_u32 v77, s95, v77
    v_cmp_lt_u32 vcc, 16, v77
    s_nop 1
    v_cndmask_b32 v77, v77, 0, vcc
    v_bfe_u32 v79, v78, 2, 2
    v_lshl_add_u32 v77, v77, 2, v79
    s_nop 1
    v_min_u32_dpp v77, v77, v77 row_ror:1 row_mask:0xf bank_mask:0xf
    s_nop 1
    v_min_u32_dpp v77, v77, v77 row_ror:2 row_mask:0xf bank_mask:0xf
    s_nop 1
    v_min_u32_dpp v77, v77, v77 row_ror:4 row_mask:0xf bank_mask:0xf
    s_nop 0
    v_readfirstlane_b32 s97, v77
    s_sub_u32 s31, s31, 1
    s_cbranch_scc1 cs_kv0_x
    s_cmp_le_u32 s40, s97
    s_cbranch_scc1 cs_kv0_x
    s_sleep 2
    s_branch cs_kv0
cs_kv0_x:
    s_add_u32 s40, s26, 0
    s_min_u32 s40, s40, s99
    s_sub_u32 s41, s96, s40
    v_bfe_u32 v77, v65, 2, 5
    v_add3_u32 v77, v77, s41, 16
    v_lshlrev_b32 v78, 3, v69
    s_nop 0
    v_mov_b32_dpp v78, v77 quad_perm:[0,1,2,3] row_mask:0xc bank_mask:0xf
    buffer_load_dword v76, v78, s[4:7], s40 offen sc1
    s_add_u32 s40, s26, 524288
    s_min_u32 s40, s40, s99
    s_sub_u32 s41, s96, s40
    v_bfe_u32 v77, v65, 2, 5
    v_add3_u32 v77, v77, s41, 16
    v_lshlrev_b32 v78, 3, v69
    s_nop 0
    v_mov_b32_dpp v78, v77 quad_perm:[0,1,2,3] row_mask:0xc bank_mask:0xf
    buffer_load_dword v76, v78, s[4:7], s40 offen sc1
cs_kvdone:
    v_mov_b64 v[0:1], 0
    v_mov_b64 v[2:3], 0
    v_mov_b64 v[4:5], 0
    v_mov_b64 v[6:7], 0
    v_mov_b64 v[8:9], 0
    v_mov_b64 v[10:11], 0
    v_mov_b64 v[12:13], 0
    v_mov_b64 v[14:15], 0
    v_mov_b64 v[16:17], 0
    v_mov_b64 v[18:19], 0
    v_mov_b64 v[20:21], 0
    v_mov_b64 v[22:23], 0
    ds_read_b128 v[44:47], v70 offset:0
    ds_read_b128 v[48:51], v70 offset:1024
    ds_read_b128 v[52:55], v70 offset:2048
    ds_read_b128 v[56:59], v70 offset:3072
    ds_read_b128 v[24:27], v70 offset:4096
    ds_read_b128 v[28:31], v70 offset:5120
    ds_read_b128 v[32:35], v70 offset:6144
    ds_read_b128 v[36:39], v70 offset:7168
    buffer_load_dwordx4 v[40:43], v65, s[4:7], s14 offen offset:0 sc1
    buffer_load_dwordx4 v[60:63], v66, s[4:7], s14 offen offset:0 sc1
    s_mov_b32 s31, 1048576
    s_waitcnt vmcnt(0) lgkmcnt(0)
    s_branch cs_goA
cs_loop:
    s_mov_b32 s31, 1048576
    s_mov_b32 s69, s70
    s_waitcnt lgkmcnt(0)
cs_cA:
    buffer_load_dwordx4 v[40:43], v65, s[4:7], s14 offen offset:0 sc1
    buffer_load_dwordx4 v[60:63], v66, s[4:7], s14 offen offset:0 sc1
cs_cA1:
    v_bitop3_b32 v77, v40, v60, s70 bitop3:0x7e
    v_and_b32 v77, 1, v77
    v_cmp_ne_u32 vcc, 0, v77
    s_cbranch_vccz cs_goA
    s_nop 15
    s_nop 15
    s_nop 7
    v_bitop3_b32 v77, v40, v60, s70 bitop3:0x7e
    v_and_b32 v77, 1, v77
    v_cmp_ne_u32 vcc, 0, v77
    s_cbranch_vccz cs_goA
    s_nop 15
    s_nop 15
    s_nop 7
    v_bitop3_b32 v77, v40, v60, s70 bitop3:0x7e
    v_and_b32 v77, 1, v77
    v_cmp_ne_u32 vcc, 0, v77
    s_cbranch_vccz cs_goA
    s_nop 15
    s_nop 15
    s_nop 7
    v_bitop3_b32 v77, v40, v60, s70 bitop3:0x7e
    v_and_b32 v77, 1, v77
    v_cmp_ne_u32 vcc, 0, v77
    s_cbranch_vccz cs_goA
    s_nop 15
    s_nop 15
    s_nop 7
    buffer_load_dwordx4 v[40:43], v65, s[4:7], s14 offen offset:0 sc1
    buffer_load_dwordx4 v[60:63], v66, s[4:7], s14 offen offset:0 sc1
    v_bitop3_b32 v77, v40, v60, s70 bitop3:0x7e
    v_and_b32 v77, 1, v77
    v_cmp_ne_u32 vcc, 0, v77
    s_cbranch_vccz cs_goA
    s_nop 15
    s_nop 15
    s_nop 7
    v_bitop3_b32 v77, v40, v60, s70 bitop3:0x7e
    v_and_b32 v77, 1, v77
    v_cmp_ne_u32 vcc, 0, v77
    s_cbranch_vccz cs_goA
    s_nop 15
    s_nop 15
    s_nop 7
    v_bitop3_b32 v77, v40, v60, s70 bitop3:0x7e
    v_and_b32 v77, 1, v77
    v_cmp_ne_u32 vcc, 0, v77
    s_cbranch_vccz cs_goA
    s_nop 15
    s_nop 15
    s_nop 7
    v_bitop3_b32 v77, v40, v60, s70 bitop3:0x7e
    v_and_b32 v77, 1, v77
    v_cmp_ne_u32 vcc, 0, v77
    s_cbranch_vccz cs_goA
    s_nop 15
    s_nop 15
    s_nop 7
    buffer_load_dwordx4 v[40:43], v65, s[4:7], s14 offen offset:0 sc1
    buffer_load_dwordx4 v[60:63], v66, s[4:7], s14 offen offset:0 sc1
    v_bitop3_b32 v77, v40, v60, s70 bitop3:0x7e
    v_and_b32 v77, 1, v77
    v_cmp_ne_u32 vcc, 0, v77
    s_cbranch_vccz cs_goA
    s_nop 15
    s_nop 15
    s_nop 7
    v_bitop3_b32 v77, v40, v60, s70 bitop3:0x7e
    v_and_b32 v77, 1, v77
    v_cmp_ne_u32 vcc, 0, v77
    s_cbranch_vccz cs_goA
    s_nop 15
    s_nop 15
    s_nop 7
    v_bitop3_b32 v77, v40, v60, s70 bitop3:0x7e
    v_and_b32 v77, 1, v77
    v_cmp_ne_u32 vcc, 0, v77
    s_cbranch_vccz cs_goA
    s_nop 15
    s_nop 15
    s_nop 7
    v_bitop3_b32 v77, v40, v60, s70 bitop3:0x7e
    v_and_b32 v77, 1, v77
    v_cmp_ne_u32 vcc, 0, v77
    s_cbranch_vccz cs_goA
    s_nop 15
    s_nop 15
    s_nop 7
    buffer_load_dwordx4 v[40:43], v65, s[4:7], s14 offen offset:0 sc1
    buffer_load_dwordx4 v[60:63], v66, s[4:7], s14 offen offset:0 sc1
    v_bitop3_b32 v77, v40, v60, s70 bitop3:0x7e
    v_and_b32 v77, 1, v77
    v_cmp_ne_u32 vcc, 0, v77
    s_cbranch_vccz cs_goA
    s_nop 15
    s_nop 15
    s_nop 7
    v_bitop3_b32 v77, v40, v60, s70 bitop3:0x7e
    v_and_b32 v77, 1, v77
    v_cmp_ne_u32 vcc, 0, v77
    s_cbranch_vccz cs_goA
    s_nop 15
    s_nop 15
    s_nop 7
    v_bitop3_b32 v77, v40, v60, s70 bitop3:0x7e
    v_and_b32 v77, 1, v77
    v_cmp_ne_u32 vcc, 0, v77
    s_cbranch_vccz cs_goA
    s_nop 15
    s_nop 15
    s_nop 7
    v_bitop3_b32 v77, v40, v60, s70 bitop3:0x7e
    v_and_b32 v77, 1, v77
    v_cmp_ne_u32 vcc, 0, v77
    s_cbranch_vccz cs_goA
    s_nop 15
    s_nop 15
    s_nop 7
    s_sub_u32 s31, s31, 64
    s_cbranch_scc0 cs_cA
cs_goA:
    ds_write_b128 v65, v[40:43] offset:0
    v_smfmac_f32_16x16x64_bf16 v[0:3], v[40:43], v[44:51], v64
    v_smfmac_f32_16x16x64_bf16 v[4:7], v[40:43], v[52:59], v64
    buffer_load_dwordx4 v[44:47], v65, s[4:7], s15 offen offset:0 sc1
    v_smfmac_f32_16x16x64_bf16 v[0:3], v[60:63], v[24:31], v64
    s_add_u32 s40, s26, 1048576
    s_min_u32 s40, s40, s99
    s_sub_u32 s41, s96, s40
    v_smfmac_f32_16x16x64_bf16 v[4:7], v[60:63], v[32:39], v64
    ds_read_b128 v[24:27], v70 offset:8192
    s_cmp_lt_u32 s97, s93
    s_cselect_b32 s41, s41, 0
    v_smfmac_f32_16x16x64_bf16 v[8:11], v[40:43], a[96:103], v64
    ds_read_b128 v[28:31], v70 offset:9216
    v_smfmac_f32_16x16x64_bf16 v[12:15], v[40:43], a[104:111], v64
    ds_read_b128 v[32:35], v70 offset:10240
    s_waitcnt lgkmcnt(3)
    s_barrier
    ds_read_b128 v[48:51], v67 offset:0
    v_smfmac_f32_16x16x64_bf16 v[8:11], v[60:63], a[112:119], v64
    ds_read_b128 v[36:39], v70 offset:11264
    v_bitop3_b32 v79, v73, -9, s54 bitop3:0x6a
    v_smfmac_f32_16x16x64_bf16 v[12:15], v[60:63], a[120:127], v64
    buffer_load_dwordx4 v[44:47], v65, s[4:7], s15 offen offset:0 sc1
    v_smfmac_f32_16x16x64_bf16 v[16:19], v[40:43], a[232:239], v64
    ds_read_b128 v[52:55], v68 offset:0
    s_waitcnt lgkmcnt(4)
    v_bfe_u32 v77, v65, 2, 5
    v_smfmac_f32_16x16x64_bf16 v[20:23], v[40:43], v[24:31], v64
    ds_read_b128 v[24:27], v70 offset:12288
    s_waitcnt lgkmcnt(3)
    v_smfmac_f32_16x16x64_bf16 v[0:3], v[48:51], a[0:7], v64
    ds_read_b128 v[28:31], v70 offset:13312
    s_waitcnt lgkmcnt(3)
    v_add3_u32 v77, v77, s41, 16
    v_smfmac_f32_16x16x64_bf16 v[4:7], v[48:51], v[32:39], v64
    buffer_load_dwordx4 v[40:43], v65, s[4:7], s16 offen offset:0 sc1
    v_smfmac_f32_16x16x64_bf16 v[16:19], v[60:63], a[240:247], v64
    ds_read_b128 v[32:35], v70 offset:14336
    v_lshlrev_b32 v78, 3, v69
    v_smfmac_f32_16x16x64_bf16 v[20:23], v[60:63], a[248:255], v64
    ds_read_b128 v[36:39], v70 offset:15360
    v_smfmac_f32_16x16x64_bf16 v[8:11], v[48:51], a[128:135], v64
    s_waitcnt vmcnt(2)
    v_mov_b32_dpp v78, v77 quad_perm:[0,1,2,3] row_mask:0xc bank_mask:0xf
    v_smfmac_f32_16x16x64_bf16 v[12:15], v[48:51], a[136:143], v64
    buffer_load_dwordx4 v[58:61], v65, s[4:7], s24 offen offset:3072 sc1
    s_waitcnt lgkmcnt(2)
    v_and_b32 v77, s36, v44
    v_smfmac_f32_16x16x64_bf16 v[12:15], v[52:55], v[24:31], v64
    ds_write_b128 v65, v[44:47] offset:4096
    v_smfmac_f32_16x16x64_bf16 v[0:3], v[52:55], a[8:15], v64
    v_cmp_ne_u32 vcc, s70, v77
    v_smfmac_f32_16x16x64_bf16 v[8:11], v[52:55], a[144:151], v64
    buffer_load_dwordx4 v[24:27], v65, s[4:7], s24 offen offset:0 sc1
    s_waitcnt lgkmcnt(1)
    v_smfmac_f32_16x16x64_bf16 v[4:7], v[52:55], v[32:39], v64
    s_cbranch_vccnz cs_spinB
cs_backB:
    v_smfmac_f32_16x16x64_bf16 v[16:19], v[44:47], v[176:183], v64
    s_waitcnt lgkmcnt(0)
    s_barrier
    ds_read_b128 v[48:51], v66 offset:4096
    v_smfmac_f32_16x16x64_bf16 v[12:15], v[44:47], a[160:167], v64
    buffer_load_dwordx4 v[28:31], v65, s[4:7], s24 offen offset:1024 sc1
    v_smfmac_f32_16x16x64_bf16 v[0:3], v[44:47], a[16:23], v64
    ds_read_b128 v[52:55], v67 offset:4096
    v_smfmac_f32_16x16x64_bf16 v[8:11], v[44:47], a[152:159], v64
    v_smfmac_f32_16x16x64_bf16 v[4:7], v[44:47], a[24:31], v64
    buffer_load_dwordx4 v[34:37], v65, s[4:7], s24 offen offset:2048 sc1
    s_waitcnt vmcnt(5)
    v_smfmac_f32_16x16x64_bf16 v[20:23], v[44:47], v[184:191], v64
    ds_read_b128 v[44:47], v68 offset:4096
    s_waitcnt lgkmcnt(2)
    v_smfmac_f32_16x16x64_bf16 v[0:3], v[48:51], a[32:39], v64
    v_smfmac_f32_16x16x64_bf16 v[8:11], v[48:51], a[168:175], v64
    buffer_load_dword v76, v78, s[4:7], s40 offen sc1
    v_smfmac_f32_16x16x64_bf16 v[4:7], v[48:51], a[40:47], v64
    s_waitcnt vmcnt(5)
    v_and_b32 v77, s36, v40
    v_smfmac_f32_16x16x64_bf16 v[12:15], v[48:51], a[176:183], v64
    ds_read_b128 v[48:51], v69 offset:15360
    s_waitcnt lgkmcnt(1)
    v_cmp_ne_u32 vcc, s70, v77
    v_smfmac_f32_16x16x64_bf16 v[0:3], v[52:55], a[48:55], v64
    v_smfmac_f32_16x16x64_bf16 v[8:11], v[52:55], a[184:191], v64
    s_cbranch_vccnz cs_spin8
cs_back8:
    v_smfmac_f32_16x16x64_bf16 v[0:3], v[44:47], a[64:71], v64
    v_smfmac_f32_16x16x64_bf16 v[8:11], v[44:47], a[200:207], v64
    v_smfmac_f32_16x16x64_bf16 v[0:3], v[40:43], a[80:87], v64
    s_nop 1
    v_smfmac_f32_16x16x64_bf16 v[8:11], v[40:43], a[216:223], v64
    s_nop 1
    v_lshrrev_b32 v77, 1, v69
    v_smfmac_f32_16x16x64_bf16 v[4:7], v[52:55], a[56:63], v64
    s_nop 1
    v_cvt_pk_bf16_f32 v0, v0, v1
    v_smfmac_f32_16x16x64_bf16 v[12:15], v[52:55], a[192:199], v64
    s_nop 1
    v_cvt_pk_bf16_f32 v1, v2, v3
    v_smfmac_f32_16x16x64_bf16 v[4:7], v[44:47], a[72:79], v64
    s_nop 1
    v_cvt_pk_bf16_f32 v2, v8, v9
    v_smfmac_f32_16x16x64_bf16 v[12:15], v[44:47], a[208:215], v64
    s_nop 1
    v_cvt_pk_bf16_f32 v3, v10, v11
    v_smfmac_f32_16x16x64_bf16 v[4:7], v[40:43], a[88:95], v64
    s_waitcnt lgkmcnt(0)
    s_nop 0
    s_nop 0
    v_smfmac_f32_16x16x64_bf16 v[12:15], v[40:43], a[224:231], v64
    s_nop 2
    v_mfma_f32_16x16x32_bf16 v[8:11], v[0:3], v[48:51], 0
    s_nop 0
    v_cvt_pk_bf16_f32 v4, v4, v5
    v_cvt_pk_bf16_f32 v5, v6, v7
    s_nop 0
    v_cvt_pk_bf16_f32 v6, v12, v13
    v_cvt_pk_bf16_f32 v7, v14, v15
    s_nop 1
    v_mfma_f32_16x16x32_bf16 v[12:15], v[4:7], v[48:51], 0
    ds_read_b128 v[48:51], v66 offset:4096
    v_cvt_pk_bf16_f32 v0, v8, v9
    v_cvt_pk_bf16_f32 v1, v10, v11
    v_smfmac_f32_16x16x64_bf16 v[16:19], v[52:55], v[208:215], v64
    s_waitcnt vmcnt(2)
    s_nop 2
    v_cvt_pk_bf16_f32 v2, v12, v13
    v_cvt_pk_bf16_f32 v3, v14, v15
    s_nop 1
    v_mfma_f32_16x16x32_bf16 v[12:15], v[0:3], v[0:3], 0
    s_nop 1
    v_bitop3_b32 v78, v73, -9, s53 bitop3:0x6a
    v_mfma_f32_16x16x32_bf16 v[4:7], v[24:27], v[0:3], 0
    ds_read_b128 v[24:27], v67 offset:0
    s_nop 1
    v_mfma_f32_16x16x32_bf16 v[8:11], v[28:31], v[0:3], 0
    s_nop 0
    v_mov_b32_dpp v12, v14 row_ror:8 row_mask:0xf bank_mask:0xc
    v_mov_b32_dpp v13, v15 row_ror:8 row_mask:0xf bank_mask:0xc
    v_smfmac_f32_16x16x64_bf16 v[20:23], v[52:55], v[216:223], v64
    ds_write_b64 v71, v[12:13]
    ds_read_b128 v[52:55], v68 offset:0
    s_nop 1
    v_mov_b32_dpp v4, v8 row_ror:8 row_mask:0xf bank_mask:0xc
    v_mov_b32_dpp v5, v9 row_ror:8 row_mask:0xf bank_mask:0xc
    v_mov_b32_dpp v6, v10 row_ror:8 row_mask:0xf bank_mask:0xc
    v_mov_b32_dpp v7, v11 row_ror:8 row_mask:0xf bank_mask:0xc
    v_smfmac_f32_16x16x64_bf16 v[16:19], v[44:47], v[224:231], v64
    ds_write_b128 v65, v[4:7] offset:8192
    v_smfmac_f32_16x16x64_bf16 v[20:23], v[44:47], v[232:239], v64
    s_waitcnt lgkmcnt(3)
    v_smfmac_f32_16x16x64_bf16 v[16:19], v[24:27], v[144:151], v64
    s_waitcnt vmcnt(1)
    v_smfmac_f32_16x16x64_bf16 v[20:23], v[24:27], v[152:159], v64
    s_mov_b64 exec, s[38:39]
    buffer_store_dword v72, v75, s[4:7], s55 offen sc1
    s_mov_b64 exec, -1
    v_smfmac_f32_16x16x64_bf16 v[16:19], v[40:43], v[240:247], v64
    s_cmp_ge_u32 s30, 56
    s_waitcnt lgkmcnt(0)
    s_barrier
    ds_read_b128 v[8:11], v66 offset:8192
    v_smfmac_f32_16x16x64_bf16 v[20:23], v[40:43], v[248:255], v64
    ds_read_b128 v[12:15], v67 offset:8192
    v_smfmac_f32_16x16x64_bf16 v[16:19], v[48:51], v[192:199], v64
    ds_read_b128 v[44:47], v68 offset:8192
    v_smfmac_f32_16x16x64_bf16 v[20:23], v[48:51], v[200:207], v64
    ds_read_b64 v[24:25], v77 offset:14336
    ds_read_b64 v[26:27], v77 offset:14592
    v_smfmac_f32_16x16x64_bf16 v[16:19], v[52:55], v[160:167], v64
    ds_read_b64 v[28:29], v77 offset:14848
    ds_read_b64 v[30:31], v77 offset:15104
    v_bitop3_b32 v77, v73, -9, s52 bitop3:0x6a
    v_smfmac_f32_16x16x64_bf16 v[20:23], v[52:55], v[168:175], v64
    s_cbranch_scc1 cs_rare
cs_rare_x:
    ds_read_b128 v[48:51], v70 offset:22528
    ds_read_b128 v[52:55], v70 offset:23552
    s_waitcnt lgkmcnt(6)
    v_pk_add_f32 v[4:5], v[4:5], v[8:9]
    v_pk_add_f32 v[6:7], v[6:7], v[10:11]
    v_pk_add_f32 v[12:13], v[12:13], v[44:45]
    v_pk_add_f32 v[14:15], v[14:15], v[46:47]
    v_pk_add_f32 v[4:5], v[4:5], v[12:13]
    v_pk_add_f32 v[6:7], v[6:7], v[14:15]
    s_waitcnt lgkmcnt(2)
    v_pk_add_f32 v[24:25], v[24:25], v[26:27]
    v_pk_add_f32 v[28:29], v[28:29], v[30:31]
    v_max3_f32 v8, v4, v5, v6
    v_pk_add_f32 v[24:25], v[24:25], v[28:29]
    v_max_f32 v8, v8, v7
    v_max3_f32 v8, v8, v24, v25
    v_cvt_pk_bf16_f32 v32, v16, v17
    v_cvt_pk_bf16_f32 v38, v18, v19
    v_max_f32_dpp v8, v8, v8 row_ror:8 row_mask:0xf bank_mask:0xf
    v_mov_b32 v9, v8
    v_cvt_pk_bf16_f32 v56, v20, v21
    v_cvt_pk_bf16_f32 v62, v22, v23
    v_permlane32_swap_b32 v8, v9
    v_max_f32 v8, v8, v9
    v_mov_b32 v9, v8
    v_mov_b32 v11, 0
    v_mov_b32 v15, 0
    v_permlane16_swap_b32 v8, v9
    v_max_f32 v8, v8, v9
    v_mul_f32 v8, s66, v8
    v_pk_fma_f32 v[4:5], v[4:5], s[44:45], v[8:9] op_sel_hi:[1,1,0]
    v_pk_fma_f32 v[6:7], v[6:7], s[44:45], v[8:9] op_sel_hi:[1,1,0]
    v_pk_fma_f32 v[24:25], v[24:25], s[44:45], v[8:9] op_sel_hi:[1,1,0]
    v_exp_f32 v4, v4
    v_exp_f32 v5, v5
    v_exp_f32 v6, v6
    v_exp_f32 v7, v7
    v_exp_f32 v24, v24
    v_exp_f32 v25, v25
    v_cvt_pk_bf16_f32 v12, v4, v5
    v_cvt_pk_bf16_f32 v13, v6, v7
    v_cvt_pk_bf16_f32 v10, v24, v25
    v_cvt_pk_bf16_f32 v14, v24, v25
    v_mov_b64 v[0:1], s[48:49]
    v_mfma_f32_16x16x32_bf16 v[4:7], v[32:35], v[10:13], 0
    ds_read_b128 v[40:43], v70 offset:20480
    v_mov_b64 v[2:3], s[50:51]
    v_mfma_f32_16x16x32_bf16 v[24:27], v[36:39], v[12:15], 0
    ds_read_b128 v[44:47], v70 offset:21504
    v_mov_b64 v[8:9], 0
    v_mfma_f32_16x16x32_bf16 v[28:31], v[0:3], v[10:13], 0
    ds_read_b128 v[32:35], v70 offset:24576
    v_mov_b64 v[0:1], 0
    v_mfma_f32_16x16x32_bf16 v[16:19], v[56:59], v[10:13], 0
    ds_read_b128 v[36:39], v70 offset:25600
    v_mov_b64 v[2:3], 0
    v_mfma_f32_16x16x32_bf16 v[20:23], v[60:63], v[12:15], 0
    ds_read_b128 v[56:59], v70 offset:28672
    v_add_f32_dpp v4, v24, v4 row_ror:8 row_mask:0xf bank_mask:0xf
    v_add_f32_dpp v5, v25, v5 row_ror:8 row_mask:0xf bank_mask:0xf
    v_add_f32_dpp v6, v26, v6 row_ror:8 row_mask:0xf bank_mask:0xf
    v_add_f32_dpp v7, v27, v7 row_ror:8 row_mask:0xf bank_mask:0xf
    v_add_f32_dpp v29, v28, v28 row_ror:8 row_mask:0xf bank_mask:0xf
    v_rcp_f32 v28, v29
    v_mov_b64 v[10:11], 0
    v_add_f32_dpp v4, v16, v20 row_ror:8 row_mask:0xf bank_mask:0xc
    v_add_f32_dpp v5, v17, v21 row_ror:8 row_mask:0xf bank_mask:0xc
    v_add_f32_dpp v6, v18, v22 row_ror:8 row_mask:0xf bank_mask:0xc
    v_add_f32_dpp v7, v19, v23 row_ror:8 row_mask:0xf bank_mask:0xc
    v_pk_mul_f32 v[4:5], v[4:5], v[28:29] op_sel_hi:[1,0]
    v_pk_mul_f32 v[6:7], v[6:7], v[28:29] op_sel_hi:[1,0]
    v_cvt_pk_bf16_f32 v4, v4, v5
    v_cvt_pk_bf16_f32 v5, v6, v7
    ds_write_b64 v73, v[4:5] offset:12288
    v_mov_b32_dpp v6, v4 row_ror:8 row_mask:0xf bank_mask:0xf
    v_mov_b32_dpp v7, v5 row_ror:8 row_mask:0xf bank_mask:0xf
    v_mov_b64 v[12:13], 0
    v_mov_b64 v[14:15], 0
    v_smfmac_f32_16x16x64_bf16 v[8:11], v[4:7], v[80:87], v64
    s_waitcnt lgkmcnt(4)
    v_mov_b64 v[24:25], 0
    v_smfmac_f32_16x16x64_bf16 v[0:3], v[4:7], v[40:47], v64
    ds_read_b128 v[60:63], v70 offset:29696
    v_mov_b64 v[26:27], 0
    v_smfmac_f32_16x16x64_bf16 v[12:15], v[4:7], v[112:119], v64
    s_waitcnt lgkmcnt(1)
    s_barrier
    ds_read_b128 v[16:19], v77 offset:12288
    v_smfmac_f32_16x16x64_bf16 v[24:27], v[4:7], v[48:55], v64
    ds_read_b128 v[20:23], v78 offset:12288
    ds_read_b128 v[28:31], v79 offset:12288
    v_mov_b64 v[4:5], 0
    v_mov_b64 v[6:7], 0
    v_bfe_u32 v77, v74, 16, 1
    v_mad_i32_i24 v77, v77, s56, v74
    s_waitcnt lgkmcnt(2)
    v_smfmac_f32_16x16x64_bf16 v[8:11], v[16:19], v[88:95], v64
    ds_read_b128 v[40:43], v70 offset:32768
    s_waitcnt lgkmcnt(2)
    v_smfmac_f32_16x16x64_bf16 v[8:11], v[20:23], v[96:103], v64
    ds_read_b128 v[44:47], v70 offset:33792
    s_waitcnt lgkmcnt(2)
    v_smfmac_f32_16x16x64_bf16 v[8:11], v[28:31], v[104:111], v64
    ds_read_b128 v[48:51], v70 offset:26624
    s_nop 0
    v_and_b32 v72, 8, v73
    v_smfmac_f32_16x16x64_bf16 v[0:3], v[16:19], v[32:39], v64
    ds_read_b128 v[52:55], v70 offset:27648
    s_nop 0
    v_mad_u32_u24 v72, v72, 63, v73
    v_smfmac_f32_16x16x64_bf16 v[12:15], v[16:19], v[120:127], v64
    ds_read_b128 v[32:35], v70 offset:30720
    v_cvt_pk_bf16_f32 v8, v8, v9
    v_cvt_pk_bf16_f32 v9, v10, v11
    v_and_or_b32 v8, v8, -2, s69
    v_smfmac_f32_16x16x64_bf16 v[12:15], v[20:23], v[128:135], v64
    buffer_store_dwordx2 v[8:9], v74, s[4:7], s22 offen offset:0 sc1
    ds_read_b128 v[36:39], v70 offset:31744
    v_smfmac_f32_16x16x64_bf16 v[12:15], v[28:31], v[136:143], v64
    s_add_u32 s30, s30, 1
    s_xor_b32 s70, s70, 1
    v_subrev_u32 v72, s47, v72
    v_smfmac_f32_16x16x64_bf16 v[0:3], v[20:23], v[56:63], v64
    ds_read_b128 v[56:59], v70 offset:34816
    s_waitcnt lgkmcnt(3)
    s_nop 0
    v_smfmac_f32_16x16x64_bf16 v[0:3], v[28:31], v[40:47], v64
    ds_read_b128 v[60:63], v70 offset:35840
    v_cvt_pk_bf16_f32 v12, v12, v13
    v_cvt_pk_bf16_f32 v13, v14, v15
    v_and_or_b32 v12, v12, -2, s69
    v_smfmac_f32_16x16x64_bf16 v[24:27], v[16:19], v[48:55], v64
    buffer_store_dwordx2 v[12:13], v74, s[4:7], s22 offen offset:64 sc1
    s_waitcnt lgkmcnt(2)
    v_smfmac_f32_16x16x64_bf16 v[24:27], v[20:23], v[32:39], v64
    ds_read_b128 v[40:43], v70 offset:16384
    v_cvt_pk_bf16_f32 v0, v0, v1
    v_cvt_pk_bf16_f32 v1, v2, v3
    v_and_or_b32 v0, v0, -2, s69
    s_waitcnt lgkmcnt(1)
    v_smfmac_f32_16x16x64_bf16 v[24:27], v[28:31], v[56:63], v64
    buffer_store_dwordx2 v[0:1], v74, s[4:7], s23 offen offset:0 sc1
    ds_read_b128 v[44:47], v70 offset:17408
    ds_read_b128 v[8:11], v72 offset:12288
    ds_read_b128 v[48:51], v70 offset:18432
    ds_read_b128 v[52:55], v70 offset:19456
    ds_read_b128 v[12:15], v72 offset:13312
    s_cmp_lg_u32 s71, 0
    s_nop 0
    v_cvt_pk_bf16_f32 v24, v24, v25
    v_cvt_pk_bf16_f32 v25, v26, v27
    v_and_or_b32 v24, v24, -2, s69
    buffer_store_dwordx2 v[24:25], v74, s[4:7], s23 offen offset:64 sc1
    s_waitcnt lgkmcnt(3)
    v_smfmac_f32_16x16x64_bf16 v[4:7], v[8:11], v[40:47], v64
    s_waitcnt lgkmcnt(0)
    v_smfmac_f32_16x16x64_bf16 v[4:7], v[12:15], v[48:55], v64
    s_nop 7
    v_cvt_pk_bf16_f32 v4, v4, v5
    v_cvt_pk_bf16_f32 v5, v6, v7
    v_and_or_b32 v4, v4, -2, s69
    buffer_store_dwordx2 v[4:5], v77, s[4:7], s25 offen offset:0 sc1
    s_nop 0
    s_cbranch_scc1 cs_e1
    s_cmp_lg_u32 s37, 0
    s_cbranch_scc1 cs_f0_xt
cs_f0_xtx:
    s_nop 2
    v_mov_b32 v79, v79
    s_nop 2
    v_mov_b32 v79, v79
    s_nop 2
    v_mov_b32 v79, v79
    s_nop 2
    v_mov_b32 v79, v79
    s_nop 2
    v_mov_b32 v79, v79
    s_nop 2
    v_mov_b32 v79, v79
    s_nop 2
    v_mov_b32 v79, v79
    s_nop 2
    v_mov_b32 v79, v79
    s_nop 2
    v_mov_b32 v79, v79
    s_nop 2
    v_mov_b32 v79, v79
    s_nop 2
    v_mov_b32 v79, v79
    s_nop 2
    v_mov_b32 v79, v79
    s_nop 2
    v_mov_b32 v79, v79
    s_nop 2
    v_mov_b32 v79, v79
    s_nop 2
    v_mov_b32 v79, v79
    s_nop 2
    v_mov_b32 v79, v79
    s_nop 2
    v_mov_b32 v79, v79
    s_nop 2
    v_mov_b32 v79, v79
    s_nop 2
    v_mov_b32 v79, v79
    s_nop 2
    v_mov_b32 v79, v79
    s_nop 2
    v_mov_b32 v79, v79
    s_nop 2
    v_mov_b32 v79, v79
    s_nop 2
    v_mov_b32 v79, v79
    s_nop 2
    v_mov_b32 v79, v79
    s_nop 2
    v_mov_b32 v79, v79
    s_nop 2
    v_mov_b32 v79, v79
    s_nop 2
    v_mov_b32 v79, v79
    s_nop 2
    v_mov_b32 v79, v79
    s_nop 2
    v_mov_b32 v79, v79
    s_nop 2
    v_mov_b32 v79, v79
    s_nop 2
    v_mov_b32 v79, v79
    s_nop 2
    v_mov_b32 v79, v79
    s_nop 2
    v_mov_b32 v79, v79
    s_nop 2
    v_mov_b32 v79, v79
    s_nop 2
    v_mov_b32 v79, v79
    s_nop 2
    v_mov_b32 v79, v79
    s_nop 0
    v_mov_b32 v79, v79
    buffer_load_dwordx4 v[8:11], v65, s[4:7], s18 offen sc1
    buffer_load_dwordx4 v[12:15], v65, s[4:7], s19 offen sc1
    buffer_load_dwordx4 v[16:19], v65, s[4:7], s20 offen sc1
    buffer_load_dwordx4 v[20:23], v65, s[4:7], s21 offen sc1
    v_and_b32 v77, 255, v69
    ds_read_b128 v[4:7], v77 offset:15872
    ds_read_b128 v[44:47], v70 offset:0
    ds_read_b128 v[48:51], v70 offset:1024
    ds_read_b128 v[52:55], v70 offset:2048
    ds_read_b128 v[56:59], v70 offset:3072
    ds_read_b128 v[24:27], v70 offset:4096
    ds_read_b128 v[28:31], v70 offset:5120
    ds_read_b128 v[32:35], v70 offset:6144
    ds_read_b128 v[36:39], v70 offset:7168
    s_mov_b32 s31, 65536
    s_add_u32 s24, s24, 524288
    s_add_u32 s26, s26, 524288
    s_add_u32 s55, s55, s57
    s_mov_b32 s14, 67633152
    s_mov_b32 s15, 67637248
    s_mov_b32 s16, 67641344
    s_mov_b32 s36, 1
    v_mov_b32 v40, s69
    v_mov_b32 v60, s69
    v_and_b32 v79, 12, v75
    v_cmp_eq_u32 vcc, 0, v79
    s_nop 1
    v_cndmask_b32 v79, 0, 1, vcc
    s_waitcnt lgkmcnt(0)
    s_waitcnt vmcnt(3)
    v_bitop3_b32 v77, v8, v10, s69 bitop3:0x7e
    v_mfma_f32_16x16x32_bf16 v[0:3], v[4:7], v[8:11], 0
    v_mov_b64 v[8:9], 0
    v_mov_b64 v[10:11], 0
    s_waitcnt vmcnt(2)
    v_bitop3_b32 v78, v12, v14, s69 bitop3:0x7e
    v_mfma_f32_16x16x32_bf16 v[0:3], v[4:7], v[12:15], v[0:3]
    v_or_b32 v77, v77, v78
    v_mov_b64 v[12:13], 0
    v_mov_b64 v[14:15], 0
    s_waitcnt vmcnt(1)
    v_bitop3_b32 v78, v16, v18, s69 bitop3:0x7e
    v_mfma_f32_16x16x32_bf16 v[0:3], v[4:7], v[16:19], v[0:3]
    v_or_b32 v77, v77, v78
    v_mov_b64 v[16:17], 0
    v_mov_b64 v[18:19], 0
    s_waitcnt vmcnt(0)
    v_bitop3_b32 v78, v20, v22, s69 bitop3:0x7e
    v_mfma_f32_16x16x32_bf16 v[0:3], v[4:7], v[20:23], v[0:3]
    v_bitop3_b32 v77, v77, v78, 1 bitop3:0xa8
    v_cmp_ne_u32 vcc, 0, v77
    v_mov_b64 v[20:21], 0
    v_mov_b64 v[22:23], 0
    s_cmp_eq_u64 vcc, 0
    s_cselect_b64 s[42:43], -1, 0
    s_nop 1
    v_add_f32_dpp v0, v0, v0 row_ror:8 row_mask:0xf bank_mask:0xf
    v_add_f32_dpp v1, v1, v1 row_ror:8 row_mask:0xf bank_mask:0xf
    s_mov_b64 exec, s[42:43]
    v_cvt_pk_bf16_f32 v72, v0, v1
    v_bfi_b32 v72, v79, s70, v72
    buffer_store_dword v72, v75, s[4:7], s17 offen offset:0 sc1
    s_mov_b64 exec, -1
    s_cbranch_scc0 cs_f0_retry
cs_f0_go:
    v_mov_b64 v[0:1], 0
    v_mov_b64 v[2:3], 0
    v_mov_b64 v[4:5], 0
    v_mov_b64 v[6:7], 0
    s_nop 2
    v_mov_b32 v79, v79
    s_nop 2
    v_mov_b32 v79, v79
    s_nop 2
    v_mov_b32 v79, v79
    s_nop 2
    v_mov_b32 v79, v79
    s_nop 2
    v_mov_b32 v79, v79
    s_nop 2
    v_mov_b32 v79, v79
    s_nop 2
    v_mov_b32 v79, v79
    s_nop 2
    v_mov_b32 v79, v79
    s_nop 2
    v_mov_b32 v79, v79
    s_nop 2
    v_mov_b32 v79, v79
    s_nop 2
    v_mov_b32 v79, v79
    s_nop 2
    v_mov_b32 v79, v79
    s_nop 2
    v_mov_b32 v79, v79
    s_nop 2
    v_mov_b32 v79, v79
    s_nop 2
    v_mov_b32 v79, v79
    s_nop 2
    v_mov_b32 v79, v79
    s_nop 2
    v_mov_b32 v79, v79
    s_nop 2
    v_mov_b32 v79, v79
    s_nop 2
    v_mov_b32 v79, v79
    s_nop 2
    v_mov_b32 v79, v79
    s_nop 2
    v_mov_b32 v79, v79
    s_nop 2
    v_mov_b32 v79, v79
    s_nop 2
    v_mov_b32 v79, v79
    s_nop 2
    v_mov_b32 v79, v79
    s_nop 2
    v_mov_b32 v79, v79
    s_branch cs_loop
cs_e1:
    s_cmp_lg_u32 s71, 2
    s_cbranch_scc1 cs_f1
    v_and_b32 v77, 255, v69
    ds_read_b128 v[4:7], v77 offset:15872
    ds_read_b128 v[44:47], v70 offset:0
    ds_read_b128 v[48:51], v70 offset:1024
    ds_read_b128 v[52:55], v70 offset:2048
    ds_read_b128 v[56:59], v70 offset:3072
    ds_read_b128 v[24:27], v70 offset:4096
    ds_read_b128 v[28:31], v70 offset:5120
    ds_read_b128 v[32:35], v70 offset:6144
    ds_read_b128 v[36:39], v70 offset:7168
    s_mov_b32 s31, 65536
    s_add_u32 s24, s24, 524288
    s_add_u32 s26, s26, 524288
    s_add_u32 s55, s55, s57
    s_mov_b32 s14, 67633152
    s_mov_b32 s15, 67637248
    s_mov_b32 s16, 67641344
    s_mov_b32 s36, 1
    v_mov_b32 v40, s69
    v_mov_b32 v60, s69
    v_and_b32 v79, 12, v75
    v_cmp_eq_u32 vcc, 0, v79
    s_nop 1
    v_cndmask_b32 v79, 0, 1, vcc
    s_cmp_lg_u32 s37, 0
    s_cbranch_scc1 cs_f2_xt
cs_f2_xtx:
    s_nop 2
    v_mov_b32 v79, v79
    s_nop 2
    v_mov_b32 v79, v79
    s_nop 2
    v_mov_b32 v79, v79
    s_nop 2
    v_mov_b32 v79, v79
    s_nop 2
    v_mov_b32 v79, v79
    s_nop 2
    v_mov_b32 v79, v79
    s_nop 2
    v_mov_b32 v79, v79
    s_nop 2
    v_mov_b32 v79, v79
    s_nop 2
    v_mov_b32 v79, v79
    s_nop 2
    v_mov_b32 v79, v79
    s_nop 2
    v_mov_b32 v79, v79
    s_nop 2
    v_mov_b32 v79, v79
    s_nop 2
    v_mov_b32 v79, v79
    s_nop 2
    v_mov_b32 v79, v79
    s_nop 2
    v_mov_b32 v79, v79
    s_nop 2
    v_mov_b32 v79, v79
    s_nop 2
    v_mov_b32 v79, v79
    s_nop 2
    v_mov_b32 v79, v79
    s_nop 2
    v_mov_b32 v79, v79
    s_nop 2
    v_mov_b32 v79, v79
    s_nop 2
    v_mov_b32 v79, v79
    s_nop 2
    v_mov_b32 v79, v79
    s_nop 2
    v_mov_b32 v79, v79
    s_nop 2
    v_mov_b32 v79, v79
    s_nop 2
    v_mov_b32 v79, v79
    s_nop 2
    v_mov_b32 v79, v79
    s_nop 2
    v_mov_b32 v79, v79
    s_nop 2
    v_mov_b32 v79, v79
    s_nop 2
    v_mov_b32 v79, v79
    s_nop 2
    v_mov_b32 v79, v79
    s_nop 2
    v_mov_b32 v79, v79
    s_nop 2
    v_mov_b32 v79, v79
    s_nop 2
    v_mov_b32 v79, v79
    s_nop 2
    v_mov_b32 v79, v79
    s_nop 2
    v_mov_b32 v79, v79
    s_nop 2
    v_mov_b32 v79, v79
    s_nop 0
    v_mov_b32 v79, v79
    s_waitcnt vmcnt(0)
    buffer_load_dwordx4 v[8:11], v65, s[4:7], s18 offen sc1
    buffer_load_dwordx4 v[12:15], v65, s[4:7], s19 offen sc1
    buffer_load_dwordx4 v[16:19], v65, s[4:7], s20 offen sc1
    buffer_load_dwordx4 v[20:23], v65, s[4:7], s21 offen sc1
    s_nop 2
    v_mov_b32 v79, v79
    s_nop 2
    v_mov_b32 v79, v79
    s_nop 2
    v_mov_b32 v79, v79
    s_nop 2
    v_mov_b32 v79, v79
    s_nop 2
    v_mov_b32 v79, v79
    s_nop 2
    v_mov_b32 v79, v79
    s_nop 2
    v_mov_b32 v79, v79
    s_nop 2
    v_mov_b32 v79, v79
    s_nop 2
    v_mov_b32 v79, v79
    s_nop 2
    v_mov_b32 v79, v79
    buffer_load_dwordx4 v[40:43], v65, s[4:7], s14 offen offset:0 sc1
    buffer_load_dwordx4 v[60:63], v66, s[4:7], s14 offen offset:0 sc1
    s_waitcnt lgkmcnt(0)
    s_waitcnt vmcnt(5)
    v_bitop3_b32 v77, v8, v10, s69 bitop3:0x7e
    v_mfma_f32_16x16x32_bf16 v[0:3], v[4:7], v[8:11], 0
    v_mov_b64 v[8:9], 0
    v_mov_b64 v[10:11], 0
    s_waitcnt vmcnt(4)
    v_bitop3_b32 v78, v12, v14, s69 bitop3:0x7e
    v_mfma_f32_16x16x32_bf16 v[0:3], v[4:7], v[12:15], v[0:3]
    v_or_b32 v77, v77, v78
    v_mov_b64 v[12:13], 0
    v_mov_b64 v[14:15], 0
    s_waitcnt vmcnt(3)
    v_bitop3_b32 v78, v16, v18, s69 bitop3:0x7e
    v_mfma_f32_16x16x32_bf16 v[0:3], v[4:7], v[16:19], v[0:3]
    v_or_b32 v77, v77, v78
    v_mov_b64 v[16:17], 0
    v_mov_b64 v[18:19], 0
    s_waitcnt vmcnt(2)
    v_bitop3_b32 v78, v20, v22, s69 bitop3:0x7e
    v_mfma_f32_16x16x32_bf16 v[0:3], v[4:7], v[20:23], v[0:3]
    v_bitop3_b32 v77, v77, v78, 1 bitop3:0xa8
    v_cmp_ne_u32 vcc, 0, v77
    v_mov_b64 v[20:21], 0
    v_mov_b64 v[22:23], 0
    buffer_load_dwordx4 v[40:43], v65, s[4:7], s14 offen offset:0 sc1
    buffer_load_dwordx4 v[60:63], v66, s[4:7], s14 offen offset:0 sc1
    s_cmp_eq_u64 vcc, 0
    s_cselect_b64 s[42:43], -1, 0
    v_add_f32_dpp v0, v0, v0 row_ror:4 row_mask:0xf bank_mask:0xf
    v_add_f32_dpp v1, v1, v1 row_ror:4 row_mask:0xf bank_mask:0xf
    s_nop 0
    v_add_f32_dpp v0, v0, v0 row_ror:8 row_mask:0xf bank_mask:0xf
    v_add_f32_dpp v1, v1, v1 row_ror:8 row_mask:0xf bank_mask:0xf
    s_mov_b64 exec, s[42:43]
    v_cvt_pk_bf16_f32 v72, v0, v1
    v_bfi_b32 v72, v79, s70, v72
    buffer_store_dword v72, v75, s[4:7], s17 offen offset:0 sc1
    buffer_store_dword v72, v75, s[4:7], s17 offen offset:1024 sc1
    buffer_store_dword v72, v75, s[4:7], s17 offen offset:2048 sc1
    buffer_store_dword v72, v75, s[4:7], s17 offen offset:3072 sc1
    s_mov_b64 exec, -1
    s_cbranch_scc0 cs_f2_retry
cs_f2_go:
    v_mov_b64 v[0:1], 0
    v_mov_b64 v[2:3], 0
    v_mov_b64 v[4:5], 0
    v_mov_b64 v[6:7], 0
    s_nop 2
    v_mov_b32 v79, v79
    s_nop 2
    v_mov_b32 v79, v79
    s_nop 2
    v_mov_b32 v79, v79
    s_nop 2
    v_mov_b32 v79, v79
    s_nop 2
    v_mov_b32 v79, v79
    s_nop 2
    v_mov_b32 v79, v79
    s_nop 2
    v_mov_b32 v79, v79
    s_nop 2
    v_mov_b32 v79, v79
    s_nop 2
    v_mov_b32 v79, v79
    s_nop 2
    v_mov_b32 v79, v79
    s_nop 2
    v_mov_b32 v79, v79
    s_nop 2
    v_mov_b32 v79, v79
    s_nop 2
    v_mov_b32 v79, v79
    s_nop 2
    v_mov_b32 v79, v79
    s_nop 2
    v_mov_b32 v79, v79
    s_nop 2
    v_mov_b32 v79, v79
    s_nop 2
    v_mov_b32 v79, v79
    s_nop 2
    v_mov_b32 v79, v79
    s_nop 2
    v_mov_b32 v79, v79
    s_nop 2
    v_mov_b32 v79, v79
    s_nop 2
    v_mov_b32 v79, v79
    s_nop 2
    v_mov_b32 v79, v79
    s_nop 2
    v_mov_b32 v79, v79
    s_nop 2
    v_mov_b32 v79, v79
    s_nop 2
    v_mov_b32 v79, v79
    s_branch cs_loop
cs_f1:
    s_cmp_lg_u32 s32, 1
    s_cbranch_scc1 cs_f3
    v_and_b32 v77, 255, v69
    ds_read_b128 v[4:7], v77 offset:15872
    ds_read_b128 v[44:47], v70 offset:0
    ds_read_b128 v[48:51], v70 offset:1024
    ds_read_b128 v[52:55], v70 offset:2048
    ds_read_b128 v[56:59], v70 offset:3072
    ds_read_b128 v[24:27], v70 offset:4096
    ds_read_b128 v[28:31], v70 offset:5120
    ds_read_b128 v[32:35], v70 offset:6144
    ds_read_b128 v[36:39], v70 offset:7168
    s_mov_b32 s31, 65536
    s_add_u32 s24, s24, 524288
    s_add_u32 s26, s26, 524288
    s_add_u32 s55, s55, s57
    s_mov_b32 s14, 67633152
    s_mov_b32 s15, 67637248
    s_mov_b32 s16, 67641344
    s_mov_b32 s36, 1
    v_mov_b32 v40, s69
    v_mov_b32 v60, s69
    v_and_b32 v79, 12, v75
    v_cmp_eq_u32 vcc, 0, v79
    s_nop 1
    v_cndmask_b32 v79, 0, 1, vcc
    s_cmp_lg_u32 s37, 0
    s_cbranch_scc1 cs_f1_xt
cs_f1_xtx:
    s_nop 2
    v_mov_b32 v79, v79
    s_nop 2
    v_mov_b32 v79, v79
    s_nop 2
    v_mov_b32 v79, v79
    s_nop 2
    v_mov_b32 v79, v79
    s_nop 2
    v_mov_b32 v79, v79
    s_nop 2
    v_mov_b32 v79, v79
    s_nop 2
    v_mov_b32 v79, v79
    s_nop 2
    v_mov_b32 v79, v79
    s_nop 2
    v_mov_b32 v79, v79
    s_nop 2
    v_mov_b32 v79, v79
    s_nop 2
    v_mov_b32 v79, v79
    s_nop 2
    v_mov_b32 v79, v79
    s_nop 2
    v_mov_b32 v79, v79
    s_nop 2
    v_mov_b32 v79, v79
    s_nop 2
    v_mov_b32 v79, v79
    s_nop 2
    v_mov_b32 v79, v79
    s_nop 2
    v_mov_b32 v79, v79
    s_nop 2
    v_mov_b32 v79, v79
    s_nop 2
    v_mov_b32 v79, v79
    s_nop 2
    v_mov_b32 v79, v79
    s_nop 2
    v_mov_b32 v79, v79
    s_nop 2
    v_mov_b32 v79, v79
    s_nop 2
    v_mov_b32 v79, v79
    s_nop 2
    v_mov_b32 v79, v79
    s_nop 2
    v_mov_b32 v79, v79
    s_nop 2
    v_mov_b32 v79, v79
    s_nop 2
    v_mov_b32 v79, v79
    s_nop 2
    v_mov_b32 v79, v79
    s_nop 2
    v_mov_b32 v79, v79
    s_nop 2
    v_mov_b32 v79, v79
    s_nop 2
    v_mov_b32 v79, v79
    s_nop 2
    v_mov_b32 v79, v79
    s_nop 2
    v_mov_b32 v79, v79
    s_nop 2
    v_mov_b32 v79, v79
    s_nop 2
    v_mov_b32 v79, v79
    s_nop 2
    v_mov_b32 v79, v79
    s_nop 0
    v_mov_b32 v79, v79
    s_waitcnt vmcnt(0)
    buffer_load_dwordx4 v[8:11], v65, s[4:7], s18 offen sc1
    buffer_load_dwordx4 v[12:15], v65, s[4:7], s19 offen sc1
    buffer_load_dwordx4 v[16:19], v65, s[4:7], s20 offen sc1
    buffer_load_dwordx4 v[20:23], v65, s[4:7], s21 offen sc1
    s_nop 2
    v_mov_b32 v79, v79
    s_nop 2
    v_mov_b32 v79, v79
    s_nop 2
    v_mov_b32 v79, v79
    s_nop 2
    v_mov_b32 v79, v79
    s_nop 2
    v_mov_b32 v79, v79
    s_nop 2
    v_mov_b32 v79, v79
    s_nop 2
    v_mov_b32 v79, v79
    s_nop 2
    v_mov_b32 v79, v79
    s_nop 2
    v_mov_b32 v79, v79
    s_nop 2
    v_mov_b32 v79, v79
    buffer_load_dwordx4 v[40:43], v65, s[4:7], s14 offen offset:0 sc1
    buffer_load_dwordx4 v[60:63], v66, s[4:7], s14 offen offset:0 sc1
    s_waitcnt lgkmcnt(0)
    s_waitcnt vmcnt(5)
    v_bitop3_b32 v77, v8, v10, s69 bitop3:0x7e
    v_mfma_f32_16x16x32_bf16 v[0:3], v[4:7], v[8:11], 0
    v_mov_b64 v[8:9], 0
    v_mov_b64 v[10:11], 0
    s_waitcnt vmcnt(4)
    v_bitop3_b32 v78, v12, v14, s69 bitop3:0x7e
    v_mfma_f32_16x16x32_bf16 v[0:3], v[4:7], v[12:15], v[0:3]
    v_or_b32 v77, v77, v78
    v_mov_b64 v[12:13], 0
    v_mov_b64 v[14:15], 0
    s_waitcnt vmcnt(3)
    v_bitop3_b32 v78, v16, v18, s69 bitop3:0x7e
    v_mfma_f32_16x16x32_bf16 v[0:3], v[4:7], v[16:19], v[0:3]
    v_or_b32 v77, v77, v78
    v_mov_b64 v[16:17], 0
    v_mov_b64 v[18:19], 0
    s_waitcnt vmcnt(2)
    v_bitop3_b32 v78, v20, v22, s69 bitop3:0x7e
    v_mfma_f32_16x16x32_bf16 v[0:3], v[4:7], v[20:23], v[0:3]
    v_bitop3_b32 v77, v77, v78, 1 bitop3:0xa8
    v_cmp_ne_u32 vcc, 0, v77
    v_mov_b64 v[20:21], 0
    v_mov_b64 v[22:23], 0
    buffer_load_dwordx4 v[40:43], v65, s[4:7], s14 offen offset:0 sc1
    buffer_load_dwordx4 v[60:63], v66, s[4:7], s14 offen offset:0 sc1
    s_cmp_eq_u64 vcc, 0
    s_cselect_b64 s[42:43], -1, 0
    v_add_f32_dpp v0, v0, v0 row_ror:8 row_mask:0xf bank_mask:0xf
    v_add_f32_dpp v1, v1, v1 row_ror:8 row_mask:0xf bank_mask:0xf
    s_mov_b64 exec, s[42:43]
    v_cvt_pk_bf16_f32 v72, v0, v1
    v_bfi_b32 v72, v79, s70, v72
    buffer_store_dword v72, v75, s[4:7], s17 offen offset:0 sc1
    s_mov_b64 exec, -1
    s_cbranch_scc0 cs_f1_retry
cs_f1_go:
    v_mov_b64 v[0:1], 0
    v_mov_b64 v[2:3], 0
    v_mov_b64 v[4:5], 0
    v_mov_b64 v[6:7], 0
    s_nop 2
    v_mov_b32 v79, v79
    s_nop 2
    v_mov_b32 v79, v79
    s_nop 2
    v_mov_b32 v79, v79
    s_nop 2
    v_mov_b32 v79, v79
    s_nop 2
    v_mov_b32 v79, v79
    s_nop 2
    v_mov_b32 v79, v79
    s_nop 2
    v_mov_b32 v79, v79
    s_nop 2
    v_mov_b32 v79, v79
    s_nop 2
    v_mov_b32 v79, v79
    s_nop 2
    v_mov_b32 v79, v79
    s_nop 2
    v_mov_b32 v79, v79
    s_nop 2
    v_mov_b32 v79, v79
    s_nop 2
    v_mov_b32 v79, v79
    s_nop 2
    v_mov_b32 v79, v79
    s_nop 2
    v_mov_b32 v79, v79
    s_nop 2
    v_mov_b32 v79, v79
    s_nop 2
    v_mov_b32 v79, v79
    s_nop 2
    v_mov_b32 v79, v79
    s_nop 2
    v_mov_b32 v79, v79
    s_nop 2
    v_mov_b32 v79, v79
    s_nop 2
    v_mov_b32 v79, v79
    s_nop 2
    v_mov_b32 v79, v79
    s_nop 2
    v_mov_b32 v79, v79
    s_nop 2
    v_mov_b32 v79, v79
    s_nop 2
    v_mov_b32 v79, v79
    s_branch cs_loop
cs_f3:
    v_and_b32 v77, 255, v69
    ds_read_b128 v[4:7], v77 offset:15872
    ds_read_b128 v[44:47], v70 offset:0
    ds_read_b128 v[48:51], v70 offset:1024
    ds_read_b128 v[52:55], v70 offset:2048
    ds_read_b128 v[56:59], v70 offset:3072
    ds_read_b128 v[24:27], v70 offset:4096
    ds_read_b128 v[28:31], v70 offset:5120
    ds_read_b128 v[32:35], v70 offset:6144
    ds_read_b128 v[36:39], v70 offset:7168
    s_mov_b32 s31, 65536
    s_add_u32 s24, s24, 524288
    s_add_u32 s26, s26, 524288
    s_add_u32 s55, s55, s57
    s_mov_b32 s14, 67633152
    s_mov_b32 s15, 67637248
    s_mov_b32 s16, 67641344
    s_mov_b32 s36, 1
    v_mov_b32 v40, s69
    v_mov_b32 v60, s69
    v_and_b32 v79, 12, v75
    v_cmp_eq_u32 vcc, 0, v79
    s_nop 1
    v_cndmask_b32 v79, 0, 1, vcc
    s_add_u32 s40, s30, s95
    v_mov_b32 v72, s40
    s_waitcnt lgkmcnt(0)
    v_mov_b64 v[0:1], 0
    v_mov_b64 v[2:3], 0
    v_mov_b64 v[4:5], 0
    v_mov_b64 v[6:7], 0
    v_mov_b64 v[8:9], 0
    v_mov_b64 v[10:11], 0
    v_mov_b64 v[12:13], 0
    v_mov_b64 v[14:15], 0
    v_mov_b64 v[16:17], 0
    v_mov_b64 v[18:19], 0
    v_mov_b64 v[20:21], 0
    v_mov_b64 v[22:23], 0
    s_nop 2
    v_mov_b32 v79, v79
    s_nop 2
    v_mov_b32 v79, v79
    s_nop 2
    v_mov_b32 v79, v79
    s_nop 2
    v_mov_b32 v79, v79
    s_nop 2
    v_mov_b32 v79, v79
    s_nop 2
    v_mov_b32 v79, v79
    s_nop 2
    v_mov_b32 v79, v79
    s_nop 2
    v_mov_b32 v79, v79
    s_nop 2
    v_mov_b32 v79, v79
    s_nop 2
    v_mov_b32 v79, v79
    s_nop 2
    v_mov_b32 v79, v79
    s_nop 2
    v_mov_b32 v79, v79
    s_nop 2
    v_mov_b32 v79, v79
    s_nop 2
    v_mov_b32 v79, v79
    s_nop 2
    v_mov_b32 v79, v79
    s_nop 2
    v_mov_b32 v79, v79
    s_nop 2
    v_mov_b32 v79, v79
    s_nop 2
    v_mov_b32 v79, v79
    s_nop 2
    v_mov_b32 v79, v79
    s_nop 2
    v_mov_b32 v79, v79
    s_nop 2
    v_mov_b32 v79, v79
    s_nop 2
    v_mov_b32 v79, v79
    s_nop 2
    v_mov_b32 v79, v79
    s_nop 2
    v_mov_b32 v79, v79
    s_nop 2
    v_mov_b32 v79, v79
    s_nop 2
    v_mov_b32 v79, v79
    s_nop 2
    v_mov_b32 v79, v79
    s_nop 2
    v_mov_b32 v79, v79
    s_nop 2
    v_mov_b32 v79, v79
    s_nop 2
    v_mov_b32 v79, v79
    s_nop 2
    v_mov_b32 v79, v79
    s_nop 2
    v_mov_b32 v79, v79
    s_nop 2
    v_mov_b32 v79, v79
    s_nop 2
    v_mov_b32 v79, v79
    s_nop 2
    v_mov_b32 v79, v79
    s_nop 2
    v_mov_b32 v79, v79
    s_nop 2
    v_mov_b32 v79, v79
    s_nop 2
    v_mov_b32 v79, v79
    s_nop 2
    v_mov_b32 v79, v79
    s_nop 2
    v_mov_b32 v79, v79
    s_nop 2
    v_mov_b32 v79, v79
    s_nop 2
    v_mov_b32 v79, v79
    s_nop 2
    v_mov_b32 v79, v79
    s_nop 2
    v_mov_b32 v79, v79
    s_nop 2
    v_mov_b32 v79, v79
    s_nop 2
    v_mov_b32 v79, v79
    s_nop 2
    v_mov_b32 v79, v79
    s_nop 2
    v_mov_b32 v79, v79
    s_nop 2
    v_mov_b32 v79, v79
    s_nop 2
    v_mov_b32 v79, v79
    s_nop 2
    v_mov_b32 v79, v79
    s_nop 2
    v_mov_b32 v79, v79
    s_nop 2
    v_mov_b32 v79, v79
    s_nop 2
    v_mov_b32 v79, v79
    s_nop 2
    v_mov_b32 v79, v79
    s_nop 2
    v_mov_b32 v79, v79
    s_nop 2
    v_mov_b32 v79, v79
    s_nop 2
    v_mov_b32 v79, v79
    s_nop 2
    v_mov_b32 v79, v79
    s_nop 2
    v_mov_b32 v79, v79
    s_nop 2
    v_mov_b32 v79, v79
    s_nop 2
    v_mov_b32 v79, v79
    s_nop 2
    v_mov_b32 v79, v79
    s_nop 2
    v_mov_b32 v79, v79
    s_nop 2
    v_mov_b32 v79, v79
    s_waitcnt vmcnt(0)
    s_cmp_lt_u32 s97, s93
    s_cbranch_scc1 cs_kvwait
    s_nop 2
    v_mov_b32 v79, v79
    s_nop 2
    v_mov_b32 v79, v79
    s_nop 2
    v_mov_b32 v79, v79
    s_nop 2
    v_mov_b32 v79, v79
    s_nop 2
    v_mov_b32 v79, v79
    s_nop 2
    v_mov_b32 v79, v79
    s_nop 2
    v_mov_b32 v79, v79
    s_nop 2
    v_mov_b32 v79, v79
cs_kvok:
    s_branch cs_loop
cs_f0_xt:
    s_sub_u32 s37, s37, 1
    s_nop 2
    v_mov_b32 v79, v79
    s_nop 2
    v_mov_b32 v79, v79
    s_nop 2
    v_mov_b32 v79, v79
    s_nop 2
    v_mov_b32 v79, v79
    s_nop 2
    v_mov_b32 v79, v79
    s_nop 2
    v_mov_b32 v79, v79
    s_branch cs_f0_xtx
cs_f0_retry:
    s_sub_u32 s41, s30, s98
    s_mov_b32 s98, s30
    s_cmp_le_u32 s41, 3
    s_cselect_b32 s37, 1, 1
cs_f0_spin:
    buffer_load_dwordx4 v[8:11], v65, s[4:7], s18 offen sc1
    buffer_load_dwordx4 v[12:15], v65, s[4:7], s19 offen sc1
    buffer_load_dwordx4 v[16:19], v65, s[4:7], s20 offen sc1
    buffer_load_dwordx4 v[20:23], v65, s[4:7], s21 offen sc1
    s_nop 2
    v_mov_b32 v79, v79
    s_nop 2
    v_mov_b32 v79, v79
    s_nop 2
    v_mov_b32 v79, v79
    buffer_load_dwordx4 v[40:43], v65, s[4:7], s14 offen offset:0 sc1
    buffer_load_dwordx4 v[60:63], v66, s[4:7], s14 offen offset:0 sc1
    s_waitcnt vmcnt(5)
    v_bitop3_b32 v77, v8, v10, s69 bitop3:0x7e
    v_mfma_f32_16x16x32_bf16 v[0:3], v[4:7], v[8:11], 0
    v_mov_b64 v[8:9], 0
    v_mov_b64 v[10:11], 0
    s_waitcnt vmcnt(4)
    v_bitop3_b32 v78, v12, v14, s69 bitop3:0x7e
    v_mfma_f32_16x16x32_bf16 v[0:3], v[4:7], v[12:15], v[0:3]
    v_or_b32 v77, v77, v78
    v_mov_b64 v[12:13], 0
    v_mov_b64 v[14:15], 0
    s_waitcnt vmcnt(3)
    v_bitop3_b32 v78, v16, v18, s69 bitop3:0x7e
    v_mfma_f32_16x16x32_bf16 v[0:3], v[4:7], v[16:19], v[0:3]
    v_or_b32 v77, v77, v78
    v_mov_b64 v[16:17], 0
    v_mov_b64 v[18:19], 0
    s_waitcnt vmcnt(2)
    v_bitop3_b32 v78, v20, v22, s69 bitop3:0x7e
    v_mfma_f32_16x16x32_bf16 v[0:3], v[4:7], v[20:23], v[0:3]
    v_bitop3_b32 v77, v77, v78, 1 bitop3:0xa8
    v_cmp_ne_u32 vcc, 0, v77
    v_mov_b64 v[20:21], 0
    v_mov_b64 v[22:23], 0
    buffer_load_dwordx4 v[40:43], v65, s[4:7], s14 offen offset:0 sc1
    buffer_load_dwordx4 v[60:63], v66, s[4:7], s14 offen offset:0 sc1
    s_cmp_eq_u64 vcc, 0
    s_cselect_b64 s[42:43], -1, 0
    v_add_f32_dpp v0, v0, v0 row_ror:8 row_mask:0xf bank_mask:0xf
    v_add_f32_dpp v1, v1, v1 row_ror:8 row_mask:0xf bank_mask:0xf
    s_mov_b64 exec, s[42:43]
    v_cvt_pk_bf16_f32 v72, v0, v1
    v_bfi_b32 v72, v79, s70, v72
    buffer_store_dword v72, v75, s[4:7], s17 offen offset:0 sc1
    s_mov_b64 exec, -1
    s_cbranch_scc1 cs_f0_rx
    s_sub_u32 s31, s31, 1
    s_cbranch_scc0 cs_f0_spin
cs_f0_rx:
    v_mov_b64 v[0:1], 0
    v_mov_b64 v[2:3], 0
    v_mov_b64 v[4:5], 0
    v_mov_b64 v[6:7], 0
    s_branch cs_loop
cs_f1_xt:
    s_sub_u32 s37, s37, 1
    s_nop 2
    v_mov_b32 v79, v79
    s_nop 2
    v_mov_b32 v79, v79
    s_nop 2
    v_mov_b32 v79, v79
    s_nop 2
    v_mov_b32 v79, v79
    s_nop 2
    v_mov_b32 v79, v79
    s_nop 2
    v_mov_b32 v79, v79
    s_branch cs_f1_xtx
cs_f1_retry:
    s_sub_u32 s41, s30, s98
    s_mov_b32 s98, s30
    s_cmp_le_u32 s41, 3
    s_cselect_b32 s37, 1, 1
cs_f1_spin:
    buffer_load_dwordx4 v[8:11], v65, s[4:7], s18 offen sc1
    buffer_load_dwordx4 v[12:15], v65, s[4:7], s19 offen sc1
    buffer_load_dwordx4 v[16:19], v65, s[4:7], s20 offen sc1
    buffer_load_dwordx4 v[20:23], v65, s[4:7], s21 offen sc1
    s_nop 2
    v_mov_b32 v79, v79
    s_nop 2
    v_mov_b32 v79, v79
    s_nop 2
    v_mov_b32 v79, v79
    buffer_load_dwordx4 v[40:43], v65, s[4:7], s14 offen offset:0 sc1
    buffer_load_dwordx4 v[60:63], v66, s[4:7], s14 offen offset:0 sc1
    s_waitcnt vmcnt(5)
    v_bitop3_b32 v77, v8, v10, s69 bitop3:0x7e
    v_mfma_f32_16x16x32_bf16 v[0:3], v[4:7], v[8:11], 0
    v_mov_b64 v[8:9], 0
    v_mov_b64 v[10:11], 0
    s_waitcnt vmcnt(4)
    v_bitop3_b32 v78, v12, v14, s69 bitop3:0x7e
    v_mfma_f32_16x16x32_bf16 v[0:3], v[4:7], v[12:15], v[0:3]
    v_or_b32 v77, v77, v78
    v_mov_b64 v[12:13], 0
    v_mov_b64 v[14:15], 0
    s_waitcnt vmcnt(3)
    v_bitop3_b32 v78, v16, v18, s69 bitop3:0x7e
    v_mfma_f32_16x16x32_bf16 v[0:3], v[4:7], v[16:19], v[0:3]
    v_or_b32 v77, v77, v78
    v_mov_b64 v[16:17], 0
    v_mov_b64 v[18:19], 0
    s_waitcnt vmcnt(2)
    v_bitop3_b32 v78, v20, v22, s69 bitop3:0x7e
    v_mfma_f32_16x16x32_bf16 v[0:3], v[4:7], v[20:23], v[0:3]
    v_bitop3_b32 v77, v77, v78, 1 bitop3:0xa8
    v_cmp_ne_u32 vcc, 0, v77
    v_mov_b64 v[20:21], 0
    v_mov_b64 v[22:23], 0
    buffer_load_dwordx4 v[40:43], v65, s[4:7], s14 offen offset:0 sc1
    buffer_load_dwordx4 v[60:63], v66, s[4:7], s14 offen offset:0 sc1
    s_cmp_eq_u64 vcc, 0
    s_cselect_b64 s[42:43], -1, 0
    v_add_f32_dpp v0, v0, v0 row_ror:8 row_mask:0xf bank_mask:0xf
    v_add_f32_dpp v1, v1, v1 row_ror:8 row_mask:0xf bank_mask:0xf
    s_mov_b64 exec, s[42:43]
    v_cvt_pk_bf16_f32 v72, v0, v1
    v_bfi_b32 v72, v79, s70, v72
    buffer_store_dword v72, v75, s[4:7], s17 offen offset:0 sc1
    s_mov_b64 exec, -1
    s_cbranch_scc1 cs_f1_rx
    s_sub_u32 s31, s31, 1
    s_cbranch_scc0 cs_f1_spin
cs_f1_rx:
    v_mov_b64 v[0:1], 0
    v_mov_b64 v[2:3], 0
    v_mov_b64 v[4:5], 0
    v_mov_b64 v[6:7], 0
    s_branch cs_loop
cs_f2_xt:
    s_sub_u32 s37, s37, 1
    s_nop 2
    v_mov_b32 v79, v79
    s_nop 2
    v_mov_b32 v79, v79
    s_nop 2
    v_mov_b32 v79, v79
    s_nop 2
    v_mov_b32 v79, v79
    s_nop 2
    v_mov_b32 v79, v79
    s_nop 2
    v_mov_b32 v79, v79
    s_branch cs_f2_xtx
cs_f2_retry:
    s_sub_u32 s41, s30, s98
    s_mov_b32 s98, s30
    s_cmp_le_u32 s41, 3
    s_cselect_b32 s37, 1, 1
cs_f2_spin:
    buffer_load_dwordx4 v[8:11], v65, s[4:7], s18 offen sc1
    buffer_load_dwordx4 v[12:15], v65, s[4:7], s19 offen sc1
    buffer_load_dwordx4 v[16:19], v65, s[4:7], s20 offen sc1
    buffer_load_dwordx4 v[20:23], v65, s[4:7], s21 offen sc1
    s_nop 2
    v_mov_b32 v79, v79
    s_nop 2
    v_mov_b32 v79, v79
    s_nop 2
    v_mov_b32 v79, v79
    buffer_load_dwordx4 v[40:43], v65, s[4:7], s14 offen offset:0 sc1
    buffer_load_dwordx4 v[60:63], v66, s[4:7], s14 offen offset:0 sc1
    s_waitcnt vmcnt(5)
    v_bitop3_b32 v77, v8, v10, s69 bitop3:0x7e
    v_mfma_f32_16x16x32_bf16 v[0:3], v[4:7], v[8:11], 0
    v_mov_b64 v[8:9], 0
    v_mov_b64 v[10:11], 0
    s_waitcnt vmcnt(4)
    v_bitop3_b32 v78, v12, v14, s69 bitop3:0x7e
    v_mfma_f32_16x16x32_bf16 v[0:3], v[4:7], v[12:15], v[0:3]
    v_or_b32 v77, v77, v78
    v_mov_b64 v[12:13], 0
    v_mov_b64 v[14:15], 0
    s_waitcnt vmcnt(3)
    v_bitop3_b32 v78, v16, v18, s69 bitop3:0x7e
    v_mfma_f32_16x16x32_bf16 v[0:3], v[4:7], v[16:19], v[0:3]
    v_or_b32 v77, v77, v78
    v_mov_b64 v[16:17], 0
    v_mov_b64 v[18:19], 0
    s_waitcnt vmcnt(2)
    v_bitop3_b32 v78, v20, v22, s69 bitop3:0x7e
    v_mfma_f32_16x16x32_bf16 v[0:3], v[4:7], v[20:23], v[0:3]
    v_bitop3_b32 v77, v77, v78, 1 bitop3:0xa8
    v_cmp_ne_u32 vcc, 0, v77
    v_mov_b64 v[20:21], 0
    v_mov_b64 v[22:23], 0
    buffer_load_dwordx4 v[40:43], v65, s[4:7], s14 offen offset:0 sc1
    buffer_load_dwordx4 v[60:63], v66, s[4:7], s14 offen offset:0 sc1
    s_cmp_eq_u64 vcc, 0
    s_cselect_b64 s[42:43], -1, 0
    v_add_f32_dpp v0, v0, v0 row_ror:4 row_mask:0xf bank_mask:0xf
    v_add_f32_dpp v1, v1, v1 row_ror:4 row_mask:0xf bank_mask:0xf
    s_nop 0
    v_add_f32_dpp v0, v0, v0 row_ror:8 row_mask:0xf bank_mask:0xf
    v_add_f32_dpp v1, v1, v1 row_ror:8 row_mask:0xf bank_mask:0xf
    s_mov_b64 exec, s[42:43]
    v_cvt_pk_bf16_f32 v72, v0, v1
    v_bfi_b32 v72, v79, s70, v72
    buffer_store_dword v72, v75, s[4:7], s17 offen offset:0 sc1
    buffer_store_dword v72, v75, s[4:7], s17 offen offset:1024 sc1
    buffer_store_dword v72, v75, s[4:7], s17 offen offset:2048 sc1
    buffer_store_dword v72, v75, s[4:7], s17 offen offset:3072 sc1
    s_mov_b64 exec, -1
    s_cbranch_scc1 cs_f2_rx
    s_sub_u32 s31, s31, 1
    s_cbranch_scc0 cs_f2_spin
cs_f2_rx:
    v_mov_b64 v[0:1], 0
    v_mov_b64 v[2:3], 0
    v_mov_b64 v[4:5], 0
    v_mov_b64 v[6:7], 0
    s_branch cs_loop
cs_spinB:
    s_waitcnt vmcnt(3)
cs_spinB_l:
    v_and_b32 v77, s36, v44
    v_cmp_ne_u32 vcc, s70, v77
    s_cbranch_vccz cs_spinB_x
    buffer_load_dwordx4 v[44:47], v65, s[4:7], s15 offen sc1
    s_sub_u32 s31, s31, 16
    s_waitcnt vmcnt(0)
    s_cbranch_scc0 cs_spinB_l
cs_spinB_x:
    ds_write_b128 v65, v[44:47] offset:4096
    s_waitcnt lgkmcnt(0)
    s_branch cs_backB
cs_spin8:
    buffer_load_dwordx4 v[40:43], v65, s[4:7], s16 offen sc1
cs_spin8_l:
    v_and_b32 v77, s36, v40
    v_cmp_ne_u32 vcc, s70, v77
    s_cbranch_vccz cs_spin8_x
    s_nop 15
    s_nop 15
    s_nop 15
    s_nop 11
    v_and_b32 v77, s36, v40
    v_cmp_ne_u32 vcc, s70, v77
    s_cbranch_vccz cs_spin8_x
    s_nop 15
    s_nop 15
    s_nop 15
    s_nop 11
    v_and_b32 v77, s36, v40
    v_cmp_ne_u32 vcc, s70, v77
    s_cbranch_vccz cs_spin8_x
    s_nop 15
    s_nop 15
    s_nop 15
    s_nop 11
    buffer_load_dwordx4 v[40:43], v65, s[4:7], s16 offen sc1
    s_sub_u32 s31, s31, 16
    s_cbranch_scc0 cs_spin8_l
cs_spin8_x:
    s_branch cs_back8
cs_rare:
    s_mov_b64 exec, s[34:35]
    buffer_store_dwordx4 v[0:3], v65, s[4:7], s28 offen sc1
    s_mov_b64 exec, -1
    s_nop 3
    v_cvt_pk_bf16_f32 v52, v16, v17
    v_cvt_pk_bf16_f32 v53, v18, v19
    v_cvt_pk_bf16_f32 v54, v20, v21
    v_cvt_pk_bf16_f32 v55, v22, v23
    buffer_store_dwordx4 v[52:55], v65, s[4:7], s27 offen sc1
    s_add_u32 s28, s28, 131072
    s_add_u32 s27, s27, 131072
    s_cmp_eq_u32 s30, 63
    s_cbranch_scc1 cs_last
    s_branch cs_rare_x
cs_kvwait:
    s_mov_b32 s41, s97
    v_bfe_u32 v78, v65, 2, 5
    v_mov_b32 v77, v76
    s_nop 1
    v_permlane32_swap_b32 v76, v77
    v_subrev_u32 v77, s95, v77
    v_cmp_lt_u32 vcc, 16, v77
    s_nop 1
    v_cndmask_b32 v77, v77, 0, vcc
    v_bfe_u32 v79, v78, 2, 2
    v_lshl_add_u32 v77, v77, 2, v79
    s_nop 1
    v_min_u32_dpp v77, v77, v77 row_ror:1 row_mask:0xf bank_mask:0xf
    s_nop 1
    v_min_u32_dpp v77, v77, v77 row_ror:2 row_mask:0xf bank_mask:0xf
    s_nop 1
    v_min_u32_dpp v77, v77, v77 row_ror:4 row_mask:0xf bank_mask:0xf
    s_nop 0
    v_readfirstlane_b32 s97, v77
    s_nop 0
    s_max_u32 s97, s97, s41
    s_add_u32 s40, s30, 3
    s_min_u32 s40, s40, 64
    s_cmp_le_u32 s40, s97
    s_cbranch_scc1 cs_kvw_x
    v_bfe_u32 v78, v65, 2, 5
    s_mov_b32 s31, 4194304
cs_kvw:
    buffer_load_dword v77, v78, s[4:7], s96 offen offset:16 sc1
    s_waitcnt vmcnt(0)
    v_subrev_u32 v77, s95, v77
    v_cmp_lt_u32 vcc, 16, v77
    s_nop 1
    v_cndmask_b32 v77, v77, 0, vcc
    v_bfe_u32 v79, v78, 2, 2
    v_lshl_add_u32 v77, v77, 2, v79
    s_nop 1
    v_min_u32_dpp v77, v77, v77 row_ror:1 row_mask:0xf bank_mask:0xf
    s_nop 1
    v_min_u32_dpp v77, v77, v77 row_ror:2 row_mask:0xf bank_mask:0xf
    s_nop 1
    v_min_u32_dpp v77, v77, v77 row_ror:4 row_mask:0xf bank_mask:0xf
    s_nop 0
    v_readfirstlane_b32 s97, v77
    s_sub_u32 s31, s31, 1
    s_cbranch_scc1 cs_kvw_x
    s_cmp_le_u32 s40, s97
    s_cbranch_scc1 cs_kvw_x
    s_sleep 2
    s_branch cs_kvw
cs_kvw_x:
    s_branch cs_kvok
cs_last:
    s_add_u32 s40, s95, 64
    v_mov_b32 v78, s40
    s_waitcnt vmcnt(0)
    s_barrier
    s_mov_b64 exec, s[100:101]
    buffer_store_dword v78, off, s[4:7], s29 sc1
    s_mov_b64 exec, -1
cs_end:
    s_endpgm
L_xform:
    v_and_b32 v1, 63, v0
    v_and_b32 v2, 15, v1
    v_lshrrev_b32 v3, 4, v1
    v_mov_b32 v7, 0x05040100
    v_mov_b32 v8, 0x07060302
    v_lshrrev_b32 v9, 6, v0
    v_lshlrev_b32 v9, 14, v9
    v_lshlrev_b32 v10, 4, v1
    v_add_u32 v11, v9, v10
    s_mov_b32 s10, 4718592
    s_mov_b32 s11, 0x20000
    s_mov_b64 s[8:9], s[58:59]
xf_f:
    s_sub_u32 s17, s16, 1504
    s_and_b32 s18, s17, 127
    s_lshr_b32 s17, s17, 7
    s_lshl_b32 s19, s17, 4
    v_add_u32 v6, s19, v2
    v_mul_u32_u24 v4, 9216, v3
    v_lshl_add_u32 v4, v6, 4, v4
    v_lshrrev_b32 v5, 2, v2
    v_lshlrev_b32 v5, 11, v5
    v_lshl_add_u32 v5, v3, 8, v5
    v_and_b32 v1, 3, v6
    v_lshl_add_u32 v5, v1, 6, v5
    v_add_u32 v5, v5, v9
    v_cmp_gt_u32 vcc, 72, v6
    s_nop 0
    s_mov_b64 exec, vcc
    s_mul_i32 s20, s18, 36864
    s_add_u32 s21, s20, 0
    buffer_load_dwordx4 v[12:15], v4, s[8:11], s21 offen
    s_add_u32 s21, s20, 1152
    buffer_load_dwordx4 v[16:19], v4, s[8:11], s21 offen
    s_add_u32 s21, s20, 2304
    buffer_load_dwordx4 v[20:23], v4, s[8:11], s21 offen
    s_add_u32 s21, s20, 3456
    buffer_load_dwordx4 v[24:27], v4, s[8:11], s21 offen
    s_add_u32 s21, s20, 4608
    buffer_load_dwordx4 v[28:31], v4, s[8:11], s21 offen
    s_add_u32 s21, s20, 5760
    buffer_load_dwordx4 v[32:35], v4, s[8:11], s21 offen
    s_add_u32 s21, s20, 6912
    buffer_load_dwordx4 v[36:39], v4, s[8:11], s21 offen
    s_add_u32 s21, s20, 8064
    buffer_load_dwordx4 v[40:43], v4, s[8:11], s21 offen
    s_lshl_b32 s20, s18, 11
    s_add_u32 s20, s20, 130023424
    s_waitcnt vmcnt(0)
    v_perm_b32 v76, v16, v12, v7
    v_perm_b32 v77, v24, v20, v7
    v_perm_b32 v78, v32, v28, v7
    v_perm_b32 v79, v40, v36, v7
    ds_write_b128 v5, v[76:79] offset:0
    v_perm_b32 v80, v17, v13, v7
    v_perm_b32 v81, v25, v21, v7
    v_perm_b32 v82, v33, v29, v7
    v_perm_b32 v83, v41, v37, v7
    ds_write_b128 v5, v[80:83] offset:16
    v_perm_b32 v84, v18, v14, v7
    v_perm_b32 v85, v26, v22, v7
    v_perm_b32 v86, v34, v30, v7
    v_perm_b32 v87, v42, v38, v7
    ds_write_b128 v5, v[84:87] offset:32
    v_perm_b32 v88, v19, v15, v7
    v_perm_b32 v89, v27, v23, v7
    v_perm_b32 v90, v35, v31, v7
    v_perm_b32 v91, v43, v39, v7
    ds_write_b128 v5, v[88:91] offset:48
    v_perm_b32 v92, v16, v12, v8
    v_perm_b32 v93, v24, v20, v8
    v_perm_b32 v94, v32, v28, v8
    v_perm_b32 v95, v40, v36, v8
    ds_write_b128 v5, v[92:95] offset:1024
    v_perm_b32 v96, v17, v13, v8
    v_perm_b32 v97, v25, v21, v8
    v_perm_b32 v98, v33, v29, v8
    v_perm_b32 v99, v41, v37, v8
    ds_write_b128 v5, v[96:99] offset:1040
    v_perm_b32 v100, v18, v14, v8
    v_perm_b32 v101, v26, v22, v8
    v_perm_b32 v102, v34, v30, v8
    v_perm_b32 v103, v42, v38, v8
    ds_write_b128 v5, v[100:103] offset:1056
    v_perm_b32 v104, v19, v15, v8
    v_perm_b32 v105, v27, v23, v8
    v_perm_b32 v106, v35, v31, v8
    v_perm_b32 v107, v43, v39, v8
    ds_write_b128 v5, v[104:107] offset:1072
    s_mov_b64 exec, -1
    s_lshl_b32 s21, s17, 20
    s_add_u32 s20, s20, s21
    s_waitcnt lgkmcnt(0)
    ds_read_b128 v[76:79], v11 offset:0
    ds_read_b128 v[80:83], v11 offset:1024
    ds_read_b128 v[84:87], v11 offset:2048
    ds_read_b128 v[88:91], v11 offset:3072
    ds_read_b128 v[92:95], v11 offset:4096
    ds_read_b128 v[96:99], v11 offset:5120
    ds_read_b128 v[100:103], v11 offset:6144
    ds_read_b128 v[104:107], v11 offset:7168
    s_add_u32 s19, s20, 0
    s_waitcnt lgkmcnt(7)
    buffer_store_dwordx4 v[76:79], v10, s[4:7], s19 offen sc1
    s_add_u32 s19, s20, 1024
    s_waitcnt lgkmcnt(6)
    buffer_store_dwordx4 v[80:83], v10, s[4:7], s19 offen sc1
    s_add_u32 s19, s20, 262144
    s_waitcnt lgkmcnt(5)
    buffer_store_dwordx4 v[84:87], v10, s[4:7], s19 offen sc1
    s_add_u32 s19, s20, 263168
    s_waitcnt lgkmcnt(4)
    buffer_store_dwordx4 v[88:91], v10, s[4:7], s19 offen sc1
    s_add_u32 s19, s20, 524288
    s_waitcnt lgkmcnt(3)
    buffer_store_dwordx4 v[92:95], v10, s[4:7], s19 offen sc1
    s_add_u32 s19, s20, 525312
    s_waitcnt lgkmcnt(2)
    buffer_store_dwordx4 v[96:99], v10, s[4:7], s19 offen sc1
    s_add_u32 s19, s20, 786432
    s_waitcnt lgkmcnt(1)
    buffer_store_dwordx4 v[100:103], v10, s[4:7], s19 offen sc1
    s_add_u32 s19, s20, 787456
    s_waitcnt lgkmcnt(0)
    buffer_store_dwordx4 v[104:107], v10, s[4:7], s19 offen sc1
xf_done:
    s_nop 1
    s_setpc_b64 s[46:47]
L_helper:
    s_load_dwordx16 s[64:79], s[0:1], 64
    s_waitcnt lgkmcnt(0)
    s_mov_b32 s93, 1000
    s_mov_b32 s95, 0
    s_cmp_lg_u32 s3, 2
    s_cbranch_scc1 L_qkv_next
    s_mov_b32 s37, 24
    v_mov_b32 v250, 1
    v_mov_b32 v251, 163832
    v_cmp_eq_u32 vcc, 0, v0
    s_nop 0
    s_and_saveexec_b64 s[38:39], vcc
    s_cbranch_execz tk3
    buffer_atomic_add v250, off, s[84:87], s37 sc0
    s_waitcnt vmcnt(0)
    ds_write_b32 v251, v250
    s_waitcnt lgkmcnt(0)
tk3:
    s_mov_b64 exec, -1
    s_barrier
    ds_read_b32 v252, v251
    s_waitcnt lgkmcnt(0)
    v_readfirstlane_b32 s36, v252
    s_barrier
    s_nop 3
    s_cmp_ge_u32 s36, 32
    s_cbranch_scc1 L_qkv_next
    s_mov_b32 s93, 0
    s_mov_b32 s88, 4194304
gn4:
    buffer_load_dword v250, off, s[84:87], 0 offset:216 sc1
    s_waitcnt vmcnt(0)
    v_readfirstlane_b32 s95, v250
    s_sub_u32 s88, s88, 1
    s_cbranch_scc1 gn4x
    s_cmp_eq_u32 s95, 0
    s_cbranch_scc1 gn4
gn4x:
    s_cmp_eq_u32 s36, 0
    s_cbranch_scc1 L_relay
    s_branch L_wf_next
L_qkv_next:
    s_mov_b32 s37, 4
    v_mov_b32 v250, 1
    v_mov_b32 v251, 163832
    v_cmp_eq_u32 vcc, 0, v0
    s_nop 0
    s_and_saveexec_b64 s[38:39], vcc
    s_cbranch_execz tk5
    buffer_atomic_add v250, off, s[84:87], s37 sc0
    s_waitcnt vmcnt(0)
    ds_write_b32 v251, v250
    s_waitcnt lgkmcnt(0)
tk5:
    s_mov_b64 exec, -1
    s_barrier
    ds_read_b32 v252, v251
    s_waitcnt lgkmcnt(0)
    v_readfirstlane_b32 s36, v252
    s_barrier
    s_nop 3
    s_or_b32 s37, s36, s32
    s_cbranch_scc1 L_non
    s_memrealtime s[90:91]
    s_waitcnt lgkmcnt(0)
    s_lshl_b32 s90, s90, 8
    s_or_b32 s90, s90, 1
    v_mov_b32 v250, s90
    s_mov_b64 exec, 1
    buffer_store_dword v250, off, s[84:87], 0 offset:216 sc1
    s_mov_b64 exec, -1
L_non:
    s_cmp_lt_u32 s36, 192
    s_cbranch_scc1 L_qkv
    s_cmp_lg_u32 s95, 0
    s_cbranch_scc1 L_hn
    s_mov_b32 s88, 4194304
gn6:
    buffer_load_dword v250, off, s[84:87], 0 offset:216 sc1
    s_waitcnt vmcnt(0)
    v_readfirstlane_b32 s95, v250
    s_sub_u32 s88, s88, 1
    s_cbranch_scc1 gn6x
    s_cmp_eq_u32 s95, 0
    s_cbranch_scc1 gn6
gn6x:
L_hn:
    s_sub_u32 s45, s36, 192
    s_cmp_lg_u32 s36, 192
    s_cbranch_scc1 L_phase2
    s_mov_b32 s37, 24
    v_mov_b32 v250, 1
    v_mov_b32 v251, 163832
    v_cmp_eq_u32 vcc, 0, v0
    s_nop 0
    s_and_saveexec_b64 s[38:39], vcc
    s_cbranch_execz tk7
    buffer_atomic_add v250, off, s[84:87], s37 sc0
    s_waitcnt vmcnt(0)
    ds_write_b32 v251, v250
    s_waitcnt lgkmcnt(0)
tk7:
    s_mov_b64 exec, -1
    s_barrier
    ds_read_b32 v252, v251
    s_waitcnt lgkmcnt(0)
    v_readfirstlane_b32 s36, v252
    s_barrier
    s_nop 3
    s_cmp_lg_u32 s36, 0
    s_cbranch_scc1 L_phase2
L_relay:
    s_cmp_lg_u32 s32, 0
    s_cbranch_scc1 L_exit
    v_and_b32 v3, 31, v0
    v_lshlrev_b32 v3, 7, v3
    s_mov_b32 s17, 0
    s_mov_b32 s23, 125845504
    s_mov_b32 s24, 125853696
    s_mov_b32 s21, 16777216
rl_rwait:
    buffer_load_dword v4, v3, s[4:7], s23 offen sc1
    s_waitcnt vmcnt(0)
    v_subrev_u32 v4, s95, v4
    v_cmp_lt_u32 vcc, 64, v4
    s_nop 1
    v_cndmask_b32 v4, v4, 0, vcc
    s_nop 1
    v_min_u32_dpp v4, v4, v4 row_ror:1 row_mask:0xf bank_mask:0xf
    s_nop 1
    v_min_u32_dpp v4, v4, v4 row_ror:2 row_mask:0xf bank_mask:0xf
    s_nop 1
    v_min_u32_dpp v4, v4, v4 row_ror:4 row_mask:0xf bank_mask:0xf
    s_nop 1
    v_min_u32_dpp v4, v4, v4 row_ror:8 row_mask:0xf bank_mask:0xf
    s_nop 0
    v_readlane_b32 s16, v4, 0
    v_readlane_b32 s22, v4, 16
    s_nop 0
    s_min_u32 s16, s16, s22
    s_sub_u32 s21, s21, 1
    s_cbranch_scc1 rl_x
    s_cmp_gt_u32 s16, s17
    s_cbranch_scc1 rl_rpub
    s_sleep 2
    s_branch rl_rwait
rl_rpub:
    s_mov_b32 s17, s16
    s_add_u32 s22, s16, s95
    v_mov_b32 v4, s22
    s_mov_b64 exec, 1
    buffer_store_dword v4, off, s[4:7], s24 sc1
    s_mov_b64 exec, -1
    s_cmp_lt_u32 s16, 64
    s_cbranch_scc1 rl_rwait
rl_x:
    s_endpgm
L_qkv:
    s_sub_u32 s33, s36, 32
    s_and_b32 s17, s36, 15
    s_lshl_b32 s17, s17, 1
    s_lshr_b32 s36, s36, 4
    s_and_b32 s16, s36, 1
    s_add_u32 s16, s16, 1
    s_lshr_b32 s19, s36, 1
    s_and_b32 s37, s36, 3
    s_cmp_ge_u32 s36, 8
    s_cselect_b32 s16, 0, s16
    s_cselect_b32 s19, s37, s19
    v_lshrrev_b32 v4, 6, v0
    s_nop 0
    v_readfirstlane_b32 s18, v4
    v_lshlrev_b32 v7, 4, v0
    s_cmp_eq_u32 s16, 1
    s_cselect_b64 s[12:13], s[54:55], s[52:53]
    s_cmp_eq_u32 s16, 2
    s_cselect_b64 s[12:13], s[56:57], s[12:13]
    s_mov_b32 s14, 4718592
    s_mov_b32 s15, 0x20000
    v_bfe_u32 v4, v0, 5, 1
    v_lshlrev_b32 v5, 2, v4
    v_and_b32 v8, 31, v0
    v_xor_b32 v8, v8, v5
    v_lshlrev_b32 v8, 4, v8
    v_lshl_add_u32 v8, v4, 13, v8
    v_xor_b32 v9, 128, v8
    s_lshl_b32 s21, s17, 8
    s_lshl_b32 s42, s18, 16
    s_add_u32 s42, s42, s21
    s_lshl_b32 s44, s18, 12
    s_barrier
    s_add_u32 m0, s44, 73728
    s_add_u32 s22, s42, 0
    buffer_load_dwordx4 v8, s[12:15], s22 offen offset:0 lds
    s_add_u32 s22, s42, 15360
    buffer_load_dwordx4 v9, s[12:15], s22 offen offset:1024 lds
    s_add_u32 s22, s42, 30720
    buffer_load_dwordx4 v8, s[12:15], s22 offen offset:2048 lds
    s_add_u32 s22, s42, 46080
    buffer_load_dwordx4 v9, s[12:15], s22 offen offset:3072 lds
    s_add_u32 m0, s44, 90112
    s_add_u32 s22, s42, 262144
    buffer_load_dwordx4 v8, s[12:15], s22 offen offset:0 lds
    s_add_u32 s22, s42, 277504
    buffer_load_dwordx4 v9, s[12:15], s22 offen offset:1024 lds
    s_add_u32 s22, s42, 292864
    buffer_load_dwordx4 v8, s[12:15], s22 offen offset:2048 lds
    s_add_u32 s22, s42, 308224
    buffer_load_dwordx4 v9, s[12:15], s22 offen offset:3072 lds
    s_add_u32 m0, s44, 106496
    s_add_u32 s22, s42, 524288
    buffer_load_dwordx4 v8, s[12:15], s22 offen offset:0 lds
    s_add_u32 s22, s42, 539648
    buffer_load_dwordx4 v9, s[12:15], s22 offen offset:1024 lds
    s_add_u32 s22, s42, 555008
    buffer_load_dwordx4 v8, s[12:15], s22 offen offset:2048 lds
    s_add_u32 s22, s42, 570368
    buffer_load_dwordx4 v9, s[12:15], s22 offen offset:3072 lds
    s_add_u32 m0, s44, 122880
    s_add_u32 s22, s42, 786432
    buffer_load_dwordx4 v8, s[12:15], s22 offen offset:0 lds
    s_add_u32 s22, s42, 801792
    buffer_load_dwordx4 v9, s[12:15], s22 offen offset:1024 lds
    s_add_u32 s22, s42, 817152
    buffer_load_dwordx4 v8, s[12:15], s22 offen offset:2048 lds
    s_add_u32 s22, s42, 832512
    buffer_load_dwordx4 v9, s[12:15], s22 offen offset:3072 lds
    v_bfe_u32 v4, v0, 2, 2
    v_xor_b32 v5, s18, v4
    v_lshlrev_b32 v10, 6, v5
    v_lshl_add_u32 v10, v4, 9, v10
    v_and_b32 v4, 3, v0
    v_lshl_add_u32 v10, v4, 4, v10
    v_bfe_u32 v4, v0, 4, 2
    v_lshl_add_u32 v10, v4, 12, v10
    v_add_u32 v10, 73728, v10
    v_add_u32 v11, 49152, v10
    v_and_b32 v4, 63, v0
    v_and_b32 v5, 15, v4
    v_lshrrev_b32 v3, 4, v4
    v_lshrrev_b32 v2, 2, v5
    v_xor_b32 v3, v3, v2
    v_lshl_add_u32 v3, v5, 2, v3
    v_lshlrev_b32 v1, 4, v3
    v_lshrrev_b32 v5, 2, v4
    v_lshrrev_b32 v3, 4, v4
    v_and_b32 v4, 3, v4
    v_xor_b32 v4, v4, v3
    v_lshlrev_b32 v3, 3, v3
    v_and_b32 v5, 3, v5
    v_add_u32 v3, v3, v5
    v_mul_u32_u24 v2, 1152, v3
    v_lshl_add_u32 v2, v4, 4, v2
    s_mov_b32 s8, s48
    s_mov_b32 s9, s49
    s_mov_b32 s10, 2359296
    s_mov_b32 s11, 0x20000
    s_lshr_b32 s22, s18, 1
    s_mul_i32 s24, s22, 4608
    s_mul_i32 s25, s22, 18432
    s_and_b32 s22, s18, 1
    s_mul_i32 s23, s22, 576
    s_add_u32 s24, s24, s23
    s_mul_i32 s25, s18, 9216
    s_mul_i32 s22, s19, 36864
    s_add_u32 s24, s24, s22
    s_mov_b32 s20, 64
    s_lshl_b32 s22, s19, 5
    s_add_u32 s22, s22, s17
    s_lshl_b32 s26, s22, 14
    s_mul_i32 s23, s18, 3072
    s_add_u32 s26, s26, s23
    s_lshl_b32 s23, s16, 11
    s_add_u32 s26, s26, s23
    s_add_u32 s26, s26, -2048
    s_lshl_b32 s22, s22, 13
    s_add_u32 s22, s22, 33554432
    s_cmp_eq_u32 s16, 0
    s_cselect_b32 s26, s22, s26
    s_cselect_b32 s40, 4096, 64
    s_cselect_b32 s41, 1, 2
    s_max_u32 s40, s40, 1024
    s_lshl_b32 s41, s41, 18
    s_lshl_b32 s29, s17, 7
    s_lshl_b32 s22, s16, 4
    s_add_u32 s29, s29, s22
    s_lshl_b32 s22, s19, 2
    s_add_u32 s29, s29, s22
    s_add_u32 s29, s29, 125829120
    s_mov_b32 s27, 0
    s_add_u32 s23, s27, s25
    s_add_u32 m0, s23, 0
    s_nop 0
    buffer_load_dwordx4 v2, s[8:11], s24 offen offset:0 lds
    s_add_u32 m0, s23, 960
    s_nop 0
    buffer_load_dwordx4 v2, s[8:11], s24 offen offset:64 lds
    s_add_u32 m0, s23, 1920
    s_nop 0
    buffer_load_dwordx4 v2, s[8:11], s24 offen offset:128 lds
    s_add_u32 m0, s23, 2880
    s_nop 0
    buffer_load_dwordx4 v2, s[8:11], s24 offen offset:192 lds
    s_add_u32 m0, s23, 3840
    s_nop 0
    buffer_load_dwordx4 v2, s[8:11], s24 offen offset:256 lds
    s_add_u32 m0, s23, 4800
    s_nop 0
    buffer_load_dwordx4 v2, s[8:11], s24 offen offset:320 lds
    s_add_u32 m0, s23, 5760
    s_nop 0
    buffer_load_dwordx4 v2, s[8:11], s24 offen offset:384 lds
    s_add_u32 m0, s23, 6720
    s_nop 0
    buffer_load_dwordx4 v2, s[8:11], s24 offen offset:448 lds
    s_add_u32 m0, s23, 7680
    s_nop 0
    buffer_load_dwordx4 v2, s[8:11], s24 offen offset:512 lds
    s_add_u32 s24, s24, 147456
    s_waitcnt vmcnt(21) lgkmcnt(0)
    s_barrier
    s_add_u32 m0, s44, 139264
    s_add_u32 s22, s42, 1048576
    buffer_load_dwordx4 v8, s[12:15], s22 offen offset:0 lds
    s_add_u32 s22, s42, 1063936
    buffer_load_dwordx4 v9, s[12:15], s22 offen offset:1024 lds
    s_add_u32 s22, s42, 1079296
    buffer_load_dwordx4 v8, s[12:15], s22 offen offset:2048 lds
    s_add_u32 s22, s42, 1094656
    buffer_load_dwordx4 v9, s[12:15], s22 offen offset:3072 lds
    ds_read_b64_tr_b16 v[64:65], v10 offset:0
    ds_read_b64_tr_b16 v[66:67], v10 offset:2048
    ds_read_b64_tr_b16 v[136:137], v10 offset:8
    ds_read_b64_tr_b16 v[138:139], v10 offset:2056
    ds_read_b64_tr_b16 a[0:1], v10 offset:256
    ds_read_b64_tr_b16 a[2:3], v10 offset:2304
    ds_read_b64_tr_b16 a[72:73], v10 offset:264
    ds_read_b64_tr_b16 a[74:75], v10 offset:2312
    s_waitcnt vmcnt(21) lgkmcnt(0)
    s_barrier
    s_add_u32 m0, s44, 73728
    s_add_u32 s22, s42, 1310720
    buffer_load_dwordx4 v8, s[12:15], s22 offen offset:0 lds
    s_add_u32 s22, s42, 1326080
    buffer_load_dwordx4 v9, s[12:15], s22 offen offset:1024 lds
    s_add_u32 s22, s42, 1341440
    buffer_load_dwordx4 v8, s[12:15], s22 offen offset:2048 lds
    s_add_u32 s22, s42, 1356800
    buffer_load_dwordx4 v9, s[12:15], s22 offen offset:3072 lds
    ds_read_b64_tr_b16 v[68:69], v10 offset:16384
    ds_read_b64_tr_b16 v[70:71], v10 offset:18432
    ds_read_b64_tr_b16 v[140:141], v10 offset:16392
    ds_read_b64_tr_b16 v[142:143], v10 offset:18440
    ds_read_b64_tr_b16 a[4:5], v10 offset:16640
    ds_read_b64_tr_b16 a[6:7], v10 offset:18688
    ds_read_b64_tr_b16 a[76:77], v10 offset:16648
    ds_read_b64_tr_b16 a[78:79], v10 offset:18696
    s_waitcnt vmcnt(21) lgkmcnt(0)
    s_barrier
    s_add_u32 m0, s44, 90112
    s_add_u32 s22, s42, 1572864
    buffer_load_dwordx4 v8, s[12:15], s22 offen offset:0 lds
    s_add_u32 s22, s42, 1588224
    buffer_load_dwordx4 v9, s[12:15], s22 offen offset:1024 lds
    s_add_u32 s22, s42, 1603584
    buffer_load_dwordx4 v8, s[12:15], s22 offen offset:2048 lds
    s_add_u32 s22, s42, 1618944
    buffer_load_dwordx4 v9, s[12:15], s22 offen offset:3072 lds
    ds_read_b64_tr_b16 v[72:73], v10 offset:32768
    ds_read_b64_tr_b16 v[74:75], v10 offset:34816
    ds_read_b64_tr_b16 v[144:145], v10 offset:32776
    ds_read_b64_tr_b16 v[146:147], v10 offset:34824
    ds_read_b64_tr_b16 a[8:9], v10 offset:33024
    ds_read_b64_tr_b16 a[10:11], v10 offset:35072
    ds_read_b64_tr_b16 a[80:81], v10 offset:33032
    ds_read_b64_tr_b16 a[82:83], v10 offset:35080
    s_waitcnt vmcnt(21) lgkmcnt(0)
    s_barrier
    s_add_u32 m0, s44, 106496
    s_add_u32 s22, s42, 1835008
    buffer_load_dwordx4 v8, s[12:15], s22 offen offset:0 lds
    s_add_u32 s22, s42, 1850368
    buffer_load_dwordx4 v9, s[12:15], s22 offen offset:1024 lds
    s_add_u32 s22, s42, 1865728
    buffer_load_dwordx4 v8, s[12:15], s22 offen offset:2048 lds
    s_add_u32 s22, s42, 1881088
    buffer_load_dwordx4 v9, s[12:15], s22 offen offset:3072 lds
    ds_read_b64_tr_b16 v[76:77], v11 offset:0
    ds_read_b64_tr_b16 v[78:79], v11 offset:2048
    ds_read_b64_tr_b16 v[148:149], v11 offset:8
    ds_read_b64_tr_b16 v[150:151], v11 offset:2056
    ds_read_b64_tr_b16 a[12:13], v11 offset:256
    ds_read_b64_tr_b16 a[14:15], v11 offset:2304
    ds_read_b64_tr_b16 a[84:85], v11 offset:264
    ds_read_b64_tr_b16 a[86:87], v11 offset:2312
    s_waitcnt vmcnt(12) lgkmcnt(0)
    s_barrier
    s_add_u32 m0, s44, 122880
    s_add_u32 s22, s42, 2097152
    buffer_load_dwordx4 v8, s[12:15], s22 offen offset:0 lds
    s_add_u32 s22, s42, 2112512
    buffer_load_dwordx4 v9, s[12:15], s22 offen offset:1024 lds
    s_add_u32 s22, s42, 2127872
    buffer_load_dwordx4 v8, s[12:15], s22 offen offset:2048 lds
    s_add_u32 s22, s42, 2143232
    buffer_load_dwordx4 v9, s[12:15], s22 offen offset:3072 lds
    ds_read_b64_tr_b16 v[80:81], v11 offset:16384
    ds_read_b64_tr_b16 v[82:83], v11 offset:18432
    ds_read_b64_tr_b16 v[152:153], v11 offset:16392
    ds_read_b64_tr_b16 v[154:155], v11 offset:18440
    ds_read_b64_tr_b16 a[16:17], v11 offset:16640
    ds_read_b64_tr_b16 a[18:19], v11 offset:18688
    ds_read_b64_tr_b16 a[88:89], v11 offset:16648
    ds_read_b64_tr_b16 a[90:91], v11 offset:18696
    s_waitcnt vmcnt(12) lgkmcnt(0)
    s_barrier
    s_add_u32 m0, s44, 139264
    s_add_u32 s22, s42, 2359296
    buffer_load_dwordx4 v8, s[12:15], s22 offen offset:0 lds
    s_add_u32 s22, s42, 2374656
    buffer_load_dwordx4 v9, s[12:15], s22 offen offset:1024 lds
    s_add_u32 s22, s42, 2390016
    buffer_load_dwordx4 v8, s[12:15], s22 offen offset:2048 lds
    s_add_u32 s22, s42, 2405376
    buffer_load_dwordx4 v9, s[12:15], s22 offen offset:3072 lds
    ds_read_b64_tr_b16 v[84:85], v10 offset:0
    ds_read_b64_tr_b16 v[86:87], v10 offset:2048
    ds_read_b64_tr_b16 v[156:157], v10 offset:8
    ds_read_b64_tr_b16 v[158:159], v10 offset:2056
    ds_read_b64_tr_b16 a[20:21], v10 offset:256
    ds_read_b64_tr_b16 a[22:23], v10 offset:2304
    ds_read_b64_tr_b16 a[92:93], v10 offset:264
    ds_read_b64_tr_b16 a[94:95], v10 offset:2312
    s_waitcnt vmcnt(12) lgkmcnt(0)
    s_barrier
    s_add_u32 m0, s44, 73728
    s_add_u32 s22, s42, 2621440
    buffer_load_dwordx4 v8, s[12:15], s22 offen offset:0 lds
    s_add_u32 s22, s42, 2636800
    buffer_load_dwordx4 v9, s[12:15], s22 offen offset:1024 lds
    s_add_u32 s22, s42, 2652160
    buffer_load_dwordx4 v8, s[12:15], s22 offen offset:2048 lds
    s_add_u32 s22, s42, 2667520
    buffer_load_dwordx4 v9, s[12:15], s22 offen offset:3072 lds
    ds_read_b64_tr_b16 v[88:89], v10 offset:16384
    ds_read_b64_tr_b16 v[90:91], v10 offset:18432
    ds_read_b64_tr_b16 v[160:161], v10 offset:16392
    ds_read_b64_tr_b16 v[162:163], v10 offset:18440
    ds_read_b64_tr_b16 a[24:25], v10 offset:16640
    ds_read_b64_tr_b16 a[26:27], v10 offset:18688
    ds_read_b64_tr_b16 a[96:97], v10 offset:16648
    ds_read_b64_tr_b16 a[98:99], v10 offset:18696
    s_waitcnt vmcnt(12) lgkmcnt(0)
    s_barrier
    s_add_u32 m0, s44, 90112
    s_add_u32 s22, s42, 2883584
    buffer_load_dwordx4 v8, s[12:15], s22 offen offset:0 lds
    s_add_u32 s22, s42, 2898944
    buffer_load_dwordx4 v9, s[12:15], s22 offen offset:1024 lds
    s_add_u32 s22, s42, 2914304
    buffer_load_dwordx4 v8, s[12:15], s22 offen offset:2048 lds
    s_add_u32 s22, s42, 2929664
    buffer_load_dwordx4 v9, s[12:15], s22 offen offset:3072 lds
    ds_read_b64_tr_b16 v[92:93], v10 offset:32768
    ds_read_b64_tr_b16 v[94:95], v10 offset:34816
    ds_read_b64_tr_b16 v[164:165], v10 offset:32776
    ds_read_b64_tr_b16 v[166:167], v10 offset:34824
    ds_read_b64_tr_b16 a[28:29], v10 offset:33024
    ds_read_b64_tr_b16 a[30:31], v10 offset:35072
    ds_read_b64_tr_b16 a[100:101], v10 offset:33032
    ds_read_b64_tr_b16 a[102:103], v10 offset:35080
    s_waitcnt vmcnt(12) lgkmcnt(0)
    s_barrier
    s_add_u32 m0, s44, 106496
    s_add_u32 s22, s42, 3145728
    buffer_load_dwordx4 v8, s[12:15], s22 offen offset:0 lds
    s_add_u32 s22, s42, 3161088
    buffer_load_dwordx4 v9, s[12:15], s22 offen offset:1024 lds
    s_add_u32 s22, s42, 3176448
    buffer_load_dwordx4 v8, s[12:15], s22 offen offset:2048 lds
    s_add_u32 s22, s42, 3191808
    buffer_load_dwordx4 v9, s[12:15], s22 offen offset:3072 lds
    ds_read_b64_tr_b16 v[96:97], v11 offset:0
    ds_read_b64_tr_b16 v[98:99], v11 offset:2048
    ds_read_b64_tr_b16 v[168:169], v11 offset:8
    ds_read_b64_tr_b16 v[170:171], v11 offset:2056
    ds_read_b64_tr_b16 a[32:33], v11 offset:256
    ds_read_b64_tr_b16 a[34:35], v11 offset:2304
    ds_read_b64_tr_b16 a[104:105], v11 offset:264
    ds_read_b64_tr_b16 a[106:107], v11 offset:2312
    s_waitcnt vmcnt(12) lgkmcnt(0)
    s_barrier
    s_add_u32 m0, s44, 122880
    s_add_u32 s22, s42, 3407872
    buffer_load_dwordx4 v8, s[12:15], s22 offen offset:0 lds
    s_add_u32 s22, s42, 3423232
    buffer_load_dwordx4 v9, s[12:15], s22 offen offset:1024 lds
    s_add_u32 s22, s42, 3438592
    buffer_load_dwordx4 v8, s[12:15], s22 offen offset:2048 lds
    s_add_u32 s22, s42, 3453952
    buffer_load_dwordx4 v9, s[12:15], s22 offen offset:3072 lds
    ds_read_b64_tr_b16 v[100:101], v11 offset:16384
    ds_read_b64_tr_b16 v[102:103], v11 offset:18432
    ds_read_b64_tr_b16 v[172:173], v11 offset:16392
    ds_read_b64_tr_b16 v[174:175], v11 offset:18440
    ds_read_b64_tr_b16 a[36:37], v11 offset:16640
    ds_read_b64_tr_b16 a[38:39], v11 offset:18688
    ds_read_b64_tr_b16 a[108:109], v11 offset:16648
    ds_read_b64_tr_b16 a[110:111], v11 offset:18696
    s_waitcnt vmcnt(12) lgkmcnt(0)
    s_barrier
    s_add_u32 m0, s44, 139264
    s_add_u32 s22, s42, 3670016
    buffer_load_dwordx4 v8, s[12:15], s22 offen offset:0 lds
    s_add_u32 s22, s42, 3685376
    buffer_load_dwordx4 v9, s[12:15], s22 offen offset:1024 lds
    s_add_u32 s22, s42, 3700736
    buffer_load_dwordx4 v8, s[12:15], s22 offen offset:2048 lds
    s_add_u32 s22, s42, 3716096
    buffer_load_dwordx4 v9, s[12:15], s22 offen offset:3072 lds
    ds_read_b64_tr_b16 v[104:105], v10 offset:0
    ds_read_b64_tr_b16 v[106:107], v10 offset:2048
    ds_read_b64_tr_b16 v[176:177], v10 offset:8
    ds_read_b64_tr_b16 v[178:179], v10 offset:2056
    ds_read_b64_tr_b16 a[40:41], v10 offset:256
    ds_read_b64_tr_b16 a[42:43], v10 offset:2304
    ds_read_b64_tr_b16 a[112:113], v10 offset:264
    ds_read_b64_tr_b16 a[114:115], v10 offset:2312
    s_waitcnt vmcnt(12) lgkmcnt(0)
    s_barrier
    s_add_u32 m0, s44, 73728
    s_add_u32 s22, s42, 3932160
    buffer_load_dwordx4 v8, s[12:15], s22 offen offset:0 lds
    s_add_u32 s22, s42, 3947520
    buffer_load_dwordx4 v9, s[12:15], s22 offen offset:1024 lds
    s_add_u32 s22, s42, 3962880
    buffer_load_dwordx4 v8, s[12:15], s22 offen offset:2048 lds
    s_add_u32 s22, s42, 3978240
    buffer_load_dwordx4 v9, s[12:15], s22 offen offset:3072 lds
    ds_read_b64_tr_b16 v[108:109], v10 offset:16384
    ds_read_b64_tr_b16 v[110:111], v10 offset:18432
    ds_read_b64_tr_b16 v[180:181], v10 offset:16392
    ds_read_b64_tr_b16 v[182:183], v10 offset:18440
    ds_read_b64_tr_b16 a[44:45], v10 offset:16640
    ds_read_b64_tr_b16 a[46:47], v10 offset:18688
    ds_read_b64_tr_b16 a[116:117], v10 offset:16648
    ds_read_b64_tr_b16 a[118:119], v10 offset:18696
    s_waitcnt vmcnt(12) lgkmcnt(0)
    s_barrier
    s_add_u32 m0, s44, 90112
    s_add_u32 s22, s42, 4194304
    buffer_load_dwordx4 v8, s[12:15], s22 offen offset:0 lds
    s_add_u32 s22, s42, 4209664
    buffer_load_dwordx4 v9, s[12:15], s22 offen offset:1024 lds
    s_add_u32 s22, s42, 4225024
    buffer_load_dwordx4 v8, s[12:15], s22 offen offset:2048 lds
    s_add_u32 s22, s42, 4240384
    buffer_load_dwordx4 v9, s[12:15], s22 offen offset:3072 lds
    ds_read_b64_tr_b16 v[112:113], v10 offset:32768
    ds_read_b64_tr_b16 v[114:115], v10 offset:34816
    ds_read_b64_tr_b16 v[184:185], v10 offset:32776
    ds_read_b64_tr_b16 v[186:187], v10 offset:34824
    ds_read_b64_tr_b16 a[48:49], v10 offset:33024
    ds_read_b64_tr_b16 a[50:51], v10 offset:35072
    ds_read_b64_tr_b16 a[120:121], v10 offset:33032
    ds_read_b64_tr_b16 a[122:123], v10 offset:35080
    s_waitcnt vmcnt(12) lgkmcnt(0)
    s_barrier
    s_add_u32 m0, s44, 106496
    s_add_u32 s22, s42, 4456448
    buffer_load_dwordx4 v8, s[12:15], s22 offen offset:0 lds
    s_add_u32 s22, s42, 4471808
    buffer_load_dwordx4 v9, s[12:15], s22 offen offset:1024 lds
    s_add_u32 s22, s42, 4487168
    buffer_load_dwordx4 v8, s[12:15], s22 offen offset:2048 lds
    s_add_u32 s22, s42, 4502528
    buffer_load_dwordx4 v9, s[12:15], s22 offen offset:3072 lds
    ds_read_b64_tr_b16 v[116:117], v11 offset:0
    ds_read_b64_tr_b16 v[118:119], v11 offset:2048
    ds_read_b64_tr_b16 v[188:189], v11 offset:8
    ds_read_b64_tr_b16 v[190:191], v11 offset:2056
    ds_read_b64_tr_b16 a[52:53], v11 offset:256
    ds_read_b64_tr_b16 a[54:55], v11 offset:2304
    ds_read_b64_tr_b16 a[124:125], v11 offset:264
    ds_read_b64_tr_b16 a[126:127], v11 offset:2312
    s_waitcnt vmcnt(12) lgkmcnt(0)
    s_barrier
    s_mov_b32 s27, 36864
    s_add_u32 s23, s27, s25
    s_add_u32 m0, s23, 0
    s_nop 0
    buffer_load_dwordx4 v2, s[8:11], s24 offen offset:0 lds
    s_add_u32 m0, s23, 960
    s_nop 0
    buffer_load_dwordx4 v2, s[8:11], s24 offen offset:64 lds
    s_add_u32 m0, s23, 1920
    s_nop 0
    buffer_load_dwordx4 v2, s[8:11], s24 offen offset:128 lds
    s_add_u32 m0, s23, 2880
    s_nop 0
    buffer_load_dwordx4 v2, s[8:11], s24 offen offset:192 lds
    s_add_u32 m0, s23, 3840
    s_nop 0
    buffer_load_dwordx4 v2, s[8:11], s24 offen offset:256 lds
    s_add_u32 m0, s23, 4800
    s_nop 0
    buffer_load_dwordx4 v2, s[8:11], s24 offen offset:320 lds
    s_add_u32 m0, s23, 5760
    s_nop 0
    buffer_load_dwordx4 v2, s[8:11], s24 offen offset:384 lds
    s_add_u32 m0, s23, 6720
    s_nop 0
    buffer_load_dwordx4 v2, s[8:11], s24 offen offset:448 lds
    s_add_u32 m0, s23, 7680
    s_nop 0
    buffer_load_dwordx4 v2, s[8:11], s24 offen offset:512 lds
    s_add_u32 s24, s24, 147456
    ds_read_b64_tr_b16 v[120:121], v11 offset:16384
    ds_read_b64_tr_b16 v[122:123], v11 offset:18432
    ds_read_b64_tr_b16 v[192:193], v11 offset:16392
    ds_read_b64_tr_b16 v[194:195], v11 offset:18440
    ds_read_b64_tr_b16 a[56:57], v11 offset:16640
    ds_read_b64_tr_b16 a[58:59], v11 offset:18688
    ds_read_b64_tr_b16 a[128:129], v11 offset:16648
    ds_read_b64_tr_b16 a[130:131], v11 offset:18696
    s_waitcnt vmcnt(17) lgkmcnt(0)
    s_barrier
    ds_read_b64_tr_b16 v[124:125], v10 offset:0
    ds_read_b64_tr_b16 v[126:127], v10 offset:2048
    ds_read_b64_tr_b16 v[196:197], v10 offset:8
    ds_read_b64_tr_b16 v[198:199], v10 offset:2056
    ds_read_b64_tr_b16 a[60:61], v10 offset:256
    ds_read_b64_tr_b16 a[62:63], v10 offset:2304
    ds_read_b64_tr_b16 a[132:133], v10 offset:264
    ds_read_b64_tr_b16 a[134:135], v10 offset:2312
    s_waitcnt vmcnt(13) lgkmcnt(0)
    s_barrier
    ds_read_b64_tr_b16 v[128:129], v10 offset:16384
    ds_read_b64_tr_b16 v[130:131], v10 offset:18432
    ds_read_b64_tr_b16 v[200:201], v10 offset:16392
    ds_read_b64_tr_b16 v[202:203], v10 offset:18440
    ds_read_b64_tr_b16 a[64:65], v10 offset:16640
    ds_read_b64_tr_b16 a[66:67], v10 offset:18688
    ds_read_b64_tr_b16 a[136:137], v10 offset:16648
    ds_read_b64_tr_b16 a[138:139], v10 offset:18696
    s_waitcnt vmcnt(9) lgkmcnt(0)
    s_barrier
    ds_read_b64_tr_b16 v[132:133], v10 offset:32768
    ds_read_b64_tr_b16 v[134:135], v10 offset:34816
    ds_read_b64_tr_b16 v[204:205], v10 offset:32776
    ds_read_b64_tr_b16 v[206:207], v10 offset:34824
    ds_read_b64_tr_b16 a[68:69], v10 offset:33024
    ds_read_b64_tr_b16 a[70:71], v10 offset:35072
    ds_read_b64_tr_b16 a[140:141], v10 offset:33032
    ds_read_b64_tr_b16 a[142:143], v10 offset:35080
    s_mov_b32 s88, 4194304
gn8:
    buffer_load_dword v250, off, s[84:87], 0 offset:216 sc1
    s_waitcnt vmcnt(0)
    v_readfirstlane_b32 s95, v250
    s_sub_u32 s88, s88, 1
    s_cbranch_scc1 gn8x
    s_cmp_eq_u32 s95, 0
    s_cbranch_scc1 gn8
gn8x:
    s_waitcnt lgkmcnt(0)
    s_mov_b32 s45, 0
    s_mov_b32 s27, 0
    s_mov_b64 s[36:37], 0
    s_mov_b32 s12, 0
    s_mov_b32 s13, s40
    s_lshr_b32 s14, s41, 5
    s_add_u32 s15, s14, s40
    s_lshl_b32 s41, s41, 2
    s_sub_u32 s26, s26, s41
    v_mov_b32 v3, v1
    s_waitcnt vmcnt(0)
    s_barrier
    ds_read_b128 v[32:35], v3 offset:0
    ds_read_b128 v[36:39], v3 offset:18432
    ds_read_b128 v[40:43], v3 offset:1024
    ds_read_b128 v[44:47], v3 offset:19456
    s_cmp_eq_u32 s18, 0
    s_cselect_b32 s34, 1, 0
    s_mov_b32 s35, 0
    s_cmp_eq_u32 s16, 2
    s_cbranch_scc1 qk_vloop
qk_loop:
    s_barrier
    s_add_u32 s22, s27, 73728
    s_sub_u32 s21, s22, 110592
    s_cselect_b32 s22, s22, s21
    s_waitcnt lgkmcnt(2)
    v_mfma_f32_16x16x32_bf16 v[208:211], v[64:67], v[32:35], 0
    ds_read_b128 v[48:51], v3 offset:2048
    v_mfma_f32_16x16x32_bf16 v[212:215], v[136:139], v[32:35], 0
    ds_read_b128 v[52:55], v3 offset:20480
    v_mfma_f32_16x16x32_bf16 v[216:219], v[64:67], v[36:39], 0
    v_mfma_f32_16x16x32_bf16 v[220:223], v[136:139], v[36:39], 0
    v_mfma_f32_16x16x32_bf16 v[224:227], a[0:3], v[32:35], 0
    v_mfma_f32_16x16x32_bf16 v[228:231], a[72:75], v[32:35], 0
    v_mfma_f32_16x16x32_bf16 v[232:235], a[0:3], v[36:39], 0
    v_mfma_f32_16x16x32_bf16 v[236:239], a[72:75], v[36:39], 0
    s_waitcnt lgkmcnt(2)
    v_mfma_f32_16x16x32_bf16 v[208:211], v[68:71], v[40:43], v[208:211]
    ds_read_b128 v[32:35], v3 offset:3072
    v_mfma_f32_16x16x32_bf16 v[212:215], v[140:143], v[40:43], v[212:215]
    ds_read_b128 v[36:39], v3 offset:21504
    v_mfma_f32_16x16x32_bf16 v[216:219], v[68:71], v[44:47], v[216:219]
    s_add_u32 s23, s22, s25
    s_add_u32 m0, s23, 0
    s_nop 0
    buffer_load_dwordx4 v2, s[8:11], s24 offen offset:0 lds
    v_mfma_f32_16x16x32_bf16 v[220:223], v[140:143], v[44:47], v[220:223]
    v_mfma_f32_16x16x32_bf16 v[224:227], a[4:7], v[40:43], v[224:227]
    v_mfma_f32_16x16x32_bf16 v[228:231], a[76:79], v[40:43], v[228:231]
    v_mfma_f32_16x16x32_bf16 v[232:235], a[4:7], v[44:47], v[232:235]
    s_add_u32 m0, s23, 960
    s_nop 0
    buffer_load_dwordx4 v2, s[8:11], s24 offen offset:64 lds
    v_mfma_f32_16x16x32_bf16 v[236:239], a[76:79], v[44:47], v[236:239]
    s_waitcnt lgkmcnt(2)
    v_mfma_f32_16x16x32_bf16 v[208:211], v[72:75], v[48:51], v[208:211]
    ds_read_b128 v[40:43], v3 offset:4096
    v_mfma_f32_16x16x32_bf16 v[212:215], v[144:147], v[48:51], v[212:215]
    ds_read_b128 v[44:47], v3 offset:22528
    v_mfma_f32_16x16x32_bf16 v[216:219], v[72:75], v[52:55], v[216:219]
    s_add_u32 m0, s23, 1920
    s_nop 0
    buffer_load_dwordx4 v2, s[8:11], s24 offen offset:128 lds
    v_mfma_f32_16x16x32_bf16 v[220:223], v[144:147], v[52:55], v[220:223]
    v_mfma_f32_16x16x32_bf16 v[224:227], a[8:11], v[48:51], v[224:227]
    v_mfma_f32_16x16x32_bf16 v[228:231], a[80:83], v[48:51], v[228:231]
    v_mfma_f32_16x16x32_bf16 v[232:235], a[8:11], v[52:55], v[232:235]
    s_add_u32 m0, s23, 2880
    s_nop 0
    buffer_load_dwordx4 v2, s[8:11], s24 offen offset:192 lds
    v_mfma_f32_16x16x32_bf16 v[236:239], a[80:83], v[52:55], v[236:239]
    s_waitcnt lgkmcnt(2)
    v_mfma_f32_16x16x32_bf16 v[208:211], v[76:79], v[32:35], v[208:211]
    ds_read_b128 v[48:51], v3 offset:5120
    v_mfma_f32_16x16x32_bf16 v[212:215], v[148:151], v[32:35], v[212:215]
    ds_read_b128 v[52:55], v3 offset:23552
    v_mfma_f32_16x16x32_bf16 v[216:219], v[76:79], v[36:39], v[216:219]
    s_add_u32 m0, s23, 3840
    s_nop 0
    buffer_load_dwordx4 v2, s[8:11], s24 offen offset:256 lds
    v_mfma_f32_16x16x32_bf16 v[220:223], v[148:151], v[36:39], v[220:223]
    v_mfma_f32_16x16x32_bf16 v[224:227], a[12:15], v[32:35], v[224:227]
    v_mfma_f32_16x16x32_bf16 v[228:231], a[84:87], v[32:35], v[228:231]
    v_mfma_f32_16x16x32_bf16 v[232:235], a[12:15], v[36:39], v[232:235]
    s_add_u32 m0, s23, 4800
    s_nop 0
    buffer_load_dwordx4 v2, s[8:11], s24 offen offset:320 lds
    v_mfma_f32_16x16x32_bf16 v[236:239], a[84:87], v[36:39], v[236:239]
    s_waitcnt lgkmcnt(2)
    v_mfma_f32_16x16x32_bf16 v[208:211], v[80:83], v[40:43], v[208:211]
    ds_read_b128 v[32:35], v3 offset:6144
    v_mfma_f32_16x16x32_bf16 v[212:215], v[152:155], v[40:43], v[212:215]
    ds_read_b128 v[36:39], v3 offset:24576
    v_mfma_f32_16x16x32_bf16 v[216:219], v[80:83], v[44:47], v[216:219]
    s_add_u32 m0, s23, 5760
    s_nop 0
    buffer_load_dwordx4 v2, s[8:11], s24 offen offset:384 lds
    v_mfma_f32_16x16x32_bf16 v[220:223], v[152:155], v[44:47], v[220:223]
    v_mfma_f32_16x16x32_bf16 v[224:227], a[16:19], v[40:43], v[224:227]
    v_mfma_f32_16x16x32_bf16 v[228:231], a[88:91], v[40:43], v[228:231]
    v_mfma_f32_16x16x32_bf16 v[232:235], a[16:19], v[44:47], v[232:235]
    s_add_u32 m0, s23, 6720
    s_nop 0
    buffer_load_dwordx4 v2, s[8:11], s24 offen offset:448 lds
    v_mfma_f32_16x16x32_bf16 v[236:239], a[88:91], v[44:47], v[236:239]
    s_waitcnt lgkmcnt(2)
    v_mfma_f32_16x16x32_bf16 v[208:211], v[84:87], v[48:51], v[208:211]
    ds_read_b128 v[40:43], v3 offset:7168
    v_mfma_f32_16x16x32_bf16 v[212:215], v[156:159], v[48:51], v[212:215]
    ds_read_b128 v[44:47], v3 offset:25600
    v_mfma_f32_16x16x32_bf16 v[216:219], v[84:87], v[52:55], v[216:219]
    s_add_u32 m0, s23, 7680
    s_nop 0
    buffer_load_dwordx4 v2, s[8:11], s24 offen offset:512 lds
    s_add_u32 s24, s24, 147456
    v_mfma_f32_16x16x32_bf16 v[220:223], v[156:159], v[52:55], v[220:223]
    v_mfma_f32_16x16x32_bf16 v[224:227], a[20:23], v[48:51], v[224:227]
    v_mfma_f32_16x16x32_bf16 v[228:231], a[92:95], v[48:51], v[228:231]
    v_mfma_f32_16x16x32_bf16 v[232:235], a[20:23], v[52:55], v[232:235]
    v_mfma_f32_16x16x32_bf16 v[236:239], a[92:95], v[52:55], v[236:239]
    s_waitcnt lgkmcnt(2)
    v_mfma_f32_16x16x32_bf16 v[208:211], v[88:91], v[32:35], v[208:211]
    ds_read_b128 v[48:51], v3 offset:8192
    v_mfma_f32_16x16x32_bf16 v[212:215], v[160:163], v[32:35], v[212:215]
    ds_read_b128 v[52:55], v3 offset:26624
    v_mfma_f32_16x16x32_bf16 v[216:219], v[88:91], v[36:39], v[216:219]
    v_mfma_f32_16x16x32_bf16 v[220:223], v[160:163], v[36:39], v[220:223]
    v_mfma_f32_16x16x32_bf16 v[224:227], a[24:27], v[32:35], v[224:227]
    v_mfma_f32_16x16x32_bf16 v[228:231], a[96:99], v[32:35], v[228:231]
    v_mfma_f32_16x16x32_bf16 v[232:235], a[24:27], v[36:39], v[232:235]
    v_mfma_f32_16x16x32_bf16 v[236:239], a[96:99], v[36:39], v[236:239]
    s_waitcnt lgkmcnt(2)
    v_mfma_f32_16x16x32_bf16 v[208:211], v[92:95], v[40:43], v[208:211]
    ds_read_b128 v[32:35], v3 offset:9216
    v_mfma_f32_16x16x32_bf16 v[212:215], v[164:167], v[40:43], v[212:215]
    ds_read_b128 v[36:39], v3 offset:27648
    v_mfma_f32_16x16x32_bf16 v[216:219], v[92:95], v[44:47], v[216:219]
    s_add_u32 s23, s45, s95
    v_mov_b32 v4, s23
    s_mov_b64 exec, s[34:35]
    buffer_store_dword v4, off, s[4:7], s29 sc1
    buffer_store_dword v4, off, s[4:7], s29 offset:128 sc1
    s_mov_b64 exec, -1
    v_mfma_f32_16x16x32_bf16 v[220:223], v[164:167], v[44:47], v[220:223]
    v_mfma_f32_16x16x32_bf16 v[224:227], a[28:31], v[40:43], v[224:227]
    v_mfma_f32_16x16x32_bf16 v[228:231], a[100:103], v[40:43], v[228:231]
    v_mfma_f32_16x16x32_bf16 v[232:235], a[28:31], v[44:47], v[232:235]
    v_mfma_f32_16x16x32_bf16 v[236:239], a[100:103], v[44:47], v[236:239]
    s_waitcnt lgkmcnt(2)
    v_mfma_f32_16x16x32_bf16 v[208:211], v[96:99], v[48:51], v[208:211]
    ds_read_b128 v[40:43], v3 offset:10240
    v_mfma_f32_16x16x32_bf16 v[212:215], v[168:171], v[48:51], v[212:215]
    ds_read_b128 v[44:47], v3 offset:28672
    v_mfma_f32_16x16x32_bf16 v[216:219], v[96:99], v[52:55], v[216:219]
    s_cmp_lt_u32 s19, 60
    s_cbranch_scc1 lt9
    buffer_load_dwordx4 v[244:247], off, s[84:87], 0 offset:16 sc1
    buffer_load_dword v248, off, s[84:87], 0 offset:4 sc1
lt9:
    s_lshr_b32 s46, s19, 2
    s_cmp_eq_u32 s16, 0
    s_cselect_b32 s46, 0, s46
    s_cmp_lg_u32 s46, 2
    s_cbranch_scc1 lp9
    v_mov_b32 v244, -1
    v_mov_b32 v245, -1
    v_mov_b32 v246, -1
    v_mov_b32 v247, -1
    s_lshl_b32 s46, s19, 5
    s_add_u32 s46, s46, s17
    s_lshl_b32 s46, s46, 12
    s_mul_i32 s47, s16, 8388608
    s_add_u32 s46, s46, s47
    s_add_u32 s47, s46, 67108864
    buffer_store_dwordx4 v[244:247], v7, s[4:7], s47 offen sc1
    s_add_u32 s47, s46, 67112960
    buffer_store_dwordx4 v[244:247], v7, s[4:7], s47 offen sc1
    s_add_u32 s47, s46, 67633152
    buffer_store_dwordx4 v[244:247], v7, s[4:7], s47 offen sc1
    s_add_u32 s47, s46, 67637248
    buffer_store_dwordx4 v[244:247], v7, s[4:7], s47 offen sc1
lp9:
    s_lshl_b32 s46, s16, 6
    s_or_b32 s46, s46, s19
    s_or_b32 s47, s46, 1
    s_cmp_lg_u32 s47, 11
    s_cbranch_scc1 lq9
    v_mov_b32 v244, -1
    v_mov_b32 v245, -1
    v_mov_b32 v246, -1
    v_mov_b32 v247, -1
    s_lshl_b32 s46, s46, 18
    s_lshl_b32 s47, s17, 12
    s_add_u32 s46, s46, s47
    s_add_u32 s47, s46, 63963136
    buffer_store_dwordx4 v[244:247], v7, s[4:7], s47 offen sc1
    s_add_u32 s47, s46, 63967232
    buffer_store_dwordx4 v[244:247], v7, s[4:7], s47 offen sc1
    s_add_u32 s47, s46, 64094208
    buffer_store_dwordx4 v[244:247], v7, s[4:7], s47 offen sc1
    s_add_u32 s47, s46, 64098304
    buffer_store_dwordx4 v[244:247], v7, s[4:7], s47 offen sc1
lq9:
    v_mfma_f32_16x16x32_bf16 v[220:223], v[168:171], v[52:55], v[220:223]
    v_mfma_f32_16x16x32_bf16 v[224:227], a[32:35], v[48:51], v[224:227]
    v_mfma_f32_16x16x32_bf16 v[228:231], a[104:107], v[48:51], v[228:231]
    v_mfma_f32_16x16x32_bf16 v[232:235], a[32:35], v[52:55], v[232:235]
    v_mfma_f32_16x16x32_bf16 v[236:239], a[104:107], v[52:55], v[236:239]
    s_waitcnt lgkmcnt(2)
    v_mfma_f32_16x16x32_bf16 v[208:211], v[100:103], v[32:35], v[208:211]
    ds_read_b128 v[48:51], v3 offset:11264
    v_mfma_f32_16x16x32_bf16 v[212:215], v[172:175], v[32:35], v[212:215]
    ds_read_b128 v[52:55], v3 offset:29696
    v_mfma_f32_16x16x32_bf16 v[216:219], v[100:103], v[36:39], v[216:219]
    v_mfma_f32_16x16x32_bf16 v[220:223], v[172:175], v[36:39], v[220:223]
    v_mfma_f32_16x16x32_bf16 v[224:227], a[36:39], v[32:35], v[224:227]
    v_mfma_f32_16x16x32_bf16 v[228:231], a[108:111], v[32:35], v[228:231]
    v_mfma_f32_16x16x32_bf16 v[232:235], a[36:39], v[36:39], v[232:235]
    v_mfma_f32_16x16x32_bf16 v[236:239], a[108:111], v[36:39], v[236:239]
    s_waitcnt lgkmcnt(2)
    v_mfma_f32_16x16x32_bf16 v[208:211], v[104:107], v[40:43], v[208:211]
    ds_read_b128 v[32:35], v3 offset:12288
    v_mfma_f32_16x16x32_bf16 v[212:215], v[176:179], v[40:43], v[212:215]
    ds_read_b128 v[36:39], v3 offset:30720
    v_mfma_f32_16x16x32_bf16 v[216:219], v[104:107], v[44:47], v[216:219]
    v_mfma_f32_16x16x32_bf16 v[220:223], v[176:179], v[44:47], v[220:223]
    v_mfma_f32_16x16x32_bf16 v[224:227], a[40:43], v[40:43], v[224:227]
    v_mfma_f32_16x16x32_bf16 v[228:231], a[112:115], v[40:43], v[228:231]
    v_mfma_f32_16x16x32_bf16 v[232:235], a[40:43], v[44:47], v[232:235]
    v_mfma_f32_16x16x32_bf16 v[236:239], a[112:115], v[44:47], v[236:239]
    s_waitcnt lgkmcnt(2)
    v_mfma_f32_16x16x32_bf16 v[208:211], v[108:111], v[48:51], v[208:211]
    ds_read_b128 v[40:43], v3 offset:13312
    v_mfma_f32_16x16x32_bf16 v[212:215], v[180:183], v[48:51], v[212:215]
    ds_read_b128 v[44:47], v3 offset:31744
    v_mfma_f32_16x16x32_bf16 v[216:219], v[108:111], v[52:55], v[216:219]
    v_mfma_f32_16x16x32_bf16 v[220:223], v[180:183], v[52:55], v[220:223]
    v_mfma_f32_16x16x32_bf16 v[224:227], a[44:47], v[48:51], v[224:227]
    v_mfma_f32_16x16x32_bf16 v[228:231], a[116:119], v[48:51], v[228:231]
    v_mfma_f32_16x16x32_bf16 v[232:235], a[44:47], v[52:55], v[232:235]
    v_mfma_f32_16x16x32_bf16 v[236:239], a[116:119], v[52:55], v[236:239]
    s_waitcnt lgkmcnt(2)
    v_mfma_f32_16x16x32_bf16 v[208:211], v[112:115], v[32:35], v[208:211]
    ds_read_b128 v[48:51], v3 offset:14336
    v_mfma_f32_16x16x32_bf16 v[212:215], v[184:187], v[32:35], v[212:215]
    ds_read_b128 v[52:55], v3 offset:32768
    v_mfma_f32_16x16x32_bf16 v[216:219], v[112:115], v[36:39], v[216:219]
    v_mfma_f32_16x16x32_bf16 v[220:223], v[184:187], v[36:39], v[220:223]
    v_mfma_f32_16x16x32_bf16 v[224:227], a[48:51], v[32:35], v[224:227]
    v_mfma_f32_16x16x32_bf16 v[228:231], a[120:123], v[32:35], v[228:231]
    v_mfma_f32_16x16x32_bf16 v[232:235], a[48:51], v[36:39], v[232:235]
    v_mfma_f32_16x16x32_bf16 v[236:239], a[120:123], v[36:39], v[236:239]
    s_waitcnt lgkmcnt(2)
    v_mfma_f32_16x16x32_bf16 v[208:211], v[116:119], v[40:43], v[208:211]
    ds_read_b128 v[32:35], v3 offset:15360
    v_mfma_f32_16x16x32_bf16 v[212:215], v[188:191], v[40:43], v[212:215]
    ds_read_b128 v[36:39], v3 offset:33792
    v_mfma_f32_16x16x32_bf16 v[216:219], v[116:119], v[44:47], v[216:219]
    v_mfma_f32_16x16x32_bf16 v[220:223], v[188:191], v[44:47], v[220:223]
    v_mfma_f32_16x16x32_bf16 v[224:227], a[52:55], v[40:43], v[224:227]
    v_mfma_f32_16x16x32_bf16 v[228:231], a[124:127], v[40:43], v[228:231]
    v_mfma_f32_16x16x32_bf16 v[232:235], a[52:55], v[44:47], v[232:235]
    v_mfma_f32_16x16x32_bf16 v[236:239], a[124:127], v[44:47], v[236:239]
    s_waitcnt lgkmcnt(2)
    v_mfma_f32_16x16x32_bf16 v[208:211], v[120:123], v[48:51], v[208:211]
    ds_read_b128 v[40:43], v3 offset:16384
    v_mfma_f32_16x16x32_bf16 v[212:215], v[192:195], v[48:51], v[212:215]
    ds_read_b128 v[44:47], v3 offset:34816
    v_mfma_f32_16x16x32_bf16 v[216:219], v[120:123], v[52:55], v[216:219]
    v_mfma_f32_16x16x32_bf16 v[220:223], v[192:195], v[52:55], v[220:223]
    v_mfma_f32_16x16x32_bf16 v[224:227], a[56:59], v[48:51], v[224:227]
    v_mfma_f32_16x16x32_bf16 v[228:231], a[128:131], v[48:51], v[228:231]
    v_mfma_f32_16x16x32_bf16 v[232:235], a[56:59], v[52:55], v[232:235]
    v_mfma_f32_16x16x32_bf16 v[236:239], a[128:131], v[52:55], v[236:239]
    s_waitcnt lgkmcnt(2)
    v_mfma_f32_16x16x32_bf16 v[208:211], v[124:127], v[32:35], v[208:211]
    ds_read_b128 v[48:51], v3 offset:17408
    v_mfma_f32_16x16x32_bf16 v[212:215], v[196:199], v[32:35], v[212:215]
    ds_read_b128 v[52:55], v3 offset:35840
    v_mfma_f32_16x16x32_bf16 v[216:219], v[124:127], v[36:39], v[216:219]
    v_mfma_f32_16x16x32_bf16 v[220:223], v[196:199], v[36:39], v[220:223]
    v_mfma_f32_16x16x32_bf16 v[224:227], a[60:63], v[32:35], v[224:227]
    s_add_u32 s27, s27, 36864
    s_cmp_eq_u32 s27, 110592
    s_cselect_b32 s27, 0, s27
    v_add_u32 v3, s27, v1
    v_mfma_f32_16x16x32_bf16 v[228:231], a[132:135], v[32:35], v[228:231]
    v_mfma_f32_16x16x32_bf16 v[232:235], a[60:63], v[36:39], v[232:235]
    v_mfma_f32_16x16x32_bf16 v[236:239], a[132:135], v[36:39], v[236:239]
    s_waitcnt lgkmcnt(2)
    v_mfma_f32_16x16x32_bf16 v[208:211], v[128:131], v[40:43], v[208:211]
    ds_read_b128 v[32:35], v3 offset:0
    v_mfma_f32_16x16x32_bf16 v[212:215], v[200:203], v[40:43], v[212:215]
    ds_read_b128 v[36:39], v3 offset:18432
    v_mfma_f32_16x16x32_bf16 v[216:219], v[128:131], v[44:47], v[216:219]
    v_mfma_f32_16x16x32_bf16 v[220:223], v[200:203], v[44:47], v[220:223]
    v_mfma_f32_16x16x32_bf16 v[224:227], a[64:67], v[40:43], v[224:227]
    v_mfma_f32_16x16x32_bf16 v[228:231], a[136:139], v[40:43], v[228:231]
    v_mfma_f32_16x16x32_bf16 v[232:235], a[64:67], v[44:47], v[232:235]
    v_mfma_f32_16x16x32_bf16 v[236:239], a[136:139], v[44:47], v[236:239]
    s_waitcnt lgkmcnt(2)
    v_mfma_f32_16x16x32_bf16 v[208:211], v[132:135], v[48:51], v[208:211]
    ds_read_b128 v[40:43], v3 offset:1024
    v_mfma_f32_16x16x32_bf16 v[212:215], v[204:207], v[48:51], v[212:215]
    ds_read_b128 v[44:47], v3 offset:19456
    v_mfma_f32_16x16x32_bf16 v[216:219], v[132:135], v[52:55], v[216:219]
    v_mfma_f32_16x16x32_bf16 v[220:223], v[204:207], v[52:55], v[220:223]
    v_mfma_f32_16x16x32_bf16 v[224:227], a[68:71], v[48:51], v[224:227]
    v_mfma_f32_16x16x32_bf16 v[228:231], a[140:143], v[48:51], v[228:231]
    v_mfma_f32_16x16x32_bf16 v[232:235], a[68:71], v[52:55], v[232:235]
    v_mfma_f32_16x16x32_bf16 v[236:239], a[140:143], v[52:55], v[236:239]
    s_add_u32 s26, s26, s41
    s_waitcnt vmcnt(0)
    v_cvt_pk_bf16_f32 v8, v208, v209
    v_cvt_pk_bf16_f32 v9, v210, v211
    v_cvt_pk_bf16_f32 v10, v212, v213
    v_cvt_pk_bf16_f32 v11, v214, v215
    v_cvt_pk_bf16_f32 v12, v216, v217
    v_cvt_pk_bf16_f32 v13, v218, v219
    v_cvt_pk_bf16_f32 v14, v220, v221
    v_cvt_pk_bf16_f32 v15, v222, v223
    v_cvt_pk_bf16_f32 v16, v224, v225
    v_cvt_pk_bf16_f32 v17, v226, v227
    v_cvt_pk_bf16_f32 v18, v228, v229
    v_cvt_pk_bf16_f32 v19, v230, v231
    v_cvt_pk_bf16_f32 v20, v232, v233
    v_cvt_pk_bf16_f32 v21, v234, v235
    v_cvt_pk_bf16_f32 v22, v236, v237
    v_cvt_pk_bf16_f32 v23, v238, v239
    s_mov_b64 s[36:37], -1
    s_add_u32 s28, s26, s12
    buffer_store_dwordx4 v[8:11], v7, s[4:7], s28 offen sc1
    s_add_u32 s28, s26, s13
    buffer_store_dwordx4 v[12:15], v7, s[4:7], s28 offen sc1
    s_add_u32 s28, s26, s14
    buffer_store_dwordx4 v[16:19], v7, s[4:7], s28 offen sc1
    s_add_u32 s28, s26, s15
    buffer_store_dwordx4 v[20:23], v7, s[4:7], s28 offen sc1
    s_lshr_b32 s45, s19, 2
    s_cbranch_scc1 qk_loop_nf
    s_mov_b32 s45, 1
    s_mov_b64 s[36:37], 0
    s_waitcnt vmcnt(0)
    s_barrier
    s_add_u32 s23, s45, s95
    v_mov_b32 v4, s23
    s_mov_b64 exec, s[34:35]
    buffer_store_dword v4, off, s[4:7], s29 sc1
    buffer_store_dword v4, off, s[4:7], s29 offset:128 sc1
    s_mov_b64 exec, -1
qk_loop_nf:
    s_add_u32 s19, s19, 4
    s_cmp_lt_u32 s19, s20
    s_cbranch_scc1 qk_loop
    s_branch qk_done
qk_vloop:
    s_barrier
    s_add_u32 s22, s27, 73728
    s_sub_u32 s21, s22, 110592
    s_cselect_b32 s22, s22, s21
    s_waitcnt lgkmcnt(2)
    v_mfma_f32_16x16x32_bf16 v[208:211], v[32:35], v[64:67], 0
    ds_read_b128 v[48:51], v3 offset:2048
    v_mfma_f32_16x16x32_bf16 v[212:215], v[32:35], v[136:139], 0
    ds_read_b128 v[52:55], v3 offset:20480
    v_mfma_f32_16x16x32_bf16 v[216:219], v[36:39], v[64:67], 0
    v_mfma_f32_16x16x32_bf16 v[220:223], v[36:39], v[136:139], 0
    v_mfma_f32_16x16x32_bf16 v[224:227], v[32:35], a[0:3], 0
    v_mfma_f32_16x16x32_bf16 v[228:231], v[32:35], a[72:75], 0
    v_mfma_f32_16x16x32_bf16 v[232:235], v[36:39], a[0:3], 0
    v_mfma_f32_16x16x32_bf16 v[236:239], v[36:39], a[72:75], 0
    s_waitcnt lgkmcnt(2)
    v_mfma_f32_16x16x32_bf16 v[208:211], v[40:43], v[68:71], v[208:211]
    ds_read_b128 v[32:35], v3 offset:3072
    v_mfma_f32_16x16x32_bf16 v[212:215], v[40:43], v[140:143], v[212:215]
    ds_read_b128 v[36:39], v3 offset:21504
    v_mfma_f32_16x16x32_bf16 v[216:219], v[44:47], v[68:71], v[216:219]
    s_add_u32 s23, s22, s25
    s_add_u32 m0, s23, 0
    s_nop 0
    buffer_load_dwordx4 v2, s[8:11], s24 offen offset:0 lds
    v_mfma_f32_16x16x32_bf16 v[220:223], v[44:47], v[140:143], v[220:223]
    v_mfma_f32_16x16x32_bf16 v[224:227], v[40:43], a[4:7], v[224:227]
    v_mfma_f32_16x16x32_bf16 v[228:231], v[40:43], a[76:79], v[228:231]
    v_mfma_f32_16x16x32_bf16 v[232:235], v[44:47], a[4:7], v[232:235]
    s_add_u32 m0, s23, 960
    s_nop 0
    buffer_load_dwordx4 v2, s[8:11], s24 offen offset:64 lds
    v_mfma_f32_16x16x32_bf16 v[236:239], v[44:47], a[76:79], v[236:239]
    s_waitcnt lgkmcnt(2)
    v_mfma_f32_16x16x32_bf16 v[208:211], v[48:51], v[72:75], v[208:211]
    ds_read_b128 v[40:43], v3 offset:4096
    v_mfma_f32_16x16x32_bf16 v[212:215], v[48:51], v[144:147], v[212:215]
    ds_read_b128 v[44:47], v3 offset:22528
    v_mfma_f32_16x16x32_bf16 v[216:219], v[52:55], v[72:75], v[216:219]
    s_add_u32 m0, s23, 1920
    s_nop 0
    buffer_load_dwordx4 v2, s[8:11], s24 offen offset:128 lds
    v_mfma_f32_16x16x32_bf16 v[220:223], v[52:55], v[144:147], v[220:223]
    v_mfma_f32_16x16x32_bf16 v[224:227], v[48:51], a[8:11], v[224:227]
    v_mfma_f32_16x16x32_bf16 v[228:231], v[48:51], a[80:83], v[228:231]
    v_mfma_f32_16x16x32_bf16 v[232:235], v[52:55], a[8:11], v[232:235]
    s_add_u32 m0, s23, 2880
    s_nop 0
    buffer_load_dwordx4 v2, s[8:11], s24 offen offset:192 lds
    v_mfma_f32_16x16x32_bf16 v[236:239], v[52:55], a[80:83], v[236:239]
    s_waitcnt lgkmcnt(2)
    v_mfma_f32_16x16x32_bf16 v[208:211], v[32:35], v[76:79], v[208:211]
    ds_read_b128 v[48:51], v3 offset:5120
    v_mfma_f32_16x16x32_bf16 v[212:215], v[32:35], v[148:151], v[212:215]
    ds_read_b128 v[52:55], v3 offset:23552
    v_mfma_f32_16x16x32_bf16 v[216:219], v[36:39], v[76:79], v[216:219]
    s_add_u32 m0, s23, 3840
    s_nop 0
    buffer_load_dwordx4 v2, s[8:11], s24 offen offset:256 lds
    v_mfma_f32_16x16x32_bf16 v[220:223], v[36:39], v[148:151], v[220:223]
    v_mfma_f32_16x16x32_bf16 v[224:227], v[32:35], a[12:15], v[224:227]
    v_mfma_f32_16x16x32_bf16 v[228:231], v[32:35], a[84:87], v[228:231]
    v_mfma_f32_16x16x32_bf16 v[232:235], v[36:39], a[12:15], v[232:235]
    s_add_u32 m0, s23, 4800
    s_nop 0
    buffer_load_dwordx4 v2, s[8:11], s24 offen offset:320 lds
    v_mfma_f32_16x16x32_bf16 v[236:239], v[36:39], a[84:87], v[236:239]
    s_waitcnt lgkmcnt(2)
    v_mfma_f32_16x16x32_bf16 v[208:211], v[40:43], v[80:83], v[208:211]
    ds_read_b128 v[32:35], v3 offset:6144
    v_mfma_f32_16x16x32_bf16 v[212:215], v[40:43], v[152:155], v[212:215]
    ds_read_b128 v[36:39], v3 offset:24576
    v_mfma_f32_16x16x32_bf16 v[216:219], v[44:47], v[80:83], v[216:219]
    s_add_u32 m0, s23, 5760
    s_nop 0
    buffer_load_dwordx4 v2, s[8:11], s24 offen offset:384 lds
    v_mfma_f32_16x16x32_bf16 v[220:223], v[44:47], v[152:155], v[220:223]
    v_mfma_f32_16x16x32_bf16 v[224:227], v[40:43], a[16:19], v[224:227]
    v_mfma_f32_16x16x32_bf16 v[228:231], v[40:43], a[88:91], v[228:231]
    v_mfma_f32_16x16x32_bf16 v[232:235], v[44:47], a[16:19], v[232:235]
    s_add_u32 m0, s23, 6720
    s_nop 0
    buffer_load_dwordx4 v2, s[8:11], s24 offen offset:448 lds
    v_mfma_f32_16x16x32_bf16 v[236:239], v[44:47], a[88:91], v[236:239]
    s_waitcnt lgkmcnt(2)
    v_mfma_f32_16x16x32_bf16 v[208:211], v[48:51], v[84:87], v[208:211]
    ds_read_b128 v[40:43], v3 offset:7168
    v_mfma_f32_16x16x32_bf16 v[212:215], v[48:51], v[156:159], v[212:215]
    ds_read_b128 v[44:47], v3 offset:25600
    v_mfma_f32_16x16x32_bf16 v[216:219], v[52:55], v[84:87], v[216:219]
    s_add_u32 m0, s23, 7680
    s_nop 0
    buffer_load_dwordx4 v2, s[8:11], s24 offen offset:512 lds
    s_add_u32 s24, s24, 147456
    v_mfma_f32_16x16x32_bf16 v[220:223], v[52:55], v[156:159], v[220:223]
    v_mfma_f32_16x16x32_bf16 v[224:227], v[48:51], a[20:23], v[224:227]
    v_mfma_f32_16x16x32_bf16 v[228:231], v[48:51], a[92:95], v[228:231]
    v_mfma_f32_16x16x32_bf16 v[232:235], v[52:55], a[20:23], v[232:235]
    v_mfma_f32_16x16x32_bf16 v[236:239], v[52:55], a[92:95], v[236:239]
    s_waitcnt lgkmcnt(2)
    v_mfma_f32_16x16x32_bf16 v[208:211], v[32:35], v[88:91], v[208:211]
    ds_read_b128 v[48:51], v3 offset:8192
    v_mfma_f32_16x16x32_bf16 v[212:215], v[32:35], v[160:163], v[212:215]
    ds_read_b128 v[52:55], v3 offset:26624
    v_mfma_f32_16x16x32_bf16 v[216:219], v[36:39], v[88:91], v[216:219]
    v_mfma_f32_16x16x32_bf16 v[220:223], v[36:39], v[160:163], v[220:223]
    v_mfma_f32_16x16x32_bf16 v[224:227], v[32:35], a[24:27], v[224:227]
    v_mfma_f32_16x16x32_bf16 v[228:231], v[32:35], a[96:99], v[228:231]
    v_mfma_f32_16x16x32_bf16 v[232:235], v[36:39], a[24:27], v[232:235]
    v_mfma_f32_16x16x32_bf16 v[236:239], v[36:39], a[96:99], v[236:239]
    s_waitcnt lgkmcnt(2)
    v_mfma_f32_16x16x32_bf16 v[208:211], v[40:43], v[92:95], v[208:211]
    ds_read_b128 v[32:35], v3 offset:9216
    v_mfma_f32_16x16x32_bf16 v[212:215], v[40:43], v[164:167], v[212:215]
    ds_read_b128 v[36:39], v3 offset:27648
    v_mfma_f32_16x16x32_bf16 v[216:219], v[44:47], v[92:95], v[216:219]
    s_add_u32 s23, s45, s95
    v_mov_b32 v4, s23
    s_mov_b64 exec, s[34:35]
    buffer_store_dword v4, off, s[4:7], s29 sc1
    buffer_store_dword v4, off, s[4:7], s29 offset:128 sc1
    s_mov_b64 exec, -1
    v_mfma_f32_16x16x32_bf16 v[220:223], v[44:47], v[164:167], v[220:223]
    v_mfma_f32_16x16x32_bf16 v[224:227], v[40:43], a[28:31], v[224:227]
    v_mfma_f32_16x16x32_bf16 v[228:231], v[40:43], a[100:103], v[228:231]
    v_mfma_f32_16x16x32_bf16 v[232:235], v[44:47], a[28:31], v[232:235]
    v_mfma_f32_16x16x32_bf16 v[236:239], v[44:47], a[100:103], v[236:239]
    s_waitcnt lgkmcnt(2)
    v_mfma_f32_16x16x32_bf16 v[208:211], v[48:51], v[96:99], v[208:211]
    ds_read_b128 v[40:43], v3 offset:10240
    v_mfma_f32_16x16x32_bf16 v[212:215], v[48:51], v[168:171], v[212:215]
    ds_read_b128 v[44:47], v3 offset:28672
    v_mfma_f32_16x16x32_bf16 v[216:219], v[52:55], v[96:99], v[216:219]
    s_cmp_lt_u32 s19, 60
    s_cbranch_scc1 lt10
    buffer_load_dwordx4 v[244:247], off, s[84:87], 0 offset:16 sc1
    buffer_load_dword v248, off, s[84:87], 0 offset:4 sc1
lt10:
    s_lshr_b32 s46, s19, 2
    s_cmp_eq_u32 s16, 0
    s_cselect_b32 s46, 0, s46
    s_cmp_lg_u32 s46, 2
    s_cbranch_scc1 lp10
    v_mov_b32 v244, -1
    v_mov_b32 v245, -1
    v_mov_b32 v246, -1
    v_mov_b32 v247, -1
    s_lshl_b32 s46, s19, 5
    s_add_u32 s46, s46, s17
    s_lshl_b32 s46, s46, 12
    s_mul_i32 s47, s16, 8388608
    s_add_u32 s46, s46, s47
    s_add_u32 s47, s46, 67108864
    buffer_store_dwordx4 v[244:247], v7, s[4:7], s47 offen sc1
    s_add_u32 s47, s46, 67112960
    buffer_store_dwordx4 v[244:247], v7, s[4:7], s47 offen sc1
    s_add_u32 s47, s46, 67633152
    buffer_store_dwordx4 v[244:247], v7, s[4:7], s47 offen sc1
    s_add_u32 s47, s46, 67637248
    buffer_store_dwordx4 v[244:247], v7, s[4:7], s47 offen sc1
lp10:
    s_lshl_b32 s46, s16, 6
    s_or_b32 s46, s46, s19
    s_or_b32 s47, s46, 1
    s_cmp_lg_u32 s47, 11
    s_cbranch_scc1 lq10
    v_mov_b32 v244, -1
    v_mov_b32 v245, -1
    v_mov_b32 v246, -1
    v_mov_b32 v247, -1
    s_lshl_b32 s46, s46, 18
    s_lshl_b32 s47, s17, 12
    s_add_u32 s46, s46, s47
    s_add_u32 s47, s46, 63963136
    buffer_store_dwordx4 v[244:247], v7, s[4:7], s47 offen sc1
    s_add_u32 s47, s46, 63967232
    buffer_store_dwordx4 v[244:247], v7, s[4:7], s47 offen sc1
    s_add_u32 s47, s46, 64094208
    buffer_store_dwordx4 v[244:247], v7, s[4:7], s47 offen sc1
    s_add_u32 s47, s46, 64098304
    buffer_store_dwordx4 v[244:247], v7, s[4:7], s47 offen sc1
lq10:
    v_mfma_f32_16x16x32_bf16 v[220:223], v[52:55], v[168:171], v[220:223]
    v_mfma_f32_16x16x32_bf16 v[224:227], v[48:51], a[32:35], v[224:227]
    v_mfma_f32_16x16x32_bf16 v[228:231], v[48:51], a[104:107], v[228:231]
    v_mfma_f32_16x16x32_bf16 v[232:235], v[52:55], a[32:35], v[232:235]
    v_mfma_f32_16x16x32_bf16 v[236:239], v[52:55], a[104:107], v[236:239]
    s_waitcnt lgkmcnt(2)
    v_mfma_f32_16x16x32_bf16 v[208:211], v[32:35], v[100:103], v[208:211]
    ds_read_b128 v[48:51], v3 offset:11264
    v_mfma_f32_16x16x32_bf16 v[212:215], v[32:35], v[172:175], v[212:215]
    ds_read_b128 v[52:55], v3 offset:29696
    v_mfma_f32_16x16x32_bf16 v[216:219], v[36:39], v[100:103], v[216:219]
    v_mfma_f32_16x16x32_bf16 v[220:223], v[36:39], v[172:175], v[220:223]
    v_mfma_f32_16x16x32_bf16 v[224:227], v[32:35], a[36:39], v[224:227]
    v_mfma_f32_16x16x32_bf16 v[228:231], v[32:35], a[108:111], v[228:231]
    v_mfma_f32_16x16x32_bf16 v[232:235], v[36:39], a[36:39], v[232:235]
    v_mfma_f32_16x16x32_bf16 v[236:239], v[36:39], a[108:111], v[236:239]
    s_waitcnt lgkmcnt(2)
    v_mfma_f32_16x16x32_bf16 v[208:211], v[40:43], v[104:107], v[208:211]
    ds_read_b128 v[32:35], v3 offset:12288
    v_mfma_f32_16x16x32_bf16 v[212:215], v[40:43], v[176:179], v[212:215]
    ds_read_b128 v[36:39], v3 offset:30720
    v_mfma_f32_16x16x32_bf16 v[216:219], v[44:47], v[104:107], v[216:219]
    v_mfma_f32_16x16x32_bf16 v[220:223], v[44:47], v[176:179], v[220:223]
    v_mfma_f32_16x16x32_bf16 v[224:227], v[40:43], a[40:43], v[224:227]
    v_mfma_f32_16x16x32_bf16 v[228:231], v[40:43], a[112:115], v[228:231]
    v_mfma_f32_16x16x32_bf16 v[232:235], v[44:47], a[40:43], v[232:235]
    v_mfma_f32_16x16x32_bf16 v[236:239], v[44:47], a[112:115], v[236:239]
    s_waitcnt lgkmcnt(2)
    v_mfma_f32_16x16x32_bf16 v[208:211], v[48:51], v[108:111], v[208:211]
    ds_read_b128 v[40:43], v3 offset:13312
    v_mfma_f32_16x16x32_bf16 v[212:215], v[48:51], v[180:183], v[212:215]
    ds_read_b128 v[44:47], v3 offset:31744
    v_mfma_f32_16x16x32_bf16 v[216:219], v[52:55], v[108:111], v[216:219]
    v_mfma_f32_16x16x32_bf16 v[220:223], v[52:55], v[180:183], v[220:223]
    v_mfma_f32_16x16x32_bf16 v[224:227], v[48:51], a[44:47], v[224:227]
    v_mfma_f32_16x16x32_bf16 v[228:231], v[48:51], a[116:119], v[228:231]
    v_mfma_f32_16x16x32_bf16 v[232:235], v[52:55], a[44:47], v[232:235]
    v_mfma_f32_16x16x32_bf16 v[236:239], v[52:55], a[116:119], v[236:239]
    s_waitcnt lgkmcnt(2)
    v_mfma_f32_16x16x32_bf16 v[208:211], v[32:35], v[112:115], v[208:211]
    ds_read_b128 v[48:51], v3 offset:14336
    v_mfma_f32_16x16x32_bf16 v[212:215], v[32:35], v[184:187], v[212:215]
    ds_read_b128 v[52:55], v3 offset:32768
    v_mfma_f32_16x16x32_bf16 v[216:219], v[36:39], v[112:115], v[216:219]
    v_mfma_f32_16x16x32_bf16 v[220:223], v[36:39], v[184:187], v[220:223]
    v_mfma_f32_16x16x32_bf16 v[224:227], v[32:35], a[48:51], v[224:227]
    v_mfma_f32_16x16x32_bf16 v[228:231], v[32:35], a[120:123], v[228:231]
    v_mfma_f32_16x16x32_bf16 v[232:235], v[36:39], a[48:51], v[232:235]
    v_mfma_f32_16x16x32_bf16 v[236:239], v[36:39], a[120:123], v[236:239]
    s_waitcnt lgkmcnt(2)
    v_mfma_f32_16x16x32_bf16 v[208:211], v[40:43], v[116:119], v[208:211]
    ds_read_b128 v[32:35], v3 offset:15360
    v_mfma_f32_16x16x32_bf16 v[212:215], v[40:43], v[188:191], v[212:215]
    ds_read_b128 v[36:39], v3 offset:33792
    v_mfma_f32_16x16x32_bf16 v[216:219], v[44:47], v[116:119], v[216:219]
    v_mfma_f32_16x16x32_bf16 v[220:223], v[44:47], v[188:191], v[220:223]
    v_mfma_f32_16x16x32_bf16 v[224:227], v[40:43], a[52:55], v[224:227]
    v_mfma_f32_16x16x32_bf16 v[228:231], v[40:43], a[124:127], v[228:231]
    v_mfma_f32_16x16x32_bf16 v[232:235], v[44:47], a[52:55], v[232:235]
    v_mfma_f32_16x16x32_bf16 v[236:239], v[44:47], a[124:127], v[236:239]
    s_waitcnt lgkmcnt(2)
    v_mfma_f32_16x16x32_bf16 v[208:211], v[48:51], v[120:123], v[208:211]
    ds_read_b128 v[40:43], v3 offset:16384
    v_mfma_f32_16x16x32_bf16 v[212:215], v[48:51], v[192:195], v[212:215]
    ds_read_b128 v[44:47], v3 offset:34816
    v_mfma_f32_16x16x32_bf16 v[216:219], v[52:55], v[120:123], v[216:219]
    v_mfma_f32_16x16x32_bf16 v[220:223], v[52:55], v[192:195], v[220:223]
    v_mfma_f32_16x16x32_bf16 v[224:227], v[48:51], a[56:59], v[224:227]
    v_mfma_f32_16x16x32_bf16 v[228:231], v[48:51], a[128:131], v[228:231]
    v_mfma_f32_16x16x32_bf16 v[232:235], v[52:55], a[56:59], v[232:235]
    v_mfma_f32_16x16x32_bf16 v[236:239], v[52:55], a[128:131], v[236:239]
    s_waitcnt lgkmcnt(2)
    v_mfma_f32_16x16x32_bf16 v[208:211], v[32:35], v[124:127], v[208:211]
    ds_read_b128 v[48:51], v3 offset:17408
    v_mfma_f32_16x16x32_bf16 v[212:215], v[32:35], v[196:199], v[212:215]
    ds_read_b128 v[52:55], v3 offset:35840
    v_mfma_f32_16x16x32_bf16 v[216:219], v[36:39], v[124:127], v[216:219]
    v_mfma_f32_16x16x32_bf16 v[220:223], v[36:39], v[196:199], v[220:223]
    v_mfma_f32_16x16x32_bf16 v[224:227], v[32:35], a[60:63], v[224:227]
    s_add_u32 s27, s27, 36864
    s_cmp_eq_u32 s27, 110592
    s_cselect_b32 s27, 0, s27
    v_add_u32 v3, s27, v1
    v_mfma_f32_16x16x32_bf16 v[228:231], v[32:35], a[132:135], v[228:231]
    v_mfma_f32_16x16x32_bf16 v[232:235], v[36:39], a[60:63], v[232:235]
    v_mfma_f32_16x16x32_bf16 v[236:239], v[36:39], a[132:135], v[236:239]
    s_waitcnt lgkmcnt(2)
    v_mfma_f32_16x16x32_bf16 v[208:211], v[40:43], v[128:131], v[208:211]
    ds_read_b128 v[32:35], v3 offset:0
    v_mfma_f32_16x16x32_bf16 v[212:215], v[40:43], v[200:203], v[212:215]
    ds_read_b128 v[36:39], v3 offset:18432
    v_mfma_f32_16x16x32_bf16 v[216:219], v[44:47], v[128:131], v[216:219]
    v_mfma_f32_16x16x32_bf16 v[220:223], v[44:47], v[200:203], v[220:223]
    v_mfma_f32_16x16x32_bf16 v[224:227], v[40:43], a[64:67], v[224:227]
    v_mfma_f32_16x16x32_bf16 v[228:231], v[40:43], a[136:139], v[228:231]
    v_mfma_f32_16x16x32_bf16 v[232:235], v[44:47], a[64:67], v[232:235]
    v_mfma_f32_16x16x32_bf16 v[236:239], v[44:47], a[136:139], v[236:239]
    s_waitcnt lgkmcnt(2)
    v_mfma_f32_16x16x32_bf16 v[208:211], v[48:51], v[132:135], v[208:211]
    ds_read_b128 v[40:43], v3 offset:1024
    v_mfma_f32_16x16x32_bf16 v[212:215], v[48:51], v[204:207], v[212:215]
    ds_read_b128 v[44:47], v3 offset:19456
    v_mfma_f32_16x16x32_bf16 v[216:219], v[52:55], v[132:135], v[216:219]
    v_mfma_f32_16x16x32_bf16 v[220:223], v[52:55], v[204:207], v[220:223]
    v_mfma_f32_16x16x32_bf16 v[224:227], v[48:51], a[68:71], v[224:227]
    v_mfma_f32_16x16x32_bf16 v[228:231], v[48:51], a[140:143], v[228:231]
    v_mfma_f32_16x16x32_bf16 v[232:235], v[52:55], a[68:71], v[232:235]
    v_mfma_f32_16x16x32_bf16 v[236:239], v[52:55], a[140:143], v[236:239]
    s_add_u32 s26, s26, s41
    s_waitcnt vmcnt(0)
    v_cvt_pk_bf16_f32 v8, v208, v209
    v_cvt_pk_bf16_f32 v9, v210, v211
    v_cvt_pk_bf16_f32 v10, v216, v217
    v_cvt_pk_bf16_f32 v11, v218, v219
    v_cvt_pk_bf16_f32 v12, v212, v213
    v_cvt_pk_bf16_f32 v13, v214, v215
    v_cvt_pk_bf16_f32 v14, v220, v221
    v_cvt_pk_bf16_f32 v15, v222, v223
    v_cvt_pk_bf16_f32 v16, v224, v225
    v_cvt_pk_bf16_f32 v17, v226, v227
    v_cvt_pk_bf16_f32 v18, v232, v233
    v_cvt_pk_bf16_f32 v19, v234, v235
    v_cvt_pk_bf16_f32 v20, v228, v229
    v_cvt_pk_bf16_f32 v21, v230, v231
    v_cvt_pk_bf16_f32 v22, v236, v237
    v_cvt_pk_bf16_f32 v23, v238, v239
    s_mov_b64 s[36:37], -1
    s_add_u32 s28, s26, s12
    buffer_store_dwordx4 v[8:11], v7, s[4:7], s28 offen sc1
    s_add_u32 s28, s26, s13
    buffer_store_dwordx4 v[12:15], v7, s[4:7], s28 offen sc1
    s_add_u32 s28, s26, s14
    buffer_store_dwordx4 v[16:19], v7, s[4:7], s28 offen sc1
    s_add_u32 s28, s26, s15
    buffer_store_dwordx4 v[20:23], v7, s[4:7], s28 offen sc1
    s_lshr_b32 s45, s19, 2
    s_cbranch_scc1 qk_vloop_nf
    s_mov_b32 s45, 1
    s_mov_b64 s[36:37], 0
    s_waitcnt vmcnt(0)
    s_barrier
    s_add_u32 s23, s45, s95
    v_mov_b32 v4, s23
    s_mov_b64 exec, s[34:35]
    buffer_store_dword v4, off, s[4:7], s29 sc1
    buffer_store_dword v4, off, s[4:7], s29 offset:128 sc1
    s_mov_b64 exec, -1
qk_vloop_nf:
    s_add_u32 s19, s19, 4
    s_cmp_lt_u32 s19, s20
    s_cbranch_scc1 qk_vloop
qk_done:
    s_waitcnt vmcnt(0) lgkmcnt(0)
    s_barrier
    s_mov_b32 s45, 16
    s_add_u32 s23, s45, s95
    v_mov_b32 v4, s23
    s_mov_b64 exec, s[34:35]
    buffer_store_dword v4, off, s[4:7], s29 sc1
    buffer_store_dword v4, off, s[4:7], s29 offset:128 sc1
    s_mov_b64 exec, -1
    s_cmp_lt_i32 s33, 0
    s_cbranch_scc1 L_memkv
    v_readfirstlane_b32 s40, v245
    v_readfirstlane_b32 s41, v246
    v_readfirstlane_b32 s42, v247
    v_readfirstlane_b32 s43, v248
    s_cmp_ge_u32 s40, 160
    s_cselect_b32 s43, s43, 0
    s_cmp_ge_u32 s41, 1
    s_cselect_b32 s43, s43, 0
    s_cmp_eq_u32 s42, 1
    s_cselect_b32 s43, s43, 0
    s_cmp_eq_u32 s93, 1000
    s_cselect_b32 s43, s43, 0
    s_mov_b32 s93, 999
    v_mov_b32 v250, s43
    v_mov_b32 v251, 163832
    s_mov_b64 exec, s[34:35]
    ds_write_b32 v251, v250
    s_mov_b64 exec, -1
    s_waitcnt lgkmcnt(0)
    s_barrier
    ds_read_b32 v252, v251
    s_waitcnt lgkmcnt(0)
    v_readfirstlane_b32 s43, v252
    s_barrier
    s_cmp_lg_u32 s43, 192
    s_cbranch_scc1 L_qkv_next
    s_mov_b32 s45, s33
    s_mov_b32 s93, 500
    s_branch L_phase2b
L_memkv:
    v_and_b32 v4, 63, v0
    v_and_b32 v2, 7, v4
    v_lshrrev_b32 v5, 4, v4
    v_lshl_add_u32 v2, v5, 3, v2
    v_lshlrev_b32 v2, 4, v2
    v_bfe_u32 v3, v4, 3, 1
    v_mul_u32_u24 v5, 9216, v3
    v_add_u32 v2, v2, v5
    v_mov_b32 v240, 0x05040100
    v_mov_b32 v241, 0x07060302
    v_lshrrev_b32 v5, 5, v4
    v_and_b32 v1, 0xdff, v7
    s_cmp_eq_u32 s16, 2
    s_cbranch_scc1 mk_isv
    v_mov_b32 v5, v3
    v_or_b32 v1, 128, v7
mk_isv:
    v_lshl_add_u32 v1, v5, 17, v1
    s_mov_b32 s28, 0
    s_mov_b32 s19, 2
    s_mov_b32 s24, 138412032
    s_lshl_b32 s26, s17, 12
    s_mov_b32 s21, 69206016
    s_cmp_eq_u32 s16, 2
    s_cselect_b32 s21, 77594624, s21
    s_add_u32 s26, s26, s21
    s_lshl_b32 s29, s17, 7
    s_lshl_b32 s21, s16, 2
    s_add_u32 s29, s29, s21
    s_add_u32 s29, s29, 125829164
mk_loop:
    s_cmp_lg_u32 s18, 0
    s_cbranch_scc1 mk_go
    s_cmp_le_u32 s19, s28
    s_cbranch_scc1 mk_go
    s_mov_b32 s23, 125853696
    s_mov_b32 s21, 4194304
mk_wait:
    buffer_load_dword v4, off, s[4:7], s23 sc1
    s_sub_u32 s21, s21, 1
    s_cbranch_scc1 mk_go
    s_waitcnt vmcnt(0)
    v_readfirstlane_b32 s28, v4
    s_nop 0
    s_sub_u32 s28, s28, s95
    s_cmp_gt_u32 s28, 64
    s_cselect_b32 s28, 0, s28
    s_cmp_le_u32 s19, s28
    s_cbranch_scc1 mk_go
    s_sleep 4
    s_branch mk_wait
mk_go:
    s_barrier
    s_add_u32 s21, s24, 4096
    s_add_u32 s23, s24, 8192
    buffer_load_dwordx4 v[24:27], v2, s[4:7], s24 offen offset:0 sc1
    buffer_load_dwordx4 v[28:31], v2, s[4:7], s24 offen offset:512 sc1
    buffer_load_dwordx4 v[32:35], v2, s[4:7], s21 offen offset:0 sc1
    buffer_load_dwordx4 v[36:39], v2, s[4:7], s21 offen offset:512 sc1
    buffer_load_dwordx4 v[40:43], v2, s[4:7], s24 offen offset:1024 sc1
    buffer_load_dwordx4 v[44:47], v2, s[4:7], s24 offen offset:1536 sc1
    buffer_load_dwordx4 v[48:51], v2, s[4:7], s21 offen offset:1024 sc1
    buffer_load_dwordx4 v[52:55], v2, s[4:7], s21 offen offset:1536 sc1
    buffer_load_dwordx4 v[56:59], v2, s[4:7], s24 offen offset:2048 sc1
    buffer_load_dwordx4 v[60:63], v2, s[4:7], s24 offen offset:2560 sc1
    buffer_load_dwordx4 v[208:211], v2, s[4:7], s21 offen offset:2048 sc1
    buffer_load_dwordx4 v[212:215], v2, s[4:7], s21 offen offset:2560 sc1
    buffer_load_dwordx4 v[216:219], v2, s[4:7], s24 offen offset:3072 sc1
    buffer_load_dwordx4 v[220:223], v2, s[4:7], s24 offen offset:3584 sc1
    buffer_load_dwordx4 v[224:227], v2, s[4:7], s21 offen offset:3072 sc1
    buffer_load_dwordx4 v[228:231], v2, s[4:7], s21 offen offset:3584 sc1
    buffer_load_dwordx4 v[232:235], v2, s[4:7], s23 offen offset:0 sc1
    buffer_load_dwordx4 v[236:239], v2, s[4:7], s23 offen offset:512 sc1
    s_add_u32 s24, s24, 18432
    s_cmp_eq_u32 s16, 2
    s_cbranch_scc1 mk_v
    s_waitcnt vmcnt(17)
    s_waitcnt vmcnt(16)
    v_mfma_f32_16x16x32_bf16 v[8:11], v[64:67], v[24:27], 0
    v_mfma_f32_16x16x32_bf16 v[12:15], v[136:139], v[24:27], 0
    v_mfma_f32_16x16x32_bf16 v[16:19], a[0:3], v[24:27], 0
    v_mfma_f32_16x16x32_bf16 v[20:23], a[72:75], v[24:27], 0
    s_waitcnt vmcnt(15)
    v_mfma_f32_16x16x32_bf16 v[8:11], v[68:71], v[28:31], v[8:11]
    v_mfma_f32_16x16x32_bf16 v[12:15], v[140:143], v[28:31], v[12:15]
    v_mfma_f32_16x16x32_bf16 v[16:19], a[4:7], v[28:31], v[16:19]
    v_mfma_f32_16x16x32_bf16 v[20:23], a[76:79], v[28:31], v[20:23]
    s_waitcnt vmcnt(14)
    v_mfma_f32_16x16x32_bf16 v[8:11], v[72:75], v[32:35], v[8:11]
    v_mfma_f32_16x16x32_bf16 v[12:15], v[144:147], v[32:35], v[12:15]
    v_mfma_f32_16x16x32_bf16 v[16:19], a[8:11], v[32:35], v[16:19]
    v_mfma_f32_16x16x32_bf16 v[20:23], a[80:83], v[32:35], v[20:23]
    s_waitcnt vmcnt(13)
    v_mfma_f32_16x16x32_bf16 v[8:11], v[76:79], v[36:39], v[8:11]
    v_mfma_f32_16x16x32_bf16 v[12:15], v[148:151], v[36:39], v[12:15]
    v_mfma_f32_16x16x32_bf16 v[16:19], a[12:15], v[36:39], v[16:19]
    v_mfma_f32_16x16x32_bf16 v[20:23], a[84:87], v[36:39], v[20:23]
    s_waitcnt vmcnt(12)
    v_mfma_f32_16x16x32_bf16 v[8:11], v[80:83], v[40:43], v[8:11]
    v_mfma_f32_16x16x32_bf16 v[12:15], v[152:155], v[40:43], v[12:15]
    v_mfma_f32_16x16x32_bf16 v[16:19], a[16:19], v[40:43], v[16:19]
    v_mfma_f32_16x16x32_bf16 v[20:23], a[88:91], v[40:43], v[20:23]
    s_waitcnt vmcnt(11)
    v_mfma_f32_16x16x32_bf16 v[8:11], v[84:87], v[44:47], v[8:11]
    v_mfma_f32_16x16x32_bf16 v[12:15], v[156:159], v[44:47], v[12:15]
    v_mfma_f32_16x16x32_bf16 v[16:19], a[20:23], v[44:47], v[16:19]
    v_mfma_f32_16x16x32_bf16 v[20:23], a[92:95], v[44:47], v[20:23]
    s_waitcnt vmcnt(10)
    v_mfma_f32_16x16x32_bf16 v[8:11], v[88:91], v[48:51], v[8:11]
    v_mfma_f32_16x16x32_bf16 v[12:15], v[160:163], v[48:51], v[12:15]
    v_mfma_f32_16x16x32_bf16 v[16:19], a[24:27], v[48:51], v[16:19]
    v_mfma_f32_16x16x32_bf16 v[20:23], a[96:99], v[48:51], v[20:23]
    s_waitcnt vmcnt(9)
    v_mfma_f32_16x16x32_bf16 v[8:11], v[92:95], v[52:55], v[8:11]
    v_mfma_f32_16x16x32_bf16 v[12:15], v[164:167], v[52:55], v[12:15]
    v_mfma_f32_16x16x32_bf16 v[16:19], a[28:31], v[52:55], v[16:19]
    v_mfma_f32_16x16x32_bf16 v[20:23], a[100:103], v[52:55], v[20:23]
    s_waitcnt vmcnt(8)
    v_mfma_f32_16x16x32_bf16 v[8:11], v[96:99], v[56:59], v[8:11]
    v_mfma_f32_16x16x32_bf16 v[12:15], v[168:171], v[56:59], v[12:15]
    v_mfma_f32_16x16x32_bf16 v[16:19], a[32:35], v[56:59], v[16:19]
    v_mfma_f32_16x16x32_bf16 v[20:23], a[104:107], v[56:59], v[20:23]
    s_waitcnt vmcnt(7)
    v_mfma_f32_16x16x32_bf16 v[8:11], v[100:103], v[60:63], v[8:11]
    v_mfma_f32_16x16x32_bf16 v[12:15], v[172:175], v[60:63], v[12:15]
    v_mfma_f32_16x16x32_bf16 v[16:19], a[36:39], v[60:63], v[16:19]
    v_mfma_f32_16x16x32_bf16 v[20:23], a[108:111], v[60:63], v[20:23]
    s_waitcnt vmcnt(6)
    v_mfma_f32_16x16x32_bf16 v[8:11], v[104:107], v[208:211], v[8:11]
    v_mfma_f32_16x16x32_bf16 v[12:15], v[176:179], v[208:211], v[12:15]
    v_mfma_f32_16x16x32_bf16 v[16:19], a[40:43], v[208:211], v[16:19]
    v_mfma_f32_16x16x32_bf16 v[20:23], a[112:115], v[208:211], v[20:23]
    s_waitcnt vmcnt(5)
    v_mfma_f32_16x16x32_bf16 v[8:11], v[108:111], v[212:215], v[8:11]
    v_mfma_f32_16x16x32_bf16 v[12:15], v[180:183], v[212:215], v[12:15]
    v_mfma_f32_16x16x32_bf16 v[16:19], a[44:47], v[212:215], v[16:19]
    v_mfma_f32_16x16x32_bf16 v[20:23], a[116:119], v[212:215], v[20:23]
    s_waitcnt vmcnt(4)
    v_mfma_f32_16x16x32_bf16 v[8:11], v[112:115], v[216:219], v[8:11]
    v_mfma_f32_16x16x32_bf16 v[12:15], v[184:187], v[216:219], v[12:15]
    v_mfma_f32_16x16x32_bf16 v[16:19], a[48:51], v[216:219], v[16:19]
    v_mfma_f32_16x16x32_bf16 v[20:23], a[120:123], v[216:219], v[20:23]
    s_waitcnt vmcnt(3)
    v_mfma_f32_16x16x32_bf16 v[8:11], v[116:119], v[220:223], v[8:11]
    v_mfma_f32_16x16x32_bf16 v[12:15], v[188:191], v[220:223], v[12:15]
    v_mfma_f32_16x16x32_bf16 v[16:19], a[52:55], v[220:223], v[16:19]
    v_mfma_f32_16x16x32_bf16 v[20:23], a[124:127], v[220:223], v[20:23]
    s_waitcnt vmcnt(2)
    v_mfma_f32_16x16x32_bf16 v[8:11], v[120:123], v[224:227], v[8:11]
    v_mfma_f32_16x16x32_bf16 v[12:15], v[192:195], v[224:227], v[12:15]
    v_mfma_f32_16x16x32_bf16 v[16:19], a[56:59], v[224:227], v[16:19]
    v_mfma_f32_16x16x32_bf16 v[20:23], a[128:131], v[224:227], v[20:23]
    s_waitcnt vmcnt(1)
    v_mfma_f32_16x16x32_bf16 v[8:11], v[124:127], v[228:231], v[8:11]
    v_mfma_f32_16x16x32_bf16 v[12:15], v[196:199], v[228:231], v[12:15]
    v_mfma_f32_16x16x32_bf16 v[16:19], a[60:63], v[228:231], v[16:19]
    v_mfma_f32_16x16x32_bf16 v[20:23], a[132:135], v[228:231], v[20:23]
    s_waitcnt vmcnt(0)
    v_mfma_f32_16x16x32_bf16 v[8:11], v[128:131], v[232:235], v[8:11]
    v_mfma_f32_16x16x32_bf16 v[12:15], v[200:203], v[232:235], v[12:15]
    v_mfma_f32_16x16x32_bf16 v[16:19], a[64:67], v[232:235], v[16:19]
    v_mfma_f32_16x16x32_bf16 v[20:23], a[136:139], v[232:235], v[20:23]
    v_mfma_f32_16x16x32_bf16 v[8:11], v[132:135], v[236:239], v[8:11]
    v_mfma_f32_16x16x32_bf16 v[12:15], v[204:207], v[236:239], v[12:15]
    v_mfma_f32_16x16x32_bf16 v[16:19], a[68:71], v[236:239], v[16:19]
    v_mfma_f32_16x16x32_bf16 v[20:23], a[140:143], v[236:239], v[20:23]
    s_nop 7
    s_branch mk_st
mk_v:
    s_waitcnt vmcnt(17)
    s_waitcnt vmcnt(16)
    v_mfma_f32_16x16x32_bf16 v[8:11], v[24:27], v[64:67], 0
    v_mfma_f32_16x16x32_bf16 v[12:15], v[24:27], v[136:139], 0
    v_mfma_f32_16x16x32_bf16 v[16:19], v[24:27], a[0:3], 0
    v_mfma_f32_16x16x32_bf16 v[20:23], v[24:27], a[72:75], 0
    s_waitcnt vmcnt(15)
    v_mfma_f32_16x16x32_bf16 v[8:11], v[28:31], v[68:71], v[8:11]
    v_mfma_f32_16x16x32_bf16 v[12:15], v[28:31], v[140:143], v[12:15]
    v_mfma_f32_16x16x32_bf16 v[16:19], v[28:31], a[4:7], v[16:19]
    v_mfma_f32_16x16x32_bf16 v[20:23], v[28:31], a[76:79], v[20:23]
    s_waitcnt vmcnt(14)
    v_mfma_f32_16x16x32_bf16 v[8:11], v[32:35], v[72:75], v[8:11]
    v_mfma_f32_16x16x32_bf16 v[12:15], v[32:35], v[144:147], v[12:15]
    v_mfma_f32_16x16x32_bf16 v[16:19], v[32:35], a[8:11], v[16:19]
    v_mfma_f32_16x16x32_bf16 v[20:23], v[32:35], a[80:83], v[20:23]
    s_waitcnt vmcnt(13)
    v_mfma_f32_16x16x32_bf16 v[8:11], v[36:39], v[76:79], v[8:11]
    v_mfma_f32_16x16x32_bf16 v[12:15], v[36:39], v[148:151], v[12:15]
    v_mfma_f32_16x16x32_bf16 v[16:19], v[36:39], a[12:15], v[16:19]
    v_mfma_f32_16x16x32_bf16 v[20:23], v[36:39], a[84:87], v[20:23]
    s_waitcnt vmcnt(12)
    v_mfma_f32_16x16x32_bf16 v[8:11], v[40:43], v[80:83], v[8:11]
    v_mfma_f32_16x16x32_bf16 v[12:15], v[40:43], v[152:155], v[12:15]
    v_mfma_f32_16x16x32_bf16 v[16:19], v[40:43], a[16:19], v[16:19]
    v_mfma_f32_16x16x32_bf16 v[20:23], v[40:43], a[88:91], v[20:23]
    s_waitcnt vmcnt(11)
    v_mfma_f32_16x16x32_bf16 v[8:11], v[44:47], v[84:87], v[8:11]
    v_mfma_f32_16x16x32_bf16 v[12:15], v[44:47], v[156:159], v[12:15]
    v_mfma_f32_16x16x32_bf16 v[16:19], v[44:47], a[20:23], v[16:19]
    v_mfma_f32_16x16x32_bf16 v[20:23], v[44:47], a[92:95], v[20:23]
    s_waitcnt vmcnt(10)
    v_mfma_f32_16x16x32_bf16 v[8:11], v[48:51], v[88:91], v[8:11]
    v_mfma_f32_16x16x32_bf16 v[12:15], v[48:51], v[160:163], v[12:15]
    v_mfma_f32_16x16x32_bf16 v[16:19], v[48:51], a[24:27], v[16:19]
    v_mfma_f32_16x16x32_bf16 v[20:23], v[48:51], a[96:99], v[20:23]
    s_waitcnt vmcnt(9)
    v_mfma_f32_16x16x32_bf16 v[8:11], v[52:55], v[92:95], v[8:11]
    v_mfma_f32_16x16x32_bf16 v[12:15], v[52:55], v[164:167], v[12:15]
    v_mfma_f32_16x16x32_bf16 v[16:19], v[52:55], a[28:31], v[16:19]
    v_mfma_f32_16x16x32_bf16 v[20:23], v[52:55], a[100:103], v[20:23]
    s_waitcnt vmcnt(8)
    v_mfma_f32_16x16x32_bf16 v[8:11], v[56:59], v[96:99], v[8:11]
    v_mfma_f32_16x16x32_bf16 v[12:15], v[56:59], v[168:171], v[12:15]
    v_mfma_f32_16x16x32_bf16 v[16:19], v[56:59], a[32:35], v[16:19]
    v_mfma_f32_16x16x32_bf16 v[20:23], v[56:59], a[104:107], v[20:23]
    s_waitcnt vmcnt(7)
    v_mfma_f32_16x16x32_bf16 v[8:11], v[60:63], v[100:103], v[8:11]
    v_mfma_f32_16x16x32_bf16 v[12:15], v[60:63], v[172:175], v[12:15]
    v_mfma_f32_16x16x32_bf16 v[16:19], v[60:63], a[36:39], v[16:19]
    v_mfma_f32_16x16x32_bf16 v[20:23], v[60:63], a[108:111], v[20:23]
    s_waitcnt vmcnt(6)
    v_mfma_f32_16x16x32_bf16 v[8:11], v[208:211], v[104:107], v[8:11]
    v_mfma_f32_16x16x32_bf16 v[12:15], v[208:211], v[176:179], v[12:15]
    v_mfma_f32_16x16x32_bf16 v[16:19], v[208:211], a[40:43], v[16:19]
    v_mfma_f32_16x16x32_bf16 v[20:23], v[208:211], a[112:115], v[20:23]
    s_waitcnt vmcnt(5)
    v_mfma_f32_16x16x32_bf16 v[8:11], v[212:215], v[108:111], v[8:11]
    v_mfma_f32_16x16x32_bf16 v[12:15], v[212:215], v[180:183], v[12:15]
    v_mfma_f32_16x16x32_bf16 v[16:19], v[212:215], a[44:47], v[16:19]
    v_mfma_f32_16x16x32_bf16 v[20:23], v[212:215], a[116:119], v[20:23]
    s_waitcnt vmcnt(4)
    v_mfma_f32_16x16x32_bf16 v[8:11], v[216:219], v[112:115], v[8:11]
    v_mfma_f32_16x16x32_bf16 v[12:15], v[216:219], v[184:187], v[12:15]
    v_mfma_f32_16x16x32_bf16 v[16:19], v[216:219], a[48:51], v[16:19]
    v_mfma_f32_16x16x32_bf16 v[20:23], v[216:219], a[120:123], v[20:23]
    s_waitcnt vmcnt(3)
    v_mfma_f32_16x16x32_bf16 v[8:11], v[220:223], v[116:119], v[8:11]
    v_mfma_f32_16x16x32_bf16 v[12:15], v[220:223], v[188:191], v[12:15]
    v_mfma_f32_16x16x32_bf16 v[16:19], v[220:223], a[52:55], v[16:19]
    v_mfma_f32_16x16x32_bf16 v[20:23], v[220:223], a[124:127], v[20:23]
    s_waitcnt vmcnt(2)
    v_mfma_f32_16x16x32_bf16 v[8:11], v[224:227], v[120:123], v[8:11]
    v_mfma_f32_16x16x32_bf16 v[12:15], v[224:227], v[192:195], v[12:15]
    v_mfma_f32_16x16x32_bf16 v[16:19], v[224:227], a[56:59], v[16:19]
    v_mfma_f32_16x16x32_bf16 v[20:23], v[224:227], a[128:131], v[20:23]
    s_waitcnt vmcnt(1)
    v_mfma_f32_16x16x32_bf16 v[8:11], v[228:231], v[124:127], v[8:11]
    v_mfma_f32_16x16x32_bf16 v[12:15], v[228:231], v[196:199], v[12:15]
    v_mfma_f32_16x16x32_bf16 v[16:19], v[228:231], a[60:63], v[16:19]
    v_mfma_f32_16x16x32_bf16 v[20:23], v[228:231], a[132:135], v[20:23]
    s_waitcnt vmcnt(0)
    v_mfma_f32_16x16x32_bf16 v[8:11], v[232:235], v[128:131], v[8:11]
    v_mfma_f32_16x16x32_bf16 v[12:15], v[232:235], v[200:203], v[12:15]
    v_mfma_f32_16x16x32_bf16 v[16:19], v[232:235], a[64:67], v[16:19]
    v_mfma_f32_16x16x32_bf16 v[20:23], v[232:235], a[136:139], v[20:23]
    v_mfma_f32_16x16x32_bf16 v[8:11], v[236:239], v[132:135], v[8:11]
    v_mfma_f32_16x16x32_bf16 v[12:15], v[236:239], v[204:207], v[12:15]
    v_mfma_f32_16x16x32_bf16 v[16:19], v[236:239], a[68:71], v[16:19]
    v_mfma_f32_16x16x32_bf16 v[20:23], v[236:239], a[140:143], v[20:23]
    s_nop 4
    v_pk_mul_f32 v[8:9], v[8:9], 0.5 op_sel_hi:[1,0]
    v_pk_mul_f32 v[10:11], v[10:11], 0.5 op_sel_hi:[1,0]
    v_pk_mul_f32 v[12:13], v[12:13], 0.5 op_sel_hi:[1,0]
    v_pk_mul_f32 v[14:15], v[14:15], 0.5 op_sel_hi:[1,0]
    v_pk_mul_f32 v[16:17], v[16:17], 0.5 op_sel_hi:[1,0]
    v_pk_mul_f32 v[18:19], v[18:19], 0.5 op_sel_hi:[1,0]
    v_pk_mul_f32 v[20:21], v[20:21], 0.5 op_sel_hi:[1,0]
    v_pk_mul_f32 v[22:23], v[22:23], 0.5 op_sel_hi:[1,0]
mk_st:
    s_nop 1
    v_cvt_pk_bf16_f32 v24, v8, v9
    v_cvt_pk_bf16_f32 v25, v10, v11
    v_cvt_pk_bf16_f32 v26, v12, v13
    v_cvt_pk_bf16_f32 v27, v14, v15
    v_cvt_pk_bf16_f32 v28, v16, v17
    v_cvt_pk_bf16_f32 v29, v18, v19
    v_cvt_pk_bf16_f32 v30, v20, v21
    v_cvt_pk_bf16_f32 v31, v22, v23
    s_add_u32 s21, s26, 4096
    buffer_store_dwordx4 v[24:27], v1, s[4:7], s26 offen sc1
    buffer_store_dwordx4 v[28:31], v1, s[4:7], s21 offen sc1
    s_add_u32 s22, s19, s95
    s_waitcnt vmcnt(0)
    s_barrier
    v_mov_b32 v4, s22
    s_mov_b64 exec, s[34:35]
    buffer_store_dword v4, off, s[4:7], s29 sc1
    buffer_store_dword v4, off, s[4:7], s29 offset:128 sc1
    s_mov_b64 exec, -1
    s_add_u32 s19, s19, 2
    s_add_u32 s26, s26, 262144
    s_cmp_le_u32 s19, 56
    s_cbranch_scc1 mk_loop
    s_mov_b32 s45, 2
    s_mov_b32 s8, s76
    s_mov_b32 s9, s77
    s_mov_b32 s10, 4718592
    s_mov_b32 s11, 0x20000
    s_branch L_att_next
L_ssm_next:
    s_sub_u32 s93, s93, 1
    s_cbranch_scc1 L_exit
    s_mov_b32 s37, 8
    v_mov_b32 v250, 1
    v_mov_b32 v251, 163832
    v_cmp_eq_u32 vcc, 0, v0
    s_nop 0
    s_and_saveexec_b64 s[38:39], vcc
    s_cbranch_execz tk11
    buffer_atomic_add v250, off, s[84:87], s37 sc0
    s_waitcnt vmcnt(0)
    ds_write_b32 v251, v250
    s_waitcnt lgkmcnt(0)
tk11:
    s_mov_b64 exec, -1
    s_barrier
    ds_read_b32 v252, v251
    s_waitcnt lgkmcnt(0)
    v_readfirstlane_b32 s20, v252
    s_barrier
    s_nop 3
    s_cmp_ge_u32 s20, 72
    s_cbranch_scc1 L_ssm_done
    s_lshl_b32 s20, s20, 3
    v_lshrrev_b32 v5, 6, v0
    s_nop 0
    v_readfirstlane_b32 s21, v5
    v_and_b32 v1, 63, v0
    v_and_b32 v2, 15, v1
    v_lshrrev_b32 v3, 4, v1
    v_lshlrev_b32 v4, 14, v5
    s_mov_b32 s8, s62
    s_mov_b32 s9, s63
    s_mov_b32 s10, 2359296
    s_mov_b32 s11, 0x20000
    s_mov_b32 s16, s76
    s_mov_b32 s17, s77
    s_mov_b32 s18, 4718592
    s_mov_b32 s19, 0x20000
    s_add_u32 s22, s20, s21
    s_lshl_b32 s23, s22, 8
    v_lshlrev_b32 v6, 3, v2
    v_lshl_add_u32 v6, v3, 1, v6
    s_mov_b32 s12, s64
    s_mov_b32 s13, s65
    s_mov_b32 s14, 147456
    s_mov_b32 s15, 0x20000
    buffer_load_ushort v8, v6, s[12:15], s23 offen offset:0
    buffer_load_ushort v12, v6, s[12:15], s23 offen offset:128
    buffer_load_ushort v16, v6, s[12:15], s23 offen offset:1024
    buffer_load_ushort v20, v6, s[12:15], s23 offen offset:1152
    s_mov_b32 s12, s66
    s_mov_b32 s13, s67
    s_mov_b32 s14, 147456
    s_mov_b32 s15, 0x20000
    buffer_load_ushort v9, v6, s[12:15], s23 offen offset:0
    buffer_load_ushort v13, v6, s[12:15], s23 offen offset:128
    buffer_load_ushort v17, v6, s[12:15], s23 offen offset:1024
    buffer_load_ushort v21, v6, s[12:15], s23 offen offset:1152
    s_mov_b32 s12, s68
    s_mov_b32 s13, s69
    s_mov_b32 s14, 147456
    s_mov_b32 s15, 0x20000
    buffer_load_ushort v10, v6, s[12:15], s23 offen offset:0
    buffer_load_ushort v14, v6, s[12:15], s23 offen offset:128
    buffer_load_ushort v18, v6, s[12:15], s23 offen offset:1024
    buffer_load_ushort v22, v6, s[12:15], s23 offen offset:1152
    s_mov_b32 s12, s70
    s_mov_b32 s13, s71
    s_mov_b32 s14, 147456
    s_mov_b32 s15, 0x20000
    buffer_load_ushort v11, v6, s[12:15], s23 offen offset:0
    buffer_load_ushort v15, v6, s[12:15], s23 offen offset:128
    buffer_load_ushort v19, v6, s[12:15], s23 offen offset:1024
    buffer_load_ushort v23, v6, s[12:15], s23 offen offset:1152
    s_mov_b32 s12, s72
    s_mov_b32 s13, s73
    s_mov_b32 s14, 1152
    s_mov_b32 s15, 0x20000
    s_lshl_b32 s23, s22, 1
    buffer_load_ushort v24, off, s[12:15], s23
    buffer_load_ushort v25, off, s[12:15], s23 offset:8
    v_mul_u32_u24 v5, 9216, v0
    s_lshl_b32 s22, s20, 1
    s_add_u32 s23, s22, 0
    buffer_load_dwordx4 v[208:211], v5, s[8:11], s23 offen
    s_add_u32 s23, s22, 1152
    buffer_load_dwordx4 v[212:215], v5, s[8:11], s23 offen
    s_add_u32 s23, s22, 2304
    buffer_load_dwordx4 v[216:219], v5, s[8:11], s23 offen
    s_add_u32 s23, s22, 3456
    buffer_load_dwordx4 v[220:223], v5, s[8:11], s23 offen
    s_add_u32 s23, s22, 4608
    buffer_load_dwordx4 v[224:227], v5, s[8:11], s23 offen
    s_add_u32 s23, s22, 5760
    buffer_load_dwordx4 v[228:231], v5, s[8:11], s23 offen
    s_add_u32 s23, s22, 6912
    buffer_load_dwordx4 v[232:235], v5, s[8:11], s23 offen
    s_add_u32 s23, s22, 8064
    buffer_load_dwordx4 v[236:239], v5, s[8:11], s23 offen
    s_mov_b32 s26, 0x3fb8aa3b
    s_mov_b32 s27, 0x3e22f983
    s_mov_b32 s28, 0
    v_cvt_f32_u32 v26, v2
    v_mul_f32 v27, 0x41800000, v26
    s_waitcnt vmcnt(8)
    s_nop 0
ss_pass:
    v_mov_b32 v36, 0
    v_mov_b32 v37, 0
    v_lshl_add_u32 v6, v1, 3, v4
    ds_write_b64 v6, v[36:37] offset:0
    v_lshlrev_b32 v38, 16, v24
    v_mul_f32 v38, s26, v38
    v_exp_f32 v38, v38
    s_nop 0
    v_cvt_pk_bf16_f32 v38, v38, v38
    v_and_b32 v38, 0xffff0000, v38
    v_add_f32 v39, v38, v38
    v_lshlrev_b32 v28, 16, v8
    v_mul_f32 v28, s26, v28
    v_exp_f32 v28, v28
    s_nop 0
    v_cvt_pk_bf16_f32 v28, v28, v28
    v_and_b32 v28, 0xffff0000, v28
    v_mul_f32 v28, v28, v38
    v_mul_f32 v28, s26, v28
    v_sub_f32 v28, 0, v28
    v_lshlrev_b32 v29, 16, v9
    v_mul_f32 v29, v29, v38
    v_mul_f32 v29, s27, v29
    v_lshlrev_b32 v30, 16, v10
    v_mul_f32 v30, v30, v39
    v_lshlrev_b32 v31, 16, v11
    v_mul_f32 v31, v31, v39
    v_lshlrev_b32 v32, 16, v12
    v_mul_f32 v32, s26, v32
    v_exp_f32 v32, v32
    s_nop 0
    v_cvt_pk_bf16_f32 v32, v32, v32
    v_and_b32 v32, 0xffff0000, v32
    v_mul_f32 v32, v32, v38
    v_mul_f32 v32, s26, v32
    v_sub_f32 v32, 0, v32
    v_lshlrev_b32 v33, 16, v13
    v_mul_f32 v33, v33, v38
    v_mul_f32 v33, s27, v33
    v_lshlrev_b32 v34, 16, v14
    v_mul_f32 v34, v34, v39
    v_lshlrev_b32 v35, 16, v15
    v_mul_f32 v35, v35, v39
    v_mov_b64 v[48:49], 0
    v_mov_b64 v[50:51], 0
    v_mov_b64 v[52:53], 0
    v_mov_b64 v[54:55], 0
    v_mov_b64 v[56:57], 0
    v_mov_b64 v[58:59], 0
    v_mov_b64 v[60:61], 0
    v_mov_b64 v[62:63], 0
    s_mov_b32 s25, 0
    s_nop 0
ss_kg:
    v_mov_b64_dpp v[64:65], v[28:29] row_newbcast:0 row_mask:0xf bank_mask:0xf
    v_mov_b64_dpp v[66:67], v[30:31] row_newbcast:0 row_mask:0xf bank_mask:0xf
    v_pk_mul_f32 v[94:95], v[64:65], v[26:27] op_sel_hi:[1,0]
    v_pk_mul_f32 v[96:97], v[64:65], v[26:27] op_sel:[0,1] op_sel_hi:[1,1]
    v_fract_f32 v95, v95
    v_fract_f32 v97, v97
    v_exp_f32 v94, v94
    v_exp_f32 v96, v96
    v_cos_f32 v68, v95
    v_sin_f32 v69, v95
    v_cos_f32 v76, v97
    v_sin_f32 v77, v97
    v_pk_mul_f32 v[68:69], v[68:69], v[94:95] op_sel_hi:[1,0]
    v_pk_mul_f32 v[76:77], v[76:77], v[96:97] op_sel_hi:[1,0]
    v_pk_mul_f32 v[92:93], v[76:77], v[76:77] op_sel:[1,1] op_sel_hi:[0,1]
    v_pk_fma_f32 v[78:79], v[76:77], v[76:77], v[92:93] op_sel:[0,0,0] op_sel_hi:[0,1,1] neg_lo:[0,0,1]
    v_pk_mul_f32 v[94:95], v[68:69], v[68:69] op_sel:[1,1] op_sel_hi:[0,1]
    v_pk_fma_f32 v[70:71], v[68:69], v[68:69], v[94:95] op_sel:[0,0,0] op_sel_hi:[0,1,1] neg_lo:[0,0,1]
    v_pk_mul_f32 v[92:93], v[78:79], v[78:79] op_sel:[1,1] op_sel_hi:[0,1]
    v_pk_fma_f32 v[80:81], v[78:79], v[78:79], v[92:93] op_sel:[0,0,0] op_sel_hi:[0,1,1] neg_lo:[0,0,1]
    v_pk_mul_f32 v[94:95], v[70:71], v[70:71] op_sel:[1,1] op_sel_hi:[0,1]
    v_pk_fma_f32 v[72:73], v[70:71], v[70:71], v[94:95] op_sel:[0,0,0] op_sel_hi:[0,1,1] neg_lo:[0,0,1]
    v_pk_mul_f32 v[92:93], v[80:81], v[80:81] op_sel:[1,1] op_sel_hi:[0,1]
    v_pk_fma_f32 v[82:83], v[80:81], v[80:81], v[92:93] op_sel:[0,0,0] op_sel_hi:[0,1,1] neg_lo:[0,0,1]
    v_pk_mul_f32 v[94:95], v[72:73], v[72:73] op_sel:[1,1] op_sel_hi:[0,1]
    v_pk_fma_f32 v[74:75], v[72:73], v[72:73], v[94:95] op_sel:[0,0,0] op_sel_hi:[0,1,1] neg_lo:[0,0,1]
    v_pk_mul_f32 v[92:93], v[82:83], v[82:83] op_sel:[1,1] op_sel_hi:[0,1]
    v_pk_fma_f32 v[84:85], v[82:83], v[82:83], v[92:93] op_sel:[0,0,0] op_sel_hi:[0,1,1] neg_lo:[0,0,1]
    v_pk_mul_f32 v[94:95], v[66:67], v[76:77] op_sel:[1,1] op_sel_hi:[1,0]
    v_pk_fma_f32 v[86:87], v[66:67], v[76:77], v[94:95] op_sel:[0,0,0] op_sel_hi:[0,1,1] neg_lo:[0,0,1] neg_hi:[1,0,1]
    v_mov_b32_dpp v80, v78 row_ror:8 row_mask:0xf bank_mask:0x3
    v_mov_b32_dpp v81, v79 row_ror:8 row_mask:0xf bank_mask:0x3
    v_mov_b32_dpp v82, v84 row_ror:8 row_mask:0xf bank_mask:0x3
    v_mov_b32_dpp v83, v85 row_ror:8 row_mask:0xf bank_mask:0x3
    v_pk_mul_f32 v[92:93], v[66:67], v[80:81] op_sel:[1,1] op_sel_hi:[1,0]
    v_pk_fma_f32 v[88:89], v[66:67], v[80:81], v[92:93] op_sel:[0,0,0] op_sel_hi:[0,1,1] neg_lo:[0,0,1] neg_hi:[1,0,1]
    v_pk_mul_f32 v[94:95], v[66:67], v[82:83] op_sel:[1,1] op_sel_hi:[1,0]
    v_pk_fma_f32 v[90:91], v[66:67], v[82:83], v[94:95] op_sel:[0,0,0] op_sel_hi:[0,1,1] neg_lo:[0,0,1] neg_hi:[1,0,1]
    v_mfma_f32_16x16x4_f32 v[48:51], v86, v68, v[48:51]
    v_mfma_f32_16x16x4_f32 v[52:55], v88, v70, v[52:55]
    v_mfma_f32_16x16x4_f32 v[56:59], v88, v72, v[56:59]
    v_mfma_f32_16x16x4_f32 v[60:63], v90, v74, v[60:63]
    v_mfma_f32_16x16x4_f32 v[48:51], v87, v69, v[48:51]
    v_mfma_f32_16x16x4_f32 v[52:55], v89, v71, v[52:55]
    v_mfma_f32_16x16x4_f32 v[56:59], v89, v73, v[56:59]
    v_mfma_f32_16x16x4_f32 v[60:63], v91, v75, v[60:63]
    v_mov_b64_dpp v[64:65], v[28:29] row_newbcast:1 row_mask:0xf bank_mask:0xf
    v_mov_b64_dpp v[66:67], v[30:31] row_newbcast:1 row_mask:0xf bank_mask:0xf
    v_pk_mul_f32 v[94:95], v[64:65], v[26:27] op_sel_hi:[1,0]
    v_pk_mul_f32 v[96:97], v[64:65], v[26:27] op_sel:[0,1] op_sel_hi:[1,1]
    v_fract_f32 v95, v95
    v_fract_f32 v97, v97
    v_exp_f32 v94, v94
    v_exp_f32 v96, v96
    v_cos_f32 v68, v95
    v_sin_f32 v69, v95
    v_cos_f32 v76, v97
    v_sin_f32 v77, v97
    v_pk_mul_f32 v[68:69], v[68:69], v[94:95] op_sel_hi:[1,0]
    v_pk_mul_f32 v[76:77], v[76:77], v[96:97] op_sel_hi:[1,0]
    v_pk_mul_f32 v[92:93], v[76:77], v[76:77] op_sel:[1,1] op_sel_hi:[0,1]
    v_pk_fma_f32 v[78:79], v[76:77], v[76:77], v[92:93] op_sel:[0,0,0] op_sel_hi:[0,1,1] neg_lo:[0,0,1]
    v_pk_mul_f32 v[94:95], v[68:69], v[68:69] op_sel:[1,1] op_sel_hi:[0,1]
    v_pk_fma_f32 v[70:71], v[68:69], v[68:69], v[94:95] op_sel:[0,0,0] op_sel_hi:[0,1,1] neg_lo:[0,0,1]
    v_pk_mul_f32 v[92:93], v[78:79], v[78:79] op_sel:[1,1] op_sel_hi:[0,1]
    v_pk_fma_f32 v[80:81], v[78:79], v[78:79], v[92:93] op_sel:[0,0,0] op_sel_hi:[0,1,1] neg_lo:[0,0,1]
    v_pk_mul_f32 v[94:95], v[70:71], v[70:71] op_sel:[1,1] op_sel_hi:[0,1]
    v_pk_fma_f32 v[72:73], v[70:71], v[70:71], v[94:95] op_sel:[0,0,0] op_sel_hi:[0,1,1] neg_lo:[0,0,1]
    v_pk_mul_f32 v[92:93], v[80:81], v[80:81] op_sel:[1,1] op_sel_hi:[0,1]
    v_pk_fma_f32 v[82:83], v[80:81], v[80:81], v[92:93] op_sel:[0,0,0] op_sel_hi:[0,1,1] neg_lo:[0,0,1]
    v_pk_mul_f32 v[94:95], v[72:73], v[72:73] op_sel:[1,1] op_sel_hi:[0,1]
    v_pk_fma_f32 v[74:75], v[72:73], v[72:73], v[94:95] op_sel:[0,0,0] op_sel_hi:[0,1,1] neg_lo:[0,0,1]
    v_pk_mul_f32 v[92:93], v[82:83], v[82:83] op_sel:[1,1] op_sel_hi:[0,1]
    v_pk_fma_f32 v[84:85], v[82:83], v[82:83], v[92:93] op_sel:[0,0,0] op_sel_hi:[0,1,1] neg_lo:[0,0,1]
    v_pk_mul_f32 v[94:95], v[66:67], v[76:77] op_sel:[1,1] op_sel_hi:[1,0]
    v_pk_fma_f32 v[86:87], v[66:67], v[76:77], v[94:95] op_sel:[0,0,0] op_sel_hi:[0,1,1] neg_lo:[0,0,1] neg_hi:[1,0,1]
    v_mov_b32_dpp v80, v78 row_ror:8 row_mask:0xf bank_mask:0x3
    v_mov_b32_dpp v81, v79 row_ror:8 row_mask:0xf bank_mask:0x3
    v_mov_b32_dpp v82, v84 row_ror:8 row_mask:0xf bank_mask:0x3
    v_mov_b32_dpp v83, v85 row_ror:8 row_mask:0xf bank_mask:0x3
    v_pk_mul_f32 v[92:93], v[66:67], v[80:81] op_sel:[1,1] op_sel_hi:[1,0]
    v_pk_fma_f32 v[88:89], v[66:67], v[80:81], v[92:93] op_sel:[0,0,0] op_sel_hi:[0,1,1] neg_lo:[0,0,1] neg_hi:[1,0,1]
    v_pk_mul_f32 v[94:95], v[66:67], v[82:83] op_sel:[1,1] op_sel_hi:[1,0]
    v_pk_fma_f32 v[90:91], v[66:67], v[82:83], v[94:95] op_sel:[0,0,0] op_sel_hi:[0,1,1] neg_lo:[0,0,1] neg_hi:[1,0,1]
    v_mfma_f32_16x16x4_f32 v[48:51], v86, v68, v[48:51]
    v_mfma_f32_16x16x4_f32 v[52:55], v88, v70, v[52:55]
    v_mfma_f32_16x16x4_f32 v[56:59], v88, v72, v[56:59]
    v_mfma_f32_16x16x4_f32 v[60:63], v90, v74, v[60:63]
    v_mfma_f32_16x16x4_f32 v[48:51], v87, v69, v[48:51]
    v_mfma_f32_16x16x4_f32 v[52:55], v89, v71, v[52:55]
    v_mfma_f32_16x16x4_f32 v[56:59], v89, v73, v[56:59]
    v_mfma_f32_16x16x4_f32 v[60:63], v91, v75, v[60:63]
    v_mov_b64_dpp v[64:65], v[28:29] row_newbcast:2 row_mask:0xf bank_mask:0xf
    v_mov_b64_dpp v[66:67], v[30:31] row_newbcast:2 row_mask:0xf bank_mask:0xf
    v_pk_mul_f32 v[94:95], v[64:65], v[26:27] op_sel_hi:[1,0]
    v_pk_mul_f32 v[96:97], v[64:65], v[26:27] op_sel:[0,1] op_sel_hi:[1,1]
    v_fract_f32 v95, v95
    v_fract_f32 v97, v97
    v_exp_f32 v94, v94
    v_exp_f32 v96, v96
    v_cos_f32 v68, v95
    v_sin_f32 v69, v95
    v_cos_f32 v76, v97
    v_sin_f32 v77, v97
    v_pk_mul_f32 v[68:69], v[68:69], v[94:95] op_sel_hi:[1,0]
    v_pk_mul_f32 v[76:77], v[76:77], v[96:97] op_sel_hi:[1,0]
    v_pk_mul_f32 v[92:93], v[76:77], v[76:77] op_sel:[1,1] op_sel_hi:[0,1]
    v_pk_fma_f32 v[78:79], v[76:77], v[76:77], v[92:93] op_sel:[0,0,0] op_sel_hi:[0,1,1] neg_lo:[0,0,1]
    v_pk_mul_f32 v[94:95], v[68:69], v[68:69] op_sel:[1,1] op_sel_hi:[0,1]
    v_pk_fma_f32 v[70:71], v[68:69], v[68:69], v[94:95] op_sel:[0,0,0] op_sel_hi:[0,1,1] neg_lo:[0,0,1]
    v_pk_mul_f32 v[92:93], v[78:79], v[78:79] op_sel:[1,1] op_sel_hi:[0,1]
    v_pk_fma_f32 v[80:81], v[78:79], v[78:79], v[92:93] op_sel:[0,0,0] op_sel_hi:[0,1,1] neg_lo:[0,0,1]
    v_pk_mul_f32 v[94:95], v[70:71], v[70:71] op_sel:[1,1] op_sel_hi:[0,1]
    v_pk_fma_f32 v[72:73], v[70:71], v[70:71], v[94:95] op_sel:[0,0,0] op_sel_hi:[0,1,1] neg_lo:[0,0,1]
    v_pk_mul_f32 v[92:93], v[80:81], v[80:81] op_sel:[1,1] op_sel_hi:[0,1]
    v_pk_fma_f32 v[82:83], v[80:81], v[80:81], v[92:93] op_sel:[0,0,0] op_sel_hi:[0,1,1] neg_lo:[0,0,1]
    v_pk_mul_f32 v[94:95], v[72:73], v[72:73] op_sel:[1,1] op_sel_hi:[0,1]
    v_pk_fma_f32 v[74:75], v[72:73], v[72:73], v[94:95] op_sel:[0,0,0] op_sel_hi:[0,1,1] neg_lo:[0,0,1]
    v_pk_mul_f32 v[92:93], v[82:83], v[82:83] op_sel:[1,1] op_sel_hi:[0,1]
    v_pk_fma_f32 v[84:85], v[82:83], v[82:83], v[92:93] op_sel:[0,0,0] op_sel_hi:[0,1,1] neg_lo:[0,0,1]
    v_pk_mul_f32 v[94:95], v[66:67], v[76:77] op_sel:[1,1] op_sel_hi:[1,0]
    v_pk_fma_f32 v[86:87], v[66:67], v[76:77], v[94:95] op_sel:[0,0,0] op_sel_hi:[0,1,1] neg_lo:[0,0,1] neg_hi:[1,0,1]
    v_mov_b32_dpp v80, v78 row_ror:8 row_mask:0xf bank_mask:0x3
    v_mov_b32_dpp v81, v79 row_ror:8 row_mask:0xf bank_mask:0x3
    v_mov_b32_dpp v82, v84 row_ror:8 row_mask:0xf bank_mask:0x3
    v_mov_b32_dpp v83, v85 row_ror:8 row_mask:0xf bank_mask:0x3
    v_pk_mul_f32 v[92:93], v[66:67], v[80:81] op_sel:[1,1] op_sel_hi:[1,0]
    v_pk_fma_f32 v[88:89], v[66:67], v[80:81], v[92:93] op_sel:[0,0,0] op_sel_hi:[0,1,1] neg_lo:[0,0,1] neg_hi:[1,0,1]
    v_pk_mul_f32 v[94:95], v[66:67], v[82:83] op_sel:[1,1] op_sel_hi:[1,0]
    v_pk_fma_f32 v[90:91], v[66:67], v[82:83], v[94:95] op_sel:[0,0,0] op_sel_hi:[0,1,1] neg_lo:[0,0,1] neg_hi:[1,0,1]
    v_mfma_f32_16x16x4_f32 v[48:51], v86, v68, v[48:51]
    v_mfma_f32_16x16x4_f32 v[52:55], v88, v70, v[52:55]
    v_mfma_f32_16x16x4_f32 v[56:59], v88, v72, v[56:59]
    v_mfma_f32_16x16x4_f32 v[60:63], v90, v74, v[60:63]
    v_mfma_f32_16x16x4_f32 v[48:51], v87, v69, v[48:51]
    v_mfma_f32_16x16x4_f32 v[52:55], v89, v71, v[52:55]
    v_mfma_f32_16x16x4_f32 v[56:59], v89, v73, v[56:59]
    v_mfma_f32_16x16x4_f32 v[60:63], v91, v75, v[60:63]
    v_mov_b64_dpp v[64:65], v[28:29] row_newbcast:3 row_mask:0xf bank_mask:0xf
    v_mov_b64_dpp v[66:67], v[30:31] row_newbcast:3 row_mask:0xf bank_mask:0xf
    v_pk_mul_f32 v[94:95], v[64:65], v[26:27] op_sel_hi:[1,0]
    v_pk_mul_f32 v[96:97], v[64:65], v[26:27] op_sel:[0,1] op_sel_hi:[1,1]
    v_fract_f32 v95, v95
    v_fract_f32 v97, v97
    v_exp_f32 v94, v94
    v_exp_f32 v96, v96
    v_cos_f32 v68, v95
    v_sin_f32 v69, v95
    v_cos_f32 v76, v97
    v_sin_f32 v77, v97
    v_pk_mul_f32 v[68:69], v[68:69], v[94:95] op_sel_hi:[1,0]
    v_pk_mul_f32 v[76:77], v[76:77], v[96:97] op_sel_hi:[1,0]
    v_pk_mul_f32 v[92:93], v[76:77], v[76:77] op_sel:[1,1] op_sel_hi:[0,1]
    v_pk_fma_f32 v[78:79], v[76:77], v[76:77], v[92:93] op_sel:[0,0,0] op_sel_hi:[0,1,1] neg_lo:[0,0,1]
    v_pk_mul_f32 v[94:95], v[68:69], v[68:69] op_sel:[1,1] op_sel_hi:[0,1]
    v_pk_fma_f32 v[70:71], v[68:69], v[68:69], v[94:95] op_sel:[0,0,0] op_sel_hi:[0,1,1] neg_lo:[0,0,1]
    v_pk_mul_f32 v[92:93], v[78:79], v[78:79] op_sel:[1,1] op_sel_hi:[0,1]
    v_pk_fma_f32 v[80:81], v[78:79], v[78:79], v[92:93] op_sel:[0,0,0] op_sel_hi:[0,1,1] neg_lo:[0,0,1]
    v_pk_mul_f32 v[94:95], v[70:71], v[70:71] op_sel:[1,1] op_sel_hi:[0,1]
    v_pk_fma_f32 v[72:73], v[70:71], v[70:71], v[94:95] op_sel:[0,0,0] op_sel_hi:[0,1,1] neg_lo:[0,0,1]
    v_pk_mul_f32 v[92:93], v[80:81], v[80:81] op_sel:[1,1] op_sel_hi:[0,1]
    v_pk_fma_f32 v[82:83], v[80:81], v[80:81], v[92:93] op_sel:[0,0,0] op_sel_hi:[0,1,1] neg_lo:[0,0,1]
    v_pk_mul_f32 v[94:95], v[72:73], v[72:73] op_sel:[1,1] op_sel_hi:[0,1]
    v_pk_fma_f32 v[74:75], v[72:73], v[72:73], v[94:95] op_sel:[0,0,0] op_sel_hi:[0,1,1] neg_lo:[0,0,1]
    v_pk_mul_f32 v[92:93], v[82:83], v[82:83] op_sel:[1,1] op_sel_hi:[0,1]
    v_pk_fma_f32 v[84:85], v[82:83], v[82:83], v[92:93] op_sel:[0,0,0] op_sel_hi:[0,1,1] neg_lo:[0,0,1]
    v_pk_mul_f32 v[94:95], v[66:67], v[76:77] op_sel:[1,1] op_sel_hi:[1,0]
    v_pk_fma_f32 v[86:87], v[66:67], v[76:77], v[94:95] op_sel:[0,0,0] op_sel_hi:[0,1,1] neg_lo:[0,0,1] neg_hi:[1,0,1]
    v_mov_b32_dpp v80, v78 row_ror:8 row_mask:0xf bank_mask:0x3
    v_mov_b32_dpp v81, v79 row_ror:8 row_mask:0xf bank_mask:0x3
    v_mov_b32_dpp v82, v84 row_ror:8 row_mask:0xf bank_mask:0x3
    v_mov_b32_dpp v83, v85 row_ror:8 row_mask:0xf bank_mask:0x3
    v_pk_mul_f32 v[92:93], v[66:67], v[80:81] op_sel:[1,1] op_sel_hi:[1,0]
    v_pk_fma_f32 v[88:89], v[66:67], v[80:81], v[92:93] op_sel:[0,0,0] op_sel_hi:[0,1,1] neg_lo:[0,0,1] neg_hi:[1,0,1]
    v_pk_mul_f32 v[94:95], v[66:67], v[82:83] op_sel:[1,1] op_sel_hi:[1,0]
    v_pk_fma_f32 v[90:91], v[66:67], v[82:83], v[94:95] op_sel:[0,0,0] op_sel_hi:[0,1,1] neg_lo:[0,0,1] neg_hi:[1,0,1]
    v_mfma_f32_16x16x4_f32 v[48:51], v86, v68, v[48:51]
    v_mfma_f32_16x16x4_f32 v[52:55], v88, v70, v[52:55]
    v_mfma_f32_16x16x4_f32 v[56:59], v88, v72, v[56:59]
    v_mfma_f32_16x16x4_f32 v[60:63], v90, v74, v[60:63]
    v_mfma_f32_16x16x4_f32 v[48:51], v87, v69, v[48:51]
    v_mfma_f32_16x16x4_f32 v[52:55], v89, v71, v[52:55]
    v_mfma_f32_16x16x4_f32 v[56:59], v89, v73, v[56:59]
    v_mfma_f32_16x16x4_f32 v[60:63], v91, v75, v[60:63]
    v_mov_b64_dpp v[64:65], v[28:29] row_newbcast:4 row_mask:0xf bank_mask:0xf
    v_mov_b64_dpp v[66:67], v[30:31] row_newbcast:4 row_mask:0xf bank_mask:0xf
    v_pk_mul_f32 v[94:95], v[64:65], v[26:27] op_sel_hi:[1,0]
    v_pk_mul_f32 v[96:97], v[64:65], v[26:27] op_sel:[0,1] op_sel_hi:[1,1]
    v_fract_f32 v95, v95
    v_fract_f32 v97, v97
    v_exp_f32 v94, v94
    v_exp_f32 v96, v96
    v_cos_f32 v68, v95
    v_sin_f32 v69, v95
    v_cos_f32 v76, v97
    v_sin_f32 v77, v97
    v_pk_mul_f32 v[68:69], v[68:69], v[94:95] op_sel_hi:[1,0]
    v_pk_mul_f32 v[76:77], v[76:77], v[96:97] op_sel_hi:[1,0]
    v_pk_mul_f32 v[92:93], v[76:77], v[76:77] op_sel:[1,1] op_sel_hi:[0,1]
    v_pk_fma_f32 v[78:79], v[76:77], v[76:77], v[92:93] op_sel:[0,0,0] op_sel_hi:[0,1,1] neg_lo:[0,0,1]
    v_pk_mul_f32 v[94:95], v[68:69], v[68:69] op_sel:[1,1] op_sel_hi:[0,1]
    v_pk_fma_f32 v[70:71], v[68:69], v[68:69], v[94:95] op_sel:[0,0,0] op_sel_hi:[0,1,1] neg_lo:[0,0,1]
    v_pk_mul_f32 v[92:93], v[78:79], v[78:79] op_sel:[1,1] op_sel_hi:[0,1]
    v_pk_fma_f32 v[80:81], v[78:79], v[78:79], v[92:93] op_sel:[0,0,0] op_sel_hi:[0,1,1] neg_lo:[0,0,1]
    v_pk_mul_f32 v[94:95], v[70:71], v[70:71] op_sel:[1,1] op_sel_hi:[0,1]
    v_pk_fma_f32 v[72:73], v[70:71], v[70:71], v[94:95] op_sel:[0,0,0] op_sel_hi:[0,1,1] neg_lo:[0,0,1]
    v_pk_mul_f32 v[92:93], v[80:81], v[80:81] op_sel:[1,1] op_sel_hi:[0,1]
    v_pk_fma_f32 v[82:83], v[80:81], v[80:81], v[92:93] op_sel:[0,0,0] op_sel_hi:[0,1,1] neg_lo:[0,0,1]
    v_pk_mul_f32 v[94:95], v[72:73], v[72:73] op_sel:[1,1] op_sel_hi:[0,1]
    v_pk_fma_f32 v[74:75], v[72:73], v[72:73], v[94:95] op_sel:[0,0,0] op_sel_hi:[0,1,1] neg_lo:[0,0,1]
    v_pk_mul_f32 v[92:93], v[82:83], v[82:83] op_sel:[1,1] op_sel_hi:[0,1]
    v_pk_fma_f32 v[84:85], v[82:83], v[82:83], v[92:93] op_sel:[0,0,0] op_sel_hi:[0,1,1] neg_lo:[0,0,1]
    v_pk_mul_f32 v[94:95], v[66:67], v[76:77] op_sel:[1,1] op_sel_hi:[1,0]
    v_pk_fma_f32 v[86:87], v[66:67], v[76:77], v[94:95] op_sel:[0,0,0] op_sel_hi:[0,1,1] neg_lo:[0,0,1] neg_hi:[1,0,1]
    v_mov_b32_dpp v80, v78 row_ror:8 row_mask:0xf bank_mask:0x3
    v_mov_b32_dpp v81, v79 row_ror:8 row_mask:0xf bank_mask:0x3
    v_mov_b32_dpp v82, v84 row_ror:8 row_mask:0xf bank_mask:0x3
    v_mov_b32_dpp v83, v85 row_ror:8 row_mask:0xf bank_mask:0x3
    v_pk_mul_f32 v[92:93], v[66:67], v[80:81] op_sel:[1,1] op_sel_hi:[1,0]
    v_pk_fma_f32 v[88:89], v[66:67], v[80:81], v[92:93] op_sel:[0,0,0] op_sel_hi:[0,1,1] neg_lo:[0,0,1] neg_hi:[1,0,1]
    v_pk_mul_f32 v[94:95], v[66:67], v[82:83] op_sel:[1,1] op_sel_hi:[1,0]
    v_pk_fma_f32 v[90:91], v[66:67], v[82:83], v[94:95] op_sel:[0,0,0] op_sel_hi:[0,1,1] neg_lo:[0,0,1] neg_hi:[1,0,1]
    v_mfma_f32_16x16x4_f32 v[48:51], v86, v68, v[48:51]
    v_mfma_f32_16x16x4_f32 v[52:55], v88, v70, v[52:55]
    v_mfma_f32_16x16x4_f32 v[56:59], v88, v72, v[56:59]
    v_mfma_f32_16x16x4_f32 v[60:63], v90, v74, v[60:63]
    v_mfma_f32_16x16x4_f32 v[48:51], v87, v69, v[48:51]
    v_mfma_f32_16x16x4_f32 v[52:55], v89, v71, v[52:55]
    v_mfma_f32_16x16x4_f32 v[56:59], v89, v73, v[56:59]
    v_mfma_f32_16x16x4_f32 v[60:63], v91, v75, v[60:63]
    v_mov_b64_dpp v[64:65], v[28:29] row_newbcast:5 row_mask:0xf bank_mask:0xf
    v_mov_b64_dpp v[66:67], v[30:31] row_newbcast:5 row_mask:0xf bank_mask:0xf
    v_pk_mul_f32 v[94:95], v[64:65], v[26:27] op_sel_hi:[1,0]
    v_pk_mul_f32 v[96:97], v[64:65], v[26:27] op_sel:[0,1] op_sel_hi:[1,1]
    v_fract_f32 v95, v95
    v_fract_f32 v97, v97
    v_exp_f32 v94, v94
    v_exp_f32 v96, v96
    v_cos_f32 v68, v95
    v_sin_f32 v69, v95
    v_cos_f32 v76, v97
    v_sin_f32 v77, v97
    v_pk_mul_f32 v[68:69], v[68:69], v[94:95] op_sel_hi:[1,0]
    v_pk_mul_f32 v[76:77], v[76:77], v[96:97] op_sel_hi:[1,0]
    v_pk_mul_f32 v[92:93], v[76:77], v[76:77] op_sel:[1,1] op_sel_hi:[0,1]
    v_pk_fma_f32 v[78:79], v[76:77], v[76:77], v[92:93] op_sel:[0,0,0] op_sel_hi:[0,1,1] neg_lo:[0,0,1]
    v_pk_mul_f32 v[94:95], v[68:69], v[68:69] op_sel:[1,1] op_sel_hi:[0,1]
    v_pk_fma_f32 v[70:71], v[68:69], v[68:69], v[94:95] op_sel:[0,0,0] op_sel_hi:[0,1,1] neg_lo:[0,0,1]
    v_pk_mul_f32 v[92:93], v[78:79], v[78:79] op_sel:[1,1] op_sel_hi:[0,1]
    v_pk_fma_f32 v[80:81], v[78:79], v[78:79], v[92:93] op_sel:[0,0,0] op_sel_hi:[0,1,1] neg_lo:[0,0,1]
    v_pk_mul_f32 v[94:95], v[70:71], v[70:71] op_sel:[1,1] op_sel_hi:[0,1]
    v_pk_fma_f32 v[72:73], v[70:71], v[70:71], v[94:95] op_sel:[0,0,0] op_sel_hi:[0,1,1] neg_lo:[0,0,1]
    v_pk_mul_f32 v[92:93], v[80:81], v[80:81] op_sel:[1,1] op_sel_hi:[0,1]
    v_pk_fma_f32 v[82:83], v[80:81], v[80:81], v[92:93] op_sel:[0,0,0] op_sel_hi:[0,1,1] neg_lo:[0,0,1]
    v_pk_mul_f32 v[94:95], v[72:73], v[72:73] op_sel:[1,1] op_sel_hi:[0,1]
    v_pk_fma_f32 v[74:75], v[72:73], v[72:73], v[94:95] op_sel:[0,0,0] op_sel_hi:[0,1,1] neg_lo:[0,0,1]
    v_pk_mul_f32 v[92:93], v[82:83], v[82:83] op_sel:[1,1] op_sel_hi:[0,1]
    v_pk_fma_f32 v[84:85], v[82:83], v[82:83], v[92:93] op_sel:[0,0,0] op_sel_hi:[0,1,1] neg_lo:[0,0,1]
    v_pk_mul_f32 v[94:95], v[66:67], v[76:77] op_sel:[1,1] op_sel_hi:[1,0]
    v_pk_fma_f32 v[86:87], v[66:67], v[76:77], v[94:95] op_sel:[0,0,0] op_sel_hi:[0,1,1] neg_lo:[0,0,1] neg_hi:[1,0,1]
    v_mov_b32_dpp v80, v78 row_ror:8 row_mask:0xf bank_mask:0x3
    v_mov_b32_dpp v81, v79 row_ror:8 row_mask:0xf bank_mask:0x3
    v_mov_b32_dpp v82, v84 row_ror:8 row_mask:0xf bank_mask:0x3
    v_mov_b32_dpp v83, v85 row_ror:8 row_mask:0xf bank_mask:0x3
    v_pk_mul_f32 v[92:93], v[66:67], v[80:81] op_sel:[1,1] op_sel_hi:[1,0]
    v_pk_fma_f32 v[88:89], v[66:67], v[80:81], v[92:93] op_sel:[0,0,0] op_sel_hi:[0,1,1] neg_lo:[0,0,1] neg_hi:[1,0,1]
    v_pk_mul_f32 v[94:95], v[66:67], v[82:83] op_sel:[1,1] op_sel_hi:[1,0]
    v_pk_fma_f32 v[90:91], v[66:67], v[82:83], v[94:95] op_sel:[0,0,0] op_sel_hi:[0,1,1] neg_lo:[0,0,1] neg_hi:[1,0,1]
    v_mfma_f32_16x16x4_f32 v[48:51], v86, v68, v[48:51]
    v_mfma_f32_16x16x4_f32 v[52:55], v88, v70, v[52:55]
    v_mfma_f32_16x16x4_f32 v[56:59], v88, v72, v[56:59]
    v_mfma_f32_16x16x4_f32 v[60:63], v90, v74, v[60:63]
    v_mfma_f32_16x16x4_f32 v[48:51], v87, v69, v[48:51]
    v_mfma_f32_16x16x4_f32 v[52:55], v89, v71, v[52:55]
    v_mfma_f32_16x16x4_f32 v[56:59], v89, v73, v[56:59]
    v_mfma_f32_16x16x4_f32 v[60:63], v91, v75, v[60:63]
    v_mov_b64_dpp v[64:65], v[28:29] row_newbcast:6 row_mask:0xf bank_mask:0xf
    v_mov_b64_dpp v[66:67], v[30:31] row_newbcast:6 row_mask:0xf bank_mask:0xf
    v_pk_mul_f32 v[94:95], v[64:65], v[26:27] op_sel_hi:[1,0]
    v_pk_mul_f32 v[96:97], v[64:65], v[26:27] op_sel:[0,1] op_sel_hi:[1,1]
    v_fract_f32 v95, v95
    v_fract_f32 v97, v97
    v_exp_f32 v94, v94
    v_exp_f32 v96, v96
    v_cos_f32 v68, v95
    v_sin_f32 v69, v95
    v_cos_f32 v76, v97
    v_sin_f32 v77, v97
    v_pk_mul_f32 v[68:69], v[68:69], v[94:95] op_sel_hi:[1,0]
    v_pk_mul_f32 v[76:77], v[76:77], v[96:97] op_sel_hi:[1,0]
    v_pk_mul_f32 v[92:93], v[76:77], v[76:77] op_sel:[1,1] op_sel_hi:[0,1]
    v_pk_fma_f32 v[78:79], v[76:77], v[76:77], v[92:93] op_sel:[0,0,0] op_sel_hi:[0,1,1] neg_lo:[0,0,1]
    v_pk_mul_f32 v[94:95], v[68:69], v[68:69] op_sel:[1,1] op_sel_hi:[0,1]
    v_pk_fma_f32 v[70:71], v[68:69], v[68:69], v[94:95] op_sel:[0,0,0] op_sel_hi:[0,1,1] neg_lo:[0,0,1]
    v_pk_mul_f32 v[92:93], v[78:79], v[78:79] op_sel:[1,1] op_sel_hi:[0,1]
    v_pk_fma_f32 v[80:81], v[78:79], v[78:79], v[92:93] op_sel:[0,0,0] op_sel_hi:[0,1,1] neg_lo:[0,0,1]
    v_pk_mul_f32 v[94:95], v[70:71], v[70:71] op_sel:[1,1] op_sel_hi:[0,1]
    v_pk_fma_f32 v[72:73], v[70:71], v[70:71], v[94:95] op_sel:[0,0,0] op_sel_hi:[0,1,1] neg_lo:[0,0,1]
    v_pk_mul_f32 v[92:93], v[80:81], v[80:81] op_sel:[1,1] op_sel_hi:[0,1]
    v_pk_fma_f32 v[82:83], v[80:81], v[80:81], v[92:93] op_sel:[0,0,0] op_sel_hi:[0,1,1] neg_lo:[0,0,1]
    v_pk_mul_f32 v[94:95], v[72:73], v[72:73] op_sel:[1,1] op_sel_hi:[0,1]
    v_pk_fma_f32 v[74:75], v[72:73], v[72:73], v[94:95] op_sel:[0,0,0] op_sel_hi:[0,1,1] neg_lo:[0,0,1]
    v_pk_mul_f32 v[92:93], v[82:83], v[82:83] op_sel:[1,1] op_sel_hi:[0,1]
    v_pk_fma_f32 v[84:85], v[82:83], v[82:83], v[92:93] op_sel:[0,0,0] op_sel_hi:[0,1,1] neg_lo:[0,0,1]
    v_pk_mul_f32 v[94:95], v[66:67], v[76:77] op_sel:[1,1] op_sel_hi:[1,0]
    v_pk_fma_f32 v[86:87], v[66:67], v[76:77], v[94:95] op_sel:[0,0,0] op_sel_hi:[0,1,1] neg_lo:[0,0,1] neg_hi:[1,0,1]
    v_mov_b32_dpp v80, v78 row_ror:8 row_mask:0xf bank_mask:0x3
    v_mov_b32_dpp v81, v79 row_ror:8 row_mask:0xf bank_mask:0x3
    v_mov_b32_dpp v82, v84 row_ror:8 row_mask:0xf bank_mask:0x3
    v_mov_b32_dpp v83, v85 row_ror:8 row_mask:0xf bank_mask:0x3
    v_pk_mul_f32 v[92:93], v[66:67], v[80:81] op_sel:[1,1] op_sel_hi:[1,0]
    v_pk_fma_f32 v[88:89], v[66:67], v[80:81], v[92:93] op_sel:[0,0,0] op_sel_hi:[0,1,1] neg_lo:[0,0,1] neg_hi:[1,0,1]
    v_pk_mul_f32 v[94:95], v[66:67], v[82:83] op_sel:[1,1] op_sel_hi:[1,0]
    v_pk_fma_f32 v[90:91], v[66:67], v[82:83], v[94:95] op_sel:[0,0,0] op_sel_hi:[0,1,1] neg_lo:[0,0,1] neg_hi:[1,0,1]
    v_mfma_f32_16x16x4_f32 v[48:51], v86, v68, v[48:51]
    v_mfma_f32_16x16x4_f32 v[52:55], v88, v70, v[52:55]
    v_mfma_f32_16x16x4_f32 v[56:59], v88, v72, v[56:59]
    v_mfma_f32_16x16x4_f32 v[60:63], v90, v74, v[60:63]
    v_mfma_f32_16x16x4_f32 v[48:51], v87, v69, v[48:51]
    v_mfma_f32_16x16x4_f32 v[52:55], v89, v71, v[52:55]
    v_mfma_f32_16x16x4_f32 v[56:59], v89, v73, v[56:59]
    v_mfma_f32_16x16x4_f32 v[60:63], v91, v75, v[60:63]
    v_mov_b64_dpp v[64:65], v[28:29] row_newbcast:7 row_mask:0xf bank_mask:0xf
    v_mov_b64_dpp v[66:67], v[30:31] row_newbcast:7 row_mask:0xf bank_mask:0xf
    v_pk_mul_f32 v[94:95], v[64:65], v[26:27] op_sel_hi:[1,0]
    v_pk_mul_f32 v[96:97], v[64:65], v[26:27] op_sel:[0,1] op_sel_hi:[1,1]
    v_fract_f32 v95, v95
    v_fract_f32 v97, v97
    v_exp_f32 v94, v94
    v_exp_f32 v96, v96
    v_cos_f32 v68, v95
    v_sin_f32 v69, v95
    v_cos_f32 v76, v97
    v_sin_f32 v77, v97
    v_pk_mul_f32 v[68:69], v[68:69], v[94:95] op_sel_hi:[1,0]
    v_pk_mul_f32 v[76:77], v[76:77], v[96:97] op_sel_hi:[1,0]
    v_pk_mul_f32 v[92:93], v[76:77], v[76:77] op_sel:[1,1] op_sel_hi:[0,1]
    v_pk_fma_f32 v[78:79], v[76:77], v[76:77], v[92:93] op_sel:[0,0,0] op_sel_hi:[0,1,1] neg_lo:[0,0,1]
    v_pk_mul_f32 v[94:95], v[68:69], v[68:69] op_sel:[1,1] op_sel_hi:[0,1]
    v_pk_fma_f32 v[70:71], v[68:69], v[68:69], v[94:95] op_sel:[0,0,0] op_sel_hi:[0,1,1] neg_lo:[0,0,1]
    v_pk_mul_f32 v[92:93], v[78:79], v[78:79] op_sel:[1,1] op_sel_hi:[0,1]
    v_pk_fma_f32 v[80:81], v[78:79], v[78:79], v[92:93] op_sel:[0,0,0] op_sel_hi:[0,1,1] neg_lo:[0,0,1]
    v_pk_mul_f32 v[94:95], v[70:71], v[70:71] op_sel:[1,1] op_sel_hi:[0,1]
    v_pk_fma_f32 v[72:73], v[70:71], v[70:71], v[94:95] op_sel:[0,0,0] op_sel_hi:[0,1,1] neg_lo:[0,0,1]
    v_pk_mul_f32 v[92:93], v[80:81], v[80:81] op_sel:[1,1] op_sel_hi:[0,1]
    v_pk_fma_f32 v[82:83], v[80:81], v[80:81], v[92:93] op_sel:[0,0,0] op_sel_hi:[0,1,1] neg_lo:[0,0,1]
    v_pk_mul_f32 v[94:95], v[72:73], v[72:73] op_sel:[1,1] op_sel_hi:[0,1]
    v_pk_fma_f32 v[74:75], v[72:73], v[72:73], v[94:95] op_sel:[0,0,0] op_sel_hi:[0,1,1] neg_lo:[0,0,1]
    v_pk_mul_f32 v[92:93], v[82:83], v[82:83] op_sel:[1,1] op_sel_hi:[0,1]
    v_pk_fma_f32 v[84:85], v[82:83], v[82:83], v[92:93] op_sel:[0,0,0] op_sel_hi:[0,1,1] neg_lo:[0,0,1]
    v_pk_mul_f32 v[94:95], v[66:67], v[76:77] op_sel:[1,1] op_sel_hi:[1,0]
    v_pk_fma_f32 v[86:87], v[66:67], v[76:77], v[94:95] op_sel:[0,0,0] op_sel_hi:[0,1,1] neg_lo:[0,0,1] neg_hi:[1,0,1]
    v_mov_b32_dpp v80, v78 row_ror:8 row_mask:0xf bank_mask:0x3
    v_mov_b32_dpp v81, v79 row_ror:8 row_mask:0xf bank_mask:0x3
    v_mov_b32_dpp v82, v84 row_ror:8 row_mask:0xf bank_mask:0x3
    v_mov_b32_dpp v83, v85 row_ror:8 row_mask:0xf bank_mask:0x3
    v_pk_mul_f32 v[92:93], v[66:67], v[80:81] op_sel:[1,1] op_sel_hi:[1,0]
    v_pk_fma_f32 v[88:89], v[66:67], v[80:81], v[92:93] op_sel:[0,0,0] op_sel_hi:[0,1,1] neg_lo:[0,0,1] neg_hi:[1,0,1]
    v_pk_mul_f32 v[94:95], v[66:67], v[82:83] op_sel:[1,1] op_sel_hi:[1,0]
    v_pk_fma_f32 v[90:91], v[66:67], v[82:83], v[94:95] op_sel:[0,0,0] op_sel_hi:[0,1,1] neg_lo:[0,0,1] neg_hi:[1,0,1]
    v_mfma_f32_16x16x4_f32 v[48:51], v86, v68, v[48:51]
    v_mfma_f32_16x16x4_f32 v[52:55], v88, v70, v[52:55]
    v_mfma_f32_16x16x4_f32 v[56:59], v88, v72, v[56:59]
    v_mfma_f32_16x16x4_f32 v[60:63], v90, v74, v[60:63]
    v_mfma_f32_16x16x4_f32 v[48:51], v87, v69, v[48:51]
    v_mfma_f32_16x16x4_f32 v[52:55], v89, v71, v[52:55]
    v_mfma_f32_16x16x4_f32 v[56:59], v89, v73, v[56:59]
    v_mfma_f32_16x16x4_f32 v[60:63], v91, v75, v[60:63]
    v_mov_b64_dpp v[64:65], v[28:29] row_newbcast:8 row_mask:0xf bank_mask:0xf
    v_mov_b64_dpp v[66:67], v[30:31] row_newbcast:8 row_mask:0xf bank_mask:0xf
    v_pk_mul_f32 v[94:95], v[64:65], v[26:27] op_sel_hi:[1,0]
    v_pk_mul_f32 v[96:97], v[64:65], v[26:27] op_sel:[0,1] op_sel_hi:[1,1]
    v_fract_f32 v95, v95
    v_fract_f32 v97, v97
    v_exp_f32 v94, v94
    v_exp_f32 v96, v96
    v_cos_f32 v68, v95
    v_sin_f32 v69, v95
    v_cos_f32 v76, v97
    v_sin_f32 v77, v97
    v_pk_mul_f32 v[68:69], v[68:69], v[94:95] op_sel_hi:[1,0]
    v_pk_mul_f32 v[76:77], v[76:77], v[96:97] op_sel_hi:[1,0]
    v_pk_mul_f32 v[92:93], v[76:77], v[76:77] op_sel:[1,1] op_sel_hi:[0,1]
    v_pk_fma_f32 v[78:79], v[76:77], v[76:77], v[92:93] op_sel:[0,0,0] op_sel_hi:[0,1,1] neg_lo:[0,0,1]
    v_pk_mul_f32 v[94:95], v[68:69], v[68:69] op_sel:[1,1] op_sel_hi:[0,1]
    v_pk_fma_f32 v[70:71], v[68:69], v[68:69], v[94:95] op_sel:[0,0,0] op_sel_hi:[0,1,1] neg_lo:[0,0,1]
    v_pk_mul_f32 v[92:93], v[78:79], v[78:79] op_sel:[1,1] op_sel_hi:[0,1]
    v_pk_fma_f32 v[80:81], v[78:79], v[78:79], v[92:93] op_sel:[0,0,0] op_sel_hi:[0,1,1] neg_lo:[0,0,1]
    v_pk_mul_f32 v[94:95], v[70:71], v[70:71] op_sel:[1,1] op_sel_hi:[0,1]
    v_pk_fma_f32 v[72:73], v[70:71], v[70:71], v[94:95] op_sel:[0,0,0] op_sel_hi:[0,1,1] neg_lo:[0,0,1]
    v_pk_mul_f32 v[92:93], v[80:81], v[80:81] op_sel:[1,1] op_sel_hi:[0,1]
    v_pk_fma_f32 v[82:83], v[80:81], v[80:81], v[92:93] op_sel:[0,0,0] op_sel_hi:[0,1,1] neg_lo:[0,0,1]
    v_pk_mul_f32 v[94:95], v[72:73], v[72:73] op_sel:[1,1] op_sel_hi:[0,1]
    v_pk_fma_f32 v[74:75], v[72:73], v[72:73], v[94:95] op_sel:[0,0,0] op_sel_hi:[0,1,1] neg_lo:[0,0,1]
    v_pk_mul_f32 v[92:93], v[82:83], v[82:83] op_sel:[1,1] op_sel_hi:[0,1]
    v_pk_fma_f32 v[84:85], v[82:83], v[82:83], v[92:93] op_sel:[0,0,0] op_sel_hi:[0,1,1] neg_lo:[0,0,1]
    v_pk_mul_f32 v[94:95], v[66:67], v[76:77] op_sel:[1,1] op_sel_hi:[1,0]
    v_pk_fma_f32 v[86:87], v[66:67], v[76:77], v[94:95] op_sel:[0,0,0] op_sel_hi:[0,1,1] neg_lo:[0,0,1] neg_hi:[1,0,1]
    v_mov_b32_dpp v80, v78 row_ror:8 row_mask:0xf bank_mask:0x3
    v_mov_b32_dpp v81, v79 row_ror:8 row_mask:0xf bank_mask:0x3
    v_mov_b32_dpp v82, v84 row_ror:8 row_mask:0xf bank_mask:0x3
    v_mov_b32_dpp v83, v85 row_ror:8 row_mask:0xf bank_mask:0x3
    v_pk_mul_f32 v[92:93], v[66:67], v[80:81] op_sel:[1,1] op_sel_hi:[1,0]
    v_pk_fma_f32 v[88:89], v[66:67], v[80:81], v[92:93] op_sel:[0,0,0] op_sel_hi:[0,1,1] neg_lo:[0,0,1] neg_hi:[1,0,1]
    v_pk_mul_f32 v[94:95], v[66:67], v[82:83] op_sel:[1,1] op_sel_hi:[1,0]
    v_pk_fma_f32 v[90:91], v[66:67], v[82:83], v[94:95] op_sel:[0,0,0] op_sel_hi:[0,1,1] neg_lo:[0,0,1] neg_hi:[1,0,1]
    v_mfma_f32_16x16x4_f32 v[48:51], v86, v68, v[48:51]
    v_mfma_f32_16x16x4_f32 v[52:55], v88, v70, v[52:55]
    v_mfma_f32_16x16x4_f32 v[56:59], v88, v72, v[56:59]
    v_mfma_f32_16x16x4_f32 v[60:63], v90, v74, v[60:63]
    v_mfma_f32_16x16x4_f32 v[48:51], v87, v69, v[48:51]
    v_mfma_f32_16x16x4_f32 v[52:55], v89, v71, v[52:55]
    v_mfma_f32_16x16x4_f32 v[56:59], v89, v73, v[56:59]
    v_mfma_f32_16x16x4_f32 v[60:63], v91, v75, v[60:63]
    v_mov_b64_dpp v[64:65], v[28:29] row_newbcast:9 row_mask:0xf bank_mask:0xf
    v_mov_b64_dpp v[66:67], v[30:31] row_newbcast:9 row_mask:0xf bank_mask:0xf
    v_pk_mul_f32 v[94:95], v[64:65], v[26:27] op_sel_hi:[1,0]
    v_pk_mul_f32 v[96:97], v[64:65], v[26:27] op_sel:[0,1] op_sel_hi:[1,1]
    v_fract_f32 v95, v95
    v_fract_f32 v97, v97
    v_exp_f32 v94, v94
    v_exp_f32 v96, v96
    v_cos_f32 v68, v95
    v_sin_f32 v69, v95
    v_cos_f32 v76, v97
    v_sin_f32 v77, v97
    v_pk_mul_f32 v[68:69], v[68:69], v[94:95] op_sel_hi:[1,0]
    v_pk_mul_f32 v[76:77], v[76:77], v[96:97] op_sel_hi:[1,0]
    v_pk_mul_f32 v[92:93], v[76:77], v[76:77] op_sel:[1,1] op_sel_hi:[0,1]
    v_pk_fma_f32 v[78:79], v[76:77], v[76:77], v[92:93] op_sel:[0,0,0] op_sel_hi:[0,1,1] neg_lo:[0,0,1]
    v_pk_mul_f32 v[94:95], v[68:69], v[68:69] op_sel:[1,1] op_sel_hi:[0,1]
    v_pk_fma_f32 v[70:71], v[68:69], v[68:69], v[94:95] op_sel:[0,0,0] op_sel_hi:[0,1,1] neg_lo:[0,0,1]
    v_pk_mul_f32 v[92:93], v[78:79], v[78:79] op_sel:[1,1] op_sel_hi:[0,1]
    v_pk_fma_f32 v[80:81], v[78:79], v[78:79], v[92:93] op_sel:[0,0,0] op_sel_hi:[0,1,1] neg_lo:[0,0,1]
    v_pk_mul_f32 v[94:95], v[70:71], v[70:71] op_sel:[1,1] op_sel_hi:[0,1]
    v_pk_fma_f32 v[72:73], v[70:71], v[70:71], v[94:95] op_sel:[0,0,0] op_sel_hi:[0,1,1] neg_lo:[0,0,1]
    v_pk_mul_f32 v[92:93], v[80:81], v[80:81] op_sel:[1,1] op_sel_hi:[0,1]
    v_pk_fma_f32 v[82:83], v[80:81], v[80:81], v[92:93] op_sel:[0,0,0] op_sel_hi:[0,1,1] neg_lo:[0,0,1]
    v_pk_mul_f32 v[94:95], v[72:73], v[72:73] op_sel:[1,1] op_sel_hi:[0,1]
    v_pk_fma_f32 v[74:75], v[72:73], v[72:73], v[94:95] op_sel:[0,0,0] op_sel_hi:[0,1,1] neg_lo:[0,0,1]
    v_pk_mul_f32 v[92:93], v[82:83], v[82:83] op_sel:[1,1] op_sel_hi:[0,1]
    v_pk_fma_f32 v[84:85], v[82:83], v[82:83], v[92:93] op_sel:[0,0,0] op_sel_hi:[0,1,1] neg_lo:[0,0,1]
    v_pk_mul_f32 v[94:95], v[66:67], v[76:77] op_sel:[1,1] op_sel_hi:[1,0]
    v_pk_fma_f32 v[86:87], v[66:67], v[76:77], v[94:95] op_sel:[0,0,0] op_sel_hi:[0,1,1] neg_lo:[0,0,1] neg_hi:[1,0,1]
    v_mov_b32_dpp v80, v78 row_ror:8 row_mask:0xf bank_mask:0x3
    v_mov_b32_dpp v81, v79 row_ror:8 row_mask:0xf bank_mask:0x3
    v_mov_b32_dpp v82, v84 row_ror:8 row_mask:0xf bank_mask:0x3
    v_mov_b32_dpp v83, v85 row_ror:8 row_mask:0xf bank_mask:0x3
    v_pk_mul_f32 v[92:93], v[66:67], v[80:81] op_sel:[1,1] op_sel_hi:[1,0]
    v_pk_fma_f32 v[88:89], v[66:67], v[80:81], v[92:93] op_sel:[0,0,0] op_sel_hi:[0,1,1] neg_lo:[0,0,1] neg_hi:[1,0,1]
    v_pk_mul_f32 v[94:95], v[66:67], v[82:83] op_sel:[1,1] op_sel_hi:[1,0]
    v_pk_fma_f32 v[90:91], v[66:67], v[82:83], v[94:95] op_sel:[0,0,0] op_sel_hi:[0,1,1] neg_lo:[0,0,1] neg_hi:[1,0,1]
    v_mfma_f32_16x16x4_f32 v[48:51], v86, v68, v[48:51]
    v_mfma_f32_16x16x4_f32 v[52:55], v88, v70, v[52:55]
    v_mfma_f32_16x16x4_f32 v[56:59], v88, v72, v[56:59]
    v_mfma_f32_16x16x4_f32 v[60:63], v90, v74, v[60:63]
    v_mfma_f32_16x16x4_f32 v[48:51], v87, v69, v[48:51]
    v_mfma_f32_16x16x4_f32 v[52:55], v89, v71, v[52:55]
    v_mfma_f32_16x16x4_f32 v[56:59], v89, v73, v[56:59]
    v_mfma_f32_16x16x4_f32 v[60:63], v91, v75, v[60:63]
    v_mov_b64_dpp v[64:65], v[28:29] row_newbcast:10 row_mask:0xf bank_mask:0xf
    v_mov_b64_dpp v[66:67], v[30:31] row_newbcast:10 row_mask:0xf bank_mask:0xf
    v_pk_mul_f32 v[94:95], v[64:65], v[26:27] op_sel_hi:[1,0]
    v_pk_mul_f32 v[96:97], v[64:65], v[26:27] op_sel:[0,1] op_sel_hi:[1,1]
    v_fract_f32 v95, v95
    v_fract_f32 v97, v97
    v_exp_f32 v94, v94
    v_exp_f32 v96, v96
    v_cos_f32 v68, v95
    v_sin_f32 v69, v95
    v_cos_f32 v76, v97
    v_sin_f32 v77, v97
    v_pk_mul_f32 v[68:69], v[68:69], v[94:95] op_sel_hi:[1,0]
    v_pk_mul_f32 v[76:77], v[76:77], v[96:97] op_sel_hi:[1,0]
    v_pk_mul_f32 v[92:93], v[76:77], v[76:77] op_sel:[1,1] op_sel_hi:[0,1]
    v_pk_fma_f32 v[78:79], v[76:77], v[76:77], v[92:93] op_sel:[0,0,0] op_sel_hi:[0,1,1] neg_lo:[0,0,1]
    v_pk_mul_f32 v[94:95], v[68:69], v[68:69] op_sel:[1,1] op_sel_hi:[0,1]
    v_pk_fma_f32 v[70:71], v[68:69], v[68:69], v[94:95] op_sel:[0,0,0] op_sel_hi:[0,1,1] neg_lo:[0,0,1]
    v_pk_mul_f32 v[92:93], v[78:79], v[78:79] op_sel:[1,1] op_sel_hi:[0,1]
    v_pk_fma_f32 v[80:81], v[78:79], v[78:79], v[92:93] op_sel:[0,0,0] op_sel_hi:[0,1,1] neg_lo:[0,0,1]
    v_pk_mul_f32 v[94:95], v[70:71], v[70:71] op_sel:[1,1] op_sel_hi:[0,1]
    v_pk_fma_f32 v[72:73], v[70:71], v[70:71], v[94:95] op_sel:[0,0,0] op_sel_hi:[0,1,1] neg_lo:[0,0,1]
    v_pk_mul_f32 v[92:93], v[80:81], v[80:81] op_sel:[1,1] op_sel_hi:[0,1]
    v_pk_fma_f32 v[82:83], v[80:81], v[80:81], v[92:93] op_sel:[0,0,0] op_sel_hi:[0,1,1] neg_lo:[0,0,1]
    v_pk_mul_f32 v[94:95], v[72:73], v[72:73] op_sel:[1,1] op_sel_hi:[0,1]
    v_pk_fma_f32 v[74:75], v[72:73], v[72:73], v[94:95] op_sel:[0,0,0] op_sel_hi:[0,1,1] neg_lo:[0,0,1]
    v_pk_mul_f32 v[92:93], v[82:83], v[82:83] op_sel:[1,1] op_sel_hi:[0,1]
    v_pk_fma_f32 v[84:85], v[82:83], v[82:83], v[92:93] op_sel:[0,0,0] op_sel_hi:[0,1,1] neg_lo:[0,0,1]
    v_pk_mul_f32 v[94:95], v[66:67], v[76:77] op_sel:[1,1] op_sel_hi:[1,0]
    v_pk_fma_f32 v[86:87], v[66:67], v[76:77], v[94:95] op_sel:[0,0,0] op_sel_hi:[0,1,1] neg_lo:[0,0,1] neg_hi:[1,0,1]
    v_mov_b32_dpp v80, v78 row_ror:8 row_mask:0xf bank_mask:0x3
    v_mov_b32_dpp v81, v79 row_ror:8 row_mask:0xf bank_mask:0x3
    v_mov_b32_dpp v82, v84 row_ror:8 row_mask:0xf bank_mask:0x3
    v_mov_b32_dpp v83, v85 row_ror:8 row_mask:0xf bank_mask:0x3
    v_pk_mul_f32 v[92:93], v[66:67], v[80:81] op_sel:[1,1] op_sel_hi:[1,0]
    v_pk_fma_f32 v[88:89], v[66:67], v[80:81], v[92:93] op_sel:[0,0,0] op_sel_hi:[0,1,1] neg_lo:[0,0,1] neg_hi:[1,0,1]
    v_pk_mul_f32 v[94:95], v[66:67], v[82:83] op_sel:[1,1] op_sel_hi:[1,0]
    v_pk_fma_f32 v[90:91], v[66:67], v[82:83], v[94:95] op_sel:[0,0,0] op_sel_hi:[0,1,1] neg_lo:[0,0,1] neg_hi:[1,0,1]
    v_mfma_f32_16x16x4_f32 v[48:51], v86, v68, v[48:51]
    v_mfma_f32_16x16x4_f32 v[52:55], v88, v70, v[52:55]
    v_mfma_f32_16x16x4_f32 v[56:59], v88, v72, v[56:59]
    v_mfma_f32_16x16x4_f32 v[60:63], v90, v74, v[60:63]
    v_mfma_f32_16x16x4_f32 v[48:51], v87, v69, v[48:51]
    v_mfma_f32_16x16x4_f32 v[52:55], v89, v71, v[52:55]
    v_mfma_f32_16x16x4_f32 v[56:59], v89, v73, v[56:59]
    v_mfma_f32_16x16x4_f32 v[60:63], v91, v75, v[60:63]
    v_mov_b64_dpp v[64:65], v[28:29] row_newbcast:11 row_mask:0xf bank_mask:0xf
    v_mov_b64_dpp v[66:67], v[30:31] row_newbcast:11 row_mask:0xf bank_mask:0xf
    v_pk_mul_f32 v[94:95], v[64:65], v[26:27] op_sel_hi:[1,0]
    v_pk_mul_f32 v[96:97], v[64:65], v[26:27] op_sel:[0,1] op_sel_hi:[1,1]
    v_fract_f32 v95, v95
    v_fract_f32 v97, v97
    v_exp_f32 v94, v94
    v_exp_f32 v96, v96
    v_cos_f32 v68, v95
    v_sin_f32 v69, v95
    v_cos_f32 v76, v97
    v_sin_f32 v77, v97
    v_pk_mul_f32 v[68:69], v[68:69], v[94:95] op_sel_hi:[1,0]
    v_pk_mul_f32 v[76:77], v[76:77], v[96:97] op_sel_hi:[1,0]
    v_pk_mul_f32 v[92:93], v[76:77], v[76:77] op_sel:[1,1] op_sel_hi:[0,1]
    v_pk_fma_f32 v[78:79], v[76:77], v[76:77], v[92:93] op_sel:[0,0,0] op_sel_hi:[0,1,1] neg_lo:[0,0,1]
    v_pk_mul_f32 v[94:95], v[68:69], v[68:69] op_sel:[1,1] op_sel_hi:[0,1]
    v_pk_fma_f32 v[70:71], v[68:69], v[68:69], v[94:95] op_sel:[0,0,0] op_sel_hi:[0,1,1] neg_lo:[0,0,1]
    v_pk_mul_f32 v[92:93], v[78:79], v[78:79] op_sel:[1,1] op_sel_hi:[0,1]
    v_pk_fma_f32 v[80:81], v[78:79], v[78:79], v[92:93] op_sel:[0,0,0] op_sel_hi:[0,1,1] neg_lo:[0,0,1]
    v_pk_mul_f32 v[94:95], v[70:71], v[70:71] op_sel:[1,1] op_sel_hi:[0,1]
    v_pk_fma_f32 v[72:73], v[70:71], v[70:71], v[94:95] op_sel:[0,0,0] op_sel_hi:[0,1,1] neg_lo:[0,0,1]
    v_pk_mul_f32 v[92:93], v[80:81], v[80:81] op_sel:[1,1] op_sel_hi:[0,1]
    v_pk_fma_f32 v[82:83], v[80:81], v[80:81], v[92:93] op_sel:[0,0,0] op_sel_hi:[0,1,1] neg_lo:[0,0,1]
    v_pk_mul_f32 v[94:95], v[72:73], v[72:73] op_sel:[1,1] op_sel_hi:[0,1]
    v_pk_fma_f32 v[74:75], v[72:73], v[72:73], v[94:95] op_sel:[0,0,0] op_sel_hi:[0,1,1] neg_lo:[0,0,1]
    v_pk_mul_f32 v[92:93], v[82:83], v[82:83] op_sel:[1,1] op_sel_hi:[0,1]
    v_pk_fma_f32 v[84:85], v[82:83], v[82:83], v[92:93] op_sel:[0,0,0] op_sel_hi:[0,1,1] neg_lo:[0,0,1]
    v_pk_mul_f32 v[94:95], v[66:67], v[76:77] op_sel:[1,1] op_sel_hi:[1,0]
    v_pk_fma_f32 v[86:87], v[66:67], v[76:77], v[94:95] op_sel:[0,0,0] op_sel_hi:[0,1,1] neg_lo:[0,0,1] neg_hi:[1,0,1]
    v_mov_b32_dpp v80, v78 row_ror:8 row_mask:0xf bank_mask:0x3
    v_mov_b32_dpp v81, v79 row_ror:8 row_mask:0xf bank_mask:0x3
    v_mov_b32_dpp v82, v84 row_ror:8 row_mask:0xf bank_mask:0x3
    v_mov_b32_dpp v83, v85 row_ror:8 row_mask:0xf bank_mask:0x3
    v_pk_mul_f32 v[92:93], v[66:67], v[80:81] op_sel:[1,1] op_sel_hi:[1,0]
    v_pk_fma_f32 v[88:89], v[66:67], v[80:81], v[92:93] op_sel:[0,0,0] op_sel_hi:[0,1,1] neg_lo:[0,0,1] neg_hi:[1,0,1]
    v_pk_mul_f32 v[94:95], v[66:67], v[82:83] op_sel:[1,1] op_sel_hi:[1,0]
    v_pk_fma_f32 v[90:91], v[66:67], v[82:83], v[94:95] op_sel:[0,0,0] op_sel_hi:[0,1,1] neg_lo:[0,0,1] neg_hi:[1,0,1]
    v_mfma_f32_16x16x4_f32 v[48:51], v86, v68, v[48:51]
    v_mfma_f32_16x16x4_f32 v[52:55], v88, v70, v[52:55]
    v_mfma_f32_16x16x4_f32 v[56:59], v88, v72, v[56:59]
    v_mfma_f32_16x16x4_f32 v[60:63], v90, v74, v[60:63]
    v_mfma_f32_16x16x4_f32 v[48:51], v87, v69, v[48:51]
    v_mfma_f32_16x16x4_f32 v[52:55], v89, v71, v[52:55]
    v_mfma_f32_16x16x4_f32 v[56:59], v89, v73, v[56:59]
    v_mfma_f32_16x16x4_f32 v[60:63], v91, v75, v[60:63]
    v_mov_b64_dpp v[64:65], v[28:29] row_newbcast:12 row_mask:0xf bank_mask:0xf
    v_mov_b64_dpp v[66:67], v[30:31] row_newbcast:12 row_mask:0xf bank_mask:0xf
    v_pk_mul_f32 v[94:95], v[64:65], v[26:27] op_sel_hi:[1,0]
    v_pk_mul_f32 v[96:97], v[64:65], v[26:27] op_sel:[0,1] op_sel_hi:[1,1]
    v_fract_f32 v95, v95
    v_fract_f32 v97, v97
    v_exp_f32 v94, v94
    v_exp_f32 v96, v96
    v_cos_f32 v68, v95
    v_sin_f32 v69, v95
    v_cos_f32 v76, v97
    v_sin_f32 v77, v97
    v_pk_mul_f32 v[68:69], v[68:69], v[94:95] op_sel_hi:[1,0]
    v_pk_mul_f32 v[76:77], v[76:77], v[96:97] op_sel_hi:[1,0]
    v_pk_mul_f32 v[92:93], v[76:77], v[76:77] op_sel:[1,1] op_sel_hi:[0,1]
    v_pk_fma_f32 v[78:79], v[76:77], v[76:77], v[92:93] op_sel:[0,0,0] op_sel_hi:[0,1,1] neg_lo:[0,0,1]
    v_pk_mul_f32 v[94:95], v[68:69], v[68:69] op_sel:[1,1] op_sel_hi:[0,1]
    v_pk_fma_f32 v[70:71], v[68:69], v[68:69], v[94:95] op_sel:[0,0,0] op_sel_hi:[0,1,1] neg_lo:[0,0,1]
    v_pk_mul_f32 v[92:93], v[78:79], v[78:79] op_sel:[1,1] op_sel_hi:[0,1]
    v_pk_fma_f32 v[80:81], v[78:79], v[78:79], v[92:93] op_sel:[0,0,0] op_sel_hi:[0,1,1] neg_lo:[0,0,1]
    v_pk_mul_f32 v[94:95], v[70:71], v[70:71] op_sel:[1,1] op_sel_hi:[0,1]
    v_pk_fma_f32 v[72:73], v[70:71], v[70:71], v[94:95] op_sel:[0,0,0] op_sel_hi:[0,1,1] neg_lo:[0,0,1]
    v_pk_mul_f32 v[92:93], v[80:81], v[80:81] op_sel:[1,1] op_sel_hi:[0,1]
    v_pk_fma_f32 v[82:83], v[80:81], v[80:81], v[92:93] op_sel:[0,0,0] op_sel_hi:[0,1,1] neg_lo:[0,0,1]
    v_pk_mul_f32 v[94:95], v[72:73], v[72:73] op_sel:[1,1] op_sel_hi:[0,1]
    v_pk_fma_f32 v[74:75], v[72:73], v[72:73], v[94:95] op_sel:[0,0,0] op_sel_hi:[0,1,1] neg_lo:[0,0,1]
    v_pk_mul_f32 v[92:93], v[82:83], v[82:83] op_sel:[1,1] op_sel_hi:[0,1]
    v_pk_fma_f32 v[84:85], v[82:83], v[82:83], v[92:93] op_sel:[0,0,0] op_sel_hi:[0,1,1] neg_lo:[0,0,1]
    v_pk_mul_f32 v[94:95], v[66:67], v[76:77] op_sel:[1,1] op_sel_hi:[1,0]
    v_pk_fma_f32 v[86:87], v[66:67], v[76:77], v[94:95] op_sel:[0,0,0] op_sel_hi:[0,1,1] neg_lo:[0,0,1] neg_hi:[1,0,1]
    v_mov_b32_dpp v80, v78 row_ror:8 row_mask:0xf bank_mask:0x3
    v_mov_b32_dpp v81, v79 row_ror:8 row_mask:0xf bank_mask:0x3
    v_mov_b32_dpp v82, v84 row_ror:8 row_mask:0xf bank_mask:0x3
    v_mov_b32_dpp v83, v85 row_ror:8 row_mask:0xf bank_mask:0x3
    v_pk_mul_f32 v[92:93], v[66:67], v[80:81] op_sel:[1,1] op_sel_hi:[1,0]
    v_pk_fma_f32 v[88:89], v[66:67], v[80:81], v[92:93] op_sel:[0,0,0] op_sel_hi:[0,1,1] neg_lo:[0,0,1] neg_hi:[1,0,1]
    v_pk_mul_f32 v[94:95], v[66:67], v[82:83] op_sel:[1,1] op_sel_hi:[1,0]
    v_pk_fma_f32 v[90:91], v[66:67], v[82:83], v[94:95] op_sel:[0,0,0] op_sel_hi:[0,1,1] neg_lo:[0,0,1] neg_hi:[1,0,1]
    v_mfma_f32_16x16x4_f32 v[48:51], v86, v68, v[48:51]
    v_mfma_f32_16x16x4_f32 v[52:55], v88, v70, v[52:55]
    v_mfma_f32_16x16x4_f32 v[56:59], v88, v72, v[56:59]
    v_mfma_f32_16x16x4_f32 v[60:63], v90, v74, v[60:63]
    v_mfma_f32_16x16x4_f32 v[48:51], v87, v69, v[48:51]
    v_mfma_f32_16x16x4_f32 v[52:55], v89, v71, v[52:55]
    v_mfma_f32_16x16x4_f32 v[56:59], v89, v73, v[56:59]
    v_mfma_f32_16x16x4_f32 v[60:63], v91, v75, v[60:63]
    v_mov_b64_dpp v[64:65], v[28:29] row_newbcast:13 row_mask:0xf bank_mask:0xf
    v_mov_b64_dpp v[66:67], v[30:31] row_newbcast:13 row_mask:0xf bank_mask:0xf
    v_pk_mul_f32 v[94:95], v[64:65], v[26:27] op_sel_hi:[1,0]
    v_pk_mul_f32 v[96:97], v[64:65], v[26:27] op_sel:[0,1] op_sel_hi:[1,1]
    v_fract_f32 v95, v95
    v_fract_f32 v97, v97
    v_exp_f32 v94, v94
    v_exp_f32 v96, v96
    v_cos_f32 v68, v95
    v_sin_f32 v69, v95
    v_cos_f32 v76, v97
    v_sin_f32 v77, v97
    v_pk_mul_f32 v[68:69], v[68:69], v[94:95] op_sel_hi:[1,0]
    v_pk_mul_f32 v[76:77], v[76:77], v[96:97] op_sel_hi:[1,0]
    v_pk_mul_f32 v[92:93], v[76:77], v[76:77] op_sel:[1,1] op_sel_hi:[0,1]
    v_pk_fma_f32 v[78:79], v[76:77], v[76:77], v[92:93] op_sel:[0,0,0] op_sel_hi:[0,1,1] neg_lo:[0,0,1]
    v_pk_mul_f32 v[94:95], v[68:69], v[68:69] op_sel:[1,1] op_sel_hi:[0,1]
    v_pk_fma_f32 v[70:71], v[68:69], v[68:69], v[94:95] op_sel:[0,0,0] op_sel_hi:[0,1,1] neg_lo:[0,0,1]
    v_pk_mul_f32 v[92:93], v[78:79], v[78:79] op_sel:[1,1] op_sel_hi:[0,1]
    v_pk_fma_f32 v[80:81], v[78:79], v[78:79], v[92:93] op_sel:[0,0,0] op_sel_hi:[0,1,1] neg_lo:[0,0,1]
    v_pk_mul_f32 v[94:95], v[70:71], v[70:71] op_sel:[1,1] op_sel_hi:[0,1]
    v_pk_fma_f32 v[72:73], v[70:71], v[70:71], v[94:95] op_sel:[0,0,0] op_sel_hi:[0,1,1] neg_lo:[0,0,1]
    v_pk_mul_f32 v[92:93], v[80:81], v[80:81] op_sel:[1,1] op_sel_hi:[0,1]
    v_pk_fma_f32 v[82:83], v[80:81], v[80:81], v[92:93] op_sel:[0,0,0] op_sel_hi:[0,1,1] neg_lo:[0,0,1]
    v_pk_mul_f32 v[94:95], v[72:73], v[72:73] op_sel:[1,1] op_sel_hi:[0,1]
    v_pk_fma_f32 v[74:75], v[72:73], v[72:73], v[94:95] op_sel:[0,0,0] op_sel_hi:[0,1,1] neg_lo:[0,0,1]
    v_pk_mul_f32 v[92:93], v[82:83], v[82:83] op_sel:[1,1] op_sel_hi:[0,1]
    v_pk_fma_f32 v[84:85], v[82:83], v[82:83], v[92:93] op_sel:[0,0,0] op_sel_hi:[0,1,1] neg_lo:[0,0,1]
    v_pk_mul_f32 v[94:95], v[66:67], v[76:77] op_sel:[1,1] op_sel_hi:[1,0]
    v_pk_fma_f32 v[86:87], v[66:67], v[76:77], v[94:95] op_sel:[0,0,0] op_sel_hi:[0,1,1] neg_lo:[0,0,1] neg_hi:[1,0,1]
    v_mov_b32_dpp v80, v78 row_ror:8 row_mask:0xf bank_mask:0x3
    v_mov_b32_dpp v81, v79 row_ror:8 row_mask:0xf bank_mask:0x3
    v_mov_b32_dpp v82, v84 row_ror:8 row_mask:0xf bank_mask:0x3
    v_mov_b32_dpp v83, v85 row_ror:8 row_mask:0xf bank_mask:0x3
    v_pk_mul_f32 v[92:93], v[66:67], v[80:81] op_sel:[1,1] op_sel_hi:[1,0]
    v_pk_fma_f32 v[88:89], v[66:67], v[80:81], v[92:93] op_sel:[0,0,0] op_sel_hi:[0,1,1] neg_lo:[0,0,1] neg_hi:[1,0,1]
    v_pk_mul_f32 v[94:95], v[66:67], v[82:83] op_sel:[1,1] op_sel_hi:[1,0]
    v_pk_fma_f32 v[90:91], v[66:67], v[82:83], v[94:95] op_sel:[0,0,0] op_sel_hi:[0,1,1] neg_lo:[0,0,1] neg_hi:[1,0,1]
    v_mfma_f32_16x16x4_f32 v[48:51], v86, v68, v[48:51]
    v_mfma_f32_16x16x4_f32 v[52:55], v88, v70, v[52:55]
    v_mfma_f32_16x16x4_f32 v[56:59], v88, v72, v[56:59]
    v_mfma_f32_16x16x4_f32 v[60:63], v90, v74, v[60:63]
    v_mfma_f32_16x16x4_f32 v[48:51], v87, v69, v[48:51]
    v_mfma_f32_16x16x4_f32 v[52:55], v89, v71, v[52:55]
    v_mfma_f32_16x16x4_f32 v[56:59], v89, v73, v[56:59]
    v_mfma_f32_16x16x4_f32 v[60:63], v91, v75, v[60:63]
    v_mov_b64_dpp v[64:65], v[28:29] row_newbcast:14 row_mask:0xf bank_mask:0xf
    v_mov_b64_dpp v[66:67], v[30:31] row_newbcast:14 row_mask:0xf bank_mask:0xf
    v_pk_mul_f32 v[94:95], v[64:65], v[26:27] op_sel_hi:[1,0]
    v_pk_mul_f32 v[96:97], v[64:65], v[26:27] op_sel:[0,1] op_sel_hi:[1,1]
    v_fract_f32 v95, v95
    v_fract_f32 v97, v97
    v_exp_f32 v94, v94
    v_exp_f32 v96, v96
    v_cos_f32 v68, v95
    v_sin_f32 v69, v95
    v_cos_f32 v76, v97
    v_sin_f32 v77, v97
    v_pk_mul_f32 v[68:69], v[68:69], v[94:95] op_sel_hi:[1,0]
    v_pk_mul_f32 v[76:77], v[76:77], v[96:97] op_sel_hi:[1,0]
    v_pk_mul_f32 v[92:93], v[76:77], v[76:77] op_sel:[1,1] op_sel_hi:[0,1]
    v_pk_fma_f32 v[78:79], v[76:77], v[76:77], v[92:93] op_sel:[0,0,0] op_sel_hi:[0,1,1] neg_lo:[0,0,1]
    v_pk_mul_f32 v[94:95], v[68:69], v[68:69] op_sel:[1,1] op_sel_hi:[0,1]
    v_pk_fma_f32 v[70:71], v[68:69], v[68:69], v[94:95] op_sel:[0,0,0] op_sel_hi:[0,1,1] neg_lo:[0,0,1]
    v_pk_mul_f32 v[92:93], v[78:79], v[78:79] op_sel:[1,1] op_sel_hi:[0,1]
    v_pk_fma_f32 v[80:81], v[78:79], v[78:79], v[92:93] op_sel:[0,0,0] op_sel_hi:[0,1,1] neg_lo:[0,0,1]
    v_pk_mul_f32 v[94:95], v[70:71], v[70:71] op_sel:[1,1] op_sel_hi:[0,1]
    v_pk_fma_f32 v[72:73], v[70:71], v[70:71], v[94:95] op_sel:[0,0,0] op_sel_hi:[0,1,1] neg_lo:[0,0,1]
    v_pk_mul_f32 v[92:93], v[80:81], v[80:81] op_sel:[1,1] op_sel_hi:[0,1]
    v_pk_fma_f32 v[82:83], v[80:81], v[80:81], v[92:93] op_sel:[0,0,0] op_sel_hi:[0,1,1] neg_lo:[0,0,1]
    v_pk_mul_f32 v[94:95], v[72:73], v[72:73] op_sel:[1,1] op_sel_hi:[0,1]
    v_pk_fma_f32 v[74:75], v[72:73], v[72:73], v[94:95] op_sel:[0,0,0] op_sel_hi:[0,1,1] neg_lo:[0,0,1]
    v_pk_mul_f32 v[92:93], v[82:83], v[82:83] op_sel:[1,1] op_sel_hi:[0,1]
    v_pk_fma_f32 v[84:85], v[82:83], v[82:83], v[92:93] op_sel:[0,0,0] op_sel_hi:[0,1,1] neg_lo:[0,0,1]
    v_pk_mul_f32 v[94:95], v[66:67], v[76:77] op_sel:[1,1] op_sel_hi:[1,0]
    v_pk_fma_f32 v[86:87], v[66:67], v[76:77], v[94:95] op_sel:[0,0,0] op_sel_hi:[0,1,1] neg_lo:[0,0,1] neg_hi:[1,0,1]
    v_mov_b32_dpp v80, v78 row_ror:8 row_mask:0xf bank_mask:0x3
    v_mov_b32_dpp v81, v79 row_ror:8 row_mask:0xf bank_mask:0x3
    v_mov_b32_dpp v82, v84 row_ror:8 row_mask:0xf bank_mask:0x3
    v_mov_b32_dpp v83, v85 row_ror:8 row_mask:0xf bank_mask:0x3
    v_pk_mul_f32 v[92:93], v[66:67], v[80:81] op_sel:[1,1] op_sel_hi:[1,0]
    v_pk_fma_f32 v[88:89], v[66:67], v[80:81], v[92:93] op_sel:[0,0,0] op_sel_hi:[0,1,1] neg_lo:[0,0,1] neg_hi:[1,0,1]
    v_pk_mul_f32 v[94:95], v[66:67], v[82:83] op_sel:[1,1] op_sel_hi:[1,0]
    v_pk_fma_f32 v[90:91], v[66:67], v[82:83], v[94:95] op_sel:[0,0,0] op_sel_hi:[0,1,1] neg_lo:[0,0,1] neg_hi:[1,0,1]
    v_mfma_f32_16x16x4_f32 v[48:51], v86, v68, v[48:51]
    v_mfma_f32_16x16x4_f32 v[52:55], v88, v70, v[52:55]
    v_mfma_f32_16x16x4_f32 v[56:59], v88, v72, v[56:59]
    v_mfma_f32_16x16x4_f32 v[60:63], v90, v74, v[60:63]
    v_mfma_f32_16x16x4_f32 v[48:51], v87, v69, v[48:51]
    v_mfma_f32_16x16x4_f32 v[52:55], v89, v71, v[52:55]
    v_mfma_f32_16x16x4_f32 v[56:59], v89, v73, v[56:59]
    v_mfma_f32_16x16x4_f32 v[60:63], v91, v75, v[60:63]
    v_mov_b64_dpp v[64:65], v[28:29] row_newbcast:15 row_mask:0xf bank_mask:0xf
    v_mov_b64_dpp v[66:67], v[30:31] row_newbcast:15 row_mask:0xf bank_mask:0xf
    v_pk_mul_f32 v[94:95], v[64:65], v[26:27] op_sel_hi:[1,0]
    v_pk_mul_f32 v[96:97], v[64:65], v[26:27] op_sel:[0,1] op_sel_hi:[1,1]
    v_fract_f32 v95, v95
    v_fract_f32 v97, v97
    v_exp_f32 v94, v94
    v_exp_f32 v96, v96
    v_cos_f32 v68, v95
    v_sin_f32 v69, v95
    v_cos_f32 v76, v97
    v_sin_f32 v77, v97
    v_pk_mul_f32 v[68:69], v[68:69], v[94:95] op_sel_hi:[1,0]
    v_pk_mul_f32 v[76:77], v[76:77], v[96:97] op_sel_hi:[1,0]
    v_pk_mul_f32 v[92:93], v[76:77], v[76:77] op_sel:[1,1] op_sel_hi:[0,1]
    v_pk_fma_f32 v[78:79], v[76:77], v[76:77], v[92:93] op_sel:[0,0,0] op_sel_hi:[0,1,1] neg_lo:[0,0,1]
    v_pk_mul_f32 v[94:95], v[68:69], v[68:69] op_sel:[1,1] op_sel_hi:[0,1]
    v_pk_fma_f32 v[70:71], v[68:69], v[68:69], v[94:95] op_sel:[0,0,0] op_sel_hi:[0,1,1] neg_lo:[0,0,1]
    v_pk_mul_f32 v[92:93], v[78:79], v[78:79] op_sel:[1,1] op_sel_hi:[0,1]
    v_pk_fma_f32 v[80:81], v[78:79], v[78:79], v[92:93] op_sel:[0,0,0] op_sel_hi:[0,1,1] neg_lo:[0,0,1]
    v_pk_mul_f32 v[94:95], v[70:71], v[70:71] op_sel:[1,1] op_sel_hi:[0,1]
    v_pk_fma_f32 v[72:73], v[70:71], v[70:71], v[94:95] op_sel:[0,0,0] op_sel_hi:[0,1,1] neg_lo:[0,0,1]
    v_pk_mul_f32 v[92:93], v[80:81], v[80:81] op_sel:[1,1] op_sel_hi:[0,1]
    v_pk_fma_f32 v[82:83], v[80:81], v[80:81], v[92:93] op_sel:[0,0,0] op_sel_hi:[0,1,1] neg_lo:[0,0,1]
    v_pk_mul_f32 v[94:95], v[72:73], v[72:73] op_sel:[1,1] op_sel_hi:[0,1]
    v_pk_fma_f32 v[74:75], v[72:73], v[72:73], v[94:95] op_sel:[0,0,0] op_sel_hi:[0,1,1] neg_lo:[0,0,1]
    v_pk_mul_f32 v[92:93], v[82:83], v[82:83] op_sel:[1,1] op_sel_hi:[0,1]
    v_pk_fma_f32 v[84:85], v[82:83], v[82:83], v[92:93] op_sel:[0,0,0] op_sel_hi:[0,1,1] neg_lo:[0,0,1]
    v_pk_mul_f32 v[94:95], v[66:67], v[76:77] op_sel:[1,1] op_sel_hi:[1,0]
    v_pk_fma_f32 v[86:87], v[66:67], v[76:77], v[94:95] op_sel:[0,0,0] op_sel_hi:[0,1,1] neg_lo:[0,0,1] neg_hi:[1,0,1]
    v_mov_b32_dpp v80, v78 row_ror:8 row_mask:0xf bank_mask:0x3
    v_mov_b32_dpp v81, v79 row_ror:8 row_mask:0xf bank_mask:0x3
    v_mov_b32_dpp v82, v84 row_ror:8 row_mask:0xf bank_mask:0x3
    v_mov_b32_dpp v83, v85 row_ror:8 row_mask:0xf bank_mask:0x3
    v_pk_mul_f32 v[92:93], v[66:67], v[80:81] op_sel:[1,1] op_sel_hi:[1,0]
    v_pk_fma_f32 v[88:89], v[66:67], v[80:81], v[92:93] op_sel:[0,0,0] op_sel_hi:[0,1,1] neg_lo:[0,0,1] neg_hi:[1,0,1]
    v_pk_mul_f32 v[94:95], v[66:67], v[82:83] op_sel:[1,1] op_sel_hi:[1,0]
    v_pk_fma_f32 v[90:91], v[66:67], v[82:83], v[94:95] op_sel:[0,0,0] op_sel_hi:[0,1,1] neg_lo:[0,0,1] neg_hi:[1,0,1]
    v_mfma_f32_16x16x4_f32 v[48:51], v86, v68, v[48:51]
    v_mfma_f32_16x16x4_f32 v[52:55], v88, v70, v[52:55]
    v_mfma_f32_16x16x4_f32 v[56:59], v88, v72, v[56:59]
    v_mfma_f32_16x16x4_f32 v[60:63], v90, v74, v[60:63]
    v_mfma_f32_16x16x4_f32 v[48:51], v87, v69, v[48:51]
    v_mfma_f32_16x16x4_f32 v[52:55], v89, v71, v[52:55]
    v_mfma_f32_16x16x4_f32 v[56:59], v89, v73, v[56:59]
    v_mfma_f32_16x16x4_f32 v[60:63], v91, v75, v[60:63]
    v_mov_b64 v[28:29], v[32:33]
    v_mov_b64 v[30:31], v[34:35]
    s_add_u32 s25, s25, 1
    s_cmp_lt_u32 s25, 2
    s_cbranch_scc1 ss_kg
    s_cmp_lg_u32 s28, 0
    s_cbranch_scc1 ss_nostage
    s_waitcnt vmcnt(0)
    v_mov_b32 v36, 0x05040100
    v_mov_b32 v37, 0x07060302
    v_lshlrev_b32 v6, 4, v0
    v_add_u32 v7, 65536, v6
    v_perm_b32 v40, v212, v208, v36
    v_perm_b32 v41, v220, v216, v36
    v_perm_b32 v42, v228, v224, v36
    v_perm_b32 v43, v236, v232, v36
    ds_write_b128 v6, v[40:43] offset:512
    v_perm_b32 v44, v212, v208, v37
    v_perm_b32 v45, v220, v216, v37
    v_perm_b32 v46, v228, v224, v37
    v_perm_b32 v47, v236, v232, v37
    ds_write_b128 v6, v[44:47] offset:16896
    v_perm_b32 v40, v213, v209, v36
    v_perm_b32 v41, v221, v217, v36
    v_perm_b32 v42, v229, v225, v36
    v_perm_b32 v43, v237, v233, v36
    ds_write_b128 v6, v[40:43] offset:33280
    v_perm_b32 v44, v213, v209, v37
    v_perm_b32 v45, v221, v217, v37
    v_perm_b32 v46, v229, v225, v37
    v_perm_b32 v47, v237, v233, v37
    ds_write_b128 v6, v[44:47] offset:49664
    v_perm_b32 v40, v214, v210, v36
    v_perm_b32 v41, v222, v218, v36
    v_perm_b32 v42, v230, v226, v36
    v_perm_b32 v43, v238, v234, v36
    ds_write_b128 v7, v[40:43] offset:512
    v_perm_b32 v44, v214, v210, v37
    v_perm_b32 v45, v222, v218, v37
    v_perm_b32 v46, v230, v226, v37
    v_perm_b32 v47, v238, v234, v37
    ds_write_b128 v7, v[44:47] offset:16896
    v_perm_b32 v40, v215, v211, v36
    v_perm_b32 v41, v223, v219, v36
    v_perm_b32 v42, v231, v227, v36
    v_perm_b32 v43, v239, v235, v36
    ds_write_b128 v7, v[40:43] offset:33280
    v_perm_b32 v44, v215, v211, v37
    v_perm_b32 v45, v223, v219, v37
    v_perm_b32 v46, v231, v227, v37
    v_perm_b32 v47, v239, v235, v37
    ds_write_b128 v7, v[44:47] offset:49664
ss_nostage:
    s_nop 11
    v_lshlrev_b32 v5, 8, v3
    v_lshl_add_u32 v5, v2, 2, v5
    v_add_u32 v5, v5, v4
    ds_write_b32 v5, v48 offset:4608
    ds_write_b32 v5, v49 offset:4672
    ds_write_b32 v5, v50 offset:4736
    ds_write_b32 v5, v51 offset:4800
    s_mov_b32 exec_hi, 0
    ds_write_b32 v5, v52 offset:5632
    ds_write_b32 v5, v53 offset:5696
    ds_write_b32 v5, v54 offset:5760
    ds_write_b32 v5, v55 offset:5824
    s_not_b64 exec, exec
    ds_write_b32 v5, v56 offset:5632
    ds_write_b32 v5, v57 offset:5696
    ds_write_b32 v5, v58 offset:5760
    ds_write_b32 v5, v59 offset:5824
    ds_write_b32 v5, v60 offset:6144
    ds_write_b32 v5, v61 offset:6208
    ds_write_b32 v5, v62 offset:6272
    ds_write_b32 v5, v63 offset:6336
    s_mov_b64 exec, 3
    v_cmp_eq_u32 vcc, 0, v2
    s_nop 1
    v_cndmask_b32 v6, 0, v60, vcc
    ds_write_b32 v5, v6 offset:7168
    s_mov_b64 exec, -1
    s_waitcnt lgkmcnt(0)
    v_lshlrev_b32 v7, 1, v1
    v_sub_u32 v7, 2065, v7
    v_lshl_add_u32 v64, v1, 2, v4
    v_mov_b32 v65, 641
    s_mov_b32 s25, 9
    s_mov_b32 s22, 256
    s_mov_b32 s23, 2048
ss_exp:
    v_subrev_u32 v66, 0, v7
    v_cvt_f32_u32 v72, v66
    v_cmp_gt_u32 vcc, s22, v66
    v_cvt_pk_bf16_f32 v72, v72, 0
    v_subrev_u32 v72, 0x4280, v72
    v_cndmask_b32 v72, v72, v66, vcc
    v_cmp_gt_u32 vcc, s23, v66
    s_nop 1
    v_cndmask_b32 v72, v65, v72, vcc
    v_lshl_add_u32 v72, v72, 2, v4
    v_subrev_u32 v67, 1, v7
    v_cvt_f32_u32 v73, v67
    v_cmp_gt_u32 vcc, s22, v67
    v_cvt_pk_bf16_f32 v73, v73, 0
    v_subrev_u32 v73, 0x4280, v73
    v_cndmask_b32 v73, v73, v67, vcc
    v_cmp_gt_u32 vcc, s23, v67
    ds_read_b32 v78, v72 offset:4608
    s_nop 0
    v_cndmask_b32 v73, v65, v73, vcc
    v_lshl_add_u32 v73, v73, 2, v4
    v_subrev_u32 v68, 2, v7
    v_cvt_f32_u32 v74, v68
    v_cmp_gt_u32 vcc, s22, v68
    v_cvt_pk_bf16_f32 v74, v74, 0
    v_subrev_u32 v74, 0x4280, v74
    v_cndmask_b32 v74, v74, v68, vcc
    v_cmp_gt_u32 vcc, s23, v68
    ds_read_b32 v79, v73 offset:4608
    s_nop 0
    v_cndmask_b32 v74, v65, v74, vcc
    v_lshl_add_u32 v74, v74, 2, v4
    v_subrev_u32 v69, 128, v7
    v_cvt_f32_u32 v75, v69
    v_cmp_gt_u32 vcc, s22, v69
    v_cvt_pk_bf16_f32 v75, v75, 0
    v_subrev_u32 v75, 0x4280, v75
    v_cndmask_b32 v75, v75, v69, vcc
    v_cmp_gt_u32 vcc, s23, v69
    ds_read_b32 v80, v74 offset:4608
    s_nop 0
    v_cndmask_b32 v75, v65, v75, vcc
    v_lshl_add_u32 v75, v75, 2, v4
    v_subrev_u32 v70, 129, v7
    v_cvt_f32_u32 v76, v70
    v_cmp_gt_u32 vcc, s22, v70
    v_cvt_pk_bf16_f32 v76, v76, 0
    v_subrev_u32 v76, 0x4280, v76
    v_cndmask_b32 v76, v76, v70, vcc
    v_cmp_gt_u32 vcc, s23, v70
    ds_read_b32 v81, v75 offset:4608
    s_nop 0
    v_cndmask_b32 v76, v65, v76, vcc
    v_lshl_add_u32 v76, v76, 2, v4
    v_subrev_u32 v71, 130, v7
    v_cvt_f32_u32 v77, v71
    v_cmp_gt_u32 vcc, s22, v71
    v_cvt_pk_bf16_f32 v77, v77, 0
    v_subrev_u32 v77, 0x4280, v77
    v_cndmask_b32 v77, v77, v71, vcc
    v_cmp_gt_u32 vcc, s23, v71
    ds_read_b32 v82, v76 offset:4608
    s_nop 0
    v_cndmask_b32 v77, v65, v77, vcc
    v_lshl_add_u32 v77, v77, 2, v4
    ds_read_b32 v83, v77 offset:4608
    v_subrev_u32 v7, 256, v7
    s_sub_u32 s25, s25, 1
    s_waitcnt lgkmcnt(0)
    v_cvt_pk_bf16_f32 v84, v79, v80
    v_cvt_pk_bf16_f32 v85, v78, v79
    v_cvt_pk_bf16_f32 v86, v82, v83
    v_cvt_pk_bf16_f32 v87, v81, v82
    ds_write_b32 v64, v84 offset:7424
    ds_write_b32 v64, v85 offset:11776
    s_cmp_eq_u32 s25, 0
    s_cbranch_scc1 ss_expx
    ds_write_b32 v64, v86 offset:7680
    ds_write_b32 v64, v87 offset:12032
    v_add_u32 v64, 512, v64
    s_nop 1
    s_branch ss_exp
ss_expx:
    s_waitcnt lgkmcnt(0)
    s_barrier
    v_and_b32 v5, 1, v2
    v_mul_u32_u24 v36, 4352, v5
    v_sub_u32 v5, v5, v2
    v_lshl_add_u32 v5, v3, 3, v5
    v_lshl_add_u32 v36, v5, 1, v36
    v_add_u32 v36, 11072, v36
    v_add_u32 v36, v36, v4
    v_subrev_u32 v37, 512, v36
    v_subrev_u32 v38, 1024, v36
    v_subrev_u32 v39, 1536, v36
    v_subrev_u32 v40, 2048, v36
    v_subrev_u32 v41, 2560, v36
    v_subrev_u32 v42, 3072, v36
    v_subrev_u32 v43, 3584, v36
    v_lshlrev_b32 v44, 5, v2
    v_lshl_add_u32 v44, v3, 4, v44
    v_add_u32 v44, 32, v44
    v_add_u32 v44, v44, v4
    ds_read_b128 v[112:115], v44 offset:448
    ds_read2_b32 v[80:81], v36 offset0:112 offset1:113
    ds_read2_b32 v[82:83], v36 offset0:114 offset1:115
    ds_read_b128 v[116:119], v44 offset:960
    ds_read2_b32 v[84:85], v37 offset0:112 offset1:113
    ds_read2_b32 v[86:87], v37 offset0:114 offset1:115
    ds_read_b128 v[120:123], v44 offset:1472
    ds_read2_b32 v[88:89], v38 offset0:112 offset1:113
    ds_read2_b32 v[90:91], v38 offset0:114 offset1:115
    ds_read_b128 v[124:127], v44 offset:1984
    ds_read2_b32 v[92:93], v39 offset0:112 offset1:113
    ds_read2_b32 v[94:95], v39 offset0:114 offset1:115
    ds_read_b128 v[128:131], v44 offset:2496
    ds_read2_b32 v[96:97], v40 offset0:112 offset1:113
    ds_read2_b32 v[98:99], v40 offset0:114 offset1:115
    ds_read_b128 v[132:135], v44 offset:3008
    ds_read2_b32 v[100:101], v41 offset0:112 offset1:113
    ds_read2_b32 v[102:103], v41 offset0:114 offset1:115
    ds_read_b128 v[136:139], v44 offset:3520
    ds_read2_b32 v[104:105], v42 offset0:112 offset1:113
    ds_read2_b32 v[106:107], v42 offset0:114 offset1:115
    ds_read_b128 v[140:143], v44 offset:4032
    ds_read2_b32 v[108:109], v43 offset0:112 offset1:113
    ds_read2_b32 v[110:111], v43 offset0:114 offset1:115
    s_waitcnt lgkmcnt(0)
    v_mfma_f32_16x16x32_bf16 v[48:51], v[80:83], v[112:115], 0
    ds_read_b128 v[176:179], v44 offset:384
    v_mfma_f32_16x16x32_bf16 v[52:55], v[80:83], v[116:119], 0
    ds_read2_b32 v[144:145], v36 offset0:96 offset1:97
    v_mfma_f32_16x16x32_bf16 v[56:59], v[80:83], v[120:123], 0
    ds_read2_b32 v[146:147], v36 offset0:98 offset1:99
    v_mfma_f32_16x16x32_bf16 v[60:63], v[80:83], v[124:127], 0
    ds_read_b128 v[180:183], v44 offset:896
    v_mfma_f32_16x16x32_bf16 v[64:67], v[80:83], v[128:131], 0
    ds_read2_b32 v[148:149], v37 offset0:96 offset1:97
    v_mfma_f32_16x16x32_bf16 v[68:71], v[80:83], v[132:135], 0
    ds_read2_b32 v[150:151], v37 offset0:98 offset1:99
    v_mfma_f32_16x16x32_bf16 v[72:75], v[80:83], v[136:139], 0
    ds_read_b128 v[184:187], v44 offset:1408
    v_mfma_f32_16x16x32_bf16 v[76:79], v[80:83], v[140:143], 0
    ds_read2_b32 v[152:153], v38 offset0:96 offset1:97
    v_mfma_f32_16x16x32_bf16 v[52:55], v[84:87], v[112:115], v[52:55]
    ds_read2_b32 v[154:155], v38 offset0:98 offset1:99
    v_mfma_f32_16x16x32_bf16 v[56:59], v[84:87], v[116:119], v[56:59]
    ds_read_b128 v[188:191], v44 offset:1920
    v_mfma_f32_16x16x32_bf16 v[60:63], v[84:87], v[120:123], v[60:63]
    ds_read2_b32 v[156:157], v39 offset0:96 offset1:97
    v_mfma_f32_16x16x32_bf16 v[64:67], v[84:87], v[124:127], v[64:67]
    ds_read2_b32 v[158:159], v39 offset0:98 offset1:99
    v_mfma_f32_16x16x32_bf16 v[68:71], v[84:87], v[128:131], v[68:71]
    ds_read_b128 v[192:195], v44 offset:2432
    v_mfma_f32_16x16x32_bf16 v[72:75], v[84:87], v[132:135], v[72:75]
    ds_read2_b32 v[160:161], v40 offset0:96 offset1:97
    v_mfma_f32_16x16x32_bf16 v[76:79], v[84:87], v[136:139], v[76:79]
    ds_read2_b32 v[162:163], v40 offset0:98 offset1:99
    v_mfma_f32_16x16x32_bf16 v[56:59], v[88:91], v[112:115], v[56:59]
    ds_read_b128 v[196:199], v44 offset:2944
    v_mfma_f32_16x16x32_bf16 v[60:63], v[88:91], v[116:119], v[60:63]
    ds_read2_b32 v[164:165], v41 offset0:96 offset1:97
    v_mfma_f32_16x16x32_bf16 v[64:67], v[88:91], v[120:123], v[64:67]
    ds_read2_b32 v[166:167], v41 offset0:98 offset1:99
    v_mfma_f32_16x16x32_bf16 v[68:71], v[88:91], v[124:127], v[68:71]
    ds_read_b128 v[200:203], v44 offset:3456
    v_mfma_f32_16x16x32_bf16 v[72:75], v[88:91], v[128:131], v[72:75]
    ds_read2_b32 v[168:169], v42 offset0:96 offset1:97
    v_mfma_f32_16x16x32_bf16 v[76:79], v[88:91], v[132:135], v[76:79]
    ds_read2_b32 v[170:171], v42 offset0:98 offset1:99
    v_mfma_f32_16x16x32_bf16 v[60:63], v[92:95], v[112:115], v[60:63]
    ds_read_b128 v[204:207], v44 offset:3968
    v_mfma_f32_16x16x32_bf16 v[64:67], v[92:95], v[116:119], v[64:67]
    ds_read2_b32 v[172:173], v43 offset0:96 offset1:97
    v_mfma_f32_16x16x32_bf16 v[68:71], v[92:95], v[120:123], v[68:71]
    ds_read2_b32 v[174:175], v43 offset0:98 offset1:99
    v_mfma_f32_16x16x32_bf16 v[72:75], v[92:95], v[124:127], v[72:75]
    v_mfma_f32_16x16x32_bf16 v[76:79], v[92:95], v[128:131], v[76:79]
    v_mfma_f32_16x16x32_bf16 v[64:67], v[96:99], v[112:115], v[64:67]
    v_mfma_f32_16x16x32_bf16 v[68:71], v[96:99], v[116:119], v[68:71]
    v_mfma_f32_16x16x32_bf16 v[72:75], v[96:99], v[120:123], v[72:75]
    v_mfma_f32_16x16x32_bf16 v[76:79], v[96:99], v[124:127], v[76:79]
    v_mfma_f32_16x16x32_bf16 v[68:71], v[100:103], v[112:115], v[68:71]
    v_mfma_f32_16x16x32_bf16 v[72:75], v[100:103], v[116:119], v[72:75]
    v_mfma_f32_16x16x32_bf16 v[76:79], v[100:103], v[120:123], v[76:79]
    v_mfma_f32_16x16x32_bf16 v[72:75], v[104:107], v[112:115], v[72:75]
    v_mfma_f32_16x16x32_bf16 v[76:79], v[104:107], v[116:119], v[76:79]
    v_mfma_f32_16x16x32_bf16 v[76:79], v[108:111], v[112:115], v[76:79]
    s_waitcnt lgkmcnt(0)
    v_mfma_f32_16x16x32_bf16 v[48:51], v[144:147], v[176:179], v[48:51]
    ds_read_b128 v[112:115], v44 offset:320
    v_mfma_f32_16x16x32_bf16 v[52:55], v[144:147], v[180:183], v[52:55]
    ds_read2_b32 v[80:81], v36 offset0:80 offset1:81
    v_mfma_f32_16x16x32_bf16 v[56:59], v[144:147], v[184:187], v[56:59]
    ds_read2_b32 v[82:83], v36 offset0:82 offset1:83
    v_mfma_f32_16x16x32_bf16 v[60:63], v[144:147], v[188:191], v[60:63]
    ds_read_b128 v[116:119], v44 offset:832
    v_mfma_f32_16x16x32_bf16 v[64:67], v[144:147], v[192:195], v[64:67]
    ds_read2_b32 v[84:85], v37 offset0:80 offset1:81
    v_mfma_f32_16x16x32_bf16 v[68:71], v[144:147], v[196:199], v[68:71]
    ds_read2_b32 v[86:87], v37 offset0:82 offset1:83
    v_mfma_f32_16x16x32_bf16 v[72:75], v[144:147], v[200:203], v[72:75]
    ds_read_b128 v[120:123], v44 offset:1344
    v_mfma_f32_16x16x32_bf16 v[76:79], v[144:147], v[204:207], v[76:79]
    ds_read2_b32 v[88:89], v38 offset0:80 offset1:81
    v_mfma_f32_16x16x32_bf16 v[52:55], v[148:151], v[176:179], v[52:55]
    ds_read2_b32 v[90:91], v38 offset0:82 offset1:83
    v_mfma_f32_16x16x32_bf16 v[56:59], v[148:151], v[180:183], v[56:59]
    ds_read_b128 v[124:127], v44 offset:1856
    v_mfma_f32_16x16x32_bf16 v[60:63], v[148:151], v[184:187], v[60:63]
    ds_read2_b32 v[92:93], v39 offset0:80 offset1:81
    v_mfma_f32_16x16x32_bf16 v[64:67], v[148:151], v[188:191], v[64:67]
    ds_read2_b32 v[94:95], v39 offset0:82 offset1:83
    v_mfma_f32_16x16x32_bf16 v[68:71], v[148:151], v[192:195], v[68:71]
    ds_read_b128 v[128:131], v44 offset:2368
    v_mfma_f32_16x16x32_bf16 v[72:75], v[148:151], v[196:199], v[72:75]
    ds_read2_b32 v[96:97], v40 offset0:80 offset1:81
    v_mfma_f32_16x16x32_bf16 v[76:79], v[148:151], v[200:203], v[76:79]
    ds_read2_b32 v[98:99], v40 offset0:82 offset1:83
    v_mfma_f32_16x16x32_bf16 v[56:59], v[152:155], v[176:179], v[56:59]
    ds_read_b128 v[132:135], v44 offset:2880
    v_mfma_f32_16x16x32_bf16 v[60:63], v[152:155], v[180:183], v[60:63]
    ds_read2_b32 v[100:101], v41 offset0:80 offset1:81
    v_mfma_f32_16x16x32_bf16 v[64:67], v[152:155], v[184:187], v[64:67]
    ds_read2_b32 v[102:103], v41 offset0:82 offset1:83
    v_mfma_f32_16x16x32_bf16 v[68:71], v[152:155], v[188:191], v[68:71]
    ds_read_b128 v[136:139], v44 offset:3392
    v_mfma_f32_16x16x32_bf16 v[72:75], v[152:155], v[192:195], v[72:75]
    ds_read2_b32 v[104:105], v42 offset0:80 offset1:81
    v_mfma_f32_16x16x32_bf16 v[76:79], v[152:155], v[196:199], v[76:79]
    ds_read2_b32 v[106:107], v42 offset0:82 offset1:83
    v_mfma_f32_16x16x32_bf16 v[60:63], v[156:159], v[176:179], v[60:63]
    ds_read_b128 v[140:143], v44 offset:3904
    v_mfma_f32_16x16x32_bf16 v[64:67], v[156:159], v[180:183], v[64:67]
    ds_read2_b32 v[108:109], v43 offset0:80 offset1:81
    v_mfma_f32_16x16x32_bf16 v[68:71], v[156:159], v[184:187], v[68:71]
    ds_read2_b32 v[110:111], v43 offset0:82 offset1:83
    v_mfma_f32_16x16x32_bf16 v[72:75], v[156:159], v[188:191], v[72:75]
    v_mfma_f32_16x16x32_bf16 v[76:79], v[156:159], v[192:195], v[76:79]
    v_mfma_f32_16x16x32_bf16 v[64:67], v[160:163], v[176:179], v[64:67]
    v_mfma_f32_16x16x32_bf16 v[68:71], v[160:163], v[180:183], v[68:71]
    v_mfma_f32_16x16x32_bf16 v[72:75], v[160:163], v[184:187], v[72:75]
    v_mfma_f32_16x16x32_bf16 v[76:79], v[160:163], v[188:191], v[76:79]
    v_mfma_f32_16x16x32_bf16 v[68:71], v[164:167], v[176:179], v[68:71]
    v_mfma_f32_16x16x32_bf16 v[72:75], v[164:167], v[180:183], v[72:75]
    v_mfma_f32_16x16x32_bf16 v[76:79], v[164:167], v[184:187], v[76:79]
    v_mfma_f32_16x16x32_bf16 v[72:75], v[168:171], v[176:179], v[72:75]
    v_mfma_f32_16x16x32_bf16 v[76:79], v[168:171], v[180:183], v[76:79]
    v_mfma_f32_16x16x32_bf16 v[76:79], v[172:175], v[176:179], v[76:79]
    s_waitcnt lgkmcnt(0)
    v_mfma_f32_16x16x32_bf16 v[48:51], v[80:83], v[112:115], v[48:51]
    ds_read_b128 v[176:179], v44 offset:256
    v_mfma_f32_16x16x32_bf16 v[52:55], v[80:83], v[116:119], v[52:55]
    ds_read2_b32 v[144:145], v36 offset0:64 offset1:65
    v_mfma_f32_16x16x32_bf16 v[56:59], v[80:83], v[120:123], v[56:59]
    ds_read2_b32 v[146:147], v36 offset0:66 offset1:67
    v_mfma_f32_16x16x32_bf16 v[60:63], v[80:83], v[124:127], v[60:63]
    ds_read_b128 v[180:183], v44 offset:768
    v_mfma_f32_16x16x32_bf16 v[64:67], v[80:83], v[128:131], v[64:67]
    ds_read2_b32 v[148:149], v37 offset0:64 offset1:65
    v_mfma_f32_16x16x32_bf16 v[68:71], v[80:83], v[132:135], v[68:71]
    ds_read2_b32 v[150:151], v37 offset0:66 offset1:67
    v_mfma_f32_16x16x32_bf16 v[72:75], v[80:83], v[136:139], v[72:75]
    ds_read_b128 v[184:187], v44 offset:1280
    v_mfma_f32_16x16x32_bf16 v[76:79], v[80:83], v[140:143], v[76:79]
    ds_read2_b32 v[152:153], v38 offset0:64 offset1:65
    v_mfma_f32_16x16x32_bf16 v[52:55], v[84:87], v[112:115], v[52:55]
    ds_read2_b32 v[154:155], v38 offset0:66 offset1:67
    v_mfma_f32_16x16x32_bf16 v[56:59], v[84:87], v[116:119], v[56:59]
    ds_read_b128 v[188:191], v44 offset:1792
    v_mfma_f32_16x16x32_bf16 v[60:63], v[84:87], v[120:123], v[60:63]
    ds_read2_b32 v[156:157], v39 offset0:64 offset1:65
    v_mfma_f32_16x16x32_bf16 v[64:67], v[84:87], v[124:127], v[64:67]
    ds_read2_b32 v[158:159], v39 offset0:66 offset1:67
    v_mfma_f32_16x16x32_bf16 v[68:71], v[84:87], v[128:131], v[68:71]
    ds_read_b128 v[192:195], v44 offset:2304
    v_mfma_f32_16x16x32_bf16 v[72:75], v[84:87], v[132:135], v[72:75]
    ds_read2_b32 v[160:161], v40 offset0:64 offset1:65
    v_mfma_f32_16x16x32_bf16 v[76:79], v[84:87], v[136:139], v[76:79]
    ds_read2_b32 v[162:163], v40 offset0:66 offset1:67
    v_mfma_f32_16x16x32_bf16 v[56:59], v[88:91], v[112:115], v[56:59]
    ds_read_b128 v[196:199], v44 offset:2816
    v_mfma_f32_16x16x32_bf16 v[60:63], v[88:91], v[116:119], v[60:63]
    ds_read2_b32 v[164:165], v41 offset0:64 offset1:65
    v_mfma_f32_16x16x32_bf16 v[64:67], v[88:91], v[120:123], v[64:67]
    ds_read2_b32 v[166:167], v41 offset0:66 offset1:67
    v_mfma_f32_16x16x32_bf16 v[68:71], v[88:91], v[124:127], v[68:71]
    ds_read_b128 v[200:203], v44 offset:3328
    v_mfma_f32_16x16x32_bf16 v[72:75], v[88:91], v[128:131], v[72:75]
    ds_read2_b32 v[168:169], v42 offset0:64 offset1:65
    v_mfma_f32_16x16x32_bf16 v[76:79], v[88:91], v[132:135], v[76:79]
    ds_read2_b32 v[170:171], v42 offset0:66 offset1:67
    v_mfma_f32_16x16x32_bf16 v[60:63], v[92:95], v[112:115], v[60:63]
    ds_read_b128 v[204:207], v44 offset:3840
    v_mfma_f32_16x16x32_bf16 v[64:67], v[92:95], v[116:119], v[64:67]
    ds_read2_b32 v[172:173], v43 offset0:64 offset1:65
    v_mfma_f32_16x16x32_bf16 v[68:71], v[92:95], v[120:123], v[68:71]
    ds_read2_b32 v[174:175], v43 offset0:66 offset1:67
    v_mfma_f32_16x16x32_bf16 v[72:75], v[92:95], v[124:127], v[72:75]
    v_mfma_f32_16x16x32_bf16 v[76:79], v[92:95], v[128:131], v[76:79]
    v_mfma_f32_16x16x32_bf16 v[64:67], v[96:99], v[112:115], v[64:67]
    v_mfma_f32_16x16x32_bf16 v[68:71], v[96:99], v[116:119], v[68:71]
    v_mfma_f32_16x16x32_bf16 v[72:75], v[96:99], v[120:123], v[72:75]
    v_mfma_f32_16x16x32_bf16 v[76:79], v[96:99], v[124:127], v[76:79]
    v_mfma_f32_16x16x32_bf16 v[68:71], v[100:103], v[112:115], v[68:71]
    v_mfma_f32_16x16x32_bf16 v[72:75], v[100:103], v[116:119], v[72:75]
    v_mfma_f32_16x16x32_bf16 v[76:79], v[100:103], v[120:123], v[76:79]
    v_mfma_f32_16x16x32_bf16 v[72:75], v[104:107], v[112:115], v[72:75]
    v_mfma_f32_16x16x32_bf16 v[76:79], v[104:107], v[116:119], v[76:79]
    v_mfma_f32_16x16x32_bf16 v[76:79], v[108:111], v[112:115], v[76:79]
    s_waitcnt lgkmcnt(0)
    v_mfma_f32_16x16x32_bf16 v[48:51], v[144:147], v[176:179], v[48:51]
    ds_read_b128 v[112:115], v44 offset:192
    v_mfma_f32_16x16x32_bf16 v[52:55], v[144:147], v[180:183], v[52:55]
    ds_read2_b32 v[80:81], v36 offset0:48 offset1:49
    v_mfma_f32_16x16x32_bf16 v[56:59], v[144:147], v[184:187], v[56:59]
    ds_read2_b32 v[82:83], v36 offset0:50 offset1:51
    v_mfma_f32_16x16x32_bf16 v[60:63], v[144:147], v[188:191], v[60:63]
    ds_read_b128 v[116:119], v44 offset:704
    v_mfma_f32_16x16x32_bf16 v[64:67], v[144:147], v[192:195], v[64:67]
    ds_read2_b32 v[84:85], v37 offset0:48 offset1:49
    v_mfma_f32_16x16x32_bf16 v[68:71], v[144:147], v[196:199], v[68:71]
    ds_read2_b32 v[86:87], v37 offset0:50 offset1:51
    v_mfma_f32_16x16x32_bf16 v[72:75], v[144:147], v[200:203], v[72:75]
    ds_read_b128 v[120:123], v44 offset:1216
    v_mfma_f32_16x16x32_bf16 v[76:79], v[144:147], v[204:207], v[76:79]
    ds_read2_b32 v[88:89], v38 offset0:48 offset1:49
    v_mfma_f32_16x16x32_bf16 v[52:55], v[148:151], v[176:179], v[52:55]
    ds_read2_b32 v[90:91], v38 offset0:50 offset1:51
    v_mfma_f32_16x16x32_bf16 v[56:59], v[148:151], v[180:183], v[56:59]
    ds_read_b128 v[124:127], v44 offset:1728
    v_mfma_f32_16x16x32_bf16 v[60:63], v[148:151], v[184:187], v[60:63]
    ds_read2_b32 v[92:93], v39 offset0:48 offset1:49
    v_mfma_f32_16x16x32_bf16 v[64:67], v[148:151], v[188:191], v[64:67]
    ds_read2_b32 v[94:95], v39 offset0:50 offset1:51
    v_mfma_f32_16x16x32_bf16 v[68:71], v[148:151], v[192:195], v[68:71]
    ds_read_b128 v[128:131], v44 offset:2240
    v_mfma_f32_16x16x32_bf16 v[72:75], v[148:151], v[196:199], v[72:75]
    ds_read2_b32 v[96:97], v40 offset0:48 offset1:49
    v_mfma_f32_16x16x32_bf16 v[76:79], v[148:151], v[200:203], v[76:79]
    ds_read2_b32 v[98:99], v40 offset0:50 offset1:51
    v_mfma_f32_16x16x32_bf16 v[56:59], v[152:155], v[176:179], v[56:59]
    ds_read_b128 v[132:135], v44 offset:2752
    v_mfma_f32_16x16x32_bf16 v[60:63], v[152:155], v[180:183], v[60:63]
    ds_read2_b32 v[100:101], v41 offset0:48 offset1:49
    v_mfma_f32_16x16x32_bf16 v[64:67], v[152:155], v[184:187], v[64:67]
    ds_read2_b32 v[102:103], v41 offset0:50 offset1:51
    v_mfma_f32_16x16x32_bf16 v[68:71], v[152:155], v[188:191], v[68:71]
    ds_read_b128 v[136:139], v44 offset:3264
    v_mfma_f32_16x16x32_bf16 v[72:75], v[152:155], v[192:195], v[72:75]
    ds_read2_b32 v[104:105], v42 offset0:48 offset1:49
    v_mfma_f32_16x16x32_bf16 v[76:79], v[152:155], v[196:199], v[76:79]
    ds_read2_b32 v[106:107], v42 offset0:50 offset1:51
    v_mfma_f32_16x16x32_bf16 v[60:63], v[156:159], v[176:179], v[60:63]
    ds_read_b128 v[140:143], v44 offset:3776
    v_mfma_f32_16x16x32_bf16 v[64:67], v[156:159], v[180:183], v[64:67]
    ds_read2_b32 v[108:109], v43 offset0:48 offset1:49
    v_mfma_f32_16x16x32_bf16 v[68:71], v[156:159], v[184:187], v[68:71]
    ds_read2_b32 v[110:111], v43 offset0:50 offset1:51
    v_mfma_f32_16x16x32_bf16 v[72:75], v[156:159], v[188:191], v[72:75]
    v_mfma_f32_16x16x32_bf16 v[76:79], v[156:159], v[192:195], v[76:79]
    v_mfma_f32_16x16x32_bf16 v[64:67], v[160:163], v[176:179], v[64:67]
    v_mfma_f32_16x16x32_bf16 v[68:71], v[160:163], v[180:183], v[68:71]
    v_mfma_f32_16x16x32_bf16 v[72:75], v[160:163], v[184:187], v[72:75]
    v_mfma_f32_16x16x32_bf16 v[76:79], v[160:163], v[188:191], v[76:79]
    v_mfma_f32_16x16x32_bf16 v[68:71], v[164:167], v[176:179], v[68:71]
    v_mfma_f32_16x16x32_bf16 v[72:75], v[164:167], v[180:183], v[72:75]
    v_mfma_f32_16x16x32_bf16 v[76:79], v[164:167], v[184:187], v[76:79]
    v_mfma_f32_16x16x32_bf16 v[72:75], v[168:171], v[176:179], v[72:75]
    v_mfma_f32_16x16x32_bf16 v[76:79], v[168:171], v[180:183], v[76:79]
    v_mfma_f32_16x16x32_bf16 v[76:79], v[172:175], v[176:179], v[76:79]
    s_waitcnt lgkmcnt(0)
    v_mfma_f32_16x16x32_bf16 v[48:51], v[80:83], v[112:115], v[48:51]
    ds_read_b128 v[176:179], v44 offset:128
    v_mfma_f32_16x16x32_bf16 v[52:55], v[80:83], v[116:119], v[52:55]
    ds_read2_b32 v[144:145], v36 offset0:32 offset1:33
    v_mfma_f32_16x16x32_bf16 v[56:59], v[80:83], v[120:123], v[56:59]
    ds_read2_b32 v[146:147], v36 offset0:34 offset1:35
    v_mfma_f32_16x16x32_bf16 v[60:63], v[80:83], v[124:127], v[60:63]
    ds_read_b128 v[180:183], v44 offset:640
    v_mfma_f32_16x16x32_bf16 v[64:67], v[80:83], v[128:131], v[64:67]
    ds_read2_b32 v[148:149], v37 offset0:32 offset1:33
    v_mfma_f32_16x16x32_bf16 v[68:71], v[80:83], v[132:135], v[68:71]
    ds_read2_b32 v[150:151], v37 offset0:34 offset1:35
    v_mfma_f32_16x16x32_bf16 v[72:75], v[80:83], v[136:139], v[72:75]
    ds_read_b128 v[184:187], v44 offset:1152
    v_mfma_f32_16x16x32_bf16 v[76:79], v[80:83], v[140:143], v[76:79]
    ds_read2_b32 v[152:153], v38 offset0:32 offset1:33
    v_mfma_f32_16x16x32_bf16 v[52:55], v[84:87], v[112:115], v[52:55]
    ds_read2_b32 v[154:155], v38 offset0:34 offset1:35
    v_mfma_f32_16x16x32_bf16 v[56:59], v[84:87], v[116:119], v[56:59]
    ds_read_b128 v[188:191], v44 offset:1664
    v_mfma_f32_16x16x32_bf16 v[60:63], v[84:87], v[120:123], v[60:63]
    ds_read2_b32 v[156:157], v39 offset0:32 offset1:33
    v_mfma_f32_16x16x32_bf16 v[64:67], v[84:87], v[124:127], v[64:67]
    ds_read2_b32 v[158:159], v39 offset0:34 offset1:35
    v_mfma_f32_16x16x32_bf16 v[68:71], v[84:87], v[128:131], v[68:71]
    ds_read_b128 v[192:195], v44 offset:2176
    v_mfma_f32_16x16x32_bf16 v[72:75], v[84:87], v[132:135], v[72:75]
    ds_read2_b32 v[160:161], v40 offset0:32 offset1:33
    v_mfma_f32_16x16x32_bf16 v[76:79], v[84:87], v[136:139], v[76:79]
    ds_read2_b32 v[162:163], v40 offset0:34 offset1:35
    v_mfma_f32_16x16x32_bf16 v[56:59], v[88:91], v[112:115], v[56:59]
    ds_read_b128 v[196:199], v44 offset:2688
    v_mfma_f32_16x16x32_bf16 v[60:63], v[88:91], v[116:119], v[60:63]
    ds_read2_b32 v[164:165], v41 offset0:32 offset1:33
    v_mfma_f32_16x16x32_bf16 v[64:67], v[88:91], v[120:123], v[64:67]
    ds_read2_b32 v[166:167], v41 offset0:34 offset1:35
    v_mfma_f32_16x16x32_bf16 v[68:71], v[88:91], v[124:127], v[68:71]
    ds_read_b128 v[200:203], v44 offset:3200
    v_mfma_f32_16x16x32_bf16 v[72:75], v[88:91], v[128:131], v[72:75]
    ds_read2_b32 v[168:169], v42 offset0:32 offset1:33
    v_mfma_f32_16x16x32_bf16 v[76:79], v[88:91], v[132:135], v[76:79]
    ds_read2_b32 v[170:171], v42 offset0:34 offset1:35
    v_mfma_f32_16x16x32_bf16 v[60:63], v[92:95], v[112:115], v[60:63]
    ds_read_b128 v[204:207], v44 offset:3712
    v_mfma_f32_16x16x32_bf16 v[64:67], v[92:95], v[116:119], v[64:67]
    ds_read2_b32 v[172:173], v43 offset0:32 offset1:33
    v_mfma_f32_16x16x32_bf16 v[68:71], v[92:95], v[120:123], v[68:71]
    ds_read2_b32 v[174:175], v43 offset0:34 offset1:35
    v_mfma_f32_16x16x32_bf16 v[72:75], v[92:95], v[124:127], v[72:75]
    v_mfma_f32_16x16x32_bf16 v[76:79], v[92:95], v[128:131], v[76:79]
    v_mfma_f32_16x16x32_bf16 v[64:67], v[96:99], v[112:115], v[64:67]
    v_mfma_f32_16x16x32_bf16 v[68:71], v[96:99], v[116:119], v[68:71]
    v_mfma_f32_16x16x32_bf16 v[72:75], v[96:99], v[120:123], v[72:75]
    v_mfma_f32_16x16x32_bf16 v[76:79], v[96:99], v[124:127], v[76:79]
    v_mfma_f32_16x16x32_bf16 v[68:71], v[100:103], v[112:115], v[68:71]
    v_mfma_f32_16x16x32_bf16 v[72:75], v[100:103], v[116:119], v[72:75]
    v_mfma_f32_16x16x32_bf16 v[76:79], v[100:103], v[120:123], v[76:79]
    v_mfma_f32_16x16x32_bf16 v[72:75], v[104:107], v[112:115], v[72:75]
    v_mfma_f32_16x16x32_bf16 v[76:79], v[104:107], v[116:119], v[76:79]
    v_mfma_f32_16x16x32_bf16 v[76:79], v[108:111], v[112:115], v[76:79]
    s_waitcnt lgkmcnt(0)
    v_mfma_f32_16x16x32_bf16 v[48:51], v[144:147], v[176:179], v[48:51]
    ds_read_b128 v[112:115], v44 offset:64
    v_mfma_f32_16x16x32_bf16 v[52:55], v[144:147], v[180:183], v[52:55]
    ds_read2_b32 v[80:81], v36 offset0:16 offset1:17
    v_mfma_f32_16x16x32_bf16 v[56:59], v[144:147], v[184:187], v[56:59]
    ds_read2_b32 v[82:83], v36 offset0:18 offset1:19
    v_mfma_f32_16x16x32_bf16 v[60:63], v[144:147], v[188:191], v[60:63]
    ds_read_b128 v[116:119], v44 offset:576
    v_mfma_f32_16x16x32_bf16 v[64:67], v[144:147], v[192:195], v[64:67]
    ds_read2_b32 v[84:85], v37 offset0:16 offset1:17
    v_mfma_f32_16x16x32_bf16 v[68:71], v[144:147], v[196:199], v[68:71]
    ds_read2_b32 v[86:87], v37 offset0:18 offset1:19
    v_mfma_f32_16x16x32_bf16 v[72:75], v[144:147], v[200:203], v[72:75]
    ds_read_b128 v[120:123], v44 offset:1088
    v_mfma_f32_16x16x32_bf16 v[76:79], v[144:147], v[204:207], v[76:79]
    ds_read2_b32 v[88:89], v38 offset0:16 offset1:17
    v_mfma_f32_16x16x32_bf16 v[52:55], v[148:151], v[176:179], v[52:55]
    ds_read2_b32 v[90:91], v38 offset0:18 offset1:19
    v_mfma_f32_16x16x32_bf16 v[56:59], v[148:151], v[180:183], v[56:59]
    ds_read_b128 v[124:127], v44 offset:1600
    v_mfma_f32_16x16x32_bf16 v[60:63], v[148:151], v[184:187], v[60:63]
    ds_read2_b32 v[92:93], v39 offset0:16 offset1:17
    v_mfma_f32_16x16x32_bf16 v[64:67], v[148:151], v[188:191], v[64:67]
    ds_read2_b32 v[94:95], v39 offset0:18 offset1:19
    v_mfma_f32_16x16x32_bf16 v[68:71], v[148:151], v[192:195], v[68:71]
    ds_read_b128 v[128:131], v44 offset:2112
    v_mfma_f32_16x16x32_bf16 v[72:75], v[148:151], v[196:199], v[72:75]
    ds_read2_b32 v[96:97], v40 offset0:16 offset1:17
    v_mfma_f32_16x16x32_bf16 v[76:79], v[148:151], v[200:203], v[76:79]
    ds_read2_b32 v[98:99], v40 offset0:18 offset1:19
    v_mfma_f32_16x16x32_bf16 v[56:59], v[152:155], v[176:179], v[56:59]
    ds_read_b128 v[132:135], v44 offset:2624
    v_mfma_f32_16x16x32_bf16 v[60:63], v[152:155], v[180:183], v[60:63]
    ds_read2_b32 v[100:101], v41 offset0:16 offset1:17
    v_mfma_f32_16x16x32_bf16 v[64:67], v[152:155], v[184:187], v[64:67]
    ds_read2_b32 v[102:103], v41 offset0:18 offset1:19
    v_mfma_f32_16x16x32_bf16 v[68:71], v[152:155], v[188:191], v[68:71]
    ds_read_b128 v[136:139], v44 offset:3136
    v_mfma_f32_16x16x32_bf16 v[72:75], v[152:155], v[192:195], v[72:75]
    ds_read2_b32 v[104:105], v42 offset0:16 offset1:17
    v_mfma_f32_16x16x32_bf16 v[76:79], v[152:155], v[196:199], v[76:79]
    ds_read2_b32 v[106:107], v42 offset0:18 offset1:19
    v_mfma_f32_16x16x32_bf16 v[60:63], v[156:159], v[176:179], v[60:63]
    ds_read_b128 v[140:143], v44 offset:3648
    v_mfma_f32_16x16x32_bf16 v[64:67], v[156:159], v[180:183], v[64:67]
    ds_read2_b32 v[108:109], v43 offset0:16 offset1:17
    v_mfma_f32_16x16x32_bf16 v[68:71], v[156:159], v[184:187], v[68:71]
    ds_read2_b32 v[110:111], v43 offset0:18 offset1:19
    v_mfma_f32_16x16x32_bf16 v[72:75], v[156:159], v[188:191], v[72:75]
    v_mfma_f32_16x16x32_bf16 v[76:79], v[156:159], v[192:195], v[76:79]
    v_mfma_f32_16x16x32_bf16 v[64:67], v[160:163], v[176:179], v[64:67]
    v_mfma_f32_16x16x32_bf16 v[68:71], v[160:163], v[180:183], v[68:71]
    v_mfma_f32_16x16x32_bf16 v[72:75], v[160:163], v[184:187], v[72:75]
    v_mfma_f32_16x16x32_bf16 v[76:79], v[160:163], v[188:191], v[76:79]
    v_mfma_f32_16x16x32_bf16 v[68:71], v[164:167], v[176:179], v[68:71]
    v_mfma_f32_16x16x32_bf16 v[72:75], v[164:167], v[180:183], v[72:75]
    v_mfma_f32_16x16x32_bf16 v[76:79], v[164:167], v[184:187], v[76:79]
    v_mfma_f32_16x16x32_bf16 v[72:75], v[168:171], v[176:179], v[72:75]
    v_mfma_f32_16x16x32_bf16 v[76:79], v[168:171], v[180:183], v[76:79]
    v_mfma_f32_16x16x32_bf16 v[76:79], v[172:175], v[176:179], v[76:79]
    s_waitcnt lgkmcnt(0)
    v_mfma_f32_16x16x32_bf16 v[48:51], v[80:83], v[112:115], v[48:51]
    ds_read_b128 v[176:179], v44 offset:0
    v_mfma_f32_16x16x32_bf16 v[52:55], v[80:83], v[116:119], v[52:55]
    ds_read2_b32 v[144:145], v36 offset0:0 offset1:1
    v_mfma_f32_16x16x32_bf16 v[56:59], v[80:83], v[120:123], v[56:59]
    ds_read2_b32 v[146:147], v36 offset0:2 offset1:3
    v_mfma_f32_16x16x32_bf16 v[60:63], v[80:83], v[124:127], v[60:63]
    ds_read_b128 v[180:183], v44 offset:512
    v_mfma_f32_16x16x32_bf16 v[64:67], v[80:83], v[128:131], v[64:67]
    ds_read2_b32 v[148:149], v37 offset0:0 offset1:1
    v_mfma_f32_16x16x32_bf16 v[68:71], v[80:83], v[132:135], v[68:71]
    ds_read2_b32 v[150:151], v37 offset0:2 offset1:3
    v_mfma_f32_16x16x32_bf16 v[72:75], v[80:83], v[136:139], v[72:75]
    ds_read_b128 v[184:187], v44 offset:1024
    v_mfma_f32_16x16x32_bf16 v[76:79], v[80:83], v[140:143], v[76:79]
    ds_read2_b32 v[152:153], v38 offset0:0 offset1:1
    v_mfma_f32_16x16x32_bf16 v[52:55], v[84:87], v[112:115], v[52:55]
    ds_read2_b32 v[154:155], v38 offset0:2 offset1:3
    v_mfma_f32_16x16x32_bf16 v[56:59], v[84:87], v[116:119], v[56:59]
    ds_read_b128 v[188:191], v44 offset:1536
    v_mfma_f32_16x16x32_bf16 v[60:63], v[84:87], v[120:123], v[60:63]
    ds_read2_b32 v[156:157], v39 offset0:0 offset1:1
    v_mfma_f32_16x16x32_bf16 v[64:67], v[84:87], v[124:127], v[64:67]
    ds_read2_b32 v[158:159], v39 offset0:2 offset1:3
    v_mfma_f32_16x16x32_bf16 v[68:71], v[84:87], v[128:131], v[68:71]
    ds_read_b128 v[192:195], v44 offset:2048
    v_mfma_f32_16x16x32_bf16 v[72:75], v[84:87], v[132:135], v[72:75]
    ds_read2_b32 v[160:161], v40 offset0:0 offset1:1
    v_mfma_f32_16x16x32_bf16 v[76:79], v[84:87], v[136:139], v[76:79]
    ds_read2_b32 v[162:163], v40 offset0:2 offset1:3
    v_mfma_f32_16x16x32_bf16 v[56:59], v[88:91], v[112:115], v[56:59]
    ds_read_b128 v[196:199], v44 offset:2560
    v_mfma_f32_16x16x32_bf16 v[60:63], v[88:91], v[116:119], v[60:63]
    ds_read2_b32 v[164:165], v41 offset0:0 offset1:1
    v_mfma_f32_16x16x32_bf16 v[64:67], v[88:91], v[120:123], v[64:67]
    ds_read2_b32 v[166:167], v41 offset0:2 offset1:3
    v_mfma_f32_16x16x32_bf16 v[68:71], v[88:91], v[124:127], v[68:71]
    ds_read_b128 v[200:203], v44 offset:3072
    v_mfma_f32_16x16x32_bf16 v[72:75], v[88:91], v[128:131], v[72:75]
    ds_read2_b32 v[168:169], v42 offset0:0 offset1:1
    v_mfma_f32_16x16x32_bf16 v[76:79], v[88:91], v[132:135], v[76:79]
    ds_read2_b32 v[170:171], v42 offset0:2 offset1:3
    v_mfma_f32_16x16x32_bf16 v[60:63], v[92:95], v[112:115], v[60:63]
    ds_read_b128 v[204:207], v44 offset:3584
    v_mfma_f32_16x16x32_bf16 v[64:67], v[92:95], v[116:119], v[64:67]
    ds_read2_b32 v[172:173], v43 offset0:0 offset1:1
    v_mfma_f32_16x16x32_bf16 v[68:71], v[92:95], v[120:123], v[68:71]
    ds_read2_b32 v[174:175], v43 offset0:2 offset1:3
    v_mfma_f32_16x16x32_bf16 v[72:75], v[92:95], v[124:127], v[72:75]
    v_mfma_f32_16x16x32_bf16 v[76:79], v[92:95], v[128:131], v[76:79]
    v_mfma_f32_16x16x32_bf16 v[64:67], v[96:99], v[112:115], v[64:67]
    v_mfma_f32_16x16x32_bf16 v[68:71], v[96:99], v[116:119], v[68:71]
    v_mfma_f32_16x16x32_bf16 v[72:75], v[96:99], v[120:123], v[72:75]
    v_mfma_f32_16x16x32_bf16 v[76:79], v[96:99], v[124:127], v[76:79]
    v_mfma_f32_16x16x32_bf16 v[68:71], v[100:103], v[112:115], v[68:71]
    v_mfma_f32_16x16x32_bf16 v[72:75], v[100:103], v[116:119], v[72:75]
    v_mfma_f32_16x16x32_bf16 v[76:79], v[100:103], v[120:123], v[76:79]
    v_mfma_f32_16x16x32_bf16 v[72:75], v[104:107], v[112:115], v[72:75]
    v_mfma_f32_16x16x32_bf16 v[76:79], v[104:107], v[116:119], v[76:79]
    v_mfma_f32_16x16x32_bf16 v[76:79], v[108:111], v[112:115], v[76:79]
    s_waitcnt lgkmcnt(0)
    v_mfma_f32_16x16x32_bf16 v[48:51], v[144:147], v[176:179], v[48:51]
    v_mfma_f32_16x16x32_bf16 v[52:55], v[144:147], v[180:183], v[52:55]
    v_mfma_f32_16x16x32_bf16 v[56:59], v[144:147], v[184:187], v[56:59]
    v_mfma_f32_16x16x32_bf16 v[60:63], v[144:147], v[188:191], v[60:63]
    v_mfma_f32_16x16x32_bf16 v[64:67], v[144:147], v[192:195], v[64:67]
    v_mfma_f32_16x16x32_bf16 v[68:71], v[144:147], v[196:199], v[68:71]
    v_mfma_f32_16x16x32_bf16 v[72:75], v[144:147], v[200:203], v[72:75]
    v_mfma_f32_16x16x32_bf16 v[76:79], v[144:147], v[204:207], v[76:79]
    v_mfma_f32_16x16x32_bf16 v[52:55], v[148:151], v[176:179], v[52:55]
    v_mfma_f32_16x16x32_bf16 v[56:59], v[148:151], v[180:183], v[56:59]
    v_mfma_f32_16x16x32_bf16 v[60:63], v[148:151], v[184:187], v[60:63]
    v_mfma_f32_16x16x32_bf16 v[64:67], v[148:151], v[188:191], v[64:67]
    v_mfma_f32_16x16x32_bf16 v[68:71], v[148:151], v[192:195], v[68:71]
    v_mfma_f32_16x16x32_bf16 v[72:75], v[148:151], v[196:199], v[72:75]
    v_mfma_f32_16x16x32_bf16 v[76:79], v[148:151], v[200:203], v[76:79]
    v_mfma_f32_16x16x32_bf16 v[56:59], v[152:155], v[176:179], v[56:59]
    v_mfma_f32_16x16x32_bf16 v[60:63], v[152:155], v[180:183], v[60:63]
    v_mfma_f32_16x16x32_bf16 v[64:67], v[152:155], v[184:187], v[64:67]
    v_mfma_f32_16x16x32_bf16 v[68:71], v[152:155], v[188:191], v[68:71]
    v_mfma_f32_16x16x32_bf16 v[72:75], v[152:155], v[192:195], v[72:75]
    v_mfma_f32_16x16x32_bf16 v[76:79], v[152:155], v[196:199], v[76:79]
    v_mfma_f32_16x16x32_bf16 v[60:63], v[156:159], v[176:179], v[60:63]
    v_mfma_f32_16x16x32_bf16 v[64:67], v[156:159], v[180:183], v[64:67]
    v_mfma_f32_16x16x32_bf16 v[68:71], v[156:159], v[184:187], v[68:71]
    v_mfma_f32_16x16x32_bf16 v[72:75], v[156:159], v[188:191], v[72:75]
    v_mfma_f32_16x16x32_bf16 v[76:79], v[156:159], v[192:195], v[76:79]
    v_mfma_f32_16x16x32_bf16 v[64:67], v[160:163], v[176:179], v[64:67]
    v_mfma_f32_16x16x32_bf16 v[68:71], v[160:163], v[180:183], v[68:71]
    v_mfma_f32_16x16x32_bf16 v[72:75], v[160:163], v[184:187], v[72:75]
    v_mfma_f32_16x16x32_bf16 v[76:79], v[160:163], v[188:191], v[76:79]
    v_mfma_f32_16x16x32_bf16 v[68:71], v[164:167], v[176:179], v[68:71]
    v_mfma_f32_16x16x32_bf16 v[72:75], v[164:167], v[180:183], v[72:75]
    v_mfma_f32_16x16x32_bf16 v[76:79], v[164:167], v[184:187], v[76:79]
    v_mfma_f32_16x16x32_bf16 v[72:75], v[168:171], v[176:179], v[72:75]
    v_mfma_f32_16x16x32_bf16 v[76:79], v[168:171], v[180:183], v[76:79]
    v_mfma_f32_16x16x32_bf16 v[76:79], v[172:175], v[176:179], v[76:79]
    s_nop 7
    v_lshlrev_b32 v5, 6, v2
    v_lshl_add_u32 v5, v3, 4, v5
    v_add_u32 v5, v5, v4
    ds_write_b128 v5, v[48:51] offset:7424
    ds_write_b128 v5, v[52:55] offset:8448
    ds_write_b128 v5, v[56:59] offset:9472
    ds_write_b128 v5, v[60:63] offset:10496
    ds_write_b128 v5, v[64:67] offset:11520
    ds_write_b128 v5, v[68:71] offset:12544
    ds_write_b128 v5, v[72:75] offset:13568
    ds_write_b128 v5, v[76:79] offset:14592
    v_mov_b64 v[8:9], v[16:17]
    v_mov_b64 v[10:11], v[18:19]
    v_mov_b64 v[12:13], v[20:21]
    v_mov_b64 v[14:15], v[22:23]
    v_mov_b32 v24, v25
    v_add_u32 v4, 65536, v4
    s_add_u32 s28, s28, 1
    s_cmp_lt_u32 s28, 2
    s_waitcnt lgkmcnt(0)
    s_cbranch_scc1 ss_pass
    s_mov_b32 s12, s74
    s_mov_b32 s13, s75
    s_mov_b32 s14, 1152
    s_mov_b32 s15, 0x20000
    s_lshl_b32 s23, s20, 1
    buffer_load_dwordx4 v[8:11], off, s[12:15], s23
    s_barrier
    v_lshlrev_b32 v5, 5, v0
    v_add_u32 v7, 65536, v5
    ds_read_b128 v[64:67], v5 offset:7424
    ds_read_b128 v[68:71], v5 offset:7440
    ds_read_b128 v[72:75], v5 offset:23808
    ds_read_b128 v[76:79], v5 offset:23824
    ds_read_b128 v[80:83], v5 offset:40192
    ds_read_b128 v[84:87], v5 offset:40208
    ds_read_b128 v[88:91], v5 offset:56576
    ds_read_b128 v[92:95], v5 offset:56592
    ds_read_b128 v[96:99], v7 offset:7424
    ds_read_b128 v[100:103], v7 offset:7440
    ds_read_b128 v[104:107], v7 offset:23808
    ds_read_b128 v[108:111], v7 offset:23824
    ds_read_b128 v[112:115], v7 offset:40192
    ds_read_b128 v[116:119], v7 offset:40208
    ds_read_b128 v[120:123], v7 offset:56576
    ds_read_b128 v[124:127], v7 offset:56592
    s_waitcnt vmcnt(0)
    v_lshlrev_b32 v12, 16, v8
    v_and_b32 v13, 0xffff0000, v8
    v_lshlrev_b32 v14, 16, v9
    v_and_b32 v15, 0xffff0000, v9
    v_lshlrev_b32 v16, 16, v10
    v_and_b32 v17, 0xffff0000, v10
    v_lshlrev_b32 v18, 16, v11
    v_and_b32 v19, 0xffff0000, v11
    v_mul_u32_u24 v5, 18432, v0
    s_lshl_b32 s22, s20, 1
    s_add_u32 s22, s22, 1152
    s_waitcnt lgkmcnt(0)
    v_lshlrev_b32 v6, 16, v208
    v_fmac_f32 v64, v6, v12
    v_and_b32 v6, 0xffff0000, v208
    v_fmac_f32 v72, v6, v13
    v_lshlrev_b32 v6, 16, v209
    v_fmac_f32 v80, v6, v14
    v_and_b32 v6, 0xffff0000, v209
    v_fmac_f32 v88, v6, v15
    v_lshlrev_b32 v6, 16, v210
    v_fmac_f32 v96, v6, v16
    v_and_b32 v6, 0xffff0000, v210
    v_fmac_f32 v104, v6, v17
    v_lshlrev_b32 v6, 16, v211
    v_fmac_f32 v112, v6, v18
    v_and_b32 v6, 0xffff0000, v211
    v_fmac_f32 v120, v6, v19
    v_cvt_pk_bf16_f32 v208, v64, v72
    v_cvt_pk_bf16_f32 v209, v80, v88
    v_cvt_pk_bf16_f32 v210, v96, v104
    v_cvt_pk_bf16_f32 v211, v112, v120
    s_add_u32 s23, s22, 0
    buffer_store_dwordx4 v[208:211], v5, s[16:19], s23 offen
    v_lshlrev_b32 v6, 16, v212
    v_fmac_f32 v65, v6, v12
    v_and_b32 v6, 0xffff0000, v212
    v_fmac_f32 v73, v6, v13
    v_lshlrev_b32 v6, 16, v213
    v_fmac_f32 v81, v6, v14
    v_and_b32 v6, 0xffff0000, v213
    v_fmac_f32 v89, v6, v15
    v_lshlrev_b32 v6, 16, v214
    v_fmac_f32 v97, v6, v16
    v_and_b32 v6, 0xffff0000, v214
    v_fmac_f32 v105, v6, v17
    v_lshlrev_b32 v6, 16, v215
    v_fmac_f32 v113, v6, v18
    v_and_b32 v6, 0xffff0000, v215
    v_fmac_f32 v121, v6, v19
    v_cvt_pk_bf16_f32 v212, v65, v73
    v_cvt_pk_bf16_f32 v213, v81, v89
    v_cvt_pk_bf16_f32 v214, v97, v105
    v_cvt_pk_bf16_f32 v215, v113, v121
    s_add_u32 s23, s22, 2304
    buffer_store_dwordx4 v[212:215], v5, s[16:19], s23 offen
    v_lshlrev_b32 v6, 16, v216
    v_fmac_f32 v66, v6, v12
    v_and_b32 v6, 0xffff0000, v216
    v_fmac_f32 v74, v6, v13
    v_lshlrev_b32 v6, 16, v217
    v_fmac_f32 v82, v6, v14
    v_and_b32 v6, 0xffff0000, v217
    v_fmac_f32 v90, v6, v15
    v_lshlrev_b32 v6, 16, v218
    v_fmac_f32 v98, v6, v16
    v_and_b32 v6, 0xffff0000, v218
    v_fmac_f32 v106, v6, v17
    v_lshlrev_b32 v6, 16, v219
    v_fmac_f32 v114, v6, v18
    v_and_b32 v6, 0xffff0000, v219
    v_fmac_f32 v122, v6, v19
    v_cvt_pk_bf16_f32 v216, v66, v74
    v_cvt_pk_bf16_f32 v217, v82, v90
    v_cvt_pk_bf16_f32 v218, v98, v106
    v_cvt_pk_bf16_f32 v219, v114, v122
    s_add_u32 s23, s22, 4608
    buffer_store_dwordx4 v[216:219], v5, s[16:19], s23 offen
    v_lshlrev_b32 v6, 16, v220
    v_fmac_f32 v67, v6, v12
    v_and_b32 v6, 0xffff0000, v220
    v_fmac_f32 v75, v6, v13
    v_lshlrev_b32 v6, 16, v221
    v_fmac_f32 v83, v6, v14
    v_and_b32 v6, 0xffff0000, v221
    v_fmac_f32 v91, v6, v15
    v_lshlrev_b32 v6, 16, v222
    v_fmac_f32 v99, v6, v16
    v_and_b32 v6, 0xffff0000, v222
    v_fmac_f32 v107, v6, v17
    v_lshlrev_b32 v6, 16, v223
    v_fmac_f32 v115, v6, v18
    v_and_b32 v6, 0xffff0000, v223
    v_fmac_f32 v123, v6, v19
    v_cvt_pk_bf16_f32 v220, v67, v75
    v_cvt_pk_bf16_f32 v221, v83, v91
    v_cvt_pk_bf16_f32 v222, v99, v107
    v_cvt_pk_bf16_f32 v223, v115, v123
    s_add_u32 s23, s22, 6912
    buffer_store_dwordx4 v[220:223], v5, s[16:19], s23 offen
    v_lshlrev_b32 v6, 16, v224
    v_fmac_f32 v68, v6, v12
    v_and_b32 v6, 0xffff0000, v224
    v_fmac_f32 v76, v6, v13
    v_lshlrev_b32 v6, 16, v225
    v_fmac_f32 v84, v6, v14
    v_and_b32 v6, 0xffff0000, v225
    v_fmac_f32 v92, v6, v15
    v_lshlrev_b32 v6, 16, v226
    v_fmac_f32 v100, v6, v16
    v_and_b32 v6, 0xffff0000, v226
    v_fmac_f32 v108, v6, v17
    v_lshlrev_b32 v6, 16, v227
    v_fmac_f32 v116, v6, v18
    v_and_b32 v6, 0xffff0000, v227
    v_fmac_f32 v124, v6, v19
    v_cvt_pk_bf16_f32 v224, v68, v76
    v_cvt_pk_bf16_f32 v225, v84, v92
    v_cvt_pk_bf16_f32 v226, v100, v108
    v_cvt_pk_bf16_f32 v227, v116, v124
    s_add_u32 s23, s22, 9216
    buffer_store_dwordx4 v[224:227], v5, s[16:19], s23 offen
    v_lshlrev_b32 v6, 16, v228
    v_fmac_f32 v69, v6, v12
    v_and_b32 v6, 0xffff0000, v228
    v_fmac_f32 v77, v6, v13
    v_lshlrev_b32 v6, 16, v229
    v_fmac_f32 v85, v6, v14
    v_and_b32 v6, 0xffff0000, v229
    v_fmac_f32 v93, v6, v15
    v_lshlrev_b32 v6, 16, v230
    v_fmac_f32 v101, v6, v16
    v_and_b32 v6, 0xffff0000, v230
    v_fmac_f32 v109, v6, v17
    v_lshlrev_b32 v6, 16, v231
    v_fmac_f32 v117, v6, v18
    v_and_b32 v6, 0xffff0000, v231
    v_fmac_f32 v125, v6, v19
    v_cvt_pk_bf16_f32 v228, v69, v77
    v_cvt_pk_bf16_f32 v229, v85, v93
    v_cvt_pk_bf16_f32 v230, v101, v109
    v_cvt_pk_bf16_f32 v231, v117, v125
    s_add_u32 s23, s22, 11520
    buffer_store_dwordx4 v[228:231], v5, s[16:19], s23 offen
    v_lshlrev_b32 v6, 16, v232
    v_fmac_f32 v70, v6, v12
    v_and_b32 v6, 0xffff0000, v232
    v_fmac_f32 v78, v6, v13
    v_lshlrev_b32 v6, 16, v233
    v_fmac_f32 v86, v6, v14
    v_and_b32 v6, 0xffff0000, v233
    v_fmac_f32 v94, v6, v15
    v_lshlrev_b32 v6, 16, v234
    v_fmac_f32 v102, v6, v16
    v_and_b32 v6, 0xffff0000, v234
    v_fmac_f32 v110, v6, v17
    v_lshlrev_b32 v6, 16, v235
    v_fmac_f32 v118, v6, v18
    v_and_b32 v6, 0xffff0000, v235
    v_fmac_f32 v126, v6, v19
    v_cvt_pk_bf16_f32 v232, v70, v78
    v_cvt_pk_bf16_f32 v233, v86, v94
    v_cvt_pk_bf16_f32 v234, v102, v110
    v_cvt_pk_bf16_f32 v235, v118, v126
    s_add_u32 s23, s22, 13824
    buffer_store_dwordx4 v[232:235], v5, s[16:19], s23 offen
    v_lshlrev_b32 v6, 16, v236
    v_fmac_f32 v71, v6, v12
    v_and_b32 v6, 0xffff0000, v236
    v_fmac_f32 v79, v6, v13
    v_lshlrev_b32 v6, 16, v237
    v_fmac_f32 v87, v6, v14
    v_and_b32 v6, 0xffff0000, v237
    v_fmac_f32 v95, v6, v15
    v_lshlrev_b32 v6, 16, v238
    v_fmac_f32 v103, v6, v16
    v_and_b32 v6, 0xffff0000, v238
    v_fmac_f32 v111, v6, v17
    v_lshlrev_b32 v6, 16, v239
    v_fmac_f32 v119, v6, v18
    v_and_b32 v6, 0xffff0000, v239
    v_fmac_f32 v127, v6, v19
    v_cvt_pk_bf16_f32 v236, v71, v79
    v_cvt_pk_bf16_f32 v237, v87, v95
    v_cvt_pk_bf16_f32 v238, v103, v111
    v_cvt_pk_bf16_f32 v239, v119, v127
    s_add_u32 s23, s22, 16128
    buffer_store_dwordx4 v[236:239], v5, s[16:19], s23 offen
    s_branch L_ssm_next
L_ssm_done:
    s_cmp_lt_u32 s93, 100
    s_cbranch_scc1 L_exit
    s_mov_b32 s8, s76
    s_mov_b32 s9, s77
    s_mov_b32 s10, 4718592
    s_mov_b32 s11, 0x20000
    s_cmp_le_u32 s45, 1
    s_cbranch_scc1 L_att_next
    s_branch L_op_nextcb
L_wf_next:
    s_mov_b32 s37, 20
    v_mov_b32 v250, 1
    v_mov_b32 v251, 163832
    v_cmp_eq_u32 vcc, 0, v0
    s_nop 0
    s_and_saveexec_b64 s[38:39], vcc
    s_cbranch_execz tk12
    buffer_atomic_add v250, off, s[84:87], s37 sc0
    s_waitcnt vmcnt(0)
    ds_write_b32 v251, v250
    s_waitcnt lgkmcnt(0)
tk12:
    s_mov_b64 exec, -1
    s_barrier
    ds_read_b32 v252, v251
    s_waitcnt lgkmcnt(0)
    v_readfirstlane_b32 s33, v252
    s_barrier
    s_nop 3
    s_cmp_ge_u32 s33, 160
    s_cbranch_scc1 L_ssm_next
    s_lshl_b32 s16, s33, 2
    s_add_u32 s16, s16, s32
    s_add_u32 s16, s16, 1504
    s_call_b64 s[46:47], L_xform
    s_lshl_b32 s40, s33, 2
    s_add_u32 s40, s40, 125841408
    s_waitcnt vmcnt(0)
    s_barrier
    v_mov_b32 v250, s95
    v_cmp_eq_u32 vcc, 0, v0
    s_nop 0
    s_and_saveexec_b64 s[38:39], vcc
    s_cbranch_execz fs13
    buffer_store_dword v250, off, s[4:7], s40 sc1
fs13:
    s_mov_b64 exec, -1
    s_branch L_wf_next
L_phase2:
    s_mov_b32 s40, 524288
mc2_w:
    buffer_load_dword v250, off, s[84:87], 0 offset:28 sc1
    s_waitcnt vmcnt(0)
    v_readfirstlane_b32 s41, v250
    s_nop 0
    s_cmp_lg_u32 s41, 0
    s_cbranch_scc1 mc2_known
    s_sub_u32 s40, s40, 1
    s_cbranch_scc1 mc2_force
    s_sleep 2
    s_branch mc2_w
mc2_force:
    v_mov_b32 v250, 2
    v_mov_b32 v251, 0
    s_mov_b64 exec, 1
    buffer_atomic_cmpswap v[250:251], off, s[84:87], 0 offset:28
    s_mov_b64 exec, -1
    s_waitcnt vmcnt(0)
    s_mov_b32 s40, 524288
    s_branch mc2_w
mc2_known:
    s_cmp_eq_u32 s41, 1
    s_cbranch_scc1 L_phase2b
    s_mov_b32 s37, 208
    v_mov_b32 v250, 1
    v_mov_b32 v251, 163832
    v_cmp_eq_u32 vcc, 0, v0
    s_nop 0
    s_and_saveexec_b64 s[38:39], vcc
    s_cbranch_execz tk14
    buffer_atomic_add v250, off, s[84:87], s37 sc0
    s_waitcnt vmcnt(0)
    ds_write_b32 v251, v250
    s_waitcnt lgkmcnt(0)
tk14:
    s_mov_b64 exec, -1
    s_barrier
    ds_read_b32 v252, v251
    s_waitcnt lgkmcnt(0)
    v_readfirstlane_b32 s12, v252
    s_barrier
    s_nop 3
    s_cmp_lt_u32 s12, 32
    s_cbranch_scc1 L_chain_safe
    s_sub_u32 s45, s12, 32
L_phase2b:
    s_mov_b32 s8, s76
    s_mov_b32 s9, s77
    s_mov_b32 s10, 4718592
    s_mov_b32 s11, 0x20000
    s_and_b32 s36, s45, 15
    s_bitcmp1_b32 42315, s36
    s_cbranch_scc0 L_nots
    s_cmp_eq_u32 s93, 500
    s_cbranch_scc1 L_ssm_next
    s_branch L_wf_next
L_nots:
    s_bitcmp1_b32 18576, s36
    s_cbranch_scc0 L_att_next
    s_bfm_b32 s37, s36, 0
    s_and_b32 s37, s37, 18576
    s_bcnt1_i32_b32 s37, s37
    s_lshr_b32 s40, s45, 4
    s_mul_i32 s40, s40, 4
    s_add_u32 s33, s40, s37
L_op_mod:
    s_mul_hi_u32 s41, s33, 0x0e38e38f
    s_mul_i32 s41, s41, 18
    s_sub_u32 s33, s33, s41
    s_branch L_op_start
L_att_next:
    s_mov_b32 s37, 16
    v_mov_b32 v250, 1
    v_mov_b32 v251, 163832
    v_cmp_eq_u32 vcc, 0, v0
    s_nop 0
    s_and_saveexec_b64 s[38:39], vcc
    s_cbranch_execz tk15
    buffer_atomic_add v250, off, s[84:87], s37 sc0
    s_waitcnt vmcnt(0)
    ds_write_b32 v251, v250
    s_waitcnt lgkmcnt(0)
tk15:
    s_mov_b64 exec, -1
    s_barrier
    ds_read_b32 v252, v251
    s_waitcnt lgkmcnt(0)
    v_readfirstlane_b32 s34, v252
    s_barrier
    s_nop 3
    s_cmp_ge_u32 s34, 512
    s_cbranch_scc1 L_op_nextcb
    s_lshr_b32 s16, s34, 3
    s_and_b32 s17, s34, 7
    s_lshl_b32 s17, s17, 2
    s_add_u32 s17, s17, s32
    s_lshl_b32 s36, s17, 7
    s_add_u32 s36, s36, 125829120
    s_lshr_b32 s41, s16, 2
    s_add_u32 s41, s41, s95
    s_add_u32 s41, s41, 1
    v_and_b32 v1, 3, v0
    v_min_u32 v1, 2, v1
    v_lshlrev_b32 v2, 4, v1
    s_and_b32 s37, s16, 3
    s_lshl_b32 s37, s37, 2
    v_add_u32 v2, s37, v2
    s_mov_b32 s40, 4194304
L_aw1:
    buffer_load_dword v3, v2, s[4:7], s36 offen sc1
    s_sub_u32 s40, s40, 1
    s_cbranch_scc1 L_aw1_go
    s_waitcnt vmcnt(0)
    v_subrev_u32 v3, s41, v3
    v_cmp_lt_u32 vcc, 64, v3
    s_cbranch_vccz L_aw1_go
    s_sleep 4
    s_branch L_aw1
L_aw1_go:
    v_and_b32 v5, 63, v0
    v_lshlrev_b32 v1, 4, v5
    s_cmp_ge_u32 s16, 56
    s_cselect_b32 s18, -1, 511
    v_and_b32 v2, s18, v1
    v_or_b32 v3, 128, v1
    v_lshrrev_b32 v4, 4, v5
    v_bfe_u32 v6, v5, 2, 2
    v_sub_u32 v4, v6, v4
    v_lshlrev_b32 v4, 3, v4
    v_and_b32 v6, 3, v5
    v_add_u32 v4, v4, v6
    v_mov_b32 v6, 0xf149f2ca
    s_mov_b32 s22, 0x3e0293ee
    s_lshl_b32 s18, s16, 5
    s_add_u32 s18, s18, s17
    s_lshl_b32 s19, s18, 13
    s_add_u32 s20, s19, 33554432
    buffer_load_dwordx4 v[8:11], v1, s[4:7], s20 offen offset:0 sc1
    s_add_u32 s20, s19, 33554432
    buffer_load_dwordx4 v[12:15], v1, s[4:7], s20 offen offset:1024 sc1
    s_add_u32 s20, s19, 33554432
    buffer_load_dwordx4 v[16:19], v1, s[4:7], s20 offen offset:2048 sc1
    s_add_u32 s20, s19, 33554432
    buffer_load_dwordx4 v[20:23], v1, s[4:7], s20 offen offset:3072 sc1
    s_add_u32 s20, s19, 33558528
    buffer_load_dwordx4 v[24:27], v1, s[4:7], s20 offen offset:0 sc1
    s_add_u32 s20, s19, 33558528
    buffer_load_dwordx4 v[28:31], v1, s[4:7], s20 offen offset:1024 sc1
    s_add_u32 s20, s19, 33558528
    buffer_load_dwordx4 v[32:35], v1, s[4:7], s20 offen offset:2048 sc1
    s_add_u32 s20, s19, 33558528
    buffer_load_dwordx4 v[36:39], v1, s[4:7], s20 offen offset:3072 sc1
    s_lshl_b32 s21, s18, 14
    s_add_u32 s20, s21, 0
    buffer_load_dwordx4 v[40:43], v1, s[4:7], s20 offen offset:0 sc1
    s_add_u32 s20, s21, 4096
    buffer_load_dwordx4 v[44:47], v1, s[4:7], s20 offen offset:0 sc1
    s_add_u32 s20, s21, 8192
    buffer_load_dwordx4 v[48:51], v1, s[4:7], s20 offen offset:0 sc1
    s_add_u32 s20, s21, 12288
    buffer_load_dwordx4 v[52:55], v1, s[4:7], s20 offen offset:0 sc1
    s_add_u32 s20, s21, 0
    buffer_load_dwordx4 v[56:59], v1, s[4:7], s20 offen offset:1024 sc1
    s_add_u32 s20, s21, 4096
    buffer_load_dwordx4 v[60:63], v1, s[4:7], s20 offen offset:1024 sc1
    s_add_u32 s20, s21, 8192
    buffer_load_dwordx4 v[64:67], v1, s[4:7], s20 offen offset:1024 sc1
    s_add_u32 s20, s21, 12288
    buffer_load_dwordx4 v[68:71], v1, s[4:7], s20 offen offset:1024 sc1
    s_add_u32 s20, s21, 0
    buffer_load_dwordx4 v[88:91], v1, s[4:7], s20 offen offset:2048 sc1
    s_add_u32 s20, s21, 4096
    buffer_load_dwordx4 v[92:95], v1, s[4:7], s20 offen offset:2048 sc1
    s_add_u32 s20, s21, 8192
    buffer_load_dwordx4 v[96:99], v1, s[4:7], s20 offen offset:2048 sc1
    s_add_u32 s20, s21, 12288
    buffer_load_dwordx4 v[100:103], v1, s[4:7], s20 offen offset:2048 sc1
    s_add_u32 s20, s21, 0
    buffer_load_dwordx4 v[104:107], v1, s[4:7], s20 offen offset:3072 sc1
    s_add_u32 s20, s21, 4096
    buffer_load_dwordx4 v[108:111], v1, s[4:7], s20 offen offset:3072 sc1
    s_add_u32 s20, s21, 8192
    buffer_load_dwordx4 v[112:115], v1, s[4:7], s20 offen offset:3072 sc1
    s_add_u32 s20, s21, 12288
    buffer_load_dwordx4 v[116:119], v1, s[4:7], s20 offen offset:3072 sc1
    v_mov_b32 v172, 0x3f803f80
    v_mov_b32 v173, 0x3f803f80
    v_mov_b32 v174, 0x3f803f80
    v_mov_b32 v175, 0x3f803f80
    v_mov_b32 v176, 0x3f003f00
    v_mov_b32 v177, 0x3f003f00
    s_waitcnt vmcnt(8)
    v_mfma_f32_16x16x32_bf16 v[136:139], v[40:43], v[8:11], 0
    v_mfma_f32_16x16x32_bf16 v[140:143], v[56:59], v[8:11], 0
    v_mfma_f32_16x16x32_bf16 v[148:151], v[40:43], v[24:27], 0
    v_mfma_f32_16x16x32_bf16 v[152:155], v[56:59], v[24:27], 0
    v_mfma_f32_16x16x32_bf16 v[136:139], v[44:47], v[12:15], v[136:139]
    v_mfma_f32_16x16x32_bf16 v[140:143], v[60:63], v[12:15], v[140:143]
    v_mfma_f32_16x16x32_bf16 v[148:151], v[44:47], v[28:31], v[148:151]
    v_mfma_f32_16x16x32_bf16 v[152:155], v[60:63], v[28:31], v[152:155]
    v_mfma_f32_16x16x32_bf16 v[136:139], v[48:51], v[16:19], v[136:139]
    v_mfma_f32_16x16x32_bf16 v[140:143], v[64:67], v[16:19], v[140:143]
    v_mfma_f32_16x16x32_bf16 v[148:151], v[48:51], v[32:35], v[148:151]
    v_mfma_f32_16x16x32_bf16 v[152:155], v[64:67], v[32:35], v[152:155]
    v_mfma_f32_16x16x32_bf16 v[136:139], v[52:55], v[20:23], v[136:139]
    v_mfma_f32_16x16x32_bf16 v[140:143], v[68:71], v[20:23], v[140:143]
    v_mfma_f32_16x16x32_bf16 v[148:151], v[52:55], v[36:39], v[148:151]
    v_mfma_f32_16x16x32_bf16 v[152:155], v[68:71], v[36:39], v[152:155]
    v_cmp_le_i32 vcc, 0, v4
    s_nop 3
    v_cndmask_b32 v136, v6, v136, vcc
    v_cmp_le_i32 vcc, 1, v4
    s_nop 1
    v_cndmask_b32 v137, v6, v137, vcc
    v_cmp_le_i32 vcc, 2, v4
    s_nop 1
    v_cndmask_b32 v138, v6, v138, vcc
    v_cmp_le_i32 vcc, 3, v4
    s_nop 1
    v_cndmask_b32 v139, v6, v139, vcc
    v_cmp_le_i32 vcc, 4, v4
    s_nop 1
    v_cndmask_b32 v140, v6, v140, vcc
    v_cmp_le_i32 vcc, 5, v4
    s_nop 1
    v_cndmask_b32 v141, v6, v141, vcc
    v_cmp_le_i32 vcc, 6, v4
    s_nop 1
    v_cndmask_b32 v142, v6, v142, vcc
    v_cmp_le_i32 vcc, 7, v4
    s_nop 1
    v_cndmask_b32 v143, v6, v143, vcc
    v_cmp_le_i32 vcc, -4, v4
    s_nop 1
    v_cndmask_b32 v148, v6, v148, vcc
    v_cmp_le_i32 vcc, -3, v4
    s_nop 1
    v_cndmask_b32 v149, v6, v149, vcc
    v_cmp_le_i32 vcc, -2, v4
    s_nop 1
    v_cndmask_b32 v150, v6, v150, vcc
    v_cmp_le_i32 vcc, -1, v4
    s_nop 1
    v_cndmask_b32 v151, v6, v151, vcc
    v_cmp_le_i32 vcc, 0, v4
    s_nop 1
    v_cndmask_b32 v152, v6, v152, vcc
    v_cmp_le_i32 vcc, 1, v4
    s_nop 1
    v_cndmask_b32 v153, v6, v153, vcc
    v_cmp_le_i32 vcc, 2, v4
    s_nop 1
    v_cndmask_b32 v154, v6, v154, vcc
    v_cmp_le_i32 vcc, 3, v4
    s_nop 1
    v_cndmask_b32 v155, v6, v155, vcc
    s_nop 1
    v_and_b32 v198, 1, v0
    v_lshlrev_b32 v198, 2, v198
    v_add_u32 v198, 48, v198
    s_add_u32 s41, s16, s95
    s_add_u32 s41, s41, 1
    s_cmp_lt_u32 s16, 56
    s_cbranch_scc1 L_amk
    v_mov_b32 v198, 16384
    s_sub_u32 s41, s41, 1
    s_mov_b32 s44, 8
L_amk:
    s_sub_u32 s43, s41, s95
    s_sub_u32 s43, s43, 1
    s_mov_b32 s88, 65536
    s_mov_b32 s89, 125853696
cw16:
    buffer_load_dword v199, off, s[4:7], s89 sc1
    s_waitcnt vmcnt(0)
    v_readfirstlane_b32 s42, v199
    s_nop 0
    s_sub_u32 s42, s42, s95
    s_cmp_gt_u32 s42, 64
    s_cselect_b32 s42, 0, s42
    s_add_u32 s42, s42, 1
    s_cmp_ge_u32 s42, s43
    s_cbranch_scc1 cw16x
    s_sub_u32 s88, s88, 1
    s_cbranch_scc1 cw16x
    s_sub_u32 s42, s43, s42
    s_min_u32 s42, s42, 6
cw16s:
    s_sleep 24
    s_sub_u32 s42, s42, 1
    s_cmp_lg_u32 s42, 0
    s_cbranch_scc1 cw16s
    s_branch cw16
cw16x:
    s_mov_b32 s40, 4194304
L_aw2:
    buffer_load_dword v199, v198, s[4:7], s36 offen sc1
    s_sub_u32 s40, s40, 1
    s_cbranch_scc1 L_aw2_go
    s_waitcnt vmcnt(0)
    v_subrev_u32 v199, s41, v199
    v_cmp_lt_u32 vcc, 64, v199
    s_cbranch_vccz L_aw2_go
    s_sleep 1
    s_branch L_aw2
L_aw2_go:
at_ldm:
    s_lshl_b32 s20, s18, 12
    s_add_u32 s20, s20, 69206016
    buffer_load_dwordx4 v[72:75], v3, s[4:7], s20 offen offset:0 sc1
    buffer_load_dwordx4 v[76:79], v3, s[4:7], s20 offen offset:1024 sc1
    buffer_load_dwordx4 v[80:83], v3, s[4:7], s20 offen offset:2048 sc1
    buffer_load_dwordx4 v[84:87], v3, s[4:7], s20 offen offset:3072 sc1
    s_lshl_b32 s20, s18, 12
    s_add_u32 s20, s20, 77594624
    buffer_load_dwordx4 v[120:123], v2, s[4:7], s20 offen offset:0 sc1
    buffer_load_dwordx4 v[124:127], v2, s[4:7], s20 offen offset:1024 sc1
    buffer_load_dwordx4 v[128:131], v2, s[4:7], s20 offen offset:2048 sc1
    buffer_load_dwordx4 v[132:135], v2, s[4:7], s20 offen offset:3072 sc1
    s_cmp_lt_u32 s16, 56
    s_cbranch_scc1 at_ok
    s_waitcnt vmcnt(0)
    v_max_u32 v196, v72, v73
    v_max3_u32 v196, v196, v74, v75
    v_max3_u32 v196, v196, v76, v77
    v_max3_u32 v196, v196, v78, v79
    v_max3_u32 v196, v196, v80, v81
    v_max3_u32 v196, v196, v82, v83
    v_max3_u32 v196, v196, v84, v85
    v_max3_u32 v196, v196, v86, v87
    v_max3_u32 v196, v196, v120, v121
    v_max3_u32 v196, v196, v122, v123
    v_max3_u32 v196, v196, v124, v125
    v_max3_u32 v196, v196, v126, v127
    v_max3_u32 v196, v196, v128, v129
    v_max3_u32 v196, v196, v130, v131
    v_max3_u32 v196, v196, v132, v133
    v_max3_u32 v196, v196, v134, v135
    v_cmp_eq_u32 vcc, -1, v196
    s_cbranch_vccz at_ok
    s_sub_u32 s44, s44, 1
    s_cbranch_scc1 at_ok
    s_cmp_lg_u32 s44, 0
    s_cbranch_scc1 at_ldm
    s_add_u32 s41, s41, 1
    s_mov_b32 s40, 4194304
L_aw3:
    buffer_load_dword v199, v198, s[4:7], s36 offen sc1
    s_sub_u32 s40, s40, 1
    s_cbranch_scc1 L_aw3_go
    s_waitcnt vmcnt(0)
    v_subrev_u32 v199, s41, v199
    v_cmp_lt_u32 vcc, 64, v199
    s_cbranch_vccz L_aw3_go
    s_sleep 1
    s_branch L_aw3
L_aw3_go:
    s_branch at_ldm
at_ok:
    s_waitcnt vmcnt(4)
    v_mfma_f32_16x16x32_bf16 v[144:147], v[72:75], v[8:11], 0
    v_mfma_f32_16x16x32_bf16 v[156:159], v[72:75], v[24:27], 0
    v_mfma_f32_16x16x32_bf16 v[144:147], v[76:79], v[12:15], v[144:147]
    v_mfma_f32_16x16x32_bf16 v[156:159], v[76:79], v[28:31], v[156:159]
    v_mfma_f32_16x16x32_bf16 v[144:147], v[80:83], v[16:19], v[144:147]
    v_mfma_f32_16x16x32_bf16 v[156:159], v[80:83], v[32:35], v[156:159]
    v_mfma_f32_16x16x32_bf16 v[144:147], v[84:87], v[20:23], v[144:147]
    v_mfma_f32_16x16x32_bf16 v[156:159], v[84:87], v[36:39], v[156:159]
    v_max3_f32 v196, v136, v137, v138
    v_max3_f32 v197, v139, v140, v141
    v_max3_f32 v196, v196, v142, v143
    s_nop 3
    v_max3_f32 v197, v197, v144, v145
    v_max3_f32 v196, v196, v146, v147
    v_max_f32 v196, v196, v197
    v_mov_b32 v197, v196
    s_nop 1
    v_permlane32_swap_b32 v196, v197
    v_max_f32 v196, v196, v197
    v_mov_b32 v197, v196
    s_nop 1
    v_permlane16_swap_b32 v196, v197
    v_max_f32 v196, v196, v197
    v_mul_f32 v196, s22, v196
    v_sub_f32 v196, 0, v196
    v_fma_f32 v136, v136, s22, v196
    v_fma_f32 v137, v137, s22, v196
    v_fma_f32 v138, v138, s22, v196
    v_fma_f32 v139, v139, s22, v196
    v_fma_f32 v140, v140, s22, v196
    v_fma_f32 v141, v141, s22, v196
    v_fma_f32 v142, v142, s22, v196
    v_fma_f32 v143, v143, s22, v196
    v_fma_f32 v144, v144, s22, v196
    v_fma_f32 v145, v145, s22, v196
    v_fma_f32 v146, v146, s22, v196
    v_fma_f32 v147, v147, s22, v196
    v_exp_f32 v136, v136
    v_exp_f32 v137, v137
    v_exp_f32 v138, v138
    v_exp_f32 v139, v139
    v_exp_f32 v140, v140
    v_exp_f32 v141, v141
    v_exp_f32 v142, v142
    v_exp_f32 v143, v143
    v_exp_f32 v144, v144
    v_exp_f32 v145, v145
    v_exp_f32 v146, v146
    v_exp_f32 v147, v147
    v_cvt_pk_bf16_f32 v160, v136, v137
    v_cvt_pk_bf16_f32 v161, v138, v139
    v_cvt_pk_bf16_f32 v162, v140, v141
    v_cvt_pk_bf16_f32 v163, v142, v143
    v_cvt_pk_bf16_f32 v164, v144, v145
    v_cvt_pk_bf16_f32 v165, v146, v147
    v_max3_f32 v196, v148, v149, v150
    v_max3_f32 v197, v151, v152, v153
    v_max3_f32 v196, v196, v154, v155
    v_max3_f32 v197, v197, v156, v157
    v_max3_f32 v196, v196, v158, v159
    v_max_f32 v196, v196, v197
    v_mov_b32 v197, v196
    s_nop 1
    v_permlane32_swap_b32 v196, v197
    v_max_f32 v196, v196, v197
    v_mov_b32 v197, v196
    s_nop 1
    v_permlane16_swap_b32 v196, v197
    v_max_f32 v196, v196, v197
    v_mul_f32 v196, s22, v196
    v_sub_f32 v196, 0, v196
    v_fma_f32 v148, v148, s22, v196
    v_fma_f32 v149, v149, s22, v196
    v_fma_f32 v150, v150, s22, v196
    v_fma_f32 v151, v151, s22, v196
    v_fma_f32 v152, v152, s22, v196
    v_fma_f32 v153, v153, s22, v196
    v_fma_f32 v154, v154, s22, v196
    v_fma_f32 v155, v155, s22, v196
    v_fma_f32 v156, v156, s22, v196
    v_fma_f32 v157, v157, s22, v196
    v_fma_f32 v158, v158, s22, v196
    v_fma_f32 v159, v159, s22, v196
    v_exp_f32 v148, v148
    v_exp_f32 v149, v149
    v_exp_f32 v150, v150
    v_exp_f32 v151, v151
    v_exp_f32 v152, v152
    v_exp_f32 v153, v153
    v_exp_f32 v154, v154
    v_exp_f32 v155, v155
    v_exp_f32 v156, v156
    v_exp_f32 v157, v157
    v_exp_f32 v158, v158
    v_exp_f32 v159, v159
    v_cvt_pk_bf16_f32 v166, v148, v149
    v_cvt_pk_bf16_f32 v167, v150, v151
    v_cvt_pk_bf16_f32 v168, v152, v153
    v_cvt_pk_bf16_f32 v169, v154, v155
    v_cvt_pk_bf16_f32 v170, v156, v157
    v_cvt_pk_bf16_f32 v171, v158, v159
    v_mfma_f32_16x16x32_bf16 v[180:183], v[172:175], v[160:163], 0
    v_mfma_f32_16x16x32_bf16 v[184:187], v[172:175], v[166:169], 0
    s_nop 4
    v_mfma_f32_16x16x16_bf16 v[180:183], v[176:177], v[164:165], v[180:183]
    v_mfma_f32_16x16x16_bf16 v[184:187], v[176:177], v[170:171], v[184:187]
    s_nop 6
    v_rcp_f32 v180, v180
    v_rcp_f32 v184, v184
    s_waitcnt vmcnt(0)
    s_lshl_b32 s18, s16, 18
    s_lshl_b32 s19, s17, 12
    s_add_u32 s18, s18, s19
    s_add_u32 s18, s18, 50331648
    s_add_u32 s19, s18, 131072
    v_mfma_f32_16x16x32_bf16 v[8:11], v[88:91], v[160:163], 0
    v_mfma_f32_16x16x32_bf16 v[12:15], v[104:107], v[160:163], 0
    v_mfma_f32_16x16x32_bf16 v[16:19], v[88:91], v[166:169], 0
    v_mfma_f32_16x16x32_bf16 v[20:23], v[104:107], v[166:169], 0
    v_mfma_f32_16x16x32_bf16 v[24:27], v[92:95], v[160:163], 0
    v_mfma_f32_16x16x32_bf16 v[28:31], v[108:111], v[160:163], 0
    v_mfma_f32_16x16x32_bf16 v[32:35], v[92:95], v[166:169], 0
    v_mfma_f32_16x16x32_bf16 v[36:39], v[108:111], v[166:169], 0
    v_mfma_f32_16x16x32_bf16 v[40:43], v[96:99], v[160:163], 0
    v_mfma_f32_16x16x32_bf16 v[44:47], v[112:115], v[160:163], 0
    v_mfma_f32_16x16x32_bf16 v[48:51], v[96:99], v[166:169], 0
    v_mfma_f32_16x16x32_bf16 v[52:55], v[112:115], v[166:169], 0
    v_mfma_f32_16x16x32_bf16 v[56:59], v[100:103], v[160:163], 0
    v_mfma_f32_16x16x32_bf16 v[60:63], v[116:119], v[160:163], 0
    v_mfma_f32_16x16x32_bf16 v[64:67], v[100:103], v[166:169], 0
    v_mfma_f32_16x16x32_bf16 v[68:71], v[116:119], v[166:169], 0
    v_mfma_f32_16x16x16_bf16 v[8:11], v[120:121], v[164:165], v[8:11]
    v_mfma_f32_16x16x16_bf16 v[12:15], v[122:123], v[164:165], v[12:15]
    v_mfma_f32_16x16x16_bf16 v[16:19], v[120:121], v[170:171], v[16:19]
    v_mfma_f32_16x16x16_bf16 v[20:23], v[122:123], v[170:171], v[20:23]
    v_mfma_f32_16x16x16_bf16 v[24:27], v[124:125], v[164:165], v[24:27]
    v_mfma_f32_16x16x16_bf16 v[28:31], v[126:127], v[164:165], v[28:31]
    v_mfma_f32_16x16x16_bf16 v[32:35], v[124:125], v[170:171], v[32:35]
    v_mfma_f32_16x16x16_bf16 v[36:39], v[126:127], v[170:171], v[36:39]
    v_mfma_f32_16x16x16_bf16 v[40:43], v[128:129], v[164:165], v[40:43]
    v_mfma_f32_16x16x16_bf16 v[44:47], v[130:131], v[164:165], v[44:47]
    v_mfma_f32_16x16x16_bf16 v[48:51], v[128:129], v[170:171], v[48:51]
    v_mfma_f32_16x16x16_bf16 v[52:55], v[130:131], v[170:171], v[52:55]
    v_mfma_f32_16x16x16_bf16 v[56:59], v[132:133], v[164:165], v[56:59]
    v_mfma_f32_16x16x16_bf16 v[60:63], v[134:135], v[164:165], v[60:63]
    v_mfma_f32_16x16x16_bf16 v[64:67], v[132:133], v[170:171], v[64:67]
    v_mfma_f32_16x16x16_bf16 v[68:71], v[134:135], v[170:171], v[68:71]
    v_mul_f32 v8, v8, v180
    v_mul_f32 v12, v12, v180
    v_mul_f32 v9, v9, v180
    v_mul_f32 v13, v13, v180
    v_mul_f32 v10, v10, v180
    v_mul_f32 v14, v14, v180
    v_mul_f32 v11, v11, v180
    v_mul_f32 v15, v15, v180
    v_cvt_pk_bf16_f32 v8, v8, v9
    v_cvt_pk_bf16_f32 v9, v10, v11
    v_cvt_pk_bf16_f32 v10, v12, v13
    v_cvt_pk_bf16_f32 v11, v14, v15
    buffer_store_dwordx4 v[8:11], v1, s[4:7], s18 offen offset:0 sc1
    v_mul_f32 v16, v16, v184
    v_mul_f32 v20, v20, v184
    v_mul_f32 v17, v17, v184
    v_mul_f32 v21, v21, v184
    v_mul_f32 v18, v18, v184
    v_mul_f32 v22, v22, v184
    v_mul_f32 v19, v19, v184
    v_mul_f32 v23, v23, v184
    v_cvt_pk_bf16_f32 v16, v16, v17
    v_cvt_pk_bf16_f32 v17, v18, v19
    v_cvt_pk_bf16_f32 v18, v20, v21
    v_cvt_pk_bf16_f32 v19, v22, v23
    buffer_store_dwordx4 v[16:19], v1, s[4:7], s19 offen offset:0 sc1
    v_mul_f32 v24, v24, v180
    v_mul_f32 v28, v28, v180
    v_mul_f32 v25, v25, v180
    v_mul_f32 v29, v29, v180
    v_mul_f32 v26, v26, v180
    v_mul_f32 v30, v30, v180
    v_mul_f32 v27, v27, v180
    v_mul_f32 v31, v31, v180
    v_cvt_pk_bf16_f32 v24, v24, v25
    v_cvt_pk_bf16_f32 v25, v26, v27
    v_cvt_pk_bf16_f32 v26, v28, v29
    v_cvt_pk_bf16_f32 v27, v30, v31
    buffer_store_dwordx4 v[24:27], v1, s[4:7], s18 offen offset:1024 sc1
    v_mul_f32 v32, v32, v184
    v_mul_f32 v36, v36, v184
    v_mul_f32 v33, v33, v184
    v_mul_f32 v37, v37, v184
    v_mul_f32 v34, v34, v184
    v_mul_f32 v38, v38, v184
    v_mul_f32 v35, v35, v184
    v_mul_f32 v39, v39, v184
    v_cvt_pk_bf16_f32 v32, v32, v33
    v_cvt_pk_bf16_f32 v33, v34, v35
    v_cvt_pk_bf16_f32 v34, v36, v37
    v_cvt_pk_bf16_f32 v35, v38, v39
    buffer_store_dwordx4 v[32:35], v1, s[4:7], s19 offen offset:1024 sc1
    v_mul_f32 v40, v40, v180
    v_mul_f32 v44, v44, v180
    v_mul_f32 v41, v41, v180
    v_mul_f32 v45, v45, v180
    v_mul_f32 v42, v42, v180
    v_mul_f32 v46, v46, v180
    v_mul_f32 v43, v43, v180
    v_mul_f32 v47, v47, v180
    v_cvt_pk_bf16_f32 v40, v40, v41
    v_cvt_pk_bf16_f32 v41, v42, v43
    v_cvt_pk_bf16_f32 v42, v44, v45
    v_cvt_pk_bf16_f32 v43, v46, v47
    buffer_store_dwordx4 v[40:43], v1, s[4:7], s18 offen offset:2048 sc1
    v_mul_f32 v48, v48, v184
    v_mul_f32 v52, v52, v184
    v_mul_f32 v49, v49, v184
    v_mul_f32 v53, v53, v184
    v_mul_f32 v50, v50, v184
    v_mul_f32 v54, v54, v184
    v_mul_f32 v51, v51, v184
    v_mul_f32 v55, v55, v184
    v_cvt_pk_bf16_f32 v48, v48, v49
    v_cvt_pk_bf16_f32 v49, v50, v51
    v_cvt_pk_bf16_f32 v50, v52, v53
    v_cvt_pk_bf16_f32 v51, v54, v55
    buffer_store_dwordx4 v[48:51], v1, s[4:7], s19 offen offset:2048 sc1
    v_mul_f32 v56, v56, v180
    v_mul_f32 v60, v60, v180
    v_mul_f32 v57, v57, v180
    v_mul_f32 v61, v61, v180
    v_mul_f32 v58, v58, v180
    v_mul_f32 v62, v62, v180
    v_mul_f32 v59, v59, v180
    v_mul_f32 v63, v63, v180
    v_cvt_pk_bf16_f32 v56, v56, v57
    v_cvt_pk_bf16_f32 v57, v58, v59
    v_cvt_pk_bf16_f32 v58, v60, v61
    v_cvt_pk_bf16_f32 v59, v62, v63
    buffer_store_dwordx4 v[56:59], v1, s[4:7], s18 offen offset:3072 sc1
    v_mul_f32 v64, v64, v184
    v_mul_f32 v68, v68, v184
    v_mul_f32 v65, v65, v184
    v_mul_f32 v69, v69, v184
    v_mul_f32 v66, v66, v184
    v_mul_f32 v70, v70, v184
    v_mul_f32 v67, v67, v184
    v_mul_f32 v71, v71, v184
    v_cvt_pk_bf16_f32 v64, v64, v65
    v_cvt_pk_bf16_f32 v65, v66, v67
    v_cvt_pk_bf16_f32 v66, v68, v69
    v_cvt_pk_bf16_f32 v67, v70, v71
    buffer_store_dwordx4 v[64:67], v1, s[4:7], s19 offen offset:3072 sc1
    s_lshr_b32 s40, s34, 1
    s_lshl_b32 s40, s40, 7
    s_and_b32 s41, s34, 1
    s_lshl_b32 s41, s41, 2
    s_add_u32 s40, s40, s41
    s_add_u32 s40, s40, 125894656
    s_cmp_lt_u32 s16, 62
    s_cbranch_scc1 L_noef
    s_lshr_b32 s42, s34, 1
    s_mul_i32 s42, s42, 4096
    s_add_u32 s41, s41, s42
    s_add_u32 s41, s41, 124944384
    s_barrier
    s_cmp_lg_u32 s32, 0
    s_cbranch_scc1 L_noef
    v_mov_b32 v250, s95
    v_lshlrev_b32 v251, 7, v0
    s_mov_b64 exec, 262143
    buffer_store_dword v250, v251, s[4:7], s41 offen sc1
    s_mov_b64 exec, -1
L_noef:
    s_waitcnt vmcnt(0)
    s_barrier
    v_mov_b32 v250, s95
    v_cmp_eq_u32 vcc, 0, v0
    s_nop 0
    s_and_saveexec_b64 s[38:39], vcc
    s_cbranch_execz fs17
    buffer_store_dword v250, off, s[4:7], s40 sc1
fs17:
    s_mov_b64 exec, -1
    s_branch L_att_next
L_op_start:
    s_lshl_b32 s35, s33, 2
    s_add_u32 s35, s35, 136
    s_lshr_b32 s89, s33, 2
    s_lshl_b32 s89, s89, 7
    s_add_u32 s89, s89, 125841408
    v_mbcnt_lo_u32_b32 v2, -1, 0
    v_mbcnt_hi_u32_b32 v2, -1, v2
    v_min_u32 v2, 31, v2
    v_lshlrev_b32 v2, 2, v2
    s_mov_b32 s88, 4194304
fw18:
    buffer_load_dword v3, v2, s[4:7], s89 offen offset:0 sc1
    s_sub_u32 s88, s88, 1
    s_cbranch_scc1 fw18x
    s_waitcnt vmcnt(0)
    v_cmp_ne_u32 vcc, s95, v3
    s_cbranch_vccz fw18x
    s_sleep 4
    s_branch fw18
fw18x:
    v_and_b32 v1, 63, v0
    v_lshlrev_b32 v1, 4, v1
    s_lshl_b32 s18, s33, 18
    s_lshl_b32 s19, s32, 16
    s_add_u32 s18, s18, s19
    s_add_u32 s18, s18, 130023424
    buffer_load_dwordx4 a[0:3], v1, s[4:7], s18 offen offset:0 sc1
    buffer_load_dwordx4 a[4:7], v1, s[4:7], s18 offen offset:1024 sc1
    buffer_load_dwordx4 a[8:11], v1, s[4:7], s18 offen offset:2048 sc1
    buffer_load_dwordx4 a[12:15], v1, s[4:7], s18 offen offset:3072 sc1
    s_add_u32 s18, s18, 4096
    buffer_load_dwordx4 a[16:19], v1, s[4:7], s18 offen offset:0 sc1
    buffer_load_dwordx4 a[20:23], v1, s[4:7], s18 offen offset:1024 sc1
    buffer_load_dwordx4 a[24:27], v1, s[4:7], s18 offen offset:2048 sc1
    buffer_load_dwordx4 a[28:31], v1, s[4:7], s18 offen offset:3072 sc1
    s_add_u32 s18, s18, 4096
    buffer_load_dwordx4 a[32:35], v1, s[4:7], s18 offen offset:0 sc1
    buffer_load_dwordx4 a[36:39], v1, s[4:7], s18 offen offset:1024 sc1
    buffer_load_dwordx4 a[40:43], v1, s[4:7], s18 offen offset:2048 sc1
    buffer_load_dwordx4 a[44:47], v1, s[4:7], s18 offen offset:3072 sc1
    s_add_u32 s18, s18, 4096
    buffer_load_dwordx4 a[48:51], v1, s[4:7], s18 offen offset:0 sc1
    buffer_load_dwordx4 a[52:55], v1, s[4:7], s18 offen offset:1024 sc1
    buffer_load_dwordx4 a[56:59], v1, s[4:7], s18 offen offset:2048 sc1
    buffer_load_dwordx4 a[60:63], v1, s[4:7], s18 offen offset:3072 sc1
    s_add_u32 s18, s18, 4096
    buffer_load_dwordx4 a[64:67], v1, s[4:7], s18 offen offset:0 sc1
    buffer_load_dwordx4 a[68:71], v1, s[4:7], s18 offen offset:1024 sc1
    buffer_load_dwordx4 a[72:75], v1, s[4:7], s18 offen offset:2048 sc1
    buffer_load_dwordx4 a[76:79], v1, s[4:7], s18 offen offset:3072 sc1
    s_add_u32 s18, s18, 4096
    buffer_load_dwordx4 a[80:83], v1, s[4:7], s18 offen offset:0 sc1
    buffer_load_dwordx4 a[84:87], v1, s[4:7], s18 offen offset:1024 sc1
    buffer_load_dwordx4 a[88:91], v1, s[4:7], s18 offen offset:2048 sc1
    buffer_load_dwordx4 a[92:95], v1, s[4:7], s18 offen offset:3072 sc1
    s_add_u32 s18, s18, 4096
    buffer_load_dwordx4 a[96:99], v1, s[4:7], s18 offen offset:0 sc1
    buffer_load_dwordx4 a[100:103], v1, s[4:7], s18 offen offset:1024 sc1
    buffer_load_dwordx4 a[104:107], v1, s[4:7], s18 offen offset:2048 sc1
    buffer_load_dwordx4 a[108:111], v1, s[4:7], s18 offen offset:3072 sc1
    s_add_u32 s18, s18, 4096
    buffer_load_dwordx4 a[112:115], v1, s[4:7], s18 offen offset:0 sc1
    buffer_load_dwordx4 a[116:119], v1, s[4:7], s18 offen offset:1024 sc1
    buffer_load_dwordx4 a[120:123], v1, s[4:7], s18 offen offset:2048 sc1
    buffer_load_dwordx4 a[124:127], v1, s[4:7], s18 offen offset:3072 sc1
    s_add_u32 s18, s18, 4096
    buffer_load_dwordx4 a[128:131], v1, s[4:7], s18 offen offset:0 sc1
    buffer_load_dwordx4 a[132:135], v1, s[4:7], s18 offen offset:1024 sc1
    buffer_load_dwordx4 a[136:139], v1, s[4:7], s18 offen offset:2048 sc1
    buffer_load_dwordx4 a[140:143], v1, s[4:7], s18 offen offset:3072 sc1
    s_add_u32 s18, s18, 4096
    buffer_load_dwordx4 a[144:147], v1, s[4:7], s18 offen offset:0 sc1
    buffer_load_dwordx4 a[148:151], v1, s[4:7], s18 offen offset:1024 sc1
    buffer_load_dwordx4 a[152:155], v1, s[4:7], s18 offen offset:2048 sc1
    buffer_load_dwordx4 a[156:159], v1, s[4:7], s18 offen offset:3072 sc1
    s_add_u32 s18, s18, 4096
    buffer_load_dwordx4 a[160:163], v1, s[4:7], s18 offen offset:0 sc1
    s_waitcnt vmcnt(20)
    buffer_load_dwordx4 a[164:167], v1, s[4:7], s18 offen offset:1024 sc1
    buffer_load_dwordx4 a[168:171], v1, s[4:7], s18 offen offset:2048 sc1
    buffer_load_dwordx4 a[172:175], v1, s[4:7], s18 offen offset:3072 sc1
    s_add_u32 s18, s18, 4096
    buffer_load_dwordx4 a[176:179], v1, s[4:7], s18 offen offset:0 sc1
    buffer_load_dwordx4 a[180:183], v1, s[4:7], s18 offen offset:1024 sc1
    buffer_load_dwordx4 a[184:187], v1, s[4:7], s18 offen offset:2048 sc1
    buffer_load_dwordx4 a[188:191], v1, s[4:7], s18 offen offset:3072 sc1
    s_add_u32 s18, s18, 4096
    buffer_load_dwordx4 a[192:195], v1, s[4:7], s18 offen offset:0 sc1
    buffer_load_dwordx4 a[196:199], v1, s[4:7], s18 offen offset:1024 sc1
    buffer_load_dwordx4 a[200:203], v1, s[4:7], s18 offen offset:2048 sc1
    buffer_load_dwordx4 a[204:207], v1, s[4:7], s18 offen offset:3072 sc1
    s_add_u32 s18, s18, 4096
    buffer_load_dwordx4 a[208:211], v1, s[4:7], s18 offen offset:0 sc1
    buffer_load_dwordx4 a[212:215], v1, s[4:7], s18 offen offset:1024 sc1
    buffer_load_dwordx4 a[216:219], v1, s[4:7], s18 offen offset:2048 sc1
    buffer_load_dwordx4 a[220:223], v1, s[4:7], s18 offen offset:3072 sc1
    s_add_u32 s18, s18, 4096
    buffer_load_dwordx4 a[224:227], v1, s[4:7], s18 offen offset:0 sc1
    buffer_load_dwordx4 a[228:231], v1, s[4:7], s18 offen offset:1024 sc1
    buffer_load_dwordx4 a[232:235], v1, s[4:7], s18 offen offset:2048 sc1
    buffer_load_dwordx4 a[236:239], v1, s[4:7], s18 offen offset:3072 sc1
    s_add_u32 s18, s18, 4096
    buffer_load_dwordx4 a[240:243], v1, s[4:7], s18 offen offset:0 sc1
    buffer_load_dwordx4 a[244:247], v1, s[4:7], s18 offen offset:1024 sc1
    buffer_load_dwordx4 a[248:251], v1, s[4:7], s18 offen offset:2048 sc1
    buffer_load_dwordx4 a[252:255], v1, s[4:7], s18 offen offset:3072 sc1
    s_waitcnt vmcnt(0)
    s_mov_b32 s44, 0
    s_mov_b32 s37, s35
    v_mov_b32 v250, 1
    v_mov_b32 v251, 163832
    v_cmp_eq_u32 vcc, 0, v0
    s_nop 0
    s_and_saveexec_b64 s[38:39], vcc
    s_cbranch_execz tk19
    buffer_atomic_add v250, off, s[84:87], s37 sc0
    s_waitcnt vmcnt(0)
    ds_write_b32 v251, v250
    s_waitcnt lgkmcnt(0)
tk19:
    s_mov_b64 exec, -1
    s_barrier
    ds_read_b32 v252, v251
    s_waitcnt lgkmcnt(0)
    v_readfirstlane_b32 s16, v252
    s_barrier
    s_nop 3
    s_cmp_ge_u32 s16, 72
    s_cbranch_scc1 L_op_nextcb
L_op_seg:
    s_min_u32 s43, s16, 56
    s_add_u32 s16, s16, s43
    s_lshr_b32 s43, s16, 1
    s_add_u32 s43, s43, 2
    s_min_u32 s43, s43, 63
    s_lshl_b32 s94, s33, 7
    s_add_u32 s94, s94, s16
    s_mov_b32 s88, 65536
    s_mov_b32 s89, 125853696
cw20:
    buffer_load_dword v3, off, s[4:7], s89 sc1
    s_waitcnt vmcnt(0)
    v_readfirstlane_b32 s42, v3
    s_nop 0
    s_sub_u32 s42, s42, s95
    s_cmp_gt_u32 s42, 64
    s_cselect_b32 s42, 0, s42
    s_add_u32 s42, s42, 1
    s_cmp_ge_u32 s42, s43
    s_cbranch_scc1 cw20x
    s_sub_u32 s88, s88, 1
    s_cbranch_scc1 cw20x
    s_sub_u32 s42, s43, s42
    s_min_u32 s42, s42, 6
cw20s:
    s_sleep 24
    s_sub_u32 s42, s42, 1
    s_cmp_lg_u32 s42, 0
    s_cbranch_scc1 cw20s
    s_branch cw20
cw20x:
    s_lshr_b32 s89, s16, 1
    s_lshl_b32 s89, s89, 2
    s_add_u32 s89, s89, s32
    s_lshl_b32 s89, s89, 7
    s_add_u32 s89, s89, 125894656
    s_sub_u32 s47, s89, 125894656
    s_lshl_b32 s47, s47, 5
    s_lshl_b32 s46, s33, 7
    s_add_u32 s47, s47, s46
    s_add_u32 s47, s47, 124944384
    s_cmp_ge_u32 s16, 124
    s_cselect_b32 s46, 8, 0
    s_cselect_b32 s47, s47, s89
    v_mbcnt_lo_u32_b32 v2, -1, 0
    v_mbcnt_hi_u32_b32 v2, -1, v2
    v_min_u32 v2, 1, v2
    v_lshlrev_b32 v2, 2, v2
    s_mov_b32 s88, 4194304
fw21:
    buffer_load_dword v3, v2, s[4:7], s47 offen offset:0 sc1
    s_sub_u32 s88, s88, 1
    s_cbranch_scc1 fw21x
    s_waitcnt vmcnt(0)
    v_cmp_ne_u32 vcc, s95, v3
    s_cbranch_vccz fw21x
    s_sleep 1
    s_branch fw21
fw21x:
    v_mov_b32 v250, 1
    v_lshrrev_b32 v252, 2, v1
    v_min_u32 v252, 68, v252
    s_cmp_lg_u32 s32, 0
    s_cbranch_scc1 L_op_na
    s_mov_b64 exec, 1
    buffer_atomic_add v250, off, s[84:87], s35 sc0
    s_mov_b64 exec, -1
    s_cmp_lg_u32 s44, 0
    s_cbranch_scc1 L_op_na
    buffer_load_dword v253, v252, s[84:87], 0 offen offset:136 sc1
L_op_na:
    s_cmp_ge_u32 s16, 112
    s_cbranch_scc1 L_op_one
o2_again:
    s_lshl_b32 s18, s16, 17
    s_lshl_b32 s19, s32, 15
    s_add_u32 s18, s18, s19
    s_add_u32 s18, s18, 50331648
    buffer_load_dwordx4 v[24:27], v1, s[4:7], s18 offen offset:0 sc1
    buffer_load_dwordx4 v[28:31], v1, s[4:7], s18 offen offset:1024 sc1
    buffer_load_dwordx4 v[32:35], v1, s[4:7], s18 offen offset:2048 sc1
    buffer_load_dwordx4 v[36:39], v1, s[4:7], s18 offen offset:3072 sc1
    s_add_u32 s18, s18, 4096
    buffer_load_dwordx4 v[40:43], v1, s[4:7], s18 offen offset:0 sc1
    buffer_load_dwordx4 v[44:47], v1, s[4:7], s18 offen offset:1024 sc1
    buffer_load_dwordx4 v[48:51], v1, s[4:7], s18 offen offset:2048 sc1
    buffer_load_dwordx4 v[52:55], v1, s[4:7], s18 offen offset:3072 sc1
    s_add_u32 s18, s18, 4096
    buffer_load_dwordx4 v[56:59], v1, s[4:7], s18 offen offset:0 sc1
    buffer_load_dwordx4 v[60:63], v1, s[4:7], s18 offen offset:1024 sc1
    buffer_load_dwordx4 v[64:67], v1, s[4:7], s18 offen offset:2048 sc1
    buffer_load_dwordx4 v[68:71], v1, s[4:7], s18 offen offset:3072 sc1
    s_add_u32 s18, s18, 4096
    buffer_load_dwordx4 v[72:75], v1, s[4:7], s18 offen offset:0 sc1
    buffer_load_dwordx4 v[76:79], v1, s[4:7], s18 offen offset:1024 sc1
    buffer_load_dwordx4 v[80:83], v1, s[4:7], s18 offen offset:2048 sc1
    buffer_load_dwordx4 v[84:87], v1, s[4:7], s18 offen offset:3072 sc1
    s_add_u32 s18, s18, 4096
    buffer_load_dwordx4 v[88:91], v1, s[4:7], s18 offen offset:0 sc1
    buffer_load_dwordx4 v[92:95], v1, s[4:7], s18 offen offset:1024 sc1
    buffer_load_dwordx4 v[96:99], v1, s[4:7], s18 offen offset:2048 sc1
    buffer_load_dwordx4 v[100:103], v1, s[4:7], s18 offen offset:3072 sc1
    s_add_u32 s18, s18, 4096
    buffer_load_dwordx4 v[104:107], v1, s[4:7], s18 offen offset:0 sc1
    buffer_load_dwordx4 v[108:111], v1, s[4:7], s18 offen offset:1024 sc1
    buffer_load_dwordx4 v[112:115], v1, s[4:7], s18 offen offset:2048 sc1
    buffer_load_dwordx4 v[116:119], v1, s[4:7], s18 offen offset:3072 sc1
    s_add_u32 s18, s18, 4096
    buffer_load_dwordx4 v[120:123], v1, s[4:7], s18 offen offset:0 sc1
    buffer_load_dwordx4 v[124:127], v1, s[4:7], s18 offen offset:1024 sc1
    buffer_load_dwordx4 v[128:131], v1, s[4:7], s18 offen offset:2048 sc1
    buffer_load_dwordx4 v[132:135], v1, s[4:7], s18 offen offset:3072 sc1
    s_add_u32 s18, s18, 4096
    buffer_load_dwordx4 v[136:139], v1, s[4:7], s18 offen offset:0 sc1
    buffer_load_dwordx4 v[140:143], v1, s[4:7], s18 offen offset:1024 sc1
    buffer_load_dwordx4 v[144:147], v1, s[4:7], s18 offen offset:2048 sc1
    buffer_load_dwordx4 v[148:151], v1, s[4:7], s18 offen offset:3072 sc1
    s_add_u32 s18, s18, 102400
    buffer_load_dwordx4 v[152:155], v1, s[4:7], s18 offen offset:0 sc1
    buffer_load_dwordx4 v[156:159], v1, s[4:7], s18 offen offset:1024 sc1
    buffer_load_dwordx4 v[160:163], v1, s[4:7], s18 offen offset:2048 sc1
    buffer_load_dwordx4 v[164:167], v1, s[4:7], s18 offen offset:3072 sc1
    s_add_u32 s18, s18, 4096
    buffer_load_dwordx4 v[168:171], v1, s[4:7], s18 offen offset:0 sc1
    buffer_load_dwordx4 v[172:175], v1, s[4:7], s18 offen offset:1024 sc1
    buffer_load_dwordx4 v[176:179], v1, s[4:7], s18 offen offset:2048 sc1
    buffer_load_dwordx4 v[180:183], v1, s[4:7], s18 offen offset:3072 sc1
    s_add_u32 s18, s18, 4096
    buffer_load_dwordx4 v[184:187], v1, s[4:7], s18 offen offset:0 sc1
    buffer_load_dwordx4 v[188:191], v1, s[4:7], s18 offen offset:1024 sc1
    buffer_load_dwordx4 v[192:195], v1, s[4:7], s18 offen offset:2048 sc1
    buffer_load_dwordx4 v[196:199], v1, s[4:7], s18 offen offset:3072 sc1
    s_add_u32 s18, s18, 4096
    buffer_load_dwordx4 v[200:203], v1, s[4:7], s18 offen offset:0 sc1
    buffer_load_dwordx4 v[204:207], v1, s[4:7], s18 offen offset:1024 sc1
    buffer_load_dwordx4 v[208:211], v1, s[4:7], s18 offen offset:2048 sc1
    buffer_load_dwordx4 v[212:215], v1, s[4:7], s18 offen offset:3072 sc1
    s_add_u32 s18, s18, 4096
    buffer_load_dwordx4 v[216:219], v1, s[4:7], s18 offen offset:0 sc1
    buffer_load_dwordx4 v[220:223], v1, s[4:7], s18 offen offset:1024 sc1
    buffer_load_dwordx4 v[224:227], v1, s[4:7], s18 offen offset:2048 sc1
    buffer_load_dwordx4 v[228:231], v1, s[4:7], s18 offen offset:3072 sc1
    s_add_u32 s18, s18, 4096
    buffer_load_dwordx4 v[232:235], v1, s[4:7], s18 offen offset:0 sc1
    buffer_load_dwordx4 v[236:239], v1, s[4:7], s18 offen offset:1024 sc1
    buffer_load_dwordx4 v[240:243], v1, s[4:7], s18 offen offset:2048 sc1
    buffer_load_dwordx4 v[244:247], v1, s[4:7], s18 offen offset:3072 sc1
    v_lshlrev_b32 v2, 4, v0
    v_and_b32 v3, 3072, v2
    v_lshl_add_u32 v2, v3, 1, v1
    s_waitcnt vmcnt(55)
    v_mfma_f32_16x16x32_bf16 v[8:11], a[0:3], v[24:27], 0
    v_mfma_f32_16x16x32_bf16 v[12:15], a[4:7], v[24:27], 0
    s_add_u32 s18, s18, 4096
    buffer_load_dwordx4 v[24:27], v1, s[4:7], s18 offen offset:0 sc1
    s_waitcnt vmcnt(55)
    v_mfma_f32_16x16x32_bf16 v[8:11], a[8:11], v[28:31], v[8:11]
    v_mfma_f32_16x16x32_bf16 v[12:15], a[12:15], v[28:31], v[12:15]
    buffer_load_dwordx4 v[28:31], v1, s[4:7], s18 offen offset:1024 sc1
    s_waitcnt vmcnt(55)
    v_mfma_f32_16x16x32_bf16 v[8:11], a[16:19], v[32:35], v[8:11]
    v_mfma_f32_16x16x32_bf16 v[12:15], a[20:23], v[32:35], v[12:15]
    buffer_load_dwordx4 v[32:35], v1, s[4:7], s18 offen offset:2048 sc1
    s_waitcnt vmcnt(55)
    v_mfma_f32_16x16x32_bf16 v[8:11], a[24:27], v[36:39], v[8:11]
    v_mfma_f32_16x16x32_bf16 v[12:15], a[28:31], v[36:39], v[12:15]
    buffer_load_dwordx4 v[36:39], v1, s[4:7], s18 offen offset:3072 sc1
    s_waitcnt vmcnt(55)
    v_mfma_f32_16x16x32_bf16 v[8:11], a[32:35], v[40:43], v[8:11]
    v_mfma_f32_16x16x32_bf16 v[12:15], a[36:39], v[40:43], v[12:15]
    s_add_u32 s18, s18, 4096
    buffer_load_dwordx4 v[40:43], v1, s[4:7], s18 offen offset:0 sc1
    s_waitcnt vmcnt(55)
    v_mfma_f32_16x16x32_bf16 v[8:11], a[40:43], v[44:47], v[8:11]
    v_mfma_f32_16x16x32_bf16 v[12:15], a[44:47], v[44:47], v[12:15]
    buffer_load_dwordx4 v[44:47], v1, s[4:7], s18 offen offset:1024 sc1
    s_waitcnt vmcnt(55)
    v_mfma_f32_16x16x32_bf16 v[8:11], a[48:51], v[48:51], v[8:11]
    v_mfma_f32_16x16x32_bf16 v[12:15], a[52:55], v[48:51], v[12:15]
    buffer_load_dwordx4 v[48:51], v1, s[4:7], s18 offen offset:2048 sc1
    s_waitcnt vmcnt(55)
    v_mfma_f32_16x16x32_bf16 v[8:11], a[56:59], v[52:55], v[8:11]
    v_mfma_f32_16x16x32_bf16 v[12:15], a[60:63], v[52:55], v[12:15]
    buffer_load_dwordx4 v[52:55], v1, s[4:7], s18 offen offset:3072 sc1
    s_waitcnt vmcnt(55)
    v_mfma_f32_16x16x32_bf16 v[8:11], a[64:67], v[56:59], v[8:11]
    v_mfma_f32_16x16x32_bf16 v[12:15], a[68:71], v[56:59], v[12:15]
    s_waitcnt vmcnt(54)
    v_mfma_f32_16x16x32_bf16 v[8:11], a[72:75], v[60:63], v[8:11]
    v_mfma_f32_16x16x32_bf16 v[12:15], a[76:79], v[60:63], v[12:15]
    s_waitcnt vmcnt(53)
    v_mfma_f32_16x16x32_bf16 v[8:11], a[80:83], v[64:67], v[8:11]
    v_mfma_f32_16x16x32_bf16 v[12:15], a[84:87], v[64:67], v[12:15]
    s_waitcnt vmcnt(52)
    v_mfma_f32_16x16x32_bf16 v[8:11], a[88:91], v[68:71], v[8:11]
    v_mfma_f32_16x16x32_bf16 v[12:15], a[92:95], v[68:71], v[12:15]
    s_waitcnt vmcnt(51)
    v_mfma_f32_16x16x32_bf16 v[8:11], a[96:99], v[72:75], v[8:11]
    v_mfma_f32_16x16x32_bf16 v[12:15], a[100:103], v[72:75], v[12:15]
    s_waitcnt vmcnt(50)
    v_mfma_f32_16x16x32_bf16 v[8:11], a[104:107], v[76:79], v[8:11]
    v_mfma_f32_16x16x32_bf16 v[12:15], a[108:111], v[76:79], v[12:15]
    s_waitcnt vmcnt(49)
    v_mfma_f32_16x16x32_bf16 v[8:11], a[112:115], v[80:83], v[8:11]
    v_mfma_f32_16x16x32_bf16 v[12:15], a[116:119], v[80:83], v[12:15]
    s_waitcnt vmcnt(48)
    v_mfma_f32_16x16x32_bf16 v[8:11], a[120:123], v[84:87], v[8:11]
    v_mfma_f32_16x16x32_bf16 v[12:15], a[124:127], v[84:87], v[12:15]
    s_waitcnt vmcnt(47)
    v_mfma_f32_16x16x32_bf16 v[8:11], a[128:131], v[88:91], v[8:11]
    v_mfma_f32_16x16x32_bf16 v[12:15], a[132:135], v[88:91], v[12:15]
    s_waitcnt vmcnt(46)
    v_mfma_f32_16x16x32_bf16 v[8:11], a[136:139], v[92:95], v[8:11]
    v_mfma_f32_16x16x32_bf16 v[12:15], a[140:143], v[92:95], v[12:15]
    s_waitcnt vmcnt(45)
    v_mfma_f32_16x16x32_bf16 v[8:11], a[144:147], v[96:99], v[8:11]
    v_mfma_f32_16x16x32_bf16 v[12:15], a[148:151], v[96:99], v[12:15]
    s_waitcnt vmcnt(44)
    v_mfma_f32_16x16x32_bf16 v[8:11], a[152:155], v[100:103], v[8:11]
    v_mfma_f32_16x16x32_bf16 v[12:15], a[156:159], v[100:103], v[12:15]
    s_waitcnt vmcnt(43)
    v_mfma_f32_16x16x32_bf16 v[8:11], a[160:163], v[104:107], v[8:11]
    v_mfma_f32_16x16x32_bf16 v[12:15], a[164:167], v[104:107], v[12:15]
    s_waitcnt vmcnt(42)
    v_mfma_f32_16x16x32_bf16 v[8:11], a[168:171], v[108:111], v[8:11]
    v_mfma_f32_16x16x32_bf16 v[12:15], a[172:175], v[108:111], v[12:15]
    s_waitcnt vmcnt(41)
    v_mfma_f32_16x16x32_bf16 v[8:11], a[176:179], v[112:115], v[8:11]
    v_mfma_f32_16x16x32_bf16 v[12:15], a[180:183], v[112:115], v[12:15]
    s_waitcnt vmcnt(40)
    v_mfma_f32_16x16x32_bf16 v[8:11], a[184:187], v[116:119], v[8:11]
    v_mfma_f32_16x16x32_bf16 v[12:15], a[188:191], v[116:119], v[12:15]
    s_waitcnt vmcnt(39)
    v_mfma_f32_16x16x32_bf16 v[8:11], a[192:195], v[120:123], v[8:11]
    v_mfma_f32_16x16x32_bf16 v[12:15], a[196:199], v[120:123], v[12:15]
    s_waitcnt vmcnt(38)
    v_mfma_f32_16x16x32_bf16 v[8:11], a[200:203], v[124:127], v[8:11]
    v_mfma_f32_16x16x32_bf16 v[12:15], a[204:207], v[124:127], v[12:15]
    s_waitcnt vmcnt(37)
    v_mfma_f32_16x16x32_bf16 v[8:11], a[208:211], v[128:131], v[8:11]
    v_mfma_f32_16x16x32_bf16 v[12:15], a[212:215], v[128:131], v[12:15]
    s_waitcnt vmcnt(36)
    v_mfma_f32_16x16x32_bf16 v[8:11], a[216:219], v[132:135], v[8:11]
    v_mfma_f32_16x16x32_bf16 v[12:15], a[220:223], v[132:135], v[12:15]
    s_waitcnt vmcnt(35)
    v_mfma_f32_16x16x32_bf16 v[8:11], a[224:227], v[136:139], v[8:11]
    v_mfma_f32_16x16x32_bf16 v[12:15], a[228:231], v[136:139], v[12:15]
    s_waitcnt vmcnt(34)
    v_mfma_f32_16x16x32_bf16 v[8:11], a[232:235], v[140:143], v[8:11]
    v_mfma_f32_16x16x32_bf16 v[12:15], a[236:239], v[140:143], v[12:15]
    s_waitcnt vmcnt(33)
    v_mfma_f32_16x16x32_bf16 v[8:11], a[240:243], v[144:147], v[8:11]
    v_mfma_f32_16x16x32_bf16 v[12:15], a[244:247], v[144:147], v[12:15]
    s_waitcnt vmcnt(32)
    v_mfma_f32_16x16x32_bf16 v[8:11], a[248:251], v[148:151], v[8:11]
    v_mfma_f32_16x16x32_bf16 v[12:15], a[252:255], v[148:151], v[12:15]
    s_waitcnt vmcnt(31)
    v_mfma_f32_16x16x32_bf16 v[16:19], a[0:3], v[152:155], 0
    v_mfma_f32_16x16x32_bf16 v[20:23], a[4:7], v[152:155], 0
    s_waitcnt vmcnt(30)
    v_mfma_f32_16x16x32_bf16 v[16:19], a[8:11], v[156:159], v[16:19]
    v_mfma_f32_16x16x32_bf16 v[20:23], a[12:15], v[156:159], v[20:23]
    s_waitcnt vmcnt(29)
    v_mfma_f32_16x16x32_bf16 v[16:19], a[16:19], v[160:163], v[16:19]
    v_mfma_f32_16x16x32_bf16 v[20:23], a[20:23], v[160:163], v[20:23]
    s_waitcnt vmcnt(28)
    v_mfma_f32_16x16x32_bf16 v[16:19], a[24:27], v[164:167], v[16:19]
    v_mfma_f32_16x16x32_bf16 v[20:23], a[28:31], v[164:167], v[20:23]
    s_waitcnt vmcnt(27)
    v_mfma_f32_16x16x32_bf16 v[16:19], a[32:35], v[168:171], v[16:19]
    v_mfma_f32_16x16x32_bf16 v[20:23], a[36:39], v[168:171], v[20:23]
    s_waitcnt vmcnt(26)
    v_mfma_f32_16x16x32_bf16 v[16:19], a[40:43], v[172:175], v[16:19]
    v_mfma_f32_16x16x32_bf16 v[20:23], a[44:47], v[172:175], v[20:23]
    s_waitcnt vmcnt(25)
    v_mfma_f32_16x16x32_bf16 v[16:19], a[48:51], v[176:179], v[16:19]
    v_mfma_f32_16x16x32_bf16 v[20:23], a[52:55], v[176:179], v[20:23]
    s_waitcnt vmcnt(24)
    v_mfma_f32_16x16x32_bf16 v[16:19], a[56:59], v[180:183], v[16:19]
    v_mfma_f32_16x16x32_bf16 v[20:23], a[60:63], v[180:183], v[20:23]
    s_waitcnt vmcnt(23)
    v_mfma_f32_16x16x32_bf16 v[16:19], a[64:67], v[184:187], v[16:19]
    v_mfma_f32_16x16x32_bf16 v[20:23], a[68:71], v[184:187], v[20:23]
    s_waitcnt vmcnt(22)
    v_mfma_f32_16x16x32_bf16 v[16:19], a[72:75], v[188:191], v[16:19]
    v_mfma_f32_16x16x32_bf16 v[20:23], a[76:79], v[188:191], v[20:23]
    s_waitcnt vmcnt(21)
    v_mfma_f32_16x16x32_bf16 v[16:19], a[80:83], v[192:195], v[16:19]
    v_mfma_f32_16x16x32_bf16 v[20:23], a[84:87], v[192:195], v[20:23]
    s_waitcnt vmcnt(20)
    v_mfma_f32_16x16x32_bf16 v[16:19], a[88:91], v[196:199], v[16:19]
    v_mfma_f32_16x16x32_bf16 v[20:23], a[92:95], v[196:199], v[20:23]
    s_waitcnt vmcnt(19)
    v_mfma_f32_16x16x32_bf16 v[16:19], a[96:99], v[200:203], v[16:19]
    v_mfma_f32_16x16x32_bf16 v[20:23], a[100:103], v[200:203], v[20:23]
    s_waitcnt vmcnt(18)
    v_mfma_f32_16x16x32_bf16 v[16:19], a[104:107], v[204:207], v[16:19]
    v_mfma_f32_16x16x32_bf16 v[20:23], a[108:111], v[204:207], v[20:23]
    s_waitcnt vmcnt(17)
    v_mfma_f32_16x16x32_bf16 v[16:19], a[112:115], v[208:211], v[16:19]
    v_mfma_f32_16x16x32_bf16 v[20:23], a[116:119], v[208:211], v[20:23]
    s_waitcnt vmcnt(16)
    v_mfma_f32_16x16x32_bf16 v[16:19], a[120:123], v[212:215], v[16:19]
    v_mfma_f32_16x16x32_bf16 v[20:23], a[124:127], v[212:215], v[20:23]
    s_waitcnt vmcnt(15)
    v_mfma_f32_16x16x32_bf16 v[16:19], a[128:131], v[216:219], v[16:19]
    v_mfma_f32_16x16x32_bf16 v[20:23], a[132:135], v[216:219], v[20:23]
    s_waitcnt vmcnt(14)
    v_mfma_f32_16x16x32_bf16 v[16:19], a[136:139], v[220:223], v[16:19]
    v_mfma_f32_16x16x32_bf16 v[20:23], a[140:143], v[220:223], v[20:23]
    s_waitcnt vmcnt(13)
    v_mfma_f32_16x16x32_bf16 v[16:19], a[144:147], v[224:227], v[16:19]
    v_mfma_f32_16x16x32_bf16 v[20:23], a[148:151], v[224:227], v[20:23]
    s_waitcnt vmcnt(12)
    v_mfma_f32_16x16x32_bf16 v[16:19], a[152:155], v[228:231], v[16:19]
    v_mfma_f32_16x16x32_bf16 v[20:23], a[156:159], v[228:231], v[20:23]
    s_waitcnt vmcnt(11)
    v_mfma_f32_16x16x32_bf16 v[16:19], a[160:163], v[232:235], v[16:19]
    v_mfma_f32_16x16x32_bf16 v[20:23], a[164:167], v[232:235], v[20:23]
    s_waitcnt vmcnt(10)
    v_mfma_f32_16x16x32_bf16 v[16:19], a[168:171], v[236:239], v[16:19]
    v_mfma_f32_16x16x32_bf16 v[20:23], a[172:175], v[236:239], v[20:23]
    s_waitcnt vmcnt(9)
    v_mfma_f32_16x16x32_bf16 v[16:19], a[176:179], v[240:243], v[16:19]
    v_mfma_f32_16x16x32_bf16 v[20:23], a[180:183], v[240:243], v[20:23]
    s_waitcnt vmcnt(8)
    v_mfma_f32_16x16x32_bf16 v[16:19], a[184:187], v[244:247], v[16:19]
    v_mfma_f32_16x16x32_bf16 v[20:23], a[188:191], v[244:247], v[20:23]
    s_waitcnt vmcnt(7)
    v_mfma_f32_16x16x32_bf16 v[16:19], a[192:195], v[24:27], v[16:19]
    v_mfma_f32_16x16x32_bf16 v[20:23], a[196:199], v[24:27], v[20:23]
    s_waitcnt vmcnt(6)
    v_mfma_f32_16x16x32_bf16 v[16:19], a[200:203], v[28:31], v[16:19]
    v_mfma_f32_16x16x32_bf16 v[20:23], a[204:207], v[28:31], v[20:23]
    s_waitcnt vmcnt(5)
    v_mfma_f32_16x16x32_bf16 v[16:19], a[208:211], v[32:35], v[16:19]
    v_mfma_f32_16x16x32_bf16 v[20:23], a[212:215], v[32:35], v[20:23]
    s_waitcnt vmcnt(4)
    v_mfma_f32_16x16x32_bf16 v[16:19], a[216:219], v[36:39], v[16:19]
    v_mfma_f32_16x16x32_bf16 v[20:23], a[220:223], v[36:39], v[20:23]
    s_waitcnt vmcnt(3)
    v_mfma_f32_16x16x32_bf16 v[16:19], a[224:227], v[40:43], v[16:19]
    v_mfma_f32_16x16x32_bf16 v[20:23], a[228:231], v[40:43], v[20:23]
    s_waitcnt vmcnt(2)
    v_mfma_f32_16x16x32_bf16 v[16:19], a[232:235], v[44:47], v[16:19]
    v_mfma_f32_16x16x32_bf16 v[20:23], a[236:239], v[44:47], v[20:23]
    s_waitcnt vmcnt(1)
    v_mfma_f32_16x16x32_bf16 v[16:19], a[240:243], v[48:51], v[16:19]
    v_mfma_f32_16x16x32_bf16 v[20:23], a[244:247], v[48:51], v[20:23]
    s_waitcnt vmcnt(0)
    v_mfma_f32_16x16x32_bf16 v[16:19], a[248:251], v[52:55], v[16:19]
    v_mfma_f32_16x16x32_bf16 v[20:23], a[252:255], v[52:55], v[20:23]
    ds_write_b128 v2, v[8:11] offset:0
    ds_write_b128 v2, v[12:15] offset:1024
    s_nop 4
    ds_write_b128 v2, v[16:19] offset:8192
    ds_write_b128 v2, v[20:23] offset:9216
    s_cmp_lg_u32 s32, 0
    s_cbranch_scc1 o2_nb
    v_cmp_eq_u32 vcc, 0, v253
    s_nop 0
    s_cmp_eq_u64 vcc, 0
    s_cselect_b32 s44, 65536, 0
    v_or_b32 v250, s44, v250
    v_mov_b32 v251, 163832
    s_mov_b64 exec, 1
    ds_write_b32 v251, v250
    s_mov_b64 exec, -1
o2_nb:
    s_waitcnt lgkmcnt(0)
    s_barrier
    s_cmp_gt_u32 s32, 1
    s_cbranch_scc1 o2_skip
    s_lshl_b32 s18, s32, 13
    v_add_u32 v2, s18, v1
    ds_read_b128 v[24:27], v2 offset:0
    ds_read_b128 v[28:31], v2 offset:1024
    ds_read_b128 v[32:35], v2 offset:2048
    ds_read_b128 v[36:39], v2 offset:3072
    ds_read_b128 v[40:43], v2 offset:4096
    ds_read_b128 v[44:47], v2 offset:5120
    ds_read_b128 v[48:51], v2 offset:6144
    ds_read_b128 v[52:55], v2 offset:7168
    v_lshrrev_b32 v3, 4, v1
    v_bfe_u32 v4, v3, 2, 2
    v_lshlrev_b32 v4, 3, v4
    v_and_b32 v2, 3, v3
    v_add_u32 v4, v4, v2
    v_mul_u32_u24 v4, 2304, v4
    v_lshrrev_b32 v3, 4, v3
    v_lshl_add_u32 v4, v3, 4, v4
    s_add_u32 s20, s16, s32
    s_lshr_b32 s18, s20, 1
    s_lshl_b32 s18, s18, 3
    s_and_b32 s19, s20, 1
    s_add_u32 s18, s18, s19
    s_mul_i32 s18, s18, 9216
    s_lshl_b32 s19, s33, 6
    s_add_u32 s18, s18, s19
    s_waitcnt lgkmcnt(0)
    v_pk_add_f32 v[24:25], v[24:25], v[32:33]
    v_pk_add_f32 v[40:41], v[40:41], v[48:49]
    v_pk_add_f32 v[24:25], v[24:25], v[40:41]
    v_pk_add_f32 v[26:27], v[26:27], v[34:35]
    v_pk_add_f32 v[42:43], v[42:43], v[50:51]
    v_pk_add_f32 v[26:27], v[26:27], v[42:43]
    v_pk_add_f32 v[28:29], v[28:29], v[36:37]
    v_pk_add_f32 v[44:45], v[44:45], v[52:53]
    v_pk_add_f32 v[28:29], v[28:29], v[44:45]
    v_pk_add_f32 v[30:31], v[30:31], v[38:39]
    v_pk_add_f32 v[46:47], v[46:47], v[54:55]
    v_pk_add_f32 v[30:31], v[30:31], v[46:47]
    v_cvt_pk_bf16_f32 v8, v24, v28
    v_cvt_pk_bf16_f32 v9, v25, v29
    v_cvt_pk_bf16_f32 v10, v26, v30
    v_cvt_pk_bf16_f32 v11, v27, v31
    buffer_store_dwordx4 v[8:11], v4, s[8:11], s18 offen
o2_skip:
    s_nop 1
    s_branch L_op_fin
L_op_one:
o1_again:
    s_lshl_b32 s18, s16, 17
    s_lshl_b32 s19, s32, 15
    s_add_u32 s18, s18, s19
    s_add_u32 s18, s18, 50331648
    buffer_load_dwordx4 v[24:27], v1, s[4:7], s18 offen offset:0 sc1
    buffer_load_dwordx4 v[28:31], v1, s[4:7], s18 offen offset:1024 sc1
    buffer_load_dwordx4 v[32:35], v1, s[4:7], s18 offen offset:2048 sc1
    buffer_load_dwordx4 v[36:39], v1, s[4:7], s18 offen offset:3072 sc1
    s_add_u32 s18, s18, 4096
    buffer_load_dwordx4 v[40:43], v1, s[4:7], s18 offen offset:0 sc1
    buffer_load_dwordx4 v[44:47], v1, s[4:7], s18 offen offset:1024 sc1
    buffer_load_dwordx4 v[48:51], v1, s[4:7], s18 offen offset:2048 sc1
    buffer_load_dwordx4 v[52:55], v1, s[4:7], s18 offen offset:3072 sc1
    s_add_u32 s18, s18, 4096
    buffer_load_dwordx4 v[56:59], v1, s[4:7], s18 offen offset:0 sc1
    buffer_load_dwordx4 v[60:63], v1, s[4:7], s18 offen offset:1024 sc1
    buffer_load_dwordx4 v[64:67], v1, s[4:7], s18 offen offset:2048 sc1
    buffer_load_dwordx4 v[68:71], v1, s[4:7], s18 offen offset:3072 sc1
    s_add_u32 s18, s18, 4096
    buffer_load_dwordx4 v[72:75], v1, s[4:7], s18 offen offset:0 sc1
    buffer_load_dwordx4 v[76:79], v1, s[4:7], s18 offen offset:1024 sc1
    buffer_load_dwordx4 v[80:83], v1, s[4:7], s18 offen offset:2048 sc1
    buffer_load_dwordx4 v[84:87], v1, s[4:7], s18 offen offset:3072 sc1
    s_add_u32 s18, s18, 4096
    buffer_load_dwordx4 v[88:91], v1, s[4:7], s18 offen offset:0 sc1
    buffer_load_dwordx4 v[92:95], v1, s[4:7], s18 offen offset:1024 sc1
    buffer_load_dwordx4 v[96:99], v1, s[4:7], s18 offen offset:2048 sc1
    buffer_load_dwordx4 v[100:103], v1, s[4:7], s18 offen offset:3072 sc1
    s_add_u32 s18, s18, 4096
    buffer_load_dwordx4 v[104:107], v1, s[4:7], s18 offen offset:0 sc1
    buffer_load_dwordx4 v[108:111], v1, s[4:7], s18 offen offset:1024 sc1
    buffer_load_dwordx4 v[112:115], v1, s[4:7], s18 offen offset:2048 sc1
    buffer_load_dwordx4 v[116:119], v1, s[4:7], s18 offen offset:3072 sc1
    s_add_u32 s18, s18, 4096
    buffer_load_dwordx4 v[120:123], v1, s[4:7], s18 offen offset:0 sc1
    buffer_load_dwordx4 v[124:127], v1, s[4:7], s18 offen offset:1024 sc1
    buffer_load_dwordx4 v[128:131], v1, s[4:7], s18 offen offset:2048 sc1
    buffer_load_dwordx4 v[132:135], v1, s[4:7], s18 offen offset:3072 sc1
    s_add_u32 s18, s18, 4096
    buffer_load_dwordx4 v[136:139], v1, s[4:7], s18 offen offset:0 sc1
    buffer_load_dwordx4 v[140:143], v1, s[4:7], s18 offen offset:1024 sc1
    buffer_load_dwordx4 v[144:147], v1, s[4:7], s18 offen offset:2048 sc1
    buffer_load_dwordx4 v[148:151], v1, s[4:7], s18 offen offset:3072 sc1
    v_lshlrev_b32 v2, 4, v0
    v_and_b32 v3, 3072, v2
    v_lshl_add_u32 v2, v3, 1, v1
    s_waitcnt vmcnt(31)
    v_mfma_f32_16x16x32_bf16 v[8:11], a[0:3], v[24:27], 0
    v_max_u32 v6, v24, v25
    v_mfma_f32_16x16x32_bf16 v[12:15], a[4:7], v[24:27], 0
    v_max3_u32 v6, v6, v26, v27
    s_waitcnt vmcnt(30)
    v_mfma_f32_16x16x32_bf16 v[8:11], a[8:11], v[28:31], v[8:11]
    v_max3_u32 v6, v6, v28, v29
    v_mfma_f32_16x16x32_bf16 v[12:15], a[12:15], v[28:31], v[12:15]
    v_max3_u32 v6, v6, v30, v31
    s_waitcnt vmcnt(29)
    v_mfma_f32_16x16x32_bf16 v[8:11], a[16:19], v[32:35], v[8:11]
    v_max3_u32 v6, v6, v32, v33
    v_mfma_f32_16x16x32_bf16 v[12:15], a[20:23], v[32:35], v[12:15]
    v_max3_u32 v6, v6, v34, v35
    s_waitcnt vmcnt(28)
    v_mfma_f32_16x16x32_bf16 v[8:11], a[24:27], v[36:39], v[8:11]
    v_max3_u32 v6, v6, v36, v37
    v_mfma_f32_16x16x32_bf16 v[12:15], a[28:31], v[36:39], v[12:15]
    v_max3_u32 v6, v6, v38, v39
    s_waitcnt vmcnt(27)
    v_mfma_f32_16x16x32_bf16 v[8:11], a[32:35], v[40:43], v[8:11]
    v_max3_u32 v6, v6, v40, v41
    v_mfma_f32_16x16x32_bf16 v[12:15], a[36:39], v[40:43], v[12:15]
    v_max3_u32 v6, v6, v42, v43
    s_waitcnt vmcnt(26)
    v_mfma_f32_16x16x32_bf16 v[8:11], a[40:43], v[44:47], v[8:11]
    v_max3_u32 v6, v6, v44, v45
    v_mfma_f32_16x16x32_bf16 v[12:15], a[44:47], v[44:47], v[12:15]
    v_max3_u32 v6, v6, v46, v47
    s_waitcnt vmcnt(25)
    v_mfma_f32_16x16x32_bf16 v[8:11], a[48:51], v[48:51], v[8:11]
    v_max3_u32 v6, v6, v48, v49
    v_mfma_f32_16x16x32_bf16 v[12:15], a[52:55], v[48:51], v[12:15]
    v_max3_u32 v6, v6, v50, v51
    s_waitcnt vmcnt(24)
    v_mfma_f32_16x16x32_bf16 v[8:11], a[56:59], v[52:55], v[8:11]
    v_max3_u32 v6, v6, v52, v53
    v_mfma_f32_16x16x32_bf16 v[12:15], a[60:63], v[52:55], v[12:15]
    v_max3_u32 v6, v6, v54, v55
    s_waitcnt vmcnt(23)
    v_mfma_f32_16x16x32_bf16 v[8:11], a[64:67], v[56:59], v[8:11]
    v_max3_u32 v6, v6, v56, v57
    v_mfma_f32_16x16x32_bf16 v[12:15], a[68:71], v[56:59], v[12:15]
    v_max3_u32 v6, v6, v58, v59
    s_waitcnt vmcnt(22)
    v_mfma_f32_16x16x32_bf16 v[8:11], a[72:75], v[60:63], v[8:11]
    v_max3_u32 v6, v6, v60, v61
    v_mfma_f32_16x16x32_bf16 v[12:15], a[76:79], v[60:63], v[12:15]
    v_max3_u32 v6, v6, v62, v63
    s_waitcnt vmcnt(21)
    v_mfma_f32_16x16x32_bf16 v[8:11], a[80:83], v[64:67], v[8:11]
    v_max3_u32 v6, v6, v64, v65
    v_mfma_f32_16x16x32_bf16 v[12:15], a[84:87], v[64:67], v[12:15]
    v_max3_u32 v6, v6, v66, v67
    s_waitcnt vmcnt(20)
    v_mfma_f32_16x16x32_bf16 v[8:11], a[88:91], v[68:71], v[8:11]
    v_max3_u32 v6, v6, v68, v69
    v_mfma_f32_16x16x32_bf16 v[12:15], a[92:95], v[68:71], v[12:15]
    v_max3_u32 v6, v6, v70, v71
    s_waitcnt vmcnt(19)
    v_mfma_f32_16x16x32_bf16 v[8:11], a[96:99], v[72:75], v[8:11]
    v_max3_u32 v6, v6, v72, v73
    v_mfma_f32_16x16x32_bf16 v[12:15], a[100:103], v[72:75], v[12:15]
    v_max3_u32 v6, v6, v74, v75
    s_waitcnt vmcnt(18)
    v_mfma_f32_16x16x32_bf16 v[8:11], a[104:107], v[76:79], v[8:11]
    v_max3_u32 v6, v6, v76, v77
    v_mfma_f32_16x16x32_bf16 v[12:15], a[108:111], v[76:79], v[12:15]
    v_max3_u32 v6, v6, v78, v79
    s_waitcnt vmcnt(17)
    v_mfma_f32_16x16x32_bf16 v[8:11], a[112:115], v[80:83], v[8:11]
    v_max3_u32 v6, v6, v80, v81
    v_mfma_f32_16x16x32_bf16 v[12:15], a[116:119], v[80:83], v[12:15]
    v_max3_u32 v6, v6, v82, v83
    s_waitcnt vmcnt(16)
    v_mfma_f32_16x16x32_bf16 v[8:11], a[120:123], v[84:87], v[8:11]
    v_max3_u32 v6, v6, v84, v85
    v_mfma_f32_16x16x32_bf16 v[12:15], a[124:127], v[84:87], v[12:15]
    v_max3_u32 v6, v6, v86, v87
    s_waitcnt vmcnt(15)
    v_mfma_f32_16x16x32_bf16 v[8:11], a[128:131], v[88:91], v[8:11]
    v_max3_u32 v6, v6, v88, v89
    v_mfma_f32_16x16x32_bf16 v[12:15], a[132:135], v[88:91], v[12:15]
    v_max3_u32 v6, v6, v90, v91
    s_waitcnt vmcnt(14)
    v_mfma_f32_16x16x32_bf16 v[8:11], a[136:139], v[92:95], v[8:11]
    v_max3_u32 v6, v6, v92, v93
    v_mfma_f32_16x16x32_bf16 v[12:15], a[140:143], v[92:95], v[12:15]
    v_max3_u32 v6, v6, v94, v95
    s_waitcnt vmcnt(13)
    v_mfma_f32_16x16x32_bf16 v[8:11], a[144:147], v[96:99], v[8:11]
    v_max3_u32 v6, v6, v96, v97
    v_mfma_f32_16x16x32_bf16 v[12:15], a[148:151], v[96:99], v[12:15]
    v_max3_u32 v6, v6, v98, v99
    s_waitcnt vmcnt(12)
    v_mfma_f32_16x16x32_bf16 v[8:11], a[152:155], v[100:103], v[8:11]
    v_max3_u32 v6, v6, v100, v101
    v_mfma_f32_16x16x32_bf16 v[12:15], a[156:159], v[100:103], v[12:15]
    v_max3_u32 v6, v6, v102, v103
    s_waitcnt vmcnt(11)
    v_mfma_f32_16x16x32_bf16 v[8:11], a[160:163], v[104:107], v[8:11]
    v_max3_u32 v6, v6, v104, v105
    v_mfma_f32_16x16x32_bf16 v[12:15], a[164:167], v[104:107], v[12:15]
    v_max3_u32 v6, v6, v106, v107
    s_waitcnt vmcnt(10)
    v_mfma_f32_16x16x32_bf16 v[8:11], a[168:171], v[108:111], v[8:11]
    v_max3_u32 v6, v6, v108, v109
    v_mfma_f32_16x16x32_bf16 v[12:15], a[172:175], v[108:111], v[12:15]
    v_max3_u32 v6, v6, v110, v111
    s_waitcnt vmcnt(9)
    v_mfma_f32_16x16x32_bf16 v[8:11], a[176:179], v[112:115], v[8:11]
    v_max3_u32 v6, v6, v112, v113
    v_mfma_f32_16x16x32_bf16 v[12:15], a[180:183], v[112:115], v[12:15]
    v_max3_u32 v6, v6, v114, v115
    s_waitcnt vmcnt(8)
    v_mfma_f32_16x16x32_bf16 v[8:11], a[184:187], v[116:119], v[8:11]
    v_max3_u32 v6, v6, v116, v117
    v_mfma_f32_16x16x32_bf16 v[12:15], a[188:191], v[116:119], v[12:15]
    v_max3_u32 v6, v6, v118, v119
    s_waitcnt vmcnt(7)
    v_mfma_f32_16x16x32_bf16 v[8:11], a[192:195], v[120:123], v[8:11]
    v_max3_u32 v6, v6, v120, v121
    v_mfma_f32_16x16x32_bf16 v[12:15], a[196:199], v[120:123], v[12:15]
    v_max3_u32 v6, v6, v122, v123
    s_waitcnt vmcnt(6)
    v_mfma_f32_16x16x32_bf16 v[8:11], a[200:203], v[124:127], v[8:11]
    v_max3_u32 v6, v6, v124, v125
    v_mfma_f32_16x16x32_bf16 v[12:15], a[204:207], v[124:127], v[12:15]
    v_max3_u32 v6, v6, v126, v127
    s_waitcnt vmcnt(5)
    v_mfma_f32_16x16x32_bf16 v[8:11], a[208:211], v[128:131], v[8:11]
    v_max3_u32 v6, v6, v128, v129
    v_mfma_f32_16x16x32_bf16 v[12:15], a[212:215], v[128:131], v[12:15]
    v_max3_u32 v6, v6, v130, v131
    s_waitcnt vmcnt(4)
    v_mfma_f32_16x16x32_bf16 v[8:11], a[216:219], v[132:135], v[8:11]
    v_max3_u32 v6, v6, v132, v133
    v_mfma_f32_16x16x32_bf16 v[12:15], a[220:223], v[132:135], v[12:15]
    v_max3_u32 v6, v6, v134, v135
    s_waitcnt vmcnt(3)
    v_mfma_f32_16x16x32_bf16 v[8:11], a[224:227], v[136:139], v[8:11]
    v_max3_u32 v6, v6, v136, v137
    v_mfma_f32_16x16x32_bf16 v[12:15], a[228:231], v[136:139], v[12:15]
    v_max3_u32 v6, v6, v138, v139
    s_waitcnt vmcnt(2)
    v_mfma_f32_16x16x32_bf16 v[8:11], a[232:235], v[140:143], v[8:11]
    v_max3_u32 v6, v6, v140, v141
    v_mfma_f32_16x16x32_bf16 v[12:15], a[236:239], v[140:143], v[12:15]
    v_max3_u32 v6, v6, v142, v143
    s_waitcnt vmcnt(1)
    v_mfma_f32_16x16x32_bf16 v[8:11], a[240:243], v[144:147], v[8:11]
    v_max3_u32 v6, v6, v144, v145
    v_mfma_f32_16x16x32_bf16 v[12:15], a[244:247], v[144:147], v[12:15]
    v_max3_u32 v6, v6, v146, v147
    s_waitcnt vmcnt(0)
    v_mfma_f32_16x16x32_bf16 v[8:11], a[248:251], v[148:151], v[8:11]
    v_max3_u32 v6, v6, v148, v149
    v_mfma_f32_16x16x32_bf16 v[12:15], a[252:255], v[148:151], v[12:15]
    v_max3_u32 v6, v6, v150, v151
    v_cmp_eq_u32 vcc, -1, v6
    s_cbranch_vccz o1_ok
    s_cmp_eq_u32 s46, 0
    s_cbranch_scc1 o1_ok
    s_mov_b32 s46, 0
    s_nop 1
    v_mbcnt_lo_u32_b32 v2, -1, 0
    v_mbcnt_hi_u32_b32 v2, -1, v2
    v_min_u32 v2, 1, v2
    v_lshlrev_b32 v2, 2, v2
    s_mov_b32 s88, 4194304
fw22:
    buffer_load_dword v3, v2, s[4:7], s89 offen offset:0 sc1
    s_sub_u32 s88, s88, 1
    s_cbranch_scc1 fw22x
    s_waitcnt vmcnt(0)
    v_cmp_ne_u32 vcc, s95, v3
    s_cbranch_vccz fw22x
    s_sleep 1
    s_branch fw22
fw22x:
    s_branch o1_again
o1_ok:
    s_nop 7
    ds_write_b128 v2, v[8:11] offset:0
    ds_write_b128 v2, v[12:15] offset:1024
    s_cmp_lg_u32 s32, 0
    s_cbranch_scc1 o1_nb
    v_cmp_eq_u32 vcc, 0, v253
    s_nop 0
    s_cmp_eq_u64 vcc, 0
    s_cselect_b32 s44, 65536, 0
    v_or_b32 v250, s44, v250
    v_mov_b32 v251, 163832
    s_mov_b64 exec, 1
    ds_write_b32 v251, v250
    s_mov_b64 exec, -1
o1_nb:
    s_waitcnt lgkmcnt(0)
    s_barrier
    s_cmp_gt_u32 s32, 0
    s_cbranch_scc1 o1_skip
    s_lshl_b32 s18, s32, 13
    v_add_u32 v2, s18, v1
    ds_read_b128 v[24:27], v2 offset:0
    ds_read_b128 v[28:31], v2 offset:1024
    ds_read_b128 v[32:35], v2 offset:2048
    ds_read_b128 v[36:39], v2 offset:3072
    ds_read_b128 v[40:43], v2 offset:4096
    ds_read_b128 v[44:47], v2 offset:5120
    ds_read_b128 v[48:51], v2 offset:6144
    ds_read_b128 v[52:55], v2 offset:7168
    v_lshrrev_b32 v3, 4, v1
    v_bfe_u32 v4, v3, 2, 2
    v_lshlrev_b32 v4, 3, v4
    v_and_b32 v2, 3, v3
    v_add_u32 v4, v4, v2
    v_mul_u32_u24 v4, 2304, v4
    v_lshrrev_b32 v3, 4, v3
    v_lshl_add_u32 v4, v3, 4, v4
    s_add_u32 s20, s16, s32
    s_lshr_b32 s18, s20, 1
    s_lshl_b32 s18, s18, 3
    s_and_b32 s19, s20, 1
    s_add_u32 s18, s18, s19
    s_mul_i32 s18, s18, 9216
    s_lshl_b32 s19, s33, 6
    s_add_u32 s18, s18, s19
    s_waitcnt lgkmcnt(0)
    v_pk_add_f32 v[24:25], v[24:25], v[32:33]
    v_pk_add_f32 v[40:41], v[40:41], v[48:49]
    v_pk_add_f32 v[24:25], v[24:25], v[40:41]
    v_pk_add_f32 v[26:27], v[26:27], v[34:35]
    v_pk_add_f32 v[42:43], v[42:43], v[50:51]
    v_pk_add_f32 v[26:27], v[26:27], v[42:43]
    v_pk_add_f32 v[28:29], v[28:29], v[36:37]
    v_pk_add_f32 v[44:45], v[44:45], v[52:53]
    v_pk_add_f32 v[28:29], v[28:29], v[44:45]
    v_pk_add_f32 v[30:31], v[30:31], v[38:39]
    v_pk_add_f32 v[46:47], v[46:47], v[54:55]
    v_pk_add_f32 v[30:31], v[30:31], v[46:47]
    v_cvt_pk_bf16_f32 v8, v24, v28
    v_cvt_pk_bf16_f32 v9, v25, v29
    v_cvt_pk_bf16_f32 v10, v26, v30
    v_cvt_pk_bf16_f32 v11, v27, v31
    buffer_store_dwordx4 v[8:11], v4, s[8:11], s18 offen
o1_skip:
    s_nop 1
L_op_fin:
    v_mov_b32 v251, 163832
    ds_read_b32 v252, v251
    s_waitcnt lgkmcnt(0)
    v_readfirstlane_b32 s40, v252
    s_nop 1
    s_cmp_ge_u32 s40, 65608
    s_cbranch_scc1 L_done
    s_barrier
    s_and_b32 s16, s40, 0xffff
    s_cmp_lt_u32 s16, 72
    s_cbranch_scc1 L_op_seg
L_op_nextcb:
    s_mov_b32 s40, -1
    s_cmp_lg_u32 s32, 0
    s_cbranch_scc1 L_op_dec
    v_and_b32 v1, 63, v0
    v_min_u32 v1, 17, v1
    v_lshlrev_b32 v2, 2, v1
    buffer_load_dword v3, v2, s[84:87], 0 offen offset:136 sc1
    s_waitcnt vmcnt(0)
    v_cmp_gt_u32 vcc, 52, v3
    s_nop 0
    s_and_b32 s40, vcc_lo, 262143
    s_lshl_b32 s41, s40, 18
    s_lshr_b32 s43, s40, 14
    s_or_b32 s42, s40, s41
    s_and_b32 s36, s45, 15
    s_bfm_b32 s37, s36, 0
    s_and_b32 s37, s37, 42315
    s_bcnt1_i32_b32 s37, s37
    s_lshr_b32 s36, s45, 4
    s_mul_i32 s36, s36, 8
    s_add_u32 s36, s36, s37
    s_add_u32 s36, s36, 38
    s_mul_hi_u32 s41, s36, 0x0e38e38f
    s_mul_i32 s41, s41, 18
    s_sub_u32 s41, s36, s41
    s_lshr_b64 s[42:43], s[42:43], s41
    s_ff1_i32_b64 s40, s[42:43]
    s_cmp_lt_i32 s40, 0
    s_cbranch_scc1 L_op_dec
    s_add_u32 s40, s40, s41
    s_sub_u32 s41, s40, 18
    s_cselect_b32 s40, s40, s41
L_op_dec:
    v_mov_b32 v250, s40
    v_mov_b32 v251, 163832
    s_cmp_lg_u32 s32, 0
    s_cbranch_scc1 L_op_nw
    ds_write_b32 v251, v250
    s_waitcnt lgkmcnt(0)
L_op_nw:
    s_barrier
    ds_read_b32 v252, v251
    s_waitcnt lgkmcnt(0)
    v_readfirstlane_b32 s33, v252
    s_barrier
    s_nop 1
    s_cmp_lt_u32 s33, 18
    s_cbranch_scc1 L_op_start
L_done:
L_exit:
    s_endpgm
.section .rodata,"a"
.p2align 6
.amdhsa_kernel concat_heads__memory_aug_recurrent_mem_tr__ssm_conv_s4d__prompt_kernel
  .amdhsa_next_free_vgpr 512
  .amdhsa_next_free_sgpr 102
  .amdhsa_accum_offset 256
  .amdhsa_group_segment_fixed_size 0
  .amdhsa_kernarg_size 136
  .amdhsa_user_sgpr_count 2
  .amdhsa_user_sgpr_kernarg_segment_ptr 1
  .amdhsa_system_sgpr_workgroup_id_x 1
.end_amdhsa_kernel
.text
```

```asm
; @launch grid=(256,1,1) block=(256,1,1) lds=163840
.amdgcn_target "amdgcn-amd-amdhsa--gfx950"
.text
.globl concat_heads__memory_aug_recurrent_mem_tr__ssm_conv_s4d__prompt_kernel
.p2align 8
.type concat_heads__memory_aug_recurrent_mem_tr__ssm_conv_s4d__prompt_kernel,@function
concat_heads__memory_aug_recurrent_mem_tr__ssm_conv_s4d__prompt_kernel:
    s_cmp_ge_u32 s2, 256
    s_cbranch_scc1 L_exit
    s_load_dwordx4 s[80:83], s[0:1], 120
    s_load_dwordx16 s[48:63], s[0:1], 0
    s_memrealtime s[90:91]
    v_lshrrev_b32 v1, 6, v0
    s_nop 0
    v_readfirstlane_b32 s32, v1
    s_waitcnt lgkmcnt(0)
    s_mov_b32 s4, s82
    s_mov_b32 s5, s83
    s_mov_b32 s6, 268435456
    s_mov_b32 s7, 0x20000
    s_mov_b32 s84, s80
    s_mov_b32 s85, s81
    s_mov_b32 s86, 256
    s_mov_b32 s87, 0x20000
    s_cmp_lg_u32 s32, 0
    s_cbranch_scc1 L_nod0
L_nod0:
    s_cmp_lg_u32 s32, 3
    s_cbranch_scc1 L_nowarm
    s_getpc_b64 s[44:45]
L_pcw:
    v_and_b32 v1, 63, v0
    v_lshlrev_b32 v1, 7, v1
    s_mul_hi_u32 s46, s2, 477218589
    s_mul_i32 s47, s46, 9
    s_sub_u32 s47, s2, s47
    s_add_u32 s46, s46, s47
    s_mul_hi_u32 s40, s46, 477218589
    s_mul_i32 s40, s40, 9
    s_sub_u32 s46, s46, s40
    s_lshl_b32 s47, s47, 13
    v_add_u32 v2, s47, v1
    v_min_u32 v2, L_exit-L_pcw, v2
    global_load_dword v240, v2, s[44:45]
    s_lshl_b32 s46, s46, 13
    v_add_u32 v2, s46, v1
    v_min_u32 v2, L_exit-L_pcw, v2
    global_load_dword v241, v2, s[44:45]
L_nowarm:
    s_getreg_b32 s3, hwreg(HW_REG_XCC_ID)
    s_and_b32 s3, s3, 15
    s_cmp_lg_u32 s3, 3
    s_cbranch_scc1 L_helper
    s_mov_b32 s37, 128
    v_mov_b32 v250, 1
    v_mov_b32 v251, 163832
    v_cmp_eq_u32 vcc, 0, v0
    s_nop 0
    s_and_saveexec_b64 s[38:39], vcc
    s_cbranch_execz tk1
    buffer_atomic_add v250, off, s[84:87], s37 sc0
    s_waitcnt vmcnt(0)
    ds_write_b32 v251, v250
    s_waitcnt lgkmcnt(0)
tk1:
    s_mov_b64 exec, -1
    s_barrier
    ds_read_b32 v252, v251
    s_waitcnt lgkmcnt(0)
    v_readfirstlane_b32 s12, v252
    s_barrier
    s_nop 3
    s_cmp_ge_u32 s12, 32
    s_cbranch_scc1 L_helper
L_chain:
    s_mov_b64 s[48:49], s[50:51]
    s_mov_b64 s[50:51], s[52:53]
    s_mov_b64 s[52:53], s[54:55]
    s_mov_b64 s[54:55], s[56:57]
    s_mov_b64 s[56:57], s[58:59]
    v_lshrrev_b32 v77, 6, v0
    s_nop 0
    v_readfirstlane_b32 s13, v77
    v_lshlrev_b32 v65, 4, v0
    v_and_b32 v48, 63, v0
    s_mov_b32 s10, 4718592
    s_mov_b32 s11, 0x20000
    v_lshrrev_b32 v49, 3, v48
    v_mul_u32_u24 v18, 1152, v49
    v_and_b32 v49, 7, v48
    v_lshl_add_u32 v18, v49, 4, v18
    s_mul_i32 s40, s12, 147456
    s_lshl_b32 s41, s13, 8
    s_add_u32 s40, s40, s41
    s_mov_b32 s42, s40
    s_xor_b32 s41, s13, 0
    s_mul_i32 s41, s41, 36864
    s_add_u32 s60, s41, s40
    s_xor_b32 s41, s13, 1
    s_mul_i32 s41, s41, 36864
    s_add_u32 s61, s41, s40
    s_xor_b32 s41, s13, 2
    s_mul_i32 s41, s41, 36864
    s_add_u32 s62, s41, s40
    s_xor_b32 s41, s13, 3
    s_mul_i32 s41, s41, 36864
    s_add_u32 s63, s41, s40
    s_lshl_b32 s43, s13, 12
    s_mov_b64 s[8:9], s[56:57]
    s_add_u32 m0, s43, 147456
    s_add_u32 s41, s60, 0
    buffer_load_dwordx4 v18, s[8:11], s41 offen offset:0 nt lds
    s_add_u32 s41, s60, 8192
    buffer_load_dwordx4 v18, s[8:11], s41 offen offset:1024 nt lds
    s_add_u32 s41, s60, 16384
    buffer_load_dwordx4 v18, s[8:11], s41 offen offset:2048 nt lds
    s_add_u32 s41, s60, 24576
    buffer_load_dwordx4 v18, s[8:11], s41 offen offset:3072 nt lds
    s_add_u32 m0, s43, 0
    s_add_u32 s41, s61, 0
    buffer_load_dwordx4 v18, s[8:11], s41 offen offset:0 nt lds
    s_add_u32 s41, s61, 8192
    buffer_load_dwordx4 v18, s[8:11], s41 offen offset:1024 nt lds
    s_add_u32 s41, s61, 16384
    buffer_load_dwordx4 v18, s[8:11], s41 offen offset:2048 nt lds
    s_add_u32 s41, s61, 24576
    buffer_load_dwordx4 v18, s[8:11], s41 offen offset:3072 nt lds
    s_add_u32 m0, s43, 36864
    s_add_u32 s41, s62, 0
    buffer_load_dwordx4 v18, s[8:11], s41 offen offset:0 nt lds
    s_add_u32 s41, s62, 8192
    buffer_load_dwordx4 v18, s[8:11], s41 offen offset:1024 nt lds
    s_add_u32 s41, s62, 16384
    buffer_load_dwordx4 v18, s[8:11], s41 offen offset:2048 nt lds
    s_add_u32 s41, s62, 24576
    buffer_load_dwordx4 v18, s[8:11], s41 offen offset:3072 nt lds
    s_add_u32 m0, s43, 73728
    s_add_u32 s41, s63, 0
    buffer_load_dwordx4 v18, s[8:11], s41 offen offset:0 nt lds
    s_add_u32 s41, s63, 8192
    buffer_load_dwordx4 v18, s[8:11], s41 offen offset:1024 nt lds
    s_add_u32 s41, s63, 16384
    buffer_load_dwordx4 v18, s[8:11], s41 offen offset:2048 nt lds
    s_add_u32 s41, s63, 24576
    buffer_load_dwordx4 v18, s[8:11], s41 offen offset:3072 nt lds
    v_lshrrev_b32 v49, 1, v48
    v_mul_u32_u24 v19, 1152, v49
    v_and_b32 v49, 1, v48
    v_lshl_add_u32 v19, v49, 4, v19
    s_mul_i32 s41, s13, 224
    s_sub_u32 s41, 1024, s41
    v_add_u32 v19, s41, v19
    v_lshrrev_b32 v49, 4, v48
    v_lshlrev_b32 v50, 2, v49
    v_and_b32 v51, 15, v48
    v_xor_b32 v51, v51, v50
    v_lshlrev_b32 v51, 4, v51
    v_lshl_add_u32 v16, v49, 15, v51
    v_lshrrev_b32 v50, 1, v49
    v_lshl_add_u32 v17, v50, 16, v51
    v_and_b32 v50, 1, v49
    v_lshl_add_u32 v17, v50, 13, v17
    s_lshl_b32 s40, s12, 8
    s_mul_i32 s58, s13, 1048576
    s_add_u32 s58, s58, s40
    s_lshr_b32 s41, s13, 1
    s_mul_i32 s59, s41, 262144
    s_and_b32 s41, s13, 1
    s_lshl_b32 s41, s41, 14
    s_add_u32 s59, s59, s41
    s_add_u32 s59, s59, s40
    s_add_u32 s59, s59, 4194304
    v_bfe_u32 v50, v48, 2, 2
    v_xor_b32 v51, s13, v50
    v_lshlrev_b32 v20, 6, v51
    v_and_b32 v51, 3, v48
    v_lshl_add_u32 v20, v51, 4, v20
    v_lshrrev_b32 v23, 2, v48
    v_lshl_add_u32 v20, v23, 8, v20
    s_xor_b32 s41, s43, 0
    v_add_u32 v24, s41, v20
    s_xor_b32 s41, s43, 4096
    v_add_u32 v25, s41, v20
    s_xor_b32 s41, s43, 8192
    v_add_u32 v26, s41, v20
    s_xor_b32 s41, s43, 12288
    v_add_u32 v27, s41, v20
    v_and_b32 v23, 1, v50
    v_lshl_add_u32 v23, v49, 2, v23
    v_lshrrev_b32 v50, 1, v50
    v_lshlrev_b32 v21, 7, v23
    v_lshl_add_u32 v21, v50, 6, v21
    v_lshrrev_b32 v16, 1, v51
    v_lshl_add_u32 v21, v16, 5, v21
    v_and_b32 v16, 1, v51
    v_lshl_add_u32 v21, v16, 3, v21
    v_add_u32 v21, s43, v21
    v_lshlrev_b32 v22, 9, v50
    v_xor_b32 v22, v22, v21
    v_lshlrev_b32 v23, 5, v23
    v_lshl_add_u32 v23, v50, 10, v23
    v_lshl_add_u32 v23, v51, 3, v23
    v_add_u32 v23, s43, v23
    v_bfe_u32 v60, v65, 4, 6
    v_and_b32 v61, 15, v60
    v_lshrrev_b32 v62, 4, v60
    v_mov_b32 v64, 0x4444
    v_mov_b32 v77, 0xeeee
    v_cmp_lt_u32 vcc, 7, v61
    s_nop 1
    v_cndmask_b32 v64, v64, v77, vcc
    v_xor_b32 v66, 1024, v65
    v_xor_b32 v67, 2048, v65
    v_xor_b32 v68, 3072, v65
    v_and_b32 v69, 511, v65
    s_mul_i32 s96, s13, 36864
    s_add_u32 s96, s96, 16384
    v_lshlrev_b32 v70, 4, v60
    v_add_u32 v70, s96, v70
    v_lshrrev_b32 v79, 1, v69
    s_lshl_b32 s96, s13, 8
    s_add_u32 s96, s96, 14336
    s_lshl_b32 s33, s13, 10
    s_add_u32 s97, s33, 8192
    v_mov_b32 v77, s97
    v_mov_b32 v78, s96
    v_cmp_lt_u32 vcc, 31, v60
    s_nop 1
    v_cndmask_b32 v71, v77, v78, vcc
    v_add_u32 v71, v71, v79
    v_and_b32 v77, 7, v61
    v_lshrrev_b32 v78, 3, v61
    v_lshlrev_b32 v74, 4, v77
    v_lshl_add_u32 v73, v62, 7, v74
    v_lshl_add_u32 v73, v78, 3, v73
    s_lshl_b32 s96, s13, 9
    v_add_u32 v73, s96, v73
    v_lshrrev_b32 v74, 1, v74
    v_lshl_add_u32 v74, v78, 14, v74
    v_lshl_add_u32 v74, v62, 15, v74
    s_lshl_b32 s96, s13, 17
    v_add_u32 v74, s96, v74
    v_bfe_u32 v77, v61, 2, 1
    v_and_b32 v78, 3, v61
    s_cmp_lt_u32 s13, 2
    s_cselect_b64 vcc, -1, 0
    v_cndmask_b32 v77, 0, v77, vcc
    v_lshlrev_b32 v75, 7, v77
    v_lshl_add_u32 v75, v62, 4, v75
    v_lshl_add_u32 v75, v78, 2, v75
    v_lshlrev_b32 v58, 3, v77
    v_lshl_add_u32 v58, v78, 1, v58
    s_bfe_u32 s97, s12, 0x10001
    s_lshl_b32 s68, s97, 6
    s_lshl_b32 s97, s97, 2
    v_add_u32 v59, s97, v62
    s_bfe_u32 s96, s12, 0x10002
    s_and_b32 s40, s12, 1
    s_lshl_b32 s96, s96, 1
    s_add_u32 s96, s96, s40
    s_lshr_b32 s97, s12, 3
    s_lshl_b32 s98, s13, 2
    s_add_u32 s98, s98, s97
    s_lshl_b32 s98, s98, 2
    s_add_u32 s98, s98, s96
    s_lshl_b32 s98, s98, 8
    s_lshl_b32 s99, s13, 2
    s_add_u32 s99, s99, s96
    s_lshl_b32 s99, s99, 4
    s_lshl_b32 s41, s97, 1
    s_add_u32 s41, s41, s40
    s_lshl_b32 s41, s41, 7
    s_add_u32 s41, s41, 8192
    s_lshl_b32 s40, s40, 3
    s_add_u32 s40, s40, 512
    s_cmp_lt_u32 s13, 2
    s_cselect_b32 s96, 7, 4
    s_cselect_b32 s98, s98, s41
    s_cselect_b32 s99, s99, s40
    s_cselect_b32 s32, 1, 0
    s_add_u32 s68, s68, s98
    s_lshl_b32 s97, s97, s96
    s_add_u32 s99, s99, s97
    v_add_u32 v58, s99, v58
    s_and_b32 s97, s12, 4
    s_or_b32 s97, s97, s13
    s_cmp_eq_u32 s97, 2
    s_cselect_b32 s32, 2, s32
    s_mov_b32 s8, s48
    s_mov_b32 s9, s49
    s_mov_b32 s10, 9216
    v_mul_u32_u24 v77, 1152, v59
    v_lshl_add_u32 v77, v58, 1, v77
    buffer_load_dword v72, v77, s[8:11], 0 offen
    s_mov_b32 s10, 4718592
    s_waitcnt vmcnt(12) lgkmcnt(0)
    s_barrier
    s_mov_b64 s[8:9], s[56:57]
    s_add_u32 m0, s43, 110592
    s_add_u32 s41, s42, 0
    buffer_load_dwordx4 v19, s[8:11], s41 offen offset:0 nt lds
    s_add_u32 s41, s42, 35840
    buffer_load_dwordx4 v19, s[8:11], s41 offen offset:1024 nt lds
    s_add_u32 s41, s42, 71680
    buffer_load_dwordx4 v19, s[8:11], s41 offen offset:2048 nt lds
    s_add_u32 s41, s42, 107520
    buffer_load_dwordx4 v19, s[8:11], s41 offen offset:3072 nt lds
    v_mov_b32 v78, v21
    v_mov_b32 v79, v22
    v_add_u32 v77, 147456, v79
    ds_read_b64_tr_b16 v[80:81], v77 offset:0
    ds_read_b64_tr_b16 v[82:83], v77 offset:256
    ds_read_b64_tr_b16 v[84:85], v77 offset:2048
    ds_read_b64_tr_b16 v[86:87], v77 offset:2304
    ds_read_b64_tr_b16 v[112:113], v77 offset:16
    ds_read_b64_tr_b16 v[114:115], v77 offset:272
    ds_read_b64_tr_b16 v[116:117], v77 offset:2064
    ds_read_b64_tr_b16 v[118:119], v77 offset:2320
    s_waitcnt vmcnt(12) lgkmcnt(0)
    s_barrier
    s_mov_b64 s[8:9], s[52:53]
    s_add_u32 m0, s43, 147456
    s_add_u32 s41, s58, 0
    buffer_load_dwordx4 v17, s[8:11], s41 offen offset:0 nt lds
    s_add_u32 s41, s58, 31744
    buffer_load_dwordx4 v17, s[8:11], s41 offen offset:1024 nt lds
    s_add_u32 s41, s58, 129024
    buffer_load_dwordx4 v17, s[8:11], s41 offen offset:2048 nt lds
    s_add_u32 s41, s58, 160768
    buffer_load_dwordx4 v17, s[8:11], s41 offen offset:3072 nt lds
    v_add_u32 v77, 0, v78
    ds_read_b64_tr_b16 v[88:89], v77 offset:0
    ds_read_b64_tr_b16 v[90:91], v77 offset:256
    ds_read_b64_tr_b16 v[92:93], v77 offset:2048
    ds_read_b64_tr_b16 v[94:95], v77 offset:2304
    ds_read_b64_tr_b16 v[120:121], v77 offset:16
    ds_read_b64_tr_b16 v[122:123], v77 offset:272
    ds_read_b64_tr_b16 v[124:125], v77 offset:2064
    ds_read_b64_tr_b16 v[126:127], v77 offset:2320
    s_waitcnt vmcnt(12) lgkmcnt(0)
    s_barrier
    s_add_u32 m0, s43, 0
    s_add_u32 s41, s58, 16384
    buffer_load_dwordx4 v17, s[8:11], s41 offen offset:0 nt lds
    s_add_u32 s41, s58, 48128
    buffer_load_dwordx4 v17, s[8:11], s41 offen offset:1024 nt lds
    s_add_u32 s41, s58, 145408
    buffer_load_dwordx4 v17, s[8:11], s41 offen offset:2048 nt lds
    s_add_u32 s41, s58, 177152
    buffer_load_dwordx4 v17, s[8:11], s41 offen offset:3072 nt lds
    v_add_u32 v77, 36864, v78
    ds_read_b64_tr_b16 v[96:97], v77 offset:0
    ds_read_b64_tr_b16 v[98:99], v77 offset:256
    ds_read_b64_tr_b16 v[100:101], v77 offset:2048
    ds_read_b64_tr_b16 v[102:103], v77 offset:2304
    ds_read_b64_tr_b16 v[128:129], v77 offset:16
    ds_read_b64_tr_b16 v[130:131], v77 offset:272
    ds_read_b64_tr_b16 v[132:133], v77 offset:2064
    ds_read_b64_tr_b16 v[134:135], v77 offset:2320
    s_waitcnt vmcnt(12) lgkmcnt(0)
    s_barrier
    s_add_u32 m0, s43, 36864
    s_add_u32 s41, s58, 262144
    buffer_load_dwordx4 v17, s[8:11], s41 offen offset:0 nt lds
    s_add_u32 s41, s58, 293888
    buffer_load_dwordx4 v17, s[8:11], s41 offen offset:1024 nt lds
    s_add_u32 s41, s58, 391168
    buffer_load_dwordx4 v17, s[8:11], s41 offen offset:2048 nt lds
    s_add_u32 s41, s58, 422912
    buffer_load_dwordx4 v17, s[8:11], s41 offen offset:3072 nt lds
    v_add_u32 v77, 73728, v78
    ds_read_b64_tr_b16 v[104:105], v77 offset:0
    ds_read_b64_tr_b16 v[106:107], v77 offset:256
    ds_read_b64_tr_b16 v[108:109], v77 offset:2048
    ds_read_b64_tr_b16 v[110:111], v77 offset:2304
    ds_read_b64_tr_b16 v[136:137], v77 offset:16
    ds_read_b64_tr_b16 v[138:139], v77 offset:272
    ds_read_b64_tr_b16 v[140:141], v77 offset:2064
    ds_read_b64_tr_b16 v[142:143], v77 offset:2320
    s_waitcnt vmcnt(12) lgkmcnt(0)
    s_barrier
    s_add_u32 m0, s43, 73728
    s_add_u32 s41, s58, 278528
    buffer_load_dwordx4 v17, s[8:11], s41 offen offset:0 nt lds
    s_add_u32 s41, s58, 310272
    buffer_load_dwordx4 v17, s[8:11], s41 offen offset:1024 nt lds
    s_add_u32 s41, s58, 407552
    buffer_load_dwordx4 v17, s[8:11], s41 offen offset:2048 nt lds
    s_add_u32 s41, s58, 439296
    buffer_load_dwordx4 v17, s[8:11], s41 offen offset:3072 nt lds
    v_add_u32 v77, 110592, v23
    ds_read_b64_tr_b16 v[0:1], v77 offset:0
    ds_read_b64_tr_b16 v[2:3], v77 offset:64
    ds_read_b64_tr_b16 v[4:5], v77 offset:512
    ds_read_b64_tr_b16 v[6:7], v77 offset:576
    ds_read_b64_tr_b16 v[8:9], v77 offset:2048
    ds_read_b64_tr_b16 v[10:11], v77 offset:2112
    ds_read_b64_tr_b16 v[12:13], v77 offset:2560
    ds_read_b64_tr_b16 v[14:15], v77 offset:2624
    s_waitcnt vmcnt(12) lgkmcnt(0)
    s_barrier
    s_add_u32 m0, s43, 110592
    s_add_u32 s41, s58, 524288
    buffer_load_dwordx4 v17, s[8:11], s41 offen offset:0 nt lds
    s_add_u32 s41, s58, 556032
    buffer_load_dwordx4 v17, s[8:11], s41 offen offset:1024 nt lds
    s_add_u32 s41, s58, 653312
    buffer_load_dwordx4 v17, s[8:11], s41 offen offset:2048 nt lds
    s_add_u32 s41, s58, 685056
    buffer_load_dwordx4 v17, s[8:11], s41 offen offset:3072 nt lds
    s_cmp_eq_u32 s32, 0
    s_cbranch_scc1 cf_init_done
    v_mov_b32 v52, 1
    v_mov_b32 v53, 1
    v_mov_b32 v54, 1
    v_mov_b32 v55, 1
    v_mov_b32 v56, 0
    s_lshl_b32 s96, s12, 14
    s_add_u32 s96, s96, 68157440
    s_add_u32 s97, s96, 0
    buffer_store_dwordx4 v[52:55], v65, s[4:7], s97 offen
    buffer_load_dwordx4 v[60:63], v65, s[4:7], s97 offen sc1
    s_add_u32 s97, s96, 4096
    buffer_store_dwordx4 v[52:55], v65, s[4:7], s97 offen
    buffer_load_dwordx4 v[60:63], v65, s[4:7], s97 offen sc1
    s_add_u32 s97, s96, 8192
    buffer_store_dwordx4 v[52:55], v65, s[4:7], s97 offen
    buffer_load_dwordx4 v[60:63], v65, s[4:7], s97 offen sc1
    s_add_u32 s97, s96, 12288
    buffer_store_dwordx4 v[52:55], v65, s[4:7], s97 offen
    buffer_load_dwordx4 v[60:63], v65, s[4:7], s97 offen sc1
    s_add_u32 s96, s68, 67108864
    s_add_u32 s97, s96, 16384
    buffer_store_dword v56, v75, s[4:7], s96 offen offset:0
    buffer_store_dword v72, v75, s[4:7], s97 offen offset:0
    buffer_load_dword v60, v75, s[4:7], s96 offen offset:0 sc1
    buffer_load_dword v60, v75, s[4:7], s97 offen offset:0 sc1
    s_cmp_lg_u32 s32, 2
    s_cbranch_scc1 cf_init_done
    buffer_store_dword v56, v75, s[4:7], s96 offen offset:1024
    buffer_store_dword v72, v75, s[4:7], s97 offen offset:1024
    buffer_load_dword v60, v75, s[4:7], s96 offen offset:1024 sc1
    buffer_load_dword v60, v75, s[4:7], s97 offen offset:1024 sc1
    buffer_store_dword v56, v75, s[4:7], s96 offen offset:2048
    buffer_store_dword v72, v75, s[4:7], s97 offen offset:2048
    buffer_load_dword v60, v75, s[4:7], s96 offen offset:2048 sc1
    buffer_load_dword v60, v75, s[4:7], s97 offen offset:2048 sc1
    buffer_store_dword v56, v75, s[4:7], s96 offen offset:3072
    buffer_store_dword v72, v75, s[4:7], s97 offen offset:3072
    buffer_load_dword v60, v75, s[4:7], s96 offen offset:3072 sc1
    buffer_load_dword v60, v75, s[4:7], s97 offen offset:3072 sc1
cf_init_done:
    ds_write_b64 v70, v[0:1] offset:16384
    ds_write_b64 v70, v[2:3] offset:16392
    ds_write_b64 v70, v[4:5] offset:17408
    ds_write_b64 v70, v[6:7] offset:17416
    ds_write_b64 v70, v[8:9] offset:18432
    ds_write_b64 v70, v[10:11] offset:18440
    ds_write_b64 v70, v[12:13] offset:19456
    ds_write_b64 v70, v[14:15] offset:19464
    v_add_u32 v28, 147456, v24
    v_add_u32 v29, 147456, v25
    v_add_u32 v30, 147456, v26
    v_add_u32 v31, 147456, v27
    ds_read_b64_tr_b16 a[96:97], v28 offset:0
    ds_read_b64_tr_b16 a[104:105], v28 offset:8
    ds_read_b64_tr_b16 a[112:113], v29 offset:0
    ds_read_b64_tr_b16 a[120:121], v29 offset:8
    ds_read_b64_tr_b16 a[128:129], v30 offset:0
    ds_read_b64_tr_b16 a[136:137], v30 offset:8
    ds_read_b64_tr_b16 a[144:145], v31 offset:0
    ds_read_b64_tr_b16 v[32:33], v31 offset:8
    s_waitcnt vmcnt(12) lgkmcnt(0)
    s_barrier
    s_add_u32 m0, s43, 147456
    s_add_u32 s41, s58, 540672
    buffer_load_dwordx4 v17, s[8:11], s41 offen offset:0 nt lds
    s_add_u32 s41, s58, 572416
    buffer_load_dwordx4 v17, s[8:11], s41 offen offset:1024 nt lds
    s_add_u32 s41, s58, 669696
    buffer_load_dwordx4 v17, s[8:11], s41 offen offset:2048 nt lds
    s_add_u32 s41, s58, 701440
    buffer_load_dwordx4 v17, s[8:11], s41 offen offset:3072 nt lds
    ds_write_b64 v70, v[32:33] offset:12288
    v_add_u32 v28, 0, v24
    v_add_u32 v29, 0, v25
    v_add_u32 v30, 0, v26
    v_add_u32 v31, 0, v27
    ds_read_b64_tr_b16 a[98:99], v28 offset:0
    ds_read_b64_tr_b16 a[106:107], v28 offset:8
    ds_read_b64_tr_b16 a[114:115], v29 offset:0
    ds_read_b64_tr_b16 a[122:123], v29 offset:8
    ds_read_b64_tr_b16 a[130:131], v30 offset:0
    ds_read_b64_tr_b16 a[138:139], v30 offset:8
    ds_read_b64_tr_b16 a[146:147], v31 offset:0
    ds_read_b64_tr_b16 v[0:1], v31 offset:8
    s_waitcnt vmcnt(12) lgkmcnt(0)
    s_barrier
    s_add_u32 m0, s43, 0
    s_add_u32 s41, s58, 786432
    buffer_load_dwordx4 v17, s[8:11], s41 offen offset:0 nt lds
    s_add_u32 s41, s58, 818176
    buffer_load_dwordx4 v17, s[8:11], s41 offen offset:1024 nt lds
    s_add_u32 s41, s58, 915456
    buffer_load_dwordx4 v17, s[8:11], s41 offen offset:2048 nt lds
    s_add_u32 s41, s58, 947200
    buffer_load_dwordx4 v17, s[8:11], s41 offen offset:3072 nt lds
    ds_write_b64 v70, v[0:1] offset:12296
    v_add_u32 v28, 36864, v24
    v_add_u32 v29, 36864, v25
    v_add_u32 v30, 36864, v26
    v_add_u32 v31, 36864, v27
    ds_read_b64_tr_b16 a[100:101], v28 offset:0
    ds_read_b64_tr_b16 a[108:109], v28 offset:8
    ds_read_b64_tr_b16 a[116:117], v29 offset:0
    ds_read_b64_tr_b16 a[124:125], v29 offset:8
    ds_read_b64_tr_b16 a[132:133], v30 offset:0
    ds_read_b64_tr_b16 a[140:141], v30 offset:8
    ds_read_b64_tr_b16 a[148:149], v31 offset:0
    ds_read_b64_tr_b16 v[32:33], v31 offset:8
    s_waitcnt vmcnt(12) lgkmcnt(0)
    s_barrier
    s_add_u32 m0, s43, 36864
    s_add_u32 s41, s58, 802816
    buffer_load_dwordx4 v17, s[8:11], s41 offen offset:0 nt lds
    s_add_u32 s41, s58, 834560
    buffer_load_dwordx4 v17, s[8:11], s41 offen offset:1024 nt lds
    s_add_u32 s41, s58, 931840
    buffer_load_dwordx4 v17, s[8:11], s41 offen offset:2048 nt lds
    s_add_u32 s41, s58, 963584
    buffer_load_dwordx4 v17, s[8:11], s41 offen offset:3072 nt lds
    ds_write_b64 v70, v[32:33] offset:13312
    v_add_u32 v28, 73728, v24
    v_add_u32 v29, 73728, v25
    v_add_u32 v30, 73728, v26
    v_add_u32 v31, 73728, v27
    ds_read_b64_tr_b16 a[102:103], v28 offset:0
    ds_read_b64_tr_b16 a[110:111], v28 offset:8
    ds_read_b64_tr_b16 a[118:119], v29 offset:0
    ds_read_b64_tr_b16 a[126:127], v29 offset:8
    ds_read_b64_tr_b16 a[134:135], v30 offset:0
    ds_read_b64_tr_b16 a[142:143], v30 offset:8
    ds_read_b64_tr_b16 a[150:151], v31 offset:0
    ds_read_b64_tr_b16 v[0:1], v31 offset:8
    s_waitcnt vmcnt(12) lgkmcnt(0)
    s_barrier
    s_add_u32 m0, s43, 73728
    s_add_u32 s41, s59, 0
    buffer_load_dwordx4 v17, s[8:11], s41 offen offset:0 nt lds
    s_add_u32 s41, s59, 31744
    buffer_load_dwordx4 v17, s[8:11], s41 offen offset:1024 nt lds
    s_add_u32 s41, s59, 129024
    buffer_load_dwordx4 v17, s[8:11], s41 offen offset:2048 nt lds
    s_add_u32 s41, s59, 160768
    buffer_load_dwordx4 v17, s[8:11], s41 offen offset:3072 nt lds
    ds_write_b64 v70, v[0:1] offset:13320
    v_add_u32 v28, 110592, v24
    v_add_u32 v29, 110592, v25
    v_add_u32 v30, 110592, v26
    v_add_u32 v31, 110592, v27
    ds_read_b64_tr_b16 a[152:153], v28 offset:0
    ds_read_b64_tr_b16 a[160:161], v28 offset:8
    ds_read_b64_tr_b16 a[168:169], v29 offset:0
    ds_read_b64_tr_b16 a[176:177], v29 offset:8
    ds_read_b64_tr_b16 a[184:185], v30 offset:0
    ds_read_b64_tr_b16 a[192:193], v30 offset:8
    ds_read_b64_tr_b16 a[200:201], v31 offset:0
    ds_read_b64_tr_b16 a[208:209], v31 offset:8
    s_waitcnt vmcnt(12) lgkmcnt(0)
    s_barrier
    s_mov_b64 s[8:9], s[50:51]
    s_add_u32 m0, s43, 110592
    s_add_u32 s41, s58, 0
    buffer_load_dwordx4 v17, s[8:11], s41 offen offset:0 nt lds
    s_add_u32 s41, s58, 31744
    buffer_load_dwordx4 v17, s[8:11], s41 offen offset:1024 nt lds
    s_add_u32 s41, s58, 129024
    buffer_load_dwordx4 v17, s[8:11], s41 offen offset:2048 nt lds
    s_add_u32 s41, s58, 160768
    buffer_load_dwordx4 v17, s[8:11], s41 offen offset:3072 nt lds
    s_cmp_lg_u32 s13, 0
    s_cbranch_scc1 cf_ma
    v_mov_b32 v54, 1
    s_mov_b64 exec, 1
    buffer_atomic_add v54, off, s[84:87], 0 offset:132
    s_mov_b64 exec, -1
cf_ma:
    v_add_u32 v28, 147456, v24
    v_add_u32 v29, 147456, v25
    v_add_u32 v30, 147456, v26
    v_add_u32 v31, 147456, v27
    ds_read_b64_tr_b16 a[154:155], v28 offset:0
    ds_read_b64_tr_b16 a[162:163], v28 offset:8
    ds_read_b64_tr_b16 a[170:171], v29 offset:0
    ds_read_b64_tr_b16 a[178:179], v29 offset:8
    ds_read_b64_tr_b16 a[186:187], v30 offset:0
    ds_read_b64_tr_b16 a[194:195], v30 offset:8
    ds_read_b64_tr_b16 a[202:203], v31 offset:0
    ds_read_b64_tr_b16 a[210:211], v31 offset:8
    s_waitcnt vmcnt(12) lgkmcnt(0)
    s_barrier
    s_add_u32 m0, s43, 147456
    s_add_u32 s41, s58, 16384
    buffer_load_dwordx4 v17, s[8:11], s41 offen offset:0 nt lds
    s_add_u32 s41, s58, 48128
    buffer_load_dwordx4 v17, s[8:11], s41 offen offset:1024 nt lds
    s_add_u32 s41, s58, 145408
    buffer_load_dwordx4 v17, s[8:11], s41 offen offset:2048 nt lds
    s_add_u32 s41, s58, 177152
    buffer_load_dwordx4 v17, s[8:11], s41 offen offset:3072 nt lds
    v_add_u32 v28, 0, v24
    v_add_u32 v29, 0, v25
    v_add_u32 v30, 0, v26
    v_add_u32 v31, 0, v27
    ds_read_b64_tr_b16 a[156:157], v28 offset:0
    ds_read_b64_tr_b16 a[164:165], v28 offset:8
    ds_read_b64_tr_b16 a[172:173], v29 offset:0
    ds_read_b64_tr_b16 a[180:181], v29 offset:8
    ds_read_b64_tr_b16 a[188:189], v30 offset:0
    ds_read_b64_tr_b16 a[196:197], v30 offset:8
    ds_read_b64_tr_b16 a[204:205], v31 offset:0
    ds_read_b64_tr_b16 a[212:213], v31 offset:8
    s_waitcnt vmcnt(12) lgkmcnt(0)
    s_barrier
    s_add_u32 m0, s43, 0
    s_add_u32 s41, s58, 262144
    buffer_load_dwordx4 v17, s[8:11], s41 offen offset:0 nt lds
    s_add_u32 s41, s58, 293888
    buffer_load_dwordx4 v17, s[8:11], s41 offen offset:1024 nt lds
    s_add_u32 s41, s58, 391168
    buffer_load_dwordx4 v17, s[8:11], s41 offen offset:2048 nt lds
    s_add_u32 s41, s58, 422912
    buffer_load_dwordx4 v17, s[8:11], s41 offen offset:3072 nt lds
    v_add_u32 v28, 36864, v24
    v_add_u32 v29, 36864, v25
    v_add_u32 v30, 36864, v26
    v_add_u32 v31, 36864, v27
    ds_read_b64_tr_b16 a[158:159], v28 offset:0
    ds_read_b64_tr_b16 a[166:167], v28 offset:8
    ds_read_b64_tr_b16 a[174:175], v29 offset:0
    ds_read_b64_tr_b16 a[182:183], v29 offset:8
    ds_read_b64_tr_b16 a[190:191], v30 offset:0
    ds_read_b64_tr_b16 a[198:199], v30 offset:8
    ds_read_b64_tr_b16 a[206:207], v31 offset:0
    ds_read_b64_tr_b16 a[214:215], v31 offset:8
    s_waitcnt vmcnt(12) lgkmcnt(0)
    s_barrier
    s_add_u32 m0, s43, 36864
    s_add_u32 s41, s58, 278528
    buffer_load_dwordx4 v17, s[8:11], s41 offen offset:0 nt lds
    s_add_u32 s41, s58, 310272
    buffer_load_dwordx4 v17, s[8:11], s41 offen offset:1024 nt lds
    s_add_u32 s41, s58, 407552
    buffer_load_dwordx4 v17, s[8:11], s41 offen offset:2048 nt lds
    s_add_u32 s41, s58, 439296
    buffer_load_dwordx4 v17, s[8:11], s41 offen offset:3072 nt lds
    v_add_u32 v77, 73728, v20
    ds_read_b64_tr_b16 a[216:217], v77 offset:0
    ds_read_b64_tr_b16 a[218:219], v77 offset:4096
    ds_read_b64_tr_b16 a[220:221], v77 offset:8192
    ds_read_b64_tr_b16 a[222:223], v77 offset:12288
    ds_read_b64_tr_b16 a[224:225], v77 offset:8
    ds_read_b64_tr_b16 a[226:227], v77 offset:4104
    ds_read_b64_tr_b16 a[228:229], v77 offset:8200
    ds_read_b64_tr_b16 a[230:231], v77 offset:12296
    s_waitcnt vmcnt(12) lgkmcnt(0)
    s_barrier
    s_add_u32 m0, s43, 73728
    s_add_u32 s41, s58, 524288
    buffer_load_dwordx4 v17, s[8:11], s41 offen offset:0 nt lds
    s_add_u32 s41, s58, 556032
    buffer_load_dwordx4 v17, s[8:11], s41 offen offset:1024 nt lds
    s_add_u32 s41, s58, 653312
    buffer_load_dwordx4 v17, s[8:11], s41 offen offset:2048 nt lds
    s_add_u32 s41, s58, 685056
    buffer_load_dwordx4 v17, s[8:11], s41 offen offset:3072 nt lds
    v_add_u32 v28, 110592, v24
    v_add_u32 v29, 110592, v25
    v_add_u32 v30, 110592, v26
    v_add_u32 v31, 110592, v27
    ds_read_b64_tr_b16 v[0:1], v28 offset:0
    ds_read_b64_tr_b16 v[2:3], v28 offset:8
    ds_read_b64_tr_b16 v[4:5], v29 offset:0
    ds_read_b64_tr_b16 v[6:7], v29 offset:8
    ds_read_b64_tr_b16 a[0:1], v30 offset:0
    ds_read_b64_tr_b16 v[8:9], v30 offset:8
    ds_read_b64_tr_b16 a[8:9], v31 offset:0
    ds_read_b64_tr_b16 v[10:11], v31 offset:8
    s_waitcnt vmcnt(12) lgkmcnt(0)
    s_barrier
    s_add_u32 m0, s43, 110592
    s_add_u32 s41, s58, 540672
    buffer_load_dwordx4 v17, s[8:11], s41 offen offset:0 nt lds
    s_add_u32 s41, s58, 572416
    buffer_load_dwordx4 v17, s[8:11], s41 offen offset:1024 nt lds
    s_add_u32 s41, s58, 669696
    buffer_load_dwordx4 v17, s[8:11], s41 offen offset:2048 nt lds
    s_add_u32 s41, s58, 701440
    buffer_load_dwordx4 v17, s[8:11], s41 offen offset:3072 nt lds
    ds_write_b64 v70, v[0:1] offset:0
    ds_write_b64 v70, v[2:3] offset:2048
    ds_write_b64 v70, v[4:5] offset:4096
    ds_write_b64 v70, v[6:7] offset:6144
    ds_write_b64 v70, v[8:9] offset:10240
    ds_write_b64 v70, v[10:11] offset:14336
    v_add_u32 v28, 147456, v24
    v_add_u32 v29, 147456, v25
    v_add_u32 v30, 147456, v26
    v_add_u32 v31, 147456, v27
    ds_read_b64_tr_b16 v[32:33], v28 offset:0
    ds_read_b64_tr_b16 v[34:35], v28 offset:8
    ds_read_b64_tr_b16 v[36:37], v29 offset:0
    ds_read_b64_tr_b16 v[38:39], v29 offset:8
    ds_read_b64_tr_b16 a[2:3], v30 offset:0
    ds_read_b64_tr_b16 v[40:41], v30 offset:8
    ds_read_b64_tr_b16 a[10:11], v31 offset:0
    ds_read_b64_tr_b16 v[42:43], v31 offset:8
    s_waitcnt vmcnt(12) lgkmcnt(0)
    s_barrier
    s_add_u32 m0, s43, 147456
    s_add_u32 s41, s58, 786432
    buffer_load_dwordx4 v17, s[8:11], s41 offen offset:0 nt lds
    s_add_u32 s41, s58, 818176
    buffer_load_dwordx4 v17, s[8:11], s41 offen offset:1024 nt lds
    s_add_u32 s41, s58, 915456
    buffer_load_dwordx4 v17, s[8:11], s41 offen offset:2048 nt lds
    s_add_u32 s41, s58, 947200
    buffer_load_dwordx4 v17, s[8:11], s41 offen offset:3072 nt lds
    ds_write_b64 v70, v[32:33] offset:8
    ds_write_b64 v70, v[34:35] offset:2056
    ds_write_b64 v70, v[36:37] offset:4104
    ds_write_b64 v70, v[38:39] offset:6152
    ds_write_b64 v70, v[40:41] offset:10248
    ds_write_b64 v70, v[42:43] offset:14344
    v_add_u32 v28, 0, v24
    v_add_u32 v29, 0, v25
    v_add_u32 v30, 0, v26
    v_add_u32 v31, 0, v27
    ds_read_b64_tr_b16 v[0:1], v28 offset:0
    ds_read_b64_tr_b16 v[2:3], v28 offset:8
    ds_read_b64_tr_b16 v[4:5], v29 offset:0
    ds_read_b64_tr_b16 v[6:7], v29 offset:8
    ds_read_b64_tr_b16 a[4:5], v30 offset:0
    ds_read_b64_tr_b16 v[8:9], v30 offset:8
    ds_read_b64_tr_b16 a[12:13], v31 offset:0
    ds_read_b64_tr_b16 v[10:11], v31 offset:8
    s_waitcnt vmcnt(12) lgkmcnt(0)
    s_barrier
    s_add_u32 m0, s43, 0
    s_add_u32 s41, s58, 802816
    buffer_load_dwordx4 v17, s[8:11], s41 offen offset:0 nt lds
    s_add_u32 s41, s58, 834560
    buffer_load_dwordx4 v17, s[8:11], s41 offen offset:1024 nt lds
    s_add_u32 s41, s58, 931840
    buffer_load_dwordx4 v17, s[8:11], s41 offen offset:2048 nt lds
    s_add_u32 s41, s58, 963584
    buffer_load_dwordx4 v17, s[8:11], s41 offen offset:3072 nt lds
    ds_write_b64 v70, v[0:1] offset:1024
    ds_write_b64 v70, v[2:3] offset:3072
    ds_write_b64 v70, v[4:5] offset:5120
    ds_write_b64 v70, v[6:7] offset:7168
    ds_write_b64 v70, v[8:9] offset:11264
    ds_write_b64 v70, v[10:11] offset:15360
    v_add_u32 v28, 36864, v24
    v_add_u32 v29, 36864, v25
    v_add_u32 v30, 36864, v26
    v_add_u32 v31, 36864, v27
    ds_read_b64_tr_b16 v[32:33], v28 offset:0
    ds_read_b64_tr_b16 v[34:35], v28 offset:8
    ds_read_b64_tr_b16 v[36:37], v29 offset:0
    ds_read_b64_tr_b16 v[38:39], v29 offset:8
    ds_read_b64_tr_b16 a[6:7], v30 offset:0
    ds_read_b64_tr_b16 v[40:41], v30 offset:8
    ds_read_b64_tr_b16 a[14:15], v31 offset:0
    ds_read_b64_tr_b16 v[42:43], v31 offset:8
    s_waitcnt vmcnt(12) lgkmcnt(0)
    s_barrier
    s_add_u32 m0, s43, 36864
    s_add_u32 s41, s59, 0
    buffer_load_dwordx4 v17, s[8:11], s41 offen offset:0 nt lds
    s_add_u32 s41, s59, 31744
    buffer_load_dwordx4 v17, s[8:11], s41 offen offset:1024 nt lds
    s_add_u32 s41, s59, 129024
    buffer_load_dwordx4 v17, s[8:11], s41 offen offset:2048 nt lds
    s_add_u32 s41, s59, 160768
    buffer_load_dwordx4 v17, s[8:11], s41 offen offset:3072 nt lds
    ds_write_b64 v70, v[32:33] offset:1032
    ds_write_b64 v70, v[34:35] offset:3080
    ds_write_b64 v70, v[36:37] offset:5128
    ds_write_b64 v70, v[38:39] offset:7176
    ds_write_b64 v70, v[40:41] offset:11272
    ds_write_b64 v70, v[42:43] offset:15368
    v_add_u32 v28, 73728, v24
    v_add_u32 v29, 73728, v25
    v_add_u32 v30, 73728, v26
    v_add_u32 v31, 73728, v27
    ds_read_b64_tr_b16 a[16:17], v28 offset:0
    ds_read_b64_tr_b16 a[24:25], v28 offset:8
    ds_read_b64_tr_b16 a[32:33], v29 offset:0
    ds_read_b64_tr_b16 a[40:41], v29 offset:8
    ds_read_b64_tr_b16 a[48:49], v30 offset:0
    ds_read_b64_tr_b16 a[56:57], v30 offset:8
    ds_read_b64_tr_b16 a[64:65], v31 offset:0
    ds_read_b64_tr_b16 a[72:73], v31 offset:8
    s_waitcnt vmcnt(12) lgkmcnt(0)
    s_barrier
    s_mov_b64 s[8:9], s[54:55]
    s_add_u32 m0, s43, 73728
    s_add_u32 s41, s58, 0
    buffer_load_dwordx4 v17, s[8:11], s41 offen offset:0 nt lds
    s_add_u32 s41, s58, 31744
    buffer_load_dwordx4 v17, s[8:11], s41 offen offset:1024 nt lds
    s_add_u32 s41, s58, 129024
    buffer_load_dwordx4 v17, s[8:11], s41 offen offset:2048 nt lds
    s_add_u32 s41, s58, 160768
    buffer_load_dwordx4 v17, s[8:11], s41 offen offset:3072 nt lds
    v_add_u32 v28, 110592, v24
    v_add_u32 v29, 110592, v25
    v_add_u32 v30, 110592, v26
    v_add_u32 v31, 110592, v27
    ds_read_b64_tr_b16 a[18:19], v28 offset:0
    ds_read_b64_tr_b16 a[26:27], v28 offset:8
    ds_read_b64_tr_b16 a[34:35], v29 offset:0
    ds_read_b64_tr_b16 a[42:43], v29 offset:8
    ds_read_b64_tr_b16 a[50:51], v30 offset:0
    ds_read_b64_tr_b16 a[58:59], v30 offset:8
    ds_read_b64_tr_b16 a[66:67], v31 offset:0
    ds_read_b64_tr_b16 a[74:75], v31 offset:8
    s_waitcnt vmcnt(12) lgkmcnt(0)
    s_barrier
    s_add_u32 m0, s43, 110592
    s_add_u32 s41, s58, 16384
    buffer_load_dwordx4 v17, s[8:11], s41 offen offset:0 nt lds
    s_add_u32 s41, s58, 48128
    buffer_load_dwordx4 v17, s[8:11], s41 offen offset:1024 nt lds
    s_add_u32 s41, s58, 145408
    buffer_load_dwordx4 v17, s[8:11], s41 offen offset:2048 nt lds
    s_add_u32 s41, s58, 177152
    buffer_load_dwordx4 v17, s[8:11], s41 offen offset:3072 nt lds
    v_add_u32 v28, 147456, v24
    v_add_u32 v29, 147456, v25
    v_add_u32 v30, 147456, v26
    v_add_u32 v31, 147456, v27
    ds_read_b64_tr_b16 a[20:21], v28 offset:0
    ds_read_b64_tr_b16 a[28:29], v28 offset:8
    ds_read_b64_tr_b16 a[36:37], v29 offset:0
    ds_read_b64_tr_b16 a[44:45], v29 offset:8
    ds_read_b64_tr_b16 a[52:53], v30 offset:0
    ds_read_b64_tr_b16 a[60:61], v30 offset:8
    ds_read_b64_tr_b16 a[68:69], v31 offset:0
    ds_read_b64_tr_b16 a[76:77], v31 offset:8
    s_waitcnt vmcnt(12) lgkmcnt(0)
    s_barrier
    s_add_u32 m0, s43, 147456
    s_add_u32 s41, s58, 262144
    buffer_load_dwordx4 v17, s[8:11], s41 offen offset:0 nt lds
    s_add_u32 s41, s58, 293888
    buffer_load_dwordx4 v17, s[8:11], s41 offen offset:1024 nt lds
    s_add_u32 s41, s58, 391168
    buffer_load_dwordx4 v17, s[8:11], s41 offen offset:2048 nt lds
    s_add_u32 s41, s58, 422912
    buffer_load_dwordx4 v17, s[8:11], s41 offen offset:3072 nt lds
    v_add_u32 v28, 0, v24
    v_add_u32 v29, 0, v25
    v_add_u32 v30, 0, v26
    v_add_u32 v31, 0, v27
    ds_read_b64_tr_b16 a[22:23], v28 offset:0
    ds_read_b64_tr_b16 a[30:31], v28 offset:8
    ds_read_b64_tr_b16 a[38:39], v29 offset:0
    ds_read_b64_tr_b16 a[46:47], v29 offset:8
    ds_read_b64_tr_b16 a[54:55], v30 offset:0
    ds_read_b64_tr_b16 a[62:63], v30 offset:8
    ds_read_b64_tr_b16 a[70:71], v31 offset:0
    ds_read_b64_tr_b16 a[78:79], v31 offset:8
    s_waitcnt vmcnt(12) lgkmcnt(0)
    s_barrier
    s_add_u32 m0, s43, 0
    s_add_u32 s41, s58, 278528
    buffer_load_dwordx4 v17, s[8:11], s41 offen offset:0 nt lds
    s_add_u32 s41, s58, 310272
    buffer_load_dwordx4 v17, s[8:11], s41 offen offset:1024 nt lds
    s_add_u32 s41, s58, 407552
    buffer_load_dwordx4 v17, s[8:11], s41 offen offset:2048 nt lds
    s_add_u32 s41, s58, 439296
    buffer_load_dwordx4 v17, s[8:11], s41 offen offset:3072 nt lds
    s_lshl_b32 s26, s12, 14
    s_add_u32 s26, s26, 0
    s_mul_i32 s40, s13, 3072
    s_add_u32 s24, s26, s40
    s_add_u32 s26, s24, s33
    s_add_u32 s99, s26, 33030144
    s_lshl_b32 s96, s12, 7
    s_add_u32 s29, s96, 125845504
    s_add_u32 s96, s96, 125829120
    v_bfe_u32 v78, v65, 2, 5
    buffer_load_dword v54, off, s[84:87], 0 offset:132 sc1
    buffer_load_dword v55, off, s[84:87], 0 offset:216 sc1
    buffer_load_dword v56, v78, s[4:7], s96 offen offset:16 sc1
    v_add_u32 v77, 36864, v20
    ds_read_b64_tr_b16 a[80:81], v77 offset:0
    ds_read_b64_tr_b16 a[82:83], v77 offset:4096
    ds_read_b64_tr_b16 a[84:85], v77 offset:8192
    ds_read_b64_tr_b16 a[86:87], v77 offset:12288
    ds_read_b64_tr_b16 a[88:89], v77 offset:8
    ds_read_b64_tr_b16 a[90:91], v77 offset:4104
    ds_read_b64_tr_b16 a[92:93], v77 offset:8200
    ds_read_b64_tr_b16 a[94:95], v77 offset:12296
    s_waitcnt vmcnt(12) lgkmcnt(0)
    s_barrier
    s_add_u32 m0, s43, 36864
    s_add_u32 s41, s58, 524288
    buffer_load_dwordx4 v17, s[8:11], s41 offen offset:0 nt lds
    s_add_u32 s41, s58, 556032
    buffer_load_dwordx4 v17, s[8:11], s41 offen offset:1024 nt lds
    s_add_u32 s41, s58, 653312
    buffer_load_dwordx4 v17, s[8:11], s41 offen offset:2048 nt lds
    s_add_u32 s41, s58, 685056
    buffer_load_dwordx4 v17, s[8:11], s41 offen offset:3072 nt lds
    v_add_u32 v28, 73728, v24
    v_add_u32 v29, 73728, v25
    v_add_u32 v30, 73728, v26
    v_add_u32 v31, 73728, v27
    ds_read_b64_tr_b16 a[232:233], v28 offset:0
    ds_read_b64_tr_b16 v[32:33], v28 offset:8
    ds_read_b64_tr_b16 a[240:241], v29 offset:0
    ds_read_b64_tr_b16 a[248:249], v29 offset:8
    ds_read_b64_tr_b16 v[144:145], v30 offset:0
    ds_read_b64_tr_b16 v[152:153], v30 offset:8
    ds_read_b64_tr_b16 v[160:161], v31 offset:0
    ds_read_b64_tr_b16 v[168:169], v31 offset:8
    s_waitcnt vmcnt(12) lgkmcnt(0)
    s_barrier
    s_add_u32 m0, s43, 73728
    s_add_u32 s41, s58, 540672
    buffer_load_dwordx4 v17, s[8:11], s41 offen offset:0 nt lds
    s_add_u32 s41, s58, 572416
    buffer_load_dwordx4 v17, s[8:11], s41 offen offset:1024 nt lds
    s_add_u32 s41, s58, 669696
    buffer_load_dwordx4 v17, s[8:11], s41 offen offset:2048 nt lds
    s_add_u32 s41, s58, 701440
    buffer_load_dwordx4 v17, s[8:11], s41 offen offset:3072 nt lds
    ds_write_b64 v70, v[32:33] offset:8192
    v_add_u32 v28, 110592, v24
    v_add_u32 v29, 110592, v25
    v_add_u32 v30, 110592, v26
    v_add_u32 v31, 110592, v27
    ds_read_b64_tr_b16 a[234:235], v28 offset:0
    ds_read_b64_tr_b16 v[0:1], v28 offset:8
    ds_read_b64_tr_b16 a[242:243], v29 offset:0
    ds_read_b64_tr_b16 a[250:251], v29 offset:8
    ds_read_b64_tr_b16 v[146:147], v30 offset:0
    ds_read_b64_tr_b16 v[154:155], v30 offset:8
    ds_read_b64_tr_b16 v[162:163], v31 offset:0
    ds_read_b64_tr_b16 v[170:171], v31 offset:8
    s_waitcnt vmcnt(12) lgkmcnt(0)
    s_barrier
    s_add_u32 m0, s43, 110592
    s_add_u32 s41, s58, 786432
    buffer_load_dwordx4 v17, s[8:11], s41 offen offset:0 nt lds
    s_add_u32 s41, s58, 818176
    buffer_load_dwordx4 v17, s[8:11], s41 offen offset:1024 nt lds
    s_add_u32 s41, s58, 915456
    buffer_load_dwordx4 v17, s[8:11], s41 offen offset:2048 nt lds
    s_add_u32 s41, s58, 947200
    buffer_load_dwordx4 v17, s[8:11], s41 offen offset:3072 nt lds
    ds_write_b64 v70, v[0:1] offset:8200
    v_add_u32 v28, 147456, v24
    v_add_u32 v29, 147456, v25
    v_add_u32 v30, 147456, v26
    v_add_u32 v31, 147456, v27
    ds_read_b64_tr_b16 a[236:237], v28 offset:0
    ds_read_b64_tr_b16 v[32:33], v28 offset:8
    ds_read_b64_tr_b16 a[244:245], v29 offset:0
    ds_read_b64_tr_b16 a[252:253], v29 offset:8
    ds_read_b64_tr_b16 v[148:149], v30 offset:0
    ds_read_b64_tr_b16 v[156:157], v30 offset:8
    ds_read_b64_tr_b16 v[164:165], v31 offset:0
    ds_read_b64_tr_b16 v[172:173], v31 offset:8
    s_waitcnt vmcnt(12) lgkmcnt(0)
    s_barrier
    s_add_u32 m0, s43, 147456
    s_add_u32 s41, s58, 802816
    buffer_load_dwordx4 v17, s[8:11], s41 offen offset:0 nt lds
    s_add_u32 s41, s58, 834560
    buffer_load_dwordx4 v17, s[8:11], s41 offen offset:1024 nt lds
    s_add_u32 s41, s58, 931840
    buffer_load_dwordx4 v17, s[8:11], s41 offen offset:2048 nt lds
    s_add_u32 s41, s58, 963584
    buffer_load_dwordx4 v17, s[8:11], s41 offen offset:3072 nt lds
    ds_write_b64 v70, v[32:33] offset:9216
    v_add_u32 v28, 0, v24
    v_add_u32 v29, 0, v25
    v_add_u32 v30, 0, v26
    v_add_u32 v31, 0, v27
    ds_read_b64_tr_b16 a[238:239], v28 offset:0
    ds_read_b64_tr_b16 v[0:1], v28 offset:8
    ds_read_b64_tr_b16 a[246:247], v29 offset:0
    ds_read_b64_tr_b16 a[254:255], v29 offset:8
    ds_read_b64_tr_b16 v[150:151], v30 offset:0
    ds_read_b64_tr_b16 v[158:159], v30 offset:8
    ds_read_b64_tr_b16 v[166:167], v31 offset:0
    ds_read_b64_tr_b16 v[174:175], v31 offset:8
    s_waitcnt vmcnt(12) lgkmcnt(0)
    s_barrier
    s_add_u32 m0, s43, 0
    s_add_u32 s41, s59, 0
    buffer_load_dwordx4 v17, s[8:11], s41 offen offset:0 nt lds
    s_add_u32 s41, s59, 31744
    buffer_load_dwordx4 v17, s[8:11], s41 offen offset:1024 nt lds
    s_add_u32 s41, s59, 129024
    buffer_load_dwordx4 v17, s[8:11], s41 offen offset:2048 nt lds
    s_add_u32 s41, s59, 160768
    buffer_load_dwordx4 v17, s[8:11], s41 offen offset:3072 nt lds
    v_readfirstlane_b32 s94, v54
    v_readfirstlane_b32 s95, v55
    v_mov_b32 v77, v56
    s_nop 0
    v_subrev_u32 v77, s95, v77
    v_cmp_lt_u32 vcc, 16, v77
    s_nop 1
    v_cndmask_b32 v77, v77, 0, vcc
    v_bfe_u32 v79, v78, 2, 2
    v_lshl_add_u32 v77, v77, 2, v79
    s_nop 1
    v_min_u32_dpp v77, v77, v77 row_ror:1 row_mask:0xf bank_mask:0xf
    s_nop 1
    v_min_u32_dpp v77, v77, v77 row_ror:2 row_mask:0xf bank_mask:0xf
    s_nop 1
    v_min_u32_dpp v77, v77, v77 row_ror:4 row_mask:0xf bank_mask:0xf
    s_nop 0
    v_readfirstlane_b32 s97, v77
    s_cmp_eq_u32 s95, 0
    s_cselect_b32 s97, 0, s97
    s_cmp_lt_u32 s97, 3
    s_cbranch_scc1 cf_mb
    s_add_u32 s40, s26, 0
    s_min_u32 s40, s40, s99
    s_sub_u32 s41, s96, s40
    v_bfe_u32 v77, v65, 2, 5
    v_add3_u32 v77, v77, s41, 16
    v_lshlrev_b32 v78, 3, v69
    s_nop 0
    v_mov_b32_dpp v78, v77 quad_perm:[0,1,2,3] row_mask:0xc bank_mask:0xf
    buffer_load_dword v58, v78, s[4:7], s40 offen sc1
    s_add_u32 s40, s26, 524288
    s_min_u32 s40, s40, s99
    s_sub_u32 s41, s96, s40
    v_bfe_u32 v77, v65, 2, 5
    v_add3_u32 v77, v77, s41, 16
    v_lshlrev_b32 v78, 3, v69
    s_nop 0
    v_mov_b32_dpp v78, v77 quad_perm:[0,1,2,3] row_mask:0xc bank_mask:0xf
    buffer_load_dword v58, v78, s[4:7], s40 offen sc1
cf_mb:
    s_cmp_lt_u32 s94, 32
    s_cbranch_scc1 cf_mc
    s_cmp_lg_u32 s13, 0
    s_cbranch_scc1 cf_mc
    v_mov_b32 v76, 1
    v_mov_b32 v77, 0
    s_mov_b64 exec, 1
    buffer_atomic_cmpswap v[76:77], off, s[84:87], 0 offset:28 sc0
    s_mov_b64 exec, -1
cf_mc:
    s_nop 1
    ds_write_b64 v70, v[0:1] offset:9224
    v_add_u32 v28, 36864, v24
    v_add_u32 v29, 36864, v25
    v_add_u32 v30, 36864, v26
    v_add_u32 v31, 36864, v27
    ds_read_b64_tr_b16 v[176:177], v28 offset:0
    ds_read_b64_tr_b16 v[184:185], v28 offset:8
    ds_read_b64_tr_b16 v[192:193], v29 offset:0
    ds_read_b64_tr_b16 v[200:201], v29 offset:8
    ds_read_b64_tr_b16 v[208:209], v30 offset:0
    ds_read_b64_tr_b16 v[216:217], v30 offset:8
    ds_read_b64_tr_b16 v[224:225], v31 offset:0
    ds_read_b64_tr_b16 v[232:233], v31 offset:8
    s_waitcnt vmcnt(12) lgkmcnt(0)
    s_barrier
    s_mov_b64 s[8:9], s[56:57]
    s_add_u32 m0, s43, 36864
    s_add_u32 s41, s60, 128
    buffer_load_dwordx4 v18, s[8:11], s41 offen offset:0 nt lds
    s_add_u32 s41, s60, 8320
    buffer_load_dwordx4 v18, s[8:11], s41 offen offset:1024 nt lds
    s_add_u32 s41, s60, 16512
    buffer_load_dwordx4 v18, s[8:11], s41 offen offset:2048 nt lds
    s_add_u32 s41, s60, 24704
    buffer_load_dwordx4 v18, s[8:11], s41 offen offset:3072 nt lds
    v_add_u32 v28, 73728, v24
    v_add_u32 v29, 73728, v25
    v_add_u32 v30, 73728, v26
    v_add_u32 v31, 73728, v27
    ds_read_b64_tr_b16 v[178:179], v28 offset:0
    ds_read_b64_tr_b16 v[186:187], v28 offset:8
    ds_read_b64_tr_b16 v[194:195], v29 offset:0
    ds_read_b64_tr_b16 v[202:203], v29 offset:8
    ds_read_b64_tr_b16 v[210:211], v30 offset:0
    ds_read_b64_tr_b16 v[218:219], v30 offset:8
    ds_read_b64_tr_b16 v[226:227], v31 offset:0
    ds_read_b64_tr_b16 v[234:235], v31 offset:8
    s_waitcnt vmcnt(12) lgkmcnt(0)
    s_barrier
    s_add_u32 m0, s43, 73728
    s_add_u32 s41, s61, 128
    buffer_load_dwordx4 v18, s[8:11], s41 offen offset:0 nt lds
    s_add_u32 s41, s61, 8320
    buffer_load_dwordx4 v18, s[8:11], s41 offen offset:1024 nt lds
    s_add_u32 s41, s61, 16512
    buffer_load_dwordx4 v18, s[8:11], s41 offen offset:2048 nt lds
    s_add_u32 s41, s61, 24704
    buffer_load_dwordx4 v18, s[8:11], s41 offen offset:3072 nt lds
    v_add_u32 v28, 110592, v24
    v_add_u32 v29, 110592, v25
    v_add_u32 v30, 110592, v26
    v_add_u32 v31, 110592, v27
    ds_read_b64_tr_b16 v[180:181], v28 offset:0
    ds_read_b64_tr_b16 v[188:189], v28 offset:8
    ds_read_b64_tr_b16 v[196:197], v29 offset:0
    ds_read_b64_tr_b16 v[204:205], v29 offset:8
    ds_read_b64_tr_b16 v[212:213], v30 offset:0
    ds_read_b64_tr_b16 v[220:221], v30 offset:8
    ds_read_b64_tr_b16 v[228:229], v31 offset:0
    ds_read_b64_tr_b16 v[236:237], v31 offset:8
    s_waitcnt vmcnt(12) lgkmcnt(0)
    s_barrier
    s_add_u32 m0, s43, 110592
    s_add_u32 s41, s62, 128
    buffer_load_dwordx4 v18, s[8:11], s41 offen offset:0 nt lds
    s_add_u32 s41, s62, 8320
    buffer_load_dwordx4 v18, s[8:11], s41 offen offset:1024 nt lds
    s_add_u32 s41, s62, 16512
    buffer_load_dwordx4 v18, s[8:11], s41 offen offset:2048 nt lds
    s_add_u32 s41, s62, 24704
    buffer_load_dwordx4 v18, s[8:11], s41 offen offset:3072 nt lds
    v_add_u32 v28, 147456, v24
    v_add_u32 v29, 147456, v25
    v_add_u32 v30, 147456, v26
    v_add_u32 v31, 147456, v27
    ds_read_b64_tr_b16 v[182:183], v28 offset:0
    ds_read_b64_tr_b16 v[190:191], v28 offset:8
    ds_read_b64_tr_b16 v[198:199], v29 offset:0
    ds_read_b64_tr_b16 v[206:207], v29 offset:8
    ds_read_b64_tr_b16 v[214:215], v30 offset:0
    ds_read_b64_tr_b16 v[222:223], v30 offset:8
    ds_read_b64_tr_b16 v[230:231], v31 offset:0
    ds_read_b64_tr_b16 v[238:239], v31 offset:8
    s_waitcnt vmcnt(12) lgkmcnt(0)
    s_barrier
    s_add_u32 m0, s43, 147456
    s_add_u32 s41, s63, 128
    buffer_load_dwordx4 v18, s[8:11], s41 offen offset:0 nt lds
    s_add_u32 s41, s63, 8320
    buffer_load_dwordx4 v18, s[8:11], s41 offen offset:1024 nt lds
    s_add_u32 s41, s63, 16512
    buffer_load_dwordx4 v18, s[8:11], s41 offen offset:2048 nt lds
    s_add_u32 s41, s63, 24704
    buffer_load_dwordx4 v18, s[8:11], s41 offen offset:3072 nt lds
    v_mov_b32 v78, v21
    v_mov_b32 v79, v22
    v_add_u32 v77, 0, v20
    ds_read_b64_tr_b16 v[240:241], v77 offset:0
    ds_read_b64_tr_b16 v[242:243], v77 offset:4096
    ds_read_b64_tr_b16 v[244:245], v77 offset:8192
    ds_read_b64_tr_b16 v[246:247], v77 offset:12288
    ds_read_b64_tr_b16 v[248:249], v77 offset:8
    ds_read_b64_tr_b16 v[250:251], v77 offset:4104
    ds_read_b64_tr_b16 v[252:253], v77 offset:8200
    ds_read_b64_tr_b16 v[254:255], v77 offset:12296
    s_waitcnt vmcnt(12) lgkmcnt(0)
    s_barrier
    v_bfe_u32 v60, v65, 4, 6
    v_and_b32 v61, 15, v60
    v_lshrrev_b32 v62, 4, v60
    v_mov_b32 v50, 0x3f80
    v_mov_b32 v51, 0x3f800000
    v_and_b32 v57, 1, v62
    v_lshlrev_b32 v57, 2, v57
    v_sub_u32 v57, v61, v57
    v_and_b32 v58, 3, v61
    v_lshlrev_b32 v58, 2, v58
    v_lshrrev_b32 v59, 2, v61
    v_add_u32 v58, v58, v59
    v_cmp_eq_u32 vcc, 0, v57
    s_nop 1
    v_cndmask_b32 v40, 0, v50, vcc
    v_cmp_eq_u32 vcc, 1, v57
    s_nop 1
    v_cndmask_b32 v40, v40, v51, vcc
    v_cmp_eq_u32 vcc, 0, v58
    s_nop 1
    v_cndmask_b32 v44, 0, v50, vcc
    v_cmp_eq_u32 vcc, 1, v58
    s_nop 1
    v_cndmask_b32 v44, v44, v51, vcc
    v_cmp_eq_u32 vcc, 2, v57
    s_nop 1
    v_cndmask_b32 v41, 0, v50, vcc
    v_cmp_eq_u32 vcc, 3, v57
    s_nop 1
    v_cndmask_b32 v41, v41, v51, vcc
    v_cmp_eq_u32 vcc, 2, v58
    s_nop 1
    v_cndmask_b32 v45, 0, v50, vcc
    v_cmp_eq_u32 vcc, 3, v58
    s_nop 1
    v_cndmask_b32 v45, v45, v51, vcc
    v_cmp_eq_u32 vcc, 8, v57
    s_nop 1
    v_cndmask_b32 v42, 0, v50, vcc
    v_cmp_eq_u32 vcc, 9, v57
    s_nop 1
    v_cndmask_b32 v42, v42, v51, vcc
    v_cmp_eq_u32 vcc, 4, v58
    s_nop 1
    v_cndmask_b32 v46, 0, v50, vcc
    v_cmp_eq_u32 vcc, 5, v58
    s_nop 1
    v_cndmask_b32 v46, v46, v51, vcc
    v_cmp_eq_u32 vcc, 10, v57
    s_nop 1
    v_cndmask_b32 v43, 0, v50, vcc
    v_cmp_eq_u32 vcc, 11, v57
    s_nop 1
    v_cndmask_b32 v43, v43, v51, vcc
    v_cmp_eq_u32 vcc, 6, v58
    s_nop 1
    v_cndmask_b32 v47, 0, v50, vcc
    v_cmp_eq_u32 vcc, 7, v58
    s_nop 1
    v_cndmask_b32 v47, v47, v51, vcc
    v_lshlrev_b32 v57, 4, v61
    ds_write_b128 v69, v[40:43] offset:15360
    ds_write_b128 v57, v[44:47] offset:15872
    v_add_u32 v77, 36864, v79
    s_waitcnt lgkmcnt(0)
    ds_read_b64_tr_b16 v[0:1], v77 offset:0
    ds_read_b64_tr_b16 v[2:3], v77 offset:256
    ds_read_b64_tr_b16 v[4:5], v77 offset:2048
    ds_read_b64_tr_b16 v[6:7], v77 offset:2304
    ds_read_b64_tr_b16 v[8:9], v77 offset:16
    ds_read_b64_tr_b16 v[10:11], v77 offset:272
    ds_read_b64_tr_b16 v[12:13], v77 offset:2064
    ds_read_b64_tr_b16 v[14:15], v77 offset:2320
    s_waitcnt vmcnt(8) lgkmcnt(0)
    s_barrier
    s_mov_b32 s44, 0x3e0293ee
    s_mov_b32 s45, s44
    s_or_b32 s66, s44, 0x80000000
    s_mov_b32 s48, 0x3f003f00
    s_mov_b32 s49, 0
    s_mov_b32 s50, 0x3f803f80
    s_mov_b32 s51, 0x3f803f80
    s_mov_b32 s52, 512
    s_mov_b32 s53, 1024
    s_mov_b32 s54, 1536
    s_mov_b32 s30, 0
    s_mov_b32 s37, 0
    s_mov_b32 s98, -100
    s_lshl_b32 s47, s13, 9
    s_cmp_lg_u32 s32, 0
    s_cselect_b32 s71, s13, 3
    s_add_u32 s46, s71, 1
    s_lshr_b32 s46, s46, 1
    s_mov_b32 s14, 67125248
    s_mov_b32 s15, 67129344
    s_mov_b32 s16, 67133440
    s_mov_b32 s36, 0
    s_add_u32 s17, s68, 67108864
    s_mov_b32 s69, 0
    s_mov_b32 s70, 0
    s_lshl_b32 s26, s12, 14
    s_add_u32 s26, s26, 0
    s_mul_i32 s40, s13, 3072
    s_add_u32 s24, s26, s40
    s_add_u32 s26, s24, s33
    s_add_u32 s99, s26, 33030144
    s_lshl_b32 s96, s12, 7
    s_add_u32 s29, s96, 125845504
    s_add_u32 s96, s96, 125829120
    s_lshl_b32 s40, s12, 14
    s_add_u32 s40, s40, 68157440
    s_add_u32 s18, s40, 0
    s_add_u32 s19, s40, 4096
    s_add_u32 s20, s40, 8192
    s_add_u32 s21, s40, 12288
    s_lshr_b32 s40, s12, 3
    s_lshl_b32 s40, s40, 12
    s_and_b32 s41, s12, 7
    s_lshl_b32 s41, s41, 7
    s_add_u32 s40, s40, s41
    s_add_u32 s22, s40, 68157440
    s_add_u32 s23, s22, 1024
    s_add_u32 s25, s22, 2048
    s_mov_b32 s56, -65472
    s_cmp_lg_u32 s32, 0
    s_cselect_b64 s[38:39], -1, 0
    s_add_u32 s55, s68, 138412032
    s_cmp_eq_u32 s13, 3
    s_cselect_b64 s[100:101], 1, 0
    s_cselect_b64 s[38:39], 1, s[38:39]
    s_cselect_b32 s93, 64, 0
    s_cselect_b32 s55, s29, s55
    s_cselect_b32 s57, 0, 9216
    s_mov_b32 s34, 0xff00ff00
    s_mov_b32 s35, 0xff00ff00
    s_lshl_b32 s28, s12, 12
    s_add_u32 s28, s28, 7340032
    s_add_u32 s27, s28, 77594624
    s_add_u32 s28, s28, 69206016
    v_add_u32 v77, 73728, v78
    ds_read_b64_tr_b16 v[16:17], v77 offset:0
    ds_read_b64_tr_b16 v[18:19], v77 offset:256
    ds_read_b64_tr_b16 v[20:21], v77 offset:2048
    ds_read_b64_tr_b16 v[22:23], v77 offset:2304
    ds_read_b64_tr_b16 v[24:25], v77 offset:16
    ds_read_b64_tr_b16 v[26:27], v77 offset:272
    ds_read_b64_tr_b16 v[28:29], v77 offset:2064
    ds_read_b64_tr_b16 v[30:31], v77 offset:2320
    s_waitcnt vmcnt(4) lgkmcnt(0)
    s_barrier
    v_add_u32 v77, 110592, v78
    ds_read_b64_tr_b16 v[32:33], v77 offset:0
    ds_read_b64_tr_b16 v[34:35], v77 offset:256
    ds_read_b64_tr_b16 v[36:37], v77 offset:2048
    ds_read_b64_tr_b16 v[38:39], v77 offset:2304
    ds_read_b64_tr_b16 v[40:41], v77 offset:16
    ds_read_b64_tr_b16 v[42:43], v77 offset:272
    ds_read_b64_tr_b16 v[44:45], v77 offset:2064
    ds_read_b64_tr_b16 v[46:47], v77 offset:2320
    s_waitcnt vmcnt(0) lgkmcnt(0)
    s_barrier
    v_add_u32 v77, 147456, v78
    ds_read_b64_tr_b16 v[48:49], v77 offset:0
    ds_read_b64_tr_b16 v[50:51], v77 offset:256
    ds_read_b64_tr_b16 v[52:53], v77 offset:2048
    ds_read_b64_tr_b16 v[54:55], v77 offset:2304
    ds_read_b64_tr_b16 v[56:57], v77 offset:16
    ds_read_b64_tr_b16 v[58:59], v77 offset:272
    ds_read_b64_tr_b16 v[60:61], v77 offset:2064
    ds_read_b64_tr_b16 v[62:63], v77 offset:2320
    s_waitcnt lgkmcnt(0)
    s_barrier
    ds_write_b128 v70, v[0:3] offset:20480
    ds_write_b128 v70, v[4:7] offset:21504
    ds_write_b128 v70, v[8:11] offset:22528
    ds_write_b128 v70, v[12:15] offset:23552
    ds_write_b128 v70, v[16:19] offset:24576
    ds_write_b128 v70, v[20:23] offset:25600
    ds_write_b128 v70, v[24:27] offset:26624
    ds_write_b128 v70, v[28:31] offset:27648
    ds_write_b128 v70, v[32:35] offset:28672
    ds_write_b128 v70, v[36:39] offset:29696
    ds_write_b128 v70, v[40:43] offset:30720
    ds_write_b128 v70, v[44:47] offset:31744
    ds_write_b128 v70, v[48:51] offset:32768
    ds_write_b128 v70, v[52:55] offset:33792
    ds_write_b128 v70, v[56:59] offset:34816
    ds_write_b128 v70, v[60:63] offset:35840
    s_waitcnt vmcnt(0) lgkmcnt(0)
    s_cmp_lg_u32 s95, 0
    s_cbranch_scc1 cf_hn
    s_mov_b32 s88, 4194304
gn2:
    buffer_load_dword v2, off, s[84:87], 0 offset:216 sc1
    s_waitcnt vmcnt(0)
    v_readfirstlane_b32 s95, v2
    s_sub_u32 s88, s88, 1
    s_cbranch_scc1 gn2x
    s_cmp_eq_u32 s95, 0
    s_cbranch_scc1 gn2
gn2x:
cf_hn:
    v_mov_b32 v2, 1
    s_cmp_lg_u32 s13, 0
    s_cbranch_scc1 cf_noarr
    s_mov_b64 exec, 1
    s_mov_b32 s42, 1
    v_mov_b32 v4, v76
    s_cmp_ge_u32 s94, 32
    s_cbranch_scc1 cf_have
    s_mov_b32 s40, 131072
    s_mov_b32 s42, 2
cf_startpoll:
    buffer_load_dword v3, off, s[84:87], 0 offset:132 sc1
    s_sub_u32 s40, s40, 1
    s_cbranch_scc1 cf_decide
    s_waitcnt vmcnt(0)
    v_readfirstlane_b32 s41, v3
    s_nop 1
    s_cmp_lt_u32 s41, 32
    s_cbranch_scc1 cf_startpoll
    s_mov_b32 s42, 1
cf_decide:
    v_mov_b32 v4, s42
    v_mov_b32 v5, 0
    buffer_atomic_cmpswap v[4:5], off, s[84:87], 0 offset:28 sc0
    s_waitcnt vmcnt(0)
cf_have:
    v_mov_b32 v5, s42
    v_cmp_eq_u32 vcc, 0, v4
    s_nop 1
    v_cndmask_b32 v4, v4, v5, vcc
    v_mov_b32 v5, 16192
    ds_write_b32 v5, v4
    s_waitcnt lgkmcnt(0)
    s_mov_b64 exec, -1
cf_noarr:
    s_barrier
    v_mov_b32 v5, 16192
    ds_read_b32 v4, v5
    s_waitcnt lgkmcnt(0)
    v_readfirstlane_b32 s41, v4
    s_nop 1
    s_cmp_eq_u32 s41, 1
    s_cbranch_scc1 cf_run
    v_lshrrev_b32 v0, 4, v65
    s_mov_b32 s32, s13
    s_load_dwordx16 s[48:63], s[0:1], 0
    s_waitcnt lgkmcnt(0)
    s_branch L_helper
cf_run:
    s_mov_b64 exec, s[100:101]
    v_mov_b32 v72, s95
    s_mov_b64 exec, -1
    s_cmp_ge_u32 s97, 3
    s_cbranch_scc1 cf_kvdone
    s_mov_b32 s40, 3
    v_bfe_u32 v78, v65, 2, 5
    s_mov_b32 s31, 4194304
cf_kv0:
    buffer_load_dword v77, v78, s[4:7], s96 offen offset:16 sc1
    s_waitcnt vmcnt(0)
    v_subrev_u32 v77, s95, v77
    v_cmp_lt_u32 vcc, 16, v77
    s_nop 1
    v_cndmask_b32 v77, v77, 0, vcc
    v_bfe_u32 v79, v78, 2, 2
    v_lshl_add_u32 v77, v77, 2, v79
    s_nop 1
    v_min_u32_dpp v77, v77, v77 row_ror:1 row_mask:0xf bank_mask:0xf
    s_nop 1
    v_min_u32_dpp v77, v77, v77 row_ror:2 row_mask:0xf bank_mask:0xf
    s_nop 1
    v_min_u32_dpp v77, v77, v77 row_ror:4 row_mask:0xf bank_mask:0xf
    s_nop 0
    v_readfirstlane_b32 s97, v77
    s_sub_u32 s31, s31, 1
    s_cbranch_scc1 cf_kv0_x
    s_cmp_le_u32 s40, s97
    s_cbranch_scc1 cf_kv0_x
    s_sleep 2
    s_branch cf_kv0
cf_kv0_x:
    s_add_u32 s40, s26, 0
    s_min_u32 s40, s40, s99
    s_sub_u32 s41, s96, s40
    v_bfe_u32 v77, v65, 2, 5
    v_add3_u32 v77, v77, s41, 16
    v_lshlrev_b32 v78, 3, v69
    s_nop 0
    v_mov_b32_dpp v78, v77 quad_perm:[0,1,2,3] row_mask:0xc bank_mask:0xf
    buffer_load_dword v76, v78, s[4:7], s40 offen sc1
    s_add_u32 s40, s26, 524288
    s_min_u32 s40, s40, s99
    s_sub_u32 s41, s96, s40
    v_bfe_u32 v77, v65, 2, 5
    v_add3_u32 v77, v77, s41, 16
    v_lshlrev_b32 v78, 3, v69
    s_nop 0
    v_mov_b32_dpp v78, v77 quad_perm:[0,1,2,3] row_mask:0xc bank_mask:0xf
    buffer_load_dword v76, v78, s[4:7], s40 offen sc1
cf_kvdone:
    v_mov_b64 v[0:1], 0
    v_mov_b64 v[2:3], 0
    v_mov_b64 v[4:5], 0
    v_mov_b64 v[6:7], 0
    v_mov_b64 v[8:9], 0
    v_mov_b64 v[10:11], 0
    v_mov_b64 v[12:13], 0
    v_mov_b64 v[14:15], 0
    v_mov_b64 v[16:17], 0
    v_mov_b64 v[18:19], 0
    v_mov_b64 v[20:21], 0
    v_mov_b64 v[22:23], 0
    ds_read_b128 v[44:47], v70 offset:0
    ds_read_b128 v[48:51], v70 offset:1024
    ds_read_b128 v[52:55], v70 offset:2048
    ds_read_b128 v[56:59], v70 offset:3072
    ds_read_b128 v[24:27], v70 offset:4096
    ds_read_b128 v[28:31], v70 offset:5120
    ds_read_b128 v[32:35], v70 offset:6144
    ds_read_b128 v[36:39], v70 offset:7168
    buffer_load_dwordx4 v[40:43], v65, s[4:7], s14 offen offset:0 nt
    buffer_load_dwordx4 v[60:63], v66, s[4:7], s14 offen offset:0 nt
    s_mov_b32 s31, 1048576
    s_waitcnt vmcnt(0) lgkmcnt(0)
    s_branch cf_goA
cf_loop:
    s_mov_b32 s31, 1048576
    s_mov_b32 s69, s70
    s_waitcnt lgkmcnt(0)
cf_cA:
    buffer_load_dwordx4 v[40:43], v65, s[4:7], s14 offen offset:0 nt
    buffer_load_dwordx4 v[60:63], v66, s[4:7], s14 offen offset:0 nt
cf_cA1:
    v_bitop3_b32 v77, v40, v60, s70 bitop3:0x7e
    v_and_b32 v77, 1, v77
    v_cmp_ne_u32 vcc, 0, v77
    s_cbranch_vccz cf_goA
    v_bitop3_b32 v77, v40, v60, s70 bitop3:0x7e
    v_and_b32 v77, 1, v77
    v_cmp_ne_u32 vcc, 0, v77
    s_cbranch_vccz cf_goA
    v_bitop3_b32 v77, v40, v60, s70 bitop3:0x7e
    v_and_b32 v77, 1, v77
    v_cmp_ne_u32 vcc, 0, v77
    s_cbranch_vccz cf_goA
    v_bitop3_b32 v77, v40, v60, s70 bitop3:0x7e
    v_and_b32 v77, 1, v77
    v_cmp_ne_u32 vcc, 0, v77
    s_cbranch_vccz cf_goA
    buffer_load_dwordx4 v[40:43], v65, s[4:7], s14 offen offset:0 nt
    buffer_load_dwordx4 v[60:63], v66, s[4:7], s14 offen offset:0 nt
    v_bitop3_b32 v77, v40, v60, s70 bitop3:0x7e
    v_and_b32 v77, 1, v77
    v_cmp_ne_u32 vcc, 0, v77
    s_cbranch_vccz cf_goA
    v_bitop3_b32 v77, v40, v60, s70 bitop3:0x7e
    v_and_b32 v77, 1, v77
    v_cmp_ne_u32 vcc, 0, v77
    s_cbranch_vccz cf_goA
    v_bitop3_b32 v77, v40, v60, s70 bitop3:0x7e
    v_and_b32 v77, 1, v77
    v_cmp_ne_u32 vcc, 0, v77
    s_cbranch_vccz cf_goA
    v_bitop3_b32 v77, v40, v60, s70 bitop3:0x7e
    v_and_b32 v77, 1, v77
    v_cmp_ne_u32 vcc, 0, v77
    s_cbranch_vccz cf_goA
    buffer_load_dwordx4 v[40:43], v65, s[4:7], s14 offen offset:0 nt
    buffer_load_dwordx4 v[60:63], v66, s[4:7], s14 offen offset:0 nt
    v_bitop3_b32 v77, v40, v60, s70 bitop3:0x7e
    v_and_b32 v77, 1, v77
    v_cmp_ne_u32 vcc, 0, v77
    s_cbranch_vccz cf_goA
    v_bitop3_b32 v77, v40, v60, s70 bitop3:0x7e
    v_and_b32 v77, 1, v77
    v_cmp_ne_u32 vcc, 0, v77
    s_cbranch_vccz cf_goA
    v_bitop3_b32 v77, v40, v60, s70 bitop3:0x7e
    v_and_b32 v77, 1, v77
    v_cmp_ne_u32 vcc, 0, v77
    s_cbranch_vccz cf_goA
    v_bitop3_b32 v77, v40, v60, s70 bitop3:0x7e
    v_and_b32 v77, 1, v77
    v_cmp_ne_u32 vcc, 0, v77
    s_cbranch_vccz cf_goA
    buffer_load_dwordx4 v[40:43], v65, s[4:7], s14 offen offset:0 nt
    buffer_load_dwordx4 v[60:63], v66, s[4:7], s14 offen offset:0 nt
    v_bitop3_b32 v77, v40, v60, s70 bitop3:0x7e
    v_and_b32 v77, 1, v77
    v_cmp_ne_u32 vcc, 0, v77
    s_cbranch_vccz cf_goA
    v_bitop3_b32 v77, v40, v60, s70 bitop3:0x7e
    v_and_b32 v77, 1, v77
    v_cmp_ne_u32 vcc, 0, v77
    s_cbranch_vccz cf_goA
    v_bitop3_b32 v77, v40, v60, s70 bitop3:0x7e
    v_and_b32 v77, 1, v77
    v_cmp_ne_u32 vcc, 0, v77
    s_cbranch_vccz cf_goA
    v_bitop3_b32 v77, v40, v60, s70 bitop3:0x7e
    v_and_b32 v77, 1, v77
    v_cmp_ne_u32 vcc, 0, v77
    s_cbranch_vccz cf_goA
    s_sub_u32 s31, s31, 64
    s_cbranch_scc0 cf_cA
cf_goA:
    ds_write_b128 v65, v[40:43] offset:0
    v_smfmac_f32_16x16x64_bf16 v[0:3], v[40:43], v[44:51], v64
    v_smfmac_f32_16x16x64_bf16 v[4:7], v[40:43], v[52:59], v64
    buffer_load_dwordx4 v[44:47], v65, s[4:7], s15 offen offset:0 nt
    v_smfmac_f32_16x16x64_bf16 v[0:3], v[60:63], v[24:31], v64
    s_add_u32 s40, s26, 1048576
    s_min_u32 s40, s40, s99
    s_sub_u32 s41, s96, s40
    v_smfmac_f32_16x16x64_bf16 v[4:7], v[60:63], v[32:39], v64
    ds_read_b128 v[24:27], v70 offset:8192
    s_cmp_lt_u32 s97, s93
    s_cselect_b32 s41, s41, 0
    v_smfmac_f32_16x16x64_bf16 v[8:11], v[40:43], a[96:103], v64
    ds_read_b128 v[28:31], v70 offset:9216
    v_smfmac_f32_16x16x64_bf16 v[12:15], v[40:43], a[104:111], v64
    ds_read_b128 v[32:35], v70 offset:10240
    s_waitcnt lgkmcnt(3)
    s_barrier
    ds_read_b128 v[48:51], v67 offset:0
    v_smfmac_f32_16x16x64_bf16 v[8:11], v[60:63], a[112:119], v64
    ds_read_b128 v[36:39], v70 offset:11264
    v_bitop3_b32 v79, v73, -9, s54 bitop3:0x6a
    v_smfmac_f32_16x16x64_bf16 v[12:15], v[60:63], a[120:127], v64
    buffer_load_dwordx4 v[44:47], v65, s[4:7], s15 offen offset:0 nt
    v_smfmac_f32_16x16x64_bf16 v[16:19], v[40:43], a[232:239], v64
    ds_read_b128 v[52:55], v68 offset:0
    s_waitcnt lgkmcnt(4)
    v_bfe_u32 v77, v65, 2, 5
    v_smfmac_f32_16x16x64_bf16 v[20:23], v[40:43], v[24:31], v64
    ds_read_b128 v[24:27], v70 offset:12288
    s_waitcnt lgkmcnt(3)
    v_smfmac_f32_16x16x64_bf16 v[0:3], v[48:51], a[0:7], v64
    ds_read_b128 v[28:31], v70 offset:13312
    s_waitcnt lgkmcnt(3)
    v_add3_u32 v77, v77, s41, 16
    v_smfmac_f32_16x16x64_bf16 v[4:7], v[48:51], v[32:39], v64
    buffer_load_dwordx4 v[40:43], v65, s[4:7], s16 offen offset:0 nt
    v_smfmac_f32_16x16x64_bf16 v[16:19], v[60:63], a[240:247], v64
    ds_read_b128 v[32:35], v70 offset:14336
    v_lshlrev_b32 v78, 3, v69
    v_smfmac_f32_16x16x64_bf16 v[20:23], v[60:63], a[248:255], v64
    ds_read_b128 v[36:39], v70 offset:15360
    v_smfmac_f32_16x16x64_bf16 v[8:11], v[48:51], a[128:135], v64
    s_waitcnt vmcnt(2)
    v_mov_b32_dpp v78, v77 quad_perm:[0,1,2,3] row_mask:0xc bank_mask:0xf
    v_smfmac_f32_16x16x64_bf16 v[12:15], v[48:51], a[136:143], v64
    buffer_load_dwordx4 v[58:61], v65, s[4:7], s24 offen offset:3072 sc1
    s_waitcnt lgkmcnt(2)
    v_and_b32 v77, s36, v44
    v_smfmac_f32_16x16x64_bf16 v[12:15], v[52:55], v[24:31], v64
    ds_write_b128 v65, v[44:47] offset:4096
    v_smfmac_f32_16x16x64_bf16 v[0:3], v[52:55], a[8:15], v64
    v_cmp_ne_u32 vcc, s70, v77
    v_smfmac_f32_16x16x64_bf16 v[8:11], v[52:55], a[144:151], v64
    buffer_load_dwordx4 v[24:27], v65, s[4:7], s24 offen offset:0 sc1
    s_waitcnt lgkmcnt(1)
    v_smfmac_f32_16x16x64_bf16 v[4:7], v[52:55], v[32:39], v64
    s_cbranch_vccnz cf_spinB
cf_backB:
    v_smfmac_f32_16x16x64_bf16 v[16:19], v[44:47], v[176:183], v64
    s_waitcnt lgkmcnt(0)
    s_barrier
    ds_read_b128 v[48:51], v66 offset:4096
    v_smfmac_f32_16x16x64_bf16 v[12:15], v[44:47], a[160:167], v64
    buffer_load_dwordx4 v[28:31], v65, s[4:7], s24 offen offset:1024 sc1
    v_smfmac_f32_16x16x64_bf16 v[0:3], v[44:47], a[16:23], v64
    ds_read_b128 v[52:55], v67 offset:4096
    v_smfmac_f32_16x16x64_bf16 v[8:11], v[44:47], a[152:159], v64
    v_smfmac_f32_16x16x64_bf16 v[4:7], v[44:47], a[24:31], v64
    buffer_load_dwordx4 v[34:37], v65, s[4:7], s24 offen offset:2048 sc1
    s_waitcnt vmcnt(5)
    v_smfmac_f32_16x16x64_bf16 v[20:23], v[44:47], v[184:191], v64
    ds_read_b128 v[44:47], v68 offset:4096
    s_waitcnt lgkmcnt(2)
    v_smfmac_f32_16x16x64_bf16 v[0:3], v[48:51], a[32:39], v64
    v_smfmac_f32_16x16x64_bf16 v[8:11], v[48:51], a[168:175], v64
    buffer_load_dword v76, v78, s[4:7], s40 offen sc1
    v_smfmac_f32_16x16x64_bf16 v[4:7], v[48:51], a[40:47], v64
    s_waitcnt vmcnt(5)
    v_and_b32 v77, s36, v40
    v_smfmac_f32_16x16x64_bf16 v[12:15], v[48:51], a[176:183], v64
    ds_read_b128 v[48:51], v69 offset:15360
    s_waitcnt lgkmcnt(1)
    v_cmp_ne_u32 vcc, s70, v77
    v_smfmac_f32_16x16x64_bf16 v[0:3], v[52:55], a[48:55], v64
    v_smfmac_f32_16x16x64_bf16 v[8:11], v[52:55], a[184:191], v64
    s_cbranch_vccnz cf_spin8
cf_back8:
    v_smfmac_f32_16x16x64_bf16 v[0:3], v[44:47], a[64:71], v64
    v_smfmac_f32_16x16x64_bf16 v[8:11], v[44:47], a[200:207], v64
    v_smfmac_f32_16x16x64_bf16 v[0:3], v[40:43], a[80:87], v64
    s_nop 1
    v_smfmac_f32_16x16x64_bf16 v[8:11], v[40:43], a[216:223], v64
    s_nop 1
    v_lshrrev_b32 v77, 1, v69
    v_smfmac_f32_16x16x64_bf16 v[4:7], v[52:55], a[56:63], v64
    s_nop 1
    v_cvt_pk_bf16_f32 v0, v0, v1
    v_smfmac_f32_16x16x64_bf16 v[12:15], v[52:55], a[192:199], v64
    s_nop 1
    v_cvt_pk_bf16_f32 v1, v2, v3
    v_smfmac_f32_16x16x64_bf16 v[4:7], v[44:47], a[72:79], v64
    s_nop 1
    v_cvt_pk_bf16_f32 v2, v8, v9
    v_smfmac_f32_16x16x64_bf16 v[12:15], v[44:47], a[208:215], v64
    s_nop 1
    v_cvt_pk_bf16_f32 v3, v10, v11
    v_smfmac_f32_16x16x64_bf16 v[4:7], v[40:43], a[88:95], v64
    s_waitcnt lgkmcnt(0)
    s_nop 0
    s_nop 0
    v_smfmac_f32_16x16x64_bf16 v[12:15], v[40:43], a[224:231], v64
    s_nop 2
    v_mfma_f32_16x16x32_bf16 v[8:11], v[0:3], v[48:51], 0
    s_nop 0
    v_cvt_pk_bf16_f32 v4, v4, v5
    v_cvt_pk_bf16_f32 v5, v6, v7
    s_nop 0
    v_cvt_pk_bf16_f32 v6, v12, v13
    v_cvt_pk_bf16_f32 v7, v14, v15
    s_nop 1
    v_mfma_f32_16x16x32_bf16 v[12:15], v[4:7], v[48:51], 0
    ds_read_b128 v[48:51], v66 offset:4096
    v_cvt_pk_bf16_f32 v0, v8, v9
    v_cvt_pk_bf16_f32 v1, v10, v11
    v_smfmac_f32_16x16x64_bf16 v[16:19], v[52:55], v[208:215], v64
    s_waitcnt vmcnt(2)
    s_nop 2
    v_cvt_pk_bf16_f32 v2, v12, v13
    v_cvt_pk_bf16_f32 v3, v14, v15
    s_nop 1
    v_mfma_f32_16x16x32_bf16 v[12:15], v[0:3], v[0:3], 0
    s_nop 1
    v_bitop3_b32 v78, v73, -9, s53 bitop3:0x6a
    v_mfma_f32_16x16x32_bf16 v[4:7], v[24:27], v[0:3], 0
    ds_read_b128 v[24:27], v67 offset:0
    s_nop 1
    v_mfma_f32_16x16x32_bf16 v[8:11], v[28:31], v[0:3], 0
    s_nop 0
    v_mov_b32_dpp v12, v14 row_ror:8 row_mask:0xf bank_mask:0xc
    v_mov_b32_dpp v13, v15 row_ror:8 row_mask:0xf bank_mask:0xc
    v_smfmac_f32_16x16x64_bf16 v[20:23], v[52:55], v[216:223], v64
    ds_write_b64 v71, v[12:13]
    ds_read_b128 v[52:55], v68 offset:0
    s_nop 1
    v_mov_b32_dpp v4, v8 row_ror:8 row_mask:0xf bank_mask:0xc
    v_mov_b32_dpp v5, v9 row_ror:8 row_mask:0xf bank_mask:0xc
    v_mov_b32_dpp v6, v10 row_ror:8 row_mask:0xf bank_mask:0xc
    v_mov_b32_dpp v7, v11 row_ror:8 row_mask:0xf bank_mask:0xc
    v_smfmac_f32_16x16x64_bf16 v[16:19], v[44:47], v[224:231], v64
    ds_write_b128 v65, v[4:7] offset:8192
    v_smfmac_f32_16x16x64_bf16 v[20:23], v[44:47], v[232:239], v64
    s_waitcnt lgkmcnt(3)
    v_smfmac_f32_16x16x64_bf16 v[16:19], v[24:27], v[144:151], v64
    s_waitcnt vmcnt(1)
    v_smfmac_f32_16x16x64_bf16 v[20:23], v[24:27], v[152:159], v64
    s_mov_b64 exec, s[38:39]
    buffer_store_dword v72, v75, s[4:7], s55 offen sc1
    s_mov_b64 exec, -1
    v_smfmac_f32_16x16x64_bf16 v[16:19], v[40:43], v[240:247], v64
    s_cmp_ge_u32 s30, 56
    s_waitcnt lgkmcnt(0)
    s_barrier
    ds_read_b128 v[8:11], v66 offset:8192
    v_smfmac_f32_16x16x64_bf16 v[20:23], v[40:43], v[248:255], v64
    ds_read_b128 v[12:15], v67 offset:8192
    v_smfmac_f32_16x16x64_bf16 v[16:19], v[48:51], v[192:199], v64
    ds_read_b128 v[44:47], v68 offset:8192
    v_smfmac_f32_16x16x64_bf16 v[20:23], v[48:51], v[200:207], v64
    ds_read_b64 v[24:25], v77 offset:14336
    ds_read_b64 v[26:27], v77 offset:14592
    v_smfmac_f32_16x16x64_bf16 v[16:19], v[52:55], v[160:167], v64
    ds_read_b64 v[28:29], v77 offset:14848
    ds_read_b64 v[30:31], v77 offset:15104
    v_bitop3_b32 v77, v73, -9, s52 bitop3:0x6a
    v_smfmac_f32_16x16x64_bf16 v[20:23], v[52:55], v[168:175], v64
    s_cbranch_scc1 cf_rare
cf_rare_x:
    ds_read_b128 v[48:51], v70 offset:22528
    ds_read_b128 v[52:55], v70 offset:23552
    s_waitcnt lgkmcnt(6)
    v_pk_add_f32 v[4:5], v[4:5], v[8:9]
    v_pk_add_f32 v[6:7], v[6:7], v[10:11]
    v_pk_add_f32 v[12:13], v[12:13], v[44:45]
    v_pk_add_f32 v[14:15], v[14:15], v[46:47]
    v_pk_add_f32 v[4:5], v[4:5], v[12:13]
    v_pk_add_f32 v[6:7], v[6:7], v[14:15]
    s_waitcnt lgkmcnt(2)
    v_pk_add_f32 v[24:25], v[24:25], v[26:27]
    v_pk_add_f32 v[28:29], v[28:29], v[30:31]
    v_max3_f32 v8, v4, v5, v6
    v_pk_add_f32 v[24:25], v[24:25], v[28:29]
    v_max_f32 v8, v8, v7
    v_max3_f32 v8, v8, v24, v25
    v_cvt_pk_bf16_f32 v32, v16, v17
    v_cvt_pk_bf16_f32 v38, v18, v19
    v_max_f32_dpp v8, v8, v8 row_ror:8 row_mask:0xf bank_mask:0xf
    v_mov_b32 v9, v8
    v_cvt_pk_bf16_f32 v56, v20, v21
    v_cvt_pk_bf16_f32 v62, v22, v23
    v_permlane32_swap_b32 v8, v9
    v_max_f32 v8, v8, v9
    v_mov_b32 v9, v8
    v_mov_b32 v11, 0
    v_mov_b32 v15, 0
    v_permlane16_swap_b32 v8, v9
    v_max_f32 v8, v8, v9
    v_mul_f32 v8, s66, v8
    v_pk_fma_f32 v[4:5], v[4:5], s[44:45], v[8:9] op_sel_hi:[1,1,0]
    v_pk_fma_f32 v[6:7], v[6:7], s[44:45], v[8:9] op_sel_hi:[1,1,0]
    v_pk_fma_f32 v[24:25], v[24:25], s[44:45], v[8:9] op_sel_hi:[1,1,0]
    v_exp_f32 v4, v4
    v_exp_f32 v5, v5
    v_exp_f32 v6, v6
    v_exp_f32 v7, v7
    v_exp_f32 v24, v24
    v_exp_f32 v25, v25
    v_cvt_pk_bf16_f32 v12, v4, v5
    v_cvt_pk_bf16_f32 v13, v6, v7
    v_cvt_pk_bf16_f32 v10, v24, v25
    v_cvt_pk_bf16_f32 v14, v24, v25
    v_mov_b64 v[0:1], s[48:49]
    v_mfma_f32_16x16x32_bf16 v[4:7], v[32:35], v[10:13], 0
    ds_read_b128 v[40:43], v70 offset:20480
    v_mov_b64 v[2:3], s[50:51]
    v_mfma_f32_16x16x32_bf16 v[24:27], v[36:39], v[12:15], 0
    ds_read_b128 v[44:47], v70 offset:21504
    v_mov_b64 v[8:9], 0
    v_mfma_f32_16x16x32_bf16 v[28:31], v[0:3], v[10:13], 0
    ds_read_b128 v[32:35], v70 offset:24576
    v_mov_b64 v[0:1], 0
    v_mfma_f32_16x16x32_bf16 v[16:19], v[56:59], v[10:13], 0
    ds_read_b128 v[36:39], v70 offset:25600
    v_mov_b64 v[2:3], 0
    v_mfma_f32_16x16x32_bf16 v[20:23], v[60:63], v[12:15], 0
    ds_read_b128 v[56:59], v70 offset:28672
    v_add_f32_dpp v4, v24, v4 row_ror:8 row_mask:0xf bank_mask:0xf
    v_add_f32_dpp v5, v25, v5 row_ror:8 row_mask:0xf bank_mask:0xf
    v_add_f32_dpp v6, v26, v6 row_ror:8 row_mask:0xf bank_mask:0xf
    v_add_f32_dpp v7, v27, v7 row_ror:8 row_mask:0xf bank_mask:0xf
    v_add_f32_dpp v29, v28, v28 row_ror:8 row_mask:0xf bank_mask:0xf
    v_rcp_f32 v28, v29
    v_mov_b64 v[10:11], 0
    v_add_f32_dpp v4, v16, v20 row_ror:8 row_mask:0xf bank_mask:0xc
    v_add_f32_dpp v5, v17, v21 row_ror:8 row_mask:0xf bank_mask:0xc
    v_add_f32_dpp v6, v18, v22 row_ror:8 row_mask:0xf bank_mask:0xc
    v_add_f32_dpp v7, v19, v23 row_ror:8 row_mask:0xf bank_mask:0xc
    v_pk_mul_f32 v[4:5], v[4:5], v[28:29] op_sel_hi:[1,0]
    v_pk_mul_f32 v[6:7], v[6:7], v[28:29] op_sel_hi:[1,0]
    v_cvt_pk_bf16_f32 v4, v4, v5
    v_cvt_pk_bf16_f32 v5, v6, v7
    ds_write_b64 v73, v[4:5] offset:12288
    v_mov_b32_dpp v6, v4 row_ror:8 row_mask:0xf bank_mask:0xf
    v_mov_b32_dpp v7, v5 row_ror:8 row_mask:0xf bank_mask:0xf
    v_mov_b64 v[12:13], 0
    v_mov_b64 v[14:15], 0
    v_smfmac_f32_16x16x64_bf16 v[8:11], v[4:7], v[80:87], v64
    s_waitcnt lgkmcnt(4)
    v_mov_b64 v[24:25], 0
    v_smfmac_f32_16x16x64_bf16 v[0:3], v[4:7], v[40:47], v64
    ds_read_b128 v[60:63], v70 offset:29696
    v_mov_b64 v[26:27], 0
    v_smfmac_f32_16x16x64_bf16 v[12:15], v[4:7], v[112:119], v64
    s_waitcnt lgkmcnt(1)
    s_barrier
    ds_read_b128 v[16:19], v77 offset:12288
    v_smfmac_f32_16x16x64_bf16 v[24:27], v[4:7], v[48:55], v64
    ds_read_b128 v[20:23], v78 offset:12288
    ds_read_b128 v[28:31], v79 offset:12288
    v_mov_b64 v[4:5], 0
    v_mov_b64 v[6:7], 0
    v_bfe_u32 v77, v74, 16, 1
    v_mad_i32_i24 v77, v77, s56, v74
    s_waitcnt lgkmcnt(2)
    v_smfmac_f32_16x16x64_bf16 v[8:11], v[16:19], v[88:95], v64
    ds_read_b128 v[40:43], v70 offset:32768
    s_waitcnt lgkmcnt(2)
    v_smfmac_f32_16x16x64_bf16 v[8:11], v[20:23], v[96:103], v64
    ds_read_b128 v[44:47], v70 offset:33792
    s_waitcnt lgkmcnt(2)
    v_smfmac_f32_16x16x64_bf16 v[8:11], v[28:31], v[104:111], v64
    ds_read_b128 v[48:51], v70 offset:26624
    s_nop 0
    v_and_b32 v72, 8, v73
    v_smfmac_f32_16x16x64_bf16 v[0:3], v[16:19], v[32:39], v64
    ds_read_b128 v[52:55], v70 offset:27648
    s_nop 0
    v_mad_u32_u24 v72, v72, 63, v73
    v_smfmac_f32_16x16x64_bf16 v[12:15], v[16:19], v[120:127], v64
    ds_read_b128 v[32:35], v70 offset:30720
    v_cvt_pk_bf16_f32 v8, v8, v9
    v_cvt_pk_bf16_f32 v9, v10, v11
    v_and_or_b32 v8, v8, -2, s69
    v_smfmac_f32_16x16x64_bf16 v[12:15], v[20:23], v[128:135], v64
    buffer_store_dwordx2 v[8:9], v74, s[4:7], s22 offen offset:0
    ds_read_b128 v[36:39], v70 offset:31744
    v_smfmac_f32_16x16x64_bf16 v[12:15], v[28:31], v[136:143], v64
    s_add_u32 s30, s30, 1
    s_xor_b32 s70, s70, 1
    v_subrev_u32 v72, s47, v72
    v_smfmac_f32_16x16x64_bf16 v[0:3], v[20:23], v[56:63], v64
    ds_read_b128 v[56:59], v70 offset:34816
    s_waitcnt lgkmcnt(3)
    s_nop 0
    v_smfmac_f32_16x16x64_bf16 v[0:3], v[28:31], v[40:47], v64
    ds_read_b128 v[60:63], v70 offset:35840
    v_cvt_pk_bf16_f32 v12, v12, v13
    v_cvt_pk_bf16_f32 v13, v14, v15
    v_and_or_b32 v12, v12, -2, s69
    v_smfmac_f32_16x16x64_bf16 v[24:27], v[16:19], v[48:55], v64
    buffer_store_dwordx2 v[12:13], v74, s[4:7], s22 offen offset:64
    s_waitcnt lgkmcnt(2)
    v_smfmac_f32_16x16x64_bf16 v[24:27], v[20:23], v[32:39], v64
    ds_read_b128 v[40:43], v70 offset:16384
    v_cvt_pk_bf16_f32 v0, v0, v1
    v_cvt_pk_bf16_f32 v1, v2, v3
    v_and_or_b32 v0, v0, -2, s69
    s_waitcnt lgkmcnt(1)
    v_smfmac_f32_16x16x64_bf16 v[24:27], v[28:31], v[56:63], v64
    buffer_store_dwordx2 v[0:1], v74, s[4:7], s23 offen offset:0
    ds_read_b128 v[44:47], v70 offset:17408
    ds_read_b128 v[8:11], v72 offset:12288
    ds_read_b128 v[48:51], v70 offset:18432
    ds_read_b128 v[52:55], v70 offset:19456
    ds_read_b128 v[12:15], v72 offset:13312
    s_cmp_lg_u32 s71, 0
    s_nop 0
    v_cvt_pk_bf16_f32 v24, v24, v25
    v_cvt_pk_bf16_f32 v25, v26, v27
    v_and_or_b32 v24, v24, -2, s69
    buffer_store_dwordx2 v[24:25], v74, s[4:7], s23 offen offset:64
    s_waitcnt lgkmcnt(3)
    v_smfmac_f32_16x16x64_bf16 v[4:7], v[8:11], v[40:47], v64
    s_waitcnt lgkmcnt(0)
    v_smfmac_f32_16x16x64_bf16 v[4:7], v[12:15], v[48:55], v64
    s_nop 7
    v_cvt_pk_bf16_f32 v4, v4, v5
    v_cvt_pk_bf16_f32 v5, v6, v7
    v_and_or_b32 v4, v4, -2, s69
    buffer_store_dwordx2 v[4:5], v77, s[4:7], s25 offen offset:0
    s_nop 0
    s_cbranch_scc1 cf_e1
    s_cmp_lg_u32 s37, 0
    s_cbranch_scc1 cf_f0_xt
cf_f0_xtx:
    s_nop 2
    v_mov_b32 v79, v79
    s_nop 2
    v_mov_b32 v79, v79
    s_nop 2
    v_mov_b32 v79, v79
    s_nop 2
    v_mov_b32 v79, v79
    s_nop 2
    v_mov_b32 v79, v79
    buffer_load_dwordx4 v[8:11], v65, s[4:7], s18 offen nt
    buffer_load_dwordx4 v[12:15], v65, s[4:7], s19 offen nt
    buffer_load_dwordx4 v[16:19], v65, s[4:7], s20 offen nt
    buffer_load_dwordx4 v[20:23], v65, s[4:7], s21 offen nt
    v_and_b32 v77, 255, v69
    ds_read_b128 v[4:7], v77 offset:15872
    ds_read_b128 v[44:47], v70 offset:0
    ds_read_b128 v[48:51], v70 offset:1024
    ds_read_b128 v[52:55], v70 offset:2048
    ds_read_b128 v[56:59], v70 offset:3072
    ds_read_b128 v[24:27], v70 offset:4096
    ds_read_b128 v[28:31], v70 offset:5120
    ds_read_b128 v[32:35], v70 offset:6144
    ds_read_b128 v[36:39], v70 offset:7168
    s_mov_b32 s31, 65536
    s_add_u32 s24, s24, 524288
    s_add_u32 s26, s26, 524288
    s_add_u32 s55, s55, s57
    s_mov_b32 s14, 67108864
    s_mov_b32 s15, 67112960
    s_mov_b32 s16, 67117056
    s_mov_b32 s36, 1
    v_mov_b32 v40, s69
    v_mov_b32 v60, s69
    v_and_b32 v79, 12, v75
    v_cmp_eq_u32 vcc, 0, v79
    s_nop 1
    v_cndmask_b32 v79, 0, 1, vcc
    s_waitcnt lgkmcnt(0)
    s_waitcnt vmcnt(3)
    v_bitop3_b32 v77, v8, v10, s69 bitop3:0x7e
    v_mfma_f32_16x16x32_bf16 v[0:3], v[4:7], v[8:11], 0
    v_mov_b64 v[8:9], 0
    v_mov_b64 v[10:11], 0
    s_waitcnt vmcnt(2)
    v_bitop3_b32 v78, v12, v14, s69 bitop3:0x7e
    v_mfma_f32_16x16x32_bf16 v[0:3], v[4:7], v[12:15], v[0:3]
    v_or_b32 v77, v77, v78
    v_mov_b64 v[12:13], 0
    v_mov_b64 v[14:15], 0
    s_waitcnt vmcnt(1)
    v_bitop3_b32 v78, v16, v18, s69 bitop3:0x7e
    v_mfma_f32_16x16x32_bf16 v[0:3], v[4:7], v[16:19], v[0:3]
    v_or_b32 v77, v77, v78
    v_mov_b64 v[16:17], 0
    v_mov_b64 v[18:19], 0
    s_waitcnt vmcnt(0)
    v_bitop3_b32 v78, v20, v22, s69 bitop3:0x7e
    v_mfma_f32_16x16x32_bf16 v[0:3], v[4:7], v[20:23], v[0:3]
    v_bitop3_b32 v77, v77, v78, 1 bitop3:0xa8
    v_cmp_ne_u32 vcc, 0, v77
    v_mov_b64 v[20:21], 0
    v_mov_b64 v[22:23], 0
    s_cmp_eq_u64 vcc, 0
    s_cselect_b64 s[42:43], -1, 0
    s_nop 1
    v_add_f32_dpp v0, v0, v0 row_ror:8 row_mask:0xf bank_mask:0xf
    v_add_f32_dpp v1, v1, v1 row_ror:8 row_mask:0xf bank_mask:0xf
    s_mov_b64 exec, s[42:43]
    v_cvt_pk_bf16_f32 v72, v0, v1
    v_bfi_b32 v72, v79, s70, v72
    buffer_store_dword v72, v75, s[4:7], s17 offen offset:0
    s_mov_b64 exec, -1
    s_cbranch_scc0 cf_f0_retry
cf_f0_go:
    v_mov_b64 v[0:1], 0
    v_mov_b64 v[2:3], 0
    v_mov_b64 v[4:5], 0
    v_mov_b64 v[6:7], 0
    s_nop 2
    v_mov_b32 v79, v79
    s_nop 2
    v_mov_b32 v79, v79
    s_nop 2
    v_mov_b32 v79, v79
    s_nop 2
    v_mov_b32 v79, v79
    s_branch cf_loop
cf_e1:
    s_cmp_lg_u32 s71, 2
    s_cbranch_scc1 cf_f1
    v_and_b32 v77, 255, v69
    ds_read_b128 v[4:7], v77 offset:15872
    ds_read_b128 v[44:47], v70 offset:0
    ds_read_b128 v[48:51], v70 offset:1024
    ds_read_b128 v[52:55], v70 offset:2048
    ds_read_b128 v[56:59], v70 offset:3072
    ds_read_b128 v[24:27], v70 offset:4096
    ds_read_b128 v[28:31], v70 offset:5120
    ds_read_b128 v[32:35], v70 offset:6144
    ds_read_b128 v[36:39], v70 offset:7168
    s_mov_b32 s31, 65536
    s_add_u32 s24, s24, 524288
    s_add_u32 s26, s26, 524288
    s_add_u32 s55, s55, s57
    s_mov_b32 s14, 67108864
    s_mov_b32 s15, 67112960
    s_mov_b32 s16, 67117056
    s_mov_b32 s36, 1
    v_mov_b32 v40, s69
    v_mov_b32 v60, s69
    v_and_b32 v79, 12, v75
    v_cmp_eq_u32 vcc, 0, v79
    s_nop 1
    v_cndmask_b32 v79, 0, 1, vcc
    s_cmp_lg_u32 s37, 0
    s_cbranch_scc1 cf_f2_xt
cf_f2_xtx:
    s_nop 2
    v_mov_b32 v79, v79
    s_nop 2
    v_mov_b32 v79, v79
    s_nop 2
    v_mov_b32 v79, v79
    s_nop 2
    v_mov_b32 v79, v79
    s_nop 2
    v_mov_b32 v79, v79
    s_nop 2
    v_mov_b32 v79, v79
    s_nop 2
    v_mov_b32 v79, v79
    s_nop 2
    v_mov_b32 v79, v79
    s_waitcnt vmcnt(0)
    buffer_load_dwordx4 v[8:11], v65, s[4:7], s18 offen nt
    buffer_load_dwordx4 v[12:15], v65, s[4:7], s19 offen nt
    buffer_load_dwordx4 v[16:19], v65, s[4:7], s20 offen nt
    buffer_load_dwordx4 v[20:23], v65, s[4:7], s21 offen nt
    s_nop 2
    v_mov_b32 v79, v79
    s_nop 2
    v_mov_b32 v79, v79
    s_nop 2
    v_mov_b32 v79, v79
    s_nop 2
    v_mov_b32 v79, v79
    s_nop 2
    v_mov_b32 v79, v79
    s_nop 2
    v_mov_b32 v79, v79
    s_nop 2
    v_mov_b32 v79, v79
    s_nop 2
    v_mov_b32 v79, v79
    s_nop 2
    v_mov_b32 v79, v79
    s_nop 2
    v_mov_b32 v79, v79
    buffer_load_dwordx4 v[40:43], v65, s[4:7], s14 offen offset:0 nt
    buffer_load_dwordx4 v[60:63], v66, s[4:7], s14 offen offset:0 nt
    s_waitcnt lgkmcnt(0)
    s_waitcnt vmcnt(5)
    v_bitop3_b32 v77, v8, v10, s69 bitop3:0x7e
    v_mfma_f32_16x16x32_bf16 v[0:3], v[4:7], v[8:11], 0
    v_mov_b64 v[8:9], 0
    v_mov_b64 v[10:11], 0
    s_waitcnt vmcnt(4)
    v_bitop3_b32 v78, v12, v14, s69 bitop3:0x7e
    v_mfma_f32_16x16x32_bf16 v[0:3], v[4:7], v[12:15], v[0:3]
    v_or_b32 v77, v77, v78
    v_mov_b64 v[12:13], 0
    v_mov_b64 v[14:15], 0
    s_waitcnt vmcnt(3)
    v_bitop3_b32 v78, v16, v18, s69 bitop3:0x7e
    v_mfma_f32_16x16x32_bf16 v[0:3], v[4:7], v[16:19], v[0:3]
    v_or_b32 v77, v77, v78
    v_mov_b64 v[16:17], 0
    v_mov_b64 v[18:19], 0
    s_waitcnt vmcnt(2)
    v_bitop3_b32 v78, v20, v22, s69 bitop3:0x7e
    v_mfma_f32_16x16x32_bf16 v[0:3], v[4:7], v[20:23], v[0:3]
    v_bitop3_b32 v77, v77, v78, 1 bitop3:0xa8
    v_cmp_ne_u32 vcc, 0, v77
    v_mov_b64 v[20:21], 0
    v_mov_b64 v[22:23], 0
    buffer_load_dwordx4 v[40:43], v65, s[4:7], s14 offen offset:0 nt
    buffer_load_dwordx4 v[60:63], v66, s[4:7], s14 offen offset:0 nt
    s_cmp_eq_u64 vcc, 0
    s_cselect_b64 s[42:43], -1, 0
    v_add_f32_dpp v0, v0, v0 row_ror:4 row_mask:0xf bank_mask:0xf
    v_add_f32_dpp v1, v1, v1 row_ror:4 row_mask:0xf bank_mask:0xf
    s_nop 0
    v_add_f32_dpp v0, v0, v0 row_ror:8 row_mask:0xf bank_mask:0xf
    v_add_f32_dpp v1, v1, v1 row_ror:8 row_mask:0xf bank_mask:0xf
    s_mov_b64 exec, s[42:43]
    v_cvt_pk_bf16_f32 v72, v0, v1
    v_bfi_b32 v72, v79, s70, v72
    buffer_store_dword v72, v75, s[4:7], s17 offen offset:0
    buffer_store_dword v72, v75, s[4:7], s17 offen offset:1024
    buffer_store_dword v72, v75, s[4:7], s17 offen offset:2048
    buffer_store_dword v72, v75, s[4:7], s17 offen offset:3072
    s_mov_b64 exec, -1
    s_cbranch_scc0 cf_f2_retry
cf_f2_go:
    v_mov_b64 v[0:1], 0
    v_mov_b64 v[2:3], 0
    v_mov_b64 v[4:5], 0
    v_mov_b64 v[6:7], 0
    s_branch cf_loop
cf_f1:
    s_cmp_lg_u32 s32, 1
    s_cbranch_scc1 cf_f3
    v_and_b32 v77, 255, v69
    ds_read_b128 v[4:7], v77 offset:15872
    ds_read_b128 v[44:47], v70 offset:0
    ds_read_b128 v[48:51], v70 offset:1024
    ds_read_b128 v[52:55], v70 offset:2048
    ds_read_b128 v[56:59], v70 offset:3072
    ds_read_b128 v[24:27], v70 offset:4096
    ds_read_b128 v[28:31], v70 offset:5120
    ds_read_b128 v[32:35], v70 offset:6144
    ds_read_b128 v[36:39], v70 offset:7168
    s_mov_b32 s31, 65536
    s_add_u32 s24, s24, 524288
    s_add_u32 s26, s26, 524288
    s_add_u32 s55, s55, s57
    s_mov_b32 s14, 67108864
    s_mov_b32 s15, 67112960
    s_mov_b32 s16, 67117056
    s_mov_b32 s36, 1
    v_mov_b32 v40, s69
    v_mov_b32 v60, s69
    v_and_b32 v79, 12, v75
    v_cmp_eq_u32 vcc, 0, v79
    s_nop 1
    v_cndmask_b32 v79, 0, 1, vcc
    s_cmp_lg_u32 s37, 0
    s_cbranch_scc1 cf_f1_xt
cf_f1_xtx:
    s_nop 2
    v_mov_b32 v79, v79
    s_waitcnt vmcnt(0)
    buffer_load_dwordx4 v[8:11], v65, s[4:7], s18 offen nt
    buffer_load_dwordx4 v[12:15], v65, s[4:7], s19 offen nt
    buffer_load_dwordx4 v[16:19], v65, s[4:7], s20 offen nt
    buffer_load_dwordx4 v[20:23], v65, s[4:7], s21 offen nt
    s_nop 2
    v_mov_b32 v79, v79
    s_nop 2
    v_mov_b32 v79, v79
    s_nop 2
    v_mov_b32 v79, v79
    s_nop 2
    v_mov_b32 v79, v79
    s_nop 2
    v_mov_b32 v79, v79
    s_nop 2
    v_mov_b32 v79, v79
    s_nop 2
    v_mov_b32 v79, v79
    s_nop 2
    v_mov_b32 v79, v79
    s_nop 2
    v_mov_b32 v79, v79
    s_nop 2
    v_mov_b32 v79, v79
    buffer_load_dwordx4 v[40:43], v65, s[4:7], s14 offen offset:0 nt
    buffer_load_dwordx4 v[60:63], v66, s[4:7], s14 offen offset:0 nt
    s_waitcnt lgkmcnt(0)
    s_waitcnt vmcnt(5)
    v_bitop3_b32 v77, v8, v10, s69 bitop3:0x7e
    v_mfma_f32_16x16x32_bf16 v[0:3], v[4:7], v[8:11], 0
    v_mov_b64 v[8:9], 0
    v_mov_b64 v[10:11], 0
    s_waitcnt vmcnt(4)
    v_bitop3_b32 v78, v12, v14, s69 bitop3:0x7e
    v_mfma_f32_16x16x32_bf16 v[0:3], v[4:7], v[12:15], v[0:3]
    v_or_b32 v77, v77, v78
    v_mov_b64 v[12:13], 0
    v_mov_b64 v[14:15], 0
    s_waitcnt vmcnt(3)
    v_bitop3_b32 v78, v16, v18, s69 bitop3:0x7e
    v_mfma_f32_16x16x32_bf16 v[0:3], v[4:7], v[16:19], v[0:3]
    v_or_b32 v77, v77, v78
    v_mov_b64 v[16:17], 0
    v_mov_b64 v[18:19], 0
    s_waitcnt vmcnt(2)
    v_bitop3_b32 v78, v20, v22, s69 bitop3:0x7e
    v_mfma_f32_16x16x32_bf16 v[0:3], v[4:7], v[20:23], v[0:3]
    v_bitop3_b32 v77, v77, v78, 1 bitop3:0xa8
    v_cmp_ne_u32 vcc, 0, v77
    v_mov_b64 v[20:21], 0
    v_mov_b64 v[22:23], 0
    buffer_load_dwordx4 v[40:43], v65, s[4:7], s14 offen offset:0 nt
    buffer_load_dwordx4 v[60:63], v66, s[4:7], s14 offen offset:0 nt
    s_cmp_eq_u64 vcc, 0
    s_cselect_b64 s[42:43], -1, 0
    v_add_f32_dpp v0, v0, v0 row_ror:8 row_mask:0xf bank_mask:0xf
    v_add_f32_dpp v1, v1, v1 row_ror:8 row_mask:0xf bank_mask:0xf
    s_mov_b64 exec, s[42:43]
    v_cvt_pk_bf16_f32 v72, v0, v1
    v_bfi_b32 v72, v79, s70, v72
    buffer_store_dword v72, v75, s[4:7], s17 offen offset:0
    s_mov_b64 exec, -1
    s_cbranch_scc0 cf_f1_retry
cf_f1_go:
    v_mov_b64 v[0:1], 0
    v_mov_b64 v[2:3], 0
    v_mov_b64 v[4:5], 0
    v_mov_b64 v[6:7], 0
    s_branch cf_loop
cf_f3:
    v_and_b32 v77, 255, v69
    ds_read_b128 v[4:7], v77 offset:15872
    ds_read_b128 v[44:47], v70 offset:0
    ds_read_b128 v[48:51], v70 offset:1024
    ds_read_b128 v[52:55], v70 offset:2048
    ds_read_b128 v[56:59], v70 offset:3072
    ds_read_b128 v[24:27], v70 offset:4096
    ds_read_b128 v[28:31], v70 offset:5120
    ds_read_b128 v[32:35], v70 offset:6144
    ds_read_b128 v[36:39], v70 offset:7168
    s_mov_b32 s31, 65536
    s_add_u32 s24, s24, 524288
    s_add_u32 s26, s26, 524288
    s_add_u32 s55, s55, s57
    s_mov_b32 s14, 67108864
    s_mov_b32 s15, 67112960
    s_mov_b32 s16, 67117056
    s_mov_b32 s36, 1
    v_mov_b32 v40, s69
    v_mov_b32 v60, s69
    v_and_b32 v79, 12, v75
    v_cmp_eq_u32 vcc, 0, v79
    s_nop 1
    v_cndmask_b32 v79, 0, 1, vcc
    s_add_u32 s40, s30, s95
    v_mov_b32 v72, s40
    s_waitcnt lgkmcnt(0)
    v_mov_b64 v[0:1], 0
    v_mov_b64 v[2:3], 0
    v_mov_b64 v[4:5], 0
    v_mov_b64 v[6:7], 0
    v_mov_b64 v[8:9], 0
    v_mov_b64 v[10:11], 0
    v_mov_b64 v[12:13], 0
    v_mov_b64 v[14:15], 0
    v_mov_b64 v[16:17], 0
    v_mov_b64 v[18:19], 0
    v_mov_b64 v[20:21], 0
    v_mov_b64 v[22:23], 0
    s_nop 2
    v_mov_b32 v79, v79
    s_nop 2
    v_mov_b32 v79, v79
    s_nop 2
    v_mov_b32 v79, v79
    s_nop 2
    v_mov_b32 v79, v79
    s_nop 2
    v_mov_b32 v79, v79
    s_nop 2
    v_mov_b32 v79, v79
    s_nop 2
    v_mov_b32 v79, v79
    s_nop 2
    v_mov_b32 v79, v79
    s_nop 2
    v_mov_b32 v79, v79
    s_waitcnt vmcnt(0)
    s_cmp_lt_u32 s97, s93
    s_cbranch_scc1 cf_kvwait
    s_nop 2
    v_mov_b32 v79, v79
    s_nop 2
    v_mov_b32 v79, v79
    s_nop 2
    v_mov_b32 v79, v79
    s_nop 2
    v_mov_b32 v79, v79
    s_nop 2
    v_mov_b32 v79, v79
    s_nop 2
    v_mov_b32 v79, v79
    s_nop 2
    v_mov_b32 v79, v79
    s_nop 2
    v_mov_b32 v79, v79
cf_kvok:
    s_branch cf_loop
cf_f0_xt:
    s_sub_u32 s37, s37, 1
    s_nop 2
    v_mov_b32 v79, v79
    s_nop 2
    v_mov_b32 v79, v79
    s_nop 2
    v_mov_b32 v79, v79
    s_nop 2
    v_mov_b32 v79, v79
    s_nop 2
    v_mov_b32 v79, v79
    s_nop 2
    v_mov_b32 v79, v79
    s_branch cf_f0_xtx
cf_f0_retry:
    s_sub_u32 s41, s30, s98
    s_mov_b32 s98, s30
    s_cmp_le_u32 s41, 3
    s_cselect_b32 s37, 1, 1
cf_f0_spin:
    buffer_load_dwordx4 v[8:11], v65, s[4:7], s18 offen nt
    buffer_load_dwordx4 v[12:15], v65, s[4:7], s19 offen nt
    buffer_load_dwordx4 v[16:19], v65, s[4:7], s20 offen nt
    buffer_load_dwordx4 v[20:23], v65, s[4:7], s21 offen nt
    s_nop 2
    v_mov_b32 v79, v79
    s_nop 2
    v_mov_b32 v79, v79
    s_nop 2
    v_mov_b32 v79, v79
    buffer_load_dwordx4 v[40:43], v65, s[4:7], s14 offen offset:0 nt
    buffer_load_dwordx4 v[60:63], v66, s[4:7], s14 offen offset:0 nt
    s_waitcnt vmcnt(5)
    v_bitop3_b32 v77, v8, v10, s69 bitop3:0x7e
    v_mfma_f32_16x16x32_bf16 v[0:3], v[4:7], v[8:11], 0
    v_mov_b64 v[8:9], 0
    v_mov_b64 v[10:11], 0
    s_waitcnt vmcnt(4)
    v_bitop3_b32 v78, v12, v14, s69 bitop3:0x7e
    v_mfma_f32_16x16x32_bf16 v[0:3], v[4:7], v[12:15], v[0:3]
    v_or_b32 v77, v77, v78
    v_mov_b64 v[12:13], 0
    v_mov_b64 v[14:15], 0
    s_waitcnt vmcnt(3)
    v_bitop3_b32 v78, v16, v18, s69 bitop3:0x7e
    v_mfma_f32_16x16x32_bf16 v[0:3], v[4:7], v[16:19], v[0:3]
    v_or_b32 v77, v77, v78
    v_mov_b64 v[16:17], 0
    v_mov_b64 v[18:19], 0
    s_waitcnt vmcnt(2)
    v_bitop3_b32 v78, v20, v22, s69 bitop3:0x7e
    v_mfma_f32_16x16x32_bf16 v[0:3], v[4:7], v[20:23], v[0:3]
    v_bitop3_b32 v77, v77, v78, 1 bitop3:0xa8
    v_cmp_ne_u32 vcc, 0, v77
    v_mov_b64 v[20:21], 0
    v_mov_b64 v[22:23], 0
    buffer_load_dwordx4 v[40:43], v65, s[4:7], s14 offen offset:0 nt
    buffer_load_dwordx4 v[60:63], v66, s[4:7], s14 offen offset:0 nt
    s_cmp_eq_u64 vcc, 0
    s_cselect_b64 s[42:43], -1, 0
    v_add_f32_dpp v0, v0, v0 row_ror:8 row_mask:0xf bank_mask:0xf
    v_add_f32_dpp v1, v1, v1 row_ror:8 row_mask:0xf bank_mask:0xf
    s_mov_b64 exec, s[42:43]
    v_cvt_pk_bf16_f32 v72, v0, v1
    v_bfi_b32 v72, v79, s70, v72
    buffer_store_dword v72, v75, s[4:7], s17 offen offset:0
    s_mov_b64 exec, -1
    s_cbranch_scc1 cf_f0_rx
    s_sub_u32 s31, s31, 1
    s_cbranch_scc0 cf_f0_spin
cf_f0_rx:
    v_mov_b64 v[0:1], 0
    v_mov_b64 v[2:3], 0
    v_mov_b64 v[4:5], 0
    v_mov_b64 v[6:7], 0
    s_branch cf_loop
cf_f1_xt:
    s_sub_u32 s37, s37, 1
    s_nop 2
    v_mov_b32 v79, v79
    s_nop 2
    v_mov_b32 v79, v79
    s_nop 2
    v_mov_b32 v79, v79
    s_nop 2
    v_mov_b32 v79, v79
    s_nop 2
    v_mov_b32 v79, v79
    s_nop 2
    v_mov_b32 v79, v79
    s_branch cf_f1_xtx
cf_f1_retry:
    s_sub_u32 s41, s30, s98
    s_mov_b32 s98, s30
    s_cmp_le_u32 s41, 3
    s_cselect_b32 s37, 1, 1
cf_f1_spin:
    buffer_load_dwordx4 v[8:11], v65, s[4:7], s18 offen nt
    buffer_load_dwordx4 v[12:15], v65, s[4:7], s19 offen nt
    buffer_load_dwordx4 v[16:19], v65, s[4:7], s20 offen nt
    buffer_load_dwordx4 v[20:23], v65, s[4:7], s21 offen nt
    s_nop 2
    v_mov_b32 v79, v79
    s_nop 2
    v_mov_b32 v79, v79
    s_nop 2
    v_mov_b32 v79, v79
    buffer_load_dwordx4 v[40:43], v65, s[4:7], s14 offen offset:0 nt
    buffer_load_dwordx4 v[60:63], v66, s[4:7], s14 offen offset:0 nt
    s_waitcnt vmcnt(5)
    v_bitop3_b32 v77, v8, v10, s69 bitop3:0x7e
    v_mfma_f32_16x16x32_bf16 v[0:3], v[4:7], v[8:11], 0
    v_mov_b64 v[8:9], 0
    v_mov_b64 v[10:11], 0
    s_waitcnt vmcnt(4)
    v_bitop3_b32 v78, v12, v14, s69 bitop3:0x7e
    v_mfma_f32_16x16x32_bf16 v[0:3], v[4:7], v[12:15], v[0:3]
    v_or_b32 v77, v77, v78
    v_mov_b64 v[12:13], 0
    v_mov_b64 v[14:15], 0
    s_waitcnt vmcnt(3)
    v_bitop3_b32 v78, v16, v18, s69 bitop3:0x7e
    v_mfma_f32_16x16x32_bf16 v[0:3], v[4:7], v[16:19], v[0:3]
    v_or_b32 v77, v77, v78
    v_mov_b64 v[16:17], 0
    v_mov_b64 v[18:19], 0
    s_waitcnt vmcnt(2)
    v_bitop3_b32 v78, v20, v22, s69 bitop3:0x7e
    v_mfma_f32_16x16x32_bf16 v[0:3], v[4:7], v[20:23], v[0:3]
    v_bitop3_b32 v77, v77, v78, 1 bitop3:0xa8
    v_cmp_ne_u32 vcc, 0, v77
    v_mov_b64 v[20:21], 0
    v_mov_b64 v[22:23], 0
    buffer_load_dwordx4 v[40:43], v65, s[4:7], s14 offen offset:0 nt
    buffer_load_dwordx4 v[60:63], v66, s[4:7], s14 offen offset:0 nt
    s_cmp_eq_u64 vcc, 0
    s_cselect_b64 s[42:43], -1, 0
    v_add_f32_dpp v0, v0, v0 row_ror:8 row_mask:0xf bank_mask:0xf
    v_add_f32_dpp v1, v1, v1 row_ror:8 row_mask:0xf bank_mask:0xf
    s_mov_b64 exec, s[42:43]
    v_cvt_pk_bf16_f32 v72, v0, v1
    v_bfi_b32 v72, v79, s70, v72
    buffer_store_dword v72, v75, s[4:7], s17 offen offset:0
    s_mov_b64 exec, -1
    s_cbranch_scc1 cf_f1_rx
    s_sub_u32 s31, s31, 1
    s_cbranch_scc0 cf_f1_spin
cf_f1_rx:
    v_mov_b64 v[0:1], 0
    v_mov_b64 v[2:3], 0
    v_mov_b64 v[4:5], 0
    v_mov_b64 v[6:7], 0
    s_branch cf_loop
cf_f2_xt:
    s_sub_u32 s37, s37, 1
    s_nop 2
    v_mov_b32 v79, v79
    s_nop 2
    v_mov_b32 v79, v79
    s_nop 2
    v_mov_b32 v79, v79
    s_nop 2
    v_mov_b32 v79, v79
    s_nop 2
    v_mov_b32 v79, v79
    s_nop 2
    v_mov_b32 v79, v79
    s_branch cf_f2_xtx
cf_f2_retry:
    s_sub_u32 s41, s30, s98
    s_mov_b32 s98, s30
    s_cmp_le_u32 s41, 3
    s_cselect_b32 s37, 1, 1
cf_f2_spin:
    buffer_load_dwordx4 v[8:11], v65, s[4:7], s18 offen nt
    buffer_load_dwordx4 v[12:15], v65, s[4:7], s19 offen nt
    buffer_load_dwordx4 v[16:19], v65, s[4:7], s20 offen nt
    buffer_load_dwordx4 v[20:23], v65, s[4:7], s21 offen nt
    s_nop 2
    v_mov_b32 v79, v79
    s_nop 2
    v_mov_b32 v79, v79
    s_nop 2
    v_mov_b32 v79, v79
    buffer_load_dwordx4 v[40:43], v65, s[4:7], s14 offen offset:0 nt
    buffer_load_dwordx4 v[60:63], v66, s[4:7], s14 offen offset:0 nt
    s_waitcnt vmcnt(5)
    v_bitop3_b32 v77, v8, v10, s69 bitop3:0x7e
    v_mfma_f32_16x16x32_bf16 v[0:3], v[4:7], v[8:11], 0
    v_mov_b64 v[8:9], 0
    v_mov_b64 v[10:11], 0
    s_waitcnt vmcnt(4)
    v_bitop3_b32 v78, v12, v14, s69 bitop3:0x7e
    v_mfma_f32_16x16x32_bf16 v[0:3], v[4:7], v[12:15], v[0:3]
    v_or_b32 v77, v77, v78
    v_mov_b64 v[12:13], 0
    v_mov_b64 v[14:15], 0
    s_waitcnt vmcnt(3)
    v_bitop3_b32 v78, v16, v18, s69 bitop3:0x7e
    v_mfma_f32_16x16x32_bf16 v[0:3], v[4:7], v[16:19], v[0:3]
    v_or_b32 v77, v77, v78
    v_mov_b64 v[16:17], 0
    v_mov_b64 v[18:19], 0
    s_waitcnt vmcnt(2)
    v_bitop3_b32 v78, v20, v22, s69 bitop3:0x7e
    v_mfma_f32_16x16x32_bf16 v[0:3], v[4:7], v[20:23], v[0:3]
    v_bitop3_b32 v77, v77, v78, 1 bitop3:0xa8
    v_cmp_ne_u32 vcc, 0, v77
    v_mov_b64 v[20:21], 0
    v_mov_b64 v[22:23], 0
    buffer_load_dwordx4 v[40:43], v65, s[4:7], s14 offen offset:0 nt
    buffer_load_dwordx4 v[60:63], v66, s[4:7], s14 offen offset:0 nt
    s_cmp_eq_u64 vcc, 0
    s_cselect_b64 s[42:43], -1, 0
    v_add_f32_dpp v0, v0, v0 row_ror:4 row_mask:0xf bank_mask:0xf
    v_add_f32_dpp v1, v1, v1 row_ror:4 row_mask:0xf bank_mask:0xf
    s_nop 0
    v_add_f32_dpp v0, v0, v0 row_ror:8 row_mask:0xf bank_mask:0xf
    v_add_f32_dpp v1, v1, v1 row_ror:8 row_mask:0xf bank_mask:0xf
    s_mov_b64 exec, s[42:43]
    v_cvt_pk_bf16_f32 v72, v0, v1
    v_bfi_b32 v72, v79, s70, v72
    buffer_store_dword v72, v75, s[4:7], s17 offen offset:0
    buffer_store_dword v72, v75, s[4:7], s17 offen offset:1024
    buffer_store_dword v72, v75, s[4:7], s17 offen offset:2048
    buffer_store_dword v72, v75, s[4:7], s17 offen offset:3072
    s_mov_b64 exec, -1
    s_cbranch_scc1 cf_f2_rx
    s_sub_u32 s31, s31, 1
    s_cbranch_scc0 cf_f2_spin
cf_f2_rx:
    v_mov_b64 v[0:1], 0
    v_mov_b64 v[2:3], 0
    v_mov_b64 v[4:5], 0
    v_mov_b64 v[6:7], 0
    s_branch cf_loop
cf_spinB:
    s_waitcnt vmcnt(3)
cf_spinB_l:
    v_and_b32 v77, s36, v44
    v_cmp_ne_u32 vcc, s70, v77
    s_cbranch_vccz cf_spinB_x
    buffer_load_dwordx4 v[44:47], v65, s[4:7], s15 offen nt
    s_sub_u32 s31, s31, 16
    s_waitcnt vmcnt(0)
    s_cbranch_scc0 cf_spinB_l
cf_spinB_x:
    ds_write_b128 v65, v[44:47] offset:4096
    s_waitcnt lgkmcnt(0)
    s_branch cf_backB
cf_spin8:
    buffer_load_dwordx4 v[40:43], v65, s[4:7], s16 offen nt
cf_spin8_l:
    v_and_b32 v77, s36, v40
    v_cmp_ne_u32 vcc, s70, v77
    s_cbranch_vccz cf_spin8_x
    s_nop 1
    v_and_b32 v77, s36, v40
    v_cmp_ne_u32 vcc, s70, v77
    s_cbranch_vccz cf_spin8_x
    s_nop 1
    v_and_b32 v77, s36, v40
    v_cmp_ne_u32 vcc, s70, v77
    s_cbranch_vccz cf_spin8_x
    s_nop 1
    buffer_load_dwordx4 v[40:43], v65, s[4:7], s16 offen nt
    s_sub_u32 s31, s31, 16
    s_cbranch_scc0 cf_spin8_l
cf_spin8_x:
    s_branch cf_back8
cf_rare:
    s_mov_b64 exec, s[34:35]
    buffer_store_dwordx4 v[0:3], v65, s[4:7], s28 offen sc1
    s_mov_b64 exec, -1
    s_nop 3
    v_cvt_pk_bf16_f32 v52, v16, v17
    v_cvt_pk_bf16_f32 v53, v18, v19
    v_cvt_pk_bf16_f32 v54, v20, v21
    v_cvt_pk_bf16_f32 v55, v22, v23
    buffer_store_dwordx4 v[52:55], v65, s[4:7], s27 offen sc1
    s_add_u32 s28, s28, 131072
    s_add_u32 s27, s27, 131072
    s_cmp_eq_u32 s30, 63
    s_cbranch_scc1 cf_last
    s_branch cf_rare_x
cf_kvwait:
    s_mov_b32 s41, s97
    v_bfe_u32 v78, v65, 2, 5
    v_mov_b32 v77, v76
    s_nop 1
    v_permlane32_swap_b32 v76, v77
    v_subrev_u32 v77, s95, v77
    v_cmp_lt_u32 vcc, 16, v77
    s_nop 1
    v_cndmask_b32 v77, v77, 0, vcc
    v_bfe_u32 v79, v78, 2, 2
    v_lshl_add_u32 v77, v77, 2, v79
    s_nop 1
    v_min_u32_dpp v77, v77, v77 row_ror:1 row_mask:0xf bank_mask:0xf
    s_nop 1
    v_min_u32_dpp v77, v77, v77 row_ror:2 row_mask:0xf bank_mask:0xf
    s_nop 1
    v_min_u32_dpp v77, v77, v77 row_ror:4 row_mask:0xf bank_mask:0xf
    s_nop 0
    v_readfirstlane_b32 s97, v77
    s_nop 0
    s_max_u32 s97, s97, s41
    s_add_u32 s40, s30, 3
    s_min_u32 s40, s40, 64
    s_cmp_le_u32 s40, s97
    s_cbranch_scc1 cf_kvw_x
    v_bfe_u32 v78, v65, 2, 5
    s_mov_b32 s31, 4194304
cf_kvw:
    buffer_load_dword v77, v78, s[4:7], s96 offen offset:16 sc1
    s_waitcnt vmcnt(0)
    v_subrev_u32 v77, s95, v77
    v_cmp_lt_u32 vcc, 16, v77
    s_nop 1
    v_cndmask_b32 v77, v77, 0, vcc
    v_bfe_u32 v79, v78, 2, 2
    v_lshl_add_u32 v77, v77, 2, v79
    s_nop 1
    v_min_u32_dpp v77, v77, v77 row_ror:1 row_mask:0xf bank_mask:0xf
    s_nop 1
    v_min_u32_dpp v77, v77, v77 row_ror:2 row_mask:0xf bank_mask:0xf
    s_nop 1
    v_min_u32_dpp v77, v77, v77 row_ror:4 row_mask:0xf bank_mask:0xf
    s_nop 0
    v_readfirstlane_b32 s97, v77
    s_sub_u32 s31, s31, 1
    s_cbranch_scc1 cf_kvw_x
    s_cmp_le_u32 s40, s97
    s_cbranch_scc1 cf_kvw_x
    s_sleep 2
    s_branch cf_kvw
cf_kvw_x:
    s_branch cf_kvok
cf_last:
    s_add_u32 s40, s95, 64
    v_mov_b32 v78, s40
    s_waitcnt vmcnt(0)
    s_barrier
    s_mov_b64 exec, s[100:101]
    buffer_store_dword v78, off, s[4:7], s29 sc1
    s_mov_b64 exec, -1
cf_end:
    s_endpgm
L_chain_safe:
    s_mov_b64 s[48:49], s[50:51]
    s_mov_b64 s[50:51], s[52:53]
    s_mov_b64 s[52:53], s[54:55]
    s_mov_b64 s[54:55], s[56:57]
    s_mov_b64 s[56:57], s[58:59]
    v_lshrrev_b32 v77, 6, v0
    s_nop 0
    v_readfirstlane_b32 s13, v77
    v_lshlrev_b32 v65, 4, v0
    v_and_b32 v48, 63, v0
    s_mov_b32 s10, 4718592
    s_mov_b32 s11, 0x20000
    v_lshrrev_b32 v49, 3, v48
    v_mul_u32_u24 v18, 1152, v49
    v_and_b32 v49, 7, v48
    v_lshl_add_u32 v18, v49, 4, v18
    s_mul_i32 s40, s12, 147456
    s_lshl_b32 s41, s13, 8
    s_add_u32 s40, s40, s41
    s_mov_b32 s42, s40
    s_xor_b32 s41, s13, 0
    s_mul_i32 s41, s41, 36864
    s_add_u32 s60, s41, s40
    s_xor_b32 s41, s13, 1
    s_mul_i32 s41, s41, 36864
    s_add_u32 s61, s41, s40
    s_xor_b32 s41, s13, 2
    s_mul_i32 s41, s41, 36864
    s_add_u32 s62, s41, s40
    s_xor_b32 s41, s13, 3
    s_mul_i32 s41, s41, 36864
    s_add_u32 s63, s41, s40
    s_lshl_b32 s43, s13, 12
    s_mov_b64 s[8:9], s[56:57]
    s_add_u32 m0, s43, 147456
    s_add_u32 s41, s60, 0
    buffer_load_dwordx4 v18, s[8:11], s41 offen offset:0 nt lds
    s_add_u32 s41, s60, 8192
    buffer_load_dwordx4 v18, s[8:11], s41 offen offset:1024 nt lds
    s_add_u32 s41, s60, 16384
    buffer_load_dwordx4 v18, s[8:11], s41 offen offset:2048 nt lds
    s_add_u32 s41, s60, 24576
    buffer_load_dwordx4 v18, s[8:11], s41 offen offset:3072 nt lds
    s_add_u32 m0, s43, 0
    s_add_u32 s41, s61, 0
    buffer_load_dwordx4 v18, s[8:11], s41 offen offset:0 nt lds
    s_add_u32 s41, s61, 8192
    buffer_load_dwordx4 v18, s[8:11], s41 offen offset:1024 nt lds
    s_add_u32 s41, s61, 16384
    buffer_load_dwordx4 v18, s[8:11], s41 offen offset:2048 nt lds
    s_add_u32 s41, s61, 24576
    buffer_load_dwordx4 v18, s[8:11], s41 offen offset:3072 nt lds
    s_add_u32 m0, s43, 36864
    s_add_u32 s41, s62, 0
    buffer_load_dwordx4 v18, s[8:11], s41 offen offset:0 nt lds
    s_add_u32 s41, s62, 8192
    buffer_load_dwordx4 v18, s[8:11], s41 offen offset:1024 nt lds
    s_add_u32 s41, s62, 16384
    buffer_load_dwordx4 v18, s[8:11], s41 offen offset:2048 nt lds
    s_add_u32 s41, s62, 24576
    buffer_load_dwordx4 v18, s[8:11], s41 offen offset:3072 nt lds
    s_add_u32 m0, s43, 73728
    s_add_u32 s41, s63, 0
    buffer_load_dwordx4 v18, s[8:11], s41 offen offset:0 nt lds
    s_add_u32 s41, s63, 8192
    buffer_load_dwordx4 v18, s[8:11], s41 offen offset:1024 nt lds
    s_add_u32 s41, s63, 16384
    buffer_load_dwordx4 v18, s[8:11], s41 offen offset:2048 nt lds
    s_add_u32 s41, s63, 24576
    buffer_load_dwordx4 v18, s[8:11], s41 offen offset:3072 nt lds
    v_lshrrev_b32 v49, 1, v48
    v_mul_u32_u24 v19, 1152, v49
    v_and_b32 v49, 1, v48
    v_lshl_add_u32 v19, v49, 4, v19
    s_mul_i32 s41, s13, 224
    s_sub_u32 s41, 1024, s41
    v_add_u32 v19, s41, v19
    v_lshrrev_b32 v49, 4, v48
    v_lshlrev_b32 v50, 2, v49
    v_and_b32 v51, 15, v48
    v_xor_b32 v51, v51, v50
    v_lshlrev_b32 v51, 4, v51
    v_lshl_add_u32 v16, v49, 15, v51
    v_lshrrev_b32 v50, 1, v49
    v_lshl_add_u32 v17, v50, 16, v51
    v_and_b32 v50, 1, v49
    v_lshl_add_u32 v17, v50, 13, v17
    s_lshl_b32 s40, s12, 8
    s_mul_i32 s58, s13, 1048576
    s_add_u32 s58, s58, s40
    s_lshr_b32 s41, s13, 1
    s_mul_i32 s59, s41, 262144
    s_and_b32 s41, s13, 1
    s_lshl_b32 s41, s41, 14
    s_add_u32 s59, s59, s41
    s_add_u32 s59, s59, s40
    s_add_u32 s59, s59, 4194304
    v_bfe_u32 v50, v48, 2, 2
    v_xor_b32 v51, s13, v50
    v_lshlrev_b32 v20, 6, v51
    v_and_b32 v51, 3, v48
    v_lshl_add_u32 v20, v51, 4, v20
    v_lshrrev_b32 v23, 2, v48
    v_lshl_add_u32 v20, v23, 8, v20
    s_xor_b32 s41, s43, 0
    v_add_u32 v24, s41, v20
    s_xor_b32 s41, s43, 4096
    v_add_u32 v25, s41, v20
    s_xor_b32 s41, s43, 8192
    v_add_u32 v26, s41, v20
    s_xor_b32 s41, s43, 12288
    v_add_u32 v27, s41, v20
    v_and_b32 v23, 1, v50
    v_lshl_add_u32 v23, v49, 2, v23
    v_lshrrev_b32 v50, 1, v50
    v_lshlrev_b32 v21, 7, v23
    v_lshl_add_u32 v21, v50, 6, v21
    v_lshrrev_b32 v16, 1, v51
    v_lshl_add_u32 v21, v16, 5, v21
    v_and_b32 v16, 1, v51
    v_lshl_add_u32 v21, v16, 3, v21
    v_add_u32 v21, s43, v21
    v_lshlrev_b32 v22, 9, v50
    v_xor_b32 v22, v22, v21
    v_lshlrev_b32 v23, 5, v23
    v_lshl_add_u32 v23, v50, 10, v23
    v_lshl_add_u32 v23, v51, 3, v23
    v_add_u32 v23, s43, v23
    v_bfe_u32 v60, v65, 4, 6
    v_and_b32 v61, 15, v60
    v_lshrrev_b32 v62, 4, v60
    v_mov_b32 v64, 0x4444
    v_mov_b32 v77, 0xeeee
    v_cmp_lt_u32 vcc, 7, v61
    s_nop 1
    v_cndmask_b32 v64, v64, v77, vcc
    v_xor_b32 v66, 1024, v65
    v_xor_b32 v67, 2048, v65
    v_xor_b32 v68, 3072, v65
    v_and_b32 v69, 511, v65
    s_mul_i32 s96, s13, 36864
    s_add_u32 s96, s96, 16384
    v_lshlrev_b32 v70, 4, v60
    v_add_u32 v70, s96, v70
    v_lshrrev_b32 v79, 1, v69
    s_lshl_b32 s96, s13, 8
    s_add_u32 s96, s96, 14336
    s_lshl_b32 s33, s13, 10
    s_add_u32 s97, s33, 8192
    v_mov_b32 v77, s97
    v_mov_b32 v78, s96
    v_cmp_lt_u32 vcc, 31, v60
    s_nop 1
    v_cndmask_b32 v71, v77, v78, vcc
    v_add_u32 v71, v71, v79
    v_and_b32 v77, 7, v61
    v_lshrrev_b32 v78, 3, v61
    v_lshlrev_b32 v74, 4, v77
    v_lshl_add_u32 v73, v62, 7, v74
    v_lshl_add_u32 v73, v78, 3, v73
    s_lshl_b32 s96, s13, 9
    v_add_u32 v73, s96, v73
    v_lshrrev_b32 v74, 1, v74
    v_lshl_add_u32 v74, v78, 14, v74
    v_lshl_add_u32 v74, v62, 15, v74
    s_lshl_b32 s96, s13, 17
    v_add_u32 v74, s96, v74
    v_bfe_u32 v77, v61, 2, 1
    v_and_b32 v78, 3, v61
    s_cmp_lt_u32 s13, 2
    s_cselect_b64 vcc, -1, 0
    v_cndmask_b32 v77, 0, v77, vcc
    v_lshlrev_b32 v75, 7, v77
    v_lshl_add_u32 v75, v62, 4, v75
    v_lshl_add_u32 v75, v78, 2, v75
    v_lshlrev_b32 v58, 3, v77
    v_lshl_add_u32 v58, v78, 1, v58
    s_bfe_u32 s97, s12, 0x10001
    s_lshl_b32 s68, s97, 6
    s_lshl_b32 s97, s97, 2
    v_add_u32 v59, s97, v62
    s_bfe_u32 s96, s12, 0x10002
    s_and_b32 s40, s12, 1
    s_lshl_b32 s96, s96, 1
    s_add_u32 s96, s96, s40
    s_lshr_b32 s97, s12, 3
    s_lshl_b32 s98, s13, 2
    s_add_u32 s98, s98, s97
    s_lshl_b32 s98, s98, 2
    s_add_u32 s98, s98, s96
    s_lshl_b32 s98, s98, 8
    s_lshl_b32 s99, s13, 2
    s_add_u32 s99, s99, s96
    s_lshl_b32 s99, s99, 4
    s_lshl_b32 s41, s97, 1
    s_add_u32 s41, s41, s40
    s_lshl_b32 s41, s41, 7
    s_add_u32 s41, s41, 8192
    s_lshl_b32 s40, s40, 3
    s_add_u32 s40, s40, 512
    s_cmp_lt_u32 s13, 2
    s_cselect_b32 s96, 7, 4
    s_cselect_b32 s98, s98, s41
    s_cselect_b32 s99, s99, s40
    s_cselect_b32 s32, 1, 0
    s_add_u32 s68, s68, s98
    s_lshl_b32 s97, s97, s96
    s_add_u32 s99, s99, s97
    v_add_u32 v58, s99, v58
    s_and_b32 s97, s12, 4
    s_or_b32 s97, s97, s13
    s_cmp_eq_u32 s97, 2
    s_cselect_b32 s32, 2, s32
    s_mov_b32 s8, s48
    s_mov_b32 s9, s49
    s_mov_b32 s10, 9216
    v_mul_u32_u24 v77, 1152, v59
    v_lshl_add_u32 v77, v58, 1, v77
    buffer_load_dword v72, v77, s[8:11], 0 offen
    s_mov_b32 s10, 4718592
    s_waitcnt vmcnt(12) lgkmcnt(0)
    s_barrier
    s_mov_b64 s[8:9], s[56:57]
    s_add_u32 m0, s43, 110592
    s_add_u32 s41, s42, 0
    buffer_load_dwordx4 v19, s[8:11], s41 offen offset:0 nt lds
    s_add_u32 s41, s42, 35840
    buffer_load_dwordx4 v19, s[8:11], s41 offen offset:1024 nt lds
    s_add_u32 s41, s42, 71680
    buffer_load_dwordx4 v19, s[8:11], s41 offen offset:2048 nt lds
    s_add_u32 s41, s42, 107520
    buffer_load_dwordx4 v19, s[8:11], s41 offen offset:3072 nt lds
    v_mov_b32 v78, v21
    v_mov_b32 v79, v22
    v_add_u32 v77, 147456, v79
    ds_read_b64_tr_b16 v[80:81], v77 offset:0
    ds_read_b64_tr_b16 v[82:83], v77 offset:256
    ds_read_b64_tr_b16 v[84:85], v77 offset:2048
    ds_read_b64_tr_b16 v[86:87], v77 offset:2304
    ds_read_b64_tr_b16 v[112:113], v77 offset:16
    ds_read_b64_tr_b16 v[114:115], v77 offset:272
    ds_read_b64_tr_b16 v[116:117], v77 offset:2064
    ds_read_b64_tr_b16 v[118:119], v77 offset:2320
    s_waitcnt vmcnt(12) lgkmcnt(0)
    s_barrier
    s_mov_b64 s[8:9], s[52:53]
    s_add_u32 m0, s43, 147456
    s_add_u32 s41, s58, 0
    buffer_load_dwordx4 v17, s[8:11], s41 offen offset:0 nt lds
    s_add_u32 s41, s58, 31744
    buffer_load_dwordx4 v17, s[8:11], s41 offen offset:1024 nt lds
    s_add_u32 s41, s58, 129024
    buffer_load_dwordx4 v17, s[8:11], s41 offen offset:2048 nt lds
    s_add_u32 s41, s58, 160768
    buffer_load_dwordx4 v17, s[8:11], s41 offen offset:3072 nt lds
    v_add_u32 v77, 0, v78
    ds_read_b64_tr_b16 v[88:89], v77 offset:0
    ds_read_b64_tr_b16 v[90:91], v77 offset:256
    ds_read_b64_tr_b16 v[92:93], v77 offset:2048
    ds_read_b64_tr_b16 v[94:95], v77 offset:2304
    ds_read_b64_tr_b16 v[120:121], v77 offset:16
    ds_read_b64_tr_b16 v[122:123], v77 offset:272
    ds_read_b64_tr_b16 v[124:125], v77 offset:2064
    ds_read_b64_tr_b16 v[126:127], v77 offset:2320
    s_waitcnt vmcnt(12) lgkmcnt(0)
    s_barrier
    s_add_u32 m0, s43, 0
    s_add_u32 s41, s58, 16384
    buffer_load_dwordx4 v17, s[8:11], s41 offen offset:0 nt lds
    s_add_u32 s41, s58, 48128
    buffer_load_dwordx4 v17, s[8:11], s41 offen offset:1024 nt lds
    s_add_u32 s41, s58, 145408
    buffer_load_dwordx4 v17, s[8:11], s41 offen offset:2048 nt lds
    s_add_u32 s41, s58, 177152
    buffer_load_dwordx4 v17, s[8:11], s41 offen offset:3072 nt lds
    v_add_u32 v77, 36864, v78
    ds_read_b64_tr_b16 v[96:97], v77 offset:0
    ds_read_b64_tr_b16 v[98:99], v77 offset:256
    ds_read_b64_tr_b16 v[100:101], v77 offset:2048
    ds_read_b64_tr_b16 v[102:103], v77 offset:2304
    ds_read_b64_tr_b16 v[128:129], v77 offset:16
    ds_read_b64_tr_b16 v[130:131], v77 offset:272
    ds_read_b64_tr_b16 v[132:133], v77 offset:2064
    ds_read_b64_tr_b16 v[134:135], v77 offset:2320
    s_waitcnt vmcnt(12) lgkmcnt(0)
    s_barrier
    s_add_u32 m0, s43, 36864
    s_add_u32 s41, s58, 262144
    buffer_load_dwordx4 v17, s[8:11], s41 offen offset:0 nt lds
    s_add_u32 s41, s58, 293888
    buffer_load_dwordx4 v17, s[8:11], s41 offen offset:1024 nt lds
    s_add_u32 s41, s58, 391168
    buffer_load_dwordx4 v17, s[8:11], s41 offen offset:2048 nt lds
    s_add_u32 s41, s58, 422912
    buffer_load_dwordx4 v17, s[8:11], s41 offen offset:3072 nt lds
    v_add_u32 v77, 73728, v78
    ds_read_b64_tr_b16 v[104:105], v77 offset:0
    ds_read_b64_tr_b16 v[106:107], v77 offset:256
    ds_read_b64_tr_b16 v[108:109], v77 offset:2048
    ds_read_b64_tr_b16 v[110:111], v77 offset:2304
    ds_read_b64_tr_b16 v[136:137], v77 offset:16
    ds_read_b64_tr_b16 v[138:139], v77 offset:272
    ds_read_b64_tr_b16 v[140:141], v77 offset:2064
    ds_read_b64_tr_b16 v[142:143], v77 offset:2320
    s_waitcnt vmcnt(12) lgkmcnt(0)
    s_barrier
    s_add_u32 m0, s43, 73728
    s_add_u32 s41, s58, 278528
    buffer_load_dwordx4 v17, s[8:11], s41 offen offset:0 nt lds
    s_add_u32 s41, s58, 310272
    buffer_load_dwordx4 v17, s[8:11], s41 offen offset:1024 nt lds
    s_add_u32 s41, s58, 407552
    buffer_load_dwordx4 v17, s[8:11], s41 offen offset:2048 nt lds
    s_add_u32 s41, s58, 439296
    buffer_load_dwordx4 v17, s[8:11], s41 offen offset:3072 nt lds
    v_add_u32 v77, 110592, v23
    ds_read_b64_tr_b16 v[0:1], v77 offset:0
    ds_read_b64_tr_b16 v[2:3], v77 offset:64
    ds_read_b64_tr_b16 v[4:5], v77 offset:512
    ds_read_b64_tr_b16 v[6:7], v77 offset:576
    ds_read_b64_tr_b16 v[8:9], v77 offset:2048
    ds_read_b64_tr_b16 v[10:11], v77 offset:2112
    ds_read_b64_tr_b16 v[12:13], v77 offset:2560
    ds_read_b64_tr_b16 v[14:15], v77 offset:2624
    s_waitcnt vmcnt(12) lgkmcnt(0)
    s_barrier
    s_add_u32 m0, s43, 110592
    s_add_u32 s41, s58, 524288
    buffer_load_dwordx4 v17, s[8:11], s41 offen offset:0 nt lds
    s_add_u32 s41, s58, 556032
    buffer_load_dwordx4 v17, s[8:11], s41 offen offset:1024 nt lds
    s_add_u32 s41, s58, 653312
    buffer_load_dwordx4 v17, s[8:11], s41 offen offset:2048 nt lds
    s_add_u32 s41, s58, 685056
    buffer_load_dwordx4 v17, s[8:11], s41 offen offset:3072 nt lds
    s_cmp_eq_u32 s32, 0
    s_cbranch_scc1 cs_init_done
    v_mov_b32 v52, 1
    v_mov_b32 v53, 1
    v_mov_b32 v54, 1
    v_mov_b32 v55, 1
    v_mov_b32 v56, 0
    s_lshl_b32 s96, s12, 14
    s_add_u32 s96, s96, 68681728
    s_add_u32 s97, s96, 0
    buffer_store_dwordx4 v[52:55], v65, s[4:7], s97 offen sc1
    s_add_u32 s97, s96, 4096
    buffer_store_dwordx4 v[52:55], v65, s[4:7], s97 offen sc1
    s_add_u32 s97, s96, 8192
    buffer_store_dwordx4 v[52:55], v65, s[4:7], s97 offen sc1
    s_add_u32 s97, s96, 12288
    buffer_store_dwordx4 v[52:55], v65, s[4:7], s97 offen sc1
    s_add_u32 s96, s68, 67633152
    s_add_u32 s97, s96, 16384
    buffer_store_dword v56, v75, s[4:7], s96 offen offset:0 sc1
    buffer_store_dword v72, v75, s[4:7], s97 offen offset:0 sc1
    s_cmp_lg_u32 s32, 2
    s_cbranch_scc1 cs_init_done
    buffer_store_dword v56, v75, s[4:7], s96 offen offset:1024 sc1
    buffer_store_dword v72, v75, s[4:7], s97 offen offset:1024 sc1
    buffer_store_dword v56, v75, s[4:7], s96 offen offset:2048 sc1
    buffer_store_dword v72, v75, s[4:7], s97 offen offset:2048 sc1
    buffer_store_dword v56, v75, s[4:7], s96 offen offset:3072 sc1
    buffer_store_dword v72, v75, s[4:7], s97 offen offset:3072 sc1
cs_init_done:
    ds_write_b64 v70, v[0:1] offset:16384
    ds_write_b64 v70, v[2:3] offset:16392
    ds_write_b64 v70, v[4:5] offset:17408
    ds_write_b64 v70, v[6:7] offset:17416
    ds_write_b64 v70, v[8:9] offset:18432
    ds_write_b64 v70, v[10:11] offset:18440
    ds_write_b64 v70, v[12:13] offset:19456
    ds_write_b64 v70, v[14:15] offset:19464
    v_add_u32 v28, 147456, v24
    v_add_u32 v29, 147456, v25
    v_add_u32 v30, 147456, v26
    v_add_u32 v31, 147456, v27
    ds_read_b64_tr_b16 a[96:97], v28 offset:0
    ds_read_b64_tr_b16 a[104:105], v28 offset:8
    ds_read_b64_tr_b16 a[112:113], v29 offset:0
    ds_read_b64_tr_b16 a[120:121], v29 offset:8
    ds_read_b64_tr_b16 a[128:129], v30 offset:0
    ds_read_b64_tr_b16 a[136:137], v30 offset:8
    ds_read_b64_tr_b16 a[144:145], v31 offset:0
    ds_read_b64_tr_b16 v[32:33], v31 offset:8
    s_waitcnt vmcnt(12) lgkmcnt(0)
    s_barrier
    s_add_u32 m0, s43, 147456
    s_add_u32 s41, s58, 540672
    buffer_load_dwordx4 v17, s[8:11], s41 offen offset:0 nt lds
    s_add_u32 s41, s58, 572416
    buffer_load_dwordx4 v17, s[8:11], s41 offen offset:1024 nt lds
    s_add_u32 s41, s58, 669696
    buffer_load_dwordx4 v17, s[8:11], s41 offen offset:2048 nt lds
    s_add_u32 s41, s58, 701440
    buffer_load_dwordx4 v17, s[8:11], s41 offen offset:3072 nt lds
    ds_write_b64 v70, v[32:33] offset:12288
    v_add_u32 v28, 0, v24
    v_add_u32 v29, 0, v25
    v_add_u32 v30, 0, v26
    v_add_u32 v31, 0, v27
    ds_read_b64_tr_b16 a[98:99], v28 offset:0
    ds_read_b64_tr_b16 a[106:107], v28 offset:8
    ds_read_b64_tr_b16 a[114:115], v29 offset:0
    ds_read_b64_tr_b16 a[122:123], v29 offset:8
    ds_read_b64_tr_b16 a[130:131], v30 offset:0
    ds_read_b64_tr_b16 a[138:139], v30 offset:8
    ds_read_b64_tr_b16 a[146:147], v31 offset:0
    ds_read_b64_tr_b16 v[0:1], v31 offset:8
    s_waitcnt vmcnt(12) lgkmcnt(0)
    s_barrier
    s_add_u32 m0, s43, 0
    s_add_u32 s41, s58, 786432
    buffer_load_dwordx4 v17, s[8:11], s41 offen offset:0 nt lds
    s_add_u32 s41, s58, 818176
    buffer_load_dwordx4 v17, s[8:11], s41 offen offset:1024 nt lds
    s_add_u32 s41, s58, 915456
    buffer_load_dwordx4 v17, s[8:11], s41 offen offset:2048 nt lds
    s_add_u32 s41, s58, 947200
    buffer_load_dwordx4 v17, s[8:11], s41 offen offset:3072 nt lds
    ds_write_b64 v70, v[0:1] offset:12296
    v_add_u32 v28, 36864, v24
    v_add_u32 v29, 36864, v25
    v_add_u32 v30, 36864, v26
    v_add_u32 v31, 36864, v27
    ds_read_b64_tr_b16 a[100:101], v28 offset:0
    ds_read_b64_tr_b16 a[108:109], v28 offset:8
    ds_read_b64_tr_b16 a[116:117], v29 offset:0
    ds_read_b64_tr_b16 a[124:125], v29 offset:8
    ds_read_b64_tr_b16 a[132:133], v30 offset:0
    ds_read_b64_tr_b16 a[140:141], v30 offset:8
    ds_read_b64_tr_b16 a[148:149], v31 offset:0
    ds_read_b64_tr_b16 v[32:33], v31 offset:8
    s_waitcnt vmcnt(12) lgkmcnt(0)
    s_barrier
    s_add_u32 m0, s43, 36864
    s_add_u32 s41, s58, 802816
    buffer_load_dwordx4 v17, s[8:11], s41 offen offset:0 nt lds
    s_add_u32 s41, s58, 834560
    buffer_load_dwordx4 v17, s[8:11], s41 offen offset:1024 nt lds
    s_add_u32 s41, s58, 931840
    buffer_load_dwordx4 v17, s[8:11], s41 offen offset:2048 nt lds
    s_add_u32 s41, s58, 963584
    buffer_load_dwordx4 v17, s[8:11], s41 offen offset:3072 nt lds
    ds_write_b64 v70, v[32:33] offset:13312
    v_add_u32 v28, 73728, v24
    v_add_u32 v29, 73728, v25
    v_add_u32 v30, 73728, v26
    v_add_u32 v31, 73728, v27
    ds_read_b64_tr_b16 a[102:103], v28 offset:0
    ds_read_b64_tr_b16 a[110:111], v28 offset:8
    ds_read_b64_tr_b16 a[118:119], v29 offset:0
    ds_read_b64_tr_b16 a[126:127], v29 offset:8
    ds_read_b64_tr_b16 a[134:135], v30 offset:0
    ds_read_b64_tr_b16 a[142:143], v30 offset:8
    ds_read_b64_tr_b16 a[150:151], v31 offset:0
    ds_read_b64_tr_b16 v[0:1], v31 offset:8
    s_waitcnt vmcnt(12) lgkmcnt(0)
    s_barrier
    s_add_u32 m0, s43, 73728
    s_add_u32 s41, s59, 0
    buffer_load_dwordx4 v17, s[8:11], s41 offen offset:0 nt lds
    s_add_u32 s41, s59, 31744
    buffer_load_dwordx4 v17, s[8:11], s41 offen offset:1024 nt lds
    s_add_u32 s41, s59, 129024
    buffer_load_dwordx4 v17, s[8:11], s41 offen offset:2048 nt lds
    s_add_u32 s41, s59, 160768
    buffer_load_dwordx4 v17, s[8:11], s41 offen offset:3072 nt lds
    ds_write_b64 v70, v[0:1] offset:13320
    v_add_u32 v28, 110592, v24
    v_add_u32 v29, 110592, v25
    v_add_u32 v30, 110592, v26
    v_add_u32 v31, 110592, v27
    ds_read_b64_tr_b16 a[152:153], v28 offset:0
    ds_read_b64_tr_b16 a[160:161], v28 offset:8
    ds_read_b64_tr_b16 a[168:169], v29 offset:0
    ds_read_b64_tr_b16 a[176:177], v29 offset:8
    ds_read_b64_tr_b16 a[184:185], v30 offset:0
    ds_read_b64_tr_b16 a[192:193], v30 offset:8
    ds_read_b64_tr_b16 a[200:201], v31 offset:0
    ds_read_b64_tr_b16 a[208:209], v31 offset:8
    s_waitcnt vmcnt(12) lgkmcnt(0)
    s_barrier
    s_mov_b64 s[8:9], s[50:51]
    s_add_u32 m0, s43, 110592
    s_add_u32 s41, s58, 0
    buffer_load_dwordx4 v17, s[8:11], s41 offen offset:0 nt lds
    s_add_u32 s41, s58, 31744
    buffer_load_dwordx4 v17, s[8:11], s41 offen offset:1024 nt lds
    s_add_u32 s41, s58, 129024
    buffer_load_dwordx4 v17, s[8:11], s41 offen offset:2048 nt lds
    s_add_u32 s41, s58, 160768
    buffer_load_dwordx4 v17, s[8:11], s41 offen offset:3072 nt lds
    v_add_u32 v28, 147456, v24
    v_add_u32 v29, 147456, v25
    v_add_u32 v30, 147456, v26
    v_add_u32 v31, 147456, v27
    ds_read_b64_tr_b16 a[154:155], v28 offset:0
    ds_read_b64_tr_b16 a[162:163], v28 offset:8
    ds_read_b64_tr_b16 a[170:171], v29 offset:0
    ds_read_b64_tr_b16 a[178:179], v29 offset:8
    ds_read_b64_tr_b16 a[186:187], v30 offset:0
    ds_read_b64_tr_b16 a[194:195], v30 offset:8
    ds_read_b64_tr_b16 a[202:203], v31 offset:0
    ds_read_b64_tr_b16 a[210:211], v31 offset:8
    s_waitcnt vmcnt(12) lgkmcnt(0)
    s_barrier
    s_add_u32 m0, s43, 147456
    s_add_u32 s41, s58, 16384
    buffer_load_dwordx4 v17, s[8:11], s41 offen offset:0 nt lds
    s_add_u32 s41, s58, 48128
    buffer_load_dwordx4 v17, s[8:11], s41 offen offset:1024 nt lds
    s_add_u32 s41, s58, 145408
    buffer_load_dwordx4 v17, s[8:11], s41 offen offset:2048 nt lds
    s_add_u32 s41, s58, 177152
    buffer_load_dwordx4 v17, s[8:11], s41 offen offset:3072 nt lds
    v_add_u32 v28, 0, v24
    v_add_u32 v29, 0, v25
    v_add_u32 v30, 0, v26
    v_add_u32 v31, 0, v27
    ds_read_b64_tr_b16 a[156:157], v28 offset:0
    ds_read_b64_tr_b16 a[164:165], v28 offset:8
    ds_read_b64_tr_b16 a[172:173], v29 offset:0
    ds_read_b64_tr_b16 a[180:181], v29 offset:8
    ds_read_b64_tr_b16 a[188:189], v30 offset:0
    ds_read_b64_tr_b16 a[196:197], v30 offset:8
    ds_read_b64_tr_b16 a[204:205], v31 offset:0
    ds_read_b64_tr_b16 a[212:213], v31 offset:8
    s_waitcnt vmcnt(12) lgkmcnt(0)
    s_barrier
    s_add_u32 m0, s43, 0
    s_add_u32 s41, s58, 262144
    buffer_load_dwordx4 v17, s[8:11], s41 offen offset:0 nt lds
    s_add_u32 s41, s58, 293888
    buffer_load_dwordx4 v17, s[8:11], s41 offen offset:1024 nt lds
    s_add_u32 s41, s58, 391168
    buffer_load_dwordx4 v17, s[8:11], s41 offen offset:2048 nt lds
    s_add_u32 s41, s58, 422912
    buffer_load_dwordx4 v17, s[8:11], s41 offen offset:3072 nt lds
    v_add_u32 v28, 36864, v24
    v_add_u32 v29, 36864, v25
    v_add_u32 v30, 36864, v26
    v_add_u32 v31, 36864, v27
    ds_read_b64_tr_b16 a[158:159], v28 offset:0
    ds_read_b64_tr_b16 a[166:167], v28 offset:8
    ds_read_b64_tr_b16 a[174:175], v29 offset:0
    ds_read_b64_tr_b16 a[182:183], v29 offset:8
    ds_read_b64_tr_b16 a[190:191], v30 offset:0
    ds_read_b64_tr_b16 a[198:199], v30 offset:8
    ds_read_b64_tr_b16 a[206:207], v31 offset:0
    ds_read_b64_tr_b16 a[214:215], v31 offset:8
    s_waitcnt vmcnt(12) lgkmcnt(0)
    s_barrier
    s_add_u32 m0, s43, 36864
    s_add_u32 s41, s58, 278528
    buffer_load_dwordx4 v17, s[8:11], s41 offen offset:0 nt lds
    s_add_u32 s41, s58, 310272
    buffer_load_dwordx4 v17, s[8:11], s41 offen offset:1024 nt lds
    s_add_u32 s41, s58, 407552
    buffer_load_dwordx4 v17, s[8:11], s41 offen offset:2048 nt lds
    s_add_u32 s41, s58, 439296
    buffer_load_dwordx4 v17, s[8:11], s41 offen offset:3072 nt lds
    v_add_u32 v77, 73728, v20
    ds_read_b64_tr_b16 a[216:217], v77 offset:0
    ds_read_b64_tr_b16 a[218:219], v77 offset:4096
    ds_read_b64_tr_b16 a[220:221], v77 offset:8192
    ds_read_b64_tr_b16 a[222:223], v77 offset:12288
    ds_read_b64_tr_b16 a[224:225], v77 offset:8
    ds_read_b64_tr_b16 a[226:227], v77 offset:4104
    ds_read_b64_tr_b16 a[228:229], v77 offset:8200
    ds_read_b64_tr_b16 a[230:231], v77 offset:12296
    s_waitcnt vmcnt(12) lgkmcnt(0)
    s_barrier
    s_add_u32 m0, s43, 73728
    s_add_u32 s41, s58, 524288
    buffer_load_dwordx4 v17, s[8:11], s41 offen offset:0 nt lds
    s_add_u32 s41, s58, 556032
    buffer_load_dwordx4 v17, s[8:11], s41 offen offset:1024 nt lds
    s_add_u32 s41, s58, 653312
    buffer_load_dwordx4 v17, s[8:11], s41 offen offset:2048 nt lds
    s_add_u32 s41, s58, 685056
    buffer_load_dwordx4 v17, s[8:11], s41 offen offset:3072 nt lds
    v_add_u32 v28, 110592, v24
    v_add_u32 v29, 110592, v25
    v_add_u32 v30, 110592, v26
    v_add_u32 v31, 110592, v27
    ds_read_b64_tr_b16 v[0:1], v28 offset:0
    ds_read_b64_tr_b16 v[2:3], v28 offset:8
    ds_read_b64_tr_b16 v[4:5], v29 offset:0
    ds_read_b64_tr_b16 v[6:7], v29 offset:8
    ds_read_b64_tr_b16 a[0:1], v30 offset:0
    ds_read_b64_tr_b16 v[8:9], v30 offset:8
    ds_read_b64_tr_b16 a[8:9], v31 offset:0
    ds_read_b64_tr_b16 v[10:11], v31 offset:8
    s_waitcnt vmcnt(12) lgkmcnt(0)
    s_barrier
    s_add_u32 m0, s43, 110592
    s_add_u32 s41, s58, 540672
    buffer_load_dwordx4 v17, s[8:11], s41 offen offset:0 nt lds
    s_add_u32 s41, s58, 572416
    buffer_load_dwordx4 v17, s[8:11], s41 offen offset:1024 nt lds
    s_add_u32 s41, s58, 669696
    buffer_load_dwordx4 v17, s[8:11], s41 offen offset:2048 nt lds
    s_add_u32 s41, s58, 701440
    buffer_load_dwordx4 v17, s[8:11], s41 offen offset:3072 nt lds
    ds_write_b64 v70, v[0:1] offset:0
    ds_write_b64 v70, v[2:3] offset:2048
    ds_write_b64 v70, v[4:5] offset:4096
    ds_write_b64 v70, v[6:7] offset:6144
    ds_write_b64 v70, v[8:9] offset:10240
    ds_write_b64 v70, v[10:11] offset:14336
    v_add_u32 v28, 147456, v24
    v_add_u32 v29, 147456, v25
    v_add_u32 v30, 147456, v26
    v_add_u32 v31, 147456, v27
    ds_read_b64_tr_b16 v[32:33], v28 offset:0
    ds_read_b64_tr_b16 v[34:35], v28 offset:8
    ds_read_b64_tr_b16 v[36:37], v29 offset:0
    ds_read_b64_tr_b16 v[38:39], v29 offset:8
    ds_read_b64_tr_b16 a[2:3], v30 offset:0
    ds_read_b64_tr_b16 v[40:41], v30 offset:8
    ds_read_b64_tr_b16 a[10:11], v31 offset:0
    ds_read_b64_tr_b16 v[42:43], v31 offset:8
    s_waitcnt vmcnt(12) lgkmcnt(0)
    s_barrier
    s_add_u32 m0, s43, 147456
    s_add_u32 s41, s58, 786432
    buffer_load_dwordx4 v17, s[8:11], s41 offen offset:0 nt lds
    s_add_u32 s41, s58, 818176
    buffer_load_dwordx4 v17, s[8:11], s41 offen offset:1024 nt lds
    s_add_u32 s41, s58, 915456
    buffer_load_dwordx4 v17, s[8:11], s41 offen offset:2048 nt lds
    s_add_u32 s41, s58, 947200
    buffer_load_dwordx4 v17, s[8:11], s41 offen offset:3072 nt lds
    ds_write_b64 v70, v[32:33] offset:8
    ds_write_b64 v70, v[34:35] offset:2056
    ds_write_b64 v70, v[36:37] offset:4104
    ds_write_b64 v70, v[38:39] offset:6152
    ds_write_b64 v70, v[40:41] offset:10248
    ds_write_b64 v70, v[42:43] offset:14344
    v_add_u32 v28, 0, v24
    v_add_u32 v29, 0, v25
    v_add_u32 v30, 0, v26
    v_add_u32 v31, 0, v27
    ds_read_b64_tr_b16 v[0:1], v28 offset:0
    ds_read_b64_tr_b16 v[2:3], v28 offset:8
    ds_read_b64_tr_b16 v[4:5], v29 offset:0
    ds_read_b64_tr_b16 v[6:7], v29 offset:8
    ds_read_b64_tr_b16 a[4:5], v30 offset:0
    ds_read_b64_tr_b16 v[8:9], v30 offset:8
    ds_read_b64_tr_b16 a[12:13], v31 offset:0
    ds_read_b64_tr_b16 v[10:11], v31 offset:8
    s_waitcnt vmcnt(12) lgkmcnt(0)
    s_barrier
    s_add_u32 m0, s43, 0
    s_add_u32 s41, s58, 802816
    buffer_load_dwordx4 v17, s[8:11], s41 offen offset:0 nt lds
    s_add_u32 s41, s58, 834560
    buffer_load_dwordx4 v17, s[8:11], s41 offen offset:1024 nt lds
    s_add_u32 s41, s58, 931840
    buffer_load_dwordx4 v17, s[8:11], s41 offen offset:2048 nt lds
    s_add_u32 s41, s58, 963584
    buffer_load_dwordx4 v17, s[8:11], s41 offen offset:3072 nt lds
    ds_write_b64 v70, v[0:1] offset:1024
    ds_write_b64 v70, v[2:3] offset:3072
    ds_write_b64 v70, v[4:5] offset:5120
    ds_write_b64 v70, v[6:7] offset:7168
    ds_write_b64 v70, v[8:9] offset:11264
    ds_write_b64 v70, v[10:11] offset:15360
    v_add_u32 v28, 36864, v24
    v_add_u32 v29, 36864, v25
    v_add_u32 v30, 36864, v26
    v_add_u32 v31, 36864, v27
    ds_read_b64_tr_b16 v[32:33], v28 offset:0
    ds_read_b64_tr_b16 v[34:35], v28 offset:8
    ds_read_b64_tr_b16 v[36:37], v29 offset:0
    ds_read_b64_tr_b16 v[38:39], v29 offset:8
    ds_read_b64_tr_b16 a[6:7], v30 offset:0
    ds_read_b64_tr_b16 v[40:41], v30 offset:8
    ds_read_b64_tr_b16 a[14:15], v31 offset:0
    ds_read_b64_tr_b16 v[42:43], v31 offset:8
    s_waitcnt vmcnt(12) lgkmcnt(0)
    s_barrier
    s_add_u32 m0, s43, 36864
    s_add_u32 s41, s59, 0
    buffer_load_dwordx4 v17, s[8:11], s41 offen offset:0 nt lds
    s_add_u32 s41, s59, 31744
    buffer_load_dwordx4 v17, s[8:11], s41 offen offset:1024 nt lds
    s_add_u32 s41, s59, 129024
    buffer_load_dwordx4 v17, s[8:11], s41 offen offset:2048 nt lds
    s_add_u32 s41, s59, 160768
    buffer_load_dwordx4 v17, s[8:11], s41 offen offset:3072 nt lds
    ds_write_b64 v70, v[32:33] offset:1032
    ds_write_b64 v70, v[34:35] offset:3080
    ds_write_b64 v70, v[36:37] offset:5128
    ds_write_b64 v70, v[38:39] offset:7176
    ds_write_b64 v70, v[40:41] offset:11272
    ds_write_b64 v70, v[42:43] offset:15368
    v_add_u32 v28, 73728, v24
    v_add_u32 v29, 73728, v25
    v_add_u32 v30, 73728, v26
    v_add_u32 v31, 73728, v27
    ds_read_b64_tr_b16 a[16:17], v28 offset:0
    ds_read_b64_tr_b16 a[24:25], v28 offset:8
    ds_read_b64_tr_b16 a[32:33], v29 offset:0
    ds_read_b64_tr_b16 a[40:41], v29 offset:8
    ds_read_b64_tr_b16 a[48:49], v30 offset:0
    ds_read_b64_tr_b16 a[56:57], v30 offset:8
    ds_read_b64_tr_b16 a[64:65], v31 offset:0
    ds_read_b64_tr_b16 a[72:73], v31 offset:8
    s_waitcnt vmcnt(12) lgkmcnt(0)
    s_barrier
    s_mov_b64 s[8:9], s[54:55]
    s_add_u32 m0, s43, 73728
    s_add_u32 s41, s58, 0
    buffer_load_dwordx4 v17, s[8:11], s41 offen offset:0 nt lds
    s_add_u32 s41, s58, 31744
    buffer_load_dwordx4 v17, s[8:11], s41 offen offset:1024 nt lds
    s_add_u32 s41, s58, 129024
    buffer_load_dwordx4 v17, s[8:11], s41 offen offset:2048 nt lds
    s_add_u32 s41, s58, 160768
    buffer_load_dwordx4 v17, s[8:11], s41 offen offset:3072 nt lds
    v_add_u32 v28, 110592, v24
    v_add_u32 v29, 110592, v25
    v_add_u32 v30, 110592, v26
    v_add_u32 v31, 110592, v27
    ds_read_b64_tr_b16 a[18:19], v28 offset:0
    ds_read_b64_tr_b16 a[26:27], v28 offset:8
    ds_read_b64_tr_b16 a[34:35], v29 offset:0
    ds_read_b64_tr_b16 a[42:43], v29 offset:8
    ds_read_b64_tr_b16 a[50:51], v30 offset:0
    ds_read_b64_tr_b16 a[58:59], v30 offset:8
    ds_read_b64_tr_b16 a[66:67], v31 offset:0
    ds_read_b64_tr_b16 a[74:75], v31 offset:8
    s_waitcnt vmcnt(12) lgkmcnt(0)
    s_barrier
    s_add_u32 m0, s43, 110592
    s_add_u32 s41, s58, 16384
    buffer_load_dwordx4 v17, s[8:11], s41 offen offset:0 nt lds
    s_add_u32 s41, s58, 48128
    buffer_load_dwordx4 v17, s[8:11], s41 offen offset:1024 nt lds
    s_add_u32 s41, s58, 145408
    buffer_load_dwordx4 v17, s[8:11], s41 offen offset:2048 nt lds
    s_add_u32 s41, s58, 177152
    buffer_load_dwordx4 v17, s[8:11], s41 offen offset:3072 nt lds
    v_add_u32 v28, 147456, v24
    v_add_u32 v29, 147456, v25
    v_add_u32 v30, 147456, v26
    v_add_u32 v31, 147456, v27
    ds_read_b64_tr_b16 a[20:21], v28 offset:0
    ds_read_b64_tr_b16 a[28:29], v28 offset:8
    ds_read_b64_tr_b16 a[36:37], v29 offset:0
    ds_read_b64_tr_b16 a[44:45], v29 offset:8
    ds_read_b64_tr_b16 a[52:53], v30 offset:0
    ds_read_b64_tr_b16 a[60:61], v30 offset:8
    ds_read_b64_tr_b16 a[68:69], v31 offset:0
    ds_read_b64_tr_b16 a[76:77], v31 offset:8
    s_waitcnt vmcnt(12) lgkmcnt(0)
    s_barrier
    s_add_u32 m0, s43, 147456
    s_add_u32 s41, s58, 262144
    buffer_load_dwordx4 v17, s[8:11], s41 offen offset:0 nt lds
    s_add_u32 s41, s58, 293888
    buffer_load_dwordx4 v17, s[8:11], s41 offen offset:1024 nt lds
    s_add_u32 s41, s58, 391168
    buffer_load_dwordx4 v17, s[8:11], s41 offen offset:2048 nt lds
    s_add_u32 s41, s58, 422912
    buffer_load_dwordx4 v17, s[8:11], s41 offen offset:3072 nt lds
    v_add_u32 v28, 0, v24
    v_add_u32 v29, 0, v25
    v_add_u32 v30, 0, v26
    v_add_u32 v31, 0, v27
    ds_read_b64_tr_b16 a[22:23], v28 offset:0
    ds_read_b64_tr_b16 a[30:31], v28 offset:8
    ds_read_b64_tr_b16 a[38:39], v29 offset:0
    ds_read_b64_tr_b16 a[46:47], v29 offset:8
    ds_read_b64_tr_b16 a[54:55], v30 offset:0
    ds_read_b64_tr_b16 a[62:63], v30 offset:8
    ds_read_b64_tr_b16 a[70:71], v31 offset:0
    ds_read_b64_tr_b16 a[78:79], v31 offset:8
    s_waitcnt vmcnt(12) lgkmcnt(0)
    s_barrier
    s_add_u32 m0, s43, 0
    s_add_u32 s41, s58, 278528
    buffer_load_dwordx4 v17, s[8:11], s41 offen offset:0 nt lds
    s_add_u32 s41, s58, 310272
    buffer_load_dwordx4 v17, s[8:11], s41 offen offset:1024 nt lds
    s_add_u32 s41, s58, 407552
    buffer_load_dwordx4 v17, s[8:11], s41 offen offset:2048 nt lds
    s_add_u32 s41, s58, 439296
    buffer_load_dwordx4 v17, s[8:11], s41 offen offset:3072 nt lds
    v_add_u32 v77, 36864, v20
    ds_read_b64_tr_b16 a[80:81], v77 offset:0
    ds_read_b64_tr_b16 a[82:83], v77 offset:4096
    ds_read_b64_tr_b16 a[84:85], v77 offset:8192
    ds_read_b64_tr_b16 a[86:87], v77 offset:12288
    ds_read_b64_tr_b16 a[88:89], v77 offset:8
    ds_read_b64_tr_b16 a[90:91], v77 offset:4104
    ds_read_b64_tr_b16 a[92:93], v77 offset:8200
    ds_read_b64_tr_b16 a[94:95], v77 offset:12296
    s_waitcnt vmcnt(12) lgkmcnt(0)
    s_barrier
    s_add_u32 m0, s43, 36864
    s_add_u32 s41, s58, 524288
    buffer_load_dwordx4 v17, s[8:11], s41 offen offset:0 nt lds
    s_add_u32 s41, s58, 556032
    buffer_load_dwordx4 v17, s[8:11], s41 offen offset:1024 nt lds
    s_add_u32 s41, s58, 653312
    buffer_load_dwordx4 v17, s[8:11], s41 offen offset:2048 nt lds
    s_add_u32 s41, s58, 685056
    buffer_load_dwordx4 v17, s[8:11], s41 offen offset:3072 nt lds
    v_add_u32 v28, 73728, v24
    v_add_u32 v29, 73728, v25
    v_add_u32 v30, 73728, v26
    v_add_u32 v31, 73728, v27
    ds_read_b64_tr_b16 a[232:233], v28 offset:0
    ds_read_b64_tr_b16 v[32:33], v28 offset:8
    ds_read_b64_tr_b16 a[240:241], v29 offset:0
    ds_read_b64_tr_b16 a[248:249], v29 offset:8
    ds_read_b64_tr_b16 v[144:145], v30 offset:0
    ds_read_b64_tr_b16 v[152:153], v30 offset:8
    ds_read_b64_tr_b16 v[160:161], v31 offset:0
    ds_read_b64_tr_b16 v[168:169], v31 offset:8
    s_waitcnt vmcnt(12) lgkmcnt(0)
    s_barrier
    s_add_u32 m0, s43, 73728
    s_add_u32 s41, s58, 540672
    buffer_load_dwordx4 v17, s[8:11], s41 offen offset:0 nt lds
    s_add_u32 s41, s58, 572416
    buffer_load_dwordx4 v17, s[8:11], s41 offen offset:1024 nt lds
    s_add_u32 s41, s58, 669696
    buffer_load_dwordx4 v17, s[8:11], s41 offen offset:2048 nt lds
    s_add_u32 s41, s58, 701440
    buffer_load_dwordx4 v17, s[8:11], s41 offen offset:3072 nt lds
    ds_write_b64 v70, v[32:33] offset:8192
    v_add_u32 v28, 110592, v24
    v_add_u32 v29, 110592, v25
    v_add_u32 v30, 110592, v26
    v_add_u32 v31, 110592, v27
    ds_read_b64_tr_b16 a[234:235], v28 offset:0
    ds_read_b64_tr_b16 v[0:1], v28 offset:8
    ds_read_b64_tr_b16 a[242:243], v29 offset:0
    ds_read_b64_tr_b16 a[250:251], v29 offset:8
    ds_read_b64_tr_b16 v[146:147], v30 offset:0
    ds_read_b64_tr_b16 v[154:155], v30 offset:8
    ds_read_b64_tr_b16 v[162:163], v31 offset:0
    ds_read_b64_tr_b16 v[170:171], v31 offset:8
    s_waitcnt vmcnt(12) lgkmcnt(0)
    s_barrier
    s_add_u32 m0, s43, 110592
    s_add_u32 s41, s58, 786432
    buffer_load_dwordx4 v17, s[8:11], s41 offen offset:0 nt lds
    s_add_u32 s41, s58, 818176
    buffer_load_dwordx4 v17, s[8:11], s41 offen offset:1024 nt lds
    s_add_u32 s41, s58, 915456
    buffer_load_dwordx4 v17, s[8:11], s41 offen offset:2048 nt lds
    s_add_u32 s41, s58, 947200
    buffer_load_dwordx4 v17, s[8:11], s41 offen offset:3072 nt lds
    ds_write_b64 v70, v[0:1] offset:8200
    v_add_u32 v28, 147456, v24
    v_add_u32 v29, 147456, v25
    v_add_u32 v30, 147456, v26
    v_add_u32 v31, 147456, v27
    ds_read_b64_tr_b16 a[236:237], v28 offset:0
    ds_read_b64_tr_b16 v[32:33], v28 offset:8
    ds_read_b64_tr_b16 a[244:245], v29 offset:0
    ds_read_b64_tr_b16 a[252:253], v29 offset:8
    ds_read_b64_tr_b16 v[148:149], v30 offset:0
    ds_read_b64_tr_b16 v[156:157], v30 offset:8
    ds_read_b64_tr_b16 v[164:165], v31 offset:0
    ds_read_b64_tr_b16 v[172:173], v31 offset:8
    s_waitcnt vmcnt(12) lgkmcnt(0)
    s_barrier
    s_add_u32 m0, s43, 147456
    s_add_u32 s41, s58, 802816
    buffer_load_dwordx4 v17, s[8:11], s41 offen offset:0 nt lds
    s_add_u32 s41, s58, 834560
    buffer_load_dwordx4 v17, s[8:11], s41 offen offset:1024 nt lds
    s_add_u32 s41, s58, 931840
    buffer_load_dwordx4 v17, s[8:11], s41 offen offset:2048 nt lds
    s_add_u32 s41, s58, 963584
    buffer_load_dwordx4 v17, s[8:11], s41 offen offset:3072 nt lds
    ds_write_b64 v70, v[32:33] offset:9216
    v_add_u32 v28, 0, v24
    v_add_u32 v29, 0, v25
    v_add_u32 v30, 0, v26
    v_add_u32 v31, 0, v27
    ds_read_b64_tr_b16 a[238:239], v28 offset:0
    ds_read_b64_tr_b16 v[0:1], v28 offset:8
    ds_read_b64_tr_b16 a[246:247], v29 offset:0
    ds_read_b64_tr_b16 a[254:255], v29 offset:8
    ds_read_b64_tr_b16 v[150:151], v30 offset:0
    ds_read_b64_tr_b16 v[158:159], v30 offset:8
    ds_read_b64_tr_b16 v[166:167], v31 offset:0
    ds_read_b64_tr_b16 v[174:175], v31 offset:8
    s_waitcnt vmcnt(12) lgkmcnt(0)
    s_barrier
    s_add_u32 m0, s43, 0
    s_add_u32 s41, s59, 0
    buffer_load_dwordx4 v17, s[8:11], s41 offen offset:0 nt lds
    s_add_u32 s41, s59, 31744
    buffer_load_dwordx4 v17, s[8:11], s41 offen offset:1024 nt lds
    s_add_u32 s41, s59, 129024
    buffer_load_dwordx4 v17, s[8:11], s41 offen offset:2048 nt lds
    s_add_u32 s41, s59, 160768
    buffer_load_dwordx4 v17, s[8:11], s41 offen offset:3072 nt lds
    ds_write_b64 v70, v[0:1] offset:9224
    v_add_u32 v28, 36864, v24
    v_add_u32 v29, 36864, v25
    v_add_u32 v30, 36864, v26
    v_add_u32 v31, 36864, v27
    ds_read_b64_tr_b16 v[176:177], v28 offset:0
    ds_read_b64_tr_b16 v[184:185], v28 offset:8
    ds_read_b64_tr_b16 v[192:193], v29 offset:0
    ds_read_b64_tr_b16 v[200:201], v29 offset:8
    ds_read_b64_tr_b16 v[208:209], v30 offset:0
    ds_read_b64_tr_b16 v[216:217], v30 offset:8
    ds_read_b64_tr_b16 v[224:225], v31 offset:0
    ds_read_b64_tr_b16 v[232:233], v31 offset:8
    s_waitcnt vmcnt(12) lgkmcnt(0)
    s_barrier
    s_mov_b64 s[8:9], s[56:57]
    s_add_u32 m0, s43, 36864
    s_add_u32 s41, s60, 128
    buffer_load_dwordx4 v18, s[8:11], s41 offen offset:0 nt lds
    s_add_u32 s41, s60, 8320
    buffer_load_dwordx4 v18, s[8:11], s41 offen offset:1024 nt lds
    s_add_u32 s41, s60, 16512
    buffer_load_dwordx4 v18, s[8:11], s41 offen offset:2048 nt lds
    s_add_u32 s41, s60, 24704
    buffer_load_dwordx4 v18, s[8:11], s41 offen offset:3072 nt lds
    v_add_u32 v28, 73728, v24
    v_add_u32 v29, 73728, v25
    v_add_u32 v30, 73728, v26
    v_add_u32 v31, 73728, v27
    ds_read_b64_tr_b16 v[178:179], v28 offset:0
    ds_read_b64_tr_b16 v[186:187], v28 offset:8
    ds_read_b64_tr_b16 v[194:195], v29 offset:0
    ds_read_b64_tr_b16 v[202:203], v29 offset:8
    ds_read_b64_tr_b16 v[210:211], v30 offset:0
    ds_read_b64_tr_b16 v[218:219], v30 offset:8
    ds_read_b64_tr_b16 v[226:227], v31 offset:0
    ds_read_b64_tr_b16 v[234:235], v31 offset:8
    s_waitcnt vmcnt(12) lgkmcnt(0)
    s_barrier
    s_add_u32 m0, s43, 73728
    s_add_u32 s41, s61, 128
    buffer_load_dwordx4 v18, s[8:11], s41 offen offset:0 nt lds
    s_add_u32 s41, s61, 8320
    buffer_load_dwordx4 v18, s[8:11], s41 offen offset:1024 nt lds
    s_add_u32 s41, s61, 16512
    buffer_load_dwordx4 v18, s[8:11], s41 offen offset:2048 nt lds
    s_add_u32 s41, s61, 24704
    buffer_load_dwordx4 v18, s[8:11], s41 offen offset:3072 nt lds
    v_add_u32 v28, 110592, v24
    v_add_u32 v29, 110592, v25
    v_add_u32 v30, 110592, v26
    v_add_u32 v31, 110592, v27
    ds_read_b64_tr_b16 v[180:181], v28 offset:0
    ds_read_b64_tr_b16 v[188:189], v28 offset:8
    ds_read_b64_tr_b16 v[196:197], v29 offset:0
    ds_read_b64_tr_b16 v[204:205], v29 offset:8
    ds_read_b64_tr_b16 v[212:213], v30 offset:0
    ds_read_b64_tr_b16 v[220:221], v30 offset:8
    ds_read_b64_tr_b16 v[228:229], v31 offset:0
    ds_read_b64_tr_b16 v[236:237], v31 offset:8
    s_waitcnt vmcnt(12) lgkmcnt(0)
    s_barrier
    s_add_u32 m0, s43, 110592
    s_add_u32 s41, s62, 128
    buffer_load_dwordx4 v18, s[8:11], s41 offen offset:0 nt lds
    s_add_u32 s41, s62, 8320
    buffer_load_dwordx4 v18, s[8:11], s41 offen offset:1024 nt lds
    s_add_u32 s41, s62, 16512
    buffer_load_dwordx4 v18, s[8:11], s41 offen offset:2048 nt lds
    s_add_u32 s41, s62, 24704
    buffer_load_dwordx4 v18, s[8:11], s41 offen offset:3072 nt lds
    v_add_u32 v28, 147456, v24
    v_add_u32 v29, 147456, v25
    v_add_u32 v30, 147456, v26
    v_add_u32 v31, 147456, v27
    ds_read_b64_tr_b16 v[182:183], v28 offset:0
    ds_read_b64_tr_b16 v[190:191], v28 offset:8
    ds_read_b64_tr_b16 v[198:199], v29 offset:0
    ds_read_b64_tr_b16 v[206:207], v29 offset:8
    ds_read_b64_tr_b16 v[214:215], v30 offset:0
    ds_read_b64_tr_b16 v[222:223], v30 offset:8
    ds_read_b64_tr_b16 v[230:231], v31 offset:0
    ds_read_b64_tr_b16 v[238:239], v31 offset:8
    s_waitcnt vmcnt(12) lgkmcnt(0)
    s_barrier
    s_add_u32 m0, s43, 147456
    s_add_u32 s41, s63, 128
    buffer_load_dwordx4 v18, s[8:11], s41 offen offset:0 nt lds
    s_add_u32 s41, s63, 8320
    buffer_load_dwordx4 v18, s[8:11], s41 offen offset:1024 nt lds
    s_add_u32 s41, s63, 16512
    buffer_load_dwordx4 v18, s[8:11], s41 offen offset:2048 nt lds
    s_add_u32 s41, s63, 24704
    buffer_load_dwordx4 v18, s[8:11], s41 offen offset:3072 nt lds
    v_mov_b32 v78, v21
    v_mov_b32 v79, v22
    v_add_u32 v77, 0, v20
    ds_read_b64_tr_b16 v[240:241], v77 offset:0
    ds_read_b64_tr_b16 v[242:243], v77 offset:4096
    ds_read_b64_tr_b16 v[244:245], v77 offset:8192
    ds_read_b64_tr_b16 v[246:247], v77 offset:12288
    ds_read_b64_tr_b16 v[248:249], v77 offset:8
    ds_read_b64_tr_b16 v[250:251], v77 offset:4104
    ds_read_b64_tr_b16 v[252:253], v77 offset:8200
    ds_read_b64_tr_b16 v[254:255], v77 offset:12296
    s_waitcnt vmcnt(12) lgkmcnt(0)
    s_barrier
    v_bfe_u32 v60, v65, 4, 6
    v_and_b32 v61, 15, v60
    v_lshrrev_b32 v62, 4, v60
    v_mov_b32 v50, 0x3f80
    v_mov_b32 v51, 0x3f800000
    v_and_b32 v57, 1, v62
    v_lshlrev_b32 v57, 2, v57
    v_sub_u32 v57, v61, v57
    v_and_b32 v58, 3, v61
    v_lshlrev_b32 v58, 2, v58
    v_lshrrev_b32 v59, 2, v61
    v_add_u32 v58, v58, v59
    v_cmp_eq_u32 vcc, 0, v57
    s_nop 1
    v_cndmask_b32 v40, 0, v50, vcc
    v_cmp_eq_u32 vcc, 1, v57
    s_nop 1
    v_cndmask_b32 v40, v40, v51, vcc
    v_cmp_eq_u32 vcc, 0, v58
    s_nop 1
    v_cndmask_b32 v44, 0, v50, vcc
    v_cmp_eq_u32 vcc, 1, v58
    s_nop 1
    v_cndmask_b32 v44, v44, v51, vcc
    v_cmp_eq_u32 vcc, 2, v57
    s_nop 1
    v_cndmask_b32 v41, 0, v50, vcc
    v_cmp_eq_u32 vcc, 3, v57
    s_nop 1
    v_cndmask_b32 v41, v41, v51, vcc
    v_cmp_eq_u32 vcc, 2, v58
    s_nop 1
    v_cndmask_b32 v45, 0, v50, vcc
    v_cmp_eq_u32 vcc, 3, v58
    s_nop 1
    v_cndmask_b32 v45, v45, v51, vcc
    v_cmp_eq_u32 vcc, 8, v57
    s_nop 1
    v_cndmask_b32 v42, 0, v50, vcc
    v_cmp_eq_u32 vcc, 9, v57
    s_nop 1
    v_cndmask_b32 v42, v42, v51, vcc
    v_cmp_eq_u32 vcc, 4, v58
    s_nop 1
    v_cndmask_b32 v46, 0, v50, vcc
    v_cmp_eq_u32 vcc, 5, v58
    s_nop 1
    v_cndmask_b32 v46, v46, v51, vcc
    v_cmp_eq_u32 vcc, 10, v57
    s_nop 1
    v_cndmask_b32 v43, 0, v50, vcc
    v_cmp_eq_u32 vcc, 11, v57
    s_nop 1
    v_cndmask_b32 v43, v43, v51, vcc
    v_cmp_eq_u32 vcc, 6, v58
    s_nop 1
    v_cndmask_b32 v47, 0, v50, vcc
    v_cmp_eq_u32 vcc, 7, v58
    s_nop 1
    v_cndmask_b32 v47, v47, v51, vcc
    v_lshlrev_b32 v57, 4, v61
    ds_write_b128 v69, v[40:43] offset:15360
    ds_write_b128 v57, v[44:47] offset:15872
    v_add_u32 v77, 36864, v79
    s_waitcnt lgkmcnt(0)
    ds_read_b64_tr_b16 v[0:1], v77 offset:0
    ds_read_b64_tr_b16 v[2:3], v77 offset:256
    ds_read_b64_tr_b16 v[4:5], v77 offset:2048
    ds_read_b64_tr_b16 v[6:7], v77 offset:2304
    ds_read_b64_tr_b16 v[8:9], v77 offset:16
    ds_read_b64_tr_b16 v[10:11], v77 offset:272
    ds_read_b64_tr_b16 v[12:13], v77 offset:2064
    ds_read_b64_tr_b16 v[14:15], v77 offset:2320
    s_waitcnt vmcnt(8) lgkmcnt(0)
    s_barrier
    v_add_u32 v77, 73728, v78
    ds_read_b64_tr_b16 v[16:17], v77 offset:0
    ds_read_b64_tr_b16 v[18:19], v77 offset:256
    ds_read_b64_tr_b16 v[20:21], v77 offset:2048
    ds_read_b64_tr_b16 v[22:23], v77 offset:2304
    ds_read_b64_tr_b16 v[24:25], v77 offset:16
    ds_read_b64_tr_b16 v[26:27], v77 offset:272
    ds_read_b64_tr_b16 v[28:29], v77 offset:2064
    ds_read_b64_tr_b16 v[30:31], v77 offset:2320
    s_waitcnt vmcnt(4) lgkmcnt(0)
    s_barrier
    v_add_u32 v77, 110592, v78
    ds_read_b64_tr_b16 v[32:33], v77 offset:0
    ds_read_b64_tr_b16 v[34:35], v77 offset:256
    ds_read_b64_tr_b16 v[36:37], v77 offset:2048
    ds_read_b64_tr_b16 v[38:39], v77 offset:2304
    ds_read_b64_tr_b16 v[40:41], v77 offset:16
    ds_read_b64_tr_b16 v[42:43], v77 offset:272
    ds_read_b64_tr_b16 v[44:45], v77 offset:2064
    ds_read_b64_tr_b16 v[46:47], v77 offset:2320
    s_waitcnt vmcnt(0) lgkmcnt(0)
    s_barrier
    v_add_u32 v77, 147456, v78
    ds_read_b64_tr_b16 v[48:49], v77 offset:0
    ds_read_b64_tr_b16 v[50:51], v77 offset:256
    ds_read_b64_tr_b16 v[52:53], v77 offset:2048
    ds_read_b64_tr_b16 v[54:55], v77 offset:2304
    ds_read_b64_tr_b16 v[56:57], v77 offset:16
    ds_read_b64_tr_b16 v[58:59], v77 offset:272
    ds_read_b64_tr_b16 v[60:61], v77 offset:2064
    ds_read_b64_tr_b16 v[62:63], v77 offset:2320
    s_waitcnt lgkmcnt(0)
    s_barrier
    ds_write_b128 v70, v[0:3] offset:20480
    ds_write_b128 v70, v[4:7] offset:21504
    ds_write_b128 v70, v[8:11] offset:22528
    ds_write_b128 v70, v[12:15] offset:23552
    ds_write_b128 v70, v[16:19] offset:24576
    ds_write_b128 v70, v[20:23] offset:25600
    ds_write_b128 v70, v[24:27] offset:26624
    ds_write_b128 v70, v[28:31] offset:27648
    ds_write_b128 v70, v[32:35] offset:28672
    ds_write_b128 v70, v[36:39] offset:29696
    ds_write_b128 v70, v[40:43] offset:30720
    ds_write_b128 v70, v[44:47] offset:31744
    ds_write_b128 v70, v[48:51] offset:32768
    ds_write_b128 v70, v[52:55] offset:33792
    ds_write_b128 v70, v[56:59] offset:34816
    ds_write_b128 v70, v[60:63] offset:35840
    s_waitcnt vmcnt(0) lgkmcnt(0)
    s_barrier
    v_mov_b32 v2, 1
    s_cmp_lg_u32 s13, 0
    s_cbranch_scc1 cs_noarr
    s_mov_b64 exec, 1
    buffer_atomic_add v2, off, s[84:87], 0 offset:212
    s_mov_b32 s40, 16777216
    s_mov_b32 s42, 2
cs_startpoll:
    buffer_load_dword v3, off, s[84:87], 0 offset:212 sc1
    s_sub_u32 s40, s40, 1
    s_cbranch_scc1 cs_decide
    s_waitcnt vmcnt(0)
    v_readfirstlane_b32 s41, v3
    s_nop 1
    s_cmp_lt_u32 s41, 32
    s_cbranch_scc1 cs_startpoll
    s_mov_b32 s42, 1
cs_decide:
    s_mov_b64 exec, -1
cs_noarr:
    s_barrier
    s_mov_b32 s44, 0x3e0293ee
    s_mov_b32 s45, s44
    s_or_b32 s66, s44, 0x80000000
    s_mov_b32 s48, 0x3f003f00
    s_mov_b32 s49, 0
    s_mov_b32 s50, 0x3f803f80
    s_mov_b32 s51, 0x3f803f80
    s_mov_b32 s52, 512
    s_mov_b32 s53, 1024
    s_mov_b32 s54, 1536
    s_mov_b32 s30, 0
    s_mov_b32 s37, 0
    s_mov_b32 s98, -100
    s_lshl_b32 s47, s13, 9
    s_cmp_lg_u32 s32, 0
    s_cselect_b32 s71, s13, 3
    s_add_u32 s46, s71, 1
    s_lshr_b32 s46, s46, 1
    s_mov_b32 s14, 67649536
    s_mov_b32 s15, 67653632
    s_mov_b32 s16, 67657728
    s_mov_b32 s36, 0
    s_add_u32 s17, s68, 67633152
    s_mov_b32 s69, 0
    s_mov_b32 s70, 0
    s_lshl_b32 s26, s12, 14
    s_add_u32 s26, s26, 0
    s_mul_i32 s40, s13, 3072
    s_add_u32 s24, s26, s40
    s_add_u32 s26, s24, s33
    s_add_u32 s99, s26, 33030144
    s_lshl_b32 s96, s12, 7
    s_add_u32 s29, s96, 125845504
    s_add_u32 s96, s96, 125829120
    s_lshl_b32 s40, s12, 14
    s_add_u32 s40, s40, 68681728
    s_add_u32 s18, s40, 0
    s_add_u32 s19, s40, 4096
    s_add_u32 s20, s40, 8192
    s_add_u32 s21, s40, 12288
    s_lshr_b32 s40, s12, 3
    s_lshl_b32 s40, s40, 12
    s_and_b32 s41, s12, 7
    s_lshl_b32 s41, s41, 7
    s_add_u32 s40, s40, s41
    s_add_u32 s22, s40, 68681728
    s_add_u32 s23, s22, 1024
    s_add_u32 s25, s22, 2048
    s_mov_b32 s56, -65472
    s_cmp_lg_u32 s32, 0
    s_cselect_b64 s[38:39], -1, 0
    s_add_u32 s55, s68, 138412032
    s_cmp_eq_u32 s13, 3
    s_cselect_b64 s[100:101], 1, 0
    s_cselect_b64 s[38:39], 1, s[38:39]
    s_cselect_b32 s93, 64, 0
    s_cselect_b32 s55, s29, s55
    s_cselect_b32 s57, 0, 9216
    s_mov_b32 s34, 0xff00ff00
    s_mov_b32 s35, 0xff00ff00
    s_lshl_b32 s28, s12, 12
    s_add_u32 s28, s28, 7340032
    s_add_u32 s27, s28, 77594624
    s_add_u32 s28, s28, 69206016
    s_mov_b64 exec, s[100:101]
    v_mov_b32 v72, s95
    s_mov_b64 exec, -1
    s_mov_b32 s40, 3
    v_bfe_u32 v78, v65, 2, 5
    s_mov_b32 s31, 4194304
cs_kv0:
    buffer_load_dword v77, v78, s[4:7], s96 offen offset:16 sc1
    s_waitcnt vmcnt(0)
    v_subrev_u32 v77, s95, v77
    v_cmp_lt_u32 vcc, 16, v77
    s_nop 1
    v_cndmask_b32 v77, v77, 0, vcc
    v_bfe_u32 v79, v78, 2, 2
    v_lshl_add_u32 v77, v77, 2, v79
    s_nop 1
    v_min_u32_dpp v77, v77, v77 row_ror:1 row_mask:0xf bank_mask:0xf
    s_nop 1
    v_min_u32_dpp v77, v77, v77 row_ror:2 row_mask:0xf bank_mask:0xf
    s_nop 1
    v_min_u32_dpp v77, v77, v77 row_ror:4 row_mask:0xf bank_mask:0xf
    s_nop 0
    v_readfirstlane_b32 s97, v77
    s_sub_u32 s31, s31, 1
    s_cbranch_scc1 cs_kv0_x
    s_cmp_le_u32 s40, s97
    s_cbranch_scc1 cs_kv0_x
    s_sleep 2
    s_branch cs_kv0
cs_kv0_x:
    s_add_u32 s40, s26, 0
    s_min_u32 s40, s40, s99
    s_sub_u32 s41, s96, s40
    v_bfe_u32 v77, v65, 2, 5
    v_add3_u32 v77, v77, s41, 16
    v_lshlrev_b32 v78, 3, v69
    s_nop 0
    v_mov_b32_dpp v78, v77 quad_perm:[0,1,2,3] row_mask:0xc bank_mask:0xf
    buffer_load_dword v76, v78, s[4:7], s40 offen sc1
    s_add_u32 s40, s26, 524288
    s_min_u32 s40, s40, s99
    s_sub_u32 s41, s96, s40
    v_bfe_u32 v77, v65, 2, 5
    v_add3_u32 v77, v77, s41, 16
    v_lshlrev_b32 v78, 3, v69
    s_nop 0
    v_mov_b32_dpp v78, v77 quad_perm:[0,1,2,3] row_mask:0xc bank_mask:0xf
    buffer_load_dword v76, v78, s[4:7], s40 offen sc1
cs_kvdone:
    v_mov_b64 v[0:1], 0
    v_mov_b64 v[2:3], 0
    v_mov_b64 v[4:5], 0
    v_mov_b64 v[6:7], 0
    v_mov_b64 v[8:9], 0
    v_mov_b64 v[10:11], 0
    v_mov_b64 v[12:13], 0
    v_mov_b64 v[14:15], 0
    v_mov_b64 v[16:17], 0
    v_mov_b64 v[18:19], 0
    v_mov_b64 v[20:21], 0
    v_mov_b64 v[22:23], 0
    ds_read_b128 v[44:47], v70 offset:0
    ds_read_b128 v[48:51], v70 offset:1024
    ds_read_b128 v[52:55], v70 offset:2048
    ds_read_b128 v[56:59], v70 offset:3072
    ds_read_b128 v[24:27], v70 offset:4096
    ds_read_b128 v[28:31], v70 offset:5120
    ds_read_b128 v[32:35], v70 offset:6144
    ds_read_b128 v[36:39], v70 offset:7168
    buffer_load_dwordx4 v[40:43], v65, s[4:7], s14 offen offset:0 sc1
    buffer_load_dwordx4 v[60:63], v66, s[4:7], s14 offen offset:0 sc1
    s_mov_b32 s31, 1048576
    s_waitcnt vmcnt(0) lgkmcnt(0)
    s_branch cs_goA
cs_loop:
    s_mov_b32 s31, 1048576
    s_mov_b32 s69, s70
    s_waitcnt lgkmcnt(0)
cs_cA:
    buffer_load_dwordx4 v[40:43], v65, s[4:7], s14 offen offset:0 sc1
    buffer_load_dwordx4 v[60:63], v66, s[4:7], s14 offen offset:0 sc1
cs_cA1:
    v_bitop3_b32 v77, v40, v60, s70 bitop3:0x7e
    v_and_b32 v77, 1, v77
    v_cmp_ne_u32 vcc, 0, v77
    s_cbranch_vccz cs_goA
    s_nop 15
    s_nop 15
    s_nop 7
    v_bitop3_b32 v77, v40, v60, s70 bitop3:0x7e
    v_and_b32 v77, 1, v77
    v_cmp_ne_u32 vcc, 0, v77
    s_cbranch_vccz cs_goA
    s_nop 15
    s_nop 15
    s_nop 7
    v_bitop3_b32 v77, v40, v60, s70 bitop3:0x7e
    v_and_b32 v77, 1, v77
    v_cmp_ne_u32 vcc, 0, v77
    s_cbranch_vccz cs_goA
    s_nop 15
    s_nop 15
    s_nop 7
    v_bitop3_b32 v77, v40, v60, s70 bitop3:0x7e
    v_and_b32 v77, 1, v77
    v_cmp_ne_u32 vcc, 0, v77
    s_cbranch_vccz cs_goA
    s_nop 15
    s_nop 15
    s_nop 7
    buffer_load_dwordx4 v[40:43], v65, s[4:7], s14 offen offset:0 sc1
    buffer_load_dwordx4 v[60:63], v66, s[4:7], s14 offen offset:0 sc1
    v_bitop3_b32 v77, v40, v60, s70 bitop3:0x7e
    v_and_b32 v77, 1, v77
    v_cmp_ne_u32 vcc, 0, v77
    s_cbranch_vccz cs_goA
    s_nop 15
    s_nop 15
    s_nop 7
    v_bitop3_b32 v77, v40, v60, s70 bitop3:0x7e
    v_and_b32 v77, 1, v77
    v_cmp_ne_u32 vcc, 0, v77
    s_cbranch_vccz cs_goA
    s_nop 15
    s_nop 15
    s_nop 7
    v_bitop3_b32 v77, v40, v60, s70 bitop3:0x7e
    v_and_b32 v77, 1, v77
    v_cmp_ne_u32 vcc, 0, v77
    s_cbranch_vccz cs_goA
    s_nop 15
    s_nop 15
    s_nop 7
    v_bitop3_b32 v77, v40, v60, s70 bitop3:0x7e
    v_and_b32 v77, 1, v77
    v_cmp_ne_u32 vcc, 0, v77
    s_cbranch_vccz cs_goA
    s_nop 15
    s_nop 15
    s_nop 7
    buffer_load_dwordx4 v[40:43], v65, s[4:7], s14 offen offset:0 sc1
    buffer_load_dwordx4 v[60:63], v66, s[4:7], s14 offen offset:0 sc1
    v_bitop3_b32 v77, v40, v60, s70 bitop3:0x7e
    v_and_b32 v77, 1, v77
    v_cmp_ne_u32 vcc, 0, v77
    s_cbranch_vccz cs_goA
    s_nop 15
    s_nop 15
    s_nop 7
    v_bitop3_b32 v77, v40, v60, s70 bitop3:0x7e
    v_and_b32 v77, 1, v77
    v_cmp_ne_u32 vcc, 0, v77
    s_cbranch_vccz cs_goA
    s_nop 15
    s_nop 15
    s_nop 7
    v_bitop3_b32 v77, v40, v60, s70 bitop3:0x7e
    v_and_b32 v77, 1, v77
    v_cmp_ne_u32 vcc, 0, v77
    s_cbranch_vccz cs_goA
    s_nop 15
    s_nop 15
    s_nop 7
    v_bitop3_b32 v77, v40, v60, s70 bitop3:0x7e
    v_and_b32 v77, 1, v77
    v_cmp_ne_u32 vcc, 0, v77
    s_cbranch_vccz cs_goA
    s_nop 15
    s_nop 15
    s_nop 7
    buffer_load_dwordx4 v[40:43], v65, s[4:7], s14 offen offset:0 sc1
    buffer_load_dwordx4 v[60:63], v66, s[4:7], s14 offen offset:0 sc1
    v_bitop3_b32 v77, v40, v60, s70 bitop3:0x7e
    v_and_b32 v77, 1, v77
    v_cmp_ne_u32 vcc, 0, v77
    s_cbranch_vccz cs_goA
    s_nop 15
    s_nop 15
    s_nop 7
    v_bitop3_b32 v77, v40, v60, s70 bitop3:0x7e
    v_and_b32 v77, 1, v77
    v_cmp_ne_u32 vcc, 0, v77
    s_cbranch_vccz cs_goA
    s_nop 15
    s_nop 15
    s_nop 7
    v_bitop3_b32 v77, v40, v60, s70 bitop3:0x7e
    v_and_b32 v77, 1, v77
    v_cmp_ne_u32 vcc, 0, v77
    s_cbranch_vccz cs_goA
    s_nop 15
    s_nop 15
    s_nop 7
    v_bitop3_b32 v77, v40, v60, s70 bitop3:0x7e
    v_and_b32 v77, 1, v77
    v_cmp_ne_u32 vcc, 0, v77
    s_cbranch_vccz cs_goA
    s_nop 15
    s_nop 15
    s_nop 7
    s_sub_u32 s31, s31, 64
    s_cbranch_scc0 cs_cA
cs_goA:
    ds_write_b128 v65, v[40:43] offset:0
    v_smfmac_f32_16x16x64_bf16 v[0:3], v[40:43], v[44:51], v64
    v_smfmac_f32_16x16x64_bf16 v[4:7], v[40:43], v[52:59], v64
    buffer_load_dwordx4 v[44:47], v65, s[4:7], s15 offen offset:0 sc1
    v_smfmac_f32_16x16x64_bf16 v[0:3], v[60:63], v[24:31], v64
    s_add_u32 s40, s26, 1048576
    s_min_u32 s40, s40, s99
    s_sub_u32 s41, s96, s40
    v_smfmac_f32_16x16x64_bf16 v[4:7], v[60:63], v[32:39], v64
    ds_read_b128 v[24:27], v70 offset:8192
    s_cmp_lt_u32 s97, s93
    s_cselect_b32 s41, s41, 0
    v_smfmac_f32_16x16x64_bf16 v[8:11], v[40:43], a[96:103], v64
    ds_read_b128 v[28:31], v70 offset:9216
    v_smfmac_f32_16x16x64_bf16 v[12:15], v[40:43], a[104:111], v64
    ds_read_b128 v[32:35], v70 offset:10240
    s_waitcnt lgkmcnt(3)
    s_barrier
    ds_read_b128 v[48:51], v67 offset:0
    v_smfmac_f32_16x16x64_bf16 v[8:11], v[60:63], a[112:119], v64
    ds_read_b128 v[36:39], v70 offset:11264
    v_bitop3_b32 v79, v73, -9, s54 bitop3:0x6a
    v_smfmac_f32_16x16x64_bf16 v[12:15], v[60:63], a[120:127], v64
    buffer_load_dwordx4 v[44:47], v65, s[4:7], s15 offen offset:0 sc1
    v_smfmac_f32_16x16x64_bf16 v[16:19], v[40:43], a[232:239], v64
    ds_read_b128 v[52:55], v68 offset:0
    s_waitcnt lgkmcnt(4)
    v_bfe_u32 v77, v65, 2, 5
    v_smfmac_f32_16x16x64_bf16 v[20:23], v[40:43], v[24:31], v64
    ds_read_b128 v[24:27], v70 offset:12288
    s_waitcnt lgkmcnt(3)
    v_smfmac_f32_16x16x64_bf16 v[0:3], v[48:51], a[0:7], v64
    ds_read_b128 v[28:31], v70 offset:13312
    s_waitcnt lgkmcnt(3)
    v_add3_u32 v77, v77, s41, 16
    v_smfmac_f32_16x16x64_bf16 v[4:7], v[48:51], v[32:39], v64
    buffer_load_dwordx4 v[40:43], v65, s[4:7], s16 offen offset:0 sc1
    v_smfmac_f32_16x16x64_bf16 v[16:19], v[60:63], a[240:247], v64
    ds_read_b128 v[32:35], v70 offset:14336
    v_lshlrev_b32 v78, 3, v69
    v_smfmac_f32_16x16x64_bf16 v[20:23], v[60:63], a[248:255], v64
    ds_read_b128 v[36:39], v70 offset:15360
    v_smfmac_f32_16x16x64_bf16 v[8:11], v[48:51], a[128:135], v64
    s_waitcnt vmcnt(2)
    v_mov_b32_dpp v78, v77 quad_perm:[0,1,2,3] row_mask:0xc bank_mask:0xf
    v_smfmac_f32_16x16x64_bf16 v[12:15], v[48:51], a[136:143], v64
    buffer_load_dwordx4 v[58:61], v65, s[4:7], s24 offen offset:3072 sc1
    s_waitcnt lgkmcnt(2)
    v_and_b32 v77, s36, v44
    v_smfmac_f32_16x16x64_bf16 v[12:15], v[52:55], v[24:31], v64
    ds_write_b128 v65, v[44:47] offset:4096
    v_smfmac_f32_16x16x64_bf16 v[0:3], v[52:55], a[8:15], v64
    v_cmp_ne_u32 vcc, s70, v77
    v_smfmac_f32_16x16x64_bf16 v[8:11], v[52:55], a[144:151], v64
    buffer_load_dwordx4 v[24:27], v65, s[4:7], s24 offen offset:0 sc1
    s_waitcnt lgkmcnt(1)
    v_smfmac_f32_16x16x64_bf16 v[4:7], v[52:55], v[32:39], v64
    s_cbranch_vccnz cs_spinB
cs_backB:
    v_smfmac_f32_16x16x64_bf16 v[16:19], v[44:47], v[176:183], v64
    s_waitcnt lgkmcnt(0)
    s_barrier
    ds_read_b128 v[48:51], v66 offset:4096
    v_smfmac_f32_16x16x64_bf16 v[12:15], v[44:47], a[160:167], v64
    buffer_load_dwordx4 v[28:31], v65, s[4:7], s24 offen offset:1024 sc1
    v_smfmac_f32_16x16x64_bf16 v[0:3], v[44:47], a[16:23], v64
    ds_read_b128 v[52:55], v67 offset:4096
    v_smfmac_f32_16x16x64_bf16 v[8:11], v[44:47], a[152:159], v64
    v_smfmac_f32_16x16x64_bf16 v[4:7], v[44:47], a[24:31], v64
    buffer_load_dwordx4 v[34:37], v65, s[4:7], s24 offen offset:2048 sc1
    s_waitcnt vmcnt(5)
    v_smfmac_f32_16x16x64_bf16 v[20:23], v[44:47], v[184:191], v64
    ds_read_b128 v[44:47], v68 offset:4096
    s_waitcnt lgkmcnt(2)
    v_smfmac_f32_16x16x64_bf16 v[0:3], v[48:51], a[32:39], v64
    v_smfmac_f32_16x16x64_bf16 v[8:11], v[48:51], a[168:175], v64
    buffer_load_dword v76, v78, s[4:7], s40 offen sc1
    v_smfmac_f32_16x16x64_bf16 v[4:7], v[48:51], a[40:47], v64
    s_waitcnt vmcnt(5)
    v_and_b32 v77, s36, v40
    v_smfmac_f32_16x16x64_bf16 v[12:15], v[48:51], a[176:183], v64
    ds_read_b128 v[48:51], v69 offset:15360
    s_waitcnt lgkmcnt(1)
    v_cmp_ne_u32 vcc, s70, v77
    v_smfmac_f32_16x16x64_bf16 v[0:3], v[52:55], a[48:55], v64
    v_smfmac_f32_16x16x64_bf16 v[8:11], v[52:55], a[184:191], v64
    s_cbranch_vccnz cs_spin8
cs_back8:
    v_smfmac_f32_16x16x64_bf16 v[0:3], v[44:47], a[64:71], v64
    v_smfmac_f32_16x16x64_bf16 v[8:11], v[44:47], a[200:207], v64
    v_smfmac_f32_16x16x64_bf16 v[0:3], v[40:43], a[80:87], v64
    s_nop 1
    v_smfmac_f32_16x16x64_bf16 v[8:11], v[40:43], a[216:223], v64
    s_nop 1
    v_lshrrev_b32 v77, 1, v69
    v_smfmac_f32_16x16x64_bf16 v[4:7], v[52:55], a[56:63], v64
    s_nop 1
    v_cvt_pk_bf16_f32 v0, v0, v1
    v_smfmac_f32_16x16x64_bf16 v[12:15], v[52:55], a[192:199], v64
    s_nop 1
    v_cvt_pk_bf16_f32 v1, v2, v3
    v_smfmac_f32_16x16x64_bf16 v[4:7], v[44:47], a[72:79], v64
    s_nop 1
    v_cvt_pk_bf16_f32 v2, v8, v9
    v_smfmac_f32_16x16x64_bf16 v[12:15], v[44:47], a[208:215], v64
    s_nop 1
    v_cvt_pk_bf16_f32 v3, v10, v11
    v_smfmac_f32_16x16x64_bf16 v[4:7], v[40:43], a[88:95], v64
    s_waitcnt lgkmcnt(0)
    s_nop 0
    s_nop 0
    v_smfmac_f32_16x16x64_bf16 v[12:15], v[40:43], a[224:231], v64
    s_nop 2
    v_mfma_f32_16x16x32_bf16 v[8:11], v[0:3], v[48:51], 0
    s_nop 0
    v_cvt_pk_bf16_f32 v4, v4, v5
    v_cvt_pk_bf16_f32 v5, v6, v7
    s_nop 0
    v_cvt_pk_bf16_f32 v6, v12, v13
    v_cvt_pk_bf16_f32 v7, v14, v15
    s_nop 1
    v_mfma_f32_16x16x32_bf16 v[12:15], v[4:7], v[48:51], 0
    ds_read_b128 v[48:51], v66 offset:4096
    v_cvt_pk_bf16_f32 v0, v8, v9
    v_cvt_pk_bf16_f32 v1, v10, v11
    v_smfmac_f32_16x16x64_bf16 v[16:19], v[52:55], v[208:215], v64
    s_waitcnt vmcnt(2)
    s_nop 2
    v_cvt_pk_bf16_f32 v2, v12, v13
    v_cvt_pk_bf16_f32 v3, v14, v15
    s_nop 1
    v_mfma_f32_16x16x32_bf16 v[12:15], v[0:3], v[0:3], 0
    s_nop 1
    v_bitop3_b32 v78, v73, -9, s53 bitop3:0x6a
    v_mfma_f32_16x16x32_bf16 v[4:7], v[24:27], v[0:3], 0
    ds_read_b128 v[24:27], v67 offset:0
    s_nop 1
    v_mfma_f32_16x16x32_bf16 v[8:11], v[28:31], v[0:3], 0
    s_nop 0
    v_mov_b32_dpp v12, v14 row_ror:8 row_mask:0xf bank_mask:0xc
    v_mov_b32_dpp v13, v15 row_ror:8 row_mask:0xf bank_mask:0xc
    v_smfmac_f32_16x16x64_bf16 v[20:23], v[52:55], v[216:223], v64
    ds_write_b64 v71, v[12:13]
    ds_read_b128 v[52:55], v68 offset:0
    s_nop 1
    v_mov_b32_dpp v4, v8 row_ror:8 row_mask:0xf bank_mask:0xc
    v_mov_b32_dpp v5, v9 row_ror:8 row_mask:0xf bank_mask:0xc
    v_mov_b32_dpp v6, v10 row_ror:8 row_mask:0xf bank_mask:0xc
    v_mov_b32_dpp v7, v11 row_ror:8 row_mask:0xf bank_mask:0xc
    v_smfmac_f32_16x16x64_bf16 v[16:19], v[44:47], v[224:231], v64
    ds_write_b128 v65, v[4:7] offset:8192
    v_smfmac_f32_16x16x64_bf16 v[20:23], v[44:47], v[232:239], v64
    s_waitcnt lgkmcnt(3)
    v_smfmac_f32_16x16x64_bf16 v[16:19], v[24:27], v[144:151], v64
    s_waitcnt vmcnt(1)
    v_smfmac_f32_16x16x64_bf16 v[20:23], v[24:27], v[152:159], v64
    s_mov_b64 exec, s[38:39]
    buffer_store_dword v72, v75, s[4:7], s55 offen sc1
    s_mov_b64 exec, -1
    v_smfmac_f32_16x16x64_bf16 v[16:19], v[40:43], v[240:247], v64
    s_cmp_ge_u32 s30, 56
    s_waitcnt lgkmcnt(0)
    s_barrier
    ds_read_b128 v[8:11], v66 offset:8192
    v_smfmac_f32_16x16x64_bf16 v[20:23], v[40:43], v[248:255], v64
    ds_read_b128 v[12:15], v67 offset:8192
    v_smfmac_f32_16x16x64_bf16 v[16:19], v[48:51], v[192:199], v64
    ds_read_b128 v[44:47], v68 offset:8192
    v_smfmac_f32_16x16x64_bf16 v[20:23], v[48:51], v[200:207], v64
    ds_read_b64 v[24:25], v77 offset:14336
    ds_read_b64 v[26:27], v77 offset:14592
    v_smfmac_f32_16x16x64_bf16 v[16:19], v[52:55], v[160:167], v64
    ds_read_b64 v[28:29], v77 offset:14848
    ds_read_b64 v[30:31], v77 offset:15104
    v_bitop3_b32 v77, v73, -9, s52 bitop3:0x6a
    v_smfmac_f32_16x16x64_bf16 v[20:23], v[52:55], v[168:175], v64
    s_cbranch_scc1 cs_rare
cs_rare_x:
    ds_read_b128 v[48:51], v70 offset:22528
    ds_read_b128 v[52:55], v70 offset:23552
    s_waitcnt lgkmcnt(6)
    v_pk_add_f32 v[4:5], v[4:5], v[8:9]
    v_pk_add_f32 v[6:7], v[6:7], v[10:11]
    v_pk_add_f32 v[12:13], v[12:13], v[44:45]
    v_pk_add_f32 v[14:15], v[14:15], v[46:47]
    v_pk_add_f32 v[4:5], v[4:5], v[12:13]
    v_pk_add_f32 v[6:7], v[6:7], v[14:15]
    s_waitcnt lgkmcnt(2)
    v_pk_add_f32 v[24:25], v[24:25], v[26:27]
    v_pk_add_f32 v[28:29], v[28:29], v[30:31]
    v_max3_f32 v8, v4, v5, v6
    v_pk_add_f32 v[24:25], v[24:25], v[28:29]
    v_max_f32 v8, v8, v7
    v_max3_f32 v8, v8, v24, v25
    v_cvt_pk_bf16_f32 v32, v16, v17
    v_cvt_pk_bf16_f32 v38, v18, v19
    v_max_f32_dpp v8, v8, v8 row_ror:8 row_mask:0xf bank_mask:0xf
    v_mov_b32 v9, v8
    v_cvt_pk_bf16_f32 v56, v20, v21
    v_cvt_pk_bf16_f32 v62, v22, v23
    v_permlane32_swap_b32 v8, v9
    v_max_f32 v8, v8, v9
    v_mov_b32 v9, v8
    v_mov_b32 v11, 0
    v_mov_b32 v15, 0
    v_permlane16_swap_b32 v8, v9
    v_max_f32 v8, v8, v9
    v_mul_f32 v8, s66, v8
    v_pk_fma_f32 v[4:5], v[4:5], s[44:45], v[8:9] op_sel_hi:[1,1,0]
    v_pk_fma_f32 v[6:7], v[6:7], s[44:45], v[8:9] op_sel_hi:[1,1,0]
    v_pk_fma_f32 v[24:25], v[24:25], s[44:45], v[8:9] op_sel_hi:[1,1,0]
    v_exp_f32 v4, v4
    v_exp_f32 v5, v5
    v_exp_f32 v6, v6
    v_exp_f32 v7, v7
    v_exp_f32 v24, v24
    v_exp_f32 v25, v25
    v_cvt_pk_bf16_f32 v12, v4, v5
    v_cvt_pk_bf16_f32 v13, v6, v7
    v_cvt_pk_bf16_f32 v10, v24, v25
    v_cvt_pk_bf16_f32 v14, v24, v25
    v_mov_b64 v[0:1], s[48:49]
    v_mfma_f32_16x16x32_bf16 v[4:7], v[32:35], v[10:13], 0
    ds_read_b128 v[40:43], v70 offset:20480
    v_mov_b64 v[2:3], s[50:51]
    v_mfma_f32_16x16x32_bf16 v[24:27], v[36:39], v[12:15], 0
    ds_read_b128 v[44:47], v70 offset:21504
    v_mov_b64 v[8:9], 0
    v_mfma_f32_16x16x32_bf16 v[28:31], v[0:3], v[10:13], 0
    ds_read_b128 v[32:35], v70 offset:24576
    v_mov_b64 v[0:1], 0
    v_mfma_f32_16x16x32_bf16 v[16:19], v[56:59], v[10:13], 0
    ds_read_b128 v[36:39], v70 offset:25600
    v_mov_b64 v[2:3], 0
    v_mfma_f32_16x16x32_bf16 v[20:23], v[60:63], v[12:15], 0
    ds_read_b128 v[56:59], v70 offset:28672
    v_add_f32_dpp v4, v24, v4 row_ror:8 row_mask:0xf bank_mask:0xf
    v_add_f32_dpp v5, v25, v5 row_ror:8 row_mask:0xf bank_mask:0xf
    v_add_f32_dpp v6, v26, v6 row_ror:8 row_mask:0xf bank_mask:0xf
    v_add_f32_dpp v7, v27, v7 row_ror:8 row_mask:0xf bank_mask:0xf
    v_add_f32_dpp v29, v28, v28 row_ror:8 row_mask:0xf bank_mask:0xf
    v_rcp_f32 v28, v29
    v_mov_b64 v[10:11], 0
    v_add_f32_dpp v4, v16, v20 row_ror:8 row_mask:0xf bank_mask:0xc
    v_add_f32_dpp v5, v17, v21 row_ror:8 row_mask:0xf bank_mask:0xc
    v_add_f32_dpp v6, v18, v22 row_ror:8 row_mask:0xf bank_mask:0xc
    v_add_f32_dpp v7, v19, v23 row_ror:8 row_mask:0xf bank_mask:0xc
    v_pk_mul_f32 v[4:5], v[4:5], v[28:29] op_sel_hi:[1,0]
    v_pk_mul_f32 v[6:7], v[6:7], v[28:29] op_sel_hi:[1,0]
    v_cvt_pk_bf16_f32 v4, v4, v5
    v_cvt_pk_bf16_f32 v5, v6, v7
    ds_write_b64 v73, v[4:5] offset:12288
    v_mov_b32_dpp v6, v4 row_ror:8 row_mask:0xf bank_mask:0xf
    v_mov_b32_dpp v7, v5 row_ror:8 row_mask:0xf bank_mask:0xf
    v_mov_b64 v[12:13], 0
    v_mov_b64 v[14:15], 0
    v_smfmac_f32_16x16x64_bf16 v[8:11], v[4:7], v[80:87], v64
    s_waitcnt lgkmcnt(4)
    v_mov_b64 v[24:25], 0
    v_smfmac_f32_16x16x64_bf16 v[0:3], v[4:7], v[40:47], v64
    ds_read_b128 v[60:63], v70 offset:29696
    v_mov_b64 v[26:27], 0
    v_smfmac_f32_16x16x64_bf16 v[12:15], v[4:7], v[112:119], v64
    s_waitcnt lgkmcnt(1)
    s_barrier
    ds_read_b128 v[16:19], v77 offset:12288
    v_smfmac_f32_16x16x64_bf16 v[24:27], v[4:7], v[48:55], v64
    ds_read_b128 v[20:23], v78 offset:12288
    ds_read_b128 v[28:31], v79 offset:12288
    v_mov_b64 v[4:5], 0
    v_mov_b64 v[6:7], 0
    v_bfe_u32 v77, v74, 16, 1
    v_mad_i32_i24 v77, v77, s56, v74
    s_waitcnt lgkmcnt(2)
    v_smfmac_f32_16x16x64_bf16 v[8:11], v[16:19], v[88:95], v64
    ds_read_b128 v[40:43], v70 offset:32768
    s_waitcnt lgkmcnt(2)
    v_smfmac_f32_16x16x64_bf16 v[8:11], v[20:23], v[96:103], v64
    ds_read_b128 v[44:47], v70 offset:33792
    s_waitcnt lgkmcnt(2)
    v_smfmac_f32_16x16x64_bf16 v[8:11], v[28:31], v[104:111], v64
    ds_read_b128 v[48:51], v70 offset:26624
    s_nop 0
    v_and_b32 v72, 8, v73
    v_smfmac_f32_16x16x64_bf16 v[0:3], v[16:19], v[32:39], v64
    ds_read_b128 v[52:55], v70 offset:27648
    s_nop 0
    v_mad_u32_u24 v72, v72, 63, v73
    v_smfmac_f32_16x16x64_bf16 v[12:15], v[16:19], v[120:127], v64
    ds_read_b128 v[32:35], v70 offset:30720
    v_cvt_pk_bf16_f32 v8, v8, v9
    v_cvt_pk_bf16_f32 v9, v10, v11
    v_and_or_b32 v8, v8, -2, s69
    v_smfmac_f32_16x16x64_bf16 v[12:15], v[20:23], v[128:135], v64
    buffer_store_dwordx2 v[8:9], v74, s[4:7], s22 offen offset:0 sc1
    ds_read_b128 v[36:39], v70 offset:31744
    v_smfmac_f32_16x16x64_bf16 v[12:15], v[28:31], v[136:143], v64
    s_add_u32 s30, s30, 1
    s_xor_b32 s70, s70, 1
    v_subrev_u32 v72, s47, v72
    v_smfmac_f32_16x16x64_bf16 v[0:3], v[20:23], v[56:63], v64
    ds_read_b128 v[56:59], v70 offset:34816
    s_waitcnt lgkmcnt(3)
    s_nop 0
    v_smfmac_f32_16x16x64_bf16 v[0:3], v[28:31], v[40:47], v64
    ds_read_b128 v[60:63], v70 offset:35840
    v_cvt_pk_bf16_f32 v12, v12, v13
    v_cvt_pk_bf16_f32 v13, v14, v15
    v_and_or_b32 v12, v12, -2, s69
    v_smfmac_f32_16x16x64_bf16 v[24:27], v[16:19], v[48:55], v64
    buffer_store_dwordx2 v[12:13], v74, s[4:7], s22 offen offset:64 sc1
    s_waitcnt lgkmcnt(2)
    v_smfmac_f32_16x16x64_bf16 v[24:27], v[20:23], v[32:39], v64
    ds_read_b128 v[40:43], v70 offset:16384
    v_cvt_pk_bf16_f32 v0, v0, v1
    v_cvt_pk_bf16_f32 v1, v2, v3
    v_and_or_b32 v0, v0, -2, s69
    s_waitcnt lgkmcnt(1)
    v_smfmac_f32_16x16x64_bf16 v[24:27], v[28:31], v[56:63], v64
    buffer_store_dwordx2 v[0:1], v74, s[4:7], s23 offen offset:0 sc1
    ds_read_b128 v[44:47], v70 offset:17408
    ds_read_b128 v[8:11], v72 offset:12288
    ds_read_b128 v[48:51], v70 offset:18432
    ds_read_b128 v[52:55], v70 offset:19456
    ds_read_b128 v[12:15], v72 offset:13312
    s_cmp_lg_u32 s71, 0
    s_nop 0
    v_cvt_pk_bf16_f32 v24, v24, v25
    v_cvt_pk_bf16_f32 v25, v26, v27
    v_and_or_b32 v24, v24, -2, s69
    buffer_store_dwordx2 v[24:25], v74, s[4:7], s23 offen offset:64 sc1
    s_waitcnt lgkmcnt(3)
    v_smfmac_f32_16x16x64_bf16 v[4:7], v[8:11], v[40:47], v64
    s_waitcnt lgkmcnt(0)
    v_smfmac_f32_16x16x64_bf16 v[4:7], v[12:15], v[48:55], v64
    s_nop 7
    v_cvt_pk_bf16_f32 v4, v4, v5
    v_cvt_pk_bf16_f32 v5, v6, v7
    v_and_or_b32 v4, v4, -2, s69
    buffer_store_dwordx2 v[4:5], v77, s[4:7], s25 offen offset:0 sc1
    s_nop 0
    s_cbranch_scc1 cs_e1
    s_cmp_lg_u32 s37, 0
    s_cbranch_scc1 cs_f0_xt
cs_f0_xtx:
    s_nop 2
    v_mov_b32 v79, v79
    s_nop 2
    v_mov_b32 v79, v79
    s_nop 2
    v_mov_b32 v79, v79
    s_nop 2
    v_mov_b32 v79, v79
    s_nop 2
    v_mov_b32 v79, v79
    s_nop 2
    v_mov_b32 v79, v79
    s_nop 2
    v_mov_b32 v79, v79
    s_nop 2
    v_mov_b32 v79, v79
    s_nop 2
    v_mov_b32 v79, v79
    s_nop 2
    v_mov_b32 v79, v79
    s_nop 2
    v_mov_b32 v79, v79
    s_nop 2
    v_mov_b32 v79, v79
    s_nop 2
    v_mov_b32 v79, v79
    s_nop 2
    v_mov_b32 v79, v79
    s_nop 2
    v_mov_b32 v79, v79
    s_nop 2
    v_mov_b32 v79, v79
    s_nop 2
    v_mov_b32 v79, v79
    s_nop 2
    v_mov_b32 v79, v79
    s_nop 2
    v_mov_b32 v79, v79
    s_nop 2
    v_mov_b32 v79, v79
    s_nop 2
    v_mov_b32 v79, v79
    s_nop 2
    v_mov_b32 v79, v79
    s_nop 2
    v_mov_b32 v79, v79
    s_nop 2
    v_mov_b32 v79, v79
    s_nop 2
    v_mov_b32 v79, v79
    s_nop 2
    v_mov_b32 v79, v79
    s_nop 2
    v_mov_b32 v79, v79
    s_nop 2
    v_mov_b32 v79, v79
    s_nop 2
    v_mov_b32 v79, v79
    s_nop 2
    v_mov_b32 v79, v79
    s_nop 2
    v_mov_b32 v79, v79
    s_nop 2
    v_mov_b32 v79, v79
    s_nop 2
    v_mov_b32 v79, v79
    s_nop 2
    v_mov_b32 v79, v79
    s_nop 2
    v_mov_b32 v79, v79
    s_nop 2
    v_mov_b32 v79, v79
    s_nop 0
    v_mov_b32 v79, v79
    buffer_load_dwordx4 v[8:11], v65, s[4:7], s18 offen sc1
    buffer_load_dwordx4 v[12:15], v65, s[4:7], s19 offen sc1
    buffer_load_dwordx4 v[16:19], v65, s[4:7], s20 offen sc1
    buffer_load_dwordx4 v[20:23], v65, s[4:7], s21 offen sc1
    v_and_b32 v77, 255, v69
    ds_read_b128 v[4:7], v77 offset:15872
    ds_read_b128 v[44:47], v70 offset:0
    ds_read_b128 v[48:51], v70 offset:1024
    ds_read_b128 v[52:55], v70 offset:2048
    ds_read_b128 v[56:59], v70 offset:3072
    ds_read_b128 v[24:27], v70 offset:4096
    ds_read_b128 v[28:31], v70 offset:5120
    ds_read_b128 v[32:35], v70 offset:6144
    ds_read_b128 v[36:39], v70 offset:7168
    s_mov_b32 s31, 65536
    s_add_u32 s24, s24, 524288
    s_add_u32 s26, s26, 524288
    s_add_u32 s55, s55, s57
    s_mov_b32 s14, 67633152
    s_mov_b32 s15, 67637248
    s_mov_b32 s16, 67641344
    s_mov_b32 s36, 1
    v_mov_b32 v40, s69
    v_mov_b32 v60, s69
    v_and_b32 v79, 12, v75
    v_cmp_eq_u32 vcc, 0, v79
    s_nop 1
    v_cndmask_b32 v79, 0, 1, vcc
    s_waitcnt lgkmcnt(0)
    s_waitcnt vmcnt(3)
    v_bitop3_b32 v77, v8, v10, s69 bitop3:0x7e
    v_mfma_f32_16x16x32_bf16 v[0:3], v[4:7], v[8:11], 0
    v_mov_b64 v[8:9], 0
    v_mov_b64 v[10:11], 0
    s_waitcnt vmcnt(2)
    v_bitop3_b32 v78, v12, v14, s69 bitop3:0x7e
    v_mfma_f32_16x16x32_bf16 v[0:3], v[4:7], v[12:15], v[0:3]
    v_or_b32 v77, v77, v78
    v_mov_b64 v[12:13], 0
    v_mov_b64 v[14:15], 0
    s_waitcnt vmcnt(1)
    v_bitop3_b32 v78, v16, v18, s69 bitop3:0x7e
    v_mfma_f32_16x16x32_bf16 v[0:3], v[4:7], v[16:19], v[0:3]
    v_or_b32 v77, v77, v78
    v_mov_b64 v[16:17], 0
    v_mov_b64 v[18:19], 0
    s_waitcnt vmcnt(0)
    v_bitop3_b32 v78, v20, v22, s69 bitop3:0x7e
    v_mfma_f32_16x16x32_bf16 v[0:3], v[4:7], v[20:23], v[0:3]
    v_bitop3_b32 v77, v77, v78, 1 bitop3:0xa8
    v_cmp_ne_u32 vcc, 0, v77
    v_mov_b64 v[20:21], 0
    v_mov_b64 v[22:23], 0
    s_cmp_eq_u64 vcc, 0
    s_cselect_b64 s[42:43], -1, 0
    s_nop 1
    v_add_f32_dpp v0, v0, v0 row_ror:8 row_mask:0xf bank_mask:0xf
    v_add_f32_dpp v1, v1, v1 row_ror:8 row_mask:0xf bank_mask:0xf
    s_mov_b64 exec, s[42:43]
    v_cvt_pk_bf16_f32 v72, v0, v1
    v_bfi_b32 v72, v79, s70, v72
    buffer_store_dword v72, v75, s[4:7], s17 offen offset:0 sc1
    s_mov_b64 exec, -1
    s_cbranch_scc0 cs_f0_retry
cs_f0_go:
    v_mov_b64 v[0:1], 0
    v_mov_b64 v[2:3], 0
    v_mov_b64 v[4:5], 0
    v_mov_b64 v[6:7], 0
    s_nop 2
    v_mov_b32 v79, v79
    s_nop 2
    v_mov_b32 v79, v79
    s_nop 2
    v_mov_b32 v79, v79
    s_nop 2
    v_mov_b32 v79, v79
    s_nop 2
    v_mov_b32 v79, v79
    s_nop 2
    v_mov_b32 v79, v79
    s_nop 2
    v_mov_b32 v79, v79
    s_nop 2
    v_mov_b32 v79, v79
    s_nop 2
    v_mov_b32 v79, v79
    s_nop 2
    v_mov_b32 v79, v79
    s_nop 2
    v_mov_b32 v79, v79
    s_nop 2
    v_mov_b32 v79, v79
    s_nop 2
    v_mov_b32 v79, v79
    s_nop 2
    v_mov_b32 v79, v79
    s_nop 2
    v_mov_b32 v79, v79
    s_nop 2
    v_mov_b32 v79, v79
    s_nop 2
    v_mov_b32 v79, v79
    s_nop 2
    v_mov_b32 v79, v79
    s_nop 2
    v_mov_b32 v79, v79
    s_nop 2
    v_mov_b32 v79, v79
    s_nop 2
    v_mov_b32 v79, v79
    s_nop 2
    v_mov_b32 v79, v79
    s_nop 2
    v_mov_b32 v79, v79
    s_nop 2
    v_mov_b32 v79, v79
    s_nop 2
    v_mov_b32 v79, v79
    s_branch cs_loop
cs_e1:
    s_cmp_lg_u32 s71, 2
    s_cbranch_scc1 cs_f1
    v_and_b32 v77, 255, v69
    ds_read_b128 v[4:7], v77 offset:15872
    ds_read_b128 v[44:47], v70 offset:0
    ds_read_b128 v[48:51], v70 offset:1024
    ds_read_b128 v[52:55], v70 offset:2048
    ds_read_b128 v[56:59], v70 offset:3072
    ds_read_b128 v[24:27], v70 offset:4096
    ds_read_b128 v[28:31], v70 offset:5120
    ds_read_b128 v[32:35], v70 offset:6144
    ds_read_b128 v[36:39], v70 offset:7168
    s_mov_b32 s31, 65536
    s_add_u32 s24, s24, 524288
    s_add_u32 s26, s26, 524288
    s_add_u32 s55, s55, s57
    s_mov_b32 s14, 67633152
    s_mov_b32 s15, 67637248
    s_mov_b32 s16, 67641344
    s_mov_b32 s36, 1
    v_mov_b32 v40, s69
    v_mov_b32 v60, s69
    v_and_b32 v79, 12, v75
    v_cmp_eq_u32 vcc, 0, v79
    s_nop 1
    v_cndmask_b32 v79, 0, 1, vcc
    s_cmp_lg_u32 s37, 0
    s_cbranch_scc1 cs_f2_xt
cs_f2_xtx:
    s_nop 2
    v_mov_b32 v79, v79
    s_nop 2
    v_mov_b32 v79, v79
    s_nop 2
    v_mov_b32 v79, v79
    s_nop 2
    v_mov_b32 v79, v79
    s_nop 2
    v_mov_b32 v79, v79
    s_nop 2
    v_mov_b32 v79, v79
    s_nop 2
    v_mov_b32 v79, v79
    s_nop 2
    v_mov_b32 v79, v79
    s_nop 2
    v_mov_b32 v79, v79
    s_nop 2
    v_mov_b32 v79, v79
    s_nop 2
    v_mov_b32 v79, v79
    s_nop 2
    v_mov_b32 v79, v79
    s_nop 2
    v_mov_b32 v79, v79
    s_nop 2
    v_mov_b32 v79, v79
    s_nop 2
    v_mov_b32 v79, v79
    s_nop 2
    v_mov_b32 v79, v79
    s_nop 2
    v_mov_b32 v79, v79
    s_nop 2
    v_mov_b32 v79, v79
    s_nop 2
    v_mov_b32 v79, v79
    s_nop 2
    v_mov_b32 v79, v79
    s_nop 2
    v_mov_b32 v79, v79
    s_nop 2
    v_mov_b32 v79, v79
    s_nop 2
    v_mov_b32 v79, v79
    s_nop 2
    v_mov_b32 v79, v79
    s_nop 2
    v_mov_b32 v79, v79
    s_nop 2
    v_mov_b32 v79, v79
    s_nop 2
    v_mov_b32 v79, v79
    s_nop 2
    v_mov_b32 v79, v79
    s_nop 2
    v_mov_b32 v79, v79
    s_nop 2
    v_mov_b32 v79, v79
    s_nop 2
    v_mov_b32 v79, v79
    s_nop 2
    v_mov_b32 v79, v79
    s_nop 2
    v_mov_b32 v79, v79
    s_nop 2
    v_mov_b32 v79, v79
    s_nop 2
    v_mov_b32 v79, v79
    s_nop 2
    v_mov_b32 v79, v79
    s_nop 0
    v_mov_b32 v79, v79
    s_waitcnt vmcnt(0)
    buffer_load_dwordx4 v[8:11], v65, s[4:7], s18 offen sc1
    buffer_load_dwordx4 v[12:15], v65, s[4:7], s19 offen sc1
    buffer_load_dwordx4 v[16:19], v65, s[4:7], s20 offen sc1
    buffer_load_dwordx4 v[20:23], v65, s[4:7], s21 offen sc1
    s_nop 2
    v_mov_b32 v79, v79
    s_nop 2
    v_mov_b32 v79, v79
    s_nop 2
    v_mov_b32 v79, v79
    s_nop 2
    v_mov_b32 v79, v79
    s_nop 2
    v_mov_b32 v79, v79
    s_nop 2
    v_mov_b32 v79, v79
    s_nop 2
    v_mov_b32 v79, v79
    s_nop 2
    v_mov_b32 v79, v79
    s_nop 2
    v_mov_b32 v79, v79
    s_nop 2
    v_mov_b32 v79, v79
    buffer_load_dwordx4 v[40:43], v65, s[4:7], s14 offen offset:0 sc1
    buffer_load_dwordx4 v[60:63], v66, s[4:7], s14 offen offset:0 sc1
    s_waitcnt lgkmcnt(0)
    s_waitcnt vmcnt(5)
    v_bitop3_b32 v77, v8, v10, s69 bitop3:0x7e
    v_mfma_f32_16x16x32_bf16 v[0:3], v[4:7], v[8:11], 0
    v_mov_b64 v[8:9], 0
    v_mov_b64 v[10:11], 0
    s_waitcnt vmcnt(4)
    v_bitop3_b32 v78, v12, v14, s69 bitop3:0x7e
    v_mfma_f32_16x16x32_bf16 v[0:3], v[4:7], v[12:15], v[0:3]
    v_or_b32 v77, v77, v78
    v_mov_b64 v[12:13], 0
    v_mov_b64 v[14:15], 0
    s_waitcnt vmcnt(3)
    v_bitop3_b32 v78, v16, v18, s69 bitop3:0x7e
    v_mfma_f32_16x16x32_bf16 v[0:3], v[4:7], v[16:19], v[0:3]
    v_or_b32 v77, v77, v78
    v_mov_b64 v[16:17], 0
    v_mov_b64 v[18:19], 0
    s_waitcnt vmcnt(2)
    v_bitop3_b32 v78, v20, v22, s69 bitop3:0x7e
    v_mfma_f32_16x16x32_bf16 v[0:3], v[4:7], v[20:23], v[0:3]
    v_bitop3_b32 v77, v77, v78, 1 bitop3:0xa8
    v_cmp_ne_u32 vcc, 0, v77
    v_mov_b64 v[20:21], 0
    v_mov_b64 v[22:23], 0
    buffer_load_dwordx4 v[40:43], v65, s[4:7], s14 offen offset:0 sc1
    buffer_load_dwordx4 v[60:63], v66, s[4:7], s14 offen offset:0 sc1
    s_cmp_eq_u64 vcc, 0
    s_cselect_b64 s[42:43], -1, 0
    v_add_f32_dpp v0, v0, v0 row_ror:4 row_mask:0xf bank_mask:0xf
    v_add_f32_dpp v1, v1, v1 row_ror:4 row_mask:0xf bank_mask:0xf
    s_nop 0
    v_add_f32_dpp v0, v0, v0 row_ror:8 row_mask:0xf bank_mask:0xf
    v_add_f32_dpp v1, v1, v1 row_ror:8 row_mask:0xf bank_mask:0xf
    s_mov_b64 exec, s[42:43]
    v_cvt_pk_bf16_f32 v72, v0, v1
    v_bfi_b32 v72, v79, s70, v72
    buffer_store_dword v72, v75, s[4:7], s17 offen offset:0 sc1
    buffer_store_dword v72, v75, s[4:7], s17 offen offset:1024 sc1
    buffer_store_dword v72, v75, s[4:7], s17 offen offset:2048 sc1
    buffer_store_dword v72, v75, s[4:7], s17 offen offset:3072 sc1
    s_mov_b64 exec, -1
    s_cbranch_scc0 cs_f2_retry
cs_f2_go:
    v_mov_b64 v[0:1], 0
    v_mov_b64 v[2:3], 0
    v_mov_b64 v[4:5], 0
    v_mov_b64 v[6:7], 0
    s_nop 2
    v_mov_b32 v79, v79
    s_nop 2
    v_mov_b32 v79, v79
    s_nop 2
    v_mov_b32 v79, v79
    s_nop 2
    v_mov_b32 v79, v79
    s_nop 2
    v_mov_b32 v79, v79
    s_nop 2
    v_mov_b32 v79, v79
    s_nop 2
    v_mov_b32 v79, v79
    s_nop 2
    v_mov_b32 v79, v79
    s_nop 2
    v_mov_b32 v79, v79
    s_nop 2
    v_mov_b32 v79, v79
    s_nop 2
    v_mov_b32 v79, v79
    s_nop 2
    v_mov_b32 v79, v79
    s_nop 2
    v_mov_b32 v79, v79
    s_nop 2
    v_mov_b32 v79, v79
    s_nop 2
    v_mov_b32 v79, v79
    s_nop 2
    v_mov_b32 v79, v79
    s_nop 2
    v_mov_b32 v79, v79
    s_nop 2
    v_mov_b32 v79, v79
    s_nop 2
    v_mov_b32 v79, v79
    s_nop 2
    v_mov_b32 v79, v79
    s_nop 2
    v_mov_b32 v79, v79
    s_nop 2
    v_mov_b32 v79, v79
    s_nop 2
    v_mov_b32 v79, v79
    s_nop 2
    v_mov_b32 v79, v79
    s_nop 2
    v_mov_b32 v79, v79
    s_branch cs_loop
cs_f1:
    s_cmp_lg_u32 s32, 1
    s_cbranch_scc1 cs_f3
    v_and_b32 v77, 255, v69
    ds_read_b128 v[4:7], v77 offset:15872
    ds_read_b128 v[44:47], v70 offset:0
    ds_read_b128 v[48:51], v70 offset:1024
    ds_read_b128 v[52:55], v70 offset:2048
    ds_read_b128 v[56:59], v70 offset:3072
    ds_read_b128 v[24:27], v70 offset:4096
    ds_read_b128 v[28:31], v70 offset:5120
    ds_read_b128 v[32:35], v70 offset:6144
    ds_read_b128 v[36:39], v70 offset:7168
    s_mov_b32 s31, 65536
    s_add_u32 s24, s24, 524288
    s_add_u32 s26, s26, 524288
    s_add_u32 s55, s55, s57
    s_mov_b32 s14, 67633152
    s_mov_b32 s15, 67637248
    s_mov_b32 s16, 67641344
    s_mov_b32 s36, 1
    v_mov_b32 v40, s69
    v_mov_b32 v60, s69
    v_and_b32 v79, 12, v75
    v_cmp_eq_u32 vcc, 0, v79
    s_nop 1
    v_cndmask_b32 v79, 0, 1, vcc
    s_cmp_lg_u32 s37, 0
    s_cbranch_scc1 cs_f1_xt
cs_f1_xtx:
    s_nop 2
    v_mov_b32 v79, v79
    s_nop 2
    v_mov_b32 v79, v79
    s_nop 2
    v_mov_b32 v79, v79
    s_nop 2
    v_mov_b32 v79, v79
    s_nop 2
    v_mov_b32 v79, v79
    s_nop 2
    v_mov_b32 v79, v79
    s_nop 2
    v_mov_b32 v79, v79
    s_nop 2
    v_mov_b32 v79, v79
    s_nop 2
    v_mov_b32 v79, v79
    s_nop 2
    v_mov_b32 v79, v79
    s_nop 2
    v_mov_b32 v79, v79
    s_nop 2
    v_mov_b32 v79, v79
    s_nop 2
    v_mov_b32 v79, v79
    s_nop 2
    v_mov_b32 v79, v79
    s_nop 2
    v_mov_b32 v79, v79
    s_nop 2
    v_mov_b32 v79, v79
    s_nop 2
    v_mov_b32 v79, v79
    s_nop 2
    v_mov_b32 v79, v79
    s_nop 2
    v_mov_b32 v79, v79
    s_nop 2
    v_mov_b32 v79, v79
    s_nop 2
    v_mov_b32 v79, v79
    s_nop 2
    v_mov_b32 v79, v79
    s_nop 2
    v_mov_b32 v79, v79
    s_nop 2
    v_mov_b32 v79, v79
    s_nop 2
    v_mov_b32 v79, v79
    s_nop 2
    v_mov_b32 v79, v79
    s_nop 2
    v_mov_b32 v79, v79
    s_nop 2
    v_mov_b32 v79, v79
    s_nop 2
    v_mov_b32 v79, v79
    s_nop 2
    v_mov_b32 v79, v79
    s_nop 2
    v_mov_b32 v79, v79
    s_nop 2
    v_mov_b32 v79, v79
    s_nop 2
    v_mov_b32 v79, v79
    s_nop 2
    v_mov_b32 v79, v79
    s_nop 2
    v_mov_b32 v79, v79
    s_nop 2
    v_mov_b32 v79, v79
    s_nop 0
    v_mov_b32 v79, v79
    s_waitcnt vmcnt(0)
    buffer_load_dwordx4 v[8:11], v65, s[4:7], s18 offen sc1
    buffer_load_dwordx4 v[12:15], v65, s[4:7], s19 offen sc1
    buffer_load_dwordx4 v[16:19], v65, s[4:7], s20 offen sc1
    buffer_load_dwordx4 v[20:23], v65, s[4:7], s21 offen sc1
    s_nop 2
    v_mov_b32 v79, v79
    s_nop 2
    v_mov_b32 v79, v79
    s_nop 2
    v_mov_b32 v79, v79
    s_nop 2
    v_mov_b32 v79, v79
    s_nop 2
    v_mov_b32 v79, v79
    s_nop 2
    v_mov_b32 v79, v79
    s_nop 2
    v_mov_b32 v79, v79
    s_nop 2
    v_mov_b32 v79, v79
    s_nop 2
    v_mov_b32 v79, v79
    s_nop 2
    v_mov_b32 v79, v79
    buffer_load_dwordx4 v[40:43], v65, s[4:7], s14 offen offset:0 sc1
    buffer_load_dwordx4 v[60:63], v66, s[4:7], s14 offen offset:0 sc1
    s_waitcnt lgkmcnt(0)
    s_waitcnt vmcnt(5)
    v_bitop3_b32 v77, v8, v10, s69 bitop3:0x7e
    v_mfma_f32_16x16x32_bf16 v[0:3], v[4:7], v[8:11], 0
    v_mov_b64 v[8:9], 0
    v_mov_b64 v[10:11], 0
    s_waitcnt vmcnt(4)
    v_bitop3_b32 v78, v12, v14, s69 bitop3:0x7e
    v_mfma_f32_16x16x32_bf16 v[0:3], v[4:7], v[12:15], v[0:3]
    v_or_b32 v77, v77, v78
    v_mov_b64 v[12:13], 0
    v_mov_b64 v[14:15], 0
    s_waitcnt vmcnt(3)
    v_bitop3_b32 v78, v16, v18, s69 bitop3:0x7e
    v_mfma_f32_16x16x32_bf16 v[0:3], v[4:7], v[16:19], v[0:3]
    v_or_b32 v77, v77, v78
    v_mov_b64 v[16:17], 0
    v_mov_b64 v[18:19], 0
    s_waitcnt vmcnt(2)
    v_bitop3_b32 v78, v20, v22, s69 bitop3:0x7e
    v_mfma_f32_16x16x32_bf16 v[0:3], v[4:7], v[20:23], v[0:3]
    v_bitop3_b32 v77, v77, v78, 1 bitop3:0xa8
    v_cmp_ne_u32 vcc, 0, v77
    v_mov_b64 v[20:21], 0
    v_mov_b64 v[22:23], 0
    buffer_load_dwordx4 v[40:43], v65, s[4:7], s14 offen offset:0 sc1
    buffer_load_dwordx4 v[60:63], v66, s[4:7], s14 offen offset:0 sc1
    s_cmp_eq_u64 vcc, 0
    s_cselect_b64 s[42:43], -1, 0
    v_add_f32_dpp v0, v0, v0 row_ror:8 row_mask:0xf bank_mask:0xf
    v_add_f32_dpp v1, v1, v1 row_ror:8 row_mask:0xf bank_mask:0xf
    s_mov_b64 exec, s[42:43]
    v_cvt_pk_bf16_f32 v72, v0, v1
    v_bfi_b32 v72, v79, s70, v72
    buffer_store_dword v72, v75, s[4:7], s17 offen offset:0 sc1
    s_mov_b64 exec, -1
    s_cbranch_scc0 cs_f1_retry
cs_f1_go:
    v_mov_b64 v[0:1], 0
    v_mov_b64 v[2:3], 0
    v_mov_b64 v[4:5], 0
    v_mov_b64 v[6:7], 0
    s_nop 2
    v_mov_b32 v79, v79
    s_nop 2
    v_mov_b32 v79, v79
    s_nop 2
    v_mov_b32 v79, v79
    s_nop 2
    v_mov_b32 v79, v79
    s_nop 2
    v_mov_b32 v79, v79
    s_nop 2
    v_mov_b32 v79, v79
    s_nop 2
    v_mov_b32 v79, v79
    s_nop 2
    v_mov_b32 v79, v79
    s_nop 2
    v_mov_b32 v79, v79
    s_nop 2
    v_mov_b32 v79, v79
    s_nop 2
    v_mov_b32 v79, v79
    s_nop 2
    v_mov_b32 v79, v79
    s_nop 2
    v_mov_b32 v79, v79
    s_nop 2
    v_mov_b32 v79, v79
    s_nop 2
    v_mov_b32 v79, v79
    s_nop 2
    v_mov_b32 v79, v79
    s_nop 2
    v_mov_b32 v79, v79
    s_nop 2
    v_mov_b32 v79, v79
    s_nop 2
    v_mov_b32 v79, v79
    s_nop 2
    v_mov_b32 v79, v79
    s_nop 2
    v_mov_b32 v79, v79
    s_nop 2
    v_mov_b32 v79, v79
    s_nop 2
    v_mov_b32 v79, v79
    s_nop 2
    v_mov_b32 v79, v79
    s_nop 2
    v_mov_b32 v79, v79
    s_branch cs_loop
cs_f3:
    v_and_b32 v77, 255, v69
    ds_read_b128 v[4:7], v77 offset:15872
    ds_read_b128 v[44:47], v70 offset:0
    ds_read_b128 v[48:51], v70 offset:1024
    ds_read_b128 v[52:55], v70 offset:2048
    ds_read_b128 v[56:59], v70 offset:3072
    ds_read_b128 v[24:27], v70 offset:4096
    ds_read_b128 v[28:31], v70 offset:5120
    ds_read_b128 v[32:35], v70 offset:6144
    ds_read_b128 v[36:39], v70 offset:7168
    s_mov_b32 s31, 65536
    s_add_u32 s24, s24, 524288
    s_add_u32 s26, s26, 524288
    s_add_u32 s55, s55, s57
    s_mov_b32 s14, 67633152
    s_mov_b32 s15, 67637248
    s_mov_b32 s16, 67641344
    s_mov_b32 s36, 1
    v_mov_b32 v40, s69
    v_mov_b32 v60, s69
    v_and_b32 v79, 12, v75
    v_cmp_eq_u32 vcc, 0, v79
    s_nop 1
    v_cndmask_b32 v79, 0, 1, vcc
    s_add_u32 s40, s30, s95
    v_mov_b32 v72, s40
    s_waitcnt lgkmcnt(0)
    v_mov_b64 v[0:1], 0
    v_mov_b64 v[2:3], 0
    v_mov_b64 v[4:5], 0
    v_mov_b64 v[6:7], 0
    v_mov_b64 v[8:9], 0
    v_mov_b64 v[10:11], 0
    v_mov_b64 v[12:13], 0
    v_mov_b64 v[14:15], 0
    v_mov_b64 v[16:17], 0
    v_mov_b64 v[18:19], 0
    v_mov_b64 v[20:21], 0
    v_mov_b64 v[22:23], 0
    s_nop 2
    v_mov_b32 v79, v79
    s_nop 2
    v_mov_b32 v79, v79
    s_nop 2
    v_mov_b32 v79, v79
    s_nop 2
    v_mov_b32 v79, v79
    s_nop 2
    v_mov_b32 v79, v79
    s_nop 2
    v_mov_b32 v79, v79
    s_nop 2
    v_mov_b32 v79, v79
    s_nop 2
    v_mov_b32 v79, v79
    s_nop 2
    v_mov_b32 v79, v79
    s_nop 2
    v_mov_b32 v79, v79
    s_nop 2
    v_mov_b32 v79, v79
    s_nop 2
    v_mov_b32 v79, v79
    s_nop 2
    v_mov_b32 v79, v79
    s_nop 2
    v_mov_b32 v79, v79
    s_nop 2
    v_mov_b32 v79, v79
    s_nop 2
    v_mov_b32 v79, v79
    s_nop 2
    v_mov_b32 v79, v79
    s_nop 2
    v_mov_b32 v79, v79
    s_nop 2
    v_mov_b32 v79, v79
    s_nop 2
    v_mov_b32 v79, v79
    s_nop 2
    v_mov_b32 v79, v79
    s_nop 2
    v_mov_b32 v79, v79
    s_nop 2
    v_mov_b32 v79, v79
    s_nop 2
    v_mov_b32 v79, v79
    s_nop 2
    v_mov_b32 v79, v79
    s_nop 2
    v_mov_b32 v79, v79
    s_nop 2
    v_mov_b32 v79, v79
    s_nop 2
    v_mov_b32 v79, v79
    s_nop 2
    v_mov_b32 v79, v79
    s_nop 2
    v_mov_b32 v79, v79
    s_nop 2
    v_mov_b32 v79, v79
    s_nop 2
    v_mov_b32 v79, v79
    s_nop 2
    v_mov_b32 v79, v79
    s_nop 2
    v_mov_b32 v79, v79
    s_nop 2
    v_mov_b32 v79, v79
    s_nop 2
    v_mov_b32 v79, v79
    s_nop 2
    v_mov_b32 v79, v79
    s_nop 2
    v_mov_b32 v79, v79
    s_nop 2
    v_mov_b32 v79, v79
    s_nop 2
    v_mov_b32 v79, v79
    s_nop 2
    v_mov_b32 v79, v79
    s_nop 2
    v_mov_b32 v79, v79
    s_nop 2
    v_mov_b32 v79, v79
    s_nop 2
    v_mov_b32 v79, v79
    s_nop 2
    v_mov_b32 v79, v79
    s_nop 2
    v_mov_b32 v79, v79
    s_nop 2
    v_mov_b32 v79, v79
    s_nop 2
    v_mov_b32 v79, v79
    s_nop 2
    v_mov_b32 v79, v79
    s_nop 2
    v_mov_b32 v79, v79
    s_nop 2
    v_mov_b32 v79, v79
    s_nop 2
    v_mov_b32 v79, v79
    s_nop 2
    v_mov_b32 v79, v79
    s_nop 2
    v_mov_b32 v79, v79
    s_nop 2
    v_mov_b32 v79, v79
    s_nop 2
    v_mov_b32 v79, v79
    s_nop 2
    v_mov_b32 v79, v79
    s_nop 2
    v_mov_b32 v79, v79
    s_nop 2
    v_mov_b32 v79, v79
    s_nop 2
    v_mov_b32 v79, v79
    s_nop 2
    v_mov_b32 v79, v79
    s_nop 2
    v_mov_b32 v79, v79
    s_nop 2
    v_mov_b32 v79, v79
    s_nop 2
    v_mov_b32 v79, v79
    s_nop 2
    v_mov_b32 v79, v79
    s_waitcnt vmcnt(0)
    s_cmp_lt_u32 s97, s93
    s_cbranch_scc1 cs_kvwait
    s_nop 2
    v_mov_b32 v79, v79
    s_nop 2
    v_mov_b32 v79, v79
    s_nop 2
    v_mov_b32 v79, v79
    s_nop 2
    v_mov_b32 v79, v79
    s_nop 2
    v_mov_b32 v79, v79
    s_nop 2
    v_mov_b32 v79, v79
    s_nop 2
    v_mov_b32 v79, v79
    s_nop 2
    v_mov_b32 v79, v79
cs_kvok:
    s_branch cs_loop
cs_f0_xt:
    s_sub_u32 s37, s37, 1
    s_nop 2
    v_mov_b32 v79, v79
    s_nop 2
    v_mov_b32 v79, v79
    s_nop 2
    v_mov_b32 v79, v79
    s_nop 2
    v_mov_b32 v79, v79
    s_nop 2
    v_mov_b32 v79, v79
    s_nop 2
    v_mov_b32 v79, v79
    s_branch cs_f0_xtx
cs_f0_retry:
    s_sub_u32 s41, s30, s98
    s_mov_b32 s98, s30
    s_cmp_le_u32 s41, 3
    s_cselect_b32 s37, 1, 1
cs_f0_spin:
    buffer_load_dwordx4 v[8:11], v65, s[4:7], s18 offen sc1
    buffer_load_dwordx4 v[12:15], v65, s[4:7], s19 offen sc1
    buffer_load_dwordx4 v[16:19], v65, s[4:7], s20 offen sc1
    buffer_load_dwordx4 v[20:23], v65, s[4:7], s21 offen sc1
    s_nop 2
    v_mov_b32 v79, v79
    s_nop 2
    v_mov_b32 v79, v79
    s_nop 2
    v_mov_b32 v79, v79
    buffer_load_dwordx4 v[40:43], v65, s[4:7], s14 offen offset:0 sc1
    buffer_load_dwordx4 v[60:63], v66, s[4:7], s14 offen offset:0 sc1
    s_waitcnt vmcnt(5)
    v_bitop3_b32 v77, v8, v10, s69 bitop3:0x7e
    v_mfma_f32_16x16x32_bf16 v[0:3], v[4:7], v[8:11], 0
    v_mov_b64 v[8:9], 0
    v_mov_b64 v[10:11], 0
    s_waitcnt vmcnt(4)
    v_bitop3_b32 v78, v12, v14, s69 bitop3:0x7e
    v_mfma_f32_16x16x32_bf16 v[0:3], v[4:7], v[12:15], v[0:3]
    v_or_b32 v77, v77, v78
    v_mov_b64 v[12:13], 0
    v_mov_b64 v[14:15], 0
    s_waitcnt vmcnt(3)
    v_bitop3_b32 v78, v16, v18, s69 bitop3:0x7e
    v_mfma_f32_16x16x32_bf16 v[0:3], v[4:7], v[16:19], v[0:3]
    v_or_b32 v77, v77, v78
    v_mov_b64 v[16:17], 0
    v_mov_b64 v[18:19], 0
    s_waitcnt vmcnt(2)
    v_bitop3_b32 v78, v20, v22, s69 bitop3:0x7e
    v_mfma_f32_16x16x32_bf16 v[0:3], v[4:7], v[20:23], v[0:3]
    v_bitop3_b32 v77, v77, v78, 1 bitop3:0xa8
    v_cmp_ne_u32 vcc, 0, v77
    v_mov_b64 v[20:21], 0
    v_mov_b64 v[22:23], 0
    buffer_load_dwordx4 v[40:43], v65, s[4:7], s14 offen offset:0 sc1
    buffer_load_dwordx4 v[60:63], v66, s[4:7], s14 offen offset:0 sc1
    s_cmp_eq_u64 vcc, 0
    s_cselect_b64 s[42:43], -1, 0
    v_add_f32_dpp v0, v0, v0 row_ror:8 row_mask:0xf bank_mask:0xf
    v_add_f32_dpp v1, v1, v1 row_ror:8 row_mask:0xf bank_mask:0xf
    s_mov_b64 exec, s[42:43]
    v_cvt_pk_bf16_f32 v72, v0, v1
    v_bfi_b32 v72, v79, s70, v72
    buffer_store_dword v72, v75, s[4:7], s17 offen offset:0 sc1
    s_mov_b64 exec, -1
    s_cbranch_scc1 cs_f0_rx
    s_sub_u32 s31, s31, 1
    s_cbranch_scc0 cs_f0_spin
cs_f0_rx:
    v_mov_b64 v[0:1], 0
    v_mov_b64 v[2:3], 0
    v_mov_b64 v[4:5], 0
    v_mov_b64 v[6:7], 0
    s_branch cs_loop
cs_f1_xt:
    s_sub_u32 s37, s37, 1
    s_nop 2
    v_mov_b32 v79, v79
    s_nop 2
    v_mov_b32 v79, v79
    s_nop 2
    v_mov_b32 v79, v79
    s_nop 2
    v_mov_b32 v79, v79
    s_nop 2
    v_mov_b32 v79, v79
    s_nop 2
    v_mov_b32 v79, v79
    s_branch cs_f1_xtx
cs_f1_retry:
    s_sub_u32 s41, s30, s98
    s_mov_b32 s98, s30
    s_cmp_le_u32 s41, 3
    s_cselect_b32 s37, 1, 1
cs_f1_spin:
    buffer_load_dwordx4 v[8:11], v65, s[4:7], s18 offen sc1
    buffer_load_dwordx4 v[12:15], v65, s[4:7], s19 offen sc1
    buffer_load_dwordx4 v[16:19], v65, s[4:7], s20 offen sc1
    buffer_load_dwordx4 v[20:23], v65, s[4:7], s21 offen sc1
    s_nop 2
    v_mov_b32 v79, v79
    s_nop 2
    v_mov_b32 v79, v79
    s_nop 2
    v_mov_b32 v79, v79
    buffer_load_dwordx4 v[40:43], v65, s[4:7], s14 offen offset:0 sc1
    buffer_load_dwordx4 v[60:63], v66, s[4:7], s14 offen offset:0 sc1
    s_waitcnt vmcnt(5)
    v_bitop3_b32 v77, v8, v10, s69 bitop3:0x7e
    v_mfma_f32_16x16x32_bf16 v[0:3], v[4:7], v[8:11], 0
    v_mov_b64 v[8:9], 0
    v_mov_b64 v[10:11], 0
    s_waitcnt vmcnt(4)
    v_bitop3_b32 v78, v12, v14, s69 bitop3:0x7e
    v_mfma_f32_16x16x32_bf16 v[0:3], v[4:7], v[12:15], v[0:3]
    v_or_b32 v77, v77, v78
    v_mov_b64 v[12:13], 0
    v_mov_b64 v[14:15], 0
    s_waitcnt vmcnt(3)
    v_bitop3_b32 v78, v16, v18, s69 bitop3:0x7e
    v_mfma_f32_16x16x32_bf16 v[0:3], v[4:7], v[16:19], v[0:3]
    v_or_b32 v77, v77, v78
    v_mov_b64 v[16:17], 0
    v_mov_b64 v[18:19], 0
    s_waitcnt vmcnt(2)
    v_bitop3_b32 v78, v20, v22, s69 bitop3:0x7e
    v_mfma_f32_16x16x32_bf16 v[0:3], v[4:7], v[20:23], v[0:3]
    v_bitop3_b32 v77, v77, v78, 1 bitop3:0xa8
    v_cmp_ne_u32 vcc, 0, v77
    v_mov_b64 v[20:21], 0
    v_mov_b64 v[22:23], 0
    buffer_load_dwordx4 v[40:43], v65, s[4:7], s14 offen offset:0 sc1
    buffer_load_dwordx4 v[60:63], v66, s[4:7], s14 offen offset:0 sc1
    s_cmp_eq_u64 vcc, 0
    s_cselect_b64 s[42:43], -1, 0
    v_add_f32_dpp v0, v0, v0 row_ror:8 row_mask:0xf bank_mask:0xf
    v_add_f32_dpp v1, v1, v1 row_ror:8 row_mask:0xf bank_mask:0xf
    s_mov_b64 exec, s[42:43]
    v_cvt_pk_bf16_f32 v72, v0, v1
    v_bfi_b32 v72, v79, s70, v72
    buffer_store_dword v72, v75, s[4:7], s17 offen offset:0 sc1
    s_mov_b64 exec, -1
    s_cbranch_scc1 cs_f1_rx
    s_sub_u32 s31, s31, 1
    s_cbranch_scc0 cs_f1_spin
cs_f1_rx:
    v_mov_b64 v[0:1], 0
    v_mov_b64 v[2:3], 0
    v_mov_b64 v[4:5], 0
    v_mov_b64 v[6:7], 0
    s_branch cs_loop
cs_f2_xt:
    s_sub_u32 s37, s37, 1
    s_nop 2
    v_mov_b32 v79, v79
    s_nop 2
    v_mov_b32 v79, v79
    s_nop 2
    v_mov_b32 v79, v79
    s_nop 2
    v_mov_b32 v79, v79
    s_nop 2
    v_mov_b32 v79, v79
    s_nop 2
    v_mov_b32 v79, v79
    s_branch cs_f2_xtx
cs_f2_retry:
    s_sub_u32 s41, s30, s98
    s_mov_b32 s98, s30
    s_cmp_le_u32 s41, 3
    s_cselect_b32 s37, 1, 1
cs_f2_spin:
    buffer_load_dwordx4 v[8:11], v65, s[4:7], s18 offen sc1
    buffer_load_dwordx4 v[12:15], v65, s[4:7], s19 offen sc1
    buffer_load_dwordx4 v[16:19], v65, s[4:7], s20 offen sc1
    buffer_load_dwordx4 v[20:23], v65, s[4:7], s21 offen sc1
    s_nop 2
    v_mov_b32 v79, v79
    s_nop 2
    v_mov_b32 v79, v79
    s_nop 2
    v_mov_b32 v79, v79
    buffer_load_dwordx4 v[40:43], v65, s[4:7], s14 offen offset:0 sc1
    buffer_load_dwordx4 v[60:63], v66, s[4:7], s14 offen offset:0 sc1
    s_waitcnt vmcnt(5)
    v_bitop3_b32 v77, v8, v10, s69 bitop3:0x7e
    v_mfma_f32_16x16x32_bf16 v[0:3], v[4:7], v[8:11], 0
    v_mov_b64 v[8:9], 0
    v_mov_b64 v[10:11], 0
    s_waitcnt vmcnt(4)
    v_bitop3_b32 v78, v12, v14, s69 bitop3:0x7e
    v_mfma_f32_16x16x32_bf16 v[0:3], v[4:7], v[12:15], v[0:3]
    v_or_b32 v77, v77, v78
    v_mov_b64 v[12:13], 0
    v_mov_b64 v[14:15], 0
    s_waitcnt vmcnt(3)
    v_bitop3_b32 v78, v16, v18, s69 bitop3:0x7e
    v_mfma_f32_16x16x32_bf16 v[0:3], v[4:7], v[16:19], v[0:3]
    v_or_b32 v77, v77, v78
    v_mov_b64 v[16:17], 0
    v_mov_b64 v[18:19], 0
    s_waitcnt vmcnt(2)
    v_bitop3_b32 v78, v20, v22, s69 bitop3:0x7e
    v_mfma_f32_16x16x32_bf16 v[0:3], v[4:7], v[20:23], v[0:3]
    v_bitop3_b32 v77, v77, v78, 1 bitop3:0xa8
    v_cmp_ne_u32 vcc, 0, v77
    v_mov_b64 v[20:21], 0
    v_mov_b64 v[22:23], 0
    buffer_load_dwordx4 v[40:43], v65, s[4:7], s14 offen offset:0 sc1
    buffer_load_dwordx4 v[60:63], v66, s[4:7], s14 offen offset:0 sc1
    s_cmp_eq_u64 vcc, 0
    s_cselect_b64 s[42:43], -1, 0
    v_add_f32_dpp v0, v0, v0 row_ror:4 row_mask:0xf bank_mask:0xf
    v_add_f32_dpp v1, v1, v1 row_ror:4 row_mask:0xf bank_mask:0xf
    s_nop 0
    v_add_f32_dpp v0, v0, v0 row_ror:8 row_mask:0xf bank_mask:0xf
    v_add_f32_dpp v1, v1, v1 row_ror:8 row_mask:0xf bank_mask:0xf
    s_mov_b64 exec, s[42:43]
    v_cvt_pk_bf16_f32 v72, v0, v1
    v_bfi_b32 v72, v79, s70, v72
    buffer_store_dword v72, v75, s[4:7], s17 offen offset:0 sc1
    buffer_store_dword v72, v75, s[4:7], s17 offen offset:1024 sc1
    buffer_store_dword v72, v75, s[4:7], s17 offen offset:2048 sc1
    buffer_store_dword v72, v75, s[4:7], s17 offen offset:3072 sc1
    s_mov_b64 exec, -1
    s_cbranch_scc1 cs_f2_rx
    s_sub_u32 s31, s31, 1
    s_cbranch_scc0 cs_f2_spin
cs_f2_rx:
    v_mov_b64 v[0:1], 0
    v_mov_b64 v[2:3], 0
    v_mov_b64 v[4:5], 0
    v_mov_b64 v[6:7], 0
    s_branch cs_loop
cs_spinB:
    s_waitcnt vmcnt(3)
cs_spinB_l:
    v_and_b32 v77, s36, v44
    v_cmp_ne_u32 vcc, s70, v77
    s_cbranch_vccz cs_spinB_x
    buffer_load_dwordx4 v[44:47], v65, s[4:7], s15 offen sc1
    s_sub_u32 s31, s31, 16
    s_waitcnt vmcnt(0)
    s_cbranch_scc0 cs_spinB_l
cs_spinB_x:
    ds_write_b128 v65, v[44:47] offset:4096
    s_waitcnt lgkmcnt(0)
    s_branch cs_backB
cs_spin8:
    buffer_load_dwordx4 v[40:43], v65, s[4:7], s16 offen sc1
cs_spin8_l:
    v_and_b32 v77, s36, v40
    v_cmp_ne_u32 vcc, s70, v77
    s_cbranch_vccz cs_spin8_x
    s_nop 15
    s_nop 15
    s_nop 15
    s_nop 11
    v_and_b32 v77, s36, v40
    v_cmp_ne_u32 vcc, s70, v77
    s_cbranch_vccz cs_spin8_x
    s_nop 15
    s_nop 15
    s_nop 15
    s_nop 11
    v_and_b32 v77, s36, v40
    v_cmp_ne_u32 vcc, s70, v77
    s_cbranch_vccz cs_spin8_x
    s_nop 15
    s_nop 15
    s_nop 15
    s_nop 11
    buffer_load_dwordx4 v[40:43], v65, s[4:7], s16 offen sc1
    s_sub_u32 s31, s31, 16
    s_cbranch_scc0 cs_spin8_l
cs_spin8_x:
    s_branch cs_back8
cs_rare:
    s_mov_b64 exec, s[34:35]
    buffer_store_dwordx4 v[0:3], v65, s[4:7], s28 offen sc1
    s_mov_b64 exec, -1
    s_nop 3
    v_cvt_pk_bf16_f32 v52, v16, v17
    v_cvt_pk_bf16_f32 v53, v18, v19
    v_cvt_pk_bf16_f32 v54, v20, v21
    v_cvt_pk_bf16_f32 v55, v22, v23
    buffer_store_dwordx4 v[52:55], v65, s[4:7], s27 offen sc1
    s_add_u32 s28, s28, 131072
    s_add_u32 s27, s27, 131072
    s_cmp_eq_u32 s30, 63
    s_cbranch_scc1 cs_last
    s_branch cs_rare_x
cs_kvwait:
    s_mov_b32 s41, s97
    v_bfe_u32 v78, v65, 2, 5
    v_mov_b32 v77, v76
    s_nop 1
    v_permlane32_swap_b32 v76, v77
    v_subrev_u32 v77, s95, v77
    v_cmp_lt_u32 vcc, 16, v77
    s_nop 1
    v_cndmask_b32 v77, v77, 0, vcc
    v_bfe_u32 v79, v78, 2, 2
    v_lshl_add_u32 v77, v77, 2, v79
    s_nop 1
    v_min_u32_dpp v77, v77, v77 row_ror:1 row_mask:0xf bank_mask:0xf
    s_nop 1
    v_min_u32_dpp v77, v77, v77 row_ror:2 row_mask:0xf bank_mask:0xf
    s_nop 1
    v_min_u32_dpp v77, v77, v77 row_ror:4 row_mask:0xf bank_mask:0xf
    s_nop 0
    v_readfirstlane_b32 s97, v77
    s_nop 0
    s_max_u32 s97, s97, s41
    s_add_u32 s40, s30, 3
    s_min_u32 s40, s40, 64
    s_cmp_le_u32 s40, s97
    s_cbranch_scc1 cs_kvw_x
    v_bfe_u32 v78, v65, 2, 5
    s_mov_b32 s31, 4194304
cs_kvw:
    buffer_load_dword v77, v78, s[4:7], s96 offen offset:16 sc1
    s_waitcnt vmcnt(0)
    v_subrev_u32 v77, s95, v77
    v_cmp_lt_u32 vcc, 16, v77
    s_nop 1
    v_cndmask_b32 v77, v77, 0, vcc
    v_bfe_u32 v79, v78, 2, 2
    v_lshl_add_u32 v77, v77, 2, v79
    s_nop 1
    v_min_u32_dpp v77, v77, v77 row_ror:1 row_mask:0xf bank_mask:0xf
    s_nop 1
    v_min_u32_dpp v77, v77, v77 row_ror:2 row_mask:0xf bank_mask:0xf
    s_nop 1
    v_min_u32_dpp v77, v77, v77 row_ror:4 row_mask:0xf bank_mask:0xf
    s_nop 0
    v_readfirstlane_b32 s97, v77
    s_sub_u32 s31, s31, 1
    s_cbranch_scc1 cs_kvw_x
    s_cmp_le_u32 s40, s97
    s_cbranch_scc1 cs_kvw_x
    s_sleep 2
    s_branch cs_kvw
cs_kvw_x:
    s_branch cs_kvok
cs_last:
    s_add_u32 s40, s95, 64
    v_mov_b32 v78, s40
    s_waitcnt vmcnt(0)
    s_barrier
    s_mov_b64 exec, s[100:101]
    buffer_store_dword v78, off, s[4:7], s29 sc1
    s_mov_b64 exec, -1
cs_end:
    s_endpgm
L_xform:
    v_and_b32 v1, 63, v0
    v_and_b32 v2, 15, v1
    v_lshrrev_b32 v3, 4, v1
    v_mov_b32 v7, 0x05040100
    v_mov_b32 v8, 0x07060302
    v_lshrrev_b32 v9, 6, v0
    v_lshlrev_b32 v9, 14, v9
    v_lshlrev_b32 v10, 4, v1
    v_add_u32 v11, v9, v10
    s_mov_b32 s10, 4718592
    s_mov_b32 s11, 0x20000
    s_mov_b64 s[8:9], s[58:59]
xf_f:
    s_sub_u32 s17, s16, 1504
    s_and_b32 s18, s17, 127
    s_lshr_b32 s17, s17, 7
    s_lshl_b32 s19, s17, 4
    v_add_u32 v6, s19, v2
    v_mul_u32_u24 v4, 9216, v3
    v_lshl_add_u32 v4, v6, 4, v4
    v_lshrrev_b32 v5, 2, v2
    v_lshlrev_b32 v5, 11, v5
    v_lshl_add_u32 v5, v3, 8, v5
    v_and_b32 v1, 3, v6
    v_lshl_add_u32 v5, v1, 6, v5
    v_add_u32 v5, v5, v9
    v_cmp_gt_u32 vcc, 72, v6
    s_nop 0
    s_mov_b64 exec, vcc
    s_mul_i32 s20, s18, 36864
    s_add_u32 s21, s20, 0
    buffer_load_dwordx4 v[12:15], v4, s[8:11], s21 offen
    s_add_u32 s21, s20, 1152
    buffer_load_dwordx4 v[16:19], v4, s[8:11], s21 offen
    s_add_u32 s21, s20, 2304
    buffer_load_dwordx4 v[20:23], v4, s[8:11], s21 offen
    s_add_u32 s21, s20, 3456
    buffer_load_dwordx4 v[24:27], v4, s[8:11], s21 offen
    s_add_u32 s21, s20, 4608
    buffer_load_dwordx4 v[28:31], v4, s[8:11], s21 offen
    s_add_u32 s21, s20, 5760
    buffer_load_dwordx4 v[32:35], v4, s[8:11], s21 offen
    s_add_u32 s21, s20, 6912
    buffer_load_dwordx4 v[36:39], v4, s[8:11], s21 offen
    s_add_u32 s21, s20, 8064
    buffer_load_dwordx4 v[40:43], v4, s[8:11], s21 offen
    s_lshl_b32 s20, s18, 11
    s_add_u32 s20, s20, 130023424
    s_waitcnt vmcnt(0)
    v_perm_b32 v76, v16, v12, v7
    v_perm_b32 v77, v24, v20, v7
    v_perm_b32 v78, v32, v28, v7
    v_perm_b32 v79, v40, v36, v7
    ds_write_b128 v5, v[76:79] offset:0
    v_perm_b32 v80, v17, v13, v7
    v_perm_b32 v81, v25, v21, v7
    v_perm_b32 v82, v33, v29, v7
    v_perm_b32 v83, v41, v37, v7
    ds_write_b128 v5, v[80:83] offset:16
    v_perm_b32 v84, v18, v14, v7
    v_perm_b32 v85, v26, v22, v7
    v_perm_b32 v86, v34, v30, v7
    v_perm_b32 v87, v42, v38, v7
    ds_write_b128 v5, v[84:87] offset:32
    v_perm_b32 v88, v19, v15, v7
    v_perm_b32 v89, v27, v23, v7
    v_perm_b32 v90, v35, v31, v7
    v_perm_b32 v91, v43, v39, v7
    ds_write_b128 v5, v[88:91] offset:48
    v_perm_b32 v92, v16, v12, v8
    v_perm_b32 v93, v24, v20, v8
    v_perm_b32 v94, v32, v28, v8
    v_perm_b32 v95, v40, v36, v8
    ds_write_b128 v5, v[92:95] offset:1024
    v_perm_b32 v96, v17, v13, v8
    v_perm_b32 v97, v25, v21, v8
    v_perm_b32 v98, v33, v29, v8
    v_perm_b32 v99, v41, v37, v8
    ds_write_b128 v5, v[96:99] offset:1040
    v_perm_b32 v100, v18, v14, v8
    v_perm_b32 v101, v26, v22, v8
    v_perm_b32 v102, v34, v30, v8
    v_perm_b32 v103, v42, v38, v8
    ds_write_b128 v5, v[100:103] offset:1056
    v_perm_b32 v104, v19, v15, v8
    v_perm_b32 v105, v27, v23, v8
    v_perm_b32 v106, v35, v31, v8
    v_perm_b32 v107, v43, v39, v8
    ds_write_b128 v5, v[104:107] offset:1072
    s_mov_b64 exec, -1
    s_lshl_b32 s21, s17, 20
    s_add_u32 s20, s20, s21
    s_waitcnt lgkmcnt(0)
    ds_read_b128 v[76:79], v11 offset:0
    ds_read_b128 v[80:83], v11 offset:1024
    ds_read_b128 v[84:87], v11 offset:2048
    ds_read_b128 v[88:91], v11 offset:3072
    ds_read_b128 v[92:95], v11 offset:4096
    ds_read_b128 v[96:99], v11 offset:5120
    ds_read_b128 v[100:103], v11 offset:6144
    ds_read_b128 v[104:107], v11 offset:7168
    s_add_u32 s19, s20, 0
    s_waitcnt lgkmcnt(7)
    buffer_store_dwordx4 v[76:79], v10, s[4:7], s19 offen sc1
    s_add_u32 s19, s20, 1024
    s_waitcnt lgkmcnt(6)
    buffer_store_dwordx4 v[80:83], v10, s[4:7], s19 offen sc1
    s_add_u32 s19, s20, 262144
    s_waitcnt lgkmcnt(5)
    buffer_store_dwordx4 v[84:87], v10, s[4:7], s19 offen sc1
    s_add_u32 s19, s20, 263168
    s_waitcnt lgkmcnt(4)
    buffer_store_dwordx4 v[88:91], v10, s[4:7], s19 offen sc1
    s_add_u32 s19, s20, 524288
    s_waitcnt lgkmcnt(3)
    buffer_store_dwordx4 v[92:95], v10, s[4:7], s19 offen sc1
    s_add_u32 s19, s20, 525312
    s_waitcnt lgkmcnt(2)
    buffer_store_dwordx4 v[96:99], v10, s[4:7], s19 offen sc1
    s_add_u32 s19, s20, 786432
    s_waitcnt lgkmcnt(1)
    buffer_store_dwordx4 v[100:103], v10, s[4:7], s19 offen sc1
    s_add_u32 s19, s20, 787456
    s_waitcnt lgkmcnt(0)
    buffer_store_dwordx4 v[104:107], v10, s[4:7], s19 offen sc1
xf_done:
    s_nop 1
    s_setpc_b64 s[46:47]
L_helper:
    s_load_dwordx16 s[64:79], s[0:1], 64
    s_waitcnt lgkmcnt(0)
    s_mov_b32 s93, 1000
    s_mov_b32 s95, 0
    s_cmp_lg_u32 s3, 2
    s_cbranch_scc1 L_qkv_next
    s_mov_b32 s37, 24
    v_mov_b32 v250, 1
    v_mov_b32 v251, 163832
    v_cmp_eq_u32 vcc, 0, v0
    s_nop 0
    s_and_saveexec_b64 s[38:39], vcc
    s_cbranch_execz tk3
    buffer_atomic_add v250, off, s[84:87], s37 sc0
    s_waitcnt vmcnt(0)
    ds_write_b32 v251, v250
    s_waitcnt lgkmcnt(0)
tk3:
    s_mov_b64 exec, -1
    s_barrier
    ds_read_b32 v252, v251
    s_waitcnt lgkmcnt(0)
    v_readfirstlane_b32 s36, v252
    s_barrier
    s_nop 3
    s_cmp_ge_u32 s36, 32
    s_cbranch_scc1 L_qkv_next
    s_mov_b32 s93, 0
    s_cmp_eq_u32 s36, 0
    s_cbranch_scc1 L_relay
    s_branch L_wf_next
L_qkv_next:
    s_mov_b32 s37, 4
    v_mov_b32 v250, 1
    v_mov_b32 v251, 163832
    v_cmp_eq_u32 vcc, 0, v0
    s_nop 0
    s_and_saveexec_b64 s[38:39], vcc
    s_cbranch_execz tk4
    buffer_atomic_add v250, off, s[84:87], s37 sc0
    s_waitcnt vmcnt(0)
    ds_write_b32 v251, v250
    s_waitcnt lgkmcnt(0)
tk4:
    s_mov_b64 exec, -1
    s_barrier
    ds_read_b32 v252, v251
    s_waitcnt lgkmcnt(0)
    v_readfirstlane_b32 s36, v252
    s_barrier
    s_nop 3
    s_or_b32 s37, s36, s32
    s_cbranch_scc1 L_non
    s_memrealtime s[90:91]
    s_waitcnt lgkmcnt(0)
    s_lshl_b32 s90, s90, 8
    s_or_b32 s90, s90, 1
    v_mov_b32 v250, s90
    s_mov_b64 exec, 1
    buffer_store_dword v250, off, s[84:87], 0 offset:216 sc1
    s_mov_b64 exec, -1
L_non:
    s_cmp_lt_u32 s36, 192
    s_cbranch_scc1 L_qkv
    s_cmp_lg_u32 s95, 0
    s_cbranch_scc1 L_hn
    s_mov_b32 s88, 4194304
gn5:
    buffer_load_dword v250, off, s[84:87], 0 offset:216 sc1
    s_waitcnt vmcnt(0)
    v_readfirstlane_b32 s95, v250
    s_sub_u32 s88, s88, 1
    s_cbranch_scc1 gn5x
    s_cmp_eq_u32 s95, 0
    s_cbranch_scc1 gn5
gn5x:
L_hn:
    s_sub_u32 s45, s36, 192
    s_cmp_lg_u32 s36, 192
    s_cbranch_scc1 L_phase2
    s_mov_b32 s37, 24
    v_mov_b32 v250, 1
    v_mov_b32 v251, 163832
    v_cmp_eq_u32 vcc, 0, v0
    s_nop 0
    s_and_saveexec_b64 s[38:39], vcc
    s_cbranch_execz tk6
    buffer_atomic_add v250, off, s[84:87], s37 sc0
    s_waitcnt vmcnt(0)
    ds_write_b32 v251, v250
    s_waitcnt lgkmcnt(0)
tk6:
    s_mov_b64 exec, -1
    s_barrier
    ds_read_b32 v252, v251
    s_waitcnt lgkmcnt(0)
    v_readfirstlane_b32 s36, v252
    s_barrier
    s_nop 3
    s_cmp_lg_u32 s36, 0
    s_cbranch_scc1 L_phase2
L_relay:
    s_cmp_lg_u32 s32, 0
    s_cbranch_scc1 L_exit
    s_sleep 100
    s_mov_b32 s88, 4194304
gn7:
    buffer_load_dword v250, off, s[84:87], 0 offset:216 sc1
    s_waitcnt vmcnt(0)
    v_readfirstlane_b32 s95, v250
    s_sub_u32 s88, s88, 1
    s_cbranch_scc1 gn7x
    s_cmp_eq_u32 s95, 0
    s_cbranch_scc1 gn7
gn7x:
    v_and_b32 v3, 31, v0
    v_lshlrev_b32 v3, 7, v3
    s_mov_b32 s17, 0
    s_mov_b32 s23, 125845504
    s_mov_b32 s24, 125853696
    s_mov_b32 s21, 16777216
rl_rwait:
    buffer_load_dword v4, v3, s[4:7], s23 offen sc1
    s_waitcnt vmcnt(0)
    v_subrev_u32 v4, s95, v4
    v_cmp_lt_u32 vcc, 64, v4
    s_nop 1
    v_cndmask_b32 v4, v4, 0, vcc
    s_nop 1
    v_min_u32_dpp v4, v4, v4 row_ror:1 row_mask:0xf bank_mask:0xf
    s_nop 1
    v_min_u32_dpp v4, v4, v4 row_ror:2 row_mask:0xf bank_mask:0xf
    s_nop 1
    v_min_u32_dpp v4, v4, v4 row_ror:4 row_mask:0xf bank_mask:0xf
    s_nop 1
    v_min_u32_dpp v4, v4, v4 row_ror:8 row_mask:0xf bank_mask:0xf
    s_nop 0
    v_readlane_b32 s16, v4, 0
    v_readlane_b32 s22, v4, 16
    s_nop 0
    s_min_u32 s16, s16, s22
    s_sub_u32 s21, s21, 1
    s_cbranch_scc1 rl_x
    s_cmp_gt_u32 s16, s17
    s_cbranch_scc1 rl_rpub
    s_sleep 2
    s_branch rl_rwait
rl_rpub:
    s_mov_b32 s17, s16
    s_add_u32 s22, s16, s95
    v_mov_b32 v4, s22
    s_mov_b64 exec, 1
    buffer_store_dword v4, off, s[4:7], s24 sc1
    s_mov_b64 exec, -1
    s_cmp_lt_u32 s16, 64
    s_cbranch_scc1 rl_rwait
rl_x:
    s_endpgm
L_qkv:
    s_sub_u32 s33, s36, 32
    s_and_b32 s17, s36, 15
    s_lshl_b32 s17, s17, 1
    s_lshr_b32 s36, s36, 4
    s_and_b32 s16, s36, 1
    s_add_u32 s16, s16, 1
    s_lshr_b32 s19, s36, 1
    s_and_b32 s37, s36, 3
    s_cmp_ge_u32 s36, 8
    s_cselect_b32 s16, 0, s16
    s_cselect_b32 s19, s37, s19
    v_lshrrev_b32 v4, 6, v0
    s_nop 0
    v_readfirstlane_b32 s18, v4
    v_lshlrev_b32 v7, 4, v0
    s_cmp_eq_u32 s16, 1
    s_cselect_b64 s[12:13], s[54:55], s[52:53]
    s_cmp_eq_u32 s16, 2
    s_cselect_b64 s[12:13], s[56:57], s[12:13]
    s_mov_b32 s14, 4718592
    s_mov_b32 s15, 0x20000
    v_bfe_u32 v4, v0, 5, 1
    v_lshlrev_b32 v5, 2, v4
    v_and_b32 v8, 31, v0
    v_xor_b32 v8, v8, v5
    v_lshlrev_b32 v8, 4, v8
    v_lshl_add_u32 v8, v4, 13, v8
    v_xor_b32 v9, 128, v8
    s_lshl_b32 s21, s17, 8
    s_lshl_b32 s42, s18, 16
    s_add_u32 s42, s42, s21
    s_lshl_b32 s44, s18, 12
    s_barrier
    s_add_u32 m0, s44, 73728
    s_add_u32 s22, s42, 0
    buffer_load_dwordx4 v8, s[12:15], s22 offen offset:0 lds
    s_add_u32 s22, s42, 15360
    buffer_load_dwordx4 v9, s[12:15], s22 offen offset:1024 lds
    s_add_u32 s22, s42, 30720
    buffer_load_dwordx4 v8, s[12:15], s22 offen offset:2048 lds
    s_add_u32 s22, s42, 46080
    buffer_load_dwordx4 v9, s[12:15], s22 offen offset:3072 lds
    s_add_u32 m0, s44, 90112
    s_add_u32 s22, s42, 262144
    buffer_load_dwordx4 v8, s[12:15], s22 offen offset:0 lds
    s_add_u32 s22, s42, 277504
    buffer_load_dwordx4 v9, s[12:15], s22 offen offset:1024 lds
    s_add_u32 s22, s42, 292864
    buffer_load_dwordx4 v8, s[12:15], s22 offen offset:2048 lds
    s_add_u32 s22, s42, 308224
    buffer_load_dwordx4 v9, s[12:15], s22 offen offset:3072 lds
    s_add_u32 m0, s44, 106496
    s_add_u32 s22, s42, 524288
    buffer_load_dwordx4 v8, s[12:15], s22 offen offset:0 lds
    s_add_u32 s22, s42, 539648
    buffer_load_dwordx4 v9, s[12:15], s22 offen offset:1024 lds
    s_add_u32 s22, s42, 555008
    buffer_load_dwordx4 v8, s[12:15], s22 offen offset:2048 lds
    s_add_u32 s22, s42, 570368
    buffer_load_dwordx4 v9, s[12:15], s22 offen offset:3072 lds
    s_add_u32 m0, s44, 122880
    s_add_u32 s22, s42, 786432
    buffer_load_dwordx4 v8, s[12:15], s22 offen offset:0 lds
    s_add_u32 s22, s42, 801792
    buffer_load_dwordx4 v9, s[12:15], s22 offen offset:1024 lds
    s_add_u32 s22, s42, 817152
    buffer_load_dwordx4 v8, s[12:15], s22 offen offset:2048 lds
    s_add_u32 s22, s42, 832512
    buffer_load_dwordx4 v9, s[12:15], s22 offen offset:3072 lds
    v_bfe_u32 v4, v0, 2, 2
    v_xor_b32 v5, s18, v4
    v_lshlrev_b32 v10, 6, v5
    v_lshl_add_u32 v10, v4, 9, v10
    v_and_b32 v4, 3, v0
    v_lshl_add_u32 v10, v4, 4, v10
    v_bfe_u32 v4, v0, 4, 2
    v_lshl_add_u32 v10, v4, 12, v10
    v_add_u32 v10, 73728, v10
    v_add_u32 v11, 49152, v10
    v_and_b32 v4, 63, v0
    v_and_b32 v5, 15, v4
    v_lshrrev_b32 v3, 4, v4
    v_lshrrev_b32 v2, 2, v5
    v_xor_b32 v3, v3, v2
    v_lshl_add_u32 v3, v5, 2, v3
    v_lshlrev_b32 v1, 4, v3
    v_lshrrev_b32 v5, 2, v4
    v_lshrrev_b32 v3, 4, v4
    v_and_b32 v4, 3, v4
    v_xor_b32 v4, v4, v3
    v_lshlrev_b32 v3, 3, v3
    v_and_b32 v5, 3, v5
    v_add_u32 v3, v3, v5
    v_mul_u32_u24 v2, 1152, v3
    v_lshl_add_u32 v2, v4, 4, v2
    s_mov_b32 s8, s48
    s_mov_b32 s9, s49
    s_mov_b32 s10, 2359296
    s_mov_b32 s11, 0x20000
    s_lshr_b32 s22, s18, 1
    s_mul_i32 s24, s22, 4608
    s_mul_i32 s25, s22, 18432
    s_and_b32 s22, s18, 1
    s_mul_i32 s23, s22, 576
    s_add_u32 s24, s24, s23
    s_mul_i32 s25, s18, 9216
    s_mul_i32 s22, s19, 36864
    s_add_u32 s24, s24, s22
    s_mov_b32 s20, 64
    s_lshl_b32 s22, s19, 5
    s_add_u32 s22, s22, s17
    s_lshl_b32 s26, s22, 14
    s_mul_i32 s23, s18, 3072
    s_add_u32 s26, s26, s23
    s_lshl_b32 s23, s16, 11
    s_add_u32 s26, s26, s23
    s_add_u32 s26, s26, -2048
    s_lshl_b32 s22, s22, 13
    s_add_u32 s22, s22, 33554432
    s_cmp_eq_u32 s16, 0
    s_cselect_b32 s26, s22, s26
    s_cselect_b32 s40, 4096, 64
    s_cselect_b32 s41, 1, 2
    s_max_u32 s40, s40, 1024
    s_lshl_b32 s41, s41, 18
    s_lshl_b32 s29, s17, 7
    s_lshl_b32 s22, s16, 4
    s_add_u32 s29, s29, s22
    s_lshl_b32 s22, s19, 2
    s_add_u32 s29, s29, s22
    s_add_u32 s29, s29, 125829120
    s_mov_b32 s27, 0
    s_add_u32 s23, s27, s25
    s_add_u32 m0, s23, 0
    s_nop 0
    buffer_load_dwordx4 v2, s[8:11], s24 offen offset:0 lds
    s_add_u32 m0, s23, 960
    s_nop 0
    buffer_load_dwordx4 v2, s[8:11], s24 offen offset:64 lds
    s_add_u32 m0, s23, 1920
    s_nop 0
    buffer_load_dwordx4 v2, s[8:11], s24 offen offset:128 lds
    s_add_u32 m0, s23, 2880
    s_nop 0
    buffer_load_dwordx4 v2, s[8:11], s24 offen offset:192 lds
    s_add_u32 m0, s23, 3840
    s_nop 0
    buffer_load_dwordx4 v2, s[8:11], s24 offen offset:256 lds
    s_add_u32 m0, s23, 4800
    s_nop 0
    buffer_load_dwordx4 v2, s[8:11], s24 offen offset:320 lds
    s_add_u32 m0, s23, 5760
    s_nop 0
    buffer_load_dwordx4 v2, s[8:11], s24 offen offset:384 lds
    s_add_u32 m0, s23, 6720
    s_nop 0
    buffer_load_dwordx4 v2, s[8:11], s24 offen offset:448 lds
    s_add_u32 m0, s23, 7680
    s_nop 0
    buffer_load_dwordx4 v2, s[8:11], s24 offen offset:512 lds
    s_add_u32 s24, s24, 147456
    s_waitcnt vmcnt(21) lgkmcnt(0)
    s_barrier
    s_add_u32 m0, s44, 139264
    s_add_u32 s22, s42, 1048576
    buffer_load_dwordx4 v8, s[12:15], s22 offen offset:0 lds
    s_add_u32 s22, s42, 1063936
    buffer_load_dwordx4 v9, s[12:15], s22 offen offset:1024 lds
    s_add_u32 s22, s42, 1079296
    buffer_load_dwordx4 v8, s[12:15], s22 offen offset:2048 lds
    s_add_u32 s22, s42, 1094656
    buffer_load_dwordx4 v9, s[12:15], s22 offen offset:3072 lds
    ds_read_b64_tr_b16 v[64:65], v10 offset:0
    ds_read_b64_tr_b16 v[66:67], v10 offset:2048
    ds_read_b64_tr_b16 v[136:137], v10 offset:8
    ds_read_b64_tr_b16 v[138:139], v10 offset:2056
    ds_read_b64_tr_b16 a[0:1], v10 offset:256
    ds_read_b64_tr_b16 a[2:3], v10 offset:2304
    ds_read_b64_tr_b16 a[72:73], v10 offset:264
    ds_read_b64_tr_b16 a[74:75], v10 offset:2312
    s_waitcnt vmcnt(21) lgkmcnt(0)
    s_barrier
    s_add_u32 m0, s44, 73728
    s_add_u32 s22, s42, 1310720
    buffer_load_dwordx4 v8, s[12:15], s22 offen offset:0 lds
    s_add_u32 s22, s42, 1326080
    buffer_load_dwordx4 v9, s[12:15], s22 offen offset:1024 lds
    s_add_u32 s22, s42, 1341440
    buffer_load_dwordx4 v8, s[12:15], s22 offen offset:2048 lds
    s_add_u32 s22, s42, 1356800
    buffer_load_dwordx4 v9, s[12:15], s22 offen offset:3072 lds
    ds_read_b64_tr_b16 v[68:69], v10 offset:16384
    ds_read_b64_tr_b16 v[70:71], v10 offset:18432
    ds_read_b64_tr_b16 v[140:141], v10 offset:16392
    ds_read_b64_tr_b16 v[142:143], v10 offset:18440
    ds_read_b64_tr_b16 a[4:5], v10 offset:16640
    ds_read_b64_tr_b16 a[6:7], v10 offset:18688
    ds_read_b64_tr_b16 a[76:77], v10 offset:16648
    ds_read_b64_tr_b16 a[78:79], v10 offset:18696
    s_waitcnt vmcnt(21) lgkmcnt(0)
    s_barrier
    s_add_u32 m0, s44, 90112
    s_add_u32 s22, s42, 1572864
    buffer_load_dwordx4 v8, s[12:15], s22 offen offset:0 lds
    s_add_u32 s22, s42, 1588224
    buffer_load_dwordx4 v9, s[12:15], s22 offen offset:1024 lds
    s_add_u32 s22, s42, 1603584
    buffer_load_dwordx4 v8, s[12:15], s22 offen offset:2048 lds
    s_add_u32 s22, s42, 1618944
    buffer_load_dwordx4 v9, s[12:15], s22 offen offset:3072 lds
    ds_read_b64_tr_b16 v[72:73], v10 offset:32768
    ds_read_b64_tr_b16 v[74:75], v10 offset:34816
    ds_read_b64_tr_b16 v[144:145], v10 offset:32776
    ds_read_b64_tr_b16 v[146:147], v10 offset:34824
    ds_read_b64_tr_b16 a[8:9], v10 offset:33024
    ds_read_b64_tr_b16 a[10:11], v10 offset:35072
    ds_read_b64_tr_b16 a[80:81], v10 offset:33032
    ds_read_b64_tr_b16 a[82:83], v10 offset:35080
    s_waitcnt vmcnt(21) lgkmcnt(0)
    s_barrier
    s_add_u32 m0, s44, 106496
    s_add_u32 s22, s42, 1835008
    buffer_load_dwordx4 v8, s[12:15], s22 offen offset:0 lds
    s_add_u32 s22, s42, 1850368
    buffer_load_dwordx4 v9, s[12:15], s22 offen offset:1024 lds
    s_add_u32 s22, s42, 1865728
    buffer_load_dwordx4 v8, s[12:15], s22 offen offset:2048 lds
    s_add_u32 s22, s42, 1881088
    buffer_load_dwordx4 v9, s[12:15], s22 offen offset:3072 lds
    ds_read_b64_tr_b16 v[76:77], v11 offset:0
    ds_read_b64_tr_b16 v[78:79], v11 offset:2048
    ds_read_b64_tr_b16 v[148:149], v11 offset:8
    ds_read_b64_tr_b16 v[150:151], v11 offset:2056
    ds_read_b64_tr_b16 a[12:13], v11 offset:256
    ds_read_b64_tr_b16 a[14:15], v11 offset:2304
    ds_read_b64_tr_b16 a[84:85], v11 offset:264
    ds_read_b64_tr_b16 a[86:87], v11 offset:2312
    s_waitcnt vmcnt(12) lgkmcnt(0)
    s_barrier
    s_add_u32 m0, s44, 122880
    s_add_u32 s22, s42, 2097152
    buffer_load_dwordx4 v8, s[12:15], s22 offen offset:0 lds
    s_add_u32 s22, s42, 2112512
    buffer_load_dwordx4 v9, s[12:15], s22 offen offset:1024 lds
    s_add_u32 s22, s42, 2127872
    buffer_load_dwordx4 v8, s[12:15], s22 offen offset:2048 lds
    s_add_u32 s22, s42, 2143232
    buffer_load_dwordx4 v9, s[12:15], s22 offen offset:3072 lds
    ds_read_b64_tr_b16 v[80:81], v11 offset:16384
    ds_read_b64_tr_b16 v[82:83], v11 offset:18432
    ds_read_b64_tr_b16 v[152:153], v11 offset:16392
    ds_read_b64_tr_b16 v[154:155], v11 offset:18440
    ds_read_b64_tr_b16 a[16:17], v11 offset:16640
    ds_read_b64_tr_b16 a[18:19], v11 offset:18688
    ds_read_b64_tr_b16 a[88:89], v11 offset:16648
    ds_read_b64_tr_b16 a[90:91], v11 offset:18696
    s_waitcnt vmcnt(12) lgkmcnt(0)
    s_barrier
    s_add_u32 m0, s44, 139264
    s_add_u32 s22, s42, 2359296
    buffer_load_dwordx4 v8, s[12:15], s22 offen offset:0 lds
    s_add_u32 s22, s42, 2374656
    buffer_load_dwordx4 v9, s[12:15], s22 offen offset:1024 lds
    s_add_u32 s22, s42, 2390016
    buffer_load_dwordx4 v8, s[12:15], s22 offen offset:2048 lds
    s_add_u32 s22, s42, 2405376
    buffer_load_dwordx4 v9, s[12:15], s22 offen offset:3072 lds
    ds_read_b64_tr_b16 v[84:85], v10 offset:0
    ds_read_b64_tr_b16 v[86:87], v10 offset:2048
    ds_read_b64_tr_b16 v[156:157], v10 offset:8
    ds_read_b64_tr_b16 v[158:159], v10 offset:2056
    ds_read_b64_tr_b16 a[20:21], v10 offset:256
    ds_read_b64_tr_b16 a[22:23], v10 offset:2304
    ds_read_b64_tr_b16 a[92:93], v10 offset:264
    ds_read_b64_tr_b16 a[94:95], v10 offset:2312
    s_waitcnt vmcnt(12) lgkmcnt(0)
    s_barrier
    s_add_u32 m0, s44, 73728
    s_add_u32 s22, s42, 2621440
    buffer_load_dwordx4 v8, s[12:15], s22 offen offset:0 lds
    s_add_u32 s22, s42, 2636800
    buffer_load_dwordx4 v9, s[12:15], s22 offen offset:1024 lds
    s_add_u32 s22, s42, 2652160
    buffer_load_dwordx4 v8, s[12:15], s22 offen offset:2048 lds
    s_add_u32 s22, s42, 2667520
    buffer_load_dwordx4 v9, s[12:15], s22 offen offset:3072 lds
    ds_read_b64_tr_b16 v[88:89], v10 offset:16384
    ds_read_b64_tr_b16 v[90:91], v10 offset:18432
    ds_read_b64_tr_b16 v[160:161], v10 offset:16392
    ds_read_b64_tr_b16 v[162:163], v10 offset:18440
    ds_read_b64_tr_b16 a[24:25], v10 offset:16640
    ds_read_b64_tr_b16 a[26:27], v10 offset:18688
    ds_read_b64_tr_b16 a[96:97], v10 offset:16648
    ds_read_b64_tr_b16 a[98:99], v10 offset:18696
    s_waitcnt vmcnt(12) lgkmcnt(0)
    s_barrier
    s_add_u32 m0, s44, 90112
    s_add_u32 s22, s42, 2883584
    buffer_load_dwordx4 v8, s[12:15], s22 offen offset:0 lds
    s_add_u32 s22, s42, 2898944
    buffer_load_dwordx4 v9, s[12:15], s22 offen offset:1024 lds
    s_add_u32 s22, s42, 2914304
    buffer_load_dwordx4 v8, s[12:15], s22 offen offset:2048 lds
    s_add_u32 s22, s42, 2929664
    buffer_load_dwordx4 v9, s[12:15], s22 offen offset:3072 lds
    ds_read_b64_tr_b16 v[92:93], v10 offset:32768
    ds_read_b64_tr_b16 v[94:95], v10 offset:34816
    ds_read_b64_tr_b16 v[164:165], v10 offset:32776
    ds_read_b64_tr_b16 v[166:167], v10 offset:34824
    ds_read_b64_tr_b16 a[28:29], v10 offset:33024
    ds_read_b64_tr_b16 a[30:31], v10 offset:35072
    ds_read_b64_tr_b16 a[100:101], v10 offset:33032
    ds_read_b64_tr_b16 a[102:103], v10 offset:35080
    s_waitcnt vmcnt(12) lgkmcnt(0)
    s_barrier
    s_add_u32 m0, s44, 106496
    s_add_u32 s22, s42, 3145728
    buffer_load_dwordx4 v8, s[12:15], s22 offen offset:0 lds
    s_add_u32 s22, s42, 3161088
    buffer_load_dwordx4 v9, s[12:15], s22 offen offset:1024 lds
    s_add_u32 s22, s42, 3176448
    buffer_load_dwordx4 v8, s[12:15], s22 offen offset:2048 lds
    s_add_u32 s22, s42, 3191808
    buffer_load_dwordx4 v9, s[12:15], s22 offen offset:3072 lds
    ds_read_b64_tr_b16 v[96:97], v11 offset:0
    ds_read_b64_tr_b16 v[98:99], v11 offset:2048
    ds_read_b64_tr_b16 v[168:169], v11 offset:8
    ds_read_b64_tr_b16 v[170:171], v11 offset:2056
    ds_read_b64_tr_b16 a[32:33], v11 offset:256
    ds_read_b64_tr_b16 a[34:35], v11 offset:2304
    ds_read_b64_tr_b16 a[104:105], v11 offset:264
    ds_read_b64_tr_b16 a[106:107], v11 offset:2312
    s_waitcnt vmcnt(12) lgkmcnt(0)
    s_barrier
    s_add_u32 m0, s44, 122880
    s_add_u32 s22, s42, 3407872
    buffer_load_dwordx4 v8, s[12:15], s22 offen offset:0 lds
    s_add_u32 s22, s42, 3423232
    buffer_load_dwordx4 v9, s[12:15], s22 offen offset:1024 lds
    s_add_u32 s22, s42, 3438592
    buffer_load_dwordx4 v8, s[12:15], s22 offen offset:2048 lds
    s_add_u32 s22, s42, 3453952
    buffer_load_dwordx4 v9, s[12:15], s22 offen offset:3072 lds
    ds_read_b64_tr_b16 v[100:101], v11 offset:16384
    ds_read_b64_tr_b16 v[102:103], v11 offset:18432
    ds_read_b64_tr_b16 v[172:173], v11 offset:16392
    ds_read_b64_tr_b16 v[174:175], v11 offset:18440
    ds_read_b64_tr_b16 a[36:37], v11 offset:16640
    ds_read_b64_tr_b16 a[38:39], v11 offset:18688
    ds_read_b64_tr_b16 a[108:109], v11 offset:16648
    ds_read_b64_tr_b16 a[110:111], v11 offset:18696
    s_waitcnt vmcnt(12) lgkmcnt(0)
    s_barrier
    s_add_u32 m0, s44, 139264
    s_add_u32 s22, s42, 3670016
    buffer_load_dwordx4 v8, s[12:15], s22 offen offset:0 lds
    s_add_u32 s22, s42, 3685376
    buffer_load_dwordx4 v9, s[12:15], s22 offen offset:1024 lds
    s_add_u32 s22, s42, 3700736
    buffer_load_dwordx4 v8, s[12:15], s22 offen offset:2048 lds
    s_add_u32 s22, s42, 3716096
    buffer_load_dwordx4 v9, s[12:15], s22 offen offset:3072 lds
    ds_read_b64_tr_b16 v[104:105], v10 offset:0
    ds_read_b64_tr_b16 v[106:107], v10 offset:2048
    ds_read_b64_tr_b16 v[176:177], v10 offset:8
    ds_read_b64_tr_b16 v[178:179], v10 offset:2056
    ds_read_b64_tr_b16 a[40:41], v10 offset:256
    ds_read_b64_tr_b16 a[42:43], v10 offset:2304
    ds_read_b64_tr_b16 a[112:113], v10 offset:264
    ds_read_b64_tr_b16 a[114:115], v10 offset:2312
    s_waitcnt vmcnt(12) lgkmcnt(0)
    s_barrier
    s_add_u32 m0, s44, 73728
    s_add_u32 s22, s42, 3932160
    buffer_load_dwordx4 v8, s[12:15], s22 offen offset:0 lds
    s_add_u32 s22, s42, 3947520
    buffer_load_dwordx4 v9, s[12:15], s22 offen offset:1024 lds
    s_add_u32 s22, s42, 3962880
    buffer_load_dwordx4 v8, s[12:15], s22 offen offset:2048 lds
    s_add_u32 s22, s42, 3978240
    buffer_load_dwordx4 v9, s[12:15], s22 offen offset:3072 lds
    ds_read_b64_tr_b16 v[108:109], v10 offset:16384
    ds_read_b64_tr_b16 v[110:111], v10 offset:18432
    ds_read_b64_tr_b16 v[180:181], v10 offset:16392
    ds_read_b64_tr_b16 v[182:183], v10 offset:18440
    ds_read_b64_tr_b16 a[44:45], v10 offset:16640
    ds_read_b64_tr_b16 a[46:47], v10 offset:18688
    ds_read_b64_tr_b16 a[116:117], v10 offset:16648
    ds_read_b64_tr_b16 a[118:119], v10 offset:18696
    s_waitcnt vmcnt(12) lgkmcnt(0)
    s_barrier
    s_add_u32 m0, s44, 90112
    s_add_u32 s22, s42, 4194304
    buffer_load_dwordx4 v8, s[12:15], s22 offen offset:0 lds
    s_add_u32 s22, s42, 4209664
    buffer_load_dwordx4 v9, s[12:15], s22 offen offset:1024 lds
    s_add_u32 s22, s42, 4225024
    buffer_load_dwordx4 v8, s[12:15], s22 offen offset:2048 lds
    s_add_u32 s22, s42, 4240384
    buffer_load_dwordx4 v9, s[12:15], s22 offen offset:3072 lds
    ds_read_b64_tr_b16 v[112:113], v10 offset:32768
    ds_read_b64_tr_b16 v[114:115], v10 offset:34816
    ds_read_b64_tr_b16 v[184:185], v10 offset:32776
    ds_read_b64_tr_b16 v[186:187], v10 offset:34824
    ds_read_b64_tr_b16 a[48:49], v10 offset:33024
    ds_read_b64_tr_b16 a[50:51], v10 offset:35072
    ds_read_b64_tr_b16 a[120:121], v10 offset:33032
    ds_read_b64_tr_b16 a[122:123], v10 offset:35080
    s_waitcnt vmcnt(12) lgkmcnt(0)
    s_barrier
    s_add_u32 m0, s44, 106496
    s_add_u32 s22, s42, 4456448
    buffer_load_dwordx4 v8, s[12:15], s22 offen offset:0 lds
    s_add_u32 s22, s42, 4471808
    buffer_load_dwordx4 v9, s[12:15], s22 offen offset:1024 lds
    s_add_u32 s22, s42, 4487168
    buffer_load_dwordx4 v8, s[12:15], s22 offen offset:2048 lds
    s_add_u32 s22, s42, 4502528
    buffer_load_dwordx4 v9, s[12:15], s22 offen offset:3072 lds
    ds_read_b64_tr_b16 v[116:117], v11 offset:0
    ds_read_b64_tr_b16 v[118:119], v11 offset:2048
    ds_read_b64_tr_b16 v[188:189], v11 offset:8
    ds_read_b64_tr_b16 v[190:191], v11 offset:2056
    ds_read_b64_tr_b16 a[52:53], v11 offset:256
    ds_read_b64_tr_b16 a[54:55], v11 offset:2304
    ds_read_b64_tr_b16 a[124:125], v11 offset:264
    ds_read_b64_tr_b16 a[126:127], v11 offset:2312
    s_waitcnt vmcnt(12) lgkmcnt(0)
    s_barrier
    s_mov_b32 s27, 36864
    s_add_u32 s23, s27, s25
    s_add_u32 m0, s23, 0
    s_nop 0
    buffer_load_dwordx4 v2, s[8:11], s24 offen offset:0 lds
    s_add_u32 m0, s23, 960
    s_nop 0
    buffer_load_dwordx4 v2, s[8:11], s24 offen offset:64 lds
    s_add_u32 m0, s23, 1920
    s_nop 0
    buffer_load_dwordx4 v2, s[8:11], s24 offen offset:128 lds
    s_add_u32 m0, s23, 2880
    s_nop 0
    buffer_load_dwordx4 v2, s[8:11], s24 offen offset:192 lds
    s_add_u32 m0, s23, 3840
    s_nop 0
    buffer_load_dwordx4 v2, s[8:11], s24 offen offset:256 lds
    s_add_u32 m0, s23, 4800
    s_nop 0
    buffer_load_dwordx4 v2, s[8:11], s24 offen offset:320 lds
    s_add_u32 m0, s23, 5760
    s_nop 0
    buffer_load_dwordx4 v2, s[8:11], s24 offen offset:384 lds
    s_add_u32 m0, s23, 6720
    s_nop 0
    buffer_load_dwordx4 v2, s[8:11], s24 offen offset:448 lds
    s_add_u32 m0, s23, 7680
    s_nop 0
    buffer_load_dwordx4 v2, s[8:11], s24 offen offset:512 lds
    s_add_u32 s24, s24, 147456
    ds_read_b64_tr_b16 v[120:121], v11 offset:16384
    ds_read_b64_tr_b16 v[122:123], v11 offset:18432
    ds_read_b64_tr_b16 v[192:193], v11 offset:16392
    ds_read_b64_tr_b16 v[194:195], v11 offset:18440
    ds_read_b64_tr_b16 a[56:57], v11 offset:16640
    ds_read_b64_tr_b16 a[58:59], v11 offset:18688
    ds_read_b64_tr_b16 a[128:129], v11 offset:16648
    ds_read_b64_tr_b16 a[130:131], v11 offset:18696
    s_waitcnt vmcnt(17) lgkmcnt(0)
    s_barrier
    ds_read_b64_tr_b16 v[124:125], v10 offset:0
    ds_read_b64_tr_b16 v[126:127], v10 offset:2048
    ds_read_b64_tr_b16 v[196:197], v10 offset:8
    ds_read_b64_tr_b16 v[198:199], v10 offset:2056
    ds_read_b64_tr_b16 a[60:61], v10 offset:256
    ds_read_b64_tr_b16 a[62:63], v10 offset:2304
    ds_read_b64_tr_b16 a[132:133], v10 offset:264
    ds_read_b64_tr_b16 a[134:135], v10 offset:2312
    s_waitcnt vmcnt(13) lgkmcnt(0)
    s_barrier
    ds_read_b64_tr_b16 v[128:129], v10 offset:16384
    ds_read_b64_tr_b16 v[130:131], v10 offset:18432
    ds_read_b64_tr_b16 v[200:201], v10 offset:16392
    ds_read_b64_tr_b16 v[202:203], v10 offset:18440
    ds_read_b64_tr_b16 a[64:65], v10 offset:16640
    ds_read_b64_tr_b16 a[66:67], v10 offset:18688
    ds_read_b64_tr_b16 a[136:137], v10 offset:16648
    ds_read_b64_tr_b16 a[138:139], v10 offset:18696
    s_waitcnt vmcnt(9) lgkmcnt(0)
    s_barrier
    ds_read_b64_tr_b16 v[132:133], v10 offset:32768
    ds_read_b64_tr_b16 v[134:135], v10 offset:34816
    ds_read_b64_tr_b16 v[204:205], v10 offset:32776
    ds_read_b64_tr_b16 v[206:207], v10 offset:34824
    ds_read_b64_tr_b16 a[68:69], v10 offset:33024
    ds_read_b64_tr_b16 a[70:71], v10 offset:35072
    ds_read_b64_tr_b16 a[140:141], v10 offset:33032
    ds_read_b64_tr_b16 a[142:143], v10 offset:35080
    s_mov_b32 s88, 4194304
gn8:
    buffer_load_dword v250, off, s[84:87], 0 offset:216 sc1
    s_waitcnt vmcnt(0)
    v_readfirstlane_b32 s95, v250
    s_sub_u32 s88, s88, 1
    s_cbranch_scc1 gn8x
    s_cmp_eq_u32 s95, 0
    s_cbranch_scc1 gn8
gn8x:
    s_waitcnt lgkmcnt(0)
    s_mov_b32 s45, 0
    s_mov_b32 s27, 0
    s_mov_b64 s[36:37], 0
    s_mov_b32 s12, 0
    s_mov_b32 s13, s40
    s_lshr_b32 s14, s41, 5
    s_add_u32 s15, s14, s40
    s_lshl_b32 s41, s41, 2
    s_sub_u32 s26, s26, s41
    v_mov_b32 v3, v1
    s_waitcnt vmcnt(0)
    s_barrier
    ds_read_b128 v[32:35], v3 offset:0
    ds_read_b128 v[36:39], v3 offset:18432
    ds_read_b128 v[40:43], v3 offset:1024
    ds_read_b128 v[44:47], v3 offset:19456
    s_cmp_eq_u32 s18, 0
    s_cselect_b32 s34, 1, 0
    s_mov_b32 s35, 0
    s_cmp_eq_u32 s16, 2
    s_cbranch_scc1 qk_vloop
qk_loop:
    s_barrier
    s_add_u32 s22, s27, 73728
    s_sub_u32 s21, s22, 110592
    s_cselect_b32 s22, s22, s21
    s_waitcnt lgkmcnt(2)
    v_mfma_f32_16x16x32_bf16 v[208:211], v[64:67], v[32:35], 0
    ds_read_b128 v[48:51], v3 offset:2048
    v_mfma_f32_16x16x32_bf16 v[212:215], v[136:139], v[32:35], 0
    ds_read_b128 v[52:55], v3 offset:20480
    v_mfma_f32_16x16x32_bf16 v[216:219], v[64:67], v[36:39], 0
    v_mfma_f32_16x16x32_bf16 v[220:223], v[136:139], v[36:39], 0
    v_mfma_f32_16x16x32_bf16 v[224:227], a[0:3], v[32:35], 0
    v_mfma_f32_16x16x32_bf16 v[228:231], a[72:75], v[32:35], 0
    v_mfma_f32_16x16x32_bf16 v[232:235], a[0:3], v[36:39], 0
    v_mfma_f32_16x16x32_bf16 v[236:239], a[72:75], v[36:39], 0
    s_waitcnt lgkmcnt(2)
    v_mfma_f32_16x16x32_bf16 v[208:211], v[68:71], v[40:43], v[208:211]
    ds_read_b128 v[32:35], v3 offset:3072
    v_mfma_f32_16x16x32_bf16 v[212:215], v[140:143], v[40:43], v[212:215]
    ds_read_b128 v[36:39], v3 offset:21504
    v_mfma_f32_16x16x32_bf16 v[216:219], v[68:71], v[44:47], v[216:219]
    s_add_u32 s23, s22, s25
    s_add_u32 m0, s23, 0
    s_nop 0
    buffer_load_dwordx4 v2, s[8:11], s24 offen offset:0 lds
    v_mfma_f32_16x16x32_bf16 v[220:223], v[140:143], v[44:47], v[220:223]
    v_mfma_f32_16x16x32_bf16 v[224:227], a[4:7], v[40:43], v[224:227]
    v_mfma_f32_16x16x32_bf16 v[228:231], a[76:79], v[40:43], v[228:231]
    v_mfma_f32_16x16x32_bf16 v[232:235], a[4:7], v[44:47], v[232:235]
    s_add_u32 m0, s23, 960
    s_nop 0
    buffer_load_dwordx4 v2, s[8:11], s24 offen offset:64 lds
    v_mfma_f32_16x16x32_bf16 v[236:239], a[76:79], v[44:47], v[236:239]
    s_waitcnt lgkmcnt(2)
    v_mfma_f32_16x16x32_bf16 v[208:211], v[72:75], v[48:51], v[208:211]
    ds_read_b128 v[40:43], v3 offset:4096
    v_mfma_f32_16x16x32_bf16 v[212:215], v[144:147], v[48:51], v[212:215]
    ds_read_b128 v[44:47], v3 offset:22528
    v_mfma_f32_16x16x32_bf16 v[216:219], v[72:75], v[52:55], v[216:219]
    s_add_u32 m0, s23, 1920
    s_nop 0
    buffer_load_dwordx4 v2, s[8:11], s24 offen offset:128 lds
    v_mfma_f32_16x16x32_bf16 v[220:223], v[144:147], v[52:55], v[220:223]
    v_mfma_f32_16x16x32_bf16 v[224:227], a[8:11], v[48:51], v[224:227]
    v_mfma_f32_16x16x32_bf16 v[228:231], a[80:83], v[48:51], v[228:231]
    v_mfma_f32_16x16x32_bf16 v[232:235], a[8:11], v[52:55], v[232:235]
    s_add_u32 m0, s23, 2880
    s_nop 0
    buffer_load_dwordx4 v2, s[8:11], s24 offen offset:192 lds
    v_mfma_f32_16x16x32_bf16 v[236:239], a[80:83], v[52:55], v[236:239]
    s_waitcnt lgkmcnt(2)
    v_mfma_f32_16x16x32_bf16 v[208:211], v[76:79], v[32:35], v[208:211]
    ds_read_b128 v[48:51], v3 offset:5120
    v_mfma_f32_16x16x32_bf16 v[212:215], v[148:151], v[32:35], v[212:215]
    ds_read_b128 v[52:55], v3 offset:23552
    v_mfma_f32_16x16x32_bf16 v[216:219], v[76:79], v[36:39], v[216:219]
    s_add_u32 m0, s23, 3840
    s_nop 0
    buffer_load_dwordx4 v2, s[8:11], s24 offen offset:256 lds
    v_mfma_f32_16x16x32_bf16 v[220:223], v[148:151], v[36:39], v[220:223]
    v_mfma_f32_16x16x32_bf16 v[224:227], a[12:15], v[32:35], v[224:227]
    v_mfma_f32_16x16x32_bf16 v[228:231], a[84:87], v[32:35], v[228:231]
    v_mfma_f32_16x16x32_bf16 v[232:235], a[12:15], v[36:39], v[232:235]
    s_add_u32 m0, s23, 4800
    s_nop 0
    buffer_load_dwordx4 v2, s[8:11], s24 offen offset:320 lds
    v_mfma_f32_16x16x32_bf16 v[236:239], a[84:87], v[36:39], v[236:239]
    s_waitcnt lgkmcnt(2)
    v_mfma_f32_16x16x32_bf16 v[208:211], v[80:83], v[40:43], v[208:211]
    ds_read_b128 v[32:35], v3 offset:6144
    v_mfma_f32_16x16x32_bf16 v[212:215], v[152:155], v[40:43], v[212:215]
    ds_read_b128 v[36:39], v3 offset:24576
    v_mfma_f32_16x16x32_bf16 v[216:219], v[80:83], v[44:47], v[216:219]
    s_add_u32 m0, s23, 5760
    s_nop 0
    buffer_load_dwordx4 v2, s[8:11], s24 offen offset:384 lds
    v_mfma_f32_16x16x32_bf16 v[220:223], v[152:155], v[44:47], v[220:223]
    v_mfma_f32_16x16x32_bf16 v[224:227], a[16:19], v[40:43], v[224:227]
    v_mfma_f32_16x16x32_bf16 v[228:231], a[88:91], v[40:43], v[228:231]
    v_mfma_f32_16x16x32_bf16 v[232:235], a[16:19], v[44:47], v[232:235]
    s_add_u32 m0, s23, 6720
    s_nop 0
    buffer_load_dwordx4 v2, s[8:11], s24 offen offset:448 lds
    v_mfma_f32_16x16x32_bf16 v[236:239], a[88:91], v[44:47], v[236:239]
    s_waitcnt lgkmcnt(2)
    v_mfma_f32_16x16x32_bf16 v[208:211], v[84:87], v[48:51], v[208:211]
    ds_read_b128 v[40:43], v3 offset:7168
    v_mfma_f32_16x16x32_bf16 v[212:215], v[156:159], v[48:51], v[212:215]
    ds_read_b128 v[44:47], v3 offset:25600
    v_mfma_f32_16x16x32_bf16 v[216:219], v[84:87], v[52:55], v[216:219]
    s_add_u32 m0, s23, 7680
    s_nop 0
    buffer_load_dwordx4 v2, s[8:11], s24 offen offset:512 lds
    s_add_u32 s24, s24, 147456
    v_mfma_f32_16x16x32_bf16 v[220:223], v[156:159], v[52:55], v[220:223]
    v_mfma_f32_16x16x32_bf16 v[224:227], a[20:23], v[48:51], v[224:227]
    v_mfma_f32_16x16x32_bf16 v[228:231], a[92:95], v[48:51], v[228:231]
    v_mfma_f32_16x16x32_bf16 v[232:235], a[20:23], v[52:55], v[232:235]
    v_mfma_f32_16x16x32_bf16 v[236:239], a[92:95], v[52:55], v[236:239]
    s_waitcnt lgkmcnt(2)
    v_mfma_f32_16x16x32_bf16 v[208:211], v[88:91], v[32:35], v[208:211]
    ds_read_b128 v[48:51], v3 offset:8192
    v_mfma_f32_16x16x32_bf16 v[212:215], v[160:163], v[32:35], v[212:215]
    ds_read_b128 v[52:55], v3 offset:26624
    v_mfma_f32_16x16x32_bf16 v[216:219], v[88:91], v[36:39], v[216:219]
    v_mfma_f32_16x16x32_bf16 v[220:223], v[160:163], v[36:39], v[220:223]
    v_mfma_f32_16x16x32_bf16 v[224:227], a[24:27], v[32:35], v[224:227]
    v_mfma_f32_16x16x32_bf16 v[228:231], a[96:99], v[32:35], v[228:231]
    v_mfma_f32_16x16x32_bf16 v[232:235], a[24:27], v[36:39], v[232:235]
    v_mfma_f32_16x16x32_bf16 v[236:239], a[96:99], v[36:39], v[236:239]
    s_waitcnt lgkmcnt(2)
    v_mfma_f32_16x16x32_bf16 v[208:211], v[92:95], v[40:43], v[208:211]
    ds_read_b128 v[32:35], v3 offset:9216
    v_mfma_f32_16x16x32_bf16 v[212:215], v[164:167], v[40:43], v[212:215]
    ds_read_b128 v[36:39], v3 offset:27648
    v_mfma_f32_16x16x32_bf16 v[216:219], v[92:95], v[44:47], v[216:219]
    s_add_u32 s23, s45, s95
    v_mov_b32 v4, s23
    s_mov_b64 exec, s[34:35]
    buffer_store_dword v4, off, s[4:7], s29 sc1
    buffer_store_dword v4, off, s[4:7], s29 offset:128 sc1
    s_mov_b64 exec, -1
    v_mfma_f32_16x16x32_bf16 v[220:223], v[164:167], v[44:47], v[220:223]
    v_mfma_f32_16x16x32_bf16 v[224:227], a[28:31], v[40:43], v[224:227]
    v_mfma_f32_16x16x32_bf16 v[228:231], a[100:103], v[40:43], v[228:231]
    v_mfma_f32_16x16x32_bf16 v[232:235], a[28:31], v[44:47], v[232:235]
    v_mfma_f32_16x16x32_bf16 v[236:239], a[100:103], v[44:47], v[236:239]
    s_waitcnt lgkmcnt(2)
    v_mfma_f32_16x16x32_bf16 v[208:211], v[96:99], v[48:51], v[208:211]
    ds_read_b128 v[40:43], v3 offset:10240
    v_mfma_f32_16x16x32_bf16 v[212:215], v[168:171], v[48:51], v[212:215]
    ds_read_b128 v[44:47], v3 offset:28672
    v_mfma_f32_16x16x32_bf16 v[216:219], v[96:99], v[52:55], v[216:219]
    s_cmp_lt_u32 s19, 60
    s_cbranch_scc1 lt9
    buffer_load_dwordx4 v[244:247], off, s[84:87], 0 offset:16 sc1
    buffer_load_dword v248, off, s[84:87], 0 offset:4 sc1
lt9:
    s_lshr_b32 s46, s19, 2
    s_cmp_eq_u32 s16, 0
    s_cselect_b32 s46, 0, s46
    s_cmp_lg_u32 s46, 2
    s_cbranch_scc1 lp9
    v_mov_b32 v244, -1
    v_mov_b32 v245, -1
    v_mov_b32 v246, -1
    v_mov_b32 v247, -1
    s_lshl_b32 s46, s19, 5
    s_add_u32 s46, s46, s17
    s_lshl_b32 s46, s46, 12
    s_mul_i32 s47, s16, 8388608
    s_add_u32 s46, s46, s47
    s_add_u32 s47, s46, 67108864
    buffer_store_dwordx4 v[244:247], v7, s[4:7], s47 offen sc1
    s_add_u32 s47, s46, 67112960
    buffer_store_dwordx4 v[244:247], v7, s[4:7], s47 offen sc1
    s_add_u32 s47, s46, 67633152
    buffer_store_dwordx4 v[244:247], v7, s[4:7], s47 offen sc1
    s_add_u32 s47, s46, 67637248
    buffer_store_dwordx4 v[244:247], v7, s[4:7], s47 offen sc1
lp9:
    s_lshl_b32 s46, s16, 6
    s_or_b32 s46, s46, s19
    s_or_b32 s47, s46, 1
    s_cmp_lg_u32 s47, 11
    s_cbranch_scc1 lq9
    v_mov_b32 v244, -1
    v_mov_b32 v245, -1
    v_mov_b32 v246, -1
    v_mov_b32 v247, -1
    s_lshl_b32 s46, s46, 18
    s_lshl_b32 s47, s17, 12
    s_add_u32 s46, s46, s47
    s_add_u32 s47, s46, 63963136
    buffer_store_dwordx4 v[244:247], v7, s[4:7], s47 offen sc1
    s_add_u32 s47, s46, 63967232
    buffer_store_dwordx4 v[244:247], v7, s[4:7], s47 offen sc1
    s_add_u32 s47, s46, 64094208
    buffer_store_dwordx4 v[244:247], v7, s[4:7], s47 offen sc1
    s_add_u32 s47, s46, 64098304
    buffer_store_dwordx4 v[244:247], v7, s[4:7], s47 offen sc1
lq9:
    v_mfma_f32_16x16x32_bf16 v[220:223], v[168:171], v[52:55], v[220:223]
    v_mfma_f32_16x16x32_bf16 v[224:227], a[32:35], v[48:51], v[224:227]
    v_mfma_f32_16x16x32_bf16 v[228:231], a[104:107], v[48:51], v[228:231]
    v_mfma_f32_16x16x32_bf16 v[232:235], a[32:35], v[52:55], v[232:235]
    v_mfma_f32_16x16x32_bf16 v[236:239], a[104:107], v[52:55], v[236:239]
    s_waitcnt lgkmcnt(2)
    v_mfma_f32_16x16x32_bf16 v[208:211], v[100:103], v[32:35], v[208:211]
    ds_read_b128 v[48:51], v3 offset:11264
    v_mfma_f32_16x16x32_bf16 v[212:215], v[172:175], v[32:35], v[212:215]
    ds_read_b128 v[52:55], v3 offset:29696
    v_mfma_f32_16x16x32_bf16 v[216:219], v[100:103], v[36:39], v[216:219]
    v_mfma_f32_16x16x32_bf16 v[220:223], v[172:175], v[36:39], v[220:223]
    v_mfma_f32_16x16x32_bf16 v[224:227], a[36:39], v[32:35], v[224:227]
    v_mfma_f32_16x16x32_bf16 v[228:231], a[108:111], v[32:35], v[228:231]
    v_mfma_f32_16x16x32_bf16 v[232:235], a[36:39], v[36:39], v[232:235]
    v_mfma_f32_16x16x32_bf16 v[236:239], a[108:111], v[36:39], v[236:239]
    s_waitcnt lgkmcnt(2)
    v_mfma_f32_16x16x32_bf16 v[208:211], v[104:107], v[40:43], v[208:211]
    ds_read_b128 v[32:35], v3 offset:12288
    v_mfma_f32_16x16x32_bf16 v[212:215], v[176:179], v[40:43], v[212:215]
    ds_read_b128 v[36:39], v3 offset:30720
    v_mfma_f32_16x16x32_bf16 v[216:219], v[104:107], v[44:47], v[216:219]
    v_mfma_f32_16x16x32_bf16 v[220:223], v[176:179], v[44:47], v[220:223]
    v_mfma_f32_16x16x32_bf16 v[224:227], a[40:43], v[40:43], v[224:227]
    v_mfma_f32_16x16x32_bf16 v[228:231], a[112:115], v[40:43], v[228:231]
    v_mfma_f32_16x16x32_bf16 v[232:235], a[40:43], v[44:47], v[232:235]
    v_mfma_f32_16x16x32_bf16 v[236:239], a[112:115], v[44:47], v[236:239]
    s_waitcnt lgkmcnt(2)
    v_mfma_f32_16x16x32_bf16 v[208:211], v[108:111], v[48:51], v[208:211]
    ds_read_b128 v[40:43], v3 offset:13312
    v_mfma_f32_16x16x32_bf16 v[212:215], v[180:183], v[48:51], v[212:215]
    ds_read_b128 v[44:47], v3 offset:31744
    v_mfma_f32_16x16x32_bf16 v[216:219], v[108:111], v[52:55], v[216:219]
    v_mfma_f32_16x16x32_bf16 v[220:223], v[180:183], v[52:55], v[220:223]
    v_mfma_f32_16x16x32_bf16 v[224:227], a[44:47], v[48:51], v[224:227]
    v_mfma_f32_16x16x32_bf16 v[228:231], a[116:119], v[48:51], v[228:231]
    v_mfma_f32_16x16x32_bf16 v[232:235], a[44:47], v[52:55], v[232:235]
    v_mfma_f32_16x16x32_bf16 v[236:239], a[116:119], v[52:55], v[236:239]
    s_waitcnt lgkmcnt(2)
    v_mfma_f32_16x16x32_bf16 v[208:211], v[112:115], v[32:35], v[208:211]
    ds_read_b128 v[48:51], v3 offset:14336
    v_mfma_f32_16x16x32_bf16 v[212:215], v[184:187], v[32:35], v[212:215]
    ds_read_b128 v[52:55], v3 offset:32768
    v_mfma_f32_16x16x32_bf16 v[216:219], v[112:115], v[36:39], v[216:219]
    v_mfma_f32_16x16x32_bf16 v[220:223], v[184:187], v[36:39], v[220:223]
    v_mfma_f32_16x16x32_bf16 v[224:227], a[48:51], v[32:35], v[224:227]
    v_mfma_f32_16x16x32_bf16 v[228:231], a[120:123], v[32:35], v[228:231]
    v_mfma_f32_16x16x32_bf16 v[232:235], a[48:51], v[36:39], v[232:235]
    v_mfma_f32_16x16x32_bf16 v[236:239], a[120:123], v[36:39], v[236:239]
    s_waitcnt lgkmcnt(2)
    v_mfma_f32_16x16x32_bf16 v[208:211], v[116:119], v[40:43], v[208:211]
    ds_read_b128 v[32:35], v3 offset:15360
    v_mfma_f32_16x16x32_bf16 v[212:215], v[188:191], v[40:43], v[212:215]
    ds_read_b128 v[36:39], v3 offset:33792
    v_mfma_f32_16x16x32_bf16 v[216:219], v[116:119], v[44:47], v[216:219]
    v_mfma_f32_16x16x32_bf16 v[220:223], v[188:191], v[44:47], v[220:223]
    v_mfma_f32_16x16x32_bf16 v[224:227], a[52:55], v[40:43], v[224:227]
    v_mfma_f32_16x16x32_bf16 v[228:231], a[124:127], v[40:43], v[228:231]
    v_mfma_f32_16x16x32_bf16 v[232:235], a[52:55], v[44:47], v[232:235]
    v_mfma_f32_16x16x32_bf16 v[236:239], a[124:127], v[44:47], v[236:239]
    s_waitcnt lgkmcnt(2)
    v_mfma_f32_16x16x32_bf16 v[208:211], v[120:123], v[48:51], v[208:211]
    ds_read_b128 v[40:43], v3 offset:16384
    v_mfma_f32_16x16x32_bf16 v[212:215], v[192:195], v[48:51], v[212:215]
    ds_read_b128 v[44:47], v3 offset:34816
    v_mfma_f32_16x16x32_bf16 v[216:219], v[120:123], v[52:55], v[216:219]
    v_mfma_f32_16x16x32_bf16 v[220:223], v[192:195], v[52:55], v[220:223]
    v_mfma_f32_16x16x32_bf16 v[224:227], a[56:59], v[48:51], v[224:227]
    v_mfma_f32_16x16x32_bf16 v[228:231], a[128:131], v[48:51], v[228:231]
    v_mfma_f32_16x16x32_bf16 v[232:235], a[56:59], v[52:55], v[232:235]
    v_mfma_f32_16x16x32_bf16 v[236:239], a[128:131], v[52:55], v[236:239]
    s_waitcnt lgkmcnt(2)
    v_mfma_f32_16x16x32_bf16 v[208:211], v[124:127], v[32:35], v[208:211]
    ds_read_b128 v[48:51], v3 offset:17408
    v_mfma_f32_16x16x32_bf16 v[212:215], v[196:199], v[32:35], v[212:215]
    ds_read_b128 v[52:55], v3 offset:35840
    v_mfma_f32_16x16x32_bf16 v[216:219], v[124:127], v[36:39], v[216:219]
    v_mfma_f32_16x16x32_bf16 v[220:223], v[196:199], v[36:39], v[220:223]
    v_mfma_f32_16x16x32_bf16 v[224:227], a[60:63], v[32:35], v[224:227]
    s_add_u32 s27, s27, 36864
    s_cmp_eq_u32 s27, 110592
    s_cselect_b32 s27, 0, s27
    v_add_u32 v3, s27, v1
    v_mfma_f32_16x16x32_bf16 v[228:231], a[132:135], v[32:35], v[228:231]
    v_mfma_f32_16x16x32_bf16 v[232:235], a[60:63], v[36:39], v[232:235]
    v_mfma_f32_16x16x32_bf16 v[236:239], a[132:135], v[36:39], v[236:239]
    s_waitcnt lgkmcnt(2)
    v_mfma_f32_16x16x32_bf16 v[208:211], v[128:131], v[40:43], v[208:211]
    ds_read_b128 v[32:35], v3 offset:0
    v_mfma_f32_16x16x32_bf16 v[212:215], v[200:203], v[40:43], v[212:215]
    ds_read_b128 v[36:39], v3 offset:18432
    v_mfma_f32_16x16x32_bf16 v[216:219], v[128:131], v[44:47], v[216:219]
    v_mfma_f32_16x16x32_bf16 v[220:223], v[200:203], v[44:47], v[220:223]
    v_mfma_f32_16x16x32_bf16 v[224:227], a[64:67], v[40:43], v[224:227]
    v_mfma_f32_16x16x32_bf16 v[228:231], a[136:139], v[40:43], v[228:231]
    v_mfma_f32_16x16x32_bf16 v[232:235], a[64:67], v[44:47], v[232:235]
    v_mfma_f32_16x16x32_bf16 v[236:239], a[136:139], v[44:47], v[236:239]
    s_waitcnt lgkmcnt(2)
    v_mfma_f32_16x16x32_bf16 v[208:211], v[132:135], v[48:51], v[208:211]
    ds_read_b128 v[40:43], v3 offset:1024
    v_mfma_f32_16x16x32_bf16 v[212:215], v[204:207], v[48:51], v[212:215]
    ds_read_b128 v[44:47], v3 offset:19456
    v_mfma_f32_16x16x32_bf16 v[216:219], v[132:135], v[52:55], v[216:219]
    v_mfma_f32_16x16x32_bf16 v[220:223], v[204:207], v[52:55], v[220:223]
    v_mfma_f32_16x16x32_bf16 v[224:227], a[68:71], v[48:51], v[224:227]
    v_mfma_f32_16x16x32_bf16 v[228:231], a[140:143], v[48:51], v[228:231]
    v_mfma_f32_16x16x32_bf16 v[232:235], a[68:71], v[52:55], v[232:235]
    v_mfma_f32_16x16x32_bf16 v[236:239], a[140:143], v[52:55], v[236:239]
    s_add_u32 s26, s26, s41
    s_waitcnt vmcnt(0)
    v_cvt_pk_bf16_f32 v8, v208, v209
    v_cvt_pk_bf16_f32 v9, v210, v211
    v_cvt_pk_bf16_f32 v10, v212, v213
    v_cvt_pk_bf16_f32 v11, v214, v215
    v_cvt_pk_bf16_f32 v12, v216, v217
    v_cvt_pk_bf16_f32 v13, v218, v219
    v_cvt_pk_bf16_f32 v14, v220, v221
    v_cvt_pk_bf16_f32 v15, v222, v223
    v_cvt_pk_bf16_f32 v16, v224, v225
    v_cvt_pk_bf16_f32 v17, v226, v227
    v_cvt_pk_bf16_f32 v18, v228, v229
    v_cvt_pk_bf16_f32 v19, v230, v231
    v_cvt_pk_bf16_f32 v20, v232, v233
    v_cvt_pk_bf16_f32 v21, v234, v235
    v_cvt_pk_bf16_f32 v22, v236, v237
    v_cvt_pk_bf16_f32 v23, v238, v239
    s_mov_b64 s[36:37], -1
    s_add_u32 s28, s26, s12
    buffer_store_dwordx4 v[8:11], v7, s[4:7], s28 offen sc1
    s_add_u32 s28, s26, s13
    buffer_store_dwordx4 v[12:15], v7, s[4:7], s28 offen sc1
    s_add_u32 s28, s26, s14
    buffer_store_dwordx4 v[16:19], v7, s[4:7], s28 offen sc1
    s_add_u32 s28, s26, s15
    buffer_store_dwordx4 v[20:23], v7, s[4:7], s28 offen sc1
    s_lshr_b32 s45, s19, 2
    s_cbranch_scc1 qk_loop_nf
    s_mov_b32 s45, 1
    s_mov_b64 s[36:37], 0
    s_waitcnt vmcnt(0)
    s_barrier
    s_add_u32 s23, s45, s95
    v_mov_b32 v4, s23
    s_mov_b64 exec, s[34:35]
    buffer_store_dword v4, off, s[4:7], s29 sc1
    buffer_store_dword v4, off, s[4:7], s29 offset:128 sc1
    s_mov_b64 exec, -1
qk_loop_nf:
    s_add_u32 s19, s19, 4
    s_cmp_lt_u32 s19, s20
    s_cbranch_scc1 qk_loop
    s_branch qk_done
qk_vloop:
    s_barrier
    s_add_u32 s22, s27, 73728
    s_sub_u32 s21, s22, 110592
    s_cselect_b32 s22, s22, s21
    s_waitcnt lgkmcnt(2)
    v_mfma_f32_16x16x32_bf16 v[208:211], v[32:35], v[64:67], 0
    ds_read_b128 v[48:51], v3 offset:2048
    v_mfma_f32_16x16x32_bf16 v[212:215], v[32:35], v[136:139], 0
    ds_read_b128 v[52:55], v3 offset:20480
    v_mfma_f32_16x16x32_bf16 v[216:219], v[36:39], v[64:67], 0
    v_mfma_f32_16x16x32_bf16 v[220:223], v[36:39], v[136:139], 0
    v_mfma_f32_16x16x32_bf16 v[224:227], v[32:35], a[0:3], 0
    v_mfma_f32_16x16x32_bf16 v[228:231], v[32:35], a[72:75], 0
    v_mfma_f32_16x16x32_bf16 v[232:235], v[36:39], a[0:3], 0
    v_mfma_f32_16x16x32_bf16 v[236:239], v[36:39], a[72:75], 0
    s_waitcnt lgkmcnt(2)
    v_mfma_f32_16x16x32_bf16 v[208:211], v[40:43], v[68:71], v[208:211]
    ds_read_b128 v[32:35], v3 offset:3072
    v_mfma_f32_16x16x32_bf16 v[212:215], v[40:43], v[140:143], v[212:215]
    ds_read_b128 v[36:39], v3 offset:21504
    v_mfma_f32_16x16x32_bf16 v[216:219], v[44:47], v[68:71], v[216:219]
    s_add_u32 s23, s22, s25
    s_add_u32 m0, s23, 0
    s_nop 0
    buffer_load_dwordx4 v2, s[8:11], s24 offen offset:0 lds
    v_mfma_f32_16x16x32_bf16 v[220:223], v[44:47], v[140:143], v[220:223]
    v_mfma_f32_16x16x32_bf16 v[224:227], v[40:43], a[4:7], v[224:227]
    v_mfma_f32_16x16x32_bf16 v[228:231], v[40:43], a[76:79], v[228:231]
    v_mfma_f32_16x16x32_bf16 v[232:235], v[44:47], a[4:7], v[232:235]
    s_add_u32 m0, s23, 960
    s_nop 0
    buffer_load_dwordx4 v2, s[8:11], s24 offen offset:64 lds
    v_mfma_f32_16x16x32_bf16 v[236:239], v[44:47], a[76:79], v[236:239]
    s_waitcnt lgkmcnt(2)
    v_mfma_f32_16x16x32_bf16 v[208:211], v[48:51], v[72:75], v[208:211]
    ds_read_b128 v[40:43], v3 offset:4096
    v_mfma_f32_16x16x32_bf16 v[212:215], v[48:51], v[144:147], v[212:215]
    ds_read_b128 v[44:47], v3 offset:22528
    v_mfma_f32_16x16x32_bf16 v[216:219], v[52:55], v[72:75], v[216:219]
    s_add_u32 m0, s23, 1920
    s_nop 0
    buffer_load_dwordx4 v2, s[8:11], s24 offen offset:128 lds
    v_mfma_f32_16x16x32_bf16 v[220:223], v[52:55], v[144:147], v[220:223]
    v_mfma_f32_16x16x32_bf16 v[224:227], v[48:51], a[8:11], v[224:227]
    v_mfma_f32_16x16x32_bf16 v[228:231], v[48:51], a[80:83], v[228:231]
    v_mfma_f32_16x16x32_bf16 v[232:235], v[52:55], a[8:11], v[232:235]
    s_add_u32 m0, s23, 2880
    s_nop 0
    buffer_load_dwordx4 v2, s[8:11], s24 offen offset:192 lds
    v_mfma_f32_16x16x32_bf16 v[236:239], v[52:55], a[80:83], v[236:239]
    s_waitcnt lgkmcnt(2)
    v_mfma_f32_16x16x32_bf16 v[208:211], v[32:35], v[76:79], v[208:211]
    ds_read_b128 v[48:51], v3 offset:5120
    v_mfma_f32_16x16x32_bf16 v[212:215], v[32:35], v[148:151], v[212:215]
    ds_read_b128 v[52:55], v3 offset:23552
    v_mfma_f32_16x16x32_bf16 v[216:219], v[36:39], v[76:79], v[216:219]
    s_add_u32 m0, s23, 3840
    s_nop 0
    buffer_load_dwordx4 v2, s[8:11], s24 offen offset:256 lds
    v_mfma_f32_16x16x32_bf16 v[220:223], v[36:39], v[148:151], v[220:223]
    v_mfma_f32_16x16x32_bf16 v[224:227], v[32:35], a[12:15], v[224:227]
    v_mfma_f32_16x16x32_bf16 v[228:231], v[32:35], a[84:87], v[228:231]
    v_mfma_f32_16x16x32_bf16 v[232:235], v[36:39], a[12:15], v[232:235]
    s_add_u32 m0, s23, 4800
    s_nop 0
    buffer_load_dwordx4 v2, s[8:11], s24 offen offset:320 lds
    v_mfma_f32_16x16x32_bf16 v[236:239], v[36:39], a[84:87], v[236:239]
    s_waitcnt lgkmcnt(2)
    v_mfma_f32_16x16x32_bf16 v[208:211], v[40:43], v[80:83], v[208:211]
    ds_read_b128 v[32:35], v3 offset:6144
    v_mfma_f32_16x16x32_bf16 v[212:215], v[40:43], v[152:155], v[212:215]
    ds_read_b128 v[36:39], v3 offset:24576
    v_mfma_f32_16x16x32_bf16 v[216:219], v[44:47], v[80:83], v[216:219]
    s_add_u32 m0, s23, 5760
    s_nop 0
    buffer_load_dwordx4 v2, s[8:11], s24 offen offset:384 lds
    v_mfma_f32_16x16x32_bf16 v[220:223], v[44:47], v[152:155], v[220:223]
    v_mfma_f32_16x16x32_bf16 v[224:227], v[40:43], a[16:19], v[224:227]
    v_mfma_f32_16x16x32_bf16 v[228:231], v[40:43], a[88:91], v[228:231]
    v_mfma_f32_16x16x32_bf16 v[232:235], v[44:47], a[16:19], v[232:235]
    s_add_u32 m0, s23, 6720
    s_nop 0
    buffer_load_dwordx4 v2, s[8:11], s24 offen offset:448 lds
    v_mfma_f32_16x16x32_bf16 v[236:239], v[44:47], a[88:91], v[236:239]
    s_waitcnt lgkmcnt(2)
    v_mfma_f32_16x16x32_bf16 v[208:211], v[48:51], v[84:87], v[208:211]
    ds_read_b128 v[40:43], v3 offset:7168
    v_mfma_f32_16x16x32_bf16 v[212:215], v[48:51], v[156:159], v[212:215]
    ds_read_b128 v[44:47], v3 offset:25600
    v_mfma_f32_16x16x32_bf16 v[216:219], v[52:55], v[84:87], v[216:219]
    s_add_u32 m0, s23, 7680
    s_nop 0
    buffer_load_dwordx4 v2, s[8:11], s24 offen offset:512 lds
    s_add_u32 s24, s24, 147456
    v_mfma_f32_16x16x32_bf16 v[220:223], v[52:55], v[156:159], v[220:223]
    v_mfma_f32_16x16x32_bf16 v[224:227], v[48:51], a[20:23], v[224:227]
    v_mfma_f32_16x16x32_bf16 v[228:231], v[48:51], a[92:95], v[228:231]
    v_mfma_f32_16x16x32_bf16 v[232:235], v[52:55], a[20:23], v[232:235]
    v_mfma_f32_16x16x32_bf16 v[236:239], v[52:55], a[92:95], v[236:239]
    s_waitcnt lgkmcnt(2)
    v_mfma_f32_16x16x32_bf16 v[208:211], v[32:35], v[88:91], v[208:211]
    ds_read_b128 v[48:51], v3 offset:8192
    v_mfma_f32_16x16x32_bf16 v[212:215], v[32:35], v[160:163], v[212:215]
    ds_read_b128 v[52:55], v3 offset:26624
    v_mfma_f32_16x16x32_bf16 v[216:219], v[36:39], v[88:91], v[216:219]
    v_mfma_f32_16x16x32_bf16 v[220:223], v[36:39], v[160:163], v[220:223]
    v_mfma_f32_16x16x32_bf16 v[224:227], v[32:35], a[24:27], v[224:227]
    v_mfma_f32_16x16x32_bf16 v[228:231], v[32:35], a[96:99], v[228:231]
    v_mfma_f32_16x16x32_bf16 v[232:235], v[36:39], a[24:27], v[232:235]
    v_mfma_f32_16x16x32_bf16 v[236:239], v[36:39], a[96:99], v[236:239]
    s_waitcnt lgkmcnt(2)
    v_mfma_f32_16x16x32_bf16 v[208:211], v[40:43], v[92:95], v[208:211]
    ds_read_b128 v[32:35], v3 offset:9216
    v_mfma_f32_16x16x32_bf16 v[212:215], v[40:43], v[164:167], v[212:215]
    ds_read_b128 v[36:39], v3 offset:27648
    v_mfma_f32_16x16x32_bf16 v[216:219], v[44:47], v[92:95], v[216:219]
    s_add_u32 s23, s45, s95
    v_mov_b32 v4, s23
    s_mov_b64 exec, s[34:35]
    buffer_store_dword v4, off, s[4:7], s29 sc1
    buffer_store_dword v4, off, s[4:7], s29 offset:128 sc1
    s_mov_b64 exec, -1
    v_mfma_f32_16x16x32_bf16 v[220:223], v[44:47], v[164:167], v[220:223]
    v_mfma_f32_16x16x32_bf16 v[224:227], v[40:43], a[28:31], v[224:227]
    v_mfma_f32_16x16x32_bf16 v[228:231], v[40:43], a[100:103], v[228:231]
    v_mfma_f32_16x16x32_bf16 v[232:235], v[44:47], a[28:31], v[232:235]
    v_mfma_f32_16x16x32_bf16 v[236:239], v[44:47], a[100:103], v[236:239]
    s_waitcnt lgkmcnt(2)
    v_mfma_f32_16x16x32_bf16 v[208:211], v[48:51], v[96:99], v[208:211]
    ds_read_b128 v[40:43], v3 offset:10240
    v_mfma_f32_16x16x32_bf16 v[212:215], v[48:51], v[168:171], v[212:215]
    ds_read_b128 v[44:47], v3 offset:28672
    v_mfma_f32_16x16x32_bf16 v[216:219], v[52:55], v[96:99], v[216:219]
    s_cmp_lt_u32 s19, 60
    s_cbranch_scc1 lt10
    buffer_load_dwordx4 v[244:247], off, s[84:87], 0 offset:16 sc1
    buffer_load_dword v248, off, s[84:87], 0 offset:4 sc1
lt10:
    s_lshr_b32 s46, s19, 2
    s_cmp_eq_u32 s16, 0
    s_cselect_b32 s46, 0, s46
    s_cmp_lg_u32 s46, 2
    s_cbranch_scc1 lp10
    v_mov_b32 v244, -1
    v_mov_b32 v245, -1
    v_mov_b32 v246, -1
    v_mov_b32 v247, -1
    s_lshl_b32 s46, s19, 5
    s_add_u32 s46, s46, s17
    s_lshl_b32 s46, s46, 12
    s_mul_i32 s47, s16, 8388608
    s_add_u32 s46, s46, s47
    s_add_u32 s47, s46, 67108864
    buffer_store_dwordx4 v[244:247], v7, s[4:7], s47 offen sc1
    s_add_u32 s47, s46, 67112960
    buffer_store_dwordx4 v[244:247], v7, s[4:7], s47 offen sc1
    s_add_u32 s47, s46, 67633152
    buffer_store_dwordx4 v[244:247], v7, s[4:7], s47 offen sc1
    s_add_u32 s47, s46, 67637248
    buffer_store_dwordx4 v[244:247], v7, s[4:7], s47 offen sc1
lp10:
    s_lshl_b32 s46, s16, 6
    s_or_b32 s46, s46, s19
    s_or_b32 s47, s46, 1
    s_cmp_lg_u32 s47, 11
    s_cbranch_scc1 lq10
    v_mov_b32 v244, -1
    v_mov_b32 v245, -1
    v_mov_b32 v246, -1
    v_mov_b32 v247, -1
    s_lshl_b32 s46, s46, 18
    s_lshl_b32 s47, s17, 12
    s_add_u32 s46, s46, s47
    s_add_u32 s47, s46, 63963136
    buffer_store_dwordx4 v[244:247], v7, s[4:7], s47 offen sc1
    s_add_u32 s47, s46, 63967232
    buffer_store_dwordx4 v[244:247], v7, s[4:7], s47 offen sc1
    s_add_u32 s47, s46, 64094208
    buffer_store_dwordx4 v[244:247], v7, s[4:7], s47 offen sc1
    s_add_u32 s47, s46, 64098304
    buffer_store_dwordx4 v[244:247], v7, s[4:7], s47 offen sc1
lq10:
    v_mfma_f32_16x16x32_bf16 v[220:223], v[52:55], v[168:171], v[220:223]
    v_mfma_f32_16x16x32_bf16 v[224:227], v[48:51], a[32:35], v[224:227]
    v_mfma_f32_16x16x32_bf16 v[228:231], v[48:51], a[104:107], v[228:231]
    v_mfma_f32_16x16x32_bf16 v[232:235], v[52:55], a[32:35], v[232:235]
    v_mfma_f32_16x16x32_bf16 v[236:239], v[52:55], a[104:107], v[236:239]
    s_waitcnt lgkmcnt(2)
    v_mfma_f32_16x16x32_bf16 v[208:211], v[32:35], v[100:103], v[208:211]
    ds_read_b128 v[48:51], v3 offset:11264
    v_mfma_f32_16x16x32_bf16 v[212:215], v[32:35], v[172:175], v[212:215]
    ds_read_b128 v[52:55], v3 offset:29696
    v_mfma_f32_16x16x32_bf16 v[216:219], v[36:39], v[100:103], v[216:219]
    v_mfma_f32_16x16x32_bf16 v[220:223], v[36:39], v[172:175], v[220:223]
    v_mfma_f32_16x16x32_bf16 v[224:227], v[32:35], a[36:39], v[224:227]
    v_mfma_f32_16x16x32_bf16 v[228:231], v[32:35], a[108:111], v[228:231]
    v_mfma_f32_16x16x32_bf16 v[232:235], v[36:39], a[36:39], v[232:235]
    v_mfma_f32_16x16x32_bf16 v[236:239], v[36:39], a[108:111], v[236:239]
    s_waitcnt lgkmcnt(2)
    v_mfma_f32_16x16x32_bf16 v[208:211], v[40:43], v[104:107], v[208:211]
    ds_read_b128 v[32:35], v3 offset:12288
    v_mfma_f32_16x16x32_bf16 v[212:215], v[40:43], v[176:179], v[212:215]
    ds_read_b128 v[36:39], v3 offset:30720
    v_mfma_f32_16x16x32_bf16 v[216:219], v[44:47], v[104:107], v[216:219]
    v_mfma_f32_16x16x32_bf16 v[220:223], v[44:47], v[176:179], v[220:223]
    v_mfma_f32_16x16x32_bf16 v[224:227], v[40:43], a[40:43], v[224:227]
    v_mfma_f32_16x16x32_bf16 v[228:231], v[40:43], a[112:115], v[228:231]
    v_mfma_f32_16x16x32_bf16 v[232:235], v[44:47], a[40:43], v[232:235]
    v_mfma_f32_16x16x32_bf16 v[236:239], v[44:47], a[112:115], v[236:239]
    s_waitcnt lgkmcnt(2)
    v_mfma_f32_16x16x32_bf16 v[208:211], v[48:51], v[108:111], v[208:211]
    ds_read_b128 v[40:43], v3 offset:13312
    v_mfma_f32_16x16x32_bf16 v[212:215], v[48:51], v[180:183], v[212:215]
    ds_read_b128 v[44:47], v3 offset:31744
    v_mfma_f32_16x16x32_bf16 v[216:219], v[52:55], v[108:111], v[216:219]
    v_mfma_f32_16x16x32_bf16 v[220:223], v[52:55], v[180:183], v[220:223]
    v_mfma_f32_16x16x32_bf16 v[224:227], v[48:51], a[44:47], v[224:227]
    v_mfma_f32_16x16x32_bf16 v[228:231], v[48:51], a[116:119], v[228:231]
    v_mfma_f32_16x16x32_bf16 v[232:235], v[52:55], a[44:47], v[232:235]
    v_mfma_f32_16x16x32_bf16 v[236:239], v[52:55], a[116:119], v[236:239]
    s_waitcnt lgkmcnt(2)
    v_mfma_f32_16x16x32_bf16 v[208:211], v[32:35], v[112:115], v[208:211]
    ds_read_b128 v[48:51], v3 offset:14336
    v_mfma_f32_16x16x32_bf16 v[212:215], v[32:35], v[184:187], v[212:215]
    ds_read_b128 v[52:55], v3 offset:32768
    v_mfma_f32_16x16x32_bf16 v[216:219], v[36:39], v[112:115], v[216:219]
    v_mfma_f32_16x16x32_bf16 v[220:223], v[36:39], v[184:187], v[220:223]
    v_mfma_f32_16x16x32_bf16 v[224:227], v[32:35], a[48:51], v[224:227]
    v_mfma_f32_16x16x32_bf16 v[228:231], v[32:35], a[120:123], v[228:231]
    v_mfma_f32_16x16x32_bf16 v[232:235], v[36:39], a[48:51], v[232:235]
    v_mfma_f32_16x16x32_bf16 v[236:239], v[36:39], a[120:123], v[236:239]
    s_waitcnt lgkmcnt(2)
    v_mfma_f32_16x16x32_bf16 v[208:211], v[40:43], v[116:119], v[208:211]
    ds_read_b128 v[32:35], v3 offset:15360
    v_mfma_f32_16x16x32_bf16 v[212:215], v[40:43], v[188:191], v[212:215]
    ds_read_b128 v[36:39], v3 offset:33792
    v_mfma_f32_16x16x32_bf16 v[216:219], v[44:47], v[116:119], v[216:219]
    v_mfma_f32_16x16x32_bf16 v[220:223], v[44:47], v[188:191], v[220:223]
    v_mfma_f32_16x16x32_bf16 v[224:227], v[40:43], a[52:55], v[224:227]
    v_mfma_f32_16x16x32_bf16 v[228:231], v[40:43], a[124:127], v[228:231]
    v_mfma_f32_16x16x32_bf16 v[232:235], v[44:47], a[52:55], v[232:235]
    v_mfma_f32_16x16x32_bf16 v[236:239], v[44:47], a[124:127], v[236:239]
    s_waitcnt lgkmcnt(2)
    v_mfma_f32_16x16x32_bf16 v[208:211], v[48:51], v[120:123], v[208:211]
    ds_read_b128 v[40:43], v3 offset:16384
    v_mfma_f32_16x16x32_bf16 v[212:215], v[48:51], v[192:195], v[212:215]
    ds_read_b128 v[44:47], v3 offset:34816
    v_mfma_f32_16x16x32_bf16 v[216:219], v[52:55], v[120:123], v[216:219]
    v_mfma_f32_16x16x32_bf16 v[220:223], v[52:55], v[192:195], v[220:223]
    v_mfma_f32_16x16x32_bf16 v[224:227], v[48:51], a[56:59], v[224:227]
    v_mfma_f32_16x16x32_bf16 v[228:231], v[48:51], a[128:131], v[228:231]
    v_mfma_f32_16x16x32_bf16 v[232:235], v[52:55], a[56:59], v[232:235]
    v_mfma_f32_16x16x32_bf16 v[236:239], v[52:55], a[128:131], v[236:239]
    s_waitcnt lgkmcnt(2)
    v_mfma_f32_16x16x32_bf16 v[208:211], v[32:35], v[124:127], v[208:211]
    ds_read_b128 v[48:51], v3 offset:17408
    v_mfma_f32_16x16x32_bf16 v[212:215], v[32:35], v[196:199], v[212:215]
    ds_read_b128 v[52:55], v3 offset:35840
    v_mfma_f32_16x16x32_bf16 v[216:219], v[36:39], v[124:127], v[216:219]
    v_mfma_f32_16x16x32_bf16 v[220:223], v[36:39], v[196:199], v[220:223]
    v_mfma_f32_16x16x32_bf16 v[224:227], v[32:35], a[60:63], v[224:227]
    s_add_u32 s27, s27, 36864
    s_cmp_eq_u32 s27, 110592
    s_cselect_b32 s27, 0, s27
    v_add_u32 v3, s27, v1
    v_mfma_f32_16x16x32_bf16 v[228:231], v[32:35], a[132:135], v[228:231]
    v_mfma_f32_16x16x32_bf16 v[232:235], v[36:39], a[60:63], v[232:235]
    v_mfma_f32_16x16x32_bf16 v[236:239], v[36:39], a[132:135], v[236:239]
    s_waitcnt lgkmcnt(2)
    v_mfma_f32_16x16x32_bf16 v[208:211], v[40:43], v[128:131], v[208:211]
    ds_read_b128 v[32:35], v3 offset:0
    v_mfma_f32_16x16x32_bf16 v[212:215], v[40:43], v[200:203], v[212:215]
    ds_read_b128 v[36:39], v3 offset:18432
    v_mfma_f32_16x16x32_bf16 v[216:219], v[44:47], v[128:131], v[216:219]
    v_mfma_f32_16x16x32_bf16 v[220:223], v[44:47], v[200:203], v[220:223]
    v_mfma_f32_16x16x32_bf16 v[224:227], v[40:43], a[64:67], v[224:227]
    v_mfma_f32_16x16x32_bf16 v[228:231], v[40:43], a[136:139], v[228:231]
    v_mfma_f32_16x16x32_bf16 v[232:235], v[44:47], a[64:67], v[232:235]
    v_mfma_f32_16x16x32_bf16 v[236:239], v[44:47], a[136:139], v[236:239]
    s_waitcnt lgkmcnt(2)
    v_mfma_f32_16x16x32_bf16 v[208:211], v[48:51], v[132:135], v[208:211]
    ds_read_b128 v[40:43], v3 offset:1024
    v_mfma_f32_16x16x32_bf16 v[212:215], v[48:51], v[204:207], v[212:215]
    ds_read_b128 v[44:47], v3 offset:19456
    v_mfma_f32_16x16x32_bf16 v[216:219], v[52:55], v[132:135], v[216:219]
    v_mfma_f32_16x16x32_bf16 v[220:223], v[52:55], v[204:207], v[220:223]
    v_mfma_f32_16x16x32_bf16 v[224:227], v[48:51], a[68:71], v[224:227]
    v_mfma_f32_16x16x32_bf16 v[228:231], v[48:51], a[140:143], v[228:231]
    v_mfma_f32_16x16x32_bf16 v[232:235], v[52:55], a[68:71], v[232:235]
    v_mfma_f32_16x16x32_bf16 v[236:239], v[52:55], a[140:143], v[236:239]
    s_add_u32 s26, s26, s41
    s_waitcnt vmcnt(0)
    v_cvt_pk_bf16_f32 v8, v208, v209
    v_cvt_pk_bf16_f32 v9, v210, v211
    v_cvt_pk_bf16_f32 v10, v216, v217
    v_cvt_pk_bf16_f32 v11, v218, v219
    v_cvt_pk_bf16_f32 v12, v212, v213
    v_cvt_pk_bf16_f32 v13, v214, v215
    v_cvt_pk_bf16_f32 v14, v220, v221
    v_cvt_pk_bf16_f32 v15, v222, v223
    v_cvt_pk_bf16_f32 v16, v224, v225
    v_cvt_pk_bf16_f32 v17, v226, v227
    v_cvt_pk_bf16_f32 v18, v232, v233
    v_cvt_pk_bf16_f32 v19, v234, v235
    v_cvt_pk_bf16_f32 v20, v228, v229
    v_cvt_pk_bf16_f32 v21, v230, v231
    v_cvt_pk_bf16_f32 v22, v236, v237
    v_cvt_pk_bf16_f32 v23, v238, v239
    s_mov_b64 s[36:37], -1
    s_add_u32 s28, s26, s12
    buffer_store_dwordx4 v[8:11], v7, s[4:7], s28 offen sc1
    s_add_u32 s28, s26, s13
    buffer_store_dwordx4 v[12:15], v7, s[4:7], s28 offen sc1
    s_add_u32 s28, s26, s14
    buffer_store_dwordx4 v[16:19], v7, s[4:7], s28 offen sc1
    s_add_u32 s28, s26, s15
    buffer_store_dwordx4 v[20:23], v7, s[4:7], s28 offen sc1
    s_lshr_b32 s45, s19, 2
    s_cbranch_scc1 qk_vloop_nf
    s_mov_b32 s45, 1
    s_mov_b64 s[36:37], 0
    s_waitcnt vmcnt(0)
    s_barrier
    s_add_u32 s23, s45, s95
    v_mov_b32 v4, s23
    s_mov_b64 exec, s[34:35]
    buffer_store_dword v4, off, s[4:7], s29 sc1
    buffer_store_dword v4, off, s[4:7], s29 offset:128 sc1
    s_mov_b64 exec, -1
qk_vloop_nf:
    s_add_u32 s19, s19, 4
    s_cmp_lt_u32 s19, s20
    s_cbranch_scc1 qk_vloop
qk_done:
    s_waitcnt vmcnt(0) lgkmcnt(0)
    s_barrier
    s_mov_b32 s45, 16
    s_add_u32 s23, s45, s95
    v_mov_b32 v4, s23
    s_mov_b64 exec, s[34:35]
    buffer_store_dword v4, off, s[4:7], s29 sc1
    buffer_store_dword v4, off, s[4:7], s29 offset:128 sc1
    s_mov_b64 exec, -1
    s_cmp_lt_i32 s33, 0
    s_cbranch_scc1 L_memkv
    v_readfirstlane_b32 s40, v245
    v_readfirstlane_b32 s41, v246
    v_readfirstlane_b32 s42, v247
    v_readfirstlane_b32 s43, v248
    s_cmp_ge_u32 s40, 160
    s_cselect_b32 s43, s43, 0
    s_cmp_ge_u32 s41, 1
    s_cselect_b32 s43, s43, 0
    s_cmp_eq_u32 s42, 1
    s_cselect_b32 s43, s43, 0
    s_cmp_eq_u32 s93, 1000
    s_cselect_b32 s43, s43, 0
    s_mov_b32 s93, 999
    v_mov_b32 v250, s43
    v_mov_b32 v251, 163832
    s_mov_b64 exec, s[34:35]
    ds_write_b32 v251, v250
    s_mov_b64 exec, -1
    s_waitcnt lgkmcnt(0)
    s_barrier
    ds_read_b32 v252, v251
    s_waitcnt lgkmcnt(0)
    v_readfirstlane_b32 s43, v252
    s_barrier
    s_cmp_lg_u32 s43, 192
    s_cbranch_scc1 L_qkv_next
    s_mov_b32 s45, s33
    s_mov_b32 s93, 500
    s_branch L_phase2b
L_memkv:
    v_and_b32 v4, 63, v0
    v_and_b32 v2, 7, v4
    v_lshrrev_b32 v5, 4, v4
    v_lshl_add_u32 v2, v5, 3, v2
    v_lshlrev_b32 v2, 4, v2
    v_bfe_u32 v3, v4, 3, 1
    v_mul_u32_u24 v5, 9216, v3
    v_add_u32 v2, v2, v5
    v_mov_b32 v240, 0x05040100
    v_mov_b32 v241, 0x07060302
    v_lshrrev_b32 v5, 5, v4
    v_and_b32 v1, 0xdff, v7
    s_cmp_eq_u32 s16, 2
    s_cbranch_scc1 mk_isv
    v_mov_b32 v5, v3
    v_or_b32 v1, 128, v7
mk_isv:
    v_lshl_add_u32 v1, v5, 17, v1
    s_mov_b32 s28, 0
    s_mov_b32 s19, 2
    s_mov_b32 s24, 138412032
    s_lshl_b32 s26, s17, 12
    s_mov_b32 s21, 69206016
    s_cmp_eq_u32 s16, 2
    s_cselect_b32 s21, 77594624, s21
    s_add_u32 s26, s26, s21
    s_lshl_b32 s29, s17, 7
    s_lshl_b32 s21, s16, 2
    s_add_u32 s29, s29, s21
    s_add_u32 s29, s29, 125829164
mk_loop:
    s_cmp_lg_u32 s18, 0
    s_cbranch_scc1 mk_go
    s_cmp_le_u32 s19, s28
    s_cbranch_scc1 mk_go
    s_mov_b32 s23, 125853696
    s_mov_b32 s21, 4194304
mk_wait:
    buffer_load_dword v4, off, s[4:7], s23 sc1
    s_sub_u32 s21, s21, 1
    s_cbranch_scc1 mk_go
    s_waitcnt vmcnt(0)
    v_readfirstlane_b32 s28, v4
    s_nop 0
    s_sub_u32 s28, s28, s95
    s_cmp_gt_u32 s28, 64
    s_cselect_b32 s28, 0, s28
    s_cmp_le_u32 s19, s28
    s_cbranch_scc1 mk_go
    s_sleep 4
    s_branch mk_wait
mk_go:
    s_barrier
    s_add_u32 s21, s24, 4096
    s_add_u32 s23, s24, 8192
    buffer_load_dwordx4 v[24:27], v2, s[4:7], s24 offen offset:0 sc1
    buffer_load_dwordx4 v[28:31], v2, s[4:7], s24 offen offset:512 sc1
    buffer_load_dwordx4 v[32:35], v2, s[4:7], s21 offen offset:0 sc1
    buffer_load_dwordx4 v[36:39], v2, s[4:7], s21 offen offset:512 sc1
    buffer_load_dwordx4 v[40:43], v2, s[4:7], s24 offen offset:1024 sc1
    buffer_load_dwordx4 v[44:47], v2, s[4:7], s24 offen offset:1536 sc1
    buffer_load_dwordx4 v[48:51], v2, s[4:7], s21 offen offset:1024 sc1
    buffer_load_dwordx4 v[52:55], v2, s[4:7], s21 offen offset:1536 sc1
    buffer_load_dwordx4 v[56:59], v2, s[4:7], s24 offen offset:2048 sc1
    buffer_load_dwordx4 v[60:63], v2, s[4:7], s24 offen offset:2560 sc1
    buffer_load_dwordx4 v[208:211], v2, s[4:7], s21 offen offset:2048 sc1
    buffer_load_dwordx4 v[212:215], v2, s[4:7], s21 offen offset:2560 sc1
    buffer_load_dwordx4 v[216:219], v2, s[4:7], s24 offen offset:3072 sc1
    buffer_load_dwordx4 v[220:223], v2, s[4:7], s24 offen offset:3584 sc1
    buffer_load_dwordx4 v[224:227], v2, s[4:7], s21 offen offset:3072 sc1
    buffer_load_dwordx4 v[228:231], v2, s[4:7], s21 offen offset:3584 sc1
    buffer_load_dwordx4 v[232:235], v2, s[4:7], s23 offen offset:0 sc1
    buffer_load_dwordx4 v[236:239], v2, s[4:7], s23 offen offset:512 sc1
    s_add_u32 s24, s24, 18432
    s_cmp_eq_u32 s16, 2
    s_cbranch_scc1 mk_v
    s_waitcnt vmcnt(17)
    s_waitcnt vmcnt(16)
    v_mfma_f32_16x16x32_bf16 v[8:11], v[64:67], v[24:27], 0
    v_mfma_f32_16x16x32_bf16 v[12:15], v[136:139], v[24:27], 0
    v_mfma_f32_16x16x32_bf16 v[16:19], a[0:3], v[24:27], 0
    v_mfma_f32_16x16x32_bf16 v[20:23], a[72:75], v[24:27], 0
    s_waitcnt vmcnt(15)
    v_mfma_f32_16x16x32_bf16 v[8:11], v[68:71], v[28:31], v[8:11]
    v_mfma_f32_16x16x32_bf16 v[12:15], v[140:143], v[28:31], v[12:15]
    v_mfma_f32_16x16x32_bf16 v[16:19], a[4:7], v[28:31], v[16:19]
    v_mfma_f32_16x16x32_bf16 v[20:23], a[76:79], v[28:31], v[20:23]
    s_waitcnt vmcnt(14)
    v_mfma_f32_16x16x32_bf16 v[8:11], v[72:75], v[32:35], v[8:11]
    v_mfma_f32_16x16x32_bf16 v[12:15], v[144:147], v[32:35], v[12:15]
    v_mfma_f32_16x16x32_bf16 v[16:19], a[8:11], v[32:35], v[16:19]
    v_mfma_f32_16x16x32_bf16 v[20:23], a[80:83], v[32:35], v[20:23]
    s_waitcnt vmcnt(13)
    v_mfma_f32_16x16x32_bf16 v[8:11], v[76:79], v[36:39], v[8:11]
    v_mfma_f32_16x16x32_bf16 v[12:15], v[148:151], v[36:39], v[12:15]
    v_mfma_f32_16x16x32_bf16 v[16:19], a[12:15], v[36:39], v[16:19]
    v_mfma_f32_16x16x32_bf16 v[20:23], a[84:87], v[36:39], v[20:23]
    s_waitcnt vmcnt(12)
    v_mfma_f32_16x16x32_bf16 v[8:11], v[80:83], v[40:43], v[8:11]
    v_mfma_f32_16x16x32_bf16 v[12:15], v[152:155], v[40:43], v[12:15]
    v_mfma_f32_16x16x32_bf16 v[16:19], a[16:19], v[40:43], v[16:19]
    v_mfma_f32_16x16x32_bf16 v[20:23], a[88:91], v[40:43], v[20:23]
    s_waitcnt vmcnt(11)
    v_mfma_f32_16x16x32_bf16 v[8:11], v[84:87], v[44:47], v[8:11]
    v_mfma_f32_16x16x32_bf16 v[12:15], v[156:159], v[44:47], v[12:15]
    v_mfma_f32_16x16x32_bf16 v[16:19], a[20:23], v[44:47], v[16:19]
    v_mfma_f32_16x16x32_bf16 v[20:23], a[92:95], v[44:47], v[20:23]
    s_waitcnt vmcnt(10)
    v_mfma_f32_16x16x32_bf16 v[8:11], v[88:91], v[48:51], v[8:11]
    v_mfma_f32_16x16x32_bf16 v[12:15], v[160:163], v[48:51], v[12:15]
    v_mfma_f32_16x16x32_bf16 v[16:19], a[24:27], v[48:51], v[16:19]
    v_mfma_f32_16x16x32_bf16 v[20:23], a[96:99], v[48:51], v[20:23]
    s_waitcnt vmcnt(9)
    v_mfma_f32_16x16x32_bf16 v[8:11], v[92:95], v[52:55], v[8:11]
    v_mfma_f32_16x16x32_bf16 v[12:15], v[164:167], v[52:55], v[12:15]
    v_mfma_f32_16x16x32_bf16 v[16:19], a[28:31], v[52:55], v[16:19]
    v_mfma_f32_16x16x32_bf16 v[20:23], a[100:103], v[52:55], v[20:23]
    s_waitcnt vmcnt(8)
    v_mfma_f32_16x16x32_bf16 v[8:11], v[96:99], v[56:59], v[8:11]
    v_mfma_f32_16x16x32_bf16 v[12:15], v[168:171], v[56:59], v[12:15]
    v_mfma_f32_16x16x32_bf16 v[16:19], a[32:35], v[56:59], v[16:19]
    v_mfma_f32_16x16x32_bf16 v[20:23], a[104:107], v[56:59], v[20:23]
    s_waitcnt vmcnt(7)
    v_mfma_f32_16x16x32_bf16 v[8:11], v[100:103], v[60:63], v[8:11]
    v_mfma_f32_16x16x32_bf16 v[12:15], v[172:175], v[60:63], v[12:15]
    v_mfma_f32_16x16x32_bf16 v[16:19], a[36:39], v[60:63], v[16:19]
    v_mfma_f32_16x16x32_bf16 v[20:23], a[108:111], v[60:63], v[20:23]
    s_waitcnt vmcnt(6)
    v_mfma_f32_16x16x32_bf16 v[8:11], v[104:107], v[208:211], v[8:11]
    v_mfma_f32_16x16x32_bf16 v[12:15], v[176:179], v[208:211], v[12:15]
    v_mfma_f32_16x16x32_bf16 v[16:19], a[40:43], v[208:211], v[16:19]
    v_mfma_f32_16x16x32_bf16 v[20:23], a[112:115], v[208:211], v[20:23]
    s_waitcnt vmcnt(5)
    v_mfma_f32_16x16x32_bf16 v[8:11], v[108:111], v[212:215], v[8:11]
    v_mfma_f32_16x16x32_bf16 v[12:15], v[180:183], v[212:215], v[12:15]
    v_mfma_f32_16x16x32_bf16 v[16:19], a[44:47], v[212:215], v[16:19]
    v_mfma_f32_16x16x32_bf16 v[20:23], a[116:119], v[212:215], v[20:23]
    s_waitcnt vmcnt(4)
    v_mfma_f32_16x16x32_bf16 v[8:11], v[112:115], v[216:219], v[8:11]
    v_mfma_f32_16x16x32_bf16 v[12:15], v[184:187], v[216:219], v[12:15]
    v_mfma_f32_16x16x32_bf16 v[16:19], a[48:51], v[216:219], v[16:19]
    v_mfma_f32_16x16x32_bf16 v[20:23], a[120:123], v[216:219], v[20:23]
    s_waitcnt vmcnt(3)
    v_mfma_f32_16x16x32_bf16 v[8:11], v[116:119], v[220:223], v[8:11]
    v_mfma_f32_16x16x32_bf16 v[12:15], v[188:191], v[220:223], v[12:15]
    v_mfma_f32_16x16x32_bf16 v[16:19], a[52:55], v[220:223], v[16:19]
    v_mfma_f32_16x16x32_bf16 v[20:23], a[124:127], v[220:223], v[20:23]
    s_waitcnt vmcnt(2)
    v_mfma_f32_16x16x32_bf16 v[8:11], v[120:123], v[224:227], v[8:11]
    v_mfma_f32_16x16x32_bf16 v[12:15], v[192:195], v[224:227], v[12:15]
    v_mfma_f32_16x16x32_bf16 v[16:19], a[56:59], v[224:227], v[16:19]
    v_mfma_f32_16x16x32_bf16 v[20:23], a[128:131], v[224:227], v[20:23]
    s_waitcnt vmcnt(1)
    v_mfma_f32_16x16x32_bf16 v[8:11], v[124:127], v[228:231], v[8:11]
    v_mfma_f32_16x16x32_bf16 v[12:15], v[196:199], v[228:231], v[12:15]
    v_mfma_f32_16x16x32_bf16 v[16:19], a[60:63], v[228:231], v[16:19]
    v_mfma_f32_16x16x32_bf16 v[20:23], a[132:135], v[228:231], v[20:23]
    s_waitcnt vmcnt(0)
    v_mfma_f32_16x16x32_bf16 v[8:11], v[128:131], v[232:235], v[8:11]
    v_mfma_f32_16x16x32_bf16 v[12:15], v[200:203], v[232:235], v[12:15]
    v_mfma_f32_16x16x32_bf16 v[16:19], a[64:67], v[232:235], v[16:19]
    v_mfma_f32_16x16x32_bf16 v[20:23], a[136:139], v[232:235], v[20:23]
    v_mfma_f32_16x16x32_bf16 v[8:11], v[132:135], v[236:239], v[8:11]
    v_mfma_f32_16x16x32_bf16 v[12:15], v[204:207], v[236:239], v[12:15]
    v_mfma_f32_16x16x32_bf16 v[16:19], a[68:71], v[236:239], v[16:19]
    v_mfma_f32_16x16x32_bf16 v[20:23], a[140:143], v[236:239], v[20:23]
    s_nop 7
    s_branch mk_st
mk_v:
    s_waitcnt vmcnt(17)
    s_waitcnt vmcnt(16)
    v_mfma_f32_16x16x32_bf16 v[8:11], v[24:27], v[64:67], 0
    v_mfma_f32_16x16x32_bf16 v[12:15], v[24:27], v[136:139], 0
    v_mfma_f32_16x16x32_bf16 v[16:19], v[24:27], a[0:3], 0
    v_mfma_f32_16x16x32_bf16 v[20:23], v[24:27], a[72:75], 0
    s_waitcnt vmcnt(15)
    v_mfma_f32_16x16x32_bf16 v[8:11], v[28:31], v[68:71], v[8:11]
    v_mfma_f32_16x16x32_bf16 v[12:15], v[28:31], v[140:143], v[12:15]
    v_mfma_f32_16x16x32_bf16 v[16:19], v[28:31], a[4:7], v[16:19]
    v_mfma_f32_16x16x32_bf16 v[20:23], v[28:31], a[76:79], v[20:23]
    s_waitcnt vmcnt(14)
    v_mfma_f32_16x16x32_bf16 v[8:11], v[32:35], v[72:75], v[8:11]
    v_mfma_f32_16x16x32_bf16 v[12:15], v[32:35], v[144:147], v[12:15]
    v_mfma_f32_16x16x32_bf16 v[16:19], v[32:35], a[8:11], v[16:19]
    v_mfma_f32_16x16x32_bf16 v[20:23], v[32:35], a[80:83], v[20:23]
    s_waitcnt vmcnt(13)
    v_mfma_f32_16x16x32_bf16 v[8:11], v[36:39], v[76:79], v[8:11]
    v_mfma_f32_16x16x32_bf16 v[12:15], v[36:39], v[148:151], v[12:15]
    v_mfma_f32_16x16x32_bf16 v[16:19], v[36:39], a[12:15], v[16:19]
    v_mfma_f32_16x16x32_bf16 v[20:23], v[36:39], a[84:87], v[20:23]
    s_waitcnt vmcnt(12)
    v_mfma_f32_16x16x32_bf16 v[8:11], v[40:43], v[80:83], v[8:11]
    v_mfma_f32_16x16x32_bf16 v[12:15], v[40:43], v[152:155], v[12:15]
    v_mfma_f32_16x16x32_bf16 v[16:19], v[40:43], a[16:19], v[16:19]
    v_mfma_f32_16x16x32_bf16 v[20:23], v[40:43], a[88:91], v[20:23]
    s_waitcnt vmcnt(11)
    v_mfma_f32_16x16x32_bf16 v[8:11], v[44:47], v[84:87], v[8:11]
    v_mfma_f32_16x16x32_bf16 v[12:15], v[44:47], v[156:159], v[12:15]
    v_mfma_f32_16x16x32_bf16 v[16:19], v[44:47], a[20:23], v[16:19]
    v_mfma_f32_16x16x32_bf16 v[20:23], v[44:47], a[92:95], v[20:23]
    s_waitcnt vmcnt(10)
    v_mfma_f32_16x16x32_bf16 v[8:11], v[48:51], v[88:91], v[8:11]
    v_mfma_f32_16x16x32_bf16 v[12:15], v[48:51], v[160:163], v[12:15]
    v_mfma_f32_16x16x32_bf16 v[16:19], v[48:51], a[24:27], v[16:19]
    v_mfma_f32_16x16x32_bf16 v[20:23], v[48:51], a[96:99], v[20:23]
    s_waitcnt vmcnt(9)
    v_mfma_f32_16x16x32_bf16 v[8:11], v[52:55], v[92:95], v[8:11]
    v_mfma_f32_16x16x32_bf16 v[12:15], v[52:55], v[164:167], v[12:15]
    v_mfma_f32_16x16x32_bf16 v[16:19], v[52:55], a[28:31], v[16:19]
    v_mfma_f32_16x16x32_bf16 v[20:23], v[52:55], a[100:103], v[20:23]
    s_waitcnt vmcnt(8)
    v_mfma_f32_16x16x32_bf16 v[8:11], v[56:59], v[96:99], v[8:11]
    v_mfma_f32_16x16x32_bf16 v[12:15], v[56:59], v[168:171], v[12:15]
    v_mfma_f32_16x16x32_bf16 v[16:19], v[56:59], a[32:35], v[16:19]
    v_mfma_f32_16x16x32_bf16 v[20:23], v[56:59], a[104:107], v[20:23]
    s_waitcnt vmcnt(7)
    v_mfma_f32_16x16x32_bf16 v[8:11], v[60:63], v[100:103], v[8:11]
    v_mfma_f32_16x16x32_bf16 v[12:15], v[60:63], v[172:175], v[12:15]
    v_mfma_f32_16x16x32_bf16 v[16:19], v[60:63], a[36:39], v[16:19]
    v_mfma_f32_16x16x32_bf16 v[20:23], v[60:63], a[108:111], v[20:23]
    s_waitcnt vmcnt(6)
    v_mfma_f32_16x16x32_bf16 v[8:11], v[208:211], v[104:107], v[8:11]
    v_mfma_f32_16x16x32_bf16 v[12:15], v[208:211], v[176:179], v[12:15]
    v_mfma_f32_16x16x32_bf16 v[16:19], v[208:211], a[40:43], v[16:19]
    v_mfma_f32_16x16x32_bf16 v[20:23], v[208:211], a[112:115], v[20:23]
    s_waitcnt vmcnt(5)
    v_mfma_f32_16x16x32_bf16 v[8:11], v[212:215], v[108:111], v[8:11]
    v_mfma_f32_16x16x32_bf16 v[12:15], v[212:215], v[180:183], v[12:15]
    v_mfma_f32_16x16x32_bf16 v[16:19], v[212:215], a[44:47], v[16:19]
    v_mfma_f32_16x16x32_bf16 v[20:23], v[212:215], a[116:119], v[20:23]
    s_waitcnt vmcnt(4)
    v_mfma_f32_16x16x32_bf16 v[8:11], v[216:219], v[112:115], v[8:11]
    v_mfma_f32_16x16x32_bf16 v[12:15], v[216:219], v[184:187], v[12:15]
    v_mfma_f32_16x16x32_bf16 v[16:19], v[216:219], a[48:51], v[16:19]
    v_mfma_f32_16x16x32_bf16 v[20:23], v[216:219], a[120:123], v[20:23]
    s_waitcnt vmcnt(3)
    v_mfma_f32_16x16x32_bf16 v[8:11], v[220:223], v[116:119], v[8:11]
    v_mfma_f32_16x16x32_bf16 v[12:15], v[220:223], v[188:191], v[12:15]
    v_mfma_f32_16x16x32_bf16 v[16:19], v[220:223], a[52:55], v[16:19]
    v_mfma_f32_16x16x32_bf16 v[20:23], v[220:223], a[124:127], v[20:23]
    s_waitcnt vmcnt(2)
    v_mfma_f32_16x16x32_bf16 v[8:11], v[224:227], v[120:123], v[8:11]
    v_mfma_f32_16x16x32_bf16 v[12:15], v[224:227], v[192:195], v[12:15]
    v_mfma_f32_16x16x32_bf16 v[16:19], v[224:227], a[56:59], v[16:19]
    v_mfma_f32_16x16x32_bf16 v[20:23], v[224:227], a[128:131], v[20:23]
    s_waitcnt vmcnt(1)
    v_mfma_f32_16x16x32_bf16 v[8:11], v[228:231], v[124:127], v[8:11]
    v_mfma_f32_16x16x32_bf16 v[12:15], v[228:231], v[196:199], v[12:15]
    v_mfma_f32_16x16x32_bf16 v[16:19], v[228:231], a[60:63], v[16:19]
    v_mfma_f32_16x16x32_bf16 v[20:23], v[228:231], a[132:135], v[20:23]
    s_waitcnt vmcnt(0)
    v_mfma_f32_16x16x32_bf16 v[8:11], v[232:235], v[128:131], v[8:11]
    v_mfma_f32_16x16x32_bf16 v[12:15], v[232:235], v[200:203], v[12:15]
    v_mfma_f32_16x16x32_bf16 v[16:19], v[232:235], a[64:67], v[16:19]
    v_mfma_f32_16x16x32_bf16 v[20:23], v[232:235], a[136:139], v[20:23]
    v_mfma_f32_16x16x32_bf16 v[8:11], v[236:239], v[132:135], v[8:11]
    v_mfma_f32_16x16x32_bf16 v[12:15], v[236:239], v[204:207], v[12:15]
    v_mfma_f32_16x16x32_bf16 v[16:19], v[236:239], a[68:71], v[16:19]
    v_mfma_f32_16x16x32_bf16 v[20:23], v[236:239], a[140:143], v[20:23]
    s_nop 4
    v_pk_mul_f32 v[8:9], v[8:9], 0.5 op_sel_hi:[1,0]
    v_pk_mul_f32 v[10:11], v[10:11], 0.5 op_sel_hi:[1,0]
    v_pk_mul_f32 v[12:13], v[12:13], 0.5 op_sel_hi:[1,0]
    v_pk_mul_f32 v[14:15], v[14:15], 0.5 op_sel_hi:[1,0]
    v_pk_mul_f32 v[16:17], v[16:17], 0.5 op_sel_hi:[1,0]
    v_pk_mul_f32 v[18:19], v[18:19], 0.5 op_sel_hi:[1,0]
    v_pk_mul_f32 v[20:21], v[20:21], 0.5 op_sel_hi:[1,0]
    v_pk_mul_f32 v[22:23], v[22:23], 0.5 op_sel_hi:[1,0]
mk_st:
    s_nop 1
    v_cvt_pk_bf16_f32 v24, v8, v9
    v_cvt_pk_bf16_f32 v25, v10, v11
    v_cvt_pk_bf16_f32 v26, v12, v13
    v_cvt_pk_bf16_f32 v27, v14, v15
    v_cvt_pk_bf16_f32 v28, v16, v17
    v_cvt_pk_bf16_f32 v29, v18, v19
    v_cvt_pk_bf16_f32 v30, v20, v21
    v_cvt_pk_bf16_f32 v31, v22, v23
    s_add_u32 s21, s26, 4096
    buffer_store_dwordx4 v[24:27], v1, s[4:7], s26 offen sc1
    buffer_store_dwordx4 v[28:31], v1, s[4:7], s21 offen sc1
    s_add_u32 s22, s19, s95
    s_waitcnt vmcnt(0)
    s_barrier
    v_mov_b32 v4, s22
    s_mov_b64 exec, s[34:35]
    buffer_store_dword v4, off, s[4:7], s29 sc1
    buffer_store_dword v4, off, s[4:7], s29 offset:128 sc1
    s_mov_b64 exec, -1
    s_add_u32 s19, s19, 2
    s_add_u32 s26, s26, 262144
    s_cmp_le_u32 s19, 56
    s_cbranch_scc1 mk_loop
    s_mov_b32 s45, 2
    s_mov_b32 s8, s76
    s_mov_b32 s9, s77
    s_mov_b32 s10, 4718592
    s_mov_b32 s11, 0x20000
    s_branch L_att_next
L_ssm_next:
    s_sub_u32 s93, s93, 1
    s_cbranch_scc1 L_exit
    s_mov_b32 s37, 8
    v_mov_b32 v250, 1
    v_mov_b32 v251, 163832
    v_cmp_eq_u32 vcc, 0, v0
    s_nop 0
    s_and_saveexec_b64 s[38:39], vcc
    s_cbranch_execz tk11
    buffer_atomic_add v250, off, s[84:87], s37 sc0
    s_waitcnt vmcnt(0)
    ds_write_b32 v251, v250
    s_waitcnt lgkmcnt(0)
tk11:
    s_mov_b64 exec, -1
    s_barrier
    ds_read_b32 v252, v251
    s_waitcnt lgkmcnt(0)
    v_readfirstlane_b32 s20, v252
    s_barrier
    s_nop 3
    s_cmp_ge_u32 s20, 72
    s_cbranch_scc1 L_ssm_done
    s_lshl_b32 s20, s20, 3
    v_lshrrev_b32 v5, 6, v0
    s_nop 0
    v_readfirstlane_b32 s21, v5
    v_and_b32 v1, 63, v0
    v_and_b32 v2, 15, v1
    v_lshrrev_b32 v3, 4, v1
    v_lshlrev_b32 v4, 14, v5
    s_mov_b32 s8, s62
    s_mov_b32 s9, s63
    s_mov_b32 s10, 2359296
    s_mov_b32 s11, 0x20000
    s_mov_b32 s16, s76
    s_mov_b32 s17, s77
    s_mov_b32 s18, 4718592
    s_mov_b32 s19, 0x20000
    s_add_u32 s22, s20, s21
    s_lshl_b32 s23, s22, 8
    v_lshlrev_b32 v6, 3, v2
    v_lshl_add_u32 v6, v3, 1, v6
    s_mov_b32 s12, s64
    s_mov_b32 s13, s65
    s_mov_b32 s14, 147456
    s_mov_b32 s15, 0x20000
    buffer_load_ushort v8, v6, s[12:15], s23 offen offset:0
    buffer_load_ushort v12, v6, s[12:15], s23 offen offset:128
    buffer_load_ushort v16, v6, s[12:15], s23 offen offset:1024
    buffer_load_ushort v20, v6, s[12:15], s23 offen offset:1152
    s_mov_b32 s12, s66
    s_mov_b32 s13, s67
    s_mov_b32 s14, 147456
    s_mov_b32 s15, 0x20000
    buffer_load_ushort v9, v6, s[12:15], s23 offen offset:0
    buffer_load_ushort v13, v6, s[12:15], s23 offen offset:128
    buffer_load_ushort v17, v6, s[12:15], s23 offen offset:1024
    buffer_load_ushort v21, v6, s[12:15], s23 offen offset:1152
    s_mov_b32 s12, s68
    s_mov_b32 s13, s69
    s_mov_b32 s14, 147456
    s_mov_b32 s15, 0x20000
    buffer_load_ushort v10, v6, s[12:15], s23 offen offset:0
    buffer_load_ushort v14, v6, s[12:15], s23 offen offset:128
    buffer_load_ushort v18, v6, s[12:15], s23 offen offset:1024
    buffer_load_ushort v22, v6, s[12:15], s23 offen offset:1152
    s_mov_b32 s12, s70
    s_mov_b32 s13, s71
    s_mov_b32 s14, 147456
    s_mov_b32 s15, 0x20000
    buffer_load_ushort v11, v6, s[12:15], s23 offen offset:0
    buffer_load_ushort v15, v6, s[12:15], s23 offen offset:128
    buffer_load_ushort v19, v6, s[12:15], s23 offen offset:1024
    buffer_load_ushort v23, v6, s[12:15], s23 offen offset:1152
    s_mov_b32 s12, s72
    s_mov_b32 s13, s73
    s_mov_b32 s14, 1152
    s_mov_b32 s15, 0x20000
    s_lshl_b32 s23, s22, 1
    buffer_load_ushort v24, off, s[12:15], s23
    buffer_load_ushort v25, off, s[12:15], s23 offset:8
    v_mul_u32_u24 v5, 9216, v0
    s_lshl_b32 s22, s20, 1
    s_add_u32 s23, s22, 0
    buffer_load_dwordx4 v[208:211], v5, s[8:11], s23 offen
    s_add_u32 s23, s22, 1152
    buffer_load_dwordx4 v[212:215], v5, s[8:11], s23 offen
    s_add_u32 s23, s22, 2304
    buffer_load_dwordx4 v[216:219], v5, s[8:11], s23 offen
    s_add_u32 s23, s22, 3456
    buffer_load_dwordx4 v[220:223], v5, s[8:11], s23 offen
    s_add_u32 s23, s22, 4608
    buffer_load_dwordx4 v[224:227], v5, s[8:11], s23 offen
    s_add_u32 s23, s22, 5760
    buffer_load_dwordx4 v[228:231], v5, s[8:11], s23 offen
    s_add_u32 s23, s22, 6912
    buffer_load_dwordx4 v[232:235], v5, s[8:11], s23 offen
    s_add_u32 s23, s22, 8064
    buffer_load_dwordx4 v[236:239], v5, s[8:11], s23 offen
    s_mov_b32 s26, 0x3fb8aa3b
    s_mov_b32 s27, 0x3e22f983
    s_mov_b32 s28, 0
    v_cvt_f32_u32 v26, v2
    v_mul_f32 v27, 0x41800000, v26
    s_waitcnt vmcnt(8)
    s_nop 0
ss_pass:
    v_mov_b32 v36, 0
    v_mov_b32 v37, 0
    v_lshl_add_u32 v6, v1, 3, v4
    ds_write_b64 v6, v[36:37] offset:0
    v_lshlrev_b32 v38, 16, v24
    v_mul_f32 v38, s26, v38
    v_exp_f32 v38, v38
    s_nop 0
    v_cvt_pk_bf16_f32 v38, v38, v38
    v_and_b32 v38, 0xffff0000, v38
    v_add_f32 v39, v38, v38
    v_lshlrev_b32 v28, 16, v8
    v_mul_f32 v28, s26, v28
    v_exp_f32 v28, v28
    s_nop 0
    v_cvt_pk_bf16_f32 v28, v28, v28
    v_and_b32 v28, 0xffff0000, v28
    v_mul_f32 v28, v28, v38
    v_mul_f32 v28, s26, v28
    v_sub_f32 v28, 0, v28
    v_lshlrev_b32 v29, 16, v9
    v_mul_f32 v29, v29, v38
    v_mul_f32 v29, s27, v29
    v_lshlrev_b32 v30, 16, v10
    v_mul_f32 v30, v30, v39
    v_lshlrev_b32 v31, 16, v11
    v_mul_f32 v31, v31, v39
    v_lshlrev_b32 v32, 16, v12
    v_mul_f32 v32, s26, v32
    v_exp_f32 v32, v32
    s_nop 0
    v_cvt_pk_bf16_f32 v32, v32, v32
    v_and_b32 v32, 0xffff0000, v32
    v_mul_f32 v32, v32, v38
    v_mul_f32 v32, s26, v32
    v_sub_f32 v32, 0, v32
    v_lshlrev_b32 v33, 16, v13
    v_mul_f32 v33, v33, v38
    v_mul_f32 v33, s27, v33
    v_lshlrev_b32 v34, 16, v14
    v_mul_f32 v34, v34, v39
    v_lshlrev_b32 v35, 16, v15
    v_mul_f32 v35, v35, v39
    v_mov_b64 v[48:49], 0
    v_mov_b64 v[50:51], 0
    v_mov_b64 v[52:53], 0
    v_mov_b64 v[54:55], 0
    v_mov_b64 v[56:57], 0
    v_mov_b64 v[58:59], 0
    v_mov_b64 v[60:61], 0
    v_mov_b64 v[62:63], 0
    s_mov_b32 s25, 0
    s_nop 0
ss_kg:
    v_mov_b64_dpp v[64:65], v[28:29] row_newbcast:0 row_mask:0xf bank_mask:0xf
    v_mov_b64_dpp v[66:67], v[30:31] row_newbcast:0 row_mask:0xf bank_mask:0xf
    v_pk_mul_f32 v[94:95], v[64:65], v[26:27] op_sel_hi:[1,0]
    v_pk_mul_f32 v[96:97], v[64:65], v[26:27] op_sel:[0,1] op_sel_hi:[1,1]
    v_fract_f32 v95, v95
    v_fract_f32 v97, v97
    v_exp_f32 v94, v94
    v_exp_f32 v96, v96
    v_cos_f32 v68, v95
    v_sin_f32 v69, v95
    v_cos_f32 v76, v97
    v_sin_f32 v77, v97
    v_pk_mul_f32 v[68:69], v[68:69], v[94:95] op_sel_hi:[1,0]
    v_pk_mul_f32 v[76:77], v[76:77], v[96:97] op_sel_hi:[1,0]
    v_pk_mul_f32 v[92:93], v[76:77], v[76:77] op_sel:[1,1] op_sel_hi:[0,1]
    v_pk_fma_f32 v[78:79], v[76:77], v[76:77], v[92:93] op_sel:[0,0,0] op_sel_hi:[0,1,1] neg_lo:[0,0,1]
    v_pk_mul_f32 v[94:95], v[68:69], v[68:69] op_sel:[1,1] op_sel_hi:[0,1]
    v_pk_fma_f32 v[70:71], v[68:69], v[68:69], v[94:95] op_sel:[0,0,0] op_sel_hi:[0,1,1] neg_lo:[0,0,1]
    v_pk_mul_f32 v[92:93], v[78:79], v[78:79] op_sel:[1,1] op_sel_hi:[0,1]
    v_pk_fma_f32 v[80:81], v[78:79], v[78:79], v[92:93] op_sel:[0,0,0] op_sel_hi:[0,1,1] neg_lo:[0,0,1]
    v_pk_mul_f32 v[94:95], v[70:71], v[70:71] op_sel:[1,1] op_sel_hi:[0,1]
    v_pk_fma_f32 v[72:73], v[70:71], v[70:71], v[94:95] op_sel:[0,0,0] op_sel_hi:[0,1,1] neg_lo:[0,0,1]
    v_pk_mul_f32 v[92:93], v[80:81], v[80:81] op_sel:[1,1] op_sel_hi:[0,1]
    v_pk_fma_f32 v[82:83], v[80:81], v[80:81], v[92:93] op_sel:[0,0,0] op_sel_hi:[0,1,1] neg_lo:[0,0,1]
    v_pk_mul_f32 v[94:95], v[72:73], v[72:73] op_sel:[1,1] op_sel_hi:[0,1]
    v_pk_fma_f32 v[74:75], v[72:73], v[72:73], v[94:95] op_sel:[0,0,0] op_sel_hi:[0,1,1] neg_lo:[0,0,1]
    v_pk_mul_f32 v[92:93], v[82:83], v[82:83] op_sel:[1,1] op_sel_hi:[0,1]
    v_pk_fma_f32 v[84:85], v[82:83], v[82:83], v[92:93] op_sel:[0,0,0] op_sel_hi:[0,1,1] neg_lo:[0,0,1]
    v_pk_mul_f32 v[94:95], v[66:67], v[76:77] op_sel:[1,1] op_sel_hi:[1,0]
    v_pk_fma_f32 v[86:87], v[66:67], v[76:77], v[94:95] op_sel:[0,0,0] op_sel_hi:[0,1,1] neg_lo:[0,0,1] neg_hi:[1,0,1]
    v_mov_b32_dpp v80, v78 row_ror:8 row_mask:0xf bank_mask:0x3
    v_mov_b32_dpp v81, v79 row_ror:8 row_mask:0xf bank_mask:0x3
    v_mov_b32_dpp v82, v84 row_ror:8 row_mask:0xf bank_mask:0x3
    v_mov_b32_dpp v83, v85 row_ror:8 row_mask:0xf bank_mask:0x3
    v_pk_mul_f32 v[92:93], v[66:67], v[80:81] op_sel:[1,1] op_sel_hi:[1,0]
    v_pk_fma_f32 v[88:89], v[66:67], v[80:81], v[92:93] op_sel:[0,0,0] op_sel_hi:[0,1,1] neg_lo:[0,0,1] neg_hi:[1,0,1]
    v_pk_mul_f32 v[94:95], v[66:67], v[82:83] op_sel:[1,1] op_sel_hi:[1,0]
    v_pk_fma_f32 v[90:91], v[66:67], v[82:83], v[94:95] op_sel:[0,0,0] op_sel_hi:[0,1,1] neg_lo:[0,0,1] neg_hi:[1,0,1]
    v_mfma_f32_16x16x4_f32 v[48:51], v86, v68, v[48:51]
    v_mfma_f32_16x16x4_f32 v[52:55], v88, v70, v[52:55]
    v_mfma_f32_16x16x4_f32 v[56:59], v88, v72, v[56:59]
    v_mfma_f32_16x16x4_f32 v[60:63], v90, v74, v[60:63]
    v_mfma_f32_16x16x4_f32 v[48:51], v87, v69, v[48:51]
    v_mfma_f32_16x16x4_f32 v[52:55], v89, v71, v[52:55]
    v_mfma_f32_16x16x4_f32 v[56:59], v89, v73, v[56:59]
    v_mfma_f32_16x16x4_f32 v[60:63], v91, v75, v[60:63]
    v_mov_b64_dpp v[64:65], v[28:29] row_newbcast:1 row_mask:0xf bank_mask:0xf
    v_mov_b64_dpp v[66:67], v[30:31] row_newbcast:1 row_mask:0xf bank_mask:0xf
    v_pk_mul_f32 v[94:95], v[64:65], v[26:27] op_sel_hi:[1,0]
    v_pk_mul_f32 v[96:97], v[64:65], v[26:27] op_sel:[0,1] op_sel_hi:[1,1]
    v_fract_f32 v95, v95
    v_fract_f32 v97, v97
    v_exp_f32 v94, v94
    v_exp_f32 v96, v96
    v_cos_f32 v68, v95
    v_sin_f32 v69, v95
    v_cos_f32 v76, v97
    v_sin_f32 v77, v97
    v_pk_mul_f32 v[68:69], v[68:69], v[94:95] op_sel_hi:[1,0]
    v_pk_mul_f32 v[76:77], v[76:77], v[96:97] op_sel_hi:[1,0]
    v_pk_mul_f32 v[92:93], v[76:77], v[76:77] op_sel:[1,1] op_sel_hi:[0,1]
    v_pk_fma_f32 v[78:79], v[76:77], v[76:77], v[92:93] op_sel:[0,0,0] op_sel_hi:[0,1,1] neg_lo:[0,0,1]
    v_pk_mul_f32 v[94:95], v[68:69], v[68:69] op_sel:[1,1] op_sel_hi:[0,1]
    v_pk_fma_f32 v[70:71], v[68:69], v[68:69], v[94:95] op_sel:[0,0,0] op_sel_hi:[0,1,1] neg_lo:[0,0,1]
    v_pk_mul_f32 v[92:93], v[78:79], v[78:79] op_sel:[1,1] op_sel_hi:[0,1]
    v_pk_fma_f32 v[80:81], v[78:79], v[78:79], v[92:93] op_sel:[0,0,0] op_sel_hi:[0,1,1] neg_lo:[0,0,1]
    v_pk_mul_f32 v[94:95], v[70:71], v[70:71] op_sel:[1,1] op_sel_hi:[0,1]
    v_pk_fma_f32 v[72:73], v[70:71], v[70:71], v[94:95] op_sel:[0,0,0] op_sel_hi:[0,1,1] neg_lo:[0,0,1]
    v_pk_mul_f32 v[92:93], v[80:81], v[80:81] op_sel:[1,1] op_sel_hi:[0,1]
    v_pk_fma_f32 v[82:83], v[80:81], v[80:81], v[92:93] op_sel:[0,0,0] op_sel_hi:[0,1,1] neg_lo:[0,0,1]
    v_pk_mul_f32 v[94:95], v[72:73], v[72:73] op_sel:[1,1] op_sel_hi:[0,1]
    v_pk_fma_f32 v[74:75], v[72:73], v[72:73], v[94:95] op_sel:[0,0,0] op_sel_hi:[0,1,1] neg_lo:[0,0,1]
    v_pk_mul_f32 v[92:93], v[82:83], v[82:83] op_sel:[1,1] op_sel_hi:[0,1]
    v_pk_fma_f32 v[84:85], v[82:83], v[82:83], v[92:93] op_sel:[0,0,0] op_sel_hi:[0,1,1] neg_lo:[0,0,1]
    v_pk_mul_f32 v[94:95], v[66:67], v[76:77] op_sel:[1,1] op_sel_hi:[1,0]
    v_pk_fma_f32 v[86:87], v[66:67], v[76:77], v[94:95] op_sel:[0,0,0] op_sel_hi:[0,1,1] neg_lo:[0,0,1] neg_hi:[1,0,1]
    v_mov_b32_dpp v80, v78 row_ror:8 row_mask:0xf bank_mask:0x3
    v_mov_b32_dpp v81, v79 row_ror:8 row_mask:0xf bank_mask:0x3
    v_mov_b32_dpp v82, v84 row_ror:8 row_mask:0xf bank_mask:0x3
    v_mov_b32_dpp v83, v85 row_ror:8 row_mask:0xf bank_mask:0x3
    v_pk_mul_f32 v[92:93], v[66:67], v[80:81] op_sel:[1,1] op_sel_hi:[1,0]
    v_pk_fma_f32 v[88:89], v[66:67], v[80:81], v[92:93] op_sel:[0,0,0] op_sel_hi:[0,1,1] neg_lo:[0,0,1] neg_hi:[1,0,1]
    v_pk_mul_f32 v[94:95], v[66:67], v[82:83] op_sel:[1,1] op_sel_hi:[1,0]
    v_pk_fma_f32 v[90:91], v[66:67], v[82:83], v[94:95] op_sel:[0,0,0] op_sel_hi:[0,1,1] neg_lo:[0,0,1] neg_hi:[1,0,1]
    v_mfma_f32_16x16x4_f32 v[48:51], v86, v68, v[48:51]
    v_mfma_f32_16x16x4_f32 v[52:55], v88, v70, v[52:55]
    v_mfma_f32_16x16x4_f32 v[56:59], v88, v72, v[56:59]
    v_mfma_f32_16x16x4_f32 v[60:63], v90, v74, v[60:63]
    v_mfma_f32_16x16x4_f32 v[48:51], v87, v69, v[48:51]
    v_mfma_f32_16x16x4_f32 v[52:55], v89, v71, v[52:55]
    v_mfma_f32_16x16x4_f32 v[56:59], v89, v73, v[56:59]
    v_mfma_f32_16x16x4_f32 v[60:63], v91, v75, v[60:63]
    v_mov_b64_dpp v[64:65], v[28:29] row_newbcast:2 row_mask:0xf bank_mask:0xf
    v_mov_b64_dpp v[66:67], v[30:31] row_newbcast:2 row_mask:0xf bank_mask:0xf
    v_pk_mul_f32 v[94:95], v[64:65], v[26:27] op_sel_hi:[1,0]
    v_pk_mul_f32 v[96:97], v[64:65], v[26:27] op_sel:[0,1] op_sel_hi:[1,1]
    v_fract_f32 v95, v95
    v_fract_f32 v97, v97
    v_exp_f32 v94, v94
    v_exp_f32 v96, v96
    v_cos_f32 v68, v95
    v_sin_f32 v69, v95
    v_cos_f32 v76, v97
    v_sin_f32 v77, v97
    v_pk_mul_f32 v[68:69], v[68:69], v[94:95] op_sel_hi:[1,0]
    v_pk_mul_f32 v[76:77], v[76:77], v[96:97] op_sel_hi:[1,0]
    v_pk_mul_f32 v[92:93], v[76:77], v[76:77] op_sel:[1,1] op_sel_hi:[0,1]
    v_pk_fma_f32 v[78:79], v[76:77], v[76:77], v[92:93] op_sel:[0,0,0] op_sel_hi:[0,1,1] neg_lo:[0,0,1]
    v_pk_mul_f32 v[94:95], v[68:69], v[68:69] op_sel:[1,1] op_sel_hi:[0,1]
    v_pk_fma_f32 v[70:71], v[68:69], v[68:69], v[94:95] op_sel:[0,0,0] op_sel_hi:[0,1,1] neg_lo:[0,0,1]
    v_pk_mul_f32 v[92:93], v[78:79], v[78:79] op_sel:[1,1] op_sel_hi:[0,1]
    v_pk_fma_f32 v[80:81], v[78:79], v[78:79], v[92:93] op_sel:[0,0,0] op_sel_hi:[0,1,1] neg_lo:[0,0,1]
    v_pk_mul_f32 v[94:95], v[70:71], v[70:71] op_sel:[1,1] op_sel_hi:[0,1]
    v_pk_fma_f32 v[72:73], v[70:71], v[70:71], v[94:95] op_sel:[0,0,0] op_sel_hi:[0,1,1] neg_lo:[0,0,1]
    v_pk_mul_f32 v[92:93], v[80:81], v[80:81] op_sel:[1,1] op_sel_hi:[0,1]
    v_pk_fma_f32 v[82:83], v[80:81], v[80:81], v[92:93] op_sel:[0,0,0] op_sel_hi:[0,1,1] neg_lo:[0,0,1]
    v_pk_mul_f32 v[94:95], v[72:73], v[72:73] op_sel:[1,1] op_sel_hi:[0,1]
    v_pk_fma_f32 v[74:75], v[72:73], v[72:73], v[94:95] op_sel:[0,0,0] op_sel_hi:[0,1,1] neg_lo:[0,0,1]
    v_pk_mul_f32 v[92:93], v[82:83], v[82:83] op_sel:[1,1] op_sel_hi:[0,1]
    v_pk_fma_f32 v[84:85], v[82:83], v[82:83], v[92:93] op_sel:[0,0,0] op_sel_hi:[0,1,1] neg_lo:[0,0,1]
    v_pk_mul_f32 v[94:95], v[66:67], v[76:77] op_sel:[1,1] op_sel_hi:[1,0]
    v_pk_fma_f32 v[86:87], v[66:67], v[76:77], v[94:95] op_sel:[0,0,0] op_sel_hi:[0,1,1] neg_lo:[0,0,1] neg_hi:[1,0,1]
    v_mov_b32_dpp v80, v78 row_ror:8 row_mask:0xf bank_mask:0x3
    v_mov_b32_dpp v81, v79 row_ror:8 row_mask:0xf bank_mask:0x3
    v_mov_b32_dpp v82, v84 row_ror:8 row_mask:0xf bank_mask:0x3
    v_mov_b32_dpp v83, v85 row_ror:8 row_mask:0xf bank_mask:0x3
    v_pk_mul_f32 v[92:93], v[66:67], v[80:81] op_sel:[1,1] op_sel_hi:[1,0]
    v_pk_fma_f32 v[88:89], v[66:67], v[80:81], v[92:93] op_sel:[0,0,0] op_sel_hi:[0,1,1] neg_lo:[0,0,1] neg_hi:[1,0,1]
    v_pk_mul_f32 v[94:95], v[66:67], v[82:83] op_sel:[1,1] op_sel_hi:[1,0]
    v_pk_fma_f32 v[90:91], v[66:67], v[82:83], v[94:95] op_sel:[0,0,0] op_sel_hi:[0,1,1] neg_lo:[0,0,1] neg_hi:[1,0,1]
    v_mfma_f32_16x16x4_f32 v[48:51], v86, v68, v[48:51]
    v_mfma_f32_16x16x4_f32 v[52:55], v88, v70, v[52:55]
    v_mfma_f32_16x16x4_f32 v[56:59], v88, v72, v[56:59]
    v_mfma_f32_16x16x4_f32 v[60:63], v90, v74, v[60:63]
    v_mfma_f32_16x16x4_f32 v[48:51], v87, v69, v[48:51]
    v_mfma_f32_16x16x4_f32 v[52:55], v89, v71, v[52:55]
    v_mfma_f32_16x16x4_f32 v[56:59], v89, v73, v[56:59]
    v_mfma_f32_16x16x4_f32 v[60:63], v91, v75, v[60:63]
    v_mov_b64_dpp v[64:65], v[28:29] row_newbcast:3 row_mask:0xf bank_mask:0xf
    v_mov_b64_dpp v[66:67], v[30:31] row_newbcast:3 row_mask:0xf bank_mask:0xf
    v_pk_mul_f32 v[94:95], v[64:65], v[26:27] op_sel_hi:[1,0]
    v_pk_mul_f32 v[96:97], v[64:65], v[26:27] op_sel:[0,1] op_sel_hi:[1,1]
    v_fract_f32 v95, v95
    v_fract_f32 v97, v97
    v_exp_f32 v94, v94
    v_exp_f32 v96, v96
    v_cos_f32 v68, v95
    v_sin_f32 v69, v95
    v_cos_f32 v76, v97
    v_sin_f32 v77, v97
    v_pk_mul_f32 v[68:69], v[68:69], v[94:95] op_sel_hi:[1,0]
    v_pk_mul_f32 v[76:77], v[76:77], v[96:97] op_sel_hi:[1,0]
    v_pk_mul_f32 v[92:93], v[76:77], v[76:77] op_sel:[1,1] op_sel_hi:[0,1]
    v_pk_fma_f32 v[78:79], v[76:77], v[76:77], v[92:93] op_sel:[0,0,0] op_sel_hi:[0,1,1] neg_lo:[0,0,1]
    v_pk_mul_f32 v[94:95], v[68:69], v[68:69] op_sel:[1,1] op_sel_hi:[0,1]
    v_pk_fma_f32 v[70:71], v[68:69], v[68:69], v[94:95] op_sel:[0,0,0] op_sel_hi:[0,1,1] neg_lo:[0,0,1]
    v_pk_mul_f32 v[92:93], v[78:79], v[78:79] op_sel:[1,1] op_sel_hi:[0,1]
    v_pk_fma_f32 v[80:81], v[78:79], v[78:79], v[92:93] op_sel:[0,0,0] op_sel_hi:[0,1,1] neg_lo:[0,0,1]
    v_pk_mul_f32 v[94:95], v[70:71], v[70:71] op_sel:[1,1] op_sel_hi:[0,1]
    v_pk_fma_f32 v[72:73], v[70:71], v[70:71], v[94:95] op_sel:[0,0,0] op_sel_hi:[0,1,1] neg_lo:[0,0,1]
    v_pk_mul_f32 v[92:93], v[80:81], v[80:81] op_sel:[1,1] op_sel_hi:[0,1]
    v_pk_fma_f32 v[82:83], v[80:81], v[80:81], v[92:93] op_sel:[0,0,0] op_sel_hi:[0,1,1] neg_lo:[0,0,1]
    v_pk_mul_f32 v[94:95], v[72:73], v[72:73] op_sel:[1,1] op_sel_hi:[0,1]
    v_pk_fma_f32 v[74:75], v[72:73], v[72:73], v[94:95] op_sel:[0,0,0] op_sel_hi:[0,1,1] neg_lo:[0,0,1]
    v_pk_mul_f32 v[92:93], v[82:83], v[82:83] op_sel:[1,1] op_sel_hi:[0,1]
    v_pk_fma_f32 v[84:85], v[82:83], v[82:83], v[92:93] op_sel:[0,0,0] op_sel_hi:[0,1,1] neg_lo:[0,0,1]
    v_pk_mul_f32 v[94:95], v[66:67], v[76:77] op_sel:[1,1] op_sel_hi:[1,0]
    v_pk_fma_f32 v[86:87], v[66:67], v[76:77], v[94:95] op_sel:[0,0,0] op_sel_hi:[0,1,1] neg_lo:[0,0,1] neg_hi:[1,0,1]
    v_mov_b32_dpp v80, v78 row_ror:8 row_mask:0xf bank_mask:0x3
    v_mov_b32_dpp v81, v79 row_ror:8 row_mask:0xf bank_mask:0x3
    v_mov_b32_dpp v82, v84 row_ror:8 row_mask:0xf bank_mask:0x3
    v_mov_b32_dpp v83, v85 row_ror:8 row_mask:0xf bank_mask:0x3
    v_pk_mul_f32 v[92:93], v[66:67], v[80:81] op_sel:[1,1] op_sel_hi:[1,0]
    v_pk_fma_f32 v[88:89], v[66:67], v[80:81], v[92:93] op_sel:[0,0,0] op_sel_hi:[0,1,1] neg_lo:[0,0,1] neg_hi:[1,0,1]
    v_pk_mul_f32 v[94:95], v[66:67], v[82:83] op_sel:[1,1] op_sel_hi:[1,0]
    v_pk_fma_f32 v[90:91], v[66:67], v[82:83], v[94:95] op_sel:[0,0,0] op_sel_hi:[0,1,1] neg_lo:[0,0,1] neg_hi:[1,0,1]
    v_mfma_f32_16x16x4_f32 v[48:51], v86, v68, v[48:51]
    v_mfma_f32_16x16x4_f32 v[52:55], v88, v70, v[52:55]
    v_mfma_f32_16x16x4_f32 v[56:59], v88, v72, v[56:59]
    v_mfma_f32_16x16x4_f32 v[60:63], v90, v74, v[60:63]
    v_mfma_f32_16x16x4_f32 v[48:51], v87, v69, v[48:51]
    v_mfma_f32_16x16x4_f32 v[52:55], v89, v71, v[52:55]
    v_mfma_f32_16x16x4_f32 v[56:59], v89, v73, v[56:59]
    v_mfma_f32_16x16x4_f32 v[60:63], v91, v75, v[60:63]
    v_mov_b64_dpp v[64:65], v[28:29] row_newbcast:4 row_mask:0xf bank_mask:0xf
    v_mov_b64_dpp v[66:67], v[30:31] row_newbcast:4 row_mask:0xf bank_mask:0xf
    v_pk_mul_f32 v[94:95], v[64:65], v[26:27] op_sel_hi:[1,0]
    v_pk_mul_f32 v[96:97], v[64:65], v[26:27] op_sel:[0,1] op_sel_hi:[1,1]
    v_fract_f32 v95, v95
    v_fract_f32 v97, v97
    v_exp_f32 v94, v94
    v_exp_f32 v96, v96
    v_cos_f32 v68, v95
    v_sin_f32 v69, v95
    v_cos_f32 v76, v97
    v_sin_f32 v77, v97
    v_pk_mul_f32 v[68:69], v[68:69], v[94:95] op_sel_hi:[1,0]
    v_pk_mul_f32 v[76:77], v[76:77], v[96:97] op_sel_hi:[1,0]
    v_pk_mul_f32 v[92:93], v[76:77], v[76:77] op_sel:[1,1] op_sel_hi:[0,1]
    v_pk_fma_f32 v[78:79], v[76:77], v[76:77], v[92:93] op_sel:[0,0,0] op_sel_hi:[0,1,1] neg_lo:[0,0,1]
    v_pk_mul_f32 v[94:95], v[68:69], v[68:69] op_sel:[1,1] op_sel_hi:[0,1]
    v_pk_fma_f32 v[70:71], v[68:69], v[68:69], v[94:95] op_sel:[0,0,0] op_sel_hi:[0,1,1] neg_lo:[0,0,1]
    v_pk_mul_f32 v[92:93], v[78:79], v[78:79] op_sel:[1,1] op_sel_hi:[0,1]
    v_pk_fma_f32 v[80:81], v[78:79], v[78:79], v[92:93] op_sel:[0,0,0] op_sel_hi:[0,1,1] neg_lo:[0,0,1]
    v_pk_mul_f32 v[94:95], v[70:71], v[70:71] op_sel:[1,1] op_sel_hi:[0,1]
    v_pk_fma_f32 v[72:73], v[70:71], v[70:71], v[94:95] op_sel:[0,0,0] op_sel_hi:[0,1,1] neg_lo:[0,0,1]
    v_pk_mul_f32 v[92:93], v[80:81], v[80:81] op_sel:[1,1] op_sel_hi:[0,1]
    v_pk_fma_f32 v[82:83], v[80:81], v[80:81], v[92:93] op_sel:[0,0,0] op_sel_hi:[0,1,1] neg_lo:[0,0,1]
    v_pk_mul_f32 v[94:95], v[72:73], v[72:73] op_sel:[1,1] op_sel_hi:[0,1]
    v_pk_fma_f32 v[74:75], v[72:73], v[72:73], v[94:95] op_sel:[0,0,0] op_sel_hi:[0,1,1] neg_lo:[0,0,1]
    v_pk_mul_f32 v[92:93], v[82:83], v[82:83] op_sel:[1,1] op_sel_hi:[0,1]
    v_pk_fma_f32 v[84:85], v[82:83], v[82:83], v[92:93] op_sel:[0,0,0] op_sel_hi:[0,1,1] neg_lo:[0,0,1]
    v_pk_mul_f32 v[94:95], v[66:67], v[76:77] op_sel:[1,1] op_sel_hi:[1,0]
    v_pk_fma_f32 v[86:87], v[66:67], v[76:77], v[94:95] op_sel:[0,0,0] op_sel_hi:[0,1,1] neg_lo:[0,0,1] neg_hi:[1,0,1]
    v_mov_b32_dpp v80, v78 row_ror:8 row_mask:0xf bank_mask:0x3
    v_mov_b32_dpp v81, v79 row_ror:8 row_mask:0xf bank_mask:0x3
    v_mov_b32_dpp v82, v84 row_ror:8 row_mask:0xf bank_mask:0x3
    v_mov_b32_dpp v83, v85 row_ror:8 row_mask:0xf bank_mask:0x3
    v_pk_mul_f32 v[92:93], v[66:67], v[80:81] op_sel:[1,1] op_sel_hi:[1,0]
    v_pk_fma_f32 v[88:89], v[66:67], v[80:81], v[92:93] op_sel:[0,0,0] op_sel_hi:[0,1,1] neg_lo:[0,0,1] neg_hi:[1,0,1]
    v_pk_mul_f32 v[94:95], v[66:67], v[82:83] op_sel:[1,1] op_sel_hi:[1,0]
    v_pk_fma_f32 v[90:91], v[66:67], v[82:83], v[94:95] op_sel:[0,0,0] op_sel_hi:[0,1,1] neg_lo:[0,0,1] neg_hi:[1,0,1]
    v_mfma_f32_16x16x4_f32 v[48:51], v86, v68, v[48:51]
    v_mfma_f32_16x16x4_f32 v[52:55], v88, v70, v[52:55]
    v_mfma_f32_16x16x4_f32 v[56:59], v88, v72, v[56:59]
    v_mfma_f32_16x16x4_f32 v[60:63], v90, v74, v[60:63]
    v_mfma_f32_16x16x4_f32 v[48:51], v87, v69, v[48:51]
    v_mfma_f32_16x16x4_f32 v[52:55], v89, v71, v[52:55]
    v_mfma_f32_16x16x4_f32 v[56:59], v89, v73, v[56:59]
    v_mfma_f32_16x16x4_f32 v[60:63], v91, v75, v[60:63]
    v_mov_b64_dpp v[64:65], v[28:29] row_newbcast:5 row_mask:0xf bank_mask:0xf
    v_mov_b64_dpp v[66:67], v[30:31] row_newbcast:5 row_mask:0xf bank_mask:0xf
    v_pk_mul_f32 v[94:95], v[64:65], v[26:27] op_sel_hi:[1,0]
    v_pk_mul_f32 v[96:97], v[64:65], v[26:27] op_sel:[0,1] op_sel_hi:[1,1]
    v_fract_f32 v95, v95
    v_fract_f32 v97, v97
    v_exp_f32 v94, v94
    v_exp_f32 v96, v96
    v_cos_f32 v68, v95
    v_sin_f32 v69, v95
    v_cos_f32 v76, v97
    v_sin_f32 v77, v97
    v_pk_mul_f32 v[68:69], v[68:69], v[94:95] op_sel_hi:[1,0]
    v_pk_mul_f32 v[76:77], v[76:77], v[96:97] op_sel_hi:[1,0]
    v_pk_mul_f32 v[92:93], v[76:77], v[76:77] op_sel:[1,1] op_sel_hi:[0,1]
    v_pk_fma_f32 v[78:79], v[76:77], v[76:77], v[92:93] op_sel:[0,0,0] op_sel_hi:[0,1,1] neg_lo:[0,0,1]
    v_pk_mul_f32 v[94:95], v[68:69], v[68:69] op_sel:[1,1] op_sel_hi:[0,1]
    v_pk_fma_f32 v[70:71], v[68:69], v[68:69], v[94:95] op_sel:[0,0,0] op_sel_hi:[0,1,1] neg_lo:[0,0,1]
    v_pk_mul_f32 v[92:93], v[78:79], v[78:79] op_sel:[1,1] op_sel_hi:[0,1]
    v_pk_fma_f32 v[80:81], v[78:79], v[78:79], v[92:93] op_sel:[0,0,0] op_sel_hi:[0,1,1] neg_lo:[0,0,1]
    v_pk_mul_f32 v[94:95], v[70:71], v[70:71] op_sel:[1,1] op_sel_hi:[0,1]
    v_pk_fma_f32 v[72:73], v[70:71], v[70:71], v[94:95] op_sel:[0,0,0] op_sel_hi:[0,1,1] neg_lo:[0,0,1]
    v_pk_mul_f32 v[92:93], v[80:81], v[80:81] op_sel:[1,1] op_sel_hi:[0,1]
    v_pk_fma_f32 v[82:83], v[80:81], v[80:81], v[92:93] op_sel:[0,0,0] op_sel_hi:[0,1,1] neg_lo:[0,0,1]
    v_pk_mul_f32 v[94:95], v[72:73], v[72:73] op_sel:[1,1] op_sel_hi:[0,1]
    v_pk_fma_f32 v[74:75], v[72:73], v[72:73], v[94:95] op_sel:[0,0,0] op_sel_hi:[0,1,1] neg_lo:[0,0,1]
    v_pk_mul_f32 v[92:93], v[82:83], v[82:83] op_sel:[1,1] op_sel_hi:[0,1]
    v_pk_fma_f32 v[84:85], v[82:83], v[82:83], v[92:93] op_sel:[0,0,0] op_sel_hi:[0,1,1] neg_lo:[0,0,1]
    v_pk_mul_f32 v[94:95], v[66:67], v[76:77] op_sel:[1,1] op_sel_hi:[1,0]
    v_pk_fma_f32 v[86:87], v[66:67], v[76:77], v[94:95] op_sel:[0,0,0] op_sel_hi:[0,1,1] neg_lo:[0,0,1] neg_hi:[1,0,1]
    v_mov_b32_dpp v80, v78 row_ror:8 row_mask:0xf bank_mask:0x3
    v_mov_b32_dpp v81, v79 row_ror:8 row_mask:0xf bank_mask:0x3
    v_mov_b32_dpp v82, v84 row_ror:8 row_mask:0xf bank_mask:0x3
    v_mov_b32_dpp v83, v85 row_ror:8 row_mask:0xf bank_mask:0x3
    v_pk_mul_f32 v[92:93], v[66:67], v[80:81] op_sel:[1,1] op_sel_hi:[1,0]
    v_pk_fma_f32 v[88:89], v[66:67], v[80:81], v[92:93] op_sel:[0,0,0] op_sel_hi:[0,1,1] neg_lo:[0,0,1] neg_hi:[1,0,1]
    v_pk_mul_f32 v[94:95], v[66:67], v[82:83] op_sel:[1,1] op_sel_hi:[1,0]
    v_pk_fma_f32 v[90:91], v[66:67], v[82:83], v[94:95] op_sel:[0,0,0] op_sel_hi:[0,1,1] neg_lo:[0,0,1] neg_hi:[1,0,1]
    v_mfma_f32_16x16x4_f32 v[48:51], v86, v68, v[48:51]
    v_mfma_f32_16x16x4_f32 v[52:55], v88, v70, v[52:55]
    v_mfma_f32_16x16x4_f32 v[56:59], v88, v72, v[56:59]
    v_mfma_f32_16x16x4_f32 v[60:63], v90, v74, v[60:63]
    v_mfma_f32_16x16x4_f32 v[48:51], v87, v69, v[48:51]
    v_mfma_f32_16x16x4_f32 v[52:55], v89, v71, v[52:55]
    v_mfma_f32_16x16x4_f32 v[56:59], v89, v73, v[56:59]
    v_mfma_f32_16x16x4_f32 v[60:63], v91, v75, v[60:63]
    v_mov_b64_dpp v[64:65], v[28:29] row_newbcast:6 row_mask:0xf bank_mask:0xf
    v_mov_b64_dpp v[66:67], v[30:31] row_newbcast:6 row_mask:0xf bank_mask:0xf
    v_pk_mul_f32 v[94:95], v[64:65], v[26:27] op_sel_hi:[1,0]
    v_pk_mul_f32 v[96:97], v[64:65], v[26:27] op_sel:[0,1] op_sel_hi:[1,1]
    v_fract_f32 v95, v95
    v_fract_f32 v97, v97
    v_exp_f32 v94, v94
    v_exp_f32 v96, v96
    v_cos_f32 v68, v95
    v_sin_f32 v69, v95
    v_cos_f32 v76, v97
    v_sin_f32 v77, v97
    v_pk_mul_f32 v[68:69], v[68:69], v[94:95] op_sel_hi:[1,0]
    v_pk_mul_f32 v[76:77], v[76:77], v[96:97] op_sel_hi:[1,0]
    v_pk_mul_f32 v[92:93], v[76:77], v[76:77] op_sel:[1,1] op_sel_hi:[0,1]
    v_pk_fma_f32 v[78:79], v[76:77], v[76:77], v[92:93] op_sel:[0,0,0] op_sel_hi:[0,1,1] neg_lo:[0,0,1]
    v_pk_mul_f32 v[94:95], v[68:69], v[68:69] op_sel:[1,1] op_sel_hi:[0,1]
    v_pk_fma_f32 v[70:71], v[68:69], v[68:69], v[94:95] op_sel:[0,0,0] op_sel_hi:[0,1,1] neg_lo:[0,0,1]
    v_pk_mul_f32 v[92:93], v[78:79], v[78:79] op_sel:[1,1] op_sel_hi:[0,1]
    v_pk_fma_f32 v[80:81], v[78:79], v[78:79], v[92:93] op_sel:[0,0,0] op_sel_hi:[0,1,1] neg_lo:[0,0,1]
    v_pk_mul_f32 v[94:95], v[70:71], v[70:71] op_sel:[1,1] op_sel_hi:[0,1]
    v_pk_fma_f32 v[72:73], v[70:71], v[70:71], v[94:95] op_sel:[0,0,0] op_sel_hi:[0,1,1] neg_lo:[0,0,1]
    v_pk_mul_f32 v[92:93], v[80:81], v[80:81] op_sel:[1,1] op_sel_hi:[0,1]
    v_pk_fma_f32 v[82:83], v[80:81], v[80:81], v[92:93] op_sel:[0,0,0] op_sel_hi:[0,1,1] neg_lo:[0,0,1]
    v_pk_mul_f32 v[94:95], v[72:73], v[72:73] op_sel:[1,1] op_sel_hi:[0,1]
    v_pk_fma_f32 v[74:75], v[72:73], v[72:73], v[94:95] op_sel:[0,0,0] op_sel_hi:[0,1,1] neg_lo:[0,0,1]
    v_pk_mul_f32 v[92:93], v[82:83], v[82:83] op_sel:[1,1] op_sel_hi:[0,1]
    v_pk_fma_f32 v[84:85], v[82:83], v[82:83], v[92:93] op_sel:[0,0,0] op_sel_hi:[0,1,1] neg_lo:[0,0,1]
    v_pk_mul_f32 v[94:95], v[66:67], v[76:77] op_sel:[1,1] op_sel_hi:[1,0]
    v_pk_fma_f32 v[86:87], v[66:67], v[76:77], v[94:95] op_sel:[0,0,0] op_sel_hi:[0,1,1] neg_lo:[0,0,1] neg_hi:[1,0,1]
    v_mov_b32_dpp v80, v78 row_ror:8 row_mask:0xf bank_mask:0x3
    v_mov_b32_dpp v81, v79 row_ror:8 row_mask:0xf bank_mask:0x3
    v_mov_b32_dpp v82, v84 row_ror:8 row_mask:0xf bank_mask:0x3
    v_mov_b32_dpp v83, v85 row_ror:8 row_mask:0xf bank_mask:0x3
    v_pk_mul_f32 v[92:93], v[66:67], v[80:81] op_sel:[1,1] op_sel_hi:[1,0]
    v_pk_fma_f32 v[88:89], v[66:67], v[80:81], v[92:93] op_sel:[0,0,0] op_sel_hi:[0,1,1] neg_lo:[0,0,1] neg_hi:[1,0,1]
    v_pk_mul_f32 v[94:95], v[66:67], v[82:83] op_sel:[1,1] op_sel_hi:[1,0]
    v_pk_fma_f32 v[90:91], v[66:67], v[82:83], v[94:95] op_sel:[0,0,0] op_sel_hi:[0,1,1] neg_lo:[0,0,1] neg_hi:[1,0,1]
    v_mfma_f32_16x16x4_f32 v[48:51], v86, v68, v[48:51]
    v_mfma_f32_16x16x4_f32 v[52:55], v88, v70, v[52:55]
    v_mfma_f32_16x16x4_f32 v[56:59], v88, v72, v[56:59]
    v_mfma_f32_16x16x4_f32 v[60:63], v90, v74, v[60:63]
    v_mfma_f32_16x16x4_f32 v[48:51], v87, v69, v[48:51]
    v_mfma_f32_16x16x4_f32 v[52:55], v89, v71, v[52:55]
    v_mfma_f32_16x16x4_f32 v[56:59], v89, v73, v[56:59]
    v_mfma_f32_16x16x4_f32 v[60:63], v91, v75, v[60:63]
    v_mov_b64_dpp v[64:65], v[28:29] row_newbcast:7 row_mask:0xf bank_mask:0xf
    v_mov_b64_dpp v[66:67], v[30:31] row_newbcast:7 row_mask:0xf bank_mask:0xf
    v_pk_mul_f32 v[94:95], v[64:65], v[26:27] op_sel_hi:[1,0]
    v_pk_mul_f32 v[96:97], v[64:65], v[26:27] op_sel:[0,1] op_sel_hi:[1,1]
    v_fract_f32 v95, v95
    v_fract_f32 v97, v97
    v_exp_f32 v94, v94
    v_exp_f32 v96, v96
    v_cos_f32 v68, v95
    v_sin_f32 v69, v95
    v_cos_f32 v76, v97
    v_sin_f32 v77, v97
    v_pk_mul_f32 v[68:69], v[68:69], v[94:95] op_sel_hi:[1,0]
    v_pk_mul_f32 v[76:77], v[76:77], v[96:97] op_sel_hi:[1,0]
    v_pk_mul_f32 v[92:93], v[76:77], v[76:77] op_sel:[1,1] op_sel_hi:[0,1]
    v_pk_fma_f32 v[78:79], v[76:77], v[76:77], v[92:93] op_sel:[0,0,0] op_sel_hi:[0,1,1] neg_lo:[0,0,1]
    v_pk_mul_f32 v[94:95], v[68:69], v[68:69] op_sel:[1,1] op_sel_hi:[0,1]
    v_pk_fma_f32 v[70:71], v[68:69], v[68:69], v[94:95] op_sel:[0,0,0] op_sel_hi:[0,1,1] neg_lo:[0,0,1]
    v_pk_mul_f32 v[92:93], v[78:79], v[78:79] op_sel:[1,1] op_sel_hi:[0,1]
    v_pk_fma_f32 v[80:81], v[78:79], v[78:79], v[92:93] op_sel:[0,0,0] op_sel_hi:[0,1,1] neg_lo:[0,0,1]
    v_pk_mul_f32 v[94:95], v[70:71], v[70:71] op_sel:[1,1] op_sel_hi:[0,1]
    v_pk_fma_f32 v[72:73], v[70:71], v[70:71], v[94:95] op_sel:[0,0,0] op_sel_hi:[0,1,1] neg_lo:[0,0,1]
    v_pk_mul_f32 v[92:93], v[80:81], v[80:81] op_sel:[1,1] op_sel_hi:[0,1]
    v_pk_fma_f32 v[82:83], v[80:81], v[80:81], v[92:93] op_sel:[0,0,0] op_sel_hi:[0,1,1] neg_lo:[0,0,1]
    v_pk_mul_f32 v[94:95], v[72:73], v[72:73] op_sel:[1,1] op_sel_hi:[0,1]
    v_pk_fma_f32 v[74:75], v[72:73], v[72:73], v[94:95] op_sel:[0,0,0] op_sel_hi:[0,1,1] neg_lo:[0,0,1]
    v_pk_mul_f32 v[92:93], v[82:83], v[82:83] op_sel:[1,1] op_sel_hi:[0,1]
    v_pk_fma_f32 v[84:85], v[82:83], v[82:83], v[92:93] op_sel:[0,0,0] op_sel_hi:[0,1,1] neg_lo:[0,0,1]
    v_pk_mul_f32 v[94:95], v[66:67], v[76:77] op_sel:[1,1] op_sel_hi:[1,0]
    v_pk_fma_f32 v[86:87], v[66:67], v[76:77], v[94:95] op_sel:[0,0,0] op_sel_hi:[0,1,1] neg_lo:[0,0,1] neg_hi:[1,0,1]
    v_mov_b32_dpp v80, v78 row_ror:8 row_mask:0xf bank_mask:0x3
    v_mov_b32_dpp v81, v79 row_ror:8 row_mask:0xf bank_mask:0x3
    v_mov_b32_dpp v82, v84 row_ror:8 row_mask:0xf bank_mask:0x3
    v_mov_b32_dpp v83, v85 row_ror:8 row_mask:0xf bank_mask:0x3
    v_pk_mul_f32 v[92:93], v[66:67], v[80:81] op_sel:[1,1] op_sel_hi:[1,0]
    v_pk_fma_f32 v[88:89], v[66:67], v[80:81], v[92:93] op_sel:[0,0,0] op_sel_hi:[0,1,1] neg_lo:[0,0,1] neg_hi:[1,0,1]
    v_pk_mul_f32 v[94:95], v[66:67], v[82:83] op_sel:[1,1] op_sel_hi:[1,0]
    v_pk_fma_f32 v[90:91], v[66:67], v[82:83], v[94:95] op_sel:[0,0,0] op_sel_hi:[0,1,1] neg_lo:[0,0,1] neg_hi:[1,0,1]
    v_mfma_f32_16x16x4_f32 v[48:51], v86, v68, v[48:51]
    v_mfma_f32_16x16x4_f32 v[52:55], v88, v70, v[52:55]
    v_mfma_f32_16x16x4_f32 v[56:59], v88, v72, v[56:59]
    v_mfma_f32_16x16x4_f32 v[60:63], v90, v74, v[60:63]
    v_mfma_f32_16x16x4_f32 v[48:51], v87, v69, v[48:51]
    v_mfma_f32_16x16x4_f32 v[52:55], v89, v71, v[52:55]
    v_mfma_f32_16x16x4_f32 v[56:59], v89, v73, v[56:59]
    v_mfma_f32_16x16x4_f32 v[60:63], v91, v75, v[60:63]
    v_mov_b64_dpp v[64:65], v[28:29] row_newbcast:8 row_mask:0xf bank_mask:0xf
    v_mov_b64_dpp v[66:67], v[30:31] row_newbcast:8 row_mask:0xf bank_mask:0xf
    v_pk_mul_f32 v[94:95], v[64:65], v[26:27] op_sel_hi:[1,0]
    v_pk_mul_f32 v[96:97], v[64:65], v[26:27] op_sel:[0,1] op_sel_hi:[1,1]
    v_fract_f32 v95, v95
    v_fract_f32 v97, v97
    v_exp_f32 v94, v94
    v_exp_f32 v96, v96
    v_cos_f32 v68, v95
    v_sin_f32 v69, v95
    v_cos_f32 v76, v97
    v_sin_f32 v77, v97
    v_pk_mul_f32 v[68:69], v[68:69], v[94:95] op_sel_hi:[1,0]
    v_pk_mul_f32 v[76:77], v[76:77], v[96:97] op_sel_hi:[1,0]
    v_pk_mul_f32 v[92:93], v[76:77], v[76:77] op_sel:[1,1] op_sel_hi:[0,1]
    v_pk_fma_f32 v[78:79], v[76:77], v[76:77], v[92:93] op_sel:[0,0,0] op_sel_hi:[0,1,1] neg_lo:[0,0,1]
    v_pk_mul_f32 v[94:95], v[68:69], v[68:69] op_sel:[1,1] op_sel_hi:[0,1]
    v_pk_fma_f32 v[70:71], v[68:69], v[68:69], v[94:95] op_sel:[0,0,0] op_sel_hi:[0,1,1] neg_lo:[0,0,1]
    v_pk_mul_f32 v[92:93], v[78:79], v[78:79] op_sel:[1,1] op_sel_hi:[0,1]
    v_pk_fma_f32 v[80:81], v[78:79], v[78:79], v[92:93] op_sel:[0,0,0] op_sel_hi:[0,1,1] neg_lo:[0,0,1]
    v_pk_mul_f32 v[94:95], v[70:71], v[70:71] op_sel:[1,1] op_sel_hi:[0,1]
    v_pk_fma_f32 v[72:73], v[70:71], v[70:71], v[94:95] op_sel:[0,0,0] op_sel_hi:[0,1,1] neg_lo:[0,0,1]
    v_pk_mul_f32 v[92:93], v[80:81], v[80:81] op_sel:[1,1] op_sel_hi:[0,1]
    v_pk_fma_f32 v[82:83], v[80:81], v[80:81], v[92:93] op_sel:[0,0,0] op_sel_hi:[0,1,1] neg_lo:[0,0,1]
    v_pk_mul_f32 v[94:95], v[72:73], v[72:73] op_sel:[1,1] op_sel_hi:[0,1]
    v_pk_fma_f32 v[74:75], v[72:73], v[72:73], v[94:95] op_sel:[0,0,0] op_sel_hi:[0,1,1] neg_lo:[0,0,1]
    v_pk_mul_f32 v[92:93], v[82:83], v[82:83] op_sel:[1,1] op_sel_hi:[0,1]
    v_pk_fma_f32 v[84:85], v[82:83], v[82:83], v[92:93] op_sel:[0,0,0] op_sel_hi:[0,1,1] neg_lo:[0,0,1]
    v_pk_mul_f32 v[94:95], v[66:67], v[76:77] op_sel:[1,1] op_sel_hi:[1,0]
    v_pk_fma_f32 v[86:87], v[66:67], v[76:77], v[94:95] op_sel:[0,0,0] op_sel_hi:[0,1,1] neg_lo:[0,0,1] neg_hi:[1,0,1]
    v_mov_b32_dpp v80, v78 row_ror:8 row_mask:0xf bank_mask:0x3
    v_mov_b32_dpp v81, v79 row_ror:8 row_mask:0xf bank_mask:0x3
    v_mov_b32_dpp v82, v84 row_ror:8 row_mask:0xf bank_mask:0x3
    v_mov_b32_dpp v83, v85 row_ror:8 row_mask:0xf bank_mask:0x3
    v_pk_mul_f32 v[92:93], v[66:67], v[80:81] op_sel:[1,1] op_sel_hi:[1,0]
    v_pk_fma_f32 v[88:89], v[66:67], v[80:81], v[92:93] op_sel:[0,0,0] op_sel_hi:[0,1,1] neg_lo:[0,0,1] neg_hi:[1,0,1]
    v_pk_mul_f32 v[94:95], v[66:67], v[82:83] op_sel:[1,1] op_sel_hi:[1,0]
    v_pk_fma_f32 v[90:91], v[66:67], v[82:83], v[94:95] op_sel:[0,0,0] op_sel_hi:[0,1,1] neg_lo:[0,0,1] neg_hi:[1,0,1]
    v_mfma_f32_16x16x4_f32 v[48:51], v86, v68, v[48:51]
    v_mfma_f32_16x16x4_f32 v[52:55], v88, v70, v[52:55]
    v_mfma_f32_16x16x4_f32 v[56:59], v88, v72, v[56:59]
    v_mfma_f32_16x16x4_f32 v[60:63], v90, v74, v[60:63]
    v_mfma_f32_16x16x4_f32 v[48:51], v87, v69, v[48:51]
    v_mfma_f32_16x16x4_f32 v[52:55], v89, v71, v[52:55]
    v_mfma_f32_16x16x4_f32 v[56:59], v89, v73, v[56:59]
    v_mfma_f32_16x16x4_f32 v[60:63], v91, v75, v[60:63]
    v_mov_b64_dpp v[64:65], v[28:29] row_newbcast:9 row_mask:0xf bank_mask:0xf
    v_mov_b64_dpp v[66:67], v[30:31] row_newbcast:9 row_mask:0xf bank_mask:0xf
    v_pk_mul_f32 v[94:95], v[64:65], v[26:27] op_sel_hi:[1,0]
    v_pk_mul_f32 v[96:97], v[64:65], v[26:27] op_sel:[0,1] op_sel_hi:[1,1]
    v_fract_f32 v95, v95
    v_fract_f32 v97, v97
    v_exp_f32 v94, v94
    v_exp_f32 v96, v96
    v_cos_f32 v68, v95
    v_sin_f32 v69, v95
    v_cos_f32 v76, v97
    v_sin_f32 v77, v97
    v_pk_mul_f32 v[68:69], v[68:69], v[94:95] op_sel_hi:[1,0]
    v_pk_mul_f32 v[76:77], v[76:77], v[96:97] op_sel_hi:[1,0]
    v_pk_mul_f32 v[92:93], v[76:77], v[76:77] op_sel:[1,1] op_sel_hi:[0,1]
    v_pk_fma_f32 v[78:79], v[76:77], v[76:77], v[92:93] op_sel:[0,0,0] op_sel_hi:[0,1,1] neg_lo:[0,0,1]
    v_pk_mul_f32 v[94:95], v[68:69], v[68:69] op_sel:[1,1] op_sel_hi:[0,1]
    v_pk_fma_f32 v[70:71], v[68:69], v[68:69], v[94:95] op_sel:[0,0,0] op_sel_hi:[0,1,1] neg_lo:[0,0,1]
    v_pk_mul_f32 v[92:93], v[78:79], v[78:79] op_sel:[1,1] op_sel_hi:[0,1]
    v_pk_fma_f32 v[80:81], v[78:79], v[78:79], v[92:93] op_sel:[0,0,0] op_sel_hi:[0,1,1] neg_lo:[0,0,1]
    v_pk_mul_f32 v[94:95], v[70:71], v[70:71] op_sel:[1,1] op_sel_hi:[0,1]
    v_pk_fma_f32 v[72:73], v[70:71], v[70:71], v[94:95] op_sel:[0,0,0] op_sel_hi:[0,1,1] neg_lo:[0,0,1]
    v_pk_mul_f32 v[92:93], v[80:81], v[80:81] op_sel:[1,1] op_sel_hi:[0,1]
    v_pk_fma_f32 v[82:83], v[80:81], v[80:81], v[92:93] op_sel:[0,0,0] op_sel_hi:[0,1,1] neg_lo:[0,0,1]
    v_pk_mul_f32 v[94:95], v[72:73], v[72:73] op_sel:[1,1] op_sel_hi:[0,1]
    v_pk_fma_f32 v[74:75], v[72:73], v[72:73], v[94:95] op_sel:[0,0,0] op_sel_hi:[0,1,1] neg_lo:[0,0,1]
    v_pk_mul_f32 v[92:93], v[82:83], v[82:83] op_sel:[1,1] op_sel_hi:[0,1]
    v_pk_fma_f32 v[84:85], v[82:83], v[82:83], v[92:93] op_sel:[0,0,0] op_sel_hi:[0,1,1] neg_lo:[0,0,1]
    v_pk_mul_f32 v[94:95], v[66:67], v[76:77] op_sel:[1,1] op_sel_hi:[1,0]
    v_pk_fma_f32 v[86:87], v[66:67], v[76:77], v[94:95] op_sel:[0,0,0] op_sel_hi:[0,1,1] neg_lo:[0,0,1] neg_hi:[1,0,1]
    v_mov_b32_dpp v80, v78 row_ror:8 row_mask:0xf bank_mask:0x3
    v_mov_b32_dpp v81, v79 row_ror:8 row_mask:0xf bank_mask:0x3
    v_mov_b32_dpp v82, v84 row_ror:8 row_mask:0xf bank_mask:0x3
    v_mov_b32_dpp v83, v85 row_ror:8 row_mask:0xf bank_mask:0x3
    v_pk_mul_f32 v[92:93], v[66:67], v[80:81] op_sel:[1,1] op_sel_hi:[1,0]
    v_pk_fma_f32 v[88:89], v[66:67], v[80:81], v[92:93] op_sel:[0,0,0] op_sel_hi:[0,1,1] neg_lo:[0,0,1] neg_hi:[1,0,1]
    v_pk_mul_f32 v[94:95], v[66:67], v[82:83] op_sel:[1,1] op_sel_hi:[1,0]
    v_pk_fma_f32 v[90:91], v[66:67], v[82:83], v[94:95] op_sel:[0,0,0] op_sel_hi:[0,1,1] neg_lo:[0,0,1] neg_hi:[1,0,1]
    v_mfma_f32_16x16x4_f32 v[48:51], v86, v68, v[48:51]
    v_mfma_f32_16x16x4_f32 v[52:55], v88, v70, v[52:55]
    v_mfma_f32_16x16x4_f32 v[56:59], v88, v72, v[56:59]
    v_mfma_f32_16x16x4_f32 v[60:63], v90, v74, v[60:63]
    v_mfma_f32_16x16x4_f32 v[48:51], v87, v69, v[48:51]
    v_mfma_f32_16x16x4_f32 v[52:55], v89, v71, v[52:55]
    v_mfma_f32_16x16x4_f32 v[56:59], v89, v73, v[56:59]
    v_mfma_f32_16x16x4_f32 v[60:63], v91, v75, v[60:63]
    v_mov_b64_dpp v[64:65], v[28:29] row_newbcast:10 row_mask:0xf bank_mask:0xf
    v_mov_b64_dpp v[66:67], v[30:31] row_newbcast:10 row_mask:0xf bank_mask:0xf
    v_pk_mul_f32 v[94:95], v[64:65], v[26:27] op_sel_hi:[1,0]
    v_pk_mul_f32 v[96:97], v[64:65], v[26:27] op_sel:[0,1] op_sel_hi:[1,1]
    v_fract_f32 v95, v95
    v_fract_f32 v97, v97
    v_exp_f32 v94, v94
    v_exp_f32 v96, v96
    v_cos_f32 v68, v95
    v_sin_f32 v69, v95
    v_cos_f32 v76, v97
    v_sin_f32 v77, v97
    v_pk_mul_f32 v[68:69], v[68:69], v[94:95] op_sel_hi:[1,0]
    v_pk_mul_f32 v[76:77], v[76:77], v[96:97] op_sel_hi:[1,0]
    v_pk_mul_f32 v[92:93], v[76:77], v[76:77] op_sel:[1,1] op_sel_hi:[0,1]
    v_pk_fma_f32 v[78:79], v[76:77], v[76:77], v[92:93] op_sel:[0,0,0] op_sel_hi:[0,1,1] neg_lo:[0,0,1]
    v_pk_mul_f32 v[94:95], v[68:69], v[68:69] op_sel:[1,1] op_sel_hi:[0,1]
    v_pk_fma_f32 v[70:71], v[68:69], v[68:69], v[94:95] op_sel:[0,0,0] op_sel_hi:[0,1,1] neg_lo:[0,0,1]
    v_pk_mul_f32 v[92:93], v[78:79], v[78:79] op_sel:[1,1] op_sel_hi:[0,1]
    v_pk_fma_f32 v[80:81], v[78:79], v[78:79], v[92:93] op_sel:[0,0,0] op_sel_hi:[0,1,1] neg_lo:[0,0,1]
    v_pk_mul_f32 v[94:95], v[70:71], v[70:71] op_sel:[1,1] op_sel_hi:[0,1]
    v_pk_fma_f32 v[72:73], v[70:71], v[70:71], v[94:95] op_sel:[0,0,0] op_sel_hi:[0,1,1] neg_lo:[0,0,1]
    v_pk_mul_f32 v[92:93], v[80:81], v[80:81] op_sel:[1,1] op_sel_hi:[0,1]
    v_pk_fma_f32 v[82:83], v[80:81], v[80:81], v[92:93] op_sel:[0,0,0] op_sel_hi:[0,1,1] neg_lo:[0,0,1]
    v_pk_mul_f32 v[94:95], v[72:73], v[72:73] op_sel:[1,1] op_sel_hi:[0,1]
    v_pk_fma_f32 v[74:75], v[72:73], v[72:73], v[94:95] op_sel:[0,0,0] op_sel_hi:[0,1,1] neg_lo:[0,0,1]
    v_pk_mul_f32 v[92:93], v[82:83], v[82:83] op_sel:[1,1] op_sel_hi:[0,1]
    v_pk_fma_f32 v[84:85], v[82:83], v[82:83], v[92:93] op_sel:[0,0,0] op_sel_hi:[0,1,1] neg_lo:[0,0,1]
    v_pk_mul_f32 v[94:95], v[66:67], v[76:77] op_sel:[1,1] op_sel_hi:[1,0]
    v_pk_fma_f32 v[86:87], v[66:67], v[76:77], v[94:95] op_sel:[0,0,0] op_sel_hi:[0,1,1] neg_lo:[0,0,1] neg_hi:[1,0,1]
    v_mov_b32_dpp v80, v78 row_ror:8 row_mask:0xf bank_mask:0x3
    v_mov_b32_dpp v81, v79 row_ror:8 row_mask:0xf bank_mask:0x3
    v_mov_b32_dpp v82, v84 row_ror:8 row_mask:0xf bank_mask:0x3
    v_mov_b32_dpp v83, v85 row_ror:8 row_mask:0xf bank_mask:0x3
    v_pk_mul_f32 v[92:93], v[66:67], v[80:81] op_sel:[1,1] op_sel_hi:[1,0]
    v_pk_fma_f32 v[88:89], v[66:67], v[80:81], v[92:93] op_sel:[0,0,0] op_sel_hi:[0,1,1] neg_lo:[0,0,1] neg_hi:[1,0,1]
    v_pk_mul_f32 v[94:95], v[66:67], v[82:83] op_sel:[1,1] op_sel_hi:[1,0]
    v_pk_fma_f32 v[90:91], v[66:67], v[82:83], v[94:95] op_sel:[0,0,0] op_sel_hi:[0,1,1] neg_lo:[0,0,1] neg_hi:[1,0,1]
    v_mfma_f32_16x16x4_f32 v[48:51], v86, v68, v[48:51]
    v_mfma_f32_16x16x4_f32 v[52:55], v88, v70, v[52:55]
    v_mfma_f32_16x16x4_f32 v[56:59], v88, v72, v[56:59]
    v_mfma_f32_16x16x4_f32 v[60:63], v90, v74, v[60:63]
    v_mfma_f32_16x16x4_f32 v[48:51], v87, v69, v[48:51]
    v_mfma_f32_16x16x4_f32 v[52:55], v89, v71, v[52:55]
    v_mfma_f32_16x16x4_f32 v[56:59], v89, v73, v[56:59]
    v_mfma_f32_16x16x4_f32 v[60:63], v91, v75, v[60:63]
    v_mov_b64_dpp v[64:65], v[28:29] row_newbcast:11 row_mask:0xf bank_mask:0xf
    v_mov_b64_dpp v[66:67], v[30:31] row_newbcast:11 row_mask:0xf bank_mask:0xf
    v_pk_mul_f32 v[94:95], v[64:65], v[26:27] op_sel_hi:[1,0]
    v_pk_mul_f32 v[96:97], v[64:65], v[26:27] op_sel:[0,1] op_sel_hi:[1,1]
    v_fract_f32 v95, v95
    v_fract_f32 v97, v97
    v_exp_f32 v94, v94
    v_exp_f32 v96, v96
    v_cos_f32 v68, v95
    v_sin_f32 v69, v95
    v_cos_f32 v76, v97
    v_sin_f32 v77, v97
    v_pk_mul_f32 v[68:69], v[68:69], v[94:95] op_sel_hi:[1,0]
    v_pk_mul_f32 v[76:77], v[76:77], v[96:97] op_sel_hi:[1,0]
    v_pk_mul_f32 v[92:93], v[76:77], v[76:77] op_sel:[1,1] op_sel_hi:[0,1]
    v_pk_fma_f32 v[78:79], v[76:77], v[76:77], v[92:93] op_sel:[0,0,0] op_sel_hi:[0,1,1] neg_lo:[0,0,1]
    v_pk_mul_f32 v[94:95], v[68:69], v[68:69] op_sel:[1,1] op_sel_hi:[0,1]
    v_pk_fma_f32 v[70:71], v[68:69], v[68:69], v[94:95] op_sel:[0,0,0] op_sel_hi:[0,1,1] neg_lo:[0,0,1]
    v_pk_mul_f32 v[92:93], v[78:79], v[78:79] op_sel:[1,1] op_sel_hi:[0,1]
    v_pk_fma_f32 v[80:81], v[78:79], v[78:79], v[92:93] op_sel:[0,0,0] op_sel_hi:[0,1,1] neg_lo:[0,0,1]
    v_pk_mul_f32 v[94:95], v[70:71], v[70:71] op_sel:[1,1] op_sel_hi:[0,1]
    v_pk_fma_f32 v[72:73], v[70:71], v[70:71], v[94:95] op_sel:[0,0,0] op_sel_hi:[0,1,1] neg_lo:[0,0,1]
    v_pk_mul_f32 v[92:93], v[80:81], v[80:81] op_sel:[1,1] op_sel_hi:[0,1]
    v_pk_fma_f32 v[82:83], v[80:81], v[80:81], v[92:93] op_sel:[0,0,0] op_sel_hi:[0,1,1] neg_lo:[0,0,1]
    v_pk_mul_f32 v[94:95], v[72:73], v[72:73] op_sel:[1,1] op_sel_hi:[0,1]
    v_pk_fma_f32 v[74:75], v[72:73], v[72:73], v[94:95] op_sel:[0,0,0] op_sel_hi:[0,1,1] neg_lo:[0,0,1]
    v_pk_mul_f32 v[92:93], v[82:83], v[82:83] op_sel:[1,1] op_sel_hi:[0,1]
    v_pk_fma_f32 v[84:85], v[82:83], v[82:83], v[92:93] op_sel:[0,0,0] op_sel_hi:[0,1,1] neg_lo:[0,0,1]
    v_pk_mul_f32 v[94:95], v[66:67], v[76:77] op_sel:[1,1] op_sel_hi:[1,0]
    v_pk_fma_f32 v[86:87], v[66:67], v[76:77], v[94:95] op_sel:[0,0,0] op_sel_hi:[0,1,1] neg_lo:[0,0,1] neg_hi:[1,0,1]
    v_mov_b32_dpp v80, v78 row_ror:8 row_mask:0xf bank_mask:0x3
    v_mov_b32_dpp v81, v79 row_ror:8 row_mask:0xf bank_mask:0x3
    v_mov_b32_dpp v82, v84 row_ror:8 row_mask:0xf bank_mask:0x3
    v_mov_b32_dpp v83, v85 row_ror:8 row_mask:0xf bank_mask:0x3
    v_pk_mul_f32 v[92:93], v[66:67], v[80:81] op_sel:[1,1] op_sel_hi:[1,0]
    v_pk_fma_f32 v[88:89], v[66:67], v[80:81], v[92:93] op_sel:[0,0,0] op_sel_hi:[0,1,1] neg_lo:[0,0,1] neg_hi:[1,0,1]
    v_pk_mul_f32 v[94:95], v[66:67], v[82:83] op_sel:[1,1] op_sel_hi:[1,0]
    v_pk_fma_f32 v[90:91], v[66:67], v[82:83], v[94:95] op_sel:[0,0,0] op_sel_hi:[0,1,1] neg_lo:[0,0,1] neg_hi:[1,0,1]
    v_mfma_f32_16x16x4_f32 v[48:51], v86, v68, v[48:51]
    v_mfma_f32_16x16x4_f32 v[52:55], v88, v70, v[52:55]
    v_mfma_f32_16x16x4_f32 v[56:59], v88, v72, v[56:59]
    v_mfma_f32_16x16x4_f32 v[60:63], v90, v74, v[60:63]
    v_mfma_f32_16x16x4_f32 v[48:51], v87, v69, v[48:51]
    v_mfma_f32_16x16x4_f32 v[52:55], v89, v71, v[52:55]
    v_mfma_f32_16x16x4_f32 v[56:59], v89, v73, v[56:59]
    v_mfma_f32_16x16x4_f32 v[60:63], v91, v75, v[60:63]
    v_mov_b64_dpp v[64:65], v[28:29] row_newbcast:12 row_mask:0xf bank_mask:0xf
    v_mov_b64_dpp v[66:67], v[30:31] row_newbcast:12 row_mask:0xf bank_mask:0xf
    v_pk_mul_f32 v[94:95], v[64:65], v[26:27] op_sel_hi:[1,0]
    v_pk_mul_f32 v[96:97], v[64:65], v[26:27] op_sel:[0,1] op_sel_hi:[1,1]
    v_fract_f32 v95, v95
    v_fract_f32 v97, v97
    v_exp_f32 v94, v94
    v_exp_f32 v96, v96
    v_cos_f32 v68, v95
    v_sin_f32 v69, v95
    v_cos_f32 v76, v97
    v_sin_f32 v77, v97
    v_pk_mul_f32 v[68:69], v[68:69], v[94:95] op_sel_hi:[1,0]
    v_pk_mul_f32 v[76:77], v[76:77], v[96:97] op_sel_hi:[1,0]
    v_pk_mul_f32 v[92:93], v[76:77], v[76:77] op_sel:[1,1] op_sel_hi:[0,1]
    v_pk_fma_f32 v[78:79], v[76:77], v[76:77], v[92:93] op_sel:[0,0,0] op_sel_hi:[0,1,1] neg_lo:[0,0,1]
    v_pk_mul_f32 v[94:95], v[68:69], v[68:69] op_sel:[1,1] op_sel_hi:[0,1]
    v_pk_fma_f32 v[70:71], v[68:69], v[68:69], v[94:95] op_sel:[0,0,0] op_sel_hi:[0,1,1] neg_lo:[0,0,1]
    v_pk_mul_f32 v[92:93], v[78:79], v[78:79] op_sel:[1,1] op_sel_hi:[0,1]
    v_pk_fma_f32 v[80:81], v[78:79], v[78:79], v[92:93] op_sel:[0,0,0] op_sel_hi:[0,1,1] neg_lo:[0,0,1]
    v_pk_mul_f32 v[94:95], v[70:71], v[70:71] op_sel:[1,1] op_sel_hi:[0,1]
    v_pk_fma_f32 v[72:73], v[70:71], v[70:71], v[94:95] op_sel:[0,0,0] op_sel_hi:[0,1,1] neg_lo:[0,0,1]
    v_pk_mul_f32 v[92:93], v[80:81], v[80:81] op_sel:[1,1] op_sel_hi:[0,1]
    v_pk_fma_f32 v[82:83], v[80:81], v[80:81], v[92:93] op_sel:[0,0,0] op_sel_hi:[0,1,1] neg_lo:[0,0,1]
    v_pk_mul_f32 v[94:95], v[72:73], v[72:73] op_sel:[1,1] op_sel_hi:[0,1]
    v_pk_fma_f32 v[74:75], v[72:73], v[72:73], v[94:95] op_sel:[0,0,0] op_sel_hi:[0,1,1] neg_lo:[0,0,1]
    v_pk_mul_f32 v[92:93], v[82:83], v[82:83] op_sel:[1,1] op_sel_hi:[0,1]
    v_pk_fma_f32 v[84:85], v[82:83], v[82:83], v[92:93] op_sel:[0,0,0] op_sel_hi:[0,1,1] neg_lo:[0,0,1]
    v_pk_mul_f32 v[94:95], v[66:67], v[76:77] op_sel:[1,1] op_sel_hi:[1,0]
    v_pk_fma_f32 v[86:87], v[66:67], v[76:77], v[94:95] op_sel:[0,0,0] op_sel_hi:[0,1,1] neg_lo:[0,0,1] neg_hi:[1,0,1]
    v_mov_b32_dpp v80, v78 row_ror:8 row_mask:0xf bank_mask:0x3
    v_mov_b32_dpp v81, v79 row_ror:8 row_mask:0xf bank_mask:0x3
    v_mov_b32_dpp v82, v84 row_ror:8 row_mask:0xf bank_mask:0x3
    v_mov_b32_dpp v83, v85 row_ror:8 row_mask:0xf bank_mask:0x3
    v_pk_mul_f32 v[92:93], v[66:67], v[80:81] op_sel:[1,1] op_sel_hi:[1,0]
    v_pk_fma_f32 v[88:89], v[66:67], v[80:81], v[92:93] op_sel:[0,0,0] op_sel_hi:[0,1,1] neg_lo:[0,0,1] neg_hi:[1,0,1]
    v_pk_mul_f32 v[94:95], v[66:67], v[82:83] op_sel:[1,1] op_sel_hi:[1,0]
    v_pk_fma_f32 v[90:91], v[66:67], v[82:83], v[94:95] op_sel:[0,0,0] op_sel_hi:[0,1,1] neg_lo:[0,0,1] neg_hi:[1,0,1]
    v_mfma_f32_16x16x4_f32 v[48:51], v86, v68, v[48:51]
    v_mfma_f32_16x16x4_f32 v[52:55], v88, v70, v[52:55]
    v_mfma_f32_16x16x4_f32 v[56:59], v88, v72, v[56:59]
    v_mfma_f32_16x16x4_f32 v[60:63], v90, v74, v[60:63]
    v_mfma_f32_16x16x4_f32 v[48:51], v87, v69, v[48:51]
    v_mfma_f32_16x16x4_f32 v[52:55], v89, v71, v[52:55]
    v_mfma_f32_16x16x4_f32 v[56:59], v89, v73, v[56:59]
    v_mfma_f32_16x16x4_f32 v[60:63], v91, v75, v[60:63]
    v_mov_b64_dpp v[64:65], v[28:29] row_newbcast:13 row_mask:0xf bank_mask:0xf
    v_mov_b64_dpp v[66:67], v[30:31] row_newbcast:13 row_mask:0xf bank_mask:0xf
    v_pk_mul_f32 v[94:95], v[64:65], v[26:27] op_sel_hi:[1,0]
    v_pk_mul_f32 v[96:97], v[64:65], v[26:27] op_sel:[0,1] op_sel_hi:[1,1]
    v_fract_f32 v95, v95
    v_fract_f32 v97, v97
    v_exp_f32 v94, v94
    v_exp_f32 v96, v96
    v_cos_f32 v68, v95
    v_sin_f32 v69, v95
    v_cos_f32 v76, v97
    v_sin_f32 v77, v97
    v_pk_mul_f32 v[68:69], v[68:69], v[94:95] op_sel_hi:[1,0]
    v_pk_mul_f32 v[76:77], v[76:77], v[96:97] op_sel_hi:[1,0]
    v_pk_mul_f32 v[92:93], v[76:77], v[76:77] op_sel:[1,1] op_sel_hi:[0,1]
    v_pk_fma_f32 v[78:79], v[76:77], v[76:77], v[92:93] op_sel:[0,0,0] op_sel_hi:[0,1,1] neg_lo:[0,0,1]
    v_pk_mul_f32 v[94:95], v[68:69], v[68:69] op_sel:[1,1] op_sel_hi:[0,1]
    v_pk_fma_f32 v[70:71], v[68:69], v[68:69], v[94:95] op_sel:[0,0,0] op_sel_hi:[0,1,1] neg_lo:[0,0,1]
    v_pk_mul_f32 v[92:93], v[78:79], v[78:79] op_sel:[1,1] op_sel_hi:[0,1]
    v_pk_fma_f32 v[80:81], v[78:79], v[78:79], v[92:93] op_sel:[0,0,0] op_sel_hi:[0,1,1] neg_lo:[0,0,1]
    v_pk_mul_f32 v[94:95], v[70:71], v[70:71] op_sel:[1,1] op_sel_hi:[0,1]
    v_pk_fma_f32 v[72:73], v[70:71], v[70:71], v[94:95] op_sel:[0,0,0] op_sel_hi:[0,1,1] neg_lo:[0,0,1]
    v_pk_mul_f32 v[92:93], v[80:81], v[80:81] op_sel:[1,1] op_sel_hi:[0,1]
    v_pk_fma_f32 v[82:83], v[80:81], v[80:81], v[92:93] op_sel:[0,0,0] op_sel_hi:[0,1,1] neg_lo:[0,0,1]
    v_pk_mul_f32 v[94:95], v[72:73], v[72:73] op_sel:[1,1] op_sel_hi:[0,1]
    v_pk_fma_f32 v[74:75], v[72:73], v[72:73], v[94:95] op_sel:[0,0,0] op_sel_hi:[0,1,1] neg_lo:[0,0,1]
    v_pk_mul_f32 v[92:93], v[82:83], v[82:83] op_sel:[1,1] op_sel_hi:[0,1]
    v_pk_fma_f32 v[84:85], v[82:83], v[82:83], v[92:93] op_sel:[0,0,0] op_sel_hi:[0,1,1] neg_lo:[0,0,1]
    v_pk_mul_f32 v[94:95], v[66:67], v[76:77] op_sel:[1,1] op_sel_hi:[1,0]
    v_pk_fma_f32 v[86:87], v[66:67], v[76:77], v[94:95] op_sel:[0,0,0] op_sel_hi:[0,1,1] neg_lo:[0,0,1] neg_hi:[1,0,1]
    v_mov_b32_dpp v80, v78 row_ror:8 row_mask:0xf bank_mask:0x3
    v_mov_b32_dpp v81, v79 row_ror:8 row_mask:0xf bank_mask:0x3
    v_mov_b32_dpp v82, v84 row_ror:8 row_mask:0xf bank_mask:0x3
    v_mov_b32_dpp v83, v85 row_ror:8 row_mask:0xf bank_mask:0x3
    v_pk_mul_f32 v[92:93], v[66:67], v[80:81] op_sel:[1,1] op_sel_hi:[1,0]
    v_pk_fma_f32 v[88:89], v[66:67], v[80:81], v[92:93] op_sel:[0,0,0] op_sel_hi:[0,1,1] neg_lo:[0,0,1] neg_hi:[1,0,1]
    v_pk_mul_f32 v[94:95], v[66:67], v[82:83] op_sel:[1,1] op_sel_hi:[1,0]
    v_pk_fma_f32 v[90:91], v[66:67], v[82:83], v[94:95] op_sel:[0,0,0] op_sel_hi:[0,1,1] neg_lo:[0,0,1] neg_hi:[1,0,1]
    v_mfma_f32_16x16x4_f32 v[48:51], v86, v68, v[48:51]
    v_mfma_f32_16x16x4_f32 v[52:55], v88, v70, v[52:55]
    v_mfma_f32_16x16x4_f32 v[56:59], v88, v72, v[56:59]
    v_mfma_f32_16x16x4_f32 v[60:63], v90, v74, v[60:63]
    v_mfma_f32_16x16x4_f32 v[48:51], v87, v69, v[48:51]
    v_mfma_f32_16x16x4_f32 v[52:55], v89, v71, v[52:55]
    v_mfma_f32_16x16x4_f32 v[56:59], v89, v73, v[56:59]
    v_mfma_f32_16x16x4_f32 v[60:63], v91, v75, v[60:63]
    v_mov_b64_dpp v[64:65], v[28:29] row_newbcast:14 row_mask:0xf bank_mask:0xf
    v_mov_b64_dpp v[66:67], v[30:31] row_newbcast:14 row_mask:0xf bank_mask:0xf
    v_pk_mul_f32 v[94:95], v[64:65], v[26:27] op_sel_hi:[1,0]
    v_pk_mul_f32 v[96:97], v[64:65], v[26:27] op_sel:[0,1] op_sel_hi:[1,1]
    v_fract_f32 v95, v95
    v_fract_f32 v97, v97
    v_exp_f32 v94, v94
    v_exp_f32 v96, v96
    v_cos_f32 v68, v95
    v_sin_f32 v69, v95
    v_cos_f32 v76, v97
    v_sin_f32 v77, v97
    v_pk_mul_f32 v[68:69], v[68:69], v[94:95] op_sel_hi:[1,0]
    v_pk_mul_f32 v[76:77], v[76:77], v[96:97] op_sel_hi:[1,0]
    v_pk_mul_f32 v[92:93], v[76:77], v[76:77] op_sel:[1,1] op_sel_hi:[0,1]
    v_pk_fma_f32 v[78:79], v[76:77], v[76:77], v[92:93] op_sel:[0,0,0] op_sel_hi:[0,1,1] neg_lo:[0,0,1]
    v_pk_mul_f32 v[94:95], v[68:69], v[68:69] op_sel:[1,1] op_sel_hi:[0,1]
    v_pk_fma_f32 v[70:71], v[68:69], v[68:69], v[94:95] op_sel:[0,0,0] op_sel_hi:[0,1,1] neg_lo:[0,0,1]
    v_pk_mul_f32 v[92:93], v[78:79], v[78:79] op_sel:[1,1] op_sel_hi:[0,1]
    v_pk_fma_f32 v[80:81], v[78:79], v[78:79], v[92:93] op_sel:[0,0,0] op_sel_hi:[0,1,1] neg_lo:[0,0,1]
    v_pk_mul_f32 v[94:95], v[70:71], v[70:71] op_sel:[1,1] op_sel_hi:[0,1]
    v_pk_fma_f32 v[72:73], v[70:71], v[70:71], v[94:95] op_sel:[0,0,0] op_sel_hi:[0,1,1] neg_lo:[0,0,1]
    v_pk_mul_f32 v[92:93], v[80:81], v[80:81] op_sel:[1,1] op_sel_hi:[0,1]
    v_pk_fma_f32 v[82:83], v[80:81], v[80:81], v[92:93] op_sel:[0,0,0] op_sel_hi:[0,1,1] neg_lo:[0,0,1]
    v_pk_mul_f32 v[94:95], v[72:73], v[72:73] op_sel:[1,1] op_sel_hi:[0,1]
    v_pk_fma_f32 v[74:75], v[72:73], v[72:73], v[94:95] op_sel:[0,0,0] op_sel_hi:[0,1,1] neg_lo:[0,0,1]
    v_pk_mul_f32 v[92:93], v[82:83], v[82:83] op_sel:[1,1] op_sel_hi:[0,1]
    v_pk_fma_f32 v[84:85], v[82:83], v[82:83], v[92:93] op_sel:[0,0,0] op_sel_hi:[0,1,1] neg_lo:[0,0,1]
    v_pk_mul_f32 v[94:95], v[66:67], v[76:77] op_sel:[1,1] op_sel_hi:[1,0]
    v_pk_fma_f32 v[86:87], v[66:67], v[76:77], v[94:95] op_sel:[0,0,0] op_sel_hi:[0,1,1] neg_lo:[0,0,1] neg_hi:[1,0,1]
    v_mov_b32_dpp v80, v78 row_ror:8 row_mask:0xf bank_mask:0x3
    v_mov_b32_dpp v81, v79 row_ror:8 row_mask:0xf bank_mask:0x3
    v_mov_b32_dpp v82, v84 row_ror:8 row_mask:0xf bank_mask:0x3
    v_mov_b32_dpp v83, v85 row_ror:8 row_mask:0xf bank_mask:0x3
    v_pk_mul_f32 v[92:93], v[66:67], v[80:81] op_sel:[1,1] op_sel_hi:[1,0]
    v_pk_fma_f32 v[88:89], v[66:67], v[80:81], v[92:93] op_sel:[0,0,0] op_sel_hi:[0,1,1] neg_lo:[0,0,1] neg_hi:[1,0,1]
    v_pk_mul_f32 v[94:95], v[66:67], v[82:83] op_sel:[1,1] op_sel_hi:[1,0]
    v_pk_fma_f32 v[90:91], v[66:67], v[82:83], v[94:95] op_sel:[0,0,0] op_sel_hi:[0,1,1] neg_lo:[0,0,1] neg_hi:[1,0,1]
    v_mfma_f32_16x16x4_f32 v[48:51], v86, v68, v[48:51]
    v_mfma_f32_16x16x4_f32 v[52:55], v88, v70, v[52:55]
    v_mfma_f32_16x16x4_f32 v[56:59], v88, v72, v[56:59]
    v_mfma_f32_16x16x4_f32 v[60:63], v90, v74, v[60:63]
    v_mfma_f32_16x16x4_f32 v[48:51], v87, v69, v[48:51]
    v_mfma_f32_16x16x4_f32 v[52:55], v89, v71, v[52:55]
    v_mfma_f32_16x16x4_f32 v[56:59], v89, v73, v[56:59]
    v_mfma_f32_16x16x4_f32 v[60:63], v91, v75, v[60:63]
    v_mov_b64_dpp v[64:65], v[28:29] row_newbcast:15 row_mask:0xf bank_mask:0xf
    v_mov_b64_dpp v[66:67], v[30:31] row_newbcast:15 row_mask:0xf bank_mask:0xf
    v_pk_mul_f32 v[94:95], v[64:65], v[26:27] op_sel_hi:[1,0]
    v_pk_mul_f32 v[96:97], v[64:65], v[26:27] op_sel:[0,1] op_sel_hi:[1,1]
    v_fract_f32 v95, v95
    v_fract_f32 v97, v97
    v_exp_f32 v94, v94
    v_exp_f32 v96, v96
    v_cos_f32 v68, v95
    v_sin_f32 v69, v95
    v_cos_f32 v76, v97
    v_sin_f32 v77, v97
    v_pk_mul_f32 v[68:69], v[68:69], v[94:95] op_sel_hi:[1,0]
    v_pk_mul_f32 v[76:77], v[76:77], v[96:97] op_sel_hi:[1,0]
    v_pk_mul_f32 v[92:93], v[76:77], v[76:77] op_sel:[1,1] op_sel_hi:[0,1]
    v_pk_fma_f32 v[78:79], v[76:77], v[76:77], v[92:93] op_sel:[0,0,0] op_sel_hi:[0,1,1] neg_lo:[0,0,1]
    v_pk_mul_f32 v[94:95], v[68:69], v[68:69] op_sel:[1,1] op_sel_hi:[0,1]
    v_pk_fma_f32 v[70:71], v[68:69], v[68:69], v[94:95] op_sel:[0,0,0] op_sel_hi:[0,1,1] neg_lo:[0,0,1]
    v_pk_mul_f32 v[92:93], v[78:79], v[78:79] op_sel:[1,1] op_sel_hi:[0,1]
    v_pk_fma_f32 v[80:81], v[78:79], v[78:79], v[92:93] op_sel:[0,0,0] op_sel_hi:[0,1,1] neg_lo:[0,0,1]
    v_pk_mul_f32 v[94:95], v[70:71], v[70:71] op_sel:[1,1] op_sel_hi:[0,1]
    v_pk_fma_f32 v[72:73], v[70:71], v[70:71], v[94:95] op_sel:[0,0,0] op_sel_hi:[0,1,1] neg_lo:[0,0,1]
    v_pk_mul_f32 v[92:93], v[80:81], v[80:81] op_sel:[1,1] op_sel_hi:[0,1]
    v_pk_fma_f32 v[82:83], v[80:81], v[80:81], v[92:93] op_sel:[0,0,0] op_sel_hi:[0,1,1] neg_lo:[0,0,1]
    v_pk_mul_f32 v[94:95], v[72:73], v[72:73] op_sel:[1,1] op_sel_hi:[0,1]
    v_pk_fma_f32 v[74:75], v[72:73], v[72:73], v[94:95] op_sel:[0,0,0] op_sel_hi:[0,1,1] neg_lo:[0,0,1]
    v_pk_mul_f32 v[92:93], v[82:83], v[82:83] op_sel:[1,1] op_sel_hi:[0,1]
    v_pk_fma_f32 v[84:85], v[82:83], v[82:83], v[92:93] op_sel:[0,0,0] op_sel_hi:[0,1,1] neg_lo:[0,0,1]
    v_pk_mul_f32 v[94:95], v[66:67], v[76:77] op_sel:[1,1] op_sel_hi:[1,0]
    v_pk_fma_f32 v[86:87], v[66:67], v[76:77], v[94:95] op_sel:[0,0,0] op_sel_hi:[0,1,1] neg_lo:[0,0,1] neg_hi:[1,0,1]
    v_mov_b32_dpp v80, v78 row_ror:8 row_mask:0xf bank_mask:0x3
    v_mov_b32_dpp v81, v79 row_ror:8 row_mask:0xf bank_mask:0x3
    v_mov_b32_dpp v82, v84 row_ror:8 row_mask:0xf bank_mask:0x3
    v_mov_b32_dpp v83, v85 row_ror:8 row_mask:0xf bank_mask:0x3
    v_pk_mul_f32 v[92:93], v[66:67], v[80:81] op_sel:[1,1] op_sel_hi:[1,0]
    v_pk_fma_f32 v[88:89], v[66:67], v[80:81], v[92:93] op_sel:[0,0,0] op_sel_hi:[0,1,1] neg_lo:[0,0,1] neg_hi:[1,0,1]
    v_pk_mul_f32 v[94:95], v[66:67], v[82:83] op_sel:[1,1] op_sel_hi:[1,0]
    v_pk_fma_f32 v[90:91], v[66:67], v[82:83], v[94:95] op_sel:[0,0,0] op_sel_hi:[0,1,1] neg_lo:[0,0,1] neg_hi:[1,0,1]
    v_mfma_f32_16x16x4_f32 v[48:51], v86, v68, v[48:51]
    v_mfma_f32_16x16x4_f32 v[52:55], v88, v70, v[52:55]
    v_mfma_f32_16x16x4_f32 v[56:59], v88, v72, v[56:59]
    v_mfma_f32_16x16x4_f32 v[60:63], v90, v74, v[60:63]
    v_mfma_f32_16x16x4_f32 v[48:51], v87, v69, v[48:51]
    v_mfma_f32_16x16x4_f32 v[52:55], v89, v71, v[52:55]
    v_mfma_f32_16x16x4_f32 v[56:59], v89, v73, v[56:59]
    v_mfma_f32_16x16x4_f32 v[60:63], v91, v75, v[60:63]
    v_mov_b64 v[28:29], v[32:33]
    v_mov_b64 v[30:31], v[34:35]
    s_add_u32 s25, s25, 1
    s_cmp_lt_u32 s25, 2
    s_cbranch_scc1 ss_kg
    s_cmp_lg_u32 s28, 0
    s_cbranch_scc1 ss_nostage
    s_waitcnt vmcnt(0)
    v_mov_b32 v36, 0x05040100
    v_mov_b32 v37, 0x07060302
    v_lshlrev_b32 v6, 4, v0
    v_add_u32 v7, 65536, v6
    v_perm_b32 v40, v212, v208, v36
    v_perm_b32 v41, v220, v216, v36
    v_perm_b32 v42, v228, v224, v36
    v_perm_b32 v43, v236, v232, v36
    ds_write_b128 v6, v[40:43] offset:512
    v_perm_b32 v44, v212, v208, v37
    v_perm_b32 v45, v220, v216, v37
    v_perm_b32 v46, v228, v224, v37
    v_perm_b32 v47, v236, v232, v37
    ds_write_b128 v6, v[44:47] offset:16896
    v_perm_b32 v40, v213, v209, v36
    v_perm_b32 v41, v221, v217, v36
    v_perm_b32 v42, v229, v225, v36
    v_perm_b32 v43, v237, v233, v36
    ds_write_b128 v6, v[40:43] offset:33280
    v_perm_b32 v44, v213, v209, v37
    v_perm_b32 v45, v221, v217, v37
    v_perm_b32 v46, v229, v225, v37
    v_perm_b32 v47, v237, v233, v37
    ds_write_b128 v6, v[44:47] offset:49664
    v_perm_b32 v40, v214, v210, v36
    v_perm_b32 v41, v222, v218, v36
    v_perm_b32 v42, v230, v226, v36
    v_perm_b32 v43, v238, v234, v36
    ds_write_b128 v7, v[40:43] offset:512
    v_perm_b32 v44, v214, v210, v37
    v_perm_b32 v45, v222, v218, v37
    v_perm_b32 v46, v230, v226, v37
    v_perm_b32 v47, v238, v234, v37
    ds_write_b128 v7, v[44:47] offset:16896
    v_perm_b32 v40, v215, v211, v36
    v_perm_b32 v41, v223, v219, v36
    v_perm_b32 v42, v231, v227, v36
    v_perm_b32 v43, v239, v235, v36
    ds_write_b128 v7, v[40:43] offset:33280
    v_perm_b32 v44, v215, v211, v37
    v_perm_b32 v45, v223, v219, v37
    v_perm_b32 v46, v231, v227, v37
    v_perm_b32 v47, v239, v235, v37
    ds_write_b128 v7, v[44:47] offset:49664
ss_nostage:
    s_nop 11
    v_lshlrev_b32 v5, 8, v3
    v_lshl_add_u32 v5, v2, 2, v5
    v_add_u32 v5, v5, v4
    ds_write_b32 v5, v48 offset:4608
    ds_write_b32 v5, v49 offset:4672
    ds_write_b32 v5, v50 offset:4736
    ds_write_b32 v5, v51 offset:4800
    s_mov_b32 exec_hi, 0
    ds_write_b32 v5, v52 offset:5632
    ds_write_b32 v5, v53 offset:5696
    ds_write_b32 v5, v54 offset:5760
    ds_write_b32 v5, v55 offset:5824
    s_not_b64 exec, exec
    ds_write_b32 v5, v56 offset:5632
    ds_write_b32 v5, v57 offset:5696
    ds_write_b32 v5, v58 offset:5760
    ds_write_b32 v5, v59 offset:5824
    ds_write_b32 v5, v60 offset:6144
    ds_write_b32 v5, v61 offset:6208
    ds_write_b32 v5, v62 offset:6272
    ds_write_b32 v5, v63 offset:6336
    s_mov_b64 exec, 3
    v_cmp_eq_u32 vcc, 0, v2
    s_nop 1
    v_cndmask_b32 v6, 0, v60, vcc
    ds_write_b32 v5, v6 offset:7168
    s_mov_b64 exec, -1
    s_waitcnt lgkmcnt(0)
    v_lshlrev_b32 v7, 1, v1
    v_sub_u32 v7, 2065, v7
    v_lshl_add_u32 v64, v1, 2, v4
    v_mov_b32 v65, 641
    s_mov_b32 s25, 9
    s_mov_b32 s22, 256
    s_mov_b32 s23, 2048
ss_exp:
    v_subrev_u32 v66, 0, v7
    v_cvt_f32_u32 v72, v66
    v_cmp_gt_u32 vcc, s22, v66
    v_cvt_pk_bf16_f32 v72, v72, 0
    v_subrev_u32 v72, 0x4280, v72
    v_cndmask_b32 v72, v72, v66, vcc
    v_cmp_gt_u32 vcc, s23, v66
    s_nop 1
    v_cndmask_b32 v72, v65, v72, vcc
    v_lshl_add_u32 v72, v72, 2, v4
    v_subrev_u32 v67, 1, v7
    v_cvt_f32_u32 v73, v67
    v_cmp_gt_u32 vcc, s22, v67
    v_cvt_pk_bf16_f32 v73, v73, 0
    v_subrev_u32 v73, 0x4280, v73
    v_cndmask_b32 v73, v73, v67, vcc
    v_cmp_gt_u32 vcc, s23, v67
    ds_read_b32 v78, v72 offset:4608
    s_nop 0
    v_cndmask_b32 v73, v65, v73, vcc
    v_lshl_add_u32 v73, v73, 2, v4
    v_subrev_u32 v68, 2, v7
    v_cvt_f32_u32 v74, v68
    v_cmp_gt_u32 vcc, s22, v68
    v_cvt_pk_bf16_f32 v74, v74, 0
    v_subrev_u32 v74, 0x4280, v74
    v_cndmask_b32 v74, v74, v68, vcc
    v_cmp_gt_u32 vcc, s23, v68
    ds_read_b32 v79, v73 offset:4608
    s_nop 0
    v_cndmask_b32 v74, v65, v74, vcc
    v_lshl_add_u32 v74, v74, 2, v4
    v_subrev_u32 v69, 128, v7
    v_cvt_f32_u32 v75, v69
    v_cmp_gt_u32 vcc, s22, v69
    v_cvt_pk_bf16_f32 v75, v75, 0
    v_subrev_u32 v75, 0x4280, v75
    v_cndmask_b32 v75, v75, v69, vcc
    v_cmp_gt_u32 vcc, s23, v69
    ds_read_b32 v80, v74 offset:4608
    s_nop 0
    v_cndmask_b32 v75, v65, v75, vcc
    v_lshl_add_u32 v75, v75, 2, v4
    v_subrev_u32 v70, 129, v7
    v_cvt_f32_u32 v76, v70
    v_cmp_gt_u32 vcc, s22, v70
    v_cvt_pk_bf16_f32 v76, v76, 0
    v_subrev_u32 v76, 0x4280, v76
    v_cndmask_b32 v76, v76, v70, vcc
    v_cmp_gt_u32 vcc, s23, v70
    ds_read_b32 v81, v75 offset:4608
    s_nop 0
    v_cndmask_b32 v76, v65, v76, vcc
    v_lshl_add_u32 v76, v76, 2, v4
    v_subrev_u32 v71, 130, v7
    v_cvt_f32_u32 v77, v71
    v_cmp_gt_u32 vcc, s22, v71
    v_cvt_pk_bf16_f32 v77, v77, 0
    v_subrev_u32 v77, 0x4280, v77
    v_cndmask_b32 v77, v77, v71, vcc
    v_cmp_gt_u32 vcc, s23, v71
    ds_read_b32 v82, v76 offset:4608
    s_nop 0
    v_cndmask_b32 v77, v65, v77, vcc
    v_lshl_add_u32 v77, v77, 2, v4
    ds_read_b32 v83, v77 offset:4608
    v_subrev_u32 v7, 256, v7
    s_sub_u32 s25, s25, 1
    s_waitcnt lgkmcnt(0)
    v_cvt_pk_bf16_f32 v84, v79, v80
    v_cvt_pk_bf16_f32 v85, v78, v79
    v_cvt_pk_bf16_f32 v86, v82, v83
    v_cvt_pk_bf16_f32 v87, v81, v82
    ds_write_b32 v64, v84 offset:7424
    ds_write_b32 v64, v85 offset:11776
    s_cmp_eq_u32 s25, 0
    s_cbranch_scc1 ss_expx
    ds_write_b32 v64, v86 offset:7680
    ds_write_b32 v64, v87 offset:12032
    v_add_u32 v64, 512, v64
    s_nop 1
    s_branch ss_exp
ss_expx:
    s_waitcnt lgkmcnt(0)
    s_barrier
    v_and_b32 v5, 1, v2
    v_mul_u32_u24 v36, 4352, v5
    v_sub_u32 v5, v5, v2
    v_lshl_add_u32 v5, v3, 3, v5
    v_lshl_add_u32 v36, v5, 1, v36
    v_add_u32 v36, 11072, v36
    v_add_u32 v36, v36, v4
    v_subrev_u32 v37, 512, v36
    v_subrev_u32 v38, 1024, v36
    v_subrev_u32 v39, 1536, v36
    v_subrev_u32 v40, 2048, v36
    v_subrev_u32 v41, 2560, v36
    v_subrev_u32 v42, 3072, v36
    v_subrev_u32 v43, 3584, v36
    v_lshlrev_b32 v44, 5, v2
    v_lshl_add_u32 v44, v3, 4, v44
    v_add_u32 v44, 32, v44
    v_add_u32 v44, v44, v4
    ds_read_b128 v[112:115], v44 offset:448
    ds_read2_b32 v[80:81], v36 offset0:112 offset1:113
    ds_read2_b32 v[82:83], v36 offset0:114 offset1:115
    ds_read_b128 v[116:119], v44 offset:960
    ds_read2_b32 v[84:85], v37 offset0:112 offset1:113
    ds_read2_b32 v[86:87], v37 offset0:114 offset1:115
    ds_read_b128 v[120:123], v44 offset:1472
    ds_read2_b32 v[88:89], v38 offset0:112 offset1:113
    ds_read2_b32 v[90:91], v38 offset0:114 offset1:115
    ds_read_b128 v[124:127], v44 offset:1984
    ds_read2_b32 v[92:93], v39 offset0:112 offset1:113
    ds_read2_b32 v[94:95], v39 offset0:114 offset1:115
    ds_read_b128 v[128:131], v44 offset:2496
    ds_read2_b32 v[96:97], v40 offset0:112 offset1:113
    ds_read2_b32 v[98:99], v40 offset0:114 offset1:115
    ds_read_b128 v[132:135], v44 offset:3008
    ds_read2_b32 v[100:101], v41 offset0:112 offset1:113
    ds_read2_b32 v[102:103], v41 offset0:114 offset1:115
    ds_read_b128 v[136:139], v44 offset:3520
    ds_read2_b32 v[104:105], v42 offset0:112 offset1:113
    ds_read2_b32 v[106:107], v42 offset0:114 offset1:115
    ds_read_b128 v[140:143], v44 offset:4032
    ds_read2_b32 v[108:109], v43 offset0:112 offset1:113
    ds_read2_b32 v[110:111], v43 offset0:114 offset1:115
    s_waitcnt lgkmcnt(0)
    v_mfma_f32_16x16x32_bf16 v[48:51], v[80:83], v[112:115], 0
    ds_read_b128 v[176:179], v44 offset:384
    v_mfma_f32_16x16x32_bf16 v[52:55], v[80:83], v[116:119], 0
    ds_read2_b32 v[144:145], v36 offset0:96 offset1:97
    v_mfma_f32_16x16x32_bf16 v[56:59], v[80:83], v[120:123], 0
    ds_read2_b32 v[146:147], v36 offset0:98 offset1:99
    v_mfma_f32_16x16x32_bf16 v[60:63], v[80:83], v[124:127], 0
    ds_read_b128 v[180:183], v44 offset:896
    v_mfma_f32_16x16x32_bf16 v[64:67], v[80:83], v[128:131], 0
    ds_read2_b32 v[148:149], v37 offset0:96 offset1:97
    v_mfma_f32_16x16x32_bf16 v[68:71], v[80:83], v[132:135], 0
    ds_read2_b32 v[150:151], v37 offset0:98 offset1:99
    v_mfma_f32_16x16x32_bf16 v[72:75], v[80:83], v[136:139], 0
    ds_read_b128 v[184:187], v44 offset:1408
    v_mfma_f32_16x16x32_bf16 v[76:79], v[80:83], v[140:143], 0
    ds_read2_b32 v[152:153], v38 offset0:96 offset1:97
    v_mfma_f32_16x16x32_bf16 v[52:55], v[84:87], v[112:115], v[52:55]
    ds_read2_b32 v[154:155], v38 offset0:98 offset1:99
    v_mfma_f32_16x16x32_bf16 v[56:59], v[84:87], v[116:119], v[56:59]
    ds_read_b128 v[188:191], v44 offset:1920
    v_mfma_f32_16x16x32_bf16 v[60:63], v[84:87], v[120:123], v[60:63]
    ds_read2_b32 v[156:157], v39 offset0:96 offset1:97
    v_mfma_f32_16x16x32_bf16 v[64:67], v[84:87], v[124:127], v[64:67]
    ds_read2_b32 v[158:159], v39 offset0:98 offset1:99
    v_mfma_f32_16x16x32_bf16 v[68:71], v[84:87], v[128:131], v[68:71]
    ds_read_b128 v[192:195], v44 offset:2432
    v_mfma_f32_16x16x32_bf16 v[72:75], v[84:87], v[132:135], v[72:75]
    ds_read2_b32 v[160:161], v40 offset0:96 offset1:97
    v_mfma_f32_16x16x32_bf16 v[76:79], v[84:87], v[136:139], v[76:79]
    ds_read2_b32 v[162:163], v40 offset0:98 offset1:99
    v_mfma_f32_16x16x32_bf16 v[56:59], v[88:91], v[112:115], v[56:59]
    ds_read_b128 v[196:199], v44 offset:2944
    v_mfma_f32_16x16x32_bf16 v[60:63], v[88:91], v[116:119], v[60:63]
    ds_read2_b32 v[164:165], v41 offset0:96 offset1:97
    v_mfma_f32_16x16x32_bf16 v[64:67], v[88:91], v[120:123], v[64:67]
    ds_read2_b32 v[166:167], v41 offset0:98 offset1:99
    v_mfma_f32_16x16x32_bf16 v[68:71], v[88:91], v[124:127], v[68:71]
    ds_read_b128 v[200:203], v44 offset:3456
    v_mfma_f32_16x16x32_bf16 v[72:75], v[88:91], v[128:131], v[72:75]
    ds_read2_b32 v[168:169], v42 offset0:96 offset1:97
    v_mfma_f32_16x16x32_bf16 v[76:79], v[88:91], v[132:135], v[76:79]
    ds_read2_b32 v[170:171], v42 offset0:98 offset1:99
    v_mfma_f32_16x16x32_bf16 v[60:63], v[92:95], v[112:115], v[60:63]
    ds_read_b128 v[204:207], v44 offset:3968
    v_mfma_f32_16x16x32_bf16 v[64:67], v[92:95], v[116:119], v[64:67]
    ds_read2_b32 v[172:173], v43 offset0:96 offset1:97
    v_mfma_f32_16x16x32_bf16 v[68:71], v[92:95], v[120:123], v[68:71]
    ds_read2_b32 v[174:175], v43 offset0:98 offset1:99
    v_mfma_f32_16x16x32_bf16 v[72:75], v[92:95], v[124:127], v[72:75]
    v_mfma_f32_16x16x32_bf16 v[76:79], v[92:95], v[128:131], v[76:79]
    v_mfma_f32_16x16x32_bf16 v[64:67], v[96:99], v[112:115], v[64:67]
    v_mfma_f32_16x16x32_bf16 v[68:71], v[96:99], v[116:119], v[68:71]
    v_mfma_f32_16x16x32_bf16 v[72:75], v[96:99], v[120:123], v[72:75]
    v_mfma_f32_16x16x32_bf16 v[76:79], v[96:99], v[124:127], v[76:79]
    v_mfma_f32_16x16x32_bf16 v[68:71], v[100:103], v[112:115], v[68:71]
    v_mfma_f32_16x16x32_bf16 v[72:75], v[100:103], v[116:119], v[72:75]
    v_mfma_f32_16x16x32_bf16 v[76:79], v[100:103], v[120:123], v[76:79]
    v_mfma_f32_16x16x32_bf16 v[72:75], v[104:107], v[112:115], v[72:75]
    v_mfma_f32_16x16x32_bf16 v[76:79], v[104:107], v[116:119], v[76:79]
    v_mfma_f32_16x16x32_bf16 v[76:79], v[108:111], v[112:115], v[76:79]
    s_waitcnt lgkmcnt(0)
    v_mfma_f32_16x16x32_bf16 v[48:51], v[144:147], v[176:179], v[48:51]
    ds_read_b128 v[112:115], v44 offset:320
    v_mfma_f32_16x16x32_bf16 v[52:55], v[144:147], v[180:183], v[52:55]
    ds_read2_b32 v[80:81], v36 offset0:80 offset1:81
    v_mfma_f32_16x16x32_bf16 v[56:59], v[144:147], v[184:187], v[56:59]
    ds_read2_b32 v[82:83], v36 offset0:82 offset1:83
    v_mfma_f32_16x16x32_bf16 v[60:63], v[144:147], v[188:191], v[60:63]
    ds_read_b128 v[116:119], v44 offset:832
    v_mfma_f32_16x16x32_bf16 v[64:67], v[144:147], v[192:195], v[64:67]
    ds_read2_b32 v[84:85], v37 offset0:80 offset1:81
    v_mfma_f32_16x16x32_bf16 v[68:71], v[144:147], v[196:199], v[68:71]
    ds_read2_b32 v[86:87], v37 offset0:82 offset1:83
    v_mfma_f32_16x16x32_bf16 v[72:75], v[144:147], v[200:203], v[72:75]
    ds_read_b128 v[120:123], v44 offset:1344
    v_mfma_f32_16x16x32_bf16 v[76:79], v[144:147], v[204:207], v[76:79]
    ds_read2_b32 v[88:89], v38 offset0:80 offset1:81
    v_mfma_f32_16x16x32_bf16 v[52:55], v[148:151], v[176:179], v[52:55]
    ds_read2_b32 v[90:91], v38 offset0:82 offset1:83
    v_mfma_f32_16x16x32_bf16 v[56:59], v[148:151], v[180:183], v[56:59]
    ds_read_b128 v[124:127], v44 offset:1856
    v_mfma_f32_16x16x32_bf16 v[60:63], v[148:151], v[184:187], v[60:63]
    ds_read2_b32 v[92:93], v39 offset0:80 offset1:81
    v_mfma_f32_16x16x32_bf16 v[64:67], v[148:151], v[188:191], v[64:67]
    ds_read2_b32 v[94:95], v39 offset0:82 offset1:83
    v_mfma_f32_16x16x32_bf16 v[68:71], v[148:151], v[192:195], v[68:71]
    ds_read_b128 v[128:131], v44 offset:2368
    v_mfma_f32_16x16x32_bf16 v[72:75], v[148:151], v[196:199], v[72:75]
    ds_read2_b32 v[96:97], v40 offset0:80 offset1:81
    v_mfma_f32_16x16x32_bf16 v[76:79], v[148:151], v[200:203], v[76:79]
    ds_read2_b32 v[98:99], v40 offset0:82 offset1:83
    v_mfma_f32_16x16x32_bf16 v[56:59], v[152:155], v[176:179], v[56:59]
    ds_read_b128 v[132:135], v44 offset:2880
    v_mfma_f32_16x16x32_bf16 v[60:63], v[152:155], v[180:183], v[60:63]
    ds_read2_b32 v[100:101], v41 offset0:80 offset1:81
    v_mfma_f32_16x16x32_bf16 v[64:67], v[152:155], v[184:187], v[64:67]
    ds_read2_b32 v[102:103], v41 offset0:82 offset1:83
    v_mfma_f32_16x16x32_bf16 v[68:71], v[152:155], v[188:191], v[68:71]
    ds_read_b128 v[136:139], v44 offset:3392
    v_mfma_f32_16x16x32_bf16 v[72:75], v[152:155], v[192:195], v[72:75]
    ds_read2_b32 v[104:105], v42 offset0:80 offset1:81
    v_mfma_f32_16x16x32_bf16 v[76:79], v[152:155], v[196:199], v[76:79]
    ds_read2_b32 v[106:107], v42 offset0:82 offset1:83
    v_mfma_f32_16x16x32_bf16 v[60:63], v[156:159], v[176:179], v[60:63]
    ds_read_b128 v[140:143], v44 offset:3904
    v_mfma_f32_16x16x32_bf16 v[64:67], v[156:159], v[180:183], v[64:67]
    ds_read2_b32 v[108:109], v43 offset0:80 offset1:81
    v_mfma_f32_16x16x32_bf16 v[68:71], v[156:159], v[184:187], v[68:71]
    ds_read2_b32 v[110:111], v43 offset0:82 offset1:83
    v_mfma_f32_16x16x32_bf16 v[72:75], v[156:159], v[188:191], v[72:75]
    v_mfma_f32_16x16x32_bf16 v[76:79], v[156:159], v[192:195], v[76:79]
    v_mfma_f32_16x16x32_bf16 v[64:67], v[160:163], v[176:179], v[64:67]
    v_mfma_f32_16x16x32_bf16 v[68:71], v[160:163], v[180:183], v[68:71]
    v_mfma_f32_16x16x32_bf16 v[72:75], v[160:163], v[184:187], v[72:75]
    v_mfma_f32_16x16x32_bf16 v[76:79], v[160:163], v[188:191], v[76:79]
    v_mfma_f32_16x16x32_bf16 v[68:71], v[164:167], v[176:179], v[68:71]
    v_mfma_f32_16x16x32_bf16 v[72:75], v[164:167], v[180:183], v[72:75]
    v_mfma_f32_16x16x32_bf16 v[76:79], v[164:167], v[184:187], v[76:79]
    v_mfma_f32_16x16x32_bf16 v[72:75], v[168:171], v[176:179], v[72:75]
    v_mfma_f32_16x16x32_bf16 v[76:79], v[168:171], v[180:183], v[76:79]
    v_mfma_f32_16x16x32_bf16 v[76:79], v[172:175], v[176:179], v[76:79]
    s_waitcnt lgkmcnt(0)
    v_mfma_f32_16x16x32_bf16 v[48:51], v[80:83], v[112:115], v[48:51]
    ds_read_b128 v[176:179], v44 offset:256
    v_mfma_f32_16x16x32_bf16 v[52:55], v[80:83], v[116:119], v[52:55]
    ds_read2_b32 v[144:145], v36 offset0:64 offset1:65
    v_mfma_f32_16x16x32_bf16 v[56:59], v[80:83], v[120:123], v[56:59]
    ds_read2_b32 v[146:147], v36 offset0:66 offset1:67
    v_mfma_f32_16x16x32_bf16 v[60:63], v[80:83], v[124:127], v[60:63]
    ds_read_b128 v[180:183], v44 offset:768
    v_mfma_f32_16x16x32_bf16 v[64:67], v[80:83], v[128:131], v[64:67]
    ds_read2_b32 v[148:149], v37 offset0:64 offset1:65
    v_mfma_f32_16x16x32_bf16 v[68:71], v[80:83], v[132:135], v[68:71]
    ds_read2_b32 v[150:151], v37 offset0:66 offset1:67
    v_mfma_f32_16x16x32_bf16 v[72:75], v[80:83], v[136:139], v[72:75]
    ds_read_b128 v[184:187], v44 offset:1280
    v_mfma_f32_16x16x32_bf16 v[76:79], v[80:83], v[140:143], v[76:79]
    ds_read2_b32 v[152:153], v38 offset0:64 offset1:65
    v_mfma_f32_16x16x32_bf16 v[52:55], v[84:87], v[112:115], v[52:55]
    ds_read2_b32 v[154:155], v38 offset0:66 offset1:67
    v_mfma_f32_16x16x32_bf16 v[56:59], v[84:87], v[116:119], v[56:59]
    ds_read_b128 v[188:191], v44 offset:1792
    v_mfma_f32_16x16x32_bf16 v[60:63], v[84:87], v[120:123], v[60:63]
    ds_read2_b32 v[156:157], v39 offset0:64 offset1:65
    v_mfma_f32_16x16x32_bf16 v[64:67], v[84:87], v[124:127], v[64:67]
    ds_read2_b32 v[158:159], v39 offset0:66 offset1:67
    v_mfma_f32_16x16x32_bf16 v[68:71], v[84:87], v[128:131], v[68:71]
    ds_read_b128 v[192:195], v44 offset:2304
    v_mfma_f32_16x16x32_bf16 v[72:75], v[84:87], v[132:135], v[72:75]
    ds_read2_b32 v[160:161], v40 offset0:64 offset1:65
    v_mfma_f32_16x16x32_bf16 v[76:79], v[84:87], v[136:139], v[76:79]
    ds_read2_b32 v[162:163], v40 offset0:66 offset1:67
    v_mfma_f32_16x16x32_bf16 v[56:59], v[88:91], v[112:115], v[56:59]
    ds_read_b128 v[196:199], v44 offset:2816
    v_mfma_f32_16x16x32_bf16 v[60:63], v[88:91], v[116:119], v[60:63]
    ds_read2_b32 v[164:165], v41 offset0:64 offset1:65
    v_mfma_f32_16x16x32_bf16 v[64:67], v[88:91], v[120:123], v[64:67]
    ds_read2_b32 v[166:167], v41 offset0:66 offset1:67
    v_mfma_f32_16x16x32_bf16 v[68:71], v[88:91], v[124:127], v[68:71]
    ds_read_b128 v[200:203], v44 offset:3328
    v_mfma_f32_16x16x32_bf16 v[72:75], v[88:91], v[128:131], v[72:75]
    ds_read2_b32 v[168:169], v42 offset0:64 offset1:65
    v_mfma_f32_16x16x32_bf16 v[76:79], v[88:91], v[132:135], v[76:79]
    ds_read2_b32 v[170:171], v42 offset0:66 offset1:67
    v_mfma_f32_16x16x32_bf16 v[60:63], v[92:95], v[112:115], v[60:63]
    ds_read_b128 v[204:207], v44 offset:3840
    v_mfma_f32_16x16x32_bf16 v[64:67], v[92:95], v[116:119], v[64:67]
    ds_read2_b32 v[172:173], v43 offset0:64 offset1:65
    v_mfma_f32_16x16x32_bf16 v[68:71], v[92:95], v[120:123], v[68:71]
    ds_read2_b32 v[174:175], v43 offset0:66 offset1:67
    v_mfma_f32_16x16x32_bf16 v[72:75], v[92:95], v[124:127], v[72:75]
    v_mfma_f32_16x16x32_bf16 v[76:79], v[92:95], v[128:131], v[76:79]
    v_mfma_f32_16x16x32_bf16 v[64:67], v[96:99], v[112:115], v[64:67]
    v_mfma_f32_16x16x32_bf16 v[68:71], v[96:99], v[116:119], v[68:71]
    v_mfma_f32_16x16x32_bf16 v[72:75], v[96:99], v[120:123], v[72:75]
    v_mfma_f32_16x16x32_bf16 v[76:79], v[96:99], v[124:127], v[76:79]
    v_mfma_f32_16x16x32_bf16 v[68:71], v[100:103], v[112:115], v[68:71]
    v_mfma_f32_16x16x32_bf16 v[72:75], v[100:103], v[116:119], v[72:75]
    v_mfma_f32_16x16x32_bf16 v[76:79], v[100:103], v[120:123], v[76:79]
    v_mfma_f32_16x16x32_bf16 v[72:75], v[104:107], v[112:115], v[72:75]
    v_mfma_f32_16x16x32_bf16 v[76:79], v[104:107], v[116:119], v[76:79]
    v_mfma_f32_16x16x32_bf16 v[76:79], v[108:111], v[112:115], v[76:79]
    s_waitcnt lgkmcnt(0)
    v_mfma_f32_16x16x32_bf16 v[48:51], v[144:147], v[176:179], v[48:51]
    ds_read_b128 v[112:115], v44 offset:192
    v_mfma_f32_16x16x32_bf16 v[52:55], v[144:147], v[180:183], v[52:55]
    ds_read2_b32 v[80:81], v36 offset0:48 offset1:49
    v_mfma_f32_16x16x32_bf16 v[56:59], v[144:147], v[184:187], v[56:59]
    ds_read2_b32 v[82:83], v36 offset0:50 offset1:51
    v_mfma_f32_16x16x32_bf16 v[60:63], v[144:147], v[188:191], v[60:63]
    ds_read_b128 v[116:119], v44 offset:704
    v_mfma_f32_16x16x32_bf16 v[64:67], v[144:147], v[192:195], v[64:67]
    ds_read2_b32 v[84:85], v37 offset0:48 offset1:49
    v_mfma_f32_16x16x32_bf16 v[68:71], v[144:147], v[196:199], v[68:71]
    ds_read2_b32 v[86:87], v37 offset0:50 offset1:51
    v_mfma_f32_16x16x32_bf16 v[72:75], v[144:147], v[200:203], v[72:75]
    ds_read_b128 v[120:123], v44 offset:1216
    v_mfma_f32_16x16x32_bf16 v[76:79], v[144:147], v[204:207], v[76:79]
    ds_read2_b32 v[88:89], v38 offset0:48 offset1:49
    v_mfma_f32_16x16x32_bf16 v[52:55], v[148:151], v[176:179], v[52:55]
    ds_read2_b32 v[90:91], v38 offset0:50 offset1:51
    v_mfma_f32_16x16x32_bf16 v[56:59], v[148:151], v[180:183], v[56:59]
    ds_read_b128 v[124:127], v44 offset:1728
    v_mfma_f32_16x16x32_bf16 v[60:63], v[148:151], v[184:187], v[60:63]
    ds_read2_b32 v[92:93], v39 offset0:48 offset1:49
    v_mfma_f32_16x16x32_bf16 v[64:67], v[148:151], v[188:191], v[64:67]
    ds_read2_b32 v[94:95], v39 offset0:50 offset1:51
    v_mfma_f32_16x16x32_bf16 v[68:71], v[148:151], v[192:195], v[68:71]
    ds_read_b128 v[128:131], v44 offset:2240
    v_mfma_f32_16x16x32_bf16 v[72:75], v[148:151], v[196:199], v[72:75]
    ds_read2_b32 v[96:97], v40 offset0:48 offset1:49
    v_mfma_f32_16x16x32_bf16 v[76:79], v[148:151], v[200:203], v[76:79]
    ds_read2_b32 v[98:99], v40 offset0:50 offset1:51
    v_mfma_f32_16x16x32_bf16 v[56:59], v[152:155], v[176:179], v[56:59]
    ds_read_b128 v[132:135], v44 offset:2752
    v_mfma_f32_16x16x32_bf16 v[60:63], v[152:155], v[180:183], v[60:63]
    ds_read2_b32 v[100:101], v41 offset0:48 offset1:49
    v_mfma_f32_16x16x32_bf16 v[64:67], v[152:155], v[184:187], v[64:67]
    ds_read2_b32 v[102:103], v41 offset0:50 offset1:51
    v_mfma_f32_16x16x32_bf16 v[68:71], v[152:155], v[188:191], v[68:71]
    ds_read_b128 v[136:139], v44 offset:3264
    v_mfma_f32_16x16x32_bf16 v[72:75], v[152:155], v[192:195], v[72:75]
    ds_read2_b32 v[104:105], v42 offset0:48 offset1:49
    v_mfma_f32_16x16x32_bf16 v[76:79], v[152:155], v[196:199], v[76:79]
    ds_read2_b32 v[106:107], v42 offset0:50 offset1:51
    v_mfma_f32_16x16x32_bf16 v[60:63], v[156:159], v[176:179], v[60:63]
    ds_read_b128 v[140:143], v44 offset:3776
    v_mfma_f32_16x16x32_bf16 v[64:67], v[156:159], v[180:183], v[64:67]
    ds_read2_b32 v[108:109], v43 offset0:48 offset1:49
    v_mfma_f32_16x16x32_bf16 v[68:71], v[156:159], v[184:187], v[68:71]
    ds_read2_b32 v[110:111], v43 offset0:50 offset1:51
    v_mfma_f32_16x16x32_bf16 v[72:75], v[156:159], v[188:191], v[72:75]
    v_mfma_f32_16x16x32_bf16 v[76:79], v[156:159], v[192:195], v[76:79]
    v_mfma_f32_16x16x32_bf16 v[64:67], v[160:163], v[176:179], v[64:67]
    v_mfma_f32_16x16x32_bf16 v[68:71], v[160:163], v[180:183], v[68:71]
    v_mfma_f32_16x16x32_bf16 v[72:75], v[160:163], v[184:187], v[72:75]
    v_mfma_f32_16x16x32_bf16 v[76:79], v[160:163], v[188:191], v[76:79]
    v_mfma_f32_16x16x32_bf16 v[68:71], v[164:167], v[176:179], v[68:71]
    v_mfma_f32_16x16x32_bf16 v[72:75], v[164:167], v[180:183], v[72:75]
    v_mfma_f32_16x16x32_bf16 v[76:79], v[164:167], v[184:187], v[76:79]
    v_mfma_f32_16x16x32_bf16 v[72:75], v[168:171], v[176:179], v[72:75]
    v_mfma_f32_16x16x32_bf16 v[76:79], v[168:171], v[180:183], v[76:79]
    v_mfma_f32_16x16x32_bf16 v[76:79], v[172:175], v[176:179], v[76:79]
    s_waitcnt lgkmcnt(0)
    v_mfma_f32_16x16x32_bf16 v[48:51], v[80:83], v[112:115], v[48:51]
    ds_read_b128 v[176:179], v44 offset:128
    v_mfma_f32_16x16x32_bf16 v[52:55], v[80:83], v[116:119], v[52:55]
    ds_read2_b32 v[144:145], v36 offset0:32 offset1:33
    v_mfma_f32_16x16x32_bf16 v[56:59], v[80:83], v[120:123], v[56:59]
    ds_read2_b32 v[146:147], v36 offset0:34 offset1:35
    v_mfma_f32_16x16x32_bf16 v[60:63], v[80:83], v[124:127], v[60:63]
    ds_read_b128 v[180:183], v44 offset:640
    v_mfma_f32_16x16x32_bf16 v[64:67], v[80:83], v[128:131], v[64:67]
    ds_read2_b32 v[148:149], v37 offset0:32 offset1:33
    v_mfma_f32_16x16x32_bf16 v[68:71], v[80:83], v[132:135], v[68:71]
    ds_read2_b32 v[150:151], v37 offset0:34 offset1:35
    v_mfma_f32_16x16x32_bf16 v[72:75], v[80:83], v[136:139], v[72:75]
    ds_read_b128 v[184:187], v44 offset:1152
    v_mfma_f32_16x16x32_bf16 v[76:79], v[80:83], v[140:143], v[76:79]
    ds_read2_b32 v[152:153], v38 offset0:32 offset1:33
    v_mfma_f32_16x16x32_bf16 v[52:55], v[84:87], v[112:115], v[52:55]
    ds_read2_b32 v[154:155], v38 offset0:34 offset1:35
    v_mfma_f32_16x16x32_bf16 v[56:59], v[84:87], v[116:119], v[56:59]
    ds_read_b128 v[188:191], v44 offset:1664
    v_mfma_f32_16x16x32_bf16 v[60:63], v[84:87], v[120:123], v[60:63]
    ds_read2_b32 v[156:157], v39 offset0:32 offset1:33
    v_mfma_f32_16x16x32_bf16 v[64:67], v[84:87], v[124:127], v[64:67]
    ds_read2_b32 v[158:159], v39 offset0:34 offset1:35
    v_mfma_f32_16x16x32_bf16 v[68:71], v[84:87], v[128:131], v[68:71]
    ds_read_b128 v[192:195], v44 offset:2176
    v_mfma_f32_16x16x32_bf16 v[72:75], v[84:87], v[132:135], v[72:75]
    ds_read2_b32 v[160:161], v40 offset0:32 offset1:33
    v_mfma_f32_16x16x32_bf16 v[76:79], v[84:87], v[136:139], v[76:79]
    ds_read2_b32 v[162:163], v40 offset0:34 offset1:35
    v_mfma_f32_16x16x32_bf16 v[56:59], v[88:91], v[112:115], v[56:59]
    ds_read_b128 v[196:199], v44 offset:2688
    v_mfma_f32_16x16x32_bf16 v[60:63], v[88:91], v[116:119], v[60:63]
    ds_read2_b32 v[164:165], v41 offset0:32 offset1:33
    v_mfma_f32_16x16x32_bf16 v[64:67], v[88:91], v[120:123], v[64:67]
    ds_read2_b32 v[166:167], v41 offset0:34 offset1:35
    v_mfma_f32_16x16x32_bf16 v[68:71], v[88:91], v[124:127], v[68:71]
    ds_read_b128 v[200:203], v44 offset:3200
    v_mfma_f32_16x16x32_bf16 v[72:75], v[88:91], v[128:131], v[72:75]
    ds_read2_b32 v[168:169], v42 offset0:32 offset1:33
    v_mfma_f32_16x16x32_bf16 v[76:79], v[88:91], v[132:135], v[76:79]
    ds_read2_b32 v[170:171], v42 offset0:34 offset1:35
    v_mfma_f32_16x16x32_bf16 v[60:63], v[92:95], v[112:115], v[60:63]
    ds_read_b128 v[204:207], v44 offset:3712
    v_mfma_f32_16x16x32_bf16 v[64:67], v[92:95], v[116:119], v[64:67]
    ds_read2_b32 v[172:173], v43 offset0:32 offset1:33
    v_mfma_f32_16x16x32_bf16 v[68:71], v[92:95], v[120:123], v[68:71]
    ds_read2_b32 v[174:175], v43 offset0:34 offset1:35
    v_mfma_f32_16x16x32_bf16 v[72:75], v[92:95], v[124:127], v[72:75]
    v_mfma_f32_16x16x32_bf16 v[76:79], v[92:95], v[128:131], v[76:79]
    v_mfma_f32_16x16x32_bf16 v[64:67], v[96:99], v[112:115], v[64:67]
    v_mfma_f32_16x16x32_bf16 v[68:71], v[96:99], v[116:119], v[68:71]
    v_mfma_f32_16x16x32_bf16 v[72:75], v[96:99], v[120:123], v[72:75]
    v_mfma_f32_16x16x32_bf16 v[76:79], v[96:99], v[124:127], v[76:79]
    v_mfma_f32_16x16x32_bf16 v[68:71], v[100:103], v[112:115], v[68:71]
    v_mfma_f32_16x16x32_bf16 v[72:75], v[100:103], v[116:119], v[72:75]
    v_mfma_f32_16x16x32_bf16 v[76:79], v[100:103], v[120:123], v[76:79]
    v_mfma_f32_16x16x32_bf16 v[72:75], v[104:107], v[112:115], v[72:75]
    v_mfma_f32_16x16x32_bf16 v[76:79], v[104:107], v[116:119], v[76:79]
    v_mfma_f32_16x16x32_bf16 v[76:79], v[108:111], v[112:115], v[76:79]
    s_waitcnt lgkmcnt(0)
    v_mfma_f32_16x16x32_bf16 v[48:51], v[144:147], v[176:179], v[48:51]
    ds_read_b128 v[112:115], v44 offset:64
    v_mfma_f32_16x16x32_bf16 v[52:55], v[144:147], v[180:183], v[52:55]
    ds_read2_b32 v[80:81], v36 offset0:16 offset1:17
    v_mfma_f32_16x16x32_bf16 v[56:59], v[144:147], v[184:187], v[56:59]
    ds_read2_b32 v[82:83], v36 offset0:18 offset1:19
    v_mfma_f32_16x16x32_bf16 v[60:63], v[144:147], v[188:191], v[60:63]
    ds_read_b128 v[116:119], v44 offset:576
    v_mfma_f32_16x16x32_bf16 v[64:67], v[144:147], v[192:195], v[64:67]
    ds_read2_b32 v[84:85], v37 offset0:16 offset1:17
    v_mfma_f32_16x16x32_bf16 v[68:71], v[144:147], v[196:199], v[68:71]
    ds_read2_b32 v[86:87], v37 offset0:18 offset1:19
    v_mfma_f32_16x16x32_bf16 v[72:75], v[144:147], v[200:203], v[72:75]
    ds_read_b128 v[120:123], v44 offset:1088
    v_mfma_f32_16x16x32_bf16 v[76:79], v[144:147], v[204:207], v[76:79]
    ds_read2_b32 v[88:89], v38 offset0:16 offset1:17
    v_mfma_f32_16x16x32_bf16 v[52:55], v[148:151], v[176:179], v[52:55]
    ds_read2_b32 v[90:91], v38 offset0:18 offset1:19
    v_mfma_f32_16x16x32_bf16 v[56:59], v[148:151], v[180:183], v[56:59]
    ds_read_b128 v[124:127], v44 offset:1600
    v_mfma_f32_16x16x32_bf16 v[60:63], v[148:151], v[184:187], v[60:63]
    ds_read2_b32 v[92:93], v39 offset0:16 offset1:17
    v_mfma_f32_16x16x32_bf16 v[64:67], v[148:151], v[188:191], v[64:67]
    ds_read2_b32 v[94:95], v39 offset0:18 offset1:19
    v_mfma_f32_16x16x32_bf16 v[68:71], v[148:151], v[192:195], v[68:71]
    ds_read_b128 v[128:131], v44 offset:2112
    v_mfma_f32_16x16x32_bf16 v[72:75], v[148:151], v[196:199], v[72:75]
    ds_read2_b32 v[96:97], v40 offset0:16 offset1:17
    v_mfma_f32_16x16x32_bf16 v[76:79], v[148:151], v[200:203], v[76:79]
    ds_read2_b32 v[98:99], v40 offset0:18 offset1:19
    v_mfma_f32_16x16x32_bf16 v[56:59], v[152:155], v[176:179], v[56:59]
    ds_read_b128 v[132:135], v44 offset:2624
    v_mfma_f32_16x16x32_bf16 v[60:63], v[152:155], v[180:183], v[60:63]
    ds_read2_b32 v[100:101], v41 offset0:16 offset1:17
    v_mfma_f32_16x16x32_bf16 v[64:67], v[152:155], v[184:187], v[64:67]
    ds_read2_b32 v[102:103], v41 offset0:18 offset1:19
    v_mfma_f32_16x16x32_bf16 v[68:71], v[152:155], v[188:191], v[68:71]
    ds_read_b128 v[136:139], v44 offset:3136
    v_mfma_f32_16x16x32_bf16 v[72:75], v[152:155], v[192:195], v[72:75]
    ds_read2_b32 v[104:105], v42 offset0:16 offset1:17
    v_mfma_f32_16x16x32_bf16 v[76:79], v[152:155], v[196:199], v[76:79]
    ds_read2_b32 v[106:107], v42 offset0:18 offset1:19
    v_mfma_f32_16x16x32_bf16 v[60:63], v[156:159], v[176:179], v[60:63]
    ds_read_b128 v[140:143], v44 offset:3648
    v_mfma_f32_16x16x32_bf16 v[64:67], v[156:159], v[180:183], v[64:67]
    ds_read2_b32 v[108:109], v43 offset0:16 offset1:17
    v_mfma_f32_16x16x32_bf16 v[68:71], v[156:159], v[184:187], v[68:71]
    ds_read2_b32 v[110:111], v43 offset0:18 offset1:19
    v_mfma_f32_16x16x32_bf16 v[72:75], v[156:159], v[188:191], v[72:75]
    v_mfma_f32_16x16x32_bf16 v[76:79], v[156:159], v[192:195], v[76:79]
    v_mfma_f32_16x16x32_bf16 v[64:67], v[160:163], v[176:179], v[64:67]
    v_mfma_f32_16x16x32_bf16 v[68:71], v[160:163], v[180:183], v[68:71]
    v_mfma_f32_16x16x32_bf16 v[72:75], v[160:163], v[184:187], v[72:75]
    v_mfma_f32_16x16x32_bf16 v[76:79], v[160:163], v[188:191], v[76:79]
    v_mfma_f32_16x16x32_bf16 v[68:71], v[164:167], v[176:179], v[68:71]
    v_mfma_f32_16x16x32_bf16 v[72:75], v[164:167], v[180:183], v[72:75]
    v_mfma_f32_16x16x32_bf16 v[76:79], v[164:167], v[184:187], v[76:79]
    v_mfma_f32_16x16x32_bf16 v[72:75], v[168:171], v[176:179], v[72:75]
    v_mfma_f32_16x16x32_bf16 v[76:79], v[168:171], v[180:183], v[76:79]
    v_mfma_f32_16x16x32_bf16 v[76:79], v[172:175], v[176:179], v[76:79]
    s_waitcnt lgkmcnt(0)
    v_mfma_f32_16x16x32_bf16 v[48:51], v[80:83], v[112:115], v[48:51]
    ds_read_b128 v[176:179], v44 offset:0
    v_mfma_f32_16x16x32_bf16 v[52:55], v[80:83], v[116:119], v[52:55]
    ds_read2_b32 v[144:145], v36 offset0:0 offset1:1
    v_mfma_f32_16x16x32_bf16 v[56:59], v[80:83], v[120:123], v[56:59]
    ds_read2_b32 v[146:147], v36 offset0:2 offset1:3
    v_mfma_f32_16x16x32_bf16 v[60:63], v[80:83], v[124:127], v[60:63]
    ds_read_b128 v[180:183], v44 offset:512
    v_mfma_f32_16x16x32_bf16 v[64:67], v[80:83], v[128:131], v[64:67]
    ds_read2_b32 v[148:149], v37 offset0:0 offset1:1
    v_mfma_f32_16x16x32_bf16 v[68:71], v[80:83], v[132:135], v[68:71]
    ds_read2_b32 v[150:151], v37 offset0:2 offset1:3
    v_mfma_f32_16x16x32_bf16 v[72:75], v[80:83], v[136:139], v[72:75]
    ds_read_b128 v[184:187], v44 offset:1024
    v_mfma_f32_16x16x32_bf16 v[76:79], v[80:83], v[140:143], v[76:79]
    ds_read2_b32 v[152:153], v38 offset0:0 offset1:1
    v_mfma_f32_16x16x32_bf16 v[52:55], v[84:87], v[112:115], v[52:55]
    ds_read2_b32 v[154:155], v38 offset0:2 offset1:3
    v_mfma_f32_16x16x32_bf16 v[56:59], v[84:87], v[116:119], v[56:59]
    ds_read_b128 v[188:191], v44 offset:1536
    v_mfma_f32_16x16x32_bf16 v[60:63], v[84:87], v[120:123], v[60:63]
    ds_read2_b32 v[156:157], v39 offset0:0 offset1:1
    v_mfma_f32_16x16x32_bf16 v[64:67], v[84:87], v[124:127], v[64:67]
    ds_read2_b32 v[158:159], v39 offset0:2 offset1:3
    v_mfma_f32_16x16x32_bf16 v[68:71], v[84:87], v[128:131], v[68:71]
    ds_read_b128 v[192:195], v44 offset:2048
    v_mfma_f32_16x16x32_bf16 v[72:75], v[84:87], v[132:135], v[72:75]
    ds_read2_b32 v[160:161], v40 offset0:0 offset1:1
    v_mfma_f32_16x16x32_bf16 v[76:79], v[84:87], v[136:139], v[76:79]
    ds_read2_b32 v[162:163], v40 offset0:2 offset1:3
    v_mfma_f32_16x16x32_bf16 v[56:59], v[88:91], v[112:115], v[56:59]
    ds_read_b128 v[196:199], v44 offset:2560
    v_mfma_f32_16x16x32_bf16 v[60:63], v[88:91], v[116:119], v[60:63]
    ds_read2_b32 v[164:165], v41 offset0:0 offset1:1
    v_mfma_f32_16x16x32_bf16 v[64:67], v[88:91], v[120:123], v[64:67]
    ds_read2_b32 v[166:167], v41 offset0:2 offset1:3
    v_mfma_f32_16x16x32_bf16 v[68:71], v[88:91], v[124:127], v[68:71]
    ds_read_b128 v[200:203], v44 offset:3072
    v_mfma_f32_16x16x32_bf16 v[72:75], v[88:91], v[128:131], v[72:75]
    ds_read2_b32 v[168:169], v42 offset0:0 offset1:1
    v_mfma_f32_16x16x32_bf16 v[76:79], v[88:91], v[132:135], v[76:79]
    ds_read2_b32 v[170:171], v42 offset0:2 offset1:3
    v_mfma_f32_16x16x32_bf16 v[60:63], v[92:95], v[112:115], v[60:63]
    ds_read_b128 v[204:207], v44 offset:3584
    v_mfma_f32_16x16x32_bf16 v[64:67], v[92:95], v[116:119], v[64:67]
    ds_read2_b32 v[172:173], v43 offset0:0 offset1:1
    v_mfma_f32_16x16x32_bf16 v[68:71], v[92:95], v[120:123], v[68:71]
    ds_read2_b32 v[174:175], v43 offset0:2 offset1:3
    v_mfma_f32_16x16x32_bf16 v[72:75], v[92:95], v[124:127], v[72:75]
    v_mfma_f32_16x16x32_bf16 v[76:79], v[92:95], v[128:131], v[76:79]
    v_mfma_f32_16x16x32_bf16 v[64:67], v[96:99], v[112:115], v[64:67]
    v_mfma_f32_16x16x32_bf16 v[68:71], v[96:99], v[116:119], v[68:71]
    v_mfma_f32_16x16x32_bf16 v[72:75], v[96:99], v[120:123], v[72:75]
    v_mfma_f32_16x16x32_bf16 v[76:79], v[96:99], v[124:127], v[76:79]
    v_mfma_f32_16x16x32_bf16 v[68:71], v[100:103], v[112:115], v[68:71]
    v_mfma_f32_16x16x32_bf16 v[72:75], v[100:103], v[116:119], v[72:75]
    v_mfma_f32_16x16x32_bf16 v[76:79], v[100:103], v[120:123], v[76:79]
    v_mfma_f32_16x16x32_bf16 v[72:75], v[104:107], v[112:115], v[72:75]
    v_mfma_f32_16x16x32_bf16 v[76:79], v[104:107], v[116:119], v[76:79]
    v_mfma_f32_16x16x32_bf16 v[76:79], v[108:111], v[112:115], v[76:79]
    s_waitcnt lgkmcnt(0)
    v_mfma_f32_16x16x32_bf16 v[48:51], v[144:147], v[176:179], v[48:51]
    v_mfma_f32_16x16x32_bf16 v[52:55], v[144:147], v[180:183], v[52:55]
    v_mfma_f32_16x16x32_bf16 v[56:59], v[144:147], v[184:187], v[56:59]
    v_mfma_f32_16x16x32_bf16 v[60:63], v[144:147], v[188:191], v[60:63]
    v_mfma_f32_16x16x32_bf16 v[64:67], v[144:147], v[192:195], v[64:67]
    v_mfma_f32_16x16x32_bf16 v[68:71], v[144:147], v[196:199], v[68:71]
    v_mfma_f32_16x16x32_bf16 v[72:75], v[144:147], v[200:203], v[72:75]
    v_mfma_f32_16x16x32_bf16 v[76:79], v[144:147], v[204:207], v[76:79]
    v_mfma_f32_16x16x32_bf16 v[52:55], v[148:151], v[176:179], v[52:55]
    v_mfma_f32_16x16x32_bf16 v[56:59], v[148:151], v[180:183], v[56:59]
    v_mfma_f32_16x16x32_bf16 v[60:63], v[148:151], v[184:187], v[60:63]
    v_mfma_f32_16x16x32_bf16 v[64:67], v[148:151], v[188:191], v[64:67]
    v_mfma_f32_16x16x32_bf16 v[68:71], v[148:151], v[192:195], v[68:71]
    v_mfma_f32_16x16x32_bf16 v[72:75], v[148:151], v[196:199], v[72:75]
    v_mfma_f32_16x16x32_bf16 v[76:79], v[148:151], v[200:203], v[76:79]
    v_mfma_f32_16x16x32_bf16 v[56:59], v[152:155], v[176:179], v[56:59]
    v_mfma_f32_16x16x32_bf16 v[60:63], v[152:155], v[180:183], v[60:63]
    v_mfma_f32_16x16x32_bf16 v[64:67], v[152:155], v[184:187], v[64:67]
    v_mfma_f32_16x16x32_bf16 v[68:71], v[152:155], v[188:191], v[68:71]
    v_mfma_f32_16x16x32_bf16 v[72:75], v[152:155], v[192:195], v[72:75]
    v_mfma_f32_16x16x32_bf16 v[76:79], v[152:155], v[196:199], v[76:79]
    v_mfma_f32_16x16x32_bf16 v[60:63], v[156:159], v[176:179], v[60:63]
    v_mfma_f32_16x16x32_bf16 v[64:67], v[156:159], v[180:183], v[64:67]
    v_mfma_f32_16x16x32_bf16 v[68:71], v[156:159], v[184:187], v[68:71]
    v_mfma_f32_16x16x32_bf16 v[72:75], v[156:159], v[188:191], v[72:75]
    v_mfma_f32_16x16x32_bf16 v[76:79], v[156:159], v[192:195], v[76:79]
    v_mfma_f32_16x16x32_bf16 v[64:67], v[160:163], v[176:179], v[64:67]
    v_mfma_f32_16x16x32_bf16 v[68:71], v[160:163], v[180:183], v[68:71]
    v_mfma_f32_16x16x32_bf16 v[72:75], v[160:163], v[184:187], v[72:75]
    v_mfma_f32_16x16x32_bf16 v[76:79], v[160:163], v[188:191], v[76:79]
    v_mfma_f32_16x16x32_bf16 v[68:71], v[164:167], v[176:179], v[68:71]
    v_mfma_f32_16x16x32_bf16 v[72:75], v[164:167], v[180:183], v[72:75]
    v_mfma_f32_16x16x32_bf16 v[76:79], v[164:167], v[184:187], v[76:79]
    v_mfma_f32_16x16x32_bf16 v[72:75], v[168:171], v[176:179], v[72:75]
    v_mfma_f32_16x16x32_bf16 v[76:79], v[168:171], v[180:183], v[76:79]
    v_mfma_f32_16x16x32_bf16 v[76:79], v[172:175], v[176:179], v[76:79]
    s_nop 7
    v_lshlrev_b32 v5, 6, v2
    v_lshl_add_u32 v5, v3, 4, v5
    v_add_u32 v5, v5, v4
    ds_write_b128 v5, v[48:51] offset:7424
    ds_write_b128 v5, v[52:55] offset:8448
    ds_write_b128 v5, v[56:59] offset:9472
    ds_write_b128 v5, v[60:63] offset:10496
    ds_write_b128 v5, v[64:67] offset:11520
    ds_write_b128 v5, v[68:71] offset:12544
    ds_write_b128 v5, v[72:75] offset:13568
    ds_write_b128 v5, v[76:79] offset:14592
    v_mov_b64 v[8:9], v[16:17]
    v_mov_b64 v[10:11], v[18:19]
    v_mov_b64 v[12:13], v[20:21]
    v_mov_b64 v[14:15], v[22:23]
    v_mov_b32 v24, v25
    v_add_u32 v4, 65536, v4
    s_add_u32 s28, s28, 1
    s_cmp_lt_u32 s28, 2
    s_waitcnt lgkmcnt(0)
    s_cbranch_scc1 ss_pass
    s_mov_b32 s12, s74
    s_mov_b32 s13, s75
    s_mov_b32 s14, 1152
    s_mov_b32 s15, 0x20000
    s_lshl_b32 s23, s20, 1
    buffer_load_dwordx4 v[8:11], off, s[12:15], s23
    s_barrier
    v_lshlrev_b32 v5, 5, v0
    v_add_u32 v7, 65536, v5
    ds_read_b128 v[64:67], v5 offset:7424
    ds_read_b128 v[68:71], v5 offset:7440
    ds_read_b128 v[72:75], v5 offset:23808
    ds_read_b128 v[76:79], v5 offset:23824
    ds_read_b128 v[80:83], v5 offset:40192
    ds_read_b128 v[84:87], v5 offset:40208
    ds_read_b128 v[88:91], v5 offset:56576
    ds_read_b128 v[92:95], v5 offset:56592
    ds_read_b128 v[96:99], v7 offset:7424
    ds_read_b128 v[100:103], v7 offset:7440
    ds_read_b128 v[104:107], v7 offset:23808
    ds_read_b128 v[108:111], v7 offset:23824
    ds_read_b128 v[112:115], v7 offset:40192
    ds_read_b128 v[116:119], v7 offset:40208
    ds_read_b128 v[120:123], v7 offset:56576
    ds_read_b128 v[124:127], v7 offset:56592
    s_waitcnt vmcnt(0)
    v_lshlrev_b32 v12, 16, v8
    v_and_b32 v13, 0xffff0000, v8
    v_lshlrev_b32 v14, 16, v9
    v_and_b32 v15, 0xffff0000, v9
    v_lshlrev_b32 v16, 16, v10
    v_and_b32 v17, 0xffff0000, v10
    v_lshlrev_b32 v18, 16, v11
    v_and_b32 v19, 0xffff0000, v11
    v_mul_u32_u24 v5, 18432, v0
    s_lshl_b32 s22, s20, 1
    s_add_u32 s22, s22, 1152
    s_waitcnt lgkmcnt(0)
    v_lshlrev_b32 v6, 16, v208
    v_fmac_f32 v64, v6, v12
    v_and_b32 v6, 0xffff0000, v208
    v_fmac_f32 v72, v6, v13
    v_lshlrev_b32 v6, 16, v209
    v_fmac_f32 v80, v6, v14
    v_and_b32 v6, 0xffff0000, v209
    v_fmac_f32 v88, v6, v15
    v_lshlrev_b32 v6, 16, v210
    v_fmac_f32 v96, v6, v16
    v_and_b32 v6, 0xffff0000, v210
    v_fmac_f32 v104, v6, v17
    v_lshlrev_b32 v6, 16, v211
    v_fmac_f32 v112, v6, v18
    v_and_b32 v6, 0xffff0000, v211
    v_fmac_f32 v120, v6, v19
    v_cvt_pk_bf16_f32 v208, v64, v72
    v_cvt_pk_bf16_f32 v209, v80, v88
    v_cvt_pk_bf16_f32 v210, v96, v104
    v_cvt_pk_bf16_f32 v211, v112, v120
    s_add_u32 s23, s22, 0
    buffer_store_dwordx4 v[208:211], v5, s[16:19], s23 offen
    v_lshlrev_b32 v6, 16, v212
    v_fmac_f32 v65, v6, v12
    v_and_b32 v6, 0xffff0000, v212
    v_fmac_f32 v73, v6, v13
    v_lshlrev_b32 v6, 16, v213
    v_fmac_f32 v81, v6, v14
    v_and_b32 v6, 0xffff0000, v213
    v_fmac_f32 v89, v6, v15
    v_lshlrev_b32 v6, 16, v214
    v_fmac_f32 v97, v6, v16
    v_and_b32 v6, 0xffff0000, v214
    v_fmac_f32 v105, v6, v17
    v_lshlrev_b32 v6, 16, v215
    v_fmac_f32 v113, v6, v18
    v_and_b32 v6, 0xffff0000, v215
    v_fmac_f32 v121, v6, v19
    v_cvt_pk_bf16_f32 v212, v65, v73
    v_cvt_pk_bf16_f32 v213, v81, v89
    v_cvt_pk_bf16_f32 v214, v97, v105
    v_cvt_pk_bf16_f32 v215, v113, v121
    s_add_u32 s23, s22, 2304
    buffer_store_dwordx4 v[212:215], v5, s[16:19], s23 offen
    v_lshlrev_b32 v6, 16, v216
    v_fmac_f32 v66, v6, v12
    v_and_b32 v6, 0xffff0000, v216
    v_fmac_f32 v74, v6, v13
    v_lshlrev_b32 v6, 16, v217
    v_fmac_f32 v82, v6, v14
    v_and_b32 v6, 0xffff0000, v217
    v_fmac_f32 v90, v6, v15
    v_lshlrev_b32 v6, 16, v218
    v_fmac_f32 v98, v6, v16
    v_and_b32 v6, 0xffff0000, v218
    v_fmac_f32 v106, v6, v17
    v_lshlrev_b32 v6, 16, v219
    v_fmac_f32 v114, v6, v18
    v_and_b32 v6, 0xffff0000, v219
    v_fmac_f32 v122, v6, v19
    v_cvt_pk_bf16_f32 v216, v66, v74
    v_cvt_pk_bf16_f32 v217, v82, v90
    v_cvt_pk_bf16_f32 v218, v98, v106
    v_cvt_pk_bf16_f32 v219, v114, v122
    s_add_u32 s23, s22, 4608
    buffer_store_dwordx4 v[216:219], v5, s[16:19], s23 offen
    v_lshlrev_b32 v6, 16, v220
    v_fmac_f32 v67, v6, v12
    v_and_b32 v6, 0xffff0000, v220
    v_fmac_f32 v75, v6, v13
    v_lshlrev_b32 v6, 16, v221
    v_fmac_f32 v83, v6, v14
    v_and_b32 v6, 0xffff0000, v221
    v_fmac_f32 v91, v6, v15
    v_lshlrev_b32 v6, 16, v222
    v_fmac_f32 v99, v6, v16
    v_and_b32 v6, 0xffff0000, v222
    v_fmac_f32 v107, v6, v17
    v_lshlrev_b32 v6, 16, v223
    v_fmac_f32 v115, v6, v18
    v_and_b32 v6, 0xffff0000, v223
    v_fmac_f32 v123, v6, v19
    v_cvt_pk_bf16_f32 v220, v67, v75
    v_cvt_pk_bf16_f32 v221, v83, v91
    v_cvt_pk_bf16_f32 v222, v99, v107
    v_cvt_pk_bf16_f32 v223, v115, v123
    s_add_u32 s23, s22, 6912
    buffer_store_dwordx4 v[220:223], v5, s[16:19], s23 offen
    v_lshlrev_b32 v6, 16, v224
    v_fmac_f32 v68, v6, v12
    v_and_b32 v6, 0xffff0000, v224
    v_fmac_f32 v76, v6, v13
    v_lshlrev_b32 v6, 16, v225
    v_fmac_f32 v84, v6, v14
    v_and_b32 v6, 0xffff0000, v225
    v_fmac_f32 v92, v6, v15
    v_lshlrev_b32 v6, 16, v226
    v_fmac_f32 v100, v6, v16
    v_and_b32 v6, 0xffff0000, v226
    v_fmac_f32 v108, v6, v17
    v_lshlrev_b32 v6, 16, v227
    v_fmac_f32 v116, v6, v18
    v_and_b32 v6, 0xffff0000, v227
    v_fmac_f32 v124, v6, v19
    v_cvt_pk_bf16_f32 v224, v68, v76
    v_cvt_pk_bf16_f32 v225, v84, v92
    v_cvt_pk_bf16_f32 v226, v100, v108
    v_cvt_pk_bf16_f32 v227, v116, v124
    s_add_u32 s23, s22, 9216
    buffer_store_dwordx4 v[224:227], v5, s[16:19], s23 offen
    v_lshlrev_b32 v6, 16, v228
    v_fmac_f32 v69, v6, v12
    v_and_b32 v6, 0xffff0000, v228
    v_fmac_f32 v77, v6, v13
    v_lshlrev_b32 v6, 16, v229
    v_fmac_f32 v85, v6, v14
    v_and_b32 v6, 0xffff0000, v229
    v_fmac_f32 v93, v6, v15
    v_lshlrev_b32 v6, 16, v230
    v_fmac_f32 v101, v6, v16
    v_and_b32 v6, 0xffff0000, v230
    v_fmac_f32 v109, v6, v17
    v_lshlrev_b32 v6, 16, v231
    v_fmac_f32 v117, v6, v18
    v_and_b32 v6, 0xffff0000, v231
    v_fmac_f32 v125, v6, v19
    v_cvt_pk_bf16_f32 v228, v69, v77
    v_cvt_pk_bf16_f32 v229, v85, v93
    v_cvt_pk_bf16_f32 v230, v101, v109
    v_cvt_pk_bf16_f32 v231, v117, v125
    s_add_u32 s23, s22, 11520
    buffer_store_dwordx4 v[228:231], v5, s[16:19], s23 offen
    v_lshlrev_b32 v6, 16, v232
    v_fmac_f32 v70, v6, v12
    v_and_b32 v6, 0xffff0000, v232
    v_fmac_f32 v78, v6, v13
    v_lshlrev_b32 v6, 16, v233
    v_fmac_f32 v86, v6, v14
    v_and_b32 v6, 0xffff0000, v233
    v_fmac_f32 v94, v6, v15
    v_lshlrev_b32 v6, 16, v234
    v_fmac_f32 v102, v6, v16
    v_and_b32 v6, 0xffff0000, v234
    v_fmac_f32 v110, v6, v17
    v_lshlrev_b32 v6, 16, v235
    v_fmac_f32 v118, v6, v18
    v_and_b32 v6, 0xffff0000, v235
    v_fmac_f32 v126, v6, v19
    v_cvt_pk_bf16_f32 v232, v70, v78
    v_cvt_pk_bf16_f32 v233, v86, v94
    v_cvt_pk_bf16_f32 v234, v102, v110
    v_cvt_pk_bf16_f32 v235, v118, v126
    s_add_u32 s23, s22, 13824
    buffer_store_dwordx4 v[232:235], v5, s[16:19], s23 offen
    v_lshlrev_b32 v6, 16, v236
    v_fmac_f32 v71, v6, v12
    v_and_b32 v6, 0xffff0000, v236
    v_fmac_f32 v79, v6, v13
    v_lshlrev_b32 v6, 16, v237
    v_fmac_f32 v87, v6, v14
    v_and_b32 v6, 0xffff0000, v237
    v_fmac_f32 v95, v6, v15
    v_lshlrev_b32 v6, 16, v238
    v_fmac_f32 v103, v6, v16
    v_and_b32 v6, 0xffff0000, v238
    v_fmac_f32 v111, v6, v17
    v_lshlrev_b32 v6, 16, v239
    v_fmac_f32 v119, v6, v18
    v_and_b32 v6, 0xffff0000, v239
    v_fmac_f32 v127, v6, v19
    v_cvt_pk_bf16_f32 v236, v71, v79
    v_cvt_pk_bf16_f32 v237, v87, v95
    v_cvt_pk_bf16_f32 v238, v103, v111
    v_cvt_pk_bf16_f32 v239, v119, v127
    s_add_u32 s23, s22, 16128
    buffer_store_dwordx4 v[236:239], v5, s[16:19], s23 offen
    s_branch L_ssm_next
L_ssm_done:
    s_cmp_lt_u32 s93, 100
    s_cbranch_scc1 L_exit
    s_mov_b32 s8, s76
    s_mov_b32 s9, s77
    s_mov_b32 s10, 4718592
    s_mov_b32 s11, 0x20000
    s_cmp_le_u32 s45, 1
    s_cbranch_scc1 L_att_next
    s_branch L_op_nextcb
L_wf_next:
    s_mov_b32 s37, 20
    v_mov_b32 v250, 1
    v_mov_b32 v251, 163832
    v_cmp_eq_u32 vcc, 0, v0
    s_nop 0
    s_and_saveexec_b64 s[38:39], vcc
    s_cbranch_execz tk12
    buffer_atomic_add v250, off, s[84:87], s37 sc0
    s_waitcnt vmcnt(0)
    ds_write_b32 v251, v250
    s_waitcnt lgkmcnt(0)
tk12:
    s_mov_b64 exec, -1
    s_barrier
    ds_read_b32 v252, v251
    s_waitcnt lgkmcnt(0)
    v_readfirstlane_b32 s33, v252
    s_barrier
    s_nop 3
    s_cmp_ge_u32 s33, 160
    s_cbranch_scc1 L_ssm_next
    s_lshl_b32 s16, s33, 2
    s_add_u32 s16, s16, s32
    s_add_u32 s16, s16, 1504
    s_call_b64 s[46:47], L_xform
    s_cmp_lg_u32 s95, 0
    s_cbranch_scc1 L_wfn
    s_mov_b32 s88, 4194304
gn13:
    buffer_load_dword v250, off, s[84:87], 0 offset:216 sc1
    s_waitcnt vmcnt(0)
    v_readfirstlane_b32 s95, v250
    s_sub_u32 s88, s88, 1
    s_cbranch_scc1 gn13x
    s_cmp_eq_u32 s95, 0
    s_cbranch_scc1 gn13
gn13x:
L_wfn:
    s_lshl_b32 s40, s33, 2
    s_add_u32 s40, s40, 125841408
    s_waitcnt vmcnt(0)
    s_barrier
    v_mov_b32 v250, s95
    v_cmp_eq_u32 vcc, 0, v0
    s_nop 0
    s_and_saveexec_b64 s[38:39], vcc
    s_cbranch_execz fs14
    buffer_store_dword v250, off, s[4:7], s40 sc1
fs14:
    s_mov_b64 exec, -1
    s_branch L_wf_next
L_phase2:
    s_mov_b32 s40, 524288
mc2_w:
    buffer_load_dword v250, off, s[84:87], 0 offset:28 sc1
    s_waitcnt vmcnt(0)
    v_readfirstlane_b32 s41, v250
    s_nop 0
    s_cmp_lg_u32 s41, 0
    s_cbranch_scc1 mc2_known
    s_sub_u32 s40, s40, 1
    s_cbranch_scc1 mc2_force
    s_sleep 2
    s_branch mc2_w
mc2_force:
    v_mov_b32 v250, 2
    v_mov_b32 v251, 0
    s_mov_b64 exec, 1
    buffer_atomic_cmpswap v[250:251], off, s[84:87], 0 offset:28
    s_mov_b64 exec, -1
    s_waitcnt vmcnt(0)
    s_mov_b32 s40, 524288
    s_branch mc2_w
mc2_known:
    s_cmp_eq_u32 s41, 1
    s_cbranch_scc1 L_phase2b
    s_mov_b32 s37, 208
    v_mov_b32 v250, 1
    v_mov_b32 v251, 163832
    v_cmp_eq_u32 vcc, 0, v0
    s_nop 0
    s_and_saveexec_b64 s[38:39], vcc
    s_cbranch_execz tk15
    buffer_atomic_add v250, off, s[84:87], s37 sc0
    s_waitcnt vmcnt(0)
    ds_write_b32 v251, v250
    s_waitcnt lgkmcnt(0)
tk15:
    s_mov_b64 exec, -1
    s_barrier
    ds_read_b32 v252, v251
    s_waitcnt lgkmcnt(0)
    v_readfirstlane_b32 s12, v252
    s_barrier
    s_nop 3
    s_cmp_lt_u32 s12, 32
    s_cbranch_scc1 L_chain_safe
    s_sub_u32 s45, s12, 32
L_phase2b:
    s_mov_b32 s8, s76
    s_mov_b32 s9, s77
    s_mov_b32 s10, 4718592
    s_mov_b32 s11, 0x20000
    s_and_b32 s36, s45, 15
    s_bitcmp1_b32 42315, s36
    s_cbranch_scc0 L_nots
    s_cmp_eq_u32 s93, 500
    s_cbranch_scc1 L_ssm_next
    s_branch L_wf_next
L_nots:
    s_bitcmp1_b32 18576, s36
    s_cbranch_scc0 L_att_next
    s_bfm_b32 s37, s36, 0
    s_and_b32 s37, s37, 18576
    s_bcnt1_i32_b32 s37, s37
    s_lshr_b32 s40, s45, 4
    s_mul_i32 s40, s40, 4
    s_add_u32 s33, s40, s37
L_op_mod:
    s_mul_hi_u32 s41, s33, 0x0e38e38f
    s_mul_i32 s41, s41, 18
    s_sub_u32 s33, s33, s41
    s_branch L_op_start
L_att_next:
    s_mov_b32 s37, 16
    v_mov_b32 v250, 1
    v_mov_b32 v251, 163832
    v_cmp_eq_u32 vcc, 0, v0
    s_nop 0
    s_and_saveexec_b64 s[38:39], vcc
    s_cbranch_execz tk16
    buffer_atomic_add v250, off, s[84:87], s37 sc0
    s_waitcnt vmcnt(0)
    ds_write_b32 v251, v250
    s_waitcnt lgkmcnt(0)
tk16:
    s_mov_b64 exec, -1
    s_barrier
    ds_read_b32 v252, v251
    s_waitcnt lgkmcnt(0)
    v_readfirstlane_b32 s34, v252
    s_barrier
    s_nop 3
    s_cmp_ge_u32 s34, 512
    s_cbranch_scc1 L_op_nextcb
    s_lshr_b32 s16, s34, 3
    s_and_b32 s17, s34, 7
    s_lshl_b32 s17, s17, 2
    s_add_u32 s17, s17, s32
    s_lshl_b32 s36, s17, 7
    s_add_u32 s36, s36, 125829120
    s_lshr_b32 s41, s16, 2
    s_add_u32 s41, s41, s95
    s_add_u32 s41, s41, 1
    v_and_b32 v1, 3, v0
    v_min_u32 v1, 2, v1
    v_lshlrev_b32 v2, 4, v1
    s_and_b32 s37, s16, 3
    s_lshl_b32 s37, s37, 2
    v_add_u32 v2, s37, v2
    s_mov_b32 s40, 4194304
L_aw1:
    buffer_load_dword v3, v2, s[4:7], s36 offen sc1
    s_sub_u32 s40, s40, 1
    s_cbranch_scc1 L_aw1_go
    s_waitcnt vmcnt(0)
    v_subrev_u32 v3, s41, v3
    v_cmp_lt_u32 vcc, 64, v3
    s_cbranch_vccz L_aw1_go
    s_sleep 4
    s_branch L_aw1
L_aw1_go:
    v_and_b32 v5, 63, v0
    v_lshlrev_b32 v1, 4, v5
    s_cmp_ge_u32 s16, 56
    s_cselect_b32 s18, -1, 511
    v_and_b32 v2, s18, v1
    v_or_b32 v3, 128, v1
    v_lshrrev_b32 v4, 4, v5
    v_bfe_u32 v6, v5, 2, 2
    v_sub_u32 v4, v6, v4
    v_lshlrev_b32 v4, 3, v4
    v_and_b32 v6, 3, v5
    v_add_u32 v4, v4, v6
    v_mov_b32 v6, 0xf149f2ca
    s_mov_b32 s22, 0x3e0293ee
    s_lshl_b32 s18, s16, 5
    s_add_u32 s18, s18, s17
    s_lshl_b32 s19, s18, 13
    s_add_u32 s20, s19, 33554432
    buffer_load_dwordx4 v[8:11], v1, s[4:7], s20 offen offset:0 sc1
    s_add_u32 s20, s19, 33554432
    buffer_load_dwordx4 v[12:15], v1, s[4:7], s20 offen offset:1024 sc1
    s_add_u32 s20, s19, 33554432
    buffer_load_dwordx4 v[16:19], v1, s[4:7], s20 offen offset:2048 sc1
    s_add_u32 s20, s19, 33554432
    buffer_load_dwordx4 v[20:23], v1, s[4:7], s20 offen offset:3072 sc1
    s_add_u32 s20, s19, 33558528
    buffer_load_dwordx4 v[24:27], v1, s[4:7], s20 offen offset:0 sc1
    s_add_u32 s20, s19, 33558528
    buffer_load_dwordx4 v[28:31], v1, s[4:7], s20 offen offset:1024 sc1
    s_add_u32 s20, s19, 33558528
    buffer_load_dwordx4 v[32:35], v1, s[4:7], s20 offen offset:2048 sc1
    s_add_u32 s20, s19, 33558528
    buffer_load_dwordx4 v[36:39], v1, s[4:7], s20 offen offset:3072 sc1
    s_lshl_b32 s21, s18, 14
    s_add_u32 s20, s21, 0
    buffer_load_dwordx4 v[40:43], v1, s[4:7], s20 offen offset:0 sc1
    s_add_u32 s20, s21, 4096
    buffer_load_dwordx4 v[44:47], v1, s[4:7], s20 offen offset:0 sc1
    s_add_u32 s20, s21, 8192
    buffer_load_dwordx4 v[48:51], v1, s[4:7], s20 offen offset:0 sc1
    s_add_u32 s20, s21, 12288
    buffer_load_dwordx4 v[52:55], v1, s[4:7], s20 offen offset:0 sc1
    s_add_u32 s20, s21, 0
    buffer_load_dwordx4 v[56:59], v1, s[4:7], s20 offen offset:1024 sc1
    s_add_u32 s20, s21, 4096
    buffer_load_dwordx4 v[60:63], v1, s[4:7], s20 offen offset:1024 sc1
    s_add_u32 s20, s21, 8192
    buffer_load_dwordx4 v[64:67], v1, s[4:7], s20 offen offset:1024 sc1
    s_add_u32 s20, s21, 12288
    buffer_load_dwordx4 v[68:71], v1, s[4:7], s20 offen offset:1024 sc1
    s_add_u32 s20, s21, 0
    buffer_load_dwordx4 v[88:91], v1, s[4:7], s20 offen offset:2048 sc1
    s_add_u32 s20, s21, 4096
    buffer_load_dwordx4 v[92:95], v1, s[4:7], s20 offen offset:2048 sc1
    s_add_u32 s20, s21, 8192
    buffer_load_dwordx4 v[96:99], v1, s[4:7], s20 offen offset:2048 sc1
    s_add_u32 s20, s21, 12288
    buffer_load_dwordx4 v[100:103], v1, s[4:7], s20 offen offset:2048 sc1
    s_add_u32 s20, s21, 0
    buffer_load_dwordx4 v[104:107], v1, s[4:7], s20 offen offset:3072 sc1
    s_add_u32 s20, s21, 4096
    buffer_load_dwordx4 v[108:111], v1, s[4:7], s20 offen offset:3072 sc1
    s_add_u32 s20, s21, 8192
    buffer_load_dwordx4 v[112:115], v1, s[4:7], s20 offen offset:3072 sc1
    s_add_u32 s20, s21, 12288
    buffer_load_dwordx4 v[116:119], v1, s[4:7], s20 offen offset:3072 sc1
    v_mov_b32 v172, 0x3f803f80
    v_mov_b32 v173, 0x3f803f80
    v_mov_b32 v174, 0x3f803f80
    v_mov_b32 v175, 0x3f803f80
    v_mov_b32 v176, 0x3f003f00
    v_mov_b32 v177, 0x3f003f00
    s_waitcnt vmcnt(8)
    v_mfma_f32_16x16x32_bf16 v[136:139], v[40:43], v[8:11], 0
    v_mfma_f32_16x16x32_bf16 v[140:143], v[56:59], v[8:11], 0
    v_mfma_f32_16x16x32_bf16 v[148:151], v[40:43], v[24:27], 0
    v_mfma_f32_16x16x32_bf16 v[152:155], v[56:59], v[24:27], 0
    v_mfma_f32_16x16x32_bf16 v[136:139], v[44:47], v[12:15], v[136:139]
    v_mfma_f32_16x16x32_bf16 v[140:143], v[60:63], v[12:15], v[140:143]
    v_mfma_f32_16x16x32_bf16 v[148:151], v[44:47], v[28:31], v[148:151]
    v_mfma_f32_16x16x32_bf16 v[152:155], v[60:63], v[28:31], v[152:155]
    v_mfma_f32_16x16x32_bf16 v[136:139], v[48:51], v[16:19], v[136:139]
    v_mfma_f32_16x16x32_bf16 v[140:143], v[64:67], v[16:19], v[140:143]
    v_mfma_f32_16x16x32_bf16 v[148:151], v[48:51], v[32:35], v[148:151]
    v_mfma_f32_16x16x32_bf16 v[152:155], v[64:67], v[32:35], v[152:155]
    v_mfma_f32_16x16x32_bf16 v[136:139], v[52:55], v[20:23], v[136:139]
    v_mfma_f32_16x16x32_bf16 v[140:143], v[68:71], v[20:23], v[140:143]
    v_mfma_f32_16x16x32_bf16 v[148:151], v[52:55], v[36:39], v[148:151]
    v_mfma_f32_16x16x32_bf16 v[152:155], v[68:71], v[36:39], v[152:155]
    v_cmp_le_i32 vcc, 0, v4
    s_nop 3
    v_cndmask_b32 v136, v6, v136, vcc
    v_cmp_le_i32 vcc, 1, v4
    s_nop 1
    v_cndmask_b32 v137, v6, v137, vcc
    v_cmp_le_i32 vcc, 2, v4
    s_nop 1
    v_cndmask_b32 v138, v6, v138, vcc
    v_cmp_le_i32 vcc, 3, v4
    s_nop 1
    v_cndmask_b32 v139, v6, v139, vcc
    v_cmp_le_i32 vcc, 4, v4
    s_nop 1
    v_cndmask_b32 v140, v6, v140, vcc
    v_cmp_le_i32 vcc, 5, v4
    s_nop 1
    v_cndmask_b32 v141, v6, v141, vcc
    v_cmp_le_i32 vcc, 6, v4
    s_nop 1
    v_cndmask_b32 v142, v6, v142, vcc
    v_cmp_le_i32 vcc, 7, v4
    s_nop 1
    v_cndmask_b32 v143, v6, v143, vcc
    v_cmp_le_i32 vcc, -4, v4
    s_nop 1
    v_cndmask_b32 v148, v6, v148, vcc
    v_cmp_le_i32 vcc, -3, v4
    s_nop 1
    v_cndmask_b32 v149, v6, v149, vcc
    v_cmp_le_i32 vcc, -2, v4
    s_nop 1
    v_cndmask_b32 v150, v6, v150, vcc
    v_cmp_le_i32 vcc, -1, v4
    s_nop 1
    v_cndmask_b32 v151, v6, v151, vcc
    v_cmp_le_i32 vcc, 0, v4
    s_nop 1
    v_cndmask_b32 v152, v6, v152, vcc
    v_cmp_le_i32 vcc, 1, v4
    s_nop 1
    v_cndmask_b32 v153, v6, v153, vcc
    v_cmp_le_i32 vcc, 2, v4
    s_nop 1
    v_cndmask_b32 v154, v6, v154, vcc
    v_cmp_le_i32 vcc, 3, v4
    s_nop 1
    v_cndmask_b32 v155, v6, v155, vcc
    s_nop 1
    v_and_b32 v198, 1, v0
    v_lshlrev_b32 v198, 2, v198
    v_add_u32 v198, 48, v198
    s_add_u32 s41, s16, s95
    s_add_u32 s41, s41, 1
    s_cmp_lt_u32 s16, 56
    s_cbranch_scc1 L_amk
    v_mov_b32 v198, 16384
    s_sub_u32 s41, s41, 1
    s_mov_b32 s44, 8
L_amk:
    s_sub_u32 s43, s41, s95
    s_sub_u32 s43, s43, 1
    s_mov_b32 s88, 65536
    s_mov_b32 s89, 125853696
cw17:
    buffer_load_dword v199, off, s[4:7], s89 sc1
    s_waitcnt vmcnt(0)
    v_readfirstlane_b32 s42, v199
    s_nop 0
    s_sub_u32 s42, s42, s95
    s_cmp_gt_u32 s42, 64
    s_cselect_b32 s42, 0, s42
    s_add_u32 s42, s42, 1
    s_cmp_ge_u32 s42, s43
    s_cbranch_scc1 cw17x
    s_sub_u32 s88, s88, 1
    s_cbranch_scc1 cw17x
    s_sub_u32 s42, s43, s42
    s_min_u32 s42, s42, 6
cw17s:
    s_sleep 24
    s_sub_u32 s42, s42, 1
    s_cmp_lg_u32 s42, 0
    s_cbranch_scc1 cw17s
    s_branch cw17
cw17x:
    s_mov_b32 s40, 4194304
L_aw2:
    buffer_load_dword v199, v198, s[4:7], s36 offen sc1
    s_sub_u32 s40, s40, 1
    s_cbranch_scc1 L_aw2_go
    s_waitcnt vmcnt(0)
    v_subrev_u32 v199, s41, v199
    v_cmp_lt_u32 vcc, 64, v199
    s_cbranch_vccz L_aw2_go
    s_sleep 1
    s_branch L_aw2
L_aw2_go:
at_ldm:
    s_lshl_b32 s20, s18, 12
    s_add_u32 s20, s20, 69206016
    buffer_load_dwordx4 v[72:75], v3, s[4:7], s20 offen offset:0 sc1
    buffer_load_dwordx4 v[76:79], v3, s[4:7], s20 offen offset:1024 sc1
    buffer_load_dwordx4 v[80:83], v3, s[4:7], s20 offen offset:2048 sc1
    buffer_load_dwordx4 v[84:87], v3, s[4:7], s20 offen offset:3072 sc1
    s_lshl_b32 s20, s18, 12
    s_add_u32 s20, s20, 77594624
    buffer_load_dwordx4 v[120:123], v2, s[4:7], s20 offen offset:0 sc1
    buffer_load_dwordx4 v[124:127], v2, s[4:7], s20 offen offset:1024 sc1
    buffer_load_dwordx4 v[128:131], v2, s[4:7], s20 offen offset:2048 sc1
    buffer_load_dwordx4 v[132:135], v2, s[4:7], s20 offen offset:3072 sc1
    s_cmp_lt_u32 s16, 56
    s_cbranch_scc1 at_ok
    s_waitcnt vmcnt(0)
    v_max_u32 v196, v72, v73
    v_max3_u32 v196, v196, v74, v75
    v_max3_u32 v196, v196, v76, v77
    v_max3_u32 v196, v196, v78, v79
    v_max3_u32 v196, v196, v80, v81
    v_max3_u32 v196, v196, v82, v83
    v_max3_u32 v196, v196, v84, v85
    v_max3_u32 v196, v196, v86, v87
    v_max3_u32 v196, v196, v120, v121
    v_max3_u32 v196, v196, v122, v123
    v_max3_u32 v196, v196, v124, v125
    v_max3_u32 v196, v196, v126, v127
    v_max3_u32 v196, v196, v128, v129
    v_max3_u32 v196, v196, v130, v131
    v_max3_u32 v196, v196, v132, v133
    v_max3_u32 v196, v196, v134, v135
    v_cmp_eq_u32 vcc, -1, v196
    s_cbranch_vccz at_ok
    s_sub_u32 s44, s44, 1
    s_cbranch_scc1 at_ok
    s_cmp_lg_u32 s44, 0
    s_cbranch_scc1 at_ldm
    s_add_u32 s41, s41, 1
    s_mov_b32 s40, 4194304
L_aw3:
    buffer_load_dword v199, v198, s[4:7], s36 offen sc1
    s_sub_u32 s40, s40, 1
    s_cbranch_scc1 L_aw3_go
    s_waitcnt vmcnt(0)
    v_subrev_u32 v199, s41, v199
    v_cmp_lt_u32 vcc, 64, v199
    s_cbranch_vccz L_aw3_go
    s_sleep 1
    s_branch L_aw3
L_aw3_go:
    s_branch at_ldm
at_ok:
    s_waitcnt vmcnt(4)
    v_mfma_f32_16x16x32_bf16 v[144:147], v[72:75], v[8:11], 0
    v_mfma_f32_16x16x32_bf16 v[156:159], v[72:75], v[24:27], 0
    v_mfma_f32_16x16x32_bf16 v[144:147], v[76:79], v[12:15], v[144:147]
    v_mfma_f32_16x16x32_bf16 v[156:159], v[76:79], v[28:31], v[156:159]
    v_mfma_f32_16x16x32_bf16 v[144:147], v[80:83], v[16:19], v[144:147]
    v_mfma_f32_16x16x32_bf16 v[156:159], v[80:83], v[32:35], v[156:159]
    v_mfma_f32_16x16x32_bf16 v[144:147], v[84:87], v[20:23], v[144:147]
    v_mfma_f32_16x16x32_bf16 v[156:159], v[84:87], v[36:39], v[156:159]
    v_max3_f32 v196, v136, v137, v138
    v_max3_f32 v197, v139, v140, v141
    v_max3_f32 v196, v196, v142, v143
    s_nop 3
    v_max3_f32 v197, v197, v144, v145
    v_max3_f32 v196, v196, v146, v147
    v_max_f32 v196, v196, v197
    v_mov_b32 v197, v196
    s_nop 1
    v_permlane32_swap_b32 v196, v197
    v_max_f32 v196, v196, v197
    v_mov_b32 v197, v196
    s_nop 1
    v_permlane16_swap_b32 v196, v197
    v_max_f32 v196, v196, v197
    v_mul_f32 v196, s22, v196
    v_sub_f32 v196, 0, v196
    v_fma_f32 v136, v136, s22, v196
    v_fma_f32 v137, v137, s22, v196
    v_fma_f32 v138, v138, s22, v196
    v_fma_f32 v139, v139, s22, v196
    v_fma_f32 v140, v140, s22, v196
    v_fma_f32 v141, v141, s22, v196
    v_fma_f32 v142, v142, s22, v196
    v_fma_f32 v143, v143, s22, v196
    v_fma_f32 v144, v144, s22, v196
    v_fma_f32 v145, v145, s22, v196
    v_fma_f32 v146, v146, s22, v196
    v_fma_f32 v147, v147, s22, v196
    v_exp_f32 v136, v136
    v_exp_f32 v137, v137
    v_exp_f32 v138, v138
    v_exp_f32 v139, v139
    v_exp_f32 v140, v140
    v_exp_f32 v141, v141
    v_exp_f32 v142, v142
    v_exp_f32 v143, v143
    v_exp_f32 v144, v144
    v_exp_f32 v145, v145
    v_exp_f32 v146, v146
    v_exp_f32 v147, v147
    v_cvt_pk_bf16_f32 v160, v136, v137
    v_cvt_pk_bf16_f32 v161, v138, v139
    v_cvt_pk_bf16_f32 v162, v140, v141
    v_cvt_pk_bf16_f32 v163, v142, v143
    v_cvt_pk_bf16_f32 v164, v144, v145
    v_cvt_pk_bf16_f32 v165, v146, v147
    v_max3_f32 v196, v148, v149, v150
    v_max3_f32 v197, v151, v152, v153
    v_max3_f32 v196, v196, v154, v155
    v_max3_f32 v197, v197, v156, v157
    v_max3_f32 v196, v196, v158, v159
    v_max_f32 v196, v196, v197
    v_mov_b32 v197, v196
    s_nop 1
    v_permlane32_swap_b32 v196, v197
    v_max_f32 v196, v196, v197
    v_mov_b32 v197, v196
    s_nop 1
    v_permlane16_swap_b32 v196, v197
    v_max_f32 v196, v196, v197
    v_mul_f32 v196, s22, v196
    v_sub_f32 v196, 0, v196
    v_fma_f32 v148, v148, s22, v196
    v_fma_f32 v149, v149, s22, v196
    v_fma_f32 v150, v150, s22, v196
    v_fma_f32 v151, v151, s22, v196
    v_fma_f32 v152, v152, s22, v196
    v_fma_f32 v153, v153, s22, v196
    v_fma_f32 v154, v154, s22, v196
    v_fma_f32 v155, v155, s22, v196
    v_fma_f32 v156, v156, s22, v196
    v_fma_f32 v157, v157, s22, v196
    v_fma_f32 v158, v158, s22, v196
    v_fma_f32 v159, v159, s22, v196
    v_exp_f32 v148, v148
    v_exp_f32 v149, v149
    v_exp_f32 v150, v150
    v_exp_f32 v151, v151
    v_exp_f32 v152, v152
    v_exp_f32 v153, v153
    v_exp_f32 v154, v154
    v_exp_f32 v155, v155
    v_exp_f32 v156, v156
    v_exp_f32 v157, v157
    v_exp_f32 v158, v158
    v_exp_f32 v159, v159
    v_cvt_pk_bf16_f32 v166, v148, v149
    v_cvt_pk_bf16_f32 v167, v150, v151
    v_cvt_pk_bf16_f32 v168, v152, v153
    v_cvt_pk_bf16_f32 v169, v154, v155
    v_cvt_pk_bf16_f32 v170, v156, v157
    v_cvt_pk_bf16_f32 v171, v158, v159
    v_mfma_f32_16x16x32_bf16 v[180:183], v[172:175], v[160:163], 0
    v_mfma_f32_16x16x32_bf16 v[184:187], v[172:175], v[166:169], 0
    s_nop 4
    v_mfma_f32_16x16x16_bf16 v[180:183], v[176:177], v[164:165], v[180:183]
    v_mfma_f32_16x16x16_bf16 v[184:187], v[176:177], v[170:171], v[184:187]
    s_nop 6
    v_rcp_f32 v180, v180
    v_rcp_f32 v184, v184
    s_waitcnt vmcnt(0)
    s_lshl_b32 s18, s16, 18
    s_lshl_b32 s19, s17, 12
    s_add_u32 s18, s18, s19
    s_add_u32 s18, s18, 50331648
    s_add_u32 s19, s18, 131072
    v_mfma_f32_16x16x32_bf16 v[8:11], v[88:91], v[160:163], 0
    v_mfma_f32_16x16x32_bf16 v[12:15], v[104:107], v[160:163], 0
    v_mfma_f32_16x16x32_bf16 v[16:19], v[88:91], v[166:169], 0
    v_mfma_f32_16x16x32_bf16 v[20:23], v[104:107], v[166:169], 0
    v_mfma_f32_16x16x32_bf16 v[24:27], v[92:95], v[160:163], 0
    v_mfma_f32_16x16x32_bf16 v[28:31], v[108:111], v[160:163], 0
    v_mfma_f32_16x16x32_bf16 v[32:35], v[92:95], v[166:169], 0
    v_mfma_f32_16x16x32_bf16 v[36:39], v[108:111], v[166:169], 0
    v_mfma_f32_16x16x32_bf16 v[40:43], v[96:99], v[160:163], 0
    v_mfma_f32_16x16x32_bf16 v[44:47], v[112:115], v[160:163], 0
    v_mfma_f32_16x16x32_bf16 v[48:51], v[96:99], v[166:169], 0
    v_mfma_f32_16x16x32_bf16 v[52:55], v[112:115], v[166:169], 0
    v_mfma_f32_16x16x32_bf16 v[56:59], v[100:103], v[160:163], 0
    v_mfma_f32_16x16x32_bf16 v[60:63], v[116:119], v[160:163], 0
    v_mfma_f32_16x16x32_bf16 v[64:67], v[100:103], v[166:169], 0
    v_mfma_f32_16x16x32_bf16 v[68:71], v[116:119], v[166:169], 0
    v_mfma_f32_16x16x16_bf16 v[8:11], v[120:121], v[164:165], v[8:11]
    v_mfma_f32_16x16x16_bf16 v[12:15], v[122:123], v[164:165], v[12:15]
    v_mfma_f32_16x16x16_bf16 v[16:19], v[120:121], v[170:171], v[16:19]
    v_mfma_f32_16x16x16_bf16 v[20:23], v[122:123], v[170:171], v[20:23]
    v_mfma_f32_16x16x16_bf16 v[24:27], v[124:125], v[164:165], v[24:27]
    v_mfma_f32_16x16x16_bf16 v[28:31], v[126:127], v[164:165], v[28:31]
    v_mfma_f32_16x16x16_bf16 v[32:35], v[124:125], v[170:171], v[32:35]
    v_mfma_f32_16x16x16_bf16 v[36:39], v[126:127], v[170:171], v[36:39]
    v_mfma_f32_16x16x16_bf16 v[40:43], v[128:129], v[164:165], v[40:43]
    v_mfma_f32_16x16x16_bf16 v[44:47], v[130:131], v[164:165], v[44:47]
    v_mfma_f32_16x16x16_bf16 v[48:51], v[128:129], v[170:171], v[48:51]
    v_mfma_f32_16x16x16_bf16 v[52:55], v[130:131], v[170:171], v[52:55]
    v_mfma_f32_16x16x16_bf16 v[56:59], v[132:133], v[164:165], v[56:59]
    v_mfma_f32_16x16x16_bf16 v[60:63], v[134:135], v[164:165], v[60:63]
    v_mfma_f32_16x16x16_bf16 v[64:67], v[132:133], v[170:171], v[64:67]
    v_mfma_f32_16x16x16_bf16 v[68:71], v[134:135], v[170:171], v[68:71]
    v_mul_f32 v8, v8, v180
    v_mul_f32 v12, v12, v180
    v_mul_f32 v9, v9, v180
    v_mul_f32 v13, v13, v180
    v_mul_f32 v10, v10, v180
    v_mul_f32 v14, v14, v180
    v_mul_f32 v11, v11, v180
    v_mul_f32 v15, v15, v180
    v_cvt_pk_bf16_f32 v8, v8, v9
    v_cvt_pk_bf16_f32 v9, v10, v11
    v_cvt_pk_bf16_f32 v10, v12, v13
    v_cvt_pk_bf16_f32 v11, v14, v15
    buffer_store_dwordx4 v[8:11], v1, s[4:7], s18 offen offset:0 sc1
    v_mul_f32 v16, v16, v184
    v_mul_f32 v20, v20, v184
    v_mul_f32 v17, v17, v184
    v_mul_f32 v21, v21, v184
    v_mul_f32 v18, v18, v184
    v_mul_f32 v22, v22, v184
    v_mul_f32 v19, v19, v184
    v_mul_f32 v23, v23, v184
    v_cvt_pk_bf16_f32 v16, v16, v17
    v_cvt_pk_bf16_f32 v17, v18, v19
    v_cvt_pk_bf16_f32 v18, v20, v21
    v_cvt_pk_bf16_f32 v19, v22, v23
    buffer_store_dwordx4 v[16:19], v1, s[4:7], s19 offen offset:0 sc1
    v_mul_f32 v24, v24, v180
    v_mul_f32 v28, v28, v180
    v_mul_f32 v25, v25, v180
    v_mul_f32 v29, v29, v180
    v_mul_f32 v26, v26, v180
    v_mul_f32 v30, v30, v180
    v_mul_f32 v27, v27, v180
    v_mul_f32 v31, v31, v180
    v_cvt_pk_bf16_f32 v24, v24, v25
    v_cvt_pk_bf16_f32 v25, v26, v27
    v_cvt_pk_bf16_f32 v26, v28, v29
    v_cvt_pk_bf16_f32 v27, v30, v31
    buffer_store_dwordx4 v[24:27], v1, s[4:7], s18 offen offset:1024 sc1
    v_mul_f32 v32, v32, v184
    v_mul_f32 v36, v36, v184
    v_mul_f32 v33, v33, v184
    v_mul_f32 v37, v37, v184
    v_mul_f32 v34, v34, v184
    v_mul_f32 v38, v38, v184
    v_mul_f32 v35, v35, v184
    v_mul_f32 v39, v39, v184
    v_cvt_pk_bf16_f32 v32, v32, v33
    v_cvt_pk_bf16_f32 v33, v34, v35
    v_cvt_pk_bf16_f32 v34, v36, v37
    v_cvt_pk_bf16_f32 v35, v38, v39
    buffer_store_dwordx4 v[32:35], v1, s[4:7], s19 offen offset:1024 sc1
    v_mul_f32 v40, v40, v180
    v_mul_f32 v44, v44, v180
    v_mul_f32 v41, v41, v180
    v_mul_f32 v45, v45, v180
    v_mul_f32 v42, v42, v180
    v_mul_f32 v46, v46, v180
    v_mul_f32 v43, v43, v180
    v_mul_f32 v47, v47, v180
    v_cvt_pk_bf16_f32 v40, v40, v41
    v_cvt_pk_bf16_f32 v41, v42, v43
    v_cvt_pk_bf16_f32 v42, v44, v45
    v_cvt_pk_bf16_f32 v43, v46, v47
    buffer_store_dwordx4 v[40:43], v1, s[4:7], s18 offen offset:2048 sc1
    v_mul_f32 v48, v48, v184
    v_mul_f32 v52, v52, v184
    v_mul_f32 v49, v49, v184
    v_mul_f32 v53, v53, v184
    v_mul_f32 v50, v50, v184
    v_mul_f32 v54, v54, v184
    v_mul_f32 v51, v51, v184
    v_mul_f32 v55, v55, v184
    v_cvt_pk_bf16_f32 v48, v48, v49
    v_cvt_pk_bf16_f32 v49, v50, v51
    v_cvt_pk_bf16_f32 v50, v52, v53
    v_cvt_pk_bf16_f32 v51, v54, v55
    buffer_store_dwordx4 v[48:51], v1, s[4:7], s19 offen offset:2048 sc1
    v_mul_f32 v56, v56, v180
    v_mul_f32 v60, v60, v180
    v_mul_f32 v57, v57, v180
    v_mul_f32 v61, v61, v180
    v_mul_f32 v58, v58, v180
    v_mul_f32 v62, v62, v180
    v_mul_f32 v59, v59, v180
    v_mul_f32 v63, v63, v180
    v_cvt_pk_bf16_f32 v56, v56, v57
    v_cvt_pk_bf16_f32 v57, v58, v59
    v_cvt_pk_bf16_f32 v58, v60, v61
    v_cvt_pk_bf16_f32 v59, v62, v63
    buffer_store_dwordx4 v[56:59], v1, s[4:7], s18 offen offset:3072 sc1
    v_mul_f32 v64, v64, v184
    v_mul_f32 v68, v68, v184
    v_mul_f32 v65, v65, v184
    v_mul_f32 v69, v69, v184
    v_mul_f32 v66, v66, v184
    v_mul_f32 v70, v70, v184
    v_mul_f32 v67, v67, v184
    v_mul_f32 v71, v71, v184
    v_cvt_pk_bf16_f32 v64, v64, v65
    v_cvt_pk_bf16_f32 v65, v66, v67
    v_cvt_pk_bf16_f32 v66, v68, v69
    v_cvt_pk_bf16_f32 v67, v70, v71
    buffer_store_dwordx4 v[64:67], v1, s[4:7], s19 offen offset:3072 sc1
    s_lshr_b32 s40, s34, 1
    s_lshl_b32 s40, s40, 7
    s_and_b32 s41, s34, 1
    s_lshl_b32 s41, s41, 2
    s_add_u32 s40, s40, s41
    s_add_u32 s40, s40, 125894656
    s_cmp_lt_u32 s16, 62
    s_cbranch_scc1 L_noef
    s_lshr_b32 s42, s34, 1
    s_mul_i32 s42, s42, 4096
    s_add_u32 s41, s41, s42
    s_add_u32 s41, s41, 124944384
    s_barrier
    s_cmp_lg_u32 s32, 0
    s_cbranch_scc1 L_noef
    v_mov_b32 v250, s95
    v_lshlrev_b32 v251, 7, v0
    s_mov_b64 exec, 262143
    buffer_store_dword v250, v251, s[4:7], s41 offen sc1
    s_mov_b64 exec, -1
L_noef:
    s_waitcnt vmcnt(0)
    s_barrier
    v_mov_b32 v250, s95
    v_cmp_eq_u32 vcc, 0, v0
    s_nop 0
    s_and_saveexec_b64 s[38:39], vcc
    s_cbranch_execz fs18
    buffer_store_dword v250, off, s[4:7], s40 sc1
fs18:
    s_mov_b64 exec, -1
    s_branch L_att_next
L_op_start:
    s_lshl_b32 s35, s33, 2
    s_add_u32 s35, s35, 136
    s_lshr_b32 s89, s33, 2
    s_lshl_b32 s89, s89, 7
    s_add_u32 s89, s89, 125841408
    v_mbcnt_lo_u32_b32 v2, -1, 0
    v_mbcnt_hi_u32_b32 v2, -1, v2
    v_min_u32 v2, 31, v2
    v_lshlrev_b32 v2, 2, v2
    s_mov_b32 s88, 4194304
fw19:
    buffer_load_dword v3, v2, s[4:7], s89 offen offset:0 sc1
    s_sub_u32 s88, s88, 1
    s_cbranch_scc1 fw19x
    s_waitcnt vmcnt(0)
    v_cmp_ne_u32 vcc, s95, v3
    s_cbranch_vccz fw19x
    s_sleep 4
    s_branch fw19
fw19x:
    v_and_b32 v1, 63, v0
    v_lshlrev_b32 v1, 4, v1
    s_lshl_b32 s18, s33, 18
    s_lshl_b32 s19, s32, 16
    s_add_u32 s18, s18, s19
    s_add_u32 s18, s18, 130023424
    buffer_load_dwordx4 a[0:3], v1, s[4:7], s18 offen offset:0 sc1
    buffer_load_dwordx4 a[4:7], v1, s[4:7], s18 offen offset:1024 sc1
    buffer_load_dwordx4 a[8:11], v1, s[4:7], s18 offen offset:2048 sc1
    buffer_load_dwordx4 a[12:15], v1, s[4:7], s18 offen offset:3072 sc1
    s_add_u32 s18, s18, 4096
    buffer_load_dwordx4 a[16:19], v1, s[4:7], s18 offen offset:0 sc1
    buffer_load_dwordx4 a[20:23], v1, s[4:7], s18 offen offset:1024 sc1
    buffer_load_dwordx4 a[24:27], v1, s[4:7], s18 offen offset:2048 sc1
    buffer_load_dwordx4 a[28:31], v1, s[4:7], s18 offen offset:3072 sc1
    s_add_u32 s18, s18, 4096
    buffer_load_dwordx4 a[32:35], v1, s[4:7], s18 offen offset:0 sc1
    buffer_load_dwordx4 a[36:39], v1, s[4:7], s18 offen offset:1024 sc1
    buffer_load_dwordx4 a[40:43], v1, s[4:7], s18 offen offset:2048 sc1
    buffer_load_dwordx4 a[44:47], v1, s[4:7], s18 offen offset:3072 sc1
    s_add_u32 s18, s18, 4096
    buffer_load_dwordx4 a[48:51], v1, s[4:7], s18 offen offset:0 sc1
    buffer_load_dwordx4 a[52:55], v1, s[4:7], s18 offen offset:1024 sc1
    buffer_load_dwordx4 a[56:59], v1, s[4:7], s18 offen offset:2048 sc1
    buffer_load_dwordx4 a[60:63], v1, s[4:7], s18 offen offset:3072 sc1
    s_add_u32 s18, s18, 4096
    buffer_load_dwordx4 a[64:67], v1, s[4:7], s18 offen offset:0 sc1
    buffer_load_dwordx4 a[68:71], v1, s[4:7], s18 offen offset:1024 sc1
    buffer_load_dwordx4 a[72:75], v1, s[4:7], s18 offen offset:2048 sc1
    buffer_load_dwordx4 a[76:79], v1, s[4:7], s18 offen offset:3072 sc1
    s_add_u32 s18, s18, 4096
    buffer_load_dwordx4 a[80:83], v1, s[4:7], s18 offen offset:0 sc1
    buffer_load_dwordx4 a[84:87], v1, s[4:7], s18 offen offset:1024 sc1
    buffer_load_dwordx4 a[88:91], v1, s[4:7], s18 offen offset:2048 sc1
    buffer_load_dwordx4 a[92:95], v1, s[4:7], s18 offen offset:3072 sc1
    s_add_u32 s18, s18, 4096
    buffer_load_dwordx4 a[96:99], v1, s[4:7], s18 offen offset:0 sc1
    buffer_load_dwordx4 a[100:103], v1, s[4:7], s18 offen offset:1024 sc1
    buffer_load_dwordx4 a[104:107], v1, s[4:7], s18 offen offset:2048 sc1
    buffer_load_dwordx4 a[108:111], v1, s[4:7], s18 offen offset:3072 sc1
    s_add_u32 s18, s18, 4096
    buffer_load_dwordx4 a[112:115], v1, s[4:7], s18 offen offset:0 sc1
    buffer_load_dwordx4 a[116:119], v1, s[4:7], s18 offen offset:1024 sc1
    buffer_load_dwordx4 a[120:123], v1, s[4:7], s18 offen offset:2048 sc1
    buffer_load_dwordx4 a[124:127], v1, s[4:7], s18 offen offset:3072 sc1
    s_add_u32 s18, s18, 4096
    buffer_load_dwordx4 a[128:131], v1, s[4:7], s18 offen offset:0 sc1
    buffer_load_dwordx4 a[132:135], v1, s[4:7], s18 offen offset:1024 sc1
    buffer_load_dwordx4 a[136:139], v1, s[4:7], s18 offen offset:2048 sc1
    buffer_load_dwordx4 a[140:143], v1, s[4:7], s18 offen offset:3072 sc1
    s_add_u32 s18, s18, 4096
    buffer_load_dwordx4 a[144:147], v1, s[4:7], s18 offen offset:0 sc1
    buffer_load_dwordx4 a[148:151], v1, s[4:7], s18 offen offset:1024 sc1
    buffer_load_dwordx4 a[152:155], v1, s[4:7], s18 offen offset:2048 sc1
    buffer_load_dwordx4 a[156:159], v1, s[4:7], s18 offen offset:3072 sc1
    s_add_u32 s18, s18, 4096
    buffer_load_dwordx4 a[160:163], v1, s[4:7], s18 offen offset:0 sc1
    s_waitcnt vmcnt(20)
    buffer_load_dwordx4 a[164:167], v1, s[4:7], s18 offen offset:1024 sc1
    buffer_load_dwordx4 a[168:171], v1, s[4:7], s18 offen offset:2048 sc1
    buffer_load_dwordx4 a[172:175], v1, s[4:7], s18 offen offset:3072 sc1
    s_add_u32 s18, s18, 4096
    buffer_load_dwordx4 a[176:179], v1, s[4:7], s18 offen offset:0 sc1
    buffer_load_dwordx4 a[180:183], v1, s[4:7], s18 offen offset:1024 sc1
    buffer_load_dwordx4 a[184:187], v1, s[4:7], s18 offen offset:2048 sc1
    buffer_load_dwordx4 a[188:191], v1, s[4:7], s18 offen offset:3072 sc1
    s_add_u32 s18, s18, 4096
    buffer_load_dwordx4 a[192:195], v1, s[4:7], s18 offen offset:0 sc1
    buffer_load_dwordx4 a[196:199], v1, s[4:7], s18 offen offset:1024 sc1
    buffer_load_dwordx4 a[200:203], v1, s[4:7], s18 offen offset:2048 sc1
    buffer_load_dwordx4 a[204:207], v1, s[4:7], s18 offen offset:3072 sc1
    s_add_u32 s18, s18, 4096
    buffer_load_dwordx4 a[208:211], v1, s[4:7], s18 offen offset:0 sc1
    buffer_load_dwordx4 a[212:215], v1, s[4:7], s18 offen offset:1024 sc1
    buffer_load_dwordx4 a[216:219], v1, s[4:7], s18 offen offset:2048 sc1
    buffer_load_dwordx4 a[220:223], v1, s[4:7], s18 offen offset:3072 sc1
    s_add_u32 s18, s18, 4096
    buffer_load_dwordx4 a[224:227], v1, s[4:7], s18 offen offset:0 sc1
    buffer_load_dwordx4 a[228:231], v1, s[4:7], s18 offen offset:1024 sc1
    buffer_load_dwordx4 a[232:235], v1, s[4:7], s18 offen offset:2048 sc1
    buffer_load_dwordx4 a[236:239], v1, s[4:7], s18 offen offset:3072 sc1
    s_add_u32 s18, s18, 4096
    buffer_load_dwordx4 a[240:243], v1, s[4:7], s18 offen offset:0 sc1
    buffer_load_dwordx4 a[244:247], v1, s[4:7], s18 offen offset:1024 sc1
    buffer_load_dwordx4 a[248:251], v1, s[4:7], s18 offen offset:2048 sc1
    buffer_load_dwordx4 a[252:255], v1, s[4:7], s18 offen offset:3072 sc1
    s_waitcnt vmcnt(0)
    s_mov_b32 s44, 0
    s_mov_b32 s37, s35
    v_mov_b32 v250, 1
    v_mov_b32 v251, 163832
    v_cmp_eq_u32 vcc, 0, v0
    s_nop 0
    s_and_saveexec_b64 s[38:39], vcc
    s_cbranch_execz tk20
    buffer_atomic_add v250, off, s[84:87], s37 sc0
    s_waitcnt vmcnt(0)
    ds_write_b32 v251, v250
    s_waitcnt lgkmcnt(0)
tk20:
    s_mov_b64 exec, -1
    s_barrier
    ds_read_b32 v252, v251
    s_waitcnt lgkmcnt(0)
    v_readfirstlane_b32 s16, v252
    s_barrier
    s_nop 3
    s_cmp_ge_u32 s16, 72
    s_cbranch_scc1 L_op_nextcb
L_op_seg:
    s_min_u32 s43, s16, 56
    s_add_u32 s16, s16, s43
    s_lshr_b32 s43, s16, 1
    s_add_u32 s43, s43, 2
    s_min_u32 s43, s43, 63
    s_lshl_b32 s94, s33, 7
    s_add_u32 s94, s94, s16
    s_mov_b32 s88, 65536
    s_mov_b32 s89, 125853696
cw21:
    buffer_load_dword v3, off, s[4:7], s89 sc1
    s_waitcnt vmcnt(0)
    v_readfirstlane_b32 s42, v3
    s_nop 0
    s_sub_u32 s42, s42, s95
    s_cmp_gt_u32 s42, 64
    s_cselect_b32 s42, 0, s42
    s_add_u32 s42, s42, 1
    s_cmp_ge_u32 s42, s43
    s_cbranch_scc1 cw21x
    s_sub_u32 s88, s88, 1
    s_cbranch_scc1 cw21x
    s_sub_u32 s42, s43, s42
    s_min_u32 s42, s42, 6
cw21s:
    s_sleep 24
    s_sub_u32 s42, s42, 1
    s_cmp_lg_u32 s42, 0
    s_cbranch_scc1 cw21s
    s_branch cw21
cw21x:
    s_lshr_b32 s89, s16, 1
    s_lshl_b32 s89, s89, 2
    s_add_u32 s89, s89, s32
    s_lshl_b32 s89, s89, 7
    s_add_u32 s89, s89, 125894656
    s_sub_u32 s47, s89, 125894656
    s_lshl_b32 s47, s47, 5
    s_lshl_b32 s46, s33, 7
    s_add_u32 s47, s47, s46
    s_add_u32 s47, s47, 124944384
    s_cmp_ge_u32 s16, 124
    s_cselect_b32 s46, 8, 0
    s_cselect_b32 s47, s47, s89
    v_mbcnt_lo_u32_b32 v2, -1, 0
    v_mbcnt_hi_u32_b32 v2, -1, v2
    v_min_u32 v2, 1, v2
    v_lshlrev_b32 v2, 2, v2
    s_mov_b32 s88, 4194304
fw22:
    buffer_load_dword v3, v2, s[4:7], s47 offen offset:0 sc1
    s_sub_u32 s88, s88, 1
    s_cbranch_scc1 fw22x
    s_waitcnt vmcnt(0)
    v_cmp_ne_u32 vcc, s95, v3
    s_cbranch_vccz fw22x
    s_sleep 1
    s_branch fw22
fw22x:
    v_mov_b32 v250, 1
    v_lshrrev_b32 v252, 2, v1
    v_min_u32 v252, 68, v252
    s_cmp_lg_u32 s32, 0
    s_cbranch_scc1 L_op_na
    s_mov_b64 exec, 1
    buffer_atomic_add v250, off, s[84:87], s35 sc0
    s_mov_b64 exec, -1
    s_cmp_lg_u32 s44, 0
    s_cbranch_scc1 L_op_na
    buffer_load_dword v253, v252, s[84:87], 0 offen offset:136 sc1
L_op_na:
    s_cmp_ge_u32 s16, 112
    s_cbranch_scc1 L_op_one
o2_again:
    s_lshl_b32 s18, s16, 17
    s_lshl_b32 s19, s32, 15
    s_add_u32 s18, s18, s19
    s_add_u32 s18, s18, 50331648
    buffer_load_dwordx4 v[24:27], v1, s[4:7], s18 offen offset:0 sc1
    buffer_load_dwordx4 v[28:31], v1, s[4:7], s18 offen offset:1024 sc1
    buffer_load_dwordx4 v[32:35], v1, s[4:7], s18 offen offset:2048 sc1
    buffer_load_dwordx4 v[36:39], v1, s[4:7], s18 offen offset:3072 sc1
    s_add_u32 s18, s18, 4096
    buffer_load_dwordx4 v[40:43], v1, s[4:7], s18 offen offset:0 sc1
    buffer_load_dwordx4 v[44:47], v1, s[4:7], s18 offen offset:1024 sc1
    buffer_load_dwordx4 v[48:51], v1, s[4:7], s18 offen offset:2048 sc1
    buffer_load_dwordx4 v[52:55], v1, s[4:7], s18 offen offset:3072 sc1
    s_add_u32 s18, s18, 4096
    buffer_load_dwordx4 v[56:59], v1, s[4:7], s18 offen offset:0 sc1
    buffer_load_dwordx4 v[60:63], v1, s[4:7], s18 offen offset:1024 sc1
    buffer_load_dwordx4 v[64:67], v1, s[4:7], s18 offen offset:2048 sc1
    buffer_load_dwordx4 v[68:71], v1, s[4:7], s18 offen offset:3072 sc1
    s_add_u32 s18, s18, 4096
    buffer_load_dwordx4 v[72:75], v1, s[4:7], s18 offen offset:0 sc1
    buffer_load_dwordx4 v[76:79], v1, s[4:7], s18 offen offset:1024 sc1
    buffer_load_dwordx4 v[80:83], v1, s[4:7], s18 offen offset:2048 sc1
    buffer_load_dwordx4 v[84:87], v1, s[4:7], s18 offen offset:3072 sc1
    s_add_u32 s18, s18, 4096
    buffer_load_dwordx4 v[88:91], v1, s[4:7], s18 offen offset:0 sc1
    buffer_load_dwordx4 v[92:95], v1, s[4:7], s18 offen offset:1024 sc1
    buffer_load_dwordx4 v[96:99], v1, s[4:7], s18 offen offset:2048 sc1
    buffer_load_dwordx4 v[100:103], v1, s[4:7], s18 offen offset:3072 sc1
    s_add_u32 s18, s18, 4096
    buffer_load_dwordx4 v[104:107], v1, s[4:7], s18 offen offset:0 sc1
    buffer_load_dwordx4 v[108:111], v1, s[4:7], s18 offen offset:1024 sc1
    buffer_load_dwordx4 v[112:115], v1, s[4:7], s18 offen offset:2048 sc1
    buffer_load_dwordx4 v[116:119], v1, s[4:7], s18 offen offset:3072 sc1
    s_add_u32 s18, s18, 4096
    buffer_load_dwordx4 v[120:123], v1, s[4:7], s18 offen offset:0 sc1
    buffer_load_dwordx4 v[124:127], v1, s[4:7], s18 offen offset:1024 sc1
    buffer_load_dwordx4 v[128:131], v1, s[4:7], s18 offen offset:2048 sc1
    buffer_load_dwordx4 v[132:135], v1, s[4:7], s18 offen offset:3072 sc1
    s_add_u32 s18, s18, 4096
    buffer_load_dwordx4 v[136:139], v1, s[4:7], s18 offen offset:0 sc1
    buffer_load_dwordx4 v[140:143], v1, s[4:7], s18 offen offset:1024 sc1
    buffer_load_dwordx4 v[144:147], v1, s[4:7], s18 offen offset:2048 sc1
    buffer_load_dwordx4 v[148:151], v1, s[4:7], s18 offen offset:3072 sc1
    s_add_u32 s18, s18, 102400
    buffer_load_dwordx4 v[152:155], v1, s[4:7], s18 offen offset:0 sc1
    buffer_load_dwordx4 v[156:159], v1, s[4:7], s18 offen offset:1024 sc1
    buffer_load_dwordx4 v[160:163], v1, s[4:7], s18 offen offset:2048 sc1
    buffer_load_dwordx4 v[164:167], v1, s[4:7], s18 offen offset:3072 sc1
    s_add_u32 s18, s18, 4096
    buffer_load_dwordx4 v[168:171], v1, s[4:7], s18 offen offset:0 sc1
    buffer_load_dwordx4 v[172:175], v1, s[4:7], s18 offen offset:1024 sc1
    buffer_load_dwordx4 v[176:179], v1, s[4:7], s18 offen offset:2048 sc1
    buffer_load_dwordx4 v[180:183], v1, s[4:7], s18 offen offset:3072 sc1
    s_add_u32 s18, s18, 4096
    buffer_load_dwordx4 v[184:187], v1, s[4:7], s18 offen offset:0 sc1
    buffer_load_dwordx4 v[188:191], v1, s[4:7], s18 offen offset:1024 sc1
    buffer_load_dwordx4 v[192:195], v1, s[4:7], s18 offen offset:2048 sc1
    buffer_load_dwordx4 v[196:199], v1, s[4:7], s18 offen offset:3072 sc1
    s_add_u32 s18, s18, 4096
    buffer_load_dwordx4 v[200:203], v1, s[4:7], s18 offen offset:0 sc1
    buffer_load_dwordx4 v[204:207], v1, s[4:7], s18 offen offset:1024 sc1
    buffer_load_dwordx4 v[208:211], v1, s[4:7], s18 offen offset:2048 sc1
    buffer_load_dwordx4 v[212:215], v1, s[4:7], s18 offen offset:3072 sc1
    s_add_u32 s18, s18, 4096
    buffer_load_dwordx4 v[216:219], v1, s[4:7], s18 offen offset:0 sc1
    buffer_load_dwordx4 v[220:223], v1, s[4:7], s18 offen offset:1024 sc1
    buffer_load_dwordx4 v[224:227], v1, s[4:7], s18 offen offset:2048 sc1
    buffer_load_dwordx4 v[228:231], v1, s[4:7], s18 offen offset:3072 sc1
    s_add_u32 s18, s18, 4096
    buffer_load_dwordx4 v[232:235], v1, s[4:7], s18 offen offset:0 sc1
    buffer_load_dwordx4 v[236:239], v1, s[4:7], s18 offen offset:1024 sc1
    buffer_load_dwordx4 v[240:243], v1, s[4:7], s18 offen offset:2048 sc1
    buffer_load_dwordx4 v[244:247], v1, s[4:7], s18 offen offset:3072 sc1
    v_lshlrev_b32 v2, 4, v0
    v_and_b32 v3, 3072, v2
    v_lshl_add_u32 v2, v3, 1, v1
    s_waitcnt vmcnt(55)
    v_mfma_f32_16x16x32_bf16 v[8:11], a[0:3], v[24:27], 0
    v_mfma_f32_16x16x32_bf16 v[12:15], a[4:7], v[24:27], 0
    s_add_u32 s18, s18, 4096
    buffer_load_dwordx4 v[24:27], v1, s[4:7], s18 offen offset:0 sc1
    s_waitcnt vmcnt(55)
    v_mfma_f32_16x16x32_bf16 v[8:11], a[8:11], v[28:31], v[8:11]
    v_mfma_f32_16x16x32_bf16 v[12:15], a[12:15], v[28:31], v[12:15]
    buffer_load_dwordx4 v[28:31], v1, s[4:7], s18 offen offset:1024 sc1
    s_waitcnt vmcnt(55)
    v_mfma_f32_16x16x32_bf16 v[8:11], a[16:19], v[32:35], v[8:11]
    v_mfma_f32_16x16x32_bf16 v[12:15], a[20:23], v[32:35], v[12:15]
    buffer_load_dwordx4 v[32:35], v1, s[4:7], s18 offen offset:2048 sc1
    s_waitcnt vmcnt(55)
    v_mfma_f32_16x16x32_bf16 v[8:11], a[24:27], v[36:39], v[8:11]
    v_mfma_f32_16x16x32_bf16 v[12:15], a[28:31], v[36:39], v[12:15]
    buffer_load_dwordx4 v[36:39], v1, s[4:7], s18 offen offset:3072 sc1
    s_waitcnt vmcnt(55)
    v_mfma_f32_16x16x32_bf16 v[8:11], a[32:35], v[40:43], v[8:11]
    v_mfma_f32_16x16x32_bf16 v[12:15], a[36:39], v[40:43], v[12:15]
    s_add_u32 s18, s18, 4096
    buffer_load_dwordx4 v[40:43], v1, s[4:7], s18 offen offset:0 sc1
    s_waitcnt vmcnt(55)
    v_mfma_f32_16x16x32_bf16 v[8:11], a[40:43], v[44:47], v[8:11]
    v_mfma_f32_16x16x32_bf16 v[12:15], a[44:47], v[44:47], v[12:15]
    buffer_load_dwordx4 v[44:47], v1, s[4:7], s18 offen offset:1024 sc1
    s_waitcnt vmcnt(55)
    v_mfma_f32_16x16x32_bf16 v[8:11], a[48:51], v[48:51], v[8:11]
    v_mfma_f32_16x16x32_bf16 v[12:15], a[52:55], v[48:51], v[12:15]
    buffer_load_dwordx4 v[48:51], v1, s[4:7], s18 offen offset:2048 sc1
    s_waitcnt vmcnt(55)
    v_mfma_f32_16x16x32_bf16 v[8:11], a[56:59], v[52:55], v[8:11]
    v_mfma_f32_16x16x32_bf16 v[12:15], a[60:63], v[52:55], v[12:15]
    buffer_load_dwordx4 v[52:55], v1, s[4:7], s18 offen offset:3072 sc1
    s_waitcnt vmcnt(55)
    v_mfma_f32_16x16x32_bf16 v[8:11], a[64:67], v[56:59], v[8:11]
    v_mfma_f32_16x16x32_bf16 v[12:15], a[68:71], v[56:59], v[12:15]
    s_waitcnt vmcnt(54)
    v_mfma_f32_16x16x32_bf16 v[8:11], a[72:75], v[60:63], v[8:11]
    v_mfma_f32_16x16x32_bf16 v[12:15], a[76:79], v[60:63], v[12:15]
    s_waitcnt vmcnt(53)
    v_mfma_f32_16x16x32_bf16 v[8:11], a[80:83], v[64:67], v[8:11]
    v_mfma_f32_16x16x32_bf16 v[12:15], a[84:87], v[64:67], v[12:15]
    s_waitcnt vmcnt(52)
    v_mfma_f32_16x16x32_bf16 v[8:11], a[88:91], v[68:71], v[8:11]
    v_mfma_f32_16x16x32_bf16 v[12:15], a[92:95], v[68:71], v[12:15]
    s_waitcnt vmcnt(51)
    v_mfma_f32_16x16x32_bf16 v[8:11], a[96:99], v[72:75], v[8:11]
    v_mfma_f32_16x16x32_bf16 v[12:15], a[100:103], v[72:75], v[12:15]
    s_waitcnt vmcnt(50)
    v_mfma_f32_16x16x32_bf16 v[8:11], a[104:107], v[76:79], v[8:11]
    v_mfma_f32_16x16x32_bf16 v[12:15], a[108:111], v[76:79], v[12:15]
    s_waitcnt vmcnt(49)
    v_mfma_f32_16x16x32_bf16 v[8:11], a[112:115], v[80:83], v[8:11]
    v_mfma_f32_16x16x32_bf16 v[12:15], a[116:119], v[80:83], v[12:15]
    s_waitcnt vmcnt(48)
    v_mfma_f32_16x16x32_bf16 v[8:11], a[120:123], v[84:87], v[8:11]
    v_mfma_f32_16x16x32_bf16 v[12:15], a[124:127], v[84:87], v[12:15]
    s_waitcnt vmcnt(47)
    v_mfma_f32_16x16x32_bf16 v[8:11], a[128:131], v[88:91], v[8:11]
    v_mfma_f32_16x16x32_bf16 v[12:15], a[132:135], v[88:91], v[12:15]
    s_waitcnt vmcnt(46)
    v_mfma_f32_16x16x32_bf16 v[8:11], a[136:139], v[92:95], v[8:11]
    v_mfma_f32_16x16x32_bf16 v[12:15], a[140:143], v[92:95], v[12:15]
    s_waitcnt vmcnt(45)
    v_mfma_f32_16x16x32_bf16 v[8:11], a[144:147], v[96:99], v[8:11]
    v_mfma_f32_16x16x32_bf16 v[12:15], a[148:151], v[96:99], v[12:15]
    s_waitcnt vmcnt(44)
    v_mfma_f32_16x16x32_bf16 v[8:11], a[152:155], v[100:103], v[8:11]
    v_mfma_f32_16x16x32_bf16 v[12:15], a[156:159], v[100:103], v[12:15]
    s_waitcnt vmcnt(43)
    v_mfma_f32_16x16x32_bf16 v[8:11], a[160:163], v[104:107], v[8:11]
    v_mfma_f32_16x16x32_bf16 v[12:15], a[164:167], v[104:107], v[12:15]
    s_waitcnt vmcnt(42)
    v_mfma_f32_16x16x32_bf16 v[8:11], a[168:171], v[108:111], v[8:11]
    v_mfma_f32_16x16x32_bf16 v[12:15], a[172:175], v[108:111], v[12:15]
    s_waitcnt vmcnt(41)
    v_mfma_f32_16x16x32_bf16 v[8:11], a[176:179], v[112:115], v[8:11]
    v_mfma_f32_16x16x32_bf16 v[12:15], a[180:183], v[112:115], v[12:15]
    s_waitcnt vmcnt(40)
    v_mfma_f32_16x16x32_bf16 v[8:11], a[184:187], v[116:119], v[8:11]
    v_mfma_f32_16x16x32_bf16 v[12:15], a[188:191], v[116:119], v[12:15]
    s_waitcnt vmcnt(39)
    v_mfma_f32_16x16x32_bf16 v[8:11], a[192:195], v[120:123], v[8:11]
    v_mfma_f32_16x16x32_bf16 v[12:15], a[196:199], v[120:123], v[12:15]
    s_waitcnt vmcnt(38)
    v_mfma_f32_16x16x32_bf16 v[8:11], a[200:203], v[124:127], v[8:11]
    v_mfma_f32_16x16x32_bf16 v[12:15], a[204:207], v[124:127], v[12:15]
    s_waitcnt vmcnt(37)
    v_mfma_f32_16x16x32_bf16 v[8:11], a[208:211], v[128:131], v[8:11]
    v_mfma_f32_16x16x32_bf16 v[12:15], a[212:215], v[128:131], v[12:15]
    s_waitcnt vmcnt(36)
    v_mfma_f32_16x16x32_bf16 v[8:11], a[216:219], v[132:135], v[8:11]
    v_mfma_f32_16x16x32_bf16 v[12:15], a[220:223], v[132:135], v[12:15]
    s_waitcnt vmcnt(35)
    v_mfma_f32_16x16x32_bf16 v[8:11], a[224:227], v[136:139], v[8:11]
    v_mfma_f32_16x16x32_bf16 v[12:15], a[228:231], v[136:139], v[12:15]
    s_waitcnt vmcnt(34)
    v_mfma_f32_16x16x32_bf16 v[8:11], a[232:235], v[140:143], v[8:11]
    v_mfma_f32_16x16x32_bf16 v[12:15], a[236:239], v[140:143], v[12:15]
    s_waitcnt vmcnt(33)
    v_mfma_f32_16x16x32_bf16 v[8:11], a[240:243], v[144:147], v[8:11]
    v_mfma_f32_16x16x32_bf16 v[12:15], a[244:247], v[144:147], v[12:15]
    s_waitcnt vmcnt(32)
    v_mfma_f32_16x16x32_bf16 v[8:11], a[248:251], v[148:151], v[8:11]
    v_mfma_f32_16x16x32_bf16 v[12:15], a[252:255], v[148:151], v[12:15]
    s_waitcnt vmcnt(31)
    v_mfma_f32_16x16x32_bf16 v[16:19], a[0:3], v[152:155], 0
    v_mfma_f32_16x16x32_bf16 v[20:23], a[4:7], v[152:155], 0
    s_waitcnt vmcnt(30)
    v_mfma_f32_16x16x32_bf16 v[16:19], a[8:11], v[156:159], v[16:19]
    v_mfma_f32_16x16x32_bf16 v[20:23], a[12:15], v[156:159], v[20:23]
    s_waitcnt vmcnt(29)
    v_mfma_f32_16x16x32_bf16 v[16:19], a[16:19], v[160:163], v[16:19]
    v_mfma_f32_16x16x32_bf16 v[20:23], a[20:23], v[160:163], v[20:23]
    s_waitcnt vmcnt(28)
    v_mfma_f32_16x16x32_bf16 v[16:19], a[24:27], v[164:167], v[16:19]
    v_mfma_f32_16x16x32_bf16 v[20:23], a[28:31], v[164:167], v[20:23]
    s_waitcnt vmcnt(27)
    v_mfma_f32_16x16x32_bf16 v[16:19], a[32:35], v[168:171], v[16:19]
    v_mfma_f32_16x16x32_bf16 v[20:23], a[36:39], v[168:171], v[20:23]
    s_waitcnt vmcnt(26)
    v_mfma_f32_16x16x32_bf16 v[16:19], a[40:43], v[172:175], v[16:19]
    v_mfma_f32_16x16x32_bf16 v[20:23], a[44:47], v[172:175], v[20:23]
    s_waitcnt vmcnt(25)
    v_mfma_f32_16x16x32_bf16 v[16:19], a[48:51], v[176:179], v[16:19]
    v_mfma_f32_16x16x32_bf16 v[20:23], a[52:55], v[176:179], v[20:23]
    s_waitcnt vmcnt(24)
    v_mfma_f32_16x16x32_bf16 v[16:19], a[56:59], v[180:183], v[16:19]
    v_mfma_f32_16x16x32_bf16 v[20:23], a[60:63], v[180:183], v[20:23]
    s_waitcnt vmcnt(23)
    v_mfma_f32_16x16x32_bf16 v[16:19], a[64:67], v[184:187], v[16:19]
    v_mfma_f32_16x16x32_bf16 v[20:23], a[68:71], v[184:187], v[20:23]
    s_waitcnt vmcnt(22)
    v_mfma_f32_16x16x32_bf16 v[16:19], a[72:75], v[188:191], v[16:19]
    v_mfma_f32_16x16x32_bf16 v[20:23], a[76:79], v[188:191], v[20:23]
    s_waitcnt vmcnt(21)
    v_mfma_f32_16x16x32_bf16 v[16:19], a[80:83], v[192:195], v[16:19]
    v_mfma_f32_16x16x32_bf16 v[20:23], a[84:87], v[192:195], v[20:23]
    s_waitcnt vmcnt(20)
    v_mfma_f32_16x16x32_bf16 v[16:19], a[88:91], v[196:199], v[16:19]
    v_mfma_f32_16x16x32_bf16 v[20:23], a[92:95], v[196:199], v[20:23]
    s_waitcnt vmcnt(19)
    v_mfma_f32_16x16x32_bf16 v[16:19], a[96:99], v[200:203], v[16:19]
    v_mfma_f32_16x16x32_bf16 v[20:23], a[100:103], v[200:203], v[20:23]
    s_waitcnt vmcnt(18)
    v_mfma_f32_16x16x32_bf16 v[16:19], a[104:107], v[204:207], v[16:19]
    v_mfma_f32_16x16x32_bf16 v[20:23], a[108:111], v[204:207], v[20:23]
    s_waitcnt vmcnt(17)
    v_mfma_f32_16x16x32_bf16 v[16:19], a[112:115], v[208:211], v[16:19]
    v_mfma_f32_16x16x32_bf16 v[20:23], a[116:119], v[208:211], v[20:23]
    s_waitcnt vmcnt(16)
    v_mfma_f32_16x16x32_bf16 v[16:19], a[120:123], v[212:215], v[16:19]
    v_mfma_f32_16x16x32_bf16 v[20:23], a[124:127], v[212:215], v[20:23]
    s_waitcnt vmcnt(15)
    v_mfma_f32_16x16x32_bf16 v[16:19], a[128:131], v[216:219], v[16:19]
    v_mfma_f32_16x16x32_bf16 v[20:23], a[132:135], v[216:219], v[20:23]
    s_waitcnt vmcnt(14)
    v_mfma_f32_16x16x32_bf16 v[16:19], a[136:139], v[220:223], v[16:19]
    v_mfma_f32_16x16x32_bf16 v[20:23], a[140:143], v[220:223], v[20:23]
    s_waitcnt vmcnt(13)
    v_mfma_f32_16x16x32_bf16 v[16:19], a[144:147], v[224:227], v[16:19]
    v_mfma_f32_16x16x32_bf16 v[20:23], a[148:151], v[224:227], v[20:23]
    s_waitcnt vmcnt(12)
    v_mfma_f32_16x16x32_bf16 v[16:19], a[152:155], v[228:231], v[16:19]
    v_mfma_f32_16x16x32_bf16 v[20:23], a[156:159], v[228:231], v[20:23]
    s_waitcnt vmcnt(11)
    v_mfma_f32_16x16x32_bf16 v[16:19], a[160:163], v[232:235], v[16:19]
    v_mfma_f32_16x16x32_bf16 v[20:23], a[164:167], v[232:235], v[20:23]
    s_waitcnt vmcnt(10)
    v_mfma_f32_16x16x32_bf16 v[16:19], a[168:171], v[236:239], v[16:19]
    v_mfma_f32_16x16x32_bf16 v[20:23], a[172:175], v[236:239], v[20:23]
    s_waitcnt vmcnt(9)
    v_mfma_f32_16x16x32_bf16 v[16:19], a[176:179], v[240:243], v[16:19]
    v_mfma_f32_16x16x32_bf16 v[20:23], a[180:183], v[240:243], v[20:23]
    s_waitcnt vmcnt(8)
    v_mfma_f32_16x16x32_bf16 v[16:19], a[184:187], v[244:247], v[16:19]
    v_mfma_f32_16x16x32_bf16 v[20:23], a[188:191], v[244:247], v[20:23]
    s_waitcnt vmcnt(7)
    v_mfma_f32_16x16x32_bf16 v[16:19], a[192:195], v[24:27], v[16:19]
    v_mfma_f32_16x16x32_bf16 v[20:23], a[196:199], v[24:27], v[20:23]
    s_waitcnt vmcnt(6)
    v_mfma_f32_16x16x32_bf16 v[16:19], a[200:203], v[28:31], v[16:19]
    v_mfma_f32_16x16x32_bf16 v[20:23], a[204:207], v[28:31], v[20:23]
    s_waitcnt vmcnt(5)
    v_mfma_f32_16x16x32_bf16 v[16:19], a[208:211], v[32:35], v[16:19]
    v_mfma_f32_16x16x32_bf16 v[20:23], a[212:215], v[32:35], v[20:23]
    s_waitcnt vmcnt(4)
    v_mfma_f32_16x16x32_bf16 v[16:19], a[216:219], v[36:39], v[16:19]
    v_mfma_f32_16x16x32_bf16 v[20:23], a[220:223], v[36:39], v[20:23]
    s_waitcnt vmcnt(3)
    v_mfma_f32_16x16x32_bf16 v[16:19], a[224:227], v[40:43], v[16:19]
    v_mfma_f32_16x16x32_bf16 v[20:23], a[228:231], v[40:43], v[20:23]
    s_waitcnt vmcnt(2)
    v_mfma_f32_16x16x32_bf16 v[16:19], a[232:235], v[44:47], v[16:19]
    v_mfma_f32_16x16x32_bf16 v[20:23], a[236:239], v[44:47], v[20:23]
    s_waitcnt vmcnt(1)
    v_mfma_f32_16x16x32_bf16 v[16:19], a[240:243], v[48:51], v[16:19]
    v_mfma_f32_16x16x32_bf16 v[20:23], a[244:247], v[48:51], v[20:23]
    s_waitcnt vmcnt(0)
    v_mfma_f32_16x16x32_bf16 v[16:19], a[248:251], v[52:55], v[16:19]
    v_mfma_f32_16x16x32_bf16 v[20:23], a[252:255], v[52:55], v[20:23]
    ds_write_b128 v2, v[8:11] offset:0
    ds_write_b128 v2, v[12:15] offset:1024
    s_nop 4
    ds_write_b128 v2, v[16:19] offset:8192
    ds_write_b128 v2, v[20:23] offset:9216
    s_cmp_lg_u32 s32, 0
    s_cbranch_scc1 o2_nb
    v_cmp_eq_u32 vcc, 0, v253
    s_nop 0
    s_cmp_eq_u64 vcc, 0
    s_cselect_b32 s44, 65536, 0
    v_or_b32 v250, s44, v250
    v_mov_b32 v251, 163832
    s_mov_b64 exec, 1
    ds_write_b32 v251, v250
    s_mov_b64 exec, -1
o2_nb:
    s_waitcnt lgkmcnt(0)
    s_barrier
    s_cmp_gt_u32 s32, 1
    s_cbranch_scc1 o2_skip
    s_lshl_b32 s18, s32, 13
    v_add_u32 v2, s18, v1
    ds_read_b128 v[24:27], v2 offset:0
    ds_read_b128 v[28:31], v2 offset:1024
    ds_read_b128 v[32:35], v2 offset:2048
    ds_read_b128 v[36:39], v2 offset:3072
    ds_read_b128 v[40:43], v2 offset:4096
    ds_read_b128 v[44:47], v2 offset:5120
    ds_read_b128 v[48:51], v2 offset:6144
    ds_read_b128 v[52:55], v2 offset:7168
    v_lshrrev_b32 v3, 4, v1
    v_bfe_u32 v4, v3, 2, 2
    v_lshlrev_b32 v4, 3, v4
    v_and_b32 v2, 3, v3
    v_add_u32 v4, v4, v2
    v_mul_u32_u24 v4, 2304, v4
    v_lshrrev_b32 v3, 4, v3
    v_lshl_add_u32 v4, v3, 4, v4
    s_add_u32 s20, s16, s32
    s_lshr_b32 s18, s20, 1
    s_lshl_b32 s18, s18, 3
    s_and_b32 s19, s20, 1
    s_add_u32 s18, s18, s19
    s_mul_i32 s18, s18, 9216
    s_lshl_b32 s19, s33, 6
    s_add_u32 s18, s18, s19
    s_waitcnt lgkmcnt(0)
    v_pk_add_f32 v[24:25], v[24:25], v[32:33]
    v_pk_add_f32 v[40:41], v[40:41], v[48:49]
    v_pk_add_f32 v[24:25], v[24:25], v[40:41]
    v_pk_add_f32 v[26:27], v[26:27], v[34:35]
    v_pk_add_f32 v[42:43], v[42:43], v[50:51]
    v_pk_add_f32 v[26:27], v[26:27], v[42:43]
    v_pk_add_f32 v[28:29], v[28:29], v[36:37]
    v_pk_add_f32 v[44:45], v[44:45], v[52:53]
    v_pk_add_f32 v[28:29], v[28:29], v[44:45]
    v_pk_add_f32 v[30:31], v[30:31], v[38:39]
    v_pk_add_f32 v[46:47], v[46:47], v[54:55]
    v_pk_add_f32 v[30:31], v[30:31], v[46:47]
    v_cvt_pk_bf16_f32 v8, v24, v28
    v_cvt_pk_bf16_f32 v9, v25, v29
    v_cvt_pk_bf16_f32 v10, v26, v30
    v_cvt_pk_bf16_f32 v11, v27, v31
    buffer_store_dwordx4 v[8:11], v4, s[8:11], s18 offen
o2_skip:
    s_nop 1
    s_branch L_op_fin
L_op_one:
o1_again:
    s_lshl_b32 s18, s16, 17
    s_lshl_b32 s19, s32, 15
    s_add_u32 s18, s18, s19
    s_add_u32 s18, s18, 50331648
    buffer_load_dwordx4 v[24:27], v1, s[4:7], s18 offen offset:0 sc1
    buffer_load_dwordx4 v[28:31], v1, s[4:7], s18 offen offset:1024 sc1
    buffer_load_dwordx4 v[32:35], v1, s[4:7], s18 offen offset:2048 sc1
    buffer_load_dwordx4 v[36:39], v1, s[4:7], s18 offen offset:3072 sc1
    s_add_u32 s18, s18, 4096
    buffer_load_dwordx4 v[40:43], v1, s[4:7], s18 offen offset:0 sc1
    buffer_load_dwordx4 v[44:47], v1, s[4:7], s18 offen offset:1024 sc1
    buffer_load_dwordx4 v[48:51], v1, s[4:7], s18 offen offset:2048 sc1
    buffer_load_dwordx4 v[52:55], v1, s[4:7], s18 offen offset:3072 sc1
    s_add_u32 s18, s18, 4096
    buffer_load_dwordx4 v[56:59], v1, s[4:7], s18 offen offset:0 sc1
    buffer_load_dwordx4 v[60:63], v1, s[4:7], s18 offen offset:1024 sc1
    buffer_load_dwordx4 v[64:67], v1, s[4:7], s18 offen offset:2048 sc1
    buffer_load_dwordx4 v[68:71], v1, s[4:7], s18 offen offset:3072 sc1
    s_add_u32 s18, s18, 4096
    buffer_load_dwordx4 v[72:75], v1, s[4:7], s18 offen offset:0 sc1
    buffer_load_dwordx4 v[76:79], v1, s[4:7], s18 offen offset:1024 sc1
    buffer_load_dwordx4 v[80:83], v1, s[4:7], s18 offen offset:2048 sc1
    buffer_load_dwordx4 v[84:87], v1, s[4:7], s18 offen offset:3072 sc1
    s_add_u32 s18, s18, 4096
    buffer_load_dwordx4 v[88:91], v1, s[4:7], s18 offen offset:0 sc1
    buffer_load_dwordx4 v[92:95], v1, s[4:7], s18 offen offset:1024 sc1
    buffer_load_dwordx4 v[96:99], v1, s[4:7], s18 offen offset:2048 sc1
    buffer_load_dwordx4 v[100:103], v1, s[4:7], s18 offen offset:3072 sc1
    s_add_u32 s18, s18, 4096
    buffer_load_dwordx4 v[104:107], v1, s[4:7], s18 offen offset:0 sc1
    buffer_load_dwordx4 v[108:111], v1, s[4:7], s18 offen offset:1024 sc1
    buffer_load_dwordx4 v[112:115], v1, s[4:7], s18 offen offset:2048 sc1
    buffer_load_dwordx4 v[116:119], v1, s[4:7], s18 offen offset:3072 sc1
    s_add_u32 s18, s18, 4096
    buffer_load_dwordx4 v[120:123], v1, s[4:7], s18 offen offset:0 sc1
    buffer_load_dwordx4 v[124:127], v1, s[4:7], s18 offen offset:1024 sc1
    buffer_load_dwordx4 v[128:131], v1, s[4:7], s18 offen offset:2048 sc1
    buffer_load_dwordx4 v[132:135], v1, s[4:7], s18 offen offset:3072 sc1
    s_add_u32 s18, s18, 4096
    buffer_load_dwordx4 v[136:139], v1, s[4:7], s18 offen offset:0 sc1
    buffer_load_dwordx4 v[140:143], v1, s[4:7], s18 offen offset:1024 sc1
    buffer_load_dwordx4 v[144:147], v1, s[4:7], s18 offen offset:2048 sc1
    buffer_load_dwordx4 v[148:151], v1, s[4:7], s18 offen offset:3072 sc1
    v_lshlrev_b32 v2, 4, v0
    v_and_b32 v3, 3072, v2
    v_lshl_add_u32 v2, v3, 1, v1
    s_waitcnt vmcnt(31)
    v_mfma_f32_16x16x32_bf16 v[8:11], a[0:3], v[24:27], 0
    v_max_u32 v6, v24, v25
    v_mfma_f32_16x16x32_bf16 v[12:15], a[4:7], v[24:27], 0
    v_max3_u32 v6, v6, v26, v27
    s_waitcnt vmcnt(30)
    v_mfma_f32_16x16x32_bf16 v[8:11], a[8:11], v[28:31], v[8:11]
    v_max3_u32 v6, v6, v28, v29
    v_mfma_f32_16x16x32_bf16 v[12:15], a[12:15], v[28:31], v[12:15]
    v_max3_u32 v6, v6, v30, v31
    s_waitcnt vmcnt(29)
    v_mfma_f32_16x16x32_bf16 v[8:11], a[16:19], v[32:35], v[8:11]
    v_max3_u32 v6, v6, v32, v33
    v_mfma_f32_16x16x32_bf16 v[12:15], a[20:23], v[32:35], v[12:15]
    v_max3_u32 v6, v6, v34, v35
    s_waitcnt vmcnt(28)
    v_mfma_f32_16x16x32_bf16 v[8:11], a[24:27], v[36:39], v[8:11]
    v_max3_u32 v6, v6, v36, v37
    v_mfma_f32_16x16x32_bf16 v[12:15], a[28:31], v[36:39], v[12:15]
    v_max3_u32 v6, v6, v38, v39
    s_waitcnt vmcnt(27)
    v_mfma_f32_16x16x32_bf16 v[8:11], a[32:35], v[40:43], v[8:11]
    v_max3_u32 v6, v6, v40, v41
    v_mfma_f32_16x16x32_bf16 v[12:15], a[36:39], v[40:43], v[12:15]
    v_max3_u32 v6, v6, v42, v43
    s_waitcnt vmcnt(26)
    v_mfma_f32_16x16x32_bf16 v[8:11], a[40:43], v[44:47], v[8:11]
    v_max3_u32 v6, v6, v44, v45
    v_mfma_f32_16x16x32_bf16 v[12:15], a[44:47], v[44:47], v[12:15]
    v_max3_u32 v6, v6, v46, v47
    s_waitcnt vmcnt(25)
    v_mfma_f32_16x16x32_bf16 v[8:11], a[48:51], v[48:51], v[8:11]
    v_max3_u32 v6, v6, v48, v49
    v_mfma_f32_16x16x32_bf16 v[12:15], a[52:55], v[48:51], v[12:15]
    v_max3_u32 v6, v6, v50, v51
    s_waitcnt vmcnt(24)
    v_mfma_f32_16x16x32_bf16 v[8:11], a[56:59], v[52:55], v[8:11]
    v_max3_u32 v6, v6, v52, v53
    v_mfma_f32_16x16x32_bf16 v[12:15], a[60:63], v[52:55], v[12:15]
    v_max3_u32 v6, v6, v54, v55
    s_waitcnt vmcnt(23)
    v_mfma_f32_16x16x32_bf16 v[8:11], a[64:67], v[56:59], v[8:11]
    v_max3_u32 v6, v6, v56, v57
    v_mfma_f32_16x16x32_bf16 v[12:15], a[68:71], v[56:59], v[12:15]
    v_max3_u32 v6, v6, v58, v59
    s_waitcnt vmcnt(22)
    v_mfma_f32_16x16x32_bf16 v[8:11], a[72:75], v[60:63], v[8:11]
    v_max3_u32 v6, v6, v60, v61
    v_mfma_f32_16x16x32_bf16 v[12:15], a[76:79], v[60:63], v[12:15]
    v_max3_u32 v6, v6, v62, v63
    s_waitcnt vmcnt(21)
    v_mfma_f32_16x16x32_bf16 v[8:11], a[80:83], v[64:67], v[8:11]
    v_max3_u32 v6, v6, v64, v65
    v_mfma_f32_16x16x32_bf16 v[12:15], a[84:87], v[64:67], v[12:15]
    v_max3_u32 v6, v6, v66, v67
    s_waitcnt vmcnt(20)
    v_mfma_f32_16x16x32_bf16 v[8:11], a[88:91], v[68:71], v[8:11]
    v_max3_u32 v6, v6, v68, v69
    v_mfma_f32_16x16x32_bf16 v[12:15], a[92:95], v[68:71], v[12:15]
    v_max3_u32 v6, v6, v70, v71
    s_waitcnt vmcnt(19)
    v_mfma_f32_16x16x32_bf16 v[8:11], a[96:99], v[72:75], v[8:11]
    v_max3_u32 v6, v6, v72, v73
    v_mfma_f32_16x16x32_bf16 v[12:15], a[100:103], v[72:75], v[12:15]
    v_max3_u32 v6, v6, v74, v75
    s_waitcnt vmcnt(18)
    v_mfma_f32_16x16x32_bf16 v[8:11], a[104:107], v[76:79], v[8:11]
    v_max3_u32 v6, v6, v76, v77
    v_mfma_f32_16x16x32_bf16 v[12:15], a[108:111], v[76:79], v[12:15]
    v_max3_u32 v6, v6, v78, v79
    s_waitcnt vmcnt(17)
    v_mfma_f32_16x16x32_bf16 v[8:11], a[112:115], v[80:83], v[8:11]
    v_max3_u32 v6, v6, v80, v81
    v_mfma_f32_16x16x32_bf16 v[12:15], a[116:119], v[80:83], v[12:15]
    v_max3_u32 v6, v6, v82, v83
    s_waitcnt vmcnt(16)
    v_mfma_f32_16x16x32_bf16 v[8:11], a[120:123], v[84:87], v[8:11]
    v_max3_u32 v6, v6, v84, v85
    v_mfma_f32_16x16x32_bf16 v[12:15], a[124:127], v[84:87], v[12:15]
    v_max3_u32 v6, v6, v86, v87
    s_waitcnt vmcnt(15)
    v_mfma_f32_16x16x32_bf16 v[8:11], a[128:131], v[88:91], v[8:11]
    v_max3_u32 v6, v6, v88, v89
    v_mfma_f32_16x16x32_bf16 v[12:15], a[132:135], v[88:91], v[12:15]
    v_max3_u32 v6, v6, v90, v91
    s_waitcnt vmcnt(14)
    v_mfma_f32_16x16x32_bf16 v[8:11], a[136:139], v[92:95], v[8:11]
    v_max3_u32 v6, v6, v92, v93
    v_mfma_f32_16x16x32_bf16 v[12:15], a[140:143], v[92:95], v[12:15]
    v_max3_u32 v6, v6, v94, v95
    s_waitcnt vmcnt(13)
    v_mfma_f32_16x16x32_bf16 v[8:11], a[144:147], v[96:99], v[8:11]
    v_max3_u32 v6, v6, v96, v97
    v_mfma_f32_16x16x32_bf16 v[12:15], a[148:151], v[96:99], v[12:15]
    v_max3_u32 v6, v6, v98, v99
    s_waitcnt vmcnt(12)
    v_mfma_f32_16x16x32_bf16 v[8:11], a[152:155], v[100:103], v[8:11]
    v_max3_u32 v6, v6, v100, v101
    v_mfma_f32_16x16x32_bf16 v[12:15], a[156:159], v[100:103], v[12:15]
    v_max3_u32 v6, v6, v102, v103
    s_waitcnt vmcnt(11)
    v_mfma_f32_16x16x32_bf16 v[8:11], a[160:163], v[104:107], v[8:11]
    v_max3_u32 v6, v6, v104, v105
    v_mfma_f32_16x16x32_bf16 v[12:15], a[164:167], v[104:107], v[12:15]
    v_max3_u32 v6, v6, v106, v107
    s_waitcnt vmcnt(10)
    v_mfma_f32_16x16x32_bf16 v[8:11], a[168:171], v[108:111], v[8:11]
    v_max3_u32 v6, v6, v108, v109
    v_mfma_f32_16x16x32_bf16 v[12:15], a[172:175], v[108:111], v[12:15]
    v_max3_u32 v6, v6, v110, v111
    s_waitcnt vmcnt(9)
    v_mfma_f32_16x16x32_bf16 v[8:11], a[176:179], v[112:115], v[8:11]
    v_max3_u32 v6, v6, v112, v113
    v_mfma_f32_16x16x32_bf16 v[12:15], a[180:183], v[112:115], v[12:15]
    v_max3_u32 v6, v6, v114, v115
    s_waitcnt vmcnt(8)
    v_mfma_f32_16x16x32_bf16 v[8:11], a[184:187], v[116:119], v[8:11]
    v_max3_u32 v6, v6, v116, v117
    v_mfma_f32_16x16x32_bf16 v[12:15], a[188:191], v[116:119], v[12:15]
    v_max3_u32 v6, v6, v118, v119
    s_waitcnt vmcnt(7)
    v_mfma_f32_16x16x32_bf16 v[8:11], a[192:195], v[120:123], v[8:11]
    v_max3_u32 v6, v6, v120, v121
    v_mfma_f32_16x16x32_bf16 v[12:15], a[196:199], v[120:123], v[12:15]
    v_max3_u32 v6, v6, v122, v123
    s_waitcnt vmcnt(6)
    v_mfma_f32_16x16x32_bf16 v[8:11], a[200:203], v[124:127], v[8:11]
    v_max3_u32 v6, v6, v124, v125
    v_mfma_f32_16x16x32_bf16 v[12:15], a[204:207], v[124:127], v[12:15]
    v_max3_u32 v6, v6, v126, v127
    s_waitcnt vmcnt(5)
    v_mfma_f32_16x16x32_bf16 v[8:11], a[208:211], v[128:131], v[8:11]
    v_max3_u32 v6, v6, v128, v129
    v_mfma_f32_16x16x32_bf16 v[12:15], a[212:215], v[128:131], v[12:15]
    v_max3_u32 v6, v6, v130, v131
    s_waitcnt vmcnt(4)
    v_mfma_f32_16x16x32_bf16 v[8:11], a[216:219], v[132:135], v[8:11]
    v_max3_u32 v6, v6, v132, v133
    v_mfma_f32_16x16x32_bf16 v[12:15], a[220:223], v[132:135], v[12:15]
    v_max3_u32 v6, v6, v134, v135
    s_waitcnt vmcnt(3)
    v_mfma_f32_16x16x32_bf16 v[8:11], a[224:227], v[136:139], v[8:11]
    v_max3_u32 v6, v6, v136, v137
    v_mfma_f32_16x16x32_bf16 v[12:15], a[228:231], v[136:139], v[12:15]
    v_max3_u32 v6, v6, v138, v139
    s_waitcnt vmcnt(2)
    v_mfma_f32_16x16x32_bf16 v[8:11], a[232:235], v[140:143], v[8:11]
    v_max3_u32 v6, v6, v140, v141
    v_mfma_f32_16x16x32_bf16 v[12:15], a[236:239], v[140:143], v[12:15]
    v_max3_u32 v6, v6, v142, v143
    s_waitcnt vmcnt(1)
    v_mfma_f32_16x16x32_bf16 v[8:11], a[240:243], v[144:147], v[8:11]
    v_max3_u32 v6, v6, v144, v145
    v_mfma_f32_16x16x32_bf16 v[12:15], a[244:247], v[144:147], v[12:15]
    v_max3_u32 v6, v6, v146, v147
    s_waitcnt vmcnt(0)
    v_mfma_f32_16x16x32_bf16 v[8:11], a[248:251], v[148:151], v[8:11]
    v_max3_u32 v6, v6, v148, v149
    v_mfma_f32_16x16x32_bf16 v[12:15], a[252:255], v[148:151], v[12:15]
    v_max3_u32 v6, v6, v150, v151
    v_cmp_eq_u32 vcc, -1, v6
    s_cbranch_vccz o1_ok
    s_cmp_eq_u32 s46, 0
    s_cbranch_scc1 o1_ok
    s_mov_b32 s46, 0
    s_nop 1
    v_mbcnt_lo_u32_b32 v2, -1, 0
    v_mbcnt_hi_u32_b32 v2, -1, v2
    v_min_u32 v2, 1, v2
    v_lshlrev_b32 v2, 2, v2
    s_mov_b32 s88, 4194304
fw23:
    buffer_load_dword v3, v2, s[4:7], s89 offen offset:0 sc1
    s_sub_u32 s88, s88, 1
    s_cbranch_scc1 fw23x
    s_waitcnt vmcnt(0)
    v_cmp_ne_u32 vcc, s95, v3
    s_cbranch_vccz fw23x
    s_sleep 1
    s_branch fw23
fw23x:
    s_branch o1_again
o1_ok:
    s_nop 7
    ds_write_b128 v2, v[8:11] offset:0
    ds_write_b128 v2, v[12:15] offset:1024
    s_cmp_lg_u32 s32, 0
    s_cbranch_scc1 o1_nb
    v_cmp_eq_u32 vcc, 0, v253
    s_nop 0
    s_cmp_eq_u64 vcc, 0
    s_cselect_b32 s44, 65536, 0
    v_or_b32 v250, s44, v250
    v_mov_b32 v251, 163832
    s_mov_b64 exec, 1
    ds_write_b32 v251, v250
    s_mov_b64 exec, -1
o1_nb:
    s_waitcnt lgkmcnt(0)
    s_barrier
    s_cmp_gt_u32 s32, 0
    s_cbranch_scc1 o1_skip
    s_lshl_b32 s18, s32, 13
    v_add_u32 v2, s18, v1
    ds_read_b128 v[24:27], v2 offset:0
    ds_read_b128 v[28:31], v2 offset:1024
    ds_read_b128 v[32:35], v2 offset:2048
    ds_read_b128 v[36:39], v2 offset:3072
    ds_read_b128 v[40:43], v2 offset:4096
    ds_read_b128 v[44:47], v2 offset:5120
    ds_read_b128 v[48:51], v2 offset:6144
    ds_read_b128 v[52:55], v2 offset:7168
    v_lshrrev_b32 v3, 4, v1
    v_bfe_u32 v4, v3, 2, 2
    v_lshlrev_b32 v4, 3, v4
    v_and_b32 v2, 3, v3
    v_add_u32 v4, v4, v2
    v_mul_u32_u24 v4, 2304, v4
    v_lshrrev_b32 v3, 4, v3
    v_lshl_add_u32 v4, v3, 4, v4
    s_add_u32 s20, s16, s32
    s_lshr_b32 s18, s20, 1
    s_lshl_b32 s18, s18, 3
    s_and_b32 s19, s20, 1
    s_add_u32 s18, s18, s19
    s_mul_i32 s18, s18, 9216
    s_lshl_b32 s19, s33, 6
    s_add_u32 s18, s18, s19
    s_waitcnt lgkmcnt(0)
    v_pk_add_f32 v[24:25], v[24:25], v[32:33]
    v_pk_add_f32 v[40:41], v[40:41], v[48:49]
    v_pk_add_f32 v[24:25], v[24:25], v[40:41]
    v_pk_add_f32 v[26:27], v[26:27], v[34:35]
    v_pk_add_f32 v[42:43], v[42:43], v[50:51]
    v_pk_add_f32 v[26:27], v[26:27], v[42:43]
    v_pk_add_f32 v[28:29], v[28:29], v[36:37]
    v_pk_add_f32 v[44:45], v[44:45], v[52:53]
    v_pk_add_f32 v[28:29], v[28:29], v[44:45]
    v_pk_add_f32 v[30:31], v[30:31], v[38:39]
    v_pk_add_f32 v[46:47], v[46:47], v[54:55]
    v_pk_add_f32 v[30:31], v[30:31], v[46:47]
    v_cvt_pk_bf16_f32 v8, v24, v28
    v_cvt_pk_bf16_f32 v9, v25, v29
    v_cvt_pk_bf16_f32 v10, v26, v30
    v_cvt_pk_bf16_f32 v11, v27, v31
    buffer_store_dwordx4 v[8:11], v4, s[8:11], s18 offen
o1_skip:
    s_nop 1
L_op_fin:
    v_mov_b32 v251, 163832
    ds_read_b32 v252, v251
    s_waitcnt lgkmcnt(0)
    v_readfirstlane_b32 s40, v252
    s_nop 1
    s_cmp_ge_u32 s40, 65608
    s_cbranch_scc1 L_done
    s_barrier
    s_and_b32 s16, s40, 0xffff
    s_cmp_lt_u32 s16, 72
    s_cbranch_scc1 L_op_seg
L_op_nextcb:
    s_mov_b32 s40, -1
    s_cmp_lg_u32 s32, 0
    s_cbranch_scc1 L_op_dec
    v_and_b32 v1, 63, v0
    v_min_u32 v1, 17, v1
    v_lshlrev_b32 v2, 2, v1
    buffer_load_dword v3, v2, s[84:87], 0 offen offset:136 sc1
    s_waitcnt vmcnt(0)
    v_cmp_gt_u32 vcc, 52, v3
    s_nop 0
    s_and_b32 s40, vcc_lo, 262143
    s_lshl_b32 s41, s40, 18
    s_lshr_b32 s43, s40, 14
    s_or_b32 s42, s40, s41
    s_and_b32 s36, s45, 15
    s_bfm_b32 s37, s36, 0
    s_and_b32 s37, s37, 42315
    s_bcnt1_i32_b32 s37, s37
    s_lshr_b32 s36, s45, 4
    s_mul_i32 s36, s36, 8
    s_add_u32 s36, s36, s37
    s_add_u32 s36, s36, 38
    s_mul_hi_u32 s41, s36, 0x0e38e38f
    s_mul_i32 s41, s41, 18
    s_sub_u32 s41, s36, s41
    s_lshr_b64 s[42:43], s[42:43], s41
    s_ff1_i32_b64 s40, s[42:43]
    s_cmp_lt_i32 s40, 0
    s_cbranch_scc1 L_op_dec
    s_add_u32 s40, s40, s41
    s_sub_u32 s41, s40, 18
    s_cselect_b32 s40, s40, s41
L_op_dec:
    v_mov_b32 v250, s40
    v_mov_b32 v251, 163832
    s_cmp_lg_u32 s32, 0
    s_cbranch_scc1 L_op_nw
    ds_write_b32 v251, v250
    s_waitcnt lgkmcnt(0)
L_op_nw:
    s_barrier
    ds_read_b32 v252, v251
    s_waitcnt lgkmcnt(0)
    v_readfirstlane_b32 s33, v252
    s_barrier
    s_nop 1
    s_cmp_lt_u32 s33, 18
    s_cbranch_scc1 L_op_start
L_done:
L_exit:
    s_endpgm
.section .rodata,"a"
.p2align 6
.amdhsa_kernel concat_heads__memory_aug_recurrent_mem_tr__ssm_conv_s4d__prompt_kernel
  .amdhsa_next_free_vgpr 512
  .amdhsa_next_free_sgpr 102
  .amdhsa_accum_offset 256
  .amdhsa_group_segment_fixed_size 0
  .amdhsa_kernarg_size 136
  .amdhsa_user_sgpr_count 2
  .amdhsa_user_sgpr_kernarg_segment_ptr 1
  .amdhsa_system_sgpr_workgroup_id_x 1
.end_amdhsa_kernel
.text
```

```asm
; @launch grid=(256,1,1) block=(256,1,1) lds=163840
.amdgcn_target "amdgcn-amd-amdhsa--gfx950"
.text
.globl concat_heads__memory_aug_recurrent_mem_tr__ssm_conv_s4d__prompt_kernel
.p2align 8
.type concat_heads__memory_aug_recurrent_mem_tr__ssm_conv_s4d__prompt_kernel,@function
concat_heads__memory_aug_recurrent_mem_tr__ssm_conv_s4d__prompt_kernel:
    s_cmp_ge_u32 s2, 256
    s_cbranch_scc1 L_exit
    s_load_dwordx4 s[80:83], s[0:1], 120
    s_load_dwordx16 s[48:63], s[0:1], 0
    s_memrealtime s[90:91]
    v_lshrrev_b32 v1, 6, v0
    s_nop 0
    v_readfirstlane_b32 s32, v1
    s_waitcnt lgkmcnt(0)
    s_mov_b32 s4, s82
    s_mov_b32 s5, s83
    s_mov_b32 s6, 268435456
    s_mov_b32 s7, 0x20000
    s_mov_b32 s84, s80
    s_mov_b32 s85, s81
    s_mov_b32 s86, 256
    s_mov_b32 s87, 0x20000
    s_cmp_lg_u32 s32, 0
    s_cbranch_scc1 L_nod0
L_nod0:
    s_cmp_lg_u32 s32, 3
    s_cbranch_scc1 L_nowarm
    s_getpc_b64 s[44:45]
L_pcw:
    v_and_b32 v1, 63, v0
    v_lshlrev_b32 v1, 7, v1
    s_mul_hi_u32 s46, s2, 477218589
    s_mul_i32 s47, s46, 9
    s_sub_u32 s47, s2, s47
    s_add_u32 s46, s46, s47
    s_mul_hi_u32 s40, s46, 477218589
    s_mul_i32 s40, s40, 9
    s_sub_u32 s46, s46, s40
    s_lshl_b32 s47, s47, 13
    v_add_u32 v2, s47, v1
    v_min_u32 v2, L_exit-L_pcw, v2
    global_load_dword v240, v2, s[44:45]
    s_lshl_b32 s46, s46, 13
    v_add_u32 v2, s46, v1
    v_min_u32 v2, L_exit-L_pcw, v2
    global_load_dword v241, v2, s[44:45]
L_nowarm:
    s_getreg_b32 s3, hwreg(HW_REG_XCC_ID)
    s_and_b32 s3, s3, 15
    s_cmp_lg_u32 s3, 3
    s_cbranch_scc1 L_helper
    s_mov_b32 s37, 128
    v_mov_b32 v250, 1
    v_mov_b32 v251, 163832
    v_cmp_eq_u32 vcc, 0, v0
    s_nop 0
    s_and_saveexec_b64 s[38:39], vcc
    s_cbranch_execz tk1
    buffer_atomic_add v250, off, s[84:87], s37 sc0
    s_waitcnt vmcnt(0)
    ds_write_b32 v251, v250
    s_waitcnt lgkmcnt(0)
tk1:
    s_mov_b64 exec, -1
    s_barrier
    ds_read_b32 v252, v251
    s_waitcnt lgkmcnt(0)
    v_readfirstlane_b32 s12, v252
    s_barrier
    s_nop 3
    s_cmp_ge_u32 s12, 32
    s_cbranch_scc1 L_helper
L_chain:
    s_mov_b64 s[48:49], s[50:51]
    s_mov_b64 s[50:51], s[52:53]
    s_mov_b64 s[52:53], s[54:55]
    s_mov_b64 s[54:55], s[56:57]
    s_mov_b64 s[56:57], s[58:59]
    v_lshrrev_b32 v77, 6, v0
    s_nop 0
    v_readfirstlane_b32 s13, v77
    v_lshlrev_b32 v65, 4, v0
    v_and_b32 v48, 63, v0
    s_mov_b32 s10, 4718592
    s_mov_b32 s11, 0x20000
    v_lshrrev_b32 v49, 3, v48
    v_mul_u32_u24 v18, 1152, v49
    v_and_b32 v49, 7, v48
    v_lshl_add_u32 v18, v49, 4, v18
    s_mul_i32 s40, s12, 147456
    s_lshl_b32 s41, s13, 8
    s_add_u32 s40, s40, s41
    s_mov_b32 s42, s40
    s_xor_b32 s41, s13, 0
    s_mul_i32 s41, s41, 36864
    s_add_u32 s60, s41, s40
    s_xor_b32 s41, s13, 1
    s_mul_i32 s41, s41, 36864
    s_add_u32 s61, s41, s40
    s_xor_b32 s41, s13, 2
    s_mul_i32 s41, s41, 36864
    s_add_u32 s62, s41, s40
    s_xor_b32 s41, s13, 3
    s_mul_i32 s41, s41, 36864
    s_add_u32 s63, s41, s40
    s_lshl_b32 s43, s13, 12
    s_mov_b64 s[8:9], s[56:57]
    s_add_u32 m0, s43, 147456
    s_add_u32 s41, s60, 0
    buffer_load_dwordx4 v18, s[8:11], s41 offen offset:0 nt lds
    s_add_u32 s41, s60, 8192
    buffer_load_dwordx4 v18, s[8:11], s41 offen offset:1024 nt lds
    s_add_u32 s41, s60, 16384
    buffer_load_dwordx4 v18, s[8:11], s41 offen offset:2048 nt lds
    s_add_u32 s41, s60, 24576
    buffer_load_dwordx4 v18, s[8:11], s41 offen offset:3072 nt lds
    s_add_u32 m0, s43, 0
    s_add_u32 s41, s61, 0
    buffer_load_dwordx4 v18, s[8:11], s41 offen offset:0 nt lds
    s_add_u32 s41, s61, 8192
    buffer_load_dwordx4 v18, s[8:11], s41 offen offset:1024 nt lds
    s_add_u32 s41, s61, 16384
    buffer_load_dwordx4 v18, s[8:11], s41 offen offset:2048 nt lds
    s_add_u32 s41, s61, 24576
    buffer_load_dwordx4 v18, s[8:11], s41 offen offset:3072 nt lds
    s_add_u32 m0, s43, 36864
    s_add_u32 s41, s62, 0
    buffer_load_dwordx4 v18, s[8:11], s41 offen offset:0 nt lds
    s_add_u32 s41, s62, 8192
    buffer_load_dwordx4 v18, s[8:11], s41 offen offset:1024 nt lds
    s_add_u32 s41, s62, 16384
    buffer_load_dwordx4 v18, s[8:11], s41 offen offset:2048 nt lds
    s_add_u32 s41, s62, 24576
    buffer_load_dwordx4 v18, s[8:11], s41 offen offset:3072 nt lds
    s_add_u32 m0, s43, 73728
    s_add_u32 s41, s63, 0
    buffer_load_dwordx4 v18, s[8:11], s41 offen offset:0 nt lds
    s_add_u32 s41, s63, 8192
    buffer_load_dwordx4 v18, s[8:11], s41 offen offset:1024 nt lds
    s_add_u32 s41, s63, 16384
    buffer_load_dwordx4 v18, s[8:11], s41 offen offset:2048 nt lds
    s_add_u32 s41, s63, 24576
    buffer_load_dwordx4 v18, s[8:11], s41 offen offset:3072 nt lds
    v_lshrrev_b32 v49, 1, v48
    v_mul_u32_u24 v19, 1152, v49
    v_and_b32 v49, 1, v48
    v_lshl_add_u32 v19, v49, 4, v19
    s_mul_i32 s41, s13, 224
    s_sub_u32 s41, 1024, s41
    v_add_u32 v19, s41, v19
    v_lshrrev_b32 v49, 4, v48
    v_lshlrev_b32 v50, 2, v49
    v_and_b32 v51, 15, v48
    v_xor_b32 v51, v51, v50
    v_lshlrev_b32 v51, 4, v51
    v_lshl_add_u32 v16, v49, 15, v51
    v_lshrrev_b32 v50, 1, v49
    v_lshl_add_u32 v17, v50, 16, v51
    v_and_b32 v50, 1, v49
    v_lshl_add_u32 v17, v50, 13, v17
    s_lshl_b32 s40, s12, 8
    s_mul_i32 s58, s13, 1048576
    s_add_u32 s58, s58, s40
    s_lshr_b32 s41, s13, 1
    s_mul_i32 s59, s41, 262144
    s_and_b32 s41, s13, 1
    s_lshl_b32 s41, s41, 14
    s_add_u32 s59, s59, s41
    s_add_u32 s59, s59, s40
    s_add_u32 s59, s59, 4194304
    v_bfe_u32 v50, v48, 2, 2
    v_xor_b32 v51, s13, v50
    v_lshlrev_b32 v20, 6, v51
    v_and_b32 v51, 3, v48
    v_lshl_add_u32 v20, v51, 4, v20
    v_lshrrev_b32 v23, 2, v48
    v_lshl_add_u32 v20, v23, 8, v20
    s_xor_b32 s41, s43, 0
    v_add_u32 v24, s41, v20
    s_xor_b32 s41, s43, 4096
    v_add_u32 v25, s41, v20
    s_xor_b32 s41, s43, 8192
    v_add_u32 v26, s41, v20
    s_xor_b32 s41, s43, 12288
    v_add_u32 v27, s41, v20
    v_and_b32 v23, 1, v50
    v_lshl_add_u32 v23, v49, 2, v23
    v_lshrrev_b32 v50, 1, v50
    v_lshlrev_b32 v21, 7, v23
    v_lshl_add_u32 v21, v50, 6, v21
    v_lshrrev_b32 v16, 1, v51
    v_lshl_add_u32 v21, v16, 5, v21
    v_and_b32 v16, 1, v51
    v_lshl_add_u32 v21, v16, 3, v21
    v_add_u32 v21, s43, v21
    v_lshlrev_b32 v22, 9, v50
    v_xor_b32 v22, v22, v21
    v_lshlrev_b32 v23, 5, v23
    v_lshl_add_u32 v23, v50, 10, v23
    v_lshl_add_u32 v23, v51, 3, v23
    v_add_u32 v23, s43, v23
    v_bfe_u32 v60, v65, 4, 6
    v_and_b32 v61, 15, v60
    v_lshrrev_b32 v62, 4, v60
    v_mov_b32 v64, 0x4444
    v_mov_b32 v77, 0xeeee
    v_cmp_lt_u32 vcc, 7, v61
    s_nop 1
    v_cndmask_b32 v64, v64, v77, vcc
    v_xor_b32 v66, 1024, v65
    v_xor_b32 v67, 2048, v65
    v_xor_b32 v68, 3072, v65
    v_and_b32 v69, 511, v65
    s_mul_i32 s96, s13, 36864
    s_add_u32 s96, s96, 16384
    v_lshlrev_b32 v70, 4, v60
    v_add_u32 v70, s96, v70
    v_lshrrev_b32 v79, 1, v69
    s_lshl_b32 s96, s13, 8
    s_add_u32 s96, s96, 14336
    s_lshl_b32 s33, s13, 10
    s_add_u32 s97, s33, 8192
    v_mov_b32 v77, s97
    v_mov_b32 v78, s96
    v_cmp_lt_u32 vcc, 31, v60
    s_nop 1
    v_cndmask_b32 v71, v77, v78, vcc
    v_add_u32 v71, v71, v79
    v_and_b32 v77, 7, v61
    v_lshrrev_b32 v78, 3, v61
    v_lshlrev_b32 v74, 4, v77
    v_lshl_add_u32 v73, v62, 7, v74
    v_lshl_add_u32 v73, v78, 3, v73
    s_lshl_b32 s96, s13, 9
    v_add_u32 v73, s96, v73
    v_lshrrev_b32 v74, 1, v74
    v_lshl_add_u32 v74, v78, 14, v74
    v_lshl_add_u32 v74, v62, 15, v74
    s_lshl_b32 s96, s13, 17
    v_add_u32 v74, s96, v74
    v_bfe_u32 v77, v61, 2, 1
    v_and_b32 v78, 3, v61
    s_cmp_lt_u32 s13, 2
    s_cselect_b64 vcc, -1, 0
    v_cndmask_b32 v77, 0, v77, vcc
    v_lshlrev_b32 v75, 7, v77
    v_lshl_add_u32 v75, v62, 4, v75
    v_lshl_add_u32 v75, v78, 2, v75
    v_lshlrev_b32 v58, 3, v77
    v_lshl_add_u32 v58, v78, 1, v58
    s_bfe_u32 s97, s12, 0x10001
    s_lshl_b32 s68, s97, 6
    s_lshl_b32 s97, s97, 2
    v_add_u32 v59, s97, v62
    s_bfe_u32 s96, s12, 0x10002
    s_and_b32 s40, s12, 1
    s_lshl_b32 s96, s96, 1
    s_add_u32 s96, s96, s40
    s_lshr_b32 s97, s12, 3
    s_lshl_b32 s98, s13, 2
    s_add_u32 s98, s98, s97
    s_lshl_b32 s98, s98, 2
    s_add_u32 s98, s98, s96
    s_lshl_b32 s98, s98, 8
    s_lshl_b32 s99, s13, 2
    s_add_u32 s99, s99, s96
    s_lshl_b32 s99, s99, 4
    s_lshl_b32 s41, s97, 1
    s_add_u32 s41, s41, s40
    s_lshl_b32 s41, s41, 7
    s_add_u32 s41, s41, 8192
    s_lshl_b32 s40, s40, 3
    s_add_u32 s40, s40, 512
    s_cmp_lt_u32 s13, 2
    s_cselect_b32 s96, 7, 4
    s_cselect_b32 s98, s98, s41
    s_cselect_b32 s99, s99, s40
    s_cselect_b32 s32, 1, 0
    s_add_u32 s68, s68, s98
    s_lshl_b32 s97, s97, s96
    s_add_u32 s99, s99, s97
    v_add_u32 v58, s99, v58
    s_and_b32 s97, s12, 4
    s_or_b32 s97, s97, s13
    s_cmp_eq_u32 s97, 2
    s_cselect_b32 s32, 2, s32
    s_mov_b32 s8, s48
    s_mov_b32 s9, s49
    s_mov_b32 s10, 9216
    v_mul_u32_u24 v77, 1152, v59
    v_lshl_add_u32 v77, v58, 1, v77
    buffer_load_dword v72, v77, s[8:11], 0 offen
    s_mov_b32 s10, 4718592
    s_lshr_b32 s71, s52, 8
    s_add_u32 s71, s71, s12
    s_and_b32 s71, s71, 3
    s_waitcnt vmcnt(12) lgkmcnt(0)
    s_barrier
    s_cmp_eq_u32 s71, 1
    s_cbranch_scc1 cf_th0
    s_waitcnt vmcnt(6)
cf_th0:
    s_mov_b64 s[8:9], s[56:57]
    s_add_u32 m0, s43, 110592
    s_add_u32 s41, s42, 0
    buffer_load_dwordx4 v19, s[8:11], s41 offen offset:0 nt lds
    s_add_u32 s41, s42, 35840
    buffer_load_dwordx4 v19, s[8:11], s41 offen offset:1024 nt lds
    s_add_u32 s41, s42, 71680
    buffer_load_dwordx4 v19, s[8:11], s41 offen offset:2048 nt lds
    s_add_u32 s41, s42, 107520
    buffer_load_dwordx4 v19, s[8:11], s41 offen offset:3072 nt lds
    v_mov_b32 v78, v21
    v_mov_b32 v79, v22
    v_add_u32 v77, 147456, v79
    ds_read_b64_tr_b16 v[80:81], v77 offset:0
    ds_read_b64_tr_b16 v[82:83], v77 offset:256
    ds_read_b64_tr_b16 v[84:85], v77 offset:2048
    ds_read_b64_tr_b16 v[86:87], v77 offset:2304
    ds_read_b64_tr_b16 v[112:113], v77 offset:16
    ds_read_b64_tr_b16 v[114:115], v77 offset:272
    ds_read_b64_tr_b16 v[116:117], v77 offset:2064
    ds_read_b64_tr_b16 v[118:119], v77 offset:2320
    s_waitcnt vmcnt(12) lgkmcnt(0)
    s_barrier
    s_cmp_eq_u32 s71, 1
    s_cbranch_scc1 cf_th1
    s_waitcnt vmcnt(6)
cf_th1:
    s_mov_b64 s[8:9], s[52:53]
    s_add_u32 m0, s43, 147456
    s_add_u32 s41, s58, 0
    buffer_load_dwordx4 v17, s[8:11], s41 offen offset:0 nt lds
    s_add_u32 s41, s58, 31744
    buffer_load_dwordx4 v17, s[8:11], s41 offen offset:1024 nt lds
    s_add_u32 s41, s58, 129024
    buffer_load_dwordx4 v17, s[8:11], s41 offen offset:2048 nt lds
    s_add_u32 s41, s58, 160768
    buffer_load_dwordx4 v17, s[8:11], s41 offen offset:3072 nt lds
    v_add_u32 v77, 0, v78
    ds_read_b64_tr_b16 v[88:89], v77 offset:0
    ds_read_b64_tr_b16 v[90:91], v77 offset:256
    ds_read_b64_tr_b16 v[92:93], v77 offset:2048
    ds_read_b64_tr_b16 v[94:95], v77 offset:2304
    ds_read_b64_tr_b16 v[120:121], v77 offset:16
    ds_read_b64_tr_b16 v[122:123], v77 offset:272
    ds_read_b64_tr_b16 v[124:125], v77 offset:2064
    ds_read_b64_tr_b16 v[126:127], v77 offset:2320
    s_waitcnt vmcnt(12) lgkmcnt(0)
    s_barrier
    s_cmp_eq_u32 s71, 1
    s_cbranch_scc1 cf_th2
    s_waitcnt vmcnt(6)
cf_th2:
    s_add_u32 m0, s43, 0
    s_add_u32 s41, s58, 16384
    buffer_load_dwordx4 v17, s[8:11], s41 offen offset:0 nt lds
    s_add_u32 s41, s58, 48128
    buffer_load_dwordx4 v17, s[8:11], s41 offen offset:1024 nt lds
    s_add_u32 s41, s58, 145408
    buffer_load_dwordx4 v17, s[8:11], s41 offen offset:2048 nt lds
    s_add_u32 s41, s58, 177152
    buffer_load_dwordx4 v17, s[8:11], s41 offen offset:3072 nt lds
    v_add_u32 v77, 36864, v78
    ds_read_b64_tr_b16 v[96:97], v77 offset:0
    ds_read_b64_tr_b16 v[98:99], v77 offset:256
    ds_read_b64_tr_b16 v[100:101], v77 offset:2048
    ds_read_b64_tr_b16 v[102:103], v77 offset:2304
    ds_read_b64_tr_b16 v[128:129], v77 offset:16
    ds_read_b64_tr_b16 v[130:131], v77 offset:272
    ds_read_b64_tr_b16 v[132:133], v77 offset:2064
    ds_read_b64_tr_b16 v[134:135], v77 offset:2320
    s_waitcnt vmcnt(12) lgkmcnt(0)
    s_barrier
    s_cmp_eq_u32 s71, 1
    s_cbranch_scc1 cf_th3
    s_waitcnt vmcnt(6)
cf_th3:
    s_add_u32 m0, s43, 36864
    s_add_u32 s41, s58, 262144
    buffer_load_dwordx4 v17, s[8:11], s41 offen offset:0 nt lds
    s_add_u32 s41, s58, 293888
    buffer_load_dwordx4 v17, s[8:11], s41 offen offset:1024 nt lds
    s_add_u32 s41, s58, 391168
    buffer_load_dwordx4 v17, s[8:11], s41 offen offset:2048 nt lds
    s_add_u32 s41, s58, 422912
    buffer_load_dwordx4 v17, s[8:11], s41 offen offset:3072 nt lds
    v_add_u32 v77, 73728, v78
    ds_read_b64_tr_b16 v[104:105], v77 offset:0
    ds_read_b64_tr_b16 v[106:107], v77 offset:256
    ds_read_b64_tr_b16 v[108:109], v77 offset:2048
    ds_read_b64_tr_b16 v[110:111], v77 offset:2304
    ds_read_b64_tr_b16 v[136:137], v77 offset:16
    ds_read_b64_tr_b16 v[138:139], v77 offset:272
    ds_read_b64_tr_b16 v[140:141], v77 offset:2064
    ds_read_b64_tr_b16 v[142:143], v77 offset:2320
    s_waitcnt vmcnt(12) lgkmcnt(0)
    s_barrier
    s_cmp_eq_u32 s71, 1
    s_cbranch_scc1 cf_th4
    s_waitcnt vmcnt(6)
cf_th4:
    s_add_u32 m0, s43, 73728
    s_add_u32 s41, s58, 278528
    buffer_load_dwordx4 v17, s[8:11], s41 offen offset:0 nt lds
    s_add_u32 s41, s58, 310272
    buffer_load_dwordx4 v17, s[8:11], s41 offen offset:1024 nt lds
    s_add_u32 s41, s58, 407552
    buffer_load_dwordx4 v17, s[8:11], s41 offen offset:2048 nt lds
    s_add_u32 s41, s58, 439296
    buffer_load_dwordx4 v17, s[8:11], s41 offen offset:3072 nt lds
    v_add_u32 v77, 110592, v23
    ds_read_b64_tr_b16 v[0:1], v77 offset:0
    ds_read_b64_tr_b16 v[2:3], v77 offset:64
    ds_read_b64_tr_b16 v[4:5], v77 offset:512
    ds_read_b64_tr_b16 v[6:7], v77 offset:576
    ds_read_b64_tr_b16 v[8:9], v77 offset:2048
    ds_read_b64_tr_b16 v[10:11], v77 offset:2112
    ds_read_b64_tr_b16 v[12:13], v77 offset:2560
    ds_read_b64_tr_b16 v[14:15], v77 offset:2624
    s_waitcnt vmcnt(12) lgkmcnt(0)
    s_barrier
    s_cmp_eq_u32 s71, 1
    s_cbranch_scc1 cf_th5
    s_waitcnt vmcnt(6)
cf_th5:
    s_add_u32 m0, s43, 110592
    s_add_u32 s41, s58, 524288
    buffer_load_dwordx4 v17, s[8:11], s41 offen offset:0 nt lds
    s_add_u32 s41, s58, 556032
    buffer_load_dwordx4 v17, s[8:11], s41 offen offset:1024 nt lds
    s_add_u32 s41, s58, 653312
    buffer_load_dwordx4 v17, s[8:11], s41 offen offset:2048 nt lds
    s_add_u32 s41, s58, 685056
    buffer_load_dwordx4 v17, s[8:11], s41 offen offset:3072 nt lds
    s_cmp_eq_u32 s32, 0
    s_cbranch_scc1 cf_init_done
    v_mov_b32 v52, 1
    v_mov_b32 v53, 1
    v_mov_b32 v54, 1
    v_mov_b32 v55, 1
    v_mov_b32 v56, 0
    s_lshl_b32 s96, s12, 14
    s_add_u32 s96, s96, 68157440
    s_add_u32 s97, s96, 0
    buffer_store_dwordx4 v[52:55], v65, s[4:7], s97 offen
    buffer_load_dwordx4 v[60:63], v65, s[4:7], s97 offen sc1
    s_add_u32 s97, s96, 4096
    buffer_store_dwordx4 v[52:55], v65, s[4:7], s97 offen
    buffer_load_dwordx4 v[60:63], v65, s[4:7], s97 offen sc1
    s_add_u32 s97, s96, 8192
    buffer_store_dwordx4 v[52:55], v65, s[4:7], s97 offen
    buffer_load_dwordx4 v[60:63], v65, s[4:7], s97 offen sc1
    s_add_u32 s97, s96, 12288
    buffer_store_dwordx4 v[52:55], v65, s[4:7], s97 offen
    buffer_load_dwordx4 v[60:63], v65, s[4:7], s97 offen sc1
    s_add_u32 s96, s68, 67108864
    s_add_u32 s97, s96, 16384
    buffer_store_dword v56, v75, s[4:7], s96 offen offset:0
    buffer_store_dword v72, v75, s[4:7], s97 offen offset:0
    buffer_load_dword v60, v75, s[4:7], s96 offen offset:0 sc1
    buffer_load_dword v60, v75, s[4:7], s97 offen offset:0 sc1
    s_cmp_lg_u32 s32, 2
    s_cbranch_scc1 cf_init_done
    buffer_store_dword v56, v75, s[4:7], s96 offen offset:1024
    buffer_store_dword v72, v75, s[4:7], s97 offen offset:1024
    buffer_load_dword v60, v75, s[4:7], s96 offen offset:1024 sc1
    buffer_load_dword v60, v75, s[4:7], s97 offen offset:1024 sc1
    buffer_store_dword v56, v75, s[4:7], s96 offen offset:2048
    buffer_store_dword v72, v75, s[4:7], s97 offen offset:2048
    buffer_load_dword v60, v75, s[4:7], s96 offen offset:2048 sc1
    buffer_load_dword v60, v75, s[4:7], s97 offen offset:2048 sc1
    buffer_store_dword v56, v75, s[4:7], s96 offen offset:3072
    buffer_store_dword v72, v75, s[4:7], s97 offen offset:3072
    buffer_load_dword v60, v75, s[4:7], s96 offen offset:3072 sc1
    buffer_load_dword v60, v75, s[4:7], s97 offen offset:3072 sc1
cf_init_done:
    ds_write_b64 v70, v[0:1] offset:16384
    ds_write_b64 v70, v[2:3] offset:16392
    ds_write_b64 v70, v[4:5] offset:17408
    ds_write_b64 v70, v[6:7] offset:17416
    ds_write_b64 v70, v[8:9] offset:18432
    ds_write_b64 v70, v[10:11] offset:18440
    ds_write_b64 v70, v[12:13] offset:19456
    ds_write_b64 v70, v[14:15] offset:19464
    v_add_u32 v28, 147456, v24
    v_add_u32 v29, 147456, v25
    v_add_u32 v30, 147456, v26
    v_add_u32 v31, 147456, v27
    ds_read_b64_tr_b16 a[96:97], v28 offset:0
    ds_read_b64_tr_b16 a[104:105], v28 offset:8
    ds_read_b64_tr_b16 a[112:113], v29 offset:0
    ds_read_b64_tr_b16 a[120:121], v29 offset:8
    ds_read_b64_tr_b16 a[128:129], v30 offset:0
    ds_read_b64_tr_b16 a[136:137], v30 offset:8
    ds_read_b64_tr_b16 a[144:145], v31 offset:0
    ds_read_b64_tr_b16 v[32:33], v31 offset:8
    s_waitcnt vmcnt(12) lgkmcnt(0)
    s_barrier
    s_cmp_eq_u32 s71, 1
    s_cbranch_scc1 cf_th6
    s_waitcnt vmcnt(6)
cf_th6:
    s_add_u32 m0, s43, 147456
    s_add_u32 s41, s58, 540672
    buffer_load_dwordx4 v17, s[8:11], s41 offen offset:0 nt lds
    s_add_u32 s41, s58, 572416
    buffer_load_dwordx4 v17, s[8:11], s41 offen offset:1024 nt lds
    s_add_u32 s41, s58, 669696
    buffer_load_dwordx4 v17, s[8:11], s41 offen offset:2048 nt lds
    s_add_u32 s41, s58, 701440
    buffer_load_dwordx4 v17, s[8:11], s41 offen offset:3072 nt lds
    ds_write_b64 v70, v[32:33] offset:12288
    v_add_u32 v28, 0, v24
    v_add_u32 v29, 0, v25
    v_add_u32 v30, 0, v26
    v_add_u32 v31, 0, v27
    ds_read_b64_tr_b16 a[98:99], v28 offset:0
    ds_read_b64_tr_b16 a[106:107], v28 offset:8
    ds_read_b64_tr_b16 a[114:115], v29 offset:0
    ds_read_b64_tr_b16 a[122:123], v29 offset:8
    ds_read_b64_tr_b16 a[130:131], v30 offset:0
    ds_read_b64_tr_b16 a[138:139], v30 offset:8
    ds_read_b64_tr_b16 a[146:147], v31 offset:0
    ds_read_b64_tr_b16 v[0:1], v31 offset:8
    s_waitcnt vmcnt(12) lgkmcnt(0)
    s_barrier
    s_cmp_eq_u32 s71, 1
    s_cbranch_scc1 cf_th7
    s_waitcnt vmcnt(6)
cf_th7:
    s_add_u32 m0, s43, 0
    s_add_u32 s41, s58, 786432
    buffer_load_dwordx4 v17, s[8:11], s41 offen offset:0 nt lds
    s_add_u32 s41, s58, 818176
    buffer_load_dwordx4 v17, s[8:11], s41 offen offset:1024 nt lds
    s_add_u32 s41, s58, 915456
    buffer_load_dwordx4 v17, s[8:11], s41 offen offset:2048 nt lds
    s_add_u32 s41, s58, 947200
    buffer_load_dwordx4 v17, s[8:11], s41 offen offset:3072 nt lds
    ds_write_b64 v70, v[0:1] offset:12296
    v_add_u32 v28, 36864, v24
    v_add_u32 v29, 36864, v25
    v_add_u32 v30, 36864, v26
    v_add_u32 v31, 36864, v27
    ds_read_b64_tr_b16 a[100:101], v28 offset:0
    ds_read_b64_tr_b16 a[108:109], v28 offset:8
    ds_read_b64_tr_b16 a[116:117], v29 offset:0
    ds_read_b64_tr_b16 a[124:125], v29 offset:8
    ds_read_b64_tr_b16 a[132:133], v30 offset:0
    ds_read_b64_tr_b16 a[140:141], v30 offset:8
    ds_read_b64_tr_b16 a[148:149], v31 offset:0
    ds_read_b64_tr_b16 v[32:33], v31 offset:8
    s_waitcnt vmcnt(12) lgkmcnt(0)
    s_barrier
    s_cmp_eq_u32 s71, 1
    s_cbranch_scc1 cf_th8
    s_waitcnt vmcnt(6)
cf_th8:
    s_add_u32 m0, s43, 36864
    s_add_u32 s41, s58, 802816
    buffer_load_dwordx4 v17, s[8:11], s41 offen offset:0 nt lds
    s_add_u32 s41, s58, 834560
    buffer_load_dwordx4 v17, s[8:11], s41 offen offset:1024 nt lds
    s_add_u32 s41, s58, 931840
    buffer_load_dwordx4 v17, s[8:11], s41 offen offset:2048 nt lds
    s_add_u32 s41, s58, 963584
    buffer_load_dwordx4 v17, s[8:11], s41 offen offset:3072 nt lds
    ds_write_b64 v70, v[32:33] offset:13312
    v_add_u32 v28, 73728, v24
    v_add_u32 v29, 73728, v25
    v_add_u32 v30, 73728, v26
    v_add_u32 v31, 73728, v27
    ds_read_b64_tr_b16 a[102:103], v28 offset:0
    ds_read_b64_tr_b16 a[110:111], v28 offset:8
    ds_read_b64_tr_b16 a[118:119], v29 offset:0
    ds_read_b64_tr_b16 a[126:127], v29 offset:8
    ds_read_b64_tr_b16 a[134:135], v30 offset:0
    ds_read_b64_tr_b16 a[142:143], v30 offset:8
    ds_read_b64_tr_b16 a[150:151], v31 offset:0
    ds_read_b64_tr_b16 v[0:1], v31 offset:8
    s_waitcnt vmcnt(12) lgkmcnt(0)
    s_barrier
    s_cmp_eq_u32 s71, 1
    s_cbranch_scc1 cf_th9
    s_waitcnt vmcnt(6)
cf_th9:
    s_add_u32 m0, s43, 73728
    s_add_u32 s41, s59, 0
    buffer_load_dwordx4 v17, s[8:11], s41 offen offset:0 nt lds
    s_add_u32 s41, s59, 31744
    buffer_load_dwordx4 v17, s[8:11], s41 offen offset:1024 nt lds
    s_add_u32 s41, s59, 129024
    buffer_load_dwordx4 v17, s[8:11], s41 offen offset:2048 nt lds
    s_add_u32 s41, s59, 160768
    buffer_load_dwordx4 v17, s[8:11], s41 offen offset:3072 nt lds
    ds_write_b64 v70, v[0:1] offset:13320
    v_add_u32 v28, 110592, v24
    v_add_u32 v29, 110592, v25
    v_add_u32 v30, 110592, v26
    v_add_u32 v31, 110592, v27
    ds_read_b64_tr_b16 a[152:153], v28 offset:0
    ds_read_b64_tr_b16 a[160:161], v28 offset:8
    ds_read_b64_tr_b16 a[168:169], v29 offset:0
    ds_read_b64_tr_b16 a[176:177], v29 offset:8
    ds_read_b64_tr_b16 a[184:185], v30 offset:0
    ds_read_b64_tr_b16 a[192:193], v30 offset:8
    ds_read_b64_tr_b16 a[200:201], v31 offset:0
    ds_read_b64_tr_b16 a[208:209], v31 offset:8
    s_waitcnt vmcnt(12) lgkmcnt(0)
    s_barrier
    s_cmp_eq_u32 s71, 1
    s_cbranch_scc1 cf_th10
    s_waitcnt vmcnt(6)
cf_th10:
    s_mov_b64 s[8:9], s[50:51]
    s_add_u32 m0, s43, 110592
    s_add_u32 s41, s58, 0
    buffer_load_dwordx4 v17, s[8:11], s41 offen offset:0 nt lds
    s_add_u32 s41, s58, 31744
    buffer_load_dwordx4 v17, s[8:11], s41 offen offset:1024 nt lds
    s_add_u32 s41, s58, 129024
    buffer_load_dwordx4 v17, s[8:11], s41 offen offset:2048 nt lds
    s_add_u32 s41, s58, 160768
    buffer_load_dwordx4 v17, s[8:11], s41 offen offset:3072 nt lds
    s_cmp_lg_u32 s13, 0
    s_cbranch_scc1 cf_ma
    v_mov_b32 v54, 1
    s_mov_b64 exec, 1
    buffer_atomic_add v54, off, s[84:87], 0 offset:132
    s_mov_b64 exec, -1
cf_ma:
    v_add_u32 v28, 147456, v24
    v_add_u32 v29, 147456, v25
    v_add_u32 v30, 147456, v26
    v_add_u32 v31, 147456, v27
    ds_read_b64_tr_b16 a[154:155], v28 offset:0
    ds_read_b64_tr_b16 a[162:163], v28 offset:8
    ds_read_b64_tr_b16 a[170:171], v29 offset:0
    ds_read_b64_tr_b16 a[178:179], v29 offset:8
    ds_read_b64_tr_b16 a[186:187], v30 offset:0
    ds_read_b64_tr_b16 a[194:195], v30 offset:8
    ds_read_b64_tr_b16 a[202:203], v31 offset:0
    ds_read_b64_tr_b16 a[210:211], v31 offset:8
    s_waitcnt vmcnt(12) lgkmcnt(0)
    s_barrier
    s_cmp_eq_u32 s71, 1
    s_cbranch_scc1 cf_th11
    s_waitcnt vmcnt(6)
cf_th11:
    s_add_u32 m0, s43, 147456
    s_add_u32 s41, s58, 16384
    buffer_load_dwordx4 v17, s[8:11], s41 offen offset:0 nt lds
    s_add_u32 s41, s58, 48128
    buffer_load_dwordx4 v17, s[8:11], s41 offen offset:1024 nt lds
    s_add_u32 s41, s58, 145408
    buffer_load_dwordx4 v17, s[8:11], s41 offen offset:2048 nt lds
    s_add_u32 s41, s58, 177152
    buffer_load_dwordx4 v17, s[8:11], s41 offen offset:3072 nt lds
    v_add_u32 v28, 0, v24
    v_add_u32 v29, 0, v25
    v_add_u32 v30, 0, v26
    v_add_u32 v31, 0, v27
    ds_read_b64_tr_b16 a[156:157], v28 offset:0
    ds_read_b64_tr_b16 a[164:165], v28 offset:8
    ds_read_b64_tr_b16 a[172:173], v29 offset:0
    ds_read_b64_tr_b16 a[180:181], v29 offset:8
    ds_read_b64_tr_b16 a[188:189], v30 offset:0
    ds_read_b64_tr_b16 a[196:197], v30 offset:8
    ds_read_b64_tr_b16 a[204:205], v31 offset:0
    ds_read_b64_tr_b16 a[212:213], v31 offset:8
    s_waitcnt vmcnt(12) lgkmcnt(0)
    s_barrier
    s_cmp_eq_u32 s71, 1
    s_cbranch_scc1 cf_th12
    s_waitcnt vmcnt(6)
cf_th12:
    s_add_u32 m0, s43, 0
    s_add_u32 s41, s58, 262144
    buffer_load_dwordx4 v17, s[8:11], s41 offen offset:0 nt lds
    s_add_u32 s41, s58, 293888
    buffer_load_dwordx4 v17, s[8:11], s41 offen offset:1024 nt lds
    s_add_u32 s41, s58, 391168
    buffer_load_dwordx4 v17, s[8:11], s41 offen offset:2048 nt lds
    s_add_u32 s41, s58, 422912
    buffer_load_dwordx4 v17, s[8:11], s41 offen offset:3072 nt lds
    v_add_u32 v28, 36864, v24
    v_add_u32 v29, 36864, v25
    v_add_u32 v30, 36864, v26
    v_add_u32 v31, 36864, v27
    ds_read_b64_tr_b16 a[158:159], v28 offset:0
    ds_read_b64_tr_b16 a[166:167], v28 offset:8
    ds_read_b64_tr_b16 a[174:175], v29 offset:0
    ds_read_b64_tr_b16 a[182:183], v29 offset:8
    ds_read_b64_tr_b16 a[190:191], v30 offset:0
    ds_read_b64_tr_b16 a[198:199], v30 offset:8
    ds_read_b64_tr_b16 a[206:207], v31 offset:0
    ds_read_b64_tr_b16 a[214:215], v31 offset:8
    s_waitcnt vmcnt(12) lgkmcnt(0)
    s_barrier
    s_cmp_eq_u32 s71, 1
    s_cbranch_scc1 cf_th13
    s_waitcnt vmcnt(6)
cf_th13:
    s_add_u32 m0, s43, 36864
    s_add_u32 s41, s58, 278528
    buffer_load_dwordx4 v17, s[8:11], s41 offen offset:0 nt lds
    s_add_u32 s41, s58, 310272
    buffer_load_dwordx4 v17, s[8:11], s41 offen offset:1024 nt lds
    s_add_u32 s41, s58, 407552
    buffer_load_dwordx4 v17, s[8:11], s41 offen offset:2048 nt lds
    s_add_u32 s41, s58, 439296
    buffer_load_dwordx4 v17, s[8:11], s41 offen offset:3072 nt lds
    v_add_u32 v77, 73728, v20
    ds_read_b64_tr_b16 a[216:217], v77 offset:0
    ds_read_b64_tr_b16 a[218:219], v77 offset:4096
    ds_read_b64_tr_b16 a[220:221], v77 offset:8192
    ds_read_b64_tr_b16 a[222:223], v77 offset:12288
    ds_read_b64_tr_b16 a[224:225], v77 offset:8
    ds_read_b64_tr_b16 a[226:227], v77 offset:4104
    ds_read_b64_tr_b16 a[228:229], v77 offset:8200
    ds_read_b64_tr_b16 a[230:231], v77 offset:12296
    s_waitcnt vmcnt(12) lgkmcnt(0)
    s_barrier
    s_cmp_eq_u32 s71, 1
    s_cbranch_scc1 cf_th14
    s_waitcnt vmcnt(6)
cf_th14:
    s_add_u32 m0, s43, 73728
    s_add_u32 s41, s58, 524288
    buffer_load_dwordx4 v17, s[8:11], s41 offen offset:0 nt lds
    s_add_u32 s41, s58, 556032
    buffer_load_dwordx4 v17, s[8:11], s41 offen offset:1024 nt lds
    s_add_u32 s41, s58, 653312
    buffer_load_dwordx4 v17, s[8:11], s41 offen offset:2048 nt lds
    s_add_u32 s41, s58, 685056
    buffer_load_dwordx4 v17, s[8:11], s41 offen offset:3072 nt lds
    v_add_u32 v28, 110592, v24
    v_add_u32 v29, 110592, v25
    v_add_u32 v30, 110592, v26
    v_add_u32 v31, 110592, v27
    ds_read_b64_tr_b16 v[0:1], v28 offset:0
    ds_read_b64_tr_b16 v[2:3], v28 offset:8
    ds_read_b64_tr_b16 v[4:5], v29 offset:0
    ds_read_b64_tr_b16 v[6:7], v29 offset:8
    ds_read_b64_tr_b16 a[0:1], v30 offset:0
    ds_read_b64_tr_b16 v[8:9], v30 offset:8
    ds_read_b64_tr_b16 a[8:9], v31 offset:0
    ds_read_b64_tr_b16 v[10:11], v31 offset:8
    s_waitcnt vmcnt(12) lgkmcnt(0)
    s_barrier
    s_cmp_eq_u32 s71, 1
    s_cbranch_scc1 cf_th15
    s_waitcnt vmcnt(6)
cf_th15:
    s_add_u32 m0, s43, 110592
    s_add_u32 s41, s58, 540672
    buffer_load_dwordx4 v17, s[8:11], s41 offen offset:0 nt lds
    s_add_u32 s41, s58, 572416
    buffer_load_dwordx4 v17, s[8:11], s41 offen offset:1024 nt lds
    s_add_u32 s41, s58, 669696
    buffer_load_dwordx4 v17, s[8:11], s41 offen offset:2048 nt lds
    s_add_u32 s41, s58, 701440
    buffer_load_dwordx4 v17, s[8:11], s41 offen offset:3072 nt lds
    ds_write_b64 v70, v[0:1] offset:0
    ds_write_b64 v70, v[2:3] offset:2048
    ds_write_b64 v70, v[4:5] offset:4096
    ds_write_b64 v70, v[6:7] offset:6144
    ds_write_b64 v70, v[8:9] offset:10240
    ds_write_b64 v70, v[10:11] offset:14336
    v_add_u32 v28, 147456, v24
    v_add_u32 v29, 147456, v25
    v_add_u32 v30, 147456, v26
    v_add_u32 v31, 147456, v27
    ds_read_b64_tr_b16 v[32:33], v28 offset:0
    ds_read_b64_tr_b16 v[34:35], v28 offset:8
    ds_read_b64_tr_b16 v[36:37], v29 offset:0
    ds_read_b64_tr_b16 v[38:39], v29 offset:8
    ds_read_b64_tr_b16 a[2:3], v30 offset:0
    ds_read_b64_tr_b16 v[40:41], v30 offset:8
    ds_read_b64_tr_b16 a[10:11], v31 offset:0
    ds_read_b64_tr_b16 v[42:43], v31 offset:8
    s_waitcnt vmcnt(12) lgkmcnt(0)
    s_barrier
    s_cmp_eq_u32 s71, 1
    s_cbranch_scc1 cf_th16
    s_waitcnt vmcnt(6)
cf_th16:
    s_add_u32 m0, s43, 147456
    s_add_u32 s41, s58, 786432
    buffer_load_dwordx4 v17, s[8:11], s41 offen offset:0 nt lds
    s_add_u32 s41, s58, 818176
    buffer_load_dwordx4 v17, s[8:11], s41 offen offset:1024 nt lds
    s_add_u32 s41, s58, 915456
    buffer_load_dwordx4 v17, s[8:11], s41 offen offset:2048 nt lds
    s_add_u32 s41, s58, 947200
    buffer_load_dwordx4 v17, s[8:11], s41 offen offset:3072 nt lds
    ds_write_b64 v70, v[32:33] offset:8
    ds_write_b64 v70, v[34:35] offset:2056
    ds_write_b64 v70, v[36:37] offset:4104
    ds_write_b64 v70, v[38:39] offset:6152
    ds_write_b64 v70, v[40:41] offset:10248
    ds_write_b64 v70, v[42:43] offset:14344
    v_add_u32 v28, 0, v24
    v_add_u32 v29, 0, v25
    v_add_u32 v30, 0, v26
    v_add_u32 v31, 0, v27
    ds_read_b64_tr_b16 v[0:1], v28 offset:0
    ds_read_b64_tr_b16 v[2:3], v28 offset:8
    ds_read_b64_tr_b16 v[4:5], v29 offset:0
    ds_read_b64_tr_b16 v[6:7], v29 offset:8
    ds_read_b64_tr_b16 a[4:5], v30 offset:0
    ds_read_b64_tr_b16 v[8:9], v30 offset:8
    ds_read_b64_tr_b16 a[12:13], v31 offset:0
    ds_read_b64_tr_b16 v[10:11], v31 offset:8
    s_waitcnt vmcnt(12) lgkmcnt(0)
    s_barrier
    s_cmp_eq_u32 s71, 1
    s_cbranch_scc1 cf_th17
    s_waitcnt vmcnt(6)
cf_th17:
    s_add_u32 m0, s43, 0
    s_add_u32 s41, s58, 802816
    buffer_load_dwordx4 v17, s[8:11], s41 offen offset:0 nt lds
    s_add_u32 s41, s58, 834560
    buffer_load_dwordx4 v17, s[8:11], s41 offen offset:1024 nt lds
    s_add_u32 s41, s58, 931840
    buffer_load_dwordx4 v17, s[8:11], s41 offen offset:2048 nt lds
    s_add_u32 s41, s58, 963584
    buffer_load_dwordx4 v17, s[8:11], s41 offen offset:3072 nt lds
    ds_write_b64 v70, v[0:1] offset:1024
    ds_write_b64 v70, v[2:3] offset:3072
    ds_write_b64 v70, v[4:5] offset:5120
    ds_write_b64 v70, v[6:7] offset:7168
    ds_write_b64 v70, v[8:9] offset:11264
    ds_write_b64 v70, v[10:11] offset:15360
    v_add_u32 v28, 36864, v24
    v_add_u32 v29, 36864, v25
    v_add_u32 v30, 36864, v26
    v_add_u32 v31, 36864, v27
    ds_read_b64_tr_b16 v[32:33], v28 offset:0
    ds_read_b64_tr_b16 v[34:35], v28 offset:8
    ds_read_b64_tr_b16 v[36:37], v29 offset:0
    ds_read_b64_tr_b16 v[38:39], v29 offset:8
    ds_read_b64_tr_b16 a[6:7], v30 offset:0
    ds_read_b64_tr_b16 v[40:41], v30 offset:8
    ds_read_b64_tr_b16 a[14:15], v31 offset:0
    ds_read_b64_tr_b16 v[42:43], v31 offset:8
    s_waitcnt vmcnt(12) lgkmcnt(0)
    s_barrier
    s_cmp_eq_u32 s71, 1
    s_cbranch_scc1 cf_th18
    s_waitcnt vmcnt(6)
cf_th18:
    s_add_u32 m0, s43, 36864
    s_add_u32 s41, s59, 0
    buffer_load_dwordx4 v17, s[8:11], s41 offen offset:0 nt lds
    s_add_u32 s41, s59, 31744
    buffer_load_dwordx4 v17, s[8:11], s41 offen offset:1024 nt lds
    s_add_u32 s41, s59, 129024
    buffer_load_dwordx4 v17, s[8:11], s41 offen offset:2048 nt lds
    s_add_u32 s41, s59, 160768
    buffer_load_dwordx4 v17, s[8:11], s41 offen offset:3072 nt lds
    ds_write_b64 v70, v[32:33] offset:1032
    ds_write_b64 v70, v[34:35] offset:3080
    ds_write_b64 v70, v[36:37] offset:5128
    ds_write_b64 v70, v[38:39] offset:7176
    ds_write_b64 v70, v[40:41] offset:11272
    ds_write_b64 v70, v[42:43] offset:15368
    v_add_u32 v28, 73728, v24
    v_add_u32 v29, 73728, v25
    v_add_u32 v30, 73728, v26
    v_add_u32 v31, 73728, v27
    ds_read_b64_tr_b16 a[16:17], v28 offset:0
    ds_read_b64_tr_b16 a[24:25], v28 offset:8
    ds_read_b64_tr_b16 a[32:33], v29 offset:0
    ds_read_b64_tr_b16 a[40:41], v29 offset:8
    ds_read_b64_tr_b16 a[48:49], v30 offset:0
    ds_read_b64_tr_b16 a[56:57], v30 offset:8
    ds_read_b64_tr_b16 a[64:65], v31 offset:0
    ds_read_b64_tr_b16 a[72:73], v31 offset:8
    s_waitcnt vmcnt(12) lgkmcnt(0)
    s_barrier
    s_cmp_eq_u32 s71, 1
    s_cbranch_scc1 cf_th19
    s_waitcnt vmcnt(6)
cf_th19:
    s_mov_b64 s[8:9], s[54:55]
    s_add_u32 m0, s43, 73728
    s_add_u32 s41, s58, 0
    buffer_load_dwordx4 v17, s[8:11], s41 offen offset:0 nt lds
    s_add_u32 s41, s58, 31744
    buffer_load_dwordx4 v17, s[8:11], s41 offen offset:1024 nt lds
    s_add_u32 s41, s58, 129024
    buffer_load_dwordx4 v17, s[8:11], s41 offen offset:2048 nt lds
    s_add_u32 s41, s58, 160768
    buffer_load_dwordx4 v17, s[8:11], s41 offen offset:3072 nt lds
    v_add_u32 v28, 110592, v24
    v_add_u32 v29, 110592, v25
    v_add_u32 v30, 110592, v26
    v_add_u32 v31, 110592, v27
    ds_read_b64_tr_b16 a[18:19], v28 offset:0
    ds_read_b64_tr_b16 a[26:27], v28 offset:8
    ds_read_b64_tr_b16 a[34:35], v29 offset:0
    ds_read_b64_tr_b16 a[42:43], v29 offset:8
    ds_read_b64_tr_b16 a[50:51], v30 offset:0
    ds_read_b64_tr_b16 a[58:59], v30 offset:8
    ds_read_b64_tr_b16 a[66:67], v31 offset:0
    ds_read_b64_tr_b16 a[74:75], v31 offset:8
    s_waitcnt vmcnt(12) lgkmcnt(0)
    s_barrier
    s_cmp_eq_u32 s71, 1
    s_cbranch_scc1 cf_th20
    s_waitcnt vmcnt(6)
cf_th20:
    s_add_u32 m0, s43, 110592
    s_add_u32 s41, s58, 16384
    buffer_load_dwordx4 v17, s[8:11], s41 offen offset:0 nt lds
    s_add_u32 s41, s58, 48128
    buffer_load_dwordx4 v17, s[8:11], s41 offen offset:1024 nt lds
    s_add_u32 s41, s58, 145408
    buffer_load_dwordx4 v17, s[8:11], s41 offen offset:2048 nt lds
    s_add_u32 s41, s58, 177152
    buffer_load_dwordx4 v17, s[8:11], s41 offen offset:3072 nt lds
    v_add_u32 v28, 147456, v24
    v_add_u32 v29, 147456, v25
    v_add_u32 v30, 147456, v26
    v_add_u32 v31, 147456, v27
    ds_read_b64_tr_b16 a[20:21], v28 offset:0
    ds_read_b64_tr_b16 a[28:29], v28 offset:8
    ds_read_b64_tr_b16 a[36:37], v29 offset:0
    ds_read_b64_tr_b16 a[44:45], v29 offset:8
    ds_read_b64_tr_b16 a[52:53], v30 offset:0
    ds_read_b64_tr_b16 a[60:61], v30 offset:8
    ds_read_b64_tr_b16 a[68:69], v31 offset:0
    ds_read_b64_tr_b16 a[76:77], v31 offset:8
    s_waitcnt vmcnt(12) lgkmcnt(0)
    s_barrier
    s_cmp_eq_u32 s71, 1
    s_cbranch_scc1 cf_th21
    s_waitcnt vmcnt(6)
cf_th21:
    s_add_u32 m0, s43, 147456
    s_add_u32 s41, s58, 262144
    buffer_load_dwordx4 v17, s[8:11], s41 offen offset:0 nt lds
    s_add_u32 s41, s58, 293888
    buffer_load_dwordx4 v17, s[8:11], s41 offen offset:1024 nt lds
    s_add_u32 s41, s58, 391168
    buffer_load_dwordx4 v17, s[8:11], s41 offen offset:2048 nt lds
    s_add_u32 s41, s58, 422912
    buffer_load_dwordx4 v17, s[8:11], s41 offen offset:3072 nt lds
    v_add_u32 v28, 0, v24
    v_add_u32 v29, 0, v25
    v_add_u32 v30, 0, v26
    v_add_u32 v31, 0, v27
    ds_read_b64_tr_b16 a[22:23], v28 offset:0
    ds_read_b64_tr_b16 a[30:31], v28 offset:8
    ds_read_b64_tr_b16 a[38:39], v29 offset:0
    ds_read_b64_tr_b16 a[46:47], v29 offset:8
    ds_read_b64_tr_b16 a[54:55], v30 offset:0
    ds_read_b64_tr_b16 a[62:63], v30 offset:8
    ds_read_b64_tr_b16 a[70:71], v31 offset:0
    ds_read_b64_tr_b16 a[78:79], v31 offset:8
    s_waitcnt vmcnt(12) lgkmcnt(0)
    s_barrier
    s_cmp_eq_u32 s71, 1
    s_cbranch_scc1 cf_th22
    s_waitcnt vmcnt(6)
cf_th22:
    s_add_u32 m0, s43, 0
    s_add_u32 s41, s58, 278528
    buffer_load_dwordx4 v17, s[8:11], s41 offen offset:0 nt lds
    s_add_u32 s41, s58, 310272
    buffer_load_dwordx4 v17, s[8:11], s41 offen offset:1024 nt lds
    s_add_u32 s41, s58, 407552
    buffer_load_dwordx4 v17, s[8:11], s41 offen offset:2048 nt lds
    s_add_u32 s41, s58, 439296
    buffer_load_dwordx4 v17, s[8:11], s41 offen offset:3072 nt lds
    s_lshl_b32 s26, s12, 14
    s_add_u32 s26, s26, 0
    s_mul_i32 s40, s13, 3072
    s_add_u32 s24, s26, s40
    s_add_u32 s26, s24, s33
    s_add_u32 s99, s26, 33030144
    s_lshl_b32 s96, s12, 7
    s_add_u32 s29, s96, 125845504
    s_add_u32 s96, s96, 125829120
    v_bfe_u32 v78, v65, 2, 5
    buffer_load_dword v54, off, s[84:87], 0 offset:132 sc1
    buffer_load_dword v55, off, s[84:87], 0 offset:216 sc1
    buffer_load_dword v56, v78, s[4:7], s96 offen offset:16 sc1
    v_add_u32 v77, 36864, v20
    ds_read_b64_tr_b16 a[80:81], v77 offset:0
    ds_read_b64_tr_b16 a[82:83], v77 offset:4096
    ds_read_b64_tr_b16 a[84:85], v77 offset:8192
    ds_read_b64_tr_b16 a[86:87], v77 offset:12288
    ds_read_b64_tr_b16 a[88:89], v77 offset:8
    ds_read_b64_tr_b16 a[90:91], v77 offset:4104
    ds_read_b64_tr_b16 a[92:93], v77 offset:8200
    ds_read_b64_tr_b16 a[94:95], v77 offset:12296
    s_waitcnt vmcnt(12) lgkmcnt(0)
    s_barrier
    s_cmp_eq_u32 s71, 1
    s_cbranch_scc1 cf_th23
    s_waitcnt vmcnt(6)
cf_th23:
    s_add_u32 m0, s43, 36864
    s_add_u32 s41, s58, 524288
    buffer_load_dwordx4 v17, s[8:11], s41 offen offset:0 nt lds
    s_add_u32 s41, s58, 556032
    buffer_load_dwordx4 v17, s[8:11], s41 offen offset:1024 nt lds
    s_add_u32 s41, s58, 653312
    buffer_load_dwordx4 v17, s[8:11], s41 offen offset:2048 nt lds
    s_add_u32 s41, s58, 685056
    buffer_load_dwordx4 v17, s[8:11], s41 offen offset:3072 nt lds
    v_add_u32 v28, 73728, v24
    v_add_u32 v29, 73728, v25
    v_add_u32 v30, 73728, v26
    v_add_u32 v31, 73728, v27
    ds_read_b64_tr_b16 a[232:233], v28 offset:0
    ds_read_b64_tr_b16 v[32:33], v28 offset:8
    ds_read_b64_tr_b16 a[240:241], v29 offset:0
    ds_read_b64_tr_b16 a[248:249], v29 offset:8
    ds_read_b64_tr_b16 v[144:145], v30 offset:0
    ds_read_b64_tr_b16 v[152:153], v30 offset:8
    ds_read_b64_tr_b16 v[160:161], v31 offset:0
    ds_read_b64_tr_b16 v[168:169], v31 offset:8
    s_waitcnt vmcnt(12) lgkmcnt(0)
    s_barrier
    s_cmp_eq_u32 s71, 1
    s_cbranch_scc1 cf_th24
    s_waitcnt vmcnt(6)
cf_th24:
    s_add_u32 m0, s43, 73728
    s_add_u32 s41, s58, 540672
    buffer_load_dwordx4 v17, s[8:11], s41 offen offset:0 nt lds
    s_add_u32 s41, s58, 572416
    buffer_load_dwordx4 v17, s[8:11], s41 offen offset:1024 nt lds
    s_add_u32 s41, s58, 669696
    buffer_load_dwordx4 v17, s[8:11], s41 offen offset:2048 nt lds
    s_add_u32 s41, s58, 701440
    buffer_load_dwordx4 v17, s[8:11], s41 offen offset:3072 nt lds
    ds_write_b64 v70, v[32:33] offset:8192
    v_add_u32 v28, 110592, v24
    v_add_u32 v29, 110592, v25
    v_add_u32 v30, 110592, v26
    v_add_u32 v31, 110592, v27
    ds_read_b64_tr_b16 a[234:235], v28 offset:0
    ds_read_b64_tr_b16 v[0:1], v28 offset:8
    ds_read_b64_tr_b16 a[242:243], v29 offset:0
    ds_read_b64_tr_b16 a[250:251], v29 offset:8
    ds_read_b64_tr_b16 v[146:147], v30 offset:0
    ds_read_b64_tr_b16 v[154:155], v30 offset:8
    ds_read_b64_tr_b16 v[162:163], v31 offset:0
    ds_read_b64_tr_b16 v[170:171], v31 offset:8
    s_waitcnt vmcnt(12) lgkmcnt(0)
    s_barrier
    s_cmp_eq_u32 s71, 1
    s_cbranch_scc1 cf_th25
    s_waitcnt vmcnt(6)
cf_th25:
    s_add_u32 m0, s43, 110592
    s_add_u32 s41, s58, 786432
    buffer_load_dwordx4 v17, s[8:11], s41 offen offset:0 nt lds
    s_add_u32 s41, s58, 818176
    buffer_load_dwordx4 v17, s[8:11], s41 offen offset:1024 nt lds
    s_add_u32 s41, s58, 915456
    buffer_load_dwordx4 v17, s[8:11], s41 offen offset:2048 nt lds
    s_add_u32 s41, s58, 947200
    buffer_load_dwordx4 v17, s[8:11], s41 offen offset:3072 nt lds
    ds_write_b64 v70, v[0:1] offset:8200
    v_add_u32 v28, 147456, v24
    v_add_u32 v29, 147456, v25
    v_add_u32 v30, 147456, v26
    v_add_u32 v31, 147456, v27
    ds_read_b64_tr_b16 a[236:237], v28 offset:0
    ds_read_b64_tr_b16 v[32:33], v28 offset:8
    ds_read_b64_tr_b16 a[244:245], v29 offset:0
    ds_read_b64_tr_b16 a[252:253], v29 offset:8
    ds_read_b64_tr_b16 v[148:149], v30 offset:0
    ds_read_b64_tr_b16 v[156:157], v30 offset:8
    ds_read_b64_tr_b16 v[164:165], v31 offset:0
    ds_read_b64_tr_b16 v[172:173], v31 offset:8
    s_waitcnt vmcnt(12) lgkmcnt(0)
    s_barrier
    s_cmp_eq_u32 s71, 1
    s_cbranch_scc1 cf_th26
    s_waitcnt vmcnt(6)
cf_th26:
    s_add_u32 m0, s43, 147456
    s_add_u32 s41, s58, 802816
    buffer_load_dwordx4 v17, s[8:11], s41 offen offset:0 nt lds
    s_add_u32 s41, s58, 834560
    buffer_load_dwordx4 v17, s[8:11], s41 offen offset:1024 nt lds
    s_add_u32 s41, s58, 931840
    buffer_load_dwordx4 v17, s[8:11], s41 offen offset:2048 nt lds
    s_add_u32 s41, s58, 963584
    buffer_load_dwordx4 v17, s[8:11], s41 offen offset:3072 nt lds
    ds_write_b64 v70, v[32:33] offset:9216
    v_add_u32 v28, 0, v24
    v_add_u32 v29, 0, v25
    v_add_u32 v30, 0, v26
    v_add_u32 v31, 0, v27
    ds_read_b64_tr_b16 a[238:239], v28 offset:0
    ds_read_b64_tr_b16 v[0:1], v28 offset:8
    ds_read_b64_tr_b16 a[246:247], v29 offset:0
    ds_read_b64_tr_b16 a[254:255], v29 offset:8
    ds_read_b64_tr_b16 v[150:151], v30 offset:0
    ds_read_b64_tr_b16 v[158:159], v30 offset:8
    ds_read_b64_tr_b16 v[166:167], v31 offset:0
    ds_read_b64_tr_b16 v[174:175], v31 offset:8
    s_waitcnt vmcnt(12) lgkmcnt(0)
    s_barrier
    s_cmp_eq_u32 s71, 1
    s_cbranch_scc1 cf_th27
    s_waitcnt vmcnt(6)
cf_th27:
    s_add_u32 m0, s43, 0
    s_add_u32 s41, s59, 0
    buffer_load_dwordx4 v17, s[8:11], s41 offen offset:0 nt lds
    s_add_u32 s41, s59, 31744
    buffer_load_dwordx4 v17, s[8:11], s41 offen offset:1024 nt lds
    s_add_u32 s41, s59, 129024
    buffer_load_dwordx4 v17, s[8:11], s41 offen offset:2048 nt lds
    s_add_u32 s41, s59, 160768
    buffer_load_dwordx4 v17, s[8:11], s41 offen offset:3072 nt lds
    v_readfirstlane_b32 s94, v54
    v_readfirstlane_b32 s95, v55
    v_mov_b32 v77, v56
    s_nop 0
    v_subrev_u32 v77, s95, v77
    v_cmp_lt_u32 vcc, 16, v77
    s_nop 1
    v_cndmask_b32 v77, v77, 0, vcc
    v_bfe_u32 v79, v78, 2, 2
    v_lshl_add_u32 v77, v77, 2, v79
    s_nop 1
    v_min_u32_dpp v77, v77, v77 row_ror:1 row_mask:0xf bank_mask:0xf
    s_nop 1
    v_min_u32_dpp v77, v77, v77 row_ror:2 row_mask:0xf bank_mask:0xf
    s_nop 1
    v_min_u32_dpp v77, v77, v77 row_ror:4 row_mask:0xf bank_mask:0xf
    s_nop 0
    v_readfirstlane_b32 s97, v77
    s_cmp_eq_u32 s95, 0
    s_cselect_b32 s97, 0, s97
    s_cmp_lt_u32 s97, 3
    s_cbranch_scc1 cf_mb
    s_add_u32 s40, s26, 0
    s_min_u32 s40, s40, s99
    s_sub_u32 s41, s96, s40
    v_bfe_u32 v77, v65, 2, 5
    v_add3_u32 v77, v77, s41, 16
    v_lshlrev_b32 v78, 3, v69
    s_nop 0
    v_mov_b32_dpp v78, v77 quad_perm:[0,1,2,3] row_mask:0xc bank_mask:0xf
    buffer_load_dword v58, v78, s[4:7], s40 offen sc1
    s_add_u32 s40, s26, 524288
    s_min_u32 s40, s40, s99
    s_sub_u32 s41, s96, s40
    v_bfe_u32 v77, v65, 2, 5
    v_add3_u32 v77, v77, s41, 16
    v_lshlrev_b32 v78, 3, v69
    s_nop 0
    v_mov_b32_dpp v78, v77 quad_perm:[0,1,2,3] row_mask:0xc bank_mask:0xf
    buffer_load_dword v58, v78, s[4:7], s40 offen sc1
cf_mb:
    s_cmp_lt_u32 s94, 32
    s_cbranch_scc1 cf_mc
    s_cmp_lg_u32 s13, 0
    s_cbranch_scc1 cf_mc
    v_mov_b32 v76, 1
    v_mov_b32 v77, 0
    s_mov_b64 exec, 1
    buffer_atomic_cmpswap v[76:77], off, s[84:87], 0 offset:28 sc0
    s_mov_b64 exec, -1
cf_mc:
    s_nop 1
    ds_write_b64 v70, v[0:1] offset:9224
    v_add_u32 v28, 36864, v24
    v_add_u32 v29, 36864, v25
    v_add_u32 v30, 36864, v26
    v_add_u32 v31, 36864, v27
    ds_read_b64_tr_b16 v[176:177], v28 offset:0
    ds_read_b64_tr_b16 v[184:185], v28 offset:8
    ds_read_b64_tr_b16 v[192:193], v29 offset:0
    ds_read_b64_tr_b16 v[200:201], v29 offset:8
    ds_read_b64_tr_b16 v[208:209], v30 offset:0
    ds_read_b64_tr_b16 v[216:217], v30 offset:8
    ds_read_b64_tr_b16 v[224:225], v31 offset:0
    ds_read_b64_tr_b16 v[232:233], v31 offset:8
    s_waitcnt vmcnt(12) lgkmcnt(0)
    s_barrier
    s_cmp_eq_u32 s71, 1
    s_cbranch_scc1 cf_th28
    s_waitcnt vmcnt(6)
cf_th28:
    s_mov_b64 s[8:9], s[56:57]
    s_add_u32 m0, s43, 36864
    s_add_u32 s41, s60, 128
    buffer_load_dwordx4 v18, s[8:11], s41 offen offset:0 nt lds
    s_add_u32 s41, s60, 8320
    buffer_load_dwordx4 v18, s[8:11], s41 offen offset:1024 nt lds
    s_add_u32 s41, s60, 16512
    buffer_load_dwordx4 v18, s[8:11], s41 offen offset:2048 nt lds
    s_add_u32 s41, s60, 24704
    buffer_load_dwordx4 v18, s[8:11], s41 offen offset:3072 nt lds
    v_add_u32 v28, 73728, v24
    v_add_u32 v29, 73728, v25
    v_add_u32 v30, 73728, v26
    v_add_u32 v31, 73728, v27
    ds_read_b64_tr_b16 v[178:179], v28 offset:0
    ds_read_b64_tr_b16 v[186:187], v28 offset:8
    ds_read_b64_tr_b16 v[194:195], v29 offset:0
    ds_read_b64_tr_b16 v[202:203], v29 offset:8
    ds_read_b64_tr_b16 v[210:211], v30 offset:0
    ds_read_b64_tr_b16 v[218:219], v30 offset:8
    ds_read_b64_tr_b16 v[226:227], v31 offset:0
    ds_read_b64_tr_b16 v[234:235], v31 offset:8
    s_waitcnt vmcnt(12) lgkmcnt(0)
    s_barrier
    s_cmp_eq_u32 s71, 1
    s_cbranch_scc1 cf_th29
    s_waitcnt vmcnt(6)
cf_th29:
    s_add_u32 m0, s43, 73728
    s_add_u32 s41, s61, 128
    buffer_load_dwordx4 v18, s[8:11], s41 offen offset:0 nt lds
    s_add_u32 s41, s61, 8320
    buffer_load_dwordx4 v18, s[8:11], s41 offen offset:1024 nt lds
    s_add_u32 s41, s61, 16512
    buffer_load_dwordx4 v18, s[8:11], s41 offen offset:2048 nt lds
    s_add_u32 s41, s61, 24704
    buffer_load_dwordx4 v18, s[8:11], s41 offen offset:3072 nt lds
    v_add_u32 v28, 110592, v24
    v_add_u32 v29, 110592, v25
    v_add_u32 v30, 110592, v26
    v_add_u32 v31, 110592, v27
    ds_read_b64_tr_b16 v[180:181], v28 offset:0
    ds_read_b64_tr_b16 v[188:189], v28 offset:8
    ds_read_b64_tr_b16 v[196:197], v29 offset:0
    ds_read_b64_tr_b16 v[204:205], v29 offset:8
    ds_read_b64_tr_b16 v[212:213], v30 offset:0
    ds_read_b64_tr_b16 v[220:221], v30 offset:8
    ds_read_b64_tr_b16 v[228:229], v31 offset:0
    ds_read_b64_tr_b16 v[236:237], v31 offset:8
    s_waitcnt vmcnt(12) lgkmcnt(0)
    s_barrier
    s_cmp_eq_u32 s71, 1
    s_cbranch_scc1 cf_th30
    s_waitcnt vmcnt(6)
cf_th30:
    s_add_u32 m0, s43, 110592
    s_add_u32 s41, s62, 128
    buffer_load_dwordx4 v18, s[8:11], s41 offen offset:0 nt lds
    s_add_u32 s41, s62, 8320
    buffer_load_dwordx4 v18, s[8:11], s41 offen offset:1024 nt lds
    s_add_u32 s41, s62, 16512
    buffer_load_dwordx4 v18, s[8:11], s41 offen offset:2048 nt lds
    s_add_u32 s41, s62, 24704
    buffer_load_dwordx4 v18, s[8:11], s41 offen offset:3072 nt lds
    v_add_u32 v28, 147456, v24
    v_add_u32 v29, 147456, v25
    v_add_u32 v30, 147456, v26
    v_add_u32 v31, 147456, v27
    ds_read_b64_tr_b16 v[182:183], v28 offset:0
    ds_read_b64_tr_b16 v[190:191], v28 offset:8
    ds_read_b64_tr_b16 v[198:199], v29 offset:0
    ds_read_b64_tr_b16 v[206:207], v29 offset:8
    ds_read_b64_tr_b16 v[214:215], v30 offset:0
    ds_read_b64_tr_b16 v[222:223], v30 offset:8
    ds_read_b64_tr_b16 v[230:231], v31 offset:0
    ds_read_b64_tr_b16 v[238:239], v31 offset:8
    s_waitcnt vmcnt(12) lgkmcnt(0)
    s_barrier
    s_cmp_eq_u32 s71, 1
    s_cbranch_scc1 cf_th31
    s_waitcnt vmcnt(6)
cf_th31:
    s_add_u32 m0, s43, 147456
    s_add_u32 s41, s63, 128
    buffer_load_dwordx4 v18, s[8:11], s41 offen offset:0 nt lds
    s_add_u32 s41, s63, 8320
    buffer_load_dwordx4 v18, s[8:11], s41 offen offset:1024 nt lds
    s_add_u32 s41, s63, 16512
    buffer_load_dwordx4 v18, s[8:11], s41 offen offset:2048 nt lds
    s_add_u32 s41, s63, 24704
    buffer_load_dwordx4 v18, s[8:11], s41 offen offset:3072 nt lds
    v_mov_b32 v78, v21
    v_mov_b32 v79, v22
    v_add_u32 v77, 0, v20
    ds_read_b64_tr_b16 v[240:241], v77 offset:0
    ds_read_b64_tr_b16 v[242:243], v77 offset:4096
    ds_read_b64_tr_b16 v[244:245], v77 offset:8192
    ds_read_b64_tr_b16 v[246:247], v77 offset:12288
    ds_read_b64_tr_b16 v[248:249], v77 offset:8
    ds_read_b64_tr_b16 v[250:251], v77 offset:4104
    ds_read_b64_tr_b16 v[252:253], v77 offset:8200
    ds_read_b64_tr_b16 v[254:255], v77 offset:12296
    s_waitcnt vmcnt(12) lgkmcnt(0)
    s_barrier
    v_bfe_u32 v60, v65, 4, 6
    v_and_b32 v61, 15, v60
    v_lshrrev_b32 v62, 4, v60
    v_mov_b32 v50, 0x3f80
    v_mov_b32 v51, 0x3f800000
    v_and_b32 v57, 1, v62
    v_lshlrev_b32 v57, 2, v57
    v_sub_u32 v57, v61, v57
    v_and_b32 v58, 3, v61
    v_lshlrev_b32 v58, 2, v58
    v_lshrrev_b32 v59, 2, v61
    v_add_u32 v58, v58, v59
    v_cmp_eq_u32 vcc, 0, v57
    s_nop 1
    v_cndmask_b32 v40, 0, v50, vcc
    v_cmp_eq_u32 vcc, 1, v57
    s_nop 1
    v_cndmask_b32 v40, v40, v51, vcc
    v_cmp_eq_u32 vcc, 0, v58
    s_nop 1
    v_cndmask_b32 v44, 0, v50, vcc
    v_cmp_eq_u32 vcc, 1, v58
    s_nop 1
    v_cndmask_b32 v44, v44, v51, vcc
    v_cmp_eq_u32 vcc, 2, v57
    s_nop 1
    v_cndmask_b32 v41, 0, v50, vcc
    v_cmp_eq_u32 vcc, 3, v57
    s_nop 1
    v_cndmask_b32 v41, v41, v51, vcc
    v_cmp_eq_u32 vcc, 2, v58
    s_nop 1
    v_cndmask_b32 v45, 0, v50, vcc
    v_cmp_eq_u32 vcc, 3, v58
    s_nop 1
    v_cndmask_b32 v45, v45, v51, vcc
    v_cmp_eq_u32 vcc, 8, v57
    s_nop 1
    v_cndmask_b32 v42, 0, v50, vcc
    v_cmp_eq_u32 vcc, 9, v57
    s_nop 1
    v_cndmask_b32 v42, v42, v51, vcc
    v_cmp_eq_u32 vcc, 4, v58
    s_nop 1
    v_cndmask_b32 v46, 0, v50, vcc
    v_cmp_eq_u32 vcc, 5, v58
    s_nop 1
    v_cndmask_b32 v46, v46, v51, vcc
    v_cmp_eq_u32 vcc, 10, v57
    s_nop 1
    v_cndmask_b32 v43, 0, v50, vcc
    v_cmp_eq_u32 vcc, 11, v57
    s_nop 1
    v_cndmask_b32 v43, v43, v51, vcc
    v_cmp_eq_u32 vcc, 6, v58
    s_nop 1
    v_cndmask_b32 v47, 0, v50, vcc
    v_cmp_eq_u32 vcc, 7, v58
    s_nop 1
    v_cndmask_b32 v47, v47, v51, vcc
    v_lshlrev_b32 v57, 4, v61
    ds_write_b128 v69, v[40:43] offset:15360
    ds_write_b128 v57, v[44:47] offset:15872
    v_add_u32 v77, 36864, v79
    s_waitcnt lgkmcnt(0)
    ds_read_b64_tr_b16 v[0:1], v77 offset:0
    ds_read_b64_tr_b16 v[2:3], v77 offset:256
    ds_read_b64_tr_b16 v[4:5], v77 offset:2048
    ds_read_b64_tr_b16 v[6:7], v77 offset:2304
    ds_read_b64_tr_b16 v[8:9], v77 offset:16
    ds_read_b64_tr_b16 v[10:11], v77 offset:272
    ds_read_b64_tr_b16 v[12:13], v77 offset:2064
    ds_read_b64_tr_b16 v[14:15], v77 offset:2320
    s_waitcnt vmcnt(8) lgkmcnt(0)
    s_barrier
    s_mov_b32 s44, 0x3e0293ee
    s_mov_b32 s45, s44
    s_or_b32 s66, s44, 0x80000000
    s_mov_b32 s48, 0x3f003f00
    s_mov_b32 s49, 0
    s_mov_b32 s50, 0x3f803f80
    s_mov_b32 s51, 0x3f803f80
    s_mov_b32 s52, 512
    s_mov_b32 s53, 1024
    s_mov_b32 s54, 1536
    s_mov_b32 s30, 0
    s_mov_b32 s37, 0
    s_mov_b32 s98, -100
    s_lshl_b32 s47, s13, 9
    s_cmp_lg_u32 s32, 0
    s_cselect_b32 s71, s13, 3
    s_add_u32 s46, s71, 1
    s_lshr_b32 s46, s46, 1
    s_mov_b32 s14, 67125248
    s_mov_b32 s15, 67129344
    s_mov_b32 s16, 67133440
    s_mov_b32 s36, 0
    s_add_u32 s17, s68, 67108864
    s_mov_b32 s69, 0
    s_mov_b32 s70, 0
    s_lshl_b32 s26, s12, 14
    s_add_u32 s26, s26, 0
    s_mul_i32 s40, s13, 3072
    s_add_u32 s24, s26, s40
    s_add_u32 s26, s24, s33
    s_add_u32 s99, s26, 33030144
    s_lshl_b32 s96, s12, 7
    s_add_u32 s29, s96, 125845504
    s_add_u32 s96, s96, 125829120
    s_lshl_b32 s40, s12, 14
    s_add_u32 s40, s40, 68157440
    s_add_u32 s18, s40, 0
    s_add_u32 s19, s40, 4096
    s_add_u32 s20, s40, 8192
    s_add_u32 s21, s40, 12288
    s_lshr_b32 s40, s12, 3
    s_lshl_b32 s40, s40, 12
    s_and_b32 s41, s12, 7
    s_lshl_b32 s41, s41, 7
    s_add_u32 s40, s40, s41
    s_add_u32 s22, s40, 68157440
    s_add_u32 s23, s22, 1024
    s_add_u32 s25, s22, 2048
    s_mov_b32 s56, -65472
    s_cmp_lg_u32 s32, 0
    s_cselect_b64 s[38:39], -1, 0
    s_add_u32 s55, s68, 138412032
    s_cmp_eq_u32 s13, 3
    s_cselect_b64 s[100:101], 1, 0
    s_cselect_b64 s[38:39], 1, s[38:39]
    s_cselect_b32 s93, 64, 0
    s_cselect_b32 s55, s29, s55
    s_cselect_b32 s57, 0, 9216
    s_mov_b32 s34, 0xff00ff00
    s_mov_b32 s35, 0xff00ff00
    s_lshl_b32 s28, s12, 12
    s_add_u32 s28, s28, 7340032
    s_add_u32 s27, s28, 77594624
    s_add_u32 s28, s28, 69206016
    v_add_u32 v77, 73728, v78
    ds_read_b64_tr_b16 v[16:17], v77 offset:0
    ds_read_b64_tr_b16 v[18:19], v77 offset:256
    ds_read_b64_tr_b16 v[20:21], v77 offset:2048
    ds_read_b64_tr_b16 v[22:23], v77 offset:2304
    ds_read_b64_tr_b16 v[24:25], v77 offset:16
    ds_read_b64_tr_b16 v[26:27], v77 offset:272
    ds_read_b64_tr_b16 v[28:29], v77 offset:2064
    ds_read_b64_tr_b16 v[30:31], v77 offset:2320
    s_waitcnt vmcnt(4) lgkmcnt(0)
    s_barrier
    v_add_u32 v77, 110592, v78
    ds_read_b64_tr_b16 v[32:33], v77 offset:0
    ds_read_b64_tr_b16 v[34:35], v77 offset:256
    ds_read_b64_tr_b16 v[36:37], v77 offset:2048
    ds_read_b64_tr_b16 v[38:39], v77 offset:2304
    ds_read_b64_tr_b16 v[40:41], v77 offset:16
    ds_read_b64_tr_b16 v[42:43], v77 offset:272
    ds_read_b64_tr_b16 v[44:45], v77 offset:2064
    ds_read_b64_tr_b16 v[46:47], v77 offset:2320
    s_waitcnt vmcnt(0) lgkmcnt(0)
    s_barrier
    v_add_u32 v77, 147456, v78
    ds_read_b64_tr_b16 v[48:49], v77 offset:0
    ds_read_b64_tr_b16 v[50:51], v77 offset:256
    ds_read_b64_tr_b16 v[52:53], v77 offset:2048
    ds_read_b64_tr_b16 v[54:55], v77 offset:2304
    ds_read_b64_tr_b16 v[56:57], v77 offset:16
    ds_read_b64_tr_b16 v[58:59], v77 offset:272
    ds_read_b64_tr_b16 v[60:61], v77 offset:2064
    ds_read_b64_tr_b16 v[62:63], v77 offset:2320
    s_waitcnt lgkmcnt(0)
    s_barrier
    ds_write_b128 v70, v[0:3] offset:20480
    ds_write_b128 v70, v[4:7] offset:21504
    ds_write_b128 v70, v[8:11] offset:22528
    ds_write_b128 v70, v[12:15] offset:23552
    ds_write_b128 v70, v[16:19] offset:24576
    ds_write_b128 v70, v[20:23] offset:25600
    ds_write_b128 v70, v[24:27] offset:26624
    ds_write_b128 v70, v[28:31] offset:27648
    ds_write_b128 v70, v[32:35] offset:28672
    ds_write_b128 v70, v[36:39] offset:29696
    ds_write_b128 v70, v[40:43] offset:30720
    ds_write_b128 v70, v[44:47] offset:31744
    ds_write_b128 v70, v[48:51] offset:32768
    ds_write_b128 v70, v[52:55] offset:33792
    ds_write_b128 v70, v[56:59] offset:34816
    ds_write_b128 v70, v[60:63] offset:35840
    s_waitcnt vmcnt(0) lgkmcnt(0)
    s_cmp_lg_u32 s95, 0
    s_cbranch_scc1 cf_hn
    s_mov_b32 s88, 4194304
gn2:
    buffer_load_dword v2, off, s[84:87], 0 offset:216 sc1
    s_waitcnt vmcnt(0)
    v_readfirstlane_b32 s95, v2
    s_sub_u32 s88, s88, 1
    s_cbranch_scc1 gn2x
    s_cmp_eq_u32 s95, 0
    s_cbranch_scc1 gn2
gn2x:
cf_hn:
    v_mov_b32 v2, 1
    s_cmp_lg_u32 s13, 0
    s_cbranch_scc1 cf_noarr
    s_mov_b64 exec, 1
    s_mov_b32 s42, 1
    v_mov_b32 v4, v76
    s_cmp_ge_u32 s94, 32
    s_cbranch_scc1 cf_have
    s_mov_b32 s40, 131072
    s_mov_b32 s42, 2
cf_startpoll:
    buffer_load_dword v3, off, s[84:87], 0 offset:132 sc1
    s_sub_u32 s40, s40, 1
    s_cbranch_scc1 cf_decide
    s_waitcnt vmcnt(0)
    v_readfirstlane_b32 s41, v3
    s_nop 1
    s_cmp_lt_u32 s41, 32
    s_cbranch_scc1 cf_startpoll
    s_mov_b32 s42, 1
cf_decide:
    v_mov_b32 v4, s42
    v_mov_b32 v5, 0
    buffer_atomic_cmpswap v[4:5], off, s[84:87], 0 offset:28 sc0
    s_waitcnt vmcnt(0)
cf_have:
    v_mov_b32 v5, s42
    v_cmp_eq_u32 vcc, 0, v4
    s_nop 1
    v_cndmask_b32 v4, v4, v5, vcc
    v_mov_b32 v5, 16192
    ds_write_b32 v5, v4
    s_waitcnt lgkmcnt(0)
    s_mov_b64 exec, -1
cf_noarr:
    s_barrier
    v_mov_b32 v5, 16192
    ds_read_b32 v4, v5
    s_waitcnt lgkmcnt(0)
    v_readfirstlane_b32 s41, v4
    s_nop 1
    s_cmp_eq_u32 s41, 1
    s_cbranch_scc1 cf_run
    v_lshrrev_b32 v0, 4, v65
    s_mov_b32 s32, s13
    s_load_dwordx16 s[48:63], s[0:1], 0
    s_waitcnt lgkmcnt(0)
    s_branch L_helper
cf_run:
    s_mov_b64 exec, s[100:101]
    v_mov_b32 v72, s95
    s_mov_b64 exec, -1
    s_cmp_ge_u32 s97, 3
    s_cbranch_scc1 cf_kvdone
    s_mov_b32 s40, 3
    v_bfe_u32 v78, v65, 2, 5
    s_mov_b32 s31, 4194304
cf_kv0:
    buffer_load_dword v77, v78, s[4:7], s96 offen offset:16 sc1
    s_waitcnt vmcnt(0)
    v_subrev_u32 v77, s95, v77
    v_cmp_lt_u32 vcc, 16, v77
    s_nop 1
    v_cndmask_b32 v77, v77, 0, vcc
    v_bfe_u32 v79, v78, 2, 2
    v_lshl_add_u32 v77, v77, 2, v79
    s_nop 1
    v_min_u32_dpp v77, v77, v77 row_ror:1 row_mask:0xf bank_mask:0xf
    s_nop 1
    v_min_u32_dpp v77, v77, v77 row_ror:2 row_mask:0xf bank_mask:0xf
    s_nop 1
    v_min_u32_dpp v77, v77, v77 row_ror:4 row_mask:0xf bank_mask:0xf
    s_nop 0
    v_readfirstlane_b32 s97, v77
    s_sub_u32 s31, s31, 1
    s_cbranch_scc1 cf_kv0_x
    s_cmp_le_u32 s40, s97
    s_cbranch_scc1 cf_kv0_x
    s_sleep 2
    s_branch cf_kv0
cf_kv0_x:
    s_add_u32 s40, s26, 0
    s_min_u32 s40, s40, s99
    s_sub_u32 s41, s96, s40
    v_bfe_u32 v77, v65, 2, 5
    v_add3_u32 v77, v77, s41, 16
    v_lshlrev_b32 v78, 3, v69
    s_nop 0
    v_mov_b32_dpp v78, v77 quad_perm:[0,1,2,3] row_mask:0xc bank_mask:0xf
    buffer_load_dword v76, v78, s[4:7], s40 offen sc1
    s_add_u32 s40, s26, 524288
    s_min_u32 s40, s40, s99
    s_sub_u32 s41, s96, s40
    v_bfe_u32 v77, v65, 2, 5
    v_add3_u32 v77, v77, s41, 16
    v_lshlrev_b32 v78, 3, v69
    s_nop 0
    v_mov_b32_dpp v78, v77 quad_perm:[0,1,2,3] row_mask:0xc bank_mask:0xf
    buffer_load_dword v76, v78, s[4:7], s40 offen sc1
cf_kvdone:
    v_mov_b64 v[0:1], 0
    v_mov_b64 v[2:3], 0
    v_mov_b64 v[4:5], 0
    v_mov_b64 v[6:7], 0
    v_mov_b64 v[8:9], 0
    v_mov_b64 v[10:11], 0
    v_mov_b64 v[12:13], 0
    v_mov_b64 v[14:15], 0
    v_mov_b64 v[16:17], 0
    v_mov_b64 v[18:19], 0
    v_mov_b64 v[20:21], 0
    v_mov_b64 v[22:23], 0
    ds_read_b128 v[44:47], v70 offset:0
    ds_read_b128 v[48:51], v70 offset:1024
    ds_read_b128 v[52:55], v70 offset:2048
    ds_read_b128 v[56:59], v70 offset:3072
    ds_read_b128 v[24:27], v70 offset:4096
    ds_read_b128 v[28:31], v70 offset:5120
    ds_read_b128 v[32:35], v70 offset:6144
    ds_read_b128 v[36:39], v70 offset:7168
    buffer_load_dwordx4 v[40:43], v65, s[4:7], s14 offen offset:0 nt
    buffer_load_dwordx4 v[60:63], v66, s[4:7], s14 offen offset:0 nt
    s_mov_b32 s31, 1048576
    s_waitcnt vmcnt(0) lgkmcnt(0)
    s_branch cf_goA
cf_loop:
    s_mov_b32 s31, 1048576
    s_mov_b32 s69, s70
    s_waitcnt lgkmcnt(0)
cf_cA:
    buffer_load_dwordx4 v[40:43], v65, s[4:7], s14 offen offset:0 nt
    buffer_load_dwordx4 v[60:63], v66, s[4:7], s14 offen offset:0 nt
cf_cA1:
    v_bitop3_b32 v77, v40, v60, s70 bitop3:0x7e
    v_and_b32 v77, 1, v77
    v_cmp_ne_u32 vcc, 0, v77
    s_cbranch_vccz cf_goA
    v_bitop3_b32 v77, v40, v60, s70 bitop3:0x7e
    v_and_b32 v77, 1, v77
    v_cmp_ne_u32 vcc, 0, v77
    s_cbranch_vccz cf_goA
    v_bitop3_b32 v77, v40, v60, s70 bitop3:0x7e
    v_and_b32 v77, 1, v77
    v_cmp_ne_u32 vcc, 0, v77
    s_cbranch_vccz cf_goA
    v_bitop3_b32 v77, v40, v60, s70 bitop3:0x7e
    v_and_b32 v77, 1, v77
    v_cmp_ne_u32 vcc, 0, v77
    s_cbranch_vccz cf_goA
    buffer_load_dwordx4 v[40:43], v65, s[4:7], s14 offen offset:0 nt
    buffer_load_dwordx4 v[60:63], v66, s[4:7], s14 offen offset:0 nt
    v_bitop3_b32 v77, v40, v60, s70 bitop3:0x7e
    v_and_b32 v77, 1, v77
    v_cmp_ne_u32 vcc, 0, v77
    s_cbranch_vccz cf_goA
    v_bitop3_b32 v77, v40, v60, s70 bitop3:0x7e
    v_and_b32 v77, 1, v77
    v_cmp_ne_u32 vcc, 0, v77
    s_cbranch_vccz cf_goA
    v_bitop3_b32 v77, v40, v60, s70 bitop3:0x7e
    v_and_b32 v77, 1, v77
    v_cmp_ne_u32 vcc, 0, v77
    s_cbranch_vccz cf_goA
    v_bitop3_b32 v77, v40, v60, s70 bitop3:0x7e
    v_and_b32 v77, 1, v77
    v_cmp_ne_u32 vcc, 0, v77
    s_cbranch_vccz cf_goA
    buffer_load_dwordx4 v[40:43], v65, s[4:7], s14 offen offset:0 nt
    buffer_load_dwordx4 v[60:63], v66, s[4:7], s14 offen offset:0 nt
    v_bitop3_b32 v77, v40, v60, s70 bitop3:0x7e
    v_and_b32 v77, 1, v77
    v_cmp_ne_u32 vcc, 0, v77
    s_cbranch_vccz cf_goA
    v_bitop3_b32 v77, v40, v60, s70 bitop3:0x7e
    v_and_b32 v77, 1, v77
    v_cmp_ne_u32 vcc, 0, v77
    s_cbranch_vccz cf_goA
    v_bitop3_b32 v77, v40, v60, s70 bitop3:0x7e
    v_and_b32 v77, 1, v77
    v_cmp_ne_u32 vcc, 0, v77
    s_cbranch_vccz cf_goA
    v_bitop3_b32 v77, v40, v60, s70 bitop3:0x7e
    v_and_b32 v77, 1, v77
    v_cmp_ne_u32 vcc, 0, v77
    s_cbranch_vccz cf_goA
    buffer_load_dwordx4 v[40:43], v65, s[4:7], s14 offen offset:0 nt
    buffer_load_dwordx4 v[60:63], v66, s[4:7], s14 offen offset:0 nt
    v_bitop3_b32 v77, v40, v60, s70 bitop3:0x7e
    v_and_b32 v77, 1, v77
    v_cmp_ne_u32 vcc, 0, v77
    s_cbranch_vccz cf_goA
    v_bitop3_b32 v77, v40, v60, s70 bitop3:0x7e
    v_and_b32 v77, 1, v77
    v_cmp_ne_u32 vcc, 0, v77
    s_cbranch_vccz cf_goA
    v_bitop3_b32 v77, v40, v60, s70 bitop3:0x7e
    v_and_b32 v77, 1, v77
    v_cmp_ne_u32 vcc, 0, v77
    s_cbranch_vccz cf_goA
    v_bitop3_b32 v77, v40, v60, s70 bitop3:0x7e
    v_and_b32 v77, 1, v77
    v_cmp_ne_u32 vcc, 0, v77
    s_cbranch_vccz cf_goA
    s_sub_u32 s31, s31, 64
    s_cbranch_scc0 cf_cA
cf_goA:
    ds_write_b128 v65, v[40:43] offset:0
    v_smfmac_f32_16x16x64_bf16 v[0:3], v[40:43], v[44:51], v64
    v_smfmac_f32_16x16x64_bf16 v[4:7], v[40:43], v[52:59], v64
    buffer_load_dwordx4 v[44:47], v65, s[4:7], s15 offen offset:0 nt
    v_smfmac_f32_16x16x64_bf16 v[0:3], v[60:63], v[24:31], v64
    s_add_u32 s40, s26, 1048576
    s_min_u32 s40, s40, s99
    s_sub_u32 s41, s96, s40
    v_smfmac_f32_16x16x64_bf16 v[4:7], v[60:63], v[32:39], v64
    ds_read_b128 v[24:27], v70 offset:8192
    s_cmp_lt_u32 s97, s93
    s_cselect_b32 s41, s41, 0
    v_smfmac_f32_16x16x64_bf16 v[8:11], v[40:43], a[96:103], v64
    ds_read_b128 v[28:31], v70 offset:9216
    v_smfmac_f32_16x16x64_bf16 v[12:15], v[40:43], a[104:111], v64
    ds_read_b128 v[32:35], v70 offset:10240
    s_waitcnt lgkmcnt(3)
    s_barrier
    ds_read_b128 v[48:51], v67 offset:0
    v_smfmac_f32_16x16x64_bf16 v[8:11], v[60:63], a[112:119], v64
    ds_read_b128 v[36:39], v70 offset:11264
    v_bitop3_b32 v79, v73, -9, s54 bitop3:0x6a
    v_smfmac_f32_16x16x64_bf16 v[12:15], v[60:63], a[120:127], v64
    buffer_load_dwordx4 v[44:47], v65, s[4:7], s15 offen offset:0 nt
    v_smfmac_f32_16x16x64_bf16 v[16:19], v[40:43], a[232:239], v64
    ds_read_b128 v[52:55], v68 offset:0
    s_waitcnt lgkmcnt(4)
    v_bfe_u32 v77, v65, 2, 5
    v_smfmac_f32_16x16x64_bf16 v[20:23], v[40:43], v[24:31], v64
    ds_read_b128 v[24:27], v70 offset:12288
    s_waitcnt lgkmcnt(3)
    v_smfmac_f32_16x16x64_bf16 v[0:3], v[48:51], a[0:7], v64
    ds_read_b128 v[28:31], v70 offset:13312
    s_waitcnt lgkmcnt(3)
    v_add3_u32 v77, v77, s41, 16
    v_smfmac_f32_16x16x64_bf16 v[4:7], v[48:51], v[32:39], v64
    buffer_load_dwordx4 v[40:43], v65, s[4:7], s16 offen offset:0 nt
    v_smfmac_f32_16x16x64_bf16 v[16:19], v[60:63], a[240:247], v64
    ds_read_b128 v[32:35], v70 offset:14336
    v_lshlrev_b32 v78, 3, v69
    v_smfmac_f32_16x16x64_bf16 v[20:23], v[60:63], a[248:255], v64
    ds_read_b128 v[36:39], v70 offset:15360
    v_smfmac_f32_16x16x64_bf16 v[8:11], v[48:51], a[128:135], v64
    s_waitcnt vmcnt(2)
    v_mov_b32_dpp v78, v77 quad_perm:[0,1,2,3] row_mask:0xc bank_mask:0xf
    v_smfmac_f32_16x16x64_bf16 v[12:15], v[48:51], a[136:143], v64
    buffer_load_dwordx4 v[58:61], v65, s[4:7], s24 offen offset:3072 sc1
    s_waitcnt lgkmcnt(2)
    v_and_b32 v77, s36, v44
    v_smfmac_f32_16x16x64_bf16 v[12:15], v[52:55], v[24:31], v64
    ds_write_b128 v65, v[44:47] offset:4096
    v_smfmac_f32_16x16x64_bf16 v[0:3], v[52:55], a[8:15], v64
    v_cmp_ne_u32 vcc, s70, v77
    v_smfmac_f32_16x16x64_bf16 v[8:11], v[52:55], a[144:151], v64
    buffer_load_dwordx4 v[24:27], v65, s[4:7], s24 offen offset:0 sc1
    s_waitcnt lgkmcnt(1)
    v_smfmac_f32_16x16x64_bf16 v[4:7], v[52:55], v[32:39], v64
    s_cbranch_vccnz cf_spinB
cf_backB:
    v_smfmac_f32_16x16x64_bf16 v[16:19], v[44:47], v[176:183], v64
    s_waitcnt lgkmcnt(0)
    s_barrier
    ds_read_b128 v[48:51], v66 offset:4096
    v_smfmac_f32_16x16x64_bf16 v[12:15], v[44:47], a[160:167], v64
    buffer_load_dwordx4 v[28:31], v65, s[4:7], s24 offen offset:1024 sc1
    v_smfmac_f32_16x16x64_bf16 v[0:3], v[44:47], a[16:23], v64
    ds_read_b128 v[52:55], v67 offset:4096
    v_smfmac_f32_16x16x64_bf16 v[8:11], v[44:47], a[152:159], v64
    v_smfmac_f32_16x16x64_bf16 v[4:7], v[44:47], a[24:31], v64
    buffer_load_dwordx4 v[34:37], v65, s[4:7], s24 offen offset:2048 sc1
    s_waitcnt vmcnt(5)
    v_smfmac_f32_16x16x64_bf16 v[20:23], v[44:47], v[184:191], v64
    ds_read_b128 v[44:47], v68 offset:4096
    s_waitcnt lgkmcnt(2)
    v_smfmac_f32_16x16x64_bf16 v[0:3], v[48:51], a[32:39], v64
    v_smfmac_f32_16x16x64_bf16 v[8:11], v[48:51], a[168:175], v64
    buffer_load_dword v76, v78, s[4:7], s40 offen sc1
    v_smfmac_f32_16x16x64_bf16 v[4:7], v[48:51], a[40:47], v64
    s_waitcnt vmcnt(5)
    v_and_b32 v77, s36, v40
    v_smfmac_f32_16x16x64_bf16 v[12:15], v[48:51], a[176:183], v64
    ds_read_b128 v[48:51], v69 offset:15360
    s_waitcnt lgkmcnt(1)
    v_cmp_ne_u32 vcc, s70, v77
    v_smfmac_f32_16x16x64_bf16 v[0:3], v[52:55], a[48:55], v64
    v_smfmac_f32_16x16x64_bf16 v[8:11], v[52:55], a[184:191], v64
    s_cbranch_vccnz cf_spin8
cf_back8:
    v_smfmac_f32_16x16x64_bf16 v[0:3], v[44:47], a[64:71], v64
    v_smfmac_f32_16x16x64_bf16 v[8:11], v[44:47], a[200:207], v64
    v_smfmac_f32_16x16x64_bf16 v[0:3], v[40:43], a[80:87], v64
    s_nop 1
    v_smfmac_f32_16x16x64_bf16 v[8:11], v[40:43], a[216:223], v64
    s_nop 1
    v_lshrrev_b32 v77, 1, v69
    v_smfmac_f32_16x16x64_bf16 v[4:7], v[52:55], a[56:63], v64
    s_nop 1
    v_cvt_pk_bf16_f32 v0, v0, v1
    v_smfmac_f32_16x16x64_bf16 v[12:15], v[52:55], a[192:199], v64
    s_nop 1
    v_cvt_pk_bf16_f32 v1, v2, v3
    v_smfmac_f32_16x16x64_bf16 v[4:7], v[44:47], a[72:79], v64
    s_nop 1
    v_cvt_pk_bf16_f32 v2, v8, v9
    v_smfmac_f32_16x16x64_bf16 v[12:15], v[44:47], a[208:215], v64
    s_nop 1
    v_cvt_pk_bf16_f32 v3, v10, v11
    v_smfmac_f32_16x16x64_bf16 v[4:7], v[40:43], a[88:95], v64
    s_waitcnt lgkmcnt(0)
    s_nop 0
    s_nop 0
    v_smfmac_f32_16x16x64_bf16 v[12:15], v[40:43], a[224:231], v64
    s_nop 2
    v_mfma_f32_16x16x32_bf16 v[8:11], v[0:3], v[48:51], 0
    s_nop 0
    v_cvt_pk_bf16_f32 v4, v4, v5
    v_cvt_pk_bf16_f32 v5, v6, v7
    s_nop 0
    v_cvt_pk_bf16_f32 v6, v12, v13
    v_cvt_pk_bf16_f32 v7, v14, v15
    s_nop 1
    v_mfma_f32_16x16x32_bf16 v[12:15], v[4:7], v[48:51], 0
    ds_read_b128 v[48:51], v66 offset:4096
    v_cvt_pk_bf16_f32 v0, v8, v9
    v_cvt_pk_bf16_f32 v1, v10, v11
    v_smfmac_f32_16x16x64_bf16 v[16:19], v[52:55], v[208:215], v64
    s_waitcnt vmcnt(2)
    s_nop 2
    v_cvt_pk_bf16_f32 v2, v12, v13
    v_cvt_pk_bf16_f32 v3, v14, v15
    s_nop 1
    v_mfma_f32_16x16x32_bf16 v[12:15], v[0:3], v[0:3], 0
    s_nop 1
    v_bitop3_b32 v78, v73, -9, s53 bitop3:0x6a
    v_mfma_f32_16x16x32_bf16 v[4:7], v[24:27], v[0:3], 0
    ds_read_b128 v[24:27], v67 offset:0
    s_nop 1
    v_mfma_f32_16x16x32_bf16 v[8:11], v[28:31], v[0:3], 0
    s_nop 0
    v_mov_b32_dpp v12, v14 row_ror:8 row_mask:0xf bank_mask:0xc
    v_mov_b32_dpp v13, v15 row_ror:8 row_mask:0xf bank_mask:0xc
    v_smfmac_f32_16x16x64_bf16 v[20:23], v[52:55], v[216:223], v64
    ds_write_b64 v71, v[12:13]
    ds_read_b128 v[52:55], v68 offset:0
    s_nop 1
    v_mov_b32_dpp v4, v8 row_ror:8 row_mask:0xf bank_mask:0xc
    v_mov_b32_dpp v5, v9 row_ror:8 row_mask:0xf bank_mask:0xc
    v_mov_b32_dpp v6, v10 row_ror:8 row_mask:0xf bank_mask:0xc
    v_mov_b32_dpp v7, v11 row_ror:8 row_mask:0xf bank_mask:0xc
    v_smfmac_f32_16x16x64_bf16 v[16:19], v[44:47], v[224:231], v64
    ds_write_b128 v65, v[4:7] offset:8192
    v_smfmac_f32_16x16x64_bf16 v[20:23], v[44:47], v[232:239], v64
    s_waitcnt lgkmcnt(3)
    v_smfmac_f32_16x16x64_bf16 v[16:19], v[24:27], v[144:151], v64
    s_waitcnt vmcnt(1)
    v_smfmac_f32_16x16x64_bf16 v[20:23], v[24:27], v[152:159], v64
    s_mov_b64 exec, s[38:39]
    buffer_store_dword v72, v75, s[4:7], s55 offen sc1
    s_mov_b64 exec, -1
    v_smfmac_f32_16x16x64_bf16 v[16:19], v[40:43], v[240:247], v64
    s_cmp_ge_u32 s30, 56
    s_waitcnt lgkmcnt(0)
    s_barrier
    ds_read_b128 v[8:11], v66 offset:8192
    v_smfmac_f32_16x16x64_bf16 v[20:23], v[40:43], v[248:255], v64
    ds_read_b128 v[12:15], v67 offset:8192
    v_smfmac_f32_16x16x64_bf16 v[16:19], v[48:51], v[192:199], v64
    ds_read_b128 v[44:47], v68 offset:8192
    v_smfmac_f32_16x16x64_bf16 v[20:23], v[48:51], v[200:207], v64
    ds_read_b64 v[24:25], v77 offset:14336
    ds_read_b64 v[26:27], v77 offset:14592
    v_smfmac_f32_16x16x64_bf16 v[16:19], v[52:55], v[160:167], v64
    ds_read_b64 v[28:29], v77 offset:14848
    ds_read_b64 v[30:31], v77 offset:15104
    v_bitop3_b32 v77, v73, -9, s52 bitop3:0x6a
    v_smfmac_f32_16x16x64_bf16 v[20:23], v[52:55], v[168:175], v64
    s_cbranch_scc1 cf_rare
cf_rare_x:
    ds_read_b128 v[48:51], v70 offset:22528
    ds_read_b128 v[52:55], v70 offset:23552
    s_waitcnt lgkmcnt(6)
    v_pk_add_f32 v[4:5], v[4:5], v[8:9]
    v_pk_add_f32 v[6:7], v[6:7], v[10:11]
    v_pk_add_f32 v[12:13], v[12:13], v[44:45]
    v_pk_add_f32 v[14:15], v[14:15], v[46:47]
    v_pk_add_f32 v[4:5], v[4:5], v[12:13]
    v_pk_add_f32 v[6:7], v[6:7], v[14:15]
    s_waitcnt lgkmcnt(2)
    v_pk_add_f32 v[24:25], v[24:25], v[26:27]
    v_pk_add_f32 v[28:29], v[28:29], v[30:31]
    v_max3_f32 v8, v4, v5, v6
    v_pk_add_f32 v[24:25], v[24:25], v[28:29]
    v_max_f32 v8, v8, v7
    v_max3_f32 v8, v8, v24, v25
    v_cvt_pk_bf16_f32 v32, v16, v17
    v_cvt_pk_bf16_f32 v38, v18, v19
    v_max_f32_dpp v8, v8, v8 row_ror:8 row_mask:0xf bank_mask:0xf
    v_mov_b32 v9, v8
    v_cvt_pk_bf16_f32 v56, v20, v21
    v_cvt_pk_bf16_f32 v62, v22, v23
    v_permlane32_swap_b32 v8, v9
    v_max_f32 v8, v8, v9
    v_mov_b32 v9, v8
    v_mov_b32 v11, 0
    v_mov_b32 v15, 0
    v_permlane16_swap_b32 v8, v9
    v_max_f32 v8, v8, v9
    v_mul_f32 v8, s66, v8
    v_pk_fma_f32 v[4:5], v[4:5], s[44:45], v[8:9] op_sel_hi:[1,1,0]
    v_pk_fma_f32 v[6:7], v[6:7], s[44:45], v[8:9] op_sel_hi:[1,1,0]
    v_pk_fma_f32 v[24:25], v[24:25], s[44:45], v[8:9] op_sel_hi:[1,1,0]
    v_exp_f32 v4, v4
    v_exp_f32 v5, v5
    v_exp_f32 v6, v6
    v_exp_f32 v7, v7
    v_exp_f32 v24, v24
    v_exp_f32 v25, v25
    v_cvt_pk_bf16_f32 v12, v4, v5
    v_cvt_pk_bf16_f32 v13, v6, v7
    v_cvt_pk_bf16_f32 v10, v24, v25
    v_cvt_pk_bf16_f32 v14, v24, v25
    v_mov_b64 v[0:1], s[48:49]
    v_mfma_f32_16x16x32_bf16 v[4:7], v[32:35], v[10:13], 0
    ds_read_b128 v[40:43], v70 offset:20480
    v_mov_b64 v[2:3], s[50:51]
    v_mfma_f32_16x16x32_bf16 v[24:27], v[36:39], v[12:15], 0
    ds_read_b128 v[44:47], v70 offset:21504
    v_mov_b64 v[8:9], 0
    v_mfma_f32_16x16x32_bf16 v[28:31], v[0:3], v[10:13], 0
    ds_read_b128 v[32:35], v70 offset:24576
    v_mov_b64 v[0:1], 0
    v_mfma_f32_16x16x32_bf16 v[16:19], v[56:59], v[10:13], 0
    ds_read_b128 v[36:39], v70 offset:25600
    v_mov_b64 v[2:3], 0
    v_mfma_f32_16x16x32_bf16 v[20:23], v[60:63], v[12:15], 0
    ds_read_b128 v[56:59], v70 offset:28672
    v_add_f32_dpp v4, v24, v4 row_ror:8 row_mask:0xf bank_mask:0xf
    v_add_f32_dpp v5, v25, v5 row_ror:8 row_mask:0xf bank_mask:0xf
    v_add_f32_dpp v6, v26, v6 row_ror:8 row_mask:0xf bank_mask:0xf
    v_add_f32_dpp v7, v27, v7 row_ror:8 row_mask:0xf bank_mask:0xf
    v_add_f32_dpp v29, v28, v28 row_ror:8 row_mask:0xf bank_mask:0xf
    v_rcp_f32 v28, v29
    v_mov_b64 v[10:11], 0
    v_add_f32_dpp v4, v16, v20 row_ror:8 row_mask:0xf bank_mask:0xc
    v_add_f32_dpp v5, v17, v21 row_ror:8 row_mask:0xf bank_mask:0xc
    v_add_f32_dpp v6, v18, v22 row_ror:8 row_mask:0xf bank_mask:0xc
    v_add_f32_dpp v7, v19, v23 row_ror:8 row_mask:0xf bank_mask:0xc
    v_pk_mul_f32 v[4:5], v[4:5], v[28:29] op_sel_hi:[1,0]
    v_pk_mul_f32 v[6:7], v[6:7], v[28:29] op_sel_hi:[1,0]
    v_cvt_pk_bf16_f32 v4, v4, v5
    v_cvt_pk_bf16_f32 v5, v6, v7
    ds_write_b64 v73, v[4:5] offset:12288
    v_mov_b32_dpp v6, v4 row_ror:8 row_mask:0xf bank_mask:0xf
    v_mov_b32_dpp v7, v5 row_ror:8 row_mask:0xf bank_mask:0xf
    v_mov_b64 v[12:13], 0
    v_mov_b64 v[14:15], 0
    v_smfmac_f32_16x16x64_bf16 v[8:11], v[4:7], v[80:87], v64
    s_waitcnt lgkmcnt(4)
    v_mov_b64 v[24:25], 0
    v_smfmac_f32_16x16x64_bf16 v[0:3], v[4:7], v[40:47], v64
    ds_read_b128 v[60:63], v70 offset:29696
    v_mov_b64 v[26:27], 0
    v_smfmac_f32_16x16x64_bf16 v[12:15], v[4:7], v[112:119], v64
    s_waitcnt lgkmcnt(1)
    s_barrier
    ds_read_b128 v[16:19], v77 offset:12288
    v_smfmac_f32_16x16x64_bf16 v[24:27], v[4:7], v[48:55], v64
    ds_read_b128 v[20:23], v78 offset:12288
    ds_read_b128 v[28:31], v79 offset:12288
    v_mov_b64 v[4:5], 0
    v_mov_b64 v[6:7], 0
    v_bfe_u32 v77, v74, 16, 1
    v_mad_i32_i24 v77, v77, s56, v74
    s_waitcnt lgkmcnt(2)
    v_smfmac_f32_16x16x64_bf16 v[8:11], v[16:19], v[88:95], v64
    ds_read_b128 v[40:43], v70 offset:32768
    s_waitcnt lgkmcnt(2)
    v_smfmac_f32_16x16x64_bf16 v[8:11], v[20:23], v[96:103], v64
    ds_read_b128 v[44:47], v70 offset:33792
    s_waitcnt lgkmcnt(2)
    v_smfmac_f32_16x16x64_bf16 v[8:11], v[28:31], v[104:111], v64
    ds_read_b128 v[48:51], v70 offset:26624
    s_nop 0
    v_and_b32 v72, 8, v73
    v_smfmac_f32_16x16x64_bf16 v[0:3], v[16:19], v[32:39], v64
    ds_read_b128 v[52:55], v70 offset:27648
    s_nop 0
    v_mad_u32_u24 v72, v72, 63, v73
    v_smfmac_f32_16x16x64_bf16 v[12:15], v[16:19], v[120:127], v64
    ds_read_b128 v[32:35], v70 offset:30720
    v_cvt_pk_bf16_f32 v8, v8, v9
    v_cvt_pk_bf16_f32 v9, v10, v11
    v_and_or_b32 v8, v8, -2, s69
    v_smfmac_f32_16x16x64_bf16 v[12:15], v[20:23], v[128:135], v64
    buffer_store_dwordx2 v[8:9], v74, s[4:7], s22 offen offset:0
    ds_read_b128 v[36:39], v70 offset:31744
    v_smfmac_f32_16x16x64_bf16 v[12:15], v[28:31], v[136:143], v64
    s_add_u32 s30, s30, 1
    s_xor_b32 s70, s70, 1
    v_subrev_u32 v72, s47, v72
    v_smfmac_f32_16x16x64_bf16 v[0:3], v[20:23], v[56:63], v64
    ds_read_b128 v[56:59], v70 offset:34816
    s_waitcnt lgkmcnt(3)
    s_nop 0
    v_smfmac_f32_16x16x64_bf16 v[0:3], v[28:31], v[40:47], v64
    ds_read_b128 v[60:63], v70 offset:35840
    v_cvt_pk_bf16_f32 v12, v12, v13
    v_cvt_pk_bf16_f32 v13, v14, v15
    v_and_or_b32 v12, v12, -2, s69
    v_smfmac_f32_16x16x64_bf16 v[24:27], v[16:19], v[48:55], v64
    buffer_store_dwordx2 v[12:13], v74, s[4:7], s22 offen offset:64
    s_waitcnt lgkmcnt(2)
    v_smfmac_f32_16x16x64_bf16 v[24:27], v[20:23], v[32:39], v64
    ds_read_b128 v[40:43], v70 offset:16384
    v_cvt_pk_bf16_f32 v0, v0, v1
    v_cvt_pk_bf16_f32 v1, v2, v3
    v_and_or_b32 v0, v0, -2, s69
    s_waitcnt lgkmcnt(1)
    v_smfmac_f32_16x16x64_bf16 v[24:27], v[28:31], v[56:63], v64
    buffer_store_dwordx2 v[0:1], v74, s[4:7], s23 offen offset:0
    ds_read_b128 v[44:47], v70 offset:17408
    ds_read_b128 v[8:11], v72 offset:12288
    ds_read_b128 v[48:51], v70 offset:18432
    ds_read_b128 v[52:55], v70 offset:19456
    ds_read_b128 v[12:15], v72 offset:13312
    s_cmp_lg_u32 s71, 0
    s_nop 0
    v_cvt_pk_bf16_f32 v24, v24, v25
    v_cvt_pk_bf16_f32 v25, v26, v27
    v_and_or_b32 v24, v24, -2, s69
    buffer_store_dwordx2 v[24:25], v74, s[4:7], s23 offen offset:64
    s_waitcnt lgkmcnt(3)
    v_smfmac_f32_16x16x64_bf16 v[4:7], v[8:11], v[40:47], v64
    s_waitcnt lgkmcnt(0)
    v_smfmac_f32_16x16x64_bf16 v[4:7], v[12:15], v[48:55], v64
    s_nop 7
    v_cvt_pk_bf16_f32 v4, v4, v5
    v_cvt_pk_bf16_f32 v5, v6, v7
    v_and_or_b32 v4, v4, -2, s69
    buffer_store_dwordx2 v[4:5], v77, s[4:7], s25 offen offset:0
    s_nop 0
    s_cbranch_scc1 cf_e1
    s_cmp_lg_u32 s37, 0
    s_cbranch_scc1 cf_f0_xt
cf_f0_xtx:
    s_nop 2
    v_mov_b32 v79, v79
    s_nop 2
    v_mov_b32 v79, v79
    s_nop 2
    v_mov_b32 v79, v79
    s_nop 2
    v_mov_b32 v79, v79
    s_nop 2
    v_mov_b32 v79, v79
    buffer_load_dwordx4 v[8:11], v65, s[4:7], s18 offen nt
    buffer_load_dwordx4 v[12:15], v65, s[4:7], s19 offen nt
    buffer_load_dwordx4 v[16:19], v65, s[4:7], s20 offen nt
    buffer_load_dwordx4 v[20:23], v65, s[4:7], s21 offen nt
    v_and_b32 v77, 255, v69
    ds_read_b128 v[4:7], v77 offset:15872
    ds_read_b128 v[44:47], v70 offset:0
    ds_read_b128 v[48:51], v70 offset:1024
    ds_read_b128 v[52:55], v70 offset:2048
    ds_read_b128 v[56:59], v70 offset:3072
    ds_read_b128 v[24:27], v70 offset:4096
    ds_read_b128 v[28:31], v70 offset:5120
    ds_read_b128 v[32:35], v70 offset:6144
    ds_read_b128 v[36:39], v70 offset:7168
    s_mov_b32 s31, 65536
    s_add_u32 s24, s24, 524288
    s_add_u32 s26, s26, 524288
    s_add_u32 s55, s55, s57
    s_mov_b32 s14, 67108864
    s_mov_b32 s15, 67112960
    s_mov_b32 s16, 67117056
    s_mov_b32 s36, 1
    v_mov_b32 v40, s69
    v_mov_b32 v60, s69
    v_and_b32 v79, 12, v75
    v_cmp_eq_u32 vcc, 0, v79
    s_nop 1
    v_cndmask_b32 v79, 0, 1, vcc
    s_waitcnt lgkmcnt(0)
    s_waitcnt vmcnt(3)
    v_bitop3_b32 v77, v8, v10, s69 bitop3:0x7e
    v_mfma_f32_16x16x32_bf16 v[0:3], v[4:7], v[8:11], 0
    v_mov_b64 v[8:9], 0
    v_mov_b64 v[10:11], 0
    s_waitcnt vmcnt(2)
    v_bitop3_b32 v78, v12, v14, s69 bitop3:0x7e
    v_mfma_f32_16x16x32_bf16 v[0:3], v[4:7], v[12:15], v[0:3]
    v_or_b32 v77, v77, v78
    v_mov_b64 v[12:13], 0
    v_mov_b64 v[14:15], 0
    s_waitcnt vmcnt(1)
    v_bitop3_b32 v78, v16, v18, s69 bitop3:0x7e
    v_mfma_f32_16x16x32_bf16 v[0:3], v[4:7], v[16:19], v[0:3]
    v_or_b32 v77, v77, v78
    v_mov_b64 v[16:17], 0
    v_mov_b64 v[18:19], 0
    s_waitcnt vmcnt(0)
    v_bitop3_b32 v78, v20, v22, s69 bitop3:0x7e
    v_mfma_f32_16x16x32_bf16 v[0:3], v[4:7], v[20:23], v[0:3]
    v_bitop3_b32 v77, v77, v78, 1 bitop3:0xa8
    v_cmp_ne_u32 vcc, 0, v77
    v_mov_b64 v[20:21], 0
    v_mov_b64 v[22:23], 0
    s_cmp_eq_u64 vcc, 0
    s_cselect_b64 s[42:43], -1, 0
    s_nop 1
    v_add_f32_dpp v0, v0, v0 row_ror:8 row_mask:0xf bank_mask:0xf
    v_add_f32_dpp v1, v1, v1 row_ror:8 row_mask:0xf bank_mask:0xf
    s_mov_b64 exec, s[42:43]
    v_cvt_pk_bf16_f32 v72, v0, v1
    v_bfi_b32 v72, v79, s70, v72
    buffer_store_dword v72, v75, s[4:7], s17 offen offset:0
    s_mov_b64 exec, -1
    s_cbranch_scc0 cf_f0_retry
cf_f0_go:
    v_mov_b64 v[0:1], 0
    v_mov_b64 v[2:3], 0
    v_mov_b64 v[4:5], 0
    v_mov_b64 v[6:7], 0
    s_nop 2
    v_mov_b32 v79, v79
    s_nop 2
    v_mov_b32 v79, v79
    s_nop 2
    v_mov_b32 v79, v79
    s_nop 2
    v_mov_b32 v79, v79
    s_branch cf_loop
cf_e1:
    s_cmp_lg_u32 s71, 2
    s_cbranch_scc1 cf_f1
    v_and_b32 v77, 255, v69
    ds_read_b128 v[4:7], v77 offset:15872
    ds_read_b128 v[44:47], v70 offset:0
    ds_read_b128 v[48:51], v70 offset:1024
    ds_read_b128 v[52:55], v70 offset:2048
    ds_read_b128 v[56:59], v70 offset:3072
    ds_read_b128 v[24:27], v70 offset:4096
    ds_read_b128 v[28:31], v70 offset:5120
    ds_read_b128 v[32:35], v70 offset:6144
    ds_read_b128 v[36:39], v70 offset:7168
    s_mov_b32 s31, 65536
    s_add_u32 s24, s24, 524288
    s_add_u32 s26, s26, 524288
    s_add_u32 s55, s55, s57
    s_mov_b32 s14, 67108864
    s_mov_b32 s15, 67112960
    s_mov_b32 s16, 67117056
    s_mov_b32 s36, 1
    v_mov_b32 v40, s69
    v_mov_b32 v60, s69
    v_and_b32 v79, 12, v75
    v_cmp_eq_u32 vcc, 0, v79
    s_nop 1
    v_cndmask_b32 v79, 0, 1, vcc
    s_cmp_lg_u32 s37, 0
    s_cbranch_scc1 cf_f2_xt
cf_f2_xtx:
    s_nop 2
    v_mov_b32 v79, v79
    s_nop 2
    v_mov_b32 v79, v79
    s_nop 2
    v_mov_b32 v79, v79
    s_nop 2
    v_mov_b32 v79, v79
    s_nop 2
    v_mov_b32 v79, v79
    s_nop 2
    v_mov_b32 v79, v79
    s_nop 2
    v_mov_b32 v79, v79
    s_nop 2
    v_mov_b32 v79, v79
    s_waitcnt vmcnt(0)
    buffer_load_dwordx4 v[8:11], v65, s[4:7], s18 offen nt
    buffer_load_dwordx4 v[12:15], v65, s[4:7], s19 offen nt
    buffer_load_dwordx4 v[16:19], v65, s[4:7], s20 offen nt
    buffer_load_dwordx4 v[20:23], v65, s[4:7], s21 offen nt
    s_nop 2
    v_mov_b32 v79, v79
    s_nop 2
    v_mov_b32 v79, v79
    s_nop 2
    v_mov_b32 v79, v79
    s_nop 2
    v_mov_b32 v79, v79
    s_nop 2
    v_mov_b32 v79, v79
    s_nop 2
    v_mov_b32 v79, v79
    s_nop 2
    v_mov_b32 v79, v79
    s_nop 2
    v_mov_b32 v79, v79
    s_nop 2
    v_mov_b32 v79, v79
    s_nop 2
    v_mov_b32 v79, v79
    buffer_load_dwordx4 v[40:43], v65, s[4:7], s14 offen offset:0 nt
    buffer_load_dwordx4 v[60:63], v66, s[4:7], s14 offen offset:0 nt
    s_waitcnt lgkmcnt(0)
    s_waitcnt vmcnt(5)
    v_bitop3_b32 v77, v8, v10, s69 bitop3:0x7e
    v_mfma_f32_16x16x32_bf16 v[0:3], v[4:7], v[8:11], 0
    v_mov_b64 v[8:9], 0
    v_mov_b64 v[10:11], 0
    s_waitcnt vmcnt(4)
    v_bitop3_b32 v78, v12, v14, s69 bitop3:0x7e
    v_mfma_f32_16x16x32_bf16 v[0:3], v[4:7], v[12:15], v[0:3]
    v_or_b32 v77, v77, v78
    v_mov_b64 v[12:13], 0
    v_mov_b64 v[14:15], 0
    s_waitcnt vmcnt(3)
    v_bitop3_b32 v78, v16, v18, s69 bitop3:0x7e
    v_mfma_f32_16x16x32_bf16 v[0:3], v[4:7], v[16:19], v[0:3]
    v_or_b32 v77, v77, v78
    v_mov_b64 v[16:17], 0
    v_mov_b64 v[18:19], 0
    s_waitcnt vmcnt(2)
    v_bitop3_b32 v78, v20, v22, s69 bitop3:0x7e
    v_mfma_f32_16x16x32_bf16 v[0:3], v[4:7], v[20:23], v[0:3]
    v_bitop3_b32 v77, v77, v78, 1 bitop3:0xa8
    v_cmp_ne_u32 vcc, 0, v77
    v_mov_b64 v[20:21], 0
    v_mov_b64 v[22:23], 0
    buffer_load_dwordx4 v[40:43], v65, s[4:7], s14 offen offset:0 nt
    buffer_load_dwordx4 v[60:63], v66, s[4:7], s14 offen offset:0 nt
    s_cmp_eq_u64 vcc, 0
    s_cselect_b64 s[42:43], -1, 0
    v_add_f32_dpp v0, v0, v0 row_ror:4 row_mask:0xf bank_mask:0xf
    v_add_f32_dpp v1, v1, v1 row_ror:4 row_mask:0xf bank_mask:0xf
    s_nop 0
    v_add_f32_dpp v0, v0, v0 row_ror:8 row_mask:0xf bank_mask:0xf
    v_add_f32_dpp v1, v1, v1 row_ror:8 row_mask:0xf bank_mask:0xf
    s_mov_b64 exec, s[42:43]
    v_cvt_pk_bf16_f32 v72, v0, v1
    v_bfi_b32 v72, v79, s70, v72
    buffer_store_dword v72, v75, s[4:7], s17 offen offset:0
    buffer_store_dword v72, v75, s[4:7], s17 offen offset:1024
    buffer_store_dword v72, v75, s[4:7], s17 offen offset:2048
    buffer_store_dword v72, v75, s[4:7], s17 offen offset:3072
    s_mov_b64 exec, -1
    s_cbranch_scc0 cf_f2_retry
cf_f2_go:
    v_mov_b64 v[0:1], 0
    v_mov_b64 v[2:3], 0
    v_mov_b64 v[4:5], 0
    v_mov_b64 v[6:7], 0
    s_branch cf_loop
cf_f1:
    s_cmp_lg_u32 s32, 1
    s_cbranch_scc1 cf_f3
    v_and_b32 v77, 255, v69
    ds_read_b128 v[4:7], v77 offset:15872
    ds_read_b128 v[44:47], v70 offset:0
    ds_read_b128 v[48:51], v70 offset:1024
    ds_read_b128 v[52:55], v70 offset:2048
    ds_read_b128 v[56:59], v70 offset:3072
    ds_read_b128 v[24:27], v70 offset:4096
    ds_read_b128 v[28:31], v70 offset:5120
    ds_read_b128 v[32:35], v70 offset:6144
    ds_read_b128 v[36:39], v70 offset:7168
    s_mov_b32 s31, 65536
    s_add_u32 s24, s24, 524288
    s_add_u32 s26, s26, 524288
    s_add_u32 s55, s55, s57
    s_mov_b32 s14, 67108864
    s_mov_b32 s15, 67112960
    s_mov_b32 s16, 67117056
    s_mov_b32 s36, 1
    v_mov_b32 v40, s69
    v_mov_b32 v60, s69
    v_and_b32 v79, 12, v75
    v_cmp_eq_u32 vcc, 0, v79
    s_nop 1
    v_cndmask_b32 v79, 0, 1, vcc
    s_cmp_lg_u32 s37, 0
    s_cbranch_scc1 cf_f1_xt
cf_f1_xtx:
    s_nop 2
    v_mov_b32 v79, v79
    s_waitcnt vmcnt(0)
    buffer_load_dwordx4 v[8:11], v65, s[4:7], s18 offen nt
    buffer_load_dwordx4 v[12:15], v65, s[4:7], s19 offen nt
    buffer_load_dwordx4 v[16:19], v65, s[4:7], s20 offen nt
    buffer_load_dwordx4 v[20:23], v65, s[4:7], s21 offen nt
    s_nop 2
    v_mov_b32 v79, v79
    s_nop 2
    v_mov_b32 v79, v79
    s_nop 2
    v_mov_b32 v79, v79
    s_nop 2
    v_mov_b32 v79, v79
    s_nop 2
    v_mov_b32 v79, v79
    s_nop 2
    v_mov_b32 v79, v79
    s_nop 2
    v_mov_b32 v79, v79
    s_nop 2
    v_mov_b32 v79, v79
    s_nop 2
    v_mov_b32 v79, v79
    s_nop 2
    v_mov_b32 v79, v79
    buffer_load_dwordx4 v[40:43], v65, s[4:7], s14 offen offset:0 nt
    buffer_load_dwordx4 v[60:63], v66, s[4:7], s14 offen offset:0 nt
    s_waitcnt lgkmcnt(0)
    s_waitcnt vmcnt(5)
    v_bitop3_b32 v77, v8, v10, s69 bitop3:0x7e
    v_mfma_f32_16x16x32_bf16 v[0:3], v[4:7], v[8:11], 0
    v_mov_b64 v[8:9], 0
    v_mov_b64 v[10:11], 0
    s_waitcnt vmcnt(4)
    v_bitop3_b32 v78, v12, v14, s69 bitop3:0x7e
    v_mfma_f32_16x16x32_bf16 v[0:3], v[4:7], v[12:15], v[0:3]
    v_or_b32 v77, v77, v78
    v_mov_b64 v[12:13], 0
    v_mov_b64 v[14:15], 0
    s_waitcnt vmcnt(3)
    v_bitop3_b32 v78, v16, v18, s69 bitop3:0x7e
    v_mfma_f32_16x16x32_bf16 v[0:3], v[4:7], v[16:19], v[0:3]
    v_or_b32 v77, v77, v78
    v_mov_b64 v[16:17], 0
    v_mov_b64 v[18:19], 0
    s_waitcnt vmcnt(2)
    v_bitop3_b32 v78, v20, v22, s69 bitop3:0x7e
    v_mfma_f32_16x16x32_bf16 v[0:3], v[4:7], v[20:23], v[0:3]
    v_bitop3_b32 v77, v77, v78, 1 bitop3:0xa8
    v_cmp_ne_u32 vcc, 0, v77
    v_mov_b64 v[20:21], 0
    v_mov_b64 v[22:23], 0
    buffer_load_dwordx4 v[40:43], v65, s[4:7], s14 offen offset:0 nt
    buffer_load_dwordx4 v[60:63], v66, s[4:7], s14 offen offset:0 nt
    s_cmp_eq_u64 vcc, 0
    s_cselect_b64 s[42:43], -1, 0
    v_add_f32_dpp v0, v0, v0 row_ror:8 row_mask:0xf bank_mask:0xf
    v_add_f32_dpp v1, v1, v1 row_ror:8 row_mask:0xf bank_mask:0xf
    s_mov_b64 exec, s[42:43]
    v_cvt_pk_bf16_f32 v72, v0, v1
    v_bfi_b32 v72, v79, s70, v72
    buffer_store_dword v72, v75, s[4:7], s17 offen offset:0
    s_mov_b64 exec, -1
    s_cbranch_scc0 cf_f1_retry
cf_f1_go:
    v_mov_b64 v[0:1], 0
    v_mov_b64 v[2:3], 0
    v_mov_b64 v[4:5], 0
    v_mov_b64 v[6:7], 0
    s_branch cf_loop
cf_f3:
    v_and_b32 v77, 255, v69
    ds_read_b128 v[4:7], v77 offset:15872
    ds_read_b128 v[44:47], v70 offset:0
    ds_read_b128 v[48:51], v70 offset:1024
    ds_read_b128 v[52:55], v70 offset:2048
    ds_read_b128 v[56:59], v70 offset:3072
    ds_read_b128 v[24:27], v70 offset:4096
    ds_read_b128 v[28:31], v70 offset:5120
    ds_read_b128 v[32:35], v70 offset:6144
    ds_read_b128 v[36:39], v70 offset:7168
    s_mov_b32 s31, 65536
    s_add_u32 s24, s24, 524288
    s_add_u32 s26, s26, 524288
    s_add_u32 s55, s55, s57
    s_mov_b32 s14, 67108864
    s_mov_b32 s15, 67112960
    s_mov_b32 s16, 67117056
    s_mov_b32 s36, 1
    v_mov_b32 v40, s69
    v_mov_b32 v60, s69
    v_and_b32 v79, 12, v75
    v_cmp_eq_u32 vcc, 0, v79
    s_nop 1
    v_cndmask_b32 v79, 0, 1, vcc
    s_add_u32 s40, s30, s95
    v_mov_b32 v72, s40
    s_waitcnt lgkmcnt(0)
    v_mov_b64 v[0:1], 0
    v_mov_b64 v[2:3], 0
    v_mov_b64 v[4:5], 0
    v_mov_b64 v[6:7], 0
    v_mov_b64 v[8:9], 0
    v_mov_b64 v[10:11], 0
    v_mov_b64 v[12:13], 0
    v_mov_b64 v[14:15], 0
    v_mov_b64 v[16:17], 0
    v_mov_b64 v[18:19], 0
    v_mov_b64 v[20:21], 0
    v_mov_b64 v[22:23], 0
    s_nop 2
    v_mov_b32 v79, v79
    s_nop 2
    v_mov_b32 v79, v79
    s_nop 2
    v_mov_b32 v79, v79
    s_nop 2
    v_mov_b32 v79, v79
    s_nop 2
    v_mov_b32 v79, v79
    s_nop 2
    v_mov_b32 v79, v79
    s_nop 2
    v_mov_b32 v79, v79
    s_nop 2
    v_mov_b32 v79, v79
    s_nop 2
    v_mov_b32 v79, v79
    s_waitcnt vmcnt(0)
    s_cmp_lt_u32 s97, s93
    s_cbranch_scc1 cf_kvwait
    s_nop 2
    v_mov_b32 v79, v79
    s_nop 2
    v_mov_b32 v79, v79
    s_nop 2
    v_mov_b32 v79, v79
    s_nop 2
    v_mov_b32 v79, v79
    s_nop 2
    v_mov_b32 v79, v79
    s_nop 2
    v_mov_b32 v79, v79
    s_nop 2
    v_mov_b32 v79, v79
    s_nop 2
    v_mov_b32 v79, v79
cf_kvok:
    s_branch cf_loop
cf_f0_xt:
    s_sub_u32 s37, s37, 1
    s_nop 2
    v_mov_b32 v79, v79
    s_nop 2
    v_mov_b32 v79, v79
    s_nop 2
    v_mov_b32 v79, v79
    s_nop 2
    v_mov_b32 v79, v79
    s_nop 2
    v_mov_b32 v79, v79
    s_nop 2
    v_mov_b32 v79, v79
    s_branch cf_f0_xtx
cf_f0_retry:
    s_sub_u32 s41, s30, s98
    s_mov_b32 s98, s30
    s_cmp_le_u32 s41, 3
    s_cselect_b32 s37, 1, 1
cf_f0_spin:
    buffer_load_dwordx4 v[8:11], v65, s[4:7], s18 offen nt
    buffer_load_dwordx4 v[12:15], v65, s[4:7], s19 offen nt
    buffer_load_dwordx4 v[16:19], v65, s[4:7], s20 offen nt
    buffer_load_dwordx4 v[20:23], v65, s[4:7], s21 offen nt
    s_nop 2
    v_mov_b32 v79, v79
    s_nop 2
    v_mov_b32 v79, v79
    s_nop 2
    v_mov_b32 v79, v79
    buffer_load_dwordx4 v[40:43], v65, s[4:7], s14 offen offset:0 nt
    buffer_load_dwordx4 v[60:63], v66, s[4:7], s14 offen offset:0 nt
    s_waitcnt vmcnt(5)
    v_bitop3_b32 v77, v8, v10, s69 bitop3:0x7e
    v_mfma_f32_16x16x32_bf16 v[0:3], v[4:7], v[8:11], 0
    v_mov_b64 v[8:9], 0
    v_mov_b64 v[10:11], 0
    s_waitcnt vmcnt(4)
    v_bitop3_b32 v78, v12, v14, s69 bitop3:0x7e
    v_mfma_f32_16x16x32_bf16 v[0:3], v[4:7], v[12:15], v[0:3]
    v_or_b32 v77, v77, v78
    v_mov_b64 v[12:13], 0
    v_mov_b64 v[14:15], 0
    s_waitcnt vmcnt(3)
    v_bitop3_b32 v78, v16, v18, s69 bitop3:0x7e
    v_mfma_f32_16x16x32_bf16 v[0:3], v[4:7], v[16:19], v[0:3]
    v_or_b32 v77, v77, v78
    v_mov_b64 v[16:17], 0
    v_mov_b64 v[18:19], 0
    s_waitcnt vmcnt(2)
    v_bitop3_b32 v78, v20, v22, s69 bitop3:0x7e
    v_mfma_f32_16x16x32_bf16 v[0:3], v[4:7], v[20:23], v[0:3]
    v_bitop3_b32 v77, v77, v78, 1 bitop3:0xa8
    v_cmp_ne_u32 vcc, 0, v77
    v_mov_b64 v[20:21], 0
    v_mov_b64 v[22:23], 0
    buffer_load_dwordx4 v[40:43], v65, s[4:7], s14 offen offset:0 nt
    buffer_load_dwordx4 v[60:63], v66, s[4:7], s14 offen offset:0 nt
    s_cmp_eq_u64 vcc, 0
    s_cselect_b64 s[42:43], -1, 0
    v_add_f32_dpp v0, v0, v0 row_ror:8 row_mask:0xf bank_mask:0xf
    v_add_f32_dpp v1, v1, v1 row_ror:8 row_mask:0xf bank_mask:0xf
    s_mov_b64 exec, s[42:43]
    v_cvt_pk_bf16_f32 v72, v0, v1
    v_bfi_b32 v72, v79, s70, v72
    buffer_store_dword v72, v75, s[4:7], s17 offen offset:0
    s_mov_b64 exec, -1
    s_cbranch_scc1 cf_f0_rx
    s_sub_u32 s31, s31, 1
    s_cbranch_scc0 cf_f0_spin
cf_f0_rx:
    v_mov_b64 v[0:1], 0
    v_mov_b64 v[2:3], 0
    v_mov_b64 v[4:5], 0
    v_mov_b64 v[6:7], 0
    s_branch cf_loop
cf_f1_xt:
    s_sub_u32 s37, s37, 1
    s_nop 2
    v_mov_b32 v79, v79
    s_nop 2
    v_mov_b32 v79, v79
    s_nop 2
    v_mov_b32 v79, v79
    s_nop 2
    v_mov_b32 v79, v79
    s_nop 2
    v_mov_b32 v79, v79
    s_nop 2
    v_mov_b32 v79, v79
    s_branch cf_f1_xtx
cf_f1_retry:
    s_sub_u32 s41, s30, s98
    s_mov_b32 s98, s30
    s_cmp_le_u32 s41, 3
    s_cselect_b32 s37, 1, 1
cf_f1_spin:
    buffer_load_dwordx4 v[8:11], v65, s[4:7], s18 offen nt
    buffer_load_dwordx4 v[12:15], v65, s[4:7], s19 offen nt
    buffer_load_dwordx4 v[16:19], v65, s[4:7], s20 offen nt
    buffer_load_dwordx4 v[20:23], v65, s[4:7], s21 offen nt
    s_nop 2
    v_mov_b32 v79, v79
    s_nop 2
    v_mov_b32 v79, v79
    s_nop 2
    v_mov_b32 v79, v79
    buffer_load_dwordx4 v[40:43], v65, s[4:7], s14 offen offset:0 nt
    buffer_load_dwordx4 v[60:63], v66, s[4:7], s14 offen offset:0 nt
    s_waitcnt vmcnt(5)
    v_bitop3_b32 v77, v8, v10, s69 bitop3:0x7e
    v_mfma_f32_16x16x32_bf16 v[0:3], v[4:7], v[8:11], 0
    v_mov_b64 v[8:9], 0
    v_mov_b64 v[10:11], 0
    s_waitcnt vmcnt(4)
    v_bitop3_b32 v78, v12, v14, s69 bitop3:0x7e
    v_mfma_f32_16x16x32_bf16 v[0:3], v[4:7], v[12:15], v[0:3]
    v_or_b32 v77, v77, v78
    v_mov_b64 v[12:13], 0
    v_mov_b64 v[14:15], 0
    s_waitcnt vmcnt(3)
    v_bitop3_b32 v78, v16, v18, s69 bitop3:0x7e
    v_mfma_f32_16x16x32_bf16 v[0:3], v[4:7], v[16:19], v[0:3]
    v_or_b32 v77, v77, v78
    v_mov_b64 v[16:17], 0
    v_mov_b64 v[18:19], 0
    s_waitcnt vmcnt(2)
    v_bitop3_b32 v78, v20, v22, s69 bitop3:0x7e
    v_mfma_f32_16x16x32_bf16 v[0:3], v[4:7], v[20:23], v[0:3]
    v_bitop3_b32 v77, v77, v78, 1 bitop3:0xa8
    v_cmp_ne_u32 vcc, 0, v77
    v_mov_b64 v[20:21], 0
    v_mov_b64 v[22:23], 0
    buffer_load_dwordx4 v[40:43], v65, s[4:7], s14 offen offset:0 nt
    buffer_load_dwordx4 v[60:63], v66, s[4:7], s14 offen offset:0 nt
    s_cmp_eq_u64 vcc, 0
    s_cselect_b64 s[42:43], -1, 0
    v_add_f32_dpp v0, v0, v0 row_ror:8 row_mask:0xf bank_mask:0xf
    v_add_f32_dpp v1, v1, v1 row_ror:8 row_mask:0xf bank_mask:0xf
    s_mov_b64 exec, s[42:43]
    v_cvt_pk_bf16_f32 v72, v0, v1
    v_bfi_b32 v72, v79, s70, v72
    buffer_store_dword v72, v75, s[4:7], s17 offen offset:0
    s_mov_b64 exec, -1
    s_cbranch_scc1 cf_f1_rx
    s_sub_u32 s31, s31, 1
    s_cbranch_scc0 cf_f1_spin
cf_f1_rx:
    v_mov_b64 v[0:1], 0
    v_mov_b64 v[2:3], 0
    v_mov_b64 v[4:5], 0
    v_mov_b64 v[6:7], 0
    s_branch cf_loop
cf_f2_xt:
    s_sub_u32 s37, s37, 1
    s_nop 2
    v_mov_b32 v79, v79
    s_nop 2
    v_mov_b32 v79, v79
    s_nop 2
    v_mov_b32 v79, v79
    s_nop 2
    v_mov_b32 v79, v79
    s_nop 2
    v_mov_b32 v79, v79
    s_nop 2
    v_mov_b32 v79, v79
    s_branch cf_f2_xtx
cf_f2_retry:
    s_sub_u32 s41, s30, s98
    s_mov_b32 s98, s30
    s_cmp_le_u32 s41, 3
    s_cselect_b32 s37, 1, 1
cf_f2_spin:
    buffer_load_dwordx4 v[8:11], v65, s[4:7], s18 offen nt
    buffer_load_dwordx4 v[12:15], v65, s[4:7], s19 offen nt
    buffer_load_dwordx4 v[16:19], v65, s[4:7], s20 offen nt
    buffer_load_dwordx4 v[20:23], v65, s[4:7], s21 offen nt
    s_nop 2
    v_mov_b32 v79, v79
    s_nop 2
    v_mov_b32 v79, v79
    s_nop 2
    v_mov_b32 v79, v79
    buffer_load_dwordx4 v[40:43], v65, s[4:7], s14 offen offset:0 nt
    buffer_load_dwordx4 v[60:63], v66, s[4:7], s14 offen offset:0 nt
    s_waitcnt vmcnt(5)
    v_bitop3_b32 v77, v8, v10, s69 bitop3:0x7e
    v_mfma_f32_16x16x32_bf16 v[0:3], v[4:7], v[8:11], 0
    v_mov_b64 v[8:9], 0
    v_mov_b64 v[10:11], 0
    s_waitcnt vmcnt(4)
    v_bitop3_b32 v78, v12, v14, s69 bitop3:0x7e
    v_mfma_f32_16x16x32_bf16 v[0:3], v[4:7], v[12:15], v[0:3]
    v_or_b32 v77, v77, v78
    v_mov_b64 v[12:13], 0
    v_mov_b64 v[14:15], 0
    s_waitcnt vmcnt(3)
    v_bitop3_b32 v78, v16, v18, s69 bitop3:0x7e
    v_mfma_f32_16x16x32_bf16 v[0:3], v[4:7], v[16:19], v[0:3]
    v_or_b32 v77, v77, v78
    v_mov_b64 v[16:17], 0
    v_mov_b64 v[18:19], 0
    s_waitcnt vmcnt(2)
    v_bitop3_b32 v78, v20, v22, s69 bitop3:0x7e
    v_mfma_f32_16x16x32_bf16 v[0:3], v[4:7], v[20:23], v[0:3]
    v_bitop3_b32 v77, v77, v78, 1 bitop3:0xa8
    v_cmp_ne_u32 vcc, 0, v77
    v_mov_b64 v[20:21], 0
    v_mov_b64 v[22:23], 0
    buffer_load_dwordx4 v[40:43], v65, s[4:7], s14 offen offset:0 nt
    buffer_load_dwordx4 v[60:63], v66, s[4:7], s14 offen offset:0 nt
    s_cmp_eq_u64 vcc, 0
    s_cselect_b64 s[42:43], -1, 0
    v_add_f32_dpp v0, v0, v0 row_ror:4 row_mask:0xf bank_mask:0xf
    v_add_f32_dpp v1, v1, v1 row_ror:4 row_mask:0xf bank_mask:0xf
    s_nop 0
    v_add_f32_dpp v0, v0, v0 row_ror:8 row_mask:0xf bank_mask:0xf
    v_add_f32_dpp v1, v1, v1 row_ror:8 row_mask:0xf bank_mask:0xf
    s_mov_b64 exec, s[42:43]
    v_cvt_pk_bf16_f32 v72, v0, v1
    v_bfi_b32 v72, v79, s70, v72
    buffer_store_dword v72, v75, s[4:7], s17 offen offset:0
    buffer_store_dword v72, v75, s[4:7], s17 offen offset:1024
    buffer_store_dword v72, v75, s[4:7], s17 offen offset:2048
    buffer_store_dword v72, v75, s[4:7], s17 offen offset:3072
    s_mov_b64 exec, -1
    s_cbranch_scc1 cf_f2_rx
    s_sub_u32 s31, s31, 1
    s_cbranch_scc0 cf_f2_spin
cf_f2_rx:
    v_mov_b64 v[0:1], 0
    v_mov_b64 v[2:3], 0
    v_mov_b64 v[4:5], 0
    v_mov_b64 v[6:7], 0
    s_branch cf_loop
cf_spinB:
    s_waitcnt vmcnt(3)
cf_spinB_l:
    v_and_b32 v77, s36, v44
    v_cmp_ne_u32 vcc, s70, v77
    s_cbranch_vccz cf_spinB_x
    buffer_load_dwordx4 v[44:47], v65, s[4:7], s15 offen nt
    s_sub_u32 s31, s31, 16
    s_waitcnt vmcnt(0)
    s_cbranch_scc0 cf_spinB_l
cf_spinB_x:
    ds_write_b128 v65, v[44:47] offset:4096
    s_waitcnt lgkmcnt(0)
    s_branch cf_backB
cf_spin8:
    buffer_load_dwordx4 v[40:43], v65, s[4:7], s16 offen nt
cf_spin8_l:
    v_and_b32 v77, s36, v40
    v_cmp_ne_u32 vcc, s70, v77
    s_cbranch_vccz cf_spin8_x
    s_nop 1
    v_and_b32 v77, s36, v40
    v_cmp_ne_u32 vcc, s70, v77
    s_cbranch_vccz cf_spin8_x
    s_nop 1
    v_and_b32 v77, s36, v40
    v_cmp_ne_u32 vcc, s70, v77
    s_cbranch_vccz cf_spin8_x
    s_nop 1
    buffer_load_dwordx4 v[40:43], v65, s[4:7], s16 offen nt
    s_sub_u32 s31, s31, 16
    s_cbranch_scc0 cf_spin8_l
cf_spin8_x:
    s_branch cf_back8
cf_rare:
    s_mov_b64 exec, s[34:35]
    buffer_store_dwordx4 v[0:3], v65, s[4:7], s28 offen sc1
    s_mov_b64 exec, -1
    s_nop 3
    v_cvt_pk_bf16_f32 v52, v16, v17
    v_cvt_pk_bf16_f32 v53, v18, v19
    v_cvt_pk_bf16_f32 v54, v20, v21
    v_cvt_pk_bf16_f32 v55, v22, v23
    buffer_store_dwordx4 v[52:55], v65, s[4:7], s27 offen sc1
    s_add_u32 s28, s28, 131072
    s_add_u32 s27, s27, 131072
    s_cmp_eq_u32 s30, 63
    s_cbranch_scc1 cf_last
    s_branch cf_rare_x
cf_kvwait:
    s_mov_b32 s41, s97
    v_bfe_u32 v78, v65, 2, 5
    v_mov_b32 v77, v76
    s_nop 1
    v_permlane32_swap_b32 v76, v77
    v_subrev_u32 v77, s95, v77
    v_cmp_lt_u32 vcc, 16, v77
    s_nop 1
    v_cndmask_b32 v77, v77, 0, vcc
    v_bfe_u32 v79, v78, 2, 2
    v_lshl_add_u32 v77, v77, 2, v79
    s_nop 1
    v_min_u32_dpp v77, v77, v77 row_ror:1 row_mask:0xf bank_mask:0xf
    s_nop 1
    v_min_u32_dpp v77, v77, v77 row_ror:2 row_mask:0xf bank_mask:0xf
    s_nop 1
    v_min_u32_dpp v77, v77, v77 row_ror:4 row_mask:0xf bank_mask:0xf
    s_nop 0
    v_readfirstlane_b32 s97, v77
    s_nop 0
    s_max_u32 s97, s97, s41
    s_add_u32 s40, s30, 3
    s_min_u32 s40, s40, 64
    s_cmp_le_u32 s40, s97
    s_cbranch_scc1 cf_kvw_x
    v_bfe_u32 v78, v65, 2, 5
    s_mov_b32 s31, 4194304
cf_kvw:
    buffer_load_dword v77, v78, s[4:7], s96 offen offset:16 sc1
    s_waitcnt vmcnt(0)
    v_subrev_u32 v77, s95, v77
    v_cmp_lt_u32 vcc, 16, v77
    s_nop 1
    v_cndmask_b32 v77, v77, 0, vcc
    v_bfe_u32 v79, v78, 2, 2
    v_lshl_add_u32 v77, v77, 2, v79
    s_nop 1
    v_min_u32_dpp v77, v77, v77 row_ror:1 row_mask:0xf bank_mask:0xf
    s_nop 1
    v_min_u32_dpp v77, v77, v77 row_ror:2 row_mask:0xf bank_mask:0xf
    s_nop 1
    v_min_u32_dpp v77, v77, v77 row_ror:4 row_mask:0xf bank_mask:0xf
    s_nop 0
    v_readfirstlane_b32 s97, v77
    s_sub_u32 s31, s31, 1
    s_cbranch_scc1 cf_kvw_x
    s_cmp_le_u32 s40, s97
    s_cbranch_scc1 cf_kvw_x
    s_sleep 2
    s_branch cf_kvw
cf_kvw_x:
    s_branch cf_kvok
cf_last:
    s_add_u32 s40, s95, 64
    v_mov_b32 v78, s40
    s_waitcnt vmcnt(0)
    s_barrier
    s_mov_b64 exec, s[100:101]
    buffer_store_dword v78, off, s[4:7], s29 sc1
    s_mov_b64 exec, -1
cf_end:
    s_endpgm
L_chain_safe:
    s_mov_b64 s[48:49], s[50:51]
    s_mov_b64 s[50:51], s[52:53]
    s_mov_b64 s[52:53], s[54:55]
    s_mov_b64 s[54:55], s[56:57]
    s_mov_b64 s[56:57], s[58:59]
    v_lshrrev_b32 v77, 6, v0
    s_nop 0
    v_readfirstlane_b32 s13, v77
    v_lshlrev_b32 v65, 4, v0
    v_and_b32 v48, 63, v0
    s_mov_b32 s10, 4718592
    s_mov_b32 s11, 0x20000
    v_lshrrev_b32 v49, 3, v48
    v_mul_u32_u24 v18, 1152, v49
    v_and_b32 v49, 7, v48
    v_lshl_add_u32 v18, v49, 4, v18
    s_mul_i32 s40, s12, 147456
    s_lshl_b32 s41, s13, 8
    s_add_u32 s40, s40, s41
    s_mov_b32 s42, s40
    s_xor_b32 s41, s13, 0
    s_mul_i32 s41, s41, 36864
    s_add_u32 s60, s41, s40
    s_xor_b32 s41, s13, 1
    s_mul_i32 s41, s41, 36864
    s_add_u32 s61, s41, s40
    s_xor_b32 s41, s13, 2
    s_mul_i32 s41, s41, 36864
    s_add_u32 s62, s41, s40
    s_xor_b32 s41, s13, 3
    s_mul_i32 s41, s41, 36864
    s_add_u32 s63, s41, s40
    s_lshl_b32 s43, s13, 12
    s_mov_b64 s[8:9], s[56:57]
    s_add_u32 m0, s43, 147456
    s_add_u32 s41, s60, 0
    buffer_load_dwordx4 v18, s[8:11], s41 offen offset:0 nt lds
    s_add_u32 s41, s60, 8192
    buffer_load_dwordx4 v18, s[8:11], s41 offen offset:1024 nt lds
    s_add_u32 s41, s60, 16384
    buffer_load_dwordx4 v18, s[8:11], s41 offen offset:2048 nt lds
    s_add_u32 s41, s60, 24576
    buffer_load_dwordx4 v18, s[8:11], s41 offen offset:3072 nt lds
    s_add_u32 m0, s43, 0
    s_add_u32 s41, s61, 0
    buffer_load_dwordx4 v18, s[8:11], s41 offen offset:0 nt lds
    s_add_u32 s41, s61, 8192
    buffer_load_dwordx4 v18, s[8:11], s41 offen offset:1024 nt lds
    s_add_u32 s41, s61, 16384
    buffer_load_dwordx4 v18, s[8:11], s41 offen offset:2048 nt lds
    s_add_u32 s41, s61, 24576
    buffer_load_dwordx4 v18, s[8:11], s41 offen offset:3072 nt lds
    s_add_u32 m0, s43, 36864
    s_add_u32 s41, s62, 0
    buffer_load_dwordx4 v18, s[8:11], s41 offen offset:0 nt lds
    s_add_u32 s41, s62, 8192
    buffer_load_dwordx4 v18, s[8:11], s41 offen offset:1024 nt lds
    s_add_u32 s41, s62, 16384
    buffer_load_dwordx4 v18, s[8:11], s41 offen offset:2048 nt lds
    s_add_u32 s41, s62, 24576
    buffer_load_dwordx4 v18, s[8:11], s41 offen offset:3072 nt lds
    s_add_u32 m0, s43, 73728
    s_add_u32 s41, s63, 0
    buffer_load_dwordx4 v18, s[8:11], s41 offen offset:0 nt lds
    s_add_u32 s41, s63, 8192
    buffer_load_dwordx4 v18, s[8:11], s41 offen offset:1024 nt lds
    s_add_u32 s41, s63, 16384
    buffer_load_dwordx4 v18, s[8:11], s41 offen offset:2048 nt lds
    s_add_u32 s41, s63, 24576
    buffer_load_dwordx4 v18, s[8:11], s41 offen offset:3072 nt lds
    v_lshrrev_b32 v49, 1, v48
    v_mul_u32_u24 v19, 1152, v49
    v_and_b32 v49, 1, v48
    v_lshl_add_u32 v19, v49, 4, v19
    s_mul_i32 s41, s13, 224
    s_sub_u32 s41, 1024, s41
    v_add_u32 v19, s41, v19
    v_lshrrev_b32 v49, 4, v48
    v_lshlrev_b32 v50, 2, v49
    v_and_b32 v51, 15, v48
    v_xor_b32 v51, v51, v50
    v_lshlrev_b32 v51, 4, v51
    v_lshl_add_u32 v16, v49, 15, v51
    v_lshrrev_b32 v50, 1, v49
    v_lshl_add_u32 v17, v50, 16, v51
    v_and_b32 v50, 1, v49
    v_lshl_add_u32 v17, v50, 13, v17
    s_lshl_b32 s40, s12, 8
    s_mul_i32 s58, s13, 1048576
    s_add_u32 s58, s58, s40
    s_lshr_b32 s41, s13, 1
    s_mul_i32 s59, s41, 262144
    s_and_b32 s41, s13, 1
    s_lshl_b32 s41, s41, 14
    s_add_u32 s59, s59, s41
    s_add_u32 s59, s59, s40
    s_add_u32 s59, s59, 4194304
    v_bfe_u32 v50, v48, 2, 2
    v_xor_b32 v51, s13, v50
    v_lshlrev_b32 v20, 6, v51
    v_and_b32 v51, 3, v48
    v_lshl_add_u32 v20, v51, 4, v20
    v_lshrrev_b32 v23, 2, v48
    v_lshl_add_u32 v20, v23, 8, v20
    s_xor_b32 s41, s43, 0
    v_add_u32 v24, s41, v20
    s_xor_b32 s41, s43, 4096
    v_add_u32 v25, s41, v20
    s_xor_b32 s41, s43, 8192
    v_add_u32 v26, s41, v20
    s_xor_b32 s41, s43, 12288
    v_add_u32 v27, s41, v20
    v_and_b32 v23, 1, v50
    v_lshl_add_u32 v23, v49, 2, v23
    v_lshrrev_b32 v50, 1, v50
    v_lshlrev_b32 v21, 7, v23
    v_lshl_add_u32 v21, v50, 6, v21
    v_lshrrev_b32 v16, 1, v51
    v_lshl_add_u32 v21, v16, 5, v21
    v_and_b32 v16, 1, v51
    v_lshl_add_u32 v21, v16, 3, v21
    v_add_u32 v21, s43, v21
    v_lshlrev_b32 v22, 9, v50
    v_xor_b32 v22, v22, v21
    v_lshlrev_b32 v23, 5, v23
    v_lshl_add_u32 v23, v50, 10, v23
    v_lshl_add_u32 v23, v51, 3, v23
    v_add_u32 v23, s43, v23
    v_bfe_u32 v60, v65, 4, 6
    v_and_b32 v61, 15, v60
    v_lshrrev_b32 v62, 4, v60
    v_mov_b32 v64, 0x4444
    v_mov_b32 v77, 0xeeee
    v_cmp_lt_u32 vcc, 7, v61
    s_nop 1
    v_cndmask_b32 v64, v64, v77, vcc
    v_xor_b32 v66, 1024, v65
    v_xor_b32 v67, 2048, v65
    v_xor_b32 v68, 3072, v65
    v_and_b32 v69, 511, v65
    s_mul_i32 s96, s13, 36864
    s_add_u32 s96, s96, 16384
    v_lshlrev_b32 v70, 4, v60
    v_add_u32 v70, s96, v70
    v_lshrrev_b32 v79, 1, v69
    s_lshl_b32 s96, s13, 8
    s_add_u32 s96, s96, 14336
    s_lshl_b32 s33, s13, 10
    s_add_u32 s97, s33, 8192
    v_mov_b32 v77, s97
    v_mov_b32 v78, s96
    v_cmp_lt_u32 vcc, 31, v60
    s_nop 1
    v_cndmask_b32 v71, v77, v78, vcc
    v_add_u32 v71, v71, v79
    v_and_b32 v77, 7, v61
    v_lshrrev_b32 v78, 3, v61
    v_lshlrev_b32 v74, 4, v77
    v_lshl_add_u32 v73, v62, 7, v74
    v_lshl_add_u32 v73, v78, 3, v73
    s_lshl_b32 s96, s13, 9
    v_add_u32 v73, s96, v73
    v_lshrrev_b32 v74, 1, v74
    v_lshl_add_u32 v74, v78, 14, v74
    v_lshl_add_u32 v74, v62, 15, v74
    s_lshl_b32 s96, s13, 17
    v_add_u32 v74, s96, v74
    v_bfe_u32 v77, v61, 2, 1
    v_and_b32 v78, 3, v61
    s_cmp_lt_u32 s13, 2
    s_cselect_b64 vcc, -1, 0
    v_cndmask_b32 v77, 0, v77, vcc
    v_lshlrev_b32 v75, 7, v77
    v_lshl_add_u32 v75, v62, 4, v75
    v_lshl_add_u32 v75, v78, 2, v75
    v_lshlrev_b32 v58, 3, v77
    v_lshl_add_u32 v58, v78, 1, v58
    s_bfe_u32 s97, s12, 0x10001
    s_lshl_b32 s68, s97, 6
    s_lshl_b32 s97, s97, 2
    v_add_u32 v59, s97, v62
    s_bfe_u32 s96, s12, 0x10002
    s_and_b32 s40, s12, 1
    s_lshl_b32 s96, s96, 1
    s_add_u32 s96, s96, s40
    s_lshr_b32 s97, s12, 3
    s_lshl_b32 s98, s13, 2
    s_add_u32 s98, s98, s97
    s_lshl_b32 s98, s98, 2
    s_add_u32 s98, s98, s96
    s_lshl_b32 s98, s98, 8
    s_lshl_b32 s99, s13, 2
    s_add_u32 s99, s99, s96
    s_lshl_b32 s99, s99, 4
    s_lshl_b32 s41, s97, 1
    s_add_u32 s41, s41, s40
    s_lshl_b32 s41, s41, 7
    s_add_u32 s41, s41, 8192
    s_lshl_b32 s40, s40, 3
    s_add_u32 s40, s40, 512
    s_cmp_lt_u32 s13, 2
    s_cselect_b32 s96, 7, 4
    s_cselect_b32 s98, s98, s41
    s_cselect_b32 s99, s99, s40
    s_cselect_b32 s32, 1, 0
    s_add_u32 s68, s68, s98
    s_lshl_b32 s97, s97, s96
    s_add_u32 s99, s99, s97
    v_add_u32 v58, s99, v58
    s_and_b32 s97, s12, 4
    s_or_b32 s97, s97, s13
    s_cmp_eq_u32 s97, 2
    s_cselect_b32 s32, 2, s32
    s_mov_b32 s8, s48
    s_mov_b32 s9, s49
    s_mov_b32 s10, 9216
    v_mul_u32_u24 v77, 1152, v59
    v_lshl_add_u32 v77, v58, 1, v77
    buffer_load_dword v72, v77, s[8:11], 0 offen
    s_mov_b32 s10, 4718592
    s_lshr_b32 s71, s52, 8
    s_add_u32 s71, s71, s12
    s_and_b32 s71, s71, 3
    s_waitcnt vmcnt(12) lgkmcnt(0)
    s_barrier
    s_cmp_eq_u32 s71, 1
    s_cbranch_scc1 cs_th0
    s_waitcnt vmcnt(6)
cs_th0:
    s_mov_b64 s[8:9], s[56:57]
    s_add_u32 m0, s43, 110592
    s_add_u32 s41, s42, 0
    buffer_load_dwordx4 v19, s[8:11], s41 offen offset:0 nt lds
    s_add_u32 s41, s42, 35840
    buffer_load_dwordx4 v19, s[8:11], s41 offen offset:1024 nt lds
    s_add_u32 s41, s42, 71680
    buffer_load_dwordx4 v19, s[8:11], s41 offen offset:2048 nt lds
    s_add_u32 s41, s42, 107520
    buffer_load_dwordx4 v19, s[8:11], s41 offen offset:3072 nt lds
    v_mov_b32 v78, v21
    v_mov_b32 v79, v22
    v_add_u32 v77, 147456, v79
    ds_read_b64_tr_b16 v[80:81], v77 offset:0
    ds_read_b64_tr_b16 v[82:83], v77 offset:256
    ds_read_b64_tr_b16 v[84:85], v77 offset:2048
    ds_read_b64_tr_b16 v[86:87], v77 offset:2304
    ds_read_b64_tr_b16 v[112:113], v77 offset:16
    ds_read_b64_tr_b16 v[114:115], v77 offset:272
    ds_read_b64_tr_b16 v[116:117], v77 offset:2064
    ds_read_b64_tr_b16 v[118:119], v77 offset:2320
    s_waitcnt vmcnt(12) lgkmcnt(0)
    s_barrier
    s_cmp_eq_u32 s71, 1
    s_cbranch_scc1 cs_th1
    s_waitcnt vmcnt(6)
cs_th1:
    s_mov_b64 s[8:9], s[52:53]
    s_add_u32 m0, s43, 147456
    s_add_u32 s41, s58, 0
    buffer_load_dwordx4 v17, s[8:11], s41 offen offset:0 nt lds
    s_add_u32 s41, s58, 31744
    buffer_load_dwordx4 v17, s[8:11], s41 offen offset:1024 nt lds
    s_add_u32 s41, s58, 129024
    buffer_load_dwordx4 v17, s[8:11], s41 offen offset:2048 nt lds
    s_add_u32 s41, s58, 160768
    buffer_load_dwordx4 v17, s[8:11], s41 offen offset:3072 nt lds
    v_add_u32 v77, 0, v78
    ds_read_b64_tr_b16 v[88:89], v77 offset:0
    ds_read_b64_tr_b16 v[90:91], v77 offset:256
    ds_read_b64_tr_b16 v[92:93], v77 offset:2048
    ds_read_b64_tr_b16 v[94:95], v77 offset:2304
    ds_read_b64_tr_b16 v[120:121], v77 offset:16
    ds_read_b64_tr_b16 v[122:123], v77 offset:272
    ds_read_b64_tr_b16 v[124:125], v77 offset:2064
    ds_read_b64_tr_b16 v[126:127], v77 offset:2320
    s_waitcnt vmcnt(12) lgkmcnt(0)
    s_barrier
    s_cmp_eq_u32 s71, 1
    s_cbranch_scc1 cs_th2
    s_waitcnt vmcnt(6)
cs_th2:
    s_add_u32 m0, s43, 0
    s_add_u32 s41, s58, 16384
    buffer_load_dwordx4 v17, s[8:11], s41 offen offset:0 nt lds
    s_add_u32 s41, s58, 48128
    buffer_load_dwordx4 v17, s[8:11], s41 offen offset:1024 nt lds
    s_add_u32 s41, s58, 145408
    buffer_load_dwordx4 v17, s[8:11], s41 offen offset:2048 nt lds
    s_add_u32 s41, s58, 177152
    buffer_load_dwordx4 v17, s[8:11], s41 offen offset:3072 nt lds
    v_add_u32 v77, 36864, v78
    ds_read_b64_tr_b16 v[96:97], v77 offset:0
    ds_read_b64_tr_b16 v[98:99], v77 offset:256
    ds_read_b64_tr_b16 v[100:101], v77 offset:2048
    ds_read_b64_tr_b16 v[102:103], v77 offset:2304
    ds_read_b64_tr_b16 v[128:129], v77 offset:16
    ds_read_b64_tr_b16 v[130:131], v77 offset:272
    ds_read_b64_tr_b16 v[132:133], v77 offset:2064
    ds_read_b64_tr_b16 v[134:135], v77 offset:2320
    s_waitcnt vmcnt(12) lgkmcnt(0)
    s_barrier
    s_cmp_eq_u32 s71, 1
    s_cbranch_scc1 cs_th3
    s_waitcnt vmcnt(6)
cs_th3:
    s_add_u32 m0, s43, 36864
    s_add_u32 s41, s58, 262144
    buffer_load_dwordx4 v17, s[8:11], s41 offen offset:0 nt lds
    s_add_u32 s41, s58, 293888
    buffer_load_dwordx4 v17, s[8:11], s41 offen offset:1024 nt lds
    s_add_u32 s41, s58, 391168
    buffer_load_dwordx4 v17, s[8:11], s41 offen offset:2048 nt lds
    s_add_u32 s41, s58, 422912
    buffer_load_dwordx4 v17, s[8:11], s41 offen offset:3072 nt lds
    v_add_u32 v77, 73728, v78
    ds_read_b64_tr_b16 v[104:105], v77 offset:0
    ds_read_b64_tr_b16 v[106:107], v77 offset:256
    ds_read_b64_tr_b16 v[108:109], v77 offset:2048
    ds_read_b64_tr_b16 v[110:111], v77 offset:2304
    ds_read_b64_tr_b16 v[136:137], v77 offset:16
    ds_read_b64_tr_b16 v[138:139], v77 offset:272
    ds_read_b64_tr_b16 v[140:141], v77 offset:2064
    ds_read_b64_tr_b16 v[142:143], v77 offset:2320
    s_waitcnt vmcnt(12) lgkmcnt(0)
    s_barrier
    s_cmp_eq_u32 s71, 1
    s_cbranch_scc1 cs_th4
    s_waitcnt vmcnt(6)
cs_th4:
    s_add_u32 m0, s43, 73728
    s_add_u32 s41, s58, 278528
    buffer_load_dwordx4 v17, s[8:11], s41 offen offset:0 nt lds
    s_add_u32 s41, s58, 310272
    buffer_load_dwordx4 v17, s[8:11], s41 offen offset:1024 nt lds
    s_add_u32 s41, s58, 407552
    buffer_load_dwordx4 v17, s[8:11], s41 offen offset:2048 nt lds
    s_add_u32 s41, s58, 439296
    buffer_load_dwordx4 v17, s[8:11], s41 offen offset:3072 nt lds
    v_add_u32 v77, 110592, v23
    ds_read_b64_tr_b16 v[0:1], v77 offset:0
    ds_read_b64_tr_b16 v[2:3], v77 offset:64
    ds_read_b64_tr_b16 v[4:5], v77 offset:512
    ds_read_b64_tr_b16 v[6:7], v77 offset:576
    ds_read_b64_tr_b16 v[8:9], v77 offset:2048
    ds_read_b64_tr_b16 v[10:11], v77 offset:2112
    ds_read_b64_tr_b16 v[12:13], v77 offset:2560
    ds_read_b64_tr_b16 v[14:15], v77 offset:2624
    s_waitcnt vmcnt(12) lgkmcnt(0)
    s_barrier
    s_cmp_eq_u32 s71, 1
    s_cbranch_scc1 cs_th5
    s_waitcnt vmcnt(6)
cs_th5:
    s_add_u32 m0, s43, 110592
    s_add_u32 s41, s58, 524288
    buffer_load_dwordx4 v17, s[8:11], s41 offen offset:0 nt lds
    s_add_u32 s41, s58, 556032
    buffer_load_dwordx4 v17, s[8:11], s41 offen offset:1024 nt lds
    s_add_u32 s41, s58, 653312
    buffer_load_dwordx4 v17, s[8:11], s41 offen offset:2048 nt lds
    s_add_u32 s41, s58, 685056
    buffer_load_dwordx4 v17, s[8:11], s41 offen offset:3072 nt lds
    s_cmp_eq_u32 s32, 0
    s_cbranch_scc1 cs_init_done
    v_mov_b32 v52, 1
    v_mov_b32 v53, 1
    v_mov_b32 v54, 1
    v_mov_b32 v55, 1
    v_mov_b32 v56, 0
    s_lshl_b32 s96, s12, 14
    s_add_u32 s96, s96, 68681728
    s_add_u32 s97, s96, 0
    buffer_store_dwordx4 v[52:55], v65, s[4:7], s97 offen sc1
    s_add_u32 s97, s96, 4096
    buffer_store_dwordx4 v[52:55], v65, s[4:7], s97 offen sc1
    s_add_u32 s97, s96, 8192
    buffer_store_dwordx4 v[52:55], v65, s[4:7], s97 offen sc1
    s_add_u32 s97, s96, 12288
    buffer_store_dwordx4 v[52:55], v65, s[4:7], s97 offen sc1
    s_add_u32 s96, s68, 67633152
    s_add_u32 s97, s96, 16384
    buffer_store_dword v56, v75, s[4:7], s96 offen offset:0 sc1
    buffer_store_dword v72, v75, s[4:7], s97 offen offset:0 sc1
    s_cmp_lg_u32 s32, 2
    s_cbranch_scc1 cs_init_done
    buffer_store_dword v56, v75, s[4:7], s96 offen offset:1024 sc1
    buffer_store_dword v72, v75, s[4:7], s97 offen offset:1024 sc1
    buffer_store_dword v56, v75, s[4:7], s96 offen offset:2048 sc1
    buffer_store_dword v72, v75, s[4:7], s97 offen offset:2048 sc1
    buffer_store_dword v56, v75, s[4:7], s96 offen offset:3072 sc1
    buffer_store_dword v72, v75, s[4:7], s97 offen offset:3072 sc1
cs_init_done:
    ds_write_b64 v70, v[0:1] offset:16384
    ds_write_b64 v70, v[2:3] offset:16392
    ds_write_b64 v70, v[4:5] offset:17408
    ds_write_b64 v70, v[6:7] offset:17416
    ds_write_b64 v70, v[8:9] offset:18432
    ds_write_b64 v70, v[10:11] offset:18440
    ds_write_b64 v70, v[12:13] offset:19456
    ds_write_b64 v70, v[14:15] offset:19464
    v_add_u32 v28, 147456, v24
    v_add_u32 v29, 147456, v25
    v_add_u32 v30, 147456, v26
    v_add_u32 v31, 147456, v27
    ds_read_b64_tr_b16 a[96:97], v28 offset:0
    ds_read_b64_tr_b16 a[104:105], v28 offset:8
    ds_read_b64_tr_b16 a[112:113], v29 offset:0
    ds_read_b64_tr_b16 a[120:121], v29 offset:8
    ds_read_b64_tr_b16 a[128:129], v30 offset:0
    ds_read_b64_tr_b16 a[136:137], v30 offset:8
    ds_read_b64_tr_b16 a[144:145], v31 offset:0
    ds_read_b64_tr_b16 v[32:33], v31 offset:8
    s_waitcnt vmcnt(12) lgkmcnt(0)
    s_barrier
    s_cmp_eq_u32 s71, 1
    s_cbranch_scc1 cs_th6
    s_waitcnt vmcnt(6)
cs_th6:
    s_add_u32 m0, s43, 147456
    s_add_u32 s41, s58, 540672
    buffer_load_dwordx4 v17, s[8:11], s41 offen offset:0 nt lds
    s_add_u32 s41, s58, 572416
    buffer_load_dwordx4 v17, s[8:11], s41 offen offset:1024 nt lds
    s_add_u32 s41, s58, 669696
    buffer_load_dwordx4 v17, s[8:11], s41 offen offset:2048 nt lds
    s_add_u32 s41, s58, 701440
    buffer_load_dwordx4 v17, s[8:11], s41 offen offset:3072 nt lds
    ds_write_b64 v70, v[32:33] offset:12288
    v_add_u32 v28, 0, v24
    v_add_u32 v29, 0, v25
    v_add_u32 v30, 0, v26
    v_add_u32 v31, 0, v27
    ds_read_b64_tr_b16 a[98:99], v28 offset:0
    ds_read_b64_tr_b16 a[106:107], v28 offset:8
    ds_read_b64_tr_b16 a[114:115], v29 offset:0
    ds_read_b64_tr_b16 a[122:123], v29 offset:8
    ds_read_b64_tr_b16 a[130:131], v30 offset:0
    ds_read_b64_tr_b16 a[138:139], v30 offset:8
    ds_read_b64_tr_b16 a[146:147], v31 offset:0
    ds_read_b64_tr_b16 v[0:1], v31 offset:8
    s_waitcnt vmcnt(12) lgkmcnt(0)
    s_barrier
    s_cmp_eq_u32 s71, 1
    s_cbranch_scc1 cs_th7
    s_waitcnt vmcnt(6)
cs_th7:
    s_add_u32 m0, s43, 0
    s_add_u32 s41, s58, 786432
    buffer_load_dwordx4 v17, s[8:11], s41 offen offset:0 nt lds
    s_add_u32 s41, s58, 818176
    buffer_load_dwordx4 v17, s[8:11], s41 offen offset:1024 nt lds
    s_add_u32 s41, s58, 915456
    buffer_load_dwordx4 v17, s[8:11], s41 offen offset:2048 nt lds
    s_add_u32 s41, s58, 947200
    buffer_load_dwordx4 v17, s[8:11], s41 offen offset:3072 nt lds
    ds_write_b64 v70, v[0:1] offset:12296
    v_add_u32 v28, 36864, v24
    v_add_u32 v29, 36864, v25
    v_add_u32 v30, 36864, v26
    v_add_u32 v31, 36864, v27
    ds_read_b64_tr_b16 a[100:101], v28 offset:0
    ds_read_b64_tr_b16 a[108:109], v28 offset:8
    ds_read_b64_tr_b16 a[116:117], v29 offset:0
    ds_read_b64_tr_b16 a[124:125], v29 offset:8
    ds_read_b64_tr_b16 a[132:133], v30 offset:0
    ds_read_b64_tr_b16 a[140:141], v30 offset:8
    ds_read_b64_tr_b16 a[148:149], v31 offset:0
    ds_read_b64_tr_b16 v[32:33], v31 offset:8
    s_waitcnt vmcnt(12) lgkmcnt(0)
    s_barrier
    s_cmp_eq_u32 s71, 1
    s_cbranch_scc1 cs_th8
    s_waitcnt vmcnt(6)
cs_th8:
    s_add_u32 m0, s43, 36864
    s_add_u32 s41, s58, 802816
    buffer_load_dwordx4 v17, s[8:11], s41 offen offset:0 nt lds
    s_add_u32 s41, s58, 834560
    buffer_load_dwordx4 v17, s[8:11], s41 offen offset:1024 nt lds
    s_add_u32 s41, s58, 931840
    buffer_load_dwordx4 v17, s[8:11], s41 offen offset:2048 nt lds
    s_add_u32 s41, s58, 963584
    buffer_load_dwordx4 v17, s[8:11], s41 offen offset:3072 nt lds
    ds_write_b64 v70, v[32:33] offset:13312
    v_add_u32 v28, 73728, v24
    v_add_u32 v29, 73728, v25
    v_add_u32 v30, 73728, v26
    v_add_u32 v31, 73728, v27
    ds_read_b64_tr_b16 a[102:103], v28 offset:0
    ds_read_b64_tr_b16 a[110:111], v28 offset:8
    ds_read_b64_tr_b16 a[118:119], v29 offset:0
    ds_read_b64_tr_b16 a[126:127], v29 offset:8
    ds_read_b64_tr_b16 a[134:135], v30 offset:0
    ds_read_b64_tr_b16 a[142:143], v30 offset:8
    ds_read_b64_tr_b16 a[150:151], v31 offset:0
    ds_read_b64_tr_b16 v[0:1], v31 offset:8
    s_waitcnt vmcnt(12) lgkmcnt(0)
    s_barrier
    s_cmp_eq_u32 s71, 1
    s_cbranch_scc1 cs_th9
    s_waitcnt vmcnt(6)
cs_th9:
    s_add_u32 m0, s43, 73728
    s_add_u32 s41, s59, 0
    buffer_load_dwordx4 v17, s[8:11], s41 offen offset:0 nt lds
    s_add_u32 s41, s59, 31744
    buffer_load_dwordx4 v17, s[8:11], s41 offen offset:1024 nt lds
    s_add_u32 s41, s59, 129024
    buffer_load_dwordx4 v17, s[8:11], s41 offen offset:2048 nt lds
    s_add_u32 s41, s59, 160768
    buffer_load_dwordx4 v17, s[8:11], s41 offen offset:3072 nt lds
    ds_write_b64 v70, v[0:1] offset:13320
    v_add_u32 v28, 110592, v24
    v_add_u32 v29, 110592, v25
    v_add_u32 v30, 110592, v26
    v_add_u32 v31, 110592, v27
    ds_read_b64_tr_b16 a[152:153], v28 offset:0
    ds_read_b64_tr_b16 a[160:161], v28 offset:8
    ds_read_b64_tr_b16 a[168:169], v29 offset:0
    ds_read_b64_tr_b16 a[176:177], v29 offset:8
    ds_read_b64_tr_b16 a[184:185], v30 offset:0
    ds_read_b64_tr_b16 a[192:193], v30 offset:8
    ds_read_b64_tr_b16 a[200:201], v31 offset:0
    ds_read_b64_tr_b16 a[208:209], v31 offset:8
    s_waitcnt vmcnt(12) lgkmcnt(0)
    s_barrier
    s_cmp_eq_u32 s71, 1
    s_cbranch_scc1 cs_th10
    s_waitcnt vmcnt(6)
cs_th10:
    s_mov_b64 s[8:9], s[50:51]
    s_add_u32 m0, s43, 110592
    s_add_u32 s41, s58, 0
    buffer_load_dwordx4 v17, s[8:11], s41 offen offset:0 nt lds
    s_add_u32 s41, s58, 31744
    buffer_load_dwordx4 v17, s[8:11], s41 offen offset:1024 nt lds
    s_add_u32 s41, s58, 129024
    buffer_load_dwordx4 v17, s[8:11], s41 offen offset:2048 nt lds
    s_add_u32 s41, s58, 160768
    buffer_load_dwordx4 v17, s[8:11], s41 offen offset:3072 nt lds
    v_add_u32 v28, 147456, v24
    v_add_u32 v29, 147456, v25
    v_add_u32 v30, 147456, v26
    v_add_u32 v31, 147456, v27
    ds_read_b64_tr_b16 a[154:155], v28 offset:0
    ds_read_b64_tr_b16 a[162:163], v28 offset:8
    ds_read_b64_tr_b16 a[170:171], v29 offset:0
    ds_read_b64_tr_b16 a[178:179], v29 offset:8
    ds_read_b64_tr_b16 a[186:187], v30 offset:0
    ds_read_b64_tr_b16 a[194:195], v30 offset:8
    ds_read_b64_tr_b16 a[202:203], v31 offset:0
    ds_read_b64_tr_b16 a[210:211], v31 offset:8
    s_waitcnt vmcnt(12) lgkmcnt(0)
    s_barrier
    s_cmp_eq_u32 s71, 1
    s_cbranch_scc1 cs_th11
    s_waitcnt vmcnt(6)
cs_th11:
    s_add_u32 m0, s43, 147456
    s_add_u32 s41, s58, 16384
    buffer_load_dwordx4 v17, s[8:11], s41 offen offset:0 nt lds
    s_add_u32 s41, s58, 48128
    buffer_load_dwordx4 v17, s[8:11], s41 offen offset:1024 nt lds
    s_add_u32 s41, s58, 145408
    buffer_load_dwordx4 v17, s[8:11], s41 offen offset:2048 nt lds
    s_add_u32 s41, s58, 177152
    buffer_load_dwordx4 v17, s[8:11], s41 offen offset:3072 nt lds
    v_add_u32 v28, 0, v24
    v_add_u32 v29, 0, v25
    v_add_u32 v30, 0, v26
    v_add_u32 v31, 0, v27
    ds_read_b64_tr_b16 a[156:157], v28 offset:0
    ds_read_b64_tr_b16 a[164:165], v28 offset:8
    ds_read_b64_tr_b16 a[172:173], v29 offset:0
    ds_read_b64_tr_b16 a[180:181], v29 offset:8
    ds_read_b64_tr_b16 a[188:189], v30 offset:0
    ds_read_b64_tr_b16 a[196:197], v30 offset:8
    ds_read_b64_tr_b16 a[204:205], v31 offset:0
    ds_read_b64_tr_b16 a[212:213], v31 offset:8
    s_waitcnt vmcnt(12) lgkmcnt(0)
    s_barrier
    s_cmp_eq_u32 s71, 1
    s_cbranch_scc1 cs_th12
    s_waitcnt vmcnt(6)
cs_th12:
    s_add_u32 m0, s43, 0
    s_add_u32 s41, s58, 262144
    buffer_load_dwordx4 v17, s[8:11], s41 offen offset:0 nt lds
    s_add_u32 s41, s58, 293888
    buffer_load_dwordx4 v17, s[8:11], s41 offen offset:1024 nt lds
    s_add_u32 s41, s58, 391168
    buffer_load_dwordx4 v17, s[8:11], s41 offen offset:2048 nt lds
    s_add_u32 s41, s58, 422912
    buffer_load_dwordx4 v17, s[8:11], s41 offen offset:3072 nt lds
    v_add_u32 v28, 36864, v24
    v_add_u32 v29, 36864, v25
    v_add_u32 v30, 36864, v26
    v_add_u32 v31, 36864, v27
    ds_read_b64_tr_b16 a[158:159], v28 offset:0
    ds_read_b64_tr_b16 a[166:167], v28 offset:8
    ds_read_b64_tr_b16 a[174:175], v29 offset:0
    ds_read_b64_tr_b16 a[182:183], v29 offset:8
    ds_read_b64_tr_b16 a[190:191], v30 offset:0
    ds_read_b64_tr_b16 a[198:199], v30 offset:8
    ds_read_b64_tr_b16 a[206:207], v31 offset:0
    ds_read_b64_tr_b16 a[214:215], v31 offset:8
    s_waitcnt vmcnt(12) lgkmcnt(0)
    s_barrier
    s_cmp_eq_u32 s71, 1
    s_cbranch_scc1 cs_th13
    s_waitcnt vmcnt(6)
cs_th13:
    s_add_u32 m0, s43, 36864
    s_add_u32 s41, s58, 278528
    buffer_load_dwordx4 v17, s[8:11], s41 offen offset:0 nt lds
    s_add_u32 s41, s58, 310272
    buffer_load_dwordx4 v17, s[8:11], s41 offen offset:1024 nt lds
    s_add_u32 s41, s58, 407552
    buffer_load_dwordx4 v17, s[8:11], s41 offen offset:2048 nt lds
    s_add_u32 s41, s58, 439296
    buffer_load_dwordx4 v17, s[8:11], s41 offen offset:3072 nt lds
    v_add_u32 v77, 73728, v20
    ds_read_b64_tr_b16 a[216:217], v77 offset:0
    ds_read_b64_tr_b16 a[218:219], v77 offset:4096
    ds_read_b64_tr_b16 a[220:221], v77 offset:8192
    ds_read_b64_tr_b16 a[222:223], v77 offset:12288
    ds_read_b64_tr_b16 a[224:225], v77 offset:8
    ds_read_b64_tr_b16 a[226:227], v77 offset:4104
    ds_read_b64_tr_b16 a[228:229], v77 offset:8200
    ds_read_b64_tr_b16 a[230:231], v77 offset:12296
    s_waitcnt vmcnt(12) lgkmcnt(0)
    s_barrier
    s_cmp_eq_u32 s71, 1
    s_cbranch_scc1 cs_th14
    s_waitcnt vmcnt(6)
cs_th14:
    s_add_u32 m0, s43, 73728
    s_add_u32 s41, s58, 524288
    buffer_load_dwordx4 v17, s[8:11], s41 offen offset:0 nt lds
    s_add_u32 s41, s58, 556032
    buffer_load_dwordx4 v17, s[8:11], s41 offen offset:1024 nt lds
    s_add_u32 s41, s58, 653312
    buffer_load_dwordx4 v17, s[8:11], s41 offen offset:2048 nt lds
    s_add_u32 s41, s58, 685056
    buffer_load_dwordx4 v17, s[8:11], s41 offen offset:3072 nt lds
    v_add_u32 v28, 110592, v24
    v_add_u32 v29, 110592, v25
    v_add_u32 v30, 110592, v26
    v_add_u32 v31, 110592, v27
    ds_read_b64_tr_b16 v[0:1], v28 offset:0
    ds_read_b64_tr_b16 v[2:3], v28 offset:8
    ds_read_b64_tr_b16 v[4:5], v29 offset:0
    ds_read_b64_tr_b16 v[6:7], v29 offset:8
    ds_read_b64_tr_b16 a[0:1], v30 offset:0
    ds_read_b64_tr_b16 v[8:9], v30 offset:8
    ds_read_b64_tr_b16 a[8:9], v31 offset:0
    ds_read_b64_tr_b16 v[10:11], v31 offset:8
    s_waitcnt vmcnt(12) lgkmcnt(0)
    s_barrier
    s_cmp_eq_u32 s71, 1
    s_cbranch_scc1 cs_th15
    s_waitcnt vmcnt(6)
cs_th15:
    s_add_u32 m0, s43, 110592
    s_add_u32 s41, s58, 540672
    buffer_load_dwordx4 v17, s[8:11], s41 offen offset:0 nt lds
    s_add_u32 s41, s58, 572416
    buffer_load_dwordx4 v17, s[8:11], s41 offen offset:1024 nt lds
    s_add_u32 s41, s58, 669696
    buffer_load_dwordx4 v17, s[8:11], s41 offen offset:2048 nt lds
    s_add_u32 s41, s58, 701440
    buffer_load_dwordx4 v17, s[8:11], s41 offen offset:3072 nt lds
    ds_write_b64 v70, v[0:1] offset:0
    ds_write_b64 v70, v[2:3] offset:2048
    ds_write_b64 v70, v[4:5] offset:4096
    ds_write_b64 v70, v[6:7] offset:6144
    ds_write_b64 v70, v[8:9] offset:10240
    ds_write_b64 v70, v[10:11] offset:14336
    v_add_u32 v28, 147456, v24
    v_add_u32 v29, 147456, v25
    v_add_u32 v30, 147456, v26
    v_add_u32 v31, 147456, v27
    ds_read_b64_tr_b16 v[32:33], v28 offset:0
    ds_read_b64_tr_b16 v[34:35], v28 offset:8
    ds_read_b64_tr_b16 v[36:37], v29 offset:0
    ds_read_b64_tr_b16 v[38:39], v29 offset:8
    ds_read_b64_tr_b16 a[2:3], v30 offset:0
    ds_read_b64_tr_b16 v[40:41], v30 offset:8
    ds_read_b64_tr_b16 a[10:11], v31 offset:0
    ds_read_b64_tr_b16 v[42:43], v31 offset:8
    s_waitcnt vmcnt(12) lgkmcnt(0)
    s_barrier
    s_cmp_eq_u32 s71, 1
    s_cbranch_scc1 cs_th16
    s_waitcnt vmcnt(6)
cs_th16:
    s_add_u32 m0, s43, 147456
    s_add_u32 s41, s58, 786432
    buffer_load_dwordx4 v17, s[8:11], s41 offen offset:0 nt lds
    s_add_u32 s41, s58, 818176
    buffer_load_dwordx4 v17, s[8:11], s41 offen offset:1024 nt lds
    s_add_u32 s41, s58, 915456
    buffer_load_dwordx4 v17, s[8:11], s41 offen offset:2048 nt lds
    s_add_u32 s41, s58, 947200
    buffer_load_dwordx4 v17, s[8:11], s41 offen offset:3072 nt lds
    ds_write_b64 v70, v[32:33] offset:8
    ds_write_b64 v70, v[34:35] offset:2056
    ds_write_b64 v70, v[36:37] offset:4104
    ds_write_b64 v70, v[38:39] offset:6152
    ds_write_b64 v70, v[40:41] offset:10248
    ds_write_b64 v70, v[42:43] offset:14344
    v_add_u32 v28, 0, v24
    v_add_u32 v29, 0, v25
    v_add_u32 v30, 0, v26
    v_add_u32 v31, 0, v27
    ds_read_b64_tr_b16 v[0:1], v28 offset:0
    ds_read_b64_tr_b16 v[2:3], v28 offset:8
    ds_read_b64_tr_b16 v[4:5], v29 offset:0
    ds_read_b64_tr_b16 v[6:7], v29 offset:8
    ds_read_b64_tr_b16 a[4:5], v30 offset:0
    ds_read_b64_tr_b16 v[8:9], v30 offset:8
    ds_read_b64_tr_b16 a[12:13], v31 offset:0
    ds_read_b64_tr_b16 v[10:11], v31 offset:8
    s_waitcnt vmcnt(12) lgkmcnt(0)
    s_barrier
    s_cmp_eq_u32 s71, 1
    s_cbranch_scc1 cs_th17
    s_waitcnt vmcnt(6)
cs_th17:
    s_add_u32 m0, s43, 0
    s_add_u32 s41, s58, 802816
    buffer_load_dwordx4 v17, s[8:11], s41 offen offset:0 nt lds
    s_add_u32 s41, s58, 834560
    buffer_load_dwordx4 v17, s[8:11], s41 offen offset:1024 nt lds
    s_add_u32 s41, s58, 931840
    buffer_load_dwordx4 v17, s[8:11], s41 offen offset:2048 nt lds
    s_add_u32 s41, s58, 963584
    buffer_load_dwordx4 v17, s[8:11], s41 offen offset:3072 nt lds
    ds_write_b64 v70, v[0:1] offset:1024
    ds_write_b64 v70, v[2:3] offset:3072
    ds_write_b64 v70, v[4:5] offset:5120
    ds_write_b64 v70, v[6:7] offset:7168
    ds_write_b64 v70, v[8:9] offset:11264
    ds_write_b64 v70, v[10:11] offset:15360
    v_add_u32 v28, 36864, v24
    v_add_u32 v29, 36864, v25
    v_add_u32 v30, 36864, v26
    v_add_u32 v31, 36864, v27
    ds_read_b64_tr_b16 v[32:33], v28 offset:0
    ds_read_b64_tr_b16 v[34:35], v28 offset:8
    ds_read_b64_tr_b16 v[36:37], v29 offset:0
    ds_read_b64_tr_b16 v[38:39], v29 offset:8
    ds_read_b64_tr_b16 a[6:7], v30 offset:0
    ds_read_b64_tr_b16 v[40:41], v30 offset:8
    ds_read_b64_tr_b16 a[14:15], v31 offset:0
    ds_read_b64_tr_b16 v[42:43], v31 offset:8
    s_waitcnt vmcnt(12) lgkmcnt(0)
    s_barrier
    s_cmp_eq_u32 s71, 1
    s_cbranch_scc1 cs_th18
    s_waitcnt vmcnt(6)
cs_th18:
    s_add_u32 m0, s43, 36864
    s_add_u32 s41, s59, 0
    buffer_load_dwordx4 v17, s[8:11], s41 offen offset:0 nt lds
    s_add_u32 s41, s59, 31744
    buffer_load_dwordx4 v17, s[8:11], s41 offen offset:1024 nt lds
    s_add_u32 s41, s59, 129024
    buffer_load_dwordx4 v17, s[8:11], s41 offen offset:2048 nt lds
    s_add_u32 s41, s59, 160768
    buffer_load_dwordx4 v17, s[8:11], s41 offen offset:3072 nt lds
    ds_write_b64 v70, v[32:33] offset:1032
    ds_write_b64 v70, v[34:35] offset:3080
    ds_write_b64 v70, v[36:37] offset:5128
    ds_write_b64 v70, v[38:39] offset:7176
    ds_write_b64 v70, v[40:41] offset:11272
    ds_write_b64 v70, v[42:43] offset:15368
    v_add_u32 v28, 73728, v24
    v_add_u32 v29, 73728, v25
    v_add_u32 v30, 73728, v26
    v_add_u32 v31, 73728, v27
    ds_read_b64_tr_b16 a[16:17], v28 offset:0
    ds_read_b64_tr_b16 a[24:25], v28 offset:8
    ds_read_b64_tr_b16 a[32:33], v29 offset:0
    ds_read_b64_tr_b16 a[40:41], v29 offset:8
    ds_read_b64_tr_b16 a[48:49], v30 offset:0
    ds_read_b64_tr_b16 a[56:57], v30 offset:8
    ds_read_b64_tr_b16 a[64:65], v31 offset:0
    ds_read_b64_tr_b16 a[72:73], v31 offset:8
    s_waitcnt vmcnt(12) lgkmcnt(0)
    s_barrier
    s_cmp_eq_u32 s71, 1
    s_cbranch_scc1 cs_th19
    s_waitcnt vmcnt(6)
cs_th19:
    s_mov_b64 s[8:9], s[54:55]
    s_add_u32 m0, s43, 73728
    s_add_u32 s41, s58, 0
    buffer_load_dwordx4 v17, s[8:11], s41 offen offset:0 nt lds
    s_add_u32 s41, s58, 31744
    buffer_load_dwordx4 v17, s[8:11], s41 offen offset:1024 nt lds
    s_add_u32 s41, s58, 129024
    buffer_load_dwordx4 v17, s[8:11], s41 offen offset:2048 nt lds
    s_add_u32 s41, s58, 160768
    buffer_load_dwordx4 v17, s[8:11], s41 offen offset:3072 nt lds
    v_add_u32 v28, 110592, v24
    v_add_u32 v29, 110592, v25
    v_add_u32 v30, 110592, v26
    v_add_u32 v31, 110592, v27
    ds_read_b64_tr_b16 a[18:19], v28 offset:0
    ds_read_b64_tr_b16 a[26:27], v28 offset:8
    ds_read_b64_tr_b16 a[34:35], v29 offset:0
    ds_read_b64_tr_b16 a[42:43], v29 offset:8
    ds_read_b64_tr_b16 a[50:51], v30 offset:0
    ds_read_b64_tr_b16 a[58:59], v30 offset:8
    ds_read_b64_tr_b16 a[66:67], v31 offset:0
    ds_read_b64_tr_b16 a[74:75], v31 offset:8
    s_waitcnt vmcnt(12) lgkmcnt(0)
    s_barrier
    s_cmp_eq_u32 s71, 1
    s_cbranch_scc1 cs_th20
    s_waitcnt vmcnt(6)
cs_th20:
    s_add_u32 m0, s43, 110592
    s_add_u32 s41, s58, 16384
    buffer_load_dwordx4 v17, s[8:11], s41 offen offset:0 nt lds
    s_add_u32 s41, s58, 48128
    buffer_load_dwordx4 v17, s[8:11], s41 offen offset:1024 nt lds
    s_add_u32 s41, s58, 145408
    buffer_load_dwordx4 v17, s[8:11], s41 offen offset:2048 nt lds
    s_add_u32 s41, s58, 177152
    buffer_load_dwordx4 v17, s[8:11], s41 offen offset:3072 nt lds
    v_add_u32 v28, 147456, v24
    v_add_u32 v29, 147456, v25
    v_add_u32 v30, 147456, v26
    v_add_u32 v31, 147456, v27
    ds_read_b64_tr_b16 a[20:21], v28 offset:0
    ds_read_b64_tr_b16 a[28:29], v28 offset:8
    ds_read_b64_tr_b16 a[36:37], v29 offset:0
    ds_read_b64_tr_b16 a[44:45], v29 offset:8
    ds_read_b64_tr_b16 a[52:53], v30 offset:0
    ds_read_b64_tr_b16 a[60:61], v30 offset:8
    ds_read_b64_tr_b16 a[68:69], v31 offset:0
    ds_read_b64_tr_b16 a[76:77], v31 offset:8
    s_waitcnt vmcnt(12) lgkmcnt(0)
    s_barrier
    s_cmp_eq_u32 s71, 1
    s_cbranch_scc1 cs_th21
    s_waitcnt vmcnt(6)
cs_th21:
    s_add_u32 m0, s43, 147456
    s_add_u32 s41, s58, 262144
    buffer_load_dwordx4 v17, s[8:11], s41 offen offset:0 nt lds
    s_add_u32 s41, s58, 293888
    buffer_load_dwordx4 v17, s[8:11], s41 offen offset:1024 nt lds
    s_add_u32 s41, s58, 391168
    buffer_load_dwordx4 v17, s[8:11], s41 offen offset:2048 nt lds
    s_add_u32 s41, s58, 422912
    buffer_load_dwordx4 v17, s[8:11], s41 offen offset:3072 nt lds
    v_add_u32 v28, 0, v24
    v_add_u32 v29, 0, v25
    v_add_u32 v30, 0, v26
    v_add_u32 v31, 0, v27
    ds_read_b64_tr_b16 a[22:23], v28 offset:0
    ds_read_b64_tr_b16 a[30:31], v28 offset:8
    ds_read_b64_tr_b16 a[38:39], v29 offset:0
    ds_read_b64_tr_b16 a[46:47], v29 offset:8
    ds_read_b64_tr_b16 a[54:55], v30 offset:0
    ds_read_b64_tr_b16 a[62:63], v30 offset:8
    ds_read_b64_tr_b16 a[70:71], v31 offset:0
    ds_read_b64_tr_b16 a[78:79], v31 offset:8
    s_waitcnt vmcnt(12) lgkmcnt(0)
    s_barrier
    s_cmp_eq_u32 s71, 1
    s_cbranch_scc1 cs_th22
    s_waitcnt vmcnt(6)
cs_th22:
    s_add_u32 m0, s43, 0
    s_add_u32 s41, s58, 278528
    buffer_load_dwordx4 v17, s[8:11], s41 offen offset:0 nt lds
    s_add_u32 s41, s58, 310272
    buffer_load_dwordx4 v17, s[8:11], s41 offen offset:1024 nt lds
    s_add_u32 s41, s58, 407552
    buffer_load_dwordx4 v17, s[8:11], s41 offen offset:2048 nt lds
    s_add_u32 s41, s58, 439296
    buffer_load_dwordx4 v17, s[8:11], s41 offen offset:3072 nt lds
    v_add_u32 v77, 36864, v20
    ds_read_b64_tr_b16 a[80:81], v77 offset:0
    ds_read_b64_tr_b16 a[82:83], v77 offset:4096
    ds_read_b64_tr_b16 a[84:85], v77 offset:8192
    ds_read_b64_tr_b16 a[86:87], v77 offset:12288
    ds_read_b64_tr_b16 a[88:89], v77 offset:8
    ds_read_b64_tr_b16 a[90:91], v77 offset:4104
    ds_read_b64_tr_b16 a[92:93], v77 offset:8200
    ds_read_b64_tr_b16 a[94:95], v77 offset:12296
    s_waitcnt vmcnt(12) lgkmcnt(0)
    s_barrier
    s_cmp_eq_u32 s71, 1
    s_cbranch_scc1 cs_th23
    s_waitcnt vmcnt(6)
cs_th23:
    s_add_u32 m0, s43, 36864
    s_add_u32 s41, s58, 524288
    buffer_load_dwordx4 v17, s[8:11], s41 offen offset:0 nt lds
    s_add_u32 s41, s58, 556032
    buffer_load_dwordx4 v17, s[8:11], s41 offen offset:1024 nt lds
    s_add_u32 s41, s58, 653312
    buffer_load_dwordx4 v17, s[8:11], s41 offen offset:2048 nt lds
    s_add_u32 s41, s58, 685056
    buffer_load_dwordx4 v17, s[8:11], s41 offen offset:3072 nt lds
    v_add_u32 v28, 73728, v24
    v_add_u32 v29, 73728, v25
    v_add_u32 v30, 73728, v26
    v_add_u32 v31, 73728, v27
    ds_read_b64_tr_b16 a[232:233], v28 offset:0
    ds_read_b64_tr_b16 v[32:33], v28 offset:8
    ds_read_b64_tr_b16 a[240:241], v29 offset:0
    ds_read_b64_tr_b16 a[248:249], v29 offset:8
    ds_read_b64_tr_b16 v[144:145], v30 offset:0
    ds_read_b64_tr_b16 v[152:153], v30 offset:8
    ds_read_b64_tr_b16 v[160:161], v31 offset:0
    ds_read_b64_tr_b16 v[168:169], v31 offset:8
    s_waitcnt vmcnt(12) lgkmcnt(0)
    s_barrier
    s_cmp_eq_u32 s71, 1
    s_cbranch_scc1 cs_th24
    s_waitcnt vmcnt(6)
cs_th24:
    s_add_u32 m0, s43, 73728
    s_add_u32 s41, s58, 540672
    buffer_load_dwordx4 v17, s[8:11], s41 offen offset:0 nt lds
    s_add_u32 s41, s58, 572416
    buffer_load_dwordx4 v17, s[8:11], s41 offen offset:1024 nt lds
    s_add_u32 s41, s58, 669696
    buffer_load_dwordx4 v17, s[8:11], s41 offen offset:2048 nt lds
    s_add_u32 s41, s58, 701440
    buffer_load_dwordx4 v17, s[8:11], s41 offen offset:3072 nt lds
    ds_write_b64 v70, v[32:33] offset:8192
    v_add_u32 v28, 110592, v24
    v_add_u32 v29, 110592, v25
    v_add_u32 v30, 110592, v26
    v_add_u32 v31, 110592, v27
    ds_read_b64_tr_b16 a[234:235], v28 offset:0
    ds_read_b64_tr_b16 v[0:1], v28 offset:8
    ds_read_b64_tr_b16 a[242:243], v29 offset:0
    ds_read_b64_tr_b16 a[250:251], v29 offset:8
    ds_read_b64_tr_b16 v[146:147], v30 offset:0
    ds_read_b64_tr_b16 v[154:155], v30 offset:8
    ds_read_b64_tr_b16 v[162:163], v31 offset:0
    ds_read_b64_tr_b16 v[170:171], v31 offset:8
    s_waitcnt vmcnt(12) lgkmcnt(0)
    s_barrier
    s_cmp_eq_u32 s71, 1
    s_cbranch_scc1 cs_th25
    s_waitcnt vmcnt(6)
cs_th25:
    s_add_u32 m0, s43, 110592
    s_add_u32 s41, s58, 786432
    buffer_load_dwordx4 v17, s[8:11], s41 offen offset:0 nt lds
    s_add_u32 s41, s58, 818176
    buffer_load_dwordx4 v17, s[8:11], s41 offen offset:1024 nt lds
    s_add_u32 s41, s58, 915456
    buffer_load_dwordx4 v17, s[8:11], s41 offen offset:2048 nt lds
    s_add_u32 s41, s58, 947200
    buffer_load_dwordx4 v17, s[8:11], s41 offen offset:3072 nt lds
    ds_write_b64 v70, v[0:1] offset:8200
    v_add_u32 v28, 147456, v24
    v_add_u32 v29, 147456, v25
    v_add_u32 v30, 147456, v26
    v_add_u32 v31, 147456, v27
    ds_read_b64_tr_b16 a[236:237], v28 offset:0
    ds_read_b64_tr_b16 v[32:33], v28 offset:8
    ds_read_b64_tr_b16 a[244:245], v29 offset:0
    ds_read_b64_tr_b16 a[252:253], v29 offset:8
    ds_read_b64_tr_b16 v[148:149], v30 offset:0
    ds_read_b64_tr_b16 v[156:157], v30 offset:8
    ds_read_b64_tr_b16 v[164:165], v31 offset:0
    ds_read_b64_tr_b16 v[172:173], v31 offset:8
    s_waitcnt vmcnt(12) lgkmcnt(0)
    s_barrier
    s_cmp_eq_u32 s71, 1
    s_cbranch_scc1 cs_th26
    s_waitcnt vmcnt(6)
cs_th26:
    s_add_u32 m0, s43, 147456
    s_add_u32 s41, s58, 802816
    buffer_load_dwordx4 v17, s[8:11], s41 offen offset:0 nt lds
    s_add_u32 s41, s58, 834560
    buffer_load_dwordx4 v17, s[8:11], s41 offen offset:1024 nt lds
    s_add_u32 s41, s58, 931840
    buffer_load_dwordx4 v17, s[8:11], s41 offen offset:2048 nt lds
    s_add_u32 s41, s58, 963584
    buffer_load_dwordx4 v17, s[8:11], s41 offen offset:3072 nt lds
    ds_write_b64 v70, v[32:33] offset:9216
    v_add_u32 v28, 0, v24
    v_add_u32 v29, 0, v25
    v_add_u32 v30, 0, v26
    v_add_u32 v31, 0, v27
    ds_read_b64_tr_b16 a[238:239], v28 offset:0
    ds_read_b64_tr_b16 v[0:1], v28 offset:8
    ds_read_b64_tr_b16 a[246:247], v29 offset:0
    ds_read_b64_tr_b16 a[254:255], v29 offset:8
    ds_read_b64_tr_b16 v[150:151], v30 offset:0
    ds_read_b64_tr_b16 v[158:159], v30 offset:8
    ds_read_b64_tr_b16 v[166:167], v31 offset:0
    ds_read_b64_tr_b16 v[174:175], v31 offset:8
    s_waitcnt vmcnt(12) lgkmcnt(0)
    s_barrier
    s_cmp_eq_u32 s71, 1
    s_cbranch_scc1 cs_th27
    s_waitcnt vmcnt(6)
cs_th27:
    s_add_u32 m0, s43, 0
    s_add_u32 s41, s59, 0
    buffer_load_dwordx4 v17, s[8:11], s41 offen offset:0 nt lds
    s_add_u32 s41, s59, 31744
    buffer_load_dwordx4 v17, s[8:11], s41 offen offset:1024 nt lds
    s_add_u32 s41, s59, 129024
    buffer_load_dwordx4 v17, s[8:11], s41 offen offset:2048 nt lds
    s_add_u32 s41, s59, 160768
    buffer_load_dwordx4 v17, s[8:11], s41 offen offset:3072 nt lds
    ds_write_b64 v70, v[0:1] offset:9224
    v_add_u32 v28, 36864, v24
    v_add_u32 v29, 36864, v25
    v_add_u32 v30, 36864, v26
    v_add_u32 v31, 36864, v27
    ds_read_b64_tr_b16 v[176:177], v28 offset:0
    ds_read_b64_tr_b16 v[184:185], v28 offset:8
    ds_read_b64_tr_b16 v[192:193], v29 offset:0
    ds_read_b64_tr_b16 v[200:201], v29 offset:8
    ds_read_b64_tr_b16 v[208:209], v30 offset:0
    ds_read_b64_tr_b16 v[216:217], v30 offset:8
    ds_read_b64_tr_b16 v[224:225], v31 offset:0
    ds_read_b64_tr_b16 v[232:233], v31 offset:8
    s_waitcnt vmcnt(12) lgkmcnt(0)
    s_barrier
    s_cmp_eq_u32 s71, 1
    s_cbranch_scc1 cs_th28
    s_waitcnt vmcnt(6)
cs_th28:
    s_mov_b64 s[8:9], s[56:57]
    s_add_u32 m0, s43, 36864
    s_add_u32 s41, s60, 128
    buffer_load_dwordx4 v18, s[8:11], s41 offen offset:0 nt lds
    s_add_u32 s41, s60, 8320
    buffer_load_dwordx4 v18, s[8:11], s41 offen offset:1024 nt lds
    s_add_u32 s41, s60, 16512
    buffer_load_dwordx4 v18, s[8:11], s41 offen offset:2048 nt lds
    s_add_u32 s41, s60, 24704
    buffer_load_dwordx4 v18, s[8:11], s41 offen offset:3072 nt lds
    v_add_u32 v28, 73728, v24
    v_add_u32 v29, 73728, v25
    v_add_u32 v30, 73728, v26
    v_add_u32 v31, 73728, v27
    ds_read_b64_tr_b16 v[178:179], v28 offset:0
    ds_read_b64_tr_b16 v[186:187], v28 offset:8
    ds_read_b64_tr_b16 v[194:195], v29 offset:0
    ds_read_b64_tr_b16 v[202:203], v29 offset:8
    ds_read_b64_tr_b16 v[210:211], v30 offset:0
    ds_read_b64_tr_b16 v[218:219], v30 offset:8
    ds_read_b64_tr_b16 v[226:227], v31 offset:0
    ds_read_b64_tr_b16 v[234:235], v31 offset:8
    s_waitcnt vmcnt(12) lgkmcnt(0)
    s_barrier
    s_cmp_eq_u32 s71, 1
    s_cbranch_scc1 cs_th29
    s_waitcnt vmcnt(6)
cs_th29:
    s_add_u32 m0, s43, 73728
    s_add_u32 s41, s61, 128
    buffer_load_dwordx4 v18, s[8:11], s41 offen offset:0 nt lds
    s_add_u32 s41, s61, 8320
    buffer_load_dwordx4 v18, s[8:11], s41 offen offset:1024 nt lds
    s_add_u32 s41, s61, 16512
    buffer_load_dwordx4 v18, s[8:11], s41 offen offset:2048 nt lds
    s_add_u32 s41, s61, 24704
    buffer_load_dwordx4 v18, s[8:11], s41 offen offset:3072 nt lds
    v_add_u32 v28, 110592, v24
    v_add_u32 v29, 110592, v25
    v_add_u32 v30, 110592, v26
    v_add_u32 v31, 110592, v27
    ds_read_b64_tr_b16 v[180:181], v28 offset:0
    ds_read_b64_tr_b16 v[188:189], v28 offset:8
    ds_read_b64_tr_b16 v[196:197], v29 offset:0
    ds_read_b64_tr_b16 v[204:205], v29 offset:8
    ds_read_b64_tr_b16 v[212:213], v30 offset:0
    ds_read_b64_tr_b16 v[220:221], v30 offset:8
    ds_read_b64_tr_b16 v[228:229], v31 offset:0
    ds_read_b64_tr_b16 v[236:237], v31 offset:8
    s_waitcnt vmcnt(12) lgkmcnt(0)
    s_barrier
    s_cmp_eq_u32 s71, 1
    s_cbranch_scc1 cs_th30
    s_waitcnt vmcnt(6)
cs_th30:
    s_add_u32 m0, s43, 110592
    s_add_u32 s41, s62, 128
    buffer_load_dwordx4 v18, s[8:11], s41 offen offset:0 nt lds
    s_add_u32 s41, s62, 8320
    buffer_load_dwordx4 v18, s[8:11], s41 offen offset:1024 nt lds
    s_add_u32 s41, s62, 16512
    buffer_load_dwordx4 v18, s[8:11], s41 offen offset:2048 nt lds
    s_add_u32 s41, s62, 24704
    buffer_load_dwordx4 v18, s[8:11], s41 offen offset:3072 nt lds
    v_add_u32 v28, 147456, v24
    v_add_u32 v29, 147456, v25
    v_add_u32 v30, 147456, v26
    v_add_u32 v31, 147456, v27
    ds_read_b64_tr_b16 v[182:183], v28 offset:0
    ds_read_b64_tr_b16 v[190:191], v28 offset:8
    ds_read_b64_tr_b16 v[198:199], v29 offset:0
    ds_read_b64_tr_b16 v[206:207], v29 offset:8
    ds_read_b64_tr_b16 v[214:215], v30 offset:0
    ds_read_b64_tr_b16 v[222:223], v30 offset:8
    ds_read_b64_tr_b16 v[230:231], v31 offset:0
    ds_read_b64_tr_b16 v[238:239], v31 offset:8
    s_waitcnt vmcnt(12) lgkmcnt(0)
    s_barrier
    s_cmp_eq_u32 s71, 1
    s_cbranch_scc1 cs_th31
    s_waitcnt vmcnt(6)
cs_th31:
    s_add_u32 m0, s43, 147456
    s_add_u32 s41, s63, 128
    buffer_load_dwordx4 v18, s[8:11], s41 offen offset:0 nt lds
    s_add_u32 s41, s63, 8320
    buffer_load_dwordx4 v18, s[8:11], s41 offen offset:1024 nt lds
    s_add_u32 s41, s63, 16512
    buffer_load_dwordx4 v18, s[8:11], s41 offen offset:2048 nt lds
    s_add_u32 s41, s63, 24704
    buffer_load_dwordx4 v18, s[8:11], s41 offen offset:3072 nt lds
    v_mov_b32 v78, v21
    v_mov_b32 v79, v22
    v_add_u32 v77, 0, v20
    ds_read_b64_tr_b16 v[240:241], v77 offset:0
    ds_read_b64_tr_b16 v[242:243], v77 offset:4096
    ds_read_b64_tr_b16 v[244:245], v77 offset:8192
    ds_read_b64_tr_b16 v[246:247], v77 offset:12288
    ds_read_b64_tr_b16 v[248:249], v77 offset:8
    ds_read_b64_tr_b16 v[250:251], v77 offset:4104
    ds_read_b64_tr_b16 v[252:253], v77 offset:8200
    ds_read_b64_tr_b16 v[254:255], v77 offset:12296
    s_waitcnt vmcnt(12) lgkmcnt(0)
    s_barrier
    v_bfe_u32 v60, v65, 4, 6
    v_and_b32 v61, 15, v60
    v_lshrrev_b32 v62, 4, v60
    v_mov_b32 v50, 0x3f80
    v_mov_b32 v51, 0x3f800000
    v_and_b32 v57, 1, v62
    v_lshlrev_b32 v57, 2, v57
    v_sub_u32 v57, v61, v57
    v_and_b32 v58, 3, v61
    v_lshlrev_b32 v58, 2, v58
    v_lshrrev_b32 v59, 2, v61
    v_add_u32 v58, v58, v59
    v_cmp_eq_u32 vcc, 0, v57
    s_nop 1
    v_cndmask_b32 v40, 0, v50, vcc
    v_cmp_eq_u32 vcc, 1, v57
    s_nop 1
    v_cndmask_b32 v40, v40, v51, vcc
    v_cmp_eq_u32 vcc, 0, v58
    s_nop 1
    v_cndmask_b32 v44, 0, v50, vcc
    v_cmp_eq_u32 vcc, 1, v58
    s_nop 1
    v_cndmask_b32 v44, v44, v51, vcc
    v_cmp_eq_u32 vcc, 2, v57
    s_nop 1
    v_cndmask_b32 v41, 0, v50, vcc
    v_cmp_eq_u32 vcc, 3, v57
    s_nop 1
    v_cndmask_b32 v41, v41, v51, vcc
    v_cmp_eq_u32 vcc, 2, v58
    s_nop 1
    v_cndmask_b32 v45, 0, v50, vcc
    v_cmp_eq_u32 vcc, 3, v58
    s_nop 1
    v_cndmask_b32 v45, v45, v51, vcc
    v_cmp_eq_u32 vcc, 8, v57
    s_nop 1
    v_cndmask_b32 v42, 0, v50, vcc
    v_cmp_eq_u32 vcc, 9, v57
    s_nop 1
    v_cndmask_b32 v42, v42, v51, vcc
    v_cmp_eq_u32 vcc, 4, v58
    s_nop 1
    v_cndmask_b32 v46, 0, v50, vcc
    v_cmp_eq_u32 vcc, 5, v58
    s_nop 1
    v_cndmask_b32 v46, v46, v51, vcc
    v_cmp_eq_u32 vcc, 10, v57
    s_nop 1
    v_cndmask_b32 v43, 0, v50, vcc
    v_cmp_eq_u32 vcc, 11, v57
    s_nop 1
    v_cndmask_b32 v43, v43, v51, vcc
    v_cmp_eq_u32 vcc, 6, v58
    s_nop 1
    v_cndmask_b32 v47, 0, v50, vcc
    v_cmp_eq_u32 vcc, 7, v58
    s_nop 1
    v_cndmask_b32 v47, v47, v51, vcc
    v_lshlrev_b32 v57, 4, v61
    ds_write_b128 v69, v[40:43] offset:15360
    ds_write_b128 v57, v[44:47] offset:15872
    v_add_u32 v77, 36864, v79
    s_waitcnt lgkmcnt(0)
    ds_read_b64_tr_b16 v[0:1], v77 offset:0
    ds_read_b64_tr_b16 v[2:3], v77 offset:256
    ds_read_b64_tr_b16 v[4:5], v77 offset:2048
    ds_read_b64_tr_b16 v[6:7], v77 offset:2304
    ds_read_b64_tr_b16 v[8:9], v77 offset:16
    ds_read_b64_tr_b16 v[10:11], v77 offset:272
    ds_read_b64_tr_b16 v[12:13], v77 offset:2064
    ds_read_b64_tr_b16 v[14:15], v77 offset:2320
    s_waitcnt vmcnt(8) lgkmcnt(0)
    s_barrier
    v_add_u32 v77, 73728, v78
    ds_read_b64_tr_b16 v[16:17], v77 offset:0
    ds_read_b64_tr_b16 v[18:19], v77 offset:256
    ds_read_b64_tr_b16 v[20:21], v77 offset:2048
    ds_read_b64_tr_b16 v[22:23], v77 offset:2304
    ds_read_b64_tr_b16 v[24:25], v77 offset:16
    ds_read_b64_tr_b16 v[26:27], v77 offset:272
    ds_read_b64_tr_b16 v[28:29], v77 offset:2064
    ds_read_b64_tr_b16 v[30:31], v77 offset:2320
    s_waitcnt vmcnt(4) lgkmcnt(0)
    s_barrier
    v_add_u32 v77, 110592, v78
    ds_read_b64_tr_b16 v[32:33], v77 offset:0
    ds_read_b64_tr_b16 v[34:35], v77 offset:256
    ds_read_b64_tr_b16 v[36:37], v77 offset:2048
    ds_read_b64_tr_b16 v[38:39], v77 offset:2304
    ds_read_b64_tr_b16 v[40:41], v77 offset:16
    ds_read_b64_tr_b16 v[42:43], v77 offset:272
    ds_read_b64_tr_b16 v[44:45], v77 offset:2064
    ds_read_b64_tr_b16 v[46:47], v77 offset:2320
    s_waitcnt vmcnt(0) lgkmcnt(0)
    s_barrier
    v_add_u32 v77, 147456, v78
    ds_read_b64_tr_b16 v[48:49], v77 offset:0
    ds_read_b64_tr_b16 v[50:51], v77 offset:256
    ds_read_b64_tr_b16 v[52:53], v77 offset:2048
    ds_read_b64_tr_b16 v[54:55], v77 offset:2304
    ds_read_b64_tr_b16 v[56:57], v77 offset:16
    ds_read_b64_tr_b16 v[58:59], v77 offset:272
    ds_read_b64_tr_b16 v[60:61], v77 offset:2064
    ds_read_b64_tr_b16 v[62:63], v77 offset:2320
    s_waitcnt lgkmcnt(0)
    s_barrier
    ds_write_b128 v70, v[0:3] offset:20480
    ds_write_b128 v70, v[4:7] offset:21504
    ds_write_b128 v70, v[8:11] offset:22528
    ds_write_b128 v70, v[12:15] offset:23552
    ds_write_b128 v70, v[16:19] offset:24576
    ds_write_b128 v70, v[20:23] offset:25600
    ds_write_b128 v70, v[24:27] offset:26624
    ds_write_b128 v70, v[28:31] offset:27648
    ds_write_b128 v70, v[32:35] offset:28672
    ds_write_b128 v70, v[36:39] offset:29696
    ds_write_b128 v70, v[40:43] offset:30720
    ds_write_b128 v70, v[44:47] offset:31744
    ds_write_b128 v70, v[48:51] offset:32768
    ds_write_b128 v70, v[52:55] offset:33792
    ds_write_b128 v70, v[56:59] offset:34816
    ds_write_b128 v70, v[60:63] offset:35840
    s_waitcnt vmcnt(0) lgkmcnt(0)
    s_barrier
    v_mov_b32 v2, 1
    s_cmp_lg_u32 s13, 0
    s_cbranch_scc1 cs_noarr
    s_mov_b64 exec, 1
    buffer_atomic_add v2, off, s[84:87], 0 offset:212
    s_mov_b32 s40, 16777216
    s_mov_b32 s42, 2
cs_startpoll:
    buffer_load_dword v3, off, s[84:87], 0 offset:212 sc1
    s_sub_u32 s40, s40, 1
    s_cbranch_scc1 cs_decide
    s_waitcnt vmcnt(0)
    v_readfirstlane_b32 s41, v3
    s_nop 1
    s_cmp_lt_u32 s41, 32
    s_cbranch_scc1 cs_startpoll
    s_mov_b32 s42, 1
cs_decide:
    s_mov_b64 exec, -1
cs_noarr:
    s_barrier
    s_mov_b32 s44, 0x3e0293ee
    s_mov_b32 s45, s44
    s_or_b32 s66, s44, 0x80000000
    s_mov_b32 s48, 0x3f003f00
    s_mov_b32 s49, 0
    s_mov_b32 s50, 0x3f803f80
    s_mov_b32 s51, 0x3f803f80
    s_mov_b32 s52, 512
    s_mov_b32 s53, 1024
    s_mov_b32 s54, 1536
    s_mov_b32 s30, 0
    s_mov_b32 s37, 0
    s_mov_b32 s98, -100
    s_lshl_b32 s47, s13, 9
    s_cmp_lg_u32 s32, 0
    s_cselect_b32 s71, s13, 3
    s_add_u32 s46, s71, 1
    s_lshr_b32 s46, s46, 1
    s_mov_b32 s14, 67649536
    s_mov_b32 s15, 67653632
    s_mov_b32 s16, 67657728
    s_mov_b32 s36, 0
    s_add_u32 s17, s68, 67633152
    s_mov_b32 s69, 0
    s_mov_b32 s70, 0
    s_lshl_b32 s26, s12, 14
    s_add_u32 s26, s26, 0
    s_mul_i32 s40, s13, 3072
    s_add_u32 s24, s26, s40
    s_add_u32 s26, s24, s33
    s_add_u32 s99, s26, 33030144
    s_lshl_b32 s96, s12, 7
    s_add_u32 s29, s96, 125845504
    s_add_u32 s96, s96, 125829120
    s_lshl_b32 s40, s12, 14
    s_add_u32 s40, s40, 68681728
    s_add_u32 s18, s40, 0
    s_add_u32 s19, s40, 4096
    s_add_u32 s20, s40, 8192
    s_add_u32 s21, s40, 12288
    s_lshr_b32 s40, s12, 3
    s_lshl_b32 s40, s40, 12
    s_and_b32 s41, s12, 7
    s_lshl_b32 s41, s41, 7
    s_add_u32 s40, s40, s41
    s_add_u32 s22, s40, 68681728
    s_add_u32 s23, s22, 1024
    s_add_u32 s25, s22, 2048
    s_mov_b32 s56, -65472
    s_cmp_lg_u32 s32, 0
    s_cselect_b64 s[38:39], -1, 0
    s_add_u32 s55, s68, 138412032
    s_cmp_eq_u32 s13, 3
    s_cselect_b64 s[100:101], 1, 0
    s_cselect_b64 s[38:39], 1, s[38:39]
    s_cselect_b32 s93, 64, 0
    s_cselect_b32 s55, s29, s55
    s_cselect_b32 s57, 0, 9216
    s_mov_b32 s34, 0xff00ff00
    s_mov_b32 s35, 0xff00ff00
    s_lshl_b32 s28, s12, 12
    s_add_u32 s28, s28, 7340032
    s_add_u32 s27, s28, 77594624
    s_add_u32 s28, s28, 69206016
    s_mov_b64 exec, s[100:101]
    v_mov_b32 v72, s95
    s_mov_b64 exec, -1
    s_mov_b32 s40, 3
    v_bfe_u32 v78, v65, 2, 5
    s_mov_b32 s31, 4194304
cs_kv0:
    buffer_load_dword v77, v78, s[4:7], s96 offen offset:16 sc1
    s_waitcnt vmcnt(0)
    v_subrev_u32 v77, s95, v77
    v_cmp_lt_u32 vcc, 16, v77
    s_nop 1
    v_cndmask_b32 v77, v77, 0, vcc
    v_bfe_u32 v79, v78, 2, 2
    v_lshl_add_u32 v77, v77, 2, v79
    s_nop 1
    v_min_u32_dpp v77, v77, v77 row_ror:1 row_mask:0xf bank_mask:0xf
    s_nop 1
    v_min_u32_dpp v77, v77, v77 row_ror:2 row_mask:0xf bank_mask:0xf
    s_nop 1
    v_min_u32_dpp v77, v77, v77 row_ror:4 row_mask:0xf bank_mask:0xf
    s_nop 0
    v_readfirstlane_b32 s97, v77
    s_sub_u32 s31, s31, 1
    s_cbranch_scc1 cs_kv0_x
    s_cmp_le_u32 s40, s97
    s_cbranch_scc1 cs_kv0_x
    s_sleep 2
    s_branch cs_kv0
cs_kv0_x:
    s_add_u32 s40, s26, 0
    s_min_u32 s40, s40, s99
    s_sub_u32 s41, s96, s40
    v_bfe_u32 v77, v65, 2, 5
    v_add3_u32 v77, v77, s41, 16
    v_lshlrev_b32 v78, 3, v69
    s_nop 0
    v_mov_b32_dpp v78, v77 quad_perm:[0,1,2,3] row_mask:0xc bank_mask:0xf
    buffer_load_dword v76, v78, s[4:7], s40 offen sc1
    s_add_u32 s40, s26, 524288
    s_min_u32 s40, s40, s99
    s_sub_u32 s41, s96, s40
    v_bfe_u32 v77, v65, 2, 5
    v_add3_u32 v77, v77, s41, 16
    v_lshlrev_b32 v78, 3, v69
    s_nop 0
    v_mov_b32_dpp v78, v77 quad_perm:[0,1,2,3] row_mask:0xc bank_mask:0xf
    buffer_load_dword v76, v78, s[4:7], s40 offen sc1
cs_kvdone:
    v_mov_b64 v[0:1], 0
    v_mov_b64 v[2:3], 0
    v_mov_b64 v[4:5], 0
    v_mov_b64 v[6:7], 0
    v_mov_b64 v[8:9], 0
    v_mov_b64 v[10:11], 0
    v_mov_b64 v[12:13], 0
    v_mov_b64 v[14:15], 0
    v_mov_b64 v[16:17], 0
    v_mov_b64 v[18:19], 0
    v_mov_b64 v[20:21], 0
    v_mov_b64 v[22:23], 0
    ds_read_b128 v[44:47], v70 offset:0
    ds_read_b128 v[48:51], v70 offset:1024
    ds_read_b128 v[52:55], v70 offset:2048
    ds_read_b128 v[56:59], v70 offset:3072
    ds_read_b128 v[24:27], v70 offset:4096
    ds_read_b128 v[28:31], v70 offset:5120
    ds_read_b128 v[32:35], v70 offset:6144
    ds_read_b128 v[36:39], v70 offset:7168
    buffer_load_dwordx4 v[40:43], v65, s[4:7], s14 offen offset:0 sc1
    buffer_load_dwordx4 v[60:63], v66, s[4:7], s14 offen offset:0 sc1
    s_mov_b32 s31, 1048576
    s_waitcnt vmcnt(0) lgkmcnt(0)
    s_branch cs_goA
cs_loop:
    s_mov_b32 s31, 1048576
    s_mov_b32 s69, s70
    s_waitcnt lgkmcnt(0)
cs_cA:
    buffer_load_dwordx4 v[40:43], v65, s[4:7], s14 offen offset:0 sc1
    buffer_load_dwordx4 v[60:63], v66, s[4:7], s14 offen offset:0 sc1
cs_cA1:
    v_bitop3_b32 v77, v40, v60, s70 bitop3:0x7e
    v_and_b32 v77, 1, v77
    v_cmp_ne_u32 vcc, 0, v77
    s_cbranch_vccz cs_goA
    s_nop 15
    s_nop 15
    s_nop 7
    v_bitop3_b32 v77, v40, v60, s70 bitop3:0x7e
    v_and_b32 v77, 1, v77
    v_cmp_ne_u32 vcc, 0, v77
    s_cbranch_vccz cs_goA
    s_nop 15
    s_nop 15
    s_nop 7
    v_bitop3_b32 v77, v40, v60, s70 bitop3:0x7e
    v_and_b32 v77, 1, v77
    v_cmp_ne_u32 vcc, 0, v77
    s_cbranch_vccz cs_goA
    s_nop 15
    s_nop 15
    s_nop 7
    v_bitop3_b32 v77, v40, v60, s70 bitop3:0x7e
    v_and_b32 v77, 1, v77
    v_cmp_ne_u32 vcc, 0, v77
    s_cbranch_vccz cs_goA
    s_nop 15
    s_nop 15
    s_nop 7
    buffer_load_dwordx4 v[40:43], v65, s[4:7], s14 offen offset:0 sc1
    buffer_load_dwordx4 v[60:63], v66, s[4:7], s14 offen offset:0 sc1
    v_bitop3_b32 v77, v40, v60, s70 bitop3:0x7e
    v_and_b32 v77, 1, v77
    v_cmp_ne_u32 vcc, 0, v77
    s_cbranch_vccz cs_goA
    s_nop 15
    s_nop 15
    s_nop 7
    v_bitop3_b32 v77, v40, v60, s70 bitop3:0x7e
    v_and_b32 v77, 1, v77
    v_cmp_ne_u32 vcc, 0, v77
    s_cbranch_vccz cs_goA
    s_nop 15
    s_nop 15
    s_nop 7
    v_bitop3_b32 v77, v40, v60, s70 bitop3:0x7e
    v_and_b32 v77, 1, v77
    v_cmp_ne_u32 vcc, 0, v77
    s_cbranch_vccz cs_goA
    s_nop 15
    s_nop 15
    s_nop 7
    v_bitop3_b32 v77, v40, v60, s70 bitop3:0x7e
    v_and_b32 v77, 1, v77
    v_cmp_ne_u32 vcc, 0, v77
    s_cbranch_vccz cs_goA
    s_nop 15
    s_nop 15
    s_nop 7
    buffer_load_dwordx4 v[40:43], v65, s[4:7], s14 offen offset:0 sc1
    buffer_load_dwordx4 v[60:63], v66, s[4:7], s14 offen offset:0 sc1
    v_bitop3_b32 v77, v40, v60, s70 bitop3:0x7e
    v_and_b32 v77, 1, v77
    v_cmp_ne_u32 vcc, 0, v77
    s_cbranch_vccz cs_goA
    s_nop 15
    s_nop 15
    s_nop 7
    v_bitop3_b32 v77, v40, v60, s70 bitop3:0x7e
    v_and_b32 v77, 1, v77
    v_cmp_ne_u32 vcc, 0, v77
    s_cbranch_vccz cs_goA
    s_nop 15
    s_nop 15
    s_nop 7
    v_bitop3_b32 v77, v40, v60, s70 bitop3:0x7e
    v_and_b32 v77, 1, v77
    v_cmp_ne_u32 vcc, 0, v77
    s_cbranch_vccz cs_goA
    s_nop 15
    s_nop 15
    s_nop 7
    v_bitop3_b32 v77, v40, v60, s70 bitop3:0x7e
    v_and_b32 v77, 1, v77
    v_cmp_ne_u32 vcc, 0, v77
    s_cbranch_vccz cs_goA
    s_nop 15
    s_nop 15
    s_nop 7
    buffer_load_dwordx4 v[40:43], v65, s[4:7], s14 offen offset:0 sc1
    buffer_load_dwordx4 v[60:63], v66, s[4:7], s14 offen offset:0 sc1
    v_bitop3_b32 v77, v40, v60, s70 bitop3:0x7e
    v_and_b32 v77, 1, v77
    v_cmp_ne_u32 vcc, 0, v77
    s_cbranch_vccz cs_goA
    s_nop 15
    s_nop 15
    s_nop 7
    v_bitop3_b32 v77, v40, v60, s70 bitop3:0x7e
    v_and_b32 v77, 1, v77
    v_cmp_ne_u32 vcc, 0, v77
    s_cbranch_vccz cs_goA
    s_nop 15
    s_nop 15
    s_nop 7
    v_bitop3_b32 v77, v40, v60, s70 bitop3:0x7e
    v_and_b32 v77, 1, v77
    v_cmp_ne_u32 vcc, 0, v77
    s_cbranch_vccz cs_goA
    s_nop 15
    s_nop 15
    s_nop 7
    v_bitop3_b32 v77, v40, v60, s70 bitop3:0x7e
    v_and_b32 v77, 1, v77
    v_cmp_ne_u32 vcc, 0, v77
    s_cbranch_vccz cs_goA
    s_nop 15
    s_nop 15
    s_nop 7
    s_sub_u32 s31, s31, 64
    s_cbranch_scc0 cs_cA
cs_goA:
    ds_write_b128 v65, v[40:43] offset:0
    v_smfmac_f32_16x16x64_bf16 v[0:3], v[40:43], v[44:51], v64
    v_smfmac_f32_16x16x64_bf16 v[4:7], v[40:43], v[52:59], v64
    buffer_load_dwordx4 v[44:47], v65, s[4:7], s15 offen offset:0 sc1
    v_smfmac_f32_16x16x64_bf16 v[0:3], v[60:63], v[24:31], v64
    s_add_u32 s40, s26, 1048576
    s_min_u32 s40, s40, s99
    s_sub_u32 s41, s96, s40
    v_smfmac_f32_16x16x64_bf16 v[4:7], v[60:63], v[32:39], v64
    ds_read_b128 v[24:27], v70 offset:8192
    s_cmp_lt_u32 s97, s93
    s_cselect_b32 s41, s41, 0
    v_smfmac_f32_16x16x64_bf16 v[8:11], v[40:43], a[96:103], v64
    ds_read_b128 v[28:31], v70 offset:9216
    v_smfmac_f32_16x16x64_bf16 v[12:15], v[40:43], a[104:111], v64
    ds_read_b128 v[32:35], v70 offset:10240
    s_waitcnt lgkmcnt(3)
    s_barrier
    ds_read_b128 v[48:51], v67 offset:0
    v_smfmac_f32_16x16x64_bf16 v[8:11], v[60:63], a[112:119], v64
    ds_read_b128 v[36:39], v70 offset:11264
    v_bitop3_b32 v79, v73, -9, s54 bitop3:0x6a
    v_smfmac_f32_16x16x64_bf16 v[12:15], v[60:63], a[120:127], v64
    buffer_load_dwordx4 v[44:47], v65, s[4:7], s15 offen offset:0 sc1
    v_smfmac_f32_16x16x64_bf16 v[16:19], v[40:43], a[232:239], v64
    ds_read_b128 v[52:55], v68 offset:0
    s_waitcnt lgkmcnt(4)
    v_bfe_u32 v77, v65, 2, 5
    v_smfmac_f32_16x16x64_bf16 v[20:23], v[40:43], v[24:31], v64
    ds_read_b128 v[24:27], v70 offset:12288
    s_waitcnt lgkmcnt(3)
    v_smfmac_f32_16x16x64_bf16 v[0:3], v[48:51], a[0:7], v64
    ds_read_b128 v[28:31], v70 offset:13312
    s_waitcnt lgkmcnt(3)
    v_add3_u32 v77, v77, s41, 16
    v_smfmac_f32_16x16x64_bf16 v[4:7], v[48:51], v[32:39], v64
    buffer_load_dwordx4 v[40:43], v65, s[4:7], s16 offen offset:0 sc1
    v_smfmac_f32_16x16x64_bf16 v[16:19], v[60:63], a[240:247], v64
    ds_read_b128 v[32:35], v70 offset:14336
    v_lshlrev_b32 v78, 3, v69
    v_smfmac_f32_16x16x64_bf16 v[20:23], v[60:63], a[248:255], v64
    ds_read_b128 v[36:39], v70 offset:15360
    v_smfmac_f32_16x16x64_bf16 v[8:11], v[48:51], a[128:135], v64
    s_waitcnt vmcnt(2)
    v_mov_b32_dpp v78, v77 quad_perm:[0,1,2,3] row_mask:0xc bank_mask:0xf
    v_smfmac_f32_16x16x64_bf16 v[12:15], v[48:51], a[136:143], v64
    buffer_load_dwordx4 v[58:61], v65, s[4:7], s24 offen offset:3072 sc1
    s_waitcnt lgkmcnt(2)
    v_and_b32 v77, s36, v44
    v_smfmac_f32_16x16x64_bf16 v[12:15], v[52:55], v[24:31], v64
    ds_write_b128 v65, v[44:47] offset:4096
    v_smfmac_f32_16x16x64_bf16 v[0:3], v[52:55], a[8:15], v64
    v_cmp_ne_u32 vcc, s70, v77
    v_smfmac_f32_16x16x64_bf16 v[8:11], v[52:55], a[144:151], v64
    buffer_load_dwordx4 v[24:27], v65, s[4:7], s24 offen offset:0 sc1
    s_waitcnt lgkmcnt(1)
    v_smfmac_f32_16x16x64_bf16 v[4:7], v[52:55], v[32:39], v64
    s_cbranch_vccnz cs_spinB
cs_backB:
    v_smfmac_f32_16x16x64_bf16 v[16:19], v[44:47], v[176:183], v64
    s_waitcnt lgkmcnt(0)
    s_barrier
    ds_read_b128 v[48:51], v66 offset:4096
    v_smfmac_f32_16x16x64_bf16 v[12:15], v[44:47], a[160:167], v64
    buffer_load_dwordx4 v[28:31], v65, s[4:7], s24 offen offset:1024 sc1
    v_smfmac_f32_16x16x64_bf16 v[0:3], v[44:47], a[16:23], v64
    ds_read_b128 v[52:55], v67 offset:4096
    v_smfmac_f32_16x16x64_bf16 v[8:11], v[44:47], a[152:159], v64
    v_smfmac_f32_16x16x64_bf16 v[4:7], v[44:47], a[24:31], v64
    buffer_load_dwordx4 v[34:37], v65, s[4:7], s24 offen offset:2048 sc1
    s_waitcnt vmcnt(5)
    v_smfmac_f32_16x16x64_bf16 v[20:23], v[44:47], v[184:191], v64
    ds_read_b128 v[44:47], v68 offset:4096
    s_waitcnt lgkmcnt(2)
    v_smfmac_f32_16x16x64_bf16 v[0:3], v[48:51], a[32:39], v64
    v_smfmac_f32_16x16x64_bf16 v[8:11], v[48:51], a[168:175], v64
    buffer_load_dword v76, v78, s[4:7], s40 offen sc1
    v_smfmac_f32_16x16x64_bf16 v[4:7], v[48:51], a[40:47], v64
    s_waitcnt vmcnt(5)
    v_and_b32 v77, s36, v40
    v_smfmac_f32_16x16x64_bf16 v[12:15], v[48:51], a[176:183], v64
    ds_read_b128 v[48:51], v69 offset:15360
    s_waitcnt lgkmcnt(1)
    v_cmp_ne_u32 vcc, s70, v77
    v_smfmac_f32_16x16x64_bf16 v[0:3], v[52:55], a[48:55], v64
    v_smfmac_f32_16x16x64_bf16 v[8:11], v[52:55], a[184:191], v64
    s_cbranch_vccnz cs_spin8
cs_back8:
    v_smfmac_f32_16x16x64_bf16 v[0:3], v[44:47], a[64:71], v64
    v_smfmac_f32_16x16x64_bf16 v[8:11], v[44:47], a[200:207], v64
    v_smfmac_f32_16x16x64_bf16 v[0:3], v[40:43], a[80:87], v64
    s_nop 1
    v_smfmac_f32_16x16x64_bf16 v[8:11], v[40:43], a[216:223], v64
    s_nop 1
    v_lshrrev_b32 v77, 1, v69
    v_smfmac_f32_16x16x64_bf16 v[4:7], v[52:55], a[56:63], v64
    s_nop 1
    v_cvt_pk_bf16_f32 v0, v0, v1
    v_smfmac_f32_16x16x64_bf16 v[12:15], v[52:55], a[192:199], v64
    s_nop 1
    v_cvt_pk_bf16_f32 v1, v2, v3
    v_smfmac_f32_16x16x64_bf16 v[4:7], v[44:47], a[72:79], v64
    s_nop 1
    v_cvt_pk_bf16_f32 v2, v8, v9
    v_smfmac_f32_16x16x64_bf16 v[12:15], v[44:47], a[208:215], v64
    s_nop 1
    v_cvt_pk_bf16_f32 v3, v10, v11
    v_smfmac_f32_16x16x64_bf16 v[4:7], v[40:43], a[88:95], v64
    s_waitcnt lgkmcnt(0)
    s_nop 0
    s_nop 0
    v_smfmac_f32_16x16x64_bf16 v[12:15], v[40:43], a[224:231], v64
    s_nop 2
    v_mfma_f32_16x16x32_bf16 v[8:11], v[0:3], v[48:51], 0
    s_nop 0
    v_cvt_pk_bf16_f32 v4, v4, v5
    v_cvt_pk_bf16_f32 v5, v6, v7
    s_nop 0
    v_cvt_pk_bf16_f32 v6, v12, v13
    v_cvt_pk_bf16_f32 v7, v14, v15
    s_nop 1
    v_mfma_f32_16x16x32_bf16 v[12:15], v[4:7], v[48:51], 0
    ds_read_b128 v[48:51], v66 offset:4096
    v_cvt_pk_bf16_f32 v0, v8, v9
    v_cvt_pk_bf16_f32 v1, v10, v11
    v_smfmac_f32_16x16x64_bf16 v[16:19], v[52:55], v[208:215], v64
    s_waitcnt vmcnt(2)
    s_nop 2
    v_cvt_pk_bf16_f32 v2, v12, v13
    v_cvt_pk_bf16_f32 v3, v14, v15
    s_nop 1
    v_mfma_f32_16x16x32_bf16 v[12:15], v[0:3], v[0:3], 0
    s_nop 1
    v_bitop3_b32 v78, v73, -9, s53 bitop3:0x6a
    v_mfma_f32_16x16x32_bf16 v[4:7], v[24:27], v[0:3], 0
    ds_read_b128 v[24:27], v67 offset:0
    s_nop 1
    v_mfma_f32_16x16x32_bf16 v[8:11], v[28:31], v[0:3], 0
    s_nop 0
    v_mov_b32_dpp v12, v14 row_ror:8 row_mask:0xf bank_mask:0xc
    v_mov_b32_dpp v13, v15 row_ror:8 row_mask:0xf bank_mask:0xc
    v_smfmac_f32_16x16x64_bf16 v[20:23], v[52:55], v[216:223], v64
    ds_write_b64 v71, v[12:13]
    ds_read_b128 v[52:55], v68 offset:0
    s_nop 1
    v_mov_b32_dpp v4, v8 row_ror:8 row_mask:0xf bank_mask:0xc
    v_mov_b32_dpp v5, v9 row_ror:8 row_mask:0xf bank_mask:0xc
    v_mov_b32_dpp v6, v10 row_ror:8 row_mask:0xf bank_mask:0xc
    v_mov_b32_dpp v7, v11 row_ror:8 row_mask:0xf bank_mask:0xc
    v_smfmac_f32_16x16x64_bf16 v[16:19], v[44:47], v[224:231], v64
    ds_write_b128 v65, v[4:7] offset:8192
    v_smfmac_f32_16x16x64_bf16 v[20:23], v[44:47], v[232:239], v64
    s_waitcnt lgkmcnt(3)
    v_smfmac_f32_16x16x64_bf16 v[16:19], v[24:27], v[144:151], v64
    s_waitcnt vmcnt(1)
    v_smfmac_f32_16x16x64_bf16 v[20:23], v[24:27], v[152:159], v64
    s_mov_b64 exec, s[38:39]
    buffer_store_dword v72, v75, s[4:7], s55 offen sc1
    s_mov_b64 exec, -1
    v_smfmac_f32_16x16x64_bf16 v[16:19], v[40:43], v[240:247], v64
    s_cmp_ge_u32 s30, 56
    s_waitcnt lgkmcnt(0)
    s_barrier
    ds_read_b128 v[8:11], v66 offset:8192
    v_smfmac_f32_16x16x64_bf16 v[20:23], v[40:43], v[248:255], v64
    ds_read_b128 v[12:15], v67 offset:8192
    v_smfmac_f32_16x16x64_bf16 v[16:19], v[48:51], v[192:199], v64
    ds_read_b128 v[44:47], v68 offset:8192
    v_smfmac_f32_16x16x64_bf16 v[20:23], v[48:51], v[200:207], v64
    ds_read_b64 v[24:25], v77 offset:14336
    ds_read_b64 v[26:27], v77 offset:14592
    v_smfmac_f32_16x16x64_bf16 v[16:19], v[52:55], v[160:167], v64
    ds_read_b64 v[28:29], v77 offset:14848
    ds_read_b64 v[30:31], v77 offset:15104
    v_bitop3_b32 v77, v73, -9, s52 bitop3:0x6a
    v_smfmac_f32_16x16x64_bf16 v[20:23], v[52:55], v[168:175], v64
    s_cbranch_scc1 cs_rare
cs_rare_x:
    ds_read_b128 v[48:51], v70 offset:22528
    ds_read_b128 v[52:55], v70 offset:23552
    s_waitcnt lgkmcnt(6)
    v_pk_add_f32 v[4:5], v[4:5], v[8:9]
    v_pk_add_f32 v[6:7], v[6:7], v[10:11]
    v_pk_add_f32 v[12:13], v[12:13], v[44:45]
    v_pk_add_f32 v[14:15], v[14:15], v[46:47]
    v_pk_add_f32 v[4:5], v[4:5], v[12:13]
    v_pk_add_f32 v[6:7], v[6:7], v[14:15]
    s_waitcnt lgkmcnt(2)
    v_pk_add_f32 v[24:25], v[24:25], v[26:27]
    v_pk_add_f32 v[28:29], v[28:29], v[30:31]
    v_max3_f32 v8, v4, v5, v6
    v_pk_add_f32 v[24:25], v[24:25], v[28:29]
    v_max_f32 v8, v8, v7
    v_max3_f32 v8, v8, v24, v25
    v_cvt_pk_bf16_f32 v32, v16, v17
    v_cvt_pk_bf16_f32 v38, v18, v19
    v_max_f32_dpp v8, v8, v8 row_ror:8 row_mask:0xf bank_mask:0xf
    v_mov_b32 v9, v8
    v_cvt_pk_bf16_f32 v56, v20, v21
    v_cvt_pk_bf16_f32 v62, v22, v23
    v_permlane32_swap_b32 v8, v9
    v_max_f32 v8, v8, v9
    v_mov_b32 v9, v8
    v_mov_b32 v11, 0
    v_mov_b32 v15, 0
    v_permlane16_swap_b32 v8, v9
    v_max_f32 v8, v8, v9
    v_mul_f32 v8, s66, v8
    v_pk_fma_f32 v[4:5], v[4:5], s[44:45], v[8:9] op_sel_hi:[1,1,0]
    v_pk_fma_f32 v[6:7], v[6:7], s[44:45], v[8:9] op_sel_hi:[1,1,0]
    v_pk_fma_f32 v[24:25], v[24:25], s[44:45], v[8:9] op_sel_hi:[1,1,0]
    v_exp_f32 v4, v4
    v_exp_f32 v5, v5
    v_exp_f32 v6, v6
    v_exp_f32 v7, v7
    v_exp_f32 v24, v24
    v_exp_f32 v25, v25
    v_cvt_pk_bf16_f32 v12, v4, v5
    v_cvt_pk_bf16_f32 v13, v6, v7
    v_cvt_pk_bf16_f32 v10, v24, v25
    v_cvt_pk_bf16_f32 v14, v24, v25
    v_mov_b64 v[0:1], s[48:49]
    v_mfma_f32_16x16x32_bf16 v[4:7], v[32:35], v[10:13], 0
    ds_read_b128 v[40:43], v70 offset:20480
    v_mov_b64 v[2:3], s[50:51]
    v_mfma_f32_16x16x32_bf16 v[24:27], v[36:39], v[12:15], 0
    ds_read_b128 v[44:47], v70 offset:21504
    v_mov_b64 v[8:9], 0
    v_mfma_f32_16x16x32_bf16 v[28:31], v[0:3], v[10:13], 0
    ds_read_b128 v[32:35], v70 offset:24576
    v_mov_b64 v[0:1], 0
    v_mfma_f32_16x16x32_bf16 v[16:19], v[56:59], v[10:13], 0
    ds_read_b128 v[36:39], v70 offset:25600
    v_mov_b64 v[2:3], 0
    v_mfma_f32_16x16x32_bf16 v[20:23], v[60:63], v[12:15], 0
    ds_read_b128 v[56:59], v70 offset:28672
    v_add_f32_dpp v4, v24, v4 row_ror:8 row_mask:0xf bank_mask:0xf
    v_add_f32_dpp v5, v25, v5 row_ror:8 row_mask:0xf bank_mask:0xf
    v_add_f32_dpp v6, v26, v6 row_ror:8 row_mask:0xf bank_mask:0xf
    v_add_f32_dpp v7, v27, v7 row_ror:8 row_mask:0xf bank_mask:0xf
    v_add_f32_dpp v29, v28, v28 row_ror:8 row_mask:0xf bank_mask:0xf
    v_rcp_f32 v28, v29
    v_mov_b64 v[10:11], 0
    v_add_f32_dpp v4, v16, v20 row_ror:8 row_mask:0xf bank_mask:0xc
    v_add_f32_dpp v5, v17, v21 row_ror:8 row_mask:0xf bank_mask:0xc
    v_add_f32_dpp v6, v18, v22 row_ror:8 row_mask:0xf bank_mask:0xc
    v_add_f32_dpp v7, v19, v23 row_ror:8 row_mask:0xf bank_mask:0xc
    v_pk_mul_f32 v[4:5], v[4:5], v[28:29] op_sel_hi:[1,0]
    v_pk_mul_f32 v[6:7], v[6:7], v[28:29] op_sel_hi:[1,0]
    v_cvt_pk_bf16_f32 v4, v4, v5
    v_cvt_pk_bf16_f32 v5, v6, v7
    ds_write_b64 v73, v[4:5] offset:12288
    v_mov_b32_dpp v6, v4 row_ror:8 row_mask:0xf bank_mask:0xf
    v_mov_b32_dpp v7, v5 row_ror:8 row_mask:0xf bank_mask:0xf
    v_mov_b64 v[12:13], 0
    v_mov_b64 v[14:15], 0
    v_smfmac_f32_16x16x64_bf16 v[8:11], v[4:7], v[80:87], v64
    s_waitcnt lgkmcnt(4)
    v_mov_b64 v[24:25], 0
    v_smfmac_f32_16x16x64_bf16 v[0:3], v[4:7], v[40:47], v64
    ds_read_b128 v[60:63], v70 offset:29696
    v_mov_b64 v[26:27], 0
    v_smfmac_f32_16x16x64_bf16 v[12:15], v[4:7], v[112:119], v64
    s_waitcnt lgkmcnt(1)
    s_barrier
    ds_read_b128 v[16:19], v77 offset:12288
    v_smfmac_f32_16x16x64_bf16 v[24:27], v[4:7], v[48:55], v64
    ds_read_b128 v[20:23], v78 offset:12288
    ds_read_b128 v[28:31], v79 offset:12288
    v_mov_b64 v[4:5], 0
    v_mov_b64 v[6:7], 0
    v_bfe_u32 v77, v74, 16, 1
    v_mad_i32_i24 v77, v77, s56, v74
    s_waitcnt lgkmcnt(2)
    v_smfmac_f32_16x16x64_bf16 v[8:11], v[16:19], v[88:95], v64
    ds_read_b128 v[40:43], v70 offset:32768
    s_waitcnt lgkmcnt(2)
    v_smfmac_f32_16x16x64_bf16 v[8:11], v[20:23], v[96:103], v64
    ds_read_b128 v[44:47], v70 offset:33792
    s_waitcnt lgkmcnt(2)
    v_smfmac_f32_16x16x64_bf16 v[8:11], v[28:31], v[104:111], v64
    ds_read_b128 v[48:51], v70 offset:26624
    s_nop 0
    v_and_b32 v72, 8, v73
    v_smfmac_f32_16x16x64_bf16 v[0:3], v[16:19], v[32:39], v64
    ds_read_b128 v[52:55], v70 offset:27648
    s_nop 0
    v_mad_u32_u24 v72, v72, 63, v73
    v_smfmac_f32_16x16x64_bf16 v[12:15], v[16:19], v[120:127], v64
    ds_read_b128 v[32:35], v70 offset:30720
    v_cvt_pk_bf16_f32 v8, v8, v9
    v_cvt_pk_bf16_f32 v9, v10, v11
    v_and_or_b32 v8, v8, -2, s69
    v_smfmac_f32_16x16x64_bf16 v[12:15], v[20:23], v[128:135], v64
    buffer_store_dwordx2 v[8:9], v74, s[4:7], s22 offen offset:0 sc1
    ds_read_b128 v[36:39], v70 offset:31744
    v_smfmac_f32_16x16x64_bf16 v[12:15], v[28:31], v[136:143], v64
    s_add_u32 s30, s30, 1
    s_xor_b32 s70, s70, 1
    v_subrev_u32 v72, s47, v72
    v_smfmac_f32_16x16x64_bf16 v[0:3], v[20:23], v[56:63], v64
    ds_read_b128 v[56:59], v70 offset:34816
    s_waitcnt lgkmcnt(3)
    s_nop 0
    v_smfmac_f32_16x16x64_bf16 v[0:3], v[28:31], v[40:47], v64
    ds_read_b128 v[60:63], v70 offset:35840
    v_cvt_pk_bf16_f32 v12, v12, v13
    v_cvt_pk_bf16_f32 v13, v14, v15
    v_and_or_b32 v12, v12, -2, s69
    v_smfmac_f32_16x16x64_bf16 v[24:27], v[16:19], v[48:55], v64
    buffer_store_dwordx2 v[12:13], v74, s[4:7], s22 offen offset:64 sc1
    s_waitcnt lgkmcnt(2)
    v_smfmac_f32_16x16x64_bf16 v[24:27], v[20:23], v[32:39], v64
    ds_read_b128 v[40:43], v70 offset:16384
    v_cvt_pk_bf16_f32 v0, v0, v1
    v_cvt_pk_bf16_f32 v1, v2, v3
    v_and_or_b32 v0, v0, -2, s69
    s_waitcnt lgkmcnt(1)
    v_smfmac_f32_16x16x64_bf16 v[24:27], v[28:31], v[56:63], v64
    buffer_store_dwordx2 v[0:1], v74, s[4:7], s23 offen offset:0 sc1
    ds_read_b128 v[44:47], v70 offset:17408
    ds_read_b128 v[8:11], v72 offset:12288
    ds_read_b128 v[48:51], v70 offset:18432
    ds_read_b128 v[52:55], v70 offset:19456
    ds_read_b128 v[12:15], v72 offset:13312
    s_cmp_lg_u32 s71, 0
    s_nop 0
    v_cvt_pk_bf16_f32 v24, v24, v25
    v_cvt_pk_bf16_f32 v25, v26, v27
    v_and_or_b32 v24, v24, -2, s69
    buffer_store_dwordx2 v[24:25], v74, s[4:7], s23 offen offset:64 sc1
    s_waitcnt lgkmcnt(3)
    v_smfmac_f32_16x16x64_bf16 v[4:7], v[8:11], v[40:47], v64
    s_waitcnt lgkmcnt(0)
    v_smfmac_f32_16x16x64_bf16 v[4:7], v[12:15], v[48:55], v64
    s_nop 7
    v_cvt_pk_bf16_f32 v4, v4, v5
    v_cvt_pk_bf16_f32 v5, v6, v7
    v_and_or_b32 v4, v4, -2, s69
    buffer_store_dwordx2 v[4:5], v77, s[4:7], s25 offen offset:0 sc1
    s_nop 0
    s_cbranch_scc1 cs_e1
    s_cmp_lg_u32 s37, 0
    s_cbranch_scc1 cs_f0_xt
cs_f0_xtx:
    s_nop 2
    v_mov_b32 v79, v79
    s_nop 2
    v_mov_b32 v79, v79
    s_nop 2
    v_mov_b32 v79, v79
    s_nop 2
    v_mov_b32 v79, v79
    s_nop 2
    v_mov_b32 v79, v79
    s_nop 2
    v_mov_b32 v79, v79
    s_nop 2
    v_mov_b32 v79, v79
    s_nop 2
    v_mov_b32 v79, v79
    s_nop 2
    v_mov_b32 v79, v79
    s_nop 2
    v_mov_b32 v79, v79
    s_nop 2
    v_mov_b32 v79, v79
    s_nop 2
    v_mov_b32 v79, v79
    s_nop 2
    v_mov_b32 v79, v79
    s_nop 2
    v_mov_b32 v79, v79
    s_nop 2
    v_mov_b32 v79, v79
    s_nop 2
    v_mov_b32 v79, v79
    s_nop 2
    v_mov_b32 v79, v79
    s_nop 2
    v_mov_b32 v79, v79
    s_nop 2
    v_mov_b32 v79, v79
    s_nop 2
    v_mov_b32 v79, v79
    s_nop 2
    v_mov_b32 v79, v79
    s_nop 2
    v_mov_b32 v79, v79
    s_nop 2
    v_mov_b32 v79, v79
    s_nop 2
    v_mov_b32 v79, v79
    s_nop 2
    v_mov_b32 v79, v79
    s_nop 2
    v_mov_b32 v79, v79
    s_nop 2
    v_mov_b32 v79, v79
    s_nop 2
    v_mov_b32 v79, v79
    s_nop 2
    v_mov_b32 v79, v79
    s_nop 2
    v_mov_b32 v79, v79
    s_nop 2
    v_mov_b32 v79, v79
    s_nop 2
    v_mov_b32 v79, v79
    s_nop 2
    v_mov_b32 v79, v79
    s_nop 2
    v_mov_b32 v79, v79
    s_nop 2
    v_mov_b32 v79, v79
    s_nop 2
    v_mov_b32 v79, v79
    s_nop 0
    v_mov_b32 v79, v79
    buffer_load_dwordx4 v[8:11], v65, s[4:7], s18 offen sc1
    buffer_load_dwordx4 v[12:15], v65, s[4:7], s19 offen sc1
    buffer_load_dwordx4 v[16:19], v65, s[4:7], s20 offen sc1
    buffer_load_dwordx4 v[20:23], v65, s[4:7], s21 offen sc1
    v_and_b32 v77, 255, v69
    ds_read_b128 v[4:7], v77 offset:15872
    ds_read_b128 v[44:47], v70 offset:0
    ds_read_b128 v[48:51], v70 offset:1024
    ds_read_b128 v[52:55], v70 offset:2048
    ds_read_b128 v[56:59], v70 offset:3072
    ds_read_b128 v[24:27], v70 offset:4096
    ds_read_b128 v[28:31], v70 offset:5120
    ds_read_b128 v[32:35], v70 offset:6144
    ds_read_b128 v[36:39], v70 offset:7168
    s_mov_b32 s31, 65536
    s_add_u32 s24, s24, 524288
    s_add_u32 s26, s26, 524288
    s_add_u32 s55, s55, s57
    s_mov_b32 s14, 67633152
    s_mov_b32 s15, 67637248
    s_mov_b32 s16, 67641344
    s_mov_b32 s36, 1
    v_mov_b32 v40, s69
    v_mov_b32 v60, s69
    v_and_b32 v79, 12, v75
    v_cmp_eq_u32 vcc, 0, v79
    s_nop 1
    v_cndmask_b32 v79, 0, 1, vcc
    s_waitcnt lgkmcnt(0)
    s_waitcnt vmcnt(3)
    v_bitop3_b32 v77, v8, v10, s69 bitop3:0x7e
    v_mfma_f32_16x16x32_bf16 v[0:3], v[4:7], v[8:11], 0
    v_mov_b64 v[8:9], 0
    v_mov_b64 v[10:11], 0
    s_waitcnt vmcnt(2)
    v_bitop3_b32 v78, v12, v14, s69 bitop3:0x7e
    v_mfma_f32_16x16x32_bf16 v[0:3], v[4:7], v[12:15], v[0:3]
    v_or_b32 v77, v77, v78
    v_mov_b64 v[12:13], 0
    v_mov_b64 v[14:15], 0
    s_waitcnt vmcnt(1)
    v_bitop3_b32 v78, v16, v18, s69 bitop3:0x7e
    v_mfma_f32_16x16x32_bf16 v[0:3], v[4:7], v[16:19], v[0:3]
    v_or_b32 v77, v77, v78
    v_mov_b64 v[16:17], 0
    v_mov_b64 v[18:19], 0
    s_waitcnt vmcnt(0)
    v_bitop3_b32 v78, v20, v22, s69 bitop3:0x7e
    v_mfma_f32_16x16x32_bf16 v[0:3], v[4:7], v[20:23], v[0:3]
    v_bitop3_b32 v77, v77, v78, 1 bitop3:0xa8
    v_cmp_ne_u32 vcc, 0, v77
    v_mov_b64 v[20:21], 0
    v_mov_b64 v[22:23], 0
    s_cmp_eq_u64 vcc, 0
    s_cselect_b64 s[42:43], -1, 0
    s_nop 1
    v_add_f32_dpp v0, v0, v0 row_ror:8 row_mask:0xf bank_mask:0xf
    v_add_f32_dpp v1, v1, v1 row_ror:8 row_mask:0xf bank_mask:0xf
    s_mov_b64 exec, s[42:43]
    v_cvt_pk_bf16_f32 v72, v0, v1
    v_bfi_b32 v72, v79, s70, v72
    buffer_store_dword v72, v75, s[4:7], s17 offen offset:0 sc1
    s_mov_b64 exec, -1
    s_cbranch_scc0 cs_f0_retry
cs_f0_go:
    v_mov_b64 v[0:1], 0
    v_mov_b64 v[2:3], 0
    v_mov_b64 v[4:5], 0
    v_mov_b64 v[6:7], 0
    s_nop 2
    v_mov_b32 v79, v79
    s_nop 2
    v_mov_b32 v79, v79
    s_nop 2
    v_mov_b32 v79, v79
    s_nop 2
    v_mov_b32 v79, v79
    s_nop 2
    v_mov_b32 v79, v79
    s_nop 2
    v_mov_b32 v79, v79
    s_nop 2
    v_mov_b32 v79, v79
    s_nop 2
    v_mov_b32 v79, v79
    s_nop 2
    v_mov_b32 v79, v79
    s_nop 2
    v_mov_b32 v79, v79
    s_nop 2
    v_mov_b32 v79, v79
    s_nop 2
    v_mov_b32 v79, v79
    s_nop 2
    v_mov_b32 v79, v79
    s_nop 2
    v_mov_b32 v79, v79
    s_nop 2
    v_mov_b32 v79, v79
    s_nop 2
    v_mov_b32 v79, v79
    s_nop 2
    v_mov_b32 v79, v79
    s_nop 2
    v_mov_b32 v79, v79
    s_nop 2
    v_mov_b32 v79, v79
    s_nop 2
    v_mov_b32 v79, v79
    s_nop 2
    v_mov_b32 v79, v79
    s_nop 2
    v_mov_b32 v79, v79
    s_nop 2
    v_mov_b32 v79, v79
    s_nop 2
    v_mov_b32 v79, v79
    s_nop 2
    v_mov_b32 v79, v79
    s_branch cs_loop
cs_e1:
    s_cmp_lg_u32 s71, 2
    s_cbranch_scc1 cs_f1
    v_and_b32 v77, 255, v69
    ds_read_b128 v[4:7], v77 offset:15872
    ds_read_b128 v[44:47], v70 offset:0
    ds_read_b128 v[48:51], v70 offset:1024
    ds_read_b128 v[52:55], v70 offset:2048
    ds_read_b128 v[56:59], v70 offset:3072
    ds_read_b128 v[24:27], v70 offset:4096
    ds_read_b128 v[28:31], v70 offset:5120
    ds_read_b128 v[32:35], v70 offset:6144
    ds_read_b128 v[36:39], v70 offset:7168
    s_mov_b32 s31, 65536
    s_add_u32 s24, s24, 524288
    s_add_u32 s26, s26, 524288
    s_add_u32 s55, s55, s57
    s_mov_b32 s14, 67633152
    s_mov_b32 s15, 67637248
    s_mov_b32 s16, 67641344
    s_mov_b32 s36, 1
    v_mov_b32 v40, s69
    v_mov_b32 v60, s69
    v_and_b32 v79, 12, v75
    v_cmp_eq_u32 vcc, 0, v79
    s_nop 1
    v_cndmask_b32 v79, 0, 1, vcc
    s_cmp_lg_u32 s37, 0
    s_cbranch_scc1 cs_f2_xt
cs_f2_xtx:
    s_nop 2
    v_mov_b32 v79, v79
    s_nop 2
    v_mov_b32 v79, v79
    s_nop 2
    v_mov_b32 v79, v79
    s_nop 2
    v_mov_b32 v79, v79
    s_nop 2
    v_mov_b32 v79, v79
    s_nop 2
    v_mov_b32 v79, v79
    s_nop 2
    v_mov_b32 v79, v79
    s_nop 2
    v_mov_b32 v79, v79
    s_nop 2
    v_mov_b32 v79, v79
    s_nop 2
    v_mov_b32 v79, v79
    s_nop 2
    v_mov_b32 v79, v79
    s_nop 2
    v_mov_b32 v79, v79
    s_nop 2
    v_mov_b32 v79, v79
    s_nop 2
    v_mov_b32 v79, v79
    s_nop 2
    v_mov_b32 v79, v79
    s_nop 2
    v_mov_b32 v79, v79
    s_nop 2
    v_mov_b32 v79, v79
    s_nop 2
    v_mov_b32 v79, v79
    s_nop 2
    v_mov_b32 v79, v79
    s_nop 2
    v_mov_b32 v79, v79
    s_nop 2
    v_mov_b32 v79, v79
    s_nop 2
    v_mov_b32 v79, v79
    s_nop 2
    v_mov_b32 v79, v79
    s_nop 2
    v_mov_b32 v79, v79
    s_nop 2
    v_mov_b32 v79, v79
    s_nop 2
    v_mov_b32 v79, v79
    s_nop 2
    v_mov_b32 v79, v79
    s_nop 2
    v_mov_b32 v79, v79
    s_nop 2
    v_mov_b32 v79, v79
    s_nop 2
    v_mov_b32 v79, v79
    s_nop 2
    v_mov_b32 v79, v79
    s_nop 2
    v_mov_b32 v79, v79
    s_nop 2
    v_mov_b32 v79, v79
    s_nop 2
    v_mov_b32 v79, v79
    s_nop 2
    v_mov_b32 v79, v79
    s_nop 2
    v_mov_b32 v79, v79
    s_nop 0
    v_mov_b32 v79, v79
    s_waitcnt vmcnt(0)
    buffer_load_dwordx4 v[8:11], v65, s[4:7], s18 offen sc1
    buffer_load_dwordx4 v[12:15], v65, s[4:7], s19 offen sc1
    buffer_load_dwordx4 v[16:19], v65, s[4:7], s20 offen sc1
    buffer_load_dwordx4 v[20:23], v65, s[4:7], s21 offen sc1
    s_nop 2
    v_mov_b32 v79, v79
    s_nop 2
    v_mov_b32 v79, v79
    s_nop 2
    v_mov_b32 v79, v79
    s_nop 2
    v_mov_b32 v79, v79
    s_nop 2
    v_mov_b32 v79, v79
    s_nop 2
    v_mov_b32 v79, v79
    s_nop 2
    v_mov_b32 v79, v79
    s_nop 2
    v_mov_b32 v79, v79
    s_nop 2
    v_mov_b32 v79, v79
    s_nop 2
    v_mov_b32 v79, v79
    buffer_load_dwordx4 v[40:43], v65, s[4:7], s14 offen offset:0 sc1
    buffer_load_dwordx4 v[60:63], v66, s[4:7], s14 offen offset:0 sc1
    s_waitcnt lgkmcnt(0)
    s_waitcnt vmcnt(5)
    v_bitop3_b32 v77, v8, v10, s69 bitop3:0x7e
    v_mfma_f32_16x16x32_bf16 v[0:3], v[4:7], v[8:11], 0
    v_mov_b64 v[8:9], 0
    v_mov_b64 v[10:11], 0
    s_waitcnt vmcnt(4)
    v_bitop3_b32 v78, v12, v14, s69 bitop3:0x7e
    v_mfma_f32_16x16x32_bf16 v[0:3], v[4:7], v[12:15], v[0:3]
    v_or_b32 v77, v77, v78
    v_mov_b64 v[12:13], 0
    v_mov_b64 v[14:15], 0
    s_waitcnt vmcnt(3)
    v_bitop3_b32 v78, v16, v18, s69 bitop3:0x7e
    v_mfma_f32_16x16x32_bf16 v[0:3], v[4:7], v[16:19], v[0:3]
    v_or_b32 v77, v77, v78
    v_mov_b64 v[16:17], 0
    v_mov_b64 v[18:19], 0
    s_waitcnt vmcnt(2)
    v_bitop3_b32 v78, v20, v22, s69 bitop3:0x7e
    v_mfma_f32_16x16x32_bf16 v[0:3], v[4:7], v[20:23], v[0:3]
    v_bitop3_b32 v77, v77, v78, 1 bitop3:0xa8
    v_cmp_ne_u32 vcc, 0, v77
    v_mov_b64 v[20:21], 0
    v_mov_b64 v[22:23], 0
    buffer_load_dwordx4 v[40:43], v65, s[4:7], s14 offen offset:0 sc1
    buffer_load_dwordx4 v[60:63], v66, s[4:7], s14 offen offset:0 sc1
    s_cmp_eq_u64 vcc, 0
    s_cselect_b64 s[42:43], -1, 0
    v_add_f32_dpp v0, v0, v0 row_ror:4 row_mask:0xf bank_mask:0xf
    v_add_f32_dpp v1, v1, v1 row_ror:4 row_mask:0xf bank_mask:0xf
    s_nop 0
    v_add_f32_dpp v0, v0, v0 row_ror:8 row_mask:0xf bank_mask:0xf
    v_add_f32_dpp v1, v1, v1 row_ror:8 row_mask:0xf bank_mask:0xf
    s_mov_b64 exec, s[42:43]
    v_cvt_pk_bf16_f32 v72, v0, v1
    v_bfi_b32 v72, v79, s70, v72
    buffer_store_dword v72, v75, s[4:7], s17 offen offset:0 sc1
    buffer_store_dword v72, v75, s[4:7], s17 offen offset:1024 sc1
    buffer_store_dword v72, v75, s[4:7], s17 offen offset:2048 sc1
    buffer_store_dword v72, v75, s[4:7], s17 offen offset:3072 sc1
    s_mov_b64 exec, -1
    s_cbranch_scc0 cs_f2_retry
cs_f2_go:
    v_mov_b64 v[0:1], 0
    v_mov_b64 v[2:3], 0
    v_mov_b64 v[4:5], 0
    v_mov_b64 v[6:7], 0
    s_nop 2
    v_mov_b32 v79, v79
    s_nop 2
    v_mov_b32 v79, v79
    s_nop 2
    v_mov_b32 v79, v79
    s_nop 2
    v_mov_b32 v79, v79
    s_nop 2
    v_mov_b32 v79, v79
    s_nop 2
    v_mov_b32 v79, v79
    s_nop 2
    v_mov_b32 v79, v79
    s_nop 2
    v_mov_b32 v79, v79
    s_nop 2
    v_mov_b32 v79, v79
    s_nop 2
    v_mov_b32 v79, v79
    s_nop 2
    v_mov_b32 v79, v79
    s_nop 2
    v_mov_b32 v79, v79
    s_nop 2
    v_mov_b32 v79, v79
    s_nop 2
    v_mov_b32 v79, v79
    s_nop 2
    v_mov_b32 v79, v79
    s_nop 2
    v_mov_b32 v79, v79
    s_nop 2
    v_mov_b32 v79, v79
    s_nop 2
    v_mov_b32 v79, v79
    s_nop 2
    v_mov_b32 v79, v79
    s_nop 2
    v_mov_b32 v79, v79
    s_nop 2
    v_mov_b32 v79, v79
    s_nop 2
    v_mov_b32 v79, v79
    s_nop 2
    v_mov_b32 v79, v79
    s_nop 2
    v_mov_b32 v79, v79
    s_nop 2
    v_mov_b32 v79, v79
    s_branch cs_loop
cs_f1:
    s_cmp_lg_u32 s32, 1
    s_cbranch_scc1 cs_f3
    v_and_b32 v77, 255, v69
    ds_read_b128 v[4:7], v77 offset:15872
    ds_read_b128 v[44:47], v70 offset:0
    ds_read_b128 v[48:51], v70 offset:1024
    ds_read_b128 v[52:55], v70 offset:2048
    ds_read_b128 v[56:59], v70 offset:3072
    ds_read_b128 v[24:27], v70 offset:4096
    ds_read_b128 v[28:31], v70 offset:5120
    ds_read_b128 v[32:35], v70 offset:6144
    ds_read_b128 v[36:39], v70 offset:7168
    s_mov_b32 s31, 65536
    s_add_u32 s24, s24, 524288
    s_add_u32 s26, s26, 524288
    s_add_u32 s55, s55, s57
    s_mov_b32 s14, 67633152
    s_mov_b32 s15, 67637248
    s_mov_b32 s16, 67641344
    s_mov_b32 s36, 1
    v_mov_b32 v40, s69
    v_mov_b32 v60, s69
    v_and_b32 v79, 12, v75
    v_cmp_eq_u32 vcc, 0, v79
    s_nop 1
    v_cndmask_b32 v79, 0, 1, vcc
    s_cmp_lg_u32 s37, 0
    s_cbranch_scc1 cs_f1_xt
cs_f1_xtx:
    s_nop 2
    v_mov_b32 v79, v79
    s_nop 2
    v_mov_b32 v79, v79
    s_nop 2
    v_mov_b32 v79, v79
    s_nop 2
    v_mov_b32 v79, v79
    s_nop 2
    v_mov_b32 v79, v79
    s_nop 2
    v_mov_b32 v79, v79
    s_nop 2
    v_mov_b32 v79, v79
    s_nop 2
    v_mov_b32 v79, v79
    s_nop 2
    v_mov_b32 v79, v79
    s_nop 2
    v_mov_b32 v79, v79
    s_nop 2
    v_mov_b32 v79, v79
    s_nop 2
    v_mov_b32 v79, v79
    s_nop 2
    v_mov_b32 v79, v79
    s_nop 2
    v_mov_b32 v79, v79
    s_nop 2
    v_mov_b32 v79, v79
    s_nop 2
    v_mov_b32 v79, v79
    s_nop 2
    v_mov_b32 v79, v79
    s_nop 2
    v_mov_b32 v79, v79
    s_nop 2
    v_mov_b32 v79, v79
    s_nop 2
    v_mov_b32 v79, v79
    s_nop 2
    v_mov_b32 v79, v79
    s_nop 2
    v_mov_b32 v79, v79
    s_nop 2
    v_mov_b32 v79, v79
    s_nop 2
    v_mov_b32 v79, v79
    s_nop 2
    v_mov_b32 v79, v79
    s_nop 2
    v_mov_b32 v79, v79
    s_nop 2
    v_mov_b32 v79, v79
    s_nop 2
    v_mov_b32 v79, v79
    s_nop 2
    v_mov_b32 v79, v79
    s_nop 2
    v_mov_b32 v79, v79
    s_nop 2
    v_mov_b32 v79, v79
    s_nop 2
    v_mov_b32 v79, v79
    s_nop 2
    v_mov_b32 v79, v79
    s_nop 2
    v_mov_b32 v79, v79
    s_nop 2
    v_mov_b32 v79, v79
    s_nop 2
    v_mov_b32 v79, v79
    s_nop 0
    v_mov_b32 v79, v79
    s_waitcnt vmcnt(0)
    buffer_load_dwordx4 v[8:11], v65, s[4:7], s18 offen sc1
    buffer_load_dwordx4 v[12:15], v65, s[4:7], s19 offen sc1
    buffer_load_dwordx4 v[16:19], v65, s[4:7], s20 offen sc1
    buffer_load_dwordx4 v[20:23], v65, s[4:7], s21 offen sc1
    s_nop 2
    v_mov_b32 v79, v79
    s_nop 2
    v_mov_b32 v79, v79
    s_nop 2
    v_mov_b32 v79, v79
    s_nop 2
    v_mov_b32 v79, v79
    s_nop 2
    v_mov_b32 v79, v79
    s_nop 2
    v_mov_b32 v79, v79
    s_nop 2
    v_mov_b32 v79, v79
    s_nop 2
    v_mov_b32 v79, v79
    s_nop 2
    v_mov_b32 v79, v79
    s_nop 2
    v_mov_b32 v79, v79
    buffer_load_dwordx4 v[40:43], v65, s[4:7], s14 offen offset:0 sc1
    buffer_load_dwordx4 v[60:63], v66, s[4:7], s14 offen offset:0 sc1
    s_waitcnt lgkmcnt(0)
    s_waitcnt vmcnt(5)
    v_bitop3_b32 v77, v8, v10, s69 bitop3:0x7e
    v_mfma_f32_16x16x32_bf16 v[0:3], v[4:7], v[8:11], 0
    v_mov_b64 v[8:9], 0
    v_mov_b64 v[10:11], 0
    s_waitcnt vmcnt(4)
    v_bitop3_b32 v78, v12, v14, s69 bitop3:0x7e
    v_mfma_f32_16x16x32_bf16 v[0:3], v[4:7], v[12:15], v[0:3]
    v_or_b32 v77, v77, v78
    v_mov_b64 v[12:13], 0
    v_mov_b64 v[14:15], 0
    s_waitcnt vmcnt(3)
    v_bitop3_b32 v78, v16, v18, s69 bitop3:0x7e
    v_mfma_f32_16x16x32_bf16 v[0:3], v[4:7], v[16:19], v[0:3]
    v_or_b32 v77, v77, v78
    v_mov_b64 v[16:17], 0
    v_mov_b64 v[18:19], 0
    s_waitcnt vmcnt(2)
    v_bitop3_b32 v78, v20, v22, s69 bitop3:0x7e
    v_mfma_f32_16x16x32_bf16 v[0:3], v[4:7], v[20:23], v[0:3]
    v_bitop3_b32 v77, v77, v78, 1 bitop3:0xa8
    v_cmp_ne_u32 vcc, 0, v77
    v_mov_b64 v[20:21], 0
    v_mov_b64 v[22:23], 0
    buffer_load_dwordx4 v[40:43], v65, s[4:7], s14 offen offset:0 sc1
    buffer_load_dwordx4 v[60:63], v66, s[4:7], s14 offen offset:0 sc1
    s_cmp_eq_u64 vcc, 0
    s_cselect_b64 s[42:43], -1, 0
    v_add_f32_dpp v0, v0, v0 row_ror:8 row_mask:0xf bank_mask:0xf
    v_add_f32_dpp v1, v1, v1 row_ror:8 row_mask:0xf bank_mask:0xf
    s_mov_b64 exec, s[42:43]
    v_cvt_pk_bf16_f32 v72, v0, v1
    v_bfi_b32 v72, v79, s70, v72
    buffer_store_dword v72, v75, s[4:7], s17 offen offset:0 sc1
    s_mov_b64 exec, -1
    s_cbranch_scc0 cs_f1_retry
cs_f1_go:
    v_mov_b64 v[0:1], 0
    v_mov_b64 v[2:3], 0
    v_mov_b64 v[4:5], 0
    v_mov_b64 v[6:7], 0
    s_nop 2
    v_mov_b32 v79, v79
    s_nop 2
    v_mov_b32 v79, v79
    s_nop 2
    v_mov_b32 v79, v79
    s_nop 2
    v_mov_b32 v79, v79
    s_nop 2
    v_mov_b32 v79, v79
    s_nop 2
    v_mov_b32 v79, v79
    s_nop 2
    v_mov_b32 v79, v79
    s_nop 2
    v_mov_b32 v79, v79
    s_nop 2
    v_mov_b32 v79, v79
    s_nop 2
    v_mov_b32 v79, v79
    s_nop 2
    v_mov_b32 v79, v79
    s_nop 2
    v_mov_b32 v79, v79
    s_nop 2
    v_mov_b32 v79, v79
    s_nop 2
    v_mov_b32 v79, v79
    s_nop 2
    v_mov_b32 v79, v79
    s_nop 2
    v_mov_b32 v79, v79
    s_nop 2
    v_mov_b32 v79, v79
    s_nop 2
    v_mov_b32 v79, v79
    s_nop 2
    v_mov_b32 v79, v79
    s_nop 2
    v_mov_b32 v79, v79
    s_nop 2
    v_mov_b32 v79, v79
    s_nop 2
    v_mov_b32 v79, v79
    s_nop 2
    v_mov_b32 v79, v79
    s_nop 2
    v_mov_b32 v79, v79
    s_nop 2
    v_mov_b32 v79, v79
    s_branch cs_loop
cs_f3:
    v_and_b32 v77, 255, v69
    ds_read_b128 v[4:7], v77 offset:15872
    ds_read_b128 v[44:47], v70 offset:0
    ds_read_b128 v[48:51], v70 offset:1024
    ds_read_b128 v[52:55], v70 offset:2048
    ds_read_b128 v[56:59], v70 offset:3072
    ds_read_b128 v[24:27], v70 offset:4096
    ds_read_b128 v[28:31], v70 offset:5120
    ds_read_b128 v[32:35], v70 offset:6144
    ds_read_b128 v[36:39], v70 offset:7168
    s_mov_b32 s31, 65536
    s_add_u32 s24, s24, 524288
    s_add_u32 s26, s26, 524288
    s_add_u32 s55, s55, s57
    s_mov_b32 s14, 67633152
    s_mov_b32 s15, 67637248
    s_mov_b32 s16, 67641344
    s_mov_b32 s36, 1
    v_mov_b32 v40, s69
    v_mov_b32 v60, s69
    v_and_b32 v79, 12, v75
    v_cmp_eq_u32 vcc, 0, v79
    s_nop 1
    v_cndmask_b32 v79, 0, 1, vcc
    s_add_u32 s40, s30, s95
    v_mov_b32 v72, s40
    s_waitcnt lgkmcnt(0)
    v_mov_b64 v[0:1], 0
    v_mov_b64 v[2:3], 0
    v_mov_b64 v[4:5], 0
    v_mov_b64 v[6:7], 0
    v_mov_b64 v[8:9], 0
    v_mov_b64 v[10:11], 0
    v_mov_b64 v[12:13], 0
    v_mov_b64 v[14:15], 0
    v_mov_b64 v[16:17], 0
    v_mov_b64 v[18:19], 0
    v_mov_b64 v[20:21], 0
    v_mov_b64 v[22:23], 0
    s_nop 2
    v_mov_b32 v79, v79
    s_nop 2
    v_mov_b32 v79, v79
    s_nop 2
    v_mov_b32 v79, v79
    s_nop 2
    v_mov_b32 v79, v79
    s_nop 2
    v_mov_b32 v79, v79
    s_nop 2
    v_mov_b32 v79, v79
    s_nop 2
    v_mov_b32 v79, v79
    s_nop 2
    v_mov_b32 v79, v79
    s_nop 2
    v_mov_b32 v79, v79
    s_nop 2
    v_mov_b32 v79, v79
    s_nop 2
    v_mov_b32 v79, v79
    s_nop 2
    v_mov_b32 v79, v79
    s_nop 2
    v_mov_b32 v79, v79
    s_nop 2
    v_mov_b32 v79, v79
    s_nop 2
    v_mov_b32 v79, v79
    s_nop 2
    v_mov_b32 v79, v79
    s_nop 2
    v_mov_b32 v79, v79
    s_nop 2
    v_mov_b32 v79, v79
    s_nop 2
    v_mov_b32 v79, v79
    s_nop 2
    v_mov_b32 v79, v79
    s_nop 2
    v_mov_b32 v79, v79
    s_nop 2
    v_mov_b32 v79, v79
    s_nop 2
    v_mov_b32 v79, v79
    s_nop 2
    v_mov_b32 v79, v79
    s_nop 2
    v_mov_b32 v79, v79
    s_nop 2
    v_mov_b32 v79, v79
    s_nop 2
    v_mov_b32 v79, v79
    s_nop 2
    v_mov_b32 v79, v79
    s_nop 2
    v_mov_b32 v79, v79
    s_nop 2
    v_mov_b32 v79, v79
    s_nop 2
    v_mov_b32 v79, v79
    s_nop 2
    v_mov_b32 v79, v79
    s_nop 2
    v_mov_b32 v79, v79
    s_nop 2
    v_mov_b32 v79, v79
    s_nop 2
    v_mov_b32 v79, v79
    s_nop 2
    v_mov_b32 v79, v79
    s_nop 2
    v_mov_b32 v79, v79
    s_nop 2
    v_mov_b32 v79, v79
    s_nop 2
    v_mov_b32 v79, v79
    s_nop 2
    v_mov_b32 v79, v79
    s_nop 2
    v_mov_b32 v79, v79
    s_nop 2
    v_mov_b32 v79, v79
    s_nop 2
    v_mov_b32 v79, v79
    s_nop 2
    v_mov_b32 v79, v79
    s_nop 2
    v_mov_b32 v79, v79
    s_nop 2
    v_mov_b32 v79, v79
    s_nop 2
    v_mov_b32 v79, v79
    s_nop 2
    v_mov_b32 v79, v79
    s_nop 2
    v_mov_b32 v79, v79
    s_nop 2
    v_mov_b32 v79, v79
    s_nop 2
    v_mov_b32 v79, v79
    s_nop 2
    v_mov_b32 v79, v79
    s_nop 2
    v_mov_b32 v79, v79
    s_nop 2
    v_mov_b32 v79, v79
    s_nop 2
    v_mov_b32 v79, v79
    s_nop 2
    v_mov_b32 v79, v79
    s_nop 2
    v_mov_b32 v79, v79
    s_nop 2
    v_mov_b32 v79, v79
    s_nop 2
    v_mov_b32 v79, v79
    s_nop 2
    v_mov_b32 v79, v79
    s_nop 2
    v_mov_b32 v79, v79
    s_nop 2
    v_mov_b32 v79, v79
    s_nop 2
    v_mov_b32 v79, v79
    s_nop 2
    v_mov_b32 v79, v79
    s_nop 2
    v_mov_b32 v79, v79
    s_waitcnt vmcnt(0)
    s_cmp_lt_u32 s97, s93
    s_cbranch_scc1 cs_kvwait
    s_nop 2
    v_mov_b32 v79, v79
    s_nop 2
    v_mov_b32 v79, v79
    s_nop 2
    v_mov_b32 v79, v79
    s_nop 2
    v_mov_b32 v79, v79
    s_nop 2
    v_mov_b32 v79, v79
    s_nop 2
    v_mov_b32 v79, v79
    s_nop 2
    v_mov_b32 v79, v79
    s_nop 2
    v_mov_b32 v79, v79
cs_kvok:
    s_branch cs_loop
cs_f0_xt:
    s_sub_u32 s37, s37, 1
    s_nop 2
    v_mov_b32 v79, v79
    s_nop 2
    v_mov_b32 v79, v79
    s_nop 2
    v_mov_b32 v79, v79
    s_nop 2
    v_mov_b32 v79, v79
    s_nop 2
    v_mov_b32 v79, v79
    s_nop 2
    v_mov_b32 v79, v79
    s_branch cs_f0_xtx
cs_f0_retry:
    s_sub_u32 s41, s30, s98
    s_mov_b32 s98, s30
    s_cmp_le_u32 s41, 3
    s_cselect_b32 s37, 1, 1
cs_f0_spin:
    buffer_load_dwordx4 v[8:11], v65, s[4:7], s18 offen sc1
    buffer_load_dwordx4 v[12:15], v65, s[4:7], s19 offen sc1
    buffer_load_dwordx4 v[16:19], v65, s[4:7], s20 offen sc1
    buffer_load_dwordx4 v[20:23], v65, s[4:7], s21 offen sc1
    s_nop 2
    v_mov_b32 v79, v79
    s_nop 2
    v_mov_b32 v79, v79
    s_nop 2
    v_mov_b32 v79, v79
    buffer_load_dwordx4 v[40:43], v65, s[4:7], s14 offen offset:0 sc1
    buffer_load_dwordx4 v[60:63], v66, s[4:7], s14 offen offset:0 sc1
    s_waitcnt vmcnt(5)
    v_bitop3_b32 v77, v8, v10, s69 bitop3:0x7e
    v_mfma_f32_16x16x32_bf16 v[0:3], v[4:7], v[8:11], 0
    v_mov_b64 v[8:9], 0
    v_mov_b64 v[10:11], 0
    s_waitcnt vmcnt(4)
    v_bitop3_b32 v78, v12, v14, s69 bitop3:0x7e
    v_mfma_f32_16x16x32_bf16 v[0:3], v[4:7], v[12:15], v[0:3]
    v_or_b32 v77, v77, v78
    v_mov_b64 v[12:13], 0
    v_mov_b64 v[14:15], 0
    s_waitcnt vmcnt(3)
    v_bitop3_b32 v78, v16, v18, s69 bitop3:0x7e
    v_mfma_f32_16x16x32_bf16 v[0:3], v[4:7], v[16:19], v[0:3]
    v_or_b32 v77, v77, v78
    v_mov_b64 v[16:17], 0
    v_mov_b64 v[18:19], 0
    s_waitcnt vmcnt(2)
    v_bitop3_b32 v78, v20, v22, s69 bitop3:0x7e
    v_mfma_f32_16x16x32_bf16 v[0:3], v[4:7], v[20:23], v[0:3]
    v_bitop3_b32 v77, v77, v78, 1 bitop3:0xa8
    v_cmp_ne_u32 vcc, 0, v77
    v_mov_b64 v[20:21], 0
    v_mov_b64 v[22:23], 0
    buffer_load_dwordx4 v[40:43], v65, s[4:7], s14 offen offset:0 sc1
    buffer_load_dwordx4 v[60:63], v66, s[4:7], s14 offen offset:0 sc1
    s_cmp_eq_u64 vcc, 0
    s_cselect_b64 s[42:43], -1, 0
    v_add_f32_dpp v0, v0, v0 row_ror:8 row_mask:0xf bank_mask:0xf
    v_add_f32_dpp v1, v1, v1 row_ror:8 row_mask:0xf bank_mask:0xf
    s_mov_b64 exec, s[42:43]
    v_cvt_pk_bf16_f32 v72, v0, v1
    v_bfi_b32 v72, v79, s70, v72
    buffer_store_dword v72, v75, s[4:7], s17 offen offset:0 sc1
    s_mov_b64 exec, -1
    s_cbranch_scc1 cs_f0_rx
    s_sub_u32 s31, s31, 1
    s_cbranch_scc0 cs_f0_spin
cs_f0_rx:
    v_mov_b64 v[0:1], 0
    v_mov_b64 v[2:3], 0
    v_mov_b64 v[4:5], 0
    v_mov_b64 v[6:7], 0
    s_branch cs_loop
cs_f1_xt:
    s_sub_u32 s37, s37, 1
    s_nop 2
    v_mov_b32 v79, v79
    s_nop 2
    v_mov_b32 v79, v79
    s_nop 2
    v_mov_b32 v79, v79
    s_nop 2
    v_mov_b32 v79, v79
    s_nop 2
    v_mov_b32 v79, v79
    s_nop 2
    v_mov_b32 v79, v79
    s_branch cs_f1_xtx
cs_f1_retry:
    s_sub_u32 s41, s30, s98
    s_mov_b32 s98, s30
    s_cmp_le_u32 s41, 3
    s_cselect_b32 s37, 1, 1
cs_f1_spin:
    buffer_load_dwordx4 v[8:11], v65, s[4:7], s18 offen sc1
    buffer_load_dwordx4 v[12:15], v65, s[4:7], s19 offen sc1
    buffer_load_dwordx4 v[16:19], v65, s[4:7], s20 offen sc1
    buffer_load_dwordx4 v[20:23], v65, s[4:7], s21 offen sc1
    s_nop 2
    v_mov_b32 v79, v79
    s_nop 2
    v_mov_b32 v79, v79
    s_nop 2
    v_mov_b32 v79, v79
    buffer_load_dwordx4 v[40:43], v65, s[4:7], s14 offen offset:0 sc1
    buffer_load_dwordx4 v[60:63], v66, s[4:7], s14 offen offset:0 sc1
    s_waitcnt vmcnt(5)
    v_bitop3_b32 v77, v8, v10, s69 bitop3:0x7e
    v_mfma_f32_16x16x32_bf16 v[0:3], v[4:7], v[8:11], 0
    v_mov_b64 v[8:9], 0
    v_mov_b64 v[10:11], 0
    s_waitcnt vmcnt(4)
    v_bitop3_b32 v78, v12, v14, s69 bitop3:0x7e
    v_mfma_f32_16x16x32_bf16 v[0:3], v[4:7], v[12:15], v[0:3]
    v_or_b32 v77, v77, v78
    v_mov_b64 v[12:13], 0
    v_mov_b64 v[14:15], 0
    s_waitcnt vmcnt(3)
    v_bitop3_b32 v78, v16, v18, s69 bitop3:0x7e
    v_mfma_f32_16x16x32_bf16 v[0:3], v[4:7], v[16:19], v[0:3]
    v_or_b32 v77, v77, v78
    v_mov_b64 v[16:17], 0
    v_mov_b64 v[18:19], 0
    s_waitcnt vmcnt(2)
    v_bitop3_b32 v78, v20, v22, s69 bitop3:0x7e
    v_mfma_f32_16x16x32_bf16 v[0:3], v[4:7], v[20:23], v[0:3]
    v_bitop3_b32 v77, v77, v78, 1 bitop3:0xa8
    v_cmp_ne_u32 vcc, 0, v77
    v_mov_b64 v[20:21], 0
    v_mov_b64 v[22:23], 0
    buffer_load_dwordx4 v[40:43], v65, s[4:7], s14 offen offset:0 sc1
    buffer_load_dwordx4 v[60:63], v66, s[4:7], s14 offen offset:0 sc1
    s_cmp_eq_u64 vcc, 0
    s_cselect_b64 s[42:43], -1, 0
    v_add_f32_dpp v0, v0, v0 row_ror:8 row_mask:0xf bank_mask:0xf
    v_add_f32_dpp v1, v1, v1 row_ror:8 row_mask:0xf bank_mask:0xf
    s_mov_b64 exec, s[42:43]
    v_cvt_pk_bf16_f32 v72, v0, v1
    v_bfi_b32 v72, v79, s70, v72
    buffer_store_dword v72, v75, s[4:7], s17 offen offset:0 sc1
    s_mov_b64 exec, -1
    s_cbranch_scc1 cs_f1_rx
    s_sub_u32 s31, s31, 1
    s_cbranch_scc0 cs_f1_spin
cs_f1_rx:
    v_mov_b64 v[0:1], 0
    v_mov_b64 v[2:3], 0
    v_mov_b64 v[4:5], 0
    v_mov_b64 v[6:7], 0
    s_branch cs_loop
cs_f2_xt:
    s_sub_u32 s37, s37, 1
    s_nop 2
    v_mov_b32 v79, v79
    s_nop 2
    v_mov_b32 v79, v79
    s_nop 2
    v_mov_b32 v79, v79
    s_nop 2
    v_mov_b32 v79, v79
    s_nop 2
    v_mov_b32 v79, v79
    s_nop 2
    v_mov_b32 v79, v79
    s_branch cs_f2_xtx
cs_f2_retry:
    s_sub_u32 s41, s30, s98
    s_mov_b32 s98, s30
    s_cmp_le_u32 s41, 3
    s_cselect_b32 s37, 1, 1
cs_f2_spin:
    buffer_load_dwordx4 v[8:11], v65, s[4:7], s18 offen sc1
    buffer_load_dwordx4 v[12:15], v65, s[4:7], s19 offen sc1
    buffer_load_dwordx4 v[16:19], v65, s[4:7], s20 offen sc1
    buffer_load_dwordx4 v[20:23], v65, s[4:7], s21 offen sc1
    s_nop 2
    v_mov_b32 v79, v79
    s_nop 2
    v_mov_b32 v79, v79
    s_nop 2
    v_mov_b32 v79, v79
    buffer_load_dwordx4 v[40:43], v65, s[4:7], s14 offen offset:0 sc1
    buffer_load_dwordx4 v[60:63], v66, s[4:7], s14 offen offset:0 sc1
    s_waitcnt vmcnt(5)
    v_bitop3_b32 v77, v8, v10, s69 bitop3:0x7e
    v_mfma_f32_16x16x32_bf16 v[0:3], v[4:7], v[8:11], 0
    v_mov_b64 v[8:9], 0
    v_mov_b64 v[10:11], 0
    s_waitcnt vmcnt(4)
    v_bitop3_b32 v78, v12, v14, s69 bitop3:0x7e
    v_mfma_f32_16x16x32_bf16 v[0:3], v[4:7], v[12:15], v[0:3]
    v_or_b32 v77, v77, v78
    v_mov_b64 v[12:13], 0
    v_mov_b64 v[14:15], 0
    s_waitcnt vmcnt(3)
    v_bitop3_b32 v78, v16, v18, s69 bitop3:0x7e
    v_mfma_f32_16x16x32_bf16 v[0:3], v[4:7], v[16:19], v[0:3]
    v_or_b32 v77, v77, v78
    v_mov_b64 v[16:17], 0
    v_mov_b64 v[18:19], 0
    s_waitcnt vmcnt(2)
    v_bitop3_b32 v78, v20, v22, s69 bitop3:0x7e
    v_mfma_f32_16x16x32_bf16 v[0:3], v[4:7], v[20:23], v[0:3]
    v_bitop3_b32 v77, v77, v78, 1 bitop3:0xa8
    v_cmp_ne_u32 vcc, 0, v77
    v_mov_b64 v[20:21], 0
    v_mov_b64 v[22:23], 0
    buffer_load_dwordx4 v[40:43], v65, s[4:7], s14 offen offset:0 sc1
    buffer_load_dwordx4 v[60:63], v66, s[4:7], s14 offen offset:0 sc1
    s_cmp_eq_u64 vcc, 0
    s_cselect_b64 s[42:43], -1, 0
    v_add_f32_dpp v0, v0, v0 row_ror:4 row_mask:0xf bank_mask:0xf
    v_add_f32_dpp v1, v1, v1 row_ror:4 row_mask:0xf bank_mask:0xf
    s_nop 0
    v_add_f32_dpp v0, v0, v0 row_ror:8 row_mask:0xf bank_mask:0xf
    v_add_f32_dpp v1, v1, v1 row_ror:8 row_mask:0xf bank_mask:0xf
    s_mov_b64 exec, s[42:43]
    v_cvt_pk_bf16_f32 v72, v0, v1
    v_bfi_b32 v72, v79, s70, v72
    buffer_store_dword v72, v75, s[4:7], s17 offen offset:0 sc1
    buffer_store_dword v72, v75, s[4:7], s17 offen offset:1024 sc1
    buffer_store_dword v72, v75, s[4:7], s17 offen offset:2048 sc1
    buffer_store_dword v72, v75, s[4:7], s17 offen offset:3072 sc1
    s_mov_b64 exec, -1
    s_cbranch_scc1 cs_f2_rx
    s_sub_u32 s31, s31, 1
    s_cbranch_scc0 cs_f2_spin
cs_f2_rx:
    v_mov_b64 v[0:1], 0
    v_mov_b64 v[2:3], 0
    v_mov_b64 v[4:5], 0
    v_mov_b64 v[6:7], 0
    s_branch cs_loop
cs_spinB:
    s_waitcnt vmcnt(3)
cs_spinB_l:
    v_and_b32 v77, s36, v44
    v_cmp_ne_u32 vcc, s70, v77
    s_cbranch_vccz cs_spinB_x
    buffer_load_dwordx4 v[44:47], v65, s[4:7], s15 offen sc1
    s_sub_u32 s31, s31, 16
    s_waitcnt vmcnt(0)
    s_cbranch_scc0 cs_spinB_l
cs_spinB_x:
    ds_write_b128 v65, v[44:47] offset:4096
    s_waitcnt lgkmcnt(0)
    s_branch cs_backB
cs_spin8:
    buffer_load_dwordx4 v[40:43], v65, s[4:7], s16 offen sc1
cs_spin8_l:
    v_and_b32 v77, s36, v40
    v_cmp_ne_u32 vcc, s70, v77
    s_cbranch_vccz cs_spin8_x
    s_nop 15
    s_nop 15
    s_nop 15
    s_nop 11
    v_and_b32 v77, s36, v40
    v_cmp_ne_u32 vcc, s70, v77
    s_cbranch_vccz cs_spin8_x
    s_nop 15
    s_nop 15
    s_nop 15
    s_nop 11
    v_and_b32 v77, s36, v40
    v_cmp_ne_u32 vcc, s70, v77
    s_cbranch_vccz cs_spin8_x
    s_nop 15
    s_nop 15
    s_nop 15
    s_nop 11
    buffer_load_dwordx4 v[40:43], v65, s[4:7], s16 offen sc1
    s_sub_u32 s31, s31, 16
    s_cbranch_scc0 cs_spin8_l
cs_spin8_x:
    s_branch cs_back8
cs_rare:
    s_mov_b64 exec, s[34:35]
    buffer_store_dwordx4 v[0:3], v65, s[4:7], s28 offen sc1
    s_mov_b64 exec, -1
    s_nop 3
    v_cvt_pk_bf16_f32 v52, v16, v17
    v_cvt_pk_bf16_f32 v53, v18, v19
    v_cvt_pk_bf16_f32 v54, v20, v21
    v_cvt_pk_bf16_f32 v55, v22, v23
    buffer_store_dwordx4 v[52:55], v65, s[4:7], s27 offen sc1
    s_add_u32 s28, s28, 131072
    s_add_u32 s27, s27, 131072
    s_cmp_eq_u32 s30, 63
    s_cbranch_scc1 cs_last
    s_branch cs_rare_x
cs_kvwait:
    s_mov_b32 s41, s97
    v_bfe_u32 v78, v65, 2, 5
    v_mov_b32 v77, v76
    s_nop 1
    v_permlane32_swap_b32 v76, v77
    v_subrev_u32 v77, s95, v77
    v_cmp_lt_u32 vcc, 16, v77
    s_nop 1
    v_cndmask_b32 v77, v77, 0, vcc
    v_bfe_u32 v79, v78, 2, 2
    v_lshl_add_u32 v77, v77, 2, v79
    s_nop 1
    v_min_u32_dpp v77, v77, v77 row_ror:1 row_mask:0xf bank_mask:0xf
    s_nop 1
    v_min_u32_dpp v77, v77, v77 row_ror:2 row_mask:0xf bank_mask:0xf
    s_nop 1
    v_min_u32_dpp v77, v77, v77 row_ror:4 row_mask:0xf bank_mask:0xf
    s_nop 0
    v_readfirstlane_b32 s97, v77
    s_nop 0
    s_max_u32 s97, s97, s41
    s_add_u32 s40, s30, 3
    s_min_u32 s40, s40, 64
    s_cmp_le_u32 s40, s97
    s_cbranch_scc1 cs_kvw_x
    v_bfe_u32 v78, v65, 2, 5
    s_mov_b32 s31, 4194304
cs_kvw:
    buffer_load_dword v77, v78, s[4:7], s96 offen offset:16 sc1
    s_waitcnt vmcnt(0)
    v_subrev_u32 v77, s95, v77
    v_cmp_lt_u32 vcc, 16, v77
    s_nop 1
    v_cndmask_b32 v77, v77, 0, vcc
    v_bfe_u32 v79, v78, 2, 2
    v_lshl_add_u32 v77, v77, 2, v79
    s_nop 1
    v_min_u32_dpp v77, v77, v77 row_ror:1 row_mask:0xf bank_mask:0xf
    s_nop 1
    v_min_u32_dpp v77, v77, v77 row_ror:2 row_mask:0xf bank_mask:0xf
    s_nop 1
    v_min_u32_dpp v77, v77, v77 row_ror:4 row_mask:0xf bank_mask:0xf
    s_nop 0
    v_readfirstlane_b32 s97, v77
    s_sub_u32 s31, s31, 1
    s_cbranch_scc1 cs_kvw_x
    s_cmp_le_u32 s40, s97
    s_cbranch_scc1 cs_kvw_x
    s_sleep 2
    s_branch cs_kvw
cs_kvw_x:
    s_branch cs_kvok
cs_last:
    s_add_u32 s40, s95, 64
    v_mov_b32 v78, s40
    s_waitcnt vmcnt(0)
    s_barrier
    s_mov_b64 exec, s[100:101]
    buffer_store_dword v78, off, s[4:7], s29 sc1
    s_mov_b64 exec, -1
cs_end:
    s_endpgm
L_xform:
    v_and_b32 v1, 63, v0
    v_and_b32 v2, 15, v1
    v_lshrrev_b32 v3, 4, v1
    v_mov_b32 v7, 0x05040100
    v_mov_b32 v8, 0x07060302
    v_lshrrev_b32 v9, 6, v0
    v_lshlrev_b32 v9, 14, v9
    v_lshlrev_b32 v10, 4, v1
    v_add_u32 v11, v9, v10
    s_mov_b32 s10, 4718592
    s_mov_b32 s11, 0x20000
    s_mov_b64 s[8:9], s[58:59]
xf_f:
    s_sub_u32 s17, s16, 1504
    s_and_b32 s18, s17, 127
    s_lshr_b32 s17, s17, 7
    s_lshl_b32 s19, s17, 4
    v_add_u32 v6, s19, v2
    v_mul_u32_u24 v4, 9216, v3
    v_lshl_add_u32 v4, v6, 4, v4
    v_lshrrev_b32 v5, 2, v2
    v_lshlrev_b32 v5, 11, v5
    v_lshl_add_u32 v5, v3, 8, v5
    v_and_b32 v1, 3, v6
    v_lshl_add_u32 v5, v1, 6, v5
    v_add_u32 v5, v5, v9
    v_cmp_gt_u32 vcc, 72, v6
    s_nop 0
    s_mov_b64 exec, vcc
    s_mul_i32 s20, s18, 36864
    s_add_u32 s21, s20, 0
    buffer_load_dwordx4 v[12:15], v4, s[8:11], s21 offen
    s_add_u32 s21, s20, 1152
    buffer_load_dwordx4 v[16:19], v4, s[8:11], s21 offen
    s_add_u32 s21, s20, 2304
    buffer_load_dwordx4 v[20:23], v4, s[8:11], s21 offen
    s_add_u32 s21, s20, 3456
    buffer_load_dwordx4 v[24:27], v4, s[8:11], s21 offen
    s_add_u32 s21, s20, 4608
    buffer_load_dwordx4 v[28:31], v4, s[8:11], s21 offen
    s_add_u32 s21, s20, 5760
    buffer_load_dwordx4 v[32:35], v4, s[8:11], s21 offen
    s_add_u32 s21, s20, 6912
    buffer_load_dwordx4 v[36:39], v4, s[8:11], s21 offen
    s_add_u32 s21, s20, 8064
    buffer_load_dwordx4 v[40:43], v4, s[8:11], s21 offen
    s_lshl_b32 s20, s18, 11
    s_add_u32 s20, s20, 130023424
    s_waitcnt vmcnt(0)
    v_perm_b32 v76, v16, v12, v7
    v_perm_b32 v77, v24, v20, v7
    v_perm_b32 v78, v32, v28, v7
    v_perm_b32 v79, v40, v36, v7
    ds_write_b128 v5, v[76:79] offset:0
    v_perm_b32 v80, v17, v13, v7
    v_perm_b32 v81, v25, v21, v7
    v_perm_b32 v82, v33, v29, v7
    v_perm_b32 v83, v41, v37, v7
    ds_write_b128 v5, v[80:83] offset:16
    v_perm_b32 v84, v18, v14, v7
    v_perm_b32 v85, v26, v22, v7
    v_perm_b32 v86, v34, v30, v7
    v_perm_b32 v87, v42, v38, v7
    ds_write_b128 v5, v[84:87] offset:32
    v_perm_b32 v88, v19, v15, v7
    v_perm_b32 v89, v27, v23, v7
    v_perm_b32 v90, v35, v31, v7
    v_perm_b32 v91, v43, v39, v7
    ds_write_b128 v5, v[88:91] offset:48
    v_perm_b32 v92, v16, v12, v8
    v_perm_b32 v93, v24, v20, v8
    v_perm_b32 v94, v32, v28, v8
    v_perm_b32 v95, v40, v36, v8
    ds_write_b128 v5, v[92:95] offset:1024
    v_perm_b32 v96, v17, v13, v8
    v_perm_b32 v97, v25, v21, v8
    v_perm_b32 v98, v33, v29, v8
    v_perm_b32 v99, v41, v37, v8
    ds_write_b128 v5, v[96:99] offset:1040
    v_perm_b32 v100, v18, v14, v8
    v_perm_b32 v101, v26, v22, v8
    v_perm_b32 v102, v34, v30, v8
    v_perm_b32 v103, v42, v38, v8
    ds_write_b128 v5, v[100:103] offset:1056
    v_perm_b32 v104, v19, v15, v8
    v_perm_b32 v105, v27, v23, v8
    v_perm_b32 v106, v35, v31, v8
    v_perm_b32 v107, v43, v39, v8
    ds_write_b128 v5, v[104:107] offset:1072
    s_mov_b64 exec, -1
    s_lshl_b32 s21, s17, 20
    s_add_u32 s20, s20, s21
    s_waitcnt lgkmcnt(0)
    ds_read_b128 v[76:79], v11 offset:0
    ds_read_b128 v[80:83], v11 offset:1024
    ds_read_b128 v[84:87], v11 offset:2048
    ds_read_b128 v[88:91], v11 offset:3072
    ds_read_b128 v[92:95], v11 offset:4096
    ds_read_b128 v[96:99], v11 offset:5120
    ds_read_b128 v[100:103], v11 offset:6144
    ds_read_b128 v[104:107], v11 offset:7168
    s_add_u32 s19, s20, 0
    s_waitcnt lgkmcnt(7)
    buffer_store_dwordx4 v[76:79], v10, s[4:7], s19 offen sc1
    s_add_u32 s19, s20, 1024
    s_waitcnt lgkmcnt(6)
    buffer_store_dwordx4 v[80:83], v10, s[4:7], s19 offen sc1
    s_add_u32 s19, s20, 262144
    s_waitcnt lgkmcnt(5)
    buffer_store_dwordx4 v[84:87], v10, s[4:7], s19 offen sc1
    s_add_u32 s19, s20, 263168
    s_waitcnt lgkmcnt(4)
    buffer_store_dwordx4 v[88:91], v10, s[4:7], s19 offen sc1
    s_add_u32 s19, s20, 524288
    s_waitcnt lgkmcnt(3)
    buffer_store_dwordx4 v[92:95], v10, s[4:7], s19 offen sc1
    s_add_u32 s19, s20, 525312
    s_waitcnt lgkmcnt(2)
    buffer_store_dwordx4 v[96:99], v10, s[4:7], s19 offen sc1
    s_add_u32 s19, s20, 786432
    s_waitcnt lgkmcnt(1)
    buffer_store_dwordx4 v[100:103], v10, s[4:7], s19 offen sc1
    s_add_u32 s19, s20, 787456
    s_waitcnt lgkmcnt(0)
    buffer_store_dwordx4 v[104:107], v10, s[4:7], s19 offen sc1
xf_done:
    s_nop 1
    s_setpc_b64 s[46:47]
L_helper:
    s_load_dwordx16 s[64:79], s[0:1], 64
    s_waitcnt lgkmcnt(0)
    s_mov_b32 s93, 1000
    s_mov_b32 s95, 0
    s_cmp_lg_u32 s3, 2
    s_cbranch_scc1 L_qkv_next
    s_mov_b32 s37, 24
    v_mov_b32 v250, 1
    v_mov_b32 v251, 163832
    v_cmp_eq_u32 vcc, 0, v0
    s_nop 0
    s_and_saveexec_b64 s[38:39], vcc
    s_cbranch_execz tk3
    buffer_atomic_add v250, off, s[84:87], s37 sc0
    s_waitcnt vmcnt(0)
    ds_write_b32 v251, v250
    s_waitcnt lgkmcnt(0)
tk3:
    s_mov_b64 exec, -1
    s_barrier
    ds_read_b32 v252, v251
    s_waitcnt lgkmcnt(0)
    v_readfirstlane_b32 s36, v252
    s_barrier
    s_nop 3
    s_cmp_ge_u32 s36, 32
    s_cbranch_scc1 L_qkv_next
    s_mov_b32 s93, 0
    s_cmp_eq_u32 s36, 0
    s_cbranch_scc1 L_relay
    s_branch L_wf_next
L_qkv_next:
    s_sub_u32 s46, s3, 2
    s_cmp_lt_u32 s3, 2
    s_cselect_b32 s46, s3, s46
    s_cmp_lt_u32 s46, 6
    s_cselect_b32 s46, s46, 0
    s_mov_b32 s47, 6
L_qq:
    s_lshl_b32 s40, s46, 2
    s_add_u32 s40, s40, 32
    s_mov_b32 s37, s40
    v_mov_b32 v250, 1
    v_mov_b32 v251, 163832
    v_cmp_eq_u32 vcc, 0, v0
    s_nop 0
    s_and_saveexec_b64 s[38:39], vcc
    s_cbranch_execz tk4
    buffer_atomic_add v250, off, s[84:87], s37 sc0
    s_waitcnt vmcnt(0)
    ds_write_b32 v251, v250
    s_waitcnt lgkmcnt(0)
tk4:
    s_mov_b64 exec, -1
    s_barrier
    ds_read_b32 v252, v251
    s_waitcnt lgkmcnt(0)
    v_readfirstlane_b32 s36, v252
    s_barrier
    s_nop 3
    s_or_b32 s37, s36, s32
    s_cbranch_scc1 L_non
    s_memrealtime s[90:91]
    s_waitcnt lgkmcnt(0)
    s_lshl_b32 s90, s90, 8
    s_or_b32 s90, s90, 1
    v_mov_b32 v250, s90
    v_mov_b32 v251, 0
    s_mov_b64 exec, 1
    buffer_atomic_cmpswap v[250:251], off, s[84:87], 0 offset:216
    s_mov_b64 exec, -1
L_non:
    s_cmp_lt_u32 s36, 32
    s_cbranch_scc1 L_qkv
    s_add_u32 s46, s46, 1
    s_cmp_lt_u32 s46, 6
    s_cselect_b32 s46, s46, 0
    s_sub_u32 s47, s47, 1
    s_cmp_lg_u32 s47, 0
    s_cbranch_scc1 L_qq
    s_mov_b32 s37, 4
    v_mov_b32 v250, 1
    v_mov_b32 v251, 163832
    v_cmp_eq_u32 vcc, 0, v0
    s_nop 0
    s_and_saveexec_b64 s[38:39], vcc
    s_cbranch_execz tk5
    buffer_atomic_add v250, off, s[84:87], s37 sc0
    s_waitcnt vmcnt(0)
    ds_write_b32 v251, v250
    s_waitcnt lgkmcnt(0)
tk5:
    s_mov_b64 exec, -1
    s_barrier
    ds_read_b32 v252, v251
    s_waitcnt lgkmcnt(0)
    v_readfirstlane_b32 s45, v252
    s_barrier
    s_nop 3
    s_cmp_lg_u32 s95, 0
    s_cbranch_scc1 L_hn
    s_mov_b32 s88, 4194304
gn6:
    buffer_load_dword v250, off, s[84:87], 0 offset:216 sc1
    s_waitcnt vmcnt(0)
    v_readfirstlane_b32 s95, v250
    s_sub_u32 s88, s88, 1
    s_cbranch_scc1 gn6x
    s_cmp_eq_u32 s95, 0
    s_cbranch_scc1 gn6
gn6x:
L_hn:
    s_cmp_lg_u32 s45, 0
    s_cbranch_scc1 L_phase2
    s_mov_b32 s37, 24
    v_mov_b32 v250, 1
    v_mov_b32 v251, 163832
    v_cmp_eq_u32 vcc, 0, v0
    s_nop 0
    s_and_saveexec_b64 s[38:39], vcc
    s_cbranch_execz tk7
    buffer_atomic_add v250, off, s[84:87], s37 sc0
    s_waitcnt vmcnt(0)
    ds_write_b32 v251, v250
    s_waitcnt lgkmcnt(0)
tk7:
    s_mov_b64 exec, -1
    s_barrier
    ds_read_b32 v252, v251
    s_waitcnt lgkmcnt(0)
    v_readfirstlane_b32 s36, v252
    s_barrier
    s_nop 3
    s_cmp_lg_u32 s36, 0
    s_cbranch_scc1 L_phase2
L_relay:
    s_cmp_lg_u32 s32, 0
    s_cbranch_scc1 L_exit
    s_sleep 100
    s_mov_b32 s88, 4194304
gn8:
    buffer_load_dword v250, off, s[84:87], 0 offset:216 sc1
    s_waitcnt vmcnt(0)
    v_readfirstlane_b32 s95, v250
    s_sub_u32 s88, s88, 1
    s_cbranch_scc1 gn8x
    s_cmp_eq_u32 s95, 0
    s_cbranch_scc1 gn8
gn8x:
    v_and_b32 v3, 31, v0
    v_lshlrev_b32 v3, 7, v3
    s_mov_b32 s17, 0
    s_mov_b32 s23, 125845504
    s_mov_b32 s24, 125853696
    s_mov_b32 s21, 16777216
rl_rwait:
    buffer_load_dword v4, v3, s[4:7], s23 offen sc1
    s_waitcnt vmcnt(0)
    v_subrev_u32 v4, s95, v4
    v_cmp_lt_u32 vcc, 64, v4
    s_nop 1
    v_cndmask_b32 v4, v4, 0, vcc
    s_nop 1
    v_min_u32_dpp v4, v4, v4 row_ror:1 row_mask:0xf bank_mask:0xf
    s_nop 1
    v_min_u32_dpp v4, v4, v4 row_ror:2 row_mask:0xf bank_mask:0xf
    s_nop 1
    v_min_u32_dpp v4, v4, v4 row_ror:4 row_mask:0xf bank_mask:0xf
    s_nop 1
    v_min_u32_dpp v4, v4, v4 row_ror:8 row_mask:0xf bank_mask:0xf
    s_nop 0
    v_readlane_b32 s16, v4, 0
    v_readlane_b32 s22, v4, 16
    s_nop 0
    s_min_u32 s16, s16, s22
    s_sub_u32 s21, s21, 1
    s_cbranch_scc1 rl_x
    s_cmp_gt_u32 s16, s17
    s_cbranch_scc1 rl_rpub
    s_sleep 2
    s_branch rl_rwait
rl_rpub:
    s_mov_b32 s17, s16
    s_add_u32 s22, s16, s95
    v_mov_b32 v4, s22
    s_mov_b64 exec, 1
    buffer_store_dword v4, off, s[4:7], s24 sc1
    s_mov_b64 exec, -1
    s_cmp_lt_u32 s16, 64
    s_cbranch_scc1 rl_rwait
rl_x:
    s_endpgm
L_qkv:
    s_and_b32 s37, s36, 3
    s_lshr_b32 s36, s36, 2
    s_lshl_b32 s40, s46, 3
    s_add_u32 s36, s36, s40
    s_lshr_b32 s40, s36, 4
    s_and_b32 s36, s36, 15
    s_lshl_b32 s41, s37, 1
    s_add_u32 s41, s41, s40
    s_add_u32 s37, s37, 8
    s_cmp_eq_u32 s40, 2
    s_cselect_b32 s41, s37, s41
    s_lshl_b32 s41, s41, 4
    s_add_u32 s36, s36, s41
    s_sub_u32 s33, s36, 32
    s_and_b32 s17, s36, 15
    s_lshl_b32 s17, s17, 1
    s_lshr_b32 s36, s36, 4
    s_and_b32 s16, s36, 1
    s_add_u32 s16, s16, 1
    s_lshr_b32 s19, s36, 1
    s_and_b32 s37, s36, 3
    s_cmp_ge_u32 s36, 8
    s_cselect_b32 s16, 0, s16
    s_cselect_b32 s19, s37, s19
    v_lshrrev_b32 v4, 6, v0
    s_nop 0
    v_readfirstlane_b32 s18, v4
    v_lshlrev_b32 v7, 4, v0
    s_cmp_eq_u32 s16, 1
    s_cselect_b64 s[12:13], s[54:55], s[52:53]
    s_cmp_eq_u32 s16, 2
    s_cselect_b64 s[12:13], s[56:57], s[12:13]
    s_mov_b32 s14, 4718592
    s_mov_b32 s15, 0x20000
    v_bfe_u32 v4, v0, 5, 1
    v_lshlrev_b32 v5, 2, v4
    v_and_b32 v8, 31, v0
    v_xor_b32 v8, v8, v5
    v_lshlrev_b32 v8, 4, v8
    v_lshl_add_u32 v8, v4, 13, v8
    v_xor_b32 v9, 128, v8
    s_lshl_b32 s21, s17, 8
    s_lshl_b32 s42, s18, 16
    s_add_u32 s42, s42, s21
    s_lshl_b32 s44, s18, 12
    s_barrier
    s_add_u32 m0, s44, 73728
    s_add_u32 s22, s42, 0
    buffer_load_dwordx4 v8, s[12:15], s22 offen offset:0 lds
    s_add_u32 s22, s42, 15360
    buffer_load_dwordx4 v9, s[12:15], s22 offen offset:1024 lds
    s_add_u32 s22, s42, 30720
    buffer_load_dwordx4 v8, s[12:15], s22 offen offset:2048 lds
    s_add_u32 s22, s42, 46080
    buffer_load_dwordx4 v9, s[12:15], s22 offen offset:3072 lds
    s_add_u32 m0, s44, 90112
    s_add_u32 s22, s42, 262144
    buffer_load_dwordx4 v8, s[12:15], s22 offen offset:0 lds
    s_add_u32 s22, s42, 277504
    buffer_load_dwordx4 v9, s[12:15], s22 offen offset:1024 lds
    s_add_u32 s22, s42, 292864
    buffer_load_dwordx4 v8, s[12:15], s22 offen offset:2048 lds
    s_add_u32 s22, s42, 308224
    buffer_load_dwordx4 v9, s[12:15], s22 offen offset:3072 lds
    s_add_u32 m0, s44, 106496
    s_add_u32 s22, s42, 524288
    buffer_load_dwordx4 v8, s[12:15], s22 offen offset:0 lds
    s_add_u32 s22, s42, 539648
    buffer_load_dwordx4 v9, s[12:15], s22 offen offset:1024 lds
    s_add_u32 s22, s42, 555008
    buffer_load_dwordx4 v8, s[12:15], s22 offen offset:2048 lds
    s_add_u32 s22, s42, 570368
    buffer_load_dwordx4 v9, s[12:15], s22 offen offset:3072 lds
    s_add_u32 m0, s44, 122880
    s_add_u32 s22, s42, 786432
    buffer_load_dwordx4 v8, s[12:15], s22 offen offset:0 lds
    s_add_u32 s22, s42, 801792
    buffer_load_dwordx4 v9, s[12:15], s22 offen offset:1024 lds
    s_add_u32 s22, s42, 817152
    buffer_load_dwordx4 v8, s[12:15], s22 offen offset:2048 lds
    s_add_u32 s22, s42, 832512
    buffer_load_dwordx4 v9, s[12:15], s22 offen offset:3072 lds
    v_bfe_u32 v4, v0, 2, 2
    v_xor_b32 v5, s18, v4
    v_lshlrev_b32 v10, 6, v5
    v_lshl_add_u32 v10, v4, 9, v10
    v_and_b32 v4, 3, v0
    v_lshl_add_u32 v10, v4, 4, v10
    v_bfe_u32 v4, v0, 4, 2
    v_lshl_add_u32 v10, v4, 12, v10
    v_add_u32 v10, 73728, v10
    v_add_u32 v11, 49152, v10
    v_and_b32 v4, 63, v0
    v_and_b32 v5, 15, v4
    v_lshrrev_b32 v3, 4, v4
    v_lshrrev_b32 v2, 2, v5
    v_xor_b32 v3, v3, v2
    v_lshl_add_u32 v3, v5, 2, v3
    v_lshlrev_b32 v1, 4, v3
    v_lshrrev_b32 v5, 2, v4
    v_lshrrev_b32 v3, 4, v4
    v_and_b32 v4, 3, v4
    v_xor_b32 v4, v4, v3
    v_lshlrev_b32 v3, 3, v3
    v_and_b32 v5, 3, v5
    v_add_u32 v3, v3, v5
    v_mul_u32_u24 v2, 1152, v3
    v_lshl_add_u32 v2, v4, 4, v2
    s_mov_b32 s8, s48
    s_mov_b32 s9, s49
    s_mov_b32 s10, 2359296
    s_mov_b32 s11, 0x20000
    s_lshr_b32 s22, s18, 1
    s_mul_i32 s24, s22, 4608
    s_mul_i32 s25, s22, 18432
    s_and_b32 s22, s18, 1
    s_mul_i32 s23, s22, 576
    s_add_u32 s24, s24, s23
    s_mul_i32 s25, s18, 9216
    s_mul_i32 s22, s19, 36864
    s_add_u32 s24, s24, s22
    s_mov_b32 s20, 64
    s_lshl_b32 s22, s19, 5
    s_add_u32 s22, s22, s17
    s_lshl_b32 s26, s22, 14
    s_mul_i32 s23, s18, 3072
    s_add_u32 s26, s26, s23
    s_lshl_b32 s23, s16, 11
    s_add_u32 s26, s26, s23
    s_add_u32 s26, s26, -2048
    s_lshl_b32 s22, s22, 13
    s_add_u32 s22, s22, 33554432
    s_cmp_eq_u32 s16, 0
    s_cselect_b32 s26, s22, s26
    s_cselect_b32 s40, 4096, 64
    s_cselect_b32 s41, 1, 2
    s_max_u32 s40, s40, 1024
    s_lshl_b32 s41, s41, 18
    s_lshl_b32 s29, s17, 7
    s_lshl_b32 s22, s16, 4
    s_add_u32 s29, s29, s22
    s_lshl_b32 s22, s19, 2
    s_add_u32 s29, s29, s22
    s_add_u32 s29, s29, 125829120
    s_mov_b32 s27, 0
    s_add_u32 s23, s27, s25
    s_add_u32 m0, s23, 0
    s_nop 0
    buffer_load_dwordx4 v2, s[8:11], s24 offen offset:0 lds
    s_add_u32 m0, s23, 960
    s_nop 0
    buffer_load_dwordx4 v2, s[8:11], s24 offen offset:64 lds
    s_add_u32 m0, s23, 1920
    s_nop 0
    buffer_load_dwordx4 v2, s[8:11], s24 offen offset:128 lds
    s_add_u32 m0, s23, 2880
    s_nop 0
    buffer_load_dwordx4 v2, s[8:11], s24 offen offset:192 lds
    s_add_u32 m0, s23, 3840
    s_nop 0
    buffer_load_dwordx4 v2, s[8:11], s24 offen offset:256 lds
    s_add_u32 m0, s23, 4800
    s_nop 0
    buffer_load_dwordx4 v2, s[8:11], s24 offen offset:320 lds
    s_add_u32 m0, s23, 5760
    s_nop 0
    buffer_load_dwordx4 v2, s[8:11], s24 offen offset:384 lds
    s_add_u32 m0, s23, 6720
    s_nop 0
    buffer_load_dwordx4 v2, s[8:11], s24 offen offset:448 lds
    s_add_u32 m0, s23, 7680
    s_nop 0
    buffer_load_dwordx4 v2, s[8:11], s24 offen offset:512 lds
    s_add_u32 s24, s24, 147456
    s_waitcnt vmcnt(21) lgkmcnt(0)
    s_barrier
    s_add_u32 m0, s44, 139264
    s_add_u32 s22, s42, 1048576
    buffer_load_dwordx4 v8, s[12:15], s22 offen offset:0 lds
    s_add_u32 s22, s42, 1063936
    buffer_load_dwordx4 v9, s[12:15], s22 offen offset:1024 lds
    s_add_u32 s22, s42, 1079296
    buffer_load_dwordx4 v8, s[12:15], s22 offen offset:2048 lds
    s_add_u32 s22, s42, 1094656
    buffer_load_dwordx4 v9, s[12:15], s22 offen offset:3072 lds
    ds_read_b64_tr_b16 v[64:65], v10 offset:0
    ds_read_b64_tr_b16 v[66:67], v10 offset:2048
    ds_read_b64_tr_b16 v[136:137], v10 offset:8
    ds_read_b64_tr_b16 v[138:139], v10 offset:2056
    ds_read_b64_tr_b16 a[0:1], v10 offset:256
    ds_read_b64_tr_b16 a[2:3], v10 offset:2304
    ds_read_b64_tr_b16 a[72:73], v10 offset:264
    ds_read_b64_tr_b16 a[74:75], v10 offset:2312
    s_waitcnt vmcnt(21) lgkmcnt(0)
    s_barrier
    s_add_u32 m0, s44, 73728
    s_add_u32 s22, s42, 1310720
    buffer_load_dwordx4 v8, s[12:15], s22 offen offset:0 lds
    s_add_u32 s22, s42, 1326080
    buffer_load_dwordx4 v9, s[12:15], s22 offen offset:1024 lds
    s_add_u32 s22, s42, 1341440
    buffer_load_dwordx4 v8, s[12:15], s22 offen offset:2048 lds
    s_add_u32 s22, s42, 1356800
    buffer_load_dwordx4 v9, s[12:15], s22 offen offset:3072 lds
    ds_read_b64_tr_b16 v[68:69], v10 offset:16384
    ds_read_b64_tr_b16 v[70:71], v10 offset:18432
    ds_read_b64_tr_b16 v[140:141], v10 offset:16392
    ds_read_b64_tr_b16 v[142:143], v10 offset:18440
    ds_read_b64_tr_b16 a[4:5], v10 offset:16640
    ds_read_b64_tr_b16 a[6:7], v10 offset:18688
    ds_read_b64_tr_b16 a[76:77], v10 offset:16648
    ds_read_b64_tr_b16 a[78:79], v10 offset:18696
    s_waitcnt vmcnt(21) lgkmcnt(0)
    s_barrier
    s_add_u32 m0, s44, 90112
    s_add_u32 s22, s42, 1572864
    buffer_load_dwordx4 v8, s[12:15], s22 offen offset:0 lds
    s_add_u32 s22, s42, 1588224
    buffer_load_dwordx4 v9, s[12:15], s22 offen offset:1024 lds
    s_add_u32 s22, s42, 1603584
    buffer_load_dwordx4 v8, s[12:15], s22 offen offset:2048 lds
    s_add_u32 s22, s42, 1618944
    buffer_load_dwordx4 v9, s[12:15], s22 offen offset:3072 lds
    ds_read_b64_tr_b16 v[72:73], v10 offset:32768
    ds_read_b64_tr_b16 v[74:75], v10 offset:34816
    ds_read_b64_tr_b16 v[144:145], v10 offset:32776
    ds_read_b64_tr_b16 v[146:147], v10 offset:34824
    ds_read_b64_tr_b16 a[8:9], v10 offset:33024
    ds_read_b64_tr_b16 a[10:11], v10 offset:35072
    ds_read_b64_tr_b16 a[80:81], v10 offset:33032
    ds_read_b64_tr_b16 a[82:83], v10 offset:35080
    s_waitcnt vmcnt(21) lgkmcnt(0)
    s_barrier
    s_add_u32 m0, s44, 106496
    s_add_u32 s22, s42, 1835008
    buffer_load_dwordx4 v8, s[12:15], s22 offen offset:0 lds
    s_add_u32 s22, s42, 1850368
    buffer_load_dwordx4 v9, s[12:15], s22 offen offset:1024 lds
    s_add_u32 s22, s42, 1865728
    buffer_load_dwordx4 v8, s[12:15], s22 offen offset:2048 lds
    s_add_u32 s22, s42, 1881088
    buffer_load_dwordx4 v9, s[12:15], s22 offen offset:3072 lds
    ds_read_b64_tr_b16 v[76:77], v11 offset:0
    ds_read_b64_tr_b16 v[78:79], v11 offset:2048
    ds_read_b64_tr_b16 v[148:149], v11 offset:8
    ds_read_b64_tr_b16 v[150:151], v11 offset:2056
    ds_read_b64_tr_b16 a[12:13], v11 offset:256
    ds_read_b64_tr_b16 a[14:15], v11 offset:2304
    ds_read_b64_tr_b16 a[84:85], v11 offset:264
    ds_read_b64_tr_b16 a[86:87], v11 offset:2312
    s_waitcnt vmcnt(12) lgkmcnt(0)
    s_barrier
    s_add_u32 m0, s44, 122880
    s_add_u32 s22, s42, 2097152
    buffer_load_dwordx4 v8, s[12:15], s22 offen offset:0 lds
    s_add_u32 s22, s42, 2112512
    buffer_load_dwordx4 v9, s[12:15], s22 offen offset:1024 lds
    s_add_u32 s22, s42, 2127872
    buffer_load_dwordx4 v8, s[12:15], s22 offen offset:2048 lds
    s_add_u32 s22, s42, 2143232
    buffer_load_dwordx4 v9, s[12:15], s22 offen offset:3072 lds
    ds_read_b64_tr_b16 v[80:81], v11 offset:16384
    ds_read_b64_tr_b16 v[82:83], v11 offset:18432
    ds_read_b64_tr_b16 v[152:153], v11 offset:16392
    ds_read_b64_tr_b16 v[154:155], v11 offset:18440
    ds_read_b64_tr_b16 a[16:17], v11 offset:16640
    ds_read_b64_tr_b16 a[18:19], v11 offset:18688
    ds_read_b64_tr_b16 a[88:89], v11 offset:16648
    ds_read_b64_tr_b16 a[90:91], v11 offset:18696
    s_waitcnt vmcnt(12) lgkmcnt(0)
    s_barrier
    s_add_u32 m0, s44, 139264
    s_add_u32 s22, s42, 2359296
    buffer_load_dwordx4 v8, s[12:15], s22 offen offset:0 lds
    s_add_u32 s22, s42, 2374656
    buffer_load_dwordx4 v9, s[12:15], s22 offen offset:1024 lds
    s_add_u32 s22, s42, 2390016
    buffer_load_dwordx4 v8, s[12:15], s22 offen offset:2048 lds
    s_add_u32 s22, s42, 2405376
    buffer_load_dwordx4 v9, s[12:15], s22 offen offset:3072 lds
    ds_read_b64_tr_b16 v[84:85], v10 offset:0
    ds_read_b64_tr_b16 v[86:87], v10 offset:2048
    ds_read_b64_tr_b16 v[156:157], v10 offset:8
    ds_read_b64_tr_b16 v[158:159], v10 offset:2056
    ds_read_b64_tr_b16 a[20:21], v10 offset:256
    ds_read_b64_tr_b16 a[22:23], v10 offset:2304
    ds_read_b64_tr_b16 a[92:93], v10 offset:264
    ds_read_b64_tr_b16 a[94:95], v10 offset:2312
    s_waitcnt vmcnt(12) lgkmcnt(0)
    s_barrier
    s_add_u32 m0, s44, 73728
    s_add_u32 s22, s42, 2621440
    buffer_load_dwordx4 v8, s[12:15], s22 offen offset:0 lds
    s_add_u32 s22, s42, 2636800
    buffer_load_dwordx4 v9, s[12:15], s22 offen offset:1024 lds
    s_add_u32 s22, s42, 2652160
    buffer_load_dwordx4 v8, s[12:15], s22 offen offset:2048 lds
    s_add_u32 s22, s42, 2667520
    buffer_load_dwordx4 v9, s[12:15], s22 offen offset:3072 lds
    ds_read_b64_tr_b16 v[88:89], v10 offset:16384
    ds_read_b64_tr_b16 v[90:91], v10 offset:18432
    ds_read_b64_tr_b16 v[160:161], v10 offset:16392
    ds_read_b64_tr_b16 v[162:163], v10 offset:18440
    ds_read_b64_tr_b16 a[24:25], v10 offset:16640
    ds_read_b64_tr_b16 a[26:27], v10 offset:18688
    ds_read_b64_tr_b16 a[96:97], v10 offset:16648
    ds_read_b64_tr_b16 a[98:99], v10 offset:18696
    s_waitcnt vmcnt(12) lgkmcnt(0)
    s_barrier
    s_add_u32 m0, s44, 90112
    s_add_u32 s22, s42, 2883584
    buffer_load_dwordx4 v8, s[12:15], s22 offen offset:0 lds
    s_add_u32 s22, s42, 2898944
    buffer_load_dwordx4 v9, s[12:15], s22 offen offset:1024 lds
    s_add_u32 s22, s42, 2914304
    buffer_load_dwordx4 v8, s[12:15], s22 offen offset:2048 lds
    s_add_u32 s22, s42, 2929664
    buffer_load_dwordx4 v9, s[12:15], s22 offen offset:3072 lds
    ds_read_b64_tr_b16 v[92:93], v10 offset:32768
    ds_read_b64_tr_b16 v[94:95], v10 offset:34816
    ds_read_b64_tr_b16 v[164:165], v10 offset:32776
    ds_read_b64_tr_b16 v[166:167], v10 offset:34824
    ds_read_b64_tr_b16 a[28:29], v10 offset:33024
    ds_read_b64_tr_b16 a[30:31], v10 offset:35072
    ds_read_b64_tr_b16 a[100:101], v10 offset:33032
    ds_read_b64_tr_b16 a[102:103], v10 offset:35080
    s_waitcnt vmcnt(12) lgkmcnt(0)
    s_barrier
    s_add_u32 m0, s44, 106496
    s_add_u32 s22, s42, 3145728
    buffer_load_dwordx4 v8, s[12:15], s22 offen offset:0 lds
    s_add_u32 s22, s42, 3161088
    buffer_load_dwordx4 v9, s[12:15], s22 offen offset:1024 lds
    s_add_u32 s22, s42, 3176448
    buffer_load_dwordx4 v8, s[12:15], s22 offen offset:2048 lds
    s_add_u32 s22, s42, 3191808
    buffer_load_dwordx4 v9, s[12:15], s22 offen offset:3072 lds
    ds_read_b64_tr_b16 v[96:97], v11 offset:0
    ds_read_b64_tr_b16 v[98:99], v11 offset:2048
    ds_read_b64_tr_b16 v[168:169], v11 offset:8
    ds_read_b64_tr_b16 v[170:171], v11 offset:2056
    ds_read_b64_tr_b16 a[32:33], v11 offset:256
    ds_read_b64_tr_b16 a[34:35], v11 offset:2304
    ds_read_b64_tr_b16 a[104:105], v11 offset:264
    ds_read_b64_tr_b16 a[106:107], v11 offset:2312
    s_waitcnt vmcnt(12) lgkmcnt(0)
    s_barrier
    s_add_u32 m0, s44, 122880
    s_add_u32 s22, s42, 3407872
    buffer_load_dwordx4 v8, s[12:15], s22 offen offset:0 lds
    s_add_u32 s22, s42, 3423232
    buffer_load_dwordx4 v9, s[12:15], s22 offen offset:1024 lds
    s_add_u32 s22, s42, 3438592
    buffer_load_dwordx4 v8, s[12:15], s22 offen offset:2048 lds
    s_add_u32 s22, s42, 3453952
    buffer_load_dwordx4 v9, s[12:15], s22 offen offset:3072 lds
    ds_read_b64_tr_b16 v[100:101], v11 offset:16384
    ds_read_b64_tr_b16 v[102:103], v11 offset:18432
    ds_read_b64_tr_b16 v[172:173], v11 offset:16392
    ds_read_b64_tr_b16 v[174:175], v11 offset:18440
    ds_read_b64_tr_b16 a[36:37], v11 offset:16640
    ds_read_b64_tr_b16 a[38:39], v11 offset:18688
    ds_read_b64_tr_b16 a[108:109], v11 offset:16648
    ds_read_b64_tr_b16 a[110:111], v11 offset:18696
    s_waitcnt vmcnt(12) lgkmcnt(0)
    s_barrier
    s_add_u32 m0, s44, 139264
    s_add_u32 s22, s42, 3670016
    buffer_load_dwordx4 v8, s[12:15], s22 offen offset:0 lds
    s_add_u32 s22, s42, 3685376
    buffer_load_dwordx4 v9, s[12:15], s22 offen offset:1024 lds
    s_add_u32 s22, s42, 3700736
    buffer_load_dwordx4 v8, s[12:15], s22 offen offset:2048 lds
    s_add_u32 s22, s42, 3716096
    buffer_load_dwordx4 v9, s[12:15], s22 offen offset:3072 lds
    ds_read_b64_tr_b16 v[104:105], v10 offset:0
    ds_read_b64_tr_b16 v[106:107], v10 offset:2048
    ds_read_b64_tr_b16 v[176:177], v10 offset:8
    ds_read_b64_tr_b16 v[178:179], v10 offset:2056
    ds_read_b64_tr_b16 a[40:41], v10 offset:256
    ds_read_b64_tr_b16 a[42:43], v10 offset:2304
    ds_read_b64_tr_b16 a[112:113], v10 offset:264
    ds_read_b64_tr_b16 a[114:115], v10 offset:2312
    s_waitcnt vmcnt(12) lgkmcnt(0)
    s_barrier
    s_add_u32 m0, s44, 73728
    s_add_u32 s22, s42, 3932160
    buffer_load_dwordx4 v8, s[12:15], s22 offen offset:0 lds
    s_add_u32 s22, s42, 3947520
    buffer_load_dwordx4 v9, s[12:15], s22 offen offset:1024 lds
    s_add_u32 s22, s42, 3962880
    buffer_load_dwordx4 v8, s[12:15], s22 offen offset:2048 lds
    s_add_u32 s22, s42, 3978240
    buffer_load_dwordx4 v9, s[12:15], s22 offen offset:3072 lds
    ds_read_b64_tr_b16 v[108:109], v10 offset:16384
    ds_read_b64_tr_b16 v[110:111], v10 offset:18432
    ds_read_b64_tr_b16 v[180:181], v10 offset:16392
    ds_read_b64_tr_b16 v[182:183], v10 offset:18440
    ds_read_b64_tr_b16 a[44:45], v10 offset:16640
    ds_read_b64_tr_b16 a[46:47], v10 offset:18688
    ds_read_b64_tr_b16 a[116:117], v10 offset:16648
    ds_read_b64_tr_b16 a[118:119], v10 offset:18696
    s_waitcnt vmcnt(12) lgkmcnt(0)
    s_barrier
    s_add_u32 m0, s44, 90112
    s_add_u32 s22, s42, 4194304
    buffer_load_dwordx4 v8, s[12:15], s22 offen offset:0 lds
    s_add_u32 s22, s42, 4209664
    buffer_load_dwordx4 v9, s[12:15], s22 offen offset:1024 lds
    s_add_u32 s22, s42, 4225024
    buffer_load_dwordx4 v8, s[12:15], s22 offen offset:2048 lds
    s_add_u32 s22, s42, 4240384
    buffer_load_dwordx4 v9, s[12:15], s22 offen offset:3072 lds
    ds_read_b64_tr_b16 v[112:113], v10 offset:32768
    ds_read_b64_tr_b16 v[114:115], v10 offset:34816
    ds_read_b64_tr_b16 v[184:185], v10 offset:32776
    ds_read_b64_tr_b16 v[186:187], v10 offset:34824
    ds_read_b64_tr_b16 a[48:49], v10 offset:33024
    ds_read_b64_tr_b16 a[50:51], v10 offset:35072
    ds_read_b64_tr_b16 a[120:121], v10 offset:33032
    ds_read_b64_tr_b16 a[122:123], v10 offset:35080
    s_waitcnt vmcnt(12) lgkmcnt(0)
    s_barrier
    s_add_u32 m0, s44, 106496
    s_add_u32 s22, s42, 4456448
    buffer_load_dwordx4 v8, s[12:15], s22 offen offset:0 lds
    s_add_u32 s22, s42, 4471808
    buffer_load_dwordx4 v9, s[12:15], s22 offen offset:1024 lds
    s_add_u32 s22, s42, 4487168
    buffer_load_dwordx4 v8, s[12:15], s22 offen offset:2048 lds
    s_add_u32 s22, s42, 4502528
    buffer_load_dwordx4 v9, s[12:15], s22 offen offset:3072 lds
    ds_read_b64_tr_b16 v[116:117], v11 offset:0
    ds_read_b64_tr_b16 v[118:119], v11 offset:2048
    ds_read_b64_tr_b16 v[188:189], v11 offset:8
    ds_read_b64_tr_b16 v[190:191], v11 offset:2056
    ds_read_b64_tr_b16 a[52:53], v11 offset:256
    ds_read_b64_tr_b16 a[54:55], v11 offset:2304
    ds_read_b64_tr_b16 a[124:125], v11 offset:264
    ds_read_b64_tr_b16 a[126:127], v11 offset:2312
    s_waitcnt vmcnt(12) lgkmcnt(0)
    s_barrier
    s_mov_b32 s27, 36864
    s_add_u32 s23, s27, s25
    s_add_u32 m0, s23, 0
    s_nop 0
    buffer_load_dwordx4 v2, s[8:11], s24 offen offset:0 lds
    s_add_u32 m0, s23, 960
    s_nop 0
    buffer_load_dwordx4 v2, s[8:11], s24 offen offset:64 lds
    s_add_u32 m0, s23, 1920
    s_nop 0
    buffer_load_dwordx4 v2, s[8:11], s24 offen offset:128 lds
    s_add_u32 m0, s23, 2880
    s_nop 0
    buffer_load_dwordx4 v2, s[8:11], s24 offen offset:192 lds
    s_add_u32 m0, s23, 3840
    s_nop 0
    buffer_load_dwordx4 v2, s[8:11], s24 offen offset:256 lds
    s_add_u32 m0, s23, 4800
    s_nop 0
    buffer_load_dwordx4 v2, s[8:11], s24 offen offset:320 lds
    s_add_u32 m0, s23, 5760
    s_nop 0
    buffer_load_dwordx4 v2, s[8:11], s24 offen offset:384 lds
    s_add_u32 m0, s23, 6720
    s_nop 0
    buffer_load_dwordx4 v2, s[8:11], s24 offen offset:448 lds
    s_add_u32 m0, s23, 7680
    s_nop 0
    buffer_load_dwordx4 v2, s[8:11], s24 offen offset:512 lds
    s_add_u32 s24, s24, 147456
    ds_read_b64_tr_b16 v[120:121], v11 offset:16384
    ds_read_b64_tr_b16 v[122:123], v11 offset:18432
    ds_read_b64_tr_b16 v[192:193], v11 offset:16392
    ds_read_b64_tr_b16 v[194:195], v11 offset:18440
    ds_read_b64_tr_b16 a[56:57], v11 offset:16640
    ds_read_b64_tr_b16 a[58:59], v11 offset:18688
    ds_read_b64_tr_b16 a[128:129], v11 offset:16648
    ds_read_b64_tr_b16 a[130:131], v11 offset:18696
    s_waitcnt vmcnt(17) lgkmcnt(0)
    s_barrier
    ds_read_b64_tr_b16 v[124:125], v10 offset:0
    ds_read_b64_tr_b16 v[126:127], v10 offset:2048
    ds_read_b64_tr_b16 v[196:197], v10 offset:8
    ds_read_b64_tr_b16 v[198:199], v10 offset:2056
    ds_read_b64_tr_b16 a[60:61], v10 offset:256
    ds_read_b64_tr_b16 a[62:63], v10 offset:2304
    ds_read_b64_tr_b16 a[132:133], v10 offset:264
    ds_read_b64_tr_b16 a[134:135], v10 offset:2312
    s_waitcnt vmcnt(13) lgkmcnt(0)
    s_barrier
    ds_read_b64_tr_b16 v[128:129], v10 offset:16384
    ds_read_b64_tr_b16 v[130:131], v10 offset:18432
    ds_read_b64_tr_b16 v[200:201], v10 offset:16392
    ds_read_b64_tr_b16 v[202:203], v10 offset:18440
    ds_read_b64_tr_b16 a[64:65], v10 offset:16640
    ds_read_b64_tr_b16 a[66:67], v10 offset:18688
    ds_read_b64_tr_b16 a[136:137], v10 offset:16648
    ds_read_b64_tr_b16 a[138:139], v10 offset:18696
    s_waitcnt vmcnt(9) lgkmcnt(0)
    s_barrier
    ds_read_b64_tr_b16 v[132:133], v10 offset:32768
    ds_read_b64_tr_b16 v[134:135], v10 offset:34816
    ds_read_b64_tr_b16 v[204:205], v10 offset:32776
    ds_read_b64_tr_b16 v[206:207], v10 offset:34824
    ds_read_b64_tr_b16 a[68:69], v10 offset:33024
    ds_read_b64_tr_b16 a[70:71], v10 offset:35072
    ds_read_b64_tr_b16 a[140:141], v10 offset:33032
    ds_read_b64_tr_b16 a[142:143], v10 offset:35080
    s_mov_b32 s88, 4194304
gn9:
    buffer_load_dword v250, off, s[84:87], 0 offset:216 sc1
    s_waitcnt vmcnt(0)
    v_readfirstlane_b32 s95, v250
    s_sub_u32 s88, s88, 1
    s_cbranch_scc1 gn9x
    s_cmp_eq_u32 s95, 0
    s_cbranch_scc1 gn9
gn9x:
    s_waitcnt lgkmcnt(0)
    s_mov_b32 s45, 0
    s_mov_b32 s27, 0
    s_mov_b64 s[36:37], 0
    s_mov_b32 s12, 0
    s_mov_b32 s13, s40
    s_lshr_b32 s14, s41, 5
    s_add_u32 s15, s14, s40
    s_lshl_b32 s41, s41, 2
    s_sub_u32 s26, s26, s41
    v_mov_b32 v3, v1
    s_waitcnt vmcnt(0)
    s_barrier
    ds_read_b128 v[32:35], v3 offset:0
    ds_read_b128 v[36:39], v3 offset:18432
    ds_read_b128 v[40:43], v3 offset:1024
    ds_read_b128 v[44:47], v3 offset:19456
    s_cmp_eq_u32 s18, 0
    s_cselect_b32 s34, 1, 0
    s_mov_b32 s35, 0
    s_cmp_eq_u32 s16, 2
    s_cbranch_scc1 qk_vloop
qk_loop:
    s_barrier
    s_add_u32 s22, s27, 73728
    s_sub_u32 s21, s22, 110592
    s_cselect_b32 s22, s22, s21
    s_waitcnt lgkmcnt(2)
    v_mfma_f32_16x16x32_bf16 v[208:211], v[64:67], v[32:35], 0
    ds_read_b128 v[48:51], v3 offset:2048
    v_mfma_f32_16x16x32_bf16 v[212:215], v[136:139], v[32:35], 0
    ds_read_b128 v[52:55], v3 offset:20480
    v_mfma_f32_16x16x32_bf16 v[216:219], v[64:67], v[36:39], 0
    v_mfma_f32_16x16x32_bf16 v[220:223], v[136:139], v[36:39], 0
    v_mfma_f32_16x16x32_bf16 v[224:227], a[0:3], v[32:35], 0
    v_mfma_f32_16x16x32_bf16 v[228:231], a[72:75], v[32:35], 0
    v_mfma_f32_16x16x32_bf16 v[232:235], a[0:3], v[36:39], 0
    v_mfma_f32_16x16x32_bf16 v[236:239], a[72:75], v[36:39], 0
    s_waitcnt lgkmcnt(2)
    v_mfma_f32_16x16x32_bf16 v[208:211], v[68:71], v[40:43], v[208:211]
    ds_read_b128 v[32:35], v3 offset:3072
    v_mfma_f32_16x16x32_bf16 v[212:215], v[140:143], v[40:43], v[212:215]
    ds_read_b128 v[36:39], v3 offset:21504
    v_mfma_f32_16x16x32_bf16 v[216:219], v[68:71], v[44:47], v[216:219]
    s_add_u32 s23, s22, s25
    s_add_u32 m0, s23, 0
    s_nop 0
    buffer_load_dwordx4 v2, s[8:11], s24 offen offset:0 lds
    v_mfma_f32_16x16x32_bf16 v[220:223], v[140:143], v[44:47], v[220:223]
    v_mfma_f32_16x16x32_bf16 v[224:227], a[4:7], v[40:43], v[224:227]
    v_mfma_f32_16x16x32_bf16 v[228:231], a[76:79], v[40:43], v[228:231]
    v_mfma_f32_16x16x32_bf16 v[232:235], a[4:7], v[44:47], v[232:235]
    s_add_u32 m0, s23, 960
    s_nop 0
    buffer_load_dwordx4 v2, s[8:11], s24 offen offset:64 lds
    v_mfma_f32_16x16x32_bf16 v[236:239], a[76:79], v[44:47], v[236:239]
    s_waitcnt lgkmcnt(2)
    v_mfma_f32_16x16x32_bf16 v[208:211], v[72:75], v[48:51], v[208:211]
    ds_read_b128 v[40:43], v3 offset:4096
    v_mfma_f32_16x16x32_bf16 v[212:215], v[144:147], v[48:51], v[212:215]
    ds_read_b128 v[44:47], v3 offset:22528
    v_mfma_f32_16x16x32_bf16 v[216:219], v[72:75], v[52:55], v[216:219]
    s_add_u32 m0, s23, 1920
    s_nop 0
    buffer_load_dwordx4 v2, s[8:11], s24 offen offset:128 lds
    v_mfma_f32_16x16x32_bf16 v[220:223], v[144:147], v[52:55], v[220:223]
    v_mfma_f32_16x16x32_bf16 v[224:227], a[8:11], v[48:51], v[224:227]
    v_mfma_f32_16x16x32_bf16 v[228:231], a[80:83], v[48:51], v[228:231]
    v_mfma_f32_16x16x32_bf16 v[232:235], a[8:11], v[52:55], v[232:235]
    s_add_u32 m0, s23, 2880
    s_nop 0
    buffer_load_dwordx4 v2, s[8:11], s24 offen offset:192 lds
    v_mfma_f32_16x16x32_bf16 v[236:239], a[80:83], v[52:55], v[236:239]
    s_waitcnt lgkmcnt(2)
    v_mfma_f32_16x16x32_bf16 v[208:211], v[76:79], v[32:35], v[208:211]
    ds_read_b128 v[48:51], v3 offset:5120
    v_mfma_f32_16x16x32_bf16 v[212:215], v[148:151], v[32:35], v[212:215]
    ds_read_b128 v[52:55], v3 offset:23552
    v_mfma_f32_16x16x32_bf16 v[216:219], v[76:79], v[36:39], v[216:219]
    s_add_u32 m0, s23, 3840
    s_nop 0
    buffer_load_dwordx4 v2, s[8:11], s24 offen offset:256 lds
    v_mfma_f32_16x16x32_bf16 v[220:223], v[148:151], v[36:39], v[220:223]
    v_mfma_f32_16x16x32_bf16 v[224:227], a[12:15], v[32:35], v[224:227]
    v_mfma_f32_16x16x32_bf16 v[228:231], a[84:87], v[32:35], v[228:231]
    v_mfma_f32_16x16x32_bf16 v[232:235], a[12:15], v[36:39], v[232:235]
    s_add_u32 m0, s23, 4800
    s_nop 0
    buffer_load_dwordx4 v2, s[8:11], s24 offen offset:320 lds
    v_mfma_f32_16x16x32_bf16 v[236:239], a[84:87], v[36:39], v[236:239]
    s_waitcnt lgkmcnt(2)
    v_mfma_f32_16x16x32_bf16 v[208:211], v[80:83], v[40:43], v[208:211]
    ds_read_b128 v[32:35], v3 offset:6144
    v_mfma_f32_16x16x32_bf16 v[212:215], v[152:155], v[40:43], v[212:215]
    ds_read_b128 v[36:39], v3 offset:24576
    v_mfma_f32_16x16x32_bf16 v[216:219], v[80:83], v[44:47], v[216:219]
    s_add_u32 m0, s23, 5760
    s_nop 0
    buffer_load_dwordx4 v2, s[8:11], s24 offen offset:384 lds
    v_mfma_f32_16x16x32_bf16 v[220:223], v[152:155], v[44:47], v[220:223]
    v_mfma_f32_16x16x32_bf16 v[224:227], a[16:19], v[40:43], v[224:227]
    v_mfma_f32_16x16x32_bf16 v[228:231], a[88:91], v[40:43], v[228:231]
    v_mfma_f32_16x16x32_bf16 v[232:235], a[16:19], v[44:47], v[232:235]
    s_add_u32 m0, s23, 6720
    s_nop 0
    buffer_load_dwordx4 v2, s[8:11], s24 offen offset:448 lds
    v_mfma_f32_16x16x32_bf16 v[236:239], a[88:91], v[44:47], v[236:239]
    s_waitcnt lgkmcnt(2)
    v_mfma_f32_16x16x32_bf16 v[208:211], v[84:87], v[48:51], v[208:211]
    ds_read_b128 v[40:43], v3 offset:7168
    v_mfma_f32_16x16x32_bf16 v[212:215], v[156:159], v[48:51], v[212:215]
    ds_read_b128 v[44:47], v3 offset:25600
    v_mfma_f32_16x16x32_bf16 v[216:219], v[84:87], v[52:55], v[216:219]
    s_add_u32 m0, s23, 7680
    s_nop 0
    buffer_load_dwordx4 v2, s[8:11], s24 offen offset:512 lds
    s_add_u32 s24, s24, 147456
    v_mfma_f32_16x16x32_bf16 v[220:223], v[156:159], v[52:55], v[220:223]
    v_mfma_f32_16x16x32_bf16 v[224:227], a[20:23], v[48:51], v[224:227]
    v_mfma_f32_16x16x32_bf16 v[228:231], a[92:95], v[48:51], v[228:231]
    v_mfma_f32_16x16x32_bf16 v[232:235], a[20:23], v[52:55], v[232:235]
    v_mfma_f32_16x16x32_bf16 v[236:239], a[92:95], v[52:55], v[236:239]
    s_waitcnt lgkmcnt(2)
    v_mfma_f32_16x16x32_bf16 v[208:211], v[88:91], v[32:35], v[208:211]
    ds_read_b128 v[48:51], v3 offset:8192
    v_mfma_f32_16x16x32_bf16 v[212:215], v[160:163], v[32:35], v[212:215]
    ds_read_b128 v[52:55], v3 offset:26624
    v_mfma_f32_16x16x32_bf16 v[216:219], v[88:91], v[36:39], v[216:219]
    v_mfma_f32_16x16x32_bf16 v[220:223], v[160:163], v[36:39], v[220:223]
    v_mfma_f32_16x16x32_bf16 v[224:227], a[24:27], v[32:35], v[224:227]
    v_mfma_f32_16x16x32_bf16 v[228:231], a[96:99], v[32:35], v[228:231]
    v_mfma_f32_16x16x32_bf16 v[232:235], a[24:27], v[36:39], v[232:235]
    v_mfma_f32_16x16x32_bf16 v[236:239], a[96:99], v[36:39], v[236:239]
    s_waitcnt lgkmcnt(2)
    v_mfma_f32_16x16x32_bf16 v[208:211], v[92:95], v[40:43], v[208:211]
    ds_read_b128 v[32:35], v3 offset:9216
    v_mfma_f32_16x16x32_bf16 v[212:215], v[164:167], v[40:43], v[212:215]
    ds_read_b128 v[36:39], v3 offset:27648
    v_mfma_f32_16x16x32_bf16 v[216:219], v[92:95], v[44:47], v[216:219]
    s_add_u32 s23, s45, s95
    v_mov_b32 v4, s23
    s_mov_b64 exec, s[34:35]
    buffer_store_dword v4, off, s[4:7], s29 sc1
    buffer_store_dword v4, off, s[4:7], s29 offset:128 sc1
    s_mov_b64 exec, -1
    v_mfma_f32_16x16x32_bf16 v[220:223], v[164:167], v[44:47], v[220:223]
    v_mfma_f32_16x16x32_bf16 v[224:227], a[28:31], v[40:43], v[224:227]
    v_mfma_f32_16x16x32_bf16 v[228:231], a[100:103], v[40:43], v[228:231]
    v_mfma_f32_16x16x32_bf16 v[232:235], a[28:31], v[44:47], v[232:235]
    v_mfma_f32_16x16x32_bf16 v[236:239], a[100:103], v[44:47], v[236:239]
    s_waitcnt lgkmcnt(2)
    v_mfma_f32_16x16x32_bf16 v[208:211], v[96:99], v[48:51], v[208:211]
    ds_read_b128 v[40:43], v3 offset:10240
    v_mfma_f32_16x16x32_bf16 v[212:215], v[168:171], v[48:51], v[212:215]
    ds_read_b128 v[44:47], v3 offset:28672
    v_mfma_f32_16x16x32_bf16 v[216:219], v[96:99], v[52:55], v[216:219]
    s_cmp_lt_u32 s19, 60
    s_cbranch_scc1 lt10
    buffer_load_dwordx4 v[244:247], off, s[84:87], 0 offset:16 sc1
    buffer_load_dwordx4 v[240:243], off, s[84:87], 0 offset:32 sc1
    buffer_load_dwordx2 v[252:253], off, s[84:87], 0 offset:48 sc1
lt10:
    s_lshr_b32 s46, s19, 2
    s_cmp_eq_u32 s16, 0
    s_cselect_b32 s46, 0, s46
    s_cmp_lg_u32 s46, 2
    s_cbranch_scc1 lp10
    v_mov_b32 v244, -1
    v_mov_b32 v245, -1
    v_mov_b32 v246, -1
    v_mov_b32 v247, -1
    s_lshl_b32 s46, s19, 5
    s_add_u32 s46, s46, s17
    s_lshl_b32 s46, s46, 12
    s_mul_i32 s47, s16, 8388608
    s_add_u32 s46, s46, s47
    s_add_u32 s47, s46, 67108864
    buffer_store_dwordx4 v[244:247], v7, s[4:7], s47 offen sc1
    s_add_u32 s47, s46, 67112960
    buffer_store_dwordx4 v[244:247], v7, s[4:7], s47 offen sc1
    s_add_u32 s47, s46, 67633152
    buffer_store_dwordx4 v[244:247], v7, s[4:7], s47 offen sc1
    s_add_u32 s47, s46, 67637248
    buffer_store_dwordx4 v[244:247], v7, s[4:7], s47 offen sc1
lp10:
    s_lshl_b32 s46, s16, 6
    s_or_b32 s46, s46, s19
    s_or_b32 s47, s46, 1
    s_cmp_lg_u32 s47, 11
    s_cbranch_scc1 lq10
    v_mov_b32 v244, -1
    v_mov_b32 v245, -1
    v_mov_b32 v246, -1
    v_mov_b32 v247, -1
    s_lshl_b32 s46, s46, 18
    s_lshl_b32 s47, s17, 12
    s_add_u32 s46, s46, s47
    s_add_u32 s47, s46, 63963136
    buffer_store_dwordx4 v[244:247], v7, s[4:7], s47 offen sc1
    s_add_u32 s47, s46, 63967232
    buffer_store_dwordx4 v[244:247], v7, s[4:7], s47 offen sc1
    s_add_u32 s47, s46, 64094208
    buffer_store_dwordx4 v[244:247], v7, s[4:7], s47 offen sc1
    s_add_u32 s47, s46, 64098304
    buffer_store_dwordx4 v[244:247], v7, s[4:7], s47 offen sc1
lq10:
    v_mfma_f32_16x16x32_bf16 v[220:223], v[168:171], v[52:55], v[220:223]
    v_mfma_f32_16x16x32_bf16 v[224:227], a[32:35], v[48:51], v[224:227]
    v_mfma_f32_16x16x32_bf16 v[228:231], a[104:107], v[48:51], v[228:231]
    v_mfma_f32_16x16x32_bf16 v[232:235], a[32:35], v[52:55], v[232:235]
    v_mfma_f32_16x16x32_bf16 v[236:239], a[104:107], v[52:55], v[236:239]
    s_waitcnt lgkmcnt(2)
    v_mfma_f32_16x16x32_bf16 v[208:211], v[100:103], v[32:35], v[208:211]
    ds_read_b128 v[48:51], v3 offset:11264
    v_mfma_f32_16x16x32_bf16 v[212:215], v[172:175], v[32:35], v[212:215]
    ds_read_b128 v[52:55], v3 offset:29696
    v_mfma_f32_16x16x32_bf16 v[216:219], v[100:103], v[36:39], v[216:219]
    v_mfma_f32_16x16x32_bf16 v[220:223], v[172:175], v[36:39], v[220:223]
    v_mfma_f32_16x16x32_bf16 v[224:227], a[36:39], v[32:35], v[224:227]
    v_mfma_f32_16x16x32_bf16 v[228:231], a[108:111], v[32:35], v[228:231]
    v_mfma_f32_16x16x32_bf16 v[232:235], a[36:39], v[36:39], v[232:235]
    v_mfma_f32_16x16x32_bf16 v[236:239], a[108:111], v[36:39], v[236:239]
    s_waitcnt lgkmcnt(2)
    v_mfma_f32_16x16x32_bf16 v[208:211], v[104:107], v[40:43], v[208:211]
    ds_read_b128 v[32:35], v3 offset:12288
    v_mfma_f32_16x16x32_bf16 v[212:215], v[176:179], v[40:43], v[212:215]
    ds_read_b128 v[36:39], v3 offset:30720
    v_mfma_f32_16x16x32_bf16 v[216:219], v[104:107], v[44:47], v[216:219]
    v_mfma_f32_16x16x32_bf16 v[220:223], v[176:179], v[44:47], v[220:223]
    v_mfma_f32_16x16x32_bf16 v[224:227], a[40:43], v[40:43], v[224:227]
    v_mfma_f32_16x16x32_bf16 v[228:231], a[112:115], v[40:43], v[228:231]
    v_mfma_f32_16x16x32_bf16 v[232:235], a[40:43], v[44:47], v[232:235]
    v_mfma_f32_16x16x32_bf16 v[236:239], a[112:115], v[44:47], v[236:239]
    s_waitcnt lgkmcnt(2)
    v_mfma_f32_16x16x32_bf16 v[208:211], v[108:111], v[48:51], v[208:211]
    ds_read_b128 v[40:43], v3 offset:13312
    v_mfma_f32_16x16x32_bf16 v[212:215], v[180:183], v[48:51], v[212:215]
    ds_read_b128 v[44:47], v3 offset:31744
    v_mfma_f32_16x16x32_bf16 v[216:219], v[108:111], v[52:55], v[216:219]
    v_mfma_f32_16x16x32_bf16 v[220:223], v[180:183], v[52:55], v[220:223]
    v_mfma_f32_16x16x32_bf16 v[224:227], a[44:47], v[48:51], v[224:227]
    v_mfma_f32_16x16x32_bf16 v[228:231], a[116:119], v[48:51], v[228:231]
    v_mfma_f32_16x16x32_bf16 v[232:235], a[44:47], v[52:55], v[232:235]
    v_mfma_f32_16x16x32_bf16 v[236:239], a[116:119], v[52:55], v[236:239]
    s_waitcnt lgkmcnt(2)
    v_mfma_f32_16x16x32_bf16 v[208:211], v[112:115], v[32:35], v[208:211]
    ds_read_b128 v[48:51], v3 offset:14336
    v_mfma_f32_16x16x32_bf16 v[212:215], v[184:187], v[32:35], v[212:215]
    ds_read_b128 v[52:55], v3 offset:32768
    v_mfma_f32_16x16x32_bf16 v[216:219], v[112:115], v[36:39], v[216:219]
    v_mfma_f32_16x16x32_bf16 v[220:223], v[184:187], v[36:39], v[220:223]
    v_mfma_f32_16x16x32_bf16 v[224:227], a[48:51], v[32:35], v[224:227]
    v_mfma_f32_16x16x32_bf16 v[228:231], a[120:123], v[32:35], v[228:231]
    v_mfma_f32_16x16x32_bf16 v[232:235], a[48:51], v[36:39], v[232:235]
    v_mfma_f32_16x16x32_bf16 v[236:239], a[120:123], v[36:39], v[236:239]
    s_waitcnt lgkmcnt(2)
    v_mfma_f32_16x16x32_bf16 v[208:211], v[116:119], v[40:43], v[208:211]
    ds_read_b128 v[32:35], v3 offset:15360
    v_mfma_f32_16x16x32_bf16 v[212:215], v[188:191], v[40:43], v[212:215]
    ds_read_b128 v[36:39], v3 offset:33792
    v_mfma_f32_16x16x32_bf16 v[216:219], v[116:119], v[44:47], v[216:219]
    v_mfma_f32_16x16x32_bf16 v[220:223], v[188:191], v[44:47], v[220:223]
    v_mfma_f32_16x16x32_bf16 v[224:227], a[52:55], v[40:43], v[224:227]
    v_mfma_f32_16x16x32_bf16 v[228:231], a[124:127], v[40:43], v[228:231]
    v_mfma_f32_16x16x32_bf16 v[232:235], a[52:55], v[44:47], v[232:235]
    v_mfma_f32_16x16x32_bf16 v[236:239], a[124:127], v[44:47], v[236:239]
    s_waitcnt lgkmcnt(2)
    v_mfma_f32_16x16x32_bf16 v[208:211], v[120:123], v[48:51], v[208:211]
    ds_read_b128 v[40:43], v3 offset:16384
    v_mfma_f32_16x16x32_bf16 v[212:215], v[192:195], v[48:51], v[212:215]
    ds_read_b128 v[44:47], v3 offset:34816
    v_mfma_f32_16x16x32_bf16 v[216:219], v[120:123], v[52:55], v[216:219]
    v_mfma_f32_16x16x32_bf16 v[220:223], v[192:195], v[52:55], v[220:223]
    v_mfma_f32_16x16x32_bf16 v[224:227], a[56:59], v[48:51], v[224:227]
    v_mfma_f32_16x16x32_bf16 v[228:231], a[128:131], v[48:51], v[228:231]
    v_mfma_f32_16x16x32_bf16 v[232:235], a[56:59], v[52:55], v[232:235]
    v_mfma_f32_16x16x32_bf16 v[236:239], a[128:131], v[52:55], v[236:239]
    s_waitcnt lgkmcnt(2)
    v_mfma_f32_16x16x32_bf16 v[208:211], v[124:127], v[32:35], v[208:211]
    ds_read_b128 v[48:51], v3 offset:17408
    v_mfma_f32_16x16x32_bf16 v[212:215], v[196:199], v[32:35], v[212:215]
    ds_read_b128 v[52:55], v3 offset:35840
    v_mfma_f32_16x16x32_bf16 v[216:219], v[124:127], v[36:39], v[216:219]
    v_mfma_f32_16x16x32_bf16 v[220:223], v[196:199], v[36:39], v[220:223]
    v_mfma_f32_16x16x32_bf16 v[224:227], a[60:63], v[32:35], v[224:227]
    s_add_u32 s27, s27, 36864
    s_cmp_eq_u32 s27, 110592
    s_cselect_b32 s27, 0, s27
    v_add_u32 v3, s27, v1
    v_mfma_f32_16x16x32_bf16 v[228:231], a[132:135], v[32:35], v[228:231]
    v_mfma_f32_16x16x32_bf16 v[232:235], a[60:63], v[36:39], v[232:235]
    v_mfma_f32_16x16x32_bf16 v[236:239], a[132:135], v[36:39], v[236:239]
    s_waitcnt lgkmcnt(2)
    v_mfma_f32_16x16x32_bf16 v[208:211], v[128:131], v[40:43], v[208:211]
    ds_read_b128 v[32:35], v3 offset:0
    v_mfma_f32_16x16x32_bf16 v[212:215], v[200:203], v[40:43], v[212:215]
    ds_read_b128 v[36:39], v3 offset:18432
    v_mfma_f32_16x16x32_bf16 v[216:219], v[128:131], v[44:47], v[216:219]
    v_mfma_f32_16x16x32_bf16 v[220:223], v[200:203], v[44:47], v[220:223]
    v_mfma_f32_16x16x32_bf16 v[224:227], a[64:67], v[40:43], v[224:227]
    v_mfma_f32_16x16x32_bf16 v[228:231], a[136:139], v[40:43], v[228:231]
    v_mfma_f32_16x16x32_bf16 v[232:235], a[64:67], v[44:47], v[232:235]
    v_mfma_f32_16x16x32_bf16 v[236:239], a[136:139], v[44:47], v[236:239]
    s_waitcnt lgkmcnt(2)
    v_mfma_f32_16x16x32_bf16 v[208:211], v[132:135], v[48:51], v[208:211]
    ds_read_b128 v[40:43], v3 offset:1024
    v_mfma_f32_16x16x32_bf16 v[212:215], v[204:207], v[48:51], v[212:215]
    ds_read_b128 v[44:47], v3 offset:19456
    v_mfma_f32_16x16x32_bf16 v[216:219], v[132:135], v[52:55], v[216:219]
    v_mfma_f32_16x16x32_bf16 v[220:223], v[204:207], v[52:55], v[220:223]
    v_mfma_f32_16x16x32_bf16 v[224:227], a[68:71], v[48:51], v[224:227]
    v_mfma_f32_16x16x32_bf16 v[228:231], a[140:143], v[48:51], v[228:231]
    v_mfma_f32_16x16x32_bf16 v[232:235], a[68:71], v[52:55], v[232:235]
    v_mfma_f32_16x16x32_bf16 v[236:239], a[140:143], v[52:55], v[236:239]
    s_add_u32 s26, s26, s41
    s_waitcnt vmcnt(0)
    v_cvt_pk_bf16_f32 v8, v208, v209
    v_cvt_pk_bf16_f32 v9, v210, v211
    v_cvt_pk_bf16_f32 v10, v212, v213
    v_cvt_pk_bf16_f32 v11, v214, v215
    v_cvt_pk_bf16_f32 v12, v216, v217
    v_cvt_pk_bf16_f32 v13, v218, v219
    v_cvt_pk_bf16_f32 v14, v220, v221
    v_cvt_pk_bf16_f32 v15, v222, v223
    v_cvt_pk_bf16_f32 v16, v224, v225
    v_cvt_pk_bf16_f32 v17, v226, v227
    v_cvt_pk_bf16_f32 v18, v228, v229
    v_cvt_pk_bf16_f32 v19, v230, v231
    v_cvt_pk_bf16_f32 v20, v232, v233
    v_cvt_pk_bf16_f32 v21, v234, v235
    v_cvt_pk_bf16_f32 v22, v236, v237
    v_cvt_pk_bf16_f32 v23, v238, v239
    s_mov_b64 s[36:37], -1
    s_add_u32 s28, s26, s12
    buffer_store_dwordx4 v[8:11], v7, s[4:7], s28 offen sc1
    s_add_u32 s28, s26, s13
    buffer_store_dwordx4 v[12:15], v7, s[4:7], s28 offen sc1
    s_add_u32 s28, s26, s14
    buffer_store_dwordx4 v[16:19], v7, s[4:7], s28 offen sc1
    s_add_u32 s28, s26, s15
    buffer_store_dwordx4 v[20:23], v7, s[4:7], s28 offen sc1
    s_lshr_b32 s45, s19, 2
    s_cbranch_scc1 qk_loop_nf
    s_mov_b32 s45, 1
    s_mov_b64 s[36:37], 0
    s_waitcnt vmcnt(0)
    s_barrier
    s_add_u32 s23, s45, s95
    v_mov_b32 v4, s23
    s_mov_b64 exec, s[34:35]
    buffer_store_dword v4, off, s[4:7], s29 sc1
    buffer_store_dword v4, off, s[4:7], s29 offset:128 sc1
    s_mov_b64 exec, -1
qk_loop_nf:
    s_add_u32 s19, s19, 4
    s_cmp_lt_u32 s19, s20
    s_cbranch_scc1 qk_loop
    s_branch qk_done
qk_vloop:
    s_barrier
    s_add_u32 s22, s27, 73728
    s_sub_u32 s21, s22, 110592
    s_cselect_b32 s22, s22, s21
    s_waitcnt lgkmcnt(2)
    v_mfma_f32_16x16x32_bf16 v[208:211], v[32:35], v[64:67], 0
    ds_read_b128 v[48:51], v3 offset:2048
    v_mfma_f32_16x16x32_bf16 v[212:215], v[32:35], v[136:139], 0
    ds_read_b128 v[52:55], v3 offset:20480
    v_mfma_f32_16x16x32_bf16 v[216:219], v[36:39], v[64:67], 0
    v_mfma_f32_16x16x32_bf16 v[220:223], v[36:39], v[136:139], 0
    v_mfma_f32_16x16x32_bf16 v[224:227], v[32:35], a[0:3], 0
    v_mfma_f32_16x16x32_bf16 v[228:231], v[32:35], a[72:75], 0
    v_mfma_f32_16x16x32_bf16 v[232:235], v[36:39], a[0:3], 0
    v_mfma_f32_16x16x32_bf16 v[236:239], v[36:39], a[72:75], 0
    s_waitcnt lgkmcnt(2)
    v_mfma_f32_16x16x32_bf16 v[208:211], v[40:43], v[68:71], v[208:211]
    ds_read_b128 v[32:35], v3 offset:3072
    v_mfma_f32_16x16x32_bf16 v[212:215], v[40:43], v[140:143], v[212:215]
    ds_read_b128 v[36:39], v3 offset:21504
    v_mfma_f32_16x16x32_bf16 v[216:219], v[44:47], v[68:71], v[216:219]
    s_add_u32 s23, s22, s25
    s_add_u32 m0, s23, 0
    s_nop 0
    buffer_load_dwordx4 v2, s[8:11], s24 offen offset:0 lds
    v_mfma_f32_16x16x32_bf16 v[220:223], v[44:47], v[140:143], v[220:223]
    v_mfma_f32_16x16x32_bf16 v[224:227], v[40:43], a[4:7], v[224:227]
    v_mfma_f32_16x16x32_bf16 v[228:231], v[40:43], a[76:79], v[228:231]
    v_mfma_f32_16x16x32_bf16 v[232:235], v[44:47], a[4:7], v[232:235]
    s_add_u32 m0, s23, 960
    s_nop 0
    buffer_load_dwordx4 v2, s[8:11], s24 offen offset:64 lds
    v_mfma_f32_16x16x32_bf16 v[236:239], v[44:47], a[76:79], v[236:239]
    s_waitcnt lgkmcnt(2)
    v_mfma_f32_16x16x32_bf16 v[208:211], v[48:51], v[72:75], v[208:211]
    ds_read_b128 v[40:43], v3 offset:4096
    v_mfma_f32_16x16x32_bf16 v[212:215], v[48:51], v[144:147], v[212:215]
    ds_read_b128 v[44:47], v3 offset:22528
    v_mfma_f32_16x16x32_bf16 v[216:219], v[52:55], v[72:75], v[216:219]
    s_add_u32 m0, s23, 1920
    s_nop 0
    buffer_load_dwordx4 v2, s[8:11], s24 offen offset:128 lds
    v_mfma_f32_16x16x32_bf16 v[220:223], v[52:55], v[144:147], v[220:223]
    v_mfma_f32_16x16x32_bf16 v[224:227], v[48:51], a[8:11], v[224:227]
    v_mfma_f32_16x16x32_bf16 v[228:231], v[48:51], a[80:83], v[228:231]
    v_mfma_f32_16x16x32_bf16 v[232:235], v[52:55], a[8:11], v[232:235]
    s_add_u32 m0, s23, 2880
    s_nop 0
    buffer_load_dwordx4 v2, s[8:11], s24 offen offset:192 lds
    v_mfma_f32_16x16x32_bf16 v[236:239], v[52:55], a[80:83], v[236:239]
    s_waitcnt lgkmcnt(2)
    v_mfma_f32_16x16x32_bf16 v[208:211], v[32:35], v[76:79], v[208:211]
    ds_read_b128 v[48:51], v3 offset:5120
    v_mfma_f32_16x16x32_bf16 v[212:215], v[32:35], v[148:151], v[212:215]
    ds_read_b128 v[52:55], v3 offset:23552
    v_mfma_f32_16x16x32_bf16 v[216:219], v[36:39], v[76:79], v[216:219]
    s_add_u32 m0, s23, 3840
    s_nop 0
    buffer_load_dwordx4 v2, s[8:11], s24 offen offset:256 lds
    v_mfma_f32_16x16x32_bf16 v[220:223], v[36:39], v[148:151], v[220:223]
    v_mfma_f32_16x16x32_bf16 v[224:227], v[32:35], a[12:15], v[224:227]
    v_mfma_f32_16x16x32_bf16 v[228:231], v[32:35], a[84:87], v[228:231]
    v_mfma_f32_16x16x32_bf16 v[232:235], v[36:39], a[12:15], v[232:235]
    s_add_u32 m0, s23, 4800
    s_nop 0
    buffer_load_dwordx4 v2, s[8:11], s24 offen offset:320 lds
    v_mfma_f32_16x16x32_bf16 v[236:239], v[36:39], a[84:87], v[236:239]
    s_waitcnt lgkmcnt(2)
    v_mfma_f32_16x16x32_bf16 v[208:211], v[40:43], v[80:83], v[208:211]
    ds_read_b128 v[32:35], v3 offset:6144
    v_mfma_f32_16x16x32_bf16 v[212:215], v[40:43], v[152:155], v[212:215]
    ds_read_b128 v[36:39], v3 offset:24576
    v_mfma_f32_16x16x32_bf16 v[216:219], v[44:47], v[80:83], v[216:219]
    s_add_u32 m0, s23, 5760
    s_nop 0
    buffer_load_dwordx4 v2, s[8:11], s24 offen offset:384 lds
    v_mfma_f32_16x16x32_bf16 v[220:223], v[44:47], v[152:155], v[220:223]
    v_mfma_f32_16x16x32_bf16 v[224:227], v[40:43], a[16:19], v[224:227]
    v_mfma_f32_16x16x32_bf16 v[228:231], v[40:43], a[88:91], v[228:231]
    v_mfma_f32_16x16x32_bf16 v[232:235], v[44:47], a[16:19], v[232:235]
    s_add_u32 m0, s23, 6720
    s_nop 0
    buffer_load_dwordx4 v2, s[8:11], s24 offen offset:448 lds
    v_mfma_f32_16x16x32_bf16 v[236:239], v[44:47], a[88:91], v[236:239]
    s_waitcnt lgkmcnt(2)
    v_mfma_f32_16x16x32_bf16 v[208:211], v[48:51], v[84:87], v[208:211]
    ds_read_b128 v[40:43], v3 offset:7168
    v_mfma_f32_16x16x32_bf16 v[212:215], v[48:51], v[156:159], v[212:215]
    ds_read_b128 v[44:47], v3 offset:25600
    v_mfma_f32_16x16x32_bf16 v[216:219], v[52:55], v[84:87], v[216:219]
    s_add_u32 m0, s23, 7680
    s_nop 0
    buffer_load_dwordx4 v2, s[8:11], s24 offen offset:512 lds
    s_add_u32 s24, s24, 147456
    v_mfma_f32_16x16x32_bf16 v[220:223], v[52:55], v[156:159], v[220:223]
    v_mfma_f32_16x16x32_bf16 v[224:227], v[48:51], a[20:23], v[224:227]
    v_mfma_f32_16x16x32_bf16 v[228:231], v[48:51], a[92:95], v[228:231]
    v_mfma_f32_16x16x32_bf16 v[232:235], v[52:55], a[20:23], v[232:235]
    v_mfma_f32_16x16x32_bf16 v[236:239], v[52:55], a[92:95], v[236:239]
    s_waitcnt lgkmcnt(2)
    v_mfma_f32_16x16x32_bf16 v[208:211], v[32:35], v[88:91], v[208:211]
    ds_read_b128 v[48:51], v3 offset:8192
    v_mfma_f32_16x16x32_bf16 v[212:215], v[32:35], v[160:163], v[212:215]
    ds_read_b128 v[52:55], v3 offset:26624
    v_mfma_f32_16x16x32_bf16 v[216:219], v[36:39], v[88:91], v[216:219]
    v_mfma_f32_16x16x32_bf16 v[220:223], v[36:39], v[160:163], v[220:223]
    v_mfma_f32_16x16x32_bf16 v[224:227], v[32:35], a[24:27], v[224:227]
    v_mfma_f32_16x16x32_bf16 v[228:231], v[32:35], a[96:99], v[228:231]
    v_mfma_f32_16x16x32_bf16 v[232:235], v[36:39], a[24:27], v[232:235]
    v_mfma_f32_16x16x32_bf16 v[236:239], v[36:39], a[96:99], v[236:239]
    s_waitcnt lgkmcnt(2)
    v_mfma_f32_16x16x32_bf16 v[208:211], v[40:43], v[92:95], v[208:211]
    ds_read_b128 v[32:35], v3 offset:9216
    v_mfma_f32_16x16x32_bf16 v[212:215], v[40:43], v[164:167], v[212:215]
    ds_read_b128 v[36:39], v3 offset:27648
    v_mfma_f32_16x16x32_bf16 v[216:219], v[44:47], v[92:95], v[216:219]
    s_add_u32 s23, s45, s95
    v_mov_b32 v4, s23
    s_mov_b64 exec, s[34:35]
    buffer_store_dword v4, off, s[4:7], s29 sc1
    buffer_store_dword v4, off, s[4:7], s29 offset:128 sc1
    s_mov_b64 exec, -1
    v_mfma_f32_16x16x32_bf16 v[220:223], v[44:47], v[164:167], v[220:223]
    v_mfma_f32_16x16x32_bf16 v[224:227], v[40:43], a[28:31], v[224:227]
    v_mfma_f32_16x16x32_bf16 v[228:231], v[40:43], a[100:103], v[228:231]
    v_mfma_f32_16x16x32_bf16 v[232:235], v[44:47], a[28:31], v[232:235]
    v_mfma_f32_16x16x32_bf16 v[236:239], v[44:47], a[100:103], v[236:239]
    s_waitcnt lgkmcnt(2)
    v_mfma_f32_16x16x32_bf16 v[208:211], v[48:51], v[96:99], v[208:211]
    ds_read_b128 v[40:43], v3 offset:10240
    v_mfma_f32_16x16x32_bf16 v[212:215], v[48:51], v[168:171], v[212:215]
    ds_read_b128 v[44:47], v3 offset:28672
    v_mfma_f32_16x16x32_bf16 v[216:219], v[52:55], v[96:99], v[216:219]
    s_cmp_lt_u32 s19, 60
    s_cbranch_scc1 lt11
    buffer_load_dwordx4 v[244:247], off, s[84:87], 0 offset:16 sc1
    buffer_load_dwordx4 v[240:243], off, s[84:87], 0 offset:32 sc1
    buffer_load_dwordx2 v[252:253], off, s[84:87], 0 offset:48 sc1
lt11:
    s_lshr_b32 s46, s19, 2
    s_cmp_eq_u32 s16, 0
    s_cselect_b32 s46, 0, s46
    s_cmp_lg_u32 s46, 2
    s_cbranch_scc1 lp11
    v_mov_b32 v244, -1
    v_mov_b32 v245, -1
    v_mov_b32 v246, -1
    v_mov_b32 v247, -1
    s_lshl_b32 s46, s19, 5
    s_add_u32 s46, s46, s17
    s_lshl_b32 s46, s46, 12
    s_mul_i32 s47, s16, 8388608
    s_add_u32 s46, s46, s47
    s_add_u32 s47, s46, 67108864
    buffer_store_dwordx4 v[244:247], v7, s[4:7], s47 offen sc1
    s_add_u32 s47, s46, 67112960
    buffer_store_dwordx4 v[244:247], v7, s[4:7], s47 offen sc1
    s_add_u32 s47, s46, 67633152
    buffer_store_dwordx4 v[244:247], v7, s[4:7], s47 offen sc1
    s_add_u32 s47, s46, 67637248
    buffer_store_dwordx4 v[244:247], v7, s[4:7], s47 offen sc1
lp11:
    s_lshl_b32 s46, s16, 6
    s_or_b32 s46, s46, s19
    s_or_b32 s47, s46, 1
    s_cmp_lg_u32 s47, 11
    s_cbranch_scc1 lq11
    v_mov_b32 v244, -1
    v_mov_b32 v245, -1
    v_mov_b32 v246, -1
    v_mov_b32 v247, -1
    s_lshl_b32 s46, s46, 18
    s_lshl_b32 s47, s17, 12
    s_add_u32 s46, s46, s47
    s_add_u32 s47, s46, 63963136
    buffer_store_dwordx4 v[244:247], v7, s[4:7], s47 offen sc1
    s_add_u32 s47, s46, 63967232
    buffer_store_dwordx4 v[244:247], v7, s[4:7], s47 offen sc1
    s_add_u32 s47, s46, 64094208
    buffer_store_dwordx4 v[244:247], v7, s[4:7], s47 offen sc1
    s_add_u32 s47, s46, 64098304
    buffer_store_dwordx4 v[244:247], v7, s[4:7], s47 offen sc1
lq11:
    v_mfma_f32_16x16x32_bf16 v[220:223], v[52:55], v[168:171], v[220:223]
    v_mfma_f32_16x16x32_bf16 v[224:227], v[48:51], a[32:35], v[224:227]
    v_mfma_f32_16x16x32_bf16 v[228:231], v[48:51], a[104:107], v[228:231]
    v_mfma_f32_16x16x32_bf16 v[232:235], v[52:55], a[32:35], v[232:235]
    v_mfma_f32_16x16x32_bf16 v[236:239], v[52:55], a[104:107], v[236:239]
    s_waitcnt lgkmcnt(2)
    v_mfma_f32_16x16x32_bf16 v[208:211], v[32:35], v[100:103], v[208:211]
    ds_read_b128 v[48:51], v3 offset:11264
    v_mfma_f32_16x16x32_bf16 v[212:215], v[32:35], v[172:175], v[212:215]
    ds_read_b128 v[52:55], v3 offset:29696
    v_mfma_f32_16x16x32_bf16 v[216:219], v[36:39], v[100:103], v[216:219]
    v_mfma_f32_16x16x32_bf16 v[220:223], v[36:39], v[172:175], v[220:223]
    v_mfma_f32_16x16x32_bf16 v[224:227], v[32:35], a[36:39], v[224:227]
    v_mfma_f32_16x16x32_bf16 v[228:231], v[32:35], a[108:111], v[228:231]
    v_mfma_f32_16x16x32_bf16 v[232:235], v[36:39], a[36:39], v[232:235]
    v_mfma_f32_16x16x32_bf16 v[236:239], v[36:39], a[108:111], v[236:239]
    s_waitcnt lgkmcnt(2)
    v_mfma_f32_16x16x32_bf16 v[208:211], v[40:43], v[104:107], v[208:211]
    ds_read_b128 v[32:35], v3 offset:12288
    v_mfma_f32_16x16x32_bf16 v[212:215], v[40:43], v[176:179], v[212:215]
    ds_read_b128 v[36:39], v3 offset:30720
    v_mfma_f32_16x16x32_bf16 v[216:219], v[44:47], v[104:107], v[216:219]
    v_mfma_f32_16x16x32_bf16 v[220:223], v[44:47], v[176:179], v[220:223]
    v_mfma_f32_16x16x32_bf16 v[224:227], v[40:43], a[40:43], v[224:227]
    v_mfma_f32_16x16x32_bf16 v[228:231], v[40:43], a[112:115], v[228:231]
    v_mfma_f32_16x16x32_bf16 v[232:235], v[44:47], a[40:43], v[232:235]
    v_mfma_f32_16x16x32_bf16 v[236:239], v[44:47], a[112:115], v[236:239]
    s_waitcnt lgkmcnt(2)
    v_mfma_f32_16x16x32_bf16 v[208:211], v[48:51], v[108:111], v[208:211]
    ds_read_b128 v[40:43], v3 offset:13312
    v_mfma_f32_16x16x32_bf16 v[212:215], v[48:51], v[180:183], v[212:215]
    ds_read_b128 v[44:47], v3 offset:31744
    v_mfma_f32_16x16x32_bf16 v[216:219], v[52:55], v[108:111], v[216:219]
    v_mfma_f32_16x16x32_bf16 v[220:223], v[52:55], v[180:183], v[220:223]
    v_mfma_f32_16x16x32_bf16 v[224:227], v[48:51], a[44:47], v[224:227]
    v_mfma_f32_16x16x32_bf16 v[228:231], v[48:51], a[116:119], v[228:231]
    v_mfma_f32_16x16x32_bf16 v[232:235], v[52:55], a[44:47], v[232:235]
    v_mfma_f32_16x16x32_bf16 v[236:239], v[52:55], a[116:119], v[236:239]
    s_waitcnt lgkmcnt(2)
    v_mfma_f32_16x16x32_bf16 v[208:211], v[32:35], v[112:115], v[208:211]
    ds_read_b128 v[48:51], v3 offset:14336
    v_mfma_f32_16x16x32_bf16 v[212:215], v[32:35], v[184:187], v[212:215]
    ds_read_b128 v[52:55], v3 offset:32768
    v_mfma_f32_16x16x32_bf16 v[216:219], v[36:39], v[112:115], v[216:219]
    v_mfma_f32_16x16x32_bf16 v[220:223], v[36:39], v[184:187], v[220:223]
    v_mfma_f32_16x16x32_bf16 v[224:227], v[32:35], a[48:51], v[224:227]
    v_mfma_f32_16x16x32_bf16 v[228:231], v[32:35], a[120:123], v[228:231]
    v_mfma_f32_16x16x32_bf16 v[232:235], v[36:39], a[48:51], v[232:235]
    v_mfma_f32_16x16x32_bf16 v[236:239], v[36:39], a[120:123], v[236:239]
    s_waitcnt lgkmcnt(2)
    v_mfma_f32_16x16x32_bf16 v[208:211], v[40:43], v[116:119], v[208:211]
    ds_read_b128 v[32:35], v3 offset:15360
    v_mfma_f32_16x16x32_bf16 v[212:215], v[40:43], v[188:191], v[212:215]
    ds_read_b128 v[36:39], v3 offset:33792
    v_mfma_f32_16x16x32_bf16 v[216:219], v[44:47], v[116:119], v[216:219]
    v_mfma_f32_16x16x32_bf16 v[220:223], v[44:47], v[188:191], v[220:223]
    v_mfma_f32_16x16x32_bf16 v[224:227], v[40:43], a[52:55], v[224:227]
    v_mfma_f32_16x16x32_bf16 v[228:231], v[40:43], a[124:127], v[228:231]
    v_mfma_f32_16x16x32_bf16 v[232:235], v[44:47], a[52:55], v[232:235]
    v_mfma_f32_16x16x32_bf16 v[236:239], v[44:47], a[124:127], v[236:239]
    s_waitcnt lgkmcnt(2)
    v_mfma_f32_16x16x32_bf16 v[208:211], v[48:51], v[120:123], v[208:211]
    ds_read_b128 v[40:43], v3 offset:16384
    v_mfma_f32_16x16x32_bf16 v[212:215], v[48:51], v[192:195], v[212:215]
    ds_read_b128 v[44:47], v3 offset:34816
    v_mfma_f32_16x16x32_bf16 v[216:219], v[52:55], v[120:123], v[216:219]
    v_mfma_f32_16x16x32_bf16 v[220:223], v[52:55], v[192:195], v[220:223]
    v_mfma_f32_16x16x32_bf16 v[224:227], v[48:51], a[56:59], v[224:227]
    v_mfma_f32_16x16x32_bf16 v[228:231], v[48:51], a[128:131], v[228:231]
    v_mfma_f32_16x16x32_bf16 v[232:235], v[52:55], a[56:59], v[232:235]
    v_mfma_f32_16x16x32_bf16 v[236:239], v[52:55], a[128:131], v[236:239]
    s_waitcnt lgkmcnt(2)
    v_mfma_f32_16x16x32_bf16 v[208:211], v[32:35], v[124:127], v[208:211]
    ds_read_b128 v[48:51], v3 offset:17408
    v_mfma_f32_16x16x32_bf16 v[212:215], v[32:35], v[196:199], v[212:215]
    ds_read_b128 v[52:55], v3 offset:35840
    v_mfma_f32_16x16x32_bf16 v[216:219], v[36:39], v[124:127], v[216:219]
    v_mfma_f32_16x16x32_bf16 v[220:223], v[36:39], v[196:199], v[220:223]
    v_mfma_f32_16x16x32_bf16 v[224:227], v[32:35], a[60:63], v[224:227]
    s_add_u32 s27, s27, 36864
    s_cmp_eq_u32 s27, 110592
    s_cselect_b32 s27, 0, s27
    v_add_u32 v3, s27, v1
    v_mfma_f32_16x16x32_bf16 v[228:231], v[32:35], a[132:135], v[228:231]
    v_mfma_f32_16x16x32_bf16 v[232:235], v[36:39], a[60:63], v[232:235]
    v_mfma_f32_16x16x32_bf16 v[236:239], v[36:39], a[132:135], v[236:239]
    s_waitcnt lgkmcnt(2)
    v_mfma_f32_16x16x32_bf16 v[208:211], v[40:43], v[128:131], v[208:211]
    ds_read_b128 v[32:35], v3 offset:0
    v_mfma_f32_16x16x32_bf16 v[212:215], v[40:43], v[200:203], v[212:215]
    ds_read_b128 v[36:39], v3 offset:18432
    v_mfma_f32_16x16x32_bf16 v[216:219], v[44:47], v[128:131], v[216:219]
    v_mfma_f32_16x16x32_bf16 v[220:223], v[44:47], v[200:203], v[220:223]
    v_mfma_f32_16x16x32_bf16 v[224:227], v[40:43], a[64:67], v[224:227]
    v_mfma_f32_16x16x32_bf16 v[228:231], v[40:43], a[136:139], v[228:231]
    v_mfma_f32_16x16x32_bf16 v[232:235], v[44:47], a[64:67], v[232:235]
    v_mfma_f32_16x16x32_bf16 v[236:239], v[44:47], a[136:139], v[236:239]
    s_waitcnt lgkmcnt(2)
    v_mfma_f32_16x16x32_bf16 v[208:211], v[48:51], v[132:135], v[208:211]
    ds_read_b128 v[40:43], v3 offset:1024
    v_mfma_f32_16x16x32_bf16 v[212:215], v[48:51], v[204:207], v[212:215]
    ds_read_b128 v[44:47], v3 offset:19456
    v_mfma_f32_16x16x32_bf16 v[216:219], v[52:55], v[132:135], v[216:219]
    v_mfma_f32_16x16x32_bf16 v[220:223], v[52:55], v[204:207], v[220:223]
    v_mfma_f32_16x16x32_bf16 v[224:227], v[48:51], a[68:71], v[224:227]
    v_mfma_f32_16x16x32_bf16 v[228:231], v[48:51], a[140:143], v[228:231]
    v_mfma_f32_16x16x32_bf16 v[232:235], v[52:55], a[68:71], v[232:235]
    v_mfma_f32_16x16x32_bf16 v[236:239], v[52:55], a[140:143], v[236:239]
    s_add_u32 s26, s26, s41
    s_waitcnt vmcnt(0)
    v_cvt_pk_bf16_f32 v8, v208, v209
    v_cvt_pk_bf16_f32 v9, v210, v211
    v_cvt_pk_bf16_f32 v10, v216, v217
    v_cvt_pk_bf16_f32 v11, v218, v219
    v_cvt_pk_bf16_f32 v12, v212, v213
    v_cvt_pk_bf16_f32 v13, v214, v215
    v_cvt_pk_bf16_f32 v14, v220, v221
    v_cvt_pk_bf16_f32 v15, v222, v223
    v_cvt_pk_bf16_f32 v16, v224, v225
    v_cvt_pk_bf16_f32 v17, v226, v227
    v_cvt_pk_bf16_f32 v18, v232, v233
    v_cvt_pk_bf16_f32 v19, v234, v235
    v_cvt_pk_bf16_f32 v20, v228, v229
    v_cvt_pk_bf16_f32 v21, v230, v231
    v_cvt_pk_bf16_f32 v22, v236, v237
    v_cvt_pk_bf16_f32 v23, v238, v239
    s_mov_b64 s[36:37], -1
    s_add_u32 s28, s26, s12
    buffer_store_dwordx4 v[8:11], v7, s[4:7], s28 offen sc1
    s_add_u32 s28, s26, s13
    buffer_store_dwordx4 v[12:15], v7, s[4:7], s28 offen sc1
    s_add_u32 s28, s26, s14
    buffer_store_dwordx4 v[16:19], v7, s[4:7], s28 offen sc1
    s_add_u32 s28, s26, s15
    buffer_store_dwordx4 v[20:23], v7, s[4:7], s28 offen sc1
    s_lshr_b32 s45, s19, 2
    s_cbranch_scc1 qk_vloop_nf
    s_mov_b32 s45, 1
    s_mov_b64 s[36:37], 0
    s_waitcnt vmcnt(0)
    s_barrier
    s_add_u32 s23, s45, s95
    v_mov_b32 v4, s23
    s_mov_b64 exec, s[34:35]
    buffer_store_dword v4, off, s[4:7], s29 sc1
    buffer_store_dword v4, off, s[4:7], s29 offset:128 sc1
    s_mov_b64 exec, -1
qk_vloop_nf:
    s_add_u32 s19, s19, 4
    s_cmp_lt_u32 s19, s20
    s_cbranch_scc1 qk_vloop
qk_done:
    s_waitcnt vmcnt(0) lgkmcnt(0)
    s_barrier
    s_mov_b32 s45, 16
    s_add_u32 s23, s45, s95
    v_mov_b32 v4, s23
    s_mov_b64 exec, s[34:35]
    buffer_store_dword v4, off, s[4:7], s29 sc1
    buffer_store_dword v4, off, s[4:7], s29 offset:128 sc1
    s_mov_b64 exec, -1
    s_cmp_lt_i32 s33, 0
    s_cbranch_scc1 L_memkv
    v_max3_u32 v248, v240, v241, v242
    v_max3_u32 v248, v248, v243, v252
    v_max_u32 v248, v248, v253
    v_min3_u32 v240, v240, v241, v242
    v_min3_u32 v240, v240, v243, v252
    v_min_u32 v240, v240, v253
    v_lshl_add_u32 v248, v248, 16, v240
    v_readfirstlane_b32 s40, v245
    v_readfirstlane_b32 s41, v246
    v_readfirstlane_b32 s42, v247
    v_readfirstlane_b32 s43, v248
    s_cmp_ge_u32 s40, 160
    s_cselect_b32 s43, s43, 0
    s_cmp_ge_u32 s41, 1
    s_cselect_b32 s43, s43, 0
    s_cmp_eq_u32 s42, 1
    s_cselect_b32 s43, s43, 0
    s_cmp_eq_u32 s93, 1000
    s_cselect_b32 s43, s43, 0
    s_mov_b32 s93, 999
    v_mov_b32 v250, s43
    v_mov_b32 v251, 163832
    s_mov_b64 exec, s[34:35]
    ds_write_b32 v251, v250
    s_mov_b64 exec, -1
    s_waitcnt lgkmcnt(0)
    s_barrier
    ds_read_b32 v252, v251
    s_waitcnt lgkmcnt(0)
    v_readfirstlane_b32 s43, v252
    s_barrier
    s_cmp_lg_u32 s43, 2097184
    s_cbranch_scc1 L_qkv_next
    s_mov_b32 s45, s33
    s_mov_b32 s93, 500
    s_branch L_phase2b
L_memkv:
    v_and_b32 v4, 63, v0
    v_and_b32 v2, 7, v4
    v_lshrrev_b32 v5, 4, v4
    v_lshl_add_u32 v2, v5, 3, v2
    v_lshlrev_b32 v2, 4, v2
    v_bfe_u32 v3, v4, 3, 1
    v_mul_u32_u24 v5, 9216, v3
    v_add_u32 v2, v2, v5
    v_mov_b32 v240, 0x05040100
    v_mov_b32 v241, 0x07060302
    v_lshrrev_b32 v5, 5, v4
    v_and_b32 v1, 0xdff, v7
    s_cmp_eq_u32 s16, 2
    s_cbranch_scc1 mk_isv
    v_mov_b32 v5, v3
    v_or_b32 v1, 128, v7
mk_isv:
    v_lshl_add_u32 v1, v5, 17, v1
    s_mov_b32 s28, 0
    s_mov_b32 s19, 2
    s_mov_b32 s24, 138412032
    s_lshl_b32 s26, s17, 12
    s_mov_b32 s21, 69206016
    s_cmp_eq_u32 s16, 2
    s_cselect_b32 s21, 77594624, s21
    s_add_u32 s26, s26, s21
    s_lshl_b32 s29, s17, 7
    s_lshl_b32 s21, s16, 2
    s_add_u32 s29, s29, s21
    s_add_u32 s29, s29, 125829164
mk_loop:
    s_cmp_lg_u32 s18, 0
    s_cbranch_scc1 mk_go
    s_cmp_le_u32 s19, s28
    s_cbranch_scc1 mk_go
    s_mov_b32 s23, 125853696
    s_mov_b32 s21, 4194304
mk_wait:
    buffer_load_dword v4, off, s[4:7], s23 sc1
    s_sub_u32 s21, s21, 1
    s_cbranch_scc1 mk_go
    s_waitcnt vmcnt(0)
    v_readfirstlane_b32 s28, v4
    s_nop 0
    s_sub_u32 s28, s28, s95
    s_cmp_gt_u32 s28, 64
    s_cselect_b32 s28, 0, s28
    s_cmp_le_u32 s19, s28
    s_cbranch_scc1 mk_go
    s_sleep 4
    s_branch mk_wait
mk_go:
    s_barrier
    s_add_u32 s21, s24, 4096
    s_add_u32 s23, s24, 8192
    buffer_load_dwordx4 v[24:27], v2, s[4:7], s24 offen offset:0 sc1
    buffer_load_dwordx4 v[28:31], v2, s[4:7], s24 offen offset:512 sc1
    buffer_load_dwordx4 v[32:35], v2, s[4:7], s21 offen offset:0 sc1
    buffer_load_dwordx4 v[36:39], v2, s[4:7], s21 offen offset:512 sc1
    buffer_load_dwordx4 v[40:43], v2, s[4:7], s24 offen offset:1024 sc1
    buffer_load_dwordx4 v[44:47], v2, s[4:7], s24 offen offset:1536 sc1
    buffer_load_dwordx4 v[48:51], v2, s[4:7], s21 offen offset:1024 sc1
    buffer_load_dwordx4 v[52:55], v2, s[4:7], s21 offen offset:1536 sc1
    buffer_load_dwordx4 v[56:59], v2, s[4:7], s24 offen offset:2048 sc1
    buffer_load_dwordx4 v[60:63], v2, s[4:7], s24 offen offset:2560 sc1
    buffer_load_dwordx4 v[208:211], v2, s[4:7], s21 offen offset:2048 sc1
    buffer_load_dwordx4 v[212:215], v2, s[4:7], s21 offen offset:2560 sc1
    buffer_load_dwordx4 v[216:219], v2, s[4:7], s24 offen offset:3072 sc1
    buffer_load_dwordx4 v[220:223], v2, s[4:7], s24 offen offset:3584 sc1
    buffer_load_dwordx4 v[224:227], v2, s[4:7], s21 offen offset:3072 sc1
    buffer_load_dwordx4 v[228:231], v2, s[4:7], s21 offen offset:3584 sc1
    buffer_load_dwordx4 v[232:235], v2, s[4:7], s23 offen offset:0 sc1
    buffer_load_dwordx4 v[236:239], v2, s[4:7], s23 offen offset:512 sc1
    s_add_u32 s24, s24, 18432
    s_cmp_eq_u32 s16, 2
    s_cbranch_scc1 mk_v
    s_waitcnt vmcnt(17)
    s_waitcnt vmcnt(16)
    v_mfma_f32_16x16x32_bf16 v[8:11], v[64:67], v[24:27], 0
    v_mfma_f32_16x16x32_bf16 v[12:15], v[136:139], v[24:27], 0
    v_mfma_f32_16x16x32_bf16 v[16:19], a[0:3], v[24:27], 0
    v_mfma_f32_16x16x32_bf16 v[20:23], a[72:75], v[24:27], 0
    s_waitcnt vmcnt(15)
    v_mfma_f32_16x16x32_bf16 v[8:11], v[68:71], v[28:31], v[8:11]
    v_mfma_f32_16x16x32_bf16 v[12:15], v[140:143], v[28:31], v[12:15]
    v_mfma_f32_16x16x32_bf16 v[16:19], a[4:7], v[28:31], v[16:19]
    v_mfma_f32_16x16x32_bf16 v[20:23], a[76:79], v[28:31], v[20:23]
    s_waitcnt vmcnt(14)
    v_mfma_f32_16x16x32_bf16 v[8:11], v[72:75], v[32:35], v[8:11]
    v_mfma_f32_16x16x32_bf16 v[12:15], v[144:147], v[32:35], v[12:15]
    v_mfma_f32_16x16x32_bf16 v[16:19], a[8:11], v[32:35], v[16:19]
    v_mfma_f32_16x16x32_bf16 v[20:23], a[80:83], v[32:35], v[20:23]
    s_waitcnt vmcnt(13)
    v_mfma_f32_16x16x32_bf16 v[8:11], v[76:79], v[36:39], v[8:11]
    v_mfma_f32_16x16x32_bf16 v[12:15], v[148:151], v[36:39], v[12:15]
    v_mfma_f32_16x16x32_bf16 v[16:19], a[12:15], v[36:39], v[16:19]
    v_mfma_f32_16x16x32_bf16 v[20:23], a[84:87], v[36:39], v[20:23]
    s_waitcnt vmcnt(12)
    v_mfma_f32_16x16x32_bf16 v[8:11], v[80:83], v[40:43], v[8:11]
    v_mfma_f32_16x16x32_bf16 v[12:15], v[152:155], v[40:43], v[12:15]
    v_mfma_f32_16x16x32_bf16 v[16:19], a[16:19], v[40:43], v[16:19]
    v_mfma_f32_16x16x32_bf16 v[20:23], a[88:91], v[40:43], v[20:23]
    s_waitcnt vmcnt(11)
    v_mfma_f32_16x16x32_bf16 v[8:11], v[84:87], v[44:47], v[8:11]
    v_mfma_f32_16x16x32_bf16 v[12:15], v[156:159], v[44:47], v[12:15]
    v_mfma_f32_16x16x32_bf16 v[16:19], a[20:23], v[44:47], v[16:19]
    v_mfma_f32_16x16x32_bf16 v[20:23], a[92:95], v[44:47], v[20:23]
    s_waitcnt vmcnt(10)
    v_mfma_f32_16x16x32_bf16 v[8:11], v[88:91], v[48:51], v[8:11]
    v_mfma_f32_16x16x32_bf16 v[12:15], v[160:163], v[48:51], v[12:15]
    v_mfma_f32_16x16x32_bf16 v[16:19], a[24:27], v[48:51], v[16:19]
    v_mfma_f32_16x16x32_bf16 v[20:23], a[96:99], v[48:51], v[20:23]
    s_waitcnt vmcnt(9)
    v_mfma_f32_16x16x32_bf16 v[8:11], v[92:95], v[52:55], v[8:11]
    v_mfma_f32_16x16x32_bf16 v[12:15], v[164:167], v[52:55], v[12:15]
    v_mfma_f32_16x16x32_bf16 v[16:19], a[28:31], v[52:55], v[16:19]
    v_mfma_f32_16x16x32_bf16 v[20:23], a[100:103], v[52:55], v[20:23]
    s_waitcnt vmcnt(8)
    v_mfma_f32_16x16x32_bf16 v[8:11], v[96:99], v[56:59], v[8:11]
    v_mfma_f32_16x16x32_bf16 v[12:15], v[168:171], v[56:59], v[12:15]
    v_mfma_f32_16x16x32_bf16 v[16:19], a[32:35], v[56:59], v[16:19]
    v_mfma_f32_16x16x32_bf16 v[20:23], a[104:107], v[56:59], v[20:23]
    s_waitcnt vmcnt(7)
    v_mfma_f32_16x16x32_bf16 v[8:11], v[100:103], v[60:63], v[8:11]
    v_mfma_f32_16x16x32_bf16 v[12:15], v[172:175], v[60:63], v[12:15]
    v_mfma_f32_16x16x32_bf16 v[16:19], a[36:39], v[60:63], v[16:19]
    v_mfma_f32_16x16x32_bf16 v[20:23], a[108:111], v[60:63], v[20:23]
    s_waitcnt vmcnt(6)
    v_mfma_f32_16x16x32_bf16 v[8:11], v[104:107], v[208:211], v[8:11]
    v_mfma_f32_16x16x32_bf16 v[12:15], v[176:179], v[208:211], v[12:15]
    v_mfma_f32_16x16x32_bf16 v[16:19], a[40:43], v[208:211], v[16:19]
    v_mfma_f32_16x16x32_bf16 v[20:23], a[112:115], v[208:211], v[20:23]
    s_waitcnt vmcnt(5)
    v_mfma_f32_16x16x32_bf16 v[8:11], v[108:111], v[212:215], v[8:11]
    v_mfma_f32_16x16x32_bf16 v[12:15], v[180:183], v[212:215], v[12:15]
    v_mfma_f32_16x16x32_bf16 v[16:19], a[44:47], v[212:215], v[16:19]
    v_mfma_f32_16x16x32_bf16 v[20:23], a[116:119], v[212:215], v[20:23]
    s_waitcnt vmcnt(4)
    v_mfma_f32_16x16x32_bf16 v[8:11], v[112:115], v[216:219], v[8:11]
    v_mfma_f32_16x16x32_bf16 v[12:15], v[184:187], v[216:219], v[12:15]
    v_mfma_f32_16x16x32_bf16 v[16:19], a[48:51], v[216:219], v[16:19]
    v_mfma_f32_16x16x32_bf16 v[20:23], a[120:123], v[216:219], v[20:23]
    s_waitcnt vmcnt(3)
    v_mfma_f32_16x16x32_bf16 v[8:11], v[116:119], v[220:223], v[8:11]
    v_mfma_f32_16x16x32_bf16 v[12:15], v[188:191], v[220:223], v[12:15]
    v_mfma_f32_16x16x32_bf16 v[16:19], a[52:55], v[220:223], v[16:19]
    v_mfma_f32_16x16x32_bf16 v[20:23], a[124:127], v[220:223], v[20:23]
    s_waitcnt vmcnt(2)
    v_mfma_f32_16x16x32_bf16 v[8:11], v[120:123], v[224:227], v[8:11]
    v_mfma_f32_16x16x32_bf16 v[12:15], v[192:195], v[224:227], v[12:15]
    v_mfma_f32_16x16x32_bf16 v[16:19], a[56:59], v[224:227], v[16:19]
    v_mfma_f32_16x16x32_bf16 v[20:23], a[128:131], v[224:227], v[20:23]
    s_waitcnt vmcnt(1)
    v_mfma_f32_16x16x32_bf16 v[8:11], v[124:127], v[228:231], v[8:11]
    v_mfma_f32_16x16x32_bf16 v[12:15], v[196:199], v[228:231], v[12:15]
    v_mfma_f32_16x16x32_bf16 v[16:19], a[60:63], v[228:231], v[16:19]
    v_mfma_f32_16x16x32_bf16 v[20:23], a[132:135], v[228:231], v[20:23]
    s_waitcnt vmcnt(0)
    v_mfma_f32_16x16x32_bf16 v[8:11], v[128:131], v[232:235], v[8:11]
    v_mfma_f32_16x16x32_bf16 v[12:15], v[200:203], v[232:235], v[12:15]
    v_mfma_f32_16x16x32_bf16 v[16:19], a[64:67], v[232:235], v[16:19]
    v_mfma_f32_16x16x32_bf16 v[20:23], a[136:139], v[232:235], v[20:23]
    v_mfma_f32_16x16x32_bf16 v[8:11], v[132:135], v[236:239], v[8:11]
    v_mfma_f32_16x16x32_bf16 v[12:15], v[204:207], v[236:239], v[12:15]
    v_mfma_f32_16x16x32_bf16 v[16:19], a[68:71], v[236:239], v[16:19]
    v_mfma_f32_16x16x32_bf16 v[20:23], a[140:143], v[236:239], v[20:23]
    s_nop 7
    s_branch mk_st
mk_v:
    s_waitcnt vmcnt(17)
    s_waitcnt vmcnt(16)
    v_mfma_f32_16x16x32_bf16 v[8:11], v[24:27], v[64:67], 0
    v_mfma_f32_16x16x32_bf16 v[12:15], v[24:27], v[136:139], 0
    v_mfma_f32_16x16x32_bf16 v[16:19], v[24:27], a[0:3], 0
    v_mfma_f32_16x16x32_bf16 v[20:23], v[24:27], a[72:75], 0
    s_waitcnt vmcnt(15)
    v_mfma_f32_16x16x32_bf16 v[8:11], v[28:31], v[68:71], v[8:11]
    v_mfma_f32_16x16x32_bf16 v[12:15], v[28:31], v[140:143], v[12:15]
    v_mfma_f32_16x16x32_bf16 v[16:19], v[28:31], a[4:7], v[16:19]
    v_mfma_f32_16x16x32_bf16 v[20:23], v[28:31], a[76:79], v[20:23]
    s_waitcnt vmcnt(14)
    v_mfma_f32_16x16x32_bf16 v[8:11], v[32:35], v[72:75], v[8:11]
    v_mfma_f32_16x16x32_bf16 v[12:15], v[32:35], v[144:147], v[12:15]
    v_mfma_f32_16x16x32_bf16 v[16:19], v[32:35], a[8:11], v[16:19]
    v_mfma_f32_16x16x32_bf16 v[20:23], v[32:35], a[80:83], v[20:23]
    s_waitcnt vmcnt(13)
    v_mfma_f32_16x16x32_bf16 v[8:11], v[36:39], v[76:79], v[8:11]
    v_mfma_f32_16x16x32_bf16 v[12:15], v[36:39], v[148:151], v[12:15]
    v_mfma_f32_16x16x32_bf16 v[16:19], v[36:39], a[12:15], v[16:19]
    v_mfma_f32_16x16x32_bf16 v[20:23], v[36:39], a[84:87], v[20:23]
    s_waitcnt vmcnt(12)
    v_mfma_f32_16x16x32_bf16 v[8:11], v[40:43], v[80:83], v[8:11]
    v_mfma_f32_16x16x32_bf16 v[12:15], v[40:43], v[152:155], v[12:15]
    v_mfma_f32_16x16x32_bf16 v[16:19], v[40:43], a[16:19], v[16:19]
    v_mfma_f32_16x16x32_bf16 v[20:23], v[40:43], a[88:91], v[20:23]
    s_waitcnt vmcnt(11)
    v_mfma_f32_16x16x32_bf16 v[8:11], v[44:47], v[84:87], v[8:11]
    v_mfma_f32_16x16x32_bf16 v[12:15], v[44:47], v[156:159], v[12:15]
    v_mfma_f32_16x16x32_bf16 v[16:19], v[44:47], a[20:23], v[16:19]
    v_mfma_f32_16x16x32_bf16 v[20:23], v[44:47], a[92:95], v[20:23]
    s_waitcnt vmcnt(10)
    v_mfma_f32_16x16x32_bf16 v[8:11], v[48:51], v[88:91], v[8:11]
    v_mfma_f32_16x16x32_bf16 v[12:15], v[48:51], v[160:163], v[12:15]
    v_mfma_f32_16x16x32_bf16 v[16:19], v[48:51], a[24:27], v[16:19]
    v_mfma_f32_16x16x32_bf16 v[20:23], v[48:51], a[96:99], v[20:23]
    s_waitcnt vmcnt(9)
    v_mfma_f32_16x16x32_bf16 v[8:11], v[52:55], v[92:95], v[8:11]
    v_mfma_f32_16x16x32_bf16 v[12:15], v[52:55], v[164:167], v[12:15]
    v_mfma_f32_16x16x32_bf16 v[16:19], v[52:55], a[28:31], v[16:19]
    v_mfma_f32_16x16x32_bf16 v[20:23], v[52:55], a[100:103], v[20:23]
    s_waitcnt vmcnt(8)
    v_mfma_f32_16x16x32_bf16 v[8:11], v[56:59], v[96:99], v[8:11]
    v_mfma_f32_16x16x32_bf16 v[12:15], v[56:59], v[168:171], v[12:15]
    v_mfma_f32_16x16x32_bf16 v[16:19], v[56:59], a[32:35], v[16:19]
    v_mfma_f32_16x16x32_bf16 v[20:23], v[56:59], a[104:107], v[20:23]
    s_waitcnt vmcnt(7)
    v_mfma_f32_16x16x32_bf16 v[8:11], v[60:63], v[100:103], v[8:11]
    v_mfma_f32_16x16x32_bf16 v[12:15], v[60:63], v[172:175], v[12:15]
    v_mfma_f32_16x16x32_bf16 v[16:19], v[60:63], a[36:39], v[16:19]
    v_mfma_f32_16x16x32_bf16 v[20:23], v[60:63], a[108:111], v[20:23]
    s_waitcnt vmcnt(6)
    v_mfma_f32_16x16x32_bf16 v[8:11], v[208:211], v[104:107], v[8:11]
    v_mfma_f32_16x16x32_bf16 v[12:15], v[208:211], v[176:179], v[12:15]
    v_mfma_f32_16x16x32_bf16 v[16:19], v[208:211], a[40:43], v[16:19]
    v_mfma_f32_16x16x32_bf16 v[20:23], v[208:211], a[112:115], v[20:23]
    s_waitcnt vmcnt(5)
    v_mfma_f32_16x16x32_bf16 v[8:11], v[212:215], v[108:111], v[8:11]
    v_mfma_f32_16x16x32_bf16 v[12:15], v[212:215], v[180:183], v[12:15]
    v_mfma_f32_16x16x32_bf16 v[16:19], v[212:215], a[44:47], v[16:19]
    v_mfma_f32_16x16x32_bf16 v[20:23], v[212:215], a[116:119], v[20:23]
    s_waitcnt vmcnt(4)
    v_mfma_f32_16x16x32_bf16 v[8:11], v[216:219], v[112:115], v[8:11]
    v_mfma_f32_16x16x32_bf16 v[12:15], v[216:219], v[184:187], v[12:15]
    v_mfma_f32_16x16x32_bf16 v[16:19], v[216:219], a[48:51], v[16:19]
    v_mfma_f32_16x16x32_bf16 v[20:23], v[216:219], a[120:123], v[20:23]
    s_waitcnt vmcnt(3)
    v_mfma_f32_16x16x32_bf16 v[8:11], v[220:223], v[116:119], v[8:11]
    v_mfma_f32_16x16x32_bf16 v[12:15], v[220:223], v[188:191], v[12:15]
    v_mfma_f32_16x16x32_bf16 v[16:19], v[220:223], a[52:55], v[16:19]
    v_mfma_f32_16x16x32_bf16 v[20:23], v[220:223], a[124:127], v[20:23]
    s_waitcnt vmcnt(2)
    v_mfma_f32_16x16x32_bf16 v[8:11], v[224:227], v[120:123], v[8:11]
    v_mfma_f32_16x16x32_bf16 v[12:15], v[224:227], v[192:195], v[12:15]
    v_mfma_f32_16x16x32_bf16 v[16:19], v[224:227], a[56:59], v[16:19]
    v_mfma_f32_16x16x32_bf16 v[20:23], v[224:227], a[128:131], v[20:23]
    s_waitcnt vmcnt(1)
    v_mfma_f32_16x16x32_bf16 v[8:11], v[228:231], v[124:127], v[8:11]
    v_mfma_f32_16x16x32_bf16 v[12:15], v[228:231], v[196:199], v[12:15]
    v_mfma_f32_16x16x32_bf16 v[16:19], v[228:231], a[60:63], v[16:19]
    v_mfma_f32_16x16x32_bf16 v[20:23], v[228:231], a[132:135], v[20:23]
    s_waitcnt vmcnt(0)
    v_mfma_f32_16x16x32_bf16 v[8:11], v[232:235], v[128:131], v[8:11]
    v_mfma_f32_16x16x32_bf16 v[12:15], v[232:235], v[200:203], v[12:15]
    v_mfma_f32_16x16x32_bf16 v[16:19], v[232:235], a[64:67], v[16:19]
    v_mfma_f32_16x16x32_bf16 v[20:23], v[232:235], a[136:139], v[20:23]
    v_mfma_f32_16x16x32_bf16 v[8:11], v[236:239], v[132:135], v[8:11]
    v_mfma_f32_16x16x32_bf16 v[12:15], v[236:239], v[204:207], v[12:15]
    v_mfma_f32_16x16x32_bf16 v[16:19], v[236:239], a[68:71], v[16:19]
    v_mfma_f32_16x16x32_bf16 v[20:23], v[236:239], a[140:143], v[20:23]
    s_nop 4
    v_pk_mul_f32 v[8:9], v[8:9], 0.5 op_sel_hi:[1,0]
    v_pk_mul_f32 v[10:11], v[10:11], 0.5 op_sel_hi:[1,0]
    v_pk_mul_f32 v[12:13], v[12:13], 0.5 op_sel_hi:[1,0]
    v_pk_mul_f32 v[14:15], v[14:15], 0.5 op_sel_hi:[1,0]
    v_pk_mul_f32 v[16:17], v[16:17], 0.5 op_sel_hi:[1,0]
    v_pk_mul_f32 v[18:19], v[18:19], 0.5 op_sel_hi:[1,0]
    v_pk_mul_f32 v[20:21], v[20:21], 0.5 op_sel_hi:[1,0]
    v_pk_mul_f32 v[22:23], v[22:23], 0.5 op_sel_hi:[1,0]
mk_st:
    s_nop 1
    v_cvt_pk_bf16_f32 v24, v8, v9
    v_cvt_pk_bf16_f32 v25, v10, v11
    v_cvt_pk_bf16_f32 v26, v12, v13
    v_cvt_pk_bf16_f32 v27, v14, v15
    v_cvt_pk_bf16_f32 v28, v16, v17
    v_cvt_pk_bf16_f32 v29, v18, v19
    v_cvt_pk_bf16_f32 v30, v20, v21
    v_cvt_pk_bf16_f32 v31, v22, v23
    s_add_u32 s21, s26, 4096
    buffer_store_dwordx4 v[24:27], v1, s[4:7], s26 offen sc1
    buffer_store_dwordx4 v[28:31], v1, s[4:7], s21 offen sc1
    s_add_u32 s22, s19, s95
    s_waitcnt vmcnt(0)
    s_barrier
    v_mov_b32 v4, s22
    s_mov_b64 exec, s[34:35]
    buffer_store_dword v4, off, s[4:7], s29 sc1
    buffer_store_dword v4, off, s[4:7], s29 offset:128 sc1
    s_mov_b64 exec, -1
    s_add_u32 s19, s19, 2
    s_add_u32 s26, s26, 262144
    s_cmp_le_u32 s19, 56
    s_cbranch_scc1 mk_loop
    s_mov_b32 s45, 0
    s_cmp_lg_u32 s93, 1000
    s_cbranch_scc1 L_wf_next
    s_mov_b32 s45, 2
    s_mov_b32 s8, s76
    s_mov_b32 s9, s77
    s_mov_b32 s10, 4718592
    s_mov_b32 s11, 0x20000
    s_branch L_att_next
L_ssm_next:
    s_sub_u32 s93, s93, 1
    s_cbranch_scc1 L_exit
    s_mov_b32 s37, 8
    v_mov_b32 v250, 1
    v_mov_b32 v251, 163832
    v_cmp_eq_u32 vcc, 0, v0
    s_nop 0
    s_and_saveexec_b64 s[38:39], vcc
    s_cbranch_execz tk12
    buffer_atomic_add v250, off, s[84:87], s37 sc0
    s_waitcnt vmcnt(0)
    ds_write_b32 v251, v250
    s_waitcnt lgkmcnt(0)
tk12:
    s_mov_b64 exec, -1
    s_barrier
    ds_read_b32 v252, v251
    s_waitcnt lgkmcnt(0)
    v_readfirstlane_b32 s20, v252
    s_barrier
    s_nop 3
    s_cmp_ge_u32 s20, 72
    s_cbranch_scc1 L_ssm_done
    s_lshl_b32 s20, s20, 3
    v_lshrrev_b32 v5, 6, v0
    s_nop 0
    v_readfirstlane_b32 s21, v5
    v_and_b32 v1, 63, v0
    v_and_b32 v2, 15, v1
    v_lshrrev_b32 v3, 4, v1
    v_lshlrev_b32 v4, 14, v5
    s_mov_b32 s8, s62
    s_mov_b32 s9, s63
    s_mov_b32 s10, 2359296
    s_mov_b32 s11, 0x20000
    s_mov_b32 s16, s76
    s_mov_b32 s17, s77
    s_mov_b32 s18, 4718592
    s_mov_b32 s19, 0x20000
    s_add_u32 s22, s20, s21
    s_lshl_b32 s23, s22, 8
    v_lshlrev_b32 v6, 3, v2
    v_lshl_add_u32 v6, v3, 1, v6
    s_mov_b32 s12, s64
    s_mov_b32 s13, s65
    s_mov_b32 s14, 147456
    s_mov_b32 s15, 0x20000
    buffer_load_ushort v8, v6, s[12:15], s23 offen offset:0
    buffer_load_ushort v12, v6, s[12:15], s23 offen offset:128
    buffer_load_ushort v16, v6, s[12:15], s23 offen offset:1024
    buffer_load_ushort v20, v6, s[12:15], s23 offen offset:1152
    s_mov_b32 s12, s66
    s_mov_b32 s13, s67
    s_mov_b32 s14, 147456
    s_mov_b32 s15, 0x20000
    buffer_load_ushort v9, v6, s[12:15], s23 offen offset:0
    buffer_load_ushort v13, v6, s[12:15], s23 offen offset:128
    buffer_load_ushort v17, v6, s[12:15], s23 offen offset:1024
    buffer_load_ushort v21, v6, s[12:15], s23 offen offset:1152
    s_mov_b32 s12, s68
    s_mov_b32 s13, s69
    s_mov_b32 s14, 147456
    s_mov_b32 s15, 0x20000
    buffer_load_ushort v10, v6, s[12:15], s23 offen offset:0
    buffer_load_ushort v14, v6, s[12:15], s23 offen offset:128
    buffer_load_ushort v18, v6, s[12:15], s23 offen offset:1024
    buffer_load_ushort v22, v6, s[12:15], s23 offen offset:1152
    s_mov_b32 s12, s70
    s_mov_b32 s13, s71
    s_mov_b32 s14, 147456
    s_mov_b32 s15, 0x20000
    buffer_load_ushort v11, v6, s[12:15], s23 offen offset:0
    buffer_load_ushort v15, v6, s[12:15], s23 offen offset:128
    buffer_load_ushort v19, v6, s[12:15], s23 offen offset:1024
    buffer_load_ushort v23, v6, s[12:15], s23 offen offset:1152
    s_mov_b32 s12, s72
    s_mov_b32 s13, s73
    s_mov_b32 s14, 1152
    s_mov_b32 s15, 0x20000
    s_lshl_b32 s23, s22, 1
    buffer_load_ushort v24, off, s[12:15], s23
    buffer_load_ushort v25, off, s[12:15], s23 offset:8
    v_mul_u32_u24 v5, 9216, v0
    s_lshl_b32 s22, s20, 1
    s_add_u32 s23, s22, 0
    buffer_load_dwordx4 v[208:211], v5, s[8:11], s23 offen
    s_add_u32 s23, s22, 1152
    buffer_load_dwordx4 v[212:215], v5, s[8:11], s23 offen
    s_add_u32 s23, s22, 2304
    buffer_load_dwordx4 v[216:219], v5, s[8:11], s23 offen
    s_add_u32 s23, s22, 3456
    buffer_load_dwordx4 v[220:223], v5, s[8:11], s23 offen
    s_add_u32 s23, s22, 4608
    buffer_load_dwordx4 v[224:227], v5, s[8:11], s23 offen
    s_add_u32 s23, s22, 5760
    buffer_load_dwordx4 v[228:231], v5, s[8:11], s23 offen
    s_add_u32 s23, s22, 6912
    buffer_load_dwordx4 v[232:235], v5, s[8:11], s23 offen
    s_add_u32 s23, s22, 8064
    buffer_load_dwordx4 v[236:239], v5, s[8:11], s23 offen
    s_mov_b32 s26, 0x3fb8aa3b
    s_mov_b32 s27, 0x3e22f983
    s_mov_b32 s28, 0
    v_cvt_f32_u32 v26, v2
    v_mul_f32 v27, 0x41800000, v26
    s_waitcnt vmcnt(8)
    s_nop 0
ss_pass:
    v_mov_b32 v36, 0
    v_mov_b32 v37, 0
    v_lshl_add_u32 v6, v1, 3, v4
    ds_write_b64 v6, v[36:37] offset:0
    v_lshlrev_b32 v38, 16, v24
    v_mul_f32 v38, s26, v38
    v_exp_f32 v38, v38
    s_nop 0
    v_cvt_pk_bf16_f32 v38, v38, v38
    v_and_b32 v38, 0xffff0000, v38
    v_add_f32 v39, v38, v38
    v_lshlrev_b32 v28, 16, v8
    v_mul_f32 v28, s26, v28
    v_exp_f32 v28, v28
    s_nop 0
    v_cvt_pk_bf16_f32 v28, v28, v28
    v_and_b32 v28, 0xffff0000, v28
    v_mul_f32 v28, v28, v38
    v_mul_f32 v28, s26, v28
    v_sub_f32 v28, 0, v28
    v_lshlrev_b32 v29, 16, v9
    v_mul_f32 v29, v29, v38
    v_mul_f32 v29, s27, v29
    v_lshlrev_b32 v30, 16, v10
    v_mul_f32 v30, v30, v39
    v_lshlrev_b32 v31, 16, v11
    v_mul_f32 v31, v31, v39
    v_lshlrev_b32 v32, 16, v12
    v_mul_f32 v32, s26, v32
    v_exp_f32 v32, v32
    s_nop 0
    v_cvt_pk_bf16_f32 v32, v32, v32
    v_and_b32 v32, 0xffff0000, v32
    v_mul_f32 v32, v32, v38
    v_mul_f32 v32, s26, v32
    v_sub_f32 v32, 0, v32
    v_lshlrev_b32 v33, 16, v13
    v_mul_f32 v33, v33, v38
    v_mul_f32 v33, s27, v33
    v_lshlrev_b32 v34, 16, v14
    v_mul_f32 v34, v34, v39
    v_lshlrev_b32 v35, 16, v15
    v_mul_f32 v35, v35, v39
    v_mov_b64 v[48:49], 0
    v_mov_b64 v[50:51], 0
    v_mov_b64 v[52:53], 0
    v_mov_b64 v[54:55], 0
    v_mov_b64 v[56:57], 0
    v_mov_b64 v[58:59], 0
    v_mov_b64 v[60:61], 0
    v_mov_b64 v[62:63], 0
    s_mov_b32 s25, 0
    s_nop 0
ss_kg:
    v_mov_b64_dpp v[64:65], v[28:29] row_newbcast:0 row_mask:0xf bank_mask:0xf
    v_mov_b64_dpp v[66:67], v[30:31] row_newbcast:0 row_mask:0xf bank_mask:0xf
    v_pk_mul_f32 v[94:95], v[64:65], v[26:27] op_sel_hi:[1,0]
    v_pk_mul_f32 v[96:97], v[64:65], v[26:27] op_sel:[0,1] op_sel_hi:[1,1]
    v_fract_f32 v95, v95
    v_fract_f32 v97, v97
    v_exp_f32 v94, v94
    v_exp_f32 v96, v96
    v_cos_f32 v68, v95
    v_sin_f32 v69, v95
    v_cos_f32 v76, v97
    v_sin_f32 v77, v97
    v_pk_mul_f32 v[68:69], v[68:69], v[94:95] op_sel_hi:[1,0]
    v_pk_mul_f32 v[76:77], v[76:77], v[96:97] op_sel_hi:[1,0]
    v_pk_mul_f32 v[92:93], v[76:77], v[76:77] op_sel:[1,1] op_sel_hi:[0,1]
    v_pk_fma_f32 v[78:79], v[76:77], v[76:77], v[92:93] op_sel:[0,0,0] op_sel_hi:[0,1,1] neg_lo:[0,0,1]
    v_pk_mul_f32 v[94:95], v[68:69], v[68:69] op_sel:[1,1] op_sel_hi:[0,1]
    v_pk_fma_f32 v[70:71], v[68:69], v[68:69], v[94:95] op_sel:[0,0,0] op_sel_hi:[0,1,1] neg_lo:[0,0,1]
    v_pk_mul_f32 v[92:93], v[78:79], v[78:79] op_sel:[1,1] op_sel_hi:[0,1]
    v_pk_fma_f32 v[80:81], v[78:79], v[78:79], v[92:93] op_sel:[0,0,0] op_sel_hi:[0,1,1] neg_lo:[0,0,1]
    v_pk_mul_f32 v[94:95], v[70:71], v[70:71] op_sel:[1,1] op_sel_hi:[0,1]
    v_pk_fma_f32 v[72:73], v[70:71], v[70:71], v[94:95] op_sel:[0,0,0] op_sel_hi:[0,1,1] neg_lo:[0,0,1]
    v_pk_mul_f32 v[92:93], v[80:81], v[80:81] op_sel:[1,1] op_sel_hi:[0,1]
    v_pk_fma_f32 v[82:83], v[80:81], v[80:81], v[92:93] op_sel:[0,0,0] op_sel_hi:[0,1,1] neg_lo:[0,0,1]
    v_pk_mul_f32 v[94:95], v[72:73], v[72:73] op_sel:[1,1] op_sel_hi:[0,1]
    v_pk_fma_f32 v[74:75], v[72:73], v[72:73], v[94:95] op_sel:[0,0,0] op_sel_hi:[0,1,1] neg_lo:[0,0,1]
    v_pk_mul_f32 v[92:93], v[82:83], v[82:83] op_sel:[1,1] op_sel_hi:[0,1]
    v_pk_fma_f32 v[84:85], v[82:83], v[82:83], v[92:93] op_sel:[0,0,0] op_sel_hi:[0,1,1] neg_lo:[0,0,1]
    v_pk_mul_f32 v[94:95], v[66:67], v[76:77] op_sel:[1,1] op_sel_hi:[1,0]
    v_pk_fma_f32 v[86:87], v[66:67], v[76:77], v[94:95] op_sel:[0,0,0] op_sel_hi:[0,1,1] neg_lo:[0,0,1] neg_hi:[1,0,1]
    v_mov_b32_dpp v80, v78 row_ror:8 row_mask:0xf bank_mask:0x3
    v_mov_b32_dpp v81, v79 row_ror:8 row_mask:0xf bank_mask:0x3
    v_mov_b32_dpp v82, v84 row_ror:8 row_mask:0xf bank_mask:0x3
    v_mov_b32_dpp v83, v85 row_ror:8 row_mask:0xf bank_mask:0x3
    v_pk_mul_f32 v[92:93], v[66:67], v[80:81] op_sel:[1,1] op_sel_hi:[1,0]
    v_pk_fma_f32 v[88:89], v[66:67], v[80:81], v[92:93] op_sel:[0,0,0] op_sel_hi:[0,1,1] neg_lo:[0,0,1] neg_hi:[1,0,1]
    v_pk_mul_f32 v[94:95], v[66:67], v[82:83] op_sel:[1,1] op_sel_hi:[1,0]
    v_pk_fma_f32 v[90:91], v[66:67], v[82:83], v[94:95] op_sel:[0,0,0] op_sel_hi:[0,1,1] neg_lo:[0,0,1] neg_hi:[1,0,1]
    v_mfma_f32_16x16x4_f32 v[48:51], v86, v68, v[48:51]
    v_mfma_f32_16x16x4_f32 v[52:55], v88, v70, v[52:55]
    v_mfma_f32_16x16x4_f32 v[56:59], v88, v72, v[56:59]
    v_mfma_f32_16x16x4_f32 v[60:63], v90, v74, v[60:63]
    v_mfma_f32_16x16x4_f32 v[48:51], v87, v69, v[48:51]
    v_mfma_f32_16x16x4_f32 v[52:55], v89, v71, v[52:55]
    v_mfma_f32_16x16x4_f32 v[56:59], v89, v73, v[56:59]
    v_mfma_f32_16x16x4_f32 v[60:63], v91, v75, v[60:63]
    v_mov_b64_dpp v[64:65], v[28:29] row_newbcast:1 row_mask:0xf bank_mask:0xf
    v_mov_b64_dpp v[66:67], v[30:31] row_newbcast:1 row_mask:0xf bank_mask:0xf
    v_pk_mul_f32 v[94:95], v[64:65], v[26:27] op_sel_hi:[1,0]
    v_pk_mul_f32 v[96:97], v[64:65], v[26:27] op_sel:[0,1] op_sel_hi:[1,1]
    v_fract_f32 v95, v95
    v_fract_f32 v97, v97
    v_exp_f32 v94, v94
    v_exp_f32 v96, v96
    v_cos_f32 v68, v95
    v_sin_f32 v69, v95
    v_cos_f32 v76, v97
    v_sin_f32 v77, v97
    v_pk_mul_f32 v[68:69], v[68:69], v[94:95] op_sel_hi:[1,0]
    v_pk_mul_f32 v[76:77], v[76:77], v[96:97] op_sel_hi:[1,0]
    v_pk_mul_f32 v[92:93], v[76:77], v[76:77] op_sel:[1,1] op_sel_hi:[0,1]
    v_pk_fma_f32 v[78:79], v[76:77], v[76:77], v[92:93] op_sel:[0,0,0] op_sel_hi:[0,1,1] neg_lo:[0,0,1]
    v_pk_mul_f32 v[94:95], v[68:69], v[68:69] op_sel:[1,1] op_sel_hi:[0,1]
    v_pk_fma_f32 v[70:71], v[68:69], v[68:69], v[94:95] op_sel:[0,0,0] op_sel_hi:[0,1,1] neg_lo:[0,0,1]
    v_pk_mul_f32 v[92:93], v[78:79], v[78:79] op_sel:[1,1] op_sel_hi:[0,1]
    v_pk_fma_f32 v[80:81], v[78:79], v[78:79], v[92:93] op_sel:[0,0,0] op_sel_hi:[0,1,1] neg_lo:[0,0,1]
    v_pk_mul_f32 v[94:95], v[70:71], v[70:71] op_sel:[1,1] op_sel_hi:[0,1]
    v_pk_fma_f32 v[72:73], v[70:71], v[70:71], v[94:95] op_sel:[0,0,0] op_sel_hi:[0,1,1] neg_lo:[0,0,1]
    v_pk_mul_f32 v[92:93], v[80:81], v[80:81] op_sel:[1,1] op_sel_hi:[0,1]
    v_pk_fma_f32 v[82:83], v[80:81], v[80:81], v[92:93] op_sel:[0,0,0] op_sel_hi:[0,1,1] neg_lo:[0,0,1]
    v_pk_mul_f32 v[94:95], v[72:73], v[72:73] op_sel:[1,1] op_sel_hi:[0,1]
    v_pk_fma_f32 v[74:75], v[72:73], v[72:73], v[94:95] op_sel:[0,0,0] op_sel_hi:[0,1,1] neg_lo:[0,0,1]
    v_pk_mul_f32 v[92:93], v[82:83], v[82:83] op_sel:[1,1] op_sel_hi:[0,1]
    v_pk_fma_f32 v[84:85], v[82:83], v[82:83], v[92:93] op_sel:[0,0,0] op_sel_hi:[0,1,1] neg_lo:[0,0,1]
    v_pk_mul_f32 v[94:95], v[66:67], v[76:77] op_sel:[1,1] op_sel_hi:[1,0]
    v_pk_fma_f32 v[86:87], v[66:67], v[76:77], v[94:95] op_sel:[0,0,0] op_sel_hi:[0,1,1] neg_lo:[0,0,1] neg_hi:[1,0,1]
    v_mov_b32_dpp v80, v78 row_ror:8 row_mask:0xf bank_mask:0x3
    v_mov_b32_dpp v81, v79 row_ror:8 row_mask:0xf bank_mask:0x3
    v_mov_b32_dpp v82, v84 row_ror:8 row_mask:0xf bank_mask:0x3
    v_mov_b32_dpp v83, v85 row_ror:8 row_mask:0xf bank_mask:0x3
    v_pk_mul_f32 v[92:93], v[66:67], v[80:81] op_sel:[1,1] op_sel_hi:[1,0]
    v_pk_fma_f32 v[88:89], v[66:67], v[80:81], v[92:93] op_sel:[0,0,0] op_sel_hi:[0,1,1] neg_lo:[0,0,1] neg_hi:[1,0,1]
    v_pk_mul_f32 v[94:95], v[66:67], v[82:83] op_sel:[1,1] op_sel_hi:[1,0]
    v_pk_fma_f32 v[90:91], v[66:67], v[82:83], v[94:95] op_sel:[0,0,0] op_sel_hi:[0,1,1] neg_lo:[0,0,1] neg_hi:[1,0,1]
    v_mfma_f32_16x16x4_f32 v[48:51], v86, v68, v[48:51]
    v_mfma_f32_16x16x4_f32 v[52:55], v88, v70, v[52:55]
    v_mfma_f32_16x16x4_f32 v[56:59], v88, v72, v[56:59]
    v_mfma_f32_16x16x4_f32 v[60:63], v90, v74, v[60:63]
    v_mfma_f32_16x16x4_f32 v[48:51], v87, v69, v[48:51]
    v_mfma_f32_16x16x4_f32 v[52:55], v89, v71, v[52:55]
    v_mfma_f32_16x16x4_f32 v[56:59], v89, v73, v[56:59]
    v_mfma_f32_16x16x4_f32 v[60:63], v91, v75, v[60:63]
    v_mov_b64_dpp v[64:65], v[28:29] row_newbcast:2 row_mask:0xf bank_mask:0xf
    v_mov_b64_dpp v[66:67], v[30:31] row_newbcast:2 row_mask:0xf bank_mask:0xf
    v_pk_mul_f32 v[94:95], v[64:65], v[26:27] op_sel_hi:[1,0]
    v_pk_mul_f32 v[96:97], v[64:65], v[26:27] op_sel:[0,1] op_sel_hi:[1,1]
    v_fract_f32 v95, v95
    v_fract_f32 v97, v97
    v_exp_f32 v94, v94
    v_exp_f32 v96, v96
    v_cos_f32 v68, v95
    v_sin_f32 v69, v95
    v_cos_f32 v76, v97
    v_sin_f32 v77, v97
    v_pk_mul_f32 v[68:69], v[68:69], v[94:95] op_sel_hi:[1,0]
    v_pk_mul_f32 v[76:77], v[76:77], v[96:97] op_sel_hi:[1,0]
    v_pk_mul_f32 v[92:93], v[76:77], v[76:77] op_sel:[1,1] op_sel_hi:[0,1]
    v_pk_fma_f32 v[78:79], v[76:77], v[76:77], v[92:93] op_sel:[0,0,0] op_sel_hi:[0,1,1] neg_lo:[0,0,1]
    v_pk_mul_f32 v[94:95], v[68:69], v[68:69] op_sel:[1,1] op_sel_hi:[0,1]
    v_pk_fma_f32 v[70:71], v[68:69], v[68:69], v[94:95] op_sel:[0,0,0] op_sel_hi:[0,1,1] neg_lo:[0,0,1]
    v_pk_mul_f32 v[92:93], v[78:79], v[78:79] op_sel:[1,1] op_sel_hi:[0,1]
    v_pk_fma_f32 v[80:81], v[78:79], v[78:79], v[92:93] op_sel:[0,0,0] op_sel_hi:[0,1,1] neg_lo:[0,0,1]
    v_pk_mul_f32 v[94:95], v[70:71], v[70:71] op_sel:[1,1] op_sel_hi:[0,1]
    v_pk_fma_f32 v[72:73], v[70:71], v[70:71], v[94:95] op_sel:[0,0,0] op_sel_hi:[0,1,1] neg_lo:[0,0,1]
    v_pk_mul_f32 v[92:93], v[80:81], v[80:81] op_sel:[1,1] op_sel_hi:[0,1]
    v_pk_fma_f32 v[82:83], v[80:81], v[80:81], v[92:93] op_sel:[0,0,0] op_sel_hi:[0,1,1] neg_lo:[0,0,1]
    v_pk_mul_f32 v[94:95], v[72:73], v[72:73] op_sel:[1,1] op_sel_hi:[0,1]
    v_pk_fma_f32 v[74:75], v[72:73], v[72:73], v[94:95] op_sel:[0,0,0] op_sel_hi:[0,1,1] neg_lo:[0,0,1]
    v_pk_mul_f32 v[92:93], v[82:83], v[82:83] op_sel:[1,1] op_sel_hi:[0,1]
    v_pk_fma_f32 v[84:85], v[82:83], v[82:83], v[92:93] op_sel:[0,0,0] op_sel_hi:[0,1,1] neg_lo:[0,0,1]
    v_pk_mul_f32 v[94:95], v[66:67], v[76:77] op_sel:[1,1] op_sel_hi:[1,0]
    v_pk_fma_f32 v[86:87], v[66:67], v[76:77], v[94:95] op_sel:[0,0,0] op_sel_hi:[0,1,1] neg_lo:[0,0,1] neg_hi:[1,0,1]
    v_mov_b32_dpp v80, v78 row_ror:8 row_mask:0xf bank_mask:0x3
    v_mov_b32_dpp v81, v79 row_ror:8 row_mask:0xf bank_mask:0x3
    v_mov_b32_dpp v82, v84 row_ror:8 row_mask:0xf bank_mask:0x3
    v_mov_b32_dpp v83, v85 row_ror:8 row_mask:0xf bank_mask:0x3
    v_pk_mul_f32 v[92:93], v[66:67], v[80:81] op_sel:[1,1] op_sel_hi:[1,0]
    v_pk_fma_f32 v[88:89], v[66:67], v[80:81], v[92:93] op_sel:[0,0,0] op_sel_hi:[0,1,1] neg_lo:[0,0,1] neg_hi:[1,0,1]
    v_pk_mul_f32 v[94:95], v[66:67], v[82:83] op_sel:[1,1] op_sel_hi:[1,0]
    v_pk_fma_f32 v[90:91], v[66:67], v[82:83], v[94:95] op_sel:[0,0,0] op_sel_hi:[0,1,1] neg_lo:[0,0,1] neg_hi:[1,0,1]
    v_mfma_f32_16x16x4_f32 v[48:51], v86, v68, v[48:51]
    v_mfma_f32_16x16x4_f32 v[52:55], v88, v70, v[52:55]
    v_mfma_f32_16x16x4_f32 v[56:59], v88, v72, v[56:59]
    v_mfma_f32_16x16x4_f32 v[60:63], v90, v74, v[60:63]
    v_mfma_f32_16x16x4_f32 v[48:51], v87, v69, v[48:51]
    v_mfma_f32_16x16x4_f32 v[52:55], v89, v71, v[52:55]
    v_mfma_f32_16x16x4_f32 v[56:59], v89, v73, v[56:59]
    v_mfma_f32_16x16x4_f32 v[60:63], v91, v75, v[60:63]
    v_mov_b64_dpp v[64:65], v[28:29] row_newbcast:3 row_mask:0xf bank_mask:0xf
    v_mov_b64_dpp v[66:67], v[30:31] row_newbcast:3 row_mask:0xf bank_mask:0xf
    v_pk_mul_f32 v[94:95], v[64:65], v[26:27] op_sel_hi:[1,0]
    v_pk_mul_f32 v[96:97], v[64:65], v[26:27] op_sel:[0,1] op_sel_hi:[1,1]
    v_fract_f32 v95, v95
    v_fract_f32 v97, v97
    v_exp_f32 v94, v94
    v_exp_f32 v96, v96
    v_cos_f32 v68, v95
    v_sin_f32 v69, v95
    v_cos_f32 v76, v97
    v_sin_f32 v77, v97
    v_pk_mul_f32 v[68:69], v[68:69], v[94:95] op_sel_hi:[1,0]
    v_pk_mul_f32 v[76:77], v[76:77], v[96:97] op_sel_hi:[1,0]
    v_pk_mul_f32 v[92:93], v[76:77], v[76:77] op_sel:[1,1] op_sel_hi:[0,1]
    v_pk_fma_f32 v[78:79], v[76:77], v[76:77], v[92:93] op_sel:[0,0,0] op_sel_hi:[0,1,1] neg_lo:[0,0,1]
    v_pk_mul_f32 v[94:95], v[68:69], v[68:69] op_sel:[1,1] op_sel_hi:[0,1]
    v_pk_fma_f32 v[70:71], v[68:69], v[68:69], v[94:95] op_sel:[0,0,0] op_sel_hi:[0,1,1] neg_lo:[0,0,1]
    v_pk_mul_f32 v[92:93], v[78:79], v[78:79] op_sel:[1,1] op_sel_hi:[0,1]
    v_pk_fma_f32 v[80:81], v[78:79], v[78:79], v[92:93] op_sel:[0,0,0] op_sel_hi:[0,1,1] neg_lo:[0,0,1]
    v_pk_mul_f32 v[94:95], v[70:71], v[70:71] op_sel:[1,1] op_sel_hi:[0,1]
    v_pk_fma_f32 v[72:73], v[70:71], v[70:71], v[94:95] op_sel:[0,0,0] op_sel_hi:[0,1,1] neg_lo:[0,0,1]
    v_pk_mul_f32 v[92:93], v[80:81], v[80:81] op_sel:[1,1] op_sel_hi:[0,1]
    v_pk_fma_f32 v[82:83], v[80:81], v[80:81], v[92:93] op_sel:[0,0,0] op_sel_hi:[0,1,1] neg_lo:[0,0,1]
    v_pk_mul_f32 v[94:95], v[72:73], v[72:73] op_sel:[1,1] op_sel_hi:[0,1]
    v_pk_fma_f32 v[74:75], v[72:73], v[72:73], v[94:95] op_sel:[0,0,0] op_sel_hi:[0,1,1] neg_lo:[0,0,1]
    v_pk_mul_f32 v[92:93], v[82:83], v[82:83] op_sel:[1,1] op_sel_hi:[0,1]
    v_pk_fma_f32 v[84:85], v[82:83], v[82:83], v[92:93] op_sel:[0,0,0] op_sel_hi:[0,1,1] neg_lo:[0,0,1]
    v_pk_mul_f32 v[94:95], v[66:67], v[76:77] op_sel:[1,1] op_sel_hi:[1,0]
    v_pk_fma_f32 v[86:87], v[66:67], v[76:77], v[94:95] op_sel:[0,0,0] op_sel_hi:[0,1,1] neg_lo:[0,0,1] neg_hi:[1,0,1]
    v_mov_b32_dpp v80, v78 row_ror:8 row_mask:0xf bank_mask:0x3
    v_mov_b32_dpp v81, v79 row_ror:8 row_mask:0xf bank_mask:0x3
    v_mov_b32_dpp v82, v84 row_ror:8 row_mask:0xf bank_mask:0x3
    v_mov_b32_dpp v83, v85 row_ror:8 row_mask:0xf bank_mask:0x3
    v_pk_mul_f32 v[92:93], v[66:67], v[80:81] op_sel:[1,1] op_sel_hi:[1,0]
    v_pk_fma_f32 v[88:89], v[66:67], v[80:81], v[92:93] op_sel:[0,0,0] op_sel_hi:[0,1,1] neg_lo:[0,0,1] neg_hi:[1,0,1]
    v_pk_mul_f32 v[94:95], v[66:67], v[82:83] op_sel:[1,1] op_sel_hi:[1,0]
    v_pk_fma_f32 v[90:91], v[66:67], v[82:83], v[94:95] op_sel:[0,0,0] op_sel_hi:[0,1,1] neg_lo:[0,0,1] neg_hi:[1,0,1]
    v_mfma_f32_16x16x4_f32 v[48:51], v86, v68, v[48:51]
    v_mfma_f32_16x16x4_f32 v[52:55], v88, v70, v[52:55]
    v_mfma_f32_16x16x4_f32 v[56:59], v88, v72, v[56:59]
    v_mfma_f32_16x16x4_f32 v[60:63], v90, v74, v[60:63]
    v_mfma_f32_16x16x4_f32 v[48:51], v87, v69, v[48:51]
    v_mfma_f32_16x16x4_f32 v[52:55], v89, v71, v[52:55]
    v_mfma_f32_16x16x4_f32 v[56:59], v89, v73, v[56:59]
    v_mfma_f32_16x16x4_f32 v[60:63], v91, v75, v[60:63]
    v_mov_b64_dpp v[64:65], v[28:29] row_newbcast:4 row_mask:0xf bank_mask:0xf
    v_mov_b64_dpp v[66:67], v[30:31] row_newbcast:4 row_mask:0xf bank_mask:0xf
    v_pk_mul_f32 v[94:95], v[64:65], v[26:27] op_sel_hi:[1,0]
    v_pk_mul_f32 v[96:97], v[64:65], v[26:27] op_sel:[0,1] op_sel_hi:[1,1]
    v_fract_f32 v95, v95
    v_fract_f32 v97, v97
    v_exp_f32 v94, v94
    v_exp_f32 v96, v96
    v_cos_f32 v68, v95
    v_sin_f32 v69, v95
    v_cos_f32 v76, v97
    v_sin_f32 v77, v97
    v_pk_mul_f32 v[68:69], v[68:69], v[94:95] op_sel_hi:[1,0]
    v_pk_mul_f32 v[76:77], v[76:77], v[96:97] op_sel_hi:[1,0]
    v_pk_mul_f32 v[92:93], v[76:77], v[76:77] op_sel:[1,1] op_sel_hi:[0,1]
    v_pk_fma_f32 v[78:79], v[76:77], v[76:77], v[92:93] op_sel:[0,0,0] op_sel_hi:[0,1,1] neg_lo:[0,0,1]
    v_pk_mul_f32 v[94:95], v[68:69], v[68:69] op_sel:[1,1] op_sel_hi:[0,1]
    v_pk_fma_f32 v[70:71], v[68:69], v[68:69], v[94:95] op_sel:[0,0,0] op_sel_hi:[0,1,1] neg_lo:[0,0,1]
    v_pk_mul_f32 v[92:93], v[78:79], v[78:79] op_sel:[1,1] op_sel_hi:[0,1]
    v_pk_fma_f32 v[80:81], v[78:79], v[78:79], v[92:93] op_sel:[0,0,0] op_sel_hi:[0,1,1] neg_lo:[0,0,1]
    v_pk_mul_f32 v[94:95], v[70:71], v[70:71] op_sel:[1,1] op_sel_hi:[0,1]
    v_pk_fma_f32 v[72:73], v[70:71], v[70:71], v[94:95] op_sel:[0,0,0] op_sel_hi:[0,1,1] neg_lo:[0,0,1]
    v_pk_mul_f32 v[92:93], v[80:81], v[80:81] op_sel:[1,1] op_sel_hi:[0,1]
    v_pk_fma_f32 v[82:83], v[80:81], v[80:81], v[92:93] op_sel:[0,0,0] op_sel_hi:[0,1,1] neg_lo:[0,0,1]
    v_pk_mul_f32 v[94:95], v[72:73], v[72:73] op_sel:[1,1] op_sel_hi:[0,1]
    v_pk_fma_f32 v[74:75], v[72:73], v[72:73], v[94:95] op_sel:[0,0,0] op_sel_hi:[0,1,1] neg_lo:[0,0,1]
    v_pk_mul_f32 v[92:93], v[82:83], v[82:83] op_sel:[1,1] op_sel_hi:[0,1]
    v_pk_fma_f32 v[84:85], v[82:83], v[82:83], v[92:93] op_sel:[0,0,0] op_sel_hi:[0,1,1] neg_lo:[0,0,1]
    v_pk_mul_f32 v[94:95], v[66:67], v[76:77] op_sel:[1,1] op_sel_hi:[1,0]
    v_pk_fma_f32 v[86:87], v[66:67], v[76:77], v[94:95] op_sel:[0,0,0] op_sel_hi:[0,1,1] neg_lo:[0,0,1] neg_hi:[1,0,1]
    v_mov_b32_dpp v80, v78 row_ror:8 row_mask:0xf bank_mask:0x3
    v_mov_b32_dpp v81, v79 row_ror:8 row_mask:0xf bank_mask:0x3
    v_mov_b32_dpp v82, v84 row_ror:8 row_mask:0xf bank_mask:0x3
    v_mov_b32_dpp v83, v85 row_ror:8 row_mask:0xf bank_mask:0x3
    v_pk_mul_f32 v[92:93], v[66:67], v[80:81] op_sel:[1,1] op_sel_hi:[1,0]
    v_pk_fma_f32 v[88:89], v[66:67], v[80:81], v[92:93] op_sel:[0,0,0] op_sel_hi:[0,1,1] neg_lo:[0,0,1] neg_hi:[1,0,1]
    v_pk_mul_f32 v[94:95], v[66:67], v[82:83] op_sel:[1,1] op_sel_hi:[1,0]
    v_pk_fma_f32 v[90:91], v[66:67], v[82:83], v[94:95] op_sel:[0,0,0] op_sel_hi:[0,1,1] neg_lo:[0,0,1] neg_hi:[1,0,1]
    v_mfma_f32_16x16x4_f32 v[48:51], v86, v68, v[48:51]
    v_mfma_f32_16x16x4_f32 v[52:55], v88, v70, v[52:55]
    v_mfma_f32_16x16x4_f32 v[56:59], v88, v72, v[56:59]
    v_mfma_f32_16x16x4_f32 v[60:63], v90, v74, v[60:63]
    v_mfma_f32_16x16x4_f32 v[48:51], v87, v69, v[48:51]
    v_mfma_f32_16x16x4_f32 v[52:55], v89, v71, v[52:55]
    v_mfma_f32_16x16x4_f32 v[56:59], v89, v73, v[56:59]
    v_mfma_f32_16x16x4_f32 v[60:63], v91, v75, v[60:63]
    v_mov_b64_dpp v[64:65], v[28:29] row_newbcast:5 row_mask:0xf bank_mask:0xf
    v_mov_b64_dpp v[66:67], v[30:31] row_newbcast:5 row_mask:0xf bank_mask:0xf
    v_pk_mul_f32 v[94:95], v[64:65], v[26:27] op_sel_hi:[1,0]
    v_pk_mul_f32 v[96:97], v[64:65], v[26:27] op_sel:[0,1] op_sel_hi:[1,1]
    v_fract_f32 v95, v95
    v_fract_f32 v97, v97
    v_exp_f32 v94, v94
    v_exp_f32 v96, v96
    v_cos_f32 v68, v95
    v_sin_f32 v69, v95
    v_cos_f32 v76, v97
    v_sin_f32 v77, v97
    v_pk_mul_f32 v[68:69], v[68:69], v[94:95] op_sel_hi:[1,0]
    v_pk_mul_f32 v[76:77], v[76:77], v[96:97] op_sel_hi:[1,0]
    v_pk_mul_f32 v[92:93], v[76:77], v[76:77] op_sel:[1,1] op_sel_hi:[0,1]
    v_pk_fma_f32 v[78:79], v[76:77], v[76:77], v[92:93] op_sel:[0,0,0] op_sel_hi:[0,1,1] neg_lo:[0,0,1]
    v_pk_mul_f32 v[94:95], v[68:69], v[68:69] op_sel:[1,1] op_sel_hi:[0,1]
    v_pk_fma_f32 v[70:71], v[68:69], v[68:69], v[94:95] op_sel:[0,0,0] op_sel_hi:[0,1,1] neg_lo:[0,0,1]
    v_pk_mul_f32 v[92:93], v[78:79], v[78:79] op_sel:[1,1] op_sel_hi:[0,1]
    v_pk_fma_f32 v[80:81], v[78:79], v[78:79], v[92:93] op_sel:[0,0,0] op_sel_hi:[0,1,1] neg_lo:[0,0,1]
    v_pk_mul_f32 v[94:95], v[70:71], v[70:71] op_sel:[1,1] op_sel_hi:[0,1]
    v_pk_fma_f32 v[72:73], v[70:71], v[70:71], v[94:95] op_sel:[0,0,0] op_sel_hi:[0,1,1] neg_lo:[0,0,1]
    v_pk_mul_f32 v[92:93], v[80:81], v[80:81] op_sel:[1,1] op_sel_hi:[0,1]
    v_pk_fma_f32 v[82:83], v[80:81], v[80:81], v[92:93] op_sel:[0,0,0] op_sel_hi:[0,1,1] neg_lo:[0,0,1]
    v_pk_mul_f32 v[94:95], v[72:73], v[72:73] op_sel:[1,1] op_sel_hi:[0,1]
    v_pk_fma_f32 v[74:75], v[72:73], v[72:73], v[94:95] op_sel:[0,0,0] op_sel_hi:[0,1,1] neg_lo:[0,0,1]
    v_pk_mul_f32 v[92:93], v[82:83], v[82:83] op_sel:[1,1] op_sel_hi:[0,1]
    v_pk_fma_f32 v[84:85], v[82:83], v[82:83], v[92:93] op_sel:[0,0,0] op_sel_hi:[0,1,1] neg_lo:[0,0,1]
    v_pk_mul_f32 v[94:95], v[66:67], v[76:77] op_sel:[1,1] op_sel_hi:[1,0]
    v_pk_fma_f32 v[86:87], v[66:67], v[76:77], v[94:95] op_sel:[0,0,0] op_sel_hi:[0,1,1] neg_lo:[0,0,1] neg_hi:[1,0,1]
    v_mov_b32_dpp v80, v78 row_ror:8 row_mask:0xf bank_mask:0x3
    v_mov_b32_dpp v81, v79 row_ror:8 row_mask:0xf bank_mask:0x3
    v_mov_b32_dpp v82, v84 row_ror:8 row_mask:0xf bank_mask:0x3
    v_mov_b32_dpp v83, v85 row_ror:8 row_mask:0xf bank_mask:0x3
    v_pk_mul_f32 v[92:93], v[66:67], v[80:81] op_sel:[1,1] op_sel_hi:[1,0]
    v_pk_fma_f32 v[88:89], v[66:67], v[80:81], v[92:93] op_sel:[0,0,0] op_sel_hi:[0,1,1] neg_lo:[0,0,1] neg_hi:[1,0,1]
    v_pk_mul_f32 v[94:95], v[66:67], v[82:83] op_sel:[1,1] op_sel_hi:[1,0]
    v_pk_fma_f32 v[90:91], v[66:67], v[82:83], v[94:95] op_sel:[0,0,0] op_sel_hi:[0,1,1] neg_lo:[0,0,1] neg_hi:[1,0,1]
    v_mfma_f32_16x16x4_f32 v[48:51], v86, v68, v[48:51]
    v_mfma_f32_16x16x4_f32 v[52:55], v88, v70, v[52:55]
    v_mfma_f32_16x16x4_f32 v[56:59], v88, v72, v[56:59]
    v_mfma_f32_16x16x4_f32 v[60:63], v90, v74, v[60:63]
    v_mfma_f32_16x16x4_f32 v[48:51], v87, v69, v[48:51]
    v_mfma_f32_16x16x4_f32 v[52:55], v89, v71, v[52:55]
    v_mfma_f32_16x16x4_f32 v[56:59], v89, v73, v[56:59]
    v_mfma_f32_16x16x4_f32 v[60:63], v91, v75, v[60:63]
    v_mov_b64_dpp v[64:65], v[28:29] row_newbcast:6 row_mask:0xf bank_mask:0xf
    v_mov_b64_dpp v[66:67], v[30:31] row_newbcast:6 row_mask:0xf bank_mask:0xf
    v_pk_mul_f32 v[94:95], v[64:65], v[26:27] op_sel_hi:[1,0]
    v_pk_mul_f32 v[96:97], v[64:65], v[26:27] op_sel:[0,1] op_sel_hi:[1,1]
    v_fract_f32 v95, v95
    v_fract_f32 v97, v97
    v_exp_f32 v94, v94
    v_exp_f32 v96, v96
    v_cos_f32 v68, v95
    v_sin_f32 v69, v95
    v_cos_f32 v76, v97
    v_sin_f32 v77, v97
    v_pk_mul_f32 v[68:69], v[68:69], v[94:95] op_sel_hi:[1,0]
    v_pk_mul_f32 v[76:77], v[76:77], v[96:97] op_sel_hi:[1,0]
    v_pk_mul_f32 v[92:93], v[76:77], v[76:77] op_sel:[1,1] op_sel_hi:[0,1]
    v_pk_fma_f32 v[78:79], v[76:77], v[76:77], v[92:93] op_sel:[0,0,0] op_sel_hi:[0,1,1] neg_lo:[0,0,1]
    v_pk_mul_f32 v[94:95], v[68:69], v[68:69] op_sel:[1,1] op_sel_hi:[0,1]
    v_pk_fma_f32 v[70:71], v[68:69], v[68:69], v[94:95] op_sel:[0,0,0] op_sel_hi:[0,1,1] neg_lo:[0,0,1]
    v_pk_mul_f32 v[92:93], v[78:79], v[78:79] op_sel:[1,1] op_sel_hi:[0,1]
    v_pk_fma_f32 v[80:81], v[78:79], v[78:79], v[92:93] op_sel:[0,0,0] op_sel_hi:[0,1,1] neg_lo:[0,0,1]
    v_pk_mul_f32 v[94:95], v[70:71], v[70:71] op_sel:[1,1] op_sel_hi:[0,1]
    v_pk_fma_f32 v[72:73], v[70:71], v[70:71], v[94:95] op_sel:[0,0,0] op_sel_hi:[0,1,1] neg_lo:[0,0,1]
    v_pk_mul_f32 v[92:93], v[80:81], v[80:81] op_sel:[1,1] op_sel_hi:[0,1]
    v_pk_fma_f32 v[82:83], v[80:81], v[80:81], v[92:93] op_sel:[0,0,0] op_sel_hi:[0,1,1] neg_lo:[0,0,1]
    v_pk_mul_f32 v[94:95], v[72:73], v[72:73] op_sel:[1,1] op_sel_hi:[0,1]
    v_pk_fma_f32 v[74:75], v[72:73], v[72:73], v[94:95] op_sel:[0,0,0] op_sel_hi:[0,1,1] neg_lo:[0,0,1]
    v_pk_mul_f32 v[92:93], v[82:83], v[82:83] op_sel:[1,1] op_sel_hi:[0,1]
    v_pk_fma_f32 v[84:85], v[82:83], v[82:83], v[92:93] op_sel:[0,0,0] op_sel_hi:[0,1,1] neg_lo:[0,0,1]
    v_pk_mul_f32 v[94:95], v[66:67], v[76:77] op_sel:[1,1] op_sel_hi:[1,0]
    v_pk_fma_f32 v[86:87], v[66:67], v[76:77], v[94:95] op_sel:[0,0,0] op_sel_hi:[0,1,1] neg_lo:[0,0,1] neg_hi:[1,0,1]
    v_mov_b32_dpp v80, v78 row_ror:8 row_mask:0xf bank_mask:0x3
    v_mov_b32_dpp v81, v79 row_ror:8 row_mask:0xf bank_mask:0x3
    v_mov_b32_dpp v82, v84 row_ror:8 row_mask:0xf bank_mask:0x3
    v_mov_b32_dpp v83, v85 row_ror:8 row_mask:0xf bank_mask:0x3
    v_pk_mul_f32 v[92:93], v[66:67], v[80:81] op_sel:[1,1] op_sel_hi:[1,0]
    v_pk_fma_f32 v[88:89], v[66:67], v[80:81], v[92:93] op_sel:[0,0,0] op_sel_hi:[0,1,1] neg_lo:[0,0,1] neg_hi:[1,0,1]
    v_pk_mul_f32 v[94:95], v[66:67], v[82:83] op_sel:[1,1] op_sel_hi:[1,0]
    v_pk_fma_f32 v[90:91], v[66:67], v[82:83], v[94:95] op_sel:[0,0,0] op_sel_hi:[0,1,1] neg_lo:[0,0,1] neg_hi:[1,0,1]
    v_mfma_f32_16x16x4_f32 v[48:51], v86, v68, v[48:51]
    v_mfma_f32_16x16x4_f32 v[52:55], v88, v70, v[52:55]
    v_mfma_f32_16x16x4_f32 v[56:59], v88, v72, v[56:59]
    v_mfma_f32_16x16x4_f32 v[60:63], v90, v74, v[60:63]
    v_mfma_f32_16x16x4_f32 v[48:51], v87, v69, v[48:51]
    v_mfma_f32_16x16x4_f32 v[52:55], v89, v71, v[52:55]
    v_mfma_f32_16x16x4_f32 v[56:59], v89, v73, v[56:59]
    v_mfma_f32_16x16x4_f32 v[60:63], v91, v75, v[60:63]
    v_mov_b64_dpp v[64:65], v[28:29] row_newbcast:7 row_mask:0xf bank_mask:0xf
    v_mov_b64_dpp v[66:67], v[30:31] row_newbcast:7 row_mask:0xf bank_mask:0xf
    v_pk_mul_f32 v[94:95], v[64:65], v[26:27] op_sel_hi:[1,0]
    v_pk_mul_f32 v[96:97], v[64:65], v[26:27] op_sel:[0,1] op_sel_hi:[1,1]
    v_fract_f32 v95, v95
    v_fract_f32 v97, v97
    v_exp_f32 v94, v94
    v_exp_f32 v96, v96
    v_cos_f32 v68, v95
    v_sin_f32 v69, v95
    v_cos_f32 v76, v97
    v_sin_f32 v77, v97
    v_pk_mul_f32 v[68:69], v[68:69], v[94:95] op_sel_hi:[1,0]
    v_pk_mul_f32 v[76:77], v[76:77], v[96:97] op_sel_hi:[1,0]
    v_pk_mul_f32 v[92:93], v[76:77], v[76:77] op_sel:[1,1] op_sel_hi:[0,1]
    v_pk_fma_f32 v[78:79], v[76:77], v[76:77], v[92:93] op_sel:[0,0,0] op_sel_hi:[0,1,1] neg_lo:[0,0,1]
    v_pk_mul_f32 v[94:95], v[68:69], v[68:69] op_sel:[1,1] op_sel_hi:[0,1]
    v_pk_fma_f32 v[70:71], v[68:69], v[68:69], v[94:95] op_sel:[0,0,0] op_sel_hi:[0,1,1] neg_lo:[0,0,1]
    v_pk_mul_f32 v[92:93], v[78:79], v[78:79] op_sel:[1,1] op_sel_hi:[0,1]
    v_pk_fma_f32 v[80:81], v[78:79], v[78:79], v[92:93] op_sel:[0,0,0] op_sel_hi:[0,1,1] neg_lo:[0,0,1]
    v_pk_mul_f32 v[94:95], v[70:71], v[70:71] op_sel:[1,1] op_sel_hi:[0,1]
    v_pk_fma_f32 v[72:73], v[70:71], v[70:71], v[94:95] op_sel:[0,0,0] op_sel_hi:[0,1,1] neg_lo:[0,0,1]
    v_pk_mul_f32 v[92:93], v[80:81], v[80:81] op_sel:[1,1] op_sel_hi:[0,1]
    v_pk_fma_f32 v[82:83], v[80:81], v[80:81], v[92:93] op_sel:[0,0,0] op_sel_hi:[0,1,1] neg_lo:[0,0,1]
    v_pk_mul_f32 v[94:95], v[72:73], v[72:73] op_sel:[1,1] op_sel_hi:[0,1]
    v_pk_fma_f32 v[74:75], v[72:73], v[72:73], v[94:95] op_sel:[0,0,0] op_sel_hi:[0,1,1] neg_lo:[0,0,1]
    v_pk_mul_f32 v[92:93], v[82:83], v[82:83] op_sel:[1,1] op_sel_hi:[0,1]
    v_pk_fma_f32 v[84:85], v[82:83], v[82:83], v[92:93] op_sel:[0,0,0] op_sel_hi:[0,1,1] neg_lo:[0,0,1]
    v_pk_mul_f32 v[94:95], v[66:67], v[76:77] op_sel:[1,1] op_sel_hi:[1,0]
    v_pk_fma_f32 v[86:87], v[66:67], v[76:77], v[94:95] op_sel:[0,0,0] op_sel_hi:[0,1,1] neg_lo:[0,0,1] neg_hi:[1,0,1]
    v_mov_b32_dpp v80, v78 row_ror:8 row_mask:0xf bank_mask:0x3
    v_mov_b32_dpp v81, v79 row_ror:8 row_mask:0xf bank_mask:0x3
    v_mov_b32_dpp v82, v84 row_ror:8 row_mask:0xf bank_mask:0x3
    v_mov_b32_dpp v83, v85 row_ror:8 row_mask:0xf bank_mask:0x3
    v_pk_mul_f32 v[92:93], v[66:67], v[80:81] op_sel:[1,1] op_sel_hi:[1,0]
    v_pk_fma_f32 v[88:89], v[66:67], v[80:81], v[92:93] op_sel:[0,0,0] op_sel_hi:[0,1,1] neg_lo:[0,0,1] neg_hi:[1,0,1]
    v_pk_mul_f32 v[94:95], v[66:67], v[82:83] op_sel:[1,1] op_sel_hi:[1,0]
    v_pk_fma_f32 v[90:91], v[66:67], v[82:83], v[94:95] op_sel:[0,0,0] op_sel_hi:[0,1,1] neg_lo:[0,0,1] neg_hi:[1,0,1]
    v_mfma_f32_16x16x4_f32 v[48:51], v86, v68, v[48:51]
    v_mfma_f32_16x16x4_f32 v[52:55], v88, v70, v[52:55]
    v_mfma_f32_16x16x4_f32 v[56:59], v88, v72, v[56:59]
    v_mfma_f32_16x16x4_f32 v[60:63], v90, v74, v[60:63]
    v_mfma_f32_16x16x4_f32 v[48:51], v87, v69, v[48:51]
    v_mfma_f32_16x16x4_f32 v[52:55], v89, v71, v[52:55]
    v_mfma_f32_16x16x4_f32 v[56:59], v89, v73, v[56:59]
    v_mfma_f32_16x16x4_f32 v[60:63], v91, v75, v[60:63]
    v_mov_b64_dpp v[64:65], v[28:29] row_newbcast:8 row_mask:0xf bank_mask:0xf
    v_mov_b64_dpp v[66:67], v[30:31] row_newbcast:8 row_mask:0xf bank_mask:0xf
    v_pk_mul_f32 v[94:95], v[64:65], v[26:27] op_sel_hi:[1,0]
    v_pk_mul_f32 v[96:97], v[64:65], v[26:27] op_sel:[0,1] op_sel_hi:[1,1]
    v_fract_f32 v95, v95
    v_fract_f32 v97, v97
    v_exp_f32 v94, v94
    v_exp_f32 v96, v96
    v_cos_f32 v68, v95
    v_sin_f32 v69, v95
    v_cos_f32 v76, v97
    v_sin_f32 v77, v97
    v_pk_mul_f32 v[68:69], v[68:69], v[94:95] op_sel_hi:[1,0]
    v_pk_mul_f32 v[76:77], v[76:77], v[96:97] op_sel_hi:[1,0]
    v_pk_mul_f32 v[92:93], v[76:77], v[76:77] op_sel:[1,1] op_sel_hi:[0,1]
    v_pk_fma_f32 v[78:79], v[76:77], v[76:77], v[92:93] op_sel:[0,0,0] op_sel_hi:[0,1,1] neg_lo:[0,0,1]
    v_pk_mul_f32 v[94:95], v[68:69], v[68:69] op_sel:[1,1] op_sel_hi:[0,1]
    v_pk_fma_f32 v[70:71], v[68:69], v[68:69], v[94:95] op_sel:[0,0,0] op_sel_hi:[0,1,1] neg_lo:[0,0,1]
    v_pk_mul_f32 v[92:93], v[78:79], v[78:79] op_sel:[1,1] op_sel_hi:[0,1]
    v_pk_fma_f32 v[80:81], v[78:79], v[78:79], v[92:93] op_sel:[0,0,0] op_sel_hi:[0,1,1] neg_lo:[0,0,1]
    v_pk_mul_f32 v[94:95], v[70:71], v[70:71] op_sel:[1,1] op_sel_hi:[0,1]
    v_pk_fma_f32 v[72:73], v[70:71], v[70:71], v[94:95] op_sel:[0,0,0] op_sel_hi:[0,1,1] neg_lo:[0,0,1]
    v_pk_mul_f32 v[92:93], v[80:81], v[80:81] op_sel:[1,1] op_sel_hi:[0,1]
    v_pk_fma_f32 v[82:83], v[80:81], v[80:81], v[92:93] op_sel:[0,0,0] op_sel_hi:[0,1,1] neg_lo:[0,0,1]
    v_pk_mul_f32 v[94:95], v[72:73], v[72:73] op_sel:[1,1] op_sel_hi:[0,1]
    v_pk_fma_f32 v[74:75], v[72:73], v[72:73], v[94:95] op_sel:[0,0,0] op_sel_hi:[0,1,1] neg_lo:[0,0,1]
    v_pk_mul_f32 v[92:93], v[82:83], v[82:83] op_sel:[1,1] op_sel_hi:[0,1]
    v_pk_fma_f32 v[84:85], v[82:83], v[82:83], v[92:93] op_sel:[0,0,0] op_sel_hi:[0,1,1] neg_lo:[0,0,1]
    v_pk_mul_f32 v[94:95], v[66:67], v[76:77] op_sel:[1,1] op_sel_hi:[1,0]
    v_pk_fma_f32 v[86:87], v[66:67], v[76:77], v[94:95] op_sel:[0,0,0] op_sel_hi:[0,1,1] neg_lo:[0,0,1] neg_hi:[1,0,1]
    v_mov_b32_dpp v80, v78 row_ror:8 row_mask:0xf bank_mask:0x3
    v_mov_b32_dpp v81, v79 row_ror:8 row_mask:0xf bank_mask:0x3
    v_mov_b32_dpp v82, v84 row_ror:8 row_mask:0xf bank_mask:0x3
    v_mov_b32_dpp v83, v85 row_ror:8 row_mask:0xf bank_mask:0x3
    v_pk_mul_f32 v[92:93], v[66:67], v[80:81] op_sel:[1,1] op_sel_hi:[1,0]
    v_pk_fma_f32 v[88:89], v[66:67], v[80:81], v[92:93] op_sel:[0,0,0] op_sel_hi:[0,1,1] neg_lo:[0,0,1] neg_hi:[1,0,1]
    v_pk_mul_f32 v[94:95], v[66:67], v[82:83] op_sel:[1,1] op_sel_hi:[1,0]
    v_pk_fma_f32 v[90:91], v[66:67], v[82:83], v[94:95] op_sel:[0,0,0] op_sel_hi:[0,1,1] neg_lo:[0,0,1] neg_hi:[1,0,1]
    v_mfma_f32_16x16x4_f32 v[48:51], v86, v68, v[48:51]
    v_mfma_f32_16x16x4_f32 v[52:55], v88, v70, v[52:55]
    v_mfma_f32_16x16x4_f32 v[56:59], v88, v72, v[56:59]
    v_mfma_f32_16x16x4_f32 v[60:63], v90, v74, v[60:63]
    v_mfma_f32_16x16x4_f32 v[48:51], v87, v69, v[48:51]
    v_mfma_f32_16x16x4_f32 v[52:55], v89, v71, v[52:55]
    v_mfma_f32_16x16x4_f32 v[56:59], v89, v73, v[56:59]
    v_mfma_f32_16x16x4_f32 v[60:63], v91, v75, v[60:63]
    v_mov_b64_dpp v[64:65], v[28:29] row_newbcast:9 row_mask:0xf bank_mask:0xf
    v_mov_b64_dpp v[66:67], v[30:31] row_newbcast:9 row_mask:0xf bank_mask:0xf
    v_pk_mul_f32 v[94:95], v[64:65], v[26:27] op_sel_hi:[1,0]
    v_pk_mul_f32 v[96:97], v[64:65], v[26:27] op_sel:[0,1] op_sel_hi:[1,1]
    v_fract_f32 v95, v95
    v_fract_f32 v97, v97
    v_exp_f32 v94, v94
    v_exp_f32 v96, v96
    v_cos_f32 v68, v95
    v_sin_f32 v69, v95
    v_cos_f32 v76, v97
    v_sin_f32 v77, v97
    v_pk_mul_f32 v[68:69], v[68:69], v[94:95] op_sel_hi:[1,0]
    v_pk_mul_f32 v[76:77], v[76:77], v[96:97] op_sel_hi:[1,0]
    v_pk_mul_f32 v[92:93], v[76:77], v[76:77] op_sel:[1,1] op_sel_hi:[0,1]
    v_pk_fma_f32 v[78:79], v[76:77], v[76:77], v[92:93] op_sel:[0,0,0] op_sel_hi:[0,1,1] neg_lo:[0,0,1]
    v_pk_mul_f32 v[94:95], v[68:69], v[68:69] op_sel:[1,1] op_sel_hi:[0,1]
    v_pk_fma_f32 v[70:71], v[68:69], v[68:69], v[94:95] op_sel:[0,0,0] op_sel_hi:[0,1,1] neg_lo:[0,0,1]
    v_pk_mul_f32 v[92:93], v[78:79], v[78:79] op_sel:[1,1] op_sel_hi:[0,1]
    v_pk_fma_f32 v[80:81], v[78:79], v[78:79], v[92:93] op_sel:[0,0,0] op_sel_hi:[0,1,1] neg_lo:[0,0,1]
    v_pk_mul_f32 v[94:95], v[70:71], v[70:71] op_sel:[1,1] op_sel_hi:[0,1]
    v_pk_fma_f32 v[72:73], v[70:71], v[70:71], v[94:95] op_sel:[0,0,0] op_sel_hi:[0,1,1] neg_lo:[0,0,1]
    v_pk_mul_f32 v[92:93], v[80:81], v[80:81] op_sel:[1,1] op_sel_hi:[0,1]
    v_pk_fma_f32 v[82:83], v[80:81], v[80:81], v[92:93] op_sel:[0,0,0] op_sel_hi:[0,1,1] neg_lo:[0,0,1]
    v_pk_mul_f32 v[94:95], v[72:73], v[72:73] op_sel:[1,1] op_sel_hi:[0,1]
    v_pk_fma_f32 v[74:75], v[72:73], v[72:73], v[94:95] op_sel:[0,0,0] op_sel_hi:[0,1,1] neg_lo:[0,0,1]
    v_pk_mul_f32 v[92:93], v[82:83], v[82:83] op_sel:[1,1] op_sel_hi:[0,1]
    v_pk_fma_f32 v[84:85], v[82:83], v[82:83], v[92:93] op_sel:[0,0,0] op_sel_hi:[0,1,1] neg_lo:[0,0,1]
    v_pk_mul_f32 v[94:95], v[66:67], v[76:77] op_sel:[1,1] op_sel_hi:[1,0]
    v_pk_fma_f32 v[86:87], v[66:67], v[76:77], v[94:95] op_sel:[0,0,0] op_sel_hi:[0,1,1] neg_lo:[0,0,1] neg_hi:[1,0,1]
    v_mov_b32_dpp v80, v78 row_ror:8 row_mask:0xf bank_mask:0x3
    v_mov_b32_dpp v81, v79 row_ror:8 row_mask:0xf bank_mask:0x3
    v_mov_b32_dpp v82, v84 row_ror:8 row_mask:0xf bank_mask:0x3
    v_mov_b32_dpp v83, v85 row_ror:8 row_mask:0xf bank_mask:0x3
    v_pk_mul_f32 v[92:93], v[66:67], v[80:81] op_sel:[1,1] op_sel_hi:[1,0]
    v_pk_fma_f32 v[88:89], v[66:67], v[80:81], v[92:93] op_sel:[0,0,0] op_sel_hi:[0,1,1] neg_lo:[0,0,1] neg_hi:[1,0,1]
    v_pk_mul_f32 v[94:95], v[66:67], v[82:83] op_sel:[1,1] op_sel_hi:[1,0]
    v_pk_fma_f32 v[90:91], v[66:67], v[82:83], v[94:95] op_sel:[0,0,0] op_sel_hi:[0,1,1] neg_lo:[0,0,1] neg_hi:[1,0,1]
    v_mfma_f32_16x16x4_f32 v[48:51], v86, v68, v[48:51]
    v_mfma_f32_16x16x4_f32 v[52:55], v88, v70, v[52:55]
    v_mfma_f32_16x16x4_f32 v[56:59], v88, v72, v[56:59]
    v_mfma_f32_16x16x4_f32 v[60:63], v90, v74, v[60:63]
    v_mfma_f32_16x16x4_f32 v[48:51], v87, v69, v[48:51]
    v_mfma_f32_16x16x4_f32 v[52:55], v89, v71, v[52:55]
    v_mfma_f32_16x16x4_f32 v[56:59], v89, v73, v[56:59]
    v_mfma_f32_16x16x4_f32 v[60:63], v91, v75, v[60:63]
    v_mov_b64_dpp v[64:65], v[28:29] row_newbcast:10 row_mask:0xf bank_mask:0xf
    v_mov_b64_dpp v[66:67], v[30:31] row_newbcast:10 row_mask:0xf bank_mask:0xf
    v_pk_mul_f32 v[94:95], v[64:65], v[26:27] op_sel_hi:[1,0]
    v_pk_mul_f32 v[96:97], v[64:65], v[26:27] op_sel:[0,1] op_sel_hi:[1,1]
    v_fract_f32 v95, v95
    v_fract_f32 v97, v97
    v_exp_f32 v94, v94
    v_exp_f32 v96, v96
    v_cos_f32 v68, v95
    v_sin_f32 v69, v95
    v_cos_f32 v76, v97
    v_sin_f32 v77, v97
    v_pk_mul_f32 v[68:69], v[68:69], v[94:95] op_sel_hi:[1,0]
    v_pk_mul_f32 v[76:77], v[76:77], v[96:97] op_sel_hi:[1,0]
    v_pk_mul_f32 v[92:93], v[76:77], v[76:77] op_sel:[1,1] op_sel_hi:[0,1]
    v_pk_fma_f32 v[78:79], v[76:77], v[76:77], v[92:93] op_sel:[0,0,0] op_sel_hi:[0,1,1] neg_lo:[0,0,1]
    v_pk_mul_f32 v[94:95], v[68:69], v[68:69] op_sel:[1,1] op_sel_hi:[0,1]
    v_pk_fma_f32 v[70:71], v[68:69], v[68:69], v[94:95] op_sel:[0,0,0] op_sel_hi:[0,1,1] neg_lo:[0,0,1]
    v_pk_mul_f32 v[92:93], v[78:79], v[78:79] op_sel:[1,1] op_sel_hi:[0,1]
    v_pk_fma_f32 v[80:81], v[78:79], v[78:79], v[92:93] op_sel:[0,0,0] op_sel_hi:[0,1,1] neg_lo:[0,0,1]
    v_pk_mul_f32 v[94:95], v[70:71], v[70:71] op_sel:[1,1] op_sel_hi:[0,1]
    v_pk_fma_f32 v[72:73], v[70:71], v[70:71], v[94:95] op_sel:[0,0,0] op_sel_hi:[0,1,1] neg_lo:[0,0,1]
    v_pk_mul_f32 v[92:93], v[80:81], v[80:81] op_sel:[1,1] op_sel_hi:[0,1]
    v_pk_fma_f32 v[82:83], v[80:81], v[80:81], v[92:93] op_sel:[0,0,0] op_sel_hi:[0,1,1] neg_lo:[0,0,1]
    v_pk_mul_f32 v[94:95], v[72:73], v[72:73] op_sel:[1,1] op_sel_hi:[0,1]
    v_pk_fma_f32 v[74:75], v[72:73], v[72:73], v[94:95] op_sel:[0,0,0] op_sel_hi:[0,1,1] neg_lo:[0,0,1]
    v_pk_mul_f32 v[92:93], v[82:83], v[82:83] op_sel:[1,1] op_sel_hi:[0,1]
    v_pk_fma_f32 v[84:85], v[82:83], v[82:83], v[92:93] op_sel:[0,0,0] op_sel_hi:[0,1,1] neg_lo:[0,0,1]
    v_pk_mul_f32 v[94:95], v[66:67], v[76:77] op_sel:[1,1] op_sel_hi:[1,0]
    v_pk_fma_f32 v[86:87], v[66:67], v[76:77], v[94:95] op_sel:[0,0,0] op_sel_hi:[0,1,1] neg_lo:[0,0,1] neg_hi:[1,0,1]
    v_mov_b32_dpp v80, v78 row_ror:8 row_mask:0xf bank_mask:0x3
    v_mov_b32_dpp v81, v79 row_ror:8 row_mask:0xf bank_mask:0x3
    v_mov_b32_dpp v82, v84 row_ror:8 row_mask:0xf bank_mask:0x3
    v_mov_b32_dpp v83, v85 row_ror:8 row_mask:0xf bank_mask:0x3
    v_pk_mul_f32 v[92:93], v[66:67], v[80:81] op_sel:[1,1] op_sel_hi:[1,0]
    v_pk_fma_f32 v[88:89], v[66:67], v[80:81], v[92:93] op_sel:[0,0,0] op_sel_hi:[0,1,1] neg_lo:[0,0,1] neg_hi:[1,0,1]
    v_pk_mul_f32 v[94:95], v[66:67], v[82:83] op_sel:[1,1] op_sel_hi:[1,0]
    v_pk_fma_f32 v[90:91], v[66:67], v[82:83], v[94:95] op_sel:[0,0,0] op_sel_hi:[0,1,1] neg_lo:[0,0,1] neg_hi:[1,0,1]
    v_mfma_f32_16x16x4_f32 v[48:51], v86, v68, v[48:51]
    v_mfma_f32_16x16x4_f32 v[52:55], v88, v70, v[52:55]
    v_mfma_f32_16x16x4_f32 v[56:59], v88, v72, v[56:59]
    v_mfma_f32_16x16x4_f32 v[60:63], v90, v74, v[60:63]
    v_mfma_f32_16x16x4_f32 v[48:51], v87, v69, v[48:51]
    v_mfma_f32_16x16x4_f32 v[52:55], v89, v71, v[52:55]
    v_mfma_f32_16x16x4_f32 v[56:59], v89, v73, v[56:59]
    v_mfma_f32_16x16x4_f32 v[60:63], v91, v75, v[60:63]
    v_mov_b64_dpp v[64:65], v[28:29] row_newbcast:11 row_mask:0xf bank_mask:0xf
    v_mov_b64_dpp v[66:67], v[30:31] row_newbcast:11 row_mask:0xf bank_mask:0xf
    v_pk_mul_f32 v[94:95], v[64:65], v[26:27] op_sel_hi:[1,0]
    v_pk_mul_f32 v[96:97], v[64:65], v[26:27] op_sel:[0,1] op_sel_hi:[1,1]
    v_fract_f32 v95, v95
    v_fract_f32 v97, v97
    v_exp_f32 v94, v94
    v_exp_f32 v96, v96
    v_cos_f32 v68, v95
    v_sin_f32 v69, v95
    v_cos_f32 v76, v97
    v_sin_f32 v77, v97
    v_pk_mul_f32 v[68:69], v[68:69], v[94:95] op_sel_hi:[1,0]
    v_pk_mul_f32 v[76:77], v[76:77], v[96:97] op_sel_hi:[1,0]
    v_pk_mul_f32 v[92:93], v[76:77], v[76:77] op_sel:[1,1] op_sel_hi:[0,1]
    v_pk_fma_f32 v[78:79], v[76:77], v[76:77], v[92:93] op_sel:[0,0,0] op_sel_hi:[0,1,1] neg_lo:[0,0,1]
    v_pk_mul_f32 v[94:95], v[68:69], v[68:69] op_sel:[1,1] op_sel_hi:[0,1]
    v_pk_fma_f32 v[70:71], v[68:69], v[68:69], v[94:95] op_sel:[0,0,0] op_sel_hi:[0,1,1] neg_lo:[0,0,1]
    v_pk_mul_f32 v[92:93], v[78:79], v[78:79] op_sel:[1,1] op_sel_hi:[0,1]
    v_pk_fma_f32 v[80:81], v[78:79], v[78:79], v[92:93] op_sel:[0,0,0] op_sel_hi:[0,1,1] neg_lo:[0,0,1]
    v_pk_mul_f32 v[94:95], v[70:71], v[70:71] op_sel:[1,1] op_sel_hi:[0,1]
    v_pk_fma_f32 v[72:73], v[70:71], v[70:71], v[94:95] op_sel:[0,0,0] op_sel_hi:[0,1,1] neg_lo:[0,0,1]
    v_pk_mul_f32 v[92:93], v[80:81], v[80:81] op_sel:[1,1] op_sel_hi:[0,1]
    v_pk_fma_f32 v[82:83], v[80:81], v[80:81], v[92:93] op_sel:[0,0,0] op_sel_hi:[0,1,1] neg_lo:[0,0,1]
    v_pk_mul_f32 v[94:95], v[72:73], v[72:73] op_sel:[1,1] op_sel_hi:[0,1]
    v_pk_fma_f32 v[74:75], v[72:73], v[72:73], v[94:95] op_sel:[0,0,0] op_sel_hi:[0,1,1] neg_lo:[0,0,1]
    v_pk_mul_f32 v[92:93], v[82:83], v[82:83] op_sel:[1,1] op_sel_hi:[0,1]
    v_pk_fma_f32 v[84:85], v[82:83], v[82:83], v[92:93] op_sel:[0,0,0] op_sel_hi:[0,1,1] neg_lo:[0,0,1]
    v_pk_mul_f32 v[94:95], v[66:67], v[76:77] op_sel:[1,1] op_sel_hi:[1,0]
    v_pk_fma_f32 v[86:87], v[66:67], v[76:77], v[94:95] op_sel:[0,0,0] op_sel_hi:[0,1,1] neg_lo:[0,0,1] neg_hi:[1,0,1]
    v_mov_b32_dpp v80, v78 row_ror:8 row_mask:0xf bank_mask:0x3
    v_mov_b32_dpp v81, v79 row_ror:8 row_mask:0xf bank_mask:0x3
    v_mov_b32_dpp v82, v84 row_ror:8 row_mask:0xf bank_mask:0x3
    v_mov_b32_dpp v83, v85 row_ror:8 row_mask:0xf bank_mask:0x3
    v_pk_mul_f32 v[92:93], v[66:67], v[80:81] op_sel:[1,1] op_sel_hi:[1,0]
    v_pk_fma_f32 v[88:89], v[66:67], v[80:81], v[92:93] op_sel:[0,0,0] op_sel_hi:[0,1,1] neg_lo:[0,0,1] neg_hi:[1,0,1]
    v_pk_mul_f32 v[94:95], v[66:67], v[82:83] op_sel:[1,1] op_sel_hi:[1,0]
    v_pk_fma_f32 v[90:91], v[66:67], v[82:83], v[94:95] op_sel:[0,0,0] op_sel_hi:[0,1,1] neg_lo:[0,0,1] neg_hi:[1,0,1]
    v_mfma_f32_16x16x4_f32 v[48:51], v86, v68, v[48:51]
    v_mfma_f32_16x16x4_f32 v[52:55], v88, v70, v[52:55]
    v_mfma_f32_16x16x4_f32 v[56:59], v88, v72, v[56:59]
    v_mfma_f32_16x16x4_f32 v[60:63], v90, v74, v[60:63]
    v_mfma_f32_16x16x4_f32 v[48:51], v87, v69, v[48:51]
    v_mfma_f32_16x16x4_f32 v[52:55], v89, v71, v[52:55]
    v_mfma_f32_16x16x4_f32 v[56:59], v89, v73, v[56:59]
    v_mfma_f32_16x16x4_f32 v[60:63], v91, v75, v[60:63]
    v_mov_b64_dpp v[64:65], v[28:29] row_newbcast:12 row_mask:0xf bank_mask:0xf
    v_mov_b64_dpp v[66:67], v[30:31] row_newbcast:12 row_mask:0xf bank_mask:0xf
    v_pk_mul_f32 v[94:95], v[64:65], v[26:27] op_sel_hi:[1,0]
    v_pk_mul_f32 v[96:97], v[64:65], v[26:27] op_sel:[0,1] op_sel_hi:[1,1]
    v_fract_f32 v95, v95
    v_fract_f32 v97, v97
    v_exp_f32 v94, v94
    v_exp_f32 v96, v96
    v_cos_f32 v68, v95
    v_sin_f32 v69, v95
    v_cos_f32 v76, v97
    v_sin_f32 v77, v97
    v_pk_mul_f32 v[68:69], v[68:69], v[94:95] op_sel_hi:[1,0]
    v_pk_mul_f32 v[76:77], v[76:77], v[96:97] op_sel_hi:[1,0]
    v_pk_mul_f32 v[92:93], v[76:77], v[76:77] op_sel:[1,1] op_sel_hi:[0,1]
    v_pk_fma_f32 v[78:79], v[76:77], v[76:77], v[92:93] op_sel:[0,0,0] op_sel_hi:[0,1,1] neg_lo:[0,0,1]
    v_pk_mul_f32 v[94:95], v[68:69], v[68:69] op_sel:[1,1] op_sel_hi:[0,1]
    v_pk_fma_f32 v[70:71], v[68:69], v[68:69], v[94:95] op_sel:[0,0,0] op_sel_hi:[0,1,1] neg_lo:[0,0,1]
    v_pk_mul_f32 v[92:93], v[78:79], v[78:79] op_sel:[1,1] op_sel_hi:[0,1]
    v_pk_fma_f32 v[80:81], v[78:79], v[78:79], v[92:93] op_sel:[0,0,0] op_sel_hi:[0,1,1] neg_lo:[0,0,1]
    v_pk_mul_f32 v[94:95], v[70:71], v[70:71] op_sel:[1,1] op_sel_hi:[0,1]
    v_pk_fma_f32 v[72:73], v[70:71], v[70:71], v[94:95] op_sel:[0,0,0] op_sel_hi:[0,1,1] neg_lo:[0,0,1]
    v_pk_mul_f32 v[92:93], v[80:81], v[80:81] op_sel:[1,1] op_sel_hi:[0,1]
    v_pk_fma_f32 v[82:83], v[80:81], v[80:81], v[92:93] op_sel:[0,0,0] op_sel_hi:[0,1,1] neg_lo:[0,0,1]
    v_pk_mul_f32 v[94:95], v[72:73], v[72:73] op_sel:[1,1] op_sel_hi:[0,1]
    v_pk_fma_f32 v[74:75], v[72:73], v[72:73], v[94:95] op_sel:[0,0,0] op_sel_hi:[0,1,1] neg_lo:[0,0,1]
    v_pk_mul_f32 v[92:93], v[82:83], v[82:83] op_sel:[1,1] op_sel_hi:[0,1]
    v_pk_fma_f32 v[84:85], v[82:83], v[82:83], v[92:93] op_sel:[0,0,0] op_sel_hi:[0,1,1] neg_lo:[0,0,1]
    v_pk_mul_f32 v[94:95], v[66:67], v[76:77] op_sel:[1,1] op_sel_hi:[1,0]
    v_pk_fma_f32 v[86:87], v[66:67], v[76:77], v[94:95] op_sel:[0,0,0] op_sel_hi:[0,1,1] neg_lo:[0,0,1] neg_hi:[1,0,1]
    v_mov_b32_dpp v80, v78 row_ror:8 row_mask:0xf bank_mask:0x3
    v_mov_b32_dpp v81, v79 row_ror:8 row_mask:0xf bank_mask:0x3
    v_mov_b32_dpp v82, v84 row_ror:8 row_mask:0xf bank_mask:0x3
    v_mov_b32_dpp v83, v85 row_ror:8 row_mask:0xf bank_mask:0x3
    v_pk_mul_f32 v[92:93], v[66:67], v[80:81] op_sel:[1,1] op_sel_hi:[1,0]
    v_pk_fma_f32 v[88:89], v[66:67], v[80:81], v[92:93] op_sel:[0,0,0] op_sel_hi:[0,1,1] neg_lo:[0,0,1] neg_hi:[1,0,1]
    v_pk_mul_f32 v[94:95], v[66:67], v[82:83] op_sel:[1,1] op_sel_hi:[1,0]
    v_pk_fma_f32 v[90:91], v[66:67], v[82:83], v[94:95] op_sel:[0,0,0] op_sel_hi:[0,1,1] neg_lo:[0,0,1] neg_hi:[1,0,1]
    v_mfma_f32_16x16x4_f32 v[48:51], v86, v68, v[48:51]
    v_mfma_f32_16x16x4_f32 v[52:55], v88, v70, v[52:55]
    v_mfma_f32_16x16x4_f32 v[56:59], v88, v72, v[56:59]
    v_mfma_f32_16x16x4_f32 v[60:63], v90, v74, v[60:63]
    v_mfma_f32_16x16x4_f32 v[48:51], v87, v69, v[48:51]
    v_mfma_f32_16x16x4_f32 v[52:55], v89, v71, v[52:55]
    v_mfma_f32_16x16x4_f32 v[56:59], v89, v73, v[56:59]
    v_mfma_f32_16x16x4_f32 v[60:63], v91, v75, v[60:63]
    v_mov_b64_dpp v[64:65], v[28:29] row_newbcast:13 row_mask:0xf bank_mask:0xf
    v_mov_b64_dpp v[66:67], v[30:31] row_newbcast:13 row_mask:0xf bank_mask:0xf
    v_pk_mul_f32 v[94:95], v[64:65], v[26:27] op_sel_hi:[1,0]
    v_pk_mul_f32 v[96:97], v[64:65], v[26:27] op_sel:[0,1] op_sel_hi:[1,1]
    v_fract_f32 v95, v95
    v_fract_f32 v97, v97
    v_exp_f32 v94, v94
    v_exp_f32 v96, v96
    v_cos_f32 v68, v95
    v_sin_f32 v69, v95
    v_cos_f32 v76, v97
    v_sin_f32 v77, v97
    v_pk_mul_f32 v[68:69], v[68:69], v[94:95] op_sel_hi:[1,0]
    v_pk_mul_f32 v[76:77], v[76:77], v[96:97] op_sel_hi:[1,0]
    v_pk_mul_f32 v[92:93], v[76:77], v[76:77] op_sel:[1,1] op_sel_hi:[0,1]
    v_pk_fma_f32 v[78:79], v[76:77], v[76:77], v[92:93] op_sel:[0,0,0] op_sel_hi:[0,1,1] neg_lo:[0,0,1]
    v_pk_mul_f32 v[94:95], v[68:69], v[68:69] op_sel:[1,1] op_sel_hi:[0,1]
    v_pk_fma_f32 v[70:71], v[68:69], v[68:69], v[94:95] op_sel:[0,0,0] op_sel_hi:[0,1,1] neg_lo:[0,0,1]
    v_pk_mul_f32 v[92:93], v[78:79], v[78:79] op_sel:[1,1] op_sel_hi:[0,1]
    v_pk_fma_f32 v[80:81], v[78:79], v[78:79], v[92:93] op_sel:[0,0,0] op_sel_hi:[0,1,1] neg_lo:[0,0,1]
    v_pk_mul_f32 v[94:95], v[70:71], v[70:71] op_sel:[1,1] op_sel_hi:[0,1]
    v_pk_fma_f32 v[72:73], v[70:71], v[70:71], v[94:95] op_sel:[0,0,0] op_sel_hi:[0,1,1] neg_lo:[0,0,1]
    v_pk_mul_f32 v[92:93], v[80:81], v[80:81] op_sel:[1,1] op_sel_hi:[0,1]
    v_pk_fma_f32 v[82:83], v[80:81], v[80:81], v[92:93] op_sel:[0,0,0] op_sel_hi:[0,1,1] neg_lo:[0,0,1]
    v_pk_mul_f32 v[94:95], v[72:73], v[72:73] op_sel:[1,1] op_sel_hi:[0,1]
    v_pk_fma_f32 v[74:75], v[72:73], v[72:73], v[94:95] op_sel:[0,0,0] op_sel_hi:[0,1,1] neg_lo:[0,0,1]
    v_pk_mul_f32 v[92:93], v[82:83], v[82:83] op_sel:[1,1] op_sel_hi:[0,1]
    v_pk_fma_f32 v[84:85], v[82:83], v[82:83], v[92:93] op_sel:[0,0,0] op_sel_hi:[0,1,1] neg_lo:[0,0,1]
    v_pk_mul_f32 v[94:95], v[66:67], v[76:77] op_sel:[1,1] op_sel_hi:[1,0]
    v_pk_fma_f32 v[86:87], v[66:67], v[76:77], v[94:95] op_sel:[0,0,0] op_sel_hi:[0,1,1] neg_lo:[0,0,1] neg_hi:[1,0,1]
    v_mov_b32_dpp v80, v78 row_ror:8 row_mask:0xf bank_mask:0x3
    v_mov_b32_dpp v81, v79 row_ror:8 row_mask:0xf bank_mask:0x3
    v_mov_b32_dpp v82, v84 row_ror:8 row_mask:0xf bank_mask:0x3
    v_mov_b32_dpp v83, v85 row_ror:8 row_mask:0xf bank_mask:0x3
    v_pk_mul_f32 v[92:93], v[66:67], v[80:81] op_sel:[1,1] op_sel_hi:[1,0]
    v_pk_fma_f32 v[88:89], v[66:67], v[80:81], v[92:93] op_sel:[0,0,0] op_sel_hi:[0,1,1] neg_lo:[0,0,1] neg_hi:[1,0,1]
    v_pk_mul_f32 v[94:95], v[66:67], v[82:83] op_sel:[1,1] op_sel_hi:[1,0]
    v_pk_fma_f32 v[90:91], v[66:67], v[82:83], v[94:95] op_sel:[0,0,0] op_sel_hi:[0,1,1] neg_lo:[0,0,1] neg_hi:[1,0,1]
    v_mfma_f32_16x16x4_f32 v[48:51], v86, v68, v[48:51]
    v_mfma_f32_16x16x4_f32 v[52:55], v88, v70, v[52:55]
    v_mfma_f32_16x16x4_f32 v[56:59], v88, v72, v[56:59]
    v_mfma_f32_16x16x4_f32 v[60:63], v90, v74, v[60:63]
    v_mfma_f32_16x16x4_f32 v[48:51], v87, v69, v[48:51]
    v_mfma_f32_16x16x4_f32 v[52:55], v89, v71, v[52:55]
    v_mfma_f32_16x16x4_f32 v[56:59], v89, v73, v[56:59]
    v_mfma_f32_16x16x4_f32 v[60:63], v91, v75, v[60:63]
    v_mov_b64_dpp v[64:65], v[28:29] row_newbcast:14 row_mask:0xf bank_mask:0xf
    v_mov_b64_dpp v[66:67], v[30:31] row_newbcast:14 row_mask:0xf bank_mask:0xf
    v_pk_mul_f32 v[94:95], v[64:65], v[26:27] op_sel_hi:[1,0]
    v_pk_mul_f32 v[96:97], v[64:65], v[26:27] op_sel:[0,1] op_sel_hi:[1,1]
    v_fract_f32 v95, v95
    v_fract_f32 v97, v97
    v_exp_f32 v94, v94
    v_exp_f32 v96, v96
    v_cos_f32 v68, v95
    v_sin_f32 v69, v95
    v_cos_f32 v76, v97
    v_sin_f32 v77, v97
    v_pk_mul_f32 v[68:69], v[68:69], v[94:95] op_sel_hi:[1,0]
    v_pk_mul_f32 v[76:77], v[76:77], v[96:97] op_sel_hi:[1,0]
    v_pk_mul_f32 v[92:93], v[76:77], v[76:77] op_sel:[1,1] op_sel_hi:[0,1]
    v_pk_fma_f32 v[78:79], v[76:77], v[76:77], v[92:93] op_sel:[0,0,0] op_sel_hi:[0,1,1] neg_lo:[0,0,1]
    v_pk_mul_f32 v[94:95], v[68:69], v[68:69] op_sel:[1,1] op_sel_hi:[0,1]
    v_pk_fma_f32 v[70:71], v[68:69], v[68:69], v[94:95] op_sel:[0,0,0] op_sel_hi:[0,1,1] neg_lo:[0,0,1]
    v_pk_mul_f32 v[92:93], v[78:79], v[78:79] op_sel:[1,1] op_sel_hi:[0,1]
    v_pk_fma_f32 v[80:81], v[78:79], v[78:79], v[92:93] op_sel:[0,0,0] op_sel_hi:[0,1,1] neg_lo:[0,0,1]
    v_pk_mul_f32 v[94:95], v[70:71], v[70:71] op_sel:[1,1] op_sel_hi:[0,1]
    v_pk_fma_f32 v[72:73], v[70:71], v[70:71], v[94:95] op_sel:[0,0,0] op_sel_hi:[0,1,1] neg_lo:[0,0,1]
    v_pk_mul_f32 v[92:93], v[80:81], v[80:81] op_sel:[1,1] op_sel_hi:[0,1]
    v_pk_fma_f32 v[82:83], v[80:81], v[80:81], v[92:93] op_sel:[0,0,0] op_sel_hi:[0,1,1] neg_lo:[0,0,1]
    v_pk_mul_f32 v[94:95], v[72:73], v[72:73] op_sel:[1,1] op_sel_hi:[0,1]
    v_pk_fma_f32 v[74:75], v[72:73], v[72:73], v[94:95] op_sel:[0,0,0] op_sel_hi:[0,1,1] neg_lo:[0,0,1]
    v_pk_mul_f32 v[92:93], v[82:83], v[82:83] op_sel:[1,1] op_sel_hi:[0,1]
    v_pk_fma_f32 v[84:85], v[82:83], v[82:83], v[92:93] op_sel:[0,0,0] op_sel_hi:[0,1,1] neg_lo:[0,0,1]
    v_pk_mul_f32 v[94:95], v[66:67], v[76:77] op_sel:[1,1] op_sel_hi:[1,0]
    v_pk_fma_f32 v[86:87], v[66:67], v[76:77], v[94:95] op_sel:[0,0,0] op_sel_hi:[0,1,1] neg_lo:[0,0,1] neg_hi:[1,0,1]
    v_mov_b32_dpp v80, v78 row_ror:8 row_mask:0xf bank_mask:0x3
    v_mov_b32_dpp v81, v79 row_ror:8 row_mask:0xf bank_mask:0x3
    v_mov_b32_dpp v82, v84 row_ror:8 row_mask:0xf bank_mask:0x3
    v_mov_b32_dpp v83, v85 row_ror:8 row_mask:0xf bank_mask:0x3
    v_pk_mul_f32 v[92:93], v[66:67], v[80:81] op_sel:[1,1] op_sel_hi:[1,0]
    v_pk_fma_f32 v[88:89], v[66:67], v[80:81], v[92:93] op_sel:[0,0,0] op_sel_hi:[0,1,1] neg_lo:[0,0,1] neg_hi:[1,0,1]
    v_pk_mul_f32 v[94:95], v[66:67], v[82:83] op_sel:[1,1] op_sel_hi:[1,0]
    v_pk_fma_f32 v[90:91], v[66:67], v[82:83], v[94:95] op_sel:[0,0,0] op_sel_hi:[0,1,1] neg_lo:[0,0,1] neg_hi:[1,0,1]
    v_mfma_f32_16x16x4_f32 v[48:51], v86, v68, v[48:51]
    v_mfma_f32_16x16x4_f32 v[52:55], v88, v70, v[52:55]
    v_mfma_f32_16x16x4_f32 v[56:59], v88, v72, v[56:59]
    v_mfma_f32_16x16x4_f32 v[60:63], v90, v74, v[60:63]
    v_mfma_f32_16x16x4_f32 v[48:51], v87, v69, v[48:51]
    v_mfma_f32_16x16x4_f32 v[52:55], v89, v71, v[52:55]
    v_mfma_f32_16x16x4_f32 v[56:59], v89, v73, v[56:59]
    v_mfma_f32_16x16x4_f32 v[60:63], v91, v75, v[60:63]
    v_mov_b64_dpp v[64:65], v[28:29] row_newbcast:15 row_mask:0xf bank_mask:0xf
    v_mov_b64_dpp v[66:67], v[30:31] row_newbcast:15 row_mask:0xf bank_mask:0xf
    v_pk_mul_f32 v[94:95], v[64:65], v[26:27] op_sel_hi:[1,0]
    v_pk_mul_f32 v[96:97], v[64:65], v[26:27] op_sel:[0,1] op_sel_hi:[1,1]
    v_fract_f32 v95, v95
    v_fract_f32 v97, v97
    v_exp_f32 v94, v94
    v_exp_f32 v96, v96
    v_cos_f32 v68, v95
    v_sin_f32 v69, v95
    v_cos_f32 v76, v97
    v_sin_f32 v77, v97
    v_pk_mul_f32 v[68:69], v[68:69], v[94:95] op_sel_hi:[1,0]
    v_pk_mul_f32 v[76:77], v[76:77], v[96:97] op_sel_hi:[1,0]
    v_pk_mul_f32 v[92:93], v[76:77], v[76:77] op_sel:[1,1] op_sel_hi:[0,1]
    v_pk_fma_f32 v[78:79], v[76:77], v[76:77], v[92:93] op_sel:[0,0,0] op_sel_hi:[0,1,1] neg_lo:[0,0,1]
    v_pk_mul_f32 v[94:95], v[68:69], v[68:69] op_sel:[1,1] op_sel_hi:[0,1]
    v_pk_fma_f32 v[70:71], v[68:69], v[68:69], v[94:95] op_sel:[0,0,0] op_sel_hi:[0,1,1] neg_lo:[0,0,1]
    v_pk_mul_f32 v[92:93], v[78:79], v[78:79] op_sel:[1,1] op_sel_hi:[0,1]
    v_pk_fma_f32 v[80:81], v[78:79], v[78:79], v[92:93] op_sel:[0,0,0] op_sel_hi:[0,1,1] neg_lo:[0,0,1]
    v_pk_mul_f32 v[94:95], v[70:71], v[70:71] op_sel:[1,1] op_sel_hi:[0,1]
    v_pk_fma_f32 v[72:73], v[70:71], v[70:71], v[94:95] op_sel:[0,0,0] op_sel_hi:[0,1,1] neg_lo:[0,0,1]
    v_pk_mul_f32 v[92:93], v[80:81], v[80:81] op_sel:[1,1] op_sel_hi:[0,1]
    v_pk_fma_f32 v[82:83], v[80:81], v[80:81], v[92:93] op_sel:[0,0,0] op_sel_hi:[0,1,1] neg_lo:[0,0,1]
    v_pk_mul_f32 v[94:95], v[72:73], v[72:73] op_sel:[1,1] op_sel_hi:[0,1]
    v_pk_fma_f32 v[74:75], v[72:73], v[72:73], v[94:95] op_sel:[0,0,0] op_sel_hi:[0,1,1] neg_lo:[0,0,1]
    v_pk_mul_f32 v[92:93], v[82:83], v[82:83] op_sel:[1,1] op_sel_hi:[0,1]
    v_pk_fma_f32 v[84:85], v[82:83], v[82:83], v[92:93] op_sel:[0,0,0] op_sel_hi:[0,1,1] neg_lo:[0,0,1]
    v_pk_mul_f32 v[94:95], v[66:67], v[76:77] op_sel:[1,1] op_sel_hi:[1,0]
    v_pk_fma_f32 v[86:87], v[66:67], v[76:77], v[94:95] op_sel:[0,0,0] op_sel_hi:[0,1,1] neg_lo:[0,0,1] neg_hi:[1,0,1]
    v_mov_b32_dpp v80, v78 row_ror:8 row_mask:0xf bank_mask:0x3
    v_mov_b32_dpp v81, v79 row_ror:8 row_mask:0xf bank_mask:0x3
    v_mov_b32_dpp v82, v84 row_ror:8 row_mask:0xf bank_mask:0x3
    v_mov_b32_dpp v83, v85 row_ror:8 row_mask:0xf bank_mask:0x3
    v_pk_mul_f32 v[92:93], v[66:67], v[80:81] op_sel:[1,1] op_sel_hi:[1,0]
    v_pk_fma_f32 v[88:89], v[66:67], v[80:81], v[92:93] op_sel:[0,0,0] op_sel_hi:[0,1,1] neg_lo:[0,0,1] neg_hi:[1,0,1]
    v_pk_mul_f32 v[94:95], v[66:67], v[82:83] op_sel:[1,1] op_sel_hi:[1,0]
    v_pk_fma_f32 v[90:91], v[66:67], v[82:83], v[94:95] op_sel:[0,0,0] op_sel_hi:[0,1,1] neg_lo:[0,0,1] neg_hi:[1,0,1]
    v_mfma_f32_16x16x4_f32 v[48:51], v86, v68, v[48:51]
    v_mfma_f32_16x16x4_f32 v[52:55], v88, v70, v[52:55]
    v_mfma_f32_16x16x4_f32 v[56:59], v88, v72, v[56:59]
    v_mfma_f32_16x16x4_f32 v[60:63], v90, v74, v[60:63]
    v_mfma_f32_16x16x4_f32 v[48:51], v87, v69, v[48:51]
    v_mfma_f32_16x16x4_f32 v[52:55], v89, v71, v[52:55]
    v_mfma_f32_16x16x4_f32 v[56:59], v89, v73, v[56:59]
    v_mfma_f32_16x16x4_f32 v[60:63], v91, v75, v[60:63]
    v_mov_b64 v[28:29], v[32:33]
    v_mov_b64 v[30:31], v[34:35]
    s_add_u32 s25, s25, 1
    s_cmp_lt_u32 s25, 2
    s_cbranch_scc1 ss_kg
    s_cmp_lg_u32 s28, 0
    s_cbranch_scc1 ss_nostage
    s_waitcnt vmcnt(0)
    v_mov_b32 v36, 0x05040100
    v_mov_b32 v37, 0x07060302
    v_lshlrev_b32 v6, 4, v0
    v_add_u32 v7, 65536, v6
    v_perm_b32 v40, v212, v208, v36
    v_perm_b32 v41, v220, v216, v36
    v_perm_b32 v42, v228, v224, v36
    v_perm_b32 v43, v236, v232, v36
    ds_write_b128 v6, v[40:43] offset:512
    v_perm_b32 v44, v212, v208, v37
    v_perm_b32 v45, v220, v216, v37
    v_perm_b32 v46, v228, v224, v37
    v_perm_b32 v47, v236, v232, v37
    ds_write_b128 v6, v[44:47] offset:16896
    v_perm_b32 v40, v213, v209, v36
    v_perm_b32 v41, v221, v217, v36
    v_perm_b32 v42, v229, v225, v36
    v_perm_b32 v43, v237, v233, v36
    ds_write_b128 v6, v[40:43] offset:33280
    v_perm_b32 v44, v213, v209, v37
    v_perm_b32 v45, v221, v217, v37
    v_perm_b32 v46, v229, v225, v37
    v_perm_b32 v47, v237, v233, v37
    ds_write_b128 v6, v[44:47] offset:49664
    v_perm_b32 v40, v214, v210, v36
    v_perm_b32 v41, v222, v218, v36
    v_perm_b32 v42, v230, v226, v36
    v_perm_b32 v43, v238, v234, v36
    ds_write_b128 v7, v[40:43] offset:512
    v_perm_b32 v44, v214, v210, v37
    v_perm_b32 v45, v222, v218, v37
    v_perm_b32 v46, v230, v226, v37
    v_perm_b32 v47, v238, v234, v37
    ds_write_b128 v7, v[44:47] offset:16896
    v_perm_b32 v40, v215, v211, v36
    v_perm_b32 v41, v223, v219, v36
    v_perm_b32 v42, v231, v227, v36
    v_perm_b32 v43, v239, v235, v36
    ds_write_b128 v7, v[40:43] offset:33280
    v_perm_b32 v44, v215, v211, v37
    v_perm_b32 v45, v223, v219, v37
    v_perm_b32 v46, v231, v227, v37
    v_perm_b32 v47, v239, v235, v37
    ds_write_b128 v7, v[44:47] offset:49664
ss_nostage:
    s_nop 11
    v_lshlrev_b32 v5, 8, v3
    v_lshl_add_u32 v5, v2, 2, v5
    v_add_u32 v5, v5, v4
    ds_write_b32 v5, v48 offset:4608
    ds_write_b32 v5, v49 offset:4672
    ds_write_b32 v5, v50 offset:4736
    ds_write_b32 v5, v51 offset:4800
    s_mov_b32 exec_hi, 0
    ds_write_b32 v5, v52 offset:5632
    ds_write_b32 v5, v53 offset:5696
    ds_write_b32 v5, v54 offset:5760
    ds_write_b32 v5, v55 offset:5824
    s_not_b64 exec, exec
    ds_write_b32 v5, v56 offset:5632
    ds_write_b32 v5, v57 offset:5696
    ds_write_b32 v5, v58 offset:5760
    ds_write_b32 v5, v59 offset:5824
    ds_write_b32 v5, v60 offset:6144
    ds_write_b32 v5, v61 offset:6208
    ds_write_b32 v5, v62 offset:6272
    ds_write_b32 v5, v63 offset:6336
    s_mov_b64 exec, 3
    v_cmp_eq_u32 vcc, 0, v2
    s_nop 1
    v_cndmask_b32 v6, 0, v60, vcc
    ds_write_b32 v5, v6 offset:7168
    s_mov_b64 exec, -1
    s_waitcnt lgkmcnt(0)
    v_lshlrev_b32 v7, 1, v1
    v_sub_u32 v7, 2065, v7
    v_lshl_add_u32 v64, v1, 2, v4
    v_mov_b32 v65, 641
    s_mov_b32 s25, 9
    s_mov_b32 s22, 256
    s_mov_b32 s23, 2048
ss_exp:
    v_subrev_u32 v66, 0, v7
    v_cvt_f32_u32 v72, v66
    v_cmp_gt_u32 vcc, s22, v66
    v_cvt_pk_bf16_f32 v72, v72, 0
    v_subrev_u32 v72, 0x4280, v72
    v_cndmask_b32 v72, v72, v66, vcc
    v_cmp_gt_u32 vcc, s23, v66
    s_nop 1
    v_cndmask_b32 v72, v65, v72, vcc
    v_lshl_add_u32 v72, v72, 2, v4
    v_subrev_u32 v67, 1, v7
    v_cvt_f32_u32 v73, v67
    v_cmp_gt_u32 vcc, s22, v67
    v_cvt_pk_bf16_f32 v73, v73, 0
    v_subrev_u32 v73, 0x4280, v73
    v_cndmask_b32 v73, v73, v67, vcc
    v_cmp_gt_u32 vcc, s23, v67
    ds_read_b32 v78, v72 offset:4608
    s_nop 0
    v_cndmask_b32 v73, v65, v73, vcc
    v_lshl_add_u32 v73, v73, 2, v4
    v_subrev_u32 v68, 2, v7
    v_cvt_f32_u32 v74, v68
    v_cmp_gt_u32 vcc, s22, v68
    v_cvt_pk_bf16_f32 v74, v74, 0
    v_subrev_u32 v74, 0x4280, v74
    v_cndmask_b32 v74, v74, v68, vcc
    v_cmp_gt_u32 vcc, s23, v68
    ds_read_b32 v79, v73 offset:4608
    s_nop 0
    v_cndmask_b32 v74, v65, v74, vcc
    v_lshl_add_u32 v74, v74, 2, v4
    v_subrev_u32 v69, 128, v7
    v_cvt_f32_u32 v75, v69
    v_cmp_gt_u32 vcc, s22, v69
    v_cvt_pk_bf16_f32 v75, v75, 0
    v_subrev_u32 v75, 0x4280, v75
    v_cndmask_b32 v75, v75, v69, vcc
    v_cmp_gt_u32 vcc, s23, v69
    ds_read_b32 v80, v74 offset:4608
    s_nop 0
    v_cndmask_b32 v75, v65, v75, vcc
    v_lshl_add_u32 v75, v75, 2, v4
    v_subrev_u32 v70, 129, v7
    v_cvt_f32_u32 v76, v70
    v_cmp_gt_u32 vcc, s22, v70
    v_cvt_pk_bf16_f32 v76, v76, 0
    v_subrev_u32 v76, 0x4280, v76
    v_cndmask_b32 v76, v76, v70, vcc
    v_cmp_gt_u32 vcc, s23, v70
    ds_read_b32 v81, v75 offset:4608
    s_nop 0
    v_cndmask_b32 v76, v65, v76, vcc
    v_lshl_add_u32 v76, v76, 2, v4
    v_subrev_u32 v71, 130, v7
    v_cvt_f32_u32 v77, v71
    v_cmp_gt_u32 vcc, s22, v71
    v_cvt_pk_bf16_f32 v77, v77, 0
    v_subrev_u32 v77, 0x4280, v77
    v_cndmask_b32 v77, v77, v71, vcc
    v_cmp_gt_u32 vcc, s23, v71
    ds_read_b32 v82, v76 offset:4608
    s_nop 0
    v_cndmask_b32 v77, v65, v77, vcc
    v_lshl_add_u32 v77, v77, 2, v4
    ds_read_b32 v83, v77 offset:4608
    v_subrev_u32 v7, 256, v7
    s_sub_u32 s25, s25, 1
    s_waitcnt lgkmcnt(0)
    v_cvt_pk_bf16_f32 v84, v79, v80
    v_cvt_pk_bf16_f32 v85, v78, v79
    v_cvt_pk_bf16_f32 v86, v82, v83
    v_cvt_pk_bf16_f32 v87, v81, v82
    ds_write_b32 v64, v84 offset:7424
    ds_write_b32 v64, v85 offset:11776
    s_cmp_eq_u32 s25, 0
    s_cbranch_scc1 ss_expx
    ds_write_b32 v64, v86 offset:7680
    ds_write_b32 v64, v87 offset:12032
    v_add_u32 v64, 512, v64
    s_nop 1
    s_branch ss_exp
ss_expx:
    s_waitcnt lgkmcnt(0)
    s_barrier
    v_and_b32 v5, 1, v2
    v_mul_u32_u24 v36, 4352, v5
    v_sub_u32 v5, v5, v2
    v_lshl_add_u32 v5, v3, 3, v5
    v_lshl_add_u32 v36, v5, 1, v36
    v_add_u32 v36, 11072, v36
    v_add_u32 v36, v36, v4
    v_subrev_u32 v37, 512, v36
    v_subrev_u32 v38, 1024, v36
    v_subrev_u32 v39, 1536, v36
    v_subrev_u32 v40, 2048, v36
    v_subrev_u32 v41, 2560, v36
    v_subrev_u32 v42, 3072, v36
    v_subrev_u32 v43, 3584, v36
    v_lshlrev_b32 v44, 5, v2
    v_lshl_add_u32 v44, v3, 4, v44
    v_add_u32 v44, 32, v44
    v_add_u32 v44, v44, v4
    ds_read_b128 v[112:115], v44 offset:448
    ds_read2_b32 v[80:81], v36 offset0:112 offset1:113
    ds_read2_b32 v[82:83], v36 offset0:114 offset1:115
    ds_read_b128 v[116:119], v44 offset:960
    ds_read2_b32 v[84:85], v37 offset0:112 offset1:113
    ds_read2_b32 v[86:87], v37 offset0:114 offset1:115
    ds_read_b128 v[120:123], v44 offset:1472
    ds_read2_b32 v[88:89], v38 offset0:112 offset1:113
    ds_read2_b32 v[90:91], v38 offset0:114 offset1:115
    ds_read_b128 v[124:127], v44 offset:1984
    ds_read2_b32 v[92:93], v39 offset0:112 offset1:113
    ds_read2_b32 v[94:95], v39 offset0:114 offset1:115
    ds_read_b128 v[128:131], v44 offset:2496
    ds_read2_b32 v[96:97], v40 offset0:112 offset1:113
    ds_read2_b32 v[98:99], v40 offset0:114 offset1:115
    ds_read_b128 v[132:135], v44 offset:3008
    ds_read2_b32 v[100:101], v41 offset0:112 offset1:113
    ds_read2_b32 v[102:103], v41 offset0:114 offset1:115
    ds_read_b128 v[136:139], v44 offset:3520
    ds_read2_b32 v[104:105], v42 offset0:112 offset1:113
    ds_read2_b32 v[106:107], v42 offset0:114 offset1:115
    ds_read_b128 v[140:143], v44 offset:4032
    ds_read2_b32 v[108:109], v43 offset0:112 offset1:113
    ds_read2_b32 v[110:111], v43 offset0:114 offset1:115
    s_waitcnt lgkmcnt(0)
    v_mfma_f32_16x16x32_bf16 v[48:51], v[80:83], v[112:115], 0
    ds_read_b128 v[176:179], v44 offset:384
    v_mfma_f32_16x16x32_bf16 v[52:55], v[80:83], v[116:119], 0
    ds_read2_b32 v[144:145], v36 offset0:96 offset1:97
    v_mfma_f32_16x16x32_bf16 v[56:59], v[80:83], v[120:123], 0
    ds_read2_b32 v[146:147], v36 offset0:98 offset1:99
    v_mfma_f32_16x16x32_bf16 v[60:63], v[80:83], v[124:127], 0
    ds_read_b128 v[180:183], v44 offset:896
    v_mfma_f32_16x16x32_bf16 v[64:67], v[80:83], v[128:131], 0
    ds_read2_b32 v[148:149], v37 offset0:96 offset1:97
    v_mfma_f32_16x16x32_bf16 v[68:71], v[80:83], v[132:135], 0
    ds_read2_b32 v[150:151], v37 offset0:98 offset1:99
    v_mfma_f32_16x16x32_bf16 v[72:75], v[80:83], v[136:139], 0
    ds_read_b128 v[184:187], v44 offset:1408
    v_mfma_f32_16x16x32_bf16 v[76:79], v[80:83], v[140:143], 0
    ds_read2_b32 v[152:153], v38 offset0:96 offset1:97
    v_mfma_f32_16x16x32_bf16 v[52:55], v[84:87], v[112:115], v[52:55]
    ds_read2_b32 v[154:155], v38 offset0:98 offset1:99
    v_mfma_f32_16x16x32_bf16 v[56:59], v[84:87], v[116:119], v[56:59]
    ds_read_b128 v[188:191], v44 offset:1920
    v_mfma_f32_16x16x32_bf16 v[60:63], v[84:87], v[120:123], v[60:63]
    ds_read2_b32 v[156:157], v39 offset0:96 offset1:97
    v_mfma_f32_16x16x32_bf16 v[64:67], v[84:87], v[124:127], v[64:67]
    ds_read2_b32 v[158:159], v39 offset0:98 offset1:99
    v_mfma_f32_16x16x32_bf16 v[68:71], v[84:87], v[128:131], v[68:71]
    ds_read_b128 v[192:195], v44 offset:2432
    v_mfma_f32_16x16x32_bf16 v[72:75], v[84:87], v[132:135], v[72:75]
    ds_read2_b32 v[160:161], v40 offset0:96 offset1:97
    v_mfma_f32_16x16x32_bf16 v[76:79], v[84:87], v[136:139], v[76:79]
    ds_read2_b32 v[162:163], v40 offset0:98 offset1:99
    v_mfma_f32_16x16x32_bf16 v[56:59], v[88:91], v[112:115], v[56:59]
    ds_read_b128 v[196:199], v44 offset:2944
    v_mfma_f32_16x16x32_bf16 v[60:63], v[88:91], v[116:119], v[60:63]
    ds_read2_b32 v[164:165], v41 offset0:96 offset1:97
    v_mfma_f32_16x16x32_bf16 v[64:67], v[88:91], v[120:123], v[64:67]
    ds_read2_b32 v[166:167], v41 offset0:98 offset1:99
    v_mfma_f32_16x16x32_bf16 v[68:71], v[88:91], v[124:127], v[68:71]
    ds_read_b128 v[200:203], v44 offset:3456
    v_mfma_f32_16x16x32_bf16 v[72:75], v[88:91], v[128:131], v[72:75]
    ds_read2_b32 v[168:169], v42 offset0:96 offset1:97
    v_mfma_f32_16x16x32_bf16 v[76:79], v[88:91], v[132:135], v[76:79]
    ds_read2_b32 v[170:171], v42 offset0:98 offset1:99
    v_mfma_f32_16x16x32_bf16 v[60:63], v[92:95], v[112:115], v[60:63]
    ds_read_b128 v[204:207], v44 offset:3968
    v_mfma_f32_16x16x32_bf16 v[64:67], v[92:95], v[116:119], v[64:67]
    ds_read2_b32 v[172:173], v43 offset0:96 offset1:97
    v_mfma_f32_16x16x32_bf16 v[68:71], v[92:95], v[120:123], v[68:71]
    ds_read2_b32 v[174:175], v43 offset0:98 offset1:99
    v_mfma_f32_16x16x32_bf16 v[72:75], v[92:95], v[124:127], v[72:75]
    v_mfma_f32_16x16x32_bf16 v[76:79], v[92:95], v[128:131], v[76:79]
    v_mfma_f32_16x16x32_bf16 v[64:67], v[96:99], v[112:115], v[64:67]
    v_mfma_f32_16x16x32_bf16 v[68:71], v[96:99], v[116:119], v[68:71]
    v_mfma_f32_16x16x32_bf16 v[72:75], v[96:99], v[120:123], v[72:75]
    v_mfma_f32_16x16x32_bf16 v[76:79], v[96:99], v[124:127], v[76:79]
    v_mfma_f32_16x16x32_bf16 v[68:71], v[100:103], v[112:115], v[68:71]
    v_mfma_f32_16x16x32_bf16 v[72:75], v[100:103], v[116:119], v[72:75]
    v_mfma_f32_16x16x32_bf16 v[76:79], v[100:103], v[120:123], v[76:79]
    v_mfma_f32_16x16x32_bf16 v[72:75], v[104:107], v[112:115], v[72:75]
    v_mfma_f32_16x16x32_bf16 v[76:79], v[104:107], v[116:119], v[76:79]
    v_mfma_f32_16x16x32_bf16 v[76:79], v[108:111], v[112:115], v[76:79]
    s_waitcnt lgkmcnt(0)
    v_mfma_f32_16x16x32_bf16 v[48:51], v[144:147], v[176:179], v[48:51]
    ds_read_b128 v[112:115], v44 offset:320
    v_mfma_f32_16x16x32_bf16 v[52:55], v[144:147], v[180:183], v[52:55]
    ds_read2_b32 v[80:81], v36 offset0:80 offset1:81
    v_mfma_f32_16x16x32_bf16 v[56:59], v[144:147], v[184:187], v[56:59]
    ds_read2_b32 v[82:83], v36 offset0:82 offset1:83
    v_mfma_f32_16x16x32_bf16 v[60:63], v[144:147], v[188:191], v[60:63]
    ds_read_b128 v[116:119], v44 offset:832
    v_mfma_f32_16x16x32_bf16 v[64:67], v[144:147], v[192:195], v[64:67]
    ds_read2_b32 v[84:85], v37 offset0:80 offset1:81
    v_mfma_f32_16x16x32_bf16 v[68:71], v[144:147], v[196:199], v[68:71]
    ds_read2_b32 v[86:87], v37 offset0:82 offset1:83
    v_mfma_f32_16x16x32_bf16 v[72:75], v[144:147], v[200:203], v[72:75]
    ds_read_b128 v[120:123], v44 offset:1344
    v_mfma_f32_16x16x32_bf16 v[76:79], v[144:147], v[204:207], v[76:79]
    ds_read2_b32 v[88:89], v38 offset0:80 offset1:81
    v_mfma_f32_16x16x32_bf16 v[52:55], v[148:151], v[176:179], v[52:55]
    ds_read2_b32 v[90:91], v38 offset0:82 offset1:83
    v_mfma_f32_16x16x32_bf16 v[56:59], v[148:151], v[180:183], v[56:59]
    ds_read_b128 v[124:127], v44 offset:1856
    v_mfma_f32_16x16x32_bf16 v[60:63], v[148:151], v[184:187], v[60:63]
    ds_read2_b32 v[92:93], v39 offset0:80 offset1:81
    v_mfma_f32_16x16x32_bf16 v[64:67], v[148:151], v[188:191], v[64:67]
    ds_read2_b32 v[94:95], v39 offset0:82 offset1:83
    v_mfma_f32_16x16x32_bf16 v[68:71], v[148:151], v[192:195], v[68:71]
    ds_read_b128 v[128:131], v44 offset:2368
    v_mfma_f32_16x16x32_bf16 v[72:75], v[148:151], v[196:199], v[72:75]
    ds_read2_b32 v[96:97], v40 offset0:80 offset1:81
    v_mfma_f32_16x16x32_bf16 v[76:79], v[148:151], v[200:203], v[76:79]
    ds_read2_b32 v[98:99], v40 offset0:82 offset1:83
    v_mfma_f32_16x16x32_bf16 v[56:59], v[152:155], v[176:179], v[56:59]
    ds_read_b128 v[132:135], v44 offset:2880
    v_mfma_f32_16x16x32_bf16 v[60:63], v[152:155], v[180:183], v[60:63]
    ds_read2_b32 v[100:101], v41 offset0:80 offset1:81
    v_mfma_f32_16x16x32_bf16 v[64:67], v[152:155], v[184:187], v[64:67]
    ds_read2_b32 v[102:103], v41 offset0:82 offset1:83
    v_mfma_f32_16x16x32_bf16 v[68:71], v[152:155], v[188:191], v[68:71]
    ds_read_b128 v[136:139], v44 offset:3392
    v_mfma_f32_16x16x32_bf16 v[72:75], v[152:155], v[192:195], v[72:75]
    ds_read2_b32 v[104:105], v42 offset0:80 offset1:81
    v_mfma_f32_16x16x32_bf16 v[76:79], v[152:155], v[196:199], v[76:79]
    ds_read2_b32 v[106:107], v42 offset0:82 offset1:83
    v_mfma_f32_16x16x32_bf16 v[60:63], v[156:159], v[176:179], v[60:63]
    ds_read_b128 v[140:143], v44 offset:3904
    v_mfma_f32_16x16x32_bf16 v[64:67], v[156:159], v[180:183], v[64:67]
    ds_read2_b32 v[108:109], v43 offset0:80 offset1:81
    v_mfma_f32_16x16x32_bf16 v[68:71], v[156:159], v[184:187], v[68:71]
    ds_read2_b32 v[110:111], v43 offset0:82 offset1:83
    v_mfma_f32_16x16x32_bf16 v[72:75], v[156:159], v[188:191], v[72:75]
    v_mfma_f32_16x16x32_bf16 v[76:79], v[156:159], v[192:195], v[76:79]
    v_mfma_f32_16x16x32_bf16 v[64:67], v[160:163], v[176:179], v[64:67]
    v_mfma_f32_16x16x32_bf16 v[68:71], v[160:163], v[180:183], v[68:71]
    v_mfma_f32_16x16x32_bf16 v[72:75], v[160:163], v[184:187], v[72:75]
    v_mfma_f32_16x16x32_bf16 v[76:79], v[160:163], v[188:191], v[76:79]
    v_mfma_f32_16x16x32_bf16 v[68:71], v[164:167], v[176:179], v[68:71]
    v_mfma_f32_16x16x32_bf16 v[72:75], v[164:167], v[180:183], v[72:75]
    v_mfma_f32_16x16x32_bf16 v[76:79], v[164:167], v[184:187], v[76:79]
    v_mfma_f32_16x16x32_bf16 v[72:75], v[168:171], v[176:179], v[72:75]
    v_mfma_f32_16x16x32_bf16 v[76:79], v[168:171], v[180:183], v[76:79]
    v_mfma_f32_16x16x32_bf16 v[76:79], v[172:175], v[176:179], v[76:79]
    s_waitcnt lgkmcnt(0)
    v_mfma_f32_16x16x32_bf16 v[48:51], v[80:83], v[112:115], v[48:51]
    ds_read_b128 v[176:179], v44 offset:256
    v_mfma_f32_16x16x32_bf16 v[52:55], v[80:83], v[116:119], v[52:55]
    ds_read2_b32 v[144:145], v36 offset0:64 offset1:65
    v_mfma_f32_16x16x32_bf16 v[56:59], v[80:83], v[120:123], v[56:59]
    ds_read2_b32 v[146:147], v36 offset0:66 offset1:67
    v_mfma_f32_16x16x32_bf16 v[60:63], v[80:83], v[124:127], v[60:63]
    ds_read_b128 v[180:183], v44 offset:768
    v_mfma_f32_16x16x32_bf16 v[64:67], v[80:83], v[128:131], v[64:67]
    ds_read2_b32 v[148:149], v37 offset0:64 offset1:65
    v_mfma_f32_16x16x32_bf16 v[68:71], v[80:83], v[132:135], v[68:71]
    ds_read2_b32 v[150:151], v37 offset0:66 offset1:67
    v_mfma_f32_16x16x32_bf16 v[72:75], v[80:83], v[136:139], v[72:75]
    ds_read_b128 v[184:187], v44 offset:1280
    v_mfma_f32_16x16x32_bf16 v[76:79], v[80:83], v[140:143], v[76:79]
    ds_read2_b32 v[152:153], v38 offset0:64 offset1:65
    v_mfma_f32_16x16x32_bf16 v[52:55], v[84:87], v[112:115], v[52:55]
    ds_read2_b32 v[154:155], v38 offset0:66 offset1:67
    v_mfma_f32_16x16x32_bf16 v[56:59], v[84:87], v[116:119], v[56:59]
    ds_read_b128 v[188:191], v44 offset:1792
    v_mfma_f32_16x16x32_bf16 v[60:63], v[84:87], v[120:123], v[60:63]
    ds_read2_b32 v[156:157], v39 offset0:64 offset1:65
    v_mfma_f32_16x16x32_bf16 v[64:67], v[84:87], v[124:127], v[64:67]
    ds_read2_b32 v[158:159], v39 offset0:66 offset1:67
    v_mfma_f32_16x16x32_bf16 v[68:71], v[84:87], v[128:131], v[68:71]
    ds_read_b128 v[192:195], v44 offset:2304
    v_mfma_f32_16x16x32_bf16 v[72:75], v[84:87], v[132:135], v[72:75]
    ds_read2_b32 v[160:161], v40 offset0:64 offset1:65
    v_mfma_f32_16x16x32_bf16 v[76:79], v[84:87], v[136:139], v[76:79]
    ds_read2_b32 v[162:163], v40 offset0:66 offset1:67
    v_mfma_f32_16x16x32_bf16 v[56:59], v[88:91], v[112:115], v[56:59]
    ds_read_b128 v[196:199], v44 offset:2816
    v_mfma_f32_16x16x32_bf16 v[60:63], v[88:91], v[116:119], v[60:63]
    ds_read2_b32 v[164:165], v41 offset0:64 offset1:65
    v_mfma_f32_16x16x32_bf16 v[64:67], v[88:91], v[120:123], v[64:67]
    ds_read2_b32 v[166:167], v41 offset0:66 offset1:67
    v_mfma_f32_16x16x32_bf16 v[68:71], v[88:91], v[124:127], v[68:71]
    ds_read_b128 v[200:203], v44 offset:3328
    v_mfma_f32_16x16x32_bf16 v[72:75], v[88:91], v[128:131], v[72:75]
    ds_read2_b32 v[168:169], v42 offset0:64 offset1:65
    v_mfma_f32_16x16x32_bf16 v[76:79], v[88:91], v[132:135], v[76:79]
    ds_read2_b32 v[170:171], v42 offset0:66 offset1:67
    v_mfma_f32_16x16x32_bf16 v[60:63], v[92:95], v[112:115], v[60:63]
    ds_read_b128 v[204:207], v44 offset:3840
    v_mfma_f32_16x16x32_bf16 v[64:67], v[92:95], v[116:119], v[64:67]
    ds_read2_b32 v[172:173], v43 offset0:64 offset1:65
    v_mfma_f32_16x16x32_bf16 v[68:71], v[92:95], v[120:123], v[68:71]
    ds_read2_b32 v[174:175], v43 offset0:66 offset1:67
    v_mfma_f32_16x16x32_bf16 v[72:75], v[92:95], v[124:127], v[72:75]
    v_mfma_f32_16x16x32_bf16 v[76:79], v[92:95], v[128:131], v[76:79]
    v_mfma_f32_16x16x32_bf16 v[64:67], v[96:99], v[112:115], v[64:67]
    v_mfma_f32_16x16x32_bf16 v[68:71], v[96:99], v[116:119], v[68:71]
    v_mfma_f32_16x16x32_bf16 v[72:75], v[96:99], v[120:123], v[72:75]
    v_mfma_f32_16x16x32_bf16 v[76:79], v[96:99], v[124:127], v[76:79]
    v_mfma_f32_16x16x32_bf16 v[68:71], v[100:103], v[112:115], v[68:71]
    v_mfma_f32_16x16x32_bf16 v[72:75], v[100:103], v[116:119], v[72:75]
    v_mfma_f32_16x16x32_bf16 v[76:79], v[100:103], v[120:123], v[76:79]
    v_mfma_f32_16x16x32_bf16 v[72:75], v[104:107], v[112:115], v[72:75]
    v_mfma_f32_16x16x32_bf16 v[76:79], v[104:107], v[116:119], v[76:79]
    v_mfma_f32_16x16x32_bf16 v[76:79], v[108:111], v[112:115], v[76:79]
    s_waitcnt lgkmcnt(0)
    v_mfma_f32_16x16x32_bf16 v[48:51], v[144:147], v[176:179], v[48:51]
    ds_read_b128 v[112:115], v44 offset:192
    v_mfma_f32_16x16x32_bf16 v[52:55], v[144:147], v[180:183], v[52:55]
    ds_read2_b32 v[80:81], v36 offset0:48 offset1:49
    v_mfma_f32_16x16x32_bf16 v[56:59], v[144:147], v[184:187], v[56:59]
    ds_read2_b32 v[82:83], v36 offset0:50 offset1:51
    v_mfma_f32_16x16x32_bf16 v[60:63], v[144:147], v[188:191], v[60:63]
    ds_read_b128 v[116:119], v44 offset:704
    v_mfma_f32_16x16x32_bf16 v[64:67], v[144:147], v[192:195], v[64:67]
    ds_read2_b32 v[84:85], v37 offset0:48 offset1:49
    v_mfma_f32_16x16x32_bf16 v[68:71], v[144:147], v[196:199], v[68:71]
    ds_read2_b32 v[86:87], v37 offset0:50 offset1:51
    v_mfma_f32_16x16x32_bf16 v[72:75], v[144:147], v[200:203], v[72:75]
    ds_read_b128 v[120:123], v44 offset:1216
    v_mfma_f32_16x16x32_bf16 v[76:79], v[144:147], v[204:207], v[76:79]
    ds_read2_b32 v[88:89], v38 offset0:48 offset1:49
    v_mfma_f32_16x16x32_bf16 v[52:55], v[148:151], v[176:179], v[52:55]
    ds_read2_b32 v[90:91], v38 offset0:50 offset1:51
    v_mfma_f32_16x16x32_bf16 v[56:59], v[148:151], v[180:183], v[56:59]
    ds_read_b128 v[124:127], v44 offset:1728
    v_mfma_f32_16x16x32_bf16 v[60:63], v[148:151], v[184:187], v[60:63]
    ds_read2_b32 v[92:93], v39 offset0:48 offset1:49
    v_mfma_f32_16x16x32_bf16 v[64:67], v[148:151], v[188:191], v[64:67]
    ds_read2_b32 v[94:95], v39 offset0:50 offset1:51
    v_mfma_f32_16x16x32_bf16 v[68:71], v[148:151], v[192:195], v[68:71]
    ds_read_b128 v[128:131], v44 offset:2240
    v_mfma_f32_16x16x32_bf16 v[72:75], v[148:151], v[196:199], v[72:75]
    ds_read2_b32 v[96:97], v40 offset0:48 offset1:49
    v_mfma_f32_16x16x32_bf16 v[76:79], v[148:151], v[200:203], v[76:79]
    ds_read2_b32 v[98:99], v40 offset0:50 offset1:51
    v_mfma_f32_16x16x32_bf16 v[56:59], v[152:155], v[176:179], v[56:59]
    ds_read_b128 v[132:135], v44 offset:2752
    v_mfma_f32_16x16x32_bf16 v[60:63], v[152:155], v[180:183], v[60:63]
    ds_read2_b32 v[100:101], v41 offset0:48 offset1:49
    v_mfma_f32_16x16x32_bf16 v[64:67], v[152:155], v[184:187], v[64:67]
    ds_read2_b32 v[102:103], v41 offset0:50 offset1:51
    v_mfma_f32_16x16x32_bf16 v[68:71], v[152:155], v[188:191], v[68:71]
    ds_read_b128 v[136:139], v44 offset:3264
    v_mfma_f32_16x16x32_bf16 v[72:75], v[152:155], v[192:195], v[72:75]
    ds_read2_b32 v[104:105], v42 offset0:48 offset1:49
    v_mfma_f32_16x16x32_bf16 v[76:79], v[152:155], v[196:199], v[76:79]
    ds_read2_b32 v[106:107], v42 offset0:50 offset1:51
    v_mfma_f32_16x16x32_bf16 v[60:63], v[156:159], v[176:179], v[60:63]
    ds_read_b128 v[140:143], v44 offset:3776
    v_mfma_f32_16x16x32_bf16 v[64:67], v[156:159], v[180:183], v[64:67]
    ds_read2_b32 v[108:109], v43 offset0:48 offset1:49
    v_mfma_f32_16x16x32_bf16 v[68:71], v[156:159], v[184:187], v[68:71]
    ds_read2_b32 v[110:111], v43 offset0:50 offset1:51
    v_mfma_f32_16x16x32_bf16 v[72:75], v[156:159], v[188:191], v[72:75]
    v_mfma_f32_16x16x32_bf16 v[76:79], v[156:159], v[192:195], v[76:79]
    v_mfma_f32_16x16x32_bf16 v[64:67], v[160:163], v[176:179], v[64:67]
    v_mfma_f32_16x16x32_bf16 v[68:71], v[160:163], v[180:183], v[68:71]
    v_mfma_f32_16x16x32_bf16 v[72:75], v[160:163], v[184:187], v[72:75]
    v_mfma_f32_16x16x32_bf16 v[76:79], v[160:163], v[188:191], v[76:79]
    v_mfma_f32_16x16x32_bf16 v[68:71], v[164:167], v[176:179], v[68:71]
    v_mfma_f32_16x16x32_bf16 v[72:75], v[164:167], v[180:183], v[72:75]
    v_mfma_f32_16x16x32_bf16 v[76:79], v[164:167], v[184:187], v[76:79]
    v_mfma_f32_16x16x32_bf16 v[72:75], v[168:171], v[176:179], v[72:75]
    v_mfma_f32_16x16x32_bf16 v[76:79], v[168:171], v[180:183], v[76:79]
    v_mfma_f32_16x16x32_bf16 v[76:79], v[172:175], v[176:179], v[76:79]
    s_waitcnt lgkmcnt(0)
    v_mfma_f32_16x16x32_bf16 v[48:51], v[80:83], v[112:115], v[48:51]
    ds_read_b128 v[176:179], v44 offset:128
    v_mfma_f32_16x16x32_bf16 v[52:55], v[80:83], v[116:119], v[52:55]
    ds_read2_b32 v[144:145], v36 offset0:32 offset1:33
    v_mfma_f32_16x16x32_bf16 v[56:59], v[80:83], v[120:123], v[56:59]
    ds_read2_b32 v[146:147], v36 offset0:34 offset1:35
    v_mfma_f32_16x16x32_bf16 v[60:63], v[80:83], v[124:127], v[60:63]
    ds_read_b128 v[180:183], v44 offset:640
    v_mfma_f32_16x16x32_bf16 v[64:67], v[80:83], v[128:131], v[64:67]
    ds_read2_b32 v[148:149], v37 offset0:32 offset1:33
    v_mfma_f32_16x16x32_bf16 v[68:71], v[80:83], v[132:135], v[68:71]
    ds_read2_b32 v[150:151], v37 offset0:34 offset1:35
    v_mfma_f32_16x16x32_bf16 v[72:75], v[80:83], v[136:139], v[72:75]
    ds_read_b128 v[184:187], v44 offset:1152
    v_mfma_f32_16x16x32_bf16 v[76:79], v[80:83], v[140:143], v[76:79]
    ds_read2_b32 v[152:153], v38 offset0:32 offset1:33
    v_mfma_f32_16x16x32_bf16 v[52:55], v[84:87], v[112:115], v[52:55]
    ds_read2_b32 v[154:155], v38 offset0:34 offset1:35
    v_mfma_f32_16x16x32_bf16 v[56:59], v[84:87], v[116:119], v[56:59]
    ds_read_b128 v[188:191], v44 offset:1664
    v_mfma_f32_16x16x32_bf16 v[60:63], v[84:87], v[120:123], v[60:63]
    ds_read2_b32 v[156:157], v39 offset0:32 offset1:33
    v_mfma_f32_16x16x32_bf16 v[64:67], v[84:87], v[124:127], v[64:67]
    ds_read2_b32 v[158:159], v39 offset0:34 offset1:35
    v_mfma_f32_16x16x32_bf16 v[68:71], v[84:87], v[128:131], v[68:71]
    ds_read_b128 v[192:195], v44 offset:2176
    v_mfma_f32_16x16x32_bf16 v[72:75], v[84:87], v[132:135], v[72:75]
    ds_read2_b32 v[160:161], v40 offset0:32 offset1:33
    v_mfma_f32_16x16x32_bf16 v[76:79], v[84:87], v[136:139], v[76:79]
    ds_read2_b32 v[162:163], v40 offset0:34 offset1:35
    v_mfma_f32_16x16x32_bf16 v[56:59], v[88:91], v[112:115], v[56:59]
    ds_read_b128 v[196:199], v44 offset:2688
    v_mfma_f32_16x16x32_bf16 v[60:63], v[88:91], v[116:119], v[60:63]
    ds_read2_b32 v[164:165], v41 offset0:32 offset1:33
    v_mfma_f32_16x16x32_bf16 v[64:67], v[88:91], v[120:123], v[64:67]
    ds_read2_b32 v[166:167], v41 offset0:34 offset1:35
    v_mfma_f32_16x16x32_bf16 v[68:71], v[88:91], v[124:127], v[68:71]
    ds_read_b128 v[200:203], v44 offset:3200
    v_mfma_f32_16x16x32_bf16 v[72:75], v[88:91], v[128:131], v[72:75]
    ds_read2_b32 v[168:169], v42 offset0:32 offset1:33
    v_mfma_f32_16x16x32_bf16 v[76:79], v[88:91], v[132:135], v[76:79]
    ds_read2_b32 v[170:171], v42 offset0:34 offset1:35
    v_mfma_f32_16x16x32_bf16 v[60:63], v[92:95], v[112:115], v[60:63]
    ds_read_b128 v[204:207], v44 offset:3712
    v_mfma_f32_16x16x32_bf16 v[64:67], v[92:95], v[116:119], v[64:67]
    ds_read2_b32 v[172:173], v43 offset0:32 offset1:33
    v_mfma_f32_16x16x32_bf16 v[68:71], v[92:95], v[120:123], v[68:71]
    ds_read2_b32 v[174:175], v43 offset0:34 offset1:35
    v_mfma_f32_16x16x32_bf16 v[72:75], v[92:95], v[124:127], v[72:75]
    v_mfma_f32_16x16x32_bf16 v[76:79], v[92:95], v[128:131], v[76:79]
    v_mfma_f32_16x16x32_bf16 v[64:67], v[96:99], v[112:115], v[64:67]
    v_mfma_f32_16x16x32_bf16 v[68:71], v[96:99], v[116:119], v[68:71]
    v_mfma_f32_16x16x32_bf16 v[72:75], v[96:99], v[120:123], v[72:75]
    v_mfma_f32_16x16x32_bf16 v[76:79], v[96:99], v[124:127], v[76:79]
    v_mfma_f32_16x16x32_bf16 v[68:71], v[100:103], v[112:115], v[68:71]
    v_mfma_f32_16x16x32_bf16 v[72:75], v[100:103], v[116:119], v[72:75]
    v_mfma_f32_16x16x32_bf16 v[76:79], v[100:103], v[120:123], v[76:79]
    v_mfma_f32_16x16x32_bf16 v[72:75], v[104:107], v[112:115], v[72:75]
    v_mfma_f32_16x16x32_bf16 v[76:79], v[104:107], v[116:119], v[76:79]
    v_mfma_f32_16x16x32_bf16 v[76:79], v[108:111], v[112:115], v[76:79]
    s_waitcnt lgkmcnt(0)
    v_mfma_f32_16x16x32_bf16 v[48:51], v[144:147], v[176:179], v[48:51]
    ds_read_b128 v[112:115], v44 offset:64
    v_mfma_f32_16x16x32_bf16 v[52:55], v[144:147], v[180:183], v[52:55]
    ds_read2_b32 v[80:81], v36 offset0:16 offset1:17
    v_mfma_f32_16x16x32_bf16 v[56:59], v[144:147], v[184:187], v[56:59]
    ds_read2_b32 v[82:83], v36 offset0:18 offset1:19
    v_mfma_f32_16x16x32_bf16 v[60:63], v[144:147], v[188:191], v[60:63]
    ds_read_b128 v[116:119], v44 offset:576
    v_mfma_f32_16x16x32_bf16 v[64:67], v[144:147], v[192:195], v[64:67]
    ds_read2_b32 v[84:85], v37 offset0:16 offset1:17
    v_mfma_f32_16x16x32_bf16 v[68:71], v[144:147], v[196:199], v[68:71]
    ds_read2_b32 v[86:87], v37 offset0:18 offset1:19
    v_mfma_f32_16x16x32_bf16 v[72:75], v[144:147], v[200:203], v[72:75]
    ds_read_b128 v[120:123], v44 offset:1088
    v_mfma_f32_16x16x32_bf16 v[76:79], v[144:147], v[204:207], v[76:79]
    ds_read2_b32 v[88:89], v38 offset0:16 offset1:17
    v_mfma_f32_16x16x32_bf16 v[52:55], v[148:151], v[176:179], v[52:55]
    ds_read2_b32 v[90:91], v38 offset0:18 offset1:19
    v_mfma_f32_16x16x32_bf16 v[56:59], v[148:151], v[180:183], v[56:59]
    ds_read_b128 v[124:127], v44 offset:1600
    v_mfma_f32_16x16x32_bf16 v[60:63], v[148:151], v[184:187], v[60:63]
    ds_read2_b32 v[92:93], v39 offset0:16 offset1:17
    v_mfma_f32_16x16x32_bf16 v[64:67], v[148:151], v[188:191], v[64:67]
    ds_read2_b32 v[94:95], v39 offset0:18 offset1:19
    v_mfma_f32_16x16x32_bf16 v[68:71], v[148:151], v[192:195], v[68:71]
    ds_read_b128 v[128:131], v44 offset:2112
    v_mfma_f32_16x16x32_bf16 v[72:75], v[148:151], v[196:199], v[72:75]
    ds_read2_b32 v[96:97], v40 offset0:16 offset1:17
    v_mfma_f32_16x16x32_bf16 v[76:79], v[148:151], v[200:203], v[76:79]
    ds_read2_b32 v[98:99], v40 offset0:18 offset1:19
    v_mfma_f32_16x16x32_bf16 v[56:59], v[152:155], v[176:179], v[56:59]
    ds_read_b128 v[132:135], v44 offset:2624
    v_mfma_f32_16x16x32_bf16 v[60:63], v[152:155], v[180:183], v[60:63]
    ds_read2_b32 v[100:101], v41 offset0:16 offset1:17
    v_mfma_f32_16x16x32_bf16 v[64:67], v[152:155], v[184:187], v[64:67]
    ds_read2_b32 v[102:103], v41 offset0:18 offset1:19
    v_mfma_f32_16x16x32_bf16 v[68:71], v[152:155], v[188:191], v[68:71]
    ds_read_b128 v[136:139], v44 offset:3136
    v_mfma_f32_16x16x32_bf16 v[72:75], v[152:155], v[192:195], v[72:75]
    ds_read2_b32 v[104:105], v42 offset0:16 offset1:17
    v_mfma_f32_16x16x32_bf16 v[76:79], v[152:155], v[196:199], v[76:79]
    ds_read2_b32 v[106:107], v42 offset0:18 offset1:19
    v_mfma_f32_16x16x32_bf16 v[60:63], v[156:159], v[176:179], v[60:63]
    ds_read_b128 v[140:143], v44 offset:3648
    v_mfma_f32_16x16x32_bf16 v[64:67], v[156:159], v[180:183], v[64:67]
    ds_read2_b32 v[108:109], v43 offset0:16 offset1:17
    v_mfma_f32_16x16x32_bf16 v[68:71], v[156:159], v[184:187], v[68:71]
    ds_read2_b32 v[110:111], v43 offset0:18 offset1:19
    v_mfma_f32_16x16x32_bf16 v[72:75], v[156:159], v[188:191], v[72:75]
    v_mfma_f32_16x16x32_bf16 v[76:79], v[156:159], v[192:195], v[76:79]
    v_mfma_f32_16x16x32_bf16 v[64:67], v[160:163], v[176:179], v[64:67]
    v_mfma_f32_16x16x32_bf16 v[68:71], v[160:163], v[180:183], v[68:71]
    v_mfma_f32_16x16x32_bf16 v[72:75], v[160:163], v[184:187], v[72:75]
    v_mfma_f32_16x16x32_bf16 v[76:79], v[160:163], v[188:191], v[76:79]
    v_mfma_f32_16x16x32_bf16 v[68:71], v[164:167], v[176:179], v[68:71]
    v_mfma_f32_16x16x32_bf16 v[72:75], v[164:167], v[180:183], v[72:75]
    v_mfma_f32_16x16x32_bf16 v[76:79], v[164:167], v[184:187], v[76:79]
    v_mfma_f32_16x16x32_bf16 v[72:75], v[168:171], v[176:179], v[72:75]
    v_mfma_f32_16x16x32_bf16 v[76:79], v[168:171], v[180:183], v[76:79]
    v_mfma_f32_16x16x32_bf16 v[76:79], v[172:175], v[176:179], v[76:79]
    s_waitcnt lgkmcnt(0)
    v_mfma_f32_16x16x32_bf16 v[48:51], v[80:83], v[112:115], v[48:51]
    ds_read_b128 v[176:179], v44 offset:0
    v_mfma_f32_16x16x32_bf16 v[52:55], v[80:83], v[116:119], v[52:55]
    ds_read2_b32 v[144:145], v36 offset0:0 offset1:1
    v_mfma_f32_16x16x32_bf16 v[56:59], v[80:83], v[120:123], v[56:59]
    ds_read2_b32 v[146:147], v36 offset0:2 offset1:3
    v_mfma_f32_16x16x32_bf16 v[60:63], v[80:83], v[124:127], v[60:63]
    ds_read_b128 v[180:183], v44 offset:512
    v_mfma_f32_16x16x32_bf16 v[64:67], v[80:83], v[128:131], v[64:67]
    ds_read2_b32 v[148:149], v37 offset0:0 offset1:1
    v_mfma_f32_16x16x32_bf16 v[68:71], v[80:83], v[132:135], v[68:71]
    ds_read2_b32 v[150:151], v37 offset0:2 offset1:3
    v_mfma_f32_16x16x32_bf16 v[72:75], v[80:83], v[136:139], v[72:75]
    ds_read_b128 v[184:187], v44 offset:1024
    v_mfma_f32_16x16x32_bf16 v[76:79], v[80:83], v[140:143], v[76:79]
    ds_read2_b32 v[152:153], v38 offset0:0 offset1:1
    v_mfma_f32_16x16x32_bf16 v[52:55], v[84:87], v[112:115], v[52:55]
    ds_read2_b32 v[154:155], v38 offset0:2 offset1:3
    v_mfma_f32_16x16x32_bf16 v[56:59], v[84:87], v[116:119], v[56:59]
    ds_read_b128 v[188:191], v44 offset:1536
    v_mfma_f32_16x16x32_bf16 v[60:63], v[84:87], v[120:123], v[60:63]
    ds_read2_b32 v[156:157], v39 offset0:0 offset1:1
    v_mfma_f32_16x16x32_bf16 v[64:67], v[84:87], v[124:127], v[64:67]
    ds_read2_b32 v[158:159], v39 offset0:2 offset1:3
    v_mfma_f32_16x16x32_bf16 v[68:71], v[84:87], v[128:131], v[68:71]
    ds_read_b128 v[192:195], v44 offset:2048
    v_mfma_f32_16x16x32_bf16 v[72:75], v[84:87], v[132:135], v[72:75]
    ds_read2_b32 v[160:161], v40 offset0:0 offset1:1
    v_mfma_f32_16x16x32_bf16 v[76:79], v[84:87], v[136:139], v[76:79]
    ds_read2_b32 v[162:163], v40 offset0:2 offset1:3
    v_mfma_f32_16x16x32_bf16 v[56:59], v[88:91], v[112:115], v[56:59]
    ds_read_b128 v[196:199], v44 offset:2560
    v_mfma_f32_16x16x32_bf16 v[60:63], v[88:91], v[116:119], v[60:63]
    ds_read2_b32 v[164:165], v41 offset0:0 offset1:1
    v_mfma_f32_16x16x32_bf16 v[64:67], v[88:91], v[120:123], v[64:67]
    ds_read2_b32 v[166:167], v41 offset0:2 offset1:3
    v_mfma_f32_16x16x32_bf16 v[68:71], v[88:91], v[124:127], v[68:71]
    ds_read_b128 v[200:203], v44 offset:3072
    v_mfma_f32_16x16x32_bf16 v[72:75], v[88:91], v[128:131], v[72:75]
    ds_read2_b32 v[168:169], v42 offset0:0 offset1:1
    v_mfma_f32_16x16x32_bf16 v[76:79], v[88:91], v[132:135], v[76:79]
    ds_read2_b32 v[170:171], v42 offset0:2 offset1:3
    v_mfma_f32_16x16x32_bf16 v[60:63], v[92:95], v[112:115], v[60:63]
    ds_read_b128 v[204:207], v44 offset:3584
    v_mfma_f32_16x16x32_bf16 v[64:67], v[92:95], v[116:119], v[64:67]
    ds_read2_b32 v[172:173], v43 offset0:0 offset1:1
    v_mfma_f32_16x16x32_bf16 v[68:71], v[92:95], v[120:123], v[68:71]
    ds_read2_b32 v[174:175], v43 offset0:2 offset1:3
    v_mfma_f32_16x16x32_bf16 v[72:75], v[92:95], v[124:127], v[72:75]
    v_mfma_f32_16x16x32_bf16 v[76:79], v[92:95], v[128:131], v[76:79]
    v_mfma_f32_16x16x32_bf16 v[64:67], v[96:99], v[112:115], v[64:67]
    v_mfma_f32_16x16x32_bf16 v[68:71], v[96:99], v[116:119], v[68:71]
    v_mfma_f32_16x16x32_bf16 v[72:75], v[96:99], v[120:123], v[72:75]
    v_mfma_f32_16x16x32_bf16 v[76:79], v[96:99], v[124:127], v[76:79]
    v_mfma_f32_16x16x32_bf16 v[68:71], v[100:103], v[112:115], v[68:71]
    v_mfma_f32_16x16x32_bf16 v[72:75], v[100:103], v[116:119], v[72:75]
    v_mfma_f32_16x16x32_bf16 v[76:79], v[100:103], v[120:123], v[76:79]
    v_mfma_f32_16x16x32_bf16 v[72:75], v[104:107], v[112:115], v[72:75]
    v_mfma_f32_16x16x32_bf16 v[76:79], v[104:107], v[116:119], v[76:79]
    v_mfma_f32_16x16x32_bf16 v[76:79], v[108:111], v[112:115], v[76:79]
    s_waitcnt lgkmcnt(0)
    v_mfma_f32_16x16x32_bf16 v[48:51], v[144:147], v[176:179], v[48:51]
    v_mfma_f32_16x16x32_bf16 v[52:55], v[144:147], v[180:183], v[52:55]
    v_mfma_f32_16x16x32_bf16 v[56:59], v[144:147], v[184:187], v[56:59]
    v_mfma_f32_16x16x32_bf16 v[60:63], v[144:147], v[188:191], v[60:63]
    v_mfma_f32_16x16x32_bf16 v[64:67], v[144:147], v[192:195], v[64:67]
    v_mfma_f32_16x16x32_bf16 v[68:71], v[144:147], v[196:199], v[68:71]
    v_mfma_f32_16x16x32_bf16 v[72:75], v[144:147], v[200:203], v[72:75]
    v_mfma_f32_16x16x32_bf16 v[76:79], v[144:147], v[204:207], v[76:79]
    v_mfma_f32_16x16x32_bf16 v[52:55], v[148:151], v[176:179], v[52:55]
    v_mfma_f32_16x16x32_bf16 v[56:59], v[148:151], v[180:183], v[56:59]
    v_mfma_f32_16x16x32_bf16 v[60:63], v[148:151], v[184:187], v[60:63]
    v_mfma_f32_16x16x32_bf16 v[64:67], v[148:151], v[188:191], v[64:67]
    v_mfma_f32_16x16x32_bf16 v[68:71], v[148:151], v[192:195], v[68:71]
    v_mfma_f32_16x16x32_bf16 v[72:75], v[148:151], v[196:199], v[72:75]
    v_mfma_f32_16x16x32_bf16 v[76:79], v[148:151], v[200:203], v[76:79]
    v_mfma_f32_16x16x32_bf16 v[56:59], v[152:155], v[176:179], v[56:59]
    v_mfma_f32_16x16x32_bf16 v[60:63], v[152:155], v[180:183], v[60:63]
    v_mfma_f32_16x16x32_bf16 v[64:67], v[152:155], v[184:187], v[64:67]
    v_mfma_f32_16x16x32_bf16 v[68:71], v[152:155], v[188:191], v[68:71]
    v_mfma_f32_16x16x32_bf16 v[72:75], v[152:155], v[192:195], v[72:75]
    v_mfma_f32_16x16x32_bf16 v[76:79], v[152:155], v[196:199], v[76:79]
    v_mfma_f32_16x16x32_bf16 v[60:63], v[156:159], v[176:179], v[60:63]
    v_mfma_f32_16x16x32_bf16 v[64:67], v[156:159], v[180:183], v[64:67]
    v_mfma_f32_16x16x32_bf16 v[68:71], v[156:159], v[184:187], v[68:71]
    v_mfma_f32_16x16x32_bf16 v[72:75], v[156:159], v[188:191], v[72:75]
    v_mfma_f32_16x16x32_bf16 v[76:79], v[156:159], v[192:195], v[76:79]
    v_mfma_f32_16x16x32_bf16 v[64:67], v[160:163], v[176:179], v[64:67]
    v_mfma_f32_16x16x32_bf16 v[68:71], v[160:163], v[180:183], v[68:71]
    v_mfma_f32_16x16x32_bf16 v[72:75], v[160:163], v[184:187], v[72:75]
    v_mfma_f32_16x16x32_bf16 v[76:79], v[160:163], v[188:191], v[76:79]
    v_mfma_f32_16x16x32_bf16 v[68:71], v[164:167], v[176:179], v[68:71]
    v_mfma_f32_16x16x32_bf16 v[72:75], v[164:167], v[180:183], v[72:75]
    v_mfma_f32_16x16x32_bf16 v[76:79], v[164:167], v[184:187], v[76:79]
    v_mfma_f32_16x16x32_bf16 v[72:75], v[168:171], v[176:179], v[72:75]
    v_mfma_f32_16x16x32_bf16 v[76:79], v[168:171], v[180:183], v[76:79]
    v_mfma_f32_16x16x32_bf16 v[76:79], v[172:175], v[176:179], v[76:79]
    s_nop 7
    v_lshlrev_b32 v5, 6, v2
    v_lshl_add_u32 v5, v3, 4, v5
    v_add_u32 v5, v5, v4
    ds_write_b128 v5, v[48:51] offset:7424
    ds_write_b128 v5, v[52:55] offset:8448
    ds_write_b128 v5, v[56:59] offset:9472
    ds_write_b128 v5, v[60:63] offset:10496
    ds_write_b128 v5, v[64:67] offset:11520
    ds_write_b128 v5, v[68:71] offset:12544
    ds_write_b128 v5, v[72:75] offset:13568
    ds_write_b128 v5, v[76:79] offset:14592
    v_mov_b64 v[8:9], v[16:17]
    v_mov_b64 v[10:11], v[18:19]
    v_mov_b64 v[12:13], v[20:21]
    v_mov_b64 v[14:15], v[22:23]
    v_mov_b32 v24, v25
    v_add_u32 v4, 65536, v4
    s_add_u32 s28, s28, 1
    s_cmp_lt_u32 s28, 2
    s_waitcnt lgkmcnt(0)
    s_cbranch_scc1 ss_pass
    s_mov_b32 s12, s74
    s_mov_b32 s13, s75
    s_mov_b32 s14, 1152
    s_mov_b32 s15, 0x20000
    s_lshl_b32 s23, s20, 1
    buffer_load_dwordx4 v[8:11], off, s[12:15], s23
    s_barrier
    v_lshlrev_b32 v5, 5, v0
    v_add_u32 v7, 65536, v5
    ds_read_b128 v[64:67], v5 offset:7424
    ds_read_b128 v[68:71], v5 offset:7440
    ds_read_b128 v[72:75], v5 offset:23808
    ds_read_b128 v[76:79], v5 offset:23824
    ds_read_b128 v[80:83], v5 offset:40192
    ds_read_b128 v[84:87], v5 offset:40208
    ds_read_b128 v[88:91], v5 offset:56576
    ds_read_b128 v[92:95], v5 offset:56592
    ds_read_b128 v[96:99], v7 offset:7424
    ds_read_b128 v[100:103], v7 offset:7440
    ds_read_b128 v[104:107], v7 offset:23808
    ds_read_b128 v[108:111], v7 offset:23824
    ds_read_b128 v[112:115], v7 offset:40192
    ds_read_b128 v[116:119], v7 offset:40208
    ds_read_b128 v[120:123], v7 offset:56576
    ds_read_b128 v[124:127], v7 offset:56592
    s_waitcnt vmcnt(0)
    v_lshlrev_b32 v12, 16, v8
    v_and_b32 v13, 0xffff0000, v8
    v_lshlrev_b32 v14, 16, v9
    v_and_b32 v15, 0xffff0000, v9
    v_lshlrev_b32 v16, 16, v10
    v_and_b32 v17, 0xffff0000, v10
    v_lshlrev_b32 v18, 16, v11
    v_and_b32 v19, 0xffff0000, v11
    v_mul_u32_u24 v5, 18432, v0
    s_lshl_b32 s22, s20, 1
    s_add_u32 s22, s22, 1152
    s_waitcnt lgkmcnt(0)
    v_lshlrev_b32 v6, 16, v208
    v_fmac_f32 v64, v6, v12
    v_and_b32 v6, 0xffff0000, v208
    v_fmac_f32 v72, v6, v13
    v_lshlrev_b32 v6, 16, v209
    v_fmac_f32 v80, v6, v14
    v_and_b32 v6, 0xffff0000, v209
    v_fmac_f32 v88, v6, v15
    v_lshlrev_b32 v6, 16, v210
    v_fmac_f32 v96, v6, v16
    v_and_b32 v6, 0xffff0000, v210
    v_fmac_f32 v104, v6, v17
    v_lshlrev_b32 v6, 16, v211
    v_fmac_f32 v112, v6, v18
    v_and_b32 v6, 0xffff0000, v211
    v_fmac_f32 v120, v6, v19
    v_cvt_pk_bf16_f32 v208, v64, v72
    v_cvt_pk_bf16_f32 v209, v80, v88
    v_cvt_pk_bf16_f32 v210, v96, v104
    v_cvt_pk_bf16_f32 v211, v112, v120
    s_add_u32 s23, s22, 0
    buffer_store_dwordx4 v[208:211], v5, s[16:19], s23 offen
    v_lshlrev_b32 v6, 16, v212
    v_fmac_f32 v65, v6, v12
    v_and_b32 v6, 0xffff0000, v212
    v_fmac_f32 v73, v6, v13
    v_lshlrev_b32 v6, 16, v213
    v_fmac_f32 v81, v6, v14
    v_and_b32 v6, 0xffff0000, v213
    v_fmac_f32 v89, v6, v15
    v_lshlrev_b32 v6, 16, v214
    v_fmac_f32 v97, v6, v16
    v_and_b32 v6, 0xffff0000, v214
    v_fmac_f32 v105, v6, v17
    v_lshlrev_b32 v6, 16, v215
    v_fmac_f32 v113, v6, v18
    v_and_b32 v6, 0xffff0000, v215
    v_fmac_f32 v121, v6, v19
    v_cvt_pk_bf16_f32 v212, v65, v73
    v_cvt_pk_bf16_f32 v213, v81, v89
    v_cvt_pk_bf16_f32 v214, v97, v105
    v_cvt_pk_bf16_f32 v215, v113, v121
    s_add_u32 s23, s22, 2304
    buffer_store_dwordx4 v[212:215], v5, s[16:19], s23 offen
    v_lshlrev_b32 v6, 16, v216
    v_fmac_f32 v66, v6, v12
    v_and_b32 v6, 0xffff0000, v216
    v_fmac_f32 v74, v6, v13
    v_lshlrev_b32 v6, 16, v217
    v_fmac_f32 v82, v6, v14
    v_and_b32 v6, 0xffff0000, v217
    v_fmac_f32 v90, v6, v15
    v_lshlrev_b32 v6, 16, v218
    v_fmac_f32 v98, v6, v16
    v_and_b32 v6, 0xffff0000, v218
    v_fmac_f32 v106, v6, v17
    v_lshlrev_b32 v6, 16, v219
    v_fmac_f32 v114, v6, v18
    v_and_b32 v6, 0xffff0000, v219
    v_fmac_f32 v122, v6, v19
    v_cvt_pk_bf16_f32 v216, v66, v74
    v_cvt_pk_bf16_f32 v217, v82, v90
    v_cvt_pk_bf16_f32 v218, v98, v106
    v_cvt_pk_bf16_f32 v219, v114, v122
    s_add_u32 s23, s22, 4608
    buffer_store_dwordx4 v[216:219], v5, s[16:19], s23 offen
    v_lshlrev_b32 v6, 16, v220
    v_fmac_f32 v67, v6, v12
    v_and_b32 v6, 0xffff0000, v220
    v_fmac_f32 v75, v6, v13
    v_lshlrev_b32 v6, 16, v221
    v_fmac_f32 v83, v6, v14
    v_and_b32 v6, 0xffff0000, v221
    v_fmac_f32 v91, v6, v15
    v_lshlrev_b32 v6, 16, v222
    v_fmac_f32 v99, v6, v16
    v_and_b32 v6, 0xffff0000, v222
    v_fmac_f32 v107, v6, v17
    v_lshlrev_b32 v6, 16, v223
    v_fmac_f32 v115, v6, v18
    v_and_b32 v6, 0xffff0000, v223
    v_fmac_f32 v123, v6, v19
    v_cvt_pk_bf16_f32 v220, v67, v75
    v_cvt_pk_bf16_f32 v221, v83, v91
    v_cvt_pk_bf16_f32 v222, v99, v107
    v_cvt_pk_bf16_f32 v223, v115, v123
    s_add_u32 s23, s22, 6912
    buffer_store_dwordx4 v[220:223], v5, s[16:19], s23 offen
    v_lshlrev_b32 v6, 16, v224
    v_fmac_f32 v68, v6, v12
    v_and_b32 v6, 0xffff0000, v224
    v_fmac_f32 v76, v6, v13
    v_lshlrev_b32 v6, 16, v225
    v_fmac_f32 v84, v6, v14
    v_and_b32 v6, 0xffff0000, v225
    v_fmac_f32 v92, v6, v15
    v_lshlrev_b32 v6, 16, v226
    v_fmac_f32 v100, v6, v16
    v_and_b32 v6, 0xffff0000, v226
    v_fmac_f32 v108, v6, v17
    v_lshlrev_b32 v6, 16, v227
    v_fmac_f32 v116, v6, v18
    v_and_b32 v6, 0xffff0000, v227
    v_fmac_f32 v124, v6, v19
    v_cvt_pk_bf16_f32 v224, v68, v76
    v_cvt_pk_bf16_f32 v225, v84, v92
    v_cvt_pk_bf16_f32 v226, v100, v108
    v_cvt_pk_bf16_f32 v227, v116, v124
    s_add_u32 s23, s22, 9216
    buffer_store_dwordx4 v[224:227], v5, s[16:19], s23 offen
    v_lshlrev_b32 v6, 16, v228
    v_fmac_f32 v69, v6, v12
    v_and_b32 v6, 0xffff0000, v228
    v_fmac_f32 v77, v6, v13
    v_lshlrev_b32 v6, 16, v229
    v_fmac_f32 v85, v6, v14
    v_and_b32 v6, 0xffff0000, v229
    v_fmac_f32 v93, v6, v15
    v_lshlrev_b32 v6, 16, v230
    v_fmac_f32 v101, v6, v16
    v_and_b32 v6, 0xffff0000, v230
    v_fmac_f32 v109, v6, v17
    v_lshlrev_b32 v6, 16, v231
    v_fmac_f32 v117, v6, v18
    v_and_b32 v6, 0xffff0000, v231
    v_fmac_f32 v125, v6, v19
    v_cvt_pk_bf16_f32 v228, v69, v77
    v_cvt_pk_bf16_f32 v229, v85, v93
    v_cvt_pk_bf16_f32 v230, v101, v109
    v_cvt_pk_bf16_f32 v231, v117, v125
    s_add_u32 s23, s22, 11520
    buffer_store_dwordx4 v[228:231], v5, s[16:19], s23 offen
    v_lshlrev_b32 v6, 16, v232
    v_fmac_f32 v70, v6, v12
    v_and_b32 v6, 0xffff0000, v232
    v_fmac_f32 v78, v6, v13
    v_lshlrev_b32 v6, 16, v233
    v_fmac_f32 v86, v6, v14
    v_and_b32 v6, 0xffff0000, v233
    v_fmac_f32 v94, v6, v15
    v_lshlrev_b32 v6, 16, v234
    v_fmac_f32 v102, v6, v16
    v_and_b32 v6, 0xffff0000, v234
    v_fmac_f32 v110, v6, v17
    v_lshlrev_b32 v6, 16, v235
    v_fmac_f32 v118, v6, v18
    v_and_b32 v6, 0xffff0000, v235
    v_fmac_f32 v126, v6, v19
    v_cvt_pk_bf16_f32 v232, v70, v78
    v_cvt_pk_bf16_f32 v233, v86, v94
    v_cvt_pk_bf16_f32 v234, v102, v110
    v_cvt_pk_bf16_f32 v235, v118, v126
    s_add_u32 s23, s22, 13824
    buffer_store_dwordx4 v[232:235], v5, s[16:19], s23 offen
    v_lshlrev_b32 v6, 16, v236
    v_fmac_f32 v71, v6, v12
    v_and_b32 v6, 0xffff0000, v236
    v_fmac_f32 v79, v6, v13
    v_lshlrev_b32 v6, 16, v237
    v_fmac_f32 v87, v6, v14
    v_and_b32 v6, 0xffff0000, v237
    v_fmac_f32 v95, v6, v15
    v_lshlrev_b32 v6, 16, v238
    v_fmac_f32 v103, v6, v16
    v_and_b32 v6, 0xffff0000, v238
    v_fmac_f32 v111, v6, v17
    v_lshlrev_b32 v6, 16, v239
    v_fmac_f32 v119, v6, v18
    v_and_b32 v6, 0xffff0000, v239
    v_fmac_f32 v127, v6, v19
    v_cvt_pk_bf16_f32 v236, v71, v79
    v_cvt_pk_bf16_f32 v237, v87, v95
    v_cvt_pk_bf16_f32 v238, v103, v111
    v_cvt_pk_bf16_f32 v239, v119, v127
    s_add_u32 s23, s22, 16128
    buffer_store_dwordx4 v[236:239], v5, s[16:19], s23 offen
    s_branch L_ssm_next
L_ssm_done:
    s_cmp_lt_u32 s93, 100
    s_cbranch_scc1 L_exit
    s_mov_b32 s8, s76
    s_mov_b32 s9, s77
    s_mov_b32 s10, 4718592
    s_mov_b32 s11, 0x20000
    s_cmp_le_u32 s45, 1
    s_cbranch_scc1 L_att_next
    s_branch L_op_nextcb
L_wf_next:
    s_mov_b32 s37, 20
    v_mov_b32 v250, 1
    v_mov_b32 v251, 163832
    v_cmp_eq_u32 vcc, 0, v0
    s_nop 0
    s_and_saveexec_b64 s[38:39], vcc
    s_cbranch_execz tk13
    buffer_atomic_add v250, off, s[84:87], s37 sc0
    s_waitcnt vmcnt(0)
    ds_write_b32 v251, v250
    s_waitcnt lgkmcnt(0)
tk13:
    s_mov_b64 exec, -1
    s_barrier
    ds_read_b32 v252, v251
    s_waitcnt lgkmcnt(0)
    v_readfirstlane_b32 s33, v252
    s_barrier
    s_nop 3
    s_cmp_ge_u32 s33, 160
    s_cbranch_scc1 L_ssm_next
    s_lshl_b32 s16, s33, 2
    s_add_u32 s16, s16, s32
    s_add_u32 s16, s16, 1504
    s_call_b64 s[46:47], L_xform
    s_cmp_lg_u32 s95, 0
    s_cbranch_scc1 L_wfn
    s_mov_b32 s88, 4194304
gn14:
    buffer_load_dword v250, off, s[84:87], 0 offset:216 sc1
    s_waitcnt vmcnt(0)
    v_readfirstlane_b32 s95, v250
    s_sub_u32 s88, s88, 1
    s_cbranch_scc1 gn14x
    s_cmp_eq_u32 s95, 0
    s_cbranch_scc1 gn14
gn14x:
L_wfn:
    s_lshl_b32 s40, s33, 2
    s_add_u32 s40, s40, 125841408
    s_waitcnt vmcnt(0)
    s_barrier
    v_mov_b32 v250, s95
    v_cmp_eq_u32 vcc, 0, v0
    s_nop 0
    s_and_saveexec_b64 s[38:39], vcc
    s_cbranch_execz fs15
    buffer_store_dword v250, off, s[4:7], s40 sc1
fs15:
    s_mov_b64 exec, -1
    s_branch L_wf_next
L_phase2:
    s_mov_b32 s40, 524288
mc2_w:
    buffer_load_dword v250, off, s[84:87], 0 offset:28 sc1
    s_waitcnt vmcnt(0)
    v_readfirstlane_b32 s41, v250
    s_nop 0
    s_cmp_lg_u32 s41, 0
    s_cbranch_scc1 mc2_known
    s_sub_u32 s40, s40, 1
    s_cbranch_scc1 mc2_force
    s_sleep 2
    s_branch mc2_w
mc2_force:
    v_mov_b32 v250, 2
    v_mov_b32 v251, 0
    s_mov_b64 exec, 1
    buffer_atomic_cmpswap v[250:251], off, s[84:87], 0 offset:28
    s_mov_b64 exec, -1
    s_waitcnt vmcnt(0)
    s_mov_b32 s40, 524288
    s_branch mc2_w
mc2_known:
    s_cmp_eq_u32 s41, 1
    s_cbranch_scc1 L_phase2b
    s_mov_b32 s37, 208
    v_mov_b32 v250, 1
    v_mov_b32 v251, 163832
    v_cmp_eq_u32 vcc, 0, v0
    s_nop 0
    s_and_saveexec_b64 s[38:39], vcc
    s_cbranch_execz tk16
    buffer_atomic_add v250, off, s[84:87], s37 sc0
    s_waitcnt vmcnt(0)
    ds_write_b32 v251, v250
    s_waitcnt lgkmcnt(0)
tk16:
    s_mov_b64 exec, -1
    s_barrier
    ds_read_b32 v252, v251
    s_waitcnt lgkmcnt(0)
    v_readfirstlane_b32 s12, v252
    s_barrier
    s_nop 3
    s_cmp_lt_u32 s12, 32
    s_cbranch_scc1 L_chain_safe
    s_sub_u32 s45, s12, 32
L_phase2b:
    s_mov_b32 s8, s76
    s_mov_b32 s9, s77
    s_mov_b32 s10, 4718592
    s_mov_b32 s11, 0x20000
    s_and_b32 s36, s45, 15
    s_bitcmp1_b32 42315, s36
    s_cbranch_scc0 L_nots
    s_cmp_eq_u32 s93, 500
    s_cbranch_scc1 L_ssm_next
    s_branch L_wf_next
L_nots:
    s_bitcmp1_b32 18576, s36
    s_cbranch_scc0 L_att_next
    s_bfm_b32 s37, s36, 0
    s_and_b32 s37, s37, 18576
    s_bcnt1_i32_b32 s37, s37
    s_lshr_b32 s40, s45, 4
    s_mul_i32 s40, s40, 4
    s_add_u32 s33, s40, s37
L_op_mod:
    s_mul_hi_u32 s41, s33, 0x0e38e38f
    s_mul_i32 s41, s41, 18
    s_sub_u32 s33, s33, s41
    s_branch L_op_start
L_att_next:
    s_mov_b32 s37, 16
    v_mov_b32 v250, 1
    v_mov_b32 v251, 163832
    v_cmp_eq_u32 vcc, 0, v0
    s_nop 0
    s_and_saveexec_b64 s[38:39], vcc
    s_cbranch_execz tk17
    buffer_atomic_add v250, off, s[84:87], s37 sc0
    s_waitcnt vmcnt(0)
    ds_write_b32 v251, v250
    s_waitcnt lgkmcnt(0)
tk17:
    s_mov_b64 exec, -1
    s_barrier
    ds_read_b32 v252, v251
    s_waitcnt lgkmcnt(0)
    v_readfirstlane_b32 s34, v252
    s_barrier
    s_nop 3
    s_cmp_ge_u32 s34, 512
    s_cbranch_scc1 L_op_nextcb
    s_lshr_b32 s16, s34, 3
    s_and_b32 s17, s34, 7
    s_lshl_b32 s17, s17, 2
    s_add_u32 s17, s17, s32
    s_lshl_b32 s36, s17, 7
    s_add_u32 s36, s36, 125829120
    s_lshr_b32 s41, s16, 2
    s_add_u32 s41, s41, s95
    s_add_u32 s41, s41, 1
    v_and_b32 v1, 3, v0
    v_min_u32 v1, 2, v1
    v_lshlrev_b32 v2, 4, v1
    s_and_b32 s37, s16, 3
    s_lshl_b32 s37, s37, 2
    v_add_u32 v2, s37, v2
    s_mov_b32 s40, 4194304
L_aw1:
    buffer_load_dword v3, v2, s[4:7], s36 offen sc1
    s_sub_u32 s40, s40, 1
    s_cbranch_scc1 L_aw1_go
    s_waitcnt vmcnt(0)
    v_subrev_u32 v3, s41, v3
    v_cmp_lt_u32 vcc, 64, v3
    s_cbranch_vccz L_aw1_go
    s_sleep 4
    s_branch L_aw1
L_aw1_go:
    v_and_b32 v5, 63, v0
    v_lshlrev_b32 v1, 4, v5
    s_cmp_ge_u32 s16, 56
    s_cselect_b32 s18, -1, 511
    v_and_b32 v2, s18, v1
    v_or_b32 v3, 128, v1
    v_lshrrev_b32 v4, 4, v5
    v_bfe_u32 v6, v5, 2, 2
    v_sub_u32 v4, v6, v4
    v_lshlrev_b32 v4, 3, v4
    v_and_b32 v6, 3, v5
    v_add_u32 v4, v4, v6
    v_mov_b32 v6, 0xf149f2ca
    s_mov_b32 s22, 0x3e0293ee
    s_lshl_b32 s18, s16, 5
    s_add_u32 s18, s18, s17
    s_lshl_b32 s19, s18, 13
    s_add_u32 s20, s19, 33554432
    buffer_load_dwordx4 v[8:11], v1, s[4:7], s20 offen offset:0 sc1
    s_add_u32 s20, s19, 33554432
    buffer_load_dwordx4 v[12:15], v1, s[4:7], s20 offen offset:1024 sc1
    s_add_u32 s20, s19, 33554432
    buffer_load_dwordx4 v[16:19], v1, s[4:7], s20 offen offset:2048 sc1
    s_add_u32 s20, s19, 33554432
    buffer_load_dwordx4 v[20:23], v1, s[4:7], s20 offen offset:3072 sc1
    s_add_u32 s20, s19, 33558528
    buffer_load_dwordx4 v[24:27], v1, s[4:7], s20 offen offset:0 sc1
    s_add_u32 s20, s19, 33558528
    buffer_load_dwordx4 v[28:31], v1, s[4:7], s20 offen offset:1024 sc1
    s_add_u32 s20, s19, 33558528
    buffer_load_dwordx4 v[32:35], v1, s[4:7], s20 offen offset:2048 sc1
    s_add_u32 s20, s19, 33558528
    buffer_load_dwordx4 v[36:39], v1, s[4:7], s20 offen offset:3072 sc1
    s_lshl_b32 s21, s18, 14
    s_add_u32 s20, s21, 0
    buffer_load_dwordx4 v[40:43], v1, s[4:7], s20 offen offset:0 sc1
    s_add_u32 s20, s21, 4096
    buffer_load_dwordx4 v[44:47], v1, s[4:7], s20 offen offset:0 sc1
    s_add_u32 s20, s21, 8192
    buffer_load_dwordx4 v[48:51], v1, s[4:7], s20 offen offset:0 sc1
    s_add_u32 s20, s21, 12288
    buffer_load_dwordx4 v[52:55], v1, s[4:7], s20 offen offset:0 sc1
    s_add_u32 s20, s21, 0
    buffer_load_dwordx4 v[56:59], v1, s[4:7], s20 offen offset:1024 sc1
    s_add_u32 s20, s21, 4096
    buffer_load_dwordx4 v[60:63], v1, s[4:7], s20 offen offset:1024 sc1
    s_add_u32 s20, s21, 8192
    buffer_load_dwordx4 v[64:67], v1, s[4:7], s20 offen offset:1024 sc1
    s_add_u32 s20, s21, 12288
    buffer_load_dwordx4 v[68:71], v1, s[4:7], s20 offen offset:1024 sc1
    s_add_u32 s20, s21, 0
    buffer_load_dwordx4 v[88:91], v1, s[4:7], s20 offen offset:2048 sc1
    s_add_u32 s20, s21, 4096
    buffer_load_dwordx4 v[92:95], v1, s[4:7], s20 offen offset:2048 sc1
    s_add_u32 s20, s21, 8192
    buffer_load_dwordx4 v[96:99], v1, s[4:7], s20 offen offset:2048 sc1
    s_add_u32 s20, s21, 12288
    buffer_load_dwordx4 v[100:103], v1, s[4:7], s20 offen offset:2048 sc1
    s_add_u32 s20, s21, 0
    buffer_load_dwordx4 v[104:107], v1, s[4:7], s20 offen offset:3072 sc1
    s_add_u32 s20, s21, 4096
    buffer_load_dwordx4 v[108:111], v1, s[4:7], s20 offen offset:3072 sc1
    s_add_u32 s20, s21, 8192
    buffer_load_dwordx4 v[112:115], v1, s[4:7], s20 offen offset:3072 sc1
    s_add_u32 s20, s21, 12288
    buffer_load_dwordx4 v[116:119], v1, s[4:7], s20 offen offset:3072 sc1
    v_mov_b32 v172, 0x3f803f80
    v_mov_b32 v173, 0x3f803f80
    v_mov_b32 v174, 0x3f803f80
    v_mov_b32 v175, 0x3f803f80
    v_mov_b32 v176, 0x3f003f00
    v_mov_b32 v177, 0x3f003f00
    s_waitcnt vmcnt(8)
    v_mfma_f32_16x16x32_bf16 v[136:139], v[40:43], v[8:11], 0
    v_mfma_f32_16x16x32_bf16 v[140:143], v[56:59], v[8:11], 0
    v_mfma_f32_16x16x32_bf16 v[148:151], v[40:43], v[24:27], 0
    v_mfma_f32_16x16x32_bf16 v[152:155], v[56:59], v[24:27], 0
    v_mfma_f32_16x16x32_bf16 v[136:139], v[44:47], v[12:15], v[136:139]
    v_mfma_f32_16x16x32_bf16 v[140:143], v[60:63], v[12:15], v[140:143]
    v_mfma_f32_16x16x32_bf16 v[148:151], v[44:47], v[28:31], v[148:151]
    v_mfma_f32_16x16x32_bf16 v[152:155], v[60:63], v[28:31], v[152:155]
    v_mfma_f32_16x16x32_bf16 v[136:139], v[48:51], v[16:19], v[136:139]
    v_mfma_f32_16x16x32_bf16 v[140:143], v[64:67], v[16:19], v[140:143]
    v_mfma_f32_16x16x32_bf16 v[148:151], v[48:51], v[32:35], v[148:151]
    v_mfma_f32_16x16x32_bf16 v[152:155], v[64:67], v[32:35], v[152:155]
    v_mfma_f32_16x16x32_bf16 v[136:139], v[52:55], v[20:23], v[136:139]
    v_mfma_f32_16x16x32_bf16 v[140:143], v[68:71], v[20:23], v[140:143]
    v_mfma_f32_16x16x32_bf16 v[148:151], v[52:55], v[36:39], v[148:151]
    v_mfma_f32_16x16x32_bf16 v[152:155], v[68:71], v[36:39], v[152:155]
    v_cmp_le_i32 vcc, 0, v4
    s_nop 3
    v_cndmask_b32 v136, v6, v136, vcc
    v_cmp_le_i32 vcc, 1, v4
    s_nop 1
    v_cndmask_b32 v137, v6, v137, vcc
    v_cmp_le_i32 vcc, 2, v4
    s_nop 1
    v_cndmask_b32 v138, v6, v138, vcc
    v_cmp_le_i32 vcc, 3, v4
    s_nop 1
    v_cndmask_b32 v139, v6, v139, vcc
    v_cmp_le_i32 vcc, 4, v4
    s_nop 1
    v_cndmask_b32 v140, v6, v140, vcc
    v_cmp_le_i32 vcc, 5, v4
    s_nop 1
    v_cndmask_b32 v141, v6, v141, vcc
    v_cmp_le_i32 vcc, 6, v4
    s_nop 1
    v_cndmask_b32 v142, v6, v142, vcc
    v_cmp_le_i32 vcc, 7, v4
    s_nop 1
    v_cndmask_b32 v143, v6, v143, vcc
    v_cmp_le_i32 vcc, -4, v4
    s_nop 1
    v_cndmask_b32 v148, v6, v148, vcc
    v_cmp_le_i32 vcc, -3, v4
    s_nop 1
    v_cndmask_b32 v149, v6, v149, vcc
    v_cmp_le_i32 vcc, -2, v4
    s_nop 1
    v_cndmask_b32 v150, v6, v150, vcc
    v_cmp_le_i32 vcc, -1, v4
    s_nop 1
    v_cndmask_b32 v151, v6, v151, vcc
    v_cmp_le_i32 vcc, 0, v4
    s_nop 1
    v_cndmask_b32 v152, v6, v152, vcc
    v_cmp_le_i32 vcc, 1, v4
    s_nop 1
    v_cndmask_b32 v153, v6, v153, vcc
    v_cmp_le_i32 vcc, 2, v4
    s_nop 1
    v_cndmask_b32 v154, v6, v154, vcc
    v_cmp_le_i32 vcc, 3, v4
    s_nop 1
    v_cndmask_b32 v155, v6, v155, vcc
    s_nop 1
    v_and_b32 v198, 1, v0
    v_lshlrev_b32 v198, 2, v198
    v_add_u32 v198, 48, v198
    s_add_u32 s41, s16, s95
    s_add_u32 s41, s41, 1
    s_cmp_lt_u32 s16, 56
    s_cbranch_scc1 L_amk
    v_mov_b32 v198, 16384
    s_sub_u32 s41, s41, 1
    s_mov_b32 s44, 8
L_amk:
    s_sub_u32 s43, s41, s95
    s_sub_u32 s43, s43, 1
    s_mov_b32 s88, 65536
    s_mov_b32 s89, 125853696
cw18:
    buffer_load_dword v199, off, s[4:7], s89 sc1
    s_waitcnt vmcnt(0)
    v_readfirstlane_b32 s42, v199
    s_nop 0
    s_sub_u32 s42, s42, s95
    s_cmp_gt_u32 s42, 64
    s_cselect_b32 s42, 0, s42
    s_add_u32 s42, s42, 1
    s_cmp_ge_u32 s42, s43
    s_cbranch_scc1 cw18x
    s_sub_u32 s88, s88, 1
    s_cbranch_scc1 cw18x
    s_sub_u32 s42, s43, s42
    s_min_u32 s42, s42, 6
cw18s:
    s_sleep 24
    s_sub_u32 s42, s42, 1
    s_cmp_lg_u32 s42, 0
    s_cbranch_scc1 cw18s
    s_branch cw18
cw18x:
    s_mov_b32 s40, 4194304
L_aw2:
    buffer_load_dword v199, v198, s[4:7], s36 offen sc1
    s_sub_u32 s40, s40, 1
    s_cbranch_scc1 L_aw2_go
    s_waitcnt vmcnt(0)
    v_subrev_u32 v199, s41, v199
    v_cmp_lt_u32 vcc, 64, v199
    s_cbranch_vccz L_aw2_go
    s_sleep 1
    s_branch L_aw2
L_aw2_go:
at_ldm:
    s_lshl_b32 s20, s18, 12
    s_add_u32 s20, s20, 69206016
    buffer_load_dwordx4 v[72:75], v3, s[4:7], s20 offen offset:0 sc1
    buffer_load_dwordx4 v[76:79], v3, s[4:7], s20 offen offset:1024 sc1
    buffer_load_dwordx4 v[80:83], v3, s[4:7], s20 offen offset:2048 sc1
    buffer_load_dwordx4 v[84:87], v3, s[4:7], s20 offen offset:3072 sc1
    s_lshl_b32 s20, s18, 12
    s_add_u32 s20, s20, 77594624
    buffer_load_dwordx4 v[120:123], v2, s[4:7], s20 offen offset:0 sc1
    buffer_load_dwordx4 v[124:127], v2, s[4:7], s20 offen offset:1024 sc1
    buffer_load_dwordx4 v[128:131], v2, s[4:7], s20 offen offset:2048 sc1
    buffer_load_dwordx4 v[132:135], v2, s[4:7], s20 offen offset:3072 sc1
    s_cmp_lt_u32 s16, 56
    s_cbranch_scc1 at_ok
    s_waitcnt vmcnt(0)
    v_max_u32 v196, v72, v73
    v_max3_u32 v196, v196, v74, v75
    v_max3_u32 v196, v196, v76, v77
    v_max3_u32 v196, v196, v78, v79
    v_max3_u32 v196, v196, v80, v81
    v_max3_u32 v196, v196, v82, v83
    v_max3_u32 v196, v196, v84, v85
    v_max3_u32 v196, v196, v86, v87
    v_max3_u32 v196, v196, v120, v121
    v_max3_u32 v196, v196, v122, v123
    v_max3_u32 v196, v196, v124, v125
    v_max3_u32 v196, v196, v126, v127
    v_max3_u32 v196, v196, v128, v129
    v_max3_u32 v196, v196, v130, v131
    v_max3_u32 v196, v196, v132, v133
    v_max3_u32 v196, v196, v134, v135
    v_cmp_eq_u32 vcc, -1, v196
    s_cbranch_vccz at_ok
    s_sub_u32 s44, s44, 1
    s_cbranch_scc1 at_ok
    s_cmp_lg_u32 s44, 0
    s_cbranch_scc1 at_ldm
    s_add_u32 s41, s41, 1
    s_mov_b32 s40, 4194304
L_aw3:
    buffer_load_dword v199, v198, s[4:7], s36 offen sc1
    s_sub_u32 s40, s40, 1
    s_cbranch_scc1 L_aw3_go
    s_waitcnt vmcnt(0)
    v_subrev_u32 v199, s41, v199
    v_cmp_lt_u32 vcc, 64, v199
    s_cbranch_vccz L_aw3_go
    s_sleep 1
    s_branch L_aw3
L_aw3_go:
    s_branch at_ldm
at_ok:
    s_waitcnt vmcnt(4)
    v_mfma_f32_16x16x32_bf16 v[144:147], v[72:75], v[8:11], 0
    v_mfma_f32_16x16x32_bf16 v[156:159], v[72:75], v[24:27], 0
    v_mfma_f32_16x16x32_bf16 v[144:147], v[76:79], v[12:15], v[144:147]
    v_mfma_f32_16x16x32_bf16 v[156:159], v[76:79], v[28:31], v[156:159]
    v_mfma_f32_16x16x32_bf16 v[144:147], v[80:83], v[16:19], v[144:147]
    v_mfma_f32_16x16x32_bf16 v[156:159], v[80:83], v[32:35], v[156:159]
    v_mfma_f32_16x16x32_bf16 v[144:147], v[84:87], v[20:23], v[144:147]
    v_mfma_f32_16x16x32_bf16 v[156:159], v[84:87], v[36:39], v[156:159]
    v_max3_f32 v196, v136, v137, v138
    v_max3_f32 v197, v139, v140, v141
    v_max3_f32 v196, v196, v142, v143
    s_nop 3
    v_max3_f32 v197, v197, v144, v145
    v_max3_f32 v196, v196, v146, v147
    v_max_f32 v196, v196, v197
    v_mov_b32 v197, v196
    s_nop 1
    v_permlane32_swap_b32 v196, v197
    v_max_f32 v196, v196, v197
    v_mov_b32 v197, v196
    s_nop 1
    v_permlane16_swap_b32 v196, v197
    v_max_f32 v196, v196, v197
    v_mul_f32 v196, s22, v196
    v_sub_f32 v196, 0, v196
    v_fma_f32 v136, v136, s22, v196
    v_fma_f32 v137, v137, s22, v196
    v_fma_f32 v138, v138, s22, v196
    v_fma_f32 v139, v139, s22, v196
    v_fma_f32 v140, v140, s22, v196
    v_fma_f32 v141, v141, s22, v196
    v_fma_f32 v142, v142, s22, v196
    v_fma_f32 v143, v143, s22, v196
    v_fma_f32 v144, v144, s22, v196
    v_fma_f32 v145, v145, s22, v196
    v_fma_f32 v146, v146, s22, v196
    v_fma_f32 v147, v147, s22, v196
    v_exp_f32 v136, v136
    v_exp_f32 v137, v137
    v_exp_f32 v138, v138
    v_exp_f32 v139, v139
    v_exp_f32 v140, v140
    v_exp_f32 v141, v141
    v_exp_f32 v142, v142
    v_exp_f32 v143, v143
    v_exp_f32 v144, v144
    v_exp_f32 v145, v145
    v_exp_f32 v146, v146
    v_exp_f32 v147, v147
    v_cvt_pk_bf16_f32 v160, v136, v137
    v_cvt_pk_bf16_f32 v161, v138, v139
    v_cvt_pk_bf16_f32 v162, v140, v141
    v_cvt_pk_bf16_f32 v163, v142, v143
    v_cvt_pk_bf16_f32 v164, v144, v145
    v_cvt_pk_bf16_f32 v165, v146, v147
    v_max3_f32 v196, v148, v149, v150
    v_max3_f32 v197, v151, v152, v153
    v_max3_f32 v196, v196, v154, v155
    v_max3_f32 v197, v197, v156, v157
    v_max3_f32 v196, v196, v158, v159
    v_max_f32 v196, v196, v197
    v_mov_b32 v197, v196
    s_nop 1
    v_permlane32_swap_b32 v196, v197
    v_max_f32 v196, v196, v197
    v_mov_b32 v197, v196
    s_nop 1
    v_permlane16_swap_b32 v196, v197
    v_max_f32 v196, v196, v197
    v_mul_f32 v196, s22, v196
    v_sub_f32 v196, 0, v196
    v_fma_f32 v148, v148, s22, v196
    v_fma_f32 v149, v149, s22, v196
    v_fma_f32 v150, v150, s22, v196
    v_fma_f32 v151, v151, s22, v196
    v_fma_f32 v152, v152, s22, v196
    v_fma_f32 v153, v153, s22, v196
    v_fma_f32 v154, v154, s22, v196
    v_fma_f32 v155, v155, s22, v196
    v_fma_f32 v156, v156, s22, v196
    v_fma_f32 v157, v157, s22, v196
    v_fma_f32 v158, v158, s22, v196
    v_fma_f32 v159, v159, s22, v196
    v_exp_f32 v148, v148
    v_exp_f32 v149, v149
    v_exp_f32 v150, v150
    v_exp_f32 v151, v151
    v_exp_f32 v152, v152
    v_exp_f32 v153, v153
    v_exp_f32 v154, v154
    v_exp_f32 v155, v155
    v_exp_f32 v156, v156
    v_exp_f32 v157, v157
    v_exp_f32 v158, v158
    v_exp_f32 v159, v159
    v_cvt_pk_bf16_f32 v166, v148, v149
    v_cvt_pk_bf16_f32 v167, v150, v151
    v_cvt_pk_bf16_f32 v168, v152, v153
    v_cvt_pk_bf16_f32 v169, v154, v155
    v_cvt_pk_bf16_f32 v170, v156, v157
    v_cvt_pk_bf16_f32 v171, v158, v159
    v_mfma_f32_16x16x32_bf16 v[180:183], v[172:175], v[160:163], 0
    v_mfma_f32_16x16x32_bf16 v[184:187], v[172:175], v[166:169], 0
    s_nop 4
    v_mfma_f32_16x16x16_bf16 v[180:183], v[176:177], v[164:165], v[180:183]
    v_mfma_f32_16x16x16_bf16 v[184:187], v[176:177], v[170:171], v[184:187]
    s_nop 6
    v_rcp_f32 v180, v180
    v_rcp_f32 v184, v184
    s_waitcnt vmcnt(0)
    s_lshl_b32 s18, s16, 18
    s_lshl_b32 s19, s17, 12
    s_add_u32 s18, s18, s19
    s_add_u32 s18, s18, 50331648
    s_add_u32 s19, s18, 131072
    v_mfma_f32_16x16x32_bf16 v[8:11], v[88:91], v[160:163], 0
    v_mfma_f32_16x16x32_bf16 v[12:15], v[104:107], v[160:163], 0
    v_mfma_f32_16x16x32_bf16 v[16:19], v[88:91], v[166:169], 0
    v_mfma_f32_16x16x32_bf16 v[20:23], v[104:107], v[166:169], 0
    v_mfma_f32_16x16x32_bf16 v[24:27], v[92:95], v[160:163], 0
    v_mfma_f32_16x16x32_bf16 v[28:31], v[108:111], v[160:163], 0
    v_mfma_f32_16x16x32_bf16 v[32:35], v[92:95], v[166:169], 0
    v_mfma_f32_16x16x32_bf16 v[36:39], v[108:111], v[166:169], 0
    v_mfma_f32_16x16x32_bf16 v[40:43], v[96:99], v[160:163], 0
    v_mfma_f32_16x16x32_bf16 v[44:47], v[112:115], v[160:163], 0
    v_mfma_f32_16x16x32_bf16 v[48:51], v[96:99], v[166:169], 0
    v_mfma_f32_16x16x32_bf16 v[52:55], v[112:115], v[166:169], 0
    v_mfma_f32_16x16x32_bf16 v[56:59], v[100:103], v[160:163], 0
    v_mfma_f32_16x16x32_bf16 v[60:63], v[116:119], v[160:163], 0
    v_mfma_f32_16x16x32_bf16 v[64:67], v[100:103], v[166:169], 0
    v_mfma_f32_16x16x32_bf16 v[68:71], v[116:119], v[166:169], 0
    v_mfma_f32_16x16x16_bf16 v[8:11], v[120:121], v[164:165], v[8:11]
    v_mfma_f32_16x16x16_bf16 v[12:15], v[122:123], v[164:165], v[12:15]
    v_mfma_f32_16x16x16_bf16 v[16:19], v[120:121], v[170:171], v[16:19]
    v_mfma_f32_16x16x16_bf16 v[20:23], v[122:123], v[170:171], v[20:23]
    v_mfma_f32_16x16x16_bf16 v[24:27], v[124:125], v[164:165], v[24:27]
    v_mfma_f32_16x16x16_bf16 v[28:31], v[126:127], v[164:165], v[28:31]
    v_mfma_f32_16x16x16_bf16 v[32:35], v[124:125], v[170:171], v[32:35]
    v_mfma_f32_16x16x16_bf16 v[36:39], v[126:127], v[170:171], v[36:39]
    v_mfma_f32_16x16x16_bf16 v[40:43], v[128:129], v[164:165], v[40:43]
    v_mfma_f32_16x16x16_bf16 v[44:47], v[130:131], v[164:165], v[44:47]
    v_mfma_f32_16x16x16_bf16 v[48:51], v[128:129], v[170:171], v[48:51]
    v_mfma_f32_16x16x16_bf16 v[52:55], v[130:131], v[170:171], v[52:55]
    v_mfma_f32_16x16x16_bf16 v[56:59], v[132:133], v[164:165], v[56:59]
    v_mfma_f32_16x16x16_bf16 v[60:63], v[134:135], v[164:165], v[60:63]
    v_mfma_f32_16x16x16_bf16 v[64:67], v[132:133], v[170:171], v[64:67]
    v_mfma_f32_16x16x16_bf16 v[68:71], v[134:135], v[170:171], v[68:71]
    v_mul_f32 v8, v8, v180
    v_mul_f32 v12, v12, v180
    v_mul_f32 v9, v9, v180
    v_mul_f32 v13, v13, v180
    v_mul_f32 v10, v10, v180
    v_mul_f32 v14, v14, v180
    v_mul_f32 v11, v11, v180
    v_mul_f32 v15, v15, v180
    v_cvt_pk_bf16_f32 v8, v8, v9
    v_cvt_pk_bf16_f32 v9, v10, v11
    v_cvt_pk_bf16_f32 v10, v12, v13
    v_cvt_pk_bf16_f32 v11, v14, v15
    buffer_store_dwordx4 v[8:11], v1, s[4:7], s18 offen offset:0 sc1
    v_mul_f32 v16, v16, v184
    v_mul_f32 v20, v20, v184
    v_mul_f32 v17, v17, v184
    v_mul_f32 v21, v21, v184
    v_mul_f32 v18, v18, v184
    v_mul_f32 v22, v22, v184
    v_mul_f32 v19, v19, v184
    v_mul_f32 v23, v23, v184
    v_cvt_pk_bf16_f32 v16, v16, v17
    v_cvt_pk_bf16_f32 v17, v18, v19
    v_cvt_pk_bf16_f32 v18, v20, v21
    v_cvt_pk_bf16_f32 v19, v22, v23
    buffer_store_dwordx4 v[16:19], v1, s[4:7], s19 offen offset:0 sc1
    v_mul_f32 v24, v24, v180
    v_mul_f32 v28, v28, v180
    v_mul_f32 v25, v25, v180
    v_mul_f32 v29, v29, v180
    v_mul_f32 v26, v26, v180
    v_mul_f32 v30, v30, v180
    v_mul_f32 v27, v27, v180
    v_mul_f32 v31, v31, v180
    v_cvt_pk_bf16_f32 v24, v24, v25
    v_cvt_pk_bf16_f32 v25, v26, v27
    v_cvt_pk_bf16_f32 v26, v28, v29
    v_cvt_pk_bf16_f32 v27, v30, v31
    buffer_store_dwordx4 v[24:27], v1, s[4:7], s18 offen offset:1024 sc1
    v_mul_f32 v32, v32, v184
    v_mul_f32 v36, v36, v184
    v_mul_f32 v33, v33, v184
    v_mul_f32 v37, v37, v184
    v_mul_f32 v34, v34, v184
    v_mul_f32 v38, v38, v184
    v_mul_f32 v35, v35, v184
    v_mul_f32 v39, v39, v184
    v_cvt_pk_bf16_f32 v32, v32, v33
    v_cvt_pk_bf16_f32 v33, v34, v35
    v_cvt_pk_bf16_f32 v34, v36, v37
    v_cvt_pk_bf16_f32 v35, v38, v39
    buffer_store_dwordx4 v[32:35], v1, s[4:7], s19 offen offset:1024 sc1
    v_mul_f32 v40, v40, v180
    v_mul_f32 v44, v44, v180
    v_mul_f32 v41, v41, v180
    v_mul_f32 v45, v45, v180
    v_mul_f32 v42, v42, v180
    v_mul_f32 v46, v46, v180
    v_mul_f32 v43, v43, v180
    v_mul_f32 v47, v47, v180
    v_cvt_pk_bf16_f32 v40, v40, v41
    v_cvt_pk_bf16_f32 v41, v42, v43
    v_cvt_pk_bf16_f32 v42, v44, v45
    v_cvt_pk_bf16_f32 v43, v46, v47
    buffer_store_dwordx4 v[40:43], v1, s[4:7], s18 offen offset:2048 sc1
    v_mul_f32 v48, v48, v184
    v_mul_f32 v52, v52, v184
    v_mul_f32 v49, v49, v184
    v_mul_f32 v53, v53, v184
    v_mul_f32 v50, v50, v184
    v_mul_f32 v54, v54, v184
    v_mul_f32 v51, v51, v184
    v_mul_f32 v55, v55, v184
    v_cvt_pk_bf16_f32 v48, v48, v49
    v_cvt_pk_bf16_f32 v49, v50, v51
    v_cvt_pk_bf16_f32 v50, v52, v53
    v_cvt_pk_bf16_f32 v51, v54, v55
    buffer_store_dwordx4 v[48:51], v1, s[4:7], s19 offen offset:2048 sc1
    v_mul_f32 v56, v56, v180
    v_mul_f32 v60, v60, v180
    v_mul_f32 v57, v57, v180
    v_mul_f32 v61, v61, v180
    v_mul_f32 v58, v58, v180
    v_mul_f32 v62, v62, v180
    v_mul_f32 v59, v59, v180
    v_mul_f32 v63, v63, v180
    v_cvt_pk_bf16_f32 v56, v56, v57
    v_cvt_pk_bf16_f32 v57, v58, v59
    v_cvt_pk_bf16_f32 v58, v60, v61
    v_cvt_pk_bf16_f32 v59, v62, v63
    buffer_store_dwordx4 v[56:59], v1, s[4:7], s18 offen offset:3072 sc1
    v_mul_f32 v64, v64, v184
    v_mul_f32 v68, v68, v184
    v_mul_f32 v65, v65, v184
    v_mul_f32 v69, v69, v184
    v_mul_f32 v66, v66, v184
    v_mul_f32 v70, v70, v184
    v_mul_f32 v67, v67, v184
    v_mul_f32 v71, v71, v184
    v_cvt_pk_bf16_f32 v64, v64, v65
    v_cvt_pk_bf16_f32 v65, v66, v67
    v_cvt_pk_bf16_f32 v66, v68, v69
    v_cvt_pk_bf16_f32 v67, v70, v71
    buffer_store_dwordx4 v[64:67], v1, s[4:7], s19 offen offset:3072 sc1
    s_lshr_b32 s40, s34, 1
    s_lshl_b32 s40, s40, 7
    s_and_b32 s41, s34, 1
    s_lshl_b32 s41, s41, 2
    s_add_u32 s40, s40, s41
    s_add_u32 s40, s40, 125894656
    s_cmp_lt_u32 s16, 62
    s_cbranch_scc1 L_noef
    s_lshr_b32 s42, s34, 1
    s_mul_i32 s42, s42, 4096
    s_add_u32 s41, s41, s42
    s_add_u32 s41, s41, 124944384
    s_barrier
    s_cmp_lg_u32 s32, 0
    s_cbranch_scc1 L_noef
    v_mov_b32 v250, s95
    v_lshlrev_b32 v251, 7, v0
    s_mov_b64 exec, 262143
    buffer_store_dword v250, v251, s[4:7], s41 offen sc1
    s_mov_b64 exec, -1
L_noef:
    s_waitcnt vmcnt(0)
    s_barrier
    v_mov_b32 v250, s95
    v_cmp_eq_u32 vcc, 0, v0
    s_nop 0
    s_and_saveexec_b64 s[38:39], vcc
    s_cbranch_execz fs19
    buffer_store_dword v250, off, s[4:7], s40 sc1
fs19:
    s_mov_b64 exec, -1
    s_branch L_att_next
L_op_start:
    s_lshl_b32 s35, s33, 2
    s_add_u32 s35, s35, 136
    s_lshr_b32 s89, s33, 2
    s_lshl_b32 s89, s89, 7
    s_add_u32 s89, s89, 125841408
    v_mbcnt_lo_u32_b32 v2, -1, 0
    v_mbcnt_hi_u32_b32 v2, -1, v2
    v_min_u32 v2, 31, v2
    v_lshlrev_b32 v2, 2, v2
    s_mov_b32 s88, 4194304
fw20:
    buffer_load_dword v3, v2, s[4:7], s89 offen offset:0 sc1
    s_sub_u32 s88, s88, 1
    s_cbranch_scc1 fw20x
    s_waitcnt vmcnt(0)
    v_cmp_ne_u32 vcc, s95, v3
    s_cbranch_vccz fw20x
    s_sleep 4
    s_branch fw20
fw20x:
    v_and_b32 v1, 63, v0
    v_lshlrev_b32 v1, 4, v1
    s_lshl_b32 s18, s33, 18
    s_lshl_b32 s19, s32, 16
    s_add_u32 s18, s18, s19
    s_add_u32 s18, s18, 130023424
    buffer_load_dwordx4 a[0:3], v1, s[4:7], s18 offen offset:0 sc1
    buffer_load_dwordx4 a[4:7], v1, s[4:7], s18 offen offset:1024 sc1
    buffer_load_dwordx4 a[8:11], v1, s[4:7], s18 offen offset:2048 sc1
    buffer_load_dwordx4 a[12:15], v1, s[4:7], s18 offen offset:3072 sc1
    s_add_u32 s18, s18, 4096
    buffer_load_dwordx4 a[16:19], v1, s[4:7], s18 offen offset:0 sc1
    buffer_load_dwordx4 a[20:23], v1, s[4:7], s18 offen offset:1024 sc1
    buffer_load_dwordx4 a[24:27], v1, s[4:7], s18 offen offset:2048 sc1
    buffer_load_dwordx4 a[28:31], v1, s[4:7], s18 offen offset:3072 sc1
    s_add_u32 s18, s18, 4096
    buffer_load_dwordx4 a[32:35], v1, s[4:7], s18 offen offset:0 sc1
    buffer_load_dwordx4 a[36:39], v1, s[4:7], s18 offen offset:1024 sc1
    buffer_load_dwordx4 a[40:43], v1, s[4:7], s18 offen offset:2048 sc1
    buffer_load_dwordx4 a[44:47], v1, s[4:7], s18 offen offset:3072 sc1
    s_add_u32 s18, s18, 4096
    buffer_load_dwordx4 a[48:51], v1, s[4:7], s18 offen offset:0 sc1
    buffer_load_dwordx4 a[52:55], v1, s[4:7], s18 offen offset:1024 sc1
    buffer_load_dwordx4 a[56:59], v1, s[4:7], s18 offen offset:2048 sc1
    buffer_load_dwordx4 a[60:63], v1, s[4:7], s18 offen offset:3072 sc1
    s_add_u32 s18, s18, 4096
    buffer_load_dwordx4 a[64:67], v1, s[4:7], s18 offen offset:0 sc1
    buffer_load_dwordx4 a[68:71], v1, s[4:7], s18 offen offset:1024 sc1
    buffer_load_dwordx4 a[72:75], v1, s[4:7], s18 offen offset:2048 sc1
    buffer_load_dwordx4 a[76:79], v1, s[4:7], s18 offen offset:3072 sc1
    s_add_u32 s18, s18, 4096
    buffer_load_dwordx4 a[80:83], v1, s[4:7], s18 offen offset:0 sc1
    buffer_load_dwordx4 a[84:87], v1, s[4:7], s18 offen offset:1024 sc1
    buffer_load_dwordx4 a[88:91], v1, s[4:7], s18 offen offset:2048 sc1
    buffer_load_dwordx4 a[92:95], v1, s[4:7], s18 offen offset:3072 sc1
    s_add_u32 s18, s18, 4096
    buffer_load_dwordx4 a[96:99], v1, s[4:7], s18 offen offset:0 sc1
    buffer_load_dwordx4 a[100:103], v1, s[4:7], s18 offen offset:1024 sc1
    buffer_load_dwordx4 a[104:107], v1, s[4:7], s18 offen offset:2048 sc1
    buffer_load_dwordx4 a[108:111], v1, s[4:7], s18 offen offset:3072 sc1
    s_add_u32 s18, s18, 4096
    buffer_load_dwordx4 a[112:115], v1, s[4:7], s18 offen offset:0 sc1
    buffer_load_dwordx4 a[116:119], v1, s[4:7], s18 offen offset:1024 sc1
    buffer_load_dwordx4 a[120:123], v1, s[4:7], s18 offen offset:2048 sc1
    buffer_load_dwordx4 a[124:127], v1, s[4:7], s18 offen offset:3072 sc1
    s_add_u32 s18, s18, 4096
    buffer_load_dwordx4 a[128:131], v1, s[4:7], s18 offen offset:0 sc1
    buffer_load_dwordx4 a[132:135], v1, s[4:7], s18 offen offset:1024 sc1
    buffer_load_dwordx4 a[136:139], v1, s[4:7], s18 offen offset:2048 sc1
    buffer_load_dwordx4 a[140:143], v1, s[4:7], s18 offen offset:3072 sc1
    s_add_u32 s18, s18, 4096
    buffer_load_dwordx4 a[144:147], v1, s[4:7], s18 offen offset:0 sc1
    buffer_load_dwordx4 a[148:151], v1, s[4:7], s18 offen offset:1024 sc1
    buffer_load_dwordx4 a[152:155], v1, s[4:7], s18 offen offset:2048 sc1
    buffer_load_dwordx4 a[156:159], v1, s[4:7], s18 offen offset:3072 sc1
    s_add_u32 s18, s18, 4096
    buffer_load_dwordx4 a[160:163], v1, s[4:7], s18 offen offset:0 sc1
    s_waitcnt vmcnt(20)
    buffer_load_dwordx4 a[164:167], v1, s[4:7], s18 offen offset:1024 sc1
    buffer_load_dwordx4 a[168:171], v1, s[4:7], s18 offen offset:2048 sc1
    buffer_load_dwordx4 a[172:175], v1, s[4:7], s18 offen offset:3072 sc1
    s_add_u32 s18, s18, 4096
    buffer_load_dwordx4 a[176:179], v1, s[4:7], s18 offen offset:0 sc1
    buffer_load_dwordx4 a[180:183], v1, s[4:7], s18 offen offset:1024 sc1
    buffer_load_dwordx4 a[184:187], v1, s[4:7], s18 offen offset:2048 sc1
    buffer_load_dwordx4 a[188:191], v1, s[4:7], s18 offen offset:3072 sc1
    s_add_u32 s18, s18, 4096
    buffer_load_dwordx4 a[192:195], v1, s[4:7], s18 offen offset:0 sc1
    buffer_load_dwordx4 a[196:199], v1, s[4:7], s18 offen offset:1024 sc1
    buffer_load_dwordx4 a[200:203], v1, s[4:7], s18 offen offset:2048 sc1
    buffer_load_dwordx4 a[204:207], v1, s[4:7], s18 offen offset:3072 sc1
    s_add_u32 s18, s18, 4096
    buffer_load_dwordx4 a[208:211], v1, s[4:7], s18 offen offset:0 sc1
    buffer_load_dwordx4 a[212:215], v1, s[4:7], s18 offen offset:1024 sc1
    buffer_load_dwordx4 a[216:219], v1, s[4:7], s18 offen offset:2048 sc1
    buffer_load_dwordx4 a[220:223], v1, s[4:7], s18 offen offset:3072 sc1
    s_add_u32 s18, s18, 4096
    buffer_load_dwordx4 a[224:227], v1, s[4:7], s18 offen offset:0 sc1
    buffer_load_dwordx4 a[228:231], v1, s[4:7], s18 offen offset:1024 sc1
    buffer_load_dwordx4 a[232:235], v1, s[4:7], s18 offen offset:2048 sc1
    buffer_load_dwordx4 a[236:239], v1, s[4:7], s18 offen offset:3072 sc1
    s_add_u32 s18, s18, 4096
    buffer_load_dwordx4 a[240:243], v1, s[4:7], s18 offen offset:0 sc1
    buffer_load_dwordx4 a[244:247], v1, s[4:7], s18 offen offset:1024 sc1
    buffer_load_dwordx4 a[248:251], v1, s[4:7], s18 offen offset:2048 sc1
    buffer_load_dwordx4 a[252:255], v1, s[4:7], s18 offen offset:3072 sc1
    s_waitcnt vmcnt(0)
    s_mov_b32 s44, 0
    s_mov_b32 s37, s35
    v_mov_b32 v250, 1
    v_mov_b32 v251, 163832
    v_cmp_eq_u32 vcc, 0, v0
    s_nop 0
    s_and_saveexec_b64 s[38:39], vcc
    s_cbranch_execz tk21
    buffer_atomic_add v250, off, s[84:87], s37 sc0
    s_waitcnt vmcnt(0)
    ds_write_b32 v251, v250
    s_waitcnt lgkmcnt(0)
tk21:
    s_mov_b64 exec, -1
    s_barrier
    ds_read_b32 v252, v251
    s_waitcnt lgkmcnt(0)
    v_readfirstlane_b32 s16, v252
    s_barrier
    s_nop 3
    s_cmp_ge_u32 s16, 72
    s_cbranch_scc1 L_op_nextcb
L_op_seg:
    s_min_u32 s43, s16, 56
    s_add_u32 s16, s16, s43
    s_lshr_b32 s43, s16, 1
    s_add_u32 s43, s43, 2
    s_min_u32 s43, s43, 63
    s_lshl_b32 s94, s33, 7
    s_add_u32 s94, s94, s16
    s_mov_b32 s88, 65536
    s_mov_b32 s89, 125853696
cw22:
    buffer_load_dword v3, off, s[4:7], s89 sc1
    s_waitcnt vmcnt(0)
    v_readfirstlane_b32 s42, v3
    s_nop 0
    s_sub_u32 s42, s42, s95
    s_cmp_gt_u32 s42, 64
    s_cselect_b32 s42, 0, s42
    s_add_u32 s42, s42, 1
    s_cmp_ge_u32 s42, s43
    s_cbranch_scc1 cw22x
    s_sub_u32 s88, s88, 1
    s_cbranch_scc1 cw22x
    s_sub_u32 s42, s43, s42
    s_min_u32 s42, s42, 6
cw22s:
    s_sleep 24
    s_sub_u32 s42, s42, 1
    s_cmp_lg_u32 s42, 0
    s_cbranch_scc1 cw22s
    s_branch cw22
cw22x:
    s_lshr_b32 s89, s16, 1
    s_lshl_b32 s89, s89, 2
    s_add_u32 s89, s89, s32
    s_lshl_b32 s89, s89, 7
    s_add_u32 s89, s89, 125894656
    s_sub_u32 s47, s89, 125894656
    s_lshl_b32 s47, s47, 5
    s_lshl_b32 s46, s33, 7
    s_add_u32 s47, s47, s46
    s_add_u32 s47, s47, 124944384
    s_cmp_ge_u32 s16, 124
    s_cselect_b32 s46, 8, 0
    s_cselect_b32 s47, s47, s89
    v_mbcnt_lo_u32_b32 v2, -1, 0
    v_mbcnt_hi_u32_b32 v2, -1, v2
    v_min_u32 v2, 1, v2
    v_lshlrev_b32 v2, 2, v2
    s_mov_b32 s88, 4194304
fw23:
    buffer_load_dword v3, v2, s[4:7], s47 offen offset:0 sc1
    s_sub_u32 s88, s88, 1
    s_cbranch_scc1 fw23x
    s_waitcnt vmcnt(0)
    v_cmp_ne_u32 vcc, s95, v3
    s_cbranch_vccz fw23x
    s_sleep 1
    s_branch fw23
fw23x:
    v_mov_b32 v250, 1
    v_lshrrev_b32 v252, 2, v1
    v_min_u32 v252, 68, v252
    s_cmp_lg_u32 s32, 0
    s_cbranch_scc1 L_op_na
    s_mov_b64 exec, 1
    buffer_atomic_add v250, off, s[84:87], s35 sc0
    s_mov_b64 exec, -1
    s_cmp_lg_u32 s44, 0
    s_cbranch_scc1 L_op_na
    buffer_load_dword v253, v252, s[84:87], 0 offen offset:136 sc1
L_op_na:
    s_cmp_ge_u32 s16, 112
    s_cbranch_scc1 L_op_one
o2_again:
    s_lshl_b32 s18, s16, 17
    s_lshl_b32 s19, s32, 15
    s_add_u32 s18, s18, s19
    s_add_u32 s18, s18, 50331648
    buffer_load_dwordx4 v[24:27], v1, s[4:7], s18 offen offset:0 sc1
    buffer_load_dwordx4 v[28:31], v1, s[4:7], s18 offen offset:1024 sc1
    buffer_load_dwordx4 v[32:35], v1, s[4:7], s18 offen offset:2048 sc1
    buffer_load_dwordx4 v[36:39], v1, s[4:7], s18 offen offset:3072 sc1
    s_add_u32 s18, s18, 4096
    buffer_load_dwordx4 v[40:43], v1, s[4:7], s18 offen offset:0 sc1
    buffer_load_dwordx4 v[44:47], v1, s[4:7], s18 offen offset:1024 sc1
    buffer_load_dwordx4 v[48:51], v1, s[4:7], s18 offen offset:2048 sc1
    buffer_load_dwordx4 v[52:55], v1, s[4:7], s18 offen offset:3072 sc1
    s_add_u32 s18, s18, 4096
    buffer_load_dwordx4 v[56:59], v1, s[4:7], s18 offen offset:0 sc1
    buffer_load_dwordx4 v[60:63], v1, s[4:7], s18 offen offset:1024 sc1
    buffer_load_dwordx4 v[64:67], v1, s[4:7], s18 offen offset:2048 sc1
    buffer_load_dwordx4 v[68:71], v1, s[4:7], s18 offen offset:3072 sc1
    s_add_u32 s18, s18, 4096
    buffer_load_dwordx4 v[72:75], v1, s[4:7], s18 offen offset:0 sc1
    buffer_load_dwordx4 v[76:79], v1, s[4:7], s18 offen offset:1024 sc1
    buffer_load_dwordx4 v[80:83], v1, s[4:7], s18 offen offset:2048 sc1
    buffer_load_dwordx4 v[84:87], v1, s[4:7], s18 offen offset:3072 sc1
    s_add_u32 s18, s18, 4096
    buffer_load_dwordx4 v[88:91], v1, s[4:7], s18 offen offset:0 sc1
    buffer_load_dwordx4 v[92:95], v1, s[4:7], s18 offen offset:1024 sc1
    buffer_load_dwordx4 v[96:99], v1, s[4:7], s18 offen offset:2048 sc1
    buffer_load_dwordx4 v[100:103], v1, s[4:7], s18 offen offset:3072 sc1
    s_add_u32 s18, s18, 4096
    buffer_load_dwordx4 v[104:107], v1, s[4:7], s18 offen offset:0 sc1
    buffer_load_dwordx4 v[108:111], v1, s[4:7], s18 offen offset:1024 sc1
    buffer_load_dwordx4 v[112:115], v1, s[4:7], s18 offen offset:2048 sc1
    buffer_load_dwordx4 v[116:119], v1, s[4:7], s18 offen offset:3072 sc1
    s_add_u32 s18, s18, 4096
    buffer_load_dwordx4 v[120:123], v1, s[4:7], s18 offen offset:0 sc1
    buffer_load_dwordx4 v[124:127], v1, s[4:7], s18 offen offset:1024 sc1
    buffer_load_dwordx4 v[128:131], v1, s[4:7], s18 offen offset:2048 sc1
    buffer_load_dwordx4 v[132:135], v1, s[4:7], s18 offen offset:3072 sc1
    s_add_u32 s18, s18, 4096
    buffer_load_dwordx4 v[136:139], v1, s[4:7], s18 offen offset:0 sc1
    buffer_load_dwordx4 v[140:143], v1, s[4:7], s18 offen offset:1024 sc1
    buffer_load_dwordx4 v[144:147], v1, s[4:7], s18 offen offset:2048 sc1
    buffer_load_dwordx4 v[148:151], v1, s[4:7], s18 offen offset:3072 sc1
    s_add_u32 s18, s18, 102400
    buffer_load_dwordx4 v[152:155], v1, s[4:7], s18 offen offset:0 sc1
    buffer_load_dwordx4 v[156:159], v1, s[4:7], s18 offen offset:1024 sc1
    buffer_load_dwordx4 v[160:163], v1, s[4:7], s18 offen offset:2048 sc1
    buffer_load_dwordx4 v[164:167], v1, s[4:7], s18 offen offset:3072 sc1
    s_add_u32 s18, s18, 4096
    buffer_load_dwordx4 v[168:171], v1, s[4:7], s18 offen offset:0 sc1
    buffer_load_dwordx4 v[172:175], v1, s[4:7], s18 offen offset:1024 sc1
    buffer_load_dwordx4 v[176:179], v1, s[4:7], s18 offen offset:2048 sc1
    buffer_load_dwordx4 v[180:183], v1, s[4:7], s18 offen offset:3072 sc1
    s_add_u32 s18, s18, 4096
    buffer_load_dwordx4 v[184:187], v1, s[4:7], s18 offen offset:0 sc1
    buffer_load_dwordx4 v[188:191], v1, s[4:7], s18 offen offset:1024 sc1
    buffer_load_dwordx4 v[192:195], v1, s[4:7], s18 offen offset:2048 sc1
    buffer_load_dwordx4 v[196:199], v1, s[4:7], s18 offen offset:3072 sc1
    s_add_u32 s18, s18, 4096
    buffer_load_dwordx4 v[200:203], v1, s[4:7], s18 offen offset:0 sc1
    buffer_load_dwordx4 v[204:207], v1, s[4:7], s18 offen offset:1024 sc1
    buffer_load_dwordx4 v[208:211], v1, s[4:7], s18 offen offset:2048 sc1
    buffer_load_dwordx4 v[212:215], v1, s[4:7], s18 offen offset:3072 sc1
    s_add_u32 s18, s18, 4096
    buffer_load_dwordx4 v[216:219], v1, s[4:7], s18 offen offset:0 sc1
    buffer_load_dwordx4 v[220:223], v1, s[4:7], s18 offen offset:1024 sc1
    buffer_load_dwordx4 v[224:227], v1, s[4:7], s18 offen offset:2048 sc1
    buffer_load_dwordx4 v[228:231], v1, s[4:7], s18 offen offset:3072 sc1
    s_add_u32 s18, s18, 4096
    buffer_load_dwordx4 v[232:235], v1, s[4:7], s18 offen offset:0 sc1
    buffer_load_dwordx4 v[236:239], v1, s[4:7], s18 offen offset:1024 sc1
    buffer_load_dwordx4 v[240:243], v1, s[4:7], s18 offen offset:2048 sc1
    buffer_load_dwordx4 v[244:247], v1, s[4:7], s18 offen offset:3072 sc1
    v_lshlrev_b32 v2, 4, v0
    v_and_b32 v3, 3072, v2
    v_lshl_add_u32 v2, v3, 1, v1
    s_waitcnt vmcnt(55)
    v_mfma_f32_16x16x32_bf16 v[8:11], a[0:3], v[24:27], 0
    v_mfma_f32_16x16x32_bf16 v[12:15], a[4:7], v[24:27], 0
    s_add_u32 s18, s18, 4096
    buffer_load_dwordx4 v[24:27], v1, s[4:7], s18 offen offset:0 sc1
    s_waitcnt vmcnt(55)
    v_mfma_f32_16x16x32_bf16 v[8:11], a[8:11], v[28:31], v[8:11]
    v_mfma_f32_16x16x32_bf16 v[12:15], a[12:15], v[28:31], v[12:15]
    buffer_load_dwordx4 v[28:31], v1, s[4:7], s18 offen offset:1024 sc1
    s_waitcnt vmcnt(55)
    v_mfma_f32_16x16x32_bf16 v[8:11], a[16:19], v[32:35], v[8:11]
    v_mfma_f32_16x16x32_bf16 v[12:15], a[20:23], v[32:35], v[12:15]
    buffer_load_dwordx4 v[32:35], v1, s[4:7], s18 offen offset:2048 sc1
    s_waitcnt vmcnt(55)
    v_mfma_f32_16x16x32_bf16 v[8:11], a[24:27], v[36:39], v[8:11]
    v_mfma_f32_16x16x32_bf16 v[12:15], a[28:31], v[36:39], v[12:15]
    buffer_load_dwordx4 v[36:39], v1, s[4:7], s18 offen offset:3072 sc1
    s_waitcnt vmcnt(55)
    v_mfma_f32_16x16x32_bf16 v[8:11], a[32:35], v[40:43], v[8:11]
    v_mfma_f32_16x16x32_bf16 v[12:15], a[36:39], v[40:43], v[12:15]
    s_add_u32 s18, s18, 4096
    buffer_load_dwordx4 v[40:43], v1, s[4:7], s18 offen offset:0 sc1
    s_waitcnt vmcnt(55)
    v_mfma_f32_16x16x32_bf16 v[8:11], a[40:43], v[44:47], v[8:11]
    v_mfma_f32_16x16x32_bf16 v[12:15], a[44:47], v[44:47], v[12:15]
    buffer_load_dwordx4 v[44:47], v1, s[4:7], s18 offen offset:1024 sc1
    s_waitcnt vmcnt(55)
    v_mfma_f32_16x16x32_bf16 v[8:11], a[48:51], v[48:51], v[8:11]
    v_mfma_f32_16x16x32_bf16 v[12:15], a[52:55], v[48:51], v[12:15]
    buffer_load_dwordx4 v[48:51], v1, s[4:7], s18 offen offset:2048 sc1
    s_waitcnt vmcnt(55)
    v_mfma_f32_16x16x32_bf16 v[8:11], a[56:59], v[52:55], v[8:11]
    v_mfma_f32_16x16x32_bf16 v[12:15], a[60:63], v[52:55], v[12:15]
    buffer_load_dwordx4 v[52:55], v1, s[4:7], s18 offen offset:3072 sc1
    s_waitcnt vmcnt(55)
    v_mfma_f32_16x16x32_bf16 v[8:11], a[64:67], v[56:59], v[8:11]
    v_mfma_f32_16x16x32_bf16 v[12:15], a[68:71], v[56:59], v[12:15]
    s_waitcnt vmcnt(54)
    v_mfma_f32_16x16x32_bf16 v[8:11], a[72:75], v[60:63], v[8:11]
    v_mfma_f32_16x16x32_bf16 v[12:15], a[76:79], v[60:63], v[12:15]
    s_waitcnt vmcnt(53)
    v_mfma_f32_16x16x32_bf16 v[8:11], a[80:83], v[64:67], v[8:11]
    v_mfma_f32_16x16x32_bf16 v[12:15], a[84:87], v[64:67], v[12:15]
    s_waitcnt vmcnt(52)
    v_mfma_f32_16x16x32_bf16 v[8:11], a[88:91], v[68:71], v[8:11]
    v_mfma_f32_16x16x32_bf16 v[12:15], a[92:95], v[68:71], v[12:15]
    s_waitcnt vmcnt(51)
    v_mfma_f32_16x16x32_bf16 v[8:11], a[96:99], v[72:75], v[8:11]
    v_mfma_f32_16x16x32_bf16 v[12:15], a[100:103], v[72:75], v[12:15]
    s_waitcnt vmcnt(50)
    v_mfma_f32_16x16x32_bf16 v[8:11], a[104:107], v[76:79], v[8:11]
    v_mfma_f32_16x16x32_bf16 v[12:15], a[108:111], v[76:79], v[12:15]
    s_waitcnt vmcnt(49)
    v_mfma_f32_16x16x32_bf16 v[8:11], a[112:115], v[80:83], v[8:11]
    v_mfma_f32_16x16x32_bf16 v[12:15], a[116:119], v[80:83], v[12:15]
    s_waitcnt vmcnt(48)
    v_mfma_f32_16x16x32_bf16 v[8:11], a[120:123], v[84:87], v[8:11]
    v_mfma_f32_16x16x32_bf16 v[12:15], a[124:127], v[84:87], v[12:15]
    s_waitcnt vmcnt(47)
    v_mfma_f32_16x16x32_bf16 v[8:11], a[128:131], v[88:91], v[8:11]
    v_mfma_f32_16x16x32_bf16 v[12:15], a[132:135], v[88:91], v[12:15]
    s_waitcnt vmcnt(46)
    v_mfma_f32_16x16x32_bf16 v[8:11], a[136:139], v[92:95], v[8:11]
    v_mfma_f32_16x16x32_bf16 v[12:15], a[140:143], v[92:95], v[12:15]
    s_waitcnt vmcnt(45)
    v_mfma_f32_16x16x32_bf16 v[8:11], a[144:147], v[96:99], v[8:11]
    v_mfma_f32_16x16x32_bf16 v[12:15], a[148:151], v[96:99], v[12:15]
    s_waitcnt vmcnt(44)
    v_mfma_f32_16x16x32_bf16 v[8:11], a[152:155], v[100:103], v[8:11]
    v_mfma_f32_16x16x32_bf16 v[12:15], a[156:159], v[100:103], v[12:15]
    s_waitcnt vmcnt(43)
    v_mfma_f32_16x16x32_bf16 v[8:11], a[160:163], v[104:107], v[8:11]
    v_mfma_f32_16x16x32_bf16 v[12:15], a[164:167], v[104:107], v[12:15]
    s_waitcnt vmcnt(42)
    v_mfma_f32_16x16x32_bf16 v[8:11], a[168:171], v[108:111], v[8:11]
    v_mfma_f32_16x16x32_bf16 v[12:15], a[172:175], v[108:111], v[12:15]
    s_waitcnt vmcnt(41)
    v_mfma_f32_16x16x32_bf16 v[8:11], a[176:179], v[112:115], v[8:11]
    v_mfma_f32_16x16x32_bf16 v[12:15], a[180:183], v[112:115], v[12:15]
    s_waitcnt vmcnt(40)
    v_mfma_f32_16x16x32_bf16 v[8:11], a[184:187], v[116:119], v[8:11]
    v_mfma_f32_16x16x32_bf16 v[12:15], a[188:191], v[116:119], v[12:15]
    s_waitcnt vmcnt(39)
    v_mfma_f32_16x16x32_bf16 v[8:11], a[192:195], v[120:123], v[8:11]
    v_mfma_f32_16x16x32_bf16 v[12:15], a[196:199], v[120:123], v[12:15]
    s_waitcnt vmcnt(38)
    v_mfma_f32_16x16x32_bf16 v[8:11], a[200:203], v[124:127], v[8:11]
    v_mfma_f32_16x16x32_bf16 v[12:15], a[204:207], v[124:127], v[12:15]
    s_waitcnt vmcnt(37)
    v_mfma_f32_16x16x32_bf16 v[8:11], a[208:211], v[128:131], v[8:11]
    v_mfma_f32_16x16x32_bf16 v[12:15], a[212:215], v[128:131], v[12:15]
    s_waitcnt vmcnt(36)
    v_mfma_f32_16x16x32_bf16 v[8:11], a[216:219], v[132:135], v[8:11]
    v_mfma_f32_16x16x32_bf16 v[12:15], a[220:223], v[132:135], v[12:15]
    s_waitcnt vmcnt(35)
    v_mfma_f32_16x16x32_bf16 v[8:11], a[224:227], v[136:139], v[8:11]
    v_mfma_f32_16x16x32_bf16 v[12:15], a[228:231], v[136:139], v[12:15]
    s_waitcnt vmcnt(34)
    v_mfma_f32_16x16x32_bf16 v[8:11], a[232:235], v[140:143], v[8:11]
    v_mfma_f32_16x16x32_bf16 v[12:15], a[236:239], v[140:143], v[12:15]
    s_waitcnt vmcnt(33)
    v_mfma_f32_16x16x32_bf16 v[8:11], a[240:243], v[144:147], v[8:11]
    v_mfma_f32_16x16x32_bf16 v[12:15], a[244:247], v[144:147], v[12:15]
    s_waitcnt vmcnt(32)
    v_mfma_f32_16x16x32_bf16 v[8:11], a[248:251], v[148:151], v[8:11]
    v_mfma_f32_16x16x32_bf16 v[12:15], a[252:255], v[148:151], v[12:15]
    s_waitcnt vmcnt(31)
    v_mfma_f32_16x16x32_bf16 v[16:19], a[0:3], v[152:155], 0
    v_mfma_f32_16x16x32_bf16 v[20:23], a[4:7], v[152:155], 0
    s_waitcnt vmcnt(30)
    v_mfma_f32_16x16x32_bf16 v[16:19], a[8:11], v[156:159], v[16:19]
    v_mfma_f32_16x16x32_bf16 v[20:23], a[12:15], v[156:159], v[20:23]
    s_waitcnt vmcnt(29)
    v_mfma_f32_16x16x32_bf16 v[16:19], a[16:19], v[160:163], v[16:19]
    v_mfma_f32_16x16x32_bf16 v[20:23], a[20:23], v[160:163], v[20:23]
    s_waitcnt vmcnt(28)
    v_mfma_f32_16x16x32_bf16 v[16:19], a[24:27], v[164:167], v[16:19]
    v_mfma_f32_16x16x32_bf16 v[20:23], a[28:31], v[164:167], v[20:23]
    s_waitcnt vmcnt(27)
    v_mfma_f32_16x16x32_bf16 v[16:19], a[32:35], v[168:171], v[16:19]
    v_mfma_f32_16x16x32_bf16 v[20:23], a[36:39], v[168:171], v[20:23]
    s_waitcnt vmcnt(26)
    v_mfma_f32_16x16x32_bf16 v[16:19], a[40:43], v[172:175], v[16:19]
    v_mfma_f32_16x16x32_bf16 v[20:23], a[44:47], v[172:175], v[20:23]
    s_waitcnt vmcnt(25)
    v_mfma_f32_16x16x32_bf16 v[16:19], a[48:51], v[176:179], v[16:19]
    v_mfma_f32_16x16x32_bf16 v[20:23], a[52:55], v[176:179], v[20:23]
    s_waitcnt vmcnt(24)
    v_mfma_f32_16x16x32_bf16 v[16:19], a[56:59], v[180:183], v[16:19]
    v_mfma_f32_16x16x32_bf16 v[20:23], a[60:63], v[180:183], v[20:23]
    s_waitcnt vmcnt(23)
    v_mfma_f32_16x16x32_bf16 v[16:19], a[64:67], v[184:187], v[16:19]
    v_mfma_f32_16x16x32_bf16 v[20:23], a[68:71], v[184:187], v[20:23]
    s_waitcnt vmcnt(22)
    v_mfma_f32_16x16x32_bf16 v[16:19], a[72:75], v[188:191], v[16:19]
    v_mfma_f32_16x16x32_bf16 v[20:23], a[76:79], v[188:191], v[20:23]
    s_waitcnt vmcnt(21)
    v_mfma_f32_16x16x32_bf16 v[16:19], a[80:83], v[192:195], v[16:19]
    v_mfma_f32_16x16x32_bf16 v[20:23], a[84:87], v[192:195], v[20:23]
    s_waitcnt vmcnt(20)
    v_mfma_f32_16x16x32_bf16 v[16:19], a[88:91], v[196:199], v[16:19]
    v_mfma_f32_16x16x32_bf16 v[20:23], a[92:95], v[196:199], v[20:23]
    s_waitcnt vmcnt(19)
    v_mfma_f32_16x16x32_bf16 v[16:19], a[96:99], v[200:203], v[16:19]
    v_mfma_f32_16x16x32_bf16 v[20:23], a[100:103], v[200:203], v[20:23]
    s_waitcnt vmcnt(18)
    v_mfma_f32_16x16x32_bf16 v[16:19], a[104:107], v[204:207], v[16:19]
    v_mfma_f32_16x16x32_bf16 v[20:23], a[108:111], v[204:207], v[20:23]
    s_waitcnt vmcnt(17)
    v_mfma_f32_16x16x32_bf16 v[16:19], a[112:115], v[208:211], v[16:19]
    v_mfma_f32_16x16x32_bf16 v[20:23], a[116:119], v[208:211], v[20:23]
    s_waitcnt vmcnt(16)
    v_mfma_f32_16x16x32_bf16 v[16:19], a[120:123], v[212:215], v[16:19]
    v_mfma_f32_16x16x32_bf16 v[20:23], a[124:127], v[212:215], v[20:23]
    s_waitcnt vmcnt(15)
    v_mfma_f32_16x16x32_bf16 v[16:19], a[128:131], v[216:219], v[16:19]
    v_mfma_f32_16x16x32_bf16 v[20:23], a[132:135], v[216:219], v[20:23]
    s_waitcnt vmcnt(14)
    v_mfma_f32_16x16x32_bf16 v[16:19], a[136:139], v[220:223], v[16:19]
    v_mfma_f32_16x16x32_bf16 v[20:23], a[140:143], v[220:223], v[20:23]
    s_waitcnt vmcnt(13)
    v_mfma_f32_16x16x32_bf16 v[16:19], a[144:147], v[224:227], v[16:19]
    v_mfma_f32_16x16x32_bf16 v[20:23], a[148:151], v[224:227], v[20:23]
    s_waitcnt vmcnt(12)
    v_mfma_f32_16x16x32_bf16 v[16:19], a[152:155], v[228:231], v[16:19]
    v_mfma_f32_16x16x32_bf16 v[20:23], a[156:159], v[228:231], v[20:23]
    s_waitcnt vmcnt(11)
    v_mfma_f32_16x16x32_bf16 v[16:19], a[160:163], v[232:235], v[16:19]
    v_mfma_f32_16x16x32_bf16 v[20:23], a[164:167], v[232:235], v[20:23]
    s_waitcnt vmcnt(10)
    v_mfma_f32_16x16x32_bf16 v[16:19], a[168:171], v[236:239], v[16:19]
    v_mfma_f32_16x16x32_bf16 v[20:23], a[172:175], v[236:239], v[20:23]
    s_waitcnt vmcnt(9)
    v_mfma_f32_16x16x32_bf16 v[16:19], a[176:179], v[240:243], v[16:19]
    v_mfma_f32_16x16x32_bf16 v[20:23], a[180:183], v[240:243], v[20:23]
    s_waitcnt vmcnt(8)
    v_mfma_f32_16x16x32_bf16 v[16:19], a[184:187], v[244:247], v[16:19]
    v_mfma_f32_16x16x32_bf16 v[20:23], a[188:191], v[244:247], v[20:23]
    s_waitcnt vmcnt(7)
    v_mfma_f32_16x16x32_bf16 v[16:19], a[192:195], v[24:27], v[16:19]
    v_mfma_f32_16x16x32_bf16 v[20:23], a[196:199], v[24:27], v[20:23]
    s_waitcnt vmcnt(6)
    v_mfma_f32_16x16x32_bf16 v[16:19], a[200:203], v[28:31], v[16:19]
    v_mfma_f32_16x16x32_bf16 v[20:23], a[204:207], v[28:31], v[20:23]
    s_waitcnt vmcnt(5)
    v_mfma_f32_16x16x32_bf16 v[16:19], a[208:211], v[32:35], v[16:19]
    v_mfma_f32_16x16x32_bf16 v[20:23], a[212:215], v[32:35], v[20:23]
    s_waitcnt vmcnt(4)
    v_mfma_f32_16x16x32_bf16 v[16:19], a[216:219], v[36:39], v[16:19]
    v_mfma_f32_16x16x32_bf16 v[20:23], a[220:223], v[36:39], v[20:23]
    s_waitcnt vmcnt(3)
    v_mfma_f32_16x16x32_bf16 v[16:19], a[224:227], v[40:43], v[16:19]
    v_mfma_f32_16x16x32_bf16 v[20:23], a[228:231], v[40:43], v[20:23]
    s_waitcnt vmcnt(2)
    v_mfma_f32_16x16x32_bf16 v[16:19], a[232:235], v[44:47], v[16:19]
    v_mfma_f32_16x16x32_bf16 v[20:23], a[236:239], v[44:47], v[20:23]
    s_waitcnt vmcnt(1)
    v_mfma_f32_16x16x32_bf16 v[16:19], a[240:243], v[48:51], v[16:19]
    v_mfma_f32_16x16x32_bf16 v[20:23], a[244:247], v[48:51], v[20:23]
    s_waitcnt vmcnt(0)
    v_mfma_f32_16x16x32_bf16 v[16:19], a[248:251], v[52:55], v[16:19]
    v_mfma_f32_16x16x32_bf16 v[20:23], a[252:255], v[52:55], v[20:23]
    ds_write_b128 v2, v[8:11] offset:0
    ds_write_b128 v2, v[12:15] offset:1024
    s_nop 4
    ds_write_b128 v2, v[16:19] offset:8192
    ds_write_b128 v2, v[20:23] offset:9216
    s_cmp_lg_u32 s32, 0
    s_cbranch_scc1 o2_nb
    v_cmp_eq_u32 vcc, 0, v253
    s_nop 0
    s_cmp_eq_u64 vcc, 0
    s_cselect_b32 s44, 65536, 0
    v_or_b32 v250, s44, v250
    v_mov_b32 v251, 163832
    s_mov_b64 exec, 1
    ds_write_b32 v251, v250
    s_mov_b64 exec, -1
o2_nb:
    s_waitcnt lgkmcnt(0)
    s_barrier
    s_cmp_gt_u32 s32, 1
    s_cbranch_scc1 o2_skip
    s_lshl_b32 s18, s32, 13
    v_add_u32 v2, s18, v1
    ds_read_b128 v[24:27], v2 offset:0
    ds_read_b128 v[28:31], v2 offset:1024
    ds_read_b128 v[32:35], v2 offset:2048
    ds_read_b128 v[36:39], v2 offset:3072
    ds_read_b128 v[40:43], v2 offset:4096
    ds_read_b128 v[44:47], v2 offset:5120
    ds_read_b128 v[48:51], v2 offset:6144
    ds_read_b128 v[52:55], v2 offset:7168
    v_lshrrev_b32 v3, 4, v1
    v_bfe_u32 v4, v3, 2, 2
    v_lshlrev_b32 v4, 3, v4
    v_and_b32 v2, 3, v3
    v_add_u32 v4, v4, v2
    v_mul_u32_u24 v4, 2304, v4
    v_lshrrev_b32 v3, 4, v3
    v_lshl_add_u32 v4, v3, 4, v4
    s_add_u32 s20, s16, s32
    s_lshr_b32 s18, s20, 1
    s_lshl_b32 s18, s18, 3
    s_and_b32 s19, s20, 1
    s_add_u32 s18, s18, s19
    s_mul_i32 s18, s18, 9216
    s_lshl_b32 s19, s33, 6
    s_add_u32 s18, s18, s19
    s_waitcnt lgkmcnt(0)
    v_pk_add_f32 v[24:25], v[24:25], v[32:33]
    v_pk_add_f32 v[40:41], v[40:41], v[48:49]
    v_pk_add_f32 v[24:25], v[24:25], v[40:41]
    v_pk_add_f32 v[26:27], v[26:27], v[34:35]
    v_pk_add_f32 v[42:43], v[42:43], v[50:51]
    v_pk_add_f32 v[26:27], v[26:27], v[42:43]
    v_pk_add_f32 v[28:29], v[28:29], v[36:37]
    v_pk_add_f32 v[44:45], v[44:45], v[52:53]
    v_pk_add_f32 v[28:29], v[28:29], v[44:45]
    v_pk_add_f32 v[30:31], v[30:31], v[38:39]
    v_pk_add_f32 v[46:47], v[46:47], v[54:55]
    v_pk_add_f32 v[30:31], v[30:31], v[46:47]
    v_cvt_pk_bf16_f32 v8, v24, v28
    v_cvt_pk_bf16_f32 v9, v25, v29
    v_cvt_pk_bf16_f32 v10, v26, v30
    v_cvt_pk_bf16_f32 v11, v27, v31
    buffer_store_dwordx4 v[8:11], v4, s[8:11], s18 offen
o2_skip:
    s_nop 1
    s_branch L_op_fin
L_op_one:
o1_again:
    s_lshl_b32 s18, s16, 17
    s_lshl_b32 s19, s32, 15
    s_add_u32 s18, s18, s19
    s_add_u32 s18, s18, 50331648
    buffer_load_dwordx4 v[24:27], v1, s[4:7], s18 offen offset:0 sc1
    buffer_load_dwordx4 v[28:31], v1, s[4:7], s18 offen offset:1024 sc1
    buffer_load_dwordx4 v[32:35], v1, s[4:7], s18 offen offset:2048 sc1
    buffer_load_dwordx4 v[36:39], v1, s[4:7], s18 offen offset:3072 sc1
    s_add_u32 s18, s18, 4096
    buffer_load_dwordx4 v[40:43], v1, s[4:7], s18 offen offset:0 sc1
    buffer_load_dwordx4 v[44:47], v1, s[4:7], s18 offen offset:1024 sc1
    buffer_load_dwordx4 v[48:51], v1, s[4:7], s18 offen offset:2048 sc1
    buffer_load_dwordx4 v[52:55], v1, s[4:7], s18 offen offset:3072 sc1
    s_add_u32 s18, s18, 4096
    buffer_load_dwordx4 v[56:59], v1, s[4:7], s18 offen offset:0 sc1
    buffer_load_dwordx4 v[60:63], v1, s[4:7], s18 offen offset:1024 sc1
    buffer_load_dwordx4 v[64:67], v1, s[4:7], s18 offen offset:2048 sc1
    buffer_load_dwordx4 v[68:71], v1, s[4:7], s18 offen offset:3072 sc1
    s_add_u32 s18, s18, 4096
    buffer_load_dwordx4 v[72:75], v1, s[4:7], s18 offen offset:0 sc1
    buffer_load_dwordx4 v[76:79], v1, s[4:7], s18 offen offset:1024 sc1
    buffer_load_dwordx4 v[80:83], v1, s[4:7], s18 offen offset:2048 sc1
    buffer_load_dwordx4 v[84:87], v1, s[4:7], s18 offen offset:3072 sc1
    s_add_u32 s18, s18, 4096
    buffer_load_dwordx4 v[88:91], v1, s[4:7], s18 offen offset:0 sc1
    buffer_load_dwordx4 v[92:95], v1, s[4:7], s18 offen offset:1024 sc1
    buffer_load_dwordx4 v[96:99], v1, s[4:7], s18 offen offset:2048 sc1
    buffer_load_dwordx4 v[100:103], v1, s[4:7], s18 offen offset:3072 sc1
    s_add_u32 s18, s18, 4096
    buffer_load_dwordx4 v[104:107], v1, s[4:7], s18 offen offset:0 sc1
    buffer_load_dwordx4 v[108:111], v1, s[4:7], s18 offen offset:1024 sc1
    buffer_load_dwordx4 v[112:115], v1, s[4:7], s18 offen offset:2048 sc1
    buffer_load_dwordx4 v[116:119], v1, s[4:7], s18 offen offset:3072 sc1
    s_add_u32 s18, s18, 4096
    buffer_load_dwordx4 v[120:123], v1, s[4:7], s18 offen offset:0 sc1
    buffer_load_dwordx4 v[124:127], v1, s[4:7], s18 offen offset:1024 sc1
    buffer_load_dwordx4 v[128:131], v1, s[4:7], s18 offen offset:2048 sc1
    buffer_load_dwordx4 v[132:135], v1, s[4:7], s18 offen offset:3072 sc1
    s_add_u32 s18, s18, 4096
    buffer_load_dwordx4 v[136:139], v1, s[4:7], s18 offen offset:0 sc1
    buffer_load_dwordx4 v[140:143], v1, s[4:7], s18 offen offset:1024 sc1
    buffer_load_dwordx4 v[144:147], v1, s[4:7], s18 offen offset:2048 sc1
    buffer_load_dwordx4 v[148:151], v1, s[4:7], s18 offen offset:3072 sc1
    v_lshlrev_b32 v2, 4, v0
    v_and_b32 v3, 3072, v2
    v_lshl_add_u32 v2, v3, 1, v1
    s_waitcnt vmcnt(31)
    v_mfma_f32_16x16x32_bf16 v[8:11], a[0:3], v[24:27], 0
    v_max_u32 v6, v24, v25
    v_mfma_f32_16x16x32_bf16 v[12:15], a[4:7], v[24:27], 0
    v_max3_u32 v6, v6, v26, v27
    s_waitcnt vmcnt(30)
    v_mfma_f32_16x16x32_bf16 v[8:11], a[8:11], v[28:31], v[8:11]
    v_max3_u32 v6, v6, v28, v29
    v_mfma_f32_16x16x32_bf16 v[12:15], a[12:15], v[28:31], v[12:15]
    v_max3_u32 v6, v6, v30, v31
    s_waitcnt vmcnt(29)
    v_mfma_f32_16x16x32_bf16 v[8:11], a[16:19], v[32:35], v[8:11]
    v_max3_u32 v6, v6, v32, v33
    v_mfma_f32_16x16x32_bf16 v[12:15], a[20:23], v[32:35], v[12:15]
    v_max3_u32 v6, v6, v34, v35
    s_waitcnt vmcnt(28)
    v_mfma_f32_16x16x32_bf16 v[8:11], a[24:27], v[36:39], v[8:11]
    v_max3_u32 v6, v6, v36, v37
    v_mfma_f32_16x16x32_bf16 v[12:15], a[28:31], v[36:39], v[12:15]
    v_max3_u32 v6, v6, v38, v39
    s_waitcnt vmcnt(27)
    v_mfma_f32_16x16x32_bf16 v[8:11], a[32:35], v[40:43], v[8:11]
    v_max3_u32 v6, v6, v40, v41
    v_mfma_f32_16x16x32_bf16 v[12:15], a[36:39], v[40:43], v[12:15]
    v_max3_u32 v6, v6, v42, v43
    s_waitcnt vmcnt(26)
    v_mfma_f32_16x16x32_bf16 v[8:11], a[40:43], v[44:47], v[8:11]
    v_max3_u32 v6, v6, v44, v45
    v_mfma_f32_16x16x32_bf16 v[12:15], a[44:47], v[44:47], v[12:15]
    v_max3_u32 v6, v6, v46, v47
    s_waitcnt vmcnt(25)
    v_mfma_f32_16x16x32_bf16 v[8:11], a[48:51], v[48:51], v[8:11]
    v_max3_u32 v6, v6, v48, v49
    v_mfma_f32_16x16x32_bf16 v[12:15], a[52:55], v[48:51], v[12:15]
    v_max3_u32 v6, v6, v50, v51
    s_waitcnt vmcnt(24)
    v_mfma_f32_16x16x32_bf16 v[8:11], a[56:59], v[52:55], v[8:11]
    v_max3_u32 v6, v6, v52, v53
    v_mfma_f32_16x16x32_bf16 v[12:15], a[60:63], v[52:55], v[12:15]
    v_max3_u32 v6, v6, v54, v55
    s_waitcnt vmcnt(23)
    v_mfma_f32_16x16x32_bf16 v[8:11], a[64:67], v[56:59], v[8:11]
    v_max3_u32 v6, v6, v56, v57
    v_mfma_f32_16x16x32_bf16 v[12:15], a[68:71], v[56:59], v[12:15]
    v_max3_u32 v6, v6, v58, v59
    s_waitcnt vmcnt(22)
    v_mfma_f32_16x16x32_bf16 v[8:11], a[72:75], v[60:63], v[8:11]
    v_max3_u32 v6, v6, v60, v61
    v_mfma_f32_16x16x32_bf16 v[12:15], a[76:79], v[60:63], v[12:15]
    v_max3_u32 v6, v6, v62, v63
    s_waitcnt vmcnt(21)
    v_mfma_f32_16x16x32_bf16 v[8:11], a[80:83], v[64:67], v[8:11]
    v_max3_u32 v6, v6, v64, v65
    v_mfma_f32_16x16x32_bf16 v[12:15], a[84:87], v[64:67], v[12:15]
    v_max3_u32 v6, v6, v66, v67
    s_waitcnt vmcnt(20)
    v_mfma_f32_16x16x32_bf16 v[8:11], a[88:91], v[68:71], v[8:11]
    v_max3_u32 v6, v6, v68, v69
    v_mfma_f32_16x16x32_bf16 v[12:15], a[92:95], v[68:71], v[12:15]
    v_max3_u32 v6, v6, v70, v71
    s_waitcnt vmcnt(19)
    v_mfma_f32_16x16x32_bf16 v[8:11], a[96:99], v[72:75], v[8:11]
    v_max3_u32 v6, v6, v72, v73
    v_mfma_f32_16x16x32_bf16 v[12:15], a[100:103], v[72:75], v[12:15]
    v_max3_u32 v6, v6, v74, v75
    s_waitcnt vmcnt(18)
    v_mfma_f32_16x16x32_bf16 v[8:11], a[104:107], v[76:79], v[8:11]
    v_max3_u32 v6, v6, v76, v77
    v_mfma_f32_16x16x32_bf16 v[12:15], a[108:111], v[76:79], v[12:15]
    v_max3_u32 v6, v6, v78, v79
    s_waitcnt vmcnt(17)
    v_mfma_f32_16x16x32_bf16 v[8:11], a[112:115], v[80:83], v[8:11]
    v_max3_u32 v6, v6, v80, v81
    v_mfma_f32_16x16x32_bf16 v[12:15], a[116:119], v[80:83], v[12:15]
    v_max3_u32 v6, v6, v82, v83
    s_waitcnt vmcnt(16)
    v_mfma_f32_16x16x32_bf16 v[8:11], a[120:123], v[84:87], v[8:11]
    v_max3_u32 v6, v6, v84, v85
    v_mfma_f32_16x16x32_bf16 v[12:15], a[124:127], v[84:87], v[12:15]
    v_max3_u32 v6, v6, v86, v87
    s_waitcnt vmcnt(15)
    v_mfma_f32_16x16x32_bf16 v[8:11], a[128:131], v[88:91], v[8:11]
    v_max3_u32 v6, v6, v88, v89
    v_mfma_f32_16x16x32_bf16 v[12:15], a[132:135], v[88:91], v[12:15]
    v_max3_u32 v6, v6, v90, v91
    s_waitcnt vmcnt(14)
    v_mfma_f32_16x16x32_bf16 v[8:11], a[136:139], v[92:95], v[8:11]
    v_max3_u32 v6, v6, v92, v93
    v_mfma_f32_16x16x32_bf16 v[12:15], a[140:143], v[92:95], v[12:15]
    v_max3_u32 v6, v6, v94, v95
    s_waitcnt vmcnt(13)
    v_mfma_f32_16x16x32_bf16 v[8:11], a[144:147], v[96:99], v[8:11]
    v_max3_u32 v6, v6, v96, v97
    v_mfma_f32_16x16x32_bf16 v[12:15], a[148:151], v[96:99], v[12:15]
    v_max3_u32 v6, v6, v98, v99
    s_waitcnt vmcnt(12)
    v_mfma_f32_16x16x32_bf16 v[8:11], a[152:155], v[100:103], v[8:11]
    v_max3_u32 v6, v6, v100, v101
    v_mfma_f32_16x16x32_bf16 v[12:15], a[156:159], v[100:103], v[12:15]
    v_max3_u32 v6, v6, v102, v103
    s_waitcnt vmcnt(11)
    v_mfma_f32_16x16x32_bf16 v[8:11], a[160:163], v[104:107], v[8:11]
    v_max3_u32 v6, v6, v104, v105
    v_mfma_f32_16x16x32_bf16 v[12:15], a[164:167], v[104:107], v[12:15]
    v_max3_u32 v6, v6, v106, v107
    s_waitcnt vmcnt(10)
    v_mfma_f32_16x16x32_bf16 v[8:11], a[168:171], v[108:111], v[8:11]
    v_max3_u32 v6, v6, v108, v109
    v_mfma_f32_16x16x32_bf16 v[12:15], a[172:175], v[108:111], v[12:15]
    v_max3_u32 v6, v6, v110, v111
    s_waitcnt vmcnt(9)
    v_mfma_f32_16x16x32_bf16 v[8:11], a[176:179], v[112:115], v[8:11]
    v_max3_u32 v6, v6, v112, v113
    v_mfma_f32_16x16x32_bf16 v[12:15], a[180:183], v[112:115], v[12:15]
    v_max3_u32 v6, v6, v114, v115
    s_waitcnt vmcnt(8)
    v_mfma_f32_16x16x32_bf16 v[8:11], a[184:187], v[116:119], v[8:11]
    v_max3_u32 v6, v6, v116, v117
    v_mfma_f32_16x16x32_bf16 v[12:15], a[188:191], v[116:119], v[12:15]
    v_max3_u32 v6, v6, v118, v119
    s_waitcnt vmcnt(7)
    v_mfma_f32_16x16x32_bf16 v[8:11], a[192:195], v[120:123], v[8:11]
    v_max3_u32 v6, v6, v120, v121
    v_mfma_f32_16x16x32_bf16 v[12:15], a[196:199], v[120:123], v[12:15]
    v_max3_u32 v6, v6, v122, v123
    s_waitcnt vmcnt(6)
    v_mfma_f32_16x16x32_bf16 v[8:11], a[200:203], v[124:127], v[8:11]
    v_max3_u32 v6, v6, v124, v125
    v_mfma_f32_16x16x32_bf16 v[12:15], a[204:207], v[124:127], v[12:15]
    v_max3_u32 v6, v6, v126, v127
    s_waitcnt vmcnt(5)
    v_mfma_f32_16x16x32_bf16 v[8:11], a[208:211], v[128:131], v[8:11]
    v_max3_u32 v6, v6, v128, v129
    v_mfma_f32_16x16x32_bf16 v[12:15], a[212:215], v[128:131], v[12:15]
    v_max3_u32 v6, v6, v130, v131
    s_waitcnt vmcnt(4)
    v_mfma_f32_16x16x32_bf16 v[8:11], a[216:219], v[132:135], v[8:11]
    v_max3_u32 v6, v6, v132, v133
    v_mfma_f32_16x16x32_bf16 v[12:15], a[220:223], v[132:135], v[12:15]
    v_max3_u32 v6, v6, v134, v135
    s_waitcnt vmcnt(3)
    v_mfma_f32_16x16x32_bf16 v[8:11], a[224:227], v[136:139], v[8:11]
    v_max3_u32 v6, v6, v136, v137
    v_mfma_f32_16x16x32_bf16 v[12:15], a[228:231], v[136:139], v[12:15]
    v_max3_u32 v6, v6, v138, v139
    s_waitcnt vmcnt(2)
    v_mfma_f32_16x16x32_bf16 v[8:11], a[232:235], v[140:143], v[8:11]
    v_max3_u32 v6, v6, v140, v141
    v_mfma_f32_16x16x32_bf16 v[12:15], a[236:239], v[140:143], v[12:15]
    v_max3_u32 v6, v6, v142, v143
    s_waitcnt vmcnt(1)
    v_mfma_f32_16x16x32_bf16 v[8:11], a[240:243], v[144:147], v[8:11]
    v_max3_u32 v6, v6, v144, v145
    v_mfma_f32_16x16x32_bf16 v[12:15], a[244:247], v[144:147], v[12:15]
    v_max3_u32 v6, v6, v146, v147
    s_waitcnt vmcnt(0)
    v_mfma_f32_16x16x32_bf16 v[8:11], a[248:251], v[148:151], v[8:11]
    v_max3_u32 v6, v6, v148, v149
    v_mfma_f32_16x16x32_bf16 v[12:15], a[252:255], v[148:151], v[12:15]
    v_max3_u32 v6, v6, v150, v151
    v_cmp_eq_u32 vcc, -1, v6
    s_cbranch_vccz o1_ok
    s_cmp_eq_u32 s46, 0
    s_cbranch_scc1 o1_ok
    s_mov_b32 s46, 0
    s_nop 1
    v_mbcnt_lo_u32_b32 v2, -1, 0
    v_mbcnt_hi_u32_b32 v2, -1, v2
    v_min_u32 v2, 1, v2
    v_lshlrev_b32 v2, 2, v2
    s_mov_b32 s88, 4194304
fw24:
    buffer_load_dword v3, v2, s[4:7], s89 offen offset:0 sc1
    s_sub_u32 s88, s88, 1
    s_cbranch_scc1 fw24x
    s_waitcnt vmcnt(0)
    v_cmp_ne_u32 vcc, s95, v3
    s_cbranch_vccz fw24x
    s_sleep 1
    s_branch fw24
fw24x:
    s_branch o1_again
o1_ok:
    s_nop 7
    ds_write_b128 v2, v[8:11] offset:0
    ds_write_b128 v2, v[12:15] offset:1024
    s_cmp_lg_u32 s32, 0
    s_cbranch_scc1 o1_nb
    v_cmp_eq_u32 vcc, 0, v253
    s_nop 0
    s_cmp_eq_u64 vcc, 0
    s_cselect_b32 s44, 65536, 0
    v_or_b32 v250, s44, v250
    v_mov_b32 v251, 163832
    s_mov_b64 exec, 1
    ds_write_b32 v251, v250
    s_mov_b64 exec, -1
o1_nb:
    s_waitcnt lgkmcnt(0)
    s_barrier
    s_cmp_gt_u32 s32, 0
    s_cbranch_scc1 o1_skip
    s_lshl_b32 s18, s32, 13
    v_add_u32 v2, s18, v1
    ds_read_b128 v[24:27], v2 offset:0
    ds_read_b128 v[28:31], v2 offset:1024
    ds_read_b128 v[32:35], v2 offset:2048
    ds_read_b128 v[36:39], v2 offset:3072
    ds_read_b128 v[40:43], v2 offset:4096
    ds_read_b128 v[44:47], v2 offset:5120
    ds_read_b128 v[48:51], v2 offset:6144
    ds_read_b128 v[52:55], v2 offset:7168
    v_lshrrev_b32 v3, 4, v1
    v_bfe_u32 v4, v3, 2, 2
    v_lshlrev_b32 v4, 3, v4
    v_and_b32 v2, 3, v3
    v_add_u32 v4, v4, v2
    v_mul_u32_u24 v4, 2304, v4
    v_lshrrev_b32 v3, 4, v3
    v_lshl_add_u32 v4, v3, 4, v4
    s_add_u32 s20, s16, s32
    s_lshr_b32 s18, s20, 1
    s_lshl_b32 s18, s18, 3
    s_and_b32 s19, s20, 1
    s_add_u32 s18, s18, s19
    s_mul_i32 s18, s18, 9216
    s_lshl_b32 s19, s33, 6
    s_add_u32 s18, s18, s19
    s_waitcnt lgkmcnt(0)
    v_pk_add_f32 v[24:25], v[24:25], v[32:33]
    v_pk_add_f32 v[40:41], v[40:41], v[48:49]
    v_pk_add_f32 v[24:25], v[24:25], v[40:41]
    v_pk_add_f32 v[26:27], v[26:27], v[34:35]
    v_pk_add_f32 v[42:43], v[42:43], v[50:51]
    v_pk_add_f32 v[26:27], v[26:27], v[42:43]
    v_pk_add_f32 v[28:29], v[28:29], v[36:37]
    v_pk_add_f32 v[44:45], v[44:45], v[52:53]
    v_pk_add_f32 v[28:29], v[28:29], v[44:45]
    v_pk_add_f32 v[30:31], v[30:31], v[38:39]
    v_pk_add_f32 v[46:47], v[46:47], v[54:55]
    v_pk_add_f32 v[30:31], v[30:31], v[46:47]
    v_cvt_pk_bf16_f32 v8, v24, v28
    v_cvt_pk_bf16_f32 v9, v25, v29
    v_cvt_pk_bf16_f32 v10, v26, v30
    v_cvt_pk_bf16_f32 v11, v27, v31
    buffer_store_dwordx4 v[8:11], v4, s[8:11], s18 offen
o1_skip:
    s_nop 1
L_op_fin:
    v_mov_b32 v251, 163832
    ds_read_b32 v252, v251
    s_waitcnt lgkmcnt(0)
    v_readfirstlane_b32 s40, v252
    s_nop 1
    s_cmp_ge_u32 s40, 65608
    s_cbranch_scc1 L_done
    s_barrier
    s_and_b32 s16, s40, 0xffff
    s_cmp_lt_u32 s16, 72
    s_cbranch_scc1 L_op_seg
L_op_nextcb:
    s_mov_b32 s40, -1
    s_cmp_lg_u32 s32, 0
    s_cbranch_scc1 L_op_dec
    v_and_b32 v1, 63, v0
    v_min_u32 v1, 17, v1
    v_lshlrev_b32 v2, 2, v1
    buffer_load_dword v3, v2, s[84:87], 0 offen offset:136 sc1
    s_waitcnt vmcnt(0)
    v_cmp_gt_u32 vcc, 52, v3
    s_nop 0
    s_and_b32 s40, vcc_lo, 262143
    s_lshl_b32 s41, s40, 18
    s_lshr_b32 s43, s40, 14
    s_or_b32 s42, s40, s41
    s_and_b32 s36, s45, 15
    s_bfm_b32 s37, s36, 0
    s_and_b32 s37, s37, 42315
    s_bcnt1_i32_b32 s37, s37
    s_lshr_b32 s36, s45, 4
    s_mul_i32 s36, s36, 8
    s_add_u32 s36, s36, s37
    s_add_u32 s36, s36, 38
    s_mul_hi_u32 s41, s36, 0x0e38e38f
    s_mul_i32 s41, s41, 18
    s_sub_u32 s41, s36, s41
    s_lshr_b64 s[42:43], s[42:43], s41
    s_ff1_i32_b64 s40, s[42:43]
    s_cmp_lt_i32 s40, 0
    s_cbranch_scc1 L_op_dec
    s_add_u32 s40, s40, s41
    s_sub_u32 s41, s40, 18
    s_cselect_b32 s40, s40, s41
L_op_dec:
    v_mov_b32 v250, s40
    v_mov_b32 v251, 163832
    s_cmp_lg_u32 s32, 0
    s_cbranch_scc1 L_op_nw
    ds_write_b32 v251, v250
    s_waitcnt lgkmcnt(0)
L_op_nw:
    s_barrier
    ds_read_b32 v252, v251
    s_waitcnt lgkmcnt(0)
    v_readfirstlane_b32 s33, v252
    s_barrier
    s_nop 1
    s_cmp_lt_u32 s33, 18
    s_cbranch_scc1 L_op_start
L_done:
L_exit:
    s_endpgm
.section .rodata,"a"
.p2align 6
.amdhsa_kernel concat_heads__memory_aug_recurrent_mem_tr__ssm_conv_s4d__prompt_kernel
  .amdhsa_next_free_vgpr 512
  .amdhsa_next_free_sgpr 102
  .amdhsa_accum_offset 256
  .amdhsa_group_segment_fixed_size 0
  .amdhsa_kernarg_size 136
  .amdhsa_user_sgpr_count 2
  .amdhsa_user_sgpr_kernarg_segment_ptr 1
  .amdhsa_system_sgpr_workgroup_id_x 1
.end_amdhsa_kernel
.text
```

```asm
; @launch grid=(256,1,1) block=(256,1,1) lds=163840
.amdgcn_target "amdgcn-amd-amdhsa--gfx950"
.text
.globl concat_heads__memory_aug_recurrent_mem_tr__ssm_conv_s4d__prompt_kernel
.p2align 8
.type concat_heads__memory_aug_recurrent_mem_tr__ssm_conv_s4d__prompt_kernel,@function
concat_heads__memory_aug_recurrent_mem_tr__ssm_conv_s4d__prompt_kernel:
    s_cmp_ge_u32 s2, 256
    s_cbranch_scc1 L_exit
    s_load_dwordx4 s[80:83], s[0:1], 120
    s_load_dwordx16 s[48:63], s[0:1], 0
    s_memrealtime s[90:91]
    v_lshrrev_b32 v1, 6, v0
    s_nop 0
    v_readfirstlane_b32 s32, v1
    s_waitcnt lgkmcnt(0)
    s_mov_b32 s4, s82
    s_mov_b32 s5, s83
    s_mov_b32 s6, 268435456
    s_mov_b32 s7, 0x20000
    s_mov_b32 s84, s80
    s_mov_b32 s85, s81
    s_mov_b32 s86, 256
    s_mov_b32 s87, 0x20000
    s_cmp_lg_u32 s32, 0
    s_cbranch_scc1 L_nod0
L_nod0:
    s_cmp_lg_u32 s32, 3
    s_cbranch_scc1 L_nowarm
    s_getpc_b64 s[44:45]
L_pcw:
    v_and_b32 v1, 63, v0
    v_lshlrev_b32 v1, 7, v1
    s_mul_hi_u32 s46, s2, 477218589
    s_mul_i32 s47, s46, 9
    s_sub_u32 s47, s2, s47
    s_add_u32 s46, s46, s47
    s_mul_hi_u32 s40, s46, 477218589
    s_mul_i32 s40, s40, 9
    s_sub_u32 s46, s46, s40
    s_lshl_b32 s47, s47, 13
    v_add_u32 v2, s47, v1
    v_min_u32 v2, L_exit-L_pcw, v2
    global_load_dword v240, v2, s[44:45]
    s_lshl_b32 s46, s46, 13
    v_add_u32 v2, s46, v1
    v_min_u32 v2, L_exit-L_pcw, v2
    global_load_dword v241, v2, s[44:45]
L_nowarm:
    s_getreg_b32 s3, hwreg(HW_REG_XCC_ID)
    s_and_b32 s3, s3, 15
    s_cmp_lg_u32 s3, 3
    s_cbranch_scc1 L_helper
    s_mov_b32 s37, 128
    v_mov_b32 v250, 1
    v_mov_b32 v251, 163832
    v_cmp_eq_u32 vcc, 0, v0
    s_nop 0
    s_and_saveexec_b64 s[38:39], vcc
    s_cbranch_execz tk1
    buffer_atomic_add v250, off, s[84:87], s37 sc0
    s_waitcnt vmcnt(0)
    ds_write_b32 v251, v250
    s_waitcnt lgkmcnt(0)
tk1:
    s_mov_b64 exec, -1
    s_barrier
    ds_read_b32 v252, v251
    s_waitcnt lgkmcnt(0)
    v_readfirstlane_b32 s12, v252
    s_barrier
    s_nop 3
    s_cmp_ge_u32 s12, 32
    s_cbranch_scc1 L_helper
L_chain:
    s_mov_b64 s[48:49], s[50:51]
    s_mov_b64 s[50:51], s[52:53]
    s_mov_b64 s[52:53], s[54:55]
    s_mov_b64 s[54:55], s[56:57]
    s_mov_b64 s[56:57], s[58:59]
    v_lshrrev_b32 v77, 6, v0
    s_nop 0
    v_readfirstlane_b32 s13, v77
    v_lshlrev_b32 v65, 4, v0
    v_and_b32 v48, 63, v0
    s_mov_b32 s10, 4718592
    s_mov_b32 s11, 0x20000
    v_lshrrev_b32 v49, 3, v48
    v_mul_u32_u24 v18, 1152, v49
    v_and_b32 v49, 7, v48
    v_lshl_add_u32 v18, v49, 4, v18
    s_mul_i32 s40, s12, 147456
    s_lshl_b32 s41, s13, 8
    s_add_u32 s40, s40, s41
    s_mov_b32 s42, s40
    s_xor_b32 s41, s13, 0
    s_mul_i32 s41, s41, 36864
    s_add_u32 s60, s41, s40
    s_xor_b32 s41, s13, 1
    s_mul_i32 s41, s41, 36864
    s_add_u32 s61, s41, s40
    s_xor_b32 s41, s13, 2
    s_mul_i32 s41, s41, 36864
    s_add_u32 s62, s41, s40
    s_xor_b32 s41, s13, 3
    s_mul_i32 s41, s41, 36864
    s_add_u32 s63, s41, s40
    s_lshl_b32 s43, s13, 12
    s_mov_b64 s[8:9], s[56:57]
    s_add_u32 m0, s43, 147456
    s_add_u32 s41, s60, 0
    buffer_load_dwordx4 v18, s[8:11], s41 offen offset:0 nt lds
    s_add_u32 s41, s60, 8192
    buffer_load_dwordx4 v18, s[8:11], s41 offen offset:1024 nt lds
    s_add_u32 s41, s60, 16384
    buffer_load_dwordx4 v18, s[8:11], s41 offen offset:2048 nt lds
    s_add_u32 s41, s60, 24576
    buffer_load_dwordx4 v18, s[8:11], s41 offen offset:3072 nt lds
    s_add_u32 m0, s43, 0
    s_add_u32 s41, s61, 0
    buffer_load_dwordx4 v18, s[8:11], s41 offen offset:0 nt lds
    s_add_u32 s41, s61, 8192
    buffer_load_dwordx4 v18, s[8:11], s41 offen offset:1024 nt lds
    s_add_u32 s41, s61, 16384
    buffer_load_dwordx4 v18, s[8:11], s41 offen offset:2048 nt lds
    s_add_u32 s41, s61, 24576
    buffer_load_dwordx4 v18, s[8:11], s41 offen offset:3072 nt lds
    s_add_u32 m0, s43, 36864
    s_add_u32 s41, s62, 0
    buffer_load_dwordx4 v18, s[8:11], s41 offen offset:0 nt lds
    s_add_u32 s41, s62, 8192
    buffer_load_dwordx4 v18, s[8:11], s41 offen offset:1024 nt lds
    s_add_u32 s41, s62, 16384
    buffer_load_dwordx4 v18, s[8:11], s41 offen offset:2048 nt lds
    s_add_u32 s41, s62, 24576
    buffer_load_dwordx4 v18, s[8:11], s41 offen offset:3072 nt lds
    s_add_u32 m0, s43, 73728
    s_add_u32 s41, s63, 0
    buffer_load_dwordx4 v18, s[8:11], s41 offen offset:0 nt lds
    s_add_u32 s41, s63, 8192
    buffer_load_dwordx4 v18, s[8:11], s41 offen offset:1024 nt lds
    s_add_u32 s41, s63, 16384
    buffer_load_dwordx4 v18, s[8:11], s41 offen offset:2048 nt lds
    s_add_u32 s41, s63, 24576
    buffer_load_dwordx4 v18, s[8:11], s41 offen offset:3072 nt lds
    v_lshrrev_b32 v49, 1, v48
    v_mul_u32_u24 v19, 1152, v49
    v_and_b32 v49, 1, v48
    v_lshl_add_u32 v19, v49, 4, v19
    s_mul_i32 s41, s13, 224
    s_sub_u32 s41, 1024, s41
    v_add_u32 v19, s41, v19
    v_lshrrev_b32 v49, 4, v48
    v_lshlrev_b32 v50, 2, v49
    v_and_b32 v51, 15, v48
    v_xor_b32 v51, v51, v50
    v_lshlrev_b32 v51, 4, v51
    v_lshl_add_u32 v16, v49, 15, v51
    v_lshrrev_b32 v50, 1, v49
    v_lshl_add_u32 v17, v50, 16, v51
    v_and_b32 v50, 1, v49
    v_lshl_add_u32 v17, v50, 13, v17
    s_lshl_b32 s40, s12, 8
    s_mul_i32 s58, s13, 1048576
    s_add_u32 s58, s58, s40
    s_lshr_b32 s41, s13, 1
    s_mul_i32 s59, s41, 262144
    s_and_b32 s41, s13, 1
    s_lshl_b32 s41, s41, 14
    s_add_u32 s59, s59, s41
    s_add_u32 s59, s59, s40
    s_add_u32 s59, s59, 4194304
    s_lshr_b32 s71, s52, 8
    s_add_u32 s71, s71, s12
    s_and_b32 s71, s71, 3
    v_bfe_u32 v50, v48, 2, 2
    v_xor_b32 v51, s13, v50
    v_lshlrev_b32 v20, 6, v51
    v_and_b32 v51, 3, v48
    v_lshl_add_u32 v20, v51, 4, v20
    v_lshrrev_b32 v23, 2, v48
    v_lshl_add_u32 v20, v23, 8, v20
    s_xor_b32 s41, s43, 0
    v_add_u32 v24, s41, v20
    s_xor_b32 s41, s43, 4096
    v_add_u32 v25, s41, v20
    s_xor_b32 s41, s43, 8192
    v_add_u32 v26, s41, v20
    s_xor_b32 s41, s43, 12288
    v_add_u32 v27, s41, v20
    v_and_b32 v23, 1, v50
    v_lshl_add_u32 v23, v49, 2, v23
    v_lshrrev_b32 v50, 1, v50
    v_lshlrev_b32 v21, 7, v23
    v_lshl_add_u32 v21, v50, 6, v21
    v_lshrrev_b32 v16, 1, v51
    v_lshl_add_u32 v21, v16, 5, v21
    v_and_b32 v16, 1, v51
    v_lshl_add_u32 v21, v16, 3, v21
    v_add_u32 v21, s43, v21
    v_lshlrev_b32 v22, 9, v50
    v_xor_b32 v22, v22, v21
    v_lshlrev_b32 v23, 5, v23
    v_lshl_add_u32 v23, v50, 10, v23
    v_lshl_add_u32 v23, v51, 3, v23
    v_add_u32 v23, s43, v23
    v_bfe_u32 v60, v65, 4, 6
    v_and_b32 v61, 15, v60
    v_lshrrev_b32 v62, 4, v60
    v_mov_b32 v64, 0x4444
    v_mov_b32 v77, 0xeeee
    v_cmp_lt_u32 vcc, 7, v61
    s_nop 1
    v_cndmask_b32 v64, v64, v77, vcc
    v_xor_b32 v66, 1024, v65
    v_xor_b32 v67, 2048, v65
    v_xor_b32 v68, 3072, v65
    v_and_b32 v69, 511, v65
    s_mul_i32 s96, s13, 36864
    s_add_u32 s96, s96, 16384
    v_lshlrev_b32 v70, 4, v60
    v_add_u32 v70, s96, v70
    v_lshrrev_b32 v79, 1, v69
    s_lshl_b32 s96, s13, 8
    s_add_u32 s96, s96, 14336
    s_lshl_b32 s33, s13, 10
    s_add_u32 s97, s33, 8192
    v_mov_b32 v77, s97
    v_mov_b32 v78, s96
    v_cmp_lt_u32 vcc, 31, v60
    s_nop 1
    v_cndmask_b32 v71, v77, v78, vcc
    v_add_u32 v71, v71, v79
    v_and_b32 v77, 7, v61
    v_lshrrev_b32 v78, 3, v61
    v_lshlrev_b32 v74, 4, v77
    v_lshl_add_u32 v73, v62, 7, v74
    v_lshl_add_u32 v73, v78, 3, v73
    s_lshl_b32 s96, s13, 9
    v_add_u32 v73, s96, v73
    v_lshrrev_b32 v74, 1, v74
    v_lshl_add_u32 v74, v78, 14, v74
    v_lshl_add_u32 v74, v62, 15, v74
    s_lshl_b32 s96, s13, 17
    v_add_u32 v74, s96, v74
    v_bfe_u32 v77, v61, 2, 1
    v_and_b32 v78, 3, v61
    s_cmp_lt_u32 s13, 2
    s_cselect_b64 vcc, -1, 0
    v_cndmask_b32 v77, 0, v77, vcc
    v_lshlrev_b32 v75, 7, v77
    v_lshl_add_u32 v75, v62, 4, v75
    v_lshl_add_u32 v75, v78, 2, v75
    v_lshlrev_b32 v58, 3, v77
    v_lshl_add_u32 v58, v78, 1, v58
    s_bfe_u32 s97, s12, 0x10001
    s_lshl_b32 s68, s97, 6
    s_lshl_b32 s97, s97, 2
    v_add_u32 v59, s97, v62
    s_bfe_u32 s96, s12, 0x10002
    s_and_b32 s40, s12, 1
    s_lshl_b32 s96, s96, 1
    s_add_u32 s96, s96, s40
    s_lshr_b32 s97, s12, 3
    s_lshl_b32 s98, s13, 2
    s_add_u32 s98, s98, s97
    s_lshl_b32 s98, s98, 2
    s_add_u32 s98, s98, s96
    s_lshl_b32 s98, s98, 8
    s_lshl_b32 s99, s13, 2
    s_add_u32 s99, s99, s96
    s_lshl_b32 s99, s99, 4
    s_lshl_b32 s41, s97, 1
    s_add_u32 s41, s41, s40
    s_lshl_b32 s41, s41, 7
    s_add_u32 s41, s41, 8192
    s_lshl_b32 s40, s40, 3
    s_add_u32 s40, s40, 512
    s_cmp_lt_u32 s13, 2
    s_cselect_b32 s96, 7, 4
    s_cselect_b32 s98, s98, s41
    s_cselect_b32 s99, s99, s40
    s_cselect_b32 s32, 1, 0
    s_add_u32 s68, s68, s98
    s_lshl_b32 s97, s97, s96
    s_add_u32 s99, s99, s97
    v_add_u32 v58, s99, v58
    s_and_b32 s97, s12, 4
    s_or_b32 s97, s97, s13
    s_cmp_eq_u32 s97, 2
    s_cselect_b32 s32, 2, s32
    s_mov_b32 s8, s48
    s_mov_b32 s9, s49
    s_mov_b32 s10, 9216
    v_mul_u32_u24 v77, 1152, v59
    v_lshl_add_u32 v77, v58, 1, v77
    buffer_load_dword v72, v77, s[8:11], 0 offen
    s_mov_b32 s10, 4718592
    s_waitcnt vmcnt(12) lgkmcnt(0)
    s_barrier
    s_cmp_eq_u32 s71, 1
    s_cbranch_scc1 cf_th0
    s_waitcnt vmcnt(6)
cf_th0:
    s_mov_b64 s[8:9], s[56:57]
    s_add_u32 m0, s43, 110592
    s_add_u32 s41, s42, 0
    buffer_load_dwordx4 v19, s[8:11], s41 offen offset:0 nt lds
    s_add_u32 s41, s42, 35840
    buffer_load_dwordx4 v19, s[8:11], s41 offen offset:1024 nt lds
    s_add_u32 s41, s42, 71680
    buffer_load_dwordx4 v19, s[8:11], s41 offen offset:2048 nt lds
    s_add_u32 s41, s42, 107520
    buffer_load_dwordx4 v19, s[8:11], s41 offen offset:3072 nt lds
    v_add_u32 v77, 147456, v22
    ds_read_b64_tr_b16 v[80:81], v77 offset:0
    ds_read_b64_tr_b16 v[82:83], v77 offset:256
    ds_read_b64_tr_b16 v[84:85], v77 offset:2048
    ds_read_b64_tr_b16 v[86:87], v77 offset:2304
    ds_read_b64_tr_b16 v[112:113], v77 offset:16
    ds_read_b64_tr_b16 v[114:115], v77 offset:272
    ds_read_b64_tr_b16 v[116:117], v77 offset:2064
    ds_read_b64_tr_b16 v[118:119], v77 offset:2320
    s_waitcnt vmcnt(12) lgkmcnt(0)
    s_barrier
    s_cmp_eq_u32 s71, 1
    s_cbranch_scc1 cf_th1
    s_waitcnt vmcnt(6)
cf_th1:
    s_mov_b64 s[8:9], s[52:53]
    s_add_u32 m0, s43, 147456
    s_add_u32 s41, s58, 0
    buffer_load_dwordx4 v17, s[8:11], s41 offen offset:0 nt lds
    s_add_u32 s41, s58, 31744
    buffer_load_dwordx4 v17, s[8:11], s41 offen offset:1024 nt lds
    s_add_u32 s41, s58, 129024
    buffer_load_dwordx4 v17, s[8:11], s41 offen offset:2048 nt lds
    s_add_u32 s41, s58, 160768
    buffer_load_dwordx4 v17, s[8:11], s41 offen offset:3072 nt lds
    v_add_u32 v77, 0, v21
    ds_read_b64_tr_b16 v[88:89], v77 offset:0
    ds_read_b64_tr_b16 v[90:91], v77 offset:256
    ds_read_b64_tr_b16 v[92:93], v77 offset:2048
    ds_read_b64_tr_b16 v[94:95], v77 offset:2304
    ds_read_b64_tr_b16 v[120:121], v77 offset:16
    ds_read_b64_tr_b16 v[122:123], v77 offset:272
    ds_read_b64_tr_b16 v[124:125], v77 offset:2064
    ds_read_b64_tr_b16 v[126:127], v77 offset:2320
    s_waitcnt vmcnt(12) lgkmcnt(0)
    s_barrier
    s_cmp_eq_u32 s71, 1
    s_cbranch_scc1 cf_th2
    s_waitcnt vmcnt(6)
cf_th2:
    s_add_u32 m0, s43, 0
    s_add_u32 s41, s58, 16384
    buffer_load_dwordx4 v17, s[8:11], s41 offen offset:0 nt lds
    s_add_u32 s41, s58, 48128
    buffer_load_dwordx4 v17, s[8:11], s41 offen offset:1024 nt lds
    s_add_u32 s41, s58, 145408
    buffer_load_dwordx4 v17, s[8:11], s41 offen offset:2048 nt lds
    s_add_u32 s41, s58, 177152
    buffer_load_dwordx4 v17, s[8:11], s41 offen offset:3072 nt lds
    v_add_u32 v77, 36864, v21
    ds_read_b64_tr_b16 v[96:97], v77 offset:0
    ds_read_b64_tr_b16 v[98:99], v77 offset:256
    ds_read_b64_tr_b16 v[100:101], v77 offset:2048
    ds_read_b64_tr_b16 v[102:103], v77 offset:2304
    ds_read_b64_tr_b16 v[128:129], v77 offset:16
    ds_read_b64_tr_b16 v[130:131], v77 offset:272
    ds_read_b64_tr_b16 v[132:133], v77 offset:2064
    ds_read_b64_tr_b16 v[134:135], v77 offset:2320
    s_waitcnt vmcnt(12) lgkmcnt(0)
    s_barrier
    s_cmp_eq_u32 s71, 1
    s_cbranch_scc1 cf_th3
    s_waitcnt vmcnt(6)
cf_th3:
    s_mov_b64 s[8:9], s[54:55]
    s_add_u32 m0, s43, 36864
    s_add_u32 s41, s58, 0
    buffer_load_dwordx4 v17, s[8:11], s41 offen offset:0 nt lds
    s_add_u32 s41, s58, 31744
    buffer_load_dwordx4 v17, s[8:11], s41 offen offset:1024 nt lds
    s_add_u32 s41, s58, 129024
    buffer_load_dwordx4 v17, s[8:11], s41 offen offset:2048 nt lds
    s_add_u32 s41, s58, 160768
    buffer_load_dwordx4 v17, s[8:11], s41 offen offset:3072 nt lds
    v_add_u32 v77, 73728, v21
    ds_read_b64_tr_b16 v[104:105], v77 offset:0
    ds_read_b64_tr_b16 v[106:107], v77 offset:256
    ds_read_b64_tr_b16 v[108:109], v77 offset:2048
    ds_read_b64_tr_b16 v[110:111], v77 offset:2304
    ds_read_b64_tr_b16 v[136:137], v77 offset:16
    ds_read_b64_tr_b16 v[138:139], v77 offset:272
    ds_read_b64_tr_b16 v[140:141], v77 offset:2064
    ds_read_b64_tr_b16 v[142:143], v77 offset:2320
    s_waitcnt vmcnt(12) lgkmcnt(0)
    s_barrier
    s_cmp_eq_u32 s71, 1
    s_cbranch_scc1 cf_th4
    s_waitcnt vmcnt(6)
cf_th4:
    s_add_u32 m0, s43, 73728
    s_add_u32 s41, s58, 16384
    buffer_load_dwordx4 v17, s[8:11], s41 offen offset:0 nt lds
    s_add_u32 s41, s58, 48128
    buffer_load_dwordx4 v17, s[8:11], s41 offen offset:1024 nt lds
    s_add_u32 s41, s58, 145408
    buffer_load_dwordx4 v17, s[8:11], s41 offen offset:2048 nt lds
    s_add_u32 s41, s58, 177152
    buffer_load_dwordx4 v17, s[8:11], s41 offen offset:3072 nt lds
    v_add_u32 v77, 110592, v23
    ds_read_b64_tr_b16 v[0:1], v77 offset:0
    ds_read_b64_tr_b16 v[2:3], v77 offset:64
    ds_read_b64_tr_b16 v[4:5], v77 offset:512
    ds_read_b64_tr_b16 v[6:7], v77 offset:576
    ds_read_b64_tr_b16 v[8:9], v77 offset:2048
    ds_read_b64_tr_b16 v[10:11], v77 offset:2112
    ds_read_b64_tr_b16 v[12:13], v77 offset:2560
    ds_read_b64_tr_b16 v[14:15], v77 offset:2624
    s_waitcnt vmcnt(12) lgkmcnt(0)
    s_barrier
    s_cmp_eq_u32 s71, 1
    s_cbranch_scc1 cf_th5
    s_waitcnt vmcnt(6)
cf_th5:
    s_mov_b64 s[8:9], s[50:51]
    s_add_u32 m0, s43, 110592
    s_add_u32 s41, s58, 0
    buffer_load_dwordx4 v17, s[8:11], s41 offen offset:0 nt lds
    s_add_u32 s41, s58, 31744
    buffer_load_dwordx4 v17, s[8:11], s41 offen offset:1024 nt lds
    s_add_u32 s41, s58, 129024
    buffer_load_dwordx4 v17, s[8:11], s41 offen offset:2048 nt lds
    s_add_u32 s41, s58, 160768
    buffer_load_dwordx4 v17, s[8:11], s41 offen offset:3072 nt lds
    s_cmp_eq_u32 s32, 0
    s_cbranch_scc1 cf_init_done
    v_mov_b32 v52, 1
    v_mov_b32 v53, 1
    v_mov_b32 v54, 1
    v_mov_b32 v55, 1
    v_mov_b32 v56, 0
    s_lshl_b32 s96, s12, 14
    s_add_u32 s96, s96, 68157440
    s_add_u32 s97, s96, 0
    buffer_store_dwordx4 v[52:55], v65, s[4:7], s97 offen
    buffer_load_dwordx4 v[60:63], v65, s[4:7], s97 offen sc1
    s_add_u32 s97, s96, 4096
    buffer_store_dwordx4 v[52:55], v65, s[4:7], s97 offen
    buffer_load_dwordx4 v[60:63], v65, s[4:7], s97 offen sc1
    s_add_u32 s97, s96, 8192
    buffer_store_dwordx4 v[52:55], v65, s[4:7], s97 offen
    buffer_load_dwordx4 v[60:63], v65, s[4:7], s97 offen sc1
    s_add_u32 s97, s96, 12288
    buffer_store_dwordx4 v[52:55], v65, s[4:7], s97 offen
    buffer_load_dwordx4 v[60:63], v65, s[4:7], s97 offen sc1
    s_add_u32 s96, s68, 67108864
    s_add_u32 s97, s96, 16384
    buffer_store_dword v56, v75, s[4:7], s96 offen offset:0
    buffer_store_dword v72, v75, s[4:7], s97 offen offset:0
    buffer_load_dword v60, v75, s[4:7], s96 offen offset:0 sc1
    buffer_load_dword v60, v75, s[4:7], s97 offen offset:0 sc1
    s_cmp_lg_u32 s32, 2
    s_cbranch_scc1 cf_init_done
    buffer_store_dword v56, v75, s[4:7], s96 offen offset:1024
    buffer_store_dword v72, v75, s[4:7], s97 offen offset:1024
    buffer_load_dword v60, v75, s[4:7], s96 offen offset:1024 sc1
    buffer_load_dword v60, v75, s[4:7], s97 offen offset:1024 sc1
    buffer_store_dword v56, v75, s[4:7], s96 offen offset:2048
    buffer_store_dword v72, v75, s[4:7], s97 offen offset:2048
    buffer_load_dword v60, v75, s[4:7], s96 offen offset:2048 sc1
    buffer_load_dword v60, v75, s[4:7], s97 offen offset:2048 sc1
    buffer_store_dword v56, v75, s[4:7], s96 offen offset:3072
    buffer_store_dword v72, v75, s[4:7], s97 offen offset:3072
    buffer_load_dword v60, v75, s[4:7], s96 offen offset:3072 sc1
    buffer_load_dword v60, v75, s[4:7], s97 offen offset:3072 sc1
cf_init_done:
    ds_write_b64 v70, v[0:1] offset:16384
    ds_write_b64 v70, v[2:3] offset:16392
    ds_write_b64 v70, v[4:5] offset:17408
    ds_write_b64 v70, v[6:7] offset:17416
    ds_write_b64 v70, v[8:9] offset:18432
    ds_write_b64 v70, v[10:11] offset:18440
    ds_write_b64 v70, v[12:13] offset:19456
    ds_write_b64 v70, v[14:15] offset:19464
    v_add_u32 v28, 147456, v24
    v_add_u32 v29, 147456, v25
    v_add_u32 v30, 147456, v26
    v_add_u32 v31, 147456, v27
    ds_read_b64_tr_b16 a[96:97], v28 offset:0
    ds_read_b64_tr_b16 a[104:105], v28 offset:8
    ds_read_b64_tr_b16 a[112:113], v29 offset:0
    ds_read_b64_tr_b16 a[120:121], v29 offset:8
    ds_read_b64_tr_b16 a[128:129], v30 offset:0
    ds_read_b64_tr_b16 a[136:137], v30 offset:8
    ds_read_b64_tr_b16 a[144:145], v31 offset:0
    ds_read_b64_tr_b16 v[32:33], v31 offset:8
    s_waitcnt vmcnt(12) lgkmcnt(0)
    s_barrier
    s_cmp_eq_u32 s71, 1
    s_cbranch_scc1 cf_th6
    s_waitcnt vmcnt(6)
cf_th6:
    s_add_u32 m0, s43, 147456
    s_add_u32 s41, s58, 16384
    buffer_load_dwordx4 v17, s[8:11], s41 offen offset:0 nt lds
    s_add_u32 s41, s58, 48128
    buffer_load_dwordx4 v17, s[8:11], s41 offen offset:1024 nt lds
    s_add_u32 s41, s58, 145408
    buffer_load_dwordx4 v17, s[8:11], s41 offen offset:2048 nt lds
    s_add_u32 s41, s58, 177152
    buffer_load_dwordx4 v17, s[8:11], s41 offen offset:3072 nt lds
    ds_write_b64 v70, v[32:33] offset:12288
    v_add_u32 v28, 0, v24
    v_add_u32 v29, 0, v25
    v_add_u32 v30, 0, v26
    v_add_u32 v31, 0, v27
    ds_read_b64_tr_b16 a[98:99], v28 offset:0
    ds_read_b64_tr_b16 a[106:107], v28 offset:8
    ds_read_b64_tr_b16 a[114:115], v29 offset:0
    ds_read_b64_tr_b16 a[122:123], v29 offset:8
    ds_read_b64_tr_b16 a[130:131], v30 offset:0
    ds_read_b64_tr_b16 a[138:139], v30 offset:8
    ds_read_b64_tr_b16 a[146:147], v31 offset:0
    ds_read_b64_tr_b16 v[0:1], v31 offset:8
    s_waitcnt vmcnt(12) lgkmcnt(0)
    s_barrier
    s_cmp_eq_u32 s71, 1
    s_cbranch_scc1 cf_th7
    s_waitcnt vmcnt(6)
cf_th7:
    s_mov_b64 s[8:9], s[52:53]
    s_add_u32 m0, s43, 0
    s_add_u32 s41, s58, 262144
    buffer_load_dwordx4 v17, s[8:11], s41 offen offset:0 nt lds
    s_add_u32 s41, s58, 293888
    buffer_load_dwordx4 v17, s[8:11], s41 offen offset:1024 nt lds
    s_add_u32 s41, s58, 391168
    buffer_load_dwordx4 v17, s[8:11], s41 offen offset:2048 nt lds
    s_add_u32 s41, s58, 422912
    buffer_load_dwordx4 v17, s[8:11], s41 offen offset:3072 nt lds
    ds_write_b64 v70, v[0:1] offset:12296
    v_add_u32 v28, 36864, v24
    v_add_u32 v29, 36864, v25
    v_add_u32 v30, 36864, v26
    v_add_u32 v31, 36864, v27
    ds_read_b64_tr_b16 a[232:233], v28 offset:0
    ds_read_b64_tr_b16 v[32:33], v28 offset:8
    ds_read_b64_tr_b16 a[240:241], v29 offset:0
    ds_read_b64_tr_b16 a[248:249], v29 offset:8
    ds_read_b64_tr_b16 v[144:145], v30 offset:0
    ds_read_b64_tr_b16 v[152:153], v30 offset:8
    ds_read_b64_tr_b16 v[160:161], v31 offset:0
    ds_read_b64_tr_b16 v[168:169], v31 offset:8
    s_waitcnt vmcnt(12) lgkmcnt(0)
    s_barrier
    s_cmp_eq_u32 s71, 1
    s_cbranch_scc1 cf_th8
    s_waitcnt vmcnt(6)
cf_th8:
    s_add_u32 m0, s43, 36864
    s_add_u32 s41, s58, 278528
    buffer_load_dwordx4 v17, s[8:11], s41 offen offset:0 nt lds
    s_add_u32 s41, s58, 310272
    buffer_load_dwordx4 v17, s[8:11], s41 offen offset:1024 nt lds
    s_add_u32 s41, s58, 407552
    buffer_load_dwordx4 v17, s[8:11], s41 offen offset:2048 nt lds
    s_add_u32 s41, s58, 439296
    buffer_load_dwordx4 v17, s[8:11], s41 offen offset:3072 nt lds
    ds_write_b64 v70, v[32:33] offset:8192
    v_add_u32 v28, 73728, v24
    v_add_u32 v29, 73728, v25
    v_add_u32 v30, 73728, v26
    v_add_u32 v31, 73728, v27
    ds_read_b64_tr_b16 a[234:235], v28 offset:0
    ds_read_b64_tr_b16 v[0:1], v28 offset:8
    ds_read_b64_tr_b16 a[242:243], v29 offset:0
    ds_read_b64_tr_b16 a[250:251], v29 offset:8
    ds_read_b64_tr_b16 v[146:147], v30 offset:0
    ds_read_b64_tr_b16 v[154:155], v30 offset:8
    ds_read_b64_tr_b16 v[162:163], v31 offset:0
    ds_read_b64_tr_b16 v[170:171], v31 offset:8
    s_waitcnt vmcnt(12) lgkmcnt(0)
    s_barrier
    s_cmp_eq_u32 s71, 1
    s_cbranch_scc1 cf_th9
    s_waitcnt vmcnt(6)
cf_th9:
    s_mov_b64 s[8:9], s[54:55]
    s_add_u32 m0, s43, 73728
    s_add_u32 s41, s58, 262144
    buffer_load_dwordx4 v17, s[8:11], s41 offen offset:0 nt lds
    s_add_u32 s41, s58, 293888
    buffer_load_dwordx4 v17, s[8:11], s41 offen offset:1024 nt lds
    s_add_u32 s41, s58, 391168
    buffer_load_dwordx4 v17, s[8:11], s41 offen offset:2048 nt lds
    s_add_u32 s41, s58, 422912
    buffer_load_dwordx4 v17, s[8:11], s41 offen offset:3072 nt lds
    ds_write_b64 v70, v[0:1] offset:8200
    v_add_u32 v28, 110592, v24
    v_add_u32 v29, 110592, v25
    v_add_u32 v30, 110592, v26
    v_add_u32 v31, 110592, v27
    ds_read_b64_tr_b16 v[32:33], v28 offset:0
    ds_read_b64_tr_b16 v[34:35], v28 offset:8
    ds_read_b64_tr_b16 v[36:37], v29 offset:0
    ds_read_b64_tr_b16 v[38:39], v29 offset:8
    ds_read_b64_tr_b16 a[0:1], v30 offset:0
    ds_read_b64_tr_b16 v[40:41], v30 offset:8
    ds_read_b64_tr_b16 a[8:9], v31 offset:0
    ds_read_b64_tr_b16 v[42:43], v31 offset:8
    s_waitcnt vmcnt(12) lgkmcnt(0)
    s_barrier
    s_cmp_eq_u32 s71, 1
    s_cbranch_scc1 cf_th10
    s_waitcnt vmcnt(6)
cf_th10:
    s_add_u32 m0, s43, 110592
    s_add_u32 s41, s58, 278528
    buffer_load_dwordx4 v17, s[8:11], s41 offen offset:0 nt lds
    s_add_u32 s41, s58, 310272
    buffer_load_dwordx4 v17, s[8:11], s41 offen offset:1024 nt lds
    s_add_u32 s41, s58, 407552
    buffer_load_dwordx4 v17, s[8:11], s41 offen offset:2048 nt lds
    s_add_u32 s41, s58, 439296
    buffer_load_dwordx4 v17, s[8:11], s41 offen offset:3072 nt lds
    s_cmp_lg_u32 s13, 0
    s_cbranch_scc1 cf_ma
    v_mov_b32 v54, 1
    s_mov_b64 exec, 1
    buffer_atomic_add v54, off, s[84:87], 0 offset:132
    s_mov_b64 exec, -1
cf_ma:
    ds_write_b64 v70, v[32:33] offset:0
    ds_write_b64 v70, v[34:35] offset:2048
    ds_write_b64 v70, v[36:37] offset:4096
    ds_write_b64 v70, v[38:39] offset:6144
    ds_write_b64 v70, v[40:41] offset:10240
    ds_write_b64 v70, v[42:43] offset:14336
    v_add_u32 v28, 147456, v24
    v_add_u32 v29, 147456, v25
    v_add_u32 v30, 147456, v26
    v_add_u32 v31, 147456, v27
    ds_read_b64_tr_b16 v[0:1], v28 offset:0
    ds_read_b64_tr_b16 v[2:3], v28 offset:8
    ds_read_b64_tr_b16 v[4:5], v29 offset:0
    ds_read_b64_tr_b16 v[6:7], v29 offset:8
    ds_read_b64_tr_b16 a[2:3], v30 offset:0
    ds_read_b64_tr_b16 v[8:9], v30 offset:8
    ds_read_b64_tr_b16 a[10:11], v31 offset:0
    ds_read_b64_tr_b16 v[10:11], v31 offset:8
    s_waitcnt vmcnt(12) lgkmcnt(0)
    s_barrier
    s_cmp_eq_u32 s71, 1
    s_cbranch_scc1 cf_th11
    s_waitcnt vmcnt(6)
cf_th11:
    s_mov_b64 s[8:9], s[50:51]
    s_add_u32 m0, s43, 147456
    s_add_u32 s41, s58, 262144
    buffer_load_dwordx4 v17, s[8:11], s41 offen offset:0 nt lds
    s_add_u32 s41, s58, 293888
    buffer_load_dwordx4 v17, s[8:11], s41 offen offset:1024 nt lds
    s_add_u32 s41, s58, 391168
    buffer_load_dwordx4 v17, s[8:11], s41 offen offset:2048 nt lds
    s_add_u32 s41, s58, 422912
    buffer_load_dwordx4 v17, s[8:11], s41 offen offset:3072 nt lds
    ds_write_b64 v70, v[0:1] offset:8
    ds_write_b64 v70, v[2:3] offset:2056
    ds_write_b64 v70, v[4:5] offset:4104
    ds_write_b64 v70, v[6:7] offset:6152
    ds_write_b64 v70, v[8:9] offset:10248
    ds_write_b64 v70, v[10:11] offset:14344
    v_add_u32 v28, 0, v24
    v_add_u32 v29, 0, v25
    v_add_u32 v30, 0, v26
    v_add_u32 v31, 0, v27
    ds_read_b64_tr_b16 a[100:101], v28 offset:0
    ds_read_b64_tr_b16 a[108:109], v28 offset:8
    ds_read_b64_tr_b16 a[116:117], v29 offset:0
    ds_read_b64_tr_b16 a[124:125], v29 offset:8
    ds_read_b64_tr_b16 a[132:133], v30 offset:0
    ds_read_b64_tr_b16 a[140:141], v30 offset:8
    ds_read_b64_tr_b16 a[148:149], v31 offset:0
    ds_read_b64_tr_b16 v[32:33], v31 offset:8
    s_waitcnt vmcnt(12) lgkmcnt(0)
    s_barrier
    s_cmp_eq_u32 s71, 1
    s_cbranch_scc1 cf_th12
    s_waitcnt vmcnt(6)
cf_th12:
    s_add_u32 m0, s43, 0
    s_add_u32 s41, s58, 278528
    buffer_load_dwordx4 v17, s[8:11], s41 offen offset:0 nt lds
    s_add_u32 s41, s58, 310272
    buffer_load_dwordx4 v17, s[8:11], s41 offen offset:1024 nt lds
    s_add_u32 s41, s58, 407552
    buffer_load_dwordx4 v17, s[8:11], s41 offen offset:2048 nt lds
    s_add_u32 s41, s58, 439296
    buffer_load_dwordx4 v17, s[8:11], s41 offen offset:3072 nt lds
    ds_write_b64 v70, v[32:33] offset:13312
    v_add_u32 v28, 36864, v24
    v_add_u32 v29, 36864, v25
    v_add_u32 v30, 36864, v26
    v_add_u32 v31, 36864, v27
    ds_read_b64_tr_b16 a[102:103], v28 offset:0
    ds_read_b64_tr_b16 a[110:111], v28 offset:8
    ds_read_b64_tr_b16 a[118:119], v29 offset:0
    ds_read_b64_tr_b16 a[126:127], v29 offset:8
    ds_read_b64_tr_b16 a[134:135], v30 offset:0
    ds_read_b64_tr_b16 a[142:143], v30 offset:8
    ds_read_b64_tr_b16 a[150:151], v31 offset:0
    ds_read_b64_tr_b16 v[0:1], v31 offset:8
    s_waitcnt vmcnt(12) lgkmcnt(0)
    s_barrier
    s_cmp_eq_u32 s71, 1
    s_cbranch_scc1 cf_th13
    s_waitcnt vmcnt(6)
cf_th13:
    s_mov_b64 s[8:9], s[52:53]
    s_add_u32 m0, s43, 36864
    s_add_u32 s41, s58, 524288
    buffer_load_dwordx4 v17, s[8:11], s41 offen offset:0 nt lds
    s_add_u32 s41, s58, 556032
    buffer_load_dwordx4 v17, s[8:11], s41 offen offset:1024 nt lds
    s_add_u32 s41, s58, 653312
    buffer_load_dwordx4 v17, s[8:11], s41 offen offset:2048 nt lds
    s_add_u32 s41, s58, 685056
    buffer_load_dwordx4 v17, s[8:11], s41 offen offset:3072 nt lds
    ds_write_b64 v70, v[0:1] offset:13320
    v_add_u32 v28, 73728, v24
    v_add_u32 v29, 73728, v25
    v_add_u32 v30, 73728, v26
    v_add_u32 v31, 73728, v27
    ds_read_b64_tr_b16 a[236:237], v28 offset:0
    ds_read_b64_tr_b16 v[32:33], v28 offset:8
    ds_read_b64_tr_b16 a[244:245], v29 offset:0
    ds_read_b64_tr_b16 a[252:253], v29 offset:8
    ds_read_b64_tr_b16 v[148:149], v30 offset:0
    ds_read_b64_tr_b16 v[156:157], v30 offset:8
    ds_read_b64_tr_b16 v[164:165], v31 offset:0
    ds_read_b64_tr_b16 v[172:173], v31 offset:8
    s_waitcnt vmcnt(12) lgkmcnt(0)
    s_barrier
    s_cmp_eq_u32 s71, 1
    s_cbranch_scc1 cf_th14
    s_waitcnt vmcnt(6)
cf_th14:
    s_add_u32 m0, s43, 73728
    s_add_u32 s41, s58, 540672
    buffer_load_dwordx4 v17, s[8:11], s41 offen offset:0 nt lds
    s_add_u32 s41, s58, 572416
    buffer_load_dwordx4 v17, s[8:11], s41 offen offset:1024 nt lds
    s_add_u32 s41, s58, 669696
    buffer_load_dwordx4 v17, s[8:11], s41 offen offset:2048 nt lds
    s_add_u32 s41, s58, 701440
    buffer_load_dwordx4 v17, s[8:11], s41 offen offset:3072 nt lds
    ds_write_b64 v70, v[32:33] offset:9216
    v_add_u32 v28, 110592, v24
    v_add_u32 v29, 110592, v25
    v_add_u32 v30, 110592, v26
    v_add_u32 v31, 110592, v27
    ds_read_b64_tr_b16 a[238:239], v28 offset:0
    ds_read_b64_tr_b16 v[0:1], v28 offset:8
    ds_read_b64_tr_b16 a[246:247], v29 offset:0
    ds_read_b64_tr_b16 a[254:255], v29 offset:8
    ds_read_b64_tr_b16 v[150:151], v30 offset:0
    ds_read_b64_tr_b16 v[158:159], v30 offset:8
    ds_read_b64_tr_b16 v[166:167], v31 offset:0
    ds_read_b64_tr_b16 v[174:175], v31 offset:8
    s_waitcnt vmcnt(12) lgkmcnt(0)
    s_barrier
    s_cmp_eq_u32 s71, 1
    s_cbranch_scc1 cf_th15
    s_waitcnt vmcnt(6)
cf_th15:
    s_mov_b64 s[8:9], s[54:55]
    s_add_u32 m0, s43, 110592
    s_add_u32 s41, s58, 524288
    buffer_load_dwordx4 v17, s[8:11], s41 offen offset:0 nt lds
    s_add_u32 s41, s58, 556032
    buffer_load_dwordx4 v17, s[8:11], s41 offen offset:1024 nt lds
    s_add_u32 s41, s58, 653312
    buffer_load_dwordx4 v17, s[8:11], s41 offen offset:2048 nt lds
    s_add_u32 s41, s58, 685056
    buffer_load_dwordx4 v17, s[8:11], s41 offen offset:3072 nt lds
    ds_write_b64 v70, v[0:1] offset:9224
    v_add_u32 v28, 147456, v24
    v_add_u32 v29, 147456, v25
    v_add_u32 v30, 147456, v26
    v_add_u32 v31, 147456, v27
    ds_read_b64_tr_b16 v[32:33], v28 offset:0
    ds_read_b64_tr_b16 v[34:35], v28 offset:8
    ds_read_b64_tr_b16 v[36:37], v29 offset:0
    ds_read_b64_tr_b16 v[38:39], v29 offset:8
    ds_read_b64_tr_b16 a[4:5], v30 offset:0
    ds_read_b64_tr_b16 v[40:41], v30 offset:8
    ds_read_b64_tr_b16 a[12:13], v31 offset:0
    ds_read_b64_tr_b16 v[42:43], v31 offset:8
    s_waitcnt vmcnt(12) lgkmcnt(0)
    s_barrier
    s_cmp_eq_u32 s71, 1
    s_cbranch_scc1 cf_th16
    s_waitcnt vmcnt(6)
cf_th16:
    s_add_u32 m0, s43, 147456
    s_add_u32 s41, s58, 540672
    buffer_load_dwordx4 v17, s[8:11], s41 offen offset:0 nt lds
    s_add_u32 s41, s58, 572416
    buffer_load_dwordx4 v17, s[8:11], s41 offen offset:1024 nt lds
    s_add_u32 s41, s58, 669696
    buffer_load_dwordx4 v17, s[8:11], s41 offen offset:2048 nt lds
    s_add_u32 s41, s58, 701440
    buffer_load_dwordx4 v17, s[8:11], s41 offen offset:3072 nt lds
    ds_write_b64 v70, v[32:33] offset:1024
    ds_write_b64 v70, v[34:35] offset:3072
    ds_write_b64 v70, v[36:37] offset:5120
    ds_write_b64 v70, v[38:39] offset:7168
    ds_write_b64 v70, v[40:41] offset:11264
    ds_write_b64 v70, v[42:43] offset:15360
    v_add_u32 v28, 0, v24
    v_add_u32 v29, 0, v25
    v_add_u32 v30, 0, v26
    v_add_u32 v31, 0, v27
    ds_read_b64_tr_b16 v[0:1], v28 offset:0
    ds_read_b64_tr_b16 v[2:3], v28 offset:8
    ds_read_b64_tr_b16 v[4:5], v29 offset:0
    ds_read_b64_tr_b16 v[6:7], v29 offset:8
    ds_read_b64_tr_b16 a[6:7], v30 offset:0
    ds_read_b64_tr_b16 v[8:9], v30 offset:8
    ds_read_b64_tr_b16 a[14:15], v31 offset:0
    ds_read_b64_tr_b16 v[10:11], v31 offset:8
    s_waitcnt vmcnt(12) lgkmcnt(0)
    s_barrier
    s_cmp_eq_u32 s71, 1
    s_cbranch_scc1 cf_th17
    s_waitcnt vmcnt(6)
cf_th17:
    s_mov_b64 s[8:9], s[50:51]
    s_add_u32 m0, s43, 0
    s_add_u32 s41, s58, 524288
    buffer_load_dwordx4 v17, s[8:11], s41 offen offset:0 nt lds
    s_add_u32 s41, s58, 556032
    buffer_load_dwordx4 v17, s[8:11], s41 offen offset:1024 nt lds
    s_add_u32 s41, s58, 653312
    buffer_load_dwordx4 v17, s[8:11], s41 offen offset:2048 nt lds
    s_add_u32 s41, s58, 685056
    buffer_load_dwordx4 v17, s[8:11], s41 offen offset:3072 nt lds
    ds_write_b64 v70, v[0:1] offset:1032
    ds_write_b64 v70, v[2:3] offset:3080
    ds_write_b64 v70, v[4:5] offset:5128
    ds_write_b64 v70, v[6:7] offset:7176
    ds_write_b64 v70, v[8:9] offset:11272
    ds_write_b64 v70, v[10:11] offset:15368
    v_add_u32 v28, 36864, v24
    v_add_u32 v29, 36864, v25
    v_add_u32 v30, 36864, v26
    v_add_u32 v31, 36864, v27
    ds_read_b64_tr_b16 a[152:153], v28 offset:0
    ds_read_b64_tr_b16 a[160:161], v28 offset:8
    ds_read_b64_tr_b16 a[168:169], v29 offset:0
    ds_read_b64_tr_b16 a[176:177], v29 offset:8
    ds_read_b64_tr_b16 a[184:185], v30 offset:0
    ds_read_b64_tr_b16 a[192:193], v30 offset:8
    ds_read_b64_tr_b16 a[200:201], v31 offset:0
    ds_read_b64_tr_b16 a[208:209], v31 offset:8
    s_waitcnt vmcnt(12) lgkmcnt(0)
    s_barrier
    s_cmp_eq_u32 s71, 1
    s_cbranch_scc1 cf_th18
    s_waitcnt vmcnt(6)
cf_th18:
    s_add_u32 m0, s43, 36864
    s_add_u32 s41, s58, 540672
    buffer_load_dwordx4 v17, s[8:11], s41 offen offset:0 nt lds
    s_add_u32 s41, s58, 572416
    buffer_load_dwordx4 v17, s[8:11], s41 offen offset:1024 nt lds
    s_add_u32 s41, s58, 669696
    buffer_load_dwordx4 v17, s[8:11], s41 offen offset:2048 nt lds
    s_add_u32 s41, s58, 701440
    buffer_load_dwordx4 v17, s[8:11], s41 offen offset:3072 nt lds
    v_add_u32 v28, 73728, v24
    v_add_u32 v29, 73728, v25
    v_add_u32 v30, 73728, v26
    v_add_u32 v31, 73728, v27
    ds_read_b64_tr_b16 a[154:155], v28 offset:0
    ds_read_b64_tr_b16 a[162:163], v28 offset:8
    ds_read_b64_tr_b16 a[170:171], v29 offset:0
    ds_read_b64_tr_b16 a[178:179], v29 offset:8
    ds_read_b64_tr_b16 a[186:187], v30 offset:0
    ds_read_b64_tr_b16 a[194:195], v30 offset:8
    ds_read_b64_tr_b16 a[202:203], v31 offset:0
    ds_read_b64_tr_b16 a[210:211], v31 offset:8
    s_waitcnt vmcnt(12) lgkmcnt(0)
    s_barrier
    s_cmp_eq_u32 s71, 1
    s_cbranch_scc1 cf_th19
    s_waitcnt vmcnt(6)
cf_th19:
    s_mov_b64 s[8:9], s[52:53]
    s_add_u32 m0, s43, 73728
    s_add_u32 s41, s58, 786432
    buffer_load_dwordx4 v17, s[8:11], s41 offen offset:0 nt lds
    s_add_u32 s41, s58, 818176
    buffer_load_dwordx4 v17, s[8:11], s41 offen offset:1024 nt lds
    s_add_u32 s41, s58, 915456
    buffer_load_dwordx4 v17, s[8:11], s41 offen offset:2048 nt lds
    s_add_u32 s41, s58, 947200
    buffer_load_dwordx4 v17, s[8:11], s41 offen offset:3072 nt lds
    v_add_u32 v28, 110592, v24
    v_add_u32 v29, 110592, v25
    v_add_u32 v30, 110592, v26
    v_add_u32 v31, 110592, v27
    ds_read_b64_tr_b16 v[176:177], v28 offset:0
    ds_read_b64_tr_b16 v[184:185], v28 offset:8
    ds_read_b64_tr_b16 v[192:193], v29 offset:0
    ds_read_b64_tr_b16 v[200:201], v29 offset:8
    ds_read_b64_tr_b16 v[208:209], v30 offset:0
    ds_read_b64_tr_b16 v[216:217], v30 offset:8
    ds_read_b64_tr_b16 v[224:225], v31 offset:0
    ds_read_b64_tr_b16 v[232:233], v31 offset:8
    s_waitcnt vmcnt(12) lgkmcnt(0)
    s_barrier
    s_cmp_eq_u32 s71, 1
    s_cbranch_scc1 cf_th20
    s_waitcnt vmcnt(6)
cf_th20:
    s_add_u32 m0, s43, 110592
    s_add_u32 s41, s58, 802816
    buffer_load_dwordx4 v17, s[8:11], s41 offen offset:0 nt lds
    s_add_u32 s41, s58, 834560
    buffer_load_dwordx4 v17, s[8:11], s41 offen offset:1024 nt lds
    s_add_u32 s41, s58, 931840
    buffer_load_dwordx4 v17, s[8:11], s41 offen offset:2048 nt lds
    s_add_u32 s41, s58, 963584
    buffer_load_dwordx4 v17, s[8:11], s41 offen offset:3072 nt lds
    v_add_u32 v28, 147456, v24
    v_add_u32 v29, 147456, v25
    v_add_u32 v30, 147456, v26
    v_add_u32 v31, 147456, v27
    ds_read_b64_tr_b16 v[178:179], v28 offset:0
    ds_read_b64_tr_b16 v[186:187], v28 offset:8
    ds_read_b64_tr_b16 v[194:195], v29 offset:0
    ds_read_b64_tr_b16 v[202:203], v29 offset:8
    ds_read_b64_tr_b16 v[210:211], v30 offset:0
    ds_read_b64_tr_b16 v[218:219], v30 offset:8
    ds_read_b64_tr_b16 v[226:227], v31 offset:0
    ds_read_b64_tr_b16 v[234:235], v31 offset:8
    s_waitcnt vmcnt(12) lgkmcnt(0)
    s_barrier
    s_cmp_eq_u32 s71, 1
    s_cbranch_scc1 cf_th21
    s_waitcnt vmcnt(6)
cf_th21:
    s_mov_b64 s[8:9], s[54:55]
    s_add_u32 m0, s43, 147456
    s_add_u32 s41, s58, 786432
    buffer_load_dwordx4 v17, s[8:11], s41 offen offset:0 nt lds
    s_add_u32 s41, s58, 818176
    buffer_load_dwordx4 v17, s[8:11], s41 offen offset:1024 nt lds
    s_add_u32 s41, s58, 915456
    buffer_load_dwordx4 v17, s[8:11], s41 offen offset:2048 nt lds
    s_add_u32 s41, s58, 947200
    buffer_load_dwordx4 v17, s[8:11], s41 offen offset:3072 nt lds
    v_add_u32 v28, 0, v24
    v_add_u32 v29, 0, v25
    v_add_u32 v30, 0, v26
    v_add_u32 v31, 0, v27
    ds_read_b64_tr_b16 a[16:17], v28 offset:0
    ds_read_b64_tr_b16 a[24:25], v28 offset:8
    ds_read_b64_tr_b16 a[32:33], v29 offset:0
    ds_read_b64_tr_b16 a[40:41], v29 offset:8
    ds_read_b64_tr_b16 a[48:49], v30 offset:0
    ds_read_b64_tr_b16 a[56:57], v30 offset:8
    ds_read_b64_tr_b16 a[64:65], v31 offset:0
    ds_read_b64_tr_b16 a[72:73], v31 offset:8
    s_waitcnt vmcnt(12) lgkmcnt(0)
    s_barrier
    s_cmp_eq_u32 s71, 1
    s_cbranch_scc1 cf_th22
    s_waitcnt vmcnt(6)
cf_th22:
    s_add_u32 m0, s43, 0
    s_add_u32 s41, s58, 802816
    buffer_load_dwordx4 v17, s[8:11], s41 offen offset:0 nt lds
    s_add_u32 s41, s58, 834560
    buffer_load_dwordx4 v17, s[8:11], s41 offen offset:1024 nt lds
    s_add_u32 s41, s58, 931840
    buffer_load_dwordx4 v17, s[8:11], s41 offen offset:2048 nt lds
    s_add_u32 s41, s58, 963584
    buffer_load_dwordx4 v17, s[8:11], s41 offen offset:3072 nt lds
    buffer_load_dword v54, off, s[84:87], 0 offset:132 sc1
    buffer_load_dword v55, off, s[84:87], 0 offset:216 sc1
    v_add_u32 v28, 36864, v24
    v_add_u32 v29, 36864, v25
    v_add_u32 v30, 36864, v26
    v_add_u32 v31, 36864, v27
    ds_read_b64_tr_b16 a[18:19], v28 offset:0
    ds_read_b64_tr_b16 a[26:27], v28 offset:8
    ds_read_b64_tr_b16 a[34:35], v29 offset:0
    ds_read_b64_tr_b16 a[42:43], v29 offset:8
    ds_read_b64_tr_b16 a[50:51], v30 offset:0
    ds_read_b64_tr_b16 a[58:59], v30 offset:8
    ds_read_b64_tr_b16 a[66:67], v31 offset:0
    ds_read_b64_tr_b16 a[74:75], v31 offset:8
    s_waitcnt vmcnt(12) lgkmcnt(0)
    s_barrier
    s_cmp_eq_u32 s71, 1
    s_cbranch_scc1 cf_th23
    s_waitcnt vmcnt(6)
cf_th23:
    s_mov_b64 s[8:9], s[50:51]
    s_add_u32 m0, s43, 36864
    s_add_u32 s41, s58, 786432
    buffer_load_dwordx4 v17, s[8:11], s41 offen offset:0 nt lds
    s_add_u32 s41, s58, 818176
    buffer_load_dwordx4 v17, s[8:11], s41 offen offset:1024 nt lds
    s_add_u32 s41, s58, 915456
    buffer_load_dwordx4 v17, s[8:11], s41 offen offset:2048 nt lds
    s_add_u32 s41, s58, 947200
    buffer_load_dwordx4 v17, s[8:11], s41 offen offset:3072 nt lds
    v_add_u32 v28, 73728, v24
    v_add_u32 v29, 73728, v25
    v_add_u32 v30, 73728, v26
    v_add_u32 v31, 73728, v27
    ds_read_b64_tr_b16 a[156:157], v28 offset:0
    ds_read_b64_tr_b16 a[164:165], v28 offset:8
    ds_read_b64_tr_b16 a[172:173], v29 offset:0
    ds_read_b64_tr_b16 a[180:181], v29 offset:8
    ds_read_b64_tr_b16 a[188:189], v30 offset:0
    ds_read_b64_tr_b16 a[196:197], v30 offset:8
    ds_read_b64_tr_b16 a[204:205], v31 offset:0
    ds_read_b64_tr_b16 a[212:213], v31 offset:8
    s_waitcnt vmcnt(12) lgkmcnt(0)
    s_barrier
    s_cmp_eq_u32 s71, 1
    s_cbranch_scc1 cf_th24
    s_waitcnt vmcnt(6)
cf_th24:
    s_add_u32 m0, s43, 73728
    s_add_u32 s41, s58, 802816
    buffer_load_dwordx4 v17, s[8:11], s41 offen offset:0 nt lds
    s_add_u32 s41, s58, 834560
    buffer_load_dwordx4 v17, s[8:11], s41 offen offset:1024 nt lds
    s_add_u32 s41, s58, 931840
    buffer_load_dwordx4 v17, s[8:11], s41 offen offset:2048 nt lds
    s_add_u32 s41, s58, 963584
    buffer_load_dwordx4 v17, s[8:11], s41 offen offset:3072 nt lds
    v_add_u32 v28, 110592, v24
    v_add_u32 v29, 110592, v25
    v_add_u32 v30, 110592, v26
    v_add_u32 v31, 110592, v27
    ds_read_b64_tr_b16 a[158:159], v28 offset:0
    ds_read_b64_tr_b16 a[166:167], v28 offset:8
    ds_read_b64_tr_b16 a[174:175], v29 offset:0
    ds_read_b64_tr_b16 a[182:183], v29 offset:8
    ds_read_b64_tr_b16 a[190:191], v30 offset:0
    ds_read_b64_tr_b16 a[198:199], v30 offset:8
    ds_read_b64_tr_b16 a[206:207], v31 offset:0
    ds_read_b64_tr_b16 a[214:215], v31 offset:8
    s_waitcnt vmcnt(12) lgkmcnt(0)
    s_barrier
    s_cmp_eq_u32 s71, 1
    s_cbranch_scc1 cf_th25
    s_waitcnt vmcnt(6)
cf_th25:
    s_mov_b64 s[8:9], s[52:53]
    s_add_u32 m0, s43, 110592
    s_add_u32 s41, s59, 0
    buffer_load_dwordx4 v17, s[8:11], s41 offen offset:0 nt lds
    s_add_u32 s41, s59, 31744
    buffer_load_dwordx4 v17, s[8:11], s41 offen offset:1024 nt lds
    s_add_u32 s41, s59, 129024
    buffer_load_dwordx4 v17, s[8:11], s41 offen offset:2048 nt lds
    s_add_u32 s41, s59, 160768
    buffer_load_dwordx4 v17, s[8:11], s41 offen offset:3072 nt lds
    v_add_u32 v28, 147456, v24
    v_add_u32 v29, 147456, v25
    v_add_u32 v30, 147456, v26
    v_add_u32 v31, 147456, v27
    ds_read_b64_tr_b16 v[180:181], v28 offset:0
    ds_read_b64_tr_b16 v[188:189], v28 offset:8
    ds_read_b64_tr_b16 v[196:197], v29 offset:0
    ds_read_b64_tr_b16 v[204:205], v29 offset:8
    ds_read_b64_tr_b16 v[212:213], v30 offset:0
    ds_read_b64_tr_b16 v[220:221], v30 offset:8
    ds_read_b64_tr_b16 v[228:229], v31 offset:0
    ds_read_b64_tr_b16 v[236:237], v31 offset:8
    s_waitcnt vmcnt(12) lgkmcnt(0)
    s_barrier
    s_cmp_eq_u32 s71, 1
    s_cbranch_scc1 cf_th26
    s_waitcnt vmcnt(6)
cf_th26:
    s_mov_b64 s[8:9], s[50:51]
    s_add_u32 m0, s43, 147456
    s_add_u32 s41, s59, 0
    buffer_load_dwordx4 v17, s[8:11], s41 offen offset:0 nt lds
    s_add_u32 s41, s59, 31744
    buffer_load_dwordx4 v17, s[8:11], s41 offen offset:1024 nt lds
    s_add_u32 s41, s59, 129024
    buffer_load_dwordx4 v17, s[8:11], s41 offen offset:2048 nt lds
    s_add_u32 s41, s59, 160768
    buffer_load_dwordx4 v17, s[8:11], s41 offen offset:3072 nt lds
    s_lshl_b32 s26, s12, 14
    s_add_u32 s26, s26, 0
    s_mul_i32 s40, s13, 3072
    s_add_u32 s24, s26, s40
    s_add_u32 s26, s24, s33
    s_add_u32 s99, s26, 33030144
    s_lshl_b32 s96, s12, 7
    s_add_u32 s29, s96, 125845504
    s_add_u32 s96, s96, 125829120
    v_bfe_u32 v78, v65, 2, 5
    buffer_load_dword v56, v78, s[4:7], s96 offen offset:16 sc1
    v_add_u32 v28, 0, v24
    v_add_u32 v29, 0, v25
    v_add_u32 v30, 0, v26
    v_add_u32 v31, 0, v27
    ds_read_b64_tr_b16 v[182:183], v28 offset:0
    ds_read_b64_tr_b16 v[190:191], v28 offset:8
    ds_read_b64_tr_b16 v[198:199], v29 offset:0
    ds_read_b64_tr_b16 v[206:207], v29 offset:8
    ds_read_b64_tr_b16 v[214:215], v30 offset:0
    ds_read_b64_tr_b16 v[222:223], v30 offset:8
    ds_read_b64_tr_b16 v[230:231], v31 offset:0
    ds_read_b64_tr_b16 v[238:239], v31 offset:8
    s_waitcnt vmcnt(12) lgkmcnt(0)
    s_barrier
    s_cmp_eq_u32 s71, 1
    s_cbranch_scc1 cf_th27
    s_waitcnt vmcnt(6)
cf_th27:
    s_mov_b64 s[8:9], s[54:55]
    s_add_u32 m0, s43, 0
    s_add_u32 s41, s59, 0
    buffer_load_dwordx4 v17, s[8:11], s41 offen offset:0 nt lds
    s_add_u32 s41, s59, 31744
    buffer_load_dwordx4 v17, s[8:11], s41 offen offset:1024 nt lds
    s_add_u32 s41, s59, 129024
    buffer_load_dwordx4 v17, s[8:11], s41 offen offset:2048 nt lds
    s_add_u32 s41, s59, 160768
    buffer_load_dwordx4 v17, s[8:11], s41 offen offset:3072 nt lds
    v_readfirstlane_b32 s94, v54
    v_readfirstlane_b32 s95, v55
    s_cmp_lt_u32 s94, 32
    s_cbranch_scc1 cf_mc
    s_cmp_lg_u32 s13, 0
    s_cbranch_scc1 cf_mc
    v_mov_b32 v76, 1
    v_mov_b32 v77, 0
    s_mov_b64 exec, 1
    buffer_atomic_cmpswap v[76:77], off, s[84:87], 0 offset:28 sc0
    s_mov_b64 exec, -1
cf_mc:
    s_nop 1
    v_add_u32 v28, 36864, v24
    v_add_u32 v29, 36864, v25
    v_add_u32 v30, 36864, v26
    v_add_u32 v31, 36864, v27
    ds_read_b64_tr_b16 a[20:21], v28 offset:0
    ds_read_b64_tr_b16 a[28:29], v28 offset:8
    ds_read_b64_tr_b16 a[36:37], v29 offset:0
    ds_read_b64_tr_b16 a[44:45], v29 offset:8
    ds_read_b64_tr_b16 a[52:53], v30 offset:0
    ds_read_b64_tr_b16 a[60:61], v30 offset:8
    ds_read_b64_tr_b16 a[68:69], v31 offset:0
    ds_read_b64_tr_b16 a[76:77], v31 offset:8
    s_waitcnt vmcnt(12) lgkmcnt(0)
    s_barrier
    s_cmp_eq_u32 s71, 1
    s_cbranch_scc1 cf_th28
    s_waitcnt vmcnt(6)
cf_th28:
    s_mov_b64 s[8:9], s[56:57]
    s_add_u32 m0, s43, 36864
    s_add_u32 s41, s60, 128
    buffer_load_dwordx4 v18, s[8:11], s41 offen offset:0 nt lds
    s_add_u32 s41, s60, 8320
    buffer_load_dwordx4 v18, s[8:11], s41 offen offset:1024 nt lds
    s_add_u32 s41, s60, 16512
    buffer_load_dwordx4 v18, s[8:11], s41 offen offset:2048 nt lds
    s_add_u32 s41, s60, 24704
    buffer_load_dwordx4 v18, s[8:11], s41 offen offset:3072 nt lds
    v_add_u32 v28, 73728, v24
    v_add_u32 v29, 73728, v25
    v_add_u32 v30, 73728, v26
    v_add_u32 v31, 73728, v27
    ds_read_b64_tr_b16 a[22:23], v28 offset:0
    ds_read_b64_tr_b16 a[30:31], v28 offset:8
    ds_read_b64_tr_b16 a[38:39], v29 offset:0
    ds_read_b64_tr_b16 a[46:47], v29 offset:8
    ds_read_b64_tr_b16 a[54:55], v30 offset:0
    ds_read_b64_tr_b16 a[62:63], v30 offset:8
    ds_read_b64_tr_b16 a[70:71], v31 offset:0
    ds_read_b64_tr_b16 a[78:79], v31 offset:8
    s_waitcnt vmcnt(12) lgkmcnt(0)
    s_barrier
    s_cmp_eq_u32 s71, 1
    s_cbranch_scc1 cf_th29
    s_waitcnt vmcnt(6)
cf_th29:
    s_add_u32 m0, s43, 73728
    s_add_u32 s41, s61, 128
    buffer_load_dwordx4 v18, s[8:11], s41 offen offset:0 nt lds
    s_add_u32 s41, s61, 8320
    buffer_load_dwordx4 v18, s[8:11], s41 offen offset:1024 nt lds
    s_add_u32 s41, s61, 16512
    buffer_load_dwordx4 v18, s[8:11], s41 offen offset:2048 nt lds
    s_add_u32 s41, s61, 24704
    buffer_load_dwordx4 v18, s[8:11], s41 offen offset:3072 nt lds
    v_add_u32 v77, 110592, v20
    ds_read_b64_tr_b16 a[216:217], v77 offset:0
    ds_read_b64_tr_b16 a[218:219], v77 offset:4096
    ds_read_b64_tr_b16 a[220:221], v77 offset:8192
    ds_read_b64_tr_b16 a[222:223], v77 offset:12288
    ds_read_b64_tr_b16 a[224:225], v77 offset:8
    ds_read_b64_tr_b16 a[226:227], v77 offset:4104
    ds_read_b64_tr_b16 a[228:229], v77 offset:8200
    ds_read_b64_tr_b16 a[230:231], v77 offset:12296
    s_waitcnt vmcnt(12) lgkmcnt(0)
    s_barrier
    s_cmp_eq_u32 s71, 1
    s_cbranch_scc1 cf_th30
    s_waitcnt vmcnt(6)
cf_th30:
    s_add_u32 m0, s43, 110592
    s_add_u32 s41, s62, 128
    buffer_load_dwordx4 v18, s[8:11], s41 offen offset:0 nt lds
    s_add_u32 s41, s62, 8320
    buffer_load_dwordx4 v18, s[8:11], s41 offen offset:1024 nt lds
    s_add_u32 s41, s62, 16512
    buffer_load_dwordx4 v18, s[8:11], s41 offen offset:2048 nt lds
    s_add_u32 s41, s62, 24704
    buffer_load_dwordx4 v18, s[8:11], s41 offen offset:3072 nt lds
    v_add_u32 v77, 147456, v20
    ds_read_b64_tr_b16 a[80:81], v77 offset:0
    ds_read_b64_tr_b16 a[82:83], v77 offset:4096
    ds_read_b64_tr_b16 a[84:85], v77 offset:8192
    ds_read_b64_tr_b16 a[86:87], v77 offset:12288
    ds_read_b64_tr_b16 a[88:89], v77 offset:8
    ds_read_b64_tr_b16 a[90:91], v77 offset:4104
    ds_read_b64_tr_b16 a[92:93], v77 offset:8200
    ds_read_b64_tr_b16 a[94:95], v77 offset:12296
    s_waitcnt vmcnt(12) lgkmcnt(0)
    s_barrier
    s_cmp_eq_u32 s71, 1
    s_cbranch_scc1 cf_th31
    s_waitcnt vmcnt(6)
cf_th31:
    s_add_u32 m0, s43, 147456
    s_add_u32 s41, s63, 128
    buffer_load_dwordx4 v18, s[8:11], s41 offen offset:0 nt lds
    s_add_u32 s41, s63, 8320
    buffer_load_dwordx4 v18, s[8:11], s41 offen offset:1024 nt lds
    s_add_u32 s41, s63, 16512
    buffer_load_dwordx4 v18, s[8:11], s41 offen offset:2048 nt lds
    s_add_u32 s41, s63, 24704
    buffer_load_dwordx4 v18, s[8:11], s41 offen offset:3072 nt lds
    v_mov_b32 v77, v56
    v_subrev_u32 v77, s95, v77
    v_cmp_lt_u32 vcc, 16, v77
    s_nop 1
    v_cndmask_b32 v77, v77, 0, vcc
    v_bfe_u32 v79, v78, 2, 2
    v_lshl_add_u32 v77, v77, 2, v79
    s_nop 1
    v_min_u32_dpp v77, v77, v77 row_ror:1 row_mask:0xf bank_mask:0xf
    s_nop 1
    v_min_u32_dpp v77, v77, v77 row_ror:2 row_mask:0xf bank_mask:0xf
    s_nop 1
    v_min_u32_dpp v77, v77, v77 row_ror:4 row_mask:0xf bank_mask:0xf
    s_nop 0
    v_readfirstlane_b32 s97, v77
    s_cmp_eq_u32 s95, 0
    s_cselect_b32 s97, 0, s97
    s_cmp_lt_u32 s97, 3
    s_cbranch_scc1 cf_mb
    s_add_u32 s40, s26, 0
    s_min_u32 s40, s40, s99
    s_sub_u32 s41, s96, s40
    v_bfe_u32 v77, v65, 2, 5
    v_add3_u32 v77, v77, s41, 16
    v_lshlrev_b32 v78, 3, v69
    s_nop 0
    v_mov_b32_dpp v78, v77 quad_perm:[0,1,2,3] row_mask:0xc bank_mask:0xf
    buffer_load_dword v63, v78, s[4:7], s40 offen sc1
    s_add_u32 s40, s26, 524288
    s_min_u32 s40, s40, s99
    s_sub_u32 s41, s96, s40
    v_bfe_u32 v77, v65, 2, 5
    v_add3_u32 v77, v77, s41, 16
    v_lshlrev_b32 v78, 3, v69
    s_nop 0
    v_mov_b32_dpp v78, v77 quad_perm:[0,1,2,3] row_mask:0xc bank_mask:0xf
    buffer_load_dword v63, v78, s[4:7], s40 offen sc1
cf_mb:
    v_mov_b32 v78, v21
    v_mov_b32 v79, v22
    v_add_u32 v77, 0, v20
    ds_read_b64_tr_b16 v[240:241], v77 offset:0
    ds_read_b64_tr_b16 v[242:243], v77 offset:4096
    ds_read_b64_tr_b16 v[244:245], v77 offset:8192
    ds_read_b64_tr_b16 v[246:247], v77 offset:12288
    ds_read_b64_tr_b16 v[248:249], v77 offset:8
    ds_read_b64_tr_b16 v[250:251], v77 offset:4104
    ds_read_b64_tr_b16 v[252:253], v77 offset:8200
    ds_read_b64_tr_b16 v[254:255], v77 offset:12296
    s_waitcnt vmcnt(12) lgkmcnt(0)
    s_barrier
    v_bfe_u32 v60, v65, 4, 6
    v_and_b32 v61, 15, v60
    v_lshrrev_b32 v62, 4, v60
    v_mov_b32 v50, 0x3f80
    v_mov_b32 v51, 0x3f800000
    v_and_b32 v57, 1, v62
    v_lshlrev_b32 v57, 2, v57
    v_sub_u32 v57, v61, v57
    v_and_b32 v58, 3, v61
    v_lshlrev_b32 v58, 2, v58
    v_lshrrev_b32 v59, 2, v61
    v_add_u32 v58, v58, v59
    v_cmp_eq_u32 vcc, 0, v57
    s_nop 1
    v_cndmask_b32 v40, 0, v50, vcc
    v_cmp_eq_u32 vcc, 1, v57
    s_nop 1
    v_cndmask_b32 v40, v40, v51, vcc
    v_cmp_eq_u32 vcc, 0, v58
    s_nop 1
    v_cndmask_b32 v44, 0, v50, vcc
    v_cmp_eq_u32 vcc, 1, v58
    s_nop 1
    v_cndmask_b32 v44, v44, v51, vcc
    v_cmp_eq_u32 vcc, 2, v57
    s_nop 1
    v_cndmask_b32 v41, 0, v50, vcc
    v_cmp_eq_u32 vcc, 3, v57
    s_nop 1
    v_cndmask_b32 v41, v41, v51, vcc
    v_cmp_eq_u32 vcc, 2, v58
    s_nop 1
    v_cndmask_b32 v45, 0, v50, vcc
    v_cmp_eq_u32 vcc, 3, v58
    s_nop 1
    v_cndmask_b32 v45, v45, v51, vcc
    v_cmp_eq_u32 vcc, 8, v57
    s_nop 1
    v_cndmask_b32 v42, 0, v50, vcc
    v_cmp_eq_u32 vcc, 9, v57
    s_nop 1
    v_cndmask_b32 v42, v42, v51, vcc
    v_cmp_eq_u32 vcc, 4, v58
    s_nop 1
    v_cndmask_b32 v46, 0, v50, vcc
    v_cmp_eq_u32 vcc, 5, v58
    s_nop 1
    v_cndmask_b32 v46, v46, v51, vcc
    v_cmp_eq_u32 vcc, 10, v57
    s_nop 1
    v_cndmask_b32 v43, 0, v50, vcc
    v_cmp_eq_u32 vcc, 11, v57
    s_nop 1
    v_cndmask_b32 v43, v43, v51, vcc
    v_cmp_eq_u32 vcc, 6, v58
    s_nop 1
    v_cndmask_b32 v47, 0, v50, vcc
    v_cmp_eq_u32 vcc, 7, v58
    s_nop 1
    v_cndmask_b32 v47, v47, v51, vcc
    v_lshlrev_b32 v57, 4, v61
    ds_write_b128 v69, v[40:43] offset:15360
    ds_write_b128 v57, v[44:47] offset:15872
    v_add_u32 v77, 36864, v79
    s_waitcnt lgkmcnt(0)
    ds_read_b64_tr_b16 v[0:1], v77 offset:0
    ds_read_b64_tr_b16 v[2:3], v77 offset:256
    ds_read_b64_tr_b16 v[4:5], v77 offset:2048
    ds_read_b64_tr_b16 v[6:7], v77 offset:2304
    ds_read_b64_tr_b16 v[8:9], v77 offset:16
    ds_read_b64_tr_b16 v[10:11], v77 offset:272
    ds_read_b64_tr_b16 v[12:13], v77 offset:2064
    ds_read_b64_tr_b16 v[14:15], v77 offset:2320
    s_waitcnt vmcnt(8) lgkmcnt(0)
    s_barrier
    s_mov_b32 s44, 0x3e0293ee
    s_mov_b32 s45, s44
    s_or_b32 s66, s44, 0x80000000
    s_mov_b32 s48, 0x3f003f00
    s_mov_b32 s49, 0
    s_mov_b32 s50, 0x3f803f80
    s_mov_b32 s51, 0x3f803f80
    s_mov_b32 s52, 512
    s_mov_b32 s53, 1024
    s_mov_b32 s54, 1536
    s_mov_b32 s30, 0
    s_mov_b32 s37, 0
    s_mov_b32 s98, -100
    s_lshl_b32 s47, s13, 9
    s_cmp_lg_u32 s32, 0
    s_cselect_b32 s71, s13, 3
    s_add_u32 s46, s71, 1
    s_lshr_b32 s46, s46, 1
    s_mov_b32 s14, 67125248
    s_mov_b32 s15, 67129344
    s_mov_b32 s16, 67133440
    s_mov_b32 s36, 0
    s_add_u32 s17, s68, 67108864
    s_mov_b32 s69, 0
    s_mov_b32 s70, 0
    s_lshl_b32 s26, s12, 14
    s_add_u32 s26, s26, 0
    s_mul_i32 s40, s13, 3072
    s_add_u32 s24, s26, s40
    s_add_u32 s26, s24, s33
    s_add_u32 s99, s26, 33030144
    s_lshl_b32 s96, s12, 7
    s_add_u32 s29, s96, 125845504
    s_add_u32 s96, s96, 125829120
    s_lshl_b32 s40, s12, 14
    s_add_u32 s40, s40, 68157440
    s_add_u32 s18, s40, 0
    s_add_u32 s19, s40, 4096
    s_add_u32 s20, s40, 8192
    s_add_u32 s21, s40, 12288
    s_lshr_b32 s40, s12, 3
    s_lshl_b32 s40, s40, 12
    s_and_b32 s41, s12, 7
    s_lshl_b32 s41, s41, 7
    s_add_u32 s40, s40, s41
    s_add_u32 s22, s40, 68157440
    s_add_u32 s23, s22, 1024
    s_add_u32 s25, s22, 2048
    s_mov_b32 s56, -65472
    s_cmp_lg_u32 s32, 0
    s_cselect_b64 s[38:39], -1, 0
    s_add_u32 s55, s68, 138412032
    s_cmp_eq_u32 s13, 3
    s_cselect_b64 s[100:101], 1, 0
    s_cselect_b64 s[38:39], 1, s[38:39]
    s_cselect_b32 s93, 64, 0
    s_cselect_b32 s55, s29, s55
    s_cselect_b32 s57, 0, 9216
    s_mov_b32 s34, 0xff00ff00
    s_mov_b32 s35, 0xff00ff00
    s_lshl_b32 s28, s12, 12
    s_add_u32 s28, s28, 7340032
    s_add_u32 s27, s28, 77594624
    s_add_u32 s28, s28, 69206016
    v_add_u32 v77, 73728, v78
    ds_read_b64_tr_b16 v[16:17], v77 offset:0
    ds_read_b64_tr_b16 v[18:19], v77 offset:256
    ds_read_b64_tr_b16 v[20:21], v77 offset:2048
    ds_read_b64_tr_b16 v[22:23], v77 offset:2304
    ds_read_b64_tr_b16 v[24:25], v77 offset:16
    ds_read_b64_tr_b16 v[26:27], v77 offset:272
    ds_read_b64_tr_b16 v[28:29], v77 offset:2064
    ds_read_b64_tr_b16 v[30:31], v77 offset:2320
    s_waitcnt vmcnt(4) lgkmcnt(0)
    s_barrier
    v_add_u32 v77, 110592, v78
    ds_read_b64_tr_b16 v[32:33], v77 offset:0
    ds_read_b64_tr_b16 v[34:35], v77 offset:256
    ds_read_b64_tr_b16 v[36:37], v77 offset:2048
    ds_read_b64_tr_b16 v[38:39], v77 offset:2304
    ds_read_b64_tr_b16 v[40:41], v77 offset:16
    ds_read_b64_tr_b16 v[42:43], v77 offset:272
    ds_read_b64_tr_b16 v[44:45], v77 offset:2064
    ds_read_b64_tr_b16 v[46:47], v77 offset:2320
    s_waitcnt vmcnt(0) lgkmcnt(0)
    s_barrier
    v_add_u32 v77, 147456, v78
    ds_read_b64_tr_b16 v[48:49], v77 offset:0
    ds_read_b64_tr_b16 v[50:51], v77 offset:256
    ds_read_b64_tr_b16 v[52:53], v77 offset:2048
    ds_read_b64_tr_b16 v[54:55], v77 offset:2304
    ds_read_b64_tr_b16 v[56:57], v77 offset:16
    ds_read_b64_tr_b16 v[58:59], v77 offset:272
    ds_read_b64_tr_b16 v[60:61], v77 offset:2064
    ds_read_b64_tr_b16 v[62:63], v77 offset:2320
    s_waitcnt lgkmcnt(0)
    s_barrier
    ds_write_b128 v70, v[0:3] offset:20480
    ds_write_b128 v70, v[4:7] offset:21504
    ds_write_b128 v70, v[8:11] offset:22528
    ds_write_b128 v70, v[12:15] offset:23552
    ds_write_b128 v70, v[16:19] offset:24576
    ds_write_b128 v70, v[20:23] offset:25600
    ds_write_b128 v70, v[24:27] offset:26624
    ds_write_b128 v70, v[28:31] offset:27648
    ds_write_b128 v70, v[32:35] offset:28672
    ds_write_b128 v70, v[36:39] offset:29696
    ds_write_b128 v70, v[40:43] offset:30720
    ds_write_b128 v70, v[44:47] offset:31744
    ds_write_b128 v70, v[48:51] offset:32768
    ds_write_b128 v70, v[52:55] offset:33792
    ds_write_b128 v70, v[56:59] offset:34816
    ds_write_b128 v70, v[60:63] offset:35840
    s_waitcnt vmcnt(0) lgkmcnt(0)
    s_cmp_lg_u32 s95, 0
    s_cbranch_scc1 cf_hn
    s_mov_b32 s88, 4194304
gn2:
    buffer_load_dword v2, off, s[84:87], 0 offset:216 sc1
    s_waitcnt vmcnt(0)
    v_readfirstlane_b32 s95, v2
    s_sub_u32 s88, s88, 1
    s_cbranch_scc1 gn2x
    s_cmp_eq_u32 s95, 0
    s_cbranch_scc1 gn2
gn2x:
cf_hn:
    v_mov_b32 v2, 1
    s_cmp_lg_u32 s13, 0
    s_cbranch_scc1 cf_noarr
    s_mov_b64 exec, 1
    s_mov_b32 s42, 1
    v_mov_b32 v4, v76
    s_cmp_ge_u32 s94, 32
    s_cbranch_scc1 cf_have
    s_mov_b32 s40, 131072
    s_mov_b32 s42, 2
cf_startpoll:
    buffer_load_dword v3, off, s[84:87], 0 offset:132 sc1
    s_sub_u32 s40, s40, 1
    s_cbranch_scc1 cf_decide
    s_waitcnt vmcnt(0)
    v_readfirstlane_b32 s41, v3
    s_nop 1
    s_cmp_lt_u32 s41, 32
    s_cbranch_scc1 cf_startpoll
    s_mov_b32 s42, 1
cf_decide:
    v_mov_b32 v4, s42
    v_mov_b32 v5, 0
    buffer_atomic_cmpswap v[4:5], off, s[84:87], 0 offset:28 sc0
    s_waitcnt vmcnt(0)
cf_have:
    v_mov_b32 v5, s42
    v_cmp_eq_u32 vcc, 0, v4
    s_nop 1
    v_cndmask_b32 v4, v4, v5, vcc
    v_mov_b32 v5, 16192
    ds_write_b32 v5, v4
    s_waitcnt lgkmcnt(0)
    s_mov_b64 exec, -1
cf_noarr:
    s_barrier
    v_mov_b32 v5, 16192
    ds_read_b32 v4, v5
    s_waitcnt lgkmcnt(0)
    v_readfirstlane_b32 s41, v4
    s_nop 1
    s_cmp_eq_u32 s41, 1
    s_cbranch_scc1 cf_run
    v_lshrrev_b32 v0, 4, v65
    s_mov_b32 s32, s13
    s_load_dwordx16 s[48:63], s[0:1], 0
    s_waitcnt lgkmcnt(0)
    s_branch L_helper
cf_run:
    s_mov_b64 exec, s[100:101]
    v_mov_b32 v72, s95
    s_mov_b64 exec, -1
    s_cmp_ge_u32 s97, 3
    s_cbranch_scc1 cf_kvdone
    s_mov_b32 s40, 3
    v_bfe_u32 v78, v65, 2, 5
    s_mov_b32 s31, 4194304
cf_kv0:
    buffer_load_dword v77, v78, s[4:7], s96 offen offset:16 sc1
    s_waitcnt vmcnt(0)
    v_subrev_u32 v77, s95, v77
    v_cmp_lt_u32 vcc, 16, v77
    s_nop 1
    v_cndmask_b32 v77, v77, 0, vcc
    v_bfe_u32 v79, v78, 2, 2
    v_lshl_add_u32 v77, v77, 2, v79
    s_nop 1
    v_min_u32_dpp v77, v77, v77 row_ror:1 row_mask:0xf bank_mask:0xf
    s_nop 1
    v_min_u32_dpp v77, v77, v77 row_ror:2 row_mask:0xf bank_mask:0xf
    s_nop 1
    v_min_u32_dpp v77, v77, v77 row_ror:4 row_mask:0xf bank_mask:0xf
    s_nop 0
    v_readfirstlane_b32 s97, v77
    s_sub_u32 s31, s31, 1
    s_cbranch_scc1 cf_kv0_x
    s_cmp_le_u32 s40, s97
    s_cbranch_scc1 cf_kv0_x
    s_sleep 2
    s_branch cf_kv0
cf_kv0_x:
    s_add_u32 s40, s26, 0
    s_min_u32 s40, s40, s99
    s_sub_u32 s41, s96, s40
    v_bfe_u32 v77, v65, 2, 5
    v_add3_u32 v77, v77, s41, 16
    v_lshlrev_b32 v78, 3, v69
    s_nop 0
    v_mov_b32_dpp v78, v77 quad_perm:[0,1,2,3] row_mask:0xc bank_mask:0xf
    buffer_load_dword v76, v78, s[4:7], s40 offen sc1
    s_add_u32 s40, s26, 524288
    s_min_u32 s40, s40, s99
    s_sub_u32 s41, s96, s40
    v_bfe_u32 v77, v65, 2, 5
    v_add3_u32 v77, v77, s41, 16
    v_lshlrev_b32 v78, 3, v69
    s_nop 0
    v_mov_b32_dpp v78, v77 quad_perm:[0,1,2,3] row_mask:0xc bank_mask:0xf
    buffer_load_dword v76, v78, s[4:7], s40 offen sc1
cf_kvdone:
    v_mov_b64 v[0:1], 0
    v_mov_b64 v[2:3], 0
    v_mov_b64 v[4:5], 0
    v_mov_b64 v[6:7], 0
    v_mov_b64 v[8:9], 0
    v_mov_b64 v[10:11], 0
    v_mov_b64 v[12:13], 0
    v_mov_b64 v[14:15], 0
    v_mov_b64 v[16:17], 0
    v_mov_b64 v[18:19], 0
    v_mov_b64 v[20:21], 0
    v_mov_b64 v[22:23], 0
    ds_read_b128 v[44:47], v70 offset:0
    ds_read_b128 v[48:51], v70 offset:1024
    ds_read_b128 v[52:55], v70 offset:2048
    ds_read_b128 v[56:59], v70 offset:3072
    ds_read_b128 v[24:27], v70 offset:4096
    ds_read_b128 v[28:31], v70 offset:5120
    ds_read_b128 v[32:35], v70 offset:6144
    ds_read_b128 v[36:39], v70 offset:7168
    buffer_load_dwordx4 v[40:43], v65, s[4:7], s14 offen offset:0 nt
    buffer_load_dwordx4 v[60:63], v66, s[4:7], s14 offen offset:0 nt
    s_mov_b32 s31, 1048576
    s_waitcnt vmcnt(0) lgkmcnt(0)
    s_branch cf_goA
cf_loop:
    s_mov_b32 s31, 1048576
    s_mov_b32 s69, s70
    s_waitcnt lgkmcnt(0)
cf_cA:
    buffer_load_dwordx4 v[40:43], v65, s[4:7], s14 offen offset:0 nt
    buffer_load_dwordx4 v[60:63], v66, s[4:7], s14 offen offset:0 nt
cf_cA1:
    v_bitop3_b32 v77, v40, v60, s70 bitop3:0x7e
    v_and_b32 v77, 1, v77
    v_cmp_ne_u32 vcc, 0, v77
    s_cbranch_vccz cf_goA
    v_bitop3_b32 v77, v40, v60, s70 bitop3:0x7e
    v_and_b32 v77, 1, v77
    v_cmp_ne_u32 vcc, 0, v77
    s_cbranch_vccz cf_goA
    v_bitop3_b32 v77, v40, v60, s70 bitop3:0x7e
    v_and_b32 v77, 1, v77
    v_cmp_ne_u32 vcc, 0, v77
    s_cbranch_vccz cf_goA
    v_bitop3_b32 v77, v40, v60, s70 bitop3:0x7e
    v_and_b32 v77, 1, v77
    v_cmp_ne_u32 vcc, 0, v77
    s_cbranch_vccz cf_goA
    buffer_load_dwordx4 v[40:43], v65, s[4:7], s14 offen offset:0 nt
    buffer_load_dwordx4 v[60:63], v66, s[4:7], s14 offen offset:0 nt
    v_bitop3_b32 v77, v40, v60, s70 bitop3:0x7e
    v_and_b32 v77, 1, v77
    v_cmp_ne_u32 vcc, 0, v77
    s_cbranch_vccz cf_goA
    v_bitop3_b32 v77, v40, v60, s70 bitop3:0x7e
    v_and_b32 v77, 1, v77
    v_cmp_ne_u32 vcc, 0, v77
    s_cbranch_vccz cf_goA
    v_bitop3_b32 v77, v40, v60, s70 bitop3:0x7e
    v_and_b32 v77, 1, v77
    v_cmp_ne_u32 vcc, 0, v77
    s_cbranch_vccz cf_goA
    v_bitop3_b32 v77, v40, v60, s70 bitop3:0x7e
    v_and_b32 v77, 1, v77
    v_cmp_ne_u32 vcc, 0, v77
    s_cbranch_vccz cf_goA
    buffer_load_dwordx4 v[40:43], v65, s[4:7], s14 offen offset:0 nt
    buffer_load_dwordx4 v[60:63], v66, s[4:7], s14 offen offset:0 nt
    v_bitop3_b32 v77, v40, v60, s70 bitop3:0x7e
    v_and_b32 v77, 1, v77
    v_cmp_ne_u32 vcc, 0, v77
    s_cbranch_vccz cf_goA
    v_bitop3_b32 v77, v40, v60, s70 bitop3:0x7e
    v_and_b32 v77, 1, v77
    v_cmp_ne_u32 vcc, 0, v77
    s_cbranch_vccz cf_goA
    v_bitop3_b32 v77, v40, v60, s70 bitop3:0x7e
    v_and_b32 v77, 1, v77
    v_cmp_ne_u32 vcc, 0, v77
    s_cbranch_vccz cf_goA
    v_bitop3_b32 v77, v40, v60, s70 bitop3:0x7e
    v_and_b32 v77, 1, v77
    v_cmp_ne_u32 vcc, 0, v77
    s_cbranch_vccz cf_goA
    buffer_load_dwordx4 v[40:43], v65, s[4:7], s14 offen offset:0 nt
    buffer_load_dwordx4 v[60:63], v66, s[4:7], s14 offen offset:0 nt
    v_bitop3_b32 v77, v40, v60, s70 bitop3:0x7e
    v_and_b32 v77, 1, v77
    v_cmp_ne_u32 vcc, 0, v77
    s_cbranch_vccz cf_goA
    v_bitop3_b32 v77, v40, v60, s70 bitop3:0x7e
    v_and_b32 v77, 1, v77
    v_cmp_ne_u32 vcc, 0, v77
    s_cbranch_vccz cf_goA
    v_bitop3_b32 v77, v40, v60, s70 bitop3:0x7e
    v_and_b32 v77, 1, v77
    v_cmp_ne_u32 vcc, 0, v77
    s_cbranch_vccz cf_goA
    v_bitop3_b32 v77, v40, v60, s70 bitop3:0x7e
    v_and_b32 v77, 1, v77
    v_cmp_ne_u32 vcc, 0, v77
    s_cbranch_vccz cf_goA
    s_sub_u32 s31, s31, 64
    s_cbranch_scc0 cf_cA
cf_goA:
    ds_write_b128 v65, v[40:43] offset:0
    v_smfmac_f32_16x16x64_bf16 v[0:3], v[40:43], v[44:51], v64
    v_smfmac_f32_16x16x64_bf16 v[4:7], v[40:43], v[52:59], v64
    buffer_load_dwordx4 v[44:47], v65, s[4:7], s15 offen offset:0 nt
    v_smfmac_f32_16x16x64_bf16 v[0:3], v[60:63], v[24:31], v64
    s_add_u32 s40, s26, 1048576
    s_min_u32 s40, s40, s99
    s_sub_u32 s41, s96, s40
    v_smfmac_f32_16x16x64_bf16 v[4:7], v[60:63], v[32:39], v64
    ds_read_b128 v[24:27], v70 offset:8192
    s_cmp_lt_u32 s97, s93
    s_cselect_b32 s41, s41, 0
    v_smfmac_f32_16x16x64_bf16 v[8:11], v[40:43], a[96:103], v64
    ds_read_b128 v[28:31], v70 offset:9216
    v_smfmac_f32_16x16x64_bf16 v[12:15], v[40:43], a[104:111], v64
    ds_read_b128 v[32:35], v70 offset:10240
    s_waitcnt lgkmcnt(3)
    s_barrier
    ds_read_b128 v[48:51], v67 offset:0
    v_smfmac_f32_16x16x64_bf16 v[8:11], v[60:63], a[112:119], v64
    ds_read_b128 v[36:39], v70 offset:11264
    v_bitop3_b32 v79, v73, -9, s54 bitop3:0x6a
    v_smfmac_f32_16x16x64_bf16 v[12:15], v[60:63], a[120:127], v64
    buffer_load_dwordx4 v[44:47], v65, s[4:7], s15 offen offset:0 nt
    v_smfmac_f32_16x16x64_bf16 v[16:19], v[40:43], a[232:239], v64
    ds_read_b128 v[52:55], v68 offset:0
    s_waitcnt lgkmcnt(4)
    v_bfe_u32 v77, v65, 2, 5
    v_smfmac_f32_16x16x64_bf16 v[20:23], v[40:43], v[24:31], v64
    ds_read_b128 v[24:27], v70 offset:12288
    s_waitcnt lgkmcnt(3)
    v_smfmac_f32_16x16x64_bf16 v[0:3], v[48:51], a[0:7], v64
    ds_read_b128 v[28:31], v70 offset:13312
    s_waitcnt lgkmcnt(3)
    v_add3_u32 v77, v77, s41, 16
    v_smfmac_f32_16x16x64_bf16 v[4:7], v[48:51], v[32:39], v64
    buffer_load_dwordx4 v[40:43], v65, s[4:7], s16 offen offset:0 nt
    v_smfmac_f32_16x16x64_bf16 v[16:19], v[60:63], a[240:247], v64
    ds_read_b128 v[32:35], v70 offset:14336
    v_lshlrev_b32 v78, 3, v69
    v_smfmac_f32_16x16x64_bf16 v[20:23], v[60:63], a[248:255], v64
    ds_read_b128 v[36:39], v70 offset:15360
    v_smfmac_f32_16x16x64_bf16 v[8:11], v[48:51], a[128:135], v64
    s_waitcnt vmcnt(2)
    v_mov_b32_dpp v78, v77 quad_perm:[0,1,2,3] row_mask:0xc bank_mask:0xf
    v_smfmac_f32_16x16x64_bf16 v[12:15], v[48:51], a[136:143], v64
    buffer_load_dwordx4 v[58:61], v65, s[4:7], s24 offen offset:3072 sc1
    s_waitcnt lgkmcnt(2)
    v_and_b32 v77, s36, v44
    v_smfmac_f32_16x16x64_bf16 v[12:15], v[52:55], v[24:31], v64
    ds_write_b128 v65, v[44:47] offset:4096
    v_smfmac_f32_16x16x64_bf16 v[0:3], v[52:55], a[8:15], v64
    v_cmp_ne_u32 vcc, s70, v77
    v_smfmac_f32_16x16x64_bf16 v[8:11], v[52:55], a[144:151], v64
    buffer_load_dwordx4 v[24:27], v65, s[4:7], s24 offen offset:0 sc1
    s_waitcnt lgkmcnt(1)
    v_smfmac_f32_16x16x64_bf16 v[4:7], v[52:55], v[32:39], v64
    s_cbranch_vccnz cf_spinB
cf_backB:
    v_smfmac_f32_16x16x64_bf16 v[16:19], v[44:47], v[176:183], v64
    s_waitcnt lgkmcnt(0)
    s_barrier
    ds_read_b128 v[48:51], v66 offset:4096
    v_smfmac_f32_16x16x64_bf16 v[12:15], v[44:47], a[160:167], v64
    buffer_load_dwordx4 v[28:31], v65, s[4:7], s24 offen offset:1024 sc1
    v_smfmac_f32_16x16x64_bf16 v[0:3], v[44:47], a[16:23], v64
    ds_read_b128 v[52:55], v67 offset:4096
    v_smfmac_f32_16x16x64_bf16 v[8:11], v[44:47], a[152:159], v64
    v_smfmac_f32_16x16x64_bf16 v[4:7], v[44:47], a[24:31], v64
    buffer_load_dwordx4 v[34:37], v65, s[4:7], s24 offen offset:2048 sc1
    s_waitcnt vmcnt(5)
    v_smfmac_f32_16x16x64_bf16 v[20:23], v[44:47], v[184:191], v64
    ds_read_b128 v[44:47], v68 offset:4096
    s_waitcnt lgkmcnt(2)
    v_smfmac_f32_16x16x64_bf16 v[0:3], v[48:51], a[32:39], v64
    v_smfmac_f32_16x16x64_bf16 v[8:11], v[48:51], a[168:175], v64
    buffer_load_dword v76, v78, s[4:7], s40 offen sc1
    v_smfmac_f32_16x16x64_bf16 v[4:7], v[48:51], a[40:47], v64
    s_waitcnt vmcnt(5)
    v_and_b32 v77, s36, v40
    v_smfmac_f32_16x16x64_bf16 v[12:15], v[48:51], a[176:183], v64
    ds_read_b128 v[48:51], v69 offset:15360
    s_waitcnt lgkmcnt(1)
    v_cmp_ne_u32 vcc, s70, v77
    v_smfmac_f32_16x16x64_bf16 v[0:3], v[52:55], a[48:55], v64
    v_smfmac_f32_16x16x64_bf16 v[8:11], v[52:55], a[184:191], v64
    s_cbranch_vccnz cf_spin8
cf_back8:
    v_smfmac_f32_16x16x64_bf16 v[0:3], v[44:47], a[64:71], v64
    v_smfmac_f32_16x16x64_bf16 v[8:11], v[44:47], a[200:207], v64
    v_smfmac_f32_16x16x64_bf16 v[0:3], v[40:43], a[80:87], v64
    s_nop 1
    v_smfmac_f32_16x16x64_bf16 v[8:11], v[40:43], a[216:223], v64
    s_nop 1
    v_lshrrev_b32 v77, 1, v69
    v_smfmac_f32_16x16x64_bf16 v[4:7], v[52:55], a[56:63], v64
    s_nop 1
    v_cvt_pk_bf16_f32 v0, v0, v1
    v_smfmac_f32_16x16x64_bf16 v[12:15], v[52:55], a[192:199], v64
    s_nop 1
    v_cvt_pk_bf16_f32 v1, v2, v3
    v_smfmac_f32_16x16x64_bf16 v[4:7], v[44:47], a[72:79], v64
    s_nop 1
    v_cvt_pk_bf16_f32 v2, v8, v9
    v_smfmac_f32_16x16x64_bf16 v[12:15], v[44:47], a[208:215], v64
    s_nop 1
    v_cvt_pk_bf16_f32 v3, v10, v11
    v_smfmac_f32_16x16x64_bf16 v[4:7], v[40:43], a[88:95], v64
    s_waitcnt lgkmcnt(0)
    s_nop 0
    s_nop 0
    v_smfmac_f32_16x16x64_bf16 v[12:15], v[40:43], a[224:231], v64
    s_nop 2
    v_mfma_f32_16x16x32_bf16 v[8:11], v[0:3], v[48:51], 0
    s_nop 0
    v_cvt_pk_bf16_f32 v4, v4, v5
    v_cvt_pk_bf16_f32 v5, v6, v7
    s_nop 0
    v_cvt_pk_bf16_f32 v6, v12, v13
    v_cvt_pk_bf16_f32 v7, v14, v15
    s_nop 1
    v_mfma_f32_16x16x32_bf16 v[12:15], v[4:7], v[48:51], 0
    ds_read_b128 v[48:51], v66 offset:4096
    v_cvt_pk_bf16_f32 v0, v8, v9
    v_cvt_pk_bf16_f32 v1, v10, v11
    v_smfmac_f32_16x16x64_bf16 v[16:19], v[52:55], v[208:215], v64
    s_waitcnt vmcnt(2)
    s_nop 2
    v_cvt_pk_bf16_f32 v2, v12, v13
    v_cvt_pk_bf16_f32 v3, v14, v15
    s_nop 1
    v_mfma_f32_16x16x32_bf16 v[12:15], v[0:3], v[0:3], 0
    s_nop 1
    v_bitop3_b32 v78, v73, -9, s53 bitop3:0x6a
    v_mfma_f32_16x16x32_bf16 v[4:7], v[24:27], v[0:3], 0
    ds_read_b128 v[24:27], v67 offset:0
    s_nop 1
    v_mfma_f32_16x16x32_bf16 v[8:11], v[28:31], v[0:3], 0
    s_nop 0
    v_mov_b32_dpp v12, v14 row_ror:8 row_mask:0xf bank_mask:0xc
    v_mov_b32_dpp v13, v15 row_ror:8 row_mask:0xf bank_mask:0xc
    v_smfmac_f32_16x16x64_bf16 v[20:23], v[52:55], v[216:223], v64
    ds_write_b64 v71, v[12:13]
    ds_read_b128 v[52:55], v68 offset:0
    s_nop 1
    v_mov_b32_dpp v4, v8 row_ror:8 row_mask:0xf bank_mask:0xc
    v_mov_b32_dpp v5, v9 row_ror:8 row_mask:0xf bank_mask:0xc
    v_mov_b32_dpp v6, v10 row_ror:8 row_mask:0xf bank_mask:0xc
    v_mov_b32_dpp v7, v11 row_ror:8 row_mask:0xf bank_mask:0xc
    v_smfmac_f32_16x16x64_bf16 v[16:19], v[44:47], v[224:231], v64
    ds_write_b128 v65, v[4:7] offset:8192
    v_smfmac_f32_16x16x64_bf16 v[20:23], v[44:47], v[232:239], v64
    s_waitcnt lgkmcnt(3)
    v_smfmac_f32_16x16x64_bf16 v[16:19], v[24:27], v[144:151], v64
    s_waitcnt vmcnt(1)
    v_smfmac_f32_16x16x64_bf16 v[20:23], v[24:27], v[152:159], v64
    s_mov_b64 exec, s[38:39]
    buffer_store_dword v72, v75, s[4:7], s55 offen sc1
    s_mov_b64 exec, -1
    v_smfmac_f32_16x16x64_bf16 v[16:19], v[40:43], v[240:247], v64
    s_cmp_ge_u32 s30, 56
    s_waitcnt lgkmcnt(0)
    s_barrier
    ds_read_b128 v[8:11], v66 offset:8192
    v_smfmac_f32_16x16x64_bf16 v[20:23], v[40:43], v[248:255], v64
    ds_read_b128 v[12:15], v67 offset:8192
    v_smfmac_f32_16x16x64_bf16 v[16:19], v[48:51], v[192:199], v64
    ds_read_b128 v[44:47], v68 offset:8192
    v_smfmac_f32_16x16x64_bf16 v[20:23], v[48:51], v[200:207], v64
    ds_read_b64 v[24:25], v77 offset:14336
    ds_read_b64 v[26:27], v77 offset:14592
    v_smfmac_f32_16x16x64_bf16 v[16:19], v[52:55], v[160:167], v64
    ds_read_b64 v[28:29], v77 offset:14848
    ds_read_b64 v[30:31], v77 offset:15104
    v_bitop3_b32 v77, v73, -9, s52 bitop3:0x6a
    v_smfmac_f32_16x16x64_bf16 v[20:23], v[52:55], v[168:175], v64
    s_cbranch_scc1 cf_rare
cf_rare_x:
    ds_read_b128 v[48:51], v70 offset:22528
    ds_read_b128 v[52:55], v70 offset:23552
    s_waitcnt lgkmcnt(6)
    v_pk_add_f32 v[4:5], v[4:5], v[8:9]
    v_pk_add_f32 v[6:7], v[6:7], v[10:11]
    v_pk_add_f32 v[12:13], v[12:13], v[44:45]
    v_pk_add_f32 v[14:15], v[14:15], v[46:47]
    v_pk_add_f32 v[4:5], v[4:5], v[12:13]
    v_pk_add_f32 v[6:7], v[6:7], v[14:15]
    s_waitcnt lgkmcnt(2)
    v_pk_add_f32 v[24:25], v[24:25], v[26:27]
    v_pk_add_f32 v[28:29], v[28:29], v[30:31]
    v_max3_f32 v8, v4, v5, v6
    v_pk_add_f32 v[24:25], v[24:25], v[28:29]
    v_max_f32 v8, v8, v7
    v_max3_f32 v8, v8, v24, v25
    v_cvt_pk_bf16_f32 v32, v16, v17
    v_cvt_pk_bf16_f32 v38, v18, v19
    v_max_f32_dpp v8, v8, v8 row_ror:8 row_mask:0xf bank_mask:0xf
    v_mov_b32 v9, v8
    v_cvt_pk_bf16_f32 v56, v20, v21
    v_cvt_pk_bf16_f32 v62, v22, v23
    v_permlane32_swap_b32 v8, v9
    v_max_f32 v8, v8, v9
    v_mov_b32 v9, v8
    v_mov_b32 v11, 0
    v_mov_b32 v15, 0
    v_permlane16_swap_b32 v8, v9
    v_max_f32 v8, v8, v9
    v_mul_f32 v8, s66, v8
    v_pk_fma_f32 v[4:5], v[4:5], s[44:45], v[8:9] op_sel_hi:[1,1,0]
    v_pk_fma_f32 v[6:7], v[6:7], s[44:45], v[8:9] op_sel_hi:[1,1,0]
    v_pk_fma_f32 v[24:25], v[24:25], s[44:45], v[8:9] op_sel_hi:[1,1,0]
    v_exp_f32 v4, v4
    v_exp_f32 v5, v5
    v_exp_f32 v6, v6
    v_exp_f32 v7, v7
    v_exp_f32 v24, v24
    v_exp_f32 v25, v25
    v_cvt_pk_bf16_f32 v12, v4, v5
    v_cvt_pk_bf16_f32 v13, v6, v7
    v_cvt_pk_bf16_f32 v10, v24, v25
    v_cvt_pk_bf16_f32 v14, v24, v25
    v_mov_b64 v[0:1], s[48:49]
    v_mfma_f32_16x16x32_bf16 v[4:7], v[32:35], v[10:13], 0
    ds_read_b128 v[40:43], v70 offset:20480
    v_mov_b64 v[2:3], s[50:51]
    v_mfma_f32_16x16x32_bf16 v[24:27], v[36:39], v[12:15], 0
    ds_read_b128 v[44:47], v70 offset:21504
    v_mov_b64 v[8:9], 0
    v_mfma_f32_16x16x32_bf16 v[28:31], v[0:3], v[10:13], 0
    ds_read_b128 v[32:35], v70 offset:24576
    v_mov_b64 v[0:1], 0
    v_mfma_f32_16x16x32_bf16 v[16:19], v[56:59], v[10:13], 0
    ds_read_b128 v[36:39], v70 offset:25600
    v_mov_b64 v[2:3], 0
    v_mfma_f32_16x16x32_bf16 v[20:23], v[60:63], v[12:15], 0
    ds_read_b128 v[56:59], v70 offset:28672
    v_add_f32_dpp v4, v24, v4 row_ror:8 row_mask:0xf bank_mask:0xf
    v_add_f32_dpp v5, v25, v5 row_ror:8 row_mask:0xf bank_mask:0xf
    v_add_f32_dpp v6, v26, v6 row_ror:8 row_mask:0xf bank_mask:0xf
    v_add_f32_dpp v7, v27, v7 row_ror:8 row_mask:0xf bank_mask:0xf
    v_add_f32_dpp v29, v28, v28 row_ror:8 row_mask:0xf bank_mask:0xf
    v_rcp_f32 v28, v29
    v_mov_b64 v[10:11], 0
    v_add_f32_dpp v4, v16, v20 row_ror:8 row_mask:0xf bank_mask:0xc
    v_add_f32_dpp v5, v17, v21 row_ror:8 row_mask:0xf bank_mask:0xc
    v_add_f32_dpp v6, v18, v22 row_ror:8 row_mask:0xf bank_mask:0xc
    v_add_f32_dpp v7, v19, v23 row_ror:8 row_mask:0xf bank_mask:0xc
    v_pk_mul_f32 v[4:5], v[4:5], v[28:29] op_sel_hi:[1,0]
    v_pk_mul_f32 v[6:7], v[6:7], v[28:29] op_sel_hi:[1,0]
    v_cvt_pk_bf16_f32 v4, v4, v5
    v_cvt_pk_bf16_f32 v5, v6, v7
    ds_write_b64 v73, v[4:5] offset:12288
    v_mov_b32_dpp v6, v4 row_ror:8 row_mask:0xf bank_mask:0xf
    v_mov_b32_dpp v7, v5 row_ror:8 row_mask:0xf bank_mask:0xf
    v_mov_b64 v[12:13], 0
    v_mov_b64 v[14:15], 0
    v_smfmac_f32_16x16x64_bf16 v[8:11], v[4:7], v[80:87], v64
    s_waitcnt lgkmcnt(4)
    v_mov_b64 v[24:25], 0
    v_smfmac_f32_16x16x64_bf16 v[0:3], v[4:7], v[40:47], v64
    ds_read_b128 v[60:63], v70 offset:29696
    v_mov_b64 v[26:27], 0
    v_smfmac_f32_16x16x64_bf16 v[12:15], v[4:7], v[112:119], v64
    s_waitcnt lgkmcnt(1)
    s_barrier
    ds_read_b128 v[16:19], v77 offset:12288
    v_smfmac_f32_16x16x64_bf16 v[24:27], v[4:7], v[48:55], v64
    ds_read_b128 v[20:23], v78 offset:12288
    ds_read_b128 v[28:31], v79 offset:12288
    v_mov_b64 v[4:5], 0
    v_mov_b64 v[6:7], 0
    v_bfe_u32 v77, v74, 16, 1
    v_mad_i32_i24 v77, v77, s56, v74
    s_waitcnt lgkmcnt(2)
    v_smfmac_f32_16x16x64_bf16 v[8:11], v[16:19], v[88:95], v64
    ds_read_b128 v[40:43], v70 offset:32768
    s_waitcnt lgkmcnt(2)
    v_smfmac_f32_16x16x64_bf16 v[8:11], v[20:23], v[96:103], v64
    ds_read_b128 v[44:47], v70 offset:33792
    s_waitcnt lgkmcnt(2)
    v_smfmac_f32_16x16x64_bf16 v[8:11], v[28:31], v[104:111], v64
    ds_read_b128 v[48:51], v70 offset:26624
    s_nop 0
    v_and_b32 v72, 8, v73
    v_smfmac_f32_16x16x64_bf16 v[0:3], v[16:19], v[32:39], v64
    ds_read_b128 v[52:55], v70 offset:27648
    s_nop 0
    v_mad_u32_u24 v72, v72, 63, v73
    v_smfmac_f32_16x16x64_bf16 v[12:15], v[16:19], v[120:127], v64
    ds_read_b128 v[32:35], v70 offset:30720
    v_cvt_pk_bf16_f32 v8, v8, v9
    v_cvt_pk_bf16_f32 v9, v10, v11
    v_and_or_b32 v8, v8, -2, s69
    v_smfmac_f32_16x16x64_bf16 v[12:15], v[20:23], v[128:135], v64
    buffer_store_dwordx2 v[8:9], v74, s[4:7], s22 offen offset:0
    ds_read_b128 v[36:39], v70 offset:31744
    v_smfmac_f32_16x16x64_bf16 v[12:15], v[28:31], v[136:143], v64
    s_add_u32 s30, s30, 1
    s_xor_b32 s70, s70, 1
    v_subrev_u32 v72, s47, v72
    v_smfmac_f32_16x16x64_bf16 v[0:3], v[20:23], v[56:63], v64
    ds_read_b128 v[56:59], v70 offset:34816
    s_waitcnt lgkmcnt(3)
    s_nop 0
    v_smfmac_f32_16x16x64_bf16 v[0:3], v[28:31], v[40:47], v64
    ds_read_b128 v[60:63], v70 offset:35840
    v_cvt_pk_bf16_f32 v12, v12, v13
    v_cvt_pk_bf16_f32 v13, v14, v15
    v_and_or_b32 v12, v12, -2, s69
    v_smfmac_f32_16x16x64_bf16 v[24:27], v[16:19], v[48:55], v64
    buffer_store_dwordx2 v[12:13], v74, s[4:7], s22 offen offset:64
    s_waitcnt lgkmcnt(2)
    v_smfmac_f32_16x16x64_bf16 v[24:27], v[20:23], v[32:39], v64
    ds_read_b128 v[40:43], v70 offset:16384
    v_cvt_pk_bf16_f32 v0, v0, v1
    v_cvt_pk_bf16_f32 v1, v2, v3
    v_and_or_b32 v0, v0, -2, s69
    s_waitcnt lgkmcnt(1)
    v_smfmac_f32_16x16x64_bf16 v[24:27], v[28:31], v[56:63], v64
    buffer_store_dwordx2 v[0:1], v74, s[4:7], s23 offen offset:0
    ds_read_b128 v[44:47], v70 offset:17408
    ds_read_b128 v[8:11], v72 offset:12288
    ds_read_b128 v[48:51], v70 offset:18432
    ds_read_b128 v[52:55], v70 offset:19456
    ds_read_b128 v[12:15], v72 offset:13312
    s_cmp_lg_u32 s71, 0
    s_nop 0
    v_cvt_pk_bf16_f32 v24, v24, v25
    v_cvt_pk_bf16_f32 v25, v26, v27
    v_and_or_b32 v24, v24, -2, s69
    buffer_store_dwordx2 v[24:25], v74, s[4:7], s23 offen offset:64
    s_waitcnt lgkmcnt(3)
    v_smfmac_f32_16x16x64_bf16 v[4:7], v[8:11], v[40:47], v64
    s_waitcnt lgkmcnt(0)
    v_smfmac_f32_16x16x64_bf16 v[4:7], v[12:15], v[48:55], v64
    s_nop 7
    v_cvt_pk_bf16_f32 v4, v4, v5
    v_cvt_pk_bf16_f32 v5, v6, v7
    v_and_or_b32 v4, v4, -2, s69
    buffer_store_dwordx2 v[4:5], v77, s[4:7], s25 offen offset:0
    s_nop 0
    s_cbranch_scc1 cf_e1
    s_cmp_lg_u32 s37, 0
    s_cbranch_scc1 cf_f0_xt
cf_f0_xtx:
    s_nop 2
    v_mov_b32 v79, v79
    s_nop 2
    v_mov_b32 v79, v79
    s_nop 2
    v_mov_b32 v79, v79
    s_nop 2
    v_mov_b32 v79, v79
    s_nop 2
    v_mov_b32 v79, v79
    buffer_load_dwordx4 v[8:11], v65, s[4:7], s18 offen nt
    buffer_load_dwordx4 v[12:15], v65, s[4:7], s19 offen nt
    buffer_load_dwordx4 v[16:19], v65, s[4:7], s20 offen nt
    buffer_load_dwordx4 v[20:23], v65, s[4:7], s21 offen nt
    v_and_b32 v77, 255, v69
    ds_read_b128 v[4:7], v77 offset:15872
    ds_read_b128 v[44:47], v70 offset:0
    ds_read_b128 v[48:51], v70 offset:1024
    ds_read_b128 v[52:55], v70 offset:2048
    ds_read_b128 v[56:59], v70 offset:3072
    ds_read_b128 v[24:27], v70 offset:4096
    ds_read_b128 v[28:31], v70 offset:5120
    ds_read_b128 v[32:35], v70 offset:6144
    ds_read_b128 v[36:39], v70 offset:7168
    s_mov_b32 s31, 65536
    s_add_u32 s24, s24, 524288
    s_add_u32 s26, s26, 524288
    s_add_u32 s55, s55, s57
    s_mov_b32 s14, 67108864
    s_mov_b32 s15, 67112960
    s_mov_b32 s16, 67117056
    s_mov_b32 s36, 1
    v_mov_b32 v40, s69
    v_mov_b32 v60, s69
    v_and_b32 v79, 12, v75
    v_cmp_eq_u32 vcc, 0, v79
    s_nop 1
    v_cndmask_b32 v79, 0, 1, vcc
    s_waitcnt lgkmcnt(0)
    s_waitcnt vmcnt(3)
    v_bitop3_b32 v77, v8, v10, s69 bitop3:0x7e
    v_mfma_f32_16x16x32_bf16 v[0:3], v[4:7], v[8:11], 0
    v_mov_b64 v[8:9], 0
    v_mov_b64 v[10:11], 0
    s_waitcnt vmcnt(2)
    v_bitop3_b32 v78, v12, v14, s69 bitop3:0x7e
    v_mfma_f32_16x16x32_bf16 v[0:3], v[4:7], v[12:15], v[0:3]
    v_or_b32 v77, v77, v78
    v_mov_b64 v[12:13], 0
    v_mov_b64 v[14:15], 0
    s_waitcnt vmcnt(1)
    v_bitop3_b32 v78, v16, v18, s69 bitop3:0x7e
    v_mfma_f32_16x16x32_bf16 v[0:3], v[4:7], v[16:19], v[0:3]
    v_or_b32 v77, v77, v78
    v_mov_b64 v[16:17], 0
    v_mov_b64 v[18:19], 0
    s_waitcnt vmcnt(0)
    v_bitop3_b32 v78, v20, v22, s69 bitop3:0x7e
    v_mfma_f32_16x16x32_bf16 v[0:3], v[4:7], v[20:23], v[0:3]
    v_bitop3_b32 v77, v77, v78, 1 bitop3:0xa8
    v_cmp_ne_u32 vcc, 0, v77
    v_mov_b64 v[20:21], 0
    v_mov_b64 v[22:23], 0
    s_cmp_eq_u64 vcc, 0
    s_cselect_b64 s[42:43], -1, 0
    s_nop 1
    v_add_f32_dpp v0, v0, v0 row_ror:8 row_mask:0xf bank_mask:0xf
    v_add_f32_dpp v1, v1, v1 row_ror:8 row_mask:0xf bank_mask:0xf
    s_mov_b64 exec, s[42:43]
    v_cvt_pk_bf16_f32 v72, v0, v1
    v_bfi_b32 v72, v79, s70, v72
    buffer_store_dword v72, v75, s[4:7], s17 offen offset:0
    s_mov_b64 exec, -1
    s_cbranch_scc0 cf_f0_retry
cf_f0_go:
    v_mov_b64 v[0:1], 0
    v_mov_b64 v[2:3], 0
    v_mov_b64 v[4:5], 0
    v_mov_b64 v[6:7], 0
    s_nop 2
    v_mov_b32 v79, v79
    s_nop 2
    v_mov_b32 v79, v79
    s_nop 2
    v_mov_b32 v79, v79
    s_nop 2
    v_mov_b32 v79, v79
    s_branch cf_loop
cf_e1:
    s_cmp_lg_u32 s71, 2
    s_cbranch_scc1 cf_f1
    v_and_b32 v77, 255, v69
    ds_read_b128 v[4:7], v77 offset:15872
    ds_read_b128 v[44:47], v70 offset:0
    ds_read_b128 v[48:51], v70 offset:1024
    ds_read_b128 v[52:55], v70 offset:2048
    ds_read_b128 v[56:59], v70 offset:3072
    ds_read_b128 v[24:27], v70 offset:4096
    ds_read_b128 v[28:31], v70 offset:5120
    ds_read_b128 v[32:35], v70 offset:6144
    ds_read_b128 v[36:39], v70 offset:7168
    s_mov_b32 s31, 65536
    s_add_u32 s24, s24, 524288
    s_add_u32 s26, s26, 524288
    s_add_u32 s55, s55, s57
    s_mov_b32 s14, 67108864
    s_mov_b32 s15, 67112960
    s_mov_b32 s16, 67117056
    s_mov_b32 s36, 1
    v_mov_b32 v40, s69
    v_mov_b32 v60, s69
    v_and_b32 v79, 12, v75
    v_cmp_eq_u32 vcc, 0, v79
    s_nop 1
    v_cndmask_b32 v79, 0, 1, vcc
    s_cmp_lg_u32 s37, 0
    s_cbranch_scc1 cf_f2_xt
cf_f2_xtx:
    s_nop 2
    v_mov_b32 v79, v79
    s_nop 2
    v_mov_b32 v79, v79
    s_nop 2
    v_mov_b32 v79, v79
    s_nop 2
    v_mov_b32 v79, v79
    s_nop 2
    v_mov_b32 v79, v79
    s_nop 2
    v_mov_b32 v79, v79
    s_nop 2
    v_mov_b32 v79, v79
    s_nop 2
    v_mov_b32 v79, v79
    s_waitcnt vmcnt(0)
    buffer_load_dwordx4 v[8:11], v65, s[4:7], s18 offen nt
    buffer_load_dwordx4 v[12:15], v65, s[4:7], s19 offen nt
    buffer_load_dwordx4 v[16:19], v65, s[4:7], s20 offen nt
    buffer_load_dwordx4 v[20:23], v65, s[4:7], s21 offen nt
    s_nop 2
    v_mov_b32 v79, v79
    s_nop 2
    v_mov_b32 v79, v79
    s_nop 2
    v_mov_b32 v79, v79
    s_nop 2
    v_mov_b32 v79, v79
    s_nop 2
    v_mov_b32 v79, v79
    s_nop 2
    v_mov_b32 v79, v79
    s_nop 2
    v_mov_b32 v79, v79
    s_nop 2
    v_mov_b32 v79, v79
    s_nop 2
    v_mov_b32 v79, v79
    s_nop 2
    v_mov_b32 v79, v79
    buffer_load_dwordx4 v[40:43], v65, s[4:7], s14 offen offset:0 nt
    buffer_load_dwordx4 v[60:63], v66, s[4:7], s14 offen offset:0 nt
    s_waitcnt lgkmcnt(0)
    s_waitcnt vmcnt(5)
    v_bitop3_b32 v77, v8, v10, s69 bitop3:0x7e
    v_mfma_f32_16x16x32_bf16 v[0:3], v[4:7], v[8:11], 0
    v_mov_b64 v[8:9], 0
    v_mov_b64 v[10:11], 0
    s_waitcnt vmcnt(4)
    v_bitop3_b32 v78, v12, v14, s69 bitop3:0x7e
    v_mfma_f32_16x16x32_bf16 v[0:3], v[4:7], v[12:15], v[0:3]
    v_or_b32 v77, v77, v78
    v_mov_b64 v[12:13], 0
    v_mov_b64 v[14:15], 0
    s_waitcnt vmcnt(3)
    v_bitop3_b32 v78, v16, v18, s69 bitop3:0x7e
    v_mfma_f32_16x16x32_bf16 v[0:3], v[4:7], v[16:19], v[0:3]
    v_or_b32 v77, v77, v78
    v_mov_b64 v[16:17], 0
    v_mov_b64 v[18:19], 0
    s_waitcnt vmcnt(2)
    v_bitop3_b32 v78, v20, v22, s69 bitop3:0x7e
    v_mfma_f32_16x16x32_bf16 v[0:3], v[4:7], v[20:23], v[0:3]
    v_bitop3_b32 v77, v77, v78, 1 bitop3:0xa8
    v_cmp_ne_u32 vcc, 0, v77
    v_mov_b64 v[20:21], 0
    v_mov_b64 v[22:23], 0
    buffer_load_dwordx4 v[40:43], v65, s[4:7], s14 offen offset:0 nt
    buffer_load_dwordx4 v[60:63], v66, s[4:7], s14 offen offset:0 nt
    s_cmp_eq_u64 vcc, 0
    s_cselect_b64 s[42:43], -1, 0
    v_add_f32_dpp v0, v0, v0 row_ror:4 row_mask:0xf bank_mask:0xf
    v_add_f32_dpp v1, v1, v1 row_ror:4 row_mask:0xf bank_mask:0xf
    s_nop 0
    v_add_f32_dpp v0, v0, v0 row_ror:8 row_mask:0xf bank_mask:0xf
    v_add_f32_dpp v1, v1, v1 row_ror:8 row_mask:0xf bank_mask:0xf
    s_mov_b64 exec, s[42:43]
    v_cvt_pk_bf16_f32 v72, v0, v1
    v_bfi_b32 v72, v79, s70, v72
    buffer_store_dword v72, v75, s[4:7], s17 offen offset:0
    buffer_store_dword v72, v75, s[4:7], s17 offen offset:1024
    buffer_store_dword v72, v75, s[4:7], s17 offen offset:2048
    buffer_store_dword v72, v75, s[4:7], s17 offen offset:3072
    s_mov_b64 exec, -1
    s_cbranch_scc0 cf_f2_retry
cf_f2_go:
    v_mov_b64 v[0:1], 0
    v_mov_b64 v[2:3], 0
    v_mov_b64 v[4:5], 0
    v_mov_b64 v[6:7], 0
    s_branch cf_loop
cf_f1:
    s_cmp_lg_u32 s32, 1
    s_cbranch_scc1 cf_f3
    v_and_b32 v77, 255, v69
    ds_read_b128 v[4:7], v77 offset:15872
    ds_read_b128 v[44:47], v70 offset:0
    ds_read_b128 v[48:51], v70 offset:1024
    ds_read_b128 v[52:55], v70 offset:2048
    ds_read_b128 v[56:59], v70 offset:3072
    ds_read_b128 v[24:27], v70 offset:4096
    ds_read_b128 v[28:31], v70 offset:5120
    ds_read_b128 v[32:35], v70 offset:6144
    ds_read_b128 v[36:39], v70 offset:7168
    s_mov_b32 s31, 65536
    s_add_u32 s24, s24, 524288
    s_add_u32 s26, s26, 524288
    s_add_u32 s55, s55, s57
    s_mov_b32 s14, 67108864
    s_mov_b32 s15, 67112960
    s_mov_b32 s16, 67117056
    s_mov_b32 s36, 1
    v_mov_b32 v40, s69
    v_mov_b32 v60, s69
    v_and_b32 v79, 12, v75
    v_cmp_eq_u32 vcc, 0, v79
    s_nop 1
    v_cndmask_b32 v79, 0, 1, vcc
    s_cmp_lg_u32 s37, 0
    s_cbranch_scc1 cf_f1_xt
cf_f1_xtx:
    s_nop 2
    v_mov_b32 v79, v79
    s_waitcnt vmcnt(0)
    buffer_load_dwordx4 v[8:11], v65, s[4:7], s18 offen nt
    buffer_load_dwordx4 v[12:15], v65, s[4:7], s19 offen nt
    buffer_load_dwordx4 v[16:19], v65, s[4:7], s20 offen nt
    buffer_load_dwordx4 v[20:23], v65, s[4:7], s21 offen nt
    s_nop 2
    v_mov_b32 v79, v79
    s_nop 2
    v_mov_b32 v79, v79
    s_nop 2
    v_mov_b32 v79, v79
    s_nop 2
    v_mov_b32 v79, v79
    s_nop 2
    v_mov_b32 v79, v79
    s_nop 2
    v_mov_b32 v79, v79
    s_nop 2
    v_mov_b32 v79, v79
    s_nop 2
    v_mov_b32 v79, v79
    s_nop 2
    v_mov_b32 v79, v79
    s_nop 2
    v_mov_b32 v79, v79
    buffer_load_dwordx4 v[40:43], v65, s[4:7], s14 offen offset:0 nt
    buffer_load_dwordx4 v[60:63], v66, s[4:7], s14 offen offset:0 nt
    s_waitcnt lgkmcnt(0)
    s_waitcnt vmcnt(5)
    v_bitop3_b32 v77, v8, v10, s69 bitop3:0x7e
    v_mfma_f32_16x16x32_bf16 v[0:3], v[4:7], v[8:11], 0
    v_mov_b64 v[8:9], 0
    v_mov_b64 v[10:11], 0
    s_waitcnt vmcnt(4)
    v_bitop3_b32 v78, v12, v14, s69 bitop3:0x7e
    v_mfma_f32_16x16x32_bf16 v[0:3], v[4:7], v[12:15], v[0:3]
    v_or_b32 v77, v77, v78
    v_mov_b64 v[12:13], 0
    v_mov_b64 v[14:15], 0
    s_waitcnt vmcnt(3)
    v_bitop3_b32 v78, v16, v18, s69 bitop3:0x7e
    v_mfma_f32_16x16x32_bf16 v[0:3], v[4:7], v[16:19], v[0:3]
    v_or_b32 v77, v77, v78
    v_mov_b64 v[16:17], 0
    v_mov_b64 v[18:19], 0
    s_waitcnt vmcnt(2)
    v_bitop3_b32 v78, v20, v22, s69 bitop3:0x7e
    v_mfma_f32_16x16x32_bf16 v[0:3], v[4:7], v[20:23], v[0:3]
    v_bitop3_b32 v77, v77, v78, 1 bitop3:0xa8
    v_cmp_ne_u32 vcc, 0, v77
    v_mov_b64 v[20:21], 0
    v_mov_b64 v[22:23], 0
    buffer_load_dwordx4 v[40:43], v65, s[4:7], s14 offen offset:0 nt
    buffer_load_dwordx4 v[60:63], v66, s[4:7], s14 offen offset:0 nt
    s_cmp_eq_u64 vcc, 0
    s_cselect_b64 s[42:43], -1, 0
    v_add_f32_dpp v0, v0, v0 row_ror:8 row_mask:0xf bank_mask:0xf
    v_add_f32_dpp v1, v1, v1 row_ror:8 row_mask:0xf bank_mask:0xf
    s_mov_b64 exec, s[42:43]
    v_cvt_pk_bf16_f32 v72, v0, v1
    v_bfi_b32 v72, v79, s70, v72
    buffer_store_dword v72, v75, s[4:7], s17 offen offset:0
    s_mov_b64 exec, -1
    s_cbranch_scc0 cf_f1_retry
cf_f1_go:
    v_mov_b64 v[0:1], 0
    v_mov_b64 v[2:3], 0
    v_mov_b64 v[4:5], 0
    v_mov_b64 v[6:7], 0
    s_branch cf_loop
cf_f3:
    v_and_b32 v77, 255, v69
    ds_read_b128 v[4:7], v77 offset:15872
    ds_read_b128 v[44:47], v70 offset:0
    ds_read_b128 v[48:51], v70 offset:1024
    ds_read_b128 v[52:55], v70 offset:2048
    ds_read_b128 v[56:59], v70 offset:3072
    ds_read_b128 v[24:27], v70 offset:4096
    ds_read_b128 v[28:31], v70 offset:5120
    ds_read_b128 v[32:35], v70 offset:6144
    ds_read_b128 v[36:39], v70 offset:7168
    s_mov_b32 s31, 65536
    s_add_u32 s24, s24, 524288
    s_add_u32 s26, s26, 524288
    s_add_u32 s55, s55, s57
    s_mov_b32 s14, 67108864
    s_mov_b32 s15, 67112960
    s_mov_b32 s16, 67117056
    s_mov_b32 s36, 1
    v_mov_b32 v40, s69
    v_mov_b32 v60, s69
    v_and_b32 v79, 12, v75
    v_cmp_eq_u32 vcc, 0, v79
    s_nop 1
    v_cndmask_b32 v79, 0, 1, vcc
    s_add_u32 s40, s30, s95
    v_mov_b32 v72, s40
    s_waitcnt lgkmcnt(0)
    v_mov_b64 v[0:1], 0
    v_mov_b64 v[2:3], 0
    v_mov_b64 v[4:5], 0
    v_mov_b64 v[6:7], 0
    v_mov_b64 v[8:9], 0
    v_mov_b64 v[10:11], 0
    v_mov_b64 v[12:13], 0
    v_mov_b64 v[14:15], 0
    v_mov_b64 v[16:17], 0
    v_mov_b64 v[18:19], 0
    v_mov_b64 v[20:21], 0
    v_mov_b64 v[22:23], 0
    s_nop 2
    v_mov_b32 v79, v79
    s_nop 2
    v_mov_b32 v79, v79
    s_nop 2
    v_mov_b32 v79, v79
    s_nop 2
    v_mov_b32 v79, v79
    s_nop 2
    v_mov_b32 v79, v79
    s_nop 2
    v_mov_b32 v79, v79
    s_nop 2
    v_mov_b32 v79, v79
    s_nop 2
    v_mov_b32 v79, v79
    s_nop 2
    v_mov_b32 v79, v79
    s_waitcnt vmcnt(0)
    s_cmp_lt_u32 s97, s93
    s_cbranch_scc1 cf_kvwait
    s_nop 2
    v_mov_b32 v79, v79
    s_nop 2
    v_mov_b32 v79, v79
    s_nop 2
    v_mov_b32 v79, v79
    s_nop 2
    v_mov_b32 v79, v79
    s_nop 2
    v_mov_b32 v79, v79
    s_nop 2
    v_mov_b32 v79, v79
    s_nop 2
    v_mov_b32 v79, v79
    s_nop 2
    v_mov_b32 v79, v79
cf_kvok:
    s_branch cf_loop
cf_f0_xt:
    s_sub_u32 s37, s37, 1
    s_nop 2
    v_mov_b32 v79, v79
    s_nop 2
    v_mov_b32 v79, v79
    s_nop 2
    v_mov_b32 v79, v79
    s_nop 2
    v_mov_b32 v79, v79
    s_nop 2
    v_mov_b32 v79, v79
    s_nop 2
    v_mov_b32 v79, v79
    s_branch cf_f0_xtx
cf_f0_retry:
    s_sub_u32 s41, s30, s98
    s_mov_b32 s98, s30
    s_cmp_le_u32 s41, 3
    s_cselect_b32 s37, 1, 1
cf_f0_spin:
    buffer_load_dwordx4 v[8:11], v65, s[4:7], s18 offen nt
    buffer_load_dwordx4 v[12:15], v65, s[4:7], s19 offen nt
    buffer_load_dwordx4 v[16:19], v65, s[4:7], s20 offen nt
    buffer_load_dwordx4 v[20:23], v65, s[4:7], s21 offen nt
    s_nop 2
    v_mov_b32 v79, v79
    s_nop 2
    v_mov_b32 v79, v79
    s_nop 2
    v_mov_b32 v79, v79
    buffer_load_dwordx4 v[40:43], v65, s[4:7], s14 offen offset:0 nt
    buffer_load_dwordx4 v[60:63], v66, s[4:7], s14 offen offset:0 nt
    s_waitcnt vmcnt(5)
    v_bitop3_b32 v77, v8, v10, s69 bitop3:0x7e
    v_mfma_f32_16x16x32_bf16 v[0:3], v[4:7], v[8:11], 0
    v_mov_b64 v[8:9], 0
    v_mov_b64 v[10:11], 0
    s_waitcnt vmcnt(4)
    v_bitop3_b32 v78, v12, v14, s69 bitop3:0x7e
    v_mfma_f32_16x16x32_bf16 v[0:3], v[4:7], v[12:15], v[0:3]
    v_or_b32 v77, v77, v78
    v_mov_b64 v[12:13], 0
    v_mov_b64 v[14:15], 0
    s_waitcnt vmcnt(3)
    v_bitop3_b32 v78, v16, v18, s69 bitop3:0x7e
    v_mfma_f32_16x16x32_bf16 v[0:3], v[4:7], v[16:19], v[0:3]
    v_or_b32 v77, v77, v78
    v_mov_b64 v[16:17], 0
    v_mov_b64 v[18:19], 0
    s_waitcnt vmcnt(2)
    v_bitop3_b32 v78, v20, v22, s69 bitop3:0x7e
    v_mfma_f32_16x16x32_bf16 v[0:3], v[4:7], v[20:23], v[0:3]
    v_bitop3_b32 v77, v77, v78, 1 bitop3:0xa8
    v_cmp_ne_u32 vcc, 0, v77
    v_mov_b64 v[20:21], 0
    v_mov_b64 v[22:23], 0
    buffer_load_dwordx4 v[40:43], v65, s[4:7], s14 offen offset:0 nt
    buffer_load_dwordx4 v[60:63], v66, s[4:7], s14 offen offset:0 nt
    s_cmp_eq_u64 vcc, 0
    s_cselect_b64 s[42:43], -1, 0
    v_add_f32_dpp v0, v0, v0 row_ror:8 row_mask:0xf bank_mask:0xf
    v_add_f32_dpp v1, v1, v1 row_ror:8 row_mask:0xf bank_mask:0xf
    s_mov_b64 exec, s[42:43]
    v_cvt_pk_bf16_f32 v72, v0, v1
    v_bfi_b32 v72, v79, s70, v72
    buffer_store_dword v72, v75, s[4:7], s17 offen offset:0
    s_mov_b64 exec, -1
    s_cbranch_scc1 cf_f0_rx
    s_sub_u32 s31, s31, 1
    s_cbranch_scc0 cf_f0_spin
cf_f0_rx:
    v_mov_b64 v[0:1], 0
    v_mov_b64 v[2:3], 0
    v_mov_b64 v[4:5], 0
    v_mov_b64 v[6:7], 0
    s_branch cf_loop
cf_f1_xt:
    s_sub_u32 s37, s37, 1
    s_nop 2
    v_mov_b32 v79, v79
    s_nop 2
    v_mov_b32 v79, v79
    s_nop 2
    v_mov_b32 v79, v79
    s_nop 2
    v_mov_b32 v79, v79
    s_nop 2
    v_mov_b32 v79, v79
    s_nop 2
    v_mov_b32 v79, v79
    s_branch cf_f1_xtx
cf_f1_retry:
    s_sub_u32 s41, s30, s98
    s_mov_b32 s98, s30
    s_cmp_le_u32 s41, 3
    s_cselect_b32 s37, 1, 1
cf_f1_spin:
    buffer_load_dwordx4 v[8:11], v65, s[4:7], s18 offen nt
    buffer_load_dwordx4 v[12:15], v65, s[4:7], s19 offen nt
    buffer_load_dwordx4 v[16:19], v65, s[4:7], s20 offen nt
    buffer_load_dwordx4 v[20:23], v65, s[4:7], s21 offen nt
    s_nop 2
    v_mov_b32 v79, v79
    s_nop 2
    v_mov_b32 v79, v79
    s_nop 2
    v_mov_b32 v79, v79
    buffer_load_dwordx4 v[40:43], v65, s[4:7], s14 offen offset:0 nt
    buffer_load_dwordx4 v[60:63], v66, s[4:7], s14 offen offset:0 nt
    s_waitcnt vmcnt(5)
    v_bitop3_b32 v77, v8, v10, s69 bitop3:0x7e
    v_mfma_f32_16x16x32_bf16 v[0:3], v[4:7], v[8:11], 0
    v_mov_b64 v[8:9], 0
    v_mov_b64 v[10:11], 0
    s_waitcnt vmcnt(4)
    v_bitop3_b32 v78, v12, v14, s69 bitop3:0x7e
    v_mfma_f32_16x16x32_bf16 v[0:3], v[4:7], v[12:15], v[0:3]
    v_or_b32 v77, v77, v78
    v_mov_b64 v[12:13], 0
    v_mov_b64 v[14:15], 0
    s_waitcnt vmcnt(3)
    v_bitop3_b32 v78, v16, v18, s69 bitop3:0x7e
    v_mfma_f32_16x16x32_bf16 v[0:3], v[4:7], v[16:19], v[0:3]
    v_or_b32 v77, v77, v78
    v_mov_b64 v[16:17], 0
    v_mov_b64 v[18:19], 0
    s_waitcnt vmcnt(2)
    v_bitop3_b32 v78, v20, v22, s69 bitop3:0x7e
    v_mfma_f32_16x16x32_bf16 v[0:3], v[4:7], v[20:23], v[0:3]
    v_bitop3_b32 v77, v77, v78, 1 bitop3:0xa8
    v_cmp_ne_u32 vcc, 0, v77
    v_mov_b64 v[20:21], 0
    v_mov_b64 v[22:23], 0
    buffer_load_dwordx4 v[40:43], v65, s[4:7], s14 offen offset:0 nt
    buffer_load_dwordx4 v[60:63], v66, s[4:7], s14 offen offset:0 nt
    s_cmp_eq_u64 vcc, 0
    s_cselect_b64 s[42:43], -1, 0
    v_add_f32_dpp v0, v0, v0 row_ror:8 row_mask:0xf bank_mask:0xf
    v_add_f32_dpp v1, v1, v1 row_ror:8 row_mask:0xf bank_mask:0xf
    s_mov_b64 exec, s[42:43]
    v_cvt_pk_bf16_f32 v72, v0, v1
    v_bfi_b32 v72, v79, s70, v72
    buffer_store_dword v72, v75, s[4:7], s17 offen offset:0
    s_mov_b64 exec, -1
    s_cbranch_scc1 cf_f1_rx
    s_sub_u32 s31, s31, 1
    s_cbranch_scc0 cf_f1_spin
cf_f1_rx:
    v_mov_b64 v[0:1], 0
    v_mov_b64 v[2:3], 0
    v_mov_b64 v[4:5], 0
    v_mov_b64 v[6:7], 0
    s_branch cf_loop
cf_f2_xt:
    s_sub_u32 s37, s37, 1
    s_nop 2
    v_mov_b32 v79, v79
    s_nop 2
    v_mov_b32 v79, v79
    s_nop 2
    v_mov_b32 v79, v79
    s_nop 2
    v_mov_b32 v79, v79
    s_nop 2
    v_mov_b32 v79, v79
    s_nop 2
    v_mov_b32 v79, v79
    s_branch cf_f2_xtx
cf_f2_retry:
    s_sub_u32 s41, s30, s98
    s_mov_b32 s98, s30
    s_cmp_le_u32 s41, 3
    s_cselect_b32 s37, 1, 1
cf_f2_spin:
    buffer_load_dwordx4 v[8:11], v65, s[4:7], s18 offen nt
    buffer_load_dwordx4 v[12:15], v65, s[4:7], s19 offen nt
    buffer_load_dwordx4 v[16:19], v65, s[4:7], s20 offen nt
    buffer_load_dwordx4 v[20:23], v65, s[4:7], s21 offen nt
    s_nop 2
    v_mov_b32 v79, v79
    s_nop 2
    v_mov_b32 v79, v79
    s_nop 2
    v_mov_b32 v79, v79
    buffer_load_dwordx4 v[40:43], v65, s[4:7], s14 offen offset:0 nt
    buffer_load_dwordx4 v[60:63], v66, s[4:7], s14 offen offset:0 nt
    s_waitcnt vmcnt(5)
    v_bitop3_b32 v77, v8, v10, s69 bitop3:0x7e
    v_mfma_f32_16x16x32_bf16 v[0:3], v[4:7], v[8:11], 0
    v_mov_b64 v[8:9], 0
    v_mov_b64 v[10:11], 0
    s_waitcnt vmcnt(4)
    v_bitop3_b32 v78, v12, v14, s69 bitop3:0x7e
    v_mfma_f32_16x16x32_bf16 v[0:3], v[4:7], v[12:15], v[0:3]
    v_or_b32 v77, v77, v78
    v_mov_b64 v[12:13], 0
    v_mov_b64 v[14:15], 0
    s_waitcnt vmcnt(3)
    v_bitop3_b32 v78, v16, v18, s69 bitop3:0x7e
    v_mfma_f32_16x16x32_bf16 v[0:3], v[4:7], v[16:19], v[0:3]
    v_or_b32 v77, v77, v78
    v_mov_b64 v[16:17], 0
    v_mov_b64 v[18:19], 0
    s_waitcnt vmcnt(2)
    v_bitop3_b32 v78, v20, v22, s69 bitop3:0x7e
    v_mfma_f32_16x16x32_bf16 v[0:3], v[4:7], v[20:23], v[0:3]
    v_bitop3_b32 v77, v77, v78, 1 bitop3:0xa8
    v_cmp_ne_u32 vcc, 0, v77
    v_mov_b64 v[20:21], 0
    v_mov_b64 v[22:23], 0
    buffer_load_dwordx4 v[40:43], v65, s[4:7], s14 offen offset:0 nt
    buffer_load_dwordx4 v[60:63], v66, s[4:7], s14 offen offset:0 nt
    s_cmp_eq_u64 vcc, 0
    s_cselect_b64 s[42:43], -1, 0
    v_add_f32_dpp v0, v0, v0 row_ror:4 row_mask:0xf bank_mask:0xf
    v_add_f32_dpp v1, v1, v1 row_ror:4 row_mask:0xf bank_mask:0xf
    s_nop 0
    v_add_f32_dpp v0, v0, v0 row_ror:8 row_mask:0xf bank_mask:0xf
    v_add_f32_dpp v1, v1, v1 row_ror:8 row_mask:0xf bank_mask:0xf
    s_mov_b64 exec, s[42:43]
    v_cvt_pk_bf16_f32 v72, v0, v1
    v_bfi_b32 v72, v79, s70, v72
    buffer_store_dword v72, v75, s[4:7], s17 offen offset:0
    buffer_store_dword v72, v75, s[4:7], s17 offen offset:1024
    buffer_store_dword v72, v75, s[4:7], s17 offen offset:2048
    buffer_store_dword v72, v75, s[4:7], s17 offen offset:3072
    s_mov_b64 exec, -1
    s_cbranch_scc1 cf_f2_rx
    s_sub_u32 s31, s31, 1
    s_cbranch_scc0 cf_f2_spin
cf_f2_rx:
    v_mov_b64 v[0:1], 0
    v_mov_b64 v[2:3], 0
    v_mov_b64 v[4:5], 0
    v_mov_b64 v[6:7], 0
    s_branch cf_loop
cf_spinB:
    s_waitcnt vmcnt(3)
cf_spinB_l:
    v_and_b32 v77, s36, v44
    v_cmp_ne_u32 vcc, s70, v77
    s_cbranch_vccz cf_spinB_x
    buffer_load_dwordx4 v[44:47], v65, s[4:7], s15 offen nt
    s_sub_u32 s31, s31, 16
    s_waitcnt vmcnt(0)
    s_cbranch_scc0 cf_spinB_l
cf_spinB_x:
    ds_write_b128 v65, v[44:47] offset:4096
    s_waitcnt lgkmcnt(0)
    s_branch cf_backB
cf_spin8:
    buffer_load_dwordx4 v[40:43], v65, s[4:7], s16 offen nt
cf_spin8_l:
    v_and_b32 v77, s36, v40
    v_cmp_ne_u32 vcc, s70, v77
    s_cbranch_vccz cf_spin8_x
    s_nop 1
    v_and_b32 v77, s36, v40
    v_cmp_ne_u32 vcc, s70, v77
    s_cbranch_vccz cf_spin8_x
    s_nop 1
    v_and_b32 v77, s36, v40
    v_cmp_ne_u32 vcc, s70, v77
    s_cbranch_vccz cf_spin8_x
    s_nop 1
    buffer_load_dwordx4 v[40:43], v65, s[4:7], s16 offen nt
    s_sub_u32 s31, s31, 16
    s_cbranch_scc0 cf_spin8_l
cf_spin8_x:
    s_branch cf_back8
cf_rare:
    s_mov_b64 exec, s[34:35]
    buffer_store_dwordx4 v[0:3], v65, s[4:7], s28 offen sc1
    s_mov_b64 exec, -1
    s_nop 3
    v_cvt_pk_bf16_f32 v52, v16, v17
    v_cvt_pk_bf16_f32 v53, v18, v19
    v_cvt_pk_bf16_f32 v54, v20, v21
    v_cvt_pk_bf16_f32 v55, v22, v23
    buffer_store_dwordx4 v[52:55], v65, s[4:7], s27 offen sc1
    s_add_u32 s28, s28, 131072
    s_add_u32 s27, s27, 131072
    s_cmp_eq_u32 s30, 63
    s_cbranch_scc1 cf_last
    s_branch cf_rare_x
cf_kvwait:
    s_mov_b32 s41, s97
    v_bfe_u32 v78, v65, 2, 5
    v_mov_b32 v77, v76
    s_nop 1
    v_permlane32_swap_b32 v76, v77
    v_subrev_u32 v77, s95, v77
    v_cmp_lt_u32 vcc, 16, v77
    s_nop 1
    v_cndmask_b32 v77, v77, 0, vcc
    v_bfe_u32 v79, v78, 2, 2
    v_lshl_add_u32 v77, v77, 2, v79
    s_nop 1
    v_min_u32_dpp v77, v77, v77 row_ror:1 row_mask:0xf bank_mask:0xf
    s_nop 1
    v_min_u32_dpp v77, v77, v77 row_ror:2 row_mask:0xf bank_mask:0xf
    s_nop 1
    v_min_u32_dpp v77, v77, v77 row_ror:4 row_mask:0xf bank_mask:0xf
    s_nop 0
    v_readfirstlane_b32 s97, v77
    s_nop 0
    s_max_u32 s97, s97, s41
    s_add_u32 s40, s30, 3
    s_min_u32 s40, s40, 64
    s_cmp_le_u32 s40, s97
    s_cbranch_scc1 cf_kvw_x
    v_bfe_u32 v78, v65, 2, 5
    s_mov_b32 s31, 4194304
cf_kvw:
    buffer_load_dword v77, v78, s[4:7], s96 offen offset:16 sc1
    s_waitcnt vmcnt(0)
    v_subrev_u32 v77, s95, v77
    v_cmp_lt_u32 vcc, 16, v77
    s_nop 1
    v_cndmask_b32 v77, v77, 0, vcc
    v_bfe_u32 v79, v78, 2, 2
    v_lshl_add_u32 v77, v77, 2, v79
    s_nop 1
    v_min_u32_dpp v77, v77, v77 row_ror:1 row_mask:0xf bank_mask:0xf
    s_nop 1
    v_min_u32_dpp v77, v77, v77 row_ror:2 row_mask:0xf bank_mask:0xf
    s_nop 1
    v_min_u32_dpp v77, v77, v77 row_ror:4 row_mask:0xf bank_mask:0xf
    s_nop 0
    v_readfirstlane_b32 s97, v77
    s_sub_u32 s31, s31, 1
    s_cbranch_scc1 cf_kvw_x
    s_cmp_le_u32 s40, s97
    s_cbranch_scc1 cf_kvw_x
    s_sleep 2
    s_branch cf_kvw
cf_kvw_x:
    s_branch cf_kvok
cf_last:
    s_add_u32 s40, s95, 64
    v_mov_b32 v78, s40
    s_waitcnt vmcnt(0)
    s_barrier
    s_mov_b64 exec, s[100:101]
    buffer_store_dword v78, off, s[4:7], s29 sc1
    s_mov_b64 exec, -1
cf_end:
    s_endpgm
L_chain_safe:
    s_mov_b64 s[48:49], s[50:51]
    s_mov_b64 s[50:51], s[52:53]
    s_mov_b64 s[52:53], s[54:55]
    s_mov_b64 s[54:55], s[56:57]
    s_mov_b64 s[56:57], s[58:59]
    v_lshrrev_b32 v77, 6, v0
    s_nop 0
    v_readfirstlane_b32 s13, v77
    v_lshlrev_b32 v65, 4, v0
    v_and_b32 v48, 63, v0
    s_mov_b32 s10, 4718592
    s_mov_b32 s11, 0x20000
    v_lshrrev_b32 v49, 3, v48
    v_mul_u32_u24 v18, 1152, v49
    v_and_b32 v49, 7, v48
    v_lshl_add_u32 v18, v49, 4, v18
    s_mul_i32 s40, s12, 147456
    s_lshl_b32 s41, s13, 8
    s_add_u32 s40, s40, s41
    s_mov_b32 s42, s40
    s_xor_b32 s41, s13, 0
    s_mul_i32 s41, s41, 36864
    s_add_u32 s60, s41, s40
    s_xor_b32 s41, s13, 1
    s_mul_i32 s41, s41, 36864
    s_add_u32 s61, s41, s40
    s_xor_b32 s41, s13, 2
    s_mul_i32 s41, s41, 36864
    s_add_u32 s62, s41, s40
    s_xor_b32 s41, s13, 3
    s_mul_i32 s41, s41, 36864
    s_add_u32 s63, s41, s40
    s_lshl_b32 s43, s13, 12
    s_mov_b64 s[8:9], s[56:57]
    s_add_u32 m0, s43, 147456
    s_add_u32 s41, s60, 0
    buffer_load_dwordx4 v18, s[8:11], s41 offen offset:0 nt lds
    s_add_u32 s41, s60, 8192
    buffer_load_dwordx4 v18, s[8:11], s41 offen offset:1024 nt lds
    s_add_u32 s41, s60, 16384
    buffer_load_dwordx4 v18, s[8:11], s41 offen offset:2048 nt lds
    s_add_u32 s41, s60, 24576
    buffer_load_dwordx4 v18, s[8:11], s41 offen offset:3072 nt lds
    s_add_u32 m0, s43, 0
    s_add_u32 s41, s61, 0
    buffer_load_dwordx4 v18, s[8:11], s41 offen offset:0 nt lds
    s_add_u32 s41, s61, 8192
    buffer_load_dwordx4 v18, s[8:11], s41 offen offset:1024 nt lds
    s_add_u32 s41, s61, 16384
    buffer_load_dwordx4 v18, s[8:11], s41 offen offset:2048 nt lds
    s_add_u32 s41, s61, 24576
    buffer_load_dwordx4 v18, s[8:11], s41 offen offset:3072 nt lds
    s_add_u32 m0, s43, 36864
    s_add_u32 s41, s62, 0
    buffer_load_dwordx4 v18, s[8:11], s41 offen offset:0 nt lds
    s_add_u32 s41, s62, 8192
    buffer_load_dwordx4 v18, s[8:11], s41 offen offset:1024 nt lds
    s_add_u32 s41, s62, 16384
    buffer_load_dwordx4 v18, s[8:11], s41 offen offset:2048 nt lds
    s_add_u32 s41, s62, 24576
    buffer_load_dwordx4 v18, s[8:11], s41 offen offset:3072 nt lds
    s_add_u32 m0, s43, 73728
    s_add_u32 s41, s63, 0
    buffer_load_dwordx4 v18, s[8:11], s41 offen offset:0 nt lds
    s_add_u32 s41, s63, 8192
    buffer_load_dwordx4 v18, s[8:11], s41 offen offset:1024 nt lds
    s_add_u32 s41, s63, 16384
    buffer_load_dwordx4 v18, s[8:11], s41 offen offset:2048 nt lds
    s_add_u32 s41, s63, 24576
    buffer_load_dwordx4 v18, s[8:11], s41 offen offset:3072 nt lds
    v_lshrrev_b32 v49, 1, v48
    v_mul_u32_u24 v19, 1152, v49
    v_and_b32 v49, 1, v48
    v_lshl_add_u32 v19, v49, 4, v19
    s_mul_i32 s41, s13, 224
    s_sub_u32 s41, 1024, s41
    v_add_u32 v19, s41, v19
    v_lshrrev_b32 v49, 4, v48
    v_lshlrev_b32 v50, 2, v49
    v_and_b32 v51, 15, v48
    v_xor_b32 v51, v51, v50
    v_lshlrev_b32 v51, 4, v51
    v_lshl_add_u32 v16, v49, 15, v51
    v_lshrrev_b32 v50, 1, v49
    v_lshl_add_u32 v17, v50, 16, v51
    v_and_b32 v50, 1, v49
    v_lshl_add_u32 v17, v50, 13, v17
    s_lshl_b32 s40, s12, 8
    s_mul_i32 s58, s13, 1048576
    s_add_u32 s58, s58, s40
    s_lshr_b32 s41, s13, 1
    s_mul_i32 s59, s41, 262144
    s_and_b32 s41, s13, 1
    s_lshl_b32 s41, s41, 14
    s_add_u32 s59, s59, s41
    s_add_u32 s59, s59, s40
    s_add_u32 s59, s59, 4194304
    s_lshr_b32 s71, s52, 8
    s_add_u32 s71, s71, s12
    s_and_b32 s71, s71, 3
    v_bfe_u32 v50, v48, 2, 2
    v_xor_b32 v51, s13, v50
    v_lshlrev_b32 v20, 6, v51
    v_and_b32 v51, 3, v48
    v_lshl_add_u32 v20, v51, 4, v20
    v_lshrrev_b32 v23, 2, v48
    v_lshl_add_u32 v20, v23, 8, v20
    s_xor_b32 s41, s43, 0
    v_add_u32 v24, s41, v20
    s_xor_b32 s41, s43, 4096
    v_add_u32 v25, s41, v20
    s_xor_b32 s41, s43, 8192
    v_add_u32 v26, s41, v20
    s_xor_b32 s41, s43, 12288
    v_add_u32 v27, s41, v20
    v_and_b32 v23, 1, v50
    v_lshl_add_u32 v23, v49, 2, v23
    v_lshrrev_b32 v50, 1, v50
    v_lshlrev_b32 v21, 7, v23
    v_lshl_add_u32 v21, v50, 6, v21
    v_lshrrev_b32 v16, 1, v51
    v_lshl_add_u32 v21, v16, 5, v21
    v_and_b32 v16, 1, v51
    v_lshl_add_u32 v21, v16, 3, v21
    v_add_u32 v21, s43, v21
    v_lshlrev_b32 v22, 9, v50
    v_xor_b32 v22, v22, v21
    v_lshlrev_b32 v23, 5, v23
    v_lshl_add_u32 v23, v50, 10, v23
    v_lshl_add_u32 v23, v51, 3, v23
    v_add_u32 v23, s43, v23
    v_bfe_u32 v60, v65, 4, 6
    v_and_b32 v61, 15, v60
    v_lshrrev_b32 v62, 4, v60
    v_mov_b32 v64, 0x4444
    v_mov_b32 v77, 0xeeee
    v_cmp_lt_u32 vcc, 7, v61
    s_nop 1
    v_cndmask_b32 v64, v64, v77, vcc
    v_xor_b32 v66, 1024, v65
    v_xor_b32 v67, 2048, v65
    v_xor_b32 v68, 3072, v65
    v_and_b32 v69, 511, v65
    s_mul_i32 s96, s13, 36864
    s_add_u32 s96, s96, 16384
    v_lshlrev_b32 v70, 4, v60
    v_add_u32 v70, s96, v70
    v_lshrrev_b32 v79, 1, v69
    s_lshl_b32 s96, s13, 8
    s_add_u32 s96, s96, 14336
    s_lshl_b32 s33, s13, 10
    s_add_u32 s97, s33, 8192
    v_mov_b32 v77, s97
    v_mov_b32 v78, s96
    v_cmp_lt_u32 vcc, 31, v60
    s_nop 1
    v_cndmask_b32 v71, v77, v78, vcc
    v_add_u32 v71, v71, v79
    v_and_b32 v77, 7, v61
    v_lshrrev_b32 v78, 3, v61
    v_lshlrev_b32 v74, 4, v77
    v_lshl_add_u32 v73, v62, 7, v74
    v_lshl_add_u32 v73, v78, 3, v73
    s_lshl_b32 s96, s13, 9
    v_add_u32 v73, s96, v73
    v_lshrrev_b32 v74, 1, v74
    v_lshl_add_u32 v74, v78, 14, v74
    v_lshl_add_u32 v74, v62, 15, v74
    s_lshl_b32 s96, s13, 17
    v_add_u32 v74, s96, v74
    v_bfe_u32 v77, v61, 2, 1
    v_and_b32 v78, 3, v61
    s_cmp_lt_u32 s13, 2
    s_cselect_b64 vcc, -1, 0
    v_cndmask_b32 v77, 0, v77, vcc
    v_lshlrev_b32 v75, 7, v77
    v_lshl_add_u32 v75, v62, 4, v75
    v_lshl_add_u32 v75, v78, 2, v75
    v_lshlrev_b32 v58, 3, v77
    v_lshl_add_u32 v58, v78, 1, v58
    s_bfe_u32 s97, s12, 0x10001
    s_lshl_b32 s68, s97, 6
    s_lshl_b32 s97, s97, 2
    v_add_u32 v59, s97, v62
    s_bfe_u32 s96, s12, 0x10002
    s_and_b32 s40, s12, 1
    s_lshl_b32 s96, s96, 1
    s_add_u32 s96, s96, s40
    s_lshr_b32 s97, s12, 3
    s_lshl_b32 s98, s13, 2
    s_add_u32 s98, s98, s97
    s_lshl_b32 s98, s98, 2
    s_add_u32 s98, s98, s96
    s_lshl_b32 s98, s98, 8
    s_lshl_b32 s99, s13, 2
    s_add_u32 s99, s99, s96
    s_lshl_b32 s99, s99, 4
    s_lshl_b32 s41, s97, 1
    s_add_u32 s41, s41, s40
    s_lshl_b32 s41, s41, 7
    s_add_u32 s41, s41, 8192
    s_lshl_b32 s40, s40, 3
    s_add_u32 s40, s40, 512
    s_cmp_lt_u32 s13, 2
    s_cselect_b32 s96, 7, 4
    s_cselect_b32 s98, s98, s41
    s_cselect_b32 s99, s99, s40
    s_cselect_b32 s32, 1, 0
    s_add_u32 s68, s68, s98
    s_lshl_b32 s97, s97, s96
    s_add_u32 s99, s99, s97
    v_add_u32 v58, s99, v58
    s_and_b32 s97, s12, 4
    s_or_b32 s97, s97, s13
    s_cmp_eq_u32 s97, 2
    s_cselect_b32 s32, 2, s32
    s_mov_b32 s8, s48
    s_mov_b32 s9, s49
    s_mov_b32 s10, 9216
    v_mul_u32_u24 v77, 1152, v59
    v_lshl_add_u32 v77, v58, 1, v77
    buffer_load_dword v72, v77, s[8:11], 0 offen
    s_mov_b32 s10, 4718592
    s_waitcnt vmcnt(12) lgkmcnt(0)
    s_barrier
    s_cmp_eq_u32 s71, 1
    s_cbranch_scc1 cs_th0
    s_waitcnt vmcnt(6)
cs_th0:
    s_mov_b64 s[8:9], s[56:57]
    s_add_u32 m0, s43, 110592
    s_add_u32 s41, s42, 0
    buffer_load_dwordx4 v19, s[8:11], s41 offen offset:0 nt lds
    s_add_u32 s41, s42, 35840
    buffer_load_dwordx4 v19, s[8:11], s41 offen offset:1024 nt lds
    s_add_u32 s41, s42, 71680
    buffer_load_dwordx4 v19, s[8:11], s41 offen offset:2048 nt lds
    s_add_u32 s41, s42, 107520
    buffer_load_dwordx4 v19, s[8:11], s41 offen offset:3072 nt lds
    v_add_u32 v77, 147456, v22
    ds_read_b64_tr_b16 v[80:81], v77 offset:0
    ds_read_b64_tr_b16 v[82:83], v77 offset:256
    ds_read_b64_tr_b16 v[84:85], v77 offset:2048
    ds_read_b64_tr_b16 v[86:87], v77 offset:2304
    ds_read_b64_tr_b16 v[112:113], v77 offset:16
    ds_read_b64_tr_b16 v[114:115], v77 offset:272
    ds_read_b64_tr_b16 v[116:117], v77 offset:2064
    ds_read_b64_tr_b16 v[118:119], v77 offset:2320
    s_waitcnt vmcnt(12) lgkmcnt(0)
    s_barrier
    s_cmp_eq_u32 s71, 1
    s_cbranch_scc1 cs_th1
    s_waitcnt vmcnt(6)
cs_th1:
    s_mov_b64 s[8:9], s[52:53]
    s_add_u32 m0, s43, 147456
    s_add_u32 s41, s58, 0
    buffer_load_dwordx4 v17, s[8:11], s41 offen offset:0 nt lds
    s_add_u32 s41, s58, 31744
    buffer_load_dwordx4 v17, s[8:11], s41 offen offset:1024 nt lds
    s_add_u32 s41, s58, 129024
    buffer_load_dwordx4 v17, s[8:11], s41 offen offset:2048 nt lds
    s_add_u32 s41, s58, 160768
    buffer_load_dwordx4 v17, s[8:11], s41 offen offset:3072 nt lds
    v_add_u32 v77, 0, v21
    ds_read_b64_tr_b16 v[88:89], v77 offset:0
    ds_read_b64_tr_b16 v[90:91], v77 offset:256
    ds_read_b64_tr_b16 v[92:93], v77 offset:2048
    ds_read_b64_tr_b16 v[94:95], v77 offset:2304
    ds_read_b64_tr_b16 v[120:121], v77 offset:16
    ds_read_b64_tr_b16 v[122:123], v77 offset:272
    ds_read_b64_tr_b16 v[124:125], v77 offset:2064
    ds_read_b64_tr_b16 v[126:127], v77 offset:2320
    s_waitcnt vmcnt(12) lgkmcnt(0)
    s_barrier
    s_cmp_eq_u32 s71, 1
    s_cbranch_scc1 cs_th2
    s_waitcnt vmcnt(6)
cs_th2:
    s_add_u32 m0, s43, 0
    s_add_u32 s41, s58, 16384
    buffer_load_dwordx4 v17, s[8:11], s41 offen offset:0 nt lds
    s_add_u32 s41, s58, 48128
    buffer_load_dwordx4 v17, s[8:11], s41 offen offset:1024 nt lds
    s_add_u32 s41, s58, 145408
    buffer_load_dwordx4 v17, s[8:11], s41 offen offset:2048 nt lds
    s_add_u32 s41, s58, 177152
    buffer_load_dwordx4 v17, s[8:11], s41 offen offset:3072 nt lds
    v_add_u32 v77, 36864, v21
    ds_read_b64_tr_b16 v[96:97], v77 offset:0
    ds_read_b64_tr_b16 v[98:99], v77 offset:256
    ds_read_b64_tr_b16 v[100:101], v77 offset:2048
    ds_read_b64_tr_b16 v[102:103], v77 offset:2304
    ds_read_b64_tr_b16 v[128:129], v77 offset:16
    ds_read_b64_tr_b16 v[130:131], v77 offset:272
    ds_read_b64_tr_b16 v[132:133], v77 offset:2064
    ds_read_b64_tr_b16 v[134:135], v77 offset:2320
    s_waitcnt vmcnt(12) lgkmcnt(0)
    s_barrier
    s_cmp_eq_u32 s71, 1
    s_cbranch_scc1 cs_th3
    s_waitcnt vmcnt(6)
cs_th3:
    s_mov_b64 s[8:9], s[54:55]
    s_add_u32 m0, s43, 36864
    s_add_u32 s41, s58, 0
    buffer_load_dwordx4 v17, s[8:11], s41 offen offset:0 nt lds
    s_add_u32 s41, s58, 31744
    buffer_load_dwordx4 v17, s[8:11], s41 offen offset:1024 nt lds
    s_add_u32 s41, s58, 129024
    buffer_load_dwordx4 v17, s[8:11], s41 offen offset:2048 nt lds
    s_add_u32 s41, s58, 160768
    buffer_load_dwordx4 v17, s[8:11], s41 offen offset:3072 nt lds
    v_add_u32 v77, 73728, v21
    ds_read_b64_tr_b16 v[104:105], v77 offset:0
    ds_read_b64_tr_b16 v[106:107], v77 offset:256
    ds_read_b64_tr_b16 v[108:109], v77 offset:2048
    ds_read_b64_tr_b16 v[110:111], v77 offset:2304
    ds_read_b64_tr_b16 v[136:137], v77 offset:16
    ds_read_b64_tr_b16 v[138:139], v77 offset:272
    ds_read_b64_tr_b16 v[140:141], v77 offset:2064
    ds_read_b64_tr_b16 v[142:143], v77 offset:2320
    s_waitcnt vmcnt(12) lgkmcnt(0)
    s_barrier
    s_cmp_eq_u32 s71, 1
    s_cbranch_scc1 cs_th4
    s_waitcnt vmcnt(6)
cs_th4:
    s_add_u32 m0, s43, 73728
    s_add_u32 s41, s58, 16384
    buffer_load_dwordx4 v17, s[8:11], s41 offen offset:0 nt lds
    s_add_u32 s41, s58, 48128
    buffer_load_dwordx4 v17, s[8:11], s41 offen offset:1024 nt lds
    s_add_u32 s41, s58, 145408
    buffer_load_dwordx4 v17, s[8:11], s41 offen offset:2048 nt lds
    s_add_u32 s41, s58, 177152
    buffer_load_dwordx4 v17, s[8:11], s41 offen offset:3072 nt lds
    v_add_u32 v77, 110592, v23
    ds_read_b64_tr_b16 v[0:1], v77 offset:0
    ds_read_b64_tr_b16 v[2:3], v77 offset:64
    ds_read_b64_tr_b16 v[4:5], v77 offset:512
    ds_read_b64_tr_b16 v[6:7], v77 offset:576
    ds_read_b64_tr_b16 v[8:9], v77 offset:2048
    ds_read_b64_tr_b16 v[10:11], v77 offset:2112
    ds_read_b64_tr_b16 v[12:13], v77 offset:2560
    ds_read_b64_tr_b16 v[14:15], v77 offset:2624
    s_waitcnt vmcnt(12) lgkmcnt(0)
    s_barrier
    s_cmp_eq_u32 s71, 1
    s_cbranch_scc1 cs_th5
    s_waitcnt vmcnt(6)
cs_th5:
    s_mov_b64 s[8:9], s[50:51]
    s_add_u32 m0, s43, 110592
    s_add_u32 s41, s58, 0
    buffer_load_dwordx4 v17, s[8:11], s41 offen offset:0 nt lds
    s_add_u32 s41, s58, 31744
    buffer_load_dwordx4 v17, s[8:11], s41 offen offset:1024 nt lds
    s_add_u32 s41, s58, 129024
    buffer_load_dwordx4 v17, s[8:11], s41 offen offset:2048 nt lds
    s_add_u32 s41, s58, 160768
    buffer_load_dwordx4 v17, s[8:11], s41 offen offset:3072 nt lds
    s_cmp_eq_u32 s32, 0
    s_cbranch_scc1 cs_init_done
    v_mov_b32 v52, 1
    v_mov_b32 v53, 1
    v_mov_b32 v54, 1
    v_mov_b32 v55, 1
    v_mov_b32 v56, 0
    s_lshl_b32 s96, s12, 14
    s_add_u32 s96, s96, 68681728
    s_add_u32 s97, s96, 0
    buffer_store_dwordx4 v[52:55], v65, s[4:7], s97 offen sc1
    s_add_u32 s97, s96, 4096
    buffer_store_dwordx4 v[52:55], v65, s[4:7], s97 offen sc1
    s_add_u32 s97, s96, 8192
    buffer_store_dwordx4 v[52:55], v65, s[4:7], s97 offen sc1
    s_add_u32 s97, s96, 12288
    buffer_store_dwordx4 v[52:55], v65, s[4:7], s97 offen sc1
    s_add_u32 s96, s68, 67633152
    s_add_u32 s97, s96, 16384
    buffer_store_dword v56, v75, s[4:7], s96 offen offset:0 sc1
    buffer_store_dword v72, v75, s[4:7], s97 offen offset:0 sc1
    s_cmp_lg_u32 s32, 2
    s_cbranch_scc1 cs_init_done
    buffer_store_dword v56, v75, s[4:7], s96 offen offset:1024 sc1
    buffer_store_dword v72, v75, s[4:7], s97 offen offset:1024 sc1
    buffer_store_dword v56, v75, s[4:7], s96 offen offset:2048 sc1
    buffer_store_dword v72, v75, s[4:7], s97 offen offset:2048 sc1
    buffer_store_dword v56, v75, s[4:7], s96 offen offset:3072 sc1
    buffer_store_dword v72, v75, s[4:7], s97 offen offset:3072 sc1
cs_init_done:
    ds_write_b64 v70, v[0:1] offset:16384
    ds_write_b64 v70, v[2:3] offset:16392
    ds_write_b64 v70, v[4:5] offset:17408
    ds_write_b64 v70, v[6:7] offset:17416
    ds_write_b64 v70, v[8:9] offset:18432
    ds_write_b64 v70, v[10:11] offset:18440
    ds_write_b64 v70, v[12:13] offset:19456
    ds_write_b64 v70, v[14:15] offset:19464
    v_add_u32 v28, 147456, v24
    v_add_u32 v29, 147456, v25
    v_add_u32 v30, 147456, v26
    v_add_u32 v31, 147456, v27
    ds_read_b64_tr_b16 a[96:97], v28 offset:0
    ds_read_b64_tr_b16 a[104:105], v28 offset:8
    ds_read_b64_tr_b16 a[112:113], v29 offset:0
    ds_read_b64_tr_b16 a[120:121], v29 offset:8
    ds_read_b64_tr_b16 a[128:129], v30 offset:0
    ds_read_b64_tr_b16 a[136:137], v30 offset:8
    ds_read_b64_tr_b16 a[144:145], v31 offset:0
    ds_read_b64_tr_b16 v[32:33], v31 offset:8
    s_waitcnt vmcnt(12) lgkmcnt(0)
    s_barrier
    s_cmp_eq_u32 s71, 1
    s_cbranch_scc1 cs_th6
    s_waitcnt vmcnt(6)
cs_th6:
    s_add_u32 m0, s43, 147456
    s_add_u32 s41, s58, 16384
    buffer_load_dwordx4 v17, s[8:11], s41 offen offset:0 nt lds
    s_add_u32 s41, s58, 48128
    buffer_load_dwordx4 v17, s[8:11], s41 offen offset:1024 nt lds
    s_add_u32 s41, s58, 145408
    buffer_load_dwordx4 v17, s[8:11], s41 offen offset:2048 nt lds
    s_add_u32 s41, s58, 177152
    buffer_load_dwordx4 v17, s[8:11], s41 offen offset:3072 nt lds
    ds_write_b64 v70, v[32:33] offset:12288
    v_add_u32 v28, 0, v24
    v_add_u32 v29, 0, v25
    v_add_u32 v30, 0, v26
    v_add_u32 v31, 0, v27
    ds_read_b64_tr_b16 a[98:99], v28 offset:0
    ds_read_b64_tr_b16 a[106:107], v28 offset:8
    ds_read_b64_tr_b16 a[114:115], v29 offset:0
    ds_read_b64_tr_b16 a[122:123], v29 offset:8
    ds_read_b64_tr_b16 a[130:131], v30 offset:0
    ds_read_b64_tr_b16 a[138:139], v30 offset:8
    ds_read_b64_tr_b16 a[146:147], v31 offset:0
    ds_read_b64_tr_b16 v[0:1], v31 offset:8
    s_waitcnt vmcnt(12) lgkmcnt(0)
    s_barrier
    s_cmp_eq_u32 s71, 1
    s_cbranch_scc1 cs_th7
    s_waitcnt vmcnt(6)
cs_th7:
    s_mov_b64 s[8:9], s[52:53]
    s_add_u32 m0, s43, 0
    s_add_u32 s41, s58, 262144
    buffer_load_dwordx4 v17, s[8:11], s41 offen offset:0 nt lds
    s_add_u32 s41, s58, 293888
    buffer_load_dwordx4 v17, s[8:11], s41 offen offset:1024 nt lds
    s_add_u32 s41, s58, 391168
    buffer_load_dwordx4 v17, s[8:11], s41 offen offset:2048 nt lds
    s_add_u32 s41, s58, 422912
    buffer_load_dwordx4 v17, s[8:11], s41 offen offset:3072 nt lds
    ds_write_b64 v70, v[0:1] offset:12296
    v_add_u32 v28, 36864, v24
    v_add_u32 v29, 36864, v25
    v_add_u32 v30, 36864, v26
    v_add_u32 v31, 36864, v27
    ds_read_b64_tr_b16 a[232:233], v28 offset:0
    ds_read_b64_tr_b16 v[32:33], v28 offset:8
    ds_read_b64_tr_b16 a[240:241], v29 offset:0
    ds_read_b64_tr_b16 a[248:249], v29 offset:8
    ds_read_b64_tr_b16 v[144:145], v30 offset:0
    ds_read_b64_tr_b16 v[152:153], v30 offset:8
    ds_read_b64_tr_b16 v[160:161], v31 offset:0
    ds_read_b64_tr_b16 v[168:169], v31 offset:8
    s_waitcnt vmcnt(12) lgkmcnt(0)
    s_barrier
    s_cmp_eq_u32 s71, 1
    s_cbranch_scc1 cs_th8
    s_waitcnt vmcnt(6)
cs_th8:
    s_add_u32 m0, s43, 36864
    s_add_u32 s41, s58, 278528
    buffer_load_dwordx4 v17, s[8:11], s41 offen offset:0 nt lds
    s_add_u32 s41, s58, 310272
    buffer_load_dwordx4 v17, s[8:11], s41 offen offset:1024 nt lds
    s_add_u32 s41, s58, 407552
    buffer_load_dwordx4 v17, s[8:11], s41 offen offset:2048 nt lds
    s_add_u32 s41, s58, 439296
    buffer_load_dwordx4 v17, s[8:11], s41 offen offset:3072 nt lds
    ds_write_b64 v70, v[32:33] offset:8192
    v_add_u32 v28, 73728, v24
    v_add_u32 v29, 73728, v25
    v_add_u32 v30, 73728, v26
    v_add_u32 v31, 73728, v27
    ds_read_b64_tr_b16 a[234:235], v28 offset:0
    ds_read_b64_tr_b16 v[0:1], v28 offset:8
    ds_read_b64_tr_b16 a[242:243], v29 offset:0
    ds_read_b64_tr_b16 a[250:251], v29 offset:8
    ds_read_b64_tr_b16 v[146:147], v30 offset:0
    ds_read_b64_tr_b16 v[154:155], v30 offset:8
    ds_read_b64_tr_b16 v[162:163], v31 offset:0
    ds_read_b64_tr_b16 v[170:171], v31 offset:8
    s_waitcnt vmcnt(12) lgkmcnt(0)
    s_barrier
    s_cmp_eq_u32 s71, 1
    s_cbranch_scc1 cs_th9
    s_waitcnt vmcnt(6)
cs_th9:
    s_mov_b64 s[8:9], s[54:55]
    s_add_u32 m0, s43, 73728
    s_add_u32 s41, s58, 262144
    buffer_load_dwordx4 v17, s[8:11], s41 offen offset:0 nt lds
    s_add_u32 s41, s58, 293888
    buffer_load_dwordx4 v17, s[8:11], s41 offen offset:1024 nt lds
    s_add_u32 s41, s58, 391168
    buffer_load_dwordx4 v17, s[8:11], s41 offen offset:2048 nt lds
    s_add_u32 s41, s58, 422912
    buffer_load_dwordx4 v17, s[8:11], s41 offen offset:3072 nt lds
    ds_write_b64 v70, v[0:1] offset:8200
    v_add_u32 v28, 110592, v24
    v_add_u32 v29, 110592, v25
    v_add_u32 v30, 110592, v26
    v_add_u32 v31, 110592, v27
    ds_read_b64_tr_b16 v[32:33], v28 offset:0
    ds_read_b64_tr_b16 v[34:35], v28 offset:8
    ds_read_b64_tr_b16 v[36:37], v29 offset:0
    ds_read_b64_tr_b16 v[38:39], v29 offset:8
    ds_read_b64_tr_b16 a[0:1], v30 offset:0
    ds_read_b64_tr_b16 v[40:41], v30 offset:8
    ds_read_b64_tr_b16 a[8:9], v31 offset:0
    ds_read_b64_tr_b16 v[42:43], v31 offset:8
    s_waitcnt vmcnt(12) lgkmcnt(0)
    s_barrier
    s_cmp_eq_u32 s71, 1
    s_cbranch_scc1 cs_th10
    s_waitcnt vmcnt(6)
cs_th10:
    s_add_u32 m0, s43, 110592
    s_add_u32 s41, s58, 278528
    buffer_load_dwordx4 v17, s[8:11], s41 offen offset:0 nt lds
    s_add_u32 s41, s58, 310272
    buffer_load_dwordx4 v17, s[8:11], s41 offen offset:1024 nt lds
    s_add_u32 s41, s58, 407552
    buffer_load_dwordx4 v17, s[8:11], s41 offen offset:2048 nt lds
    s_add_u32 s41, s58, 439296
    buffer_load_dwordx4 v17, s[8:11], s41 offen offset:3072 nt lds
    ds_write_b64 v70, v[32:33] offset:0
    ds_write_b64 v70, v[34:35] offset:2048
    ds_write_b64 v70, v[36:37] offset:4096
    ds_write_b64 v70, v[38:39] offset:6144
    ds_write_b64 v70, v[40:41] offset:10240
    ds_write_b64 v70, v[42:43] offset:14336
    v_add_u32 v28, 147456, v24
    v_add_u32 v29, 147456, v25
    v_add_u32 v30, 147456, v26
    v_add_u32 v31, 147456, v27
    ds_read_b64_tr_b16 v[0:1], v28 offset:0
    ds_read_b64_tr_b16 v[2:3], v28 offset:8
    ds_read_b64_tr_b16 v[4:5], v29 offset:0
    ds_read_b64_tr_b16 v[6:7], v29 offset:8
    ds_read_b64_tr_b16 a[2:3], v30 offset:0
    ds_read_b64_tr_b16 v[8:9], v30 offset:8
    ds_read_b64_tr_b16 a[10:11], v31 offset:0
    ds_read_b64_tr_b16 v[10:11], v31 offset:8
    s_waitcnt vmcnt(12) lgkmcnt(0)
    s_barrier
    s_cmp_eq_u32 s71, 1
    s_cbranch_scc1 cs_th11
    s_waitcnt vmcnt(6)
cs_th11:
    s_mov_b64 s[8:9], s[50:51]
    s_add_u32 m0, s43, 147456
    s_add_u32 s41, s58, 262144
    buffer_load_dwordx4 v17, s[8:11], s41 offen offset:0 nt lds
    s_add_u32 s41, s58, 293888
    buffer_load_dwordx4 v17, s[8:11], s41 offen offset:1024 nt lds
    s_add_u32 s41, s58, 391168
    buffer_load_dwordx4 v17, s[8:11], s41 offen offset:2048 nt lds
    s_add_u32 s41, s58, 422912
    buffer_load_dwordx4 v17, s[8:11], s41 offen offset:3072 nt lds
    ds_write_b64 v70, v[0:1] offset:8
    ds_write_b64 v70, v[2:3] offset:2056
    ds_write_b64 v70, v[4:5] offset:4104
    ds_write_b64 v70, v[6:7] offset:6152
    ds_write_b64 v70, v[8:9] offset:10248
    ds_write_b64 v70, v[10:11] offset:14344
    v_add_u32 v28, 0, v24
    v_add_u32 v29, 0, v25
    v_add_u32 v30, 0, v26
    v_add_u32 v31, 0, v27
    ds_read_b64_tr_b16 a[100:101], v28 offset:0
    ds_read_b64_tr_b16 a[108:109], v28 offset:8
    ds_read_b64_tr_b16 a[116:117], v29 offset:0
    ds_read_b64_tr_b16 a[124:125], v29 offset:8
    ds_read_b64_tr_b16 a[132:133], v30 offset:0
    ds_read_b64_tr_b16 a[140:141], v30 offset:8
    ds_read_b64_tr_b16 a[148:149], v31 offset:0
    ds_read_b64_tr_b16 v[32:33], v31 offset:8
    s_waitcnt vmcnt(12) lgkmcnt(0)
    s_barrier
    s_cmp_eq_u32 s71, 1
    s_cbranch_scc1 cs_th12
    s_waitcnt vmcnt(6)
cs_th12:
    s_add_u32 m0, s43, 0
    s_add_u32 s41, s58, 278528
    buffer_load_dwordx4 v17, s[8:11], s41 offen offset:0 nt lds
    s_add_u32 s41, s58, 310272
    buffer_load_dwordx4 v17, s[8:11], s41 offen offset:1024 nt lds
    s_add_u32 s41, s58, 407552
    buffer_load_dwordx4 v17, s[8:11], s41 offen offset:2048 nt lds
    s_add_u32 s41, s58, 439296
    buffer_load_dwordx4 v17, s[8:11], s41 offen offset:3072 nt lds
    ds_write_b64 v70, v[32:33] offset:13312
    v_add_u32 v28, 36864, v24
    v_add_u32 v29, 36864, v25
    v_add_u32 v30, 36864, v26
    v_add_u32 v31, 36864, v27
    ds_read_b64_tr_b16 a[102:103], v28 offset:0
    ds_read_b64_tr_b16 a[110:111], v28 offset:8
    ds_read_b64_tr_b16 a[118:119], v29 offset:0
    ds_read_b64_tr_b16 a[126:127], v29 offset:8
    ds_read_b64_tr_b16 a[134:135], v30 offset:0
    ds_read_b64_tr_b16 a[142:143], v30 offset:8
    ds_read_b64_tr_b16 a[150:151], v31 offset:0
    ds_read_b64_tr_b16 v[0:1], v31 offset:8
    s_waitcnt vmcnt(12) lgkmcnt(0)
    s_barrier
    s_cmp_eq_u32 s71, 1
    s_cbranch_scc1 cs_th13
    s_waitcnt vmcnt(6)
cs_th13:
    s_mov_b64 s[8:9], s[52:53]
    s_add_u32 m0, s43, 36864
    s_add_u32 s41, s58, 524288
    buffer_load_dwordx4 v17, s[8:11], s41 offen offset:0 nt lds
    s_add_u32 s41, s58, 556032
    buffer_load_dwordx4 v17, s[8:11], s41 offen offset:1024 nt lds
    s_add_u32 s41, s58, 653312
    buffer_load_dwordx4 v17, s[8:11], s41 offen offset:2048 nt lds
    s_add_u32 s41, s58, 685056
    buffer_load_dwordx4 v17, s[8:11], s41 offen offset:3072 nt lds
    ds_write_b64 v70, v[0:1] offset:13320
    v_add_u32 v28, 73728, v24
    v_add_u32 v29, 73728, v25
    v_add_u32 v30, 73728, v26
    v_add_u32 v31, 73728, v27
    ds_read_b64_tr_b16 a[236:237], v28 offset:0
    ds_read_b64_tr_b16 v[32:33], v28 offset:8
    ds_read_b64_tr_b16 a[244:245], v29 offset:0
    ds_read_b64_tr_b16 a[252:253], v29 offset:8
    ds_read_b64_tr_b16 v[148:149], v30 offset:0
    ds_read_b64_tr_b16 v[156:157], v30 offset:8
    ds_read_b64_tr_b16 v[164:165], v31 offset:0
    ds_read_b64_tr_b16 v[172:173], v31 offset:8
    s_waitcnt vmcnt(12) lgkmcnt(0)
    s_barrier
    s_cmp_eq_u32 s71, 1
    s_cbranch_scc1 cs_th14
    s_waitcnt vmcnt(6)
cs_th14:
    s_add_u32 m0, s43, 73728
    s_add_u32 s41, s58, 540672
    buffer_load_dwordx4 v17, s[8:11], s41 offen offset:0 nt lds
    s_add_u32 s41, s58, 572416
    buffer_load_dwordx4 v17, s[8:11], s41 offen offset:1024 nt lds
    s_add_u32 s41, s58, 669696
    buffer_load_dwordx4 v17, s[8:11], s41 offen offset:2048 nt lds
    s_add_u32 s41, s58, 701440
    buffer_load_dwordx4 v17, s[8:11], s41 offen offset:3072 nt lds
    ds_write_b64 v70, v[32:33] offset:9216
    v_add_u32 v28, 110592, v24
    v_add_u32 v29, 110592, v25
    v_add_u32 v30, 110592, v26
    v_add_u32 v31, 110592, v27
    ds_read_b64_tr_b16 a[238:239], v28 offset:0
    ds_read_b64_tr_b16 v[0:1], v28 offset:8
    ds_read_b64_tr_b16 a[246:247], v29 offset:0
    ds_read_b64_tr_b16 a[254:255], v29 offset:8
    ds_read_b64_tr_b16 v[150:151], v30 offset:0
    ds_read_b64_tr_b16 v[158:159], v30 offset:8
    ds_read_b64_tr_b16 v[166:167], v31 offset:0
    ds_read_b64_tr_b16 v[174:175], v31 offset:8
    s_waitcnt vmcnt(12) lgkmcnt(0)
    s_barrier
    s_cmp_eq_u32 s71, 1
    s_cbranch_scc1 cs_th15
    s_waitcnt vmcnt(6)
cs_th15:
    s_mov_b64 s[8:9], s[54:55]
    s_add_u32 m0, s43, 110592
    s_add_u32 s41, s58, 524288
    buffer_load_dwordx4 v17, s[8:11], s41 offen offset:0 nt lds
    s_add_u32 s41, s58, 556032
    buffer_load_dwordx4 v17, s[8:11], s41 offen offset:1024 nt lds
    s_add_u32 s41, s58, 653312
    buffer_load_dwordx4 v17, s[8:11], s41 offen offset:2048 nt lds
    s_add_u32 s41, s58, 685056
    buffer_load_dwordx4 v17, s[8:11], s41 offen offset:3072 nt lds
    ds_write_b64 v70, v[0:1] offset:9224
    v_add_u32 v28, 147456, v24
    v_add_u32 v29, 147456, v25
    v_add_u32 v30, 147456, v26
    v_add_u32 v31, 147456, v27
    ds_read_b64_tr_b16 v[32:33], v28 offset:0
    ds_read_b64_tr_b16 v[34:35], v28 offset:8
    ds_read_b64_tr_b16 v[36:37], v29 offset:0
    ds_read_b64_tr_b16 v[38:39], v29 offset:8
    ds_read_b64_tr_b16 a[4:5], v30 offset:0
    ds_read_b64_tr_b16 v[40:41], v30 offset:8
    ds_read_b64_tr_b16 a[12:13], v31 offset:0
    ds_read_b64_tr_b16 v[42:43], v31 offset:8
    s_waitcnt vmcnt(12) lgkmcnt(0)
    s_barrier
    s_cmp_eq_u32 s71, 1
    s_cbranch_scc1 cs_th16
    s_waitcnt vmcnt(6)
cs_th16:
    s_add_u32 m0, s43, 147456
    s_add_u32 s41, s58, 540672
    buffer_load_dwordx4 v17, s[8:11], s41 offen offset:0 nt lds
    s_add_u32 s41, s58, 572416
    buffer_load_dwordx4 v17, s[8:11], s41 offen offset:1024 nt lds
    s_add_u32 s41, s58, 669696
    buffer_load_dwordx4 v17, s[8:11], s41 offen offset:2048 nt lds
    s_add_u32 s41, s58, 701440
    buffer_load_dwordx4 v17, s[8:11], s41 offen offset:3072 nt lds
    ds_write_b64 v70, v[32:33] offset:1024
    ds_write_b64 v70, v[34:35] offset:3072
    ds_write_b64 v70, v[36:37] offset:5120
    ds_write_b64 v70, v[38:39] offset:7168
    ds_write_b64 v70, v[40:41] offset:11264
    ds_write_b64 v70, v[42:43] offset:15360
    v_add_u32 v28, 0, v24
    v_add_u32 v29, 0, v25
    v_add_u32 v30, 0, v26
    v_add_u32 v31, 0, v27
    ds_read_b64_tr_b16 v[0:1], v28 offset:0
    ds_read_b64_tr_b16 v[2:3], v28 offset:8
    ds_read_b64_tr_b16 v[4:5], v29 offset:0
    ds_read_b64_tr_b16 v[6:7], v29 offset:8
    ds_read_b64_tr_b16 a[6:7], v30 offset:0
    ds_read_b64_tr_b16 v[8:9], v30 offset:8
    ds_read_b64_tr_b16 a[14:15], v31 offset:0
    ds_read_b64_tr_b16 v[10:11], v31 offset:8
    s_waitcnt vmcnt(12) lgkmcnt(0)
    s_barrier
    s_cmp_eq_u32 s71, 1
    s_cbranch_scc1 cs_th17
    s_waitcnt vmcnt(6)
cs_th17:
    s_mov_b64 s[8:9], s[50:51]
    s_add_u32 m0, s43, 0
    s_add_u32 s41, s58, 524288
    buffer_load_dwordx4 v17, s[8:11], s41 offen offset:0 nt lds
    s_add_u32 s41, s58, 556032
    buffer_load_dwordx4 v17, s[8:11], s41 offen offset:1024 nt lds
    s_add_u32 s41, s58, 653312
    buffer_load_dwordx4 v17, s[8:11], s41 offen offset:2048 nt lds
    s_add_u32 s41, s58, 685056
    buffer_load_dwordx4 v17, s[8:11], s41 offen offset:3072 nt lds
    ds_write_b64 v70, v[0:1] offset:1032
    ds_write_b64 v70, v[2:3] offset:3080
    ds_write_b64 v70, v[4:5] offset:5128
    ds_write_b64 v70, v[6:7] offset:7176
    ds_write_b64 v70, v[8:9] offset:11272
    ds_write_b64 v70, v[10:11] offset:15368
    v_add_u32 v28, 36864, v24
    v_add_u32 v29, 36864, v25
    v_add_u32 v30, 36864, v26
    v_add_u32 v31, 36864, v27
    ds_read_b64_tr_b16 a[152:153], v28 offset:0
    ds_read_b64_tr_b16 a[160:161], v28 offset:8
    ds_read_b64_tr_b16 a[168:169], v29 offset:0
    ds_read_b64_tr_b16 a[176:177], v29 offset:8
    ds_read_b64_tr_b16 a[184:185], v30 offset:0
    ds_read_b64_tr_b16 a[192:193], v30 offset:8
    ds_read_b64_tr_b16 a[200:201], v31 offset:0
    ds_read_b64_tr_b16 a[208:209], v31 offset:8
    s_waitcnt vmcnt(12) lgkmcnt(0)
    s_barrier
    s_cmp_eq_u32 s71, 1
    s_cbranch_scc1 cs_th18
    s_waitcnt vmcnt(6)
cs_th18:
    s_add_u32 m0, s43, 36864
    s_add_u32 s41, s58, 540672
    buffer_load_dwordx4 v17, s[8:11], s41 offen offset:0 nt lds
    s_add_u32 s41, s58, 572416
    buffer_load_dwordx4 v17, s[8:11], s41 offen offset:1024 nt lds
    s_add_u32 s41, s58, 669696
    buffer_load_dwordx4 v17, s[8:11], s41 offen offset:2048 nt lds
    s_add_u32 s41, s58, 701440
    buffer_load_dwordx4 v17, s[8:11], s41 offen offset:3072 nt lds
    v_add_u32 v28, 73728, v24
    v_add_u32 v29, 73728, v25
    v_add_u32 v30, 73728, v26
    v_add_u32 v31, 73728, v27
    ds_read_b64_tr_b16 a[154:155], v28 offset:0
    ds_read_b64_tr_b16 a[162:163], v28 offset:8
    ds_read_b64_tr_b16 a[170:171], v29 offset:0
    ds_read_b64_tr_b16 a[178:179], v29 offset:8
    ds_read_b64_tr_b16 a[186:187], v30 offset:0
    ds_read_b64_tr_b16 a[194:195], v30 offset:8
    ds_read_b64_tr_b16 a[202:203], v31 offset:0
    ds_read_b64_tr_b16 a[210:211], v31 offset:8
    s_waitcnt vmcnt(12) lgkmcnt(0)
    s_barrier
    s_cmp_eq_u32 s71, 1
    s_cbranch_scc1 cs_th19
    s_waitcnt vmcnt(6)
cs_th19:
    s_mov_b64 s[8:9], s[52:53]
    s_add_u32 m0, s43, 73728
    s_add_u32 s41, s58, 786432
    buffer_load_dwordx4 v17, s[8:11], s41 offen offset:0 nt lds
    s_add_u32 s41, s58, 818176
    buffer_load_dwordx4 v17, s[8:11], s41 offen offset:1024 nt lds
    s_add_u32 s41, s58, 915456
    buffer_load_dwordx4 v17, s[8:11], s41 offen offset:2048 nt lds
    s_add_u32 s41, s58, 947200
    buffer_load_dwordx4 v17, s[8:11], s41 offen offset:3072 nt lds
    v_add_u32 v28, 110592, v24
    v_add_u32 v29, 110592, v25
    v_add_u32 v30, 110592, v26
    v_add_u32 v31, 110592, v27
    ds_read_b64_tr_b16 v[176:177], v28 offset:0
    ds_read_b64_tr_b16 v[184:185], v28 offset:8
    ds_read_b64_tr_b16 v[192:193], v29 offset:0
    ds_read_b64_tr_b16 v[200:201], v29 offset:8
    ds_read_b64_tr_b16 v[208:209], v30 offset:0
    ds_read_b64_tr_b16 v[216:217], v30 offset:8
    ds_read_b64_tr_b16 v[224:225], v31 offset:0
    ds_read_b64_tr_b16 v[232:233], v31 offset:8
    s_waitcnt vmcnt(12) lgkmcnt(0)
    s_barrier
    s_cmp_eq_u32 s71, 1
    s_cbranch_scc1 cs_th20
    s_waitcnt vmcnt(6)
cs_th20:
    s_add_u32 m0, s43, 110592
    s_add_u32 s41, s58, 802816
    buffer_load_dwordx4 v17, s[8:11], s41 offen offset:0 nt lds
    s_add_u32 s41, s58, 834560
    buffer_load_dwordx4 v17, s[8:11], s41 offen offset:1024 nt lds
    s_add_u32 s41, s58, 931840
    buffer_load_dwordx4 v17, s[8:11], s41 offen offset:2048 nt lds
    s_add_u32 s41, s58, 963584
    buffer_load_dwordx4 v17, s[8:11], s41 offen offset:3072 nt lds
    v_add_u32 v28, 147456, v24
    v_add_u32 v29, 147456, v25
    v_add_u32 v30, 147456, v26
    v_add_u32 v31, 147456, v27
    ds_read_b64_tr_b16 v[178:179], v28 offset:0
    ds_read_b64_tr_b16 v[186:187], v28 offset:8
    ds_read_b64_tr_b16 v[194:195], v29 offset:0
    ds_read_b64_tr_b16 v[202:203], v29 offset:8
    ds_read_b64_tr_b16 v[210:211], v30 offset:0
    ds_read_b64_tr_b16 v[218:219], v30 offset:8
    ds_read_b64_tr_b16 v[226:227], v31 offset:0
    ds_read_b64_tr_b16 v[234:235], v31 offset:8
    s_waitcnt vmcnt(12) lgkmcnt(0)
    s_barrier
    s_cmp_eq_u32 s71, 1
    s_cbranch_scc1 cs_th21
    s_waitcnt vmcnt(6)
cs_th21:
    s_mov_b64 s[8:9], s[54:55]
    s_add_u32 m0, s43, 147456
    s_add_u32 s41, s58, 786432
    buffer_load_dwordx4 v17, s[8:11], s41 offen offset:0 nt lds
    s_add_u32 s41, s58, 818176
    buffer_load_dwordx4 v17, s[8:11], s41 offen offset:1024 nt lds
    s_add_u32 s41, s58, 915456
    buffer_load_dwordx4 v17, s[8:11], s41 offen offset:2048 nt lds
    s_add_u32 s41, s58, 947200
    buffer_load_dwordx4 v17, s[8:11], s41 offen offset:3072 nt lds
    v_add_u32 v28, 0, v24
    v_add_u32 v29, 0, v25
    v_add_u32 v30, 0, v26
    v_add_u32 v31, 0, v27
    ds_read_b64_tr_b16 a[16:17], v28 offset:0
    ds_read_b64_tr_b16 a[24:25], v28 offset:8
    ds_read_b64_tr_b16 a[32:33], v29 offset:0
    ds_read_b64_tr_b16 a[40:41], v29 offset:8
    ds_read_b64_tr_b16 a[48:49], v30 offset:0
    ds_read_b64_tr_b16 a[56:57], v30 offset:8
    ds_read_b64_tr_b16 a[64:65], v31 offset:0
    ds_read_b64_tr_b16 a[72:73], v31 offset:8
    s_waitcnt vmcnt(12) lgkmcnt(0)
    s_barrier
    s_cmp_eq_u32 s71, 1
    s_cbranch_scc1 cs_th22
    s_waitcnt vmcnt(6)
cs_th22:
    s_add_u32 m0, s43, 0
    s_add_u32 s41, s58, 802816
    buffer_load_dwordx4 v17, s[8:11], s41 offen offset:0 nt lds
    s_add_u32 s41, s58, 834560
    buffer_load_dwordx4 v17, s[8:11], s41 offen offset:1024 nt lds
    s_add_u32 s41, s58, 931840
    buffer_load_dwordx4 v17, s[8:11], s41 offen offset:2048 nt lds
    s_add_u32 s41, s58, 963584
    buffer_load_dwordx4 v17, s[8:11], s41 offen offset:3072 nt lds
    v_add_u32 v28, 36864, v24
    v_add_u32 v29, 36864, v25
    v_add_u32 v30, 36864, v26
    v_add_u32 v31, 36864, v27
    ds_read_b64_tr_b16 a[18:19], v28 offset:0
    ds_read_b64_tr_b16 a[26:27], v28 offset:8
    ds_read_b64_tr_b16 a[34:35], v29 offset:0
    ds_read_b64_tr_b16 a[42:43], v29 offset:8
    ds_read_b64_tr_b16 a[50:51], v30 offset:0
    ds_read_b64_tr_b16 a[58:59], v30 offset:8
    ds_read_b64_tr_b16 a[66:67], v31 offset:0
    ds_read_b64_tr_b16 a[74:75], v31 offset:8
    s_waitcnt vmcnt(12) lgkmcnt(0)
    s_barrier
    s_cmp_eq_u32 s71, 1
    s_cbranch_scc1 cs_th23
    s_waitcnt vmcnt(6)
cs_th23:
    s_mov_b64 s[8:9], s[50:51]
    s_add_u32 m0, s43, 36864
    s_add_u32 s41, s58, 786432
    buffer_load_dwordx4 v17, s[8:11], s41 offen offset:0 nt lds
    s_add_u32 s41, s58, 818176
    buffer_load_dwordx4 v17, s[8:11], s41 offen offset:1024 nt lds
    s_add_u32 s41, s58, 915456
    buffer_load_dwordx4 v17, s[8:11], s41 offen offset:2048 nt lds
    s_add_u32 s41, s58, 947200
    buffer_load_dwordx4 v17, s[8:11], s41 offen offset:3072 nt lds
    v_add_u32 v28, 73728, v24
    v_add_u32 v29, 73728, v25
    v_add_u32 v30, 73728, v26
    v_add_u32 v31, 73728, v27
    ds_read_b64_tr_b16 a[156:157], v28 offset:0
    ds_read_b64_tr_b16 a[164:165], v28 offset:8
    ds_read_b64_tr_b16 a[172:173], v29 offset:0
    ds_read_b64_tr_b16 a[180:181], v29 offset:8
    ds_read_b64_tr_b16 a[188:189], v30 offset:0
    ds_read_b64_tr_b16 a[196:197], v30 offset:8
    ds_read_b64_tr_b16 a[204:205], v31 offset:0
    ds_read_b64_tr_b16 a[212:213], v31 offset:8
    s_waitcnt vmcnt(12) lgkmcnt(0)
    s_barrier
    s_cmp_eq_u32 s71, 1
    s_cbranch_scc1 cs_th24
    s_waitcnt vmcnt(6)
cs_th24:
    s_add_u32 m0, s43, 73728
    s_add_u32 s41, s58, 802816
    buffer_load_dwordx4 v17, s[8:11], s41 offen offset:0 nt lds
    s_add_u32 s41, s58, 834560
    buffer_load_dwordx4 v17, s[8:11], s41 offen offset:1024 nt lds
    s_add_u32 s41, s58, 931840
    buffer_load_dwordx4 v17, s[8:11], s41 offen offset:2048 nt lds
    s_add_u32 s41, s58, 963584
    buffer_load_dwordx4 v17, s[8:11], s41 offen offset:3072 nt lds
    v_add_u32 v28, 110592, v24
    v_add_u32 v29, 110592, v25
    v_add_u32 v30, 110592, v26
    v_add_u32 v31, 110592, v27
    ds_read_b64_tr_b16 a[158:159], v28 offset:0
    ds_read_b64_tr_b16 a[166:167], v28 offset:8
    ds_read_b64_tr_b16 a[174:175], v29 offset:0
    ds_read_b64_tr_b16 a[182:183], v29 offset:8
    ds_read_b64_tr_b16 a[190:191], v30 offset:0
    ds_read_b64_tr_b16 a[198:199], v30 offset:8
    ds_read_b64_tr_b16 a[206:207], v31 offset:0
    ds_read_b64_tr_b16 a[214:215], v31 offset:8
    s_waitcnt vmcnt(12) lgkmcnt(0)
    s_barrier
    s_cmp_eq_u32 s71, 1
    s_cbranch_scc1 cs_th25
    s_waitcnt vmcnt(6)
cs_th25:
    s_mov_b64 s[8:9], s[52:53]
    s_add_u32 m0, s43, 110592
    s_add_u32 s41, s59, 0
    buffer_load_dwordx4 v17, s[8:11], s41 offen offset:0 nt lds
    s_add_u32 s41, s59, 31744
    buffer_load_dwordx4 v17, s[8:11], s41 offen offset:1024 nt lds
    s_add_u32 s41, s59, 129024
    buffer_load_dwordx4 v17, s[8:11], s41 offen offset:2048 nt lds
    s_add_u32 s41, s59, 160768
    buffer_load_dwordx4 v17, s[8:11], s41 offen offset:3072 nt lds
    v_add_u32 v28, 147456, v24
    v_add_u32 v29, 147456, v25
    v_add_u32 v30, 147456, v26
    v_add_u32 v31, 147456, v27
    ds_read_b64_tr_b16 v[180:181], v28 offset:0
    ds_read_b64_tr_b16 v[188:189], v28 offset:8
    ds_read_b64_tr_b16 v[196:197], v29 offset:0
    ds_read_b64_tr_b16 v[204:205], v29 offset:8
    ds_read_b64_tr_b16 v[212:213], v30 offset:0
    ds_read_b64_tr_b16 v[220:221], v30 offset:8
    ds_read_b64_tr_b16 v[228:229], v31 offset:0
    ds_read_b64_tr_b16 v[236:237], v31 offset:8
    s_waitcnt vmcnt(12) lgkmcnt(0)
    s_barrier
    s_cmp_eq_u32 s71, 1
    s_cbranch_scc1 cs_th26
    s_waitcnt vmcnt(6)
cs_th26:
    s_mov_b64 s[8:9], s[50:51]
    s_add_u32 m0, s43, 147456
    s_add_u32 s41, s59, 0
    buffer_load_dwordx4 v17, s[8:11], s41 offen offset:0 nt lds
    s_add_u32 s41, s59, 31744
    buffer_load_dwordx4 v17, s[8:11], s41 offen offset:1024 nt lds
    s_add_u32 s41, s59, 129024
    buffer_load_dwordx4 v17, s[8:11], s41 offen offset:2048 nt lds
    s_add_u32 s41, s59, 160768
    buffer_load_dwordx4 v17, s[8:11], s41 offen offset:3072 nt lds
    v_add_u32 v28, 0, v24
    v_add_u32 v29, 0, v25
    v_add_u32 v30, 0, v26
    v_add_u32 v31, 0, v27
    ds_read_b64_tr_b16 v[182:183], v28 offset:0
    ds_read_b64_tr_b16 v[190:191], v28 offset:8
    ds_read_b64_tr_b16 v[198:199], v29 offset:0
    ds_read_b64_tr_b16 v[206:207], v29 offset:8
    ds_read_b64_tr_b16 v[214:215], v30 offset:0
    ds_read_b64_tr_b16 v[222:223], v30 offset:8
    ds_read_b64_tr_b16 v[230:231], v31 offset:0
    ds_read_b64_tr_b16 v[238:239], v31 offset:8
    s_waitcnt vmcnt(12) lgkmcnt(0)
    s_barrier
    s_cmp_eq_u32 s71, 1
    s_cbranch_scc1 cs_th27
    s_waitcnt vmcnt(6)
cs_th27:
    s_mov_b64 s[8:9], s[54:55]
    s_add_u32 m0, s43, 0
    s_add_u32 s41, s59, 0
    buffer_load_dwordx4 v17, s[8:11], s41 offen offset:0 nt lds
    s_add_u32 s41, s59, 31744
    buffer_load_dwordx4 v17, s[8:11], s41 offen offset:1024 nt lds
    s_add_u32 s41, s59, 129024
    buffer_load_dwordx4 v17, s[8:11], s41 offen offset:2048 nt lds
    s_add_u32 s41, s59, 160768
    buffer_load_dwordx4 v17, s[8:11], s41 offen offset:3072 nt lds
    v_add_u32 v28, 36864, v24
    v_add_u32 v29, 36864, v25
    v_add_u32 v30, 36864, v26
    v_add_u32 v31, 36864, v27
    ds_read_b64_tr_b16 a[20:21], v28 offset:0
    ds_read_b64_tr_b16 a[28:29], v28 offset:8
    ds_read_b64_tr_b16 a[36:37], v29 offset:0
    ds_read_b64_tr_b16 a[44:45], v29 offset:8
    ds_read_b64_tr_b16 a[52:53], v30 offset:0
    ds_read_b64_tr_b16 a[60:61], v30 offset:8
    ds_read_b64_tr_b16 a[68:69], v31 offset:0
    ds_read_b64_tr_b16 a[76:77], v31 offset:8
    s_waitcnt vmcnt(12) lgkmcnt(0)
    s_barrier
    s_cmp_eq_u32 s71, 1
    s_cbranch_scc1 cs_th28
    s_waitcnt vmcnt(6)
cs_th28:
    s_mov_b64 s[8:9], s[56:57]
    s_add_u32 m0, s43, 36864
    s_add_u32 s41, s60, 128
    buffer_load_dwordx4 v18, s[8:11], s41 offen offset:0 nt lds
    s_add_u32 s41, s60, 8320
    buffer_load_dwordx4 v18, s[8:11], s41 offen offset:1024 nt lds
    s_add_u32 s41, s60, 16512
    buffer_load_dwordx4 v18, s[8:11], s41 offen offset:2048 nt lds
    s_add_u32 s41, s60, 24704
    buffer_load_dwordx4 v18, s[8:11], s41 offen offset:3072 nt lds
    v_add_u32 v28, 73728, v24
    v_add_u32 v29, 73728, v25
    v_add_u32 v30, 73728, v26
    v_add_u32 v31, 73728, v27
    ds_read_b64_tr_b16 a[22:23], v28 offset:0
    ds_read_b64_tr_b16 a[30:31], v28 offset:8
    ds_read_b64_tr_b16 a[38:39], v29 offset:0
    ds_read_b64_tr_b16 a[46:47], v29 offset:8
    ds_read_b64_tr_b16 a[54:55], v30 offset:0
    ds_read_b64_tr_b16 a[62:63], v30 offset:8
    ds_read_b64_tr_b16 a[70:71], v31 offset:0
    ds_read_b64_tr_b16 a[78:79], v31 offset:8
    s_waitcnt vmcnt(12) lgkmcnt(0)
    s_barrier
    s_cmp_eq_u32 s71, 1
    s_cbranch_scc1 cs_th29
    s_waitcnt vmcnt(6)
cs_th29:
    s_add_u32 m0, s43, 73728
    s_add_u32 s41, s61, 128
    buffer_load_dwordx4 v18, s[8:11], s41 offen offset:0 nt lds
    s_add_u32 s41, s61, 8320
    buffer_load_dwordx4 v18, s[8:11], s41 offen offset:1024 nt lds
    s_add_u32 s41, s61, 16512
    buffer_load_dwordx4 v18, s[8:11], s41 offen offset:2048 nt lds
    s_add_u32 s41, s61, 24704
    buffer_load_dwordx4 v18, s[8:11], s41 offen offset:3072 nt lds
    v_add_u32 v77, 110592, v20
    ds_read_b64_tr_b16 a[216:217], v77 offset:0
    ds_read_b64_tr_b16 a[218:219], v77 offset:4096
    ds_read_b64_tr_b16 a[220:221], v77 offset:8192
    ds_read_b64_tr_b16 a[222:223], v77 offset:12288
    ds_read_b64_tr_b16 a[224:225], v77 offset:8
    ds_read_b64_tr_b16 a[226:227], v77 offset:4104
    ds_read_b64_tr_b16 a[228:229], v77 offset:8200
    ds_read_b64_tr_b16 a[230:231], v77 offset:12296
    s_waitcnt vmcnt(12) lgkmcnt(0)
    s_barrier
    s_cmp_eq_u32 s71, 1
    s_cbranch_scc1 cs_th30
    s_waitcnt vmcnt(6)
cs_th30:
    s_add_u32 m0, s43, 110592
    s_add_u32 s41, s62, 128
    buffer_load_dwordx4 v18, s[8:11], s41 offen offset:0 nt lds
    s_add_u32 s41, s62, 8320
    buffer_load_dwordx4 v18, s[8:11], s41 offen offset:1024 nt lds
    s_add_u32 s41, s62, 16512
    buffer_load_dwordx4 v18, s[8:11], s41 offen offset:2048 nt lds
    s_add_u32 s41, s62, 24704
    buffer_load_dwordx4 v18, s[8:11], s41 offen offset:3072 nt lds
    v_add_u32 v77, 147456, v20
    ds_read_b64_tr_b16 a[80:81], v77 offset:0
    ds_read_b64_tr_b16 a[82:83], v77 offset:4096
    ds_read_b64_tr_b16 a[84:85], v77 offset:8192
    ds_read_b64_tr_b16 a[86:87], v77 offset:12288
    ds_read_b64_tr_b16 a[88:89], v77 offset:8
    ds_read_b64_tr_b16 a[90:91], v77 offset:4104
    ds_read_b64_tr_b16 a[92:93], v77 offset:8200
    ds_read_b64_tr_b16 a[94:95], v77 offset:12296
    s_waitcnt vmcnt(12) lgkmcnt(0)
    s_barrier
    s_cmp_eq_u32 s71, 1
    s_cbranch_scc1 cs_th31
    s_waitcnt vmcnt(6)
cs_th31:
    s_add_u32 m0, s43, 147456
    s_add_u32 s41, s63, 128
    buffer_load_dwordx4 v18, s[8:11], s41 offen offset:0 nt lds
    s_add_u32 s41, s63, 8320
    buffer_load_dwordx4 v18, s[8:11], s41 offen offset:1024 nt lds
    s_add_u32 s41, s63, 16512
    buffer_load_dwordx4 v18, s[8:11], s41 offen offset:2048 nt lds
    s_add_u32 s41, s63, 24704
    buffer_load_dwordx4 v18, s[8:11], s41 offen offset:3072 nt lds
    v_mov_b32 v78, v21
    v_mov_b32 v79, v22
    v_add_u32 v77, 0, v20
    ds_read_b64_tr_b16 v[240:241], v77 offset:0
    ds_read_b64_tr_b16 v[242:243], v77 offset:4096
    ds_read_b64_tr_b16 v[244:245], v77 offset:8192
    ds_read_b64_tr_b16 v[246:247], v77 offset:12288
    ds_read_b64_tr_b16 v[248:249], v77 offset:8
    ds_read_b64_tr_b16 v[250:251], v77 offset:4104
    ds_read_b64_tr_b16 v[252:253], v77 offset:8200
    ds_read_b64_tr_b16 v[254:255], v77 offset:12296
    s_waitcnt vmcnt(12) lgkmcnt(0)
    s_barrier
    v_bfe_u32 v60, v65, 4, 6
    v_and_b32 v61, 15, v60
    v_lshrrev_b32 v62, 4, v60
    v_mov_b32 v50, 0x3f80
    v_mov_b32 v51, 0x3f800000
    v_and_b32 v57, 1, v62
    v_lshlrev_b32 v57, 2, v57
    v_sub_u32 v57, v61, v57
    v_and_b32 v58, 3, v61
    v_lshlrev_b32 v58, 2, v58
    v_lshrrev_b32 v59, 2, v61
    v_add_u32 v58, v58, v59
    v_cmp_eq_u32 vcc, 0, v57
    s_nop 1
    v_cndmask_b32 v40, 0, v50, vcc
    v_cmp_eq_u32 vcc, 1, v57
    s_nop 1
    v_cndmask_b32 v40, v40, v51, vcc
    v_cmp_eq_u32 vcc, 0, v58
    s_nop 1
    v_cndmask_b32 v44, 0, v50, vcc
    v_cmp_eq_u32 vcc, 1, v58
    s_nop 1
    v_cndmask_b32 v44, v44, v51, vcc
    v_cmp_eq_u32 vcc, 2, v57
    s_nop 1
    v_cndmask_b32 v41, 0, v50, vcc
    v_cmp_eq_u32 vcc, 3, v57
    s_nop 1
    v_cndmask_b32 v41, v41, v51, vcc
    v_cmp_eq_u32 vcc, 2, v58
    s_nop 1
    v_cndmask_b32 v45, 0, v50, vcc
    v_cmp_eq_u32 vcc, 3, v58
    s_nop 1
    v_cndmask_b32 v45, v45, v51, vcc
    v_cmp_eq_u32 vcc, 8, v57
    s_nop 1
    v_cndmask_b32 v42, 0, v50, vcc
    v_cmp_eq_u32 vcc, 9, v57
    s_nop 1
    v_cndmask_b32 v42, v42, v51, vcc
    v_cmp_eq_u32 vcc, 4, v58
    s_nop 1
    v_cndmask_b32 v46, 0, v50, vcc
    v_cmp_eq_u32 vcc, 5, v58
    s_nop 1
    v_cndmask_b32 v46, v46, v51, vcc
    v_cmp_eq_u32 vcc, 10, v57
    s_nop 1
    v_cndmask_b32 v43, 0, v50, vcc
    v_cmp_eq_u32 vcc, 11, v57
    s_nop 1
    v_cndmask_b32 v43, v43, v51, vcc
    v_cmp_eq_u32 vcc, 6, v58
    s_nop 1
    v_cndmask_b32 v47, 0, v50, vcc
    v_cmp_eq_u32 vcc, 7, v58
    s_nop 1
    v_cndmask_b32 v47, v47, v51, vcc
    v_lshlrev_b32 v57, 4, v61
    ds_write_b128 v69, v[40:43] offset:15360
    ds_write_b128 v57, v[44:47] offset:15872
    v_add_u32 v77, 36864, v79
    s_waitcnt lgkmcnt(0)
    ds_read_b64_tr_b16 v[0:1], v77 offset:0
    ds_read_b64_tr_b16 v[2:3], v77 offset:256
    ds_read_b64_tr_b16 v[4:5], v77 offset:2048
    ds_read_b64_tr_b16 v[6:7], v77 offset:2304
    ds_read_b64_tr_b16 v[8:9], v77 offset:16
    ds_read_b64_tr_b16 v[10:11], v77 offset:272
    ds_read_b64_tr_b16 v[12:13], v77 offset:2064
    ds_read_b64_tr_b16 v[14:15], v77 offset:2320
    s_waitcnt vmcnt(8) lgkmcnt(0)
    s_barrier
    v_add_u32 v77, 73728, v78
    ds_read_b64_tr_b16 v[16:17], v77 offset:0
    ds_read_b64_tr_b16 v[18:19], v77 offset:256
    ds_read_b64_tr_b16 v[20:21], v77 offset:2048
    ds_read_b64_tr_b16 v[22:23], v77 offset:2304
    ds_read_b64_tr_b16 v[24:25], v77 offset:16
    ds_read_b64_tr_b16 v[26:27], v77 offset:272
    ds_read_b64_tr_b16 v[28:29], v77 offset:2064
    ds_read_b64_tr_b16 v[30:31], v77 offset:2320
    s_waitcnt vmcnt(4) lgkmcnt(0)
    s_barrier
    v_add_u32 v77, 110592, v78
    ds_read_b64_tr_b16 v[32:33], v77 offset:0
    ds_read_b64_tr_b16 v[34:35], v77 offset:256
    ds_read_b64_tr_b16 v[36:37], v77 offset:2048
    ds_read_b64_tr_b16 v[38:39], v77 offset:2304
    ds_read_b64_tr_b16 v[40:41], v77 offset:16
    ds_read_b64_tr_b16 v[42:43], v77 offset:272
    ds_read_b64_tr_b16 v[44:45], v77 offset:2064
    ds_read_b64_tr_b16 v[46:47], v77 offset:2320
    s_waitcnt vmcnt(0) lgkmcnt(0)
    s_barrier
    v_add_u32 v77, 147456, v78
    ds_read_b64_tr_b16 v[48:49], v77 offset:0
    ds_read_b64_tr_b16 v[50:51], v77 offset:256
    ds_read_b64_tr_b16 v[52:53], v77 offset:2048
    ds_read_b64_tr_b16 v[54:55], v77 offset:2304
    ds_read_b64_tr_b16 v[56:57], v77 offset:16
    ds_read_b64_tr_b16 v[58:59], v77 offset:272
    ds_read_b64_tr_b16 v[60:61], v77 offset:2064
    ds_read_b64_tr_b16 v[62:63], v77 offset:2320
    s_waitcnt lgkmcnt(0)
    s_barrier
    ds_write_b128 v70, v[0:3] offset:20480
    ds_write_b128 v70, v[4:7] offset:21504
    ds_write_b128 v70, v[8:11] offset:22528
    ds_write_b128 v70, v[12:15] offset:23552
    ds_write_b128 v70, v[16:19] offset:24576
    ds_write_b128 v70, v[20:23] offset:25600
    ds_write_b128 v70, v[24:27] offset:26624
    ds_write_b128 v70, v[28:31] offset:27648
    ds_write_b128 v70, v[32:35] offset:28672
    ds_write_b128 v70, v[36:39] offset:29696
    ds_write_b128 v70, v[40:43] offset:30720
    ds_write_b128 v70, v[44:47] offset:31744
    ds_write_b128 v70, v[48:51] offset:32768
    ds_write_b128 v70, v[52:55] offset:33792
    ds_write_b128 v70, v[56:59] offset:34816
    ds_write_b128 v70, v[60:63] offset:35840
    s_waitcnt vmcnt(0) lgkmcnt(0)
    s_barrier
    v_mov_b32 v2, 1
    s_cmp_lg_u32 s13, 0
    s_cbranch_scc1 cs_noarr
    s_mov_b64 exec, 1
    buffer_atomic_add v2, off, s[84:87], 0 offset:212
    s_mov_b32 s40, 16777216
    s_mov_b32 s42, 2
cs_startpoll:
    buffer_load_dword v3, off, s[84:87], 0 offset:212 sc1
    s_sub_u32 s40, s40, 1
    s_cbranch_scc1 cs_decide
    s_waitcnt vmcnt(0)
    v_readfirstlane_b32 s41, v3
    s_nop 1
    s_cmp_lt_u32 s41, 32
    s_cbranch_scc1 cs_startpoll
    s_mov_b32 s42, 1
cs_decide:
    s_mov_b64 exec, -1
cs_noarr:
    s_barrier
    s_mov_b32 s44, 0x3e0293ee
    s_mov_b32 s45, s44
    s_or_b32 s66, s44, 0x80000000
    s_mov_b32 s48, 0x3f003f00
    s_mov_b32 s49, 0
    s_mov_b32 s50, 0x3f803f80
    s_mov_b32 s51, 0x3f803f80
    s_mov_b32 s52, 512
    s_mov_b32 s53, 1024
    s_mov_b32 s54, 1536
    s_mov_b32 s30, 0
    s_mov_b32 s37, 0
    s_mov_b32 s98, -100
    s_lshl_b32 s47, s13, 9
    s_cmp_lg_u32 s32, 0
    s_cselect_b32 s71, s13, 3
    s_add_u32 s46, s71, 1
    s_lshr_b32 s46, s46, 1
    s_mov_b32 s14, 67649536
    s_mov_b32 s15, 67653632
    s_mov_b32 s16, 67657728
    s_mov_b32 s36, 0
    s_add_u32 s17, s68, 67633152
    s_mov_b32 s69, 0
    s_mov_b32 s70, 0
    s_lshl_b32 s26, s12, 14
    s_add_u32 s26, s26, 0
    s_mul_i32 s40, s13, 3072
    s_add_u32 s24, s26, s40
    s_add_u32 s26, s24, s33
    s_add_u32 s99, s26, 33030144
    s_lshl_b32 s96, s12, 7
    s_add_u32 s29, s96, 125845504
    s_add_u32 s96, s96, 125829120
    s_lshl_b32 s40, s12, 14
    s_add_u32 s40, s40, 68681728
    s_add_u32 s18, s40, 0
    s_add_u32 s19, s40, 4096
    s_add_u32 s20, s40, 8192
    s_add_u32 s21, s40, 12288
    s_lshr_b32 s40, s12, 3
    s_lshl_b32 s40, s40, 12
    s_and_b32 s41, s12, 7
    s_lshl_b32 s41, s41, 7
    s_add_u32 s40, s40, s41
    s_add_u32 s22, s40, 68681728
    s_add_u32 s23, s22, 1024
    s_add_u32 s25, s22, 2048
    s_mov_b32 s56, -65472
    s_cmp_lg_u32 s32, 0
    s_cselect_b64 s[38:39], -1, 0
    s_add_u32 s55, s68, 138412032
    s_cmp_eq_u32 s13, 3
    s_cselect_b64 s[100:101], 1, 0
    s_cselect_b64 s[38:39], 1, s[38:39]
    s_cselect_b32 s93, 64, 0
    s_cselect_b32 s55, s29, s55
    s_cselect_b32 s57, 0, 9216
    s_mov_b32 s34, 0xff00ff00
    s_mov_b32 s35, 0xff00ff00
    s_lshl_b32 s28, s12, 12
    s_add_u32 s28, s28, 7340032
    s_add_u32 s27, s28, 77594624
    s_add_u32 s28, s28, 69206016
    s_mov_b64 exec, s[100:101]
    v_mov_b32 v72, s95
    s_mov_b64 exec, -1
    s_mov_b32 s40, 3
    v_bfe_u32 v78, v65, 2, 5
    s_mov_b32 s31, 4194304
cs_kv0:
    buffer_load_dword v77, v78, s[4:7], s96 offen offset:16 sc1
    s_waitcnt vmcnt(0)
    v_subrev_u32 v77, s95, v77
    v_cmp_lt_u32 vcc, 16, v77
    s_nop 1
    v_cndmask_b32 v77, v77, 0, vcc
    v_bfe_u32 v79, v78, 2, 2
    v_lshl_add_u32 v77, v77, 2, v79
    s_nop 1
    v_min_u32_dpp v77, v77, v77 row_ror:1 row_mask:0xf bank_mask:0xf
    s_nop 1
    v_min_u32_dpp v77, v77, v77 row_ror:2 row_mask:0xf bank_mask:0xf
    s_nop 1
    v_min_u32_dpp v77, v77, v77 row_ror:4 row_mask:0xf bank_mask:0xf
    s_nop 0
    v_readfirstlane_b32 s97, v77
    s_sub_u32 s31, s31, 1
    s_cbranch_scc1 cs_kv0_x
    s_cmp_le_u32 s40, s97
    s_cbranch_scc1 cs_kv0_x
    s_sleep 2
    s_branch cs_kv0
cs_kv0_x:
    s_add_u32 s40, s26, 0
    s_min_u32 s40, s40, s99
    s_sub_u32 s41, s96, s40
    v_bfe_u32 v77, v65, 2, 5
    v_add3_u32 v77, v77, s41, 16
    v_lshlrev_b32 v78, 3, v69
    s_nop 0
    v_mov_b32_dpp v78, v77 quad_perm:[0,1,2,3] row_mask:0xc bank_mask:0xf
    buffer_load_dword v76, v78, s[4:7], s40 offen sc1
    s_add_u32 s40, s26, 524288
    s_min_u32 s40, s40, s99
    s_sub_u32 s41, s96, s40
    v_bfe_u32 v77, v65, 2, 5
    v_add3_u32 v77, v77, s41, 16
    v_lshlrev_b32 v78, 3, v69
    s_nop 0
    v_mov_b32_dpp v78, v77 quad_perm:[0,1,2,3] row_mask:0xc bank_mask:0xf
    buffer_load_dword v76, v78, s[4:7], s40 offen sc1
cs_kvdone:
    v_mov_b64 v[0:1], 0
    v_mov_b64 v[2:3], 0
    v_mov_b64 v[4:5], 0
    v_mov_b64 v[6:7], 0
    v_mov_b64 v[8:9], 0
    v_mov_b64 v[10:11], 0
    v_mov_b64 v[12:13], 0
    v_mov_b64 v[14:15], 0
    v_mov_b64 v[16:17], 0
    v_mov_b64 v[18:19], 0
    v_mov_b64 v[20:21], 0
    v_mov_b64 v[22:23], 0
    ds_read_b128 v[44:47], v70 offset:0
    ds_read_b128 v[48:51], v70 offset:1024
    ds_read_b128 v[52:55], v70 offset:2048
    ds_read_b128 v[56:59], v70 offset:3072
    ds_read_b128 v[24:27], v70 offset:4096
    ds_read_b128 v[28:31], v70 offset:5120
    ds_read_b128 v[32:35], v70 offset:6144
    ds_read_b128 v[36:39], v70 offset:7168
    buffer_load_dwordx4 v[40:43], v65, s[4:7], s14 offen offset:0 sc1
    buffer_load_dwordx4 v[60:63], v66, s[4:7], s14 offen offset:0 sc1
    s_mov_b32 s31, 1048576
    s_waitcnt vmcnt(0) lgkmcnt(0)
    s_branch cs_goA
cs_loop:
    s_mov_b32 s31, 1048576
    s_mov_b32 s69, s70
    s_waitcnt lgkmcnt(0)
cs_cA:
    buffer_load_dwordx4 v[40:43], v65, s[4:7], s14 offen offset:0 sc1
    buffer_load_dwordx4 v[60:63], v66, s[4:7], s14 offen offset:0 sc1
cs_cA1:
    s_waitcnt vmcnt(0)
    v_bitop3_b32 v77, v40, v60, s70 bitop3:0x7e
    v_bitop3_b32 v77, v77, v41, s70 bitop3:0xf6
    v_bitop3_b32 v77, v77, v42, s70 bitop3:0xf6
    v_bitop3_b32 v77, v77, v43, s70 bitop3:0xf6
    v_bitop3_b32 v77, v77, v61, s70 bitop3:0xf6
    v_bitop3_b32 v77, v77, v62, s70 bitop3:0xf6
    v_bitop3_b32 v77, v77, v63, s70 bitop3:0xf6
    v_and_b32 v77, 1, v77
    v_cmp_ne_u32 vcc, 0, v77
    s_cbranch_vccz cs_goA
    s_nop 15
    s_nop 15
    s_nop 7
    buffer_load_dwordx4 v[40:43], v65, s[4:7], s14 offen offset:0 sc1
    buffer_load_dwordx4 v[60:63], v66, s[4:7], s14 offen offset:0 sc1
    s_waitcnt vmcnt(0)
    v_bitop3_b32 v77, v40, v60, s70 bitop3:0x7e
    v_bitop3_b32 v77, v77, v41, s70 bitop3:0xf6
    v_bitop3_b32 v77, v77, v42, s70 bitop3:0xf6
    v_bitop3_b32 v77, v77, v43, s70 bitop3:0xf6
    v_bitop3_b32 v77, v77, v61, s70 bitop3:0xf6
    v_bitop3_b32 v77, v77, v62, s70 bitop3:0xf6
    v_bitop3_b32 v77, v77, v63, s70 bitop3:0xf6
    v_and_b32 v77, 1, v77
    v_cmp_ne_u32 vcc, 0, v77
    s_cbranch_vccz cs_goA
    s_nop 15
    s_nop 15
    s_nop 7
    buffer_load_dwordx4 v[40:43], v65, s[4:7], s14 offen offset:0 sc1
    buffer_load_dwordx4 v[60:63], v66, s[4:7], s14 offen offset:0 sc1
    s_waitcnt vmcnt(0)
    v_bitop3_b32 v77, v40, v60, s70 bitop3:0x7e
    v_bitop3_b32 v77, v77, v41, s70 bitop3:0xf6
    v_bitop3_b32 v77, v77, v42, s70 bitop3:0xf6
    v_bitop3_b32 v77, v77, v43, s70 bitop3:0xf6
    v_bitop3_b32 v77, v77, v61, s70 bitop3:0xf6
    v_bitop3_b32 v77, v77, v62, s70 bitop3:0xf6
    v_bitop3_b32 v77, v77, v63, s70 bitop3:0xf6
    v_and_b32 v77, 1, v77
    v_cmp_ne_u32 vcc, 0, v77
    s_cbranch_vccz cs_goA
    s_nop 15
    s_nop 15
    s_nop 7
    buffer_load_dwordx4 v[40:43], v65, s[4:7], s14 offen offset:0 sc1
    buffer_load_dwordx4 v[60:63], v66, s[4:7], s14 offen offset:0 sc1
    s_waitcnt vmcnt(0)
    v_bitop3_b32 v77, v40, v60, s70 bitop3:0x7e
    v_bitop3_b32 v77, v77, v41, s70 bitop3:0xf6
    v_bitop3_b32 v77, v77, v42, s70 bitop3:0xf6
    v_bitop3_b32 v77, v77, v43, s70 bitop3:0xf6
    v_bitop3_b32 v77, v77, v61, s70 bitop3:0xf6
    v_bitop3_b32 v77, v77, v62, s70 bitop3:0xf6
    v_bitop3_b32 v77, v77, v63, s70 bitop3:0xf6
    v_and_b32 v77, 1, v77
    v_cmp_ne_u32 vcc, 0, v77
    s_cbranch_vccz cs_goA
    s_nop 15
    s_nop 15
    s_nop 7
    s_sub_u32 s31, s31, 64
    s_cbranch_scc0 cs_cA
cs_goA:
    ds_write_b128 v65, v[40:43] offset:0
    v_smfmac_f32_16x16x64_bf16 v[0:3], v[40:43], v[44:51], v64
    v_smfmac_f32_16x16x64_bf16 v[4:7], v[40:43], v[52:59], v64
    buffer_load_dwordx4 v[44:47], v65, s[4:7], s15 offen offset:0 sc1
    v_smfmac_f32_16x16x64_bf16 v[0:3], v[60:63], v[24:31], v64
    s_add_u32 s40, s26, 1048576
    s_min_u32 s40, s40, s99
    s_sub_u32 s41, s96, s40
    v_smfmac_f32_16x16x64_bf16 v[4:7], v[60:63], v[32:39], v64
    ds_read_b128 v[24:27], v70 offset:8192
    s_cmp_lt_u32 s97, s93
    s_cselect_b32 s41, s41, 0
    v_smfmac_f32_16x16x64_bf16 v[8:11], v[40:43], a[96:103], v64
    ds_read_b128 v[28:31], v70 offset:9216
    v_smfmac_f32_16x16x64_bf16 v[12:15], v[40:43], a[104:111], v64
    ds_read_b128 v[32:35], v70 offset:10240
    s_waitcnt lgkmcnt(3)
    s_barrier
    ds_read_b128 v[48:51], v67 offset:0
    v_smfmac_f32_16x16x64_bf16 v[8:11], v[60:63], a[112:119], v64
    ds_read_b128 v[36:39], v70 offset:11264
    v_bitop3_b32 v79, v73, -9, s54 bitop3:0x6a
    v_smfmac_f32_16x16x64_bf16 v[12:15], v[60:63], a[120:127], v64
    v_smfmac_f32_16x16x64_bf16 v[16:19], v[40:43], a[232:239], v64
    ds_read_b128 v[52:55], v68 offset:0
    s_waitcnt lgkmcnt(4)
    v_bfe_u32 v77, v65, 2, 5
    v_smfmac_f32_16x16x64_bf16 v[20:23], v[40:43], v[24:31], v64
    ds_read_b128 v[24:27], v70 offset:12288
    s_waitcnt lgkmcnt(3)
    v_smfmac_f32_16x16x64_bf16 v[0:3], v[48:51], a[0:7], v64
    ds_read_b128 v[28:31], v70 offset:13312
    s_waitcnt lgkmcnt(3)
    v_add3_u32 v77, v77, s41, 16
    v_smfmac_f32_16x16x64_bf16 v[4:7], v[48:51], v[32:39], v64
    buffer_load_dwordx4 v[40:43], v65, s[4:7], s16 offen offset:0 sc1
    v_smfmac_f32_16x16x64_bf16 v[16:19], v[60:63], a[240:247], v64
    ds_read_b128 v[32:35], v70 offset:14336
    v_lshlrev_b32 v78, 3, v69
    v_smfmac_f32_16x16x64_bf16 v[20:23], v[60:63], a[248:255], v64
    ds_read_b128 v[36:39], v70 offset:15360
    v_smfmac_f32_16x16x64_bf16 v[8:11], v[48:51], a[128:135], v64
    s_waitcnt vmcnt(1)
    v_mov_b32_dpp v78, v77 quad_perm:[0,1,2,3] row_mask:0xc bank_mask:0xf
    v_smfmac_f32_16x16x64_bf16 v[12:15], v[48:51], a[136:143], v64
    buffer_load_dwordx4 v[58:61], v65, s[4:7], s24 offen offset:3072 sc1
    s_waitcnt lgkmcnt(2)
    v_bitop3_b32 v77, v44, v45, s70 bitop3:0x7e
    v_bitop3_b32 v77, v77, v46, s70 bitop3:0xf6
    v_bitop3_b32 v77, v77, v47, s70 bitop3:0xf6
    v_and_b32 v77, s36, v77
    v_smfmac_f32_16x16x64_bf16 v[12:15], v[52:55], v[24:31], v64
    ds_write_b128 v65, v[44:47] offset:4096
    v_smfmac_f32_16x16x64_bf16 v[0:3], v[52:55], a[8:15], v64
    v_cmp_ne_u32 vcc, 0, v77
    v_smfmac_f32_16x16x64_bf16 v[8:11], v[52:55], a[144:151], v64
    buffer_load_dwordx4 v[24:27], v65, s[4:7], s24 offen offset:0 sc1
    s_waitcnt lgkmcnt(1)
    v_smfmac_f32_16x16x64_bf16 v[4:7], v[52:55], v[32:39], v64
    s_cbranch_vccnz cs_spinB
cs_backB:
    v_smfmac_f32_16x16x64_bf16 v[16:19], v[44:47], v[176:183], v64
    s_waitcnt lgkmcnt(0)
    s_barrier
    ds_read_b128 v[48:51], v66 offset:4096
    v_smfmac_f32_16x16x64_bf16 v[12:15], v[44:47], a[160:167], v64
    buffer_load_dwordx4 v[28:31], v65, s[4:7], s24 offen offset:1024 sc1
    v_smfmac_f32_16x16x64_bf16 v[0:3], v[44:47], a[16:23], v64
    ds_read_b128 v[52:55], v67 offset:4096
    v_smfmac_f32_16x16x64_bf16 v[8:11], v[44:47], a[152:159], v64
    v_smfmac_f32_16x16x64_bf16 v[4:7], v[44:47], a[24:31], v64
    buffer_load_dwordx4 v[34:37], v65, s[4:7], s24 offen offset:2048 sc1
    s_waitcnt vmcnt(5)
    v_smfmac_f32_16x16x64_bf16 v[20:23], v[44:47], v[184:191], v64
    ds_read_b128 v[44:47], v68 offset:4096
    s_waitcnt lgkmcnt(2)
    v_smfmac_f32_16x16x64_bf16 v[0:3], v[48:51], a[32:39], v64
    v_smfmac_f32_16x16x64_bf16 v[8:11], v[48:51], a[168:175], v64
    buffer_load_dword v76, v78, s[4:7], s40 offen sc1
    v_smfmac_f32_16x16x64_bf16 v[4:7], v[48:51], a[40:47], v64
    s_waitcnt vmcnt(5)
    v_bitop3_b32 v77, v40, v41, s70 bitop3:0x7e
    v_bitop3_b32 v77, v77, v42, s70 bitop3:0xf6
    v_bitop3_b32 v77, v77, v43, s70 bitop3:0xf6
    v_and_b32 v77, s36, v77
    v_smfmac_f32_16x16x64_bf16 v[12:15], v[48:51], a[176:183], v64
    ds_read_b128 v[48:51], v69 offset:15360
    s_waitcnt lgkmcnt(1)
    v_cmp_ne_u32 vcc, 0, v77
    v_smfmac_f32_16x16x64_bf16 v[0:3], v[52:55], a[48:55], v64
    v_smfmac_f32_16x16x64_bf16 v[8:11], v[52:55], a[184:191], v64
    s_cbranch_vccnz cs_spin8
cs_back8:
    v_smfmac_f32_16x16x64_bf16 v[0:3], v[44:47], a[64:71], v64
    v_smfmac_f32_16x16x64_bf16 v[8:11], v[44:47], a[200:207], v64
    v_smfmac_f32_16x16x64_bf16 v[0:3], v[40:43], a[80:87], v64
    s_nop 1
    v_smfmac_f32_16x16x64_bf16 v[8:11], v[40:43], a[216:223], v64
    s_nop 1
    v_lshrrev_b32 v77, 1, v69
    v_smfmac_f32_16x16x64_bf16 v[4:7], v[52:55], a[56:63], v64
    s_nop 1
    v_cvt_pk_bf16_f32 v0, v0, v1
    v_smfmac_f32_16x16x64_bf16 v[12:15], v[52:55], a[192:199], v64
    s_nop 1
    v_cvt_pk_bf16_f32 v1, v2, v3
    v_smfmac_f32_16x16x64_bf16 v[4:7], v[44:47], a[72:79], v64
    s_nop 1
    v_cvt_pk_bf16_f32 v2, v8, v9
    v_smfmac_f32_16x16x64_bf16 v[12:15], v[44:47], a[208:215], v64
    s_nop 1
    v_cvt_pk_bf16_f32 v3, v10, v11
    v_smfmac_f32_16x16x64_bf16 v[4:7], v[40:43], a[88:95], v64
    s_waitcnt lgkmcnt(0)
    s_nop 0
    s_nop 0
    v_smfmac_f32_16x16x64_bf16 v[12:15], v[40:43], a[224:231], v64
    s_nop 2
    v_mfma_f32_16x16x32_bf16 v[8:11], v[0:3], v[48:51], 0
    s_nop 0
    v_cvt_pk_bf16_f32 v4, v4, v5
    v_cvt_pk_bf16_f32 v5, v6, v7
    s_nop 0
    v_cvt_pk_bf16_f32 v6, v12, v13
    v_cvt_pk_bf16_f32 v7, v14, v15
    s_nop 1
    v_mfma_f32_16x16x32_bf16 v[12:15], v[4:7], v[48:51], 0
    ds_read_b128 v[48:51], v66 offset:4096
    v_cvt_pk_bf16_f32 v0, v8, v9
    v_cvt_pk_bf16_f32 v1, v10, v11
    v_smfmac_f32_16x16x64_bf16 v[16:19], v[52:55], v[208:215], v64
    s_waitcnt vmcnt(2)
    s_nop 2
    v_cvt_pk_bf16_f32 v2, v12, v13
    v_cvt_pk_bf16_f32 v3, v14, v15
    s_nop 1
    v_mfma_f32_16x16x32_bf16 v[12:15], v[0:3], v[0:3], 0
    s_nop 1
    v_bitop3_b32 v78, v73, -9, s53 bitop3:0x6a
    v_mfma_f32_16x16x32_bf16 v[4:7], v[24:27], v[0:3], 0
    ds_read_b128 v[24:27], v67 offset:0
    s_nop 1
    v_mfma_f32_16x16x32_bf16 v[8:11], v[28:31], v[0:3], 0
    s_nop 0
    v_mov_b32_dpp v12, v14 row_ror:8 row_mask:0xf bank_mask:0xc
    v_mov_b32_dpp v13, v15 row_ror:8 row_mask:0xf bank_mask:0xc
    v_smfmac_f32_16x16x64_bf16 v[20:23], v[52:55], v[216:223], v64
    ds_write_b64 v71, v[12:13]
    ds_read_b128 v[52:55], v68 offset:0
    s_nop 1
    v_mov_b32_dpp v4, v8 row_ror:8 row_mask:0xf bank_mask:0xc
    v_mov_b32_dpp v5, v9 row_ror:8 row_mask:0xf bank_mask:0xc
    v_mov_b32_dpp v6, v10 row_ror:8 row_mask:0xf bank_mask:0xc
    v_mov_b32_dpp v7, v11 row_ror:8 row_mask:0xf bank_mask:0xc
    v_smfmac_f32_16x16x64_bf16 v[16:19], v[44:47], v[224:231], v64
    ds_write_b128 v65, v[4:7] offset:8192
    v_smfmac_f32_16x16x64_bf16 v[20:23], v[44:47], v[232:239], v64
    s_waitcnt lgkmcnt(3)
    v_smfmac_f32_16x16x64_bf16 v[16:19], v[24:27], v[144:151], v64
    s_waitcnt vmcnt(1)
    v_smfmac_f32_16x16x64_bf16 v[20:23], v[24:27], v[152:159], v64
    s_mov_b64 exec, s[38:39]
    buffer_store_dword v72, v75, s[4:7], s55 offen sc1
    s_mov_b64 exec, -1
    v_smfmac_f32_16x16x64_bf16 v[16:19], v[40:43], v[240:247], v64
    s_cmp_ge_u32 s30, 56
    s_waitcnt lgkmcnt(0)
    s_barrier
    ds_read_b128 v[8:11], v66 offset:8192
    v_smfmac_f32_16x16x64_bf16 v[20:23], v[40:43], v[248:255], v64
    ds_read_b128 v[12:15], v67 offset:8192
    v_smfmac_f32_16x16x64_bf16 v[16:19], v[48:51], v[192:199], v64
    ds_read_b128 v[44:47], v68 offset:8192
    v_smfmac_f32_16x16x64_bf16 v[20:23], v[48:51], v[200:207], v64
    ds_read_b64 v[24:25], v77 offset:14336
    ds_read_b64 v[26:27], v77 offset:14592
    v_smfmac_f32_16x16x64_bf16 v[16:19], v[52:55], v[160:167], v64
    ds_read_b64 v[28:29], v77 offset:14848
    ds_read_b64 v[30:31], v77 offset:15104
    v_bitop3_b32 v77, v73, -9, s52 bitop3:0x6a
    v_smfmac_f32_16x16x64_bf16 v[20:23], v[52:55], v[168:175], v64
    s_cbranch_scc1 cs_rare
cs_rare_x:
    ds_read_b128 v[48:51], v70 offset:22528
    ds_read_b128 v[52:55], v70 offset:23552
    s_waitcnt lgkmcnt(6)
    v_pk_add_f32 v[4:5], v[4:5], v[8:9]
    v_pk_add_f32 v[6:7], v[6:7], v[10:11]
    v_pk_add_f32 v[12:13], v[12:13], v[44:45]
    v_pk_add_f32 v[14:15], v[14:15], v[46:47]
    v_pk_add_f32 v[4:5], v[4:5], v[12:13]
    v_pk_add_f32 v[6:7], v[6:7], v[14:15]
    s_waitcnt lgkmcnt(2)
    v_pk_add_f32 v[24:25], v[24:25], v[26:27]
    v_pk_add_f32 v[28:29], v[28:29], v[30:31]
    v_max3_f32 v8, v4, v5, v6
    v_pk_add_f32 v[24:25], v[24:25], v[28:29]
    v_max_f32 v8, v8, v7
    v_max3_f32 v8, v8, v24, v25
    v_cvt_pk_bf16_f32 v32, v16, v17
    v_cvt_pk_bf16_f32 v38, v18, v19
    v_max_f32_dpp v8, v8, v8 row_ror:8 row_mask:0xf bank_mask:0xf
    v_mov_b32 v9, v8
    v_cvt_pk_bf16_f32 v56, v20, v21
    v_cvt_pk_bf16_f32 v62, v22, v23
    v_permlane32_swap_b32 v8, v9
    v_max_f32 v8, v8, v9
    v_mov_b32 v9, v8
    v_mov_b32 v11, 0
    v_mov_b32 v15, 0
    v_permlane16_swap_b32 v8, v9
    v_max_f32 v8, v8, v9
    v_mul_f32 v8, s66, v8
    v_pk_fma_f32 v[4:5], v[4:5], s[44:45], v[8:9] op_sel_hi:[1,1,0]
    v_pk_fma_f32 v[6:7], v[6:7], s[44:45], v[8:9] op_sel_hi:[1,1,0]
    v_pk_fma_f32 v[24:25], v[24:25], s[44:45], v[8:9] op_sel_hi:[1,1,0]
    v_exp_f32 v4, v4
    v_exp_f32 v5, v5
    v_exp_f32 v6, v6
    v_exp_f32 v7, v7
    v_exp_f32 v24, v24
    v_exp_f32 v25, v25
    v_cvt_pk_bf16_f32 v12, v4, v5
    v_cvt_pk_bf16_f32 v13, v6, v7
    v_cvt_pk_bf16_f32 v10, v24, v25
    v_cvt_pk_bf16_f32 v14, v24, v25
    v_mov_b64 v[0:1], s[48:49]
    v_mfma_f32_16x16x32_bf16 v[4:7], v[32:35], v[10:13], 0
    ds_read_b128 v[40:43], v70 offset:20480
    v_mov_b64 v[2:3], s[50:51]
    v_mfma_f32_16x16x32_bf16 v[24:27], v[36:39], v[12:15], 0
    ds_read_b128 v[44:47], v70 offset:21504
    v_mov_b64 v[8:9], 0
    v_mfma_f32_16x16x32_bf16 v[28:31], v[0:3], v[10:13], 0
    ds_read_b128 v[32:35], v70 offset:24576
    v_mov_b64 v[0:1], 0
    v_mfma_f32_16x16x32_bf16 v[16:19], v[56:59], v[10:13], 0
    ds_read_b128 v[36:39], v70 offset:25600
    v_mov_b64 v[2:3], 0
    v_mfma_f32_16x16x32_bf16 v[20:23], v[60:63], v[12:15], 0
    ds_read_b128 v[56:59], v70 offset:28672
    v_add_f32_dpp v4, v24, v4 row_ror:8 row_mask:0xf bank_mask:0xf
    v_add_f32_dpp v5, v25, v5 row_ror:8 row_mask:0xf bank_mask:0xf
    v_add_f32_dpp v6, v26, v6 row_ror:8 row_mask:0xf bank_mask:0xf
    v_add_f32_dpp v7, v27, v7 row_ror:8 row_mask:0xf bank_mask:0xf
    v_add_f32_dpp v29, v28, v28 row_ror:8 row_mask:0xf bank_mask:0xf
    v_rcp_f32 v28, v29
    v_mov_b64 v[10:11], 0
    v_add_f32_dpp v4, v16, v20 row_ror:8 row_mask:0xf bank_mask:0xc
    v_add_f32_dpp v5, v17, v21 row_ror:8 row_mask:0xf bank_mask:0xc
    v_add_f32_dpp v6, v18, v22 row_ror:8 row_mask:0xf bank_mask:0xc
    v_add_f32_dpp v7, v19, v23 row_ror:8 row_mask:0xf bank_mask:0xc
    v_pk_mul_f32 v[4:5], v[4:5], v[28:29] op_sel_hi:[1,0]
    v_pk_mul_f32 v[6:7], v[6:7], v[28:29] op_sel_hi:[1,0]
    v_cvt_pk_bf16_f32 v4, v4, v5
    v_cvt_pk_bf16_f32 v5, v6, v7
    ds_write_b64 v73, v[4:5] offset:12288
    v_mov_b32_dpp v6, v4 row_ror:8 row_mask:0xf bank_mask:0xf
    v_mov_b32_dpp v7, v5 row_ror:8 row_mask:0xf bank_mask:0xf
    v_mov_b64 v[12:13], 0
    v_mov_b64 v[14:15], 0
    v_smfmac_f32_16x16x64_bf16 v[8:11], v[4:7], v[80:87], v64
    s_waitcnt lgkmcnt(4)
    v_mov_b64 v[24:25], 0
    v_smfmac_f32_16x16x64_bf16 v[0:3], v[4:7], v[40:47], v64
    ds_read_b128 v[60:63], v70 offset:29696
    v_mov_b64 v[26:27], 0
    v_smfmac_f32_16x16x64_bf16 v[12:15], v[4:7], v[112:119], v64
    s_waitcnt lgkmcnt(1)
    s_barrier
    ds_read_b128 v[16:19], v77 offset:12288
    v_smfmac_f32_16x16x64_bf16 v[24:27], v[4:7], v[48:55], v64
    ds_read_b128 v[20:23], v78 offset:12288
    ds_read_b128 v[28:31], v79 offset:12288
    v_mov_b64 v[4:5], 0
    v_mov_b64 v[6:7], 0
    v_bfe_u32 v77, v74, 16, 1
    v_mad_i32_i24 v77, v77, s56, v74
    s_waitcnt lgkmcnt(2)
    v_smfmac_f32_16x16x64_bf16 v[8:11], v[16:19], v[88:95], v64
    ds_read_b128 v[40:43], v70 offset:32768
    s_waitcnt lgkmcnt(2)
    v_smfmac_f32_16x16x64_bf16 v[8:11], v[20:23], v[96:103], v64
    ds_read_b128 v[44:47], v70 offset:33792
    s_waitcnt lgkmcnt(2)
    v_smfmac_f32_16x16x64_bf16 v[8:11], v[28:31], v[104:111], v64
    ds_read_b128 v[48:51], v70 offset:26624
    s_nop 0
    v_and_b32 v72, 8, v73
    v_smfmac_f32_16x16x64_bf16 v[0:3], v[16:19], v[32:39], v64
    ds_read_b128 v[52:55], v70 offset:27648
    s_nop 0
    v_mad_u32_u24 v72, v72, 63, v73
    v_smfmac_f32_16x16x64_bf16 v[12:15], v[16:19], v[120:127], v64
    ds_read_b128 v[32:35], v70 offset:30720
    v_cvt_pk_bf16_f32 v8, v8, v9
    v_cvt_pk_bf16_f32 v9, v10, v11
    v_and_or_b32 v8, v8, -2, s69
    v_smfmac_f32_16x16x64_bf16 v[12:15], v[20:23], v[128:135], v64
    buffer_store_dwordx2 v[8:9], v74, s[4:7], s22 offen offset:0 sc1
    ds_read_b128 v[36:39], v70 offset:31744
    v_smfmac_f32_16x16x64_bf16 v[12:15], v[28:31], v[136:143], v64
    s_add_u32 s30, s30, 1
    s_xor_b32 s70, s70, 1
    v_subrev_u32 v72, s47, v72
    v_smfmac_f32_16x16x64_bf16 v[0:3], v[20:23], v[56:63], v64
    ds_read_b128 v[56:59], v70 offset:34816
    s_waitcnt lgkmcnt(3)
    s_nop 0
    v_smfmac_f32_16x16x64_bf16 v[0:3], v[28:31], v[40:47], v64
    ds_read_b128 v[60:63], v70 offset:35840
    v_cvt_pk_bf16_f32 v12, v12, v13
    v_cvt_pk_bf16_f32 v13, v14, v15
    v_and_or_b32 v12, v12, -2, s69
    v_smfmac_f32_16x16x64_bf16 v[24:27], v[16:19], v[48:55], v64
    buffer_store_dwordx2 v[12:13], v74, s[4:7], s22 offen offset:64 sc1
    s_waitcnt lgkmcnt(2)
    v_smfmac_f32_16x16x64_bf16 v[24:27], v[20:23], v[32:39], v64
    ds_read_b128 v[40:43], v70 offset:16384
    v_cvt_pk_bf16_f32 v0, v0, v1
    v_cvt_pk_bf16_f32 v1, v2, v3
    v_and_or_b32 v0, v0, -2, s69
    s_waitcnt lgkmcnt(1)
    v_smfmac_f32_16x16x64_bf16 v[24:27], v[28:31], v[56:63], v64
    buffer_store_dwordx2 v[0:1], v74, s[4:7], s23 offen offset:0 sc1
    ds_read_b128 v[44:47], v70 offset:17408
    ds_read_b128 v[8:11], v72 offset:12288
    ds_read_b128 v[48:51], v70 offset:18432
    ds_read_b128 v[52:55], v70 offset:19456
    ds_read_b128 v[12:15], v72 offset:13312
    s_cmp_lg_u32 s71, 0
    s_nop 0
    v_cvt_pk_bf16_f32 v24, v24, v25
    v_cvt_pk_bf16_f32 v25, v26, v27
    v_and_or_b32 v24, v24, -2, s69
    buffer_store_dwordx2 v[24:25], v74, s[4:7], s23 offen offset:64 sc1
    s_waitcnt lgkmcnt(3)
    v_smfmac_f32_16x16x64_bf16 v[4:7], v[8:11], v[40:47], v64
    s_waitcnt lgkmcnt(0)
    v_smfmac_f32_16x16x64_bf16 v[4:7], v[12:15], v[48:55], v64
    s_nop 7
    v_cvt_pk_bf16_f32 v4, v4, v5
    v_cvt_pk_bf16_f32 v5, v6, v7
    v_and_or_b32 v4, v4, -2, s69
    buffer_store_dwordx2 v[4:5], v77, s[4:7], s25 offen offset:0 sc1
    s_nop 0
    s_cbranch_scc1 cs_e1
    s_cmp_lg_u32 s37, 0
    s_cbranch_scc1 cs_f0_xt
cs_f0_xtx:
    s_nop 2
    v_mov_b32 v79, v79
    s_nop 2
    v_mov_b32 v79, v79
    s_nop 2
    v_mov_b32 v79, v79
    s_nop 2
    v_mov_b32 v79, v79
    s_nop 2
    v_mov_b32 v79, v79
    s_nop 2
    v_mov_b32 v79, v79
    s_nop 2
    v_mov_b32 v79, v79
    s_nop 2
    v_mov_b32 v79, v79
    s_nop 2
    v_mov_b32 v79, v79
    s_nop 2
    v_mov_b32 v79, v79
    s_nop 2
    v_mov_b32 v79, v79
    s_nop 2
    v_mov_b32 v79, v79
    s_nop 2
    v_mov_b32 v79, v79
    s_nop 2
    v_mov_b32 v79, v79
    s_nop 2
    v_mov_b32 v79, v79
    s_nop 2
    v_mov_b32 v79, v79
    s_nop 2
    v_mov_b32 v79, v79
    s_nop 2
    v_mov_b32 v79, v79
    s_nop 2
    v_mov_b32 v79, v79
    s_nop 2
    v_mov_b32 v79, v79
    s_nop 2
    v_mov_b32 v79, v79
    s_nop 2
    v_mov_b32 v79, v79
    s_nop 2
    v_mov_b32 v79, v79
    s_nop 2
    v_mov_b32 v79, v79
    s_nop 2
    v_mov_b32 v79, v79
    s_nop 2
    v_mov_b32 v79, v79
    s_nop 2
    v_mov_b32 v79, v79
    s_nop 2
    v_mov_b32 v79, v79
    s_nop 2
    v_mov_b32 v79, v79
    s_nop 2
    v_mov_b32 v79, v79
    s_nop 2
    v_mov_b32 v79, v79
    s_nop 2
    v_mov_b32 v79, v79
    s_nop 2
    v_mov_b32 v79, v79
    s_nop 2
    v_mov_b32 v79, v79
    s_nop 2
    v_mov_b32 v79, v79
    s_nop 2
    v_mov_b32 v79, v79
    s_nop 0
    v_mov_b32 v79, v79
    buffer_load_dwordx4 v[8:11], v65, s[4:7], s18 offen sc1
    buffer_load_dwordx4 v[12:15], v65, s[4:7], s19 offen sc1
    buffer_load_dwordx4 v[16:19], v65, s[4:7], s20 offen sc1
    buffer_load_dwordx4 v[20:23], v65, s[4:7], s21 offen sc1
    v_and_b32 v77, 255, v69
    ds_read_b128 v[4:7], v77 offset:15872
    ds_read_b128 v[44:47], v70 offset:0
    ds_read_b128 v[48:51], v70 offset:1024
    ds_read_b128 v[52:55], v70 offset:2048
    ds_read_b128 v[56:59], v70 offset:3072
    ds_read_b128 v[24:27], v70 offset:4096
    ds_read_b128 v[28:31], v70 offset:5120
    ds_read_b128 v[32:35], v70 offset:6144
    ds_read_b128 v[36:39], v70 offset:7168
    s_mov_b32 s31, 65536
    s_add_u32 s24, s24, 524288
    s_add_u32 s26, s26, 524288
    s_add_u32 s55, s55, s57
    s_mov_b32 s14, 67633152
    s_mov_b32 s15, 67637248
    s_mov_b32 s16, 67641344
    s_mov_b32 s36, 1
    v_mov_b32 v40, s69
    v_mov_b32 v60, s69
    v_mov_b32 v79, 1
    s_waitcnt lgkmcnt(0)
    s_waitcnt vmcnt(3)
    v_bitop3_b32 v77, v8, v10, s69 bitop3:0x7e
    v_mfma_f32_16x16x32_bf16 v[0:3], v[4:7], v[8:11], 0
    v_mov_b64 v[8:9], 0
    v_mov_b64 v[10:11], 0
    s_waitcnt vmcnt(2)
    v_bitop3_b32 v78, v12, v14, s69 bitop3:0x7e
    v_mfma_f32_16x16x32_bf16 v[0:3], v[4:7], v[12:15], v[0:3]
    v_or_b32 v77, v77, v78
    v_mov_b64 v[12:13], 0
    v_mov_b64 v[14:15], 0
    s_waitcnt vmcnt(1)
    v_bitop3_b32 v78, v16, v18, s69 bitop3:0x7e
    v_mfma_f32_16x16x32_bf16 v[0:3], v[4:7], v[16:19], v[0:3]
    v_or_b32 v77, v77, v78
    v_mov_b64 v[16:17], 0
    v_mov_b64 v[18:19], 0
    s_waitcnt vmcnt(0)
    v_bitop3_b32 v78, v20, v22, s69 bitop3:0x7e
    v_mfma_f32_16x16x32_bf16 v[0:3], v[4:7], v[20:23], v[0:3]
    v_bitop3_b32 v77, v77, v78, 1 bitop3:0xa8
    v_cmp_ne_u32 vcc, 0, v77
    v_mov_b64 v[20:21], 0
    v_mov_b64 v[22:23], 0
    s_cmp_eq_u64 vcc, 0
    s_cselect_b64 s[42:43], -1, 0
    s_nop 1
    v_add_f32_dpp v0, v0, v0 row_ror:8 row_mask:0xf bank_mask:0xf
    v_add_f32_dpp v1, v1, v1 row_ror:8 row_mask:0xf bank_mask:0xf
    s_mov_b64 exec, s[42:43]
    v_cvt_pk_bf16_f32 v72, v0, v1
    v_bfi_b32 v72, v79, s70, v72
    buffer_store_dword v72, v75, s[4:7], s17 offen offset:0 sc1
    s_mov_b64 exec, -1
    s_cbranch_scc0 cs_f0_retry
cs_f0_go:
    v_mov_b64 v[0:1], 0
    v_mov_b64 v[2:3], 0
    v_mov_b64 v[4:5], 0
    v_mov_b64 v[6:7], 0
    s_nop 2
    v_mov_b32 v79, v79
    s_nop 2
    v_mov_b32 v79, v79
    s_nop 2
    v_mov_b32 v79, v79
    s_nop 2
    v_mov_b32 v79, v79
    s_nop 2
    v_mov_b32 v79, v79
    s_nop 2
    v_mov_b32 v79, v79
    s_nop 2
    v_mov_b32 v79, v79
    s_nop 2
    v_mov_b32 v79, v79
    s_nop 2
    v_mov_b32 v79, v79
    s_nop 2
    v_mov_b32 v79, v79
    s_nop 2
    v_mov_b32 v79, v79
    s_nop 2
    v_mov_b32 v79, v79
    s_nop 2
    v_mov_b32 v79, v79
    s_nop 2
    v_mov_b32 v79, v79
    s_nop 2
    v_mov_b32 v79, v79
    s_nop 2
    v_mov_b32 v79, v79
    s_nop 2
    v_mov_b32 v79, v79
    s_nop 2
    v_mov_b32 v79, v79
    s_nop 2
    v_mov_b32 v79, v79
    s_nop 2
    v_mov_b32 v79, v79
    s_nop 2
    v_mov_b32 v79, v79
    s_nop 2
    v_mov_b32 v79, v79
    s_nop 2
    v_mov_b32 v79, v79
    s_nop 2
    v_mov_b32 v79, v79
    s_nop 2
    v_mov_b32 v79, v79
    s_branch cs_loop
cs_e1:
    s_cmp_lg_u32 s71, 2
    s_cbranch_scc1 cs_f1
    v_and_b32 v77, 255, v69
    ds_read_b128 v[4:7], v77 offset:15872
    ds_read_b128 v[44:47], v70 offset:0
    ds_read_b128 v[48:51], v70 offset:1024
    ds_read_b128 v[52:55], v70 offset:2048
    ds_read_b128 v[56:59], v70 offset:3072
    ds_read_b128 v[24:27], v70 offset:4096
    ds_read_b128 v[28:31], v70 offset:5120
    ds_read_b128 v[32:35], v70 offset:6144
    ds_read_b128 v[36:39], v70 offset:7168
    s_mov_b32 s31, 65536
    s_add_u32 s24, s24, 524288
    s_add_u32 s26, s26, 524288
    s_add_u32 s55, s55, s57
    s_mov_b32 s14, 67633152
    s_mov_b32 s15, 67637248
    s_mov_b32 s16, 67641344
    s_mov_b32 s36, 1
    v_mov_b32 v40, s69
    v_mov_b32 v60, s69
    v_mov_b32 v79, 1
    s_cmp_lg_u32 s37, 0
    s_cbranch_scc1 cs_f2_xt
cs_f2_xtx:
    s_nop 2
    v_mov_b32 v79, v79
    s_nop 2
    v_mov_b32 v79, v79
    s_nop 2
    v_mov_b32 v79, v79
    s_nop 2
    v_mov_b32 v79, v79
    s_nop 2
    v_mov_b32 v79, v79
    s_nop 2
    v_mov_b32 v79, v79
    s_nop 2
    v_mov_b32 v79, v79
    s_nop 2
    v_mov_b32 v79, v79
    s_nop 2
    v_mov_b32 v79, v79
    s_nop 2
    v_mov_b32 v79, v79
    s_nop 2
    v_mov_b32 v79, v79
    s_nop 2
    v_mov_b32 v79, v79
    s_nop 2
    v_mov_b32 v79, v79
    s_nop 2
    v_mov_b32 v79, v79
    s_nop 2
    v_mov_b32 v79, v79
    s_nop 2
    v_mov_b32 v79, v79
    s_nop 2
    v_mov_b32 v79, v79
    s_nop 2
    v_mov_b32 v79, v79
    s_nop 2
    v_mov_b32 v79, v79
    s_nop 2
    v_mov_b32 v79, v79
    s_nop 2
    v_mov_b32 v79, v79
    s_nop 2
    v_mov_b32 v79, v79
    s_nop 2
    v_mov_b32 v79, v79
    s_nop 2
    v_mov_b32 v79, v79
    s_nop 2
    v_mov_b32 v79, v79
    s_nop 2
    v_mov_b32 v79, v79
    s_nop 2
    v_mov_b32 v79, v79
    s_nop 2
    v_mov_b32 v79, v79
    s_nop 2
    v_mov_b32 v79, v79
    s_nop 2
    v_mov_b32 v79, v79
    s_nop 2
    v_mov_b32 v79, v79
    s_nop 2
    v_mov_b32 v79, v79
    s_nop 2
    v_mov_b32 v79, v79
    s_nop 2
    v_mov_b32 v79, v79
    s_nop 2
    v_mov_b32 v79, v79
    s_nop 2
    v_mov_b32 v79, v79
    s_nop 0
    v_mov_b32 v79, v79
    s_waitcnt vmcnt(0)
    buffer_load_dwordx4 v[8:11], v65, s[4:7], s18 offen sc1
    buffer_load_dwordx4 v[12:15], v65, s[4:7], s19 offen sc1
    buffer_load_dwordx4 v[16:19], v65, s[4:7], s20 offen sc1
    buffer_load_dwordx4 v[20:23], v65, s[4:7], s21 offen sc1
    s_nop 2
    v_mov_b32 v79, v79
    s_nop 2
    v_mov_b32 v79, v79
    s_nop 2
    v_mov_b32 v79, v79
    s_nop 2
    v_mov_b32 v79, v79
    s_nop 2
    v_mov_b32 v79, v79
    s_nop 2
    v_mov_b32 v79, v79
    s_nop 2
    v_mov_b32 v79, v79
    s_nop 2
    v_mov_b32 v79, v79
    s_nop 2
    v_mov_b32 v79, v79
    s_nop 2
    v_mov_b32 v79, v79
    buffer_load_dwordx4 v[40:43], v65, s[4:7], s14 offen offset:0 sc1
    buffer_load_dwordx4 v[60:63], v66, s[4:7], s14 offen offset:0 sc1
    s_waitcnt lgkmcnt(0)
    s_waitcnt vmcnt(5)
    v_bitop3_b32 v77, v8, v10, s69 bitop3:0x7e
    v_mfma_f32_16x16x32_bf16 v[0:3], v[4:7], v[8:11], 0
    v_mov_b64 v[8:9], 0
    v_mov_b64 v[10:11], 0
    s_waitcnt vmcnt(4)
    v_bitop3_b32 v78, v12, v14, s69 bitop3:0x7e
    v_mfma_f32_16x16x32_bf16 v[0:3], v[4:7], v[12:15], v[0:3]
    v_or_b32 v77, v77, v78
    v_mov_b64 v[12:13], 0
    v_mov_b64 v[14:15], 0
    s_waitcnt vmcnt(3)
    v_bitop3_b32 v78, v16, v18, s69 bitop3:0x7e
    v_mfma_f32_16x16x32_bf16 v[0:3], v[4:7], v[16:19], v[0:3]
    v_or_b32 v77, v77, v78
    v_mov_b64 v[16:17], 0
    v_mov_b64 v[18:19], 0
    s_waitcnt vmcnt(2)
    v_bitop3_b32 v78, v20, v22, s69 bitop3:0x7e
    v_mfma_f32_16x16x32_bf16 v[0:3], v[4:7], v[20:23], v[0:3]
    v_bitop3_b32 v77, v77, v78, 1 bitop3:0xa8
    v_cmp_ne_u32 vcc, 0, v77
    v_mov_b64 v[20:21], 0
    v_mov_b64 v[22:23], 0
    buffer_load_dwordx4 v[40:43], v65, s[4:7], s14 offen offset:0 sc1
    buffer_load_dwordx4 v[60:63], v66, s[4:7], s14 offen offset:0 sc1
    s_cmp_eq_u64 vcc, 0
    s_cselect_b64 s[42:43], -1, 0
    v_add_f32_dpp v0, v0, v0 row_ror:4 row_mask:0xf bank_mask:0xf
    v_add_f32_dpp v1, v1, v1 row_ror:4 row_mask:0xf bank_mask:0xf
    s_nop 0
    v_add_f32_dpp v0, v0, v0 row_ror:8 row_mask:0xf bank_mask:0xf
    v_add_f32_dpp v1, v1, v1 row_ror:8 row_mask:0xf bank_mask:0xf
    s_mov_b64 exec, s[42:43]
    v_cvt_pk_bf16_f32 v72, v0, v1
    v_bfi_b32 v72, v79, s70, v72
    buffer_store_dword v72, v75, s[4:7], s17 offen offset:0 sc1
    buffer_store_dword v72, v75, s[4:7], s17 offen offset:1024 sc1
    buffer_store_dword v72, v75, s[4:7], s17 offen offset:2048 sc1
    buffer_store_dword v72, v75, s[4:7], s17 offen offset:3072 sc1
    s_mov_b64 exec, -1
    s_cbranch_scc0 cs_f2_retry
cs_f2_go:
    v_mov_b64 v[0:1], 0
    v_mov_b64 v[2:3], 0
    v_mov_b64 v[4:5], 0
    v_mov_b64 v[6:7], 0
    s_nop 2
    v_mov_b32 v79, v79
    s_nop 2
    v_mov_b32 v79, v79
    s_nop 2
    v_mov_b32 v79, v79
    s_nop 2
    v_mov_b32 v79, v79
    s_nop 2
    v_mov_b32 v79, v79
    s_nop 2
    v_mov_b32 v79, v79
    s_nop 2
    v_mov_b32 v79, v79
    s_nop 2
    v_mov_b32 v79, v79
    s_nop 2
    v_mov_b32 v79, v79
    s_nop 2
    v_mov_b32 v79, v79
    s_nop 2
    v_mov_b32 v79, v79
    s_nop 2
    v_mov_b32 v79, v79
    s_nop 2
    v_mov_b32 v79, v79
    s_nop 2
    v_mov_b32 v79, v79
    s_nop 2
    v_mov_b32 v79, v79
    s_nop 2
    v_mov_b32 v79, v79
    s_nop 2
    v_mov_b32 v79, v79
    s_nop 2
    v_mov_b32 v79, v79
    s_nop 2
    v_mov_b32 v79, v79
    s_nop 2
    v_mov_b32 v79, v79
    s_nop 2
    v_mov_b32 v79, v79
    s_nop 2
    v_mov_b32 v79, v79
    s_nop 2
    v_mov_b32 v79, v79
    s_nop 2
    v_mov_b32 v79, v79
    s_nop 2
    v_mov_b32 v79, v79
    s_branch cs_loop
cs_f1:
    s_cmp_lg_u32 s32, 1
    s_cbranch_scc1 cs_f3
    v_and_b32 v77, 255, v69
    ds_read_b128 v[4:7], v77 offset:15872
    ds_read_b128 v[44:47], v70 offset:0
    ds_read_b128 v[48:51], v70 offset:1024
    ds_read_b128 v[52:55], v70 offset:2048
    ds_read_b128 v[56:59], v70 offset:3072
    ds_read_b128 v[24:27], v70 offset:4096
    ds_read_b128 v[28:31], v70 offset:5120
    ds_read_b128 v[32:35], v70 offset:6144
    ds_read_b128 v[36:39], v70 offset:7168
    s_mov_b32 s31, 65536
    s_add_u32 s24, s24, 524288
    s_add_u32 s26, s26, 524288
    s_add_u32 s55, s55, s57
    s_mov_b32 s14, 67633152
    s_mov_b32 s15, 67637248
    s_mov_b32 s16, 67641344
    s_mov_b32 s36, 1
    v_mov_b32 v40, s69
    v_mov_b32 v60, s69
    v_mov_b32 v79, 1
    s_cmp_lg_u32 s37, 0
    s_cbranch_scc1 cs_f1_xt
cs_f1_xtx:
    s_nop 2
    v_mov_b32 v79, v79
    s_nop 2
    v_mov_b32 v79, v79
    s_nop 2
    v_mov_b32 v79, v79
    s_nop 2
    v_mov_b32 v79, v79
    s_nop 2
    v_mov_b32 v79, v79
    s_nop 2
    v_mov_b32 v79, v79
    s_nop 2
    v_mov_b32 v79, v79
    s_nop 2
    v_mov_b32 v79, v79
    s_nop 2
    v_mov_b32 v79, v79
    s_nop 2
    v_mov_b32 v79, v79
    s_nop 2
    v_mov_b32 v79, v79
    s_nop 2
    v_mov_b32 v79, v79
    s_nop 2
    v_mov_b32 v79, v79
    s_nop 2
    v_mov_b32 v79, v79
    s_nop 2
    v_mov_b32 v79, v79
    s_nop 2
    v_mov_b32 v79, v79
    s_nop 2
    v_mov_b32 v79, v79
    s_nop 2
    v_mov_b32 v79, v79
    s_nop 2
    v_mov_b32 v79, v79
    s_nop 2
    v_mov_b32 v79, v79
    s_nop 2
    v_mov_b32 v79, v79
    s_nop 2
    v_mov_b32 v79, v79
    s_nop 2
    v_mov_b32 v79, v79
    s_nop 2
    v_mov_b32 v79, v79
    s_nop 2
    v_mov_b32 v79, v79
    s_nop 2
    v_mov_b32 v79, v79
    s_nop 2
    v_mov_b32 v79, v79
    s_nop 2
    v_mov_b32 v79, v79
    s_nop 2
    v_mov_b32 v79, v79
    s_nop 2
    v_mov_b32 v79, v79
    s_nop 2
    v_mov_b32 v79, v79
    s_nop 2
    v_mov_b32 v79, v79
    s_nop 2
    v_mov_b32 v79, v79
    s_nop 2
    v_mov_b32 v79, v79
    s_nop 2
    v_mov_b32 v79, v79
    s_nop 2
    v_mov_b32 v79, v79
    s_nop 0
    v_mov_b32 v79, v79
    s_waitcnt vmcnt(0)
    buffer_load_dwordx4 v[8:11], v65, s[4:7], s18 offen sc1
    buffer_load_dwordx4 v[12:15], v65, s[4:7], s19 offen sc1
    buffer_load_dwordx4 v[16:19], v65, s[4:7], s20 offen sc1
    buffer_load_dwordx4 v[20:23], v65, s[4:7], s21 offen sc1
    s_nop 2
    v_mov_b32 v79, v79
    s_nop 2
    v_mov_b32 v79, v79
    s_nop 2
    v_mov_b32 v79, v79
    s_nop 2
    v_mov_b32 v79, v79
    s_nop 2
    v_mov_b32 v79, v79
    s_nop 2
    v_mov_b32 v79, v79
    s_nop 2
    v_mov_b32 v79, v79
    s_nop 2
    v_mov_b32 v79, v79
    s_nop 2
    v_mov_b32 v79, v79
    s_nop 2
    v_mov_b32 v79, v79
    buffer_load_dwordx4 v[40:43], v65, s[4:7], s14 offen offset:0 sc1
    buffer_load_dwordx4 v[60:63], v66, s[4:7], s14 offen offset:0 sc1
    s_waitcnt lgkmcnt(0)
    s_waitcnt vmcnt(5)
    v_bitop3_b32 v77, v8, v10, s69 bitop3:0x7e
    v_mfma_f32_16x16x32_bf16 v[0:3], v[4:7], v[8:11], 0
    v_mov_b64 v[8:9], 0
    v_mov_b64 v[10:11], 0
    s_waitcnt vmcnt(4)
    v_bitop3_b32 v78, v12, v14, s69 bitop3:0x7e
    v_mfma_f32_16x16x32_bf16 v[0:3], v[4:7], v[12:15], v[0:3]
    v_or_b32 v77, v77, v78
    v_mov_b64 v[12:13], 0
    v_mov_b64 v[14:15], 0
    s_waitcnt vmcnt(3)
    v_bitop3_b32 v78, v16, v18, s69 bitop3:0x7e
    v_mfma_f32_16x16x32_bf16 v[0:3], v[4:7], v[16:19], v[0:3]
    v_or_b32 v77, v77, v78
    v_mov_b64 v[16:17], 0
    v_mov_b64 v[18:19], 0
    s_waitcnt vmcnt(2)
    v_bitop3_b32 v78, v20, v22, s69 bitop3:0x7e
    v_mfma_f32_16x16x32_bf16 v[0:3], v[4:7], v[20:23], v[0:3]
    v_bitop3_b32 v77, v77, v78, 1 bitop3:0xa8
    v_cmp_ne_u32 vcc, 0, v77
    v_mov_b64 v[20:21], 0
    v_mov_b64 v[22:23], 0
    buffer_load_dwordx4 v[40:43], v65, s[4:7], s14 offen offset:0 sc1
    buffer_load_dwordx4 v[60:63], v66, s[4:7], s14 offen offset:0 sc1
    s_cmp_eq_u64 vcc, 0
    s_cselect_b64 s[42:43], -1, 0
    v_add_f32_dpp v0, v0, v0 row_ror:8 row_mask:0xf bank_mask:0xf
    v_add_f32_dpp v1, v1, v1 row_ror:8 row_mask:0xf bank_mask:0xf
    s_mov_b64 exec, s[42:43]
    v_cvt_pk_bf16_f32 v72, v0, v1
    v_bfi_b32 v72, v79, s70, v72
    buffer_store_dword v72, v75, s[4:7], s17 offen offset:0 sc1
    s_mov_b64 exec, -1
    s_cbranch_scc0 cs_f1_retry
cs_f1_go:
    v_mov_b64 v[0:1], 0
    v_mov_b64 v[2:3], 0
    v_mov_b64 v[4:5], 0
    v_mov_b64 v[6:7], 0
    s_nop 2
    v_mov_b32 v79, v79
    s_nop 2
    v_mov_b32 v79, v79
    s_nop 2
    v_mov_b32 v79, v79
    s_nop 2
    v_mov_b32 v79, v79
    s_nop 2
    v_mov_b32 v79, v79
    s_nop 2
    v_mov_b32 v79, v79
    s_nop 2
    v_mov_b32 v79, v79
    s_nop 2
    v_mov_b32 v79, v79
    s_nop 2
    v_mov_b32 v79, v79
    s_nop 2
    v_mov_b32 v79, v79
    s_nop 2
    v_mov_b32 v79, v79
    s_nop 2
    v_mov_b32 v79, v79
    s_nop 2
    v_mov_b32 v79, v79
    s_nop 2
    v_mov_b32 v79, v79
    s_nop 2
    v_mov_b32 v79, v79
    s_nop 2
    v_mov_b32 v79, v79
    s_nop 2
    v_mov_b32 v79, v79
    s_nop 2
    v_mov_b32 v79, v79
    s_nop 2
    v_mov_b32 v79, v79
    s_nop 2
    v_mov_b32 v79, v79
    s_nop 2
    v_mov_b32 v79, v79
    s_nop 2
    v_mov_b32 v79, v79
    s_nop 2
    v_mov_b32 v79, v79
    s_nop 2
    v_mov_b32 v79, v79
    s_nop 2
    v_mov_b32 v79, v79
    s_branch cs_loop
cs_f3:
    v_and_b32 v77, 255, v69
    ds_read_b128 v[4:7], v77 offset:15872
    ds_read_b128 v[44:47], v70 offset:0
    ds_read_b128 v[48:51], v70 offset:1024
    ds_read_b128 v[52:55], v70 offset:2048
    ds_read_b128 v[56:59], v70 offset:3072
    ds_read_b128 v[24:27], v70 offset:4096
    ds_read_b128 v[28:31], v70 offset:5120
    ds_read_b128 v[32:35], v70 offset:6144
    ds_read_b128 v[36:39], v70 offset:7168
    s_mov_b32 s31, 65536
    s_add_u32 s24, s24, 524288
    s_add_u32 s26, s26, 524288
    s_add_u32 s55, s55, s57
    s_mov_b32 s14, 67633152
    s_mov_b32 s15, 67637248
    s_mov_b32 s16, 67641344
    s_mov_b32 s36, 1
    v_mov_b32 v40, s69
    v_mov_b32 v60, s69
    v_mov_b32 v79, 1
    s_add_u32 s40, s30, s95
    v_mov_b32 v72, s40
    s_waitcnt lgkmcnt(0)
    v_mov_b64 v[0:1], 0
    v_mov_b64 v[2:3], 0
    v_mov_b64 v[4:5], 0
    v_mov_b64 v[6:7], 0
    v_mov_b64 v[8:9], 0
    v_mov_b64 v[10:11], 0
    v_mov_b64 v[12:13], 0
    v_mov_b64 v[14:15], 0
    v_mov_b64 v[16:17], 0
    v_mov_b64 v[18:19], 0
    v_mov_b64 v[20:21], 0
    v_mov_b64 v[22:23], 0
    s_nop 2
    v_mov_b32 v79, v79
    s_nop 2
    v_mov_b32 v79, v79
    s_nop 2
    v_mov_b32 v79, v79
    s_nop 2
    v_mov_b32 v79, v79
    s_nop 2
    v_mov_b32 v79, v79
    s_nop 2
    v_mov_b32 v79, v79
    s_nop 2
    v_mov_b32 v79, v79
    s_nop 2
    v_mov_b32 v79, v79
    s_nop 2
    v_mov_b32 v79, v79
    s_nop 2
    v_mov_b32 v79, v79
    s_nop 2
    v_mov_b32 v79, v79
    s_nop 2
    v_mov_b32 v79, v79
    s_nop 2
    v_mov_b32 v79, v79
    s_nop 2
    v_mov_b32 v79, v79
    s_nop 2
    v_mov_b32 v79, v79
    s_nop 2
    v_mov_b32 v79, v79
    s_nop 2
    v_mov_b32 v79, v79
    s_nop 2
    v_mov_b32 v79, v79
    s_nop 2
    v_mov_b32 v79, v79
    s_nop 2
    v_mov_b32 v79, v79
    s_nop 2
    v_mov_b32 v79, v79
    s_nop 2
    v_mov_b32 v79, v79
    s_nop 2
    v_mov_b32 v79, v79
    s_nop 2
    v_mov_b32 v79, v79
    s_nop 2
    v_mov_b32 v79, v79
    s_nop 2
    v_mov_b32 v79, v79
    s_nop 2
    v_mov_b32 v79, v79
    s_nop 2
    v_mov_b32 v79, v79
    s_nop 2
    v_mov_b32 v79, v79
    s_nop 2
    v_mov_b32 v79, v79
    s_nop 2
    v_mov_b32 v79, v79
    s_nop 2
    v_mov_b32 v79, v79
    s_nop 2
    v_mov_b32 v79, v79
    s_nop 2
    v_mov_b32 v79, v79
    s_nop 2
    v_mov_b32 v79, v79
    s_nop 2
    v_mov_b32 v79, v79
    s_nop 2
    v_mov_b32 v79, v79
    s_nop 2
    v_mov_b32 v79, v79
    s_nop 2
    v_mov_b32 v79, v79
    s_nop 2
    v_mov_b32 v79, v79
    s_nop 2
    v_mov_b32 v79, v79
    s_nop 2
    v_mov_b32 v79, v79
    s_nop 2
    v_mov_b32 v79, v79
    s_nop 2
    v_mov_b32 v79, v79
    s_nop 2
    v_mov_b32 v79, v79
    s_nop 2
    v_mov_b32 v79, v79
    s_nop 2
    v_mov_b32 v79, v79
    s_nop 2
    v_mov_b32 v79, v79
    s_nop 2
    v_mov_b32 v79, v79
    s_nop 2
    v_mov_b32 v79, v79
    s_nop 2
    v_mov_b32 v79, v79
    s_nop 2
    v_mov_b32 v79, v79
    s_nop 2
    v_mov_b32 v79, v79
    s_nop 2
    v_mov_b32 v79, v79
    s_nop 2
    v_mov_b32 v79, v79
    s_nop 2
    v_mov_b32 v79, v79
    s_nop 2
    v_mov_b32 v79, v79
    s_nop 2
    v_mov_b32 v79, v79
    s_nop 2
    v_mov_b32 v79, v79
    s_nop 2
    v_mov_b32 v79, v79
    s_nop 2
    v_mov_b32 v79, v79
    s_nop 2
    v_mov_b32 v79, v79
    s_nop 2
    v_mov_b32 v79, v79
    s_nop 2
    v_mov_b32 v79, v79
    s_nop 2
    v_mov_b32 v79, v79
    s_waitcnt vmcnt(0)
    s_cmp_lt_u32 s97, s93
    s_cbranch_scc1 cs_kvwait
    s_nop 2
    v_mov_b32 v79, v79
    s_nop 2
    v_mov_b32 v79, v79
    s_nop 2
    v_mov_b32 v79, v79
    s_nop 2
    v_mov_b32 v79, v79
    s_nop 2
    v_mov_b32 v79, v79
    s_nop 2
    v_mov_b32 v79, v79
    s_nop 2
    v_mov_b32 v79, v79
    s_nop 2
    v_mov_b32 v79, v79
cs_kvok:
    s_branch cs_loop
cs_f0_xt:
    s_sub_u32 s37, s37, 1
    s_nop 2
    v_mov_b32 v79, v79
    s_nop 2
    v_mov_b32 v79, v79
    s_nop 2
    v_mov_b32 v79, v79
    s_nop 2
    v_mov_b32 v79, v79
    s_nop 2
    v_mov_b32 v79, v79
    s_nop 2
    v_mov_b32 v79, v79
    s_branch cs_f0_xtx
cs_f0_retry:
    s_sub_u32 s41, s30, s98
    s_mov_b32 s98, s30
    s_cmp_le_u32 s41, 3
    s_cselect_b32 s37, 1, 1
cs_f0_spin:
    buffer_load_dwordx4 v[8:11], v65, s[4:7], s18 offen sc1
    buffer_load_dwordx4 v[12:15], v65, s[4:7], s19 offen sc1
    buffer_load_dwordx4 v[16:19], v65, s[4:7], s20 offen sc1
    buffer_load_dwordx4 v[20:23], v65, s[4:7], s21 offen sc1
    s_nop 2
    v_mov_b32 v79, v79
    s_nop 2
    v_mov_b32 v79, v79
    s_nop 2
    v_mov_b32 v79, v79
    buffer_load_dwordx4 v[40:43], v65, s[4:7], s14 offen offset:0 sc1
    buffer_load_dwordx4 v[60:63], v66, s[4:7], s14 offen offset:0 sc1
    s_waitcnt vmcnt(5)
    v_bitop3_b32 v77, v8, v10, s69 bitop3:0x7e
    v_mfma_f32_16x16x32_bf16 v[0:3], v[4:7], v[8:11], 0
    v_mov_b64 v[8:9], 0
    v_mov_b64 v[10:11], 0
    s_waitcnt vmcnt(4)
    v_bitop3_b32 v78, v12, v14, s69 bitop3:0x7e
    v_mfma_f32_16x16x32_bf16 v[0:3], v[4:7], v[12:15], v[0:3]
    v_or_b32 v77, v77, v78
    v_mov_b64 v[12:13], 0
    v_mov_b64 v[14:15], 0
    s_waitcnt vmcnt(3)
    v_bitop3_b32 v78, v16, v18, s69 bitop3:0x7e
    v_mfma_f32_16x16x32_bf16 v[0:3], v[4:7], v[16:19], v[0:3]
    v_or_b32 v77, v77, v78
    v_mov_b64 v[16:17], 0
    v_mov_b64 v[18:19], 0
    s_waitcnt vmcnt(2)
    v_bitop3_b32 v78, v20, v22, s69 bitop3:0x7e
    v_mfma_f32_16x16x32_bf16 v[0:3], v[4:7], v[20:23], v[0:3]
    v_bitop3_b32 v77, v77, v78, 1 bitop3:0xa8
    v_cmp_ne_u32 vcc, 0, v77
    v_mov_b64 v[20:21], 0
    v_mov_b64 v[22:23], 0
    buffer_load_dwordx4 v[40:43], v65, s[4:7], s14 offen offset:0 sc1
    buffer_load_dwordx4 v[60:63], v66, s[4:7], s14 offen offset:0 sc1
    s_cmp_eq_u64 vcc, 0
    s_cselect_b64 s[42:43], -1, 0
    v_add_f32_dpp v0, v0, v0 row_ror:8 row_mask:0xf bank_mask:0xf
    v_add_f32_dpp v1, v1, v1 row_ror:8 row_mask:0xf bank_mask:0xf
    s_mov_b64 exec, s[42:43]
    v_cvt_pk_bf16_f32 v72, v0, v1
    v_bfi_b32 v72, v79, s70, v72
    buffer_store_dword v72, v75, s[4:7], s17 offen offset:0 sc1
    s_mov_b64 exec, -1
    s_cbranch_scc1 cs_f0_rx
    s_sub_u32 s31, s31, 1
    s_cbranch_scc0 cs_f0_spin
cs_f0_rx:
    v_mov_b64 v[0:1], 0
    v_mov_b64 v[2:3], 0
    v_mov_b64 v[4:5], 0
    v_mov_b64 v[6:7], 0
    s_branch cs_loop
cs_f1_xt:
    s_sub_u32 s37, s37, 1
    s_nop 2
    v_mov_b32 v79, v79
    s_nop 2
    v_mov_b32 v79, v79
    s_nop 2
    v_mov_b32 v79, v79
    s_nop 2
    v_mov_b32 v79, v79
    s_nop 2
    v_mov_b32 v79, v79
    s_nop 2
    v_mov_b32 v79, v79
    s_branch cs_f1_xtx
cs_f1_retry:
    s_sub_u32 s41, s30, s98
    s_mov_b32 s98, s30
    s_cmp_le_u32 s41, 3
    s_cselect_b32 s37, 1, 1
cs_f1_spin:
    buffer_load_dwordx4 v[8:11], v65, s[4:7], s18 offen sc1
    buffer_load_dwordx4 v[12:15], v65, s[4:7], s19 offen sc1
    buffer_load_dwordx4 v[16:19], v65, s[4:7], s20 offen sc1
    buffer_load_dwordx4 v[20:23], v65, s[4:7], s21 offen sc1
    s_nop 2
    v_mov_b32 v79, v79
    s_nop 2
    v_mov_b32 v79, v79
    s_nop 2
    v_mov_b32 v79, v79
    buffer_load_dwordx4 v[40:43], v65, s[4:7], s14 offen offset:0 sc1
    buffer_load_dwordx4 v[60:63], v66, s[4:7], s14 offen offset:0 sc1
    s_waitcnt vmcnt(5)
    v_bitop3_b32 v77, v8, v10, s69 bitop3:0x7e
    v_mfma_f32_16x16x32_bf16 v[0:3], v[4:7], v[8:11], 0
    v_mov_b64 v[8:9], 0
    v_mov_b64 v[10:11], 0
    s_waitcnt vmcnt(4)
    v_bitop3_b32 v78, v12, v14, s69 bitop3:0x7e
    v_mfma_f32_16x16x32_bf16 v[0:3], v[4:7], v[12:15], v[0:3]
    v_or_b32 v77, v77, v78
    v_mov_b64 v[12:13], 0
    v_mov_b64 v[14:15], 0
    s_waitcnt vmcnt(3)
    v_bitop3_b32 v78, v16, v18, s69 bitop3:0x7e
    v_mfma_f32_16x16x32_bf16 v[0:3], v[4:7], v[16:19], v[0:3]
    v_or_b32 v77, v77, v78
    v_mov_b64 v[16:17], 0
    v_mov_b64 v[18:19], 0
    s_waitcnt vmcnt(2)
    v_bitop3_b32 v78, v20, v22, s69 bitop3:0x7e
    v_mfma_f32_16x16x32_bf16 v[0:3], v[4:7], v[20:23], v[0:3]
    v_bitop3_b32 v77, v77, v78, 1 bitop3:0xa8
    v_cmp_ne_u32 vcc, 0, v77
    v_mov_b64 v[20:21], 0
    v_mov_b64 v[22:23], 0
    buffer_load_dwordx4 v[40:43], v65, s[4:7], s14 offen offset:0 sc1
    buffer_load_dwordx4 v[60:63], v66, s[4:7], s14 offen offset:0 sc1
    s_cmp_eq_u64 vcc, 0
    s_cselect_b64 s[42:43], -1, 0
    v_add_f32_dpp v0, v0, v0 row_ror:8 row_mask:0xf bank_mask:0xf
    v_add_f32_dpp v1, v1, v1 row_ror:8 row_mask:0xf bank_mask:0xf
    s_mov_b64 exec, s[42:43]
    v_cvt_pk_bf16_f32 v72, v0, v1
    v_bfi_b32 v72, v79, s70, v72
    buffer_store_dword v72, v75, s[4:7], s17 offen offset:0 sc1
    s_mov_b64 exec, -1
    s_cbranch_scc1 cs_f1_rx
    s_sub_u32 s31, s31, 1
    s_cbranch_scc0 cs_f1_spin
cs_f1_rx:
    v_mov_b64 v[0:1], 0
    v_mov_b64 v[2:3], 0
    v_mov_b64 v[4:5], 0
    v_mov_b64 v[6:7], 0
    s_branch cs_loop
cs_f2_xt:
    s_sub_u32 s37, s37, 1
    s_nop 2
    v_mov_b32 v79, v79
    s_nop 2
    v_mov_b32 v79, v79
    s_nop 2
    v_mov_b32 v79, v79
    s_nop 2
    v_mov_b32 v79, v79
    s_nop 2
    v_mov_b32 v79, v79
    s_nop 2
    v_mov_b32 v79, v79
    s_branch cs_f2_xtx
cs_f2_retry:
    s_sub_u32 s41, s30, s98
    s_mov_b32 s98, s30
    s_cmp_le_u32 s41, 3
    s_cselect_b32 s37, 1, 1
cs_f2_spin:
    buffer_load_dwordx4 v[8:11], v65, s[4:7], s18 offen sc1
    buffer_load_dwordx4 v[12:15], v65, s[4:7], s19 offen sc1
    buffer_load_dwordx4 v[16:19], v65, s[4:7], s20 offen sc1
    buffer_load_dwordx4 v[20:23], v65, s[4:7], s21 offen sc1
    s_nop 2
    v_mov_b32 v79, v79
    s_nop 2
    v_mov_b32 v79, v79
    s_nop 2
    v_mov_b32 v79, v79
    buffer_load_dwordx4 v[40:43], v65, s[4:7], s14 offen offset:0 sc1
    buffer_load_dwordx4 v[60:63], v66, s[4:7], s14 offen offset:0 sc1
    s_waitcnt vmcnt(5)
    v_bitop3_b32 v77, v8, v10, s69 bitop3:0x7e
    v_mfma_f32_16x16x32_bf16 v[0:3], v[4:7], v[8:11], 0
    v_mov_b64 v[8:9], 0
    v_mov_b64 v[10:11], 0
    s_waitcnt vmcnt(4)
    v_bitop3_b32 v78, v12, v14, s69 bitop3:0x7e
    v_mfma_f32_16x16x32_bf16 v[0:3], v[4:7], v[12:15], v[0:3]
    v_or_b32 v77, v77, v78
    v_mov_b64 v[12:13], 0
    v_mov_b64 v[14:15], 0
    s_waitcnt vmcnt(3)
    v_bitop3_b32 v78, v16, v18, s69 bitop3:0x7e
    v_mfma_f32_16x16x32_bf16 v[0:3], v[4:7], v[16:19], v[0:3]
    v_or_b32 v77, v77, v78
    v_mov_b64 v[16:17], 0
    v_mov_b64 v[18:19], 0
    s_waitcnt vmcnt(2)
    v_bitop3_b32 v78, v20, v22, s69 bitop3:0x7e
    v_mfma_f32_16x16x32_bf16 v[0:3], v[4:7], v[20:23], v[0:3]
    v_bitop3_b32 v77, v77, v78, 1 bitop3:0xa8
    v_cmp_ne_u32 vcc, 0, v77
    v_mov_b64 v[20:21], 0
    v_mov_b64 v[22:23], 0
    buffer_load_dwordx4 v[40:43], v65, s[4:7], s14 offen offset:0 sc1
    buffer_load_dwordx4 v[60:63], v66, s[4:7], s14 offen offset:0 sc1
    s_cmp_eq_u64 vcc, 0
    s_cselect_b64 s[42:43], -1, 0
    v_add_f32_dpp v0, v0, v0 row_ror:4 row_mask:0xf bank_mask:0xf
    v_add_f32_dpp v1, v1, v1 row_ror:4 row_mask:0xf bank_mask:0xf
    s_nop 0
    v_add_f32_dpp v0, v0, v0 row_ror:8 row_mask:0xf bank_mask:0xf
    v_add_f32_dpp v1, v1, v1 row_ror:8 row_mask:0xf bank_mask:0xf
    s_mov_b64 exec, s[42:43]
    v_cvt_pk_bf16_f32 v72, v0, v1
    v_bfi_b32 v72, v79, s70, v72
    buffer_store_dword v72, v75, s[4:7], s17 offen offset:0 sc1
    buffer_store_dword v72, v75, s[4:7], s17 offen offset:1024 sc1
    buffer_store_dword v72, v75, s[4:7], s17 offen offset:2048 sc1
    buffer_store_dword v72, v75, s[4:7], s17 offen offset:3072 sc1
    s_mov_b64 exec, -1
    s_cbranch_scc1 cs_f2_rx
    s_sub_u32 s31, s31, 1
    s_cbranch_scc0 cs_f2_spin
cs_f2_rx:
    v_mov_b64 v[0:1], 0
    v_mov_b64 v[2:3], 0
    v_mov_b64 v[4:5], 0
    v_mov_b64 v[6:7], 0
    s_branch cs_loop
cs_spinB:
    s_waitcnt vmcnt(3)
cs_spinB_l:
    v_bitop3_b32 v77, v44, v45, s70 bitop3:0x7e
    v_bitop3_b32 v77, v77, v46, s70 bitop3:0xf6
    v_bitop3_b32 v77, v77, v47, s70 bitop3:0xf6
    v_and_b32 v77, s36, v77
    v_cmp_ne_u32 vcc, 0, v77
    s_cbranch_vccz cs_spinB_x
    buffer_load_dwordx4 v[44:47], v65, s[4:7], s15 offen sc1
    s_sub_u32 s31, s31, 16
    s_waitcnt vmcnt(0)
    s_cbranch_scc0 cs_spinB_l
cs_spinB_x:
    ds_write_b128 v65, v[44:47] offset:4096
    s_waitcnt lgkmcnt(0)
    s_branch cs_backB
cs_spin8:
    buffer_load_dwordx4 v[40:43], v65, s[4:7], s16 offen sc1
cs_spin8_l:
    s_waitcnt vmcnt(0)
    v_bitop3_b32 v77, v40, v41, s70 bitop3:0x7e
    v_bitop3_b32 v77, v77, v42, s70 bitop3:0xf6
    v_bitop3_b32 v77, v77, v43, s70 bitop3:0xf6
    v_and_b32 v77, s36, v77
    v_cmp_ne_u32 vcc, 0, v77
    s_cbranch_vccz cs_spin8_x
    s_nop 15
    s_nop 15
    s_nop 15
    s_nop 11
    buffer_load_dwordx4 v[40:43], v65, s[4:7], s16 offen sc1
    s_sub_u32 s31, s31, 16
    s_cbranch_scc0 cs_spin8_l
cs_spin8_x:
    s_branch cs_back8
cs_rare:
    s_mov_b64 exec, s[34:35]
    buffer_store_dwordx4 v[0:3], v65, s[4:7], s28 offen sc1
    s_mov_b64 exec, -1
    s_nop 3
    v_cvt_pk_bf16_f32 v52, v16, v17
    v_cvt_pk_bf16_f32 v53, v18, v19
    v_cvt_pk_bf16_f32 v54, v20, v21
    v_cvt_pk_bf16_f32 v55, v22, v23
    buffer_store_dwordx4 v[52:55], v65, s[4:7], s27 offen sc1
    s_add_u32 s28, s28, 131072
    s_add_u32 s27, s27, 131072
    s_cmp_eq_u32 s30, 63
    s_cbranch_scc1 cs_last
    s_branch cs_rare_x
cs_kvwait:
    s_mov_b32 s41, s97
    v_bfe_u32 v78, v65, 2, 5
    v_mov_b32 v77, v76
    s_nop 1
    v_permlane32_swap_b32 v76, v77
    v_subrev_u32 v77, s95, v77
    v_cmp_lt_u32 vcc, 16, v77
    s_nop 1
    v_cndmask_b32 v77, v77, 0, vcc
    v_bfe_u32 v79, v78, 2, 2
    v_lshl_add_u32 v77, v77, 2, v79
    s_nop 1
    v_min_u32_dpp v77, v77, v77 row_ror:1 row_mask:0xf bank_mask:0xf
    s_nop 1
    v_min_u32_dpp v77, v77, v77 row_ror:2 row_mask:0xf bank_mask:0xf
    s_nop 1
    v_min_u32_dpp v77, v77, v77 row_ror:4 row_mask:0xf bank_mask:0xf
    s_nop 0
    v_readfirstlane_b32 s97, v77
    s_nop 0
    s_max_u32 s97, s97, s41
    s_add_u32 s40, s30, 3
    s_min_u32 s40, s40, 64
    s_cmp_le_u32 s40, s97
    s_cbranch_scc1 cs_kvw_x
    v_bfe_u32 v78, v65, 2, 5
    s_mov_b32 s31, 4194304
cs_kvw:
    buffer_load_dword v77, v78, s[4:7], s96 offen offset:16 sc1
    s_waitcnt vmcnt(0)
    v_subrev_u32 v77, s95, v77
    v_cmp_lt_u32 vcc, 16, v77
    s_nop 1
    v_cndmask_b32 v77, v77, 0, vcc
    v_bfe_u32 v79, v78, 2, 2
    v_lshl_add_u32 v77, v77, 2, v79
    s_nop 1
    v_min_u32_dpp v77, v77, v77 row_ror:1 row_mask:0xf bank_mask:0xf
    s_nop 1
    v_min_u32_dpp v77, v77, v77 row_ror:2 row_mask:0xf bank_mask:0xf
    s_nop 1
    v_min_u32_dpp v77, v77, v77 row_ror:4 row_mask:0xf bank_mask:0xf
    s_nop 0
    v_readfirstlane_b32 s97, v77
    s_sub_u32 s31, s31, 1
    s_cbranch_scc1 cs_kvw_x
    s_cmp_le_u32 s40, s97
    s_cbranch_scc1 cs_kvw_x
    s_sleep 2
    s_branch cs_kvw
cs_kvw_x:
    s_branch cs_kvok
cs_last:
    s_add_u32 s40, s95, 64
    v_mov_b32 v78, s40
    s_waitcnt vmcnt(0)
    s_barrier
    s_mov_b64 exec, s[100:101]
    buffer_store_dword v78, off, s[4:7], s29 sc1
    s_mov_b64 exec, -1
cs_end:
    s_endpgm
L_xform:
    v_and_b32 v1, 63, v0
    v_and_b32 v2, 15, v1
    v_lshrrev_b32 v3, 4, v1
    v_mov_b32 v7, 0x05040100
    v_mov_b32 v8, 0x07060302
    v_lshrrev_b32 v9, 6, v0
    v_lshlrev_b32 v9, 14, v9
    v_lshlrev_b32 v10, 4, v1
    v_add_u32 v11, v9, v10
    s_mov_b32 s10, 4718592
    s_mov_b32 s11, 0x20000
    s_mov_b64 s[8:9], s[58:59]
xf_f:
    s_sub_u32 s17, s16, 1504
    s_and_b32 s18, s17, 127
    s_lshr_b32 s17, s17, 7
    s_lshl_b32 s19, s17, 4
    v_add_u32 v6, s19, v2
    v_mul_u32_u24 v4, 9216, v3
    v_lshl_add_u32 v4, v6, 4, v4
    v_lshrrev_b32 v5, 2, v2
    v_lshlrev_b32 v5, 11, v5
    v_lshl_add_u32 v5, v3, 8, v5
    v_and_b32 v1, 3, v6
    v_lshl_add_u32 v5, v1, 6, v5
    v_add_u32 v5, v5, v9
    v_cmp_gt_u32 vcc, 72, v6
    s_nop 0
    s_mov_b64 exec, vcc
    s_mul_i32 s20, s18, 36864
    s_add_u32 s21, s20, 0
    buffer_load_dwordx4 v[12:15], v4, s[8:11], s21 offen
    s_add_u32 s21, s20, 1152
    buffer_load_dwordx4 v[16:19], v4, s[8:11], s21 offen
    s_add_u32 s21, s20, 2304
    buffer_load_dwordx4 v[20:23], v4, s[8:11], s21 offen
    s_add_u32 s21, s20, 3456
    buffer_load_dwordx4 v[24:27], v4, s[8:11], s21 offen
    s_add_u32 s21, s20, 4608
    buffer_load_dwordx4 v[28:31], v4, s[8:11], s21 offen
    s_add_u32 s21, s20, 5760
    buffer_load_dwordx4 v[32:35], v4, s[8:11], s21 offen
    s_add_u32 s21, s20, 6912
    buffer_load_dwordx4 v[36:39], v4, s[8:11], s21 offen
    s_add_u32 s21, s20, 8064
    buffer_load_dwordx4 v[40:43], v4, s[8:11], s21 offen
    s_lshl_b32 s20, s18, 11
    s_add_u32 s20, s20, 130023424
    s_waitcnt vmcnt(0)
    v_perm_b32 v76, v16, v12, v7
    v_perm_b32 v77, v24, v20, v7
    v_perm_b32 v78, v32, v28, v7
    v_perm_b32 v79, v40, v36, v7
    ds_write_b128 v5, v[76:79] offset:0
    v_perm_b32 v80, v17, v13, v7
    v_perm_b32 v81, v25, v21, v7
    v_perm_b32 v82, v33, v29, v7
    v_perm_b32 v83, v41, v37, v7
    ds_write_b128 v5, v[80:83] offset:16
    v_perm_b32 v84, v18, v14, v7
    v_perm_b32 v85, v26, v22, v7
    v_perm_b32 v86, v34, v30, v7
    v_perm_b32 v87, v42, v38, v7
    ds_write_b128 v5, v[84:87] offset:32
    v_perm_b32 v88, v19, v15, v7
    v_perm_b32 v89, v27, v23, v7
    v_perm_b32 v90, v35, v31, v7
    v_perm_b32 v91, v43, v39, v7
    ds_write_b128 v5, v[88:91] offset:48
    v_perm_b32 v92, v16, v12, v8
    v_perm_b32 v93, v24, v20, v8
    v_perm_b32 v94, v32, v28, v8
    v_perm_b32 v95, v40, v36, v8
    ds_write_b128 v5, v[92:95] offset:1024
    v_perm_b32 v96, v17, v13, v8
    v_perm_b32 v97, v25, v21, v8
    v_perm_b32 v98, v33, v29, v8
    v_perm_b32 v99, v41, v37, v8
    ds_write_b128 v5, v[96:99] offset:1040
    v_perm_b32 v100, v18, v14, v8
    v_perm_b32 v101, v26, v22, v8
    v_perm_b32 v102, v34, v30, v8
    v_perm_b32 v103, v42, v38, v8
    ds_write_b128 v5, v[100:103] offset:1056
    v_perm_b32 v104, v19, v15, v8
    v_perm_b32 v105, v27, v23, v8
    v_perm_b32 v106, v35, v31, v8
    v_perm_b32 v107, v43, v39, v8
    ds_write_b128 v5, v[104:107] offset:1072
    s_mov_b64 exec, -1
    s_lshl_b32 s21, s17, 20
    s_add_u32 s20, s20, s21
    s_waitcnt lgkmcnt(0)
    ds_read_b128 v[76:79], v11 offset:0
    ds_read_b128 v[80:83], v11 offset:1024
    ds_read_b128 v[84:87], v11 offset:2048
    ds_read_b128 v[88:91], v11 offset:3072
    ds_read_b128 v[92:95], v11 offset:4096
    ds_read_b128 v[96:99], v11 offset:5120
    ds_read_b128 v[100:103], v11 offset:6144
    ds_read_b128 v[104:107], v11 offset:7168
    s_add_u32 s19, s20, 0
    s_waitcnt lgkmcnt(7)
    buffer_store_dwordx4 v[76:79], v10, s[4:7], s19 offen sc1
    s_add_u32 s19, s20, 1024
    s_waitcnt lgkmcnt(6)
    buffer_store_dwordx4 v[80:83], v10, s[4:7], s19 offen sc1
    s_add_u32 s19, s20, 262144
    s_waitcnt lgkmcnt(5)
    buffer_store_dwordx4 v[84:87], v10, s[4:7], s19 offen sc1
    s_add_u32 s19, s20, 263168
    s_waitcnt lgkmcnt(4)
    buffer_store_dwordx4 v[88:91], v10, s[4:7], s19 offen sc1
    s_add_u32 s19, s20, 524288
    s_waitcnt lgkmcnt(3)
    buffer_store_dwordx4 v[92:95], v10, s[4:7], s19 offen sc1
    s_add_u32 s19, s20, 525312
    s_waitcnt lgkmcnt(2)
    buffer_store_dwordx4 v[96:99], v10, s[4:7], s19 offen sc1
    s_add_u32 s19, s20, 786432
    s_waitcnt lgkmcnt(1)
    buffer_store_dwordx4 v[100:103], v10, s[4:7], s19 offen sc1
    s_add_u32 s19, s20, 787456
    s_waitcnt lgkmcnt(0)
    buffer_store_dwordx4 v[104:107], v10, s[4:7], s19 offen sc1
xf_done:
    s_nop 1
    s_setpc_b64 s[46:47]
L_helper:
    s_load_dwordx16 s[64:79], s[0:1], 64
    s_waitcnt lgkmcnt(0)
    s_mov_b32 s93, 1000
    s_mov_b32 s95, 0
    s_cmp_lg_u32 s3, 2
    s_cbranch_scc1 L_qkv_next
    s_mov_b32 s37, 24
    v_mov_b32 v250, 1
    v_mov_b32 v251, 163832
    v_cmp_eq_u32 vcc, 0, v0
    s_nop 0
    s_and_saveexec_b64 s[38:39], vcc
    s_cbranch_execz tk3
    buffer_atomic_add v250, off, s[84:87], s37 sc0
    s_waitcnt vmcnt(0)
    ds_write_b32 v251, v250
    s_waitcnt lgkmcnt(0)
tk3:
    s_mov_b64 exec, -1
    s_barrier
    ds_read_b32 v252, v251
    s_waitcnt lgkmcnt(0)
    v_readfirstlane_b32 s36, v252
    s_barrier
    s_nop 3
    s_cmp_ge_u32 s36, 32
    s_cbranch_scc1 L_qkv_next
    s_mov_b32 s93, 0
    s_cmp_eq_u32 s36, 0
    s_cbranch_scc1 L_relay
    s_branch L_wf_next
L_qkv_next:
    s_sub_u32 s46, s3, 2
    s_cmp_lt_u32 s3, 2
    s_cselect_b32 s46, s3, s46
    s_cmp_lt_u32 s46, 6
    s_cselect_b32 s46, s46, 0
    s_mov_b32 s47, 6
L_qq:
    s_lshl_b32 s40, s46, 2
    s_add_u32 s40, s40, 32
    s_mov_b32 s37, s40
    v_mov_b32 v250, 1
    v_mov_b32 v251, 163832
    v_cmp_eq_u32 vcc, 0, v0
    s_nop 0
    s_and_saveexec_b64 s[38:39], vcc
    s_cbranch_execz tk4
    buffer_atomic_add v250, off, s[84:87], s37 sc0
    s_waitcnt vmcnt(0)
    ds_write_b32 v251, v250
    s_waitcnt lgkmcnt(0)
tk4:
    s_mov_b64 exec, -1
    s_barrier
    ds_read_b32 v252, v251
    s_waitcnt lgkmcnt(0)
    v_readfirstlane_b32 s36, v252
    s_barrier
    s_nop 3
    s_or_b32 s37, s36, s32
    s_cbranch_scc1 L_non
    s_memrealtime s[90:91]
    s_waitcnt lgkmcnt(0)
    s_lshl_b32 s90, s90, 8
    s_or_b32 s90, s90, 1
    v_mov_b32 v250, s90
    v_mov_b32 v251, 0
    s_mov_b64 exec, 1
    buffer_atomic_cmpswap v[250:251], off, s[84:87], 0 offset:216
    s_mov_b64 exec, -1
L_non:
    s_cmp_lt_u32 s36, 32
    s_cbranch_scc1 L_qkv
    s_add_u32 s46, s46, 1
    s_cmp_lt_u32 s46, 6
    s_cselect_b32 s46, s46, 0
    s_sub_u32 s47, s47, 1
    s_cmp_lg_u32 s47, 0
    s_cbranch_scc1 L_qq
    s_mov_b32 s37, 4
    v_mov_b32 v250, 1
    v_mov_b32 v251, 163832
    v_cmp_eq_u32 vcc, 0, v0
    s_nop 0
    s_and_saveexec_b64 s[38:39], vcc
    s_cbranch_execz tk5
    buffer_atomic_add v250, off, s[84:87], s37 sc0
    s_waitcnt vmcnt(0)
    ds_write_b32 v251, v250
    s_waitcnt lgkmcnt(0)
tk5:
    s_mov_b64 exec, -1
    s_barrier
    ds_read_b32 v252, v251
    s_waitcnt lgkmcnt(0)
    v_readfirstlane_b32 s45, v252
    s_barrier
    s_nop 3
    s_cmp_lg_u32 s95, 0
    s_cbranch_scc1 L_hn
    s_mov_b32 s88, 4194304
gn6:
    buffer_load_dword v250, off, s[84:87], 0 offset:216 sc1
    s_waitcnt vmcnt(0)
    v_readfirstlane_b32 s95, v250
    s_sub_u32 s88, s88, 1
    s_cbranch_scc1 gn6x
    s_cmp_eq_u32 s95, 0
    s_cbranch_scc1 gn6
gn6x:
L_hn:
    s_cmp_lg_u32 s45, 0
    s_cbranch_scc1 L_phase2
    s_mov_b32 s37, 24
    v_mov_b32 v250, 1
    v_mov_b32 v251, 163832
    v_cmp_eq_u32 vcc, 0, v0
    s_nop 0
    s_and_saveexec_b64 s[38:39], vcc
    s_cbranch_execz tk7
    buffer_atomic_add v250, off, s[84:87], s37 sc0
    s_waitcnt vmcnt(0)
    ds_write_b32 v251, v250
    s_waitcnt lgkmcnt(0)
tk7:
    s_mov_b64 exec, -1
    s_barrier
    ds_read_b32 v252, v251
    s_waitcnt lgkmcnt(0)
    v_readfirstlane_b32 s36, v252
    s_barrier
    s_nop 3
    s_cmp_lg_u32 s36, 0
    s_cbranch_scc1 L_phase2
L_relay:
    s_cmp_lg_u32 s32, 0
    s_cbranch_scc1 L_exit
    s_sleep 100
    s_mov_b32 s88, 4194304
gn8:
    buffer_load_dword v250, off, s[84:87], 0 offset:216 sc1
    s_waitcnt vmcnt(0)
    v_readfirstlane_b32 s95, v250
    s_sub_u32 s88, s88, 1
    s_cbranch_scc1 gn8x
    s_cmp_eq_u32 s95, 0
    s_cbranch_scc1 gn8
gn8x:
    v_and_b32 v3, 31, v0
    v_lshlrev_b32 v3, 7, v3
    s_mov_b32 s17, 0
    s_mov_b32 s23, 125845504
    s_mov_b32 s24, 125853696
    s_mov_b32 s21, 16777216
rl_rwait:
    buffer_load_dword v4, v3, s[4:7], s23 offen sc1
    s_waitcnt vmcnt(0)
    v_subrev_u32 v4, s95, v4
    v_cmp_lt_u32 vcc, 64, v4
    s_nop 1
    v_cndmask_b32 v4, v4, 0, vcc
    s_nop 1
    v_min_u32_dpp v4, v4, v4 row_ror:1 row_mask:0xf bank_mask:0xf
    s_nop 1
    v_min_u32_dpp v4, v4, v4 row_ror:2 row_mask:0xf bank_mask:0xf
    s_nop 1
    v_min_u32_dpp v4, v4, v4 row_ror:4 row_mask:0xf bank_mask:0xf
    s_nop 1
    v_min_u32_dpp v4, v4, v4 row_ror:8 row_mask:0xf bank_mask:0xf
    s_nop 0
    v_readlane_b32 s16, v4, 0
    v_readlane_b32 s22, v4, 16
    s_nop 0
    s_min_u32 s16, s16, s22
    s_sub_u32 s21, s21, 1
    s_cbranch_scc1 rl_x
    s_cmp_gt_u32 s16, s17
    s_cbranch_scc1 rl_rpub
    s_sleep 2
    s_branch rl_rwait
rl_rpub:
    s_mov_b32 s17, s16
    s_add_u32 s22, s16, s95
    v_mov_b32 v4, s22
    s_mov_b64 exec, 1
    buffer_store_dword v4, off, s[4:7], s24 sc1
    s_mov_b64 exec, -1
    s_cmp_lt_u32 s16, 64
    s_cbranch_scc1 rl_rwait
rl_x:
    s_endpgm
L_qkv:
    s_and_b32 s37, s36, 3
    s_lshr_b32 s36, s36, 2
    s_lshl_b32 s40, s46, 3
    s_add_u32 s36, s36, s40
    s_lshr_b32 s40, s36, 4
    s_and_b32 s36, s36, 15
    s_lshl_b32 s41, s37, 1
    s_add_u32 s41, s41, s40
    s_add_u32 s37, s37, 8
    s_cmp_eq_u32 s40, 2
    s_cselect_b32 s41, s37, s41
    s_lshl_b32 s41, s41, 4
    s_add_u32 s36, s36, s41
    s_sub_u32 s33, s36, 32
    s_and_b32 s17, s36, 15
    s_lshl_b32 s17, s17, 1
    s_lshr_b32 s36, s36, 4
    s_and_b32 s16, s36, 1
    s_add_u32 s16, s16, 1
    s_lshr_b32 s19, s36, 1
    s_and_b32 s37, s36, 3
    s_cmp_ge_u32 s36, 8
    s_cselect_b32 s16, 0, s16
    s_cselect_b32 s19, s37, s19
    v_lshrrev_b32 v4, 6, v0
    s_nop 0
    v_readfirstlane_b32 s18, v4
    v_lshlrev_b32 v7, 4, v0
    s_cmp_eq_u32 s16, 1
    s_cselect_b64 s[12:13], s[54:55], s[52:53]
    s_cmp_eq_u32 s16, 2
    s_cselect_b64 s[12:13], s[56:57], s[12:13]
    s_mov_b32 s14, 4718592
    s_mov_b32 s15, 0x20000
    v_bfe_u32 v4, v0, 5, 1
    v_lshlrev_b32 v5, 2, v4
    v_and_b32 v8, 31, v0
    v_xor_b32 v8, v8, v5
    v_lshlrev_b32 v8, 4, v8
    v_lshl_add_u32 v8, v4, 13, v8
    v_xor_b32 v9, 128, v8
    s_lshl_b32 s21, s17, 8
    s_lshl_b32 s42, s18, 16
    s_add_u32 s42, s42, s21
    s_lshl_b32 s44, s18, 12
    s_barrier
    s_add_u32 m0, s44, 73728
    s_add_u32 s22, s42, 0
    buffer_load_dwordx4 v8, s[12:15], s22 offen offset:0 lds
    s_add_u32 s22, s42, 15360
    buffer_load_dwordx4 v9, s[12:15], s22 offen offset:1024 lds
    s_add_u32 s22, s42, 30720
    buffer_load_dwordx4 v8, s[12:15], s22 offen offset:2048 lds
    s_add_u32 s22, s42, 46080
    buffer_load_dwordx4 v9, s[12:15], s22 offen offset:3072 lds
    s_add_u32 m0, s44, 90112
    s_add_u32 s22, s42, 1048576
    buffer_load_dwordx4 v8, s[12:15], s22 offen offset:0 lds
    s_add_u32 s22, s42, 1063936
    buffer_load_dwordx4 v9, s[12:15], s22 offen offset:1024 lds
    s_add_u32 s22, s42, 1079296
    buffer_load_dwordx4 v8, s[12:15], s22 offen offset:2048 lds
    s_add_u32 s22, s42, 1094656
    buffer_load_dwordx4 v9, s[12:15], s22 offen offset:3072 lds
    s_add_u32 m0, s44, 106496
    s_add_u32 s22, s42, 2097152
    buffer_load_dwordx4 v8, s[12:15], s22 offen offset:0 lds
    s_add_u32 s22, s42, 2112512
    buffer_load_dwordx4 v9, s[12:15], s22 offen offset:1024 lds
    s_add_u32 s22, s42, 2127872
    buffer_load_dwordx4 v8, s[12:15], s22 offen offset:2048 lds
    s_add_u32 s22, s42, 2143232
    buffer_load_dwordx4 v9, s[12:15], s22 offen offset:3072 lds
    s_add_u32 m0, s44, 122880
    s_add_u32 s22, s42, 3145728
    buffer_load_dwordx4 v8, s[12:15], s22 offen offset:0 lds
    s_add_u32 s22, s42, 3161088
    buffer_load_dwordx4 v9, s[12:15], s22 offen offset:1024 lds
    s_add_u32 s22, s42, 3176448
    buffer_load_dwordx4 v8, s[12:15], s22 offen offset:2048 lds
    s_add_u32 s22, s42, 3191808
    buffer_load_dwordx4 v9, s[12:15], s22 offen offset:3072 lds
    v_bfe_u32 v4, v0, 2, 2
    v_xor_b32 v5, s18, v4
    v_lshlrev_b32 v10, 6, v5
    v_lshl_add_u32 v10, v4, 9, v10
    v_and_b32 v4, 3, v0
    v_lshl_add_u32 v10, v4, 4, v10
    v_bfe_u32 v4, v0, 4, 2
    v_lshl_add_u32 v10, v4, 12, v10
    v_add_u32 v10, 73728, v10
    v_add_u32 v11, 49152, v10
    v_and_b32 v4, 63, v0
    v_and_b32 v5, 15, v4
    v_lshrrev_b32 v3, 4, v4
    v_lshrrev_b32 v2, 2, v5
    v_xor_b32 v3, v3, v2
    v_lshl_add_u32 v3, v5, 2, v3
    v_lshlrev_b32 v1, 4, v3
    v_lshrrev_b32 v5, 2, v4
    v_lshrrev_b32 v3, 4, v4
    v_and_b32 v4, 3, v4
    v_xor_b32 v4, v4, v3
    v_lshlrev_b32 v3, 3, v3
    v_and_b32 v5, 3, v5
    v_add_u32 v3, v3, v5
    v_mul_u32_u24 v2, 1152, v3
    v_lshl_add_u32 v2, v4, 4, v2
    s_mov_b32 s8, s48
    s_mov_b32 s9, s49
    s_mov_b32 s10, 2359296
    s_mov_b32 s11, 0x20000
    s_lshr_b32 s22, s18, 1
    s_mul_i32 s24, s22, 4608
    s_mul_i32 s25, s22, 18432
    s_and_b32 s22, s18, 1
    s_mul_i32 s23, s22, 576
    s_add_u32 s24, s24, s23
    s_mul_i32 s25, s18, 9216
    s_mul_i32 s22, s19, 36864
    s_add_u32 s24, s24, s22
    s_mov_b32 s20, 64
    s_lshl_b32 s22, s19, 5
    s_add_u32 s22, s22, s17
    s_lshl_b32 s26, s22, 14
    s_mul_i32 s23, s18, 3072
    s_add_u32 s26, s26, s23
    s_lshl_b32 s23, s16, 11
    s_add_u32 s26, s26, s23
    s_add_u32 s26, s26, -2048
    s_lshl_b32 s22, s22, 13
    s_add_u32 s22, s22, 33554432
    s_cmp_eq_u32 s16, 0
    s_cselect_b32 s26, s22, s26
    s_cselect_b32 s40, 4096, 64
    s_cselect_b32 s41, 1, 2
    s_max_u32 s40, s40, 1024
    s_lshl_b32 s41, s41, 18
    s_lshl_b32 s29, s17, 7
    s_lshl_b32 s22, s16, 4
    s_add_u32 s29, s29, s22
    s_lshl_b32 s22, s19, 2
    s_add_u32 s29, s29, s22
    s_add_u32 s29, s29, 125829120
    s_mov_b32 s27, 0
    s_add_u32 s23, s27, s25
    s_add_u32 m0, s23, 0
    s_nop 0
    buffer_load_dwordx4 v2, s[8:11], s24 offen offset:0 lds
    s_add_u32 m0, s23, 960
    s_nop 0
    buffer_load_dwordx4 v2, s[8:11], s24 offen offset:64 lds
    s_add_u32 m0, s23, 1920
    s_nop 0
    buffer_load_dwordx4 v2, s[8:11], s24 offen offset:128 lds
    s_add_u32 m0, s23, 2880
    s_nop 0
    buffer_load_dwordx4 v2, s[8:11], s24 offen offset:192 lds
    s_add_u32 m0, s23, 3840
    s_nop 0
    buffer_load_dwordx4 v2, s[8:11], s24 offen offset:256 lds
    s_add_u32 m0, s23, 4800
    s_nop 0
    buffer_load_dwordx4 v2, s[8:11], s24 offen offset:320 lds
    s_add_u32 m0, s23, 5760
    s_nop 0
    buffer_load_dwordx4 v2, s[8:11], s24 offen offset:384 lds
    s_add_u32 m0, s23, 6720
    s_nop 0
    buffer_load_dwordx4 v2, s[8:11], s24 offen offset:448 lds
    s_add_u32 m0, s23, 7680
    s_nop 0
    buffer_load_dwordx4 v2, s[8:11], s24 offen offset:512 lds
    s_add_u32 s24, s24, 147456
    s_waitcnt vmcnt(21) lgkmcnt(0)
    s_barrier
    s_add_u32 m0, s44, 139264
    s_add_u32 s22, s42, 262144
    buffer_load_dwordx4 v8, s[12:15], s22 offen offset:0 lds
    s_add_u32 s22, s42, 277504
    buffer_load_dwordx4 v9, s[12:15], s22 offen offset:1024 lds
    s_add_u32 s22, s42, 292864
    buffer_load_dwordx4 v8, s[12:15], s22 offen offset:2048 lds
    s_add_u32 s22, s42, 308224
    buffer_load_dwordx4 v9, s[12:15], s22 offen offset:3072 lds
    ds_read_b64_tr_b16 v[64:65], v10 offset:0
    ds_read_b64_tr_b16 v[66:67], v10 offset:2048
    ds_read_b64_tr_b16 v[136:137], v10 offset:8
    ds_read_b64_tr_b16 v[138:139], v10 offset:2056
    ds_read_b64_tr_b16 a[0:1], v10 offset:256
    ds_read_b64_tr_b16 a[2:3], v10 offset:2304
    ds_read_b64_tr_b16 a[72:73], v10 offset:264
    ds_read_b64_tr_b16 a[74:75], v10 offset:2312
    s_waitcnt vmcnt(21) lgkmcnt(0)
    s_barrier
    s_add_u32 m0, s44, 73728
    s_add_u32 s22, s42, 1310720
    buffer_load_dwordx4 v8, s[12:15], s22 offen offset:0 lds
    s_add_u32 s22, s42, 1326080
    buffer_load_dwordx4 v9, s[12:15], s22 offen offset:1024 lds
    s_add_u32 s22, s42, 1341440
    buffer_load_dwordx4 v8, s[12:15], s22 offen offset:2048 lds
    s_add_u32 s22, s42, 1356800
    buffer_load_dwordx4 v9, s[12:15], s22 offen offset:3072 lds
    ds_read_b64_tr_b16 v[80:81], v10 offset:16384
    ds_read_b64_tr_b16 v[82:83], v10 offset:18432
    ds_read_b64_tr_b16 v[152:153], v10 offset:16392
    ds_read_b64_tr_b16 v[154:155], v10 offset:18440
    ds_read_b64_tr_b16 a[16:17], v10 offset:16640
    ds_read_b64_tr_b16 a[18:19], v10 offset:18688
    ds_read_b64_tr_b16 a[88:89], v10 offset:16648
    ds_read_b64_tr_b16 a[90:91], v10 offset:18696
    s_waitcnt vmcnt(21) lgkmcnt(0)
    s_barrier
    s_add_u32 m0, s44, 90112
    s_add_u32 s22, s42, 2359296
    buffer_load_dwordx4 v8, s[12:15], s22 offen offset:0 lds
    s_add_u32 s22, s42, 2374656
    buffer_load_dwordx4 v9, s[12:15], s22 offen offset:1024 lds
    s_add_u32 s22, s42, 2390016
    buffer_load_dwordx4 v8, s[12:15], s22 offen offset:2048 lds
    s_add_u32 s22, s42, 2405376
    buffer_load_dwordx4 v9, s[12:15], s22 offen offset:3072 lds
    ds_read_b64_tr_b16 v[96:97], v10 offset:32768
    ds_read_b64_tr_b16 v[98:99], v10 offset:34816
    ds_read_b64_tr_b16 v[168:169], v10 offset:32776
    ds_read_b64_tr_b16 v[170:171], v10 offset:34824
    ds_read_b64_tr_b16 a[32:33], v10 offset:33024
    ds_read_b64_tr_b16 a[34:35], v10 offset:35072
    ds_read_b64_tr_b16 a[104:105], v10 offset:33032
    ds_read_b64_tr_b16 a[106:107], v10 offset:35080
    s_waitcnt vmcnt(21) lgkmcnt(0)
    s_barrier
    s_add_u32 m0, s44, 106496
    s_add_u32 s22, s42, 3407872
    buffer_load_dwordx4 v8, s[12:15], s22 offen offset:0 lds
    s_add_u32 s22, s42, 3423232
    buffer_load_dwordx4 v9, s[12:15], s22 offen offset:1024 lds
    s_add_u32 s22, s42, 3438592
    buffer_load_dwordx4 v8, s[12:15], s22 offen offset:2048 lds
    s_add_u32 s22, s42, 3453952
    buffer_load_dwordx4 v9, s[12:15], s22 offen offset:3072 lds
    ds_read_b64_tr_b16 v[112:113], v11 offset:0
    ds_read_b64_tr_b16 v[114:115], v11 offset:2048
    ds_read_b64_tr_b16 v[184:185], v11 offset:8
    ds_read_b64_tr_b16 v[186:187], v11 offset:2056
    ds_read_b64_tr_b16 a[48:49], v11 offset:256
    ds_read_b64_tr_b16 a[50:51], v11 offset:2304
    ds_read_b64_tr_b16 a[120:121], v11 offset:264
    ds_read_b64_tr_b16 a[122:123], v11 offset:2312
    s_waitcnt vmcnt(12) lgkmcnt(0)
    s_barrier
    s_add_u32 m0, s44, 122880
    s_add_u32 s22, s42, 524288
    buffer_load_dwordx4 v8, s[12:15], s22 offen offset:0 lds
    s_add_u32 s22, s42, 539648
    buffer_load_dwordx4 v9, s[12:15], s22 offen offset:1024 lds
    s_add_u32 s22, s42, 555008
    buffer_load_dwordx4 v8, s[12:15], s22 offen offset:2048 lds
    s_add_u32 s22, s42, 570368
    buffer_load_dwordx4 v9, s[12:15], s22 offen offset:3072 lds
    ds_read_b64_tr_b16 v[68:69], v11 offset:16384
    ds_read_b64_tr_b16 v[70:71], v11 offset:18432
    ds_read_b64_tr_b16 v[140:141], v11 offset:16392
    ds_read_b64_tr_b16 v[142:143], v11 offset:18440
    ds_read_b64_tr_b16 a[4:5], v11 offset:16640
    ds_read_b64_tr_b16 a[6:7], v11 offset:18688
    ds_read_b64_tr_b16 a[76:77], v11 offset:16648
    ds_read_b64_tr_b16 a[78:79], v11 offset:18696
    s_waitcnt vmcnt(12) lgkmcnt(0)
    s_barrier
    s_add_u32 m0, s44, 139264
    s_add_u32 s22, s42, 1572864
    buffer_load_dwordx4 v8, s[12:15], s22 offen offset:0 lds
    s_add_u32 s22, s42, 1588224
    buffer_load_dwordx4 v9, s[12:15], s22 offen offset:1024 lds
    s_add_u32 s22, s42, 1603584
    buffer_load_dwordx4 v8, s[12:15], s22 offen offset:2048 lds
    s_add_u32 s22, s42, 1618944
    buffer_load_dwordx4 v9, s[12:15], s22 offen offset:3072 lds
    ds_read_b64_tr_b16 v[84:85], v10 offset:0
    ds_read_b64_tr_b16 v[86:87], v10 offset:2048
    ds_read_b64_tr_b16 v[156:157], v10 offset:8
    ds_read_b64_tr_b16 v[158:159], v10 offset:2056
    ds_read_b64_tr_b16 a[20:21], v10 offset:256
    ds_read_b64_tr_b16 a[22:23], v10 offset:2304
    ds_read_b64_tr_b16 a[92:93], v10 offset:264
    ds_read_b64_tr_b16 a[94:95], v10 offset:2312
    s_waitcnt vmcnt(12) lgkmcnt(0)
    s_barrier
    s_add_u32 m0, s44, 73728
    s_add_u32 s22, s42, 2621440
    buffer_load_dwordx4 v8, s[12:15], s22 offen offset:0 lds
    s_add_u32 s22, s42, 2636800
    buffer_load_dwordx4 v9, s[12:15], s22 offen offset:1024 lds
    s_add_u32 s22, s42, 2652160
    buffer_load_dwordx4 v8, s[12:15], s22 offen offset:2048 lds
    s_add_u32 s22, s42, 2667520
    buffer_load_dwordx4 v9, s[12:15], s22 offen offset:3072 lds
    ds_read_b64_tr_b16 v[100:101], v10 offset:16384
    ds_read_b64_tr_b16 v[102:103], v10 offset:18432
    ds_read_b64_tr_b16 v[172:173], v10 offset:16392
    ds_read_b64_tr_b16 v[174:175], v10 offset:18440
    ds_read_b64_tr_b16 a[36:37], v10 offset:16640
    ds_read_b64_tr_b16 a[38:39], v10 offset:18688
    ds_read_b64_tr_b16 a[108:109], v10 offset:16648
    ds_read_b64_tr_b16 a[110:111], v10 offset:18696
    s_waitcnt vmcnt(12) lgkmcnt(0)
    s_barrier
    s_add_u32 m0, s44, 90112
    s_add_u32 s22, s42, 3670016
    buffer_load_dwordx4 v8, s[12:15], s22 offen offset:0 lds
    s_add_u32 s22, s42, 3685376
    buffer_load_dwordx4 v9, s[12:15], s22 offen offset:1024 lds
    s_add_u32 s22, s42, 3700736
    buffer_load_dwordx4 v8, s[12:15], s22 offen offset:2048 lds
    s_add_u32 s22, s42, 3716096
    buffer_load_dwordx4 v9, s[12:15], s22 offen offset:3072 lds
    ds_read_b64_tr_b16 v[116:117], v10 offset:32768
    ds_read_b64_tr_b16 v[118:119], v10 offset:34816
    ds_read_b64_tr_b16 v[188:189], v10 offset:32776
    ds_read_b64_tr_b16 v[190:191], v10 offset:34824
    ds_read_b64_tr_b16 a[52:53], v10 offset:33024
    ds_read_b64_tr_b16 a[54:55], v10 offset:35072
    ds_read_b64_tr_b16 a[124:125], v10 offset:33032
    ds_read_b64_tr_b16 a[126:127], v10 offset:35080
    s_waitcnt vmcnt(12) lgkmcnt(0)
    s_barrier
    s_add_u32 m0, s44, 106496
    s_add_u32 s22, s42, 786432
    buffer_load_dwordx4 v8, s[12:15], s22 offen offset:0 lds
    s_add_u32 s22, s42, 801792
    buffer_load_dwordx4 v9, s[12:15], s22 offen offset:1024 lds
    s_add_u32 s22, s42, 817152
    buffer_load_dwordx4 v8, s[12:15], s22 offen offset:2048 lds
    s_add_u32 s22, s42, 832512
    buffer_load_dwordx4 v9, s[12:15], s22 offen offset:3072 lds
    ds_read_b64_tr_b16 v[72:73], v11 offset:0
    ds_read_b64_tr_b16 v[74:75], v11 offset:2048
    ds_read_b64_tr_b16 v[144:145], v11 offset:8
    ds_read_b64_tr_b16 v[146:147], v11 offset:2056
    ds_read_b64_tr_b16 a[8:9], v11 offset:256
    ds_read_b64_tr_b16 a[10:11], v11 offset:2304
    ds_read_b64_tr_b16 a[80:81], v11 offset:264
    ds_read_b64_tr_b16 a[82:83], v11 offset:2312
    s_waitcnt vmcnt(12) lgkmcnt(0)
    s_barrier
    s_add_u32 m0, s44, 122880
    s_add_u32 s22, s42, 1835008
    buffer_load_dwordx4 v8, s[12:15], s22 offen offset:0 lds
    s_add_u32 s22, s42, 1850368
    buffer_load_dwordx4 v9, s[12:15], s22 offen offset:1024 lds
    s_add_u32 s22, s42, 1865728
    buffer_load_dwordx4 v8, s[12:15], s22 offen offset:2048 lds
    s_add_u32 s22, s42, 1881088
    buffer_load_dwordx4 v9, s[12:15], s22 offen offset:3072 lds
    ds_read_b64_tr_b16 v[88:89], v11 offset:16384
    ds_read_b64_tr_b16 v[90:91], v11 offset:18432
    ds_read_b64_tr_b16 v[160:161], v11 offset:16392
    ds_read_b64_tr_b16 v[162:163], v11 offset:18440
    ds_read_b64_tr_b16 a[24:25], v11 offset:16640
    ds_read_b64_tr_b16 a[26:27], v11 offset:18688
    ds_read_b64_tr_b16 a[96:97], v11 offset:16648
    ds_read_b64_tr_b16 a[98:99], v11 offset:18696
    s_waitcnt vmcnt(12) lgkmcnt(0)
    s_barrier
    s_add_u32 m0, s44, 139264
    s_add_u32 s22, s42, 2883584
    buffer_load_dwordx4 v8, s[12:15], s22 offen offset:0 lds
    s_add_u32 s22, s42, 2898944
    buffer_load_dwordx4 v9, s[12:15], s22 offen offset:1024 lds
    s_add_u32 s22, s42, 2914304
    buffer_load_dwordx4 v8, s[12:15], s22 offen offset:2048 lds
    s_add_u32 s22, s42, 2929664
    buffer_load_dwordx4 v9, s[12:15], s22 offen offset:3072 lds
    ds_read_b64_tr_b16 v[104:105], v10 offset:0
    ds_read_b64_tr_b16 v[106:107], v10 offset:2048
    ds_read_b64_tr_b16 v[176:177], v10 offset:8
    ds_read_b64_tr_b16 v[178:179], v10 offset:2056
    ds_read_b64_tr_b16 a[40:41], v10 offset:256
    ds_read_b64_tr_b16 a[42:43], v10 offset:2304
    ds_read_b64_tr_b16 a[112:113], v10 offset:264
    ds_read_b64_tr_b16 a[114:115], v10 offset:2312
    s_waitcnt vmcnt(12) lgkmcnt(0)
    s_barrier
    s_add_u32 m0, s44, 73728
    s_add_u32 s22, s42, 3932160
    buffer_load_dwordx4 v8, s[12:15], s22 offen offset:0 lds
    s_add_u32 s22, s42, 3947520
    buffer_load_dwordx4 v9, s[12:15], s22 offen offset:1024 lds
    s_add_u32 s22, s42, 3962880
    buffer_load_dwordx4 v8, s[12:15], s22 offen offset:2048 lds
    s_add_u32 s22, s42, 3978240
    buffer_load_dwordx4 v9, s[12:15], s22 offen offset:3072 lds
    ds_read_b64_tr_b16 v[120:121], v10 offset:16384
    ds_read_b64_tr_b16 v[122:123], v10 offset:18432
    ds_read_b64_tr_b16 v[192:193], v10 offset:16392
    ds_read_b64_tr_b16 v[194:195], v10 offset:18440
    ds_read_b64_tr_b16 a[56:57], v10 offset:16640
    ds_read_b64_tr_b16 a[58:59], v10 offset:18688
    ds_read_b64_tr_b16 a[128:129], v10 offset:16648
    ds_read_b64_tr_b16 a[130:131], v10 offset:18696
    s_waitcnt vmcnt(12) lgkmcnt(0)
    s_barrier
    s_add_u32 m0, s44, 90112
    s_add_u32 s22, s42, 4194304
    buffer_load_dwordx4 v8, s[12:15], s22 offen offset:0 lds
    s_add_u32 s22, s42, 4209664
    buffer_load_dwordx4 v9, s[12:15], s22 offen offset:1024 lds
    s_add_u32 s22, s42, 4225024
    buffer_load_dwordx4 v8, s[12:15], s22 offen offset:2048 lds
    s_add_u32 s22, s42, 4240384
    buffer_load_dwordx4 v9, s[12:15], s22 offen offset:3072 lds
    ds_read_b64_tr_b16 v[76:77], v10 offset:32768
    ds_read_b64_tr_b16 v[78:79], v10 offset:34816
    ds_read_b64_tr_b16 v[148:149], v10 offset:32776
    ds_read_b64_tr_b16 v[150:151], v10 offset:34824
    ds_read_b64_tr_b16 a[12:13], v10 offset:33024
    ds_read_b64_tr_b16 a[14:15], v10 offset:35072
    ds_read_b64_tr_b16 a[84:85], v10 offset:33032
    ds_read_b64_tr_b16 a[86:87], v10 offset:35080
    s_waitcnt vmcnt(12) lgkmcnt(0)
    s_barrier
    s_add_u32 m0, s44, 106496
    s_add_u32 s22, s42, 4456448
    buffer_load_dwordx4 v8, s[12:15], s22 offen offset:0 lds
    s_add_u32 s22, s42, 4471808
    buffer_load_dwordx4 v9, s[12:15], s22 offen offset:1024 lds
    s_add_u32 s22, s42, 4487168
    buffer_load_dwordx4 v8, s[12:15], s22 offen offset:2048 lds
    s_add_u32 s22, s42, 4502528
    buffer_load_dwordx4 v9, s[12:15], s22 offen offset:3072 lds
    ds_read_b64_tr_b16 v[92:93], v11 offset:0
    ds_read_b64_tr_b16 v[94:95], v11 offset:2048
    ds_read_b64_tr_b16 v[164:165], v11 offset:8
    ds_read_b64_tr_b16 v[166:167], v11 offset:2056
    ds_read_b64_tr_b16 a[28:29], v11 offset:256
    ds_read_b64_tr_b16 a[30:31], v11 offset:2304
    ds_read_b64_tr_b16 a[100:101], v11 offset:264
    ds_read_b64_tr_b16 a[102:103], v11 offset:2312
    s_waitcnt vmcnt(12) lgkmcnt(0)
    s_barrier
    s_mov_b32 s27, 36864
    s_add_u32 s23, s27, s25
    s_add_u32 m0, s23, 0
    s_nop 0
    buffer_load_dwordx4 v2, s[8:11], s24 offen offset:0 lds
    s_add_u32 m0, s23, 960
    s_nop 0
    buffer_load_dwordx4 v2, s[8:11], s24 offen offset:64 lds
    s_add_u32 m0, s23, 1920
    s_nop 0
    buffer_load_dwordx4 v2, s[8:11], s24 offen offset:128 lds
    s_add_u32 m0, s23, 2880
    s_nop 0
    buffer_load_dwordx4 v2, s[8:11], s24 offen offset:192 lds
    s_add_u32 m0, s23, 3840
    s_nop 0
    buffer_load_dwordx4 v2, s[8:11], s24 offen offset:256 lds
    s_add_u32 m0, s23, 4800
    s_nop 0
    buffer_load_dwordx4 v2, s[8:11], s24 offen offset:320 lds
    s_add_u32 m0, s23, 5760
    s_nop 0
    buffer_load_dwordx4 v2, s[8:11], s24 offen offset:384 lds
    s_add_u32 m0, s23, 6720
    s_nop 0
    buffer_load_dwordx4 v2, s[8:11], s24 offen offset:448 lds
    s_add_u32 m0, s23, 7680
    s_nop 0
    buffer_load_dwordx4 v2, s[8:11], s24 offen offset:512 lds
    s_add_u32 s24, s24, 147456
    ds_read_b64_tr_b16 v[108:109], v11 offset:16384
    ds_read_b64_tr_b16 v[110:111], v11 offset:18432
    ds_read_b64_tr_b16 v[180:181], v11 offset:16392
    ds_read_b64_tr_b16 v[182:183], v11 offset:18440
    ds_read_b64_tr_b16 a[44:45], v11 offset:16640
    ds_read_b64_tr_b16 a[46:47], v11 offset:18688
    ds_read_b64_tr_b16 a[116:117], v11 offset:16648
    ds_read_b64_tr_b16 a[118:119], v11 offset:18696
    s_waitcnt vmcnt(17) lgkmcnt(0)
    s_barrier
    ds_read_b64_tr_b16 v[124:125], v10 offset:0
    ds_read_b64_tr_b16 v[126:127], v10 offset:2048
    ds_read_b64_tr_b16 v[196:197], v10 offset:8
    ds_read_b64_tr_b16 v[198:199], v10 offset:2056
    ds_read_b64_tr_b16 a[60:61], v10 offset:256
    ds_read_b64_tr_b16 a[62:63], v10 offset:2304
    ds_read_b64_tr_b16 a[132:133], v10 offset:264
    ds_read_b64_tr_b16 a[134:135], v10 offset:2312
    s_waitcnt vmcnt(13) lgkmcnt(0)
    s_barrier
    ds_read_b64_tr_b16 v[128:129], v10 offset:16384
    ds_read_b64_tr_b16 v[130:131], v10 offset:18432
    ds_read_b64_tr_b16 v[200:201], v10 offset:16392
    ds_read_b64_tr_b16 v[202:203], v10 offset:18440
    ds_read_b64_tr_b16 a[64:65], v10 offset:16640
    ds_read_b64_tr_b16 a[66:67], v10 offset:18688
    ds_read_b64_tr_b16 a[136:137], v10 offset:16648
    ds_read_b64_tr_b16 a[138:139], v10 offset:18696
    s_waitcnt vmcnt(9) lgkmcnt(0)
    s_barrier
    ds_read_b64_tr_b16 v[132:133], v10 offset:32768
    ds_read_b64_tr_b16 v[134:135], v10 offset:34816
    ds_read_b64_tr_b16 v[204:205], v10 offset:32776
    ds_read_b64_tr_b16 v[206:207], v10 offset:34824
    ds_read_b64_tr_b16 a[68:69], v10 offset:33024
    ds_read_b64_tr_b16 a[70:71], v10 offset:35072
    ds_read_b64_tr_b16 a[140:141], v10 offset:33032
    ds_read_b64_tr_b16 a[142:143], v10 offset:35080
    s_mov_b32 s88, 4194304
gn9:
    buffer_load_dword v250, off, s[84:87], 0 offset:216 sc1
    s_waitcnt vmcnt(0)
    v_readfirstlane_b32 s95, v250
    s_sub_u32 s88, s88, 1
    s_cbranch_scc1 gn9x
    s_cmp_eq_u32 s95, 0
    s_cbranch_scc1 gn9
gn9x:
    s_waitcnt lgkmcnt(0)
    s_mov_b32 s45, 0
    s_mov_b32 s27, 0
    s_mov_b64 s[36:37], 0
    s_mov_b32 s12, 0
    s_mov_b32 s13, s40
    s_lshr_b32 s14, s41, 5
    s_add_u32 s15, s14, s40
    s_lshl_b32 s41, s41, 2
    s_sub_u32 s26, s26, s41
    v_mov_b32 v3, v1
    s_waitcnt vmcnt(0)
    s_barrier
    ds_read_b128 v[32:35], v3 offset:0
    ds_read_b128 v[36:39], v3 offset:18432
    ds_read_b128 v[40:43], v3 offset:1024
    ds_read_b128 v[44:47], v3 offset:19456
    s_cmp_eq_u32 s18, 0
    s_cselect_b32 s34, 1, 0
    s_mov_b32 s35, 0
    s_cmp_eq_u32 s16, 2
    s_cbranch_scc1 qk_vloop
qk_loop:
    s_barrier
    s_add_u32 s22, s27, 73728
    s_sub_u32 s21, s22, 110592
    s_cselect_b32 s22, s22, s21
    s_waitcnt lgkmcnt(2)
    v_mfma_f32_16x16x32_bf16 v[208:211], v[64:67], v[32:35], 0
    ds_read_b128 v[48:51], v3 offset:2048
    v_mfma_f32_16x16x32_bf16 v[212:215], v[136:139], v[32:35], 0
    ds_read_b128 v[52:55], v3 offset:20480
    v_mfma_f32_16x16x32_bf16 v[216:219], v[64:67], v[36:39], 0
    v_mfma_f32_16x16x32_bf16 v[220:223], v[136:139], v[36:39], 0
    v_mfma_f32_16x16x32_bf16 v[224:227], a[0:3], v[32:35], 0
    v_mfma_f32_16x16x32_bf16 v[228:231], a[72:75], v[32:35], 0
    v_mfma_f32_16x16x32_bf16 v[232:235], a[0:3], v[36:39], 0
    v_mfma_f32_16x16x32_bf16 v[236:239], a[72:75], v[36:39], 0
    s_waitcnt lgkmcnt(2)
    v_mfma_f32_16x16x32_bf16 v[208:211], v[68:71], v[40:43], v[208:211]
    ds_read_b128 v[32:35], v3 offset:3072
    v_mfma_f32_16x16x32_bf16 v[212:215], v[140:143], v[40:43], v[212:215]
    ds_read_b128 v[36:39], v3 offset:21504
    v_mfma_f32_16x16x32_bf16 v[216:219], v[68:71], v[44:47], v[216:219]
    s_add_u32 s23, s22, s25
    s_add_u32 m0, s23, 0
    s_nop 0
    buffer_load_dwordx4 v2, s[8:11], s24 offen offset:0 lds
    v_mfma_f32_16x16x32_bf16 v[220:223], v[140:143], v[44:47], v[220:223]
    v_mfma_f32_16x16x32_bf16 v[224:227], a[4:7], v[40:43], v[224:227]
    v_mfma_f32_16x16x32_bf16 v[228:231], a[76:79], v[40:43], v[228:231]
    v_mfma_f32_16x16x32_bf16 v[232:235], a[4:7], v[44:47], v[232:235]
    s_add_u32 m0, s23, 960
    s_nop 0
    buffer_load_dwordx4 v2, s[8:11], s24 offen offset:64 lds
    v_mfma_f32_16x16x32_bf16 v[236:239], a[76:79], v[44:47], v[236:239]
    s_waitcnt lgkmcnt(2)
    v_mfma_f32_16x16x32_bf16 v[208:211], v[72:75], v[48:51], v[208:211]
    ds_read_b128 v[40:43], v3 offset:4096
    v_mfma_f32_16x16x32_bf16 v[212:215], v[144:147], v[48:51], v[212:215]
    ds_read_b128 v[44:47], v3 offset:22528
    v_mfma_f32_16x16x32_bf16 v[216:219], v[72:75], v[52:55], v[216:219]
    s_add_u32 m0, s23, 1920
    s_nop 0
    buffer_load_dwordx4 v2, s[8:11], s24 offen offset:128 lds
    v_mfma_f32_16x16x32_bf16 v[220:223], v[144:147], v[52:55], v[220:223]
    v_mfma_f32_16x16x32_bf16 v[224:227], a[8:11], v[48:51], v[224:227]
    v_mfma_f32_16x16x32_bf16 v[228:231], a[80:83], v[48:51], v[228:231]
    v_mfma_f32_16x16x32_bf16 v[232:235], a[8:11], v[52:55], v[232:235]
    s_add_u32 m0, s23, 2880
    s_nop 0
    buffer_load_dwordx4 v2, s[8:11], s24 offen offset:192 lds
    v_mfma_f32_16x16x32_bf16 v[236:239], a[80:83], v[52:55], v[236:239]
    s_waitcnt lgkmcnt(2)
    v_mfma_f32_16x16x32_bf16 v[208:211], v[76:79], v[32:35], v[208:211]
    ds_read_b128 v[48:51], v3 offset:5120
    v_mfma_f32_16x16x32_bf16 v[212:215], v[148:151], v[32:35], v[212:215]
    ds_read_b128 v[52:55], v3 offset:23552
    v_mfma_f32_16x16x32_bf16 v[216:219], v[76:79], v[36:39], v[216:219]
    s_add_u32 m0, s23, 3840
    s_nop 0
    buffer_load_dwordx4 v2, s[8:11], s24 offen offset:256 lds
    v_mfma_f32_16x16x32_bf16 v[220:223], v[148:151], v[36:39], v[220:223]
    v_mfma_f32_16x16x32_bf16 v[224:227], a[12:15], v[32:35], v[224:227]
    v_mfma_f32_16x16x32_bf16 v[228:231], a[84:87], v[32:35], v[228:231]
    v_mfma_f32_16x16x32_bf16 v[232:235], a[12:15], v[36:39], v[232:235]
    s_add_u32 m0, s23, 4800
    s_nop 0
    buffer_load_dwordx4 v2, s[8:11], s24 offen offset:320 lds
    v_mfma_f32_16x16x32_bf16 v[236:239], a[84:87], v[36:39], v[236:239]
    s_waitcnt lgkmcnt(2)
    v_mfma_f32_16x16x32_bf16 v[208:211], v[80:83], v[40:43], v[208:211]
    ds_read_b128 v[32:35], v3 offset:6144
    v_mfma_f32_16x16x32_bf16 v[212:215], v[152:155], v[40:43], v[212:215]
    ds_read_b128 v[36:39], v3 offset:24576
    v_mfma_f32_16x16x32_bf16 v[216:219], v[80:83], v[44:47], v[216:219]
    s_add_u32 m0, s23, 5760
    s_nop 0
    buffer_load_dwordx4 v2, s[8:11], s24 offen offset:384 lds
    v_mfma_f32_16x16x32_bf16 v[220:223], v[152:155], v[44:47], v[220:223]
    v_mfma_f32_16x16x32_bf16 v[224:227], a[16:19], v[40:43], v[224:227]
    v_mfma_f32_16x16x32_bf16 v[228:231], a[88:91], v[40:43], v[228:231]
    v_mfma_f32_16x16x32_bf16 v[232:235], a[16:19], v[44:47], v[232:235]
    s_add_u32 m0, s23, 6720
    s_nop 0
    buffer_load_dwordx4 v2, s[8:11], s24 offen offset:448 lds
    v_mfma_f32_16x16x32_bf16 v[236:239], a[88:91], v[44:47], v[236:239]
    s_waitcnt lgkmcnt(2)
    v_mfma_f32_16x16x32_bf16 v[208:211], v[84:87], v[48:51], v[208:211]
    ds_read_b128 v[40:43], v3 offset:7168
    v_mfma_f32_16x16x32_bf16 v[212:215], v[156:159], v[48:51], v[212:215]
    ds_read_b128 v[44:47], v3 offset:25600
    v_mfma_f32_16x16x32_bf16 v[216:219], v[84:87], v[52:55], v[216:219]
    s_add_u32 m0, s23, 7680
    s_nop 0
    buffer_load_dwordx4 v2, s[8:11], s24 offen offset:512 lds
    s_add_u32 s24, s24, 147456
    v_mfma_f32_16x16x32_bf16 v[220:223], v[156:159], v[52:55], v[220:223]
    v_mfma_f32_16x16x32_bf16 v[224:227], a[20:23], v[48:51], v[224:227]
    v_mfma_f32_16x16x32_bf16 v[228:231], a[92:95], v[48:51], v[228:231]
    v_mfma_f32_16x16x32_bf16 v[232:235], a[20:23], v[52:55], v[232:235]
    v_mfma_f32_16x16x32_bf16 v[236:239], a[92:95], v[52:55], v[236:239]
    s_waitcnt lgkmcnt(2)
    v_mfma_f32_16x16x32_bf16 v[208:211], v[88:91], v[32:35], v[208:211]
    ds_read_b128 v[48:51], v3 offset:8192
    v_mfma_f32_16x16x32_bf16 v[212:215], v[160:163], v[32:35], v[212:215]
    ds_read_b128 v[52:55], v3 offset:26624
    v_mfma_f32_16x16x32_bf16 v[216:219], v[88:91], v[36:39], v[216:219]
    v_mfma_f32_16x16x32_bf16 v[220:223], v[160:163], v[36:39], v[220:223]
    v_mfma_f32_16x16x32_bf16 v[224:227], a[24:27], v[32:35], v[224:227]
    v_mfma_f32_16x16x32_bf16 v[228:231], a[96:99], v[32:35], v[228:231]
    v_mfma_f32_16x16x32_bf16 v[232:235], a[24:27], v[36:39], v[232:235]
    v_mfma_f32_16x16x32_bf16 v[236:239], a[96:99], v[36:39], v[236:239]
    s_waitcnt lgkmcnt(2)
    v_mfma_f32_16x16x32_bf16 v[208:211], v[92:95], v[40:43], v[208:211]
    ds_read_b128 v[32:35], v3 offset:9216
    v_mfma_f32_16x16x32_bf16 v[212:215], v[164:167], v[40:43], v[212:215]
    ds_read_b128 v[36:39], v3 offset:27648
    v_mfma_f32_16x16x32_bf16 v[216:219], v[92:95], v[44:47], v[216:219]
    s_add_u32 s23, s45, s95
    v_mov_b32 v4, s23
    s_mov_b64 exec, s[34:35]
    buffer_store_dword v4, off, s[4:7], s29 sc1
    buffer_store_dword v4, off, s[4:7], s29 offset:128 sc1
    s_mov_b64 exec, -1
    v_mfma_f32_16x16x32_bf16 v[220:223], v[164:167], v[44:47], v[220:223]
    v_mfma_f32_16x16x32_bf16 v[224:227], a[28:31], v[40:43], v[224:227]
    v_mfma_f32_16x16x32_bf16 v[228:231], a[100:103], v[40:43], v[228:231]
    v_mfma_f32_16x16x32_bf16 v[232:235], a[28:31], v[44:47], v[232:235]
    v_mfma_f32_16x16x32_bf16 v[236:239], a[100:103], v[44:47], v[236:239]
    s_waitcnt lgkmcnt(2)
    v_mfma_f32_16x16x32_bf16 v[208:211], v[96:99], v[48:51], v[208:211]
    ds_read_b128 v[40:43], v3 offset:10240
    v_mfma_f32_16x16x32_bf16 v[212:215], v[168:171], v[48:51], v[212:215]
    ds_read_b128 v[44:47], v3 offset:28672
    v_mfma_f32_16x16x32_bf16 v[216:219], v[96:99], v[52:55], v[216:219]
    s_cmp_lt_u32 s19, 60
    s_cbranch_scc1 lt10
    buffer_load_dwordx4 v[244:247], off, s[84:87], 0 offset:16 sc1
    buffer_load_dwordx4 v[240:243], off, s[84:87], 0 offset:32 sc1
    buffer_load_dwordx2 v[252:253], off, s[84:87], 0 offset:48 sc1
lt10:
    s_lshr_b32 s46, s19, 2
    s_cmp_eq_u32 s16, 0
    s_cselect_b32 s46, 0, s46
    s_cmp_lg_u32 s46, 2
    s_cbranch_scc1 lp10
    v_mov_b32 v244, -1
    v_mov_b32 v245, -1
    v_mov_b32 v246, -1
    v_mov_b32 v247, -1
    s_lshl_b32 s46, s19, 5
    s_add_u32 s46, s46, s17
    s_lshl_b32 s46, s46, 12
    s_mul_i32 s47, s16, 8388608
    s_add_u32 s46, s46, s47
    s_add_u32 s47, s46, 67108864
    buffer_store_dwordx4 v[244:247], v7, s[4:7], s47 offen sc1
    s_add_u32 s47, s46, 67112960
    buffer_store_dwordx4 v[244:247], v7, s[4:7], s47 offen sc1
    s_add_u32 s47, s46, 67633152
    buffer_store_dwordx4 v[244:247], v7, s[4:7], s47 offen sc1
    s_add_u32 s47, s46, 67637248
    buffer_store_dwordx4 v[244:247], v7, s[4:7], s47 offen sc1
lp10:
    s_lshl_b32 s46, s16, 6
    s_or_b32 s46, s46, s19
    s_or_b32 s47, s46, 1
    s_cmp_lg_u32 s47, 11
    s_cbranch_scc1 lq10
    v_mov_b32 v244, -1
    v_mov_b32 v245, -1
    v_mov_b32 v246, -1
    v_mov_b32 v247, -1
    s_lshl_b32 s46, s46, 18
    s_lshl_b32 s47, s17, 12
    s_add_u32 s46, s46, s47
    s_add_u32 s47, s46, 63963136
    buffer_store_dwordx4 v[244:247], v7, s[4:7], s47 offen sc1
    s_add_u32 s47, s46, 63967232
    buffer_store_dwordx4 v[244:247], v7, s[4:7], s47 offen sc1
    s_add_u32 s47, s46, 64094208
    buffer_store_dwordx4 v[244:247], v7, s[4:7], s47 offen sc1
    s_add_u32 s47, s46, 64098304
    buffer_store_dwordx4 v[244:247], v7, s[4:7], s47 offen sc1
lq10:
    v_mfma_f32_16x16x32_bf16 v[220:223], v[168:171], v[52:55], v[220:223]
    v_mfma_f32_16x16x32_bf16 v[224:227], a[32:35], v[48:51], v[224:227]
    v_mfma_f32_16x16x32_bf16 v[228:231], a[104:107], v[48:51], v[228:231]
    v_mfma_f32_16x16x32_bf16 v[232:235], a[32:35], v[52:55], v[232:235]
    v_mfma_f32_16x16x32_bf16 v[236:239], a[104:107], v[52:55], v[236:239]
    s_waitcnt lgkmcnt(2)
    v_mfma_f32_16x16x32_bf16 v[208:211], v[100:103], v[32:35], v[208:211]
    ds_read_b128 v[48:51], v3 offset:11264
    v_mfma_f32_16x16x32_bf16 v[212:215], v[172:175], v[32:35], v[212:215]
    ds_read_b128 v[52:55], v3 offset:29696
    v_mfma_f32_16x16x32_bf16 v[216:219], v[100:103], v[36:39], v[216:219]
    v_mfma_f32_16x16x32_bf16 v[220:223], v[172:175], v[36:39], v[220:223]
    v_mfma_f32_16x16x32_bf16 v[224:227], a[36:39], v[32:35], v[224:227]
    v_mfma_f32_16x16x32_bf16 v[228:231], a[108:111], v[32:35], v[228:231]
    v_mfma_f32_16x16x32_bf16 v[232:235], a[36:39], v[36:39], v[232:235]
    v_mfma_f32_16x16x32_bf16 v[236:239], a[108:111], v[36:39], v[236:239]
    s_waitcnt lgkmcnt(2)
    v_mfma_f32_16x16x32_bf16 v[208:211], v[104:107], v[40:43], v[208:211]
    ds_read_b128 v[32:35], v3 offset:12288
    v_mfma_f32_16x16x32_bf16 v[212:215], v[176:179], v[40:43], v[212:215]
    ds_read_b128 v[36:39], v3 offset:30720
    v_mfma_f32_16x16x32_bf16 v[216:219], v[104:107], v[44:47], v[216:219]
    v_mfma_f32_16x16x32_bf16 v[220:223], v[176:179], v[44:47], v[220:223]
    v_mfma_f32_16x16x32_bf16 v[224:227], a[40:43], v[40:43], v[224:227]
    v_mfma_f32_16x16x32_bf16 v[228:231], a[112:115], v[40:43], v[228:231]
    v_mfma_f32_16x16x32_bf16 v[232:235], a[40:43], v[44:47], v[232:235]
    v_mfma_f32_16x16x32_bf16 v[236:239], a[112:115], v[44:47], v[236:239]
    s_waitcnt lgkmcnt(2)
    v_mfma_f32_16x16x32_bf16 v[208:211], v[108:111], v[48:51], v[208:211]
    ds_read_b128 v[40:43], v3 offset:13312
    v_mfma_f32_16x16x32_bf16 v[212:215], v[180:183], v[48:51], v[212:215]
    ds_read_b128 v[44:47], v3 offset:31744
    v_mfma_f32_16x16x32_bf16 v[216:219], v[108:111], v[52:55], v[216:219]
    v_mfma_f32_16x16x32_bf16 v[220:223], v[180:183], v[52:55], v[220:223]
    v_mfma_f32_16x16x32_bf16 v[224:227], a[44:47], v[48:51], v[224:227]
    v_mfma_f32_16x16x32_bf16 v[228:231], a[116:119], v[48:51], v[228:231]
    v_mfma_f32_16x16x32_bf16 v[232:235], a[44:47], v[52:55], v[232:235]
    v_mfma_f32_16x16x32_bf16 v[236:239], a[116:119], v[52:55], v[236:239]
    s_waitcnt lgkmcnt(2)
    v_mfma_f32_16x16x32_bf16 v[208:211], v[112:115], v[32:35], v[208:211]
    ds_read_b128 v[48:51], v3 offset:14336
    v_mfma_f32_16x16x32_bf16 v[212:215], v[184:187], v[32:35], v[212:215]
    ds_read_b128 v[52:55], v3 offset:32768
    v_mfma_f32_16x16x32_bf16 v[216:219], v[112:115], v[36:39], v[216:219]
    v_mfma_f32_16x16x32_bf16 v[220:223], v[184:187], v[36:39], v[220:223]
    v_mfma_f32_16x16x32_bf16 v[224:227], a[48:51], v[32:35], v[224:227]
    v_mfma_f32_16x16x32_bf16 v[228:231], a[120:123], v[32:35], v[228:231]
    v_mfma_f32_16x16x32_bf16 v[232:235], a[48:51], v[36:39], v[232:235]
    v_mfma_f32_16x16x32_bf16 v[236:239], a[120:123], v[36:39], v[236:239]
    s_waitcnt lgkmcnt(2)
    v_mfma_f32_16x16x32_bf16 v[208:211], v[116:119], v[40:43], v[208:211]
    ds_read_b128 v[32:35], v3 offset:15360
    v_mfma_f32_16x16x32_bf16 v[212:215], v[188:191], v[40:43], v[212:215]
    ds_read_b128 v[36:39], v3 offset:33792
    v_mfma_f32_16x16x32_bf16 v[216:219], v[116:119], v[44:47], v[216:219]
    v_mfma_f32_16x16x32_bf16 v[220:223], v[188:191], v[44:47], v[220:223]
    v_mfma_f32_16x16x32_bf16 v[224:227], a[52:55], v[40:43], v[224:227]
    v_mfma_f32_16x16x32_bf16 v[228:231], a[124:127], v[40:43], v[228:231]
    v_mfma_f32_16x16x32_bf16 v[232:235], a[52:55], v[44:47], v[232:235]
    v_mfma_f32_16x16x32_bf16 v[236:239], a[124:127], v[44:47], v[236:239]
    s_waitcnt lgkmcnt(2)
    v_mfma_f32_16x16x32_bf16 v[208:211], v[120:123], v[48:51], v[208:211]
    ds_read_b128 v[40:43], v3 offset:16384
    v_mfma_f32_16x16x32_bf16 v[212:215], v[192:195], v[48:51], v[212:215]
    ds_read_b128 v[44:47], v3 offset:34816
    v_mfma_f32_16x16x32_bf16 v[216:219], v[120:123], v[52:55], v[216:219]
    v_mfma_f32_16x16x32_bf16 v[220:223], v[192:195], v[52:55], v[220:223]
    v_mfma_f32_16x16x32_bf16 v[224:227], a[56:59], v[48:51], v[224:227]
    v_mfma_f32_16x16x32_bf16 v[228:231], a[128:131], v[48:51], v[228:231]
    v_mfma_f32_16x16x32_bf16 v[232:235], a[56:59], v[52:55], v[232:235]
    v_mfma_f32_16x16x32_bf16 v[236:239], a[128:131], v[52:55], v[236:239]
    s_waitcnt lgkmcnt(2)
    v_mfma_f32_16x16x32_bf16 v[208:211], v[124:127], v[32:35], v[208:211]
    ds_read_b128 v[48:51], v3 offset:17408
    v_mfma_f32_16x16x32_bf16 v[212:215], v[196:199], v[32:35], v[212:215]
    ds_read_b128 v[52:55], v3 offset:35840
    v_mfma_f32_16x16x32_bf16 v[216:219], v[124:127], v[36:39], v[216:219]
    v_mfma_f32_16x16x32_bf16 v[220:223], v[196:199], v[36:39], v[220:223]
    v_mfma_f32_16x16x32_bf16 v[224:227], a[60:63], v[32:35], v[224:227]
    s_add_u32 s27, s27, 36864
    s_cmp_eq_u32 s27, 110592
    s_cselect_b32 s27, 0, s27
    v_add_u32 v3, s27, v1
    v_mfma_f32_16x16x32_bf16 v[228:231], a[132:135], v[32:35], v[228:231]
    v_mfma_f32_16x16x32_bf16 v[232:235], a[60:63], v[36:39], v[232:235]
    v_mfma_f32_16x16x32_bf16 v[236:239], a[132:135], v[36:39], v[236:239]
    s_waitcnt lgkmcnt(2)
    v_mfma_f32_16x16x32_bf16 v[208:211], v[128:131], v[40:43], v[208:211]
    ds_read_b128 v[32:35], v3 offset:0
    v_mfma_f32_16x16x32_bf16 v[212:215], v[200:203], v[40:43], v[212:215]
    ds_read_b128 v[36:39], v3 offset:18432
    v_mfma_f32_16x16x32_bf16 v[216:219], v[128:131], v[44:47], v[216:219]
    v_mfma_f32_16x16x32_bf16 v[220:223], v[200:203], v[44:47], v[220:223]
    v_mfma_f32_16x16x32_bf16 v[224:227], a[64:67], v[40:43], v[224:227]
    v_mfma_f32_16x16x32_bf16 v[228:231], a[136:139], v[40:43], v[228:231]
    v_mfma_f32_16x16x32_bf16 v[232:235], a[64:67], v[44:47], v[232:235]
    v_mfma_f32_16x16x32_bf16 v[236:239], a[136:139], v[44:47], v[236:239]
    s_waitcnt lgkmcnt(2)
    v_mfma_f32_16x16x32_bf16 v[208:211], v[132:135], v[48:51], v[208:211]
    ds_read_b128 v[40:43], v3 offset:1024
    v_mfma_f32_16x16x32_bf16 v[212:215], v[204:207], v[48:51], v[212:215]
    ds_read_b128 v[44:47], v3 offset:19456
    v_mfma_f32_16x16x32_bf16 v[216:219], v[132:135], v[52:55], v[216:219]
    v_mfma_f32_16x16x32_bf16 v[220:223], v[204:207], v[52:55], v[220:223]
    v_mfma_f32_16x16x32_bf16 v[224:227], a[68:71], v[48:51], v[224:227]
    v_mfma_f32_16x16x32_bf16 v[228:231], a[140:143], v[48:51], v[228:231]
    v_mfma_f32_16x16x32_bf16 v[232:235], a[68:71], v[52:55], v[232:235]
    v_mfma_f32_16x16x32_bf16 v[236:239], a[140:143], v[52:55], v[236:239]
    s_add_u32 s26, s26, s41
    s_waitcnt vmcnt(0)
    v_cvt_pk_bf16_f32 v8, v208, v209
    v_cvt_pk_bf16_f32 v9, v210, v211
    v_cvt_pk_bf16_f32 v10, v212, v213
    v_cvt_pk_bf16_f32 v11, v214, v215
    v_cvt_pk_bf16_f32 v12, v216, v217
    v_cvt_pk_bf16_f32 v13, v218, v219
    v_cvt_pk_bf16_f32 v14, v220, v221
    v_cvt_pk_bf16_f32 v15, v222, v223
    v_cvt_pk_bf16_f32 v16, v224, v225
    v_cvt_pk_bf16_f32 v17, v226, v227
    v_cvt_pk_bf16_f32 v18, v228, v229
    v_cvt_pk_bf16_f32 v19, v230, v231
    v_cvt_pk_bf16_f32 v20, v232, v233
    v_cvt_pk_bf16_f32 v21, v234, v235
    v_cvt_pk_bf16_f32 v22, v236, v237
    v_cvt_pk_bf16_f32 v23, v238, v239
    s_mov_b64 s[36:37], -1
    s_add_u32 s28, s26, s12
    buffer_store_dwordx4 v[8:11], v7, s[4:7], s28 offen sc1
    s_add_u32 s28, s26, s13
    buffer_store_dwordx4 v[12:15], v7, s[4:7], s28 offen sc1
    s_add_u32 s28, s26, s14
    buffer_store_dwordx4 v[16:19], v7, s[4:7], s28 offen sc1
    s_add_u32 s28, s26, s15
    buffer_store_dwordx4 v[20:23], v7, s[4:7], s28 offen sc1
    s_lshr_b32 s45, s19, 2
    s_cbranch_scc1 qk_loop_nf
    s_mov_b32 s45, 1
    s_mov_b64 s[36:37], 0
    s_waitcnt vmcnt(0)
    s_barrier
    s_add_u32 s23, s45, s95
    v_mov_b32 v4, s23
    s_mov_b64 exec, s[34:35]
    buffer_store_dword v4, off, s[4:7], s29 sc1
    buffer_store_dword v4, off, s[4:7], s29 offset:128 sc1
    s_mov_b64 exec, -1
qk_loop_nf:
    s_add_u32 s19, s19, 4
    s_cmp_lt_u32 s19, s20
    s_cbranch_scc1 qk_loop
    s_branch qk_done
qk_vloop:
    s_barrier
    s_add_u32 s22, s27, 73728
    s_sub_u32 s21, s22, 110592
    s_cselect_b32 s22, s22, s21
    s_waitcnt lgkmcnt(2)
    v_mfma_f32_16x16x32_bf16 v[208:211], v[32:35], v[64:67], 0
    ds_read_b128 v[48:51], v3 offset:2048
    v_mfma_f32_16x16x32_bf16 v[212:215], v[32:35], v[136:139], 0
    ds_read_b128 v[52:55], v3 offset:20480
    v_mfma_f32_16x16x32_bf16 v[216:219], v[36:39], v[64:67], 0
    v_mfma_f32_16x16x32_bf16 v[220:223], v[36:39], v[136:139], 0
    v_mfma_f32_16x16x32_bf16 v[224:227], v[32:35], a[0:3], 0
    v_mfma_f32_16x16x32_bf16 v[228:231], v[32:35], a[72:75], 0
    v_mfma_f32_16x16x32_bf16 v[232:235], v[36:39], a[0:3], 0
    v_mfma_f32_16x16x32_bf16 v[236:239], v[36:39], a[72:75], 0
    s_waitcnt lgkmcnt(2)
    v_mfma_f32_16x16x32_bf16 v[208:211], v[40:43], v[68:71], v[208:211]
    ds_read_b128 v[32:35], v3 offset:3072
    v_mfma_f32_16x16x32_bf16 v[212:215], v[40:43], v[140:143], v[212:215]
    ds_read_b128 v[36:39], v3 offset:21504
    v_mfma_f32_16x16x32_bf16 v[216:219], v[44:47], v[68:71], v[216:219]
    s_add_u32 s23, s22, s25
    s_add_u32 m0, s23, 0
    s_nop 0
    buffer_load_dwordx4 v2, s[8:11], s24 offen offset:0 lds
    v_mfma_f32_16x16x32_bf16 v[220:223], v[44:47], v[140:143], v[220:223]
    v_mfma_f32_16x16x32_bf16 v[224:227], v[40:43], a[4:7], v[224:227]
    v_mfma_f32_16x16x32_bf16 v[228:231], v[40:43], a[76:79], v[228:231]
    v_mfma_f32_16x16x32_bf16 v[232:235], v[44:47], a[4:7], v[232:235]
    s_add_u32 m0, s23, 960
    s_nop 0
    buffer_load_dwordx4 v2, s[8:11], s24 offen offset:64 lds
    v_mfma_f32_16x16x32_bf16 v[236:239], v[44:47], a[76:79], v[236:239]
    s_waitcnt lgkmcnt(2)
    v_mfma_f32_16x16x32_bf16 v[208:211], v[48:51], v[72:75], v[208:211]
    ds_read_b128 v[40:43], v3 offset:4096
    v_mfma_f32_16x16x32_bf16 v[212:215], v[48:51], v[144:147], v[212:215]
    ds_read_b128 v[44:47], v3 offset:22528
    v_mfma_f32_16x16x32_bf16 v[216:219], v[52:55], v[72:75], v[216:219]
    s_add_u32 m0, s23, 1920
    s_nop 0
    buffer_load_dwordx4 v2, s[8:11], s24 offen offset:128 lds
    v_mfma_f32_16x16x32_bf16 v[220:223], v[52:55], v[144:147], v[220:223]
    v_mfma_f32_16x16x32_bf16 v[224:227], v[48:51], a[8:11], v[224:227]
    v_mfma_f32_16x16x32_bf16 v[228:231], v[48:51], a[80:83], v[228:231]
    v_mfma_f32_16x16x32_bf16 v[232:235], v[52:55], a[8:11], v[232:235]
    s_add_u32 m0, s23, 2880
    s_nop 0
    buffer_load_dwordx4 v2, s[8:11], s24 offen offset:192 lds
    v_mfma_f32_16x16x32_bf16 v[236:239], v[52:55], a[80:83], v[236:239]
    s_waitcnt lgkmcnt(2)
    v_mfma_f32_16x16x32_bf16 v[208:211], v[32:35], v[76:79], v[208:211]
    ds_read_b128 v[48:51], v3 offset:5120
    v_mfma_f32_16x16x32_bf16 v[212:215], v[32:35], v[148:151], v[212:215]
    ds_read_b128 v[52:55], v3 offset:23552
    v_mfma_f32_16x16x32_bf16 v[216:219], v[36:39], v[76:79], v[216:219]
    s_add_u32 m0, s23, 3840
    s_nop 0
    buffer_load_dwordx4 v2, s[8:11], s24 offen offset:256 lds
    v_mfma_f32_16x16x32_bf16 v[220:223], v[36:39], v[148:151], v[220:223]
    v_mfma_f32_16x16x32_bf16 v[224:227], v[32:35], a[12:15], v[224:227]
    v_mfma_f32_16x16x32_bf16 v[228:231], v[32:35], a[84:87], v[228:231]
    v_mfma_f32_16x16x32_bf16 v[232:235], v[36:39], a[12:15], v[232:235]
    s_add_u32 m0, s23, 4800
    s_nop 0
    buffer_load_dwordx4 v2, s[8:11], s24 offen offset:320 lds
    v_mfma_f32_16x16x32_bf16 v[236:239], v[36:39], a[84:87], v[236:239]
    s_waitcnt lgkmcnt(2)
    v_mfma_f32_16x16x32_bf16 v[208:211], v[40:43], v[80:83], v[208:211]
    ds_read_b128 v[32:35], v3 offset:6144
    v_mfma_f32_16x16x32_bf16 v[212:215], v[40:43], v[152:155], v[212:215]
    ds_read_b128 v[36:39], v3 offset:24576
    v_mfma_f32_16x16x32_bf16 v[216:219], v[44:47], v[80:83], v[216:219]
    s_add_u32 m0, s23, 5760
    s_nop 0
    buffer_load_dwordx4 v2, s[8:11], s24 offen offset:384 lds
    v_mfma_f32_16x16x32_bf16 v[220:223], v[44:47], v[152:155], v[220:223]
    v_mfma_f32_16x16x32_bf16 v[224:227], v[40:43], a[16:19], v[224:227]
    v_mfma_f32_16x16x32_bf16 v[228:231], v[40:43], a[88:91], v[228:231]
    v_mfma_f32_16x16x32_bf16 v[232:235], v[44:47], a[16:19], v[232:235]
    s_add_u32 m0, s23, 6720
    s_nop 0
    buffer_load_dwordx4 v2, s[8:11], s24 offen offset:448 lds
    v_mfma_f32_16x16x32_bf16 v[236:239], v[44:47], a[88:91], v[236:239]
    s_waitcnt lgkmcnt(2)
    v_mfma_f32_16x16x32_bf16 v[208:211], v[48:51], v[84:87], v[208:211]
    ds_read_b128 v[40:43], v3 offset:7168
    v_mfma_f32_16x16x32_bf16 v[212:215], v[48:51], v[156:159], v[212:215]
    ds_read_b128 v[44:47], v3 offset:25600
    v_mfma_f32_16x16x32_bf16 v[216:219], v[52:55], v[84:87], v[216:219]
    s_add_u32 m0, s23, 7680
    s_nop 0
    buffer_load_dwordx4 v2, s[8:11], s24 offen offset:512 lds
    s_add_u32 s24, s24, 147456
    v_mfma_f32_16x16x32_bf16 v[220:223], v[52:55], v[156:159], v[220:223]
    v_mfma_f32_16x16x32_bf16 v[224:227], v[48:51], a[20:23], v[224:227]
    v_mfma_f32_16x16x32_bf16 v[228:231], v[48:51], a[92:95], v[228:231]
    v_mfma_f32_16x16x32_bf16 v[232:235], v[52:55], a[20:23], v[232:235]
    v_mfma_f32_16x16x32_bf16 v[236:239], v[52:55], a[92:95], v[236:239]
    s_waitcnt lgkmcnt(2)
    v_mfma_f32_16x16x32_bf16 v[208:211], v[32:35], v[88:91], v[208:211]
    ds_read_b128 v[48:51], v3 offset:8192
    v_mfma_f32_16x16x32_bf16 v[212:215], v[32:35], v[160:163], v[212:215]
    ds_read_b128 v[52:55], v3 offset:26624
    v_mfma_f32_16x16x32_bf16 v[216:219], v[36:39], v[88:91], v[216:219]
    v_mfma_f32_16x16x32_bf16 v[220:223], v[36:39], v[160:163], v[220:223]
    v_mfma_f32_16x16x32_bf16 v[224:227], v[32:35], a[24:27], v[224:227]
    v_mfma_f32_16x16x32_bf16 v[228:231], v[32:35], a[96:99], v[228:231]
    v_mfma_f32_16x16x32_bf16 v[232:235], v[36:39], a[24:27], v[232:235]
    v_mfma_f32_16x16x32_bf16 v[236:239], v[36:39], a[96:99], v[236:239]
    s_waitcnt lgkmcnt(2)
    v_mfma_f32_16x16x32_bf16 v[208:211], v[40:43], v[92:95], v[208:211]
    ds_read_b128 v[32:35], v3 offset:9216
    v_mfma_f32_16x16x32_bf16 v[212:215], v[40:43], v[164:167], v[212:215]
    ds_read_b128 v[36:39], v3 offset:27648
    v_mfma_f32_16x16x32_bf16 v[216:219], v[44:47], v[92:95], v[216:219]
    s_add_u32 s23, s45, s95
    v_mov_b32 v4, s23
    s_mov_b64 exec, s[34:35]
    buffer_store_dword v4, off, s[4:7], s29 sc1
    buffer_store_dword v4, off, s[4:7], s29 offset:128 sc1
    s_mov_b64 exec, -1
    v_mfma_f32_16x16x32_bf16 v[220:223], v[44:47], v[164:167], v[220:223]
    v_mfma_f32_16x16x32_bf16 v[224:227], v[40:43], a[28:31], v[224:227]
    v_mfma_f32_16x16x32_bf16 v[228:231], v[40:43], a[100:103], v[228:231]
    v_mfma_f32_16x16x32_bf16 v[232:235], v[44:47], a[28:31], v[232:235]
    v_mfma_f32_16x16x32_bf16 v[236:239], v[44:47], a[100:103], v[236:239]
    s_waitcnt lgkmcnt(2)
    v_mfma_f32_16x16x32_bf16 v[208:211], v[48:51], v[96:99], v[208:211]
    ds_read_b128 v[40:43], v3 offset:10240
    v_mfma_f32_16x16x32_bf16 v[212:215], v[48:51], v[168:171], v[212:215]
    ds_read_b128 v[44:47], v3 offset:28672
    v_mfma_f32_16x16x32_bf16 v[216:219], v[52:55], v[96:99], v[216:219]
    s_cmp_lt_u32 s19, 60
    s_cbranch_scc1 lt11
    buffer_load_dwordx4 v[244:247], off, s[84:87], 0 offset:16 sc1
    buffer_load_dwordx4 v[240:243], off, s[84:87], 0 offset:32 sc1
    buffer_load_dwordx2 v[252:253], off, s[84:87], 0 offset:48 sc1
lt11:
    s_lshr_b32 s46, s19, 2
    s_cmp_eq_u32 s16, 0
    s_cselect_b32 s46, 0, s46
    s_cmp_lg_u32 s46, 2
    s_cbranch_scc1 lp11
    v_mov_b32 v244, -1
    v_mov_b32 v245, -1
    v_mov_b32 v246, -1
    v_mov_b32 v247, -1
    s_lshl_b32 s46, s19, 5
    s_add_u32 s46, s46, s17
    s_lshl_b32 s46, s46, 12
    s_mul_i32 s47, s16, 8388608
    s_add_u32 s46, s46, s47
    s_add_u32 s47, s46, 67108864
    buffer_store_dwordx4 v[244:247], v7, s[4:7], s47 offen sc1
    s_add_u32 s47, s46, 67112960
    buffer_store_dwordx4 v[244:247], v7, s[4:7], s47 offen sc1
    s_add_u32 s47, s46, 67633152
    buffer_store_dwordx4 v[244:247], v7, s[4:7], s47 offen sc1
    s_add_u32 s47, s46, 67637248
    buffer_store_dwordx4 v[244:247], v7, s[4:7], s47 offen sc1
lp11:
    s_lshl_b32 s46, s16, 6
    s_or_b32 s46, s46, s19
    s_or_b32 s47, s46, 1
    s_cmp_lg_u32 s47, 11
    s_cbranch_scc1 lq11
    v_mov_b32 v244, -1
    v_mov_b32 v245, -1
    v_mov_b32 v246, -1
    v_mov_b32 v247, -1
    s_lshl_b32 s46, s46, 18
    s_lshl_b32 s47, s17, 12
    s_add_u32 s46, s46, s47
    s_add_u32 s47, s46, 63963136
    buffer_store_dwordx4 v[244:247], v7, s[4:7], s47 offen sc1
    s_add_u32 s47, s46, 63967232
    buffer_store_dwordx4 v[244:247], v7, s[4:7], s47 offen sc1
    s_add_u32 s47, s46, 64094208
    buffer_store_dwordx4 v[244:247], v7, s[4:7], s47 offen sc1
    s_add_u32 s47, s46, 64098304
    buffer_store_dwordx4 v[244:247], v7, s[4:7], s47 offen sc1
lq11:
    v_mfma_f32_16x16x32_bf16 v[220:223], v[52:55], v[168:171], v[220:223]
    v_mfma_f32_16x16x32_bf16 v[224:227], v[48:51], a[32:35], v[224:227]
    v_mfma_f32_16x16x32_bf16 v[228:231], v[48:51], a[104:107], v[228:231]
    v_mfma_f32_16x16x32_bf16 v[232:235], v[52:55], a[32:35], v[232:235]
    v_mfma_f32_16x16x32_bf16 v[236:239], v[52:55], a[104:107], v[236:239]
    s_waitcnt lgkmcnt(2)
    v_mfma_f32_16x16x32_bf16 v[208:211], v[32:35], v[100:103], v[208:211]
    ds_read_b128 v[48:51], v3 offset:11264
    v_mfma_f32_16x16x32_bf16 v[212:215], v[32:35], v[172:175], v[212:215]
    ds_read_b128 v[52:55], v3 offset:29696
    v_mfma_f32_16x16x32_bf16 v[216:219], v[36:39], v[100:103], v[216:219]
    v_mfma_f32_16x16x32_bf16 v[220:223], v[36:39], v[172:175], v[220:223]
    v_mfma_f32_16x16x32_bf16 v[224:227], v[32:35], a[36:39], v[224:227]
    v_mfma_f32_16x16x32_bf16 v[228:231], v[32:35], a[108:111], v[228:231]
    v_mfma_f32_16x16x32_bf16 v[232:235], v[36:39], a[36:39], v[232:235]
    v_mfma_f32_16x16x32_bf16 v[236:239], v[36:39], a[108:111], v[236:239]
    s_waitcnt lgkmcnt(2)
    v_mfma_f32_16x16x32_bf16 v[208:211], v[40:43], v[104:107], v[208:211]
    ds_read_b128 v[32:35], v3 offset:12288
    v_mfma_f32_16x16x32_bf16 v[212:215], v[40:43], v[176:179], v[212:215]
    ds_read_b128 v[36:39], v3 offset:30720
    v_mfma_f32_16x16x32_bf16 v[216:219], v[44:47], v[104:107], v[216:219]
    v_mfma_f32_16x16x32_bf16 v[220:223], v[44:47], v[176:179], v[220:223]
    v_mfma_f32_16x16x32_bf16 v[224:227], v[40:43], a[40:43], v[224:227]
    v_mfma_f32_16x16x32_bf16 v[228:231], v[40:43], a[112:115], v[228:231]
    v_mfma_f32_16x16x32_bf16 v[232:235], v[44:47], a[40:43], v[232:235]
    v_mfma_f32_16x16x32_bf16 v[236:239], v[44:47], a[112:115], v[236:239]
    s_waitcnt lgkmcnt(2)
    v_mfma_f32_16x16x32_bf16 v[208:211], v[48:51], v[108:111], v[208:211]
    ds_read_b128 v[40:43], v3 offset:13312
    v_mfma_f32_16x16x32_bf16 v[212:215], v[48:51], v[180:183], v[212:215]
    ds_read_b128 v[44:47], v3 offset:31744
    v_mfma_f32_16x16x32_bf16 v[216:219], v[52:55], v[108:111], v[216:219]
    v_mfma_f32_16x16x32_bf16 v[220:223], v[52:55], v[180:183], v[220:223]
    v_mfma_f32_16x16x32_bf16 v[224:227], v[48:51], a[44:47], v[224:227]
    v_mfma_f32_16x16x32_bf16 v[228:231], v[48:51], a[116:119], v[228:231]
    v_mfma_f32_16x16x32_bf16 v[232:235], v[52:55], a[44:47], v[232:235]
    v_mfma_f32_16x16x32_bf16 v[236:239], v[52:55], a[116:119], v[236:239]
    s_waitcnt lgkmcnt(2)
    v_mfma_f32_16x16x32_bf16 v[208:211], v[32:35], v[112:115], v[208:211]
    ds_read_b128 v[48:51], v3 offset:14336
    v_mfma_f32_16x16x32_bf16 v[212:215], v[32:35], v[184:187], v[212:215]
    ds_read_b128 v[52:55], v3 offset:32768
    v_mfma_f32_16x16x32_bf16 v[216:219], v[36:39], v[112:115], v[216:219]
    v_mfma_f32_16x16x32_bf16 v[220:223], v[36:39], v[184:187], v[220:223]
    v_mfma_f32_16x16x32_bf16 v[224:227], v[32:35], a[48:51], v[224:227]
    v_mfma_f32_16x16x32_bf16 v[228:231], v[32:35], a[120:123], v[228:231]
    v_mfma_f32_16x16x32_bf16 v[232:235], v[36:39], a[48:51], v[232:235]
    v_mfma_f32_16x16x32_bf16 v[236:239], v[36:39], a[120:123], v[236:239]
    s_waitcnt lgkmcnt(2)
    v_mfma_f32_16x16x32_bf16 v[208:211], v[40:43], v[116:119], v[208:211]
    ds_read_b128 v[32:35], v3 offset:15360
    v_mfma_f32_16x16x32_bf16 v[212:215], v[40:43], v[188:191], v[212:215]
    ds_read_b128 v[36:39], v3 offset:33792
    v_mfma_f32_16x16x32_bf16 v[216:219], v[44:47], v[116:119], v[216:219]
    v_mfma_f32_16x16x32_bf16 v[220:223], v[44:47], v[188:191], v[220:223]
    v_mfma_f32_16x16x32_bf16 v[224:227], v[40:43], a[52:55], v[224:227]
    v_mfma_f32_16x16x32_bf16 v[228:231], v[40:43], a[124:127], v[228:231]
    v_mfma_f32_16x16x32_bf16 v[232:235], v[44:47], a[52:55], v[232:235]
    v_mfma_f32_16x16x32_bf16 v[236:239], v[44:47], a[124:127], v[236:239]
    s_waitcnt lgkmcnt(2)
    v_mfma_f32_16x16x32_bf16 v[208:211], v[48:51], v[120:123], v[208:211]
    ds_read_b128 v[40:43], v3 offset:16384
    v_mfma_f32_16x16x32_bf16 v[212:215], v[48:51], v[192:195], v[212:215]
    ds_read_b128 v[44:47], v3 offset:34816
    v_mfma_f32_16x16x32_bf16 v[216:219], v[52:55], v[120:123], v[216:219]
    v_mfma_f32_16x16x32_bf16 v[220:223], v[52:55], v[192:195], v[220:223]
    v_mfma_f32_16x16x32_bf16 v[224:227], v[48:51], a[56:59], v[224:227]
    v_mfma_f32_16x16x32_bf16 v[228:231], v[48:51], a[128:131], v[228:231]
    v_mfma_f32_16x16x32_bf16 v[232:235], v[52:55], a[56:59], v[232:235]
    v_mfma_f32_16x16x32_bf16 v[236:239], v[52:55], a[128:131], v[236:239]
    s_waitcnt lgkmcnt(2)
    v_mfma_f32_16x16x32_bf16 v[208:211], v[32:35], v[124:127], v[208:211]
    ds_read_b128 v[48:51], v3 offset:17408
    v_mfma_f32_16x16x32_bf16 v[212:215], v[32:35], v[196:199], v[212:215]
    ds_read_b128 v[52:55], v3 offset:35840
    v_mfma_f32_16x16x32_bf16 v[216:219], v[36:39], v[124:127], v[216:219]
    v_mfma_f32_16x16x32_bf16 v[220:223], v[36:39], v[196:199], v[220:223]
    v_mfma_f32_16x16x32_bf16 v[224:227], v[32:35], a[60:63], v[224:227]
    s_add_u32 s27, s27, 36864
    s_cmp_eq_u32 s27, 110592
    s_cselect_b32 s27, 0, s27
    v_add_u32 v3, s27, v1
    v_mfma_f32_16x16x32_bf16 v[228:231], v[32:35], a[132:135], v[228:231]
    v_mfma_f32_16x16x32_bf16 v[232:235], v[36:39], a[60:63], v[232:235]
    v_mfma_f32_16x16x32_bf16 v[236:239], v[36:39], a[132:135], v[236:239]
    s_waitcnt lgkmcnt(2)
    v_mfma_f32_16x16x32_bf16 v[208:211], v[40:43], v[128:131], v[208:211]
    ds_read_b128 v[32:35], v3 offset:0
    v_mfma_f32_16x16x32_bf16 v[212:215], v[40:43], v[200:203], v[212:215]
    ds_read_b128 v[36:39], v3 offset:18432
    v_mfma_f32_16x16x32_bf16 v[216:219], v[44:47], v[128:131], v[216:219]
    v_mfma_f32_16x16x32_bf16 v[220:223], v[44:47], v[200:203], v[220:223]
    v_mfma_f32_16x16x32_bf16 v[224:227], v[40:43], a[64:67], v[224:227]
    v_mfma_f32_16x16x32_bf16 v[228:231], v[40:43], a[136:139], v[228:231]
    v_mfma_f32_16x16x32_bf16 v[232:235], v[44:47], a[64:67], v[232:235]
    v_mfma_f32_16x16x32_bf16 v[236:239], v[44:47], a[136:139], v[236:239]
    s_waitcnt lgkmcnt(2)
    v_mfma_f32_16x16x32_bf16 v[208:211], v[48:51], v[132:135], v[208:211]
    ds_read_b128 v[40:43], v3 offset:1024
    v_mfma_f32_16x16x32_bf16 v[212:215], v[48:51], v[204:207], v[212:215]
    ds_read_b128 v[44:47], v3 offset:19456
    v_mfma_f32_16x16x32_bf16 v[216:219], v[52:55], v[132:135], v[216:219]
    v_mfma_f32_16x16x32_bf16 v[220:223], v[52:55], v[204:207], v[220:223]
    v_mfma_f32_16x16x32_bf16 v[224:227], v[48:51], a[68:71], v[224:227]
    v_mfma_f32_16x16x32_bf16 v[228:231], v[48:51], a[140:143], v[228:231]
    v_mfma_f32_16x16x32_bf16 v[232:235], v[52:55], a[68:71], v[232:235]
    v_mfma_f32_16x16x32_bf16 v[236:239], v[52:55], a[140:143], v[236:239]
    s_add_u32 s26, s26, s41
    s_waitcnt vmcnt(0)
    v_cvt_pk_bf16_f32 v8, v208, v209
    v_cvt_pk_bf16_f32 v9, v210, v211
    v_cvt_pk_bf16_f32 v10, v216, v217
    v_cvt_pk_bf16_f32 v11, v218, v219
    v_cvt_pk_bf16_f32 v12, v212, v213
    v_cvt_pk_bf16_f32 v13, v214, v215
    v_cvt_pk_bf16_f32 v14, v220, v221
    v_cvt_pk_bf16_f32 v15, v222, v223
    v_cvt_pk_bf16_f32 v16, v224, v225
    v_cvt_pk_bf16_f32 v17, v226, v227
    v_cvt_pk_bf16_f32 v18, v232, v233
    v_cvt_pk_bf16_f32 v19, v234, v235
    v_cvt_pk_bf16_f32 v20, v228, v229
    v_cvt_pk_bf16_f32 v21, v230, v231
    v_cvt_pk_bf16_f32 v22, v236, v237
    v_cvt_pk_bf16_f32 v23, v238, v239
    s_mov_b64 s[36:37], -1
    s_add_u32 s28, s26, s12
    buffer_store_dwordx4 v[8:11], v7, s[4:7], s28 offen sc1
    s_add_u32 s28, s26, s13
    buffer_store_dwordx4 v[12:15], v7, s[4:7], s28 offen sc1
    s_add_u32 s28, s26, s14
    buffer_store_dwordx4 v[16:19], v7, s[4:7], s28 offen sc1
    s_add_u32 s28, s26, s15
    buffer_store_dwordx4 v[20:23], v7, s[4:7], s28 offen sc1
    s_lshr_b32 s45, s19, 2
    s_cbranch_scc1 qk_vloop_nf
    s_mov_b32 s45, 1
    s_mov_b64 s[36:37], 0
    s_waitcnt vmcnt(0)
    s_barrier
    s_add_u32 s23, s45, s95
    v_mov_b32 v4, s23
    s_mov_b64 exec, s[34:35]
    buffer_store_dword v4, off, s[4:7], s29 sc1
    buffer_store_dword v4, off, s[4:7], s29 offset:128 sc1
    s_mov_b64 exec, -1
qk_vloop_nf:
    s_add_u32 s19, s19, 4
    s_cmp_lt_u32 s19, s20
    s_cbranch_scc1 qk_vloop
qk_done:
    s_waitcnt vmcnt(0) lgkmcnt(0)
    s_barrier
    s_mov_b32 s45, 16
    s_add_u32 s23, s45, s95
    v_mov_b32 v4, s23
    s_mov_b64 exec, s[34:35]
    buffer_store_dword v4, off, s[4:7], s29 sc1
    buffer_store_dword v4, off, s[4:7], s29 offset:128 sc1
    s_mov_b64 exec, -1
    s_cmp_lt_i32 s33, 0
    s_cbranch_scc1 L_memkv
    v_max3_u32 v248, v240, v241, v242
    v_max3_u32 v248, v248, v243, v252
    v_max_u32 v248, v248, v253
    v_min3_u32 v240, v240, v241, v242
    v_min3_u32 v240, v240, v243, v252
    v_min_u32 v240, v240, v253
    v_lshl_add_u32 v248, v248, 16, v240
    v_readfirstlane_b32 s40, v245
    v_readfirstlane_b32 s41, v246
    v_readfirstlane_b32 s42, v247
    v_readfirstlane_b32 s43, v248
    s_cmp_ge_u32 s40, 160
    s_cselect_b32 s43, s43, 0
    s_cmp_ge_u32 s41, 1
    s_cselect_b32 s43, s43, 0
    s_cmp_eq_u32 s42, 1
    s_cselect_b32 s43, s43, 0
    s_cmp_eq_u32 s93, 1000
    s_cselect_b32 s43, s43, 0
    s_mov_b32 s93, 999
    v_mov_b32 v250, s43
    v_mov_b32 v251, 163832
    s_mov_b64 exec, s[34:35]
    ds_write_b32 v251, v250
    s_mov_b64 exec, -1
    s_waitcnt lgkmcnt(0)
    s_barrier
    ds_read_b32 v252, v251
    s_waitcnt lgkmcnt(0)
    v_readfirstlane_b32 s43, v252
    s_barrier
    s_cmp_lg_u32 s43, 2097184
    s_cbranch_scc1 L_qkv_next
    s_mov_b32 s45, s33
    s_mov_b32 s93, 500
    s_branch L_phase2b
L_memkv:
    v_and_b32 v4, 63, v0
    v_and_b32 v2, 7, v4
    v_lshrrev_b32 v5, 4, v4
    v_lshl_add_u32 v2, v5, 3, v2
    v_lshlrev_b32 v2, 4, v2
    v_bfe_u32 v3, v4, 3, 1
    v_mul_u32_u24 v5, 9216, v3
    v_add_u32 v2, v2, v5
    v_mov_b32 v240, 0x05040100
    v_mov_b32 v241, 0x07060302
    v_lshrrev_b32 v5, 5, v4
    v_and_b32 v1, 0xdff, v7
    s_cmp_eq_u32 s16, 2
    s_cbranch_scc1 mk_isv
    v_mov_b32 v5, v3
    v_or_b32 v1, 128, v7
mk_isv:
    v_lshl_add_u32 v1, v5, 17, v1
    s_mov_b32 s28, 0
    s_mov_b32 s19, 2
    s_mov_b32 s24, 138412032
    s_lshl_b32 s26, s17, 12
    s_mov_b32 s21, 69206016
    s_cmp_eq_u32 s16, 2
    s_cselect_b32 s21, 77594624, s21
    s_add_u32 s26, s26, s21
    s_lshl_b32 s29, s17, 7
    s_lshl_b32 s21, s16, 2
    s_add_u32 s29, s29, s21
    s_add_u32 s29, s29, 125829164
mk_loop:
    s_cmp_lg_u32 s18, 0
    s_cbranch_scc1 mk_go
    s_cmp_le_u32 s19, s28
    s_cbranch_scc1 mk_go
    s_mov_b32 s23, 125853696
    s_mov_b32 s21, 4194304
mk_wait:
    buffer_load_dword v4, off, s[4:7], s23 sc1
    s_sub_u32 s21, s21, 1
    s_cbranch_scc1 mk_go
    s_waitcnt vmcnt(0)
    v_readfirstlane_b32 s28, v4
    s_nop 0
    s_sub_u32 s28, s28, s95
    s_cmp_gt_u32 s28, 64
    s_cselect_b32 s28, 0, s28
    s_cmp_le_u32 s19, s28
    s_cbranch_scc1 mk_go
    s_sleep 4
    s_branch mk_wait
mk_go:
    s_barrier
    s_add_u32 s21, s24, 4096
    s_add_u32 s23, s24, 8192
    buffer_load_dwordx4 v[24:27], v2, s[4:7], s24 offen offset:0 sc1
    buffer_load_dwordx4 v[28:31], v2, s[4:7], s24 offen offset:512 sc1
    buffer_load_dwordx4 v[32:35], v2, s[4:7], s21 offen offset:0 sc1
    buffer_load_dwordx4 v[36:39], v2, s[4:7], s21 offen offset:512 sc1
    buffer_load_dwordx4 v[40:43], v2, s[4:7], s24 offen offset:1024 sc1
    buffer_load_dwordx4 v[44:47], v2, s[4:7], s24 offen offset:1536 sc1
    buffer_load_dwordx4 v[48:51], v2, s[4:7], s21 offen offset:1024 sc1
    buffer_load_dwordx4 v[52:55], v2, s[4:7], s21 offen offset:1536 sc1
    buffer_load_dwordx4 v[56:59], v2, s[4:7], s24 offen offset:2048 sc1
    buffer_load_dwordx4 v[60:63], v2, s[4:7], s24 offen offset:2560 sc1
    buffer_load_dwordx4 v[208:211], v2, s[4:7], s21 offen offset:2048 sc1
    buffer_load_dwordx4 v[212:215], v2, s[4:7], s21 offen offset:2560 sc1
    buffer_load_dwordx4 v[216:219], v2, s[4:7], s24 offen offset:3072 sc1
    buffer_load_dwordx4 v[220:223], v2, s[4:7], s24 offen offset:3584 sc1
    buffer_load_dwordx4 v[224:227], v2, s[4:7], s21 offen offset:3072 sc1
    buffer_load_dwordx4 v[228:231], v2, s[4:7], s21 offen offset:3584 sc1
    buffer_load_dwordx4 v[232:235], v2, s[4:7], s23 offen offset:0 sc1
    buffer_load_dwordx4 v[236:239], v2, s[4:7], s23 offen offset:512 sc1
    s_add_u32 s24, s24, 18432
    s_cmp_eq_u32 s16, 2
    s_cbranch_scc1 mk_v
    s_waitcnt vmcnt(17)
    s_waitcnt vmcnt(16)
    v_mfma_f32_16x16x32_bf16 v[8:11], v[64:67], v[24:27], 0
    v_mfma_f32_16x16x32_bf16 v[12:15], v[136:139], v[24:27], 0
    v_mfma_f32_16x16x32_bf16 v[16:19], a[0:3], v[24:27], 0
    v_mfma_f32_16x16x32_bf16 v[20:23], a[72:75], v[24:27], 0
    s_waitcnt vmcnt(15)
    v_mfma_f32_16x16x32_bf16 v[8:11], v[68:71], v[28:31], v[8:11]
    v_mfma_f32_16x16x32_bf16 v[12:15], v[140:143], v[28:31], v[12:15]
    v_mfma_f32_16x16x32_bf16 v[16:19], a[4:7], v[28:31], v[16:19]
    v_mfma_f32_16x16x32_bf16 v[20:23], a[76:79], v[28:31], v[20:23]
    s_waitcnt vmcnt(14)
    v_mfma_f32_16x16x32_bf16 v[8:11], v[72:75], v[32:35], v[8:11]
    v_mfma_f32_16x16x32_bf16 v[12:15], v[144:147], v[32:35], v[12:15]
    v_mfma_f32_16x16x32_bf16 v[16:19], a[8:11], v[32:35], v[16:19]
    v_mfma_f32_16x16x32_bf16 v[20:23], a[80:83], v[32:35], v[20:23]
    s_waitcnt vmcnt(13)
    v_mfma_f32_16x16x32_bf16 v[8:11], v[76:79], v[36:39], v[8:11]
    v_mfma_f32_16x16x32_bf16 v[12:15], v[148:151], v[36:39], v[12:15]
    v_mfma_f32_16x16x32_bf16 v[16:19], a[12:15], v[36:39], v[16:19]
    v_mfma_f32_16x16x32_bf16 v[20:23], a[84:87], v[36:39], v[20:23]
    s_waitcnt vmcnt(12)
    v_mfma_f32_16x16x32_bf16 v[8:11], v[80:83], v[40:43], v[8:11]
    v_mfma_f32_16x16x32_bf16 v[12:15], v[152:155], v[40:43], v[12:15]
    v_mfma_f32_16x16x32_bf16 v[16:19], a[16:19], v[40:43], v[16:19]
    v_mfma_f32_16x16x32_bf16 v[20:23], a[88:91], v[40:43], v[20:23]
    s_waitcnt vmcnt(11)
    v_mfma_f32_16x16x32_bf16 v[8:11], v[84:87], v[44:47], v[8:11]
    v_mfma_f32_16x16x32_bf16 v[12:15], v[156:159], v[44:47], v[12:15]
    v_mfma_f32_16x16x32_bf16 v[16:19], a[20:23], v[44:47], v[16:19]
    v_mfma_f32_16x16x32_bf16 v[20:23], a[92:95], v[44:47], v[20:23]
    s_waitcnt vmcnt(10)
    v_mfma_f32_16x16x32_bf16 v[8:11], v[88:91], v[48:51], v[8:11]
    v_mfma_f32_16x16x32_bf16 v[12:15], v[160:163], v[48:51], v[12:15]
    v_mfma_f32_16x16x32_bf16 v[16:19], a[24:27], v[48:51], v[16:19]
    v_mfma_f32_16x16x32_bf16 v[20:23], a[96:99], v[48:51], v[20:23]
    s_waitcnt vmcnt(9)
    v_mfma_f32_16x16x32_bf16 v[8:11], v[92:95], v[52:55], v[8:11]
    v_mfma_f32_16x16x32_bf16 v[12:15], v[164:167], v[52:55], v[12:15]
    v_mfma_f32_16x16x32_bf16 v[16:19], a[28:31], v[52:55], v[16:19]
    v_mfma_f32_16x16x32_bf16 v[20:23], a[100:103], v[52:55], v[20:23]
    s_waitcnt vmcnt(8)
    v_mfma_f32_16x16x32_bf16 v[8:11], v[96:99], v[56:59], v[8:11]
    v_mfma_f32_16x16x32_bf16 v[12:15], v[168:171], v[56:59], v[12:15]
    v_mfma_f32_16x16x32_bf16 v[16:19], a[32:35], v[56:59], v[16:19]
    v_mfma_f32_16x16x32_bf16 v[20:23], a[104:107], v[56:59], v[20:23]
    s_waitcnt vmcnt(7)
    v_mfma_f32_16x16x32_bf16 v[8:11], v[100:103], v[60:63], v[8:11]
    v_mfma_f32_16x16x32_bf16 v[12:15], v[172:175], v[60:63], v[12:15]
    v_mfma_f32_16x16x32_bf16 v[16:19], a[36:39], v[60:63], v[16:19]
    v_mfma_f32_16x16x32_bf16 v[20:23], a[108:111], v[60:63], v[20:23]
    s_waitcnt vmcnt(6)
    v_mfma_f32_16x16x32_bf16 v[8:11], v[104:107], v[208:211], v[8:11]
    v_mfma_f32_16x16x32_bf16 v[12:15], v[176:179], v[208:211], v[12:15]
    v_mfma_f32_16x16x32_bf16 v[16:19], a[40:43], v[208:211], v[16:19]
    v_mfma_f32_16x16x32_bf16 v[20:23], a[112:115], v[208:211], v[20:23]
    s_waitcnt vmcnt(5)
    v_mfma_f32_16x16x32_bf16 v[8:11], v[108:111], v[212:215], v[8:11]
    v_mfma_f32_16x16x32_bf16 v[12:15], v[180:183], v[212:215], v[12:15]
    v_mfma_f32_16x16x32_bf16 v[16:19], a[44:47], v[212:215], v[16:19]
    v_mfma_f32_16x16x32_bf16 v[20:23], a[116:119], v[212:215], v[20:23]
    s_waitcnt vmcnt(4)
    v_mfma_f32_16x16x32_bf16 v[8:11], v[112:115], v[216:219], v[8:11]
    v_mfma_f32_16x16x32_bf16 v[12:15], v[184:187], v[216:219], v[12:15]
    v_mfma_f32_16x16x32_bf16 v[16:19], a[48:51], v[216:219], v[16:19]
    v_mfma_f32_16x16x32_bf16 v[20:23], a[120:123], v[216:219], v[20:23]
    s_waitcnt vmcnt(3)
    v_mfma_f32_16x16x32_bf16 v[8:11], v[116:119], v[220:223], v[8:11]
    v_mfma_f32_16x16x32_bf16 v[12:15], v[188:191], v[220:223], v[12:15]
    v_mfma_f32_16x16x32_bf16 v[16:19], a[52:55], v[220:223], v[16:19]
    v_mfma_f32_16x16x32_bf16 v[20:23], a[124:127], v[220:223], v[20:23]
    s_waitcnt vmcnt(2)
    v_mfma_f32_16x16x32_bf16 v[8:11], v[120:123], v[224:227], v[8:11]
    v_mfma_f32_16x16x32_bf16 v[12:15], v[192:195], v[224:227], v[12:15]
    v_mfma_f32_16x16x32_bf16 v[16:19], a[56:59], v[224:227], v[16:19]
    v_mfma_f32_16x16x32_bf16 v[20:23], a[128:131], v[224:227], v[20:23]
    s_waitcnt vmcnt(1)
    v_mfma_f32_16x16x32_bf16 v[8:11], v[124:127], v[228:231], v[8:11]
    v_mfma_f32_16x16x32_bf16 v[12:15], v[196:199], v[228:231], v[12:15]
    v_mfma_f32_16x16x32_bf16 v[16:19], a[60:63], v[228:231], v[16:19]
    v_mfma_f32_16x16x32_bf16 v[20:23], a[132:135], v[228:231], v[20:23]
    s_waitcnt vmcnt(0)
    v_mfma_f32_16x16x32_bf16 v[8:11], v[128:131], v[232:235], v[8:11]
    v_mfma_f32_16x16x32_bf16 v[12:15], v[200:203], v[232:235], v[12:15]
    v_mfma_f32_16x16x32_bf16 v[16:19], a[64:67], v[232:235], v[16:19]
    v_mfma_f32_16x16x32_bf16 v[20:23], a[136:139], v[232:235], v[20:23]
    v_mfma_f32_16x16x32_bf16 v[8:11], v[132:135], v[236:239], v[8:11]
    v_mfma_f32_16x16x32_bf16 v[12:15], v[204:207], v[236:239], v[12:15]
    v_mfma_f32_16x16x32_bf16 v[16:19], a[68:71], v[236:239], v[16:19]
    v_mfma_f32_16x16x32_bf16 v[20:23], a[140:143], v[236:239], v[20:23]
    s_nop 7
    s_branch mk_st
mk_v:
    s_waitcnt vmcnt(17)
    s_waitcnt vmcnt(16)
    v_mfma_f32_16x16x32_bf16 v[8:11], v[24:27], v[64:67], 0
    v_mfma_f32_16x16x32_bf16 v[12:15], v[24:27], v[136:139], 0
    v_mfma_f32_16x16x32_bf16 v[16:19], v[24:27], a[0:3], 0
    v_mfma_f32_16x16x32_bf16 v[20:23], v[24:27], a[72:75], 0
    s_waitcnt vmcnt(15)
    v_mfma_f32_16x16x32_bf16 v[8:11], v[28:31], v[68:71], v[8:11]
    v_mfma_f32_16x16x32_bf16 v[12:15], v[28:31], v[140:143], v[12:15]
    v_mfma_f32_16x16x32_bf16 v[16:19], v[28:31], a[4:7], v[16:19]
    v_mfma_f32_16x16x32_bf16 v[20:23], v[28:31], a[76:79], v[20:23]
    s_waitcnt vmcnt(14)
    v_mfma_f32_16x16x32_bf16 v[8:11], v[32:35], v[72:75], v[8:11]
    v_mfma_f32_16x16x32_bf16 v[12:15], v[32:35], v[144:147], v[12:15]
    v_mfma_f32_16x16x32_bf16 v[16:19], v[32:35], a[8:11], v[16:19]
    v_mfma_f32_16x16x32_bf16 v[20:23], v[32:35], a[80:83], v[20:23]
    s_waitcnt vmcnt(13)
    v_mfma_f32_16x16x32_bf16 v[8:11], v[36:39], v[76:79], v[8:11]
    v_mfma_f32_16x16x32_bf16 v[12:15], v[36:39], v[148:151], v[12:15]
    v_mfma_f32_16x16x32_bf16 v[16:19], v[36:39], a[12:15], v[16:19]
    v_mfma_f32_16x16x32_bf16 v[20:23], v[36:39], a[84:87], v[20:23]
    s_waitcnt vmcnt(12)
    v_mfma_f32_16x16x32_bf16 v[8:11], v[40:43], v[80:83], v[8:11]
    v_mfma_f32_16x16x32_bf16 v[12:15], v[40:43], v[152:155], v[12:15]
    v_mfma_f32_16x16x32_bf16 v[16:19], v[40:43], a[16:19], v[16:19]
    v_mfma_f32_16x16x32_bf16 v[20:23], v[40:43], a[88:91], v[20:23]
    s_waitcnt vmcnt(11)
    v_mfma_f32_16x16x32_bf16 v[8:11], v[44:47], v[84:87], v[8:11]
    v_mfma_f32_16x16x32_bf16 v[12:15], v[44:47], v[156:159], v[12:15]
    v_mfma_f32_16x16x32_bf16 v[16:19], v[44:47], a[20:23], v[16:19]
    v_mfma_f32_16x16x32_bf16 v[20:23], v[44:47], a[92:95], v[20:23]
    s_waitcnt vmcnt(10)
    v_mfma_f32_16x16x32_bf16 v[8:11], v[48:51], v[88:91], v[8:11]
    v_mfma_f32_16x16x32_bf16 v[12:15], v[48:51], v[160:163], v[12:15]
    v_mfma_f32_16x16x32_bf16 v[16:19], v[48:51], a[24:27], v[16:19]
    v_mfma_f32_16x16x32_bf16 v[20:23], v[48:51], a[96:99], v[20:23]
    s_waitcnt vmcnt(9)
    v_mfma_f32_16x16x32_bf16 v[8:11], v[52:55], v[92:95], v[8:11]
    v_mfma_f32_16x16x32_bf16 v[12:15], v[52:55], v[164:167], v[12:15]
    v_mfma_f32_16x16x32_bf16 v[16:19], v[52:55], a[28:31], v[16:19]
    v_mfma_f32_16x16x32_bf16 v[20:23], v[52:55], a[100:103], v[20:23]
    s_waitcnt vmcnt(8)
    v_mfma_f32_16x16x32_bf16 v[8:11], v[56:59], v[96:99], v[8:11]
    v_mfma_f32_16x16x32_bf16 v[12:15], v[56:59], v[168:171], v[12:15]
    v_mfma_f32_16x16x32_bf16 v[16:19], v[56:59], a[32:35], v[16:19]
    v_mfma_f32_16x16x32_bf16 v[20:23], v[56:59], a[104:107], v[20:23]
    s_waitcnt vmcnt(7)
    v_mfma_f32_16x16x32_bf16 v[8:11], v[60:63], v[100:103], v[8:11]
    v_mfma_f32_16x16x32_bf16 v[12:15], v[60:63], v[172:175], v[12:15]
    v_mfma_f32_16x16x32_bf16 v[16:19], v[60:63], a[36:39], v[16:19]
    v_mfma_f32_16x16x32_bf16 v[20:23], v[60:63], a[108:111], v[20:23]
    s_waitcnt vmcnt(6)
    v_mfma_f32_16x16x32_bf16 v[8:11], v[208:211], v[104:107], v[8:11]
    v_mfma_f32_16x16x32_bf16 v[12:15], v[208:211], v[176:179], v[12:15]
    v_mfma_f32_16x16x32_bf16 v[16:19], v[208:211], a[40:43], v[16:19]
    v_mfma_f32_16x16x32_bf16 v[20:23], v[208:211], a[112:115], v[20:23]
    s_waitcnt vmcnt(5)
    v_mfma_f32_16x16x32_bf16 v[8:11], v[212:215], v[108:111], v[8:11]
    v_mfma_f32_16x16x32_bf16 v[12:15], v[212:215], v[180:183], v[12:15]
    v_mfma_f32_16x16x32_bf16 v[16:19], v[212:215], a[44:47], v[16:19]
    v_mfma_f32_16x16x32_bf16 v[20:23], v[212:215], a[116:119], v[20:23]
    s_waitcnt vmcnt(4)
    v_mfma_f32_16x16x32_bf16 v[8:11], v[216:219], v[112:115], v[8:11]
    v_mfma_f32_16x16x32_bf16 v[12:15], v[216:219], v[184:187], v[12:15]
    v_mfma_f32_16x16x32_bf16 v[16:19], v[216:219], a[48:51], v[16:19]
    v_mfma_f32_16x16x32_bf16 v[20:23], v[216:219], a[120:123], v[20:23]
    s_waitcnt vmcnt(3)
    v_mfma_f32_16x16x32_bf16 v[8:11], v[220:223], v[116:119], v[8:11]
    v_mfma_f32_16x16x32_bf16 v[12:15], v[220:223], v[188:191], v[12:15]
    v_mfma_f32_16x16x32_bf16 v[16:19], v[220:223], a[52:55], v[16:19]
    v_mfma_f32_16x16x32_bf16 v[20:23], v[220:223], a[124:127], v[20:23]
    s_waitcnt vmcnt(2)
    v_mfma_f32_16x16x32_bf16 v[8:11], v[224:227], v[120:123], v[8:11]
    v_mfma_f32_16x16x32_bf16 v[12:15], v[224:227], v[192:195], v[12:15]
    v_mfma_f32_16x16x32_bf16 v[16:19], v[224:227], a[56:59], v[16:19]
    v_mfma_f32_16x16x32_bf16 v[20:23], v[224:227], a[128:131], v[20:23]
    s_waitcnt vmcnt(1)
    v_mfma_f32_16x16x32_bf16 v[8:11], v[228:231], v[124:127], v[8:11]
    v_mfma_f32_16x16x32_bf16 v[12:15], v[228:231], v[196:199], v[12:15]
    v_mfma_f32_16x16x32_bf16 v[16:19], v[228:231], a[60:63], v[16:19]
    v_mfma_f32_16x16x32_bf16 v[20:23], v[228:231], a[132:135], v[20:23]
    s_waitcnt vmcnt(0)
    v_mfma_f32_16x16x32_bf16 v[8:11], v[232:235], v[128:131], v[8:11]
    v_mfma_f32_16x16x32_bf16 v[12:15], v[232:235], v[200:203], v[12:15]
    v_mfma_f32_16x16x32_bf16 v[16:19], v[232:235], a[64:67], v[16:19]
    v_mfma_f32_16x16x32_bf16 v[20:23], v[232:235], a[136:139], v[20:23]
    v_mfma_f32_16x16x32_bf16 v[8:11], v[236:239], v[132:135], v[8:11]
    v_mfma_f32_16x16x32_bf16 v[12:15], v[236:239], v[204:207], v[12:15]
    v_mfma_f32_16x16x32_bf16 v[16:19], v[236:239], a[68:71], v[16:19]
    v_mfma_f32_16x16x32_bf16 v[20:23], v[236:239], a[140:143], v[20:23]
    s_nop 4
    v_pk_mul_f32 v[8:9], v[8:9], 0.5 op_sel_hi:[1,0]
    v_pk_mul_f32 v[10:11], v[10:11], 0.5 op_sel_hi:[1,0]
    v_pk_mul_f32 v[12:13], v[12:13], 0.5 op_sel_hi:[1,0]
    v_pk_mul_f32 v[14:15], v[14:15], 0.5 op_sel_hi:[1,0]
    v_pk_mul_f32 v[16:17], v[16:17], 0.5 op_sel_hi:[1,0]
    v_pk_mul_f32 v[18:19], v[18:19], 0.5 op_sel_hi:[1,0]
    v_pk_mul_f32 v[20:21], v[20:21], 0.5 op_sel_hi:[1,0]
    v_pk_mul_f32 v[22:23], v[22:23], 0.5 op_sel_hi:[1,0]
mk_st:
    s_nop 1
    v_cvt_pk_bf16_f32 v24, v8, v9
    v_cvt_pk_bf16_f32 v25, v10, v11
    v_cvt_pk_bf16_f32 v26, v12, v13
    v_cvt_pk_bf16_f32 v27, v14, v15
    v_cvt_pk_bf16_f32 v28, v16, v17
    v_cvt_pk_bf16_f32 v29, v18, v19
    v_cvt_pk_bf16_f32 v30, v20, v21
    v_cvt_pk_bf16_f32 v31, v22, v23
    s_add_u32 s21, s26, 4096
    buffer_store_dwordx4 v[24:27], v1, s[4:7], s26 offen sc1
    buffer_store_dwordx4 v[28:31], v1, s[4:7], s21 offen sc1
    s_add_u32 s22, s19, s95
    s_waitcnt vmcnt(0)
    s_barrier
    v_mov_b32 v4, s22
    s_mov_b64 exec, s[34:35]
    buffer_store_dword v4, off, s[4:7], s29 sc1
    buffer_store_dword v4, off, s[4:7], s29 offset:128 sc1
    s_mov_b64 exec, -1
    s_add_u32 s19, s19, 2
    s_add_u32 s26, s26, 262144
    s_cmp_le_u32 s19, 56
    s_cbranch_scc1 mk_loop
    s_mov_b32 s45, 0
    s_cmp_lg_u32 s93, 1000
    s_cbranch_scc1 L_wf_next
    s_mov_b32 s45, 2
    s_mov_b32 s8, s76
    s_mov_b32 s9, s77
    s_mov_b32 s10, 4718592
    s_mov_b32 s11, 0x20000
    s_branch L_att_next
L_ssm_next:
    s_sub_u32 s93, s93, 1
    s_cbranch_scc1 L_exit
    s_mov_b32 s37, 8
    v_mov_b32 v250, 1
    v_mov_b32 v251, 163832
    v_cmp_eq_u32 vcc, 0, v0
    s_nop 0
    s_and_saveexec_b64 s[38:39], vcc
    s_cbranch_execz tk12
    buffer_atomic_add v250, off, s[84:87], s37 sc0
    s_waitcnt vmcnt(0)
    ds_write_b32 v251, v250
    s_waitcnt lgkmcnt(0)
tk12:
    s_mov_b64 exec, -1
    s_barrier
    ds_read_b32 v252, v251
    s_waitcnt lgkmcnt(0)
    v_readfirstlane_b32 s20, v252
    s_barrier
    s_nop 3
    s_cmp_ge_u32 s20, 72
    s_cbranch_scc1 L_ssm_done
    s_lshl_b32 s20, s20, 3
    v_lshrrev_b32 v5, 6, v0
    s_nop 0
    v_readfirstlane_b32 s21, v5
    v_and_b32 v1, 63, v0
    v_and_b32 v2, 15, v1
    v_lshrrev_b32 v3, 4, v1
    v_lshlrev_b32 v4, 14, v5
    s_mov_b32 s8, s62
    s_mov_b32 s9, s63
    s_mov_b32 s10, 2359296
    s_mov_b32 s11, 0x20000
    s_mov_b32 s16, s76
    s_mov_b32 s17, s77
    s_mov_b32 s18, 4718592
    s_mov_b32 s19, 0x20000
    s_add_u32 s22, s20, s21
    s_lshl_b32 s23, s22, 8
    v_lshlrev_b32 v6, 3, v2
    v_lshl_add_u32 v6, v3, 1, v6
    s_mov_b32 s12, s64
    s_mov_b32 s13, s65
    s_mov_b32 s14, 147456
    s_mov_b32 s15, 0x20000
    buffer_load_ushort v8, v6, s[12:15], s23 offen offset:0
    buffer_load_ushort v12, v6, s[12:15], s23 offen offset:128
    buffer_load_ushort v16, v6, s[12:15], s23 offen offset:1024
    buffer_load_ushort v20, v6, s[12:15], s23 offen offset:1152
    s_mov_b32 s12, s66
    s_mov_b32 s13, s67
    s_mov_b32 s14, 147456
    s_mov_b32 s15, 0x20000
    buffer_load_ushort v9, v6, s[12:15], s23 offen offset:0
    buffer_load_ushort v13, v6, s[12:15], s23 offen offset:128
    buffer_load_ushort v17, v6, s[12:15], s23 offen offset:1024
    buffer_load_ushort v21, v6, s[12:15], s23 offen offset:1152
    s_mov_b32 s12, s68
    s_mov_b32 s13, s69
    s_mov_b32 s14, 147456
    s_mov_b32 s15, 0x20000
    buffer_load_ushort v10, v6, s[12:15], s23 offen offset:0
    buffer_load_ushort v14, v6, s[12:15], s23 offen offset:128
    buffer_load_ushort v18, v6, s[12:15], s23 offen offset:1024
    buffer_load_ushort v22, v6, s[12:15], s23 offen offset:1152
    s_mov_b32 s12, s70
    s_mov_b32 s13, s71
    s_mov_b32 s14, 147456
    s_mov_b32 s15, 0x20000
    buffer_load_ushort v11, v6, s[12:15], s23 offen offset:0
    buffer_load_ushort v15, v6, s[12:15], s23 offen offset:128
    buffer_load_ushort v19, v6, s[12:15], s23 offen offset:1024
    buffer_load_ushort v23, v6, s[12:15], s23 offen offset:1152
    s_mov_b32 s12, s72
    s_mov_b32 s13, s73
    s_mov_b32 s14, 1152
    s_mov_b32 s15, 0x20000
    s_lshl_b32 s23, s22, 1
    buffer_load_ushort v24, off, s[12:15], s23
    buffer_load_ushort v25, off, s[12:15], s23 offset:8
    v_mul_u32_u24 v5, 9216, v0
    s_lshl_b32 s22, s20, 1
    s_add_u32 s23, s22, 0
    buffer_load_dwordx4 v[208:211], v5, s[8:11], s23 offen
    s_add_u32 s23, s22, 1152
    buffer_load_dwordx4 v[212:215], v5, s[8:11], s23 offen
    s_add_u32 s23, s22, 2304
    buffer_load_dwordx4 v[216:219], v5, s[8:11], s23 offen
    s_add_u32 s23, s22, 3456
    buffer_load_dwordx4 v[220:223], v5, s[8:11], s23 offen
    s_add_u32 s23, s22, 4608
    buffer_load_dwordx4 v[224:227], v5, s[8:11], s23 offen
    s_add_u32 s23, s22, 5760
    buffer_load_dwordx4 v[228:231], v5, s[8:11], s23 offen
    s_add_u32 s23, s22, 6912
    buffer_load_dwordx4 v[232:235], v5, s[8:11], s23 offen
    s_add_u32 s23, s22, 8064
    buffer_load_dwordx4 v[236:239], v5, s[8:11], s23 offen
    s_mov_b32 s26, 0x3fb8aa3b
    s_mov_b32 s27, 0x3e22f983
    s_mov_b32 s28, 0
    v_cvt_f32_u32 v26, v2
    v_mul_f32 v27, 0x41800000, v26
    s_waitcnt vmcnt(8)
    s_nop 0
ss_pass:
    v_mov_b32 v36, 0
    v_mov_b32 v37, 0
    v_lshl_add_u32 v6, v1, 3, v4
    ds_write_b64 v6, v[36:37] offset:0
    v_lshlrev_b32 v38, 16, v24
    v_mul_f32 v38, s26, v38
    v_exp_f32 v38, v38
    s_nop 0
    v_cvt_pk_bf16_f32 v38, v38, v38
    v_and_b32 v38, 0xffff0000, v38
    v_add_f32 v39, v38, v38
    v_lshlrev_b32 v28, 16, v8
    v_mul_f32 v28, s26, v28
    v_exp_f32 v28, v28
    s_nop 0
    v_cvt_pk_bf16_f32 v28, v28, v28
    v_and_b32 v28, 0xffff0000, v28
    v_mul_f32 v28, v28, v38
    v_mul_f32 v28, s26, v28
    v_sub_f32 v28, 0, v28
    v_lshlrev_b32 v29, 16, v9
    v_mul_f32 v29, v29, v38
    v_mul_f32 v29, s27, v29
    v_lshlrev_b32 v30, 16, v10
    v_mul_f32 v30, v30, v39
    v_lshlrev_b32 v31, 16, v11
    v_mul_f32 v31, v31, v39
    v_lshlrev_b32 v32, 16, v12
    v_mul_f32 v32, s26, v32
    v_exp_f32 v32, v32
    s_nop 0
    v_cvt_pk_bf16_f32 v32, v32, v32
    v_and_b32 v32, 0xffff0000, v32
    v_mul_f32 v32, v32, v38
    v_mul_f32 v32, s26, v32
    v_sub_f32 v32, 0, v32
    v_lshlrev_b32 v33, 16, v13
    v_mul_f32 v33, v33, v38
    v_mul_f32 v33, s27, v33
    v_lshlrev_b32 v34, 16, v14
    v_mul_f32 v34, v34, v39
    v_lshlrev_b32 v35, 16, v15
    v_mul_f32 v35, v35, v39
    v_mov_b64 v[48:49], 0
    v_mov_b64 v[50:51], 0
    v_mov_b64 v[52:53], 0
    v_mov_b64 v[54:55], 0
    v_mov_b64 v[56:57], 0
    v_mov_b64 v[58:59], 0
    v_mov_b64 v[60:61], 0
    v_mov_b64 v[62:63], 0
    s_mov_b32 s25, 0
    s_nop 0
ss_kg:
    v_mov_b64_dpp v[64:65], v[28:29] row_newbcast:0 row_mask:0xf bank_mask:0xf
    v_mov_b64_dpp v[66:67], v[30:31] row_newbcast:0 row_mask:0xf bank_mask:0xf
    v_pk_mul_f32 v[94:95], v[64:65], v[26:27] op_sel_hi:[1,0]
    v_pk_mul_f32 v[96:97], v[64:65], v[26:27] op_sel:[0,1] op_sel_hi:[1,1]
    v_fract_f32 v95, v95
    v_fract_f32 v97, v97
    v_exp_f32 v94, v94
    v_exp_f32 v96, v96
    v_cos_f32 v68, v95
    v_sin_f32 v69, v95
    v_cos_f32 v76, v97
    v_sin_f32 v77, v97
    v_pk_mul_f32 v[68:69], v[68:69], v[94:95] op_sel_hi:[1,0]
    v_pk_mul_f32 v[76:77], v[76:77], v[96:97] op_sel_hi:[1,0]
    v_pk_mul_f32 v[92:93], v[76:77], v[76:77] op_sel:[1,1] op_sel_hi:[0,1]
    v_pk_fma_f32 v[78:79], v[76:77], v[76:77], v[92:93] op_sel:[0,0,0] op_sel_hi:[0,1,1] neg_lo:[0,0,1]
    v_pk_mul_f32 v[94:95], v[68:69], v[68:69] op_sel:[1,1] op_sel_hi:[0,1]
    v_pk_fma_f32 v[70:71], v[68:69], v[68:69], v[94:95] op_sel:[0,0,0] op_sel_hi:[0,1,1] neg_lo:[0,0,1]
    v_pk_mul_f32 v[92:93], v[78:79], v[78:79] op_sel:[1,1] op_sel_hi:[0,1]
    v_pk_fma_f32 v[80:81], v[78:79], v[78:79], v[92:93] op_sel:[0,0,0] op_sel_hi:[0,1,1] neg_lo:[0,0,1]
    v_pk_mul_f32 v[94:95], v[70:71], v[70:71] op_sel:[1,1] op_sel_hi:[0,1]
    v_pk_fma_f32 v[72:73], v[70:71], v[70:71], v[94:95] op_sel:[0,0,0] op_sel_hi:[0,1,1] neg_lo:[0,0,1]
    v_pk_mul_f32 v[92:93], v[80:81], v[80:81] op_sel:[1,1] op_sel_hi:[0,1]
    v_pk_fma_f32 v[82:83], v[80:81], v[80:81], v[92:93] op_sel:[0,0,0] op_sel_hi:[0,1,1] neg_lo:[0,0,1]
    v_pk_mul_f32 v[94:95], v[72:73], v[72:73] op_sel:[1,1] op_sel_hi:[0,1]
    v_pk_fma_f32 v[74:75], v[72:73], v[72:73], v[94:95] op_sel:[0,0,0] op_sel_hi:[0,1,1] neg_lo:[0,0,1]
    v_pk_mul_f32 v[92:93], v[82:83], v[82:83] op_sel:[1,1] op_sel_hi:[0,1]
    v_pk_fma_f32 v[84:85], v[82:83], v[82:83], v[92:93] op_sel:[0,0,0] op_sel_hi:[0,1,1] neg_lo:[0,0,1]
    v_pk_mul_f32 v[94:95], v[66:67], v[76:77] op_sel:[1,1] op_sel_hi:[1,0]
    v_pk_fma_f32 v[86:87], v[66:67], v[76:77], v[94:95] op_sel:[0,0,0] op_sel_hi:[0,1,1] neg_lo:[0,0,1] neg_hi:[1,0,1]
    v_mov_b32_dpp v80, v78 row_ror:8 row_mask:0xf bank_mask:0x3
    v_mov_b32_dpp v81, v79 row_ror:8 row_mask:0xf bank_mask:0x3
    v_mov_b32_dpp v82, v84 row_ror:8 row_mask:0xf bank_mask:0x3
    v_mov_b32_dpp v83, v85 row_ror:8 row_mask:0xf bank_mask:0x3
    v_pk_mul_f32 v[92:93], v[66:67], v[80:81] op_sel:[1,1] op_sel_hi:[1,0]
    v_pk_fma_f32 v[88:89], v[66:67], v[80:81], v[92:93] op_sel:[0,0,0] op_sel_hi:[0,1,1] neg_lo:[0,0,1] neg_hi:[1,0,1]
    v_pk_mul_f32 v[94:95], v[66:67], v[82:83] op_sel:[1,1] op_sel_hi:[1,0]
    v_pk_fma_f32 v[90:91], v[66:67], v[82:83], v[94:95] op_sel:[0,0,0] op_sel_hi:[0,1,1] neg_lo:[0,0,1] neg_hi:[1,0,1]
    v_mfma_f32_16x16x4_f32 v[48:51], v86, v68, v[48:51]
    v_mfma_f32_16x16x4_f32 v[52:55], v88, v70, v[52:55]
    v_mfma_f32_16x16x4_f32 v[56:59], v88, v72, v[56:59]
    v_mfma_f32_16x16x4_f32 v[60:63], v90, v74, v[60:63]
    v_mfma_f32_16x16x4_f32 v[48:51], v87, v69, v[48:51]
    v_mfma_f32_16x16x4_f32 v[52:55], v89, v71, v[52:55]
    v_mfma_f32_16x16x4_f32 v[56:59], v89, v73, v[56:59]
    v_mfma_f32_16x16x4_f32 v[60:63], v91, v75, v[60:63]
    v_mov_b64_dpp v[64:65], v[28:29] row_newbcast:1 row_mask:0xf bank_mask:0xf
    v_mov_b64_dpp v[66:67], v[30:31] row_newbcast:1 row_mask:0xf bank_mask:0xf
    v_pk_mul_f32 v[94:95], v[64:65], v[26:27] op_sel_hi:[1,0]
    v_pk_mul_f32 v[96:97], v[64:65], v[26:27] op_sel:[0,1] op_sel_hi:[1,1]
    v_fract_f32 v95, v95
    v_fract_f32 v97, v97
    v_exp_f32 v94, v94
    v_exp_f32 v96, v96
    v_cos_f32 v68, v95
    v_sin_f32 v69, v95
    v_cos_f32 v76, v97
    v_sin_f32 v77, v97
    v_pk_mul_f32 v[68:69], v[68:69], v[94:95] op_sel_hi:[1,0]
    v_pk_mul_f32 v[76:77], v[76:77], v[96:97] op_sel_hi:[1,0]
    v_pk_mul_f32 v[92:93], v[76:77], v[76:77] op_sel:[1,1] op_sel_hi:[0,1]
    v_pk_fma_f32 v[78:79], v[76:77], v[76:77], v[92:93] op_sel:[0,0,0] op_sel_hi:[0,1,1] neg_lo:[0,0,1]
    v_pk_mul_f32 v[94:95], v[68:69], v[68:69] op_sel:[1,1] op_sel_hi:[0,1]
    v_pk_fma_f32 v[70:71], v[68:69], v[68:69], v[94:95] op_sel:[0,0,0] op_sel_hi:[0,1,1] neg_lo:[0,0,1]
    v_pk_mul_f32 v[92:93], v[78:79], v[78:79] op_sel:[1,1] op_sel_hi:[0,1]
    v_pk_fma_f32 v[80:81], v[78:79], v[78:79], v[92:93] op_sel:[0,0,0] op_sel_hi:[0,1,1] neg_lo:[0,0,1]
    v_pk_mul_f32 v[94:95], v[70:71], v[70:71] op_sel:[1,1] op_sel_hi:[0,1]
    v_pk_fma_f32 v[72:73], v[70:71], v[70:71], v[94:95] op_sel:[0,0,0] op_sel_hi:[0,1,1] neg_lo:[0,0,1]
    v_pk_mul_f32 v[92:93], v[80:81], v[80:81] op_sel:[1,1] op_sel_hi:[0,1]
    v_pk_fma_f32 v[82:83], v[80:81], v[80:81], v[92:93] op_sel:[0,0,0] op_sel_hi:[0,1,1] neg_lo:[0,0,1]
    v_pk_mul_f32 v[94:95], v[72:73], v[72:73] op_sel:[1,1] op_sel_hi:[0,1]
    v_pk_fma_f32 v[74:75], v[72:73], v[72:73], v[94:95] op_sel:[0,0,0] op_sel_hi:[0,1,1] neg_lo:[0,0,1]
    v_pk_mul_f32 v[92:93], v[82:83], v[82:83] op_sel:[1,1] op_sel_hi:[0,1]
    v_pk_fma_f32 v[84:85], v[82:83], v[82:83], v[92:93] op_sel:[0,0,0] op_sel_hi:[0,1,1] neg_lo:[0,0,1]
    v_pk_mul_f32 v[94:95], v[66:67], v[76:77] op_sel:[1,1] op_sel_hi:[1,0]
    v_pk_fma_f32 v[86:87], v[66:67], v[76:77], v[94:95] op_sel:[0,0,0] op_sel_hi:[0,1,1] neg_lo:[0,0,1] neg_hi:[1,0,1]
    v_mov_b32_dpp v80, v78 row_ror:8 row_mask:0xf bank_mask:0x3
    v_mov_b32_dpp v81, v79 row_ror:8 row_mask:0xf bank_mask:0x3
    v_mov_b32_dpp v82, v84 row_ror:8 row_mask:0xf bank_mask:0x3
    v_mov_b32_dpp v83, v85 row_ror:8 row_mask:0xf bank_mask:0x3
    v_pk_mul_f32 v[92:93], v[66:67], v[80:81] op_sel:[1,1] op_sel_hi:[1,0]
    v_pk_fma_f32 v[88:89], v[66:67], v[80:81], v[92:93] op_sel:[0,0,0] op_sel_hi:[0,1,1] neg_lo:[0,0,1] neg_hi:[1,0,1]
    v_pk_mul_f32 v[94:95], v[66:67], v[82:83] op_sel:[1,1] op_sel_hi:[1,0]
    v_pk_fma_f32 v[90:91], v[66:67], v[82:83], v[94:95] op_sel:[0,0,0] op_sel_hi:[0,1,1] neg_lo:[0,0,1] neg_hi:[1,0,1]
    v_mfma_f32_16x16x4_f32 v[48:51], v86, v68, v[48:51]
    v_mfma_f32_16x16x4_f32 v[52:55], v88, v70, v[52:55]
    v_mfma_f32_16x16x4_f32 v[56:59], v88, v72, v[56:59]
    v_mfma_f32_16x16x4_f32 v[60:63], v90, v74, v[60:63]
    v_mfma_f32_16x16x4_f32 v[48:51], v87, v69, v[48:51]
    v_mfma_f32_16x16x4_f32 v[52:55], v89, v71, v[52:55]
    v_mfma_f32_16x16x4_f32 v[56:59], v89, v73, v[56:59]
    v_mfma_f32_16x16x4_f32 v[60:63], v91, v75, v[60:63]
    v_mov_b64_dpp v[64:65], v[28:29] row_newbcast:2 row_mask:0xf bank_mask:0xf
    v_mov_b64_dpp v[66:67], v[30:31] row_newbcast:2 row_mask:0xf bank_mask:0xf
    v_pk_mul_f32 v[94:95], v[64:65], v[26:27] op_sel_hi:[1,0]
    v_pk_mul_f32 v[96:97], v[64:65], v[26:27] op_sel:[0,1] op_sel_hi:[1,1]
    v_fract_f32 v95, v95
    v_fract_f32 v97, v97
    v_exp_f32 v94, v94
    v_exp_f32 v96, v96
    v_cos_f32 v68, v95
    v_sin_f32 v69, v95
    v_cos_f32 v76, v97
    v_sin_f32 v77, v97
    v_pk_mul_f32 v[68:69], v[68:69], v[94:95] op_sel_hi:[1,0]
    v_pk_mul_f32 v[76:77], v[76:77], v[96:97] op_sel_hi:[1,0]
    v_pk_mul_f32 v[92:93], v[76:77], v[76:77] op_sel:[1,1] op_sel_hi:[0,1]
    v_pk_fma_f32 v[78:79], v[76:77], v[76:77], v[92:93] op_sel:[0,0,0] op_sel_hi:[0,1,1] neg_lo:[0,0,1]
    v_pk_mul_f32 v[94:95], v[68:69], v[68:69] op_sel:[1,1] op_sel_hi:[0,1]
    v_pk_fma_f32 v[70:71], v[68:69], v[68:69], v[94:95] op_sel:[0,0,0] op_sel_hi:[0,1,1] neg_lo:[0,0,1]
    v_pk_mul_f32 v[92:93], v[78:79], v[78:79] op_sel:[1,1] op_sel_hi:[0,1]
    v_pk_fma_f32 v[80:81], v[78:79], v[78:79], v[92:93] op_sel:[0,0,0] op_sel_hi:[0,1,1] neg_lo:[0,0,1]
    v_pk_mul_f32 v[94:95], v[70:71], v[70:71] op_sel:[1,1] op_sel_hi:[0,1]
    v_pk_fma_f32 v[72:73], v[70:71], v[70:71], v[94:95] op_sel:[0,0,0] op_sel_hi:[0,1,1] neg_lo:[0,0,1]
    v_pk_mul_f32 v[92:93], v[80:81], v[80:81] op_sel:[1,1] op_sel_hi:[0,1]
    v_pk_fma_f32 v[82:83], v[80:81], v[80:81], v[92:93] op_sel:[0,0,0] op_sel_hi:[0,1,1] neg_lo:[0,0,1]
    v_pk_mul_f32 v[94:95], v[72:73], v[72:73] op_sel:[1,1] op_sel_hi:[0,1]
    v_pk_fma_f32 v[74:75], v[72:73], v[72:73], v[94:95] op_sel:[0,0,0] op_sel_hi:[0,1,1] neg_lo:[0,0,1]
    v_pk_mul_f32 v[92:93], v[82:83], v[82:83] op_sel:[1,1] op_sel_hi:[0,1]
    v_pk_fma_f32 v[84:85], v[82:83], v[82:83], v[92:93] op_sel:[0,0,0] op_sel_hi:[0,1,1] neg_lo:[0,0,1]
    v_pk_mul_f32 v[94:95], v[66:67], v[76:77] op_sel:[1,1] op_sel_hi:[1,0]
    v_pk_fma_f32 v[86:87], v[66:67], v[76:77], v[94:95] op_sel:[0,0,0] op_sel_hi:[0,1,1] neg_lo:[0,0,1] neg_hi:[1,0,1]
    v_mov_b32_dpp v80, v78 row_ror:8 row_mask:0xf bank_mask:0x3
    v_mov_b32_dpp v81, v79 row_ror:8 row_mask:0xf bank_mask:0x3
    v_mov_b32_dpp v82, v84 row_ror:8 row_mask:0xf bank_mask:0x3
    v_mov_b32_dpp v83, v85 row_ror:8 row_mask:0xf bank_mask:0x3
    v_pk_mul_f32 v[92:93], v[66:67], v[80:81] op_sel:[1,1] op_sel_hi:[1,0]
    v_pk_fma_f32 v[88:89], v[66:67], v[80:81], v[92:93] op_sel:[0,0,0] op_sel_hi:[0,1,1] neg_lo:[0,0,1] neg_hi:[1,0,1]
    v_pk_mul_f32 v[94:95], v[66:67], v[82:83] op_sel:[1,1] op_sel_hi:[1,0]
    v_pk_fma_f32 v[90:91], v[66:67], v[82:83], v[94:95] op_sel:[0,0,0] op_sel_hi:[0,1,1] neg_lo:[0,0,1] neg_hi:[1,0,1]
    v_mfma_f32_16x16x4_f32 v[48:51], v86, v68, v[48:51]
    v_mfma_f32_16x16x4_f32 v[52:55], v88, v70, v[52:55]
    v_mfma_f32_16x16x4_f32 v[56:59], v88, v72, v[56:59]
    v_mfma_f32_16x16x4_f32 v[60:63], v90, v74, v[60:63]
    v_mfma_f32_16x16x4_f32 v[48:51], v87, v69, v[48:51]
    v_mfma_f32_16x16x4_f32 v[52:55], v89, v71, v[52:55]
    v_mfma_f32_16x16x4_f32 v[56:59], v89, v73, v[56:59]
    v_mfma_f32_16x16x4_f32 v[60:63], v91, v75, v[60:63]
    v_mov_b64_dpp v[64:65], v[28:29] row_newbcast:3 row_mask:0xf bank_mask:0xf
    v_mov_b64_dpp v[66:67], v[30:31] row_newbcast:3 row_mask:0xf bank_mask:0xf
    v_pk_mul_f32 v[94:95], v[64:65], v[26:27] op_sel_hi:[1,0]
    v_pk_mul_f32 v[96:97], v[64:65], v[26:27] op_sel:[0,1] op_sel_hi:[1,1]
    v_fract_f32 v95, v95
    v_fract_f32 v97, v97
    v_exp_f32 v94, v94
    v_exp_f32 v96, v96
    v_cos_f32 v68, v95
    v_sin_f32 v69, v95
    v_cos_f32 v76, v97
    v_sin_f32 v77, v97
    v_pk_mul_f32 v[68:69], v[68:69], v[94:95] op_sel_hi:[1,0]
    v_pk_mul_f32 v[76:77], v[76:77], v[96:97] op_sel_hi:[1,0]
    v_pk_mul_f32 v[92:93], v[76:77], v[76:77] op_sel:[1,1] op_sel_hi:[0,1]
    v_pk_fma_f32 v[78:79], v[76:77], v[76:77], v[92:93] op_sel:[0,0,0] op_sel_hi:[0,1,1] neg_lo:[0,0,1]
    v_pk_mul_f32 v[94:95], v[68:69], v[68:69] op_sel:[1,1] op_sel_hi:[0,1]
    v_pk_fma_f32 v[70:71], v[68:69], v[68:69], v[94:95] op_sel:[0,0,0] op_sel_hi:[0,1,1] neg_lo:[0,0,1]
    v_pk_mul_f32 v[92:93], v[78:79], v[78:79] op_sel:[1,1] op_sel_hi:[0,1]
    v_pk_fma_f32 v[80:81], v[78:79], v[78:79], v[92:93] op_sel:[0,0,0] op_sel_hi:[0,1,1] neg_lo:[0,0,1]
    v_pk_mul_f32 v[94:95], v[70:71], v[70:71] op_sel:[1,1] op_sel_hi:[0,1]
    v_pk_fma_f32 v[72:73], v[70:71], v[70:71], v[94:95] op_sel:[0,0,0] op_sel_hi:[0,1,1] neg_lo:[0,0,1]
    v_pk_mul_f32 v[92:93], v[80:81], v[80:81] op_sel:[1,1] op_sel_hi:[0,1]
    v_pk_fma_f32 v[82:83], v[80:81], v[80:81], v[92:93] op_sel:[0,0,0] op_sel_hi:[0,1,1] neg_lo:[0,0,1]
    v_pk_mul_f32 v[94:95], v[72:73], v[72:73] op_sel:[1,1] op_sel_hi:[0,1]
    v_pk_fma_f32 v[74:75], v[72:73], v[72:73], v[94:95] op_sel:[0,0,0] op_sel_hi:[0,1,1] neg_lo:[0,0,1]
    v_pk_mul_f32 v[92:93], v[82:83], v[82:83] op_sel:[1,1] op_sel_hi:[0,1]
    v_pk_fma_f32 v[84:85], v[82:83], v[82:83], v[92:93] op_sel:[0,0,0] op_sel_hi:[0,1,1] neg_lo:[0,0,1]
    v_pk_mul_f32 v[94:95], v[66:67], v[76:77] op_sel:[1,1] op_sel_hi:[1,0]
    v_pk_fma_f32 v[86:87], v[66:67], v[76:77], v[94:95] op_sel:[0,0,0] op_sel_hi:[0,1,1] neg_lo:[0,0,1] neg_hi:[1,0,1]
    v_mov_b32_dpp v80, v78 row_ror:8 row_mask:0xf bank_mask:0x3
    v_mov_b32_dpp v81, v79 row_ror:8 row_mask:0xf bank_mask:0x3
    v_mov_b32_dpp v82, v84 row_ror:8 row_mask:0xf bank_mask:0x3
    v_mov_b32_dpp v83, v85 row_ror:8 row_mask:0xf bank_mask:0x3
    v_pk_mul_f32 v[92:93], v[66:67], v[80:81] op_sel:[1,1] op_sel_hi:[1,0]
    v_pk_fma_f32 v[88:89], v[66:67], v[80:81], v[92:93] op_sel:[0,0,0] op_sel_hi:[0,1,1] neg_lo:[0,0,1] neg_hi:[1,0,1]
    v_pk_mul_f32 v[94:95], v[66:67], v[82:83] op_sel:[1,1] op_sel_hi:[1,0]
    v_pk_fma_f32 v[90:91], v[66:67], v[82:83], v[94:95] op_sel:[0,0,0] op_sel_hi:[0,1,1] neg_lo:[0,0,1] neg_hi:[1,0,1]
    v_mfma_f32_16x16x4_f32 v[48:51], v86, v68, v[48:51]
    v_mfma_f32_16x16x4_f32 v[52:55], v88, v70, v[52:55]
    v_mfma_f32_16x16x4_f32 v[56:59], v88, v72, v[56:59]
    v_mfma_f32_16x16x4_f32 v[60:63], v90, v74, v[60:63]
    v_mfma_f32_16x16x4_f32 v[48:51], v87, v69, v[48:51]
    v_mfma_f32_16x16x4_f32 v[52:55], v89, v71, v[52:55]
    v_mfma_f32_16x16x4_f32 v[56:59], v89, v73, v[56:59]
    v_mfma_f32_16x16x4_f32 v[60:63], v91, v75, v[60:63]
    v_mov_b64_dpp v[64:65], v[28:29] row_newbcast:4 row_mask:0xf bank_mask:0xf
    v_mov_b64_dpp v[66:67], v[30:31] row_newbcast:4 row_mask:0xf bank_mask:0xf
    v_pk_mul_f32 v[94:95], v[64:65], v[26:27] op_sel_hi:[1,0]
    v_pk_mul_f32 v[96:97], v[64:65], v[26:27] op_sel:[0,1] op_sel_hi:[1,1]
    v_fract_f32 v95, v95
    v_fract_f32 v97, v97
    v_exp_f32 v94, v94
    v_exp_f32 v96, v96
    v_cos_f32 v68, v95
    v_sin_f32 v69, v95
    v_cos_f32 v76, v97
    v_sin_f32 v77, v97
    v_pk_mul_f32 v[68:69], v[68:69], v[94:95] op_sel_hi:[1,0]
    v_pk_mul_f32 v[76:77], v[76:77], v[96:97] op_sel_hi:[1,0]
    v_pk_mul_f32 v[92:93], v[76:77], v[76:77] op_sel:[1,1] op_sel_hi:[0,1]
    v_pk_fma_f32 v[78:79], v[76:77], v[76:77], v[92:93] op_sel:[0,0,0] op_sel_hi:[0,1,1] neg_lo:[0,0,1]
    v_pk_mul_f32 v[94:95], v[68:69], v[68:69] op_sel:[1,1] op_sel_hi:[0,1]
    v_pk_fma_f32 v[70:71], v[68:69], v[68:69], v[94:95] op_sel:[0,0,0] op_sel_hi:[0,1,1] neg_lo:[0,0,1]
    v_pk_mul_f32 v[92:93], v[78:79], v[78:79] op_sel:[1,1] op_sel_hi:[0,1]
    v_pk_fma_f32 v[80:81], v[78:79], v[78:79], v[92:93] op_sel:[0,0,0] op_sel_hi:[0,1,1] neg_lo:[0,0,1]
    v_pk_mul_f32 v[94:95], v[70:71], v[70:71] op_sel:[1,1] op_sel_hi:[0,1]
    v_pk_fma_f32 v[72:73], v[70:71], v[70:71], v[94:95] op_sel:[0,0,0] op_sel_hi:[0,1,1] neg_lo:[0,0,1]
    v_pk_mul_f32 v[92:93], v[80:81], v[80:81] op_sel:[1,1] op_sel_hi:[0,1]
    v_pk_fma_f32 v[82:83], v[80:81], v[80:81], v[92:93] op_sel:[0,0,0] op_sel_hi:[0,1,1] neg_lo:[0,0,1]
    v_pk_mul_f32 v[94:95], v[72:73], v[72:73] op_sel:[1,1] op_sel_hi:[0,1]
    v_pk_fma_f32 v[74:75], v[72:73], v[72:73], v[94:95] op_sel:[0,0,0] op_sel_hi:[0,1,1] neg_lo:[0,0,1]
    v_pk_mul_f32 v[92:93], v[82:83], v[82:83] op_sel:[1,1] op_sel_hi:[0,1]
    v_pk_fma_f32 v[84:85], v[82:83], v[82:83], v[92:93] op_sel:[0,0,0] op_sel_hi:[0,1,1] neg_lo:[0,0,1]
    v_pk_mul_f32 v[94:95], v[66:67], v[76:77] op_sel:[1,1] op_sel_hi:[1,0]
    v_pk_fma_f32 v[86:87], v[66:67], v[76:77], v[94:95] op_sel:[0,0,0] op_sel_hi:[0,1,1] neg_lo:[0,0,1] neg_hi:[1,0,1]
    v_mov_b32_dpp v80, v78 row_ror:8 row_mask:0xf bank_mask:0x3
    v_mov_b32_dpp v81, v79 row_ror:8 row_mask:0xf bank_mask:0x3
    v_mov_b32_dpp v82, v84 row_ror:8 row_mask:0xf bank_mask:0x3
    v_mov_b32_dpp v83, v85 row_ror:8 row_mask:0xf bank_mask:0x3
    v_pk_mul_f32 v[92:93], v[66:67], v[80:81] op_sel:[1,1] op_sel_hi:[1,0]
    v_pk_fma_f32 v[88:89], v[66:67], v[80:81], v[92:93] op_sel:[0,0,0] op_sel_hi:[0,1,1] neg_lo:[0,0,1] neg_hi:[1,0,1]
    v_pk_mul_f32 v[94:95], v[66:67], v[82:83] op_sel:[1,1] op_sel_hi:[1,0]
    v_pk_fma_f32 v[90:91], v[66:67], v[82:83], v[94:95] op_sel:[0,0,0] op_sel_hi:[0,1,1] neg_lo:[0,0,1] neg_hi:[1,0,1]
    v_mfma_f32_16x16x4_f32 v[48:51], v86, v68, v[48:51]
    v_mfma_f32_16x16x4_f32 v[52:55], v88, v70, v[52:55]
    v_mfma_f32_16x16x4_f32 v[56:59], v88, v72, v[56:59]
    v_mfma_f32_16x16x4_f32 v[60:63], v90, v74, v[60:63]
    v_mfma_f32_16x16x4_f32 v[48:51], v87, v69, v[48:51]
    v_mfma_f32_16x16x4_f32 v[52:55], v89, v71, v[52:55]
    v_mfma_f32_16x16x4_f32 v[56:59], v89, v73, v[56:59]
    v_mfma_f32_16x16x4_f32 v[60:63], v91, v75, v[60:63]
    v_mov_b64_dpp v[64:65], v[28:29] row_newbcast:5 row_mask:0xf bank_mask:0xf
    v_mov_b64_dpp v[66:67], v[30:31] row_newbcast:5 row_mask:0xf bank_mask:0xf
    v_pk_mul_f32 v[94:95], v[64:65], v[26:27] op_sel_hi:[1,0]
    v_pk_mul_f32 v[96:97], v[64:65], v[26:27] op_sel:[0,1] op_sel_hi:[1,1]
    v_fract_f32 v95, v95
    v_fract_f32 v97, v97
    v_exp_f32 v94, v94
    v_exp_f32 v96, v96
    v_cos_f32 v68, v95
    v_sin_f32 v69, v95
    v_cos_f32 v76, v97
    v_sin_f32 v77, v97
    v_pk_mul_f32 v[68:69], v[68:69], v[94:95] op_sel_hi:[1,0]
    v_pk_mul_f32 v[76:77], v[76:77], v[96:97] op_sel_hi:[1,0]
    v_pk_mul_f32 v[92:93], v[76:77], v[76:77] op_sel:[1,1] op_sel_hi:[0,1]
    v_pk_fma_f32 v[78:79], v[76:77], v[76:77], v[92:93] op_sel:[0,0,0] op_sel_hi:[0,1,1] neg_lo:[0,0,1]
    v_pk_mul_f32 v[94:95], v[68:69], v[68:69] op_sel:[1,1] op_sel_hi:[0,1]
    v_pk_fma_f32 v[70:71], v[68:69], v[68:69], v[94:95] op_sel:[0,0,0] op_sel_hi:[0,1,1] neg_lo:[0,0,1]
    v_pk_mul_f32 v[92:93], v[78:79], v[78:79] op_sel:[1,1] op_sel_hi:[0,1]
    v_pk_fma_f32 v[80:81], v[78:79], v[78:79], v[92:93] op_sel:[0,0,0] op_sel_hi:[0,1,1] neg_lo:[0,0,1]
    v_pk_mul_f32 v[94:95], v[70:71], v[70:71] op_sel:[1,1] op_sel_hi:[0,1]
    v_pk_fma_f32 v[72:73], v[70:71], v[70:71], v[94:95] op_sel:[0,0,0] op_sel_hi:[0,1,1] neg_lo:[0,0,1]
    v_pk_mul_f32 v[92:93], v[80:81], v[80:81] op_sel:[1,1] op_sel_hi:[0,1]
    v_pk_fma_f32 v[82:83], v[80:81], v[80:81], v[92:93] op_sel:[0,0,0] op_sel_hi:[0,1,1] neg_lo:[0,0,1]
    v_pk_mul_f32 v[94:95], v[72:73], v[72:73] op_sel:[1,1] op_sel_hi:[0,1]
    v_pk_fma_f32 v[74:75], v[72:73], v[72:73], v[94:95] op_sel:[0,0,0] op_sel_hi:[0,1,1] neg_lo:[0,0,1]
    v_pk_mul_f32 v[92:93], v[82:83], v[82:83] op_sel:[1,1] op_sel_hi:[0,1]
    v_pk_fma_f32 v[84:85], v[82:83], v[82:83], v[92:93] op_sel:[0,0,0] op_sel_hi:[0,1,1] neg_lo:[0,0,1]
    v_pk_mul_f32 v[94:95], v[66:67], v[76:77] op_sel:[1,1] op_sel_hi:[1,0]
    v_pk_fma_f32 v[86:87], v[66:67], v[76:77], v[94:95] op_sel:[0,0,0] op_sel_hi:[0,1,1] neg_lo:[0,0,1] neg_hi:[1,0,1]
    v_mov_b32_dpp v80, v78 row_ror:8 row_mask:0xf bank_mask:0x3
    v_mov_b32_dpp v81, v79 row_ror:8 row_mask:0xf bank_mask:0x3
    v_mov_b32_dpp v82, v84 row_ror:8 row_mask:0xf bank_mask:0x3
    v_mov_b32_dpp v83, v85 row_ror:8 row_mask:0xf bank_mask:0x3
    v_pk_mul_f32 v[92:93], v[66:67], v[80:81] op_sel:[1,1] op_sel_hi:[1,0]
    v_pk_fma_f32 v[88:89], v[66:67], v[80:81], v[92:93] op_sel:[0,0,0] op_sel_hi:[0,1,1] neg_lo:[0,0,1] neg_hi:[1,0,1]
    v_pk_mul_f32 v[94:95], v[66:67], v[82:83] op_sel:[1,1] op_sel_hi:[1,0]
    v_pk_fma_f32 v[90:91], v[66:67], v[82:83], v[94:95] op_sel:[0,0,0] op_sel_hi:[0,1,1] neg_lo:[0,0,1] neg_hi:[1,0,1]
    v_mfma_f32_16x16x4_f32 v[48:51], v86, v68, v[48:51]
    v_mfma_f32_16x16x4_f32 v[52:55], v88, v70, v[52:55]
    v_mfma_f32_16x16x4_f32 v[56:59], v88, v72, v[56:59]
    v_mfma_f32_16x16x4_f32 v[60:63], v90, v74, v[60:63]
    v_mfma_f32_16x16x4_f32 v[48:51], v87, v69, v[48:51]
    v_mfma_f32_16x16x4_f32 v[52:55], v89, v71, v[52:55]
    v_mfma_f32_16x16x4_f32 v[56:59], v89, v73, v[56:59]
    v_mfma_f32_16x16x4_f32 v[60:63], v91, v75, v[60:63]
    v_mov_b64_dpp v[64:65], v[28:29] row_newbcast:6 row_mask:0xf bank_mask:0xf
    v_mov_b64_dpp v[66:67], v[30:31] row_newbcast:6 row_mask:0xf bank_mask:0xf
    v_pk_mul_f32 v[94:95], v[64:65], v[26:27] op_sel_hi:[1,0]
    v_pk_mul_f32 v[96:97], v[64:65], v[26:27] op_sel:[0,1] op_sel_hi:[1,1]
    v_fract_f32 v95, v95
    v_fract_f32 v97, v97
    v_exp_f32 v94, v94
    v_exp_f32 v96, v96
    v_cos_f32 v68, v95
    v_sin_f32 v69, v95
    v_cos_f32 v76, v97
    v_sin_f32 v77, v97
    v_pk_mul_f32 v[68:69], v[68:69], v[94:95] op_sel_hi:[1,0]
    v_pk_mul_f32 v[76:77], v[76:77], v[96:97] op_sel_hi:[1,0]
    v_pk_mul_f32 v[92:93], v[76:77], v[76:77] op_sel:[1,1] op_sel_hi:[0,1]
    v_pk_fma_f32 v[78:79], v[76:77], v[76:77], v[92:93] op_sel:[0,0,0] op_sel_hi:[0,1,1] neg_lo:[0,0,1]
    v_pk_mul_f32 v[94:95], v[68:69], v[68:69] op_sel:[1,1] op_sel_hi:[0,1]
    v_pk_fma_f32 v[70:71], v[68:69], v[68:69], v[94:95] op_sel:[0,0,0] op_sel_hi:[0,1,1] neg_lo:[0,0,1]
    v_pk_mul_f32 v[92:93], v[78:79], v[78:79] op_sel:[1,1] op_sel_hi:[0,1]
    v_pk_fma_f32 v[80:81], v[78:79], v[78:79], v[92:93] op_sel:[0,0,0] op_sel_hi:[0,1,1] neg_lo:[0,0,1]
    v_pk_mul_f32 v[94:95], v[70:71], v[70:71] op_sel:[1,1] op_sel_hi:[0,1]
    v_pk_fma_f32 v[72:73], v[70:71], v[70:71], v[94:95] op_sel:[0,0,0] op_sel_hi:[0,1,1] neg_lo:[0,0,1]
    v_pk_mul_f32 v[92:93], v[80:81], v[80:81] op_sel:[1,1] op_sel_hi:[0,1]
    v_pk_fma_f32 v[82:83], v[80:81], v[80:81], v[92:93] op_sel:[0,0,0] op_sel_hi:[0,1,1] neg_lo:[0,0,1]
    v_pk_mul_f32 v[94:95], v[72:73], v[72:73] op_sel:[1,1] op_sel_hi:[0,1]
    v_pk_fma_f32 v[74:75], v[72:73], v[72:73], v[94:95] op_sel:[0,0,0] op_sel_hi:[0,1,1] neg_lo:[0,0,1]
    v_pk_mul_f32 v[92:93], v[82:83], v[82:83] op_sel:[1,1] op_sel_hi:[0,1]
    v_pk_fma_f32 v[84:85], v[82:83], v[82:83], v[92:93] op_sel:[0,0,0] op_sel_hi:[0,1,1] neg_lo:[0,0,1]
    v_pk_mul_f32 v[94:95], v[66:67], v[76:77] op_sel:[1,1] op_sel_hi:[1,0]
    v_pk_fma_f32 v[86:87], v[66:67], v[76:77], v[94:95] op_sel:[0,0,0] op_sel_hi:[0,1,1] neg_lo:[0,0,1] neg_hi:[1,0,1]
    v_mov_b32_dpp v80, v78 row_ror:8 row_mask:0xf bank_mask:0x3
    v_mov_b32_dpp v81, v79 row_ror:8 row_mask:0xf bank_mask:0x3
    v_mov_b32_dpp v82, v84 row_ror:8 row_mask:0xf bank_mask:0x3
    v_mov_b32_dpp v83, v85 row_ror:8 row_mask:0xf bank_mask:0x3
    v_pk_mul_f32 v[92:93], v[66:67], v[80:81] op_sel:[1,1] op_sel_hi:[1,0]
    v_pk_fma_f32 v[88:89], v[66:67], v[80:81], v[92:93] op_sel:[0,0,0] op_sel_hi:[0,1,1] neg_lo:[0,0,1] neg_hi:[1,0,1]
    v_pk_mul_f32 v[94:95], v[66:67], v[82:83] op_sel:[1,1] op_sel_hi:[1,0]
    v_pk_fma_f32 v[90:91], v[66:67], v[82:83], v[94:95] op_sel:[0,0,0] op_sel_hi:[0,1,1] neg_lo:[0,0,1] neg_hi:[1,0,1]
    v_mfma_f32_16x16x4_f32 v[48:51], v86, v68, v[48:51]
    v_mfma_f32_16x16x4_f32 v[52:55], v88, v70, v[52:55]
    v_mfma_f32_16x16x4_f32 v[56:59], v88, v72, v[56:59]
    v_mfma_f32_16x16x4_f32 v[60:63], v90, v74, v[60:63]
    v_mfma_f32_16x16x4_f32 v[48:51], v87, v69, v[48:51]
    v_mfma_f32_16x16x4_f32 v[52:55], v89, v71, v[52:55]
    v_mfma_f32_16x16x4_f32 v[56:59], v89, v73, v[56:59]
    v_mfma_f32_16x16x4_f32 v[60:63], v91, v75, v[60:63]
    v_mov_b64_dpp v[64:65], v[28:29] row_newbcast:7 row_mask:0xf bank_mask:0xf
    v_mov_b64_dpp v[66:67], v[30:31] row_newbcast:7 row_mask:0xf bank_mask:0xf
    v_pk_mul_f32 v[94:95], v[64:65], v[26:27] op_sel_hi:[1,0]
    v_pk_mul_f32 v[96:97], v[64:65], v[26:27] op_sel:[0,1] op_sel_hi:[1,1]
    v_fract_f32 v95, v95
    v_fract_f32 v97, v97
    v_exp_f32 v94, v94
    v_exp_f32 v96, v96
    v_cos_f32 v68, v95
    v_sin_f32 v69, v95
    v_cos_f32 v76, v97
    v_sin_f32 v77, v97
    v_pk_mul_f32 v[68:69], v[68:69], v[94:95] op_sel_hi:[1,0]
    v_pk_mul_f32 v[76:77], v[76:77], v[96:97] op_sel_hi:[1,0]
    v_pk_mul_f32 v[92:93], v[76:77], v[76:77] op_sel:[1,1] op_sel_hi:[0,1]
    v_pk_fma_f32 v[78:79], v[76:77], v[76:77], v[92:93] op_sel:[0,0,0] op_sel_hi:[0,1,1] neg_lo:[0,0,1]
    v_pk_mul_f32 v[94:95], v[68:69], v[68:69] op_sel:[1,1] op_sel_hi:[0,1]
    v_pk_fma_f32 v[70:71], v[68:69], v[68:69], v[94:95] op_sel:[0,0,0] op_sel_hi:[0,1,1] neg_lo:[0,0,1]
    v_pk_mul_f32 v[92:93], v[78:79], v[78:79] op_sel:[1,1] op_sel_hi:[0,1]
    v_pk_fma_f32 v[80:81], v[78:79], v[78:79], v[92:93] op_sel:[0,0,0] op_sel_hi:[0,1,1] neg_lo:[0,0,1]
    v_pk_mul_f32 v[94:95], v[70:71], v[70:71] op_sel:[1,1] op_sel_hi:[0,1]
    v_pk_fma_f32 v[72:73], v[70:71], v[70:71], v[94:95] op_sel:[0,0,0] op_sel_hi:[0,1,1] neg_lo:[0,0,1]
    v_pk_mul_f32 v[92:93], v[80:81], v[80:81] op_sel:[1,1] op_sel_hi:[0,1]
    v_pk_fma_f32 v[82:83], v[80:81], v[80:81], v[92:93] op_sel:[0,0,0] op_sel_hi:[0,1,1] neg_lo:[0,0,1]
    v_pk_mul_f32 v[94:95], v[72:73], v[72:73] op_sel:[1,1] op_sel_hi:[0,1]
    v_pk_fma_f32 v[74:75], v[72:73], v[72:73], v[94:95] op_sel:[0,0,0] op_sel_hi:[0,1,1] neg_lo:[0,0,1]
    v_pk_mul_f32 v[92:93], v[82:83], v[82:83] op_sel:[1,1] op_sel_hi:[0,1]
    v_pk_fma_f32 v[84:85], v[82:83], v[82:83], v[92:93] op_sel:[0,0,0] op_sel_hi:[0,1,1] neg_lo:[0,0,1]
    v_pk_mul_f32 v[94:95], v[66:67], v[76:77] op_sel:[1,1] op_sel_hi:[1,0]
    v_pk_fma_f32 v[86:87], v[66:67], v[76:77], v[94:95] op_sel:[0,0,0] op_sel_hi:[0,1,1] neg_lo:[0,0,1] neg_hi:[1,0,1]
    v_mov_b32_dpp v80, v78 row_ror:8 row_mask:0xf bank_mask:0x3
    v_mov_b32_dpp v81, v79 row_ror:8 row_mask:0xf bank_mask:0x3
    v_mov_b32_dpp v82, v84 row_ror:8 row_mask:0xf bank_mask:0x3
    v_mov_b32_dpp v83, v85 row_ror:8 row_mask:0xf bank_mask:0x3
    v_pk_mul_f32 v[92:93], v[66:67], v[80:81] op_sel:[1,1] op_sel_hi:[1,0]
    v_pk_fma_f32 v[88:89], v[66:67], v[80:81], v[92:93] op_sel:[0,0,0] op_sel_hi:[0,1,1] neg_lo:[0,0,1] neg_hi:[1,0,1]
    v_pk_mul_f32 v[94:95], v[66:67], v[82:83] op_sel:[1,1] op_sel_hi:[1,0]
    v_pk_fma_f32 v[90:91], v[66:67], v[82:83], v[94:95] op_sel:[0,0,0] op_sel_hi:[0,1,1] neg_lo:[0,0,1] neg_hi:[1,0,1]
    v_mfma_f32_16x16x4_f32 v[48:51], v86, v68, v[48:51]
    v_mfma_f32_16x16x4_f32 v[52:55], v88, v70, v[52:55]
    v_mfma_f32_16x16x4_f32 v[56:59], v88, v72, v[56:59]
    v_mfma_f32_16x16x4_f32 v[60:63], v90, v74, v[60:63]
    v_mfma_f32_16x16x4_f32 v[48:51], v87, v69, v[48:51]
    v_mfma_f32_16x16x4_f32 v[52:55], v89, v71, v[52:55]
    v_mfma_f32_16x16x4_f32 v[56:59], v89, v73, v[56:59]
    v_mfma_f32_16x16x4_f32 v[60:63], v91, v75, v[60:63]
    v_mov_b64_dpp v[64:65], v[28:29] row_newbcast:8 row_mask:0xf bank_mask:0xf
    v_mov_b64_dpp v[66:67], v[30:31] row_newbcast:8 row_mask:0xf bank_mask:0xf
    v_pk_mul_f32 v[94:95], v[64:65], v[26:27] op_sel_hi:[1,0]
    v_pk_mul_f32 v[96:97], v[64:65], v[26:27] op_sel:[0,1] op_sel_hi:[1,1]
    v_fract_f32 v95, v95
    v_fract_f32 v97, v97
    v_exp_f32 v94, v94
    v_exp_f32 v96, v96
    v_cos_f32 v68, v95
    v_sin_f32 v69, v95
    v_cos_f32 v76, v97
    v_sin_f32 v77, v97
    v_pk_mul_f32 v[68:69], v[68:69], v[94:95] op_sel_hi:[1,0]
    v_pk_mul_f32 v[76:77], v[76:77], v[96:97] op_sel_hi:[1,0]
    v_pk_mul_f32 v[92:93], v[76:77], v[76:77] op_sel:[1,1] op_sel_hi:[0,1]
    v_pk_fma_f32 v[78:79], v[76:77], v[76:77], v[92:93] op_sel:[0,0,0] op_sel_hi:[0,1,1] neg_lo:[0,0,1]
    v_pk_mul_f32 v[94:95], v[68:69], v[68:69] op_sel:[1,1] op_sel_hi:[0,1]
    v_pk_fma_f32 v[70:71], v[68:69], v[68:69], v[94:95] op_sel:[0,0,0] op_sel_hi:[0,1,1] neg_lo:[0,0,1]
    v_pk_mul_f32 v[92:93], v[78:79], v[78:79] op_sel:[1,1] op_sel_hi:[0,1]
    v_pk_fma_f32 v[80:81], v[78:79], v[78:79], v[92:93] op_sel:[0,0,0] op_sel_hi:[0,1,1] neg_lo:[0,0,1]
    v_pk_mul_f32 v[94:95], v[70:71], v[70:71] op_sel:[1,1] op_sel_hi:[0,1]
    v_pk_fma_f32 v[72:73], v[70:71], v[70:71], v[94:95] op_sel:[0,0,0] op_sel_hi:[0,1,1] neg_lo:[0,0,1]
    v_pk_mul_f32 v[92:93], v[80:81], v[80:81] op_sel:[1,1] op_sel_hi:[0,1]
    v_pk_fma_f32 v[82:83], v[80:81], v[80:81], v[92:93] op_sel:[0,0,0] op_sel_hi:[0,1,1] neg_lo:[0,0,1]
    v_pk_mul_f32 v[94:95], v[72:73], v[72:73] op_sel:[1,1] op_sel_hi:[0,1]
    v_pk_fma_f32 v[74:75], v[72:73], v[72:73], v[94:95] op_sel:[0,0,0] op_sel_hi:[0,1,1] neg_lo:[0,0,1]
    v_pk_mul_f32 v[92:93], v[82:83], v[82:83] op_sel:[1,1] op_sel_hi:[0,1]
    v_pk_fma_f32 v[84:85], v[82:83], v[82:83], v[92:93] op_sel:[0,0,0] op_sel_hi:[0,1,1] neg_lo:[0,0,1]
    v_pk_mul_f32 v[94:95], v[66:67], v[76:77] op_sel:[1,1] op_sel_hi:[1,0]
    v_pk_fma_f32 v[86:87], v[66:67], v[76:77], v[94:95] op_sel:[0,0,0] op_sel_hi:[0,1,1] neg_lo:[0,0,1] neg_hi:[1,0,1]
    v_mov_b32_dpp v80, v78 row_ror:8 row_mask:0xf bank_mask:0x3
    v_mov_b32_dpp v81, v79 row_ror:8 row_mask:0xf bank_mask:0x3
    v_mov_b32_dpp v82, v84 row_ror:8 row_mask:0xf bank_mask:0x3
    v_mov_b32_dpp v83, v85 row_ror:8 row_mask:0xf bank_mask:0x3
    v_pk_mul_f32 v[92:93], v[66:67], v[80:81] op_sel:[1,1] op_sel_hi:[1,0]
    v_pk_fma_f32 v[88:89], v[66:67], v[80:81], v[92:93] op_sel:[0,0,0] op_sel_hi:[0,1,1] neg_lo:[0,0,1] neg_hi:[1,0,1]
    v_pk_mul_f32 v[94:95], v[66:67], v[82:83] op_sel:[1,1] op_sel_hi:[1,0]
    v_pk_fma_f32 v[90:91], v[66:67], v[82:83], v[94:95] op_sel:[0,0,0] op_sel_hi:[0,1,1] neg_lo:[0,0,1] neg_hi:[1,0,1]
    v_mfma_f32_16x16x4_f32 v[48:51], v86, v68, v[48:51]
    v_mfma_f32_16x16x4_f32 v[52:55], v88, v70, v[52:55]
    v_mfma_f32_16x16x4_f32 v[56:59], v88, v72, v[56:59]
    v_mfma_f32_16x16x4_f32 v[60:63], v90, v74, v[60:63]
    v_mfma_f32_16x16x4_f32 v[48:51], v87, v69, v[48:51]
    v_mfma_f32_16x16x4_f32 v[52:55], v89, v71, v[52:55]
    v_mfma_f32_16x16x4_f32 v[56:59], v89, v73, v[56:59]
    v_mfma_f32_16x16x4_f32 v[60:63], v91, v75, v[60:63]
    v_mov_b64_dpp v[64:65], v[28:29] row_newbcast:9 row_mask:0xf bank_mask:0xf
    v_mov_b64_dpp v[66:67], v[30:31] row_newbcast:9 row_mask:0xf bank_mask:0xf
    v_pk_mul_f32 v[94:95], v[64:65], v[26:27] op_sel_hi:[1,0]
    v_pk_mul_f32 v[96:97], v[64:65], v[26:27] op_sel:[0,1] op_sel_hi:[1,1]
    v_fract_f32 v95, v95
    v_fract_f32 v97, v97
    v_exp_f32 v94, v94
    v_exp_f32 v96, v96
    v_cos_f32 v68, v95
    v_sin_f32 v69, v95
    v_cos_f32 v76, v97
    v_sin_f32 v77, v97
    v_pk_mul_f32 v[68:69], v[68:69], v[94:95] op_sel_hi:[1,0]
    v_pk_mul_f32 v[76:77], v[76:77], v[96:97] op_sel_hi:[1,0]
    v_pk_mul_f32 v[92:93], v[76:77], v[76:77] op_sel:[1,1] op_sel_hi:[0,1]
    v_pk_fma_f32 v[78:79], v[76:77], v[76:77], v[92:93] op_sel:[0,0,0] op_sel_hi:[0,1,1] neg_lo:[0,0,1]
    v_pk_mul_f32 v[94:95], v[68:69], v[68:69] op_sel:[1,1] op_sel_hi:[0,1]
    v_pk_fma_f32 v[70:71], v[68:69], v[68:69], v[94:95] op_sel:[0,0,0] op_sel_hi:[0,1,1] neg_lo:[0,0,1]
    v_pk_mul_f32 v[92:93], v[78:79], v[78:79] op_sel:[1,1] op_sel_hi:[0,1]
    v_pk_fma_f32 v[80:81], v[78:79], v[78:79], v[92:93] op_sel:[0,0,0] op_sel_hi:[0,1,1] neg_lo:[0,0,1]
    v_pk_mul_f32 v[94:95], v[70:71], v[70:71] op_sel:[1,1] op_sel_hi:[0,1]
    v_pk_fma_f32 v[72:73], v[70:71], v[70:71], v[94:95] op_sel:[0,0,0] op_sel_hi:[0,1,1] neg_lo:[0,0,1]
    v_pk_mul_f32 v[92:93], v[80:81], v[80:81] op_sel:[1,1] op_sel_hi:[0,1]
    v_pk_fma_f32 v[82:83], v[80:81], v[80:81], v[92:93] op_sel:[0,0,0] op_sel_hi:[0,1,1] neg_lo:[0,0,1]
    v_pk_mul_f32 v[94:95], v[72:73], v[72:73] op_sel:[1,1] op_sel_hi:[0,1]
    v_pk_fma_f32 v[74:75], v[72:73], v[72:73], v[94:95] op_sel:[0,0,0] op_sel_hi:[0,1,1] neg_lo:[0,0,1]
    v_pk_mul_f32 v[92:93], v[82:83], v[82:83] op_sel:[1,1] op_sel_hi:[0,1]
    v_pk_fma_f32 v[84:85], v[82:83], v[82:83], v[92:93] op_sel:[0,0,0] op_sel_hi:[0,1,1] neg_lo:[0,0,1]
    v_pk_mul_f32 v[94:95], v[66:67], v[76:77] op_sel:[1,1] op_sel_hi:[1,0]
    v_pk_fma_f32 v[86:87], v[66:67], v[76:77], v[94:95] op_sel:[0,0,0] op_sel_hi:[0,1,1] neg_lo:[0,0,1] neg_hi:[1,0,1]
    v_mov_b32_dpp v80, v78 row_ror:8 row_mask:0xf bank_mask:0x3
    v_mov_b32_dpp v81, v79 row_ror:8 row_mask:0xf bank_mask:0x3
    v_mov_b32_dpp v82, v84 row_ror:8 row_mask:0xf bank_mask:0x3
    v_mov_b32_dpp v83, v85 row_ror:8 row_mask:0xf bank_mask:0x3
    v_pk_mul_f32 v[92:93], v[66:67], v[80:81] op_sel:[1,1] op_sel_hi:[1,0]
    v_pk_fma_f32 v[88:89], v[66:67], v[80:81], v[92:93] op_sel:[0,0,0] op_sel_hi:[0,1,1] neg_lo:[0,0,1] neg_hi:[1,0,1]
    v_pk_mul_f32 v[94:95], v[66:67], v[82:83] op_sel:[1,1] op_sel_hi:[1,0]
    v_pk_fma_f32 v[90:91], v[66:67], v[82:83], v[94:95] op_sel:[0,0,0] op_sel_hi:[0,1,1] neg_lo:[0,0,1] neg_hi:[1,0,1]
    v_mfma_f32_16x16x4_f32 v[48:51], v86, v68, v[48:51]
    v_mfma_f32_16x16x4_f32 v[52:55], v88, v70, v[52:55]
    v_mfma_f32_16x16x4_f32 v[56:59], v88, v72, v[56:59]
    v_mfma_f32_16x16x4_f32 v[60:63], v90, v74, v[60:63]
    v_mfma_f32_16x16x4_f32 v[48:51], v87, v69, v[48:51]
    v_mfma_f32_16x16x4_f32 v[52:55], v89, v71, v[52:55]
    v_mfma_f32_16x16x4_f32 v[56:59], v89, v73, v[56:59]
    v_mfma_f32_16x16x4_f32 v[60:63], v91, v75, v[60:63]
    v_mov_b64_dpp v[64:65], v[28:29] row_newbcast:10 row_mask:0xf bank_mask:0xf
    v_mov_b64_dpp v[66:67], v[30:31] row_newbcast:10 row_mask:0xf bank_mask:0xf
    v_pk_mul_f32 v[94:95], v[64:65], v[26:27] op_sel_hi:[1,0]
    v_pk_mul_f32 v[96:97], v[64:65], v[26:27] op_sel:[0,1] op_sel_hi:[1,1]
    v_fract_f32 v95, v95
    v_fract_f32 v97, v97
    v_exp_f32 v94, v94
    v_exp_f32 v96, v96
    v_cos_f32 v68, v95
    v_sin_f32 v69, v95
    v_cos_f32 v76, v97
    v_sin_f32 v77, v97
    v_pk_mul_f32 v[68:69], v[68:69], v[94:95] op_sel_hi:[1,0]
    v_pk_mul_f32 v[76:77], v[76:77], v[96:97] op_sel_hi:[1,0]
    v_pk_mul_f32 v[92:93], v[76:77], v[76:77] op_sel:[1,1] op_sel_hi:[0,1]
    v_pk_fma_f32 v[78:79], v[76:77], v[76:77], v[92:93] op_sel:[0,0,0] op_sel_hi:[0,1,1] neg_lo:[0,0,1]
    v_pk_mul_f32 v[94:95], v[68:69], v[68:69] op_sel:[1,1] op_sel_hi:[0,1]
    v_pk_fma_f32 v[70:71], v[68:69], v[68:69], v[94:95] op_sel:[0,0,0] op_sel_hi:[0,1,1] neg_lo:[0,0,1]
    v_pk_mul_f32 v[92:93], v[78:79], v[78:79] op_sel:[1,1] op_sel_hi:[0,1]
    v_pk_fma_f32 v[80:81], v[78:79], v[78:79], v[92:93] op_sel:[0,0,0] op_sel_hi:[0,1,1] neg_lo:[0,0,1]
    v_pk_mul_f32 v[94:95], v[70:71], v[70:71] op_sel:[1,1] op_sel_hi:[0,1]
    v_pk_fma_f32 v[72:73], v[70:71], v[70:71], v[94:95] op_sel:[0,0,0] op_sel_hi:[0,1,1] neg_lo:[0,0,1]
    v_pk_mul_f32 v[92:93], v[80:81], v[80:81] op_sel:[1,1] op_sel_hi:[0,1]
    v_pk_fma_f32 v[82:83], v[80:81], v[80:81], v[92:93] op_sel:[0,0,0] op_sel_hi:[0,1,1] neg_lo:[0,0,1]
    v_pk_mul_f32 v[94:95], v[72:73], v[72:73] op_sel:[1,1] op_sel_hi:[0,1]
    v_pk_fma_f32 v[74:75], v[72:73], v[72:73], v[94:95] op_sel:[0,0,0] op_sel_hi:[0,1,1] neg_lo:[0,0,1]
    v_pk_mul_f32 v[92:93], v[82:83], v[82:83] op_sel:[1,1] op_sel_hi:[0,1]
    v_pk_fma_f32 v[84:85], v[82:83], v[82:83], v[92:93] op_sel:[0,0,0] op_sel_hi:[0,1,1] neg_lo:[0,0,1]
    v_pk_mul_f32 v[94:95], v[66:67], v[76:77] op_sel:[1,1] op_sel_hi:[1,0]
    v_pk_fma_f32 v[86:87], v[66:67], v[76:77], v[94:95] op_sel:[0,0,0] op_sel_hi:[0,1,1] neg_lo:[0,0,1] neg_hi:[1,0,1]
    v_mov_b32_dpp v80, v78 row_ror:8 row_mask:0xf bank_mask:0x3
    v_mov_b32_dpp v81, v79 row_ror:8 row_mask:0xf bank_mask:0x3
    v_mov_b32_dpp v82, v84 row_ror:8 row_mask:0xf bank_mask:0x3
    v_mov_b32_dpp v83, v85 row_ror:8 row_mask:0xf bank_mask:0x3
    v_pk_mul_f32 v[92:93], v[66:67], v[80:81] op_sel:[1,1] op_sel_hi:[1,0]
    v_pk_fma_f32 v[88:89], v[66:67], v[80:81], v[92:93] op_sel:[0,0,0] op_sel_hi:[0,1,1] neg_lo:[0,0,1] neg_hi:[1,0,1]
    v_pk_mul_f32 v[94:95], v[66:67], v[82:83] op_sel:[1,1] op_sel_hi:[1,0]
    v_pk_fma_f32 v[90:91], v[66:67], v[82:83], v[94:95] op_sel:[0,0,0] op_sel_hi:[0,1,1] neg_lo:[0,0,1] neg_hi:[1,0,1]
    v_mfma_f32_16x16x4_f32 v[48:51], v86, v68, v[48:51]
    v_mfma_f32_16x16x4_f32 v[52:55], v88, v70, v[52:55]
    v_mfma_f32_16x16x4_f32 v[56:59], v88, v72, v[56:59]
    v_mfma_f32_16x16x4_f32 v[60:63], v90, v74, v[60:63]
    v_mfma_f32_16x16x4_f32 v[48:51], v87, v69, v[48:51]
    v_mfma_f32_16x16x4_f32 v[52:55], v89, v71, v[52:55]
    v_mfma_f32_16x16x4_f32 v[56:59], v89, v73, v[56:59]
    v_mfma_f32_16x16x4_f32 v[60:63], v91, v75, v[60:63]
    v_mov_b64_dpp v[64:65], v[28:29] row_newbcast:11 row_mask:0xf bank_mask:0xf
    v_mov_b64_dpp v[66:67], v[30:31] row_newbcast:11 row_mask:0xf bank_mask:0xf
    v_pk_mul_f32 v[94:95], v[64:65], v[26:27] op_sel_hi:[1,0]
    v_pk_mul_f32 v[96:97], v[64:65], v[26:27] op_sel:[0,1] op_sel_hi:[1,1]
    v_fract_f32 v95, v95
    v_fract_f32 v97, v97
    v_exp_f32 v94, v94
    v_exp_f32 v96, v96
    v_cos_f32 v68, v95
    v_sin_f32 v69, v95
    v_cos_f32 v76, v97
    v_sin_f32 v77, v97
    v_pk_mul_f32 v[68:69], v[68:69], v[94:95] op_sel_hi:[1,0]
    v_pk_mul_f32 v[76:77], v[76:77], v[96:97] op_sel_hi:[1,0]
    v_pk_mul_f32 v[92:93], v[76:77], v[76:77] op_sel:[1,1] op_sel_hi:[0,1]
    v_pk_fma_f32 v[78:79], v[76:77], v[76:77], v[92:93] op_sel:[0,0,0] op_sel_hi:[0,1,1] neg_lo:[0,0,1]
    v_pk_mul_f32 v[94:95], v[68:69], v[68:69] op_sel:[1,1] op_sel_hi:[0,1]
    v_pk_fma_f32 v[70:71], v[68:69], v[68:69], v[94:95] op_sel:[0,0,0] op_sel_hi:[0,1,1] neg_lo:[0,0,1]
    v_pk_mul_f32 v[92:93], v[78:79], v[78:79] op_sel:[1,1] op_sel_hi:[0,1]
    v_pk_fma_f32 v[80:81], v[78:79], v[78:79], v[92:93] op_sel:[0,0,0] op_sel_hi:[0,1,1] neg_lo:[0,0,1]
    v_pk_mul_f32 v[94:95], v[70:71], v[70:71] op_sel:[1,1] op_sel_hi:[0,1]
    v_pk_fma_f32 v[72:73], v[70:71], v[70:71], v[94:95] op_sel:[0,0,0] op_sel_hi:[0,1,1] neg_lo:[0,0,1]
    v_pk_mul_f32 v[92:93], v[80:81], v[80:81] op_sel:[1,1] op_sel_hi:[0,1]
    v_pk_fma_f32 v[82:83], v[80:81], v[80:81], v[92:93] op_sel:[0,0,0] op_sel_hi:[0,1,1] neg_lo:[0,0,1]
    v_pk_mul_f32 v[94:95], v[72:73], v[72:73] op_sel:[1,1] op_sel_hi:[0,1]
    v_pk_fma_f32 v[74:75], v[72:73], v[72:73], v[94:95] op_sel:[0,0,0] op_sel_hi:[0,1,1] neg_lo:[0,0,1]
    v_pk_mul_f32 v[92:93], v[82:83], v[82:83] op_sel:[1,1] op_sel_hi:[0,1]
    v_pk_fma_f32 v[84:85], v[82:83], v[82:83], v[92:93] op_sel:[0,0,0] op_sel_hi:[0,1,1] neg_lo:[0,0,1]
    v_pk_mul_f32 v[94:95], v[66:67], v[76:77] op_sel:[1,1] op_sel_hi:[1,0]
    v_pk_fma_f32 v[86:87], v[66:67], v[76:77], v[94:95] op_sel:[0,0,0] op_sel_hi:[0,1,1] neg_lo:[0,0,1] neg_hi:[1,0,1]
    v_mov_b32_dpp v80, v78 row_ror:8 row_mask:0xf bank_mask:0x3
    v_mov_b32_dpp v81, v79 row_ror:8 row_mask:0xf bank_mask:0x3
    v_mov_b32_dpp v82, v84 row_ror:8 row_mask:0xf bank_mask:0x3
    v_mov_b32_dpp v83, v85 row_ror:8 row_mask:0xf bank_mask:0x3
    v_pk_mul_f32 v[92:93], v[66:67], v[80:81] op_sel:[1,1] op_sel_hi:[1,0]
    v_pk_fma_f32 v[88:89], v[66:67], v[80:81], v[92:93] op_sel:[0,0,0] op_sel_hi:[0,1,1] neg_lo:[0,0,1] neg_hi:[1,0,1]
    v_pk_mul_f32 v[94:95], v[66:67], v[82:83] op_sel:[1,1] op_sel_hi:[1,0]
    v_pk_fma_f32 v[90:91], v[66:67], v[82:83], v[94:95] op_sel:[0,0,0] op_sel_hi:[0,1,1] neg_lo:[0,0,1] neg_hi:[1,0,1]
    v_mfma_f32_16x16x4_f32 v[48:51], v86, v68, v[48:51]
    v_mfma_f32_16x16x4_f32 v[52:55], v88, v70, v[52:55]
    v_mfma_f32_16x16x4_f32 v[56:59], v88, v72, v[56:59]
    v_mfma_f32_16x16x4_f32 v[60:63], v90, v74, v[60:63]
    v_mfma_f32_16x16x4_f32 v[48:51], v87, v69, v[48:51]
    v_mfma_f32_16x16x4_f32 v[52:55], v89, v71, v[52:55]
    v_mfma_f32_16x16x4_f32 v[56:59], v89, v73, v[56:59]
    v_mfma_f32_16x16x4_f32 v[60:63], v91, v75, v[60:63]
    v_mov_b64_dpp v[64:65], v[28:29] row_newbcast:12 row_mask:0xf bank_mask:0xf
    v_mov_b64_dpp v[66:67], v[30:31] row_newbcast:12 row_mask:0xf bank_mask:0xf
    v_pk_mul_f32 v[94:95], v[64:65], v[26:27] op_sel_hi:[1,0]
    v_pk_mul_f32 v[96:97], v[64:65], v[26:27] op_sel:[0,1] op_sel_hi:[1,1]
    v_fract_f32 v95, v95
    v_fract_f32 v97, v97
    v_exp_f32 v94, v94
    v_exp_f32 v96, v96
    v_cos_f32 v68, v95
    v_sin_f32 v69, v95
    v_cos_f32 v76, v97
    v_sin_f32 v77, v97
    v_pk_mul_f32 v[68:69], v[68:69], v[94:95] op_sel_hi:[1,0]
    v_pk_mul_f32 v[76:77], v[76:77], v[96:97] op_sel_hi:[1,0]
    v_pk_mul_f32 v[92:93], v[76:77], v[76:77] op_sel:[1,1] op_sel_hi:[0,1]
    v_pk_fma_f32 v[78:79], v[76:77], v[76:77], v[92:93] op_sel:[0,0,0] op_sel_hi:[0,1,1] neg_lo:[0,0,1]
    v_pk_mul_f32 v[94:95], v[68:69], v[68:69] op_sel:[1,1] op_sel_hi:[0,1]
    v_pk_fma_f32 v[70:71], v[68:69], v[68:69], v[94:95] op_sel:[0,0,0] op_sel_hi:[0,1,1] neg_lo:[0,0,1]
    v_pk_mul_f32 v[92:93], v[78:79], v[78:79] op_sel:[1,1] op_sel_hi:[0,1]
    v_pk_fma_f32 v[80:81], v[78:79], v[78:79], v[92:93] op_sel:[0,0,0] op_sel_hi:[0,1,1] neg_lo:[0,0,1]
    v_pk_mul_f32 v[94:95], v[70:71], v[70:71] op_sel:[1,1] op_sel_hi:[0,1]
    v_pk_fma_f32 v[72:73], v[70:71], v[70:71], v[94:95] op_sel:[0,0,0] op_sel_hi:[0,1,1] neg_lo:[0,0,1]
    v_pk_mul_f32 v[92:93], v[80:81], v[80:81] op_sel:[1,1] op_sel_hi:[0,1]
    v_pk_fma_f32 v[82:83], v[80:81], v[80:81], v[92:93] op_sel:[0,0,0] op_sel_hi:[0,1,1] neg_lo:[0,0,1]
    v_pk_mul_f32 v[94:95], v[72:73], v[72:73] op_sel:[1,1] op_sel_hi:[0,1]
    v_pk_fma_f32 v[74:75], v[72:73], v[72:73], v[94:95] op_sel:[0,0,0] op_sel_hi:[0,1,1] neg_lo:[0,0,1]
    v_pk_mul_f32 v[92:93], v[82:83], v[82:83] op_sel:[1,1] op_sel_hi:[0,1]
    v_pk_fma_f32 v[84:85], v[82:83], v[82:83], v[92:93] op_sel:[0,0,0] op_sel_hi:[0,1,1] neg_lo:[0,0,1]
    v_pk_mul_f32 v[94:95], v[66:67], v[76:77] op_sel:[1,1] op_sel_hi:[1,0]
    v_pk_fma_f32 v[86:87], v[66:67], v[76:77], v[94:95] op_sel:[0,0,0] op_sel_hi:[0,1,1] neg_lo:[0,0,1] neg_hi:[1,0,1]
    v_mov_b32_dpp v80, v78 row_ror:8 row_mask:0xf bank_mask:0x3
    v_mov_b32_dpp v81, v79 row_ror:8 row_mask:0xf bank_mask:0x3
    v_mov_b32_dpp v82, v84 row_ror:8 row_mask:0xf bank_mask:0x3
    v_mov_b32_dpp v83, v85 row_ror:8 row_mask:0xf bank_mask:0x3
    v_pk_mul_f32 v[92:93], v[66:67], v[80:81] op_sel:[1,1] op_sel_hi:[1,0]
    v_pk_fma_f32 v[88:89], v[66:67], v[80:81], v[92:93] op_sel:[0,0,0] op_sel_hi:[0,1,1] neg_lo:[0,0,1] neg_hi:[1,0,1]
    v_pk_mul_f32 v[94:95], v[66:67], v[82:83] op_sel:[1,1] op_sel_hi:[1,0]
    v_pk_fma_f32 v[90:91], v[66:67], v[82:83], v[94:95] op_sel:[0,0,0] op_sel_hi:[0,1,1] neg_lo:[0,0,1] neg_hi:[1,0,1]
    v_mfma_f32_16x16x4_f32 v[48:51], v86, v68, v[48:51]
    v_mfma_f32_16x16x4_f32 v[52:55], v88, v70, v[52:55]
    v_mfma_f32_16x16x4_f32 v[56:59], v88, v72, v[56:59]
    v_mfma_f32_16x16x4_f32 v[60:63], v90, v74, v[60:63]
    v_mfma_f32_16x16x4_f32 v[48:51], v87, v69, v[48:51]
    v_mfma_f32_16x16x4_f32 v[52:55], v89, v71, v[52:55]
    v_mfma_f32_16x16x4_f32 v[56:59], v89, v73, v[56:59]
    v_mfma_f32_16x16x4_f32 v[60:63], v91, v75, v[60:63]
    v_mov_b64_dpp v[64:65], v[28:29] row_newbcast:13 row_mask:0xf bank_mask:0xf
    v_mov_b64_dpp v[66:67], v[30:31] row_newbcast:13 row_mask:0xf bank_mask:0xf
    v_pk_mul_f32 v[94:95], v[64:65], v[26:27] op_sel_hi:[1,0]
    v_pk_mul_f32 v[96:97], v[64:65], v[26:27] op_sel:[0,1] op_sel_hi:[1,1]
    v_fract_f32 v95, v95
    v_fract_f32 v97, v97
    v_exp_f32 v94, v94
    v_exp_f32 v96, v96
    v_cos_f32 v68, v95
    v_sin_f32 v69, v95
    v_cos_f32 v76, v97
    v_sin_f32 v77, v97
    v_pk_mul_f32 v[68:69], v[68:69], v[94:95] op_sel_hi:[1,0]
    v_pk_mul_f32 v[76:77], v[76:77], v[96:97] op_sel_hi:[1,0]
    v_pk_mul_f32 v[92:93], v[76:77], v[76:77] op_sel:[1,1] op_sel_hi:[0,1]
    v_pk_fma_f32 v[78:79], v[76:77], v[76:77], v[92:93] op_sel:[0,0,0] op_sel_hi:[0,1,1] neg_lo:[0,0,1]
    v_pk_mul_f32 v[94:95], v[68:69], v[68:69] op_sel:[1,1] op_sel_hi:[0,1]
    v_pk_fma_f32 v[70:71], v[68:69], v[68:69], v[94:95] op_sel:[0,0,0] op_sel_hi:[0,1,1] neg_lo:[0,0,1]
    v_pk_mul_f32 v[92:93], v[78:79], v[78:79] op_sel:[1,1] op_sel_hi:[0,1]
    v_pk_fma_f32 v[80:81], v[78:79], v[78:79], v[92:93] op_sel:[0,0,0] op_sel_hi:[0,1,1] neg_lo:[0,0,1]
    v_pk_mul_f32 v[94:95], v[70:71], v[70:71] op_sel:[1,1] op_sel_hi:[0,1]
    v_pk_fma_f32 v[72:73], v[70:71], v[70:71], v[94:95] op_sel:[0,0,0] op_sel_hi:[0,1,1] neg_lo:[0,0,1]
    v_pk_mul_f32 v[92:93], v[80:81], v[80:81] op_sel:[1,1] op_sel_hi:[0,1]
    v_pk_fma_f32 v[82:83], v[80:81], v[80:81], v[92:93] op_sel:[0,0,0] op_sel_hi:[0,1,1] neg_lo:[0,0,1]
    v_pk_mul_f32 v[94:95], v[72:73], v[72:73] op_sel:[1,1] op_sel_hi:[0,1]
    v_pk_fma_f32 v[74:75], v[72:73], v[72:73], v[94:95] op_sel:[0,0,0] op_sel_hi:[0,1,1] neg_lo:[0,0,1]
    v_pk_mul_f32 v[92:93], v[82:83], v[82:83] op_sel:[1,1] op_sel_hi:[0,1]
    v_pk_fma_f32 v[84:85], v[82:83], v[82:83], v[92:93] op_sel:[0,0,0] op_sel_hi:[0,1,1] neg_lo:[0,0,1]
    v_pk_mul_f32 v[94:95], v[66:67], v[76:77] op_sel:[1,1] op_sel_hi:[1,0]
    v_pk_fma_f32 v[86:87], v[66:67], v[76:77], v[94:95] op_sel:[0,0,0] op_sel_hi:[0,1,1] neg_lo:[0,0,1] neg_hi:[1,0,1]
    v_mov_b32_dpp v80, v78 row_ror:8 row_mask:0xf bank_mask:0x3
    v_mov_b32_dpp v81, v79 row_ror:8 row_mask:0xf bank_mask:0x3
    v_mov_b32_dpp v82, v84 row_ror:8 row_mask:0xf bank_mask:0x3
    v_mov_b32_dpp v83, v85 row_ror:8 row_mask:0xf bank_mask:0x3
    v_pk_mul_f32 v[92:93], v[66:67], v[80:81] op_sel:[1,1] op_sel_hi:[1,0]
    v_pk_fma_f32 v[88:89], v[66:67], v[80:81], v[92:93] op_sel:[0,0,0] op_sel_hi:[0,1,1] neg_lo:[0,0,1] neg_hi:[1,0,1]
    v_pk_mul_f32 v[94:95], v[66:67], v[82:83] op_sel:[1,1] op_sel_hi:[1,0]
    v_pk_fma_f32 v[90:91], v[66:67], v[82:83], v[94:95] op_sel:[0,0,0] op_sel_hi:[0,1,1] neg_lo:[0,0,1] neg_hi:[1,0,1]
    v_mfma_f32_16x16x4_f32 v[48:51], v86, v68, v[48:51]
    v_mfma_f32_16x16x4_f32 v[52:55], v88, v70, v[52:55]
    v_mfma_f32_16x16x4_f32 v[56:59], v88, v72, v[56:59]
    v_mfma_f32_16x16x4_f32 v[60:63], v90, v74, v[60:63]
    v_mfma_f32_16x16x4_f32 v[48:51], v87, v69, v[48:51]
    v_mfma_f32_16x16x4_f32 v[52:55], v89, v71, v[52:55]
    v_mfma_f32_16x16x4_f32 v[56:59], v89, v73, v[56:59]
    v_mfma_f32_16x16x4_f32 v[60:63], v91, v75, v[60:63]
    v_mov_b64_dpp v[64:65], v[28:29] row_newbcast:14 row_mask:0xf bank_mask:0xf
    v_mov_b64_dpp v[66:67], v[30:31] row_newbcast:14 row_mask:0xf bank_mask:0xf
    v_pk_mul_f32 v[94:95], v[64:65], v[26:27] op_sel_hi:[1,0]
    v_pk_mul_f32 v[96:97], v[64:65], v[26:27] op_sel:[0,1] op_sel_hi:[1,1]
    v_fract_f32 v95, v95
    v_fract_f32 v97, v97
    v_exp_f32 v94, v94
    v_exp_f32 v96, v96
    v_cos_f32 v68, v95
    v_sin_f32 v69, v95
    v_cos_f32 v76, v97
    v_sin_f32 v77, v97
    v_pk_mul_f32 v[68:69], v[68:69], v[94:95] op_sel_hi:[1,0]
    v_pk_mul_f32 v[76:77], v[76:77], v[96:97] op_sel_hi:[1,0]
    v_pk_mul_f32 v[92:93], v[76:77], v[76:77] op_sel:[1,1] op_sel_hi:[0,1]
    v_pk_fma_f32 v[78:79], v[76:77], v[76:77], v[92:93] op_sel:[0,0,0] op_sel_hi:[0,1,1] neg_lo:[0,0,1]
    v_pk_mul_f32 v[94:95], v[68:69], v[68:69] op_sel:[1,1] op_sel_hi:[0,1]
    v_pk_fma_f32 v[70:71], v[68:69], v[68:69], v[94:95] op_sel:[0,0,0] op_sel_hi:[0,1,1] neg_lo:[0,0,1]
    v_pk_mul_f32 v[92:93], v[78:79], v[78:79] op_sel:[1,1] op_sel_hi:[0,1]
    v_pk_fma_f32 v[80:81], v[78:79], v[78:79], v[92:93] op_sel:[0,0,0] op_sel_hi:[0,1,1] neg_lo:[0,0,1]
    v_pk_mul_f32 v[94:95], v[70:71], v[70:71] op_sel:[1,1] op_sel_hi:[0,1]
    v_pk_fma_f32 v[72:73], v[70:71], v[70:71], v[94:95] op_sel:[0,0,0] op_sel_hi:[0,1,1] neg_lo:[0,0,1]
    v_pk_mul_f32 v[92:93], v[80:81], v[80:81] op_sel:[1,1] op_sel_hi:[0,1]
    v_pk_fma_f32 v[82:83], v[80:81], v[80:81], v[92:93] op_sel:[0,0,0] op_sel_hi:[0,1,1] neg_lo:[0,0,1]
    v_pk_mul_f32 v[94:95], v[72:73], v[72:73] op_sel:[1,1] op_sel_hi:[0,1]
    v_pk_fma_f32 v[74:75], v[72:73], v[72:73], v[94:95] op_sel:[0,0,0] op_sel_hi:[0,1,1] neg_lo:[0,0,1]
    v_pk_mul_f32 v[92:93], v[82:83], v[82:83] op_sel:[1,1] op_sel_hi:[0,1]
    v_pk_fma_f32 v[84:85], v[82:83], v[82:83], v[92:93] op_sel:[0,0,0] op_sel_hi:[0,1,1] neg_lo:[0,0,1]
    v_pk_mul_f32 v[94:95], v[66:67], v[76:77] op_sel:[1,1] op_sel_hi:[1,0]
    v_pk_fma_f32 v[86:87], v[66:67], v[76:77], v[94:95] op_sel:[0,0,0] op_sel_hi:[0,1,1] neg_lo:[0,0,1] neg_hi:[1,0,1]
    v_mov_b32_dpp v80, v78 row_ror:8 row_mask:0xf bank_mask:0x3
    v_mov_b32_dpp v81, v79 row_ror:8 row_mask:0xf bank_mask:0x3
    v_mov_b32_dpp v82, v84 row_ror:8 row_mask:0xf bank_mask:0x3
    v_mov_b32_dpp v83, v85 row_ror:8 row_mask:0xf bank_mask:0x3
    v_pk_mul_f32 v[92:93], v[66:67], v[80:81] op_sel:[1,1] op_sel_hi:[1,0]
    v_pk_fma_f32 v[88:89], v[66:67], v[80:81], v[92:93] op_sel:[0,0,0] op_sel_hi:[0,1,1] neg_lo:[0,0,1] neg_hi:[1,0,1]
    v_pk_mul_f32 v[94:95], v[66:67], v[82:83] op_sel:[1,1] op_sel_hi:[1,0]
    v_pk_fma_f32 v[90:91], v[66:67], v[82:83], v[94:95] op_sel:[0,0,0] op_sel_hi:[0,1,1] neg_lo:[0,0,1] neg_hi:[1,0,1]
    v_mfma_f32_16x16x4_f32 v[48:51], v86, v68, v[48:51]
    v_mfma_f32_16x16x4_f32 v[52:55], v88, v70, v[52:55]
    v_mfma_f32_16x16x4_f32 v[56:59], v88, v72, v[56:59]
    v_mfma_f32_16x16x4_f32 v[60:63], v90, v74, v[60:63]
    v_mfma_f32_16x16x4_f32 v[48:51], v87, v69, v[48:51]
    v_mfma_f32_16x16x4_f32 v[52:55], v89, v71, v[52:55]
    v_mfma_f32_16x16x4_f32 v[56:59], v89, v73, v[56:59]
    v_mfma_f32_16x16x4_f32 v[60:63], v91, v75, v[60:63]
    v_mov_b64_dpp v[64:65], v[28:29] row_newbcast:15 row_mask:0xf bank_mask:0xf
    v_mov_b64_dpp v[66:67], v[30:31] row_newbcast:15 row_mask:0xf bank_mask:0xf
    v_pk_mul_f32 v[94:95], v[64:65], v[26:27] op_sel_hi:[1,0]
    v_pk_mul_f32 v[96:97], v[64:65], v[26:27] op_sel:[0,1] op_sel_hi:[1,1]
    v_fract_f32 v95, v95
    v_fract_f32 v97, v97
    v_exp_f32 v94, v94
    v_exp_f32 v96, v96
    v_cos_f32 v68, v95
    v_sin_f32 v69, v95
    v_cos_f32 v76, v97
    v_sin_f32 v77, v97
    v_pk_mul_f32 v[68:69], v[68:69], v[94:95] op_sel_hi:[1,0]
    v_pk_mul_f32 v[76:77], v[76:77], v[96:97] op_sel_hi:[1,0]
    v_pk_mul_f32 v[92:93], v[76:77], v[76:77] op_sel:[1,1] op_sel_hi:[0,1]
    v_pk_fma_f32 v[78:79], v[76:77], v[76:77], v[92:93] op_sel:[0,0,0] op_sel_hi:[0,1,1] neg_lo:[0,0,1]
    v_pk_mul_f32 v[94:95], v[68:69], v[68:69] op_sel:[1,1] op_sel_hi:[0,1]
    v_pk_fma_f32 v[70:71], v[68:69], v[68:69], v[94:95] op_sel:[0,0,0] op_sel_hi:[0,1,1] neg_lo:[0,0,1]
    v_pk_mul_f32 v[92:93], v[78:79], v[78:79] op_sel:[1,1] op_sel_hi:[0,1]
    v_pk_fma_f32 v[80:81], v[78:79], v[78:79], v[92:93] op_sel:[0,0,0] op_sel_hi:[0,1,1] neg_lo:[0,0,1]
    v_pk_mul_f32 v[94:95], v[70:71], v[70:71] op_sel:[1,1] op_sel_hi:[0,1]
    v_pk_fma_f32 v[72:73], v[70:71], v[70:71], v[94:95] op_sel:[0,0,0] op_sel_hi:[0,1,1] neg_lo:[0,0,1]
    v_pk_mul_f32 v[92:93], v[80:81], v[80:81] op_sel:[1,1] op_sel_hi:[0,1]
    v_pk_fma_f32 v[82:83], v[80:81], v[80:81], v[92:93] op_sel:[0,0,0] op_sel_hi:[0,1,1] neg_lo:[0,0,1]
    v_pk_mul_f32 v[94:95], v[72:73], v[72:73] op_sel:[1,1] op_sel_hi:[0,1]
    v_pk_fma_f32 v[74:75], v[72:73], v[72:73], v[94:95] op_sel:[0,0,0] op_sel_hi:[0,1,1] neg_lo:[0,0,1]
    v_pk_mul_f32 v[92:93], v[82:83], v[82:83] op_sel:[1,1] op_sel_hi:[0,1]
    v_pk_fma_f32 v[84:85], v[82:83], v[82:83], v[92:93] op_sel:[0,0,0] op_sel_hi:[0,1,1] neg_lo:[0,0,1]
    v_pk_mul_f32 v[94:95], v[66:67], v[76:77] op_sel:[1,1] op_sel_hi:[1,0]
    v_pk_fma_f32 v[86:87], v[66:67], v[76:77], v[94:95] op_sel:[0,0,0] op_sel_hi:[0,1,1] neg_lo:[0,0,1] neg_hi:[1,0,1]
    v_mov_b32_dpp v80, v78 row_ror:8 row_mask:0xf bank_mask:0x3
    v_mov_b32_dpp v81, v79 row_ror:8 row_mask:0xf bank_mask:0x3
    v_mov_b32_dpp v82, v84 row_ror:8 row_mask:0xf bank_mask:0x3
    v_mov_b32_dpp v83, v85 row_ror:8 row_mask:0xf bank_mask:0x3
    v_pk_mul_f32 v[92:93], v[66:67], v[80:81] op_sel:[1,1] op_sel_hi:[1,0]
    v_pk_fma_f32 v[88:89], v[66:67], v[80:81], v[92:93] op_sel:[0,0,0] op_sel_hi:[0,1,1] neg_lo:[0,0,1] neg_hi:[1,0,1]
    v_pk_mul_f32 v[94:95], v[66:67], v[82:83] op_sel:[1,1] op_sel_hi:[1,0]
    v_pk_fma_f32 v[90:91], v[66:67], v[82:83], v[94:95] op_sel:[0,0,0] op_sel_hi:[0,1,1] neg_lo:[0,0,1] neg_hi:[1,0,1]
    v_mfma_f32_16x16x4_f32 v[48:51], v86, v68, v[48:51]
    v_mfma_f32_16x16x4_f32 v[52:55], v88, v70, v[52:55]
    v_mfma_f32_16x16x4_f32 v[56:59], v88, v72, v[56:59]
    v_mfma_f32_16x16x4_f32 v[60:63], v90, v74, v[60:63]
    v_mfma_f32_16x16x4_f32 v[48:51], v87, v69, v[48:51]
    v_mfma_f32_16x16x4_f32 v[52:55], v89, v71, v[52:55]
    v_mfma_f32_16x16x4_f32 v[56:59], v89, v73, v[56:59]
    v_mfma_f32_16x16x4_f32 v[60:63], v91, v75, v[60:63]
    v_mov_b64 v[28:29], v[32:33]
    v_mov_b64 v[30:31], v[34:35]
    s_add_u32 s25, s25, 1
    s_cmp_lt_u32 s25, 2
    s_cbranch_scc1 ss_kg
    s_cmp_lg_u32 s28, 0
    s_cbranch_scc1 ss_nostage
    s_waitcnt vmcnt(0)
    v_mov_b32 v36, 0x05040100
    v_mov_b32 v37, 0x07060302
    v_lshlrev_b32 v6, 4, v0
    v_add_u32 v7, 65536, v6
    v_perm_b32 v40, v212, v208, v36
    v_perm_b32 v41, v220, v216, v36
    v_perm_b32 v42, v228, v224, v36
    v_perm_b32 v43, v236, v232, v36
    ds_write_b128 v6, v[40:43] offset:512
    v_perm_b32 v44, v212, v208, v37
    v_perm_b32 v45, v220, v216, v37
    v_perm_b32 v46, v228, v224, v37
    v_perm_b32 v47, v236, v232, v37
    ds_write_b128 v6, v[44:47] offset:16896
    v_perm_b32 v40, v213, v209, v36
    v_perm_b32 v41, v221, v217, v36
    v_perm_b32 v42, v229, v225, v36
    v_perm_b32 v43, v237, v233, v36
    ds_write_b128 v6, v[40:43] offset:33280
    v_perm_b32 v44, v213, v209, v37
    v_perm_b32 v45, v221, v217, v37
    v_perm_b32 v46, v229, v225, v37
    v_perm_b32 v47, v237, v233, v37
    ds_write_b128 v6, v[44:47] offset:49664
    v_perm_b32 v40, v214, v210, v36
    v_perm_b32 v41, v222, v218, v36
    v_perm_b32 v42, v230, v226, v36
    v_perm_b32 v43, v238, v234, v36
    ds_write_b128 v7, v[40:43] offset:512
    v_perm_b32 v44, v214, v210, v37
    v_perm_b32 v45, v222, v218, v37
    v_perm_b32 v46, v230, v226, v37
    v_perm_b32 v47, v238, v234, v37
    ds_write_b128 v7, v[44:47] offset:16896
    v_perm_b32 v40, v215, v211, v36
    v_perm_b32 v41, v223, v219, v36
    v_perm_b32 v42, v231, v227, v36
    v_perm_b32 v43, v239, v235, v36
    ds_write_b128 v7, v[40:43] offset:33280
    v_perm_b32 v44, v215, v211, v37
    v_perm_b32 v45, v223, v219, v37
    v_perm_b32 v46, v231, v227, v37
    v_perm_b32 v47, v239, v235, v37
    ds_write_b128 v7, v[44:47] offset:49664
ss_nostage:
    s_nop 11
    v_lshlrev_b32 v5, 8, v3
    v_lshl_add_u32 v5, v2, 2, v5
    v_add_u32 v5, v5, v4
    ds_write_b32 v5, v48 offset:4608
    ds_write_b32 v5, v49 offset:4672
    ds_write_b32 v5, v50 offset:4736
    ds_write_b32 v5, v51 offset:4800
    s_mov_b32 exec_hi, 0
    ds_write_b32 v5, v52 offset:5632
    ds_write_b32 v5, v53 offset:5696
    ds_write_b32 v5, v54 offset:5760
    ds_write_b32 v5, v55 offset:5824
    s_not_b64 exec, exec
    ds_write_b32 v5, v56 offset:5632
    ds_write_b32 v5, v57 offset:5696
    ds_write_b32 v5, v58 offset:5760
    ds_write_b32 v5, v59 offset:5824
    ds_write_b32 v5, v60 offset:6144
    ds_write_b32 v5, v61 offset:6208
    ds_write_b32 v5, v62 offset:6272
    ds_write_b32 v5, v63 offset:6336
    s_mov_b64 exec, 3
    v_cmp_eq_u32 vcc, 0, v2
    s_nop 1
    v_cndmask_b32 v6, 0, v60, vcc
    ds_write_b32 v5, v6 offset:7168
    s_mov_b64 exec, -1
    s_waitcnt lgkmcnt(0)
    v_lshlrev_b32 v7, 1, v1
    v_sub_u32 v7, 2065, v7
    v_lshl_add_u32 v64, v1, 2, v4
    v_mov_b32 v65, 641
    s_mov_b32 s25, 9
    s_mov_b32 s22, 256
    s_mov_b32 s23, 2048
ss_exp:
    v_subrev_u32 v66, 0, v7
    v_cvt_f32_u32 v72, v66
    v_cmp_gt_u32 vcc, s22, v66
    v_cvt_pk_bf16_f32 v72, v72, 0
    v_subrev_u32 v72, 0x4280, v72
    v_cndmask_b32 v72, v72, v66, vcc
    v_cmp_gt_u32 vcc, s23, v66
    s_nop 1
    v_cndmask_b32 v72, v65, v72, vcc
    v_lshl_add_u32 v72, v72, 2, v4
    v_subrev_u32 v67, 1, v7
    v_cvt_f32_u32 v73, v67
    v_cmp_gt_u32 vcc, s22, v67
    v_cvt_pk_bf16_f32 v73, v73, 0
    v_subrev_u32 v73, 0x4280, v73
    v_cndmask_b32 v73, v73, v67, vcc
    v_cmp_gt_u32 vcc, s23, v67
    ds_read_b32 v78, v72 offset:4608
    s_nop 0
    v_cndmask_b32 v73, v65, v73, vcc
    v_lshl_add_u32 v73, v73, 2, v4
    v_subrev_u32 v68, 2, v7
    v_cvt_f32_u32 v74, v68
    v_cmp_gt_u32 vcc, s22, v68
    v_cvt_pk_bf16_f32 v74, v74, 0
    v_subrev_u32 v74, 0x4280, v74
    v_cndmask_b32 v74, v74, v68, vcc
    v_cmp_gt_u32 vcc, s23, v68
    ds_read_b32 v79, v73 offset:4608
    s_nop 0
    v_cndmask_b32 v74, v65, v74, vcc
    v_lshl_add_u32 v74, v74, 2, v4
    v_subrev_u32 v69, 128, v7
    v_cvt_f32_u32 v75, v69
    v_cmp_gt_u32 vcc, s22, v69
    v_cvt_pk_bf16_f32 v75, v75, 0
    v_subrev_u32 v75, 0x4280, v75
    v_cndmask_b32 v75, v75, v69, vcc
    v_cmp_gt_u32 vcc, s23, v69
    ds_read_b32 v80, v74 offset:4608
    s_nop 0
    v_cndmask_b32 v75, v65, v75, vcc
    v_lshl_add_u32 v75, v75, 2, v4
    v_subrev_u32 v70, 129, v7
    v_cvt_f32_u32 v76, v70
    v_cmp_gt_u32 vcc, s22, v70
    v_cvt_pk_bf16_f32 v76, v76, 0
    v_subrev_u32 v76, 0x4280, v76
    v_cndmask_b32 v76, v76, v70, vcc
    v_cmp_gt_u32 vcc, s23, v70
    ds_read_b32 v81, v75 offset:4608
    s_nop 0
    v_cndmask_b32 v76, v65, v76, vcc
    v_lshl_add_u32 v76, v76, 2, v4
    v_subrev_u32 v71, 130, v7
    v_cvt_f32_u32 v77, v71
    v_cmp_gt_u32 vcc, s22, v71
    v_cvt_pk_bf16_f32 v77, v77, 0
    v_subrev_u32 v77, 0x4280, v77
    v_cndmask_b32 v77, v77, v71, vcc
    v_cmp_gt_u32 vcc, s23, v71
    ds_read_b32 v82, v76 offset:4608
    s_nop 0
    v_cndmask_b32 v77, v65, v77, vcc
    v_lshl_add_u32 v77, v77, 2, v4
    ds_read_b32 v83, v77 offset:4608
    v_subrev_u32 v7, 256, v7
    s_sub_u32 s25, s25, 1
    s_waitcnt lgkmcnt(0)
    v_cvt_pk_bf16_f32 v84, v79, v80
    v_cvt_pk_bf16_f32 v85, v78, v79
    v_cvt_pk_bf16_f32 v86, v82, v83
    v_cvt_pk_bf16_f32 v87, v81, v82
    ds_write_b32 v64, v84 offset:7424
    ds_write_b32 v64, v85 offset:11776
    s_cmp_eq_u32 s25, 0
    s_cbranch_scc1 ss_expx
    ds_write_b32 v64, v86 offset:7680
    ds_write_b32 v64, v87 offset:12032
    v_add_u32 v64, 512, v64
    s_nop 1
    s_branch ss_exp
ss_expx:
    s_waitcnt lgkmcnt(0)
    s_barrier
    v_and_b32 v5, 1, v2
    v_mul_u32_u24 v36, 4352, v5
    v_sub_u32 v5, v5, v2
    v_lshl_add_u32 v5, v3, 3, v5
    v_lshl_add_u32 v36, v5, 1, v36
    v_add_u32 v36, 11072, v36
    v_add_u32 v36, v36, v4
    v_subrev_u32 v37, 512, v36
    v_subrev_u32 v38, 1024, v36
    v_subrev_u32 v39, 1536, v36
    v_subrev_u32 v40, 2048, v36
    v_subrev_u32 v41, 2560, v36
    v_subrev_u32 v42, 3072, v36
    v_subrev_u32 v43, 3584, v36
    v_lshlrev_b32 v44, 5, v2
    v_lshl_add_u32 v44, v3, 4, v44
    v_add_u32 v44, 32, v44
    v_add_u32 v44, v44, v4
    ds_read_b128 v[112:115], v44 offset:448
    ds_read2_b32 v[80:81], v36 offset0:112 offset1:113
    ds_read2_b32 v[82:83], v36 offset0:114 offset1:115
    ds_read_b128 v[116:119], v44 offset:960
    ds_read2_b32 v[84:85], v37 offset0:112 offset1:113
    ds_read2_b32 v[86:87], v37 offset0:114 offset1:115
    ds_read_b128 v[120:123], v44 offset:1472
    ds_read2_b32 v[88:89], v38 offset0:112 offset1:113
    ds_read2_b32 v[90:91], v38 offset0:114 offset1:115
    ds_read_b128 v[124:127], v44 offset:1984
    ds_read2_b32 v[92:93], v39 offset0:112 offset1:113
    ds_read2_b32 v[94:95], v39 offset0:114 offset1:115
    ds_read_b128 v[128:131], v44 offset:2496
    ds_read2_b32 v[96:97], v40 offset0:112 offset1:113
    ds_read2_b32 v[98:99], v40 offset0:114 offset1:115
    ds_read_b128 v[132:135], v44 offset:3008
    ds_read2_b32 v[100:101], v41 offset0:112 offset1:113
    ds_read2_b32 v[102:103], v41 offset0:114 offset1:115
    ds_read_b128 v[136:139], v44 offset:3520
    ds_read2_b32 v[104:105], v42 offset0:112 offset1:113
    ds_read2_b32 v[106:107], v42 offset0:114 offset1:115
    ds_read_b128 v[140:143], v44 offset:4032
    ds_read2_b32 v[108:109], v43 offset0:112 offset1:113
    ds_read2_b32 v[110:111], v43 offset0:114 offset1:115
    s_waitcnt lgkmcnt(0)
    v_mfma_f32_16x16x32_bf16 v[48:51], v[80:83], v[112:115], 0
    ds_read_b128 v[176:179], v44 offset:384
    v_mfma_f32_16x16x32_bf16 v[52:55], v[80:83], v[116:119], 0
    ds_read2_b32 v[144:145], v36 offset0:96 offset1:97
    v_mfma_f32_16x16x32_bf16 v[56:59], v[80:83], v[120:123], 0
    ds_read2_b32 v[146:147], v36 offset0:98 offset1:99
    v_mfma_f32_16x16x32_bf16 v[60:63], v[80:83], v[124:127], 0
    ds_read_b128 v[180:183], v44 offset:896
    v_mfma_f32_16x16x32_bf16 v[64:67], v[80:83], v[128:131], 0
    ds_read2_b32 v[148:149], v37 offset0:96 offset1:97
    v_mfma_f32_16x16x32_bf16 v[68:71], v[80:83], v[132:135], 0
    ds_read2_b32 v[150:151], v37 offset0:98 offset1:99
    v_mfma_f32_16x16x32_bf16 v[72:75], v[80:83], v[136:139], 0
    ds_read_b128 v[184:187], v44 offset:1408
    v_mfma_f32_16x16x32_bf16 v[76:79], v[80:83], v[140:143], 0
    ds_read2_b32 v[152:153], v38 offset0:96 offset1:97
    v_mfma_f32_16x16x32_bf16 v[52:55], v[84:87], v[112:115], v[52:55]
    ds_read2_b32 v[154:155], v38 offset0:98 offset1:99
    v_mfma_f32_16x16x32_bf16 v[56:59], v[84:87], v[116:119], v[56:59]
    ds_read_b128 v[188:191], v44 offset:1920
    v_mfma_f32_16x16x32_bf16 v[60:63], v[84:87], v[120:123], v[60:63]
    ds_read2_b32 v[156:157], v39 offset0:96 offset1:97
    v_mfma_f32_16x16x32_bf16 v[64:67], v[84:87], v[124:127], v[64:67]
    ds_read2_b32 v[158:159], v39 offset0:98 offset1:99
    v_mfma_f32_16x16x32_bf16 v[68:71], v[84:87], v[128:131], v[68:71]
    ds_read_b128 v[192:195], v44 offset:2432
    v_mfma_f32_16x16x32_bf16 v[72:75], v[84:87], v[132:135], v[72:75]
    ds_read2_b32 v[160:161], v40 offset0:96 offset1:97
    v_mfma_f32_16x16x32_bf16 v[76:79], v[84:87], v[136:139], v[76:79]
    ds_read2_b32 v[162:163], v40 offset0:98 offset1:99
    v_mfma_f32_16x16x32_bf16 v[56:59], v[88:91], v[112:115], v[56:59]
    ds_read_b128 v[196:199], v44 offset:2944
    v_mfma_f32_16x16x32_bf16 v[60:63], v[88:91], v[116:119], v[60:63]
    ds_read2_b32 v[164:165], v41 offset0:96 offset1:97
    v_mfma_f32_16x16x32_bf16 v[64:67], v[88:91], v[120:123], v[64:67]
    ds_read2_b32 v[166:167], v41 offset0:98 offset1:99
    v_mfma_f32_16x16x32_bf16 v[68:71], v[88:91], v[124:127], v[68:71]
    ds_read_b128 v[200:203], v44 offset:3456
    v_mfma_f32_16x16x32_bf16 v[72:75], v[88:91], v[128:131], v[72:75]
    ds_read2_b32 v[168:169], v42 offset0:96 offset1:97
    v_mfma_f32_16x16x32_bf16 v[76:79], v[88:91], v[132:135], v[76:79]
    ds_read2_b32 v[170:171], v42 offset0:98 offset1:99
    v_mfma_f32_16x16x32_bf16 v[60:63], v[92:95], v[112:115], v[60:63]
    ds_read_b128 v[204:207], v44 offset:3968
    v_mfma_f32_16x16x32_bf16 v[64:67], v[92:95], v[116:119], v[64:67]
    ds_read2_b32 v[172:173], v43 offset0:96 offset1:97
    v_mfma_f32_16x16x32_bf16 v[68:71], v[92:95], v[120:123], v[68:71]
    ds_read2_b32 v[174:175], v43 offset0:98 offset1:99
    v_mfma_f32_16x16x32_bf16 v[72:75], v[92:95], v[124:127], v[72:75]
    v_mfma_f32_16x16x32_bf16 v[76:79], v[92:95], v[128:131], v[76:79]
    v_mfma_f32_16x16x32_bf16 v[64:67], v[96:99], v[112:115], v[64:67]
    v_mfma_f32_16x16x32_bf16 v[68:71], v[96:99], v[116:119], v[68:71]
    v_mfma_f32_16x16x32_bf16 v[72:75], v[96:99], v[120:123], v[72:75]
    v_mfma_f32_16x16x32_bf16 v[76:79], v[96:99], v[124:127], v[76:79]
    v_mfma_f32_16x16x32_bf16 v[68:71], v[100:103], v[112:115], v[68:71]
    v_mfma_f32_16x16x32_bf16 v[72:75], v[100:103], v[116:119], v[72:75]
    v_mfma_f32_16x16x32_bf16 v[76:79], v[100:103], v[120:123], v[76:79]
    v_mfma_f32_16x16x32_bf16 v[72:75], v[104:107], v[112:115], v[72:75]
    v_mfma_f32_16x16x32_bf16 v[76:79], v[104:107], v[116:119], v[76:79]
    v_mfma_f32_16x16x32_bf16 v[76:79], v[108:111], v[112:115], v[76:79]
    s_waitcnt lgkmcnt(0)
    v_mfma_f32_16x16x32_bf16 v[48:51], v[144:147], v[176:179], v[48:51]
    ds_read_b128 v[112:115], v44 offset:320
    v_mfma_f32_16x16x32_bf16 v[52:55], v[144:147], v[180:183], v[52:55]
    ds_read2_b32 v[80:81], v36 offset0:80 offset1:81
    v_mfma_f32_16x16x32_bf16 v[56:59], v[144:147], v[184:187], v[56:59]
    ds_read2_b32 v[82:83], v36 offset0:82 offset1:83
    v_mfma_f32_16x16x32_bf16 v[60:63], v[144:147], v[188:191], v[60:63]
    ds_read_b128 v[116:119], v44 offset:832
    v_mfma_f32_16x16x32_bf16 v[64:67], v[144:147], v[192:195], v[64:67]
    ds_read2_b32 v[84:85], v37 offset0:80 offset1:81
    v_mfma_f32_16x16x32_bf16 v[68:71], v[144:147], v[196:199], v[68:71]
    ds_read2_b32 v[86:87], v37 offset0:82 offset1:83
    v_mfma_f32_16x16x32_bf16 v[72:75], v[144:147], v[200:203], v[72:75]
    ds_read_b128 v[120:123], v44 offset:1344
    v_mfma_f32_16x16x32_bf16 v[76:79], v[144:147], v[204:207], v[76:79]
    ds_read2_b32 v[88:89], v38 offset0:80 offset1:81
    v_mfma_f32_16x16x32_bf16 v[52:55], v[148:151], v[176:179], v[52:55]
    ds_read2_b32 v[90:91], v38 offset0:82 offset1:83
    v_mfma_f32_16x16x32_bf16 v[56:59], v[148:151], v[180:183], v[56:59]
    ds_read_b128 v[124:127], v44 offset:1856
    v_mfma_f32_16x16x32_bf16 v[60:63], v[148:151], v[184:187], v[60:63]
    ds_read2_b32 v[92:93], v39 offset0:80 offset1:81
    v_mfma_f32_16x16x32_bf16 v[64:67], v[148:151], v[188:191], v[64:67]
    ds_read2_b32 v[94:95], v39 offset0:82 offset1:83
    v_mfma_f32_16x16x32_bf16 v[68:71], v[148:151], v[192:195], v[68:71]
    ds_read_b128 v[128:131], v44 offset:2368
    v_mfma_f32_16x16x32_bf16 v[72:75], v[148:151], v[196:199], v[72:75]
    ds_read2_b32 v[96:97], v40 offset0:80 offset1:81
    v_mfma_f32_16x16x32_bf16 v[76:79], v[148:151], v[200:203], v[76:79]
    ds_read2_b32 v[98:99], v40 offset0:82 offset1:83
    v_mfma_f32_16x16x32_bf16 v[56:59], v[152:155], v[176:179], v[56:59]
    ds_read_b128 v[132:135], v44 offset:2880
    v_mfma_f32_16x16x32_bf16 v[60:63], v[152:155], v[180:183], v[60:63]
    ds_read2_b32 v[100:101], v41 offset0:80 offset1:81
    v_mfma_f32_16x16x32_bf16 v[64:67], v[152:155], v[184:187], v[64:67]
    ds_read2_b32 v[102:103], v41 offset0:82 offset1:83
    v_mfma_f32_16x16x32_bf16 v[68:71], v[152:155], v[188:191], v[68:71]
    ds_read_b128 v[136:139], v44 offset:3392
    v_mfma_f32_16x16x32_bf16 v[72:75], v[152:155], v[192:195], v[72:75]
    ds_read2_b32 v[104:105], v42 offset0:80 offset1:81
    v_mfma_f32_16x16x32_bf16 v[76:79], v[152:155], v[196:199], v[76:79]
    ds_read2_b32 v[106:107], v42 offset0:82 offset1:83
    v_mfma_f32_16x16x32_bf16 v[60:63], v[156:159], v[176:179], v[60:63]
    ds_read_b128 v[140:143], v44 offset:3904
    v_mfma_f32_16x16x32_bf16 v[64:67], v[156:159], v[180:183], v[64:67]
    ds_read2_b32 v[108:109], v43 offset0:80 offset1:81
    v_mfma_f32_16x16x32_bf16 v[68:71], v[156:159], v[184:187], v[68:71]
    ds_read2_b32 v[110:111], v43 offset0:82 offset1:83
    v_mfma_f32_16x16x32_bf16 v[72:75], v[156:159], v[188:191], v[72:75]
    v_mfma_f32_16x16x32_bf16 v[76:79], v[156:159], v[192:195], v[76:79]
    v_mfma_f32_16x16x32_bf16 v[64:67], v[160:163], v[176:179], v[64:67]
    v_mfma_f32_16x16x32_bf16 v[68:71], v[160:163], v[180:183], v[68:71]
    v_mfma_f32_16x16x32_bf16 v[72:75], v[160:163], v[184:187], v[72:75]
    v_mfma_f32_16x16x32_bf16 v[76:79], v[160:163], v[188:191], v[76:79]
    v_mfma_f32_16x16x32_bf16 v[68:71], v[164:167], v[176:179], v[68:71]
    v_mfma_f32_16x16x32_bf16 v[72:75], v[164:167], v[180:183], v[72:75]
    v_mfma_f32_16x16x32_bf16 v[76:79], v[164:167], v[184:187], v[76:79]
    v_mfma_f32_16x16x32_bf16 v[72:75], v[168:171], v[176:179], v[72:75]
    v_mfma_f32_16x16x32_bf16 v[76:79], v[168:171], v[180:183], v[76:79]
    v_mfma_f32_16x16x32_bf16 v[76:79], v[172:175], v[176:179], v[76:79]
    s_waitcnt lgkmcnt(0)
    v_mfma_f32_16x16x32_bf16 v[48:51], v[80:83], v[112:115], v[48:51]
    ds_read_b128 v[176:179], v44 offset:256
    v_mfma_f32_16x16x32_bf16 v[52:55], v[80:83], v[116:119], v[52:55]
    ds_read2_b32 v[144:145], v36 offset0:64 offset1:65
    v_mfma_f32_16x16x32_bf16 v[56:59], v[80:83], v[120:123], v[56:59]
    ds_read2_b32 v[146:147], v36 offset0:66 offset1:67
    v_mfma_f32_16x16x32_bf16 v[60:63], v[80:83], v[124:127], v[60:63]
    ds_read_b128 v[180:183], v44 offset:768
    v_mfma_f32_16x16x32_bf16 v[64:67], v[80:83], v[128:131], v[64:67]
    ds_read2_b32 v[148:149], v37 offset0:64 offset1:65
    v_mfma_f32_16x16x32_bf16 v[68:71], v[80:83], v[132:135], v[68:71]
    ds_read2_b32 v[150:151], v37 offset0:66 offset1:67
    v_mfma_f32_16x16x32_bf16 v[72:75], v[80:83], v[136:139], v[72:75]
    ds_read_b128 v[184:187], v44 offset:1280
    v_mfma_f32_16x16x32_bf16 v[76:79], v[80:83], v[140:143], v[76:79]
    ds_read2_b32 v[152:153], v38 offset0:64 offset1:65
    v_mfma_f32_16x16x32_bf16 v[52:55], v[84:87], v[112:115], v[52:55]
    ds_read2_b32 v[154:155], v38 offset0:66 offset1:67
    v_mfma_f32_16x16x32_bf16 v[56:59], v[84:87], v[116:119], v[56:59]
    ds_read_b128 v[188:191], v44 offset:1792
    v_mfma_f32_16x16x32_bf16 v[60:63], v[84:87], v[120:123], v[60:63]
    ds_read2_b32 v[156:157], v39 offset0:64 offset1:65
    v_mfma_f32_16x16x32_bf16 v[64:67], v[84:87], v[124:127], v[64:67]
    ds_read2_b32 v[158:159], v39 offset0:66 offset1:67
    v_mfma_f32_16x16x32_bf16 v[68:71], v[84:87], v[128:131], v[68:71]
    ds_read_b128 v[192:195], v44 offset:2304
    v_mfma_f32_16x16x32_bf16 v[72:75], v[84:87], v[132:135], v[72:75]
    ds_read2_b32 v[160:161], v40 offset0:64 offset1:65
    v_mfma_f32_16x16x32_bf16 v[76:79], v[84:87], v[136:139], v[76:79]
    ds_read2_b32 v[162:163], v40 offset0:66 offset1:67
    v_mfma_f32_16x16x32_bf16 v[56:59], v[88:91], v[112:115], v[56:59]
    ds_read_b128 v[196:199], v44 offset:2816
    v_mfma_f32_16x16x32_bf16 v[60:63], v[88:91], v[116:119], v[60:63]
    ds_read2_b32 v[164:165], v41 offset0:64 offset1:65
    v_mfma_f32_16x16x32_bf16 v[64:67], v[88:91], v[120:123], v[64:67]
    ds_read2_b32 v[166:167], v41 offset0:66 offset1:67
    v_mfma_f32_16x16x32_bf16 v[68:71], v[88:91], v[124:127], v[68:71]
    ds_read_b128 v[200:203], v44 offset:3328
    v_mfma_f32_16x16x32_bf16 v[72:75], v[88:91], v[128:131], v[72:75]
    ds_read2_b32 v[168:169], v42 offset0:64 offset1:65
    v_mfma_f32_16x16x32_bf16 v[76:79], v[88:91], v[132:135], v[76:79]
    ds_read2_b32 v[170:171], v42 offset0:66 offset1:67
    v_mfma_f32_16x16x32_bf16 v[60:63], v[92:95], v[112:115], v[60:63]
    ds_read_b128 v[204:207], v44 offset:3840
    v_mfma_f32_16x16x32_bf16 v[64:67], v[92:95], v[116:119], v[64:67]
    ds_read2_b32 v[172:173], v43 offset0:64 offset1:65
    v_mfma_f32_16x16x32_bf16 v[68:71], v[92:95], v[120:123], v[68:71]
    ds_read2_b32 v[174:175], v43 offset0:66 offset1:67
    v_mfma_f32_16x16x32_bf16 v[72:75], v[92:95], v[124:127], v[72:75]
    v_mfma_f32_16x16x32_bf16 v[76:79], v[92:95], v[128:131], v[76:79]
    v_mfma_f32_16x16x32_bf16 v[64:67], v[96:99], v[112:115], v[64:67]
    v_mfma_f32_16x16x32_bf16 v[68:71], v[96:99], v[116:119], v[68:71]
    v_mfma_f32_16x16x32_bf16 v[72:75], v[96:99], v[120:123], v[72:75]
    v_mfma_f32_16x16x32_bf16 v[76:79], v[96:99], v[124:127], v[76:79]
    v_mfma_f32_16x16x32_bf16 v[68:71], v[100:103], v[112:115], v[68:71]
    v_mfma_f32_16x16x32_bf16 v[72:75], v[100:103], v[116:119], v[72:75]
    v_mfma_f32_16x16x32_bf16 v[76:79], v[100:103], v[120:123], v[76:79]
    v_mfma_f32_16x16x32_bf16 v[72:75], v[104:107], v[112:115], v[72:75]
    v_mfma_f32_16x16x32_bf16 v[76:79], v[104:107], v[116:119], v[76:79]
    v_mfma_f32_16x16x32_bf16 v[76:79], v[108:111], v[112:115], v[76:79]
    s_waitcnt lgkmcnt(0)
    v_mfma_f32_16x16x32_bf16 v[48:51], v[144:147], v[176:179], v[48:51]
    ds_read_b128 v[112:115], v44 offset:192
    v_mfma_f32_16x16x32_bf16 v[52:55], v[144:147], v[180:183], v[52:55]
    ds_read2_b32 v[80:81], v36 offset0:48 offset1:49
    v_mfma_f32_16x16x32_bf16 v[56:59], v[144:147], v[184:187], v[56:59]
    ds_read2_b32 v[82:83], v36 offset0:50 offset1:51
    v_mfma_f32_16x16x32_bf16 v[60:63], v[144:147], v[188:191], v[60:63]
    ds_read_b128 v[116:119], v44 offset:704
    v_mfma_f32_16x16x32_bf16 v[64:67], v[144:147], v[192:195], v[64:67]
    ds_read2_b32 v[84:85], v37 offset0:48 offset1:49
    v_mfma_f32_16x16x32_bf16 v[68:71], v[144:147], v[196:199], v[68:71]
    ds_read2_b32 v[86:87], v37 offset0:50 offset1:51
    v_mfma_f32_16x16x32_bf16 v[72:75], v[144:147], v[200:203], v[72:75]
    ds_read_b128 v[120:123], v44 offset:1216
    v_mfma_f32_16x16x32_bf16 v[76:79], v[144:147], v[204:207], v[76:79]
    ds_read2_b32 v[88:89], v38 offset0:48 offset1:49
    v_mfma_f32_16x16x32_bf16 v[52:55], v[148:151], v[176:179], v[52:55]
    ds_read2_b32 v[90:91], v38 offset0:50 offset1:51
    v_mfma_f32_16x16x32_bf16 v[56:59], v[148:151], v[180:183], v[56:59]
    ds_read_b128 v[124:127], v44 offset:1728
    v_mfma_f32_16x16x32_bf16 v[60:63], v[148:151], v[184:187], v[60:63]
    ds_read2_b32 v[92:93], v39 offset0:48 offset1:49
    v_mfma_f32_16x16x32_bf16 v[64:67], v[148:151], v[188:191], v[64:67]
    ds_read2_b32 v[94:95], v39 offset0:50 offset1:51
    v_mfma_f32_16x16x32_bf16 v[68:71], v[148:151], v[192:195], v[68:71]
    ds_read_b128 v[128:131], v44 offset:2240
    v_mfma_f32_16x16x32_bf16 v[72:75], v[148:151], v[196:199], v[72:75]
    ds_read2_b32 v[96:97], v40 offset0:48 offset1:49
    v_mfma_f32_16x16x32_bf16 v[76:79], v[148:151], v[200:203], v[76:79]
    ds_read2_b32 v[98:99], v40 offset0:50 offset1:51
    v_mfma_f32_16x16x32_bf16 v[56:59], v[152:155], v[176:179], v[56:59]
    ds_read_b128 v[132:135], v44 offset:2752
    v_mfma_f32_16x16x32_bf16 v[60:63], v[152:155], v[180:183], v[60:63]
    ds_read2_b32 v[100:101], v41 offset0:48 offset1:49
    v_mfma_f32_16x16x32_bf16 v[64:67], v[152:155], v[184:187], v[64:67]
    ds_read2_b32 v[102:103], v41 offset0:50 offset1:51
    v_mfma_f32_16x16x32_bf16 v[68:71], v[152:155], v[188:191], v[68:71]
    ds_read_b128 v[136:139], v44 offset:3264
    v_mfma_f32_16x16x32_bf16 v[72:75], v[152:155], v[192:195], v[72:75]
    ds_read2_b32 v[104:105], v42 offset0:48 offset1:49
    v_mfma_f32_16x16x32_bf16 v[76:79], v[152:155], v[196:199], v[76:79]
    ds_read2_b32 v[106:107], v42 offset0:50 offset1:51
    v_mfma_f32_16x16x32_bf16 v[60:63], v[156:159], v[176:179], v[60:63]
    ds_read_b128 v[140:143], v44 offset:3776
    v_mfma_f32_16x16x32_bf16 v[64:67], v[156:159], v[180:183], v[64:67]
    ds_read2_b32 v[108:109], v43 offset0:48 offset1:49
    v_mfma_f32_16x16x32_bf16 v[68:71], v[156:159], v[184:187], v[68:71]
    ds_read2_b32 v[110:111], v43 offset0:50 offset1:51
    v_mfma_f32_16x16x32_bf16 v[72:75], v[156:159], v[188:191], v[72:75]
    v_mfma_f32_16x16x32_bf16 v[76:79], v[156:159], v[192:195], v[76:79]
    v_mfma_f32_16x16x32_bf16 v[64:67], v[160:163], v[176:179], v[64:67]
    v_mfma_f32_16x16x32_bf16 v[68:71], v[160:163], v[180:183], v[68:71]
    v_mfma_f32_16x16x32_bf16 v[72:75], v[160:163], v[184:187], v[72:75]
    v_mfma_f32_16x16x32_bf16 v[76:79], v[160:163], v[188:191], v[76:79]
    v_mfma_f32_16x16x32_bf16 v[68:71], v[164:167], v[176:179], v[68:71]
    v_mfma_f32_16x16x32_bf16 v[72:75], v[164:167], v[180:183], v[72:75]
    v_mfma_f32_16x16x32_bf16 v[76:79], v[164:167], v[184:187], v[76:79]
    v_mfma_f32_16x16x32_bf16 v[72:75], v[168:171], v[176:179], v[72:75]
    v_mfma_f32_16x16x32_bf16 v[76:79], v[168:171], v[180:183], v[76:79]
    v_mfma_f32_16x16x32_bf16 v[76:79], v[172:175], v[176:179], v[76:79]
    s_waitcnt lgkmcnt(0)
    v_mfma_f32_16x16x32_bf16 v[48:51], v[80:83], v[112:115], v[48:51]
    ds_read_b128 v[176:179], v44 offset:128
    v_mfma_f32_16x16x32_bf16 v[52:55], v[80:83], v[116:119], v[52:55]
    ds_read2_b32 v[144:145], v36 offset0:32 offset1:33
    v_mfma_f32_16x16x32_bf16 v[56:59], v[80:83], v[120:123], v[56:59]
    ds_read2_b32 v[146:147], v36 offset0:34 offset1:35
    v_mfma_f32_16x16x32_bf16 v[60:63], v[80:83], v[124:127], v[60:63]
    ds_read_b128 v[180:183], v44 offset:640
    v_mfma_f32_16x16x32_bf16 v[64:67], v[80:83], v[128:131], v[64:67]
    ds_read2_b32 v[148:149], v37 offset0:32 offset1:33
    v_mfma_f32_16x16x32_bf16 v[68:71], v[80:83], v[132:135], v[68:71]
    ds_read2_b32 v[150:151], v37 offset0:34 offset1:35
    v_mfma_f32_16x16x32_bf16 v[72:75], v[80:83], v[136:139], v[72:75]
    ds_read_b128 v[184:187], v44 offset:1152
    v_mfma_f32_16x16x32_bf16 v[76:79], v[80:83], v[140:143], v[76:79]
    ds_read2_b32 v[152:153], v38 offset0:32 offset1:33
    v_mfma_f32_16x16x32_bf16 v[52:55], v[84:87], v[112:115], v[52:55]
    ds_read2_b32 v[154:155], v38 offset0:34 offset1:35
    v_mfma_f32_16x16x32_bf16 v[56:59], v[84:87], v[116:119], v[56:59]
    ds_read_b128 v[188:191], v44 offset:1664
    v_mfma_f32_16x16x32_bf16 v[60:63], v[84:87], v[120:123], v[60:63]
    ds_read2_b32 v[156:157], v39 offset0:32 offset1:33
    v_mfma_f32_16x16x32_bf16 v[64:67], v[84:87], v[124:127], v[64:67]
    ds_read2_b32 v[158:159], v39 offset0:34 offset1:35
    v_mfma_f32_16x16x32_bf16 v[68:71], v[84:87], v[128:131], v[68:71]
    ds_read_b128 v[192:195], v44 offset:2176
    v_mfma_f32_16x16x32_bf16 v[72:75], v[84:87], v[132:135], v[72:75]
    ds_read2_b32 v[160:161], v40 offset0:32 offset1:33
    v_mfma_f32_16x16x32_bf16 v[76:79], v[84:87], v[136:139], v[76:79]
    ds_read2_b32 v[162:163], v40 offset0:34 offset1:35
    v_mfma_f32_16x16x32_bf16 v[56:59], v[88:91], v[112:115], v[56:59]
    ds_read_b128 v[196:199], v44 offset:2688
    v_mfma_f32_16x16x32_bf16 v[60:63], v[88:91], v[116:119], v[60:63]
    ds_read2_b32 v[164:165], v41 offset0:32 offset1:33
    v_mfma_f32_16x16x32_bf16 v[64:67], v[88:91], v[120:123], v[64:67]
    ds_read2_b32 v[166:167], v41 offset0:34 offset1:35
    v_mfma_f32_16x16x32_bf16 v[68:71], v[88:91], v[124:127], v[68:71]
    ds_read_b128 v[200:203], v44 offset:3200
    v_mfma_f32_16x16x32_bf16 v[72:75], v[88:91], v[128:131], v[72:75]
    ds_read2_b32 v[168:169], v42 offset0:32 offset1:33
    v_mfma_f32_16x16x32_bf16 v[76:79], v[88:91], v[132:135], v[76:79]
    ds_read2_b32 v[170:171], v42 offset0:34 offset1:35
    v_mfma_f32_16x16x32_bf16 v[60:63], v[92:95], v[112:115], v[60:63]
    ds_read_b128 v[204:207], v44 offset:3712
    v_mfma_f32_16x16x32_bf16 v[64:67], v[92:95], v[116:119], v[64:67]
    ds_read2_b32 v[172:173], v43 offset0:32 offset1:33
    v_mfma_f32_16x16x32_bf16 v[68:71], v[92:95], v[120:123], v[68:71]
    ds_read2_b32 v[174:175], v43 offset0:34 offset1:35
    v_mfma_f32_16x16x32_bf16 v[72:75], v[92:95], v[124:127], v[72:75]
    v_mfma_f32_16x16x32_bf16 v[76:79], v[92:95], v[128:131], v[76:79]
    v_mfma_f32_16x16x32_bf16 v[64:67], v[96:99], v[112:115], v[64:67]
    v_mfma_f32_16x16x32_bf16 v[68:71], v[96:99], v[116:119], v[68:71]
    v_mfma_f32_16x16x32_bf16 v[72:75], v[96:99], v[120:123], v[72:75]
    v_mfma_f32_16x16x32_bf16 v[76:79], v[96:99], v[124:127], v[76:79]
    v_mfma_f32_16x16x32_bf16 v[68:71], v[100:103], v[112:115], v[68:71]
    v_mfma_f32_16x16x32_bf16 v[72:75], v[100:103], v[116:119], v[72:75]
    v_mfma_f32_16x16x32_bf16 v[76:79], v[100:103], v[120:123], v[76:79]
    v_mfma_f32_16x16x32_bf16 v[72:75], v[104:107], v[112:115], v[72:75]
    v_mfma_f32_16x16x32_bf16 v[76:79], v[104:107], v[116:119], v[76:79]
    v_mfma_f32_16x16x32_bf16 v[76:79], v[108:111], v[112:115], v[76:79]
    s_waitcnt lgkmcnt(0)
    v_mfma_f32_16x16x32_bf16 v[48:51], v[144:147], v[176:179], v[48:51]
    ds_read_b128 v[112:115], v44 offset:64
    v_mfma_f32_16x16x32_bf16 v[52:55], v[144:147], v[180:183], v[52:55]
    ds_read2_b32 v[80:81], v36 offset0:16 offset1:17
    v_mfma_f32_16x16x32_bf16 v[56:59], v[144:147], v[184:187], v[56:59]
    ds_read2_b32 v[82:83], v36 offset0:18 offset1:19
    v_mfma_f32_16x16x32_bf16 v[60:63], v[144:147], v[188:191], v[60:63]
    ds_read_b128 v[116:119], v44 offset:576
    v_mfma_f32_16x16x32_bf16 v[64:67], v[144:147], v[192:195], v[64:67]
    ds_read2_b32 v[84:85], v37 offset0:16 offset1:17
    v_mfma_f32_16x16x32_bf16 v[68:71], v[144:147], v[196:199], v[68:71]
    ds_read2_b32 v[86:87], v37 offset0:18 offset1:19
    v_mfma_f32_16x16x32_bf16 v[72:75], v[144:147], v[200:203], v[72:75]
    ds_read_b128 v[120:123], v44 offset:1088
    v_mfma_f32_16x16x32_bf16 v[76:79], v[144:147], v[204:207], v[76:79]
    ds_read2_b32 v[88:89], v38 offset0:16 offset1:17
    v_mfma_f32_16x16x32_bf16 v[52:55], v[148:151], v[176:179], v[52:55]
    ds_read2_b32 v[90:91], v38 offset0:18 offset1:19
    v_mfma_f32_16x16x32_bf16 v[56:59], v[148:151], v[180:183], v[56:59]
    ds_read_b128 v[124:127], v44 offset:1600
    v_mfma_f32_16x16x32_bf16 v[60:63], v[148:151], v[184:187], v[60:63]
    ds_read2_b32 v[92:93], v39 offset0:16 offset1:17
    v_mfma_f32_16x16x32_bf16 v[64:67], v[148:151], v[188:191], v[64:67]
    ds_read2_b32 v[94:95], v39 offset0:18 offset1:19
    v_mfma_f32_16x16x32_bf16 v[68:71], v[148:151], v[192:195], v[68:71]
    ds_read_b128 v[128:131], v44 offset:2112
    v_mfma_f32_16x16x32_bf16 v[72:75], v[148:151], v[196:199], v[72:75]
    ds_read2_b32 v[96:97], v40 offset0:16 offset1:17
    v_mfma_f32_16x16x32_bf16 v[76:79], v[148:151], v[200:203], v[76:79]
    ds_read2_b32 v[98:99], v40 offset0:18 offset1:19
    v_mfma_f32_16x16x32_bf16 v[56:59], v[152:155], v[176:179], v[56:59]
    ds_read_b128 v[132:135], v44 offset:2624
    v_mfma_f32_16x16x32_bf16 v[60:63], v[152:155], v[180:183], v[60:63]
    ds_read2_b32 v[100:101], v41 offset0:16 offset1:17
    v_mfma_f32_16x16x32_bf16 v[64:67], v[152:155], v[184:187], v[64:67]
    ds_read2_b32 v[102:103], v41 offset0:18 offset1:19
    v_mfma_f32_16x16x32_bf16 v[68:71], v[152:155], v[188:191], v[68:71]
    ds_read_b128 v[136:139], v44 offset:3136
    v_mfma_f32_16x16x32_bf16 v[72:75], v[152:155], v[192:195], v[72:75]
    ds_read2_b32 v[104:105], v42 offset0:16 offset1:17
    v_mfma_f32_16x16x32_bf16 v[76:79], v[152:155], v[196:199], v[76:79]
    ds_read2_b32 v[106:107], v42 offset0:18 offset1:19
    v_mfma_f32_16x16x32_bf16 v[60:63], v[156:159], v[176:179], v[60:63]
    ds_read_b128 v[140:143], v44 offset:3648
    v_mfma_f32_16x16x32_bf16 v[64:67], v[156:159], v[180:183], v[64:67]
    ds_read2_b32 v[108:109], v43 offset0:16 offset1:17
    v_mfma_f32_16x16x32_bf16 v[68:71], v[156:159], v[184:187], v[68:71]
    ds_read2_b32 v[110:111], v43 offset0:18 offset1:19
    v_mfma_f32_16x16x32_bf16 v[72:75], v[156:159], v[188:191], v[72:75]
    v_mfma_f32_16x16x32_bf16 v[76:79], v[156:159], v[192:195], v[76:79]
    v_mfma_f32_16x16x32_bf16 v[64:67], v[160:163], v[176:179], v[64:67]
    v_mfma_f32_16x16x32_bf16 v[68:71], v[160:163], v[180:183], v[68:71]
    v_mfma_f32_16x16x32_bf16 v[72:75], v[160:163], v[184:187], v[72:75]
    v_mfma_f32_16x16x32_bf16 v[76:79], v[160:163], v[188:191], v[76:79]
    v_mfma_f32_16x16x32_bf16 v[68:71], v[164:167], v[176:179], v[68:71]
    v_mfma_f32_16x16x32_bf16 v[72:75], v[164:167], v[180:183], v[72:75]
    v_mfma_f32_16x16x32_bf16 v[76:79], v[164:167], v[184:187], v[76:79]
    v_mfma_f32_16x16x32_bf16 v[72:75], v[168:171], v[176:179], v[72:75]
    v_mfma_f32_16x16x32_bf16 v[76:79], v[168:171], v[180:183], v[76:79]
    v_mfma_f32_16x16x32_bf16 v[76:79], v[172:175], v[176:179], v[76:79]
    s_waitcnt lgkmcnt(0)
    v_mfma_f32_16x16x32_bf16 v[48:51], v[80:83], v[112:115], v[48:51]
    ds_read_b128 v[176:179], v44 offset:0
    v_mfma_f32_16x16x32_bf16 v[52:55], v[80:83], v[116:119], v[52:55]
    ds_read2_b32 v[144:145], v36 offset0:0 offset1:1
    v_mfma_f32_16x16x32_bf16 v[56:59], v[80:83], v[120:123], v[56:59]
    ds_read2_b32 v[146:147], v36 offset0:2 offset1:3
    v_mfma_f32_16x16x32_bf16 v[60:63], v[80:83], v[124:127], v[60:63]
    ds_read_b128 v[180:183], v44 offset:512
    v_mfma_f32_16x16x32_bf16 v[64:67], v[80:83], v[128:131], v[64:67]
    ds_read2_b32 v[148:149], v37 offset0:0 offset1:1
    v_mfma_f32_16x16x32_bf16 v[68:71], v[80:83], v[132:135], v[68:71]
    ds_read2_b32 v[150:151], v37 offset0:2 offset1:3
    v_mfma_f32_16x16x32_bf16 v[72:75], v[80:83], v[136:139], v[72:75]
    ds_read_b128 v[184:187], v44 offset:1024
    v_mfma_f32_16x16x32_bf16 v[76:79], v[80:83], v[140:143], v[76:79]
    ds_read2_b32 v[152:153], v38 offset0:0 offset1:1
    v_mfma_f32_16x16x32_bf16 v[52:55], v[84:87], v[112:115], v[52:55]
    ds_read2_b32 v[154:155], v38 offset0:2 offset1:3
    v_mfma_f32_16x16x32_bf16 v[56:59], v[84:87], v[116:119], v[56:59]
    ds_read_b128 v[188:191], v44 offset:1536
    v_mfma_f32_16x16x32_bf16 v[60:63], v[84:87], v[120:123], v[60:63]
    ds_read2_b32 v[156:157], v39 offset0:0 offset1:1
    v_mfma_f32_16x16x32_bf16 v[64:67], v[84:87], v[124:127], v[64:67]
    ds_read2_b32 v[158:159], v39 offset0:2 offset1:3
    v_mfma_f32_16x16x32_bf16 v[68:71], v[84:87], v[128:131], v[68:71]
    ds_read_b128 v[192:195], v44 offset:2048
    v_mfma_f32_16x16x32_bf16 v[72:75], v[84:87], v[132:135], v[72:75]
    ds_read2_b32 v[160:161], v40 offset0:0 offset1:1
    v_mfma_f32_16x16x32_bf16 v[76:79], v[84:87], v[136:139], v[76:79]
    ds_read2_b32 v[162:163], v40 offset0:2 offset1:3
    v_mfma_f32_16x16x32_bf16 v[56:59], v[88:91], v[112:115], v[56:59]
    ds_read_b128 v[196:199], v44 offset:2560
    v_mfma_f32_16x16x32_bf16 v[60:63], v[88:91], v[116:119], v[60:63]
    ds_read2_b32 v[164:165], v41 offset0:0 offset1:1
    v_mfma_f32_16x16x32_bf16 v[64:67], v[88:91], v[120:123], v[64:67]
    ds_read2_b32 v[166:167], v41 offset0:2 offset1:3
    v_mfma_f32_16x16x32_bf16 v[68:71], v[88:91], v[124:127], v[68:71]
    ds_read_b128 v[200:203], v44 offset:3072
    v_mfma_f32_16x16x32_bf16 v[72:75], v[88:91], v[128:131], v[72:75]
    ds_read2_b32 v[168:169], v42 offset0:0 offset1:1
    v_mfma_f32_16x16x32_bf16 v[76:79], v[88:91], v[132:135], v[76:79]
    ds_read2_b32 v[170:171], v42 offset0:2 offset1:3
    v_mfma_f32_16x16x32_bf16 v[60:63], v[92:95], v[112:115], v[60:63]
    ds_read_b128 v[204:207], v44 offset:3584
    v_mfma_f32_16x16x32_bf16 v[64:67], v[92:95], v[116:119], v[64:67]
    ds_read2_b32 v[172:173], v43 offset0:0 offset1:1
    v_mfma_f32_16x16x32_bf16 v[68:71], v[92:95], v[120:123], v[68:71]
    ds_read2_b32 v[174:175], v43 offset0:2 offset1:3
    v_mfma_f32_16x16x32_bf16 v[72:75], v[92:95], v[124:127], v[72:75]
    v_mfma_f32_16x16x32_bf16 v[76:79], v[92:95], v[128:131], v[76:79]
    v_mfma_f32_16x16x32_bf16 v[64:67], v[96:99], v[112:115], v[64:67]
    v_mfma_f32_16x16x32_bf16 v[68:71], v[96:99], v[116:119], v[68:71]
    v_mfma_f32_16x16x32_bf16 v[72:75], v[96:99], v[120:123], v[72:75]
    v_mfma_f32_16x16x32_bf16 v[76:79], v[96:99], v[124:127], v[76:79]
    v_mfma_f32_16x16x32_bf16 v[68:71], v[100:103], v[112:115], v[68:71]
    v_mfma_f32_16x16x32_bf16 v[72:75], v[100:103], v[116:119], v[72:75]
    v_mfma_f32_16x16x32_bf16 v[76:79], v[100:103], v[120:123], v[76:79]
    v_mfma_f32_16x16x32_bf16 v[72:75], v[104:107], v[112:115], v[72:75]
    v_mfma_f32_16x16x32_bf16 v[76:79], v[104:107], v[116:119], v[76:79]
    v_mfma_f32_16x16x32_bf16 v[76:79], v[108:111], v[112:115], v[76:79]
    s_waitcnt lgkmcnt(0)
    v_mfma_f32_16x16x32_bf16 v[48:51], v[144:147], v[176:179], v[48:51]
    v_mfma_f32_16x16x32_bf16 v[52:55], v[144:147], v[180:183], v[52:55]
    v_mfma_f32_16x16x32_bf16 v[56:59], v[144:147], v[184:187], v[56:59]
    v_mfma_f32_16x16x32_bf16 v[60:63], v[144:147], v[188:191], v[60:63]
    v_mfma_f32_16x16x32_bf16 v[64:67], v[144:147], v[192:195], v[64:67]
    v_mfma_f32_16x16x32_bf16 v[68:71], v[144:147], v[196:199], v[68:71]
    v_mfma_f32_16x16x32_bf16 v[72:75], v[144:147], v[200:203], v[72:75]
    v_mfma_f32_16x16x32_bf16 v[76:79], v[144:147], v[204:207], v[76:79]
    v_mfma_f32_16x16x32_bf16 v[52:55], v[148:151], v[176:179], v[52:55]
    v_mfma_f32_16x16x32_bf16 v[56:59], v[148:151], v[180:183], v[56:59]
    v_mfma_f32_16x16x32_bf16 v[60:63], v[148:151], v[184:187], v[60:63]
    v_mfma_f32_16x16x32_bf16 v[64:67], v[148:151], v[188:191], v[64:67]
    v_mfma_f32_16x16x32_bf16 v[68:71], v[148:151], v[192:195], v[68:71]
    v_mfma_f32_16x16x32_bf16 v[72:75], v[148:151], v[196:199], v[72:75]
    v_mfma_f32_16x16x32_bf16 v[76:79], v[148:151], v[200:203], v[76:79]
    v_mfma_f32_16x16x32_bf16 v[56:59], v[152:155], v[176:179], v[56:59]
    v_mfma_f32_16x16x32_bf16 v[60:63], v[152:155], v[180:183], v[60:63]
    v_mfma_f32_16x16x32_bf16 v[64:67], v[152:155], v[184:187], v[64:67]
    v_mfma_f32_16x16x32_bf16 v[68:71], v[152:155], v[188:191], v[68:71]
    v_mfma_f32_16x16x32_bf16 v[72:75], v[152:155], v[192:195], v[72:75]
    v_mfma_f32_16x16x32_bf16 v[76:79], v[152:155], v[196:199], v[76:79]
    v_mfma_f32_16x16x32_bf16 v[60:63], v[156:159], v[176:179], v[60:63]
    v_mfma_f32_16x16x32_bf16 v[64:67], v[156:159], v[180:183], v[64:67]
    v_mfma_f32_16x16x32_bf16 v[68:71], v[156:159], v[184:187], v[68:71]
    v_mfma_f32_16x16x32_bf16 v[72:75], v[156:159], v[188:191], v[72:75]
    v_mfma_f32_16x16x32_bf16 v[76:79], v[156:159], v[192:195], v[76:79]
    v_mfma_f32_16x16x32_bf16 v[64:67], v[160:163], v[176:179], v[64:67]
    v_mfma_f32_16x16x32_bf16 v[68:71], v[160:163], v[180:183], v[68:71]
    v_mfma_f32_16x16x32_bf16 v[72:75], v[160:163], v[184:187], v[72:75]
    v_mfma_f32_16x16x32_bf16 v[76:79], v[160:163], v[188:191], v[76:79]
    v_mfma_f32_16x16x32_bf16 v[68:71], v[164:167], v[176:179], v[68:71]
    v_mfma_f32_16x16x32_bf16 v[72:75], v[164:167], v[180:183], v[72:75]
    v_mfma_f32_16x16x32_bf16 v[76:79], v[164:167], v[184:187], v[76:79]
    v_mfma_f32_16x16x32_bf16 v[72:75], v[168:171], v[176:179], v[72:75]
    v_mfma_f32_16x16x32_bf16 v[76:79], v[168:171], v[180:183], v[76:79]
    v_mfma_f32_16x16x32_bf16 v[76:79], v[172:175], v[176:179], v[76:79]
    s_nop 7
    v_lshlrev_b32 v5, 6, v2
    v_lshl_add_u32 v5, v3, 4, v5
    v_add_u32 v5, v5, v4
    ds_write_b128 v5, v[48:51] offset:7424
    ds_write_b128 v5, v[52:55] offset:8448
    ds_write_b128 v5, v[56:59] offset:9472
    ds_write_b128 v5, v[60:63] offset:10496
    ds_write_b128 v5, v[64:67] offset:11520
    ds_write_b128 v5, v[68:71] offset:12544
    ds_write_b128 v5, v[72:75] offset:13568
    ds_write_b128 v5, v[76:79] offset:14592
    v_mov_b64 v[8:9], v[16:17]
    v_mov_b64 v[10:11], v[18:19]
    v_mov_b64 v[12:13], v[20:21]
    v_mov_b64 v[14:15], v[22:23]
    v_mov_b32 v24, v25
    v_add_u32 v4, 65536, v4
    s_add_u32 s28, s28, 1
    s_cmp_lt_u32 s28, 2
    s_waitcnt lgkmcnt(0)
    s_cbranch_scc1 ss_pass
    s_mov_b32 s12, s74
    s_mov_b32 s13, s75
    s_mov_b32 s14, 1152
    s_mov_b32 s15, 0x20000
    s_lshl_b32 s23, s20, 1
    buffer_load_dwordx4 v[8:11], off, s[12:15], s23
    s_barrier
    v_lshlrev_b32 v5, 5, v0
    v_add_u32 v7, 65536, v5
    ds_read_b128 v[64:67], v5 offset:7424
    ds_read_b128 v[68:71], v5 offset:7440
    ds_read_b128 v[72:75], v5 offset:23808
    ds_read_b128 v[76:79], v5 offset:23824
    ds_read_b128 v[80:83], v5 offset:40192
    ds_read_b128 v[84:87], v5 offset:40208
    ds_read_b128 v[88:91], v5 offset:56576
    ds_read_b128 v[92:95], v5 offset:56592
    ds_read_b128 v[96:99], v7 offset:7424
    ds_read_b128 v[100:103], v7 offset:7440
    ds_read_b128 v[104:107], v7 offset:23808
    ds_read_b128 v[108:111], v7 offset:23824
    ds_read_b128 v[112:115], v7 offset:40192
    ds_read_b128 v[116:119], v7 offset:40208
    ds_read_b128 v[120:123], v7 offset:56576
    ds_read_b128 v[124:127], v7 offset:56592
    s_waitcnt vmcnt(0)
    v_lshlrev_b32 v12, 16, v8
    v_and_b32 v13, 0xffff0000, v8
    v_lshlrev_b32 v14, 16, v9
    v_and_b32 v15, 0xffff0000, v9
    v_lshlrev_b32 v16, 16, v10
    v_and_b32 v17, 0xffff0000, v10
    v_lshlrev_b32 v18, 16, v11
    v_and_b32 v19, 0xffff0000, v11
    v_mul_u32_u24 v5, 18432, v0
    s_lshl_b32 s22, s20, 1
    s_add_u32 s22, s22, 1152
    s_waitcnt lgkmcnt(0)
    v_lshlrev_b32 v6, 16, v208
    v_fmac_f32 v64, v6, v12
    v_and_b32 v6, 0xffff0000, v208
    v_fmac_f32 v72, v6, v13
    v_lshlrev_b32 v6, 16, v209
    v_fmac_f32 v80, v6, v14
    v_and_b32 v6, 0xffff0000, v209
    v_fmac_f32 v88, v6, v15
    v_lshlrev_b32 v6, 16, v210
    v_fmac_f32 v96, v6, v16
    v_and_b32 v6, 0xffff0000, v210
    v_fmac_f32 v104, v6, v17
    v_lshlrev_b32 v6, 16, v211
    v_fmac_f32 v112, v6, v18
    v_and_b32 v6, 0xffff0000, v211
    v_fmac_f32 v120, v6, v19
    v_cvt_pk_bf16_f32 v208, v64, v72
    v_cvt_pk_bf16_f32 v209, v80, v88
    v_cvt_pk_bf16_f32 v210, v96, v104
    v_cvt_pk_bf16_f32 v211, v112, v120
    s_add_u32 s23, s22, 0
    buffer_store_dwordx4 v[208:211], v5, s[16:19], s23 offen
    v_lshlrev_b32 v6, 16, v212
    v_fmac_f32 v65, v6, v12
    v_and_b32 v6, 0xffff0000, v212
    v_fmac_f32 v73, v6, v13
    v_lshlrev_b32 v6, 16, v213
    v_fmac_f32 v81, v6, v14
    v_and_b32 v6, 0xffff0000, v213
    v_fmac_f32 v89, v6, v15
    v_lshlrev_b32 v6, 16, v214
    v_fmac_f32 v97, v6, v16
    v_and_b32 v6, 0xffff0000, v214
    v_fmac_f32 v105, v6, v17
    v_lshlrev_b32 v6, 16, v215
    v_fmac_f32 v113, v6, v18
    v_and_b32 v6, 0xffff0000, v215
    v_fmac_f32 v121, v6, v19
    v_cvt_pk_bf16_f32 v212, v65, v73
    v_cvt_pk_bf16_f32 v213, v81, v89
    v_cvt_pk_bf16_f32 v214, v97, v105
    v_cvt_pk_bf16_f32 v215, v113, v121
    s_add_u32 s23, s22, 2304
    buffer_store_dwordx4 v[212:215], v5, s[16:19], s23 offen
    v_lshlrev_b32 v6, 16, v216
    v_fmac_f32 v66, v6, v12
    v_and_b32 v6, 0xffff0000, v216
    v_fmac_f32 v74, v6, v13
    v_lshlrev_b32 v6, 16, v217
    v_fmac_f32 v82, v6, v14
    v_and_b32 v6, 0xffff0000, v217
    v_fmac_f32 v90, v6, v15
    v_lshlrev_b32 v6, 16, v218
    v_fmac_f32 v98, v6, v16
    v_and_b32 v6, 0xffff0000, v218
    v_fmac_f32 v106, v6, v17
    v_lshlrev_b32 v6, 16, v219
    v_fmac_f32 v114, v6, v18
    v_and_b32 v6, 0xffff0000, v219
    v_fmac_f32 v122, v6, v19
    v_cvt_pk_bf16_f32 v216, v66, v74
    v_cvt_pk_bf16_f32 v217, v82, v90
    v_cvt_pk_bf16_f32 v218, v98, v106
    v_cvt_pk_bf16_f32 v219, v114, v122
    s_add_u32 s23, s22, 4608
    buffer_store_dwordx4 v[216:219], v5, s[16:19], s23 offen
    v_lshlrev_b32 v6, 16, v220
    v_fmac_f32 v67, v6, v12
    v_and_b32 v6, 0xffff0000, v220
    v_fmac_f32 v75, v6, v13
    v_lshlrev_b32 v6, 16, v221
    v_fmac_f32 v83, v6, v14
    v_and_b32 v6, 0xffff0000, v221
    v_fmac_f32 v91, v6, v15
    v_lshlrev_b32 v6, 16, v222
    v_fmac_f32 v99, v6, v16
    v_and_b32 v6, 0xffff0000, v222
    v_fmac_f32 v107, v6, v17
    v_lshlrev_b32 v6, 16, v223
    v_fmac_f32 v115, v6, v18
    v_and_b32 v6, 0xffff0000, v223
    v_fmac_f32 v123, v6, v19
    v_cvt_pk_bf16_f32 v220, v67, v75
    v_cvt_pk_bf16_f32 v221, v83, v91
    v_cvt_pk_bf16_f32 v222, v99, v107
    v_cvt_pk_bf16_f32 v223, v115, v123
    s_add_u32 s23, s22, 6912
    buffer_store_dwordx4 v[220:223], v5, s[16:19], s23 offen
    v_lshlrev_b32 v6, 16, v224
    v_fmac_f32 v68, v6, v12
    v_and_b32 v6, 0xffff0000, v224
    v_fmac_f32 v76, v6, v13
    v_lshlrev_b32 v6, 16, v225
    v_fmac_f32 v84, v6, v14
    v_and_b32 v6, 0xffff0000, v225
    v_fmac_f32 v92, v6, v15
    v_lshlrev_b32 v6, 16, v226
    v_fmac_f32 v100, v6, v16
    v_and_b32 v6, 0xffff0000, v226
    v_fmac_f32 v108, v6, v17
    v_lshlrev_b32 v6, 16, v227
    v_fmac_f32 v116, v6, v18
    v_and_b32 v6, 0xffff0000, v227
    v_fmac_f32 v124, v6, v19
    v_cvt_pk_bf16_f32 v224, v68, v76
    v_cvt_pk_bf16_f32 v225, v84, v92
    v_cvt_pk_bf16_f32 v226, v100, v108
    v_cvt_pk_bf16_f32 v227, v116, v124
    s_add_u32 s23, s22, 9216
    buffer_store_dwordx4 v[224:227], v5, s[16:19], s23 offen
    v_lshlrev_b32 v6, 16, v228
    v_fmac_f32 v69, v6, v12
    v_and_b32 v6, 0xffff0000, v228
    v_fmac_f32 v77, v6, v13
    v_lshlrev_b32 v6, 16, v229
    v_fmac_f32 v85, v6, v14
    v_and_b32 v6, 0xffff0000, v229
    v_fmac_f32 v93, v6, v15
    v_lshlrev_b32 v6, 16, v230
    v_fmac_f32 v101, v6, v16
    v_and_b32 v6, 0xffff0000, v230
    v_fmac_f32 v109, v6, v17
    v_lshlrev_b32 v6, 16, v231
    v_fmac_f32 v117, v6, v18
    v_and_b32 v6, 0xffff0000, v231
    v_fmac_f32 v125, v6, v19
    v_cvt_pk_bf16_f32 v228, v69, v77
    v_cvt_pk_bf16_f32 v229, v85, v93
    v_cvt_pk_bf16_f32 v230, v101, v109
    v_cvt_pk_bf16_f32 v231, v117, v125
    s_add_u32 s23, s22, 11520
    buffer_store_dwordx4 v[228:231], v5, s[16:19], s23 offen
    v_lshlrev_b32 v6, 16, v232
    v_fmac_f32 v70, v6, v12
    v_and_b32 v6, 0xffff0000, v232
    v_fmac_f32 v78, v6, v13
    v_lshlrev_b32 v6, 16, v233
    v_fmac_f32 v86, v6, v14
    v_and_b32 v6, 0xffff0000, v233
    v_fmac_f32 v94, v6, v15
    v_lshlrev_b32 v6, 16, v234
    v_fmac_f32 v102, v6, v16
    v_and_b32 v6, 0xffff0000, v234
    v_fmac_f32 v110, v6, v17
    v_lshlrev_b32 v6, 16, v235
    v_fmac_f32 v118, v6, v18
    v_and_b32 v6, 0xffff0000, v235
    v_fmac_f32 v126, v6, v19
    v_cvt_pk_bf16_f32 v232, v70, v78
    v_cvt_pk_bf16_f32 v233, v86, v94
    v_cvt_pk_bf16_f32 v234, v102, v110
    v_cvt_pk_bf16_f32 v235, v118, v126
    s_add_u32 s23, s22, 13824
    buffer_store_dwordx4 v[232:235], v5, s[16:19], s23 offen
    v_lshlrev_b32 v6, 16, v236
    v_fmac_f32 v71, v6, v12
    v_and_b32 v6, 0xffff0000, v236
    v_fmac_f32 v79, v6, v13
    v_lshlrev_b32 v6, 16, v237
    v_fmac_f32 v87, v6, v14
    v_and_b32 v6, 0xffff0000, v237
    v_fmac_f32 v95, v6, v15
    v_lshlrev_b32 v6, 16, v238
    v_fmac_f32 v103, v6, v16
    v_and_b32 v6, 0xffff0000, v238
    v_fmac_f32 v111, v6, v17
    v_lshlrev_b32 v6, 16, v239
    v_fmac_f32 v119, v6, v18
    v_and_b32 v6, 0xffff0000, v239
    v_fmac_f32 v127, v6, v19
    v_cvt_pk_bf16_f32 v236, v71, v79
    v_cvt_pk_bf16_f32 v237, v87, v95
    v_cvt_pk_bf16_f32 v238, v103, v111
    v_cvt_pk_bf16_f32 v239, v119, v127
    s_add_u32 s23, s22, 16128
    buffer_store_dwordx4 v[236:239], v5, s[16:19], s23 offen
    s_branch L_ssm_next
L_ssm_done:
    s_cmp_lt_u32 s93, 100
    s_cbranch_scc1 L_exit
    s_mov_b32 s8, s76
    s_mov_b32 s9, s77
    s_mov_b32 s10, 4718592
    s_mov_b32 s11, 0x20000
    s_cmp_le_u32 s45, 1
    s_cbranch_scc1 L_att_next
    s_branch L_op_nextcb
L_wf_next:
    s_mov_b32 s37, 20
    v_mov_b32 v250, 1
    v_mov_b32 v251, 163832
    v_cmp_eq_u32 vcc, 0, v0
    s_nop 0
    s_and_saveexec_b64 s[38:39], vcc
    s_cbranch_execz tk13
    buffer_atomic_add v250, off, s[84:87], s37 sc0
    s_waitcnt vmcnt(0)
    ds_write_b32 v251, v250
    s_waitcnt lgkmcnt(0)
tk13:
    s_mov_b64 exec, -1
    s_barrier
    ds_read_b32 v252, v251
    s_waitcnt lgkmcnt(0)
    v_readfirstlane_b32 s33, v252
    s_barrier
    s_nop 3
    s_cmp_ge_u32 s33, 160
    s_cbranch_scc1 L_ssm_next
    s_lshl_b32 s16, s33, 2
    s_add_u32 s16, s16, s32
    s_add_u32 s16, s16, 1504
    s_call_b64 s[46:47], L_xform
    s_cmp_lg_u32 s95, 0
    s_cbranch_scc1 L_wfn
    s_mov_b32 s88, 4194304
gn14:
    buffer_load_dword v250, off, s[84:87], 0 offset:216 sc1
    s_waitcnt vmcnt(0)
    v_readfirstlane_b32 s95, v250
    s_sub_u32 s88, s88, 1
    s_cbranch_scc1 gn14x
    s_cmp_eq_u32 s95, 0
    s_cbranch_scc1 gn14
gn14x:
L_wfn:
    s_lshl_b32 s40, s33, 2
    s_add_u32 s40, s40, 125841408
    s_waitcnt vmcnt(0)
    s_barrier
    v_mov_b32 v250, s95
    v_cmp_eq_u32 vcc, 0, v0
    s_nop 0
    s_and_saveexec_b64 s[38:39], vcc
    s_cbranch_execz fs15
    buffer_store_dword v250, off, s[4:7], s40 sc1
fs15:
    s_mov_b64 exec, -1
    s_branch L_wf_next
L_phase2:
    s_mov_b32 s40, 524288
mc2_w:
    buffer_load_dword v250, off, s[84:87], 0 offset:28 sc1
    s_waitcnt vmcnt(0)
    v_readfirstlane_b32 s41, v250
    s_nop 0
    s_cmp_lg_u32 s41, 0
    s_cbranch_scc1 mc2_known
    s_sub_u32 s40, s40, 1
    s_cbranch_scc1 mc2_force
    s_sleep 2
    s_branch mc2_w
mc2_force:
    v_mov_b32 v250, 2
    v_mov_b32 v251, 0
    s_mov_b64 exec, 1
    buffer_atomic_cmpswap v[250:251], off, s[84:87], 0 offset:28
    s_mov_b64 exec, -1
    s_waitcnt vmcnt(0)
    s_mov_b32 s40, 524288
    s_branch mc2_w
mc2_known:
    s_cmp_eq_u32 s41, 1
    s_cbranch_scc1 L_phase2b
    s_mov_b32 s37, 208
    v_mov_b32 v250, 1
    v_mov_b32 v251, 163832
    v_cmp_eq_u32 vcc, 0, v0
    s_nop 0
    s_and_saveexec_b64 s[38:39], vcc
    s_cbranch_execz tk16
    buffer_atomic_add v250, off, s[84:87], s37 sc0
    s_waitcnt vmcnt(0)
    ds_write_b32 v251, v250
    s_waitcnt lgkmcnt(0)
tk16:
    s_mov_b64 exec, -1
    s_barrier
    ds_read_b32 v252, v251
    s_waitcnt lgkmcnt(0)
    v_readfirstlane_b32 s12, v252
    s_barrier
    s_nop 3
    s_cmp_lt_u32 s12, 32
    s_cbranch_scc1 L_chain_safe
    s_sub_u32 s45, s12, 32
L_phase2b:
    s_mov_b32 s8, s76
    s_mov_b32 s9, s77
    s_mov_b32 s10, 4718592
    s_mov_b32 s11, 0x20000
    s_and_b32 s36, s45, 15
    s_bitcmp1_b32 42315, s36
    s_cbranch_scc0 L_nots
    s_cmp_eq_u32 s93, 500
    s_cbranch_scc1 L_ssm_next
    s_branch L_wf_next
L_nots:
    s_bitcmp1_b32 18576, s36
    s_cbranch_scc0 L_att_next
    s_bfm_b32 s37, s36, 0
    s_and_b32 s37, s37, 18576
    s_bcnt1_i32_b32 s37, s37
    s_lshr_b32 s40, s45, 4
    s_mul_i32 s40, s40, 4
    s_add_u32 s33, s40, s37
L_op_mod:
    s_mul_hi_u32 s41, s33, 0x0e38e38f
    s_mul_i32 s41, s41, 18
    s_sub_u32 s33, s33, s41
    s_branch L_op_start
L_att_next:
    s_mov_b32 s37, 16
    v_mov_b32 v250, 1
    v_mov_b32 v251, 163832
    v_cmp_eq_u32 vcc, 0, v0
    s_nop 0
    s_and_saveexec_b64 s[38:39], vcc
    s_cbranch_execz tk17
    buffer_atomic_add v250, off, s[84:87], s37 sc0
    s_waitcnt vmcnt(0)
    ds_write_b32 v251, v250
    s_waitcnt lgkmcnt(0)
tk17:
    s_mov_b64 exec, -1
    s_barrier
    ds_read_b32 v252, v251
    s_waitcnt lgkmcnt(0)
    v_readfirstlane_b32 s34, v252
    s_barrier
    s_nop 3
    s_cmp_ge_u32 s34, 512
    s_cbranch_scc1 L_op_nextcb
    s_lshr_b32 s16, s34, 3
    s_and_b32 s17, s34, 7
    s_lshl_b32 s17, s17, 2
    s_add_u32 s17, s17, s32
    s_lshl_b32 s36, s17, 7
    s_add_u32 s36, s36, 125829120
    s_lshr_b32 s41, s16, 2
    s_add_u32 s41, s41, s95
    s_add_u32 s41, s41, 1
    v_and_b32 v1, 3, v0
    v_min_u32 v1, 2, v1
    v_lshlrev_b32 v2, 4, v1
    s_and_b32 s37, s16, 3
    s_lshl_b32 s37, s37, 2
    v_add_u32 v2, s37, v2
    s_mov_b32 s40, 4194304
L_aw1:
    buffer_load_dword v3, v2, s[4:7], s36 offen sc1
    s_sub_u32 s40, s40, 1
    s_cbranch_scc1 L_aw1_go
    s_waitcnt vmcnt(0)
    v_subrev_u32 v3, s41, v3
    v_cmp_lt_u32 vcc, 64, v3
    s_cbranch_vccz L_aw1_go
    s_sleep 4
    s_branch L_aw1
L_aw1_go:
    v_and_b32 v5, 63, v0
    v_lshlrev_b32 v1, 4, v5
    s_cmp_ge_u32 s16, 56
    s_cselect_b32 s18, -1, 511
    v_and_b32 v2, s18, v1
    v_or_b32 v3, 128, v1
    v_lshrrev_b32 v4, 4, v5
    v_bfe_u32 v6, v5, 2, 2
    v_sub_u32 v4, v6, v4
    v_lshlrev_b32 v4, 3, v4
    v_and_b32 v6, 3, v5
    v_add_u32 v4, v4, v6
    v_mov_b32 v6, 0xf149f2ca
    s_mov_b32 s22, 0x3e0293ee
    s_lshl_b32 s18, s16, 5
    s_add_u32 s18, s18, s17
    s_lshl_b32 s19, s18, 13
    s_add_u32 s20, s19, 33554432
    buffer_load_dwordx4 v[8:11], v1, s[4:7], s20 offen offset:0 sc1
    s_add_u32 s20, s19, 33554432
    buffer_load_dwordx4 v[12:15], v1, s[4:7], s20 offen offset:1024 sc1
    s_add_u32 s20, s19, 33554432
    buffer_load_dwordx4 v[16:19], v1, s[4:7], s20 offen offset:2048 sc1
    s_add_u32 s20, s19, 33554432
    buffer_load_dwordx4 v[20:23], v1, s[4:7], s20 offen offset:3072 sc1
    s_add_u32 s20, s19, 33558528
    buffer_load_dwordx4 v[24:27], v1, s[4:7], s20 offen offset:0 sc1
    s_add_u32 s20, s19, 33558528
    buffer_load_dwordx4 v[28:31], v1, s[4:7], s20 offen offset:1024 sc1
    s_add_u32 s20, s19, 33558528
    buffer_load_dwordx4 v[32:35], v1, s[4:7], s20 offen offset:2048 sc1
    s_add_u32 s20, s19, 33558528
    buffer_load_dwordx4 v[36:39], v1, s[4:7], s20 offen offset:3072 sc1
    s_lshl_b32 s21, s18, 14
    s_add_u32 s20, s21, 0
    buffer_load_dwordx4 v[40:43], v1, s[4:7], s20 offen offset:0 sc1
    s_add_u32 s20, s21, 4096
    buffer_load_dwordx4 v[44:47], v1, s[4:7], s20 offen offset:0 sc1
    s_add_u32 s20, s21, 8192
    buffer_load_dwordx4 v[48:51], v1, s[4:7], s20 offen offset:0 sc1
    s_add_u32 s20, s21, 12288
    buffer_load_dwordx4 v[52:55], v1, s[4:7], s20 offen offset:0 sc1
    s_add_u32 s20, s21, 0
    buffer_load_dwordx4 v[56:59], v1, s[4:7], s20 offen offset:1024 sc1
    s_add_u32 s20, s21, 4096
    buffer_load_dwordx4 v[60:63], v1, s[4:7], s20 offen offset:1024 sc1
    s_add_u32 s20, s21, 8192
    buffer_load_dwordx4 v[64:67], v1, s[4:7], s20 offen offset:1024 sc1
    s_add_u32 s20, s21, 12288
    buffer_load_dwordx4 v[68:71], v1, s[4:7], s20 offen offset:1024 sc1
    s_add_u32 s20, s21, 0
    buffer_load_dwordx4 v[88:91], v1, s[4:7], s20 offen offset:2048 sc1
    s_add_u32 s20, s21, 4096
    buffer_load_dwordx4 v[92:95], v1, s[4:7], s20 offen offset:2048 sc1
    s_add_u32 s20, s21, 8192
    buffer_load_dwordx4 v[96:99], v1, s[4:7], s20 offen offset:2048 sc1
    s_add_u32 s20, s21, 12288
    buffer_load_dwordx4 v[100:103], v1, s[4:7], s20 offen offset:2048 sc1
    s_add_u32 s20, s21, 0
    buffer_load_dwordx4 v[104:107], v1, s[4:7], s20 offen offset:3072 sc1
    s_add_u32 s20, s21, 4096
    buffer_load_dwordx4 v[108:111], v1, s[4:7], s20 offen offset:3072 sc1
    s_add_u32 s20, s21, 8192
    buffer_load_dwordx4 v[112:115], v1, s[4:7], s20 offen offset:3072 sc1
    s_add_u32 s20, s21, 12288
    buffer_load_dwordx4 v[116:119], v1, s[4:7], s20 offen offset:3072 sc1
    v_mov_b32 v172, 0x3f803f80
    v_mov_b32 v173, 0x3f803f80
    v_mov_b32 v174, 0x3f803f80
    v_mov_b32 v175, 0x3f803f80
    v_mov_b32 v176, 0x3f003f00
    v_mov_b32 v177, 0x3f003f00
    s_waitcnt vmcnt(8)
    v_mfma_f32_16x16x32_bf16 v[136:139], v[40:43], v[8:11], 0
    v_mfma_f32_16x16x32_bf16 v[140:143], v[56:59], v[8:11], 0
    v_mfma_f32_16x16x32_bf16 v[148:151], v[40:43], v[24:27], 0
    v_mfma_f32_16x16x32_bf16 v[152:155], v[56:59], v[24:27], 0
    v_mfma_f32_16x16x32_bf16 v[136:139], v[44:47], v[12:15], v[136:139]
    v_mfma_f32_16x16x32_bf16 v[140:143], v[60:63], v[12:15], v[140:143]
    v_mfma_f32_16x16x32_bf16 v[148:151], v[44:47], v[28:31], v[148:151]
    v_mfma_f32_16x16x32_bf16 v[152:155], v[60:63], v[28:31], v[152:155]
    v_mfma_f32_16x16x32_bf16 v[136:139], v[48:51], v[16:19], v[136:139]
    v_mfma_f32_16x16x32_bf16 v[140:143], v[64:67], v[16:19], v[140:143]
    v_mfma_f32_16x16x32_bf16 v[148:151], v[48:51], v[32:35], v[148:151]
    v_mfma_f32_16x16x32_bf16 v[152:155], v[64:67], v[32:35], v[152:155]
    v_mfma_f32_16x16x32_bf16 v[136:139], v[52:55], v[20:23], v[136:139]
    v_mfma_f32_16x16x32_bf16 v[140:143], v[68:71], v[20:23], v[140:143]
    v_mfma_f32_16x16x32_bf16 v[148:151], v[52:55], v[36:39], v[148:151]
    v_mfma_f32_16x16x32_bf16 v[152:155], v[68:71], v[36:39], v[152:155]
    v_cmp_le_i32 vcc, 0, v4
    s_nop 3
    v_cndmask_b32 v136, v6, v136, vcc
    v_cmp_le_i32 vcc, 1, v4
    s_nop 1
    v_cndmask_b32 v137, v6, v137, vcc
    v_cmp_le_i32 vcc, 2, v4
    s_nop 1
    v_cndmask_b32 v138, v6, v138, vcc
    v_cmp_le_i32 vcc, 3, v4
    s_nop 1
    v_cndmask_b32 v139, v6, v139, vcc
    v_cmp_le_i32 vcc, 4, v4
    s_nop 1
    v_cndmask_b32 v140, v6, v140, vcc
    v_cmp_le_i32 vcc, 5, v4
    s_nop 1
    v_cndmask_b32 v141, v6, v141, vcc
    v_cmp_le_i32 vcc, 6, v4
    s_nop 1
    v_cndmask_b32 v142, v6, v142, vcc
    v_cmp_le_i32 vcc, 7, v4
    s_nop 1
    v_cndmask_b32 v143, v6, v143, vcc
    v_cmp_le_i32 vcc, -4, v4
    s_nop 1
    v_cndmask_b32 v148, v6, v148, vcc
    v_cmp_le_i32 vcc, -3, v4
    s_nop 1
    v_cndmask_b32 v149, v6, v149, vcc
    v_cmp_le_i32 vcc, -2, v4
    s_nop 1
    v_cndmask_b32 v150, v6, v150, vcc
    v_cmp_le_i32 vcc, -1, v4
    s_nop 1
    v_cndmask_b32 v151, v6, v151, vcc
    v_cmp_le_i32 vcc, 0, v4
    s_nop 1
    v_cndmask_b32 v152, v6, v152, vcc
    v_cmp_le_i32 vcc, 1, v4
    s_nop 1
    v_cndmask_b32 v153, v6, v153, vcc
    v_cmp_le_i32 vcc, 2, v4
    s_nop 1
    v_cndmask_b32 v154, v6, v154, vcc
    v_cmp_le_i32 vcc, 3, v4
    s_nop 1
    v_cndmask_b32 v155, v6, v155, vcc
    s_nop 1
    v_and_b32 v198, 1, v0
    v_lshlrev_b32 v198, 2, v198
    v_add_u32 v198, 48, v198
    s_add_u32 s41, s16, s95
    s_add_u32 s41, s41, 1
    s_cmp_lt_u32 s16, 56
    s_cbranch_scc1 L_amk
    v_mov_b32 v198, 16384
    s_sub_u32 s41, s41, 1
    s_mov_b32 s44, 8
L_amk:
    s_sub_u32 s43, s41, s95
    s_sub_u32 s43, s43, 1
    s_mov_b32 s88, 65536
    s_mov_b32 s89, 125853696
cw18:
    buffer_load_dword v199, off, s[4:7], s89 sc1
    s_waitcnt vmcnt(0)
    v_readfirstlane_b32 s42, v199
    s_nop 0
    s_sub_u32 s42, s42, s95
    s_cmp_gt_u32 s42, 64
    s_cselect_b32 s42, 0, s42
    s_add_u32 s42, s42, 1
    s_cmp_ge_u32 s42, s43
    s_cbranch_scc1 cw18x
    s_sub_u32 s88, s88, 1
    s_cbranch_scc1 cw18x
    s_sub_u32 s42, s43, s42
    s_min_u32 s42, s42, 6
cw18s:
    s_sleep 24
    s_sub_u32 s42, s42, 1
    s_cmp_lg_u32 s42, 0
    s_cbranch_scc1 cw18s
    s_branch cw18
cw18x:
    s_mov_b32 s40, 4194304
L_aw2:
    buffer_load_dword v199, v198, s[4:7], s36 offen sc1
    s_sub_u32 s40, s40, 1
    s_cbranch_scc1 L_aw2_go
    s_waitcnt vmcnt(0)
    v_subrev_u32 v199, s41, v199
    v_cmp_lt_u32 vcc, 64, v199
    s_cbranch_vccz L_aw2_go
    s_sleep 1
    s_branch L_aw2
L_aw2_go:
at_ldm:
    s_lshl_b32 s20, s18, 12
    s_add_u32 s20, s20, 69206016
    buffer_load_dwordx4 v[72:75], v3, s[4:7], s20 offen offset:0 sc1
    buffer_load_dwordx4 v[76:79], v3, s[4:7], s20 offen offset:1024 sc1
    buffer_load_dwordx4 v[80:83], v3, s[4:7], s20 offen offset:2048 sc1
    buffer_load_dwordx4 v[84:87], v3, s[4:7], s20 offen offset:3072 sc1
    s_lshl_b32 s20, s18, 12
    s_add_u32 s20, s20, 77594624
    buffer_load_dwordx4 v[120:123], v2, s[4:7], s20 offen offset:0 sc1
    buffer_load_dwordx4 v[124:127], v2, s[4:7], s20 offen offset:1024 sc1
    buffer_load_dwordx4 v[128:131], v2, s[4:7], s20 offen offset:2048 sc1
    buffer_load_dwordx4 v[132:135], v2, s[4:7], s20 offen offset:3072 sc1
    s_cmp_lt_u32 s16, 56
    s_cbranch_scc1 at_ok
    s_waitcnt vmcnt(0)
    v_max_u32 v196, v72, v73
    v_max3_u32 v196, v196, v74, v75
    v_max3_u32 v196, v196, v76, v77
    v_max3_u32 v196, v196, v78, v79
    v_max3_u32 v196, v196, v80, v81
    v_max3_u32 v196, v196, v82, v83
    v_max3_u32 v196, v196, v84, v85
    v_max3_u32 v196, v196, v86, v87
    v_max3_u32 v196, v196, v120, v121
    v_max3_u32 v196, v196, v122, v123
    v_max3_u32 v196, v196, v124, v125
    v_max3_u32 v196, v196, v126, v127
    v_max3_u32 v196, v196, v128, v129
    v_max3_u32 v196, v196, v130, v131
    v_max3_u32 v196, v196, v132, v133
    v_max3_u32 v196, v196, v134, v135
    v_cmp_eq_u32 vcc, -1, v196
    s_cbranch_vccz at_ok
    s_sub_u32 s44, s44, 1
    s_cbranch_scc1 at_ok
    s_cmp_lg_u32 s44, 0
    s_cbranch_scc1 at_ldm
    s_add_u32 s41, s41, 1
    s_mov_b32 s40, 4194304
L_aw3:
    buffer_load_dword v199, v198, s[4:7], s36 offen sc1
    s_sub_u32 s40, s40, 1
    s_cbranch_scc1 L_aw3_go
    s_waitcnt vmcnt(0)
    v_subrev_u32 v199, s41, v199
    v_cmp_lt_u32 vcc, 64, v199
    s_cbranch_vccz L_aw3_go
    s_sleep 1
    s_branch L_aw3
L_aw3_go:
    s_branch at_ldm
at_ok:
    s_waitcnt vmcnt(4)
    v_mfma_f32_16x16x32_bf16 v[144:147], v[72:75], v[8:11], 0
    v_mfma_f32_16x16x32_bf16 v[156:159], v[72:75], v[24:27], 0
    v_mfma_f32_16x16x32_bf16 v[144:147], v[76:79], v[12:15], v[144:147]
    v_mfma_f32_16x16x32_bf16 v[156:159], v[76:79], v[28:31], v[156:159]
    v_mfma_f32_16x16x32_bf16 v[144:147], v[80:83], v[16:19], v[144:147]
    v_mfma_f32_16x16x32_bf16 v[156:159], v[80:83], v[32:35], v[156:159]
    v_mfma_f32_16x16x32_bf16 v[144:147], v[84:87], v[20:23], v[144:147]
    v_mfma_f32_16x16x32_bf16 v[156:159], v[84:87], v[36:39], v[156:159]
    v_max3_f32 v196, v136, v137, v138
    v_max3_f32 v197, v139, v140, v141
    v_max3_f32 v196, v196, v142, v143
    s_nop 3
    v_max3_f32 v197, v197, v144, v145
    v_max3_f32 v196, v196, v146, v147
    v_max_f32 v196, v196, v197
    v_mov_b32 v197, v196
    s_nop 1
    v_permlane32_swap_b32 v196, v197
    v_max_f32 v196, v196, v197
    v_mov_b32 v197, v196
    s_nop 1
    v_permlane16_swap_b32 v196, v197
    v_max_f32 v196, v196, v197
    v_mul_f32 v196, s22, v196
    v_sub_f32 v196, 0, v196
    v_fma_f32 v136, v136, s22, v196
    v_fma_f32 v137, v137, s22, v196
    v_fma_f32 v138, v138, s22, v196
    v_fma_f32 v139, v139, s22, v196
    v_fma_f32 v140, v140, s22, v196
    v_fma_f32 v141, v141, s22, v196
    v_fma_f32 v142, v142, s22, v196
    v_fma_f32 v143, v143, s22, v196
    v_fma_f32 v144, v144, s22, v196
    v_fma_f32 v145, v145, s22, v196
    v_fma_f32 v146, v146, s22, v196
    v_fma_f32 v147, v147, s22, v196
    v_exp_f32 v136, v136
    v_exp_f32 v137, v137
    v_exp_f32 v138, v138
    v_exp_f32 v139, v139
    v_exp_f32 v140, v140
    v_exp_f32 v141, v141
    v_exp_f32 v142, v142
    v_exp_f32 v143, v143
    v_exp_f32 v144, v144
    v_exp_f32 v145, v145
    v_exp_f32 v146, v146
    v_exp_f32 v147, v147
    v_cvt_pk_bf16_f32 v160, v136, v137
    v_cvt_pk_bf16_f32 v161, v138, v139
    v_cvt_pk_bf16_f32 v162, v140, v141
    v_cvt_pk_bf16_f32 v163, v142, v143
    v_cvt_pk_bf16_f32 v164, v144, v145
    v_cvt_pk_bf16_f32 v165, v146, v147
    v_max3_f32 v196, v148, v149, v150
    v_max3_f32 v197, v151, v152, v153
    v_max3_f32 v196, v196, v154, v155
    v_max3_f32 v197, v197, v156, v157
    v_max3_f32 v196, v196, v158, v159
    v_max_f32 v196, v196, v197
    v_mov_b32 v197, v196
    s_nop 1
    v_permlane32_swap_b32 v196, v197
    v_max_f32 v196, v196, v197
    v_mov_b32 v197, v196
    s_nop 1
    v_permlane16_swap_b32 v196, v197
    v_max_f32 v196, v196, v197
    v_mul_f32 v196, s22, v196
    v_sub_f32 v196, 0, v196
    v_fma_f32 v148, v148, s22, v196
    v_fma_f32 v149, v149, s22, v196
    v_fma_f32 v150, v150, s22, v196
    v_fma_f32 v151, v151, s22, v196
    v_fma_f32 v152, v152, s22, v196
    v_fma_f32 v153, v153, s22, v196
    v_fma_f32 v154, v154, s22, v196
    v_fma_f32 v155, v155, s22, v196
    v_fma_f32 v156, v156, s22, v196
    v_fma_f32 v157, v157, s22, v196
    v_fma_f32 v158, v158, s22, v196
    v_fma_f32 v159, v159, s22, v196
    v_exp_f32 v148, v148
    v_exp_f32 v149, v149
    v_exp_f32 v150, v150
    v_exp_f32 v151, v151
    v_exp_f32 v152, v152
    v_exp_f32 v153, v153
    v_exp_f32 v154, v154
    v_exp_f32 v155, v155
    v_exp_f32 v156, v156
    v_exp_f32 v157, v157
    v_exp_f32 v158, v158
    v_exp_f32 v159, v159
    v_cvt_pk_bf16_f32 v166, v148, v149
    v_cvt_pk_bf16_f32 v167, v150, v151
    v_cvt_pk_bf16_f32 v168, v152, v153
    v_cvt_pk_bf16_f32 v169, v154, v155
    v_cvt_pk_bf16_f32 v170, v156, v157
    v_cvt_pk_bf16_f32 v171, v158, v159
    v_mfma_f32_16x16x32_bf16 v[180:183], v[172:175], v[160:163], 0
    v_mfma_f32_16x16x32_bf16 v[184:187], v[172:175], v[166:169], 0
    s_nop 4
    v_mfma_f32_16x16x16_bf16 v[180:183], v[176:177], v[164:165], v[180:183]
    v_mfma_f32_16x16x16_bf16 v[184:187], v[176:177], v[170:171], v[184:187]
    s_nop 6
    v_rcp_f32 v180, v180
    v_rcp_f32 v184, v184
    s_waitcnt vmcnt(0)
    s_lshl_b32 s18, s16, 18
    s_lshl_b32 s19, s17, 12
    s_add_u32 s18, s18, s19
    s_add_u32 s18, s18, 50331648
    s_add_u32 s19, s18, 131072
    v_mfma_f32_16x16x32_bf16 v[8:11], v[88:91], v[160:163], 0
    v_mfma_f32_16x16x32_bf16 v[12:15], v[104:107], v[160:163], 0
    v_mfma_f32_16x16x32_bf16 v[16:19], v[88:91], v[166:169], 0
    v_mfma_f32_16x16x32_bf16 v[20:23], v[104:107], v[166:169], 0
    v_mfma_f32_16x16x32_bf16 v[24:27], v[92:95], v[160:163], 0
    v_mfma_f32_16x16x32_bf16 v[28:31], v[108:111], v[160:163], 0
    v_mfma_f32_16x16x32_bf16 v[32:35], v[92:95], v[166:169], 0
    v_mfma_f32_16x16x32_bf16 v[36:39], v[108:111], v[166:169], 0
    v_mfma_f32_16x16x32_bf16 v[40:43], v[96:99], v[160:163], 0
    v_mfma_f32_16x16x32_bf16 v[44:47], v[112:115], v[160:163], 0
    v_mfma_f32_16x16x32_bf16 v[48:51], v[96:99], v[166:169], 0
    v_mfma_f32_16x16x32_bf16 v[52:55], v[112:115], v[166:169], 0
    v_mfma_f32_16x16x32_bf16 v[56:59], v[100:103], v[160:163], 0
    v_mfma_f32_16x16x32_bf16 v[60:63], v[116:119], v[160:163], 0
    v_mfma_f32_16x16x32_bf16 v[64:67], v[100:103], v[166:169], 0
    v_mfma_f32_16x16x32_bf16 v[68:71], v[116:119], v[166:169], 0
    v_mfma_f32_16x16x16_bf16 v[8:11], v[120:121], v[164:165], v[8:11]
    v_mfma_f32_16x16x16_bf16 v[12:15], v[122:123], v[164:165], v[12:15]
    v_mfma_f32_16x16x16_bf16 v[16:19], v[120:121], v[170:171], v[16:19]
    v_mfma_f32_16x16x16_bf16 v[20:23], v[122:123], v[170:171], v[20:23]
    v_mfma_f32_16x16x16_bf16 v[24:27], v[124:125], v[164:165], v[24:27]
    v_mfma_f32_16x16x16_bf16 v[28:31], v[126:127], v[164:165], v[28:31]
    v_mfma_f32_16x16x16_bf16 v[32:35], v[124:125], v[170:171], v[32:35]
    v_mfma_f32_16x16x16_bf16 v[36:39], v[126:127], v[170:171], v[36:39]
    v_mfma_f32_16x16x16_bf16 v[40:43], v[128:129], v[164:165], v[40:43]
    v_mfma_f32_16x16x16_bf16 v[44:47], v[130:131], v[164:165], v[44:47]
    v_mfma_f32_16x16x16_bf16 v[48:51], v[128:129], v[170:171], v[48:51]
    v_mfma_f32_16x16x16_bf16 v[52:55], v[130:131], v[170:171], v[52:55]
    v_mfma_f32_16x16x16_bf16 v[56:59], v[132:133], v[164:165], v[56:59]
    v_mfma_f32_16x16x16_bf16 v[60:63], v[134:135], v[164:165], v[60:63]
    v_mfma_f32_16x16x16_bf16 v[64:67], v[132:133], v[170:171], v[64:67]
    v_mfma_f32_16x16x16_bf16 v[68:71], v[134:135], v[170:171], v[68:71]
    v_mul_f32 v8, v8, v180
    v_mul_f32 v12, v12, v180
    v_mul_f32 v9, v9, v180
    v_mul_f32 v13, v13, v180
    v_mul_f32 v10, v10, v180
    v_mul_f32 v14, v14, v180
    v_mul_f32 v11, v11, v180
    v_mul_f32 v15, v15, v180
    v_cvt_pk_bf16_f32 v8, v8, v9
    v_cvt_pk_bf16_f32 v9, v10, v11
    v_cvt_pk_bf16_f32 v10, v12, v13
    v_cvt_pk_bf16_f32 v11, v14, v15
    buffer_store_dwordx4 v[8:11], v1, s[4:7], s18 offen offset:0 sc1
    v_mul_f32 v16, v16, v184
    v_mul_f32 v20, v20, v184
    v_mul_f32 v17, v17, v184
    v_mul_f32 v21, v21, v184
    v_mul_f32 v18, v18, v184
    v_mul_f32 v22, v22, v184
    v_mul_f32 v19, v19, v184
    v_mul_f32 v23, v23, v184
    v_cvt_pk_bf16_f32 v16, v16, v17
    v_cvt_pk_bf16_f32 v17, v18, v19
    v_cvt_pk_bf16_f32 v18, v20, v21
    v_cvt_pk_bf16_f32 v19, v22, v23
    buffer_store_dwordx4 v[16:19], v1, s[4:7], s19 offen offset:0 sc1
    v_mul_f32 v24, v24, v180
    v_mul_f32 v28, v28, v180
    v_mul_f32 v25, v25, v180
    v_mul_f32 v29, v29, v180
    v_mul_f32 v26, v26, v180
    v_mul_f32 v30, v30, v180
    v_mul_f32 v27, v27, v180
    v_mul_f32 v31, v31, v180
    v_cvt_pk_bf16_f32 v24, v24, v25
    v_cvt_pk_bf16_f32 v25, v26, v27
    v_cvt_pk_bf16_f32 v26, v28, v29
    v_cvt_pk_bf16_f32 v27, v30, v31
    buffer_store_dwordx4 v[24:27], v1, s[4:7], s18 offen offset:1024 sc1
    v_mul_f32 v32, v32, v184
    v_mul_f32 v36, v36, v184
    v_mul_f32 v33, v33, v184
    v_mul_f32 v37, v37, v184
    v_mul_f32 v34, v34, v184
    v_mul_f32 v38, v38, v184
    v_mul_f32 v35, v35, v184
    v_mul_f32 v39, v39, v184
    v_cvt_pk_bf16_f32 v32, v32, v33
    v_cvt_pk_bf16_f32 v33, v34, v35
    v_cvt_pk_bf16_f32 v34, v36, v37
    v_cvt_pk_bf16_f32 v35, v38, v39
    buffer_store_dwordx4 v[32:35], v1, s[4:7], s19 offen offset:1024 sc1
    v_mul_f32 v40, v40, v180
    v_mul_f32 v44, v44, v180
    v_mul_f32 v41, v41, v180
    v_mul_f32 v45, v45, v180
    v_mul_f32 v42, v42, v180
    v_mul_f32 v46, v46, v180
    v_mul_f32 v43, v43, v180
    v_mul_f32 v47, v47, v180
    v_cvt_pk_bf16_f32 v40, v40, v41
    v_cvt_pk_bf16_f32 v41, v42, v43
    v_cvt_pk_bf16_f32 v42, v44, v45
    v_cvt_pk_bf16_f32 v43, v46, v47
    buffer_store_dwordx4 v[40:43], v1, s[4:7], s18 offen offset:2048 sc1
    v_mul_f32 v48, v48, v184
    v_mul_f32 v52, v52, v184
    v_mul_f32 v49, v49, v184
    v_mul_f32 v53, v53, v184
    v_mul_f32 v50, v50, v184
    v_mul_f32 v54, v54, v184
    v_mul_f32 v51, v51, v184
    v_mul_f32 v55, v55, v184
    v_cvt_pk_bf16_f32 v48, v48, v49
    v_cvt_pk_bf16_f32 v49, v50, v51
    v_cvt_pk_bf16_f32 v50, v52, v53
    v_cvt_pk_bf16_f32 v51, v54, v55
    buffer_store_dwordx4 v[48:51], v1, s[4:7], s19 offen offset:2048 sc1
    v_mul_f32 v56, v56, v180
    v_mul_f32 v60, v60, v180
    v_mul_f32 v57, v57, v180
    v_mul_f32 v61, v61, v180
    v_mul_f32 v58, v58, v180
    v_mul_f32 v62, v62, v180
    v_mul_f32 v59, v59, v180
    v_mul_f32 v63, v63, v180
    v_cvt_pk_bf16_f32 v56, v56, v57
    v_cvt_pk_bf16_f32 v57, v58, v59
    v_cvt_pk_bf16_f32 v58, v60, v61
    v_cvt_pk_bf16_f32 v59, v62, v63
    buffer_store_dwordx4 v[56:59], v1, s[4:7], s18 offen offset:3072 sc1
    v_mul_f32 v64, v64, v184
    v_mul_f32 v68, v68, v184
    v_mul_f32 v65, v65, v184
    v_mul_f32 v69, v69, v184
    v_mul_f32 v66, v66, v184
    v_mul_f32 v70, v70, v184
    v_mul_f32 v67, v67, v184
    v_mul_f32 v71, v71, v184
    v_cvt_pk_bf16_f32 v64, v64, v65
    v_cvt_pk_bf16_f32 v65, v66, v67
    v_cvt_pk_bf16_f32 v66, v68, v69
    v_cvt_pk_bf16_f32 v67, v70, v71
    buffer_store_dwordx4 v[64:67], v1, s[4:7], s19 offen offset:3072 sc1
    s_lshr_b32 s40, s34, 1
    s_lshl_b32 s40, s40, 7
    s_and_b32 s41, s34, 1
    s_lshl_b32 s41, s41, 2
    s_add_u32 s40, s40, s41
    s_add_u32 s40, s40, 125894656
    s_cmp_lt_u32 s16, 62
    s_cbranch_scc1 L_noef
    s_lshr_b32 s42, s34, 1
    s_mul_i32 s42, s42, 4096
    s_add_u32 s41, s41, s42
    s_add_u32 s41, s41, 124944384
    s_barrier
    s_cmp_lg_u32 s32, 0
    s_cbranch_scc1 L_noef
    v_mov_b32 v250, s95
    v_lshlrev_b32 v251, 7, v0
    s_mov_b64 exec, 262143
    buffer_store_dword v250, v251, s[4:7], s41 offen sc1
    s_mov_b64 exec, -1
L_noef:
    s_waitcnt vmcnt(0)
    s_barrier
    v_mov_b32 v250, s95
    v_cmp_eq_u32 vcc, 0, v0
    s_nop 0
    s_and_saveexec_b64 s[38:39], vcc
    s_cbranch_execz fs19
    buffer_store_dword v250, off, s[4:7], s40 sc1
fs19:
    s_mov_b64 exec, -1
    s_branch L_att_next
L_op_start:
    s_lshl_b32 s35, s33, 2
    s_add_u32 s35, s35, 136
    s_lshr_b32 s89, s33, 2
    s_lshl_b32 s89, s89, 7
    s_add_u32 s89, s89, 125841408
    v_mbcnt_lo_u32_b32 v2, -1, 0
    v_mbcnt_hi_u32_b32 v2, -1, v2
    v_min_u32 v2, 31, v2
    v_lshlrev_b32 v2, 2, v2
    s_mov_b32 s88, 4194304
fw20:
    buffer_load_dword v3, v2, s[4:7], s89 offen offset:0 sc1
    s_sub_u32 s88, s88, 1
    s_cbranch_scc1 fw20x
    s_waitcnt vmcnt(0)
    v_cmp_ne_u32 vcc, s95, v3
    s_cbranch_vccz fw20x
    s_sleep 4
    s_branch fw20
fw20x:
    v_and_b32 v1, 63, v0
    v_lshlrev_b32 v1, 4, v1
    s_lshl_b32 s18, s33, 18
    s_lshl_b32 s19, s32, 16
    s_add_u32 s18, s18, s19
    s_add_u32 s18, s18, 130023424
    buffer_load_dwordx4 a[0:3], v1, s[4:7], s18 offen offset:0 sc1
    buffer_load_dwordx4 a[4:7], v1, s[4:7], s18 offen offset:1024 sc1
    buffer_load_dwordx4 a[8:11], v1, s[4:7], s18 offen offset:2048 sc1
    buffer_load_dwordx4 a[12:15], v1, s[4:7], s18 offen offset:3072 sc1
    s_add_u32 s18, s18, 4096
    buffer_load_dwordx4 a[16:19], v1, s[4:7], s18 offen offset:0 sc1
    buffer_load_dwordx4 a[20:23], v1, s[4:7], s18 offen offset:1024 sc1
    buffer_load_dwordx4 a[24:27], v1, s[4:7], s18 offen offset:2048 sc1
    buffer_load_dwordx4 a[28:31], v1, s[4:7], s18 offen offset:3072 sc1
    s_add_u32 s18, s18, 4096
    buffer_load_dwordx4 a[32:35], v1, s[4:7], s18 offen offset:0 sc1
    buffer_load_dwordx4 a[36:39], v1, s[4:7], s18 offen offset:1024 sc1
    buffer_load_dwordx4 a[40:43], v1, s[4:7], s18 offen offset:2048 sc1
    buffer_load_dwordx4 a[44:47], v1, s[4:7], s18 offen offset:3072 sc1
    s_add_u32 s18, s18, 4096
    buffer_load_dwordx4 a[48:51], v1, s[4:7], s18 offen offset:0 sc1
    buffer_load_dwordx4 a[52:55], v1, s[4:7], s18 offen offset:1024 sc1
    buffer_load_dwordx4 a[56:59], v1, s[4:7], s18 offen offset:2048 sc1
    buffer_load_dwordx4 a[60:63], v1, s[4:7], s18 offen offset:3072 sc1
    s_add_u32 s18, s18, 4096
    buffer_load_dwordx4 a[64:67], v1, s[4:7], s18 offen offset:0 sc1
    buffer_load_dwordx4 a[68:71], v1, s[4:7], s18 offen offset:1024 sc1
    buffer_load_dwordx4 a[72:75], v1, s[4:7], s18 offen offset:2048 sc1
    buffer_load_dwordx4 a[76:79], v1, s[4:7], s18 offen offset:3072 sc1
    s_add_u32 s18, s18, 4096
    buffer_load_dwordx4 a[80:83], v1, s[4:7], s18 offen offset:0 sc1
    buffer_load_dwordx4 a[84:87], v1, s[4:7], s18 offen offset:1024 sc1
    buffer_load_dwordx4 a[88:91], v1, s[4:7], s18 offen offset:2048 sc1
    buffer_load_dwordx4 a[92:95], v1, s[4:7], s18 offen offset:3072 sc1
    s_add_u32 s18, s18, 4096
    buffer_load_dwordx4 a[96:99], v1, s[4:7], s18 offen offset:0 sc1
    buffer_load_dwordx4 a[100:103], v1, s[4:7], s18 offen offset:1024 sc1
    buffer_load_dwordx4 a[104:107], v1, s[4:7], s18 offen offset:2048 sc1
    buffer_load_dwordx4 a[108:111], v1, s[4:7], s18 offen offset:3072 sc1
    s_add_u32 s18, s18, 4096
    buffer_load_dwordx4 a[112:115], v1, s[4:7], s18 offen offset:0 sc1
    buffer_load_dwordx4 a[116:119], v1, s[4:7], s18 offen offset:1024 sc1
    buffer_load_dwordx4 a[120:123], v1, s[4:7], s18 offen offset:2048 sc1
    buffer_load_dwordx4 a[124:127], v1, s[4:7], s18 offen offset:3072 sc1
    s_add_u32 s18, s18, 4096
    buffer_load_dwordx4 a[128:131], v1, s[4:7], s18 offen offset:0 sc1
    buffer_load_dwordx4 a[132:135], v1, s[4:7], s18 offen offset:1024 sc1
    buffer_load_dwordx4 a[136:139], v1, s[4:7], s18 offen offset:2048 sc1
    buffer_load_dwordx4 a[140:143], v1, s[4:7], s18 offen offset:3072 sc1
    s_add_u32 s18, s18, 4096
    buffer_load_dwordx4 a[144:147], v1, s[4:7], s18 offen offset:0 sc1
    buffer_load_dwordx4 a[148:151], v1, s[4:7], s18 offen offset:1024 sc1
    buffer_load_dwordx4 a[152:155], v1, s[4:7], s18 offen offset:2048 sc1
    buffer_load_dwordx4 a[156:159], v1, s[4:7], s18 offen offset:3072 sc1
    s_add_u32 s18, s18, 4096
    buffer_load_dwordx4 a[160:163], v1, s[4:7], s18 offen offset:0 sc1
    s_waitcnt vmcnt(20)
    buffer_load_dwordx4 a[164:167], v1, s[4:7], s18 offen offset:1024 sc1
    buffer_load_dwordx4 a[168:171], v1, s[4:7], s18 offen offset:2048 sc1
    buffer_load_dwordx4 a[172:175], v1, s[4:7], s18 offen offset:3072 sc1
    s_add_u32 s18, s18, 4096
    buffer_load_dwordx4 a[176:179], v1, s[4:7], s18 offen offset:0 sc1
    buffer_load_dwordx4 a[180:183], v1, s[4:7], s18 offen offset:1024 sc1
    buffer_load_dwordx4 a[184:187], v1, s[4:7], s18 offen offset:2048 sc1
    buffer_load_dwordx4 a[188:191], v1, s[4:7], s18 offen offset:3072 sc1
    s_add_u32 s18, s18, 4096
    buffer_load_dwordx4 a[192:195], v1, s[4:7], s18 offen offset:0 sc1
    buffer_load_dwordx4 a[196:199], v1, s[4:7], s18 offen offset:1024 sc1
    buffer_load_dwordx4 a[200:203], v1, s[4:7], s18 offen offset:2048 sc1
    buffer_load_dwordx4 a[204:207], v1, s[4:7], s18 offen offset:3072 sc1
    s_add_u32 s18, s18, 4096
    buffer_load_dwordx4 a[208:211], v1, s[4:7], s18 offen offset:0 sc1
    buffer_load_dwordx4 a[212:215], v1, s[4:7], s18 offen offset:1024 sc1
    buffer_load_dwordx4 a[216:219], v1, s[4:7], s18 offen offset:2048 sc1
    buffer_load_dwordx4 a[220:223], v1, s[4:7], s18 offen offset:3072 sc1
    s_add_u32 s18, s18, 4096
    buffer_load_dwordx4 a[224:227], v1, s[4:7], s18 offen offset:0 sc1
    buffer_load_dwordx4 a[228:231], v1, s[4:7], s18 offen offset:1024 sc1
    buffer_load_dwordx4 a[232:235], v1, s[4:7], s18 offen offset:2048 sc1
    buffer_load_dwordx4 a[236:239], v1, s[4:7], s18 offen offset:3072 sc1
    s_add_u32 s18, s18, 4096
    buffer_load_dwordx4 a[240:243], v1, s[4:7], s18 offen offset:0 sc1
    buffer_load_dwordx4 a[244:247], v1, s[4:7], s18 offen offset:1024 sc1
    buffer_load_dwordx4 a[248:251], v1, s[4:7], s18 offen offset:2048 sc1
    buffer_load_dwordx4 a[252:255], v1, s[4:7], s18 offen offset:3072 sc1
    s_waitcnt vmcnt(0)
    s_mov_b32 s44, 0
    s_mov_b32 s37, s35
    v_mov_b32 v250, 1
    v_mov_b32 v251, 163832
    v_cmp_eq_u32 vcc, 0, v0
    s_nop 0
    s_and_saveexec_b64 s[38:39], vcc
    s_cbranch_execz tk21
    buffer_atomic_add v250, off, s[84:87], s37 sc0
    s_waitcnt vmcnt(0)
    ds_write_b32 v251, v250
    s_waitcnt lgkmcnt(0)
tk21:
    s_mov_b64 exec, -1
    s_barrier
    ds_read_b32 v252, v251
    s_waitcnt lgkmcnt(0)
    v_readfirstlane_b32 s16, v252
    s_barrier
    s_nop 3
    s_cmp_ge_u32 s16, 72
    s_cbranch_scc1 L_op_nextcb
L_op_seg:
    s_min_u32 s43, s16, 56
    s_add_u32 s16, s16, s43
    s_lshr_b32 s43, s16, 1
    s_add_u32 s43, s43, 2
    s_min_u32 s43, s43, 63
    s_lshl_b32 s94, s33, 7
    s_add_u32 s94, s94, s16
    s_mov_b32 s88, 65536
    s_mov_b32 s89, 125853696
cw22:
    buffer_load_dword v3, off, s[4:7], s89 sc1
    s_waitcnt vmcnt(0)
    v_readfirstlane_b32 s42, v3
    s_nop 0
    s_sub_u32 s42, s42, s95
    s_cmp_gt_u32 s42, 64
    s_cselect_b32 s42, 0, s42
    s_add_u32 s42, s42, 1
    s_cmp_ge_u32 s42, s43
    s_cbranch_scc1 cw22x
    s_sub_u32 s88, s88, 1
    s_cbranch_scc1 cw22x
    s_sub_u32 s42, s43, s42
    s_min_u32 s42, s42, 6
cw22s:
    s_sleep 24
    s_sub_u32 s42, s42, 1
    s_cmp_lg_u32 s42, 0
    s_cbranch_scc1 cw22s
    s_branch cw22
cw22x:
    s_lshr_b32 s89, s16, 1
    s_lshl_b32 s89, s89, 2
    s_add_u32 s89, s89, s32
    s_lshl_b32 s89, s89, 7
    s_add_u32 s89, s89, 125894656
    s_sub_u32 s47, s89, 125894656
    s_lshl_b32 s47, s47, 5
    s_lshl_b32 s46, s33, 7
    s_add_u32 s47, s47, s46
    s_add_u32 s47, s47, 124944384
    s_cmp_ge_u32 s16, 124
    s_cselect_b32 s46, 8, 0
    s_cselect_b32 s47, s47, s89
    v_mbcnt_lo_u32_b32 v2, -1, 0
    v_mbcnt_hi_u32_b32 v2, -1, v2
    v_min_u32 v2, 1, v2
    v_lshlrev_b32 v2, 2, v2
    s_mov_b32 s88, 4194304
fw23:
    buffer_load_dword v3, v2, s[4:7], s47 offen offset:0 sc1
    s_sub_u32 s88, s88, 1
    s_cbranch_scc1 fw23x
    s_waitcnt vmcnt(0)
    v_cmp_ne_u32 vcc, s95, v3
    s_cbranch_vccz fw23x
    s_sleep 1
    s_branch fw23
fw23x:
    v_mov_b32 v250, 1
    v_lshrrev_b32 v252, 2, v1
    v_min_u32 v252, 68, v252
    s_cmp_lg_u32 s32, 0
    s_cbranch_scc1 L_op_na
    s_mov_b64 exec, 1
    buffer_atomic_add v250, off, s[84:87], s35 sc0
    s_mov_b64 exec, -1
    s_cmp_lg_u32 s44, 0
    s_cbranch_scc1 L_op_na
    buffer_load_dword v253, v252, s[84:87], 0 offen offset:136 sc1
L_op_na:
    s_cmp_ge_u32 s16, 112
    s_cbranch_scc1 L_op_one
o2_again:
    s_lshl_b32 s18, s16, 17
    s_lshl_b32 s19, s32, 15
    s_add_u32 s18, s18, s19
    s_add_u32 s18, s18, 50331648
    buffer_load_dwordx4 v[24:27], v1, s[4:7], s18 offen offset:0 sc1
    buffer_load_dwordx4 v[28:31], v1, s[4:7], s18 offen offset:1024 sc1
    buffer_load_dwordx4 v[32:35], v1, s[4:7], s18 offen offset:2048 sc1
    buffer_load_dwordx4 v[36:39], v1, s[4:7], s18 offen offset:3072 sc1
    s_add_u32 s18, s18, 4096
    buffer_load_dwordx4 v[40:43], v1, s[4:7], s18 offen offset:0 sc1
    buffer_load_dwordx4 v[44:47], v1, s[4:7], s18 offen offset:1024 sc1
    buffer_load_dwordx4 v[48:51], v1, s[4:7], s18 offen offset:2048 sc1
    buffer_load_dwordx4 v[52:55], v1, s[4:7], s18 offen offset:3072 sc1
    s_add_u32 s18, s18, 4096
    buffer_load_dwordx4 v[56:59], v1, s[4:7], s18 offen offset:0 sc1
    buffer_load_dwordx4 v[60:63], v1, s[4:7], s18 offen offset:1024 sc1
    buffer_load_dwordx4 v[64:67], v1, s[4:7], s18 offen offset:2048 sc1
    buffer_load_dwordx4 v[68:71], v1, s[4:7], s18 offen offset:3072 sc1
    s_add_u32 s18, s18, 4096
    buffer_load_dwordx4 v[72:75], v1, s[4:7], s18 offen offset:0 sc1
    buffer_load_dwordx4 v[76:79], v1, s[4:7], s18 offen offset:1024 sc1
    buffer_load_dwordx4 v[80:83], v1, s[4:7], s18 offen offset:2048 sc1
    buffer_load_dwordx4 v[84:87], v1, s[4:7], s18 offen offset:3072 sc1
    s_add_u32 s18, s18, 4096
    buffer_load_dwordx4 v[88:91], v1, s[4:7], s18 offen offset:0 sc1
    buffer_load_dwordx4 v[92:95], v1, s[4:7], s18 offen offset:1024 sc1
    buffer_load_dwordx4 v[96:99], v1, s[4:7], s18 offen offset:2048 sc1
    buffer_load_dwordx4 v[100:103], v1, s[4:7], s18 offen offset:3072 sc1
    s_add_u32 s18, s18, 4096
    buffer_load_dwordx4 v[104:107], v1, s[4:7], s18 offen offset:0 sc1
    buffer_load_dwordx4 v[108:111], v1, s[4:7], s18 offen offset:1024 sc1
    buffer_load_dwordx4 v[112:115], v1, s[4:7], s18 offen offset:2048 sc1
    buffer_load_dwordx4 v[116:119], v1, s[4:7], s18 offen offset:3072 sc1
    s_add_u32 s18, s18, 4096
    buffer_load_dwordx4 v[120:123], v1, s[4:7], s18 offen offset:0 sc1
    buffer_load_dwordx4 v[124:127], v1, s[4:7], s18 offen offset:1024 sc1
    buffer_load_dwordx4 v[128:131], v1, s[4:7], s18 offen offset:2048 sc1
    buffer_load_dwordx4 v[132:135], v1, s[4:7], s18 offen offset:3072 sc1
    s_add_u32 s18, s18, 4096
    buffer_load_dwordx4 v[136:139], v1, s[4:7], s18 offen offset:0 sc1
    buffer_load_dwordx4 v[140:143], v1, s[4:7], s18 offen offset:1024 sc1
    buffer_load_dwordx4 v[144:147], v1, s[4:7], s18 offen offset:2048 sc1
    buffer_load_dwordx4 v[148:151], v1, s[4:7], s18 offen offset:3072 sc1
    s_add_u32 s18, s18, 102400
    buffer_load_dwordx4 v[152:155], v1, s[4:7], s18 offen offset:0 sc1
    buffer_load_dwordx4 v[156:159], v1, s[4:7], s18 offen offset:1024 sc1
    buffer_load_dwordx4 v[160:163], v1, s[4:7], s18 offen offset:2048 sc1
    buffer_load_dwordx4 v[164:167], v1, s[4:7], s18 offen offset:3072 sc1
    s_add_u32 s18, s18, 4096
    buffer_load_dwordx4 v[168:171], v1, s[4:7], s18 offen offset:0 sc1
    buffer_load_dwordx4 v[172:175], v1, s[4:7], s18 offen offset:1024 sc1
    buffer_load_dwordx4 v[176:179], v1, s[4:7], s18 offen offset:2048 sc1
    buffer_load_dwordx4 v[180:183], v1, s[4:7], s18 offen offset:3072 sc1
    s_add_u32 s18, s18, 4096
    buffer_load_dwordx4 v[184:187], v1, s[4:7], s18 offen offset:0 sc1
    buffer_load_dwordx4 v[188:191], v1, s[4:7], s18 offen offset:1024 sc1
    buffer_load_dwordx4 v[192:195], v1, s[4:7], s18 offen offset:2048 sc1
    buffer_load_dwordx4 v[196:199], v1, s[4:7], s18 offen offset:3072 sc1
    s_add_u32 s18, s18, 4096
    buffer_load_dwordx4 v[200:203], v1, s[4:7], s18 offen offset:0 sc1
    buffer_load_dwordx4 v[204:207], v1, s[4:7], s18 offen offset:1024 sc1
    buffer_load_dwordx4 v[208:211], v1, s[4:7], s18 offen offset:2048 sc1
    buffer_load_dwordx4 v[212:215], v1, s[4:7], s18 offen offset:3072 sc1
    s_add_u32 s18, s18, 4096
    buffer_load_dwordx4 v[216:219], v1, s[4:7], s18 offen offset:0 sc1
    buffer_load_dwordx4 v[220:223], v1, s[4:7], s18 offen offset:1024 sc1
    buffer_load_dwordx4 v[224:227], v1, s[4:7], s18 offen offset:2048 sc1
    buffer_load_dwordx4 v[228:231], v1, s[4:7], s18 offen offset:3072 sc1
    s_add_u32 s18, s18, 4096
    buffer_load_dwordx4 v[232:235], v1, s[4:7], s18 offen offset:0 sc1
    buffer_load_dwordx4 v[236:239], v1, s[4:7], s18 offen offset:1024 sc1
    buffer_load_dwordx4 v[240:243], v1, s[4:7], s18 offen offset:2048 sc1
    buffer_load_dwordx4 v[244:247], v1, s[4:7], s18 offen offset:3072 sc1
    v_lshlrev_b32 v2, 4, v0
    v_and_b32 v3, 3072, v2
    v_lshl_add_u32 v2, v3, 1, v1
    s_waitcnt vmcnt(55)
    v_mfma_f32_16x16x32_bf16 v[8:11], a[0:3], v[24:27], 0
    v_mfma_f32_16x16x32_bf16 v[12:15], a[4:7], v[24:27], 0
    s_add_u32 s18, s18, 4096
    buffer_load_dwordx4 v[24:27], v1, s[4:7], s18 offen offset:0 sc1
    s_waitcnt vmcnt(55)
    v_mfma_f32_16x16x32_bf16 v[8:11], a[8:11], v[28:31], v[8:11]
    v_mfma_f32_16x16x32_bf16 v[12:15], a[12:15], v[28:31], v[12:15]
    buffer_load_dwordx4 v[28:31], v1, s[4:7], s18 offen offset:1024 sc1
    s_waitcnt vmcnt(55)
    v_mfma_f32_16x16x32_bf16 v[8:11], a[16:19], v[32:35], v[8:11]
    v_mfma_f32_16x16x32_bf16 v[12:15], a[20:23], v[32:35], v[12:15]
    buffer_load_dwordx4 v[32:35], v1, s[4:7], s18 offen offset:2048 sc1
    s_waitcnt vmcnt(55)
    v_mfma_f32_16x16x32_bf16 v[8:11], a[24:27], v[36:39], v[8:11]
    v_mfma_f32_16x16x32_bf16 v[12:15], a[28:31], v[36:39], v[12:15]
    buffer_load_dwordx4 v[36:39], v1, s[4:7], s18 offen offset:3072 sc1
    s_waitcnt vmcnt(55)
    v_mfma_f32_16x16x32_bf16 v[8:11], a[32:35], v[40:43], v[8:11]
    v_mfma_f32_16x16x32_bf16 v[12:15], a[36:39], v[40:43], v[12:15]
    s_add_u32 s18, s18, 4096
    buffer_load_dwordx4 v[40:43], v1, s[4:7], s18 offen offset:0 sc1
    s_waitcnt vmcnt(55)
    v_mfma_f32_16x16x32_bf16 v[8:11], a[40:43], v[44:47], v[8:11]
    v_mfma_f32_16x16x32_bf16 v[12:15], a[44:47], v[44:47], v[12:15]
    buffer_load_dwordx4 v[44:47], v1, s[4:7], s18 offen offset:1024 sc1
    s_waitcnt vmcnt(55)
    v_mfma_f32_16x16x32_bf16 v[8:11], a[48:51], v[48:51], v[8:11]
    v_mfma_f32_16x16x32_bf16 v[12:15], a[52:55], v[48:51], v[12:15]
    buffer_load_dwordx4 v[48:51], v1, s[4:7], s18 offen offset:2048 sc1
    s_waitcnt vmcnt(55)
    v_mfma_f32_16x16x32_bf16 v[8:11], a[56:59], v[52:55], v[8:11]
    v_mfma_f32_16x16x32_bf16 v[12:15], a[60:63], v[52:55], v[12:15]
    buffer_load_dwordx4 v[52:55], v1, s[4:7], s18 offen offset:3072 sc1
    s_waitcnt vmcnt(55)
    v_mfma_f32_16x16x32_bf16 v[8:11], a[64:67], v[56:59], v[8:11]
    v_mfma_f32_16x16x32_bf16 v[12:15], a[68:71], v[56:59], v[12:15]
    s_waitcnt vmcnt(54)
    v_mfma_f32_16x16x32_bf16 v[8:11], a[72:75], v[60:63], v[8:11]
    v_mfma_f32_16x16x32_bf16 v[12:15], a[76:79], v[60:63], v[12:15]
    s_waitcnt vmcnt(53)
    v_mfma_f32_16x16x32_bf16 v[8:11], a[80:83], v[64:67], v[8:11]
    v_mfma_f32_16x16x32_bf16 v[12:15], a[84:87], v[64:67], v[12:15]
    s_waitcnt vmcnt(52)
    v_mfma_f32_16x16x32_bf16 v[8:11], a[88:91], v[68:71], v[8:11]
    v_mfma_f32_16x16x32_bf16 v[12:15], a[92:95], v[68:71], v[12:15]
    s_waitcnt vmcnt(51)
    v_mfma_f32_16x16x32_bf16 v[8:11], a[96:99], v[72:75], v[8:11]
    v_mfma_f32_16x16x32_bf16 v[12:15], a[100:103], v[72:75], v[12:15]
    s_waitcnt vmcnt(50)
    v_mfma_f32_16x16x32_bf16 v[8:11], a[104:107], v[76:79], v[8:11]
    v_mfma_f32_16x16x32_bf16 v[12:15], a[108:111], v[76:79], v[12:15]
    s_waitcnt vmcnt(49)
    v_mfma_f32_16x16x32_bf16 v[8:11], a[112:115], v[80:83], v[8:11]
    v_mfma_f32_16x16x32_bf16 v[12:15], a[116:119], v[80:83], v[12:15]
    s_waitcnt vmcnt(48)
    v_mfma_f32_16x16x32_bf16 v[8:11], a[120:123], v[84:87], v[8:11]
    v_mfma_f32_16x16x32_bf16 v[12:15], a[124:127], v[84:87], v[12:15]
    s_waitcnt vmcnt(47)
    v_mfma_f32_16x16x32_bf16 v[8:11], a[128:131], v[88:91], v[8:11]
    v_mfma_f32_16x16x32_bf16 v[12:15], a[132:135], v[88:91], v[12:15]
    s_waitcnt vmcnt(46)
    v_mfma_f32_16x16x32_bf16 v[8:11], a[136:139], v[92:95], v[8:11]
    v_mfma_f32_16x16x32_bf16 v[12:15], a[140:143], v[92:95], v[12:15]
    s_waitcnt vmcnt(45)
    v_mfma_f32_16x16x32_bf16 v[8:11], a[144:147], v[96:99], v[8:11]
    v_mfma_f32_16x16x32_bf16 v[12:15], a[148:151], v[96:99], v[12:15]
    s_waitcnt vmcnt(44)
    v_mfma_f32_16x16x32_bf16 v[8:11], a[152:155], v[100:103], v[8:11]
    v_mfma_f32_16x16x32_bf16 v[12:15], a[156:159], v[100:103], v[12:15]
    s_waitcnt vmcnt(43)
    v_mfma_f32_16x16x32_bf16 v[8:11], a[160:163], v[104:107], v[8:11]
    v_mfma_f32_16x16x32_bf16 v[12:15], a[164:167], v[104:107], v[12:15]
    s_waitcnt vmcnt(42)
    v_mfma_f32_16x16x32_bf16 v[8:11], a[168:171], v[108:111], v[8:11]
    v_mfma_f32_16x16x32_bf16 v[12:15], a[172:175], v[108:111], v[12:15]
    s_waitcnt vmcnt(41)
    v_mfma_f32_16x16x32_bf16 v[8:11], a[176:179], v[112:115], v[8:11]
    v_mfma_f32_16x16x32_bf16 v[12:15], a[180:183], v[112:115], v[12:15]
    s_waitcnt vmcnt(40)
    v_mfma_f32_16x16x32_bf16 v[8:11], a[184:187], v[116:119], v[8:11]
    v_mfma_f32_16x16x32_bf16 v[12:15], a[188:191], v[116:119], v[12:15]
    s_waitcnt vmcnt(39)
    v_mfma_f32_16x16x32_bf16 v[8:11], a[192:195], v[120:123], v[8:11]
    v_mfma_f32_16x16x32_bf16 v[12:15], a[196:199], v[120:123], v[12:15]
    s_waitcnt vmcnt(38)
    v_mfma_f32_16x16x32_bf16 v[8:11], a[200:203], v[124:127], v[8:11]
    v_mfma_f32_16x16x32_bf16 v[12:15], a[204:207], v[124:127], v[12:15]
    s_waitcnt vmcnt(37)
    v_mfma_f32_16x16x32_bf16 v[8:11], a[208:211], v[128:131], v[8:11]
    v_mfma_f32_16x16x32_bf16 v[12:15], a[212:215], v[128:131], v[12:15]
    s_waitcnt vmcnt(36)
    v_mfma_f32_16x16x32_bf16 v[8:11], a[216:219], v[132:135], v[8:11]
    v_mfma_f32_16x16x32_bf16 v[12:15], a[220:223], v[132:135], v[12:15]
    s_waitcnt vmcnt(35)
    v_mfma_f32_16x16x32_bf16 v[8:11], a[224:227], v[136:139], v[8:11]
    v_mfma_f32_16x16x32_bf16 v[12:15], a[228:231], v[136:139], v[12:15]
    s_waitcnt vmcnt(34)
    v_mfma_f32_16x16x32_bf16 v[8:11], a[232:235], v[140:143], v[8:11]
    v_mfma_f32_16x16x32_bf16 v[12:15], a[236:239], v[140:143], v[12:15]
    s_waitcnt vmcnt(33)
    v_mfma_f32_16x16x32_bf16 v[8:11], a[240:243], v[144:147], v[8:11]
    v_mfma_f32_16x16x32_bf16 v[12:15], a[244:247], v[144:147], v[12:15]
    s_waitcnt vmcnt(32)
    v_mfma_f32_16x16x32_bf16 v[8:11], a[248:251], v[148:151], v[8:11]
    v_mfma_f32_16x16x32_bf16 v[12:15], a[252:255], v[148:151], v[12:15]
    s_waitcnt vmcnt(31)
    v_mfma_f32_16x16x32_bf16 v[16:19], a[0:3], v[152:155], 0
    v_mfma_f32_16x16x32_bf16 v[20:23], a[4:7], v[152:155], 0
    s_waitcnt vmcnt(30)
    v_mfma_f32_16x16x32_bf16 v[16:19], a[8:11], v[156:159], v[16:19]
    v_mfma_f32_16x16x32_bf16 v[20:23], a[12:15], v[156:159], v[20:23]
    s_waitcnt vmcnt(29)
    v_mfma_f32_16x16x32_bf16 v[16:19], a[16:19], v[160:163], v[16:19]
    v_mfma_f32_16x16x32_bf16 v[20:23], a[20:23], v[160:163], v[20:23]
    s_waitcnt vmcnt(28)
    v_mfma_f32_16x16x32_bf16 v[16:19], a[24:27], v[164:167], v[16:19]
    v_mfma_f32_16x16x32_bf16 v[20:23], a[28:31], v[164:167], v[20:23]
    s_waitcnt vmcnt(27)
    v_mfma_f32_16x16x32_bf16 v[16:19], a[32:35], v[168:171], v[16:19]
    v_mfma_f32_16x16x32_bf16 v[20:23], a[36:39], v[168:171], v[20:23]
    s_waitcnt vmcnt(26)
    v_mfma_f32_16x16x32_bf16 v[16:19], a[40:43], v[172:175], v[16:19]
    v_mfma_f32_16x16x32_bf16 v[20:23], a[44:47], v[172:175], v[20:23]
    s_waitcnt vmcnt(25)
    v_mfma_f32_16x16x32_bf16 v[16:19], a[48:51], v[176:179], v[16:19]
    v_mfma_f32_16x16x32_bf16 v[20:23], a[52:55], v[176:179], v[20:23]
    s_waitcnt vmcnt(24)
    v_mfma_f32_16x16x32_bf16 v[16:19], a[56:59], v[180:183], v[16:19]
    v_mfma_f32_16x16x32_bf16 v[20:23], a[60:63], v[180:183], v[20:23]
    s_waitcnt vmcnt(23)
    v_mfma_f32_16x16x32_bf16 v[16:19], a[64:67], v[184:187], v[16:19]
    v_mfma_f32_16x16x32_bf16 v[20:23], a[68:71], v[184:187], v[20:23]
    s_waitcnt vmcnt(22)
    v_mfma_f32_16x16x32_bf16 v[16:19], a[72:75], v[188:191], v[16:19]
    v_mfma_f32_16x16x32_bf16 v[20:23], a[76:79], v[188:191], v[20:23]
    s_waitcnt vmcnt(21)
    v_mfma_f32_16x16x32_bf16 v[16:19], a[80:83], v[192:195], v[16:19]
    v_mfma_f32_16x16x32_bf16 v[20:23], a[84:87], v[192:195], v[20:23]
    s_waitcnt vmcnt(20)
    v_mfma_f32_16x16x32_bf16 v[16:19], a[88:91], v[196:199], v[16:19]
    v_mfma_f32_16x16x32_bf16 v[20:23], a[92:95], v[196:199], v[20:23]
    s_waitcnt vmcnt(19)
    v_mfma_f32_16x16x32_bf16 v[16:19], a[96:99], v[200:203], v[16:19]
    v_mfma_f32_16x16x32_bf16 v[20:23], a[100:103], v[200:203], v[20:23]
    s_waitcnt vmcnt(18)
    v_mfma_f32_16x16x32_bf16 v[16:19], a[104:107], v[204:207], v[16:19]
    v_mfma_f32_16x16x32_bf16 v[20:23], a[108:111], v[204:207], v[20:23]
    s_waitcnt vmcnt(17)
    v_mfma_f32_16x16x32_bf16 v[16:19], a[112:115], v[208:211], v[16:19]
    v_mfma_f32_16x16x32_bf16 v[20:23], a[116:119], v[208:211], v[20:23]
    s_waitcnt vmcnt(16)
    v_mfma_f32_16x16x32_bf16 v[16:19], a[120:123], v[212:215], v[16:19]
    v_mfma_f32_16x16x32_bf16 v[20:23], a[124:127], v[212:215], v[20:23]
    s_waitcnt vmcnt(15)
    v_mfma_f32_16x16x32_bf16 v[16:19], a[128:131], v[216:219], v[16:19]
    v_mfma_f32_16x16x32_bf16 v[20:23], a[132:135], v[216:219], v[20:23]
    s_waitcnt vmcnt(14)
    v_mfma_f32_16x16x32_bf16 v[16:19], a[136:139], v[220:223], v[16:19]
    v_mfma_f32_16x16x32_bf16 v[20:23], a[140:143], v[220:223], v[20:23]
    s_waitcnt vmcnt(13)
    v_mfma_f32_16x16x32_bf16 v[16:19], a[144:147], v[224:227], v[16:19]
    v_mfma_f32_16x16x32_bf16 v[20:23], a[148:151], v[224:227], v[20:23]
    s_waitcnt vmcnt(12)
    v_mfma_f32_16x16x32_bf16 v[16:19], a[152:155], v[228:231], v[16:19]
    v_mfma_f32_16x16x32_bf16 v[20:23], a[156:159], v[228:231], v[20:23]
    s_waitcnt vmcnt(11)
    v_mfma_f32_16x16x32_bf16 v[16:19], a[160:163], v[232:235], v[16:19]
    v_mfma_f32_16x16x32_bf16 v[20:23], a[164:167], v[232:235], v[20:23]
    s_waitcnt vmcnt(10)
    v_mfma_f32_16x16x32_bf16 v[16:19], a[168:171], v[236:239], v[16:19]
    v_mfma_f32_16x16x32_bf16 v[20:23], a[172:175], v[236:239], v[20:23]
    s_waitcnt vmcnt(9)
    v_mfma_f32_16x16x32_bf16 v[16:19], a[176:179], v[240:243], v[16:19]
    v_mfma_f32_16x16x32_bf16 v[20:23], a[180:183], v[240:243], v[20:23]
    s_waitcnt vmcnt(8)
    v_mfma_f32_16x16x32_bf16 v[16:19], a[184:187], v[244:247], v[16:19]
    v_mfma_f32_16x16x32_bf16 v[20:23], a[188:191], v[244:247], v[20:23]
    s_waitcnt vmcnt(7)
    v_mfma_f32_16x16x32_bf16 v[16:19], a[192:195], v[24:27], v[16:19]
    v_mfma_f32_16x16x32_bf16 v[20:23], a[196:199], v[24:27], v[20:23]
    s_waitcnt vmcnt(6)
    v_mfma_f32_16x16x32_bf16 v[16:19], a[200:203], v[28:31], v[16:19]
    v_mfma_f32_16x16x32_bf16 v[20:23], a[204:207], v[28:31], v[20:23]
    s_waitcnt vmcnt(5)
    v_mfma_f32_16x16x32_bf16 v[16:19], a[208:211], v[32:35], v[16:19]
    v_mfma_f32_16x16x32_bf16 v[20:23], a[212:215], v[32:35], v[20:23]
    s_waitcnt vmcnt(4)
    v_mfma_f32_16x16x32_bf16 v[16:19], a[216:219], v[36:39], v[16:19]
    v_mfma_f32_16x16x32_bf16 v[20:23], a[220:223], v[36:39], v[20:23]
    s_waitcnt vmcnt(3)
    v_mfma_f32_16x16x32_bf16 v[16:19], a[224:227], v[40:43], v[16:19]
    v_mfma_f32_16x16x32_bf16 v[20:23], a[228:231], v[40:43], v[20:23]
    s_waitcnt vmcnt(2)
    v_mfma_f32_16x16x32_bf16 v[16:19], a[232:235], v[44:47], v[16:19]
    v_mfma_f32_16x16x32_bf16 v[20:23], a[236:239], v[44:47], v[20:23]
    s_waitcnt vmcnt(1)
    v_mfma_f32_16x16x32_bf16 v[16:19], a[240:243], v[48:51], v[16:19]
    v_mfma_f32_16x16x32_bf16 v[20:23], a[244:247], v[48:51], v[20:23]
    s_waitcnt vmcnt(0)
    v_mfma_f32_16x16x32_bf16 v[16:19], a[248:251], v[52:55], v[16:19]
    v_mfma_f32_16x16x32_bf16 v[20:23], a[252:255], v[52:55], v[20:23]
    ds_write_b128 v2, v[8:11] offset:0
    ds_write_b128 v2, v[12:15] offset:1024
    s_nop 4
    ds_write_b128 v2, v[16:19] offset:8192
    ds_write_b128 v2, v[20:23] offset:9216
    s_cmp_lg_u32 s32, 0
    s_cbranch_scc1 o2_nb
    v_cmp_eq_u32 vcc, 0, v253
    s_nop 0
    s_cmp_eq_u64 vcc, 0
    s_cselect_b32 s44, 65536, 0
    v_or_b32 v250, s44, v250
    v_mov_b32 v251, 163832
    s_mov_b64 exec, 1
    ds_write_b32 v251, v250
    s_mov_b64 exec, -1
o2_nb:
    s_waitcnt lgkmcnt(0)
    s_barrier
    s_cmp_gt_u32 s32, 1
    s_cbranch_scc1 o2_skip
    s_lshl_b32 s18, s32, 13
    v_add_u32 v2, s18, v1
    ds_read_b128 v[24:27], v2 offset:0
    ds_read_b128 v[28:31], v2 offset:1024
    ds_read_b128 v[32:35], v2 offset:2048
    ds_read_b128 v[36:39], v2 offset:3072
    ds_read_b128 v[40:43], v2 offset:4096
    ds_read_b128 v[44:47], v2 offset:5120
    ds_read_b128 v[48:51], v2 offset:6144
    ds_read_b128 v[52:55], v2 offset:7168
    v_lshrrev_b32 v3, 4, v1
    v_bfe_u32 v4, v3, 2, 2
    v_lshlrev_b32 v4, 3, v4
    v_and_b32 v2, 3, v3
    v_add_u32 v4, v4, v2
    v_mul_u32_u24 v4, 2304, v4
    v_lshrrev_b32 v3, 4, v3
    v_lshl_add_u32 v4, v3, 4, v4
    s_add_u32 s20, s16, s32
    s_lshr_b32 s18, s20, 1
    s_lshl_b32 s18, s18, 3
    s_and_b32 s19, s20, 1
    s_add_u32 s18, s18, s19
    s_mul_i32 s18, s18, 9216
    s_lshl_b32 s19, s33, 6
    s_add_u32 s18, s18, s19
    s_waitcnt lgkmcnt(0)
    v_pk_add_f32 v[24:25], v[24:25], v[32:33]
    v_pk_add_f32 v[40:41], v[40:41], v[48:49]
    v_pk_add_f32 v[24:25], v[24:25], v[40:41]
    v_pk_add_f32 v[26:27], v[26:27], v[34:35]
    v_pk_add_f32 v[42:43], v[42:43], v[50:51]
    v_pk_add_f32 v[26:27], v[26:27], v[42:43]
    v_pk_add_f32 v[28:29], v[28:29], v[36:37]
    v_pk_add_f32 v[44:45], v[44:45], v[52:53]
    v_pk_add_f32 v[28:29], v[28:29], v[44:45]
    v_pk_add_f32 v[30:31], v[30:31], v[38:39]
    v_pk_add_f32 v[46:47], v[46:47], v[54:55]
    v_pk_add_f32 v[30:31], v[30:31], v[46:47]
    v_cvt_pk_bf16_f32 v8, v24, v28
    v_cvt_pk_bf16_f32 v9, v25, v29
    v_cvt_pk_bf16_f32 v10, v26, v30
    v_cvt_pk_bf16_f32 v11, v27, v31
    buffer_store_dwordx4 v[8:11], v4, s[8:11], s18 offen
o2_skip:
    s_nop 1
    s_branch L_op_fin
L_op_one:
o1_again:
    s_lshl_b32 s18, s16, 17
    s_lshl_b32 s19, s32, 15
    s_add_u32 s18, s18, s19
    s_add_u32 s18, s18, 50331648
    buffer_load_dwordx4 v[24:27], v1, s[4:7], s18 offen offset:0 sc1
    buffer_load_dwordx4 v[28:31], v1, s[4:7], s18 offen offset:1024 sc1
    buffer_load_dwordx4 v[32:35], v1, s[4:7], s18 offen offset:2048 sc1
    buffer_load_dwordx4 v[36:39], v1, s[4:7], s18 offen offset:3072 sc1
    s_add_u32 s18, s18, 4096
    buffer_load_dwordx4 v[40:43], v1, s[4:7], s18 offen offset:0 sc1
    buffer_load_dwordx4 v[44:47], v1, s[4:7], s18 offen offset:1024 sc1
    buffer_load_dwordx4 v[48:51], v1, s[4:7], s18 offen offset:2048 sc1
    buffer_load_dwordx4 v[52:55], v1, s[4:7], s18 offen offset:3072 sc1
    s_add_u32 s18, s18, 4096
    buffer_load_dwordx4 v[56:59], v1, s[4:7], s18 offen offset:0 sc1
    buffer_load_dwordx4 v[60:63], v1, s[4:7], s18 offen offset:1024 sc1
    buffer_load_dwordx4 v[64:67], v1, s[4:7], s18 offen offset:2048 sc1
    buffer_load_dwordx4 v[68:71], v1, s[4:7], s18 offen offset:3072 sc1
    s_add_u32 s18, s18, 4096
    buffer_load_dwordx4 v[72:75], v1, s[4:7], s18 offen offset:0 sc1
    buffer_load_dwordx4 v[76:79], v1, s[4:7], s18 offen offset:1024 sc1
    buffer_load_dwordx4 v[80:83], v1, s[4:7], s18 offen offset:2048 sc1
    buffer_load_dwordx4 v[84:87], v1, s[4:7], s18 offen offset:3072 sc1
    s_add_u32 s18, s18, 4096
    buffer_load_dwordx4 v[88:91], v1, s[4:7], s18 offen offset:0 sc1
    buffer_load_dwordx4 v[92:95], v1, s[4:7], s18 offen offset:1024 sc1
    buffer_load_dwordx4 v[96:99], v1, s[4:7], s18 offen offset:2048 sc1
    buffer_load_dwordx4 v[100:103], v1, s[4:7], s18 offen offset:3072 sc1
    s_add_u32 s18, s18, 4096
    buffer_load_dwordx4 v[104:107], v1, s[4:7], s18 offen offset:0 sc1
    buffer_load_dwordx4 v[108:111], v1, s[4:7], s18 offen offset:1024 sc1
    buffer_load_dwordx4 v[112:115], v1, s[4:7], s18 offen offset:2048 sc1
    buffer_load_dwordx4 v[116:119], v1, s[4:7], s18 offen offset:3072 sc1
    s_add_u32 s18, s18, 4096
    buffer_load_dwordx4 v[120:123], v1, s[4:7], s18 offen offset:0 sc1
    buffer_load_dwordx4 v[124:127], v1, s[4:7], s18 offen offset:1024 sc1
    buffer_load_dwordx4 v[128:131], v1, s[4:7], s18 offen offset:2048 sc1
    buffer_load_dwordx4 v[132:135], v1, s[4:7], s18 offen offset:3072 sc1
    s_add_u32 s18, s18, 4096
    buffer_load_dwordx4 v[136:139], v1, s[4:7], s18 offen offset:0 sc1
    buffer_load_dwordx4 v[140:143], v1, s[4:7], s18 offen offset:1024 sc1
    buffer_load_dwordx4 v[144:147], v1, s[4:7], s18 offen offset:2048 sc1
    buffer_load_dwordx4 v[148:151], v1, s[4:7], s18 offen offset:3072 sc1
    v_lshlrev_b32 v2, 4, v0
    v_and_b32 v3, 3072, v2
    v_lshl_add_u32 v2, v3, 1, v1
    s_waitcnt vmcnt(31)
    v_mfma_f32_16x16x32_bf16 v[8:11], a[0:3], v[24:27], 0
    v_max_u32 v6, v24, v25
    v_mfma_f32_16x16x32_bf16 v[12:15], a[4:7], v[24:27], 0
    v_max3_u32 v6, v6, v26, v27
    s_waitcnt vmcnt(30)
    v_mfma_f32_16x16x32_bf16 v[8:11], a[8:11], v[28:31], v[8:11]
    v_max3_u32 v6, v6, v28, v29
    v_mfma_f32_16x16x32_bf16 v[12:15], a[12:15], v[28:31], v[12:15]
    v_max3_u32 v6, v6, v30, v31
    s_waitcnt vmcnt(29)
    v_mfma_f32_16x16x32_bf16 v[8:11], a[16:19], v[32:35], v[8:11]
    v_max3_u32 v6, v6, v32, v33
    v_mfma_f32_16x16x32_bf16 v[12:15], a[20:23], v[32:35], v[12:15]
    v_max3_u32 v6, v6, v34, v35
    s_waitcnt vmcnt(28)
    v_mfma_f32_16x16x32_bf16 v[8:11], a[24:27], v[36:39], v[8:11]
    v_max3_u32 v6, v6, v36, v37
    v_mfma_f32_16x16x32_bf16 v[12:15], a[28:31], v[36:39], v[12:15]
    v_max3_u32 v6, v6, v38, v39
    s_waitcnt vmcnt(27)
    v_mfma_f32_16x16x32_bf16 v[8:11], a[32:35], v[40:43], v[8:11]
    v_max3_u32 v6, v6, v40, v41
    v_mfma_f32_16x16x32_bf16 v[12:15], a[36:39], v[40:43], v[12:15]
    v_max3_u32 v6, v6, v42, v43
    s_waitcnt vmcnt(26)
    v_mfma_f32_16x16x32_bf16 v[8:11], a[40:43], v[44:47], v[8:11]
    v_max3_u32 v6, v6, v44, v45
    v_mfma_f32_16x16x32_bf16 v[12:15], a[44:47], v[44:47], v[12:15]
    v_max3_u32 v6, v6, v46, v47
    s_waitcnt vmcnt(25)
    v_mfma_f32_16x16x32_bf16 v[8:11], a[48:51], v[48:51], v[8:11]
    v_max3_u32 v6, v6, v48, v49
    v_mfma_f32_16x16x32_bf16 v[12:15], a[52:55], v[48:51], v[12:15]
    v_max3_u32 v6, v6, v50, v51
    s_waitcnt vmcnt(24)
    v_mfma_f32_16x16x32_bf16 v[8:11], a[56:59], v[52:55], v[8:11]
    v_max3_u32 v6, v6, v52, v53
    v_mfma_f32_16x16x32_bf16 v[12:15], a[60:63], v[52:55], v[12:15]
    v_max3_u32 v6, v6, v54, v55
    s_waitcnt vmcnt(23)
    v_mfma_f32_16x16x32_bf16 v[8:11], a[64:67], v[56:59], v[8:11]
    v_max3_u32 v6, v6, v56, v57
    v_mfma_f32_16x16x32_bf16 v[12:15], a[68:71], v[56:59], v[12:15]
    v_max3_u32 v6, v6, v58, v59
    s_waitcnt vmcnt(22)
    v_mfma_f32_16x16x32_bf16 v[8:11], a[72:75], v[60:63], v[8:11]
    v_max3_u32 v6, v6, v60, v61
    v_mfma_f32_16x16x32_bf16 v[12:15], a[76:79], v[60:63], v[12:15]
    v_max3_u32 v6, v6, v62, v63
    s_waitcnt vmcnt(21)
    v_mfma_f32_16x16x32_bf16 v[8:11], a[80:83], v[64:67], v[8:11]
    v_max3_u32 v6, v6, v64, v65
    v_mfma_f32_16x16x32_bf16 v[12:15], a[84:87], v[64:67], v[12:15]
    v_max3_u32 v6, v6, v66, v67
    s_waitcnt vmcnt(20)
    v_mfma_f32_16x16x32_bf16 v[8:11], a[88:91], v[68:71], v[8:11]
    v_max3_u32 v6, v6, v68, v69
    v_mfma_f32_16x16x32_bf16 v[12:15], a[92:95], v[68:71], v[12:15]
    v_max3_u32 v6, v6, v70, v71
    s_waitcnt vmcnt(19)
    v_mfma_f32_16x16x32_bf16 v[8:11], a[96:99], v[72:75], v[8:11]
    v_max3_u32 v6, v6, v72, v73
    v_mfma_f32_16x16x32_bf16 v[12:15], a[100:103], v[72:75], v[12:15]
    v_max3_u32 v6, v6, v74, v75
    s_waitcnt vmcnt(18)
    v_mfma_f32_16x16x32_bf16 v[8:11], a[104:107], v[76:79], v[8:11]
    v_max3_u32 v6, v6, v76, v77
    v_mfma_f32_16x16x32_bf16 v[12:15], a[108:111], v[76:79], v[12:15]
    v_max3_u32 v6, v6, v78, v79
    s_waitcnt vmcnt(17)
    v_mfma_f32_16x16x32_bf16 v[8:11], a[112:115], v[80:83], v[8:11]
    v_max3_u32 v6, v6, v80, v81
    v_mfma_f32_16x16x32_bf16 v[12:15], a[116:119], v[80:83], v[12:15]
    v_max3_u32 v6, v6, v82, v83
    s_waitcnt vmcnt(16)
    v_mfma_f32_16x16x32_bf16 v[8:11], a[120:123], v[84:87], v[8:11]
    v_max3_u32 v6, v6, v84, v85
    v_mfma_f32_16x16x32_bf16 v[12:15], a[124:127], v[84:87], v[12:15]
    v_max3_u32 v6, v6, v86, v87
    s_waitcnt vmcnt(15)
    v_mfma_f32_16x16x32_bf16 v[8:11], a[128:131], v[88:91], v[8:11]
    v_max3_u32 v6, v6, v88, v89
    v_mfma_f32_16x16x32_bf16 v[12:15], a[132:135], v[88:91], v[12:15]
    v_max3_u32 v6, v6, v90, v91
    s_waitcnt vmcnt(14)
    v_mfma_f32_16x16x32_bf16 v[8:11], a[136:139], v[92:95], v[8:11]
    v_max3_u32 v6, v6, v92, v93
    v_mfma_f32_16x16x32_bf16 v[12:15], a[140:143], v[92:95], v[12:15]
    v_max3_u32 v6, v6, v94, v95
    s_waitcnt vmcnt(13)
    v_mfma_f32_16x16x32_bf16 v[8:11], a[144:147], v[96:99], v[8:11]
    v_max3_u32 v6, v6, v96, v97
    v_mfma_f32_16x16x32_bf16 v[12:15], a[148:151], v[96:99], v[12:15]
    v_max3_u32 v6, v6, v98, v99
    s_waitcnt vmcnt(12)
    v_mfma_f32_16x16x32_bf16 v[8:11], a[152:155], v[100:103], v[8:11]
    v_max3_u32 v6, v6, v100, v101
    v_mfma_f32_16x16x32_bf16 v[12:15], a[156:159], v[100:103], v[12:15]
    v_max3_u32 v6, v6, v102, v103
    s_waitcnt vmcnt(11)
    v_mfma_f32_16x16x32_bf16 v[8:11], a[160:163], v[104:107], v[8:11]
    v_max3_u32 v6, v6, v104, v105
    v_mfma_f32_16x16x32_bf16 v[12:15], a[164:167], v[104:107], v[12:15]
    v_max3_u32 v6, v6, v106, v107
    s_waitcnt vmcnt(10)
    v_mfma_f32_16x16x32_bf16 v[8:11], a[168:171], v[108:111], v[8:11]
    v_max3_u32 v6, v6, v108, v109
    v_mfma_f32_16x16x32_bf16 v[12:15], a[172:175], v[108:111], v[12:15]
    v_max3_u32 v6, v6, v110, v111
    s_waitcnt vmcnt(9)
    v_mfma_f32_16x16x32_bf16 v[8:11], a[176:179], v[112:115], v[8:11]
    v_max3_u32 v6, v6, v112, v113
    v_mfma_f32_16x16x32_bf16 v[12:15], a[180:183], v[112:115], v[12:15]
    v_max3_u32 v6, v6, v114, v115
    s_waitcnt vmcnt(8)
    v_mfma_f32_16x16x32_bf16 v[8:11], a[184:187], v[116:119], v[8:11]
    v_max3_u32 v6, v6, v116, v117
    v_mfma_f32_16x16x32_bf16 v[12:15], a[188:191], v[116:119], v[12:15]
    v_max3_u32 v6, v6, v118, v119
    s_waitcnt vmcnt(7)
    v_mfma_f32_16x16x32_bf16 v[8:11], a[192:195], v[120:123], v[8:11]
    v_max3_u32 v6, v6, v120, v121
    v_mfma_f32_16x16x32_bf16 v[12:15], a[196:199], v[120:123], v[12:15]
    v_max3_u32 v6, v6, v122, v123
    s_waitcnt vmcnt(6)
    v_mfma_f32_16x16x32_bf16 v[8:11], a[200:203], v[124:127], v[8:11]
    v_max3_u32 v6, v6, v124, v125
    v_mfma_f32_16x16x32_bf16 v[12:15], a[204:207], v[124:127], v[12:15]
    v_max3_u32 v6, v6, v126, v127
    s_waitcnt vmcnt(5)
    v_mfma_f32_16x16x32_bf16 v[8:11], a[208:211], v[128:131], v[8:11]
    v_max3_u32 v6, v6, v128, v129
    v_mfma_f32_16x16x32_bf16 v[12:15], a[212:215], v[128:131], v[12:15]
    v_max3_u32 v6, v6, v130, v131
    s_waitcnt vmcnt(4)
    v_mfma_f32_16x16x32_bf16 v[8:11], a[216:219], v[132:135], v[8:11]
    v_max3_u32 v6, v6, v132, v133
    v_mfma_f32_16x16x32_bf16 v[12:15], a[220:223], v[132:135], v[12:15]
    v_max3_u32 v6, v6, v134, v135
    s_waitcnt vmcnt(3)
    v_mfma_f32_16x16x32_bf16 v[8:11], a[224:227], v[136:139], v[8:11]
    v_max3_u32 v6, v6, v136, v137
    v_mfma_f32_16x16x32_bf16 v[12:15], a[228:231], v[136:139], v[12:15]
    v_max3_u32 v6, v6, v138, v139
    s_waitcnt vmcnt(2)
    v_mfma_f32_16x16x32_bf16 v[8:11], a[232:235], v[140:143], v[8:11]
    v_max3_u32 v6, v6, v140, v141
    v_mfma_f32_16x16x32_bf16 v[12:15], a[236:239], v[140:143], v[12:15]
    v_max3_u32 v6, v6, v142, v143
    s_waitcnt vmcnt(1)
    v_mfma_f32_16x16x32_bf16 v[8:11], a[240:243], v[144:147], v[8:11]
    v_max3_u32 v6, v6, v144, v145
    v_mfma_f32_16x16x32_bf16 v[12:15], a[244:247], v[144:147], v[12:15]
    v_max3_u32 v6, v6, v146, v147
    s_waitcnt vmcnt(0)
    v_mfma_f32_16x16x32_bf16 v[8:11], a[248:251], v[148:151], v[8:11]
    v_max3_u32 v6, v6, v148, v149
    v_mfma_f32_16x16x32_bf16 v[12:15], a[252:255], v[148:151], v[12:15]
    v_max3_u32 v6, v6, v150, v151
    v_cmp_eq_u32 vcc, -1, v6
    s_cbranch_vccz o1_ok
    s_cmp_eq_u32 s46, 0
    s_cbranch_scc1 o1_ok
    s_mov_b32 s46, 0
    s_nop 1
    v_mbcnt_lo_u32_b32 v2, -1, 0
    v_mbcnt_hi_u32_b32 v2, -1, v2
    v_min_u32 v2, 1, v2
    v_lshlrev_b32 v2, 2, v2
    s_mov_b32 s88, 4194304
fw24:
    buffer_load_dword v3, v2, s[4:7], s89 offen offset:0 sc1
    s_sub_u32 s88, s88, 1
    s_cbranch_scc1 fw24x
    s_waitcnt vmcnt(0)
    v_cmp_ne_u32 vcc, s95, v3
    s_cbranch_vccz fw24x
    s_sleep 1
    s_branch fw24
fw24x:
    s_branch o1_again
o1_ok:
    s_nop 7
    ds_write_b128 v2, v[8:11] offset:0
    ds_write_b128 v2, v[12:15] offset:1024
    s_cmp_lg_u32 s32, 0
    s_cbranch_scc1 o1_nb
    v_cmp_eq_u32 vcc, 0, v253
    s_nop 0
    s_cmp_eq_u64 vcc, 0
    s_cselect_b32 s44, 65536, 0
    v_or_b32 v250, s44, v250
    v_mov_b32 v251, 163832
    s_mov_b64 exec, 1
    ds_write_b32 v251, v250
    s_mov_b64 exec, -1
o1_nb:
    s_waitcnt lgkmcnt(0)
    s_barrier
    s_cmp_gt_u32 s32, 0
    s_cbranch_scc1 o1_skip
    s_lshl_b32 s18, s32, 13
    v_add_u32 v2, s18, v1
    ds_read_b128 v[24:27], v2 offset:0
    ds_read_b128 v[28:31], v2 offset:1024
    ds_read_b128 v[32:35], v2 offset:2048
    ds_read_b128 v[36:39], v2 offset:3072
    ds_read_b128 v[40:43], v2 offset:4096
    ds_read_b128 v[44:47], v2 offset:5120
    ds_read_b128 v[48:51], v2 offset:6144
    ds_read_b128 v[52:55], v2 offset:7168
    v_lshrrev_b32 v3, 4, v1
    v_bfe_u32 v4, v3, 2, 2
    v_lshlrev_b32 v4, 3, v4
    v_and_b32 v2, 3, v3
    v_add_u32 v4, v4, v2
    v_mul_u32_u24 v4, 2304, v4
    v_lshrrev_b32 v3, 4, v3
    v_lshl_add_u32 v4, v3, 4, v4
    s_add_u32 s20, s16, s32
    s_lshr_b32 s18, s20, 1
    s_lshl_b32 s18, s18, 3
    s_and_b32 s19, s20, 1
    s_add_u32 s18, s18, s19
    s_mul_i32 s18, s18, 9216
    s_lshl_b32 s19, s33, 6
    s_add_u32 s18, s18, s19
    s_waitcnt lgkmcnt(0)
    v_pk_add_f32 v[24:25], v[24:25], v[32:33]
    v_pk_add_f32 v[40:41], v[40:41], v[48:49]
    v_pk_add_f32 v[24:25], v[24:25], v[40:41]
    v_pk_add_f32 v[26:27], v[26:27], v[34:35]
    v_pk_add_f32 v[42:43], v[42:43], v[50:51]
    v_pk_add_f32 v[26:27], v[26:27], v[42:43]
    v_pk_add_f32 v[28:29], v[28:29], v[36:37]
    v_pk_add_f32 v[44:45], v[44:45], v[52:53]
    v_pk_add_f32 v[28:29], v[28:29], v[44:45]
    v_pk_add_f32 v[30:31], v[30:31], v[38:39]
    v_pk_add_f32 v[46:47], v[46:47], v[54:55]
    v_pk_add_f32 v[30:31], v[30:31], v[46:47]
    v_cvt_pk_bf16_f32 v8, v24, v28
    v_cvt_pk_bf16_f32 v9, v25, v29
    v_cvt_pk_bf16_f32 v10, v26, v30
    v_cvt_pk_bf16_f32 v11, v27, v31
    buffer_store_dwordx4 v[8:11], v4, s[8:11], s18 offen
o1_skip:
    s_nop 1
L_op_fin:
    v_mov_b32 v251, 163832
    ds_read_b32 v252, v251
    s_waitcnt lgkmcnt(0)
    v_readfirstlane_b32 s40, v252
    s_nop 1
    s_cmp_ge_u32 s40, 65608
    s_cbranch_scc1 L_done
    s_barrier
    s_and_b32 s16, s40, 0xffff
    s_cmp_lt_u32 s16, 72
    s_cbranch_scc1 L_op_seg
L_op_nextcb:
    s_mov_b32 s40, -1
    s_cmp_lg_u32 s32, 0
    s_cbranch_scc1 L_op_dec
    v_and_b32 v1, 63, v0
    v_min_u32 v1, 17, v1
    v_lshlrev_b32 v2, 2, v1
    buffer_load_dword v3, v2, s[84:87], 0 offen offset:136 sc1
    s_waitcnt vmcnt(0)
    v_cmp_gt_u32 vcc, 52, v3
    s_nop 0
    s_and_b32 s40, vcc_lo, 262143
    s_lshl_b32 s41, s40, 18
    s_lshr_b32 s43, s40, 14
    s_or_b32 s42, s40, s41
    s_and_b32 s36, s45, 15
    s_bfm_b32 s37, s36, 0
    s_and_b32 s37, s37, 42315
    s_bcnt1_i32_b32 s37, s37
    s_lshr_b32 s36, s45, 4
    s_mul_i32 s36, s36, 8
    s_add_u32 s36, s36, s37
    s_add_u32 s36, s36, 38
    s_mul_hi_u32 s41, s36, 0x0e38e38f
    s_mul_i32 s41, s41, 18
    s_sub_u32 s41, s36, s41
    s_lshr_b64 s[42:43], s[42:43], s41
    s_ff1_i32_b64 s40, s[42:43]
    s_cmp_lt_i32 s40, 0
    s_cbranch_scc1 L_op_dec
    s_add_u32 s40, s40, s41
    s_sub_u32 s41, s40, 18
    s_cselect_b32 s40, s40, s41
L_op_dec:
    v_mov_b32 v250, s40
    v_mov_b32 v251, 163832
    s_cmp_lg_u32 s32, 0
    s_cbranch_scc1 L_op_nw
    ds_write_b32 v251, v250
    s_waitcnt lgkmcnt(0)
L_op_nw:
    s_barrier
    ds_read_b32 v252, v251
    s_waitcnt lgkmcnt(0)
    v_readfirstlane_b32 s33, v252
    s_barrier
    s_nop 1
    s_cmp_lt_u32 s33, 18
    s_cbranch_scc1 L_op_start
L_done:
L_exit:
    s_endpgm
.section .rodata,"a"
.p2align 6
.amdhsa_kernel concat_heads__memory_aug_recurrent_mem_tr__ssm_conv_s4d__prompt_kernel
  .amdhsa_next_free_vgpr 512
  .amdhsa_next_free_sgpr 102
  .amdhsa_accum_offset 256
  .amdhsa_group_segment_fixed_size 0
  .amdhsa_kernarg_size 136
  .amdhsa_user_sgpr_count 2
  .amdhsa_user_sgpr_kernarg_segment_ptr 1
  .amdhsa_system_sgpr_workgroup_id_x 1
.end_amdhsa_kernel
.text
```

```asm
; @launch grid=(256,1,1) block=(256,1,1) lds=163840
.amdgcn_target "amdgcn-amd-amdhsa--gfx950"
.text
.globl concat_heads__memory_aug_recurrent_mem_tr__ssm_conv_s4d__prompt_kernel
.p2align 8
.type concat_heads__memory_aug_recurrent_mem_tr__ssm_conv_s4d__prompt_kernel,@function
concat_heads__memory_aug_recurrent_mem_tr__ssm_conv_s4d__prompt_kernel:
    s_cmp_ge_u32 s2, 256
    s_cbranch_scc1 L_exit
    s_load_dwordx4 s[80:83], s[0:1], 120
    s_load_dwordx16 s[48:63], s[0:1], 0
    s_memrealtime s[90:91]
    v_lshrrev_b32 v1, 6, v0
    s_nop 0
    v_readfirstlane_b32 s32, v1
    s_waitcnt lgkmcnt(0)
    s_mov_b32 s4, s82
    s_mov_b32 s5, s83
    s_mov_b32 s6, 268435456
    s_mov_b32 s7, 0x20000
    s_mov_b32 s84, s80
    s_mov_b32 s85, s81
    s_mov_b32 s86, 256
    s_mov_b32 s87, 0x20000
    s_cmp_lg_u32 s32, 0
    s_cbranch_scc1 L_nod0
L_nod0:
    s_cmp_lg_u32 s32, 3
    s_cbranch_scc1 L_nowarm
    s_getpc_b64 s[44:45]
L_pcw:
    v_and_b32 v1, 63, v0
    v_lshlrev_b32 v1, 7, v1
    s_mul_hi_u32 s46, s2, 477218589
    s_mul_i32 s47, s46, 9
    s_sub_u32 s47, s2, s47
    s_add_u32 s46, s46, s47
    s_mul_hi_u32 s40, s46, 477218589
    s_mul_i32 s40, s40, 9
    s_sub_u32 s46, s46, s40
    s_lshl_b32 s47, s47, 13
    v_add_u32 v2, s47, v1
    v_min_u32 v2, L_exit-L_pcw, v2
    global_load_dword v240, v2, s[44:45]
    s_lshl_b32 s46, s46, 13
    v_add_u32 v2, s46, v1
    v_min_u32 v2, L_exit-L_pcw, v2
    global_load_dword v241, v2, s[44:45]
L_nowarm:
    s_getreg_b32 s3, hwreg(HW_REG_XCC_ID)
    s_and_b32 s3, s3, 15
    s_cmp_lg_u32 s3, 3
    s_cbranch_scc1 L_helper
    s_mov_b32 s37, 128
    v_mov_b32 v250, 1
    v_mov_b32 v251, 163832
    v_cmp_eq_u32 vcc, 0, v0
    s_nop 0
    s_and_saveexec_b64 s[38:39], vcc
    s_cbranch_execz tk1
    buffer_atomic_add v250, off, s[84:87], s37 sc0
    s_waitcnt vmcnt(0)
    ds_write_b32 v251, v250
    s_waitcnt lgkmcnt(0)
tk1:
    s_mov_b64 exec, -1
    s_barrier
    ds_read_b32 v252, v251
    s_waitcnt lgkmcnt(0)
    v_readfirstlane_b32 s12, v252
    s_barrier
    s_nop 3
    s_cmp_ge_u32 s12, 32
    s_cbranch_scc1 L_helper
L_chain:
    s_mov_b64 s[48:49], s[50:51]
    s_mov_b64 s[50:51], s[52:53]
    s_mov_b64 s[52:53], s[54:55]
    s_mov_b64 s[54:55], s[56:57]
    s_mov_b64 s[56:57], s[58:59]
    v_lshrrev_b32 v77, 6, v0
    s_nop 0
    v_readfirstlane_b32 s13, v77
    v_lshlrev_b32 v65, 4, v0
    v_and_b32 v48, 63, v0
    s_mov_b32 s10, 4718592
    s_mov_b32 s11, 0x20000
    v_lshrrev_b32 v49, 3, v48
    v_mul_u32_u24 v18, 1152, v49
    v_and_b32 v49, 7, v48
    v_lshl_add_u32 v18, v49, 4, v18
    s_mul_i32 s40, s12, 147456
    s_lshl_b32 s41, s13, 8
    s_add_u32 s40, s40, s41
    s_mov_b32 s42, s40
    s_xor_b32 s41, s13, 0
    s_mul_i32 s41, s41, 36864
    s_add_u32 s60, s41, s40
    s_xor_b32 s41, s13, 1
    s_mul_i32 s41, s41, 36864
    s_add_u32 s61, s41, s40
    s_xor_b32 s41, s13, 2
    s_mul_i32 s41, s41, 36864
    s_add_u32 s62, s41, s40
    s_xor_b32 s41, s13, 3
    s_mul_i32 s41, s41, 36864
    s_add_u32 s63, s41, s40
    s_lshl_b32 s43, s13, 12
    s_mov_b64 s[8:9], s[56:57]
    s_add_u32 m0, s43, 147456
    s_add_u32 s41, s60, 0
    buffer_load_dwordx4 v18, s[8:11], s41 offen offset:0 nt lds
    s_add_u32 s41, s60, 8192
    buffer_load_dwordx4 v18, s[8:11], s41 offen offset:1024 nt lds
    s_add_u32 s41, s60, 16384
    buffer_load_dwordx4 v18, s[8:11], s41 offen offset:2048 nt lds
    s_add_u32 s41, s60, 24576
    buffer_load_dwordx4 v18, s[8:11], s41 offen offset:3072 nt lds
    s_add_u32 m0, s43, 0
    s_add_u32 s41, s61, 0
    buffer_load_dwordx4 v18, s[8:11], s41 offen offset:0 nt lds
    s_add_u32 s41, s61, 8192
    buffer_load_dwordx4 v18, s[8:11], s41 offen offset:1024 nt lds
    s_add_u32 s41, s61, 16384
    buffer_load_dwordx4 v18, s[8:11], s41 offen offset:2048 nt lds
    s_add_u32 s41, s61, 24576
    buffer_load_dwordx4 v18, s[8:11], s41 offen offset:3072 nt lds
    s_add_u32 m0, s43, 36864
    s_add_u32 s41, s62, 0
    buffer_load_dwordx4 v18, s[8:11], s41 offen offset:0 nt lds
    s_add_u32 s41, s62, 8192
    buffer_load_dwordx4 v18, s[8:11], s41 offen offset:1024 nt lds
    s_add_u32 s41, s62, 16384
    buffer_load_dwordx4 v18, s[8:11], s41 offen offset:2048 nt lds
    s_add_u32 s41, s62, 24576
    buffer_load_dwordx4 v18, s[8:11], s41 offen offset:3072 nt lds
    s_add_u32 m0, s43, 73728
    s_add_u32 s41, s63, 0
    buffer_load_dwordx4 v18, s[8:11], s41 offen offset:0 nt lds
    s_add_u32 s41, s63, 8192
    buffer_load_dwordx4 v18, s[8:11], s41 offen offset:1024 nt lds
    s_add_u32 s41, s63, 16384
    buffer_load_dwordx4 v18, s[8:11], s41 offen offset:2048 nt lds
    s_add_u32 s41, s63, 24576
    buffer_load_dwordx4 v18, s[8:11], s41 offen offset:3072 nt lds
    v_lshrrev_b32 v49, 1, v48
    v_mul_u32_u24 v19, 1152, v49
    v_and_b32 v49, 1, v48
    v_lshl_add_u32 v19, v49, 4, v19
    s_mul_i32 s41, s13, 224
    s_sub_u32 s41, 1024, s41
    v_add_u32 v19, s41, v19
    v_lshrrev_b32 v49, 4, v48
    v_lshlrev_b32 v50, 2, v49
    v_and_b32 v51, 15, v48
    v_xor_b32 v51, v51, v50
    v_lshlrev_b32 v51, 4, v51
    v_lshl_add_u32 v16, v49, 15, v51
    v_lshrrev_b32 v50, 1, v49
    v_lshl_add_u32 v17, v50, 16, v51
    v_and_b32 v50, 1, v49
    v_lshl_add_u32 v17, v50, 13, v17
    s_lshl_b32 s40, s12, 8
    s_mul_i32 s58, s13, 1048576
    s_add_u32 s58, s58, s40
    s_lshr_b32 s41, s13, 1
    s_mul_i32 s59, s41, 262144
    s_and_b32 s41, s13, 1
    s_lshl_b32 s41, s41, 14
    s_add_u32 s59, s59, s41
    s_add_u32 s59, s59, s40
    s_add_u32 s59, s59, 4194304
    s_lshr_b32 s71, s52, 8
    s_add_u32 s71, s71, s12
    s_and_b32 s71, s71, 3
    v_bfe_u32 v50, v48, 2, 2
    v_xor_b32 v51, s13, v50
    v_lshlrev_b32 v20, 6, v51
    v_and_b32 v51, 3, v48
    v_lshl_add_u32 v20, v51, 4, v20
    v_lshrrev_b32 v23, 2, v48
    v_lshl_add_u32 v20, v23, 8, v20
    s_xor_b32 s41, s43, 0
    v_add_u32 v24, s41, v20
    s_xor_b32 s41, s43, 4096
    v_add_u32 v25, s41, v20
    s_xor_b32 s41, s43, 8192
    v_add_u32 v26, s41, v20
    s_xor_b32 s41, s43, 12288
    v_add_u32 v27, s41, v20
    v_and_b32 v23, 1, v50
    v_lshl_add_u32 v23, v49, 2, v23
    v_lshrrev_b32 v50, 1, v50
    v_lshlrev_b32 v21, 7, v23
    v_lshl_add_u32 v21, v50, 6, v21
    v_lshrrev_b32 v16, 1, v51
    v_lshl_add_u32 v21, v16, 5, v21
    v_and_b32 v16, 1, v51
    v_lshl_add_u32 v21, v16, 3, v21
    v_add_u32 v21, s43, v21
    v_lshlrev_b32 v22, 9, v50
    v_xor_b32 v22, v22, v21
    v_lshlrev_b32 v23, 5, v23
    v_lshl_add_u32 v23, v50, 10, v23
    v_lshl_add_u32 v23, v51, 3, v23
    v_add_u32 v23, s43, v23
    v_bfe_u32 v60, v65, 4, 6
    v_and_b32 v61, 15, v60
    v_lshrrev_b32 v62, 4, v60
    v_mov_b32 v64, 0x4444
    v_mov_b32 v77, 0xeeee
    v_cmp_lt_u32 vcc, 7, v61
    s_nop 1
    v_cndmask_b32 v64, v64, v77, vcc
    v_xor_b32 v66, 1024, v65
    v_xor_b32 v67, 2048, v65
    v_xor_b32 v68, 3072, v65
    v_and_b32 v69, 511, v65
    s_mul_i32 s96, s13, 36864
    s_add_u32 s96, s96, 16384
    v_lshlrev_b32 v70, 4, v60
    v_add_u32 v70, s96, v70
    v_lshrrev_b32 v79, 1, v69
    s_lshl_b32 s96, s13, 8
    s_add_u32 s96, s96, 14336
    s_lshl_b32 s33, s13, 10
    s_add_u32 s97, s33, 8192
    v_mov_b32 v77, s97
    v_mov_b32 v78, s96
    v_cmp_lt_u32 vcc, 31, v60
    s_nop 1
    v_cndmask_b32 v71, v77, v78, vcc
    v_add_u32 v71, v71, v79
    v_and_b32 v77, 7, v61
    v_lshrrev_b32 v78, 3, v61
    v_lshlrev_b32 v74, 4, v77
    v_lshl_add_u32 v73, v62, 7, v74
    v_lshl_add_u32 v73, v78, 3, v73
    s_lshl_b32 s96, s13, 9
    v_add_u32 v73, s96, v73
    v_lshrrev_b32 v74, 1, v74
    v_lshl_add_u32 v74, v78, 14, v74
    v_lshl_add_u32 v74, v62, 15, v74
    s_lshl_b32 s96, s13, 17
    v_add_u32 v74, s96, v74
    v_bfe_u32 v77, v61, 2, 1
    v_and_b32 v78, 3, v61
    s_cmp_lt_u32 s13, 2
    s_cselect_b64 vcc, -1, 0
    v_cndmask_b32 v77, 0, v77, vcc
    v_lshlrev_b32 v75, 7, v77
    v_lshl_add_u32 v75, v62, 4, v75
    v_lshl_add_u32 v75, v78, 2, v75
    v_lshlrev_b32 v58, 3, v77
    v_lshl_add_u32 v58, v78, 1, v58
    s_bfe_u32 s97, s12, 0x10001
    s_lshl_b32 s68, s97, 6
    s_lshl_b32 s97, s97, 2
    v_add_u32 v59, s97, v62
    s_bfe_u32 s96, s12, 0x10002
    s_and_b32 s40, s12, 1
    s_lshl_b32 s96, s96, 1
    s_add_u32 s96, s96, s40
    s_lshr_b32 s97, s12, 3
    s_lshl_b32 s98, s13, 2
    s_add_u32 s98, s98, s97
    s_lshl_b32 s98, s98, 2
    s_add_u32 s98, s98, s96
    s_lshl_b32 s98, s98, 8
    s_lshl_b32 s99, s13, 2
    s_add_u32 s99, s99, s96
    s_lshl_b32 s99, s99, 4
    s_lshl_b32 s41, s97, 1
    s_add_u32 s41, s41, s40
    s_lshl_b32 s41, s41, 7
    s_add_u32 s41, s41, 8192
    s_lshl_b32 s40, s40, 3
    s_add_u32 s40, s40, 512
    s_cmp_lt_u32 s13, 2
    s_cselect_b32 s96, 7, 4
    s_cselect_b32 s98, s98, s41
    s_cselect_b32 s99, s99, s40
    s_cselect_b32 s32, 1, 0
    s_add_u32 s68, s68, s98
    s_lshl_b32 s97, s97, s96
    s_add_u32 s99, s99, s97
    v_add_u32 v58, s99, v58
    s_and_b32 s97, s12, 4
    s_or_b32 s97, s97, s13
    s_cmp_eq_u32 s97, 2
    s_cselect_b32 s32, 2, s32
    s_mov_b32 s8, s48
    s_mov_b32 s9, s49
    s_mov_b32 s10, 9216
    v_mul_u32_u24 v77, 1152, v59
    v_lshl_add_u32 v77, v58, 1, v77
    buffer_load_dword v72, v77, s[8:11], 0 offen
    s_mov_b32 s10, 4718592
    s_waitcnt vmcnt(12) lgkmcnt(0)
    s_barrier
    s_cmp_eq_u32 s71, 1
    s_cbranch_scc1 cf_th0
    s_waitcnt vmcnt(6)
cf_th0:
    s_mov_b64 s[8:9], s[56:57]
    s_add_u32 m0, s43, 110592
    s_add_u32 s41, s42, 0
    buffer_load_dwordx4 v19, s[8:11], s41 offen offset:0 nt lds
    s_add_u32 s41, s42, 35840
    buffer_load_dwordx4 v19, s[8:11], s41 offen offset:1024 nt lds
    s_add_u32 s41, s42, 71680
    buffer_load_dwordx4 v19, s[8:11], s41 offen offset:2048 nt lds
    s_add_u32 s41, s42, 107520
    buffer_load_dwordx4 v19, s[8:11], s41 offen offset:3072 nt lds
    v_add_u32 v77, 147456, v22
    ds_read_b64_tr_b16 v[80:81], v77 offset:0
    ds_read_b64_tr_b16 v[82:83], v77 offset:256
    ds_read_b64_tr_b16 v[84:85], v77 offset:2048
    ds_read_b64_tr_b16 v[86:87], v77 offset:2304
    ds_read_b64_tr_b16 v[112:113], v77 offset:16
    ds_read_b64_tr_b16 v[114:115], v77 offset:272
    ds_read_b64_tr_b16 v[116:117], v77 offset:2064
    ds_read_b64_tr_b16 v[118:119], v77 offset:2320
    s_waitcnt vmcnt(12) lgkmcnt(0)
    s_barrier
    s_cmp_eq_u32 s71, 1
    s_cbranch_scc1 cf_th1
    s_waitcnt vmcnt(6)
cf_th1:
    s_mov_b64 s[8:9], s[52:53]
    s_add_u32 m0, s43, 147456
    s_add_u32 s41, s58, 0
    buffer_load_dwordx4 v17, s[8:11], s41 offen offset:0 nt lds
    s_add_u32 s41, s58, 31744
    buffer_load_dwordx4 v17, s[8:11], s41 offen offset:1024 nt lds
    s_add_u32 s41, s58, 129024
    buffer_load_dwordx4 v17, s[8:11], s41 offen offset:2048 nt lds
    s_add_u32 s41, s58, 160768
    buffer_load_dwordx4 v17, s[8:11], s41 offen offset:3072 nt lds
    v_add_u32 v77, 0, v21
    ds_read_b64_tr_b16 v[88:89], v77 offset:0
    ds_read_b64_tr_b16 v[90:91], v77 offset:256
    ds_read_b64_tr_b16 v[92:93], v77 offset:2048
    ds_read_b64_tr_b16 v[94:95], v77 offset:2304
    ds_read_b64_tr_b16 v[120:121], v77 offset:16
    ds_read_b64_tr_b16 v[122:123], v77 offset:272
    ds_read_b64_tr_b16 v[124:125], v77 offset:2064
    ds_read_b64_tr_b16 v[126:127], v77 offset:2320
    s_waitcnt vmcnt(12) lgkmcnt(0)
    s_barrier
    s_cmp_eq_u32 s71, 1
    s_cbranch_scc1 cf_th2
    s_waitcnt vmcnt(6)
cf_th2:
    s_add_u32 m0, s43, 0
    s_add_u32 s41, s58, 16384
    buffer_load_dwordx4 v17, s[8:11], s41 offen offset:0 nt lds
    s_add_u32 s41, s58, 48128
    buffer_load_dwordx4 v17, s[8:11], s41 offen offset:1024 nt lds
    s_add_u32 s41, s58, 145408
    buffer_load_dwordx4 v17, s[8:11], s41 offen offset:2048 nt lds
    s_add_u32 s41, s58, 177152
    buffer_load_dwordx4 v17, s[8:11], s41 offen offset:3072 nt lds
    v_add_u32 v77, 36864, v21
    ds_read_b64_tr_b16 v[96:97], v77 offset:0
    ds_read_b64_tr_b16 v[98:99], v77 offset:256
    ds_read_b64_tr_b16 v[100:101], v77 offset:2048
    ds_read_b64_tr_b16 v[102:103], v77 offset:2304
    ds_read_b64_tr_b16 v[128:129], v77 offset:16
    ds_read_b64_tr_b16 v[130:131], v77 offset:272
    ds_read_b64_tr_b16 v[132:133], v77 offset:2064
    ds_read_b64_tr_b16 v[134:135], v77 offset:2320
    s_waitcnt vmcnt(12) lgkmcnt(0)
    s_barrier
    s_cmp_eq_u32 s71, 1
    s_cbranch_scc1 cf_th3
    s_waitcnt vmcnt(6)
cf_th3:
    s_mov_b64 s[8:9], s[54:55]
    s_add_u32 m0, s43, 36864
    s_add_u32 s41, s58, 0
    buffer_load_dwordx4 v17, s[8:11], s41 offen offset:0 nt lds
    s_add_u32 s41, s58, 31744
    buffer_load_dwordx4 v17, s[8:11], s41 offen offset:1024 nt lds
    s_add_u32 s41, s58, 129024
    buffer_load_dwordx4 v17, s[8:11], s41 offen offset:2048 nt lds
    s_add_u32 s41, s58, 160768
    buffer_load_dwordx4 v17, s[8:11], s41 offen offset:3072 nt lds
    v_add_u32 v77, 73728, v21
    ds_read_b64_tr_b16 v[104:105], v77 offset:0
    ds_read_b64_tr_b16 v[106:107], v77 offset:256
    ds_read_b64_tr_b16 v[108:109], v77 offset:2048
    ds_read_b64_tr_b16 v[110:111], v77 offset:2304
    ds_read_b64_tr_b16 v[136:137], v77 offset:16
    ds_read_b64_tr_b16 v[138:139], v77 offset:272
    ds_read_b64_tr_b16 v[140:141], v77 offset:2064
    ds_read_b64_tr_b16 v[142:143], v77 offset:2320
    s_waitcnt vmcnt(12) lgkmcnt(0)
    s_barrier
    s_cmp_eq_u32 s71, 1
    s_cbranch_scc1 cf_th4
    s_waitcnt vmcnt(6)
cf_th4:
    s_add_u32 m0, s43, 73728
    s_add_u32 s41, s58, 16384
    buffer_load_dwordx4 v17, s[8:11], s41 offen offset:0 nt lds
    s_add_u32 s41, s58, 48128
    buffer_load_dwordx4 v17, s[8:11], s41 offen offset:1024 nt lds
    s_add_u32 s41, s58, 145408
    buffer_load_dwordx4 v17, s[8:11], s41 offen offset:2048 nt lds
    s_add_u32 s41, s58, 177152
    buffer_load_dwordx4 v17, s[8:11], s41 offen offset:3072 nt lds
    v_add_u32 v77, 110592, v23
    ds_read_b64_tr_b16 v[0:1], v77 offset:0
    ds_read_b64_tr_b16 v[2:3], v77 offset:64
    ds_read_b64_tr_b16 v[4:5], v77 offset:512
    ds_read_b64_tr_b16 v[6:7], v77 offset:576
    ds_read_b64_tr_b16 v[8:9], v77 offset:2048
    ds_read_b64_tr_b16 v[10:11], v77 offset:2112
    ds_read_b64_tr_b16 v[12:13], v77 offset:2560
    ds_read_b64_tr_b16 v[14:15], v77 offset:2624
    s_waitcnt vmcnt(12) lgkmcnt(0)
    s_barrier
    s_cmp_eq_u32 s71, 1
    s_cbranch_scc1 cf_th5
    s_waitcnt vmcnt(6)
cf_th5:
    s_mov_b64 s[8:9], s[50:51]
    s_add_u32 m0, s43, 110592
    s_add_u32 s41, s58, 0
    buffer_load_dwordx4 v17, s[8:11], s41 offen offset:0 nt lds
    s_add_u32 s41, s58, 31744
    buffer_load_dwordx4 v17, s[8:11], s41 offen offset:1024 nt lds
    s_add_u32 s41, s58, 129024
    buffer_load_dwordx4 v17, s[8:11], s41 offen offset:2048 nt lds
    s_add_u32 s41, s58, 160768
    buffer_load_dwordx4 v17, s[8:11], s41 offen offset:3072 nt lds
    s_cmp_eq_u32 s32, 0
    s_cbranch_scc1 cf_init_done
    v_mov_b32 v52, 1
    v_mov_b32 v53, 1
    v_mov_b32 v54, 1
    v_mov_b32 v55, 1
    v_mov_b32 v56, 0
    s_lshl_b32 s96, s12, 14
    s_add_u32 s96, s96, 68157440
    s_add_u32 s97, s96, 0
    buffer_store_dwordx4 v[52:55], v65, s[4:7], s97 offen
    buffer_load_dwordx4 v[60:63], v65, s[4:7], s97 offen sc1
    s_add_u32 s97, s96, 4096
    buffer_store_dwordx4 v[52:55], v65, s[4:7], s97 offen
    buffer_load_dwordx4 v[60:63], v65, s[4:7], s97 offen sc1
    s_add_u32 s97, s96, 8192
    buffer_store_dwordx4 v[52:55], v65, s[4:7], s97 offen
    buffer_load_dwordx4 v[60:63], v65, s[4:7], s97 offen sc1
    s_add_u32 s97, s96, 12288
    buffer_store_dwordx4 v[52:55], v65, s[4:7], s97 offen
    buffer_load_dwordx4 v[60:63], v65, s[4:7], s97 offen sc1
    s_add_u32 s96, s68, 67108864
    s_add_u32 s97, s96, 16384
    buffer_store_dword v56, v75, s[4:7], s96 offen offset:0
    buffer_store_dword v72, v75, s[4:7], s97 offen offset:0
    buffer_load_dword v60, v75, s[4:7], s96 offen offset:0 sc1
    buffer_load_dword v60, v75, s[4:7], s97 offen offset:0 sc1
    s_cmp_lg_u32 s32, 2
    s_cbranch_scc1 cf_init_done
    buffer_store_dword v56, v75, s[4:7], s96 offen offset:1024
    buffer_store_dword v72, v75, s[4:7], s97 offen offset:1024
    buffer_load_dword v60, v75, s[4:7], s96 offen offset:1024 sc1
    buffer_load_dword v60, v75, s[4:7], s97 offen offset:1024 sc1
    buffer_store_dword v56, v75, s[4:7], s96 offen offset:2048
    buffer_store_dword v72, v75, s[4:7], s97 offen offset:2048
    buffer_load_dword v60, v75, s[4:7], s96 offen offset:2048 sc1
    buffer_load_dword v60, v75, s[4:7], s97 offen offset:2048 sc1
    buffer_store_dword v56, v75, s[4:7], s96 offen offset:3072
    buffer_store_dword v72, v75, s[4:7], s97 offen offset:3072
    buffer_load_dword v60, v75, s[4:7], s96 offen offset:3072 sc1
    buffer_load_dword v60, v75, s[4:7], s97 offen offset:3072 sc1
cf_init_done:
    ds_write_b64 v70, v[0:1] offset:16384
    ds_write_b64 v70, v[2:3] offset:16392
    ds_write_b64 v70, v[4:5] offset:17408
    ds_write_b64 v70, v[6:7] offset:17416
    ds_write_b64 v70, v[8:9] offset:18432
    ds_write_b64 v70, v[10:11] offset:18440
    ds_write_b64 v70, v[12:13] offset:19456
    ds_write_b64 v70, v[14:15] offset:19464
    v_add_u32 v28, 147456, v24
    v_add_u32 v29, 147456, v25
    v_add_u32 v30, 147456, v26
    v_add_u32 v31, 147456, v27
    ds_read_b64_tr_b16 a[96:97], v28 offset:0
    ds_read_b64_tr_b16 a[104:105], v28 offset:8
    ds_read_b64_tr_b16 a[112:113], v29 offset:0
    ds_read_b64_tr_b16 a[120:121], v29 offset:8
    ds_read_b64_tr_b16 a[128:129], v30 offset:0
    ds_read_b64_tr_b16 a[136:137], v30 offset:8
    ds_read_b64_tr_b16 a[144:145], v31 offset:0
    ds_read_b64_tr_b16 v[32:33], v31 offset:8
    s_waitcnt vmcnt(12) lgkmcnt(0)
    s_barrier
    s_cmp_eq_u32 s71, 1
    s_cbranch_scc1 cf_th6
    s_waitcnt vmcnt(6)
cf_th6:
    s_add_u32 m0, s43, 147456
    s_add_u32 s41, s58, 16384
    buffer_load_dwordx4 v17, s[8:11], s41 offen offset:0 nt lds
    s_add_u32 s41, s58, 48128
    buffer_load_dwordx4 v17, s[8:11], s41 offen offset:1024 nt lds
    s_add_u32 s41, s58, 145408
    buffer_load_dwordx4 v17, s[8:11], s41 offen offset:2048 nt lds
    s_add_u32 s41, s58, 177152
    buffer_load_dwordx4 v17, s[8:11], s41 offen offset:3072 nt lds
    ds_write_b64 v70, v[32:33] offset:12288
    v_add_u32 v28, 0, v24
    v_add_u32 v29, 0, v25
    v_add_u32 v30, 0, v26
    v_add_u32 v31, 0, v27
    ds_read_b64_tr_b16 a[98:99], v28 offset:0
    ds_read_b64_tr_b16 a[106:107], v28 offset:8
    ds_read_b64_tr_b16 a[114:115], v29 offset:0
    ds_read_b64_tr_b16 a[122:123], v29 offset:8
    ds_read_b64_tr_b16 a[130:131], v30 offset:0
    ds_read_b64_tr_b16 a[138:139], v30 offset:8
    ds_read_b64_tr_b16 a[146:147], v31 offset:0
    ds_read_b64_tr_b16 v[0:1], v31 offset:8
    s_waitcnt vmcnt(12) lgkmcnt(0)
    s_barrier
    s_cmp_eq_u32 s71, 1
    s_cbranch_scc1 cf_th7
    s_waitcnt vmcnt(6)
cf_th7:
    s_mov_b64 s[8:9], s[52:53]
    s_add_u32 m0, s43, 0
    s_add_u32 s41, s58, 262144
    buffer_load_dwordx4 v17, s[8:11], s41 offen offset:0 nt lds
    s_add_u32 s41, s58, 293888
    buffer_load_dwordx4 v17, s[8:11], s41 offen offset:1024 nt lds
    s_add_u32 s41, s58, 391168
    buffer_load_dwordx4 v17, s[8:11], s41 offen offset:2048 nt lds
    s_add_u32 s41, s58, 422912
    buffer_load_dwordx4 v17, s[8:11], s41 offen offset:3072 nt lds
    ds_write_b64 v70, v[0:1] offset:12296
    v_add_u32 v28, 36864, v24
    v_add_u32 v29, 36864, v25
    v_add_u32 v30, 36864, v26
    v_add_u32 v31, 36864, v27
    ds_read_b64_tr_b16 a[232:233], v28 offset:0
    ds_read_b64_tr_b16 v[32:33], v28 offset:8
    ds_read_b64_tr_b16 a[240:241], v29 offset:0
    ds_read_b64_tr_b16 a[248:249], v29 offset:8
    ds_read_b64_tr_b16 v[144:145], v30 offset:0
    ds_read_b64_tr_b16 v[152:153], v30 offset:8
    ds_read_b64_tr_b16 v[160:161], v31 offset:0
    ds_read_b64_tr_b16 v[168:169], v31 offset:8
    s_waitcnt vmcnt(12) lgkmcnt(0)
    s_barrier
    s_cmp_eq_u32 s71, 1
    s_cbranch_scc1 cf_th8
    s_waitcnt vmcnt(6)
cf_th8:
    s_add_u32 m0, s43, 36864
    s_add_u32 s41, s58, 278528
    buffer_load_dwordx4 v17, s[8:11], s41 offen offset:0 nt lds
    s_add_u32 s41, s58, 310272
    buffer_load_dwordx4 v17, s[8:11], s41 offen offset:1024 nt lds
    s_add_u32 s41, s58, 407552
    buffer_load_dwordx4 v17, s[8:11], s41 offen offset:2048 nt lds
    s_add_u32 s41, s58, 439296
    buffer_load_dwordx4 v17, s[8:11], s41 offen offset:3072 nt lds
    ds_write_b64 v70, v[32:33] offset:8192
    v_add_u32 v28, 73728, v24
    v_add_u32 v29, 73728, v25
    v_add_u32 v30, 73728, v26
    v_add_u32 v31, 73728, v27
    ds_read_b64_tr_b16 a[234:235], v28 offset:0
    ds_read_b64_tr_b16 v[0:1], v28 offset:8
    ds_read_b64_tr_b16 a[242:243], v29 offset:0
    ds_read_b64_tr_b16 a[250:251], v29 offset:8
    ds_read_b64_tr_b16 v[146:147], v30 offset:0
    ds_read_b64_tr_b16 v[154:155], v30 offset:8
    ds_read_b64_tr_b16 v[162:163], v31 offset:0
    ds_read_b64_tr_b16 v[170:171], v31 offset:8
    s_waitcnt vmcnt(12) lgkmcnt(0)
    s_barrier
    s_cmp_eq_u32 s71, 1
    s_cbranch_scc1 cf_th9
    s_waitcnt vmcnt(6)
cf_th9:
    s_mov_b64 s[8:9], s[54:55]
    s_add_u32 m0, s43, 73728
    s_add_u32 s41, s58, 262144
    buffer_load_dwordx4 v17, s[8:11], s41 offen offset:0 nt lds
    s_add_u32 s41, s58, 293888
    buffer_load_dwordx4 v17, s[8:11], s41 offen offset:1024 nt lds
    s_add_u32 s41, s58, 391168
    buffer_load_dwordx4 v17, s[8:11], s41 offen offset:2048 nt lds
    s_add_u32 s41, s58, 422912
    buffer_load_dwordx4 v17, s[8:11], s41 offen offset:3072 nt lds
    ds_write_b64 v70, v[0:1] offset:8200
    v_add_u32 v28, 110592, v24
    v_add_u32 v29, 110592, v25
    v_add_u32 v30, 110592, v26
    v_add_u32 v31, 110592, v27
    ds_read_b64_tr_b16 v[32:33], v28 offset:0
    ds_read_b64_tr_b16 v[34:35], v28 offset:8
    ds_read_b64_tr_b16 v[36:37], v29 offset:0
    ds_read_b64_tr_b16 v[38:39], v29 offset:8
    ds_read_b64_tr_b16 a[0:1], v30 offset:0
    ds_read_b64_tr_b16 v[40:41], v30 offset:8
    ds_read_b64_tr_b16 a[8:9], v31 offset:0
    ds_read_b64_tr_b16 v[42:43], v31 offset:8
    s_waitcnt vmcnt(12) lgkmcnt(0)
    s_barrier
    s_cmp_eq_u32 s71, 1
    s_cbranch_scc1 cf_th10
    s_waitcnt vmcnt(6)
cf_th10:
    s_add_u32 m0, s43, 110592
    s_add_u32 s41, s58, 278528
    buffer_load_dwordx4 v17, s[8:11], s41 offen offset:0 nt lds
    s_add_u32 s41, s58, 310272
    buffer_load_dwordx4 v17, s[8:11], s41 offen offset:1024 nt lds
    s_add_u32 s41, s58, 407552
    buffer_load_dwordx4 v17, s[8:11], s41 offen offset:2048 nt lds
    s_add_u32 s41, s58, 439296
    buffer_load_dwordx4 v17, s[8:11], s41 offen offset:3072 nt lds
    s_cmp_lg_u32 s13, 0
    s_cbranch_scc1 cf_ma
    v_mov_b32 v54, 1
    s_mov_b64 exec, 1
    buffer_atomic_add v54, off, s[84:87], 0 offset:132
    s_mov_b64 exec, -1
cf_ma:
    ds_write_b64 v70, v[32:33] offset:0
    ds_write_b64 v70, v[34:35] offset:2048
    ds_write_b64 v70, v[36:37] offset:4096
    ds_write_b64 v70, v[38:39] offset:6144
    ds_write_b64 v70, v[40:41] offset:10240
    ds_write_b64 v70, v[42:43] offset:14336
    v_add_u32 v28, 147456, v24
    v_add_u32 v29, 147456, v25
    v_add_u32 v30, 147456, v26
    v_add_u32 v31, 147456, v27
    ds_read_b64_tr_b16 v[0:1], v28 offset:0
    ds_read_b64_tr_b16 v[2:3], v28 offset:8
    ds_read_b64_tr_b16 v[4:5], v29 offset:0
    ds_read_b64_tr_b16 v[6:7], v29 offset:8
    ds_read_b64_tr_b16 a[2:3], v30 offset:0
    ds_read_b64_tr_b16 v[8:9], v30 offset:8
    ds_read_b64_tr_b16 a[10:11], v31 offset:0
    ds_read_b64_tr_b16 v[10:11], v31 offset:8
    s_waitcnt vmcnt(12) lgkmcnt(0)
    s_barrier
    s_cmp_eq_u32 s71, 1
    s_cbranch_scc1 cf_th11
    s_waitcnt vmcnt(6)
cf_th11:
    s_mov_b64 s[8:9], s[50:51]
    s_add_u32 m0, s43, 147456
    s_add_u32 s41, s58, 262144
    buffer_load_dwordx4 v17, s[8:11], s41 offen offset:0 nt lds
    s_add_u32 s41, s58, 293888
    buffer_load_dwordx4 v17, s[8:11], s41 offen offset:1024 nt lds
    s_add_u32 s41, s58, 391168
    buffer_load_dwordx4 v17, s[8:11], s41 offen offset:2048 nt lds
    s_add_u32 s41, s58, 422912
    buffer_load_dwordx4 v17, s[8:11], s41 offen offset:3072 nt lds
    ds_write_b64 v70, v[0:1] offset:8
    ds_write_b64 v70, v[2:3] offset:2056
    ds_write_b64 v70, v[4:5] offset:4104
    ds_write_b64 v70, v[6:7] offset:6152
    ds_write_b64 v70, v[8:9] offset:10248
    ds_write_b64 v70, v[10:11] offset:14344
    v_add_u32 v28, 0, v24
    v_add_u32 v29, 0, v25
    v_add_u32 v30, 0, v26
    v_add_u32 v31, 0, v27
    ds_read_b64_tr_b16 a[100:101], v28 offset:0
    ds_read_b64_tr_b16 a[108:109], v28 offset:8
    ds_read_b64_tr_b16 a[116:117], v29 offset:0
    ds_read_b64_tr_b16 a[124:125], v29 offset:8
    ds_read_b64_tr_b16 a[132:133], v30 offset:0
    ds_read_b64_tr_b16 a[140:141], v30 offset:8
    ds_read_b64_tr_b16 a[148:149], v31 offset:0
    ds_read_b64_tr_b16 v[32:33], v31 offset:8
    s_waitcnt vmcnt(12) lgkmcnt(0)
    s_barrier
    s_cmp_eq_u32 s71, 1
    s_cbranch_scc1 cf_th12
    s_waitcnt vmcnt(6)
cf_th12:
    s_add_u32 m0, s43, 0
    s_add_u32 s41, s58, 278528
    buffer_load_dwordx4 v17, s[8:11], s41 offen offset:0 nt lds
    s_add_u32 s41, s58, 310272
    buffer_load_dwordx4 v17, s[8:11], s41 offen offset:1024 nt lds
    s_add_u32 s41, s58, 407552
    buffer_load_dwordx4 v17, s[8:11], s41 offen offset:2048 nt lds
    s_add_u32 s41, s58, 439296
    buffer_load_dwordx4 v17, s[8:11], s41 offen offset:3072 nt lds
    ds_write_b64 v70, v[32:33] offset:13312
    v_add_u32 v28, 36864, v24
    v_add_u32 v29, 36864, v25
    v_add_u32 v30, 36864, v26
    v_add_u32 v31, 36864, v27
    ds_read_b64_tr_b16 a[102:103], v28 offset:0
    ds_read_b64_tr_b16 a[110:111], v28 offset:8
    ds_read_b64_tr_b16 a[118:119], v29 offset:0
    ds_read_b64_tr_b16 a[126:127], v29 offset:8
    ds_read_b64_tr_b16 a[134:135], v30 offset:0
    ds_read_b64_tr_b16 a[142:143], v30 offset:8
    ds_read_b64_tr_b16 a[150:151], v31 offset:0
    ds_read_b64_tr_b16 v[0:1], v31 offset:8
    s_waitcnt vmcnt(12) lgkmcnt(0)
    s_barrier
    s_cmp_eq_u32 s71, 1
    s_cbranch_scc1 cf_th13
    s_waitcnt vmcnt(6)
cf_th13:
    s_mov_b64 s[8:9], s[52:53]
    s_add_u32 m0, s43, 36864
    s_add_u32 s41, s58, 524288
    buffer_load_dwordx4 v17, s[8:11], s41 offen offset:0 nt lds
    s_add_u32 s41, s58, 556032
    buffer_load_dwordx4 v17, s[8:11], s41 offen offset:1024 nt lds
    s_add_u32 s41, s58, 653312
    buffer_load_dwordx4 v17, s[8:11], s41 offen offset:2048 nt lds
    s_add_u32 s41, s58, 685056
    buffer_load_dwordx4 v17, s[8:11], s41 offen offset:3072 nt lds
    ds_write_b64 v70, v[0:1] offset:13320
    v_add_u32 v28, 73728, v24
    v_add_u32 v29, 73728, v25
    v_add_u32 v30, 73728, v26
    v_add_u32 v31, 73728, v27
    ds_read_b64_tr_b16 a[236:237], v28 offset:0
    ds_read_b64_tr_b16 v[32:33], v28 offset:8
    ds_read_b64_tr_b16 a[244:245], v29 offset:0
    ds_read_b64_tr_b16 a[252:253], v29 offset:8
    ds_read_b64_tr_b16 v[148:149], v30 offset:0
    ds_read_b64_tr_b16 v[156:157], v30 offset:8
    ds_read_b64_tr_b16 v[164:165], v31 offset:0
    ds_read_b64_tr_b16 v[172:173], v31 offset:8
    s_waitcnt vmcnt(12) lgkmcnt(0)
    s_barrier
    s_cmp_eq_u32 s71, 1
    s_cbranch_scc1 cf_th14
    s_waitcnt vmcnt(6)
cf_th14:
    s_add_u32 m0, s43, 73728
    s_add_u32 s41, s58, 540672
    buffer_load_dwordx4 v17, s[8:11], s41 offen offset:0 nt lds
    s_add_u32 s41, s58, 572416
    buffer_load_dwordx4 v17, s[8:11], s41 offen offset:1024 nt lds
    s_add_u32 s41, s58, 669696
    buffer_load_dwordx4 v17, s[8:11], s41 offen offset:2048 nt lds
    s_add_u32 s41, s58, 701440
    buffer_load_dwordx4 v17, s[8:11], s41 offen offset:3072 nt lds
    ds_write_b64 v70, v[32:33] offset:9216
    v_add_u32 v28, 110592, v24
    v_add_u32 v29, 110592, v25
    v_add_u32 v30, 110592, v26
    v_add_u32 v31, 110592, v27
    ds_read_b64_tr_b16 a[238:239], v28 offset:0
    ds_read_b64_tr_b16 v[0:1], v28 offset:8
    ds_read_b64_tr_b16 a[246:247], v29 offset:0
    ds_read_b64_tr_b16 a[254:255], v29 offset:8
    ds_read_b64_tr_b16 v[150:151], v30 offset:0
    ds_read_b64_tr_b16 v[158:159], v30 offset:8
    ds_read_b64_tr_b16 v[166:167], v31 offset:0
    ds_read_b64_tr_b16 v[174:175], v31 offset:8
    s_waitcnt vmcnt(12) lgkmcnt(0)
    s_barrier
    s_cmp_eq_u32 s71, 1
    s_cbranch_scc1 cf_th15
    s_waitcnt vmcnt(6)
cf_th15:
    s_mov_b64 s[8:9], s[54:55]
    s_add_u32 m0, s43, 110592
    s_add_u32 s41, s58, 524288
    buffer_load_dwordx4 v17, s[8:11], s41 offen offset:0 nt lds
    s_add_u32 s41, s58, 556032
    buffer_load_dwordx4 v17, s[8:11], s41 offen offset:1024 nt lds
    s_add_u32 s41, s58, 653312
    buffer_load_dwordx4 v17, s[8:11], s41 offen offset:2048 nt lds
    s_add_u32 s41, s58, 685056
    buffer_load_dwordx4 v17, s[8:11], s41 offen offset:3072 nt lds
    ds_write_b64 v70, v[0:1] offset:9224
    v_add_u32 v28, 147456, v24
    v_add_u32 v29, 147456, v25
    v_add_u32 v30, 147456, v26
    v_add_u32 v31, 147456, v27
    ds_read_b64_tr_b16 v[32:33], v28 offset:0
    ds_read_b64_tr_b16 v[34:35], v28 offset:8
    ds_read_b64_tr_b16 v[36:37], v29 offset:0
    ds_read_b64_tr_b16 v[38:39], v29 offset:8
    ds_read_b64_tr_b16 a[4:5], v30 offset:0
    ds_read_b64_tr_b16 v[40:41], v30 offset:8
    ds_read_b64_tr_b16 a[12:13], v31 offset:0
    ds_read_b64_tr_b16 v[42:43], v31 offset:8
    s_waitcnt vmcnt(12) lgkmcnt(0)
    s_barrier
    s_cmp_eq_u32 s71, 1
    s_cbranch_scc1 cf_th16
    s_waitcnt vmcnt(6)
cf_th16:
    s_add_u32 m0, s43, 147456
    s_add_u32 s41, s58, 540672
    buffer_load_dwordx4 v17, s[8:11], s41 offen offset:0 nt lds
    s_add_u32 s41, s58, 572416
    buffer_load_dwordx4 v17, s[8:11], s41 offen offset:1024 nt lds
    s_add_u32 s41, s58, 669696
    buffer_load_dwordx4 v17, s[8:11], s41 offen offset:2048 nt lds
    s_add_u32 s41, s58, 701440
    buffer_load_dwordx4 v17, s[8:11], s41 offen offset:3072 nt lds
    ds_write_b64 v70, v[32:33] offset:1024
    ds_write_b64 v70, v[34:35] offset:3072
    ds_write_b64 v70, v[36:37] offset:5120
    ds_write_b64 v70, v[38:39] offset:7168
    ds_write_b64 v70, v[40:41] offset:11264
    ds_write_b64 v70, v[42:43] offset:15360
    v_add_u32 v28, 0, v24
    v_add_u32 v29, 0, v25
    v_add_u32 v30, 0, v26
    v_add_u32 v31, 0, v27
    ds_read_b64_tr_b16 v[0:1], v28 offset:0
    ds_read_b64_tr_b16 v[2:3], v28 offset:8
    ds_read_b64_tr_b16 v[4:5], v29 offset:0
    ds_read_b64_tr_b16 v[6:7], v29 offset:8
    ds_read_b64_tr_b16 a[6:7], v30 offset:0
    ds_read_b64_tr_b16 v[8:9], v30 offset:8
    ds_read_b64_tr_b16 a[14:15], v31 offset:0
    ds_read_b64_tr_b16 v[10:11], v31 offset:8
    s_waitcnt vmcnt(12) lgkmcnt(0)
    s_barrier
    s_cmp_eq_u32 s71, 1
    s_cbranch_scc1 cf_th17
    s_waitcnt vmcnt(6)
cf_th17:
    s_mov_b64 s[8:9], s[50:51]
    s_add_u32 m0, s43, 0
    s_add_u32 s41, s58, 524288
    buffer_load_dwordx4 v17, s[8:11], s41 offen offset:0 nt lds
    s_add_u32 s41, s58, 556032
    buffer_load_dwordx4 v17, s[8:11], s41 offen offset:1024 nt lds
    s_add_u32 s41, s58, 653312
    buffer_load_dwordx4 v17, s[8:11], s41 offen offset:2048 nt lds
    s_add_u32 s41, s58, 685056
    buffer_load_dwordx4 v17, s[8:11], s41 offen offset:3072 nt lds
    ds_write_b64 v70, v[0:1] offset:1032
    ds_write_b64 v70, v[2:3] offset:3080
    ds_write_b64 v70, v[4:5] offset:5128
    ds_write_b64 v70, v[6:7] offset:7176
    ds_write_b64 v70, v[8:9] offset:11272
    ds_write_b64 v70, v[10:11] offset:15368
    v_add_u32 v28, 36864, v24
    v_add_u32 v29, 36864, v25
    v_add_u32 v30, 36864, v26
    v_add_u32 v31, 36864, v27
    ds_read_b64_tr_b16 a[152:153], v28 offset:0
    ds_read_b64_tr_b16 a[160:161], v28 offset:8
    ds_read_b64_tr_b16 a[168:169], v29 offset:0
    ds_read_b64_tr_b16 a[176:177], v29 offset:8
    ds_read_b64_tr_b16 a[184:185], v30 offset:0
    ds_read_b64_tr_b16 a[192:193], v30 offset:8
    ds_read_b64_tr_b16 a[200:201], v31 offset:0
    ds_read_b64_tr_b16 a[208:209], v31 offset:8
    s_waitcnt vmcnt(12) lgkmcnt(0)
    s_barrier
    s_cmp_eq_u32 s71, 1
    s_cbranch_scc1 cf_th18
    s_waitcnt vmcnt(6)
cf_th18:
    s_add_u32 m0, s43, 36864
    s_add_u32 s41, s58, 540672
    buffer_load_dwordx4 v17, s[8:11], s41 offen offset:0 nt lds
    s_add_u32 s41, s58, 572416
    buffer_load_dwordx4 v17, s[8:11], s41 offen offset:1024 nt lds
    s_add_u32 s41, s58, 669696
    buffer_load_dwordx4 v17, s[8:11], s41 offen offset:2048 nt lds
    s_add_u32 s41, s58, 701440
    buffer_load_dwordx4 v17, s[8:11], s41 offen offset:3072 nt lds
    v_add_u32 v28, 73728, v24
    v_add_u32 v29, 73728, v25
    v_add_u32 v30, 73728, v26
    v_add_u32 v31, 73728, v27
    ds_read_b64_tr_b16 a[154:155], v28 offset:0
    ds_read_b64_tr_b16 a[162:163], v28 offset:8
    ds_read_b64_tr_b16 a[170:171], v29 offset:0
    ds_read_b64_tr_b16 a[178:179], v29 offset:8
    ds_read_b64_tr_b16 a[186:187], v30 offset:0
    ds_read_b64_tr_b16 a[194:195], v30 offset:8
    ds_read_b64_tr_b16 a[202:203], v31 offset:0
    ds_read_b64_tr_b16 a[210:211], v31 offset:8
    s_waitcnt vmcnt(12) lgkmcnt(0)
    s_barrier
    s_cmp_eq_u32 s71, 1
    s_cbranch_scc1 cf_th19
    s_waitcnt vmcnt(6)
cf_th19:
    s_mov_b64 s[8:9], s[52:53]
    s_add_u32 m0, s43, 73728
    s_add_u32 s41, s58, 786432
    buffer_load_dwordx4 v17, s[8:11], s41 offen offset:0 nt lds
    s_add_u32 s41, s58, 818176
    buffer_load_dwordx4 v17, s[8:11], s41 offen offset:1024 nt lds
    s_add_u32 s41, s58, 915456
    buffer_load_dwordx4 v17, s[8:11], s41 offen offset:2048 nt lds
    s_add_u32 s41, s58, 947200
    buffer_load_dwordx4 v17, s[8:11], s41 offen offset:3072 nt lds
    v_add_u32 v28, 110592, v24
    v_add_u32 v29, 110592, v25
    v_add_u32 v30, 110592, v26
    v_add_u32 v31, 110592, v27
    ds_read_b64_tr_b16 v[176:177], v28 offset:0
    ds_read_b64_tr_b16 v[184:185], v28 offset:8
    ds_read_b64_tr_b16 v[192:193], v29 offset:0
    ds_read_b64_tr_b16 v[200:201], v29 offset:8
    ds_read_b64_tr_b16 v[208:209], v30 offset:0
    ds_read_b64_tr_b16 v[216:217], v30 offset:8
    ds_read_b64_tr_b16 v[224:225], v31 offset:0
    ds_read_b64_tr_b16 v[232:233], v31 offset:8
    s_waitcnt vmcnt(12) lgkmcnt(0)
    s_barrier
    s_cmp_eq_u32 s71, 1
    s_cbranch_scc1 cf_th20
    s_waitcnt vmcnt(6)
cf_th20:
    s_add_u32 m0, s43, 110592
    s_add_u32 s41, s58, 802816
    buffer_load_dwordx4 v17, s[8:11], s41 offen offset:0 nt lds
    s_add_u32 s41, s58, 834560
    buffer_load_dwordx4 v17, s[8:11], s41 offen offset:1024 nt lds
    s_add_u32 s41, s58, 931840
    buffer_load_dwordx4 v17, s[8:11], s41 offen offset:2048 nt lds
    s_add_u32 s41, s58, 963584
    buffer_load_dwordx4 v17, s[8:11], s41 offen offset:3072 nt lds
    v_add_u32 v28, 147456, v24
    v_add_u32 v29, 147456, v25
    v_add_u32 v30, 147456, v26
    v_add_u32 v31, 147456, v27
    ds_read_b64_tr_b16 v[178:179], v28 offset:0
    ds_read_b64_tr_b16 v[186:187], v28 offset:8
    ds_read_b64_tr_b16 v[194:195], v29 offset:0
    ds_read_b64_tr_b16 v[202:203], v29 offset:8
    ds_read_b64_tr_b16 v[210:211], v30 offset:0
    ds_read_b64_tr_b16 v[218:219], v30 offset:8
    ds_read_b64_tr_b16 v[226:227], v31 offset:0
    ds_read_b64_tr_b16 v[234:235], v31 offset:8
    s_waitcnt vmcnt(12) lgkmcnt(0)
    s_barrier
    s_cmp_eq_u32 s71, 1
    s_cbranch_scc1 cf_th21
    s_waitcnt vmcnt(6)
cf_th21:
    s_mov_b64 s[8:9], s[54:55]
    s_add_u32 m0, s43, 147456
    s_add_u32 s41, s58, 786432
    buffer_load_dwordx4 v17, s[8:11], s41 offen offset:0 nt lds
    s_add_u32 s41, s58, 818176
    buffer_load_dwordx4 v17, s[8:11], s41 offen offset:1024 nt lds
    s_add_u32 s41, s58, 915456
    buffer_load_dwordx4 v17, s[8:11], s41 offen offset:2048 nt lds
    s_add_u32 s41, s58, 947200
    buffer_load_dwordx4 v17, s[8:11], s41 offen offset:3072 nt lds
    v_add_u32 v28, 0, v24
    v_add_u32 v29, 0, v25
    v_add_u32 v30, 0, v26
    v_add_u32 v31, 0, v27
    ds_read_b64_tr_b16 a[16:17], v28 offset:0
    ds_read_b64_tr_b16 a[24:25], v28 offset:8
    ds_read_b64_tr_b16 a[32:33], v29 offset:0
    ds_read_b64_tr_b16 a[40:41], v29 offset:8
    ds_read_b64_tr_b16 a[48:49], v30 offset:0
    ds_read_b64_tr_b16 a[56:57], v30 offset:8
    ds_read_b64_tr_b16 a[64:65], v31 offset:0
    ds_read_b64_tr_b16 a[72:73], v31 offset:8
    s_waitcnt vmcnt(12) lgkmcnt(0)
    s_barrier
    s_cmp_eq_u32 s71, 1
    s_cbranch_scc1 cf_th22
    s_waitcnt vmcnt(6)
cf_th22:
    s_add_u32 m0, s43, 0
    s_add_u32 s41, s58, 802816
    buffer_load_dwordx4 v17, s[8:11], s41 offen offset:0 nt lds
    s_add_u32 s41, s58, 834560
    buffer_load_dwordx4 v17, s[8:11], s41 offen offset:1024 nt lds
    s_add_u32 s41, s58, 931840
    buffer_load_dwordx4 v17, s[8:11], s41 offen offset:2048 nt lds
    s_add_u32 s41, s58, 963584
    buffer_load_dwordx4 v17, s[8:11], s41 offen offset:3072 nt lds
    buffer_load_dword v54, off, s[84:87], 0 offset:132 sc1
    buffer_load_dword v55, off, s[84:87], 0 offset:216 sc1
    v_add_u32 v28, 36864, v24
    v_add_u32 v29, 36864, v25
    v_add_u32 v30, 36864, v26
    v_add_u32 v31, 36864, v27
    ds_read_b64_tr_b16 a[18:19], v28 offset:0
    ds_read_b64_tr_b16 a[26:27], v28 offset:8
    ds_read_b64_tr_b16 a[34:35], v29 offset:0
    ds_read_b64_tr_b16 a[42:43], v29 offset:8
    ds_read_b64_tr_b16 a[50:51], v30 offset:0
    ds_read_b64_tr_b16 a[58:59], v30 offset:8
    ds_read_b64_tr_b16 a[66:67], v31 offset:0
    ds_read_b64_tr_b16 a[74:75], v31 offset:8
    s_waitcnt vmcnt(12) lgkmcnt(0)
    s_barrier
    s_cmp_eq_u32 s71, 1
    s_cbranch_scc1 cf_th23
    s_waitcnt vmcnt(6)
cf_th23:
    s_mov_b64 s[8:9], s[50:51]
    s_add_u32 m0, s43, 36864
    s_add_u32 s41, s58, 786432
    buffer_load_dwordx4 v17, s[8:11], s41 offen offset:0 nt lds
    s_add_u32 s41, s58, 818176
    buffer_load_dwordx4 v17, s[8:11], s41 offen offset:1024 nt lds
    s_add_u32 s41, s58, 915456
    buffer_load_dwordx4 v17, s[8:11], s41 offen offset:2048 nt lds
    s_add_u32 s41, s58, 947200
    buffer_load_dwordx4 v17, s[8:11], s41 offen offset:3072 nt lds
    v_add_u32 v28, 73728, v24
    v_add_u32 v29, 73728, v25
    v_add_u32 v30, 73728, v26
    v_add_u32 v31, 73728, v27
    ds_read_b64_tr_b16 a[156:157], v28 offset:0
    ds_read_b64_tr_b16 a[164:165], v28 offset:8
    ds_read_b64_tr_b16 a[172:173], v29 offset:0
    ds_read_b64_tr_b16 a[180:181], v29 offset:8
    ds_read_b64_tr_b16 a[188:189], v30 offset:0
    ds_read_b64_tr_b16 a[196:197], v30 offset:8
    ds_read_b64_tr_b16 a[204:205], v31 offset:0
    ds_read_b64_tr_b16 a[212:213], v31 offset:8
    s_waitcnt vmcnt(12) lgkmcnt(0)
    s_barrier
    s_cmp_eq_u32 s71, 1
    s_cbranch_scc1 cf_th24
    s_waitcnt vmcnt(6)
cf_th24:
    s_add_u32 m0, s43, 73728
    s_add_u32 s41, s58, 802816
    buffer_load_dwordx4 v17, s[8:11], s41 offen offset:0 nt lds
    s_add_u32 s41, s58, 834560
    buffer_load_dwordx4 v17, s[8:11], s41 offen offset:1024 nt lds
    s_add_u32 s41, s58, 931840
    buffer_load_dwordx4 v17, s[8:11], s41 offen offset:2048 nt lds
    s_add_u32 s41, s58, 963584
    buffer_load_dwordx4 v17, s[8:11], s41 offen offset:3072 nt lds
    v_add_u32 v28, 110592, v24
    v_add_u32 v29, 110592, v25
    v_add_u32 v30, 110592, v26
    v_add_u32 v31, 110592, v27
    ds_read_b64_tr_b16 a[158:159], v28 offset:0
    ds_read_b64_tr_b16 a[166:167], v28 offset:8
    ds_read_b64_tr_b16 a[174:175], v29 offset:0
    ds_read_b64_tr_b16 a[182:183], v29 offset:8
    ds_read_b64_tr_b16 a[190:191], v30 offset:0
    ds_read_b64_tr_b16 a[198:199], v30 offset:8
    ds_read_b64_tr_b16 a[206:207], v31 offset:0
    ds_read_b64_tr_b16 a[214:215], v31 offset:8
    s_waitcnt vmcnt(12) lgkmcnt(0)
    s_barrier
    s_cmp_eq_u32 s71, 1
    s_cbranch_scc1 cf_th25
    s_waitcnt vmcnt(6)
cf_th25:
    s_mov_b64 s[8:9], s[52:53]
    s_add_u32 m0, s43, 110592
    s_add_u32 s41, s59, 0
    buffer_load_dwordx4 v17, s[8:11], s41 offen offset:0 nt lds
    s_add_u32 s41, s59, 31744
    buffer_load_dwordx4 v17, s[8:11], s41 offen offset:1024 nt lds
    s_add_u32 s41, s59, 129024
    buffer_load_dwordx4 v17, s[8:11], s41 offen offset:2048 nt lds
    s_add_u32 s41, s59, 160768
    buffer_load_dwordx4 v17, s[8:11], s41 offen offset:3072 nt lds
    v_add_u32 v28, 147456, v24
    v_add_u32 v29, 147456, v25
    v_add_u32 v30, 147456, v26
    v_add_u32 v31, 147456, v27
    ds_read_b64_tr_b16 v[180:181], v28 offset:0
    ds_read_b64_tr_b16 v[188:189], v28 offset:8
    ds_read_b64_tr_b16 v[196:197], v29 offset:0
    ds_read_b64_tr_b16 v[204:205], v29 offset:8
    ds_read_b64_tr_b16 v[212:213], v30 offset:0
    ds_read_b64_tr_b16 v[220:221], v30 offset:8
    ds_read_b64_tr_b16 v[228:229], v31 offset:0
    ds_read_b64_tr_b16 v[236:237], v31 offset:8
    s_waitcnt vmcnt(12) lgkmcnt(0)
    s_barrier
    s_cmp_eq_u32 s71, 1
    s_cbranch_scc1 cf_th26
    s_waitcnt vmcnt(6)
cf_th26:
    s_mov_b64 s[8:9], s[50:51]
    s_add_u32 m0, s43, 147456
    s_add_u32 s41, s59, 0
    buffer_load_dwordx4 v17, s[8:11], s41 offen offset:0 nt lds
    s_add_u32 s41, s59, 31744
    buffer_load_dwordx4 v17, s[8:11], s41 offen offset:1024 nt lds
    s_add_u32 s41, s59, 129024
    buffer_load_dwordx4 v17, s[8:11], s41 offen offset:2048 nt lds
    s_add_u32 s41, s59, 160768
    buffer_load_dwordx4 v17, s[8:11], s41 offen offset:3072 nt lds
    s_lshl_b32 s26, s12, 14
    s_add_u32 s26, s26, 0
    s_mul_i32 s40, s13, 3072
    s_add_u32 s24, s26, s40
    s_add_u32 s26, s24, s33
    s_add_u32 s99, s26, 33030144
    s_lshl_b32 s96, s12, 7
    s_add_u32 s29, s96, 125845504
    s_add_u32 s96, s96, 125829120
    v_bfe_u32 v78, v65, 2, 5
    buffer_load_dword v56, v78, s[4:7], s96 offen offset:16 sc1
    v_add_u32 v28, 0, v24
    v_add_u32 v29, 0, v25
    v_add_u32 v30, 0, v26
    v_add_u32 v31, 0, v27
    ds_read_b64_tr_b16 v[182:183], v28 offset:0
    ds_read_b64_tr_b16 v[190:191], v28 offset:8
    ds_read_b64_tr_b16 v[198:199], v29 offset:0
    ds_read_b64_tr_b16 v[206:207], v29 offset:8
    ds_read_b64_tr_b16 v[214:215], v30 offset:0
    ds_read_b64_tr_b16 v[222:223], v30 offset:8
    ds_read_b64_tr_b16 v[230:231], v31 offset:0
    ds_read_b64_tr_b16 v[238:239], v31 offset:8
    s_waitcnt vmcnt(12) lgkmcnt(0)
    s_barrier
    s_cmp_eq_u32 s71, 1
    s_cbranch_scc1 cf_th27
    s_waitcnt vmcnt(6)
cf_th27:
    s_mov_b64 s[8:9], s[54:55]
    s_add_u32 m0, s43, 0
    s_add_u32 s41, s59, 0
    buffer_load_dwordx4 v17, s[8:11], s41 offen offset:0 nt lds
    s_add_u32 s41, s59, 31744
    buffer_load_dwordx4 v17, s[8:11], s41 offen offset:1024 nt lds
    s_add_u32 s41, s59, 129024
    buffer_load_dwordx4 v17, s[8:11], s41 offen offset:2048 nt lds
    s_add_u32 s41, s59, 160768
    buffer_load_dwordx4 v17, s[8:11], s41 offen offset:3072 nt lds
    v_readfirstlane_b32 s94, v54
    v_readfirstlane_b32 s95, v55
    s_cmp_lt_u32 s94, 32
    s_cbranch_scc1 cf_mc
    s_cmp_lg_u32 s13, 0
    s_cbranch_scc1 cf_mc
    v_mov_b32 v76, 1
    v_mov_b32 v77, 0
    s_mov_b64 exec, 1
    buffer_atomic_cmpswap v[76:77], off, s[84:87], 0 offset:28 sc0
    s_mov_b64 exec, -1
cf_mc:
    s_nop 1
    v_add_u32 v28, 36864, v24
    v_add_u32 v29, 36864, v25
    v_add_u32 v30, 36864, v26
    v_add_u32 v31, 36864, v27
    ds_read_b64_tr_b16 a[20:21], v28 offset:0
    ds_read_b64_tr_b16 a[28:29], v28 offset:8
    ds_read_b64_tr_b16 a[36:37], v29 offset:0
    ds_read_b64_tr_b16 a[44:45], v29 offset:8
    ds_read_b64_tr_b16 a[52:53], v30 offset:0
    ds_read_b64_tr_b16 a[60:61], v30 offset:8
    ds_read_b64_tr_b16 a[68:69], v31 offset:0
    ds_read_b64_tr_b16 a[76:77], v31 offset:8
    s_waitcnt vmcnt(12) lgkmcnt(0)
    s_barrier
    s_cmp_eq_u32 s71, 1
    s_cbranch_scc1 cf_th28
    s_waitcnt vmcnt(6)
cf_th28:
    s_mov_b64 s[8:9], s[56:57]
    s_add_u32 m0, s43, 36864
    s_add_u32 s41, s60, 128
    buffer_load_dwordx4 v18, s[8:11], s41 offen offset:0 nt lds
    s_add_u32 s41, s60, 8320
    buffer_load_dwordx4 v18, s[8:11], s41 offen offset:1024 nt lds
    s_add_u32 s41, s60, 16512
    buffer_load_dwordx4 v18, s[8:11], s41 offen offset:2048 nt lds
    s_add_u32 s41, s60, 24704
    buffer_load_dwordx4 v18, s[8:11], s41 offen offset:3072 nt lds
    v_add_u32 v28, 73728, v24
    v_add_u32 v29, 73728, v25
    v_add_u32 v30, 73728, v26
    v_add_u32 v31, 73728, v27
    ds_read_b64_tr_b16 a[22:23], v28 offset:0
    ds_read_b64_tr_b16 a[30:31], v28 offset:8
    ds_read_b64_tr_b16 a[38:39], v29 offset:0
    ds_read_b64_tr_b16 a[46:47], v29 offset:8
    ds_read_b64_tr_b16 a[54:55], v30 offset:0
    ds_read_b64_tr_b16 a[62:63], v30 offset:8
    ds_read_b64_tr_b16 a[70:71], v31 offset:0
    ds_read_b64_tr_b16 a[78:79], v31 offset:8
    s_waitcnt vmcnt(12) lgkmcnt(0)
    s_barrier
    s_cmp_eq_u32 s71, 1
    s_cbranch_scc1 cf_th29
    s_waitcnt vmcnt(6)
cf_th29:
    s_add_u32 m0, s43, 73728
    s_add_u32 s41, s61, 128
    buffer_load_dwordx4 v18, s[8:11], s41 offen offset:0 nt lds
    s_add_u32 s41, s61, 8320
    buffer_load_dwordx4 v18, s[8:11], s41 offen offset:1024 nt lds
    s_add_u32 s41, s61, 16512
    buffer_load_dwordx4 v18, s[8:11], s41 offen offset:2048 nt lds
    s_add_u32 s41, s61, 24704
    buffer_load_dwordx4 v18, s[8:11], s41 offen offset:3072 nt lds
    v_add_u32 v77, 110592, v20
    ds_read_b64_tr_b16 a[216:217], v77 offset:0
    ds_read_b64_tr_b16 a[218:219], v77 offset:4096
    ds_read_b64_tr_b16 a[220:221], v77 offset:8192
    ds_read_b64_tr_b16 a[222:223], v77 offset:12288
    ds_read_b64_tr_b16 a[224:225], v77 offset:8
    ds_read_b64_tr_b16 a[226:227], v77 offset:4104
    ds_read_b64_tr_b16 a[228:229], v77 offset:8200
    ds_read_b64_tr_b16 a[230:231], v77 offset:12296
    s_waitcnt vmcnt(12) lgkmcnt(0)
    s_barrier
    s_cmp_eq_u32 s71, 1
    s_cbranch_scc1 cf_th30
    s_waitcnt vmcnt(6)
cf_th30:
    s_add_u32 m0, s43, 110592
    s_add_u32 s41, s62, 128
    buffer_load_dwordx4 v18, s[8:11], s41 offen offset:0 nt lds
    s_add_u32 s41, s62, 8320
    buffer_load_dwordx4 v18, s[8:11], s41 offen offset:1024 nt lds
    s_add_u32 s41, s62, 16512
    buffer_load_dwordx4 v18, s[8:11], s41 offen offset:2048 nt lds
    s_add_u32 s41, s62, 24704
    buffer_load_dwordx4 v18, s[8:11], s41 offen offset:3072 nt lds
    v_add_u32 v77, 147456, v20
    ds_read_b64_tr_b16 a[80:81], v77 offset:0
    ds_read_b64_tr_b16 a[82:83], v77 offset:4096
    ds_read_b64_tr_b16 a[84:85], v77 offset:8192
    ds_read_b64_tr_b16 a[86:87], v77 offset:12288
    ds_read_b64_tr_b16 a[88:89], v77 offset:8
    ds_read_b64_tr_b16 a[90:91], v77 offset:4104
    ds_read_b64_tr_b16 a[92:93], v77 offset:8200
    ds_read_b64_tr_b16 a[94:95], v77 offset:12296
    s_waitcnt vmcnt(12) lgkmcnt(0)
    s_barrier
    s_cmp_eq_u32 s71, 1
    s_cbranch_scc1 cf_th31
    s_waitcnt vmcnt(6)
cf_th31:
    s_add_u32 m0, s43, 147456
    s_add_u32 s41, s63, 128
    buffer_load_dwordx4 v18, s[8:11], s41 offen offset:0 nt lds
    s_add_u32 s41, s63, 8320
    buffer_load_dwordx4 v18, s[8:11], s41 offen offset:1024 nt lds
    s_add_u32 s41, s63, 16512
    buffer_load_dwordx4 v18, s[8:11], s41 offen offset:2048 nt lds
    s_add_u32 s41, s63, 24704
    buffer_load_dwordx4 v18, s[8:11], s41 offen offset:3072 nt lds
    v_mov_b32 v77, v56
    v_subrev_u32 v77, s95, v77
    v_cmp_lt_u32 vcc, 16, v77
    s_nop 1
    v_cndmask_b32 v77, v77, 0, vcc
    v_bfe_u32 v79, v78, 2, 2
    v_lshl_add_u32 v77, v77, 2, v79
    s_nop 1
    v_min_u32_dpp v77, v77, v77 row_ror:1 row_mask:0xf bank_mask:0xf
    s_nop 1
    v_min_u32_dpp v77, v77, v77 row_ror:2 row_mask:0xf bank_mask:0xf
    s_nop 1
    v_min_u32_dpp v77, v77, v77 row_ror:4 row_mask:0xf bank_mask:0xf
    s_nop 0
    v_readfirstlane_b32 s97, v77
    s_cmp_eq_u32 s95, 0
    s_cselect_b32 s97, 0, s97
    s_cmp_lt_u32 s97, 3
    s_cbranch_scc1 cf_mb
    s_add_u32 s40, s26, 0
    s_min_u32 s40, s40, s99
    s_sub_u32 s41, s96, s40
    v_bfe_u32 v77, v65, 2, 5
    v_add3_u32 v77, v77, s41, 16
    v_lshlrev_b32 v78, 3, v69
    s_nop 0
    v_mov_b32_dpp v78, v77 quad_perm:[0,1,2,3] row_mask:0xc bank_mask:0xf
    buffer_load_dword v63, v78, s[4:7], s40 offen sc1
    s_add_u32 s40, s26, 524288
    s_min_u32 s40, s40, s99
    s_sub_u32 s41, s96, s40
    v_bfe_u32 v77, v65, 2, 5
    v_add3_u32 v77, v77, s41, 16
    v_lshlrev_b32 v78, 3, v69
    s_nop 0
    v_mov_b32_dpp v78, v77 quad_perm:[0,1,2,3] row_mask:0xc bank_mask:0xf
    buffer_load_dword v63, v78, s[4:7], s40 offen sc1
cf_mb:
    v_mov_b32 v78, v21
    v_mov_b32 v79, v22
    v_add_u32 v77, 0, v20
    ds_read_b64_tr_b16 v[240:241], v77 offset:0
    ds_read_b64_tr_b16 v[242:243], v77 offset:4096
    ds_read_b64_tr_b16 v[244:245], v77 offset:8192
    ds_read_b64_tr_b16 v[246:247], v77 offset:12288
    ds_read_b64_tr_b16 v[248:249], v77 offset:8
    ds_read_b64_tr_b16 v[250:251], v77 offset:4104
    ds_read_b64_tr_b16 v[252:253], v77 offset:8200
    ds_read_b64_tr_b16 v[254:255], v77 offset:12296
    s_waitcnt vmcnt(12) lgkmcnt(0)
    s_barrier
    v_bfe_u32 v60, v65, 4, 6
    v_and_b32 v61, 15, v60
    v_lshrrev_b32 v62, 4, v60
    v_mov_b32 v50, 0x3f80
    v_mov_b32 v51, 0x3f800000
    v_and_b32 v57, 1, v62
    v_lshlrev_b32 v57, 2, v57
    v_sub_u32 v57, v61, v57
    v_and_b32 v58, 3, v61
    v_lshlrev_b32 v58, 2, v58
    v_lshrrev_b32 v59, 2, v61
    v_add_u32 v58, v58, v59
    v_cmp_eq_u32 vcc, 0, v57
    s_nop 1
    v_cndmask_b32 v40, 0, v50, vcc
    v_cmp_eq_u32 vcc, 1, v57
    s_nop 1
    v_cndmask_b32 v40, v40, v51, vcc
    v_cmp_eq_u32 vcc, 0, v58
    s_nop 1
    v_cndmask_b32 v44, 0, v50, vcc
    v_cmp_eq_u32 vcc, 1, v58
    s_nop 1
    v_cndmask_b32 v44, v44, v51, vcc
    v_cmp_eq_u32 vcc, 2, v57
    s_nop 1
    v_cndmask_b32 v41, 0, v50, vcc
    v_cmp_eq_u32 vcc, 3, v57
    s_nop 1
    v_cndmask_b32 v41, v41, v51, vcc
    v_cmp_eq_u32 vcc, 2, v58
    s_nop 1
    v_cndmask_b32 v45, 0, v50, vcc
    v_cmp_eq_u32 vcc, 3, v58
    s_nop 1
    v_cndmask_b32 v45, v45, v51, vcc
    v_cmp_eq_u32 vcc, 8, v57
    s_nop 1
    v_cndmask_b32 v42, 0, v50, vcc
    v_cmp_eq_u32 vcc, 9, v57
    s_nop 1
    v_cndmask_b32 v42, v42, v51, vcc
    v_cmp_eq_u32 vcc, 4, v58
    s_nop 1
    v_cndmask_b32 v46, 0, v50, vcc
    v_cmp_eq_u32 vcc, 5, v58
    s_nop 1
    v_cndmask_b32 v46, v46, v51, vcc
    v_cmp_eq_u32 vcc, 10, v57
    s_nop 1
    v_cndmask_b32 v43, 0, v50, vcc
    v_cmp_eq_u32 vcc, 11, v57
    s_nop 1
    v_cndmask_b32 v43, v43, v51, vcc
    v_cmp_eq_u32 vcc, 6, v58
    s_nop 1
    v_cndmask_b32 v47, 0, v50, vcc
    v_cmp_eq_u32 vcc, 7, v58
    s_nop 1
    v_cndmask_b32 v47, v47, v51, vcc
    v_lshlrev_b32 v57, 4, v61
    ds_write_b128 v69, v[40:43] offset:15360
    ds_write_b128 v57, v[44:47] offset:15872
    v_add_u32 v77, 36864, v79
    s_waitcnt lgkmcnt(0)
    ds_read_b64_tr_b16 v[0:1], v77 offset:0
    ds_read_b64_tr_b16 v[2:3], v77 offset:256
    ds_read_b64_tr_b16 v[4:5], v77 offset:2048
    ds_read_b64_tr_b16 v[6:7], v77 offset:2304
    ds_read_b64_tr_b16 v[8:9], v77 offset:16
    ds_read_b64_tr_b16 v[10:11], v77 offset:272
    ds_read_b64_tr_b16 v[12:13], v77 offset:2064
    ds_read_b64_tr_b16 v[14:15], v77 offset:2320
    s_waitcnt vmcnt(8) lgkmcnt(0)
    s_barrier
    s_mov_b32 s44, 0x3e0293ee
    s_mov_b32 s45, s44
    s_or_b32 s66, s44, 0x80000000
    s_mov_b32 s48, 0x3f003f00
    s_mov_b32 s49, 0
    s_mov_b32 s50, 0x3f803f80
    s_mov_b32 s51, 0x3f803f80
    s_mov_b32 s52, 512
    s_mov_b32 s53, 1024
    s_mov_b32 s54, 1536
    s_mov_b32 s30, 0
    s_mov_b32 s37, 0
    s_mov_b32 s98, -100
    s_lshl_b32 s47, s13, 9
    s_cmp_lg_u32 s32, 0
    s_cselect_b32 s71, s13, 3
    s_add_u32 s46, s71, 1
    s_lshr_b32 s46, s46, 1
    s_mov_b32 s14, 67125248
    s_mov_b32 s15, 67129344
    s_mov_b32 s16, 67133440
    s_mov_b32 s36, 0
    s_add_u32 s17, s68, 67108864
    s_mov_b32 s69, 0
    s_mov_b32 s70, 0
    s_lshl_b32 s26, s12, 14
    s_add_u32 s26, s26, 0
    s_mul_i32 s40, s13, 3072
    s_add_u32 s24, s26, s40
    s_add_u32 s26, s24, s33
    s_add_u32 s99, s26, 33030144
    s_lshl_b32 s96, s12, 7
    s_add_u32 s29, s96, 125845504
    s_add_u32 s96, s96, 125829120
    s_lshl_b32 s40, s12, 14
    s_add_u32 s40, s40, 68157440
    s_add_u32 s18, s40, 0
    s_add_u32 s19, s40, 4096
    s_add_u32 s20, s40, 8192
    s_add_u32 s21, s40, 12288
    s_lshr_b32 s40, s12, 3
    s_lshl_b32 s40, s40, 12
    s_and_b32 s41, s12, 7
    s_lshl_b32 s41, s41, 7
    s_add_u32 s40, s40, s41
    s_add_u32 s22, s40, 68157440
    s_add_u32 s23, s22, 1024
    s_add_u32 s25, s22, 2048
    s_mov_b32 s56, -65472
    s_cmp_lg_u32 s32, 0
    s_cselect_b64 s[38:39], -1, 0
    s_add_u32 s55, s68, 138412032
    s_cmp_eq_u32 s13, 3
    s_cselect_b64 s[100:101], 1, 0
    s_cselect_b64 s[38:39], 1, s[38:39]
    s_cselect_b32 s93, 64, 0
    s_cselect_b32 s55, s29, s55
    s_cselect_b32 s57, 0, 9216
    s_mov_b32 s34, 0xff00ff00
    s_mov_b32 s35, 0xff00ff00
    s_lshl_b32 s28, s12, 12
    s_add_u32 s28, s28, 7340032
    s_add_u32 s27, s28, 77594624
    s_add_u32 s28, s28, 69206016
    v_add_u32 v77, 73728, v78
    ds_read_b64_tr_b16 v[16:17], v77 offset:0
    ds_read_b64_tr_b16 v[18:19], v77 offset:256
    ds_read_b64_tr_b16 v[20:21], v77 offset:2048
    ds_read_b64_tr_b16 v[22:23], v77 offset:2304
    ds_read_b64_tr_b16 v[24:25], v77 offset:16
    ds_read_b64_tr_b16 v[26:27], v77 offset:272
    ds_read_b64_tr_b16 v[28:29], v77 offset:2064
    ds_read_b64_tr_b16 v[30:31], v77 offset:2320
    s_waitcnt vmcnt(4) lgkmcnt(0)
    s_barrier
    v_add_u32 v77, 110592, v78
    ds_read_b64_tr_b16 v[32:33], v77 offset:0
    ds_read_b64_tr_b16 v[34:35], v77 offset:256
    ds_read_b64_tr_b16 v[36:37], v77 offset:2048
    ds_read_b64_tr_b16 v[38:39], v77 offset:2304
    ds_read_b64_tr_b16 v[40:41], v77 offset:16
    ds_read_b64_tr_b16 v[42:43], v77 offset:272
    ds_read_b64_tr_b16 v[44:45], v77 offset:2064
    ds_read_b64_tr_b16 v[46:47], v77 offset:2320
    s_waitcnt vmcnt(0) lgkmcnt(0)
    s_barrier
    v_add_u32 v77, 147456, v78
    ds_read_b64_tr_b16 v[48:49], v77 offset:0
    ds_read_b64_tr_b16 v[50:51], v77 offset:256
    ds_read_b64_tr_b16 v[52:53], v77 offset:2048
    ds_read_b64_tr_b16 v[54:55], v77 offset:2304
    ds_read_b64_tr_b16 v[56:57], v77 offset:16
    ds_read_b64_tr_b16 v[58:59], v77 offset:272
    ds_read_b64_tr_b16 v[60:61], v77 offset:2064
    ds_read_b64_tr_b16 v[62:63], v77 offset:2320
    s_waitcnt lgkmcnt(0)
    s_barrier
    ds_write_b128 v70, v[0:3] offset:20480
    ds_write_b128 v70, v[4:7] offset:21504
    ds_write_b128 v70, v[8:11] offset:22528
    ds_write_b128 v70, v[12:15] offset:23552
    ds_write_b128 v70, v[16:19] offset:24576
    ds_write_b128 v70, v[20:23] offset:25600
    ds_write_b128 v70, v[24:27] offset:26624
    ds_write_b128 v70, v[28:31] offset:27648
    ds_write_b128 v70, v[32:35] offset:28672
    ds_write_b128 v70, v[36:39] offset:29696
    ds_write_b128 v70, v[40:43] offset:30720
    ds_write_b128 v70, v[44:47] offset:31744
    ds_write_b128 v70, v[48:51] offset:32768
    ds_write_b128 v70, v[52:55] offset:33792
    ds_write_b128 v70, v[56:59] offset:34816
    ds_write_b128 v70, v[60:63] offset:35840
    s_waitcnt vmcnt(0) lgkmcnt(0)
    s_cmp_lg_u32 s95, 0
    s_cbranch_scc1 cf_hn
    s_mov_b32 s88, 4194304
gn2:
    buffer_load_dword v2, off, s[84:87], 0 offset:216 sc1
    s_waitcnt vmcnt(0)
    v_readfirstlane_b32 s95, v2
    s_sub_u32 s88, s88, 1
    s_cbranch_scc1 gn2x
    s_cmp_eq_u32 s95, 0
    s_cbranch_scc1 gn2
gn2x:
cf_hn:
    v_mov_b32 v2, 1
    s_cmp_lg_u32 s13, 0
    s_cbranch_scc1 cf_noarr
    s_mov_b64 exec, 1
    s_mov_b32 s42, 1
    v_mov_b32 v4, v76
    s_cmp_ge_u32 s94, 32
    s_cbranch_scc1 cf_have
    s_mov_b32 s40, 131072
    s_mov_b32 s42, 2
cf_startpoll:
    buffer_load_dword v3, off, s[84:87], 0 offset:132 sc1
    s_sub_u32 s40, s40, 1
    s_cbranch_scc1 cf_decide
    s_waitcnt vmcnt(0)
    v_readfirstlane_b32 s41, v3
    s_nop 1
    s_cmp_lt_u32 s41, 32
    s_cbranch_scc1 cf_startpoll
    s_mov_b32 s42, 1
cf_decide:
    v_mov_b32 v4, s42
    v_mov_b32 v5, 0
    buffer_atomic_cmpswap v[4:5], off, s[84:87], 0 offset:28 sc0
    s_waitcnt vmcnt(0)
cf_have:
    v_mov_b32 v5, s42
    v_cmp_eq_u32 vcc, 0, v4
    s_nop 1
    v_cndmask_b32 v4, v4, v5, vcc
    v_mov_b32 v5, 16192
    ds_write_b32 v5, v4
    s_waitcnt lgkmcnt(0)
    s_mov_b64 exec, -1
cf_noarr:
    s_barrier
    v_mov_b32 v5, 16192
    ds_read_b32 v4, v5
    s_waitcnt lgkmcnt(0)
    v_readfirstlane_b32 s41, v4
    s_nop 1
    s_cmp_eq_u32 s41, 1
    s_cbranch_scc1 cf_run
    v_lshrrev_b32 v0, 4, v65
    s_mov_b32 s32, s13
    s_load_dwordx16 s[48:63], s[0:1], 0
    s_waitcnt lgkmcnt(0)
    s_branch L_helper
cf_run:
    s_mov_b64 exec, s[100:101]
    v_mov_b32 v72, s95
    s_mov_b64 exec, -1
    s_cmp_ge_u32 s97, 3
    s_cbranch_scc1 cf_kvdone
    s_mov_b32 s40, 3
    v_bfe_u32 v78, v65, 2, 5
    s_mov_b32 s31, 4194304
cf_kv0:
    buffer_load_dword v77, v78, s[4:7], s96 offen offset:16 sc1
    s_waitcnt vmcnt(0)
    v_subrev_u32 v77, s95, v77
    v_cmp_lt_u32 vcc, 16, v77
    s_nop 1
    v_cndmask_b32 v77, v77, 0, vcc
    v_bfe_u32 v79, v78, 2, 2
    v_lshl_add_u32 v77, v77, 2, v79
    s_nop 1
    v_min_u32_dpp v77, v77, v77 row_ror:1 row_mask:0xf bank_mask:0xf
    s_nop 1
    v_min_u32_dpp v77, v77, v77 row_ror:2 row_mask:0xf bank_mask:0xf
    s_nop 1
    v_min_u32_dpp v77, v77, v77 row_ror:4 row_mask:0xf bank_mask:0xf
    s_nop 0
    v_readfirstlane_b32 s97, v77
    s_sub_u32 s31, s31, 1
    s_cbranch_scc1 cf_kv0_x
    s_cmp_le_u32 s40, s97
    s_cbranch_scc1 cf_kv0_x
    s_sleep 2
    s_branch cf_kv0
cf_kv0_x:
    s_add_u32 s40, s26, 0
    s_min_u32 s40, s40, s99
    s_sub_u32 s41, s96, s40
    v_bfe_u32 v77, v65, 2, 5
    v_add3_u32 v77, v77, s41, 16
    v_lshlrev_b32 v78, 3, v69
    s_nop 0
    v_mov_b32_dpp v78, v77 quad_perm:[0,1,2,3] row_mask:0xc bank_mask:0xf
    buffer_load_dword v76, v78, s[4:7], s40 offen sc1
    s_add_u32 s40, s26, 524288
    s_min_u32 s40, s40, s99
    s_sub_u32 s41, s96, s40
    v_bfe_u32 v77, v65, 2, 5
    v_add3_u32 v77, v77, s41, 16
    v_lshlrev_b32 v78, 3, v69
    s_nop 0
    v_mov_b32_dpp v78, v77 quad_perm:[0,1,2,3] row_mask:0xc bank_mask:0xf
    buffer_load_dword v76, v78, s[4:7], s40 offen sc1
cf_kvdone:
    v_mov_b64 v[0:1], 0
    v_mov_b64 v[2:3], 0
    v_mov_b64 v[4:5], 0
    v_mov_b64 v[6:7], 0
    v_mov_b64 v[8:9], 0
    v_mov_b64 v[10:11], 0
    v_mov_b64 v[12:13], 0
    v_mov_b64 v[14:15], 0
    v_mov_b64 v[16:17], 0
    v_mov_b64 v[18:19], 0
    v_mov_b64 v[20:21], 0
    v_mov_b64 v[22:23], 0
    ds_read_b128 v[44:47], v70 offset:0
    ds_read_b128 v[48:51], v70 offset:1024
    ds_read_b128 v[52:55], v70 offset:2048
    ds_read_b128 v[56:59], v70 offset:3072
    ds_read_b128 v[24:27], v70 offset:4096
    ds_read_b128 v[28:31], v70 offset:5120
    ds_read_b128 v[32:35], v70 offset:6144
    ds_read_b128 v[36:39], v70 offset:7168
    buffer_load_dwordx4 v[40:43], v65, s[4:7], s14 offen offset:0 nt
    buffer_load_dwordx4 v[60:63], v66, s[4:7], s14 offen offset:0 nt
    s_mov_b32 s31, 1048576
    s_waitcnt vmcnt(0) lgkmcnt(0)
    s_branch cf_goA
cf_loop:
    s_mov_b32 s31, 1048576
    s_mov_b32 s69, s70
    s_waitcnt lgkmcnt(0)
cf_cA:
    buffer_load_dwordx4 v[40:43], v65, s[4:7], s14 offen offset:0 nt
    buffer_load_dwordx4 v[60:63], v66, s[4:7], s14 offen offset:0 nt
cf_cA1:
    v_bitop3_b32 v77, v40, v60, s70 bitop3:0x7e
    v_and_b32 v77, 1, v77
    v_cmp_ne_u32 vcc, 0, v77
    s_cbranch_vccz cf_goA
    v_bitop3_b32 v77, v40, v60, s70 bitop3:0x7e
    v_and_b32 v77, 1, v77
    v_cmp_ne_u32 vcc, 0, v77
    s_cbranch_vccz cf_goA
    v_bitop3_b32 v77, v40, v60, s70 bitop3:0x7e
    v_and_b32 v77, 1, v77
    v_cmp_ne_u32 vcc, 0, v77
    s_cbranch_vccz cf_goA
    v_bitop3_b32 v77, v40, v60, s70 bitop3:0x7e
    v_and_b32 v77, 1, v77
    v_cmp_ne_u32 vcc, 0, v77
    s_cbranch_vccz cf_goA
    buffer_load_dwordx4 v[40:43], v65, s[4:7], s14 offen offset:0 nt
    buffer_load_dwordx4 v[60:63], v66, s[4:7], s14 offen offset:0 nt
    v_bitop3_b32 v77, v40, v60, s70 bitop3:0x7e
    v_and_b32 v77, 1, v77
    v_cmp_ne_u32 vcc, 0, v77
    s_cbranch_vccz cf_goA
    v_bitop3_b32 v77, v40, v60, s70 bitop3:0x7e
    v_and_b32 v77, 1, v77
    v_cmp_ne_u32 vcc, 0, v77
    s_cbranch_vccz cf_goA
    v_bitop3_b32 v77, v40, v60, s70 bitop3:0x7e
    v_and_b32 v77, 1, v77
    v_cmp_ne_u32 vcc, 0, v77
    s_cbranch_vccz cf_goA
    v_bitop3_b32 v77, v40, v60, s70 bitop3:0x7e
    v_and_b32 v77, 1, v77
    v_cmp_ne_u32 vcc, 0, v77
    s_cbranch_vccz cf_goA
    buffer_load_dwordx4 v[40:43], v65, s[4:7], s14 offen offset:0 nt
    buffer_load_dwordx4 v[60:63], v66, s[4:7], s14 offen offset:0 nt
    v_bitop3_b32 v77, v40, v60, s70 bitop3:0x7e
    v_and_b32 v77, 1, v77
    v_cmp_ne_u32 vcc, 0, v77
    s_cbranch_vccz cf_goA
    v_bitop3_b32 v77, v40, v60, s70 bitop3:0x7e
    v_and_b32 v77, 1, v77
    v_cmp_ne_u32 vcc, 0, v77
    s_cbranch_vccz cf_goA
    v_bitop3_b32 v77, v40, v60, s70 bitop3:0x7e
    v_and_b32 v77, 1, v77
    v_cmp_ne_u32 vcc, 0, v77
    s_cbranch_vccz cf_goA
    v_bitop3_b32 v77, v40, v60, s70 bitop3:0x7e
    v_and_b32 v77, 1, v77
    v_cmp_ne_u32 vcc, 0, v77
    s_cbranch_vccz cf_goA
    buffer_load_dwordx4 v[40:43], v65, s[4:7], s14 offen offset:0 nt
    buffer_load_dwordx4 v[60:63], v66, s[4:7], s14 offen offset:0 nt
    v_bitop3_b32 v77, v40, v60, s70 bitop3:0x7e
    v_and_b32 v77, 1, v77
    v_cmp_ne_u32 vcc, 0, v77
    s_cbranch_vccz cf_goA
    v_bitop3_b32 v77, v40, v60, s70 bitop3:0x7e
    v_and_b32 v77, 1, v77
    v_cmp_ne_u32 vcc, 0, v77
    s_cbranch_vccz cf_goA
    v_bitop3_b32 v77, v40, v60, s70 bitop3:0x7e
    v_and_b32 v77, 1, v77
    v_cmp_ne_u32 vcc, 0, v77
    s_cbranch_vccz cf_goA
    v_bitop3_b32 v77, v40, v60, s70 bitop3:0x7e
    v_and_b32 v77, 1, v77
    v_cmp_ne_u32 vcc, 0, v77
    s_cbranch_vccz cf_goA
    s_sub_u32 s31, s31, 64
    s_cbranch_scc0 cf_cA
cf_goA:
    ds_write_b128 v65, v[40:43] offset:0
    v_smfmac_f32_16x16x64_bf16 v[0:3], v[40:43], v[44:51], v64
    v_smfmac_f32_16x16x64_bf16 v[4:7], v[40:43], v[52:59], v64
    buffer_load_dwordx4 v[44:47], v65, s[4:7], s15 offen offset:0 nt
    v_smfmac_f32_16x16x64_bf16 v[0:3], v[60:63], v[24:31], v64
    s_add_u32 s40, s26, 1048576
    s_min_u32 s40, s40, s99
    s_sub_u32 s41, s96, s40
    v_smfmac_f32_16x16x64_bf16 v[4:7], v[60:63], v[32:39], v64
    ds_read_b128 v[24:27], v70 offset:8192
    s_cmp_lt_u32 s97, s93
    s_cselect_b32 s41, s41, 0
    v_smfmac_f32_16x16x64_bf16 v[8:11], v[40:43], a[96:103], v64
    ds_read_b128 v[28:31], v70 offset:9216
    v_smfmac_f32_16x16x64_bf16 v[12:15], v[40:43], a[104:111], v64
    ds_read_b128 v[32:35], v70 offset:10240
    s_waitcnt lgkmcnt(3)
    s_barrier
    ds_read_b128 v[48:51], v67 offset:0
    v_smfmac_f32_16x16x64_bf16 v[8:11], v[60:63], a[112:119], v64
    ds_read_b128 v[36:39], v70 offset:11264
    v_bitop3_b32 v79, v73, -9, s54 bitop3:0x6a
    v_smfmac_f32_16x16x64_bf16 v[12:15], v[60:63], a[120:127], v64
    buffer_load_dwordx4 v[44:47], v65, s[4:7], s15 offen offset:0 nt
    v_smfmac_f32_16x16x64_bf16 v[16:19], v[40:43], a[232:239], v64
    ds_read_b128 v[52:55], v68 offset:0
    s_waitcnt lgkmcnt(4)
    v_bfe_u32 v77, v65, 2, 5
    v_smfmac_f32_16x16x64_bf16 v[20:23], v[40:43], v[24:31], v64
    ds_read_b128 v[24:27], v70 offset:12288
    s_waitcnt lgkmcnt(3)
    v_smfmac_f32_16x16x64_bf16 v[0:3], v[48:51], a[0:7], v64
    ds_read_b128 v[28:31], v70 offset:13312
    s_waitcnt lgkmcnt(3)
    v_add3_u32 v77, v77, s41, 16
    v_smfmac_f32_16x16x64_bf16 v[4:7], v[48:51], v[32:39], v64
    buffer_load_dwordx4 v[40:43], v65, s[4:7], s16 offen offset:0 nt
    v_smfmac_f32_16x16x64_bf16 v[16:19], v[60:63], a[240:247], v64
    ds_read_b128 v[32:35], v70 offset:14336
    v_lshlrev_b32 v78, 3, v69
    v_smfmac_f32_16x16x64_bf16 v[20:23], v[60:63], a[248:255], v64
    ds_read_b128 v[36:39], v70 offset:15360
    v_smfmac_f32_16x16x64_bf16 v[8:11], v[48:51], a[128:135], v64
    s_waitcnt vmcnt(2)
    v_mov_b32_dpp v78, v77 quad_perm:[0,1,2,3] row_mask:0xc bank_mask:0xf
    v_smfmac_f32_16x16x64_bf16 v[12:15], v[48:51], a[136:143], v64
    buffer_load_dwordx4 v[58:61], v65, s[4:7], s24 offen offset:3072 sc1
    s_waitcnt lgkmcnt(2)
    v_and_b32 v77, s36, v44
    v_smfmac_f32_16x16x64_bf16 v[12:15], v[52:55], v[24:31], v64
    ds_write_b128 v65, v[44:47] offset:4096
    v_smfmac_f32_16x16x64_bf16 v[0:3], v[52:55], a[8:15], v64
    v_cmp_ne_u32 vcc, s70, v77
    v_smfmac_f32_16x16x64_bf16 v[8:11], v[52:55], a[144:151], v64
    buffer_load_dwordx4 v[24:27], v65, s[4:7], s24 offen offset:0 sc1
    s_waitcnt lgkmcnt(1)
    v_smfmac_f32_16x16x64_bf16 v[4:7], v[52:55], v[32:39], v64
    s_cbranch_vccnz cf_spinB
cf_backB:
    v_smfmac_f32_16x16x64_bf16 v[16:19], v[44:47], v[176:183], v64
    s_waitcnt lgkmcnt(0)
    s_barrier
    ds_read_b128 v[48:51], v66 offset:4096
    v_smfmac_f32_16x16x64_bf16 v[12:15], v[44:47], a[160:167], v64
    buffer_load_dwordx4 v[28:31], v65, s[4:7], s24 offen offset:1024 sc1
    v_smfmac_f32_16x16x64_bf16 v[0:3], v[44:47], a[16:23], v64
    ds_read_b128 v[52:55], v67 offset:4096
    v_smfmac_f32_16x16x64_bf16 v[8:11], v[44:47], a[152:159], v64
    v_smfmac_f32_16x16x64_bf16 v[4:7], v[44:47], a[24:31], v64
    buffer_load_dwordx4 v[34:37], v65, s[4:7], s24 offen offset:2048 sc1
    s_waitcnt vmcnt(5)
    v_smfmac_f32_16x16x64_bf16 v[20:23], v[44:47], v[184:191], v64
    ds_read_b128 v[44:47], v68 offset:4096
    s_waitcnt lgkmcnt(2)
    v_smfmac_f32_16x16x64_bf16 v[0:3], v[48:51], a[32:39], v64
    v_smfmac_f32_16x16x64_bf16 v[8:11], v[48:51], a[168:175], v64
    buffer_load_dword v76, v78, s[4:7], s40 offen sc1
    v_smfmac_f32_16x16x64_bf16 v[4:7], v[48:51], a[40:47], v64
    s_waitcnt vmcnt(5)
    v_and_b32 v77, s36, v40
    v_smfmac_f32_16x16x64_bf16 v[12:15], v[48:51], a[176:183], v64
    ds_read_b128 v[48:51], v69 offset:15360
    s_waitcnt lgkmcnt(1)
    v_cmp_ne_u32 vcc, s70, v77
    v_smfmac_f32_16x16x64_bf16 v[0:3], v[52:55], a[48:55], v64
    v_smfmac_f32_16x16x64_bf16 v[8:11], v[52:55], a[184:191], v64
    s_cbranch_vccnz cf_spin8
cf_back8:
    v_smfmac_f32_16x16x64_bf16 v[0:3], v[44:47], a[64:71], v64
    v_smfmac_f32_16x16x64_bf16 v[8:11], v[44:47], a[200:207], v64
    v_smfmac_f32_16x16x64_bf16 v[0:3], v[40:43], a[80:87], v64
    s_nop 1
    v_smfmac_f32_16x16x64_bf16 v[8:11], v[40:43], a[216:223], v64
    s_nop 1
    v_lshrrev_b32 v77, 1, v69
    v_smfmac_f32_16x16x64_bf16 v[4:7], v[52:55], a[56:63], v64
    s_nop 1
    v_cvt_pk_bf16_f32 v0, v0, v1
    v_smfmac_f32_16x16x64_bf16 v[12:15], v[52:55], a[192:199], v64
    s_nop 1
    v_cvt_pk_bf16_f32 v1, v2, v3
    v_smfmac_f32_16x16x64_bf16 v[4:7], v[44:47], a[72:79], v64
    s_nop 1
    v_cvt_pk_bf16_f32 v2, v8, v9
    v_smfmac_f32_16x16x64_bf16 v[12:15], v[44:47], a[208:215], v64
    s_nop 1
    v_cvt_pk_bf16_f32 v3, v10, v11
    v_smfmac_f32_16x16x64_bf16 v[4:7], v[40:43], a[88:95], v64
    s_waitcnt lgkmcnt(0)
    s_nop 0
    s_nop 0
    v_smfmac_f32_16x16x64_bf16 v[12:15], v[40:43], a[224:231], v64
    s_nop 2
    v_mfma_f32_16x16x32_bf16 v[8:11], v[0:3], v[48:51], 0
    s_nop 0
    v_cvt_pk_bf16_f32 v4, v4, v5
    v_cvt_pk_bf16_f32 v5, v6, v7
    s_nop 0
    v_cvt_pk_bf16_f32 v6, v12, v13
    v_cvt_pk_bf16_f32 v7, v14, v15
    s_nop 1
    v_mfma_f32_16x16x32_bf16 v[12:15], v[4:7], v[48:51], 0
    ds_read_b128 v[48:51], v66 offset:4096
    v_cvt_pk_bf16_f32 v0, v8, v9
    v_cvt_pk_bf16_f32 v1, v10, v11
    v_smfmac_f32_16x16x64_bf16 v[16:19], v[52:55], v[208:215], v64
    s_waitcnt vmcnt(2)
    s_nop 2
    v_cvt_pk_bf16_f32 v2, v12, v13
    v_cvt_pk_bf16_f32 v3, v14, v15
    s_nop 1
    v_mfma_f32_16x16x32_bf16 v[12:15], v[0:3], v[0:3], 0
    s_nop 1
    v_bitop3_b32 v78, v73, -9, s53 bitop3:0x6a
    v_mfma_f32_16x16x32_bf16 v[4:7], v[24:27], v[0:3], 0
    ds_read_b128 v[24:27], v67 offset:0
    s_nop 1
    v_mfma_f32_16x16x32_bf16 v[8:11], v[28:31], v[0:3], 0
    s_nop 0
    v_mov_b32_dpp v12, v14 row_ror:8 row_mask:0xf bank_mask:0xc
    v_mov_b32_dpp v13, v15 row_ror:8 row_mask:0xf bank_mask:0xc
    v_smfmac_f32_16x16x64_bf16 v[20:23], v[52:55], v[216:223], v64
    ds_write_b64 v71, v[12:13]
    ds_read_b128 v[52:55], v68 offset:0
    s_nop 1
    v_mov_b32_dpp v4, v8 row_ror:8 row_mask:0xf bank_mask:0xc
    v_mov_b32_dpp v5, v9 row_ror:8 row_mask:0xf bank_mask:0xc
    v_mov_b32_dpp v6, v10 row_ror:8 row_mask:0xf bank_mask:0xc
    v_mov_b32_dpp v7, v11 row_ror:8 row_mask:0xf bank_mask:0xc
    v_smfmac_f32_16x16x64_bf16 v[16:19], v[44:47], v[224:231], v64
    ds_write_b128 v65, v[4:7] offset:8192
    v_smfmac_f32_16x16x64_bf16 v[20:23], v[44:47], v[232:239], v64
    s_waitcnt lgkmcnt(3)
    v_smfmac_f32_16x16x64_bf16 v[16:19], v[24:27], v[144:151], v64
    s_waitcnt vmcnt(1)
    v_smfmac_f32_16x16x64_bf16 v[20:23], v[24:27], v[152:159], v64
    s_mov_b64 exec, s[38:39]
    buffer_store_dword v72, v75, s[4:7], s55 offen sc1
    s_mov_b64 exec, -1
    v_smfmac_f32_16x16x64_bf16 v[16:19], v[40:43], v[240:247], v64
    s_cmp_ge_u32 s30, 56
    s_waitcnt lgkmcnt(0)
    s_barrier
    ds_read_b128 v[8:11], v66 offset:8192
    v_smfmac_f32_16x16x64_bf16 v[20:23], v[40:43], v[248:255], v64
    ds_read_b128 v[12:15], v67 offset:8192
    v_smfmac_f32_16x16x64_bf16 v[16:19], v[48:51], v[192:199], v64
    ds_read_b128 v[44:47], v68 offset:8192
    v_smfmac_f32_16x16x64_bf16 v[20:23], v[48:51], v[200:207], v64
    ds_read_b64 v[24:25], v77 offset:14336
    ds_read_b64 v[26:27], v77 offset:14592
    v_smfmac_f32_16x16x64_bf16 v[16:19], v[52:55], v[160:167], v64
    ds_read_b64 v[28:29], v77 offset:14848
    ds_read_b64 v[30:31], v77 offset:15104
    v_bitop3_b32 v77, v73, -9, s52 bitop3:0x6a
    v_smfmac_f32_16x16x64_bf16 v[20:23], v[52:55], v[168:175], v64
    s_cbranch_scc1 cf_rare
cf_rare_x:
    ds_read_b128 v[48:51], v70 offset:22528
    ds_read_b128 v[52:55], v70 offset:23552
    s_waitcnt lgkmcnt(6)
    v_pk_add_f32 v[4:5], v[4:5], v[8:9]
    v_pk_add_f32 v[6:7], v[6:7], v[10:11]
    v_pk_add_f32 v[12:13], v[12:13], v[44:45]
    v_pk_add_f32 v[14:15], v[14:15], v[46:47]
    v_pk_add_f32 v[4:5], v[4:5], v[12:13]
    v_pk_add_f32 v[6:7], v[6:7], v[14:15]
    s_waitcnt lgkmcnt(2)
    v_pk_add_f32 v[24:25], v[24:25], v[26:27]
    v_pk_add_f32 v[28:29], v[28:29], v[30:31]
    v_max3_f32 v8, v4, v5, v6
    v_pk_add_f32 v[24:25], v[24:25], v[28:29]
    v_max_f32 v8, v8, v7
    v_max3_f32 v8, v8, v24, v25
    v_cvt_pk_bf16_f32 v32, v16, v17
    v_cvt_pk_bf16_f32 v38, v18, v19
    v_max_f32_dpp v8, v8, v8 row_ror:8 row_mask:0xf bank_mask:0xf
    v_mov_b32 v9, v8
    v_cvt_pk_bf16_f32 v56, v20, v21
    v_cvt_pk_bf16_f32 v62, v22, v23
    v_permlane32_swap_b32 v8, v9
    v_max_f32 v8, v8, v9
    v_mov_b32 v9, v8
    v_mov_b32 v11, 0
    v_mov_b32 v15, 0
    v_permlane16_swap_b32 v8, v9
    v_max_f32 v8, v8, v9
    v_mul_f32 v8, s66, v8
    v_pk_fma_f32 v[4:5], v[4:5], s[44:45], v[8:9] op_sel_hi:[1,1,0]
    v_pk_fma_f32 v[6:7], v[6:7], s[44:45], v[8:9] op_sel_hi:[1,1,0]
    v_pk_fma_f32 v[24:25], v[24:25], s[44:45], v[8:9] op_sel_hi:[1,1,0]
    v_exp_f32 v4, v4
    v_exp_f32 v5, v5
    v_exp_f32 v6, v6
    v_exp_f32 v7, v7
    v_exp_f32 v24, v24
    v_exp_f32 v25, v25
    v_cvt_pk_bf16_f32 v12, v4, v5
    v_cvt_pk_bf16_f32 v13, v6, v7
    v_cvt_pk_bf16_f32 v10, v24, v25
    v_cvt_pk_bf16_f32 v14, v24, v25
    v_mov_b64 v[0:1], s[48:49]
    v_mfma_f32_16x16x32_bf16 v[4:7], v[32:35], v[10:13], 0
    ds_read_b128 v[40:43], v70 offset:20480
    v_mov_b64 v[2:3], s[50:51]
    v_mfma_f32_16x16x32_bf16 v[24:27], v[36:39], v[12:15], 0
    ds_read_b128 v[44:47], v70 offset:21504
    v_mov_b64 v[8:9], 0
    v_mfma_f32_16x16x32_bf16 v[28:31], v[0:3], v[10:13], 0
    ds_read_b128 v[32:35], v70 offset:24576
    v_mov_b64 v[0:1], 0
    v_mfma_f32_16x16x32_bf16 v[16:19], v[56:59], v[10:13], 0
    ds_read_b128 v[36:39], v70 offset:25600
    v_mov_b64 v[2:3], 0
    v_mfma_f32_16x16x32_bf16 v[20:23], v[60:63], v[12:15], 0
    ds_read_b128 v[56:59], v70 offset:28672
    v_add_f32_dpp v4, v24, v4 row_ror:8 row_mask:0xf bank_mask:0xf
    v_add_f32_dpp v5, v25, v5 row_ror:8 row_mask:0xf bank_mask:0xf
    v_add_f32_dpp v6, v26, v6 row_ror:8 row_mask:0xf bank_mask:0xf
    v_add_f32_dpp v7, v27, v7 row_ror:8 row_mask:0xf bank_mask:0xf
    v_add_f32_dpp v29, v28, v28 row_ror:8 row_mask:0xf bank_mask:0xf
    v_rcp_f32 v28, v29
    v_mov_b64 v[10:11], 0
    v_add_f32_dpp v4, v16, v20 row_ror:8 row_mask:0xf bank_mask:0xc
    v_add_f32_dpp v5, v17, v21 row_ror:8 row_mask:0xf bank_mask:0xc
    v_add_f32_dpp v6, v18, v22 row_ror:8 row_mask:0xf bank_mask:0xc
    v_add_f32_dpp v7, v19, v23 row_ror:8 row_mask:0xf bank_mask:0xc
    v_pk_mul_f32 v[4:5], v[4:5], v[28:29] op_sel_hi:[1,0]
    v_pk_mul_f32 v[6:7], v[6:7], v[28:29] op_sel_hi:[1,0]
    v_cvt_pk_bf16_f32 v4, v4, v5
    v_cvt_pk_bf16_f32 v5, v6, v7
    ds_write_b64 v73, v[4:5] offset:12288
    v_mov_b32_dpp v6, v4 row_ror:8 row_mask:0xf bank_mask:0xf
    v_mov_b32_dpp v7, v5 row_ror:8 row_mask:0xf bank_mask:0xf
    v_mov_b64 v[12:13], 0
    v_mov_b64 v[14:15], 0
    v_smfmac_f32_16x16x64_bf16 v[8:11], v[4:7], v[80:87], v64
    s_waitcnt lgkmcnt(4)
    v_mov_b64 v[24:25], 0
    v_smfmac_f32_16x16x64_bf16 v[0:3], v[4:7], v[40:47], v64
    ds_read_b128 v[60:63], v70 offset:29696
    v_mov_b64 v[26:27], 0
    v_smfmac_f32_16x16x64_bf16 v[12:15], v[4:7], v[112:119], v64
    s_waitcnt lgkmcnt(1)
    s_barrier
    ds_read_b128 v[16:19], v77 offset:12288
    v_smfmac_f32_16x16x64_bf16 v[24:27], v[4:7], v[48:55], v64
    ds_read_b128 v[20:23], v78 offset:12288
    ds_read_b128 v[28:31], v79 offset:12288
    v_mov_b64 v[4:5], 0
    v_mov_b64 v[6:7], 0
    v_bfe_u32 v77, v74, 16, 1
    v_mad_i32_i24 v77, v77, s56, v74
    s_waitcnt lgkmcnt(2)
    v_smfmac_f32_16x16x64_bf16 v[8:11], v[16:19], v[88:95], v64
    ds_read_b128 v[40:43], v70 offset:32768
    s_waitcnt lgkmcnt(2)
    v_smfmac_f32_16x16x64_bf16 v[8:11], v[20:23], v[96:103], v64
    ds_read_b128 v[44:47], v70 offset:33792
    s_waitcnt lgkmcnt(2)
    v_smfmac_f32_16x16x64_bf16 v[8:11], v[28:31], v[104:111], v64
    ds_read_b128 v[48:51], v70 offset:26624
    s_nop 0
    v_and_b32 v72, 8, v73
    v_smfmac_f32_16x16x64_bf16 v[0:3], v[16:19], v[32:39], v64
    ds_read_b128 v[52:55], v70 offset:27648
    s_nop 0
    v_mad_u32_u24 v72, v72, 63, v73
    v_smfmac_f32_16x16x64_bf16 v[12:15], v[16:19], v[120:127], v64
    ds_read_b128 v[32:35], v70 offset:30720
    v_cvt_pk_bf16_f32 v8, v8, v9
    v_cvt_pk_bf16_f32 v9, v10, v11
    v_and_or_b32 v8, v8, -2, s69
    v_smfmac_f32_16x16x64_bf16 v[12:15], v[20:23], v[128:135], v64
    buffer_store_dwordx2 v[8:9], v74, s[4:7], s22 offen offset:0
    ds_read_b128 v[36:39], v70 offset:31744
    v_smfmac_f32_16x16x64_bf16 v[12:15], v[28:31], v[136:143], v64
    s_add_u32 s30, s30, 1
    s_xor_b32 s70, s70, 1
    v_subrev_u32 v72, s47, v72
    v_smfmac_f32_16x16x64_bf16 v[0:3], v[20:23], v[56:63], v64
    ds_read_b128 v[56:59], v70 offset:34816
    s_waitcnt lgkmcnt(3)
    s_nop 0
    v_smfmac_f32_16x16x64_bf16 v[0:3], v[28:31], v[40:47], v64
    ds_read_b128 v[60:63], v70 offset:35840
    v_cvt_pk_bf16_f32 v12, v12, v13
    v_cvt_pk_bf16_f32 v13, v14, v15
    v_and_or_b32 v12, v12, -2, s69
    v_smfmac_f32_16x16x64_bf16 v[24:27], v[16:19], v[48:55], v64
    buffer_store_dwordx2 v[12:13], v74, s[4:7], s22 offen offset:64
    s_waitcnt lgkmcnt(2)
    v_smfmac_f32_16x16x64_bf16 v[24:27], v[20:23], v[32:39], v64
    ds_read_b128 v[40:43], v70 offset:16384
    v_cvt_pk_bf16_f32 v0, v0, v1
    v_cvt_pk_bf16_f32 v1, v2, v3
    v_and_or_b32 v0, v0, -2, s69
    s_waitcnt lgkmcnt(1)
    v_smfmac_f32_16x16x64_bf16 v[24:27], v[28:31], v[56:63], v64
    buffer_store_dwordx2 v[0:1], v74, s[4:7], s23 offen offset:0
    ds_read_b128 v[44:47], v70 offset:17408
    ds_read_b128 v[8:11], v72 offset:12288
    ds_read_b128 v[48:51], v70 offset:18432
    ds_read_b128 v[52:55], v70 offset:19456
    ds_read_b128 v[12:15], v72 offset:13312
    s_cmp_lg_u32 s71, 0
    s_nop 0
    v_cvt_pk_bf16_f32 v24, v24, v25
    v_cvt_pk_bf16_f32 v25, v26, v27
    v_and_or_b32 v24, v24, -2, s69
    buffer_store_dwordx2 v[24:25], v74, s[4:7], s23 offen offset:64
    s_waitcnt lgkmcnt(3)
    v_smfmac_f32_16x16x64_bf16 v[4:7], v[8:11], v[40:47], v64
    s_waitcnt lgkmcnt(0)
    v_smfmac_f32_16x16x64_bf16 v[4:7], v[12:15], v[48:55], v64
    s_nop 7
    v_cvt_pk_bf16_f32 v4, v4, v5
    v_cvt_pk_bf16_f32 v5, v6, v7
    v_and_or_b32 v4, v4, -2, s69
    buffer_store_dwordx2 v[4:5], v77, s[4:7], s25 offen offset:0
    s_nop 0
    s_cbranch_scc1 cf_e1
    s_cmp_lg_u32 s37, 0
    s_cbranch_scc1 cf_f0_xt
cf_f0_xtx:
    s_nop 2
    v_mov_b32 v79, v79
    s_nop 2
    v_mov_b32 v79, v79
    s_nop 2
    v_mov_b32 v79, v79
    s_nop 2
    v_mov_b32 v79, v79
    s_nop 2
    v_mov_b32 v79, v79
    buffer_load_dwordx4 v[8:11], v65, s[4:7], s18 offen nt
    buffer_load_dwordx4 v[12:15], v65, s[4:7], s19 offen nt
    buffer_load_dwordx4 v[16:19], v65, s[4:7], s20 offen nt
    buffer_load_dwordx4 v[20:23], v65, s[4:7], s21 offen nt
    v_and_b32 v77, 255, v69
    ds_read_b128 v[4:7], v77 offset:15872
    ds_read_b128 v[44:47], v70 offset:0
    ds_read_b128 v[48:51], v70 offset:1024
    ds_read_b128 v[52:55], v70 offset:2048
    ds_read_b128 v[56:59], v70 offset:3072
    ds_read_b128 v[24:27], v70 offset:4096
    ds_read_b128 v[28:31], v70 offset:5120
    ds_read_b128 v[32:35], v70 offset:6144
    ds_read_b128 v[36:39], v70 offset:7168
    s_mov_b32 s31, 65536
    s_add_u32 s24, s24, 524288
    s_add_u32 s26, s26, 524288
    s_add_u32 s55, s55, s57
    s_mov_b32 s14, 67108864
    s_mov_b32 s15, 67112960
    s_mov_b32 s16, 67117056
    s_mov_b32 s36, 1
    v_mov_b32 v40, s69
    v_mov_b32 v60, s69
    v_and_b32 v79, 12, v75
    v_cmp_eq_u32 vcc, 0, v79
    s_nop 1
    v_cndmask_b32 v79, 0, 1, vcc
    s_waitcnt lgkmcnt(0)
    s_waitcnt vmcnt(3)
    v_bitop3_b32 v77, v8, v10, s69 bitop3:0x7e
    v_mfma_f32_16x16x32_bf16 v[0:3], v[4:7], v[8:11], 0
    v_mov_b64 v[8:9], 0
    v_mov_b64 v[10:11], 0
    s_waitcnt vmcnt(2)
    v_bitop3_b32 v78, v12, v14, s69 bitop3:0x7e
    v_mfma_f32_16x16x32_bf16 v[0:3], v[4:7], v[12:15], v[0:3]
    v_or_b32 v77, v77, v78
    v_mov_b64 v[12:13], 0
    v_mov_b64 v[14:15], 0
    s_waitcnt vmcnt(1)
    v_bitop3_b32 v78, v16, v18, s69 bitop3:0x7e
    v_mfma_f32_16x16x32_bf16 v[0:3], v[4:7], v[16:19], v[0:3]
    v_or_b32 v77, v77, v78
    v_mov_b64 v[16:17], 0
    v_mov_b64 v[18:19], 0
    s_waitcnt vmcnt(0)
    v_bitop3_b32 v78, v20, v22, s69 bitop3:0x7e
    v_mfma_f32_16x16x32_bf16 v[0:3], v[4:7], v[20:23], v[0:3]
    v_bitop3_b32 v77, v77, v78, 1 bitop3:0xa8
    v_cmp_ne_u32 vcc, 0, v77
    v_mov_b64 v[20:21], 0
    v_mov_b64 v[22:23], 0
    s_cmp_eq_u64 vcc, 0
    s_cselect_b64 s[42:43], -1, 0
    s_nop 1
    v_add_f32_dpp v0, v0, v0 row_ror:8 row_mask:0xf bank_mask:0xf
    v_add_f32_dpp v1, v1, v1 row_ror:8 row_mask:0xf bank_mask:0xf
    s_mov_b64 exec, s[42:43]
    v_cvt_pk_bf16_f32 v72, v0, v1
    v_bfi_b32 v72, v79, s70, v72
    buffer_store_dword v72, v75, s[4:7], s17 offen offset:0
    s_mov_b64 exec, -1
    s_cbranch_scc0 cf_f0_retry
cf_f0_go:
    v_mov_b64 v[0:1], 0
    v_mov_b64 v[2:3], 0
    v_mov_b64 v[4:5], 0
    v_mov_b64 v[6:7], 0
    s_nop 2
    v_mov_b32 v79, v79
    s_nop 2
    v_mov_b32 v79, v79
    s_nop 2
    v_mov_b32 v79, v79
    s_nop 2
    v_mov_b32 v79, v79
    s_branch cf_loop
cf_e1:
    s_cmp_lg_u32 s71, 2
    s_cbranch_scc1 cf_f1
    v_and_b32 v77, 255, v69
    ds_read_b128 v[4:7], v77 offset:15872
    ds_read_b128 v[44:47], v70 offset:0
    ds_read_b128 v[48:51], v70 offset:1024
    ds_read_b128 v[52:55], v70 offset:2048
    ds_read_b128 v[56:59], v70 offset:3072
    ds_read_b128 v[24:27], v70 offset:4096
    ds_read_b128 v[28:31], v70 offset:5120
    ds_read_b128 v[32:35], v70 offset:6144
    ds_read_b128 v[36:39], v70 offset:7168
    s_mov_b32 s31, 65536
    s_add_u32 s24, s24, 524288
    s_add_u32 s26, s26, 524288
    s_add_u32 s55, s55, s57
    s_mov_b32 s14, 67108864
    s_mov_b32 s15, 67112960
    s_mov_b32 s16, 67117056
    s_mov_b32 s36, 1
    v_mov_b32 v40, s69
    v_mov_b32 v60, s69
    v_and_b32 v79, 12, v75
    v_cmp_eq_u32 vcc, 0, v79
    s_nop 1
    v_cndmask_b32 v79, 0, 1, vcc
    s_cmp_lg_u32 s37, 0
    s_cbranch_scc1 cf_f2_xt
cf_f2_xtx:
    s_nop 2
    v_mov_b32 v79, v79
    s_nop 2
    v_mov_b32 v79, v79
    s_nop 2
    v_mov_b32 v79, v79
    s_nop 2
    v_mov_b32 v79, v79
    s_nop 2
    v_mov_b32 v79, v79
    s_nop 2
    v_mov_b32 v79, v79
    s_nop 2
    v_mov_b32 v79, v79
    s_nop 2
    v_mov_b32 v79, v79
    s_waitcnt vmcnt(0)
    buffer_load_dwordx4 v[8:11], v65, s[4:7], s18 offen nt
    buffer_load_dwordx4 v[12:15], v65, s[4:7], s19 offen nt
    buffer_load_dwordx4 v[16:19], v65, s[4:7], s20 offen nt
    buffer_load_dwordx4 v[20:23], v65, s[4:7], s21 offen nt
    s_nop 2
    v_mov_b32 v79, v79
    s_nop 2
    v_mov_b32 v79, v79
    s_nop 2
    v_mov_b32 v79, v79
    s_nop 2
    v_mov_b32 v79, v79
    s_nop 2
    v_mov_b32 v79, v79
    s_nop 2
    v_mov_b32 v79, v79
    s_nop 2
    v_mov_b32 v79, v79
    s_nop 2
    v_mov_b32 v79, v79
    s_nop 2
    v_mov_b32 v79, v79
    s_nop 2
    v_mov_b32 v79, v79
    buffer_load_dwordx4 v[40:43], v65, s[4:7], s14 offen offset:0 nt
    buffer_load_dwordx4 v[60:63], v66, s[4:7], s14 offen offset:0 nt
    s_waitcnt lgkmcnt(0)
    s_waitcnt vmcnt(5)
    v_bitop3_b32 v77, v8, v10, s69 bitop3:0x7e
    v_mfma_f32_16x16x32_bf16 v[0:3], v[4:7], v[8:11], 0
    v_mov_b64 v[8:9], 0
    v_mov_b64 v[10:11], 0
    s_waitcnt vmcnt(4)
    v_bitop3_b32 v78, v12, v14, s69 bitop3:0x7e
    v_mfma_f32_16x16x32_bf16 v[0:3], v[4:7], v[12:15], v[0:3]
    v_or_b32 v77, v77, v78
    v_mov_b64 v[12:13], 0
    v_mov_b64 v[14:15], 0
    s_waitcnt vmcnt(3)
    v_bitop3_b32 v78, v16, v18, s69 bitop3:0x7e
    v_mfma_f32_16x16x32_bf16 v[0:3], v[4:7], v[16:19], v[0:3]
    v_or_b32 v77, v77, v78
    v_mov_b64 v[16:17], 0
    v_mov_b64 v[18:19], 0
    s_waitcnt vmcnt(2)
    v_bitop3_b32 v78, v20, v22, s69 bitop3:0x7e
    v_mfma_f32_16x16x32_bf16 v[0:3], v[4:7], v[20:23], v[0:3]
    v_bitop3_b32 v77, v77, v78, 1 bitop3:0xa8
    v_cmp_ne_u32 vcc, 0, v77
    v_mov_b64 v[20:21], 0
    v_mov_b64 v[22:23], 0
    buffer_load_dwordx4 v[40:43], v65, s[4:7], s14 offen offset:0 nt
    buffer_load_dwordx4 v[60:63], v66, s[4:7], s14 offen offset:0 nt
    s_cmp_eq_u64 vcc, 0
    s_cselect_b64 s[42:43], -1, 0
    v_add_f32_dpp v0, v0, v0 row_ror:4 row_mask:0xf bank_mask:0xf
    v_add_f32_dpp v1, v1, v1 row_ror:4 row_mask:0xf bank_mask:0xf
    s_nop 0
    v_add_f32_dpp v0, v0, v0 row_ror:8 row_mask:0xf bank_mask:0xf
    v_add_f32_dpp v1, v1, v1 row_ror:8 row_mask:0xf bank_mask:0xf
    s_mov_b64 exec, s[42:43]
    v_cvt_pk_bf16_f32 v72, v0, v1
    v_bfi_b32 v72, v79, s70, v72
    buffer_store_dword v72, v75, s[4:7], s17 offen offset:0
    buffer_store_dword v72, v75, s[4:7], s17 offen offset:1024
    buffer_store_dword v72, v75, s[4:7], s17 offen offset:2048
    buffer_store_dword v72, v75, s[4:7], s17 offen offset:3072
    s_mov_b64 exec, -1
    s_cbranch_scc0 cf_f2_retry
cf_f2_go:
    v_mov_b64 v[0:1], 0
    v_mov_b64 v[2:3], 0
    v_mov_b64 v[4:5], 0
    v_mov_b64 v[6:7], 0
    s_branch cf_loop
cf_f1:
    s_cmp_lg_u32 s32, 1
    s_cbranch_scc1 cf_f3
    v_and_b32 v77, 255, v69
    ds_read_b128 v[4:7], v77 offset:15872
    ds_read_b128 v[44:47], v70 offset:0
    ds_read_b128 v[48:51], v70 offset:1024
    ds_read_b128 v[52:55], v70 offset:2048
    ds_read_b128 v[56:59], v70 offset:3072
    ds_read_b128 v[24:27], v70 offset:4096
    ds_read_b128 v[28:31], v70 offset:5120
    ds_read_b128 v[32:35], v70 offset:6144
    ds_read_b128 v[36:39], v70 offset:7168
    s_mov_b32 s31, 65536
    s_add_u32 s24, s24, 524288
    s_add_u32 s26, s26, 524288
    s_add_u32 s55, s55, s57
    s_mov_b32 s14, 67108864
    s_mov_b32 s15, 67112960
    s_mov_b32 s16, 67117056
    s_mov_b32 s36, 1
    v_mov_b32 v40, s69
    v_mov_b32 v60, s69
    v_and_b32 v79, 12, v75
    v_cmp_eq_u32 vcc, 0, v79
    s_nop 1
    v_cndmask_b32 v79, 0, 1, vcc
    s_cmp_lg_u32 s37, 0
    s_cbranch_scc1 cf_f1_xt
cf_f1_xtx:
    s_nop 2
    v_mov_b32 v79, v79
    s_waitcnt vmcnt(0)
    buffer_load_dwordx4 v[8:11], v65, s[4:7], s18 offen nt
    buffer_load_dwordx4 v[12:15], v65, s[4:7], s19 offen nt
    buffer_load_dwordx4 v[16:19], v65, s[4:7], s20 offen nt
    buffer_load_dwordx4 v[20:23], v65, s[4:7], s21 offen nt
    s_nop 2
    v_mov_b32 v79, v79
    s_nop 2
    v_mov_b32 v79, v79
    s_nop 2
    v_mov_b32 v79, v79
    s_nop 2
    v_mov_b32 v79, v79
    s_nop 2
    v_mov_b32 v79, v79
    s_nop 2
    v_mov_b32 v79, v79
    s_nop 2
    v_mov_b32 v79, v79
    s_nop 2
    v_mov_b32 v79, v79
    s_nop 2
    v_mov_b32 v79, v79
    s_nop 2
    v_mov_b32 v79, v79
    buffer_load_dwordx4 v[40:43], v65, s[4:7], s14 offen offset:0 nt
    buffer_load_dwordx4 v[60:63], v66, s[4:7], s14 offen offset:0 nt
    s_waitcnt lgkmcnt(0)
    s_waitcnt vmcnt(5)
    v_bitop3_b32 v77, v8, v10, s69 bitop3:0x7e
    v_mfma_f32_16x16x32_bf16 v[0:3], v[4:7], v[8:11], 0
    v_mov_b64 v[8:9], 0
    v_mov_b64 v[10:11], 0
    s_waitcnt vmcnt(4)
    v_bitop3_b32 v78, v12, v14, s69 bitop3:0x7e
    v_mfma_f32_16x16x32_bf16 v[0:3], v[4:7], v[12:15], v[0:3]
    v_or_b32 v77, v77, v78
    v_mov_b64 v[12:13], 0
    v_mov_b64 v[14:15], 0
    s_waitcnt vmcnt(3)
    v_bitop3_b32 v78, v16, v18, s69 bitop3:0x7e
    v_mfma_f32_16x16x32_bf16 v[0:3], v[4:7], v[16:19], v[0:3]
    v_or_b32 v77, v77, v78
    v_mov_b64 v[16:17], 0
    v_mov_b64 v[18:19], 0
    s_waitcnt vmcnt(2)
    v_bitop3_b32 v78, v20, v22, s69 bitop3:0x7e
    v_mfma_f32_16x16x32_bf16 v[0:3], v[4:7], v[20:23], v[0:3]
    v_bitop3_b32 v77, v77, v78, 1 bitop3:0xa8
    v_cmp_ne_u32 vcc, 0, v77
    v_mov_b64 v[20:21], 0
    v_mov_b64 v[22:23], 0
    buffer_load_dwordx4 v[40:43], v65, s[4:7], s14 offen offset:0 nt
    buffer_load_dwordx4 v[60:63], v66, s[4:7], s14 offen offset:0 nt
    s_cmp_eq_u64 vcc, 0
    s_cselect_b64 s[42:43], -1, 0
    v_add_f32_dpp v0, v0, v0 row_ror:8 row_mask:0xf bank_mask:0xf
    v_add_f32_dpp v1, v1, v1 row_ror:8 row_mask:0xf bank_mask:0xf
    s_mov_b64 exec, s[42:43]
    v_cvt_pk_bf16_f32 v72, v0, v1
    v_bfi_b32 v72, v79, s70, v72
    buffer_store_dword v72, v75, s[4:7], s17 offen offset:0
    s_mov_b64 exec, -1
    s_cbranch_scc0 cf_f1_retry
cf_f1_go:
    v_mov_b64 v[0:1], 0
    v_mov_b64 v[2:3], 0
    v_mov_b64 v[4:5], 0
    v_mov_b64 v[6:7], 0
    s_branch cf_loop
cf_f3:
    v_and_b32 v77, 255, v69
    ds_read_b128 v[4:7], v77 offset:15872
    ds_read_b128 v[44:47], v70 offset:0
    ds_read_b128 v[48:51], v70 offset:1024
    ds_read_b128 v[52:55], v70 offset:2048
    ds_read_b128 v[56:59], v70 offset:3072
    ds_read_b128 v[24:27], v70 offset:4096
    ds_read_b128 v[28:31], v70 offset:5120
    ds_read_b128 v[32:35], v70 offset:6144
    ds_read_b128 v[36:39], v70 offset:7168
    s_mov_b32 s31, 65536
    s_add_u32 s24, s24, 524288
    s_add_u32 s26, s26, 524288
    s_add_u32 s55, s55, s57
    s_mov_b32 s14, 67108864
    s_mov_b32 s15, 67112960
    s_mov_b32 s16, 67117056
    s_mov_b32 s36, 1
    v_mov_b32 v40, s69
    v_mov_b32 v60, s69
    v_and_b32 v79, 12, v75
    v_cmp_eq_u32 vcc, 0, v79
    s_nop 1
    v_cndmask_b32 v79, 0, 1, vcc
    s_add_u32 s40, s30, s95
    v_mov_b32 v72, s40
    s_waitcnt lgkmcnt(0)
    v_mov_b64 v[0:1], 0
    v_mov_b64 v[2:3], 0
    v_mov_b64 v[4:5], 0
    v_mov_b64 v[6:7], 0
    v_mov_b64 v[8:9], 0
    v_mov_b64 v[10:11], 0
    v_mov_b64 v[12:13], 0
    v_mov_b64 v[14:15], 0
    v_mov_b64 v[16:17], 0
    v_mov_b64 v[18:19], 0
    v_mov_b64 v[20:21], 0
    v_mov_b64 v[22:23], 0
    s_nop 2
    v_mov_b32 v79, v79
    s_nop 2
    v_mov_b32 v79, v79
    s_nop 2
    v_mov_b32 v79, v79
    s_nop 2
    v_mov_b32 v79, v79
    s_nop 2
    v_mov_b32 v79, v79
    s_nop 2
    v_mov_b32 v79, v79
    s_nop 2
    v_mov_b32 v79, v79
    s_nop 2
    v_mov_b32 v79, v79
    s_nop 2
    v_mov_b32 v79, v79
    s_waitcnt vmcnt(0)
    s_cmp_lt_u32 s97, s93
    s_cbranch_scc1 cf_kvwait
    s_nop 2
    v_mov_b32 v79, v79
    s_nop 2
    v_mov_b32 v79, v79
    s_nop 2
    v_mov_b32 v79, v79
    s_nop 2
    v_mov_b32 v79, v79
    s_nop 2
    v_mov_b32 v79, v79
    s_nop 2
    v_mov_b32 v79, v79
    s_nop 2
    v_mov_b32 v79, v79
    s_nop 2
    v_mov_b32 v79, v79
cf_kvok:
    s_branch cf_loop
cf_f0_xt:
    s_sub_u32 s37, s37, 1
    s_nop 2
    v_mov_b32 v79, v79
    s_nop 2
    v_mov_b32 v79, v79
    s_nop 2
    v_mov_b32 v79, v79
    s_nop 2
    v_mov_b32 v79, v79
    s_nop 2
    v_mov_b32 v79, v79
    s_nop 2
    v_mov_b32 v79, v79
    s_branch cf_f0_xtx
cf_f0_retry:
    s_sub_u32 s41, s30, s98
    s_mov_b32 s98, s30
    s_cmp_le_u32 s41, 3
    s_cselect_b32 s37, 1, 1
cf_f0_spin:
    buffer_load_dwordx4 v[8:11], v65, s[4:7], s18 offen nt
    buffer_load_dwordx4 v[12:15], v65, s[4:7], s19 offen nt
    buffer_load_dwordx4 v[16:19], v65, s[4:7], s20 offen nt
    buffer_load_dwordx4 v[20:23], v65, s[4:7], s21 offen nt
    s_nop 2
    v_mov_b32 v79, v79
    s_nop 2
    v_mov_b32 v79, v79
    s_nop 2
    v_mov_b32 v79, v79
    buffer_load_dwordx4 v[40:43], v65, s[4:7], s14 offen offset:0 nt
    buffer_load_dwordx4 v[60:63], v66, s[4:7], s14 offen offset:0 nt
    s_waitcnt vmcnt(5)
    v_bitop3_b32 v77, v8, v10, s69 bitop3:0x7e
    v_mfma_f32_16x16x32_bf16 v[0:3], v[4:7], v[8:11], 0
    v_mov_b64 v[8:9], 0
    v_mov_b64 v[10:11], 0
    s_waitcnt vmcnt(4)
    v_bitop3_b32 v78, v12, v14, s69 bitop3:0x7e
    v_mfma_f32_16x16x32_bf16 v[0:3], v[4:7], v[12:15], v[0:3]
    v_or_b32 v77, v77, v78
    v_mov_b64 v[12:13], 0
    v_mov_b64 v[14:15], 0
    s_waitcnt vmcnt(3)
    v_bitop3_b32 v78, v16, v18, s69 bitop3:0x7e
    v_mfma_f32_16x16x32_bf16 v[0:3], v[4:7], v[16:19], v[0:3]
    v_or_b32 v77, v77, v78
    v_mov_b64 v[16:17], 0
    v_mov_b64 v[18:19], 0
    s_waitcnt vmcnt(2)
    v_bitop3_b32 v78, v20, v22, s69 bitop3:0x7e
    v_mfma_f32_16x16x32_bf16 v[0:3], v[4:7], v[20:23], v[0:3]
    v_bitop3_b32 v77, v77, v78, 1 bitop3:0xa8
    v_cmp_ne_u32 vcc, 0, v77
    v_mov_b64 v[20:21], 0
    v_mov_b64 v[22:23], 0
    buffer_load_dwordx4 v[40:43], v65, s[4:7], s14 offen offset:0 nt
    buffer_load_dwordx4 v[60:63], v66, s[4:7], s14 offen offset:0 nt
    s_cmp_eq_u64 vcc, 0
    s_cselect_b64 s[42:43], -1, 0
    v_add_f32_dpp v0, v0, v0 row_ror:8 row_mask:0xf bank_mask:0xf
    v_add_f32_dpp v1, v1, v1 row_ror:8 row_mask:0xf bank_mask:0xf
    s_mov_b64 exec, s[42:43]
    v_cvt_pk_bf16_f32 v72, v0, v1
    v_bfi_b32 v72, v79, s70, v72
    buffer_store_dword v72, v75, s[4:7], s17 offen offset:0
    s_mov_b64 exec, -1
    s_cbranch_scc1 cf_f0_rx
    s_sub_u32 s31, s31, 1
    s_cbranch_scc0 cf_f0_spin
cf_f0_rx:
    v_mov_b64 v[0:1], 0
    v_mov_b64 v[2:3], 0
    v_mov_b64 v[4:5], 0
    v_mov_b64 v[6:7], 0
    s_branch cf_loop
cf_f1_xt:
    s_sub_u32 s37, s37, 1
    s_nop 2
    v_mov_b32 v79, v79
    s_nop 2
    v_mov_b32 v79, v79
    s_nop 2
    v_mov_b32 v79, v79
    s_nop 2
    v_mov_b32 v79, v79
    s_nop 2
    v_mov_b32 v79, v79
    s_nop 2
    v_mov_b32 v79, v79
    s_branch cf_f1_xtx
cf_f1_retry:
    s_sub_u32 s41, s30, s98
    s_mov_b32 s98, s30
    s_cmp_le_u32 s41, 3
    s_cselect_b32 s37, 1, 1
cf_f1_spin:
    buffer_load_dwordx4 v[8:11], v65, s[4:7], s18 offen nt
    buffer_load_dwordx4 v[12:15], v65, s[4:7], s19 offen nt
    buffer_load_dwordx4 v[16:19], v65, s[4:7], s20 offen nt
    buffer_load_dwordx4 v[20:23], v65, s[4:7], s21 offen nt
    s_nop 2
    v_mov_b32 v79, v79
    s_nop 2
    v_mov_b32 v79, v79
    s_nop 2
    v_mov_b32 v79, v79
    buffer_load_dwordx4 v[40:43], v65, s[4:7], s14 offen offset:0 nt
    buffer_load_dwordx4 v[60:63], v66, s[4:7], s14 offen offset:0 nt
    s_waitcnt vmcnt(5)
    v_bitop3_b32 v77, v8, v10, s69 bitop3:0x7e
    v_mfma_f32_16x16x32_bf16 v[0:3], v[4:7], v[8:11], 0
    v_mov_b64 v[8:9], 0
    v_mov_b64 v[10:11], 0
    s_waitcnt vmcnt(4)
    v_bitop3_b32 v78, v12, v14, s69 bitop3:0x7e
    v_mfma_f32_16x16x32_bf16 v[0:3], v[4:7], v[12:15], v[0:3]
    v_or_b32 v77, v77, v78
    v_mov_b64 v[12:13], 0
    v_mov_b64 v[14:15], 0
    s_waitcnt vmcnt(3)
    v_bitop3_b32 v78, v16, v18, s69 bitop3:0x7e
    v_mfma_f32_16x16x32_bf16 v[0:3], v[4:7], v[16:19], v[0:3]
    v_or_b32 v77, v77, v78
    v_mov_b64 v[16:17], 0
    v_mov_b64 v[18:19], 0
    s_waitcnt vmcnt(2)
    v_bitop3_b32 v78, v20, v22, s69 bitop3:0x7e
    v_mfma_f32_16x16x32_bf16 v[0:3], v[4:7], v[20:23], v[0:3]
    v_bitop3_b32 v77, v77, v78, 1 bitop3:0xa8
    v_cmp_ne_u32 vcc, 0, v77
    v_mov_b64 v[20:21], 0
    v_mov_b64 v[22:23], 0
    buffer_load_dwordx4 v[40:43], v65, s[4:7], s14 offen offset:0 nt
    buffer_load_dwordx4 v[60:63], v66, s[4:7], s14 offen offset:0 nt
    s_cmp_eq_u64 vcc, 0
    s_cselect_b64 s[42:43], -1, 0
    v_add_f32_dpp v0, v0, v0 row_ror:8 row_mask:0xf bank_mask:0xf
    v_add_f32_dpp v1, v1, v1 row_ror:8 row_mask:0xf bank_mask:0xf
    s_mov_b64 exec, s[42:43]
    v_cvt_pk_bf16_f32 v72, v0, v1
    v_bfi_b32 v72, v79, s70, v72
    buffer_store_dword v72, v75, s[4:7], s17 offen offset:0
    s_mov_b64 exec, -1
    s_cbranch_scc1 cf_f1_rx
    s_sub_u32 s31, s31, 1
    s_cbranch_scc0 cf_f1_spin
cf_f1_rx:
    v_mov_b64 v[0:1], 0
    v_mov_b64 v[2:3], 0
    v_mov_b64 v[4:5], 0
    v_mov_b64 v[6:7], 0
    s_branch cf_loop
cf_f2_xt:
    s_sub_u32 s37, s37, 1
    s_nop 2
    v_mov_b32 v79, v79
    s_nop 2
    v_mov_b32 v79, v79
    s_nop 2
    v_mov_b32 v79, v79
    s_nop 2
    v_mov_b32 v79, v79
    s_nop 2
    v_mov_b32 v79, v79
    s_nop 2
    v_mov_b32 v79, v79
    s_branch cf_f2_xtx
cf_f2_retry:
    s_sub_u32 s41, s30, s98
    s_mov_b32 s98, s30
    s_cmp_le_u32 s41, 3
    s_cselect_b32 s37, 1, 1
cf_f2_spin:
    buffer_load_dwordx4 v[8:11], v65, s[4:7], s18 offen nt
    buffer_load_dwordx4 v[12:15], v65, s[4:7], s19 offen nt
    buffer_load_dwordx4 v[16:19], v65, s[4:7], s20 offen nt
    buffer_load_dwordx4 v[20:23], v65, s[4:7], s21 offen nt
    s_nop 2
    v_mov_b32 v79, v79
    s_nop 2
    v_mov_b32 v79, v79
    s_nop 2
    v_mov_b32 v79, v79
    buffer_load_dwordx4 v[40:43], v65, s[4:7], s14 offen offset:0 nt
    buffer_load_dwordx4 v[60:63], v66, s[4:7], s14 offen offset:0 nt
    s_waitcnt vmcnt(5)
    v_bitop3_b32 v77, v8, v10, s69 bitop3:0x7e
    v_mfma_f32_16x16x32_bf16 v[0:3], v[4:7], v[8:11], 0
    v_mov_b64 v[8:9], 0
    v_mov_b64 v[10:11], 0
    s_waitcnt vmcnt(4)
    v_bitop3_b32 v78, v12, v14, s69 bitop3:0x7e
    v_mfma_f32_16x16x32_bf16 v[0:3], v[4:7], v[12:15], v[0:3]
    v_or_b32 v77, v77, v78
    v_mov_b64 v[12:13], 0
    v_mov_b64 v[14:15], 0
    s_waitcnt vmcnt(3)
    v_bitop3_b32 v78, v16, v18, s69 bitop3:0x7e
    v_mfma_f32_16x16x32_bf16 v[0:3], v[4:7], v[16:19], v[0:3]
    v_or_b32 v77, v77, v78
    v_mov_b64 v[16:17], 0
    v_mov_b64 v[18:19], 0
    s_waitcnt vmcnt(2)
    v_bitop3_b32 v78, v20, v22, s69 bitop3:0x7e
    v_mfma_f32_16x16x32_bf16 v[0:3], v[4:7], v[20:23], v[0:3]
    v_bitop3_b32 v77, v77, v78, 1 bitop3:0xa8
    v_cmp_ne_u32 vcc, 0, v77
    v_mov_b64 v[20:21], 0
    v_mov_b64 v[22:23], 0
    buffer_load_dwordx4 v[40:43], v65, s[4:7], s14 offen offset:0 nt
    buffer_load_dwordx4 v[60:63], v66, s[4:7], s14 offen offset:0 nt
    s_cmp_eq_u64 vcc, 0
    s_cselect_b64 s[42:43], -1, 0
    v_add_f32_dpp v0, v0, v0 row_ror:4 row_mask:0xf bank_mask:0xf
    v_add_f32_dpp v1, v1, v1 row_ror:4 row_mask:0xf bank_mask:0xf
    s_nop 0
    v_add_f32_dpp v0, v0, v0 row_ror:8 row_mask:0xf bank_mask:0xf
    v_add_f32_dpp v1, v1, v1 row_ror:8 row_mask:0xf bank_mask:0xf
    s_mov_b64 exec, s[42:43]
    v_cvt_pk_bf16_f32 v72, v0, v1
    v_bfi_b32 v72, v79, s70, v72
    buffer_store_dword v72, v75, s[4:7], s17 offen offset:0
    buffer_store_dword v72, v75, s[4:7], s17 offen offset:1024
    buffer_store_dword v72, v75, s[4:7], s17 offen offset:2048
    buffer_store_dword v72, v75, s[4:7], s17 offen offset:3072
    s_mov_b64 exec, -1
    s_cbranch_scc1 cf_f2_rx
    s_sub_u32 s31, s31, 1
    s_cbranch_scc0 cf_f2_spin
cf_f2_rx:
    v_mov_b64 v[0:1], 0
    v_mov_b64 v[2:3], 0
    v_mov_b64 v[4:5], 0
    v_mov_b64 v[6:7], 0
    s_branch cf_loop
cf_spinB:
    s_waitcnt vmcnt(3)
cf_spinB_l:
    v_and_b32 v77, s36, v44
    v_cmp_ne_u32 vcc, s70, v77
    s_cbranch_vccz cf_spinB_x
    buffer_load_dwordx4 v[44:47], v65, s[4:7], s15 offen nt
    s_sub_u32 s31, s31, 16
    s_waitcnt vmcnt(0)
    s_cbranch_scc0 cf_spinB_l
cf_spinB_x:
    ds_write_b128 v65, v[44:47] offset:4096
    s_waitcnt lgkmcnt(0)
    s_branch cf_backB
cf_spin8:
    buffer_load_dwordx4 v[40:43], v65, s[4:7], s16 offen nt
cf_spin8_l:
    v_and_b32 v77, s36, v40
    v_cmp_ne_u32 vcc, s70, v77
    s_cbranch_vccz cf_spin8_x
    s_nop 1
    v_and_b32 v77, s36, v40
    v_cmp_ne_u32 vcc, s70, v77
    s_cbranch_vccz cf_spin8_x
    s_nop 1
    v_and_b32 v77, s36, v40
    v_cmp_ne_u32 vcc, s70, v77
    s_cbranch_vccz cf_spin8_x
    s_nop 1
    buffer_load_dwordx4 v[40:43], v65, s[4:7], s16 offen nt
    s_sub_u32 s31, s31, 16
    s_cbranch_scc0 cf_spin8_l
cf_spin8_x:
    s_branch cf_back8
cf_rare:
    s_mov_b64 exec, s[34:35]
    buffer_store_dwordx4 v[0:3], v65, s[4:7], s28 offen sc1
    s_mov_b64 exec, -1
    s_nop 3
    v_cvt_pk_bf16_f32 v52, v16, v17
    v_cvt_pk_bf16_f32 v53, v18, v19
    v_cvt_pk_bf16_f32 v54, v20, v21
    v_cvt_pk_bf16_f32 v55, v22, v23
    buffer_store_dwordx4 v[52:55], v65, s[4:7], s27 offen sc1
    s_add_u32 s28, s28, 131072
    s_add_u32 s27, s27, 131072
    s_cmp_eq_u32 s30, 63
    s_cbranch_scc1 cf_last
    s_branch cf_rare_x
cf_kvwait:
    s_mov_b32 s41, s97
    v_bfe_u32 v78, v65, 2, 5
    v_mov_b32 v77, v76
    s_nop 1
    v_permlane32_swap_b32 v76, v77
    v_subrev_u32 v77, s95, v77
    v_cmp_lt_u32 vcc, 16, v77
    s_nop 1
    v_cndmask_b32 v77, v77, 0, vcc
    v_bfe_u32 v79, v78, 2, 2
    v_lshl_add_u32 v77, v77, 2, v79
    s_nop 1
    v_min_u32_dpp v77, v77, v77 row_ror:1 row_mask:0xf bank_mask:0xf
    s_nop 1
    v_min_u32_dpp v77, v77, v77 row_ror:2 row_mask:0xf bank_mask:0xf
    s_nop 1
    v_min_u32_dpp v77, v77, v77 row_ror:4 row_mask:0xf bank_mask:0xf
    s_nop 0
    v_readfirstlane_b32 s97, v77
    s_nop 0
    s_max_u32 s97, s97, s41
    s_add_u32 s40, s30, 3
    s_min_u32 s40, s40, 64
    s_cmp_le_u32 s40, s97
    s_cbranch_scc1 cf_kvw_x
    v_bfe_u32 v78, v65, 2, 5
    s_mov_b32 s31, 4194304
cf_kvw:
    buffer_load_dword v77, v78, s[4:7], s96 offen offset:16 sc1
    s_waitcnt vmcnt(0)
    v_subrev_u32 v77, s95, v77
    v_cmp_lt_u32 vcc, 16, v77
    s_nop 1
    v_cndmask_b32 v77, v77, 0, vcc
    v_bfe_u32 v79, v78, 2, 2
    v_lshl_add_u32 v77, v77, 2, v79
    s_nop 1
    v_min_u32_dpp v77, v77, v77 row_ror:1 row_mask:0xf bank_mask:0xf
    s_nop 1
    v_min_u32_dpp v77, v77, v77 row_ror:2 row_mask:0xf bank_mask:0xf
    s_nop 1
    v_min_u32_dpp v77, v77, v77 row_ror:4 row_mask:0xf bank_mask:0xf
    s_nop 0
    v_readfirstlane_b32 s97, v77
    s_sub_u32 s31, s31, 1
    s_cbranch_scc1 cf_kvw_x
    s_cmp_le_u32 s40, s97
    s_cbranch_scc1 cf_kvw_x
    s_sleep 2
    s_branch cf_kvw
cf_kvw_x:
    s_branch cf_kvok
cf_last:
    s_add_u32 s40, s95, 64
    v_mov_b32 v78, s40
    s_waitcnt vmcnt(0)
    s_barrier
    s_mov_b64 exec, s[100:101]
    buffer_store_dword v78, off, s[4:7], s29 sc1
    s_mov_b64 exec, -1
cf_end:
    s_endpgm
L_chain_safe:
    s_mov_b64 s[48:49], s[50:51]
    s_mov_b64 s[50:51], s[52:53]
    s_mov_b64 s[52:53], s[54:55]
    s_mov_b64 s[54:55], s[56:57]
    s_mov_b64 s[56:57], s[58:59]
    v_lshrrev_b32 v77, 6, v0
    s_nop 0
    v_readfirstlane_b32 s13, v77
    v_lshlrev_b32 v65, 4, v0
    v_and_b32 v48, 63, v0
    s_mov_b32 s10, 4718592
    s_mov_b32 s11, 0x20000
    v_lshrrev_b32 v49, 3, v48
    v_mul_u32_u24 v18, 1152, v49
    v_and_b32 v49, 7, v48
    v_lshl_add_u32 v18, v49, 4, v18
    s_mul_i32 s40, s12, 147456
    s_lshl_b32 s41, s13, 8
    s_add_u32 s40, s40, s41
    s_mov_b32 s42, s40
    s_xor_b32 s41, s13, 0
    s_mul_i32 s41, s41, 36864
    s_add_u32 s60, s41, s40
    s_xor_b32 s41, s13, 1
    s_mul_i32 s41, s41, 36864
    s_add_u32 s61, s41, s40
    s_xor_b32 s41, s13, 2
    s_mul_i32 s41, s41, 36864
    s_add_u32 s62, s41, s40
    s_xor_b32 s41, s13, 3
    s_mul_i32 s41, s41, 36864
    s_add_u32 s63, s41, s40
    s_lshl_b32 s43, s13, 12
    s_mov_b64 s[8:9], s[56:57]
    s_add_u32 m0, s43, 147456
    s_add_u32 s41, s60, 0
    buffer_load_dwordx4 v18, s[8:11], s41 offen offset:0 nt lds
    s_add_u32 s41, s60, 8192
    buffer_load_dwordx4 v18, s[8:11], s41 offen offset:1024 nt lds
    s_add_u32 s41, s60, 16384
    buffer_load_dwordx4 v18, s[8:11], s41 offen offset:2048 nt lds
    s_add_u32 s41, s60, 24576
    buffer_load_dwordx4 v18, s[8:11], s41 offen offset:3072 nt lds
    s_add_u32 m0, s43, 0
    s_add_u32 s41, s61, 0
    buffer_load_dwordx4 v18, s[8:11], s41 offen offset:0 nt lds
    s_add_u32 s41, s61, 8192
    buffer_load_dwordx4 v18, s[8:11], s41 offen offset:1024 nt lds
    s_add_u32 s41, s61, 16384
    buffer_load_dwordx4 v18, s[8:11], s41 offen offset:2048 nt lds
    s_add_u32 s41, s61, 24576
    buffer_load_dwordx4 v18, s[8:11], s41 offen offset:3072 nt lds
    s_add_u32 m0, s43, 36864
    s_add_u32 s41, s62, 0
    buffer_load_dwordx4 v18, s[8:11], s41 offen offset:0 nt lds
    s_add_u32 s41, s62, 8192
    buffer_load_dwordx4 v18, s[8:11], s41 offen offset:1024 nt lds
    s_add_u32 s41, s62, 16384
    buffer_load_dwordx4 v18, s[8:11], s41 offen offset:2048 nt lds
    s_add_u32 s41, s62, 24576
    buffer_load_dwordx4 v18, s[8:11], s41 offen offset:3072 nt lds
    s_add_u32 m0, s43, 73728
    s_add_u32 s41, s63, 0
    buffer_load_dwordx4 v18, s[8:11], s41 offen offset:0 nt lds
    s_add_u32 s41, s63, 8192
    buffer_load_dwordx4 v18, s[8:11], s41 offen offset:1024 nt lds
    s_add_u32 s41, s63, 16384
    buffer_load_dwordx4 v18, s[8:11], s41 offen offset:2048 nt lds
    s_add_u32 s41, s63, 24576
    buffer_load_dwordx4 v18, s[8:11], s41 offen offset:3072 nt lds
    v_lshrrev_b32 v49, 1, v48
    v_mul_u32_u24 v19, 1152, v49
    v_and_b32 v49, 1, v48
    v_lshl_add_u32 v19, v49, 4, v19
    s_mul_i32 s41, s13, 224
    s_sub_u32 s41, 1024, s41
    v_add_u32 v19, s41, v19
    v_lshrrev_b32 v49, 4, v48
    v_lshlrev_b32 v50, 2, v49
    v_and_b32 v51, 15, v48
    v_xor_b32 v51, v51, v50
    v_lshlrev_b32 v51, 4, v51
    v_lshl_add_u32 v16, v49, 15, v51
    v_lshrrev_b32 v50, 1, v49
    v_lshl_add_u32 v17, v50, 16, v51
    v_and_b32 v50, 1, v49
    v_lshl_add_u32 v17, v50, 13, v17
    s_lshl_b32 s40, s12, 8
    s_mul_i32 s58, s13, 1048576
    s_add_u32 s58, s58, s40
    s_lshr_b32 s41, s13, 1
    s_mul_i32 s59, s41, 262144
    s_and_b32 s41, s13, 1
    s_lshl_b32 s41, s41, 14
    s_add_u32 s59, s59, s41
    s_add_u32 s59, s59, s40
    s_add_u32 s59, s59, 4194304
    s_lshr_b32 s71, s52, 8
    s_add_u32 s71, s71, s12
    s_and_b32 s71, s71, 3
    v_bfe_u32 v50, v48, 2, 2
    v_xor_b32 v51, s13, v50
    v_lshlrev_b32 v20, 6, v51
    v_and_b32 v51, 3, v48
    v_lshl_add_u32 v20, v51, 4, v20
    v_lshrrev_b32 v23, 2, v48
    v_lshl_add_u32 v20, v23, 8, v20
    s_xor_b32 s41, s43, 0
    v_add_u32 v24, s41, v20
    s_xor_b32 s41, s43, 4096
    v_add_u32 v25, s41, v20
    s_xor_b32 s41, s43, 8192
    v_add_u32 v26, s41, v20
    s_xor_b32 s41, s43, 12288
    v_add_u32 v27, s41, v20
    v_and_b32 v23, 1, v50
    v_lshl_add_u32 v23, v49, 2, v23
    v_lshrrev_b32 v50, 1, v50
    v_lshlrev_b32 v21, 7, v23
    v_lshl_add_u32 v21, v50, 6, v21
    v_lshrrev_b32 v16, 1, v51
    v_lshl_add_u32 v21, v16, 5, v21
    v_and_b32 v16, 1, v51
    v_lshl_add_u32 v21, v16, 3, v21
    v_add_u32 v21, s43, v21
    v_lshlrev_b32 v22, 9, v50
    v_xor_b32 v22, v22, v21
    v_lshlrev_b32 v23, 5, v23
    v_lshl_add_u32 v23, v50, 10, v23
    v_lshl_add_u32 v23, v51, 3, v23
    v_add_u32 v23, s43, v23
    v_bfe_u32 v60, v65, 4, 6
    v_and_b32 v61, 15, v60
    v_lshrrev_b32 v62, 4, v60
    v_mov_b32 v64, 0x4444
    v_mov_b32 v77, 0xeeee
    v_cmp_lt_u32 vcc, 7, v61
    s_nop 1
    v_cndmask_b32 v64, v64, v77, vcc
    v_xor_b32 v66, 1024, v65
    v_xor_b32 v67, 2048, v65
    v_xor_b32 v68, 3072, v65
    v_and_b32 v69, 511, v65
    s_mul_i32 s96, s13, 36864
    s_add_u32 s96, s96, 16384
    v_lshlrev_b32 v70, 4, v60
    v_add_u32 v70, s96, v70
    v_lshrrev_b32 v79, 1, v69
    s_lshl_b32 s96, s13, 8
    s_add_u32 s96, s96, 14336
    s_lshl_b32 s33, s13, 10
    s_add_u32 s97, s33, 8192
    v_mov_b32 v77, s97
    v_mov_b32 v78, s96
    v_cmp_lt_u32 vcc, 31, v60
    s_nop 1
    v_cndmask_b32 v71, v77, v78, vcc
    v_add_u32 v71, v71, v79
    v_and_b32 v77, 7, v61
    v_lshrrev_b32 v78, 3, v61
    v_lshlrev_b32 v74, 4, v77
    v_lshl_add_u32 v73, v62, 7, v74
    v_lshl_add_u32 v73, v78, 3, v73
    s_lshl_b32 s96, s13, 9
    v_add_u32 v73, s96, v73
    v_lshrrev_b32 v74, 1, v74
    v_lshl_add_u32 v74, v78, 14, v74
    v_lshl_add_u32 v74, v62, 15, v74
    s_lshl_b32 s96, s13, 17
    v_add_u32 v74, s96, v74
    v_bfe_u32 v77, v61, 2, 1
    v_and_b32 v78, 3, v61
    s_cmp_lt_u32 s13, 2
    s_cselect_b64 vcc, -1, 0
    v_cndmask_b32 v77, 0, v77, vcc
    v_lshlrev_b32 v75, 7, v77
    v_lshl_add_u32 v75, v62, 4, v75
    v_lshl_add_u32 v75, v78, 2, v75
    v_lshlrev_b32 v58, 3, v77
    v_lshl_add_u32 v58, v78, 1, v58
    s_bfe_u32 s97, s12, 0x10001
    s_lshl_b32 s68, s97, 6
    s_lshl_b32 s97, s97, 2
    v_add_u32 v59, s97, v62
    s_bfe_u32 s96, s12, 0x10002
    s_and_b32 s40, s12, 1
    s_lshl_b32 s96, s96, 1
    s_add_u32 s96, s96, s40
    s_lshr_b32 s97, s12, 3
    s_lshl_b32 s98, s13, 2
    s_add_u32 s98, s98, s97
    s_lshl_b32 s98, s98, 2
    s_add_u32 s98, s98, s96
    s_lshl_b32 s98, s98, 8
    s_lshl_b32 s99, s13, 2
    s_add_u32 s99, s99, s96
    s_lshl_b32 s99, s99, 4
    s_lshl_b32 s41, s97, 1
    s_add_u32 s41, s41, s40
    s_lshl_b32 s41, s41, 7
    s_add_u32 s41, s41, 8192
    s_lshl_b32 s40, s40, 3
    s_add_u32 s40, s40, 512
    s_cmp_lt_u32 s13, 2
    s_cselect_b32 s96, 7, 4
    s_cselect_b32 s98, s98, s41
    s_cselect_b32 s99, s99, s40
    s_cselect_b32 s32, 1, 0
    s_add_u32 s68, s68, s98
    s_lshl_b32 s97, s97, s96
    s_add_u32 s99, s99, s97
    v_add_u32 v58, s99, v58
    s_and_b32 s97, s12, 4
    s_or_b32 s97, s97, s13
    s_cmp_eq_u32 s97, 2
    s_cselect_b32 s32, 2, s32
    s_mov_b32 s8, s48
    s_mov_b32 s9, s49
    s_mov_b32 s10, 9216
    v_mul_u32_u24 v77, 1152, v59
    v_lshl_add_u32 v77, v58, 1, v77
    buffer_load_dword v72, v77, s[8:11], 0 offen
    s_mov_b32 s10, 4718592
    s_waitcnt vmcnt(12) lgkmcnt(0)
    s_barrier
    s_cmp_eq_u32 s71, 1
    s_cbranch_scc1 cs_th0
    s_waitcnt vmcnt(6)
cs_th0:
    s_mov_b64 s[8:9], s[56:57]
    s_add_u32 m0, s43, 110592
    s_add_u32 s41, s42, 0
    buffer_load_dwordx4 v19, s[8:11], s41 offen offset:0 nt lds
    s_add_u32 s41, s42, 35840
    buffer_load_dwordx4 v19, s[8:11], s41 offen offset:1024 nt lds
    s_add_u32 s41, s42, 71680
    buffer_load_dwordx4 v19, s[8:11], s41 offen offset:2048 nt lds
    s_add_u32 s41, s42, 107520
    buffer_load_dwordx4 v19, s[8:11], s41 offen offset:3072 nt lds
    v_add_u32 v77, 147456, v22
    ds_read_b64_tr_b16 v[80:81], v77 offset:0
    ds_read_b64_tr_b16 v[82:83], v77 offset:256
    ds_read_b64_tr_b16 v[84:85], v77 offset:2048
    ds_read_b64_tr_b16 v[86:87], v77 offset:2304
    ds_read_b64_tr_b16 v[112:113], v77 offset:16
    ds_read_b64_tr_b16 v[114:115], v77 offset:272
    ds_read_b64_tr_b16 v[116:117], v77 offset:2064
    ds_read_b64_tr_b16 v[118:119], v77 offset:2320
    s_waitcnt vmcnt(12) lgkmcnt(0)
    s_barrier
    s_cmp_eq_u32 s71, 1
    s_cbranch_scc1 cs_th1
    s_waitcnt vmcnt(6)
cs_th1:
    s_mov_b64 s[8:9], s[52:53]
    s_add_u32 m0, s43, 147456
    s_add_u32 s41, s58, 0
    buffer_load_dwordx4 v17, s[8:11], s41 offen offset:0 nt lds
    s_add_u32 s41, s58, 31744
    buffer_load_dwordx4 v17, s[8:11], s41 offen offset:1024 nt lds
    s_add_u32 s41, s58, 129024
    buffer_load_dwordx4 v17, s[8:11], s41 offen offset:2048 nt lds
    s_add_u32 s41, s58, 160768
    buffer_load_dwordx4 v17, s[8:11], s41 offen offset:3072 nt lds
    v_add_u32 v77, 0, v21
    ds_read_b64_tr_b16 v[88:89], v77 offset:0
    ds_read_b64_tr_b16 v[90:91], v77 offset:256
    ds_read_b64_tr_b16 v[92:93], v77 offset:2048
    ds_read_b64_tr_b16 v[94:95], v77 offset:2304
    ds_read_b64_tr_b16 v[120:121], v77 offset:16
    ds_read_b64_tr_b16 v[122:123], v77 offset:272
    ds_read_b64_tr_b16 v[124:125], v77 offset:2064
    ds_read_b64_tr_b16 v[126:127], v77 offset:2320
    s_waitcnt vmcnt(12) lgkmcnt(0)
    s_barrier
    s_cmp_eq_u32 s71, 1
    s_cbranch_scc1 cs_th2
    s_waitcnt vmcnt(6)
cs_th2:
    s_add_u32 m0, s43, 0
    s_add_u32 s41, s58, 16384
    buffer_load_dwordx4 v17, s[8:11], s41 offen offset:0 nt lds
    s_add_u32 s41, s58, 48128
    buffer_load_dwordx4 v17, s[8:11], s41 offen offset:1024 nt lds
    s_add_u32 s41, s58, 145408
    buffer_load_dwordx4 v17, s[8:11], s41 offen offset:2048 nt lds
    s_add_u32 s41, s58, 177152
    buffer_load_dwordx4 v17, s[8:11], s41 offen offset:3072 nt lds
    v_add_u32 v77, 36864, v21
    ds_read_b64_tr_b16 v[96:97], v77 offset:0
    ds_read_b64_tr_b16 v[98:99], v77 offset:256
    ds_read_b64_tr_b16 v[100:101], v77 offset:2048
    ds_read_b64_tr_b16 v[102:103], v77 offset:2304
    ds_read_b64_tr_b16 v[128:129], v77 offset:16
    ds_read_b64_tr_b16 v[130:131], v77 offset:272
    ds_read_b64_tr_b16 v[132:133], v77 offset:2064
    ds_read_b64_tr_b16 v[134:135], v77 offset:2320
    s_waitcnt vmcnt(12) lgkmcnt(0)
    s_barrier
    s_cmp_eq_u32 s71, 1
    s_cbranch_scc1 cs_th3
    s_waitcnt vmcnt(6)
cs_th3:
    s_mov_b64 s[8:9], s[54:55]
    s_add_u32 m0, s43, 36864
    s_add_u32 s41, s58, 0
    buffer_load_dwordx4 v17, s[8:11], s41 offen offset:0 nt lds
    s_add_u32 s41, s58, 31744
    buffer_load_dwordx4 v17, s[8:11], s41 offen offset:1024 nt lds
    s_add_u32 s41, s58, 129024
    buffer_load_dwordx4 v17, s[8:11], s41 offen offset:2048 nt lds
    s_add_u32 s41, s58, 160768
    buffer_load_dwordx4 v17, s[8:11], s41 offen offset:3072 nt lds
    v_add_u32 v77, 73728, v21
    ds_read_b64_tr_b16 v[104:105], v77 offset:0
    ds_read_b64_tr_b16 v[106:107], v77 offset:256
    ds_read_b64_tr_b16 v[108:109], v77 offset:2048
    ds_read_b64_tr_b16 v[110:111], v77 offset:2304
    ds_read_b64_tr_b16 v[136:137], v77 offset:16
    ds_read_b64_tr_b16 v[138:139], v77 offset:272
    ds_read_b64_tr_b16 v[140:141], v77 offset:2064
    ds_read_b64_tr_b16 v[142:143], v77 offset:2320
    s_waitcnt vmcnt(12) lgkmcnt(0)
    s_barrier
    s_cmp_eq_u32 s71, 1
    s_cbranch_scc1 cs_th4
    s_waitcnt vmcnt(6)
cs_th4:
    s_add_u32 m0, s43, 73728
    s_add_u32 s41, s58, 16384
    buffer_load_dwordx4 v17, s[8:11], s41 offen offset:0 nt lds
    s_add_u32 s41, s58, 48128
    buffer_load_dwordx4 v17, s[8:11], s41 offen offset:1024 nt lds
    s_add_u32 s41, s58, 145408
    buffer_load_dwordx4 v17, s[8:11], s41 offen offset:2048 nt lds
    s_add_u32 s41, s58, 177152
    buffer_load_dwordx4 v17, s[8:11], s41 offen offset:3072 nt lds
    v_add_u32 v77, 110592, v23
    ds_read_b64_tr_b16 v[0:1], v77 offset:0
    ds_read_b64_tr_b16 v[2:3], v77 offset:64
    ds_read_b64_tr_b16 v[4:5], v77 offset:512
    ds_read_b64_tr_b16 v[6:7], v77 offset:576
    ds_read_b64_tr_b16 v[8:9], v77 offset:2048
    ds_read_b64_tr_b16 v[10:11], v77 offset:2112
    ds_read_b64_tr_b16 v[12:13], v77 offset:2560
    ds_read_b64_tr_b16 v[14:15], v77 offset:2624
    s_waitcnt vmcnt(12) lgkmcnt(0)
    s_barrier
    s_cmp_eq_u32 s71, 1
    s_cbranch_scc1 cs_th5
    s_waitcnt vmcnt(6)
cs_th5:
    s_mov_b64 s[8:9], s[50:51]
    s_add_u32 m0, s43, 110592
    s_add_u32 s41, s58, 0
    buffer_load_dwordx4 v17, s[8:11], s41 offen offset:0 nt lds
    s_add_u32 s41, s58, 31744
    buffer_load_dwordx4 v17, s[8:11], s41 offen offset:1024 nt lds
    s_add_u32 s41, s58, 129024
    buffer_load_dwordx4 v17, s[8:11], s41 offen offset:2048 nt lds
    s_add_u32 s41, s58, 160768
    buffer_load_dwordx4 v17, s[8:11], s41 offen offset:3072 nt lds
    s_cmp_eq_u32 s32, 0
    s_cbranch_scc1 cs_init_done
    v_mov_b32 v52, 1
    v_mov_b32 v53, 1
    v_mov_b32 v54, 1
    v_mov_b32 v55, 1
    v_mov_b32 v56, 0
    s_lshl_b32 s96, s12, 14
    s_add_u32 s96, s96, 68681728
    s_add_u32 s97, s96, 0
    buffer_store_dwordx4 v[52:55], v65, s[4:7], s97 offen sc1
    s_add_u32 s97, s96, 4096
    buffer_store_dwordx4 v[52:55], v65, s[4:7], s97 offen sc1
    s_add_u32 s97, s96, 8192
    buffer_store_dwordx4 v[52:55], v65, s[4:7], s97 offen sc1
    s_add_u32 s97, s96, 12288
    buffer_store_dwordx4 v[52:55], v65, s[4:7], s97 offen sc1
    s_add_u32 s96, s68, 67633152
    s_add_u32 s97, s96, 16384
    buffer_store_dword v56, v75, s[4:7], s96 offen offset:0 sc1
    buffer_store_dword v72, v75, s[4:7], s97 offen offset:0 sc1
    s_cmp_lg_u32 s32, 2
    s_cbranch_scc1 cs_init_done
    buffer_store_dword v56, v75, s[4:7], s96 offen offset:1024 sc1
    buffer_store_dword v72, v75, s[4:7], s97 offen offset:1024 sc1
    buffer_store_dword v56, v75, s[4:7], s96 offen offset:2048 sc1
    buffer_store_dword v72, v75, s[4:7], s97 offen offset:2048 sc1
    buffer_store_dword v56, v75, s[4:7], s96 offen offset:3072 sc1
    buffer_store_dword v72, v75, s[4:7], s97 offen offset:3072 sc1
cs_init_done:
    ds_write_b64 v70, v[0:1] offset:16384
    ds_write_b64 v70, v[2:3] offset:16392
    ds_write_b64 v70, v[4:5] offset:17408
    ds_write_b64 v70, v[6:7] offset:17416
    ds_write_b64 v70, v[8:9] offset:18432
    ds_write_b64 v70, v[10:11] offset:18440
    ds_write_b64 v70, v[12:13] offset:19456
    ds_write_b64 v70, v[14:15] offset:19464
    v_add_u32 v28, 147456, v24
    v_add_u32 v29, 147456, v25
    v_add_u32 v30, 147456, v26
    v_add_u32 v31, 147456, v27
    ds_read_b64_tr_b16 a[96:97], v28 offset:0
    ds_read_b64_tr_b16 a[104:105], v28 offset:8
    ds_read_b64_tr_b16 a[112:113], v29 offset:0
    ds_read_b64_tr_b16 a[120:121], v29 offset:8
    ds_read_b64_tr_b16 a[128:129], v30 offset:0
    ds_read_b64_tr_b16 a[136:137], v30 offset:8
    ds_read_b64_tr_b16 a[144:145], v31 offset:0
    ds_read_b64_tr_b16 v[32:33], v31 offset:8
    s_waitcnt vmcnt(12) lgkmcnt(0)
    s_barrier
    s_cmp_eq_u32 s71, 1
    s_cbranch_scc1 cs_th6
    s_waitcnt vmcnt(6)
cs_th6:
    s_add_u32 m0, s43, 147456
    s_add_u32 s41, s58, 16384
    buffer_load_dwordx4 v17, s[8:11], s41 offen offset:0 nt lds
    s_add_u32 s41, s58, 48128
    buffer_load_dwordx4 v17, s[8:11], s41 offen offset:1024 nt lds
    s_add_u32 s41, s58, 145408
    buffer_load_dwordx4 v17, s[8:11], s41 offen offset:2048 nt lds
    s_add_u32 s41, s58, 177152
    buffer_load_dwordx4 v17, s[8:11], s41 offen offset:3072 nt lds
    ds_write_b64 v70, v[32:33] offset:12288
    v_add_u32 v28, 0, v24
    v_add_u32 v29, 0, v25
    v_add_u32 v30, 0, v26
    v_add_u32 v31, 0, v27
    ds_read_b64_tr_b16 a[98:99], v28 offset:0
    ds_read_b64_tr_b16 a[106:107], v28 offset:8
    ds_read_b64_tr_b16 a[114:115], v29 offset:0
    ds_read_b64_tr_b16 a[122:123], v29 offset:8
    ds_read_b64_tr_b16 a[130:131], v30 offset:0
    ds_read_b64_tr_b16 a[138:139], v30 offset:8
    ds_read_b64_tr_b16 a[146:147], v31 offset:0
    ds_read_b64_tr_b16 v[0:1], v31 offset:8
    s_waitcnt vmcnt(12) lgkmcnt(0)
    s_barrier
    s_cmp_eq_u32 s71, 1
    s_cbranch_scc1 cs_th7
    s_waitcnt vmcnt(6)
cs_th7:
    s_mov_b64 s[8:9], s[52:53]
    s_add_u32 m0, s43, 0
    s_add_u32 s41, s58, 262144
    buffer_load_dwordx4 v17, s[8:11], s41 offen offset:0 nt lds
    s_add_u32 s41, s58, 293888
    buffer_load_dwordx4 v17, s[8:11], s41 offen offset:1024 nt lds
    s_add_u32 s41, s58, 391168
    buffer_load_dwordx4 v17, s[8:11], s41 offen offset:2048 nt lds
    s_add_u32 s41, s58, 422912
    buffer_load_dwordx4 v17, s[8:11], s41 offen offset:3072 nt lds
    ds_write_b64 v70, v[0:1] offset:12296
    v_add_u32 v28, 36864, v24
    v_add_u32 v29, 36864, v25
    v_add_u32 v30, 36864, v26
    v_add_u32 v31, 36864, v27
    ds_read_b64_tr_b16 a[232:233], v28 offset:0
    ds_read_b64_tr_b16 v[32:33], v28 offset:8
    ds_read_b64_tr_b16 a[240:241], v29 offset:0
    ds_read_b64_tr_b16 a[248:249], v29 offset:8
    ds_read_b64_tr_b16 v[144:145], v30 offset:0
    ds_read_b64_tr_b16 v[152:153], v30 offset:8
    ds_read_b64_tr_b16 v[160:161], v31 offset:0
    ds_read_b64_tr_b16 v[168:169], v31 offset:8
    s_waitcnt vmcnt(12) lgkmcnt(0)
    s_barrier
    s_cmp_eq_u32 s71, 1
    s_cbranch_scc1 cs_th8
    s_waitcnt vmcnt(6)
cs_th8:
    s_add_u32 m0, s43, 36864
    s_add_u32 s41, s58, 278528
    buffer_load_dwordx4 v17, s[8:11], s41 offen offset:0 nt lds
    s_add_u32 s41, s58, 310272
    buffer_load_dwordx4 v17, s[8:11], s41 offen offset:1024 nt lds
    s_add_u32 s41, s58, 407552
    buffer_load_dwordx4 v17, s[8:11], s41 offen offset:2048 nt lds
    s_add_u32 s41, s58, 439296
    buffer_load_dwordx4 v17, s[8:11], s41 offen offset:3072 nt lds
    ds_write_b64 v70, v[32:33] offset:8192
    v_add_u32 v28, 73728, v24
    v_add_u32 v29, 73728, v25
    v_add_u32 v30, 73728, v26
    v_add_u32 v31, 73728, v27
    ds_read_b64_tr_b16 a[234:235], v28 offset:0
    ds_read_b64_tr_b16 v[0:1], v28 offset:8
    ds_read_b64_tr_b16 a[242:243], v29 offset:0
    ds_read_b64_tr_b16 a[250:251], v29 offset:8
    ds_read_b64_tr_b16 v[146:147], v30 offset:0
    ds_read_b64_tr_b16 v[154:155], v30 offset:8
    ds_read_b64_tr_b16 v[162:163], v31 offset:0
    ds_read_b64_tr_b16 v[170:171], v31 offset:8
    s_waitcnt vmcnt(12) lgkmcnt(0)
    s_barrier
    s_cmp_eq_u32 s71, 1
    s_cbranch_scc1 cs_th9
    s_waitcnt vmcnt(6)
cs_th9:
    s_mov_b64 s[8:9], s[54:55]
    s_add_u32 m0, s43, 73728
    s_add_u32 s41, s58, 262144
    buffer_load_dwordx4 v17, s[8:11], s41 offen offset:0 nt lds
    s_add_u32 s41, s58, 293888
    buffer_load_dwordx4 v17, s[8:11], s41 offen offset:1024 nt lds
    s_add_u32 s41, s58, 391168
    buffer_load_dwordx4 v17, s[8:11], s41 offen offset:2048 nt lds
    s_add_u32 s41, s58, 422912
    buffer_load_dwordx4 v17, s[8:11], s41 offen offset:3072 nt lds
    ds_write_b64 v70, v[0:1] offset:8200
    v_add_u32 v28, 110592, v24
    v_add_u32 v29, 110592, v25
    v_add_u32 v30, 110592, v26
    v_add_u32 v31, 110592, v27
    ds_read_b64_tr_b16 v[32:33], v28 offset:0
    ds_read_b64_tr_b16 v[34:35], v28 offset:8
    ds_read_b64_tr_b16 v[36:37], v29 offset:0
    ds_read_b64_tr_b16 v[38:39], v29 offset:8
    ds_read_b64_tr_b16 a[0:1], v30 offset:0
    ds_read_b64_tr_b16 v[40:41], v30 offset:8
    ds_read_b64_tr_b16 a[8:9], v31 offset:0
    ds_read_b64_tr_b16 v[42:43], v31 offset:8
    s_waitcnt vmcnt(12) lgkmcnt(0)
    s_barrier
    s_cmp_eq_u32 s71, 1
    s_cbranch_scc1 cs_th10
    s_waitcnt vmcnt(6)
cs_th10:
    s_add_u32 m0, s43, 110592
    s_add_u32 s41, s58, 278528
    buffer_load_dwordx4 v17, s[8:11], s41 offen offset:0 nt lds
    s_add_u32 s41, s58, 310272
    buffer_load_dwordx4 v17, s[8:11], s41 offen offset:1024 nt lds
    s_add_u32 s41, s58, 407552
    buffer_load_dwordx4 v17, s[8:11], s41 offen offset:2048 nt lds
    s_add_u32 s41, s58, 439296
    buffer_load_dwordx4 v17, s[8:11], s41 offen offset:3072 nt lds
    ds_write_b64 v70, v[32:33] offset:0
    ds_write_b64 v70, v[34:35] offset:2048
    ds_write_b64 v70, v[36:37] offset:4096
    ds_write_b64 v70, v[38:39] offset:6144
    ds_write_b64 v70, v[40:41] offset:10240
    ds_write_b64 v70, v[42:43] offset:14336
    v_add_u32 v28, 147456, v24
    v_add_u32 v29, 147456, v25
    v_add_u32 v30, 147456, v26
    v_add_u32 v31, 147456, v27
    ds_read_b64_tr_b16 v[0:1], v28 offset:0
    ds_read_b64_tr_b16 v[2:3], v28 offset:8
    ds_read_b64_tr_b16 v[4:5], v29 offset:0
    ds_read_b64_tr_b16 v[6:7], v29 offset:8
    ds_read_b64_tr_b16 a[2:3], v30 offset:0
    ds_read_b64_tr_b16 v[8:9], v30 offset:8
    ds_read_b64_tr_b16 a[10:11], v31 offset:0
    ds_read_b64_tr_b16 v[10:11], v31 offset:8
    s_waitcnt vmcnt(12) lgkmcnt(0)
    s_barrier
    s_cmp_eq_u32 s71, 1
    s_cbranch_scc1 cs_th11
    s_waitcnt vmcnt(6)
cs_th11:
    s_mov_b64 s[8:9], s[50:51]
    s_add_u32 m0, s43, 147456
    s_add_u32 s41, s58, 262144
    buffer_load_dwordx4 v17, s[8:11], s41 offen offset:0 nt lds
    s_add_u32 s41, s58, 293888
    buffer_load_dwordx4 v17, s[8:11], s41 offen offset:1024 nt lds
    s_add_u32 s41, s58, 391168
    buffer_load_dwordx4 v17, s[8:11], s41 offen offset:2048 nt lds
    s_add_u32 s41, s58, 422912
    buffer_load_dwordx4 v17, s[8:11], s41 offen offset:3072 nt lds
    ds_write_b64 v70, v[0:1] offset:8
    ds_write_b64 v70, v[2:3] offset:2056
    ds_write_b64 v70, v[4:5] offset:4104
    ds_write_b64 v70, v[6:7] offset:6152
    ds_write_b64 v70, v[8:9] offset:10248
    ds_write_b64 v70, v[10:11] offset:14344
    v_add_u32 v28, 0, v24
    v_add_u32 v29, 0, v25
    v_add_u32 v30, 0, v26
    v_add_u32 v31, 0, v27
    ds_read_b64_tr_b16 a[100:101], v28 offset:0
    ds_read_b64_tr_b16 a[108:109], v28 offset:8
    ds_read_b64_tr_b16 a[116:117], v29 offset:0
    ds_read_b64_tr_b16 a[124:125], v29 offset:8
    ds_read_b64_tr_b16 a[132:133], v30 offset:0
    ds_read_b64_tr_b16 a[140:141], v30 offset:8
    ds_read_b64_tr_b16 a[148:149], v31 offset:0
    ds_read_b64_tr_b16 v[32:33], v31 offset:8
    s_waitcnt vmcnt(12) lgkmcnt(0)
    s_barrier
    s_cmp_eq_u32 s71, 1
    s_cbranch_scc1 cs_th12
    s_waitcnt vmcnt(6)
cs_th12:
    s_add_u32 m0, s43, 0
    s_add_u32 s41, s58, 278528
    buffer_load_dwordx4 v17, s[8:11], s41 offen offset:0 nt lds
    s_add_u32 s41, s58, 310272
    buffer_load_dwordx4 v17, s[8:11], s41 offen offset:1024 nt lds
    s_add_u32 s41, s58, 407552
    buffer_load_dwordx4 v17, s[8:11], s41 offen offset:2048 nt lds
    s_add_u32 s41, s58, 439296
    buffer_load_dwordx4 v17, s[8:11], s41 offen offset:3072 nt lds
    ds_write_b64 v70, v[32:33] offset:13312
    v_add_u32 v28, 36864, v24
    v_add_u32 v29, 36864, v25
    v_add_u32 v30, 36864, v26
    v_add_u32 v31, 36864, v27
    ds_read_b64_tr_b16 a[102:103], v28 offset:0
    ds_read_b64_tr_b16 a[110:111], v28 offset:8
    ds_read_b64_tr_b16 a[118:119], v29 offset:0
    ds_read_b64_tr_b16 a[126:127], v29 offset:8
    ds_read_b64_tr_b16 a[134:135], v30 offset:0
    ds_read_b64_tr_b16 a[142:143], v30 offset:8
    ds_read_b64_tr_b16 a[150:151], v31 offset:0
    ds_read_b64_tr_b16 v[0:1], v31 offset:8
    s_waitcnt vmcnt(12) lgkmcnt(0)
    s_barrier
    s_cmp_eq_u32 s71, 1
    s_cbranch_scc1 cs_th13
    s_waitcnt vmcnt(6)
cs_th13:
    s_mov_b64 s[8:9], s[52:53]
    s_add_u32 m0, s43, 36864
    s_add_u32 s41, s58, 524288
    buffer_load_dwordx4 v17, s[8:11], s41 offen offset:0 nt lds
    s_add_u32 s41, s58, 556032
    buffer_load_dwordx4 v17, s[8:11], s41 offen offset:1024 nt lds
    s_add_u32 s41, s58, 653312
    buffer_load_dwordx4 v17, s[8:11], s41 offen offset:2048 nt lds
    s_add_u32 s41, s58, 685056
    buffer_load_dwordx4 v17, s[8:11], s41 offen offset:3072 nt lds
    ds_write_b64 v70, v[0:1] offset:13320
    v_add_u32 v28, 73728, v24
    v_add_u32 v29, 73728, v25
    v_add_u32 v30, 73728, v26
    v_add_u32 v31, 73728, v27
    ds_read_b64_tr_b16 a[236:237], v28 offset:0
    ds_read_b64_tr_b16 v[32:33], v28 offset:8
    ds_read_b64_tr_b16 a[244:245], v29 offset:0
    ds_read_b64_tr_b16 a[252:253], v29 offset:8
    ds_read_b64_tr_b16 v[148:149], v30 offset:0
    ds_read_b64_tr_b16 v[156:157], v30 offset:8
    ds_read_b64_tr_b16 v[164:165], v31 offset:0
    ds_read_b64_tr_b16 v[172:173], v31 offset:8
    s_waitcnt vmcnt(12) lgkmcnt(0)
    s_barrier
    s_cmp_eq_u32 s71, 1
    s_cbranch_scc1 cs_th14
    s_waitcnt vmcnt(6)
cs_th14:
    s_add_u32 m0, s43, 73728
    s_add_u32 s41, s58, 540672
    buffer_load_dwordx4 v17, s[8:11], s41 offen offset:0 nt lds
    s_add_u32 s41, s58, 572416
    buffer_load_dwordx4 v17, s[8:11], s41 offen offset:1024 nt lds
    s_add_u32 s41, s58, 669696
    buffer_load_dwordx4 v17, s[8:11], s41 offen offset:2048 nt lds
    s_add_u32 s41, s58, 701440
    buffer_load_dwordx4 v17, s[8:11], s41 offen offset:3072 nt lds
    ds_write_b64 v70, v[32:33] offset:9216
    v_add_u32 v28, 110592, v24
    v_add_u32 v29, 110592, v25
    v_add_u32 v30, 110592, v26
    v_add_u32 v31, 110592, v27
    ds_read_b64_tr_b16 a[238:239], v28 offset:0
    ds_read_b64_tr_b16 v[0:1], v28 offset:8
    ds_read_b64_tr_b16 a[246:247], v29 offset:0
    ds_read_b64_tr_b16 a[254:255], v29 offset:8
    ds_read_b64_tr_b16 v[150:151], v30 offset:0
    ds_read_b64_tr_b16 v[158:159], v30 offset:8
    ds_read_b64_tr_b16 v[166:167], v31 offset:0
    ds_read_b64_tr_b16 v[174:175], v31 offset:8
    s_waitcnt vmcnt(12) lgkmcnt(0)
    s_barrier
    s_cmp_eq_u32 s71, 1
    s_cbranch_scc1 cs_th15
    s_waitcnt vmcnt(6)
cs_th15:
    s_mov_b64 s[8:9], s[54:55]
    s_add_u32 m0, s43, 110592
    s_add_u32 s41, s58, 524288
    buffer_load_dwordx4 v17, s[8:11], s41 offen offset:0 nt lds
    s_add_u32 s41, s58, 556032
    buffer_load_dwordx4 v17, s[8:11], s41 offen offset:1024 nt lds
    s_add_u32 s41, s58, 653312
    buffer_load_dwordx4 v17, s[8:11], s41 offen offset:2048 nt lds
    s_add_u32 s41, s58, 685056
    buffer_load_dwordx4 v17, s[8:11], s41 offen offset:3072 nt lds
    ds_write_b64 v70, v[0:1] offset:9224
    v_add_u32 v28, 147456, v24
    v_add_u32 v29, 147456, v25
    v_add_u32 v30, 147456, v26
    v_add_u32 v31, 147456, v27
    ds_read_b64_tr_b16 v[32:33], v28 offset:0
    ds_read_b64_tr_b16 v[34:35], v28 offset:8
    ds_read_b64_tr_b16 v[36:37], v29 offset:0
    ds_read_b64_tr_b16 v[38:39], v29 offset:8
    ds_read_b64_tr_b16 a[4:5], v30 offset:0
    ds_read_b64_tr_b16 v[40:41], v30 offset:8
    ds_read_b64_tr_b16 a[12:13], v31 offset:0
    ds_read_b64_tr_b16 v[42:43], v31 offset:8
    s_waitcnt vmcnt(12) lgkmcnt(0)
    s_barrier
    s_cmp_eq_u32 s71, 1
    s_cbranch_scc1 cs_th16
    s_waitcnt vmcnt(6)
cs_th16:
    s_add_u32 m0, s43, 147456
    s_add_u32 s41, s58, 540672
    buffer_load_dwordx4 v17, s[8:11], s41 offen offset:0 nt lds
    s_add_u32 s41, s58, 572416
    buffer_load_dwordx4 v17, s[8:11], s41 offen offset:1024 nt lds
    s_add_u32 s41, s58, 669696
    buffer_load_dwordx4 v17, s[8:11], s41 offen offset:2048 nt lds
    s_add_u32 s41, s58, 701440
    buffer_load_dwordx4 v17, s[8:11], s41 offen offset:3072 nt lds
    ds_write_b64 v70, v[32:33] offset:1024
    ds_write_b64 v70, v[34:35] offset:3072
    ds_write_b64 v70, v[36:37] offset:5120
    ds_write_b64 v70, v[38:39] offset:7168
    ds_write_b64 v70, v[40:41] offset:11264
    ds_write_b64 v70, v[42:43] offset:15360
    v_add_u32 v28, 0, v24
    v_add_u32 v29, 0, v25
    v_add_u32 v30, 0, v26
    v_add_u32 v31, 0, v27
    ds_read_b64_tr_b16 v[0:1], v28 offset:0
    ds_read_b64_tr_b16 v[2:3], v28 offset:8
    ds_read_b64_tr_b16 v[4:5], v29 offset:0
    ds_read_b64_tr_b16 v[6:7], v29 offset:8
    ds_read_b64_tr_b16 a[6:7], v30 offset:0
    ds_read_b64_tr_b16 v[8:9], v30 offset:8
    ds_read_b64_tr_b16 a[14:15], v31 offset:0
    ds_read_b64_tr_b16 v[10:11], v31 offset:8
    s_waitcnt vmcnt(12) lgkmcnt(0)
    s_barrier
    s_cmp_eq_u32 s71, 1
    s_cbranch_scc1 cs_th17
    s_waitcnt vmcnt(6)
cs_th17:
    s_mov_b64 s[8:9], s[50:51]
    s_add_u32 m0, s43, 0
    s_add_u32 s41, s58, 524288
    buffer_load_dwordx4 v17, s[8:11], s41 offen offset:0 nt lds
    s_add_u32 s41, s58, 556032
    buffer_load_dwordx4 v17, s[8:11], s41 offen offset:1024 nt lds
    s_add_u32 s41, s58, 653312
    buffer_load_dwordx4 v17, s[8:11], s41 offen offset:2048 nt lds
    s_add_u32 s41, s58, 685056
    buffer_load_dwordx4 v17, s[8:11], s41 offen offset:3072 nt lds
    ds_write_b64 v70, v[0:1] offset:1032
    ds_write_b64 v70, v[2:3] offset:3080
    ds_write_b64 v70, v[4:5] offset:5128
    ds_write_b64 v70, v[6:7] offset:7176
    ds_write_b64 v70, v[8:9] offset:11272
    ds_write_b64 v70, v[10:11] offset:15368
    v_add_u32 v28, 36864, v24
    v_add_u32 v29, 36864, v25
    v_add_u32 v30, 36864, v26
    v_add_u32 v31, 36864, v27
    ds_read_b64_tr_b16 a[152:153], v28 offset:0
    ds_read_b64_tr_b16 a[160:161], v28 offset:8
    ds_read_b64_tr_b16 a[168:169], v29 offset:0
    ds_read_b64_tr_b16 a[176:177], v29 offset:8
    ds_read_b64_tr_b16 a[184:185], v30 offset:0
    ds_read_b64_tr_b16 a[192:193], v30 offset:8
    ds_read_b64_tr_b16 a[200:201], v31 offset:0
    ds_read_b64_tr_b16 a[208:209], v31 offset:8
    s_waitcnt vmcnt(12) lgkmcnt(0)
    s_barrier
    s_cmp_eq_u32 s71, 1
    s_cbranch_scc1 cs_th18
    s_waitcnt vmcnt(6)
cs_th18:
    s_add_u32 m0, s43, 36864
    s_add_u32 s41, s58, 540672
    buffer_load_dwordx4 v17, s[8:11], s41 offen offset:0 nt lds
    s_add_u32 s41, s58, 572416
    buffer_load_dwordx4 v17, s[8:11], s41 offen offset:1024 nt lds
    s_add_u32 s41, s58, 669696
    buffer_load_dwordx4 v17, s[8:11], s41 offen offset:2048 nt lds
    s_add_u32 s41, s58, 701440
    buffer_load_dwordx4 v17, s[8:11], s41 offen offset:3072 nt lds
    v_add_u32 v28, 73728, v24
    v_add_u32 v29, 73728, v25
    v_add_u32 v30, 73728, v26
    v_add_u32 v31, 73728, v27
    ds_read_b64_tr_b16 a[154:155], v28 offset:0
    ds_read_b64_tr_b16 a[162:163], v28 offset:8
    ds_read_b64_tr_b16 a[170:171], v29 offset:0
    ds_read_b64_tr_b16 a[178:179], v29 offset:8
    ds_read_b64_tr_b16 a[186:187], v30 offset:0
    ds_read_b64_tr_b16 a[194:195], v30 offset:8
    ds_read_b64_tr_b16 a[202:203], v31 offset:0
    ds_read_b64_tr_b16 a[210:211], v31 offset:8
    s_waitcnt vmcnt(12) lgkmcnt(0)
    s_barrier
    s_cmp_eq_u32 s71, 1
    s_cbranch_scc1 cs_th19
    s_waitcnt vmcnt(6)
cs_th19:
    s_mov_b64 s[8:9], s[52:53]
    s_add_u32 m0, s43, 73728
    s_add_u32 s41, s58, 786432
    buffer_load_dwordx4 v17, s[8:11], s41 offen offset:0 nt lds
    s_add_u32 s41, s58, 818176
    buffer_load_dwordx4 v17, s[8:11], s41 offen offset:1024 nt lds
    s_add_u32 s41, s58, 915456
    buffer_load_dwordx4 v17, s[8:11], s41 offen offset:2048 nt lds
    s_add_u32 s41, s58, 947200
    buffer_load_dwordx4 v17, s[8:11], s41 offen offset:3072 nt lds
    v_add_u32 v28, 110592, v24
    v_add_u32 v29, 110592, v25
    v_add_u32 v30, 110592, v26
    v_add_u32 v31, 110592, v27
    ds_read_b64_tr_b16 v[176:177], v28 offset:0
    ds_read_b64_tr_b16 v[184:185], v28 offset:8
    ds_read_b64_tr_b16 v[192:193], v29 offset:0
    ds_read_b64_tr_b16 v[200:201], v29 offset:8
    ds_read_b64_tr_b16 v[208:209], v30 offset:0
    ds_read_b64_tr_b16 v[216:217], v30 offset:8
    ds_read_b64_tr_b16 v[224:225], v31 offset:0
    ds_read_b64_tr_b16 v[232:233], v31 offset:8
    s_waitcnt vmcnt(12) lgkmcnt(0)
    s_barrier
    s_cmp_eq_u32 s71, 1
    s_cbranch_scc1 cs_th20
    s_waitcnt vmcnt(6)
cs_th20:
    s_add_u32 m0, s43, 110592
    s_add_u32 s41, s58, 802816
    buffer_load_dwordx4 v17, s[8:11], s41 offen offset:0 nt lds
    s_add_u32 s41, s58, 834560
    buffer_load_dwordx4 v17, s[8:11], s41 offen offset:1024 nt lds
    s_add_u32 s41, s58, 931840
    buffer_load_dwordx4 v17, s[8:11], s41 offen offset:2048 nt lds
    s_add_u32 s41, s58, 963584
    buffer_load_dwordx4 v17, s[8:11], s41 offen offset:3072 nt lds
    v_add_u32 v28, 147456, v24
    v_add_u32 v29, 147456, v25
    v_add_u32 v30, 147456, v26
    v_add_u32 v31, 147456, v27
    ds_read_b64_tr_b16 v[178:179], v28 offset:0
    ds_read_b64_tr_b16 v[186:187], v28 offset:8
    ds_read_b64_tr_b16 v[194:195], v29 offset:0
    ds_read_b64_tr_b16 v[202:203], v29 offset:8
    ds_read_b64_tr_b16 v[210:211], v30 offset:0
    ds_read_b64_tr_b16 v[218:219], v30 offset:8
    ds_read_b64_tr_b16 v[226:227], v31 offset:0
    ds_read_b64_tr_b16 v[234:235], v31 offset:8
    s_waitcnt vmcnt(12) lgkmcnt(0)
    s_barrier
    s_cmp_eq_u32 s71, 1
    s_cbranch_scc1 cs_th21
    s_waitcnt vmcnt(6)
cs_th21:
    s_mov_b64 s[8:9], s[54:55]
    s_add_u32 m0, s43, 147456
    s_add_u32 s41, s58, 786432
    buffer_load_dwordx4 v17, s[8:11], s41 offen offset:0 nt lds
    s_add_u32 s41, s58, 818176
    buffer_load_dwordx4 v17, s[8:11], s41 offen offset:1024 nt lds
    s_add_u32 s41, s58, 915456
    buffer_load_dwordx4 v17, s[8:11], s41 offen offset:2048 nt lds
    s_add_u32 s41, s58, 947200
    buffer_load_dwordx4 v17, s[8:11], s41 offen offset:3072 nt lds
    v_add_u32 v28, 0, v24
    v_add_u32 v29, 0, v25
    v_add_u32 v30, 0, v26
    v_add_u32 v31, 0, v27
    ds_read_b64_tr_b16 a[16:17], v28 offset:0
    ds_read_b64_tr_b16 a[24:25], v28 offset:8
    ds_read_b64_tr_b16 a[32:33], v29 offset:0
    ds_read_b64_tr_b16 a[40:41], v29 offset:8
    ds_read_b64_tr_b16 a[48:49], v30 offset:0
    ds_read_b64_tr_b16 a[56:57], v30 offset:8
    ds_read_b64_tr_b16 a[64:65], v31 offset:0
    ds_read_b64_tr_b16 a[72:73], v31 offset:8
    s_waitcnt vmcnt(12) lgkmcnt(0)
    s_barrier
    s_cmp_eq_u32 s71, 1
    s_cbranch_scc1 cs_th22
    s_waitcnt vmcnt(6)
cs_th22:
    s_add_u32 m0, s43, 0
    s_add_u32 s41, s58, 802816
    buffer_load_dwordx4 v17, s[8:11], s41 offen offset:0 nt lds
    s_add_u32 s41, s58, 834560
    buffer_load_dwordx4 v17, s[8:11], s41 offen offset:1024 nt lds
    s_add_u32 s41, s58, 931840
    buffer_load_dwordx4 v17, s[8:11], s41 offen offset:2048 nt lds
    s_add_u32 s41, s58, 963584
    buffer_load_dwordx4 v17, s[8:11], s41 offen offset:3072 nt lds
    v_add_u32 v28, 36864, v24
    v_add_u32 v29, 36864, v25
    v_add_u32 v30, 36864, v26
    v_add_u32 v31, 36864, v27
    ds_read_b64_tr_b16 a[18:19], v28 offset:0
    ds_read_b64_tr_b16 a[26:27], v28 offset:8
    ds_read_b64_tr_b16 a[34:35], v29 offset:0
    ds_read_b64_tr_b16 a[42:43], v29 offset:8
    ds_read_b64_tr_b16 a[50:51], v30 offset:0
    ds_read_b64_tr_b16 a[58:59], v30 offset:8
    ds_read_b64_tr_b16 a[66:67], v31 offset:0
    ds_read_b64_tr_b16 a[74:75], v31 offset:8
    s_waitcnt vmcnt(12) lgkmcnt(0)
    s_barrier
    s_cmp_eq_u32 s71, 1
    s_cbranch_scc1 cs_th23
    s_waitcnt vmcnt(6)
cs_th23:
    s_mov_b64 s[8:9], s[50:51]
    s_add_u32 m0, s43, 36864
    s_add_u32 s41, s58, 786432
    buffer_load_dwordx4 v17, s[8:11], s41 offen offset:0 nt lds
    s_add_u32 s41, s58, 818176
    buffer_load_dwordx4 v17, s[8:11], s41 offen offset:1024 nt lds
    s_add_u32 s41, s58, 915456
    buffer_load_dwordx4 v17, s[8:11], s41 offen offset:2048 nt lds
    s_add_u32 s41, s58, 947200
    buffer_load_dwordx4 v17, s[8:11], s41 offen offset:3072 nt lds
    v_add_u32 v28, 73728, v24
    v_add_u32 v29, 73728, v25
    v_add_u32 v30, 73728, v26
    v_add_u32 v31, 73728, v27
    ds_read_b64_tr_b16 a[156:157], v28 offset:0
    ds_read_b64_tr_b16 a[164:165], v28 offset:8
    ds_read_b64_tr_b16 a[172:173], v29 offset:0
    ds_read_b64_tr_b16 a[180:181], v29 offset:8
    ds_read_b64_tr_b16 a[188:189], v30 offset:0
    ds_read_b64_tr_b16 a[196:197], v30 offset:8
    ds_read_b64_tr_b16 a[204:205], v31 offset:0
    ds_read_b64_tr_b16 a[212:213], v31 offset:8
    s_waitcnt vmcnt(12) lgkmcnt(0)
    s_barrier
    s_cmp_eq_u32 s71, 1
    s_cbranch_scc1 cs_th24
    s_waitcnt vmcnt(6)
cs_th24:
    s_add_u32 m0, s43, 73728
    s_add_u32 s41, s58, 802816
    buffer_load_dwordx4 v17, s[8:11], s41 offen offset:0 nt lds
    s_add_u32 s41, s58, 834560
    buffer_load_dwordx4 v17, s[8:11], s41 offen offset:1024 nt lds
    s_add_u32 s41, s58, 931840
    buffer_load_dwordx4 v17, s[8:11], s41 offen offset:2048 nt lds
    s_add_u32 s41, s58, 963584
    buffer_load_dwordx4 v17, s[8:11], s41 offen offset:3072 nt lds
    v_add_u32 v28, 110592, v24
    v_add_u32 v29, 110592, v25
    v_add_u32 v30, 110592, v26
    v_add_u32 v31, 110592, v27
    ds_read_b64_tr_b16 a[158:159], v28 offset:0
    ds_read_b64_tr_b16 a[166:167], v28 offset:8
    ds_read_b64_tr_b16 a[174:175], v29 offset:0
    ds_read_b64_tr_b16 a[182:183], v29 offset:8
    ds_read_b64_tr_b16 a[190:191], v30 offset:0
    ds_read_b64_tr_b16 a[198:199], v30 offset:8
    ds_read_b64_tr_b16 a[206:207], v31 offset:0
    ds_read_b64_tr_b16 a[214:215], v31 offset:8
    s_waitcnt vmcnt(12) lgkmcnt(0)
    s_barrier
    s_cmp_eq_u32 s71, 1
    s_cbranch_scc1 cs_th25
    s_waitcnt vmcnt(6)
cs_th25:
    s_mov_b64 s[8:9], s[52:53]
    s_add_u32 m0, s43, 110592
    s_add_u32 s41, s59, 0
    buffer_load_dwordx4 v17, s[8:11], s41 offen offset:0 nt lds
    s_add_u32 s41, s59, 31744
    buffer_load_dwordx4 v17, s[8:11], s41 offen offset:1024 nt lds
    s_add_u32 s41, s59, 129024
    buffer_load_dwordx4 v17, s[8:11], s41 offen offset:2048 nt lds
    s_add_u32 s41, s59, 160768
    buffer_load_dwordx4 v17, s[8:11], s41 offen offset:3072 nt lds
    v_add_u32 v28, 147456, v24
    v_add_u32 v29, 147456, v25
    v_add_u32 v30, 147456, v26
    v_add_u32 v31, 147456, v27
    ds_read_b64_tr_b16 v[180:181], v28 offset:0
    ds_read_b64_tr_b16 v[188:189], v28 offset:8
    ds_read_b64_tr_b16 v[196:197], v29 offset:0
    ds_read_b64_tr_b16 v[204:205], v29 offset:8
    ds_read_b64_tr_b16 v[212:213], v30 offset:0
    ds_read_b64_tr_b16 v[220:221], v30 offset:8
    ds_read_b64_tr_b16 v[228:229], v31 offset:0
    ds_read_b64_tr_b16 v[236:237], v31 offset:8
    s_waitcnt vmcnt(12) lgkmcnt(0)
    s_barrier
    s_cmp_eq_u32 s71, 1
    s_cbranch_scc1 cs_th26
    s_waitcnt vmcnt(6)
cs_th26:
    s_mov_b64 s[8:9], s[50:51]
    s_add_u32 m0, s43, 147456
    s_add_u32 s41, s59, 0
    buffer_load_dwordx4 v17, s[8:11], s41 offen offset:0 nt lds
    s_add_u32 s41, s59, 31744
    buffer_load_dwordx4 v17, s[8:11], s41 offen offset:1024 nt lds
    s_add_u32 s41, s59, 129024
    buffer_load_dwordx4 v17, s[8:11], s41 offen offset:2048 nt lds
    s_add_u32 s41, s59, 160768
    buffer_load_dwordx4 v17, s[8:11], s41 offen offset:3072 nt lds
    v_add_u32 v28, 0, v24
    v_add_u32 v29, 0, v25
    v_add_u32 v30, 0, v26
    v_add_u32 v31, 0, v27
    ds_read_b64_tr_b16 v[182:183], v28 offset:0
    ds_read_b64_tr_b16 v[190:191], v28 offset:8
    ds_read_b64_tr_b16 v[198:199], v29 offset:0
    ds_read_b64_tr_b16 v[206:207], v29 offset:8
    ds_read_b64_tr_b16 v[214:215], v30 offset:0
    ds_read_b64_tr_b16 v[222:223], v30 offset:8
    ds_read_b64_tr_b16 v[230:231], v31 offset:0
    ds_read_b64_tr_b16 v[238:239], v31 offset:8
    s_waitcnt vmcnt(12) lgkmcnt(0)
    s_barrier
    s_cmp_eq_u32 s71, 1
    s_cbranch_scc1 cs_th27
    s_waitcnt vmcnt(6)
cs_th27:
    s_mov_b64 s[8:9], s[54:55]
    s_add_u32 m0, s43, 0
    s_add_u32 s41, s59, 0
    buffer_load_dwordx4 v17, s[8:11], s41 offen offset:0 nt lds
    s_add_u32 s41, s59, 31744
    buffer_load_dwordx4 v17, s[8:11], s41 offen offset:1024 nt lds
    s_add_u32 s41, s59, 129024
    buffer_load_dwordx4 v17, s[8:11], s41 offen offset:2048 nt lds
    s_add_u32 s41, s59, 160768
    buffer_load_dwordx4 v17, s[8:11], s41 offen offset:3072 nt lds
    v_add_u32 v28, 36864, v24
    v_add_u32 v29, 36864, v25
    v_add_u32 v30, 36864, v26
    v_add_u32 v31, 36864, v27
    ds_read_b64_tr_b16 a[20:21], v28 offset:0
    ds_read_b64_tr_b16 a[28:29], v28 offset:8
    ds_read_b64_tr_b16 a[36:37], v29 offset:0
    ds_read_b64_tr_b16 a[44:45], v29 offset:8
    ds_read_b64_tr_b16 a[52:53], v30 offset:0
    ds_read_b64_tr_b16 a[60:61], v30 offset:8
    ds_read_b64_tr_b16 a[68:69], v31 offset:0
    ds_read_b64_tr_b16 a[76:77], v31 offset:8
    s_waitcnt vmcnt(12) lgkmcnt(0)
    s_barrier
    s_cmp_eq_u32 s71, 1
    s_cbranch_scc1 cs_th28
    s_waitcnt vmcnt(6)
cs_th28:
    s_mov_b64 s[8:9], s[56:57]
    s_add_u32 m0, s43, 36864
    s_add_u32 s41, s60, 128
    buffer_load_dwordx4 v18, s[8:11], s41 offen offset:0 nt lds
    s_add_u32 s41, s60, 8320
    buffer_load_dwordx4 v18, s[8:11], s41 offen offset:1024 nt lds
    s_add_u32 s41, s60, 16512
    buffer_load_dwordx4 v18, s[8:11], s41 offen offset:2048 nt lds
    s_add_u32 s41, s60, 24704
    buffer_load_dwordx4 v18, s[8:11], s41 offen offset:3072 nt lds
    v_add_u32 v28, 73728, v24
    v_add_u32 v29, 73728, v25
    v_add_u32 v30, 73728, v26
    v_add_u32 v31, 73728, v27
    ds_read_b64_tr_b16 a[22:23], v28 offset:0
    ds_read_b64_tr_b16 a[30:31], v28 offset:8
    ds_read_b64_tr_b16 a[38:39], v29 offset:0
    ds_read_b64_tr_b16 a[46:47], v29 offset:8
    ds_read_b64_tr_b16 a[54:55], v30 offset:0
    ds_read_b64_tr_b16 a[62:63], v30 offset:8
    ds_read_b64_tr_b16 a[70:71], v31 offset:0
    ds_read_b64_tr_b16 a[78:79], v31 offset:8
    s_waitcnt vmcnt(12) lgkmcnt(0)
    s_barrier
    s_cmp_eq_u32 s71, 1
    s_cbranch_scc1 cs_th29
    s_waitcnt vmcnt(6)
cs_th29:
    s_add_u32 m0, s43, 73728
    s_add_u32 s41, s61, 128
    buffer_load_dwordx4 v18, s[8:11], s41 offen offset:0 nt lds
    s_add_u32 s41, s61, 8320
    buffer_load_dwordx4 v18, s[8:11], s41 offen offset:1024 nt lds
    s_add_u32 s41, s61, 16512
    buffer_load_dwordx4 v18, s[8:11], s41 offen offset:2048 nt lds
    s_add_u32 s41, s61, 24704
    buffer_load_dwordx4 v18, s[8:11], s41 offen offset:3072 nt lds
    v_add_u32 v77, 110592, v20
    ds_read_b64_tr_b16 a[216:217], v77 offset:0
    ds_read_b64_tr_b16 a[218:219], v77 offset:4096
    ds_read_b64_tr_b16 a[220:221], v77 offset:8192
    ds_read_b64_tr_b16 a[222:223], v77 offset:12288
    ds_read_b64_tr_b16 a[224:225], v77 offset:8
    ds_read_b64_tr_b16 a[226:227], v77 offset:4104
    ds_read_b64_tr_b16 a[228:229], v77 offset:8200
    ds_read_b64_tr_b16 a[230:231], v77 offset:12296
    s_waitcnt vmcnt(12) lgkmcnt(0)
    s_barrier
    s_cmp_eq_u32 s71, 1
    s_cbranch_scc1 cs_th30
    s_waitcnt vmcnt(6)
cs_th30:
    s_add_u32 m0, s43, 110592
    s_add_u32 s41, s62, 128
    buffer_load_dwordx4 v18, s[8:11], s41 offen offset:0 nt lds
    s_add_u32 s41, s62, 8320
    buffer_load_dwordx4 v18, s[8:11], s41 offen offset:1024 nt lds
    s_add_u32 s41, s62, 16512
    buffer_load_dwordx4 v18, s[8:11], s41 offen offset:2048 nt lds
    s_add_u32 s41, s62, 24704
    buffer_load_dwordx4 v18, s[8:11], s41 offen offset:3072 nt lds
    v_add_u32 v77, 147456, v20
    ds_read_b64_tr_b16 a[80:81], v77 offset:0
    ds_read_b64_tr_b16 a[82:83], v77 offset:4096
    ds_read_b64_tr_b16 a[84:85], v77 offset:8192
    ds_read_b64_tr_b16 a[86:87], v77 offset:12288
    ds_read_b64_tr_b16 a[88:89], v77 offset:8
    ds_read_b64_tr_b16 a[90:91], v77 offset:4104
    ds_read_b64_tr_b16 a[92:93], v77 offset:8200
    ds_read_b64_tr_b16 a[94:95], v77 offset:12296
    s_waitcnt vmcnt(12) lgkmcnt(0)
    s_barrier
    s_cmp_eq_u32 s71, 1
    s_cbranch_scc1 cs_th31
    s_waitcnt vmcnt(6)
cs_th31:
    s_add_u32 m0, s43, 147456
    s_add_u32 s41, s63, 128
    buffer_load_dwordx4 v18, s[8:11], s41 offen offset:0 nt lds
    s_add_u32 s41, s63, 8320
    buffer_load_dwordx4 v18, s[8:11], s41 offen offset:1024 nt lds
    s_add_u32 s41, s63, 16512
    buffer_load_dwordx4 v18, s[8:11], s41 offen offset:2048 nt lds
    s_add_u32 s41, s63, 24704
    buffer_load_dwordx4 v18, s[8:11], s41 offen offset:3072 nt lds
    v_mov_b32 v78, v21
    v_mov_b32 v79, v22
    v_add_u32 v77, 0, v20
    ds_read_b64_tr_b16 v[240:241], v77 offset:0
    ds_read_b64_tr_b16 v[242:243], v77 offset:4096
    ds_read_b64_tr_b16 v[244:245], v77 offset:8192
    ds_read_b64_tr_b16 v[246:247], v77 offset:12288
    ds_read_b64_tr_b16 v[248:249], v77 offset:8
    ds_read_b64_tr_b16 v[250:251], v77 offset:4104
    ds_read_b64_tr_b16 v[252:253], v77 offset:8200
    ds_read_b64_tr_b16 v[254:255], v77 offset:12296
    s_waitcnt vmcnt(12) lgkmcnt(0)
    s_barrier
    v_bfe_u32 v60, v65, 4, 6
    v_and_b32 v61, 15, v60
    v_lshrrev_b32 v62, 4, v60
    v_mov_b32 v50, 0x3f80
    v_mov_b32 v51, 0x3f800000
    v_and_b32 v57, 1, v62
    v_lshlrev_b32 v57, 2, v57
    v_sub_u32 v57, v61, v57
    v_and_b32 v58, 3, v61
    v_lshlrev_b32 v58, 2, v58
    v_lshrrev_b32 v59, 2, v61
    v_add_u32 v58, v58, v59
    v_cmp_eq_u32 vcc, 0, v57
    s_nop 1
    v_cndmask_b32 v40, 0, v50, vcc
    v_cmp_eq_u32 vcc, 1, v57
    s_nop 1
    v_cndmask_b32 v40, v40, v51, vcc
    v_cmp_eq_u32 vcc, 0, v58
    s_nop 1
    v_cndmask_b32 v44, 0, v50, vcc
    v_cmp_eq_u32 vcc, 1, v58
    s_nop 1
    v_cndmask_b32 v44, v44, v51, vcc
    v_cmp_eq_u32 vcc, 2, v57
    s_nop 1
    v_cndmask_b32 v41, 0, v50, vcc
    v_cmp_eq_u32 vcc, 3, v57
    s_nop 1
    v_cndmask_b32 v41, v41, v51, vcc
    v_cmp_eq_u32 vcc, 2, v58
    s_nop 1
    v_cndmask_b32 v45, 0, v50, vcc
    v_cmp_eq_u32 vcc, 3, v58
    s_nop 1
    v_cndmask_b32 v45, v45, v51, vcc
    v_cmp_eq_u32 vcc, 8, v57
    s_nop 1
    v_cndmask_b32 v42, 0, v50, vcc
    v_cmp_eq_u32 vcc, 9, v57
    s_nop 1
    v_cndmask_b32 v42, v42, v51, vcc
    v_cmp_eq_u32 vcc, 4, v58
    s_nop 1
    v_cndmask_b32 v46, 0, v50, vcc
    v_cmp_eq_u32 vcc, 5, v58
    s_nop 1
    v_cndmask_b32 v46, v46, v51, vcc
    v_cmp_eq_u32 vcc, 10, v57
    s_nop 1
    v_cndmask_b32 v43, 0, v50, vcc
    v_cmp_eq_u32 vcc, 11, v57
    s_nop 1
    v_cndmask_b32 v43, v43, v51, vcc
    v_cmp_eq_u32 vcc, 6, v58
    s_nop 1
    v_cndmask_b32 v47, 0, v50, vcc
    v_cmp_eq_u32 vcc, 7, v58
    s_nop 1
    v_cndmask_b32 v47, v47, v51, vcc
    v_lshlrev_b32 v57, 4, v61
    ds_write_b128 v69, v[40:43] offset:15360
    ds_write_b128 v57, v[44:47] offset:15872
    v_add_u32 v77, 36864, v79
    s_waitcnt lgkmcnt(0)
    ds_read_b64_tr_b16 v[0:1], v77 offset:0
    ds_read_b64_tr_b16 v[2:3], v77 offset:256
    ds_read_b64_tr_b16 v[4:5], v77 offset:2048
    ds_read_b64_tr_b16 v[6:7], v77 offset:2304
    ds_read_b64_tr_b16 v[8:9], v77 offset:16
    ds_read_b64_tr_b16 v[10:11], v77 offset:272
    ds_read_b64_tr_b16 v[12:13], v77 offset:2064
    ds_read_b64_tr_b16 v[14:15], v77 offset:2320
    s_waitcnt vmcnt(8) lgkmcnt(0)
    s_barrier
    v_add_u32 v77, 73728, v78
    ds_read_b64_tr_b16 v[16:17], v77 offset:0
    ds_read_b64_tr_b16 v[18:19], v77 offset:256
    ds_read_b64_tr_b16 v[20:21], v77 offset:2048
    ds_read_b64_tr_b16 v[22:23], v77 offset:2304
    ds_read_b64_tr_b16 v[24:25], v77 offset:16
    ds_read_b64_tr_b16 v[26:27], v77 offset:272
    ds_read_b64_tr_b16 v[28:29], v77 offset:2064
    ds_read_b64_tr_b16 v[30:31], v77 offset:2320
    s_waitcnt vmcnt(4) lgkmcnt(0)
    s_barrier
    v_add_u32 v77, 110592, v78
    ds_read_b64_tr_b16 v[32:33], v77 offset:0
    ds_read_b64_tr_b16 v[34:35], v77 offset:256
    ds_read_b64_tr_b16 v[36:37], v77 offset:2048
    ds_read_b64_tr_b16 v[38:39], v77 offset:2304
    ds_read_b64_tr_b16 v[40:41], v77 offset:16
    ds_read_b64_tr_b16 v[42:43], v77 offset:272
    ds_read_b64_tr_b16 v[44:45], v77 offset:2064
    ds_read_b64_tr_b16 v[46:47], v77 offset:2320
    s_waitcnt vmcnt(0) lgkmcnt(0)
    s_barrier
    v_add_u32 v77, 147456, v78
    ds_read_b64_tr_b16 v[48:49], v77 offset:0
    ds_read_b64_tr_b16 v[50:51], v77 offset:256
    ds_read_b64_tr_b16 v[52:53], v77 offset:2048
    ds_read_b64_tr_b16 v[54:55], v77 offset:2304
    ds_read_b64_tr_b16 v[56:57], v77 offset:16
    ds_read_b64_tr_b16 v[58:59], v77 offset:272
    ds_read_b64_tr_b16 v[60:61], v77 offset:2064
    ds_read_b64_tr_b16 v[62:63], v77 offset:2320
    s_waitcnt lgkmcnt(0)
    s_barrier
    ds_write_b128 v70, v[0:3] offset:20480
    ds_write_b128 v70, v[4:7] offset:21504
    ds_write_b128 v70, v[8:11] offset:22528
    ds_write_b128 v70, v[12:15] offset:23552
    ds_write_b128 v70, v[16:19] offset:24576
    ds_write_b128 v70, v[20:23] offset:25600
    ds_write_b128 v70, v[24:27] offset:26624
    ds_write_b128 v70, v[28:31] offset:27648
    ds_write_b128 v70, v[32:35] offset:28672
    ds_write_b128 v70, v[36:39] offset:29696
    ds_write_b128 v70, v[40:43] offset:30720
    ds_write_b128 v70, v[44:47] offset:31744
    ds_write_b128 v70, v[48:51] offset:32768
    ds_write_b128 v70, v[52:55] offset:33792
    ds_write_b128 v70, v[56:59] offset:34816
    ds_write_b128 v70, v[60:63] offset:35840
    s_waitcnt vmcnt(0) lgkmcnt(0)
    s_barrier
    v_mov_b32 v2, 1
    s_cmp_lg_u32 s13, 0
    s_cbranch_scc1 cs_noarr
    s_mov_b64 exec, 1
    buffer_atomic_add v2, off, s[84:87], 0 offset:212
    s_mov_b32 s40, 16777216
    s_mov_b32 s42, 2
cs_startpoll:
    buffer_load_dword v3, off, s[84:87], 0 offset:212 sc1
    s_sub_u32 s40, s40, 1
    s_cbranch_scc1 cs_decide
    s_waitcnt vmcnt(0)
    v_readfirstlane_b32 s41, v3
    s_nop 1
    s_cmp_lt_u32 s41, 32
    s_cbranch_scc1 cs_startpoll
    s_mov_b32 s42, 1
cs_decide:
    s_mov_b64 exec, -1
cs_noarr:
    s_barrier
    s_mov_b32 s44, 0x3e0293ee
    s_mov_b32 s45, s44
    s_or_b32 s66, s44, 0x80000000
    s_mov_b32 s48, 0x3f003f00
    s_mov_b32 s49, 0
    s_mov_b32 s50, 0x3f803f80
    s_mov_b32 s51, 0x3f803f80
    s_mov_b32 s52, 512
    s_mov_b32 s53, 1024
    s_mov_b32 s54, 1536
    s_mov_b32 s30, 0
    s_mov_b32 s37, 0
    s_mov_b32 s98, -100
    s_lshl_b32 s47, s13, 9
    s_cmp_lg_u32 s32, 0
    s_cselect_b32 s71, s13, 3
    s_add_u32 s46, s71, 1
    s_lshr_b32 s46, s46, 1
    s_mov_b32 s14, 67649536
    s_mov_b32 s15, 67653632
    s_mov_b32 s16, 67657728
    s_mov_b32 s36, 0
    s_add_u32 s17, s68, 67633152
    s_mov_b32 s69, 0
    s_mov_b32 s70, 0
    s_lshl_b32 s26, s12, 14
    s_add_u32 s26, s26, 0
    s_mul_i32 s40, s13, 3072
    s_add_u32 s24, s26, s40
    s_add_u32 s26, s24, s33
    s_add_u32 s99, s26, 33030144
    s_lshl_b32 s96, s12, 7
    s_add_u32 s29, s96, 125845504
    s_add_u32 s96, s96, 125829120
    s_lshl_b32 s40, s12, 14
    s_add_u32 s40, s40, 68681728
    s_add_u32 s18, s40, 0
    s_add_u32 s19, s40, 4096
    s_add_u32 s20, s40, 8192
    s_add_u32 s21, s40, 12288
    s_lshr_b32 s40, s12, 3
    s_lshl_b32 s40, s40, 12
    s_and_b32 s41, s12, 7
    s_lshl_b32 s41, s41, 7
    s_add_u32 s40, s40, s41
    s_add_u32 s22, s40, 68681728
    s_add_u32 s23, s22, 1024
    s_add_u32 s25, s22, 2048
    s_mov_b32 s56, -65472
    s_cmp_lg_u32 s32, 0
    s_cselect_b64 s[38:39], -1, 0
    s_add_u32 s55, s68, 138412032
    s_cmp_eq_u32 s13, 3
    s_cselect_b64 s[100:101], 1, 0
    s_cselect_b64 s[38:39], 1, s[38:39]
    s_cselect_b32 s93, 64, 0
    s_cselect_b32 s55, s29, s55
    s_cselect_b32 s57, 0, 9216
    s_mov_b32 s34, 0xff00ff00
    s_mov_b32 s35, 0xff00ff00
    s_lshl_b32 s28, s12, 12
    s_add_u32 s28, s28, 7340032
    s_add_u32 s27, s28, 77594624
    s_add_u32 s28, s28, 69206016
    s_mov_b64 exec, s[100:101]
    v_mov_b32 v72, s95
    s_mov_b64 exec, -1
    s_mov_b32 s40, 3
    v_bfe_u32 v78, v65, 2, 5
    s_mov_b32 s31, 4194304
cs_kv0:
    buffer_load_dword v77, v78, s[4:7], s96 offen offset:16 sc1
    s_waitcnt vmcnt(0)
    v_subrev_u32 v77, s95, v77
    v_cmp_lt_u32 vcc, 16, v77
    s_nop 1
    v_cndmask_b32 v77, v77, 0, vcc
    v_bfe_u32 v79, v78, 2, 2
    v_lshl_add_u32 v77, v77, 2, v79
    s_nop 1
    v_min_u32_dpp v77, v77, v77 row_ror:1 row_mask:0xf bank_mask:0xf
    s_nop 1
    v_min_u32_dpp v77, v77, v77 row_ror:2 row_mask:0xf bank_mask:0xf
    s_nop 1
    v_min_u32_dpp v77, v77, v77 row_ror:4 row_mask:0xf bank_mask:0xf
    s_nop 0
    v_readfirstlane_b32 s97, v77
    s_sub_u32 s31, s31, 1
    s_cbranch_scc1 cs_kv0_x
    s_cmp_le_u32 s40, s97
    s_cbranch_scc1 cs_kv0_x
    s_sleep 2
    s_branch cs_kv0
cs_kv0_x:
    s_add_u32 s40, s26, 0
    s_min_u32 s40, s40, s99
    s_sub_u32 s41, s96, s40
    v_bfe_u32 v77, v65, 2, 5
    v_add3_u32 v77, v77, s41, 16
    v_lshlrev_b32 v78, 3, v69
    s_nop 0
    v_mov_b32_dpp v78, v77 quad_perm:[0,1,2,3] row_mask:0xc bank_mask:0xf
    buffer_load_dword v76, v78, s[4:7], s40 offen sc1
    s_add_u32 s40, s26, 524288
    s_min_u32 s40, s40, s99
    s_sub_u32 s41, s96, s40
    v_bfe_u32 v77, v65, 2, 5
    v_add3_u32 v77, v77, s41, 16
    v_lshlrev_b32 v78, 3, v69
    s_nop 0
    v_mov_b32_dpp v78, v77 quad_perm:[0,1,2,3] row_mask:0xc bank_mask:0xf
    buffer_load_dword v76, v78, s[4:7], s40 offen sc1
cs_kvdone:
    v_mov_b64 v[0:1], 0
    v_mov_b64 v[2:3], 0
    v_mov_b64 v[4:5], 0
    v_mov_b64 v[6:7], 0
    v_mov_b64 v[8:9], 0
    v_mov_b64 v[10:11], 0
    v_mov_b64 v[12:13], 0
    v_mov_b64 v[14:15], 0
    v_mov_b64 v[16:17], 0
    v_mov_b64 v[18:19], 0
    v_mov_b64 v[20:21], 0
    v_mov_b64 v[22:23], 0
    ds_read_b128 v[44:47], v70 offset:0
    ds_read_b128 v[48:51], v70 offset:1024
    ds_read_b128 v[52:55], v70 offset:2048
    ds_read_b128 v[56:59], v70 offset:3072
    ds_read_b128 v[24:27], v70 offset:4096
    ds_read_b128 v[28:31], v70 offset:5120
    ds_read_b128 v[32:35], v70 offset:6144
    ds_read_b128 v[36:39], v70 offset:7168
    buffer_load_dwordx4 v[40:43], v65, s[4:7], s14 offen offset:0 sc1
    buffer_load_dwordx4 v[60:63], v66, s[4:7], s14 offen offset:0 sc1
    s_mov_b32 s31, 1048576
    s_waitcnt vmcnt(0) lgkmcnt(0)
    s_branch cs_goA
cs_loop:
    s_mov_b32 s31, 1048576
    s_mov_b32 s69, s70
    s_waitcnt lgkmcnt(0)
cs_cA:
    buffer_load_dwordx4 v[40:43], v65, s[4:7], s14 offen offset:0 sc1
    buffer_load_dwordx4 v[60:63], v66, s[4:7], s14 offen offset:0 sc1
cs_cA1:
    s_waitcnt vmcnt(0)
    v_bitop3_b32 v77, v40, v60, s70 bitop3:0x7e
    v_bitop3_b32 v77, v77, v41, s70 bitop3:0xf6
    v_bitop3_b32 v77, v77, v42, s70 bitop3:0xf6
    v_bitop3_b32 v77, v77, v43, s70 bitop3:0xf6
    v_bitop3_b32 v77, v77, v61, s70 bitop3:0xf6
    v_bitop3_b32 v77, v77, v62, s70 bitop3:0xf6
    v_bitop3_b32 v77, v77, v63, s70 bitop3:0xf6
    v_and_b32 v77, 1, v77
    v_cmp_ne_u32 vcc, 0, v77
    s_cbranch_vccz cs_goA
    s_nop 15
    s_nop 15
    s_nop 7
    buffer_load_dwordx4 v[40:43], v65, s[4:7], s14 offen offset:0 sc1
    buffer_load_dwordx4 v[60:63], v66, s[4:7], s14 offen offset:0 sc1
    s_waitcnt vmcnt(0)
    v_bitop3_b32 v77, v40, v60, s70 bitop3:0x7e
    v_bitop3_b32 v77, v77, v41, s70 bitop3:0xf6
    v_bitop3_b32 v77, v77, v42, s70 bitop3:0xf6
    v_bitop3_b32 v77, v77, v43, s70 bitop3:0xf6
    v_bitop3_b32 v77, v77, v61, s70 bitop3:0xf6
    v_bitop3_b32 v77, v77, v62, s70 bitop3:0xf6
    v_bitop3_b32 v77, v77, v63, s70 bitop3:0xf6
    v_and_b32 v77, 1, v77
    v_cmp_ne_u32 vcc, 0, v77
    s_cbranch_vccz cs_goA
    s_nop 15
    s_nop 15
    s_nop 7
    buffer_load_dwordx4 v[40:43], v65, s[4:7], s14 offen offset:0 sc1
    buffer_load_dwordx4 v[60:63], v66, s[4:7], s14 offen offset:0 sc1
    s_waitcnt vmcnt(0)
    v_bitop3_b32 v77, v40, v60, s70 bitop3:0x7e
    v_bitop3_b32 v77, v77, v41, s70 bitop3:0xf6
    v_bitop3_b32 v77, v77, v42, s70 bitop3:0xf6
    v_bitop3_b32 v77, v77, v43, s70 bitop3:0xf6
    v_bitop3_b32 v77, v77, v61, s70 bitop3:0xf6
    v_bitop3_b32 v77, v77, v62, s70 bitop3:0xf6
    v_bitop3_b32 v77, v77, v63, s70 bitop3:0xf6
    v_and_b32 v77, 1, v77
    v_cmp_ne_u32 vcc, 0, v77
    s_cbranch_vccz cs_goA
    s_nop 15
    s_nop 15
    s_nop 7
    buffer_load_dwordx4 v[40:43], v65, s[4:7], s14 offen offset:0 sc1
    buffer_load_dwordx4 v[60:63], v66, s[4:7], s14 offen offset:0 sc1
    s_waitcnt vmcnt(0)
    v_bitop3_b32 v77, v40, v60, s70 bitop3:0x7e
    v_bitop3_b32 v77, v77, v41, s70 bitop3:0xf6
    v_bitop3_b32 v77, v77, v42, s70 bitop3:0xf6
    v_bitop3_b32 v77, v77, v43, s70 bitop3:0xf6
    v_bitop3_b32 v77, v77, v61, s70 bitop3:0xf6
    v_bitop3_b32 v77, v77, v62, s70 bitop3:0xf6
    v_bitop3_b32 v77, v77, v63, s70 bitop3:0xf6
    v_and_b32 v77, 1, v77
    v_cmp_ne_u32 vcc, 0, v77
    s_cbranch_vccz cs_goA
    s_nop 15
    s_nop 15
    s_nop 7
    s_sub_u32 s31, s31, 64
    s_cbranch_scc0 cs_cA
cs_goA:
    ds_write_b128 v65, v[40:43] offset:0
    v_smfmac_f32_16x16x64_bf16 v[0:3], v[40:43], v[44:51], v64
    v_smfmac_f32_16x16x64_bf16 v[4:7], v[40:43], v[52:59], v64
    buffer_load_dwordx4 v[44:47], v65, s[4:7], s15 offen offset:0 sc1
    v_smfmac_f32_16x16x64_bf16 v[0:3], v[60:63], v[24:31], v64
    s_add_u32 s40, s26, 1048576
    s_min_u32 s40, s40, s99
    s_sub_u32 s41, s96, s40
    v_smfmac_f32_16x16x64_bf16 v[4:7], v[60:63], v[32:39], v64
    ds_read_b128 v[24:27], v70 offset:8192
    s_cmp_lt_u32 s97, s93
    s_cselect_b32 s41, s41, 0
    v_smfmac_f32_16x16x64_bf16 v[8:11], v[40:43], a[96:103], v64
    ds_read_b128 v[28:31], v70 offset:9216
    v_smfmac_f32_16x16x64_bf16 v[12:15], v[40:43], a[104:111], v64
    ds_read_b128 v[32:35], v70 offset:10240
    s_waitcnt lgkmcnt(3)
    s_barrier
    ds_read_b128 v[48:51], v67 offset:0
    v_smfmac_f32_16x16x64_bf16 v[8:11], v[60:63], a[112:119], v64
    ds_read_b128 v[36:39], v70 offset:11264
    v_bitop3_b32 v79, v73, -9, s54 bitop3:0x6a
    v_smfmac_f32_16x16x64_bf16 v[12:15], v[60:63], a[120:127], v64
    v_smfmac_f32_16x16x64_bf16 v[16:19], v[40:43], a[232:239], v64
    ds_read_b128 v[52:55], v68 offset:0
    s_waitcnt lgkmcnt(4)
    v_bfe_u32 v77, v65, 2, 5
    v_smfmac_f32_16x16x64_bf16 v[20:23], v[40:43], v[24:31], v64
    ds_read_b128 v[24:27], v70 offset:12288
    s_waitcnt lgkmcnt(3)
    v_smfmac_f32_16x16x64_bf16 v[0:3], v[48:51], a[0:7], v64
    ds_read_b128 v[28:31], v70 offset:13312
    s_waitcnt lgkmcnt(3)
    v_add3_u32 v77, v77, s41, 16
    v_smfmac_f32_16x16x64_bf16 v[4:7], v[48:51], v[32:39], v64
    buffer_load_dwordx4 v[40:43], v65, s[4:7], s16 offen offset:0 sc1
    v_smfmac_f32_16x16x64_bf16 v[16:19], v[60:63], a[240:247], v64
    ds_read_b128 v[32:35], v70 offset:14336
    v_lshlrev_b32 v78, 3, v69
    v_smfmac_f32_16x16x64_bf16 v[20:23], v[60:63], a[248:255], v64
    ds_read_b128 v[36:39], v70 offset:15360
    v_smfmac_f32_16x16x64_bf16 v[8:11], v[48:51], a[128:135], v64
    s_waitcnt vmcnt(1)
    v_mov_b32_dpp v78, v77 quad_perm:[0,1,2,3] row_mask:0xc bank_mask:0xf
    v_smfmac_f32_16x16x64_bf16 v[12:15], v[48:51], a[136:143], v64
    buffer_load_dwordx4 v[58:61], v65, s[4:7], s24 offen offset:3072 sc1
    s_waitcnt lgkmcnt(2)
    v_bitop3_b32 v77, v44, v45, s70 bitop3:0x7e
    v_bitop3_b32 v77, v77, v46, s70 bitop3:0xf6
    v_bitop3_b32 v77, v77, v47, s70 bitop3:0xf6
    v_and_b32 v77, s36, v77
    v_smfmac_f32_16x16x64_bf16 v[12:15], v[52:55], v[24:31], v64
    ds_write_b128 v65, v[44:47] offset:4096
    v_smfmac_f32_16x16x64_bf16 v[0:3], v[52:55], a[8:15], v64
    v_cmp_ne_u32 vcc, 0, v77
    v_smfmac_f32_16x16x64_bf16 v[8:11], v[52:55], a[144:151], v64
    buffer_load_dwordx4 v[24:27], v65, s[4:7], s24 offen offset:0 sc1
    s_waitcnt lgkmcnt(1)
    v_smfmac_f32_16x16x64_bf16 v[4:7], v[52:55], v[32:39], v64
    s_cbranch_vccnz cs_spinB
cs_backB:
    v_smfmac_f32_16x16x64_bf16 v[16:19], v[44:47], v[176:183], v64
    s_waitcnt lgkmcnt(0)
    s_barrier
    ds_read_b128 v[48:51], v66 offset:4096
    v_smfmac_f32_16x16x64_bf16 v[12:15], v[44:47], a[160:167], v64
    buffer_load_dwordx4 v[28:31], v65, s[4:7], s24 offen offset:1024 sc1
    v_smfmac_f32_16x16x64_bf16 v[0:3], v[44:47], a[16:23], v64
    ds_read_b128 v[52:55], v67 offset:4096
    v_smfmac_f32_16x16x64_bf16 v[8:11], v[44:47], a[152:159], v64
    v_smfmac_f32_16x16x64_bf16 v[4:7], v[44:47], a[24:31], v64
    buffer_load_dwordx4 v[34:37], v65, s[4:7], s24 offen offset:2048 sc1
    s_waitcnt vmcnt(5)
    v_smfmac_f32_16x16x64_bf16 v[20:23], v[44:47], v[184:191], v64
    ds_read_b128 v[44:47], v68 offset:4096
    s_waitcnt lgkmcnt(2)
    v_smfmac_f32_16x16x64_bf16 v[0:3], v[48:51], a[32:39], v64
    v_smfmac_f32_16x16x64_bf16 v[8:11], v[48:51], a[168:175], v64
    buffer_load_dword v76, v78, s[4:7], s40 offen sc1
    v_smfmac_f32_16x16x64_bf16 v[4:7], v[48:51], a[40:47], v64
    s_waitcnt vmcnt(5)
    v_bitop3_b32 v77, v40, v41, s70 bitop3:0x7e
    v_bitop3_b32 v77, v77, v42, s70 bitop3:0xf6
    v_bitop3_b32 v77, v77, v43, s70 bitop3:0xf6
    v_and_b32 v77, s36, v77
    v_smfmac_f32_16x16x64_bf16 v[12:15], v[48:51], a[176:183], v64
    ds_read_b128 v[48:51], v69 offset:15360
    s_waitcnt lgkmcnt(1)
    v_cmp_ne_u32 vcc, 0, v77
    v_smfmac_f32_16x16x64_bf16 v[0:3], v[52:55], a[48:55], v64
    v_smfmac_f32_16x16x64_bf16 v[8:11], v[52:55], a[184:191], v64
    s_cbranch_vccnz cs_spin8
cs_back8:
    v_smfmac_f32_16x16x64_bf16 v[0:3], v[44:47], a[64:71], v64
    v_smfmac_f32_16x16x64_bf16 v[8:11], v[44:47], a[200:207], v64
    v_smfmac_f32_16x16x64_bf16 v[0:3], v[40:43], a[80:87], v64
    s_nop 1
    v_smfmac_f32_16x16x64_bf16 v[8:11], v[40:43], a[216:223], v64
    s_nop 1
    v_lshrrev_b32 v77, 1, v69
    v_smfmac_f32_16x16x64_bf16 v[4:7], v[52:55], a[56:63], v64
    s_nop 1
    v_cvt_pk_bf16_f32 v0, v0, v1
    v_smfmac_f32_16x16x64_bf16 v[12:15], v[52:55], a[192:199], v64
    s_nop 1
    v_cvt_pk_bf16_f32 v1, v2, v3
    v_smfmac_f32_16x16x64_bf16 v[4:7], v[44:47], a[72:79], v64
    s_nop 1
    v_cvt_pk_bf16_f32 v2, v8, v9
    v_smfmac_f32_16x16x64_bf16 v[12:15], v[44:47], a[208:215], v64
    s_nop 1
    v_cvt_pk_bf16_f32 v3, v10, v11
    v_smfmac_f32_16x16x64_bf16 v[4:7], v[40:43], a[88:95], v64
    s_waitcnt lgkmcnt(0)
    s_nop 0
    s_nop 0
    v_smfmac_f32_16x16x64_bf16 v[12:15], v[40:43], a[224:231], v64
    s_nop 2
    v_mfma_f32_16x16x32_bf16 v[8:11], v[0:3], v[48:51], 0
    s_nop 0
    v_cvt_pk_bf16_f32 v4, v4, v5
    v_cvt_pk_bf16_f32 v5, v6, v7
    s_nop 0
    v_cvt_pk_bf16_f32 v6, v12, v13
    v_cvt_pk_bf16_f32 v7, v14, v15
    s_nop 1
    v_mfma_f32_16x16x32_bf16 v[12:15], v[4:7], v[48:51], 0
    ds_read_b128 v[48:51], v66 offset:4096
    v_cvt_pk_bf16_f32 v0, v8, v9
    v_cvt_pk_bf16_f32 v1, v10, v11
    v_smfmac_f32_16x16x64_bf16 v[16:19], v[52:55], v[208:215], v64
    s_waitcnt vmcnt(2)
    s_nop 2
    v_cvt_pk_bf16_f32 v2, v12, v13
    v_cvt_pk_bf16_f32 v3, v14, v15
    s_nop 1
    v_mfma_f32_16x16x32_bf16 v[12:15], v[0:3], v[0:3], 0
    s_nop 1
    v_bitop3_b32 v78, v73, -9, s53 bitop3:0x6a
    v_mfma_f32_16x16x32_bf16 v[4:7], v[24:27], v[0:3], 0
    ds_read_b128 v[24:27], v67 offset:0
    s_nop 1
    v_mfma_f32_16x16x32_bf16 v[8:11], v[28:31], v[0:3], 0
    s_nop 0
    v_mov_b32_dpp v12, v14 row_ror:8 row_mask:0xf bank_mask:0xc
    v_mov_b32_dpp v13, v15 row_ror:8 row_mask:0xf bank_mask:0xc
    v_smfmac_f32_16x16x64_bf16 v[20:23], v[52:55], v[216:223], v64
    ds_write_b64 v71, v[12:13]
    ds_read_b128 v[52:55], v68 offset:0
    s_nop 1
    v_mov_b32_dpp v4, v8 row_ror:8 row_mask:0xf bank_mask:0xc
    v_mov_b32_dpp v5, v9 row_ror:8 row_mask:0xf bank_mask:0xc
    v_mov_b32_dpp v6, v10 row_ror:8 row_mask:0xf bank_mask:0xc
    v_mov_b32_dpp v7, v11 row_ror:8 row_mask:0xf bank_mask:0xc
    v_smfmac_f32_16x16x64_bf16 v[16:19], v[44:47], v[224:231], v64
    ds_write_b128 v65, v[4:7] offset:8192
    v_smfmac_f32_16x16x64_bf16 v[20:23], v[44:47], v[232:239], v64
    s_waitcnt lgkmcnt(3)
    v_smfmac_f32_16x16x64_bf16 v[16:19], v[24:27], v[144:151], v64
    s_waitcnt vmcnt(1)
    v_smfmac_f32_16x16x64_bf16 v[20:23], v[24:27], v[152:159], v64
    s_mov_b64 exec, s[38:39]
    buffer_store_dword v72, v75, s[4:7], s55 offen sc1
    s_mov_b64 exec, -1
    v_smfmac_f32_16x16x64_bf16 v[16:19], v[40:43], v[240:247], v64
    s_cmp_ge_u32 s30, 56
    s_waitcnt lgkmcnt(0)
    s_barrier
    ds_read_b128 v[8:11], v66 offset:8192
    v_smfmac_f32_16x16x64_bf16 v[20:23], v[40:43], v[248:255], v64
    ds_read_b128 v[12:15], v67 offset:8192
    v_smfmac_f32_16x16x64_bf16 v[16:19], v[48:51], v[192:199], v64
    ds_read_b128 v[44:47], v68 offset:8192
    v_smfmac_f32_16x16x64_bf16 v[20:23], v[48:51], v[200:207], v64
    ds_read_b64 v[24:25], v77 offset:14336
    ds_read_b64 v[26:27], v77 offset:14592
    v_smfmac_f32_16x16x64_bf16 v[16:19], v[52:55], v[160:167], v64
    ds_read_b64 v[28:29], v77 offset:14848
    ds_read_b64 v[30:31], v77 offset:15104
    v_bitop3_b32 v77, v73, -9, s52 bitop3:0x6a
    v_smfmac_f32_16x16x64_bf16 v[20:23], v[52:55], v[168:175], v64
    s_cbranch_scc1 cs_rare
cs_rare_x:
    ds_read_b128 v[48:51], v70 offset:22528
    ds_read_b128 v[52:55], v70 offset:23552
    s_waitcnt lgkmcnt(6)
    v_pk_add_f32 v[4:5], v[4:5], v[8:9]
    v_pk_add_f32 v[6:7], v[6:7], v[10:11]
    v_pk_add_f32 v[12:13], v[12:13], v[44:45]
    v_pk_add_f32 v[14:15], v[14:15], v[46:47]
    v_pk_add_f32 v[4:5], v[4:5], v[12:13]
    v_pk_add_f32 v[6:7], v[6:7], v[14:15]
    s_waitcnt lgkmcnt(2)
    v_pk_add_f32 v[24:25], v[24:25], v[26:27]
    v_pk_add_f32 v[28:29], v[28:29], v[30:31]
    v_max3_f32 v8, v4, v5, v6
    v_pk_add_f32 v[24:25], v[24:25], v[28:29]
    v_max_f32 v8, v8, v7
    v_max3_f32 v8, v8, v24, v25
    v_cvt_pk_bf16_f32 v32, v16, v17
    v_cvt_pk_bf16_f32 v38, v18, v19
    v_max_f32_dpp v8, v8, v8 row_ror:8 row_mask:0xf bank_mask:0xf
    v_mov_b32 v9, v8
    v_cvt_pk_bf16_f32 v56, v20, v21
    v_cvt_pk_bf16_f32 v62, v22, v23
    v_permlane32_swap_b32 v8, v9
    v_max_f32 v8, v8, v9
    v_mov_b32 v9, v8
    v_mov_b32 v11, 0
    v_mov_b32 v15, 0
    v_permlane16_swap_b32 v8, v9
    v_max_f32 v8, v8, v9
    v_mul_f32 v8, s66, v8
    v_pk_fma_f32 v[4:5], v[4:5], s[44:45], v[8:9] op_sel_hi:[1,1,0]
    v_pk_fma_f32 v[6:7], v[6:7], s[44:45], v[8:9] op_sel_hi:[1,1,0]
    v_pk_fma_f32 v[24:25], v[24:25], s[44:45], v[8:9] op_sel_hi:[1,1,0]
    v_exp_f32 v4, v4
    v_exp_f32 v5, v5
    v_exp_f32 v6, v6
    v_exp_f32 v7, v7
    v_exp_f32 v24, v24
    v_exp_f32 v25, v25
    v_cvt_pk_bf16_f32 v12, v4, v5
    v_cvt_pk_bf16_f32 v13, v6, v7
    v_cvt_pk_bf16_f32 v10, v24, v25
    v_cvt_pk_bf16_f32 v14, v24, v25
    v_mov_b64 v[0:1], s[48:49]
    v_mfma_f32_16x16x32_bf16 v[4:7], v[32:35], v[10:13], 0
    ds_read_b128 v[40:43], v70 offset:20480
    v_mov_b64 v[2:3], s[50:51]
    v_mfma_f32_16x16x32_bf16 v[24:27], v[36:39], v[12:15], 0
    ds_read_b128 v[44:47], v70 offset:21504
    v_mov_b64 v[8:9], 0
    v_mfma_f32_16x16x32_bf16 v[28:31], v[0:3], v[10:13], 0
    ds_read_b128 v[32:35], v70 offset:24576
    v_mov_b64 v[0:1], 0
    v_mfma_f32_16x16x32_bf16 v[16:19], v[56:59], v[10:13], 0
    ds_read_b128 v[36:39], v70 offset:25600
    v_mov_b64 v[2:3], 0
    v_mfma_f32_16x16x32_bf16 v[20:23], v[60:63], v[12:15], 0
    ds_read_b128 v[56:59], v70 offset:28672
    v_add_f32_dpp v4, v24, v4 row_ror:8 row_mask:0xf bank_mask:0xf
    v_add_f32_dpp v5, v25, v5 row_ror:8 row_mask:0xf bank_mask:0xf
    v_add_f32_dpp v6, v26, v6 row_ror:8 row_mask:0xf bank_mask:0xf
    v_add_f32_dpp v7, v27, v7 row_ror:8 row_mask:0xf bank_mask:0xf
    v_add_f32_dpp v29, v28, v28 row_ror:8 row_mask:0xf bank_mask:0xf
    v_rcp_f32 v28, v29
    v_mov_b64 v[10:11], 0
    v_add_f32_dpp v4, v16, v20 row_ror:8 row_mask:0xf bank_mask:0xc
    v_add_f32_dpp v5, v17, v21 row_ror:8 row_mask:0xf bank_mask:0xc
    v_add_f32_dpp v6, v18, v22 row_ror:8 row_mask:0xf bank_mask:0xc
    v_add_f32_dpp v7, v19, v23 row_ror:8 row_mask:0xf bank_mask:0xc
    v_pk_mul_f32 v[4:5], v[4:5], v[28:29] op_sel_hi:[1,0]
    v_pk_mul_f32 v[6:7], v[6:7], v[28:29] op_sel_hi:[1,0]
    v_cvt_pk_bf16_f32 v4, v4, v5
    v_cvt_pk_bf16_f32 v5, v6, v7
    ds_write_b64 v73, v[4:5] offset:12288
    v_mov_b32_dpp v6, v4 row_ror:8 row_mask:0xf bank_mask:0xf
    v_mov_b32_dpp v7, v5 row_ror:8 row_mask:0xf bank_mask:0xf
    v_mov_b64 v[12:13], 0
    v_mov_b64 v[14:15], 0
    v_smfmac_f32_16x16x64_bf16 v[8:11], v[4:7], v[80:87], v64
    s_waitcnt lgkmcnt(4)
    v_mov_b64 v[24:25], 0
    v_smfmac_f32_16x16x64_bf16 v[0:3], v[4:7], v[40:47], v64
    ds_read_b128 v[60:63], v70 offset:29696
    v_mov_b64 v[26:27], 0
    v_smfmac_f32_16x16x64_bf16 v[12:15], v[4:7], v[112:119], v64
    s_waitcnt lgkmcnt(1)
    s_barrier
    ds_read_b128 v[16:19], v77 offset:12288
    v_smfmac_f32_16x16x64_bf16 v[24:27], v[4:7], v[48:55], v64
    ds_read_b128 v[20:23], v78 offset:12288
    ds_read_b128 v[28:31], v79 offset:12288
    v_mov_b64 v[4:5], 0
    v_mov_b64 v[6:7], 0
    v_bfe_u32 v77, v74, 16, 1
    v_mad_i32_i24 v77, v77, s56, v74
    s_waitcnt lgkmcnt(2)
    v_smfmac_f32_16x16x64_bf16 v[8:11], v[16:19], v[88:95], v64
    ds_read_b128 v[40:43], v70 offset:32768
    s_waitcnt lgkmcnt(2)
    v_smfmac_f32_16x16x64_bf16 v[8:11], v[20:23], v[96:103], v64
    ds_read_b128 v[44:47], v70 offset:33792
    s_waitcnt lgkmcnt(2)
    v_smfmac_f32_16x16x64_bf16 v[8:11], v[28:31], v[104:111], v64
    ds_read_b128 v[48:51], v70 offset:26624
    s_nop 0
    v_and_b32 v72, 8, v73
    v_smfmac_f32_16x16x64_bf16 v[0:3], v[16:19], v[32:39], v64
    ds_read_b128 v[52:55], v70 offset:27648
    s_nop 0
    v_mad_u32_u24 v72, v72, 63, v73
    v_smfmac_f32_16x16x64_bf16 v[12:15], v[16:19], v[120:127], v64
    ds_read_b128 v[32:35], v70 offset:30720
    v_cvt_pk_bf16_f32 v8, v8, v9
    v_cvt_pk_bf16_f32 v9, v10, v11
    v_and_or_b32 v8, v8, -2, s69
    v_smfmac_f32_16x16x64_bf16 v[12:15], v[20:23], v[128:135], v64
    buffer_store_dwordx2 v[8:9], v74, s[4:7], s22 offen offset:0 sc1
    ds_read_b128 v[36:39], v70 offset:31744
    v_smfmac_f32_16x16x64_bf16 v[12:15], v[28:31], v[136:143], v64
    s_add_u32 s30, s30, 1
    s_xor_b32 s70, s70, 1
    v_subrev_u32 v72, s47, v72
    v_smfmac_f32_16x16x64_bf16 v[0:3], v[20:23], v[56:63], v64
    ds_read_b128 v[56:59], v70 offset:34816
    s_waitcnt lgkmcnt(3)
    s_nop 0
    v_smfmac_f32_16x16x64_bf16 v[0:3], v[28:31], v[40:47], v64
    ds_read_b128 v[60:63], v70 offset:35840
    v_cvt_pk_bf16_f32 v12, v12, v13
    v_cvt_pk_bf16_f32 v13, v14, v15
    v_and_or_b32 v12, v12, -2, s69
    v_smfmac_f32_16x16x64_bf16 v[24:27], v[16:19], v[48:55], v64
    buffer_store_dwordx2 v[12:13], v74, s[4:7], s22 offen offset:64 sc1
    s_waitcnt lgkmcnt(2)
    v_smfmac_f32_16x16x64_bf16 v[24:27], v[20:23], v[32:39], v64
    ds_read_b128 v[40:43], v70 offset:16384
    v_cvt_pk_bf16_f32 v0, v0, v1
    v_cvt_pk_bf16_f32 v1, v2, v3
    v_and_or_b32 v0, v0, -2, s69
    s_waitcnt lgkmcnt(1)
    v_smfmac_f32_16x16x64_bf16 v[24:27], v[28:31], v[56:63], v64
    buffer_store_dwordx2 v[0:1], v74, s[4:7], s23 offen offset:0 sc1
    ds_read_b128 v[44:47], v70 offset:17408
    ds_read_b128 v[8:11], v72 offset:12288
    ds_read_b128 v[48:51], v70 offset:18432
    ds_read_b128 v[52:55], v70 offset:19456
    ds_read_b128 v[12:15], v72 offset:13312
    s_cmp_lg_u32 s71, 0
    s_nop 0
    v_cvt_pk_bf16_f32 v24, v24, v25
    v_cvt_pk_bf16_f32 v25, v26, v27
    v_and_or_b32 v24, v24, -2, s69
    buffer_store_dwordx2 v[24:25], v74, s[4:7], s23 offen offset:64 sc1
    s_waitcnt lgkmcnt(3)
    v_smfmac_f32_16x16x64_bf16 v[4:7], v[8:11], v[40:47], v64
    s_waitcnt lgkmcnt(0)
    v_smfmac_f32_16x16x64_bf16 v[4:7], v[12:15], v[48:55], v64
    s_nop 7
    v_cvt_pk_bf16_f32 v4, v4, v5
    v_cvt_pk_bf16_f32 v5, v6, v7
    v_and_or_b32 v4, v4, -2, s69
    buffer_store_dwordx2 v[4:5], v77, s[4:7], s25 offen offset:0 sc1
    s_nop 0
    s_cbranch_scc1 cs_e1
    s_cmp_lg_u32 s37, 0
    s_cbranch_scc1 cs_f0_xt
cs_f0_xtx:
    s_nop 2
    v_mov_b32 v79, v79
    s_nop 2
    v_mov_b32 v79, v79
    s_nop 2
    v_mov_b32 v79, v79
    s_nop 2
    v_mov_b32 v79, v79
    s_nop 2
    v_mov_b32 v79, v79
    s_nop 2
    v_mov_b32 v79, v79
    s_nop 2
    v_mov_b32 v79, v79
    s_nop 2
    v_mov_b32 v79, v79
    s_nop 2
    v_mov_b32 v79, v79
    s_nop 2
    v_mov_b32 v79, v79
    s_nop 2
    v_mov_b32 v79, v79
    s_nop 2
    v_mov_b32 v79, v79
    s_nop 2
    v_mov_b32 v79, v79
    s_nop 2
    v_mov_b32 v79, v79
    s_nop 2
    v_mov_b32 v79, v79
    s_nop 2
    v_mov_b32 v79, v79
    s_nop 2
    v_mov_b32 v79, v79
    s_nop 2
    v_mov_b32 v79, v79
    s_nop 2
    v_mov_b32 v79, v79
    s_nop 2
    v_mov_b32 v79, v79
    s_nop 2
    v_mov_b32 v79, v79
    s_nop 2
    v_mov_b32 v79, v79
    s_nop 2
    v_mov_b32 v79, v79
    s_nop 2
    v_mov_b32 v79, v79
    s_nop 2
    v_mov_b32 v79, v79
    s_nop 2
    v_mov_b32 v79, v79
    s_nop 2
    v_mov_b32 v79, v79
    s_nop 2
    v_mov_b32 v79, v79
    s_nop 2
    v_mov_b32 v79, v79
    s_nop 2
    v_mov_b32 v79, v79
    s_nop 2
    v_mov_b32 v79, v79
    s_nop 2
    v_mov_b32 v79, v79
    s_nop 2
    v_mov_b32 v79, v79
    s_nop 2
    v_mov_b32 v79, v79
    s_nop 2
    v_mov_b32 v79, v79
    s_nop 2
    v_mov_b32 v79, v79
    s_nop 0
    v_mov_b32 v79, v79
    buffer_load_dwordx4 v[8:11], v65, s[4:7], s18 offen sc1
    buffer_load_dwordx4 v[12:15], v65, s[4:7], s19 offen sc1
    buffer_load_dwordx4 v[16:19], v65, s[4:7], s20 offen sc1
    buffer_load_dwordx4 v[20:23], v65, s[4:7], s21 offen sc1
    v_and_b32 v77, 255, v69
    ds_read_b128 v[4:7], v77 offset:15872
    ds_read_b128 v[44:47], v70 offset:0
    ds_read_b128 v[48:51], v70 offset:1024
    ds_read_b128 v[52:55], v70 offset:2048
    ds_read_b128 v[56:59], v70 offset:3072
    ds_read_b128 v[24:27], v70 offset:4096
    ds_read_b128 v[28:31], v70 offset:5120
    ds_read_b128 v[32:35], v70 offset:6144
    ds_read_b128 v[36:39], v70 offset:7168
    s_mov_b32 s31, 65536
    s_add_u32 s24, s24, 524288
    s_add_u32 s26, s26, 524288
    s_add_u32 s55, s55, s57
    s_mov_b32 s14, 67633152
    s_mov_b32 s15, 67637248
    s_mov_b32 s16, 67641344
    s_mov_b32 s36, 1
    v_mov_b32 v40, s69
    v_mov_b32 v60, s69
    v_mov_b32 v79, 1
    s_waitcnt lgkmcnt(0)
    s_waitcnt vmcnt(3)
    v_bitop3_b32 v77, v8, v10, s69 bitop3:0x7e
    v_mfma_f32_16x16x32_bf16 v[0:3], v[4:7], v[8:11], 0
    v_mov_b64 v[8:9], 0
    v_mov_b64 v[10:11], 0
    s_waitcnt vmcnt(2)
    v_bitop3_b32 v78, v12, v14, s69 bitop3:0x7e
    v_mfma_f32_16x16x32_bf16 v[0:3], v[4:7], v[12:15], v[0:3]
    v_or_b32 v77, v77, v78
    v_mov_b64 v[12:13], 0
    v_mov_b64 v[14:15], 0
    s_waitcnt vmcnt(1)
    v_bitop3_b32 v78, v16, v18, s69 bitop3:0x7e
    v_mfma_f32_16x16x32_bf16 v[0:3], v[4:7], v[16:19], v[0:3]
    v_or_b32 v77, v77, v78
    v_mov_b64 v[16:17], 0
    v_mov_b64 v[18:19], 0
    s_waitcnt vmcnt(0)
    v_bitop3_b32 v78, v20, v22, s69 bitop3:0x7e
    v_mfma_f32_16x16x32_bf16 v[0:3], v[4:7], v[20:23], v[0:3]
    v_bitop3_b32 v77, v77, v78, 1 bitop3:0xa8
    v_cmp_ne_u32 vcc, 0, v77
    v_mov_b64 v[20:21], 0
    v_mov_b64 v[22:23], 0
    s_cmp_eq_u64 vcc, 0
    s_cselect_b64 s[42:43], -1, 0
    s_nop 1
    v_add_f32_dpp v0, v0, v0 row_ror:8 row_mask:0xf bank_mask:0xf
    v_add_f32_dpp v1, v1, v1 row_ror:8 row_mask:0xf bank_mask:0xf
    s_mov_b64 exec, s[42:43]
    v_cvt_pk_bf16_f32 v72, v0, v1
    v_bfi_b32 v72, v79, s70, v72
    buffer_store_dword v72, v75, s[4:7], s17 offen offset:0 sc1
    s_mov_b64 exec, -1
    s_cbranch_scc0 cs_f0_retry
cs_f0_go:
    v_mov_b64 v[0:1], 0
    v_mov_b64 v[2:3], 0
    v_mov_b64 v[4:5], 0
    v_mov_b64 v[6:7], 0
    s_nop 2
    v_mov_b32 v79, v79
    s_nop 2
    v_mov_b32 v79, v79
    s_nop 2
    v_mov_b32 v79, v79
    s_nop 2
    v_mov_b32 v79, v79
    s_nop 2
    v_mov_b32 v79, v79
    s_nop 2
    v_mov_b32 v79, v79
    s_nop 2
    v_mov_b32 v79, v79
    s_nop 2
    v_mov_b32 v79, v79
    s_nop 2
    v_mov_b32 v79, v79
    s_nop 2
    v_mov_b32 v79, v79
    s_nop 2
    v_mov_b32 v79, v79
    s_nop 2
    v_mov_b32 v79, v79
    s_nop 2
    v_mov_b32 v79, v79
    s_nop 2
    v_mov_b32 v79, v79
    s_nop 2
    v_mov_b32 v79, v79
    s_nop 2
    v_mov_b32 v79, v79
    s_nop 2
    v_mov_b32 v79, v79
    s_nop 2
    v_mov_b32 v79, v79
    s_nop 2
    v_mov_b32 v79, v79
    s_nop 2
    v_mov_b32 v79, v79
    s_nop 2
    v_mov_b32 v79, v79
    s_nop 2
    v_mov_b32 v79, v79
    s_nop 2
    v_mov_b32 v79, v79
    s_nop 2
    v_mov_b32 v79, v79
    s_nop 2
    v_mov_b32 v79, v79
    s_branch cs_loop
cs_e1:
    s_cmp_lg_u32 s71, 2
    s_cbranch_scc1 cs_f1
    v_and_b32 v77, 255, v69
    ds_read_b128 v[4:7], v77 offset:15872
    ds_read_b128 v[44:47], v70 offset:0
    ds_read_b128 v[48:51], v70 offset:1024
    ds_read_b128 v[52:55], v70 offset:2048
    ds_read_b128 v[56:59], v70 offset:3072
    ds_read_b128 v[24:27], v70 offset:4096
    ds_read_b128 v[28:31], v70 offset:5120
    ds_read_b128 v[32:35], v70 offset:6144
    ds_read_b128 v[36:39], v70 offset:7168
    s_mov_b32 s31, 65536
    s_add_u32 s24, s24, 524288
    s_add_u32 s26, s26, 524288
    s_add_u32 s55, s55, s57
    s_mov_b32 s14, 67633152
    s_mov_b32 s15, 67637248
    s_mov_b32 s16, 67641344
    s_mov_b32 s36, 1
    v_mov_b32 v40, s69
    v_mov_b32 v60, s69
    v_mov_b32 v79, 1
    s_cmp_lg_u32 s37, 0
    s_cbranch_scc1 cs_f2_xt
cs_f2_xtx:
    s_nop 2
    v_mov_b32 v79, v79
    s_nop 2
    v_mov_b32 v79, v79
    s_nop 2
    v_mov_b32 v79, v79
    s_nop 2
    v_mov_b32 v79, v79
    s_nop 2
    v_mov_b32 v79, v79
    s_nop 2
    v_mov_b32 v79, v79
    s_nop 2
    v_mov_b32 v79, v79
    s_nop 2
    v_mov_b32 v79, v79
    s_nop 2
    v_mov_b32 v79, v79
    s_nop 2
    v_mov_b32 v79, v79
    s_nop 2
    v_mov_b32 v79, v79
    s_nop 2
    v_mov_b32 v79, v79
    s_nop 2
    v_mov_b32 v79, v79
    s_nop 2
    v_mov_b32 v79, v79
    s_nop 2
    v_mov_b32 v79, v79
    s_nop 2
    v_mov_b32 v79, v79
    s_nop 2
    v_mov_b32 v79, v79
    s_nop 2
    v_mov_b32 v79, v79
    s_nop 2
    v_mov_b32 v79, v79
    s_nop 2
    v_mov_b32 v79, v79
    s_nop 2
    v_mov_b32 v79, v79
    s_nop 2
    v_mov_b32 v79, v79
    s_nop 2
    v_mov_b32 v79, v79
    s_nop 2
    v_mov_b32 v79, v79
    s_nop 2
    v_mov_b32 v79, v79
    s_nop 2
    v_mov_b32 v79, v79
    s_nop 2
    v_mov_b32 v79, v79
    s_nop 2
    v_mov_b32 v79, v79
    s_nop 2
    v_mov_b32 v79, v79
    s_nop 2
    v_mov_b32 v79, v79
    s_nop 2
    v_mov_b32 v79, v79
    s_nop 2
    v_mov_b32 v79, v79
    s_nop 2
    v_mov_b32 v79, v79
    s_nop 2
    v_mov_b32 v79, v79
    s_nop 2
    v_mov_b32 v79, v79
    s_nop 2
    v_mov_b32 v79, v79
    s_nop 0
    v_mov_b32 v79, v79
    s_waitcnt vmcnt(0)
    buffer_load_dwordx4 v[8:11], v65, s[4:7], s18 offen sc1
    buffer_load_dwordx4 v[12:15], v65, s[4:7], s19 offen sc1
    buffer_load_dwordx4 v[16:19], v65, s[4:7], s20 offen sc1
    buffer_load_dwordx4 v[20:23], v65, s[4:7], s21 offen sc1
    s_nop 2
    v_mov_b32 v79, v79
    s_nop 2
    v_mov_b32 v79, v79
    s_nop 2
    v_mov_b32 v79, v79
    s_nop 2
    v_mov_b32 v79, v79
    s_nop 2
    v_mov_b32 v79, v79
    s_nop 2
    v_mov_b32 v79, v79
    s_nop 2
    v_mov_b32 v79, v79
    s_nop 2
    v_mov_b32 v79, v79
    s_nop 2
    v_mov_b32 v79, v79
    s_nop 2
    v_mov_b32 v79, v79
    buffer_load_dwordx4 v[40:43], v65, s[4:7], s14 offen offset:0 sc1
    buffer_load_dwordx4 v[60:63], v66, s[4:7], s14 offen offset:0 sc1
    s_waitcnt lgkmcnt(0)
    s_waitcnt vmcnt(5)
    v_bitop3_b32 v77, v8, v10, s69 bitop3:0x7e
    v_mfma_f32_16x16x32_bf16 v[0:3], v[4:7], v[8:11], 0
    v_mov_b64 v[8:9], 0
    v_mov_b64 v[10:11], 0
    s_waitcnt vmcnt(4)
    v_bitop3_b32 v78, v12, v14, s69 bitop3:0x7e
    v_mfma_f32_16x16x32_bf16 v[0:3], v[4:7], v[12:15], v[0:3]
    v_or_b32 v77, v77, v78
    v_mov_b64 v[12:13], 0
    v_mov_b64 v[14:15], 0
    s_waitcnt vmcnt(3)
    v_bitop3_b32 v78, v16, v18, s69 bitop3:0x7e
    v_mfma_f32_16x16x32_bf16 v[0:3], v[4:7], v[16:19], v[0:3]
    v_or_b32 v77, v77, v78
    v_mov_b64 v[16:17], 0
    v_mov_b64 v[18:19], 0
    s_waitcnt vmcnt(2)
    v_bitop3_b32 v78, v20, v22, s69 bitop3:0x7e
    v_mfma_f32_16x16x32_bf16 v[0:3], v[4:7], v[20:23], v[0:3]
    v_bitop3_b32 v77, v77, v78, 1 bitop3:0xa8
    v_cmp_ne_u32 vcc, 0, v77
    v_mov_b64 v[20:21], 0
    v_mov_b64 v[22:23], 0
    buffer_load_dwordx4 v[40:43], v65, s[4:7], s14 offen offset:0 sc1
    buffer_load_dwordx4 v[60:63], v66, s[4:7], s14 offen offset:0 sc1
    s_cmp_eq_u64 vcc, 0
    s_cselect_b64 s[42:43], -1, 0
    v_add_f32_dpp v0, v0, v0 row_ror:4 row_mask:0xf bank_mask:0xf
    v_add_f32_dpp v1, v1, v1 row_ror:4 row_mask:0xf bank_mask:0xf
    s_nop 0
    v_add_f32_dpp v0, v0, v0 row_ror:8 row_mask:0xf bank_mask:0xf
    v_add_f32_dpp v1, v1, v1 row_ror:8 row_mask:0xf bank_mask:0xf
    s_mov_b64 exec, s[42:43]
    v_cvt_pk_bf16_f32 v72, v0, v1
    v_bfi_b32 v72, v79, s70, v72
    buffer_store_dword v72, v75, s[4:7], s17 offen offset:0 sc1
    buffer_store_dword v72, v75, s[4:7], s17 offen offset:1024 sc1
    buffer_store_dword v72, v75, s[4:7], s17 offen offset:2048 sc1
    buffer_store_dword v72, v75, s[4:7], s17 offen offset:3072 sc1
    s_mov_b64 exec, -1
    s_cbranch_scc0 cs_f2_retry
cs_f2_go:
    v_mov_b64 v[0:1], 0
    v_mov_b64 v[2:3], 0
    v_mov_b64 v[4:5], 0
    v_mov_b64 v[6:7], 0
    s_nop 2
    v_mov_b32 v79, v79
    s_nop 2
    v_mov_b32 v79, v79
    s_nop 2
    v_mov_b32 v79, v79
    s_nop 2
    v_mov_b32 v79, v79
    s_nop 2
    v_mov_b32 v79, v79
    s_nop 2
    v_mov_b32 v79, v79
    s_nop 2
    v_mov_b32 v79, v79
    s_nop 2
    v_mov_b32 v79, v79
    s_nop 2
    v_mov_b32 v79, v79
    s_nop 2
    v_mov_b32 v79, v79
    s_nop 2
    v_mov_b32 v79, v79
    s_nop 2
    v_mov_b32 v79, v79
    s_nop 2
    v_mov_b32 v79, v79
    s_nop 2
    v_mov_b32 v79, v79
    s_nop 2
    v_mov_b32 v79, v79
    s_nop 2
    v_mov_b32 v79, v79
    s_nop 2
    v_mov_b32 v79, v79
    s_nop 2
    v_mov_b32 v79, v79
    s_nop 2
    v_mov_b32 v79, v79
    s_nop 2
    v_mov_b32 v79, v79
    s_nop 2
    v_mov_b32 v79, v79
    s_nop 2
    v_mov_b32 v79, v79
    s_nop 2
    v_mov_b32 v79, v79
    s_nop 2
    v_mov_b32 v79, v79
    s_nop 2
    v_mov_b32 v79, v79
    s_branch cs_loop
cs_f1:
    s_cmp_lg_u32 s32, 1
    s_cbranch_scc1 cs_f3
    v_and_b32 v77, 255, v69
    ds_read_b128 v[4:7], v77 offset:15872
    ds_read_b128 v[44:47], v70 offset:0
    ds_read_b128 v[48:51], v70 offset:1024
    ds_read_b128 v[52:55], v70 offset:2048
    ds_read_b128 v[56:59], v70 offset:3072
    ds_read_b128 v[24:27], v70 offset:4096
    ds_read_b128 v[28:31], v70 offset:5120
    ds_read_b128 v[32:35], v70 offset:6144
    ds_read_b128 v[36:39], v70 offset:7168
    s_mov_b32 s31, 65536
    s_add_u32 s24, s24, 524288
    s_add_u32 s26, s26, 524288
    s_add_u32 s55, s55, s57
    s_mov_b32 s14, 67633152
    s_mov_b32 s15, 67637248
    s_mov_b32 s16, 67641344
    s_mov_b32 s36, 1
    v_mov_b32 v40, s69
    v_mov_b32 v60, s69
    v_mov_b32 v79, 1
    s_cmp_lg_u32 s37, 0
    s_cbranch_scc1 cs_f1_xt
cs_f1_xtx:
    s_nop 2
    v_mov_b32 v79, v79
    s_nop 2
    v_mov_b32 v79, v79
    s_nop 2
    v_mov_b32 v79, v79
    s_nop 2
    v_mov_b32 v79, v79
    s_nop 2
    v_mov_b32 v79, v79
    s_nop 2
    v_mov_b32 v79, v79
    s_nop 2
    v_mov_b32 v79, v79
    s_nop 2
    v_mov_b32 v79, v79
    s_nop 2
    v_mov_b32 v79, v79
    s_nop 2
    v_mov_b32 v79, v79
    s_nop 2
    v_mov_b32 v79, v79
    s_nop 2
    v_mov_b32 v79, v79
    s_nop 2
    v_mov_b32 v79, v79
    s_nop 2
    v_mov_b32 v79, v79
    s_nop 2
    v_mov_b32 v79, v79
    s_nop 2
    v_mov_b32 v79, v79
    s_nop 2
    v_mov_b32 v79, v79
    s_nop 2
    v_mov_b32 v79, v79
    s_nop 2
    v_mov_b32 v79, v79
    s_nop 2
    v_mov_b32 v79, v79
    s_nop 2
    v_mov_b32 v79, v79
    s_nop 2
    v_mov_b32 v79, v79
    s_nop 2
    v_mov_b32 v79, v79
    s_nop 2
    v_mov_b32 v79, v79
    s_nop 2
    v_mov_b32 v79, v79
    s_nop 2
    v_mov_b32 v79, v79
    s_nop 2
    v_mov_b32 v79, v79
    s_nop 2
    v_mov_b32 v79, v79
    s_nop 2
    v_mov_b32 v79, v79
    s_nop 2
    v_mov_b32 v79, v79
    s_nop 2
    v_mov_b32 v79, v79
    s_nop 2
    v_mov_b32 v79, v79
    s_nop 2
    v_mov_b32 v79, v79
    s_nop 2
    v_mov_b32 v79, v79
    s_nop 2
    v_mov_b32 v79, v79
    s_nop 2
    v_mov_b32 v79, v79
    s_nop 0
    v_mov_b32 v79, v79
    s_waitcnt vmcnt(0)
    buffer_load_dwordx4 v[8:11], v65, s[4:7], s18 offen sc1
    buffer_load_dwordx4 v[12:15], v65, s[4:7], s19 offen sc1
    buffer_load_dwordx4 v[16:19], v65, s[4:7], s20 offen sc1
    buffer_load_dwordx4 v[20:23], v65, s[4:7], s21 offen sc1
    s_nop 2
    v_mov_b32 v79, v79
    s_nop 2
    v_mov_b32 v79, v79
    s_nop 2
    v_mov_b32 v79, v79
    s_nop 2
    v_mov_b32 v79, v79
    s_nop 2
    v_mov_b32 v79, v79
    s_nop 2
    v_mov_b32 v79, v79
    s_nop 2
    v_mov_b32 v79, v79
    s_nop 2
    v_mov_b32 v79, v79
    s_nop 2
    v_mov_b32 v79, v79
    s_nop 2
    v_mov_b32 v79, v79
    buffer_load_dwordx4 v[40:43], v65, s[4:7], s14 offen offset:0 sc1
    buffer_load_dwordx4 v[60:63], v66, s[4:7], s14 offen offset:0 sc1
    s_waitcnt lgkmcnt(0)
    s_waitcnt vmcnt(5)
    v_bitop3_b32 v77, v8, v10, s69 bitop3:0x7e
    v_mfma_f32_16x16x32_bf16 v[0:3], v[4:7], v[8:11], 0
    v_mov_b64 v[8:9], 0
    v_mov_b64 v[10:11], 0
    s_waitcnt vmcnt(4)
    v_bitop3_b32 v78, v12, v14, s69 bitop3:0x7e
    v_mfma_f32_16x16x32_bf16 v[0:3], v[4:7], v[12:15], v[0:3]
    v_or_b32 v77, v77, v78
    v_mov_b64 v[12:13], 0
    v_mov_b64 v[14:15], 0
    s_waitcnt vmcnt(3)
    v_bitop3_b32 v78, v16, v18, s69 bitop3:0x7e
    v_mfma_f32_16x16x32_bf16 v[0:3], v[4:7], v[16:19], v[0:3]
    v_or_b32 v77, v77, v78
    v_mov_b64 v[16:17], 0
    v_mov_b64 v[18:19], 0
    s_waitcnt vmcnt(2)
    v_bitop3_b32 v78, v20, v22, s69 bitop3:0x7e
    v_mfma_f32_16x16x32_bf16 v[0:3], v[4:7], v[20:23], v[0:3]
    v_bitop3_b32 v77, v77, v78, 1 bitop3:0xa8
    v_cmp_ne_u32 vcc, 0, v77
    v_mov_b64 v[20:21], 0
    v_mov_b64 v[22:23], 0
    buffer_load_dwordx4 v[40:43], v65, s[4:7], s14 offen offset:0 sc1
    buffer_load_dwordx4 v[60:63], v66, s[4:7], s14 offen offset:0 sc1
    s_cmp_eq_u64 vcc, 0
    s_cselect_b64 s[42:43], -1, 0
    v_add_f32_dpp v0, v0, v0 row_ror:8 row_mask:0xf bank_mask:0xf
    v_add_f32_dpp v1, v1, v1 row_ror:8 row_mask:0xf bank_mask:0xf
    s_mov_b64 exec, s[42:43]
    v_cvt_pk_bf16_f32 v72, v0, v1
    v_bfi_b32 v72, v79, s70, v72
    buffer_store_dword v72, v75, s[4:7], s17 offen offset:0 sc1
    s_mov_b64 exec, -1
    s_cbranch_scc0 cs_f1_retry
cs_f1_go:
    v_mov_b64 v[0:1], 0
    v_mov_b64 v[2:3], 0
    v_mov_b64 v[4:5], 0
    v_mov_b64 v[6:7], 0
    s_nop 2
    v_mov_b32 v79, v79
    s_nop 2
    v_mov_b32 v79, v79
    s_nop 2
    v_mov_b32 v79, v79
    s_nop 2
    v_mov_b32 v79, v79
    s_nop 2
    v_mov_b32 v79, v79
    s_nop 2
    v_mov_b32 v79, v79
    s_nop 2
    v_mov_b32 v79, v79
    s_nop 2
    v_mov_b32 v79, v79
    s_nop 2
    v_mov_b32 v79, v79
    s_nop 2
    v_mov_b32 v79, v79
    s_nop 2
    v_mov_b32 v79, v79
    s_nop 2
    v_mov_b32 v79, v79
    s_nop 2
    v_mov_b32 v79, v79
    s_nop 2
    v_mov_b32 v79, v79
    s_nop 2
    v_mov_b32 v79, v79
    s_nop 2
    v_mov_b32 v79, v79
    s_nop 2
    v_mov_b32 v79, v79
    s_nop 2
    v_mov_b32 v79, v79
    s_nop 2
    v_mov_b32 v79, v79
    s_nop 2
    v_mov_b32 v79, v79
    s_nop 2
    v_mov_b32 v79, v79
    s_nop 2
    v_mov_b32 v79, v79
    s_nop 2
    v_mov_b32 v79, v79
    s_nop 2
    v_mov_b32 v79, v79
    s_nop 2
    v_mov_b32 v79, v79
    s_branch cs_loop
cs_f3:
    v_and_b32 v77, 255, v69
    ds_read_b128 v[4:7], v77 offset:15872
    ds_read_b128 v[44:47], v70 offset:0
    ds_read_b128 v[48:51], v70 offset:1024
    ds_read_b128 v[52:55], v70 offset:2048
    ds_read_b128 v[56:59], v70 offset:3072
    ds_read_b128 v[24:27], v70 offset:4096
    ds_read_b128 v[28:31], v70 offset:5120
    ds_read_b128 v[32:35], v70 offset:6144
    ds_read_b128 v[36:39], v70 offset:7168
    s_mov_b32 s31, 65536
    s_add_u32 s24, s24, 524288
    s_add_u32 s26, s26, 524288
    s_add_u32 s55, s55, s57
    s_mov_b32 s14, 67633152
    s_mov_b32 s15, 67637248
    s_mov_b32 s16, 67641344
    s_mov_b32 s36, 1
    v_mov_b32 v40, s69
    v_mov_b32 v60, s69
    v_mov_b32 v79, 1
    s_add_u32 s40, s30, s95
    v_mov_b32 v72, s40
    s_waitcnt lgkmcnt(0)
    v_mov_b64 v[0:1], 0
    v_mov_b64 v[2:3], 0
    v_mov_b64 v[4:5], 0
    v_mov_b64 v[6:7], 0
    v_mov_b64 v[8:9], 0
    v_mov_b64 v[10:11], 0
    v_mov_b64 v[12:13], 0
    v_mov_b64 v[14:15], 0
    v_mov_b64 v[16:17], 0
    v_mov_b64 v[18:19], 0
    v_mov_b64 v[20:21], 0
    v_mov_b64 v[22:23], 0
    s_nop 2
    v_mov_b32 v79, v79
    s_nop 2
    v_mov_b32 v79, v79
    s_nop 2
    v_mov_b32 v79, v79
    s_nop 2
    v_mov_b32 v79, v79
    s_nop 2
    v_mov_b32 v79, v79
    s_nop 2
    v_mov_b32 v79, v79
    s_nop 2
    v_mov_b32 v79, v79
    s_nop 2
    v_mov_b32 v79, v79
    s_nop 2
    v_mov_b32 v79, v79
    s_nop 2
    v_mov_b32 v79, v79
    s_nop 2
    v_mov_b32 v79, v79
    s_nop 2
    v_mov_b32 v79, v79
    s_nop 2
    v_mov_b32 v79, v79
    s_nop 2
    v_mov_b32 v79, v79
    s_nop 2
    v_mov_b32 v79, v79
    s_nop 2
    v_mov_b32 v79, v79
    s_nop 2
    v_mov_b32 v79, v79
    s_nop 2
    v_mov_b32 v79, v79
    s_nop 2
    v_mov_b32 v79, v79
    s_nop 2
    v_mov_b32 v79, v79
    s_nop 2
    v_mov_b32 v79, v79
    s_nop 2
    v_mov_b32 v79, v79
    s_nop 2
    v_mov_b32 v79, v79
    s_nop 2
    v_mov_b32 v79, v79
    s_nop 2
    v_mov_b32 v79, v79
    s_nop 2
    v_mov_b32 v79, v79
    s_nop 2
    v_mov_b32 v79, v79
    s_nop 2
    v_mov_b32 v79, v79
    s_nop 2
    v_mov_b32 v79, v79
    s_nop 2
    v_mov_b32 v79, v79
    s_nop 2
    v_mov_b32 v79, v79
    s_nop 2
    v_mov_b32 v79, v79
    s_nop 2
    v_mov_b32 v79, v79
    s_nop 2
    v_mov_b32 v79, v79
    s_nop 2
    v_mov_b32 v79, v79
    s_nop 2
    v_mov_b32 v79, v79
    s_nop 2
    v_mov_b32 v79, v79
    s_nop 2
    v_mov_b32 v79, v79
    s_nop 2
    v_mov_b32 v79, v79
    s_nop 2
    v_mov_b32 v79, v79
    s_nop 2
    v_mov_b32 v79, v79
    s_nop 2
    v_mov_b32 v79, v79
    s_nop 2
    v_mov_b32 v79, v79
    s_nop 2
    v_mov_b32 v79, v79
    s_nop 2
    v_mov_b32 v79, v79
    s_nop 2
    v_mov_b32 v79, v79
    s_nop 2
    v_mov_b32 v79, v79
    s_nop 2
    v_mov_b32 v79, v79
    s_nop 2
    v_mov_b32 v79, v79
    s_nop 2
    v_mov_b32 v79, v79
    s_nop 2
    v_mov_b32 v79, v79
    s_nop 2
    v_mov_b32 v79, v79
    s_nop 2
    v_mov_b32 v79, v79
    s_nop 2
    v_mov_b32 v79, v79
    s_nop 2
    v_mov_b32 v79, v79
    s_nop 2
    v_mov_b32 v79, v79
    s_nop 2
    v_mov_b32 v79, v79
    s_nop 2
    v_mov_b32 v79, v79
    s_nop 2
    v_mov_b32 v79, v79
    s_nop 2
    v_mov_b32 v79, v79
    s_nop 2
    v_mov_b32 v79, v79
    s_nop 2
    v_mov_b32 v79, v79
    s_nop 2
    v_mov_b32 v79, v79
    s_nop 2
    v_mov_b32 v79, v79
    s_nop 2
    v_mov_b32 v79, v79
    s_waitcnt vmcnt(0)
    s_cmp_lt_u32 s97, s93
    s_cbranch_scc1 cs_kvwait
    s_nop 2
    v_mov_b32 v79, v79
    s_nop 2
    v_mov_b32 v79, v79
    s_nop 2
    v_mov_b32 v79, v79
    s_nop 2
    v_mov_b32 v79, v79
    s_nop 2
    v_mov_b32 v79, v79
    s_nop 2
    v_mov_b32 v79, v79
    s_nop 2
    v_mov_b32 v79, v79
    s_nop 2
    v_mov_b32 v79, v79
cs_kvok:
    s_branch cs_loop
cs_f0_xt:
    s_sub_u32 s37, s37, 1
    s_nop 2
    v_mov_b32 v79, v79
    s_nop 2
    v_mov_b32 v79, v79
    s_nop 2
    v_mov_b32 v79, v79
    s_nop 2
    v_mov_b32 v79, v79
    s_nop 2
    v_mov_b32 v79, v79
    s_nop 2
    v_mov_b32 v79, v79
    s_branch cs_f0_xtx
cs_f0_retry:
    s_sub_u32 s41, s30, s98
    s_mov_b32 s98, s30
    s_cmp_le_u32 s41, 3
    s_cselect_b32 s37, 1, 1
cs_f0_spin:
    buffer_load_dwordx4 v[8:11], v65, s[4:7], s18 offen sc1
    buffer_load_dwordx4 v[12:15], v65, s[4:7], s19 offen sc1
    buffer_load_dwordx4 v[16:19], v65, s[4:7], s20 offen sc1
    buffer_load_dwordx4 v[20:23], v65, s[4:7], s21 offen sc1
    s_nop 2
    v_mov_b32 v79, v79
    s_nop 2
    v_mov_b32 v79, v79
    s_nop 2
    v_mov_b32 v79, v79
    buffer_load_dwordx4 v[40:43], v65, s[4:7], s14 offen offset:0 sc1
    buffer_load_dwordx4 v[60:63], v66, s[4:7], s14 offen offset:0 sc1
    s_waitcnt vmcnt(5)
    v_bitop3_b32 v77, v8, v10, s69 bitop3:0x7e
    v_mfma_f32_16x16x32_bf16 v[0:3], v[4:7], v[8:11], 0
    v_mov_b64 v[8:9], 0
    v_mov_b64 v[10:11], 0
    s_waitcnt vmcnt(4)
    v_bitop3_b32 v78, v12, v14, s69 bitop3:0x7e
    v_mfma_f32_16x16x32_bf16 v[0:3], v[4:7], v[12:15], v[0:3]
    v_or_b32 v77, v77, v78
    v_mov_b64 v[12:13], 0
    v_mov_b64 v[14:15], 0
    s_waitcnt vmcnt(3)
    v_bitop3_b32 v78, v16, v18, s69 bitop3:0x7e
    v_mfma_f32_16x16x32_bf16 v[0:3], v[4:7], v[16:19], v[0:3]
    v_or_b32 v77, v77, v78
    v_mov_b64 v[16:17], 0
    v_mov_b64 v[18:19], 0
    s_waitcnt vmcnt(2)
    v_bitop3_b32 v78, v20, v22, s69 bitop3:0x7e
    v_mfma_f32_16x16x32_bf16 v[0:3], v[4:7], v[20:23], v[0:3]
    v_bitop3_b32 v77, v77, v78, 1 bitop3:0xa8
    v_cmp_ne_u32 vcc, 0, v77
    v_mov_b64 v[20:21], 0
    v_mov_b64 v[22:23], 0
    buffer_load_dwordx4 v[40:43], v65, s[4:7], s14 offen offset:0 sc1
    buffer_load_dwordx4 v[60:63], v66, s[4:7], s14 offen offset:0 sc1
    s_cmp_eq_u64 vcc, 0
    s_cselect_b64 s[42:43], -1, 0
    v_add_f32_dpp v0, v0, v0 row_ror:8 row_mask:0xf bank_mask:0xf
    v_add_f32_dpp v1, v1, v1 row_ror:8 row_mask:0xf bank_mask:0xf
    s_mov_b64 exec, s[42:43]
    v_cvt_pk_bf16_f32 v72, v0, v1
    v_bfi_b32 v72, v79, s70, v72
    buffer_store_dword v72, v75, s[4:7], s17 offen offset:0 sc1
    s_mov_b64 exec, -1
    s_cbranch_scc1 cs_f0_rx
    s_sub_u32 s31, s31, 1
    s_cbranch_scc0 cs_f0_spin
cs_f0_rx:
    v_mov_b64 v[0:1], 0
    v_mov_b64 v[2:3], 0
    v_mov_b64 v[4:5], 0
    v_mov_b64 v[6:7], 0
    s_branch cs_loop
cs_f1_xt:
    s_sub_u32 s37, s37, 1
    s_nop 2
    v_mov_b32 v79, v79
    s_nop 2
    v_mov_b32 v79, v79
    s_nop 2
    v_mov_b32 v79, v79
    s_nop 2
    v_mov_b32 v79, v79
    s_nop 2
    v_mov_b32 v79, v79
    s_nop 2
    v_mov_b32 v79, v79
    s_branch cs_f1_xtx
cs_f1_retry:
    s_sub_u32 s41, s30, s98
    s_mov_b32 s98, s30
    s_cmp_le_u32 s41, 3
    s_cselect_b32 s37, 1, 1
cs_f1_spin:
    buffer_load_dwordx4 v[8:11], v65, s[4:7], s18 offen sc1
    buffer_load_dwordx4 v[12:15], v65, s[4:7], s19 offen sc1
    buffer_load_dwordx4 v[16:19], v65, s[4:7], s20 offen sc1
    buffer_load_dwordx4 v[20:23], v65, s[4:7], s21 offen sc1
    s_nop 2
    v_mov_b32 v79, v79
    s_nop 2
    v_mov_b32 v79, v79
    s_nop 2
    v_mov_b32 v79, v79
    buffer_load_dwordx4 v[40:43], v65, s[4:7], s14 offen offset:0 sc1
    buffer_load_dwordx4 v[60:63], v66, s[4:7], s14 offen offset:0 sc1
    s_waitcnt vmcnt(5)
    v_bitop3_b32 v77, v8, v10, s69 bitop3:0x7e
    v_mfma_f32_16x16x32_bf16 v[0:3], v[4:7], v[8:11], 0
    v_mov_b64 v[8:9], 0
    v_mov_b64 v[10:11], 0
    s_waitcnt vmcnt(4)
    v_bitop3_b32 v78, v12, v14, s69 bitop3:0x7e
    v_mfma_f32_16x16x32_bf16 v[0:3], v[4:7], v[12:15], v[0:3]
    v_or_b32 v77, v77, v78
    v_mov_b64 v[12:13], 0
    v_mov_b64 v[14:15], 0
    s_waitcnt vmcnt(3)
    v_bitop3_b32 v78, v16, v18, s69 bitop3:0x7e
    v_mfma_f32_16x16x32_bf16 v[0:3], v[4:7], v[16:19], v[0:3]
    v_or_b32 v77, v77, v78
    v_mov_b64 v[16:17], 0
    v_mov_b64 v[18:19], 0
    s_waitcnt vmcnt(2)
    v_bitop3_b32 v78, v20, v22, s69 bitop3:0x7e
    v_mfma_f32_16x16x32_bf16 v[0:3], v[4:7], v[20:23], v[0:3]
    v_bitop3_b32 v77, v77, v78, 1 bitop3:0xa8
    v_cmp_ne_u32 vcc, 0, v77
    v_mov_b64 v[20:21], 0
    v_mov_b64 v[22:23], 0
    buffer_load_dwordx4 v[40:43], v65, s[4:7], s14 offen offset:0 sc1
    buffer_load_dwordx4 v[60:63], v66, s[4:7], s14 offen offset:0 sc1
    s_cmp_eq_u64 vcc, 0
    s_cselect_b64 s[42:43], -1, 0
    v_add_f32_dpp v0, v0, v0 row_ror:8 row_mask:0xf bank_mask:0xf
    v_add_f32_dpp v1, v1, v1 row_ror:8 row_mask:0xf bank_mask:0xf
    s_mov_b64 exec, s[42:43]
    v_cvt_pk_bf16_f32 v72, v0, v1
    v_bfi_b32 v72, v79, s70, v72
    buffer_store_dword v72, v75, s[4:7], s17 offen offset:0 sc1
    s_mov_b64 exec, -1
    s_cbranch_scc1 cs_f1_rx
    s_sub_u32 s31, s31, 1
    s_cbranch_scc0 cs_f1_spin
cs_f1_rx:
    v_mov_b64 v[0:1], 0
    v_mov_b64 v[2:3], 0
    v_mov_b64 v[4:5], 0
    v_mov_b64 v[6:7], 0
    s_branch cs_loop
cs_f2_xt:
    s_sub_u32 s37, s37, 1
    s_nop 2
    v_mov_b32 v79, v79
    s_nop 2
    v_mov_b32 v79, v79
    s_nop 2
    v_mov_b32 v79, v79
    s_nop 2
    v_mov_b32 v79, v79
    s_nop 2
    v_mov_b32 v79, v79
    s_nop 2
    v_mov_b32 v79, v79
    s_branch cs_f2_xtx
cs_f2_retry:
    s_sub_u32 s41, s30, s98
    s_mov_b32 s98, s30
    s_cmp_le_u32 s41, 3
    s_cselect_b32 s37, 1, 1
cs_f2_spin:
    buffer_load_dwordx4 v[8:11], v65, s[4:7], s18 offen sc1
    buffer_load_dwordx4 v[12:15], v65, s[4:7], s19 offen sc1
    buffer_load_dwordx4 v[16:19], v65, s[4:7], s20 offen sc1
    buffer_load_dwordx4 v[20:23], v65, s[4:7], s21 offen sc1
    s_nop 2
    v_mov_b32 v79, v79
    s_nop 2
    v_mov_b32 v79, v79
    s_nop 2
    v_mov_b32 v79, v79
    buffer_load_dwordx4 v[40:43], v65, s[4:7], s14 offen offset:0 sc1
    buffer_load_dwordx4 v[60:63], v66, s[4:7], s14 offen offset:0 sc1
    s_waitcnt vmcnt(5)
    v_bitop3_b32 v77, v8, v10, s69 bitop3:0x7e
    v_mfma_f32_16x16x32_bf16 v[0:3], v[4:7], v[8:11], 0
    v_mov_b64 v[8:9], 0
    v_mov_b64 v[10:11], 0
    s_waitcnt vmcnt(4)
    v_bitop3_b32 v78, v12, v14, s69 bitop3:0x7e
    v_mfma_f32_16x16x32_bf16 v[0:3], v[4:7], v[12:15], v[0:3]
    v_or_b32 v77, v77, v78
    v_mov_b64 v[12:13], 0
    v_mov_b64 v[14:15], 0
    s_waitcnt vmcnt(3)
    v_bitop3_b32 v78, v16, v18, s69 bitop3:0x7e
    v_mfma_f32_16x16x32_bf16 v[0:3], v[4:7], v[16:19], v[0:3]
    v_or_b32 v77, v77, v78
    v_mov_b64 v[16:17], 0
    v_mov_b64 v[18:19], 0
    s_waitcnt vmcnt(2)
    v_bitop3_b32 v78, v20, v22, s69 bitop3:0x7e
    v_mfma_f32_16x16x32_bf16 v[0:3], v[4:7], v[20:23], v[0:3]
    v_bitop3_b32 v77, v77, v78, 1 bitop3:0xa8
    v_cmp_ne_u32 vcc, 0, v77
    v_mov_b64 v[20:21], 0
    v_mov_b64 v[22:23], 0
    buffer_load_dwordx4 v[40:43], v65, s[4:7], s14 offen offset:0 sc1
    buffer_load_dwordx4 v[60:63], v66, s[4:7], s14 offen offset:0 sc1
    s_cmp_eq_u64 vcc, 0
    s_cselect_b64 s[42:43], -1, 0
    v_add_f32_dpp v0, v0, v0 row_ror:4 row_mask:0xf bank_mask:0xf
    v_add_f32_dpp v1, v1, v1 row_ror:4 row_mask:0xf bank_mask:0xf
    s_nop 0
    v_add_f32_dpp v0, v0, v0 row_ror:8 row_mask:0xf bank_mask:0xf
    v_add_f32_dpp v1, v1, v1 row_ror:8 row_mask:0xf bank_mask:0xf
    s_mov_b64 exec, s[42:43]
    v_cvt_pk_bf16_f32 v72, v0, v1
    v_bfi_b32 v72, v79, s70, v72
    buffer_store_dword v72, v75, s[4:7], s17 offen offset:0 sc1
    buffer_store_dword v72, v75, s[4:7], s17 offen offset:1024 sc1
    buffer_store_dword v72, v75, s[4:7], s17 offen offset:2048 sc1
    buffer_store_dword v72, v75, s[4:7], s17 offen offset:3072 sc1
    s_mov_b64 exec, -1
    s_cbranch_scc1 cs_f2_rx
    s_sub_u32 s31, s31, 1
    s_cbranch_scc0 cs_f2_spin
cs_f2_rx:
    v_mov_b64 v[0:1], 0
    v_mov_b64 v[2:3], 0
    v_mov_b64 v[4:5], 0
    v_mov_b64 v[6:7], 0
    s_branch cs_loop
cs_spinB:
    s_waitcnt vmcnt(3)
cs_spinB_l:
    v_bitop3_b32 v77, v44, v45, s70 bitop3:0x7e
    v_bitop3_b32 v77, v77, v46, s70 bitop3:0xf6
    v_bitop3_b32 v77, v77, v47, s70 bitop3:0xf6
    v_and_b32 v77, s36, v77
    v_cmp_ne_u32 vcc, 0, v77
    s_cbranch_vccz cs_spinB_x
    buffer_load_dwordx4 v[44:47], v65, s[4:7], s15 offen sc1
    s_sub_u32 s31, s31, 16
    s_waitcnt vmcnt(0)
    s_cbranch_scc0 cs_spinB_l
cs_spinB_x:
    ds_write_b128 v65, v[44:47] offset:4096
    s_waitcnt lgkmcnt(0)
    s_branch cs_backB
cs_spin8:
    buffer_load_dwordx4 v[40:43], v65, s[4:7], s16 offen sc1
cs_spin8_l:
    s_waitcnt vmcnt(0)
    v_bitop3_b32 v77, v40, v41, s70 bitop3:0x7e
    v_bitop3_b32 v77, v77, v42, s70 bitop3:0xf6
    v_bitop3_b32 v77, v77, v43, s70 bitop3:0xf6
    v_and_b32 v77, s36, v77
    v_cmp_ne_u32 vcc, 0, v77
    s_cbranch_vccz cs_spin8_x
    s_nop 15
    s_nop 15
    s_nop 15
    s_nop 11
    buffer_load_dwordx4 v[40:43], v65, s[4:7], s16 offen sc1
    s_sub_u32 s31, s31, 16
    s_cbranch_scc0 cs_spin8_l
cs_spin8_x:
    s_branch cs_back8
cs_rare:
    s_mov_b64 exec, s[34:35]
    buffer_store_dwordx4 v[0:3], v65, s[4:7], s28 offen sc1
    s_mov_b64 exec, -1
    s_nop 3
    v_cvt_pk_bf16_f32 v52, v16, v17
    v_cvt_pk_bf16_f32 v53, v18, v19
    v_cvt_pk_bf16_f32 v54, v20, v21
    v_cvt_pk_bf16_f32 v55, v22, v23
    buffer_store_dwordx4 v[52:55], v65, s[4:7], s27 offen sc1
    s_add_u32 s28, s28, 131072
    s_add_u32 s27, s27, 131072
    s_cmp_eq_u32 s30, 63
    s_cbranch_scc1 cs_last
    s_branch cs_rare_x
cs_kvwait:
    s_mov_b32 s41, s97
    v_bfe_u32 v78, v65, 2, 5
    v_mov_b32 v77, v76
    s_nop 1
    v_permlane32_swap_b32 v76, v77
    v_subrev_u32 v77, s95, v77
    v_cmp_lt_u32 vcc, 16, v77
    s_nop 1
    v_cndmask_b32 v77, v77, 0, vcc
    v_bfe_u32 v79, v78, 2, 2
    v_lshl_add_u32 v77, v77, 2, v79
    s_nop 1
    v_min_u32_dpp v77, v77, v77 row_ror:1 row_mask:0xf bank_mask:0xf
    s_nop 1
    v_min_u32_dpp v77, v77, v77 row_ror:2 row_mask:0xf bank_mask:0xf
    s_nop 1
    v_min_u32_dpp v77, v77, v77 row_ror:4 row_mask:0xf bank_mask:0xf
    s_nop 0
    v_readfirstlane_b32 s97, v77
    s_nop 0
    s_max_u32 s97, s97, s41
    s_add_u32 s40, s30, 3
    s_min_u32 s40, s40, 64
    s_cmp_le_u32 s40, s97
    s_cbranch_scc1 cs_kvw_x
    v_bfe_u32 v78, v65, 2, 5
    s_mov_b32 s31, 4194304
cs_kvw:
    buffer_load_dword v77, v78, s[4:7], s96 offen offset:16 sc1
    s_waitcnt vmcnt(0)
    v_subrev_u32 v77, s95, v77
    v_cmp_lt_u32 vcc, 16, v77
    s_nop 1
    v_cndmask_b32 v77, v77, 0, vcc
    v_bfe_u32 v79, v78, 2, 2
    v_lshl_add_u32 v77, v77, 2, v79
    s_nop 1
    v_min_u32_dpp v77, v77, v77 row_ror:1 row_mask:0xf bank_mask:0xf
    s_nop 1
    v_min_u32_dpp v77, v77, v77 row_ror:2 row_mask:0xf bank_mask:0xf
    s_nop 1
    v_min_u32_dpp v77, v77, v77 row_ror:4 row_mask:0xf bank_mask:0xf
    s_nop 0
    v_readfirstlane_b32 s97, v77
    s_sub_u32 s31, s31, 1
    s_cbranch_scc1 cs_kvw_x
    s_cmp_le_u32 s40, s97
    s_cbranch_scc1 cs_kvw_x
    s_sleep 2
    s_branch cs_kvw
cs_kvw_x:
    s_branch cs_kvok
cs_last:
    s_add_u32 s40, s95, 64
    v_mov_b32 v78, s40
    s_waitcnt vmcnt(0)
    s_barrier
    s_mov_b64 exec, s[100:101]
    buffer_store_dword v78, off, s[4:7], s29 sc1
    s_mov_b64 exec, -1
cs_end:
    s_endpgm
L_xform:
    v_and_b32 v1, 63, v0
    v_and_b32 v2, 15, v1
    v_lshrrev_b32 v3, 4, v1
    v_mov_b32 v7, 0x05040100
    v_mov_b32 v8, 0x07060302
    v_lshrrev_b32 v9, 6, v0
    v_lshlrev_b32 v9, 14, v9
    v_lshlrev_b32 v10, 4, v1
    v_add_u32 v11, v9, v10
    s_mov_b32 s10, 4718592
    s_mov_b32 s11, 0x20000
    s_mov_b64 s[8:9], s[58:59]
xf_f:
    s_sub_u32 s17, s16, 1504
    s_and_b32 s18, s17, 127
    s_lshr_b32 s17, s17, 7
    s_lshl_b32 s19, s17, 4
    v_add_u32 v6, s19, v2
    v_mul_u32_u24 v4, 9216, v3
    v_lshl_add_u32 v4, v6, 4, v4
    v_lshrrev_b32 v5, 2, v2
    v_lshlrev_b32 v5, 11, v5
    v_lshl_add_u32 v5, v3, 8, v5
    v_and_b32 v1, 3, v6
    v_lshl_add_u32 v5, v1, 6, v5
    v_add_u32 v5, v5, v9
    v_cmp_gt_u32 vcc, 72, v6
    s_nop 0
    s_mov_b64 exec, vcc
    s_mul_i32 s20, s18, 36864
    s_add_u32 s21, s20, 0
    buffer_load_dwordx4 v[12:15], v4, s[8:11], s21 offen
    s_add_u32 s21, s20, 1152
    buffer_load_dwordx4 v[16:19], v4, s[8:11], s21 offen
    s_add_u32 s21, s20, 2304
    buffer_load_dwordx4 v[20:23], v4, s[8:11], s21 offen
    s_add_u32 s21, s20, 3456
    buffer_load_dwordx4 v[24:27], v4, s[8:11], s21 offen
    s_add_u32 s21, s20, 4608
    buffer_load_dwordx4 v[28:31], v4, s[8:11], s21 offen
    s_add_u32 s21, s20, 5760
    buffer_load_dwordx4 v[32:35], v4, s[8:11], s21 offen
    s_add_u32 s21, s20, 6912
    buffer_load_dwordx4 v[36:39], v4, s[8:11], s21 offen
    s_add_u32 s21, s20, 8064
    buffer_load_dwordx4 v[40:43], v4, s[8:11], s21 offen
    s_lshl_b32 s20, s18, 11
    s_add_u32 s20, s20, 130023424
    s_waitcnt vmcnt(0)
    v_perm_b32 v76, v16, v12, v7
    v_perm_b32 v77, v24, v20, v7
    v_perm_b32 v78, v32, v28, v7
    v_perm_b32 v79, v40, v36, v7
    ds_write_b128 v5, v[76:79] offset:0
    v_perm_b32 v80, v17, v13, v7
    v_perm_b32 v81, v25, v21, v7
    v_perm_b32 v82, v33, v29, v7
    v_perm_b32 v83, v41, v37, v7
    ds_write_b128 v5, v[80:83] offset:16
    v_perm_b32 v84, v18, v14, v7
    v_perm_b32 v85, v26, v22, v7
    v_perm_b32 v86, v34, v30, v7
    v_perm_b32 v87, v42, v38, v7
    ds_write_b128 v5, v[84:87] offset:32
    v_perm_b32 v88, v19, v15, v7
    v_perm_b32 v89, v27, v23, v7
    v_perm_b32 v90, v35, v31, v7
    v_perm_b32 v91, v43, v39, v7
    ds_write_b128 v5, v[88:91] offset:48
    v_perm_b32 v92, v16, v12, v8
    v_perm_b32 v93, v24, v20, v8
    v_perm_b32 v94, v32, v28, v8
    v_perm_b32 v95, v40, v36, v8
    ds_write_b128 v5, v[92:95] offset:1024
    v_perm_b32 v96, v17, v13, v8
    v_perm_b32 v97, v25, v21, v8
    v_perm_b32 v98, v33, v29, v8
    v_perm_b32 v99, v41, v37, v8
    ds_write_b128 v5, v[96:99] offset:1040
    v_perm_b32 v100, v18, v14, v8
    v_perm_b32 v101, v26, v22, v8
    v_perm_b32 v102, v34, v30, v8
    v_perm_b32 v103, v42, v38, v8
    ds_write_b128 v5, v[100:103] offset:1056
    v_perm_b32 v104, v19, v15, v8
    v_perm_b32 v105, v27, v23, v8
    v_perm_b32 v106, v35, v31, v8
    v_perm_b32 v107, v43, v39, v8
    ds_write_b128 v5, v[104:107] offset:1072
    s_mov_b64 exec, -1
    s_lshl_b32 s21, s17, 20
    s_add_u32 s20, s20, s21
    s_waitcnt lgkmcnt(0)
    ds_read_b128 v[76:79], v11 offset:0
    ds_read_b128 v[80:83], v11 offset:1024
    ds_read_b128 v[84:87], v11 offset:2048
    ds_read_b128 v[88:91], v11 offset:3072
    ds_read_b128 v[92:95], v11 offset:4096
    ds_read_b128 v[96:99], v11 offset:5120
    ds_read_b128 v[100:103], v11 offset:6144
    ds_read_b128 v[104:107], v11 offset:7168
    s_add_u32 s19, s20, 0
    s_waitcnt lgkmcnt(7)
    buffer_store_dwordx4 v[76:79], v10, s[4:7], s19 offen sc1
    s_add_u32 s19, s20, 1024
    s_waitcnt lgkmcnt(6)
    buffer_store_dwordx4 v[80:83], v10, s[4:7], s19 offen sc1
    s_add_u32 s19, s20, 262144
    s_waitcnt lgkmcnt(5)
    buffer_store_dwordx4 v[84:87], v10, s[4:7], s19 offen sc1
    s_add_u32 s19, s20, 263168
    s_waitcnt lgkmcnt(4)
    buffer_store_dwordx4 v[88:91], v10, s[4:7], s19 offen sc1
    s_add_u32 s19, s20, 524288
    s_waitcnt lgkmcnt(3)
    buffer_store_dwordx4 v[92:95], v10, s[4:7], s19 offen sc1
    s_add_u32 s19, s20, 525312
    s_waitcnt lgkmcnt(2)
    buffer_store_dwordx4 v[96:99], v10, s[4:7], s19 offen sc1
    s_add_u32 s19, s20, 786432
    s_waitcnt lgkmcnt(1)
    buffer_store_dwordx4 v[100:103], v10, s[4:7], s19 offen sc1
    s_add_u32 s19, s20, 787456
    s_waitcnt lgkmcnt(0)
    buffer_store_dwordx4 v[104:107], v10, s[4:7], s19 offen sc1
xf_done:
    s_nop 1
    s_setpc_b64 s[46:47]
L_helper:
    s_load_dwordx16 s[64:79], s[0:1], 64
    s_waitcnt lgkmcnt(0)
    s_mov_b32 s93, 1000
    s_mov_b32 s95, 0
    s_cmp_lg_u32 s3, 2
    s_cbranch_scc1 L_qkv_next
    s_mov_b32 s37, 24
    v_mov_b32 v250, 1
    v_mov_b32 v251, 163832
    v_cmp_eq_u32 vcc, 0, v0
    s_nop 0
    s_and_saveexec_b64 s[38:39], vcc
    s_cbranch_execz tk3
    buffer_atomic_add v250, off, s[84:87], s37 sc0
    s_waitcnt vmcnt(0)
    ds_write_b32 v251, v250
    s_waitcnt lgkmcnt(0)
tk3:
    s_mov_b64 exec, -1
    s_barrier
    ds_read_b32 v252, v251
    s_waitcnt lgkmcnt(0)
    v_readfirstlane_b32 s36, v252
    s_barrier
    s_nop 3
    s_cmp_ge_u32 s36, 32
    s_cbranch_scc1 L_qkv_next
    s_mov_b32 s93, 0
    s_cmp_eq_u32 s36, 0
    s_cbranch_scc1 L_relay
    s_branch L_wf_next
L_qkv_next:
    s_sub_u32 s46, s3, 2
    s_cmp_lt_u32 s3, 2
    s_cselect_b32 s46, s3, s46
    s_cmp_lt_u32 s46, 6
    s_cselect_b32 s46, s46, 0
    s_mov_b32 s47, 6
L_qq:
    s_lshl_b32 s40, s46, 2
    s_add_u32 s40, s40, 32
    s_mov_b32 s37, s40
    v_mov_b32 v250, 1
    v_mov_b32 v251, 163832
    v_cmp_eq_u32 vcc, 0, v0
    s_nop 0
    s_and_saveexec_b64 s[38:39], vcc
    s_cbranch_execz tk4
    buffer_atomic_add v250, off, s[84:87], s37 sc0
    s_waitcnt vmcnt(0)
    ds_write_b32 v251, v250
    s_waitcnt lgkmcnt(0)
tk4:
    s_mov_b64 exec, -1
    s_barrier
    ds_read_b32 v252, v251
    s_waitcnt lgkmcnt(0)
    v_readfirstlane_b32 s36, v252
    s_barrier
    s_nop 3
    s_or_b32 s37, s36, s32
    s_cbranch_scc1 L_non
    s_memrealtime s[90:91]
    s_waitcnt lgkmcnt(0)
    s_lshl_b32 s90, s90, 8
    s_or_b32 s90, s90, 1
    v_mov_b32 v250, s90
    v_mov_b32 v251, 0
    s_mov_b64 exec, 1
    buffer_atomic_cmpswap v[250:251], off, s[84:87], 0 offset:216
    s_mov_b64 exec, -1
L_non:
    s_cmp_lt_u32 s36, 32
    s_cbranch_scc1 L_qkv
    s_add_u32 s46, s46, 1
    s_cmp_lt_u32 s46, 6
    s_cselect_b32 s46, s46, 0
    s_sub_u32 s47, s47, 1
    s_cmp_lg_u32 s47, 0
    s_cbranch_scc1 L_qq
    s_mov_b32 s37, 4
    v_mov_b32 v250, 1
    v_mov_b32 v251, 163832
    v_cmp_eq_u32 vcc, 0, v0
    s_nop 0
    s_and_saveexec_b64 s[38:39], vcc
    s_cbranch_execz tk5
    buffer_atomic_add v250, off, s[84:87], s37 sc0
    s_waitcnt vmcnt(0)
    ds_write_b32 v251, v250
    s_waitcnt lgkmcnt(0)
tk5:
    s_mov_b64 exec, -1
    s_barrier
    ds_read_b32 v252, v251
    s_waitcnt lgkmcnt(0)
    v_readfirstlane_b32 s45, v252
    s_barrier
    s_nop 3
    s_cmp_lg_u32 s95, 0
    s_cbranch_scc1 L_hn
    s_mov_b32 s88, 4194304
gn6:
    buffer_load_dword v250, off, s[84:87], 0 offset:216 sc1
    s_waitcnt vmcnt(0)
    v_readfirstlane_b32 s95, v250
    s_sub_u32 s88, s88, 1
    s_cbranch_scc1 gn6x
    s_cmp_eq_u32 s95, 0
    s_cbranch_scc1 gn6
gn6x:
L_hn:
    s_cmp_lg_u32 s45, 0
    s_cbranch_scc1 L_phase2
    s_mov_b32 s37, 24
    v_mov_b32 v250, 1
    v_mov_b32 v251, 163832
    v_cmp_eq_u32 vcc, 0, v0
    s_nop 0
    s_and_saveexec_b64 s[38:39], vcc
    s_cbranch_execz tk7
    buffer_atomic_add v250, off, s[84:87], s37 sc0
    s_waitcnt vmcnt(0)
    ds_write_b32 v251, v250
    s_waitcnt lgkmcnt(0)
tk7:
    s_mov_b64 exec, -1
    s_barrier
    ds_read_b32 v252, v251
    s_waitcnt lgkmcnt(0)
    v_readfirstlane_b32 s36, v252
    s_barrier
    s_nop 3
    s_cmp_lg_u32 s36, 0
    s_cbranch_scc1 L_phase2
L_relay:
    s_cmp_lg_u32 s32, 0
    s_cbranch_scc1 L_exit
    s_sleep 100
    s_mov_b32 s88, 4194304
gn8:
    buffer_load_dword v250, off, s[84:87], 0 offset:216 sc1
    s_waitcnt vmcnt(0)
    v_readfirstlane_b32 s95, v250
    s_sub_u32 s88, s88, 1
    s_cbranch_scc1 gn8x
    s_cmp_eq_u32 s95, 0
    s_cbranch_scc1 gn8
gn8x:
    v_and_b32 v3, 31, v0
    v_lshlrev_b32 v3, 7, v3
    s_mov_b32 s17, 0
    s_mov_b32 s23, 125845504
    s_mov_b32 s24, 125853696
    s_mov_b32 s21, 16777216
rl_rwait:
    buffer_load_dword v4, v3, s[4:7], s23 offen sc1
    s_waitcnt vmcnt(0)
    v_subrev_u32 v4, s95, v4
    v_cmp_lt_u32 vcc, 64, v4
    s_nop 1
    v_cndmask_b32 v4, v4, 0, vcc
    s_nop 1
    v_min_u32_dpp v4, v4, v4 row_ror:1 row_mask:0xf bank_mask:0xf
    s_nop 1
    v_min_u32_dpp v4, v4, v4 row_ror:2 row_mask:0xf bank_mask:0xf
    s_nop 1
    v_min_u32_dpp v4, v4, v4 row_ror:4 row_mask:0xf bank_mask:0xf
    s_nop 1
    v_min_u32_dpp v4, v4, v4 row_ror:8 row_mask:0xf bank_mask:0xf
    s_nop 0
    v_readlane_b32 s16, v4, 0
    v_readlane_b32 s22, v4, 16
    s_nop 0
    s_min_u32 s16, s16, s22
    s_sub_u32 s21, s21, 1
    s_cbranch_scc1 rl_x
    s_cmp_gt_u32 s16, s17
    s_cbranch_scc1 rl_rpub
    s_sleep 2
    s_branch rl_rwait
rl_rpub:
    s_mov_b32 s17, s16
    s_add_u32 s22, s16, s95
    v_mov_b32 v4, s22
    s_mov_b64 exec, 1
    buffer_store_dword v4, off, s[4:7], s24 sc1
    s_mov_b64 exec, -1
    s_cmp_lt_u32 s16, 64
    s_cbranch_scc1 rl_rwait
rl_x:
    s_endpgm
L_qkv:
    s_and_b32 s37, s36, 3
    s_lshr_b32 s36, s36, 2
    s_lshl_b32 s40, s46, 3
    s_add_u32 s36, s36, s40
    s_lshr_b32 s40, s36, 4
    s_and_b32 s36, s36, 15
    s_lshl_b32 s41, s37, 1
    s_add_u32 s41, s41, s40
    s_add_u32 s37, s37, 8
    s_cmp_eq_u32 s40, 2
    s_cselect_b32 s41, s37, s41
    s_lshl_b32 s41, s41, 4
    s_add_u32 s36, s36, s41
    s_sub_u32 s33, s36, 32
    s_and_b32 s17, s36, 15
    s_lshl_b32 s17, s17, 1
    s_lshr_b32 s36, s36, 4
    s_and_b32 s16, s36, 1
    s_add_u32 s16, s16, 1
    s_lshr_b32 s19, s36, 1
    s_and_b32 s37, s36, 3
    s_cmp_ge_u32 s36, 8
    s_cselect_b32 s16, 0, s16
    s_cselect_b32 s19, s37, s19
    v_lshrrev_b32 v4, 6, v0
    s_nop 0
    v_readfirstlane_b32 s18, v4
    v_lshlrev_b32 v7, 4, v0
    s_cmp_eq_u32 s16, 1
    s_cselect_b64 s[12:13], s[54:55], s[52:53]
    s_cmp_eq_u32 s16, 2
    s_cselect_b64 s[12:13], s[56:57], s[12:13]
    s_mov_b32 s14, 4718592
    s_mov_b32 s15, 0x20000
    v_bfe_u32 v4, v0, 5, 1
    v_lshlrev_b32 v5, 2, v4
    v_and_b32 v8, 31, v0
    v_xor_b32 v8, v8, v5
    v_lshlrev_b32 v8, 4, v8
    v_lshl_add_u32 v8, v4, 13, v8
    v_xor_b32 v9, 128, v8
    s_lshl_b32 s21, s17, 8
    s_lshl_b32 s42, s18, 16
    s_add_u32 s42, s42, s21
    s_lshl_b32 s44, s18, 12
    s_barrier
    s_add_u32 m0, s44, 73728
    s_add_u32 s22, s42, 0
    buffer_load_dwordx4 v8, s[12:15], s22 offen offset:0 lds
    s_add_u32 s22, s42, 15360
    buffer_load_dwordx4 v9, s[12:15], s22 offen offset:1024 lds
    s_add_u32 s22, s42, 30720
    buffer_load_dwordx4 v8, s[12:15], s22 offen offset:2048 lds
    s_add_u32 s22, s42, 46080
    buffer_load_dwordx4 v9, s[12:15], s22 offen offset:3072 lds
    s_add_u32 m0, s44, 90112
    s_add_u32 s22, s42, 1048576
    buffer_load_dwordx4 v8, s[12:15], s22 offen offset:0 lds
    s_add_u32 s22, s42, 1063936
    buffer_load_dwordx4 v9, s[12:15], s22 offen offset:1024 lds
    s_add_u32 s22, s42, 1079296
    buffer_load_dwordx4 v8, s[12:15], s22 offen offset:2048 lds
    s_add_u32 s22, s42, 1094656
    buffer_load_dwordx4 v9, s[12:15], s22 offen offset:3072 lds
    s_add_u32 m0, s44, 106496
    s_add_u32 s22, s42, 2097152
    buffer_load_dwordx4 v8, s[12:15], s22 offen offset:0 lds
    s_add_u32 s22, s42, 2112512
    buffer_load_dwordx4 v9, s[12:15], s22 offen offset:1024 lds
    s_add_u32 s22, s42, 2127872
    buffer_load_dwordx4 v8, s[12:15], s22 offen offset:2048 lds
    s_add_u32 s22, s42, 2143232
    buffer_load_dwordx4 v9, s[12:15], s22 offen offset:3072 lds
    s_add_u32 m0, s44, 122880
    s_add_u32 s22, s42, 3145728
    buffer_load_dwordx4 v8, s[12:15], s22 offen offset:0 lds
    s_add_u32 s22, s42, 3161088
    buffer_load_dwordx4 v9, s[12:15], s22 offen offset:1024 lds
    s_add_u32 s22, s42, 3176448
    buffer_load_dwordx4 v8, s[12:15], s22 offen offset:2048 lds
    s_add_u32 s22, s42, 3191808
    buffer_load_dwordx4 v9, s[12:15], s22 offen offset:3072 lds
    v_bfe_u32 v4, v0, 2, 2
    v_xor_b32 v5, s18, v4
    v_lshlrev_b32 v10, 6, v5
    v_lshl_add_u32 v10, v4, 9, v10
    v_and_b32 v4, 3, v0
    v_lshl_add_u32 v10, v4, 4, v10
    v_bfe_u32 v4, v0, 4, 2
    v_lshl_add_u32 v10, v4, 12, v10
    v_add_u32 v10, 73728, v10
    v_add_u32 v11, 49152, v10
    v_and_b32 v4, 63, v0
    v_and_b32 v5, 15, v4
    v_lshrrev_b32 v3, 4, v4
    v_lshrrev_b32 v2, 2, v5
    v_xor_b32 v3, v3, v2
    v_lshl_add_u32 v3, v5, 2, v3
    v_lshlrev_b32 v1, 4, v3
    v_lshrrev_b32 v5, 2, v4
    v_lshrrev_b32 v3, 4, v4
    v_and_b32 v4, 3, v4
    v_xor_b32 v4, v4, v3
    v_lshlrev_b32 v3, 3, v3
    v_and_b32 v5, 3, v5
    v_add_u32 v3, v3, v5
    v_mul_u32_u24 v2, 1152, v3
    v_lshl_add_u32 v2, v4, 4, v2
    s_mov_b32 s8, s48
    s_mov_b32 s9, s49
    s_mov_b32 s10, 2359296
    s_mov_b32 s11, 0x20000
    s_lshr_b32 s22, s18, 1
    s_mul_i32 s24, s22, 4608
    s_mul_i32 s25, s22, 18432
    s_and_b32 s22, s18, 1
    s_mul_i32 s23, s22, 576
    s_add_u32 s24, s24, s23
    s_mul_i32 s25, s18, 9216
    s_mul_i32 s22, s19, 36864
    s_add_u32 s24, s24, s22
    s_mov_b32 s20, 64
    s_lshl_b32 s22, s19, 5
    s_add_u32 s22, s22, s17
    s_lshl_b32 s26, s22, 14
    s_mul_i32 s23, s18, 3072
    s_add_u32 s26, s26, s23
    s_lshl_b32 s23, s16, 11
    s_add_u32 s26, s26, s23
    s_add_u32 s26, s26, -2048
    s_lshl_b32 s22, s22, 13
    s_add_u32 s22, s22, 33554432
    s_cmp_eq_u32 s16, 0
    s_cselect_b32 s26, s22, s26
    s_cselect_b32 s40, 4096, 64
    s_cselect_b32 s41, 1, 2
    s_max_u32 s40, s40, 1024
    s_lshl_b32 s41, s41, 18
    s_lshl_b32 s29, s17, 7
    s_lshl_b32 s22, s16, 4
    s_add_u32 s29, s29, s22
    s_lshl_b32 s22, s19, 2
    s_add_u32 s29, s29, s22
    s_add_u32 s29, s29, 125829120
    s_mov_b32 s27, 0
    s_add_u32 s23, s27, s25
    s_add_u32 m0, s23, 0
    s_nop 0
    buffer_load_dwordx4 v2, s[8:11], s24 offen offset:0 lds
    s_add_u32 m0, s23, 960
    s_nop 0
    buffer_load_dwordx4 v2, s[8:11], s24 offen offset:64 lds
    s_add_u32 m0, s23, 1920
    s_nop 0
    buffer_load_dwordx4 v2, s[8:11], s24 offen offset:128 lds
    s_add_u32 m0, s23, 2880
    s_nop 0
    buffer_load_dwordx4 v2, s[8:11], s24 offen offset:192 lds
    s_add_u32 m0, s23, 3840
    s_nop 0
    buffer_load_dwordx4 v2, s[8:11], s24 offen offset:256 lds
    s_add_u32 m0, s23, 4800
    s_nop 0
    buffer_load_dwordx4 v2, s[8:11], s24 offen offset:320 lds
    s_add_u32 m0, s23, 5760
    s_nop 0
    buffer_load_dwordx4 v2, s[8:11], s24 offen offset:384 lds
    s_add_u32 m0, s23, 6720
    s_nop 0
    buffer_load_dwordx4 v2, s[8:11], s24 offen offset:448 lds
    s_add_u32 m0, s23, 7680
    s_nop 0
    buffer_load_dwordx4 v2, s[8:11], s24 offen offset:512 lds
    s_add_u32 s24, s24, 147456
    s_waitcnt vmcnt(21) lgkmcnt(0)
    s_barrier
    s_add_u32 m0, s44, 139264
    s_add_u32 s22, s42, 262144
    buffer_load_dwordx4 v8, s[12:15], s22 offen offset:0 lds
    s_add_u32 s22, s42, 277504
    buffer_load_dwordx4 v9, s[12:15], s22 offen offset:1024 lds
    s_add_u32 s22, s42, 292864
    buffer_load_dwordx4 v8, s[12:15], s22 offen offset:2048 lds
    s_add_u32 s22, s42, 308224
    buffer_load_dwordx4 v9, s[12:15], s22 offen offset:3072 lds
    ds_read_b64_tr_b16 v[64:65], v10 offset:0
    ds_read_b64_tr_b16 v[66:67], v10 offset:2048
    ds_read_b64_tr_b16 v[136:137], v10 offset:8
    ds_read_b64_tr_b16 v[138:139], v10 offset:2056
    ds_read_b64_tr_b16 a[0:1], v10 offset:256
    ds_read_b64_tr_b16 a[2:3], v10 offset:2304
    ds_read_b64_tr_b16 a[72:73], v10 offset:264
    ds_read_b64_tr_b16 a[74:75], v10 offset:2312
    s_waitcnt vmcnt(21) lgkmcnt(0)
    s_barrier
    s_add_u32 m0, s44, 73728
    s_add_u32 s22, s42, 1310720
    buffer_load_dwordx4 v8, s[12:15], s22 offen offset:0 lds
    s_add_u32 s22, s42, 1326080
    buffer_load_dwordx4 v9, s[12:15], s22 offen offset:1024 lds
    s_add_u32 s22, s42, 1341440
    buffer_load_dwordx4 v8, s[12:15], s22 offen offset:2048 lds
    s_add_u32 s22, s42, 1356800
    buffer_load_dwordx4 v9, s[12:15], s22 offen offset:3072 lds
    ds_read_b64_tr_b16 v[80:81], v10 offset:16384
    ds_read_b64_tr_b16 v[82:83], v10 offset:18432
    ds_read_b64_tr_b16 v[152:153], v10 offset:16392
    ds_read_b64_tr_b16 v[154:155], v10 offset:18440
    ds_read_b64_tr_b16 a[16:17], v10 offset:16640
    ds_read_b64_tr_b16 a[18:19], v10 offset:18688
    ds_read_b64_tr_b16 a[88:89], v10 offset:16648
    ds_read_b64_tr_b16 a[90:91], v10 offset:18696
    s_waitcnt vmcnt(21) lgkmcnt(0)
    s_barrier
    s_add_u32 m0, s44, 90112
    s_add_u32 s22, s42, 2359296
    buffer_load_dwordx4 v8, s[12:15], s22 offen offset:0 lds
    s_add_u32 s22, s42, 2374656
    buffer_load_dwordx4 v9, s[12:15], s22 offen offset:1024 lds
    s_add_u32 s22, s42, 2390016
    buffer_load_dwordx4 v8, s[12:15], s22 offen offset:2048 lds
    s_add_u32 s22, s42, 2405376
    buffer_load_dwordx4 v9, s[12:15], s22 offen offset:3072 lds
    ds_read_b64_tr_b16 v[96:97], v10 offset:32768
    ds_read_b64_tr_b16 v[98:99], v10 offset:34816
    ds_read_b64_tr_b16 v[168:169], v10 offset:32776
    ds_read_b64_tr_b16 v[170:171], v10 offset:34824
    ds_read_b64_tr_b16 a[32:33], v10 offset:33024
    ds_read_b64_tr_b16 a[34:35], v10 offset:35072
    ds_read_b64_tr_b16 a[104:105], v10 offset:33032
    ds_read_b64_tr_b16 a[106:107], v10 offset:35080
    s_waitcnt vmcnt(21) lgkmcnt(0)
    s_barrier
    s_add_u32 m0, s44, 106496
    s_add_u32 s22, s42, 3407872
    buffer_load_dwordx4 v8, s[12:15], s22 offen offset:0 lds
    s_add_u32 s22, s42, 3423232
    buffer_load_dwordx4 v9, s[12:15], s22 offen offset:1024 lds
    s_add_u32 s22, s42, 3438592
    buffer_load_dwordx4 v8, s[12:15], s22 offen offset:2048 lds
    s_add_u32 s22, s42, 3453952
    buffer_load_dwordx4 v9, s[12:15], s22 offen offset:3072 lds
    ds_read_b64_tr_b16 v[112:113], v11 offset:0
    ds_read_b64_tr_b16 v[114:115], v11 offset:2048
    ds_read_b64_tr_b16 v[184:185], v11 offset:8
    ds_read_b64_tr_b16 v[186:187], v11 offset:2056
    ds_read_b64_tr_b16 a[48:49], v11 offset:256
    ds_read_b64_tr_b16 a[50:51], v11 offset:2304
    ds_read_b64_tr_b16 a[120:121], v11 offset:264
    ds_read_b64_tr_b16 a[122:123], v11 offset:2312
    s_waitcnt vmcnt(12) lgkmcnt(0)
    s_barrier
    s_add_u32 m0, s44, 122880
    s_add_u32 s22, s42, 524288
    buffer_load_dwordx4 v8, s[12:15], s22 offen offset:0 lds
    s_add_u32 s22, s42, 539648
    buffer_load_dwordx4 v9, s[12:15], s22 offen offset:1024 lds
    s_add_u32 s22, s42, 555008
    buffer_load_dwordx4 v8, s[12:15], s22 offen offset:2048 lds
    s_add_u32 s22, s42, 570368
    buffer_load_dwordx4 v9, s[12:15], s22 offen offset:3072 lds
    ds_read_b64_tr_b16 v[68:69], v11 offset:16384
    ds_read_b64_tr_b16 v[70:71], v11 offset:18432
    ds_read_b64_tr_b16 v[140:141], v11 offset:16392
    ds_read_b64_tr_b16 v[142:143], v11 offset:18440
    ds_read_b64_tr_b16 a[4:5], v11 offset:16640
    ds_read_b64_tr_b16 a[6:7], v11 offset:18688
    ds_read_b64_tr_b16 a[76:77], v11 offset:16648
    ds_read_b64_tr_b16 a[78:79], v11 offset:18696
    s_waitcnt vmcnt(12) lgkmcnt(0)
    s_barrier
    s_add_u32 m0, s44, 139264
    s_add_u32 s22, s42, 1572864
    buffer_load_dwordx4 v8, s[12:15], s22 offen offset:0 lds
    s_add_u32 s22, s42, 1588224
    buffer_load_dwordx4 v9, s[12:15], s22 offen offset:1024 lds
    s_add_u32 s22, s42, 1603584
    buffer_load_dwordx4 v8, s[12:15], s22 offen offset:2048 lds
    s_add_u32 s22, s42, 1618944
    buffer_load_dwordx4 v9, s[12:15], s22 offen offset:3072 lds
    ds_read_b64_tr_b16 v[84:85], v10 offset:0
    ds_read_b64_tr_b16 v[86:87], v10 offset:2048
    ds_read_b64_tr_b16 v[156:157], v10 offset:8
    ds_read_b64_tr_b16 v[158:159], v10 offset:2056
    ds_read_b64_tr_b16 a[20:21], v10 offset:256
    ds_read_b64_tr_b16 a[22:23], v10 offset:2304
    ds_read_b64_tr_b16 a[92:93], v10 offset:264
    ds_read_b64_tr_b16 a[94:95], v10 offset:2312
    s_waitcnt vmcnt(12) lgkmcnt(0)
    s_barrier
    s_add_u32 m0, s44, 73728
    s_add_u32 s22, s42, 2621440
    buffer_load_dwordx4 v8, s[12:15], s22 offen offset:0 lds
    s_add_u32 s22, s42, 2636800
    buffer_load_dwordx4 v9, s[12:15], s22 offen offset:1024 lds
    s_add_u32 s22, s42, 2652160
    buffer_load_dwordx4 v8, s[12:15], s22 offen offset:2048 lds
    s_add_u32 s22, s42, 2667520
    buffer_load_dwordx4 v9, s[12:15], s22 offen offset:3072 lds
    ds_read_b64_tr_b16 v[100:101], v10 offset:16384
    ds_read_b64_tr_b16 v[102:103], v10 offset:18432
    ds_read_b64_tr_b16 v[172:173], v10 offset:16392
    ds_read_b64_tr_b16 v[174:175], v10 offset:18440
    ds_read_b64_tr_b16 a[36:37], v10 offset:16640
    ds_read_b64_tr_b16 a[38:39], v10 offset:18688
    ds_read_b64_tr_b16 a[108:109], v10 offset:16648
    ds_read_b64_tr_b16 a[110:111], v10 offset:18696
    s_waitcnt vmcnt(12) lgkmcnt(0)
    s_barrier
    s_add_u32 m0, s44, 90112
    s_add_u32 s22, s42, 3670016
    buffer_load_dwordx4 v8, s[12:15], s22 offen offset:0 lds
    s_add_u32 s22, s42, 3685376
    buffer_load_dwordx4 v9, s[12:15], s22 offen offset:1024 lds
    s_add_u32 s22, s42, 3700736
    buffer_load_dwordx4 v8, s[12:15], s22 offen offset:2048 lds
    s_add_u32 s22, s42, 3716096
    buffer_load_dwordx4 v9, s[12:15], s22 offen offset:3072 lds
    ds_read_b64_tr_b16 v[116:117], v10 offset:32768
    ds_read_b64_tr_b16 v[118:119], v10 offset:34816
    ds_read_b64_tr_b16 v[188:189], v10 offset:32776
    ds_read_b64_tr_b16 v[190:191], v10 offset:34824
    ds_read_b64_tr_b16 a[52:53], v10 offset:33024
    ds_read_b64_tr_b16 a[54:55], v10 offset:35072
    ds_read_b64_tr_b16 a[124:125], v10 offset:33032
    ds_read_b64_tr_b16 a[126:127], v10 offset:35080
    s_waitcnt vmcnt(12) lgkmcnt(0)
    s_barrier
    s_add_u32 m0, s44, 106496
    s_add_u32 s22, s42, 786432
    buffer_load_dwordx4 v8, s[12:15], s22 offen offset:0 lds
    s_add_u32 s22, s42, 801792
    buffer_load_dwordx4 v9, s[12:15], s22 offen offset:1024 lds
    s_add_u32 s22, s42, 817152
    buffer_load_dwordx4 v8, s[12:15], s22 offen offset:2048 lds
    s_add_u32 s22, s42, 832512
    buffer_load_dwordx4 v9, s[12:15], s22 offen offset:3072 lds
    ds_read_b64_tr_b16 v[72:73], v11 offset:0
    ds_read_b64_tr_b16 v[74:75], v11 offset:2048
    ds_read_b64_tr_b16 v[144:145], v11 offset:8
    ds_read_b64_tr_b16 v[146:147], v11 offset:2056
    ds_read_b64_tr_b16 a[8:9], v11 offset:256
    ds_read_b64_tr_b16 a[10:11], v11 offset:2304
    ds_read_b64_tr_b16 a[80:81], v11 offset:264
    ds_read_b64_tr_b16 a[82:83], v11 offset:2312
    s_waitcnt vmcnt(12) lgkmcnt(0)
    s_barrier
    s_add_u32 m0, s44, 122880
    s_add_u32 s22, s42, 1835008
    buffer_load_dwordx4 v8, s[12:15], s22 offen offset:0 lds
    s_add_u32 s22, s42, 1850368
    buffer_load_dwordx4 v9, s[12:15], s22 offen offset:1024 lds
    s_add_u32 s22, s42, 1865728
    buffer_load_dwordx4 v8, s[12:15], s22 offen offset:2048 lds
    s_add_u32 s22, s42, 1881088
    buffer_load_dwordx4 v9, s[12:15], s22 offen offset:3072 lds
    ds_read_b64_tr_b16 v[88:89], v11 offset:16384
    ds_read_b64_tr_b16 v[90:91], v11 offset:18432
    ds_read_b64_tr_b16 v[160:161], v11 offset:16392
    ds_read_b64_tr_b16 v[162:163], v11 offset:18440
    ds_read_b64_tr_b16 a[24:25], v11 offset:16640
    ds_read_b64_tr_b16 a[26:27], v11 offset:18688
    ds_read_b64_tr_b16 a[96:97], v11 offset:16648
    ds_read_b64_tr_b16 a[98:99], v11 offset:18696
    s_waitcnt vmcnt(12) lgkmcnt(0)
    s_barrier
    s_add_u32 m0, s44, 139264
    s_add_u32 s22, s42, 2883584
    buffer_load_dwordx4 v8, s[12:15], s22 offen offset:0 lds
    s_add_u32 s22, s42, 2898944
    buffer_load_dwordx4 v9, s[12:15], s22 offen offset:1024 lds
    s_add_u32 s22, s42, 2914304
    buffer_load_dwordx4 v8, s[12:15], s22 offen offset:2048 lds
    s_add_u32 s22, s42, 2929664
    buffer_load_dwordx4 v9, s[12:15], s22 offen offset:3072 lds
    ds_read_b64_tr_b16 v[104:105], v10 offset:0
    ds_read_b64_tr_b16 v[106:107], v10 offset:2048
    ds_read_b64_tr_b16 v[176:177], v10 offset:8
    ds_read_b64_tr_b16 v[178:179], v10 offset:2056
    ds_read_b64_tr_b16 a[40:41], v10 offset:256
    ds_read_b64_tr_b16 a[42:43], v10 offset:2304
    ds_read_b64_tr_b16 a[112:113], v10 offset:264
    ds_read_b64_tr_b16 a[114:115], v10 offset:2312
    s_waitcnt vmcnt(12) lgkmcnt(0)
    s_barrier
    s_add_u32 m0, s44, 73728
    s_add_u32 s22, s42, 3932160
    buffer_load_dwordx4 v8, s[12:15], s22 offen offset:0 lds
    s_add_u32 s22, s42, 3947520
    buffer_load_dwordx4 v9, s[12:15], s22 offen offset:1024 lds
    s_add_u32 s22, s42, 3962880
    buffer_load_dwordx4 v8, s[12:15], s22 offen offset:2048 lds
    s_add_u32 s22, s42, 3978240
    buffer_load_dwordx4 v9, s[12:15], s22 offen offset:3072 lds
    ds_read_b64_tr_b16 v[120:121], v10 offset:16384
    ds_read_b64_tr_b16 v[122:123], v10 offset:18432
    ds_read_b64_tr_b16 v[192:193], v10 offset:16392
    ds_read_b64_tr_b16 v[194:195], v10 offset:18440
    ds_read_b64_tr_b16 a[56:57], v10 offset:16640
    ds_read_b64_tr_b16 a[58:59], v10 offset:18688
    ds_read_b64_tr_b16 a[128:129], v10 offset:16648
    ds_read_b64_tr_b16 a[130:131], v10 offset:18696
    s_waitcnt vmcnt(12) lgkmcnt(0)
    s_barrier
    s_add_u32 m0, s44, 90112
    s_add_u32 s22, s42, 4194304
    buffer_load_dwordx4 v8, s[12:15], s22 offen offset:0 lds
    s_add_u32 s22, s42, 4209664
    buffer_load_dwordx4 v9, s[12:15], s22 offen offset:1024 lds
    s_add_u32 s22, s42, 4225024
    buffer_load_dwordx4 v8, s[12:15], s22 offen offset:2048 lds
    s_add_u32 s22, s42, 4240384
    buffer_load_dwordx4 v9, s[12:15], s22 offen offset:3072 lds
    ds_read_b64_tr_b16 v[76:77], v10 offset:32768
    ds_read_b64_tr_b16 v[78:79], v10 offset:34816
    ds_read_b64_tr_b16 v[148:149], v10 offset:32776
    ds_read_b64_tr_b16 v[150:151], v10 offset:34824
    ds_read_b64_tr_b16 a[12:13], v10 offset:33024
    ds_read_b64_tr_b16 a[14:15], v10 offset:35072
    ds_read_b64_tr_b16 a[84:85], v10 offset:33032
    ds_read_b64_tr_b16 a[86:87], v10 offset:35080
    s_waitcnt vmcnt(12) lgkmcnt(0)
    s_barrier
    s_add_u32 m0, s44, 106496
    s_add_u32 s22, s42, 4456448
    buffer_load_dwordx4 v8, s[12:15], s22 offen offset:0 lds
    s_add_u32 s22, s42, 4471808
    buffer_load_dwordx4 v9, s[12:15], s22 offen offset:1024 lds
    s_add_u32 s22, s42, 4487168
    buffer_load_dwordx4 v8, s[12:15], s22 offen offset:2048 lds
    s_add_u32 s22, s42, 4502528
    buffer_load_dwordx4 v9, s[12:15], s22 offen offset:3072 lds
    ds_read_b64_tr_b16 v[92:93], v11 offset:0
    ds_read_b64_tr_b16 v[94:95], v11 offset:2048
    ds_read_b64_tr_b16 v[164:165], v11 offset:8
    ds_read_b64_tr_b16 v[166:167], v11 offset:2056
    ds_read_b64_tr_b16 a[28:29], v11 offset:256
    ds_read_b64_tr_b16 a[30:31], v11 offset:2304
    ds_read_b64_tr_b16 a[100:101], v11 offset:264
    ds_read_b64_tr_b16 a[102:103], v11 offset:2312
    s_waitcnt vmcnt(12) lgkmcnt(0)
    s_barrier
    s_mov_b32 s27, 36864
    s_add_u32 s23, s27, s25
    s_add_u32 m0, s23, 0
    s_nop 0
    buffer_load_dwordx4 v2, s[8:11], s24 offen offset:0 lds
    s_add_u32 m0, s23, 960
    s_nop 0
    buffer_load_dwordx4 v2, s[8:11], s24 offen offset:64 lds
    s_add_u32 m0, s23, 1920
    s_nop 0
    buffer_load_dwordx4 v2, s[8:11], s24 offen offset:128 lds
    s_add_u32 m0, s23, 2880
    s_nop 0
    buffer_load_dwordx4 v2, s[8:11], s24 offen offset:192 lds
    s_add_u32 m0, s23, 3840
    s_nop 0
    buffer_load_dwordx4 v2, s[8:11], s24 offen offset:256 lds
    s_add_u32 m0, s23, 4800
    s_nop 0
    buffer_load_dwordx4 v2, s[8:11], s24 offen offset:320 lds
    s_add_u32 m0, s23, 5760
    s_nop 0
    buffer_load_dwordx4 v2, s[8:11], s24 offen offset:384 lds
    s_add_u32 m0, s23, 6720
    s_nop 0
    buffer_load_dwordx4 v2, s[8:11], s24 offen offset:448 lds
    s_add_u32 m0, s23, 7680
    s_nop 0
    buffer_load_dwordx4 v2, s[8:11], s24 offen offset:512 lds
    s_add_u32 s24, s24, 147456
    ds_read_b64_tr_b16 v[108:109], v11 offset:16384
    ds_read_b64_tr_b16 v[110:111], v11 offset:18432
    ds_read_b64_tr_b16 v[180:181], v11 offset:16392
    ds_read_b64_tr_b16 v[182:183], v11 offset:18440
    ds_read_b64_tr_b16 a[44:45], v11 offset:16640
    ds_read_b64_tr_b16 a[46:47], v11 offset:18688
    ds_read_b64_tr_b16 a[116:117], v11 offset:16648
    ds_read_b64_tr_b16 a[118:119], v11 offset:18696
    s_waitcnt vmcnt(17) lgkmcnt(0)
    s_barrier
    ds_read_b64_tr_b16 v[124:125], v10 offset:0
    ds_read_b64_tr_b16 v[126:127], v10 offset:2048
    ds_read_b64_tr_b16 v[196:197], v10 offset:8
    ds_read_b64_tr_b16 v[198:199], v10 offset:2056
    ds_read_b64_tr_b16 a[60:61], v10 offset:256
    ds_read_b64_tr_b16 a[62:63], v10 offset:2304
    ds_read_b64_tr_b16 a[132:133], v10 offset:264
    ds_read_b64_tr_b16 a[134:135], v10 offset:2312
    s_waitcnt vmcnt(13) lgkmcnt(0)
    s_barrier
    ds_read_b64_tr_b16 v[128:129], v10 offset:16384
    ds_read_b64_tr_b16 v[130:131], v10 offset:18432
    ds_read_b64_tr_b16 v[200:201], v10 offset:16392
    ds_read_b64_tr_b16 v[202:203], v10 offset:18440
    ds_read_b64_tr_b16 a[64:65], v10 offset:16640
    ds_read_b64_tr_b16 a[66:67], v10 offset:18688
    ds_read_b64_tr_b16 a[136:137], v10 offset:16648
    ds_read_b64_tr_b16 a[138:139], v10 offset:18696
    s_waitcnt vmcnt(9) lgkmcnt(0)
    s_barrier
    ds_read_b64_tr_b16 v[132:133], v10 offset:32768
    ds_read_b64_tr_b16 v[134:135], v10 offset:34816
    ds_read_b64_tr_b16 v[204:205], v10 offset:32776
    ds_read_b64_tr_b16 v[206:207], v10 offset:34824
    ds_read_b64_tr_b16 a[68:69], v10 offset:33024
    ds_read_b64_tr_b16 a[70:71], v10 offset:35072
    ds_read_b64_tr_b16 a[140:141], v10 offset:33032
    ds_read_b64_tr_b16 a[142:143], v10 offset:35080
    s_mov_b32 s88, 4194304
gn9:
    buffer_load_dword v250, off, s[84:87], 0 offset:216 sc1
    s_waitcnt vmcnt(0)
    v_readfirstlane_b32 s95, v250
    s_sub_u32 s88, s88, 1
    s_cbranch_scc1 gn9x
    s_cmp_eq_u32 s95, 0
    s_cbranch_scc1 gn9
gn9x:
    s_waitcnt lgkmcnt(0)
    s_mov_b32 s45, 0
    s_mov_b32 s27, 0
    s_mov_b64 s[36:37], 0
    s_mov_b32 s12, 0
    s_mov_b32 s13, s40
    s_lshr_b32 s14, s41, 5
    s_add_u32 s15, s14, s40
    s_lshl_b32 s41, s41, 2
    s_sub_u32 s26, s26, s41
    v_mov_b32 v3, v1
    s_waitcnt vmcnt(0)
    s_barrier
    ds_read_b128 v[32:35], v3 offset:0
    ds_read_b128 v[36:39], v3 offset:18432
    ds_read_b128 v[40:43], v3 offset:1024
    ds_read_b128 v[44:47], v3 offset:19456
    s_cmp_eq_u32 s18, 0
    s_cselect_b32 s34, 1, 0
    s_mov_b32 s35, 0
    s_cmp_eq_u32 s16, 2
    s_cbranch_scc1 qk_vloop
qk_loop:
    s_barrier
    s_add_u32 s22, s27, 73728
    s_sub_u32 s21, s22, 110592
    s_cselect_b32 s22, s22, s21
    s_waitcnt lgkmcnt(2)
    v_mfma_f32_16x16x32_bf16 v[208:211], v[64:67], v[32:35], 0
    ds_read_b128 v[48:51], v3 offset:2048
    v_mfma_f32_16x16x32_bf16 v[212:215], v[136:139], v[32:35], 0
    ds_read_b128 v[52:55], v3 offset:20480
    v_mfma_f32_16x16x32_bf16 v[216:219], v[64:67], v[36:39], 0
    v_mfma_f32_16x16x32_bf16 v[220:223], v[136:139], v[36:39], 0
    v_mfma_f32_16x16x32_bf16 v[224:227], a[0:3], v[32:35], 0
    v_mfma_f32_16x16x32_bf16 v[228:231], a[72:75], v[32:35], 0
    v_mfma_f32_16x16x32_bf16 v[232:235], a[0:3], v[36:39], 0
    v_mfma_f32_16x16x32_bf16 v[236:239], a[72:75], v[36:39], 0
    s_waitcnt lgkmcnt(2)
    v_mfma_f32_16x16x32_bf16 v[208:211], v[68:71], v[40:43], v[208:211]
    ds_read_b128 v[32:35], v3 offset:3072
    v_mfma_f32_16x16x32_bf16 v[212:215], v[140:143], v[40:43], v[212:215]
    ds_read_b128 v[36:39], v3 offset:21504
    v_mfma_f32_16x16x32_bf16 v[216:219], v[68:71], v[44:47], v[216:219]
    s_add_u32 s23, s22, s25
    s_add_u32 m0, s23, 0
    s_nop 0
    buffer_load_dwordx4 v2, s[8:11], s24 offen offset:0 lds
    v_mfma_f32_16x16x32_bf16 v[220:223], v[140:143], v[44:47], v[220:223]
    v_mfma_f32_16x16x32_bf16 v[224:227], a[4:7], v[40:43], v[224:227]
    v_mfma_f32_16x16x32_bf16 v[228:231], a[76:79], v[40:43], v[228:231]
    v_mfma_f32_16x16x32_bf16 v[232:235], a[4:7], v[44:47], v[232:235]
    s_add_u32 m0, s23, 960
    s_nop 0
    buffer_load_dwordx4 v2, s[8:11], s24 offen offset:64 lds
    v_mfma_f32_16x16x32_bf16 v[236:239], a[76:79], v[44:47], v[236:239]
    s_waitcnt lgkmcnt(2)
    v_mfma_f32_16x16x32_bf16 v[208:211], v[72:75], v[48:51], v[208:211]
    ds_read_b128 v[40:43], v3 offset:4096
    v_mfma_f32_16x16x32_bf16 v[212:215], v[144:147], v[48:51], v[212:215]
    ds_read_b128 v[44:47], v3 offset:22528
    v_mfma_f32_16x16x32_bf16 v[216:219], v[72:75], v[52:55], v[216:219]
    s_add_u32 m0, s23, 1920
    s_nop 0
    buffer_load_dwordx4 v2, s[8:11], s24 offen offset:128 lds
    v_mfma_f32_16x16x32_bf16 v[220:223], v[144:147], v[52:55], v[220:223]
    v_mfma_f32_16x16x32_bf16 v[224:227], a[8:11], v[48:51], v[224:227]
    v_mfma_f32_16x16x32_bf16 v[228:231], a[80:83], v[48:51], v[228:231]
    v_mfma_f32_16x16x32_bf16 v[232:235], a[8:11], v[52:55], v[232:235]
    s_add_u32 m0, s23, 2880
    s_nop 0
    buffer_load_dwordx4 v2, s[8:11], s24 offen offset:192 lds
    v_mfma_f32_16x16x32_bf16 v[236:239], a[80:83], v[52:55], v[236:239]
    s_waitcnt lgkmcnt(2)
    v_mfma_f32_16x16x32_bf16 v[208:211], v[76:79], v[32:35], v[208:211]
    ds_read_b128 v[48:51], v3 offset:5120
    v_mfma_f32_16x16x32_bf16 v[212:215], v[148:151], v[32:35], v[212:215]
    ds_read_b128 v[52:55], v3 offset:23552
    v_mfma_f32_16x16x32_bf16 v[216:219], v[76:79], v[36:39], v[216:219]
    s_add_u32 m0, s23, 3840
    s_nop 0
    buffer_load_dwordx4 v2, s[8:11], s24 offen offset:256 lds
    v_mfma_f32_16x16x32_bf16 v[220:223], v[148:151], v[36:39], v[220:223]
    v_mfma_f32_16x16x32_bf16 v[224:227], a[12:15], v[32:35], v[224:227]
    v_mfma_f32_16x16x32_bf16 v[228:231], a[84:87], v[32:35], v[228:231]
    v_mfma_f32_16x16x32_bf16 v[232:235], a[12:15], v[36:39], v[232:235]
    s_add_u32 m0, s23, 4800
    s_nop 0
    buffer_load_dwordx4 v2, s[8:11], s24 offen offset:320 lds
    v_mfma_f32_16x16x32_bf16 v[236:239], a[84:87], v[36:39], v[236:239]
    s_waitcnt lgkmcnt(2)
    v_mfma_f32_16x16x32_bf16 v[208:211], v[80:83], v[40:43], v[208:211]
    ds_read_b128 v[32:35], v3 offset:6144
    v_mfma_f32_16x16x32_bf16 v[212:215], v[152:155], v[40:43], v[212:215]
    ds_read_b128 v[36:39], v3 offset:24576
    v_mfma_f32_16x16x32_bf16 v[216:219], v[80:83], v[44:47], v[216:219]
    s_add_u32 m0, s23, 5760
    s_nop 0
    buffer_load_dwordx4 v2, s[8:11], s24 offen offset:384 lds
    v_mfma_f32_16x16x32_bf16 v[220:223], v[152:155], v[44:47], v[220:223]
    v_mfma_f32_16x16x32_bf16 v[224:227], a[16:19], v[40:43], v[224:227]
    v_mfma_f32_16x16x32_bf16 v[228:231], a[88:91], v[40:43], v[228:231]
    v_mfma_f32_16x16x32_bf16 v[232:235], a[16:19], v[44:47], v[232:235]
    s_add_u32 m0, s23, 6720
    s_nop 0
    buffer_load_dwordx4 v2, s[8:11], s24 offen offset:448 lds
    v_mfma_f32_16x16x32_bf16 v[236:239], a[88:91], v[44:47], v[236:239]
    s_waitcnt lgkmcnt(2)
    v_mfma_f32_16x16x32_bf16 v[208:211], v[84:87], v[48:51], v[208:211]
    ds_read_b128 v[40:43], v3 offset:7168
    v_mfma_f32_16x16x32_bf16 v[212:215], v[156:159], v[48:51], v[212:215]
    ds_read_b128 v[44:47], v3 offset:25600
    v_mfma_f32_16x16x32_bf16 v[216:219], v[84:87], v[52:55], v[216:219]
    s_add_u32 m0, s23, 7680
    s_nop 0
    buffer_load_dwordx4 v2, s[8:11], s24 offen offset:512 lds
    s_add_u32 s24, s24, 147456
    v_mfma_f32_16x16x32_bf16 v[220:223], v[156:159], v[52:55], v[220:223]
    v_mfma_f32_16x16x32_bf16 v[224:227], a[20:23], v[48:51], v[224:227]
    v_mfma_f32_16x16x32_bf16 v[228:231], a[92:95], v[48:51], v[228:231]
    v_mfma_f32_16x16x32_bf16 v[232:235], a[20:23], v[52:55], v[232:235]
    v_mfma_f32_16x16x32_bf16 v[236:239], a[92:95], v[52:55], v[236:239]
    s_waitcnt lgkmcnt(2)
    v_mfma_f32_16x16x32_bf16 v[208:211], v[88:91], v[32:35], v[208:211]
    ds_read_b128 v[48:51], v3 offset:8192
    v_mfma_f32_16x16x32_bf16 v[212:215], v[160:163], v[32:35], v[212:215]
    ds_read_b128 v[52:55], v3 offset:26624
    v_mfma_f32_16x16x32_bf16 v[216:219], v[88:91], v[36:39], v[216:219]
    v_mfma_f32_16x16x32_bf16 v[220:223], v[160:163], v[36:39], v[220:223]
    v_mfma_f32_16x16x32_bf16 v[224:227], a[24:27], v[32:35], v[224:227]
    v_mfma_f32_16x16x32_bf16 v[228:231], a[96:99], v[32:35], v[228:231]
    v_mfma_f32_16x16x32_bf16 v[232:235], a[24:27], v[36:39], v[232:235]
    v_mfma_f32_16x16x32_bf16 v[236:239], a[96:99], v[36:39], v[236:239]
    s_waitcnt lgkmcnt(2)
    v_mfma_f32_16x16x32_bf16 v[208:211], v[92:95], v[40:43], v[208:211]
    ds_read_b128 v[32:35], v3 offset:9216
    v_mfma_f32_16x16x32_bf16 v[212:215], v[164:167], v[40:43], v[212:215]
    ds_read_b128 v[36:39], v3 offset:27648
    v_mfma_f32_16x16x32_bf16 v[216:219], v[92:95], v[44:47], v[216:219]
    s_add_u32 s23, s45, s95
    v_mov_b32 v4, s23
    s_mov_b64 exec, s[34:35]
    buffer_store_dword v4, off, s[4:7], s29 sc1
    buffer_store_dword v4, off, s[4:7], s29 offset:128 sc1
    s_mov_b64 exec, -1
    v_mfma_f32_16x16x32_bf16 v[220:223], v[164:167], v[44:47], v[220:223]
    v_mfma_f32_16x16x32_bf16 v[224:227], a[28:31], v[40:43], v[224:227]
    v_mfma_f32_16x16x32_bf16 v[228:231], a[100:103], v[40:43], v[228:231]
    v_mfma_f32_16x16x32_bf16 v[232:235], a[28:31], v[44:47], v[232:235]
    v_mfma_f32_16x16x32_bf16 v[236:239], a[100:103], v[44:47], v[236:239]
    s_waitcnt lgkmcnt(2)
    v_mfma_f32_16x16x32_bf16 v[208:211], v[96:99], v[48:51], v[208:211]
    ds_read_b128 v[40:43], v3 offset:10240
    v_mfma_f32_16x16x32_bf16 v[212:215], v[168:171], v[48:51], v[212:215]
    ds_read_b128 v[44:47], v3 offset:28672
    v_mfma_f32_16x16x32_bf16 v[216:219], v[96:99], v[52:55], v[216:219]
    s_cmp_lt_u32 s19, 60
    s_cbranch_scc1 lt10
    buffer_load_dwordx4 v[244:247], off, s[84:87], 0 offset:16 sc1
    buffer_load_dwordx4 v[240:243], off, s[84:87], 0 offset:32 sc1
    buffer_load_dwordx2 v[252:253], off, s[84:87], 0 offset:48 sc1
lt10:
    s_lshr_b32 s46, s19, 2
    s_cmp_eq_u32 s16, 0
    s_cselect_b32 s46, 0, s46
    s_cmp_lg_u32 s46, 2
    s_cbranch_scc1 lp10
    v_mov_b32 v244, -1
    v_mov_b32 v245, -1
    v_mov_b32 v246, -1
    v_mov_b32 v247, -1
    s_lshl_b32 s46, s19, 5
    s_add_u32 s46, s46, s17
    s_lshl_b32 s46, s46, 12
    s_mul_i32 s47, s16, 8388608
    s_add_u32 s46, s46, s47
    s_add_u32 s47, s46, 67108864
    buffer_store_dwordx4 v[244:247], v7, s[4:7], s47 offen sc1
    s_add_u32 s47, s46, 67112960
    buffer_store_dwordx4 v[244:247], v7, s[4:7], s47 offen sc1
    s_add_u32 s47, s46, 67633152
    buffer_store_dwordx4 v[244:247], v7, s[4:7], s47 offen sc1
    s_add_u32 s47, s46, 67637248
    buffer_store_dwordx4 v[244:247], v7, s[4:7], s47 offen sc1
lp10:
    s_lshl_b32 s46, s16, 6
    s_or_b32 s46, s46, s19
    s_or_b32 s47, s46, 1
    s_cmp_lg_u32 s47, 11
    s_cbranch_scc1 lq10
    v_mov_b32 v244, -1
    v_mov_b32 v245, -1
    v_mov_b32 v246, -1
    v_mov_b32 v247, -1
    s_lshl_b32 s46, s46, 18
    s_lshl_b32 s47, s17, 12
    s_add_u32 s46, s46, s47
    s_add_u32 s47, s46, 63963136
    buffer_store_dwordx4 v[244:247], v7, s[4:7], s47 offen sc1
    s_add_u32 s47, s46, 63967232
    buffer_store_dwordx4 v[244:247], v7, s[4:7], s47 offen sc1
    s_add_u32 s47, s46, 64094208
    buffer_store_dwordx4 v[244:247], v7, s[4:7], s47 offen sc1
    s_add_u32 s47, s46, 64098304
    buffer_store_dwordx4 v[244:247], v7, s[4:7], s47 offen sc1
lq10:
    v_mfma_f32_16x16x32_bf16 v[220:223], v[168:171], v[52:55], v[220:223]
    v_mfma_f32_16x16x32_bf16 v[224:227], a[32:35], v[48:51], v[224:227]
    v_mfma_f32_16x16x32_bf16 v[228:231], a[104:107], v[48:51], v[228:231]
    v_mfma_f32_16x16x32_bf16 v[232:235], a[32:35], v[52:55], v[232:235]
    v_mfma_f32_16x16x32_bf16 v[236:239], a[104:107], v[52:55], v[236:239]
    s_waitcnt lgkmcnt(2)
    v_mfma_f32_16x16x32_bf16 v[208:211], v[100:103], v[32:35], v[208:211]
    ds_read_b128 v[48:51], v3 offset:11264
    v_mfma_f32_16x16x32_bf16 v[212:215], v[172:175], v[32:35], v[212:215]
    ds_read_b128 v[52:55], v3 offset:29696
    v_mfma_f32_16x16x32_bf16 v[216:219], v[100:103], v[36:39], v[216:219]
    v_mfma_f32_16x16x32_bf16 v[220:223], v[172:175], v[36:39], v[220:223]
    v_mfma_f32_16x16x32_bf16 v[224:227], a[36:39], v[32:35], v[224:227]
    v_mfma_f32_16x16x32_bf16 v[228:231], a[108:111], v[32:35], v[228:231]
    v_mfma_f32_16x16x32_bf16 v[232:235], a[36:39], v[36:39], v[232:235]
    v_mfma_f32_16x16x32_bf16 v[236:239], a[108:111], v[36:39], v[236:239]
    s_waitcnt lgkmcnt(2)
    v_mfma_f32_16x16x32_bf16 v[208:211], v[104:107], v[40:43], v[208:211]
    ds_read_b128 v[32:35], v3 offset:12288
    v_mfma_f32_16x16x32_bf16 v[212:215], v[176:179], v[40:43], v[212:215]
    ds_read_b128 v[36:39], v3 offset:30720
    v_mfma_f32_16x16x32_bf16 v[216:219], v[104:107], v[44:47], v[216:219]
    v_mfma_f32_16x16x32_bf16 v[220:223], v[176:179], v[44:47], v[220:223]
    v_mfma_f32_16x16x32_bf16 v[224:227], a[40:43], v[40:43], v[224:227]
    v_mfma_f32_16x16x32_bf16 v[228:231], a[112:115], v[40:43], v[228:231]
    v_mfma_f32_16x16x32_bf16 v[232:235], a[40:43], v[44:47], v[232:235]
    v_mfma_f32_16x16x32_bf16 v[236:239], a[112:115], v[44:47], v[236:239]
    s_waitcnt lgkmcnt(2)
    v_mfma_f32_16x16x32_bf16 v[208:211], v[108:111], v[48:51], v[208:211]
    ds_read_b128 v[40:43], v3 offset:13312
    v_mfma_f32_16x16x32_bf16 v[212:215], v[180:183], v[48:51], v[212:215]
    ds_read_b128 v[44:47], v3 offset:31744
    v_mfma_f32_16x16x32_bf16 v[216:219], v[108:111], v[52:55], v[216:219]
    v_mfma_f32_16x16x32_bf16 v[220:223], v[180:183], v[52:55], v[220:223]
    v_mfma_f32_16x16x32_bf16 v[224:227], a[44:47], v[48:51], v[224:227]
    v_mfma_f32_16x16x32_bf16 v[228:231], a[116:119], v[48:51], v[228:231]
    v_mfma_f32_16x16x32_bf16 v[232:235], a[44:47], v[52:55], v[232:235]
    v_mfma_f32_16x16x32_bf16 v[236:239], a[116:119], v[52:55], v[236:239]
    s_waitcnt lgkmcnt(2)
    v_mfma_f32_16x16x32_bf16 v[208:211], v[112:115], v[32:35], v[208:211]
    ds_read_b128 v[48:51], v3 offset:14336
    v_mfma_f32_16x16x32_bf16 v[212:215], v[184:187], v[32:35], v[212:215]
    ds_read_b128 v[52:55], v3 offset:32768
    v_mfma_f32_16x16x32_bf16 v[216:219], v[112:115], v[36:39], v[216:219]
    v_mfma_f32_16x16x32_bf16 v[220:223], v[184:187], v[36:39], v[220:223]
    v_mfma_f32_16x16x32_bf16 v[224:227], a[48:51], v[32:35], v[224:227]
    v_mfma_f32_16x16x32_bf16 v[228:231], a[120:123], v[32:35], v[228:231]
    v_mfma_f32_16x16x32_bf16 v[232:235], a[48:51], v[36:39], v[232:235]
    v_mfma_f32_16x16x32_bf16 v[236:239], a[120:123], v[36:39], v[236:239]
    s_waitcnt lgkmcnt(2)
    v_mfma_f32_16x16x32_bf16 v[208:211], v[116:119], v[40:43], v[208:211]
    ds_read_b128 v[32:35], v3 offset:15360
    v_mfma_f32_16x16x32_bf16 v[212:215], v[188:191], v[40:43], v[212:215]
    ds_read_b128 v[36:39], v3 offset:33792
    v_mfma_f32_16x16x32_bf16 v[216:219], v[116:119], v[44:47], v[216:219]
    v_mfma_f32_16x16x32_bf16 v[220:223], v[188:191], v[44:47], v[220:223]
    v_mfma_f32_16x16x32_bf16 v[224:227], a[52:55], v[40:43], v[224:227]
    v_mfma_f32_16x16x32_bf16 v[228:231], a[124:127], v[40:43], v[228:231]
    v_mfma_f32_16x16x32_bf16 v[232:235], a[52:55], v[44:47], v[232:235]
    v_mfma_f32_16x16x32_bf16 v[236:239], a[124:127], v[44:47], v[236:239]
    s_waitcnt lgkmcnt(2)
    v_mfma_f32_16x16x32_bf16 v[208:211], v[120:123], v[48:51], v[208:211]
    ds_read_b128 v[40:43], v3 offset:16384
    v_mfma_f32_16x16x32_bf16 v[212:215], v[192:195], v[48:51], v[212:215]
    ds_read_b128 v[44:47], v3 offset:34816
    v_mfma_f32_16x16x32_bf16 v[216:219], v[120:123], v[52:55], v[216:219]
    v_mfma_f32_16x16x32_bf16 v[220:223], v[192:195], v[52:55], v[220:223]
    v_mfma_f32_16x16x32_bf16 v[224:227], a[56:59], v[48:51], v[224:227]
    v_mfma_f32_16x16x32_bf16 v[228:231], a[128:131], v[48:51], v[228:231]
    v_mfma_f32_16x16x32_bf16 v[232:235], a[56:59], v[52:55], v[232:235]
    v_mfma_f32_16x16x32_bf16 v[236:239], a[128:131], v[52:55], v[236:239]
    s_waitcnt lgkmcnt(2)
    v_mfma_f32_16x16x32_bf16 v[208:211], v[124:127], v[32:35], v[208:211]
    ds_read_b128 v[48:51], v3 offset:17408
    v_mfma_f32_16x16x32_bf16 v[212:215], v[196:199], v[32:35], v[212:215]
    ds_read_b128 v[52:55], v3 offset:35840
    v_mfma_f32_16x16x32_bf16 v[216:219], v[124:127], v[36:39], v[216:219]
    v_mfma_f32_16x16x32_bf16 v[220:223], v[196:199], v[36:39], v[220:223]
    v_mfma_f32_16x16x32_bf16 v[224:227], a[60:63], v[32:35], v[224:227]
    s_add_u32 s27, s27, 36864
    s_cmp_eq_u32 s27, 110592
    s_cselect_b32 s27, 0, s27
    v_add_u32 v3, s27, v1
    v_mfma_f32_16x16x32_bf16 v[228:231], a[132:135], v[32:35], v[228:231]
    v_mfma_f32_16x16x32_bf16 v[232:235], a[60:63], v[36:39], v[232:235]
    v_mfma_f32_16x16x32_bf16 v[236:239], a[132:135], v[36:39], v[236:239]
    s_waitcnt lgkmcnt(2)
    v_mfma_f32_16x16x32_bf16 v[208:211], v[128:131], v[40:43], v[208:211]
    ds_read_b128 v[32:35], v3 offset:0
    v_mfma_f32_16x16x32_bf16 v[212:215], v[200:203], v[40:43], v[212:215]
    ds_read_b128 v[36:39], v3 offset:18432
    v_mfma_f32_16x16x32_bf16 v[216:219], v[128:131], v[44:47], v[216:219]
    v_mfma_f32_16x16x32_bf16 v[220:223], v[200:203], v[44:47], v[220:223]
    v_mfma_f32_16x16x32_bf16 v[224:227], a[64:67], v[40:43], v[224:227]
    v_mfma_f32_16x16x32_bf16 v[228:231], a[136:139], v[40:43], v[228:231]
    v_mfma_f32_16x16x32_bf16 v[232:235], a[64:67], v[44:47], v[232:235]
    v_mfma_f32_16x16x32_bf16 v[236:239], a[136:139], v[44:47], v[236:239]
    s_waitcnt lgkmcnt(2)
    v_mfma_f32_16x16x32_bf16 v[208:211], v[132:135], v[48:51], v[208:211]
    ds_read_b128 v[40:43], v3 offset:1024
    v_mfma_f32_16x16x32_bf16 v[212:215], v[204:207], v[48:51], v[212:215]
    ds_read_b128 v[44:47], v3 offset:19456
    v_mfma_f32_16x16x32_bf16 v[216:219], v[132:135], v[52:55], v[216:219]
    v_mfma_f32_16x16x32_bf16 v[220:223], v[204:207], v[52:55], v[220:223]
    v_mfma_f32_16x16x32_bf16 v[224:227], a[68:71], v[48:51], v[224:227]
    v_mfma_f32_16x16x32_bf16 v[228:231], a[140:143], v[48:51], v[228:231]
    v_mfma_f32_16x16x32_bf16 v[232:235], a[68:71], v[52:55], v[232:235]
    v_mfma_f32_16x16x32_bf16 v[236:239], a[140:143], v[52:55], v[236:239]
    s_add_u32 s26, s26, s41
    s_waitcnt vmcnt(0)
    v_cvt_pk_bf16_f32 v8, v208, v209
    v_cvt_pk_bf16_f32 v9, v210, v211
    v_cvt_pk_bf16_f32 v10, v212, v213
    v_cvt_pk_bf16_f32 v11, v214, v215
    v_cvt_pk_bf16_f32 v12, v216, v217
    v_cvt_pk_bf16_f32 v13, v218, v219
    v_cvt_pk_bf16_f32 v14, v220, v221
    v_cvt_pk_bf16_f32 v15, v222, v223
    v_cvt_pk_bf16_f32 v16, v224, v225
    v_cvt_pk_bf16_f32 v17, v226, v227
    v_cvt_pk_bf16_f32 v18, v228, v229
    v_cvt_pk_bf16_f32 v19, v230, v231
    v_cvt_pk_bf16_f32 v20, v232, v233
    v_cvt_pk_bf16_f32 v21, v234, v235
    v_cvt_pk_bf16_f32 v22, v236, v237
    v_cvt_pk_bf16_f32 v23, v238, v239
    s_mov_b64 s[36:37], -1
    s_add_u32 s28, s26, s12
    buffer_store_dwordx4 v[8:11], v7, s[4:7], s28 offen sc1
    s_add_u32 s28, s26, s13
    buffer_store_dwordx4 v[12:15], v7, s[4:7], s28 offen sc1
    s_add_u32 s28, s26, s14
    buffer_store_dwordx4 v[16:19], v7, s[4:7], s28 offen sc1
    s_add_u32 s28, s26, s15
    buffer_store_dwordx4 v[20:23], v7, s[4:7], s28 offen sc1
    s_lshr_b32 s45, s19, 2
    s_cbranch_scc1 qk_loop_nf
    s_mov_b32 s45, 1
    s_mov_b64 s[36:37], 0
    s_waitcnt vmcnt(0)
    s_barrier
    s_add_u32 s23, s45, s95
    v_mov_b32 v4, s23
    s_mov_b64 exec, s[34:35]
    buffer_store_dword v4, off, s[4:7], s29 sc1
    buffer_store_dword v4, off, s[4:7], s29 offset:128 sc1
    s_mov_b64 exec, -1
qk_loop_nf:
    s_add_u32 s19, s19, 4
    s_cmp_lt_u32 s19, s20
    s_cbranch_scc1 qk_loop
    s_branch qk_done
qk_vloop:
    s_barrier
    s_add_u32 s22, s27, 73728
    s_sub_u32 s21, s22, 110592
    s_cselect_b32 s22, s22, s21
    s_waitcnt lgkmcnt(2)
    v_mfma_f32_16x16x32_bf16 v[208:211], v[32:35], v[64:67], 0
    ds_read_b128 v[48:51], v3 offset:2048
    v_mfma_f32_16x16x32_bf16 v[212:215], v[32:35], v[136:139], 0
    ds_read_b128 v[52:55], v3 offset:20480
    v_mfma_f32_16x16x32_bf16 v[216:219], v[36:39], v[64:67], 0
    v_mfma_f32_16x16x32_bf16 v[220:223], v[36:39], v[136:139], 0
    v_mfma_f32_16x16x32_bf16 v[224:227], v[32:35], a[0:3], 0
    v_mfma_f32_16x16x32_bf16 v[228:231], v[32:35], a[72:75], 0
    v_mfma_f32_16x16x32_bf16 v[232:235], v[36:39], a[0:3], 0
    v_mfma_f32_16x16x32_bf16 v[236:239], v[36:39], a[72:75], 0
    s_waitcnt lgkmcnt(2)
    v_mfma_f32_16x16x32_bf16 v[208:211], v[40:43], v[68:71], v[208:211]
    ds_read_b128 v[32:35], v3 offset:3072
    v_mfma_f32_16x16x32_bf16 v[212:215], v[40:43], v[140:143], v[212:215]
    ds_read_b128 v[36:39], v3 offset:21504
    v_mfma_f32_16x16x32_bf16 v[216:219], v[44:47], v[68:71], v[216:219]
    s_add_u32 s23, s22, s25
    s_add_u32 m0, s23, 0
    s_nop 0
    buffer_load_dwordx4 v2, s[8:11], s24 offen offset:0 lds
    v_mfma_f32_16x16x32_bf16 v[220:223], v[44:47], v[140:143], v[220:223]
    v_mfma_f32_16x16x32_bf16 v[224:227], v[40:43], a[4:7], v[224:227]
    v_mfma_f32_16x16x32_bf16 v[228:231], v[40:43], a[76:79], v[228:231]
    v_mfma_f32_16x16x32_bf16 v[232:235], v[44:47], a[4:7], v[232:235]
    s_add_u32 m0, s23, 960
    s_nop 0
    buffer_load_dwordx4 v2, s[8:11], s24 offen offset:64 lds
    v_mfma_f32_16x16x32_bf16 v[236:239], v[44:47], a[76:79], v[236:239]
    s_waitcnt lgkmcnt(2)
    v_mfma_f32_16x16x32_bf16 v[208:211], v[48:51], v[72:75], v[208:211]
    ds_read_b128 v[40:43], v3 offset:4096
    v_mfma_f32_16x16x32_bf16 v[212:215], v[48:51], v[144:147], v[212:215]
    ds_read_b128 v[44:47], v3 offset:22528
    v_mfma_f32_16x16x32_bf16 v[216:219], v[52:55], v[72:75], v[216:219]
    s_add_u32 m0, s23, 1920
    s_nop 0
    buffer_load_dwordx4 v2, s[8:11], s24 offen offset:128 lds
    v_mfma_f32_16x16x32_bf16 v[220:223], v[52:55], v[144:147], v[220:223]
    v_mfma_f32_16x16x32_bf16 v[224:227], v[48:51], a[8:11], v[224:227]
    v_mfma_f32_16x16x32_bf16 v[228:231], v[48:51], a[80:83], v[228:231]
    v_mfma_f32_16x16x32_bf16 v[232:235], v[52:55], a[8:11], v[232:235]
    s_add_u32 m0, s23, 2880
    s_nop 0
    buffer_load_dwordx4 v2, s[8:11], s24 offen offset:192 lds
    v_mfma_f32_16x16x32_bf16 v[236:239], v[52:55], a[80:83], v[236:239]
    s_waitcnt lgkmcnt(2)
    v_mfma_f32_16x16x32_bf16 v[208:211], v[32:35], v[76:79], v[208:211]
    ds_read_b128 v[48:51], v3 offset:5120
    v_mfma_f32_16x16x32_bf16 v[212:215], v[32:35], v[148:151], v[212:215]
    ds_read_b128 v[52:55], v3 offset:23552
    v_mfma_f32_16x16x32_bf16 v[216:219], v[36:39], v[76:79], v[216:219]
    s_add_u32 m0, s23, 3840
    s_nop 0
    buffer_load_dwordx4 v2, s[8:11], s24 offen offset:256 lds
    v_mfma_f32_16x16x32_bf16 v[220:223], v[36:39], v[148:151], v[220:223]
    v_mfma_f32_16x16x32_bf16 v[224:227], v[32:35], a[12:15], v[224:227]
    v_mfma_f32_16x16x32_bf16 v[228:231], v[32:35], a[84:87], v[228:231]
    v_mfma_f32_16x16x32_bf16 v[232:235], v[36:39], a[12:15], v[232:235]
    s_add_u32 m0, s23, 4800
    s_nop 0
    buffer_load_dwordx4 v2, s[8:11], s24 offen offset:320 lds
    v_mfma_f32_16x16x32_bf16 v[236:239], v[36:39], a[84:87], v[236:239]
    s_waitcnt lgkmcnt(2)
    v_mfma_f32_16x16x32_bf16 v[208:211], v[40:43], v[80:83], v[208:211]
    ds_read_b128 v[32:35], v3 offset:6144
    v_mfma_f32_16x16x32_bf16 v[212:215], v[40:43], v[152:155], v[212:215]
    ds_read_b128 v[36:39], v3 offset:24576
    v_mfma_f32_16x16x32_bf16 v[216:219], v[44:47], v[80:83], v[216:219]
    s_add_u32 m0, s23, 5760
    s_nop 0
    buffer_load_dwordx4 v2, s[8:11], s24 offen offset:384 lds
    v_mfma_f32_16x16x32_bf16 v[220:223], v[44:47], v[152:155], v[220:223]
    v_mfma_f32_16x16x32_bf16 v[224:227], v[40:43], a[16:19], v[224:227]
    v_mfma_f32_16x16x32_bf16 v[228:231], v[40:43], a[88:91], v[228:231]
    v_mfma_f32_16x16x32_bf16 v[232:235], v[44:47], a[16:19], v[232:235]
    s_add_u32 m0, s23, 6720
    s_nop 0
    buffer_load_dwordx4 v2, s[8:11], s24 offen offset:448 lds
    v_mfma_f32_16x16x32_bf16 v[236:239], v[44:47], a[88:91], v[236:239]
    s_waitcnt lgkmcnt(2)
    v_mfma_f32_16x16x32_bf16 v[208:211], v[48:51], v[84:87], v[208:211]
    ds_read_b128 v[40:43], v3 offset:7168
    v_mfma_f32_16x16x32_bf16 v[212:215], v[48:51], v[156:159], v[212:215]
    ds_read_b128 v[44:47], v3 offset:25600
    v_mfma_f32_16x16x32_bf16 v[216:219], v[52:55], v[84:87], v[216:219]
    s_add_u32 m0, s23, 7680
    s_nop 0
    buffer_load_dwordx4 v2, s[8:11], s24 offen offset:512 lds
    s_add_u32 s24, s24, 147456
    v_mfma_f32_16x16x32_bf16 v[220:223], v[52:55], v[156:159], v[220:223]
    v_mfma_f32_16x16x32_bf16 v[224:227], v[48:51], a[20:23], v[224:227]
    v_mfma_f32_16x16x32_bf16 v[228:231], v[48:51], a[92:95], v[228:231]
    v_mfma_f32_16x16x32_bf16 v[232:235], v[52:55], a[20:23], v[232:235]
    v_mfma_f32_16x16x32_bf16 v[236:239], v[52:55], a[92:95], v[236:239]
    s_waitcnt lgkmcnt(2)
    v_mfma_f32_16x16x32_bf16 v[208:211], v[32:35], v[88:91], v[208:211]
    ds_read_b128 v[48:51], v3 offset:8192
    v_mfma_f32_16x16x32_bf16 v[212:215], v[32:35], v[160:163], v[212:215]
    ds_read_b128 v[52:55], v3 offset:26624
    v_mfma_f32_16x16x32_bf16 v[216:219], v[36:39], v[88:91], v[216:219]
    v_mfma_f32_16x16x32_bf16 v[220:223], v[36:39], v[160:163], v[220:223]
    v_mfma_f32_16x16x32_bf16 v[224:227], v[32:35], a[24:27], v[224:227]
    v_mfma_f32_16x16x32_bf16 v[228:231], v[32:35], a[96:99], v[228:231]
    v_mfma_f32_16x16x32_bf16 v[232:235], v[36:39], a[24:27], v[232:235]
    v_mfma_f32_16x16x32_bf16 v[236:239], v[36:39], a[96:99], v[236:239]
    s_waitcnt lgkmcnt(2)
    v_mfma_f32_16x16x32_bf16 v[208:211], v[40:43], v[92:95], v[208:211]
    ds_read_b128 v[32:35], v3 offset:9216
    v_mfma_f32_16x16x32_bf16 v[212:215], v[40:43], v[164:167], v[212:215]
    ds_read_b128 v[36:39], v3 offset:27648
    v_mfma_f32_16x16x32_bf16 v[216:219], v[44:47], v[92:95], v[216:219]
    s_add_u32 s23, s45, s95
    v_mov_b32 v4, s23
    s_mov_b64 exec, s[34:35]
    buffer_store_dword v4, off, s[4:7], s29 sc1
    buffer_store_dword v4, off, s[4:7], s29 offset:128 sc1
    s_mov_b64 exec, -1
    v_mfma_f32_16x16x32_bf16 v[220:223], v[44:47], v[164:167], v[220:223]
    v_mfma_f32_16x16x32_bf16 v[224:227], v[40:43], a[28:31], v[224:227]
    v_mfma_f32_16x16x32_bf16 v[228:231], v[40:43], a[100:103], v[228:231]
    v_mfma_f32_16x16x32_bf16 v[232:235], v[44:47], a[28:31], v[232:235]
    v_mfma_f32_16x16x32_bf16 v[236:239], v[44:47], a[100:103], v[236:239]
    s_waitcnt lgkmcnt(2)
    v_mfma_f32_16x16x32_bf16 v[208:211], v[48:51], v[96:99], v[208:211]
    ds_read_b128 v[40:43], v3 offset:10240
    v_mfma_f32_16x16x32_bf16 v[212:215], v[48:51], v[168:171], v[212:215]
    ds_read_b128 v[44:47], v3 offset:28672
    v_mfma_f32_16x16x32_bf16 v[216:219], v[52:55], v[96:99], v[216:219]
    s_cmp_lt_u32 s19, 60
    s_cbranch_scc1 lt11
    buffer_load_dwordx4 v[244:247], off, s[84:87], 0 offset:16 sc1
    buffer_load_dwordx4 v[240:243], off, s[84:87], 0 offset:32 sc1
    buffer_load_dwordx2 v[252:253], off, s[84:87], 0 offset:48 sc1
lt11:
    s_lshr_b32 s46, s19, 2
    s_cmp_eq_u32 s16, 0
    s_cselect_b32 s46, 0, s46
    s_cmp_lg_u32 s46, 2
    s_cbranch_scc1 lp11
    v_mov_b32 v244, -1
    v_mov_b32 v245, -1
    v_mov_b32 v246, -1
    v_mov_b32 v247, -1
    s_lshl_b32 s46, s19, 5
    s_add_u32 s46, s46, s17
    s_lshl_b32 s46, s46, 12
    s_mul_i32 s47, s16, 8388608
    s_add_u32 s46, s46, s47
    s_add_u32 s47, s46, 67108864
    buffer_store_dwordx4 v[244:247], v7, s[4:7], s47 offen sc1
    s_add_u32 s47, s46, 67112960
    buffer_store_dwordx4 v[244:247], v7, s[4:7], s47 offen sc1
    s_add_u32 s47, s46, 67633152
    buffer_store_dwordx4 v[244:247], v7, s[4:7], s47 offen sc1
    s_add_u32 s47, s46, 67637248
    buffer_store_dwordx4 v[244:247], v7, s[4:7], s47 offen sc1
lp11:
    s_lshl_b32 s46, s16, 6
    s_or_b32 s46, s46, s19
    s_or_b32 s47, s46, 1
    s_cmp_lg_u32 s47, 11
    s_cbranch_scc1 lq11
    v_mov_b32 v244, -1
    v_mov_b32 v245, -1
    v_mov_b32 v246, -1
    v_mov_b32 v247, -1
    s_lshl_b32 s46, s46, 18
    s_lshl_b32 s47, s17, 12
    s_add_u32 s46, s46, s47
    s_add_u32 s47, s46, 63963136
    buffer_store_dwordx4 v[244:247], v7, s[4:7], s47 offen sc1
    s_add_u32 s47, s46, 63967232
    buffer_store_dwordx4 v[244:247], v7, s[4:7], s47 offen sc1
    s_add_u32 s47, s46, 64094208
    buffer_store_dwordx4 v[244:247], v7, s[4:7], s47 offen sc1
    s_add_u32 s47, s46, 64098304
    buffer_store_dwordx4 v[244:247], v7, s[4:7], s47 offen sc1
lq11:
    v_mfma_f32_16x16x32_bf16 v[220:223], v[52:55], v[168:171], v[220:223]
    v_mfma_f32_16x16x32_bf16 v[224:227], v[48:51], a[32:35], v[224:227]
    v_mfma_f32_16x16x32_bf16 v[228:231], v[48:51], a[104:107], v[228:231]
    v_mfma_f32_16x16x32_bf16 v[232:235], v[52:55], a[32:35], v[232:235]
    v_mfma_f32_16x16x32_bf16 v[236:239], v[52:55], a[104:107], v[236:239]
    s_waitcnt lgkmcnt(2)
    v_mfma_f32_16x16x32_bf16 v[208:211], v[32:35], v[100:103], v[208:211]
    ds_read_b128 v[48:51], v3 offset:11264
    v_mfma_f32_16x16x32_bf16 v[212:215], v[32:35], v[172:175], v[212:215]
    ds_read_b128 v[52:55], v3 offset:29696
    v_mfma_f32_16x16x32_bf16 v[216:219], v[36:39], v[100:103], v[216:219]
    v_mfma_f32_16x16x32_bf16 v[220:223], v[36:39], v[172:175], v[220:223]
    v_mfma_f32_16x16x32_bf16 v[224:227], v[32:35], a[36:39], v[224:227]
    v_mfma_f32_16x16x32_bf16 v[228:231], v[32:35], a[108:111], v[228:231]
    v_mfma_f32_16x16x32_bf16 v[232:235], v[36:39], a[36:39], v[232:235]
    v_mfma_f32_16x16x32_bf16 v[236:239], v[36:39], a[108:111], v[236:239]
    s_waitcnt lgkmcnt(2)
    v_mfma_f32_16x16x32_bf16 v[208:211], v[40:43], v[104:107], v[208:211]
    ds_read_b128 v[32:35], v3 offset:12288
    v_mfma_f32_16x16x32_bf16 v[212:215], v[40:43], v[176:179], v[212:215]
    ds_read_b128 v[36:39], v3 offset:30720
    v_mfma_f32_16x16x32_bf16 v[216:219], v[44:47], v[104:107], v[216:219]
    v_mfma_f32_16x16x32_bf16 v[220:223], v[44:47], v[176:179], v[220:223]
    v_mfma_f32_16x16x32_bf16 v[224:227], v[40:43], a[40:43], v[224:227]
    v_mfma_f32_16x16x32_bf16 v[228:231], v[40:43], a[112:115], v[228:231]
    v_mfma_f32_16x16x32_bf16 v[232:235], v[44:47], a[40:43], v[232:235]
    v_mfma_f32_16x16x32_bf16 v[236:239], v[44:47], a[112:115], v[236:239]
    s_waitcnt lgkmcnt(2)
    v_mfma_f32_16x16x32_bf16 v[208:211], v[48:51], v[108:111], v[208:211]
    ds_read_b128 v[40:43], v3 offset:13312
    v_mfma_f32_16x16x32_bf16 v[212:215], v[48:51], v[180:183], v[212:215]
    ds_read_b128 v[44:47], v3 offset:31744
    v_mfma_f32_16x16x32_bf16 v[216:219], v[52:55], v[108:111], v[216:219]
    v_mfma_f32_16x16x32_bf16 v[220:223], v[52:55], v[180:183], v[220:223]
    v_mfma_f32_16x16x32_bf16 v[224:227], v[48:51], a[44:47], v[224:227]
    v_mfma_f32_16x16x32_bf16 v[228:231], v[48:51], a[116:119], v[228:231]
    v_mfma_f32_16x16x32_bf16 v[232:235], v[52:55], a[44:47], v[232:235]
    v_mfma_f32_16x16x32_bf16 v[236:239], v[52:55], a[116:119], v[236:239]
    s_waitcnt lgkmcnt(2)
    v_mfma_f32_16x16x32_bf16 v[208:211], v[32:35], v[112:115], v[208:211]
    ds_read_b128 v[48:51], v3 offset:14336
    v_mfma_f32_16x16x32_bf16 v[212:215], v[32:35], v[184:187], v[212:215]
    ds_read_b128 v[52:55], v3 offset:32768
    v_mfma_f32_16x16x32_bf16 v[216:219], v[36:39], v[112:115], v[216:219]
    v_mfma_f32_16x16x32_bf16 v[220:223], v[36:39], v[184:187], v[220:223]
    v_mfma_f32_16x16x32_bf16 v[224:227], v[32:35], a[48:51], v[224:227]
    v_mfma_f32_16x16x32_bf16 v[228:231], v[32:35], a[120:123], v[228:231]
    v_mfma_f32_16x16x32_bf16 v[232:235], v[36:39], a[48:51], v[232:235]
    v_mfma_f32_16x16x32_bf16 v[236:239], v[36:39], a[120:123], v[236:239]
    s_waitcnt lgkmcnt(2)
    v_mfma_f32_16x16x32_bf16 v[208:211], v[40:43], v[116:119], v[208:211]
    ds_read_b128 v[32:35], v3 offset:15360
    v_mfma_f32_16x16x32_bf16 v[212:215], v[40:43], v[188:191], v[212:215]
    ds_read_b128 v[36:39], v3 offset:33792
    v_mfma_f32_16x16x32_bf16 v[216:219], v[44:47], v[116:119], v[216:219]
    v_mfma_f32_16x16x32_bf16 v[220:223], v[44:47], v[188:191], v[220:223]
    v_mfma_f32_16x16x32_bf16 v[224:227], v[40:43], a[52:55], v[224:227]
    v_mfma_f32_16x16x32_bf16 v[228:231], v[40:43], a[124:127], v[228:231]
    v_mfma_f32_16x16x32_bf16 v[232:235], v[44:47], a[52:55], v[232:235]
    v_mfma_f32_16x16x32_bf16 v[236:239], v[44:47], a[124:127], v[236:239]
    s_waitcnt lgkmcnt(2)
    v_mfma_f32_16x16x32_bf16 v[208:211], v[48:51], v[120:123], v[208:211]
    ds_read_b128 v[40:43], v3 offset:16384
    v_mfma_f32_16x16x32_bf16 v[212:215], v[48:51], v[192:195], v[212:215]
    ds_read_b128 v[44:47], v3 offset:34816
    v_mfma_f32_16x16x32_bf16 v[216:219], v[52:55], v[120:123], v[216:219]
    v_mfma_f32_16x16x32_bf16 v[220:223], v[52:55], v[192:195], v[220:223]
    v_mfma_f32_16x16x32_bf16 v[224:227], v[48:51], a[56:59], v[224:227]
    v_mfma_f32_16x16x32_bf16 v[228:231], v[48:51], a[128:131], v[228:231]
    v_mfma_f32_16x16x32_bf16 v[232:235], v[52:55], a[56:59], v[232:235]
    v_mfma_f32_16x16x32_bf16 v[236:239], v[52:55], a[128:131], v[236:239]
    s_waitcnt lgkmcnt(2)
    v_mfma_f32_16x16x32_bf16 v[208:211], v[32:35], v[124:127], v[208:211]
    ds_read_b128 v[48:51], v3 offset:17408
    v_mfma_f32_16x16x32_bf16 v[212:215], v[32:35], v[196:199], v[212:215]
    ds_read_b128 v[52:55], v3 offset:35840
    v_mfma_f32_16x16x32_bf16 v[216:219], v[36:39], v[124:127], v[216:219]
    v_mfma_f32_16x16x32_bf16 v[220:223], v[36:39], v[196:199], v[220:223]
    v_mfma_f32_16x16x32_bf16 v[224:227], v[32:35], a[60:63], v[224:227]
    s_add_u32 s27, s27, 36864
    s_cmp_eq_u32 s27, 110592
    s_cselect_b32 s27, 0, s27
    v_add_u32 v3, s27, v1
    v_mfma_f32_16x16x32_bf16 v[228:231], v[32:35], a[132:135], v[228:231]
    v_mfma_f32_16x16x32_bf16 v[232:235], v[36:39], a[60:63], v[232:235]
    v_mfma_f32_16x16x32_bf16 v[236:239], v[36:39], a[132:135], v[236:239]
    s_waitcnt lgkmcnt(2)
    v_mfma_f32_16x16x32_bf16 v[208:211], v[40:43], v[128:131], v[208:211]
    ds_read_b128 v[32:35], v3 offset:0
    v_mfma_f32_16x16x32_bf16 v[212:215], v[40:43], v[200:203], v[212:215]
    ds_read_b128 v[36:39], v3 offset:18432
    v_mfma_f32_16x16x32_bf16 v[216:219], v[44:47], v[128:131], v[216:219]
    v_mfma_f32_16x16x32_bf16 v[220:223], v[44:47], v[200:203], v[220:223]
    v_mfma_f32_16x16x32_bf16 v[224:227], v[40:43], a[64:67], v[224:227]
    v_mfma_f32_16x16x32_bf16 v[228:231], v[40:43], a[136:139], v[228:231]
    v_mfma_f32_16x16x32_bf16 v[232:235], v[44:47], a[64:67], v[232:235]
    v_mfma_f32_16x16x32_bf16 v[236:239], v[44:47], a[136:139], v[236:239]
    s_waitcnt lgkmcnt(2)
    v_mfma_f32_16x16x32_bf16 v[208:211], v[48:51], v[132:135], v[208:211]
    ds_read_b128 v[40:43], v3 offset:1024
    v_mfma_f32_16x16x32_bf16 v[212:215], v[48:51], v[204:207], v[212:215]
    ds_read_b128 v[44:47], v3 offset:19456
    v_mfma_f32_16x16x32_bf16 v[216:219], v[52:55], v[132:135], v[216:219]
    v_mfma_f32_16x16x32_bf16 v[220:223], v[52:55], v[204:207], v[220:223]
    v_mfma_f32_16x16x32_bf16 v[224:227], v[48:51], a[68:71], v[224:227]
    v_mfma_f32_16x16x32_bf16 v[228:231], v[48:51], a[140:143], v[228:231]
    v_mfma_f32_16x16x32_bf16 v[232:235], v[52:55], a[68:71], v[232:235]
    v_mfma_f32_16x16x32_bf16 v[236:239], v[52:55], a[140:143], v[236:239]
    s_add_u32 s26, s26, s41
    s_waitcnt vmcnt(0)
    v_cvt_pk_bf16_f32 v8, v208, v209
    v_cvt_pk_bf16_f32 v9, v210, v211
    v_cvt_pk_bf16_f32 v10, v216, v217
    v_cvt_pk_bf16_f32 v11, v218, v219
    v_cvt_pk_bf16_f32 v12, v212, v213
    v_cvt_pk_bf16_f32 v13, v214, v215
    v_cvt_pk_bf16_f32 v14, v220, v221
    v_cvt_pk_bf16_f32 v15, v222, v223
    v_cvt_pk_bf16_f32 v16, v224, v225
    v_cvt_pk_bf16_f32 v17, v226, v227
    v_cvt_pk_bf16_f32 v18, v232, v233
    v_cvt_pk_bf16_f32 v19, v234, v235
    v_cvt_pk_bf16_f32 v20, v228, v229
    v_cvt_pk_bf16_f32 v21, v230, v231
    v_cvt_pk_bf16_f32 v22, v236, v237
    v_cvt_pk_bf16_f32 v23, v238, v239
    s_mov_b64 s[36:37], -1
    s_add_u32 s28, s26, s12
    buffer_store_dwordx4 v[8:11], v7, s[4:7], s28 offen sc1
    s_add_u32 s28, s26, s13
    buffer_store_dwordx4 v[12:15], v7, s[4:7], s28 offen sc1
    s_add_u32 s28, s26, s14
    buffer_store_dwordx4 v[16:19], v7, s[4:7], s28 offen sc1
    s_add_u32 s28, s26, s15
    buffer_store_dwordx4 v[20:23], v7, s[4:7], s28 offen sc1
    s_lshr_b32 s45, s19, 2
    s_cbranch_scc1 qk_vloop_nf
    s_mov_b32 s45, 1
    s_mov_b64 s[36:37], 0
    s_waitcnt vmcnt(0)
    s_barrier
    s_add_u32 s23, s45, s95
    v_mov_b32 v4, s23
    s_mov_b64 exec, s[34:35]
    buffer_store_dword v4, off, s[4:7], s29 sc1
    buffer_store_dword v4, off, s[4:7], s29 offset:128 sc1
    s_mov_b64 exec, -1
qk_vloop_nf:
    s_add_u32 s19, s19, 4
    s_cmp_lt_u32 s19, s20
    s_cbranch_scc1 qk_vloop
qk_done:
    s_waitcnt vmcnt(0) lgkmcnt(0)
    s_barrier
    s_mov_b32 s45, 16
    s_add_u32 s23, s45, s95
    v_mov_b32 v4, s23
    s_mov_b64 exec, s[34:35]
    buffer_store_dword v4, off, s[4:7], s29 sc1
    buffer_store_dword v4, off, s[4:7], s29 offset:128 sc1
    s_mov_b64 exec, -1
    s_cmp_lt_i32 s33, 0
    s_cbranch_scc1 L_memkv
    v_max3_u32 v248, v240, v241, v242
    v_max3_u32 v248, v248, v243, v252
    v_max_u32 v248, v248, v253
    v_min3_u32 v240, v240, v241, v242
    v_min3_u32 v240, v240, v243, v252
    v_min_u32 v240, v240, v253
    v_lshl_add_u32 v248, v248, 16, v240
    v_readfirstlane_b32 s40, v245
    v_readfirstlane_b32 s41, v246
    v_readfirstlane_b32 s42, v247
    v_readfirstlane_b32 s43, v248
    s_cmp_ge_u32 s40, 160
    s_cselect_b32 s43, s43, 0
    s_cmp_ge_u32 s41, 1
    s_cselect_b32 s43, s43, 0
    s_cmp_eq_u32 s42, 1
    s_cselect_b32 s43, s43, 0
    s_cmp_eq_u32 s93, 1000
    s_cselect_b32 s43, s43, 0
    s_mov_b32 s93, 999
    v_mov_b32 v250, s43
    v_mov_b32 v251, 163832
    s_mov_b64 exec, s[34:35]
    ds_write_b32 v251, v250
    s_mov_b64 exec, -1
    s_waitcnt lgkmcnt(0)
    s_barrier
    ds_read_b32 v252, v251
    s_waitcnt lgkmcnt(0)
    v_readfirstlane_b32 s43, v252
    s_barrier
    s_cmp_lg_u32 s43, 2097184
    s_cbranch_scc1 L_qkv_next
    s_mov_b32 s45, s33
    s_mov_b32 s93, 500
    s_branch L_phase2b
L_memkv:
    v_and_b32 v4, 63, v0
    v_and_b32 v2, 7, v4
    v_lshrrev_b32 v5, 4, v4
    v_lshl_add_u32 v2, v5, 3, v2
    v_lshlrev_b32 v2, 4, v2
    v_bfe_u32 v3, v4, 3, 1
    v_mul_u32_u24 v5, 9216, v3
    v_add_u32 v2, v2, v5
    v_mov_b32 v240, 0x05040100
    v_mov_b32 v241, 0x07060302
    v_lshrrev_b32 v5, 5, v4
    v_and_b32 v1, 0xdff, v7
    s_cmp_eq_u32 s16, 2
    s_cbranch_scc1 mk_isv
    v_mov_b32 v5, v3
    v_or_b32 v1, 128, v7
mk_isv:
    v_lshl_add_u32 v1, v5, 17, v1
    s_mov_b32 s28, 0
    s_mov_b32 s19, 2
    s_mov_b32 s24, 138412032
    s_lshl_b32 s26, s17, 12
    s_mov_b32 s21, 69206016
    s_cmp_eq_u32 s16, 2
    s_cselect_b32 s21, 77594624, s21
    s_add_u32 s26, s26, s21
    s_lshl_b32 s29, s17, 7
    s_lshl_b32 s21, s16, 2
    s_add_u32 s29, s29, s21
    s_add_u32 s29, s29, 125829164
mk_loop:
    s_cmp_lg_u32 s18, 0
    s_cbranch_scc1 mk_go
    s_cmp_le_u32 s19, s28
    s_cbranch_scc1 mk_go
    s_mov_b32 s23, 125853696
    s_mov_b32 s21, 4194304
mk_wait:
    buffer_load_dword v4, off, s[4:7], s23 sc1
    s_sub_u32 s21, s21, 1
    s_cbranch_scc1 mk_go
    s_waitcnt vmcnt(0)
    v_readfirstlane_b32 s28, v4
    s_nop 0
    s_sub_u32 s28, s28, s95
    s_cmp_gt_u32 s28, 64
    s_cselect_b32 s28, 0, s28
    s_cmp_le_u32 s19, s28
    s_cbranch_scc1 mk_go
    s_sleep 4
    s_branch mk_wait
mk_go:
    s_barrier
    s_add_u32 s21, s24, 4096
    s_add_u32 s23, s24, 8192
    buffer_load_dwordx4 v[24:27], v2, s[4:7], s24 offen offset:0 sc1
    buffer_load_dwordx4 v[28:31], v2, s[4:7], s24 offen offset:512 sc1
    buffer_load_dwordx4 v[32:35], v2, s[4:7], s21 offen offset:0 sc1
    buffer_load_dwordx4 v[36:39], v2, s[4:7], s21 offen offset:512 sc1
    buffer_load_dwordx4 v[40:43], v2, s[4:7], s24 offen offset:1024 sc1
    buffer_load_dwordx4 v[44:47], v2, s[4:7], s24 offen offset:1536 sc1
    buffer_load_dwordx4 v[48:51], v2, s[4:7], s21 offen offset:1024 sc1
    buffer_load_dwordx4 v[52:55], v2, s[4:7], s21 offen offset:1536 sc1
    buffer_load_dwordx4 v[56:59], v2, s[4:7], s24 offen offset:2048 sc1
    buffer_load_dwordx4 v[60:63], v2, s[4:7], s24 offen offset:2560 sc1
    buffer_load_dwordx4 v[208:211], v2, s[4:7], s21 offen offset:2048 sc1
    buffer_load_dwordx4 v[212:215], v2, s[4:7], s21 offen offset:2560 sc1
    buffer_load_dwordx4 v[216:219], v2, s[4:7], s24 offen offset:3072 sc1
    buffer_load_dwordx4 v[220:223], v2, s[4:7], s24 offen offset:3584 sc1
    buffer_load_dwordx4 v[224:227], v2, s[4:7], s21 offen offset:3072 sc1
    buffer_load_dwordx4 v[228:231], v2, s[4:7], s21 offen offset:3584 sc1
    buffer_load_dwordx4 v[232:235], v2, s[4:7], s23 offen offset:0 sc1
    buffer_load_dwordx4 v[236:239], v2, s[4:7], s23 offen offset:512 sc1
    s_add_u32 s24, s24, 18432
    s_cmp_eq_u32 s16, 2
    s_cbranch_scc1 mk_v
    s_waitcnt vmcnt(17)
    s_waitcnt vmcnt(16)
    v_mfma_f32_16x16x32_bf16 v[8:11], v[64:67], v[24:27], 0
    v_mfma_f32_16x16x32_bf16 v[12:15], v[136:139], v[24:27], 0
    v_mfma_f32_16x16x32_bf16 v[16:19], a[0:3], v[24:27], 0
    v_mfma_f32_16x16x32_bf16 v[20:23], a[72:75], v[24:27], 0
    s_waitcnt vmcnt(15)
    v_mfma_f32_16x16x32_bf16 v[8:11], v[68:71], v[28:31], v[8:11]
    v_mfma_f32_16x16x32_bf16 v[12:15], v[140:143], v[28:31], v[12:15]
    v_mfma_f32_16x16x32_bf16 v[16:19], a[4:7], v[28:31], v[16:19]
    v_mfma_f32_16x16x32_bf16 v[20:23], a[76:79], v[28:31], v[20:23]
    s_waitcnt vmcnt(14)
    v_mfma_f32_16x16x32_bf16 v[8:11], v[72:75], v[32:35], v[8:11]
    v_mfma_f32_16x16x32_bf16 v[12:15], v[144:147], v[32:35], v[12:15]
    v_mfma_f32_16x16x32_bf16 v[16:19], a[8:11], v[32:35], v[16:19]
    v_mfma_f32_16x16x32_bf16 v[20:23], a[80:83], v[32:35], v[20:23]
    s_waitcnt vmcnt(13)
    v_mfma_f32_16x16x32_bf16 v[8:11], v[76:79], v[36:39], v[8:11]
    v_mfma_f32_16x16x32_bf16 v[12:15], v[148:151], v[36:39], v[12:15]
    v_mfma_f32_16x16x32_bf16 v[16:19], a[12:15], v[36:39], v[16:19]
    v_mfma_f32_16x16x32_bf16 v[20:23], a[84:87], v[36:39], v[20:23]
    s_waitcnt vmcnt(12)
    v_mfma_f32_16x16x32_bf16 v[8:11], v[80:83], v[40:43], v[8:11]
    v_mfma_f32_16x16x32_bf16 v[12:15], v[152:155], v[40:43], v[12:15]
    v_mfma_f32_16x16x32_bf16 v[16:19], a[16:19], v[40:43], v[16:19]
    v_mfma_f32_16x16x32_bf16 v[20:23], a[88:91], v[40:43], v[20:23]
    s_waitcnt vmcnt(11)
    v_mfma_f32_16x16x32_bf16 v[8:11], v[84:87], v[44:47], v[8:11]
    v_mfma_f32_16x16x32_bf16 v[12:15], v[156:159], v[44:47], v[12:15]
    v_mfma_f32_16x16x32_bf16 v[16:19], a[20:23], v[44:47], v[16:19]
    v_mfma_f32_16x16x32_bf16 v[20:23], a[92:95], v[44:47], v[20:23]
    s_waitcnt vmcnt(10)
    v_mfma_f32_16x16x32_bf16 v[8:11], v[88:91], v[48:51], v[8:11]
    v_mfma_f32_16x16x32_bf16 v[12:15], v[160:163], v[48:51], v[12:15]
    v_mfma_f32_16x16x32_bf16 v[16:19], a[24:27], v[48:51], v[16:19]
    v_mfma_f32_16x16x32_bf16 v[20:23], a[96:99], v[48:51], v[20:23]
    s_waitcnt vmcnt(9)
    v_mfma_f32_16x16x32_bf16 v[8:11], v[92:95], v[52:55], v[8:11]
    v_mfma_f32_16x16x32_bf16 v[12:15], v[164:167], v[52:55], v[12:15]
    v_mfma_f32_16x16x32_bf16 v[16:19], a[28:31], v[52:55], v[16:19]
    v_mfma_f32_16x16x32_bf16 v[20:23], a[100:103], v[52:55], v[20:23]
    s_waitcnt vmcnt(8)
    v_mfma_f32_16x16x32_bf16 v[8:11], v[96:99], v[56:59], v[8:11]
    v_mfma_f32_16x16x32_bf16 v[12:15], v[168:171], v[56:59], v[12:15]
    v_mfma_f32_16x16x32_bf16 v[16:19], a[32:35], v[56:59], v[16:19]
    v_mfma_f32_16x16x32_bf16 v[20:23], a[104:107], v[56:59], v[20:23]
    s_waitcnt vmcnt(7)
    v_mfma_f32_16x16x32_bf16 v[8:11], v[100:103], v[60:63], v[8:11]
    v_mfma_f32_16x16x32_bf16 v[12:15], v[172:175], v[60:63], v[12:15]
    v_mfma_f32_16x16x32_bf16 v[16:19], a[36:39], v[60:63], v[16:19]
    v_mfma_f32_16x16x32_bf16 v[20:23], a[108:111], v[60:63], v[20:23]
    s_waitcnt vmcnt(6)
    v_mfma_f32_16x16x32_bf16 v[8:11], v[104:107], v[208:211], v[8:11]
    v_mfma_f32_16x16x32_bf16 v[12:15], v[176:179], v[208:211], v[12:15]
    v_mfma_f32_16x16x32_bf16 v[16:19], a[40:43], v[208:211], v[16:19]
    v_mfma_f32_16x16x32_bf16 v[20:23], a[112:115], v[208:211], v[20:23]
    s_waitcnt vmcnt(5)
    v_mfma_f32_16x16x32_bf16 v[8:11], v[108:111], v[212:215], v[8:11]
    v_mfma_f32_16x16x32_bf16 v[12:15], v[180:183], v[212:215], v[12:15]
    v_mfma_f32_16x16x32_bf16 v[16:19], a[44:47], v[212:215], v[16:19]
    v_mfma_f32_16x16x32_bf16 v[20:23], a[116:119], v[212:215], v[20:23]
    s_waitcnt vmcnt(4)
    v_mfma_f32_16x16x32_bf16 v[8:11], v[112:115], v[216:219], v[8:11]
    v_mfma_f32_16x16x32_bf16 v[12:15], v[184:187], v[216:219], v[12:15]
    v_mfma_f32_16x16x32_bf16 v[16:19], a[48:51], v[216:219], v[16:19]
    v_mfma_f32_16x16x32_bf16 v[20:23], a[120:123], v[216:219], v[20:23]
    s_waitcnt vmcnt(3)
    v_mfma_f32_16x16x32_bf16 v[8:11], v[116:119], v[220:223], v[8:11]
    v_mfma_f32_16x16x32_bf16 v[12:15], v[188:191], v[220:223], v[12:15]
    v_mfma_f32_16x16x32_bf16 v[16:19], a[52:55], v[220:223], v[16:19]
    v_mfma_f32_16x16x32_bf16 v[20:23], a[124:127], v[220:223], v[20:23]
    s_waitcnt vmcnt(2)
    v_mfma_f32_16x16x32_bf16 v[8:11], v[120:123], v[224:227], v[8:11]
    v_mfma_f32_16x16x32_bf16 v[12:15], v[192:195], v[224:227], v[12:15]
    v_mfma_f32_16x16x32_bf16 v[16:19], a[56:59], v[224:227], v[16:19]
    v_mfma_f32_16x16x32_bf16 v[20:23], a[128:131], v[224:227], v[20:23]
    s_waitcnt vmcnt(1)
    v_mfma_f32_16x16x32_bf16 v[8:11], v[124:127], v[228:231], v[8:11]
    v_mfma_f32_16x16x32_bf16 v[12:15], v[196:199], v[228:231], v[12:15]
    v_mfma_f32_16x16x32_bf16 v[16:19], a[60:63], v[228:231], v[16:19]
    v_mfma_f32_16x16x32_bf16 v[20:23], a[132:135], v[228:231], v[20:23]
    s_waitcnt vmcnt(0)
    v_mfma_f32_16x16x32_bf16 v[8:11], v[128:131], v[232:235], v[8:11]
    v_mfma_f32_16x16x32_bf16 v[12:15], v[200:203], v[232:235], v[12:15]
    v_mfma_f32_16x16x32_bf16 v[16:19], a[64:67], v[232:235], v[16:19]
    v_mfma_f32_16x16x32_bf16 v[20:23], a[136:139], v[232:235], v[20:23]
    v_mfma_f32_16x16x32_bf16 v[8:11], v[132:135], v[236:239], v[8:11]
    v_mfma_f32_16x16x32_bf16 v[12:15], v[204:207], v[236:239], v[12:15]
    v_mfma_f32_16x16x32_bf16 v[16:19], a[68:71], v[236:239], v[16:19]
    v_mfma_f32_16x16x32_bf16 v[20:23], a[140:143], v[236:239], v[20:23]
    s_nop 7
    s_branch mk_st
mk_v:
    s_waitcnt vmcnt(17)
    s_waitcnt vmcnt(16)
    v_mfma_f32_16x16x32_bf16 v[8:11], v[24:27], v[64:67], 0
    v_mfma_f32_16x16x32_bf16 v[12:15], v[24:27], v[136:139], 0
    v_mfma_f32_16x16x32_bf16 v[16:19], v[24:27], a[0:3], 0
    v_mfma_f32_16x16x32_bf16 v[20:23], v[24:27], a[72:75], 0
    s_waitcnt vmcnt(15)
    v_mfma_f32_16x16x32_bf16 v[8:11], v[28:31], v[68:71], v[8:11]
    v_mfma_f32_16x16x32_bf16 v[12:15], v[28:31], v[140:143], v[12:15]
    v_mfma_f32_16x16x32_bf16 v[16:19], v[28:31], a[4:7], v[16:19]
    v_mfma_f32_16x16x32_bf16 v[20:23], v[28:31], a[76:79], v[20:23]
    s_waitcnt vmcnt(14)
    v_mfma_f32_16x16x32_bf16 v[8:11], v[32:35], v[72:75], v[8:11]
    v_mfma_f32_16x16x32_bf16 v[12:15], v[32:35], v[144:147], v[12:15]
    v_mfma_f32_16x16x32_bf16 v[16:19], v[32:35], a[8:11], v[16:19]
    v_mfma_f32_16x16x32_bf16 v[20:23], v[32:35], a[80:83], v[20:23]
    s_waitcnt vmcnt(13)
    v_mfma_f32_16x16x32_bf16 v[8:11], v[36:39], v[76:79], v[8:11]
    v_mfma_f32_16x16x32_bf16 v[12:15], v[36:39], v[148:151], v[12:15]
    v_mfma_f32_16x16x32_bf16 v[16:19], v[36:39], a[12:15], v[16:19]
    v_mfma_f32_16x16x32_bf16 v[20:23], v[36:39], a[84:87], v[20:23]
    s_waitcnt vmcnt(12)
    v_mfma_f32_16x16x32_bf16 v[8:11], v[40:43], v[80:83], v[8:11]
    v_mfma_f32_16x16x32_bf16 v[12:15], v[40:43], v[152:155], v[12:15]
    v_mfma_f32_16x16x32_bf16 v[16:19], v[40:43], a[16:19], v[16:19]
    v_mfma_f32_16x16x32_bf16 v[20:23], v[40:43], a[88:91], v[20:23]
    s_waitcnt vmcnt(11)
    v_mfma_f32_16x16x32_bf16 v[8:11], v[44:47], v[84:87], v[8:11]
    v_mfma_f32_16x16x32_bf16 v[12:15], v[44:47], v[156:159], v[12:15]
    v_mfma_f32_16x16x32_bf16 v[16:19], v[44:47], a[20:23], v[16:19]
    v_mfma_f32_16x16x32_bf16 v[20:23], v[44:47], a[92:95], v[20:23]
    s_waitcnt vmcnt(10)
    v_mfma_f32_16x16x32_bf16 v[8:11], v[48:51], v[88:91], v[8:11]
    v_mfma_f32_16x16x32_bf16 v[12:15], v[48:51], v[160:163], v[12:15]
    v_mfma_f32_16x16x32_bf16 v[16:19], v[48:51], a[24:27], v[16:19]
    v_mfma_f32_16x16x32_bf16 v[20:23], v[48:51], a[96:99], v[20:23]
    s_waitcnt vmcnt(9)
    v_mfma_f32_16x16x32_bf16 v[8:11], v[52:55], v[92:95], v[8:11]
    v_mfma_f32_16x16x32_bf16 v[12:15], v[52:55], v[164:167], v[12:15]
    v_mfma_f32_16x16x32_bf16 v[16:19], v[52:55], a[28:31], v[16:19]
    v_mfma_f32_16x16x32_bf16 v[20:23], v[52:55], a[100:103], v[20:23]
    s_waitcnt vmcnt(8)
    v_mfma_f32_16x16x32_bf16 v[8:11], v[56:59], v[96:99], v[8:11]
    v_mfma_f32_16x16x32_bf16 v[12:15], v[56:59], v[168:171], v[12:15]
    v_mfma_f32_16x16x32_bf16 v[16:19], v[56:59], a[32:35], v[16:19]
    v_mfma_f32_16x16x32_bf16 v[20:23], v[56:59], a[104:107], v[20:23]
    s_waitcnt vmcnt(7)
    v_mfma_f32_16x16x32_bf16 v[8:11], v[60:63], v[100:103], v[8:11]
    v_mfma_f32_16x16x32_bf16 v[12:15], v[60:63], v[172:175], v[12:15]
    v_mfma_f32_16x16x32_bf16 v[16:19], v[60:63], a[36:39], v[16:19]
    v_mfma_f32_16x16x32_bf16 v[20:23], v[60:63], a[108:111], v[20:23]
    s_waitcnt vmcnt(6)
    v_mfma_f32_16x16x32_bf16 v[8:11], v[208:211], v[104:107], v[8:11]
    v_mfma_f32_16x16x32_bf16 v[12:15], v[208:211], v[176:179], v[12:15]
    v_mfma_f32_16x16x32_bf16 v[16:19], v[208:211], a[40:43], v[16:19]
    v_mfma_f32_16x16x32_bf16 v[20:23], v[208:211], a[112:115], v[20:23]
    s_waitcnt vmcnt(5)
    v_mfma_f32_16x16x32_bf16 v[8:11], v[212:215], v[108:111], v[8:11]
    v_mfma_f32_16x16x32_bf16 v[12:15], v[212:215], v[180:183], v[12:15]
    v_mfma_f32_16x16x32_bf16 v[16:19], v[212:215], a[44:47], v[16:19]
    v_mfma_f32_16x16x32_bf16 v[20:23], v[212:215], a[116:119], v[20:23]
    s_waitcnt vmcnt(4)
    v_mfma_f32_16x16x32_bf16 v[8:11], v[216:219], v[112:115], v[8:11]
    v_mfma_f32_16x16x32_bf16 v[12:15], v[216:219], v[184:187], v[12:15]
    v_mfma_f32_16x16x32_bf16 v[16:19], v[216:219], a[48:51], v[16:19]
    v_mfma_f32_16x16x32_bf16 v[20:23], v[216:219], a[120:123], v[20:23]
    s_waitcnt vmcnt(3)
    v_mfma_f32_16x16x32_bf16 v[8:11], v[220:223], v[116:119], v[8:11]
    v_mfma_f32_16x16x32_bf16 v[12:15], v[220:223], v[188:191], v[12:15]
    v_mfma_f32_16x16x32_bf16 v[16:19], v[220:223], a[52:55], v[16:19]
    v_mfma_f32_16x16x32_bf16 v[20:23], v[220:223], a[124:127], v[20:23]
    s_waitcnt vmcnt(2)
    v_mfma_f32_16x16x32_bf16 v[8:11], v[224:227], v[120:123], v[8:11]
    v_mfma_f32_16x16x32_bf16 v[12:15], v[224:227], v[192:195], v[12:15]
    v_mfma_f32_16x16x32_bf16 v[16:19], v[224:227], a[56:59], v[16:19]
    v_mfma_f32_16x16x32_bf16 v[20:23], v[224:227], a[128:131], v[20:23]
    s_waitcnt vmcnt(1)
    v_mfma_f32_16x16x32_bf16 v[8:11], v[228:231], v[124:127], v[8:11]
    v_mfma_f32_16x16x32_bf16 v[12:15], v[228:231], v[196:199], v[12:15]
    v_mfma_f32_16x16x32_bf16 v[16:19], v[228:231], a[60:63], v[16:19]
    v_mfma_f32_16x16x32_bf16 v[20:23], v[228:231], a[132:135], v[20:23]
    s_waitcnt vmcnt(0)
    v_mfma_f32_16x16x32_bf16 v[8:11], v[232:235], v[128:131], v[8:11]
    v_mfma_f32_16x16x32_bf16 v[12:15], v[232:235], v[200:203], v[12:15]
    v_mfma_f32_16x16x32_bf16 v[16:19], v[232:235], a[64:67], v[16:19]
    v_mfma_f32_16x16x32_bf16 v[20:23], v[232:235], a[136:139], v[20:23]
    v_mfma_f32_16x16x32_bf16 v[8:11], v[236:239], v[132:135], v[8:11]
    v_mfma_f32_16x16x32_bf16 v[12:15], v[236:239], v[204:207], v[12:15]
    v_mfma_f32_16x16x32_bf16 v[16:19], v[236:239], a[68:71], v[16:19]
    v_mfma_f32_16x16x32_bf16 v[20:23], v[236:239], a[140:143], v[20:23]
    s_nop 4
    v_pk_mul_f32 v[8:9], v[8:9], 0.5 op_sel_hi:[1,0]
    v_pk_mul_f32 v[10:11], v[10:11], 0.5 op_sel_hi:[1,0]
    v_pk_mul_f32 v[12:13], v[12:13], 0.5 op_sel_hi:[1,0]
    v_pk_mul_f32 v[14:15], v[14:15], 0.5 op_sel_hi:[1,0]
    v_pk_mul_f32 v[16:17], v[16:17], 0.5 op_sel_hi:[1,0]
    v_pk_mul_f32 v[18:19], v[18:19], 0.5 op_sel_hi:[1,0]
    v_pk_mul_f32 v[20:21], v[20:21], 0.5 op_sel_hi:[1,0]
    v_pk_mul_f32 v[22:23], v[22:23], 0.5 op_sel_hi:[1,0]
mk_st:
    s_nop 1
    v_cvt_pk_bf16_f32 v24, v8, v9
    v_cvt_pk_bf16_f32 v25, v10, v11
    v_cvt_pk_bf16_f32 v26, v12, v13
    v_cvt_pk_bf16_f32 v27, v14, v15
    v_cvt_pk_bf16_f32 v28, v16, v17
    v_cvt_pk_bf16_f32 v29, v18, v19
    v_cvt_pk_bf16_f32 v30, v20, v21
    v_cvt_pk_bf16_f32 v31, v22, v23
    s_add_u32 s21, s26, 4096
    buffer_store_dwordx4 v[24:27], v1, s[4:7], s26 offen sc1
    buffer_store_dwordx4 v[28:31], v1, s[4:7], s21 offen sc1
    s_add_u32 s22, s19, s95
    s_waitcnt vmcnt(0)
    s_barrier
    v_mov_b32 v4, s22
    s_mov_b64 exec, s[34:35]
    buffer_store_dword v4, off, s[4:7], s29 sc1
    buffer_store_dword v4, off, s[4:7], s29 offset:128 sc1
    s_mov_b64 exec, -1
    s_add_u32 s19, s19, 2
    s_add_u32 s26, s26, 262144
    s_cmp_le_u32 s19, 56
    s_cbranch_scc1 mk_loop
    s_mov_b32 s45, 0
    s_cmp_lg_u32 s93, 1000
    s_cbranch_scc1 L_wf_next
    s_mov_b32 s45, 2
    s_mov_b32 s8, s76
    s_mov_b32 s9, s77
    s_mov_b32 s10, 4718592
    s_mov_b32 s11, 0x20000
    s_branch L_att_next
L_ssm_next:
    s_sub_u32 s93, s93, 1
    s_cbranch_scc1 L_exit
    s_mov_b32 s37, 8
    v_mov_b32 v250, 1
    v_mov_b32 v251, 163832
    v_cmp_eq_u32 vcc, 0, v0
    s_nop 0
    s_and_saveexec_b64 s[38:39], vcc
    s_cbranch_execz tk12
    buffer_atomic_add v250, off, s[84:87], s37 sc0
    s_waitcnt vmcnt(0)
    ds_write_b32 v251, v250
    s_waitcnt lgkmcnt(0)
tk12:
    s_mov_b64 exec, -1
    s_barrier
    ds_read_b32 v252, v251
    s_waitcnt lgkmcnt(0)
    v_readfirstlane_b32 s20, v252
    s_barrier
    s_nop 3
    s_cmp_ge_u32 s20, 72
    s_cbranch_scc1 L_ssm_done
    s_lshl_b32 s20, s20, 3
    v_lshrrev_b32 v5, 6, v0
    s_nop 0
    v_readfirstlane_b32 s21, v5
    v_and_b32 v1, 63, v0
    v_and_b32 v2, 15, v1
    v_lshrrev_b32 v3, 4, v1
    v_lshlrev_b32 v4, 14, v5
    s_mov_b32 s8, s62
    s_mov_b32 s9, s63
    s_mov_b32 s10, 2359296
    s_mov_b32 s11, 0x20000
    s_mov_b32 s16, s76
    s_mov_b32 s17, s77
    s_mov_b32 s18, 4718592
    s_mov_b32 s19, 0x20000
    s_add_u32 s22, s20, s21
    s_lshl_b32 s23, s22, 8
    v_lshlrev_b32 v6, 3, v2
    v_lshl_add_u32 v6, v3, 1, v6
    s_mov_b32 s12, s64
    s_mov_b32 s13, s65
    s_mov_b32 s14, 147456
    s_mov_b32 s15, 0x20000
    buffer_load_ushort v8, v6, s[12:15], s23 offen offset:0
    buffer_load_ushort v12, v6, s[12:15], s23 offen offset:128
    buffer_load_ushort v16, v6, s[12:15], s23 offen offset:1024
    buffer_load_ushort v20, v6, s[12:15], s23 offen offset:1152
    s_mov_b32 s12, s66
    s_mov_b32 s13, s67
    s_mov_b32 s14, 147456
    s_mov_b32 s15, 0x20000
    buffer_load_ushort v9, v6, s[12:15], s23 offen offset:0
    buffer_load_ushort v13, v6, s[12:15], s23 offen offset:128
    buffer_load_ushort v17, v6, s[12:15], s23 offen offset:1024
    buffer_load_ushort v21, v6, s[12:15], s23 offen offset:1152
    s_mov_b32 s12, s68
    s_mov_b32 s13, s69
    s_mov_b32 s14, 147456
    s_mov_b32 s15, 0x20000
    buffer_load_ushort v10, v6, s[12:15], s23 offen offset:0
    buffer_load_ushort v14, v6, s[12:15], s23 offen offset:128
    buffer_load_ushort v18, v6, s[12:15], s23 offen offset:1024
    buffer_load_ushort v22, v6, s[12:15], s23 offen offset:1152
    s_mov_b32 s12, s70
    s_mov_b32 s13, s71
    s_mov_b32 s14, 147456
    s_mov_b32 s15, 0x20000
    buffer_load_ushort v11, v6, s[12:15], s23 offen offset:0
    buffer_load_ushort v15, v6, s[12:15], s23 offen offset:128
    buffer_load_ushort v19, v6, s[12:15], s23 offen offset:1024
    buffer_load_ushort v23, v6, s[12:15], s23 offen offset:1152
    s_mov_b32 s12, s72
    s_mov_b32 s13, s73
    s_mov_b32 s14, 1152
    s_mov_b32 s15, 0x20000
    s_lshl_b32 s23, s22, 1
    buffer_load_ushort v24, off, s[12:15], s23
    buffer_load_ushort v25, off, s[12:15], s23 offset:8
    v_mul_u32_u24 v5, 9216, v0
    s_lshl_b32 s22, s20, 1
    s_add_u32 s23, s22, 0
    buffer_load_dwordx4 v[208:211], v5, s[8:11], s23 offen
    s_add_u32 s23, s22, 1152
    buffer_load_dwordx4 v[212:215], v5, s[8:11], s23 offen
    s_add_u32 s23, s22, 2304
    buffer_load_dwordx4 v[216:219], v5, s[8:11], s23 offen
    s_add_u32 s23, s22, 3456
    buffer_load_dwordx4 v[220:223], v5, s[8:11], s23 offen
    s_add_u32 s23, s22, 4608
    buffer_load_dwordx4 v[224:227], v5, s[8:11], s23 offen
    s_add_u32 s23, s22, 5760
    buffer_load_dwordx4 v[228:231], v5, s[8:11], s23 offen
    s_add_u32 s23, s22, 6912
    buffer_load_dwordx4 v[232:235], v5, s[8:11], s23 offen
    s_add_u32 s23, s22, 8064
    buffer_load_dwordx4 v[236:239], v5, s[8:11], s23 offen
    s_mov_b32 s26, 0x3fb8aa3b
    s_mov_b32 s27, 0x3e22f983
    s_mov_b32 s28, 0
    v_cvt_f32_u32 v26, v2
    v_mul_f32 v27, 0x41800000, v26
    s_waitcnt vmcnt(8)
    s_nop 0
ss_pass:
    v_mov_b32 v36, 0
    v_mov_b32 v37, 0
    v_lshl_add_u32 v6, v1, 3, v4
    ds_write_b64 v6, v[36:37] offset:0
    v_lshlrev_b32 v38, 16, v24
    v_mul_f32 v38, s26, v38
    v_exp_f32 v38, v38
    s_nop 0
    v_cvt_pk_bf16_f32 v38, v38, v38
    v_and_b32 v38, 0xffff0000, v38
    v_add_f32 v39, v38, v38
    v_lshlrev_b32 v28, 16, v8
    v_mul_f32 v28, s26, v28
    v_exp_f32 v28, v28
    s_nop 0
    v_cvt_pk_bf16_f32 v28, v28, v28
    v_and_b32 v28, 0xffff0000, v28
    v_mul_f32 v28, v28, v38
    v_mul_f32 v28, s26, v28
    v_sub_f32 v28, 0, v28
    v_lshlrev_b32 v29, 16, v9
    v_mul_f32 v29, v29, v38
    v_mul_f32 v29, s27, v29
    v_lshlrev_b32 v30, 16, v10
    v_mul_f32 v30, v30, v39
    v_lshlrev_b32 v31, 16, v11
    v_mul_f32 v31, v31, v39
    v_lshlrev_b32 v32, 16, v12
    v_mul_f32 v32, s26, v32
    v_exp_f32 v32, v32
    s_nop 0
    v_cvt_pk_bf16_f32 v32, v32, v32
    v_and_b32 v32, 0xffff0000, v32
    v_mul_f32 v32, v32, v38
    v_mul_f32 v32, s26, v32
    v_sub_f32 v32, 0, v32
    v_lshlrev_b32 v33, 16, v13
    v_mul_f32 v33, v33, v38
    v_mul_f32 v33, s27, v33
    v_lshlrev_b32 v34, 16, v14
    v_mul_f32 v34, v34, v39
    v_lshlrev_b32 v35, 16, v15
    v_mul_f32 v35, v35, v39
    v_mov_b64 v[48:49], 0
    v_mov_b64 v[50:51], 0
    v_mov_b64 v[52:53], 0
    v_mov_b64 v[54:55], 0
    v_mov_b64 v[56:57], 0
    v_mov_b64 v[58:59], 0
    v_mov_b64 v[60:61], 0
    v_mov_b64 v[62:63], 0
    s_mov_b32 s25, 0
    s_nop 0
ss_kg:
    v_mov_b64_dpp v[64:65], v[28:29] row_newbcast:0 row_mask:0xf bank_mask:0xf
    v_mov_b64_dpp v[66:67], v[30:31] row_newbcast:0 row_mask:0xf bank_mask:0xf
    v_pk_mul_f32 v[94:95], v[64:65], v[26:27] op_sel_hi:[1,0]
    v_pk_mul_f32 v[96:97], v[64:65], v[26:27] op_sel:[0,1] op_sel_hi:[1,1]
    v_fract_f32 v95, v95
    v_fract_f32 v97, v97
    v_exp_f32 v94, v94
    v_exp_f32 v96, v96
    v_cos_f32 v68, v95
    v_sin_f32 v69, v95
    v_cos_f32 v76, v97
    v_sin_f32 v77, v97
    v_pk_mul_f32 v[68:69], v[68:69], v[94:95] op_sel_hi:[1,0]
    v_pk_mul_f32 v[76:77], v[76:77], v[96:97] op_sel_hi:[1,0]
    v_pk_mul_f32 v[92:93], v[76:77], v[76:77] op_sel:[1,1] op_sel_hi:[0,1]
    v_pk_fma_f32 v[78:79], v[76:77], v[76:77], v[92:93] op_sel:[0,0,0] op_sel_hi:[0,1,1] neg_lo:[0,0,1]
    v_pk_mul_f32 v[94:95], v[68:69], v[68:69] op_sel:[1,1] op_sel_hi:[0,1]
    v_pk_fma_f32 v[70:71], v[68:69], v[68:69], v[94:95] op_sel:[0,0,0] op_sel_hi:[0,1,1] neg_lo:[0,0,1]
    v_pk_mul_f32 v[92:93], v[78:79], v[78:79] op_sel:[1,1] op_sel_hi:[0,1]
    v_pk_fma_f32 v[80:81], v[78:79], v[78:79], v[92:93] op_sel:[0,0,0] op_sel_hi:[0,1,1] neg_lo:[0,0,1]
    v_pk_mul_f32 v[94:95], v[70:71], v[70:71] op_sel:[1,1] op_sel_hi:[0,1]
    v_pk_fma_f32 v[72:73], v[70:71], v[70:71], v[94:95] op_sel:[0,0,0] op_sel_hi:[0,1,1] neg_lo:[0,0,1]
    v_pk_mul_f32 v[92:93], v[80:81], v[80:81] op_sel:[1,1] op_sel_hi:[0,1]
    v_pk_fma_f32 v[82:83], v[80:81], v[80:81], v[92:93] op_sel:[0,0,0] op_sel_hi:[0,1,1] neg_lo:[0,0,1]
    v_pk_mul_f32 v[94:95], v[72:73], v[72:73] op_sel:[1,1] op_sel_hi:[0,1]
    v_pk_fma_f32 v[74:75], v[72:73], v[72:73], v[94:95] op_sel:[0,0,0] op_sel_hi:[0,1,1] neg_lo:[0,0,1]
    v_pk_mul_f32 v[92:93], v[82:83], v[82:83] op_sel:[1,1] op_sel_hi:[0,1]
    v_pk_fma_f32 v[84:85], v[82:83], v[82:83], v[92:93] op_sel:[0,0,0] op_sel_hi:[0,1,1] neg_lo:[0,0,1]
    v_pk_mul_f32 v[94:95], v[66:67], v[76:77] op_sel:[1,1] op_sel_hi:[1,0]
    v_pk_fma_f32 v[86:87], v[66:67], v[76:77], v[94:95] op_sel:[0,0,0] op_sel_hi:[0,1,1] neg_lo:[0,0,1] neg_hi:[1,0,1]
    v_mov_b32_dpp v80, v78 row_ror:8 row_mask:0xf bank_mask:0x3
    v_mov_b32_dpp v81, v79 row_ror:8 row_mask:0xf bank_mask:0x3
    v_mov_b32_dpp v82, v84 row_ror:8 row_mask:0xf bank_mask:0x3
    v_mov_b32_dpp v83, v85 row_ror:8 row_mask:0xf bank_mask:0x3
    v_pk_mul_f32 v[92:93], v[66:67], v[80:81] op_sel:[1,1] op_sel_hi:[1,0]
    v_pk_fma_f32 v[88:89], v[66:67], v[80:81], v[92:93] op_sel:[0,0,0] op_sel_hi:[0,1,1] neg_lo:[0,0,1] neg_hi:[1,0,1]
    v_pk_mul_f32 v[94:95], v[66:67], v[82:83] op_sel:[1,1] op_sel_hi:[1,0]
    v_pk_fma_f32 v[90:91], v[66:67], v[82:83], v[94:95] op_sel:[0,0,0] op_sel_hi:[0,1,1] neg_lo:[0,0,1] neg_hi:[1,0,1]
    v_mfma_f32_16x16x4_f32 v[48:51], v86, v68, v[48:51]
    v_mfma_f32_16x16x4_f32 v[52:55], v88, v70, v[52:55]
    v_mfma_f32_16x16x4_f32 v[56:59], v88, v72, v[56:59]
    v_mfma_f32_16x16x4_f32 v[60:63], v90, v74, v[60:63]
    v_mfma_f32_16x16x4_f32 v[48:51], v87, v69, v[48:51]
    v_mfma_f32_16x16x4_f32 v[52:55], v89, v71, v[52:55]
    v_mfma_f32_16x16x4_f32 v[56:59], v89, v73, v[56:59]
    v_mfma_f32_16x16x4_f32 v[60:63], v91, v75, v[60:63]
    v_mov_b64_dpp v[64:65], v[28:29] row_newbcast:1 row_mask:0xf bank_mask:0xf
    v_mov_b64_dpp v[66:67], v[30:31] row_newbcast:1 row_mask:0xf bank_mask:0xf
    v_pk_mul_f32 v[94:95], v[64:65], v[26:27] op_sel_hi:[1,0]
    v_pk_mul_f32 v[96:97], v[64:65], v[26:27] op_sel:[0,1] op_sel_hi:[1,1]
    v_fract_f32 v95, v95
    v_fract_f32 v97, v97
    v_exp_f32 v94, v94
    v_exp_f32 v96, v96
    v_cos_f32 v68, v95
    v_sin_f32 v69, v95
    v_cos_f32 v76, v97
    v_sin_f32 v77, v97
    v_pk_mul_f32 v[68:69], v[68:69], v[94:95] op_sel_hi:[1,0]
    v_pk_mul_f32 v[76:77], v[76:77], v[96:97] op_sel_hi:[1,0]
    v_pk_mul_f32 v[92:93], v[76:77], v[76:77] op_sel:[1,1] op_sel_hi:[0,1]
    v_pk_fma_f32 v[78:79], v[76:77], v[76:77], v[92:93] op_sel:[0,0,0] op_sel_hi:[0,1,1] neg_lo:[0,0,1]
    v_pk_mul_f32 v[94:95], v[68:69], v[68:69] op_sel:[1,1] op_sel_hi:[0,1]
    v_pk_fma_f32 v[70:71], v[68:69], v[68:69], v[94:95] op_sel:[0,0,0] op_sel_hi:[0,1,1] neg_lo:[0,0,1]
    v_pk_mul_f32 v[92:93], v[78:79], v[78:79] op_sel:[1,1] op_sel_hi:[0,1]
    v_pk_fma_f32 v[80:81], v[78:79], v[78:79], v[92:93] op_sel:[0,0,0] op_sel_hi:[0,1,1] neg_lo:[0,0,1]
    v_pk_mul_f32 v[94:95], v[70:71], v[70:71] op_sel:[1,1] op_sel_hi:[0,1]
    v_pk_fma_f32 v[72:73], v[70:71], v[70:71], v[94:95] op_sel:[0,0,0] op_sel_hi:[0,1,1] neg_lo:[0,0,1]
    v_pk_mul_f32 v[92:93], v[80:81], v[80:81] op_sel:[1,1] op_sel_hi:[0,1]
    v_pk_fma_f32 v[82:83], v[80:81], v[80:81], v[92:93] op_sel:[0,0,0] op_sel_hi:[0,1,1] neg_lo:[0,0,1]
    v_pk_mul_f32 v[94:95], v[72:73], v[72:73] op_sel:[1,1] op_sel_hi:[0,1]
    v_pk_fma_f32 v[74:75], v[72:73], v[72:73], v[94:95] op_sel:[0,0,0] op_sel_hi:[0,1,1] neg_lo:[0,0,1]
    v_pk_mul_f32 v[92:93], v[82:83], v[82:83] op_sel:[1,1] op_sel_hi:[0,1]
    v_pk_fma_f32 v[84:85], v[82:83], v[82:83], v[92:93] op_sel:[0,0,0] op_sel_hi:[0,1,1] neg_lo:[0,0,1]
    v_pk_mul_f32 v[94:95], v[66:67], v[76:77] op_sel:[1,1] op_sel_hi:[1,0]
    v_pk_fma_f32 v[86:87], v[66:67], v[76:77], v[94:95] op_sel:[0,0,0] op_sel_hi:[0,1,1] neg_lo:[0,0,1] neg_hi:[1,0,1]
    v_mov_b32_dpp v80, v78 row_ror:8 row_mask:0xf bank_mask:0x3
    v_mov_b32_dpp v81, v79 row_ror:8 row_mask:0xf bank_mask:0x3
    v_mov_b32_dpp v82, v84 row_ror:8 row_mask:0xf bank_mask:0x3
    v_mov_b32_dpp v83, v85 row_ror:8 row_mask:0xf bank_mask:0x3
    v_pk_mul_f32 v[92:93], v[66:67], v[80:81] op_sel:[1,1] op_sel_hi:[1,0]
    v_pk_fma_f32 v[88:89], v[66:67], v[80:81], v[92:93] op_sel:[0,0,0] op_sel_hi:[0,1,1] neg_lo:[0,0,1] neg_hi:[1,0,1]
    v_pk_mul_f32 v[94:95], v[66:67], v[82:83] op_sel:[1,1] op_sel_hi:[1,0]
    v_pk_fma_f32 v[90:91], v[66:67], v[82:83], v[94:95] op_sel:[0,0,0] op_sel_hi:[0,1,1] neg_lo:[0,0,1] neg_hi:[1,0,1]
    v_mfma_f32_16x16x4_f32 v[48:51], v86, v68, v[48:51]
    v_mfma_f32_16x16x4_f32 v[52:55], v88, v70, v[52:55]
    v_mfma_f32_16x16x4_f32 v[56:59], v88, v72, v[56:59]
    v_mfma_f32_16x16x4_f32 v[60:63], v90, v74, v[60:63]
    v_mfma_f32_16x16x4_f32 v[48:51], v87, v69, v[48:51]
    v_mfma_f32_16x16x4_f32 v[52:55], v89, v71, v[52:55]
    v_mfma_f32_16x16x4_f32 v[56:59], v89, v73, v[56:59]
    v_mfma_f32_16x16x4_f32 v[60:63], v91, v75, v[60:63]
    v_mov_b64_dpp v[64:65], v[28:29] row_newbcast:2 row_mask:0xf bank_mask:0xf
    v_mov_b64_dpp v[66:67], v[30:31] row_newbcast:2 row_mask:0xf bank_mask:0xf
    v_pk_mul_f32 v[94:95], v[64:65], v[26:27] op_sel_hi:[1,0]
    v_pk_mul_f32 v[96:97], v[64:65], v[26:27] op_sel:[0,1] op_sel_hi:[1,1]
    v_fract_f32 v95, v95
    v_fract_f32 v97, v97
    v_exp_f32 v94, v94
    v_exp_f32 v96, v96
    v_cos_f32 v68, v95
    v_sin_f32 v69, v95
    v_cos_f32 v76, v97
    v_sin_f32 v77, v97
    v_pk_mul_f32 v[68:69], v[68:69], v[94:95] op_sel_hi:[1,0]
    v_pk_mul_f32 v[76:77], v[76:77], v[96:97] op_sel_hi:[1,0]
    v_pk_mul_f32 v[92:93], v[76:77], v[76:77] op_sel:[1,1] op_sel_hi:[0,1]
    v_pk_fma_f32 v[78:79], v[76:77], v[76:77], v[92:93] op_sel:[0,0,0] op_sel_hi:[0,1,1] neg_lo:[0,0,1]
    v_pk_mul_f32 v[94:95], v[68:69], v[68:69] op_sel:[1,1] op_sel_hi:[0,1]
    v_pk_fma_f32 v[70:71], v[68:69], v[68:69], v[94:95] op_sel:[0,0,0] op_sel_hi:[0,1,1] neg_lo:[0,0,1]
    v_pk_mul_f32 v[92:93], v[78:79], v[78:79] op_sel:[1,1] op_sel_hi:[0,1]
    v_pk_fma_f32 v[80:81], v[78:79], v[78:79], v[92:93] op_sel:[0,0,0] op_sel_hi:[0,1,1] neg_lo:[0,0,1]
    v_pk_mul_f32 v[94:95], v[70:71], v[70:71] op_sel:[1,1] op_sel_hi:[0,1]
    v_pk_fma_f32 v[72:73], v[70:71], v[70:71], v[94:95] op_sel:[0,0,0] op_sel_hi:[0,1,1] neg_lo:[0,0,1]
    v_pk_mul_f32 v[92:93], v[80:81], v[80:81] op_sel:[1,1] op_sel_hi:[0,1]
    v_pk_fma_f32 v[82:83], v[80:81], v[80:81], v[92:93] op_sel:[0,0,0] op_sel_hi:[0,1,1] neg_lo:[0,0,1]
    v_pk_mul_f32 v[94:95], v[72:73], v[72:73] op_sel:[1,1] op_sel_hi:[0,1]
    v_pk_fma_f32 v[74:75], v[72:73], v[72:73], v[94:95] op_sel:[0,0,0] op_sel_hi:[0,1,1] neg_lo:[0,0,1]
    v_pk_mul_f32 v[92:93], v[82:83], v[82:83] op_sel:[1,1] op_sel_hi:[0,1]
    v_pk_fma_f32 v[84:85], v[82:83], v[82:83], v[92:93] op_sel:[0,0,0] op_sel_hi:[0,1,1] neg_lo:[0,0,1]
    v_pk_mul_f32 v[94:95], v[66:67], v[76:77] op_sel:[1,1] op_sel_hi:[1,0]
    v_pk_fma_f32 v[86:87], v[66:67], v[76:77], v[94:95] op_sel:[0,0,0] op_sel_hi:[0,1,1] neg_lo:[0,0,1] neg_hi:[1,0,1]
    v_mov_b32_dpp v80, v78 row_ror:8 row_mask:0xf bank_mask:0x3
    v_mov_b32_dpp v81, v79 row_ror:8 row_mask:0xf bank_mask:0x3
    v_mov_b32_dpp v82, v84 row_ror:8 row_mask:0xf bank_mask:0x3
    v_mov_b32_dpp v83, v85 row_ror:8 row_mask:0xf bank_mask:0x3
    v_pk_mul_f32 v[92:93], v[66:67], v[80:81] op_sel:[1,1] op_sel_hi:[1,0]
    v_pk_fma_f32 v[88:89], v[66:67], v[80:81], v[92:93] op_sel:[0,0,0] op_sel_hi:[0,1,1] neg_lo:[0,0,1] neg_hi:[1,0,1]
    v_pk_mul_f32 v[94:95], v[66:67], v[82:83] op_sel:[1,1] op_sel_hi:[1,0]
    v_pk_fma_f32 v[90:91], v[66:67], v[82:83], v[94:95] op_sel:[0,0,0] op_sel_hi:[0,1,1] neg_lo:[0,0,1] neg_hi:[1,0,1]
    v_mfma_f32_16x16x4_f32 v[48:51], v86, v68, v[48:51]
    v_mfma_f32_16x16x4_f32 v[52:55], v88, v70, v[52:55]
    v_mfma_f32_16x16x4_f32 v[56:59], v88, v72, v[56:59]
    v_mfma_f32_16x16x4_f32 v[60:63], v90, v74, v[60:63]
    v_mfma_f32_16x16x4_f32 v[48:51], v87, v69, v[48:51]
    v_mfma_f32_16x16x4_f32 v[52:55], v89, v71, v[52:55]
    v_mfma_f32_16x16x4_f32 v[56:59], v89, v73, v[56:59]
    v_mfma_f32_16x16x4_f32 v[60:63], v91, v75, v[60:63]
    v_mov_b64_dpp v[64:65], v[28:29] row_newbcast:3 row_mask:0xf bank_mask:0xf
    v_mov_b64_dpp v[66:67], v[30:31] row_newbcast:3 row_mask:0xf bank_mask:0xf
    v_pk_mul_f32 v[94:95], v[64:65], v[26:27] op_sel_hi:[1,0]
    v_pk_mul_f32 v[96:97], v[64:65], v[26:27] op_sel:[0,1] op_sel_hi:[1,1]
    v_fract_f32 v95, v95
    v_fract_f32 v97, v97
    v_exp_f32 v94, v94
    v_exp_f32 v96, v96
    v_cos_f32 v68, v95
    v_sin_f32 v69, v95
    v_cos_f32 v76, v97
    v_sin_f32 v77, v97
    v_pk_mul_f32 v[68:69], v[68:69], v[94:95] op_sel_hi:[1,0]
    v_pk_mul_f32 v[76:77], v[76:77], v[96:97] op_sel_hi:[1,0]
    v_pk_mul_f32 v[92:93], v[76:77], v[76:77] op_sel:[1,1] op_sel_hi:[0,1]
    v_pk_fma_f32 v[78:79], v[76:77], v[76:77], v[92:93] op_sel:[0,0,0] op_sel_hi:[0,1,1] neg_lo:[0,0,1]
    v_pk_mul_f32 v[94:95], v[68:69], v[68:69] op_sel:[1,1] op_sel_hi:[0,1]
    v_pk_fma_f32 v[70:71], v[68:69], v[68:69], v[94:95] op_sel:[0,0,0] op_sel_hi:[0,1,1] neg_lo:[0,0,1]
    v_pk_mul_f32 v[92:93], v[78:79], v[78:79] op_sel:[1,1] op_sel_hi:[0,1]
    v_pk_fma_f32 v[80:81], v[78:79], v[78:79], v[92:93] op_sel:[0,0,0] op_sel_hi:[0,1,1] neg_lo:[0,0,1]
    v_pk_mul_f32 v[94:95], v[70:71], v[70:71] op_sel:[1,1] op_sel_hi:[0,1]
    v_pk_fma_f32 v[72:73], v[70:71], v[70:71], v[94:95] op_sel:[0,0,0] op_sel_hi:[0,1,1] neg_lo:[0,0,1]
    v_pk_mul_f32 v[92:93], v[80:81], v[80:81] op_sel:[1,1] op_sel_hi:[0,1]
    v_pk_fma_f32 v[82:83], v[80:81], v[80:81], v[92:93] op_sel:[0,0,0] op_sel_hi:[0,1,1] neg_lo:[0,0,1]
    v_pk_mul_f32 v[94:95], v[72:73], v[72:73] op_sel:[1,1] op_sel_hi:[0,1]
    v_pk_fma_f32 v[74:75], v[72:73], v[72:73], v[94:95] op_sel:[0,0,0] op_sel_hi:[0,1,1] neg_lo:[0,0,1]
    v_pk_mul_f32 v[92:93], v[82:83], v[82:83] op_sel:[1,1] op_sel_hi:[0,1]
    v_pk_fma_f32 v[84:85], v[82:83], v[82:83], v[92:93] op_sel:[0,0,0] op_sel_hi:[0,1,1] neg_lo:[0,0,1]
    v_pk_mul_f32 v[94:95], v[66:67], v[76:77] op_sel:[1,1] op_sel_hi:[1,0]
    v_pk_fma_f32 v[86:87], v[66:67], v[76:77], v[94:95] op_sel:[0,0,0] op_sel_hi:[0,1,1] neg_lo:[0,0,1] neg_hi:[1,0,1]
    v_mov_b32_dpp v80, v78 row_ror:8 row_mask:0xf bank_mask:0x3
    v_mov_b32_dpp v81, v79 row_ror:8 row_mask:0xf bank_mask:0x3
    v_mov_b32_dpp v82, v84 row_ror:8 row_mask:0xf bank_mask:0x3
    v_mov_b32_dpp v83, v85 row_ror:8 row_mask:0xf bank_mask:0x3
    v_pk_mul_f32 v[92:93], v[66:67], v[80:81] op_sel:[1,1] op_sel_hi:[1,0]
    v_pk_fma_f32 v[88:89], v[66:67], v[80:81], v[92:93] op_sel:[0,0,0] op_sel_hi:[0,1,1] neg_lo:[0,0,1] neg_hi:[1,0,1]
    v_pk_mul_f32 v[94:95], v[66:67], v[82:83] op_sel:[1,1] op_sel_hi:[1,0]
    v_pk_fma_f32 v[90:91], v[66:67], v[82:83], v[94:95] op_sel:[0,0,0] op_sel_hi:[0,1,1] neg_lo:[0,0,1] neg_hi:[1,0,1]
    v_mfma_f32_16x16x4_f32 v[48:51], v86, v68, v[48:51]
    v_mfma_f32_16x16x4_f32 v[52:55], v88, v70, v[52:55]
    v_mfma_f32_16x16x4_f32 v[56:59], v88, v72, v[56:59]
    v_mfma_f32_16x16x4_f32 v[60:63], v90, v74, v[60:63]
    v_mfma_f32_16x16x4_f32 v[48:51], v87, v69, v[48:51]
    v_mfma_f32_16x16x4_f32 v[52:55], v89, v71, v[52:55]
    v_mfma_f32_16x16x4_f32 v[56:59], v89, v73, v[56:59]
    v_mfma_f32_16x16x4_f32 v[60:63], v91, v75, v[60:63]
    v_mov_b64_dpp v[64:65], v[28:29] row_newbcast:4 row_mask:0xf bank_mask:0xf
    v_mov_b64_dpp v[66:67], v[30:31] row_newbcast:4 row_mask:0xf bank_mask:0xf
    v_pk_mul_f32 v[94:95], v[64:65], v[26:27] op_sel_hi:[1,0]
    v_pk_mul_f32 v[96:97], v[64:65], v[26:27] op_sel:[0,1] op_sel_hi:[1,1]
    v_fract_f32 v95, v95
    v_fract_f32 v97, v97
    v_exp_f32 v94, v94
    v_exp_f32 v96, v96
    v_cos_f32 v68, v95
    v_sin_f32 v69, v95
    v_cos_f32 v76, v97
    v_sin_f32 v77, v97
    v_pk_mul_f32 v[68:69], v[68:69], v[94:95] op_sel_hi:[1,0]
    v_pk_mul_f32 v[76:77], v[76:77], v[96:97] op_sel_hi:[1,0]
    v_pk_mul_f32 v[92:93], v[76:77], v[76:77] op_sel:[1,1] op_sel_hi:[0,1]
    v_pk_fma_f32 v[78:79], v[76:77], v[76:77], v[92:93] op_sel:[0,0,0] op_sel_hi:[0,1,1] neg_lo:[0,0,1]
    v_pk_mul_f32 v[94:95], v[68:69], v[68:69] op_sel:[1,1] op_sel_hi:[0,1]
    v_pk_fma_f32 v[70:71], v[68:69], v[68:69], v[94:95] op_sel:[0,0,0] op_sel_hi:[0,1,1] neg_lo:[0,0,1]
    v_pk_mul_f32 v[92:93], v[78:79], v[78:79] op_sel:[1,1] op_sel_hi:[0,1]
    v_pk_fma_f32 v[80:81], v[78:79], v[78:79], v[92:93] op_sel:[0,0,0] op_sel_hi:[0,1,1] neg_lo:[0,0,1]
    v_pk_mul_f32 v[94:95], v[70:71], v[70:71] op_sel:[1,1] op_sel_hi:[0,1]
    v_pk_fma_f32 v[72:73], v[70:71], v[70:71], v[94:95] op_sel:[0,0,0] op_sel_hi:[0,1,1] neg_lo:[0,0,1]
    v_pk_mul_f32 v[92:93], v[80:81], v[80:81] op_sel:[1,1] op_sel_hi:[0,1]
    v_pk_fma_f32 v[82:83], v[80:81], v[80:81], v[92:93] op_sel:[0,0,0] op_sel_hi:[0,1,1] neg_lo:[0,0,1]
    v_pk_mul_f32 v[94:95], v[72:73], v[72:73] op_sel:[1,1] op_sel_hi:[0,1]
    v_pk_fma_f32 v[74:75], v[72:73], v[72:73], v[94:95] op_sel:[0,0,0] op_sel_hi:[0,1,1] neg_lo:[0,0,1]
    v_pk_mul_f32 v[92:93], v[82:83], v[82:83] op_sel:[1,1] op_sel_hi:[0,1]
    v_pk_fma_f32 v[84:85], v[82:83], v[82:83], v[92:93] op_sel:[0,0,0] op_sel_hi:[0,1,1] neg_lo:[0,0,1]
    v_pk_mul_f32 v[94:95], v[66:67], v[76:77] op_sel:[1,1] op_sel_hi:[1,0]
    v_pk_fma_f32 v[86:87], v[66:67], v[76:77], v[94:95] op_sel:[0,0,0] op_sel_hi:[0,1,1] neg_lo:[0,0,1] neg_hi:[1,0,1]
    v_mov_b32_dpp v80, v78 row_ror:8 row_mask:0xf bank_mask:0x3
    v_mov_b32_dpp v81, v79 row_ror:8 row_mask:0xf bank_mask:0x3
    v_mov_b32_dpp v82, v84 row_ror:8 row_mask:0xf bank_mask:0x3
    v_mov_b32_dpp v83, v85 row_ror:8 row_mask:0xf bank_mask:0x3
    v_pk_mul_f32 v[92:93], v[66:67], v[80:81] op_sel:[1,1] op_sel_hi:[1,0]
    v_pk_fma_f32 v[88:89], v[66:67], v[80:81], v[92:93] op_sel:[0,0,0] op_sel_hi:[0,1,1] neg_lo:[0,0,1] neg_hi:[1,0,1]
    v_pk_mul_f32 v[94:95], v[66:67], v[82:83] op_sel:[1,1] op_sel_hi:[1,0]
    v_pk_fma_f32 v[90:91], v[66:67], v[82:83], v[94:95] op_sel:[0,0,0] op_sel_hi:[0,1,1] neg_lo:[0,0,1] neg_hi:[1,0,1]
    v_mfma_f32_16x16x4_f32 v[48:51], v86, v68, v[48:51]
    v_mfma_f32_16x16x4_f32 v[52:55], v88, v70, v[52:55]
    v_mfma_f32_16x16x4_f32 v[56:59], v88, v72, v[56:59]
    v_mfma_f32_16x16x4_f32 v[60:63], v90, v74, v[60:63]
    v_mfma_f32_16x16x4_f32 v[48:51], v87, v69, v[48:51]
    v_mfma_f32_16x16x4_f32 v[52:55], v89, v71, v[52:55]
    v_mfma_f32_16x16x4_f32 v[56:59], v89, v73, v[56:59]
    v_mfma_f32_16x16x4_f32 v[60:63], v91, v75, v[60:63]
    v_mov_b64_dpp v[64:65], v[28:29] row_newbcast:5 row_mask:0xf bank_mask:0xf
    v_mov_b64_dpp v[66:67], v[30:31] row_newbcast:5 row_mask:0xf bank_mask:0xf
    v_pk_mul_f32 v[94:95], v[64:65], v[26:27] op_sel_hi:[1,0]
    v_pk_mul_f32 v[96:97], v[64:65], v[26:27] op_sel:[0,1] op_sel_hi:[1,1]
    v_fract_f32 v95, v95
    v_fract_f32 v97, v97
    v_exp_f32 v94, v94
    v_exp_f32 v96, v96
    v_cos_f32 v68, v95
    v_sin_f32 v69, v95
    v_cos_f32 v76, v97
    v_sin_f32 v77, v97
    v_pk_mul_f32 v[68:69], v[68:69], v[94:95] op_sel_hi:[1,0]
    v_pk_mul_f32 v[76:77], v[76:77], v[96:97] op_sel_hi:[1,0]
    v_pk_mul_f32 v[92:93], v[76:77], v[76:77] op_sel:[1,1] op_sel_hi:[0,1]
    v_pk_fma_f32 v[78:79], v[76:77], v[76:77], v[92:93] op_sel:[0,0,0] op_sel_hi:[0,1,1] neg_lo:[0,0,1]
    v_pk_mul_f32 v[94:95], v[68:69], v[68:69] op_sel:[1,1] op_sel_hi:[0,1]
    v_pk_fma_f32 v[70:71], v[68:69], v[68:69], v[94:95] op_sel:[0,0,0] op_sel_hi:[0,1,1] neg_lo:[0,0,1]
    v_pk_mul_f32 v[92:93], v[78:79], v[78:79] op_sel:[1,1] op_sel_hi:[0,1]
    v_pk_fma_f32 v[80:81], v[78:79], v[78:79], v[92:93] op_sel:[0,0,0] op_sel_hi:[0,1,1] neg_lo:[0,0,1]
    v_pk_mul_f32 v[94:95], v[70:71], v[70:71] op_sel:[1,1] op_sel_hi:[0,1]
    v_pk_fma_f32 v[72:73], v[70:71], v[70:71], v[94:95] op_sel:[0,0,0] op_sel_hi:[0,1,1] neg_lo:[0,0,1]
    v_pk_mul_f32 v[92:93], v[80:81], v[80:81] op_sel:[1,1] op_sel_hi:[0,1]
    v_pk_fma_f32 v[82:83], v[80:81], v[80:81], v[92:93] op_sel:[0,0,0] op_sel_hi:[0,1,1] neg_lo:[0,0,1]
    v_pk_mul_f32 v[94:95], v[72:73], v[72:73] op_sel:[1,1] op_sel_hi:[0,1]
    v_pk_fma_f32 v[74:75], v[72:73], v[72:73], v[94:95] op_sel:[0,0,0] op_sel_hi:[0,1,1] neg_lo:[0,0,1]
    v_pk_mul_f32 v[92:93], v[82:83], v[82:83] op_sel:[1,1] op_sel_hi:[0,1]
    v_pk_fma_f32 v[84:85], v[82:83], v[82:83], v[92:93] op_sel:[0,0,0] op_sel_hi:[0,1,1] neg_lo:[0,0,1]
    v_pk_mul_f32 v[94:95], v[66:67], v[76:77] op_sel:[1,1] op_sel_hi:[1,0]
    v_pk_fma_f32 v[86:87], v[66:67], v[76:77], v[94:95] op_sel:[0,0,0] op_sel_hi:[0,1,1] neg_lo:[0,0,1] neg_hi:[1,0,1]
    v_mov_b32_dpp v80, v78 row_ror:8 row_mask:0xf bank_mask:0x3
    v_mov_b32_dpp v81, v79 row_ror:8 row_mask:0xf bank_mask:0x3
    v_mov_b32_dpp v82, v84 row_ror:8 row_mask:0xf bank_mask:0x3
    v_mov_b32_dpp v83, v85 row_ror:8 row_mask:0xf bank_mask:0x3
    v_pk_mul_f32 v[92:93], v[66:67], v[80:81] op_sel:[1,1] op_sel_hi:[1,0]
    v_pk_fma_f32 v[88:89], v[66:67], v[80:81], v[92:93] op_sel:[0,0,0] op_sel_hi:[0,1,1] neg_lo:[0,0,1] neg_hi:[1,0,1]
    v_pk_mul_f32 v[94:95], v[66:67], v[82:83] op_sel:[1,1] op_sel_hi:[1,0]
    v_pk_fma_f32 v[90:91], v[66:67], v[82:83], v[94:95] op_sel:[0,0,0] op_sel_hi:[0,1,1] neg_lo:[0,0,1] neg_hi:[1,0,1]
    v_mfma_f32_16x16x4_f32 v[48:51], v86, v68, v[48:51]
    v_mfma_f32_16x16x4_f32 v[52:55], v88, v70, v[52:55]
    v_mfma_f32_16x16x4_f32 v[56:59], v88, v72, v[56:59]
    v_mfma_f32_16x16x4_f32 v[60:63], v90, v74, v[60:63]
    v_mfma_f32_16x16x4_f32 v[48:51], v87, v69, v[48:51]
    v_mfma_f32_16x16x4_f32 v[52:55], v89, v71, v[52:55]
    v_mfma_f32_16x16x4_f32 v[56:59], v89, v73, v[56:59]
    v_mfma_f32_16x16x4_f32 v[60:63], v91, v75, v[60:63]
    v_mov_b64_dpp v[64:65], v[28:29] row_newbcast:6 row_mask:0xf bank_mask:0xf
    v_mov_b64_dpp v[66:67], v[30:31] row_newbcast:6 row_mask:0xf bank_mask:0xf
    v_pk_mul_f32 v[94:95], v[64:65], v[26:27] op_sel_hi:[1,0]
    v_pk_mul_f32 v[96:97], v[64:65], v[26:27] op_sel:[0,1] op_sel_hi:[1,1]
    v_fract_f32 v95, v95
    v_fract_f32 v97, v97
    v_exp_f32 v94, v94
    v_exp_f32 v96, v96
    v_cos_f32 v68, v95
    v_sin_f32 v69, v95
    v_cos_f32 v76, v97
    v_sin_f32 v77, v97
    v_pk_mul_f32 v[68:69], v[68:69], v[94:95] op_sel_hi:[1,0]
    v_pk_mul_f32 v[76:77], v[76:77], v[96:97] op_sel_hi:[1,0]
    v_pk_mul_f32 v[92:93], v[76:77], v[76:77] op_sel:[1,1] op_sel_hi:[0,1]
    v_pk_fma_f32 v[78:79], v[76:77], v[76:77], v[92:93] op_sel:[0,0,0] op_sel_hi:[0,1,1] neg_lo:[0,0,1]
    v_pk_mul_f32 v[94:95], v[68:69], v[68:69] op_sel:[1,1] op_sel_hi:[0,1]
    v_pk_fma_f32 v[70:71], v[68:69], v[68:69], v[94:95] op_sel:[0,0,0] op_sel_hi:[0,1,1] neg_lo:[0,0,1]
    v_pk_mul_f32 v[92:93], v[78:79], v[78:79] op_sel:[1,1] op_sel_hi:[0,1]
    v_pk_fma_f32 v[80:81], v[78:79], v[78:79], v[92:93] op_sel:[0,0,0] op_sel_hi:[0,1,1] neg_lo:[0,0,1]
    v_pk_mul_f32 v[94:95], v[70:71], v[70:71] op_sel:[1,1] op_sel_hi:[0,1]
    v_pk_fma_f32 v[72:73], v[70:71], v[70:71], v[94:95] op_sel:[0,0,0] op_sel_hi:[0,1,1] neg_lo:[0,0,1]
    v_pk_mul_f32 v[92:93], v[80:81], v[80:81] op_sel:[1,1] op_sel_hi:[0,1]
    v_pk_fma_f32 v[82:83], v[80:81], v[80:81], v[92:93] op_sel:[0,0,0] op_sel_hi:[0,1,1] neg_lo:[0,0,1]
    v_pk_mul_f32 v[94:95], v[72:73], v[72:73] op_sel:[1,1] op_sel_hi:[0,1]
    v_pk_fma_f32 v[74:75], v[72:73], v[72:73], v[94:95] op_sel:[0,0,0] op_sel_hi:[0,1,1] neg_lo:[0,0,1]
    v_pk_mul_f32 v[92:93], v[82:83], v[82:83] op_sel:[1,1] op_sel_hi:[0,1]
    v_pk_fma_f32 v[84:85], v[82:83], v[82:83], v[92:93] op_sel:[0,0,0] op_sel_hi:[0,1,1] neg_lo:[0,0,1]
    v_pk_mul_f32 v[94:95], v[66:67], v[76:77] op_sel:[1,1] op_sel_hi:[1,0]
    v_pk_fma_f32 v[86:87], v[66:67], v[76:77], v[94:95] op_sel:[0,0,0] op_sel_hi:[0,1,1] neg_lo:[0,0,1] neg_hi:[1,0,1]
    v_mov_b32_dpp v80, v78 row_ror:8 row_mask:0xf bank_mask:0x3
    v_mov_b32_dpp v81, v79 row_ror:8 row_mask:0xf bank_mask:0x3
    v_mov_b32_dpp v82, v84 row_ror:8 row_mask:0xf bank_mask:0x3
    v_mov_b32_dpp v83, v85 row_ror:8 row_mask:0xf bank_mask:0x3
    v_pk_mul_f32 v[92:93], v[66:67], v[80:81] op_sel:[1,1] op_sel_hi:[1,0]
    v_pk_fma_f32 v[88:89], v[66:67], v[80:81], v[92:93] op_sel:[0,0,0] op_sel_hi:[0,1,1] neg_lo:[0,0,1] neg_hi:[1,0,1]
    v_pk_mul_f32 v[94:95], v[66:67], v[82:83] op_sel:[1,1] op_sel_hi:[1,0]
    v_pk_fma_f32 v[90:91], v[66:67], v[82:83], v[94:95] op_sel:[0,0,0] op_sel_hi:[0,1,1] neg_lo:[0,0,1] neg_hi:[1,0,1]
    v_mfma_f32_16x16x4_f32 v[48:51], v86, v68, v[48:51]
    v_mfma_f32_16x16x4_f32 v[52:55], v88, v70, v[52:55]
    v_mfma_f32_16x16x4_f32 v[56:59], v88, v72, v[56:59]
    v_mfma_f32_16x16x4_f32 v[60:63], v90, v74, v[60:63]
    v_mfma_f32_16x16x4_f32 v[48:51], v87, v69, v[48:51]
    v_mfma_f32_16x16x4_f32 v[52:55], v89, v71, v[52:55]
    v_mfma_f32_16x16x4_f32 v[56:59], v89, v73, v[56:59]
    v_mfma_f32_16x16x4_f32 v[60:63], v91, v75, v[60:63]
    v_mov_b64_dpp v[64:65], v[28:29] row_newbcast:7 row_mask:0xf bank_mask:0xf
    v_mov_b64_dpp v[66:67], v[30:31] row_newbcast:7 row_mask:0xf bank_mask:0xf
    v_pk_mul_f32 v[94:95], v[64:65], v[26:27] op_sel_hi:[1,0]
    v_pk_mul_f32 v[96:97], v[64:65], v[26:27] op_sel:[0,1] op_sel_hi:[1,1]
    v_fract_f32 v95, v95
    v_fract_f32 v97, v97
    v_exp_f32 v94, v94
    v_exp_f32 v96, v96
    v_cos_f32 v68, v95
    v_sin_f32 v69, v95
    v_cos_f32 v76, v97
    v_sin_f32 v77, v97
    v_pk_mul_f32 v[68:69], v[68:69], v[94:95] op_sel_hi:[1,0]
    v_pk_mul_f32 v[76:77], v[76:77], v[96:97] op_sel_hi:[1,0]
    v_pk_mul_f32 v[92:93], v[76:77], v[76:77] op_sel:[1,1] op_sel_hi:[0,1]
    v_pk_fma_f32 v[78:79], v[76:77], v[76:77], v[92:93] op_sel:[0,0,0] op_sel_hi:[0,1,1] neg_lo:[0,0,1]
    v_pk_mul_f32 v[94:95], v[68:69], v[68:69] op_sel:[1,1] op_sel_hi:[0,1]
    v_pk_fma_f32 v[70:71], v[68:69], v[68:69], v[94:95] op_sel:[0,0,0] op_sel_hi:[0,1,1] neg_lo:[0,0,1]
    v_pk_mul_f32 v[92:93], v[78:79], v[78:79] op_sel:[1,1] op_sel_hi:[0,1]
    v_pk_fma_f32 v[80:81], v[78:79], v[78:79], v[92:93] op_sel:[0,0,0] op_sel_hi:[0,1,1] neg_lo:[0,0,1]
    v_pk_mul_f32 v[94:95], v[70:71], v[70:71] op_sel:[1,1] op_sel_hi:[0,1]
    v_pk_fma_f32 v[72:73], v[70:71], v[70:71], v[94:95] op_sel:[0,0,0] op_sel_hi:[0,1,1] neg_lo:[0,0,1]
    v_pk_mul_f32 v[92:93], v[80:81], v[80:81] op_sel:[1,1] op_sel_hi:[0,1]
    v_pk_fma_f32 v[82:83], v[80:81], v[80:81], v[92:93] op_sel:[0,0,0] op_sel_hi:[0,1,1] neg_lo:[0,0,1]
    v_pk_mul_f32 v[94:95], v[72:73], v[72:73] op_sel:[1,1] op_sel_hi:[0,1]
    v_pk_fma_f32 v[74:75], v[72:73], v[72:73], v[94:95] op_sel:[0,0,0] op_sel_hi:[0,1,1] neg_lo:[0,0,1]
    v_pk_mul_f32 v[92:93], v[82:83], v[82:83] op_sel:[1,1] op_sel_hi:[0,1]
    v_pk_fma_f32 v[84:85], v[82:83], v[82:83], v[92:93] op_sel:[0,0,0] op_sel_hi:[0,1,1] neg_lo:[0,0,1]
    v_pk_mul_f32 v[94:95], v[66:67], v[76:77] op_sel:[1,1] op_sel_hi:[1,0]
    v_pk_fma_f32 v[86:87], v[66:67], v[76:77], v[94:95] op_sel:[0,0,0] op_sel_hi:[0,1,1] neg_lo:[0,0,1] neg_hi:[1,0,1]
    v_mov_b32_dpp v80, v78 row_ror:8 row_mask:0xf bank_mask:0x3
    v_mov_b32_dpp v81, v79 row_ror:8 row_mask:0xf bank_mask:0x3
    v_mov_b32_dpp v82, v84 row_ror:8 row_mask:0xf bank_mask:0x3
    v_mov_b32_dpp v83, v85 row_ror:8 row_mask:0xf bank_mask:0x3
    v_pk_mul_f32 v[92:93], v[66:67], v[80:81] op_sel:[1,1] op_sel_hi:[1,0]
    v_pk_fma_f32 v[88:89], v[66:67], v[80:81], v[92:93] op_sel:[0,0,0] op_sel_hi:[0,1,1] neg_lo:[0,0,1] neg_hi:[1,0,1]
    v_pk_mul_f32 v[94:95], v[66:67], v[82:83] op_sel:[1,1] op_sel_hi:[1,0]
    v_pk_fma_f32 v[90:91], v[66:67], v[82:83], v[94:95] op_sel:[0,0,0] op_sel_hi:[0,1,1] neg_lo:[0,0,1] neg_hi:[1,0,1]
    v_mfma_f32_16x16x4_f32 v[48:51], v86, v68, v[48:51]
    v_mfma_f32_16x16x4_f32 v[52:55], v88, v70, v[52:55]
    v_mfma_f32_16x16x4_f32 v[56:59], v88, v72, v[56:59]
    v_mfma_f32_16x16x4_f32 v[60:63], v90, v74, v[60:63]
    v_mfma_f32_16x16x4_f32 v[48:51], v87, v69, v[48:51]
    v_mfma_f32_16x16x4_f32 v[52:55], v89, v71, v[52:55]
    v_mfma_f32_16x16x4_f32 v[56:59], v89, v73, v[56:59]
    v_mfma_f32_16x16x4_f32 v[60:63], v91, v75, v[60:63]
    v_mov_b64_dpp v[64:65], v[28:29] row_newbcast:8 row_mask:0xf bank_mask:0xf
    v_mov_b64_dpp v[66:67], v[30:31] row_newbcast:8 row_mask:0xf bank_mask:0xf
    v_pk_mul_f32 v[94:95], v[64:65], v[26:27] op_sel_hi:[1,0]
    v_pk_mul_f32 v[96:97], v[64:65], v[26:27] op_sel:[0,1] op_sel_hi:[1,1]
    v_fract_f32 v95, v95
    v_fract_f32 v97, v97
    v_exp_f32 v94, v94
    v_exp_f32 v96, v96
    v_cos_f32 v68, v95
    v_sin_f32 v69, v95
    v_cos_f32 v76, v97
    v_sin_f32 v77, v97
    v_pk_mul_f32 v[68:69], v[68:69], v[94:95] op_sel_hi:[1,0]
    v_pk_mul_f32 v[76:77], v[76:77], v[96:97] op_sel_hi:[1,0]
    v_pk_mul_f32 v[92:93], v[76:77], v[76:77] op_sel:[1,1] op_sel_hi:[0,1]
    v_pk_fma_f32 v[78:79], v[76:77], v[76:77], v[92:93] op_sel:[0,0,0] op_sel_hi:[0,1,1] neg_lo:[0,0,1]
    v_pk_mul_f32 v[94:95], v[68:69], v[68:69] op_sel:[1,1] op_sel_hi:[0,1]
    v_pk_fma_f32 v[70:71], v[68:69], v[68:69], v[94:95] op_sel:[0,0,0] op_sel_hi:[0,1,1] neg_lo:[0,0,1]
    v_pk_mul_f32 v[92:93], v[78:79], v[78:79] op_sel:[1,1] op_sel_hi:[0,1]
    v_pk_fma_f32 v[80:81], v[78:79], v[78:79], v[92:93] op_sel:[0,0,0] op_sel_hi:[0,1,1] neg_lo:[0,0,1]
    v_pk_mul_f32 v[94:95], v[70:71], v[70:71] op_sel:[1,1] op_sel_hi:[0,1]
    v_pk_fma_f32 v[72:73], v[70:71], v[70:71], v[94:95] op_sel:[0,0,0] op_sel_hi:[0,1,1] neg_lo:[0,0,1]
    v_pk_mul_f32 v[92:93], v[80:81], v[80:81] op_sel:[1,1] op_sel_hi:[0,1]
    v_pk_fma_f32 v[82:83], v[80:81], v[80:81], v[92:93] op_sel:[0,0,0] op_sel_hi:[0,1,1] neg_lo:[0,0,1]
    v_pk_mul_f32 v[94:95], v[72:73], v[72:73] op_sel:[1,1] op_sel_hi:[0,1]
    v_pk_fma_f32 v[74:75], v[72:73], v[72:73], v[94:95] op_sel:[0,0,0] op_sel_hi:[0,1,1] neg_lo:[0,0,1]
    v_pk_mul_f32 v[92:93], v[82:83], v[82:83] op_sel:[1,1] op_sel_hi:[0,1]
    v_pk_fma_f32 v[84:85], v[82:83], v[82:83], v[92:93] op_sel:[0,0,0] op_sel_hi:[0,1,1] neg_lo:[0,0,1]
    v_pk_mul_f32 v[94:95], v[66:67], v[76:77] op_sel:[1,1] op_sel_hi:[1,0]
    v_pk_fma_f32 v[86:87], v[66:67], v[76:77], v[94:95] op_sel:[0,0,0] op_sel_hi:[0,1,1] neg_lo:[0,0,1] neg_hi:[1,0,1]
    v_mov_b32_dpp v80, v78 row_ror:8 row_mask:0xf bank_mask:0x3
    v_mov_b32_dpp v81, v79 row_ror:8 row_mask:0xf bank_mask:0x3
    v_mov_b32_dpp v82, v84 row_ror:8 row_mask:0xf bank_mask:0x3
    v_mov_b32_dpp v83, v85 row_ror:8 row_mask:0xf bank_mask:0x3
    v_pk_mul_f32 v[92:93], v[66:67], v[80:81] op_sel:[1,1] op_sel_hi:[1,0]
    v_pk_fma_f32 v[88:89], v[66:67], v[80:81], v[92:93] op_sel:[0,0,0] op_sel_hi:[0,1,1] neg_lo:[0,0,1] neg_hi:[1,0,1]
    v_pk_mul_f32 v[94:95], v[66:67], v[82:83] op_sel:[1,1] op_sel_hi:[1,0]
    v_pk_fma_f32 v[90:91], v[66:67], v[82:83], v[94:95] op_sel:[0,0,0] op_sel_hi:[0,1,1] neg_lo:[0,0,1] neg_hi:[1,0,1]
    v_mfma_f32_16x16x4_f32 v[48:51], v86, v68, v[48:51]
    v_mfma_f32_16x16x4_f32 v[52:55], v88, v70, v[52:55]
    v_mfma_f32_16x16x4_f32 v[56:59], v88, v72, v[56:59]
    v_mfma_f32_16x16x4_f32 v[60:63], v90, v74, v[60:63]
    v_mfma_f32_16x16x4_f32 v[48:51], v87, v69, v[48:51]
    v_mfma_f32_16x16x4_f32 v[52:55], v89, v71, v[52:55]
    v_mfma_f32_16x16x4_f32 v[56:59], v89, v73, v[56:59]
    v_mfma_f32_16x16x4_f32 v[60:63], v91, v75, v[60:63]
    v_mov_b64_dpp v[64:65], v[28:29] row_newbcast:9 row_mask:0xf bank_mask:0xf
    v_mov_b64_dpp v[66:67], v[30:31] row_newbcast:9 row_mask:0xf bank_mask:0xf
    v_pk_mul_f32 v[94:95], v[64:65], v[26:27] op_sel_hi:[1,0]
    v_pk_mul_f32 v[96:97], v[64:65], v[26:27] op_sel:[0,1] op_sel_hi:[1,1]
    v_fract_f32 v95, v95
    v_fract_f32 v97, v97
    v_exp_f32 v94, v94
    v_exp_f32 v96, v96
    v_cos_f32 v68, v95
    v_sin_f32 v69, v95
    v_cos_f32 v76, v97
    v_sin_f32 v77, v97
    v_pk_mul_f32 v[68:69], v[68:69], v[94:95] op_sel_hi:[1,0]
    v_pk_mul_f32 v[76:77], v[76:77], v[96:97] op_sel_hi:[1,0]
    v_pk_mul_f32 v[92:93], v[76:77], v[76:77] op_sel:[1,1] op_sel_hi:[0,1]
    v_pk_fma_f32 v[78:79], v[76:77], v[76:77], v[92:93] op_sel:[0,0,0] op_sel_hi:[0,1,1] neg_lo:[0,0,1]
    v_pk_mul_f32 v[94:95], v[68:69], v[68:69] op_sel:[1,1] op_sel_hi:[0,1]
    v_pk_fma_f32 v[70:71], v[68:69], v[68:69], v[94:95] op_sel:[0,0,0] op_sel_hi:[0,1,1] neg_lo:[0,0,1]
    v_pk_mul_f32 v[92:93], v[78:79], v[78:79] op_sel:[1,1] op_sel_hi:[0,1]
    v_pk_fma_f32 v[80:81], v[78:79], v[78:79], v[92:93] op_sel:[0,0,0] op_sel_hi:[0,1,1] neg_lo:[0,0,1]
    v_pk_mul_f32 v[94:95], v[70:71], v[70:71] op_sel:[1,1] op_sel_hi:[0,1]
    v_pk_fma_f32 v[72:73], v[70:71], v[70:71], v[94:95] op_sel:[0,0,0] op_sel_hi:[0,1,1] neg_lo:[0,0,1]
    v_pk_mul_f32 v[92:93], v[80:81], v[80:81] op_sel:[1,1] op_sel_hi:[0,1]
    v_pk_fma_f32 v[82:83], v[80:81], v[80:81], v[92:93] op_sel:[0,0,0] op_sel_hi:[0,1,1] neg_lo:[0,0,1]
    v_pk_mul_f32 v[94:95], v[72:73], v[72:73] op_sel:[1,1] op_sel_hi:[0,1]
    v_pk_fma_f32 v[74:75], v[72:73], v[72:73], v[94:95] op_sel:[0,0,0] op_sel_hi:[0,1,1] neg_lo:[0,0,1]
    v_pk_mul_f32 v[92:93], v[82:83], v[82:83] op_sel:[1,1] op_sel_hi:[0,1]
    v_pk_fma_f32 v[84:85], v[82:83], v[82:83], v[92:93] op_sel:[0,0,0] op_sel_hi:[0,1,1] neg_lo:[0,0,1]
    v_pk_mul_f32 v[94:95], v[66:67], v[76:77] op_sel:[1,1] op_sel_hi:[1,0]
    v_pk_fma_f32 v[86:87], v[66:67], v[76:77], v[94:95] op_sel:[0,0,0] op_sel_hi:[0,1,1] neg_lo:[0,0,1] neg_hi:[1,0,1]
    v_mov_b32_dpp v80, v78 row_ror:8 row_mask:0xf bank_mask:0x3
    v_mov_b32_dpp v81, v79 row_ror:8 row_mask:0xf bank_mask:0x3
    v_mov_b32_dpp v82, v84 row_ror:8 row_mask:0xf bank_mask:0x3
    v_mov_b32_dpp v83, v85 row_ror:8 row_mask:0xf bank_mask:0x3
    v_pk_mul_f32 v[92:93], v[66:67], v[80:81] op_sel:[1,1] op_sel_hi:[1,0]
    v_pk_fma_f32 v[88:89], v[66:67], v[80:81], v[92:93] op_sel:[0,0,0] op_sel_hi:[0,1,1] neg_lo:[0,0,1] neg_hi:[1,0,1]
    v_pk_mul_f32 v[94:95], v[66:67], v[82:83] op_sel:[1,1] op_sel_hi:[1,0]
    v_pk_fma_f32 v[90:91], v[66:67], v[82:83], v[94:95] op_sel:[0,0,0] op_sel_hi:[0,1,1] neg_lo:[0,0,1] neg_hi:[1,0,1]
    v_mfma_f32_16x16x4_f32 v[48:51], v86, v68, v[48:51]
    v_mfma_f32_16x16x4_f32 v[52:55], v88, v70, v[52:55]
    v_mfma_f32_16x16x4_f32 v[56:59], v88, v72, v[56:59]
    v_mfma_f32_16x16x4_f32 v[60:63], v90, v74, v[60:63]
    v_mfma_f32_16x16x4_f32 v[48:51], v87, v69, v[48:51]
    v_mfma_f32_16x16x4_f32 v[52:55], v89, v71, v[52:55]
    v_mfma_f32_16x16x4_f32 v[56:59], v89, v73, v[56:59]
    v_mfma_f32_16x16x4_f32 v[60:63], v91, v75, v[60:63]
    v_mov_b64_dpp v[64:65], v[28:29] row_newbcast:10 row_mask:0xf bank_mask:0xf
    v_mov_b64_dpp v[66:67], v[30:31] row_newbcast:10 row_mask:0xf bank_mask:0xf
    v_pk_mul_f32 v[94:95], v[64:65], v[26:27] op_sel_hi:[1,0]
    v_pk_mul_f32 v[96:97], v[64:65], v[26:27] op_sel:[0,1] op_sel_hi:[1,1]
    v_fract_f32 v95, v95
    v_fract_f32 v97, v97
    v_exp_f32 v94, v94
    v_exp_f32 v96, v96
    v_cos_f32 v68, v95
    v_sin_f32 v69, v95
    v_cos_f32 v76, v97
    v_sin_f32 v77, v97
    v_pk_mul_f32 v[68:69], v[68:69], v[94:95] op_sel_hi:[1,0]
    v_pk_mul_f32 v[76:77], v[76:77], v[96:97] op_sel_hi:[1,0]
    v_pk_mul_f32 v[92:93], v[76:77], v[76:77] op_sel:[1,1] op_sel_hi:[0,1]
    v_pk_fma_f32 v[78:79], v[76:77], v[76:77], v[92:93] op_sel:[0,0,0] op_sel_hi:[0,1,1] neg_lo:[0,0,1]
    v_pk_mul_f32 v[94:95], v[68:69], v[68:69] op_sel:[1,1] op_sel_hi:[0,1]
    v_pk_fma_f32 v[70:71], v[68:69], v[68:69], v[94:95] op_sel:[0,0,0] op_sel_hi:[0,1,1] neg_lo:[0,0,1]
    v_pk_mul_f32 v[92:93], v[78:79], v[78:79] op_sel:[1,1] op_sel_hi:[0,1]
    v_pk_fma_f32 v[80:81], v[78:79], v[78:79], v[92:93] op_sel:[0,0,0] op_sel_hi:[0,1,1] neg_lo:[0,0,1]
    v_pk_mul_f32 v[94:95], v[70:71], v[70:71] op_sel:[1,1] op_sel_hi:[0,1]
    v_pk_fma_f32 v[72:73], v[70:71], v[70:71], v[94:95] op_sel:[0,0,0] op_sel_hi:[0,1,1] neg_lo:[0,0,1]
    v_pk_mul_f32 v[92:93], v[80:81], v[80:81] op_sel:[1,1] op_sel_hi:[0,1]
    v_pk_fma_f32 v[82:83], v[80:81], v[80:81], v[92:93] op_sel:[0,0,0] op_sel_hi:[0,1,1] neg_lo:[0,0,1]
    v_pk_mul_f32 v[94:95], v[72:73], v[72:73] op_sel:[1,1] op_sel_hi:[0,1]
    v_pk_fma_f32 v[74:75], v[72:73], v[72:73], v[94:95] op_sel:[0,0,0] op_sel_hi:[0,1,1] neg_lo:[0,0,1]
    v_pk_mul_f32 v[92:93], v[82:83], v[82:83] op_sel:[1,1] op_sel_hi:[0,1]
    v_pk_fma_f32 v[84:85], v[82:83], v[82:83], v[92:93] op_sel:[0,0,0] op_sel_hi:[0,1,1] neg_lo:[0,0,1]
    v_pk_mul_f32 v[94:95], v[66:67], v[76:77] op_sel:[1,1] op_sel_hi:[1,0]
    v_pk_fma_f32 v[86:87], v[66:67], v[76:77], v[94:95] op_sel:[0,0,0] op_sel_hi:[0,1,1] neg_lo:[0,0,1] neg_hi:[1,0,1]
    v_mov_b32_dpp v80, v78 row_ror:8 row_mask:0xf bank_mask:0x3
    v_mov_b32_dpp v81, v79 row_ror:8 row_mask:0xf bank_mask:0x3
    v_mov_b32_dpp v82, v84 row_ror:8 row_mask:0xf bank_mask:0x3
    v_mov_b32_dpp v83, v85 row_ror:8 row_mask:0xf bank_mask:0x3
    v_pk_mul_f32 v[92:93], v[66:67], v[80:81] op_sel:[1,1] op_sel_hi:[1,0]
    v_pk_fma_f32 v[88:89], v[66:67], v[80:81], v[92:93] op_sel:[0,0,0] op_sel_hi:[0,1,1] neg_lo:[0,0,1] neg_hi:[1,0,1]
    v_pk_mul_f32 v[94:95], v[66:67], v[82:83] op_sel:[1,1] op_sel_hi:[1,0]
    v_pk_fma_f32 v[90:91], v[66:67], v[82:83], v[94:95] op_sel:[0,0,0] op_sel_hi:[0,1,1] neg_lo:[0,0,1] neg_hi:[1,0,1]
    v_mfma_f32_16x16x4_f32 v[48:51], v86, v68, v[48:51]
    v_mfma_f32_16x16x4_f32 v[52:55], v88, v70, v[52:55]
    v_mfma_f32_16x16x4_f32 v[56:59], v88, v72, v[56:59]
    v_mfma_f32_16x16x4_f32 v[60:63], v90, v74, v[60:63]
    v_mfma_f32_16x16x4_f32 v[48:51], v87, v69, v[48:51]
    v_mfma_f32_16x16x4_f32 v[52:55], v89, v71, v[52:55]
    v_mfma_f32_16x16x4_f32 v[56:59], v89, v73, v[56:59]
    v_mfma_f32_16x16x4_f32 v[60:63], v91, v75, v[60:63]
    v_mov_b64_dpp v[64:65], v[28:29] row_newbcast:11 row_mask:0xf bank_mask:0xf
    v_mov_b64_dpp v[66:67], v[30:31] row_newbcast:11 row_mask:0xf bank_mask:0xf
    v_pk_mul_f32 v[94:95], v[64:65], v[26:27] op_sel_hi:[1,0]
    v_pk_mul_f32 v[96:97], v[64:65], v[26:27] op_sel:[0,1] op_sel_hi:[1,1]
    v_fract_f32 v95, v95
    v_fract_f32 v97, v97
    v_exp_f32 v94, v94
    v_exp_f32 v96, v96
    v_cos_f32 v68, v95
    v_sin_f32 v69, v95
    v_cos_f32 v76, v97
    v_sin_f32 v77, v97
    v_pk_mul_f32 v[68:69], v[68:69], v[94:95] op_sel_hi:[1,0]
    v_pk_mul_f32 v[76:77], v[76:77], v[96:97] op_sel_hi:[1,0]
    v_pk_mul_f32 v[92:93], v[76:77], v[76:77] op_sel:[1,1] op_sel_hi:[0,1]
    v_pk_fma_f32 v[78:79], v[76:77], v[76:77], v[92:93] op_sel:[0,0,0] op_sel_hi:[0,1,1] neg_lo:[0,0,1]
    v_pk_mul_f32 v[94:95], v[68:69], v[68:69] op_sel:[1,1] op_sel_hi:[0,1]
    v_pk_fma_f32 v[70:71], v[68:69], v[68:69], v[94:95] op_sel:[0,0,0] op_sel_hi:[0,1,1] neg_lo:[0,0,1]
    v_pk_mul_f32 v[92:93], v[78:79], v[78:79] op_sel:[1,1] op_sel_hi:[0,1]
    v_pk_fma_f32 v[80:81], v[78:79], v[78:79], v[92:93] op_sel:[0,0,0] op_sel_hi:[0,1,1] neg_lo:[0,0,1]
    v_pk_mul_f32 v[94:95], v[70:71], v[70:71] op_sel:[1,1] op_sel_hi:[0,1]
    v_pk_fma_f32 v[72:73], v[70:71], v[70:71], v[94:95] op_sel:[0,0,0] op_sel_hi:[0,1,1] neg_lo:[0,0,1]
    v_pk_mul_f32 v[92:93], v[80:81], v[80:81] op_sel:[1,1] op_sel_hi:[0,1]
    v_pk_fma_f32 v[82:83], v[80:81], v[80:81], v[92:93] op_sel:[0,0,0] op_sel_hi:[0,1,1] neg_lo:[0,0,1]
    v_pk_mul_f32 v[94:95], v[72:73], v[72:73] op_sel:[1,1] op_sel_hi:[0,1]
    v_pk_fma_f32 v[74:75], v[72:73], v[72:73], v[94:95] op_sel:[0,0,0] op_sel_hi:[0,1,1] neg_lo:[0,0,1]
    v_pk_mul_f32 v[92:93], v[82:83], v[82:83] op_sel:[1,1] op_sel_hi:[0,1]
    v_pk_fma_f32 v[84:85], v[82:83], v[82:83], v[92:93] op_sel:[0,0,0] op_sel_hi:[0,1,1] neg_lo:[0,0,1]
    v_pk_mul_f32 v[94:95], v[66:67], v[76:77] op_sel:[1,1] op_sel_hi:[1,0]
    v_pk_fma_f32 v[86:87], v[66:67], v[76:77], v[94:95] op_sel:[0,0,0] op_sel_hi:[0,1,1] neg_lo:[0,0,1] neg_hi:[1,0,1]
    v_mov_b32_dpp v80, v78 row_ror:8 row_mask:0xf bank_mask:0x3
    v_mov_b32_dpp v81, v79 row_ror:8 row_mask:0xf bank_mask:0x3
    v_mov_b32_dpp v82, v84 row_ror:8 row_mask:0xf bank_mask:0x3
    v_mov_b32_dpp v83, v85 row_ror:8 row_mask:0xf bank_mask:0x3
    v_pk_mul_f32 v[92:93], v[66:67], v[80:81] op_sel:[1,1] op_sel_hi:[1,0]
    v_pk_fma_f32 v[88:89], v[66:67], v[80:81], v[92:93] op_sel:[0,0,0] op_sel_hi:[0,1,1] neg_lo:[0,0,1] neg_hi:[1,0,1]
    v_pk_mul_f32 v[94:95], v[66:67], v[82:83] op_sel:[1,1] op_sel_hi:[1,0]
    v_pk_fma_f32 v[90:91], v[66:67], v[82:83], v[94:95] op_sel:[0,0,0] op_sel_hi:[0,1,1] neg_lo:[0,0,1] neg_hi:[1,0,1]
    v_mfma_f32_16x16x4_f32 v[48:51], v86, v68, v[48:51]
    v_mfma_f32_16x16x4_f32 v[52:55], v88, v70, v[52:55]
    v_mfma_f32_16x16x4_f32 v[56:59], v88, v72, v[56:59]
    v_mfma_f32_16x16x4_f32 v[60:63], v90, v74, v[60:63]
    v_mfma_f32_16x16x4_f32 v[48:51], v87, v69, v[48:51]
    v_mfma_f32_16x16x4_f32 v[52:55], v89, v71, v[52:55]
    v_mfma_f32_16x16x4_f32 v[56:59], v89, v73, v[56:59]
    v_mfma_f32_16x16x4_f32 v[60:63], v91, v75, v[60:63]
    v_mov_b64_dpp v[64:65], v[28:29] row_newbcast:12 row_mask:0xf bank_mask:0xf
    v_mov_b64_dpp v[66:67], v[30:31] row_newbcast:12 row_mask:0xf bank_mask:0xf
    v_pk_mul_f32 v[94:95], v[64:65], v[26:27] op_sel_hi:[1,0]
    v_pk_mul_f32 v[96:97], v[64:65], v[26:27] op_sel:[0,1] op_sel_hi:[1,1]
    v_fract_f32 v95, v95
    v_fract_f32 v97, v97
    v_exp_f32 v94, v94
    v_exp_f32 v96, v96
    v_cos_f32 v68, v95
    v_sin_f32 v69, v95
    v_cos_f32 v76, v97
    v_sin_f32 v77, v97
    v_pk_mul_f32 v[68:69], v[68:69], v[94:95] op_sel_hi:[1,0]
    v_pk_mul_f32 v[76:77], v[76:77], v[96:97] op_sel_hi:[1,0]
    v_pk_mul_f32 v[92:93], v[76:77], v[76:77] op_sel:[1,1] op_sel_hi:[0,1]
    v_pk_fma_f32 v[78:79], v[76:77], v[76:77], v[92:93] op_sel:[0,0,0] op_sel_hi:[0,1,1] neg_lo:[0,0,1]
    v_pk_mul_f32 v[94:95], v[68:69], v[68:69] op_sel:[1,1] op_sel_hi:[0,1]
    v_pk_fma_f32 v[70:71], v[68:69], v[68:69], v[94:95] op_sel:[0,0,0] op_sel_hi:[0,1,1] neg_lo:[0,0,1]
    v_pk_mul_f32 v[92:93], v[78:79], v[78:79] op_sel:[1,1] op_sel_hi:[0,1]
    v_pk_fma_f32 v[80:81], v[78:79], v[78:79], v[92:93] op_sel:[0,0,0] op_sel_hi:[0,1,1] neg_lo:[0,0,1]
    v_pk_mul_f32 v[94:95], v[70:71], v[70:71] op_sel:[1,1] op_sel_hi:[0,1]
    v_pk_fma_f32 v[72:73], v[70:71], v[70:71], v[94:95] op_sel:[0,0,0] op_sel_hi:[0,1,1] neg_lo:[0,0,1]
    v_pk_mul_f32 v[92:93], v[80:81], v[80:81] op_sel:[1,1] op_sel_hi:[0,1]
    v_pk_fma_f32 v[82:83], v[80:81], v[80:81], v[92:93] op_sel:[0,0,0] op_sel_hi:[0,1,1] neg_lo:[0,0,1]
    v_pk_mul_f32 v[94:95], v[72:73], v[72:73] op_sel:[1,1] op_sel_hi:[0,1]
    v_pk_fma_f32 v[74:75], v[72:73], v[72:73], v[94:95] op_sel:[0,0,0] op_sel_hi:[0,1,1] neg_lo:[0,0,1]
    v_pk_mul_f32 v[92:93], v[82:83], v[82:83] op_sel:[1,1] op_sel_hi:[0,1]
    v_pk_fma_f32 v[84:85], v[82:83], v[82:83], v[92:93] op_sel:[0,0,0] op_sel_hi:[0,1,1] neg_lo:[0,0,1]
    v_pk_mul_f32 v[94:95], v[66:67], v[76:77] op_sel:[1,1] op_sel_hi:[1,0]
    v_pk_fma_f32 v[86:87], v[66:67], v[76:77], v[94:95] op_sel:[0,0,0] op_sel_hi:[0,1,1] neg_lo:[0,0,1] neg_hi:[1,0,1]
    v_mov_b32_dpp v80, v78 row_ror:8 row_mask:0xf bank_mask:0x3
    v_mov_b32_dpp v81, v79 row_ror:8 row_mask:0xf bank_mask:0x3
    v_mov_b32_dpp v82, v84 row_ror:8 row_mask:0xf bank_mask:0x3
    v_mov_b32_dpp v83, v85 row_ror:8 row_mask:0xf bank_mask:0x3
    v_pk_mul_f32 v[92:93], v[66:67], v[80:81] op_sel:[1,1] op_sel_hi:[1,0]
    v_pk_fma_f32 v[88:89], v[66:67], v[80:81], v[92:93] op_sel:[0,0,0] op_sel_hi:[0,1,1] neg_lo:[0,0,1] neg_hi:[1,0,1]
    v_pk_mul_f32 v[94:95], v[66:67], v[82:83] op_sel:[1,1] op_sel_hi:[1,0]
    v_pk_fma_f32 v[90:91], v[66:67], v[82:83], v[94:95] op_sel:[0,0,0] op_sel_hi:[0,1,1] neg_lo:[0,0,1] neg_hi:[1,0,1]
    v_mfma_f32_16x16x4_f32 v[48:51], v86, v68, v[48:51]
    v_mfma_f32_16x16x4_f32 v[52:55], v88, v70, v[52:55]
    v_mfma_f32_16x16x4_f32 v[56:59], v88, v72, v[56:59]
    v_mfma_f32_16x16x4_f32 v[60:63], v90, v74, v[60:63]
    v_mfma_f32_16x16x4_f32 v[48:51], v87, v69, v[48:51]
    v_mfma_f32_16x16x4_f32 v[52:55], v89, v71, v[52:55]
    v_mfma_f32_16x16x4_f32 v[56:59], v89, v73, v[56:59]
    v_mfma_f32_16x16x4_f32 v[60:63], v91, v75, v[60:63]
    v_mov_b64_dpp v[64:65], v[28:29] row_newbcast:13 row_mask:0xf bank_mask:0xf
    v_mov_b64_dpp v[66:67], v[30:31] row_newbcast:13 row_mask:0xf bank_mask:0xf
    v_pk_mul_f32 v[94:95], v[64:65], v[26:27] op_sel_hi:[1,0]
    v_pk_mul_f32 v[96:97], v[64:65], v[26:27] op_sel:[0,1] op_sel_hi:[1,1]
    v_fract_f32 v95, v95
    v_fract_f32 v97, v97
    v_exp_f32 v94, v94
    v_exp_f32 v96, v96
    v_cos_f32 v68, v95
    v_sin_f32 v69, v95
    v_cos_f32 v76, v97
    v_sin_f32 v77, v97
    v_pk_mul_f32 v[68:69], v[68:69], v[94:95] op_sel_hi:[1,0]
    v_pk_mul_f32 v[76:77], v[76:77], v[96:97] op_sel_hi:[1,0]
    v_pk_mul_f32 v[92:93], v[76:77], v[76:77] op_sel:[1,1] op_sel_hi:[0,1]
    v_pk_fma_f32 v[78:79], v[76:77], v[76:77], v[92:93] op_sel:[0,0,0] op_sel_hi:[0,1,1] neg_lo:[0,0,1]
    v_pk_mul_f32 v[94:95], v[68:69], v[68:69] op_sel:[1,1] op_sel_hi:[0,1]
    v_pk_fma_f32 v[70:71], v[68:69], v[68:69], v[94:95] op_sel:[0,0,0] op_sel_hi:[0,1,1] neg_lo:[0,0,1]
    v_pk_mul_f32 v[92:93], v[78:79], v[78:79] op_sel:[1,1] op_sel_hi:[0,1]
    v_pk_fma_f32 v[80:81], v[78:79], v[78:79], v[92:93] op_sel:[0,0,0] op_sel_hi:[0,1,1] neg_lo:[0,0,1]
    v_pk_mul_f32 v[94:95], v[70:71], v[70:71] op_sel:[1,1] op_sel_hi:[0,1]
    v_pk_fma_f32 v[72:73], v[70:71], v[70:71], v[94:95] op_sel:[0,0,0] op_sel_hi:[0,1,1] neg_lo:[0,0,1]
    v_pk_mul_f32 v[92:93], v[80:81], v[80:81] op_sel:[1,1] op_sel_hi:[0,1]
    v_pk_fma_f32 v[82:83], v[80:81], v[80:81], v[92:93] op_sel:[0,0,0] op_sel_hi:[0,1,1] neg_lo:[0,0,1]
    v_pk_mul_f32 v[94:95], v[72:73], v[72:73] op_sel:[1,1] op_sel_hi:[0,1]
    v_pk_fma_f32 v[74:75], v[72:73], v[72:73], v[94:95] op_sel:[0,0,0] op_sel_hi:[0,1,1] neg_lo:[0,0,1]
    v_pk_mul_f32 v[92:93], v[82:83], v[82:83] op_sel:[1,1] op_sel_hi:[0,1]
    v_pk_fma_f32 v[84:85], v[82:83], v[82:83], v[92:93] op_sel:[0,0,0] op_sel_hi:[0,1,1] neg_lo:[0,0,1]
    v_pk_mul_f32 v[94:95], v[66:67], v[76:77] op_sel:[1,1] op_sel_hi:[1,0]
    v_pk_fma_f32 v[86:87], v[66:67], v[76:77], v[94:95] op_sel:[0,0,0] op_sel_hi:[0,1,1] neg_lo:[0,0,1] neg_hi:[1,0,1]
    v_mov_b32_dpp v80, v78 row_ror:8 row_mask:0xf bank_mask:0x3
    v_mov_b32_dpp v81, v79 row_ror:8 row_mask:0xf bank_mask:0x3
    v_mov_b32_dpp v82, v84 row_ror:8 row_mask:0xf bank_mask:0x3
    v_mov_b32_dpp v83, v85 row_ror:8 row_mask:0xf bank_mask:0x3
    v_pk_mul_f32 v[92:93], v[66:67], v[80:81] op_sel:[1,1] op_sel_hi:[1,0]
    v_pk_fma_f32 v[88:89], v[66:67], v[80:81], v[92:93] op_sel:[0,0,0] op_sel_hi:[0,1,1] neg_lo:[0,0,1] neg_hi:[1,0,1]
    v_pk_mul_f32 v[94:95], v[66:67], v[82:83] op_sel:[1,1] op_sel_hi:[1,0]
    v_pk_fma_f32 v[90:91], v[66:67], v[82:83], v[94:95] op_sel:[0,0,0] op_sel_hi:[0,1,1] neg_lo:[0,0,1] neg_hi:[1,0,1]
    v_mfma_f32_16x16x4_f32 v[48:51], v86, v68, v[48:51]
    v_mfma_f32_16x16x4_f32 v[52:55], v88, v70, v[52:55]
    v_mfma_f32_16x16x4_f32 v[56:59], v88, v72, v[56:59]
    v_mfma_f32_16x16x4_f32 v[60:63], v90, v74, v[60:63]
    v_mfma_f32_16x16x4_f32 v[48:51], v87, v69, v[48:51]
    v_mfma_f32_16x16x4_f32 v[52:55], v89, v71, v[52:55]
    v_mfma_f32_16x16x4_f32 v[56:59], v89, v73, v[56:59]
    v_mfma_f32_16x16x4_f32 v[60:63], v91, v75, v[60:63]
    v_mov_b64_dpp v[64:65], v[28:29] row_newbcast:14 row_mask:0xf bank_mask:0xf
    v_mov_b64_dpp v[66:67], v[30:31] row_newbcast:14 row_mask:0xf bank_mask:0xf
    v_pk_mul_f32 v[94:95], v[64:65], v[26:27] op_sel_hi:[1,0]
    v_pk_mul_f32 v[96:97], v[64:65], v[26:27] op_sel:[0,1] op_sel_hi:[1,1]
    v_fract_f32 v95, v95
    v_fract_f32 v97, v97
    v_exp_f32 v94, v94
    v_exp_f32 v96, v96
    v_cos_f32 v68, v95
    v_sin_f32 v69, v95
    v_cos_f32 v76, v97
    v_sin_f32 v77, v97
    v_pk_mul_f32 v[68:69], v[68:69], v[94:95] op_sel_hi:[1,0]
    v_pk_mul_f32 v[76:77], v[76:77], v[96:97] op_sel_hi:[1,0]
    v_pk_mul_f32 v[92:93], v[76:77], v[76:77] op_sel:[1,1] op_sel_hi:[0,1]
    v_pk_fma_f32 v[78:79], v[76:77], v[76:77], v[92:93] op_sel:[0,0,0] op_sel_hi:[0,1,1] neg_lo:[0,0,1]
    v_pk_mul_f32 v[94:95], v[68:69], v[68:69] op_sel:[1,1] op_sel_hi:[0,1]
    v_pk_fma_f32 v[70:71], v[68:69], v[68:69], v[94:95] op_sel:[0,0,0] op_sel_hi:[0,1,1] neg_lo:[0,0,1]
    v_pk_mul_f32 v[92:93], v[78:79], v[78:79] op_sel:[1,1] op_sel_hi:[0,1]
    v_pk_fma_f32 v[80:81], v[78:79], v[78:79], v[92:93] op_sel:[0,0,0] op_sel_hi:[0,1,1] neg_lo:[0,0,1]
    v_pk_mul_f32 v[94:95], v[70:71], v[70:71] op_sel:[1,1] op_sel_hi:[0,1]
    v_pk_fma_f32 v[72:73], v[70:71], v[70:71], v[94:95] op_sel:[0,0,0] op_sel_hi:[0,1,1] neg_lo:[0,0,1]
    v_pk_mul_f32 v[92:93], v[80:81], v[80:81] op_sel:[1,1] op_sel_hi:[0,1]
    v_pk_fma_f32 v[82:83], v[80:81], v[80:81], v[92:93] op_sel:[0,0,0] op_sel_hi:[0,1,1] neg_lo:[0,0,1]
    v_pk_mul_f32 v[94:95], v[72:73], v[72:73] op_sel:[1,1] op_sel_hi:[0,1]
    v_pk_fma_f32 v[74:75], v[72:73], v[72:73], v[94:95] op_sel:[0,0,0] op_sel_hi:[0,1,1] neg_lo:[0,0,1]
    v_pk_mul_f32 v[92:93], v[82:83], v[82:83] op_sel:[1,1] op_sel_hi:[0,1]
    v_pk_fma_f32 v[84:85], v[82:83], v[82:83], v[92:93] op_sel:[0,0,0] op_sel_hi:[0,1,1] neg_lo:[0,0,1]
    v_pk_mul_f32 v[94:95], v[66:67], v[76:77] op_sel:[1,1] op_sel_hi:[1,0]
    v_pk_fma_f32 v[86:87], v[66:67], v[76:77], v[94:95] op_sel:[0,0,0] op_sel_hi:[0,1,1] neg_lo:[0,0,1] neg_hi:[1,0,1]
    v_mov_b32_dpp v80, v78 row_ror:8 row_mask:0xf bank_mask:0x3
    v_mov_b32_dpp v81, v79 row_ror:8 row_mask:0xf bank_mask:0x3
    v_mov_b32_dpp v82, v84 row_ror:8 row_mask:0xf bank_mask:0x3
    v_mov_b32_dpp v83, v85 row_ror:8 row_mask:0xf bank_mask:0x3
    v_pk_mul_f32 v[92:93], v[66:67], v[80:81] op_sel:[1,1] op_sel_hi:[1,0]
    v_pk_fma_f32 v[88:89], v[66:67], v[80:81], v[92:93] op_sel:[0,0,0] op_sel_hi:[0,1,1] neg_lo:[0,0,1] neg_hi:[1,0,1]
    v_pk_mul_f32 v[94:95], v[66:67], v[82:83] op_sel:[1,1] op_sel_hi:[1,0]
    v_pk_fma_f32 v[90:91], v[66:67], v[82:83], v[94:95] op_sel:[0,0,0] op_sel_hi:[0,1,1] neg_lo:[0,0,1] neg_hi:[1,0,1]
    v_mfma_f32_16x16x4_f32 v[48:51], v86, v68, v[48:51]
    v_mfma_f32_16x16x4_f32 v[52:55], v88, v70, v[52:55]
    v_mfma_f32_16x16x4_f32 v[56:59], v88, v72, v[56:59]
    v_mfma_f32_16x16x4_f32 v[60:63], v90, v74, v[60:63]
    v_mfma_f32_16x16x4_f32 v[48:51], v87, v69, v[48:51]
    v_mfma_f32_16x16x4_f32 v[52:55], v89, v71, v[52:55]
    v_mfma_f32_16x16x4_f32 v[56:59], v89, v73, v[56:59]
    v_mfma_f32_16x16x4_f32 v[60:63], v91, v75, v[60:63]
    v_mov_b64_dpp v[64:65], v[28:29] row_newbcast:15 row_mask:0xf bank_mask:0xf
    v_mov_b64_dpp v[66:67], v[30:31] row_newbcast:15 row_mask:0xf bank_mask:0xf
    v_pk_mul_f32 v[94:95], v[64:65], v[26:27] op_sel_hi:[1,0]
    v_pk_mul_f32 v[96:97], v[64:65], v[26:27] op_sel:[0,1] op_sel_hi:[1,1]
    v_fract_f32 v95, v95
    v_fract_f32 v97, v97
    v_exp_f32 v94, v94
    v_exp_f32 v96, v96
    v_cos_f32 v68, v95
    v_sin_f32 v69, v95
    v_cos_f32 v76, v97
    v_sin_f32 v77, v97
    v_pk_mul_f32 v[68:69], v[68:69], v[94:95] op_sel_hi:[1,0]
    v_pk_mul_f32 v[76:77], v[76:77], v[96:97] op_sel_hi:[1,0]
    v_pk_mul_f32 v[92:93], v[76:77], v[76:77] op_sel:[1,1] op_sel_hi:[0,1]
    v_pk_fma_f32 v[78:79], v[76:77], v[76:77], v[92:93] op_sel:[0,0,0] op_sel_hi:[0,1,1] neg_lo:[0,0,1]
    v_pk_mul_f32 v[94:95], v[68:69], v[68:69] op_sel:[1,1] op_sel_hi:[0,1]
    v_pk_fma_f32 v[70:71], v[68:69], v[68:69], v[94:95] op_sel:[0,0,0] op_sel_hi:[0,1,1] neg_lo:[0,0,1]
    v_pk_mul_f32 v[92:93], v[78:79], v[78:79] op_sel:[1,1] op_sel_hi:[0,1]
    v_pk_fma_f32 v[80:81], v[78:79], v[78:79], v[92:93] op_sel:[0,0,0] op_sel_hi:[0,1,1] neg_lo:[0,0,1]
    v_pk_mul_f32 v[94:95], v[70:71], v[70:71] op_sel:[1,1] op_sel_hi:[0,1]
    v_pk_fma_f32 v[72:73], v[70:71], v[70:71], v[94:95] op_sel:[0,0,0] op_sel_hi:[0,1,1] neg_lo:[0,0,1]
    v_pk_mul_f32 v[92:93], v[80:81], v[80:81] op_sel:[1,1] op_sel_hi:[0,1]
    v_pk_fma_f32 v[82:83], v[80:81], v[80:81], v[92:93] op_sel:[0,0,0] op_sel_hi:[0,1,1] neg_lo:[0,0,1]
    v_pk_mul_f32 v[94:95], v[72:73], v[72:73] op_sel:[1,1] op_sel_hi:[0,1]
    v_pk_fma_f32 v[74:75], v[72:73], v[72:73], v[94:95] op_sel:[0,0,0] op_sel_hi:[0,1,1] neg_lo:[0,0,1]
    v_pk_mul_f32 v[92:93], v[82:83], v[82:83] op_sel:[1,1] op_sel_hi:[0,1]
    v_pk_fma_f32 v[84:85], v[82:83], v[82:83], v[92:93] op_sel:[0,0,0] op_sel_hi:[0,1,1] neg_lo:[0,0,1]
    v_pk_mul_f32 v[94:95], v[66:67], v[76:77] op_sel:[1,1] op_sel_hi:[1,0]
    v_pk_fma_f32 v[86:87], v[66:67], v[76:77], v[94:95] op_sel:[0,0,0] op_sel_hi:[0,1,1] neg_lo:[0,0,1] neg_hi:[1,0,1]
    v_mov_b32_dpp v80, v78 row_ror:8 row_mask:0xf bank_mask:0x3
    v_mov_b32_dpp v81, v79 row_ror:8 row_mask:0xf bank_mask:0x3
    v_mov_b32_dpp v82, v84 row_ror:8 row_mask:0xf bank_mask:0x3
    v_mov_b32_dpp v83, v85 row_ror:8 row_mask:0xf bank_mask:0x3
    v_pk_mul_f32 v[92:93], v[66:67], v[80:81] op_sel:[1,1] op_sel_hi:[1,0]
    v_pk_fma_f32 v[88:89], v[66:67], v[80:81], v[92:93] op_sel:[0,0,0] op_sel_hi:[0,1,1] neg_lo:[0,0,1] neg_hi:[1,0,1]
    v_pk_mul_f32 v[94:95], v[66:67], v[82:83] op_sel:[1,1] op_sel_hi:[1,0]
    v_pk_fma_f32 v[90:91], v[66:67], v[82:83], v[94:95] op_sel:[0,0,0] op_sel_hi:[0,1,1] neg_lo:[0,0,1] neg_hi:[1,0,1]
    v_mfma_f32_16x16x4_f32 v[48:51], v86, v68, v[48:51]
    v_mfma_f32_16x16x4_f32 v[52:55], v88, v70, v[52:55]
    v_mfma_f32_16x16x4_f32 v[56:59], v88, v72, v[56:59]
    v_mfma_f32_16x16x4_f32 v[60:63], v90, v74, v[60:63]
    v_mfma_f32_16x16x4_f32 v[48:51], v87, v69, v[48:51]
    v_mfma_f32_16x16x4_f32 v[52:55], v89, v71, v[52:55]
    v_mfma_f32_16x16x4_f32 v[56:59], v89, v73, v[56:59]
    v_mfma_f32_16x16x4_f32 v[60:63], v91, v75, v[60:63]
    v_mov_b64 v[28:29], v[32:33]
    v_mov_b64 v[30:31], v[34:35]
    s_add_u32 s25, s25, 1
    s_cmp_lt_u32 s25, 2
    s_cbranch_scc1 ss_kg
    s_cmp_lg_u32 s28, 0
    s_cbranch_scc1 ss_nostage
    s_waitcnt vmcnt(0)
    v_mov_b32 v36, 0x05040100
    v_mov_b32 v37, 0x07060302
    v_lshlrev_b32 v6, 4, v0
    v_add_u32 v7, 65536, v6
    v_perm_b32 v40, v212, v208, v36
    v_perm_b32 v41, v220, v216, v36
    v_perm_b32 v42, v228, v224, v36
    v_perm_b32 v43, v236, v232, v36
    ds_write_b128 v6, v[40:43] offset:512
    v_perm_b32 v44, v212, v208, v37
    v_perm_b32 v45, v220, v216, v37
    v_perm_b32 v46, v228, v224, v37
    v_perm_b32 v47, v236, v232, v37
    ds_write_b128 v6, v[44:47] offset:16896
    v_perm_b32 v40, v213, v209, v36
    v_perm_b32 v41, v221, v217, v36
    v_perm_b32 v42, v229, v225, v36
    v_perm_b32 v43, v237, v233, v36
    ds_write_b128 v6, v[40:43] offset:33280
    v_perm_b32 v44, v213, v209, v37
    v_perm_b32 v45, v221, v217, v37
    v_perm_b32 v46, v229, v225, v37
    v_perm_b32 v47, v237, v233, v37
    ds_write_b128 v6, v[44:47] offset:49664
    v_perm_b32 v40, v214, v210, v36
    v_perm_b32 v41, v222, v218, v36
    v_perm_b32 v42, v230, v226, v36
    v_perm_b32 v43, v238, v234, v36
    ds_write_b128 v7, v[40:43] offset:512
    v_perm_b32 v44, v214, v210, v37
    v_perm_b32 v45, v222, v218, v37
    v_perm_b32 v46, v230, v226, v37
    v_perm_b32 v47, v238, v234, v37
    ds_write_b128 v7, v[44:47] offset:16896
    v_perm_b32 v40, v215, v211, v36
    v_perm_b32 v41, v223, v219, v36
    v_perm_b32 v42, v231, v227, v36
    v_perm_b32 v43, v239, v235, v36
    ds_write_b128 v7, v[40:43] offset:33280
    v_perm_b32 v44, v215, v211, v37
    v_perm_b32 v45, v223, v219, v37
    v_perm_b32 v46, v231, v227, v37
    v_perm_b32 v47, v239, v235, v37
    ds_write_b128 v7, v[44:47] offset:49664
ss_nostage:
    s_nop 11
    v_lshlrev_b32 v5, 8, v3
    v_lshl_add_u32 v5, v2, 2, v5
    v_add_u32 v5, v5, v4
    ds_write_b32 v5, v48 offset:4608
    ds_write_b32 v5, v49 offset:4672
    ds_write_b32 v5, v50 offset:4736
    ds_write_b32 v5, v51 offset:4800
    s_mov_b32 exec_hi, 0
    ds_write_b32 v5, v52 offset:5632
    ds_write_b32 v5, v53 offset:5696
    ds_write_b32 v5, v54 offset:5760
    ds_write_b32 v5, v55 offset:5824
    s_not_b64 exec, exec
    ds_write_b32 v5, v56 offset:5632
    ds_write_b32 v5, v57 offset:5696
    ds_write_b32 v5, v58 offset:5760
    ds_write_b32 v5, v59 offset:5824
    ds_write_b32 v5, v60 offset:6144
    ds_write_b32 v5, v61 offset:6208
    ds_write_b32 v5, v62 offset:6272
    ds_write_b32 v5, v63 offset:6336
    s_mov_b64 exec, 3
    v_cmp_eq_u32 vcc, 0, v2
    s_nop 1
    v_cndmask_b32 v6, 0, v60, vcc
    ds_write_b32 v5, v6 offset:7168
    s_mov_b64 exec, -1
    s_waitcnt lgkmcnt(0)
    v_lshlrev_b32 v7, 1, v1
    v_sub_u32 v7, 2065, v7
    v_lshl_add_u32 v64, v1, 2, v4
    v_mov_b32 v65, 641
    s_mov_b32 s25, 9
    s_mov_b32 s22, 256
    s_mov_b32 s23, 2048
ss_exp:
    v_subrev_u32 v66, 0, v7
    v_cvt_f32_u32 v72, v66
    v_cmp_gt_u32 vcc, s22, v66
    v_cvt_pk_bf16_f32 v72, v72, 0
    v_subrev_u32 v72, 0x4280, v72
    v_cndmask_b32 v72, v72, v66, vcc
    v_cmp_gt_u32 vcc, s23, v66
    s_nop 1
    v_cndmask_b32 v72, v65, v72, vcc
    v_lshl_add_u32 v72, v72, 2, v4
    v_subrev_u32 v67, 1, v7
    v_cvt_f32_u32 v73, v67
    v_cmp_gt_u32 vcc, s22, v67
    v_cvt_pk_bf16_f32 v73, v73, 0
    v_subrev_u32 v73, 0x4280, v73
    v_cndmask_b32 v73, v73, v67, vcc
    v_cmp_gt_u32 vcc, s23, v67
    ds_read_b32 v78, v72 offset:4608
    s_nop 0
    v_cndmask_b32 v73, v65, v73, vcc
    v_lshl_add_u32 v73, v73, 2, v4
    v_subrev_u32 v68, 2, v7
    v_cvt_f32_u32 v74, v68
    v_cmp_gt_u32 vcc, s22, v68
    v_cvt_pk_bf16_f32 v74, v74, 0
    v_subrev_u32 v74, 0x4280, v74
    v_cndmask_b32 v74, v74, v68, vcc
    v_cmp_gt_u32 vcc, s23, v68
    ds_read_b32 v79, v73 offset:4608
    s_nop 0
    v_cndmask_b32 v74, v65, v74, vcc
    v_lshl_add_u32 v74, v74, 2, v4
    v_subrev_u32 v69, 128, v7
    v_cvt_f32_u32 v75, v69
    v_cmp_gt_u32 vcc, s22, v69
    v_cvt_pk_bf16_f32 v75, v75, 0
    v_subrev_u32 v75, 0x4280, v75
    v_cndmask_b32 v75, v75, v69, vcc
    v_cmp_gt_u32 vcc, s23, v69
    ds_read_b32 v80, v74 offset:4608
    s_nop 0
    v_cndmask_b32 v75, v65, v75, vcc
    v_lshl_add_u32 v75, v75, 2, v4
    v_subrev_u32 v70, 129, v7
    v_cvt_f32_u32 v76, v70
    v_cmp_gt_u32 vcc, s22, v70
    v_cvt_pk_bf16_f32 v76, v76, 0
    v_subrev_u32 v76, 0x4280, v76
    v_cndmask_b32 v76, v76, v70, vcc
    v_cmp_gt_u32 vcc, s23, v70
    ds_read_b32 v81, v75 offset:4608
    s_nop 0
    v_cndmask_b32 v76, v65, v76, vcc
    v_lshl_add_u32 v76, v76, 2, v4
    v_subrev_u32 v71, 130, v7
    v_cvt_f32_u32 v77, v71
    v_cmp_gt_u32 vcc, s22, v71
    v_cvt_pk_bf16_f32 v77, v77, 0
    v_subrev_u32 v77, 0x4280, v77
    v_cndmask_b32 v77, v77, v71, vcc
    v_cmp_gt_u32 vcc, s23, v71
    ds_read_b32 v82, v76 offset:4608
    s_nop 0
    v_cndmask_b32 v77, v65, v77, vcc
    v_lshl_add_u32 v77, v77, 2, v4
    ds_read_b32 v83, v77 offset:4608
    v_subrev_u32 v7, 256, v7
    s_sub_u32 s25, s25, 1
    s_waitcnt lgkmcnt(0)
    v_cvt_pk_bf16_f32 v84, v79, v80
    v_cvt_pk_bf16_f32 v85, v78, v79
    v_cvt_pk_bf16_f32 v86, v82, v83
    v_cvt_pk_bf16_f32 v87, v81, v82
    ds_write_b32 v64, v84 offset:7424
    ds_write_b32 v64, v85 offset:11776
    s_cmp_eq_u32 s25, 0
    s_cbranch_scc1 ss_expx
    ds_write_b32 v64, v86 offset:7680
    ds_write_b32 v64, v87 offset:12032
    v_add_u32 v64, 512, v64
    s_nop 1
    s_branch ss_exp
ss_expx:
    s_waitcnt lgkmcnt(0)
    s_barrier
    v_and_b32 v5, 1, v2
    v_mul_u32_u24 v36, 4352, v5
    v_sub_u32 v5, v5, v2
    v_lshl_add_u32 v5, v3, 3, v5
    v_lshl_add_u32 v36, v5, 1, v36
    v_add_u32 v36, 11072, v36
    v_add_u32 v36, v36, v4
    v_subrev_u32 v37, 512, v36
    v_subrev_u32 v38, 1024, v36
    v_subrev_u32 v39, 1536, v36
    v_subrev_u32 v40, 2048, v36
    v_subrev_u32 v41, 2560, v36
    v_subrev_u32 v42, 3072, v36
    v_subrev_u32 v43, 3584, v36
    v_lshlrev_b32 v44, 5, v2
    v_lshl_add_u32 v44, v3, 4, v44
    v_add_u32 v44, 32, v44
    v_add_u32 v44, v44, v4
    ds_read_b128 v[112:115], v44 offset:448
    ds_read2_b32 v[80:81], v36 offset0:112 offset1:113
    ds_read2_b32 v[82:83], v36 offset0:114 offset1:115
    ds_read_b128 v[116:119], v44 offset:960
    ds_read2_b32 v[84:85], v37 offset0:112 offset1:113
    ds_read2_b32 v[86:87], v37 offset0:114 offset1:115
    ds_read_b128 v[120:123], v44 offset:1472
    ds_read2_b32 v[88:89], v38 offset0:112 offset1:113
    ds_read2_b32 v[90:91], v38 offset0:114 offset1:115
    ds_read_b128 v[124:127], v44 offset:1984
    ds_read2_b32 v[92:93], v39 offset0:112 offset1:113
    ds_read2_b32 v[94:95], v39 offset0:114 offset1:115
    ds_read_b128 v[128:131], v44 offset:2496
    ds_read2_b32 v[96:97], v40 offset0:112 offset1:113
    ds_read2_b32 v[98:99], v40 offset0:114 offset1:115
    ds_read_b128 v[132:135], v44 offset:3008
    ds_read2_b32 v[100:101], v41 offset0:112 offset1:113
    ds_read2_b32 v[102:103], v41 offset0:114 offset1:115
    ds_read_b128 v[136:139], v44 offset:3520
    ds_read2_b32 v[104:105], v42 offset0:112 offset1:113
    ds_read2_b32 v[106:107], v42 offset0:114 offset1:115
    ds_read_b128 v[140:143], v44 offset:4032
    ds_read2_b32 v[108:109], v43 offset0:112 offset1:113
    ds_read2_b32 v[110:111], v43 offset0:114 offset1:115
    s_waitcnt lgkmcnt(0)
    v_mfma_f32_16x16x32_bf16 v[48:51], v[80:83], v[112:115], 0
    ds_read_b128 v[176:179], v44 offset:384
    v_mfma_f32_16x16x32_bf16 v[52:55], v[80:83], v[116:119], 0
    ds_read2_b32 v[144:145], v36 offset0:96 offset1:97
    v_mfma_f32_16x16x32_bf16 v[56:59], v[80:83], v[120:123], 0
    ds_read2_b32 v[146:147], v36 offset0:98 offset1:99
    v_mfma_f32_16x16x32_bf16 v[60:63], v[80:83], v[124:127], 0
    ds_read_b128 v[180:183], v44 offset:896
    v_mfma_f32_16x16x32_bf16 v[64:67], v[80:83], v[128:131], 0
    ds_read2_b32 v[148:149], v37 offset0:96 offset1:97
    v_mfma_f32_16x16x32_bf16 v[68:71], v[80:83], v[132:135], 0
    ds_read2_b32 v[150:151], v37 offset0:98 offset1:99
    v_mfma_f32_16x16x32_bf16 v[72:75], v[80:83], v[136:139], 0
    ds_read_b128 v[184:187], v44 offset:1408
    v_mfma_f32_16x16x32_bf16 v[76:79], v[80:83], v[140:143], 0
    ds_read2_b32 v[152:153], v38 offset0:96 offset1:97
    v_mfma_f32_16x16x32_bf16 v[52:55], v[84:87], v[112:115], v[52:55]
    ds_read2_b32 v[154:155], v38 offset0:98 offset1:99
    v_mfma_f32_16x16x32_bf16 v[56:59], v[84:87], v[116:119], v[56:59]
    ds_read_b128 v[188:191], v44 offset:1920
    v_mfma_f32_16x16x32_bf16 v[60:63], v[84:87], v[120:123], v[60:63]
    ds_read2_b32 v[156:157], v39 offset0:96 offset1:97
    v_mfma_f32_16x16x32_bf16 v[64:67], v[84:87], v[124:127], v[64:67]
    ds_read2_b32 v[158:159], v39 offset0:98 offset1:99
    v_mfma_f32_16x16x32_bf16 v[68:71], v[84:87], v[128:131], v[68:71]
    ds_read_b128 v[192:195], v44 offset:2432
    v_mfma_f32_16x16x32_bf16 v[72:75], v[84:87], v[132:135], v[72:75]
    ds_read2_b32 v[160:161], v40 offset0:96 offset1:97
    v_mfma_f32_16x16x32_bf16 v[76:79], v[84:87], v[136:139], v[76:79]
    ds_read2_b32 v[162:163], v40 offset0:98 offset1:99
    v_mfma_f32_16x16x32_bf16 v[56:59], v[88:91], v[112:115], v[56:59]
    ds_read_b128 v[196:199], v44 offset:2944
    v_mfma_f32_16x16x32_bf16 v[60:63], v[88:91], v[116:119], v[60:63]
    ds_read2_b32 v[164:165], v41 offset0:96 offset1:97
    v_mfma_f32_16x16x32_bf16 v[64:67], v[88:91], v[120:123], v[64:67]
    ds_read2_b32 v[166:167], v41 offset0:98 offset1:99
    v_mfma_f32_16x16x32_bf16 v[68:71], v[88:91], v[124:127], v[68:71]
    ds_read_b128 v[200:203], v44 offset:3456
    v_mfma_f32_16x16x32_bf16 v[72:75], v[88:91], v[128:131], v[72:75]
    ds_read2_b32 v[168:169], v42 offset0:96 offset1:97
    v_mfma_f32_16x16x32_bf16 v[76:79], v[88:91], v[132:135], v[76:79]
    ds_read2_b32 v[170:171], v42 offset0:98 offset1:99
    v_mfma_f32_16x16x32_bf16 v[60:63], v[92:95], v[112:115], v[60:63]
    ds_read_b128 v[204:207], v44 offset:3968
    v_mfma_f32_16x16x32_bf16 v[64:67], v[92:95], v[116:119], v[64:67]
    ds_read2_b32 v[172:173], v43 offset0:96 offset1:97
    v_mfma_f32_16x16x32_bf16 v[68:71], v[92:95], v[120:123], v[68:71]
    ds_read2_b32 v[174:175], v43 offset0:98 offset1:99
    v_mfma_f32_16x16x32_bf16 v[72:75], v[92:95], v[124:127], v[72:75]
    v_mfma_f32_16x16x32_bf16 v[76:79], v[92:95], v[128:131], v[76:79]
    v_mfma_f32_16x16x32_bf16 v[64:67], v[96:99], v[112:115], v[64:67]
    v_mfma_f32_16x16x32_bf16 v[68:71], v[96:99], v[116:119], v[68:71]
    v_mfma_f32_16x16x32_bf16 v[72:75], v[96:99], v[120:123], v[72:75]
    v_mfma_f32_16x16x32_bf16 v[76:79], v[96:99], v[124:127], v[76:79]
    v_mfma_f32_16x16x32_bf16 v[68:71], v[100:103], v[112:115], v[68:71]
    v_mfma_f32_16x16x32_bf16 v[72:75], v[100:103], v[116:119], v[72:75]
    v_mfma_f32_16x16x32_bf16 v[76:79], v[100:103], v[120:123], v[76:79]
    v_mfma_f32_16x16x32_bf16 v[72:75], v[104:107], v[112:115], v[72:75]
    v_mfma_f32_16x16x32_bf16 v[76:79], v[104:107], v[116:119], v[76:79]
    v_mfma_f32_16x16x32_bf16 v[76:79], v[108:111], v[112:115], v[76:79]
    s_waitcnt lgkmcnt(0)
    v_mfma_f32_16x16x32_bf16 v[48:51], v[144:147], v[176:179], v[48:51]
    ds_read_b128 v[112:115], v44 offset:320
    v_mfma_f32_16x16x32_bf16 v[52:55], v[144:147], v[180:183], v[52:55]
    ds_read2_b32 v[80:81], v36 offset0:80 offset1:81
    v_mfma_f32_16x16x32_bf16 v[56:59], v[144:147], v[184:187], v[56:59]
    ds_read2_b32 v[82:83], v36 offset0:82 offset1:83
    v_mfma_f32_16x16x32_bf16 v[60:63], v[144:147], v[188:191], v[60:63]
    ds_read_b128 v[116:119], v44 offset:832
    v_mfma_f32_16x16x32_bf16 v[64:67], v[144:147], v[192:195], v[64:67]
    ds_read2_b32 v[84:85], v37 offset0:80 offset1:81
    v_mfma_f32_16x16x32_bf16 v[68:71], v[144:147], v[196:199], v[68:71]
    ds_read2_b32 v[86:87], v37 offset0:82 offset1:83
    v_mfma_f32_16x16x32_bf16 v[72:75], v[144:147], v[200:203], v[72:75]
    ds_read_b128 v[120:123], v44 offset:1344
    v_mfma_f32_16x16x32_bf16 v[76:79], v[144:147], v[204:207], v[76:79]
    ds_read2_b32 v[88:89], v38 offset0:80 offset1:81
    v_mfma_f32_16x16x32_bf16 v[52:55], v[148:151], v[176:179], v[52:55]
    ds_read2_b32 v[90:91], v38 offset0:82 offset1:83
    v_mfma_f32_16x16x32_bf16 v[56:59], v[148:151], v[180:183], v[56:59]
    ds_read_b128 v[124:127], v44 offset:1856
    v_mfma_f32_16x16x32_bf16 v[60:63], v[148:151], v[184:187], v[60:63]
    ds_read2_b32 v[92:93], v39 offset0:80 offset1:81
    v_mfma_f32_16x16x32_bf16 v[64:67], v[148:151], v[188:191], v[64:67]
    ds_read2_b32 v[94:95], v39 offset0:82 offset1:83
    v_mfma_f32_16x16x32_bf16 v[68:71], v[148:151], v[192:195], v[68:71]
    ds_read_b128 v[128:131], v44 offset:2368
    v_mfma_f32_16x16x32_bf16 v[72:75], v[148:151], v[196:199], v[72:75]
    ds_read2_b32 v[96:97], v40 offset0:80 offset1:81
    v_mfma_f32_16x16x32_bf16 v[76:79], v[148:151], v[200:203], v[76:79]
    ds_read2_b32 v[98:99], v40 offset0:82 offset1:83
    v_mfma_f32_16x16x32_bf16 v[56:59], v[152:155], v[176:179], v[56:59]
    ds_read_b128 v[132:135], v44 offset:2880
    v_mfma_f32_16x16x32_bf16 v[60:63], v[152:155], v[180:183], v[60:63]
    ds_read2_b32 v[100:101], v41 offset0:80 offset1:81
    v_mfma_f32_16x16x32_bf16 v[64:67], v[152:155], v[184:187], v[64:67]
    ds_read2_b32 v[102:103], v41 offset0:82 offset1:83
    v_mfma_f32_16x16x32_bf16 v[68:71], v[152:155], v[188:191], v[68:71]
    ds_read_b128 v[136:139], v44 offset:3392
    v_mfma_f32_16x16x32_bf16 v[72:75], v[152:155], v[192:195], v[72:75]
    ds_read2_b32 v[104:105], v42 offset0:80 offset1:81
    v_mfma_f32_16x16x32_bf16 v[76:79], v[152:155], v[196:199], v[76:79]
    ds_read2_b32 v[106:107], v42 offset0:82 offset1:83
    v_mfma_f32_16x16x32_bf16 v[60:63], v[156:159], v[176:179], v[60:63]
    ds_read_b128 v[140:143], v44 offset:3904
    v_mfma_f32_16x16x32_bf16 v[64:67], v[156:159], v[180:183], v[64:67]
    ds_read2_b32 v[108:109], v43 offset0:80 offset1:81
    v_mfma_f32_16x16x32_bf16 v[68:71], v[156:159], v[184:187], v[68:71]
    ds_read2_b32 v[110:111], v43 offset0:82 offset1:83
    v_mfma_f32_16x16x32_bf16 v[72:75], v[156:159], v[188:191], v[72:75]
    v_mfma_f32_16x16x32_bf16 v[76:79], v[156:159], v[192:195], v[76:79]
    v_mfma_f32_16x16x32_bf16 v[64:67], v[160:163], v[176:179], v[64:67]
    v_mfma_f32_16x16x32_bf16 v[68:71], v[160:163], v[180:183], v[68:71]
    v_mfma_f32_16x16x32_bf16 v[72:75], v[160:163], v[184:187], v[72:75]
    v_mfma_f32_16x16x32_bf16 v[76:79], v[160:163], v[188:191], v[76:79]
    v_mfma_f32_16x16x32_bf16 v[68:71], v[164:167], v[176:179], v[68:71]
    v_mfma_f32_16x16x32_bf16 v[72:75], v[164:167], v[180:183], v[72:75]
    v_mfma_f32_16x16x32_bf16 v[76:79], v[164:167], v[184:187], v[76:79]
    v_mfma_f32_16x16x32_bf16 v[72:75], v[168:171], v[176:179], v[72:75]
    v_mfma_f32_16x16x32_bf16 v[76:79], v[168:171], v[180:183], v[76:79]
    v_mfma_f32_16x16x32_bf16 v[76:79], v[172:175], v[176:179], v[76:79]
    s_waitcnt lgkmcnt(0)
    v_mfma_f32_16x16x32_bf16 v[48:51], v[80:83], v[112:115], v[48:51]
    ds_read_b128 v[176:179], v44 offset:256
    v_mfma_f32_16x16x32_bf16 v[52:55], v[80:83], v[116:119], v[52:55]
    ds_read2_b32 v[144:145], v36 offset0:64 offset1:65
    v_mfma_f32_16x16x32_bf16 v[56:59], v[80:83], v[120:123], v[56:59]
    ds_read2_b32 v[146:147], v36 offset0:66 offset1:67
    v_mfma_f32_16x16x32_bf16 v[60:63], v[80:83], v[124:127], v[60:63]
    ds_read_b128 v[180:183], v44 offset:768
    v_mfma_f32_16x16x32_bf16 v[64:67], v[80:83], v[128:131], v[64:67]
    ds_read2_b32 v[148:149], v37 offset0:64 offset1:65
    v_mfma_f32_16x16x32_bf16 v[68:71], v[80:83], v[132:135], v[68:71]
    ds_read2_b32 v[150:151], v37 offset0:66 offset1:67
    v_mfma_f32_16x16x32_bf16 v[72:75], v[80:83], v[136:139], v[72:75]
    ds_read_b128 v[184:187], v44 offset:1280
    v_mfma_f32_16x16x32_bf16 v[76:79], v[80:83], v[140:143], v[76:79]
    ds_read2_b32 v[152:153], v38 offset0:64 offset1:65
    v_mfma_f32_16x16x32_bf16 v[52:55], v[84:87], v[112:115], v[52:55]
    ds_read2_b32 v[154:155], v38 offset0:66 offset1:67
    v_mfma_f32_16x16x32_bf16 v[56:59], v[84:87], v[116:119], v[56:59]
    ds_read_b128 v[188:191], v44 offset:1792
    v_mfma_f32_16x16x32_bf16 v[60:63], v[84:87], v[120:123], v[60:63]
    ds_read2_b32 v[156:157], v39 offset0:64 offset1:65
    v_mfma_f32_16x16x32_bf16 v[64:67], v[84:87], v[124:127], v[64:67]
    ds_read2_b32 v[158:159], v39 offset0:66 offset1:67
    v_mfma_f32_16x16x32_bf16 v[68:71], v[84:87], v[128:131], v[68:71]
    ds_read_b128 v[192:195], v44 offset:2304
    v_mfma_f32_16x16x32_bf16 v[72:75], v[84:87], v[132:135], v[72:75]
    ds_read2_b32 v[160:161], v40 offset0:64 offset1:65
    v_mfma_f32_16x16x32_bf16 v[76:79], v[84:87], v[136:139], v[76:79]
    ds_read2_b32 v[162:163], v40 offset0:66 offset1:67
    v_mfma_f32_16x16x32_bf16 v[56:59], v[88:91], v[112:115], v[56:59]
    ds_read_b128 v[196:199], v44 offset:2816
    v_mfma_f32_16x16x32_bf16 v[60:63], v[88:91], v[116:119], v[60:63]
    ds_read2_b32 v[164:165], v41 offset0:64 offset1:65
    v_mfma_f32_16x16x32_bf16 v[64:67], v[88:91], v[120:123], v[64:67]
    ds_read2_b32 v[166:167], v41 offset0:66 offset1:67
    v_mfma_f32_16x16x32_bf16 v[68:71], v[88:91], v[124:127], v[68:71]
    ds_read_b128 v[200:203], v44 offset:3328
    v_mfma_f32_16x16x32_bf16 v[72:75], v[88:91], v[128:131], v[72:75]
    ds_read2_b32 v[168:169], v42 offset0:64 offset1:65
    v_mfma_f32_16x16x32_bf16 v[76:79], v[88:91], v[132:135], v[76:79]
    ds_read2_b32 v[170:171], v42 offset0:66 offset1:67
    v_mfma_f32_16x16x32_bf16 v[60:63], v[92:95], v[112:115], v[60:63]
    ds_read_b128 v[204:207], v44 offset:3840
    v_mfma_f32_16x16x32_bf16 v[64:67], v[92:95], v[116:119], v[64:67]
    ds_read2_b32 v[172:173], v43 offset0:64 offset1:65
    v_mfma_f32_16x16x32_bf16 v[68:71], v[92:95], v[120:123], v[68:71]
    ds_read2_b32 v[174:175], v43 offset0:66 offset1:67
    v_mfma_f32_16x16x32_bf16 v[72:75], v[92:95], v[124:127], v[72:75]
    v_mfma_f32_16x16x32_bf16 v[76:79], v[92:95], v[128:131], v[76:79]
    v_mfma_f32_16x16x32_bf16 v[64:67], v[96:99], v[112:115], v[64:67]
    v_mfma_f32_16x16x32_bf16 v[68:71], v[96:99], v[116:119], v[68:71]
    v_mfma_f32_16x16x32_bf16 v[72:75], v[96:99], v[120:123], v[72:75]
    v_mfma_f32_16x16x32_bf16 v[76:79], v[96:99], v[124:127], v[76:79]
    v_mfma_f32_16x16x32_bf16 v[68:71], v[100:103], v[112:115], v[68:71]
    v_mfma_f32_16x16x32_bf16 v[72:75], v[100:103], v[116:119], v[72:75]
    v_mfma_f32_16x16x32_bf16 v[76:79], v[100:103], v[120:123], v[76:79]
    v_mfma_f32_16x16x32_bf16 v[72:75], v[104:107], v[112:115], v[72:75]
    v_mfma_f32_16x16x32_bf16 v[76:79], v[104:107], v[116:119], v[76:79]
    v_mfma_f32_16x16x32_bf16 v[76:79], v[108:111], v[112:115], v[76:79]
    s_waitcnt lgkmcnt(0)
    v_mfma_f32_16x16x32_bf16 v[48:51], v[144:147], v[176:179], v[48:51]
    ds_read_b128 v[112:115], v44 offset:192
    v_mfma_f32_16x16x32_bf16 v[52:55], v[144:147], v[180:183], v[52:55]
    ds_read2_b32 v[80:81], v36 offset0:48 offset1:49
    v_mfma_f32_16x16x32_bf16 v[56:59], v[144:147], v[184:187], v[56:59]
    ds_read2_b32 v[82:83], v36 offset0:50 offset1:51
    v_mfma_f32_16x16x32_bf16 v[60:63], v[144:147], v[188:191], v[60:63]
    ds_read_b128 v[116:119], v44 offset:704
    v_mfma_f32_16x16x32_bf16 v[64:67], v[144:147], v[192:195], v[64:67]
    ds_read2_b32 v[84:85], v37 offset0:48 offset1:49
    v_mfma_f32_16x16x32_bf16 v[68:71], v[144:147], v[196:199], v[68:71]
    ds_read2_b32 v[86:87], v37 offset0:50 offset1:51
    v_mfma_f32_16x16x32_bf16 v[72:75], v[144:147], v[200:203], v[72:75]
    ds_read_b128 v[120:123], v44 offset:1216
    v_mfma_f32_16x16x32_bf16 v[76:79], v[144:147], v[204:207], v[76:79]
    ds_read2_b32 v[88:89], v38 offset0:48 offset1:49
    v_mfma_f32_16x16x32_bf16 v[52:55], v[148:151], v[176:179], v[52:55]
    ds_read2_b32 v[90:91], v38 offset0:50 offset1:51
    v_mfma_f32_16x16x32_bf16 v[56:59], v[148:151], v[180:183], v[56:59]
    ds_read_b128 v[124:127], v44 offset:1728
    v_mfma_f32_16x16x32_bf16 v[60:63], v[148:151], v[184:187], v[60:63]
    ds_read2_b32 v[92:93], v39 offset0:48 offset1:49
    v_mfma_f32_16x16x32_bf16 v[64:67], v[148:151], v[188:191], v[64:67]
    ds_read2_b32 v[94:95], v39 offset0:50 offset1:51
    v_mfma_f32_16x16x32_bf16 v[68:71], v[148:151], v[192:195], v[68:71]
    ds_read_b128 v[128:131], v44 offset:2240
    v_mfma_f32_16x16x32_bf16 v[72:75], v[148:151], v[196:199], v[72:75]
    ds_read2_b32 v[96:97], v40 offset0:48 offset1:49
    v_mfma_f32_16x16x32_bf16 v[76:79], v[148:151], v[200:203], v[76:79]
    ds_read2_b32 v[98:99], v40 offset0:50 offset1:51
    v_mfma_f32_16x16x32_bf16 v[56:59], v[152:155], v[176:179], v[56:59]
    ds_read_b128 v[132:135], v44 offset:2752
    v_mfma_f32_16x16x32_bf16 v[60:63], v[152:155], v[180:183], v[60:63]
    ds_read2_b32 v[100:101], v41 offset0:48 offset1:49
    v_mfma_f32_16x16x32_bf16 v[64:67], v[152:155], v[184:187], v[64:67]
    ds_read2_b32 v[102:103], v41 offset0:50 offset1:51
    v_mfma_f32_16x16x32_bf16 v[68:71], v[152:155], v[188:191], v[68:71]
    ds_read_b128 v[136:139], v44 offset:3264
    v_mfma_f32_16x16x32_bf16 v[72:75], v[152:155], v[192:195], v[72:75]
    ds_read2_b32 v[104:105], v42 offset0:48 offset1:49
    v_mfma_f32_16x16x32_bf16 v[76:79], v[152:155], v[196:199], v[76:79]
    ds_read2_b32 v[106:107], v42 offset0:50 offset1:51
    v_mfma_f32_16x16x32_bf16 v[60:63], v[156:159], v[176:179], v[60:63]
    ds_read_b128 v[140:143], v44 offset:3776
    v_mfma_f32_16x16x32_bf16 v[64:67], v[156:159], v[180:183], v[64:67]
    ds_read2_b32 v[108:109], v43 offset0:48 offset1:49
    v_mfma_f32_16x16x32_bf16 v[68:71], v[156:159], v[184:187], v[68:71]
    ds_read2_b32 v[110:111], v43 offset0:50 offset1:51
    v_mfma_f32_16x16x32_bf16 v[72:75], v[156:159], v[188:191], v[72:75]
    v_mfma_f32_16x16x32_bf16 v[76:79], v[156:159], v[192:195], v[76:79]
    v_mfma_f32_16x16x32_bf16 v[64:67], v[160:163], v[176:179], v[64:67]
    v_mfma_f32_16x16x32_bf16 v[68:71], v[160:163], v[180:183], v[68:71]
    v_mfma_f32_16x16x32_bf16 v[72:75], v[160:163], v[184:187], v[72:75]
    v_mfma_f32_16x16x32_bf16 v[76:79], v[160:163], v[188:191], v[76:79]
    v_mfma_f32_16x16x32_bf16 v[68:71], v[164:167], v[176:179], v[68:71]
    v_mfma_f32_16x16x32_bf16 v[72:75], v[164:167], v[180:183], v[72:75]
    v_mfma_f32_16x16x32_bf16 v[76:79], v[164:167], v[184:187], v[76:79]
    v_mfma_f32_16x16x32_bf16 v[72:75], v[168:171], v[176:179], v[72:75]
    v_mfma_f32_16x16x32_bf16 v[76:79], v[168:171], v[180:183], v[76:79]
    v_mfma_f32_16x16x32_bf16 v[76:79], v[172:175], v[176:179], v[76:79]
    s_waitcnt lgkmcnt(0)
    v_mfma_f32_16x16x32_bf16 v[48:51], v[80:83], v[112:115], v[48:51]
    ds_read_b128 v[176:179], v44 offset:128
    v_mfma_f32_16x16x32_bf16 v[52:55], v[80:83], v[116:119], v[52:55]
    ds_read2_b32 v[144:145], v36 offset0:32 offset1:33
    v_mfma_f32_16x16x32_bf16 v[56:59], v[80:83], v[120:123], v[56:59]
    ds_read2_b32 v[146:147], v36 offset0:34 offset1:35
    v_mfma_f32_16x16x32_bf16 v[60:63], v[80:83], v[124:127], v[60:63]
    ds_read_b128 v[180:183], v44 offset:640
    v_mfma_f32_16x16x32_bf16 v[64:67], v[80:83], v[128:131], v[64:67]
    ds_read2_b32 v[148:149], v37 offset0:32 offset1:33
    v_mfma_f32_16x16x32_bf16 v[68:71], v[80:83], v[132:135], v[68:71]
    ds_read2_b32 v[150:151], v37 offset0:34 offset1:35
    v_mfma_f32_16x16x32_bf16 v[72:75], v[80:83], v[136:139], v[72:75]
    ds_read_b128 v[184:187], v44 offset:1152
    v_mfma_f32_16x16x32_bf16 v[76:79], v[80:83], v[140:143], v[76:79]
    ds_read2_b32 v[152:153], v38 offset0:32 offset1:33
    v_mfma_f32_16x16x32_bf16 v[52:55], v[84:87], v[112:115], v[52:55]
    ds_read2_b32 v[154:155], v38 offset0:34 offset1:35
    v_mfma_f32_16x16x32_bf16 v[56:59], v[84:87], v[116:119], v[56:59]
    ds_read_b128 v[188:191], v44 offset:1664
    v_mfma_f32_16x16x32_bf16 v[60:63], v[84:87], v[120:123], v[60:63]
    ds_read2_b32 v[156:157], v39 offset0:32 offset1:33
    v_mfma_f32_16x16x32_bf16 v[64:67], v[84:87], v[124:127], v[64:67]
    ds_read2_b32 v[158:159], v39 offset0:34 offset1:35
    v_mfma_f32_16x16x32_bf16 v[68:71], v[84:87], v[128:131], v[68:71]
    ds_read_b128 v[192:195], v44 offset:2176
    v_mfma_f32_16x16x32_bf16 v[72:75], v[84:87], v[132:135], v[72:75]
    ds_read2_b32 v[160:161], v40 offset0:32 offset1:33
    v_mfma_f32_16x16x32_bf16 v[76:79], v[84:87], v[136:139], v[76:79]
    ds_read2_b32 v[162:163], v40 offset0:34 offset1:35
    v_mfma_f32_16x16x32_bf16 v[56:59], v[88:91], v[112:115], v[56:59]
    ds_read_b128 v[196:199], v44 offset:2688
    v_mfma_f32_16x16x32_bf16 v[60:63], v[88:91], v[116:119], v[60:63]
    ds_read2_b32 v[164:165], v41 offset0:32 offset1:33
    v_mfma_f32_16x16x32_bf16 v[64:67], v[88:91], v[120:123], v[64:67]
    ds_read2_b32 v[166:167], v41 offset0:34 offset1:35
    v_mfma_f32_16x16x32_bf16 v[68:71], v[88:91], v[124:127], v[68:71]
    ds_read_b128 v[200:203], v44 offset:3200
    v_mfma_f32_16x16x32_bf16 v[72:75], v[88:91], v[128:131], v[72:75]
    ds_read2_b32 v[168:169], v42 offset0:32 offset1:33
    v_mfma_f32_16x16x32_bf16 v[76:79], v[88:91], v[132:135], v[76:79]
    ds_read2_b32 v[170:171], v42 offset0:34 offset1:35
    v_mfma_f32_16x16x32_bf16 v[60:63], v[92:95], v[112:115], v[60:63]
    ds_read_b128 v[204:207], v44 offset:3712
    v_mfma_f32_16x16x32_bf16 v[64:67], v[92:95], v[116:119], v[64:67]
    ds_read2_b32 v[172:173], v43 offset0:32 offset1:33
    v_mfma_f32_16x16x32_bf16 v[68:71], v[92:95], v[120:123], v[68:71]
    ds_read2_b32 v[174:175], v43 offset0:34 offset1:35
    v_mfma_f32_16x16x32_bf16 v[72:75], v[92:95], v[124:127], v[72:75]
    v_mfma_f32_16x16x32_bf16 v[76:79], v[92:95], v[128:131], v[76:79]
    v_mfma_f32_16x16x32_bf16 v[64:67], v[96:99], v[112:115], v[64:67]
    v_mfma_f32_16x16x32_bf16 v[68:71], v[96:99], v[116:119], v[68:71]
    v_mfma_f32_16x16x32_bf16 v[72:75], v[96:99], v[120:123], v[72:75]
    v_mfma_f32_16x16x32_bf16 v[76:79], v[96:99], v[124:127], v[76:79]
    v_mfma_f32_16x16x32_bf16 v[68:71], v[100:103], v[112:115], v[68:71]
    v_mfma_f32_16x16x32_bf16 v[72:75], v[100:103], v[116:119], v[72:75]
    v_mfma_f32_16x16x32_bf16 v[76:79], v[100:103], v[120:123], v[76:79]
    v_mfma_f32_16x16x32_bf16 v[72:75], v[104:107], v[112:115], v[72:75]
    v_mfma_f32_16x16x32_bf16 v[76:79], v[104:107], v[116:119], v[76:79]
    v_mfma_f32_16x16x32_bf16 v[76:79], v[108:111], v[112:115], v[76:79]
    s_waitcnt lgkmcnt(0)
    v_mfma_f32_16x16x32_bf16 v[48:51], v[144:147], v[176:179], v[48:51]
    ds_read_b128 v[112:115], v44 offset:64
    v_mfma_f32_16x16x32_bf16 v[52:55], v[144:147], v[180:183], v[52:55]
    ds_read2_b32 v[80:81], v36 offset0:16 offset1:17
    v_mfma_f32_16x16x32_bf16 v[56:59], v[144:147], v[184:187], v[56:59]
    ds_read2_b32 v[82:83], v36 offset0:18 offset1:19
    v_mfma_f32_16x16x32_bf16 v[60:63], v[144:147], v[188:191], v[60:63]
    ds_read_b128 v[116:119], v44 offset:576
    v_mfma_f32_16x16x32_bf16 v[64:67], v[144:147], v[192:195], v[64:67]
    ds_read2_b32 v[84:85], v37 offset0:16 offset1:17
    v_mfma_f32_16x16x32_bf16 v[68:71], v[144:147], v[196:199], v[68:71]
    ds_read2_b32 v[86:87], v37 offset0:18 offset1:19
    v_mfma_f32_16x16x32_bf16 v[72:75], v[144:147], v[200:203], v[72:75]
    ds_read_b128 v[120:123], v44 offset:1088
    v_mfma_f32_16x16x32_bf16 v[76:79], v[144:147], v[204:207], v[76:79]
    ds_read2_b32 v[88:89], v38 offset0:16 offset1:17
    v_mfma_f32_16x16x32_bf16 v[52:55], v[148:151], v[176:179], v[52:55]
    ds_read2_b32 v[90:91], v38 offset0:18 offset1:19
    v_mfma_f32_16x16x32_bf16 v[56:59], v[148:151], v[180:183], v[56:59]
    ds_read_b128 v[124:127], v44 offset:1600
    v_mfma_f32_16x16x32_bf16 v[60:63], v[148:151], v[184:187], v[60:63]
    ds_read2_b32 v[92:93], v39 offset0:16 offset1:17
    v_mfma_f32_16x16x32_bf16 v[64:67], v[148:151], v[188:191], v[64:67]
    ds_read2_b32 v[94:95], v39 offset0:18 offset1:19
    v_mfma_f32_16x16x32_bf16 v[68:71], v[148:151], v[192:195], v[68:71]
    ds_read_b128 v[128:131], v44 offset:2112
    v_mfma_f32_16x16x32_bf16 v[72:75], v[148:151], v[196:199], v[72:75]
    ds_read2_b32 v[96:97], v40 offset0:16 offset1:17
    v_mfma_f32_16x16x32_bf16 v[76:79], v[148:151], v[200:203], v[76:79]
    ds_read2_b32 v[98:99], v40 offset0:18 offset1:19
    v_mfma_f32_16x16x32_bf16 v[56:59], v[152:155], v[176:179], v[56:59]
    ds_read_b128 v[132:135], v44 offset:2624
    v_mfma_f32_16x16x32_bf16 v[60:63], v[152:155], v[180:183], v[60:63]
    ds_read2_b32 v[100:101], v41 offset0:16 offset1:17
    v_mfma_f32_16x16x32_bf16 v[64:67], v[152:155], v[184:187], v[64:67]
    ds_read2_b32 v[102:103], v41 offset0:18 offset1:19
    v_mfma_f32_16x16x32_bf16 v[68:71], v[152:155], v[188:191], v[68:71]
    ds_read_b128 v[136:139], v44 offset:3136
    v_mfma_f32_16x16x32_bf16 v[72:75], v[152:155], v[192:195], v[72:75]
    ds_read2_b32 v[104:105], v42 offset0:16 offset1:17
    v_mfma_f32_16x16x32_bf16 v[76:79], v[152:155], v[196:199], v[76:79]
    ds_read2_b32 v[106:107], v42 offset0:18 offset1:19
    v_mfma_f32_16x16x32_bf16 v[60:63], v[156:159], v[176:179], v[60:63]
    ds_read_b128 v[140:143], v44 offset:3648
    v_mfma_f32_16x16x32_bf16 v[64:67], v[156:159], v[180:183], v[64:67]
    ds_read2_b32 v[108:109], v43 offset0:16 offset1:17
    v_mfma_f32_16x16x32_bf16 v[68:71], v[156:159], v[184:187], v[68:71]
    ds_read2_b32 v[110:111], v43 offset0:18 offset1:19
    v_mfma_f32_16x16x32_bf16 v[72:75], v[156:159], v[188:191], v[72:75]
    v_mfma_f32_16x16x32_bf16 v[76:79], v[156:159], v[192:195], v[76:79]
    v_mfma_f32_16x16x32_bf16 v[64:67], v[160:163], v[176:179], v[64:67]
    v_mfma_f32_16x16x32_bf16 v[68:71], v[160:163], v[180:183], v[68:71]
    v_mfma_f32_16x16x32_bf16 v[72:75], v[160:163], v[184:187], v[72:75]
    v_mfma_f32_16x16x32_bf16 v[76:79], v[160:163], v[188:191], v[76:79]
    v_mfma_f32_16x16x32_bf16 v[68:71], v[164:167], v[176:179], v[68:71]
    v_mfma_f32_16x16x32_bf16 v[72:75], v[164:167], v[180:183], v[72:75]
    v_mfma_f32_16x16x32_bf16 v[76:79], v[164:167], v[184:187], v[76:79]
    v_mfma_f32_16x16x32_bf16 v[72:75], v[168:171], v[176:179], v[72:75]
    v_mfma_f32_16x16x32_bf16 v[76:79], v[168:171], v[180:183], v[76:79]
    v_mfma_f32_16x16x32_bf16 v[76:79], v[172:175], v[176:179], v[76:79]
    s_waitcnt lgkmcnt(0)
    v_mfma_f32_16x16x32_bf16 v[48:51], v[80:83], v[112:115], v[48:51]
    ds_read_b128 v[176:179], v44 offset:0
    v_mfma_f32_16x16x32_bf16 v[52:55], v[80:83], v[116:119], v[52:55]
    ds_read2_b32 v[144:145], v36 offset0:0 offset1:1
    v_mfma_f32_16x16x32_bf16 v[56:59], v[80:83], v[120:123], v[56:59]
    ds_read2_b32 v[146:147], v36 offset0:2 offset1:3
    v_mfma_f32_16x16x32_bf16 v[60:63], v[80:83], v[124:127], v[60:63]
    ds_read_b128 v[180:183], v44 offset:512
    v_mfma_f32_16x16x32_bf16 v[64:67], v[80:83], v[128:131], v[64:67]
    ds_read2_b32 v[148:149], v37 offset0:0 offset1:1
    v_mfma_f32_16x16x32_bf16 v[68:71], v[80:83], v[132:135], v[68:71]
    ds_read2_b32 v[150:151], v37 offset0:2 offset1:3
    v_mfma_f32_16x16x32_bf16 v[72:75], v[80:83], v[136:139], v[72:75]
    ds_read_b128 v[184:187], v44 offset:1024
    v_mfma_f32_16x16x32_bf16 v[76:79], v[80:83], v[140:143], v[76:79]
    ds_read2_b32 v[152:153], v38 offset0:0 offset1:1
    v_mfma_f32_16x16x32_bf16 v[52:55], v[84:87], v[112:115], v[52:55]
    ds_read2_b32 v[154:155], v38 offset0:2 offset1:3
    v_mfma_f32_16x16x32_bf16 v[56:59], v[84:87], v[116:119], v[56:59]
    ds_read_b128 v[188:191], v44 offset:1536
    v_mfma_f32_16x16x32_bf16 v[60:63], v[84:87], v[120:123], v[60:63]
    ds_read2_b32 v[156:157], v39 offset0:0 offset1:1
    v_mfma_f32_16x16x32_bf16 v[64:67], v[84:87], v[124:127], v[64:67]
    ds_read2_b32 v[158:159], v39 offset0:2 offset1:3
    v_mfma_f32_16x16x32_bf16 v[68:71], v[84:87], v[128:131], v[68:71]
    ds_read_b128 v[192:195], v44 offset:2048
    v_mfma_f32_16x16x32_bf16 v[72:75], v[84:87], v[132:135], v[72:75]
    ds_read2_b32 v[160:161], v40 offset0:0 offset1:1
    v_mfma_f32_16x16x32_bf16 v[76:79], v[84:87], v[136:139], v[76:79]
    ds_read2_b32 v[162:163], v40 offset0:2 offset1:3
    v_mfma_f32_16x16x32_bf16 v[56:59], v[88:91], v[112:115], v[56:59]
    ds_read_b128 v[196:199], v44 offset:2560
    v_mfma_f32_16x16x32_bf16 v[60:63], v[88:91], v[116:119], v[60:63]
    ds_read2_b32 v[164:165], v41 offset0:0 offset1:1
    v_mfma_f32_16x16x32_bf16 v[64:67], v[88:91], v[120:123], v[64:67]
    ds_read2_b32 v[166:167], v41 offset0:2 offset1:3
    v_mfma_f32_16x16x32_bf16 v[68:71], v[88:91], v[124:127], v[68:71]
    ds_read_b128 v[200:203], v44 offset:3072
    v_mfma_f32_16x16x32_bf16 v[72:75], v[88:91], v[128:131], v[72:75]
    ds_read2_b32 v[168:169], v42 offset0:0 offset1:1
    v_mfma_f32_16x16x32_bf16 v[76:79], v[88:91], v[132:135], v[76:79]
    ds_read2_b32 v[170:171], v42 offset0:2 offset1:3
    v_mfma_f32_16x16x32_bf16 v[60:63], v[92:95], v[112:115], v[60:63]
    ds_read_b128 v[204:207], v44 offset:3584
    v_mfma_f32_16x16x32_bf16 v[64:67], v[92:95], v[116:119], v[64:67]
    ds_read2_b32 v[172:173], v43 offset0:0 offset1:1
    v_mfma_f32_16x16x32_bf16 v[68:71], v[92:95], v[120:123], v[68:71]
    ds_read2_b32 v[174:175], v43 offset0:2 offset1:3
    v_mfma_f32_16x16x32_bf16 v[72:75], v[92:95], v[124:127], v[72:75]
    v_mfma_f32_16x16x32_bf16 v[76:79], v[92:95], v[128:131], v[76:79]
    v_mfma_f32_16x16x32_bf16 v[64:67], v[96:99], v[112:115], v[64:67]
    v_mfma_f32_16x16x32_bf16 v[68:71], v[96:99], v[116:119], v[68:71]
    v_mfma_f32_16x16x32_bf16 v[72:75], v[96:99], v[120:123], v[72:75]
    v_mfma_f32_16x16x32_bf16 v[76:79], v[96:99], v[124:127], v[76:79]
    v_mfma_f32_16x16x32_bf16 v[68:71], v[100:103], v[112:115], v[68:71]
    v_mfma_f32_16x16x32_bf16 v[72:75], v[100:103], v[116:119], v[72:75]
    v_mfma_f32_16x16x32_bf16 v[76:79], v[100:103], v[120:123], v[76:79]
    v_mfma_f32_16x16x32_bf16 v[72:75], v[104:107], v[112:115], v[72:75]
    v_mfma_f32_16x16x32_bf16 v[76:79], v[104:107], v[116:119], v[76:79]
    v_mfma_f32_16x16x32_bf16 v[76:79], v[108:111], v[112:115], v[76:79]
    s_waitcnt lgkmcnt(0)
    v_mfma_f32_16x16x32_bf16 v[48:51], v[144:147], v[176:179], v[48:51]
    v_mfma_f32_16x16x32_bf16 v[52:55], v[144:147], v[180:183], v[52:55]
    v_mfma_f32_16x16x32_bf16 v[56:59], v[144:147], v[184:187], v[56:59]
    v_mfma_f32_16x16x32_bf16 v[60:63], v[144:147], v[188:191], v[60:63]
    v_mfma_f32_16x16x32_bf16 v[64:67], v[144:147], v[192:195], v[64:67]
    v_mfma_f32_16x16x32_bf16 v[68:71], v[144:147], v[196:199], v[68:71]
    v_mfma_f32_16x16x32_bf16 v[72:75], v[144:147], v[200:203], v[72:75]
    v_mfma_f32_16x16x32_bf16 v[76:79], v[144:147], v[204:207], v[76:79]
    v_mfma_f32_16x16x32_bf16 v[52:55], v[148:151], v[176:179], v[52:55]
    v_mfma_f32_16x16x32_bf16 v[56:59], v[148:151], v[180:183], v[56:59]
    v_mfma_f32_16x16x32_bf16 v[60:63], v[148:151], v[184:187], v[60:63]
    v_mfma_f32_16x16x32_bf16 v[64:67], v[148:151], v[188:191], v[64:67]
    v_mfma_f32_16x16x32_bf16 v[68:71], v[148:151], v[192:195], v[68:71]
    v_mfma_f32_16x16x32_bf16 v[72:75], v[148:151], v[196:199], v[72:75]
    v_mfma_f32_16x16x32_bf16 v[76:79], v[148:151], v[200:203], v[76:79]
    v_mfma_f32_16x16x32_bf16 v[56:59], v[152:155], v[176:179], v[56:59]
    v_mfma_f32_16x16x32_bf16 v[60:63], v[152:155], v[180:183], v[60:63]
    v_mfma_f32_16x16x32_bf16 v[64:67], v[152:155], v[184:187], v[64:67]
    v_mfma_f32_16x16x32_bf16 v[68:71], v[152:155], v[188:191], v[68:71]
    v_mfma_f32_16x16x32_bf16 v[72:75], v[152:155], v[192:195], v[72:75]
    v_mfma_f32_16x16x32_bf16 v[76:79], v[152:155], v[196:199], v[76:79]
    v_mfma_f32_16x16x32_bf16 v[60:63], v[156:159], v[176:179], v[60:63]
    v_mfma_f32_16x16x32_bf16 v[64:67], v[156:159], v[180:183], v[64:67]
    v_mfma_f32_16x16x32_bf16 v[68:71], v[156:159], v[184:187], v[68:71]
    v_mfma_f32_16x16x32_bf16 v[72:75], v[156:159], v[188:191], v[72:75]
    v_mfma_f32_16x16x32_bf16 v[76:79], v[156:159], v[192:195], v[76:79]
    v_mfma_f32_16x16x32_bf16 v[64:67], v[160:163], v[176:179], v[64:67]
    v_mfma_f32_16x16x32_bf16 v[68:71], v[160:163], v[180:183], v[68:71]
    v_mfma_f32_16x16x32_bf16 v[72:75], v[160:163], v[184:187], v[72:75]
    v_mfma_f32_16x16x32_bf16 v[76:79], v[160:163], v[188:191], v[76:79]
    v_mfma_f32_16x16x32_bf16 v[68:71], v[164:167], v[176:179], v[68:71]
    v_mfma_f32_16x16x32_bf16 v[72:75], v[164:167], v[180:183], v[72:75]
    v_mfma_f32_16x16x32_bf16 v[76:79], v[164:167], v[184:187], v[76:79]
    v_mfma_f32_16x16x32_bf16 v[72:75], v[168:171], v[176:179], v[72:75]
    v_mfma_f32_16x16x32_bf16 v[76:79], v[168:171], v[180:183], v[76:79]
    v_mfma_f32_16x16x32_bf16 v[76:79], v[172:175], v[176:179], v[76:79]
    s_nop 7
    v_lshlrev_b32 v5, 6, v2
    v_lshl_add_u32 v5, v3, 4, v5
    v_add_u32 v5, v5, v4
    ds_write_b128 v5, v[48:51] offset:7424
    ds_write_b128 v5, v[52:55] offset:8448
    ds_write_b128 v5, v[56:59] offset:9472
    ds_write_b128 v5, v[60:63] offset:10496
    ds_write_b128 v5, v[64:67] offset:11520
    ds_write_b128 v5, v[68:71] offset:12544
    ds_write_b128 v5, v[72:75] offset:13568
    ds_write_b128 v5, v[76:79] offset:14592
    v_mov_b64 v[8:9], v[16:17]
    v_mov_b64 v[10:11], v[18:19]
    v_mov_b64 v[12:13], v[20:21]
    v_mov_b64 v[14:15], v[22:23]
    v_mov_b32 v24, v25
    v_add_u32 v4, 65536, v4
    s_add_u32 s28, s28, 1
    s_cmp_lt_u32 s28, 2
    s_waitcnt lgkmcnt(0)
    s_cbranch_scc1 ss_pass
    s_mov_b32 s12, s74
    s_mov_b32 s13, s75
    s_mov_b32 s14, 1152
    s_mov_b32 s15, 0x20000
    s_lshl_b32 s23, s20, 1
    buffer_load_dwordx4 v[8:11], off, s[12:15], s23
    s_barrier
    v_lshlrev_b32 v5, 5, v0
    v_add_u32 v7, 65536, v5
    ds_read_b128 v[64:67], v5 offset:7424
    ds_read_b128 v[68:71], v5 offset:7440
    ds_read_b128 v[72:75], v5 offset:23808
    ds_read_b128 v[76:79], v5 offset:23824
    ds_read_b128 v[80:83], v5 offset:40192
    ds_read_b128 v[84:87], v5 offset:40208
    ds_read_b128 v[88:91], v5 offset:56576
    ds_read_b128 v[92:95], v5 offset:56592
    ds_read_b128 v[96:99], v7 offset:7424
    ds_read_b128 v[100:103], v7 offset:7440
    ds_read_b128 v[104:107], v7 offset:23808
    ds_read_b128 v[108:111], v7 offset:23824
    ds_read_b128 v[112:115], v7 offset:40192
    ds_read_b128 v[116:119], v7 offset:40208
    ds_read_b128 v[120:123], v7 offset:56576
    ds_read_b128 v[124:127], v7 offset:56592
    s_waitcnt vmcnt(0)
    v_lshlrev_b32 v12, 16, v8
    v_and_b32 v13, 0xffff0000, v8
    v_lshlrev_b32 v14, 16, v9
    v_and_b32 v15, 0xffff0000, v9
    v_lshlrev_b32 v16, 16, v10
    v_and_b32 v17, 0xffff0000, v10
    v_lshlrev_b32 v18, 16, v11
    v_and_b32 v19, 0xffff0000, v11
    v_mul_u32_u24 v5, 18432, v0
    s_lshl_b32 s22, s20, 1
    s_add_u32 s22, s22, 1152
    s_waitcnt lgkmcnt(0)
    v_lshlrev_b32 v6, 16, v208
    v_fmac_f32 v64, v6, v12
    v_and_b32 v6, 0xffff0000, v208
    v_fmac_f32 v72, v6, v13
    v_lshlrev_b32 v6, 16, v209
    v_fmac_f32 v80, v6, v14
    v_and_b32 v6, 0xffff0000, v209
    v_fmac_f32 v88, v6, v15
    v_lshlrev_b32 v6, 16, v210
    v_fmac_f32 v96, v6, v16
    v_and_b32 v6, 0xffff0000, v210
    v_fmac_f32 v104, v6, v17
    v_lshlrev_b32 v6, 16, v211
    v_fmac_f32 v112, v6, v18
    v_and_b32 v6, 0xffff0000, v211
    v_fmac_f32 v120, v6, v19
    v_cvt_pk_bf16_f32 v208, v64, v72
    v_cvt_pk_bf16_f32 v209, v80, v88
    v_cvt_pk_bf16_f32 v210, v96, v104
    v_cvt_pk_bf16_f32 v211, v112, v120
    s_add_u32 s23, s22, 0
    buffer_store_dwordx4 v[208:211], v5, s[16:19], s23 offen
    v_lshlrev_b32 v6, 16, v212
    v_fmac_f32 v65, v6, v12
    v_and_b32 v6, 0xffff0000, v212
    v_fmac_f32 v73, v6, v13
    v_lshlrev_b32 v6, 16, v213
    v_fmac_f32 v81, v6, v14
    v_and_b32 v6, 0xffff0000, v213
    v_fmac_f32 v89, v6, v15
    v_lshlrev_b32 v6, 16, v214
    v_fmac_f32 v97, v6, v16
    v_and_b32 v6, 0xffff0000, v214
    v_fmac_f32 v105, v6, v17
    v_lshlrev_b32 v6, 16, v215
    v_fmac_f32 v113, v6, v18
    v_and_b32 v6, 0xffff0000, v215
    v_fmac_f32 v121, v6, v19
    v_cvt_pk_bf16_f32 v212, v65, v73
    v_cvt_pk_bf16_f32 v213, v81, v89
    v_cvt_pk_bf16_f32 v214, v97, v105
    v_cvt_pk_bf16_f32 v215, v113, v121
    s_add_u32 s23, s22, 2304
    buffer_store_dwordx4 v[212:215], v5, s[16:19], s23 offen
    v_lshlrev_b32 v6, 16, v216
    v_fmac_f32 v66, v6, v12
    v_and_b32 v6, 0xffff0000, v216
    v_fmac_f32 v74, v6, v13
    v_lshlrev_b32 v6, 16, v217
    v_fmac_f32 v82, v6, v14
    v_and_b32 v6, 0xffff0000, v217
    v_fmac_f32 v90, v6, v15
    v_lshlrev_b32 v6, 16, v218
    v_fmac_f32 v98, v6, v16
    v_and_b32 v6, 0xffff0000, v218
    v_fmac_f32 v106, v6, v17
    v_lshlrev_b32 v6, 16, v219
    v_fmac_f32 v114, v6, v18
    v_and_b32 v6, 0xffff0000, v219
    v_fmac_f32 v122, v6, v19
    v_cvt_pk_bf16_f32 v216, v66, v74
    v_cvt_pk_bf16_f32 v217, v82, v90
    v_cvt_pk_bf16_f32 v218, v98, v106
    v_cvt_pk_bf16_f32 v219, v114, v122
    s_add_u32 s23, s22, 4608
    buffer_store_dwordx4 v[216:219], v5, s[16:19], s23 offen
    v_lshlrev_b32 v6, 16, v220
    v_fmac_f32 v67, v6, v12
    v_and_b32 v6, 0xffff0000, v220
    v_fmac_f32 v75, v6, v13
    v_lshlrev_b32 v6, 16, v221
    v_fmac_f32 v83, v6, v14
    v_and_b32 v6, 0xffff0000, v221
    v_fmac_f32 v91, v6, v15
    v_lshlrev_b32 v6, 16, v222
    v_fmac_f32 v99, v6, v16
    v_and_b32 v6, 0xffff0000, v222
    v_fmac_f32 v107, v6, v17
    v_lshlrev_b32 v6, 16, v223
    v_fmac_f32 v115, v6, v18
    v_and_b32 v6, 0xffff0000, v223
    v_fmac_f32 v123, v6, v19
    v_cvt_pk_bf16_f32 v220, v67, v75
    v_cvt_pk_bf16_f32 v221, v83, v91
    v_cvt_pk_bf16_f32 v222, v99, v107
    v_cvt_pk_bf16_f32 v223, v115, v123
    s_add_u32 s23, s22, 6912
    buffer_store_dwordx4 v[220:223], v5, s[16:19], s23 offen
    v_lshlrev_b32 v6, 16, v224
    v_fmac_f32 v68, v6, v12
    v_and_b32 v6, 0xffff0000, v224
    v_fmac_f32 v76, v6, v13
    v_lshlrev_b32 v6, 16, v225
    v_fmac_f32 v84, v6, v14
    v_and_b32 v6, 0xffff0000, v225
    v_fmac_f32 v92, v6, v15
    v_lshlrev_b32 v6, 16, v226
    v_fmac_f32 v100, v6, v16
    v_and_b32 v6, 0xffff0000, v226
    v_fmac_f32 v108, v6, v17
    v_lshlrev_b32 v6, 16, v227
    v_fmac_f32 v116, v6, v18
    v_and_b32 v6, 0xffff0000, v227
    v_fmac_f32 v124, v6, v19
    v_cvt_pk_bf16_f32 v224, v68, v76
    v_cvt_pk_bf16_f32 v225, v84, v92
    v_cvt_pk_bf16_f32 v226, v100, v108
    v_cvt_pk_bf16_f32 v227, v116, v124
    s_add_u32 s23, s22, 9216
    buffer_store_dwordx4 v[224:227], v5, s[16:19], s23 offen
    v_lshlrev_b32 v6, 16, v228
    v_fmac_f32 v69, v6, v12
    v_and_b32 v6, 0xffff0000, v228
    v_fmac_f32 v77, v6, v13
    v_lshlrev_b32 v6, 16, v229
    v_fmac_f32 v85, v6, v14
    v_and_b32 v6, 0xffff0000, v229
    v_fmac_f32 v93, v6, v15
    v_lshlrev_b32 v6, 16, v230
    v_fmac_f32 v101, v6, v16
    v_and_b32 v6, 0xffff0000, v230
    v_fmac_f32 v109, v6, v17
    v_lshlrev_b32 v6, 16, v231
    v_fmac_f32 v117, v6, v18
    v_and_b32 v6, 0xffff0000, v231
    v_fmac_f32 v125, v6, v19
    v_cvt_pk_bf16_f32 v228, v69, v77
    v_cvt_pk_bf16_f32 v229, v85, v93
    v_cvt_pk_bf16_f32 v230, v101, v109
    v_cvt_pk_bf16_f32 v231, v117, v125
    s_add_u32 s23, s22, 11520
    buffer_store_dwordx4 v[228:231], v5, s[16:19], s23 offen
    v_lshlrev_b32 v6, 16, v232
    v_fmac_f32 v70, v6, v12
    v_and_b32 v6, 0xffff0000, v232
    v_fmac_f32 v78, v6, v13
    v_lshlrev_b32 v6, 16, v233
    v_fmac_f32 v86, v6, v14
    v_and_b32 v6, 0xffff0000, v233
    v_fmac_f32 v94, v6, v15
    v_lshlrev_b32 v6, 16, v234
    v_fmac_f32 v102, v6, v16
    v_and_b32 v6, 0xffff0000, v234
    v_fmac_f32 v110, v6, v17
    v_lshlrev_b32 v6, 16, v235
    v_fmac_f32 v118, v6, v18
    v_and_b32 v6, 0xffff0000, v235
    v_fmac_f32 v126, v6, v19
    v_cvt_pk_bf16_f32 v232, v70, v78
    v_cvt_pk_bf16_f32 v233, v86, v94
    v_cvt_pk_bf16_f32 v234, v102, v110
    v_cvt_pk_bf16_f32 v235, v118, v126
    s_add_u32 s23, s22, 13824
    buffer_store_dwordx4 v[232:235], v5, s[16:19], s23 offen
    v_lshlrev_b32 v6, 16, v236
    v_fmac_f32 v71, v6, v12
    v_and_b32 v6, 0xffff0000, v236
    v_fmac_f32 v79, v6, v13
    v_lshlrev_b32 v6, 16, v237
    v_fmac_f32 v87, v6, v14
    v_and_b32 v6, 0xffff0000, v237
    v_fmac_f32 v95, v6, v15
    v_lshlrev_b32 v6, 16, v238
    v_fmac_f32 v103, v6, v16
    v_and_b32 v6, 0xffff0000, v238
    v_fmac_f32 v111, v6, v17
    v_lshlrev_b32 v6, 16, v239
    v_fmac_f32 v119, v6, v18
    v_and_b32 v6, 0xffff0000, v239
    v_fmac_f32 v127, v6, v19
    v_cvt_pk_bf16_f32 v236, v71, v79
    v_cvt_pk_bf16_f32 v237, v87, v95
    v_cvt_pk_bf16_f32 v238, v103, v111
    v_cvt_pk_bf16_f32 v239, v119, v127
    s_add_u32 s23, s22, 16128
    buffer_store_dwordx4 v[236:239], v5, s[16:19], s23 offen
    s_branch L_ssm_next
L_ssm_done:
    s_cmp_lt_u32 s93, 100
    s_cbranch_scc1 L_exit
    s_mov_b32 s8, s76
    s_mov_b32 s9, s77
    s_mov_b32 s10, 4718592
    s_mov_b32 s11, 0x20000
    s_cmp_le_u32 s45, 1
    s_cbranch_scc1 L_att_next
    s_branch L_op_nextcb
L_wf_next:
    s_mov_b32 s37, 20
    v_mov_b32 v250, 1
    v_mov_b32 v251, 163832
    v_cmp_eq_u32 vcc, 0, v0
    s_nop 0
    s_and_saveexec_b64 s[38:39], vcc
    s_cbranch_execz tk13
    buffer_atomic_add v250, off, s[84:87], s37 sc0
    s_waitcnt vmcnt(0)
    ds_write_b32 v251, v250
    s_waitcnt lgkmcnt(0)
tk13:
    s_mov_b64 exec, -1
    s_barrier
    ds_read_b32 v252, v251
    s_waitcnt lgkmcnt(0)
    v_readfirstlane_b32 s33, v252
    s_barrier
    s_nop 3
    s_cmp_ge_u32 s33, 160
    s_cbranch_scc1 L_ssm_next
    s_lshl_b32 s16, s33, 2
    s_add_u32 s16, s16, s32
    s_add_u32 s16, s16, 1504
    s_call_b64 s[46:47], L_xform
    s_cmp_lg_u32 s95, 0
    s_cbranch_scc1 L_wfn
    s_mov_b32 s88, 4194304
gn14:
    buffer_load_dword v250, off, s[84:87], 0 offset:216 sc1
    s_waitcnt vmcnt(0)
    v_readfirstlane_b32 s95, v250
    s_sub_u32 s88, s88, 1
    s_cbranch_scc1 gn14x
    s_cmp_eq_u32 s95, 0
    s_cbranch_scc1 gn14
gn14x:
L_wfn:
    s_lshl_b32 s40, s33, 2
    s_add_u32 s40, s40, 125841408
    s_waitcnt vmcnt(0)
    s_barrier
    v_mov_b32 v250, s95
    v_cmp_eq_u32 vcc, 0, v0
    s_nop 0
    s_and_saveexec_b64 s[38:39], vcc
    s_cbranch_execz fs15
    buffer_store_dword v250, off, s[4:7], s40 sc1
fs15:
    s_mov_b64 exec, -1
    s_branch L_wf_next
L_phase2:
    s_mov_b32 s40, 524288
mc2_w:
    buffer_load_dword v250, off, s[84:87], 0 offset:28 sc1
    s_waitcnt vmcnt(0)
    v_readfirstlane_b32 s41, v250
    s_nop 0
    s_cmp_lg_u32 s41, 0
    s_cbranch_scc1 mc2_known
    s_sub_u32 s40, s40, 1
    s_cbranch_scc1 mc2_force
    s_sleep 2
    s_branch mc2_w
mc2_force:
    v_mov_b32 v250, 2
    v_mov_b32 v251, 0
    s_mov_b64 exec, 1
    buffer_atomic_cmpswap v[250:251], off, s[84:87], 0 offset:28
    s_mov_b64 exec, -1
    s_waitcnt vmcnt(0)
    s_mov_b32 s40, 524288
    s_branch mc2_w
mc2_known:
    s_cmp_eq_u32 s41, 1
    s_cbranch_scc1 L_phase2b
    s_mov_b32 s37, 208
    v_mov_b32 v250, 1
    v_mov_b32 v251, 163832
    v_cmp_eq_u32 vcc, 0, v0
    s_nop 0
    s_and_saveexec_b64 s[38:39], vcc
    s_cbranch_execz tk16
    buffer_atomic_add v250, off, s[84:87], s37 sc0
    s_waitcnt vmcnt(0)
    ds_write_b32 v251, v250
    s_waitcnt lgkmcnt(0)
tk16:
    s_mov_b64 exec, -1
    s_barrier
    ds_read_b32 v252, v251
    s_waitcnt lgkmcnt(0)
    v_readfirstlane_b32 s12, v252
    s_barrier
    s_nop 3
    s_cmp_lt_u32 s12, 32
    s_cbranch_scc1 L_chain_safe
    s_sub_u32 s45, s12, 32
L_phase2b:
    s_mov_b32 s8, s76
    s_mov_b32 s9, s77
    s_mov_b32 s10, 4718592
    s_mov_b32 s11, 0x20000
    s_and_b32 s36, s45, 15
    s_bitcmp1_b32 42315, s36
    s_cbranch_scc0 L_nots
    s_cmp_eq_u32 s93, 500
    s_cbranch_scc1 L_ssm_next
    s_branch L_wf_next
L_nots:
    s_bitcmp1_b32 18576, s36
    s_cbranch_scc0 L_att_next
    s_bfm_b32 s37, s36, 0
    s_and_b32 s37, s37, 18576
    s_bcnt1_i32_b32 s37, s37
    s_lshr_b32 s40, s45, 4
    s_mul_i32 s40, s40, 4
    s_add_u32 s33, s40, s37
L_op_mod:
    s_mul_hi_u32 s41, s33, 0x0e38e38f
    s_mul_i32 s41, s41, 18
    s_sub_u32 s33, s33, s41
    s_branch L_op_start
L_att_next:
    s_mov_b32 s37, 16
    v_mov_b32 v250, 1
    v_mov_b32 v251, 163832
    v_cmp_eq_u32 vcc, 0, v0
    s_nop 0
    s_and_saveexec_b64 s[38:39], vcc
    s_cbranch_execz tk17
    buffer_atomic_add v250, off, s[84:87], s37 sc0
    s_waitcnt vmcnt(0)
    ds_write_b32 v251, v250
    s_waitcnt lgkmcnt(0)
tk17:
    s_mov_b64 exec, -1
    s_barrier
    ds_read_b32 v252, v251
    s_waitcnt lgkmcnt(0)
    v_readfirstlane_b32 s34, v252
    s_barrier
    s_nop 3
    s_cmp_ge_u32 s34, 512
    s_cbranch_scc1 L_op_nextcb
    s_lshr_b32 s16, s34, 3
    s_and_b32 s17, s34, 7
    s_lshl_b32 s17, s17, 2
    s_add_u32 s17, s17, s32
    s_lshl_b32 s36, s17, 7
    s_add_u32 s36, s36, 125829120
    s_lshr_b32 s41, s16, 2
    s_add_u32 s41, s41, s95
    s_add_u32 s41, s41, 1
    v_and_b32 v1, 3, v0
    v_min_u32 v1, 2, v1
    v_lshlrev_b32 v2, 4, v1
    s_and_b32 s37, s16, 3
    s_lshl_b32 s37, s37, 2
    v_add_u32 v2, s37, v2
    s_mov_b32 s40, 4194304
L_aw1:
    buffer_load_dword v3, v2, s[4:7], s36 offen sc1
    s_sub_u32 s40, s40, 1
    s_cbranch_scc1 L_aw1_go
    s_waitcnt vmcnt(0)
    v_subrev_u32 v3, s41, v3
    v_cmp_lt_u32 vcc, 64, v3
    s_cbranch_vccz L_aw1_go
    s_sleep 4
    s_branch L_aw1
L_aw1_go:
    v_and_b32 v5, 63, v0
    v_lshlrev_b32 v1, 4, v5
    s_cmp_ge_u32 s16, 56
    s_cselect_b32 s18, -1, 511
    v_and_b32 v2, s18, v1
    v_or_b32 v3, 128, v1
    v_lshrrev_b32 v4, 4, v5
    v_bfe_u32 v6, v5, 2, 2
    v_sub_u32 v4, v6, v4
    v_lshlrev_b32 v4, 3, v4
    v_and_b32 v6, 3, v5
    v_add_u32 v4, v4, v6
    v_mov_b32 v6, 0xf149f2ca
    s_mov_b32 s22, 0x3e0293ee
    s_lshl_b32 s18, s16, 5
    s_add_u32 s18, s18, s17
    s_lshl_b32 s19, s18, 13
    s_add_u32 s20, s19, 33554432
    buffer_load_dwordx4 v[8:11], v1, s[4:7], s20 offen offset:0 sc1
    s_add_u32 s20, s19, 33554432
    buffer_load_dwordx4 v[12:15], v1, s[4:7], s20 offen offset:1024 sc1
    s_add_u32 s20, s19, 33554432
    buffer_load_dwordx4 v[16:19], v1, s[4:7], s20 offen offset:2048 sc1
    s_add_u32 s20, s19, 33554432
    buffer_load_dwordx4 v[20:23], v1, s[4:7], s20 offen offset:3072 sc1
    s_add_u32 s20, s19, 33558528
    buffer_load_dwordx4 v[24:27], v1, s[4:7], s20 offen offset:0 sc1
    s_add_u32 s20, s19, 33558528
    buffer_load_dwordx4 v[28:31], v1, s[4:7], s20 offen offset:1024 sc1
    s_add_u32 s20, s19, 33558528
    buffer_load_dwordx4 v[32:35], v1, s[4:7], s20 offen offset:2048 sc1
    s_add_u32 s20, s19, 33558528
    buffer_load_dwordx4 v[36:39], v1, s[4:7], s20 offen offset:3072 sc1
    s_lshl_b32 s21, s18, 14
    s_add_u32 s20, s21, 0
    buffer_load_dwordx4 v[40:43], v1, s[4:7], s20 offen offset:0 sc1
    s_add_u32 s20, s21, 4096
    buffer_load_dwordx4 v[44:47], v1, s[4:7], s20 offen offset:0 sc1
    s_add_u32 s20, s21, 8192
    buffer_load_dwordx4 v[48:51], v1, s[4:7], s20 offen offset:0 sc1
    s_add_u32 s20, s21, 12288
    buffer_load_dwordx4 v[52:55], v1, s[4:7], s20 offen offset:0 sc1
    s_add_u32 s20, s21, 0
    buffer_load_dwordx4 v[56:59], v1, s[4:7], s20 offen offset:1024 sc1
    s_add_u32 s20, s21, 4096
    buffer_load_dwordx4 v[60:63], v1, s[4:7], s20 offen offset:1024 sc1
    s_add_u32 s20, s21, 8192
    buffer_load_dwordx4 v[64:67], v1, s[4:7], s20 offen offset:1024 sc1
    s_add_u32 s20, s21, 12288
    buffer_load_dwordx4 v[68:71], v1, s[4:7], s20 offen offset:1024 sc1
    s_add_u32 s20, s21, 0
    buffer_load_dwordx4 v[88:91], v1, s[4:7], s20 offen offset:2048 sc1
    s_add_u32 s20, s21, 4096
    buffer_load_dwordx4 v[92:95], v1, s[4:7], s20 offen offset:2048 sc1
    s_add_u32 s20, s21, 8192
    buffer_load_dwordx4 v[96:99], v1, s[4:7], s20 offen offset:2048 sc1
    s_add_u32 s20, s21, 12288
    buffer_load_dwordx4 v[100:103], v1, s[4:7], s20 offen offset:2048 sc1
    s_add_u32 s20, s21, 0
    buffer_load_dwordx4 v[104:107], v1, s[4:7], s20 offen offset:3072 sc1
    s_add_u32 s20, s21, 4096
    buffer_load_dwordx4 v[108:111], v1, s[4:7], s20 offen offset:3072 sc1
    s_add_u32 s20, s21, 8192
    buffer_load_dwordx4 v[112:115], v1, s[4:7], s20 offen offset:3072 sc1
    s_add_u32 s20, s21, 12288
    buffer_load_dwordx4 v[116:119], v1, s[4:7], s20 offen offset:3072 sc1
    v_mov_b32 v172, 0x3f803f80
    v_mov_b32 v173, 0x3f803f80
    v_mov_b32 v174, 0x3f803f80
    v_mov_b32 v175, 0x3f803f80
    v_mov_b32 v176, 0x3f003f00
    v_mov_b32 v177, 0x3f003f00
    s_waitcnt vmcnt(8)
    v_mfma_f32_16x16x32_bf16 v[136:139], v[40:43], v[8:11], 0
    v_mfma_f32_16x16x32_bf16 v[140:143], v[56:59], v[8:11], 0
    v_mfma_f32_16x16x32_bf16 v[148:151], v[40:43], v[24:27], 0
    v_mfma_f32_16x16x32_bf16 v[152:155], v[56:59], v[24:27], 0
    v_mfma_f32_16x16x32_bf16 v[136:139], v[44:47], v[12:15], v[136:139]
    v_mfma_f32_16x16x32_bf16 v[140:143], v[60:63], v[12:15], v[140:143]
    v_mfma_f32_16x16x32_bf16 v[148:151], v[44:47], v[28:31], v[148:151]
    v_mfma_f32_16x16x32_bf16 v[152:155], v[60:63], v[28:31], v[152:155]
    v_mfma_f32_16x16x32_bf16 v[136:139], v[48:51], v[16:19], v[136:139]
    v_mfma_f32_16x16x32_bf16 v[140:143], v[64:67], v[16:19], v[140:143]
    v_mfma_f32_16x16x32_bf16 v[148:151], v[48:51], v[32:35], v[148:151]
    v_mfma_f32_16x16x32_bf16 v[152:155], v[64:67], v[32:35], v[152:155]
    v_mfma_f32_16x16x32_bf16 v[136:139], v[52:55], v[20:23], v[136:139]
    v_mfma_f32_16x16x32_bf16 v[140:143], v[68:71], v[20:23], v[140:143]
    v_mfma_f32_16x16x32_bf16 v[148:151], v[52:55], v[36:39], v[148:151]
    v_mfma_f32_16x16x32_bf16 v[152:155], v[68:71], v[36:39], v[152:155]
    v_cmp_le_i32 vcc, 0, v4
    s_nop 3
    v_cndmask_b32 v136, v6, v136, vcc
    v_cmp_le_i32 vcc, 1, v4
    s_nop 1
    v_cndmask_b32 v137, v6, v137, vcc
    v_cmp_le_i32 vcc, 2, v4
    s_nop 1
    v_cndmask_b32 v138, v6, v138, vcc
    v_cmp_le_i32 vcc, 3, v4
    s_nop 1
    v_cndmask_b32 v139, v6, v139, vcc
    v_cmp_le_i32 vcc, 4, v4
    s_nop 1
    v_cndmask_b32 v140, v6, v140, vcc
    v_cmp_le_i32 vcc, 5, v4
    s_nop 1
    v_cndmask_b32 v141, v6, v141, vcc
    v_cmp_le_i32 vcc, 6, v4
    s_nop 1
    v_cndmask_b32 v142, v6, v142, vcc
    v_cmp_le_i32 vcc, 7, v4
    s_nop 1
    v_cndmask_b32 v143, v6, v143, vcc
    v_cmp_le_i32 vcc, -4, v4
    s_nop 1
    v_cndmask_b32 v148, v6, v148, vcc
    v_cmp_le_i32 vcc, -3, v4
    s_nop 1
    v_cndmask_b32 v149, v6, v149, vcc
    v_cmp_le_i32 vcc, -2, v4
    s_nop 1
    v_cndmask_b32 v150, v6, v150, vcc
    v_cmp_le_i32 vcc, -1, v4
    s_nop 1
    v_cndmask_b32 v151, v6, v151, vcc
    v_cmp_le_i32 vcc, 0, v4
    s_nop 1
    v_cndmask_b32 v152, v6, v152, vcc
    v_cmp_le_i32 vcc, 1, v4
    s_nop 1
    v_cndmask_b32 v153, v6, v153, vcc
    v_cmp_le_i32 vcc, 2, v4
    s_nop 1
    v_cndmask_b32 v154, v6, v154, vcc
    v_cmp_le_i32 vcc, 3, v4
    s_nop 1
    v_cndmask_b32 v155, v6, v155, vcc
    s_nop 1
    v_and_b32 v198, 1, v0
    v_lshlrev_b32 v198, 2, v198
    v_add_u32 v198, 48, v198
    s_add_u32 s41, s16, s95
    s_add_u32 s41, s41, 1
    s_cmp_lt_u32 s16, 56
    s_cbranch_scc1 L_amk
    v_mov_b32 v198, 16384
    s_sub_u32 s41, s41, 1
    s_mov_b32 s44, 8
L_amk:
    s_sub_u32 s43, s41, s95
    s_sub_u32 s43, s43, 1
    s_mov_b32 s88, 65536
    s_mov_b32 s89, 125853696
cw18:
    buffer_load_dword v199, off, s[4:7], s89 sc1
    s_waitcnt vmcnt(0)
    v_readfirstlane_b32 s42, v199
    s_nop 0
    s_sub_u32 s42, s42, s95
    s_cmp_gt_u32 s42, 64
    s_cselect_b32 s42, 0, s42
    s_add_u32 s42, s42, 1
    s_cmp_ge_u32 s42, s43
    s_cbranch_scc1 cw18x
    s_sub_u32 s88, s88, 1
    s_cbranch_scc1 cw18x
    s_sub_u32 s42, s43, s42
    s_min_u32 s42, s42, 6
cw18s:
    s_sleep 24
    s_sub_u32 s42, s42, 1
    s_cmp_lg_u32 s42, 0
    s_cbranch_scc1 cw18s
    s_branch cw18
cw18x:
    s_mov_b32 s40, 4194304
L_aw2:
    buffer_load_dword v199, v198, s[4:7], s36 offen sc1
    s_sub_u32 s40, s40, 1
    s_cbranch_scc1 L_aw2_go
    s_waitcnt vmcnt(0)
    v_subrev_u32 v199, s41, v199
    v_cmp_lt_u32 vcc, 64, v199
    s_cbranch_vccz L_aw2_go
    s_sleep 1
    s_branch L_aw2
L_aw2_go:
at_ldm:
    s_lshl_b32 s20, s18, 12
    s_add_u32 s20, s20, 69206016
    buffer_load_dwordx4 v[72:75], v3, s[4:7], s20 offen offset:0 sc1
    buffer_load_dwordx4 v[76:79], v3, s[4:7], s20 offen offset:1024 sc1
    buffer_load_dwordx4 v[80:83], v3, s[4:7], s20 offen offset:2048 sc1
    buffer_load_dwordx4 v[84:87], v3, s[4:7], s20 offen offset:3072 sc1
    s_lshl_b32 s20, s18, 12
    s_add_u32 s20, s20, 77594624
    buffer_load_dwordx4 v[120:123], v2, s[4:7], s20 offen offset:0 sc1
    buffer_load_dwordx4 v[124:127], v2, s[4:7], s20 offen offset:1024 sc1
    buffer_load_dwordx4 v[128:131], v2, s[4:7], s20 offen offset:2048 sc1
    buffer_load_dwordx4 v[132:135], v2, s[4:7], s20 offen offset:3072 sc1
    s_cmp_lt_u32 s16, 56
    s_cbranch_scc1 at_ok
    s_waitcnt vmcnt(0)
    v_max_u32 v196, v72, v73
    v_max3_u32 v196, v196, v74, v75
    v_max3_u32 v196, v196, v76, v77
    v_max3_u32 v196, v196, v78, v79
    v_max3_u32 v196, v196, v80, v81
    v_max3_u32 v196, v196, v82, v83
    v_max3_u32 v196, v196, v84, v85
    v_max3_u32 v196, v196, v86, v87
    v_max3_u32 v196, v196, v120, v121
    v_max3_u32 v196, v196, v122, v123
    v_max3_u32 v196, v196, v124, v125
    v_max3_u32 v196, v196, v126, v127
    v_max3_u32 v196, v196, v128, v129
    v_max3_u32 v196, v196, v130, v131
    v_max3_u32 v196, v196, v132, v133
    v_max3_u32 v196, v196, v134, v135
    v_cmp_eq_u32 vcc, -1, v196
    s_cbranch_vccz at_ok
    s_sub_u32 s44, s44, 1
    s_cbranch_scc1 at_ok
    s_cmp_lg_u32 s44, 0
    s_cbranch_scc1 at_ldm
    s_add_u32 s41, s41, 1
    s_mov_b32 s40, 4194304
L_aw3:
    buffer_load_dword v199, v198, s[4:7], s36 offen sc1
    s_sub_u32 s40, s40, 1
    s_cbranch_scc1 L_aw3_go
    s_waitcnt vmcnt(0)
    v_subrev_u32 v199, s41, v199
    v_cmp_lt_u32 vcc, 64, v199
    s_cbranch_vccz L_aw3_go
    s_sleep 1
    s_branch L_aw3
L_aw3_go:
    s_branch at_ldm
at_ok:
    s_waitcnt vmcnt(4)
    v_mfma_f32_16x16x32_bf16 v[144:147], v[72:75], v[8:11], 0
    v_mfma_f32_16x16x32_bf16 v[156:159], v[72:75], v[24:27], 0
    v_mfma_f32_16x16x32_bf16 v[144:147], v[76:79], v[12:15], v[144:147]
    v_mfma_f32_16x16x32_bf16 v[156:159], v[76:79], v[28:31], v[156:159]
    v_mfma_f32_16x16x32_bf16 v[144:147], v[80:83], v[16:19], v[144:147]
    v_mfma_f32_16x16x32_bf16 v[156:159], v[80:83], v[32:35], v[156:159]
    v_mfma_f32_16x16x32_bf16 v[144:147], v[84:87], v[20:23], v[144:147]
    v_mfma_f32_16x16x32_bf16 v[156:159], v[84:87], v[36:39], v[156:159]
    v_max3_f32 v196, v136, v137, v138
    v_max3_f32 v197, v139, v140, v141
    v_max3_f32 v196, v196, v142, v143
    s_nop 3
    v_max3_f32 v197, v197, v144, v145
    v_max3_f32 v196, v196, v146, v147
    v_max_f32 v196, v196, v197
    v_mov_b32 v197, v196
    s_nop 1
    v_permlane32_swap_b32 v196, v197
    v_max_f32 v196, v196, v197
    v_mov_b32 v197, v196
    s_nop 1
    v_permlane16_swap_b32 v196, v197
    v_max_f32 v196, v196, v197
    v_mul_f32 v196, s22, v196
    v_pk_fma_f32 v[136:137], v[136:137], s[22:23], v[196:197] op_sel_hi:[1,0,0] neg_lo:[0,0,1] neg_hi:[0,0,1]
    v_pk_fma_f32 v[138:139], v[138:139], s[22:23], v[196:197] op_sel_hi:[1,0,0] neg_lo:[0,0,1] neg_hi:[0,0,1]
    v_pk_fma_f32 v[140:141], v[140:141], s[22:23], v[196:197] op_sel_hi:[1,0,0] neg_lo:[0,0,1] neg_hi:[0,0,1]
    v_pk_fma_f32 v[142:143], v[142:143], s[22:23], v[196:197] op_sel_hi:[1,0,0] neg_lo:[0,0,1] neg_hi:[0,0,1]
    v_pk_fma_f32 v[144:145], v[144:145], s[22:23], v[196:197] op_sel_hi:[1,0,0] neg_lo:[0,0,1] neg_hi:[0,0,1]
    v_pk_fma_f32 v[146:147], v[146:147], s[22:23], v[196:197] op_sel_hi:[1,0,0] neg_lo:[0,0,1] neg_hi:[0,0,1]
    v_exp_f32 v136, v136
    v_exp_f32 v137, v137
    v_exp_f32 v138, v138
    v_exp_f32 v139, v139
    v_exp_f32 v140, v140
    v_exp_f32 v141, v141
    v_exp_f32 v142, v142
    v_exp_f32 v143, v143
    v_exp_f32 v144, v144
    v_exp_f32 v145, v145
    v_exp_f32 v146, v146
    v_exp_f32 v147, v147
    v_cvt_pk_bf16_f32 v160, v136, v137
    v_cvt_pk_bf16_f32 v161, v138, v139
    v_cvt_pk_bf16_f32 v162, v140, v141
    v_cvt_pk_bf16_f32 v163, v142, v143
    v_cvt_pk_bf16_f32 v164, v144, v145
    v_cvt_pk_bf16_f32 v165, v146, v147
    v_max3_f32 v196, v148, v149, v150
    v_max3_f32 v197, v151, v152, v153
    v_max3_f32 v196, v196, v154, v155
    v_max3_f32 v197, v197, v156, v157
    v_max3_f32 v196, v196, v158, v159
    v_max_f32 v196, v196, v197
    v_mov_b32 v197, v196
    s_nop 1
    v_permlane32_swap_b32 v196, v197
    v_max_f32 v196, v196, v197
    v_mov_b32 v197, v196
    s_nop 1
    v_permlane16_swap_b32 v196, v197
    v_max_f32 v196, v196, v197
    v_mul_f32 v196, s22, v196
    v_pk_fma_f32 v[148:149], v[148:149], s[22:23], v[196:197] op_sel_hi:[1,0,0] neg_lo:[0,0,1] neg_hi:[0,0,1]
    v_pk_fma_f32 v[150:151], v[150:151], s[22:23], v[196:197] op_sel_hi:[1,0,0] neg_lo:[0,0,1] neg_hi:[0,0,1]
    v_pk_fma_f32 v[152:153], v[152:153], s[22:23], v[196:197] op_sel_hi:[1,0,0] neg_lo:[0,0,1] neg_hi:[0,0,1]
    v_pk_fma_f32 v[154:155], v[154:155], s[22:23], v[196:197] op_sel_hi:[1,0,0] neg_lo:[0,0,1] neg_hi:[0,0,1]
    v_pk_fma_f32 v[156:157], v[156:157], s[22:23], v[196:197] op_sel_hi:[1,0,0] neg_lo:[0,0,1] neg_hi:[0,0,1]
    v_pk_fma_f32 v[158:159], v[158:159], s[22:23], v[196:197] op_sel_hi:[1,0,0] neg_lo:[0,0,1] neg_hi:[0,0,1]
    v_exp_f32 v148, v148
    v_exp_f32 v149, v149
    v_exp_f32 v150, v150
    v_exp_f32 v151, v151
    v_exp_f32 v152, v152
    v_exp_f32 v153, v153
    v_exp_f32 v154, v154
    v_exp_f32 v155, v155
    v_exp_f32 v156, v156
    v_exp_f32 v157, v157
    v_exp_f32 v158, v158
    v_exp_f32 v159, v159
    v_cvt_pk_bf16_f32 v166, v148, v149
    v_cvt_pk_bf16_f32 v167, v150, v151
    v_cvt_pk_bf16_f32 v168, v152, v153
    v_cvt_pk_bf16_f32 v169, v154, v155
    v_cvt_pk_bf16_f32 v170, v156, v157
    v_cvt_pk_bf16_f32 v171, v158, v159
    v_mfma_f32_16x16x32_bf16 v[180:183], v[172:175], v[160:163], 0
    v_mfma_f32_16x16x32_bf16 v[184:187], v[172:175], v[166:169], 0
    s_nop 4
    v_mfma_f32_16x16x16_bf16 v[180:183], v[176:177], v[164:165], v[180:183]
    v_mfma_f32_16x16x16_bf16 v[184:187], v[176:177], v[170:171], v[184:187]
    s_nop 6
    v_rcp_f32 v180, v180
    v_rcp_f32 v184, v184
    s_waitcnt vmcnt(0)
    s_lshl_b32 s18, s16, 18
    s_lshl_b32 s19, s17, 12
    s_add_u32 s18, s18, s19
    s_add_u32 s18, s18, 50331648
    s_add_u32 s19, s18, 131072
    v_mfma_f32_16x16x32_bf16 v[8:11], v[88:91], v[160:163], 0
    v_mfma_f32_16x16x32_bf16 v[12:15], v[104:107], v[160:163], 0
    v_mfma_f32_16x16x32_bf16 v[16:19], v[88:91], v[166:169], 0
    v_mfma_f32_16x16x32_bf16 v[20:23], v[104:107], v[166:169], 0
    v_mfma_f32_16x16x32_bf16 v[24:27], v[92:95], v[160:163], 0
    v_mfma_f32_16x16x32_bf16 v[28:31], v[108:111], v[160:163], 0
    v_mfma_f32_16x16x32_bf16 v[32:35], v[92:95], v[166:169], 0
    v_mfma_f32_16x16x32_bf16 v[36:39], v[108:111], v[166:169], 0
    v_mfma_f32_16x16x32_bf16 v[40:43], v[96:99], v[160:163], 0
    v_mfma_f32_16x16x32_bf16 v[44:47], v[112:115], v[160:163], 0
    v_mfma_f32_16x16x32_bf16 v[48:51], v[96:99], v[166:169], 0
    v_mfma_f32_16x16x32_bf16 v[52:55], v[112:115], v[166:169], 0
    v_mfma_f32_16x16x32_bf16 v[56:59], v[100:103], v[160:163], 0
    v_mfma_f32_16x16x32_bf16 v[60:63], v[116:119], v[160:163], 0
    v_mfma_f32_16x16x32_bf16 v[64:67], v[100:103], v[166:169], 0
    v_mfma_f32_16x16x32_bf16 v[68:71], v[116:119], v[166:169], 0
    v_mfma_f32_16x16x16_bf16 v[8:11], v[120:121], v[164:165], v[8:11]
    v_mfma_f32_16x16x16_bf16 v[12:15], v[122:123], v[164:165], v[12:15]
    v_mfma_f32_16x16x16_bf16 v[16:19], v[120:121], v[170:171], v[16:19]
    v_mfma_f32_16x16x16_bf16 v[20:23], v[122:123], v[170:171], v[20:23]
    v_mfma_f32_16x16x16_bf16 v[24:27], v[124:125], v[164:165], v[24:27]
    v_mfma_f32_16x16x16_bf16 v[28:31], v[126:127], v[164:165], v[28:31]
    v_mfma_f32_16x16x16_bf16 v[32:35], v[124:125], v[170:171], v[32:35]
    v_mfma_f32_16x16x16_bf16 v[36:39], v[126:127], v[170:171], v[36:39]
    v_mfma_f32_16x16x16_bf16 v[40:43], v[128:129], v[164:165], v[40:43]
    v_mfma_f32_16x16x16_bf16 v[44:47], v[130:131], v[164:165], v[44:47]
    v_mfma_f32_16x16x16_bf16 v[48:51], v[128:129], v[170:171], v[48:51]
    v_mfma_f32_16x16x16_bf16 v[52:55], v[130:131], v[170:171], v[52:55]
    v_mfma_f32_16x16x16_bf16 v[56:59], v[132:133], v[164:165], v[56:59]
    v_mfma_f32_16x16x16_bf16 v[60:63], v[134:135], v[164:165], v[60:63]
    v_mfma_f32_16x16x16_bf16 v[64:67], v[132:133], v[170:171], v[64:67]
    v_mfma_f32_16x16x16_bf16 v[68:71], v[134:135], v[170:171], v[68:71]
    v_pk_mul_f32 v[8:9], v[8:9], v[180:181] op_sel_hi:[1,0]
    v_pk_mul_f32 v[10:11], v[10:11], v[180:181] op_sel_hi:[1,0]
    v_pk_mul_f32 v[12:13], v[12:13], v[180:181] op_sel_hi:[1,0]
    v_pk_mul_f32 v[14:15], v[14:15], v[180:181] op_sel_hi:[1,0]
    v_cvt_pk_bf16_f32 v8, v8, v9
    v_cvt_pk_bf16_f32 v9, v10, v11
    v_cvt_pk_bf16_f32 v10, v12, v13
    v_cvt_pk_bf16_f32 v11, v14, v15
    buffer_store_dwordx4 v[8:11], v1, s[4:7], s18 offen offset:0 sc1
    v_pk_mul_f32 v[16:17], v[16:17], v[184:185] op_sel_hi:[1,0]
    v_pk_mul_f32 v[18:19], v[18:19], v[184:185] op_sel_hi:[1,0]
    v_pk_mul_f32 v[20:21], v[20:21], v[184:185] op_sel_hi:[1,0]
    v_pk_mul_f32 v[22:23], v[22:23], v[184:185] op_sel_hi:[1,0]
    v_cvt_pk_bf16_f32 v16, v16, v17
    v_cvt_pk_bf16_f32 v17, v18, v19
    v_cvt_pk_bf16_f32 v18, v20, v21
    v_cvt_pk_bf16_f32 v19, v22, v23
    buffer_store_dwordx4 v[16:19], v1, s[4:7], s19 offen offset:0 sc1
    v_pk_mul_f32 v[24:25], v[24:25], v[180:181] op_sel_hi:[1,0]
    v_pk_mul_f32 v[26:27], v[26:27], v[180:181] op_sel_hi:[1,0]
    v_pk_mul_f32 v[28:29], v[28:29], v[180:181] op_sel_hi:[1,0]
    v_pk_mul_f32 v[30:31], v[30:31], v[180:181] op_sel_hi:[1,0]
    v_cvt_pk_bf16_f32 v24, v24, v25
    v_cvt_pk_bf16_f32 v25, v26, v27
    v_cvt_pk_bf16_f32 v26, v28, v29
    v_cvt_pk_bf16_f32 v27, v30, v31
    buffer_store_dwordx4 v[24:27], v1, s[4:7], s18 offen offset:1024 sc1
    v_pk_mul_f32 v[32:33], v[32:33], v[184:185] op_sel_hi:[1,0]
    v_pk_mul_f32 v[34:35], v[34:35], v[184:185] op_sel_hi:[1,0]
    v_pk_mul_f32 v[36:37], v[36:37], v[184:185] op_sel_hi:[1,0]
    v_pk_mul_f32 v[38:39], v[38:39], v[184:185] op_sel_hi:[1,0]
    v_cvt_pk_bf16_f32 v32, v32, v33
    v_cvt_pk_bf16_f32 v33, v34, v35
    v_cvt_pk_bf16_f32 v34, v36, v37
    v_cvt_pk_bf16_f32 v35, v38, v39
    buffer_store_dwordx4 v[32:35], v1, s[4:7], s19 offen offset:1024 sc1
    v_pk_mul_f32 v[40:41], v[40:41], v[180:181] op_sel_hi:[1,0]
    v_pk_mul_f32 v[42:43], v[42:43], v[180:181] op_sel_hi:[1,0]
    v_pk_mul_f32 v[44:45], v[44:45], v[180:181] op_sel_hi:[1,0]
    v_pk_mul_f32 v[46:47], v[46:47], v[180:181] op_sel_hi:[1,0]
    v_cvt_pk_bf16_f32 v40, v40, v41
    v_cvt_pk_bf16_f32 v41, v42, v43
    v_cvt_pk_bf16_f32 v42, v44, v45
    v_cvt_pk_bf16_f32 v43, v46, v47
    buffer_store_dwordx4 v[40:43], v1, s[4:7], s18 offen offset:2048 sc1
    v_pk_mul_f32 v[48:49], v[48:49], v[184:185] op_sel_hi:[1,0]
    v_pk_mul_f32 v[50:51], v[50:51], v[184:185] op_sel_hi:[1,0]
    v_pk_mul_f32 v[52:53], v[52:53], v[184:185] op_sel_hi:[1,0]
    v_pk_mul_f32 v[54:55], v[54:55], v[184:185] op_sel_hi:[1,0]
    v_cvt_pk_bf16_f32 v48, v48, v49
    v_cvt_pk_bf16_f32 v49, v50, v51
    v_cvt_pk_bf16_f32 v50, v52, v53
    v_cvt_pk_bf16_f32 v51, v54, v55
    buffer_store_dwordx4 v[48:51], v1, s[4:7], s19 offen offset:2048 sc1
    v_pk_mul_f32 v[56:57], v[56:57], v[180:181] op_sel_hi:[1,0]
    v_pk_mul_f32 v[58:59], v[58:59], v[180:181] op_sel_hi:[1,0]
    v_pk_mul_f32 v[60:61], v[60:61], v[180:181] op_sel_hi:[1,0]
    v_pk_mul_f32 v[62:63], v[62:63], v[180:181] op_sel_hi:[1,0]
    v_cvt_pk_bf16_f32 v56, v56, v57
    v_cvt_pk_bf16_f32 v57, v58, v59
    v_cvt_pk_bf16_f32 v58, v60, v61
    v_cvt_pk_bf16_f32 v59, v62, v63
    buffer_store_dwordx4 v[56:59], v1, s[4:7], s18 offen offset:3072 sc1
    v_pk_mul_f32 v[64:65], v[64:65], v[184:185] op_sel_hi:[1,0]
    v_pk_mul_f32 v[66:67], v[66:67], v[184:185] op_sel_hi:[1,0]
    v_pk_mul_f32 v[68:69], v[68:69], v[184:185] op_sel_hi:[1,0]
    v_pk_mul_f32 v[70:71], v[70:71], v[184:185] op_sel_hi:[1,0]
    v_cvt_pk_bf16_f32 v64, v64, v65
    v_cvt_pk_bf16_f32 v65, v66, v67
    v_cvt_pk_bf16_f32 v66, v68, v69
    v_cvt_pk_bf16_f32 v67, v70, v71
    buffer_store_dwordx4 v[64:67], v1, s[4:7], s19 offen offset:3072 sc1
    s_lshr_b32 s40, s34, 1
    s_lshl_b32 s40, s40, 7
    s_and_b32 s41, s34, 1
    s_lshl_b32 s41, s41, 2
    s_add_u32 s40, s40, s41
    s_add_u32 s40, s40, 125894656
    s_cmp_lt_u32 s16, 62
    s_cbranch_scc1 L_noef
    s_lshr_b32 s42, s34, 1
    s_mul_i32 s42, s42, 4096
    s_add_u32 s41, s41, s42
    s_add_u32 s41, s41, 124944384
    s_barrier
    s_cmp_lg_u32 s32, 0
    s_cbranch_scc1 L_noef
    v_mov_b32 v250, s95
    v_lshlrev_b32 v251, 7, v0
    s_mov_b64 exec, 262143
    buffer_store_dword v250, v251, s[4:7], s41 offen sc1
    s_mov_b64 exec, -1
L_noef:
    s_waitcnt vmcnt(0)
    s_barrier
    v_mov_b32 v250, s95
    v_cmp_eq_u32 vcc, 0, v0
    s_nop 0
    s_and_saveexec_b64 s[38:39], vcc
    s_cbranch_execz fs19
    buffer_store_dword v250, off, s[4:7], s40 sc1
fs19:
    s_mov_b64 exec, -1
    s_branch L_att_next
L_op_start:
    s_lshl_b32 s35, s33, 2
    s_add_u32 s35, s35, 136
    s_lshr_b32 s89, s33, 2
    s_lshl_b32 s89, s89, 7
    s_add_u32 s89, s89, 125841408
    v_mbcnt_lo_u32_b32 v2, -1, 0
    v_mbcnt_hi_u32_b32 v2, -1, v2
    v_min_u32 v2, 31, v2
    v_lshlrev_b32 v2, 2, v2
    s_mov_b32 s88, 4194304
fw20:
    buffer_load_dword v3, v2, s[4:7], s89 offen offset:0 sc1
    s_sub_u32 s88, s88, 1
    s_cbranch_scc1 fw20x
    s_waitcnt vmcnt(0)
    v_cmp_ne_u32 vcc, s95, v3
    s_cbranch_vccz fw20x
    s_sleep 4
    s_branch fw20
fw20x:
    v_and_b32 v1, 63, v0
    v_lshlrev_b32 v1, 4, v1
    s_lshl_b32 s18, s33, 18
    s_lshl_b32 s19, s32, 16
    s_add_u32 s18, s18, s19
    s_add_u32 s18, s18, 130023424
    buffer_load_dwordx4 a[0:3], v1, s[4:7], s18 offen offset:0 sc1
    buffer_load_dwordx4 a[4:7], v1, s[4:7], s18 offen offset:1024 sc1
    buffer_load_dwordx4 a[8:11], v1, s[4:7], s18 offen offset:2048 sc1
    buffer_load_dwordx4 a[12:15], v1, s[4:7], s18 offen offset:3072 sc1
    s_add_u32 s18, s18, 4096
    buffer_load_dwordx4 a[16:19], v1, s[4:7], s18 offen offset:0 sc1
    buffer_load_dwordx4 a[20:23], v1, s[4:7], s18 offen offset:1024 sc1
    buffer_load_dwordx4 a[24:27], v1, s[4:7], s18 offen offset:2048 sc1
    buffer_load_dwordx4 a[28:31], v1, s[4:7], s18 offen offset:3072 sc1
    s_add_u32 s18, s18, 4096
    buffer_load_dwordx4 a[32:35], v1, s[4:7], s18 offen offset:0 sc1
    buffer_load_dwordx4 a[36:39], v1, s[4:7], s18 offen offset:1024 sc1
    buffer_load_dwordx4 a[40:43], v1, s[4:7], s18 offen offset:2048 sc1
    buffer_load_dwordx4 a[44:47], v1, s[4:7], s18 offen offset:3072 sc1
    s_add_u32 s18, s18, 4096
    buffer_load_dwordx4 a[48:51], v1, s[4:7], s18 offen offset:0 sc1
    buffer_load_dwordx4 a[52:55], v1, s[4:7], s18 offen offset:1024 sc1
    buffer_load_dwordx4 a[56:59], v1, s[4:7], s18 offen offset:2048 sc1
    buffer_load_dwordx4 a[60:63], v1, s[4:7], s18 offen offset:3072 sc1
    s_add_u32 s18, s18, 4096
    buffer_load_dwordx4 a[64:67], v1, s[4:7], s18 offen offset:0 sc1
    buffer_load_dwordx4 a[68:71], v1, s[4:7], s18 offen offset:1024 sc1
    buffer_load_dwordx4 a[72:75], v1, s[4:7], s18 offen offset:2048 sc1
    buffer_load_dwordx4 a[76:79], v1, s[4:7], s18 offen offset:3072 sc1
    s_add_u32 s18, s18, 4096
    buffer_load_dwordx4 a[80:83], v1, s[4:7], s18 offen offset:0 sc1
    buffer_load_dwordx4 a[84:87], v1, s[4:7], s18 offen offset:1024 sc1
    buffer_load_dwordx4 a[88:91], v1, s[4:7], s18 offen offset:2048 sc1
    buffer_load_dwordx4 a[92:95], v1, s[4:7], s18 offen offset:3072 sc1
    s_add_u32 s18, s18, 4096
    buffer_load_dwordx4 a[96:99], v1, s[4:7], s18 offen offset:0 sc1
    buffer_load_dwordx4 a[100:103], v1, s[4:7], s18 offen offset:1024 sc1
    buffer_load_dwordx4 a[104:107], v1, s[4:7], s18 offen offset:2048 sc1
    buffer_load_dwordx4 a[108:111], v1, s[4:7], s18 offen offset:3072 sc1
    s_add_u32 s18, s18, 4096
    buffer_load_dwordx4 a[112:115], v1, s[4:7], s18 offen offset:0 sc1
    buffer_load_dwordx4 a[116:119], v1, s[4:7], s18 offen offset:1024 sc1
    buffer_load_dwordx4 a[120:123], v1, s[4:7], s18 offen offset:2048 sc1
    buffer_load_dwordx4 a[124:127], v1, s[4:7], s18 offen offset:3072 sc1
    s_add_u32 s18, s18, 4096
    buffer_load_dwordx4 a[128:131], v1, s[4:7], s18 offen offset:0 sc1
    buffer_load_dwordx4 a[132:135], v1, s[4:7], s18 offen offset:1024 sc1
    buffer_load_dwordx4 a[136:139], v1, s[4:7], s18 offen offset:2048 sc1
    buffer_load_dwordx4 a[140:143], v1, s[4:7], s18 offen offset:3072 sc1
    s_add_u32 s18, s18, 4096
    buffer_load_dwordx4 a[144:147], v1, s[4:7], s18 offen offset:0 sc1
    buffer_load_dwordx4 a[148:151], v1, s[4:7], s18 offen offset:1024 sc1
    buffer_load_dwordx4 a[152:155], v1, s[4:7], s18 offen offset:2048 sc1
    buffer_load_dwordx4 a[156:159], v1, s[4:7], s18 offen offset:3072 sc1
    s_add_u32 s18, s18, 4096
    buffer_load_dwordx4 a[160:163], v1, s[4:7], s18 offen offset:0 sc1
    s_waitcnt vmcnt(20)
    buffer_load_dwordx4 a[164:167], v1, s[4:7], s18 offen offset:1024 sc1
    buffer_load_dwordx4 a[168:171], v1, s[4:7], s18 offen offset:2048 sc1
    buffer_load_dwordx4 a[172:175], v1, s[4:7], s18 offen offset:3072 sc1
    s_add_u32 s18, s18, 4096
    buffer_load_dwordx4 a[176:179], v1, s[4:7], s18 offen offset:0 sc1
    buffer_load_dwordx4 a[180:183], v1, s[4:7], s18 offen offset:1024 sc1
    buffer_load_dwordx4 a[184:187], v1, s[4:7], s18 offen offset:2048 sc1
    buffer_load_dwordx4 a[188:191], v1, s[4:7], s18 offen offset:3072 sc1
    s_add_u32 s18, s18, 4096
    buffer_load_dwordx4 a[192:195], v1, s[4:7], s18 offen offset:0 sc1
    buffer_load_dwordx4 a[196:199], v1, s[4:7], s18 offen offset:1024 sc1
    buffer_load_dwordx4 a[200:203], v1, s[4:7], s18 offen offset:2048 sc1
    buffer_load_dwordx4 a[204:207], v1, s[4:7], s18 offen offset:3072 sc1
    s_add_u32 s18, s18, 4096
    buffer_load_dwordx4 a[208:211], v1, s[4:7], s18 offen offset:0 sc1
    buffer_load_dwordx4 a[212:215], v1, s[4:7], s18 offen offset:1024 sc1
    buffer_load_dwordx4 a[216:219], v1, s[4:7], s18 offen offset:2048 sc1
    buffer_load_dwordx4 a[220:223], v1, s[4:7], s18 offen offset:3072 sc1
    s_add_u32 s18, s18, 4096
    buffer_load_dwordx4 a[224:227], v1, s[4:7], s18 offen offset:0 sc1
    buffer_load_dwordx4 a[228:231], v1, s[4:7], s18 offen offset:1024 sc1
    buffer_load_dwordx4 a[232:235], v1, s[4:7], s18 offen offset:2048 sc1
    buffer_load_dwordx4 a[236:239], v1, s[4:7], s18 offen offset:3072 sc1
    s_add_u32 s18, s18, 4096
    buffer_load_dwordx4 a[240:243], v1, s[4:7], s18 offen offset:0 sc1
    buffer_load_dwordx4 a[244:247], v1, s[4:7], s18 offen offset:1024 sc1
    buffer_load_dwordx4 a[248:251], v1, s[4:7], s18 offen offset:2048 sc1
    buffer_load_dwordx4 a[252:255], v1, s[4:7], s18 offen offset:3072 sc1
    s_waitcnt vmcnt(0)
    s_mov_b32 s44, 0
    s_mov_b32 s37, s35
    v_mov_b32 v250, 1
    v_mov_b32 v251, 163832
    v_cmp_eq_u32 vcc, 0, v0
    s_nop 0
    s_and_saveexec_b64 s[38:39], vcc
    s_cbranch_execz tk21
    buffer_atomic_add v250, off, s[84:87], s37 sc0
    s_waitcnt vmcnt(0)
    ds_write_b32 v251, v250
    s_waitcnt lgkmcnt(0)
tk21:
    s_mov_b64 exec, -1
    s_barrier
    ds_read_b32 v252, v251
    s_waitcnt lgkmcnt(0)
    v_readfirstlane_b32 s16, v252
    s_barrier
    s_nop 3
    s_cmp_ge_u32 s16, 68
    s_cbranch_scc1 L_op_nextcb
L_op_seg:
    s_min_u32 s43, s16, 60
    s_add_u32 s16, s16, s43
    s_cmp_lt_u32 s16, 120
    s_cbranch_scc1 L_op_nr
    s_add_u32 s43, s16, 6
    s_sub_u32 s16, s16, 2
    s_cmp_lt_u32 s16, 120
    s_cselect_b32 s16, s43, s16
L_op_nr:
    s_lshr_b32 s43, s16, 1
    s_add_u32 s43, s43, 2
    s_min_u32 s43, s43, 63
    s_lshl_b32 s94, s33, 7
    s_add_u32 s94, s94, s16
    s_mov_b32 s88, 65536
    s_mov_b32 s89, 125853696
cw22:
    buffer_load_dword v3, off, s[4:7], s89 sc1
    s_waitcnt vmcnt(0)
    v_readfirstlane_b32 s42, v3
    s_nop 0
    s_sub_u32 s42, s42, s95
    s_cmp_gt_u32 s42, 64
    s_cselect_b32 s42, 0, s42
    s_add_u32 s42, s42, 1
    s_cmp_ge_u32 s42, s43
    s_cbranch_scc1 cw22x
    s_sub_u32 s88, s88, 1
    s_cbranch_scc1 cw22x
    s_sub_u32 s42, s43, s42
    s_min_u32 s42, s42, 6
cw22s:
    s_sleep 24
    s_sub_u32 s42, s42, 1
    s_cmp_lg_u32 s42, 0
    s_cbranch_scc1 cw22s
    s_branch cw22
cw22x:
    s_lshr_b32 s89, s16, 1
    s_lshl_b32 s89, s89, 2
    s_add_u32 s89, s89, s32
    s_lshl_b32 s89, s89, 7
    s_add_u32 s89, s89, 125894656
    s_sub_u32 s47, s89, 125894656
    s_lshl_b32 s47, s47, 5
    s_lshl_b32 s46, s33, 7
    s_add_u32 s47, s47, s46
    s_add_u32 s47, s47, 124944384
    s_cmp_ge_u32 s16, 124
    s_cselect_b32 s46, 8, 0
    s_cselect_b32 s47, s47, s89
    v_mbcnt_lo_u32_b32 v2, -1, 0
    v_mbcnt_hi_u32_b32 v2, -1, v2
    v_min_u32 v2, 1, v2
    v_lshlrev_b32 v2, 2, v2
    s_mov_b32 s88, 4194304
fw23:
    buffer_load_dword v3, v2, s[4:7], s47 offen offset:0 sc1
    s_sub_u32 s88, s88, 1
    s_cbranch_scc1 fw23x
    s_waitcnt vmcnt(0)
    v_cmp_ne_u32 vcc, s95, v3
    s_cbranch_vccz fw23x
    s_sleep 1
    s_branch fw23
fw23x:
    v_mov_b32 v250, 1
    v_lshrrev_b32 v252, 2, v1
    v_min_u32 v252, 68, v252
    s_cmp_lg_u32 s32, 0
    s_cbranch_scc1 L_op_na
    s_mov_b64 exec, 1
    buffer_atomic_add v250, off, s[84:87], s35 sc0
    s_mov_b64 exec, -1
    s_cmp_lg_u32 s44, 0
    s_cbranch_scc1 L_op_na
    buffer_load_dword v253, v252, s[84:87], 0 offen offset:136 sc1
L_op_na:
    s_cmp_ge_u32 s16, 120
    s_cbranch_scc1 L_op_one
o2_again:
    s_lshl_b32 s18, s16, 17
    s_lshl_b32 s19, s32, 15
    s_add_u32 s18, s18, s19
    s_add_u32 s18, s18, 50331648
    buffer_load_dwordx4 v[24:27], v1, s[4:7], s18 offen offset:0 sc1
    buffer_load_dwordx4 v[28:31], v1, s[4:7], s18 offen offset:1024 sc1
    buffer_load_dwordx4 v[32:35], v1, s[4:7], s18 offen offset:2048 sc1
    buffer_load_dwordx4 v[36:39], v1, s[4:7], s18 offen offset:3072 sc1
    s_add_u32 s18, s18, 4096
    buffer_load_dwordx4 v[40:43], v1, s[4:7], s18 offen offset:0 sc1
    buffer_load_dwordx4 v[44:47], v1, s[4:7], s18 offen offset:1024 sc1
    buffer_load_dwordx4 v[48:51], v1, s[4:7], s18 offen offset:2048 sc1
    buffer_load_dwordx4 v[52:55], v1, s[4:7], s18 offen offset:3072 sc1
    s_add_u32 s18, s18, 4096
    buffer_load_dwordx4 v[56:59], v1, s[4:7], s18 offen offset:0 sc1
    buffer_load_dwordx4 v[60:63], v1, s[4:7], s18 offen offset:1024 sc1
    buffer_load_dwordx4 v[64:67], v1, s[4:7], s18 offen offset:2048 sc1
    buffer_load_dwordx4 v[68:71], v1, s[4:7], s18 offen offset:3072 sc1
    s_add_u32 s18, s18, 4096
    buffer_load_dwordx4 v[72:75], v1, s[4:7], s18 offen offset:0 sc1
    buffer_load_dwordx4 v[76:79], v1, s[4:7], s18 offen offset:1024 sc1
    buffer_load_dwordx4 v[80:83], v1, s[4:7], s18 offen offset:2048 sc1
    buffer_load_dwordx4 v[84:87], v1, s[4:7], s18 offen offset:3072 sc1
    s_add_u32 s18, s18, 4096
    buffer_load_dwordx4 v[88:91], v1, s[4:7], s18 offen offset:0 sc1
    buffer_load_dwordx4 v[92:95], v1, s[4:7], s18 offen offset:1024 sc1
    buffer_load_dwordx4 v[96:99], v1, s[4:7], s18 offen offset:2048 sc1
    buffer_load_dwordx4 v[100:103], v1, s[4:7], s18 offen offset:3072 sc1
    s_add_u32 s18, s18, 4096
    buffer_load_dwordx4 v[104:107], v1, s[4:7], s18 offen offset:0 sc1
    buffer_load_dwordx4 v[108:111], v1, s[4:7], s18 offen offset:1024 sc1
    buffer_load_dwordx4 v[112:115], v1, s[4:7], s18 offen offset:2048 sc1
    buffer_load_dwordx4 v[116:119], v1, s[4:7], s18 offen offset:3072 sc1
    s_add_u32 s18, s18, 4096
    buffer_load_dwordx4 v[120:123], v1, s[4:7], s18 offen offset:0 sc1
    buffer_load_dwordx4 v[124:127], v1, s[4:7], s18 offen offset:1024 sc1
    buffer_load_dwordx4 v[128:131], v1, s[4:7], s18 offen offset:2048 sc1
    buffer_load_dwordx4 v[132:135], v1, s[4:7], s18 offen offset:3072 sc1
    s_add_u32 s18, s18, 4096
    buffer_load_dwordx4 v[136:139], v1, s[4:7], s18 offen offset:0 sc1
    buffer_load_dwordx4 v[140:143], v1, s[4:7], s18 offen offset:1024 sc1
    buffer_load_dwordx4 v[144:147], v1, s[4:7], s18 offen offset:2048 sc1
    buffer_load_dwordx4 v[148:151], v1, s[4:7], s18 offen offset:3072 sc1
    s_add_u32 s18, s18, 102400
    buffer_load_dwordx4 v[152:155], v1, s[4:7], s18 offen offset:0 sc1
    buffer_load_dwordx4 v[156:159], v1, s[4:7], s18 offen offset:1024 sc1
    buffer_load_dwordx4 v[160:163], v1, s[4:7], s18 offen offset:2048 sc1
    buffer_load_dwordx4 v[164:167], v1, s[4:7], s18 offen offset:3072 sc1
    s_add_u32 s18, s18, 4096
    buffer_load_dwordx4 v[168:171], v1, s[4:7], s18 offen offset:0 sc1
    buffer_load_dwordx4 v[172:175], v1, s[4:7], s18 offen offset:1024 sc1
    buffer_load_dwordx4 v[176:179], v1, s[4:7], s18 offen offset:2048 sc1
    buffer_load_dwordx4 v[180:183], v1, s[4:7], s18 offen offset:3072 sc1
    s_add_u32 s18, s18, 4096
    buffer_load_dwordx4 v[184:187], v1, s[4:7], s18 offen offset:0 sc1
    buffer_load_dwordx4 v[188:191], v1, s[4:7], s18 offen offset:1024 sc1
    buffer_load_dwordx4 v[192:195], v1, s[4:7], s18 offen offset:2048 sc1
    buffer_load_dwordx4 v[196:199], v1, s[4:7], s18 offen offset:3072 sc1
    s_add_u32 s18, s18, 4096
    buffer_load_dwordx4 v[200:203], v1, s[4:7], s18 offen offset:0 sc1
    buffer_load_dwordx4 v[204:207], v1, s[4:7], s18 offen offset:1024 sc1
    buffer_load_dwordx4 v[208:211], v1, s[4:7], s18 offen offset:2048 sc1
    buffer_load_dwordx4 v[212:215], v1, s[4:7], s18 offen offset:3072 sc1
    s_add_u32 s18, s18, 4096
    buffer_load_dwordx4 v[216:219], v1, s[4:7], s18 offen offset:0 sc1
    buffer_load_dwordx4 v[220:223], v1, s[4:7], s18 offen offset:1024 sc1
    buffer_load_dwordx4 v[224:227], v1, s[4:7], s18 offen offset:2048 sc1
    buffer_load_dwordx4 v[228:231], v1, s[4:7], s18 offen offset:3072 sc1
    s_add_u32 s18, s18, 4096
    buffer_load_dwordx4 v[232:235], v1, s[4:7], s18 offen offset:0 sc1
    buffer_load_dwordx4 v[236:239], v1, s[4:7], s18 offen offset:1024 sc1
    buffer_load_dwordx4 v[240:243], v1, s[4:7], s18 offen offset:2048 sc1
    buffer_load_dwordx4 v[244:247], v1, s[4:7], s18 offen offset:3072 sc1
    v_lshlrev_b32 v2, 4, v0
    v_and_b32 v3, 3072, v2
    v_lshl_add_u32 v2, v3, 1, v1
    s_waitcnt vmcnt(55)
    v_mfma_f32_16x16x32_bf16 v[8:11], a[0:3], v[24:27], 0
    v_mfma_f32_16x16x32_bf16 v[12:15], a[4:7], v[24:27], 0
    s_add_u32 s18, s18, 4096
    buffer_load_dwordx4 v[24:27], v1, s[4:7], s18 offen offset:0 sc1
    s_waitcnt vmcnt(55)
    v_mfma_f32_16x16x32_bf16 v[8:11], a[8:11], v[28:31], v[8:11]
    v_mfma_f32_16x16x32_bf16 v[12:15], a[12:15], v[28:31], v[12:15]
    buffer_load_dwordx4 v[28:31], v1, s[4:7], s18 offen offset:1024 sc1
    s_waitcnt vmcnt(55)
    v_mfma_f32_16x16x32_bf16 v[8:11], a[16:19], v[32:35], v[8:11]
    v_mfma_f32_16x16x32_bf16 v[12:15], a[20:23], v[32:35], v[12:15]
    buffer_load_dwordx4 v[32:35], v1, s[4:7], s18 offen offset:2048 sc1
    s_waitcnt vmcnt(55)
    v_mfma_f32_16x16x32_bf16 v[8:11], a[24:27], v[36:39], v[8:11]
    v_mfma_f32_16x16x32_bf16 v[12:15], a[28:31], v[36:39], v[12:15]
    buffer_load_dwordx4 v[36:39], v1, s[4:7], s18 offen offset:3072 sc1
    s_waitcnt vmcnt(55)
    v_mfma_f32_16x16x32_bf16 v[8:11], a[32:35], v[40:43], v[8:11]
    v_mfma_f32_16x16x32_bf16 v[12:15], a[36:39], v[40:43], v[12:15]
    s_add_u32 s18, s18, 4096
    buffer_load_dwordx4 v[40:43], v1, s[4:7], s18 offen offset:0 sc1
    s_waitcnt vmcnt(55)
    v_mfma_f32_16x16x32_bf16 v[8:11], a[40:43], v[44:47], v[8:11]
    v_mfma_f32_16x16x32_bf16 v[12:15], a[44:47], v[44:47], v[12:15]
    buffer_load_dwordx4 v[44:47], v1, s[4:7], s18 offen offset:1024 sc1
    s_waitcnt vmcnt(55)
    v_mfma_f32_16x16x32_bf16 v[8:11], a[48:51], v[48:51], v[8:11]
    v_mfma_f32_16x16x32_bf16 v[12:15], a[52:55], v[48:51], v[12:15]
    buffer_load_dwordx4 v[48:51], v1, s[4:7], s18 offen offset:2048 sc1
    s_waitcnt vmcnt(55)
    v_mfma_f32_16x16x32_bf16 v[8:11], a[56:59], v[52:55], v[8:11]
    v_mfma_f32_16x16x32_bf16 v[12:15], a[60:63], v[52:55], v[12:15]
    buffer_load_dwordx4 v[52:55], v1, s[4:7], s18 offen offset:3072 sc1
    s_waitcnt vmcnt(55)
    v_mfma_f32_16x16x32_bf16 v[8:11], a[64:67], v[56:59], v[8:11]
    v_mfma_f32_16x16x32_bf16 v[12:15], a[68:71], v[56:59], v[12:15]
    s_waitcnt vmcnt(54)
    v_mfma_f32_16x16x32_bf16 v[8:11], a[72:75], v[60:63], v[8:11]
    v_mfma_f32_16x16x32_bf16 v[12:15], a[76:79], v[60:63], v[12:15]
    s_waitcnt vmcnt(53)
    v_mfma_f32_16x16x32_bf16 v[8:11], a[80:83], v[64:67], v[8:11]
    v_mfma_f32_16x16x32_bf16 v[12:15], a[84:87], v[64:67], v[12:15]
    s_waitcnt vmcnt(52)
    v_mfma_f32_16x16x32_bf16 v[8:11], a[88:91], v[68:71], v[8:11]
    v_mfma_f32_16x16x32_bf16 v[12:15], a[92:95], v[68:71], v[12:15]
    s_waitcnt vmcnt(51)
    v_mfma_f32_16x16x32_bf16 v[8:11], a[96:99], v[72:75], v[8:11]
    v_mfma_f32_16x16x32_bf16 v[12:15], a[100:103], v[72:75], v[12:15]
    s_waitcnt vmcnt(50)
    v_mfma_f32_16x16x32_bf16 v[8:11], a[104:107], v[76:79], v[8:11]
    v_mfma_f32_16x16x32_bf16 v[12:15], a[108:111], v[76:79], v[12:15]
    s_waitcnt vmcnt(49)
    v_mfma_f32_16x16x32_bf16 v[8:11], a[112:115], v[80:83], v[8:11]
    v_mfma_f32_16x16x32_bf16 v[12:15], a[116:119], v[80:83], v[12:15]
    s_waitcnt vmcnt(48)
    v_mfma_f32_16x16x32_bf16 v[8:11], a[120:123], v[84:87], v[8:11]
    v_mfma_f32_16x16x32_bf16 v[12:15], a[124:127], v[84:87], v[12:15]
    s_waitcnt vmcnt(47)
    v_mfma_f32_16x16x32_bf16 v[8:11], a[128:131], v[88:91], v[8:11]
    v_mfma_f32_16x16x32_bf16 v[12:15], a[132:135], v[88:91], v[12:15]
    s_waitcnt vmcnt(46)
    v_mfma_f32_16x16x32_bf16 v[8:11], a[136:139], v[92:95], v[8:11]
    v_mfma_f32_16x16x32_bf16 v[12:15], a[140:143], v[92:95], v[12:15]
    s_waitcnt vmcnt(45)
    v_mfma_f32_16x16x32_bf16 v[8:11], a[144:147], v[96:99], v[8:11]
    v_mfma_f32_16x16x32_bf16 v[12:15], a[148:151], v[96:99], v[12:15]
    s_waitcnt vmcnt(44)
    v_mfma_f32_16x16x32_bf16 v[8:11], a[152:155], v[100:103], v[8:11]
    v_mfma_f32_16x16x32_bf16 v[12:15], a[156:159], v[100:103], v[12:15]
    s_waitcnt vmcnt(43)
    v_mfma_f32_16x16x32_bf16 v[8:11], a[160:163], v[104:107], v[8:11]
    v_mfma_f32_16x16x32_bf16 v[12:15], a[164:167], v[104:107], v[12:15]
    s_waitcnt vmcnt(42)
    v_mfma_f32_16x16x32_bf16 v[8:11], a[168:171], v[108:111], v[8:11]
    v_mfma_f32_16x16x32_bf16 v[12:15], a[172:175], v[108:111], v[12:15]
    s_waitcnt vmcnt(41)
    v_mfma_f32_16x16x32_bf16 v[8:11], a[176:179], v[112:115], v[8:11]
    v_mfma_f32_16x16x32_bf16 v[12:15], a[180:183], v[112:115], v[12:15]
    s_waitcnt vmcnt(40)
    v_mfma_f32_16x16x32_bf16 v[8:11], a[184:187], v[116:119], v[8:11]
    v_mfma_f32_16x16x32_bf16 v[12:15], a[188:191], v[116:119], v[12:15]
    s_waitcnt vmcnt(39)
    v_mfma_f32_16x16x32_bf16 v[8:11], a[192:195], v[120:123], v[8:11]
    v_mfma_f32_16x16x32_bf16 v[12:15], a[196:199], v[120:123], v[12:15]
    s_waitcnt vmcnt(38)
    v_mfma_f32_16x16x32_bf16 v[8:11], a[200:203], v[124:127], v[8:11]
    v_mfma_f32_16x16x32_bf16 v[12:15], a[204:207], v[124:127], v[12:15]
    s_waitcnt vmcnt(37)
    v_mfma_f32_16x16x32_bf16 v[8:11], a[208:211], v[128:131], v[8:11]
    v_mfma_f32_16x16x32_bf16 v[12:15], a[212:215], v[128:131], v[12:15]
    s_waitcnt vmcnt(36)
    v_mfma_f32_16x16x32_bf16 v[8:11], a[216:219], v[132:135], v[8:11]
    v_mfma_f32_16x16x32_bf16 v[12:15], a[220:223], v[132:135], v[12:15]
    s_waitcnt vmcnt(35)
    v_mfma_f32_16x16x32_bf16 v[8:11], a[224:227], v[136:139], v[8:11]
    v_mfma_f32_16x16x32_bf16 v[12:15], a[228:231], v[136:139], v[12:15]
    s_waitcnt vmcnt(34)
    v_mfma_f32_16x16x32_bf16 v[8:11], a[232:235], v[140:143], v[8:11]
    v_mfma_f32_16x16x32_bf16 v[12:15], a[236:239], v[140:143], v[12:15]
    s_waitcnt vmcnt(33)
    v_mfma_f32_16x16x32_bf16 v[8:11], a[240:243], v[144:147], v[8:11]
    v_mfma_f32_16x16x32_bf16 v[12:15], a[244:247], v[144:147], v[12:15]
    s_waitcnt vmcnt(32)
    v_mfma_f32_16x16x32_bf16 v[8:11], a[248:251], v[148:151], v[8:11]
    v_mfma_f32_16x16x32_bf16 v[12:15], a[252:255], v[148:151], v[12:15]
    s_waitcnt vmcnt(31)
    v_mfma_f32_16x16x32_bf16 v[16:19], a[0:3], v[152:155], 0
    v_mfma_f32_16x16x32_bf16 v[20:23], a[4:7], v[152:155], 0
    s_waitcnt vmcnt(30)
    v_mfma_f32_16x16x32_bf16 v[16:19], a[8:11], v[156:159], v[16:19]
    v_mfma_f32_16x16x32_bf16 v[20:23], a[12:15], v[156:159], v[20:23]
    s_waitcnt vmcnt(29)
    v_mfma_f32_16x16x32_bf16 v[16:19], a[16:19], v[160:163], v[16:19]
    v_mfma_f32_16x16x32_bf16 v[20:23], a[20:23], v[160:163], v[20:23]
    s_waitcnt vmcnt(28)
    v_mfma_f32_16x16x32_bf16 v[16:19], a[24:27], v[164:167], v[16:19]
    v_mfma_f32_16x16x32_bf16 v[20:23], a[28:31], v[164:167], v[20:23]
    s_waitcnt vmcnt(27)
    v_mfma_f32_16x16x32_bf16 v[16:19], a[32:35], v[168:171], v[16:19]
    v_mfma_f32_16x16x32_bf16 v[20:23], a[36:39], v[168:171], v[20:23]
    s_waitcnt vmcnt(26)
    v_mfma_f32_16x16x32_bf16 v[16:19], a[40:43], v[172:175], v[16:19]
    v_mfma_f32_16x16x32_bf16 v[20:23], a[44:47], v[172:175], v[20:23]
    s_waitcnt vmcnt(25)
    v_mfma_f32_16x16x32_bf16 v[16:19], a[48:51], v[176:179], v[16:19]
    v_mfma_f32_16x16x32_bf16 v[20:23], a[52:55], v[176:179], v[20:23]
    s_waitcnt vmcnt(24)
    v_mfma_f32_16x16x32_bf16 v[16:19], a[56:59], v[180:183], v[16:19]
    v_mfma_f32_16x16x32_bf16 v[20:23], a[60:63], v[180:183], v[20:23]
    s_waitcnt vmcnt(23)
    v_mfma_f32_16x16x32_bf16 v[16:19], a[64:67], v[184:187], v[16:19]
    v_mfma_f32_16x16x32_bf16 v[20:23], a[68:71], v[184:187], v[20:23]
    s_waitcnt vmcnt(22)
    v_mfma_f32_16x16x32_bf16 v[16:19], a[72:75], v[188:191], v[16:19]
    v_mfma_f32_16x16x32_bf16 v[20:23], a[76:79], v[188:191], v[20:23]
    s_waitcnt vmcnt(21)
    v_mfma_f32_16x16x32_bf16 v[16:19], a[80:83], v[192:195], v[16:19]
    v_mfma_f32_16x16x32_bf16 v[20:23], a[84:87], v[192:195], v[20:23]
    s_waitcnt vmcnt(20)
    v_mfma_f32_16x16x32_bf16 v[16:19], a[88:91], v[196:199], v[16:19]
    v_mfma_f32_16x16x32_bf16 v[20:23], a[92:95], v[196:199], v[20:23]
    s_waitcnt vmcnt(19)
    v_mfma_f32_16x16x32_bf16 v[16:19], a[96:99], v[200:203], v[16:19]
    v_mfma_f32_16x16x32_bf16 v[20:23], a[100:103], v[200:203], v[20:23]
    s_waitcnt vmcnt(18)
    v_mfma_f32_16x16x32_bf16 v[16:19], a[104:107], v[204:207], v[16:19]
    v_mfma_f32_16x16x32_bf16 v[20:23], a[108:111], v[204:207], v[20:23]
    s_waitcnt vmcnt(17)
    v_mfma_f32_16x16x32_bf16 v[16:19], a[112:115], v[208:211], v[16:19]
    v_mfma_f32_16x16x32_bf16 v[20:23], a[116:119], v[208:211], v[20:23]
    s_waitcnt vmcnt(16)
    v_mfma_f32_16x16x32_bf16 v[16:19], a[120:123], v[212:215], v[16:19]
    v_mfma_f32_16x16x32_bf16 v[20:23], a[124:127], v[212:215], v[20:23]
    s_waitcnt vmcnt(15)
    v_mfma_f32_16x16x32_bf16 v[16:19], a[128:131], v[216:219], v[16:19]
    v_mfma_f32_16x16x32_bf16 v[20:23], a[132:135], v[216:219], v[20:23]
    s_waitcnt vmcnt(14)
    v_mfma_f32_16x16x32_bf16 v[16:19], a[136:139], v[220:223], v[16:19]
    v_mfma_f32_16x16x32_bf16 v[20:23], a[140:143], v[220:223], v[20:23]
    s_waitcnt vmcnt(13)
    v_mfma_f32_16x16x32_bf16 v[16:19], a[144:147], v[224:227], v[16:19]
    v_mfma_f32_16x16x32_bf16 v[20:23], a[148:151], v[224:227], v[20:23]
    s_waitcnt vmcnt(12)
    v_mfma_f32_16x16x32_bf16 v[16:19], a[152:155], v[228:231], v[16:19]
    v_mfma_f32_16x16x32_bf16 v[20:23], a[156:159], v[228:231], v[20:23]
    s_waitcnt vmcnt(11)
    v_mfma_f32_16x16x32_bf16 v[16:19], a[160:163], v[232:235], v[16:19]
    v_mfma_f32_16x16x32_bf16 v[20:23], a[164:167], v[232:235], v[20:23]
    s_waitcnt vmcnt(10)
    v_mfma_f32_16x16x32_bf16 v[16:19], a[168:171], v[236:239], v[16:19]
    v_mfma_f32_16x16x32_bf16 v[20:23], a[172:175], v[236:239], v[20:23]
    s_waitcnt vmcnt(9)
    v_mfma_f32_16x16x32_bf16 v[16:19], a[176:179], v[240:243], v[16:19]
    v_mfma_f32_16x16x32_bf16 v[20:23], a[180:183], v[240:243], v[20:23]
    s_waitcnt vmcnt(8)
    v_mfma_f32_16x16x32_bf16 v[16:19], a[184:187], v[244:247], v[16:19]
    v_mfma_f32_16x16x32_bf16 v[20:23], a[188:191], v[244:247], v[20:23]
    s_waitcnt vmcnt(7)
    v_mfma_f32_16x16x32_bf16 v[16:19], a[192:195], v[24:27], v[16:19]
    v_mfma_f32_16x16x32_bf16 v[20:23], a[196:199], v[24:27], v[20:23]
    s_waitcnt vmcnt(6)
    v_mfma_f32_16x16x32_bf16 v[16:19], a[200:203], v[28:31], v[16:19]
    v_mfma_f32_16x16x32_bf16 v[20:23], a[204:207], v[28:31], v[20:23]
    s_waitcnt vmcnt(5)
    v_mfma_f32_16x16x32_bf16 v[16:19], a[208:211], v[32:35], v[16:19]
    v_mfma_f32_16x16x32_bf16 v[20:23], a[212:215], v[32:35], v[20:23]
    s_waitcnt vmcnt(4)
    v_mfma_f32_16x16x32_bf16 v[16:19], a[216:219], v[36:39], v[16:19]
    v_mfma_f32_16x16x32_bf16 v[20:23], a[220:223], v[36:39], v[20:23]
    s_waitcnt vmcnt(3)
    v_mfma_f32_16x16x32_bf16 v[16:19], a[224:227], v[40:43], v[16:19]
    v_mfma_f32_16x16x32_bf16 v[20:23], a[228:231], v[40:43], v[20:23]
    s_waitcnt vmcnt(2)
    v_mfma_f32_16x16x32_bf16 v[16:19], a[232:235], v[44:47], v[16:19]
    v_mfma_f32_16x16x32_bf16 v[20:23], a[236:239], v[44:47], v[20:23]
    s_waitcnt vmcnt(1)
    v_mfma_f32_16x16x32_bf16 v[16:19], a[240:243], v[48:51], v[16:19]
    v_mfma_f32_16x16x32_bf16 v[20:23], a[244:247], v[48:51], v[20:23]
    s_waitcnt vmcnt(0)
    v_mfma_f32_16x16x32_bf16 v[16:19], a[248:251], v[52:55], v[16:19]
    v_mfma_f32_16x16x32_bf16 v[20:23], a[252:255], v[52:55], v[20:23]
    ds_write_b128 v2, v[8:11] offset:0
    ds_write_b128 v2, v[12:15] offset:1024
    s_nop 4
    ds_write_b128 v2, v[16:19] offset:8192
    ds_write_b128 v2, v[20:23] offset:9216
    s_cmp_lg_u32 s32, 0
    s_cbranch_scc1 o2_nb
    v_cmp_eq_u32 vcc, 0, v253
    s_nop 0
    s_cmp_eq_u64 vcc, 0
    s_cselect_b32 s44, 65536, 0
    v_or_b32 v250, s44, v250
    v_mov_b32 v251, 163832
    s_mov_b64 exec, 1
    ds_write_b32 v251, v250
    s_mov_b64 exec, -1
o2_nb:
    s_waitcnt lgkmcnt(0)
    s_barrier
    s_cmp_gt_u32 s32, 1
    s_cbranch_scc1 o2_skip
    s_lshl_b32 s18, s32, 13
    v_add_u32 v2, s18, v1
    ds_read_b128 v[24:27], v2 offset:0
    ds_read_b128 v[28:31], v2 offset:1024
    ds_read_b128 v[32:35], v2 offset:2048
    ds_read_b128 v[36:39], v2 offset:3072
    ds_read_b128 v[40:43], v2 offset:4096
    ds_read_b128 v[44:47], v2 offset:5120
    ds_read_b128 v[48:51], v2 offset:6144
    ds_read_b128 v[52:55], v2 offset:7168
    v_lshrrev_b32 v3, 4, v1
    v_bfe_u32 v4, v3, 2, 2
    v_lshlrev_b32 v4, 3, v4
    v_and_b32 v2, 3, v3
    v_add_u32 v4, v4, v2
    v_mul_u32_u24 v4, 2304, v4
    v_lshrrev_b32 v3, 4, v3
    v_lshl_add_u32 v4, v3, 4, v4
    s_add_u32 s20, s16, s32
    s_lshr_b32 s18, s20, 1
    s_lshl_b32 s18, s18, 3
    s_and_b32 s19, s20, 1
    s_add_u32 s18, s18, s19
    s_mul_i32 s18, s18, 9216
    s_lshl_b32 s19, s33, 6
    s_add_u32 s18, s18, s19
    s_waitcnt lgkmcnt(0)
    v_pk_add_f32 v[24:25], v[24:25], v[32:33]
    v_pk_add_f32 v[40:41], v[40:41], v[48:49]
    v_pk_add_f32 v[24:25], v[24:25], v[40:41]
    v_pk_add_f32 v[26:27], v[26:27], v[34:35]
    v_pk_add_f32 v[42:43], v[42:43], v[50:51]
    v_pk_add_f32 v[26:27], v[26:27], v[42:43]
    v_pk_add_f32 v[28:29], v[28:29], v[36:37]
    v_pk_add_f32 v[44:45], v[44:45], v[52:53]
    v_pk_add_f32 v[28:29], v[28:29], v[44:45]
    v_pk_add_f32 v[30:31], v[30:31], v[38:39]
    v_pk_add_f32 v[46:47], v[46:47], v[54:55]
    v_pk_add_f32 v[30:31], v[30:31], v[46:47]
    v_cvt_pk_bf16_f32 v8, v24, v28
    v_cvt_pk_bf16_f32 v9, v25, v29
    v_cvt_pk_bf16_f32 v10, v26, v30
    v_cvt_pk_bf16_f32 v11, v27, v31
    buffer_store_dwordx4 v[8:11], v4, s[8:11], s18 offen
o2_skip:
    s_nop 1
    s_branch L_op_fin
L_op_one:
o1_again:
    s_lshl_b32 s18, s16, 17
    s_lshl_b32 s19, s32, 15
    s_add_u32 s18, s18, s19
    s_add_u32 s18, s18, 50331648
    buffer_load_dwordx4 v[24:27], v1, s[4:7], s18 offen offset:0 sc1
    buffer_load_dwordx4 v[28:31], v1, s[4:7], s18 offen offset:1024 sc1
    buffer_load_dwordx4 v[32:35], v1, s[4:7], s18 offen offset:2048 sc1
    buffer_load_dwordx4 v[36:39], v1, s[4:7], s18 offen offset:3072 sc1
    s_add_u32 s18, s18, 4096
    buffer_load_dwordx4 v[40:43], v1, s[4:7], s18 offen offset:0 sc1
    buffer_load_dwordx4 v[44:47], v1, s[4:7], s18 offen offset:1024 sc1
    buffer_load_dwordx4 v[48:51], v1, s[4:7], s18 offen offset:2048 sc1
    buffer_load_dwordx4 v[52:55], v1, s[4:7], s18 offen offset:3072 sc1
    s_add_u32 s18, s18, 4096
    buffer_load_dwordx4 v[56:59], v1, s[4:7], s18 offen offset:0 sc1
    buffer_load_dwordx4 v[60:63], v1, s[4:7], s18 offen offset:1024 sc1
    buffer_load_dwordx4 v[64:67], v1, s[4:7], s18 offen offset:2048 sc1
    buffer_load_dwordx4 v[68:71], v1, s[4:7], s18 offen offset:3072 sc1
    s_add_u32 s18, s18, 4096
    buffer_load_dwordx4 v[72:75], v1, s[4:7], s18 offen offset:0 sc1
    buffer_load_dwordx4 v[76:79], v1, s[4:7], s18 offen offset:1024 sc1
    buffer_load_dwordx4 v[80:83], v1, s[4:7], s18 offen offset:2048 sc1
    buffer_load_dwordx4 v[84:87], v1, s[4:7], s18 offen offset:3072 sc1
    s_add_u32 s18, s18, 4096
    buffer_load_dwordx4 v[88:91], v1, s[4:7], s18 offen offset:0 sc1
    buffer_load_dwordx4 v[92:95], v1, s[4:7], s18 offen offset:1024 sc1
    buffer_load_dwordx4 v[96:99], v1, s[4:7], s18 offen offset:2048 sc1
    buffer_load_dwordx4 v[100:103], v1, s[4:7], s18 offen offset:3072 sc1
    s_add_u32 s18, s18, 4096
    buffer_load_dwordx4 v[104:107], v1, s[4:7], s18 offen offset:0 sc1
    buffer_load_dwordx4 v[108:111], v1, s[4:7], s18 offen offset:1024 sc1
    buffer_load_dwordx4 v[112:115], v1, s[4:7], s18 offen offset:2048 sc1
    buffer_load_dwordx4 v[116:119], v1, s[4:7], s18 offen offset:3072 sc1
    s_add_u32 s18, s18, 4096
    buffer_load_dwordx4 v[120:123], v1, s[4:7], s18 offen offset:0 sc1
    buffer_load_dwordx4 v[124:127], v1, s[4:7], s18 offen offset:1024 sc1
    buffer_load_dwordx4 v[128:131], v1, s[4:7], s18 offen offset:2048 sc1
    buffer_load_dwordx4 v[132:135], v1, s[4:7], s18 offen offset:3072 sc1
    s_add_u32 s18, s18, 4096
    buffer_load_dwordx4 v[136:139], v1, s[4:7], s18 offen offset:0 sc1
    buffer_load_dwordx4 v[140:143], v1, s[4:7], s18 offen offset:1024 sc1
    buffer_load_dwordx4 v[144:147], v1, s[4:7], s18 offen offset:2048 sc1
    buffer_load_dwordx4 v[148:151], v1, s[4:7], s18 offen offset:3072 sc1
    v_lshlrev_b32 v2, 4, v0
    v_and_b32 v3, 3072, v2
    v_lshl_add_u32 v2, v3, 1, v1
    s_waitcnt vmcnt(31)
    v_mfma_f32_16x16x32_bf16 v[8:11], a[0:3], v[24:27], 0
    v_max_u32 v6, v24, v25
    v_mfma_f32_16x16x32_bf16 v[12:15], a[4:7], v[24:27], 0
    v_max3_u32 v6, v6, v26, v27
    s_waitcnt vmcnt(30)
    v_mfma_f32_16x16x32_bf16 v[8:11], a[8:11], v[28:31], v[8:11]
    v_max3_u32 v6, v6, v28, v29
    v_mfma_f32_16x16x32_bf16 v[12:15], a[12:15], v[28:31], v[12:15]
    v_max3_u32 v6, v6, v30, v31
    s_waitcnt vmcnt(29)
    v_mfma_f32_16x16x32_bf16 v[8:11], a[16:19], v[32:35], v[8:11]
    v_max3_u32 v6, v6, v32, v33
    v_mfma_f32_16x16x32_bf16 v[12:15], a[20:23], v[32:35], v[12:15]
    v_max3_u32 v6, v6, v34, v35
    s_waitcnt vmcnt(28)
    v_mfma_f32_16x16x32_bf16 v[8:11], a[24:27], v[36:39], v[8:11]
    v_max3_u32 v6, v6, v36, v37
    v_mfma_f32_16x16x32_bf16 v[12:15], a[28:31], v[36:39], v[12:15]
    v_max3_u32 v6, v6, v38, v39
    s_waitcnt vmcnt(27)
    v_mfma_f32_16x16x32_bf16 v[8:11], a[32:35], v[40:43], v[8:11]
    v_max3_u32 v6, v6, v40, v41
    v_mfma_f32_16x16x32_bf16 v[12:15], a[36:39], v[40:43], v[12:15]
    v_max3_u32 v6, v6, v42, v43
    s_waitcnt vmcnt(26)
    v_mfma_f32_16x16x32_bf16 v[8:11], a[40:43], v[44:47], v[8:11]
    v_max3_u32 v6, v6, v44, v45
    v_mfma_f32_16x16x32_bf16 v[12:15], a[44:47], v[44:47], v[12:15]
    v_max3_u32 v6, v6, v46, v47
    s_waitcnt vmcnt(25)
    v_mfma_f32_16x16x32_bf16 v[8:11], a[48:51], v[48:51], v[8:11]
    v_max3_u32 v6, v6, v48, v49
    v_mfma_f32_16x16x32_bf16 v[12:15], a[52:55], v[48:51], v[12:15]
    v_max3_u32 v6, v6, v50, v51
    s_waitcnt vmcnt(24)
    v_mfma_f32_16x16x32_bf16 v[8:11], a[56:59], v[52:55], v[8:11]
    v_max3_u32 v6, v6, v52, v53
    v_mfma_f32_16x16x32_bf16 v[12:15], a[60:63], v[52:55], v[12:15]
    v_max3_u32 v6, v6, v54, v55
    s_waitcnt vmcnt(23)
    v_mfma_f32_16x16x32_bf16 v[8:11], a[64:67], v[56:59], v[8:11]
    v_max3_u32 v6, v6, v56, v57
    v_mfma_f32_16x16x32_bf16 v[12:15], a[68:71], v[56:59], v[12:15]
    v_max3_u32 v6, v6, v58, v59
    s_waitcnt vmcnt(22)
    v_mfma_f32_16x16x32_bf16 v[8:11], a[72:75], v[60:63], v[8:11]
    v_max3_u32 v6, v6, v60, v61
    v_mfma_f32_16x16x32_bf16 v[12:15], a[76:79], v[60:63], v[12:15]
    v_max3_u32 v6, v6, v62, v63
    s_waitcnt vmcnt(21)
    v_mfma_f32_16x16x32_bf16 v[8:11], a[80:83], v[64:67], v[8:11]
    v_max3_u32 v6, v6, v64, v65
    v_mfma_f32_16x16x32_bf16 v[12:15], a[84:87], v[64:67], v[12:15]
    v_max3_u32 v6, v6, v66, v67
    s_waitcnt vmcnt(20)
    v_mfma_f32_16x16x32_bf16 v[8:11], a[88:91], v[68:71], v[8:11]
    v_max3_u32 v6, v6, v68, v69
    v_mfma_f32_16x16x32_bf16 v[12:15], a[92:95], v[68:71], v[12:15]
    v_max3_u32 v6, v6, v70, v71
    s_waitcnt vmcnt(19)
    v_mfma_f32_16x16x32_bf16 v[8:11], a[96:99], v[72:75], v[8:11]
    v_max3_u32 v6, v6, v72, v73
    v_mfma_f32_16x16x32_bf16 v[12:15], a[100:103], v[72:75], v[12:15]
    v_max3_u32 v6, v6, v74, v75
    s_waitcnt vmcnt(18)
    v_mfma_f32_16x16x32_bf16 v[8:11], a[104:107], v[76:79], v[8:11]
    v_max3_u32 v6, v6, v76, v77
    v_mfma_f32_16x16x32_bf16 v[12:15], a[108:111], v[76:79], v[12:15]
    v_max3_u32 v6, v6, v78, v79
    s_waitcnt vmcnt(17)
    v_mfma_f32_16x16x32_bf16 v[8:11], a[112:115], v[80:83], v[8:11]
    v_max3_u32 v6, v6, v80, v81
    v_mfma_f32_16x16x32_bf16 v[12:15], a[116:119], v[80:83], v[12:15]
    v_max3_u32 v6, v6, v82, v83
    s_waitcnt vmcnt(16)
    v_mfma_f32_16x16x32_bf16 v[8:11], a[120:123], v[84:87], v[8:11]
    v_max3_u32 v6, v6, v84, v85
    v_mfma_f32_16x16x32_bf16 v[12:15], a[124:127], v[84:87], v[12:15]
    v_max3_u32 v6, v6, v86, v87
    s_waitcnt vmcnt(15)
    v_mfma_f32_16x16x32_bf16 v[8:11], a[128:131], v[88:91], v[8:11]
    v_max3_u32 v6, v6, v88, v89
    v_mfma_f32_16x16x32_bf16 v[12:15], a[132:135], v[88:91], v[12:15]
    v_max3_u32 v6, v6, v90, v91
    s_waitcnt vmcnt(14)
    v_mfma_f32_16x16x32_bf16 v[8:11], a[136:139], v[92:95], v[8:11]
    v_max3_u32 v6, v6, v92, v93
    v_mfma_f32_16x16x32_bf16 v[12:15], a[140:143], v[92:95], v[12:15]
    v_max3_u32 v6, v6, v94, v95
    s_waitcnt vmcnt(13)
    v_mfma_f32_16x16x32_bf16 v[8:11], a[144:147], v[96:99], v[8:11]
    v_max3_u32 v6, v6, v96, v97
    v_mfma_f32_16x16x32_bf16 v[12:15], a[148:151], v[96:99], v[12:15]
    v_max3_u32 v6, v6, v98, v99
    s_waitcnt vmcnt(12)
    v_mfma_f32_16x16x32_bf16 v[8:11], a[152:155], v[100:103], v[8:11]
    v_max3_u32 v6, v6, v100, v101
    v_mfma_f32_16x16x32_bf16 v[12:15], a[156:159], v[100:103], v[12:15]
    v_max3_u32 v6, v6, v102, v103
    s_waitcnt vmcnt(11)
    v_mfma_f32_16x16x32_bf16 v[8:11], a[160:163], v[104:107], v[8:11]
    v_max3_u32 v6, v6, v104, v105
    v_mfma_f32_16x16x32_bf16 v[12:15], a[164:167], v[104:107], v[12:15]
    v_max3_u32 v6, v6, v106, v107
    s_waitcnt vmcnt(10)
    v_mfma_f32_16x16x32_bf16 v[8:11], a[168:171], v[108:111], v[8:11]
    v_max3_u32 v6, v6, v108, v109
    v_mfma_f32_16x16x32_bf16 v[12:15], a[172:175], v[108:111], v[12:15]
    v_max3_u32 v6, v6, v110, v111
    s_waitcnt vmcnt(9)
    v_mfma_f32_16x16x32_bf16 v[8:11], a[176:179], v[112:115], v[8:11]
    v_max3_u32 v6, v6, v112, v113
    v_mfma_f32_16x16x32_bf16 v[12:15], a[180:183], v[112:115], v[12:15]
    v_max3_u32 v6, v6, v114, v115
    s_waitcnt vmcnt(8)
    v_mfma_f32_16x16x32_bf16 v[8:11], a[184:187], v[116:119], v[8:11]
    v_max3_u32 v6, v6, v116, v117
    v_mfma_f32_16x16x32_bf16 v[12:15], a[188:191], v[116:119], v[12:15]
    v_max3_u32 v6, v6, v118, v119
    s_waitcnt vmcnt(7)
    v_mfma_f32_16x16x32_bf16 v[8:11], a[192:195], v[120:123], v[8:11]
    v_max3_u32 v6, v6, v120, v121
    v_mfma_f32_16x16x32_bf16 v[12:15], a[196:199], v[120:123], v[12:15]
    v_max3_u32 v6, v6, v122, v123
    s_waitcnt vmcnt(6)
    v_mfma_f32_16x16x32_bf16 v[8:11], a[200:203], v[124:127], v[8:11]
    v_max3_u32 v6, v6, v124, v125
    v_mfma_f32_16x16x32_bf16 v[12:15], a[204:207], v[124:127], v[12:15]
    v_max3_u32 v6, v6, v126, v127
    s_waitcnt vmcnt(5)
    v_mfma_f32_16x16x32_bf16 v[8:11], a[208:211], v[128:131], v[8:11]
    v_max3_u32 v6, v6, v128, v129
    v_mfma_f32_16x16x32_bf16 v[12:15], a[212:215], v[128:131], v[12:15]
    v_max3_u32 v6, v6, v130, v131
    s_waitcnt vmcnt(4)
    v_mfma_f32_16x16x32_bf16 v[8:11], a[216:219], v[132:135], v[8:11]
    v_max3_u32 v6, v6, v132, v133
    v_mfma_f32_16x16x32_bf16 v[12:15], a[220:223], v[132:135], v[12:15]
    v_max3_u32 v6, v6, v134, v135
    s_waitcnt vmcnt(3)
    v_mfma_f32_16x16x32_bf16 v[8:11], a[224:227], v[136:139], v[8:11]
    v_max3_u32 v6, v6, v136, v137
    v_mfma_f32_16x16x32_bf16 v[12:15], a[228:231], v[136:139], v[12:15]
    v_max3_u32 v6, v6, v138, v139
    s_waitcnt vmcnt(2)
    v_mfma_f32_16x16x32_bf16 v[8:11], a[232:235], v[140:143], v[8:11]
    v_max3_u32 v6, v6, v140, v141
    v_mfma_f32_16x16x32_bf16 v[12:15], a[236:239], v[140:143], v[12:15]
    v_max3_u32 v6, v6, v142, v143
    s_waitcnt vmcnt(1)
    v_mfma_f32_16x16x32_bf16 v[8:11], a[240:243], v[144:147], v[8:11]
    v_max3_u32 v6, v6, v144, v145
    v_mfma_f32_16x16x32_bf16 v[12:15], a[244:247], v[144:147], v[12:15]
    v_max3_u32 v6, v6, v146, v147
    s_waitcnt vmcnt(0)
    v_mfma_f32_16x16x32_bf16 v[8:11], a[248:251], v[148:151], v[8:11]
    v_max3_u32 v6, v6, v148, v149
    v_mfma_f32_16x16x32_bf16 v[12:15], a[252:255], v[148:151], v[12:15]
    v_max3_u32 v6, v6, v150, v151
    v_cmp_eq_u32 vcc, -1, v6
    s_cbranch_vccz o1_ok
    s_cmp_eq_u32 s46, 0
    s_cbranch_scc1 o1_ok
    s_mov_b32 s46, 0
    s_nop 1
    v_mbcnt_lo_u32_b32 v2, -1, 0
    v_mbcnt_hi_u32_b32 v2, -1, v2
    v_min_u32 v2, 1, v2
    v_lshlrev_b32 v2, 2, v2
    s_mov_b32 s88, 4194304
fw24:
    buffer_load_dword v3, v2, s[4:7], s89 offen offset:0 sc1
    s_sub_u32 s88, s88, 1
    s_cbranch_scc1 fw24x
    s_waitcnt vmcnt(0)
    v_cmp_ne_u32 vcc, s95, v3
    s_cbranch_vccz fw24x
    s_sleep 1
    s_branch fw24
fw24x:
    s_branch o1_again
o1_ok:
    s_nop 7
    ds_write_b128 v2, v[8:11] offset:0
    ds_write_b128 v2, v[12:15] offset:1024
    s_cmp_lg_u32 s32, 0
    s_cbranch_scc1 o1_nb
    v_cmp_eq_u32 vcc, 0, v253
    s_nop 0
    s_cmp_eq_u64 vcc, 0
    s_cselect_b32 s44, 65536, 0
    v_or_b32 v250, s44, v250
    v_mov_b32 v251, 163832
    s_mov_b64 exec, 1
    ds_write_b32 v251, v250
    s_mov_b64 exec, -1
o1_nb:
    s_waitcnt lgkmcnt(0)
    s_barrier
    s_cmp_gt_u32 s32, 0
    s_cbranch_scc1 o1_skip
    s_lshl_b32 s18, s32, 13
    v_add_u32 v2, s18, v1
    ds_read_b128 v[24:27], v2 offset:0
    ds_read_b128 v[28:31], v2 offset:1024
    ds_read_b128 v[32:35], v2 offset:2048
    ds_read_b128 v[36:39], v2 offset:3072
    ds_read_b128 v[40:43], v2 offset:4096
    ds_read_b128 v[44:47], v2 offset:5120
    ds_read_b128 v[48:51], v2 offset:6144
    ds_read_b128 v[52:55], v2 offset:7168
    v_lshrrev_b32 v3, 4, v1
    v_bfe_u32 v4, v3, 2, 2
    v_lshlrev_b32 v4, 3, v4
    v_and_b32 v2, 3, v3
    v_add_u32 v4, v4, v2
    v_mul_u32_u24 v4, 2304, v4
    v_lshrrev_b32 v3, 4, v3
    v_lshl_add_u32 v4, v3, 4, v4
    s_add_u32 s20, s16, s32
    s_lshr_b32 s18, s20, 1
    s_lshl_b32 s18, s18, 3
    s_and_b32 s19, s20, 1
    s_add_u32 s18, s18, s19
    s_mul_i32 s18, s18, 9216
    s_lshl_b32 s19, s33, 6
    s_add_u32 s18, s18, s19
    s_waitcnt lgkmcnt(0)
    v_pk_add_f32 v[24:25], v[24:25], v[32:33]
    v_pk_add_f32 v[40:41], v[40:41], v[48:49]
    v_pk_add_f32 v[24:25], v[24:25], v[40:41]
    v_pk_add_f32 v[26:27], v[26:27], v[34:35]
    v_pk_add_f32 v[42:43], v[42:43], v[50:51]
    v_pk_add_f32 v[26:27], v[26:27], v[42:43]
    v_pk_add_f32 v[28:29], v[28:29], v[36:37]
    v_pk_add_f32 v[44:45], v[44:45], v[52:53]
    v_pk_add_f32 v[28:29], v[28:29], v[44:45]
    v_pk_add_f32 v[30:31], v[30:31], v[38:39]
    v_pk_add_f32 v[46:47], v[46:47], v[54:55]
    v_pk_add_f32 v[30:31], v[30:31], v[46:47]
    v_cvt_pk_bf16_f32 v8, v24, v28
    v_cvt_pk_bf16_f32 v9, v25, v29
    v_cvt_pk_bf16_f32 v10, v26, v30
    v_cvt_pk_bf16_f32 v11, v27, v31
    buffer_store_dwordx4 v[8:11], v4, s[8:11], s18 offen
o1_skip:
    s_nop 1
L_op_fin:
    v_mov_b32 v251, 163832
    ds_read_b32 v252, v251
    s_waitcnt lgkmcnt(0)
    v_readfirstlane_b32 s40, v252
    s_nop 1
    s_cmp_ge_u32 s40, 65604
    s_cbranch_scc1 L_done
    s_barrier
    s_and_b32 s16, s40, 0xffff
    s_cmp_lt_u32 s16, 68
    s_cbranch_scc1 L_op_seg
L_op_nextcb:
    s_mov_b32 s40, -1
    s_cmp_lg_u32 s32, 0
    s_cbranch_scc1 L_op_dec
    v_and_b32 v1, 63, v0
    v_min_u32 v1, 17, v1
    v_lshlrev_b32 v2, 2, v1
    buffer_load_dword v3, v2, s[84:87], 0 offen offset:136 sc1
    s_waitcnt vmcnt(0)
    v_cmp_gt_u32 vcc, 52, v3
    s_nop 0
    s_and_b32 s40, vcc_lo, 262143
    s_lshl_b32 s41, s40, 18
    s_lshr_b32 s43, s40, 14
    s_or_b32 s42, s40, s41
    s_and_b32 s36, s45, 15
    s_bfm_b32 s37, s36, 0
    s_and_b32 s37, s37, 42315
    s_bcnt1_i32_b32 s37, s37
    s_lshr_b32 s36, s45, 4
    s_mul_i32 s36, s36, 8
    s_add_u32 s36, s36, s37
    s_add_u32 s36, s36, 38
    s_mul_hi_u32 s41, s36, 0x0e38e38f
    s_mul_i32 s41, s41, 18
    s_sub_u32 s41, s36, s41
    s_lshr_b64 s[42:43], s[42:43], s41
    s_ff1_i32_b64 s40, s[42:43]
    s_cmp_lt_i32 s40, 0
    s_cbranch_scc1 L_op_dec
    s_add_u32 s40, s40, s41
    s_sub_u32 s41, s40, 18
    s_cselect_b32 s40, s40, s41
L_op_dec:
    v_mov_b32 v250, s40
    v_mov_b32 v251, 163832
    s_cmp_lg_u32 s32, 0
    s_cbranch_scc1 L_op_nw
    ds_write_b32 v251, v250
    s_waitcnt lgkmcnt(0)
L_op_nw:
    s_barrier
    ds_read_b32 v252, v251
    s_waitcnt lgkmcnt(0)
    v_readfirstlane_b32 s33, v252
    s_barrier
    s_nop 1
    s_cmp_lt_u32 s33, 18
    s_cbranch_scc1 L_op_start
L_done:
L_exit:
    s_endpgm
.section .rodata,"a"
.p2align 6
.amdhsa_kernel concat_heads__memory_aug_recurrent_mem_tr__ssm_conv_s4d__prompt_kernel
  .amdhsa_next_free_vgpr 512
  .amdhsa_next_free_sgpr 102
  .amdhsa_accum_offset 256
  .amdhsa_group_segment_fixed_size 0
  .amdhsa_kernarg_size 136
  .amdhsa_user_sgpr_count 2
  .amdhsa_user_sgpr_kernarg_segment_ptr 1
  .amdhsa_system_sgpr_workgroup_id_x 1
.end_amdhsa_kernel
.text
```

```asm
; @launch grid=(256,1,1) block=(256,1,1) lds=163840
.amdgcn_target "amdgcn-amd-amdhsa--gfx950"
.text
.globl concat_heads__memory_aug_recurrent_mem_tr__ssm_conv_s4d__prompt_kernel
.p2align 8
.type concat_heads__memory_aug_recurrent_mem_tr__ssm_conv_s4d__prompt_kernel,@function
concat_heads__memory_aug_recurrent_mem_tr__ssm_conv_s4d__prompt_kernel:
    s_cmp_ge_u32 s2, 256
    s_cbranch_scc1 L_exit
    s_load_dwordx4 s[80:83], s[0:1], 120
    s_load_dwordx16 s[48:63], s[0:1], 0
    s_memrealtime s[90:91]
    v_lshrrev_b32 v1, 6, v0
    s_nop 0
    v_readfirstlane_b32 s32, v1
    s_waitcnt lgkmcnt(0)
    s_mov_b32 s4, s82
    s_mov_b32 s5, s83
    s_mov_b32 s6, 268435456
    s_mov_b32 s7, 0x20000
    s_mov_b32 s84, s80
    s_mov_b32 s85, s81
    s_mov_b32 s86, 256
    s_mov_b32 s87, 0x20000
    s_cmp_lg_u32 s32, 0
    s_cbranch_scc1 L_nod0
L_nod0:
    s_cmp_lg_u32 s32, 3
    s_cbranch_scc1 L_nowarm
    s_getpc_b64 s[44:45]
L_pcw:
    v_and_b32 v1, 63, v0
    v_lshlrev_b32 v1, 7, v1
    s_mul_hi_u32 s46, s2, 477218589
    s_mul_i32 s47, s46, 9
    s_sub_u32 s47, s2, s47
    s_add_u32 s46, s46, s47
    s_mul_hi_u32 s40, s46, 477218589
    s_mul_i32 s40, s40, 9
    s_sub_u32 s46, s46, s40
    s_lshl_b32 s47, s47, 13
    v_add_u32 v2, s47, v1
    v_min_u32 v2, L_exit-L_pcw, v2
    global_load_dword v240, v2, s[44:45]
    s_lshl_b32 s46, s46, 13
    v_add_u32 v2, s46, v1
    v_min_u32 v2, L_exit-L_pcw, v2
    global_load_dword v241, v2, s[44:45]
L_nowarm:
    s_getreg_b32 s3, hwreg(HW_REG_XCC_ID)
    s_and_b32 s3, s3, 15
    s_cmp_lg_u32 s3, 3
    s_cbranch_scc1 L_helper
    s_mov_b32 s37, 128
    v_mov_b32 v250, 1
    v_mov_b32 v251, 163832
    v_cmp_eq_u32 vcc, 0, v0
    s_nop 0
    s_and_saveexec_b64 s[38:39], vcc
    s_cbranch_execz tk1
    buffer_atomic_add v250, off, s[84:87], s37 sc0
    s_waitcnt vmcnt(0)
    ds_write_b32 v251, v250
    s_waitcnt lgkmcnt(0)
tk1:
    s_mov_b64 exec, -1
    s_barrier
    ds_read_b32 v252, v251
    s_waitcnt lgkmcnt(0)
    v_readfirstlane_b32 s12, v252
    s_barrier
    s_nop 3
    s_cmp_ge_u32 s12, 32
    s_cbranch_scc1 L_helper
L_chain:
    s_mov_b64 s[48:49], s[50:51]
    s_mov_b64 s[50:51], s[52:53]
    s_mov_b64 s[52:53], s[54:55]
    s_mov_b64 s[54:55], s[56:57]
    s_mov_b64 s[56:57], s[58:59]
    v_lshrrev_b32 v77, 6, v0
    s_nop 0
    v_readfirstlane_b32 s13, v77
    v_lshlrev_b32 v65, 4, v0
    v_and_b32 v48, 63, v0
    s_mov_b32 s10, 4718592
    s_mov_b32 s11, 0x20000
    v_lshrrev_b32 v49, 3, v48
    v_mul_u32_u24 v18, 1152, v49
    v_and_b32 v49, 7, v48
    v_lshl_add_u32 v18, v49, 4, v18
    s_mul_i32 s40, s12, 147456
    s_lshl_b32 s41, s13, 8
    s_add_u32 s40, s40, s41
    s_mov_b32 s42, s40
    s_xor_b32 s41, s13, 0
    s_mul_i32 s41, s41, 36864
    s_add_u32 s60, s41, s40
    s_xor_b32 s41, s13, 1
    s_mul_i32 s41, s41, 36864
    s_add_u32 s61, s41, s40
    s_xor_b32 s41, s13, 2
    s_mul_i32 s41, s41, 36864
    s_add_u32 s62, s41, s40
    s_xor_b32 s41, s13, 3
    s_mul_i32 s41, s41, 36864
    s_add_u32 s63, s41, s40
    s_lshl_b32 s43, s13, 12
    s_mov_b64 s[8:9], s[56:57]
    s_add_u32 m0, s43, 147456
    s_add_u32 s41, s60, 0
    buffer_load_dwordx4 v18, s[8:11], s41 offen offset:0 nt lds
    s_add_u32 s41, s60, 8192
    buffer_load_dwordx4 v18, s[8:11], s41 offen offset:1024 nt lds
    s_add_u32 s41, s60, 16384
    buffer_load_dwordx4 v18, s[8:11], s41 offen offset:2048 nt lds
    s_add_u32 s41, s60, 24576
    buffer_load_dwordx4 v18, s[8:11], s41 offen offset:3072 nt lds
    s_add_u32 m0, s43, 0
    s_add_u32 s41, s61, 0
    buffer_load_dwordx4 v18, s[8:11], s41 offen offset:0 nt lds
    s_add_u32 s41, s61, 8192
    buffer_load_dwordx4 v18, s[8:11], s41 offen offset:1024 nt lds
    s_add_u32 s41, s61, 16384
    buffer_load_dwordx4 v18, s[8:11], s41 offen offset:2048 nt lds
    s_add_u32 s41, s61, 24576
    buffer_load_dwordx4 v18, s[8:11], s41 offen offset:3072 nt lds
    s_add_u32 m0, s43, 36864
    s_add_u32 s41, s62, 0
    buffer_load_dwordx4 v18, s[8:11], s41 offen offset:0 nt lds
    s_add_u32 s41, s62, 8192
    buffer_load_dwordx4 v18, s[8:11], s41 offen offset:1024 nt lds
    s_add_u32 s41, s62, 16384
    buffer_load_dwordx4 v18, s[8:11], s41 offen offset:2048 nt lds
    s_add_u32 s41, s62, 24576
    buffer_load_dwordx4 v18, s[8:11], s41 offen offset:3072 nt lds
    s_add_u32 m0, s43, 73728
    s_add_u32 s41, s63, 0
    buffer_load_dwordx4 v18, s[8:11], s41 offen offset:0 nt lds
    s_add_u32 s41, s63, 8192
    buffer_load_dwordx4 v18, s[8:11], s41 offen offset:1024 nt lds
    s_add_u32 s41, s63, 16384
    buffer_load_dwordx4 v18, s[8:11], s41 offen offset:2048 nt lds
    s_add_u32 s41, s63, 24576
    buffer_load_dwordx4 v18, s[8:11], s41 offen offset:3072 nt lds
    v_lshrrev_b32 v49, 1, v48
    v_mul_u32_u24 v19, 1152, v49
    v_and_b32 v49, 1, v48
    v_lshl_add_u32 v19, v49, 4, v19
    s_mul_i32 s41, s13, 224
    s_sub_u32 s41, 1024, s41
    v_add_u32 v19, s41, v19
    v_lshrrev_b32 v49, 4, v48
    v_lshlrev_b32 v50, 2, v49
    v_and_b32 v51, 15, v48
    v_xor_b32 v51, v51, v50
    v_lshlrev_b32 v51, 4, v51
    v_lshl_add_u32 v16, v49, 15, v51
    v_lshrrev_b32 v50, 1, v49
    v_lshl_add_u32 v17, v50, 16, v51
    v_and_b32 v50, 1, v49
    v_lshl_add_u32 v17, v50, 13, v17
    s_lshl_b32 s40, s12, 8
    s_mul_i32 s58, s13, 1048576
    s_add_u32 s58, s58, s40
    s_lshr_b32 s41, s13, 1
    s_mul_i32 s59, s41, 262144
    s_and_b32 s41, s13, 1
    s_lshl_b32 s41, s41, 14
    s_add_u32 s59, s59, s41
    s_add_u32 s59, s59, s40
    s_add_u32 s59, s59, 4194304
    s_lshr_b32 s71, s52, 8
    s_add_u32 s71, s71, s12
    s_and_b32 s71, s71, 3
    v_bfe_u32 v50, v48, 2, 2
    v_xor_b32 v51, s13, v50
    v_lshlrev_b32 v20, 6, v51
    v_and_b32 v51, 3, v48
    v_lshl_add_u32 v20, v51, 4, v20
    v_lshrrev_b32 v23, 2, v48
    v_lshl_add_u32 v20, v23, 8, v20
    s_xor_b32 s41, s43, 0
    v_add_u32 v24, s41, v20
    s_xor_b32 s41, s43, 4096
    v_add_u32 v25, s41, v20
    s_xor_b32 s41, s43, 8192
    v_add_u32 v26, s41, v20
    s_xor_b32 s41, s43, 12288
    v_add_u32 v27, s41, v20
    v_and_b32 v23, 1, v50
    v_lshl_add_u32 v23, v49, 2, v23
    v_lshrrev_b32 v50, 1, v50
    v_lshlrev_b32 v21, 7, v23
    v_lshl_add_u32 v21, v50, 6, v21
    v_lshrrev_b32 v16, 1, v51
    v_lshl_add_u32 v21, v16, 5, v21
    v_and_b32 v16, 1, v51
    v_lshl_add_u32 v21, v16, 3, v21
    v_add_u32 v21, s43, v21
    v_lshlrev_b32 v22, 9, v50
    v_xor_b32 v22, v22, v21
    v_lshlrev_b32 v23, 5, v23
    v_lshl_add_u32 v23, v50, 10, v23
    v_lshl_add_u32 v23, v51, 3, v23
    v_add_u32 v23, s43, v23
    v_bfe_u32 v60, v65, 4, 6
    v_and_b32 v61, 15, v60
    v_lshrrev_b32 v62, 4, v60
    v_mov_b32 v64, 0x4444
    v_mov_b32 v77, 0xeeee
    v_cmp_lt_u32 vcc, 7, v61
    s_nop 1
    v_cndmask_b32 v64, v64, v77, vcc
    v_xor_b32 v66, 1024, v65
    v_xor_b32 v67, 2048, v65
    v_xor_b32 v68, 3072, v65
    v_and_b32 v69, 511, v65
    s_mul_i32 s96, s13, 36864
    s_add_u32 s96, s96, 16384
    v_lshlrev_b32 v70, 4, v60
    v_add_u32 v70, s96, v70
    v_lshrrev_b32 v79, 1, v69
    s_lshl_b32 s96, s13, 8
    s_add_u32 s96, s96, 14336
    s_lshl_b32 s33, s13, 10
    s_add_u32 s97, s33, 8192
    v_mov_b32 v77, s97
    v_mov_b32 v78, s96
    v_cmp_lt_u32 vcc, 31, v60
    s_nop 1
    v_cndmask_b32 v71, v77, v78, vcc
    v_add_u32 v71, v71, v79
    v_and_b32 v77, 7, v61
    v_lshrrev_b32 v78, 3, v61
    v_lshlrev_b32 v74, 4, v77
    v_lshl_add_u32 v73, v62, 7, v74
    v_lshl_add_u32 v73, v78, 3, v73
    s_lshl_b32 s96, s13, 9
    v_add_u32 v73, s96, v73
    v_lshrrev_b32 v74, 1, v74
    v_lshl_add_u32 v74, v78, 14, v74
    v_lshl_add_u32 v74, v62, 15, v74
    s_lshl_b32 s96, s13, 17
    v_add_u32 v74, s96, v74
    v_bfe_u32 v77, v61, 2, 1
    v_and_b32 v78, 3, v61
    s_cmp_lt_u32 s13, 2
    s_cselect_b64 vcc, -1, 0
    v_cndmask_b32 v77, 0, v77, vcc
    v_lshlrev_b32 v75, 7, v77
    v_lshl_add_u32 v75, v62, 4, v75
    v_lshl_add_u32 v75, v78, 2, v75
    v_lshlrev_b32 v58, 3, v77
    v_lshl_add_u32 v58, v78, 1, v58
    s_bfe_u32 s97, s12, 0x10001
    s_lshl_b32 s68, s97, 6
    s_lshl_b32 s97, s97, 2
    v_add_u32 v59, s97, v62
    s_bfe_u32 s96, s12, 0x10002
    s_and_b32 s40, s12, 1
    s_lshl_b32 s96, s96, 1
    s_add_u32 s96, s96, s40
    s_lshr_b32 s97, s12, 3
    s_lshl_b32 s98, s13, 2
    s_add_u32 s98, s98, s97
    s_lshl_b32 s98, s98, 2
    s_add_u32 s98, s98, s96
    s_lshl_b32 s98, s98, 8
    s_lshl_b32 s99, s13, 2
    s_add_u32 s99, s99, s96
    s_lshl_b32 s99, s99, 4
    s_lshl_b32 s41, s97, 1
    s_add_u32 s41, s41, s40
    s_lshl_b32 s41, s41, 7
    s_add_u32 s41, s41, 8192
    s_lshl_b32 s40, s40, 3
    s_add_u32 s40, s40, 512
    s_cmp_lt_u32 s13, 2
    s_cselect_b32 s96, 7, 4
    s_cselect_b32 s98, s98, s41
    s_cselect_b32 s99, s99, s40
    s_cselect_b32 s32, 1, 0
    s_add_u32 s68, s68, s98
    s_lshl_b32 s97, s97, s96
    s_add_u32 s99, s99, s97
    v_add_u32 v58, s99, v58
    s_and_b32 s97, s12, 4
    s_or_b32 s97, s97, s13
    s_cmp_eq_u32 s97, 2
    s_cselect_b32 s32, 2, s32
    s_mov_b32 s8, s48
    s_mov_b32 s9, s49
    s_mov_b32 s10, 9216
    v_mul_u32_u24 v77, 1152, v59
    v_lshl_add_u32 v77, v58, 1, v77
    buffer_load_dword v72, v77, s[8:11], 0 offen
    s_mov_b32 s10, 4718592
    s_waitcnt vmcnt(12) lgkmcnt(0)
    s_barrier
    s_cmp_eq_u32 s71, 1
    s_cbranch_scc1 cf_th0
    s_waitcnt vmcnt(6)
cf_th0:
    s_mov_b64 s[8:9], s[56:57]
    s_add_u32 m0, s43, 110592
    s_add_u32 s41, s42, 0
    buffer_load_dwordx4 v19, s[8:11], s41 offen offset:0 nt lds
    s_add_u32 s41, s42, 35840
    buffer_load_dwordx4 v19, s[8:11], s41 offen offset:1024 nt lds
    s_add_u32 s41, s42, 71680
    buffer_load_dwordx4 v19, s[8:11], s41 offen offset:2048 nt lds
    s_add_u32 s41, s42, 107520
    buffer_load_dwordx4 v19, s[8:11], s41 offen offset:3072 nt lds
    v_add_u32 v77, 147456, v22
    ds_read_b64_tr_b16 v[80:81], v77 offset:0
    ds_read_b64_tr_b16 v[82:83], v77 offset:256
    ds_read_b64_tr_b16 v[84:85], v77 offset:2048
    ds_read_b64_tr_b16 v[86:87], v77 offset:2304
    ds_read_b64_tr_b16 v[112:113], v77 offset:16
    ds_read_b64_tr_b16 v[114:115], v77 offset:272
    ds_read_b64_tr_b16 v[116:117], v77 offset:2064
    ds_read_b64_tr_b16 v[118:119], v77 offset:2320
    s_waitcnt vmcnt(12) lgkmcnt(0)
    s_barrier
    s_cmp_eq_u32 s71, 1
    s_cbranch_scc1 cf_th1
    s_waitcnt vmcnt(6)
cf_th1:
    s_mov_b64 s[8:9], s[52:53]
    s_add_u32 m0, s43, 147456
    s_add_u32 s41, s58, 0
    buffer_load_dwordx4 v17, s[8:11], s41 offen offset:0 nt lds
    s_add_u32 s41, s58, 31744
    buffer_load_dwordx4 v17, s[8:11], s41 offen offset:1024 nt lds
    s_add_u32 s41, s58, 129024
    buffer_load_dwordx4 v17, s[8:11], s41 offen offset:2048 nt lds
    s_add_u32 s41, s58, 160768
    buffer_load_dwordx4 v17, s[8:11], s41 offen offset:3072 nt lds
    v_add_u32 v77, 0, v21
    ds_read_b64_tr_b16 v[88:89], v77 offset:0
    ds_read_b64_tr_b16 v[90:91], v77 offset:256
    ds_read_b64_tr_b16 v[92:93], v77 offset:2048
    ds_read_b64_tr_b16 v[94:95], v77 offset:2304
    ds_read_b64_tr_b16 v[120:121], v77 offset:16
    ds_read_b64_tr_b16 v[122:123], v77 offset:272
    ds_read_b64_tr_b16 v[124:125], v77 offset:2064
    ds_read_b64_tr_b16 v[126:127], v77 offset:2320
    s_waitcnt vmcnt(12) lgkmcnt(0)
    s_barrier
    s_cmp_eq_u32 s71, 1
    s_cbranch_scc1 cf_th2
    s_waitcnt vmcnt(6)
cf_th2:
    s_add_u32 m0, s43, 0
    s_add_u32 s41, s58, 16384
    buffer_load_dwordx4 v17, s[8:11], s41 offen offset:0 nt lds
    s_add_u32 s41, s58, 48128
    buffer_load_dwordx4 v17, s[8:11], s41 offen offset:1024 nt lds
    s_add_u32 s41, s58, 145408
    buffer_load_dwordx4 v17, s[8:11], s41 offen offset:2048 nt lds
    s_add_u32 s41, s58, 177152
    buffer_load_dwordx4 v17, s[8:11], s41 offen offset:3072 nt lds
    v_add_u32 v77, 36864, v21
    ds_read_b64_tr_b16 v[96:97], v77 offset:0
    ds_read_b64_tr_b16 v[98:99], v77 offset:256
    ds_read_b64_tr_b16 v[100:101], v77 offset:2048
    ds_read_b64_tr_b16 v[102:103], v77 offset:2304
    ds_read_b64_tr_b16 v[128:129], v77 offset:16
    ds_read_b64_tr_b16 v[130:131], v77 offset:272
    ds_read_b64_tr_b16 v[132:133], v77 offset:2064
    ds_read_b64_tr_b16 v[134:135], v77 offset:2320
    s_waitcnt vmcnt(12) lgkmcnt(0)
    s_barrier
    s_cmp_eq_u32 s71, 1
    s_cbranch_scc1 cf_th3
    s_waitcnt vmcnt(6)
cf_th3:
    s_mov_b64 s[8:9], s[54:55]
    s_add_u32 m0, s43, 36864
    s_add_u32 s41, s58, 0
    buffer_load_dwordx4 v17, s[8:11], s41 offen offset:0 nt lds
    s_add_u32 s41, s58, 31744
    buffer_load_dwordx4 v17, s[8:11], s41 offen offset:1024 nt lds
    s_add_u32 s41, s58, 129024
    buffer_load_dwordx4 v17, s[8:11], s41 offen offset:2048 nt lds
    s_add_u32 s41, s58, 160768
    buffer_load_dwordx4 v17, s[8:11], s41 offen offset:3072 nt lds
    v_add_u32 v77, 73728, v21
    ds_read_b64_tr_b16 v[104:105], v77 offset:0
    ds_read_b64_tr_b16 v[106:107], v77 offset:256
    ds_read_b64_tr_b16 v[108:109], v77 offset:2048
    ds_read_b64_tr_b16 v[110:111], v77 offset:2304
    ds_read_b64_tr_b16 v[136:137], v77 offset:16
    ds_read_b64_tr_b16 v[138:139], v77 offset:272
    ds_read_b64_tr_b16 v[140:141], v77 offset:2064
    ds_read_b64_tr_b16 v[142:143], v77 offset:2320
    s_waitcnt vmcnt(12) lgkmcnt(0)
    s_barrier
    s_cmp_eq_u32 s71, 1
    s_cbranch_scc1 cf_th4
    s_waitcnt vmcnt(6)
cf_th4:
    s_add_u32 m0, s43, 73728
    s_add_u32 s41, s58, 16384
    buffer_load_dwordx4 v17, s[8:11], s41 offen offset:0 nt lds
    s_add_u32 s41, s58, 48128
    buffer_load_dwordx4 v17, s[8:11], s41 offen offset:1024 nt lds
    s_add_u32 s41, s58, 145408
    buffer_load_dwordx4 v17, s[8:11], s41 offen offset:2048 nt lds
    s_add_u32 s41, s58, 177152
    buffer_load_dwordx4 v17, s[8:11], s41 offen offset:3072 nt lds
    v_add_u32 v77, 110592, v23
    ds_read_b64_tr_b16 v[0:1], v77 offset:0
    ds_read_b64_tr_b16 v[2:3], v77 offset:64
    ds_read_b64_tr_b16 v[4:5], v77 offset:512
    ds_read_b64_tr_b16 v[6:7], v77 offset:576
    ds_read_b64_tr_b16 v[8:9], v77 offset:2048
    ds_read_b64_tr_b16 v[10:11], v77 offset:2112
    ds_read_b64_tr_b16 v[12:13], v77 offset:2560
    ds_read_b64_tr_b16 v[14:15], v77 offset:2624
    s_waitcnt vmcnt(12) lgkmcnt(0)
    s_barrier
    s_cmp_eq_u32 s71, 1
    s_cbranch_scc1 cf_th5
    s_waitcnt vmcnt(6)
cf_th5:
    s_mov_b64 s[8:9], s[50:51]
    s_add_u32 m0, s43, 110592
    s_add_u32 s41, s58, 0
    buffer_load_dwordx4 v17, s[8:11], s41 offen offset:0 nt lds
    s_add_u32 s41, s58, 31744
    buffer_load_dwordx4 v17, s[8:11], s41 offen offset:1024 nt lds
    s_add_u32 s41, s58, 129024
    buffer_load_dwordx4 v17, s[8:11], s41 offen offset:2048 nt lds
    s_add_u32 s41, s58, 160768
    buffer_load_dwordx4 v17, s[8:11], s41 offen offset:3072 nt lds
    s_cmp_eq_u32 s32, 0
    s_cbranch_scc1 cf_init_done
    v_mov_b32 v52, 1
    v_mov_b32 v53, 1
    v_mov_b32 v54, 1
    v_mov_b32 v55, 1
    v_mov_b32 v56, 0
    s_lshl_b32 s96, s12, 14
    s_add_u32 s96, s96, 68157440
    s_add_u32 s97, s96, 0
    buffer_store_dwordx4 v[52:55], v65, s[4:7], s97 offen
    buffer_load_dwordx4 v[60:63], v65, s[4:7], s97 offen sc1
    s_add_u32 s97, s96, 4096
    buffer_store_dwordx4 v[52:55], v65, s[4:7], s97 offen
    buffer_load_dwordx4 v[60:63], v65, s[4:7], s97 offen sc1
    s_add_u32 s97, s96, 8192
    buffer_store_dwordx4 v[52:55], v65, s[4:7], s97 offen
    buffer_load_dwordx4 v[60:63], v65, s[4:7], s97 offen sc1
    s_add_u32 s97, s96, 12288
    buffer_store_dwordx4 v[52:55], v65, s[4:7], s97 offen
    buffer_load_dwordx4 v[60:63], v65, s[4:7], s97 offen sc1
    s_add_u32 s96, s68, 67108864
    s_add_u32 s97, s96, 16384
    buffer_store_dword v56, v75, s[4:7], s96 offen offset:0
    buffer_store_dword v72, v75, s[4:7], s97 offen offset:0
    buffer_load_dword v60, v75, s[4:7], s96 offen offset:0 sc1
    buffer_load_dword v60, v75, s[4:7], s97 offen offset:0 sc1
    s_cmp_lg_u32 s32, 2
    s_cbranch_scc1 cf_init_done
    buffer_store_dword v56, v75, s[4:7], s96 offen offset:1024
    buffer_store_dword v72, v75, s[4:7], s97 offen offset:1024
    buffer_load_dword v60, v75, s[4:7], s96 offen offset:1024 sc1
    buffer_load_dword v60, v75, s[4:7], s97 offen offset:1024 sc1
    buffer_store_dword v56, v75, s[4:7], s96 offen offset:2048
    buffer_store_dword v72, v75, s[4:7], s97 offen offset:2048
    buffer_load_dword v60, v75, s[4:7], s96 offen offset:2048 sc1
    buffer_load_dword v60, v75, s[4:7], s97 offen offset:2048 sc1
    buffer_store_dword v56, v75, s[4:7], s96 offen offset:3072
    buffer_store_dword v72, v75, s[4:7], s97 offen offset:3072
    buffer_load_dword v60, v75, s[4:7], s96 offen offset:3072 sc1
    buffer_load_dword v60, v75, s[4:7], s97 offen offset:3072 sc1
cf_init_done:
    ds_write_b64 v70, v[0:1] offset:16384
    ds_write_b64 v70, v[2:3] offset:16392
    ds_write_b64 v70, v[4:5] offset:17408
    ds_write_b64 v70, v[6:7] offset:17416
    ds_write_b64 v70, v[8:9] offset:18432
    ds_write_b64 v70, v[10:11] offset:18440
    ds_write_b64 v70, v[12:13] offset:19456
    ds_write_b64 v70, v[14:15] offset:19464
    v_add_u32 v28, 147456, v24
    v_add_u32 v29, 147456, v25
    v_add_u32 v30, 147456, v26
    v_add_u32 v31, 147456, v27
    ds_read_b64_tr_b16 a[96:97], v28 offset:0
    ds_read_b64_tr_b16 a[104:105], v28 offset:8
    ds_read_b64_tr_b16 a[112:113], v29 offset:0
    ds_read_b64_tr_b16 a[120:121], v29 offset:8
    ds_read_b64_tr_b16 a[128:129], v30 offset:0
    ds_read_b64_tr_b16 a[136:137], v30 offset:8
    ds_read_b64_tr_b16 a[144:145], v31 offset:0
    ds_read_b64_tr_b16 v[32:33], v31 offset:8
    s_waitcnt vmcnt(12) lgkmcnt(0)
    s_barrier
    s_cmp_eq_u32 s71, 1
    s_cbranch_scc1 cf_th6
    s_waitcnt vmcnt(6)
cf_th6:
    s_add_u32 m0, s43, 147456
    s_add_u32 s41, s58, 16384
    buffer_load_dwordx4 v17, s[8:11], s41 offen offset:0 nt lds
    s_add_u32 s41, s58, 48128
    buffer_load_dwordx4 v17, s[8:11], s41 offen offset:1024 nt lds
    s_add_u32 s41, s58, 145408
    buffer_load_dwordx4 v17, s[8:11], s41 offen offset:2048 nt lds
    s_add_u32 s41, s58, 177152
    buffer_load_dwordx4 v17, s[8:11], s41 offen offset:3072 nt lds
    ds_write_b64 v70, v[32:33] offset:12288
    v_add_u32 v28, 0, v24
    v_add_u32 v29, 0, v25
    v_add_u32 v30, 0, v26
    v_add_u32 v31, 0, v27
    ds_read_b64_tr_b16 a[98:99], v28 offset:0
    ds_read_b64_tr_b16 a[106:107], v28 offset:8
    ds_read_b64_tr_b16 a[114:115], v29 offset:0
    ds_read_b64_tr_b16 a[122:123], v29 offset:8
    ds_read_b64_tr_b16 a[130:131], v30 offset:0
    ds_read_b64_tr_b16 a[138:139], v30 offset:8
    ds_read_b64_tr_b16 a[146:147], v31 offset:0
    ds_read_b64_tr_b16 v[0:1], v31 offset:8
    s_waitcnt vmcnt(12) lgkmcnt(0)
    s_barrier
    s_cmp_eq_u32 s71, 1
    s_cbranch_scc1 cf_th7
    s_waitcnt vmcnt(6)
cf_th7:
    s_mov_b64 s[8:9], s[52:53]
    s_add_u32 m0, s43, 0
    s_add_u32 s41, s58, 262144
    buffer_load_dwordx4 v17, s[8:11], s41 offen offset:0 nt lds
    s_add_u32 s41, s58, 293888
    buffer_load_dwordx4 v17, s[8:11], s41 offen offset:1024 nt lds
    s_add_u32 s41, s58, 391168
    buffer_load_dwordx4 v17, s[8:11], s41 offen offset:2048 nt lds
    s_add_u32 s41, s58, 422912
    buffer_load_dwordx4 v17, s[8:11], s41 offen offset:3072 nt lds
    ds_write_b64 v70, v[0:1] offset:12296
    v_add_u32 v28, 36864, v24
    v_add_u32 v29, 36864, v25
    v_add_u32 v30, 36864, v26
    v_add_u32 v31, 36864, v27
    ds_read_b64_tr_b16 a[232:233], v28 offset:0
    ds_read_b64_tr_b16 v[32:33], v28 offset:8
    ds_read_b64_tr_b16 a[240:241], v29 offset:0
    ds_read_b64_tr_b16 a[248:249], v29 offset:8
    ds_read_b64_tr_b16 v[144:145], v30 offset:0
    ds_read_b64_tr_b16 v[152:153], v30 offset:8
    ds_read_b64_tr_b16 v[160:161], v31 offset:0
    ds_read_b64_tr_b16 v[168:169], v31 offset:8
    s_waitcnt vmcnt(12) lgkmcnt(0)
    s_barrier
    s_cmp_eq_u32 s71, 1
    s_cbranch_scc1 cf_th8
    s_waitcnt vmcnt(6)
cf_th8:
    s_add_u32 m0, s43, 36864
    s_add_u32 s41, s58, 278528
    buffer_load_dwordx4 v17, s[8:11], s41 offen offset:0 nt lds
    s_add_u32 s41, s58, 310272
    buffer_load_dwordx4 v17, s[8:11], s41 offen offset:1024 nt lds
    s_add_u32 s41, s58, 407552
    buffer_load_dwordx4 v17, s[8:11], s41 offen offset:2048 nt lds
    s_add_u32 s41, s58, 439296
    buffer_load_dwordx4 v17, s[8:11], s41 offen offset:3072 nt lds
    ds_write_b64 v70, v[32:33] offset:8192
    v_add_u32 v28, 73728, v24
    v_add_u32 v29, 73728, v25
    v_add_u32 v30, 73728, v26
    v_add_u32 v31, 73728, v27
    ds_read_b64_tr_b16 a[234:235], v28 offset:0
    ds_read_b64_tr_b16 v[0:1], v28 offset:8
    ds_read_b64_tr_b16 a[242:243], v29 offset:0
    ds_read_b64_tr_b16 a[250:251], v29 offset:8
    ds_read_b64_tr_b16 v[146:147], v30 offset:0
    ds_read_b64_tr_b16 v[154:155], v30 offset:8
    ds_read_b64_tr_b16 v[162:163], v31 offset:0
    ds_read_b64_tr_b16 v[170:171], v31 offset:8
    s_waitcnt vmcnt(12) lgkmcnt(0)
    s_barrier
    s_cmp_eq_u32 s71, 1
    s_cbranch_scc1 cf_th9
    s_waitcnt vmcnt(6)
cf_th9:
    s_mov_b64 s[8:9], s[54:55]
    s_add_u32 m0, s43, 73728
    s_add_u32 s41, s58, 262144
    buffer_load_dwordx4 v17, s[8:11], s41 offen offset:0 nt lds
    s_add_u32 s41, s58, 293888
    buffer_load_dwordx4 v17, s[8:11], s41 offen offset:1024 nt lds
    s_add_u32 s41, s58, 391168
    buffer_load_dwordx4 v17, s[8:11], s41 offen offset:2048 nt lds
    s_add_u32 s41, s58, 422912
    buffer_load_dwordx4 v17, s[8:11], s41 offen offset:3072 nt lds
    ds_write_b64 v70, v[0:1] offset:8200
    v_add_u32 v28, 110592, v24
    v_add_u32 v29, 110592, v25
    v_add_u32 v30, 110592, v26
    v_add_u32 v31, 110592, v27
    ds_read_b64_tr_b16 v[32:33], v28 offset:0
    ds_read_b64_tr_b16 v[34:35], v28 offset:8
    ds_read_b64_tr_b16 v[36:37], v29 offset:0
    ds_read_b64_tr_b16 v[38:39], v29 offset:8
    ds_read_b64_tr_b16 a[0:1], v30 offset:0
    ds_read_b64_tr_b16 v[40:41], v30 offset:8
    ds_read_b64_tr_b16 a[8:9], v31 offset:0
    ds_read_b64_tr_b16 v[42:43], v31 offset:8
    s_waitcnt vmcnt(12) lgkmcnt(0)
    s_barrier
    s_cmp_eq_u32 s71, 1
    s_cbranch_scc1 cf_th10
    s_waitcnt vmcnt(6)
cf_th10:
    s_add_u32 m0, s43, 110592
    s_add_u32 s41, s58, 278528
    buffer_load_dwordx4 v17, s[8:11], s41 offen offset:0 nt lds
    s_add_u32 s41, s58, 310272
    buffer_load_dwordx4 v17, s[8:11], s41 offen offset:1024 nt lds
    s_add_u32 s41, s58, 407552
    buffer_load_dwordx4 v17, s[8:11], s41 offen offset:2048 nt lds
    s_add_u32 s41, s58, 439296
    buffer_load_dwordx4 v17, s[8:11], s41 offen offset:3072 nt lds
    s_cmp_lg_u32 s13, 0
    s_cbranch_scc1 cf_ma
    v_mov_b32 v54, 1
    s_mov_b64 exec, 1
    buffer_atomic_add v54, off, s[84:87], 0 offset:132
    s_mov_b64 exec, -1
cf_ma:
    ds_write_b64 v70, v[32:33] offset:0
    ds_write_b64 v70, v[34:35] offset:2048
    ds_write_b64 v70, v[36:37] offset:4096
    ds_write_b64 v70, v[38:39] offset:6144
    ds_write_b64 v70, v[40:41] offset:10240
    ds_write_b64 v70, v[42:43] offset:14336
    v_add_u32 v28, 147456, v24
    v_add_u32 v29, 147456, v25
    v_add_u32 v30, 147456, v26
    v_add_u32 v31, 147456, v27
    ds_read_b64_tr_b16 v[0:1], v28 offset:0
    ds_read_b64_tr_b16 v[2:3], v28 offset:8
    ds_read_b64_tr_b16 v[4:5], v29 offset:0
    ds_read_b64_tr_b16 v[6:7], v29 offset:8
    ds_read_b64_tr_b16 a[2:3], v30 offset:0
    ds_read_b64_tr_b16 v[8:9], v30 offset:8
    ds_read_b64_tr_b16 a[10:11], v31 offset:0
    ds_read_b64_tr_b16 v[10:11], v31 offset:8
    s_waitcnt vmcnt(12) lgkmcnt(0)
    s_barrier
    s_cmp_eq_u32 s71, 1
    s_cbranch_scc1 cf_th11
    s_waitcnt vmcnt(6)
cf_th11:
    s_mov_b64 s[8:9], s[50:51]
    s_add_u32 m0, s43, 147456
    s_add_u32 s41, s58, 262144
    buffer_load_dwordx4 v17, s[8:11], s41 offen offset:0 nt lds
    s_add_u32 s41, s58, 293888
    buffer_load_dwordx4 v17, s[8:11], s41 offen offset:1024 nt lds
    s_add_u32 s41, s58, 391168
    buffer_load_dwordx4 v17, s[8:11], s41 offen offset:2048 nt lds
    s_add_u32 s41, s58, 422912
    buffer_load_dwordx4 v17, s[8:11], s41 offen offset:3072 nt lds
    ds_write_b64 v70, v[0:1] offset:8
    ds_write_b64 v70, v[2:3] offset:2056
    ds_write_b64 v70, v[4:5] offset:4104
    ds_write_b64 v70, v[6:7] offset:6152
    ds_write_b64 v70, v[8:9] offset:10248
    ds_write_b64 v70, v[10:11] offset:14344
    v_add_u32 v28, 0, v24
    v_add_u32 v29, 0, v25
    v_add_u32 v30, 0, v26
    v_add_u32 v31, 0, v27
    ds_read_b64_tr_b16 a[100:101], v28 offset:0
    ds_read_b64_tr_b16 a[108:109], v28 offset:8
    ds_read_b64_tr_b16 a[116:117], v29 offset:0
    ds_read_b64_tr_b16 a[124:125], v29 offset:8
    ds_read_b64_tr_b16 a[132:133], v30 offset:0
    ds_read_b64_tr_b16 a[140:141], v30 offset:8
    ds_read_b64_tr_b16 a[148:149], v31 offset:0
    ds_read_b64_tr_b16 v[32:33], v31 offset:8
    s_waitcnt vmcnt(12) lgkmcnt(0)
    s_barrier
    s_cmp_eq_u32 s71, 1
    s_cbranch_scc1 cf_th12
    s_waitcnt vmcnt(6)
cf_th12:
    s_add_u32 m0, s43, 0
    s_add_u32 s41, s58, 278528
    buffer_load_dwordx4 v17, s[8:11], s41 offen offset:0 nt lds
    s_add_u32 s41, s58, 310272
    buffer_load_dwordx4 v17, s[8:11], s41 offen offset:1024 nt lds
    s_add_u32 s41, s58, 407552
    buffer_load_dwordx4 v17, s[8:11], s41 offen offset:2048 nt lds
    s_add_u32 s41, s58, 439296
    buffer_load_dwordx4 v17, s[8:11], s41 offen offset:3072 nt lds
    ds_write_b64 v70, v[32:33] offset:13312
    v_add_u32 v28, 36864, v24
    v_add_u32 v29, 36864, v25
    v_add_u32 v30, 36864, v26
    v_add_u32 v31, 36864, v27
    ds_read_b64_tr_b16 a[102:103], v28 offset:0
    ds_read_b64_tr_b16 a[110:111], v28 offset:8
    ds_read_b64_tr_b16 a[118:119], v29 offset:0
    ds_read_b64_tr_b16 a[126:127], v29 offset:8
    ds_read_b64_tr_b16 a[134:135], v30 offset:0
    ds_read_b64_tr_b16 a[142:143], v30 offset:8
    ds_read_b64_tr_b16 a[150:151], v31 offset:0
    ds_read_b64_tr_b16 v[0:1], v31 offset:8
    s_waitcnt vmcnt(12) lgkmcnt(0)
    s_barrier
    s_cmp_eq_u32 s71, 1
    s_cbranch_scc1 cf_th13
    s_waitcnt vmcnt(6)
cf_th13:
    s_mov_b64 s[8:9], s[52:53]
    s_add_u32 m0, s43, 36864
    s_add_u32 s41, s58, 524288
    buffer_load_dwordx4 v17, s[8:11], s41 offen offset:0 nt lds
    s_add_u32 s41, s58, 556032
    buffer_load_dwordx4 v17, s[8:11], s41 offen offset:1024 nt lds
    s_add_u32 s41, s58, 653312
    buffer_load_dwordx4 v17, s[8:11], s41 offen offset:2048 nt lds
    s_add_u32 s41, s58, 685056
    buffer_load_dwordx4 v17, s[8:11], s41 offen offset:3072 nt lds
    ds_write_b64 v70, v[0:1] offset:13320
    v_add_u32 v28, 73728, v24
    v_add_u32 v29, 73728, v25
    v_add_u32 v30, 73728, v26
    v_add_u32 v31, 73728, v27
    ds_read_b64_tr_b16 a[236:237], v28 offset:0
    ds_read_b64_tr_b16 v[32:33], v28 offset:8
    ds_read_b64_tr_b16 a[244:245], v29 offset:0
    ds_read_b64_tr_b16 a[252:253], v29 offset:8
    ds_read_b64_tr_b16 v[148:149], v30 offset:0
    ds_read_b64_tr_b16 v[156:157], v30 offset:8
    ds_read_b64_tr_b16 v[164:165], v31 offset:0
    ds_read_b64_tr_b16 v[172:173], v31 offset:8
    s_waitcnt vmcnt(12) lgkmcnt(0)
    s_barrier
    s_cmp_eq_u32 s71, 1
    s_cbranch_scc1 cf_th14
    s_waitcnt vmcnt(6)
cf_th14:
    s_add_u32 m0, s43, 73728
    s_add_u32 s41, s58, 540672
    buffer_load_dwordx4 v17, s[8:11], s41 offen offset:0 nt lds
    s_add_u32 s41, s58, 572416
    buffer_load_dwordx4 v17, s[8:11], s41 offen offset:1024 nt lds
    s_add_u32 s41, s58, 669696
    buffer_load_dwordx4 v17, s[8:11], s41 offen offset:2048 nt lds
    s_add_u32 s41, s58, 701440
    buffer_load_dwordx4 v17, s[8:11], s41 offen offset:3072 nt lds
    ds_write_b64 v70, v[32:33] offset:9216
    v_add_u32 v28, 110592, v24
    v_add_u32 v29, 110592, v25
    v_add_u32 v30, 110592, v26
    v_add_u32 v31, 110592, v27
    ds_read_b64_tr_b16 a[238:239], v28 offset:0
    ds_read_b64_tr_b16 v[0:1], v28 offset:8
    ds_read_b64_tr_b16 a[246:247], v29 offset:0
    ds_read_b64_tr_b16 a[254:255], v29 offset:8
    ds_read_b64_tr_b16 v[150:151], v30 offset:0
    ds_read_b64_tr_b16 v[158:159], v30 offset:8
    ds_read_b64_tr_b16 v[166:167], v31 offset:0
    ds_read_b64_tr_b16 v[174:175], v31 offset:8
    s_waitcnt vmcnt(12) lgkmcnt(0)
    s_barrier
    s_cmp_eq_u32 s71, 1
    s_cbranch_scc1 cf_th15
    s_waitcnt vmcnt(6)
cf_th15:
    s_mov_b64 s[8:9], s[54:55]
    s_add_u32 m0, s43, 110592
    s_add_u32 s41, s58, 524288
    buffer_load_dwordx4 v17, s[8:11], s41 offen offset:0 nt lds
    s_add_u32 s41, s58, 556032
    buffer_load_dwordx4 v17, s[8:11], s41 offen offset:1024 nt lds
    s_add_u32 s41, s58, 653312
    buffer_load_dwordx4 v17, s[8:11], s41 offen offset:2048 nt lds
    s_add_u32 s41, s58, 685056
    buffer_load_dwordx4 v17, s[8:11], s41 offen offset:3072 nt lds
    ds_write_b64 v70, v[0:1] offset:9224
    v_add_u32 v28, 147456, v24
    v_add_u32 v29, 147456, v25
    v_add_u32 v30, 147456, v26
    v_add_u32 v31, 147456, v27
    ds_read_b64_tr_b16 v[32:33], v28 offset:0
    ds_read_b64_tr_b16 v[34:35], v28 offset:8
    ds_read_b64_tr_b16 v[36:37], v29 offset:0
    ds_read_b64_tr_b16 v[38:39], v29 offset:8
    ds_read_b64_tr_b16 a[4:5], v30 offset:0
    ds_read_b64_tr_b16 v[40:41], v30 offset:8
    ds_read_b64_tr_b16 a[12:13], v31 offset:0
    ds_read_b64_tr_b16 v[42:43], v31 offset:8
    s_waitcnt vmcnt(12) lgkmcnt(0)
    s_barrier
    s_cmp_eq_u32 s71, 1
    s_cbranch_scc1 cf_th16
    s_waitcnt vmcnt(6)
cf_th16:
    s_add_u32 m0, s43, 147456
    s_add_u32 s41, s58, 540672
    buffer_load_dwordx4 v17, s[8:11], s41 offen offset:0 nt lds
    s_add_u32 s41, s58, 572416
    buffer_load_dwordx4 v17, s[8:11], s41 offen offset:1024 nt lds
    s_add_u32 s41, s58, 669696
    buffer_load_dwordx4 v17, s[8:11], s41 offen offset:2048 nt lds
    s_add_u32 s41, s58, 701440
    buffer_load_dwordx4 v17, s[8:11], s41 offen offset:3072 nt lds
    ds_write_b64 v70, v[32:33] offset:1024
    ds_write_b64 v70, v[34:35] offset:3072
    ds_write_b64 v70, v[36:37] offset:5120
    ds_write_b64 v70, v[38:39] offset:7168
    ds_write_b64 v70, v[40:41] offset:11264
    ds_write_b64 v70, v[42:43] offset:15360
    v_add_u32 v28, 0, v24
    v_add_u32 v29, 0, v25
    v_add_u32 v30, 0, v26
    v_add_u32 v31, 0, v27
    ds_read_b64_tr_b16 v[0:1], v28 offset:0
    ds_read_b64_tr_b16 v[2:3], v28 offset:8
    ds_read_b64_tr_b16 v[4:5], v29 offset:0
    ds_read_b64_tr_b16 v[6:7], v29 offset:8
    ds_read_b64_tr_b16 a[6:7], v30 offset:0
    ds_read_b64_tr_b16 v[8:9], v30 offset:8
    ds_read_b64_tr_b16 a[14:15], v31 offset:0
    ds_read_b64_tr_b16 v[10:11], v31 offset:8
    s_waitcnt vmcnt(12) lgkmcnt(0)
    s_barrier
    s_cmp_eq_u32 s71, 1
    s_cbranch_scc1 cf_th17
    s_waitcnt vmcnt(6)
cf_th17:
    s_mov_b64 s[8:9], s[50:51]
    s_add_u32 m0, s43, 0
    s_add_u32 s41, s58, 524288
    buffer_load_dwordx4 v17, s[8:11], s41 offen offset:0 nt lds
    s_add_u32 s41, s58, 556032
    buffer_load_dwordx4 v17, s[8:11], s41 offen offset:1024 nt lds
    s_add_u32 s41, s58, 653312
    buffer_load_dwordx4 v17, s[8:11], s41 offen offset:2048 nt lds
    s_add_u32 s41, s58, 685056
    buffer_load_dwordx4 v17, s[8:11], s41 offen offset:3072 nt lds
    ds_write_b64 v70, v[0:1] offset:1032
    ds_write_b64 v70, v[2:3] offset:3080
    ds_write_b64 v70, v[4:5] offset:5128
    ds_write_b64 v70, v[6:7] offset:7176
    ds_write_b64 v70, v[8:9] offset:11272
    ds_write_b64 v70, v[10:11] offset:15368
    v_add_u32 v28, 36864, v24
    v_add_u32 v29, 36864, v25
    v_add_u32 v30, 36864, v26
    v_add_u32 v31, 36864, v27
    ds_read_b64_tr_b16 a[152:153], v28 offset:0
    ds_read_b64_tr_b16 a[160:161], v28 offset:8
    ds_read_b64_tr_b16 a[168:169], v29 offset:0
    ds_read_b64_tr_b16 a[176:177], v29 offset:8
    ds_read_b64_tr_b16 a[184:185], v30 offset:0
    ds_read_b64_tr_b16 a[192:193], v30 offset:8
    ds_read_b64_tr_b16 a[200:201], v31 offset:0
    ds_read_b64_tr_b16 a[208:209], v31 offset:8
    s_waitcnt vmcnt(12) lgkmcnt(0)
    s_barrier
    s_cmp_eq_u32 s71, 1
    s_cbranch_scc1 cf_th18
    s_waitcnt vmcnt(6)
cf_th18:
    s_add_u32 m0, s43, 36864
    s_add_u32 s41, s58, 540672
    buffer_load_dwordx4 v17, s[8:11], s41 offen offset:0 nt lds
    s_add_u32 s41, s58, 572416
    buffer_load_dwordx4 v17, s[8:11], s41 offen offset:1024 nt lds
    s_add_u32 s41, s58, 669696
    buffer_load_dwordx4 v17, s[8:11], s41 offen offset:2048 nt lds
    s_add_u32 s41, s58, 701440
    buffer_load_dwordx4 v17, s[8:11], s41 offen offset:3072 nt lds
    v_add_u32 v28, 73728, v24
    v_add_u32 v29, 73728, v25
    v_add_u32 v30, 73728, v26
    v_add_u32 v31, 73728, v27
    ds_read_b64_tr_b16 a[154:155], v28 offset:0
    ds_read_b64_tr_b16 a[162:163], v28 offset:8
    ds_read_b64_tr_b16 a[170:171], v29 offset:0
    ds_read_b64_tr_b16 a[178:179], v29 offset:8
    ds_read_b64_tr_b16 a[186:187], v30 offset:0
    ds_read_b64_tr_b16 a[194:195], v30 offset:8
    ds_read_b64_tr_b16 a[202:203], v31 offset:0
    ds_read_b64_tr_b16 a[210:211], v31 offset:8
    s_waitcnt vmcnt(12) lgkmcnt(0)
    s_barrier
    s_cmp_eq_u32 s71, 1
    s_cbranch_scc1 cf_th19
    s_waitcnt vmcnt(6)
cf_th19:
    s_mov_b64 s[8:9], s[52:53]
    s_add_u32 m0, s43, 73728
    s_add_u32 s41, s58, 786432
    buffer_load_dwordx4 v17, s[8:11], s41 offen offset:0 nt lds
    s_add_u32 s41, s58, 818176
    buffer_load_dwordx4 v17, s[8:11], s41 offen offset:1024 nt lds
    s_add_u32 s41, s58, 915456
    buffer_load_dwordx4 v17, s[8:11], s41 offen offset:2048 nt lds
    s_add_u32 s41, s58, 947200
    buffer_load_dwordx4 v17, s[8:11], s41 offen offset:3072 nt lds
    v_add_u32 v28, 110592, v24
    v_add_u32 v29, 110592, v25
    v_add_u32 v30, 110592, v26
    v_add_u32 v31, 110592, v27
    ds_read_b64_tr_b16 v[176:177], v28 offset:0
    ds_read_b64_tr_b16 v[184:185], v28 offset:8
    ds_read_b64_tr_b16 v[192:193], v29 offset:0
    ds_read_b64_tr_b16 v[200:201], v29 offset:8
    ds_read_b64_tr_b16 v[208:209], v30 offset:0
    ds_read_b64_tr_b16 v[216:217], v30 offset:8
    ds_read_b64_tr_b16 v[224:225], v31 offset:0
    ds_read_b64_tr_b16 v[232:233], v31 offset:8
    s_waitcnt vmcnt(12) lgkmcnt(0)
    s_barrier
    s_cmp_eq_u32 s71, 1
    s_cbranch_scc1 cf_th20
    s_waitcnt vmcnt(6)
cf_th20:
    s_add_u32 m0, s43, 110592
    s_add_u32 s41, s58, 802816
    buffer_load_dwordx4 v17, s[8:11], s41 offen offset:0 nt lds
    s_add_u32 s41, s58, 834560
    buffer_load_dwordx4 v17, s[8:11], s41 offen offset:1024 nt lds
    s_add_u32 s41, s58, 931840
    buffer_load_dwordx4 v17, s[8:11], s41 offen offset:2048 nt lds
    s_add_u32 s41, s58, 963584
    buffer_load_dwordx4 v17, s[8:11], s41 offen offset:3072 nt lds
    v_add_u32 v28, 147456, v24
    v_add_u32 v29, 147456, v25
    v_add_u32 v30, 147456, v26
    v_add_u32 v31, 147456, v27
    ds_read_b64_tr_b16 v[178:179], v28 offset:0
    ds_read_b64_tr_b16 v[186:187], v28 offset:8
    ds_read_b64_tr_b16 v[194:195], v29 offset:0
    ds_read_b64_tr_b16 v[202:203], v29 offset:8
    ds_read_b64_tr_b16 v[210:211], v30 offset:0
    ds_read_b64_tr_b16 v[218:219], v30 offset:8
    ds_read_b64_tr_b16 v[226:227], v31 offset:0
    ds_read_b64_tr_b16 v[234:235], v31 offset:8
    s_waitcnt vmcnt(12) lgkmcnt(0)
    s_barrier
    s_cmp_eq_u32 s71, 1
    s_cbranch_scc1 cf_th21
    s_waitcnt vmcnt(6)
cf_th21:
    s_mov_b64 s[8:9], s[54:55]
    s_add_u32 m0, s43, 147456
    s_add_u32 s41, s58, 786432
    buffer_load_dwordx4 v17, s[8:11], s41 offen offset:0 nt lds
    s_add_u32 s41, s58, 818176
    buffer_load_dwordx4 v17, s[8:11], s41 offen offset:1024 nt lds
    s_add_u32 s41, s58, 915456
    buffer_load_dwordx4 v17, s[8:11], s41 offen offset:2048 nt lds
    s_add_u32 s41, s58, 947200
    buffer_load_dwordx4 v17, s[8:11], s41 offen offset:3072 nt lds
    v_add_u32 v28, 0, v24
    v_add_u32 v29, 0, v25
    v_add_u32 v30, 0, v26
    v_add_u32 v31, 0, v27
    ds_read_b64_tr_b16 a[16:17], v28 offset:0
    ds_read_b64_tr_b16 a[24:25], v28 offset:8
    ds_read_b64_tr_b16 a[32:33], v29 offset:0
    ds_read_b64_tr_b16 a[40:41], v29 offset:8
    ds_read_b64_tr_b16 a[48:49], v30 offset:0
    ds_read_b64_tr_b16 a[56:57], v30 offset:8
    ds_read_b64_tr_b16 a[64:65], v31 offset:0
    ds_read_b64_tr_b16 a[72:73], v31 offset:8
    s_waitcnt vmcnt(12) lgkmcnt(0)
    s_barrier
    s_cmp_eq_u32 s71, 1
    s_cbranch_scc1 cf_th22
    s_waitcnt vmcnt(6)
cf_th22:
    s_add_u32 m0, s43, 0
    s_add_u32 s41, s58, 802816
    buffer_load_dwordx4 v17, s[8:11], s41 offen offset:0 nt lds
    s_add_u32 s41, s58, 834560
    buffer_load_dwordx4 v17, s[8:11], s41 offen offset:1024 nt lds
    s_add_u32 s41, s58, 931840
    buffer_load_dwordx4 v17, s[8:11], s41 offen offset:2048 nt lds
    s_add_u32 s41, s58, 963584
    buffer_load_dwordx4 v17, s[8:11], s41 offen offset:3072 nt lds
    buffer_load_dword v54, off, s[84:87], 0 offset:132 sc1
    buffer_load_dword v55, off, s[84:87], 0 offset:216 sc1
    v_add_u32 v28, 36864, v24
    v_add_u32 v29, 36864, v25
    v_add_u32 v30, 36864, v26
    v_add_u32 v31, 36864, v27
    ds_read_b64_tr_b16 a[18:19], v28 offset:0
    ds_read_b64_tr_b16 a[26:27], v28 offset:8
    ds_read_b64_tr_b16 a[34:35], v29 offset:0
    ds_read_b64_tr_b16 a[42:43], v29 offset:8
    ds_read_b64_tr_b16 a[50:51], v30 offset:0
    ds_read_b64_tr_b16 a[58:59], v30 offset:8
    ds_read_b64_tr_b16 a[66:67], v31 offset:0
    ds_read_b64_tr_b16 a[74:75], v31 offset:8
    s_waitcnt vmcnt(12) lgkmcnt(0)
    s_barrier
    s_cmp_eq_u32 s71, 1
    s_cbranch_scc1 cf_th23
    s_waitcnt vmcnt(6)
cf_th23:
    s_mov_b64 s[8:9], s[50:51]
    s_add_u32 m0, s43, 36864
    s_add_u32 s41, s58, 786432
    buffer_load_dwordx4 v17, s[8:11], s41 offen offset:0 nt lds
    s_add_u32 s41, s58, 818176
    buffer_load_dwordx4 v17, s[8:11], s41 offen offset:1024 nt lds
    s_add_u32 s41, s58, 915456
    buffer_load_dwordx4 v17, s[8:11], s41 offen offset:2048 nt lds
    s_add_u32 s41, s58, 947200
    buffer_load_dwordx4 v17, s[8:11], s41 offen offset:3072 nt lds
    v_add_u32 v28, 73728, v24
    v_add_u32 v29, 73728, v25
    v_add_u32 v30, 73728, v26
    v_add_u32 v31, 73728, v27
    ds_read_b64_tr_b16 a[156:157], v28 offset:0
    ds_read_b64_tr_b16 a[164:165], v28 offset:8
    ds_read_b64_tr_b16 a[172:173], v29 offset:0
    ds_read_b64_tr_b16 a[180:181], v29 offset:8
    ds_read_b64_tr_b16 a[188:189], v30 offset:0
    ds_read_b64_tr_b16 a[196:197], v30 offset:8
    ds_read_b64_tr_b16 a[204:205], v31 offset:0
    ds_read_b64_tr_b16 a[212:213], v31 offset:8
    s_waitcnt vmcnt(12) lgkmcnt(0)
    s_barrier
    s_cmp_eq_u32 s71, 1
    s_cbranch_scc1 cf_th24
    s_waitcnt vmcnt(6)
cf_th24:
    s_add_u32 m0, s43, 73728
    s_add_u32 s41, s58, 802816
    buffer_load_dwordx4 v17, s[8:11], s41 offen offset:0 nt lds
    s_add_u32 s41, s58, 834560
    buffer_load_dwordx4 v17, s[8:11], s41 offen offset:1024 nt lds
    s_add_u32 s41, s58, 931840
    buffer_load_dwordx4 v17, s[8:11], s41 offen offset:2048 nt lds
    s_add_u32 s41, s58, 963584
    buffer_load_dwordx4 v17, s[8:11], s41 offen offset:3072 nt lds
    v_add_u32 v28, 110592, v24
    v_add_u32 v29, 110592, v25
    v_add_u32 v30, 110592, v26
    v_add_u32 v31, 110592, v27
    ds_read_b64_tr_b16 a[158:159], v28 offset:0
    ds_read_b64_tr_b16 a[166:167], v28 offset:8
    ds_read_b64_tr_b16 a[174:175], v29 offset:0
    ds_read_b64_tr_b16 a[182:183], v29 offset:8
    ds_read_b64_tr_b16 a[190:191], v30 offset:0
    ds_read_b64_tr_b16 a[198:199], v30 offset:8
    ds_read_b64_tr_b16 a[206:207], v31 offset:0
    ds_read_b64_tr_b16 a[214:215], v31 offset:8
    s_waitcnt vmcnt(12) lgkmcnt(0)
    s_barrier
    s_cmp_eq_u32 s71, 1
    s_cbranch_scc1 cf_th25
    s_waitcnt vmcnt(6)
cf_th25:
    s_mov_b64 s[8:9], s[52:53]
    s_add_u32 m0, s43, 110592
    s_add_u32 s41, s59, 0
    buffer_load_dwordx4 v17, s[8:11], s41 offen offset:0 nt lds
    s_add_u32 s41, s59, 31744
    buffer_load_dwordx4 v17, s[8:11], s41 offen offset:1024 nt lds
    s_add_u32 s41, s59, 129024
    buffer_load_dwordx4 v17, s[8:11], s41 offen offset:2048 nt lds
    s_add_u32 s41, s59, 160768
    buffer_load_dwordx4 v17, s[8:11], s41 offen offset:3072 nt lds
    v_add_u32 v28, 147456, v24
    v_add_u32 v29, 147456, v25
    v_add_u32 v30, 147456, v26
    v_add_u32 v31, 147456, v27
    ds_read_b64_tr_b16 v[180:181], v28 offset:0
    ds_read_b64_tr_b16 v[188:189], v28 offset:8
    ds_read_b64_tr_b16 v[196:197], v29 offset:0
    ds_read_b64_tr_b16 v[204:205], v29 offset:8
    ds_read_b64_tr_b16 v[212:213], v30 offset:0
    ds_read_b64_tr_b16 v[220:221], v30 offset:8
    ds_read_b64_tr_b16 v[228:229], v31 offset:0
    ds_read_b64_tr_b16 v[236:237], v31 offset:8
    s_waitcnt vmcnt(12) lgkmcnt(0)
    s_barrier
    s_cmp_eq_u32 s71, 1
    s_cbranch_scc1 cf_th26
    s_waitcnt vmcnt(6)
cf_th26:
    s_mov_b64 s[8:9], s[50:51]
    s_add_u32 m0, s43, 147456
    s_add_u32 s41, s59, 0
    buffer_load_dwordx4 v17, s[8:11], s41 offen offset:0 nt lds
    s_add_u32 s41, s59, 31744
    buffer_load_dwordx4 v17, s[8:11], s41 offen offset:1024 nt lds
    s_add_u32 s41, s59, 129024
    buffer_load_dwordx4 v17, s[8:11], s41 offen offset:2048 nt lds
    s_add_u32 s41, s59, 160768
    buffer_load_dwordx4 v17, s[8:11], s41 offen offset:3072 nt lds
    s_lshl_b32 s26, s12, 14
    s_add_u32 s26, s26, 0
    s_mul_i32 s40, s13, 3072
    s_add_u32 s24, s26, s40
    s_add_u32 s26, s24, s33
    s_add_u32 s99, s26, 33030144
    s_lshl_b32 s96, s12, 7
    s_add_u32 s29, s96, 125845504
    s_lshr_b32 s96, s12, 1
    s_lshl_b32 s96, s96, 11
    s_add_u32 s96, s96, 126091776
    v_bfe_u32 v78, v65, 4, 3
    v_lshlrev_b32 v78, 7, v78
    buffer_load_dword v56, v78, s[4:7], s96 offen sc1
    v_add_u32 v28, 0, v24
    v_add_u32 v29, 0, v25
    v_add_u32 v30, 0, v26
    v_add_u32 v31, 0, v27
    ds_read_b64_tr_b16 v[182:183], v28 offset:0
    ds_read_b64_tr_b16 v[190:191], v28 offset:8
    ds_read_b64_tr_b16 v[198:199], v29 offset:0
    ds_read_b64_tr_b16 v[206:207], v29 offset:8
    ds_read_b64_tr_b16 v[214:215], v30 offset:0
    ds_read_b64_tr_b16 v[222:223], v30 offset:8
    ds_read_b64_tr_b16 v[230:231], v31 offset:0
    ds_read_b64_tr_b16 v[238:239], v31 offset:8
    s_waitcnt vmcnt(12) lgkmcnt(0)
    s_barrier
    s_cmp_eq_u32 s71, 1
    s_cbranch_scc1 cf_th27
    s_waitcnt vmcnt(6)
cf_th27:
    s_mov_b64 s[8:9], s[54:55]
    s_add_u32 m0, s43, 0
    s_add_u32 s41, s59, 0
    buffer_load_dwordx4 v17, s[8:11], s41 offen offset:0 nt lds
    s_add_u32 s41, s59, 31744
    buffer_load_dwordx4 v17, s[8:11], s41 offen offset:1024 nt lds
    s_add_u32 s41, s59, 129024
    buffer_load_dwordx4 v17, s[8:11], s41 offen offset:2048 nt lds
    s_add_u32 s41, s59, 160768
    buffer_load_dwordx4 v17, s[8:11], s41 offen offset:3072 nt lds
    v_readfirstlane_b32 s94, v54
    v_readfirstlane_b32 s95, v55
    s_cmp_lt_u32 s94, 32
    s_cbranch_scc1 cf_mc
    s_cmp_lg_u32 s13, 0
    s_cbranch_scc1 cf_mc
    v_mov_b32 v76, 1
    v_mov_b32 v77, 0
    s_mov_b64 exec, 1
    buffer_atomic_cmpswap v[76:77], off, s[84:87], 0 offset:28 sc0
    s_mov_b64 exec, -1
cf_mc:
    s_nop 1
    v_add_u32 v28, 36864, v24
    v_add_u32 v29, 36864, v25
    v_add_u32 v30, 36864, v26
    v_add_u32 v31, 36864, v27
    ds_read_b64_tr_b16 a[20:21], v28 offset:0
    ds_read_b64_tr_b16 a[28:29], v28 offset:8
    ds_read_b64_tr_b16 a[36:37], v29 offset:0
    ds_read_b64_tr_b16 a[44:45], v29 offset:8
    ds_read_b64_tr_b16 a[52:53], v30 offset:0
    ds_read_b64_tr_b16 a[60:61], v30 offset:8
    ds_read_b64_tr_b16 a[68:69], v31 offset:0
    ds_read_b64_tr_b16 a[76:77], v31 offset:8
    s_waitcnt vmcnt(12) lgkmcnt(0)
    s_barrier
    s_cmp_eq_u32 s71, 1
    s_cbranch_scc1 cf_th28
    s_waitcnt vmcnt(6)
cf_th28:
    s_mov_b64 s[8:9], s[56:57]
    s_add_u32 m0, s43, 36864
    s_add_u32 s41, s60, 128
    buffer_load_dwordx4 v18, s[8:11], s41 offen offset:0 nt lds
    s_add_u32 s41, s60, 8320
    buffer_load_dwordx4 v18, s[8:11], s41 offen offset:1024 nt lds
    s_add_u32 s41, s60, 16512
    buffer_load_dwordx4 v18, s[8:11], s41 offen offset:2048 nt lds
    s_add_u32 s41, s60, 24704
    buffer_load_dwordx4 v18, s[8:11], s41 offen offset:3072 nt lds
    v_add_u32 v28, 73728, v24
    v_add_u32 v29, 73728, v25
    v_add_u32 v30, 73728, v26
    v_add_u32 v31, 73728, v27
    ds_read_b64_tr_b16 a[22:23], v28 offset:0
    ds_read_b64_tr_b16 a[30:31], v28 offset:8
    ds_read_b64_tr_b16 a[38:39], v29 offset:0
    ds_read_b64_tr_b16 a[46:47], v29 offset:8
    ds_read_b64_tr_b16 a[54:55], v30 offset:0
    ds_read_b64_tr_b16 a[62:63], v30 offset:8
    ds_read_b64_tr_b16 a[70:71], v31 offset:0
    ds_read_b64_tr_b16 a[78:79], v31 offset:8
    s_waitcnt vmcnt(12) lgkmcnt(0)
    s_barrier
    s_cmp_eq_u32 s71, 1
    s_cbranch_scc1 cf_th29
    s_waitcnt vmcnt(6)
cf_th29:
    s_add_u32 m0, s43, 73728
    s_add_u32 s41, s61, 128
    buffer_load_dwordx4 v18, s[8:11], s41 offen offset:0 nt lds
    s_add_u32 s41, s61, 8320
    buffer_load_dwordx4 v18, s[8:11], s41 offen offset:1024 nt lds
    s_add_u32 s41, s61, 16512
    buffer_load_dwordx4 v18, s[8:11], s41 offen offset:2048 nt lds
    s_add_u32 s41, s61, 24704
    buffer_load_dwordx4 v18, s[8:11], s41 offen offset:3072 nt lds
    v_add_u32 v77, 110592, v20
    ds_read_b64_tr_b16 a[216:217], v77 offset:0
    ds_read_b64_tr_b16 a[218:219], v77 offset:4096
    ds_read_b64_tr_b16 a[220:221], v77 offset:8192
    ds_read_b64_tr_b16 a[222:223], v77 offset:12288
    ds_read_b64_tr_b16 a[224:225], v77 offset:8
    ds_read_b64_tr_b16 a[226:227], v77 offset:4104
    ds_read_b64_tr_b16 a[228:229], v77 offset:8200
    ds_read_b64_tr_b16 a[230:231], v77 offset:12296
    s_waitcnt vmcnt(12) lgkmcnt(0)
    s_barrier
    s_cmp_eq_u32 s71, 1
    s_cbranch_scc1 cf_th30
    s_waitcnt vmcnt(6)
cf_th30:
    s_add_u32 m0, s43, 110592
    s_add_u32 s41, s62, 128
    buffer_load_dwordx4 v18, s[8:11], s41 offen offset:0 nt lds
    s_add_u32 s41, s62, 8320
    buffer_load_dwordx4 v18, s[8:11], s41 offen offset:1024 nt lds
    s_add_u32 s41, s62, 16512
    buffer_load_dwordx4 v18, s[8:11], s41 offen offset:2048 nt lds
    s_add_u32 s41, s62, 24704
    buffer_load_dwordx4 v18, s[8:11], s41 offen offset:3072 nt lds
    v_add_u32 v77, 147456, v20
    ds_read_b64_tr_b16 a[80:81], v77 offset:0
    ds_read_b64_tr_b16 a[82:83], v77 offset:4096
    ds_read_b64_tr_b16 a[84:85], v77 offset:8192
    ds_read_b64_tr_b16 a[86:87], v77 offset:12288
    ds_read_b64_tr_b16 a[88:89], v77 offset:8
    ds_read_b64_tr_b16 a[90:91], v77 offset:4104
    ds_read_b64_tr_b16 a[92:93], v77 offset:8200
    ds_read_b64_tr_b16 a[94:95], v77 offset:12296
    s_waitcnt vmcnt(12) lgkmcnt(0)
    s_barrier
    s_cmp_eq_u32 s71, 1
    s_cbranch_scc1 cf_th31
    s_waitcnt vmcnt(6)
cf_th31:
    s_add_u32 m0, s43, 147456
    s_add_u32 s41, s63, 128
    buffer_load_dwordx4 v18, s[8:11], s41 offen offset:0 nt lds
    s_add_u32 s41, s63, 8320
    buffer_load_dwordx4 v18, s[8:11], s41 offen offset:1024 nt lds
    s_add_u32 s41, s63, 16512
    buffer_load_dwordx4 v18, s[8:11], s41 offen offset:2048 nt lds
    s_add_u32 s41, s63, 24704
    buffer_load_dwordx4 v18, s[8:11], s41 offen offset:3072 nt lds
    v_mov_b32 v77, v56
    v_subrev_u32 v77, s95, v77
    v_cmp_lt_u32 vcc, 16, v77
    s_nop 1
    v_cndmask_b32 v77, v77, 0, vcc
    v_bfe_u32 v79, v78, 7, 2
    v_lshl_add_u32 v77, v77, 2, v79
    s_nop 1
    v_min_u32_dpp v77, v77, v77 row_ror:1 row_mask:0xf bank_mask:0xf
    s_nop 1
    v_min_u32_dpp v77, v77, v77 row_ror:2 row_mask:0xf bank_mask:0xf
    s_nop 1
    v_min_u32_dpp v77, v77, v77 row_ror:4 row_mask:0xf bank_mask:0xf
    s_nop 0
    v_readfirstlane_b32 s97, v77
    s_cmp_eq_u32 s95, 0
    s_cselect_b32 s97, 0, s97
    s_cmp_lt_u32 s97, 3
    s_cbranch_scc1 cf_mb
    s_add_u32 s40, s26, 0
    s_min_u32 s40, s40, s99
    s_sub_u32 s41, s96, s40
    v_bfe_u32 v77, v65, 4, 3
    v_lshl_add_u32 v77, v77, 7, s41
    v_lshlrev_b32 v78, 3, v69
    s_nop 0
    v_mov_b32_dpp v78, v77 quad_perm:[0,1,2,3] row_mask:0xc bank_mask:0xf
    buffer_load_dword v63, v78, s[4:7], s40 offen sc1
    s_add_u32 s40, s26, 524288
    s_min_u32 s40, s40, s99
    s_sub_u32 s41, s96, s40
    v_bfe_u32 v77, v65, 4, 3
    v_lshl_add_u32 v77, v77, 7, s41
    v_lshlrev_b32 v78, 3, v69
    s_nop 0
    v_mov_b32_dpp v78, v77 quad_perm:[0,1,2,3] row_mask:0xc bank_mask:0xf
    buffer_load_dword v63, v78, s[4:7], s40 offen sc1
cf_mb:
    v_mov_b32 v78, v21
    v_mov_b32 v79, v22
    v_add_u32 v77, 0, v20
    ds_read_b64_tr_b16 v[240:241], v77 offset:0
    ds_read_b64_tr_b16 v[242:243], v77 offset:4096
    ds_read_b64_tr_b16 v[244:245], v77 offset:8192
    ds_read_b64_tr_b16 v[246:247], v77 offset:12288
    ds_read_b64_tr_b16 v[248:249], v77 offset:8
    ds_read_b64_tr_b16 v[250:251], v77 offset:4104
    ds_read_b64_tr_b16 v[252:253], v77 offset:8200
    ds_read_b64_tr_b16 v[254:255], v77 offset:12296
    s_waitcnt vmcnt(12) lgkmcnt(0)
    s_barrier
    v_bfe_u32 v60, v65, 4, 6
    v_and_b32 v61, 15, v60
    v_lshrrev_b32 v62, 4, v60
    v_mov_b32 v50, 0x3f80
    v_mov_b32 v51, 0x3f800000
    v_and_b32 v57, 1, v62
    v_lshlrev_b32 v57, 2, v57
    v_sub_u32 v57, v61, v57
    v_and_b32 v58, 3, v61
    v_lshlrev_b32 v58, 2, v58
    v_lshrrev_b32 v59, 2, v61
    v_add_u32 v58, v58, v59
    v_cmp_eq_u32 vcc, 0, v57
    s_nop 1
    v_cndmask_b32 v40, 0, v50, vcc
    v_cmp_eq_u32 vcc, 1, v57
    s_nop 1
    v_cndmask_b32 v40, v40, v51, vcc
    v_cmp_eq_u32 vcc, 0, v58
    s_nop 1
    v_cndmask_b32 v44, 0, v50, vcc
    v_cmp_eq_u32 vcc, 1, v58
    s_nop 1
    v_cndmask_b32 v44, v44, v51, vcc
    v_cmp_eq_u32 vcc, 2, v57
    s_nop 1
    v_cndmask_b32 v41, 0, v50, vcc
    v_cmp_eq_u32 vcc, 3, v57
    s_nop 1
    v_cndmask_b32 v41, v41, v51, vcc
    v_cmp_eq_u32 vcc, 2, v58
    s_nop 1
    v_cndmask_b32 v45, 0, v50, vcc
    v_cmp_eq_u32 vcc, 3, v58
    s_nop 1
    v_cndmask_b32 v45, v45, v51, vcc
    v_cmp_eq_u32 vcc, 8, v57
    s_nop 1
    v_cndmask_b32 v42, 0, v50, vcc
    v_cmp_eq_u32 vcc, 9, v57
    s_nop 1
    v_cndmask_b32 v42, v42, v51, vcc
    v_cmp_eq_u32 vcc, 4, v58
    s_nop 1
    v_cndmask_b32 v46, 0, v50, vcc
    v_cmp_eq_u32 vcc, 5, v58
    s_nop 1
    v_cndmask_b32 v46, v46, v51, vcc
    v_cmp_eq_u32 vcc, 10, v57
    s_nop 1
    v_cndmask_b32 v43, 0, v50, vcc
    v_cmp_eq_u32 vcc, 11, v57
    s_nop 1
    v_cndmask_b32 v43, v43, v51, vcc
    v_cmp_eq_u32 vcc, 6, v58
    s_nop 1
    v_cndmask_b32 v47, 0, v50, vcc
    v_cmp_eq_u32 vcc, 7, v58
    s_nop 1
    v_cndmask_b32 v47, v47, v51, vcc
    v_lshlrev_b32 v57, 4, v61
    ds_write_b128 v69, v[40:43] offset:15360
    ds_write_b128 v57, v[44:47] offset:15872
    v_add_u32 v77, 36864, v79
    s_waitcnt lgkmcnt(0)
    ds_read_b64_tr_b16 v[0:1], v77 offset:0
    ds_read_b64_tr_b16 v[2:3], v77 offset:256
    ds_read_b64_tr_b16 v[4:5], v77 offset:2048
    ds_read_b64_tr_b16 v[6:7], v77 offset:2304
    ds_read_b64_tr_b16 v[8:9], v77 offset:16
    ds_read_b64_tr_b16 v[10:11], v77 offset:272
    ds_read_b64_tr_b16 v[12:13], v77 offset:2064
    ds_read_b64_tr_b16 v[14:15], v77 offset:2320
    s_waitcnt vmcnt(8) lgkmcnt(0)
    s_barrier
    s_mov_b32 s44, 0x3e0293ee
    s_mov_b32 s45, s44
    s_or_b32 s66, s44, 0x80000000
    s_mov_b32 s48, 0x3f003f00
    s_mov_b32 s49, 0
    s_mov_b32 s50, 0x3f803f80
    s_mov_b32 s51, 0x3f803f80
    s_mov_b32 s52, 512
    s_mov_b32 s53, 1024
    s_mov_b32 s54, 1536
    s_mov_b32 s30, 0
    s_mov_b32 s37, 0
    s_mov_b32 s98, -100
    s_lshl_b32 s47, s13, 9
    s_cmp_lg_u32 s32, 0
    s_cselect_b32 s71, s13, 3
    s_add_u32 s46, s71, 1
    s_lshr_b32 s46, s46, 1
    s_mov_b32 s14, 67125248
    s_mov_b32 s15, 67129344
    s_mov_b32 s16, 67133440
    s_mov_b32 s36, 0
    s_add_u32 s17, s68, 67108864
    s_mov_b32 s69, 0
    s_mov_b32 s70, 0
    s_lshl_b32 s26, s12, 14
    s_add_u32 s26, s26, 0
    s_mul_i32 s40, s13, 3072
    s_add_u32 s24, s26, s40
    s_add_u32 s26, s24, s33
    s_add_u32 s99, s26, 33030144
    s_lshl_b32 s96, s12, 7
    s_add_u32 s29, s96, 125845504
    s_lshr_b32 s96, s12, 1
    s_lshl_b32 s96, s96, 11
    s_add_u32 s96, s96, 126091776
    s_lshl_b32 s40, s12, 14
    s_add_u32 s40, s40, 68157440
    s_add_u32 s18, s40, 0
    s_add_u32 s19, s40, 4096
    s_add_u32 s20, s40, 8192
    s_add_u32 s21, s40, 12288
    s_lshr_b32 s40, s12, 3
    s_lshl_b32 s40, s40, 12
    s_and_b32 s41, s12, 7
    s_lshl_b32 s41, s41, 7
    s_add_u32 s40, s40, s41
    s_add_u32 s22, s40, 68157440
    s_add_u32 s23, s22, 1024
    s_add_u32 s25, s22, 2048
    s_mov_b32 s56, -65472
    s_cmp_lg_u32 s32, 0
    s_cselect_b64 s[38:39], -1, 0
    s_add_u32 s55, s68, 138412032
    s_cmp_eq_u32 s13, 3
    s_cselect_b64 s[100:101], 1, 0
    s_cselect_b64 s[38:39], 1, s[38:39]
    s_cselect_b32 s93, 64, 0
    s_cselect_b32 s67, 64, 0
    s_cselect_b32 s55, s29, s55
    s_cselect_b32 s57, 0, 9216
    s_mov_b32 s34, 0xff00ff00
    s_mov_b32 s35, 0xff00ff00
    s_lshl_b32 s28, s12, 12
    s_add_u32 s28, s28, 7340032
    s_add_u32 s27, s28, 77594624
    s_add_u32 s28, s28, 69206016
    v_add_u32 v77, 73728, v78
    ds_read_b64_tr_b16 v[16:17], v77 offset:0
    ds_read_b64_tr_b16 v[18:19], v77 offset:256
    ds_read_b64_tr_b16 v[20:21], v77 offset:2048
    ds_read_b64_tr_b16 v[22:23], v77 offset:2304
    ds_read_b64_tr_b16 v[24:25], v77 offset:16
    ds_read_b64_tr_b16 v[26:27], v77 offset:272
    ds_read_b64_tr_b16 v[28:29], v77 offset:2064
    ds_read_b64_tr_b16 v[30:31], v77 offset:2320
    s_waitcnt vmcnt(4) lgkmcnt(0)
    s_barrier
    v_add_u32 v77, 110592, v78
    ds_read_b64_tr_b16 v[32:33], v77 offset:0
    ds_read_b64_tr_b16 v[34:35], v77 offset:256
    ds_read_b64_tr_b16 v[36:37], v77 offset:2048
    ds_read_b64_tr_b16 v[38:39], v77 offset:2304
    ds_read_b64_tr_b16 v[40:41], v77 offset:16
    ds_read_b64_tr_b16 v[42:43], v77 offset:272
    ds_read_b64_tr_b16 v[44:45], v77 offset:2064
    ds_read_b64_tr_b16 v[46:47], v77 offset:2320
    s_waitcnt vmcnt(0) lgkmcnt(0)
    s_barrier
    v_add_u32 v77, 147456, v78
    ds_read_b64_tr_b16 v[48:49], v77 offset:0
    ds_read_b64_tr_b16 v[50:51], v77 offset:256
    ds_read_b64_tr_b16 v[52:53], v77 offset:2048
    ds_read_b64_tr_b16 v[54:55], v77 offset:2304
    ds_read_b64_tr_b16 v[56:57], v77 offset:16
    ds_read_b64_tr_b16 v[58:59], v77 offset:272
    ds_read_b64_tr_b16 v[60:61], v77 offset:2064
    ds_read_b64_tr_b16 v[62:63], v77 offset:2320
    s_waitcnt lgkmcnt(0)
    s_barrier
    ds_write_b128 v70, v[0:3] offset:20480
    ds_write_b128 v70, v[4:7] offset:21504
    ds_write_b128 v70, v[8:11] offset:22528
    ds_write_b128 v70, v[12:15] offset:23552
    ds_write_b128 v70, v[16:19] offset:24576
    ds_write_b128 v70, v[20:23] offset:25600
    ds_write_b128 v70, v[24:27] offset:26624
    ds_write_b128 v70, v[28:31] offset:27648
    ds_write_b128 v70, v[32:35] offset:28672
    ds_write_b128 v70, v[36:39] offset:29696
    ds_write_b128 v70, v[40:43] offset:30720
    ds_write_b128 v70, v[44:47] offset:31744
    ds_write_b128 v70, v[48:51] offset:32768
    ds_write_b128 v70, v[52:55] offset:33792
    ds_write_b128 v70, v[56:59] offset:34816
    ds_write_b128 v70, v[60:63] offset:35840
    s_waitcnt vmcnt(0) lgkmcnt(0)
    s_cmp_lg_u32 s95, 0
    s_cbranch_scc1 cf_hn
    s_mov_b32 s88, 4194304
gn2:
    buffer_load_dword v2, off, s[84:87], 0 offset:216 sc1
    s_waitcnt vmcnt(0)
    v_readfirstlane_b32 s95, v2
    s_sub_u32 s88, s88, 1
    s_cbranch_scc1 gn2x
    s_cmp_eq_u32 s95, 0
    s_cbranch_scc1 gn2
gn2x:
cf_hn:
    v_mov_b32 v2, 1
    s_cmp_lg_u32 s13, 0
    s_cbranch_scc1 cf_noarr
    s_mov_b64 exec, 1
    s_mov_b32 s42, 1
    v_mov_b32 v4, v76
    s_cmp_ge_u32 s94, 32
    s_cbranch_scc1 cf_have
    s_mov_b32 s40, 131072
    s_mov_b32 s42, 2
cf_startpoll:
    buffer_load_dword v3, off, s[84:87], 0 offset:132 sc1
    s_sub_u32 s40, s40, 1
    s_cbranch_scc1 cf_decide
    s_waitcnt vmcnt(0)
    v_readfirstlane_b32 s41, v3
    s_nop 1
    s_cmp_lt_u32 s41, 32
    s_cbranch_scc1 cf_startpoll
    s_mov_b32 s42, 1
cf_decide:
    v_mov_b32 v4, s42
    v_mov_b32 v5, 0
    buffer_atomic_cmpswap v[4:5], off, s[84:87], 0 offset:28 sc0
    s_waitcnt vmcnt(0)
cf_have:
    v_mov_b32 v5, s42
    v_cmp_eq_u32 vcc, 0, v4
    s_nop 1
    v_cndmask_b32 v4, v4, v5, vcc
    v_mov_b32 v5, 16192
    ds_write_b32 v5, v4
    s_waitcnt lgkmcnt(0)
    s_mov_b64 exec, -1
cf_noarr:
    s_barrier
    v_mov_b32 v5, 16192
    ds_read_b32 v4, v5
    s_waitcnt lgkmcnt(0)
    v_readfirstlane_b32 s41, v4
    s_nop 1
    s_cmp_eq_u32 s41, 1
    s_cbranch_scc1 cf_run
    v_lshrrev_b32 v0, 4, v65
    s_mov_b32 s32, s13
    s_load_dwordx16 s[48:63], s[0:1], 0
    s_waitcnt lgkmcnt(0)
    s_branch L_helper
cf_run:
    s_mov_b64 exec, s[100:101]
    v_mov_b32 v72, s95
    s_mov_b64 exec, -1
    s_cmp_ge_u32 s97, 3
    s_cbranch_scc1 cf_kvdone
    s_mov_b32 s40, 3
    v_bfe_u32 v78, v65, 4, 3
    v_lshlrev_b32 v78, 7, v78
    s_mov_b32 s31, 4194304
cf_kv0:
    buffer_load_dword v77, v78, s[4:7], s96 offen sc1
    s_waitcnt vmcnt(0)
    v_subrev_u32 v77, s95, v77
    v_cmp_lt_u32 vcc, 16, v77
    s_nop 1
    v_cndmask_b32 v77, v77, 0, vcc
    v_bfe_u32 v79, v78, 7, 2
    v_lshl_add_u32 v77, v77, 2, v79
    s_nop 1
    v_min_u32_dpp v77, v77, v77 row_ror:1 row_mask:0xf bank_mask:0xf
    s_nop 1
    v_min_u32_dpp v77, v77, v77 row_ror:2 row_mask:0xf bank_mask:0xf
    s_nop 1
    v_min_u32_dpp v77, v77, v77 row_ror:4 row_mask:0xf bank_mask:0xf
    s_nop 0
    v_readfirstlane_b32 s97, v77
    s_sub_u32 s31, s31, 1
    s_cbranch_scc1 cf_kv0_x
    s_cmp_le_u32 s40, s97
    s_cbranch_scc1 cf_kv0_x
    s_sleep 2
    s_branch cf_kv0
cf_kv0_x:
    s_add_u32 s40, s26, 0
    s_min_u32 s40, s40, s99
    s_sub_u32 s41, s96, s40
    v_bfe_u32 v77, v65, 4, 3
    v_lshl_add_u32 v77, v77, 7, s41
    v_lshlrev_b32 v78, 3, v69
    s_nop 0
    v_mov_b32_dpp v78, v77 quad_perm:[0,1,2,3] row_mask:0xc bank_mask:0xf
    buffer_load_dword v76, v78, s[4:7], s40 offen sc1
    s_add_u32 s40, s26, 524288
    s_min_u32 s40, s40, s99
    s_sub_u32 s41, s96, s40
    v_bfe_u32 v77, v65, 4, 3
    v_lshl_add_u32 v77, v77, 7, s41
    v_lshlrev_b32 v78, 3, v69
    s_nop 0
    v_mov_b32_dpp v78, v77 quad_perm:[0,1,2,3] row_mask:0xc bank_mask:0xf
    buffer_load_dword v76, v78, s[4:7], s40 offen sc1
cf_kvdone:
    v_mov_b64 v[0:1], 0
    v_mov_b64 v[2:3], 0
    v_mov_b64 v[4:5], 0
    v_mov_b64 v[6:7], 0
    v_mov_b64 v[8:9], 0
    v_mov_b64 v[10:11], 0
    v_mov_b64 v[12:13], 0
    v_mov_b64 v[14:15], 0
    v_mov_b64 v[16:17], 0
    v_mov_b64 v[18:19], 0
    v_mov_b64 v[20:21], 0
    v_mov_b64 v[22:23], 0
    ds_read_b128 v[44:47], v70 offset:0
    ds_read_b128 v[48:51], v70 offset:1024
    ds_read_b128 v[52:55], v70 offset:2048
    ds_read_b128 v[56:59], v70 offset:3072
    ds_read_b128 v[24:27], v70 offset:4096
    ds_read_b128 v[28:31], v70 offset:5120
    ds_read_b128 v[32:35], v70 offset:6144
    ds_read_b128 v[36:39], v70 offset:7168
    buffer_load_dwordx4 v[40:43], v65, s[4:7], s14 offen offset:0 nt
    buffer_load_dwordx4 v[60:63], v66, s[4:7], s14 offen offset:0 nt
    s_mov_b32 s31, 1048576
    s_waitcnt vmcnt(0) lgkmcnt(0)
    s_branch cf_goA
cf_loop:
    s_mov_b32 s31, 1048576
    s_mov_b32 s69, s70
    s_waitcnt lgkmcnt(0)
cf_cA:
    buffer_load_dwordx4 v[40:43], v65, s[4:7], s14 offen offset:0 nt
    buffer_load_dwordx4 v[60:63], v66, s[4:7], s14 offen offset:0 nt
cf_cA1:
    v_bitop3_b32 v77, v40, v60, s70 bitop3:0x7e
    v_and_b32 v77, 1, v77
    v_cmp_ne_u32 vcc, 0, v77
    s_cbranch_vccz cf_goA
    v_bitop3_b32 v77, v40, v60, s70 bitop3:0x7e
    v_and_b32 v77, 1, v77
    v_cmp_ne_u32 vcc, 0, v77
    s_cbranch_vccz cf_goA
    v_bitop3_b32 v77, v40, v60, s70 bitop3:0x7e
    v_and_b32 v77, 1, v77
    v_cmp_ne_u32 vcc, 0, v77
    s_cbranch_vccz cf_goA
    v_bitop3_b32 v77, v40, v60, s70 bitop3:0x7e
    v_and_b32 v77, 1, v77
    v_cmp_ne_u32 vcc, 0, v77
    s_cbranch_vccz cf_goA
    buffer_load_dwordx4 v[40:43], v65, s[4:7], s14 offen offset:0 nt
    buffer_load_dwordx4 v[60:63], v66, s[4:7], s14 offen offset:0 nt
    v_bitop3_b32 v77, v40, v60, s70 bitop3:0x7e
    v_and_b32 v77, 1, v77
    v_cmp_ne_u32 vcc, 0, v77
    s_cbranch_vccz cf_goA
    v_bitop3_b32 v77, v40, v60, s70 bitop3:0x7e
    v_and_b32 v77, 1, v77
    v_cmp_ne_u32 vcc, 0, v77
    s_cbranch_vccz cf_goA
    v_bitop3_b32 v77, v40, v60, s70 bitop3:0x7e
    v_and_b32 v77, 1, v77
    v_cmp_ne_u32 vcc, 0, v77
    s_cbranch_vccz cf_goA
    v_bitop3_b32 v77, v40, v60, s70 bitop3:0x7e
    v_and_b32 v77, 1, v77
    v_cmp_ne_u32 vcc, 0, v77
    s_cbranch_vccz cf_goA
    buffer_load_dwordx4 v[40:43], v65, s[4:7], s14 offen offset:0 nt
    buffer_load_dwordx4 v[60:63], v66, s[4:7], s14 offen offset:0 nt
    v_bitop3_b32 v77, v40, v60, s70 bitop3:0x7e
    v_and_b32 v77, 1, v77
    v_cmp_ne_u32 vcc, 0, v77
    s_cbranch_vccz cf_goA
    v_bitop3_b32 v77, v40, v60, s70 bitop3:0x7e
    v_and_b32 v77, 1, v77
    v_cmp_ne_u32 vcc, 0, v77
    s_cbranch_vccz cf_goA
    v_bitop3_b32 v77, v40, v60, s70 bitop3:0x7e
    v_and_b32 v77, 1, v77
    v_cmp_ne_u32 vcc, 0, v77
    s_cbranch_vccz cf_goA
    v_bitop3_b32 v77, v40, v60, s70 bitop3:0x7e
    v_and_b32 v77, 1, v77
    v_cmp_ne_u32 vcc, 0, v77
    s_cbranch_vccz cf_goA
    buffer_load_dwordx4 v[40:43], v65, s[4:7], s14 offen offset:0 nt
    buffer_load_dwordx4 v[60:63], v66, s[4:7], s14 offen offset:0 nt
    v_bitop3_b32 v77, v40, v60, s70 bitop3:0x7e
    v_and_b32 v77, 1, v77
    v_cmp_ne_u32 vcc, 0, v77
    s_cbranch_vccz cf_goA
    v_bitop3_b32 v77, v40, v60, s70 bitop3:0x7e
    v_and_b32 v77, 1, v77
    v_cmp_ne_u32 vcc, 0, v77
    s_cbranch_vccz cf_goA
    v_bitop3_b32 v77, v40, v60, s70 bitop3:0x7e
    v_and_b32 v77, 1, v77
    v_cmp_ne_u32 vcc, 0, v77
    s_cbranch_vccz cf_goA
    v_bitop3_b32 v77, v40, v60, s70 bitop3:0x7e
    v_and_b32 v77, 1, v77
    v_cmp_ne_u32 vcc, 0, v77
    s_cbranch_vccz cf_goA
    s_sub_u32 s31, s31, 64
    s_cbranch_scc0 cf_cA
cf_goA:
    ds_write_b128 v65, v[40:43] offset:0
    v_smfmac_f32_16x16x64_bf16 v[0:3], v[40:43], v[44:51], v64
    v_smfmac_f32_16x16x64_bf16 v[4:7], v[40:43], v[52:59], v64
    buffer_load_dwordx4 v[44:47], v65, s[4:7], s15 offen offset:0 nt
    v_smfmac_f32_16x16x64_bf16 v[0:3], v[60:63], v[24:31], v64
    s_add_u32 s40, s26, 1048576
    s_min_u32 s40, s40, s99
    s_sub_u32 s41, s96, s40
    v_smfmac_f32_16x16x64_bf16 v[4:7], v[60:63], v[32:39], v64
    ds_read_b128 v[24:27], v70 offset:8192
    s_cmp_lt_u32 s97, s67
    s_cselect_b32 s42, -1, 0
    v_smfmac_f32_16x16x64_bf16 v[8:11], v[40:43], a[96:103], v64
    ds_read_b128 v[28:31], v70 offset:9216
    v_smfmac_f32_16x16x64_bf16 v[12:15], v[40:43], a[104:111], v64
    ds_read_b128 v[32:35], v70 offset:10240
    s_waitcnt lgkmcnt(3)
    s_barrier
    ds_read_b128 v[48:51], v67 offset:0
    v_smfmac_f32_16x16x64_bf16 v[8:11], v[60:63], a[112:119], v64
    ds_read_b128 v[36:39], v70 offset:11264
    v_bitop3_b32 v79, v73, -9, s54 bitop3:0x6a
    v_smfmac_f32_16x16x64_bf16 v[12:15], v[60:63], a[120:127], v64
    buffer_load_dwordx4 v[44:47], v65, s[4:7], s15 offen offset:0 nt
    v_smfmac_f32_16x16x64_bf16 v[16:19], v[40:43], a[232:239], v64
    ds_read_b128 v[52:55], v68 offset:0
    s_waitcnt lgkmcnt(4)
    v_bfe_u32 v77, v65, 4, 3
    v_smfmac_f32_16x16x64_bf16 v[20:23], v[40:43], v[24:31], v64
    ds_read_b128 v[24:27], v70 offset:12288
    s_waitcnt lgkmcnt(3)
    v_smfmac_f32_16x16x64_bf16 v[0:3], v[48:51], a[0:7], v64
    ds_read_b128 v[28:31], v70 offset:13312
    s_waitcnt lgkmcnt(3)
    v_lshl_add_u32 v77, v77, 7, s41
    v_smfmac_f32_16x16x64_bf16 v[4:7], v[48:51], v[32:39], v64
    buffer_load_dwordx4 v[40:43], v65, s[4:7], s16 offen offset:0 nt
    v_smfmac_f32_16x16x64_bf16 v[16:19], v[60:63], a[240:247], v64
    ds_read_b128 v[32:35], v70 offset:14336
    v_lshlrev_b32 v78, 3, v69
    v_smfmac_f32_16x16x64_bf16 v[20:23], v[60:63], a[248:255], v64
    ds_read_b128 v[36:39], v70 offset:15360
    v_smfmac_f32_16x16x64_bf16 v[8:11], v[48:51], a[128:135], v64
    s_waitcnt vmcnt(2)
    v_mov_b32_dpp v78, v77 quad_perm:[0,1,2,3] row_mask:0xc bank_mask:0xf
    v_smfmac_f32_16x16x64_bf16 v[12:15], v[48:51], a[136:143], v64
    buffer_load_dwordx4 v[58:61], v65, s[4:7], s24 offen offset:3072 sc1
    s_waitcnt lgkmcnt(2)
    v_and_b32 v77, s36, v44
    v_smfmac_f32_16x16x64_bf16 v[12:15], v[52:55], v[24:31], v64
    ds_write_b128 v65, v[44:47] offset:4096
    v_smfmac_f32_16x16x64_bf16 v[0:3], v[52:55], a[8:15], v64
    v_cmp_ne_u32 vcc, s70, v77
    v_smfmac_f32_16x16x64_bf16 v[8:11], v[52:55], a[144:151], v64
    buffer_load_dwordx4 v[24:27], v65, s[4:7], s24 offen offset:0 sc1
    s_waitcnt lgkmcnt(1)
    v_smfmac_f32_16x16x64_bf16 v[4:7], v[52:55], v[32:39], v64
    s_cbranch_vccnz cf_spinB
cf_backB:
    v_smfmac_f32_16x16x64_bf16 v[16:19], v[44:47], v[176:183], v64
    s_waitcnt lgkmcnt(0)
    s_barrier
    ds_read_b128 v[48:51], v66 offset:4096
    v_smfmac_f32_16x16x64_bf16 v[12:15], v[44:47], a[160:167], v64
    buffer_load_dwordx4 v[28:31], v65, s[4:7], s24 offen offset:1024 sc1
    v_smfmac_f32_16x16x64_bf16 v[0:3], v[44:47], a[16:23], v64
    ds_read_b128 v[52:55], v67 offset:4096
    v_smfmac_f32_16x16x64_bf16 v[8:11], v[44:47], a[152:159], v64
    v_smfmac_f32_16x16x64_bf16 v[4:7], v[44:47], a[24:31], v64
    buffer_load_dwordx4 v[34:37], v65, s[4:7], s24 offen offset:2048 sc1
    s_waitcnt vmcnt(5)
    v_smfmac_f32_16x16x64_bf16 v[20:23], v[44:47], v[184:191], v64
    ds_read_b128 v[44:47], v68 offset:4096
    s_waitcnt lgkmcnt(2)
    v_smfmac_f32_16x16x64_bf16 v[0:3], v[48:51], a[32:39], v64
    v_smfmac_f32_16x16x64_bf16 v[8:11], v[48:51], a[168:175], v64
    s_mov_b32 exec_hi, s42
    buffer_load_dword v76, v78, s[4:7], s40 offen sc1
    s_mov_b32 exec_hi, -1
    v_smfmac_f32_16x16x64_bf16 v[4:7], v[48:51], a[40:47], v64
    s_waitcnt vmcnt(5)
    v_and_b32 v77, s36, v40
    v_smfmac_f32_16x16x64_bf16 v[12:15], v[48:51], a[176:183], v64
    ds_read_b128 v[48:51], v69 offset:15360
    s_waitcnt lgkmcnt(1)
    v_cmp_ne_u32 vcc, s70, v77
    v_smfmac_f32_16x16x64_bf16 v[0:3], v[52:55], a[48:55], v64
    v_smfmac_f32_16x16x64_bf16 v[8:11], v[52:55], a[184:191], v64
    s_cbranch_vccnz cf_spin8
cf_back8:
    v_smfmac_f32_16x16x64_bf16 v[0:3], v[44:47], a[64:71], v64
    v_smfmac_f32_16x16x64_bf16 v[8:11], v[44:47], a[200:207], v64
    v_smfmac_f32_16x16x64_bf16 v[0:3], v[40:43], a[80:87], v64
    s_nop 1
    v_smfmac_f32_16x16x64_bf16 v[8:11], v[40:43], a[216:223], v64
    s_nop 1
    v_lshrrev_b32 v77, 1, v69
    v_smfmac_f32_16x16x64_bf16 v[4:7], v[52:55], a[56:63], v64
    s_nop 1
    v_cvt_pk_bf16_f32 v0, v0, v1
    v_smfmac_f32_16x16x64_bf16 v[12:15], v[52:55], a[192:199], v64
    s_nop 1
    v_cvt_pk_bf16_f32 v1, v2, v3
    v_smfmac_f32_16x16x64_bf16 v[4:7], v[44:47], a[72:79], v64
    s_nop 1
    v_cvt_pk_bf16_f32 v2, v8, v9
    v_smfmac_f32_16x16x64_bf16 v[12:15], v[44:47], a[208:215], v64
    s_nop 1
    v_cvt_pk_bf16_f32 v3, v10, v11
    v_smfmac_f32_16x16x64_bf16 v[4:7], v[40:43], a[88:95], v64
    s_waitcnt lgkmcnt(0)
    s_nop 0
    s_nop 0
    v_smfmac_f32_16x16x64_bf16 v[12:15], v[40:43], a[224:231], v64
    s_nop 2
    v_mfma_f32_16x16x32_bf16 v[8:11], v[0:3], v[48:51], 0
    s_nop 0
    v_cvt_pk_bf16_f32 v4, v4, v5
    v_cvt_pk_bf16_f32 v5, v6, v7
    s_nop 0
    v_cvt_pk_bf16_f32 v6, v12, v13
    v_cvt_pk_bf16_f32 v7, v14, v15
    s_nop 1
    v_mfma_f32_16x16x32_bf16 v[12:15], v[4:7], v[48:51], 0
    ds_read_b128 v[48:51], v66 offset:4096
    v_cvt_pk_bf16_f32 v0, v8, v9
    v_cvt_pk_bf16_f32 v1, v10, v11
    v_smfmac_f32_16x16x64_bf16 v[16:19], v[52:55], v[208:215], v64
    s_waitcnt vmcnt(2)
    s_nop 2
    v_cvt_pk_bf16_f32 v2, v12, v13
    v_cvt_pk_bf16_f32 v3, v14, v15
    s_nop 1
    v_mfma_f32_16x16x32_bf16 v[12:15], v[0:3], v[0:3], 0
    s_nop 1
    v_bitop3_b32 v78, v73, -9, s53 bitop3:0x6a
    v_mfma_f32_16x16x32_bf16 v[4:7], v[24:27], v[0:3], 0
    ds_read_b128 v[24:27], v67 offset:0
    s_nop 1
    v_mfma_f32_16x16x32_bf16 v[8:11], v[28:31], v[0:3], 0
    s_nop 0
    v_mov_b32_dpp v12, v14 row_ror:8 row_mask:0xf bank_mask:0xc
    v_mov_b32_dpp v13, v15 row_ror:8 row_mask:0xf bank_mask:0xc
    v_smfmac_f32_16x16x64_bf16 v[20:23], v[52:55], v[216:223], v64
    ds_write_b64 v71, v[12:13]
    ds_read_b128 v[52:55], v68 offset:0
    s_nop 1
    v_mov_b32_dpp v4, v8 row_ror:8 row_mask:0xf bank_mask:0xc
    v_mov_b32_dpp v5, v9 row_ror:8 row_mask:0xf bank_mask:0xc
    v_mov_b32_dpp v6, v10 row_ror:8 row_mask:0xf bank_mask:0xc
    v_mov_b32_dpp v7, v11 row_ror:8 row_mask:0xf bank_mask:0xc
    v_smfmac_f32_16x16x64_bf16 v[16:19], v[44:47], v[224:231], v64
    ds_write_b128 v65, v[4:7] offset:8192
    v_smfmac_f32_16x16x64_bf16 v[20:23], v[44:47], v[232:239], v64
    s_waitcnt lgkmcnt(3)
    v_smfmac_f32_16x16x64_bf16 v[16:19], v[24:27], v[144:151], v64
    s_waitcnt vmcnt(1)
    v_smfmac_f32_16x16x64_bf16 v[20:23], v[24:27], v[152:159], v64
    s_mov_b64 exec, s[38:39]
    buffer_store_dword v72, v75, s[4:7], s55 offen sc1
    s_mov_b64 exec, -1
    v_smfmac_f32_16x16x64_bf16 v[16:19], v[40:43], v[240:247], v64
    s_cmp_ge_u32 s30, 56
    s_waitcnt lgkmcnt(0)
    s_barrier
    ds_read_b128 v[8:11], v66 offset:8192
    v_smfmac_f32_16x16x64_bf16 v[20:23], v[40:43], v[248:255], v64
    ds_read_b128 v[12:15], v67 offset:8192
    v_smfmac_f32_16x16x64_bf16 v[16:19], v[48:51], v[192:199], v64
    ds_read_b128 v[44:47], v68 offset:8192
    v_smfmac_f32_16x16x64_bf16 v[20:23], v[48:51], v[200:207], v64
    ds_read_b64 v[24:25], v77 offset:14336
    ds_read_b64 v[26:27], v77 offset:14592
    v_smfmac_f32_16x16x64_bf16 v[16:19], v[52:55], v[160:167], v64
    ds_read_b64 v[28:29], v77 offset:14848
    ds_read_b64 v[30:31], v77 offset:15104
    v_bitop3_b32 v77, v73, -9, s52 bitop3:0x6a
    v_smfmac_f32_16x16x64_bf16 v[20:23], v[52:55], v[168:175], v64
    s_cbranch_scc1 cf_rare
cf_rare_x:
    ds_read_b128 v[48:51], v70 offset:22528
    ds_read_b128 v[52:55], v70 offset:23552
    s_waitcnt lgkmcnt(6)
    v_pk_add_f32 v[4:5], v[4:5], v[8:9]
    v_pk_add_f32 v[6:7], v[6:7], v[10:11]
    v_pk_add_f32 v[12:13], v[12:13], v[44:45]
    v_pk_add_f32 v[14:15], v[14:15], v[46:47]
    v_pk_add_f32 v[4:5], v[4:5], v[12:13]
    v_pk_add_f32 v[6:7], v[6:7], v[14:15]
    s_waitcnt lgkmcnt(2)
    v_pk_add_f32 v[24:25], v[24:25], v[26:27]
    v_pk_add_f32 v[28:29], v[28:29], v[30:31]
    v_max3_f32 v8, v4, v5, v6
    v_pk_add_f32 v[24:25], v[24:25], v[28:29]
    v_max_f32 v8, v8, v7
    v_max3_f32 v8, v8, v24, v25
    v_cvt_pk_bf16_f32 v32, v16, v17
    v_cvt_pk_bf16_f32 v38, v18, v19
    v_max_f32_dpp v8, v8, v8 row_ror:8 row_mask:0xf bank_mask:0xf
    v_mov_b32 v9, v8
    v_cvt_pk_bf16_f32 v56, v20, v21
    v_cvt_pk_bf16_f32 v62, v22, v23
    v_permlane32_swap_b32 v8, v9
    v_max_f32 v8, v8, v9
    v_mov_b32 v9, v8
    v_mov_b32 v11, 0
    v_mov_b32 v15, 0
    v_permlane16_swap_b32 v8, v9
    v_max_f32 v8, v8, v9
    v_mul_f32 v8, s66, v8
    v_pk_fma_f32 v[4:5], v[4:5], s[44:45], v[8:9] op_sel_hi:[1,1,0]
    v_pk_fma_f32 v[6:7], v[6:7], s[44:45], v[8:9] op_sel_hi:[1,1,0]
    v_pk_fma_f32 v[24:25], v[24:25], s[44:45], v[8:9] op_sel_hi:[1,1,0]
    v_exp_f32 v4, v4
    v_exp_f32 v5, v5
    v_exp_f32 v6, v6
    v_exp_f32 v7, v7
    v_exp_f32 v24, v24
    v_exp_f32 v25, v25
    v_cvt_pk_bf16_f32 v12, v4, v5
    v_cvt_pk_bf16_f32 v13, v6, v7
    v_cvt_pk_bf16_f32 v10, v24, v25
    v_cvt_pk_bf16_f32 v14, v24, v25
    v_mov_b64 v[0:1], s[48:49]
    v_mfma_f32_16x16x32_bf16 v[4:7], v[32:35], v[10:13], 0
    ds_read_b128 v[40:43], v70 offset:20480
    v_mov_b64 v[2:3], s[50:51]
    v_mfma_f32_16x16x32_bf16 v[24:27], v[36:39], v[12:15], 0
    ds_read_b128 v[44:47], v70 offset:21504
    v_mov_b64 v[8:9], 0
    v_mfma_f32_16x16x32_bf16 v[28:31], v[0:3], v[10:13], 0
    ds_read_b128 v[32:35], v70 offset:24576
    v_mov_b64 v[0:1], 0
    v_mfma_f32_16x16x32_bf16 v[16:19], v[56:59], v[10:13], 0
    ds_read_b128 v[36:39], v70 offset:25600
    v_mov_b64 v[2:3], 0
    v_mfma_f32_16x16x32_bf16 v[20:23], v[60:63], v[12:15], 0
    ds_read_b128 v[56:59], v70 offset:28672
    v_add_f32_dpp v4, v24, v4 row_ror:8 row_mask:0xf bank_mask:0xf
    v_add_f32_dpp v5, v25, v5 row_ror:8 row_mask:0xf bank_mask:0xf
    v_add_f32_dpp v6, v26, v6 row_ror:8 row_mask:0xf bank_mask:0xf
    v_add_f32_dpp v7, v27, v7 row_ror:8 row_mask:0xf bank_mask:0xf
    v_add_f32_dpp v29, v28, v28 row_ror:8 row_mask:0xf bank_mask:0xf
    v_rcp_f32 v28, v29
    v_mov_b64 v[10:11], 0
    v_add_f32_dpp v4, v16, v20 row_ror:8 row_mask:0xf bank_mask:0xc
    v_add_f32_dpp v5, v17, v21 row_ror:8 row_mask:0xf bank_mask:0xc
    v_add_f32_dpp v6, v18, v22 row_ror:8 row_mask:0xf bank_mask:0xc
    v_add_f32_dpp v7, v19, v23 row_ror:8 row_mask:0xf bank_mask:0xc
    v_pk_mul_f32 v[4:5], v[4:5], v[28:29] op_sel_hi:[1,0]
    v_pk_mul_f32 v[6:7], v[6:7], v[28:29] op_sel_hi:[1,0]
    v_cvt_pk_bf16_f32 v4, v4, v5
    v_cvt_pk_bf16_f32 v5, v6, v7
    ds_write_b64 v73, v[4:5] offset:12288
    v_mov_b32_dpp v6, v4 row_ror:8 row_mask:0xf bank_mask:0xf
    v_mov_b32_dpp v7, v5 row_ror:8 row_mask:0xf bank_mask:0xf
    v_mov_b64 v[12:13], 0
    v_mov_b64 v[14:15], 0
    v_smfmac_f32_16x16x64_bf16 v[8:11], v[4:7], v[80:87], v64
    s_waitcnt lgkmcnt(4)
    v_mov_b64 v[24:25], 0
    v_smfmac_f32_16x16x64_bf16 v[0:3], v[4:7], v[40:47], v64
    ds_read_b128 v[60:63], v70 offset:29696
    v_mov_b64 v[26:27], 0
    v_smfmac_f32_16x16x64_bf16 v[12:15], v[4:7], v[112:119], v64
    s_waitcnt lgkmcnt(1)
    s_barrier
    ds_read_b128 v[16:19], v77 offset:12288
    v_smfmac_f32_16x16x64_bf16 v[24:27], v[4:7], v[48:55], v64
    ds_read_b128 v[20:23], v78 offset:12288
    ds_read_b128 v[28:31], v79 offset:12288
    v_mov_b64 v[4:5], 0
    v_mov_b64 v[6:7], 0
    v_bfe_u32 v77, v74, 16, 1
    v_mad_i32_i24 v77, v77, s56, v74
    s_waitcnt lgkmcnt(2)
    v_smfmac_f32_16x16x64_bf16 v[8:11], v[16:19], v[88:95], v64
    ds_read_b128 v[40:43], v70 offset:32768
    s_waitcnt lgkmcnt(2)
    v_smfmac_f32_16x16x64_bf16 v[8:11], v[20:23], v[96:103], v64
    ds_read_b128 v[44:47], v70 offset:33792
    s_waitcnt lgkmcnt(2)
    v_smfmac_f32_16x16x64_bf16 v[8:11], v[28:31], v[104:111], v64
    ds_read_b128 v[48:51], v70 offset:26624
    s_nop 0
    v_and_b32 v72, 8, v73
    v_smfmac_f32_16x16x64_bf16 v[0:3], v[16:19], v[32:39], v64
    ds_read_b128 v[52:55], v70 offset:27648
    s_nop 0
    v_mad_u32_u24 v72, v72, 63, v73
    v_smfmac_f32_16x16x64_bf16 v[12:15], v[16:19], v[120:127], v64
    ds_read_b128 v[32:35], v70 offset:30720
    v_cvt_pk_bf16_f32 v8, v8, v9
    v_cvt_pk_bf16_f32 v9, v10, v11
    v_and_or_b32 v8, v8, -2, s69
    v_smfmac_f32_16x16x64_bf16 v[12:15], v[20:23], v[128:135], v64
    buffer_store_dwordx2 v[8:9], v74, s[4:7], s22 offen offset:0
    ds_read_b128 v[36:39], v70 offset:31744
    v_smfmac_f32_16x16x64_bf16 v[12:15], v[28:31], v[136:143], v64
    s_add_u32 s30, s30, 1
    s_xor_b32 s70, s70, 1
    v_subrev_u32 v72, s47, v72
    v_smfmac_f32_16x16x64_bf16 v[0:3], v[20:23], v[56:63], v64
    ds_read_b128 v[56:59], v70 offset:34816
    s_waitcnt lgkmcnt(3)
    s_nop 0
    v_smfmac_f32_16x16x64_bf16 v[0:3], v[28:31], v[40:47], v64
    ds_read_b128 v[60:63], v70 offset:35840
    v_cvt_pk_bf16_f32 v12, v12, v13
    v_cvt_pk_bf16_f32 v13, v14, v15
    v_and_or_b32 v12, v12, -2, s69
    v_smfmac_f32_16x16x64_bf16 v[24:27], v[16:19], v[48:55], v64
    buffer_store_dwordx2 v[12:13], v74, s[4:7], s22 offen offset:64
    s_waitcnt lgkmcnt(2)
    v_smfmac_f32_16x16x64_bf16 v[24:27], v[20:23], v[32:39], v64
    ds_read_b128 v[40:43], v70 offset:16384
    v_cvt_pk_bf16_f32 v0, v0, v1
    v_cvt_pk_bf16_f32 v1, v2, v3
    v_and_or_b32 v0, v0, -2, s69
    s_waitcnt lgkmcnt(1)
    v_smfmac_f32_16x16x64_bf16 v[24:27], v[28:31], v[56:63], v64
    buffer_store_dwordx2 v[0:1], v74, s[4:7], s23 offen offset:0
    ds_read_b128 v[44:47], v70 offset:17408
    ds_read_b128 v[8:11], v72 offset:12288
    ds_read_b128 v[48:51], v70 offset:18432
    ds_read_b128 v[52:55], v70 offset:19456
    ds_read_b128 v[12:15], v72 offset:13312
    s_cmp_lg_u32 s71, 0
    s_nop 0
    v_cvt_pk_bf16_f32 v24, v24, v25
    v_cvt_pk_bf16_f32 v25, v26, v27
    v_and_or_b32 v24, v24, -2, s69
    buffer_store_dwordx2 v[24:25], v74, s[4:7], s23 offen offset:64
    s_waitcnt lgkmcnt(3)
    v_smfmac_f32_16x16x64_bf16 v[4:7], v[8:11], v[40:47], v64
    s_waitcnt lgkmcnt(0)
    v_smfmac_f32_16x16x64_bf16 v[4:7], v[12:15], v[48:55], v64
    s_nop 7
    v_cvt_pk_bf16_f32 v4, v4, v5
    v_cvt_pk_bf16_f32 v5, v6, v7
    v_and_or_b32 v4, v4, -2, s69
    buffer_store_dwordx2 v[4:5], v77, s[4:7], s25 offen offset:0
    s_nop 0
    s_cbranch_scc1 cf_e1
    s_cmp_lg_u32 s37, 0
    s_cbranch_scc1 cf_f0_xt
cf_f0_xtx:
    s_nop 2
    v_mov_b32 v79, v79
    s_nop 2
    v_mov_b32 v79, v79
    s_nop 2
    v_mov_b32 v79, v79
    s_nop 2
    v_mov_b32 v79, v79
    s_nop 2
    v_mov_b32 v79, v79
    buffer_load_dwordx4 v[8:11], v65, s[4:7], s18 offen nt
    buffer_load_dwordx4 v[12:15], v65, s[4:7], s19 offen nt
    buffer_load_dwordx4 v[16:19], v65, s[4:7], s20 offen nt
    buffer_load_dwordx4 v[20:23], v65, s[4:7], s21 offen nt
    v_and_b32 v77, 255, v69
    ds_read_b128 v[4:7], v77 offset:15872
    ds_read_b128 v[44:47], v70 offset:0
    ds_read_b128 v[48:51], v70 offset:1024
    ds_read_b128 v[52:55], v70 offset:2048
    ds_read_b128 v[56:59], v70 offset:3072
    ds_read_b128 v[24:27], v70 offset:4096
    ds_read_b128 v[28:31], v70 offset:5120
    ds_read_b128 v[32:35], v70 offset:6144
    ds_read_b128 v[36:39], v70 offset:7168
    s_mov_b32 s31, 65536
    s_add_u32 s24, s24, 524288
    s_add_u32 s26, s26, 524288
    s_add_u32 s55, s55, s57
    s_mov_b32 s14, 67108864
    s_mov_b32 s15, 67112960
    s_mov_b32 s16, 67117056
    s_mov_b32 s36, 1
    v_mov_b32 v40, s69
    v_mov_b32 v60, s69
    v_and_b32 v79, 12, v75
    v_cmp_eq_u32 vcc, 0, v79
    s_nop 1
    v_cndmask_b32 v79, 0, 1, vcc
    s_waitcnt lgkmcnt(0)
    s_waitcnt vmcnt(3)
    v_bitop3_b32 v77, v8, v10, s69 bitop3:0x7e
    v_mfma_f32_16x16x32_bf16 v[0:3], v[4:7], v[8:11], 0
    v_mov_b64 v[8:9], 0
    v_mov_b64 v[10:11], 0
    s_waitcnt vmcnt(2)
    v_bitop3_b32 v78, v12, v14, s69 bitop3:0x7e
    v_mfma_f32_16x16x32_bf16 v[0:3], v[4:7], v[12:15], v[0:3]
    v_or_b32 v77, v77, v78
    v_mov_b64 v[12:13], 0
    v_mov_b64 v[14:15], 0
    s_waitcnt vmcnt(1)
    v_bitop3_b32 v78, v16, v18, s69 bitop3:0x7e
    v_mfma_f32_16x16x32_bf16 v[0:3], v[4:7], v[16:19], v[0:3]
    v_or_b32 v77, v77, v78
    v_mov_b64 v[16:17], 0
    v_mov_b64 v[18:19], 0
    s_waitcnt vmcnt(0)
    v_bitop3_b32 v78, v20, v22, s69 bitop3:0x7e
    v_mfma_f32_16x16x32_bf16 v[0:3], v[4:7], v[20:23], v[0:3]
    v_bitop3_b32 v77, v77, v78, 1 bitop3:0xa8
    v_cmp_ne_u32 vcc, 0, v77
    v_mov_b64 v[20:21], 0
    v_mov_b64 v[22:23], 0
    s_cmp_eq_u64 vcc, 0
    s_cselect_b64 s[42:43], -1, 0
    s_nop 1
    v_add_f32_dpp v0, v0, v0 row_ror:8 row_mask:0xf bank_mask:0xf
    v_add_f32_dpp v1, v1, v1 row_ror:8 row_mask:0xf bank_mask:0xf
    s_mov_b64 exec, s[42:43]
    v_cvt_pk_bf16_f32 v72, v0, v1
    v_bfi_b32 v72, v79, s70, v72
    buffer_store_dword v72, v75, s[4:7], s17 offen offset:0
    s_mov_b64 exec, -1
    s_cbranch_scc0 cf_f0_retry
cf_f0_go:
    v_mov_b64 v[0:1], 0
    v_mov_b64 v[2:3], 0
    v_mov_b64 v[4:5], 0
    v_mov_b64 v[6:7], 0
    s_nop 2
    v_mov_b32 v79, v79
    s_nop 2
    v_mov_b32 v79, v79
    s_nop 2
    v_mov_b32 v79, v79
    s_nop 2
    v_mov_b32 v79, v79
    s_branch cf_loop
cf_e1:
    s_cmp_lg_u32 s71, 2
    s_cbranch_scc1 cf_f1
    v_and_b32 v77, 255, v69
    ds_read_b128 v[4:7], v77 offset:15872
    ds_read_b128 v[44:47], v70 offset:0
    ds_read_b128 v[48:51], v70 offset:1024
    ds_read_b128 v[52:55], v70 offset:2048
    ds_read_b128 v[56:59], v70 offset:3072
    ds_read_b128 v[24:27], v70 offset:4096
    ds_read_b128 v[28:31], v70 offset:5120
    ds_read_b128 v[32:35], v70 offset:6144
    ds_read_b128 v[36:39], v70 offset:7168
    s_mov_b32 s31, 65536
    s_add_u32 s24, s24, 524288
    s_add_u32 s26, s26, 524288
    s_add_u32 s55, s55, s57
    s_mov_b32 s14, 67108864
    s_mov_b32 s15, 67112960
    s_mov_b32 s16, 67117056
    s_mov_b32 s36, 1
    v_mov_b32 v40, s69
    v_mov_b32 v60, s69
    v_and_b32 v79, 12, v75
    v_cmp_eq_u32 vcc, 0, v79
    s_nop 1
    v_cndmask_b32 v79, 0, 1, vcc
    s_cmp_lg_u32 s37, 0
    s_cbranch_scc1 cf_f2_xt
cf_f2_xtx:
    s_nop 2
    v_mov_b32 v79, v79
    s_nop 2
    v_mov_b32 v79, v79
    s_nop 2
    v_mov_b32 v79, v79
    s_nop 2
    v_mov_b32 v79, v79
    s_nop 2
    v_mov_b32 v79, v79
    s_nop 2
    v_mov_b32 v79, v79
    s_nop 2
    v_mov_b32 v79, v79
    s_nop 2
    v_mov_b32 v79, v79
    s_waitcnt vmcnt(0)
    buffer_load_dwordx4 v[8:11], v65, s[4:7], s18 offen nt
    buffer_load_dwordx4 v[12:15], v65, s[4:7], s19 offen nt
    buffer_load_dwordx4 v[16:19], v65, s[4:7], s20 offen nt
    buffer_load_dwordx4 v[20:23], v65, s[4:7], s21 offen nt
    s_nop 2
    v_mov_b32 v79, v79
    s_nop 2
    v_mov_b32 v79, v79
    s_nop 2
    v_mov_b32 v79, v79
    s_nop 2
    v_mov_b32 v79, v79
    s_nop 2
    v_mov_b32 v79, v79
    s_nop 2
    v_mov_b32 v79, v79
    s_nop 2
    v_mov_b32 v79, v79
    s_nop 2
    v_mov_b32 v79, v79
    s_nop 2
    v_mov_b32 v79, v79
    s_nop 2
    v_mov_b32 v79, v79
    buffer_load_dwordx4 v[40:43], v65, s[4:7], s14 offen offset:0 nt
    buffer_load_dwordx4 v[60:63], v66, s[4:7], s14 offen offset:0 nt
    s_waitcnt lgkmcnt(0)
    s_waitcnt vmcnt(5)
    v_bitop3_b32 v77, v8, v10, s69 bitop3:0x7e
    v_mfma_f32_16x16x32_bf16 v[0:3], v[4:7], v[8:11], 0
    v_mov_b64 v[8:9], 0
    v_mov_b64 v[10:11], 0
    s_waitcnt vmcnt(4)
    v_bitop3_b32 v78, v12, v14, s69 bitop3:0x7e
    v_mfma_f32_16x16x32_bf16 v[0:3], v[4:7], v[12:15], v[0:3]
    v_or_b32 v77, v77, v78
    v_mov_b64 v[12:13], 0
    v_mov_b64 v[14:15], 0
    s_waitcnt vmcnt(3)
    v_bitop3_b32 v78, v16, v18, s69 bitop3:0x7e
    v_mfma_f32_16x16x32_bf16 v[0:3], v[4:7], v[16:19], v[0:3]
    v_or_b32 v77, v77, v78
    v_mov_b64 v[16:17], 0
    v_mov_b64 v[18:19], 0
    s_waitcnt vmcnt(2)
    v_bitop3_b32 v78, v20, v22, s69 bitop3:0x7e
    v_mfma_f32_16x16x32_bf16 v[0:3], v[4:7], v[20:23], v[0:3]
    v_bitop3_b32 v77, v77, v78, 1 bitop3:0xa8
    v_cmp_ne_u32 vcc, 0, v77
    v_mov_b64 v[20:21], 0
    v_mov_b64 v[22:23], 0
    buffer_load_dwordx4 v[40:43], v65, s[4:7], s14 offen offset:0 nt
    buffer_load_dwordx4 v[60:63], v66, s[4:7], s14 offen offset:0 nt
    s_cmp_eq_u64 vcc, 0
    s_cselect_b64 s[42:43], -1, 0
    v_add_f32_dpp v0, v0, v0 row_ror:4 row_mask:0xf bank_mask:0xf
    v_add_f32_dpp v1, v1, v1 row_ror:4 row_mask:0xf bank_mask:0xf
    s_nop 0
    v_add_f32_dpp v0, v0, v0 row_ror:8 row_mask:0xf bank_mask:0xf
    v_add_f32_dpp v1, v1, v1 row_ror:8 row_mask:0xf bank_mask:0xf
    s_mov_b64 exec, s[42:43]
    v_cvt_pk_bf16_f32 v72, v0, v1
    v_bfi_b32 v72, v79, s70, v72
    buffer_store_dword v72, v75, s[4:7], s17 offen offset:0
    buffer_store_dword v72, v75, s[4:7], s17 offen offset:1024
    buffer_store_dword v72, v75, s[4:7], s17 offen offset:2048
    buffer_store_dword v72, v75, s[4:7], s17 offen offset:3072
    s_mov_b64 exec, -1
    s_cbranch_scc0 cf_f2_retry
cf_f2_go:
    v_mov_b64 v[0:1], 0
    v_mov_b64 v[2:3], 0
    v_mov_b64 v[4:5], 0
    v_mov_b64 v[6:7], 0
    s_branch cf_loop
cf_f1:
    s_cmp_lg_u32 s32, 1
    s_cbranch_scc1 cf_f3
    v_and_b32 v77, 255, v69
    ds_read_b128 v[4:7], v77 offset:15872
    ds_read_b128 v[44:47], v70 offset:0
    ds_read_b128 v[48:51], v70 offset:1024
    ds_read_b128 v[52:55], v70 offset:2048
    ds_read_b128 v[56:59], v70 offset:3072
    ds_read_b128 v[24:27], v70 offset:4096
    ds_read_b128 v[28:31], v70 offset:5120
    ds_read_b128 v[32:35], v70 offset:6144
    ds_read_b128 v[36:39], v70 offset:7168
    s_mov_b32 s31, 65536
    s_add_u32 s24, s24, 524288
    s_add_u32 s26, s26, 524288
    s_add_u32 s55, s55, s57
    s_mov_b32 s14, 67108864
    s_mov_b32 s15, 67112960
    s_mov_b32 s16, 67117056
    s_mov_b32 s36, 1
    v_mov_b32 v40, s69
    v_mov_b32 v60, s69
    v_and_b32 v79, 12, v75
    v_cmp_eq_u32 vcc, 0, v79
    s_nop 1
    v_cndmask_b32 v79, 0, 1, vcc
    s_cmp_lg_u32 s37, 0
    s_cbranch_scc1 cf_f1_xt
cf_f1_xtx:
    s_nop 2
    v_mov_b32 v79, v79
    s_waitcnt vmcnt(0)
    buffer_load_dwordx4 v[8:11], v65, s[4:7], s18 offen nt
    buffer_load_dwordx4 v[12:15], v65, s[4:7], s19 offen nt
    buffer_load_dwordx4 v[16:19], v65, s[4:7], s20 offen nt
    buffer_load_dwordx4 v[20:23], v65, s[4:7], s21 offen nt
    s_nop 2
    v_mov_b32 v79, v79
    s_nop 2
    v_mov_b32 v79, v79
    s_nop 2
    v_mov_b32 v79, v79
    s_nop 2
    v_mov_b32 v79, v79
    s_nop 2
    v_mov_b32 v79, v79
    s_nop 2
    v_mov_b32 v79, v79
    s_nop 2
    v_mov_b32 v79, v79
    s_nop 2
    v_mov_b32 v79, v79
    s_nop 2
    v_mov_b32 v79, v79
    s_nop 2
    v_mov_b32 v79, v79
    buffer_load_dwordx4 v[40:43], v65, s[4:7], s14 offen offset:0 nt
    buffer_load_dwordx4 v[60:63], v66, s[4:7], s14 offen offset:0 nt
    s_waitcnt lgkmcnt(0)
    s_waitcnt vmcnt(5)
    v_bitop3_b32 v77, v8, v10, s69 bitop3:0x7e
    v_mfma_f32_16x16x32_bf16 v[0:3], v[4:7], v[8:11], 0
    v_mov_b64 v[8:9], 0
    v_mov_b64 v[10:11], 0
    s_waitcnt vmcnt(4)
    v_bitop3_b32 v78, v12, v14, s69 bitop3:0x7e
    v_mfma_f32_16x16x32_bf16 v[0:3], v[4:7], v[12:15], v[0:3]
    v_or_b32 v77, v77, v78
    v_mov_b64 v[12:13], 0
    v_mov_b64 v[14:15], 0
    s_waitcnt vmcnt(3)
    v_bitop3_b32 v78, v16, v18, s69 bitop3:0x7e
    v_mfma_f32_16x16x32_bf16 v[0:3], v[4:7], v[16:19], v[0:3]
    v_or_b32 v77, v77, v78
    v_mov_b64 v[16:17], 0
    v_mov_b64 v[18:19], 0
    s_waitcnt vmcnt(2)
    v_bitop3_b32 v78, v20, v22, s69 bitop3:0x7e
    v_mfma_f32_16x16x32_bf16 v[0:3], v[4:7], v[20:23], v[0:3]
    v_bitop3_b32 v77, v77, v78, 1 bitop3:0xa8
    v_cmp_ne_u32 vcc, 0, v77
    v_mov_b64 v[20:21], 0
    v_mov_b64 v[22:23], 0
    buffer_load_dwordx4 v[40:43], v65, s[4:7], s14 offen offset:0 nt
    buffer_load_dwordx4 v[60:63], v66, s[4:7], s14 offen offset:0 nt
    s_cmp_eq_u64 vcc, 0
    s_cselect_b64 s[42:43], -1, 0
    v_add_f32_dpp v0, v0, v0 row_ror:8 row_mask:0xf bank_mask:0xf
    v_add_f32_dpp v1, v1, v1 row_ror:8 row_mask:0xf bank_mask:0xf
    s_mov_b64 exec, s[42:43]
    v_cvt_pk_bf16_f32 v72, v0, v1
    v_bfi_b32 v72, v79, s70, v72
    buffer_store_dword v72, v75, s[4:7], s17 offen offset:0
    s_mov_b64 exec, -1
    s_cbranch_scc0 cf_f1_retry
cf_f1_go:
    v_mov_b64 v[0:1], 0
    v_mov_b64 v[2:3], 0
    v_mov_b64 v[4:5], 0
    v_mov_b64 v[6:7], 0
    s_branch cf_loop
cf_f3:
    v_and_b32 v77, 255, v69
    ds_read_b128 v[4:7], v77 offset:15872
    ds_read_b128 v[44:47], v70 offset:0
    ds_read_b128 v[48:51], v70 offset:1024
    ds_read_b128 v[52:55], v70 offset:2048
    ds_read_b128 v[56:59], v70 offset:3072
    ds_read_b128 v[24:27], v70 offset:4096
    ds_read_b128 v[28:31], v70 offset:5120
    ds_read_b128 v[32:35], v70 offset:6144
    ds_read_b128 v[36:39], v70 offset:7168
    s_mov_b32 s31, 65536
    s_add_u32 s24, s24, 524288
    s_add_u32 s26, s26, 524288
    s_add_u32 s55, s55, s57
    s_mov_b32 s14, 67108864
    s_mov_b32 s15, 67112960
    s_mov_b32 s16, 67117056
    s_mov_b32 s36, 1
    v_mov_b32 v40, s69
    v_mov_b32 v60, s69
    v_and_b32 v79, 12, v75
    v_cmp_eq_u32 vcc, 0, v79
    s_nop 1
    v_cndmask_b32 v79, 0, 1, vcc
    s_add_u32 s40, s30, s95
    v_mov_b32 v72, s40
    s_waitcnt lgkmcnt(0)
    v_mov_b64 v[0:1], 0
    v_mov_b64 v[2:3], 0
    v_mov_b64 v[4:5], 0
    v_mov_b64 v[6:7], 0
    v_mov_b64 v[8:9], 0
    v_mov_b64 v[10:11], 0
    v_mov_b64 v[12:13], 0
    v_mov_b64 v[14:15], 0
    v_mov_b64 v[16:17], 0
    v_mov_b64 v[18:19], 0
    v_mov_b64 v[20:21], 0
    v_mov_b64 v[22:23], 0
    s_nop 2
    v_mov_b32 v79, v79
    s_nop 2
    v_mov_b32 v79, v79
    s_nop 2
    v_mov_b32 v79, v79
    s_nop 2
    v_mov_b32 v79, v79
    s_nop 2
    v_mov_b32 v79, v79
    s_nop 2
    v_mov_b32 v79, v79
    s_nop 2
    v_mov_b32 v79, v79
    s_nop 2
    v_mov_b32 v79, v79
    s_nop 2
    v_mov_b32 v79, v79
    s_waitcnt vmcnt(0)
    s_mov_b32 s40, s67
    s_add_u32 s67, s30, 5
    s_min_u32 s67, s67, s93
    s_cmp_lt_u32 s97, s40
    s_cbranch_scc1 cf_kvwait
    s_nop 2
    v_mov_b32 v79, v79
    s_nop 2
    v_mov_b32 v79, v79
    s_nop 2
    v_mov_b32 v79, v79
    s_nop 2
    v_mov_b32 v79, v79
    s_nop 2
    v_mov_b32 v79, v79
    s_nop 2
    v_mov_b32 v79, v79
    s_nop 2
    v_mov_b32 v79, v79
    s_nop 2
    v_mov_b32 v79, v79
cf_kvok:
    s_branch cf_loop
cf_f0_xt:
    s_sub_u32 s37, s37, 1
    s_nop 2
    v_mov_b32 v79, v79
    s_nop 2
    v_mov_b32 v79, v79
    s_nop 2
    v_mov_b32 v79, v79
    s_nop 2
    v_mov_b32 v79, v79
    s_nop 2
    v_mov_b32 v79, v79
    s_nop 2
    v_mov_b32 v79, v79
    s_branch cf_f0_xtx
cf_f0_retry:
    s_sub_u32 s41, s30, s98
    s_mov_b32 s98, s30
    s_cmp_le_u32 s41, 3
    s_cselect_b32 s37, 1, 1
cf_f0_spin:
    buffer_load_dwordx4 v[8:11], v65, s[4:7], s18 offen nt
    buffer_load_dwordx4 v[12:15], v65, s[4:7], s19 offen nt
    buffer_load_dwordx4 v[16:19], v65, s[4:7], s20 offen nt
    buffer_load_dwordx4 v[20:23], v65, s[4:7], s21 offen nt
    s_nop 2
    v_mov_b32 v79, v79
    s_nop 2
    v_mov_b32 v79, v79
    s_nop 2
    v_mov_b32 v79, v79
    buffer_load_dwordx4 v[40:43], v65, s[4:7], s14 offen offset:0 nt
    buffer_load_dwordx4 v[60:63], v66, s[4:7], s14 offen offset:0 nt
    s_waitcnt vmcnt(5)
    v_bitop3_b32 v77, v8, v10, s69 bitop3:0x7e
    v_mfma_f32_16x16x32_bf16 v[0:3], v[4:7], v[8:11], 0
    v_mov_b64 v[8:9], 0
    v_mov_b64 v[10:11], 0
    s_waitcnt vmcnt(4)
    v_bitop3_b32 v78, v12, v14, s69 bitop3:0x7e
    v_mfma_f32_16x16x32_bf16 v[0:3], v[4:7], v[12:15], v[0:3]
    v_or_b32 v77, v77, v78
    v_mov_b64 v[12:13], 0
    v_mov_b64 v[14:15], 0
    s_waitcnt vmcnt(3)
    v_bitop3_b32 v78, v16, v18, s69 bitop3:0x7e
    v_mfma_f32_16x16x32_bf16 v[0:3], v[4:7], v[16:19], v[0:3]
    v_or_b32 v77, v77, v78
    v_mov_b64 v[16:17], 0
    v_mov_b64 v[18:19], 0
    s_waitcnt vmcnt(2)
    v_bitop3_b32 v78, v20, v22, s69 bitop3:0x7e
    v_mfma_f32_16x16x32_bf16 v[0:3], v[4:7], v[20:23], v[0:3]
    v_bitop3_b32 v77, v77, v78, 1 bitop3:0xa8
    v_cmp_ne_u32 vcc, 0, v77
    v_mov_b64 v[20:21], 0
    v_mov_b64 v[22:23], 0
    buffer_load_dwordx4 v[40:43], v65, s[4:7], s14 offen offset:0 nt
    buffer_load_dwordx4 v[60:63], v66, s[4:7], s14 offen offset:0 nt
    s_cmp_eq_u64 vcc, 0
    s_cselect_b64 s[42:43], -1, 0
    v_add_f32_dpp v0, v0, v0 row_ror:8 row_mask:0xf bank_mask:0xf
    v_add_f32_dpp v1, v1, v1 row_ror:8 row_mask:0xf bank_mask:0xf
    s_mov_b64 exec, s[42:43]
    v_cvt_pk_bf16_f32 v72, v0, v1
    v_bfi_b32 v72, v79, s70, v72
    buffer_store_dword v72, v75, s[4:7], s17 offen offset:0
    s_mov_b64 exec, -1
    s_cbranch_scc1 cf_f0_rx
    s_sub_u32 s31, s31, 1
    s_cbranch_scc0 cf_f0_spin
cf_f0_rx:
    v_mov_b64 v[0:1], 0
    v_mov_b64 v[2:3], 0
    v_mov_b64 v[4:5], 0
    v_mov_b64 v[6:7], 0
    s_branch cf_loop
cf_f1_xt:
    s_sub_u32 s37, s37, 1
    s_nop 2
    v_mov_b32 v79, v79
    s_nop 2
    v_mov_b32 v79, v79
    s_nop 2
    v_mov_b32 v79, v79
    s_nop 2
    v_mov_b32 v79, v79
    s_nop 2
    v_mov_b32 v79, v79
    s_nop 2
    v_mov_b32 v79, v79
    s_branch cf_f1_xtx
cf_f1_retry:
    s_sub_u32 s41, s30, s98
    s_mov_b32 s98, s30
    s_cmp_le_u32 s41, 3
    s_cselect_b32 s37, 1, 1
cf_f1_spin:
    buffer_load_dwordx4 v[8:11], v65, s[4:7], s18 offen nt
    buffer_load_dwordx4 v[12:15], v65, s[4:7], s19 offen nt
    buffer_load_dwordx4 v[16:19], v65, s[4:7], s20 offen nt
    buffer_load_dwordx4 v[20:23], v65, s[4:7], s21 offen nt
    s_nop 2
    v_mov_b32 v79, v79
    s_nop 2
    v_mov_b32 v79, v79
    s_nop 2
    v_mov_b32 v79, v79
    buffer_load_dwordx4 v[40:43], v65, s[4:7], s14 offen offset:0 nt
    buffer_load_dwordx4 v[60:63], v66, s[4:7], s14 offen offset:0 nt
    s_waitcnt vmcnt(5)
    v_bitop3_b32 v77, v8, v10, s69 bitop3:0x7e
    v_mfma_f32_16x16x32_bf16 v[0:3], v[4:7], v[8:11], 0
    v_mov_b64 v[8:9], 0
    v_mov_b64 v[10:11], 0
    s_waitcnt vmcnt(4)
    v_bitop3_b32 v78, v12, v14, s69 bitop3:0x7e
    v_mfma_f32_16x16x32_bf16 v[0:3], v[4:7], v[12:15], v[0:3]
    v_or_b32 v77, v77, v78
    v_mov_b64 v[12:13], 0
    v_mov_b64 v[14:15], 0
    s_waitcnt vmcnt(3)
    v_bitop3_b32 v78, v16, v18, s69 bitop3:0x7e
    v_mfma_f32_16x16x32_bf16 v[0:3], v[4:7], v[16:19], v[0:3]
    v_or_b32 v77, v77, v78
    v_mov_b64 v[16:17], 0
    v_mov_b64 v[18:19], 0
    s_waitcnt vmcnt(2)
    v_bitop3_b32 v78, v20, v22, s69 bitop3:0x7e
    v_mfma_f32_16x16x32_bf16 v[0:3], v[4:7], v[20:23], v[0:3]
    v_bitop3_b32 v77, v77, v78, 1 bitop3:0xa8
    v_cmp_ne_u32 vcc, 0, v77
    v_mov_b64 v[20:21], 0
    v_mov_b64 v[22:23], 0
    buffer_load_dwordx4 v[40:43], v65, s[4:7], s14 offen offset:0 nt
    buffer_load_dwordx4 v[60:63], v66, s[4:7], s14 offen offset:0 nt
    s_cmp_eq_u64 vcc, 0
    s_cselect_b64 s[42:43], -1, 0
    v_add_f32_dpp v0, v0, v0 row_ror:8 row_mask:0xf bank_mask:0xf
    v_add_f32_dpp v1, v1, v1 row_ror:8 row_mask:0xf bank_mask:0xf
    s_mov_b64 exec, s[42:43]
    v_cvt_pk_bf16_f32 v72, v0, v1
    v_bfi_b32 v72, v79, s70, v72
    buffer_store_dword v72, v75, s[4:7], s17 offen offset:0
    s_mov_b64 exec, -1
    s_cbranch_scc1 cf_f1_rx
    s_sub_u32 s31, s31, 1
    s_cbranch_scc0 cf_f1_spin
cf_f1_rx:
    v_mov_b64 v[0:1], 0
    v_mov_b64 v[2:3], 0
    v_mov_b64 v[4:5], 0
    v_mov_b64 v[6:7], 0
    s_branch cf_loop
cf_f2_xt:
    s_sub_u32 s37, s37, 1
    s_nop 2
    v_mov_b32 v79, v79
    s_nop 2
    v_mov_b32 v79, v79
    s_nop 2
    v_mov_b32 v79, v79
    s_nop 2
    v_mov_b32 v79, v79
    s_nop 2
    v_mov_b32 v79, v79
    s_nop 2
    v_mov_b32 v79, v79
    s_branch cf_f2_xtx
cf_f2_retry:
    s_sub_u32 s41, s30, s98
    s_mov_b32 s98, s30
    s_cmp_le_u32 s41, 3
    s_cselect_b32 s37, 1, 1
cf_f2_spin:
    buffer_load_dwordx4 v[8:11], v65, s[4:7], s18 offen nt
    buffer_load_dwordx4 v[12:15], v65, s[4:7], s19 offen nt
    buffer_load_dwordx4 v[16:19], v65, s[4:7], s20 offen nt
    buffer_load_dwordx4 v[20:23], v65, s[4:7], s21 offen nt
    s_nop 2
    v_mov_b32 v79, v79
    s_nop 2
    v_mov_b32 v79, v79
    s_nop 2
    v_mov_b32 v79, v79
    buffer_load_dwordx4 v[40:43], v65, s[4:7], s14 offen offset:0 nt
    buffer_load_dwordx4 v[60:63], v66, s[4:7], s14 offen offset:0 nt
    s_waitcnt vmcnt(5)
    v_bitop3_b32 v77, v8, v10, s69 bitop3:0x7e
    v_mfma_f32_16x16x32_bf16 v[0:3], v[4:7], v[8:11], 0
    v_mov_b64 v[8:9], 0
    v_mov_b64 v[10:11], 0
    s_waitcnt vmcnt(4)
    v_bitop3_b32 v78, v12, v14, s69 bitop3:0x7e
    v_mfma_f32_16x16x32_bf16 v[0:3], v[4:7], v[12:15], v[0:3]
    v_or_b32 v77, v77, v78
    v_mov_b64 v[12:13], 0
    v_mov_b64 v[14:15], 0
    s_waitcnt vmcnt(3)
    v_bitop3_b32 v78, v16, v18, s69 bitop3:0x7e
    v_mfma_f32_16x16x32_bf16 v[0:3], v[4:7], v[16:19], v[0:3]
    v_or_b32 v77, v77, v78
    v_mov_b64 v[16:17], 0
    v_mov_b64 v[18:19], 0
    s_waitcnt vmcnt(2)
    v_bitop3_b32 v78, v20, v22, s69 bitop3:0x7e
    v_mfma_f32_16x16x32_bf16 v[0:3], v[4:7], v[20:23], v[0:3]
    v_bitop3_b32 v77, v77, v78, 1 bitop3:0xa8
    v_cmp_ne_u32 vcc, 0, v77
    v_mov_b64 v[20:21], 0
    v_mov_b64 v[22:23], 0
    buffer_load_dwordx4 v[40:43], v65, s[4:7], s14 offen offset:0 nt
    buffer_load_dwordx4 v[60:63], v66, s[4:7], s14 offen offset:0 nt
    s_cmp_eq_u64 vcc, 0
    s_cselect_b64 s[42:43], -1, 0
    v_add_f32_dpp v0, v0, v0 row_ror:4 row_mask:0xf bank_mask:0xf
    v_add_f32_dpp v1, v1, v1 row_ror:4 row_mask:0xf bank_mask:0xf
    s_nop 0
    v_add_f32_dpp v0, v0, v0 row_ror:8 row_mask:0xf bank_mask:0xf
    v_add_f32_dpp v1, v1, v1 row_ror:8 row_mask:0xf bank_mask:0xf
    s_mov_b64 exec, s[42:43]
    v_cvt_pk_bf16_f32 v72, v0, v1
    v_bfi_b32 v72, v79, s70, v72
    buffer_store_dword v72, v75, s[4:7], s17 offen offset:0
    buffer_store_dword v72, v75, s[4:7], s17 offen offset:1024
    buffer_store_dword v72, v75, s[4:7], s17 offen offset:2048
    buffer_store_dword v72, v75, s[4:7], s17 offen offset:3072
    s_mov_b64 exec, -1
    s_cbranch_scc1 cf_f2_rx
    s_sub_u32 s31, s31, 1
    s_cbranch_scc0 cf_f2_spin
cf_f2_rx:
    v_mov_b64 v[0:1], 0
    v_mov_b64 v[2:3], 0
    v_mov_b64 v[4:5], 0
    v_mov_b64 v[6:7], 0
    s_branch cf_loop
cf_spinB:
    s_waitcnt vmcnt(3)
cf_spinB_l:
    v_and_b32 v77, s36, v44
    v_cmp_ne_u32 vcc, s70, v77
    s_cbranch_vccz cf_spinB_x
    buffer_load_dwordx4 v[44:47], v65, s[4:7], s15 offen nt
    s_sub_u32 s31, s31, 16
    s_waitcnt vmcnt(0)
    s_cbranch_scc0 cf_spinB_l
cf_spinB_x:
    ds_write_b128 v65, v[44:47] offset:4096
    s_waitcnt lgkmcnt(0)
    s_branch cf_backB
cf_spin8:
    buffer_load_dwordx4 v[40:43], v65, s[4:7], s16 offen nt
cf_spin8_l:
    v_and_b32 v77, s36, v40
    v_cmp_ne_u32 vcc, s70, v77
    s_cbranch_vccz cf_spin8_x
    s_nop 1
    v_and_b32 v77, s36, v40
    v_cmp_ne_u32 vcc, s70, v77
    s_cbranch_vccz cf_spin8_x
    s_nop 1
    v_and_b32 v77, s36, v40
    v_cmp_ne_u32 vcc, s70, v77
    s_cbranch_vccz cf_spin8_x
    s_nop 1
    buffer_load_dwordx4 v[40:43], v65, s[4:7], s16 offen nt
    s_sub_u32 s31, s31, 16
    s_cbranch_scc0 cf_spin8_l
cf_spin8_x:
    s_branch cf_back8
cf_rare:
    s_mov_b64 exec, s[34:35]
    buffer_store_dwordx4 v[0:3], v65, s[4:7], s28 offen sc1
    s_mov_b64 exec, -1
    s_nop 3
    v_cvt_pk_bf16_f32 v52, v16, v17
    v_cvt_pk_bf16_f32 v53, v18, v19
    v_cvt_pk_bf16_f32 v54, v20, v21
    v_cvt_pk_bf16_f32 v55, v22, v23
    buffer_store_dwordx4 v[52:55], v65, s[4:7], s27 offen sc1
    s_add_u32 s28, s28, 131072
    s_add_u32 s27, s27, 131072
    s_cmp_eq_u32 s30, 63
    s_cbranch_scc1 cf_last
    s_branch cf_rare_x
cf_kvwait:
    s_mov_b32 s41, s97
    v_bfe_u32 v78, v65, 4, 3
    v_lshlrev_b32 v78, 7, v78
    v_mov_b32 v77, v76
    s_nop 1
    v_permlane32_swap_b32 v76, v77
    v_subrev_u32 v77, s95, v77
    v_cmp_lt_u32 vcc, 16, v77
    s_nop 1
    v_cndmask_b32 v77, v77, 0, vcc
    v_bfe_u32 v79, v78, 7, 2
    v_lshl_add_u32 v77, v77, 2, v79
    s_nop 1
    v_min_u32_dpp v77, v77, v77 row_ror:1 row_mask:0xf bank_mask:0xf
    s_nop 1
    v_min_u32_dpp v77, v77, v77 row_ror:2 row_mask:0xf bank_mask:0xf
    s_nop 1
    v_min_u32_dpp v77, v77, v77 row_ror:4 row_mask:0xf bank_mask:0xf
    s_nop 0
    v_readfirstlane_b32 s97, v77
    s_nop 0
    s_max_u32 s97, s97, s41
    s_add_u32 s40, s30, 3
    s_min_u32 s40, s40, 64
    s_cmp_le_u32 s40, s97
    s_cbranch_scc1 cf_kvw_x
    v_bfe_u32 v78, v65, 4, 3
    v_lshlrev_b32 v78, 7, v78
    s_mov_b32 s31, 4194304
cf_kvw:
    buffer_load_dword v77, v78, s[4:7], s96 offen sc1
    s_waitcnt vmcnt(0)
    v_subrev_u32 v77, s95, v77
    v_cmp_lt_u32 vcc, 16, v77
    s_nop 1
    v_cndmask_b32 v77, v77, 0, vcc
    v_bfe_u32 v79, v78, 7, 2
    v_lshl_add_u32 v77, v77, 2, v79
    s_nop 1
    v_min_u32_dpp v77, v77, v77 row_ror:1 row_mask:0xf bank_mask:0xf
    s_nop 1
    v_min_u32_dpp v77, v77, v77 row_ror:2 row_mask:0xf bank_mask:0xf
    s_nop 1
    v_min_u32_dpp v77, v77, v77 row_ror:4 row_mask:0xf bank_mask:0xf
    s_nop 0
    v_readfirstlane_b32 s97, v77
    s_sub_u32 s31, s31, 1
    s_cbranch_scc1 cf_kvw_x
    s_cmp_le_u32 s40, s97
    s_cbranch_scc1 cf_kvw_x
    s_sleep 2
    s_branch cf_kvw
cf_kvw_x:
    s_branch cf_kvok
cf_last:
    s_add_u32 s40, s95, 64
    v_mov_b32 v78, s40
    s_waitcnt vmcnt(0)
    s_barrier
    s_mov_b64 exec, s[100:101]
    buffer_store_dword v78, off, s[4:7], s29 sc1
    s_mov_b64 exec, -1
cf_end:
    s_endpgm
L_chain_safe:
    s_mov_b64 s[48:49], s[50:51]
    s_mov_b64 s[50:51], s[52:53]
    s_mov_b64 s[52:53], s[54:55]
    s_mov_b64 s[54:55], s[56:57]
    s_mov_b64 s[56:57], s[58:59]
    v_lshrrev_b32 v77, 6, v0
    s_nop 0
    v_readfirstlane_b32 s13, v77
    v_lshlrev_b32 v65, 4, v0
    v_and_b32 v48, 63, v0
    s_mov_b32 s10, 4718592
    s_mov_b32 s11, 0x20000
    v_lshrrev_b32 v49, 3, v48
    v_mul_u32_u24 v18, 1152, v49
    v_and_b32 v49, 7, v48
    v_lshl_add_u32 v18, v49, 4, v18
    s_mul_i32 s40, s12, 147456
    s_lshl_b32 s41, s13, 8
    s_add_u32 s40, s40, s41
    s_mov_b32 s42, s40
    s_xor_b32 s41, s13, 0
    s_mul_i32 s41, s41, 36864
    s_add_u32 s60, s41, s40
    s_xor_b32 s41, s13, 1
    s_mul_i32 s41, s41, 36864
    s_add_u32 s61, s41, s40
    s_xor_b32 s41, s13, 2
    s_mul_i32 s41, s41, 36864
    s_add_u32 s62, s41, s40
    s_xor_b32 s41, s13, 3
    s_mul_i32 s41, s41, 36864
    s_add_u32 s63, s41, s40
    s_lshl_b32 s43, s13, 12
    s_mov_b64 s[8:9], s[56:57]
    s_add_u32 m0, s43, 147456
    s_add_u32 s41, s60, 0
    buffer_load_dwordx4 v18, s[8:11], s41 offen offset:0 nt lds
    s_add_u32 s41, s60, 8192
    buffer_load_dwordx4 v18, s[8:11], s41 offen offset:1024 nt lds
    s_add_u32 s41, s60, 16384
    buffer_load_dwordx4 v18, s[8:11], s41 offen offset:2048 nt lds
    s_add_u32 s41, s60, 24576
    buffer_load_dwordx4 v18, s[8:11], s41 offen offset:3072 nt lds
    s_add_u32 m0, s43, 0
    s_add_u32 s41, s61, 0
    buffer_load_dwordx4 v18, s[8:11], s41 offen offset:0 nt lds
    s_add_u32 s41, s61, 8192
    buffer_load_dwordx4 v18, s[8:11], s41 offen offset:1024 nt lds
    s_add_u32 s41, s61, 16384
    buffer_load_dwordx4 v18, s[8:11], s41 offen offset:2048 nt lds
    s_add_u32 s41, s61, 24576
    buffer_load_dwordx4 v18, s[8:11], s41 offen offset:3072 nt lds
    s_add_u32 m0, s43, 36864
    s_add_u32 s41, s62, 0
    buffer_load_dwordx4 v18, s[8:11], s41 offen offset:0 nt lds
    s_add_u32 s41, s62, 8192
    buffer_load_dwordx4 v18, s[8:11], s41 offen offset:1024 nt lds
    s_add_u32 s41, s62, 16384
    buffer_load_dwordx4 v18, s[8:11], s41 offen offset:2048 nt lds
    s_add_u32 s41, s62, 24576
    buffer_load_dwordx4 v18, s[8:11], s41 offen offset:3072 nt lds
    s_add_u32 m0, s43, 73728
    s_add_u32 s41, s63, 0
    buffer_load_dwordx4 v18, s[8:11], s41 offen offset:0 nt lds
    s_add_u32 s41, s63, 8192
    buffer_load_dwordx4 v18, s[8:11], s41 offen offset:1024 nt lds
    s_add_u32 s41, s63, 16384
    buffer_load_dwordx4 v18, s[8:11], s41 offen offset:2048 nt lds
    s_add_u32 s41, s63, 24576
    buffer_load_dwordx4 v18, s[8:11], s41 offen offset:3072 nt lds
    v_lshrrev_b32 v49, 1, v48
    v_mul_u32_u24 v19, 1152, v49
    v_and_b32 v49, 1, v48
    v_lshl_add_u32 v19, v49, 4, v19
    s_mul_i32 s41, s13, 224
    s_sub_u32 s41, 1024, s41
    v_add_u32 v19, s41, v19
    v_lshrrev_b32 v49, 4, v48
    v_lshlrev_b32 v50, 2, v49
    v_and_b32 v51, 15, v48
    v_xor_b32 v51, v51, v50
    v_lshlrev_b32 v51, 4, v51
    v_lshl_add_u32 v16, v49, 15, v51
    v_lshrrev_b32 v50, 1, v49
    v_lshl_add_u32 v17, v50, 16, v51
    v_and_b32 v50, 1, v49
    v_lshl_add_u32 v17, v50, 13, v17
    s_lshl_b32 s40, s12, 8
    s_mul_i32 s58, s13, 1048576
    s_add_u32 s58, s58, s40
    s_lshr_b32 s41, s13, 1
    s_mul_i32 s59, s41, 262144
    s_and_b32 s41, s13, 1
    s_lshl_b32 s41, s41, 14
    s_add_u32 s59, s59, s41
    s_add_u32 s59, s59, s40
    s_add_u32 s59, s59, 4194304
    s_lshr_b32 s71, s52, 8
    s_add_u32 s71, s71, s12
    s_and_b32 s71, s71, 3
    v_bfe_u32 v50, v48, 2, 2
    v_xor_b32 v51, s13, v50
    v_lshlrev_b32 v20, 6, v51
    v_and_b32 v51, 3, v48
    v_lshl_add_u32 v20, v51, 4, v20
    v_lshrrev_b32 v23, 2, v48
    v_lshl_add_u32 v20, v23, 8, v20
    s_xor_b32 s41, s43, 0
    v_add_u32 v24, s41, v20
    s_xor_b32 s41, s43, 4096
    v_add_u32 v25, s41, v20
    s_xor_b32 s41, s43, 8192
    v_add_u32 v26, s41, v20
    s_xor_b32 s41, s43, 12288
    v_add_u32 v27, s41, v20
    v_and_b32 v23, 1, v50
    v_lshl_add_u32 v23, v49, 2, v23
    v_lshrrev_b32 v50, 1, v50
    v_lshlrev_b32 v21, 7, v23
    v_lshl_add_u32 v21, v50, 6, v21
    v_lshrrev_b32 v16, 1, v51
    v_lshl_add_u32 v21, v16, 5, v21
    v_and_b32 v16, 1, v51
    v_lshl_add_u32 v21, v16, 3, v21
    v_add_u32 v21, s43, v21
    v_lshlrev_b32 v22, 9, v50
    v_xor_b32 v22, v22, v21
    v_lshlrev_b32 v23, 5, v23
    v_lshl_add_u32 v23, v50, 10, v23
    v_lshl_add_u32 v23, v51, 3, v23
    v_add_u32 v23, s43, v23
    v_bfe_u32 v60, v65, 4, 6
    v_and_b32 v61, 15, v60
    v_lshrrev_b32 v62, 4, v60
    v_mov_b32 v64, 0x4444
    v_mov_b32 v77, 0xeeee
    v_cmp_lt_u32 vcc, 7, v61
    s_nop 1
    v_cndmask_b32 v64, v64, v77, vcc
    v_xor_b32 v66, 1024, v65
    v_xor_b32 v67, 2048, v65
    v_xor_b32 v68, 3072, v65
    v_and_b32 v69, 511, v65
    s_mul_i32 s96, s13, 36864
    s_add_u32 s96, s96, 16384
    v_lshlrev_b32 v70, 4, v60
    v_add_u32 v70, s96, v70
    v_lshrrev_b32 v79, 1, v69
    s_lshl_b32 s96, s13, 8
    s_add_u32 s96, s96, 14336
    s_lshl_b32 s33, s13, 10
    s_add_u32 s97, s33, 8192
    v_mov_b32 v77, s97
    v_mov_b32 v78, s96
    v_cmp_lt_u32 vcc, 31, v60
    s_nop 1
    v_cndmask_b32 v71, v77, v78, vcc
    v_add_u32 v71, v71, v79
    v_and_b32 v77, 7, v61
    v_lshrrev_b32 v78, 3, v61
    v_lshlrev_b32 v74, 4, v77
    v_lshl_add_u32 v73, v62, 7, v74
    v_lshl_add_u32 v73, v78, 3, v73
    s_lshl_b32 s96, s13, 9
    v_add_u32 v73, s96, v73
    v_lshrrev_b32 v74, 1, v74
    v_lshl_add_u32 v74, v78, 14, v74
    v_lshl_add_u32 v74, v62, 15, v74
    s_lshl_b32 s96, s13, 17
    v_add_u32 v74, s96, v74
    v_bfe_u32 v77, v61, 2, 1
    v_and_b32 v78, 3, v61
    s_cmp_lt_u32 s13, 2
    s_cselect_b64 vcc, -1, 0
    v_cndmask_b32 v77, 0, v77, vcc
    v_lshlrev_b32 v75, 7, v77
    v_lshl_add_u32 v75, v62, 4, v75
    v_lshl_add_u32 v75, v78, 2, v75
    v_lshlrev_b32 v58, 3, v77
    v_lshl_add_u32 v58, v78, 1, v58
    s_bfe_u32 s97, s12, 0x10001
    s_lshl_b32 s68, s97, 6
    s_lshl_b32 s97, s97, 2
    v_add_u32 v59, s97, v62
    s_bfe_u32 s96, s12, 0x10002
    s_and_b32 s40, s12, 1
    s_lshl_b32 s96, s96, 1
    s_add_u32 s96, s96, s40
    s_lshr_b32 s97, s12, 3
    s_lshl_b32 s98, s13, 2
    s_add_u32 s98, s98, s97
    s_lshl_b32 s98, s98, 2
    s_add_u32 s98, s98, s96
    s_lshl_b32 s98, s98, 8
    s_lshl_b32 s99, s13, 2
    s_add_u32 s99, s99, s96
    s_lshl_b32 s99, s99, 4
    s_lshl_b32 s41, s97, 1
    s_add_u32 s41, s41, s40
    s_lshl_b32 s41, s41, 7
    s_add_u32 s41, s41, 8192
    s_lshl_b32 s40, s40, 3
    s_add_u32 s40, s40, 512
    s_cmp_lt_u32 s13, 2
    s_cselect_b32 s96, 7, 4
    s_cselect_b32 s98, s98, s41
    s_cselect_b32 s99, s99, s40
    s_cselect_b32 s32, 1, 0
    s_add_u32 s68, s68, s98
    s_lshl_b32 s97, s97, s96
    s_add_u32 s99, s99, s97
    v_add_u32 v58, s99, v58
    s_and_b32 s97, s12, 4
    s_or_b32 s97, s97, s13
    s_cmp_eq_u32 s97, 2
    s_cselect_b32 s32, 2, s32
    s_mov_b32 s8, s48
    s_mov_b32 s9, s49
    s_mov_b32 s10, 9216
    v_mul_u32_u24 v77, 1152, v59
    v_lshl_add_u32 v77, v58, 1, v77
    buffer_load_dword v72, v77, s[8:11], 0 offen
    s_mov_b32 s10, 4718592
    s_waitcnt vmcnt(12) lgkmcnt(0)
    s_barrier
    s_cmp_eq_u32 s71, 1
    s_cbranch_scc1 cs_th0
    s_waitcnt vmcnt(6)
cs_th0:
    s_mov_b64 s[8:9], s[56:57]
    s_add_u32 m0, s43, 110592
    s_add_u32 s41, s42, 0
    buffer_load_dwordx4 v19, s[8:11], s41 offen offset:0 nt lds
    s_add_u32 s41, s42, 35840
    buffer_load_dwordx4 v19, s[8:11], s41 offen offset:1024 nt lds
    s_add_u32 s41, s42, 71680
    buffer_load_dwordx4 v19, s[8:11], s41 offen offset:2048 nt lds
    s_add_u32 s41, s42, 107520
    buffer_load_dwordx4 v19, s[8:11], s41 offen offset:3072 nt lds
    v_add_u32 v77, 147456, v22
    ds_read_b64_tr_b16 v[80:81], v77 offset:0
    ds_read_b64_tr_b16 v[82:83], v77 offset:256
    ds_read_b64_tr_b16 v[84:85], v77 offset:2048
    ds_read_b64_tr_b16 v[86:87], v77 offset:2304
    ds_read_b64_tr_b16 v[112:113], v77 offset:16
    ds_read_b64_tr_b16 v[114:115], v77 offset:272
    ds_read_b64_tr_b16 v[116:117], v77 offset:2064
    ds_read_b64_tr_b16 v[118:119], v77 offset:2320
    s_waitcnt vmcnt(12) lgkmcnt(0)
    s_barrier
    s_cmp_eq_u32 s71, 1
    s_cbranch_scc1 cs_th1
    s_waitcnt vmcnt(6)
cs_th1:
    s_mov_b64 s[8:9], s[52:53]
    s_add_u32 m0, s43, 147456
    s_add_u32 s41, s58, 0
    buffer_load_dwordx4 v17, s[8:11], s41 offen offset:0 nt lds
    s_add_u32 s41, s58, 31744
    buffer_load_dwordx4 v17, s[8:11], s41 offen offset:1024 nt lds
    s_add_u32 s41, s58, 129024
    buffer_load_dwordx4 v17, s[8:11], s41 offen offset:2048 nt lds
    s_add_u32 s41, s58, 160768
    buffer_load_dwordx4 v17, s[8:11], s41 offen offset:3072 nt lds
    v_add_u32 v77, 0, v21
    ds_read_b64_tr_b16 v[88:89], v77 offset:0
    ds_read_b64_tr_b16 v[90:91], v77 offset:256
    ds_read_b64_tr_b16 v[92:93], v77 offset:2048
    ds_read_b64_tr_b16 v[94:95], v77 offset:2304
    ds_read_b64_tr_b16 v[120:121], v77 offset:16
    ds_read_b64_tr_b16 v[122:123], v77 offset:272
    ds_read_b64_tr_b16 v[124:125], v77 offset:2064
    ds_read_b64_tr_b16 v[126:127], v77 offset:2320
    s_waitcnt vmcnt(12) lgkmcnt(0)
    s_barrier
    s_cmp_eq_u32 s71, 1
    s_cbranch_scc1 cs_th2
    s_waitcnt vmcnt(6)
cs_th2:
    s_add_u32 m0, s43, 0
    s_add_u32 s41, s58, 16384
    buffer_load_dwordx4 v17, s[8:11], s41 offen offset:0 nt lds
    s_add_u32 s41, s58, 48128
    buffer_load_dwordx4 v17, s[8:11], s41 offen offset:1024 nt lds
    s_add_u32 s41, s58, 145408
    buffer_load_dwordx4 v17, s[8:11], s41 offen offset:2048 nt lds
    s_add_u32 s41, s58, 177152
    buffer_load_dwordx4 v17, s[8:11], s41 offen offset:3072 nt lds
    v_add_u32 v77, 36864, v21
    ds_read_b64_tr_b16 v[96:97], v77 offset:0
    ds_read_b64_tr_b16 v[98:99], v77 offset:256
    ds_read_b64_tr_b16 v[100:101], v77 offset:2048
    ds_read_b64_tr_b16 v[102:103], v77 offset:2304
    ds_read_b64_tr_b16 v[128:129], v77 offset:16
    ds_read_b64_tr_b16 v[130:131], v77 offset:272
    ds_read_b64_tr_b16 v[132:133], v77 offset:2064
    ds_read_b64_tr_b16 v[134:135], v77 offset:2320
    s_waitcnt vmcnt(12) lgkmcnt(0)
    s_barrier
    s_cmp_eq_u32 s71, 1
    s_cbranch_scc1 cs_th3
    s_waitcnt vmcnt(6)
cs_th3:
    s_mov_b64 s[8:9], s[54:55]
    s_add_u32 m0, s43, 36864
    s_add_u32 s41, s58, 0
    buffer_load_dwordx4 v17, s[8:11], s41 offen offset:0 nt lds
    s_add_u32 s41, s58, 31744
    buffer_load_dwordx4 v17, s[8:11], s41 offen offset:1024 nt lds
    s_add_u32 s41, s58, 129024
    buffer_load_dwordx4 v17, s[8:11], s41 offen offset:2048 nt lds
    s_add_u32 s41, s58, 160768
    buffer_load_dwordx4 v17, s[8:11], s41 offen offset:3072 nt lds
    v_add_u32 v77, 73728, v21
    ds_read_b64_tr_b16 v[104:105], v77 offset:0
    ds_read_b64_tr_b16 v[106:107], v77 offset:256
    ds_read_b64_tr_b16 v[108:109], v77 offset:2048
    ds_read_b64_tr_b16 v[110:111], v77 offset:2304
    ds_read_b64_tr_b16 v[136:137], v77 offset:16
    ds_read_b64_tr_b16 v[138:139], v77 offset:272
    ds_read_b64_tr_b16 v[140:141], v77 offset:2064
    ds_read_b64_tr_b16 v[142:143], v77 offset:2320
    s_waitcnt vmcnt(12) lgkmcnt(0)
    s_barrier
    s_cmp_eq_u32 s71, 1
    s_cbranch_scc1 cs_th4
    s_waitcnt vmcnt(6)
cs_th4:
    s_add_u32 m0, s43, 73728
    s_add_u32 s41, s58, 16384
    buffer_load_dwordx4 v17, s[8:11], s41 offen offset:0 nt lds
    s_add_u32 s41, s58, 48128
    buffer_load_dwordx4 v17, s[8:11], s41 offen offset:1024 nt lds
    s_add_u32 s41, s58, 145408
    buffer_load_dwordx4 v17, s[8:11], s41 offen offset:2048 nt lds
    s_add_u32 s41, s58, 177152
    buffer_load_dwordx4 v17, s[8:11], s41 offen offset:3072 nt lds
    v_add_u32 v77, 110592, v23
    ds_read_b64_tr_b16 v[0:1], v77 offset:0
    ds_read_b64_tr_b16 v[2:3], v77 offset:64
    ds_read_b64_tr_b16 v[4:5], v77 offset:512
    ds_read_b64_tr_b16 v[6:7], v77 offset:576
    ds_read_b64_tr_b16 v[8:9], v77 offset:2048
    ds_read_b64_tr_b16 v[10:11], v77 offset:2112
    ds_read_b64_tr_b16 v[12:13], v77 offset:2560
    ds_read_b64_tr_b16 v[14:15], v77 offset:2624
    s_waitcnt vmcnt(12) lgkmcnt(0)
    s_barrier
    s_cmp_eq_u32 s71, 1
    s_cbranch_scc1 cs_th5
    s_waitcnt vmcnt(6)
cs_th5:
    s_mov_b64 s[8:9], s[50:51]
    s_add_u32 m0, s43, 110592
    s_add_u32 s41, s58, 0
    buffer_load_dwordx4 v17, s[8:11], s41 offen offset:0 nt lds
    s_add_u32 s41, s58, 31744
    buffer_load_dwordx4 v17, s[8:11], s41 offen offset:1024 nt lds
    s_add_u32 s41, s58, 129024
    buffer_load_dwordx4 v17, s[8:11], s41 offen offset:2048 nt lds
    s_add_u32 s41, s58, 160768
    buffer_load_dwordx4 v17, s[8:11], s41 offen offset:3072 nt lds
    s_cmp_eq_u32 s32, 0
    s_cbranch_scc1 cs_init_done
    v_mov_b32 v52, 1
    v_mov_b32 v53, 1
    v_mov_b32 v54, 1
    v_mov_b32 v55, 1
    v_mov_b32 v56, 0
    s_lshl_b32 s96, s12, 14
    s_add_u32 s96, s96, 68681728
    s_add_u32 s97, s96, 0
    buffer_store_dwordx4 v[52:55], v65, s[4:7], s97 offen sc1
    s_add_u32 s97, s96, 4096
    buffer_store_dwordx4 v[52:55], v65, s[4:7], s97 offen sc1
    s_add_u32 s97, s96, 8192
    buffer_store_dwordx4 v[52:55], v65, s[4:7], s97 offen sc1
    s_add_u32 s97, s96, 12288
    buffer_store_dwordx4 v[52:55], v65, s[4:7], s97 offen sc1
    s_add_u32 s96, s68, 67633152
    s_add_u32 s97, s96, 16384
    buffer_store_dword v56, v75, s[4:7], s96 offen offset:0 sc1
    buffer_store_dword v72, v75, s[4:7], s97 offen offset:0 sc1
    s_cmp_lg_u32 s32, 2
    s_cbranch_scc1 cs_init_done
    buffer_store_dword v56, v75, s[4:7], s96 offen offset:1024 sc1
    buffer_store_dword v72, v75, s[4:7], s97 offen offset:1024 sc1
    buffer_store_dword v56, v75, s[4:7], s96 offen offset:2048 sc1
    buffer_store_dword v72, v75, s[4:7], s97 offen offset:2048 sc1
    buffer_store_dword v56, v75, s[4:7], s96 offen offset:3072 sc1
    buffer_store_dword v72, v75, s[4:7], s97 offen offset:3072 sc1
cs_init_done:
    ds_write_b64 v70, v[0:1] offset:16384
    ds_write_b64 v70, v[2:3] offset:16392
    ds_write_b64 v70, v[4:5] offset:17408
    ds_write_b64 v70, v[6:7] offset:17416
    ds_write_b64 v70, v[8:9] offset:18432
    ds_write_b64 v70, v[10:11] offset:18440
    ds_write_b64 v70, v[12:13] offset:19456
    ds_write_b64 v70, v[14:15] offset:19464
    v_add_u32 v28, 147456, v24
    v_add_u32 v29, 147456, v25
    v_add_u32 v30, 147456, v26
    v_add_u32 v31, 147456, v27
    ds_read_b64_tr_b16 a[96:97], v28 offset:0
    ds_read_b64_tr_b16 a[104:105], v28 offset:8
    ds_read_b64_tr_b16 a[112:113], v29 offset:0
    ds_read_b64_tr_b16 a[120:121], v29 offset:8
    ds_read_b64_tr_b16 a[128:129], v30 offset:0
    ds_read_b64_tr_b16 a[136:137], v30 offset:8
    ds_read_b64_tr_b16 a[144:145], v31 offset:0
    ds_read_b64_tr_b16 v[32:33], v31 offset:8
    s_waitcnt vmcnt(12) lgkmcnt(0)
    s_barrier
    s_cmp_eq_u32 s71, 1
    s_cbranch_scc1 cs_th6
    s_waitcnt vmcnt(6)
cs_th6:
    s_add_u32 m0, s43, 147456
    s_add_u32 s41, s58, 16384
    buffer_load_dwordx4 v17, s[8:11], s41 offen offset:0 nt lds
    s_add_u32 s41, s58, 48128
    buffer_load_dwordx4 v17, s[8:11], s41 offen offset:1024 nt lds
    s_add_u32 s41, s58, 145408
    buffer_load_dwordx4 v17, s[8:11], s41 offen offset:2048 nt lds
    s_add_u32 s41, s58, 177152
    buffer_load_dwordx4 v17, s[8:11], s41 offen offset:3072 nt lds
    ds_write_b64 v70, v[32:33] offset:12288
    v_add_u32 v28, 0, v24
    v_add_u32 v29, 0, v25
    v_add_u32 v30, 0, v26
    v_add_u32 v31, 0, v27
    ds_read_b64_tr_b16 a[98:99], v28 offset:0
    ds_read_b64_tr_b16 a[106:107], v28 offset:8
    ds_read_b64_tr_b16 a[114:115], v29 offset:0
    ds_read_b64_tr_b16 a[122:123], v29 offset:8
    ds_read_b64_tr_b16 a[130:131], v30 offset:0
    ds_read_b64_tr_b16 a[138:139], v30 offset:8
    ds_read_b64_tr_b16 a[146:147], v31 offset:0
    ds_read_b64_tr_b16 v[0:1], v31 offset:8
    s_waitcnt vmcnt(12) lgkmcnt(0)
    s_barrier
    s_cmp_eq_u32 s71, 1
    s_cbranch_scc1 cs_th7
    s_waitcnt vmcnt(6)
cs_th7:
    s_mov_b64 s[8:9], s[52:53]
    s_add_u32 m0, s43, 0
    s_add_u32 s41, s58, 262144
    buffer_load_dwordx4 v17, s[8:11], s41 offen offset:0 nt lds
    s_add_u32 s41, s58, 293888
    buffer_load_dwordx4 v17, s[8:11], s41 offen offset:1024 nt lds
    s_add_u32 s41, s58, 391168
    buffer_load_dwordx4 v17, s[8:11], s41 offen offset:2048 nt lds
    s_add_u32 s41, s58, 422912
    buffer_load_dwordx4 v17, s[8:11], s41 offen offset:3072 nt lds
    ds_write_b64 v70, v[0:1] offset:12296
    v_add_u32 v28, 36864, v24
    v_add_u32 v29, 36864, v25
    v_add_u32 v30, 36864, v26
    v_add_u32 v31, 36864, v27
    ds_read_b64_tr_b16 a[232:233], v28 offset:0
    ds_read_b64_tr_b16 v[32:33], v28 offset:8
    ds_read_b64_tr_b16 a[240:241], v29 offset:0
    ds_read_b64_tr_b16 a[248:249], v29 offset:8
    ds_read_b64_tr_b16 v[144:145], v30 offset:0
    ds_read_b64_tr_b16 v[152:153], v30 offset:8
    ds_read_b64_tr_b16 v[160:161], v31 offset:0
    ds_read_b64_tr_b16 v[168:169], v31 offset:8
    s_waitcnt vmcnt(12) lgkmcnt(0)
    s_barrier
    s_cmp_eq_u32 s71, 1
    s_cbranch_scc1 cs_th8
    s_waitcnt vmcnt(6)
cs_th8:
    s_add_u32 m0, s43, 36864
    s_add_u32 s41, s58, 278528
    buffer_load_dwordx4 v17, s[8:11], s41 offen offset:0 nt lds
    s_add_u32 s41, s58, 310272
    buffer_load_dwordx4 v17, s[8:11], s41 offen offset:1024 nt lds
    s_add_u32 s41, s58, 407552
    buffer_load_dwordx4 v17, s[8:11], s41 offen offset:2048 nt lds
    s_add_u32 s41, s58, 439296
    buffer_load_dwordx4 v17, s[8:11], s41 offen offset:3072 nt lds
    ds_write_b64 v70, v[32:33] offset:8192
    v_add_u32 v28, 73728, v24
    v_add_u32 v29, 73728, v25
    v_add_u32 v30, 73728, v26
    v_add_u32 v31, 73728, v27
    ds_read_b64_tr_b16 a[234:235], v28 offset:0
    ds_read_b64_tr_b16 v[0:1], v28 offset:8
    ds_read_b64_tr_b16 a[242:243], v29 offset:0
    ds_read_b64_tr_b16 a[250:251], v29 offset:8
    ds_read_b64_tr_b16 v[146:147], v30 offset:0
    ds_read_b64_tr_b16 v[154:155], v30 offset:8
    ds_read_b64_tr_b16 v[162:163], v31 offset:0
    ds_read_b64_tr_b16 v[170:171], v31 offset:8
    s_waitcnt vmcnt(12) lgkmcnt(0)
    s_barrier
    s_cmp_eq_u32 s71, 1
    s_cbranch_scc1 cs_th9
    s_waitcnt vmcnt(6)
cs_th9:
    s_mov_b64 s[8:9], s[54:55]
    s_add_u32 m0, s43, 73728
    s_add_u32 s41, s58, 262144
    buffer_load_dwordx4 v17, s[8:11], s41 offen offset:0 nt lds
    s_add_u32 s41, s58, 293888
    buffer_load_dwordx4 v17, s[8:11], s41 offen offset:1024 nt lds
    s_add_u32 s41, s58, 391168
    buffer_load_dwordx4 v17, s[8:11], s41 offen offset:2048 nt lds
    s_add_u32 s41, s58, 422912
    buffer_load_dwordx4 v17, s[8:11], s41 offen offset:3072 nt lds
    ds_write_b64 v70, v[0:1] offset:8200
    v_add_u32 v28, 110592, v24
    v_add_u32 v29, 110592, v25
    v_add_u32 v30, 110592, v26
    v_add_u32 v31, 110592, v27
    ds_read_b64_tr_b16 v[32:33], v28 offset:0
    ds_read_b64_tr_b16 v[34:35], v28 offset:8
    ds_read_b64_tr_b16 v[36:37], v29 offset:0
    ds_read_b64_tr_b16 v[38:39], v29 offset:8
    ds_read_b64_tr_b16 a[0:1], v30 offset:0
    ds_read_b64_tr_b16 v[40:41], v30 offset:8
    ds_read_b64_tr_b16 a[8:9], v31 offset:0
    ds_read_b64_tr_b16 v[42:43], v31 offset:8
    s_waitcnt vmcnt(12) lgkmcnt(0)
    s_barrier
    s_cmp_eq_u32 s71, 1
    s_cbranch_scc1 cs_th10
    s_waitcnt vmcnt(6)
cs_th10:
    s_add_u32 m0, s43, 110592
    s_add_u32 s41, s58, 278528
    buffer_load_dwordx4 v17, s[8:11], s41 offen offset:0 nt lds
    s_add_u32 s41, s58, 310272
    buffer_load_dwordx4 v17, s[8:11], s41 offen offset:1024 nt lds
    s_add_u32 s41, s58, 407552
    buffer_load_dwordx4 v17, s[8:11], s41 offen offset:2048 nt lds
    s_add_u32 s41, s58, 439296
    buffer_load_dwordx4 v17, s[8:11], s41 offen offset:3072 nt lds
    ds_write_b64 v70, v[32:33] offset:0
    ds_write_b64 v70, v[34:35] offset:2048
    ds_write_b64 v70, v[36:37] offset:4096
    ds_write_b64 v70, v[38:39] offset:6144
    ds_write_b64 v70, v[40:41] offset:10240
    ds_write_b64 v70, v[42:43] offset:14336
    v_add_u32 v28, 147456, v24
    v_add_u32 v29, 147456, v25
    v_add_u32 v30, 147456, v26
    v_add_u32 v31, 147456, v27
    ds_read_b64_tr_b16 v[0:1], v28 offset:0
    ds_read_b64_tr_b16 v[2:3], v28 offset:8
    ds_read_b64_tr_b16 v[4:5], v29 offset:0
    ds_read_b64_tr_b16 v[6:7], v29 offset:8
    ds_read_b64_tr_b16 a[2:3], v30 offset:0
    ds_read_b64_tr_b16 v[8:9], v30 offset:8
    ds_read_b64_tr_b16 a[10:11], v31 offset:0
    ds_read_b64_tr_b16 v[10:11], v31 offset:8
    s_waitcnt vmcnt(12) lgkmcnt(0)
    s_barrier
    s_cmp_eq_u32 s71, 1
    s_cbranch_scc1 cs_th11
    s_waitcnt vmcnt(6)
cs_th11:
    s_mov_b64 s[8:9], s[50:51]
    s_add_u32 m0, s43, 147456
    s_add_u32 s41, s58, 262144
    buffer_load_dwordx4 v17, s[8:11], s41 offen offset:0 nt lds
    s_add_u32 s41, s58, 293888
    buffer_load_dwordx4 v17, s[8:11], s41 offen offset:1024 nt lds
    s_add_u32 s41, s58, 391168
    buffer_load_dwordx4 v17, s[8:11], s41 offen offset:2048 nt lds
    s_add_u32 s41, s58, 422912
    buffer_load_dwordx4 v17, s[8:11], s41 offen offset:3072 nt lds
    ds_write_b64 v70, v[0:1] offset:8
    ds_write_b64 v70, v[2:3] offset:2056
    ds_write_b64 v70, v[4:5] offset:4104
    ds_write_b64 v70, v[6:7] offset:6152
    ds_write_b64 v70, v[8:9] offset:10248
    ds_write_b64 v70, v[10:11] offset:14344
    v_add_u32 v28, 0, v24
    v_add_u32 v29, 0, v25
    v_add_u32 v30, 0, v26
    v_add_u32 v31, 0, v27
    ds_read_b64_tr_b16 a[100:101], v28 offset:0
    ds_read_b64_tr_b16 a[108:109], v28 offset:8
    ds_read_b64_tr_b16 a[116:117], v29 offset:0
    ds_read_b64_tr_b16 a[124:125], v29 offset:8
    ds_read_b64_tr_b16 a[132:133], v30 offset:0
    ds_read_b64_tr_b16 a[140:141], v30 offset:8
    ds_read_b64_tr_b16 a[148:149], v31 offset:0
    ds_read_b64_tr_b16 v[32:33], v31 offset:8
    s_waitcnt vmcnt(12) lgkmcnt(0)
    s_barrier
    s_cmp_eq_u32 s71, 1
    s_cbranch_scc1 cs_th12
    s_waitcnt vmcnt(6)
cs_th12:
    s_add_u32 m0, s43, 0
    s_add_u32 s41, s58, 278528
    buffer_load_dwordx4 v17, s[8:11], s41 offen offset:0 nt lds
    s_add_u32 s41, s58, 310272
    buffer_load_dwordx4 v17, s[8:11], s41 offen offset:1024 nt lds
    s_add_u32 s41, s58, 407552
    buffer_load_dwordx4 v17, s[8:11], s41 offen offset:2048 nt lds
    s_add_u32 s41, s58, 439296
    buffer_load_dwordx4 v17, s[8:11], s41 offen offset:3072 nt lds
    ds_write_b64 v70, v[32:33] offset:13312
    v_add_u32 v28, 36864, v24
    v_add_u32 v29, 36864, v25
    v_add_u32 v30, 36864, v26
    v_add_u32 v31, 36864, v27
    ds_read_b64_tr_b16 a[102:103], v28 offset:0
    ds_read_b64_tr_b16 a[110:111], v28 offset:8
    ds_read_b64_tr_b16 a[118:119], v29 offset:0
    ds_read_b64_tr_b16 a[126:127], v29 offset:8
    ds_read_b64_tr_b16 a[134:135], v30 offset:0
    ds_read_b64_tr_b16 a[142:143], v30 offset:8
    ds_read_b64_tr_b16 a[150:151], v31 offset:0
    ds_read_b64_tr_b16 v[0:1], v31 offset:8
    s_waitcnt vmcnt(12) lgkmcnt(0)
    s_barrier
    s_cmp_eq_u32 s71, 1
    s_cbranch_scc1 cs_th13
    s_waitcnt vmcnt(6)
cs_th13:
    s_mov_b64 s[8:9], s[52:53]
    s_add_u32 m0, s43, 36864
    s_add_u32 s41, s58, 524288
    buffer_load_dwordx4 v17, s[8:11], s41 offen offset:0 nt lds
    s_add_u32 s41, s58, 556032
    buffer_load_dwordx4 v17, s[8:11], s41 offen offset:1024 nt lds
    s_add_u32 s41, s58, 653312
    buffer_load_dwordx4 v17, s[8:11], s41 offen offset:2048 nt lds
    s_add_u32 s41, s58, 685056
    buffer_load_dwordx4 v17, s[8:11], s41 offen offset:3072 nt lds
    ds_write_b64 v70, v[0:1] offset:13320
    v_add_u32 v28, 73728, v24
    v_add_u32 v29, 73728, v25
    v_add_u32 v30, 73728, v26
    v_add_u32 v31, 73728, v27
    ds_read_b64_tr_b16 a[236:237], v28 offset:0
    ds_read_b64_tr_b16 v[32:33], v28 offset:8
    ds_read_b64_tr_b16 a[244:245], v29 offset:0
    ds_read_b64_tr_b16 a[252:253], v29 offset:8
    ds_read_b64_tr_b16 v[148:149], v30 offset:0
    ds_read_b64_tr_b16 v[156:157], v30 offset:8
    ds_read_b64_tr_b16 v[164:165], v31 offset:0
    ds_read_b64_tr_b16 v[172:173], v31 offset:8
    s_waitcnt vmcnt(12) lgkmcnt(0)
    s_barrier
    s_cmp_eq_u32 s71, 1
    s_cbranch_scc1 cs_th14
    s_waitcnt vmcnt(6)
cs_th14:
    s_add_u32 m0, s43, 73728
    s_add_u32 s41, s58, 540672
    buffer_load_dwordx4 v17, s[8:11], s41 offen offset:0 nt lds
    s_add_u32 s41, s58, 572416
    buffer_load_dwordx4 v17, s[8:11], s41 offen offset:1024 nt lds
    s_add_u32 s41, s58, 669696
    buffer_load_dwordx4 v17, s[8:11], s41 offen offset:2048 nt lds
    s_add_u32 s41, s58, 701440
    buffer_load_dwordx4 v17, s[8:11], s41 offen offset:3072 nt lds
    ds_write_b64 v70, v[32:33] offset:9216
    v_add_u32 v28, 110592, v24
    v_add_u32 v29, 110592, v25
    v_add_u32 v30, 110592, v26
    v_add_u32 v31, 110592, v27
    ds_read_b64_tr_b16 a[238:239], v28 offset:0
    ds_read_b64_tr_b16 v[0:1], v28 offset:8
    ds_read_b64_tr_b16 a[246:247], v29 offset:0
    ds_read_b64_tr_b16 a[254:255], v29 offset:8
    ds_read_b64_tr_b16 v[150:151], v30 offset:0
    ds_read_b64_tr_b16 v[158:159], v30 offset:8
    ds_read_b64_tr_b16 v[166:167], v31 offset:0
    ds_read_b64_tr_b16 v[174:175], v31 offset:8
    s_waitcnt vmcnt(12) lgkmcnt(0)
    s_barrier
    s_cmp_eq_u32 s71, 1
    s_cbranch_scc1 cs_th15
    s_waitcnt vmcnt(6)
cs_th15:
    s_mov_b64 s[8:9], s[54:55]
    s_add_u32 m0, s43, 110592
    s_add_u32 s41, s58, 524288
    buffer_load_dwordx4 v17, s[8:11], s41 offen offset:0 nt lds
    s_add_u32 s41, s58, 556032
    buffer_load_dwordx4 v17, s[8:11], s41 offen offset:1024 nt lds
    s_add_u32 s41, s58, 653312
    buffer_load_dwordx4 v17, s[8:11], s41 offen offset:2048 nt lds
    s_add_u32 s41, s58, 685056
    buffer_load_dwordx4 v17, s[8:11], s41 offen offset:3072 nt lds
    ds_write_b64 v70, v[0:1] offset:9224
    v_add_u32 v28, 147456, v24
    v_add_u32 v29, 147456, v25
    v_add_u32 v30, 147456, v26
    v_add_u32 v31, 147456, v27
    ds_read_b64_tr_b16 v[32:33], v28 offset:0
    ds_read_b64_tr_b16 v[34:35], v28 offset:8
    ds_read_b64_tr_b16 v[36:37], v29 offset:0
    ds_read_b64_tr_b16 v[38:39], v29 offset:8
    ds_read_b64_tr_b16 a[4:5], v30 offset:0
    ds_read_b64_tr_b16 v[40:41], v30 offset:8
    ds_read_b64_tr_b16 a[12:13], v31 offset:0
    ds_read_b64_tr_b16 v[42:43], v31 offset:8
    s_waitcnt vmcnt(12) lgkmcnt(0)
    s_barrier
    s_cmp_eq_u32 s71, 1
    s_cbranch_scc1 cs_th16
    s_waitcnt vmcnt(6)
cs_th16:
    s_add_u32 m0, s43, 147456
    s_add_u32 s41, s58, 540672
    buffer_load_dwordx4 v17, s[8:11], s41 offen offset:0 nt lds
    s_add_u32 s41, s58, 572416
    buffer_load_dwordx4 v17, s[8:11], s41 offen offset:1024 nt lds
    s_add_u32 s41, s58, 669696
    buffer_load_dwordx4 v17, s[8:11], s41 offen offset:2048 nt lds
    s_add_u32 s41, s58, 701440
    buffer_load_dwordx4 v17, s[8:11], s41 offen offset:3072 nt lds
    ds_write_b64 v70, v[32:33] offset:1024
    ds_write_b64 v70, v[34:35] offset:3072
    ds_write_b64 v70, v[36:37] offset:5120
    ds_write_b64 v70, v[38:39] offset:7168
    ds_write_b64 v70, v[40:41] offset:11264
    ds_write_b64 v70, v[42:43] offset:15360
    v_add_u32 v28, 0, v24
    v_add_u32 v29, 0, v25
    v_add_u32 v30, 0, v26
    v_add_u32 v31, 0, v27
    ds_read_b64_tr_b16 v[0:1], v28 offset:0
    ds_read_b64_tr_b16 v[2:3], v28 offset:8
    ds_read_b64_tr_b16 v[4:5], v29 offset:0
    ds_read_b64_tr_b16 v[6:7], v29 offset:8
    ds_read_b64_tr_b16 a[6:7], v30 offset:0
    ds_read_b64_tr_b16 v[8:9], v30 offset:8
    ds_read_b64_tr_b16 a[14:15], v31 offset:0
    ds_read_b64_tr_b16 v[10:11], v31 offset:8
    s_waitcnt vmcnt(12) lgkmcnt(0)
    s_barrier
    s_cmp_eq_u32 s71, 1
    s_cbranch_scc1 cs_th17
    s_waitcnt vmcnt(6)
cs_th17:
    s_mov_b64 s[8:9], s[50:51]
    s_add_u32 m0, s43, 0
    s_add_u32 s41, s58, 524288
    buffer_load_dwordx4 v17, s[8:11], s41 offen offset:0 nt lds
    s_add_u32 s41, s58, 556032
    buffer_load_dwordx4 v17, s[8:11], s41 offen offset:1024 nt lds
    s_add_u32 s41, s58, 653312
    buffer_load_dwordx4 v17, s[8:11], s41 offen offset:2048 nt lds
    s_add_u32 s41, s58, 685056
    buffer_load_dwordx4 v17, s[8:11], s41 offen offset:3072 nt lds
    ds_write_b64 v70, v[0:1] offset:1032
    ds_write_b64 v70, v[2:3] offset:3080
    ds_write_b64 v70, v[4:5] offset:5128
    ds_write_b64 v70, v[6:7] offset:7176
    ds_write_b64 v70, v[8:9] offset:11272
    ds_write_b64 v70, v[10:11] offset:15368
    v_add_u32 v28, 36864, v24
    v_add_u32 v29, 36864, v25
    v_add_u32 v30, 36864, v26
    v_add_u32 v31, 36864, v27
    ds_read_b64_tr_b16 a[152:153], v28 offset:0
    ds_read_b64_tr_b16 a[160:161], v28 offset:8
    ds_read_b64_tr_b16 a[168:169], v29 offset:0
    ds_read_b64_tr_b16 a[176:177], v29 offset:8
    ds_read_b64_tr_b16 a[184:185], v30 offset:0
    ds_read_b64_tr_b16 a[192:193], v30 offset:8
    ds_read_b64_tr_b16 a[200:201], v31 offset:0
    ds_read_b64_tr_b16 a[208:209], v31 offset:8
    s_waitcnt vmcnt(12) lgkmcnt(0)
    s_barrier
    s_cmp_eq_u32 s71, 1
    s_cbranch_scc1 cs_th18
    s_waitcnt vmcnt(6)
cs_th18:
    s_add_u32 m0, s43, 36864
    s_add_u32 s41, s58, 540672
    buffer_load_dwordx4 v17, s[8:11], s41 offen offset:0 nt lds
    s_add_u32 s41, s58, 572416
    buffer_load_dwordx4 v17, s[8:11], s41 offen offset:1024 nt lds
    s_add_u32 s41, s58, 669696
    buffer_load_dwordx4 v17, s[8:11], s41 offen offset:2048 nt lds
    s_add_u32 s41, s58, 701440
    buffer_load_dwordx4 v17, s[8:11], s41 offen offset:3072 nt lds
    v_add_u32 v28, 73728, v24
    v_add_u32 v29, 73728, v25
    v_add_u32 v30, 73728, v26
    v_add_u32 v31, 73728, v27
    ds_read_b64_tr_b16 a[154:155], v28 offset:0
    ds_read_b64_tr_b16 a[162:163], v28 offset:8
    ds_read_b64_tr_b16 a[170:171], v29 offset:0
    ds_read_b64_tr_b16 a[178:179], v29 offset:8
    ds_read_b64_tr_b16 a[186:187], v30 offset:0
    ds_read_b64_tr_b16 a[194:195], v30 offset:8
    ds_read_b64_tr_b16 a[202:203], v31 offset:0
    ds_read_b64_tr_b16 a[210:211], v31 offset:8
    s_waitcnt vmcnt(12) lgkmcnt(0)
    s_barrier
    s_cmp_eq_u32 s71, 1
    s_cbranch_scc1 cs_th19
    s_waitcnt vmcnt(6)
cs_th19:
    s_mov_b64 s[8:9], s[52:53]
    s_add_u32 m0, s43, 73728
    s_add_u32 s41, s58, 786432
    buffer_load_dwordx4 v17, s[8:11], s41 offen offset:0 nt lds
    s_add_u32 s41, s58, 818176
    buffer_load_dwordx4 v17, s[8:11], s41 offen offset:1024 nt lds
    s_add_u32 s41, s58, 915456
    buffer_load_dwordx4 v17, s[8:11], s41 offen offset:2048 nt lds
    s_add_u32 s41, s58, 947200
    buffer_load_dwordx4 v17, s[8:11], s41 offen offset:3072 nt lds
    v_add_u32 v28, 110592, v24
    v_add_u32 v29, 110592, v25
    v_add_u32 v30, 110592, v26
    v_add_u32 v31, 110592, v27
    ds_read_b64_tr_b16 v[176:177], v28 offset:0
    ds_read_b64_tr_b16 v[184:185], v28 offset:8
    ds_read_b64_tr_b16 v[192:193], v29 offset:0
    ds_read_b64_tr_b16 v[200:201], v29 offset:8
    ds_read_b64_tr_b16 v[208:209], v30 offset:0
    ds_read_b64_tr_b16 v[216:217], v30 offset:8
    ds_read_b64_tr_b16 v[224:225], v31 offset:0
    ds_read_b64_tr_b16 v[232:233], v31 offset:8
    s_waitcnt vmcnt(12) lgkmcnt(0)
    s_barrier
    s_cmp_eq_u32 s71, 1
    s_cbranch_scc1 cs_th20
    s_waitcnt vmcnt(6)
cs_th20:
    s_add_u32 m0, s43, 110592
    s_add_u32 s41, s58, 802816
    buffer_load_dwordx4 v17, s[8:11], s41 offen offset:0 nt lds
    s_add_u32 s41, s58, 834560
    buffer_load_dwordx4 v17, s[8:11], s41 offen offset:1024 nt lds
    s_add_u32 s41, s58, 931840
    buffer_load_dwordx4 v17, s[8:11], s41 offen offset:2048 nt lds
    s_add_u32 s41, s58, 963584
    buffer_load_dwordx4 v17, s[8:11], s41 offen offset:3072 nt lds
    v_add_u32 v28, 147456, v24
    v_add_u32 v29, 147456, v25
    v_add_u32 v30, 147456, v26
    v_add_u32 v31, 147456, v27
    ds_read_b64_tr_b16 v[178:179], v28 offset:0
    ds_read_b64_tr_b16 v[186:187], v28 offset:8
    ds_read_b64_tr_b16 v[194:195], v29 offset:0
    ds_read_b64_tr_b16 v[202:203], v29 offset:8
    ds_read_b64_tr_b16 v[210:211], v30 offset:0
    ds_read_b64_tr_b16 v[218:219], v30 offset:8
    ds_read_b64_tr_b16 v[226:227], v31 offset:0
    ds_read_b64_tr_b16 v[234:235], v31 offset:8
    s_waitcnt vmcnt(12) lgkmcnt(0)
    s_barrier
    s_cmp_eq_u32 s71, 1
    s_cbranch_scc1 cs_th21
    s_waitcnt vmcnt(6)
cs_th21:
    s_mov_b64 s[8:9], s[54:55]
    s_add_u32 m0, s43, 147456
    s_add_u32 s41, s58, 786432
    buffer_load_dwordx4 v17, s[8:11], s41 offen offset:0 nt lds
    s_add_u32 s41, s58, 818176
    buffer_load_dwordx4 v17, s[8:11], s41 offen offset:1024 nt lds
    s_add_u32 s41, s58, 915456
    buffer_load_dwordx4 v17, s[8:11], s41 offen offset:2048 nt lds
    s_add_u32 s41, s58, 947200
    buffer_load_dwordx4 v17, s[8:11], s41 offen offset:3072 nt lds
    v_add_u32 v28, 0, v24
    v_add_u32 v29, 0, v25
    v_add_u32 v30, 0, v26
    v_add_u32 v31, 0, v27
    ds_read_b64_tr_b16 a[16:17], v28 offset:0
    ds_read_b64_tr_b16 a[24:25], v28 offset:8
    ds_read_b64_tr_b16 a[32:33], v29 offset:0
    ds_read_b64_tr_b16 a[40:41], v29 offset:8
    ds_read_b64_tr_b16 a[48:49], v30 offset:0
    ds_read_b64_tr_b16 a[56:57], v30 offset:8
    ds_read_b64_tr_b16 a[64:65], v31 offset:0
    ds_read_b64_tr_b16 a[72:73], v31 offset:8
    s_waitcnt vmcnt(12) lgkmcnt(0)
    s_barrier
    s_cmp_eq_u32 s71, 1
    s_cbranch_scc1 cs_th22
    s_waitcnt vmcnt(6)
cs_th22:
    s_add_u32 m0, s43, 0
    s_add_u32 s41, s58, 802816
    buffer_load_dwordx4 v17, s[8:11], s41 offen offset:0 nt lds
    s_add_u32 s41, s58, 834560
    buffer_load_dwordx4 v17, s[8:11], s41 offen offset:1024 nt lds
    s_add_u32 s41, s58, 931840
    buffer_load_dwordx4 v17, s[8:11], s41 offen offset:2048 nt lds
    s_add_u32 s41, s58, 963584
    buffer_load_dwordx4 v17, s[8:11], s41 offen offset:3072 nt lds
    v_add_u32 v28, 36864, v24
    v_add_u32 v29, 36864, v25
    v_add_u32 v30, 36864, v26
    v_add_u32 v31, 36864, v27
    ds_read_b64_tr_b16 a[18:19], v28 offset:0
    ds_read_b64_tr_b16 a[26:27], v28 offset:8
    ds_read_b64_tr_b16 a[34:35], v29 offset:0
    ds_read_b64_tr_b16 a[42:43], v29 offset:8
    ds_read_b64_tr_b16 a[50:51], v30 offset:0
    ds_read_b64_tr_b16 a[58:59], v30 offset:8
    ds_read_b64_tr_b16 a[66:67], v31 offset:0
    ds_read_b64_tr_b16 a[74:75], v31 offset:8
    s_waitcnt vmcnt(12) lgkmcnt(0)
    s_barrier
    s_cmp_eq_u32 s71, 1
    s_cbranch_scc1 cs_th23
    s_waitcnt vmcnt(6)
cs_th23:
    s_mov_b64 s[8:9], s[50:51]
    s_add_u32 m0, s43, 36864
    s_add_u32 s41, s58, 786432
    buffer_load_dwordx4 v17, s[8:11], s41 offen offset:0 nt lds
    s_add_u32 s41, s58, 818176
    buffer_load_dwordx4 v17, s[8:11], s41 offen offset:1024 nt lds
    s_add_u32 s41, s58, 915456
    buffer_load_dwordx4 v17, s[8:11], s41 offen offset:2048 nt lds
    s_add_u32 s41, s58, 947200
    buffer_load_dwordx4 v17, s[8:11], s41 offen offset:3072 nt lds
    v_add_u32 v28, 73728, v24
    v_add_u32 v29, 73728, v25
    v_add_u32 v30, 73728, v26
    v_add_u32 v31, 73728, v27
    ds_read_b64_tr_b16 a[156:157], v28 offset:0
    ds_read_b64_tr_b16 a[164:165], v28 offset:8
    ds_read_b64_tr_b16 a[172:173], v29 offset:0
    ds_read_b64_tr_b16 a[180:181], v29 offset:8
    ds_read_b64_tr_b16 a[188:189], v30 offset:0
    ds_read_b64_tr_b16 a[196:197], v30 offset:8
    ds_read_b64_tr_b16 a[204:205], v31 offset:0
    ds_read_b64_tr_b16 a[212:213], v31 offset:8
    s_waitcnt vmcnt(12) lgkmcnt(0)
    s_barrier
    s_cmp_eq_u32 s71, 1
    s_cbranch_scc1 cs_th24
    s_waitcnt vmcnt(6)
cs_th24:
    s_add_u32 m0, s43, 73728
    s_add_u32 s41, s58, 802816
    buffer_load_dwordx4 v17, s[8:11], s41 offen offset:0 nt lds
    s_add_u32 s41, s58, 834560
    buffer_load_dwordx4 v17, s[8:11], s41 offen offset:1024 nt lds
    s_add_u32 s41, s58, 931840
    buffer_load_dwordx4 v17, s[8:11], s41 offen offset:2048 nt lds
    s_add_u32 s41, s58, 963584
    buffer_load_dwordx4 v17, s[8:11], s41 offen offset:3072 nt lds
    v_add_u32 v28, 110592, v24
    v_add_u32 v29, 110592, v25
    v_add_u32 v30, 110592, v26
    v_add_u32 v31, 110592, v27
    ds_read_b64_tr_b16 a[158:159], v28 offset:0
    ds_read_b64_tr_b16 a[166:167], v28 offset:8
    ds_read_b64_tr_b16 a[174:175], v29 offset:0
    ds_read_b64_tr_b16 a[182:183], v29 offset:8
    ds_read_b64_tr_b16 a[190:191], v30 offset:0
    ds_read_b64_tr_b16 a[198:199], v30 offset:8
    ds_read_b64_tr_b16 a[206:207], v31 offset:0
    ds_read_b64_tr_b16 a[214:215], v31 offset:8
    s_waitcnt vmcnt(12) lgkmcnt(0)
    s_barrier
    s_cmp_eq_u32 s71, 1
    s_cbranch_scc1 cs_th25
    s_waitcnt vmcnt(6)
cs_th25:
    s_mov_b64 s[8:9], s[52:53]
    s_add_u32 m0, s43, 110592
    s_add_u32 s41, s59, 0
    buffer_load_dwordx4 v17, s[8:11], s41 offen offset:0 nt lds
    s_add_u32 s41, s59, 31744
    buffer_load_dwordx4 v17, s[8:11], s41 offen offset:1024 nt lds
    s_add_u32 s41, s59, 129024
    buffer_load_dwordx4 v17, s[8:11], s41 offen offset:2048 nt lds
    s_add_u32 s41, s59, 160768
    buffer_load_dwordx4 v17, s[8:11], s41 offen offset:3072 nt lds
    v_add_u32 v28, 147456, v24
    v_add_u32 v29, 147456, v25
    v_add_u32 v30, 147456, v26
    v_add_u32 v31, 147456, v27
    ds_read_b64_tr_b16 v[180:181], v28 offset:0
    ds_read_b64_tr_b16 v[188:189], v28 offset:8
    ds_read_b64_tr_b16 v[196:197], v29 offset:0
    ds_read_b64_tr_b16 v[204:205], v29 offset:8
    ds_read_b64_tr_b16 v[212:213], v30 offset:0
    ds_read_b64_tr_b16 v[220:221], v30 offset:8
    ds_read_b64_tr_b16 v[228:229], v31 offset:0
    ds_read_b64_tr_b16 v[236:237], v31 offset:8
    s_waitcnt vmcnt(12) lgkmcnt(0)
    s_barrier
    s_cmp_eq_u32 s71, 1
    s_cbranch_scc1 cs_th26
    s_waitcnt vmcnt(6)
cs_th26:
    s_mov_b64 s[8:9], s[50:51]
    s_add_u32 m0, s43, 147456
    s_add_u32 s41, s59, 0
    buffer_load_dwordx4 v17, s[8:11], s41 offen offset:0 nt lds
    s_add_u32 s41, s59, 31744
    buffer_load_dwordx4 v17, s[8:11], s41 offen offset:1024 nt lds
    s_add_u32 s41, s59, 129024
    buffer_load_dwordx4 v17, s[8:11], s41 offen offset:2048 nt lds
    s_add_u32 s41, s59, 160768
    buffer_load_dwordx4 v17, s[8:11], s41 offen offset:3072 nt lds
    v_add_u32 v28, 0, v24
    v_add_u32 v29, 0, v25
    v_add_u32 v30, 0, v26
    v_add_u32 v31, 0, v27
    ds_read_b64_tr_b16 v[182:183], v28 offset:0
    ds_read_b64_tr_b16 v[190:191], v28 offset:8
    ds_read_b64_tr_b16 v[198:199], v29 offset:0
    ds_read_b64_tr_b16 v[206:207], v29 offset:8
    ds_read_b64_tr_b16 v[214:215], v30 offset:0
    ds_read_b64_tr_b16 v[222:223], v30 offset:8
    ds_read_b64_tr_b16 v[230:231], v31 offset:0
    ds_read_b64_tr_b16 v[238:239], v31 offset:8
    s_waitcnt vmcnt(12) lgkmcnt(0)
    s_barrier
    s_cmp_eq_u32 s71, 1
    s_cbranch_scc1 cs_th27
    s_waitcnt vmcnt(6)
cs_th27:
    s_mov_b64 s[8:9], s[54:55]
    s_add_u32 m0, s43, 0
    s_add_u32 s41, s59, 0
    buffer_load_dwordx4 v17, s[8:11], s41 offen offset:0 nt lds
    s_add_u32 s41, s59, 31744
    buffer_load_dwordx4 v17, s[8:11], s41 offen offset:1024 nt lds
    s_add_u32 s41, s59, 129024
    buffer_load_dwordx4 v17, s[8:11], s41 offen offset:2048 nt lds
    s_add_u32 s41, s59, 160768
    buffer_load_dwordx4 v17, s[8:11], s41 offen offset:3072 nt lds
    v_add_u32 v28, 36864, v24
    v_add_u32 v29, 36864, v25
    v_add_u32 v30, 36864, v26
    v_add_u32 v31, 36864, v27
    ds_read_b64_tr_b16 a[20:21], v28 offset:0
    ds_read_b64_tr_b16 a[28:29], v28 offset:8
    ds_read_b64_tr_b16 a[36:37], v29 offset:0
    ds_read_b64_tr_b16 a[44:45], v29 offset:8
    ds_read_b64_tr_b16 a[52:53], v30 offset:0
    ds_read_b64_tr_b16 a[60:61], v30 offset:8
    ds_read_b64_tr_b16 a[68:69], v31 offset:0
    ds_read_b64_tr_b16 a[76:77], v31 offset:8
    s_waitcnt vmcnt(12) lgkmcnt(0)
    s_barrier
    s_cmp_eq_u32 s71, 1
    s_cbranch_scc1 cs_th28
    s_waitcnt vmcnt(6)
cs_th28:
    s_mov_b64 s[8:9], s[56:57]
    s_add_u32 m0, s43, 36864
    s_add_u32 s41, s60, 128
    buffer_load_dwordx4 v18, s[8:11], s41 offen offset:0 nt lds
    s_add_u32 s41, s60, 8320
    buffer_load_dwordx4 v18, s[8:11], s41 offen offset:1024 nt lds
    s_add_u32 s41, s60, 16512
    buffer_load_dwordx4 v18, s[8:11], s41 offen offset:2048 nt lds
    s_add_u32 s41, s60, 24704
    buffer_load_dwordx4 v18, s[8:11], s41 offen offset:3072 nt lds
    v_add_u32 v28, 73728, v24
    v_add_u32 v29, 73728, v25
    v_add_u32 v30, 73728, v26
    v_add_u32 v31, 73728, v27
    ds_read_b64_tr_b16 a[22:23], v28 offset:0
    ds_read_b64_tr_b16 a[30:31], v28 offset:8
    ds_read_b64_tr_b16 a[38:39], v29 offset:0
    ds_read_b64_tr_b16 a[46:47], v29 offset:8
    ds_read_b64_tr_b16 a[54:55], v30 offset:0
    ds_read_b64_tr_b16 a[62:63], v30 offset:8
    ds_read_b64_tr_b16 a[70:71], v31 offset:0
    ds_read_b64_tr_b16 a[78:79], v31 offset:8
    s_waitcnt vmcnt(12) lgkmcnt(0)
    s_barrier
    s_cmp_eq_u32 s71, 1
    s_cbranch_scc1 cs_th29
    s_waitcnt vmcnt(6)
cs_th29:
    s_add_u32 m0, s43, 73728
    s_add_u32 s41, s61, 128
    buffer_load_dwordx4 v18, s[8:11], s41 offen offset:0 nt lds
    s_add_u32 s41, s61, 8320
    buffer_load_dwordx4 v18, s[8:11], s41 offen offset:1024 nt lds
    s_add_u32 s41, s61, 16512
    buffer_load_dwordx4 v18, s[8:11], s41 offen offset:2048 nt lds
    s_add_u32 s41, s61, 24704
    buffer_load_dwordx4 v18, s[8:11], s41 offen offset:3072 nt lds
    v_add_u32 v77, 110592, v20
    ds_read_b64_tr_b16 a[216:217], v77 offset:0
    ds_read_b64_tr_b16 a[218:219], v77 offset:4096
    ds_read_b64_tr_b16 a[220:221], v77 offset:8192
    ds_read_b64_tr_b16 a[222:223], v77 offset:12288
    ds_read_b64_tr_b16 a[224:225], v77 offset:8
    ds_read_b64_tr_b16 a[226:227], v77 offset:4104
    ds_read_b64_tr_b16 a[228:229], v77 offset:8200
    ds_read_b64_tr_b16 a[230:231], v77 offset:12296
    s_waitcnt vmcnt(12) lgkmcnt(0)
    s_barrier
    s_cmp_eq_u32 s71, 1
    s_cbranch_scc1 cs_th30
    s_waitcnt vmcnt(6)
cs_th30:
    s_add_u32 m0, s43, 110592
    s_add_u32 s41, s62, 128
    buffer_load_dwordx4 v18, s[8:11], s41 offen offset:0 nt lds
    s_add_u32 s41, s62, 8320
    buffer_load_dwordx4 v18, s[8:11], s41 offen offset:1024 nt lds
    s_add_u32 s41, s62, 16512
    buffer_load_dwordx4 v18, s[8:11], s41 offen offset:2048 nt lds
    s_add_u32 s41, s62, 24704
    buffer_load_dwordx4 v18, s[8:11], s41 offen offset:3072 nt lds
    v_add_u32 v77, 147456, v20
    ds_read_b64_tr_b16 a[80:81], v77 offset:0
    ds_read_b64_tr_b16 a[82:83], v77 offset:4096
    ds_read_b64_tr_b16 a[84:85], v77 offset:8192
    ds_read_b64_tr_b16 a[86:87], v77 offset:12288
    ds_read_b64_tr_b16 a[88:89], v77 offset:8
    ds_read_b64_tr_b16 a[90:91], v77 offset:4104
    ds_read_b64_tr_b16 a[92:93], v77 offset:8200
    ds_read_b64_tr_b16 a[94:95], v77 offset:12296
    s_waitcnt vmcnt(12) lgkmcnt(0)
    s_barrier
    s_cmp_eq_u32 s71, 1
    s_cbranch_scc1 cs_th31
    s_waitcnt vmcnt(6)
cs_th31:
    s_add_u32 m0, s43, 147456
    s_add_u32 s41, s63, 128
    buffer_load_dwordx4 v18, s[8:11], s41 offen offset:0 nt lds
    s_add_u32 s41, s63, 8320
    buffer_load_dwordx4 v18, s[8:11], s41 offen offset:1024 nt lds
    s_add_u32 s41, s63, 16512
    buffer_load_dwordx4 v18, s[8:11], s41 offen offset:2048 nt lds
    s_add_u32 s41, s63, 24704
    buffer_load_dwordx4 v18, s[8:11], s41 offen offset:3072 nt lds
    v_mov_b32 v78, v21
    v_mov_b32 v79, v22
    v_add_u32 v77, 0, v20
    ds_read_b64_tr_b16 v[240:241], v77 offset:0
    ds_read_b64_tr_b16 v[242:243], v77 offset:4096
    ds_read_b64_tr_b16 v[244:245], v77 offset:8192
    ds_read_b64_tr_b16 v[246:247], v77 offset:12288
    ds_read_b64_tr_b16 v[248:249], v77 offset:8
    ds_read_b64_tr_b16 v[250:251], v77 offset:4104
    ds_read_b64_tr_b16 v[252:253], v77 offset:8200
    ds_read_b64_tr_b16 v[254:255], v77 offset:12296
    s_waitcnt vmcnt(12) lgkmcnt(0)
    s_barrier
    v_bfe_u32 v60, v65, 4, 6
    v_and_b32 v61, 15, v60
    v_lshrrev_b32 v62, 4, v60
    v_mov_b32 v50, 0x3f80
    v_mov_b32 v51, 0x3f800000
    v_and_b32 v57, 1, v62
    v_lshlrev_b32 v57, 2, v57
    v_sub_u32 v57, v61, v57
    v_and_b32 v58, 3, v61
    v_lshlrev_b32 v58, 2, v58
    v_lshrrev_b32 v59, 2, v61
    v_add_u32 v58, v58, v59
    v_cmp_eq_u32 vcc, 0, v57
    s_nop 1
    v_cndmask_b32 v40, 0, v50, vcc
    v_cmp_eq_u32 vcc, 1, v57
    s_nop 1
    v_cndmask_b32 v40, v40, v51, vcc
    v_cmp_eq_u32 vcc, 0, v58
    s_nop 1
    v_cndmask_b32 v44, 0, v50, vcc
    v_cmp_eq_u32 vcc, 1, v58
    s_nop 1
    v_cndmask_b32 v44, v44, v51, vcc
    v_cmp_eq_u32 vcc, 2, v57
    s_nop 1
    v_cndmask_b32 v41, 0, v50, vcc
    v_cmp_eq_u32 vcc, 3, v57
    s_nop 1
    v_cndmask_b32 v41, v41, v51, vcc
    v_cmp_eq_u32 vcc, 2, v58
    s_nop 1
    v_cndmask_b32 v45, 0, v50, vcc
    v_cmp_eq_u32 vcc, 3, v58
    s_nop 1
    v_cndmask_b32 v45, v45, v51, vcc
    v_cmp_eq_u32 vcc, 8, v57
    s_nop 1
    v_cndmask_b32 v42, 0, v50, vcc
    v_cmp_eq_u32 vcc, 9, v57
    s_nop 1
    v_cndmask_b32 v42, v42, v51, vcc
    v_cmp_eq_u32 vcc, 4, v58
    s_nop 1
    v_cndmask_b32 v46, 0, v50, vcc
    v_cmp_eq_u32 vcc, 5, v58
    s_nop 1
    v_cndmask_b32 v46, v46, v51, vcc
    v_cmp_eq_u32 vcc, 10, v57
    s_nop 1
    v_cndmask_b32 v43, 0, v50, vcc
    v_cmp_eq_u32 vcc, 11, v57
    s_nop 1
    v_cndmask_b32 v43, v43, v51, vcc
    v_cmp_eq_u32 vcc, 6, v58
    s_nop 1
    v_cndmask_b32 v47, 0, v50, vcc
    v_cmp_eq_u32 vcc, 7, v58
    s_nop 1
    v_cndmask_b32 v47, v47, v51, vcc
    v_lshlrev_b32 v57, 4, v61
    ds_write_b128 v69, v[40:43] offset:15360
    ds_write_b128 v57, v[44:47] offset:15872
    v_add_u32 v77, 36864, v79
    s_waitcnt lgkmcnt(0)
    ds_read_b64_tr_b16 v[0:1], v77 offset:0
    ds_read_b64_tr_b16 v[2:3], v77 offset:256
    ds_read_b64_tr_b16 v[4:5], v77 offset:2048
    ds_read_b64_tr_b16 v[6:7], v77 offset:2304
    ds_read_b64_tr_b16 v[8:9], v77 offset:16
    ds_read_b64_tr_b16 v[10:11], v77 offset:272
    ds_read_b64_tr_b16 v[12:13], v77 offset:2064
    ds_read_b64_tr_b16 v[14:15], v77 offset:2320
    s_waitcnt vmcnt(8) lgkmcnt(0)
    s_barrier
    v_add_u32 v77, 73728, v78
    ds_read_b64_tr_b16 v[16:17], v77 offset:0
    ds_read_b64_tr_b16 v[18:19], v77 offset:256
    ds_read_b64_tr_b16 v[20:21], v77 offset:2048
    ds_read_b64_tr_b16 v[22:23], v77 offset:2304
    ds_read_b64_tr_b16 v[24:25], v77 offset:16
    ds_read_b64_tr_b16 v[26:27], v77 offset:272
    ds_read_b64_tr_b16 v[28:29], v77 offset:2064
    ds_read_b64_tr_b16 v[30:31], v77 offset:2320
    s_waitcnt vmcnt(4) lgkmcnt(0)
    s_barrier
    v_add_u32 v77, 110592, v78
    ds_read_b64_tr_b16 v[32:33], v77 offset:0
    ds_read_b64_tr_b16 v[34:35], v77 offset:256
    ds_read_b64_tr_b16 v[36:37], v77 offset:2048
    ds_read_b64_tr_b16 v[38:39], v77 offset:2304
    ds_read_b64_tr_b16 v[40:41], v77 offset:16
    ds_read_b64_tr_b16 v[42:43], v77 offset:272
    ds_read_b64_tr_b16 v[44:45], v77 offset:2064
    ds_read_b64_tr_b16 v[46:47], v77 offset:2320
    s_waitcnt vmcnt(0) lgkmcnt(0)
    s_barrier
    v_add_u32 v77, 147456, v78
    ds_read_b64_tr_b16 v[48:49], v77 offset:0
    ds_read_b64_tr_b16 v[50:51], v77 offset:256
    ds_read_b64_tr_b16 v[52:53], v77 offset:2048
    ds_read_b64_tr_b16 v[54:55], v77 offset:2304
    ds_read_b64_tr_b16 v[56:57], v77 offset:16
    ds_read_b64_tr_b16 v[58:59], v77 offset:272
    ds_read_b64_tr_b16 v[60:61], v77 offset:2064
    ds_read_b64_tr_b16 v[62:63], v77 offset:2320
    s_waitcnt lgkmcnt(0)
    s_barrier
    ds_write_b128 v70, v[0:3] offset:20480
    ds_write_b128 v70, v[4:7] offset:21504
    ds_write_b128 v70, v[8:11] offset:22528
    ds_write_b128 v70, v[12:15] offset:23552
    ds_write_b128 v70, v[16:19] offset:24576
    ds_write_b128 v70, v[20:23] offset:25600
    ds_write_b128 v70, v[24:27] offset:26624
    ds_write_b128 v70, v[28:31] offset:27648
    ds_write_b128 v70, v[32:35] offset:28672
    ds_write_b128 v70, v[36:39] offset:29696
    ds_write_b128 v70, v[40:43] offset:30720
    ds_write_b128 v70, v[44:47] offset:31744
    ds_write_b128 v70, v[48:51] offset:32768
    ds_write_b128 v70, v[52:55] offset:33792
    ds_write_b128 v70, v[56:59] offset:34816
    ds_write_b128 v70, v[60:63] offset:35840
    s_waitcnt vmcnt(0) lgkmcnt(0)
    s_barrier
    v_mov_b32 v2, 1
    s_cmp_lg_u32 s13, 0
    s_cbranch_scc1 cs_noarr
    s_mov_b64 exec, 1
    buffer_atomic_add v2, off, s[84:87], 0 offset:212
    s_mov_b32 s40, 16777216
    s_mov_b32 s42, 2
cs_startpoll:
    buffer_load_dword v3, off, s[84:87], 0 offset:212 sc1
    s_sub_u32 s40, s40, 1
    s_cbranch_scc1 cs_decide
    s_waitcnt vmcnt(0)
    v_readfirstlane_b32 s41, v3
    s_nop 1
    s_cmp_lt_u32 s41, 32
    s_cbranch_scc1 cs_startpoll
    s_mov_b32 s42, 1
cs_decide:
    s_mov_b64 exec, -1
cs_noarr:
    s_barrier
    s_mov_b32 s44, 0x3e0293ee
    s_mov_b32 s45, s44
    s_or_b32 s66, s44, 0x80000000
    s_mov_b32 s48, 0x3f003f00
    s_mov_b32 s49, 0
    s_mov_b32 s50, 0x3f803f80
    s_mov_b32 s51, 0x3f803f80
    s_mov_b32 s52, 512
    s_mov_b32 s53, 1024
    s_mov_b32 s54, 1536
    s_mov_b32 s30, 0
    s_mov_b32 s37, 0
    s_mov_b32 s98, -100
    s_lshl_b32 s47, s13, 9
    s_cmp_lg_u32 s32, 0
    s_cselect_b32 s71, s13, 3
    s_add_u32 s46, s71, 1
    s_lshr_b32 s46, s46, 1
    s_mov_b32 s14, 67649536
    s_mov_b32 s15, 67653632
    s_mov_b32 s16, 67657728
    s_mov_b32 s36, 0
    s_add_u32 s17, s68, 67633152
    s_mov_b32 s69, 0
    s_mov_b32 s70, 0
    s_lshl_b32 s26, s12, 14
    s_add_u32 s26, s26, 0
    s_mul_i32 s40, s13, 3072
    s_add_u32 s24, s26, s40
    s_add_u32 s26, s24, s33
    s_add_u32 s99, s26, 33030144
    s_lshl_b32 s96, s12, 7
    s_add_u32 s29, s96, 125845504
    s_lshr_b32 s96, s12, 1
    s_lshl_b32 s96, s96, 11
    s_add_u32 s96, s96, 126091776
    s_lshl_b32 s40, s12, 14
    s_add_u32 s40, s40, 68681728
    s_add_u32 s18, s40, 0
    s_add_u32 s19, s40, 4096
    s_add_u32 s20, s40, 8192
    s_add_u32 s21, s40, 12288
    s_lshr_b32 s40, s12, 3
    s_lshl_b32 s40, s40, 12
    s_and_b32 s41, s12, 7
    s_lshl_b32 s41, s41, 7
    s_add_u32 s40, s40, s41
    s_add_u32 s22, s40, 68681728
    s_add_u32 s23, s22, 1024
    s_add_u32 s25, s22, 2048
    s_mov_b32 s56, -65472
    s_cmp_lg_u32 s32, 0
    s_cselect_b64 s[38:39], -1, 0
    s_add_u32 s55, s68, 138412032
    s_cmp_eq_u32 s13, 3
    s_cselect_b64 s[100:101], 1, 0
    s_cselect_b64 s[38:39], 1, s[38:39]
    s_cselect_b32 s93, 64, 0
    s_cselect_b32 s67, 64, 0
    s_cselect_b32 s55, s29, s55
    s_cselect_b32 s57, 0, 9216
    s_mov_b32 s34, 0xff00ff00
    s_mov_b32 s35, 0xff00ff00
    s_lshl_b32 s28, s12, 12
    s_add_u32 s28, s28, 7340032
    s_add_u32 s27, s28, 77594624
    s_add_u32 s28, s28, 69206016
    s_mov_b64 exec, s[100:101]
    v_mov_b32 v72, s95
    s_mov_b64 exec, -1
    s_mov_b32 s40, 3
    v_bfe_u32 v78, v65, 4, 3
    v_lshlrev_b32 v78, 7, v78
    s_mov_b32 s31, 4194304
cs_kv0:
    buffer_load_dword v77, v78, s[4:7], s96 offen sc1
    s_waitcnt vmcnt(0)
    v_subrev_u32 v77, s95, v77
    v_cmp_lt_u32 vcc, 16, v77
    s_nop 1
    v_cndmask_b32 v77, v77, 0, vcc
    v_bfe_u32 v79, v78, 7, 2
    v_lshl_add_u32 v77, v77, 2, v79
    s_nop 1
    v_min_u32_dpp v77, v77, v77 row_ror:1 row_mask:0xf bank_mask:0xf
    s_nop 1
    v_min_u32_dpp v77, v77, v77 row_ror:2 row_mask:0xf bank_mask:0xf
    s_nop 1
    v_min_u32_dpp v77, v77, v77 row_ror:4 row_mask:0xf bank_mask:0xf
    s_nop 0
    v_readfirstlane_b32 s97, v77
    s_sub_u32 s31, s31, 1
    s_cbranch_scc1 cs_kv0_x
    s_cmp_le_u32 s40, s97
    s_cbranch_scc1 cs_kv0_x
    s_sleep 2
    s_branch cs_kv0
cs_kv0_x:
    s_add_u32 s40, s26, 0
    s_min_u32 s40, s40, s99
    s_sub_u32 s41, s96, s40
    v_bfe_u32 v77, v65, 4, 3
    v_lshl_add_u32 v77, v77, 7, s41
    v_lshlrev_b32 v78, 3, v69
    s_nop 0
    v_mov_b32_dpp v78, v77 quad_perm:[0,1,2,3] row_mask:0xc bank_mask:0xf
    buffer_load_dword v76, v78, s[4:7], s40 offen sc1
    s_add_u32 s40, s26, 524288
    s_min_u32 s40, s40, s99
    s_sub_u32 s41, s96, s40
    v_bfe_u32 v77, v65, 4, 3
    v_lshl_add_u32 v77, v77, 7, s41
    v_lshlrev_b32 v78, 3, v69
    s_nop 0
    v_mov_b32_dpp v78, v77 quad_perm:[0,1,2,3] row_mask:0xc bank_mask:0xf
    buffer_load_dword v76, v78, s[4:7], s40 offen sc1
cs_kvdone:
    v_mov_b64 v[0:1], 0
    v_mov_b64 v[2:3], 0
    v_mov_b64 v[4:5], 0
    v_mov_b64 v[6:7], 0
    v_mov_b64 v[8:9], 0
    v_mov_b64 v[10:11], 0
    v_mov_b64 v[12:13], 0
    v_mov_b64 v[14:15], 0
    v_mov_b64 v[16:17], 0
    v_mov_b64 v[18:19], 0
    v_mov_b64 v[20:21], 0
    v_mov_b64 v[22:23], 0
    ds_read_b128 v[44:47], v70 offset:0
    ds_read_b128 v[48:51], v70 offset:1024
    ds_read_b128 v[52:55], v70 offset:2048
    ds_read_b128 v[56:59], v70 offset:3072
    ds_read_b128 v[24:27], v70 offset:4096
    ds_read_b128 v[28:31], v70 offset:5120
    ds_read_b128 v[32:35], v70 offset:6144
    ds_read_b128 v[36:39], v70 offset:7168
    buffer_load_dwordx4 v[40:43], v65, s[4:7], s14 offen offset:0 sc1
    buffer_load_dwordx4 v[60:63], v66, s[4:7], s14 offen offset:0 sc1
    s_mov_b32 s31, 1048576
    s_waitcnt vmcnt(0) lgkmcnt(0)
    s_branch cs_goA
cs_loop:
    s_mov_b32 s31, 1048576
    s_mov_b32 s69, s70
    s_waitcnt lgkmcnt(0)
cs_cA:
    buffer_load_dwordx4 v[40:43], v65, s[4:7], s14 offen offset:0 sc1
    buffer_load_dwordx4 v[60:63], v66, s[4:7], s14 offen offset:0 sc1
cs_cA1:
    s_waitcnt vmcnt(0)
    v_bitop3_b32 v77, v40, v60, s70 bitop3:0x7e
    v_bitop3_b32 v77, v77, v41, s70 bitop3:0xf6
    v_bitop3_b32 v77, v77, v42, s70 bitop3:0xf6
    v_bitop3_b32 v77, v77, v43, s70 bitop3:0xf6
    v_bitop3_b32 v77, v77, v61, s70 bitop3:0xf6
    v_bitop3_b32 v77, v77, v62, s70 bitop3:0xf6
    v_bitop3_b32 v77, v77, v63, s70 bitop3:0xf6
    v_and_b32 v77, 1, v77
    v_cmp_ne_u32 vcc, 0, v77
    s_cbranch_vccz cs_goA
    s_nop 15
    s_nop 15
    s_nop 7
    buffer_load_dwordx4 v[40:43], v65, s[4:7], s14 offen offset:0 sc1
    buffer_load_dwordx4 v[60:63], v66, s[4:7], s14 offen offset:0 sc1
    s_waitcnt vmcnt(0)
    v_bitop3_b32 v77, v40, v60, s70 bitop3:0x7e
    v_bitop3_b32 v77, v77, v41, s70 bitop3:0xf6
    v_bitop3_b32 v77, v77, v42, s70 bitop3:0xf6
    v_bitop3_b32 v77, v77, v43, s70 bitop3:0xf6
    v_bitop3_b32 v77, v77, v61, s70 bitop3:0xf6
    v_bitop3_b32 v77, v77, v62, s70 bitop3:0xf6
    v_bitop3_b32 v77, v77, v63, s70 bitop3:0xf6
    v_and_b32 v77, 1, v77
    v_cmp_ne_u32 vcc, 0, v77
    s_cbranch_vccz cs_goA
    s_nop 15
    s_nop 15
    s_nop 7
    buffer_load_dwordx4 v[40:43], v65, s[4:7], s14 offen offset:0 sc1
    buffer_load_dwordx4 v[60:63], v66, s[4:7], s14 offen offset:0 sc1
    s_waitcnt vmcnt(0)
    v_bitop3_b32 v77, v40, v60, s70 bitop3:0x7e
    v_bitop3_b32 v77, v77, v41, s70 bitop3:0xf6
    v_bitop3_b32 v77, v77, v42, s70 bitop3:0xf6
    v_bitop3_b32 v77, v77, v43, s70 bitop3:0xf6
    v_bitop3_b32 v77, v77, v61, s70 bitop3:0xf6
    v_bitop3_b32 v77, v77, v62, s70 bitop3:0xf6
    v_bitop3_b32 v77, v77, v63, s70 bitop3:0xf6
    v_and_b32 v77, 1, v77
    v_cmp_ne_u32 vcc, 0, v77
    s_cbranch_vccz cs_goA
    s_nop 15
    s_nop 15
    s_nop 7
    buffer_load_dwordx4 v[40:43], v65, s[4:7], s14 offen offset:0 sc1
    buffer_load_dwordx4 v[60:63], v66, s[4:7], s14 offen offset:0 sc1
    s_waitcnt vmcnt(0)
    v_bitop3_b32 v77, v40, v60, s70 bitop3:0x7e
    v_bitop3_b32 v77, v77, v41, s70 bitop3:0xf6
    v_bitop3_b32 v77, v77, v42, s70 bitop3:0xf6
    v_bitop3_b32 v77, v77, v43, s70 bitop3:0xf6
    v_bitop3_b32 v77, v77, v61, s70 bitop3:0xf6
    v_bitop3_b32 v77, v77, v62, s70 bitop3:0xf6
    v_bitop3_b32 v77, v77, v63, s70 bitop3:0xf6
    v_and_b32 v77, 1, v77
    v_cmp_ne_u32 vcc, 0, v77
    s_cbranch_vccz cs_goA
    s_nop 15
    s_nop 15
    s_nop 7
    s_sub_u32 s31, s31, 64
    s_cbranch_scc0 cs_cA
cs_goA:
    ds_write_b128 v65, v[40:43] offset:0
    v_smfmac_f32_16x16x64_bf16 v[0:3], v[40:43], v[44:51], v64
    v_smfmac_f32_16x16x64_bf16 v[4:7], v[40:43], v[52:59], v64
    buffer_load_dwordx4 v[44:47], v65, s[4:7], s15 offen offset:0 sc1
    v_smfmac_f32_16x16x64_bf16 v[0:3], v[60:63], v[24:31], v64
    s_add_u32 s40, s26, 1048576
    s_min_u32 s40, s40, s99
    s_sub_u32 s41, s96, s40
    v_smfmac_f32_16x16x64_bf16 v[4:7], v[60:63], v[32:39], v64
    ds_read_b128 v[24:27], v70 offset:8192
    s_cmp_lt_u32 s97, s67
    s_cselect_b32 s42, -1, 0
    v_smfmac_f32_16x16x64_bf16 v[8:11], v[40:43], a[96:103], v64
    ds_read_b128 v[28:31], v70 offset:9216
    v_smfmac_f32_16x16x64_bf16 v[12:15], v[40:43], a[104:111], v64
    ds_read_b128 v[32:35], v70 offset:10240
    s_waitcnt lgkmcnt(3)
    s_barrier
    ds_read_b128 v[48:51], v67 offset:0
    v_smfmac_f32_16x16x64_bf16 v[8:11], v[60:63], a[112:119], v64
    ds_read_b128 v[36:39], v70 offset:11264
    v_bitop3_b32 v79, v73, -9, s54 bitop3:0x6a
    v_smfmac_f32_16x16x64_bf16 v[12:15], v[60:63], a[120:127], v64
    v_smfmac_f32_16x16x64_bf16 v[16:19], v[40:43], a[232:239], v64
    ds_read_b128 v[52:55], v68 offset:0
    s_waitcnt lgkmcnt(4)
    v_bfe_u32 v77, v65, 4, 3
    v_smfmac_f32_16x16x64_bf16 v[20:23], v[40:43], v[24:31], v64
    ds_read_b128 v[24:27], v70 offset:12288
    s_waitcnt lgkmcnt(3)
    v_smfmac_f32_16x16x64_bf16 v[0:3], v[48:51], a[0:7], v64
    ds_read_b128 v[28:31], v70 offset:13312
    s_waitcnt lgkmcnt(3)
    v_lshl_add_u32 v77, v77, 7, s41
    v_smfmac_f32_16x16x64_bf16 v[4:7], v[48:51], v[32:39], v64
    buffer_load_dwordx4 v[40:43], v65, s[4:7], s16 offen offset:0 sc1
    v_smfmac_f32_16x16x64_bf16 v[16:19], v[60:63], a[240:247], v64
    ds_read_b128 v[32:35], v70 offset:14336
    v_lshlrev_b32 v78, 3, v69
    v_smfmac_f32_16x16x64_bf16 v[20:23], v[60:63], a[248:255], v64
    ds_read_b128 v[36:39], v70 offset:15360
    v_smfmac_f32_16x16x64_bf16 v[8:11], v[48:51], a[128:135], v64
    s_waitcnt vmcnt(1)
    v_mov_b32_dpp v78, v77 quad_perm:[0,1,2,3] row_mask:0xc bank_mask:0xf
    v_smfmac_f32_16x16x64_bf16 v[12:15], v[48:51], a[136:143], v64
    buffer_load_dwordx4 v[58:61], v65, s[4:7], s24 offen offset:3072 sc1
    s_waitcnt lgkmcnt(2)
    v_bitop3_b32 v77, v44, v45, s70 bitop3:0x7e
    v_bitop3_b32 v77, v77, v46, s70 bitop3:0xf6
    v_bitop3_b32 v77, v77, v47, s70 bitop3:0xf6
    v_and_b32 v77, s36, v77
    v_smfmac_f32_16x16x64_bf16 v[12:15], v[52:55], v[24:31], v64
    ds_write_b128 v65, v[44:47] offset:4096
    v_smfmac_f32_16x16x64_bf16 v[0:3], v[52:55], a[8:15], v64
    v_cmp_ne_u32 vcc, 0, v77
    v_smfmac_f32_16x16x64_bf16 v[8:11], v[52:55], a[144:151], v64
    buffer_load_dwordx4 v[24:27], v65, s[4:7], s24 offen offset:0 sc1
    s_waitcnt lgkmcnt(1)
    v_smfmac_f32_16x16x64_bf16 v[4:7], v[52:55], v[32:39], v64
    s_cbranch_vccnz cs_spinB
cs_backB:
    v_smfmac_f32_16x16x64_bf16 v[16:19], v[44:47], v[176:183], v64
    s_waitcnt lgkmcnt(0)
    s_barrier
    ds_read_b128 v[48:51], v66 offset:4096
    v_smfmac_f32_16x16x64_bf16 v[12:15], v[44:47], a[160:167], v64
    buffer_load_dwordx4 v[28:31], v65, s[4:7], s24 offen offset:1024 sc1
    v_smfmac_f32_16x16x64_bf16 v[0:3], v[44:47], a[16:23], v64
    ds_read_b128 v[52:55], v67 offset:4096
    v_smfmac_f32_16x16x64_bf16 v[8:11], v[44:47], a[152:159], v64
    v_smfmac_f32_16x16x64_bf16 v[4:7], v[44:47], a[24:31], v64
    buffer_load_dwordx4 v[34:37], v65, s[4:7], s24 offen offset:2048 sc1
    s_waitcnt vmcnt(5)
    v_smfmac_f32_16x16x64_bf16 v[20:23], v[44:47], v[184:191], v64
    ds_read_b128 v[44:47], v68 offset:4096
    s_waitcnt lgkmcnt(2)
    v_smfmac_f32_16x16x64_bf16 v[0:3], v[48:51], a[32:39], v64
    v_smfmac_f32_16x16x64_bf16 v[8:11], v[48:51], a[168:175], v64
    s_mov_b32 exec_hi, s42
    buffer_load_dword v76, v78, s[4:7], s40 offen sc1
    s_mov_b32 exec_hi, -1
    v_smfmac_f32_16x16x64_bf16 v[4:7], v[48:51], a[40:47], v64
    s_waitcnt vmcnt(5)
    v_bitop3_b32 v77, v40, v41, s70 bitop3:0x7e
    v_bitop3_b32 v77, v77, v42, s70 bitop3:0xf6
    v_bitop3_b32 v77, v77, v43, s70 bitop3:0xf6
    v_and_b32 v77, s36, v77
    v_smfmac_f32_16x16x64_bf16 v[12:15], v[48:51], a[176:183], v64
    ds_read_b128 v[48:51], v69 offset:15360
    s_waitcnt lgkmcnt(1)
    v_cmp_ne_u32 vcc, 0, v77
    v_smfmac_f32_16x16x64_bf16 v[0:3], v[52:55], a[48:55], v64
    v_smfmac_f32_16x16x64_bf16 v[8:11], v[52:55], a[184:191], v64
    s_cbranch_vccnz cs_spin8
cs_back8:
    v_smfmac_f32_16x16x64_bf16 v[0:3], v[44:47], a[64:71], v64
    v_smfmac_f32_16x16x64_bf16 v[8:11], v[44:47], a[200:207], v64
    v_smfmac_f32_16x16x64_bf16 v[0:3], v[40:43], a[80:87], v64
    s_nop 1
    v_smfmac_f32_16x16x64_bf16 v[8:11], v[40:43], a[216:223], v64
    s_nop 1
    v_lshrrev_b32 v77, 1, v69
    v_smfmac_f32_16x16x64_bf16 v[4:7], v[52:55], a[56:63], v64
    s_nop 1
    v_cvt_pk_bf16_f32 v0, v0, v1
    v_smfmac_f32_16x16x64_bf16 v[12:15], v[52:55], a[192:199], v64
    s_nop 1
    v_cvt_pk_bf16_f32 v1, v2, v3
    v_smfmac_f32_16x16x64_bf16 v[4:7], v[44:47], a[72:79], v64
    s_nop 1
    v_cvt_pk_bf16_f32 v2, v8, v9
    v_smfmac_f32_16x16x64_bf16 v[12:15], v[44:47], a[208:215], v64
    s_nop 1
    v_cvt_pk_bf16_f32 v3, v10, v11
    v_smfmac_f32_16x16x64_bf16 v[4:7], v[40:43], a[88:95], v64
    s_waitcnt lgkmcnt(0)
    s_nop 0
    s_nop 0
    v_smfmac_f32_16x16x64_bf16 v[12:15], v[40:43], a[224:231], v64
    s_nop 2
    v_mfma_f32_16x16x32_bf16 v[8:11], v[0:3], v[48:51], 0
    s_nop 0
    v_cvt_pk_bf16_f32 v4, v4, v5
    v_cvt_pk_bf16_f32 v5, v6, v7
    s_nop 0
    v_cvt_pk_bf16_f32 v6, v12, v13
    v_cvt_pk_bf16_f32 v7, v14, v15
    s_nop 1
    v_mfma_f32_16x16x32_bf16 v[12:15], v[4:7], v[48:51], 0
    ds_read_b128 v[48:51], v66 offset:4096
    v_cvt_pk_bf16_f32 v0, v8, v9
    v_cvt_pk_bf16_f32 v1, v10, v11
    v_smfmac_f32_16x16x64_bf16 v[16:19], v[52:55], v[208:215], v64
    s_waitcnt vmcnt(2)
    s_nop 2
    v_cvt_pk_bf16_f32 v2, v12, v13
    v_cvt_pk_bf16_f32 v3, v14, v15
    s_nop 1
    v_mfma_f32_16x16x32_bf16 v[12:15], v[0:3], v[0:3], 0
    s_nop 1
    v_bitop3_b32 v78, v73, -9, s53 bitop3:0x6a
    v_mfma_f32_16x16x32_bf16 v[4:7], v[24:27], v[0:3], 0
    ds_read_b128 v[24:27], v67 offset:0
    s_nop 1
    v_mfma_f32_16x16x32_bf16 v[8:11], v[28:31], v[0:3], 0
    s_nop 0
    v_mov_b32_dpp v12, v14 row_ror:8 row_mask:0xf bank_mask:0xc
    v_mov_b32_dpp v13, v15 row_ror:8 row_mask:0xf bank_mask:0xc
    v_smfmac_f32_16x16x64_bf16 v[20:23], v[52:55], v[216:223], v64
    ds_write_b64 v71, v[12:13]
    ds_read_b128 v[52:55], v68 offset:0
    s_nop 1
    v_mov_b32_dpp v4, v8 row_ror:8 row_mask:0xf bank_mask:0xc
    v_mov_b32_dpp v5, v9 row_ror:8 row_mask:0xf bank_mask:0xc
    v_mov_b32_dpp v6, v10 row_ror:8 row_mask:0xf bank_mask:0xc
    v_mov_b32_dpp v7, v11 row_ror:8 row_mask:0xf bank_mask:0xc
    v_smfmac_f32_16x16x64_bf16 v[16:19], v[44:47], v[224:231], v64
    ds_write_b128 v65, v[4:7] offset:8192
    v_smfmac_f32_16x16x64_bf16 v[20:23], v[44:47], v[232:239], v64
    s_waitcnt lgkmcnt(3)
    v_smfmac_f32_16x16x64_bf16 v[16:19], v[24:27], v[144:151], v64
    s_waitcnt vmcnt(1)
    v_smfmac_f32_16x16x64_bf16 v[20:23], v[24:27], v[152:159], v64
    s_mov_b64 exec, s[38:39]
    buffer_store_dword v72, v75, s[4:7], s55 offen sc1
    s_mov_b64 exec, -1
    v_smfmac_f32_16x16x64_bf16 v[16:19], v[40:43], v[240:247], v64
    s_cmp_ge_u32 s30, 56
    s_waitcnt lgkmcnt(0)
    s_barrier
    ds_read_b128 v[8:11], v66 offset:8192
    v_smfmac_f32_16x16x64_bf16 v[20:23], v[40:43], v[248:255], v64
    ds_read_b128 v[12:15], v67 offset:8192
    v_smfmac_f32_16x16x64_bf16 v[16:19], v[48:51], v[192:199], v64
    ds_read_b128 v[44:47], v68 offset:8192
    v_smfmac_f32_16x16x64_bf16 v[20:23], v[48:51], v[200:207], v64
    ds_read_b64 v[24:25], v77 offset:14336
    ds_read_b64 v[26:27], v77 offset:14592
    v_smfmac_f32_16x16x64_bf16 v[16:19], v[52:55], v[160:167], v64
    ds_read_b64 v[28:29], v77 offset:14848
    ds_read_b64 v[30:31], v77 offset:15104
    v_bitop3_b32 v77, v73, -9, s52 bitop3:0x6a
    v_smfmac_f32_16x16x64_bf16 v[20:23], v[52:55], v[168:175], v64
    s_cbranch_scc1 cs_rare
cs_rare_x:
    ds_read_b128 v[48:51], v70 offset:22528
    ds_read_b128 v[52:55], v70 offset:23552
    s_waitcnt lgkmcnt(6)
    v_pk_add_f32 v[4:5], v[4:5], v[8:9]
    v_pk_add_f32 v[6:7], v[6:7], v[10:11]
    v_pk_add_f32 v[12:13], v[12:13], v[44:45]
    v_pk_add_f32 v[14:15], v[14:15], v[46:47]
    v_pk_add_f32 v[4:5], v[4:5], v[12:13]
    v_pk_add_f32 v[6:7], v[6:7], v[14:15]
    s_waitcnt lgkmcnt(2)
    v_pk_add_f32 v[24:25], v[24:25], v[26:27]
    v_pk_add_f32 v[28:29], v[28:29], v[30:31]
    v_max3_f32 v8, v4, v5, v6
    v_pk_add_f32 v[24:25], v[24:25], v[28:29]
    v_max_f32 v8, v8, v7
    v_max3_f32 v8, v8, v24, v25
    v_cvt_pk_bf16_f32 v32, v16, v17
    v_cvt_pk_bf16_f32 v38, v18, v19
    v_max_f32_dpp v8, v8, v8 row_ror:8 row_mask:0xf bank_mask:0xf
    v_mov_b32 v9, v8
    v_cvt_pk_bf16_f32 v56, v20, v21
    v_cvt_pk_bf16_f32 v62, v22, v23
    v_permlane32_swap_b32 v8, v9
    v_max_f32 v8, v8, v9
    v_mov_b32 v9, v8
    v_mov_b32 v11, 0
    v_mov_b32 v15, 0
    v_permlane16_swap_b32 v8, v9
    v_max_f32 v8, v8, v9
    v_mul_f32 v8, s66, v8
    v_pk_fma_f32 v[4:5], v[4:5], s[44:45], v[8:9] op_sel_hi:[1,1,0]
    v_pk_fma_f32 v[6:7], v[6:7], s[44:45], v[8:9] op_sel_hi:[1,1,0]
    v_pk_fma_f32 v[24:25], v[24:25], s[44:45], v[8:9] op_sel_hi:[1,1,0]
    v_exp_f32 v4, v4
    v_exp_f32 v5, v5
    v_exp_f32 v6, v6
    v_exp_f32 v7, v7
    v_exp_f32 v24, v24
    v_exp_f32 v25, v25
    v_cvt_pk_bf16_f32 v12, v4, v5
    v_cvt_pk_bf16_f32 v13, v6, v7
    v_cvt_pk_bf16_f32 v10, v24, v25
    v_cvt_pk_bf16_f32 v14, v24, v25
    v_mov_b64 v[0:1], s[48:49]
    v_mfma_f32_16x16x32_bf16 v[4:7], v[32:35], v[10:13], 0
    ds_read_b128 v[40:43], v70 offset:20480
    v_mov_b64 v[2:3], s[50:51]
    v_mfma_f32_16x16x32_bf16 v[24:27], v[36:39], v[12:15], 0
    ds_read_b128 v[44:47], v70 offset:21504
    v_mov_b64 v[8:9], 0
    v_mfma_f32_16x16x32_bf16 v[28:31], v[0:3], v[10:13], 0
    ds_read_b128 v[32:35], v70 offset:24576
    v_mov_b64 v[0:1], 0
    v_mfma_f32_16x16x32_bf16 v[16:19], v[56:59], v[10:13], 0
    ds_read_b128 v[36:39], v70 offset:25600
    v_mov_b64 v[2:3], 0
    v_mfma_f32_16x16x32_bf16 v[20:23], v[60:63], v[12:15], 0
    ds_read_b128 v[56:59], v70 offset:28672
    v_add_f32_dpp v4, v24, v4 row_ror:8 row_mask:0xf bank_mask:0xf
    v_add_f32_dpp v5, v25, v5 row_ror:8 row_mask:0xf bank_mask:0xf
    v_add_f32_dpp v6, v26, v6 row_ror:8 row_mask:0xf bank_mask:0xf
    v_add_f32_dpp v7, v27, v7 row_ror:8 row_mask:0xf bank_mask:0xf
    v_add_f32_dpp v29, v28, v28 row_ror:8 row_mask:0xf bank_mask:0xf
    v_rcp_f32 v28, v29
    v_mov_b64 v[10:11], 0
    v_add_f32_dpp v4, v16, v20 row_ror:8 row_mask:0xf bank_mask:0xc
    v_add_f32_dpp v5, v17, v21 row_ror:8 row_mask:0xf bank_mask:0xc
    v_add_f32_dpp v6, v18, v22 row_ror:8 row_mask:0xf bank_mask:0xc
    v_add_f32_dpp v7, v19, v23 row_ror:8 row_mask:0xf bank_mask:0xc
    v_pk_mul_f32 v[4:5], v[4:5], v[28:29] op_sel_hi:[1,0]
    v_pk_mul_f32 v[6:7], v[6:7], v[28:29] op_sel_hi:[1,0]
    v_cvt_pk_bf16_f32 v4, v4, v5
    v_cvt_pk_bf16_f32 v5, v6, v7
    ds_write_b64 v73, v[4:5] offset:12288
    v_mov_b32_dpp v6, v4 row_ror:8 row_mask:0xf bank_mask:0xf
    v_mov_b32_dpp v7, v5 row_ror:8 row_mask:0xf bank_mask:0xf
    v_mov_b64 v[12:13], 0
    v_mov_b64 v[14:15], 0
    v_smfmac_f32_16x16x64_bf16 v[8:11], v[4:7], v[80:87], v64
    s_waitcnt lgkmcnt(4)
    v_mov_b64 v[24:25], 0
    v_smfmac_f32_16x16x64_bf16 v[0:3], v[4:7], v[40:47], v64
    ds_read_b128 v[60:63], v70 offset:29696
    v_mov_b64 v[26:27], 0
    v_smfmac_f32_16x16x64_bf16 v[12:15], v[4:7], v[112:119], v64
    s_waitcnt lgkmcnt(1)
    s_barrier
    ds_read_b128 v[16:19], v77 offset:12288
    v_smfmac_f32_16x16x64_bf16 v[24:27], v[4:7], v[48:55], v64
    ds_read_b128 v[20:23], v78 offset:12288
    ds_read_b128 v[28:31], v79 offset:12288
    v_mov_b64 v[4:5], 0
    v_mov_b64 v[6:7], 0
    v_bfe_u32 v77, v74, 16, 1
    v_mad_i32_i24 v77, v77, s56, v74
    s_waitcnt lgkmcnt(2)
    v_smfmac_f32_16x16x64_bf16 v[8:11], v[16:19], v[88:95], v64
    ds_read_b128 v[40:43], v70 offset:32768
    s_waitcnt lgkmcnt(2)
    v_smfmac_f32_16x16x64_bf16 v[8:11], v[20:23], v[96:103], v64
    ds_read_b128 v[44:47], v70 offset:33792
    s_waitcnt lgkmcnt(2)
    v_smfmac_f32_16x16x64_bf16 v[8:11], v[28:31], v[104:111], v64
    ds_read_b128 v[48:51], v70 offset:26624
    s_nop 0
    v_and_b32 v72, 8, v73
    v_smfmac_f32_16x16x64_bf16 v[0:3], v[16:19], v[32:39], v64
    ds_read_b128 v[52:55], v70 offset:27648
    s_nop 0
    v_mad_u32_u24 v72, v72, 63, v73
    v_smfmac_f32_16x16x64_bf16 v[12:15], v[16:19], v[120:127], v64
    ds_read_b128 v[32:35], v70 offset:30720
    v_cvt_pk_bf16_f32 v8, v8, v9
    v_cvt_pk_bf16_f32 v9, v10, v11
    v_and_or_b32 v8, v8, -2, s69
    v_smfmac_f32_16x16x64_bf16 v[12:15], v[20:23], v[128:135], v64
    buffer_store_dwordx2 v[8:9], v74, s[4:7], s22 offen offset:0 sc1
    ds_read_b128 v[36:39], v70 offset:31744
    v_smfmac_f32_16x16x64_bf16 v[12:15], v[28:31], v[136:143], v64
    s_add_u32 s30, s30, 1
    s_xor_b32 s70, s70, 1
    v_subrev_u32 v72, s47, v72
    v_smfmac_f32_16x16x64_bf16 v[0:3], v[20:23], v[56:63], v64
    ds_read_b128 v[56:59], v70 offset:34816
    s_waitcnt lgkmcnt(3)
    s_nop 0
    v_smfmac_f32_16x16x64_bf16 v[0:3], v[28:31], v[40:47], v64
    ds_read_b128 v[60:63], v70 offset:35840
    v_cvt_pk_bf16_f32 v12, v12, v13
    v_cvt_pk_bf16_f32 v13, v14, v15
    v_and_or_b32 v12, v12, -2, s69
    v_smfmac_f32_16x16x64_bf16 v[24:27], v[16:19], v[48:55], v64
    buffer_store_dwordx2 v[12:13], v74, s[4:7], s22 offen offset:64 sc1
    s_waitcnt lgkmcnt(2)
    v_smfmac_f32_16x16x64_bf16 v[24:27], v[20:23], v[32:39], v64
    ds_read_b128 v[40:43], v70 offset:16384
    v_cvt_pk_bf16_f32 v0, v0, v1
    v_cvt_pk_bf16_f32 v1, v2, v3
    v_and_or_b32 v0, v0, -2, s69
    s_waitcnt lgkmcnt(1)
    v_smfmac_f32_16x16x64_bf16 v[24:27], v[28:31], v[56:63], v64
    buffer_store_dwordx2 v[0:1], v74, s[4:7], s23 offen offset:0 sc1
    ds_read_b128 v[44:47], v70 offset:17408
    ds_read_b128 v[8:11], v72 offset:12288
    ds_read_b128 v[48:51], v70 offset:18432
    ds_read_b128 v[52:55], v70 offset:19456
    ds_read_b128 v[12:15], v72 offset:13312
    s_cmp_lg_u32 s71, 0
    s_nop 0
    v_cvt_pk_bf16_f32 v24, v24, v25
    v_cvt_pk_bf16_f32 v25, v26, v27
    v_and_or_b32 v24, v24, -2, s69
    buffer_store_dwordx2 v[24:25], v74, s[4:7], s23 offen offset:64 sc1
    s_waitcnt lgkmcnt(3)
    v_smfmac_f32_16x16x64_bf16 v[4:7], v[8:11], v[40:47], v64
    s_waitcnt lgkmcnt(0)
    v_smfmac_f32_16x16x64_bf16 v[4:7], v[12:15], v[48:55], v64
    s_nop 7
    v_cvt_pk_bf16_f32 v4, v4, v5
    v_cvt_pk_bf16_f32 v5, v6, v7
    v_and_or_b32 v4, v4, -2, s69
    buffer_store_dwordx2 v[4:5], v77, s[4:7], s25 offen offset:0 sc1
    s_nop 0
    s_cbranch_scc1 cs_e1
    s_cmp_lg_u32 s37, 0
    s_cbranch_scc1 cs_f0_xt
cs_f0_xtx:
    s_nop 2
    v_mov_b32 v79, v79
    s_nop 2
    v_mov_b32 v79, v79
    s_nop 2
    v_mov_b32 v79, v79
    s_nop 2
    v_mov_b32 v79, v79
    s_nop 2
    v_mov_b32 v79, v79
    s_nop 2
    v_mov_b32 v79, v79
    s_nop 2
    v_mov_b32 v79, v79
    s_nop 2
    v_mov_b32 v79, v79
    s_nop 2
    v_mov_b32 v79, v79
    s_nop 2
    v_mov_b32 v79, v79
    s_nop 2
    v_mov_b32 v79, v79
    s_nop 2
    v_mov_b32 v79, v79
    s_nop 2
    v_mov_b32 v79, v79
    s_nop 2
    v_mov_b32 v79, v79
    s_nop 2
    v_mov_b32 v79, v79
    s_nop 2
    v_mov_b32 v79, v79
    s_nop 2
    v_mov_b32 v79, v79
    s_nop 2
    v_mov_b32 v79, v79
    s_nop 2
    v_mov_b32 v79, v79
    s_nop 2
    v_mov_b32 v79, v79
    s_nop 2
    v_mov_b32 v79, v79
    s_nop 2
    v_mov_b32 v79, v79
    s_nop 2
    v_mov_b32 v79, v79
    s_nop 2
    v_mov_b32 v79, v79
    s_nop 2
    v_mov_b32 v79, v79
    s_nop 2
    v_mov_b32 v79, v79
    s_nop 2
    v_mov_b32 v79, v79
    s_nop 2
    v_mov_b32 v79, v79
    s_nop 2
    v_mov_b32 v79, v79
    s_nop 2
    v_mov_b32 v79, v79
    s_nop 2
    v_mov_b32 v79, v79
    s_nop 2
    v_mov_b32 v79, v79
    s_nop 2
    v_mov_b32 v79, v79
    s_nop 2
    v_mov_b32 v79, v79
    s_nop 2
    v_mov_b32 v79, v79
    s_nop 2
    v_mov_b32 v79, v79
    s_nop 0
    v_mov_b32 v79, v79
    buffer_load_dwordx4 v[8:11], v65, s[4:7], s18 offen sc1
    buffer_load_dwordx4 v[12:15], v65, s[4:7], s19 offen sc1
    buffer_load_dwordx4 v[16:19], v65, s[4:7], s20 offen sc1
    buffer_load_dwordx4 v[20:23], v65, s[4:7], s21 offen sc1
    v_and_b32 v77, 255, v69
    ds_read_b128 v[4:7], v77 offset:15872
    ds_read_b128 v[44:47], v70 offset:0
    ds_read_b128 v[48:51], v70 offset:1024
    ds_read_b128 v[52:55], v70 offset:2048
    ds_read_b128 v[56:59], v70 offset:3072
    ds_read_b128 v[24:27], v70 offset:4096
    ds_read_b128 v[28:31], v70 offset:5120
    ds_read_b128 v[32:35], v70 offset:6144
    ds_read_b128 v[36:39], v70 offset:7168
    s_mov_b32 s31, 65536
    s_add_u32 s24, s24, 524288
    s_add_u32 s26, s26, 524288
    s_add_u32 s55, s55, s57
    s_mov_b32 s14, 67633152
    s_mov_b32 s15, 67637248
    s_mov_b32 s16, 67641344
    s_mov_b32 s36, 1
    v_mov_b32 v40, s69
    v_mov_b32 v60, s69
    v_mov_b32 v79, 1
    s_waitcnt lgkmcnt(0)
    s_waitcnt vmcnt(3)
    v_bitop3_b32 v77, v8, v10, s69 bitop3:0x7e
    v_mfma_f32_16x16x32_bf16 v[0:3], v[4:7], v[8:11], 0
    v_mov_b64 v[8:9], 0
    v_mov_b64 v[10:11], 0
    s_waitcnt vmcnt(2)
    v_bitop3_b32 v78, v12, v14, s69 bitop3:0x7e
    v_mfma_f32_16x16x32_bf16 v[0:3], v[4:7], v[12:15], v[0:3]
    v_or_b32 v77, v77, v78
    v_mov_b64 v[12:13], 0
    v_mov_b64 v[14:15], 0
    s_waitcnt vmcnt(1)
    v_bitop3_b32 v78, v16, v18, s69 bitop3:0x7e
    v_mfma_f32_16x16x32_bf16 v[0:3], v[4:7], v[16:19], v[0:3]
    v_or_b32 v77, v77, v78
    v_mov_b64 v[16:17], 0
    v_mov_b64 v[18:19], 0
    s_waitcnt vmcnt(0)
    v_bitop3_b32 v78, v20, v22, s69 bitop3:0x7e
    v_mfma_f32_16x16x32_bf16 v[0:3], v[4:7], v[20:23], v[0:3]
    v_bitop3_b32 v77, v77, v78, 1 bitop3:0xa8
    v_cmp_ne_u32 vcc, 0, v77
    v_mov_b64 v[20:21], 0
    v_mov_b64 v[22:23], 0
    s_cmp_eq_u64 vcc, 0
    s_cselect_b64 s[42:43], -1, 0
    s_nop 1
    v_add_f32_dpp v0, v0, v0 row_ror:8 row_mask:0xf bank_mask:0xf
    v_add_f32_dpp v1, v1, v1 row_ror:8 row_mask:0xf bank_mask:0xf
    s_mov_b64 exec, s[42:43]
    v_cvt_pk_bf16_f32 v72, v0, v1
    v_bfi_b32 v72, v79, s70, v72
    buffer_store_dword v72, v75, s[4:7], s17 offen offset:0 sc1
    s_mov_b64 exec, -1
    s_cbranch_scc0 cs_f0_retry
cs_f0_go:
    v_mov_b64 v[0:1], 0
    v_mov_b64 v[2:3], 0
    v_mov_b64 v[4:5], 0
    v_mov_b64 v[6:7], 0
    s_nop 2
    v_mov_b32 v79, v79
    s_nop 2
    v_mov_b32 v79, v79
    s_nop 2
    v_mov_b32 v79, v79
    s_nop 2
    v_mov_b32 v79, v79
    s_nop 2
    v_mov_b32 v79, v79
    s_nop 2
    v_mov_b32 v79, v79
    s_nop 2
    v_mov_b32 v79, v79
    s_nop 2
    v_mov_b32 v79, v79
    s_nop 2
    v_mov_b32 v79, v79
    s_nop 2
    v_mov_b32 v79, v79
    s_nop 2
    v_mov_b32 v79, v79
    s_nop 2
    v_mov_b32 v79, v79
    s_nop 2
    v_mov_b32 v79, v79
    s_nop 2
    v_mov_b32 v79, v79
    s_nop 2
    v_mov_b32 v79, v79
    s_nop 2
    v_mov_b32 v79, v79
    s_nop 2
    v_mov_b32 v79, v79
    s_nop 2
    v_mov_b32 v79, v79
    s_nop 2
    v_mov_b32 v79, v79
    s_nop 2
    v_mov_b32 v79, v79
    s_nop 2
    v_mov_b32 v79, v79
    s_nop 2
    v_mov_b32 v79, v79
    s_nop 2
    v_mov_b32 v79, v79
    s_nop 2
    v_mov_b32 v79, v79
    s_nop 2
    v_mov_b32 v79, v79
    s_branch cs_loop
cs_e1:
    s_cmp_lg_u32 s71, 2
    s_cbranch_scc1 cs_f1
    v_and_b32 v77, 255, v69
    ds_read_b128 v[4:7], v77 offset:15872
    ds_read_b128 v[44:47], v70 offset:0
    ds_read_b128 v[48:51], v70 offset:1024
    ds_read_b128 v[52:55], v70 offset:2048
    ds_read_b128 v[56:59], v70 offset:3072
    ds_read_b128 v[24:27], v70 offset:4096
    ds_read_b128 v[28:31], v70 offset:5120
    ds_read_b128 v[32:35], v70 offset:6144
    ds_read_b128 v[36:39], v70 offset:7168
    s_mov_b32 s31, 65536
    s_add_u32 s24, s24, 524288
    s_add_u32 s26, s26, 524288
    s_add_u32 s55, s55, s57
    s_mov_b32 s14, 67633152
    s_mov_b32 s15, 67637248
    s_mov_b32 s16, 67641344
    s_mov_b32 s36, 1
    v_mov_b32 v40, s69
    v_mov_b32 v60, s69
    v_mov_b32 v79, 1
    s_cmp_lg_u32 s37, 0
    s_cbranch_scc1 cs_f2_xt
cs_f2_xtx:
    s_nop 2
    v_mov_b32 v79, v79
    s_nop 2
    v_mov_b32 v79, v79
    s_nop 2
    v_mov_b32 v79, v79
    s_nop 2
    v_mov_b32 v79, v79
    s_nop 2
    v_mov_b32 v79, v79
    s_nop 2
    v_mov_b32 v79, v79
    s_nop 2
    v_mov_b32 v79, v79
    s_nop 2
    v_mov_b32 v79, v79
    s_nop 2
    v_mov_b32 v79, v79
    s_nop 2
    v_mov_b32 v79, v79
    s_nop 2
    v_mov_b32 v79, v79
    s_nop 2
    v_mov_b32 v79, v79
    s_nop 2
    v_mov_b32 v79, v79
    s_nop 2
    v_mov_b32 v79, v79
    s_nop 2
    v_mov_b32 v79, v79
    s_nop 2
    v_mov_b32 v79, v79
    s_nop 2
    v_mov_b32 v79, v79
    s_nop 2
    v_mov_b32 v79, v79
    s_nop 2
    v_mov_b32 v79, v79
    s_nop 2
    v_mov_b32 v79, v79
    s_nop 2
    v_mov_b32 v79, v79
    s_nop 2
    v_mov_b32 v79, v79
    s_nop 2
    v_mov_b32 v79, v79
    s_nop 2
    v_mov_b32 v79, v79
    s_nop 2
    v_mov_b32 v79, v79
    s_nop 2
    v_mov_b32 v79, v79
    s_nop 2
    v_mov_b32 v79, v79
    s_nop 2
    v_mov_b32 v79, v79
    s_nop 2
    v_mov_b32 v79, v79
    s_nop 2
    v_mov_b32 v79, v79
    s_nop 2
    v_mov_b32 v79, v79
    s_nop 2
    v_mov_b32 v79, v79
    s_nop 2
    v_mov_b32 v79, v79
    s_nop 2
    v_mov_b32 v79, v79
    s_nop 2
    v_mov_b32 v79, v79
    s_nop 2
    v_mov_b32 v79, v79
    s_nop 0
    v_mov_b32 v79, v79
    s_waitcnt vmcnt(0)
    buffer_load_dwordx4 v[8:11], v65, s[4:7], s18 offen sc1
    buffer_load_dwordx4 v[12:15], v65, s[4:7], s19 offen sc1
    buffer_load_dwordx4 v[16:19], v65, s[4:7], s20 offen sc1
    buffer_load_dwordx4 v[20:23], v65, s[4:7], s21 offen sc1
    s_nop 2
    v_mov_b32 v79, v79
    s_nop 2
    v_mov_b32 v79, v79
    s_nop 2
    v_mov_b32 v79, v79
    s_nop 2
    v_mov_b32 v79, v79
    s_nop 2
    v_mov_b32 v79, v79
    s_nop 2
    v_mov_b32 v79, v79
    s_nop 2
    v_mov_b32 v79, v79
    s_nop 2
    v_mov_b32 v79, v79
    s_nop 2
    v_mov_b32 v79, v79
    s_nop 2
    v_mov_b32 v79, v79
    buffer_load_dwordx4 v[40:43], v65, s[4:7], s14 offen offset:0 sc1
    buffer_load_dwordx4 v[60:63], v66, s[4:7], s14 offen offset:0 sc1
    s_waitcnt lgkmcnt(0)
    s_waitcnt vmcnt(5)
    v_bitop3_b32 v77, v8, v10, s69 bitop3:0x7e
    v_mfma_f32_16x16x32_bf16 v[0:3], v[4:7], v[8:11], 0
    v_mov_b64 v[8:9], 0
    v_mov_b64 v[10:11], 0
    s_waitcnt vmcnt(4)
    v_bitop3_b32 v78, v12, v14, s69 bitop3:0x7e
    v_mfma_f32_16x16x32_bf16 v[0:3], v[4:7], v[12:15], v[0:3]
    v_or_b32 v77, v77, v78
    v_mov_b64 v[12:13], 0
    v_mov_b64 v[14:15], 0
    s_waitcnt vmcnt(3)
    v_bitop3_b32 v78, v16, v18, s69 bitop3:0x7e
    v_mfma_f32_16x16x32_bf16 v[0:3], v[4:7], v[16:19], v[0:3]
    v_or_b32 v77, v77, v78
    v_mov_b64 v[16:17], 0
    v_mov_b64 v[18:19], 0
    s_waitcnt vmcnt(2)
    v_bitop3_b32 v78, v20, v22, s69 bitop3:0x7e
    v_mfma_f32_16x16x32_bf16 v[0:3], v[4:7], v[20:23], v[0:3]
    v_bitop3_b32 v77, v77, v78, 1 bitop3:0xa8
    v_cmp_ne_u32 vcc, 0, v77
    v_mov_b64 v[20:21], 0
    v_mov_b64 v[22:23], 0
    buffer_load_dwordx4 v[40:43], v65, s[4:7], s14 offen offset:0 sc1
    buffer_load_dwordx4 v[60:63], v66, s[4:7], s14 offen offset:0 sc1
    s_cmp_eq_u64 vcc, 0
    s_cselect_b64 s[42:43], -1, 0
    v_add_f32_dpp v0, v0, v0 row_ror:4 row_mask:0xf bank_mask:0xf
    v_add_f32_dpp v1, v1, v1 row_ror:4 row_mask:0xf bank_mask:0xf
    s_nop 0
    v_add_f32_dpp v0, v0, v0 row_ror:8 row_mask:0xf bank_mask:0xf
    v_add_f32_dpp v1, v1, v1 row_ror:8 row_mask:0xf bank_mask:0xf
    s_mov_b64 exec, s[42:43]
    v_cvt_pk_bf16_f32 v72, v0, v1
    v_bfi_b32 v72, v79, s70, v72
    buffer_store_dword v72, v75, s[4:7], s17 offen offset:0 sc1
    buffer_store_dword v72, v75, s[4:7], s17 offen offset:1024 sc1
    buffer_store_dword v72, v75, s[4:7], s17 offen offset:2048 sc1
    buffer_store_dword v72, v75, s[4:7], s17 offen offset:3072 sc1
    s_mov_b64 exec, -1
    s_cbranch_scc0 cs_f2_retry
cs_f2_go:
    v_mov_b64 v[0:1], 0
    v_mov_b64 v[2:3], 0
    v_mov_b64 v[4:5], 0
    v_mov_b64 v[6:7], 0
    s_nop 2
    v_mov_b32 v79, v79
    s_nop 2
    v_mov_b32 v79, v79
    s_nop 2
    v_mov_b32 v79, v79
    s_nop 2
    v_mov_b32 v79, v79
    s_nop 2
    v_mov_b32 v79, v79
    s_nop 2
    v_mov_b32 v79, v79
    s_nop 2
    v_mov_b32 v79, v79
    s_nop 2
    v_mov_b32 v79, v79
    s_nop 2
    v_mov_b32 v79, v79
    s_nop 2
    v_mov_b32 v79, v79
    s_nop 2
    v_mov_b32 v79, v79
    s_nop 2
    v_mov_b32 v79, v79
    s_nop 2
    v_mov_b32 v79, v79
    s_nop 2
    v_mov_b32 v79, v79
    s_nop 2
    v_mov_b32 v79, v79
    s_nop 2
    v_mov_b32 v79, v79
    s_nop 2
    v_mov_b32 v79, v79
    s_nop 2
    v_mov_b32 v79, v79
    s_nop 2
    v_mov_b32 v79, v79
    s_nop 2
    v_mov_b32 v79, v79
    s_nop 2
    v_mov_b32 v79, v79
    s_nop 2
    v_mov_b32 v79, v79
    s_nop 2
    v_mov_b32 v79, v79
    s_nop 2
    v_mov_b32 v79, v79
    s_nop 2
    v_mov_b32 v79, v79
    s_branch cs_loop
cs_f1:
    s_cmp_lg_u32 s32, 1
    s_cbranch_scc1 cs_f3
    v_and_b32 v77, 255, v69
    ds_read_b128 v[4:7], v77 offset:15872
    ds_read_b128 v[44:47], v70 offset:0
    ds_read_b128 v[48:51], v70 offset:1024
    ds_read_b128 v[52:55], v70 offset:2048
    ds_read_b128 v[56:59], v70 offset:3072
    ds_read_b128 v[24:27], v70 offset:4096
    ds_read_b128 v[28:31], v70 offset:5120
    ds_read_b128 v[32:35], v70 offset:6144
    ds_read_b128 v[36:39], v70 offset:7168
    s_mov_b32 s31, 65536
    s_add_u32 s24, s24, 524288
    s_add_u32 s26, s26, 524288
    s_add_u32 s55, s55, s57
    s_mov_b32 s14, 67633152
    s_mov_b32 s15, 67637248
    s_mov_b32 s16, 67641344
    s_mov_b32 s36, 1
    v_mov_b32 v40, s69
    v_mov_b32 v60, s69
    v_mov_b32 v79, 1
    s_cmp_lg_u32 s37, 0
    s_cbranch_scc1 cs_f1_xt
cs_f1_xtx:
    s_nop 2
    v_mov_b32 v79, v79
    s_nop 2
    v_mov_b32 v79, v79
    s_nop 2
    v_mov_b32 v79, v79
    s_nop 2
    v_mov_b32 v79, v79
    s_nop 2
    v_mov_b32 v79, v79
    s_nop 2
    v_mov_b32 v79, v79
    s_nop 2
    v_mov_b32 v79, v79
    s_nop 2
    v_mov_b32 v79, v79
    s_nop 2
    v_mov_b32 v79, v79
    s_nop 2
    v_mov_b32 v79, v79
    s_nop 2
    v_mov_b32 v79, v79
    s_nop 2
    v_mov_b32 v79, v79
    s_nop 2
    v_mov_b32 v79, v79
    s_nop 2
    v_mov_b32 v79, v79
    s_nop 2
    v_mov_b32 v79, v79
    s_nop 2
    v_mov_b32 v79, v79
    s_nop 2
    v_mov_b32 v79, v79
    s_nop 2
    v_mov_b32 v79, v79
    s_nop 2
    v_mov_b32 v79, v79
    s_nop 2
    v_mov_b32 v79, v79
    s_nop 2
    v_mov_b32 v79, v79
    s_nop 2
    v_mov_b32 v79, v79
    s_nop 2
    v_mov_b32 v79, v79
    s_nop 2
    v_mov_b32 v79, v79
    s_nop 2
    v_mov_b32 v79, v79
    s_nop 2
    v_mov_b32 v79, v79
    s_nop 2
    v_mov_b32 v79, v79
    s_nop 2
    v_mov_b32 v79, v79
    s_nop 2
    v_mov_b32 v79, v79
    s_nop 2
    v_mov_b32 v79, v79
    s_nop 2
    v_mov_b32 v79, v79
    s_nop 2
    v_mov_b32 v79, v79
    s_nop 2
    v_mov_b32 v79, v79
    s_nop 2
    v_mov_b32 v79, v79
    s_nop 2
    v_mov_b32 v79, v79
    s_nop 2
    v_mov_b32 v79, v79
    s_nop 0
    v_mov_b32 v79, v79
    s_waitcnt vmcnt(0)
    buffer_load_dwordx4 v[8:11], v65, s[4:7], s18 offen sc1
    buffer_load_dwordx4 v[12:15], v65, s[4:7], s19 offen sc1
    buffer_load_dwordx4 v[16:19], v65, s[4:7], s20 offen sc1
    buffer_load_dwordx4 v[20:23], v65, s[4:7], s21 offen sc1
    s_nop 2
    v_mov_b32 v79, v79
    s_nop 2
    v_mov_b32 v79, v79
    s_nop 2
    v_mov_b32 v79, v79
    s_nop 2
    v_mov_b32 v79, v79
    s_nop 2
    v_mov_b32 v79, v79
    s_nop 2
    v_mov_b32 v79, v79
    s_nop 2
    v_mov_b32 v79, v79
    s_nop 2
    v_mov_b32 v79, v79
    s_nop 2
    v_mov_b32 v79, v79
    s_nop 2
    v_mov_b32 v79, v79
    buffer_load_dwordx4 v[40:43], v65, s[4:7], s14 offen offset:0 sc1
    buffer_load_dwordx4 v[60:63], v66, s[4:7], s14 offen offset:0 sc1
    s_waitcnt lgkmcnt(0)
    s_waitcnt vmcnt(5)
    v_bitop3_b32 v77, v8, v10, s69 bitop3:0x7e
    v_mfma_f32_16x16x32_bf16 v[0:3], v[4:7], v[8:11], 0
    v_mov_b64 v[8:9], 0
    v_mov_b64 v[10:11], 0
    s_waitcnt vmcnt(4)
    v_bitop3_b32 v78, v12, v14, s69 bitop3:0x7e
    v_mfma_f32_16x16x32_bf16 v[0:3], v[4:7], v[12:15], v[0:3]
    v_or_b32 v77, v77, v78
    v_mov_b64 v[12:13], 0
    v_mov_b64 v[14:15], 0
    s_waitcnt vmcnt(3)
    v_bitop3_b32 v78, v16, v18, s69 bitop3:0x7e
    v_mfma_f32_16x16x32_bf16 v[0:3], v[4:7], v[16:19], v[0:3]
    v_or_b32 v77, v77, v78
    v_mov_b64 v[16:17], 0
    v_mov_b64 v[18:19], 0
    s_waitcnt vmcnt(2)
    v_bitop3_b32 v78, v20, v22, s69 bitop3:0x7e
    v_mfma_f32_16x16x32_bf16 v[0:3], v[4:7], v[20:23], v[0:3]
    v_bitop3_b32 v77, v77, v78, 1 bitop3:0xa8
    v_cmp_ne_u32 vcc, 0, v77
    v_mov_b64 v[20:21], 0
    v_mov_b64 v[22:23], 0
    buffer_load_dwordx4 v[40:43], v65, s[4:7], s14 offen offset:0 sc1
    buffer_load_dwordx4 v[60:63], v66, s[4:7], s14 offen offset:0 sc1
    s_cmp_eq_u64 vcc, 0
    s_cselect_b64 s[42:43], -1, 0
    v_add_f32_dpp v0, v0, v0 row_ror:8 row_mask:0xf bank_mask:0xf
    v_add_f32_dpp v1, v1, v1 row_ror:8 row_mask:0xf bank_mask:0xf
    s_mov_b64 exec, s[42:43]
    v_cvt_pk_bf16_f32 v72, v0, v1
    v_bfi_b32 v72, v79, s70, v72
    buffer_store_dword v72, v75, s[4:7], s17 offen offset:0 sc1
    s_mov_b64 exec, -1
    s_cbranch_scc0 cs_f1_retry
cs_f1_go:
    v_mov_b64 v[0:1], 0
    v_mov_b64 v[2:3], 0
    v_mov_b64 v[4:5], 0
    v_mov_b64 v[6:7], 0
    s_nop 2
    v_mov_b32 v79, v79
    s_nop 2
    v_mov_b32 v79, v79
    s_nop 2
    v_mov_b32 v79, v79
    s_nop 2
    v_mov_b32 v79, v79
    s_nop 2
    v_mov_b32 v79, v79
    s_nop 2
    v_mov_b32 v79, v79
    s_nop 2
    v_mov_b32 v79, v79
    s_nop 2
    v_mov_b32 v79, v79
    s_nop 2
    v_mov_b32 v79, v79
    s_nop 2
    v_mov_b32 v79, v79
    s_nop 2
    v_mov_b32 v79, v79
    s_nop 2
    v_mov_b32 v79, v79
    s_nop 2
    v_mov_b32 v79, v79
    s_nop 2
    v_mov_b32 v79, v79
    s_nop 2
    v_mov_b32 v79, v79
    s_nop 2
    v_mov_b32 v79, v79
    s_nop 2
    v_mov_b32 v79, v79
    s_nop 2
    v_mov_b32 v79, v79
    s_nop 2
    v_mov_b32 v79, v79
    s_nop 2
    v_mov_b32 v79, v79
    s_nop 2
    v_mov_b32 v79, v79
    s_nop 2
    v_mov_b32 v79, v79
    s_nop 2
    v_mov_b32 v79, v79
    s_nop 2
    v_mov_b32 v79, v79
    s_nop 2
    v_mov_b32 v79, v79
    s_branch cs_loop
cs_f3:
    v_and_b32 v77, 255, v69
    ds_read_b128 v[4:7], v77 offset:15872
    ds_read_b128 v[44:47], v70 offset:0
    ds_read_b128 v[48:51], v70 offset:1024
    ds_read_b128 v[52:55], v70 offset:2048
    ds_read_b128 v[56:59], v70 offset:3072
    ds_read_b128 v[24:27], v70 offset:4096
    ds_read_b128 v[28:31], v70 offset:5120
    ds_read_b128 v[32:35], v70 offset:6144
    ds_read_b128 v[36:39], v70 offset:7168
    s_mov_b32 s31, 65536
    s_add_u32 s24, s24, 524288
    s_add_u32 s26, s26, 524288
    s_add_u32 s55, s55, s57
    s_mov_b32 s14, 67633152
    s_mov_b32 s15, 67637248
    s_mov_b32 s16, 67641344
    s_mov_b32 s36, 1
    v_mov_b32 v40, s69
    v_mov_b32 v60, s69
    v_mov_b32 v79, 1
    s_add_u32 s40, s30, s95
    v_mov_b32 v72, s40
    s_waitcnt lgkmcnt(0)
    v_mov_b64 v[0:1], 0
    v_mov_b64 v[2:3], 0
    v_mov_b64 v[4:5], 0
    v_mov_b64 v[6:7], 0
    v_mov_b64 v[8:9], 0
    v_mov_b64 v[10:11], 0
    v_mov_b64 v[12:13], 0
    v_mov_b64 v[14:15], 0
    v_mov_b64 v[16:17], 0
    v_mov_b64 v[18:19], 0
    v_mov_b64 v[20:21], 0
    v_mov_b64 v[22:23], 0
    s_nop 2
    v_mov_b32 v79, v79
    s_nop 2
    v_mov_b32 v79, v79
    s_nop 2
    v_mov_b32 v79, v79
    s_nop 2
    v_mov_b32 v79, v79
    s_nop 2
    v_mov_b32 v79, v79
    s_nop 2
    v_mov_b32 v79, v79
    s_nop 2
    v_mov_b32 v79, v79
    s_nop 2
    v_mov_b32 v79, v79
    s_nop 2
    v_mov_b32 v79, v79
    s_nop 2
    v_mov_b32 v79, v79
    s_nop 2
    v_mov_b32 v79, v79
    s_nop 2
    v_mov_b32 v79, v79
    s_nop 2
    v_mov_b32 v79, v79
    s_nop 2
    v_mov_b32 v79, v79
    s_nop 2
    v_mov_b32 v79, v79
    s_nop 2
    v_mov_b32 v79, v79
    s_nop 2
    v_mov_b32 v79, v79
    s_nop 2
    v_mov_b32 v79, v79
    s_nop 2
    v_mov_b32 v79, v79
    s_nop 2
    v_mov_b32 v79, v79
    s_nop 2
    v_mov_b32 v79, v79
    s_nop 2
    v_mov_b32 v79, v79
    s_nop 2
    v_mov_b32 v79, v79
    s_nop 2
    v_mov_b32 v79, v79
    s_nop 2
    v_mov_b32 v79, v79
    s_nop 2
    v_mov_b32 v79, v79
    s_nop 2
    v_mov_b32 v79, v79
    s_nop 2
    v_mov_b32 v79, v79
    s_nop 2
    v_mov_b32 v79, v79
    s_nop 2
    v_mov_b32 v79, v79
    s_nop 2
    v_mov_b32 v79, v79
    s_nop 2
    v_mov_b32 v79, v79
    s_nop 2
    v_mov_b32 v79, v79
    s_nop 2
    v_mov_b32 v79, v79
    s_nop 2
    v_mov_b32 v79, v79
    s_nop 2
    v_mov_b32 v79, v79
    s_nop 2
    v_mov_b32 v79, v79
    s_nop 2
    v_mov_b32 v79, v79
    s_nop 2
    v_mov_b32 v79, v79
    s_nop 2
    v_mov_b32 v79, v79
    s_nop 2
    v_mov_b32 v79, v79
    s_nop 2
    v_mov_b32 v79, v79
    s_nop 2
    v_mov_b32 v79, v79
    s_nop 2
    v_mov_b32 v79, v79
    s_nop 2
    v_mov_b32 v79, v79
    s_nop 2
    v_mov_b32 v79, v79
    s_nop 2
    v_mov_b32 v79, v79
    s_nop 2
    v_mov_b32 v79, v79
    s_nop 2
    v_mov_b32 v79, v79
    s_nop 2
    v_mov_b32 v79, v79
    s_nop 2
    v_mov_b32 v79, v79
    s_nop 2
    v_mov_b32 v79, v79
    s_nop 2
    v_mov_b32 v79, v79
    s_nop 2
    v_mov_b32 v79, v79
    s_nop 2
    v_mov_b32 v79, v79
    s_nop 2
    v_mov_b32 v79, v79
    s_nop 2
    v_mov_b32 v79, v79
    s_nop 2
    v_mov_b32 v79, v79
    s_nop 2
    v_mov_b32 v79, v79
    s_nop 2
    v_mov_b32 v79, v79
    s_nop 2
    v_mov_b32 v79, v79
    s_nop 2
    v_mov_b32 v79, v79
    s_nop 2
    v_mov_b32 v79, v79
    s_nop 2
    v_mov_b32 v79, v79
    s_nop 2
    v_mov_b32 v79, v79
    s_waitcnt vmcnt(0)
    s_mov_b32 s40, s67
    s_add_u32 s67, s30, 5
    s_min_u32 s67, s67, s93
    s_cmp_lt_u32 s97, s40
    s_cbranch_scc1 cs_kvwait
    s_nop 2
    v_mov_b32 v79, v79
    s_nop 2
    v_mov_b32 v79, v79
    s_nop 2
    v_mov_b32 v79, v79
    s_nop 2
    v_mov_b32 v79, v79
    s_nop 2
    v_mov_b32 v79, v79
    s_nop 2
    v_mov_b32 v79, v79
    s_nop 2
    v_mov_b32 v79, v79
    s_nop 2
    v_mov_b32 v79, v79
cs_kvok:
    s_branch cs_loop
cs_f0_xt:
    s_sub_u32 s37, s37, 1
    s_nop 2
    v_mov_b32 v79, v79
    s_nop 2
    v_mov_b32 v79, v79
    s_nop 2
    v_mov_b32 v79, v79
    s_nop 2
    v_mov_b32 v79, v79
    s_nop 2
    v_mov_b32 v79, v79
    s_nop 2
    v_mov_b32 v79, v79
    s_branch cs_f0_xtx
cs_f0_retry:
    s_sub_u32 s41, s30, s98
    s_mov_b32 s98, s30
    s_cmp_le_u32 s41, 3
    s_cselect_b32 s37, 1, 1
cs_f0_spin:
    buffer_load_dwordx4 v[8:11], v65, s[4:7], s18 offen sc1
    buffer_load_dwordx4 v[12:15], v65, s[4:7], s19 offen sc1
    buffer_load_dwordx4 v[16:19], v65, s[4:7], s20 offen sc1
    buffer_load_dwordx4 v[20:23], v65, s[4:7], s21 offen sc1
    s_nop 2
    v_mov_b32 v79, v79
    s_nop 2
    v_mov_b32 v79, v79
    s_nop 2
    v_mov_b32 v79, v79
    buffer_load_dwordx4 v[40:43], v65, s[4:7], s14 offen offset:0 sc1
    buffer_load_dwordx4 v[60:63], v66, s[4:7], s14 offen offset:0 sc1
    s_waitcnt vmcnt(5)
    v_bitop3_b32 v77, v8, v10, s69 bitop3:0x7e
    v_mfma_f32_16x16x32_bf16 v[0:3], v[4:7], v[8:11], 0
    v_mov_b64 v[8:9], 0
    v_mov_b64 v[10:11], 0
    s_waitcnt vmcnt(4)
    v_bitop3_b32 v78, v12, v14, s69 bitop3:0x7e
    v_mfma_f32_16x16x32_bf16 v[0:3], v[4:7], v[12:15], v[0:3]
    v_or_b32 v77, v77, v78
    v_mov_b64 v[12:13], 0
    v_mov_b64 v[14:15], 0
    s_waitcnt vmcnt(3)
    v_bitop3_b32 v78, v16, v18, s69 bitop3:0x7e
    v_mfma_f32_16x16x32_bf16 v[0:3], v[4:7], v[16:19], v[0:3]
    v_or_b32 v77, v77, v78
    v_mov_b64 v[16:17], 0
    v_mov_b64 v[18:19], 0
    s_waitcnt vmcnt(2)
    v_bitop3_b32 v78, v20, v22, s69 bitop3:0x7e
    v_mfma_f32_16x16x32_bf16 v[0:3], v[4:7], v[20:23], v[0:3]
    v_bitop3_b32 v77, v77, v78, 1 bitop3:0xa8
    v_cmp_ne_u32 vcc, 0, v77
    v_mov_b64 v[20:21], 0
    v_mov_b64 v[22:23], 0
    buffer_load_dwordx4 v[40:43], v65, s[4:7], s14 offen offset:0 sc1
    buffer_load_dwordx4 v[60:63], v66, s[4:7], s14 offen offset:0 sc1
    s_cmp_eq_u64 vcc, 0
    s_cselect_b64 s[42:43], -1, 0
    v_add_f32_dpp v0, v0, v0 row_ror:8 row_mask:0xf bank_mask:0xf
    v_add_f32_dpp v1, v1, v1 row_ror:8 row_mask:0xf bank_mask:0xf
    s_mov_b64 exec, s[42:43]
    v_cvt_pk_bf16_f32 v72, v0, v1
    v_bfi_b32 v72, v79, s70, v72
    buffer_store_dword v72, v75, s[4:7], s17 offen offset:0 sc1
    s_mov_b64 exec, -1
    s_cbranch_scc1 cs_f0_rx
    s_sub_u32 s31, s31, 1
    s_cbranch_scc0 cs_f0_spin
cs_f0_rx:
    v_mov_b64 v[0:1], 0
    v_mov_b64 v[2:3], 0
    v_mov_b64 v[4:5], 0
    v_mov_b64 v[6:7], 0
    s_branch cs_loop
cs_f1_xt:
    s_sub_u32 s37, s37, 1
    s_nop 2
    v_mov_b32 v79, v79
    s_nop 2
    v_mov_b32 v79, v79
    s_nop 2
    v_mov_b32 v79, v79
    s_nop 2
    v_mov_b32 v79, v79
    s_nop 2
    v_mov_b32 v79, v79
    s_nop 2
    v_mov_b32 v79, v79
    s_branch cs_f1_xtx
cs_f1_retry:
    s_sub_u32 s41, s30, s98
    s_mov_b32 s98, s30
    s_cmp_le_u32 s41, 3
    s_cselect_b32 s37, 1, 1
cs_f1_spin:
    buffer_load_dwordx4 v[8:11], v65, s[4:7], s18 offen sc1
    buffer_load_dwordx4 v[12:15], v65, s[4:7], s19 offen sc1
    buffer_load_dwordx4 v[16:19], v65, s[4:7], s20 offen sc1
    buffer_load_dwordx4 v[20:23], v65, s[4:7], s21 offen sc1
    s_nop 2
    v_mov_b32 v79, v79
    s_nop 2
    v_mov_b32 v79, v79
    s_nop 2
    v_mov_b32 v79, v79
    buffer_load_dwordx4 v[40:43], v65, s[4:7], s14 offen offset:0 sc1
    buffer_load_dwordx4 v[60:63], v66, s[4:7], s14 offen offset:0 sc1
    s_waitcnt vmcnt(5)
    v_bitop3_b32 v77, v8, v10, s69 bitop3:0x7e
    v_mfma_f32_16x16x32_bf16 v[0:3], v[4:7], v[8:11], 0
    v_mov_b64 v[8:9], 0
    v_mov_b64 v[10:11], 0
    s_waitcnt vmcnt(4)
    v_bitop3_b32 v78, v12, v14, s69 bitop3:0x7e
    v_mfma_f32_16x16x32_bf16 v[0:3], v[4:7], v[12:15], v[0:3]
    v_or_b32 v77, v77, v78
    v_mov_b64 v[12:13], 0
    v_mov_b64 v[14:15], 0
    s_waitcnt vmcnt(3)
    v_bitop3_b32 v78, v16, v18, s69 bitop3:0x7e
    v_mfma_f32_16x16x32_bf16 v[0:3], v[4:7], v[16:19], v[0:3]
    v_or_b32 v77, v77, v78
    v_mov_b64 v[16:17], 0
    v_mov_b64 v[18:19], 0
    s_waitcnt vmcnt(2)
    v_bitop3_b32 v78, v20, v22, s69 bitop3:0x7e
    v_mfma_f32_16x16x32_bf16 v[0:3], v[4:7], v[20:23], v[0:3]
    v_bitop3_b32 v77, v77, v78, 1 bitop3:0xa8
    v_cmp_ne_u32 vcc, 0, v77
    v_mov_b64 v[20:21], 0
    v_mov_b64 v[22:23], 0
    buffer_load_dwordx4 v[40:43], v65, s[4:7], s14 offen offset:0 sc1
    buffer_load_dwordx4 v[60:63], v66, s[4:7], s14 offen offset:0 sc1
    s_cmp_eq_u64 vcc, 0
    s_cselect_b64 s[42:43], -1, 0
    v_add_f32_dpp v0, v0, v0 row_ror:8 row_mask:0xf bank_mask:0xf
    v_add_f32_dpp v1, v1, v1 row_ror:8 row_mask:0xf bank_mask:0xf
    s_mov_b64 exec, s[42:43]
    v_cvt_pk_bf16_f32 v72, v0, v1
    v_bfi_b32 v72, v79, s70, v72
    buffer_store_dword v72, v75, s[4:7], s17 offen offset:0 sc1
    s_mov_b64 exec, -1
    s_cbranch_scc1 cs_f1_rx
    s_sub_u32 s31, s31, 1
    s_cbranch_scc0 cs_f1_spin
cs_f1_rx:
    v_mov_b64 v[0:1], 0
    v_mov_b64 v[2:3], 0
    v_mov_b64 v[4:5], 0
    v_mov_b64 v[6:7], 0
    s_branch cs_loop
cs_f2_xt:
    s_sub_u32 s37, s37, 1
    s_nop 2
    v_mov_b32 v79, v79
    s_nop 2
    v_mov_b32 v79, v79
    s_nop 2
    v_mov_b32 v79, v79
    s_nop 2
    v_mov_b32 v79, v79
    s_nop 2
    v_mov_b32 v79, v79
    s_nop 2
    v_mov_b32 v79, v79
    s_branch cs_f2_xtx
cs_f2_retry:
    s_sub_u32 s41, s30, s98
    s_mov_b32 s98, s30
    s_cmp_le_u32 s41, 3
    s_cselect_b32 s37, 1, 1
cs_f2_spin:
    buffer_load_dwordx4 v[8:11], v65, s[4:7], s18 offen sc1
    buffer_load_dwordx4 v[12:15], v65, s[4:7], s19 offen sc1
    buffer_load_dwordx4 v[16:19], v65, s[4:7], s20 offen sc1
    buffer_load_dwordx4 v[20:23], v65, s[4:7], s21 offen sc1
    s_nop 2
    v_mov_b32 v79, v79
    s_nop 2
    v_mov_b32 v79, v79
    s_nop 2
    v_mov_b32 v79, v79
    buffer_load_dwordx4 v[40:43], v65, s[4:7], s14 offen offset:0 sc1
    buffer_load_dwordx4 v[60:63], v66, s[4:7], s14 offen offset:0 sc1
    s_waitcnt vmcnt(5)
    v_bitop3_b32 v77, v8, v10, s69 bitop3:0x7e
    v_mfma_f32_16x16x32_bf16 v[0:3], v[4:7], v[8:11], 0
    v_mov_b64 v[8:9], 0
    v_mov_b64 v[10:11], 0
    s_waitcnt vmcnt(4)
    v_bitop3_b32 v78, v12, v14, s69 bitop3:0x7e
    v_mfma_f32_16x16x32_bf16 v[0:3], v[4:7], v[12:15], v[0:3]
    v_or_b32 v77, v77, v78
    v_mov_b64 v[12:13], 0
    v_mov_b64 v[14:15], 0
    s_waitcnt vmcnt(3)
    v_bitop3_b32 v78, v16, v18, s69 bitop3:0x7e
    v_mfma_f32_16x16x32_bf16 v[0:3], v[4:7], v[16:19], v[0:3]
    v_or_b32 v77, v77, v78
    v_mov_b64 v[16:17], 0
    v_mov_b64 v[18:19], 0
    s_waitcnt vmcnt(2)
    v_bitop3_b32 v78, v20, v22, s69 bitop3:0x7e
    v_mfma_f32_16x16x32_bf16 v[0:3], v[4:7], v[20:23], v[0:3]
    v_bitop3_b32 v77, v77, v78, 1 bitop3:0xa8
    v_cmp_ne_u32 vcc, 0, v77
    v_mov_b64 v[20:21], 0
    v_mov_b64 v[22:23], 0
    buffer_load_dwordx4 v[40:43], v65, s[4:7], s14 offen offset:0 sc1
    buffer_load_dwordx4 v[60:63], v66, s[4:7], s14 offen offset:0 sc1
    s_cmp_eq_u64 vcc, 0
    s_cselect_b64 s[42:43], -1, 0
    v_add_f32_dpp v0, v0, v0 row_ror:4 row_mask:0xf bank_mask:0xf
    v_add_f32_dpp v1, v1, v1 row_ror:4 row_mask:0xf bank_mask:0xf
    s_nop 0
    v_add_f32_dpp v0, v0, v0 row_ror:8 row_mask:0xf bank_mask:0xf
    v_add_f32_dpp v1, v1, v1 row_ror:8 row_mask:0xf bank_mask:0xf
    s_mov_b64 exec, s[42:43]
    v_cvt_pk_bf16_f32 v72, v0, v1
    v_bfi_b32 v72, v79, s70, v72
    buffer_store_dword v72, v75, s[4:7], s17 offen offset:0 sc1
    buffer_store_dword v72, v75, s[4:7], s17 offen offset:1024 sc1
    buffer_store_dword v72, v75, s[4:7], s17 offen offset:2048 sc1
    buffer_store_dword v72, v75, s[4:7], s17 offen offset:3072 sc1
    s_mov_b64 exec, -1
    s_cbranch_scc1 cs_f2_rx
    s_sub_u32 s31, s31, 1
    s_cbranch_scc0 cs_f2_spin
cs_f2_rx:
    v_mov_b64 v[0:1], 0
    v_mov_b64 v[2:3], 0
    v_mov_b64 v[4:5], 0
    v_mov_b64 v[6:7], 0
    s_branch cs_loop
cs_spinB:
    s_waitcnt vmcnt(3)
cs_spinB_l:
    v_bitop3_b32 v77, v44, v45, s70 bitop3:0x7e
    v_bitop3_b32 v77, v77, v46, s70 bitop3:0xf6
    v_bitop3_b32 v77, v77, v47, s70 bitop3:0xf6
    v_and_b32 v77, s36, v77
    v_cmp_ne_u32 vcc, 0, v77
    s_cbranch_vccz cs_spinB_x
    buffer_load_dwordx4 v[44:47], v65, s[4:7], s15 offen sc1
    s_sub_u32 s31, s31, 16
    s_waitcnt vmcnt(0)
    s_cbranch_scc0 cs_spinB_l
cs_spinB_x:
    ds_write_b128 v65, v[44:47] offset:4096
    s_waitcnt lgkmcnt(0)
    s_branch cs_backB
cs_spin8:
    buffer_load_dwordx4 v[40:43], v65, s[4:7], s16 offen sc1
cs_spin8_l:
    s_waitcnt vmcnt(0)
    v_bitop3_b32 v77, v40, v41, s70 bitop3:0x7e
    v_bitop3_b32 v77, v77, v42, s70 bitop3:0xf6
    v_bitop3_b32 v77, v77, v43, s70 bitop3:0xf6
    v_and_b32 v77, s36, v77
    v_cmp_ne_u32 vcc, 0, v77
    s_cbranch_vccz cs_spin8_x
    s_nop 15
    s_nop 15
    s_nop 15
    s_nop 11
    buffer_load_dwordx4 v[40:43], v65, s[4:7], s16 offen sc1
    s_sub_u32 s31, s31, 16
    s_cbranch_scc0 cs_spin8_l
cs_spin8_x:
    s_branch cs_back8
cs_rare:
    s_mov_b64 exec, s[34:35]
    buffer_store_dwordx4 v[0:3], v65, s[4:7], s28 offen sc1
    s_mov_b64 exec, -1
    s_nop 3
    v_cvt_pk_bf16_f32 v52, v16, v17
    v_cvt_pk_bf16_f32 v53, v18, v19
    v_cvt_pk_bf16_f32 v54, v20, v21
    v_cvt_pk_bf16_f32 v55, v22, v23
    buffer_store_dwordx4 v[52:55], v65, s[4:7], s27 offen sc1
    s_add_u32 s28, s28, 131072
    s_add_u32 s27, s27, 131072
    s_cmp_eq_u32 s30, 63
    s_cbranch_scc1 cs_last
    s_branch cs_rare_x
cs_kvwait:
    s_mov_b32 s41, s97
    v_bfe_u32 v78, v65, 4, 3
    v_lshlrev_b32 v78, 7, v78
    v_mov_b32 v77, v76
    s_nop 1
    v_permlane32_swap_b32 v76, v77
    v_subrev_u32 v77, s95, v77
    v_cmp_lt_u32 vcc, 16, v77
    s_nop 1
    v_cndmask_b32 v77, v77, 0, vcc
    v_bfe_u32 v79, v78, 7, 2
    v_lshl_add_u32 v77, v77, 2, v79
    s_nop 1
    v_min_u32_dpp v77, v77, v77 row_ror:1 row_mask:0xf bank_mask:0xf
    s_nop 1
    v_min_u32_dpp v77, v77, v77 row_ror:2 row_mask:0xf bank_mask:0xf
    s_nop 1
    v_min_u32_dpp v77, v77, v77 row_ror:4 row_mask:0xf bank_mask:0xf
    s_nop 0
    v_readfirstlane_b32 s97, v77
    s_nop 0
    s_max_u32 s97, s97, s41
    s_add_u32 s40, s30, 3
    s_min_u32 s40, s40, 64
    s_cmp_le_u32 s40, s97
    s_cbranch_scc1 cs_kvw_x
    v_bfe_u32 v78, v65, 4, 3
    v_lshlrev_b32 v78, 7, v78
    s_mov_b32 s31, 4194304
cs_kvw:
    buffer_load_dword v77, v78, s[4:7], s96 offen sc1
    s_waitcnt vmcnt(0)
    v_subrev_u32 v77, s95, v77
    v_cmp_lt_u32 vcc, 16, v77
    s_nop 1
    v_cndmask_b32 v77, v77, 0, vcc
    v_bfe_u32 v79, v78, 7, 2
    v_lshl_add_u32 v77, v77, 2, v79
    s_nop 1
    v_min_u32_dpp v77, v77, v77 row_ror:1 row_mask:0xf bank_mask:0xf
    s_nop 1
    v_min_u32_dpp v77, v77, v77 row_ror:2 row_mask:0xf bank_mask:0xf
    s_nop 1
    v_min_u32_dpp v77, v77, v77 row_ror:4 row_mask:0xf bank_mask:0xf
    s_nop 0
    v_readfirstlane_b32 s97, v77
    s_sub_u32 s31, s31, 1
    s_cbranch_scc1 cs_kvw_x
    s_cmp_le_u32 s40, s97
    s_cbranch_scc1 cs_kvw_x
    s_sleep 2
    s_branch cs_kvw
cs_kvw_x:
    s_branch cs_kvok
cs_last:
    s_add_u32 s40, s95, 64
    v_mov_b32 v78, s40
    s_waitcnt vmcnt(0)
    s_barrier
    s_mov_b64 exec, s[100:101]
    buffer_store_dword v78, off, s[4:7], s29 sc1
    s_mov_b64 exec, -1
cs_end:
    s_endpgm
L_xform:
    v_and_b32 v1, 63, v0
    v_and_b32 v2, 15, v1
    v_lshrrev_b32 v3, 4, v1
    v_mov_b32 v7, 0x05040100
    v_mov_b32 v8, 0x07060302
    v_lshrrev_b32 v9, 6, v0
    v_lshlrev_b32 v9, 14, v9
    v_lshlrev_b32 v10, 4, v1
    v_add_u32 v11, v9, v10
    s_mov_b32 s10, 4718592
    s_mov_b32 s11, 0x20000
    s_mov_b64 s[8:9], s[58:59]
xf_f:
    s_sub_u32 s17, s16, 1504
    s_and_b32 s18, s17, 127
    s_lshr_b32 s17, s17, 7
    s_lshl_b32 s19, s17, 4
    v_add_u32 v6, s19, v2
    v_mul_u32_u24 v4, 9216, v3
    v_lshl_add_u32 v4, v6, 4, v4
    v_lshrrev_b32 v5, 2, v2
    v_lshlrev_b32 v5, 11, v5
    v_lshl_add_u32 v5, v3, 8, v5
    v_and_b32 v1, 3, v6
    v_lshl_add_u32 v5, v1, 6, v5
    v_add_u32 v5, v5, v9
    v_cmp_gt_u32 vcc, 72, v6
    s_nop 0
    s_mov_b64 exec, vcc
    s_mul_i32 s20, s18, 36864
    s_add_u32 s21, s20, 0
    buffer_load_dwordx4 v[12:15], v4, s[8:11], s21 offen
    s_add_u32 s21, s20, 1152
    buffer_load_dwordx4 v[16:19], v4, s[8:11], s21 offen
    s_add_u32 s21, s20, 2304
    buffer_load_dwordx4 v[20:23], v4, s[8:11], s21 offen
    s_add_u32 s21, s20, 3456
    buffer_load_dwordx4 v[24:27], v4, s[8:11], s21 offen
    s_add_u32 s21, s20, 4608
    buffer_load_dwordx4 v[28:31], v4, s[8:11], s21 offen
    s_add_u32 s21, s20, 5760
    buffer_load_dwordx4 v[32:35], v4, s[8:11], s21 offen
    s_add_u32 s21, s20, 6912
    buffer_load_dwordx4 v[36:39], v4, s[8:11], s21 offen
    s_add_u32 s21, s20, 8064
    buffer_load_dwordx4 v[40:43], v4, s[8:11], s21 offen
    s_lshl_b32 s20, s18, 11
    s_add_u32 s20, s20, 130023424
    s_waitcnt vmcnt(0)
    v_perm_b32 v76, v16, v12, v7
    v_perm_b32 v77, v24, v20, v7
    v_perm_b32 v78, v32, v28, v7
    v_perm_b32 v79, v40, v36, v7
    ds_write_b128 v5, v[76:79] offset:0
    v_perm_b32 v80, v17, v13, v7
    v_perm_b32 v81, v25, v21, v7
    v_perm_b32 v82, v33, v29, v7
    v_perm_b32 v83, v41, v37, v7
    ds_write_b128 v5, v[80:83] offset:16
    v_perm_b32 v84, v18, v14, v7
    v_perm_b32 v85, v26, v22, v7
    v_perm_b32 v86, v34, v30, v7
    v_perm_b32 v87, v42, v38, v7
    ds_write_b128 v5, v[84:87] offset:32
    v_perm_b32 v88, v19, v15, v7
    v_perm_b32 v89, v27, v23, v7
    v_perm_b32 v90, v35, v31, v7
    v_perm_b32 v91, v43, v39, v7
    ds_write_b128 v5, v[88:91] offset:48
    v_perm_b32 v92, v16, v12, v8
    v_perm_b32 v93, v24, v20, v8
    v_perm_b32 v94, v32, v28, v8
    v_perm_b32 v95, v40, v36, v8
    ds_write_b128 v5, v[92:95] offset:1024
    v_perm_b32 v96, v17, v13, v8
    v_perm_b32 v97, v25, v21, v8
    v_perm_b32 v98, v33, v29, v8
    v_perm_b32 v99, v41, v37, v8
    ds_write_b128 v5, v[96:99] offset:1040
    v_perm_b32 v100, v18, v14, v8
    v_perm_b32 v101, v26, v22, v8
    v_perm_b32 v102, v34, v30, v8
    v_perm_b32 v103, v42, v38, v8
    ds_write_b128 v5, v[100:103] offset:1056
    v_perm_b32 v104, v19, v15, v8
    v_perm_b32 v105, v27, v23, v8
    v_perm_b32 v106, v35, v31, v8
    v_perm_b32 v107, v43, v39, v8
    ds_write_b128 v5, v[104:107] offset:1072
    s_mov_b64 exec, -1
    s_lshl_b32 s21, s17, 20
    s_add_u32 s20, s20, s21
    s_waitcnt lgkmcnt(0)
    ds_read_b128 v[76:79], v11 offset:0
    ds_read_b128 v[80:83], v11 offset:1024
    ds_read_b128 v[84:87], v11 offset:2048
    ds_read_b128 v[88:91], v11 offset:3072
    ds_read_b128 v[92:95], v11 offset:4096
    ds_read_b128 v[96:99], v11 offset:5120
    ds_read_b128 v[100:103], v11 offset:6144
    ds_read_b128 v[104:107], v11 offset:7168
    s_add_u32 s19, s20, 0
    s_waitcnt lgkmcnt(7)
    buffer_store_dwordx4 v[76:79], v10, s[4:7], s19 offen sc1
    s_add_u32 s19, s20, 1024
    s_waitcnt lgkmcnt(6)
    buffer_store_dwordx4 v[80:83], v10, s[4:7], s19 offen sc1
    s_add_u32 s19, s20, 262144
    s_waitcnt lgkmcnt(5)
    buffer_store_dwordx4 v[84:87], v10, s[4:7], s19 offen sc1
    s_add_u32 s19, s20, 263168
    s_waitcnt lgkmcnt(4)
    buffer_store_dwordx4 v[88:91], v10, s[4:7], s19 offen sc1
    s_add_u32 s19, s20, 524288
    s_waitcnt lgkmcnt(3)
    buffer_store_dwordx4 v[92:95], v10, s[4:7], s19 offen sc1
    s_add_u32 s19, s20, 525312
    s_waitcnt lgkmcnt(2)
    buffer_store_dwordx4 v[96:99], v10, s[4:7], s19 offen sc1
    s_add_u32 s19, s20, 786432
    s_waitcnt lgkmcnt(1)
    buffer_store_dwordx4 v[100:103], v10, s[4:7], s19 offen sc1
    s_add_u32 s19, s20, 787456
    s_waitcnt lgkmcnt(0)
    buffer_store_dwordx4 v[104:107], v10, s[4:7], s19 offen sc1
xf_done:
    s_nop 1
    s_setpc_b64 s[46:47]
L_helper:
    s_load_dwordx16 s[64:79], s[0:1], 64
    s_waitcnt lgkmcnt(0)
    s_mov_b32 s93, 1000
    s_mov_b32 s95, 0
    s_cmp_lg_u32 s3, 2
    s_cbranch_scc1 L_qkv_next
    s_mov_b32 s37, 24
    v_mov_b32 v250, 1
    v_mov_b32 v251, 163832
    v_cmp_eq_u32 vcc, 0, v0
    s_nop 0
    s_and_saveexec_b64 s[38:39], vcc
    s_cbranch_execz tk3
    buffer_atomic_add v250, off, s[84:87], s37 sc0
    s_waitcnt vmcnt(0)
    ds_write_b32 v251, v250
    s_waitcnt lgkmcnt(0)
tk3:
    s_mov_b64 exec, -1
    s_barrier
    ds_read_b32 v252, v251
    s_waitcnt lgkmcnt(0)
    v_readfirstlane_b32 s36, v252
    s_barrier
    s_nop 3
    s_cmp_ge_u32 s36, 32
    s_cbranch_scc1 L_qkv_next
    s_mov_b32 s93, 0
    s_cmp_eq_u32 s36, 0
    s_cbranch_scc1 L_relay
    s_branch L_wf_next
L_qkv_next:
    s_sub_u32 s46, s3, 2
    s_cmp_lt_u32 s3, 2
    s_cselect_b32 s46, s3, s46
    s_cmp_lt_u32 s46, 6
    s_cselect_b32 s46, s46, 0
    s_mov_b32 s47, 6
L_qq:
    s_lshl_b32 s40, s46, 2
    s_add_u32 s40, s40, 32
    s_mov_b32 s37, s40
    v_mov_b32 v250, 1
    v_mov_b32 v251, 163832
    v_cmp_eq_u32 vcc, 0, v0
    s_nop 0
    s_and_saveexec_b64 s[38:39], vcc
    s_cbranch_execz tk4
    buffer_atomic_add v250, off, s[84:87], s37 sc0
    s_waitcnt vmcnt(0)
    ds_write_b32 v251, v250
    s_waitcnt lgkmcnt(0)
tk4:
    s_mov_b64 exec, -1
    s_barrier
    ds_read_b32 v252, v251
    s_waitcnt lgkmcnt(0)
    v_readfirstlane_b32 s36, v252
    s_barrier
    s_nop 3
    s_or_b32 s37, s36, s32
    s_cbranch_scc1 L_non
    s_memrealtime s[90:91]
    s_waitcnt lgkmcnt(0)
    s_lshl_b32 s90, s90, 8
    s_or_b32 s90, s90, 1
    v_mov_b32 v250, s90
    v_mov_b32 v251, 0
    s_mov_b64 exec, 1
    buffer_atomic_cmpswap v[250:251], off, s[84:87], 0 offset:216
    s_mov_b64 exec, -1
L_non:
    s_cmp_lt_u32 s36, 32
    s_cbranch_scc1 L_qkv
    s_add_u32 s46, s46, 1
    s_cmp_lt_u32 s46, 6
    s_cselect_b32 s46, s46, 0
    s_sub_u32 s47, s47, 1
    s_cmp_lg_u32 s47, 0
    s_cbranch_scc1 L_qq
    s_mov_b32 s37, 4
    v_mov_b32 v250, 1
    v_mov_b32 v251, 163832
    v_cmp_eq_u32 vcc, 0, v0
    s_nop 0
    s_and_saveexec_b64 s[38:39], vcc
    s_cbranch_execz tk5
    buffer_atomic_add v250, off, s[84:87], s37 sc0
    s_waitcnt vmcnt(0)
    ds_write_b32 v251, v250
    s_waitcnt lgkmcnt(0)
tk5:
    s_mov_b64 exec, -1
    s_barrier
    ds_read_b32 v252, v251
    s_waitcnt lgkmcnt(0)
    v_readfirstlane_b32 s45, v252
    s_barrier
    s_nop 3
    s_cmp_lg_u32 s95, 0
    s_cbranch_scc1 L_hn
    s_mov_b32 s88, 4194304
gn6:
    buffer_load_dword v250, off, s[84:87], 0 offset:216 sc1
    s_waitcnt vmcnt(0)
    v_readfirstlane_b32 s95, v250
    s_sub_u32 s88, s88, 1
    s_cbranch_scc1 gn6x
    s_cmp_eq_u32 s95, 0
    s_cbranch_scc1 gn6
gn6x:
L_hn:
    s_cmp_lg_u32 s45, 0
    s_cbranch_scc1 L_phase2
    s_mov_b32 s37, 24
    v_mov_b32 v250, 1
    v_mov_b32 v251, 163832
    v_cmp_eq_u32 vcc, 0, v0
    s_nop 0
    s_and_saveexec_b64 s[38:39], vcc
    s_cbranch_execz tk7
    buffer_atomic_add v250, off, s[84:87], s37 sc0
    s_waitcnt vmcnt(0)
    ds_write_b32 v251, v250
    s_waitcnt lgkmcnt(0)
tk7:
    s_mov_b64 exec, -1
    s_barrier
    ds_read_b32 v252, v251
    s_waitcnt lgkmcnt(0)
    v_readfirstlane_b32 s36, v252
    s_barrier
    s_nop 3
    s_cmp_lg_u32 s36, 0
    s_cbranch_scc1 L_phase2
L_relay:
    s_cmp_lg_u32 s32, 0
    s_cbranch_scc1 L_exit
    s_sleep 100
    s_mov_b32 s88, 4194304
gn8:
    buffer_load_dword v250, off, s[84:87], 0 offset:216 sc1
    s_waitcnt vmcnt(0)
    v_readfirstlane_b32 s95, v250
    s_sub_u32 s88, s88, 1
    s_cbranch_scc1 gn8x
    s_cmp_eq_u32 s95, 0
    s_cbranch_scc1 gn8
gn8x:
    v_and_b32 v3, 31, v0
    v_lshlrev_b32 v3, 7, v3
    s_mov_b32 s17, 0
    s_mov_b32 s23, 125845504
    s_mov_b32 s24, 125853696
    s_mov_b32 s21, 16777216
rl_rwait:
    buffer_load_dword v4, v3, s[4:7], s23 offen sc1
    s_waitcnt vmcnt(0)
    v_subrev_u32 v4, s95, v4
    v_cmp_lt_u32 vcc, 64, v4
    s_nop 1
    v_cndmask_b32 v4, v4, 0, vcc
    s_nop 1
    v_min_u32_dpp v4, v4, v4 row_ror:1 row_mask:0xf bank_mask:0xf
    s_nop 1
    v_min_u32_dpp v4, v4, v4 row_ror:2 row_mask:0xf bank_mask:0xf
    s_nop 1
    v_min_u32_dpp v4, v4, v4 row_ror:4 row_mask:0xf bank_mask:0xf
    s_nop 1
    v_min_u32_dpp v4, v4, v4 row_ror:8 row_mask:0xf bank_mask:0xf
    s_nop 0
    v_readlane_b32 s16, v4, 0
    v_readlane_b32 s22, v4, 16
    s_nop 0
    s_min_u32 s16, s16, s22
    s_sub_u32 s21, s21, 1
    s_cbranch_scc1 rl_x
    s_cmp_gt_u32 s16, s17
    s_cbranch_scc1 rl_rpub
    s_sleep 2
    s_branch rl_rwait
rl_rpub:
    s_mov_b32 s17, s16
    s_add_u32 s22, s16, s95
    v_mov_b32 v4, s22
    s_mov_b64 exec, 1
    buffer_store_dword v4, off, s[4:7], s24 sc1
    s_mov_b64 exec, -1
    s_cmp_lt_u32 s16, 64
    s_cbranch_scc1 rl_rwait
rl_x:
    s_endpgm
L_qkv:
    s_and_b32 s37, s36, 3
    s_lshr_b32 s36, s36, 2
    s_lshl_b32 s40, s46, 3
    s_add_u32 s36, s36, s40
    s_lshr_b32 s40, s36, 4
    s_and_b32 s36, s36, 15
    s_lshl_b32 s41, s37, 1
    s_add_u32 s41, s41, s40
    s_add_u32 s37, s37, 8
    s_cmp_eq_u32 s40, 2
    s_cselect_b32 s41, s37, s41
    s_lshl_b32 s41, s41, 4
    s_add_u32 s36, s36, s41
    s_sub_u32 s33, s36, 32
    s_and_b32 s17, s36, 15
    s_lshl_b32 s17, s17, 1
    s_lshr_b32 s36, s36, 4
    s_and_b32 s16, s36, 1
    s_add_u32 s16, s16, 1
    s_lshr_b32 s19, s36, 1
    s_and_b32 s37, s36, 3
    s_cmp_ge_u32 s36, 8
    s_cselect_b32 s16, 0, s16
    s_cselect_b32 s19, s37, s19
    v_lshrrev_b32 v4, 6, v0
    s_nop 0
    v_readfirstlane_b32 s18, v4
    v_lshlrev_b32 v7, 4, v0
    s_cmp_eq_u32 s16, 1
    s_cselect_b64 s[12:13], s[54:55], s[52:53]
    s_cmp_eq_u32 s16, 2
    s_cselect_b64 s[12:13], s[56:57], s[12:13]
    s_mov_b32 s14, 4718592
    s_mov_b32 s15, 0x20000
    v_bfe_u32 v4, v0, 5, 1
    v_lshlrev_b32 v5, 2, v4
    v_and_b32 v8, 31, v0
    v_xor_b32 v8, v8, v5
    v_lshlrev_b32 v8, 4, v8
    v_lshl_add_u32 v8, v4, 13, v8
    v_xor_b32 v9, 128, v8
    s_lshl_b32 s21, s17, 8
    s_lshl_b32 s42, s18, 16
    s_add_u32 s42, s42, s21
    s_lshl_b32 s44, s18, 12
    s_barrier
    s_add_u32 m0, s44, 73728
    s_add_u32 s22, s42, 0
    buffer_load_dwordx4 v8, s[12:15], s22 offen offset:0 lds
    s_add_u32 s22, s42, 15360
    buffer_load_dwordx4 v9, s[12:15], s22 offen offset:1024 lds
    s_add_u32 s22, s42, 30720
    buffer_load_dwordx4 v8, s[12:15], s22 offen offset:2048 lds
    s_add_u32 s22, s42, 46080
    buffer_load_dwordx4 v9, s[12:15], s22 offen offset:3072 lds
    s_add_u32 m0, s44, 90112
    s_add_u32 s22, s42, 1048576
    buffer_load_dwordx4 v8, s[12:15], s22 offen offset:0 lds
    s_add_u32 s22, s42, 1063936
    buffer_load_dwordx4 v9, s[12:15], s22 offen offset:1024 lds
    s_add_u32 s22, s42, 1079296
    buffer_load_dwordx4 v8, s[12:15], s22 offen offset:2048 lds
    s_add_u32 s22, s42, 1094656
    buffer_load_dwordx4 v9, s[12:15], s22 offen offset:3072 lds
    s_add_u32 m0, s44, 106496
    s_add_u32 s22, s42, 2097152
    buffer_load_dwordx4 v8, s[12:15], s22 offen offset:0 lds
    s_add_u32 s22, s42, 2112512
    buffer_load_dwordx4 v9, s[12:15], s22 offen offset:1024 lds
    s_add_u32 s22, s42, 2127872
    buffer_load_dwordx4 v8, s[12:15], s22 offen offset:2048 lds
    s_add_u32 s22, s42, 2143232
    buffer_load_dwordx4 v9, s[12:15], s22 offen offset:3072 lds
    s_add_u32 m0, s44, 122880
    s_add_u32 s22, s42, 3145728
    buffer_load_dwordx4 v8, s[12:15], s22 offen offset:0 lds
    s_add_u32 s22, s42, 3161088
    buffer_load_dwordx4 v9, s[12:15], s22 offen offset:1024 lds
    s_add_u32 s22, s42, 3176448
    buffer_load_dwordx4 v8, s[12:15], s22 offen offset:2048 lds
    s_add_u32 s22, s42, 3191808
    buffer_load_dwordx4 v9, s[12:15], s22 offen offset:3072 lds
    v_bfe_u32 v4, v0, 2, 2
    v_xor_b32 v5, s18, v4
    v_lshlrev_b32 v10, 6, v5
    v_lshl_add_u32 v10, v4, 9, v10
    v_and_b32 v4, 3, v0
    v_lshl_add_u32 v10, v4, 4, v10
    v_bfe_u32 v4, v0, 4, 2
    v_lshl_add_u32 v10, v4, 12, v10
    v_add_u32 v10, 73728, v10
    v_add_u32 v11, 49152, v10
    v_and_b32 v4, 63, v0
    v_and_b32 v5, 15, v4
    v_lshrrev_b32 v3, 4, v4
    v_lshrrev_b32 v2, 2, v5
    v_xor_b32 v3, v3, v2
    v_lshl_add_u32 v3, v5, 2, v3
    v_lshlrev_b32 v1, 4, v3
    v_lshrrev_b32 v5, 2, v4
    v_lshrrev_b32 v3, 4, v4
    v_and_b32 v4, 3, v4
    v_xor_b32 v4, v4, v3
    v_lshlrev_b32 v3, 3, v3
    v_and_b32 v5, 3, v5
    v_add_u32 v3, v3, v5
    v_mul_u32_u24 v2, 1152, v3
    v_lshl_add_u32 v2, v4, 4, v2
    s_mov_b32 s8, s48
    s_mov_b32 s9, s49
    s_mov_b32 s10, 2359296
    s_mov_b32 s11, 0x20000
    s_lshr_b32 s22, s18, 1
    s_mul_i32 s24, s22, 4608
    s_mul_i32 s25, s22, 18432
    s_and_b32 s22, s18, 1
    s_mul_i32 s23, s22, 576
    s_add_u32 s24, s24, s23
    s_mul_i32 s25, s18, 9216
    s_mul_i32 s22, s19, 36864
    s_add_u32 s24, s24, s22
    s_mov_b32 s20, 64
    s_lshl_b32 s22, s19, 5
    s_add_u32 s22, s22, s17
    s_lshl_b32 s26, s22, 14
    s_mul_i32 s23, s18, 3072
    s_add_u32 s26, s26, s23
    s_lshl_b32 s23, s16, 11
    s_add_u32 s26, s26, s23
    s_add_u32 s26, s26, -2048
    s_lshl_b32 s22, s22, 13
    s_add_u32 s22, s22, 33554432
    s_cmp_eq_u32 s16, 0
    s_cselect_b32 s26, s22, s26
    s_cselect_b32 s40, 4096, 64
    s_cselect_b32 s41, 1, 2
    s_max_u32 s40, s40, 1024
    s_lshl_b32 s41, s41, 18
    s_lshl_b32 s29, s17, 10
    s_lshl_b32 s22, s16, 9
    s_add_u32 s29, s29, s22
    s_lshl_b32 s22, s19, 7
    s_add_u32 s29, s29, s22
    s_add_u32 s29, s29, 126091264
    s_mov_b32 s27, 0
    s_add_u32 s23, s27, s25
    s_add_u32 m0, s23, 0
    s_nop 0
    buffer_load_dwordx4 v2, s[8:11], s24 offen offset:0 lds
    s_add_u32 m0, s23, 960
    s_nop 0
    buffer_load_dwordx4 v2, s[8:11], s24 offen offset:64 lds
    s_add_u32 m0, s23, 1920
    s_nop 0
    buffer_load_dwordx4 v2, s[8:11], s24 offen offset:128 lds
    s_add_u32 m0, s23, 2880
    s_nop 0
    buffer_load_dwordx4 v2, s[8:11], s24 offen offset:192 lds
    s_add_u32 m0, s23, 3840
    s_nop 0
    buffer_load_dwordx4 v2, s[8:11], s24 offen offset:256 lds
    s_add_u32 m0, s23, 4800
    s_nop 0
    buffer_load_dwordx4 v2, s[8:11], s24 offen offset:320 lds
    s_add_u32 m0, s23, 5760
    s_nop 0
    buffer_load_dwordx4 v2, s[8:11], s24 offen offset:384 lds
    s_add_u32 m0, s23, 6720
    s_nop 0
    buffer_load_dwordx4 v2, s[8:11], s24 offen offset:448 lds
    s_add_u32 m0, s23, 7680
    s_nop 0
    buffer_load_dwordx4 v2, s[8:11], s24 offen offset:512 lds
    s_add_u32 s24, s24, 147456
    s_waitcnt vmcnt(21) lgkmcnt(0)
    s_barrier
    s_add_u32 m0, s44, 139264
    s_add_u32 s22, s42, 262144
    buffer_load_dwordx4 v8, s[12:15], s22 offen offset:0 lds
    s_add_u32 s22, s42, 277504
    buffer_load_dwordx4 v9, s[12:15], s22 offen offset:1024 lds
    s_add_u32 s22, s42, 292864
    buffer_load_dwordx4 v8, s[12:15], s22 offen offset:2048 lds
    s_add_u32 s22, s42, 308224
    buffer_load_dwordx4 v9, s[12:15], s22 offen offset:3072 lds
    ds_read_b64_tr_b16 v[64:65], v10 offset:0
    ds_read_b64_tr_b16 v[66:67], v10 offset:2048
    ds_read_b64_tr_b16 v[136:137], v10 offset:8
    ds_read_b64_tr_b16 v[138:139], v10 offset:2056
    ds_read_b64_tr_b16 a[0:1], v10 offset:256
    ds_read_b64_tr_b16 a[2:3], v10 offset:2304
    ds_read_b64_tr_b16 a[72:73], v10 offset:264
    ds_read_b64_tr_b16 a[74:75], v10 offset:2312
    s_waitcnt vmcnt(21) lgkmcnt(0)
    s_barrier
    s_add_u32 m0, s44, 73728
    s_add_u32 s22, s42, 1310720
    buffer_load_dwordx4 v8, s[12:15], s22 offen offset:0 lds
    s_add_u32 s22, s42, 1326080
    buffer_load_dwordx4 v9, s[12:15], s22 offen offset:1024 lds
    s_add_u32 s22, s42, 1341440
    buffer_load_dwordx4 v8, s[12:15], s22 offen offset:2048 lds
    s_add_u32 s22, s42, 1356800
    buffer_load_dwordx4 v9, s[12:15], s22 offen offset:3072 lds
    ds_read_b64_tr_b16 v[80:81], v10 offset:16384
    ds_read_b64_tr_b16 v[82:83], v10 offset:18432
    ds_read_b64_tr_b16 v[152:153], v10 offset:16392
    ds_read_b64_tr_b16 v[154:155], v10 offset:18440
    ds_read_b64_tr_b16 a[16:17], v10 offset:16640
    ds_read_b64_tr_b16 a[18:19], v10 offset:18688
    ds_read_b64_tr_b16 a[88:89], v10 offset:16648
    ds_read_b64_tr_b16 a[90:91], v10 offset:18696
    s_waitcnt vmcnt(21) lgkmcnt(0)
    s_barrier
    s_add_u32 m0, s44, 90112
    s_add_u32 s22, s42, 2359296
    buffer_load_dwordx4 v8, s[12:15], s22 offen offset:0 lds
    s_add_u32 s22, s42, 2374656
    buffer_load_dwordx4 v9, s[12:15], s22 offen offset:1024 lds
    s_add_u32 s22, s42, 2390016
    buffer_load_dwordx4 v8, s[12:15], s22 offen offset:2048 lds
    s_add_u32 s22, s42, 2405376
    buffer_load_dwordx4 v9, s[12:15], s22 offen offset:3072 lds
    ds_read_b64_tr_b16 v[96:97], v10 offset:32768
    ds_read_b64_tr_b16 v[98:99], v10 offset:34816
    ds_read_b64_tr_b16 v[168:169], v10 offset:32776
    ds_read_b64_tr_b16 v[170:171], v10 offset:34824
    ds_read_b64_tr_b16 a[32:33], v10 offset:33024
    ds_read_b64_tr_b16 a[34:35], v10 offset:35072
    ds_read_b64_tr_b16 a[104:105], v10 offset:33032
    ds_read_b64_tr_b16 a[106:107], v10 offset:35080
    s_waitcnt vmcnt(21) lgkmcnt(0)
    s_barrier
    s_add_u32 m0, s44, 106496
    s_add_u32 s22, s42, 3407872
    buffer_load_dwordx4 v8, s[12:15], s22 offen offset:0 lds
    s_add_u32 s22, s42, 3423232
    buffer_load_dwordx4 v9, s[12:15], s22 offen offset:1024 lds
    s_add_u32 s22, s42, 3438592
    buffer_load_dwordx4 v8, s[12:15], s22 offen offset:2048 lds
    s_add_u32 s22, s42, 3453952
    buffer_load_dwordx4 v9, s[12:15], s22 offen offset:3072 lds
    ds_read_b64_tr_b16 v[112:113], v11 offset:0
    ds_read_b64_tr_b16 v[114:115], v11 offset:2048
    ds_read_b64_tr_b16 v[184:185], v11 offset:8
    ds_read_b64_tr_b16 v[186:187], v11 offset:2056
    ds_read_b64_tr_b16 a[48:49], v11 offset:256
    ds_read_b64_tr_b16 a[50:51], v11 offset:2304
    ds_read_b64_tr_b16 a[120:121], v11 offset:264
    ds_read_b64_tr_b16 a[122:123], v11 offset:2312
    s_waitcnt vmcnt(12) lgkmcnt(0)
    s_barrier
    s_add_u32 m0, s44, 122880
    s_add_u32 s22, s42, 524288
    buffer_load_dwordx4 v8, s[12:15], s22 offen offset:0 lds
    s_add_u32 s22, s42, 539648
    buffer_load_dwordx4 v9, s[12:15], s22 offen offset:1024 lds
    s_add_u32 s22, s42, 555008
    buffer_load_dwordx4 v8, s[12:15], s22 offen offset:2048 lds
    s_add_u32 s22, s42, 570368
    buffer_load_dwordx4 v9, s[12:15], s22 offen offset:3072 lds
    ds_read_b64_tr_b16 v[68:69], v11 offset:16384
    ds_read_b64_tr_b16 v[70:71], v11 offset:18432
    ds_read_b64_tr_b16 v[140:141], v11 offset:16392
    ds_read_b64_tr_b16 v[142:143], v11 offset:18440
    ds_read_b64_tr_b16 a[4:5], v11 offset:16640
    ds_read_b64_tr_b16 a[6:7], v11 offset:18688
    ds_read_b64_tr_b16 a[76:77], v11 offset:16648
    ds_read_b64_tr_b16 a[78:79], v11 offset:18696
    s_waitcnt vmcnt(12) lgkmcnt(0)
    s_barrier
    s_add_u32 m0, s44, 139264
    s_add_u32 s22, s42, 1572864
    buffer_load_dwordx4 v8, s[12:15], s22 offen offset:0 lds
    s_add_u32 s22, s42, 1588224
    buffer_load_dwordx4 v9, s[12:15], s22 offen offset:1024 lds
    s_add_u32 s22, s42, 1603584
    buffer_load_dwordx4 v8, s[12:15], s22 offen offset:2048 lds
    s_add_u32 s22, s42, 1618944
    buffer_load_dwordx4 v9, s[12:15], s22 offen offset:3072 lds
    ds_read_b64_tr_b16 v[84:85], v10 offset:0
    ds_read_b64_tr_b16 v[86:87], v10 offset:2048
    ds_read_b64_tr_b16 v[156:157], v10 offset:8
    ds_read_b64_tr_b16 v[158:159], v10 offset:2056
    ds_read_b64_tr_b16 a[20:21], v10 offset:256
    ds_read_b64_tr_b16 a[22:23], v10 offset:2304
    ds_read_b64_tr_b16 a[92:93], v10 offset:264
    ds_read_b64_tr_b16 a[94:95], v10 offset:2312
    s_waitcnt vmcnt(12) lgkmcnt(0)
    s_barrier
    s_add_u32 m0, s44, 73728
    s_add_u32 s22, s42, 2621440
    buffer_load_dwordx4 v8, s[12:15], s22 offen offset:0 lds
    s_add_u32 s22, s42, 2636800
    buffer_load_dwordx4 v9, s[12:15], s22 offen offset:1024 lds
    s_add_u32 s22, s42, 2652160
    buffer_load_dwordx4 v8, s[12:15], s22 offen offset:2048 lds
    s_add_u32 s22, s42, 2667520
    buffer_load_dwordx4 v9, s[12:15], s22 offen offset:3072 lds
    ds_read_b64_tr_b16 v[100:101], v10 offset:16384
    ds_read_b64_tr_b16 v[102:103], v10 offset:18432
    ds_read_b64_tr_b16 v[172:173], v10 offset:16392
    ds_read_b64_tr_b16 v[174:175], v10 offset:18440
    ds_read_b64_tr_b16 a[36:37], v10 offset:16640
    ds_read_b64_tr_b16 a[38:39], v10 offset:18688
    ds_read_b64_tr_b16 a[108:109], v10 offset:16648
    ds_read_b64_tr_b16 a[110:111], v10 offset:18696
    s_waitcnt vmcnt(12) lgkmcnt(0)
    s_barrier
    s_add_u32 m0, s44, 90112
    s_add_u32 s22, s42, 3670016
    buffer_load_dwordx4 v8, s[12:15], s22 offen offset:0 lds
    s_add_u32 s22, s42, 3685376
    buffer_load_dwordx4 v9, s[12:15], s22 offen offset:1024 lds
    s_add_u32 s22, s42, 3700736
    buffer_load_dwordx4 v8, s[12:15], s22 offen offset:2048 lds
    s_add_u32 s22, s42, 3716096
    buffer_load_dwordx4 v9, s[12:15], s22 offen offset:3072 lds
    ds_read_b64_tr_b16 v[116:117], v10 offset:32768
    ds_read_b64_tr_b16 v[118:119], v10 offset:34816
    ds_read_b64_tr_b16 v[188:189], v10 offset:32776
    ds_read_b64_tr_b16 v[190:191], v10 offset:34824
    ds_read_b64_tr_b16 a[52:53], v10 offset:33024
    ds_read_b64_tr_b16 a[54:55], v10 offset:35072
    ds_read_b64_tr_b16 a[124:125], v10 offset:33032
    ds_read_b64_tr_b16 a[126:127], v10 offset:35080
    s_waitcnt vmcnt(12) lgkmcnt(0)
    s_barrier
    s_add_u32 m0, s44, 106496
    s_add_u32 s22, s42, 786432
    buffer_load_dwordx4 v8, s[12:15], s22 offen offset:0 lds
    s_add_u32 s22, s42, 801792
    buffer_load_dwordx4 v9, s[12:15], s22 offen offset:1024 lds
    s_add_u32 s22, s42, 817152
    buffer_load_dwordx4 v8, s[12:15], s22 offen offset:2048 lds
    s_add_u32 s22, s42, 832512
    buffer_load_dwordx4 v9, s[12:15], s22 offen offset:3072 lds
    ds_read_b64_tr_b16 v[72:73], v11 offset:0
    ds_read_b64_tr_b16 v[74:75], v11 offset:2048
    ds_read_b64_tr_b16 v[144:145], v11 offset:8
    ds_read_b64_tr_b16 v[146:147], v11 offset:2056
    ds_read_b64_tr_b16 a[8:9], v11 offset:256
    ds_read_b64_tr_b16 a[10:11], v11 offset:2304
    ds_read_b64_tr_b16 a[80:81], v11 offset:264
    ds_read_b64_tr_b16 a[82:83], v11 offset:2312
    s_waitcnt vmcnt(12) lgkmcnt(0)
    s_barrier
    s_add_u32 m0, s44, 122880
    s_add_u32 s22, s42, 1835008
    buffer_load_dwordx4 v8, s[12:15], s22 offen offset:0 lds
    s_add_u32 s22, s42, 1850368
    buffer_load_dwordx4 v9, s[12:15], s22 offen offset:1024 lds
    s_add_u32 s22, s42, 1865728
    buffer_load_dwordx4 v8, s[12:15], s22 offen offset:2048 lds
    s_add_u32 s22, s42, 1881088
    buffer_load_dwordx4 v9, s[12:15], s22 offen offset:3072 lds
    ds_read_b64_tr_b16 v[88:89], v11 offset:16384
    ds_read_b64_tr_b16 v[90:91], v11 offset:18432
    ds_read_b64_tr_b16 v[160:161], v11 offset:16392
    ds_read_b64_tr_b16 v[162:163], v11 offset:18440
    ds_read_b64_tr_b16 a[24:25], v11 offset:16640
    ds_read_b64_tr_b16 a[26:27], v11 offset:18688
    ds_read_b64_tr_b16 a[96:97], v11 offset:16648
    ds_read_b64_tr_b16 a[98:99], v11 offset:18696
    s_waitcnt vmcnt(12) lgkmcnt(0)
    s_barrier
    s_add_u32 m0, s44, 139264
    s_add_u32 s22, s42, 2883584
    buffer_load_dwordx4 v8, s[12:15], s22 offen offset:0 lds
    s_add_u32 s22, s42, 2898944
    buffer_load_dwordx4 v9, s[12:15], s22 offen offset:1024 lds
    s_add_u32 s22, s42, 2914304
    buffer_load_dwordx4 v8, s[12:15], s22 offen offset:2048 lds
    s_add_u32 s22, s42, 2929664
    buffer_load_dwordx4 v9, s[12:15], s22 offen offset:3072 lds
    ds_read_b64_tr_b16 v[104:105], v10 offset:0
    ds_read_b64_tr_b16 v[106:107], v10 offset:2048
    ds_read_b64_tr_b16 v[176:177], v10 offset:8
    ds_read_b64_tr_b16 v[178:179], v10 offset:2056
    ds_read_b64_tr_b16 a[40:41], v10 offset:256
    ds_read_b64_tr_b16 a[42:43], v10 offset:2304
    ds_read_b64_tr_b16 a[112:113], v10 offset:264
    ds_read_b64_tr_b16 a[114:115], v10 offset:2312
    s_waitcnt vmcnt(12) lgkmcnt(0)
    s_barrier
    s_add_u32 m0, s44, 73728
    s_add_u32 s22, s42, 3932160
    buffer_load_dwordx4 v8, s[12:15], s22 offen offset:0 lds
    s_add_u32 s22, s42, 3947520
    buffer_load_dwordx4 v9, s[12:15], s22 offen offset:1024 lds
    s_add_u32 s22, s42, 3962880
    buffer_load_dwordx4 v8, s[12:15], s22 offen offset:2048 lds
    s_add_u32 s22, s42, 3978240
    buffer_load_dwordx4 v9, s[12:15], s22 offen offset:3072 lds
    ds_read_b64_tr_b16 v[120:121], v10 offset:16384
    ds_read_b64_tr_b16 v[122:123], v10 offset:18432
    ds_read_b64_tr_b16 v[192:193], v10 offset:16392
    ds_read_b64_tr_b16 v[194:195], v10 offset:18440
    ds_read_b64_tr_b16 a[56:57], v10 offset:16640
    ds_read_b64_tr_b16 a[58:59], v10 offset:18688
    ds_read_b64_tr_b16 a[128:129], v10 offset:16648
    ds_read_b64_tr_b16 a[130:131], v10 offset:18696
    s_waitcnt vmcnt(12) lgkmcnt(0)
    s_barrier
    s_add_u32 m0, s44, 90112
    s_add_u32 s22, s42, 4194304
    buffer_load_dwordx4 v8, s[12:15], s22 offen offset:0 lds
    s_add_u32 s22, s42, 4209664
    buffer_load_dwordx4 v9, s[12:15], s22 offen offset:1024 lds
    s_add_u32 s22, s42, 4225024
    buffer_load_dwordx4 v8, s[12:15], s22 offen offset:2048 lds
    s_add_u32 s22, s42, 4240384
    buffer_load_dwordx4 v9, s[12:15], s22 offen offset:3072 lds
    ds_read_b64_tr_b16 v[76:77], v10 offset:32768
    ds_read_b64_tr_b16 v[78:79], v10 offset:34816
    ds_read_b64_tr_b16 v[148:149], v10 offset:32776
    ds_read_b64_tr_b16 v[150:151], v10 offset:34824
    ds_read_b64_tr_b16 a[12:13], v10 offset:33024
    ds_read_b64_tr_b16 a[14:15], v10 offset:35072
    ds_read_b64_tr_b16 a[84:85], v10 offset:33032
    ds_read_b64_tr_b16 a[86:87], v10 offset:35080
    s_waitcnt vmcnt(12) lgkmcnt(0)
    s_barrier
    s_add_u32 m0, s44, 106496
    s_add_u32 s22, s42, 4456448
    buffer_load_dwordx4 v8, s[12:15], s22 offen offset:0 lds
    s_add_u32 s22, s42, 4471808
    buffer_load_dwordx4 v9, s[12:15], s22 offen offset:1024 lds
    s_add_u32 s22, s42, 4487168
    buffer_load_dwordx4 v8, s[12:15], s22 offen offset:2048 lds
    s_add_u32 s22, s42, 4502528
    buffer_load_dwordx4 v9, s[12:15], s22 offen offset:3072 lds
    ds_read_b64_tr_b16 v[92:93], v11 offset:0
    ds_read_b64_tr_b16 v[94:95], v11 offset:2048
    ds_read_b64_tr_b16 v[164:165], v11 offset:8
    ds_read_b64_tr_b16 v[166:167], v11 offset:2056
    ds_read_b64_tr_b16 a[28:29], v11 offset:256
    ds_read_b64_tr_b16 a[30:31], v11 offset:2304
    ds_read_b64_tr_b16 a[100:101], v11 offset:264
    ds_read_b64_tr_b16 a[102:103], v11 offset:2312
    s_waitcnt vmcnt(12) lgkmcnt(0)
    s_barrier
    s_mov_b32 s27, 36864
    s_add_u32 s23, s27, s25
    s_add_u32 m0, s23, 0
    s_nop 0
    buffer_load_dwordx4 v2, s[8:11], s24 offen offset:0 lds
    s_add_u32 m0, s23, 960
    s_nop 0
    buffer_load_dwordx4 v2, s[8:11], s24 offen offset:64 lds
    s_add_u32 m0, s23, 1920
    s_nop 0
    buffer_load_dwordx4 v2, s[8:11], s24 offen offset:128 lds
    s_add_u32 m0, s23, 2880
    s_nop 0
    buffer_load_dwordx4 v2, s[8:11], s24 offen offset:192 lds
    s_add_u32 m0, s23, 3840
    s_nop 0
    buffer_load_dwordx4 v2, s[8:11], s24 offen offset:256 lds
    s_add_u32 m0, s23, 4800
    s_nop 0
    buffer_load_dwordx4 v2, s[8:11], s24 offen offset:320 lds
    s_add_u32 m0, s23, 5760
    s_nop 0
    buffer_load_dwordx4 v2, s[8:11], s24 offen offset:384 lds
    s_add_u32 m0, s23, 6720
    s_nop 0
    buffer_load_dwordx4 v2, s[8:11], s24 offen offset:448 lds
    s_add_u32 m0, s23, 7680
    s_nop 0
    buffer_load_dwordx4 v2, s[8:11], s24 offen offset:512 lds
    s_add_u32 s24, s24, 147456
    ds_read_b64_tr_b16 v[108:109], v11 offset:16384
    ds_read_b64_tr_b16 v[110:111], v11 offset:18432
    ds_read_b64_tr_b16 v[180:181], v11 offset:16392
    ds_read_b64_tr_b16 v[182:183], v11 offset:18440
    ds_read_b64_tr_b16 a[44:45], v11 offset:16640
    ds_read_b64_tr_b16 a[46:47], v11 offset:18688
    ds_read_b64_tr_b16 a[116:117], v11 offset:16648
    ds_read_b64_tr_b16 a[118:119], v11 offset:18696
    s_waitcnt vmcnt(17) lgkmcnt(0)
    s_barrier
    ds_read_b64_tr_b16 v[124:125], v10 offset:0
    ds_read_b64_tr_b16 v[126:127], v10 offset:2048
    ds_read_b64_tr_b16 v[196:197], v10 offset:8
    ds_read_b64_tr_b16 v[198:199], v10 offset:2056
    ds_read_b64_tr_b16 a[60:61], v10 offset:256
    ds_read_b64_tr_b16 a[62:63], v10 offset:2304
    ds_read_b64_tr_b16 a[132:133], v10 offset:264
    ds_read_b64_tr_b16 a[134:135], v10 offset:2312
    s_waitcnt vmcnt(13) lgkmcnt(0)
    s_barrier
    ds_read_b64_tr_b16 v[128:129], v10 offset:16384
    ds_read_b64_tr_b16 v[130:131], v10 offset:18432
    ds_read_b64_tr_b16 v[200:201], v10 offset:16392
    ds_read_b64_tr_b16 v[202:203], v10 offset:18440
    ds_read_b64_tr_b16 a[64:65], v10 offset:16640
    ds_read_b64_tr_b16 a[66:67], v10 offset:18688
    ds_read_b64_tr_b16 a[136:137], v10 offset:16648
    ds_read_b64_tr_b16 a[138:139], v10 offset:18696
    s_waitcnt vmcnt(9) lgkmcnt(0)
    s_barrier
    ds_read_b64_tr_b16 v[132:133], v10 offset:32768
    ds_read_b64_tr_b16 v[134:135], v10 offset:34816
    ds_read_b64_tr_b16 v[204:205], v10 offset:32776
    ds_read_b64_tr_b16 v[206:207], v10 offset:34824
    ds_read_b64_tr_b16 a[68:69], v10 offset:33024
    ds_read_b64_tr_b16 a[70:71], v10 offset:35072
    ds_read_b64_tr_b16 a[140:141], v10 offset:33032
    ds_read_b64_tr_b16 a[142:143], v10 offset:35080
    s_mov_b32 s88, 4194304
gn9:
    buffer_load_dword v250, off, s[84:87], 0 offset:216 sc1
    s_waitcnt vmcnt(0)
    v_readfirstlane_b32 s95, v250
    s_sub_u32 s88, s88, 1
    s_cbranch_scc1 gn9x
    s_cmp_eq_u32 s95, 0
    s_cbranch_scc1 gn9
gn9x:
    s_waitcnt lgkmcnt(0)
    s_mov_b32 s45, 0
    s_mov_b32 s27, 0
    s_mov_b64 s[36:37], 0
    s_mov_b32 s12, 0
    s_mov_b32 s13, s40
    s_lshr_b32 s14, s41, 5
    s_add_u32 s15, s14, s40
    s_lshl_b32 s41, s41, 2
    s_sub_u32 s26, s26, s41
    v_mov_b32 v3, v1
    s_waitcnt vmcnt(0)
    s_barrier
    ds_read_b128 v[32:35], v3 offset:0
    ds_read_b128 v[36:39], v3 offset:18432
    ds_read_b128 v[40:43], v3 offset:1024
    ds_read_b128 v[44:47], v3 offset:19456
    s_cmp_eq_u32 s18, 0
    s_cselect_b32 s34, 1, 0
    s_mov_b32 s35, 0
    s_cmp_eq_u32 s16, 2
    s_cbranch_scc1 qk_vloop
qk_loop:
    s_barrier
    s_add_u32 s22, s27, 73728
    s_sub_u32 s21, s22, 110592
    s_cselect_b32 s22, s22, s21
    s_waitcnt lgkmcnt(2)
    v_mfma_f32_16x16x32_bf16 v[208:211], v[64:67], v[32:35], 0
    ds_read_b128 v[48:51], v3 offset:2048
    v_mfma_f32_16x16x32_bf16 v[212:215], v[136:139], v[32:35], 0
    ds_read_b128 v[52:55], v3 offset:20480
    v_mfma_f32_16x16x32_bf16 v[216:219], v[64:67], v[36:39], 0
    v_mfma_f32_16x16x32_bf16 v[220:223], v[136:139], v[36:39], 0
    v_mfma_f32_16x16x32_bf16 v[224:227], a[0:3], v[32:35], 0
    v_mfma_f32_16x16x32_bf16 v[228:231], a[72:75], v[32:35], 0
    v_mfma_f32_16x16x32_bf16 v[232:235], a[0:3], v[36:39], 0
    v_mfma_f32_16x16x32_bf16 v[236:239], a[72:75], v[36:39], 0
    s_waitcnt lgkmcnt(2)
    v_mfma_f32_16x16x32_bf16 v[208:211], v[68:71], v[40:43], v[208:211]
    ds_read_b128 v[32:35], v3 offset:3072
    v_mfma_f32_16x16x32_bf16 v[212:215], v[140:143], v[40:43], v[212:215]
    ds_read_b128 v[36:39], v3 offset:21504
    v_mfma_f32_16x16x32_bf16 v[216:219], v[68:71], v[44:47], v[216:219]
    s_add_u32 s23, s22, s25
    s_add_u32 m0, s23, 0
    s_nop 0
    buffer_load_dwordx4 v2, s[8:11], s24 offen offset:0 lds
    v_mfma_f32_16x16x32_bf16 v[220:223], v[140:143], v[44:47], v[220:223]
    v_mfma_f32_16x16x32_bf16 v[224:227], a[4:7], v[40:43], v[224:227]
    v_mfma_f32_16x16x32_bf16 v[228:231], a[76:79], v[40:43], v[228:231]
    v_mfma_f32_16x16x32_bf16 v[232:235], a[4:7], v[44:47], v[232:235]
    s_add_u32 m0, s23, 960
    s_nop 0
    buffer_load_dwordx4 v2, s[8:11], s24 offen offset:64 lds
    v_mfma_f32_16x16x32_bf16 v[236:239], a[76:79], v[44:47], v[236:239]
    s_waitcnt lgkmcnt(2)
    v_mfma_f32_16x16x32_bf16 v[208:211], v[72:75], v[48:51], v[208:211]
    ds_read_b128 v[40:43], v3 offset:4096
    v_mfma_f32_16x16x32_bf16 v[212:215], v[144:147], v[48:51], v[212:215]
    ds_read_b128 v[44:47], v3 offset:22528
    v_mfma_f32_16x16x32_bf16 v[216:219], v[72:75], v[52:55], v[216:219]
    s_add_u32 m0, s23, 1920
    s_nop 0
    buffer_load_dwordx4 v2, s[8:11], s24 offen offset:128 lds
    v_mfma_f32_16x16x32_bf16 v[220:223], v[144:147], v[52:55], v[220:223]
    v_mfma_f32_16x16x32_bf16 v[224:227], a[8:11], v[48:51], v[224:227]
    v_mfma_f32_16x16x32_bf16 v[228:231], a[80:83], v[48:51], v[228:231]
    v_mfma_f32_16x16x32_bf16 v[232:235], a[8:11], v[52:55], v[232:235]
    s_add_u32 m0, s23, 2880
    s_nop 0
    buffer_load_dwordx4 v2, s[8:11], s24 offen offset:192 lds
    v_mfma_f32_16x16x32_bf16 v[236:239], a[80:83], v[52:55], v[236:239]
    s_waitcnt lgkmcnt(2)
    v_mfma_f32_16x16x32_bf16 v[208:211], v[76:79], v[32:35], v[208:211]
    ds_read_b128 v[48:51], v3 offset:5120
    v_mfma_f32_16x16x32_bf16 v[212:215], v[148:151], v[32:35], v[212:215]
    ds_read_b128 v[52:55], v3 offset:23552
    v_mfma_f32_16x16x32_bf16 v[216:219], v[76:79], v[36:39], v[216:219]
    s_add_u32 m0, s23, 3840
    s_nop 0
    buffer_load_dwordx4 v2, s[8:11], s24 offen offset:256 lds
    v_mfma_f32_16x16x32_bf16 v[220:223], v[148:151], v[36:39], v[220:223]
    v_mfma_f32_16x16x32_bf16 v[224:227], a[12:15], v[32:35], v[224:227]
    v_mfma_f32_16x16x32_bf16 v[228:231], a[84:87], v[32:35], v[228:231]
    v_mfma_f32_16x16x32_bf16 v[232:235], a[12:15], v[36:39], v[232:235]
    s_add_u32 m0, s23, 4800
    s_nop 0
    buffer_load_dwordx4 v2, s[8:11], s24 offen offset:320 lds
    v_mfma_f32_16x16x32_bf16 v[236:239], a[84:87], v[36:39], v[236:239]
    s_waitcnt lgkmcnt(2)
    v_mfma_f32_16x16x32_bf16 v[208:211], v[80:83], v[40:43], v[208:211]
    ds_read_b128 v[32:35], v3 offset:6144
    v_mfma_f32_16x16x32_bf16 v[212:215], v[152:155], v[40:43], v[212:215]
    ds_read_b128 v[36:39], v3 offset:24576
    v_mfma_f32_16x16x32_bf16 v[216:219], v[80:83], v[44:47], v[216:219]
    s_add_u32 m0, s23, 5760
    s_nop 0
    buffer_load_dwordx4 v2, s[8:11], s24 offen offset:384 lds
    v_mfma_f32_16x16x32_bf16 v[220:223], v[152:155], v[44:47], v[220:223]
    v_mfma_f32_16x16x32_bf16 v[224:227], a[16:19], v[40:43], v[224:227]
    v_mfma_f32_16x16x32_bf16 v[228:231], a[88:91], v[40:43], v[228:231]
    v_mfma_f32_16x16x32_bf16 v[232:235], a[16:19], v[44:47], v[232:235]
    s_add_u32 m0, s23, 6720
    s_nop 0
    buffer_load_dwordx4 v2, s[8:11], s24 offen offset:448 lds
    v_mfma_f32_16x16x32_bf16 v[236:239], a[88:91], v[44:47], v[236:239]
    s_waitcnt lgkmcnt(2)
    v_mfma_f32_16x16x32_bf16 v[208:211], v[84:87], v[48:51], v[208:211]
    ds_read_b128 v[40:43], v3 offset:7168
    v_mfma_f32_16x16x32_bf16 v[212:215], v[156:159], v[48:51], v[212:215]
    ds_read_b128 v[44:47], v3 offset:25600
    v_mfma_f32_16x16x32_bf16 v[216:219], v[84:87], v[52:55], v[216:219]
    s_add_u32 m0, s23, 7680
    s_nop 0
    buffer_load_dwordx4 v2, s[8:11], s24 offen offset:512 lds
    s_add_u32 s24, s24, 147456
    v_mfma_f32_16x16x32_bf16 v[220:223], v[156:159], v[52:55], v[220:223]
    v_mfma_f32_16x16x32_bf16 v[224:227], a[20:23], v[48:51], v[224:227]
    v_mfma_f32_16x16x32_bf16 v[228:231], a[92:95], v[48:51], v[228:231]
    v_mfma_f32_16x16x32_bf16 v[232:235], a[20:23], v[52:55], v[232:235]
    v_mfma_f32_16x16x32_bf16 v[236:239], a[92:95], v[52:55], v[236:239]
    s_waitcnt lgkmcnt(2)
    v_mfma_f32_16x16x32_bf16 v[208:211], v[88:91], v[32:35], v[208:211]
    ds_read_b128 v[48:51], v3 offset:8192
    v_mfma_f32_16x16x32_bf16 v[212:215], v[160:163], v[32:35], v[212:215]
    ds_read_b128 v[52:55], v3 offset:26624
    v_mfma_f32_16x16x32_bf16 v[216:219], v[88:91], v[36:39], v[216:219]
    v_mfma_f32_16x16x32_bf16 v[220:223], v[160:163], v[36:39], v[220:223]
    v_mfma_f32_16x16x32_bf16 v[224:227], a[24:27], v[32:35], v[224:227]
    v_mfma_f32_16x16x32_bf16 v[228:231], a[96:99], v[32:35], v[228:231]
    v_mfma_f32_16x16x32_bf16 v[232:235], a[24:27], v[36:39], v[232:235]
    v_mfma_f32_16x16x32_bf16 v[236:239], a[96:99], v[36:39], v[236:239]
    s_waitcnt lgkmcnt(2)
    v_mfma_f32_16x16x32_bf16 v[208:211], v[92:95], v[40:43], v[208:211]
    ds_read_b128 v[32:35], v3 offset:9216
    v_mfma_f32_16x16x32_bf16 v[212:215], v[164:167], v[40:43], v[212:215]
    ds_read_b128 v[36:39], v3 offset:27648
    v_mfma_f32_16x16x32_bf16 v[216:219], v[92:95], v[44:47], v[216:219]
    s_add_u32 s23, s45, s95
    v_mov_b32 v4, s23
    s_mov_b64 exec, s[34:35]
    buffer_store_dword v4, off, s[4:7], s29 sc1
    s_mov_b64 exec, -1
    v_mfma_f32_16x16x32_bf16 v[220:223], v[164:167], v[44:47], v[220:223]
    v_mfma_f32_16x16x32_bf16 v[224:227], a[28:31], v[40:43], v[224:227]
    v_mfma_f32_16x16x32_bf16 v[228:231], a[100:103], v[40:43], v[228:231]
    v_mfma_f32_16x16x32_bf16 v[232:235], a[28:31], v[44:47], v[232:235]
    v_mfma_f32_16x16x32_bf16 v[236:239], a[100:103], v[44:47], v[236:239]
    s_waitcnt lgkmcnt(2)
    v_mfma_f32_16x16x32_bf16 v[208:211], v[96:99], v[48:51], v[208:211]
    ds_read_b128 v[40:43], v3 offset:10240
    v_mfma_f32_16x16x32_bf16 v[212:215], v[168:171], v[48:51], v[212:215]
    ds_read_b128 v[44:47], v3 offset:28672
    v_mfma_f32_16x16x32_bf16 v[216:219], v[96:99], v[52:55], v[216:219]
    s_cmp_lt_u32 s19, 60
    s_cbranch_scc1 lt10
    buffer_load_dwordx4 v[244:247], off, s[84:87], 0 offset:16 sc1
    buffer_load_dwordx4 v[240:243], off, s[84:87], 0 offset:32 sc1
    buffer_load_dwordx2 v[252:253], off, s[84:87], 0 offset:48 sc1
lt10:
    s_lshr_b32 s46, s19, 2
    s_cmp_eq_u32 s16, 0
    s_cselect_b32 s46, 0, s46
    s_cmp_lg_u32 s46, 2
    s_cbranch_scc1 lp10
    v_mov_b32 v244, -1
    v_mov_b32 v245, -1
    v_mov_b32 v246, -1
    v_mov_b32 v247, -1
    s_lshl_b32 s46, s19, 5
    s_add_u32 s46, s46, s17
    s_lshl_b32 s46, s46, 12
    s_mul_i32 s47, s16, 8388608
    s_add_u32 s46, s46, s47
    s_add_u32 s47, s46, 67108864
    buffer_store_dwordx4 v[244:247], v7, s[4:7], s47 offen sc1
    s_add_u32 s47, s46, 67112960
    buffer_store_dwordx4 v[244:247], v7, s[4:7], s47 offen sc1
    s_add_u32 s47, s46, 67633152
    buffer_store_dwordx4 v[244:247], v7, s[4:7], s47 offen sc1
    s_add_u32 s47, s46, 67637248
    buffer_store_dwordx4 v[244:247], v7, s[4:7], s47 offen sc1
lp10:
    s_lshl_b32 s46, s16, 6
    s_or_b32 s46, s46, s19
    s_or_b32 s47, s46, 1
    s_cmp_lg_u32 s47, 11
    s_cbranch_scc1 lq10
    v_mov_b32 v244, -1
    v_mov_b32 v245, -1
    v_mov_b32 v246, -1
    v_mov_b32 v247, -1
    s_lshl_b32 s46, s46, 18
    s_lshl_b32 s47, s17, 12
    s_add_u32 s46, s46, s47
    s_add_u32 s47, s46, 63963136
    buffer_store_dwordx4 v[244:247], v7, s[4:7], s47 offen sc1
    s_add_u32 s47, s46, 63967232
    buffer_store_dwordx4 v[244:247], v7, s[4:7], s47 offen sc1
    s_add_u32 s47, s46, 64094208
    buffer_store_dwordx4 v[244:247], v7, s[4:7], s47 offen sc1
    s_add_u32 s47, s46, 64098304
    buffer_store_dwordx4 v[244:247], v7, s[4:7], s47 offen sc1
lq10:
    v_mfma_f32_16x16x32_bf16 v[220:223], v[168:171], v[52:55], v[220:223]
    v_mfma_f32_16x16x32_bf16 v[224:227], a[32:35], v[48:51], v[224:227]
    v_mfma_f32_16x16x32_bf16 v[228:231], a[104:107], v[48:51], v[228:231]
    v_mfma_f32_16x16x32_bf16 v[232:235], a[32:35], v[52:55], v[232:235]
    v_mfma_f32_16x16x32_bf16 v[236:239], a[104:107], v[52:55], v[236:239]
    s_waitcnt lgkmcnt(2)
    v_mfma_f32_16x16x32_bf16 v[208:211], v[100:103], v[32:35], v[208:211]
    ds_read_b128 v[48:51], v3 offset:11264
    v_mfma_f32_16x16x32_bf16 v[212:215], v[172:175], v[32:35], v[212:215]
    ds_read_b128 v[52:55], v3 offset:29696
    v_mfma_f32_16x16x32_bf16 v[216:219], v[100:103], v[36:39], v[216:219]
    v_mfma_f32_16x16x32_bf16 v[220:223], v[172:175], v[36:39], v[220:223]
    v_mfma_f32_16x16x32_bf16 v[224:227], a[36:39], v[32:35], v[224:227]
    v_mfma_f32_16x16x32_bf16 v[228:231], a[108:111], v[32:35], v[228:231]
    v_mfma_f32_16x16x32_bf16 v[232:235], a[36:39], v[36:39], v[232:235]
    v_mfma_f32_16x16x32_bf16 v[236:239], a[108:111], v[36:39], v[236:239]
    s_waitcnt lgkmcnt(2)
    v_mfma_f32_16x16x32_bf16 v[208:211], v[104:107], v[40:43], v[208:211]
    ds_read_b128 v[32:35], v3 offset:12288
    v_mfma_f32_16x16x32_bf16 v[212:215], v[176:179], v[40:43], v[212:215]
    ds_read_b128 v[36:39], v3 offset:30720
    v_mfma_f32_16x16x32_bf16 v[216:219], v[104:107], v[44:47], v[216:219]
    v_mfma_f32_16x16x32_bf16 v[220:223], v[176:179], v[44:47], v[220:223]
    v_mfma_f32_16x16x32_bf16 v[224:227], a[40:43], v[40:43], v[224:227]
    v_mfma_f32_16x16x32_bf16 v[228:231], a[112:115], v[40:43], v[228:231]
    v_mfma_f32_16x16x32_bf16 v[232:235], a[40:43], v[44:47], v[232:235]
    v_mfma_f32_16x16x32_bf16 v[236:239], a[112:115], v[44:47], v[236:239]
    s_waitcnt lgkmcnt(2)
    v_mfma_f32_16x16x32_bf16 v[208:211], v[108:111], v[48:51], v[208:211]
    ds_read_b128 v[40:43], v3 offset:13312
    v_mfma_f32_16x16x32_bf16 v[212:215], v[180:183], v[48:51], v[212:215]
    ds_read_b128 v[44:47], v3 offset:31744
    v_mfma_f32_16x16x32_bf16 v[216:219], v[108:111], v[52:55], v[216:219]
    v_mfma_f32_16x16x32_bf16 v[220:223], v[180:183], v[52:55], v[220:223]
    v_mfma_f32_16x16x32_bf16 v[224:227], a[44:47], v[48:51], v[224:227]
    v_mfma_f32_16x16x32_bf16 v[228:231], a[116:119], v[48:51], v[228:231]
    v_mfma_f32_16x16x32_bf16 v[232:235], a[44:47], v[52:55], v[232:235]
    v_mfma_f32_16x16x32_bf16 v[236:239], a[116:119], v[52:55], v[236:239]
    s_waitcnt lgkmcnt(2)
    v_mfma_f32_16x16x32_bf16 v[208:211], v[112:115], v[32:35], v[208:211]
    ds_read_b128 v[48:51], v3 offset:14336
    v_mfma_f32_16x16x32_bf16 v[212:215], v[184:187], v[32:35], v[212:215]
    ds_read_b128 v[52:55], v3 offset:32768
    v_mfma_f32_16x16x32_bf16 v[216:219], v[112:115], v[36:39], v[216:219]
    v_mfma_f32_16x16x32_bf16 v[220:223], v[184:187], v[36:39], v[220:223]
    v_mfma_f32_16x16x32_bf16 v[224:227], a[48:51], v[32:35], v[224:227]
    v_mfma_f32_16x16x32_bf16 v[228:231], a[120:123], v[32:35], v[228:231]
    v_mfma_f32_16x16x32_bf16 v[232:235], a[48:51], v[36:39], v[232:235]
    v_mfma_f32_16x16x32_bf16 v[236:239], a[120:123], v[36:39], v[236:239]
    s_waitcnt lgkmcnt(2)
    v_mfma_f32_16x16x32_bf16 v[208:211], v[116:119], v[40:43], v[208:211]
    ds_read_b128 v[32:35], v3 offset:15360
    v_mfma_f32_16x16x32_bf16 v[212:215], v[188:191], v[40:43], v[212:215]
    ds_read_b128 v[36:39], v3 offset:33792
    v_mfma_f32_16x16x32_bf16 v[216:219], v[116:119], v[44:47], v[216:219]
    v_mfma_f32_16x16x32_bf16 v[220:223], v[188:191], v[44:47], v[220:223]
    v_mfma_f32_16x16x32_bf16 v[224:227], a[52:55], v[40:43], v[224:227]
    v_mfma_f32_16x16x32_bf16 v[228:231], a[124:127], v[40:43], v[228:231]
    v_mfma_f32_16x16x32_bf16 v[232:235], a[52:55], v[44:47], v[232:235]
    v_mfma_f32_16x16x32_bf16 v[236:239], a[124:127], v[44:47], v[236:239]
    s_waitcnt lgkmcnt(2)
    v_mfma_f32_16x16x32_bf16 v[208:211], v[120:123], v[48:51], v[208:211]
    ds_read_b128 v[40:43], v3 offset:16384
    v_mfma_f32_16x16x32_bf16 v[212:215], v[192:195], v[48:51], v[212:215]
    ds_read_b128 v[44:47], v3 offset:34816
    v_mfma_f32_16x16x32_bf16 v[216:219], v[120:123], v[52:55], v[216:219]
    v_mfma_f32_16x16x32_bf16 v[220:223], v[192:195], v[52:55], v[220:223]
    v_mfma_f32_16x16x32_bf16 v[224:227], a[56:59], v[48:51], v[224:227]
    v_mfma_f32_16x16x32_bf16 v[228:231], a[128:131], v[48:51], v[228:231]
    v_mfma_f32_16x16x32_bf16 v[232:235], a[56:59], v[52:55], v[232:235]
    v_mfma_f32_16x16x32_bf16 v[236:239], a[128:131], v[52:55], v[236:239]
    s_waitcnt lgkmcnt(2)
    v_mfma_f32_16x16x32_bf16 v[208:211], v[124:127], v[32:35], v[208:211]
    ds_read_b128 v[48:51], v3 offset:17408
    v_mfma_f32_16x16x32_bf16 v[212:215], v[196:199], v[32:35], v[212:215]
    ds_read_b128 v[52:55], v3 offset:35840
    v_mfma_f32_16x16x32_bf16 v[216:219], v[124:127], v[36:39], v[216:219]
    v_mfma_f32_16x16x32_bf16 v[220:223], v[196:199], v[36:39], v[220:223]
    v_mfma_f32_16x16x32_bf16 v[224:227], a[60:63], v[32:35], v[224:227]
    s_add_u32 s27, s27, 36864
    s_cmp_eq_u32 s27, 110592
    s_cselect_b32 s27, 0, s27
    v_add_u32 v3, s27, v1
    v_mfma_f32_16x16x32_bf16 v[228:231], a[132:135], v[32:35], v[228:231]
    v_mfma_f32_16x16x32_bf16 v[232:235], a[60:63], v[36:39], v[232:235]
    v_mfma_f32_16x16x32_bf16 v[236:239], a[132:135], v[36:39], v[236:239]
    s_waitcnt lgkmcnt(2)
    v_mfma_f32_16x16x32_bf16 v[208:211], v[128:131], v[40:43], v[208:211]
    ds_read_b128 v[32:35], v3 offset:0
    v_mfma_f32_16x16x32_bf16 v[212:215], v[200:203], v[40:43], v[212:215]
    ds_read_b128 v[36:39], v3 offset:18432
    v_mfma_f32_16x16x32_bf16 v[216:219], v[128:131], v[44:47], v[216:219]
    v_mfma_f32_16x16x32_bf16 v[220:223], v[200:203], v[44:47], v[220:223]
    v_mfma_f32_16x16x32_bf16 v[224:227], a[64:67], v[40:43], v[224:227]
    v_mfma_f32_16x16x32_bf16 v[228:231], a[136:139], v[40:43], v[228:231]
    v_mfma_f32_16x16x32_bf16 v[232:235], a[64:67], v[44:47], v[232:235]
    v_mfma_f32_16x16x32_bf16 v[236:239], a[136:139], v[44:47], v[236:239]
    s_waitcnt lgkmcnt(2)
    v_mfma_f32_16x16x32_bf16 v[208:211], v[132:135], v[48:51], v[208:211]
    ds_read_b128 v[40:43], v3 offset:1024
    v_mfma_f32_16x16x32_bf16 v[212:215], v[204:207], v[48:51], v[212:215]
    ds_read_b128 v[44:47], v3 offset:19456
    v_mfma_f32_16x16x32_bf16 v[216:219], v[132:135], v[52:55], v[216:219]
    v_mfma_f32_16x16x32_bf16 v[220:223], v[204:207], v[52:55], v[220:223]
    v_mfma_f32_16x16x32_bf16 v[224:227], a[68:71], v[48:51], v[224:227]
    v_mfma_f32_16x16x32_bf16 v[228:231], a[140:143], v[48:51], v[228:231]
    v_mfma_f32_16x16x32_bf16 v[232:235], a[68:71], v[52:55], v[232:235]
    v_mfma_f32_16x16x32_bf16 v[236:239], a[140:143], v[52:55], v[236:239]
    s_add_u32 s26, s26, s41
    s_waitcnt vmcnt(0)
    v_cvt_pk_bf16_f32 v8, v208, v209
    v_cvt_pk_bf16_f32 v9, v210, v211
    v_cvt_pk_bf16_f32 v10, v212, v213
    v_cvt_pk_bf16_f32 v11, v214, v215
    v_cvt_pk_bf16_f32 v12, v216, v217
    v_cvt_pk_bf16_f32 v13, v218, v219
    v_cvt_pk_bf16_f32 v14, v220, v221
    v_cvt_pk_bf16_f32 v15, v222, v223
    v_cvt_pk_bf16_f32 v16, v224, v225
    v_cvt_pk_bf16_f32 v17, v226, v227
    v_cvt_pk_bf16_f32 v18, v228, v229
    v_cvt_pk_bf16_f32 v19, v230, v231
    v_cvt_pk_bf16_f32 v20, v232, v233
    v_cvt_pk_bf16_f32 v21, v234, v235
    v_cvt_pk_bf16_f32 v22, v236, v237
    v_cvt_pk_bf16_f32 v23, v238, v239
    s_mov_b64 s[36:37], -1
    s_add_u32 s28, s26, s12
    buffer_store_dwordx4 v[8:11], v7, s[4:7], s28 offen sc1
    s_add_u32 s28, s26, s13
    buffer_store_dwordx4 v[12:15], v7, s[4:7], s28 offen sc1
    s_add_u32 s28, s26, s14
    buffer_store_dwordx4 v[16:19], v7, s[4:7], s28 offen sc1
    s_add_u32 s28, s26, s15
    buffer_store_dwordx4 v[20:23], v7, s[4:7], s28 offen sc1
    s_lshr_b32 s45, s19, 2
    s_cbranch_scc1 qk_loop_nf
    s_mov_b32 s45, 1
    s_mov_b64 s[36:37], 0
    s_waitcnt vmcnt(0)
    s_barrier
    s_add_u32 s23, s45, s95
    v_mov_b32 v4, s23
    s_mov_b64 exec, s[34:35]
    buffer_store_dword v4, off, s[4:7], s29 sc1
    s_mov_b64 exec, -1
qk_loop_nf:
    s_add_u32 s19, s19, 4
    s_cmp_lt_u32 s19, s20
    s_cbranch_scc1 qk_loop
    s_branch qk_done
qk_vloop:
    s_barrier
    s_add_u32 s22, s27, 73728
    s_sub_u32 s21, s22, 110592
    s_cselect_b32 s22, s22, s21
    s_waitcnt lgkmcnt(2)
    v_mfma_f32_16x16x32_bf16 v[208:211], v[32:35], v[64:67], 0
    ds_read_b128 v[48:51], v3 offset:2048
    v_mfma_f32_16x16x32_bf16 v[212:215], v[32:35], v[136:139], 0
    ds_read_b128 v[52:55], v3 offset:20480
    v_mfma_f32_16x16x32_bf16 v[216:219], v[36:39], v[64:67], 0
    v_mfma_f32_16x16x32_bf16 v[220:223], v[36:39], v[136:139], 0
    v_mfma_f32_16x16x32_bf16 v[224:227], v[32:35], a[0:3], 0
    v_mfma_f32_16x16x32_bf16 v[228:231], v[32:35], a[72:75], 0
    v_mfma_f32_16x16x32_bf16 v[232:235], v[36:39], a[0:3], 0
    v_mfma_f32_16x16x32_bf16 v[236:239], v[36:39], a[72:75], 0
    s_waitcnt lgkmcnt(2)
    v_mfma_f32_16x16x32_bf16 v[208:211], v[40:43], v[68:71], v[208:211]
    ds_read_b128 v[32:35], v3 offset:3072
    v_mfma_f32_16x16x32_bf16 v[212:215], v[40:43], v[140:143], v[212:215]
    ds_read_b128 v[36:39], v3 offset:21504
    v_mfma_f32_16x16x32_bf16 v[216:219], v[44:47], v[68:71], v[216:219]
    s_add_u32 s23, s22, s25
    s_add_u32 m0, s23, 0
    s_nop 0
    buffer_load_dwordx4 v2, s[8:11], s24 offen offset:0 lds
    v_mfma_f32_16x16x32_bf16 v[220:223], v[44:47], v[140:143], v[220:223]
    v_mfma_f32_16x16x32_bf16 v[224:227], v[40:43], a[4:7], v[224:227]
    v_mfma_f32_16x16x32_bf16 v[228:231], v[40:43], a[76:79], v[228:231]
    v_mfma_f32_16x16x32_bf16 v[232:235], v[44:47], a[4:7], v[232:235]
    s_add_u32 m0, s23, 960
    s_nop 0
    buffer_load_dwordx4 v2, s[8:11], s24 offen offset:64 lds
    v_mfma_f32_16x16x32_bf16 v[236:239], v[44:47], a[76:79], v[236:239]
    s_waitcnt lgkmcnt(2)
    v_mfma_f32_16x16x32_bf16 v[208:211], v[48:51], v[72:75], v[208:211]
    ds_read_b128 v[40:43], v3 offset:4096
    v_mfma_f32_16x16x32_bf16 v[212:215], v[48:51], v[144:147], v[212:215]
    ds_read_b128 v[44:47], v3 offset:22528
    v_mfma_f32_16x16x32_bf16 v[216:219], v[52:55], v[72:75], v[216:219]
    s_add_u32 m0, s23, 1920
    s_nop 0
    buffer_load_dwordx4 v2, s[8:11], s24 offen offset:128 lds
    v_mfma_f32_16x16x32_bf16 v[220:223], v[52:55], v[144:147], v[220:223]
    v_mfma_f32_16x16x32_bf16 v[224:227], v[48:51], a[8:11], v[224:227]
    v_mfma_f32_16x16x32_bf16 v[228:231], v[48:51], a[80:83], v[228:231]
    v_mfma_f32_16x16x32_bf16 v[232:235], v[52:55], a[8:11], v[232:235]
    s_add_u32 m0, s23, 2880
    s_nop 0
    buffer_load_dwordx4 v2, s[8:11], s24 offen offset:192 lds
    v_mfma_f32_16x16x32_bf16 v[236:239], v[52:55], a[80:83], v[236:239]
    s_waitcnt lgkmcnt(2)
    v_mfma_f32_16x16x32_bf16 v[208:211], v[32:35], v[76:79], v[208:211]
    ds_read_b128 v[48:51], v3 offset:5120
    v_mfma_f32_16x16x32_bf16 v[212:215], v[32:35], v[148:151], v[212:215]
    ds_read_b128 v[52:55], v3 offset:23552
    v_mfma_f32_16x16x32_bf16 v[216:219], v[36:39], v[76:79], v[216:219]
    s_add_u32 m0, s23, 3840
    s_nop 0
    buffer_load_dwordx4 v2, s[8:11], s24 offen offset:256 lds
    v_mfma_f32_16x16x32_bf16 v[220:223], v[36:39], v[148:151], v[220:223]
    v_mfma_f32_16x16x32_bf16 v[224:227], v[32:35], a[12:15], v[224:227]
    v_mfma_f32_16x16x32_bf16 v[228:231], v[32:35], a[84:87], v[228:231]
    v_mfma_f32_16x16x32_bf16 v[232:235], v[36:39], a[12:15], v[232:235]
    s_add_u32 m0, s23, 4800
    s_nop 0
    buffer_load_dwordx4 v2, s[8:11], s24 offen offset:320 lds
    v_mfma_f32_16x16x32_bf16 v[236:239], v[36:39], a[84:87], v[236:239]
    s_waitcnt lgkmcnt(2)
    v_mfma_f32_16x16x32_bf16 v[208:211], v[40:43], v[80:83], v[208:211]
    ds_read_b128 v[32:35], v3 offset:6144
    v_mfma_f32_16x16x32_bf16 v[212:215], v[40:43], v[152:155], v[212:215]
    ds_read_b128 v[36:39], v3 offset:24576
    v_mfma_f32_16x16x32_bf16 v[216:219], v[44:47], v[80:83], v[216:219]
    s_add_u32 m0, s23, 5760
    s_nop 0
    buffer_load_dwordx4 v2, s[8:11], s24 offen offset:384 lds
    v_mfma_f32_16x16x32_bf16 v[220:223], v[44:47], v[152:155], v[220:223]
    v_mfma_f32_16x16x32_bf16 v[224:227], v[40:43], a[16:19], v[224:227]
    v_mfma_f32_16x16x32_bf16 v[228:231], v[40:43], a[88:91], v[228:231]
    v_mfma_f32_16x16x32_bf16 v[232:235], v[44:47], a[16:19], v[232:235]
    s_add_u32 m0, s23, 6720
    s_nop 0
    buffer_load_dwordx4 v2, s[8:11], s24 offen offset:448 lds
    v_mfma_f32_16x16x32_bf16 v[236:239], v[44:47], a[88:91], v[236:239]
    s_waitcnt lgkmcnt(2)
    v_mfma_f32_16x16x32_bf16 v[208:211], v[48:51], v[84:87], v[208:211]
    ds_read_b128 v[40:43], v3 offset:7168
    v_mfma_f32_16x16x32_bf16 v[212:215], v[48:51], v[156:159], v[212:215]
    ds_read_b128 v[44:47], v3 offset:25600
    v_mfma_f32_16x16x32_bf16 v[216:219], v[52:55], v[84:87], v[216:219]
    s_add_u32 m0, s23, 7680
    s_nop 0
    buffer_load_dwordx4 v2, s[8:11], s24 offen offset:512 lds
    s_add_u32 s24, s24, 147456
    v_mfma_f32_16x16x32_bf16 v[220:223], v[52:55], v[156:159], v[220:223]
    v_mfma_f32_16x16x32_bf16 v[224:227], v[48:51], a[20:23], v[224:227]
    v_mfma_f32_16x16x32_bf16 v[228:231], v[48:51], a[92:95], v[228:231]
    v_mfma_f32_16x16x32_bf16 v[232:235], v[52:55], a[20:23], v[232:235]
    v_mfma_f32_16x16x32_bf16 v[236:239], v[52:55], a[92:95], v[236:239]
    s_waitcnt lgkmcnt(2)
    v_mfma_f32_16x16x32_bf16 v[208:211], v[32:35], v[88:91], v[208:211]
    ds_read_b128 v[48:51], v3 offset:8192
    v_mfma_f32_16x16x32_bf16 v[212:215], v[32:35], v[160:163], v[212:215]
    ds_read_b128 v[52:55], v3 offset:26624
    v_mfma_f32_16x16x32_bf16 v[216:219], v[36:39], v[88:91], v[216:219]
    v_mfma_f32_16x16x32_bf16 v[220:223], v[36:39], v[160:163], v[220:223]
    v_mfma_f32_16x16x32_bf16 v[224:227], v[32:35], a[24:27], v[224:227]
    v_mfma_f32_16x16x32_bf16 v[228:231], v[32:35], a[96:99], v[228:231]
    v_mfma_f32_16x16x32_bf16 v[232:235], v[36:39], a[24:27], v[232:235]
    v_mfma_f32_16x16x32_bf16 v[236:239], v[36:39], a[96:99], v[236:239]
    s_waitcnt lgkmcnt(2)
    v_mfma_f32_16x16x32_bf16 v[208:211], v[40:43], v[92:95], v[208:211]
    ds_read_b128 v[32:35], v3 offset:9216
    v_mfma_f32_16x16x32_bf16 v[212:215], v[40:43], v[164:167], v[212:215]
    ds_read_b128 v[36:39], v3 offset:27648
    v_mfma_f32_16x16x32_bf16 v[216:219], v[44:47], v[92:95], v[216:219]
    s_add_u32 s23, s45, s95
    v_mov_b32 v4, s23
    s_mov_b64 exec, s[34:35]
    buffer_store_dword v4, off, s[4:7], s29 sc1
    s_mov_b64 exec, -1
    v_mfma_f32_16x16x32_bf16 v[220:223], v[44:47], v[164:167], v[220:223]
    v_mfma_f32_16x16x32_bf16 v[224:227], v[40:43], a[28:31], v[224:227]
    v_mfma_f32_16x16x32_bf16 v[228:231], v[40:43], a[100:103], v[228:231]
    v_mfma_f32_16x16x32_bf16 v[232:235], v[44:47], a[28:31], v[232:235]
    v_mfma_f32_16x16x32_bf16 v[236:239], v[44:47], a[100:103], v[236:239]
    s_waitcnt lgkmcnt(2)
    v_mfma_f32_16x16x32_bf16 v[208:211], v[48:51], v[96:99], v[208:211]
    ds_read_b128 v[40:43], v3 offset:10240
    v_mfma_f32_16x16x32_bf16 v[212:215], v[48:51], v[168:171], v[212:215]
    ds_read_b128 v[44:47], v3 offset:28672
    v_mfma_f32_16x16x32_bf16 v[216:219], v[52:55], v[96:99], v[216:219]
    s_cmp_lt_u32 s19, 60
    s_cbranch_scc1 lt11
    buffer_load_dwordx4 v[244:247], off, s[84:87], 0 offset:16 sc1
    buffer_load_dwordx4 v[240:243], off, s[84:87], 0 offset:32 sc1
    buffer_load_dwordx2 v[252:253], off, s[84:87], 0 offset:48 sc1
lt11:
    s_lshr_b32 s46, s19, 2
    s_cmp_eq_u32 s16, 0
    s_cselect_b32 s46, 0, s46
    s_cmp_lg_u32 s46, 2
    s_cbranch_scc1 lp11
    v_mov_b32 v244, -1
    v_mov_b32 v245, -1
    v_mov_b32 v246, -1
    v_mov_b32 v247, -1
    s_lshl_b32 s46, s19, 5
    s_add_u32 s46, s46, s17
    s_lshl_b32 s46, s46, 12
    s_mul_i32 s47, s16, 8388608
    s_add_u32 s46, s46, s47
    s_add_u32 s47, s46, 67108864
    buffer_store_dwordx4 v[244:247], v7, s[4:7], s47 offen sc1
    s_add_u32 s47, s46, 67112960
    buffer_store_dwordx4 v[244:247], v7, s[4:7], s47 offen sc1
    s_add_u32 s47, s46, 67633152
    buffer_store_dwordx4 v[244:247], v7, s[4:7], s47 offen sc1
    s_add_u32 s47, s46, 67637248
    buffer_store_dwordx4 v[244:247], v7, s[4:7], s47 offen sc1
lp11:
    s_lshl_b32 s46, s16, 6
    s_or_b32 s46, s46, s19
    s_or_b32 s47, s46, 1
    s_cmp_lg_u32 s47, 11
    s_cbranch_scc1 lq11
    v_mov_b32 v244, -1
    v_mov_b32 v245, -1
    v_mov_b32 v246, -1
    v_mov_b32 v247, -1
    s_lshl_b32 s46, s46, 18
    s_lshl_b32 s47, s17, 12
    s_add_u32 s46, s46, s47
    s_add_u32 s47, s46, 63963136
    buffer_store_dwordx4 v[244:247], v7, s[4:7], s47 offen sc1
    s_add_u32 s47, s46, 63967232
    buffer_store_dwordx4 v[244:247], v7, s[4:7], s47 offen sc1
    s_add_u32 s47, s46, 64094208
    buffer_store_dwordx4 v[244:247], v7, s[4:7], s47 offen sc1
    s_add_u32 s47, s46, 64098304
    buffer_store_dwordx4 v[244:247], v7, s[4:7], s47 offen sc1
lq11:
    v_mfma_f32_16x16x32_bf16 v[220:223], v[52:55], v[168:171], v[220:223]
    v_mfma_f32_16x16x32_bf16 v[224:227], v[48:51], a[32:35], v[224:227]
    v_mfma_f32_16x16x32_bf16 v[228:231], v[48:51], a[104:107], v[228:231]
    v_mfma_f32_16x16x32_bf16 v[232:235], v[52:55], a[32:35], v[232:235]
    v_mfma_f32_16x16x32_bf16 v[236:239], v[52:55], a[104:107], v[236:239]
    s_waitcnt lgkmcnt(2)
    v_mfma_f32_16x16x32_bf16 v[208:211], v[32:35], v[100:103], v[208:211]
    ds_read_b128 v[48:51], v3 offset:11264
    v_mfma_f32_16x16x32_bf16 v[212:215], v[32:35], v[172:175], v[212:215]
    ds_read_b128 v[52:55], v3 offset:29696
    v_mfma_f32_16x16x32_bf16 v[216:219], v[36:39], v[100:103], v[216:219]
    v_mfma_f32_16x16x32_bf16 v[220:223], v[36:39], v[172:175], v[220:223]
    v_mfma_f32_16x16x32_bf16 v[224:227], v[32:35], a[36:39], v[224:227]
    v_mfma_f32_16x16x32_bf16 v[228:231], v[32:35], a[108:111], v[228:231]
    v_mfma_f32_16x16x32_bf16 v[232:235], v[36:39], a[36:39], v[232:235]
    v_mfma_f32_16x16x32_bf16 v[236:239], v[36:39], a[108:111], v[236:239]
    s_waitcnt lgkmcnt(2)
    v_mfma_f32_16x16x32_bf16 v[208:211], v[40:43], v[104:107], v[208:211]
    ds_read_b128 v[32:35], v3 offset:12288
    v_mfma_f32_16x16x32_bf16 v[212:215], v[40:43], v[176:179], v[212:215]
    ds_read_b128 v[36:39], v3 offset:30720
    v_mfma_f32_16x16x32_bf16 v[216:219], v[44:47], v[104:107], v[216:219]
    v_mfma_f32_16x16x32_bf16 v[220:223], v[44:47], v[176:179], v[220:223]
    v_mfma_f32_16x16x32_bf16 v[224:227], v[40:43], a[40:43], v[224:227]
    v_mfma_f32_16x16x32_bf16 v[228:231], v[40:43], a[112:115], v[228:231]
    v_mfma_f32_16x16x32_bf16 v[232:235], v[44:47], a[40:43], v[232:235]
    v_mfma_f32_16x16x32_bf16 v[236:239], v[44:47], a[112:115], v[236:239]
    s_waitcnt lgkmcnt(2)
    v_mfma_f32_16x16x32_bf16 v[208:211], v[48:51], v[108:111], v[208:211]
    ds_read_b128 v[40:43], v3 offset:13312
    v_mfma_f32_16x16x32_bf16 v[212:215], v[48:51], v[180:183], v[212:215]
    ds_read_b128 v[44:47], v3 offset:31744
    v_mfma_f32_16x16x32_bf16 v[216:219], v[52:55], v[108:111], v[216:219]
    v_mfma_f32_16x16x32_bf16 v[220:223], v[52:55], v[180:183], v[220:223]
    v_mfma_f32_16x16x32_bf16 v[224:227], v[48:51], a[44:47], v[224:227]
    v_mfma_f32_16x16x32_bf16 v[228:231], v[48:51], a[116:119], v[228:231]
    v_mfma_f32_16x16x32_bf16 v[232:235], v[52:55], a[44:47], v[232:235]
    v_mfma_f32_16x16x32_bf16 v[236:239], v[52:55], a[116:119], v[236:239]
    s_waitcnt lgkmcnt(2)
    v_mfma_f32_16x16x32_bf16 v[208:211], v[32:35], v[112:115], v[208:211]
    ds_read_b128 v[48:51], v3 offset:14336
    v_mfma_f32_16x16x32_bf16 v[212:215], v[32:35], v[184:187], v[212:215]
    ds_read_b128 v[52:55], v3 offset:32768
    v_mfma_f32_16x16x32_bf16 v[216:219], v[36:39], v[112:115], v[216:219]
    v_mfma_f32_16x16x32_bf16 v[220:223], v[36:39], v[184:187], v[220:223]
    v_mfma_f32_16x16x32_bf16 v[224:227], v[32:35], a[48:51], v[224:227]
    v_mfma_f32_16x16x32_bf16 v[228:231], v[32:35], a[120:123], v[228:231]
    v_mfma_f32_16x16x32_bf16 v[232:235], v[36:39], a[48:51], v[232:235]
    v_mfma_f32_16x16x32_bf16 v[236:239], v[36:39], a[120:123], v[236:239]
    s_waitcnt lgkmcnt(2)
    v_mfma_f32_16x16x32_bf16 v[208:211], v[40:43], v[116:119], v[208:211]
    ds_read_b128 v[32:35], v3 offset:15360
    v_mfma_f32_16x16x32_bf16 v[212:215], v[40:43], v[188:191], v[212:215]
    ds_read_b128 v[36:39], v3 offset:33792
    v_mfma_f32_16x16x32_bf16 v[216:219], v[44:47], v[116:119], v[216:219]
    v_mfma_f32_16x16x32_bf16 v[220:223], v[44:47], v[188:191], v[220:223]
    v_mfma_f32_16x16x32_bf16 v[224:227], v[40:43], a[52:55], v[224:227]
    v_mfma_f32_16x16x32_bf16 v[228:231], v[40:43], a[124:127], v[228:231]
    v_mfma_f32_16x16x32_bf16 v[232:235], v[44:47], a[52:55], v[232:235]
    v_mfma_f32_16x16x32_bf16 v[236:239], v[44:47], a[124:127], v[236:239]
    s_waitcnt lgkmcnt(2)
    v_mfma_f32_16x16x32_bf16 v[208:211], v[48:51], v[120:123], v[208:211]
    ds_read_b128 v[40:43], v3 offset:16384
    v_mfma_f32_16x16x32_bf16 v[212:215], v[48:51], v[192:195], v[212:215]
    ds_read_b128 v[44:47], v3 offset:34816
    v_mfma_f32_16x16x32_bf16 v[216:219], v[52:55], v[120:123], v[216:219]
    v_mfma_f32_16x16x32_bf16 v[220:223], v[52:55], v[192:195], v[220:223]
    v_mfma_f32_16x16x32_bf16 v[224:227], v[48:51], a[56:59], v[224:227]
    v_mfma_f32_16x16x32_bf16 v[228:231], v[48:51], a[128:131], v[228:231]
    v_mfma_f32_16x16x32_bf16 v[232:235], v[52:55], a[56:59], v[232:235]
    v_mfma_f32_16x16x32_bf16 v[236:239], v[52:55], a[128:131], v[236:239]
    s_waitcnt lgkmcnt(2)
    v_mfma_f32_16x16x32_bf16 v[208:211], v[32:35], v[124:127], v[208:211]
    ds_read_b128 v[48:51], v3 offset:17408
    v_mfma_f32_16x16x32_bf16 v[212:215], v[32:35], v[196:199], v[212:215]
    ds_read_b128 v[52:55], v3 offset:35840
    v_mfma_f32_16x16x32_bf16 v[216:219], v[36:39], v[124:127], v[216:219]
    v_mfma_f32_16x16x32_bf16 v[220:223], v[36:39], v[196:199], v[220:223]
    v_mfma_f32_16x16x32_bf16 v[224:227], v[32:35], a[60:63], v[224:227]
    s_add_u32 s27, s27, 36864
    s_cmp_eq_u32 s27, 110592
    s_cselect_b32 s27, 0, s27
    v_add_u32 v3, s27, v1
    v_mfma_f32_16x16x32_bf16 v[228:231], v[32:35], a[132:135], v[228:231]
    v_mfma_f32_16x16x32_bf16 v[232:235], v[36:39], a[60:63], v[232:235]
    v_mfma_f32_16x16x32_bf16 v[236:239], v[36:39], a[132:135], v[236:239]
    s_waitcnt lgkmcnt(2)
    v_mfma_f32_16x16x32_bf16 v[208:211], v[40:43], v[128:131], v[208:211]
    ds_read_b128 v[32:35], v3 offset:0
    v_mfma_f32_16x16x32_bf16 v[212:215], v[40:43], v[200:203], v[212:215]
    ds_read_b128 v[36:39], v3 offset:18432
    v_mfma_f32_16x16x32_bf16 v[216:219], v[44:47], v[128:131], v[216:219]
    v_mfma_f32_16x16x32_bf16 v[220:223], v[44:47], v[200:203], v[220:223]
    v_mfma_f32_16x16x32_bf16 v[224:227], v[40:43], a[64:67], v[224:227]
    v_mfma_f32_16x16x32_bf16 v[228:231], v[40:43], a[136:139], v[228:231]
    v_mfma_f32_16x16x32_bf16 v[232:235], v[44:47], a[64:67], v[232:235]
    v_mfma_f32_16x16x32_bf16 v[236:239], v[44:47], a[136:139], v[236:239]
    s_waitcnt lgkmcnt(2)
    v_mfma_f32_16x16x32_bf16 v[208:211], v[48:51], v[132:135], v[208:211]
    ds_read_b128 v[40:43], v3 offset:1024
    v_mfma_f32_16x16x32_bf16 v[212:215], v[48:51], v[204:207], v[212:215]
    ds_read_b128 v[44:47], v3 offset:19456
    v_mfma_f32_16x16x32_bf16 v[216:219], v[52:55], v[132:135], v[216:219]
    v_mfma_f32_16x16x32_bf16 v[220:223], v[52:55], v[204:207], v[220:223]
    v_mfma_f32_16x16x32_bf16 v[224:227], v[48:51], a[68:71], v[224:227]
    v_mfma_f32_16x16x32_bf16 v[228:231], v[48:51], a[140:143], v[228:231]
    v_mfma_f32_16x16x32_bf16 v[232:235], v[52:55], a[68:71], v[232:235]
    v_mfma_f32_16x16x32_bf16 v[236:239], v[52:55], a[140:143], v[236:239]
    s_add_u32 s26, s26, s41
    s_waitcnt vmcnt(0)
    v_cvt_pk_bf16_f32 v8, v208, v209
    v_cvt_pk_bf16_f32 v9, v210, v211
    v_cvt_pk_bf16_f32 v10, v216, v217
    v_cvt_pk_bf16_f32 v11, v218, v219
    v_cvt_pk_bf16_f32 v12, v212, v213
    v_cvt_pk_bf16_f32 v13, v214, v215
    v_cvt_pk_bf16_f32 v14, v220, v221
    v_cvt_pk_bf16_f32 v15, v222, v223
    v_cvt_pk_bf16_f32 v16, v224, v225
    v_cvt_pk_bf16_f32 v17, v226, v227
    v_cvt_pk_bf16_f32 v18, v232, v233
    v_cvt_pk_bf16_f32 v19, v234, v235
    v_cvt_pk_bf16_f32 v20, v228, v229
    v_cvt_pk_bf16_f32 v21, v230, v231
    v_cvt_pk_bf16_f32 v22, v236, v237
    v_cvt_pk_bf16_f32 v23, v238, v239
    s_mov_b64 s[36:37], -1
    s_add_u32 s28, s26, s12
    buffer_store_dwordx4 v[8:11], v7, s[4:7], s28 offen sc1
    s_add_u32 s28, s26, s13
    buffer_store_dwordx4 v[12:15], v7, s[4:7], s28 offen sc1
    s_add_u32 s28, s26, s14
    buffer_store_dwordx4 v[16:19], v7, s[4:7], s28 offen sc1
    s_add_u32 s28, s26, s15
    buffer_store_dwordx4 v[20:23], v7, s[4:7], s28 offen sc1
    s_lshr_b32 s45, s19, 2
    s_cbranch_scc1 qk_vloop_nf
    s_mov_b32 s45, 1
    s_mov_b64 s[36:37], 0
    s_waitcnt vmcnt(0)
    s_barrier
    s_add_u32 s23, s45, s95
    v_mov_b32 v4, s23
    s_mov_b64 exec, s[34:35]
    buffer_store_dword v4, off, s[4:7], s29 sc1
    s_mov_b64 exec, -1
qk_vloop_nf:
    s_add_u32 s19, s19, 4
    s_cmp_lt_u32 s19, s20
    s_cbranch_scc1 qk_vloop
qk_done:
    s_waitcnt vmcnt(0) lgkmcnt(0)
    s_barrier
    s_mov_b32 s45, 16
    s_add_u32 s23, s45, s95
    v_mov_b32 v4, s23
    s_mov_b64 exec, s[34:35]
    buffer_store_dword v4, off, s[4:7], s29 sc1
    s_mov_b64 exec, -1
    s_cmp_lt_i32 s33, 0
    s_cbranch_scc1 L_memkv
    v_max3_u32 v248, v240, v241, v242
    v_max3_u32 v248, v248, v243, v252
    v_max_u32 v248, v248, v253
    v_min3_u32 v240, v240, v241, v242
    v_min3_u32 v240, v240, v243, v252
    v_min_u32 v240, v240, v253
    v_lshl_add_u32 v248, v248, 16, v240
    v_readfirstlane_b32 s40, v245
    v_readfirstlane_b32 s41, v246
    v_readfirstlane_b32 s42, v247
    v_readfirstlane_b32 s43, v248
    s_cmp_ge_u32 s40, 160
    s_cselect_b32 s43, s43, 0
    s_cmp_ge_u32 s41, 1
    s_cselect_b32 s43, s43, 0
    s_cmp_eq_u32 s42, 1
    s_cselect_b32 s43, s43, 0
    s_cmp_eq_u32 s93, 1000
    s_cselect_b32 s43, s43, 0
    s_mov_b32 s93, 999
    v_mov_b32 v250, s43
    v_mov_b32 v251, 163832
    s_mov_b64 exec, s[34:35]
    ds_write_b32 v251, v250
    s_mov_b64 exec, -1
    s_waitcnt lgkmcnt(0)
    s_barrier
    ds_read_b32 v252, v251
    s_waitcnt lgkmcnt(0)
    v_readfirstlane_b32 s43, v252
    s_barrier
    s_cmp_lg_u32 s43, 2097184
    s_cbranch_scc1 L_qkv_next
    s_mov_b32 s45, s33
    s_mov_b32 s93, 500
    s_branch L_phase2b
L_memkv:
    v_and_b32 v4, 63, v0
    v_and_b32 v2, 7, v4
    v_lshrrev_b32 v5, 4, v4
    v_lshl_add_u32 v2, v5, 3, v2
    v_lshlrev_b32 v2, 4, v2
    v_bfe_u32 v3, v4, 3, 1
    v_mul_u32_u24 v5, 9216, v3
    v_add_u32 v2, v2, v5
    v_mov_b32 v240, 0x05040100
    v_mov_b32 v241, 0x07060302
    v_lshrrev_b32 v5, 5, v4
    v_and_b32 v1, 0xdff, v7
    s_cmp_eq_u32 s16, 2
    s_cbranch_scc1 mk_isv
    v_mov_b32 v5, v3
    v_or_b32 v1, 128, v7
mk_isv:
    v_lshl_add_u32 v1, v5, 17, v1
    s_mov_b32 s28, 0
    s_mov_b32 s19, 2
    s_mov_b32 s24, 138412032
    s_lshl_b32 s26, s17, 12
    s_mov_b32 s21, 69206016
    s_cmp_eq_u32 s16, 2
    s_cselect_b32 s21, 77594624, s21
    s_add_u32 s26, s26, s21
    s_lshl_b32 s29, s17, 10
    s_lshl_b32 s21, s16, 7
    s_add_u32 s29, s29, s21
    s_add_u32 s29, s29, 126092672
mk_loop:
    s_cmp_lg_u32 s18, 0
    s_cbranch_scc1 mk_go
    s_cmp_le_u32 s19, s28
    s_cbranch_scc1 mk_go
    s_mov_b32 s23, 125853696
    s_mov_b32 s21, 4194304
mk_wait:
    buffer_load_dword v4, off, s[4:7], s23 sc1
    s_sub_u32 s21, s21, 1
    s_cbranch_scc1 mk_go
    s_waitcnt vmcnt(0)
    v_readfirstlane_b32 s28, v4
    s_nop 0
    s_sub_u32 s28, s28, s95
    s_cmp_gt_u32 s28, 64
    s_cselect_b32 s28, 0, s28
    s_cmp_le_u32 s19, s28
    s_cbranch_scc1 mk_go
    s_sleep 4
    s_branch mk_wait
mk_go:
    s_barrier
    s_add_u32 s21, s24, 4096
    s_add_u32 s23, s24, 8192
    buffer_load_dwordx4 v[24:27], v2, s[4:7], s24 offen offset:0 sc1
    buffer_load_dwordx4 v[28:31], v2, s[4:7], s24 offen offset:512 sc1
    buffer_load_dwordx4 v[32:35], v2, s[4:7], s21 offen offset:0 sc1
    buffer_load_dwordx4 v[36:39], v2, s[4:7], s21 offen offset:512 sc1
    buffer_load_dwordx4 v[40:43], v2, s[4:7], s24 offen offset:1024 sc1
    buffer_load_dwordx4 v[44:47], v2, s[4:7], s24 offen offset:1536 sc1
    buffer_load_dwordx4 v[48:51], v2, s[4:7], s21 offen offset:1024 sc1
    buffer_load_dwordx4 v[52:55], v2, s[4:7], s21 offen offset:1536 sc1
    buffer_load_dwordx4 v[56:59], v2, s[4:7], s24 offen offset:2048 sc1
    buffer_load_dwordx4 v[60:63], v2, s[4:7], s24 offen offset:2560 sc1
    buffer_load_dwordx4 v[208:211], v2, s[4:7], s21 offen offset:2048 sc1
    buffer_load_dwordx4 v[212:215], v2, s[4:7], s21 offen offset:2560 sc1
    buffer_load_dwordx4 v[216:219], v2, s[4:7], s24 offen offset:3072 sc1
    buffer_load_dwordx4 v[220:223], v2, s[4:7], s24 offen offset:3584 sc1
    buffer_load_dwordx4 v[224:227], v2, s[4:7], s21 offen offset:3072 sc1
    buffer_load_dwordx4 v[228:231], v2, s[4:7], s21 offen offset:3584 sc1
    buffer_load_dwordx4 v[232:235], v2, s[4:7], s23 offen offset:0 sc1
    buffer_load_dwordx4 v[236:239], v2, s[4:7], s23 offen offset:512 sc1
    s_add_u32 s24, s24, 18432
    s_cmp_eq_u32 s16, 2
    s_cbranch_scc1 mk_v
    s_waitcnt vmcnt(17)
    s_waitcnt vmcnt(16)
    v_mfma_f32_16x16x32_bf16 v[8:11], v[64:67], v[24:27], 0
    v_mfma_f32_16x16x32_bf16 v[12:15], v[136:139], v[24:27], 0
    v_mfma_f32_16x16x32_bf16 v[16:19], a[0:3], v[24:27], 0
    v_mfma_f32_16x16x32_bf16 v[20:23], a[72:75], v[24:27], 0
    s_waitcnt vmcnt(15)
    v_mfma_f32_16x16x32_bf16 v[8:11], v[68:71], v[28:31], v[8:11]
    v_mfma_f32_16x16x32_bf16 v[12:15], v[140:143], v[28:31], v[12:15]
    v_mfma_f32_16x16x32_bf16 v[16:19], a[4:7], v[28:31], v[16:19]
    v_mfma_f32_16x16x32_bf16 v[20:23], a[76:79], v[28:31], v[20:23]
    s_waitcnt vmcnt(14)
    v_mfma_f32_16x16x32_bf16 v[8:11], v[72:75], v[32:35], v[8:11]
    v_mfma_f32_16x16x32_bf16 v[12:15], v[144:147], v[32:35], v[12:15]
    v_mfma_f32_16x16x32_bf16 v[16:19], a[8:11], v[32:35], v[16:19]
    v_mfma_f32_16x16x32_bf16 v[20:23], a[80:83], v[32:35], v[20:23]
    s_waitcnt vmcnt(13)
    v_mfma_f32_16x16x32_bf16 v[8:11], v[76:79], v[36:39], v[8:11]
    v_mfma_f32_16x16x32_bf16 v[12:15], v[148:151], v[36:39], v[12:15]
    v_mfma_f32_16x16x32_bf16 v[16:19], a[12:15], v[36:39], v[16:19]
    v_mfma_f32_16x16x32_bf16 v[20:23], a[84:87], v[36:39], v[20:23]
    s_waitcnt vmcnt(12)
    v_mfma_f32_16x16x32_bf16 v[8:11], v[80:83], v[40:43], v[8:11]
    v_mfma_f32_16x16x32_bf16 v[12:15], v[152:155], v[40:43], v[12:15]
    v_mfma_f32_16x16x32_bf16 v[16:19], a[16:19], v[40:43], v[16:19]
    v_mfma_f32_16x16x32_bf16 v[20:23], a[88:91], v[40:43], v[20:23]
    s_waitcnt vmcnt(11)
    v_mfma_f32_16x16x32_bf16 v[8:11], v[84:87], v[44:47], v[8:11]
    v_mfma_f32_16x16x32_bf16 v[12:15], v[156:159], v[44:47], v[12:15]
    v_mfma_f32_16x16x32_bf16 v[16:19], a[20:23], v[44:47], v[16:19]
    v_mfma_f32_16x16x32_bf16 v[20:23], a[92:95], v[44:47], v[20:23]
    s_waitcnt vmcnt(10)
    v_mfma_f32_16x16x32_bf16 v[8:11], v[88:91], v[48:51], v[8:11]
    v_mfma_f32_16x16x32_bf16 v[12:15], v[160:163], v[48:51], v[12:15]
    v_mfma_f32_16x16x32_bf16 v[16:19], a[24:27], v[48:51], v[16:19]
    v_mfma_f32_16x16x32_bf16 v[20:23], a[96:99], v[48:51], v[20:23]
    s_waitcnt vmcnt(9)
    v_mfma_f32_16x16x32_bf16 v[8:11], v[92:95], v[52:55], v[8:11]
    v_mfma_f32_16x16x32_bf16 v[12:15], v[164:167], v[52:55], v[12:15]
    v_mfma_f32_16x16x32_bf16 v[16:19], a[28:31], v[52:55], v[16:19]
    v_mfma_f32_16x16x32_bf16 v[20:23], a[100:103], v[52:55], v[20:23]
    s_waitcnt vmcnt(8)
    v_mfma_f32_16x16x32_bf16 v[8:11], v[96:99], v[56:59], v[8:11]
    v_mfma_f32_16x16x32_bf16 v[12:15], v[168:171], v[56:59], v[12:15]
    v_mfma_f32_16x16x32_bf16 v[16:19], a[32:35], v[56:59], v[16:19]
    v_mfma_f32_16x16x32_bf16 v[20:23], a[104:107], v[56:59], v[20:23]
    s_waitcnt vmcnt(7)
    v_mfma_f32_16x16x32_bf16 v[8:11], v[100:103], v[60:63], v[8:11]
    v_mfma_f32_16x16x32_bf16 v[12:15], v[172:175], v[60:63], v[12:15]
    v_mfma_f32_16x16x32_bf16 v[16:19], a[36:39], v[60:63], v[16:19]
    v_mfma_f32_16x16x32_bf16 v[20:23], a[108:111], v[60:63], v[20:23]
    s_waitcnt vmcnt(6)
    v_mfma_f32_16x16x32_bf16 v[8:11], v[104:107], v[208:211], v[8:11]
    v_mfma_f32_16x16x32_bf16 v[12:15], v[176:179], v[208:211], v[12:15]
    v_mfma_f32_16x16x32_bf16 v[16:19], a[40:43], v[208:211], v[16:19]
    v_mfma_f32_16x16x32_bf16 v[20:23], a[112:115], v[208:211], v[20:23]
    s_waitcnt vmcnt(5)
    v_mfma_f32_16x16x32_bf16 v[8:11], v[108:111], v[212:215], v[8:11]
    v_mfma_f32_16x16x32_bf16 v[12:15], v[180:183], v[212:215], v[12:15]
    v_mfma_f32_16x16x32_bf16 v[16:19], a[44:47], v[212:215], v[16:19]
    v_mfma_f32_16x16x32_bf16 v[20:23], a[116:119], v[212:215], v[20:23]
    s_waitcnt vmcnt(4)
    v_mfma_f32_16x16x32_bf16 v[8:11], v[112:115], v[216:219], v[8:11]
    v_mfma_f32_16x16x32_bf16 v[12:15], v[184:187], v[216:219], v[12:15]
    v_mfma_f32_16x16x32_bf16 v[16:19], a[48:51], v[216:219], v[16:19]
    v_mfma_f32_16x16x32_bf16 v[20:23], a[120:123], v[216:219], v[20:23]
    s_waitcnt vmcnt(3)
    v_mfma_f32_16x16x32_bf16 v[8:11], v[116:119], v[220:223], v[8:11]
    v_mfma_f32_16x16x32_bf16 v[12:15], v[188:191], v[220:223], v[12:15]
    v_mfma_f32_16x16x32_bf16 v[16:19], a[52:55], v[220:223], v[16:19]
    v_mfma_f32_16x16x32_bf16 v[20:23], a[124:127], v[220:223], v[20:23]
    s_waitcnt vmcnt(2)
    v_mfma_f32_16x16x32_bf16 v[8:11], v[120:123], v[224:227], v[8:11]
    v_mfma_f32_16x16x32_bf16 v[12:15], v[192:195], v[224:227], v[12:15]
    v_mfma_f32_16x16x32_bf16 v[16:19], a[56:59], v[224:227], v[16:19]
    v_mfma_f32_16x16x32_bf16 v[20:23], a[128:131], v[224:227], v[20:23]
    s_waitcnt vmcnt(1)
    v_mfma_f32_16x16x32_bf16 v[8:11], v[124:127], v[228:231], v[8:11]
    v_mfma_f32_16x16x32_bf16 v[12:15], v[196:199], v[228:231], v[12:15]
    v_mfma_f32_16x16x32_bf16 v[16:19], a[60:63], v[228:231], v[16:19]
    v_mfma_f32_16x16x32_bf16 v[20:23], a[132:135], v[228:231], v[20:23]
    s_waitcnt vmcnt(0)
    v_mfma_f32_16x16x32_bf16 v[8:11], v[128:131], v[232:235], v[8:11]
    v_mfma_f32_16x16x32_bf16 v[12:15], v[200:203], v[232:235], v[12:15]
    v_mfma_f32_16x16x32_bf16 v[16:19], a[64:67], v[232:235], v[16:19]
    v_mfma_f32_16x16x32_bf16 v[20:23], a[136:139], v[232:235], v[20:23]
    v_mfma_f32_16x16x32_bf16 v[8:11], v[132:135], v[236:239], v[8:11]
    v_mfma_f32_16x16x32_bf16 v[12:15], v[204:207], v[236:239], v[12:15]
    v_mfma_f32_16x16x32_bf16 v[16:19], a[68:71], v[236:239], v[16:19]
    v_mfma_f32_16x16x32_bf16 v[20:23], a[140:143], v[236:239], v[20:23]
    s_nop 7
    s_branch mk_st
mk_v:
    s_waitcnt vmcnt(17)
    s_waitcnt vmcnt(16)
    v_mfma_f32_16x16x32_bf16 v[8:11], v[24:27], v[64:67], 0
    v_mfma_f32_16x16x32_bf16 v[12:15], v[24:27], v[136:139], 0
    v_mfma_f32_16x16x32_bf16 v[16:19], v[24:27], a[0:3], 0
    v_mfma_f32_16x16x32_bf16 v[20:23], v[24:27], a[72:75], 0
    s_waitcnt vmcnt(15)
    v_mfma_f32_16x16x32_bf16 v[8:11], v[28:31], v[68:71], v[8:11]
    v_mfma_f32_16x16x32_bf16 v[12:15], v[28:31], v[140:143], v[12:15]
    v_mfma_f32_16x16x32_bf16 v[16:19], v[28:31], a[4:7], v[16:19]
    v_mfma_f32_16x16x32_bf16 v[20:23], v[28:31], a[76:79], v[20:23]
    s_waitcnt vmcnt(14)
    v_mfma_f32_16x16x32_bf16 v[8:11], v[32:35], v[72:75], v[8:11]
    v_mfma_f32_16x16x32_bf16 v[12:15], v[32:35], v[144:147], v[12:15]
    v_mfma_f32_16x16x32_bf16 v[16:19], v[32:35], a[8:11], v[16:19]
    v_mfma_f32_16x16x32_bf16 v[20:23], v[32:35], a[80:83], v[20:23]
    s_waitcnt vmcnt(13)
    v_mfma_f32_16x16x32_bf16 v[8:11], v[36:39], v[76:79], v[8:11]
    v_mfma_f32_16x16x32_bf16 v[12:15], v[36:39], v[148:151], v[12:15]
    v_mfma_f32_16x16x32_bf16 v[16:19], v[36:39], a[12:15], v[16:19]
    v_mfma_f32_16x16x32_bf16 v[20:23], v[36:39], a[84:87], v[20:23]
    s_waitcnt vmcnt(12)
    v_mfma_f32_16x16x32_bf16 v[8:11], v[40:43], v[80:83], v[8:11]
    v_mfma_f32_16x16x32_bf16 v[12:15], v[40:43], v[152:155], v[12:15]
    v_mfma_f32_16x16x32_bf16 v[16:19], v[40:43], a[16:19], v[16:19]
    v_mfma_f32_16x16x32_bf16 v[20:23], v[40:43], a[88:91], v[20:23]
    s_waitcnt vmcnt(11)
    v_mfma_f32_16x16x32_bf16 v[8:11], v[44:47], v[84:87], v[8:11]
    v_mfma_f32_16x16x32_bf16 v[12:15], v[44:47], v[156:159], v[12:15]
    v_mfma_f32_16x16x32_bf16 v[16:19], v[44:47], a[20:23], v[16:19]
    v_mfma_f32_16x16x32_bf16 v[20:23], v[44:47], a[92:95], v[20:23]
    s_waitcnt vmcnt(10)
    v_mfma_f32_16x16x32_bf16 v[8:11], v[48:51], v[88:91], v[8:11]
    v_mfma_f32_16x16x32_bf16 v[12:15], v[48:51], v[160:163], v[12:15]
    v_mfma_f32_16x16x32_bf16 v[16:19], v[48:51], a[24:27], v[16:19]
    v_mfma_f32_16x16x32_bf16 v[20:23], v[48:51], a[96:99], v[20:23]
    s_waitcnt vmcnt(9)
    v_mfma_f32_16x16x32_bf16 v[8:11], v[52:55], v[92:95], v[8:11]
    v_mfma_f32_16x16x32_bf16 v[12:15], v[52:55], v[164:167], v[12:15]
    v_mfma_f32_16x16x32_bf16 v[16:19], v[52:55], a[28:31], v[16:19]
    v_mfma_f32_16x16x32_bf16 v[20:23], v[52:55], a[100:103], v[20:23]
    s_waitcnt vmcnt(8)
    v_mfma_f32_16x16x32_bf16 v[8:11], v[56:59], v[96:99], v[8:11]
    v_mfma_f32_16x16x32_bf16 v[12:15], v[56:59], v[168:171], v[12:15]
    v_mfma_f32_16x16x32_bf16 v[16:19], v[56:59], a[32:35], v[16:19]
    v_mfma_f32_16x16x32_bf16 v[20:23], v[56:59], a[104:107], v[20:23]
    s_waitcnt vmcnt(7)
    v_mfma_f32_16x16x32_bf16 v[8:11], v[60:63], v[100:103], v[8:11]
    v_mfma_f32_16x16x32_bf16 v[12:15], v[60:63], v[172:175], v[12:15]
    v_mfma_f32_16x16x32_bf16 v[16:19], v[60:63], a[36:39], v[16:19]
    v_mfma_f32_16x16x32_bf16 v[20:23], v[60:63], a[108:111], v[20:23]
    s_waitcnt vmcnt(6)
    v_mfma_f32_16x16x32_bf16 v[8:11], v[208:211], v[104:107], v[8:11]
    v_mfma_f32_16x16x32_bf16 v[12:15], v[208:211], v[176:179], v[12:15]
    v_mfma_f32_16x16x32_bf16 v[16:19], v[208:211], a[40:43], v[16:19]
    v_mfma_f32_16x16x32_bf16 v[20:23], v[208:211], a[112:115], v[20:23]
    s_waitcnt vmcnt(5)
    v_mfma_f32_16x16x32_bf16 v[8:11], v[212:215], v[108:111], v[8:11]
    v_mfma_f32_16x16x32_bf16 v[12:15], v[212:215], v[180:183], v[12:15]
    v_mfma_f32_16x16x32_bf16 v[16:19], v[212:215], a[44:47], v[16:19]
    v_mfma_f32_16x16x32_bf16 v[20:23], v[212:215], a[116:119], v[20:23]
    s_waitcnt vmcnt(4)
    v_mfma_f32_16x16x32_bf16 v[8:11], v[216:219], v[112:115], v[8:11]
    v_mfma_f32_16x16x32_bf16 v[12:15], v[216:219], v[184:187], v[12:15]
    v_mfma_f32_16x16x32_bf16 v[16:19], v[216:219], a[48:51], v[16:19]
    v_mfma_f32_16x16x32_bf16 v[20:23], v[216:219], a[120:123], v[20:23]
    s_waitcnt vmcnt(3)
    v_mfma_f32_16x16x32_bf16 v[8:11], v[220:223], v[116:119], v[8:11]
    v_mfma_f32_16x16x32_bf16 v[12:15], v[220:223], v[188:191], v[12:15]
    v_mfma_f32_16x16x32_bf16 v[16:19], v[220:223], a[52:55], v[16:19]
    v_mfma_f32_16x16x32_bf16 v[20:23], v[220:223], a[124:127], v[20:23]
    s_waitcnt vmcnt(2)
    v_mfma_f32_16x16x32_bf16 v[8:11], v[224:227], v[120:123], v[8:11]
    v_mfma_f32_16x16x32_bf16 v[12:15], v[224:227], v[192:195], v[12:15]
    v_mfma_f32_16x16x32_bf16 v[16:19], v[224:227], a[56:59], v[16:19]
    v_mfma_f32_16x16x32_bf16 v[20:23], v[224:227], a[128:131], v[20:23]
    s_waitcnt vmcnt(1)
    v_mfma_f32_16x16x32_bf16 v[8:11], v[228:231], v[124:127], v[8:11]
    v_mfma_f32_16x16x32_bf16 v[12:15], v[228:231], v[196:199], v[12:15]
    v_mfma_f32_16x16x32_bf16 v[16:19], v[228:231], a[60:63], v[16:19]
    v_mfma_f32_16x16x32_bf16 v[20:23], v[228:231], a[132:135], v[20:23]
    s_waitcnt vmcnt(0)
    v_mfma_f32_16x16x32_bf16 v[8:11], v[232:235], v[128:131], v[8:11]
    v_mfma_f32_16x16x32_bf16 v[12:15], v[232:235], v[200:203], v[12:15]
    v_mfma_f32_16x16x32_bf16 v[16:19], v[232:235], a[64:67], v[16:19]
    v_mfma_f32_16x16x32_bf16 v[20:23], v[232:235], a[136:139], v[20:23]
    v_mfma_f32_16x16x32_bf16 v[8:11], v[236:239], v[132:135], v[8:11]
    v_mfma_f32_16x16x32_bf16 v[12:15], v[236:239], v[204:207], v[12:15]
    v_mfma_f32_16x16x32_bf16 v[16:19], v[236:239], a[68:71], v[16:19]
    v_mfma_f32_16x16x32_bf16 v[20:23], v[236:239], a[140:143], v[20:23]
    s_nop 4
    v_pk_mul_f32 v[8:9], v[8:9], 0.5 op_sel_hi:[1,0]
    v_pk_mul_f32 v[10:11], v[10:11], 0.5 op_sel_hi:[1,0]
    v_pk_mul_f32 v[12:13], v[12:13], 0.5 op_sel_hi:[1,0]
    v_pk_mul_f32 v[14:15], v[14:15], 0.5 op_sel_hi:[1,0]
    v_pk_mul_f32 v[16:17], v[16:17], 0.5 op_sel_hi:[1,0]
    v_pk_mul_f32 v[18:19], v[18:19], 0.5 op_sel_hi:[1,0]
    v_pk_mul_f32 v[20:21], v[20:21], 0.5 op_sel_hi:[1,0]
    v_pk_mul_f32 v[22:23], v[22:23], 0.5 op_sel_hi:[1,0]
mk_st:
    s_nop 1
    v_cvt_pk_bf16_f32 v24, v8, v9
    v_cvt_pk_bf16_f32 v25, v10, v11
    v_cvt_pk_bf16_f32 v26, v12, v13
    v_cvt_pk_bf16_f32 v27, v14, v15
    v_cvt_pk_bf16_f32 v28, v16, v17
    v_cvt_pk_bf16_f32 v29, v18, v19
    v_cvt_pk_bf16_f32 v30, v20, v21
    v_cvt_pk_bf16_f32 v31, v22, v23
    s_add_u32 s21, s26, 4096
    buffer_store_dwordx4 v[24:27], v1, s[4:7], s26 offen sc1
    buffer_store_dwordx4 v[28:31], v1, s[4:7], s21 offen sc1
    s_add_u32 s22, s19, s95
    s_waitcnt vmcnt(0)
    s_barrier
    v_mov_b32 v4, s22
    s_mov_b64 exec, s[34:35]
    buffer_store_dword v4, off, s[4:7], s29 sc1
    s_mov_b64 exec, -1
    s_add_u32 s19, s19, 2
    s_add_u32 s26, s26, 262144
    s_cmp_le_u32 s19, 56
    s_cbranch_scc1 mk_loop
    s_mov_b32 s45, 0
    s_cmp_lg_u32 s93, 1000
    s_cbranch_scc1 L_wf_next
    s_mov_b32 s45, 2
    s_mov_b32 s8, s76
    s_mov_b32 s9, s77
    s_mov_b32 s10, 4718592
    s_mov_b32 s11, 0x20000
    s_branch L_att_next
L_ssm_next:
    s_sub_u32 s93, s93, 1
    s_cbranch_scc1 L_exit
    s_sub_u32 s46, s3, 2
    s_cmp_lt_u32 s3, 2
    s_cselect_b32 s46, s3, s46
    s_cmp_lt_u32 s46, 6
    s_cselect_b32 s46, s46, 0
    s_cmp_gt_u32 s93, 500
    s_cselect_b32 s47, 6, 1
    s_cmp_le_u32 s45, 1
    s_cselect_b32 s47, 6, s47
L_sq:
    s_lshl_b32 s40, s46, 2
    s_add_u32 s40, s40, 56
    s_mov_b32 s37, s40
    v_mov_b32 v250, 1
    v_mov_b32 v251, 163832
    v_cmp_eq_u32 vcc, 0, v0
    s_nop 0
    s_and_saveexec_b64 s[38:39], vcc
    s_cbranch_execz tk12
    buffer_atomic_add v250, off, s[84:87], s37 sc0
    s_waitcnt vmcnt(0)
    ds_write_b32 v251, v250
    s_waitcnt lgkmcnt(0)
tk12:
    s_mov_b64 exec, -1
    s_barrier
    ds_read_b32 v252, v251
    s_waitcnt lgkmcnt(0)
    v_readfirstlane_b32 s20, v252
    s_barrier
    s_nop 3
    s_cmp_lt_u32 s20, 12
    s_cbranch_scc1 L_sgo
    s_add_u32 s46, s46, 1
    s_cmp_lt_u32 s46, 6
    s_cselect_b32 s46, s46, 0
    s_sub_u32 s47, s47, 1
    s_cmp_lg_u32 s47, 0
    s_cbranch_scc1 L_sq
    s_branch L_ssm_done
L_sgo:
    s_mul_i32 s46, s46, 12
    s_add_u32 s20, s20, s46
    s_lshl_b32 s20, s20, 3
    v_lshrrev_b32 v5, 6, v0
    s_nop 0
    v_readfirstlane_b32 s21, v5
    v_and_b32 v1, 63, v0
    v_and_b32 v2, 15, v1
    v_lshrrev_b32 v3, 4, v1
    v_lshlrev_b32 v4, 14, v5
    s_mov_b32 s8, s62
    s_mov_b32 s9, s63
    s_mov_b32 s10, 2359296
    s_mov_b32 s11, 0x20000
    s_mov_b32 s16, s76
    s_mov_b32 s17, s77
    s_mov_b32 s18, 4718592
    s_mov_b32 s19, 0x20000
    s_add_u32 s22, s20, s21
    s_lshl_b32 s23, s22, 8
    v_lshlrev_b32 v6, 3, v2
    v_lshl_add_u32 v6, v3, 1, v6
    s_mov_b32 s12, s64
    s_mov_b32 s13, s65
    s_mov_b32 s14, 147456
    s_mov_b32 s15, 0x20000
    buffer_load_ushort v8, v6, s[12:15], s23 offen offset:0
    buffer_load_ushort v12, v6, s[12:15], s23 offen offset:128
    buffer_load_ushort v16, v6, s[12:15], s23 offen offset:1024
    buffer_load_ushort v20, v6, s[12:15], s23 offen offset:1152
    s_mov_b32 s12, s66
    s_mov_b32 s13, s67
    s_mov_b32 s14, 147456
    s_mov_b32 s15, 0x20000
    buffer_load_ushort v9, v6, s[12:15], s23 offen offset:0
    buffer_load_ushort v13, v6, s[12:15], s23 offen offset:128
    buffer_load_ushort v17, v6, s[12:15], s23 offen offset:1024
    buffer_load_ushort v21, v6, s[12:15], s23 offen offset:1152
    s_mov_b32 s12, s68
    s_mov_b32 s13, s69
    s_mov_b32 s14, 147456
    s_mov_b32 s15, 0x20000
    buffer_load_ushort v10, v6, s[12:15], s23 offen offset:0
    buffer_load_ushort v14, v6, s[12:15], s23 offen offset:128
    buffer_load_ushort v18, v6, s[12:15], s23 offen offset:1024
    buffer_load_ushort v22, v6, s[12:15], s23 offen offset:1152
    s_mov_b32 s12, s70
    s_mov_b32 s13, s71
    s_mov_b32 s14, 147456
    s_mov_b32 s15, 0x20000
    buffer_load_ushort v11, v6, s[12:15], s23 offen offset:0
    buffer_load_ushort v15, v6, s[12:15], s23 offen offset:128
    buffer_load_ushort v19, v6, s[12:15], s23 offen offset:1024
    buffer_load_ushort v23, v6, s[12:15], s23 offen offset:1152
    s_mov_b32 s12, s72
    s_mov_b32 s13, s73
    s_mov_b32 s14, 1152
    s_mov_b32 s15, 0x20000
    s_lshl_b32 s23, s22, 1
    buffer_load_ushort v24, off, s[12:15], s23
    buffer_load_ushort v25, off, s[12:15], s23 offset:8
    v_mul_u32_u24 v5, 9216, v0
    s_lshl_b32 s22, s20, 1
    s_add_u32 s23, s22, 0
    buffer_load_dwordx4 v[208:211], v5, s[8:11], s23 offen
    s_add_u32 s23, s22, 1152
    buffer_load_dwordx4 v[212:215], v5, s[8:11], s23 offen
    s_add_u32 s23, s22, 2304
    buffer_load_dwordx4 v[216:219], v5, s[8:11], s23 offen
    s_add_u32 s23, s22, 3456
    buffer_load_dwordx4 v[220:223], v5, s[8:11], s23 offen
    s_add_u32 s23, s22, 4608
    buffer_load_dwordx4 v[224:227], v5, s[8:11], s23 offen
    s_add_u32 s23, s22, 5760
    buffer_load_dwordx4 v[228:231], v5, s[8:11], s23 offen
    s_add_u32 s23, s22, 6912
    buffer_load_dwordx4 v[232:235], v5, s[8:11], s23 offen
    s_add_u32 s23, s22, 8064
    buffer_load_dwordx4 v[236:239], v5, s[8:11], s23 offen
    s_mov_b32 s26, 0x3fb8aa3b
    s_mov_b32 s27, 0x3e22f983
    s_mov_b32 s28, 0
    v_cvt_f32_u32 v26, v2
    v_mul_f32 v27, 0x41800000, v26
    s_waitcnt vmcnt(8)
    s_nop 0
ss_pass:
    v_mov_b32 v36, 0
    v_mov_b32 v37, 0
    v_lshl_add_u32 v6, v1, 3, v4
    ds_write_b64 v6, v[36:37] offset:0
    v_lshlrev_b32 v38, 16, v24
    v_mul_f32 v38, s26, v38
    v_exp_f32 v38, v38
    s_nop 0
    v_cvt_pk_bf16_f32 v38, v38, v38
    v_and_b32 v38, 0xffff0000, v38
    v_add_f32 v39, v38, v38
    v_lshlrev_b32 v28, 16, v8
    v_mul_f32 v28, s26, v28
    v_exp_f32 v28, v28
    s_nop 0
    v_cvt_pk_bf16_f32 v28, v28, v28
    v_and_b32 v28, 0xffff0000, v28
    v_mul_f32 v28, v28, v38
    v_mul_f32 v28, s26, v28
    v_sub_f32 v28, 0, v28
    v_lshlrev_b32 v29, 16, v9
    v_mul_f32 v29, v29, v38
    v_mul_f32 v29, s27, v29
    v_lshlrev_b32 v30, 16, v10
    v_mul_f32 v30, v30, v39
    v_lshlrev_b32 v31, 16, v11
    v_mul_f32 v31, v31, v39
    v_lshlrev_b32 v32, 16, v12
    v_mul_f32 v32, s26, v32
    v_exp_f32 v32, v32
    s_nop 0
    v_cvt_pk_bf16_f32 v32, v32, v32
    v_and_b32 v32, 0xffff0000, v32
    v_mul_f32 v32, v32, v38
    v_mul_f32 v32, s26, v32
    v_sub_f32 v32, 0, v32
    v_lshlrev_b32 v33, 16, v13
    v_mul_f32 v33, v33, v38
    v_mul_f32 v33, s27, v33
    v_lshlrev_b32 v34, 16, v14
    v_mul_f32 v34, v34, v39
    v_lshlrev_b32 v35, 16, v15
    v_mul_f32 v35, v35, v39
    v_mov_b64 v[48:49], 0
    v_mov_b64 v[50:51], 0
    v_mov_b64 v[52:53], 0
    v_mov_b64 v[54:55], 0
    v_mov_b64 v[56:57], 0
    v_mov_b64 v[58:59], 0
    v_mov_b64 v[60:61], 0
    v_mov_b64 v[62:63], 0
    s_mov_b32 s25, 0
    s_nop 0
ss_kg:
    v_mov_b64_dpp v[64:65], v[28:29] row_newbcast:0 row_mask:0xf bank_mask:0xf
    v_mov_b64_dpp v[66:67], v[30:31] row_newbcast:0 row_mask:0xf bank_mask:0xf
    v_pk_mul_f32 v[94:95], v[64:65], v[26:27] op_sel_hi:[1,0]
    v_pk_mul_f32 v[96:97], v[64:65], v[26:27] op_sel:[0,1] op_sel_hi:[1,1]
    v_fract_f32 v95, v95
    v_fract_f32 v97, v97
    v_exp_f32 v94, v94
    v_exp_f32 v96, v96
    v_cos_f32 v68, v95
    v_sin_f32 v69, v95
    v_cos_f32 v76, v97
    v_sin_f32 v77, v97
    v_pk_mul_f32 v[68:69], v[68:69], v[94:95] op_sel_hi:[1,0]
    v_pk_mul_f32 v[76:77], v[76:77], v[96:97] op_sel_hi:[1,0]
    v_pk_mul_f32 v[92:93], v[76:77], v[76:77] op_sel:[1,1] op_sel_hi:[0,1]
    v_pk_fma_f32 v[78:79], v[76:77], v[76:77], v[92:93] op_sel:[0,0,0] op_sel_hi:[0,1,1] neg_lo:[0,0,1]
    v_pk_mul_f32 v[94:95], v[68:69], v[68:69] op_sel:[1,1] op_sel_hi:[0,1]
    v_pk_fma_f32 v[70:71], v[68:69], v[68:69], v[94:95] op_sel:[0,0,0] op_sel_hi:[0,1,1] neg_lo:[0,0,1]
    v_pk_mul_f32 v[92:93], v[78:79], v[78:79] op_sel:[1,1] op_sel_hi:[0,1]
    v_pk_fma_f32 v[80:81], v[78:79], v[78:79], v[92:93] op_sel:[0,0,0] op_sel_hi:[0,1,1] neg_lo:[0,0,1]
    v_pk_mul_f32 v[94:95], v[70:71], v[70:71] op_sel:[1,1] op_sel_hi:[0,1]
    v_pk_fma_f32 v[72:73], v[70:71], v[70:71], v[94:95] op_sel:[0,0,0] op_sel_hi:[0,1,1] neg_lo:[0,0,1]
    v_pk_mul_f32 v[92:93], v[80:81], v[80:81] op_sel:[1,1] op_sel_hi:[0,1]
    v_pk_fma_f32 v[82:83], v[80:81], v[80:81], v[92:93] op_sel:[0,0,0] op_sel_hi:[0,1,1] neg_lo:[0,0,1]
    v_pk_mul_f32 v[94:95], v[72:73], v[72:73] op_sel:[1,1] op_sel_hi:[0,1]
    v_pk_fma_f32 v[74:75], v[72:73], v[72:73], v[94:95] op_sel:[0,0,0] op_sel_hi:[0,1,1] neg_lo:[0,0,1]
    v_pk_mul_f32 v[92:93], v[82:83], v[82:83] op_sel:[1,1] op_sel_hi:[0,1]
    v_pk_fma_f32 v[84:85], v[82:83], v[82:83], v[92:93] op_sel:[0,0,0] op_sel_hi:[0,1,1] neg_lo:[0,0,1]
    v_pk_mul_f32 v[94:95], v[66:67], v[76:77] op_sel:[1,1] op_sel_hi:[1,0]
    v_pk_fma_f32 v[86:87], v[66:67], v[76:77], v[94:95] op_sel:[0,0,0] op_sel_hi:[0,1,1] neg_lo:[0,0,1] neg_hi:[1,0,1]
    v_mov_b32_dpp v80, v78 row_ror:8 row_mask:0xf bank_mask:0x3
    v_mov_b32_dpp v81, v79 row_ror:8 row_mask:0xf bank_mask:0x3
    v_mov_b32_dpp v82, v84 row_ror:8 row_mask:0xf bank_mask:0x3
    v_mov_b32_dpp v83, v85 row_ror:8 row_mask:0xf bank_mask:0x3
    v_pk_mul_f32 v[92:93], v[66:67], v[80:81] op_sel:[1,1] op_sel_hi:[1,0]
    v_pk_fma_f32 v[88:89], v[66:67], v[80:81], v[92:93] op_sel:[0,0,0] op_sel_hi:[0,1,1] neg_lo:[0,0,1] neg_hi:[1,0,1]
    v_pk_mul_f32 v[94:95], v[66:67], v[82:83] op_sel:[1,1] op_sel_hi:[1,0]
    v_pk_fma_f32 v[90:91], v[66:67], v[82:83], v[94:95] op_sel:[0,0,0] op_sel_hi:[0,1,1] neg_lo:[0,0,1] neg_hi:[1,0,1]
    v_mfma_f32_16x16x4_f32 v[48:51], v86, v68, v[48:51]
    v_mfma_f32_16x16x4_f32 v[52:55], v88, v70, v[52:55]
    v_mfma_f32_16x16x4_f32 v[56:59], v88, v72, v[56:59]
    v_mfma_f32_16x16x4_f32 v[60:63], v90, v74, v[60:63]
    v_mfma_f32_16x16x4_f32 v[48:51], v87, v69, v[48:51]
    v_mfma_f32_16x16x4_f32 v[52:55], v89, v71, v[52:55]
    v_mfma_f32_16x16x4_f32 v[56:59], v89, v73, v[56:59]
    v_mfma_f32_16x16x4_f32 v[60:63], v91, v75, v[60:63]
    v_mov_b64_dpp v[64:65], v[28:29] row_newbcast:1 row_mask:0xf bank_mask:0xf
    v_mov_b64_dpp v[66:67], v[30:31] row_newbcast:1 row_mask:0xf bank_mask:0xf
    v_pk_mul_f32 v[94:95], v[64:65], v[26:27] op_sel_hi:[1,0]
    v_pk_mul_f32 v[96:97], v[64:65], v[26:27] op_sel:[0,1] op_sel_hi:[1,1]
    v_fract_f32 v95, v95
    v_fract_f32 v97, v97
    v_exp_f32 v94, v94
    v_exp_f32 v96, v96
    v_cos_f32 v68, v95
    v_sin_f32 v69, v95
    v_cos_f32 v76, v97
    v_sin_f32 v77, v97
    v_pk_mul_f32 v[68:69], v[68:69], v[94:95] op_sel_hi:[1,0]
    v_pk_mul_f32 v[76:77], v[76:77], v[96:97] op_sel_hi:[1,0]
    v_pk_mul_f32 v[92:93], v[76:77], v[76:77] op_sel:[1,1] op_sel_hi:[0,1]
    v_pk_fma_f32 v[78:79], v[76:77], v[76:77], v[92:93] op_sel:[0,0,0] op_sel_hi:[0,1,1] neg_lo:[0,0,1]
    v_pk_mul_f32 v[94:95], v[68:69], v[68:69] op_sel:[1,1] op_sel_hi:[0,1]
    v_pk_fma_f32 v[70:71], v[68:69], v[68:69], v[94:95] op_sel:[0,0,0] op_sel_hi:[0,1,1] neg_lo:[0,0,1]
    v_pk_mul_f32 v[92:93], v[78:79], v[78:79] op_sel:[1,1] op_sel_hi:[0,1]
    v_pk_fma_f32 v[80:81], v[78:79], v[78:79], v[92:93] op_sel:[0,0,0] op_sel_hi:[0,1,1] neg_lo:[0,0,1]
    v_pk_mul_f32 v[94:95], v[70:71], v[70:71] op_sel:[1,1] op_sel_hi:[0,1]
    v_pk_fma_f32 v[72:73], v[70:71], v[70:71], v[94:95] op_sel:[0,0,0] op_sel_hi:[0,1,1] neg_lo:[0,0,1]
    v_pk_mul_f32 v[92:93], v[80:81], v[80:81] op_sel:[1,1] op_sel_hi:[0,1]
    v_pk_fma_f32 v[82:83], v[80:81], v[80:81], v[92:93] op_sel:[0,0,0] op_sel_hi:[0,1,1] neg_lo:[0,0,1]
    v_pk_mul_f32 v[94:95], v[72:73], v[72:73] op_sel:[1,1] op_sel_hi:[0,1]
    v_pk_fma_f32 v[74:75], v[72:73], v[72:73], v[94:95] op_sel:[0,0,0] op_sel_hi:[0,1,1] neg_lo:[0,0,1]
    v_pk_mul_f32 v[92:93], v[82:83], v[82:83] op_sel:[1,1] op_sel_hi:[0,1]
    v_pk_fma_f32 v[84:85], v[82:83], v[82:83], v[92:93] op_sel:[0,0,0] op_sel_hi:[0,1,1] neg_lo:[0,0,1]
    v_pk_mul_f32 v[94:95], v[66:67], v[76:77] op_sel:[1,1] op_sel_hi:[1,0]
    v_pk_fma_f32 v[86:87], v[66:67], v[76:77], v[94:95] op_sel:[0,0,0] op_sel_hi:[0,1,1] neg_lo:[0,0,1] neg_hi:[1,0,1]
    v_mov_b32_dpp v80, v78 row_ror:8 row_mask:0xf bank_mask:0x3
    v_mov_b32_dpp v81, v79 row_ror:8 row_mask:0xf bank_mask:0x3
    v_mov_b32_dpp v82, v84 row_ror:8 row_mask:0xf bank_mask:0x3
    v_mov_b32_dpp v83, v85 row_ror:8 row_mask:0xf bank_mask:0x3
    v_pk_mul_f32 v[92:93], v[66:67], v[80:81] op_sel:[1,1] op_sel_hi:[1,0]
    v_pk_fma_f32 v[88:89], v[66:67], v[80:81], v[92:93] op_sel:[0,0,0] op_sel_hi:[0,1,1] neg_lo:[0,0,1] neg_hi:[1,0,1]
    v_pk_mul_f32 v[94:95], v[66:67], v[82:83] op_sel:[1,1] op_sel_hi:[1,0]
    v_pk_fma_f32 v[90:91], v[66:67], v[82:83], v[94:95] op_sel:[0,0,0] op_sel_hi:[0,1,1] neg_lo:[0,0,1] neg_hi:[1,0,1]
    v_mfma_f32_16x16x4_f32 v[48:51], v86, v68, v[48:51]
    v_mfma_f32_16x16x4_f32 v[52:55], v88, v70, v[52:55]
    v_mfma_f32_16x16x4_f32 v[56:59], v88, v72, v[56:59]
    v_mfma_f32_16x16x4_f32 v[60:63], v90, v74, v[60:63]
    v_mfma_f32_16x16x4_f32 v[48:51], v87, v69, v[48:51]
    v_mfma_f32_16x16x4_f32 v[52:55], v89, v71, v[52:55]
    v_mfma_f32_16x16x4_f32 v[56:59], v89, v73, v[56:59]
    v_mfma_f32_16x16x4_f32 v[60:63], v91, v75, v[60:63]
    v_mov_b64_dpp v[64:65], v[28:29] row_newbcast:2 row_mask:0xf bank_mask:0xf
    v_mov_b64_dpp v[66:67], v[30:31] row_newbcast:2 row_mask:0xf bank_mask:0xf
    v_pk_mul_f32 v[94:95], v[64:65], v[26:27] op_sel_hi:[1,0]
    v_pk_mul_f32 v[96:97], v[64:65], v[26:27] op_sel:[0,1] op_sel_hi:[1,1]
    v_fract_f32 v95, v95
    v_fract_f32 v97, v97
    v_exp_f32 v94, v94
    v_exp_f32 v96, v96
    v_cos_f32 v68, v95
    v_sin_f32 v69, v95
    v_cos_f32 v76, v97
    v_sin_f32 v77, v97
    v_pk_mul_f32 v[68:69], v[68:69], v[94:95] op_sel_hi:[1,0]
    v_pk_mul_f32 v[76:77], v[76:77], v[96:97] op_sel_hi:[1,0]
    v_pk_mul_f32 v[92:93], v[76:77], v[76:77] op_sel:[1,1] op_sel_hi:[0,1]
    v_pk_fma_f32 v[78:79], v[76:77], v[76:77], v[92:93] op_sel:[0,0,0] op_sel_hi:[0,1,1] neg_lo:[0,0,1]
    v_pk_mul_f32 v[94:95], v[68:69], v[68:69] op_sel:[1,1] op_sel_hi:[0,1]
    v_pk_fma_f32 v[70:71], v[68:69], v[68:69], v[94:95] op_sel:[0,0,0] op_sel_hi:[0,1,1] neg_lo:[0,0,1]
    v_pk_mul_f32 v[92:93], v[78:79], v[78:79] op_sel:[1,1] op_sel_hi:[0,1]
    v_pk_fma_f32 v[80:81], v[78:79], v[78:79], v[92:93] op_sel:[0,0,0] op_sel_hi:[0,1,1] neg_lo:[0,0,1]
    v_pk_mul_f32 v[94:95], v[70:71], v[70:71] op_sel:[1,1] op_sel_hi:[0,1]
    v_pk_fma_f32 v[72:73], v[70:71], v[70:71], v[94:95] op_sel:[0,0,0] op_sel_hi:[0,1,1] neg_lo:[0,0,1]
    v_pk_mul_f32 v[92:93], v[80:81], v[80:81] op_sel:[1,1] op_sel_hi:[0,1]
    v_pk_fma_f32 v[82:83], v[80:81], v[80:81], v[92:93] op_sel:[0,0,0] op_sel_hi:[0,1,1] neg_lo:[0,0,1]
    v_pk_mul_f32 v[94:95], v[72:73], v[72:73] op_sel:[1,1] op_sel_hi:[0,1]
    v_pk_fma_f32 v[74:75], v[72:73], v[72:73], v[94:95] op_sel:[0,0,0] op_sel_hi:[0,1,1] neg_lo:[0,0,1]
    v_pk_mul_f32 v[92:93], v[82:83], v[82:83] op_sel:[1,1] op_sel_hi:[0,1]
    v_pk_fma_f32 v[84:85], v[82:83], v[82:83], v[92:93] op_sel:[0,0,0] op_sel_hi:[0,1,1] neg_lo:[0,0,1]
    v_pk_mul_f32 v[94:95], v[66:67], v[76:77] op_sel:[1,1] op_sel_hi:[1,0]
    v_pk_fma_f32 v[86:87], v[66:67], v[76:77], v[94:95] op_sel:[0,0,0] op_sel_hi:[0,1,1] neg_lo:[0,0,1] neg_hi:[1,0,1]
    v_mov_b32_dpp v80, v78 row_ror:8 row_mask:0xf bank_mask:0x3
    v_mov_b32_dpp v81, v79 row_ror:8 row_mask:0xf bank_mask:0x3
    v_mov_b32_dpp v82, v84 row_ror:8 row_mask:0xf bank_mask:0x3
    v_mov_b32_dpp v83, v85 row_ror:8 row_mask:0xf bank_mask:0x3
    v_pk_mul_f32 v[92:93], v[66:67], v[80:81] op_sel:[1,1] op_sel_hi:[1,0]
    v_pk_fma_f32 v[88:89], v[66:67], v[80:81], v[92:93] op_sel:[0,0,0] op_sel_hi:[0,1,1] neg_lo:[0,0,1] neg_hi:[1,0,1]
    v_pk_mul_f32 v[94:95], v[66:67], v[82:83] op_sel:[1,1] op_sel_hi:[1,0]
    v_pk_fma_f32 v[90:91], v[66:67], v[82:83], v[94:95] op_sel:[0,0,0] op_sel_hi:[0,1,1] neg_lo:[0,0,1] neg_hi:[1,0,1]
    v_mfma_f32_16x16x4_f32 v[48:51], v86, v68, v[48:51]
    v_mfma_f32_16x16x4_f32 v[52:55], v88, v70, v[52:55]
    v_mfma_f32_16x16x4_f32 v[56:59], v88, v72, v[56:59]
    v_mfma_f32_16x16x4_f32 v[60:63], v90, v74, v[60:63]
    v_mfma_f32_16x16x4_f32 v[48:51], v87, v69, v[48:51]
    v_mfma_f32_16x16x4_f32 v[52:55], v89, v71, v[52:55]
    v_mfma_f32_16x16x4_f32 v[56:59], v89, v73, v[56:59]
    v_mfma_f32_16x16x4_f32 v[60:63], v91, v75, v[60:63]
    v_mov_b64_dpp v[64:65], v[28:29] row_newbcast:3 row_mask:0xf bank_mask:0xf
    v_mov_b64_dpp v[66:67], v[30:31] row_newbcast:3 row_mask:0xf bank_mask:0xf
    v_pk_mul_f32 v[94:95], v[64:65], v[26:27] op_sel_hi:[1,0]
    v_pk_mul_f32 v[96:97], v[64:65], v[26:27] op_sel:[0,1] op_sel_hi:[1,1]
    v_fract_f32 v95, v95
    v_fract_f32 v97, v97
    v_exp_f32 v94, v94
    v_exp_f32 v96, v96
    v_cos_f32 v68, v95
    v_sin_f32 v69, v95
    v_cos_f32 v76, v97
    v_sin_f32 v77, v97
    v_pk_mul_f32 v[68:69], v[68:69], v[94:95] op_sel_hi:[1,0]
    v_pk_mul_f32 v[76:77], v[76:77], v[96:97] op_sel_hi:[1,0]
    v_pk_mul_f32 v[92:93], v[76:77], v[76:77] op_sel:[1,1] op_sel_hi:[0,1]
    v_pk_fma_f32 v[78:79], v[76:77], v[76:77], v[92:93] op_sel:[0,0,0] op_sel_hi:[0,1,1] neg_lo:[0,0,1]
    v_pk_mul_f32 v[94:95], v[68:69], v[68:69] op_sel:[1,1] op_sel_hi:[0,1]
    v_pk_fma_f32 v[70:71], v[68:69], v[68:69], v[94:95] op_sel:[0,0,0] op_sel_hi:[0,1,1] neg_lo:[0,0,1]
    v_pk_mul_f32 v[92:93], v[78:79], v[78:79] op_sel:[1,1] op_sel_hi:[0,1]
    v_pk_fma_f32 v[80:81], v[78:79], v[78:79], v[92:93] op_sel:[0,0,0] op_sel_hi:[0,1,1] neg_lo:[0,0,1]
    v_pk_mul_f32 v[94:95], v[70:71], v[70:71] op_sel:[1,1] op_sel_hi:[0,1]
    v_pk_fma_f32 v[72:73], v[70:71], v[70:71], v[94:95] op_sel:[0,0,0] op_sel_hi:[0,1,1] neg_lo:[0,0,1]
    v_pk_mul_f32 v[92:93], v[80:81], v[80:81] op_sel:[1,1] op_sel_hi:[0,1]
    v_pk_fma_f32 v[82:83], v[80:81], v[80:81], v[92:93] op_sel:[0,0,0] op_sel_hi:[0,1,1] neg_lo:[0,0,1]
    v_pk_mul_f32 v[94:95], v[72:73], v[72:73] op_sel:[1,1] op_sel_hi:[0,1]
    v_pk_fma_f32 v[74:75], v[72:73], v[72:73], v[94:95] op_sel:[0,0,0] op_sel_hi:[0,1,1] neg_lo:[0,0,1]
    v_pk_mul_f32 v[92:93], v[82:83], v[82:83] op_sel:[1,1] op_sel_hi:[0,1]
    v_pk_fma_f32 v[84:85], v[82:83], v[82:83], v[92:93] op_sel:[0,0,0] op_sel_hi:[0,1,1] neg_lo:[0,0,1]
    v_pk_mul_f32 v[94:95], v[66:67], v[76:77] op_sel:[1,1] op_sel_hi:[1,0]
    v_pk_fma_f32 v[86:87], v[66:67], v[76:77], v[94:95] op_sel:[0,0,0] op_sel_hi:[0,1,1] neg_lo:[0,0,1] neg_hi:[1,0,1]
    v_mov_b32_dpp v80, v78 row_ror:8 row_mask:0xf bank_mask:0x3
    v_mov_b32_dpp v81, v79 row_ror:8 row_mask:0xf bank_mask:0x3
    v_mov_b32_dpp v82, v84 row_ror:8 row_mask:0xf bank_mask:0x3
    v_mov_b32_dpp v83, v85 row_ror:8 row_mask:0xf bank_mask:0x3
    v_pk_mul_f32 v[92:93], v[66:67], v[80:81] op_sel:[1,1] op_sel_hi:[1,0]
    v_pk_fma_f32 v[88:89], v[66:67], v[80:81], v[92:93] op_sel:[0,0,0] op_sel_hi:[0,1,1] neg_lo:[0,0,1] neg_hi:[1,0,1]
    v_pk_mul_f32 v[94:95], v[66:67], v[82:83] op_sel:[1,1] op_sel_hi:[1,0]
    v_pk_fma_f32 v[90:91], v[66:67], v[82:83], v[94:95] op_sel:[0,0,0] op_sel_hi:[0,1,1] neg_lo:[0,0,1] neg_hi:[1,0,1]
    v_mfma_f32_16x16x4_f32 v[48:51], v86, v68, v[48:51]
    v_mfma_f32_16x16x4_f32 v[52:55], v88, v70, v[52:55]
    v_mfma_f32_16x16x4_f32 v[56:59], v88, v72, v[56:59]
    v_mfma_f32_16x16x4_f32 v[60:63], v90, v74, v[60:63]
    v_mfma_f32_16x16x4_f32 v[48:51], v87, v69, v[48:51]
    v_mfma_f32_16x16x4_f32 v[52:55], v89, v71, v[52:55]
    v_mfma_f32_16x16x4_f32 v[56:59], v89, v73, v[56:59]
    v_mfma_f32_16x16x4_f32 v[60:63], v91, v75, v[60:63]
    v_mov_b64_dpp v[64:65], v[28:29] row_newbcast:4 row_mask:0xf bank_mask:0xf
    v_mov_b64_dpp v[66:67], v[30:31] row_newbcast:4 row_mask:0xf bank_mask:0xf
    v_pk_mul_f32 v[94:95], v[64:65], v[26:27] op_sel_hi:[1,0]
    v_pk_mul_f32 v[96:97], v[64:65], v[26:27] op_sel:[0,1] op_sel_hi:[1,1]
    v_fract_f32 v95, v95
    v_fract_f32 v97, v97
    v_exp_f32 v94, v94
    v_exp_f32 v96, v96
    v_cos_f32 v68, v95
    v_sin_f32 v69, v95
    v_cos_f32 v76, v97
    v_sin_f32 v77, v97
    v_pk_mul_f32 v[68:69], v[68:69], v[94:95] op_sel_hi:[1,0]
    v_pk_mul_f32 v[76:77], v[76:77], v[96:97] op_sel_hi:[1,0]
    v_pk_mul_f32 v[92:93], v[76:77], v[76:77] op_sel:[1,1] op_sel_hi:[0,1]
    v_pk_fma_f32 v[78:79], v[76:77], v[76:77], v[92:93] op_sel:[0,0,0] op_sel_hi:[0,1,1] neg_lo:[0,0,1]
    v_pk_mul_f32 v[94:95], v[68:69], v[68:69] op_sel:[1,1] op_sel_hi:[0,1]
    v_pk_fma_f32 v[70:71], v[68:69], v[68:69], v[94:95] op_sel:[0,0,0] op_sel_hi:[0,1,1] neg_lo:[0,0,1]
    v_pk_mul_f32 v[92:93], v[78:79], v[78:79] op_sel:[1,1] op_sel_hi:[0,1]
    v_pk_fma_f32 v[80:81], v[78:79], v[78:79], v[92:93] op_sel:[0,0,0] op_sel_hi:[0,1,1] neg_lo:[0,0,1]
    v_pk_mul_f32 v[94:95], v[70:71], v[70:71] op_sel:[1,1] op_sel_hi:[0,1]
    v_pk_fma_f32 v[72:73], v[70:71], v[70:71], v[94:95] op_sel:[0,0,0] op_sel_hi:[0,1,1] neg_lo:[0,0,1]
    v_pk_mul_f32 v[92:93], v[80:81], v[80:81] op_sel:[1,1] op_sel_hi:[0,1]
    v_pk_fma_f32 v[82:83], v[80:81], v[80:81], v[92:93] op_sel:[0,0,0] op_sel_hi:[0,1,1] neg_lo:[0,0,1]
    v_pk_mul_f32 v[94:95], v[72:73], v[72:73] op_sel:[1,1] op_sel_hi:[0,1]
    v_pk_fma_f32 v[74:75], v[72:73], v[72:73], v[94:95] op_sel:[0,0,0] op_sel_hi:[0,1,1] neg_lo:[0,0,1]
    v_pk_mul_f32 v[92:93], v[82:83], v[82:83] op_sel:[1,1] op_sel_hi:[0,1]
    v_pk_fma_f32 v[84:85], v[82:83], v[82:83], v[92:93] op_sel:[0,0,0] op_sel_hi:[0,1,1] neg_lo:[0,0,1]
    v_pk_mul_f32 v[94:95], v[66:67], v[76:77] op_sel:[1,1] op_sel_hi:[1,0]
    v_pk_fma_f32 v[86:87], v[66:67], v[76:77], v[94:95] op_sel:[0,0,0] op_sel_hi:[0,1,1] neg_lo:[0,0,1] neg_hi:[1,0,1]
    v_mov_b32_dpp v80, v78 row_ror:8 row_mask:0xf bank_mask:0x3
    v_mov_b32_dpp v81, v79 row_ror:8 row_mask:0xf bank_mask:0x3
    v_mov_b32_dpp v82, v84 row_ror:8 row_mask:0xf bank_mask:0x3
    v_mov_b32_dpp v83, v85 row_ror:8 row_mask:0xf bank_mask:0x3
    v_pk_mul_f32 v[92:93], v[66:67], v[80:81] op_sel:[1,1] op_sel_hi:[1,0]
    v_pk_fma_f32 v[88:89], v[66:67], v[80:81], v[92:93] op_sel:[0,0,0] op_sel_hi:[0,1,1] neg_lo:[0,0,1] neg_hi:[1,0,1]
    v_pk_mul_f32 v[94:95], v[66:67], v[82:83] op_sel:[1,1] op_sel_hi:[1,0]
    v_pk_fma_f32 v[90:91], v[66:67], v[82:83], v[94:95] op_sel:[0,0,0] op_sel_hi:[0,1,1] neg_lo:[0,0,1] neg_hi:[1,0,1]
    v_mfma_f32_16x16x4_f32 v[48:51], v86, v68, v[48:51]
    v_mfma_f32_16x16x4_f32 v[52:55], v88, v70, v[52:55]
    v_mfma_f32_16x16x4_f32 v[56:59], v88, v72, v[56:59]
    v_mfma_f32_16x16x4_f32 v[60:63], v90, v74, v[60:63]
    v_mfma_f32_16x16x4_f32 v[48:51], v87, v69, v[48:51]
    v_mfma_f32_16x16x4_f32 v[52:55], v89, v71, v[52:55]
    v_mfma_f32_16x16x4_f32 v[56:59], v89, v73, v[56:59]
    v_mfma_f32_16x16x4_f32 v[60:63], v91, v75, v[60:63]
    v_mov_b64_dpp v[64:65], v[28:29] row_newbcast:5 row_mask:0xf bank_mask:0xf
    v_mov_b64_dpp v[66:67], v[30:31] row_newbcast:5 row_mask:0xf bank_mask:0xf
    v_pk_mul_f32 v[94:95], v[64:65], v[26:27] op_sel_hi:[1,0]
    v_pk_mul_f32 v[96:97], v[64:65], v[26:27] op_sel:[0,1] op_sel_hi:[1,1]
    v_fract_f32 v95, v95
    v_fract_f32 v97, v97
    v_exp_f32 v94, v94
    v_exp_f32 v96, v96
    v_cos_f32 v68, v95
    v_sin_f32 v69, v95
    v_cos_f32 v76, v97
    v_sin_f32 v77, v97
    v_pk_mul_f32 v[68:69], v[68:69], v[94:95] op_sel_hi:[1,0]
    v_pk_mul_f32 v[76:77], v[76:77], v[96:97] op_sel_hi:[1,0]
    v_pk_mul_f32 v[92:93], v[76:77], v[76:77] op_sel:[1,1] op_sel_hi:[0,1]
    v_pk_fma_f32 v[78:79], v[76:77], v[76:77], v[92:93] op_sel:[0,0,0] op_sel_hi:[0,1,1] neg_lo:[0,0,1]
    v_pk_mul_f32 v[94:95], v[68:69], v[68:69] op_sel:[1,1] op_sel_hi:[0,1]
    v_pk_fma_f32 v[70:71], v[68:69], v[68:69], v[94:95] op_sel:[0,0,0] op_sel_hi:[0,1,1] neg_lo:[0,0,1]
    v_pk_mul_f32 v[92:93], v[78:79], v[78:79] op_sel:[1,1] op_sel_hi:[0,1]
    v_pk_fma_f32 v[80:81], v[78:79], v[78:79], v[92:93] op_sel:[0,0,0] op_sel_hi:[0,1,1] neg_lo:[0,0,1]
    v_pk_mul_f32 v[94:95], v[70:71], v[70:71] op_sel:[1,1] op_sel_hi:[0,1]
    v_pk_fma_f32 v[72:73], v[70:71], v[70:71], v[94:95] op_sel:[0,0,0] op_sel_hi:[0,1,1] neg_lo:[0,0,1]
    v_pk_mul_f32 v[92:93], v[80:81], v[80:81] op_sel:[1,1] op_sel_hi:[0,1]
    v_pk_fma_f32 v[82:83], v[80:81], v[80:81], v[92:93] op_sel:[0,0,0] op_sel_hi:[0,1,1] neg_lo:[0,0,1]
    v_pk_mul_f32 v[94:95], v[72:73], v[72:73] op_sel:[1,1] op_sel_hi:[0,1]
    v_pk_fma_f32 v[74:75], v[72:73], v[72:73], v[94:95] op_sel:[0,0,0] op_sel_hi:[0,1,1] neg_lo:[0,0,1]
    v_pk_mul_f32 v[92:93], v[82:83], v[82:83] op_sel:[1,1] op_sel_hi:[0,1]
    v_pk_fma_f32 v[84:85], v[82:83], v[82:83], v[92:93] op_sel:[0,0,0] op_sel_hi:[0,1,1] neg_lo:[0,0,1]
    v_pk_mul_f32 v[94:95], v[66:67], v[76:77] op_sel:[1,1] op_sel_hi:[1,0]
    v_pk_fma_f32 v[86:87], v[66:67], v[76:77], v[94:95] op_sel:[0,0,0] op_sel_hi:[0,1,1] neg_lo:[0,0,1] neg_hi:[1,0,1]
    v_mov_b32_dpp v80, v78 row_ror:8 row_mask:0xf bank_mask:0x3
    v_mov_b32_dpp v81, v79 row_ror:8 row_mask:0xf bank_mask:0x3
    v_mov_b32_dpp v82, v84 row_ror:8 row_mask:0xf bank_mask:0x3
    v_mov_b32_dpp v83, v85 row_ror:8 row_mask:0xf bank_mask:0x3
    v_pk_mul_f32 v[92:93], v[66:67], v[80:81] op_sel:[1,1] op_sel_hi:[1,0]
    v_pk_fma_f32 v[88:89], v[66:67], v[80:81], v[92:93] op_sel:[0,0,0] op_sel_hi:[0,1,1] neg_lo:[0,0,1] neg_hi:[1,0,1]
    v_pk_mul_f32 v[94:95], v[66:67], v[82:83] op_sel:[1,1] op_sel_hi:[1,0]
    v_pk_fma_f32 v[90:91], v[66:67], v[82:83], v[94:95] op_sel:[0,0,0] op_sel_hi:[0,1,1] neg_lo:[0,0,1] neg_hi:[1,0,1]
    v_mfma_f32_16x16x4_f32 v[48:51], v86, v68, v[48:51]
    v_mfma_f32_16x16x4_f32 v[52:55], v88, v70, v[52:55]
    v_mfma_f32_16x16x4_f32 v[56:59], v88, v72, v[56:59]
    v_mfma_f32_16x16x4_f32 v[60:63], v90, v74, v[60:63]
    v_mfma_f32_16x16x4_f32 v[48:51], v87, v69, v[48:51]
    v_mfma_f32_16x16x4_f32 v[52:55], v89, v71, v[52:55]
    v_mfma_f32_16x16x4_f32 v[56:59], v89, v73, v[56:59]
    v_mfma_f32_16x16x4_f32 v[60:63], v91, v75, v[60:63]
    v_mov_b64_dpp v[64:65], v[28:29] row_newbcast:6 row_mask:0xf bank_mask:0xf
    v_mov_b64_dpp v[66:67], v[30:31] row_newbcast:6 row_mask:0xf bank_mask:0xf
    v_pk_mul_f32 v[94:95], v[64:65], v[26:27] op_sel_hi:[1,0]
    v_pk_mul_f32 v[96:97], v[64:65], v[26:27] op_sel:[0,1] op_sel_hi:[1,1]
    v_fract_f32 v95, v95
    v_fract_f32 v97, v97
    v_exp_f32 v94, v94
    v_exp_f32 v96, v96
    v_cos_f32 v68, v95
    v_sin_f32 v69, v95
    v_cos_f32 v76, v97
    v_sin_f32 v77, v97
    v_pk_mul_f32 v[68:69], v[68:69], v[94:95] op_sel_hi:[1,0]
    v_pk_mul_f32 v[76:77], v[76:77], v[96:97] op_sel_hi:[1,0]
    v_pk_mul_f32 v[92:93], v[76:77], v[76:77] op_sel:[1,1] op_sel_hi:[0,1]
    v_pk_fma_f32 v[78:79], v[76:77], v[76:77], v[92:93] op_sel:[0,0,0] op_sel_hi:[0,1,1] neg_lo:[0,0,1]
    v_pk_mul_f32 v[94:95], v[68:69], v[68:69] op_sel:[1,1] op_sel_hi:[0,1]
    v_pk_fma_f32 v[70:71], v[68:69], v[68:69], v[94:95] op_sel:[0,0,0] op_sel_hi:[0,1,1] neg_lo:[0,0,1]
    v_pk_mul_f32 v[92:93], v[78:79], v[78:79] op_sel:[1,1] op_sel_hi:[0,1]
    v_pk_fma_f32 v[80:81], v[78:79], v[78:79], v[92:93] op_sel:[0,0,0] op_sel_hi:[0,1,1] neg_lo:[0,0,1]
    v_pk_mul_f32 v[94:95], v[70:71], v[70:71] op_sel:[1,1] op_sel_hi:[0,1]
    v_pk_fma_f32 v[72:73], v[70:71], v[70:71], v[94:95] op_sel:[0,0,0] op_sel_hi:[0,1,1] neg_lo:[0,0,1]
    v_pk_mul_f32 v[92:93], v[80:81], v[80:81] op_sel:[1,1] op_sel_hi:[0,1]
    v_pk_fma_f32 v[82:83], v[80:81], v[80:81], v[92:93] op_sel:[0,0,0] op_sel_hi:[0,1,1] neg_lo:[0,0,1]
    v_pk_mul_f32 v[94:95], v[72:73], v[72:73] op_sel:[1,1] op_sel_hi:[0,1]
    v_pk_fma_f32 v[74:75], v[72:73], v[72:73], v[94:95] op_sel:[0,0,0] op_sel_hi:[0,1,1] neg_lo:[0,0,1]
    v_pk_mul_f32 v[92:93], v[82:83], v[82:83] op_sel:[1,1] op_sel_hi:[0,1]
    v_pk_fma_f32 v[84:85], v[82:83], v[82:83], v[92:93] op_sel:[0,0,0] op_sel_hi:[0,1,1] neg_lo:[0,0,1]
    v_pk_mul_f32 v[94:95], v[66:67], v[76:77] op_sel:[1,1] op_sel_hi:[1,0]
    v_pk_fma_f32 v[86:87], v[66:67], v[76:77], v[94:95] op_sel:[0,0,0] op_sel_hi:[0,1,1] neg_lo:[0,0,1] neg_hi:[1,0,1]
    v_mov_b32_dpp v80, v78 row_ror:8 row_mask:0xf bank_mask:0x3
    v_mov_b32_dpp v81, v79 row_ror:8 row_mask:0xf bank_mask:0x3
    v_mov_b32_dpp v82, v84 row_ror:8 row_mask:0xf bank_mask:0x3
    v_mov_b32_dpp v83, v85 row_ror:8 row_mask:0xf bank_mask:0x3
    v_pk_mul_f32 v[92:93], v[66:67], v[80:81] op_sel:[1,1] op_sel_hi:[1,0]
    v_pk_fma_f32 v[88:89], v[66:67], v[80:81], v[92:93] op_sel:[0,0,0] op_sel_hi:[0,1,1] neg_lo:[0,0,1] neg_hi:[1,0,1]
    v_pk_mul_f32 v[94:95], v[66:67], v[82:83] op_sel:[1,1] op_sel_hi:[1,0]
    v_pk_fma_f32 v[90:91], v[66:67], v[82:83], v[94:95] op_sel:[0,0,0] op_sel_hi:[0,1,1] neg_lo:[0,0,1] neg_hi:[1,0,1]
    v_mfma_f32_16x16x4_f32 v[48:51], v86, v68, v[48:51]
    v_mfma_f32_16x16x4_f32 v[52:55], v88, v70, v[52:55]
    v_mfma_f32_16x16x4_f32 v[56:59], v88, v72, v[56:59]
    v_mfma_f32_16x16x4_f32 v[60:63], v90, v74, v[60:63]
    v_mfma_f32_16x16x4_f32 v[48:51], v87, v69, v[48:51]
    v_mfma_f32_16x16x4_f32 v[52:55], v89, v71, v[52:55]
    v_mfma_f32_16x16x4_f32 v[56:59], v89, v73, v[56:59]
    v_mfma_f32_16x16x4_f32 v[60:63], v91, v75, v[60:63]
    v_mov_b64_dpp v[64:65], v[28:29] row_newbcast:7 row_mask:0xf bank_mask:0xf
    v_mov_b64_dpp v[66:67], v[30:31] row_newbcast:7 row_mask:0xf bank_mask:0xf
    v_pk_mul_f32 v[94:95], v[64:65], v[26:27] op_sel_hi:[1,0]
    v_pk_mul_f32 v[96:97], v[64:65], v[26:27] op_sel:[0,1] op_sel_hi:[1,1]
    v_fract_f32 v95, v95
    v_fract_f32 v97, v97
    v_exp_f32 v94, v94
    v_exp_f32 v96, v96
    v_cos_f32 v68, v95
    v_sin_f32 v69, v95
    v_cos_f32 v76, v97
    v_sin_f32 v77, v97
    v_pk_mul_f32 v[68:69], v[68:69], v[94:95] op_sel_hi:[1,0]
    v_pk_mul_f32 v[76:77], v[76:77], v[96:97] op_sel_hi:[1,0]
    v_pk_mul_f32 v[92:93], v[76:77], v[76:77] op_sel:[1,1] op_sel_hi:[0,1]
    v_pk_fma_f32 v[78:79], v[76:77], v[76:77], v[92:93] op_sel:[0,0,0] op_sel_hi:[0,1,1] neg_lo:[0,0,1]
    v_pk_mul_f32 v[94:95], v[68:69], v[68:69] op_sel:[1,1] op_sel_hi:[0,1]
    v_pk_fma_f32 v[70:71], v[68:69], v[68:69], v[94:95] op_sel:[0,0,0] op_sel_hi:[0,1,1] neg_lo:[0,0,1]
    v_pk_mul_f32 v[92:93], v[78:79], v[78:79] op_sel:[1,1] op_sel_hi:[0,1]
    v_pk_fma_f32 v[80:81], v[78:79], v[78:79], v[92:93] op_sel:[0,0,0] op_sel_hi:[0,1,1] neg_lo:[0,0,1]
    v_pk_mul_f32 v[94:95], v[70:71], v[70:71] op_sel:[1,1] op_sel_hi:[0,1]
    v_pk_fma_f32 v[72:73], v[70:71], v[70:71], v[94:95] op_sel:[0,0,0] op_sel_hi:[0,1,1] neg_lo:[0,0,1]
    v_pk_mul_f32 v[92:93], v[80:81], v[80:81] op_sel:[1,1] op_sel_hi:[0,1]
    v_pk_fma_f32 v[82:83], v[80:81], v[80:81], v[92:93] op_sel:[0,0,0] op_sel_hi:[0,1,1] neg_lo:[0,0,1]
    v_pk_mul_f32 v[94:95], v[72:73], v[72:73] op_sel:[1,1] op_sel_hi:[0,1]
    v_pk_fma_f32 v[74:75], v[72:73], v[72:73], v[94:95] op_sel:[0,0,0] op_sel_hi:[0,1,1] neg_lo:[0,0,1]
    v_pk_mul_f32 v[92:93], v[82:83], v[82:83] op_sel:[1,1] op_sel_hi:[0,1]
    v_pk_fma_f32 v[84:85], v[82:83], v[82:83], v[92:93] op_sel:[0,0,0] op_sel_hi:[0,1,1] neg_lo:[0,0,1]
    v_pk_mul_f32 v[94:95], v[66:67], v[76:77] op_sel:[1,1] op_sel_hi:[1,0]
    v_pk_fma_f32 v[86:87], v[66:67], v[76:77], v[94:95] op_sel:[0,0,0] op_sel_hi:[0,1,1] neg_lo:[0,0,1] neg_hi:[1,0,1]
    v_mov_b32_dpp v80, v78 row_ror:8 row_mask:0xf bank_mask:0x3
    v_mov_b32_dpp v81, v79 row_ror:8 row_mask:0xf bank_mask:0x3
    v_mov_b32_dpp v82, v84 row_ror:8 row_mask:0xf bank_mask:0x3
    v_mov_b32_dpp v83, v85 row_ror:8 row_mask:0xf bank_mask:0x3
    v_pk_mul_f32 v[92:93], v[66:67], v[80:81] op_sel:[1,1] op_sel_hi:[1,0]
    v_pk_fma_f32 v[88:89], v[66:67], v[80:81], v[92:93] op_sel:[0,0,0] op_sel_hi:[0,1,1] neg_lo:[0,0,1] neg_hi:[1,0,1]
    v_pk_mul_f32 v[94:95], v[66:67], v[82:83] op_sel:[1,1] op_sel_hi:[1,0]
    v_pk_fma_f32 v[90:91], v[66:67], v[82:83], v[94:95] op_sel:[0,0,0] op_sel_hi:[0,1,1] neg_lo:[0,0,1] neg_hi:[1,0,1]
    v_mfma_f32_16x16x4_f32 v[48:51], v86, v68, v[48:51]
    v_mfma_f32_16x16x4_f32 v[52:55], v88, v70, v[52:55]
    v_mfma_f32_16x16x4_f32 v[56:59], v88, v72, v[56:59]
    v_mfma_f32_16x16x4_f32 v[60:63], v90, v74, v[60:63]
    v_mfma_f32_16x16x4_f32 v[48:51], v87, v69, v[48:51]
    v_mfma_f32_16x16x4_f32 v[52:55], v89, v71, v[52:55]
    v_mfma_f32_16x16x4_f32 v[56:59], v89, v73, v[56:59]
    v_mfma_f32_16x16x4_f32 v[60:63], v91, v75, v[60:63]
    v_mov_b64_dpp v[64:65], v[28:29] row_newbcast:8 row_mask:0xf bank_mask:0xf
    v_mov_b64_dpp v[66:67], v[30:31] row_newbcast:8 row_mask:0xf bank_mask:0xf
    v_pk_mul_f32 v[94:95], v[64:65], v[26:27] op_sel_hi:[1,0]
    v_pk_mul_f32 v[96:97], v[64:65], v[26:27] op_sel:[0,1] op_sel_hi:[1,1]
    v_fract_f32 v95, v95
    v_fract_f32 v97, v97
    v_exp_f32 v94, v94
    v_exp_f32 v96, v96
    v_cos_f32 v68, v95
    v_sin_f32 v69, v95
    v_cos_f32 v76, v97
    v_sin_f32 v77, v97
    v_pk_mul_f32 v[68:69], v[68:69], v[94:95] op_sel_hi:[1,0]
    v_pk_mul_f32 v[76:77], v[76:77], v[96:97] op_sel_hi:[1,0]
    v_pk_mul_f32 v[92:93], v[76:77], v[76:77] op_sel:[1,1] op_sel_hi:[0,1]
    v_pk_fma_f32 v[78:79], v[76:77], v[76:77], v[92:93] op_sel:[0,0,0] op_sel_hi:[0,1,1] neg_lo:[0,0,1]
    v_pk_mul_f32 v[94:95], v[68:69], v[68:69] op_sel:[1,1] op_sel_hi:[0,1]
    v_pk_fma_f32 v[70:71], v[68:69], v[68:69], v[94:95] op_sel:[0,0,0] op_sel_hi:[0,1,1] neg_lo:[0,0,1]
    v_pk_mul_f32 v[92:93], v[78:79], v[78:79] op_sel:[1,1] op_sel_hi:[0,1]
    v_pk_fma_f32 v[80:81], v[78:79], v[78:79], v[92:93] op_sel:[0,0,0] op_sel_hi:[0,1,1] neg_lo:[0,0,1]
    v_pk_mul_f32 v[94:95], v[70:71], v[70:71] op_sel:[1,1] op_sel_hi:[0,1]
    v_pk_fma_f32 v[72:73], v[70:71], v[70:71], v[94:95] op_sel:[0,0,0] op_sel_hi:[0,1,1] neg_lo:[0,0,1]
    v_pk_mul_f32 v[92:93], v[80:81], v[80:81] op_sel:[1,1] op_sel_hi:[0,1]
    v_pk_fma_f32 v[82:83], v[80:81], v[80:81], v[92:93] op_sel:[0,0,0] op_sel_hi:[0,1,1] neg_lo:[0,0,1]
    v_pk_mul_f32 v[94:95], v[72:73], v[72:73] op_sel:[1,1] op_sel_hi:[0,1]
    v_pk_fma_f32 v[74:75], v[72:73], v[72:73], v[94:95] op_sel:[0,0,0] op_sel_hi:[0,1,1] neg_lo:[0,0,1]
    v_pk_mul_f32 v[92:93], v[82:83], v[82:83] op_sel:[1,1] op_sel_hi:[0,1]
    v_pk_fma_f32 v[84:85], v[82:83], v[82:83], v[92:93] op_sel:[0,0,0] op_sel_hi:[0,1,1] neg_lo:[0,0,1]
    v_pk_mul_f32 v[94:95], v[66:67], v[76:77] op_sel:[1,1] op_sel_hi:[1,0]
    v_pk_fma_f32 v[86:87], v[66:67], v[76:77], v[94:95] op_sel:[0,0,0] op_sel_hi:[0,1,1] neg_lo:[0,0,1] neg_hi:[1,0,1]
    v_mov_b32_dpp v80, v78 row_ror:8 row_mask:0xf bank_mask:0x3
    v_mov_b32_dpp v81, v79 row_ror:8 row_mask:0xf bank_mask:0x3
    v_mov_b32_dpp v82, v84 row_ror:8 row_mask:0xf bank_mask:0x3
    v_mov_b32_dpp v83, v85 row_ror:8 row_mask:0xf bank_mask:0x3
    v_pk_mul_f32 v[92:93], v[66:67], v[80:81] op_sel:[1,1] op_sel_hi:[1,0]
    v_pk_fma_f32 v[88:89], v[66:67], v[80:81], v[92:93] op_sel:[0,0,0] op_sel_hi:[0,1,1] neg_lo:[0,0,1] neg_hi:[1,0,1]
    v_pk_mul_f32 v[94:95], v[66:67], v[82:83] op_sel:[1,1] op_sel_hi:[1,0]
    v_pk_fma_f32 v[90:91], v[66:67], v[82:83], v[94:95] op_sel:[0,0,0] op_sel_hi:[0,1,1] neg_lo:[0,0,1] neg_hi:[1,0,1]
    v_mfma_f32_16x16x4_f32 v[48:51], v86, v68, v[48:51]
    v_mfma_f32_16x16x4_f32 v[52:55], v88, v70, v[52:55]
    v_mfma_f32_16x16x4_f32 v[56:59], v88, v72, v[56:59]
    v_mfma_f32_16x16x4_f32 v[60:63], v90, v74, v[60:63]
    v_mfma_f32_16x16x4_f32 v[48:51], v87, v69, v[48:51]
    v_mfma_f32_16x16x4_f32 v[52:55], v89, v71, v[52:55]
    v_mfma_f32_16x16x4_f32 v[56:59], v89, v73, v[56:59]
    v_mfma_f32_16x16x4_f32 v[60:63], v91, v75, v[60:63]
    v_mov_b64_dpp v[64:65], v[28:29] row_newbcast:9 row_mask:0xf bank_mask:0xf
    v_mov_b64_dpp v[66:67], v[30:31] row_newbcast:9 row_mask:0xf bank_mask:0xf
    v_pk_mul_f32 v[94:95], v[64:65], v[26:27] op_sel_hi:[1,0]
    v_pk_mul_f32 v[96:97], v[64:65], v[26:27] op_sel:[0,1] op_sel_hi:[1,1]
    v_fract_f32 v95, v95
    v_fract_f32 v97, v97
    v_exp_f32 v94, v94
    v_exp_f32 v96, v96
    v_cos_f32 v68, v95
    v_sin_f32 v69, v95
    v_cos_f32 v76, v97
    v_sin_f32 v77, v97
    v_pk_mul_f32 v[68:69], v[68:69], v[94:95] op_sel_hi:[1,0]
    v_pk_mul_f32 v[76:77], v[76:77], v[96:97] op_sel_hi:[1,0]
    v_pk_mul_f32 v[92:93], v[76:77], v[76:77] op_sel:[1,1] op_sel_hi:[0,1]
    v_pk_fma_f32 v[78:79], v[76:77], v[76:77], v[92:93] op_sel:[0,0,0] op_sel_hi:[0,1,1] neg_lo:[0,0,1]
    v_pk_mul_f32 v[94:95], v[68:69], v[68:69] op_sel:[1,1] op_sel_hi:[0,1]
    v_pk_fma_f32 v[70:71], v[68:69], v[68:69], v[94:95] op_sel:[0,0,0] op_sel_hi:[0,1,1] neg_lo:[0,0,1]
    v_pk_mul_f32 v[92:93], v[78:79], v[78:79] op_sel:[1,1] op_sel_hi:[0,1]
    v_pk_fma_f32 v[80:81], v[78:79], v[78:79], v[92:93] op_sel:[0,0,0] op_sel_hi:[0,1,1] neg_lo:[0,0,1]
    v_pk_mul_f32 v[94:95], v[70:71], v[70:71] op_sel:[1,1] op_sel_hi:[0,1]
    v_pk_fma_f32 v[72:73], v[70:71], v[70:71], v[94:95] op_sel:[0,0,0] op_sel_hi:[0,1,1] neg_lo:[0,0,1]
    v_pk_mul_f32 v[92:93], v[80:81], v[80:81] op_sel:[1,1] op_sel_hi:[0,1]
    v_pk_fma_f32 v[82:83], v[80:81], v[80:81], v[92:93] op_sel:[0,0,0] op_sel_hi:[0,1,1] neg_lo:[0,0,1]
    v_pk_mul_f32 v[94:95], v[72:73], v[72:73] op_sel:[1,1] op_sel_hi:[0,1]
    v_pk_fma_f32 v[74:75], v[72:73], v[72:73], v[94:95] op_sel:[0,0,0] op_sel_hi:[0,1,1] neg_lo:[0,0,1]
    v_pk_mul_f32 v[92:93], v[82:83], v[82:83] op_sel:[1,1] op_sel_hi:[0,1]
    v_pk_fma_f32 v[84:85], v[82:83], v[82:83], v[92:93] op_sel:[0,0,0] op_sel_hi:[0,1,1] neg_lo:[0,0,1]
    v_pk_mul_f32 v[94:95], v[66:67], v[76:77] op_sel:[1,1] op_sel_hi:[1,0]
    v_pk_fma_f32 v[86:87], v[66:67], v[76:77], v[94:95] op_sel:[0,0,0] op_sel_hi:[0,1,1] neg_lo:[0,0,1] neg_hi:[1,0,1]
    v_mov_b32_dpp v80, v78 row_ror:8 row_mask:0xf bank_mask:0x3
    v_mov_b32_dpp v81, v79 row_ror:8 row_mask:0xf bank_mask:0x3
    v_mov_b32_dpp v82, v84 row_ror:8 row_mask:0xf bank_mask:0x3
    v_mov_b32_dpp v83, v85 row_ror:8 row_mask:0xf bank_mask:0x3
    v_pk_mul_f32 v[92:93], v[66:67], v[80:81] op_sel:[1,1] op_sel_hi:[1,0]
    v_pk_fma_f32 v[88:89], v[66:67], v[80:81], v[92:93] op_sel:[0,0,0] op_sel_hi:[0,1,1] neg_lo:[0,0,1] neg_hi:[1,0,1]
    v_pk_mul_f32 v[94:95], v[66:67], v[82:83] op_sel:[1,1] op_sel_hi:[1,0]
    v_pk_fma_f32 v[90:91], v[66:67], v[82:83], v[94:95] op_sel:[0,0,0] op_sel_hi:[0,1,1] neg_lo:[0,0,1] neg_hi:[1,0,1]
    v_mfma_f32_16x16x4_f32 v[48:51], v86, v68, v[48:51]
    v_mfma_f32_16x16x4_f32 v[52:55], v88, v70, v[52:55]
    v_mfma_f32_16x16x4_f32 v[56:59], v88, v72, v[56:59]
    v_mfma_f32_16x16x4_f32 v[60:63], v90, v74, v[60:63]
    v_mfma_f32_16x16x4_f32 v[48:51], v87, v69, v[48:51]
    v_mfma_f32_16x16x4_f32 v[52:55], v89, v71, v[52:55]
    v_mfma_f32_16x16x4_f32 v[56:59], v89, v73, v[56:59]
    v_mfma_f32_16x16x4_f32 v[60:63], v91, v75, v[60:63]
    v_mov_b64_dpp v[64:65], v[28:29] row_newbcast:10 row_mask:0xf bank_mask:0xf
    v_mov_b64_dpp v[66:67], v[30:31] row_newbcast:10 row_mask:0xf bank_mask:0xf
    v_pk_mul_f32 v[94:95], v[64:65], v[26:27] op_sel_hi:[1,0]
    v_pk_mul_f32 v[96:97], v[64:65], v[26:27] op_sel:[0,1] op_sel_hi:[1,1]
    v_fract_f32 v95, v95
    v_fract_f32 v97, v97
    v_exp_f32 v94, v94
    v_exp_f32 v96, v96
    v_cos_f32 v68, v95
    v_sin_f32 v69, v95
    v_cos_f32 v76, v97
    v_sin_f32 v77, v97
    v_pk_mul_f32 v[68:69], v[68:69], v[94:95] op_sel_hi:[1,0]
    v_pk_mul_f32 v[76:77], v[76:77], v[96:97] op_sel_hi:[1,0]
    v_pk_mul_f32 v[92:93], v[76:77], v[76:77] op_sel:[1,1] op_sel_hi:[0,1]
    v_pk_fma_f32 v[78:79], v[76:77], v[76:77], v[92:93] op_sel:[0,0,0] op_sel_hi:[0,1,1] neg_lo:[0,0,1]
    v_pk_mul_f32 v[94:95], v[68:69], v[68:69] op_sel:[1,1] op_sel_hi:[0,1]
    v_pk_fma_f32 v[70:71], v[68:69], v[68:69], v[94:95] op_sel:[0,0,0] op_sel_hi:[0,1,1] neg_lo:[0,0,1]
    v_pk_mul_f32 v[92:93], v[78:79], v[78:79] op_sel:[1,1] op_sel_hi:[0,1]
    v_pk_fma_f32 v[80:81], v[78:79], v[78:79], v[92:93] op_sel:[0,0,0] op_sel_hi:[0,1,1] neg_lo:[0,0,1]
    v_pk_mul_f32 v[94:95], v[70:71], v[70:71] op_sel:[1,1] op_sel_hi:[0,1]
    v_pk_fma_f32 v[72:73], v[70:71], v[70:71], v[94:95] op_sel:[0,0,0] op_sel_hi:[0,1,1] neg_lo:[0,0,1]
    v_pk_mul_f32 v[92:93], v[80:81], v[80:81] op_sel:[1,1] op_sel_hi:[0,1]
    v_pk_fma_f32 v[82:83], v[80:81], v[80:81], v[92:93] op_sel:[0,0,0] op_sel_hi:[0,1,1] neg_lo:[0,0,1]
    v_pk_mul_f32 v[94:95], v[72:73], v[72:73] op_sel:[1,1] op_sel_hi:[0,1]
    v_pk_fma_f32 v[74:75], v[72:73], v[72:73], v[94:95] op_sel:[0,0,0] op_sel_hi:[0,1,1] neg_lo:[0,0,1]
    v_pk_mul_f32 v[92:93], v[82:83], v[82:83] op_sel:[1,1] op_sel_hi:[0,1]
    v_pk_fma_f32 v[84:85], v[82:83], v[82:83], v[92:93] op_sel:[0,0,0] op_sel_hi:[0,1,1] neg_lo:[0,0,1]
    v_pk_mul_f32 v[94:95], v[66:67], v[76:77] op_sel:[1,1] op_sel_hi:[1,0]
    v_pk_fma_f32 v[86:87], v[66:67], v[76:77], v[94:95] op_sel:[0,0,0] op_sel_hi:[0,1,1] neg_lo:[0,0,1] neg_hi:[1,0,1]
    v_mov_b32_dpp v80, v78 row_ror:8 row_mask:0xf bank_mask:0x3
    v_mov_b32_dpp v81, v79 row_ror:8 row_mask:0xf bank_mask:0x3
    v_mov_b32_dpp v82, v84 row_ror:8 row_mask:0xf bank_mask:0x3
    v_mov_b32_dpp v83, v85 row_ror:8 row_mask:0xf bank_mask:0x3
    v_pk_mul_f32 v[92:93], v[66:67], v[80:81] op_sel:[1,1] op_sel_hi:[1,0]
    v_pk_fma_f32 v[88:89], v[66:67], v[80:81], v[92:93] op_sel:[0,0,0] op_sel_hi:[0,1,1] neg_lo:[0,0,1] neg_hi:[1,0,1]
    v_pk_mul_f32 v[94:95], v[66:67], v[82:83] op_sel:[1,1] op_sel_hi:[1,0]
    v_pk_fma_f32 v[90:91], v[66:67], v[82:83], v[94:95] op_sel:[0,0,0] op_sel_hi:[0,1,1] neg_lo:[0,0,1] neg_hi:[1,0,1]
    v_mfma_f32_16x16x4_f32 v[48:51], v86, v68, v[48:51]
    v_mfma_f32_16x16x4_f32 v[52:55], v88, v70, v[52:55]
    v_mfma_f32_16x16x4_f32 v[56:59], v88, v72, v[56:59]
    v_mfma_f32_16x16x4_f32 v[60:63], v90, v74, v[60:63]
    v_mfma_f32_16x16x4_f32 v[48:51], v87, v69, v[48:51]
    v_mfma_f32_16x16x4_f32 v[52:55], v89, v71, v[52:55]
    v_mfma_f32_16x16x4_f32 v[56:59], v89, v73, v[56:59]
    v_mfma_f32_16x16x4_f32 v[60:63], v91, v75, v[60:63]
    v_mov_b64_dpp v[64:65], v[28:29] row_newbcast:11 row_mask:0xf bank_mask:0xf
    v_mov_b64_dpp v[66:67], v[30:31] row_newbcast:11 row_mask:0xf bank_mask:0xf
    v_pk_mul_f32 v[94:95], v[64:65], v[26:27] op_sel_hi:[1,0]
    v_pk_mul_f32 v[96:97], v[64:65], v[26:27] op_sel:[0,1] op_sel_hi:[1,1]
    v_fract_f32 v95, v95
    v_fract_f32 v97, v97
    v_exp_f32 v94, v94
    v_exp_f32 v96, v96
    v_cos_f32 v68, v95
    v_sin_f32 v69, v95
    v_cos_f32 v76, v97
    v_sin_f32 v77, v97
    v_pk_mul_f32 v[68:69], v[68:69], v[94:95] op_sel_hi:[1,0]
    v_pk_mul_f32 v[76:77], v[76:77], v[96:97] op_sel_hi:[1,0]
    v_pk_mul_f32 v[92:93], v[76:77], v[76:77] op_sel:[1,1] op_sel_hi:[0,1]
    v_pk_fma_f32 v[78:79], v[76:77], v[76:77], v[92:93] op_sel:[0,0,0] op_sel_hi:[0,1,1] neg_lo:[0,0,1]
    v_pk_mul_f32 v[94:95], v[68:69], v[68:69] op_sel:[1,1] op_sel_hi:[0,1]
    v_pk_fma_f32 v[70:71], v[68:69], v[68:69], v[94:95] op_sel:[0,0,0] op_sel_hi:[0,1,1] neg_lo:[0,0,1]
    v_pk_mul_f32 v[92:93], v[78:79], v[78:79] op_sel:[1,1] op_sel_hi:[0,1]
    v_pk_fma_f32 v[80:81], v[78:79], v[78:79], v[92:93] op_sel:[0,0,0] op_sel_hi:[0,1,1] neg_lo:[0,0,1]
    v_pk_mul_f32 v[94:95], v[70:71], v[70:71] op_sel:[1,1] op_sel_hi:[0,1]
    v_pk_fma_f32 v[72:73], v[70:71], v[70:71], v[94:95] op_sel:[0,0,0] op_sel_hi:[0,1,1] neg_lo:[0,0,1]
    v_pk_mul_f32 v[92:93], v[80:81], v[80:81] op_sel:[1,1] op_sel_hi:[0,1]
    v_pk_fma_f32 v[82:83], v[80:81], v[80:81], v[92:93] op_sel:[0,0,0] op_sel_hi:[0,1,1] neg_lo:[0,0,1]
    v_pk_mul_f32 v[94:95], v[72:73], v[72:73] op_sel:[1,1] op_sel_hi:[0,1]
    v_pk_fma_f32 v[74:75], v[72:73], v[72:73], v[94:95] op_sel:[0,0,0] op_sel_hi:[0,1,1] neg_lo:[0,0,1]
    v_pk_mul_f32 v[92:93], v[82:83], v[82:83] op_sel:[1,1] op_sel_hi:[0,1]
    v_pk_fma_f32 v[84:85], v[82:83], v[82:83], v[92:93] op_sel:[0,0,0] op_sel_hi:[0,1,1] neg_lo:[0,0,1]
    v_pk_mul_f32 v[94:95], v[66:67], v[76:77] op_sel:[1,1] op_sel_hi:[1,0]
    v_pk_fma_f32 v[86:87], v[66:67], v[76:77], v[94:95] op_sel:[0,0,0] op_sel_hi:[0,1,1] neg_lo:[0,0,1] neg_hi:[1,0,1]
    v_mov_b32_dpp v80, v78 row_ror:8 row_mask:0xf bank_mask:0x3
    v_mov_b32_dpp v81, v79 row_ror:8 row_mask:0xf bank_mask:0x3
    v_mov_b32_dpp v82, v84 row_ror:8 row_mask:0xf bank_mask:0x3
    v_mov_b32_dpp v83, v85 row_ror:8 row_mask:0xf bank_mask:0x3
    v_pk_mul_f32 v[92:93], v[66:67], v[80:81] op_sel:[1,1] op_sel_hi:[1,0]
    v_pk_fma_f32 v[88:89], v[66:67], v[80:81], v[92:93] op_sel:[0,0,0] op_sel_hi:[0,1,1] neg_lo:[0,0,1] neg_hi:[1,0,1]
    v_pk_mul_f32 v[94:95], v[66:67], v[82:83] op_sel:[1,1] op_sel_hi:[1,0]
    v_pk_fma_f32 v[90:91], v[66:67], v[82:83], v[94:95] op_sel:[0,0,0] op_sel_hi:[0,1,1] neg_lo:[0,0,1] neg_hi:[1,0,1]
    v_mfma_f32_16x16x4_f32 v[48:51], v86, v68, v[48:51]
    v_mfma_f32_16x16x4_f32 v[52:55], v88, v70, v[52:55]
    v_mfma_f32_16x16x4_f32 v[56:59], v88, v72, v[56:59]
    v_mfma_f32_16x16x4_f32 v[60:63], v90, v74, v[60:63]
    v_mfma_f32_16x16x4_f32 v[48:51], v87, v69, v[48:51]
    v_mfma_f32_16x16x4_f32 v[52:55], v89, v71, v[52:55]
    v_mfma_f32_16x16x4_f32 v[56:59], v89, v73, v[56:59]
    v_mfma_f32_16x16x4_f32 v[60:63], v91, v75, v[60:63]
    v_mov_b64_dpp v[64:65], v[28:29] row_newbcast:12 row_mask:0xf bank_mask:0xf
    v_mov_b64_dpp v[66:67], v[30:31] row_newbcast:12 row_mask:0xf bank_mask:0xf
    v_pk_mul_f32 v[94:95], v[64:65], v[26:27] op_sel_hi:[1,0]
    v_pk_mul_f32 v[96:97], v[64:65], v[26:27] op_sel:[0,1] op_sel_hi:[1,1]
    v_fract_f32 v95, v95
    v_fract_f32 v97, v97
    v_exp_f32 v94, v94
    v_exp_f32 v96, v96
    v_cos_f32 v68, v95
    v_sin_f32 v69, v95
    v_cos_f32 v76, v97
    v_sin_f32 v77, v97
    v_pk_mul_f32 v[68:69], v[68:69], v[94:95] op_sel_hi:[1,0]
    v_pk_mul_f32 v[76:77], v[76:77], v[96:97] op_sel_hi:[1,0]
    v_pk_mul_f32 v[92:93], v[76:77], v[76:77] op_sel:[1,1] op_sel_hi:[0,1]
    v_pk_fma_f32 v[78:79], v[76:77], v[76:77], v[92:93] op_sel:[0,0,0] op_sel_hi:[0,1,1] neg_lo:[0,0,1]
    v_pk_mul_f32 v[94:95], v[68:69], v[68:69] op_sel:[1,1] op_sel_hi:[0,1]
    v_pk_fma_f32 v[70:71], v[68:69], v[68:69], v[94:95] op_sel:[0,0,0] op_sel_hi:[0,1,1] neg_lo:[0,0,1]
    v_pk_mul_f32 v[92:93], v[78:79], v[78:79] op_sel:[1,1] op_sel_hi:[0,1]
    v_pk_fma_f32 v[80:81], v[78:79], v[78:79], v[92:93] op_sel:[0,0,0] op_sel_hi:[0,1,1] neg_lo:[0,0,1]
    v_pk_mul_f32 v[94:95], v[70:71], v[70:71] op_sel:[1,1] op_sel_hi:[0,1]
    v_pk_fma_f32 v[72:73], v[70:71], v[70:71], v[94:95] op_sel:[0,0,0] op_sel_hi:[0,1,1] neg_lo:[0,0,1]
    v_pk_mul_f32 v[92:93], v[80:81], v[80:81] op_sel:[1,1] op_sel_hi:[0,1]
    v_pk_fma_f32 v[82:83], v[80:81], v[80:81], v[92:93] op_sel:[0,0,0] op_sel_hi:[0,1,1] neg_lo:[0,0,1]
    v_pk_mul_f32 v[94:95], v[72:73], v[72:73] op_sel:[1,1] op_sel_hi:[0,1]
    v_pk_fma_f32 v[74:75], v[72:73], v[72:73], v[94:95] op_sel:[0,0,0] op_sel_hi:[0,1,1] neg_lo:[0,0,1]
    v_pk_mul_f32 v[92:93], v[82:83], v[82:83] op_sel:[1,1] op_sel_hi:[0,1]
    v_pk_fma_f32 v[84:85], v[82:83], v[82:83], v[92:93] op_sel:[0,0,0] op_sel_hi:[0,1,1] neg_lo:[0,0,1]
    v_pk_mul_f32 v[94:95], v[66:67], v[76:77] op_sel:[1,1] op_sel_hi:[1,0]
    v_pk_fma_f32 v[86:87], v[66:67], v[76:77], v[94:95] op_sel:[0,0,0] op_sel_hi:[0,1,1] neg_lo:[0,0,1] neg_hi:[1,0,1]
    v_mov_b32_dpp v80, v78 row_ror:8 row_mask:0xf bank_mask:0x3
    v_mov_b32_dpp v81, v79 row_ror:8 row_mask:0xf bank_mask:0x3
    v_mov_b32_dpp v82, v84 row_ror:8 row_mask:0xf bank_mask:0x3
    v_mov_b32_dpp v83, v85 row_ror:8 row_mask:0xf bank_mask:0x3
    v_pk_mul_f32 v[92:93], v[66:67], v[80:81] op_sel:[1,1] op_sel_hi:[1,0]
    v_pk_fma_f32 v[88:89], v[66:67], v[80:81], v[92:93] op_sel:[0,0,0] op_sel_hi:[0,1,1] neg_lo:[0,0,1] neg_hi:[1,0,1]
    v_pk_mul_f32 v[94:95], v[66:67], v[82:83] op_sel:[1,1] op_sel_hi:[1,0]
    v_pk_fma_f32 v[90:91], v[66:67], v[82:83], v[94:95] op_sel:[0,0,0] op_sel_hi:[0,1,1] neg_lo:[0,0,1] neg_hi:[1,0,1]
    v_mfma_f32_16x16x4_f32 v[48:51], v86, v68, v[48:51]
    v_mfma_f32_16x16x4_f32 v[52:55], v88, v70, v[52:55]
    v_mfma_f32_16x16x4_f32 v[56:59], v88, v72, v[56:59]
    v_mfma_f32_16x16x4_f32 v[60:63], v90, v74, v[60:63]
    v_mfma_f32_16x16x4_f32 v[48:51], v87, v69, v[48:51]
    v_mfma_f32_16x16x4_f32 v[52:55], v89, v71, v[52:55]
    v_mfma_f32_16x16x4_f32 v[56:59], v89, v73, v[56:59]
    v_mfma_f32_16x16x4_f32 v[60:63], v91, v75, v[60:63]
    v_mov_b64_dpp v[64:65], v[28:29] row_newbcast:13 row_mask:0xf bank_mask:0xf
    v_mov_b64_dpp v[66:67], v[30:31] row_newbcast:13 row_mask:0xf bank_mask:0xf
    v_pk_mul_f32 v[94:95], v[64:65], v[26:27] op_sel_hi:[1,0]
    v_pk_mul_f32 v[96:97], v[64:65], v[26:27] op_sel:[0,1] op_sel_hi:[1,1]
    v_fract_f32 v95, v95
    v_fract_f32 v97, v97
    v_exp_f32 v94, v94
    v_exp_f32 v96, v96
    v_cos_f32 v68, v95
    v_sin_f32 v69, v95
    v_cos_f32 v76, v97
    v_sin_f32 v77, v97
    v_pk_mul_f32 v[68:69], v[68:69], v[94:95] op_sel_hi:[1,0]
    v_pk_mul_f32 v[76:77], v[76:77], v[96:97] op_sel_hi:[1,0]
    v_pk_mul_f32 v[92:93], v[76:77], v[76:77] op_sel:[1,1] op_sel_hi:[0,1]
    v_pk_fma_f32 v[78:79], v[76:77], v[76:77], v[92:93] op_sel:[0,0,0] op_sel_hi:[0,1,1] neg_lo:[0,0,1]
    v_pk_mul_f32 v[94:95], v[68:69], v[68:69] op_sel:[1,1] op_sel_hi:[0,1]
    v_pk_fma_f32 v[70:71], v[68:69], v[68:69], v[94:95] op_sel:[0,0,0] op_sel_hi:[0,1,1] neg_lo:[0,0,1]
    v_pk_mul_f32 v[92:93], v[78:79], v[78:79] op_sel:[1,1] op_sel_hi:[0,1]
    v_pk_fma_f32 v[80:81], v[78:79], v[78:79], v[92:93] op_sel:[0,0,0] op_sel_hi:[0,1,1] neg_lo:[0,0,1]
    v_pk_mul_f32 v[94:95], v[70:71], v[70:71] op_sel:[1,1] op_sel_hi:[0,1]
    v_pk_fma_f32 v[72:73], v[70:71], v[70:71], v[94:95] op_sel:[0,0,0] op_sel_hi:[0,1,1] neg_lo:[0,0,1]
    v_pk_mul_f32 v[92:93], v[80:81], v[80:81] op_sel:[1,1] op_sel_hi:[0,1]
    v_pk_fma_f32 v[82:83], v[80:81], v[80:81], v[92:93] op_sel:[0,0,0] op_sel_hi:[0,1,1] neg_lo:[0,0,1]
    v_pk_mul_f32 v[94:95], v[72:73], v[72:73] op_sel:[1,1] op_sel_hi:[0,1]
    v_pk_fma_f32 v[74:75], v[72:73], v[72:73], v[94:95] op_sel:[0,0,0] op_sel_hi:[0,1,1] neg_lo:[0,0,1]
    v_pk_mul_f32 v[92:93], v[82:83], v[82:83] op_sel:[1,1] op_sel_hi:[0,1]
    v_pk_fma_f32 v[84:85], v[82:83], v[82:83], v[92:93] op_sel:[0,0,0] op_sel_hi:[0,1,1] neg_lo:[0,0,1]
    v_pk_mul_f32 v[94:95], v[66:67], v[76:77] op_sel:[1,1] op_sel_hi:[1,0]
    v_pk_fma_f32 v[86:87], v[66:67], v[76:77], v[94:95] op_sel:[0,0,0] op_sel_hi:[0,1,1] neg_lo:[0,0,1] neg_hi:[1,0,1]
    v_mov_b32_dpp v80, v78 row_ror:8 row_mask:0xf bank_mask:0x3
    v_mov_b32_dpp v81, v79 row_ror:8 row_mask:0xf bank_mask:0x3
    v_mov_b32_dpp v82, v84 row_ror:8 row_mask:0xf bank_mask:0x3
    v_mov_b32_dpp v83, v85 row_ror:8 row_mask:0xf bank_mask:0x3
    v_pk_mul_f32 v[92:93], v[66:67], v[80:81] op_sel:[1,1] op_sel_hi:[1,0]
    v_pk_fma_f32 v[88:89], v[66:67], v[80:81], v[92:93] op_sel:[0,0,0] op_sel_hi:[0,1,1] neg_lo:[0,0,1] neg_hi:[1,0,1]
    v_pk_mul_f32 v[94:95], v[66:67], v[82:83] op_sel:[1,1] op_sel_hi:[1,0]
    v_pk_fma_f32 v[90:91], v[66:67], v[82:83], v[94:95] op_sel:[0,0,0] op_sel_hi:[0,1,1] neg_lo:[0,0,1] neg_hi:[1,0,1]
    v_mfma_f32_16x16x4_f32 v[48:51], v86, v68, v[48:51]
    v_mfma_f32_16x16x4_f32 v[52:55], v88, v70, v[52:55]
    v_mfma_f32_16x16x4_f32 v[56:59], v88, v72, v[56:59]
    v_mfma_f32_16x16x4_f32 v[60:63], v90, v74, v[60:63]
    v_mfma_f32_16x16x4_f32 v[48:51], v87, v69, v[48:51]
    v_mfma_f32_16x16x4_f32 v[52:55], v89, v71, v[52:55]
    v_mfma_f32_16x16x4_f32 v[56:59], v89, v73, v[56:59]
    v_mfma_f32_16x16x4_f32 v[60:63], v91, v75, v[60:63]
    v_mov_b64_dpp v[64:65], v[28:29] row_newbcast:14 row_mask:0xf bank_mask:0xf
    v_mov_b64_dpp v[66:67], v[30:31] row_newbcast:14 row_mask:0xf bank_mask:0xf
    v_pk_mul_f32 v[94:95], v[64:65], v[26:27] op_sel_hi:[1,0]
    v_pk_mul_f32 v[96:97], v[64:65], v[26:27] op_sel:[0,1] op_sel_hi:[1,1]
    v_fract_f32 v95, v95
    v_fract_f32 v97, v97
    v_exp_f32 v94, v94
    v_exp_f32 v96, v96
    v_cos_f32 v68, v95
    v_sin_f32 v69, v95
    v_cos_f32 v76, v97
    v_sin_f32 v77, v97
    v_pk_mul_f32 v[68:69], v[68:69], v[94:95] op_sel_hi:[1,0]
    v_pk_mul_f32 v[76:77], v[76:77], v[96:97] op_sel_hi:[1,0]
    v_pk_mul_f32 v[92:93], v[76:77], v[76:77] op_sel:[1,1] op_sel_hi:[0,1]
    v_pk_fma_f32 v[78:79], v[76:77], v[76:77], v[92:93] op_sel:[0,0,0] op_sel_hi:[0,1,1] neg_lo:[0,0,1]
    v_pk_mul_f32 v[94:95], v[68:69], v[68:69] op_sel:[1,1] op_sel_hi:[0,1]
    v_pk_fma_f32 v[70:71], v[68:69], v[68:69], v[94:95] op_sel:[0,0,0] op_sel_hi:[0,1,1] neg_lo:[0,0,1]
    v_pk_mul_f32 v[92:93], v[78:79], v[78:79] op_sel:[1,1] op_sel_hi:[0,1]
    v_pk_fma_f32 v[80:81], v[78:79], v[78:79], v[92:93] op_sel:[0,0,0] op_sel_hi:[0,1,1] neg_lo:[0,0,1]
    v_pk_mul_f32 v[94:95], v[70:71], v[70:71] op_sel:[1,1] op_sel_hi:[0,1]
    v_pk_fma_f32 v[72:73], v[70:71], v[70:71], v[94:95] op_sel:[0,0,0] op_sel_hi:[0,1,1] neg_lo:[0,0,1]
    v_pk_mul_f32 v[92:93], v[80:81], v[80:81] op_sel:[1,1] op_sel_hi:[0,1]
    v_pk_fma_f32 v[82:83], v[80:81], v[80:81], v[92:93] op_sel:[0,0,0] op_sel_hi:[0,1,1] neg_lo:[0,0,1]
    v_pk_mul_f32 v[94:95], v[72:73], v[72:73] op_sel:[1,1] op_sel_hi:[0,1]
    v_pk_fma_f32 v[74:75], v[72:73], v[72:73], v[94:95] op_sel:[0,0,0] op_sel_hi:[0,1,1] neg_lo:[0,0,1]
    v_pk_mul_f32 v[92:93], v[82:83], v[82:83] op_sel:[1,1] op_sel_hi:[0,1]
    v_pk_fma_f32 v[84:85], v[82:83], v[82:83], v[92:93] op_sel:[0,0,0] op_sel_hi:[0,1,1] neg_lo:[0,0,1]
    v_pk_mul_f32 v[94:95], v[66:67], v[76:77] op_sel:[1,1] op_sel_hi:[1,0]
    v_pk_fma_f32 v[86:87], v[66:67], v[76:77], v[94:95] op_sel:[0,0,0] op_sel_hi:[0,1,1] neg_lo:[0,0,1] neg_hi:[1,0,1]
    v_mov_b32_dpp v80, v78 row_ror:8 row_mask:0xf bank_mask:0x3
    v_mov_b32_dpp v81, v79 row_ror:8 row_mask:0xf bank_mask:0x3
    v_mov_b32_dpp v82, v84 row_ror:8 row_mask:0xf bank_mask:0x3
    v_mov_b32_dpp v83, v85 row_ror:8 row_mask:0xf bank_mask:0x3
    v_pk_mul_f32 v[92:93], v[66:67], v[80:81] op_sel:[1,1] op_sel_hi:[1,0]
    v_pk_fma_f32 v[88:89], v[66:67], v[80:81], v[92:93] op_sel:[0,0,0] op_sel_hi:[0,1,1] neg_lo:[0,0,1] neg_hi:[1,0,1]
    v_pk_mul_f32 v[94:95], v[66:67], v[82:83] op_sel:[1,1] op_sel_hi:[1,0]
    v_pk_fma_f32 v[90:91], v[66:67], v[82:83], v[94:95] op_sel:[0,0,0] op_sel_hi:[0,1,1] neg_lo:[0,0,1] neg_hi:[1,0,1]
    v_mfma_f32_16x16x4_f32 v[48:51], v86, v68, v[48:51]
    v_mfma_f32_16x16x4_f32 v[52:55], v88, v70, v[52:55]
    v_mfma_f32_16x16x4_f32 v[56:59], v88, v72, v[56:59]
    v_mfma_f32_16x16x4_f32 v[60:63], v90, v74, v[60:63]
    v_mfma_f32_16x16x4_f32 v[48:51], v87, v69, v[48:51]
    v_mfma_f32_16x16x4_f32 v[52:55], v89, v71, v[52:55]
    v_mfma_f32_16x16x4_f32 v[56:59], v89, v73, v[56:59]
    v_mfma_f32_16x16x4_f32 v[60:63], v91, v75, v[60:63]
    v_mov_b64_dpp v[64:65], v[28:29] row_newbcast:15 row_mask:0xf bank_mask:0xf
    v_mov_b64_dpp v[66:67], v[30:31] row_newbcast:15 row_mask:0xf bank_mask:0xf
    v_pk_mul_f32 v[94:95], v[64:65], v[26:27] op_sel_hi:[1,0]
    v_pk_mul_f32 v[96:97], v[64:65], v[26:27] op_sel:[0,1] op_sel_hi:[1,1]
    v_fract_f32 v95, v95
    v_fract_f32 v97, v97
    v_exp_f32 v94, v94
    v_exp_f32 v96, v96
    v_cos_f32 v68, v95
    v_sin_f32 v69, v95
    v_cos_f32 v76, v97
    v_sin_f32 v77, v97
    v_pk_mul_f32 v[68:69], v[68:69], v[94:95] op_sel_hi:[1,0]
    v_pk_mul_f32 v[76:77], v[76:77], v[96:97] op_sel_hi:[1,0]
    v_pk_mul_f32 v[92:93], v[76:77], v[76:77] op_sel:[1,1] op_sel_hi:[0,1]
    v_pk_fma_f32 v[78:79], v[76:77], v[76:77], v[92:93] op_sel:[0,0,0] op_sel_hi:[0,1,1] neg_lo:[0,0,1]
    v_pk_mul_f32 v[94:95], v[68:69], v[68:69] op_sel:[1,1] op_sel_hi:[0,1]
    v_pk_fma_f32 v[70:71], v[68:69], v[68:69], v[94:95] op_sel:[0,0,0] op_sel_hi:[0,1,1] neg_lo:[0,0,1]
    v_pk_mul_f32 v[92:93], v[78:79], v[78:79] op_sel:[1,1] op_sel_hi:[0,1]
    v_pk_fma_f32 v[80:81], v[78:79], v[78:79], v[92:93] op_sel:[0,0,0] op_sel_hi:[0,1,1] neg_lo:[0,0,1]
    v_pk_mul_f32 v[94:95], v[70:71], v[70:71] op_sel:[1,1] op_sel_hi:[0,1]
    v_pk_fma_f32 v[72:73], v[70:71], v[70:71], v[94:95] op_sel:[0,0,0] op_sel_hi:[0,1,1] neg_lo:[0,0,1]
    v_pk_mul_f32 v[92:93], v[80:81], v[80:81] op_sel:[1,1] op_sel_hi:[0,1]
    v_pk_fma_f32 v[82:83], v[80:81], v[80:81], v[92:93] op_sel:[0,0,0] op_sel_hi:[0,1,1] neg_lo:[0,0,1]
    v_pk_mul_f32 v[94:95], v[72:73], v[72:73] op_sel:[1,1] op_sel_hi:[0,1]
    v_pk_fma_f32 v[74:75], v[72:73], v[72:73], v[94:95] op_sel:[0,0,0] op_sel_hi:[0,1,1] neg_lo:[0,0,1]
    v_pk_mul_f32 v[92:93], v[82:83], v[82:83] op_sel:[1,1] op_sel_hi:[0,1]
    v_pk_fma_f32 v[84:85], v[82:83], v[82:83], v[92:93] op_sel:[0,0,0] op_sel_hi:[0,1,1] neg_lo:[0,0,1]
    v_pk_mul_f32 v[94:95], v[66:67], v[76:77] op_sel:[1,1] op_sel_hi:[1,0]
    v_pk_fma_f32 v[86:87], v[66:67], v[76:77], v[94:95] op_sel:[0,0,0] op_sel_hi:[0,1,1] neg_lo:[0,0,1] neg_hi:[1,0,1]
    v_mov_b32_dpp v80, v78 row_ror:8 row_mask:0xf bank_mask:0x3
    v_mov_b32_dpp v81, v79 row_ror:8 row_mask:0xf bank_mask:0x3
    v_mov_b32_dpp v82, v84 row_ror:8 row_mask:0xf bank_mask:0x3
    v_mov_b32_dpp v83, v85 row_ror:8 row_mask:0xf bank_mask:0x3
    v_pk_mul_f32 v[92:93], v[66:67], v[80:81] op_sel:[1,1] op_sel_hi:[1,0]
    v_pk_fma_f32 v[88:89], v[66:67], v[80:81], v[92:93] op_sel:[0,0,0] op_sel_hi:[0,1,1] neg_lo:[0,0,1] neg_hi:[1,0,1]
    v_pk_mul_f32 v[94:95], v[66:67], v[82:83] op_sel:[1,1] op_sel_hi:[1,0]
    v_pk_fma_f32 v[90:91], v[66:67], v[82:83], v[94:95] op_sel:[0,0,0] op_sel_hi:[0,1,1] neg_lo:[0,0,1] neg_hi:[1,0,1]
    v_mfma_f32_16x16x4_f32 v[48:51], v86, v68, v[48:51]
    v_mfma_f32_16x16x4_f32 v[52:55], v88, v70, v[52:55]
    v_mfma_f32_16x16x4_f32 v[56:59], v88, v72, v[56:59]
    v_mfma_f32_16x16x4_f32 v[60:63], v90, v74, v[60:63]
    v_mfma_f32_16x16x4_f32 v[48:51], v87, v69, v[48:51]
    v_mfma_f32_16x16x4_f32 v[52:55], v89, v71, v[52:55]
    v_mfma_f32_16x16x4_f32 v[56:59], v89, v73, v[56:59]
    v_mfma_f32_16x16x4_f32 v[60:63], v91, v75, v[60:63]
    v_mov_b64 v[28:29], v[32:33]
    v_mov_b64 v[30:31], v[34:35]
    s_add_u32 s25, s25, 1
    s_cmp_lt_u32 s25, 2
    s_cbranch_scc1 ss_kg
    s_cmp_lg_u32 s28, 0
    s_cbranch_scc1 ss_nostage
    s_waitcnt vmcnt(0)
    v_mov_b32 v36, 0x05040100
    v_mov_b32 v37, 0x07060302
    v_lshlrev_b32 v6, 4, v0
    v_add_u32 v7, 65536, v6
    v_perm_b32 v40, v212, v208, v36
    v_perm_b32 v41, v220, v216, v36
    v_perm_b32 v42, v228, v224, v36
    v_perm_b32 v43, v236, v232, v36
    ds_write_b128 v6, v[40:43] offset:512
    v_perm_b32 v44, v212, v208, v37
    v_perm_b32 v45, v220, v216, v37
    v_perm_b32 v46, v228, v224, v37
    v_perm_b32 v47, v236, v232, v37
    ds_write_b128 v6, v[44:47] offset:16896
    v_perm_b32 v40, v213, v209, v36
    v_perm_b32 v41, v221, v217, v36
    v_perm_b32 v42, v229, v225, v36
    v_perm_b32 v43, v237, v233, v36
    ds_write_b128 v6, v[40:43] offset:33280
    v_perm_b32 v44, v213, v209, v37
    v_perm_b32 v45, v221, v217, v37
    v_perm_b32 v46, v229, v225, v37
    v_perm_b32 v47, v237, v233, v37
    ds_write_b128 v6, v[44:47] offset:49664
    v_perm_b32 v40, v214, v210, v36
    v_perm_b32 v41, v222, v218, v36
    v_perm_b32 v42, v230, v226, v36
    v_perm_b32 v43, v238, v234, v36
    ds_write_b128 v7, v[40:43] offset:512
    v_perm_b32 v44, v214, v210, v37
    v_perm_b32 v45, v222, v218, v37
    v_perm_b32 v46, v230, v226, v37
    v_perm_b32 v47, v238, v234, v37
    ds_write_b128 v7, v[44:47] offset:16896
    v_perm_b32 v40, v215, v211, v36
    v_perm_b32 v41, v223, v219, v36
    v_perm_b32 v42, v231, v227, v36
    v_perm_b32 v43, v239, v235, v36
    ds_write_b128 v7, v[40:43] offset:33280
    v_perm_b32 v44, v215, v211, v37
    v_perm_b32 v45, v223, v219, v37
    v_perm_b32 v46, v231, v227, v37
    v_perm_b32 v47, v239, v235, v37
    ds_write_b128 v7, v[44:47] offset:49664
ss_nostage:
    s_nop 11
    v_lshlrev_b32 v5, 8, v3
    v_lshl_add_u32 v5, v2, 2, v5
    v_add_u32 v5, v5, v4
    ds_write_b32 v5, v48 offset:4608
    ds_write_b32 v5, v49 offset:4672
    ds_write_b32 v5, v50 offset:4736
    ds_write_b32 v5, v51 offset:4800
    s_mov_b32 exec_hi, 0
    ds_write_b32 v5, v52 offset:5632
    ds_write_b32 v5, v53 offset:5696
    ds_write_b32 v5, v54 offset:5760
    ds_write_b32 v5, v55 offset:5824
    s_not_b64 exec, exec
    ds_write_b32 v5, v56 offset:5632
    ds_write_b32 v5, v57 offset:5696
    ds_write_b32 v5, v58 offset:5760
    ds_write_b32 v5, v59 offset:5824
    ds_write_b32 v5, v60 offset:6144
    ds_write_b32 v5, v61 offset:6208
    ds_write_b32 v5, v62 offset:6272
    ds_write_b32 v5, v63 offset:6336
    s_mov_b64 exec, 3
    v_cmp_eq_u32 vcc, 0, v2
    s_nop 1
    v_cndmask_b32 v6, 0, v60, vcc
    ds_write_b32 v5, v6 offset:7168
    s_mov_b64 exec, -1
    s_waitcnt lgkmcnt(0)
    v_lshlrev_b32 v7, 1, v1
    v_sub_u32 v7, 2065, v7
    v_lshl_add_u32 v64, v1, 2, v4
    v_mov_b32 v65, 641
    s_mov_b32 s25, 9
    s_mov_b32 s22, 256
    s_mov_b32 s23, 2048
ss_exp:
    v_subrev_u32 v66, 0, v7
    v_cvt_f32_u32 v72, v66
    v_cmp_gt_u32 vcc, s22, v66
    v_cvt_pk_bf16_f32 v72, v72, 0
    v_subrev_u32 v72, 0x4280, v72
    v_cndmask_b32 v72, v72, v66, vcc
    v_cmp_gt_u32 vcc, s23, v66
    s_nop 1
    v_cndmask_b32 v72, v65, v72, vcc
    v_lshl_add_u32 v72, v72, 2, v4
    v_subrev_u32 v67, 1, v7
    v_cvt_f32_u32 v73, v67
    v_cmp_gt_u32 vcc, s22, v67
    v_cvt_pk_bf16_f32 v73, v73, 0
    v_subrev_u32 v73, 0x4280, v73
    v_cndmask_b32 v73, v73, v67, vcc
    v_cmp_gt_u32 vcc, s23, v67
    ds_read_b32 v78, v72 offset:4608
    s_nop 0
    v_cndmask_b32 v73, v65, v73, vcc
    v_lshl_add_u32 v73, v73, 2, v4
    v_subrev_u32 v68, 2, v7
    v_cvt_f32_u32 v74, v68
    v_cmp_gt_u32 vcc, s22, v68
    v_cvt_pk_bf16_f32 v74, v74, 0
    v_subrev_u32 v74, 0x4280, v74
    v_cndmask_b32 v74, v74, v68, vcc
    v_cmp_gt_u32 vcc, s23, v68
    ds_read_b32 v79, v73 offset:4608
    s_nop 0
    v_cndmask_b32 v74, v65, v74, vcc
    v_lshl_add_u32 v74, v74, 2, v4
    v_subrev_u32 v69, 128, v7
    v_cvt_f32_u32 v75, v69
    v_cmp_gt_u32 vcc, s22, v69
    v_cvt_pk_bf16_f32 v75, v75, 0
    v_subrev_u32 v75, 0x4280, v75
    v_cndmask_b32 v75, v75, v69, vcc
    v_cmp_gt_u32 vcc, s23, v69
    ds_read_b32 v80, v74 offset:4608
    s_nop 0
    v_cndmask_b32 v75, v65, v75, vcc
    v_lshl_add_u32 v75, v75, 2, v4
    v_subrev_u32 v70, 129, v7
    v_cvt_f32_u32 v76, v70
    v_cmp_gt_u32 vcc, s22, v70
    v_cvt_pk_bf16_f32 v76, v76, 0
    v_subrev_u32 v76, 0x4280, v76
    v_cndmask_b32 v76, v76, v70, vcc
    v_cmp_gt_u32 vcc, s23, v70
    ds_read_b32 v81, v75 offset:4608
    s_nop 0
    v_cndmask_b32 v76, v65, v76, vcc
    v_lshl_add_u32 v76, v76, 2, v4
    v_subrev_u32 v71, 130, v7
    v_cvt_f32_u32 v77, v71
    v_cmp_gt_u32 vcc, s22, v71
    v_cvt_pk_bf16_f32 v77, v77, 0
    v_subrev_u32 v77, 0x4280, v77
    v_cndmask_b32 v77, v77, v71, vcc
    v_cmp_gt_u32 vcc, s23, v71
    ds_read_b32 v82, v76 offset:4608
    s_nop 0
    v_cndmask_b32 v77, v65, v77, vcc
    v_lshl_add_u32 v77, v77, 2, v4
    ds_read_b32 v83, v77 offset:4608
    v_subrev_u32 v7, 256, v7
    s_sub_u32 s25, s25, 1
    s_waitcnt lgkmcnt(0)
    v_cvt_pk_bf16_f32 v84, v79, v80
    v_cvt_pk_bf16_f32 v85, v78, v79
    v_cvt_pk_bf16_f32 v86, v82, v83
    v_cvt_pk_bf16_f32 v87, v81, v82
    ds_write_b32 v64, v84 offset:7424
    ds_write_b32 v64, v85 offset:11776
    s_cmp_eq_u32 s25, 0
    s_cbranch_scc1 ss_expx
    ds_write_b32 v64, v86 offset:7680
    ds_write_b32 v64, v87 offset:12032
    v_add_u32 v64, 512, v64
    s_nop 1
    s_branch ss_exp
ss_expx:
    s_waitcnt lgkmcnt(0)
    s_barrier
    v_and_b32 v5, 1, v2
    v_mul_u32_u24 v36, 4352, v5
    v_sub_u32 v5, v5, v2
    v_lshl_add_u32 v5, v3, 3, v5
    v_lshl_add_u32 v36, v5, 1, v36
    v_add_u32 v36, 11072, v36
    v_add_u32 v36, v36, v4
    v_subrev_u32 v37, 512, v36
    v_subrev_u32 v38, 1024, v36
    v_subrev_u32 v39, 1536, v36
    v_subrev_u32 v40, 2048, v36
    v_subrev_u32 v41, 2560, v36
    v_subrev_u32 v42, 3072, v36
    v_subrev_u32 v43, 3584, v36
    v_lshlrev_b32 v44, 5, v2
    v_lshl_add_u32 v44, v3, 4, v44
    v_add_u32 v44, 32, v44
    v_add_u32 v44, v44, v4
    ds_read_b128 v[112:115], v44 offset:448
    ds_read2_b32 v[80:81], v36 offset0:112 offset1:113
    ds_read2_b32 v[82:83], v36 offset0:114 offset1:115
    ds_read_b128 v[116:119], v44 offset:960
    ds_read2_b32 v[84:85], v37 offset0:112 offset1:113
    ds_read2_b32 v[86:87], v37 offset0:114 offset1:115
    ds_read_b128 v[120:123], v44 offset:1472
    ds_read2_b32 v[88:89], v38 offset0:112 offset1:113
    ds_read2_b32 v[90:91], v38 offset0:114 offset1:115
    ds_read_b128 v[124:127], v44 offset:1984
    ds_read2_b32 v[92:93], v39 offset0:112 offset1:113
    ds_read2_b32 v[94:95], v39 offset0:114 offset1:115
    ds_read_b128 v[128:131], v44 offset:2496
    ds_read2_b32 v[96:97], v40 offset0:112 offset1:113
    ds_read2_b32 v[98:99], v40 offset0:114 offset1:115
    ds_read_b128 v[132:135], v44 offset:3008
    ds_read2_b32 v[100:101], v41 offset0:112 offset1:113
    ds_read2_b32 v[102:103], v41 offset0:114 offset1:115
    ds_read_b128 v[136:139], v44 offset:3520
    ds_read2_b32 v[104:105], v42 offset0:112 offset1:113
    ds_read2_b32 v[106:107], v42 offset0:114 offset1:115
    ds_read_b128 v[140:143], v44 offset:4032
    ds_read2_b32 v[108:109], v43 offset0:112 offset1:113
    ds_read2_b32 v[110:111], v43 offset0:114 offset1:115
    s_waitcnt lgkmcnt(0)
    v_mfma_f32_16x16x32_bf16 v[48:51], v[80:83], v[112:115], 0
    ds_read_b128 v[176:179], v44 offset:384
    v_mfma_f32_16x16x32_bf16 v[52:55], v[80:83], v[116:119], 0
    ds_read2_b32 v[144:145], v36 offset0:96 offset1:97
    v_mfma_f32_16x16x32_bf16 v[56:59], v[80:83], v[120:123], 0
    ds_read2_b32 v[146:147], v36 offset0:98 offset1:99
    v_mfma_f32_16x16x32_bf16 v[60:63], v[80:83], v[124:127], 0
    ds_read_b128 v[180:183], v44 offset:896
    v_mfma_f32_16x16x32_bf16 v[64:67], v[80:83], v[128:131], 0
    ds_read2_b32 v[148:149], v37 offset0:96 offset1:97
    v_mfma_f32_16x16x32_bf16 v[68:71], v[80:83], v[132:135], 0
    ds_read2_b32 v[150:151], v37 offset0:98 offset1:99
    v_mfma_f32_16x16x32_bf16 v[72:75], v[80:83], v[136:139], 0
    ds_read_b128 v[184:187], v44 offset:1408
    v_mfma_f32_16x16x32_bf16 v[76:79], v[80:83], v[140:143], 0
    ds_read2_b32 v[152:153], v38 offset0:96 offset1:97
    v_mfma_f32_16x16x32_bf16 v[52:55], v[84:87], v[112:115], v[52:55]
    ds_read2_b32 v[154:155], v38 offset0:98 offset1:99
    v_mfma_f32_16x16x32_bf16 v[56:59], v[84:87], v[116:119], v[56:59]
    ds_read_b128 v[188:191], v44 offset:1920
    v_mfma_f32_16x16x32_bf16 v[60:63], v[84:87], v[120:123], v[60:63]
    ds_read2_b32 v[156:157], v39 offset0:96 offset1:97
    v_mfma_f32_16x16x32_bf16 v[64:67], v[84:87], v[124:127], v[64:67]
    ds_read2_b32 v[158:159], v39 offset0:98 offset1:99
    v_mfma_f32_16x16x32_bf16 v[68:71], v[84:87], v[128:131], v[68:71]
    ds_read_b128 v[192:195], v44 offset:2432
    v_mfma_f32_16x16x32_bf16 v[72:75], v[84:87], v[132:135], v[72:75]
    ds_read2_b32 v[160:161], v40 offset0:96 offset1:97
    v_mfma_f32_16x16x32_bf16 v[76:79], v[84:87], v[136:139], v[76:79]
    ds_read2_b32 v[162:163], v40 offset0:98 offset1:99
    v_mfma_f32_16x16x32_bf16 v[56:59], v[88:91], v[112:115], v[56:59]
    ds_read_b128 v[196:199], v44 offset:2944
    v_mfma_f32_16x16x32_bf16 v[60:63], v[88:91], v[116:119], v[60:63]
    ds_read2_b32 v[164:165], v41 offset0:96 offset1:97
    v_mfma_f32_16x16x32_bf16 v[64:67], v[88:91], v[120:123], v[64:67]
    ds_read2_b32 v[166:167], v41 offset0:98 offset1:99
    v_mfma_f32_16x16x32_bf16 v[68:71], v[88:91], v[124:127], v[68:71]
    ds_read_b128 v[200:203], v44 offset:3456
    v_mfma_f32_16x16x32_bf16 v[72:75], v[88:91], v[128:131], v[72:75]
    ds_read2_b32 v[168:169], v42 offset0:96 offset1:97
    v_mfma_f32_16x16x32_bf16 v[76:79], v[88:91], v[132:135], v[76:79]
    ds_read2_b32 v[170:171], v42 offset0:98 offset1:99
    v_mfma_f32_16x16x32_bf16 v[60:63], v[92:95], v[112:115], v[60:63]
    ds_read_b128 v[204:207], v44 offset:3968
    v_mfma_f32_16x16x32_bf16 v[64:67], v[92:95], v[116:119], v[64:67]
    ds_read2_b32 v[172:173], v43 offset0:96 offset1:97
    v_mfma_f32_16x16x32_bf16 v[68:71], v[92:95], v[120:123], v[68:71]
    ds_read2_b32 v[174:175], v43 offset0:98 offset1:99
    v_mfma_f32_16x16x32_bf16 v[72:75], v[92:95], v[124:127], v[72:75]
    v_mfma_f32_16x16x32_bf16 v[76:79], v[92:95], v[128:131], v[76:79]
    v_mfma_f32_16x16x32_bf16 v[64:67], v[96:99], v[112:115], v[64:67]
    v_mfma_f32_16x16x32_bf16 v[68:71], v[96:99], v[116:119], v[68:71]
    v_mfma_f32_16x16x32_bf16 v[72:75], v[96:99], v[120:123], v[72:75]
    v_mfma_f32_16x16x32_bf16 v[76:79], v[96:99], v[124:127], v[76:79]
    v_mfma_f32_16x16x32_bf16 v[68:71], v[100:103], v[112:115], v[68:71]
    v_mfma_f32_16x16x32_bf16 v[72:75], v[100:103], v[116:119], v[72:75]
    v_mfma_f32_16x16x32_bf16 v[76:79], v[100:103], v[120:123], v[76:79]
    v_mfma_f32_16x16x32_bf16 v[72:75], v[104:107], v[112:115], v[72:75]
    v_mfma_f32_16x16x32_bf16 v[76:79], v[104:107], v[116:119], v[76:79]
    v_mfma_f32_16x16x32_bf16 v[76:79], v[108:111], v[112:115], v[76:79]
    s_waitcnt lgkmcnt(0)
    v_mfma_f32_16x16x32_bf16 v[48:51], v[144:147], v[176:179], v[48:51]
    ds_read_b128 v[112:115], v44 offset:320
    v_mfma_f32_16x16x32_bf16 v[52:55], v[144:147], v[180:183], v[52:55]
    ds_read2_b32 v[80:81], v36 offset0:80 offset1:81
    v_mfma_f32_16x16x32_bf16 v[56:59], v[144:147], v[184:187], v[56:59]
    ds_read2_b32 v[82:83], v36 offset0:82 offset1:83
    v_mfma_f32_16x16x32_bf16 v[60:63], v[144:147], v[188:191], v[60:63]
    ds_read_b128 v[116:119], v44 offset:832
    v_mfma_f32_16x16x32_bf16 v[64:67], v[144:147], v[192:195], v[64:67]
    ds_read2_b32 v[84:85], v37 offset0:80 offset1:81
    v_mfma_f32_16x16x32_bf16 v[68:71], v[144:147], v[196:199], v[68:71]
    ds_read2_b32 v[86:87], v37 offset0:82 offset1:83
    v_mfma_f32_16x16x32_bf16 v[72:75], v[144:147], v[200:203], v[72:75]
    ds_read_b128 v[120:123], v44 offset:1344
    v_mfma_f32_16x16x32_bf16 v[76:79], v[144:147], v[204:207], v[76:79]
    ds_read2_b32 v[88:89], v38 offset0:80 offset1:81
    v_mfma_f32_16x16x32_bf16 v[52:55], v[148:151], v[176:179], v[52:55]
    ds_read2_b32 v[90:91], v38 offset0:82 offset1:83
    v_mfma_f32_16x16x32_bf16 v[56:59], v[148:151], v[180:183], v[56:59]
    ds_read_b128 v[124:127], v44 offset:1856
    v_mfma_f32_16x16x32_bf16 v[60:63], v[148:151], v[184:187], v[60:63]
    ds_read2_b32 v[92:93], v39 offset0:80 offset1:81
    v_mfma_f32_16x16x32_bf16 v[64:67], v[148:151], v[188:191], v[64:67]
    ds_read2_b32 v[94:95], v39 offset0:82 offset1:83
    v_mfma_f32_16x16x32_bf16 v[68:71], v[148:151], v[192:195], v[68:71]
    ds_read_b128 v[128:131], v44 offset:2368
    v_mfma_f32_16x16x32_bf16 v[72:75], v[148:151], v[196:199], v[72:75]
    ds_read2_b32 v[96:97], v40 offset0:80 offset1:81
    v_mfma_f32_16x16x32_bf16 v[76:79], v[148:151], v[200:203], v[76:79]
    ds_read2_b32 v[98:99], v40 offset0:82 offset1:83
    v_mfma_f32_16x16x32_bf16 v[56:59], v[152:155], v[176:179], v[56:59]
    ds_read_b128 v[132:135], v44 offset:2880
    v_mfma_f32_16x16x32_bf16 v[60:63], v[152:155], v[180:183], v[60:63]
    ds_read2_b32 v[100:101], v41 offset0:80 offset1:81
    v_mfma_f32_16x16x32_bf16 v[64:67], v[152:155], v[184:187], v[64:67]
    ds_read2_b32 v[102:103], v41 offset0:82 offset1:83
    v_mfma_f32_16x16x32_bf16 v[68:71], v[152:155], v[188:191], v[68:71]
    ds_read_b128 v[136:139], v44 offset:3392
    v_mfma_f32_16x16x32_bf16 v[72:75], v[152:155], v[192:195], v[72:75]
    ds_read2_b32 v[104:105], v42 offset0:80 offset1:81
    v_mfma_f32_16x16x32_bf16 v[76:79], v[152:155], v[196:199], v[76:79]
    ds_read2_b32 v[106:107], v42 offset0:82 offset1:83
    v_mfma_f32_16x16x32_bf16 v[60:63], v[156:159], v[176:179], v[60:63]
    ds_read_b128 v[140:143], v44 offset:3904
    v_mfma_f32_16x16x32_bf16 v[64:67], v[156:159], v[180:183], v[64:67]
    ds_read2_b32 v[108:109], v43 offset0:80 offset1:81
    v_mfma_f32_16x16x32_bf16 v[68:71], v[156:159], v[184:187], v[68:71]
    ds_read2_b32 v[110:111], v43 offset0:82 offset1:83
    v_mfma_f32_16x16x32_bf16 v[72:75], v[156:159], v[188:191], v[72:75]
    v_mfma_f32_16x16x32_bf16 v[76:79], v[156:159], v[192:195], v[76:79]
    v_mfma_f32_16x16x32_bf16 v[64:67], v[160:163], v[176:179], v[64:67]
    v_mfma_f32_16x16x32_bf16 v[68:71], v[160:163], v[180:183], v[68:71]
    v_mfma_f32_16x16x32_bf16 v[72:75], v[160:163], v[184:187], v[72:75]
    v_mfma_f32_16x16x32_bf16 v[76:79], v[160:163], v[188:191], v[76:79]
    v_mfma_f32_16x16x32_bf16 v[68:71], v[164:167], v[176:179], v[68:71]
    v_mfma_f32_16x16x32_bf16 v[72:75], v[164:167], v[180:183], v[72:75]
    v_mfma_f32_16x16x32_bf16 v[76:79], v[164:167], v[184:187], v[76:79]
    v_mfma_f32_16x16x32_bf16 v[72:75], v[168:171], v[176:179], v[72:75]
    v_mfma_f32_16x16x32_bf16 v[76:79], v[168:171], v[180:183], v[76:79]
    v_mfma_f32_16x16x32_bf16 v[76:79], v[172:175], v[176:179], v[76:79]
    s_waitcnt lgkmcnt(0)
    v_mfma_f32_16x16x32_bf16 v[48:51], v[80:83], v[112:115], v[48:51]
    ds_read_b128 v[176:179], v44 offset:256
    v_mfma_f32_16x16x32_bf16 v[52:55], v[80:83], v[116:119], v[52:55]
    ds_read2_b32 v[144:145], v36 offset0:64 offset1:65
    v_mfma_f32_16x16x32_bf16 v[56:59], v[80:83], v[120:123], v[56:59]
    ds_read2_b32 v[146:147], v36 offset0:66 offset1:67
    v_mfma_f32_16x16x32_bf16 v[60:63], v[80:83], v[124:127], v[60:63]
    ds_read_b128 v[180:183], v44 offset:768
    v_mfma_f32_16x16x32_bf16 v[64:67], v[80:83], v[128:131], v[64:67]
    ds_read2_b32 v[148:149], v37 offset0:64 offset1:65
    v_mfma_f32_16x16x32_bf16 v[68:71], v[80:83], v[132:135], v[68:71]
    ds_read2_b32 v[150:151], v37 offset0:66 offset1:67
    v_mfma_f32_16x16x32_bf16 v[72:75], v[80:83], v[136:139], v[72:75]
    ds_read_b128 v[184:187], v44 offset:1280
    v_mfma_f32_16x16x32_bf16 v[76:79], v[80:83], v[140:143], v[76:79]
    ds_read2_b32 v[152:153], v38 offset0:64 offset1:65
    v_mfma_f32_16x16x32_bf16 v[52:55], v[84:87], v[112:115], v[52:55]
    ds_read2_b32 v[154:155], v38 offset0:66 offset1:67
    v_mfma_f32_16x16x32_bf16 v[56:59], v[84:87], v[116:119], v[56:59]
    ds_read_b128 v[188:191], v44 offset:1792
    v_mfma_f32_16x16x32_bf16 v[60:63], v[84:87], v[120:123], v[60:63]
    ds_read2_b32 v[156:157], v39 offset0:64 offset1:65
    v_mfma_f32_16x16x32_bf16 v[64:67], v[84:87], v[124:127], v[64:67]
    ds_read2_b32 v[158:159], v39 offset0:66 offset1:67
    v_mfma_f32_16x16x32_bf16 v[68:71], v[84:87], v[128:131], v[68:71]
    ds_read_b128 v[192:195], v44 offset:2304
    v_mfma_f32_16x16x32_bf16 v[72:75], v[84:87], v[132:135], v[72:75]
    ds_read2_b32 v[160:161], v40 offset0:64 offset1:65
    v_mfma_f32_16x16x32_bf16 v[76:79], v[84:87], v[136:139], v[76:79]
    ds_read2_b32 v[162:163], v40 offset0:66 offset1:67
    v_mfma_f32_16x16x32_bf16 v[56:59], v[88:91], v[112:115], v[56:59]
    ds_read_b128 v[196:199], v44 offset:2816
    v_mfma_f32_16x16x32_bf16 v[60:63], v[88:91], v[116:119], v[60:63]
    ds_read2_b32 v[164:165], v41 offset0:64 offset1:65
    v_mfma_f32_16x16x32_bf16 v[64:67], v[88:91], v[120:123], v[64:67]
    ds_read2_b32 v[166:167], v41 offset0:66 offset1:67
    v_mfma_f32_16x16x32_bf16 v[68:71], v[88:91], v[124:127], v[68:71]
    ds_read_b128 v[200:203], v44 offset:3328
    v_mfma_f32_16x16x32_bf16 v[72:75], v[88:91], v[128:131], v[72:75]
    ds_read2_b32 v[168:169], v42 offset0:64 offset1:65
    v_mfma_f32_16x16x32_bf16 v[76:79], v[88:91], v[132:135], v[76:79]
    ds_read2_b32 v[170:171], v42 offset0:66 offset1:67
    v_mfma_f32_16x16x32_bf16 v[60:63], v[92:95], v[112:115], v[60:63]
    ds_read_b128 v[204:207], v44 offset:3840
    v_mfma_f32_16x16x32_bf16 v[64:67], v[92:95], v[116:119], v[64:67]
    ds_read2_b32 v[172:173], v43 offset0:64 offset1:65
    v_mfma_f32_16x16x32_bf16 v[68:71], v[92:95], v[120:123], v[68:71]
    ds_read2_b32 v[174:175], v43 offset0:66 offset1:67
    v_mfma_f32_16x16x32_bf16 v[72:75], v[92:95], v[124:127], v[72:75]
    v_mfma_f32_16x16x32_bf16 v[76:79], v[92:95], v[128:131], v[76:79]
    v_mfma_f32_16x16x32_bf16 v[64:67], v[96:99], v[112:115], v[64:67]
    v_mfma_f32_16x16x32_bf16 v[68:71], v[96:99], v[116:119], v[68:71]
    v_mfma_f32_16x16x32_bf16 v[72:75], v[96:99], v[120:123], v[72:75]
    v_mfma_f32_16x16x32_bf16 v[76:79], v[96:99], v[124:127], v[76:79]
    v_mfma_f32_16x16x32_bf16 v[68:71], v[100:103], v[112:115], v[68:71]
    v_mfma_f32_16x16x32_bf16 v[72:75], v[100:103], v[116:119], v[72:75]
    v_mfma_f32_16x16x32_bf16 v[76:79], v[100:103], v[120:123], v[76:79]
    v_mfma_f32_16x16x32_bf16 v[72:75], v[104:107], v[112:115], v[72:75]
    v_mfma_f32_16x16x32_bf16 v[76:79], v[104:107], v[116:119], v[76:79]
    v_mfma_f32_16x16x32_bf16 v[76:79], v[108:111], v[112:115], v[76:79]
    s_waitcnt lgkmcnt(0)
    v_mfma_f32_16x16x32_bf16 v[48:51], v[144:147], v[176:179], v[48:51]
    ds_read_b128 v[112:115], v44 offset:192
    v_mfma_f32_16x16x32_bf16 v[52:55], v[144:147], v[180:183], v[52:55]
    ds_read2_b32 v[80:81], v36 offset0:48 offset1:49
    v_mfma_f32_16x16x32_bf16 v[56:59], v[144:147], v[184:187], v[56:59]
    ds_read2_b32 v[82:83], v36 offset0:50 offset1:51
    v_mfma_f32_16x16x32_bf16 v[60:63], v[144:147], v[188:191], v[60:63]
    ds_read_b128 v[116:119], v44 offset:704
    v_mfma_f32_16x16x32_bf16 v[64:67], v[144:147], v[192:195], v[64:67]
    ds_read2_b32 v[84:85], v37 offset0:48 offset1:49
    v_mfma_f32_16x16x32_bf16 v[68:71], v[144:147], v[196:199], v[68:71]
    ds_read2_b32 v[86:87], v37 offset0:50 offset1:51
    v_mfma_f32_16x16x32_bf16 v[72:75], v[144:147], v[200:203], v[72:75]
    ds_read_b128 v[120:123], v44 offset:1216
    v_mfma_f32_16x16x32_bf16 v[76:79], v[144:147], v[204:207], v[76:79]
    ds_read2_b32 v[88:89], v38 offset0:48 offset1:49
    v_mfma_f32_16x16x32_bf16 v[52:55], v[148:151], v[176:179], v[52:55]
    ds_read2_b32 v[90:91], v38 offset0:50 offset1:51
    v_mfma_f32_16x16x32_bf16 v[56:59], v[148:151], v[180:183], v[56:59]
    ds_read_b128 v[124:127], v44 offset:1728
    v_mfma_f32_16x16x32_bf16 v[60:63], v[148:151], v[184:187], v[60:63]
    ds_read2_b32 v[92:93], v39 offset0:48 offset1:49
    v_mfma_f32_16x16x32_bf16 v[64:67], v[148:151], v[188:191], v[64:67]
    ds_read2_b32 v[94:95], v39 offset0:50 offset1:51
    v_mfma_f32_16x16x32_bf16 v[68:71], v[148:151], v[192:195], v[68:71]
    ds_read_b128 v[128:131], v44 offset:2240
    v_mfma_f32_16x16x32_bf16 v[72:75], v[148:151], v[196:199], v[72:75]
    ds_read2_b32 v[96:97], v40 offset0:48 offset1:49
    v_mfma_f32_16x16x32_bf16 v[76:79], v[148:151], v[200:203], v[76:79]
    ds_read2_b32 v[98:99], v40 offset0:50 offset1:51
    v_mfma_f32_16x16x32_bf16 v[56:59], v[152:155], v[176:179], v[56:59]
    ds_read_b128 v[132:135], v44 offset:2752
    v_mfma_f32_16x16x32_bf16 v[60:63], v[152:155], v[180:183], v[60:63]
    ds_read2_b32 v[100:101], v41 offset0:48 offset1:49
    v_mfma_f32_16x16x32_bf16 v[64:67], v[152:155], v[184:187], v[64:67]
    ds_read2_b32 v[102:103], v41 offset0:50 offset1:51
    v_mfma_f32_16x16x32_bf16 v[68:71], v[152:155], v[188:191], v[68:71]
    ds_read_b128 v[136:139], v44 offset:3264
    v_mfma_f32_16x16x32_bf16 v[72:75], v[152:155], v[192:195], v[72:75]
    ds_read2_b32 v[104:105], v42 offset0:48 offset1:49
    v_mfma_f32_16x16x32_bf16 v[76:79], v[152:155], v[196:199], v[76:79]
    ds_read2_b32 v[106:107], v42 offset0:50 offset1:51
    v_mfma_f32_16x16x32_bf16 v[60:63], v[156:159], v[176:179], v[60:63]
    ds_read_b128 v[140:143], v44 offset:3776
    v_mfma_f32_16x16x32_bf16 v[64:67], v[156:159], v[180:183], v[64:67]
    ds_read2_b32 v[108:109], v43 offset0:48 offset1:49
    v_mfma_f32_16x16x32_bf16 v[68:71], v[156:159], v[184:187], v[68:71]
    ds_read2_b32 v[110:111], v43 offset0:50 offset1:51
    v_mfma_f32_16x16x32_bf16 v[72:75], v[156:159], v[188:191], v[72:75]
    v_mfma_f32_16x16x32_bf16 v[76:79], v[156:159], v[192:195], v[76:79]
    v_mfma_f32_16x16x32_bf16 v[64:67], v[160:163], v[176:179], v[64:67]
    v_mfma_f32_16x16x32_bf16 v[68:71], v[160:163], v[180:183], v[68:71]
    v_mfma_f32_16x16x32_bf16 v[72:75], v[160:163], v[184:187], v[72:75]
    v_mfma_f32_16x16x32_bf16 v[76:79], v[160:163], v[188:191], v[76:79]
    v_mfma_f32_16x16x32_bf16 v[68:71], v[164:167], v[176:179], v[68:71]
    v_mfma_f32_16x16x32_bf16 v[72:75], v[164:167], v[180:183], v[72:75]
    v_mfma_f32_16x16x32_bf16 v[76:79], v[164:167], v[184:187], v[76:79]
    v_mfma_f32_16x16x32_bf16 v[72:75], v[168:171], v[176:179], v[72:75]
    v_mfma_f32_16x16x32_bf16 v[76:79], v[168:171], v[180:183], v[76:79]
    v_mfma_f32_16x16x32_bf16 v[76:79], v[172:175], v[176:179], v[76:79]
    s_waitcnt lgkmcnt(0)
    v_mfma_f32_16x16x32_bf16 v[48:51], v[80:83], v[112:115], v[48:51]
    ds_read_b128 v[176:179], v44 offset:128
    v_mfma_f32_16x16x32_bf16 v[52:55], v[80:83], v[116:119], v[52:55]
    ds_read2_b32 v[144:145], v36 offset0:32 offset1:33
    v_mfma_f32_16x16x32_bf16 v[56:59], v[80:83], v[120:123], v[56:59]
    ds_read2_b32 v[146:147], v36 offset0:34 offset1:35
    v_mfma_f32_16x16x32_bf16 v[60:63], v[80:83], v[124:127], v[60:63]
    ds_read_b128 v[180:183], v44 offset:640
    v_mfma_f32_16x16x32_bf16 v[64:67], v[80:83], v[128:131], v[64:67]
    ds_read2_b32 v[148:149], v37 offset0:32 offset1:33
    v_mfma_f32_16x16x32_bf16 v[68:71], v[80:83], v[132:135], v[68:71]
    ds_read2_b32 v[150:151], v37 offset0:34 offset1:35
    v_mfma_f32_16x16x32_bf16 v[72:75], v[80:83], v[136:139], v[72:75]
    ds_read_b128 v[184:187], v44 offset:1152
    v_mfma_f32_16x16x32_bf16 v[76:79], v[80:83], v[140:143], v[76:79]
    ds_read2_b32 v[152:153], v38 offset0:32 offset1:33
    v_mfma_f32_16x16x32_bf16 v[52:55], v[84:87], v[112:115], v[52:55]
    ds_read2_b32 v[154:155], v38 offset0:34 offset1:35
    v_mfma_f32_16x16x32_bf16 v[56:59], v[84:87], v[116:119], v[56:59]
    ds_read_b128 v[188:191], v44 offset:1664
    v_mfma_f32_16x16x32_bf16 v[60:63], v[84:87], v[120:123], v[60:63]
    ds_read2_b32 v[156:157], v39 offset0:32 offset1:33
    v_mfma_f32_16x16x32_bf16 v[64:67], v[84:87], v[124:127], v[64:67]
    ds_read2_b32 v[158:159], v39 offset0:34 offset1:35
    v_mfma_f32_16x16x32_bf16 v[68:71], v[84:87], v[128:131], v[68:71]
    ds_read_b128 v[192:195], v44 offset:2176
    v_mfma_f32_16x16x32_bf16 v[72:75], v[84:87], v[132:135], v[72:75]
    ds_read2_b32 v[160:161], v40 offset0:32 offset1:33
    v_mfma_f32_16x16x32_bf16 v[76:79], v[84:87], v[136:139], v[76:79]
    ds_read2_b32 v[162:163], v40 offset0:34 offset1:35
    v_mfma_f32_16x16x32_bf16 v[56:59], v[88:91], v[112:115], v[56:59]
    ds_read_b128 v[196:199], v44 offset:2688
    v_mfma_f32_16x16x32_bf16 v[60:63], v[88:91], v[116:119], v[60:63]
    ds_read2_b32 v[164:165], v41 offset0:32 offset1:33
    v_mfma_f32_16x16x32_bf16 v[64:67], v[88:91], v[120:123], v[64:67]
    ds_read2_b32 v[166:167], v41 offset0:34 offset1:35
    v_mfma_f32_16x16x32_bf16 v[68:71], v[88:91], v[124:127], v[68:71]
    ds_read_b128 v[200:203], v44 offset:3200
    v_mfma_f32_16x16x32_bf16 v[72:75], v[88:91], v[128:131], v[72:75]
    ds_read2_b32 v[168:169], v42 offset0:32 offset1:33
    v_mfma_f32_16x16x32_bf16 v[76:79], v[88:91], v[132:135], v[76:79]
    ds_read2_b32 v[170:171], v42 offset0:34 offset1:35
    v_mfma_f32_16x16x32_bf16 v[60:63], v[92:95], v[112:115], v[60:63]
    ds_read_b128 v[204:207], v44 offset:3712
    v_mfma_f32_16x16x32_bf16 v[64:67], v[92:95], v[116:119], v[64:67]
    ds_read2_b32 v[172:173], v43 offset0:32 offset1:33
    v_mfma_f32_16x16x32_bf16 v[68:71], v[92:95], v[120:123], v[68:71]
    ds_read2_b32 v[174:175], v43 offset0:34 offset1:35
    v_mfma_f32_16x16x32_bf16 v[72:75], v[92:95], v[124:127], v[72:75]
    v_mfma_f32_16x16x32_bf16 v[76:79], v[92:95], v[128:131], v[76:79]
    v_mfma_f32_16x16x32_bf16 v[64:67], v[96:99], v[112:115], v[64:67]
    v_mfma_f32_16x16x32_bf16 v[68:71], v[96:99], v[116:119], v[68:71]
    v_mfma_f32_16x16x32_bf16 v[72:75], v[96:99], v[120:123], v[72:75]
    v_mfma_f32_16x16x32_bf16 v[76:79], v[96:99], v[124:127], v[76:79]
    v_mfma_f32_16x16x32_bf16 v[68:71], v[100:103], v[112:115], v[68:71]
    v_mfma_f32_16x16x32_bf16 v[72:75], v[100:103], v[116:119], v[72:75]
    v_mfma_f32_16x16x32_bf16 v[76:79], v[100:103], v[120:123], v[76:79]
    v_mfma_f32_16x16x32_bf16 v[72:75], v[104:107], v[112:115], v[72:75]
    v_mfma_f32_16x16x32_bf16 v[76:79], v[104:107], v[116:119], v[76:79]
    v_mfma_f32_16x16x32_bf16 v[76:79], v[108:111], v[112:115], v[76:79]
    s_waitcnt lgkmcnt(0)
    v_mfma_f32_16x16x32_bf16 v[48:51], v[144:147], v[176:179], v[48:51]
    ds_read_b128 v[112:115], v44 offset:64
    v_mfma_f32_16x16x32_bf16 v[52:55], v[144:147], v[180:183], v[52:55]
    ds_read2_b32 v[80:81], v36 offset0:16 offset1:17
    v_mfma_f32_16x16x32_bf16 v[56:59], v[144:147], v[184:187], v[56:59]
    ds_read2_b32 v[82:83], v36 offset0:18 offset1:19
    v_mfma_f32_16x16x32_bf16 v[60:63], v[144:147], v[188:191], v[60:63]
    ds_read_b128 v[116:119], v44 offset:576
    v_mfma_f32_16x16x32_bf16 v[64:67], v[144:147], v[192:195], v[64:67]
    ds_read2_b32 v[84:85], v37 offset0:16 offset1:17
    v_mfma_f32_16x16x32_bf16 v[68:71], v[144:147], v[196:199], v[68:71]
    ds_read2_b32 v[86:87], v37 offset0:18 offset1:19
    v_mfma_f32_16x16x32_bf16 v[72:75], v[144:147], v[200:203], v[72:75]
    ds_read_b128 v[120:123], v44 offset:1088
    v_mfma_f32_16x16x32_bf16 v[76:79], v[144:147], v[204:207], v[76:79]
    ds_read2_b32 v[88:89], v38 offset0:16 offset1:17
    v_mfma_f32_16x16x32_bf16 v[52:55], v[148:151], v[176:179], v[52:55]
    ds_read2_b32 v[90:91], v38 offset0:18 offset1:19
    v_mfma_f32_16x16x32_bf16 v[56:59], v[148:151], v[180:183], v[56:59]
    ds_read_b128 v[124:127], v44 offset:1600
    v_mfma_f32_16x16x32_bf16 v[60:63], v[148:151], v[184:187], v[60:63]
    ds_read2_b32 v[92:93], v39 offset0:16 offset1:17
    v_mfma_f32_16x16x32_bf16 v[64:67], v[148:151], v[188:191], v[64:67]
    ds_read2_b32 v[94:95], v39 offset0:18 offset1:19
    v_mfma_f32_16x16x32_bf16 v[68:71], v[148:151], v[192:195], v[68:71]
    ds_read_b128 v[128:131], v44 offset:2112
    v_mfma_f32_16x16x32_bf16 v[72:75], v[148:151], v[196:199], v[72:75]
    ds_read2_b32 v[96:97], v40 offset0:16 offset1:17
    v_mfma_f32_16x16x32_bf16 v[76:79], v[148:151], v[200:203], v[76:79]
    ds_read2_b32 v[98:99], v40 offset0:18 offset1:19
    v_mfma_f32_16x16x32_bf16 v[56:59], v[152:155], v[176:179], v[56:59]
    ds_read_b128 v[132:135], v44 offset:2624
    v_mfma_f32_16x16x32_bf16 v[60:63], v[152:155], v[180:183], v[60:63]
    ds_read2_b32 v[100:101], v41 offset0:16 offset1:17
    v_mfma_f32_16x16x32_bf16 v[64:67], v[152:155], v[184:187], v[64:67]
    ds_read2_b32 v[102:103], v41 offset0:18 offset1:19
    v_mfma_f32_16x16x32_bf16 v[68:71], v[152:155], v[188:191], v[68:71]
    ds_read_b128 v[136:139], v44 offset:3136
    v_mfma_f32_16x16x32_bf16 v[72:75], v[152:155], v[192:195], v[72:75]
    ds_read2_b32 v[104:105], v42 offset0:16 offset1:17
    v_mfma_f32_16x16x32_bf16 v[76:79], v[152:155], v[196:199], v[76:79]
    ds_read2_b32 v[106:107], v42 offset0:18 offset1:19
    v_mfma_f32_16x16x32_bf16 v[60:63], v[156:159], v[176:179], v[60:63]
    ds_read_b128 v[140:143], v44 offset:3648
    v_mfma_f32_16x16x32_bf16 v[64:67], v[156:159], v[180:183], v[64:67]
    ds_read2_b32 v[108:109], v43 offset0:16 offset1:17
    v_mfma_f32_16x16x32_bf16 v[68:71], v[156:159], v[184:187], v[68:71]
    ds_read2_b32 v[110:111], v43 offset0:18 offset1:19
    v_mfma_f32_16x16x32_bf16 v[72:75], v[156:159], v[188:191], v[72:75]
    v_mfma_f32_16x16x32_bf16 v[76:79], v[156:159], v[192:195], v[76:79]
    v_mfma_f32_16x16x32_bf16 v[64:67], v[160:163], v[176:179], v[64:67]
    v_mfma_f32_16x16x32_bf16 v[68:71], v[160:163], v[180:183], v[68:71]
    v_mfma_f32_16x16x32_bf16 v[72:75], v[160:163], v[184:187], v[72:75]
    v_mfma_f32_16x16x32_bf16 v[76:79], v[160:163], v[188:191], v[76:79]
    v_mfma_f32_16x16x32_bf16 v[68:71], v[164:167], v[176:179], v[68:71]
    v_mfma_f32_16x16x32_bf16 v[72:75], v[164:167], v[180:183], v[72:75]
    v_mfma_f32_16x16x32_bf16 v[76:79], v[164:167], v[184:187], v[76:79]
    v_mfma_f32_16x16x32_bf16 v[72:75], v[168:171], v[176:179], v[72:75]
    v_mfma_f32_16x16x32_bf16 v[76:79], v[168:171], v[180:183], v[76:79]
    v_mfma_f32_16x16x32_bf16 v[76:79], v[172:175], v[176:179], v[76:79]
    s_waitcnt lgkmcnt(0)
    v_mfma_f32_16x16x32_bf16 v[48:51], v[80:83], v[112:115], v[48:51]
    ds_read_b128 v[176:179], v44 offset:0
    v_mfma_f32_16x16x32_bf16 v[52:55], v[80:83], v[116:119], v[52:55]
    ds_read2_b32 v[144:145], v36 offset0:0 offset1:1
    v_mfma_f32_16x16x32_bf16 v[56:59], v[80:83], v[120:123], v[56:59]
    ds_read2_b32 v[146:147], v36 offset0:2 offset1:3
    v_mfma_f32_16x16x32_bf16 v[60:63], v[80:83], v[124:127], v[60:63]
    ds_read_b128 v[180:183], v44 offset:512
    v_mfma_f32_16x16x32_bf16 v[64:67], v[80:83], v[128:131], v[64:67]
    ds_read2_b32 v[148:149], v37 offset0:0 offset1:1
    v_mfma_f32_16x16x32_bf16 v[68:71], v[80:83], v[132:135], v[68:71]
    ds_read2_b32 v[150:151], v37 offset0:2 offset1:3
    v_mfma_f32_16x16x32_bf16 v[72:75], v[80:83], v[136:139], v[72:75]
    ds_read_b128 v[184:187], v44 offset:1024
    v_mfma_f32_16x16x32_bf16 v[76:79], v[80:83], v[140:143], v[76:79]
    ds_read2_b32 v[152:153], v38 offset0:0 offset1:1
    v_mfma_f32_16x16x32_bf16 v[52:55], v[84:87], v[112:115], v[52:55]
    ds_read2_b32 v[154:155], v38 offset0:2 offset1:3
    v_mfma_f32_16x16x32_bf16 v[56:59], v[84:87], v[116:119], v[56:59]
    ds_read_b128 v[188:191], v44 offset:1536
    v_mfma_f32_16x16x32_bf16 v[60:63], v[84:87], v[120:123], v[60:63]
    ds_read2_b32 v[156:157], v39 offset0:0 offset1:1
    v_mfma_f32_16x16x32_bf16 v[64:67], v[84:87], v[124:127], v[64:67]
    ds_read2_b32 v[158:159], v39 offset0:2 offset1:3
    v_mfma_f32_16x16x32_bf16 v[68:71], v[84:87], v[128:131], v[68:71]
    ds_read_b128 v[192:195], v44 offset:2048
    v_mfma_f32_16x16x32_bf16 v[72:75], v[84:87], v[132:135], v[72:75]
    ds_read2_b32 v[160:161], v40 offset0:0 offset1:1
    v_mfma_f32_16x16x32_bf16 v[76:79], v[84:87], v[136:139], v[76:79]
    ds_read2_b32 v[162:163], v40 offset0:2 offset1:3
    v_mfma_f32_16x16x32_bf16 v[56:59], v[88:91], v[112:115], v[56:59]
    ds_read_b128 v[196:199], v44 offset:2560
    v_mfma_f32_16x16x32_bf16 v[60:63], v[88:91], v[116:119], v[60:63]
    ds_read2_b32 v[164:165], v41 offset0:0 offset1:1
    v_mfma_f32_16x16x32_bf16 v[64:67], v[88:91], v[120:123], v[64:67]
    ds_read2_b32 v[166:167], v41 offset0:2 offset1:3
    v_mfma_f32_16x16x32_bf16 v[68:71], v[88:91], v[124:127], v[68:71]
    ds_read_b128 v[200:203], v44 offset:3072
    v_mfma_f32_16x16x32_bf16 v[72:75], v[88:91], v[128:131], v[72:75]
    ds_read2_b32 v[168:169], v42 offset0:0 offset1:1
    v_mfma_f32_16x16x32_bf16 v[76:79], v[88:91], v[132:135], v[76:79]
    ds_read2_b32 v[170:171], v42 offset0:2 offset1:3
    v_mfma_f32_16x16x32_bf16 v[60:63], v[92:95], v[112:115], v[60:63]
    ds_read_b128 v[204:207], v44 offset:3584
    v_mfma_f32_16x16x32_bf16 v[64:67], v[92:95], v[116:119], v[64:67]
    ds_read2_b32 v[172:173], v43 offset0:0 offset1:1
    v_mfma_f32_16x16x32_bf16 v[68:71], v[92:95], v[120:123], v[68:71]
    ds_read2_b32 v[174:175], v43 offset0:2 offset1:3
    v_mfma_f32_16x16x32_bf16 v[72:75], v[92:95], v[124:127], v[72:75]
    v_mfma_f32_16x16x32_bf16 v[76:79], v[92:95], v[128:131], v[76:79]
    v_mfma_f32_16x16x32_bf16 v[64:67], v[96:99], v[112:115], v[64:67]
    v_mfma_f32_16x16x32_bf16 v[68:71], v[96:99], v[116:119], v[68:71]
    v_mfma_f32_16x16x32_bf16 v[72:75], v[96:99], v[120:123], v[72:75]
    v_mfma_f32_16x16x32_bf16 v[76:79], v[96:99], v[124:127], v[76:79]
    v_mfma_f32_16x16x32_bf16 v[68:71], v[100:103], v[112:115], v[68:71]
    v_mfma_f32_16x16x32_bf16 v[72:75], v[100:103], v[116:119], v[72:75]
    v_mfma_f32_16x16x32_bf16 v[76:79], v[100:103], v[120:123], v[76:79]
    v_mfma_f32_16x16x32_bf16 v[72:75], v[104:107], v[112:115], v[72:75]
    v_mfma_f32_16x16x32_bf16 v[76:79], v[104:107], v[116:119], v[76:79]
    v_mfma_f32_16x16x32_bf16 v[76:79], v[108:111], v[112:115], v[76:79]
    s_waitcnt lgkmcnt(0)
    v_mfma_f32_16x16x32_bf16 v[48:51], v[144:147], v[176:179], v[48:51]
    v_mfma_f32_16x16x32_bf16 v[52:55], v[144:147], v[180:183], v[52:55]
    v_mfma_f32_16x16x32_bf16 v[56:59], v[144:147], v[184:187], v[56:59]
    v_mfma_f32_16x16x32_bf16 v[60:63], v[144:147], v[188:191], v[60:63]
    v_mfma_f32_16x16x32_bf16 v[64:67], v[144:147], v[192:195], v[64:67]
    v_mfma_f32_16x16x32_bf16 v[68:71], v[144:147], v[196:199], v[68:71]
    v_mfma_f32_16x16x32_bf16 v[72:75], v[144:147], v[200:203], v[72:75]
    v_mfma_f32_16x16x32_bf16 v[76:79], v[144:147], v[204:207], v[76:79]
    v_mfma_f32_16x16x32_bf16 v[52:55], v[148:151], v[176:179], v[52:55]
    v_mfma_f32_16x16x32_bf16 v[56:59], v[148:151], v[180:183], v[56:59]
    v_mfma_f32_16x16x32_bf16 v[60:63], v[148:151], v[184:187], v[60:63]
    v_mfma_f32_16x16x32_bf16 v[64:67], v[148:151], v[188:191], v[64:67]
    v_mfma_f32_16x16x32_bf16 v[68:71], v[148:151], v[192:195], v[68:71]
    v_mfma_f32_16x16x32_bf16 v[72:75], v[148:151], v[196:199], v[72:75]
    v_mfma_f32_16x16x32_bf16 v[76:79], v[148:151], v[200:203], v[76:79]
    v_mfma_f32_16x16x32_bf16 v[56:59], v[152:155], v[176:179], v[56:59]
    v_mfma_f32_16x16x32_bf16 v[60:63], v[152:155], v[180:183], v[60:63]
    v_mfma_f32_16x16x32_bf16 v[64:67], v[152:155], v[184:187], v[64:67]
    v_mfma_f32_16x16x32_bf16 v[68:71], v[152:155], v[188:191], v[68:71]
    v_mfma_f32_16x16x32_bf16 v[72:75], v[152:155], v[192:195], v[72:75]
    v_mfma_f32_16x16x32_bf16 v[76:79], v[152:155], v[196:199], v[76:79]
    v_mfma_f32_16x16x32_bf16 v[60:63], v[156:159], v[176:179], v[60:63]
    v_mfma_f32_16x16x32_bf16 v[64:67], v[156:159], v[180:183], v[64:67]
    v_mfma_f32_16x16x32_bf16 v[68:71], v[156:159], v[184:187], v[68:71]
    v_mfma_f32_16x16x32_bf16 v[72:75], v[156:159], v[188:191], v[72:75]
    v_mfma_f32_16x16x32_bf16 v[76:79], v[156:159], v[192:195], v[76:79]
    v_mfma_f32_16x16x32_bf16 v[64:67], v[160:163], v[176:179], v[64:67]
    v_mfma_f32_16x16x32_bf16 v[68:71], v[160:163], v[180:183], v[68:71]
    v_mfma_f32_16x16x32_bf16 v[72:75], v[160:163], v[184:187], v[72:75]
    v_mfma_f32_16x16x32_bf16 v[76:79], v[160:163], v[188:191], v[76:79]
    v_mfma_f32_16x16x32_bf16 v[68:71], v[164:167], v[176:179], v[68:71]
    v_mfma_f32_16x16x32_bf16 v[72:75], v[164:167], v[180:183], v[72:75]
    v_mfma_f32_16x16x32_bf16 v[76:79], v[164:167], v[184:187], v[76:79]
    v_mfma_f32_16x16x32_bf16 v[72:75], v[168:171], v[176:179], v[72:75]
    v_mfma_f32_16x16x32_bf16 v[76:79], v[168:171], v[180:183], v[76:79]
    v_mfma_f32_16x16x32_bf16 v[76:79], v[172:175], v[176:179], v[76:79]
    s_nop 7
    v_lshlrev_b32 v5, 6, v2
    v_lshl_add_u32 v5, v3, 4, v5
    v_add_u32 v5, v5, v4
    ds_write_b128 v5, v[48:51] offset:7424
    ds_write_b128 v5, v[52:55] offset:8448
    ds_write_b128 v5, v[56:59] offset:9472
    ds_write_b128 v5, v[60:63] offset:10496
    ds_write_b128 v5, v[64:67] offset:11520
    ds_write_b128 v5, v[68:71] offset:12544
    ds_write_b128 v5, v[72:75] offset:13568
    ds_write_b128 v5, v[76:79] offset:14592
    v_mov_b64 v[8:9], v[16:17]
    v_mov_b64 v[10:11], v[18:19]
    v_mov_b64 v[12:13], v[20:21]
    v_mov_b64 v[14:15], v[22:23]
    v_mov_b32 v24, v25
    v_add_u32 v4, 65536, v4
    s_add_u32 s28, s28, 1
    s_cmp_lt_u32 s28, 2
    s_waitcnt lgkmcnt(0)
    s_cbranch_scc1 ss_pass
    s_mov_b32 s12, s74
    s_mov_b32 s13, s75
    s_mov_b32 s14, 1152
    s_mov_b32 s15, 0x20000
    s_lshl_b32 s23, s20, 1
    buffer_load_dwordx4 v[8:11], off, s[12:15], s23
    s_barrier
    v_lshlrev_b32 v5, 5, v0
    v_add_u32 v7, 65536, v5
    ds_read_b128 v[64:67], v5 offset:7424
    ds_read_b128 v[68:71], v5 offset:7440
    ds_read_b128 v[72:75], v5 offset:23808
    ds_read_b128 v[76:79], v5 offset:23824
    ds_read_b128 v[80:83], v5 offset:40192
    ds_read_b128 v[84:87], v5 offset:40208
    ds_read_b128 v[88:91], v5 offset:56576
    ds_read_b128 v[92:95], v5 offset:56592
    ds_read_b128 v[96:99], v7 offset:7424
    ds_read_b128 v[100:103], v7 offset:7440
    ds_read_b128 v[104:107], v7 offset:23808
    ds_read_b128 v[108:111], v7 offset:23824
    ds_read_b128 v[112:115], v7 offset:40192
    ds_read_b128 v[116:119], v7 offset:40208
    ds_read_b128 v[120:123], v7 offset:56576
    ds_read_b128 v[124:127], v7 offset:56592
    s_waitcnt vmcnt(0)
    v_lshlrev_b32 v12, 16, v8
    v_and_b32 v13, 0xffff0000, v8
    v_lshlrev_b32 v14, 16, v9
    v_and_b32 v15, 0xffff0000, v9
    v_lshlrev_b32 v16, 16, v10
    v_and_b32 v17, 0xffff0000, v10
    v_lshlrev_b32 v18, 16, v11
    v_and_b32 v19, 0xffff0000, v11
    v_mul_u32_u24 v5, 18432, v0
    s_lshl_b32 s22, s20, 1
    s_add_u32 s22, s22, 1152
    s_waitcnt lgkmcnt(0)
    v_lshlrev_b32 v6, 16, v208
    v_fmac_f32 v64, v6, v12
    v_and_b32 v6, 0xffff0000, v208
    v_fmac_f32 v72, v6, v13
    v_lshlrev_b32 v6, 16, v209
    v_fmac_f32 v80, v6, v14
    v_and_b32 v6, 0xffff0000, v209
    v_fmac_f32 v88, v6, v15
    v_lshlrev_b32 v6, 16, v210
    v_fmac_f32 v96, v6, v16
    v_and_b32 v6, 0xffff0000, v210
    v_fmac_f32 v104, v6, v17
    v_lshlrev_b32 v6, 16, v211
    v_fmac_f32 v112, v6, v18
    v_and_b32 v6, 0xffff0000, v211
    v_fmac_f32 v120, v6, v19
    v_cvt_pk_bf16_f32 v208, v64, v72
    v_cvt_pk_bf16_f32 v209, v80, v88
    v_cvt_pk_bf16_f32 v210, v96, v104
    v_cvt_pk_bf16_f32 v211, v112, v120
    s_add_u32 s23, s22, 0
    buffer_store_dwordx4 v[208:211], v5, s[16:19], s23 offen
    v_lshlrev_b32 v6, 16, v212
    v_fmac_f32 v65, v6, v12
    v_and_b32 v6, 0xffff0000, v212
    v_fmac_f32 v73, v6, v13
    v_lshlrev_b32 v6, 16, v213
    v_fmac_f32 v81, v6, v14
    v_and_b32 v6, 0xffff0000, v213
    v_fmac_f32 v89, v6, v15
    v_lshlrev_b32 v6, 16, v214
    v_fmac_f32 v97, v6, v16
    v_and_b32 v6, 0xffff0000, v214
    v_fmac_f32 v105, v6, v17
    v_lshlrev_b32 v6, 16, v215
    v_fmac_f32 v113, v6, v18
    v_and_b32 v6, 0xffff0000, v215
    v_fmac_f32 v121, v6, v19
    v_cvt_pk_bf16_f32 v212, v65, v73
    v_cvt_pk_bf16_f32 v213, v81, v89
    v_cvt_pk_bf16_f32 v214, v97, v105
    v_cvt_pk_bf16_f32 v215, v113, v121
    s_add_u32 s23, s22, 2304
    buffer_store_dwordx4 v[212:215], v5, s[16:19], s23 offen
    v_lshlrev_b32 v6, 16, v216
    v_fmac_f32 v66, v6, v12
    v_and_b32 v6, 0xffff0000, v216
    v_fmac_f32 v74, v6, v13
    v_lshlrev_b32 v6, 16, v217
    v_fmac_f32 v82, v6, v14
    v_and_b32 v6, 0xffff0000, v217
    v_fmac_f32 v90, v6, v15
    v_lshlrev_b32 v6, 16, v218
    v_fmac_f32 v98, v6, v16
    v_and_b32 v6, 0xffff0000, v218
    v_fmac_f32 v106, v6, v17
    v_lshlrev_b32 v6, 16, v219
    v_fmac_f32 v114, v6, v18
    v_and_b32 v6, 0xffff0000, v219
    v_fmac_f32 v122, v6, v19
    v_cvt_pk_bf16_f32 v216, v66, v74
    v_cvt_pk_bf16_f32 v217, v82, v90
    v_cvt_pk_bf16_f32 v218, v98, v106
    v_cvt_pk_bf16_f32 v219, v114, v122
    s_add_u32 s23, s22, 4608
    buffer_store_dwordx4 v[216:219], v5, s[16:19], s23 offen
    v_lshlrev_b32 v6, 16, v220
    v_fmac_f32 v67, v6, v12
    v_and_b32 v6, 0xffff0000, v220
    v_fmac_f32 v75, v6, v13
    v_lshlrev_b32 v6, 16, v221
    v_fmac_f32 v83, v6, v14
    v_and_b32 v6, 0xffff0000, v221
    v_fmac_f32 v91, v6, v15
    v_lshlrev_b32 v6, 16, v222
    v_fmac_f32 v99, v6, v16
    v_and_b32 v6, 0xffff0000, v222
    v_fmac_f32 v107, v6, v17
    v_lshlrev_b32 v6, 16, v223
    v_fmac_f32 v115, v6, v18
    v_and_b32 v6, 0xffff0000, v223
    v_fmac_f32 v123, v6, v19
    v_cvt_pk_bf16_f32 v220, v67, v75
    v_cvt_pk_bf16_f32 v221, v83, v91
    v_cvt_pk_bf16_f32 v222, v99, v107
    v_cvt_pk_bf16_f32 v223, v115, v123
    s_add_u32 s23, s22, 6912
    buffer_store_dwordx4 v[220:223], v5, s[16:19], s23 offen
    v_lshlrev_b32 v6, 16, v224
    v_fmac_f32 v68, v6, v12
    v_and_b32 v6, 0xffff0000, v224
    v_fmac_f32 v76, v6, v13
    v_lshlrev_b32 v6, 16, v225
    v_fmac_f32 v84, v6, v14
    v_and_b32 v6, 0xffff0000, v225
    v_fmac_f32 v92, v6, v15
    v_lshlrev_b32 v6, 16, v226
    v_fmac_f32 v100, v6, v16
    v_and_b32 v6, 0xffff0000, v226
    v_fmac_f32 v108, v6, v17
    v_lshlrev_b32 v6, 16, v227
    v_fmac_f32 v116, v6, v18
    v_and_b32 v6, 0xffff0000, v227
    v_fmac_f32 v124, v6, v19
    v_cvt_pk_bf16_f32 v224, v68, v76
    v_cvt_pk_bf16_f32 v225, v84, v92
    v_cvt_pk_bf16_f32 v226, v100, v108
    v_cvt_pk_bf16_f32 v227, v116, v124
    s_add_u32 s23, s22, 9216
    buffer_store_dwordx4 v[224:227], v5, s[16:19], s23 offen
    v_lshlrev_b32 v6, 16, v228
    v_fmac_f32 v69, v6, v12
    v_and_b32 v6, 0xffff0000, v228
    v_fmac_f32 v77, v6, v13
    v_lshlrev_b32 v6, 16, v229
    v_fmac_f32 v85, v6, v14
    v_and_b32 v6, 0xffff0000, v229
    v_fmac_f32 v93, v6, v15
    v_lshlrev_b32 v6, 16, v230
    v_fmac_f32 v101, v6, v16
    v_and_b32 v6, 0xffff0000, v230
    v_fmac_f32 v109, v6, v17
    v_lshlrev_b32 v6, 16, v231
    v_fmac_f32 v117, v6, v18
    v_and_b32 v6, 0xffff0000, v231
    v_fmac_f32 v125, v6, v19
    v_cvt_pk_bf16_f32 v228, v69, v77
    v_cvt_pk_bf16_f32 v229, v85, v93
    v_cvt_pk_bf16_f32 v230, v101, v109
    v_cvt_pk_bf16_f32 v231, v117, v125
    s_add_u32 s23, s22, 11520
    buffer_store_dwordx4 v[228:231], v5, s[16:19], s23 offen
    v_lshlrev_b32 v6, 16, v232
    v_fmac_f32 v70, v6, v12
    v_and_b32 v6, 0xffff0000, v232
    v_fmac_f32 v78, v6, v13
    v_lshlrev_b32 v6, 16, v233
    v_fmac_f32 v86, v6, v14
    v_and_b32 v6, 0xffff0000, v233
    v_fmac_f32 v94, v6, v15
    v_lshlrev_b32 v6, 16, v234
    v_fmac_f32 v102, v6, v16
    v_and_b32 v6, 0xffff0000, v234
    v_fmac_f32 v110, v6, v17
    v_lshlrev_b32 v6, 16, v235
    v_fmac_f32 v118, v6, v18
    v_and_b32 v6, 0xffff0000, v235
    v_fmac_f32 v126, v6, v19
    v_cvt_pk_bf16_f32 v232, v70, v78
    v_cvt_pk_bf16_f32 v233, v86, v94
    v_cvt_pk_bf16_f32 v234, v102, v110
    v_cvt_pk_bf16_f32 v235, v118, v126
    s_add_u32 s23, s22, 13824
    buffer_store_dwordx4 v[232:235], v5, s[16:19], s23 offen
    v_lshlrev_b32 v6, 16, v236
    v_fmac_f32 v71, v6, v12
    v_and_b32 v6, 0xffff0000, v236
    v_fmac_f32 v79, v6, v13
    v_lshlrev_b32 v6, 16, v237
    v_fmac_f32 v87, v6, v14
    v_and_b32 v6, 0xffff0000, v237
    v_fmac_f32 v95, v6, v15
    v_lshlrev_b32 v6, 16, v238
    v_fmac_f32 v103, v6, v16
    v_and_b32 v6, 0xffff0000, v238
    v_fmac_f32 v111, v6, v17
    v_lshlrev_b32 v6, 16, v239
    v_fmac_f32 v119, v6, v18
    v_and_b32 v6, 0xffff0000, v239
    v_fmac_f32 v127, v6, v19
    v_cvt_pk_bf16_f32 v236, v71, v79
    v_cvt_pk_bf16_f32 v237, v87, v95
    v_cvt_pk_bf16_f32 v238, v103, v111
    v_cvt_pk_bf16_f32 v239, v119, v127
    s_add_u32 s23, s22, 16128
    buffer_store_dwordx4 v[236:239], v5, s[16:19], s23 offen
    s_branch L_ssm_next
L_ssm_done:
    s_cmp_lt_u32 s93, 100
    s_cbranch_scc1 L_exit
    s_mov_b32 s8, s76
    s_mov_b32 s9, s77
    s_mov_b32 s10, 4718592
    s_mov_b32 s11, 0x20000
    s_cmp_le_u32 s45, 1
    s_cbranch_scc1 L_att_next
    s_branch L_op_nextcb
L_wf_next:
    s_mov_b32 s37, 20
    v_mov_b32 v250, 1
    v_mov_b32 v251, 163832
    v_cmp_eq_u32 vcc, 0, v0
    s_nop 0
    s_and_saveexec_b64 s[38:39], vcc
    s_cbranch_execz tk13
    buffer_atomic_add v250, off, s[84:87], s37 sc0
    s_waitcnt vmcnt(0)
    ds_write_b32 v251, v250
    s_waitcnt lgkmcnt(0)
tk13:
    s_mov_b64 exec, -1
    s_barrier
    ds_read_b32 v252, v251
    s_waitcnt lgkmcnt(0)
    v_readfirstlane_b32 s33, v252
    s_barrier
    s_nop 3
    s_cmp_ge_u32 s33, 160
    s_cbranch_scc1 L_ssm_next
    s_lshl_b32 s16, s33, 2
    s_add_u32 s16, s16, s32
    s_add_u32 s16, s16, 1504
    s_call_b64 s[46:47], L_xform
    s_cmp_lg_u32 s95, 0
    s_cbranch_scc1 L_wfn
    s_mov_b32 s88, 4194304
gn14:
    buffer_load_dword v250, off, s[84:87], 0 offset:216 sc1
    s_waitcnt vmcnt(0)
    v_readfirstlane_b32 s95, v250
    s_sub_u32 s88, s88, 1
    s_cbranch_scc1 gn14x
    s_cmp_eq_u32 s95, 0
    s_cbranch_scc1 gn14
gn14x:
L_wfn:
    s_lshl_b32 s40, s33, 2
    s_add_u32 s40, s40, 125841408
    s_waitcnt vmcnt(0)
    s_barrier
    v_mov_b32 v250, s95
    v_cmp_eq_u32 vcc, 0, v0
    s_nop 0
    s_and_saveexec_b64 s[38:39], vcc
    s_cbranch_execz fs15
    buffer_store_dword v250, off, s[4:7], s40 sc1
fs15:
    s_mov_b64 exec, -1
    s_branch L_wf_next
L_phase2:
    s_mov_b32 s40, 524288
mc2_w:
    buffer_load_dword v250, off, s[84:87], 0 offset:28 sc1
    s_waitcnt vmcnt(0)
    v_readfirstlane_b32 s41, v250
    s_nop 0
    s_cmp_lg_u32 s41, 0
    s_cbranch_scc1 mc2_known
    s_sub_u32 s40, s40, 1
    s_cbranch_scc1 mc2_force
    s_sleep 2
    s_branch mc2_w
mc2_force:
    v_mov_b32 v250, 2
    v_mov_b32 v251, 0
    s_mov_b64 exec, 1
    buffer_atomic_cmpswap v[250:251], off, s[84:87], 0 offset:28
    s_mov_b64 exec, -1
    s_waitcnt vmcnt(0)
    s_mov_b32 s40, 524288
    s_branch mc2_w
mc2_known:
    s_cmp_eq_u32 s41, 1
    s_cbranch_scc1 L_phase2b
    s_mov_b32 s37, 208
    v_mov_b32 v250, 1
    v_mov_b32 v251, 163832
    v_cmp_eq_u32 vcc, 0, v0
    s_nop 0
    s_and_saveexec_b64 s[38:39], vcc
    s_cbranch_execz tk16
    buffer_atomic_add v250, off, s[84:87], s37 sc0
    s_waitcnt vmcnt(0)
    ds_write_b32 v251, v250
    s_waitcnt lgkmcnt(0)
tk16:
    s_mov_b64 exec, -1
    s_barrier
    ds_read_b32 v252, v251
    s_waitcnt lgkmcnt(0)
    v_readfirstlane_b32 s12, v252
    s_barrier
    s_nop 3
    s_cmp_lt_u32 s12, 32
    s_cbranch_scc1 L_chain_safe
    s_sub_u32 s45, s12, 32
L_phase2b:
    s_mov_b32 s8, s76
    s_mov_b32 s9, s77
    s_mov_b32 s10, 4718592
    s_mov_b32 s11, 0x20000
    s_and_b32 s36, s45, 15
    s_bitcmp1_b32 42315, s36
    s_cbranch_scc0 L_nots
    s_cmp_eq_u32 s93, 500
    s_cbranch_scc1 L_ssm_next
    s_branch L_wf_next
L_nots:
    s_bitcmp1_b32 18576, s36
    s_cbranch_scc0 L_att_next
    s_bfm_b32 s37, s36, 0
    s_and_b32 s37, s37, 18576
    s_bcnt1_i32_b32 s37, s37
    s_lshr_b32 s40, s45, 4
    s_mul_i32 s40, s40, 4
    s_add_u32 s33, s40, s37
L_op_mod:
    s_mul_hi_u32 s41, s33, 0x0e38e38f
    s_mul_i32 s41, s41, 18
    s_sub_u32 s33, s33, s41
    s_branch L_op_start
L_att_next:
    s_mov_b32 s37, 16
    v_mov_b32 v250, 1
    v_mov_b32 v251, 163832
    v_cmp_eq_u32 vcc, 0, v0
    s_nop 0
    s_and_saveexec_b64 s[38:39], vcc
    s_cbranch_execz tk17
    buffer_atomic_add v250, off, s[84:87], s37 sc0
    s_waitcnt vmcnt(0)
    ds_write_b32 v251, v250
    s_waitcnt lgkmcnt(0)
tk17:
    s_mov_b64 exec, -1
    s_barrier
    ds_read_b32 v252, v251
    s_waitcnt lgkmcnt(0)
    v_readfirstlane_b32 s34, v252
    s_barrier
    s_nop 3
    s_cmp_ge_u32 s34, 512
    s_cbranch_scc1 L_op_nextcb
    s_lshr_b32 s16, s34, 3
    s_and_b32 s17, s34, 7
    s_lshl_b32 s17, s17, 2
    s_add_u32 s17, s17, s32
    s_lshr_b32 s36, s17, 1
    s_lshl_b32 s36, s36, 11
    s_add_u32 s36, s36, 126091264
    s_lshr_b32 s41, s16, 2
    s_add_u32 s41, s41, s95
    s_add_u32 s41, s41, 1
    v_and_b32 v1, 3, v0
    v_min_u32 v1, 2, v1
    v_lshlrev_b32 v2, 9, v1
    s_and_b32 s37, s16, 3
    s_lshl_b32 s37, s37, 7
    v_add_u32 v2, s37, v2
    s_mov_b32 s40, 4194304
L_aw1:
    buffer_load_dword v3, v2, s[4:7], s36 offen sc1
    s_sub_u32 s40, s40, 1
    s_cbranch_scc1 L_aw1_go
    s_waitcnt vmcnt(0)
    v_subrev_u32 v3, s41, v3
    v_cmp_lt_u32 vcc, 64, v3
    s_cbranch_vccz L_aw1_go
    s_sleep 4
    s_branch L_aw1
L_aw1_go:
    v_and_b32 v5, 63, v0
    v_lshlrev_b32 v1, 4, v5
    s_cmp_ge_u32 s16, 56
    s_cselect_b32 s18, -1, 511
    v_and_b32 v2, s18, v1
    v_or_b32 v3, 128, v1
    v_lshrrev_b32 v4, 4, v5
    v_bfe_u32 v6, v5, 2, 2
    v_sub_u32 v4, v6, v4
    v_lshlrev_b32 v4, 3, v4
    v_and_b32 v6, 3, v5
    v_add_u32 v4, v4, v6
    v_mov_b32 v6, 0xf149f2ca
    s_mov_b32 s22, 0x3e0293ee
    s_lshl_b32 s18, s16, 5
    s_add_u32 s18, s18, s17
    s_lshl_b32 s19, s18, 13
    s_add_u32 s20, s19, 33554432
    buffer_load_dwordx4 v[8:11], v1, s[4:7], s20 offen offset:0 sc1
    s_add_u32 s20, s19, 33554432
    buffer_load_dwordx4 v[12:15], v1, s[4:7], s20 offen offset:1024 sc1
    s_add_u32 s20, s19, 33554432
    buffer_load_dwordx4 v[16:19], v1, s[4:7], s20 offen offset:2048 sc1
    s_add_u32 s20, s19, 33554432
    buffer_load_dwordx4 v[20:23], v1, s[4:7], s20 offen offset:3072 sc1
    s_add_u32 s20, s19, 33558528
    buffer_load_dwordx4 v[24:27], v1, s[4:7], s20 offen offset:0 sc1
    s_add_u32 s20, s19, 33558528
    buffer_load_dwordx4 v[28:31], v1, s[4:7], s20 offen offset:1024 sc1
    s_add_u32 s20, s19, 33558528
    buffer_load_dwordx4 v[32:35], v1, s[4:7], s20 offen offset:2048 sc1
    s_add_u32 s20, s19, 33558528
    buffer_load_dwordx4 v[36:39], v1, s[4:7], s20 offen offset:3072 sc1
    s_lshl_b32 s21, s18, 14
    s_add_u32 s20, s21, 0
    buffer_load_dwordx4 v[40:43], v1, s[4:7], s20 offen offset:0 sc1
    s_add_u32 s20, s21, 4096
    buffer_load_dwordx4 v[44:47], v1, s[4:7], s20 offen offset:0 sc1
    s_add_u32 s20, s21, 8192
    buffer_load_dwordx4 v[48:51], v1, s[4:7], s20 offen offset:0 sc1
    s_add_u32 s20, s21, 12288
    buffer_load_dwordx4 v[52:55], v1, s[4:7], s20 offen offset:0 sc1
    s_add_u32 s20, s21, 0
    buffer_load_dwordx4 v[56:59], v1, s[4:7], s20 offen offset:1024 sc1
    s_add_u32 s20, s21, 4096
    buffer_load_dwordx4 v[60:63], v1, s[4:7], s20 offen offset:1024 sc1
    s_add_u32 s20, s21, 8192
    buffer_load_dwordx4 v[64:67], v1, s[4:7], s20 offen offset:1024 sc1
    s_add_u32 s20, s21, 12288
    buffer_load_dwordx4 v[68:71], v1, s[4:7], s20 offen offset:1024 sc1
    s_add_u32 s20, s21, 0
    buffer_load_dwordx4 v[88:91], v1, s[4:7], s20 offen offset:2048 sc1
    s_add_u32 s20, s21, 4096
    buffer_load_dwordx4 v[92:95], v1, s[4:7], s20 offen offset:2048 sc1
    s_add_u32 s20, s21, 8192
    buffer_load_dwordx4 v[96:99], v1, s[4:7], s20 offen offset:2048 sc1
    s_add_u32 s20, s21, 12288
    buffer_load_dwordx4 v[100:103], v1, s[4:7], s20 offen offset:2048 sc1
    s_add_u32 s20, s21, 0
    buffer_load_dwordx4 v[104:107], v1, s[4:7], s20 offen offset:3072 sc1
    s_add_u32 s20, s21, 4096
    buffer_load_dwordx4 v[108:111], v1, s[4:7], s20 offen offset:3072 sc1
    s_add_u32 s20, s21, 8192
    buffer_load_dwordx4 v[112:115], v1, s[4:7], s20 offen offset:3072 sc1
    s_add_u32 s20, s21, 12288
    buffer_load_dwordx4 v[116:119], v1, s[4:7], s20 offen offset:3072 sc1
    v_mov_b32 v172, 0x3f803f80
    v_mov_b32 v173, 0x3f803f80
    v_mov_b32 v174, 0x3f803f80
    v_mov_b32 v175, 0x3f803f80
    v_mov_b32 v176, 0x3f003f00
    v_mov_b32 v177, 0x3f003f00
    s_waitcnt vmcnt(8)
    v_mfma_f32_16x16x32_bf16 v[136:139], v[40:43], v[8:11], 0
    v_mfma_f32_16x16x32_bf16 v[140:143], v[56:59], v[8:11], 0
    v_mfma_f32_16x16x32_bf16 v[148:151], v[40:43], v[24:27], 0
    v_mfma_f32_16x16x32_bf16 v[152:155], v[56:59], v[24:27], 0
    v_mfma_f32_16x16x32_bf16 v[136:139], v[44:47], v[12:15], v[136:139]
    v_mfma_f32_16x16x32_bf16 v[140:143], v[60:63], v[12:15], v[140:143]
    v_mfma_f32_16x16x32_bf16 v[148:151], v[44:47], v[28:31], v[148:151]
    v_mfma_f32_16x16x32_bf16 v[152:155], v[60:63], v[28:31], v[152:155]
    v_mfma_f32_16x16x32_bf16 v[136:139], v[48:51], v[16:19], v[136:139]
    v_mfma_f32_16x16x32_bf16 v[140:143], v[64:67], v[16:19], v[140:143]
    v_mfma_f32_16x16x32_bf16 v[148:151], v[48:51], v[32:35], v[148:151]
    v_mfma_f32_16x16x32_bf16 v[152:155], v[64:67], v[32:35], v[152:155]
    v_mfma_f32_16x16x32_bf16 v[136:139], v[52:55], v[20:23], v[136:139]
    v_mfma_f32_16x16x32_bf16 v[140:143], v[68:71], v[20:23], v[140:143]
    v_mfma_f32_16x16x32_bf16 v[148:151], v[52:55], v[36:39], v[148:151]
    v_mfma_f32_16x16x32_bf16 v[152:155], v[68:71], v[36:39], v[152:155]
    v_cmp_le_i32 vcc, 0, v4
    s_nop 3
    v_cndmask_b32 v136, v6, v136, vcc
    v_cmp_le_i32 vcc, 1, v4
    s_nop 1
    v_cndmask_b32 v137, v6, v137, vcc
    v_cmp_le_i32 vcc, 2, v4
    s_nop 1
    v_cndmask_b32 v138, v6, v138, vcc
    v_cmp_le_i32 vcc, 3, v4
    s_nop 1
    v_cndmask_b32 v139, v6, v139, vcc
    v_cmp_le_i32 vcc, 4, v4
    s_nop 1
    v_cndmask_b32 v140, v6, v140, vcc
    v_cmp_le_i32 vcc, 5, v4
    s_nop 1
    v_cndmask_b32 v141, v6, v141, vcc
    v_cmp_le_i32 vcc, 6, v4
    s_nop 1
    v_cndmask_b32 v142, v6, v142, vcc
    v_cmp_le_i32 vcc, 7, v4
    s_nop 1
    v_cndmask_b32 v143, v6, v143, vcc
    v_cmp_le_i32 vcc, -4, v4
    s_nop 1
    v_cndmask_b32 v148, v6, v148, vcc
    v_cmp_le_i32 vcc, -3, v4
    s_nop 1
    v_cndmask_b32 v149, v6, v149, vcc
    v_cmp_le_i32 vcc, -2, v4
    s_nop 1
    v_cndmask_b32 v150, v6, v150, vcc
    v_cmp_le_i32 vcc, -1, v4
    s_nop 1
    v_cndmask_b32 v151, v6, v151, vcc
    v_cmp_le_i32 vcc, 0, v4
    s_nop 1
    v_cndmask_b32 v152, v6, v152, vcc
    v_cmp_le_i32 vcc, 1, v4
    s_nop 1
    v_cndmask_b32 v153, v6, v153, vcc
    v_cmp_le_i32 vcc, 2, v4
    s_nop 1
    v_cndmask_b32 v154, v6, v154, vcc
    v_cmp_le_i32 vcc, 3, v4
    s_nop 1
    v_cndmask_b32 v155, v6, v155, vcc
    s_nop 1
    v_and_b32 v198, 1, v0
    v_lshlrev_b32 v198, 7, v198
    v_add_u32 v198, 1536, v198
    s_add_u32 s41, s16, s95
    s_add_u32 s41, s41, 1
    s_cmp_lt_u32 s16, 56
    s_cbranch_scc1 L_amk
    s_lshl_b32 s36, s17, 7
    s_add_u32 s36, s36, 125845504
    v_mov_b32 v198, 0
    s_sub_u32 s41, s41, 1
    s_mov_b32 s44, 8
L_amk:
    s_sub_u32 s43, s41, s95
    s_sub_u32 s43, s43, 1
    s_mov_b32 s88, 65536
    s_mov_b32 s89, 125853696
cw18:
    buffer_load_dword v199, off, s[4:7], s89 sc1
    s_waitcnt vmcnt(0)
    v_readfirstlane_b32 s42, v199
    s_nop 0
    s_sub_u32 s42, s42, s95
    s_cmp_gt_u32 s42, 64
    s_cselect_b32 s42, 0, s42
    s_add_u32 s42, s42, 1
    s_cmp_ge_u32 s42, s43
    s_cbranch_scc1 cw18x
    s_sub_u32 s88, s88, 1
    s_cbranch_scc1 cw18x
    s_sub_u32 s42, s43, s42
    s_min_u32 s42, s42, 6
cw18s:
    s_sleep 24
    s_sub_u32 s42, s42, 1
    s_cmp_lg_u32 s42, 0
    s_cbranch_scc1 cw18s
    s_branch cw18
cw18x:
    s_mov_b32 s40, 4194304
L_aw2:
    buffer_load_dword v199, v198, s[4:7], s36 offen sc1
    s_sub_u32 s40, s40, 1
    s_cbranch_scc1 L_aw2_go
    s_waitcnt vmcnt(0)
    v_subrev_u32 v199, s41, v199
    v_cmp_lt_u32 vcc, 64, v199
    s_cbranch_vccz L_aw2_go
    s_sleep 1
    s_branch L_aw2
L_aw2_go:
at_ldm:
    s_lshl_b32 s20, s18, 12
    s_add_u32 s20, s20, 69206016
    buffer_load_dwordx4 v[72:75], v3, s[4:7], s20 offen offset:0 sc1
    buffer_load_dwordx4 v[76:79], v3, s[4:7], s20 offen offset:1024 sc1
    buffer_load_dwordx4 v[80:83], v3, s[4:7], s20 offen offset:2048 sc1
    buffer_load_dwordx4 v[84:87], v3, s[4:7], s20 offen offset:3072 sc1
    s_lshl_b32 s20, s18, 12
    s_add_u32 s20, s20, 77594624
    buffer_load_dwordx4 v[120:123], v2, s[4:7], s20 offen offset:0 sc1
    buffer_load_dwordx4 v[124:127], v2, s[4:7], s20 offen offset:1024 sc1
    buffer_load_dwordx4 v[128:131], v2, s[4:7], s20 offen offset:2048 sc1
    buffer_load_dwordx4 v[132:135], v2, s[4:7], s20 offen offset:3072 sc1
    s_cmp_lt_u32 s16, 56
    s_cbranch_scc1 at_ok
    s_waitcnt vmcnt(0)
    v_max_u32 v196, v72, v73
    v_max3_u32 v196, v196, v74, v75
    v_max3_u32 v196, v196, v76, v77
    v_max3_u32 v196, v196, v78, v79
    v_max3_u32 v196, v196, v80, v81
    v_max3_u32 v196, v196, v82, v83
    v_max3_u32 v196, v196, v84, v85
    v_max3_u32 v196, v196, v86, v87
    v_max3_u32 v196, v196, v120, v121
    v_max3_u32 v196, v196, v122, v123
    v_max3_u32 v196, v196, v124, v125
    v_max3_u32 v196, v196, v126, v127
    v_max3_u32 v196, v196, v128, v129
    v_max3_u32 v196, v196, v130, v131
    v_max3_u32 v196, v196, v132, v133
    v_max3_u32 v196, v196, v134, v135
    v_cmp_eq_u32 vcc, -1, v196
    s_cbranch_vccz at_ok
    s_sub_u32 s44, s44, 1
    s_cbranch_scc1 at_ok
    s_cmp_lg_u32 s44, 0
    s_cbranch_scc1 at_ldm
    s_add_u32 s41, s41, 1
    s_mov_b32 s40, 4194304
L_aw3:
    buffer_load_dword v199, v198, s[4:7], s36 offen sc1
    s_sub_u32 s40, s40, 1
    s_cbranch_scc1 L_aw3_go
    s_waitcnt vmcnt(0)
    v_subrev_u32 v199, s41, v199
    v_cmp_lt_u32 vcc, 64, v199
    s_cbranch_vccz L_aw3_go
    s_sleep 1
    s_branch L_aw3
L_aw3_go:
    s_branch at_ldm
at_ok:
    s_waitcnt vmcnt(4)
    v_mfma_f32_16x16x32_bf16 v[144:147], v[72:75], v[8:11], 0
    v_mfma_f32_16x16x32_bf16 v[156:159], v[72:75], v[24:27], 0
    v_mfma_f32_16x16x32_bf16 v[144:147], v[76:79], v[12:15], v[144:147]
    v_mfma_f32_16x16x32_bf16 v[156:159], v[76:79], v[28:31], v[156:159]
    v_mfma_f32_16x16x32_bf16 v[144:147], v[80:83], v[16:19], v[144:147]
    v_mfma_f32_16x16x32_bf16 v[156:159], v[80:83], v[32:35], v[156:159]
    v_mfma_f32_16x16x32_bf16 v[144:147], v[84:87], v[20:23], v[144:147]
    v_mfma_f32_16x16x32_bf16 v[156:159], v[84:87], v[36:39], v[156:159]
    v_max3_f32 v196, v136, v137, v138
    v_max3_f32 v197, v139, v140, v141
    v_max3_f32 v196, v196, v142, v143
    s_nop 3
    v_max3_f32 v197, v197, v144, v145
    v_max3_f32 v196, v196, v146, v147
    v_max_f32 v196, v196, v197
    v_mov_b32 v197, v196
    s_nop 1
    v_permlane32_swap_b32 v196, v197
    v_max_f32 v196, v196, v197
    v_mov_b32 v197, v196
    s_nop 1
    v_permlane16_swap_b32 v196, v197
    v_max_f32 v196, v196, v197
    v_mul_f32 v196, s22, v196
    v_pk_fma_f32 v[136:137], v[136:137], s[22:23], v[196:197] op_sel_hi:[1,0,0] neg_lo:[0,0,1] neg_hi:[0,0,1]
    v_pk_fma_f32 v[138:139], v[138:139], s[22:23], v[196:197] op_sel_hi:[1,0,0] neg_lo:[0,0,1] neg_hi:[0,0,1]
    v_pk_fma_f32 v[140:141], v[140:141], s[22:23], v[196:197] op_sel_hi:[1,0,0] neg_lo:[0,0,1] neg_hi:[0,0,1]
    v_pk_fma_f32 v[142:143], v[142:143], s[22:23], v[196:197] op_sel_hi:[1,0,0] neg_lo:[0,0,1] neg_hi:[0,0,1]
    v_pk_fma_f32 v[144:145], v[144:145], s[22:23], v[196:197] op_sel_hi:[1,0,0] neg_lo:[0,0,1] neg_hi:[0,0,1]
    v_pk_fma_f32 v[146:147], v[146:147], s[22:23], v[196:197] op_sel_hi:[1,0,0] neg_lo:[0,0,1] neg_hi:[0,0,1]
    v_exp_f32 v136, v136
    v_exp_f32 v137, v137
    v_exp_f32 v138, v138
    v_exp_f32 v139, v139
    v_exp_f32 v140, v140
    v_exp_f32 v141, v141
    v_exp_f32 v142, v142
    v_exp_f32 v143, v143
    v_exp_f32 v144, v144
    v_exp_f32 v145, v145
    v_exp_f32 v146, v146
    v_exp_f32 v147, v147
    v_cvt_pk_bf16_f32 v160, v136, v137
    v_cvt_pk_bf16_f32 v161, v138, v139
    v_cvt_pk_bf16_f32 v162, v140, v141
    v_cvt_pk_bf16_f32 v163, v142, v143
    v_cvt_pk_bf16_f32 v164, v144, v145
    v_cvt_pk_bf16_f32 v165, v146, v147
    v_max3_f32 v196, v148, v149, v150
    v_max3_f32 v197, v151, v152, v153
    v_max3_f32 v196, v196, v154, v155
    v_max3_f32 v197, v197, v156, v157
    v_max3_f32 v196, v196, v158, v159
    v_max_f32 v196, v196, v197
    v_mov_b32 v197, v196
    s_nop 1
    v_permlane32_swap_b32 v196, v197
    v_max_f32 v196, v196, v197
    v_mov_b32 v197, v196
    s_nop 1
    v_permlane16_swap_b32 v196, v197
    v_max_f32 v196, v196, v197
    v_mul_f32 v196, s22, v196
    v_pk_fma_f32 v[148:149], v[148:149], s[22:23], v[196:197] op_sel_hi:[1,0,0] neg_lo:[0,0,1] neg_hi:[0,0,1]
    v_pk_fma_f32 v[150:151], v[150:151], s[22:23], v[196:197] op_sel_hi:[1,0,0] neg_lo:[0,0,1] neg_hi:[0,0,1]
    v_pk_fma_f32 v[152:153], v[152:153], s[22:23], v[196:197] op_sel_hi:[1,0,0] neg_lo:[0,0,1] neg_hi:[0,0,1]
    v_pk_fma_f32 v[154:155], v[154:155], s[22:23], v[196:197] op_sel_hi:[1,0,0] neg_lo:[0,0,1] neg_hi:[0,0,1]
    v_pk_fma_f32 v[156:157], v[156:157], s[22:23], v[196:197] op_sel_hi:[1,0,0] neg_lo:[0,0,1] neg_hi:[0,0,1]
    v_pk_fma_f32 v[158:159], v[158:159], s[22:23], v[196:197] op_sel_hi:[1,0,0] neg_lo:[0,0,1] neg_hi:[0,0,1]
    v_exp_f32 v148, v148
    v_exp_f32 v149, v149
    v_exp_f32 v150, v150
    v_exp_f32 v151, v151
    v_exp_f32 v152, v152
    v_exp_f32 v153, v153
    v_exp_f32 v154, v154
    v_exp_f32 v155, v155
    v_exp_f32 v156, v156
    v_exp_f32 v157, v157
    v_exp_f32 v158, v158
    v_exp_f32 v159, v159
    v_cvt_pk_bf16_f32 v166, v148, v149
    v_cvt_pk_bf16_f32 v167, v150, v151
    v_cvt_pk_bf16_f32 v168, v152, v153
    v_cvt_pk_bf16_f32 v169, v154, v155
    v_cvt_pk_bf16_f32 v170, v156, v157
    v_cvt_pk_bf16_f32 v171, v158, v159
    v_mfma_f32_16x16x32_bf16 v[180:183], v[172:175], v[160:163], 0
    v_mfma_f32_16x16x32_bf16 v[184:187], v[172:175], v[166:169], 0
    s_nop 4
    v_mfma_f32_16x16x16_bf16 v[180:183], v[176:177], v[164:165], v[180:183]
    v_mfma_f32_16x16x16_bf16 v[184:187], v[176:177], v[170:171], v[184:187]
    s_nop 6
    v_rcp_f32 v180, v180
    v_rcp_f32 v184, v184
    s_waitcnt vmcnt(0)
    s_lshl_b32 s18, s16, 18
    s_lshl_b32 s19, s17, 12
    s_add_u32 s18, s18, s19
    s_add_u32 s18, s18, 50331648
    s_add_u32 s19, s18, 131072
    v_mfma_f32_16x16x32_bf16 v[8:11], v[88:91], v[160:163], 0
    v_mfma_f32_16x16x32_bf16 v[12:15], v[104:107], v[160:163], 0
    v_mfma_f32_16x16x32_bf16 v[16:19], v[88:91], v[166:169], 0
    v_mfma_f32_16x16x32_bf16 v[20:23], v[104:107], v[166:169], 0
    v_mfma_f32_16x16x32_bf16 v[24:27], v[92:95], v[160:163], 0
    v_mfma_f32_16x16x32_bf16 v[28:31], v[108:111], v[160:163], 0
    v_mfma_f32_16x16x32_bf16 v[32:35], v[92:95], v[166:169], 0
    v_mfma_f32_16x16x32_bf16 v[36:39], v[108:111], v[166:169], 0
    v_mfma_f32_16x16x32_bf16 v[40:43], v[96:99], v[160:163], 0
    v_mfma_f32_16x16x32_bf16 v[44:47], v[112:115], v[160:163], 0
    v_mfma_f32_16x16x32_bf16 v[48:51], v[96:99], v[166:169], 0
    v_mfma_f32_16x16x32_bf16 v[52:55], v[112:115], v[166:169], 0
    v_mfma_f32_16x16x32_bf16 v[56:59], v[100:103], v[160:163], 0
    v_mfma_f32_16x16x32_bf16 v[60:63], v[116:119], v[160:163], 0
    v_mfma_f32_16x16x32_bf16 v[64:67], v[100:103], v[166:169], 0
    v_mfma_f32_16x16x32_bf16 v[68:71], v[116:119], v[166:169], 0
    v_mfma_f32_16x16x16_bf16 v[8:11], v[120:121], v[164:165], v[8:11]
    v_mfma_f32_16x16x16_bf16 v[12:15], v[122:123], v[164:165], v[12:15]
    v_mfma_f32_16x16x16_bf16 v[16:19], v[120:121], v[170:171], v[16:19]
    v_mfma_f32_16x16x16_bf16 v[20:23], v[122:123], v[170:171], v[20:23]
    v_mfma_f32_16x16x16_bf16 v[24:27], v[124:125], v[164:165], v[24:27]
    v_mfma_f32_16x16x16_bf16 v[28:31], v[126:127], v[164:165], v[28:31]
    v_mfma_f32_16x16x16_bf16 v[32:35], v[124:125], v[170:171], v[32:35]
    v_mfma_f32_16x16x16_bf16 v[36:39], v[126:127], v[170:171], v[36:39]
    v_mfma_f32_16x16x16_bf16 v[40:43], v[128:129], v[164:165], v[40:43]
    v_mfma_f32_16x16x16_bf16 v[44:47], v[130:131], v[164:165], v[44:47]
    v_mfma_f32_16x16x16_bf16 v[48:51], v[128:129], v[170:171], v[48:51]
    v_mfma_f32_16x16x16_bf16 v[52:55], v[130:131], v[170:171], v[52:55]
    v_mfma_f32_16x16x16_bf16 v[56:59], v[132:133], v[164:165], v[56:59]
    v_mfma_f32_16x16x16_bf16 v[60:63], v[134:135], v[164:165], v[60:63]
    v_mfma_f32_16x16x16_bf16 v[64:67], v[132:133], v[170:171], v[64:67]
    v_mfma_f32_16x16x16_bf16 v[68:71], v[134:135], v[170:171], v[68:71]
    v_pk_mul_f32 v[8:9], v[8:9], v[180:181] op_sel_hi:[1,0]
    v_pk_mul_f32 v[10:11], v[10:11], v[180:181] op_sel_hi:[1,0]
    v_pk_mul_f32 v[12:13], v[12:13], v[180:181] op_sel_hi:[1,0]
    v_pk_mul_f32 v[14:15], v[14:15], v[180:181] op_sel_hi:[1,0]
    v_cvt_pk_bf16_f32 v8, v8, v9
    v_cvt_pk_bf16_f32 v9, v10, v11
    v_cvt_pk_bf16_f32 v10, v12, v13
    v_cvt_pk_bf16_f32 v11, v14, v15
    buffer_store_dwordx4 v[8:11], v1, s[4:7], s18 offen offset:0 sc1
    v_pk_mul_f32 v[16:17], v[16:17], v[184:185] op_sel_hi:[1,0]
    v_pk_mul_f32 v[18:19], v[18:19], v[184:185] op_sel_hi:[1,0]
    v_pk_mul_f32 v[20:21], v[20:21], v[184:185] op_sel_hi:[1,0]
    v_pk_mul_f32 v[22:23], v[22:23], v[184:185] op_sel_hi:[1,0]
    v_cvt_pk_bf16_f32 v16, v16, v17
    v_cvt_pk_bf16_f32 v17, v18, v19
    v_cvt_pk_bf16_f32 v18, v20, v21
    v_cvt_pk_bf16_f32 v19, v22, v23
    buffer_store_dwordx4 v[16:19], v1, s[4:7], s19 offen offset:0 sc1
    v_pk_mul_f32 v[24:25], v[24:25], v[180:181] op_sel_hi:[1,0]
    v_pk_mul_f32 v[26:27], v[26:27], v[180:181] op_sel_hi:[1,0]
    v_pk_mul_f32 v[28:29], v[28:29], v[180:181] op_sel_hi:[1,0]
    v_pk_mul_f32 v[30:31], v[30:31], v[180:181] op_sel_hi:[1,0]
    v_cvt_pk_bf16_f32 v24, v24, v25
    v_cvt_pk_bf16_f32 v25, v26, v27
    v_cvt_pk_bf16_f32 v26, v28, v29
    v_cvt_pk_bf16_f32 v27, v30, v31
    buffer_store_dwordx4 v[24:27], v1, s[4:7], s18 offen offset:1024 sc1
    v_pk_mul_f32 v[32:33], v[32:33], v[184:185] op_sel_hi:[1,0]
    v_pk_mul_f32 v[34:35], v[34:35], v[184:185] op_sel_hi:[1,0]
    v_pk_mul_f32 v[36:37], v[36:37], v[184:185] op_sel_hi:[1,0]
    v_pk_mul_f32 v[38:39], v[38:39], v[184:185] op_sel_hi:[1,0]
    v_cvt_pk_bf16_f32 v32, v32, v33
    v_cvt_pk_bf16_f32 v33, v34, v35
    v_cvt_pk_bf16_f32 v34, v36, v37
    v_cvt_pk_bf16_f32 v35, v38, v39
    buffer_store_dwordx4 v[32:35], v1, s[4:7], s19 offen offset:1024 sc1
    v_pk_mul_f32 v[40:41], v[40:41], v[180:181] op_sel_hi:[1,0]
    v_pk_mul_f32 v[42:43], v[42:43], v[180:181] op_sel_hi:[1,0]
    v_pk_mul_f32 v[44:45], v[44:45], v[180:181] op_sel_hi:[1,0]
    v_pk_mul_f32 v[46:47], v[46:47], v[180:181] op_sel_hi:[1,0]
    v_cvt_pk_bf16_f32 v40, v40, v41
    v_cvt_pk_bf16_f32 v41, v42, v43
    v_cvt_pk_bf16_f32 v42, v44, v45
    v_cvt_pk_bf16_f32 v43, v46, v47
    buffer_store_dwordx4 v[40:43], v1, s[4:7], s18 offen offset:2048 sc1
    v_pk_mul_f32 v[48:49], v[48:49], v[184:185] op_sel_hi:[1,0]
    v_pk_mul_f32 v[50:51], v[50:51], v[184:185] op_sel_hi:[1,0]
    v_pk_mul_f32 v[52:53], v[52:53], v[184:185] op_sel_hi:[1,0]
    v_pk_mul_f32 v[54:55], v[54:55], v[184:185] op_sel_hi:[1,0]
    v_cvt_pk_bf16_f32 v48, v48, v49
    v_cvt_pk_bf16_f32 v49, v50, v51
    v_cvt_pk_bf16_f32 v50, v52, v53
    v_cvt_pk_bf16_f32 v51, v54, v55
    buffer_store_dwordx4 v[48:51], v1, s[4:7], s19 offen offset:2048 sc1
    v_pk_mul_f32 v[56:57], v[56:57], v[180:181] op_sel_hi:[1,0]
    v_pk_mul_f32 v[58:59], v[58:59], v[180:181] op_sel_hi:[1,0]
    v_pk_mul_f32 v[60:61], v[60:61], v[180:181] op_sel_hi:[1,0]
    v_pk_mul_f32 v[62:63], v[62:63], v[180:181] op_sel_hi:[1,0]
    v_cvt_pk_bf16_f32 v56, v56, v57
    v_cvt_pk_bf16_f32 v57, v58, v59
    v_cvt_pk_bf16_f32 v58, v60, v61
    v_cvt_pk_bf16_f32 v59, v62, v63
    buffer_store_dwordx4 v[56:59], v1, s[4:7], s18 offen offset:3072 sc1
    v_pk_mul_f32 v[64:65], v[64:65], v[184:185] op_sel_hi:[1,0]
    v_pk_mul_f32 v[66:67], v[66:67], v[184:185] op_sel_hi:[1,0]
    v_pk_mul_f32 v[68:69], v[68:69], v[184:185] op_sel_hi:[1,0]
    v_pk_mul_f32 v[70:71], v[70:71], v[184:185] op_sel_hi:[1,0]
    v_cvt_pk_bf16_f32 v64, v64, v65
    v_cvt_pk_bf16_f32 v65, v66, v67
    v_cvt_pk_bf16_f32 v66, v68, v69
    v_cvt_pk_bf16_f32 v67, v70, v71
    buffer_store_dwordx4 v[64:67], v1, s[4:7], s19 offen offset:3072 sc1
    s_lshr_b32 s40, s34, 1
    s_lshl_b32 s40, s40, 7
    s_and_b32 s41, s34, 1
    s_lshl_b32 s41, s41, 2
    s_add_u32 s40, s40, s41
    s_add_u32 s40, s40, 125894656
    s_cmp_lt_u32 s16, 62
    s_cbranch_scc1 L_noef
    s_lshr_b32 s42, s34, 1
    s_mul_i32 s42, s42, 4096
    s_add_u32 s41, s41, s42
    s_add_u32 s41, s41, 124944384
    s_barrier
    s_cmp_lg_u32 s32, 0
    s_cbranch_scc1 L_noef
    v_mov_b32 v250, s95
    v_lshlrev_b32 v251, 7, v0
    s_mov_b64 exec, 262143
    buffer_store_dword v250, v251, s[4:7], s41 offen sc1
    s_mov_b64 exec, -1
L_noef:
    s_waitcnt vmcnt(0)
    s_barrier
    v_mov_b32 v250, s95
    v_cmp_eq_u32 vcc, 0, v0
    s_nop 0
    s_and_saveexec_b64 s[38:39], vcc
    s_cbranch_execz fs19
    buffer_store_dword v250, off, s[4:7], s40 sc1
fs19:
    s_mov_b64 exec, -1
    s_branch L_att_next
L_op_start:
    s_lshl_b32 s35, s33, 2
    s_add_u32 s35, s35, 136
    s_lshr_b32 s89, s33, 2
    s_lshl_b32 s89, s89, 7
    s_add_u32 s89, s89, 125841408
    v_mbcnt_lo_u32_b32 v2, -1, 0
    v_mbcnt_hi_u32_b32 v2, -1, v2
    v_min_u32 v2, 31, v2
    v_lshlrev_b32 v2, 2, v2
    s_mov_b32 s88, 4194304
fw20:
    buffer_load_dword v3, v2, s[4:7], s89 offen offset:0 sc1
    s_sub_u32 s88, s88, 1
    s_cbranch_scc1 fw20x
    s_waitcnt vmcnt(0)
    v_cmp_ne_u32 vcc, s95, v3
    s_cbranch_vccz fw20x
    s_sleep 4
    s_branch fw20
fw20x:
    v_and_b32 v1, 63, v0
    v_lshlrev_b32 v1, 4, v1
    s_lshl_b32 s18, s33, 18
    s_lshl_b32 s19, s32, 16
    s_add_u32 s18, s18, s19
    s_add_u32 s18, s18, 130023424
    buffer_load_dwordx4 a[0:3], v1, s[4:7], s18 offen offset:0 sc1
    s_waitcnt vmcnt(6)
    buffer_load_dwordx4 a[4:7], v1, s[4:7], s18 offen offset:1024 sc1
    s_waitcnt vmcnt(6)
    buffer_load_dwordx4 a[8:11], v1, s[4:7], s18 offen offset:2048 sc1
    s_waitcnt vmcnt(6)
    buffer_load_dwordx4 a[12:15], v1, s[4:7], s18 offen offset:3072 sc1
    s_waitcnt vmcnt(6)
    s_add_u32 s18, s18, 4096
    buffer_load_dwordx4 a[16:19], v1, s[4:7], s18 offen offset:0 sc1
    s_waitcnt vmcnt(6)
    buffer_load_dwordx4 a[20:23], v1, s[4:7], s18 offen offset:1024 sc1
    s_waitcnt vmcnt(6)
    buffer_load_dwordx4 a[24:27], v1, s[4:7], s18 offen offset:2048 sc1
    s_waitcnt vmcnt(6)
    buffer_load_dwordx4 a[28:31], v1, s[4:7], s18 offen offset:3072 sc1
    s_waitcnt vmcnt(6)
    s_add_u32 s18, s18, 4096
    buffer_load_dwordx4 a[32:35], v1, s[4:7], s18 offen offset:0 sc1
    s_waitcnt vmcnt(6)
    buffer_load_dwordx4 a[36:39], v1, s[4:7], s18 offen offset:1024 sc1
    s_waitcnt vmcnt(6)
    buffer_load_dwordx4 a[40:43], v1, s[4:7], s18 offen offset:2048 sc1
    s_waitcnt vmcnt(6)
    buffer_load_dwordx4 a[44:47], v1, s[4:7], s18 offen offset:3072 sc1
    s_waitcnt vmcnt(6)
    s_add_u32 s18, s18, 4096
    buffer_load_dwordx4 a[48:51], v1, s[4:7], s18 offen offset:0 sc1
    s_waitcnt vmcnt(6)
    buffer_load_dwordx4 a[52:55], v1, s[4:7], s18 offen offset:1024 sc1
    s_waitcnt vmcnt(6)
    buffer_load_dwordx4 a[56:59], v1, s[4:7], s18 offen offset:2048 sc1
    s_waitcnt vmcnt(6)
    buffer_load_dwordx4 a[60:63], v1, s[4:7], s18 offen offset:3072 sc1
    s_waitcnt vmcnt(6)
    s_add_u32 s18, s18, 4096
    buffer_load_dwordx4 a[64:67], v1, s[4:7], s18 offen offset:0 sc1
    s_waitcnt vmcnt(6)
    buffer_load_dwordx4 a[68:71], v1, s[4:7], s18 offen offset:1024 sc1
    s_waitcnt vmcnt(6)
    buffer_load_dwordx4 a[72:75], v1, s[4:7], s18 offen offset:2048 sc1
    s_waitcnt vmcnt(6)
    buffer_load_dwordx4 a[76:79], v1, s[4:7], s18 offen offset:3072 sc1
    s_waitcnt vmcnt(6)
    s_add_u32 s18, s18, 4096
    buffer_load_dwordx4 a[80:83], v1, s[4:7], s18 offen offset:0 sc1
    s_waitcnt vmcnt(6)
    buffer_load_dwordx4 a[84:87], v1, s[4:7], s18 offen offset:1024 sc1
    s_waitcnt vmcnt(6)
    buffer_load_dwordx4 a[88:91], v1, s[4:7], s18 offen offset:2048 sc1
    s_waitcnt vmcnt(6)
    buffer_load_dwordx4 a[92:95], v1, s[4:7], s18 offen offset:3072 sc1
    s_waitcnt vmcnt(6)
    s_add_u32 s18, s18, 4096
    buffer_load_dwordx4 a[96:99], v1, s[4:7], s18 offen offset:0 sc1
    s_waitcnt vmcnt(6)
    buffer_load_dwordx4 a[100:103], v1, s[4:7], s18 offen offset:1024 sc1
    s_waitcnt vmcnt(6)
    buffer_load_dwordx4 a[104:107], v1, s[4:7], s18 offen offset:2048 sc1
    s_waitcnt vmcnt(6)
    buffer_load_dwordx4 a[108:111], v1, s[4:7], s18 offen offset:3072 sc1
    s_waitcnt vmcnt(6)
    s_add_u32 s18, s18, 4096
    buffer_load_dwordx4 a[112:115], v1, s[4:7], s18 offen offset:0 sc1
    s_waitcnt vmcnt(6)
    buffer_load_dwordx4 a[116:119], v1, s[4:7], s18 offen offset:1024 sc1
    s_waitcnt vmcnt(6)
    buffer_load_dwordx4 a[120:123], v1, s[4:7], s18 offen offset:2048 sc1
    s_waitcnt vmcnt(6)
    buffer_load_dwordx4 a[124:127], v1, s[4:7], s18 offen offset:3072 sc1
    s_waitcnt vmcnt(6)
    s_add_u32 s18, s18, 4096
    buffer_load_dwordx4 a[128:131], v1, s[4:7], s18 offen offset:0 sc1
    s_waitcnt vmcnt(6)
    buffer_load_dwordx4 a[132:135], v1, s[4:7], s18 offen offset:1024 sc1
    s_waitcnt vmcnt(6)
    buffer_load_dwordx4 a[136:139], v1, s[4:7], s18 offen offset:2048 sc1
    s_waitcnt vmcnt(6)
    buffer_load_dwordx4 a[140:143], v1, s[4:7], s18 offen offset:3072 sc1
    s_waitcnt vmcnt(6)
    s_add_u32 s18, s18, 4096
    buffer_load_dwordx4 a[144:147], v1, s[4:7], s18 offen offset:0 sc1
    s_waitcnt vmcnt(6)
    buffer_load_dwordx4 a[148:151], v1, s[4:7], s18 offen offset:1024 sc1
    s_waitcnt vmcnt(6)
    buffer_load_dwordx4 a[152:155], v1, s[4:7], s18 offen offset:2048 sc1
    s_waitcnt vmcnt(6)
    buffer_load_dwordx4 a[156:159], v1, s[4:7], s18 offen offset:3072 sc1
    s_waitcnt vmcnt(6)
    s_add_u32 s18, s18, 4096
    buffer_load_dwordx4 a[160:163], v1, s[4:7], s18 offen offset:0 sc1
    s_waitcnt vmcnt(6)
    buffer_load_dwordx4 a[164:167], v1, s[4:7], s18 offen offset:1024 sc1
    s_waitcnt vmcnt(6)
    buffer_load_dwordx4 a[168:171], v1, s[4:7], s18 offen offset:2048 sc1
    s_waitcnt vmcnt(6)
    buffer_load_dwordx4 a[172:175], v1, s[4:7], s18 offen offset:3072 sc1
    s_waitcnt vmcnt(6)
    s_add_u32 s18, s18, 4096
    buffer_load_dwordx4 a[176:179], v1, s[4:7], s18 offen offset:0 sc1
    s_waitcnt vmcnt(6)
    buffer_load_dwordx4 a[180:183], v1, s[4:7], s18 offen offset:1024 sc1
    s_waitcnt vmcnt(6)
    buffer_load_dwordx4 a[184:187], v1, s[4:7], s18 offen offset:2048 sc1
    s_waitcnt vmcnt(6)
    buffer_load_dwordx4 a[188:191], v1, s[4:7], s18 offen offset:3072 sc1
    s_waitcnt vmcnt(6)
    s_add_u32 s18, s18, 4096
    buffer_load_dwordx4 a[192:195], v1, s[4:7], s18 offen offset:0 sc1
    s_waitcnt vmcnt(6)
    buffer_load_dwordx4 a[196:199], v1, s[4:7], s18 offen offset:1024 sc1
    s_waitcnt vmcnt(6)
    buffer_load_dwordx4 a[200:203], v1, s[4:7], s18 offen offset:2048 sc1
    s_waitcnt vmcnt(6)
    buffer_load_dwordx4 a[204:207], v1, s[4:7], s18 offen offset:3072 sc1
    s_waitcnt vmcnt(6)
    s_add_u32 s18, s18, 4096
    buffer_load_dwordx4 a[208:211], v1, s[4:7], s18 offen offset:0 sc1
    s_waitcnt vmcnt(6)
    buffer_load_dwordx4 a[212:215], v1, s[4:7], s18 offen offset:1024 sc1
    s_waitcnt vmcnt(6)
    buffer_load_dwordx4 a[216:219], v1, s[4:7], s18 offen offset:2048 sc1
    s_waitcnt vmcnt(6)
    buffer_load_dwordx4 a[220:223], v1, s[4:7], s18 offen offset:3072 sc1
    s_waitcnt vmcnt(6)
    s_add_u32 s18, s18, 4096
    buffer_load_dwordx4 a[224:227], v1, s[4:7], s18 offen offset:0 sc1
    s_waitcnt vmcnt(6)
    buffer_load_dwordx4 a[228:231], v1, s[4:7], s18 offen offset:1024 sc1
    s_waitcnt vmcnt(6)
    buffer_load_dwordx4 a[232:235], v1, s[4:7], s18 offen offset:2048 sc1
    s_waitcnt vmcnt(6)
    buffer_load_dwordx4 a[236:239], v1, s[4:7], s18 offen offset:3072 sc1
    s_waitcnt vmcnt(6)
    s_add_u32 s18, s18, 4096
    buffer_load_dwordx4 a[240:243], v1, s[4:7], s18 offen offset:0 sc1
    s_waitcnt vmcnt(6)
    buffer_load_dwordx4 a[244:247], v1, s[4:7], s18 offen offset:1024 sc1
    s_waitcnt vmcnt(6)
    buffer_load_dwordx4 a[248:251], v1, s[4:7], s18 offen offset:2048 sc1
    s_waitcnt vmcnt(6)
    buffer_load_dwordx4 a[252:255], v1, s[4:7], s18 offen offset:3072 sc1
    s_waitcnt vmcnt(6)
    s_waitcnt vmcnt(0)
    s_mov_b32 s44, 0
    s_mov_b32 s37, s35
    v_mov_b32 v250, 1
    v_mov_b32 v251, 163832
    v_cmp_eq_u32 vcc, 0, v0
    s_nop 0
    s_and_saveexec_b64 s[38:39], vcc
    s_cbranch_execz tk21
    buffer_atomic_add v250, off, s[84:87], s37 sc0
    s_waitcnt vmcnt(0)
    ds_write_b32 v251, v250
    s_waitcnt lgkmcnt(0)
tk21:
    s_mov_b64 exec, -1
    s_barrier
    ds_read_b32 v252, v251
    s_waitcnt lgkmcnt(0)
    v_readfirstlane_b32 s16, v252
    s_barrier
    s_nop 3
    s_cmp_ge_u32 s16, 68
    s_cbranch_scc1 L_op_nextcb
L_op_seg:
    s_min_u32 s43, s16, 60
    s_add_u32 s16, s16, s43
    s_cmp_lt_u32 s16, 120
    s_cbranch_scc1 L_op_nr
    s_add_u32 s43, s16, 6
    s_sub_u32 s16, s16, 2
    s_cmp_lt_u32 s16, 120
    s_cselect_b32 s16, s43, s16
L_op_nr:
    s_lshr_b32 s43, s16, 1
    s_add_u32 s43, s43, 2
    s_min_u32 s43, s43, 63
    s_lshl_b32 s94, s33, 7
    s_add_u32 s94, s94, s16
    s_mov_b32 s88, 65536
    s_mov_b32 s89, 125853696
cw22:
    buffer_load_dword v3, off, s[4:7], s89 sc1
    s_waitcnt vmcnt(0)
    v_readfirstlane_b32 s42, v3
    s_nop 0
    s_sub_u32 s42, s42, s95
    s_cmp_gt_u32 s42, 64
    s_cselect_b32 s42, 0, s42
    s_add_u32 s42, s42, 1
    s_cmp_ge_u32 s42, s43
    s_cbranch_scc1 cw22x
    s_sub_u32 s88, s88, 1
    s_cbranch_scc1 cw22x
    s_sub_u32 s42, s43, s42
    s_min_u32 s42, s42, 6
cw22s:
    s_sleep 24
    s_sub_u32 s42, s42, 1
    s_cmp_lg_u32 s42, 0
    s_cbranch_scc1 cw22s
    s_branch cw22
cw22x:
    s_lshr_b32 s89, s16, 1
    s_lshl_b32 s89, s89, 2
    s_add_u32 s89, s89, s32
    s_lshl_b32 s89, s89, 7
    s_add_u32 s89, s89, 125894656
    s_sub_u32 s47, s89, 125894656
    s_lshl_b32 s47, s47, 5
    s_lshl_b32 s46, s33, 7
    s_add_u32 s47, s47, s46
    s_add_u32 s47, s47, 124944384
    s_cmp_ge_u32 s16, 124
    s_cselect_b32 s46, 8, 0
    s_cselect_b32 s47, s47, s89
    v_mbcnt_lo_u32_b32 v2, -1, 0
    v_mbcnt_hi_u32_b32 v2, -1, v2
    v_min_u32 v2, 1, v2
    v_lshlrev_b32 v2, 2, v2
    s_mov_b32 s88, 4194304
fw23:
    buffer_load_dword v3, v2, s[4:7], s47 offen offset:0 sc1
    s_sub_u32 s88, s88, 1
    s_cbranch_scc1 fw23x
    s_waitcnt vmcnt(0)
    v_cmp_ne_u32 vcc, s95, v3
    s_cbranch_vccz fw23x
    s_sleep 1
    s_branch fw23
fw23x:
    v_mov_b32 v250, 1
    v_lshrrev_b32 v252, 2, v1
    v_min_u32 v252, 68, v252
    s_cmp_lg_u32 s32, 0
    s_cbranch_scc1 L_op_na
    s_mov_b64 exec, 1
    buffer_atomic_add v250, off, s[84:87], s35 sc0
    s_mov_b64 exec, -1
    s_cmp_lg_u32 s44, 0
    s_cbranch_scc1 L_op_na
    buffer_load_dword v253, v252, s[84:87], 0 offen offset:136 sc1
L_op_na:
    s_cmp_ge_u32 s16, 120
    s_cbranch_scc1 L_op_one
o2_again:
    s_lshl_b32 s18, s16, 17
    s_lshl_b32 s19, s32, 15
    s_add_u32 s18, s18, s19
    s_add_u32 s18, s18, 50331648
    buffer_load_dwordx4 v[24:27], v1, s[4:7], s18 offen offset:0 sc1
    buffer_load_dwordx4 v[28:31], v1, s[4:7], s18 offen offset:1024 sc1
    buffer_load_dwordx4 v[32:35], v1, s[4:7], s18 offen offset:2048 sc1
    buffer_load_dwordx4 v[36:39], v1, s[4:7], s18 offen offset:3072 sc1
    s_add_u32 s18, s18, 4096
    buffer_load_dwordx4 v[40:43], v1, s[4:7], s18 offen offset:0 sc1
    buffer_load_dwordx4 v[44:47], v1, s[4:7], s18 offen offset:1024 sc1
    buffer_load_dwordx4 v[48:51], v1, s[4:7], s18 offen offset:2048 sc1
    buffer_load_dwordx4 v[52:55], v1, s[4:7], s18 offen offset:3072 sc1
    s_add_u32 s18, s18, 4096
    buffer_load_dwordx4 v[56:59], v1, s[4:7], s18 offen offset:0 sc1
    buffer_load_dwordx4 v[60:63], v1, s[4:7], s18 offen offset:1024 sc1
    buffer_load_dwordx4 v[64:67], v1, s[4:7], s18 offen offset:2048 sc1
    buffer_load_dwordx4 v[68:71], v1, s[4:7], s18 offen offset:3072 sc1
    s_add_u32 s18, s18, 4096
    buffer_load_dwordx4 v[72:75], v1, s[4:7], s18 offen offset:0 sc1
    buffer_load_dwordx4 v[76:79], v1, s[4:7], s18 offen offset:1024 sc1
    buffer_load_dwordx4 v[80:83], v1, s[4:7], s18 offen offset:2048 sc1
    buffer_load_dwordx4 v[84:87], v1, s[4:7], s18 offen offset:3072 sc1
    s_add_u32 s18, s18, 4096
    buffer_load_dwordx4 v[88:91], v1, s[4:7], s18 offen offset:0 sc1
    buffer_load_dwordx4 v[92:95], v1, s[4:7], s18 offen offset:1024 sc1
    buffer_load_dwordx4 v[96:99], v1, s[4:7], s18 offen offset:2048 sc1
    buffer_load_dwordx4 v[100:103], v1, s[4:7], s18 offen offset:3072 sc1
    s_add_u32 s18, s18, 4096
    buffer_load_dwordx4 v[104:107], v1, s[4:7], s18 offen offset:0 sc1
    buffer_load_dwordx4 v[108:111], v1, s[4:7], s18 offen offset:1024 sc1
    buffer_load_dwordx4 v[112:115], v1, s[4:7], s18 offen offset:2048 sc1
    buffer_load_dwordx4 v[116:119], v1, s[4:7], s18 offen offset:3072 sc1
    s_add_u32 s18, s18, 4096
    buffer_load_dwordx4 v[120:123], v1, s[4:7], s18 offen offset:0 sc1
    buffer_load_dwordx4 v[124:127], v1, s[4:7], s18 offen offset:1024 sc1
    buffer_load_dwordx4 v[128:131], v1, s[4:7], s18 offen offset:2048 sc1
    buffer_load_dwordx4 v[132:135], v1, s[4:7], s18 offen offset:3072 sc1
    s_add_u32 s18, s18, 4096
    buffer_load_dwordx4 v[136:139], v1, s[4:7], s18 offen offset:0 sc1
    buffer_load_dwordx4 v[140:143], v1, s[4:7], s18 offen offset:1024 sc1
    buffer_load_dwordx4 v[144:147], v1, s[4:7], s18 offen offset:2048 sc1
    buffer_load_dwordx4 v[148:151], v1, s[4:7], s18 offen offset:3072 sc1
    s_add_u32 s18, s18, 102400
    buffer_load_dwordx4 v[152:155], v1, s[4:7], s18 offen offset:0 sc1
    buffer_load_dwordx4 v[156:159], v1, s[4:7], s18 offen offset:1024 sc1
    buffer_load_dwordx4 v[160:163], v1, s[4:7], s18 offen offset:2048 sc1
    buffer_load_dwordx4 v[164:167], v1, s[4:7], s18 offen offset:3072 sc1
    s_add_u32 s18, s18, 4096
    buffer_load_dwordx4 v[168:171], v1, s[4:7], s18 offen offset:0 sc1
    buffer_load_dwordx4 v[172:175], v1, s[4:7], s18 offen offset:1024 sc1
    buffer_load_dwordx4 v[176:179], v1, s[4:7], s18 offen offset:2048 sc1
    buffer_load_dwordx4 v[180:183], v1, s[4:7], s18 offen offset:3072 sc1
    s_add_u32 s18, s18, 4096
    buffer_load_dwordx4 v[184:187], v1, s[4:7], s18 offen offset:0 sc1
    buffer_load_dwordx4 v[188:191], v1, s[4:7], s18 offen offset:1024 sc1
    buffer_load_dwordx4 v[192:195], v1, s[4:7], s18 offen offset:2048 sc1
    buffer_load_dwordx4 v[196:199], v1, s[4:7], s18 offen offset:3072 sc1
    s_add_u32 s18, s18, 4096
    buffer_load_dwordx4 v[200:203], v1, s[4:7], s18 offen offset:0 sc1
    buffer_load_dwordx4 v[204:207], v1, s[4:7], s18 offen offset:1024 sc1
    buffer_load_dwordx4 v[208:211], v1, s[4:7], s18 offen offset:2048 sc1
    buffer_load_dwordx4 v[212:215], v1, s[4:7], s18 offen offset:3072 sc1
    s_add_u32 s18, s18, 4096
    buffer_load_dwordx4 v[216:219], v1, s[4:7], s18 offen offset:0 sc1
    buffer_load_dwordx4 v[220:223], v1, s[4:7], s18 offen offset:1024 sc1
    buffer_load_dwordx4 v[224:227], v1, s[4:7], s18 offen offset:2048 sc1
    buffer_load_dwordx4 v[228:231], v1, s[4:7], s18 offen offset:3072 sc1
    s_add_u32 s18, s18, 4096
    buffer_load_dwordx4 v[232:235], v1, s[4:7], s18 offen offset:0 sc1
    buffer_load_dwordx4 v[236:239], v1, s[4:7], s18 offen offset:1024 sc1
    buffer_load_dwordx4 v[240:243], v1, s[4:7], s18 offen offset:2048 sc1
    buffer_load_dwordx4 v[244:247], v1, s[4:7], s18 offen offset:3072 sc1
    v_lshlrev_b32 v2, 4, v0
    v_and_b32 v3, 3072, v2
    v_lshl_add_u32 v2, v3, 1, v1
    s_waitcnt vmcnt(55)
    v_mfma_f32_16x16x32_bf16 v[8:11], a[0:3], v[24:27], 0
    v_mfma_f32_16x16x32_bf16 v[12:15], a[4:7], v[24:27], 0
    s_add_u32 s18, s18, 4096
    buffer_load_dwordx4 v[24:27], v1, s[4:7], s18 offen offset:0 sc1
    s_waitcnt vmcnt(55)
    v_mfma_f32_16x16x32_bf16 v[8:11], a[8:11], v[28:31], v[8:11]
    v_mfma_f32_16x16x32_bf16 v[12:15], a[12:15], v[28:31], v[12:15]
    buffer_load_dwordx4 v[28:31], v1, s[4:7], s18 offen offset:1024 sc1
    s_waitcnt vmcnt(55)
    v_mfma_f32_16x16x32_bf16 v[8:11], a[16:19], v[32:35], v[8:11]
    v_mfma_f32_16x16x32_bf16 v[12:15], a[20:23], v[32:35], v[12:15]
    buffer_load_dwordx4 v[32:35], v1, s[4:7], s18 offen offset:2048 sc1
    s_waitcnt vmcnt(55)
    v_mfma_f32_16x16x32_bf16 v[8:11], a[24:27], v[36:39], v[8:11]
    v_mfma_f32_16x16x32_bf16 v[12:15], a[28:31], v[36:39], v[12:15]
    buffer_load_dwordx4 v[36:39], v1, s[4:7], s18 offen offset:3072 sc1
    s_waitcnt vmcnt(55)
    v_mfma_f32_16x16x32_bf16 v[8:11], a[32:35], v[40:43], v[8:11]
    v_mfma_f32_16x16x32_bf16 v[12:15], a[36:39], v[40:43], v[12:15]
    s_add_u32 s18, s18, 4096
    buffer_load_dwordx4 v[40:43], v1, s[4:7], s18 offen offset:0 sc1
    s_waitcnt vmcnt(55)
    v_mfma_f32_16x16x32_bf16 v[8:11], a[40:43], v[44:47], v[8:11]
    v_mfma_f32_16x16x32_bf16 v[12:15], a[44:47], v[44:47], v[12:15]
    buffer_load_dwordx4 v[44:47], v1, s[4:7], s18 offen offset:1024 sc1
    s_waitcnt vmcnt(55)
    v_mfma_f32_16x16x32_bf16 v[8:11], a[48:51], v[48:51], v[8:11]
    v_mfma_f32_16x16x32_bf16 v[12:15], a[52:55], v[48:51], v[12:15]
    buffer_load_dwordx4 v[48:51], v1, s[4:7], s18 offen offset:2048 sc1
    s_waitcnt vmcnt(55)
    v_mfma_f32_16x16x32_bf16 v[8:11], a[56:59], v[52:55], v[8:11]
    v_mfma_f32_16x16x32_bf16 v[12:15], a[60:63], v[52:55], v[12:15]
    buffer_load_dwordx4 v[52:55], v1, s[4:7], s18 offen offset:3072 sc1
    s_waitcnt vmcnt(55)
    v_mfma_f32_16x16x32_bf16 v[8:11], a[64:67], v[56:59], v[8:11]
    v_mfma_f32_16x16x32_bf16 v[12:15], a[68:71], v[56:59], v[12:15]
    s_waitcnt vmcnt(54)
    v_mfma_f32_16x16x32_bf16 v[8:11], a[72:75], v[60:63], v[8:11]
    v_mfma_f32_16x16x32_bf16 v[12:15], a[76:79], v[60:63], v[12:15]
    s_waitcnt vmcnt(53)
    v_mfma_f32_16x16x32_bf16 v[8:11], a[80:83], v[64:67], v[8:11]
    v_mfma_f32_16x16x32_bf16 v[12:15], a[84:87], v[64:67], v[12:15]
    s_waitcnt vmcnt(52)
    v_mfma_f32_16x16x32_bf16 v[8:11], a[88:91], v[68:71], v[8:11]
    v_mfma_f32_16x16x32_bf16 v[12:15], a[92:95], v[68:71], v[12:15]
    s_waitcnt vmcnt(51)
    v_mfma_f32_16x16x32_bf16 v[8:11], a[96:99], v[72:75], v[8:11]
    v_mfma_f32_16x16x32_bf16 v[12:15], a[100:103], v[72:75], v[12:15]
    s_waitcnt vmcnt(50)
    v_mfma_f32_16x16x32_bf16 v[8:11], a[104:107], v[76:79], v[8:11]
    v_mfma_f32_16x16x32_bf16 v[12:15], a[108:111], v[76:79], v[12:15]
    s_waitcnt vmcnt(49)
    v_mfma_f32_16x16x32_bf16 v[8:11], a[112:115], v[80:83], v[8:11]
    v_mfma_f32_16x16x32_bf16 v[12:15], a[116:119], v[80:83], v[12:15]
    s_waitcnt vmcnt(48)
    v_mfma_f32_16x16x32_bf16 v[8:11], a[120:123], v[84:87], v[8:11]
    v_mfma_f32_16x16x32_bf16 v[12:15], a[124:127], v[84:87], v[12:15]
    s_waitcnt vmcnt(47)
    v_mfma_f32_16x16x32_bf16 v[8:11], a[128:131], v[88:91], v[8:11]
    v_mfma_f32_16x16x32_bf16 v[12:15], a[132:135], v[88:91], v[12:15]
    s_waitcnt vmcnt(46)
    v_mfma_f32_16x16x32_bf16 v[8:11], a[136:139], v[92:95], v[8:11]
    v_mfma_f32_16x16x32_bf16 v[12:15], a[140:143], v[92:95], v[12:15]
    s_waitcnt vmcnt(45)
    v_mfma_f32_16x16x32_bf16 v[8:11], a[144:147], v[96:99], v[8:11]
    v_mfma_f32_16x16x32_bf16 v[12:15], a[148:151], v[96:99], v[12:15]
    s_waitcnt vmcnt(44)
    v_mfma_f32_16x16x32_bf16 v[8:11], a[152:155], v[100:103], v[8:11]
    v_mfma_f32_16x16x32_bf16 v[12:15], a[156:159], v[100:103], v[12:15]
    s_waitcnt vmcnt(43)
    v_mfma_f32_16x16x32_bf16 v[8:11], a[160:163], v[104:107], v[8:11]
    v_mfma_f32_16x16x32_bf16 v[12:15], a[164:167], v[104:107], v[12:15]
    s_waitcnt vmcnt(42)
    v_mfma_f32_16x16x32_bf16 v[8:11], a[168:171], v[108:111], v[8:11]
    v_mfma_f32_16x16x32_bf16 v[12:15], a[172:175], v[108:111], v[12:15]
    s_waitcnt vmcnt(41)
    v_mfma_f32_16x16x32_bf16 v[8:11], a[176:179], v[112:115], v[8:11]
    v_mfma_f32_16x16x32_bf16 v[12:15], a[180:183], v[112:115], v[12:15]
    s_waitcnt vmcnt(40)
    v_mfma_f32_16x16x32_bf16 v[8:11], a[184:187], v[116:119], v[8:11]
    v_mfma_f32_16x16x32_bf16 v[12:15], a[188:191], v[116:119], v[12:15]
    s_waitcnt vmcnt(39)
    v_mfma_f32_16x16x32_bf16 v[8:11], a[192:195], v[120:123], v[8:11]
    v_mfma_f32_16x16x32_bf16 v[12:15], a[196:199], v[120:123], v[12:15]
    s_waitcnt vmcnt(38)
    v_mfma_f32_16x16x32_bf16 v[8:11], a[200:203], v[124:127], v[8:11]
    v_mfma_f32_16x16x32_bf16 v[12:15], a[204:207], v[124:127], v[12:15]
    s_waitcnt vmcnt(37)
    v_mfma_f32_16x16x32_bf16 v[8:11], a[208:211], v[128:131], v[8:11]
    v_mfma_f32_16x16x32_bf16 v[12:15], a[212:215], v[128:131], v[12:15]
    s_waitcnt vmcnt(36)
    v_mfma_f32_16x16x32_bf16 v[8:11], a[216:219], v[132:135], v[8:11]
    v_mfma_f32_16x16x32_bf16 v[12:15], a[220:223], v[132:135], v[12:15]
    s_waitcnt vmcnt(35)
    v_mfma_f32_16x16x32_bf16 v[8:11], a[224:227], v[136:139], v[8:11]
    v_mfma_f32_16x16x32_bf16 v[12:15], a[228:231], v[136:139], v[12:15]
    s_waitcnt vmcnt(34)
    v_mfma_f32_16x16x32_bf16 v[8:11], a[232:235], v[140:143], v[8:11]
    v_mfma_f32_16x16x32_bf16 v[12:15], a[236:239], v[140:143], v[12:15]
    s_waitcnt vmcnt(33)
    v_mfma_f32_16x16x32_bf16 v[8:11], a[240:243], v[144:147], v[8:11]
    v_mfma_f32_16x16x32_bf16 v[12:15], a[244:247], v[144:147], v[12:15]
    s_waitcnt vmcnt(32)
    v_mfma_f32_16x16x32_bf16 v[8:11], a[248:251], v[148:151], v[8:11]
    v_mfma_f32_16x16x32_bf16 v[12:15], a[252:255], v[148:151], v[12:15]
    s_waitcnt vmcnt(31)
    v_mfma_f32_16x16x32_bf16 v[16:19], a[0:3], v[152:155], 0
    v_mfma_f32_16x16x32_bf16 v[20:23], a[4:7], v[152:155], 0
    s_waitcnt vmcnt(30)
    v_mfma_f32_16x16x32_bf16 v[16:19], a[8:11], v[156:159], v[16:19]
    v_mfma_f32_16x16x32_bf16 v[20:23], a[12:15], v[156:159], v[20:23]
    s_waitcnt vmcnt(29)
    v_mfma_f32_16x16x32_bf16 v[16:19], a[16:19], v[160:163], v[16:19]
    v_mfma_f32_16x16x32_bf16 v[20:23], a[20:23], v[160:163], v[20:23]
    s_waitcnt vmcnt(28)
    v_mfma_f32_16x16x32_bf16 v[16:19], a[24:27], v[164:167], v[16:19]
    v_mfma_f32_16x16x32_bf16 v[20:23], a[28:31], v[164:167], v[20:23]
    s_waitcnt vmcnt(27)
    v_mfma_f32_16x16x32_bf16 v[16:19], a[32:35], v[168:171], v[16:19]
    v_mfma_f32_16x16x32_bf16 v[20:23], a[36:39], v[168:171], v[20:23]
    s_waitcnt vmcnt(26)
    v_mfma_f32_16x16x32_bf16 v[16:19], a[40:43], v[172:175], v[16:19]
    v_mfma_f32_16x16x32_bf16 v[20:23], a[44:47], v[172:175], v[20:23]
    s_waitcnt vmcnt(25)
    v_mfma_f32_16x16x32_bf16 v[16:19], a[48:51], v[176:179], v[16:19]
    v_mfma_f32_16x16x32_bf16 v[20:23], a[52:55], v[176:179], v[20:23]
    s_waitcnt vmcnt(24)
    v_mfma_f32_16x16x32_bf16 v[16:19], a[56:59], v[180:183], v[16:19]
    v_mfma_f32_16x16x32_bf16 v[20:23], a[60:63], v[180:183], v[20:23]
    s_waitcnt vmcnt(23)
    v_mfma_f32_16x16x32_bf16 v[16:19], a[64:67], v[184:187], v[16:19]
    v_mfma_f32_16x16x32_bf16 v[20:23], a[68:71], v[184:187], v[20:23]
    s_waitcnt vmcnt(22)
    v_mfma_f32_16x16x32_bf16 v[16:19], a[72:75], v[188:191], v[16:19]
    v_mfma_f32_16x16x32_bf16 v[20:23], a[76:79], v[188:191], v[20:23]
    s_waitcnt vmcnt(21)
    v_mfma_f32_16x16x32_bf16 v[16:19], a[80:83], v[192:195], v[16:19]
    v_mfma_f32_16x16x32_bf16 v[20:23], a[84:87], v[192:195], v[20:23]
    s_waitcnt vmcnt(20)
    v_mfma_f32_16x16x32_bf16 v[16:19], a[88:91], v[196:199], v[16:19]
    v_mfma_f32_16x16x32_bf16 v[20:23], a[92:95], v[196:199], v[20:23]
    s_waitcnt vmcnt(19)
    v_mfma_f32_16x16x32_bf16 v[16:19], a[96:99], v[200:203], v[16:19]
    v_mfma_f32_16x16x32_bf16 v[20:23], a[100:103], v[200:203], v[20:23]
    s_waitcnt vmcnt(18)
    v_mfma_f32_16x16x32_bf16 v[16:19], a[104:107], v[204:207], v[16:19]
    v_mfma_f32_16x16x32_bf16 v[20:23], a[108:111], v[204:207], v[20:23]
    s_waitcnt vmcnt(17)
    v_mfma_f32_16x16x32_bf16 v[16:19], a[112:115], v[208:211], v[16:19]
    v_mfma_f32_16x16x32_bf16 v[20:23], a[116:119], v[208:211], v[20:23]
    s_waitcnt vmcnt(16)
    v_mfma_f32_16x16x32_bf16 v[16:19], a[120:123], v[212:215], v[16:19]
    v_mfma_f32_16x16x32_bf16 v[20:23], a[124:127], v[212:215], v[20:23]
    s_waitcnt vmcnt(15)
    v_mfma_f32_16x16x32_bf16 v[16:19], a[128:131], v[216:219], v[16:19]
    v_mfma_f32_16x16x32_bf16 v[20:23], a[132:135], v[216:219], v[20:23]
    s_waitcnt vmcnt(14)
    v_mfma_f32_16x16x32_bf16 v[16:19], a[136:139], v[220:223], v[16:19]
    v_mfma_f32_16x16x32_bf16 v[20:23], a[140:143], v[220:223], v[20:23]
    s_waitcnt vmcnt(13)
    v_mfma_f32_16x16x32_bf16 v[16:19], a[144:147], v[224:227], v[16:19]
    v_mfma_f32_16x16x32_bf16 v[20:23], a[148:151], v[224:227], v[20:23]
    s_waitcnt vmcnt(12)
    v_mfma_f32_16x16x32_bf16 v[16:19], a[152:155], v[228:231], v[16:19]
    v_mfma_f32_16x16x32_bf16 v[20:23], a[156:159], v[228:231], v[20:23]
    s_waitcnt vmcnt(11)
    v_mfma_f32_16x16x32_bf16 v[16:19], a[160:163], v[232:235], v[16:19]
    v_mfma_f32_16x16x32_bf16 v[20:23], a[164:167], v[232:235], v[20:23]
    s_waitcnt vmcnt(10)
    v_mfma_f32_16x16x32_bf16 v[16:19], a[168:171], v[236:239], v[16:19]
    v_mfma_f32_16x16x32_bf16 v[20:23], a[172:175], v[236:239], v[20:23]
    s_waitcnt vmcnt(9)
    v_mfma_f32_16x16x32_bf16 v[16:19], a[176:179], v[240:243], v[16:19]
    v_mfma_f32_16x16x32_bf16 v[20:23], a[180:183], v[240:243], v[20:23]
    s_waitcnt vmcnt(8)
    v_mfma_f32_16x16x32_bf16 v[16:19], a[184:187], v[244:247], v[16:19]
    v_mfma_f32_16x16x32_bf16 v[20:23], a[188:191], v[244:247], v[20:23]
    s_waitcnt vmcnt(7)
    v_mfma_f32_16x16x32_bf16 v[16:19], a[192:195], v[24:27], v[16:19]
    v_mfma_f32_16x16x32_bf16 v[20:23], a[196:199], v[24:27], v[20:23]
    s_waitcnt vmcnt(6)
    v_mfma_f32_16x16x32_bf16 v[16:19], a[200:203], v[28:31], v[16:19]
    v_mfma_f32_16x16x32_bf16 v[20:23], a[204:207], v[28:31], v[20:23]
    s_waitcnt vmcnt(5)
    v_mfma_f32_16x16x32_bf16 v[16:19], a[208:211], v[32:35], v[16:19]
    v_mfma_f32_16x16x32_bf16 v[20:23], a[212:215], v[32:35], v[20:23]
    s_waitcnt vmcnt(4)
    v_mfma_f32_16x16x32_bf16 v[16:19], a[216:219], v[36:39], v[16:19]
    v_mfma_f32_16x16x32_bf16 v[20:23], a[220:223], v[36:39], v[20:23]
    s_waitcnt vmcnt(3)
    v_mfma_f32_16x16x32_bf16 v[16:19], a[224:227], v[40:43], v[16:19]
    v_mfma_f32_16x16x32_bf16 v[20:23], a[228:231], v[40:43], v[20:23]
    s_waitcnt vmcnt(2)
    v_mfma_f32_16x16x32_bf16 v[16:19], a[232:235], v[44:47], v[16:19]
    v_mfma_f32_16x16x32_bf16 v[20:23], a[236:239], v[44:47], v[20:23]
    s_waitcnt vmcnt(1)
    v_mfma_f32_16x16x32_bf16 v[16:19], a[240:243], v[48:51], v[16:19]
    v_mfma_f32_16x16x32_bf16 v[20:23], a[244:247], v[48:51], v[20:23]
    s_waitcnt vmcnt(0)
    v_mfma_f32_16x16x32_bf16 v[16:19], a[248:251], v[52:55], v[16:19]
    v_mfma_f32_16x16x32_bf16 v[20:23], a[252:255], v[52:55], v[20:23]
    ds_write_b128 v2, v[8:11] offset:0
    ds_write_b128 v2, v[12:15] offset:1024
    s_nop 4
    ds_write_b128 v2, v[16:19] offset:8192
    ds_write_b128 v2, v[20:23] offset:9216
    s_cmp_lg_u32 s32, 0
    s_cbranch_scc1 o2_nb
    v_cmp_eq_u32 vcc, 0, v253
    s_nop 0
    s_cmp_eq_u64 vcc, 0
    s_cselect_b32 s44, 65536, 0
    v_or_b32 v250, s44, v250
    v_mov_b32 v251, 163832
    s_mov_b64 exec, 1
    ds_write_b32 v251, v250
    s_mov_b64 exec, -1
o2_nb:
    s_waitcnt lgkmcnt(0)
    s_barrier
    s_cmp_gt_u32 s32, 1
    s_cbranch_scc1 o2_skip
    s_lshl_b32 s18, s32, 13
    v_add_u32 v2, s18, v1
    ds_read_b128 v[24:27], v2 offset:0
    ds_read_b128 v[28:31], v2 offset:1024
    ds_read_b128 v[32:35], v2 offset:2048
    ds_read_b128 v[36:39], v2 offset:3072
    ds_read_b128 v[40:43], v2 offset:4096
    ds_read_b128 v[44:47], v2 offset:5120
    ds_read_b128 v[48:51], v2 offset:6144
    ds_read_b128 v[52:55], v2 offset:7168
    v_lshrrev_b32 v3, 4, v1
    v_bfe_u32 v4, v3, 2, 2
    v_lshlrev_b32 v4, 3, v4
    v_and_b32 v2, 3, v3
    v_add_u32 v4, v4, v2
    v_mul_u32_u24 v4, 2304, v4
    v_lshrrev_b32 v3, 4, v3
    v_lshl_add_u32 v4, v3, 4, v4
    s_add_u32 s20, s16, s32
    s_lshr_b32 s18, s20, 1
    s_lshl_b32 s18, s18, 3
    s_and_b32 s19, s20, 1
    s_add_u32 s18, s18, s19
    s_mul_i32 s18, s18, 9216
    s_lshl_b32 s19, s33, 6
    s_add_u32 s18, s18, s19
    s_waitcnt lgkmcnt(0)
    v_pk_add_f32 v[24:25], v[24:25], v[32:33]
    v_pk_add_f32 v[40:41], v[40:41], v[48:49]
    v_pk_add_f32 v[24:25], v[24:25], v[40:41]
    v_pk_add_f32 v[26:27], v[26:27], v[34:35]
    v_pk_add_f32 v[42:43], v[42:43], v[50:51]
    v_pk_add_f32 v[26:27], v[26:27], v[42:43]
    v_pk_add_f32 v[28:29], v[28:29], v[36:37]
    v_pk_add_f32 v[44:45], v[44:45], v[52:53]
    v_pk_add_f32 v[28:29], v[28:29], v[44:45]
    v_pk_add_f32 v[30:31], v[30:31], v[38:39]
    v_pk_add_f32 v[46:47], v[46:47], v[54:55]
    v_pk_add_f32 v[30:31], v[30:31], v[46:47]
    v_cvt_pk_bf16_f32 v8, v24, v28
    v_cvt_pk_bf16_f32 v9, v25, v29
    v_cvt_pk_bf16_f32 v10, v26, v30
    v_cvt_pk_bf16_f32 v11, v27, v31
    buffer_store_dwordx4 v[8:11], v4, s[8:11], s18 offen
o2_skip:
    s_nop 1
    s_branch L_op_fin
L_op_one:
o1_again:
    s_lshl_b32 s18, s16, 17
    s_lshl_b32 s19, s32, 15
    s_add_u32 s18, s18, s19
    s_add_u32 s18, s18, 50331648
    buffer_load_dwordx4 v[24:27], v1, s[4:7], s18 offen offset:0 sc1
    buffer_load_dwordx4 v[28:31], v1, s[4:7], s18 offen offset:1024 sc1
    buffer_load_dwordx4 v[32:35], v1, s[4:7], s18 offen offset:2048 sc1
    buffer_load_dwordx4 v[36:39], v1, s[4:7], s18 offen offset:3072 sc1
    s_add_u32 s18, s18, 4096
    buffer_load_dwordx4 v[40:43], v1, s[4:7], s18 offen offset:0 sc1
    buffer_load_dwordx4 v[44:47], v1, s[4:7], s18 offen offset:1024 sc1
    buffer_load_dwordx4 v[48:51], v1, s[4:7], s18 offen offset:2048 sc1
    buffer_load_dwordx4 v[52:55], v1, s[4:7], s18 offen offset:3072 sc1
    s_add_u32 s18, s18, 4096
    buffer_load_dwordx4 v[56:59], v1, s[4:7], s18 offen offset:0 sc1
    buffer_load_dwordx4 v[60:63], v1, s[4:7], s18 offen offset:1024 sc1
    buffer_load_dwordx4 v[64:67], v1, s[4:7], s18 offen offset:2048 sc1
    buffer_load_dwordx4 v[68:71], v1, s[4:7], s18 offen offset:3072 sc1
    s_add_u32 s18, s18, 4096
    buffer_load_dwordx4 v[72:75], v1, s[4:7], s18 offen offset:0 sc1
    buffer_load_dwordx4 v[76:79], v1, s[4:7], s18 offen offset:1024 sc1
    buffer_load_dwordx4 v[80:83], v1, s[4:7], s18 offen offset:2048 sc1
    buffer_load_dwordx4 v[84:87], v1, s[4:7], s18 offen offset:3072 sc1
    s_add_u32 s18, s18, 4096
    buffer_load_dwordx4 v[88:91], v1, s[4:7], s18 offen offset:0 sc1
    buffer_load_dwordx4 v[92:95], v1, s[4:7], s18 offen offset:1024 sc1
    buffer_load_dwordx4 v[96:99], v1, s[4:7], s18 offen offset:2048 sc1
    buffer_load_dwordx4 v[100:103], v1, s[4:7], s18 offen offset:3072 sc1
    s_add_u32 s18, s18, 4096
    buffer_load_dwordx4 v[104:107], v1, s[4:7], s18 offen offset:0 sc1
    buffer_load_dwordx4 v[108:111], v1, s[4:7], s18 offen offset:1024 sc1
    buffer_load_dwordx4 v[112:115], v1, s[4:7], s18 offen offset:2048 sc1
    buffer_load_dwordx4 v[116:119], v1, s[4:7], s18 offen offset:3072 sc1
    s_add_u32 s18, s18, 4096
    buffer_load_dwordx4 v[120:123], v1, s[4:7], s18 offen offset:0 sc1
    buffer_load_dwordx4 v[124:127], v1, s[4:7], s18 offen offset:1024 sc1
    buffer_load_dwordx4 v[128:131], v1, s[4:7], s18 offen offset:2048 sc1
    buffer_load_dwordx4 v[132:135], v1, s[4:7], s18 offen offset:3072 sc1
    s_add_u32 s18, s18, 4096
    buffer_load_dwordx4 v[136:139], v1, s[4:7], s18 offen offset:0 sc1
    buffer_load_dwordx4 v[140:143], v1, s[4:7], s18 offen offset:1024 sc1
    buffer_load_dwordx4 v[144:147], v1, s[4:7], s18 offen offset:2048 sc1
    buffer_load_dwordx4 v[148:151], v1, s[4:7], s18 offen offset:3072 sc1
    v_lshlrev_b32 v2, 4, v0
    v_and_b32 v3, 3072, v2
    v_lshl_add_u32 v2, v3, 1, v1
    s_waitcnt vmcnt(31)
    v_mfma_f32_16x16x32_bf16 v[8:11], a[0:3], v[24:27], 0
    v_max_u32 v6, v24, v25
    v_mfma_f32_16x16x32_bf16 v[12:15], a[4:7], v[24:27], 0
    v_max3_u32 v6, v6, v26, v27
    s_waitcnt vmcnt(30)
    v_mfma_f32_16x16x32_bf16 v[8:11], a[8:11], v[28:31], v[8:11]
    v_max3_u32 v6, v6, v28, v29
    v_mfma_f32_16x16x32_bf16 v[12:15], a[12:15], v[28:31], v[12:15]
    v_max3_u32 v6, v6, v30, v31
    s_waitcnt vmcnt(29)
    v_mfma_f32_16x16x32_bf16 v[8:11], a[16:19], v[32:35], v[8:11]
    v_max3_u32 v6, v6, v32, v33
    v_mfma_f32_16x16x32_bf16 v[12:15], a[20:23], v[32:35], v[12:15]
    v_max3_u32 v6, v6, v34, v35
    s_waitcnt vmcnt(28)
    v_mfma_f32_16x16x32_bf16 v[8:11], a[24:27], v[36:39], v[8:11]
    v_max3_u32 v6, v6, v36, v37
    v_mfma_f32_16x16x32_bf16 v[12:15], a[28:31], v[36:39], v[12:15]
    v_max3_u32 v6, v6, v38, v39
    s_waitcnt vmcnt(27)
    v_mfma_f32_16x16x32_bf16 v[8:11], a[32:35], v[40:43], v[8:11]
    v_max3_u32 v6, v6, v40, v41
    v_mfma_f32_16x16x32_bf16 v[12:15], a[36:39], v[40:43], v[12:15]
    v_max3_u32 v6, v6, v42, v43
    s_waitcnt vmcnt(26)
    v_mfma_f32_16x16x32_bf16 v[8:11], a[40:43], v[44:47], v[8:11]
    v_max3_u32 v6, v6, v44, v45
    v_mfma_f32_16x16x32_bf16 v[12:15], a[44:47], v[44:47], v[12:15]
    v_max3_u32 v6, v6, v46, v47
    s_waitcnt vmcnt(25)
    v_mfma_f32_16x16x32_bf16 v[8:11], a[48:51], v[48:51], v[8:11]
    v_max3_u32 v6, v6, v48, v49
    v_mfma_f32_16x16x32_bf16 v[12:15], a[52:55], v[48:51], v[12:15]
    v_max3_u32 v6, v6, v50, v51
    s_waitcnt vmcnt(24)
    v_mfma_f32_16x16x32_bf16 v[8:11], a[56:59], v[52:55], v[8:11]
    v_max3_u32 v6, v6, v52, v53
    v_mfma_f32_16x16x32_bf16 v[12:15], a[60:63], v[52:55], v[12:15]
    v_max3_u32 v6, v6, v54, v55
    s_waitcnt vmcnt(23)
    v_mfma_f32_16x16x32_bf16 v[8:11], a[64:67], v[56:59], v[8:11]
    v_max3_u32 v6, v6, v56, v57
    v_mfma_f32_16x16x32_bf16 v[12:15], a[68:71], v[56:59], v[12:15]
    v_max3_u32 v6, v6, v58, v59
    s_waitcnt vmcnt(22)
    v_mfma_f32_16x16x32_bf16 v[8:11], a[72:75], v[60:63], v[8:11]
    v_max3_u32 v6, v6, v60, v61
    v_mfma_f32_16x16x32_bf16 v[12:15], a[76:79], v[60:63], v[12:15]
    v_max3_u32 v6, v6, v62, v63
    s_waitcnt vmcnt(21)
    v_mfma_f32_16x16x32_bf16 v[8:11], a[80:83], v[64:67], v[8:11]
    v_max3_u32 v6, v6, v64, v65
    v_mfma_f32_16x16x32_bf16 v[12:15], a[84:87], v[64:67], v[12:15]
    v_max3_u32 v6, v6, v66, v67
    s_waitcnt vmcnt(20)
    v_mfma_f32_16x16x32_bf16 v[8:11], a[88:91], v[68:71], v[8:11]
    v_max3_u32 v6, v6, v68, v69
    v_mfma_f32_16x16x32_bf16 v[12:15], a[92:95], v[68:71], v[12:15]
    v_max3_u32 v6, v6, v70, v71
    s_waitcnt vmcnt(19)
    v_mfma_f32_16x16x32_bf16 v[8:11], a[96:99], v[72:75], v[8:11]
    v_max3_u32 v6, v6, v72, v73
    v_mfma_f32_16x16x32_bf16 v[12:15], a[100:103], v[72:75], v[12:15]
    v_max3_u32 v6, v6, v74, v75
    s_waitcnt vmcnt(18)
    v_mfma_f32_16x16x32_bf16 v[8:11], a[104:107], v[76:79], v[8:11]
    v_max3_u32 v6, v6, v76, v77
    v_mfma_f32_16x16x32_bf16 v[12:15], a[108:111], v[76:79], v[12:15]
    v_max3_u32 v6, v6, v78, v79
    s_waitcnt vmcnt(17)
    v_mfma_f32_16x16x32_bf16 v[8:11], a[112:115], v[80:83], v[8:11]
    v_max3_u32 v6, v6, v80, v81
    v_mfma_f32_16x16x32_bf16 v[12:15], a[116:119], v[80:83], v[12:15]
    v_max3_u32 v6, v6, v82, v83
    s_waitcnt vmcnt(16)
    v_mfma_f32_16x16x32_bf16 v[8:11], a[120:123], v[84:87], v[8:11]
    v_max3_u32 v6, v6, v84, v85
    v_mfma_f32_16x16x32_bf16 v[12:15], a[124:127], v[84:87], v[12:15]
    v_max3_u32 v6, v6, v86, v87
    s_waitcnt vmcnt(15)
    v_mfma_f32_16x16x32_bf16 v[8:11], a[128:131], v[88:91], v[8:11]
    v_max3_u32 v6, v6, v88, v89
    v_mfma_f32_16x16x32_bf16 v[12:15], a[132:135], v[88:91], v[12:15]
    v_max3_u32 v6, v6, v90, v91
    s_waitcnt vmcnt(14)
    v_mfma_f32_16x16x32_bf16 v[8:11], a[136:139], v[92:95], v[8:11]
    v_max3_u32 v6, v6, v92, v93
    v_mfma_f32_16x16x32_bf16 v[12:15], a[140:143], v[92:95], v[12:15]
    v_max3_u32 v6, v6, v94, v95
    s_waitcnt vmcnt(13)
    v_mfma_f32_16x16x32_bf16 v[8:11], a[144:147], v[96:99], v[8:11]
    v_max3_u32 v6, v6, v96, v97
    v_mfma_f32_16x16x32_bf16 v[12:15], a[148:151], v[96:99], v[12:15]
    v_max3_u32 v6, v6, v98, v99
    s_waitcnt vmcnt(12)
    v_mfma_f32_16x16x32_bf16 v[8:11], a[152:155], v[100:103], v[8:11]
    v_max3_u32 v6, v6, v100, v101
    v_mfma_f32_16x16x32_bf16 v[12:15], a[156:159], v[100:103], v[12:15]
    v_max3_u32 v6, v6, v102, v103
    s_waitcnt vmcnt(11)
    v_mfma_f32_16x16x32_bf16 v[8:11], a[160:163], v[104:107], v[8:11]
    v_max3_u32 v6, v6, v104, v105
    v_mfma_f32_16x16x32_bf16 v[12:15], a[164:167], v[104:107], v[12:15]
    v_max3_u32 v6, v6, v106, v107
    s_waitcnt vmcnt(10)
    v_mfma_f32_16x16x32_bf16 v[8:11], a[168:171], v[108:111], v[8:11]
    v_max3_u32 v6, v6, v108, v109
    v_mfma_f32_16x16x32_bf16 v[12:15], a[172:175], v[108:111], v[12:15]
    v_max3_u32 v6, v6, v110, v111
    s_waitcnt vmcnt(9)
    v_mfma_f32_16x16x32_bf16 v[8:11], a[176:179], v[112:115], v[8:11]
    v_max3_u32 v6, v6, v112, v113
    v_mfma_f32_16x16x32_bf16 v[12:15], a[180:183], v[112:115], v[12:15]
    v_max3_u32 v6, v6, v114, v115
    s_waitcnt vmcnt(8)
    v_mfma_f32_16x16x32_bf16 v[8:11], a[184:187], v[116:119], v[8:11]
    v_max3_u32 v6, v6, v116, v117
    v_mfma_f32_16x16x32_bf16 v[12:15], a[188:191], v[116:119], v[12:15]
    v_max3_u32 v6, v6, v118, v119
    s_waitcnt vmcnt(7)
    v_mfma_f32_16x16x32_bf16 v[8:11], a[192:195], v[120:123], v[8:11]
    v_max3_u32 v6, v6, v120, v121
    v_mfma_f32_16x16x32_bf16 v[12:15], a[196:199], v[120:123], v[12:15]
    v_max3_u32 v6, v6, v122, v123
    s_waitcnt vmcnt(6)
    v_mfma_f32_16x16x32_bf16 v[8:11], a[200:203], v[124:127], v[8:11]
    v_max3_u32 v6, v6, v124, v125
    v_mfma_f32_16x16x32_bf16 v[12:15], a[204:207], v[124:127], v[12:15]
    v_max3_u32 v6, v6, v126, v127
    s_waitcnt vmcnt(5)
    v_mfma_f32_16x16x32_bf16 v[8:11], a[208:211], v[128:131], v[8:11]
    v_max3_u32 v6, v6, v128, v129
    v_mfma_f32_16x16x32_bf16 v[12:15], a[212:215], v[128:131], v[12:15]
    v_max3_u32 v6, v6, v130, v131
    s_waitcnt vmcnt(4)
    v_mfma_f32_16x16x32_bf16 v[8:11], a[216:219], v[132:135], v[8:11]
    v_max3_u32 v6, v6, v132, v133
    v_mfma_f32_16x16x32_bf16 v[12:15], a[220:223], v[132:135], v[12:15]
    v_max3_u32 v6, v6, v134, v135
    s_waitcnt vmcnt(3)
    v_mfma_f32_16x16x32_bf16 v[8:11], a[224:227], v[136:139], v[8:11]
    v_max3_u32 v6, v6, v136, v137
    v_mfma_f32_16x16x32_bf16 v[12:15], a[228:231], v[136:139], v[12:15]
    v_max3_u32 v6, v6, v138, v139
    s_waitcnt vmcnt(2)
    v_mfma_f32_16x16x32_bf16 v[8:11], a[232:235], v[140:143], v[8:11]
    v_max3_u32 v6, v6, v140, v141
    v_mfma_f32_16x16x32_bf16 v[12:15], a[236:239], v[140:143], v[12:15]
    v_max3_u32 v6, v6, v142, v143
    s_waitcnt vmcnt(1)
    v_mfma_f32_16x16x32_bf16 v[8:11], a[240:243], v[144:147], v[8:11]
    v_max3_u32 v6, v6, v144, v145
    v_mfma_f32_16x16x32_bf16 v[12:15], a[244:247], v[144:147], v[12:15]
    v_max3_u32 v6, v6, v146, v147
    s_waitcnt vmcnt(0)
    v_mfma_f32_16x16x32_bf16 v[8:11], a[248:251], v[148:151], v[8:11]
    v_max3_u32 v6, v6, v148, v149
    v_mfma_f32_16x16x32_bf16 v[12:15], a[252:255], v[148:151], v[12:15]
    v_max3_u32 v6, v6, v150, v151
    v_cmp_eq_u32 vcc, -1, v6
    s_cbranch_vccz o1_ok
    s_cmp_eq_u32 s46, 0
    s_cbranch_scc1 o1_ok
    s_mov_b32 s46, 0
    s_nop 1
    v_mbcnt_lo_u32_b32 v2, -1, 0
    v_mbcnt_hi_u32_b32 v2, -1, v2
    v_min_u32 v2, 1, v2
    v_lshlrev_b32 v2, 2, v2
    s_mov_b32 s88, 4194304
fw24:
    buffer_load_dword v3, v2, s[4:7], s89 offen offset:0 sc1
    s_sub_u32 s88, s88, 1
    s_cbranch_scc1 fw24x
    s_waitcnt vmcnt(0)
    v_cmp_ne_u32 vcc, s95, v3
    s_cbranch_vccz fw24x
    s_sleep 1
    s_branch fw24
fw24x:
    s_branch o1_again
o1_ok:
    s_nop 7
    ds_write_b128 v2, v[8:11] offset:0
    ds_write_b128 v2, v[12:15] offset:1024
    s_cmp_lg_u32 s32, 0
    s_cbranch_scc1 o1_nb
    v_cmp_eq_u32 vcc, 0, v253
    s_nop 0
    s_cmp_eq_u64 vcc, 0
    s_cselect_b32 s44, 65536, 0
    v_or_b32 v250, s44, v250
    v_mov_b32 v251, 163832
    s_mov_b64 exec, 1
    ds_write_b32 v251, v250
    s_mov_b64 exec, -1
o1_nb:
    s_waitcnt lgkmcnt(0)
    s_barrier
    s_cmp_gt_u32 s32, 0
    s_cbranch_scc1 o1_skip
    s_lshl_b32 s18, s32, 13
    v_add_u32 v2, s18, v1
    ds_read_b128 v[24:27], v2 offset:0
    ds_read_b128 v[28:31], v2 offset:1024
    ds_read_b128 v[32:35], v2 offset:2048
    ds_read_b128 v[36:39], v2 offset:3072
    ds_read_b128 v[40:43], v2 offset:4096
    ds_read_b128 v[44:47], v2 offset:5120
    ds_read_b128 v[48:51], v2 offset:6144
    ds_read_b128 v[52:55], v2 offset:7168
    v_lshrrev_b32 v3, 4, v1
    v_bfe_u32 v4, v3, 2, 2
    v_lshlrev_b32 v4, 3, v4
    v_and_b32 v2, 3, v3
    v_add_u32 v4, v4, v2
    v_mul_u32_u24 v4, 2304, v4
    v_lshrrev_b32 v3, 4, v3
    v_lshl_add_u32 v4, v3, 4, v4
    s_add_u32 s20, s16, s32
    s_lshr_b32 s18, s20, 1
    s_lshl_b32 s18, s18, 3
    s_and_b32 s19, s20, 1
    s_add_u32 s18, s18, s19
    s_mul_i32 s18, s18, 9216
    s_lshl_b32 s19, s33, 6
    s_add_u32 s18, s18, s19
    s_waitcnt lgkmcnt(0)
    v_pk_add_f32 v[24:25], v[24:25], v[32:33]
    v_pk_add_f32 v[40:41], v[40:41], v[48:49]
    v_pk_add_f32 v[24:25], v[24:25], v[40:41]
    v_pk_add_f32 v[26:27], v[26:27], v[34:35]
    v_pk_add_f32 v[42:43], v[42:43], v[50:51]
    v_pk_add_f32 v[26:27], v[26:27], v[42:43]
    v_pk_add_f32 v[28:29], v[28:29], v[36:37]
    v_pk_add_f32 v[44:45], v[44:45], v[52:53]
    v_pk_add_f32 v[28:29], v[28:29], v[44:45]
    v_pk_add_f32 v[30:31], v[30:31], v[38:39]
    v_pk_add_f32 v[46:47], v[46:47], v[54:55]
    v_pk_add_f32 v[30:31], v[30:31], v[46:47]
    v_cvt_pk_bf16_f32 v8, v24, v28
    v_cvt_pk_bf16_f32 v9, v25, v29
    v_cvt_pk_bf16_f32 v10, v26, v30
    v_cvt_pk_bf16_f32 v11, v27, v31
    buffer_store_dwordx4 v[8:11], v4, s[8:11], s18 offen
o1_skip:
    s_nop 1
L_op_fin:
    v_mov_b32 v251, 163832
    ds_read_b32 v252, v251
    s_waitcnt lgkmcnt(0)
    v_readfirstlane_b32 s40, v252
    s_nop 1
    s_cmp_ge_u32 s40, 65604
    s_cbranch_scc1 L_done
    s_barrier
    s_and_b32 s16, s40, 0xffff
    s_cmp_lt_u32 s16, 68
    s_cbranch_scc1 L_op_seg
L_op_nextcb:
    s_mov_b32 s40, -1
    s_cmp_lg_u32 s32, 0
    s_cbranch_scc1 L_op_dec
    v_and_b32 v1, 63, v0
    v_min_u32 v1, 17, v1
    v_lshlrev_b32 v2, 2, v1
    buffer_load_dword v3, v2, s[84:87], 0 offen offset:136 sc1
    s_waitcnt vmcnt(0)
    v_cmp_gt_u32 vcc, 52, v3
    s_nop 0
    s_and_b32 s40, vcc_lo, 262143
    s_lshl_b32 s41, s40, 18
    s_lshr_b32 s43, s40, 14
    s_or_b32 s42, s40, s41
    s_and_b32 s36, s45, 15
    s_bfm_b32 s37, s36, 0
    s_and_b32 s37, s37, 42315
    s_bcnt1_i32_b32 s37, s37
    s_lshr_b32 s36, s45, 4
    s_mul_i32 s36, s36, 8
    s_add_u32 s36, s36, s37
    s_add_u32 s36, s36, 38
    s_mul_hi_u32 s41, s36, 0x0e38e38f
    s_mul_i32 s41, s41, 18
    s_sub_u32 s41, s36, s41
    s_lshr_b64 s[42:43], s[42:43], s41
    s_ff1_i32_b64 s40, s[42:43]
    s_cmp_lt_i32 s40, 0
    s_cbranch_scc1 L_op_dec
    s_add_u32 s40, s40, s41
    s_sub_u32 s41, s40, 18
    s_cselect_b32 s40, s40, s41
L_op_dec:
    v_mov_b32 v250, s40
    v_mov_b32 v251, 163832
    s_cmp_lg_u32 s32, 0
    s_cbranch_scc1 L_op_nw
    ds_write_b32 v251, v250
    s_waitcnt lgkmcnt(0)
L_op_nw:
    s_barrier
    ds_read_b32 v252, v251
    s_waitcnt lgkmcnt(0)
    v_readfirstlane_b32 s33, v252
    s_barrier
    s_nop 1
    s_cmp_lt_u32 s33, 18
    s_cbranch_scc1 L_op_start
L_done:
L_exit:
    s_endpgm
.section .rodata,"a"
.p2align 6
.amdhsa_kernel concat_heads__memory_aug_recurrent_mem_tr__ssm_conv_s4d__prompt_kernel
  .amdhsa_next_free_vgpr 512
  .amdhsa_next_free_sgpr 102
  .amdhsa_accum_offset 256
  .amdhsa_group_segment_fixed_size 0
  .amdhsa_kernarg_size 136
  .amdhsa_user_sgpr_count 2
  .amdhsa_user_sgpr_kernarg_segment_ptr 1
  .amdhsa_system_sgpr_workgroup_id_x 1
.end_amdhsa_kernel
.text
```

```asm
; @launch grid=(256,1,1) block=(256,1,1) lds=163840
.amdgcn_target "amdgcn-amd-amdhsa--gfx950"
.text
.globl concat_heads__memory_aug_recurrent_mem_tr__ssm_conv_s4d__prompt_kernel
.p2align 8
.type concat_heads__memory_aug_recurrent_mem_tr__ssm_conv_s4d__prompt_kernel,@function
concat_heads__memory_aug_recurrent_mem_tr__ssm_conv_s4d__prompt_kernel:
    s_cmp_ge_u32 s2, 256
    s_cbranch_scc1 L_exit
    s_load_dwordx4 s[80:83], s[0:1], 120
    s_load_dwordx16 s[48:63], s[0:1], 0
    v_lshrrev_b32 v1, 6, v0
    s_nop 0
    v_readfirstlane_b32 s32, v1
    s_waitcnt lgkmcnt(0)
    s_mov_b32 s4, s82
    s_mov_b32 s5, s83
    s_mov_b32 s6, 268435456
    s_mov_b32 s7, 0x20000
    s_mov_b32 s84, s80
    s_mov_b32 s85, s81
    s_mov_b32 s86, 256
    s_mov_b32 s87, 0x20000
    s_cmp_lg_u32 s32, 0
    s_cbranch_scc1 L_nod0
L_nod0:
    s_cmp_lg_u32 s32, 3
    s_cbranch_scc1 L_nowarm
    s_getpc_b64 s[44:45]
L_pcw:
    v_and_b32 v1, 63, v0
    v_lshlrev_b32 v1, 7, v1
    s_mul_hi_u32 s46, s2, 477218589
    s_mul_i32 s47, s46, 9
    s_sub_u32 s47, s2, s47
    s_add_u32 s46, s46, s47
    s_mul_hi_u32 s40, s46, 477218589
    s_mul_i32 s40, s40, 9
    s_sub_u32 s46, s46, s40
    s_lshl_b32 s47, s47, 13
    v_add_u32 v2, s47, v1
    v_min_u32 v2, L_exit-L_pcw, v2
    global_load_dword v240, v2, s[44:45]
    s_lshl_b32 s46, s46, 13
    v_add_u32 v2, s46, v1
    v_min_u32 v2, L_exit-L_pcw, v2
    global_load_dword v241, v2, s[44:45]
L_nowarm:
    s_getreg_b32 s3, hwreg(HW_REG_XCC_ID)
    s_and_b32 s3, s3, 15
    s_cmp_lg_u32 s3, 3
    s_cbranch_scc1 L_helper
    s_mov_b32 s37, 128
    v_mov_b32 v250, 1
    v_mov_b32 v251, 163832
    v_cmp_eq_u32 vcc, 0, v0
    s_nop 0
    s_and_saveexec_b64 s[38:39], vcc
    s_cbranch_execz tk1
    buffer_atomic_add v250, off, s[84:87], s37 sc0
    s_waitcnt vmcnt(0)
    ds_write_b32 v251, v250
    s_waitcnt lgkmcnt(0)
tk1:
    s_mov_b64 exec, -1
    s_barrier
    ds_read_b32 v252, v251
    s_waitcnt lgkmcnt(0)
    v_readfirstlane_b32 s12, v252
    s_barrier
    s_nop 3
    s_cmp_ge_u32 s12, 32
    s_cbranch_scc1 L_helper
L_chain:
    s_mov_b64 s[48:49], s[50:51]
    s_mov_b64 s[50:51], s[52:53]
    s_mov_b64 s[52:53], s[54:55]
    s_mov_b64 s[54:55], s[56:57]
    s_mov_b64 s[56:57], s[58:59]
    v_lshrrev_b32 v77, 6, v0
    s_nop 0
    v_readfirstlane_b32 s13, v77
    v_lshlrev_b32 v65, 4, v0
    v_and_b32 v48, 63, v0
    s_mov_b32 s10, 4718592
    s_mov_b32 s11, 0x20000
    v_lshrrev_b32 v49, 3, v48
    v_mul_u32_u24 v18, 1152, v49
    v_and_b32 v49, 7, v48
    v_lshl_add_u32 v18, v49, 4, v18
    s_mul_i32 s40, s12, 147456
    s_lshl_b32 s41, s13, 8
    s_add_u32 s40, s40, s41
    s_mov_b32 s42, s40
    s_xor_b32 s41, s13, 0
    s_mul_i32 s41, s41, 36864
    s_add_u32 s60, s41, s40
    s_xor_b32 s41, s13, 1
    s_mul_i32 s41, s41, 36864
    s_add_u32 s61, s41, s40
    s_xor_b32 s41, s13, 2
    s_mul_i32 s41, s41, 36864
    s_add_u32 s62, s41, s40
    s_xor_b32 s41, s13, 3
    s_mul_i32 s41, s41, 36864
    s_add_u32 s63, s41, s40
    s_lshl_b32 s43, s13, 12
    s_mov_b64 s[8:9], s[56:57]
    s_add_u32 m0, s43, 147456
    s_add_u32 s41, s60, 0
    buffer_load_dwordx4 v18, s[8:11], s41 offen offset:0 nt lds
    s_add_u32 s41, s60, 8192
    buffer_load_dwordx4 v18, s[8:11], s41 offen offset:1024 nt lds
    s_add_u32 s41, s60, 16384
    buffer_load_dwordx4 v18, s[8:11], s41 offen offset:2048 nt lds
    s_add_u32 s41, s60, 24576
    buffer_load_dwordx4 v18, s[8:11], s41 offen offset:3072 nt lds
    s_add_u32 m0, s43, 0
    s_add_u32 s41, s61, 0
    buffer_load_dwordx4 v18, s[8:11], s41 offen offset:0 nt lds
    s_add_u32 s41, s61, 8192
    buffer_load_dwordx4 v18, s[8:11], s41 offen offset:1024 nt lds
    s_add_u32 s41, s61, 16384
    buffer_load_dwordx4 v18, s[8:11], s41 offen offset:2048 nt lds
    s_add_u32 s41, s61, 24576
    buffer_load_dwordx4 v18, s[8:11], s41 offen offset:3072 nt lds
    s_add_u32 m0, s43, 36864
    s_add_u32 s41, s62, 0
    buffer_load_dwordx4 v18, s[8:11], s41 offen offset:0 nt lds
    s_add_u32 s41, s62, 8192
    buffer_load_dwordx4 v18, s[8:11], s41 offen offset:1024 nt lds
    s_add_u32 s41, s62, 16384
    buffer_load_dwordx4 v18, s[8:11], s41 offen offset:2048 nt lds
    s_add_u32 s41, s62, 24576
    buffer_load_dwordx4 v18, s[8:11], s41 offen offset:3072 nt lds
    s_add_u32 m0, s43, 73728
    s_add_u32 s41, s63, 0
    buffer_load_dwordx4 v18, s[8:11], s41 offen offset:0 nt lds
    s_add_u32 s41, s63, 8192
    buffer_load_dwordx4 v18, s[8:11], s41 offen offset:1024 nt lds
    s_add_u32 s41, s63, 16384
    buffer_load_dwordx4 v18, s[8:11], s41 offen offset:2048 nt lds
    s_add_u32 s41, s63, 24576
    buffer_load_dwordx4 v18, s[8:11], s41 offen offset:3072 nt lds
    v_lshrrev_b32 v49, 1, v48
    v_mul_u32_u24 v19, 1152, v49
    v_and_b32 v49, 1, v48
    v_lshl_add_u32 v19, v49, 4, v19
    s_mul_i32 s41, s13, 224
    s_sub_u32 s41, 1024, s41
    v_add_u32 v19, s41, v19
    v_lshrrev_b32 v49, 4, v48
    v_lshlrev_b32 v50, 2, v49
    v_and_b32 v51, 15, v48
    v_xor_b32 v51, v51, v50
    v_lshlrev_b32 v51, 4, v51
    v_lshl_add_u32 v16, v49, 15, v51
    v_lshrrev_b32 v50, 1, v49
    v_lshl_add_u32 v17, v50, 16, v51
    v_and_b32 v50, 1, v49
    v_lshl_add_u32 v17, v50, 13, v17
    s_lshl_b32 s40, s12, 8
    s_mul_i32 s58, s13, 1048576
    s_add_u32 s58, s58, s40
    s_lshr_b32 s41, s13, 1
    s_mul_i32 s59, s41, 262144
    s_and_b32 s41, s13, 1
    s_lshl_b32 s41, s41, 14
    s_add_u32 s59, s59, s41
    s_add_u32 s59, s59, s40
    s_add_u32 s59, s59, 4194304
    s_lshr_b32 s71, s52, 8
    s_add_u32 s71, s71, s12
    s_and_b32 s71, s71, 3
    v_bfe_u32 v50, v48, 2, 2
    v_xor_b32 v51, s13, v50
    v_lshlrev_b32 v20, 6, v51
    v_and_b32 v51, 3, v48
    v_lshl_add_u32 v20, v51, 4, v20
    v_lshrrev_b32 v23, 2, v48
    v_lshl_add_u32 v20, v23, 8, v20
    s_xor_b32 s41, s43, 0
    v_add_u32 v24, s41, v20
    s_xor_b32 s41, s43, 4096
    v_add_u32 v25, s41, v20
    s_xor_b32 s41, s43, 8192
    v_add_u32 v26, s41, v20
    s_xor_b32 s41, s43, 12288
    v_add_u32 v27, s41, v20
    v_and_b32 v23, 1, v50
    v_lshl_add_u32 v23, v49, 2, v23
    v_lshrrev_b32 v50, 1, v50
    v_lshlrev_b32 v21, 7, v23
    v_lshl_add_u32 v21, v50, 6, v21
    v_lshrrev_b32 v16, 1, v51
    v_lshl_add_u32 v21, v16, 5, v21
    v_and_b32 v16, 1, v51
    v_lshl_add_u32 v21, v16, 3, v21
    v_add_u32 v21, s43, v21
    v_lshlrev_b32 v22, 9, v50
    v_xor_b32 v22, v22, v21
    v_lshlrev_b32 v23, 5, v23
    v_lshl_add_u32 v23, v50, 10, v23
    v_lshl_add_u32 v23, v51, 3, v23
    v_add_u32 v23, s43, v23
    v_bfe_u32 v60, v65, 4, 6
    v_and_b32 v61, 15, v60
    v_lshrrev_b32 v62, 4, v60
    v_mov_b32 v64, 0x4444
    v_mov_b32 v77, 0xeeee
    v_cmp_lt_u32 vcc, 7, v61
    s_nop 1
    v_cndmask_b32 v64, v64, v77, vcc
    v_xor_b32 v66, 1024, v65
    v_xor_b32 v67, 2048, v65
    v_xor_b32 v68, 3072, v65
    v_and_b32 v69, 511, v65
    s_mul_i32 s96, s13, 36864
    s_add_u32 s96, s96, 16384
    v_lshlrev_b32 v70, 4, v60
    v_add_u32 v70, s96, v70
    v_lshrrev_b32 v79, 1, v69
    s_lshl_b32 s96, s13, 8
    s_add_u32 s96, s96, 14336
    s_lshl_b32 s33, s13, 10
    s_add_u32 s97, s33, 8192
    v_mov_b32 v77, s97
    v_mov_b32 v78, s96
    v_cmp_lt_u32 vcc, 31, v60
    s_nop 1
    v_cndmask_b32 v71, v77, v78, vcc
    v_add_u32 v71, v71, v79
    v_and_b32 v77, 7, v61
    v_lshrrev_b32 v78, 3, v61
    v_lshlrev_b32 v74, 4, v77
    v_lshl_add_u32 v73, v62, 7, v74
    v_lshl_add_u32 v73, v78, 3, v73
    s_lshl_b32 s96, s13, 9
    v_add_u32 v73, s96, v73
    v_lshrrev_b32 v74, 1, v74
    v_lshl_add_u32 v74, v78, 14, v74
    v_lshl_add_u32 v74, v62, 15, v74
    s_lshl_b32 s96, s13, 17
    v_add_u32 v74, s96, v74
    v_bfe_u32 v77, v61, 2, 1
    v_and_b32 v78, 3, v61
    s_cmp_lt_u32 s13, 2
    s_cselect_b64 vcc, -1, 0
    v_cndmask_b32 v77, 0, v77, vcc
    v_lshlrev_b32 v75, 7, v77
    v_lshl_add_u32 v75, v62, 4, v75
    v_lshl_add_u32 v75, v78, 2, v75
    v_lshlrev_b32 v58, 3, v77
    v_lshl_add_u32 v58, v78, 1, v58
    s_bfe_u32 s97, s12, 0x10001
    s_lshl_b32 s68, s97, 6
    s_lshl_b32 s97, s97, 2
    v_add_u32 v59, s97, v62
    s_bfe_u32 s96, s12, 0x10002
    s_and_b32 s40, s12, 1
    s_lshl_b32 s96, s96, 1
    s_add_u32 s96, s96, s40
    s_lshr_b32 s97, s12, 3
    s_lshl_b32 s98, s13, 2
    s_add_u32 s98, s98, s97
    s_lshl_b32 s98, s98, 2
    s_add_u32 s98, s98, s96
    s_lshl_b32 s98, s98, 8
    s_lshl_b32 s99, s13, 2
    s_add_u32 s99, s99, s96
    s_lshl_b32 s99, s99, 4
    s_lshl_b32 s41, s97, 1
    s_add_u32 s41, s41, s40
    s_lshl_b32 s41, s41, 7
    s_add_u32 s41, s41, 8192
    s_lshl_b32 s40, s40, 3
    s_add_u32 s40, s40, 512
    s_cmp_lt_u32 s13, 2
    s_cselect_b32 s96, 7, 4
    s_cselect_b32 s98, s98, s41
    s_cselect_b32 s99, s99, s40
    s_cselect_b32 s32, 1, 0
    s_add_u32 s68, s68, s98
    s_lshl_b32 s97, s97, s96
    s_add_u32 s99, s99, s97
    v_add_u32 v58, s99, v58
    s_and_b32 s97, s12, 4
    s_or_b32 s97, s97, s13
    s_cmp_eq_u32 s97, 2
    s_cselect_b32 s32, 2, s32
    s_mov_b32 s8, s48
    s_mov_b32 s9, s49
    s_mov_b32 s10, 9216
    v_mul_u32_u24 v77, 1152, v59
    v_lshl_add_u32 v77, v58, 1, v77
    buffer_load_dword v72, v77, s[8:11], 0 offen
    s_mov_b32 s10, 4718592
    s_waitcnt vmcnt(12) lgkmcnt(0)
    s_barrier
    s_cmp_eq_u32 s71, 1
    s_cbranch_scc1 cf_th0
    s_waitcnt vmcnt(6)
cf_th0:
    s_mov_b64 s[8:9], s[56:57]
    s_add_u32 m0, s43, 110592
    s_add_u32 s41, s42, 0
    buffer_load_dwordx4 v19, s[8:11], s41 offen offset:0 nt lds
    s_add_u32 s41, s42, 35840
    buffer_load_dwordx4 v19, s[8:11], s41 offen offset:1024 nt lds
    s_add_u32 s41, s42, 71680
    buffer_load_dwordx4 v19, s[8:11], s41 offen offset:2048 nt lds
    s_add_u32 s41, s42, 107520
    buffer_load_dwordx4 v19, s[8:11], s41 offen offset:3072 nt lds
    v_add_u32 v77, 147456, v22
    ds_read_b64_tr_b16 v[80:81], v77 offset:0
    ds_read_b64_tr_b16 v[82:83], v77 offset:256
    ds_read_b64_tr_b16 v[84:85], v77 offset:2048
    ds_read_b64_tr_b16 v[86:87], v77 offset:2304
    ds_read_b64_tr_b16 v[112:113], v77 offset:16
    ds_read_b64_tr_b16 v[114:115], v77 offset:272
    ds_read_b64_tr_b16 v[116:117], v77 offset:2064
    ds_read_b64_tr_b16 v[118:119], v77 offset:2320
    s_waitcnt vmcnt(12) lgkmcnt(0)
    s_barrier
    s_cmp_eq_u32 s71, 1
    s_cbranch_scc1 cf_th1
    s_waitcnt vmcnt(6)
cf_th1:
    s_mov_b64 s[8:9], s[52:53]
    s_add_u32 m0, s43, 147456
    s_add_u32 s41, s58, 0
    buffer_load_dwordx4 v17, s[8:11], s41 offen offset:0 nt lds
    s_add_u32 s41, s58, 31744
    buffer_load_dwordx4 v17, s[8:11], s41 offen offset:1024 nt lds
    s_add_u32 s41, s58, 129024
    buffer_load_dwordx4 v17, s[8:11], s41 offen offset:2048 nt lds
    s_add_u32 s41, s58, 160768
    buffer_load_dwordx4 v17, s[8:11], s41 offen offset:3072 nt lds
    v_add_u32 v77, 0, v21
    ds_read_b64_tr_b16 v[88:89], v77 offset:0
    ds_read_b64_tr_b16 v[90:91], v77 offset:256
    ds_read_b64_tr_b16 v[92:93], v77 offset:2048
    ds_read_b64_tr_b16 v[94:95], v77 offset:2304
    ds_read_b64_tr_b16 v[120:121], v77 offset:16
    ds_read_b64_tr_b16 v[122:123], v77 offset:272
    ds_read_b64_tr_b16 v[124:125], v77 offset:2064
    ds_read_b64_tr_b16 v[126:127], v77 offset:2320
    s_waitcnt vmcnt(12) lgkmcnt(0)
    s_barrier
    s_cmp_eq_u32 s71, 1
    s_cbranch_scc1 cf_th2
    s_waitcnt vmcnt(6)
cf_th2:
    s_add_u32 m0, s43, 0
    s_add_u32 s41, s58, 16384
    buffer_load_dwordx4 v17, s[8:11], s41 offen offset:0 nt lds
    s_add_u32 s41, s58, 48128
    buffer_load_dwordx4 v17, s[8:11], s41 offen offset:1024 nt lds
    s_add_u32 s41, s58, 145408
    buffer_load_dwordx4 v17, s[8:11], s41 offen offset:2048 nt lds
    s_add_u32 s41, s58, 177152
    buffer_load_dwordx4 v17, s[8:11], s41 offen offset:3072 nt lds
    v_add_u32 v77, 36864, v21
    ds_read_b64_tr_b16 v[96:97], v77 offset:0
    ds_read_b64_tr_b16 v[98:99], v77 offset:256
    ds_read_b64_tr_b16 v[100:101], v77 offset:2048
    ds_read_b64_tr_b16 v[102:103], v77 offset:2304
    ds_read_b64_tr_b16 v[128:129], v77 offset:16
    ds_read_b64_tr_b16 v[130:131], v77 offset:272
    ds_read_b64_tr_b16 v[132:133], v77 offset:2064
    ds_read_b64_tr_b16 v[134:135], v77 offset:2320
    s_waitcnt vmcnt(12) lgkmcnt(0)
    s_barrier
    s_cmp_eq_u32 s71, 1
    s_cbranch_scc1 cf_th3
    s_waitcnt vmcnt(6)
cf_th3:
    s_mov_b64 s[8:9], s[54:55]
    s_add_u32 m0, s43, 36864
    s_add_u32 s41, s58, 0
    buffer_load_dwordx4 v17, s[8:11], s41 offen offset:0 nt lds
    s_add_u32 s41, s58, 31744
    buffer_load_dwordx4 v17, s[8:11], s41 offen offset:1024 nt lds
    s_add_u32 s41, s58, 129024
    buffer_load_dwordx4 v17, s[8:11], s41 offen offset:2048 nt lds
    s_add_u32 s41, s58, 160768
    buffer_load_dwordx4 v17, s[8:11], s41 offen offset:3072 nt lds
    v_add_u32 v77, 73728, v21
    ds_read_b64_tr_b16 v[104:105], v77 offset:0
    ds_read_b64_tr_b16 v[106:107], v77 offset:256
    ds_read_b64_tr_b16 v[108:109], v77 offset:2048
    ds_read_b64_tr_b16 v[110:111], v77 offset:2304
    ds_read_b64_tr_b16 v[136:137], v77 offset:16
    ds_read_b64_tr_b16 v[138:139], v77 offset:272
    ds_read_b64_tr_b16 v[140:141], v77 offset:2064
    ds_read_b64_tr_b16 v[142:143], v77 offset:2320
    s_waitcnt vmcnt(12) lgkmcnt(0)
    s_barrier
    s_cmp_eq_u32 s71, 1
    s_cbranch_scc1 cf_th4
    s_waitcnt vmcnt(6)
cf_th4:
    s_add_u32 m0, s43, 73728
    s_add_u32 s41, s58, 16384
    buffer_load_dwordx4 v17, s[8:11], s41 offen offset:0 nt lds
    s_add_u32 s41, s58, 48128
    buffer_load_dwordx4 v17, s[8:11], s41 offen offset:1024 nt lds
    s_add_u32 s41, s58, 145408
    buffer_load_dwordx4 v17, s[8:11], s41 offen offset:2048 nt lds
    s_add_u32 s41, s58, 177152
    buffer_load_dwordx4 v17, s[8:11], s41 offen offset:3072 nt lds
    v_add_u32 v77, 110592, v23
    ds_read_b64_tr_b16 v[0:1], v77 offset:0
    ds_read_b64_tr_b16 v[2:3], v77 offset:64
    ds_read_b64_tr_b16 v[4:5], v77 offset:512
    ds_read_b64_tr_b16 v[6:7], v77 offset:576
    ds_read_b64_tr_b16 v[8:9], v77 offset:2048
    ds_read_b64_tr_b16 v[10:11], v77 offset:2112
    ds_read_b64_tr_b16 v[12:13], v77 offset:2560
    ds_read_b64_tr_b16 v[14:15], v77 offset:2624
    s_waitcnt vmcnt(12) lgkmcnt(0)
    s_barrier
    s_cmp_eq_u32 s71, 1
    s_cbranch_scc1 cf_th5
    s_waitcnt vmcnt(6)
cf_th5:
    s_mov_b64 s[8:9], s[50:51]
    s_add_u32 m0, s43, 110592
    s_add_u32 s41, s58, 0
    buffer_load_dwordx4 v17, s[8:11], s41 offen offset:0 nt lds
    s_add_u32 s41, s58, 31744
    buffer_load_dwordx4 v17, s[8:11], s41 offen offset:1024 nt lds
    s_add_u32 s41, s58, 129024
    buffer_load_dwordx4 v17, s[8:11], s41 offen offset:2048 nt lds
    s_add_u32 s41, s58, 160768
    buffer_load_dwordx4 v17, s[8:11], s41 offen offset:3072 nt lds
    s_cmp_eq_u32 s32, 0
    s_cbranch_scc1 cf_init_done
    v_mov_b32 v52, 1
    v_mov_b32 v53, 1
    v_mov_b32 v54, 1
    v_mov_b32 v55, 1
    v_mov_b32 v56, 0
    s_lshl_b32 s96, s12, 14
    s_add_u32 s96, s96, 68157440
    s_add_u32 s97, s96, 0
    buffer_store_dwordx4 v[52:55], v65, s[4:7], s97 offen
    buffer_load_dwordx4 v[60:63], v65, s[4:7], s97 offen sc1
    s_add_u32 s97, s96, 4096
    buffer_store_dwordx4 v[52:55], v65, s[4:7], s97 offen
    buffer_load_dwordx4 v[60:63], v65, s[4:7], s97 offen sc1
    s_add_u32 s97, s96, 8192
    buffer_store_dwordx4 v[52:55], v65, s[4:7], s97 offen
    buffer_load_dwordx4 v[60:63], v65, s[4:7], s97 offen sc1
    s_add_u32 s97, s96, 12288
    buffer_store_dwordx4 v[52:55], v65, s[4:7], s97 offen
    buffer_load_dwordx4 v[60:63], v65, s[4:7], s97 offen sc1
    s_add_u32 s96, s68, 67108864
    s_add_u32 s97, s96, 16384
    buffer_store_dword v56, v75, s[4:7], s96 offen offset:0
    buffer_store_dword v72, v75, s[4:7], s97 offen offset:0
    buffer_load_dword v60, v75, s[4:7], s96 offen offset:0 sc1
    buffer_load_dword v60, v75, s[4:7], s97 offen offset:0 sc1
    s_cmp_lg_u32 s32, 2
    s_cbranch_scc1 cf_init_done
    buffer_store_dword v56, v75, s[4:7], s96 offen offset:1024
    buffer_store_dword v72, v75, s[4:7], s97 offen offset:1024
    buffer_load_dword v60, v75, s[4:7], s96 offen offset:1024 sc1
    buffer_load_dword v60, v75, s[4:7], s97 offen offset:1024 sc1
    buffer_store_dword v56, v75, s[4:7], s96 offen offset:2048
    buffer_store_dword v72, v75, s[4:7], s97 offen offset:2048
    buffer_load_dword v60, v75, s[4:7], s96 offen offset:2048 sc1
    buffer_load_dword v60, v75, s[4:7], s97 offen offset:2048 sc1
    buffer_store_dword v56, v75, s[4:7], s96 offen offset:3072
    buffer_store_dword v72, v75, s[4:7], s97 offen offset:3072
    buffer_load_dword v60, v75, s[4:7], s96 offen offset:3072 sc1
    buffer_load_dword v60, v75, s[4:7], s97 offen offset:3072 sc1
cf_init_done:
    ds_write_b64 v70, v[0:1] offset:16384
    ds_write_b64 v70, v[2:3] offset:16392
    ds_write_b64 v70, v[4:5] offset:17408
    ds_write_b64 v70, v[6:7] offset:17416
    ds_write_b64 v70, v[8:9] offset:18432
    ds_write_b64 v70, v[10:11] offset:18440
    ds_write_b64 v70, v[12:13] offset:19456
    ds_write_b64 v70, v[14:15] offset:19464
    v_add_u32 v28, 147456, v24
    v_add_u32 v29, 147456, v25
    v_add_u32 v30, 147456, v26
    v_add_u32 v31, 147456, v27
    ds_read_b64_tr_b16 a[96:97], v28 offset:0
    ds_read_b64_tr_b16 a[104:105], v28 offset:8
    ds_read_b64_tr_b16 a[112:113], v29 offset:0
    ds_read_b64_tr_b16 a[120:121], v29 offset:8
    ds_read_b64_tr_b16 a[128:129], v30 offset:0
    ds_read_b64_tr_b16 a[136:137], v30 offset:8
    ds_read_b64_tr_b16 a[144:145], v31 offset:0
    ds_read_b64_tr_b16 v[32:33], v31 offset:8
    s_waitcnt vmcnt(12) lgkmcnt(0)
    s_barrier
    s_cmp_eq_u32 s71, 1
    s_cbranch_scc1 cf_th6
    s_waitcnt vmcnt(6)
cf_th6:
    s_add_u32 m0, s43, 147456
    s_add_u32 s41, s58, 16384
    buffer_load_dwordx4 v17, s[8:11], s41 offen offset:0 nt lds
    s_add_u32 s41, s58, 48128
    buffer_load_dwordx4 v17, s[8:11], s41 offen offset:1024 nt lds
    s_add_u32 s41, s58, 145408
    buffer_load_dwordx4 v17, s[8:11], s41 offen offset:2048 nt lds
    s_add_u32 s41, s58, 177152
    buffer_load_dwordx4 v17, s[8:11], s41 offen offset:3072 nt lds
    ds_write_b64 v70, v[32:33] offset:12288
    v_add_u32 v28, 0, v24
    v_add_u32 v29, 0, v25
    v_add_u32 v30, 0, v26
    v_add_u32 v31, 0, v27
    ds_read_b64_tr_b16 a[98:99], v28 offset:0
    ds_read_b64_tr_b16 a[106:107], v28 offset:8
    ds_read_b64_tr_b16 a[114:115], v29 offset:0
    ds_read_b64_tr_b16 a[122:123], v29 offset:8
    ds_read_b64_tr_b16 a[130:131], v30 offset:0
    ds_read_b64_tr_b16 a[138:139], v30 offset:8
    ds_read_b64_tr_b16 a[146:147], v31 offset:0
    ds_read_b64_tr_b16 v[0:1], v31 offset:8
    s_waitcnt vmcnt(12) lgkmcnt(0)
    s_barrier
    s_cmp_eq_u32 s71, 1
    s_cbranch_scc1 cf_th7
    s_waitcnt vmcnt(6)
cf_th7:
    s_mov_b64 s[8:9], s[52:53]
    s_add_u32 m0, s43, 0
    s_add_u32 s41, s58, 262144
    buffer_load_dwordx4 v17, s[8:11], s41 offen offset:0 nt lds
    s_add_u32 s41, s58, 293888
    buffer_load_dwordx4 v17, s[8:11], s41 offen offset:1024 nt lds
    s_add_u32 s41, s58, 391168
    buffer_load_dwordx4 v17, s[8:11], s41 offen offset:2048 nt lds
    s_add_u32 s41, s58, 422912
    buffer_load_dwordx4 v17, s[8:11], s41 offen offset:3072 nt lds
    ds_write_b64 v70, v[0:1] offset:12296
    v_add_u32 v28, 36864, v24
    v_add_u32 v29, 36864, v25
    v_add_u32 v30, 36864, v26
    v_add_u32 v31, 36864, v27
    ds_read_b64_tr_b16 a[232:233], v28 offset:0
    ds_read_b64_tr_b16 v[32:33], v28 offset:8
    ds_read_b64_tr_b16 a[240:241], v29 offset:0
    ds_read_b64_tr_b16 a[248:249], v29 offset:8
    ds_read_b64_tr_b16 v[144:145], v30 offset:0
    ds_read_b64_tr_b16 v[152:153], v30 offset:8
    ds_read_b64_tr_b16 v[160:161], v31 offset:0
    ds_read_b64_tr_b16 v[168:169], v31 offset:8
    s_waitcnt vmcnt(12) lgkmcnt(0)
    s_barrier
    s_cmp_eq_u32 s71, 1
    s_cbranch_scc1 cf_th8
    s_waitcnt vmcnt(6)
cf_th8:
    s_add_u32 m0, s43, 36864
    s_add_u32 s41, s58, 278528
    buffer_load_dwordx4 v17, s[8:11], s41 offen offset:0 nt lds
    s_add_u32 s41, s58, 310272
    buffer_load_dwordx4 v17, s[8:11], s41 offen offset:1024 nt lds
    s_add_u32 s41, s58, 407552
    buffer_load_dwordx4 v17, s[8:11], s41 offen offset:2048 nt lds
    s_add_u32 s41, s58, 439296
    buffer_load_dwordx4 v17, s[8:11], s41 offen offset:3072 nt lds
    ds_write_b64 v70, v[32:33] offset:8192
    v_add_u32 v28, 73728, v24
    v_add_u32 v29, 73728, v25
    v_add_u32 v30, 73728, v26
    v_add_u32 v31, 73728, v27
    ds_read_b64_tr_b16 a[234:235], v28 offset:0
    ds_read_b64_tr_b16 v[0:1], v28 offset:8
    ds_read_b64_tr_b16 a[242:243], v29 offset:0
    ds_read_b64_tr_b16 a[250:251], v29 offset:8
    ds_read_b64_tr_b16 v[146:147], v30 offset:0
    ds_read_b64_tr_b16 v[154:155], v30 offset:8
    ds_read_b64_tr_b16 v[162:163], v31 offset:0
    ds_read_b64_tr_b16 v[170:171], v31 offset:8
    s_waitcnt vmcnt(12) lgkmcnt(0)
    s_barrier
    s_cmp_eq_u32 s71, 1
    s_cbranch_scc1 cf_th9
    s_waitcnt vmcnt(6)
cf_th9:
    s_mov_b64 s[8:9], s[54:55]
    s_add_u32 m0, s43, 73728
    s_add_u32 s41, s58, 262144
    buffer_load_dwordx4 v17, s[8:11], s41 offen offset:0 nt lds
    s_add_u32 s41, s58, 293888
    buffer_load_dwordx4 v17, s[8:11], s41 offen offset:1024 nt lds
    s_add_u32 s41, s58, 391168
    buffer_load_dwordx4 v17, s[8:11], s41 offen offset:2048 nt lds
    s_add_u32 s41, s58, 422912
    buffer_load_dwordx4 v17, s[8:11], s41 offen offset:3072 nt lds
    ds_write_b64 v70, v[0:1] offset:8200
    v_add_u32 v28, 110592, v24
    v_add_u32 v29, 110592, v25
    v_add_u32 v30, 110592, v26
    v_add_u32 v31, 110592, v27
    ds_read_b64_tr_b16 v[32:33], v28 offset:0
    ds_read_b64_tr_b16 v[34:35], v28 offset:8
    ds_read_b64_tr_b16 v[36:37], v29 offset:0
    ds_read_b64_tr_b16 v[38:39], v29 offset:8
    ds_read_b64_tr_b16 a[0:1], v30 offset:0
    ds_read_b64_tr_b16 v[40:41], v30 offset:8
    ds_read_b64_tr_b16 a[8:9], v31 offset:0
    ds_read_b64_tr_b16 v[42:43], v31 offset:8
    s_waitcnt vmcnt(12) lgkmcnt(0)
    s_barrier
    s_cmp_eq_u32 s71, 1
    s_cbranch_scc1 cf_th10
    s_waitcnt vmcnt(6)
cf_th10:
    s_add_u32 m0, s43, 110592
    s_add_u32 s41, s58, 278528
    buffer_load_dwordx4 v17, s[8:11], s41 offen offset:0 nt lds
    s_add_u32 s41, s58, 310272
    buffer_load_dwordx4 v17, s[8:11], s41 offen offset:1024 nt lds
    s_add_u32 s41, s58, 407552
    buffer_load_dwordx4 v17, s[8:11], s41 offen offset:2048 nt lds
    s_add_u32 s41, s58, 439296
    buffer_load_dwordx4 v17, s[8:11], s41 offen offset:3072 nt lds
    s_cmp_lg_u32 s13, 0
    s_cbranch_scc1 cf_ma
    v_mov_b32 v54, 1
    s_mov_b64 exec, 1
    buffer_atomic_add v54, off, s[84:87], 0 offset:132
    s_mov_b64 exec, -1
cf_ma:
    ds_write_b64 v70, v[32:33] offset:0
    ds_write_b64 v70, v[34:35] offset:2048
    ds_write_b64 v70, v[36:37] offset:4096
    ds_write_b64 v70, v[38:39] offset:6144
    ds_write_b64 v70, v[40:41] offset:10240
    ds_write_b64 v70, v[42:43] offset:14336
    v_add_u32 v28, 147456, v24
    v_add_u32 v29, 147456, v25
    v_add_u32 v30, 147456, v26
    v_add_u32 v31, 147456, v27
    ds_read_b64_tr_b16 v[0:1], v28 offset:0
    ds_read_b64_tr_b16 v[2:3], v28 offset:8
    ds_read_b64_tr_b16 v[4:5], v29 offset:0
    ds_read_b64_tr_b16 v[6:7], v29 offset:8
    ds_read_b64_tr_b16 a[2:3], v30 offset:0
    ds_read_b64_tr_b16 v[8:9], v30 offset:8
    ds_read_b64_tr_b16 a[10:11], v31 offset:0
    ds_read_b64_tr_b16 v[10:11], v31 offset:8
    s_waitcnt vmcnt(12) lgkmcnt(0)
    s_barrier
    s_cmp_eq_u32 s71, 1
    s_cbranch_scc1 cf_th11
    s_waitcnt vmcnt(6)
cf_th11:
    s_mov_b64 s[8:9], s[50:51]
    s_add_u32 m0, s43, 147456
    s_add_u32 s41, s58, 262144
    buffer_load_dwordx4 v17, s[8:11], s41 offen offset:0 nt lds
    s_add_u32 s41, s58, 293888
    buffer_load_dwordx4 v17, s[8:11], s41 offen offset:1024 nt lds
    s_add_u32 s41, s58, 391168
    buffer_load_dwordx4 v17, s[8:11], s41 offen offset:2048 nt lds
    s_add_u32 s41, s58, 422912
    buffer_load_dwordx4 v17, s[8:11], s41 offen offset:3072 nt lds
    ds_write_b64 v70, v[0:1] offset:8
    ds_write_b64 v70, v[2:3] offset:2056
    ds_write_b64 v70, v[4:5] offset:4104
    ds_write_b64 v70, v[6:7] offset:6152
    ds_write_b64 v70, v[8:9] offset:10248
    ds_write_b64 v70, v[10:11] offset:14344
    v_add_u32 v28, 0, v24
    v_add_u32 v29, 0, v25
    v_add_u32 v30, 0, v26
    v_add_u32 v31, 0, v27
    ds_read_b64_tr_b16 a[100:101], v28 offset:0
    ds_read_b64_tr_b16 a[108:109], v28 offset:8
    ds_read_b64_tr_b16 a[116:117], v29 offset:0
    ds_read_b64_tr_b16 a[124:125], v29 offset:8
    ds_read_b64_tr_b16 a[132:133], v30 offset:0
    ds_read_b64_tr_b16 a[140:141], v30 offset:8
    ds_read_b64_tr_b16 a[148:149], v31 offset:0
    ds_read_b64_tr_b16 v[32:33], v31 offset:8
    s_waitcnt vmcnt(12) lgkmcnt(0)
    s_barrier
    s_cmp_eq_u32 s71, 1
    s_cbranch_scc1 cf_th12
    s_waitcnt vmcnt(6)
cf_th12:
    s_add_u32 m0, s43, 0
    s_add_u32 s41, s58, 278528
    buffer_load_dwordx4 v17, s[8:11], s41 offen offset:0 nt lds
    s_add_u32 s41, s58, 310272
    buffer_load_dwordx4 v17, s[8:11], s41 offen offset:1024 nt lds
    s_add_u32 s41, s58, 407552
    buffer_load_dwordx4 v17, s[8:11], s41 offen offset:2048 nt lds
    s_add_u32 s41, s58, 439296
    buffer_load_dwordx4 v17, s[8:11], s41 offen offset:3072 nt lds
    ds_write_b64 v70, v[32:33] offset:13312
    v_add_u32 v28, 36864, v24
    v_add_u32 v29, 36864, v25
    v_add_u32 v30, 36864, v26
    v_add_u32 v31, 36864, v27
    ds_read_b64_tr_b16 a[102:103], v28 offset:0
    ds_read_b64_tr_b16 a[110:111], v28 offset:8
    ds_read_b64_tr_b16 a[118:119], v29 offset:0
    ds_read_b64_tr_b16 a[126:127], v29 offset:8
    ds_read_b64_tr_b16 a[134:135], v30 offset:0
    ds_read_b64_tr_b16 a[142:143], v30 offset:8
    ds_read_b64_tr_b16 a[150:151], v31 offset:0
    ds_read_b64_tr_b16 v[0:1], v31 offset:8
    s_waitcnt vmcnt(12) lgkmcnt(0)
    s_barrier
    s_cmp_eq_u32 s71, 1
    s_cbranch_scc1 cf_th13
    s_waitcnt vmcnt(6)
cf_th13:
    s_mov_b64 s[8:9], s[52:53]
    s_add_u32 m0, s43, 36864
    s_add_u32 s41, s58, 524288
    buffer_load_dwordx4 v17, s[8:11], s41 offen offset:0 nt lds
    s_add_u32 s41, s58, 556032
    buffer_load_dwordx4 v17, s[8:11], s41 offen offset:1024 nt lds
    s_add_u32 s41, s58, 653312
    buffer_load_dwordx4 v17, s[8:11], s41 offen offset:2048 nt lds
    s_add_u32 s41, s58, 685056
    buffer_load_dwordx4 v17, s[8:11], s41 offen offset:3072 nt lds
    ds_write_b64 v70, v[0:1] offset:13320
    v_add_u32 v28, 73728, v24
    v_add_u32 v29, 73728, v25
    v_add_u32 v30, 73728, v26
    v_add_u32 v31, 73728, v27
    ds_read_b64_tr_b16 a[236:237], v28 offset:0
    ds_read_b64_tr_b16 v[32:33], v28 offset:8
    ds_read_b64_tr_b16 a[244:245], v29 offset:0
    ds_read_b64_tr_b16 a[252:253], v29 offset:8
    ds_read_b64_tr_b16 v[148:149], v30 offset:0
    ds_read_b64_tr_b16 v[156:157], v30 offset:8
    ds_read_b64_tr_b16 v[164:165], v31 offset:0
    ds_read_b64_tr_b16 v[172:173], v31 offset:8
    s_waitcnt vmcnt(12) lgkmcnt(0)
    s_barrier
    s_cmp_eq_u32 s71, 1
    s_cbranch_scc1 cf_th14
    s_waitcnt vmcnt(6)
cf_th14:
    s_add_u32 m0, s43, 73728
    s_add_u32 s41, s58, 540672
    buffer_load_dwordx4 v17, s[8:11], s41 offen offset:0 nt lds
    s_add_u32 s41, s58, 572416
    buffer_load_dwordx4 v17, s[8:11], s41 offen offset:1024 nt lds
    s_add_u32 s41, s58, 669696
    buffer_load_dwordx4 v17, s[8:11], s41 offen offset:2048 nt lds
    s_add_u32 s41, s58, 701440
    buffer_load_dwordx4 v17, s[8:11], s41 offen offset:3072 nt lds
    ds_write_b64 v70, v[32:33] offset:9216
    v_add_u32 v28, 110592, v24
    v_add_u32 v29, 110592, v25
    v_add_u32 v30, 110592, v26
    v_add_u32 v31, 110592, v27
    ds_read_b64_tr_b16 a[238:239], v28 offset:0
    ds_read_b64_tr_b16 v[0:1], v28 offset:8
    ds_read_b64_tr_b16 a[246:247], v29 offset:0
    ds_read_b64_tr_b16 a[254:255], v29 offset:8
    ds_read_b64_tr_b16 v[150:151], v30 offset:0
    ds_read_b64_tr_b16 v[158:159], v30 offset:8
    ds_read_b64_tr_b16 v[166:167], v31 offset:0
    ds_read_b64_tr_b16 v[174:175], v31 offset:8
    s_waitcnt vmcnt(12) lgkmcnt(0)
    s_barrier
    s_cmp_eq_u32 s71, 1
    s_cbranch_scc1 cf_th15
    s_waitcnt vmcnt(6)
cf_th15:
    s_mov_b64 s[8:9], s[54:55]
    s_add_u32 m0, s43, 110592
    s_add_u32 s41, s58, 524288
    buffer_load_dwordx4 v17, s[8:11], s41 offen offset:0 nt lds
    s_add_u32 s41, s58, 556032
    buffer_load_dwordx4 v17, s[8:11], s41 offen offset:1024 nt lds
    s_add_u32 s41, s58, 653312
    buffer_load_dwordx4 v17, s[8:11], s41 offen offset:2048 nt lds
    s_add_u32 s41, s58, 685056
    buffer_load_dwordx4 v17, s[8:11], s41 offen offset:3072 nt lds
    ds_write_b64 v70, v[0:1] offset:9224
    v_add_u32 v28, 147456, v24
    v_add_u32 v29, 147456, v25
    v_add_u32 v30, 147456, v26
    v_add_u32 v31, 147456, v27
    ds_read_b64_tr_b16 v[32:33], v28 offset:0
    ds_read_b64_tr_b16 v[34:35], v28 offset:8
    ds_read_b64_tr_b16 v[36:37], v29 offset:0
    ds_read_b64_tr_b16 v[38:39], v29 offset:8
    ds_read_b64_tr_b16 a[4:5], v30 offset:0
    ds_read_b64_tr_b16 v[40:41], v30 offset:8
    ds_read_b64_tr_b16 a[12:13], v31 offset:0
    ds_read_b64_tr_b16 v[42:43], v31 offset:8
    s_waitcnt vmcnt(12) lgkmcnt(0)
    s_barrier
    s_cmp_eq_u32 s71, 1
    s_cbranch_scc1 cf_th16
    s_waitcnt vmcnt(6)
cf_th16:
    s_add_u32 m0, s43, 147456
    s_add_u32 s41, s58, 540672
    buffer_load_dwordx4 v17, s[8:11], s41 offen offset:0 nt lds
    s_add_u32 s41, s58, 572416
    buffer_load_dwordx4 v17, s[8:11], s41 offen offset:1024 nt lds
    s_add_u32 s41, s58, 669696
    buffer_load_dwordx4 v17, s[8:11], s41 offen offset:2048 nt lds
    s_add_u32 s41, s58, 701440
    buffer_load_dwordx4 v17, s[8:11], s41 offen offset:3072 nt lds
    ds_write_b64 v70, v[32:33] offset:1024
    ds_write_b64 v70, v[34:35] offset:3072
    ds_write_b64 v70, v[36:37] offset:5120
    ds_write_b64 v70, v[38:39] offset:7168
    ds_write_b64 v70, v[40:41] offset:11264
    ds_write_b64 v70, v[42:43] offset:15360
    v_add_u32 v28, 0, v24
    v_add_u32 v29, 0, v25
    v_add_u32 v30, 0, v26
    v_add_u32 v31, 0, v27
    ds_read_b64_tr_b16 v[0:1], v28 offset:0
    ds_read_b64_tr_b16 v[2:3], v28 offset:8
    ds_read_b64_tr_b16 v[4:5], v29 offset:0
    ds_read_b64_tr_b16 v[6:7], v29 offset:8
    ds_read_b64_tr_b16 a[6:7], v30 offset:0
    ds_read_b64_tr_b16 v[8:9], v30 offset:8
    ds_read_b64_tr_b16 a[14:15], v31 offset:0
    ds_read_b64_tr_b16 v[10:11], v31 offset:8
    s_waitcnt vmcnt(12) lgkmcnt(0)
    s_barrier
    s_cmp_eq_u32 s71, 1
    s_cbranch_scc1 cf_th17
    s_waitcnt vmcnt(6)
cf_th17:
    s_mov_b64 s[8:9], s[50:51]
    s_add_u32 m0, s43, 0
    s_add_u32 s41, s58, 524288
    buffer_load_dwordx4 v17, s[8:11], s41 offen offset:0 nt lds
    s_add_u32 s41, s58, 556032
    buffer_load_dwordx4 v17, s[8:11], s41 offen offset:1024 nt lds
    s_add_u32 s41, s58, 653312
    buffer_load_dwordx4 v17, s[8:11], s41 offen offset:2048 nt lds
    s_add_u32 s41, s58, 685056
    buffer_load_dwordx4 v17, s[8:11], s41 offen offset:3072 nt lds
    ds_write_b64 v70, v[0:1] offset:1032
    ds_write_b64 v70, v[2:3] offset:3080
    ds_write_b64 v70, v[4:5] offset:5128
    ds_write_b64 v70, v[6:7] offset:7176
    ds_write_b64 v70, v[8:9] offset:11272
    ds_write_b64 v70, v[10:11] offset:15368
    v_add_u32 v28, 36864, v24
    v_add_u32 v29, 36864, v25
    v_add_u32 v30, 36864, v26
    v_add_u32 v31, 36864, v27
    ds_read_b64_tr_b16 a[152:153], v28 offset:0
    ds_read_b64_tr_b16 a[160:161], v28 offset:8
    ds_read_b64_tr_b16 a[168:169], v29 offset:0
    ds_read_b64_tr_b16 a[176:177], v29 offset:8
    ds_read_b64_tr_b16 a[184:185], v30 offset:0
    ds_read_b64_tr_b16 a[192:193], v30 offset:8
    ds_read_b64_tr_b16 a[200:201], v31 offset:0
    ds_read_b64_tr_b16 a[208:209], v31 offset:8
    s_waitcnt vmcnt(12) lgkmcnt(0)
    s_barrier
    s_cmp_eq_u32 s71, 1
    s_cbranch_scc1 cf_th18
    s_waitcnt vmcnt(6)
cf_th18:
    s_add_u32 m0, s43, 36864
    s_add_u32 s41, s58, 540672
    buffer_load_dwordx4 v17, s[8:11], s41 offen offset:0 nt lds
    s_add_u32 s41, s58, 572416
    buffer_load_dwordx4 v17, s[8:11], s41 offen offset:1024 nt lds
    s_add_u32 s41, s58, 669696
    buffer_load_dwordx4 v17, s[8:11], s41 offen offset:2048 nt lds
    s_add_u32 s41, s58, 701440
    buffer_load_dwordx4 v17, s[8:11], s41 offen offset:3072 nt lds
    v_add_u32 v28, 73728, v24
    v_add_u32 v29, 73728, v25
    v_add_u32 v30, 73728, v26
    v_add_u32 v31, 73728, v27
    ds_read_b64_tr_b16 a[154:155], v28 offset:0
    ds_read_b64_tr_b16 a[162:163], v28 offset:8
    ds_read_b64_tr_b16 a[170:171], v29 offset:0
    ds_read_b64_tr_b16 a[178:179], v29 offset:8
    ds_read_b64_tr_b16 a[186:187], v30 offset:0
    ds_read_b64_tr_b16 a[194:195], v30 offset:8
    ds_read_b64_tr_b16 a[202:203], v31 offset:0
    ds_read_b64_tr_b16 a[210:211], v31 offset:8
    s_waitcnt vmcnt(12) lgkmcnt(0)
    s_barrier
    s_cmp_eq_u32 s71, 1
    s_cbranch_scc1 cf_th19
    s_waitcnt vmcnt(6)
cf_th19:
    s_mov_b64 s[8:9], s[52:53]
    s_add_u32 m0, s43, 73728
    s_add_u32 s41, s58, 786432
    buffer_load_dwordx4 v17, s[8:11], s41 offen offset:0 nt lds
    s_add_u32 s41, s58, 818176
    buffer_load_dwordx4 v17, s[8:11], s41 offen offset:1024 nt lds
    s_add_u32 s41, s58, 915456
    buffer_load_dwordx4 v17, s[8:11], s41 offen offset:2048 nt lds
    s_add_u32 s41, s58, 947200
    buffer_load_dwordx4 v17, s[8:11], s41 offen offset:3072 nt lds
    v_add_u32 v28, 110592, v24
    v_add_u32 v29, 110592, v25
    v_add_u32 v30, 110592, v26
    v_add_u32 v31, 110592, v27
    ds_read_b64_tr_b16 v[176:177], v28 offset:0
    ds_read_b64_tr_b16 v[184:185], v28 offset:8
    ds_read_b64_tr_b16 v[192:193], v29 offset:0
    ds_read_b64_tr_b16 v[200:201], v29 offset:8
    ds_read_b64_tr_b16 v[208:209], v30 offset:0
    ds_read_b64_tr_b16 v[216:217], v30 offset:8
    ds_read_b64_tr_b16 v[224:225], v31 offset:0
    ds_read_b64_tr_b16 v[232:233], v31 offset:8
    s_waitcnt vmcnt(12) lgkmcnt(0)
    s_barrier
    s_cmp_eq_u32 s71, 1
    s_cbranch_scc1 cf_th20
    s_waitcnt vmcnt(6)
cf_th20:
    s_add_u32 m0, s43, 110592
    s_add_u32 s41, s58, 802816
    buffer_load_dwordx4 v17, s[8:11], s41 offen offset:0 nt lds
    s_add_u32 s41, s58, 834560
    buffer_load_dwordx4 v17, s[8:11], s41 offen offset:1024 nt lds
    s_add_u32 s41, s58, 931840
    buffer_load_dwordx4 v17, s[8:11], s41 offen offset:2048 nt lds
    s_add_u32 s41, s58, 963584
    buffer_load_dwordx4 v17, s[8:11], s41 offen offset:3072 nt lds
    v_add_u32 v28, 147456, v24
    v_add_u32 v29, 147456, v25
    v_add_u32 v30, 147456, v26
    v_add_u32 v31, 147456, v27
    ds_read_b64_tr_b16 v[178:179], v28 offset:0
    ds_read_b64_tr_b16 v[186:187], v28 offset:8
    ds_read_b64_tr_b16 v[194:195], v29 offset:0
    ds_read_b64_tr_b16 v[202:203], v29 offset:8
    ds_read_b64_tr_b16 v[210:211], v30 offset:0
    ds_read_b64_tr_b16 v[218:219], v30 offset:8
    ds_read_b64_tr_b16 v[226:227], v31 offset:0
    ds_read_b64_tr_b16 v[234:235], v31 offset:8
    s_waitcnt vmcnt(12) lgkmcnt(0)
    s_barrier
    s_cmp_eq_u32 s71, 1
    s_cbranch_scc1 cf_th21
    s_waitcnt vmcnt(6)
cf_th21:
    s_mov_b64 s[8:9], s[54:55]
    s_add_u32 m0, s43, 147456
    s_add_u32 s41, s58, 786432
    buffer_load_dwordx4 v17, s[8:11], s41 offen offset:0 nt lds
    s_add_u32 s41, s58, 818176
    buffer_load_dwordx4 v17, s[8:11], s41 offen offset:1024 nt lds
    s_add_u32 s41, s58, 915456
    buffer_load_dwordx4 v17, s[8:11], s41 offen offset:2048 nt lds
    s_add_u32 s41, s58, 947200
    buffer_load_dwordx4 v17, s[8:11], s41 offen offset:3072 nt lds
    v_add_u32 v28, 0, v24
    v_add_u32 v29, 0, v25
    v_add_u32 v30, 0, v26
    v_add_u32 v31, 0, v27
    ds_read_b64_tr_b16 a[16:17], v28 offset:0
    ds_read_b64_tr_b16 a[24:25], v28 offset:8
    ds_read_b64_tr_b16 a[32:33], v29 offset:0
    ds_read_b64_tr_b16 a[40:41], v29 offset:8
    ds_read_b64_tr_b16 a[48:49], v30 offset:0
    ds_read_b64_tr_b16 a[56:57], v30 offset:8
    ds_read_b64_tr_b16 a[64:65], v31 offset:0
    ds_read_b64_tr_b16 a[72:73], v31 offset:8
    s_waitcnt vmcnt(12) lgkmcnt(0)
    s_barrier
    s_cmp_eq_u32 s71, 1
    s_cbranch_scc1 cf_th22
    s_waitcnt vmcnt(6)
cf_th22:
    s_add_u32 m0, s43, 0
    s_add_u32 s41, s58, 802816
    buffer_load_dwordx4 v17, s[8:11], s41 offen offset:0 nt lds
    s_add_u32 s41, s58, 834560
    buffer_load_dwordx4 v17, s[8:11], s41 offen offset:1024 nt lds
    s_add_u32 s41, s58, 931840
    buffer_load_dwordx4 v17, s[8:11], s41 offen offset:2048 nt lds
    s_add_u32 s41, s58, 963584
    buffer_load_dwordx4 v17, s[8:11], s41 offen offset:3072 nt lds
    buffer_load_dword v54, off, s[84:87], 0 offset:132 sc1
    buffer_load_dword v55, off, s[84:87], 0 offset:216 sc1
    v_add_u32 v28, 36864, v24
    v_add_u32 v29, 36864, v25
    v_add_u32 v30, 36864, v26
    v_add_u32 v31, 36864, v27
    ds_read_b64_tr_b16 a[18:19], v28 offset:0
    ds_read_b64_tr_b16 a[26:27], v28 offset:8
    ds_read_b64_tr_b16 a[34:35], v29 offset:0
    ds_read_b64_tr_b16 a[42:43], v29 offset:8
    ds_read_b64_tr_b16 a[50:51], v30 offset:0
    ds_read_b64_tr_b16 a[58:59], v30 offset:8
    ds_read_b64_tr_b16 a[66:67], v31 offset:0
    ds_read_b64_tr_b16 a[74:75], v31 offset:8
    s_waitcnt vmcnt(12) lgkmcnt(0)
    s_barrier
    s_cmp_eq_u32 s71, 1
    s_cbranch_scc1 cf_th23
    s_waitcnt vmcnt(6)
cf_th23:
    s_mov_b64 s[8:9], s[50:51]
    s_add_u32 m0, s43, 36864
    s_add_u32 s41, s58, 786432
    buffer_load_dwordx4 v17, s[8:11], s41 offen offset:0 nt lds
    s_add_u32 s41, s58, 818176
    buffer_load_dwordx4 v17, s[8:11], s41 offen offset:1024 nt lds
    s_add_u32 s41, s58, 915456
    buffer_load_dwordx4 v17, s[8:11], s41 offen offset:2048 nt lds
    s_add_u32 s41, s58, 947200
    buffer_load_dwordx4 v17, s[8:11], s41 offen offset:3072 nt lds
    v_add_u32 v28, 73728, v24
    v_add_u32 v29, 73728, v25
    v_add_u32 v30, 73728, v26
    v_add_u32 v31, 73728, v27
    ds_read_b64_tr_b16 a[156:157], v28 offset:0
    ds_read_b64_tr_b16 a[164:165], v28 offset:8
    ds_read_b64_tr_b16 a[172:173], v29 offset:0
    ds_read_b64_tr_b16 a[180:181], v29 offset:8
    ds_read_b64_tr_b16 a[188:189], v30 offset:0
    ds_read_b64_tr_b16 a[196:197], v30 offset:8
    ds_read_b64_tr_b16 a[204:205], v31 offset:0
    ds_read_b64_tr_b16 a[212:213], v31 offset:8
    s_waitcnt vmcnt(12) lgkmcnt(0)
    s_barrier
    s_cmp_eq_u32 s71, 1
    s_cbranch_scc1 cf_th24
    s_waitcnt vmcnt(6)
cf_th24:
    s_add_u32 m0, s43, 73728
    s_add_u32 s41, s58, 802816
    buffer_load_dwordx4 v17, s[8:11], s41 offen offset:0 nt lds
    s_add_u32 s41, s58, 834560
    buffer_load_dwordx4 v17, s[8:11], s41 offen offset:1024 nt lds
    s_add_u32 s41, s58, 931840
    buffer_load_dwordx4 v17, s[8:11], s41 offen offset:2048 nt lds
    s_add_u32 s41, s58, 963584
    buffer_load_dwordx4 v17, s[8:11], s41 offen offset:3072 nt lds
    v_add_u32 v28, 110592, v24
    v_add_u32 v29, 110592, v25
    v_add_u32 v30, 110592, v26
    v_add_u32 v31, 110592, v27
    ds_read_b64_tr_b16 a[158:159], v28 offset:0
    ds_read_b64_tr_b16 a[166:167], v28 offset:8
    ds_read_b64_tr_b16 a[174:175], v29 offset:0
    ds_read_b64_tr_b16 a[182:183], v29 offset:8
    ds_read_b64_tr_b16 a[190:191], v30 offset:0
    ds_read_b64_tr_b16 a[198:199], v30 offset:8
    ds_read_b64_tr_b16 a[206:207], v31 offset:0
    ds_read_b64_tr_b16 a[214:215], v31 offset:8
    s_waitcnt vmcnt(12) lgkmcnt(0)
    s_barrier
    s_cmp_eq_u32 s71, 1
    s_cbranch_scc1 cf_th25
    s_waitcnt vmcnt(6)
cf_th25:
    s_mov_b64 s[8:9], s[52:53]
    s_add_u32 m0, s43, 110592
    s_add_u32 s41, s59, 0
    buffer_load_dwordx4 v17, s[8:11], s41 offen offset:0 nt lds
    s_add_u32 s41, s59, 31744
    buffer_load_dwordx4 v17, s[8:11], s41 offen offset:1024 nt lds
    s_add_u32 s41, s59, 129024
    buffer_load_dwordx4 v17, s[8:11], s41 offen offset:2048 nt lds
    s_add_u32 s41, s59, 160768
    buffer_load_dwordx4 v17, s[8:11], s41 offen offset:3072 nt lds
    v_add_u32 v28, 147456, v24
    v_add_u32 v29, 147456, v25
    v_add_u32 v30, 147456, v26
    v_add_u32 v31, 147456, v27
    ds_read_b64_tr_b16 v[180:181], v28 offset:0
    ds_read_b64_tr_b16 v[188:189], v28 offset:8
    ds_read_b64_tr_b16 v[196:197], v29 offset:0
    ds_read_b64_tr_b16 v[204:205], v29 offset:8
    ds_read_b64_tr_b16 v[212:213], v30 offset:0
    ds_read_b64_tr_b16 v[220:221], v30 offset:8
    ds_read_b64_tr_b16 v[228:229], v31 offset:0
    ds_read_b64_tr_b16 v[236:237], v31 offset:8
    s_waitcnt vmcnt(12) lgkmcnt(0)
    s_barrier
    s_cmp_eq_u32 s71, 1
    s_cbranch_scc1 cf_th26
    s_waitcnt vmcnt(6)
cf_th26:
    s_mov_b64 s[8:9], s[50:51]
    s_add_u32 m0, s43, 147456
    s_add_u32 s41, s59, 0
    buffer_load_dwordx4 v17, s[8:11], s41 offen offset:0 nt lds
    s_add_u32 s41, s59, 31744
    buffer_load_dwordx4 v17, s[8:11], s41 offen offset:1024 nt lds
    s_add_u32 s41, s59, 129024
    buffer_load_dwordx4 v17, s[8:11], s41 offen offset:2048 nt lds
    s_add_u32 s41, s59, 160768
    buffer_load_dwordx4 v17, s[8:11], s41 offen offset:3072 nt lds
    s_mul_i32 s26, s12, 16384
    s_add_u32 s26, s26, 0
    s_mul_i32 s40, s13, 3072
    s_add_u32 s24, s26, s40
    s_add_u32 s26, s24, s33
    s_add_u32 s99, s26, 33030144
    s_lshl_b32 s96, s12, 7
    s_add_u32 s29, s96, 125845504
    s_lshr_b32 s96, s12, 1
    s_lshl_b32 s96, s96, 11
    s_add_u32 s96, s96, 126091776
    v_bfe_u32 v78, v65, 4, 3
    v_lshlrev_b32 v78, 7, v78
    buffer_load_dword v56, v78, s[4:7], s96 offen sc1
    v_add_u32 v28, 0, v24
    v_add_u32 v29, 0, v25
    v_add_u32 v30, 0, v26
    v_add_u32 v31, 0, v27
    ds_read_b64_tr_b16 v[182:183], v28 offset:0
    ds_read_b64_tr_b16 v[190:191], v28 offset:8
    ds_read_b64_tr_b16 v[198:199], v29 offset:0
    ds_read_b64_tr_b16 v[206:207], v29 offset:8
    ds_read_b64_tr_b16 v[214:215], v30 offset:0
    ds_read_b64_tr_b16 v[222:223], v30 offset:8
    ds_read_b64_tr_b16 v[230:231], v31 offset:0
    ds_read_b64_tr_b16 v[238:239], v31 offset:8
    s_waitcnt vmcnt(12) lgkmcnt(0)
    s_barrier
    s_cmp_eq_u32 s71, 1
    s_cbranch_scc1 cf_th27
    s_waitcnt vmcnt(6)
cf_th27:
    s_mov_b64 s[8:9], s[54:55]
    s_add_u32 m0, s43, 0
    s_add_u32 s41, s59, 0
    buffer_load_dwordx4 v17, s[8:11], s41 offen offset:0 nt lds
    s_add_u32 s41, s59, 31744
    buffer_load_dwordx4 v17, s[8:11], s41 offen offset:1024 nt lds
    s_add_u32 s41, s59, 129024
    buffer_load_dwordx4 v17, s[8:11], s41 offen offset:2048 nt lds
    s_add_u32 s41, s59, 160768
    buffer_load_dwordx4 v17, s[8:11], s41 offen offset:3072 nt lds
    v_readfirstlane_b32 s94, v54
    v_readfirstlane_b32 s95, v55
    s_cmp_lt_u32 s94, 32
    s_cbranch_scc1 cf_mc
    s_cmp_lg_u32 s13, 0
    s_cbranch_scc1 cf_mc
    v_mov_b32 v76, 1
    v_mov_b32 v77, 0
    s_mov_b64 exec, 1
    buffer_atomic_cmpswap v[76:77], off, s[84:87], 0 offset:28 sc0
    s_mov_b64 exec, -1
cf_mc:
    s_nop 1
    v_add_u32 v28, 36864, v24
    v_add_u32 v29, 36864, v25
    v_add_u32 v30, 36864, v26
    v_add_u32 v31, 36864, v27
    ds_read_b64_tr_b16 a[20:21], v28 offset:0
    ds_read_b64_tr_b16 a[28:29], v28 offset:8
    ds_read_b64_tr_b16 a[36:37], v29 offset:0
    ds_read_b64_tr_b16 a[44:45], v29 offset:8
    ds_read_b64_tr_b16 a[52:53], v30 offset:0
    ds_read_b64_tr_b16 a[60:61], v30 offset:8
    ds_read_b64_tr_b16 a[68:69], v31 offset:0
    ds_read_b64_tr_b16 a[76:77], v31 offset:8
    s_waitcnt vmcnt(12) lgkmcnt(0)
    s_barrier
    s_cmp_eq_u32 s71, 1
    s_cbranch_scc1 cf_th28
    s_waitcnt vmcnt(6)
cf_th28:
    s_mov_b64 s[8:9], s[56:57]
    s_add_u32 m0, s43, 36864
    s_add_u32 s41, s60, 128
    buffer_load_dwordx4 v18, s[8:11], s41 offen offset:0 nt lds
    s_add_u32 s41, s60, 8320
    buffer_load_dwordx4 v18, s[8:11], s41 offen offset:1024 nt lds
    s_add_u32 s41, s60, 16512
    buffer_load_dwordx4 v18, s[8:11], s41 offen offset:2048 nt lds
    s_add_u32 s41, s60, 24704
    buffer_load_dwordx4 v18, s[8:11], s41 offen offset:3072 nt lds
    v_add_u32 v28, 73728, v24
    v_add_u32 v29, 73728, v25
    v_add_u32 v30, 73728, v26
    v_add_u32 v31, 73728, v27
    ds_read_b64_tr_b16 a[22:23], v28 offset:0
    ds_read_b64_tr_b16 a[30:31], v28 offset:8
    ds_read_b64_tr_b16 a[38:39], v29 offset:0
    ds_read_b64_tr_b16 a[46:47], v29 offset:8
    ds_read_b64_tr_b16 a[54:55], v30 offset:0
    ds_read_b64_tr_b16 a[62:63], v30 offset:8
    ds_read_b64_tr_b16 a[70:71], v31 offset:0
    ds_read_b64_tr_b16 a[78:79], v31 offset:8
    s_waitcnt vmcnt(12) lgkmcnt(0)
    s_barrier
    s_cmp_eq_u32 s71, 1
    s_cbranch_scc1 cf_th29
    s_waitcnt vmcnt(6)
cf_th29:
    s_add_u32 m0, s43, 73728
    s_add_u32 s41, s61, 128
    buffer_load_dwordx4 v18, s[8:11], s41 offen offset:0 nt lds
    s_add_u32 s41, s61, 8320
    buffer_load_dwordx4 v18, s[8:11], s41 offen offset:1024 nt lds
    s_add_u32 s41, s61, 16512
    buffer_load_dwordx4 v18, s[8:11], s41 offen offset:2048 nt lds
    s_add_u32 s41, s61, 24704
    buffer_load_dwordx4 v18, s[8:11], s41 offen offset:3072 nt lds
    v_add_u32 v77, 110592, v20
    ds_read_b64_tr_b16 a[216:217], v77 offset:0
    ds_read_b64_tr_b16 a[218:219], v77 offset:4096
    ds_read_b64_tr_b16 a[220:221], v77 offset:8192
    ds_read_b64_tr_b16 a[222:223], v77 offset:12288
    ds_read_b64_tr_b16 a[224:225], v77 offset:8
    ds_read_b64_tr_b16 a[226:227], v77 offset:4104
    ds_read_b64_tr_b16 a[228:229], v77 offset:8200
    ds_read_b64_tr_b16 a[230:231], v77 offset:12296
    s_waitcnt vmcnt(12) lgkmcnt(0)
    s_barrier
    s_cmp_eq_u32 s71, 1
    s_cbranch_scc1 cf_th30
    s_waitcnt vmcnt(6)
cf_th30:
    s_add_u32 m0, s43, 110592
    s_add_u32 s41, s62, 128
    buffer_load_dwordx4 v18, s[8:11], s41 offen offset:0 nt lds
    s_add_u32 s41, s62, 8320
    buffer_load_dwordx4 v18, s[8:11], s41 offen offset:1024 nt lds
    s_add_u32 s41, s62, 16512
    buffer_load_dwordx4 v18, s[8:11], s41 offen offset:2048 nt lds
    s_add_u32 s41, s62, 24704
    buffer_load_dwordx4 v18, s[8:11], s41 offen offset:3072 nt lds
    v_add_u32 v77, 147456, v20
    ds_read_b64_tr_b16 a[80:81], v77 offset:0
    ds_read_b64_tr_b16 a[82:83], v77 offset:4096
    ds_read_b64_tr_b16 a[84:85], v77 offset:8192
    ds_read_b64_tr_b16 a[86:87], v77 offset:12288
    ds_read_b64_tr_b16 a[88:89], v77 offset:8
    ds_read_b64_tr_b16 a[90:91], v77 offset:4104
    ds_read_b64_tr_b16 a[92:93], v77 offset:8200
    ds_read_b64_tr_b16 a[94:95], v77 offset:12296
    s_waitcnt vmcnt(12) lgkmcnt(0)
    s_barrier
    s_cmp_eq_u32 s71, 1
    s_cbranch_scc1 cf_th31
    s_waitcnt vmcnt(6)
cf_th31:
    s_add_u32 m0, s43, 147456
    s_add_u32 s41, s63, 128
    buffer_load_dwordx4 v18, s[8:11], s41 offen offset:0 nt lds
    s_add_u32 s41, s63, 8320
    buffer_load_dwordx4 v18, s[8:11], s41 offen offset:1024 nt lds
    s_add_u32 s41, s63, 16512
    buffer_load_dwordx4 v18, s[8:11], s41 offen offset:2048 nt lds
    s_add_u32 s41, s63, 24704
    buffer_load_dwordx4 v18, s[8:11], s41 offen offset:3072 nt lds
    v_mov_b32 v77, v56
    v_subrev_u32 v77, s95, v77
    v_cmp_lt_u32 vcc, 16, v77
    s_nop 1
    v_cndmask_b32 v77, v77, 0, vcc
    v_bfe_u32 v79, v78, 7, 2
    v_lshl_add_u32 v77, v77, 2, v79
    s_nop 1
    v_min_u32_dpp v77, v77, v77 row_ror:1 row_mask:0xf bank_mask:0xf
    s_nop 1
    v_min_u32_dpp v77, v77, v77 row_ror:2 row_mask:0xf bank_mask:0xf
    s_nop 1
    v_min_u32_dpp v77, v77, v77 row_ror:4 row_mask:0xf bank_mask:0xf
    s_nop 0
    v_readfirstlane_b32 s97, v77
    s_cmp_eq_u32 s95, 0
    s_cselect_b32 s97, 0, s97
    s_cmp_lt_u32 s97, 3
    s_cbranch_scc1 cf_mb
    s_add_u32 s40, s26, 0
    s_min_u32 s40, s40, s99
    s_sub_u32 s41, s96, s40
    v_bfe_u32 v77, v65, 4, 3
    v_lshl_add_u32 v77, v77, 7, s41
    v_lshlrev_b32 v78, 3, v69
    s_nop 0
    v_mov_b32_dpp v78, v77 quad_perm:[0,1,2,3] row_mask:0xc bank_mask:0xf
    buffer_load_dword v63, v78, s[4:7], s40 offen sc1
    s_add_u32 s40, s26, 524288
    s_min_u32 s40, s40, s99
    s_sub_u32 s41, s96, s40
    v_bfe_u32 v77, v65, 4, 3
    v_lshl_add_u32 v77, v77, 7, s41
    v_lshlrev_b32 v78, 3, v69
    s_nop 0
    v_mov_b32_dpp v78, v77 quad_perm:[0,1,2,3] row_mask:0xc bank_mask:0xf
    buffer_load_dword v63, v78, s[4:7], s40 offen sc1
cf_mb:
    v_mov_b32 v78, v21
    v_mov_b32 v79, v22
    v_add_u32 v77, 0, v20
    ds_read_b64_tr_b16 v[240:241], v77 offset:0
    ds_read_b64_tr_b16 v[242:243], v77 offset:4096
    ds_read_b64_tr_b16 v[244:245], v77 offset:8192
    ds_read_b64_tr_b16 v[246:247], v77 offset:12288
    ds_read_b64_tr_b16 v[248:249], v77 offset:8
    ds_read_b64_tr_b16 v[250:251], v77 offset:4104
    ds_read_b64_tr_b16 v[252:253], v77 offset:8200
    ds_read_b64_tr_b16 v[254:255], v77 offset:12296
    s_waitcnt vmcnt(12) lgkmcnt(0)
    s_barrier
    v_bfe_u32 v60, v65, 4, 6
    v_and_b32 v61, 15, v60
    v_lshrrev_b32 v62, 4, v60
    v_mov_b32 v50, 0x3f80
    v_mov_b32 v51, 0x3f800000
    v_and_b32 v57, 1, v62
    v_lshlrev_b32 v57, 2, v57
    v_sub_u32 v57, v61, v57
    v_and_b32 v58, 3, v61
    v_lshlrev_b32 v58, 2, v58
    v_lshrrev_b32 v59, 2, v61
    v_add_u32 v58, v58, v59
    v_cmp_eq_u32 vcc, 0, v57
    s_nop 1
    v_cndmask_b32 v40, 0, v50, vcc
    v_cmp_eq_u32 vcc, 1, v57
    s_nop 1
    v_cndmask_b32 v40, v40, v51, vcc
    v_cmp_eq_u32 vcc, 0, v58
    s_nop 1
    v_cndmask_b32 v44, 0, v50, vcc
    v_cmp_eq_u32 vcc, 1, v58
    s_nop 1
    v_cndmask_b32 v44, v44, v51, vcc
    v_cmp_eq_u32 vcc, 2, v57
    s_nop 1
    v_cndmask_b32 v41, 0, v50, vcc
    v_cmp_eq_u32 vcc, 3, v57
    s_nop 1
    v_cndmask_b32 v41, v41, v51, vcc
    v_cmp_eq_u32 vcc, 2, v58
    s_nop 1
    v_cndmask_b32 v45, 0, v50, vcc
    v_cmp_eq_u32 vcc, 3, v58
    s_nop 1
    v_cndmask_b32 v45, v45, v51, vcc
    v_cmp_eq_u32 vcc, 8, v57
    s_nop 1
    v_cndmask_b32 v42, 0, v50, vcc
    v_cmp_eq_u32 vcc, 9, v57
    s_nop 1
    v_cndmask_b32 v42, v42, v51, vcc
    v_cmp_eq_u32 vcc, 4, v58
    s_nop 1
    v_cndmask_b32 v46, 0, v50, vcc
    v_cmp_eq_u32 vcc, 5, v58
    s_nop 1
    v_cndmask_b32 v46, v46, v51, vcc
    v_cmp_eq_u32 vcc, 10, v57
    s_nop 1
    v_cndmask_b32 v43, 0, v50, vcc
    v_cmp_eq_u32 vcc, 11, v57
    s_nop 1
    v_cndmask_b32 v43, v43, v51, vcc
    v_cmp_eq_u32 vcc, 6, v58
    s_nop 1
    v_cndmask_b32 v47, 0, v50, vcc
    v_cmp_eq_u32 vcc, 7, v58
    s_nop 1
    v_cndmask_b32 v47, v47, v51, vcc
    v_lshlrev_b32 v57, 4, v61
    ds_write_b128 v69, v[40:43] offset:15360
    ds_write_b128 v57, v[44:47] offset:15872
    v_add_u32 v77, 36864, v79
    s_waitcnt lgkmcnt(0)
    ds_read_b64_tr_b16 v[0:1], v77 offset:0
    ds_read_b64_tr_b16 v[2:3], v77 offset:256
    ds_read_b64_tr_b16 v[4:5], v77 offset:2048
    ds_read_b64_tr_b16 v[6:7], v77 offset:2304
    ds_read_b64_tr_b16 v[8:9], v77 offset:16
    ds_read_b64_tr_b16 v[10:11], v77 offset:272
    ds_read_b64_tr_b16 v[12:13], v77 offset:2064
    ds_read_b64_tr_b16 v[14:15], v77 offset:2320
    s_waitcnt vmcnt(8) lgkmcnt(0)
    s_barrier
    s_mov_b32 s44, 0x3e0293ee
    s_mov_b32 s45, s44
    s_or_b32 s66, s44, 0x80000000
    s_mov_b32 s48, 0x3f003f00
    s_mov_b32 s49, 0
    s_mov_b32 s50, 0x3f803f80
    s_mov_b32 s51, 0x3f803f80
    s_mov_b32 s52, 512
    s_mov_b32 s53, 1024
    s_mov_b32 s54, 1536
    s_mov_b32 s30, 0
    s_mov_b32 s37, 0
    s_mov_b32 s98, -100
    s_lshl_b32 s47, s13, 9
    s_cmp_lg_u32 s32, 0
    s_cselect_b32 s71, s13, 3
    s_add_u32 s46, s71, 1
    s_lshr_b32 s46, s46, 1
    s_mov_b32 s14, 67125248
    s_mov_b32 s15, 67129344
    s_mov_b32 s16, 67133440
    s_mov_b32 s36, 0
    s_add_u32 s17, s68, 67108864
    s_mov_b32 s69, 0
    s_mov_b32 s70, 0
    s_mul_i32 s26, s12, 16384
    s_add_u32 s26, s26, 0
    s_mul_i32 s40, s13, 3072
    s_add_u32 s24, s26, s40
    s_add_u32 s26, s24, s33
    s_add_u32 s99, s26, 33030144
    s_lshl_b32 s96, s12, 7
    s_add_u32 s29, s96, 125845504
    s_lshr_b32 s96, s12, 1
    s_lshl_b32 s96, s96, 11
    s_add_u32 s96, s96, 126091776
    s_lshl_b32 s40, s12, 14
    s_add_u32 s40, s40, 68157440
    s_add_u32 s18, s40, 0
    s_add_u32 s19, s40, 4096
    s_add_u32 s20, s40, 8192
    s_add_u32 s21, s40, 12288
    s_lshr_b32 s40, s12, 3
    s_lshl_b32 s40, s40, 12
    s_and_b32 s41, s12, 7
    s_lshl_b32 s41, s41, 7
    s_add_u32 s40, s40, s41
    s_add_u32 s22, s40, 68157440
    s_add_u32 s23, s22, 1024
    s_add_u32 s25, s22, 2048
    s_mov_b32 s56, -65472
    s_cmp_lg_u32 s32, 0
    s_cselect_b64 s[38:39], -1, 0
    s_add_u32 s55, s68, 138412032
    s_cmp_eq_u32 s13, 3
    s_cselect_b64 s[100:101], 1, 0
    s_cselect_b64 s[38:39], 1, s[38:39]
    s_cselect_b32 s93, 64, 0
    s_cselect_b32 s67, 64, 0
    s_cselect_b32 s55, s29, s55
    s_cselect_b32 s57, 0, 9216
    s_mov_b32 s34, 0xff00ff00
    s_mov_b32 s35, 0xff00ff00
    s_lshl_b32 s28, s12, 12
    s_add_u32 s28, s28, 7340032
    s_add_u32 s27, s28, 77594624
    s_add_u32 s28, s28, 69206016
    v_add_u32 v77, 73728, v78
    ds_read_b64_tr_b16 v[16:17], v77 offset:0
    ds_read_b64_tr_b16 v[18:19], v77 offset:256
    ds_read_b64_tr_b16 v[20:21], v77 offset:2048
    ds_read_b64_tr_b16 v[22:23], v77 offset:2304
    ds_read_b64_tr_b16 v[24:25], v77 offset:16
    ds_read_b64_tr_b16 v[26:27], v77 offset:272
    ds_read_b64_tr_b16 v[28:29], v77 offset:2064
    ds_read_b64_tr_b16 v[30:31], v77 offset:2320
    s_waitcnt vmcnt(4) lgkmcnt(0)
    s_barrier
    v_add_u32 v77, 110592, v78
    ds_read_b64_tr_b16 v[32:33], v77 offset:0
    ds_read_b64_tr_b16 v[34:35], v77 offset:256
    ds_read_b64_tr_b16 v[36:37], v77 offset:2048
    ds_read_b64_tr_b16 v[38:39], v77 offset:2304
    ds_read_b64_tr_b16 v[40:41], v77 offset:16
    ds_read_b64_tr_b16 v[42:43], v77 offset:272
    ds_read_b64_tr_b16 v[44:45], v77 offset:2064
    ds_read_b64_tr_b16 v[46:47], v77 offset:2320
    s_waitcnt vmcnt(0) lgkmcnt(0)
    s_barrier
    v_add_u32 v77, 147456, v78
    ds_read_b64_tr_b16 v[48:49], v77 offset:0
    ds_read_b64_tr_b16 v[50:51], v77 offset:256
    ds_read_b64_tr_b16 v[52:53], v77 offset:2048
    ds_read_b64_tr_b16 v[54:55], v77 offset:2304
    ds_read_b64_tr_b16 v[56:57], v77 offset:16
    ds_read_b64_tr_b16 v[58:59], v77 offset:272
    ds_read_b64_tr_b16 v[60:61], v77 offset:2064
    ds_read_b64_tr_b16 v[62:63], v77 offset:2320
    s_waitcnt lgkmcnt(0)
    s_barrier
    ds_write_b128 v70, v[0:3] offset:20480
    ds_write_b128 v70, v[4:7] offset:21504
    ds_write_b128 v70, v[8:11] offset:22528
    ds_write_b128 v70, v[12:15] offset:23552
    ds_write_b128 v70, v[16:19] offset:24576
    ds_write_b128 v70, v[20:23] offset:25600
    ds_write_b128 v70, v[24:27] offset:26624
    ds_write_b128 v70, v[28:31] offset:27648
    ds_write_b128 v70, v[32:35] offset:28672
    ds_write_b128 v70, v[36:39] offset:29696
    ds_write_b128 v70, v[40:43] offset:30720
    ds_write_b128 v70, v[44:47] offset:31744
    ds_write_b128 v70, v[48:51] offset:32768
    ds_write_b128 v70, v[52:55] offset:33792
    ds_write_b128 v70, v[56:59] offset:34816
    ds_write_b128 v70, v[60:63] offset:35840
    s_waitcnt vmcnt(0) lgkmcnt(0)
    s_cmp_lg_u32 s95, 0
    s_cbranch_scc1 cf_hn
    s_mov_b32 s88, 4194304
gn2:
    buffer_load_dword v2, off, s[84:87], 0 offset:216 sc1
    s_waitcnt vmcnt(0)
    v_readfirstlane_b32 s95, v2
    s_sub_u32 s88, s88, 1
    s_cbranch_scc1 gn2x
    s_cmp_eq_u32 s95, 0
    s_cbranch_scc1 gn2
gn2x:
cf_hn:
    v_mov_b32 v2, 1
    s_cmp_lg_u32 s13, 0
    s_cbranch_scc1 cf_noarr
    s_mov_b64 exec, 1
    s_mov_b32 s42, 1
    v_mov_b32 v4, v76
    s_cmp_ge_u32 s94, 32
    s_cbranch_scc1 cf_have
    s_mov_b32 s40, 131072
    s_mov_b32 s42, 2
cf_startpoll:
    buffer_load_dword v3, off, s[84:87], 0 offset:132 sc1
    s_sub_u32 s40, s40, 1
    s_cbranch_scc1 cf_decide
    s_waitcnt vmcnt(0)
    v_readfirstlane_b32 s41, v3
    s_nop 1
    s_cmp_lt_u32 s41, 32
    s_cbranch_scc1 cf_startpoll
    s_mov_b32 s42, 1
cf_decide:
    v_mov_b32 v4, s42
    v_mov_b32 v5, 0
    buffer_atomic_cmpswap v[4:5], off, s[84:87], 0 offset:28 sc0
    s_waitcnt vmcnt(0)
cf_have:
    v_mov_b32 v5, s42
    v_cmp_eq_u32 vcc, 0, v4
    s_nop 1
    v_cndmask_b32 v4, v4, v5, vcc
    v_mov_b32 v5, 16192
    ds_write_b32 v5, v4
    s_waitcnt lgkmcnt(0)
    s_mov_b64 exec, -1
cf_noarr:
    s_barrier
    v_mov_b32 v5, 16192
    ds_read_b32 v4, v5
    s_waitcnt lgkmcnt(0)
    v_readfirstlane_b32 s41, v4
    s_nop 1
    s_cmp_eq_u32 s41, 1
    s_cbranch_scc1 cf_run
    v_lshrrev_b32 v0, 4, v65
    s_mov_b32 s32, s13
    s_load_dwordx16 s[48:63], s[0:1], 0
    s_waitcnt lgkmcnt(0)
    s_branch L_helper
cf_run:
    s_mov_b64 exec, s[100:101]
    v_mov_b32 v72, s95
    s_mov_b64 exec, -1
    s_cmp_ge_u32 s97, 3
    s_cbranch_scc1 cf_kvdone
    s_mov_b32 s40, 3
    v_bfe_u32 v78, v65, 4, 3
    v_lshlrev_b32 v78, 7, v78
    s_mov_b32 s31, 4194304
cf_kv0:
    buffer_load_dword v77, v78, s[4:7], s96 offen sc1
    s_waitcnt vmcnt(0)
    v_subrev_u32 v77, s95, v77
    v_cmp_lt_u32 vcc, 16, v77
    s_nop 1
    v_cndmask_b32 v77, v77, 0, vcc
    v_bfe_u32 v79, v78, 7, 2
    v_lshl_add_u32 v77, v77, 2, v79
    s_nop 1
    v_min_u32_dpp v77, v77, v77 row_ror:1 row_mask:0xf bank_mask:0xf
    s_nop 1
    v_min_u32_dpp v77, v77, v77 row_ror:2 row_mask:0xf bank_mask:0xf
    s_nop 1
    v_min_u32_dpp v77, v77, v77 row_ror:4 row_mask:0xf bank_mask:0xf
    s_nop 0
    v_readfirstlane_b32 s97, v77
    s_sub_u32 s31, s31, 1
    s_cbranch_scc1 cf_kv0_x
    s_cmp_le_u32 s40, s97
    s_cbranch_scc1 cf_kv0_x
    s_sleep 2
    s_branch cf_kv0
cf_kv0_x:
    s_add_u32 s40, s26, 0
    s_min_u32 s40, s40, s99
    s_sub_u32 s41, s96, s40
    v_bfe_u32 v77, v65, 4, 3
    v_lshl_add_u32 v77, v77, 7, s41
    v_lshlrev_b32 v78, 3, v69
    s_nop 0
    v_mov_b32_dpp v78, v77 quad_perm:[0,1,2,3] row_mask:0xc bank_mask:0xf
    buffer_load_dword v76, v78, s[4:7], s40 offen sc1
    s_add_u32 s40, s26, 524288
    s_min_u32 s40, s40, s99
    s_sub_u32 s41, s96, s40
    v_bfe_u32 v77, v65, 4, 3
    v_lshl_add_u32 v77, v77, 7, s41
    v_lshlrev_b32 v78, 3, v69
    s_nop 0
    v_mov_b32_dpp v78, v77 quad_perm:[0,1,2,3] row_mask:0xc bank_mask:0xf
    buffer_load_dword v76, v78, s[4:7], s40 offen sc1
cf_kvdone:
    v_mov_b64 v[0:1], 0
    v_mov_b64 v[2:3], 0
    v_mov_b64 v[4:5], 0
    v_mov_b64 v[6:7], 0
    v_mov_b64 v[8:9], 0
    v_mov_b64 v[10:11], 0
    v_mov_b64 v[12:13], 0
    v_mov_b64 v[14:15], 0
    v_mov_b64 v[16:17], 0
    v_mov_b64 v[18:19], 0
    v_mov_b64 v[20:21], 0
    v_mov_b64 v[22:23], 0
    ds_read_b128 v[44:47], v70 offset:0
    ds_read_b128 v[48:51], v70 offset:1024
    ds_read_b128 v[52:55], v70 offset:2048
    ds_read_b128 v[56:59], v70 offset:3072
    ds_read_b128 v[24:27], v70 offset:4096
    ds_read_b128 v[28:31], v70 offset:5120
    ds_read_b128 v[32:35], v70 offset:6144
    ds_read_b128 v[36:39], v70 offset:7168
    buffer_load_dwordx4 v[40:43], v65, s[4:7], s14 offen offset:0 nt
    buffer_load_dwordx4 v[60:63], v66, s[4:7], s14 offen offset:0 nt
    s_mov_b32 s31, 1048576
    s_waitcnt vmcnt(0) lgkmcnt(0)
    s_branch cf_goA
cf_loop:
    s_mov_b32 s31, 1048576
    s_mov_b32 s69, s70
    s_waitcnt lgkmcnt(0)
cf_cA:
    buffer_load_dwordx4 v[40:43], v65, s[4:7], s14 offen offset:0 nt
    buffer_load_dwordx4 v[60:63], v66, s[4:7], s14 offen offset:0 nt
cf_cA1:
    v_bitop3_b32 v77, v40, v60, s70 bitop3:0x7e
    v_and_b32 v77, 1, v77
    v_cmp_ne_u32 vcc, 0, v77
    s_cbranch_vccz cf_goA
    v_bitop3_b32 v77, v40, v60, s70 bitop3:0x7e
    v_and_b32 v77, 1, v77
    v_cmp_ne_u32 vcc, 0, v77
    s_cbranch_vccz cf_goA
    v_bitop3_b32 v77, v40, v60, s70 bitop3:0x7e
    v_and_b32 v77, 1, v77
    v_cmp_ne_u32 vcc, 0, v77
    s_cbranch_vccz cf_goA
    v_bitop3_b32 v77, v40, v60, s70 bitop3:0x7e
    v_and_b32 v77, 1, v77
    v_cmp_ne_u32 vcc, 0, v77
    s_cbranch_vccz cf_goA
    buffer_load_dwordx4 v[40:43], v65, s[4:7], s14 offen offset:0 nt
    buffer_load_dwordx4 v[60:63], v66, s[4:7], s14 offen offset:0 nt
    v_bitop3_b32 v77, v40, v60, s70 bitop3:0x7e
    v_and_b32 v77, 1, v77
    v_cmp_ne_u32 vcc, 0, v77
    s_cbranch_vccz cf_goA
    v_bitop3_b32 v77, v40, v60, s70 bitop3:0x7e
    v_and_b32 v77, 1, v77
    v_cmp_ne_u32 vcc, 0, v77
    s_cbranch_vccz cf_goA
    v_bitop3_b32 v77, v40, v60, s70 bitop3:0x7e
    v_and_b32 v77, 1, v77
    v_cmp_ne_u32 vcc, 0, v77
    s_cbranch_vccz cf_goA
    v_bitop3_b32 v77, v40, v60, s70 bitop3:0x7e
    v_and_b32 v77, 1, v77
    v_cmp_ne_u32 vcc, 0, v77
    s_cbranch_vccz cf_goA
    buffer_load_dwordx4 v[40:43], v65, s[4:7], s14 offen offset:0 nt
    buffer_load_dwordx4 v[60:63], v66, s[4:7], s14 offen offset:0 nt
    v_bitop3_b32 v77, v40, v60, s70 bitop3:0x7e
    v_and_b32 v77, 1, v77
    v_cmp_ne_u32 vcc, 0, v77
    s_cbranch_vccz cf_goA
    v_bitop3_b32 v77, v40, v60, s70 bitop3:0x7e
    v_and_b32 v77, 1, v77
    v_cmp_ne_u32 vcc, 0, v77
    s_cbranch_vccz cf_goA
    v_bitop3_b32 v77, v40, v60, s70 bitop3:0x7e
    v_and_b32 v77, 1, v77
    v_cmp_ne_u32 vcc, 0, v77
    s_cbranch_vccz cf_goA
    v_bitop3_b32 v77, v40, v60, s70 bitop3:0x7e
    v_and_b32 v77, 1, v77
    v_cmp_ne_u32 vcc, 0, v77
    s_cbranch_vccz cf_goA
    buffer_load_dwordx4 v[40:43], v65, s[4:7], s14 offen offset:0 nt
    buffer_load_dwordx4 v[60:63], v66, s[4:7], s14 offen offset:0 nt
    v_bitop3_b32 v77, v40, v60, s70 bitop3:0x7e
    v_and_b32 v77, 1, v77
    v_cmp_ne_u32 vcc, 0, v77
    s_cbranch_vccz cf_goA
    v_bitop3_b32 v77, v40, v60, s70 bitop3:0x7e
    v_and_b32 v77, 1, v77
    v_cmp_ne_u32 vcc, 0, v77
    s_cbranch_vccz cf_goA
    v_bitop3_b32 v77, v40, v60, s70 bitop3:0x7e
    v_and_b32 v77, 1, v77
    v_cmp_ne_u32 vcc, 0, v77
    s_cbranch_vccz cf_goA
    v_bitop3_b32 v77, v40, v60, s70 bitop3:0x7e
    v_and_b32 v77, 1, v77
    v_cmp_ne_u32 vcc, 0, v77
    s_cbranch_vccz cf_goA
    s_sub_u32 s31, s31, 64
    s_cbranch_scc0 cf_cA
cf_goA:
    ds_write_b128 v65, v[40:43] offset:0
    v_smfmac_f32_16x16x64_bf16 v[0:3], v[40:43], v[44:51], v64
    v_smfmac_f32_16x16x64_bf16 v[4:7], v[40:43], v[52:59], v64
    buffer_load_dwordx4 v[44:47], v65, s[4:7], s15 offen offset:0 nt
    v_smfmac_f32_16x16x64_bf16 v[0:3], v[60:63], v[24:31], v64
    s_add_u32 s40, s26, 1048576
    s_min_u32 s40, s40, s99
    s_sub_u32 s41, s96, s40
    v_smfmac_f32_16x16x64_bf16 v[4:7], v[60:63], v[32:39], v64
    ds_read_b128 v[24:27], v70 offset:8192
    s_cmp_lt_u32 s97, s67
    s_cselect_b32 s42, -1, 0
    v_smfmac_f32_16x16x64_bf16 v[8:11], v[40:43], a[96:103], v64
    ds_read_b128 v[28:31], v70 offset:9216
    v_smfmac_f32_16x16x64_bf16 v[12:15], v[40:43], a[104:111], v64
    ds_read_b128 v[32:35], v70 offset:10240
    s_waitcnt lgkmcnt(3)
    s_barrier
    ds_read_b128 v[48:51], v67 offset:0
    v_smfmac_f32_16x16x64_bf16 v[8:11], v[60:63], a[112:119], v64
    ds_read_b128 v[36:39], v70 offset:11264
    v_bitop3_b32 v79, v73, -9, s54 bitop3:0x6a
    v_smfmac_f32_16x16x64_bf16 v[12:15], v[60:63], a[120:127], v64
    buffer_load_dwordx4 v[44:47], v65, s[4:7], s15 offen offset:0 nt
    v_smfmac_f32_16x16x64_bf16 v[16:19], v[40:43], a[232:239], v64
    ds_read_b128 v[52:55], v68 offset:0
    s_waitcnt lgkmcnt(4)
    v_bfe_u32 v77, v65, 4, 3
    v_smfmac_f32_16x16x64_bf16 v[20:23], v[40:43], v[24:31], v64
    ds_read_b128 v[24:27], v70 offset:12288
    s_waitcnt lgkmcnt(3)
    v_smfmac_f32_16x16x64_bf16 v[0:3], v[48:51], a[0:7], v64
    ds_read_b128 v[28:31], v70 offset:13312
    s_waitcnt lgkmcnt(3)
    v_lshl_add_u32 v77, v77, 7, s41
    v_smfmac_f32_16x16x64_bf16 v[4:7], v[48:51], v[32:39], v64
    buffer_load_dwordx4 v[40:43], v65, s[4:7], s16 offen offset:0 nt
    v_smfmac_f32_16x16x64_bf16 v[16:19], v[60:63], a[240:247], v64
    ds_read_b128 v[32:35], v70 offset:14336
    v_lshlrev_b32 v78, 3, v69
    v_smfmac_f32_16x16x64_bf16 v[20:23], v[60:63], a[248:255], v64
    ds_read_b128 v[36:39], v70 offset:15360
    v_smfmac_f32_16x16x64_bf16 v[8:11], v[48:51], a[128:135], v64
    s_waitcnt vmcnt(2)
    v_mov_b32_dpp v78, v77 quad_perm:[0,1,2,3] row_mask:0xc bank_mask:0xf
    v_smfmac_f32_16x16x64_bf16 v[12:15], v[48:51], a[136:143], v64
    buffer_load_dwordx4 v[58:61], v65, s[4:7], s24 offen offset:3072 sc1
    s_waitcnt lgkmcnt(2)
    v_and_b32 v77, s36, v44
    v_smfmac_f32_16x16x64_bf16 v[12:15], v[52:55], v[24:31], v64
    ds_write_b128 v65, v[44:47] offset:4096
    v_smfmac_f32_16x16x64_bf16 v[0:3], v[52:55], a[8:15], v64
    v_cmp_ne_u32 vcc, s70, v77
    v_smfmac_f32_16x16x64_bf16 v[8:11], v[52:55], a[144:151], v64
    buffer_load_dwordx4 v[24:27], v65, s[4:7], s24 offen offset:0 sc1
    s_waitcnt lgkmcnt(1)
    v_smfmac_f32_16x16x64_bf16 v[4:7], v[52:55], v[32:39], v64
    s_cbranch_vccnz cf_spinB
cf_backB:
    v_smfmac_f32_16x16x64_bf16 v[16:19], v[44:47], v[176:183], v64
    s_waitcnt lgkmcnt(0)
    s_barrier
    ds_read_b128 v[48:51], v66 offset:4096
    v_smfmac_f32_16x16x64_bf16 v[12:15], v[44:47], a[160:167], v64
    buffer_load_dwordx4 v[28:31], v65, s[4:7], s24 offen offset:1024 sc1
    v_smfmac_f32_16x16x64_bf16 v[0:3], v[44:47], a[16:23], v64
    ds_read_b128 v[52:55], v67 offset:4096
    v_smfmac_f32_16x16x64_bf16 v[8:11], v[44:47], a[152:159], v64
    v_smfmac_f32_16x16x64_bf16 v[4:7], v[44:47], a[24:31], v64
    buffer_load_dwordx4 v[34:37], v65, s[4:7], s24 offen offset:2048 sc1
    s_waitcnt vmcnt(5)
    v_smfmac_f32_16x16x64_bf16 v[20:23], v[44:47], v[184:191], v64
    ds_read_b128 v[44:47], v68 offset:4096
    s_waitcnt lgkmcnt(2)
    v_smfmac_f32_16x16x64_bf16 v[0:3], v[48:51], a[32:39], v64
    s_mov_b32 exec_hi, s42
    buffer_load_dword v76, v78, s[4:7], s40 offen sc1
    s_mov_b32 exec_hi, -1
    v_smfmac_f32_16x16x64_bf16 v[8:11], v[48:51], a[168:175], v64
    v_smfmac_f32_16x16x64_bf16 v[4:7], v[48:51], a[40:47], v64
    s_waitcnt vmcnt(5)
    v_and_b32 v77, s36, v40
    v_smfmac_f32_16x16x64_bf16 v[12:15], v[48:51], a[176:183], v64
    ds_read_b128 v[48:51], v69 offset:15360
    s_waitcnt lgkmcnt(1)
    v_cmp_ne_u32 vcc, s70, v77
    v_smfmac_f32_16x16x64_bf16 v[0:3], v[52:55], a[48:55], v64
    v_smfmac_f32_16x16x64_bf16 v[8:11], v[52:55], a[184:191], v64
    s_cbranch_vccnz cf_spin8
cf_back8:
    v_smfmac_f32_16x16x64_bf16 v[0:3], v[44:47], a[64:71], v64
    v_smfmac_f32_16x16x64_bf16 v[8:11], v[44:47], a[200:207], v64
    v_smfmac_f32_16x16x64_bf16 v[0:3], v[40:43], a[80:87], v64
    s_nop 1
    v_smfmac_f32_16x16x64_bf16 v[8:11], v[40:43], a[216:223], v64
    s_nop 1
    v_lshrrev_b32 v77, 1, v69
    v_smfmac_f32_16x16x64_bf16 v[4:7], v[52:55], a[56:63], v64
    s_nop 1
    v_cvt_pk_bf16_f32 v0, v0, v1
    v_smfmac_f32_16x16x64_bf16 v[12:15], v[52:55], a[192:199], v64
    s_nop 1
    v_cvt_pk_bf16_f32 v1, v2, v3
    v_smfmac_f32_16x16x64_bf16 v[4:7], v[44:47], a[72:79], v64
    s_nop 1
    v_cvt_pk_bf16_f32 v2, v8, v9
    v_smfmac_f32_16x16x64_bf16 v[12:15], v[44:47], a[208:215], v64
    s_nop 1
    v_cvt_pk_bf16_f32 v3, v10, v11
    v_smfmac_f32_16x16x64_bf16 v[4:7], v[40:43], a[88:95], v64
    s_waitcnt lgkmcnt(0)
    s_nop 0
    s_nop 0
    v_smfmac_f32_16x16x64_bf16 v[12:15], v[40:43], a[224:231], v64
    s_nop 2
    v_mfma_f32_16x16x32_bf16 v[8:11], v[0:3], v[48:51], 0
    s_nop 0
    v_cvt_pk_bf16_f32 v4, v4, v5
    v_cvt_pk_bf16_f32 v5, v6, v7
    s_nop 0
    v_cvt_pk_bf16_f32 v6, v12, v13
    v_cvt_pk_bf16_f32 v7, v14, v15
    s_nop 1
    v_mfma_f32_16x16x32_bf16 v[12:15], v[4:7], v[48:51], 0
    ds_read_b128 v[48:51], v66 offset:4096
    v_cvt_pk_bf16_f32 v0, v8, v9
    v_cvt_pk_bf16_f32 v1, v10, v11
    v_smfmac_f32_16x16x64_bf16 v[16:19], v[52:55], v[208:215], v64
    s_waitcnt vmcnt(2)
    s_nop 2
    v_cvt_pk_bf16_f32 v2, v12, v13
    v_cvt_pk_bf16_f32 v3, v14, v15
    s_nop 1
    v_mfma_f32_16x16x32_bf16 v[12:15], v[0:3], v[0:3], 0
    s_nop 1
    v_bitop3_b32 v78, v73, -9, s53 bitop3:0x6a
    v_mfma_f32_16x16x32_bf16 v[4:7], v[24:27], v[0:3], 0
    ds_read_b128 v[24:27], v67 offset:0
    s_nop 1
    v_mfma_f32_16x16x32_bf16 v[8:11], v[28:31], v[0:3], 0
    s_nop 0
    v_mov_b32_dpp v12, v14 row_ror:8 row_mask:0xf bank_mask:0xc
    v_mov_b32_dpp v13, v15 row_ror:8 row_mask:0xf bank_mask:0xc
    v_smfmac_f32_16x16x64_bf16 v[20:23], v[52:55], v[216:223], v64
    ds_write_b64 v71, v[12:13]
    ds_read_b128 v[52:55], v68 offset:0
    s_nop 1
    v_mov_b32_dpp v4, v8 row_ror:8 row_mask:0xf bank_mask:0xc
    v_mov_b32_dpp v5, v9 row_ror:8 row_mask:0xf bank_mask:0xc
    v_mov_b32_dpp v6, v10 row_ror:8 row_mask:0xf bank_mask:0xc
    v_mov_b32_dpp v7, v11 row_ror:8 row_mask:0xf bank_mask:0xc
    v_smfmac_f32_16x16x64_bf16 v[16:19], v[44:47], v[224:231], v64
    ds_write_b128 v65, v[4:7] offset:8192
    v_smfmac_f32_16x16x64_bf16 v[20:23], v[44:47], v[232:239], v64
    s_waitcnt lgkmcnt(3)
    v_smfmac_f32_16x16x64_bf16 v[16:19], v[24:27], v[144:151], v64
    s_waitcnt vmcnt(1)
    v_smfmac_f32_16x16x64_bf16 v[20:23], v[24:27], v[152:159], v64
    s_mov_b64 exec, s[38:39]
    buffer_store_dword v72, v75, s[4:7], s55 offen sc1
    s_mov_b64 exec, -1
    v_smfmac_f32_16x16x64_bf16 v[16:19], v[40:43], v[240:247], v64
    s_cmp_ge_u32 s30, 56
    s_waitcnt lgkmcnt(0)
    s_barrier
    ds_read_b128 v[8:11], v66 offset:8192
    v_smfmac_f32_16x16x64_bf16 v[20:23], v[40:43], v[248:255], v64
    ds_read_b128 v[12:15], v67 offset:8192
    v_smfmac_f32_16x16x64_bf16 v[16:19], v[48:51], v[192:199], v64
    ds_read_b128 v[44:47], v68 offset:8192
    v_smfmac_f32_16x16x64_bf16 v[20:23], v[48:51], v[200:207], v64
    ds_read_b64 v[24:25], v77 offset:14336
    ds_read_b64 v[26:27], v77 offset:14592
    v_smfmac_f32_16x16x64_bf16 v[16:19], v[52:55], v[160:167], v64
    ds_read_b64 v[28:29], v77 offset:14848
    ds_read_b64 v[30:31], v77 offset:15104
    v_bitop3_b32 v77, v73, -9, s52 bitop3:0x6a
    v_smfmac_f32_16x16x64_bf16 v[20:23], v[52:55], v[168:175], v64
    s_cbranch_scc1 cf_rare
cf_rare_x:
    ds_read_b128 v[48:51], v70 offset:22528
    ds_read_b128 v[52:55], v70 offset:23552
    s_waitcnt lgkmcnt(6)
    v_pk_add_f32 v[4:5], v[4:5], v[8:9]
    v_pk_add_f32 v[6:7], v[6:7], v[10:11]
    v_pk_add_f32 v[12:13], v[12:13], v[44:45]
    v_pk_add_f32 v[14:15], v[14:15], v[46:47]
    v_pk_add_f32 v[4:5], v[4:5], v[12:13]
    v_pk_add_f32 v[6:7], v[6:7], v[14:15]
    s_waitcnt lgkmcnt(2)
    v_pk_add_f32 v[24:25], v[24:25], v[26:27]
    v_pk_add_f32 v[28:29], v[28:29], v[30:31]
    v_max3_f32 v8, v4, v5, v6
    v_pk_add_f32 v[24:25], v[24:25], v[28:29]
    v_max_f32 v8, v8, v7
    v_max3_f32 v8, v8, v24, v25
    v_cvt_pk_bf16_f32 v32, v16, v17
    v_cvt_pk_bf16_f32 v38, v18, v19
    v_max_f32_dpp v8, v8, v8 row_ror:8 row_mask:0xf bank_mask:0xf
    v_mov_b32 v9, v8
    v_cvt_pk_bf16_f32 v56, v20, v21
    v_cvt_pk_bf16_f32 v62, v22, v23
    v_permlane32_swap_b32 v8, v9
    v_max_f32 v8, v8, v9
    v_mov_b32 v9, v8
    v_mov_b32 v11, 0
    v_mov_b32 v15, 0
    v_permlane16_swap_b32 v8, v9
    v_max_f32 v8, v8, v9
    v_mul_f32 v8, s66, v8
    v_pk_fma_f32 v[4:5], v[4:5], s[44:45], v[8:9] op_sel_hi:[1,1,0]
    v_pk_fma_f32 v[6:7], v[6:7], s[44:45], v[8:9] op_sel_hi:[1,1,0]
    v_pk_fma_f32 v[24:25], v[24:25], s[44:45], v[8:9] op_sel_hi:[1,1,0]
    v_exp_f32 v4, v4
    v_exp_f32 v5, v5
    v_exp_f32 v6, v6
    v_exp_f32 v7, v7
    v_exp_f32 v24, v24
    v_exp_f32 v25, v25
    v_cvt_pk_bf16_f32 v12, v4, v5
    v_cvt_pk_bf16_f32 v13, v6, v7
    v_cvt_pk_bf16_f32 v10, v24, v25
    v_cvt_pk_bf16_f32 v14, v24, v25
    v_mov_b64 v[0:1], s[48:49]
    v_mfma_f32_16x16x32_bf16 v[4:7], v[32:35], v[10:13], 0
    ds_read_b128 v[40:43], v70 offset:20480
    v_mov_b64 v[2:3], s[50:51]
    v_mfma_f32_16x16x32_bf16 v[24:27], v[36:39], v[12:15], 0
    ds_read_b128 v[44:47], v70 offset:21504
    v_mov_b64 v[8:9], 0
    v_mfma_f32_16x16x32_bf16 v[28:31], v[0:3], v[10:13], 0
    ds_read_b128 v[32:35], v70 offset:24576
    v_mov_b64 v[0:1], 0
    v_mfma_f32_16x16x32_bf16 v[16:19], v[56:59], v[10:13], 0
    ds_read_b128 v[36:39], v70 offset:25600
    v_mov_b64 v[2:3], 0
    v_mfma_f32_16x16x32_bf16 v[20:23], v[60:63], v[12:15], 0
    ds_read_b128 v[56:59], v70 offset:28672
    v_add_f32_dpp v4, v24, v4 row_ror:8 row_mask:0xf bank_mask:0xf
    v_add_f32_dpp v5, v25, v5 row_ror:8 row_mask:0xf bank_mask:0xf
    v_add_f32_dpp v6, v26, v6 row_ror:8 row_mask:0xf bank_mask:0xf
    v_add_f32_dpp v7, v27, v7 row_ror:8 row_mask:0xf bank_mask:0xf
    v_add_f32_dpp v29, v28, v28 row_ror:8 row_mask:0xf bank_mask:0xf
    v_rcp_f32 v28, v29
    v_mov_b64 v[10:11], 0
    v_add_f32_dpp v4, v16, v20 row_ror:8 row_mask:0xf bank_mask:0xc
    v_add_f32_dpp v5, v17, v21 row_ror:8 row_mask:0xf bank_mask:0xc
    v_add_f32_dpp v6, v18, v22 row_ror:8 row_mask:0xf bank_mask:0xc
    v_add_f32_dpp v7, v19, v23 row_ror:8 row_mask:0xf bank_mask:0xc
    v_pk_mul_f32 v[4:5], v[4:5], v[28:29] op_sel_hi:[1,0]
    v_pk_mul_f32 v[6:7], v[6:7], v[28:29] op_sel_hi:[1,0]
    v_cvt_pk_bf16_f32 v4, v4, v5
    v_cvt_pk_bf16_f32 v5, v6, v7
    ds_write_b64 v73, v[4:5] offset:12288
    v_mov_b32_dpp v6, v4 row_ror:8 row_mask:0xf bank_mask:0xf
    v_mov_b32_dpp v7, v5 row_ror:8 row_mask:0xf bank_mask:0xf
    v_mov_b64 v[12:13], 0
    v_mov_b64 v[14:15], 0
    v_smfmac_f32_16x16x64_bf16 v[8:11], v[4:7], v[80:87], v64
    s_waitcnt lgkmcnt(4)
    v_mov_b64 v[24:25], 0
    v_smfmac_f32_16x16x64_bf16 v[0:3], v[4:7], v[40:47], v64
    ds_read_b128 v[60:63], v70 offset:29696
    v_mov_b64 v[26:27], 0
    v_smfmac_f32_16x16x64_bf16 v[12:15], v[4:7], v[112:119], v64
    s_waitcnt lgkmcnt(1)
    s_barrier
    ds_read_b128 v[16:19], v77 offset:12288
    v_smfmac_f32_16x16x64_bf16 v[24:27], v[4:7], v[48:55], v64
    ds_read_b128 v[20:23], v78 offset:12288
    ds_read_b128 v[28:31], v79 offset:12288
    v_mov_b64 v[4:5], 0
    v_mov_b64 v[6:7], 0
    v_bfe_u32 v77, v74, 16, 1
    v_mad_i32_i24 v77, v77, s56, v74
    s_waitcnt lgkmcnt(2)
    v_smfmac_f32_16x16x64_bf16 v[8:11], v[16:19], v[88:95], v64
    ds_read_b128 v[40:43], v70 offset:32768
    s_waitcnt lgkmcnt(2)
    v_smfmac_f32_16x16x64_bf16 v[8:11], v[20:23], v[96:103], v64
    ds_read_b128 v[44:47], v70 offset:33792
    s_waitcnt lgkmcnt(2)
    v_smfmac_f32_16x16x64_bf16 v[8:11], v[28:31], v[104:111], v64
    ds_read_b128 v[48:51], v70 offset:26624
    s_nop 0
    v_and_b32 v72, 8, v73
    v_smfmac_f32_16x16x64_bf16 v[0:3], v[16:19], v[32:39], v64
    ds_read_b128 v[52:55], v70 offset:27648
    s_nop 0
    v_mad_u32_u24 v72, v72, 63, v73
    v_smfmac_f32_16x16x64_bf16 v[12:15], v[16:19], v[120:127], v64
    ds_read_b128 v[32:35], v70 offset:30720
    v_cvt_pk_bf16_f32 v8, v8, v9
    v_cvt_pk_bf16_f32 v9, v10, v11
    v_and_or_b32 v8, v8, -2, s69
    v_smfmac_f32_16x16x64_bf16 v[12:15], v[20:23], v[128:135], v64
    buffer_store_dwordx2 v[8:9], v74, s[4:7], s22 offen offset:0
    ds_read_b128 v[36:39], v70 offset:31744
    v_smfmac_f32_16x16x64_bf16 v[12:15], v[28:31], v[136:143], v64
    s_add_u32 s30, s30, 1
    s_xor_b32 s70, s70, 1
    v_subrev_u32 v72, s47, v72
    v_smfmac_f32_16x16x64_bf16 v[0:3], v[20:23], v[56:63], v64
    ds_read_b128 v[56:59], v70 offset:34816
    s_waitcnt lgkmcnt(3)
    s_nop 0
    v_smfmac_f32_16x16x64_bf16 v[0:3], v[28:31], v[40:47], v64
    ds_read_b128 v[60:63], v70 offset:35840
    v_cvt_pk_bf16_f32 v12, v12, v13
    v_cvt_pk_bf16_f32 v13, v14, v15
    v_and_or_b32 v12, v12, -2, s69
    v_smfmac_f32_16x16x64_bf16 v[24:27], v[16:19], v[48:55], v64
    buffer_store_dwordx2 v[12:13], v74, s[4:7], s22 offen offset:64
    s_waitcnt lgkmcnt(2)
    v_smfmac_f32_16x16x64_bf16 v[24:27], v[20:23], v[32:39], v64
    ds_read_b128 v[40:43], v70 offset:16384
    v_cvt_pk_bf16_f32 v0, v0, v1
    v_cvt_pk_bf16_f32 v1, v2, v3
    v_and_or_b32 v0, v0, -2, s69
    s_waitcnt lgkmcnt(1)
    v_smfmac_f32_16x16x64_bf16 v[24:27], v[28:31], v[56:63], v64
    buffer_store_dwordx2 v[0:1], v74, s[4:7], s23 offen offset:0
    ds_read_b128 v[44:47], v70 offset:17408
    ds_read_b128 v[8:11], v72 offset:12288
    ds_read_b128 v[48:51], v70 offset:18432
    ds_read_b128 v[52:55], v70 offset:19456
    ds_read_b128 v[12:15], v72 offset:13312
    s_cmp_lg_u32 s71, 0
    s_nop 0
    v_cvt_pk_bf16_f32 v24, v24, v25
    v_cvt_pk_bf16_f32 v25, v26, v27
    v_and_or_b32 v24, v24, -2, s69
    buffer_store_dwordx2 v[24:25], v74, s[4:7], s23 offen offset:64
    s_waitcnt lgkmcnt(3)
    v_smfmac_f32_16x16x64_bf16 v[4:7], v[8:11], v[40:47], v64
    s_waitcnt lgkmcnt(0)
    v_smfmac_f32_16x16x64_bf16 v[4:7], v[12:15], v[48:55], v64
    s_nop 7
    v_cvt_pk_bf16_f32 v4, v4, v5
    v_cvt_pk_bf16_f32 v5, v6, v7
    v_and_or_b32 v4, v4, -2, s69
    buffer_store_dwordx2 v[4:5], v77, s[4:7], s25 offen offset:0
    s_nop 0
    s_cbranch_scc1 cf_e1
    s_cmp_lg_u32 s37, 0
    s_cbranch_scc1 cf_f0_xt
cf_f0_xtx:
    s_nop 2
    v_mov_b32 v79, v79
    s_nop 2
    v_mov_b32 v79, v79
    s_nop 2
    v_mov_b32 v79, v79
    s_nop 2
    v_mov_b32 v79, v79
    s_nop 2
    v_mov_b32 v79, v79
    s_nop 2
    v_mov_b32 v79, v79
    buffer_load_dwordx4 v[8:11], v65, s[4:7], s18 offen nt
    buffer_load_dwordx4 v[12:15], v65, s[4:7], s19 offen nt
    buffer_load_dwordx4 v[16:19], v65, s[4:7], s20 offen nt
    buffer_load_dwordx4 v[20:23], v65, s[4:7], s21 offen nt
    v_and_b32 v77, 255, v69
    ds_read_b128 v[4:7], v77 offset:15872
    ds_read_b128 v[44:47], v70 offset:0
    ds_read_b128 v[48:51], v70 offset:1024
    ds_read_b128 v[52:55], v70 offset:2048
    ds_read_b128 v[56:59], v70 offset:3072
    ds_read_b128 v[24:27], v70 offset:4096
    ds_read_b128 v[28:31], v70 offset:5120
    ds_read_b128 v[32:35], v70 offset:6144
    ds_read_b128 v[36:39], v70 offset:7168
    s_mov_b32 s31, 65536
    s_add_u32 s24, s24, 524288
    s_add_u32 s26, s26, 524288
    s_add_u32 s55, s55, s57
    s_mov_b32 s14, 67108864
    s_mov_b32 s15, 67112960
    s_mov_b32 s16, 67117056
    s_mov_b32 s36, 1
    v_mov_b32 v40, s69
    v_mov_b32 v60, s69
    v_and_b32 v79, 12, v75
    v_cmp_eq_u32 vcc, 0, v79
    s_nop 1
    v_cndmask_b32 v79, 0, 1, vcc
    s_waitcnt lgkmcnt(0)
    s_waitcnt vmcnt(3)
    v_bitop3_b32 v77, v8, v10, s69 bitop3:0x7e
    v_mfma_f32_16x16x32_bf16 v[0:3], v[4:7], v[8:11], 0
    v_mov_b64 v[8:9], 0
    v_mov_b64 v[10:11], 0
    s_waitcnt vmcnt(2)
    v_bitop3_b32 v78, v12, v14, s69 bitop3:0x7e
    v_mfma_f32_16x16x32_bf16 v[0:3], v[4:7], v[12:15], v[0:3]
    v_or_b32 v77, v77, v78
    v_mov_b64 v[12:13], 0
    v_mov_b64 v[14:15], 0
    s_waitcnt vmcnt(1)
    v_bitop3_b32 v78, v16, v18, s69 bitop3:0x7e
    v_mfma_f32_16x16x32_bf16 v[0:3], v[4:7], v[16:19], v[0:3]
    v_or_b32 v77, v77, v78
    v_mov_b64 v[16:17], 0
    v_mov_b64 v[18:19], 0
    s_waitcnt vmcnt(0)
    v_bitop3_b32 v78, v20, v22, s69 bitop3:0x7e
    v_mfma_f32_16x16x32_bf16 v[0:3], v[4:7], v[20:23], v[0:3]
    v_bitop3_b32 v77, v77, v78, 1 bitop3:0xa8
    v_cmp_ne_u32 vcc, 0, v77
    v_mov_b64 v[20:21], 0
    v_mov_b64 v[22:23], 0
    s_cmp_eq_u64 vcc, 0
    s_cselect_b64 s[42:43], -1, 0
    s_nop 1
    v_add_f32_dpp v0, v0, v0 row_ror:8 row_mask:0xf bank_mask:0xf
    v_add_f32_dpp v1, v1, v1 row_ror:8 row_mask:0xf bank_mask:0xf
    s_mov_b64 exec, s[42:43]
    v_cvt_pk_bf16_f32 v72, v0, v1
    v_bfi_b32 v72, v79, s70, v72
    buffer_store_dword v72, v75, s[4:7], s17 offen offset:0
    s_mov_b64 exec, -1
    s_cbranch_scc0 cf_f0_retry
cf_f0_go:
    v_mov_b64 v[0:1], 0
    v_mov_b64 v[2:3], 0
    v_mov_b64 v[4:5], 0
    v_mov_b64 v[6:7], 0
    s_nop 2
    v_mov_b32 v79, v79
    s_nop 2
    v_mov_b32 v79, v79
    s_nop 2
    v_mov_b32 v79, v79
    s_nop 2
    v_mov_b32 v79, v79
    s_branch cf_loop
cf_e1:
    s_cmp_lg_u32 s71, 2
    s_cbranch_scc1 cf_f1
    v_and_b32 v77, 255, v69
    ds_read_b128 v[4:7], v77 offset:15872
    ds_read_b128 v[44:47], v70 offset:0
    ds_read_b128 v[48:51], v70 offset:1024
    ds_read_b128 v[52:55], v70 offset:2048
    ds_read_b128 v[56:59], v70 offset:3072
    ds_read_b128 v[24:27], v70 offset:4096
    ds_read_b128 v[28:31], v70 offset:5120
    ds_read_b128 v[32:35], v70 offset:6144
    ds_read_b128 v[36:39], v70 offset:7168
    s_mov_b32 s31, 65536
    s_add_u32 s24, s24, 524288
    s_add_u32 s26, s26, 524288
    s_add_u32 s55, s55, s57
    s_mov_b32 s14, 67108864
    s_mov_b32 s15, 67112960
    s_mov_b32 s16, 67117056
    s_mov_b32 s36, 1
    v_mov_b32 v40, s69
    v_mov_b32 v60, s69
    v_and_b32 v79, 12, v75
    v_cmp_eq_u32 vcc, 0, v79
    s_nop 1
    v_cndmask_b32 v79, 0, 1, vcc
    s_cmp_lg_u32 s37, 0
    s_cbranch_scc1 cf_f2_xt
cf_f2_xtx:
    s_nop 2
    v_mov_b32 v79, v79
    s_nop 2
    v_mov_b32 v79, v79
    s_nop 2
    v_mov_b32 v79, v79
    s_nop 2
    v_mov_b32 v79, v79
    s_nop 2
    v_mov_b32 v79, v79
    s_nop 2
    v_mov_b32 v79, v79
    s_nop 2
    v_mov_b32 v79, v79
    s_nop 2
    v_mov_b32 v79, v79
    s_nop 2
    v_mov_b32 v79, v79
    s_waitcnt vmcnt(0)
    buffer_load_dwordx4 v[8:11], v65, s[4:7], s18 offen nt
    buffer_load_dwordx4 v[12:15], v65, s[4:7], s19 offen nt
    buffer_load_dwordx4 v[16:19], v65, s[4:7], s20 offen nt
    buffer_load_dwordx4 v[20:23], v65, s[4:7], s21 offen nt
    s_nop 2
    v_mov_b32 v79, v79
    s_nop 2
    v_mov_b32 v79, v79
    s_nop 2
    v_mov_b32 v79, v79
    s_nop 2
    v_mov_b32 v79, v79
    s_nop 2
    v_mov_b32 v79, v79
    s_nop 2
    v_mov_b32 v79, v79
    s_nop 2
    v_mov_b32 v79, v79
    s_nop 2
    v_mov_b32 v79, v79
    s_nop 2
    v_mov_b32 v79, v79
    s_nop 2
    v_mov_b32 v79, v79
    buffer_load_dwordx4 v[40:43], v65, s[4:7], s14 offen offset:0 nt
    buffer_load_dwordx4 v[60:63], v66, s[4:7], s14 offen offset:0 nt
    s_waitcnt lgkmcnt(0)
    s_waitcnt vmcnt(5)
    v_bitop3_b32 v77, v8, v10, s69 bitop3:0x7e
    v_mfma_f32_16x16x32_bf16 v[0:3], v[4:7], v[8:11], 0
    v_mov_b64 v[8:9], 0
    v_mov_b64 v[10:11], 0
    s_waitcnt vmcnt(4)
    v_bitop3_b32 v78, v12, v14, s69 bitop3:0x7e
    v_mfma_f32_16x16x32_bf16 v[0:3], v[4:7], v[12:15], v[0:3]
    v_or_b32 v77, v77, v78
    v_mov_b64 v[12:13], 0
    v_mov_b64 v[14:15], 0
    s_waitcnt vmcnt(3)
    v_bitop3_b32 v78, v16, v18, s69 bitop3:0x7e
    v_mfma_f32_16x16x32_bf16 v[0:3], v[4:7], v[16:19], v[0:3]
    v_or_b32 v77, v77, v78
    v_mov_b64 v[16:17], 0
    v_mov_b64 v[18:19], 0
    s_waitcnt vmcnt(2)
    v_bitop3_b32 v78, v20, v22, s69 bitop3:0x7e
    v_mfma_f32_16x16x32_bf16 v[0:3], v[4:7], v[20:23], v[0:3]
    v_bitop3_b32 v77, v77, v78, 1 bitop3:0xa8
    v_cmp_ne_u32 vcc, 0, v77
    v_mov_b64 v[20:21], 0
    v_mov_b64 v[22:23], 0
    buffer_load_dwordx4 v[40:43], v65, s[4:7], s14 offen offset:0 nt
    buffer_load_dwordx4 v[60:63], v66, s[4:7], s14 offen offset:0 nt
    s_cmp_eq_u64 vcc, 0
    s_cselect_b64 s[42:43], -1, 0
    v_add_f32_dpp v0, v0, v0 row_ror:4 row_mask:0xf bank_mask:0xf
    v_add_f32_dpp v1, v1, v1 row_ror:4 row_mask:0xf bank_mask:0xf
    s_nop 0
    v_add_f32_dpp v0, v0, v0 row_ror:8 row_mask:0xf bank_mask:0xf
    v_add_f32_dpp v1, v1, v1 row_ror:8 row_mask:0xf bank_mask:0xf
    s_mov_b64 exec, s[42:43]
    v_cvt_pk_bf16_f32 v72, v0, v1
    v_bfi_b32 v72, v79, s70, v72
    buffer_store_dword v72, v75, s[4:7], s17 offen offset:0
    buffer_store_dword v72, v75, s[4:7], s17 offen offset:1024
    buffer_store_dword v72, v75, s[4:7], s17 offen offset:2048
    buffer_store_dword v72, v75, s[4:7], s17 offen offset:3072
    s_mov_b64 exec, -1
    s_cbranch_scc0 cf_f2_retry
cf_f2_go:
    v_mov_b64 v[0:1], 0
    v_mov_b64 v[2:3], 0
    v_mov_b64 v[4:5], 0
    v_mov_b64 v[6:7], 0
    s_branch cf_loop
cf_f1:
    s_cmp_lg_u32 s32, 1
    s_cbranch_scc1 cf_f3
    v_and_b32 v77, 255, v69
    ds_read_b128 v[4:7], v77 offset:15872
    ds_read_b128 v[44:47], v70 offset:0
    ds_read_b128 v[48:51], v70 offset:1024
    ds_read_b128 v[52:55], v70 offset:2048
    ds_read_b128 v[56:59], v70 offset:3072
    ds_read_b128 v[24:27], v70 offset:4096
    ds_read_b128 v[28:31], v70 offset:5120
    ds_read_b128 v[32:35], v70 offset:6144
    ds_read_b128 v[36:39], v70 offset:7168
    s_mov_b32 s31, 65536
    s_add_u32 s24, s24, 524288
    s_add_u32 s26, s26, 524288
    s_add_u32 s55, s55, s57
    s_mov_b32 s14, 67108864
    s_mov_b32 s15, 67112960
    s_mov_b32 s16, 67117056
    s_mov_b32 s36, 1
    v_mov_b32 v40, s69
    v_mov_b32 v60, s69
    v_and_b32 v79, 12, v75
    v_cmp_eq_u32 vcc, 0, v79
    s_nop 1
    v_cndmask_b32 v79, 0, 1, vcc
    s_cmp_lg_u32 s37, 0
    s_cbranch_scc1 cf_f1_xt
cf_f1_xtx:
    s_nop 2
    v_mov_b32 v79, v79
    s_waitcnt vmcnt(0)
    buffer_load_dwordx4 v[8:11], v65, s[4:7], s18 offen nt
    buffer_load_dwordx4 v[12:15], v65, s[4:7], s19 offen nt
    buffer_load_dwordx4 v[16:19], v65, s[4:7], s20 offen nt
    buffer_load_dwordx4 v[20:23], v65, s[4:7], s21 offen nt
    s_nop 2
    v_mov_b32 v79, v79
    s_nop 2
    v_mov_b32 v79, v79
    s_nop 2
    v_mov_b32 v79, v79
    s_nop 2
    v_mov_b32 v79, v79
    s_nop 2
    v_mov_b32 v79, v79
    s_nop 2
    v_mov_b32 v79, v79
    s_nop 2
    v_mov_b32 v79, v79
    s_nop 2
    v_mov_b32 v79, v79
    s_nop 2
    v_mov_b32 v79, v79
    s_nop 2
    v_mov_b32 v79, v79
    buffer_load_dwordx4 v[40:43], v65, s[4:7], s14 offen offset:0 nt
    buffer_load_dwordx4 v[60:63], v66, s[4:7], s14 offen offset:0 nt
    s_waitcnt lgkmcnt(0)
    s_waitcnt vmcnt(5)
    v_bitop3_b32 v77, v8, v10, s69 bitop3:0x7e
    v_mfma_f32_16x16x32_bf16 v[0:3], v[4:7], v[8:11], 0
    v_mov_b64 v[8:9], 0
    v_mov_b64 v[10:11], 0
    s_waitcnt vmcnt(4)
    v_bitop3_b32 v78, v12, v14, s69 bitop3:0x7e
    v_mfma_f32_16x16x32_bf16 v[0:3], v[4:7], v[12:15], v[0:3]
    v_or_b32 v77, v77, v78
    v_mov_b64 v[12:13], 0
    v_mov_b64 v[14:15], 0
    s_waitcnt vmcnt(3)
    v_bitop3_b32 v78, v16, v18, s69 bitop3:0x7e
    v_mfma_f32_16x16x32_bf16 v[0:3], v[4:7], v[16:19], v[0:3]
    v_or_b32 v77, v77, v78
    v_mov_b64 v[16:17], 0
    v_mov_b64 v[18:19], 0
    s_waitcnt vmcnt(2)
    v_bitop3_b32 v78, v20, v22, s69 bitop3:0x7e
    v_mfma_f32_16x16x32_bf16 v[0:3], v[4:7], v[20:23], v[0:3]
    v_bitop3_b32 v77, v77, v78, 1 bitop3:0xa8
    v_cmp_ne_u32 vcc, 0, v77
    v_mov_b64 v[20:21], 0
    v_mov_b64 v[22:23], 0
    buffer_load_dwordx4 v[40:43], v65, s[4:7], s14 offen offset:0 nt
    buffer_load_dwordx4 v[60:63], v66, s[4:7], s14 offen offset:0 nt
    s_cmp_eq_u64 vcc, 0
    s_cselect_b64 s[42:43], -1, 0
    v_add_f32_dpp v0, v0, v0 row_ror:8 row_mask:0xf bank_mask:0xf
    v_add_f32_dpp v1, v1, v1 row_ror:8 row_mask:0xf bank_mask:0xf
    s_mov_b64 exec, s[42:43]
    v_cvt_pk_bf16_f32 v72, v0, v1
    v_bfi_b32 v72, v79, s70, v72
    buffer_store_dword v72, v75, s[4:7], s17 offen offset:0
    s_mov_b64 exec, -1
    s_cbranch_scc0 cf_f1_retry
cf_f1_go:
    v_mov_b64 v[0:1], 0
    v_mov_b64 v[2:3], 0
    v_mov_b64 v[4:5], 0
    v_mov_b64 v[6:7], 0
    s_branch cf_loop
cf_f3:
    v_and_b32 v77, 255, v69
    ds_read_b128 v[4:7], v77 offset:15872
    ds_read_b128 v[44:47], v70 offset:0
    ds_read_b128 v[48:51], v70 offset:1024
    ds_read_b128 v[52:55], v70 offset:2048
    ds_read_b128 v[56:59], v70 offset:3072
    ds_read_b128 v[24:27], v70 offset:4096
    ds_read_b128 v[28:31], v70 offset:5120
    ds_read_b128 v[32:35], v70 offset:6144
    ds_read_b128 v[36:39], v70 offset:7168
    s_mov_b32 s31, 65536
    s_add_u32 s24, s24, 524288
    s_add_u32 s26, s26, 524288
    s_add_u32 s55, s55, s57
    s_mov_b32 s14, 67108864
    s_mov_b32 s15, 67112960
    s_mov_b32 s16, 67117056
    s_mov_b32 s36, 1
    v_mov_b32 v40, s69
    v_mov_b32 v60, s69
    v_and_b32 v79, 12, v75
    v_cmp_eq_u32 vcc, 0, v79
    s_nop 1
    v_cndmask_b32 v79, 0, 1, vcc
    s_add_u32 s40, s30, s95
    v_mov_b32 v72, s40
    s_waitcnt lgkmcnt(0)
    v_mov_b64 v[0:1], 0
    v_mov_b64 v[2:3], 0
    v_mov_b64 v[4:5], 0
    v_mov_b64 v[6:7], 0
    v_mov_b64 v[8:9], 0
    v_mov_b64 v[10:11], 0
    v_mov_b64 v[12:13], 0
    v_mov_b64 v[14:15], 0
    v_mov_b64 v[16:17], 0
    v_mov_b64 v[18:19], 0
    v_mov_b64 v[20:21], 0
    v_mov_b64 v[22:23], 0
    s_nop 2
    v_mov_b32 v79, v79
    s_nop 2
    v_mov_b32 v79, v79
    s_nop 2
    v_mov_b32 v79, v79
    s_nop 2
    v_mov_b32 v79, v79
    s_nop 2
    v_mov_b32 v79, v79
    s_nop 2
    v_mov_b32 v79, v79
    s_nop 2
    v_mov_b32 v79, v79
    s_nop 2
    v_mov_b32 v79, v79
    s_nop 2
    v_mov_b32 v79, v79
    s_nop 2
    v_mov_b32 v79, v79
    s_waitcnt vmcnt(0)
    s_mov_b32 s40, s67
    s_add_u32 s67, s30, 5
    s_min_u32 s67, s67, s93
    s_cmp_lt_u32 s97, s40
    s_cbranch_scc1 cf_kvwait
    s_nop 2
    v_mov_b32 v79, v79
    s_nop 2
    v_mov_b32 v79, v79
    s_nop 2
    v_mov_b32 v79, v79
    s_nop 2
    v_mov_b32 v79, v79
    s_nop 2
    v_mov_b32 v79, v79
    s_nop 2
    v_mov_b32 v79, v79
    s_nop 2
    v_mov_b32 v79, v79
    s_nop 2
    v_mov_b32 v79, v79
cf_kvok:
    s_branch cf_loop
cf_f0_xt:
    s_sub_u32 s37, s37, 1
    s_nop 2
    v_mov_b32 v79, v79
    s_nop 2
    v_mov_b32 v79, v79
    s_nop 2
    v_mov_b32 v79, v79
    s_nop 2
    v_mov_b32 v79, v79
    s_nop 2
    v_mov_b32 v79, v79
    s_nop 2
    v_mov_b32 v79, v79
    s_branch cf_f0_xtx
cf_f0_retry:
    s_sub_u32 s41, s30, s98
    s_mov_b32 s98, s30
    s_cmp_le_u32 s41, 3
    s_cselect_b32 s37, 1, 1
cf_f0_spin:
    buffer_load_dwordx4 v[8:11], v65, s[4:7], s18 offen nt
    buffer_load_dwordx4 v[12:15], v65, s[4:7], s19 offen nt
    buffer_load_dwordx4 v[16:19], v65, s[4:7], s20 offen nt
    buffer_load_dwordx4 v[20:23], v65, s[4:7], s21 offen nt
    s_nop 2
    v_mov_b32 v79, v79
    s_nop 2
    v_mov_b32 v79, v79
    s_nop 2
    v_mov_b32 v79, v79
    buffer_load_dwordx4 v[40:43], v65, s[4:7], s14 offen offset:0 nt
    buffer_load_dwordx4 v[60:63], v66, s[4:7], s14 offen offset:0 nt
    s_waitcnt vmcnt(5)
    v_bitop3_b32 v77, v8, v10, s69 bitop3:0x7e
    v_mfma_f32_16x16x32_bf16 v[0:3], v[4:7], v[8:11], 0
    v_mov_b64 v[8:9], 0
    v_mov_b64 v[10:11], 0
    s_waitcnt vmcnt(4)
    v_bitop3_b32 v78, v12, v14, s69 bitop3:0x7e
    v_mfma_f32_16x16x32_bf16 v[0:3], v[4:7], v[12:15], v[0:3]
    v_or_b32 v77, v77, v78
    v_mov_b64 v[12:13], 0
    v_mov_b64 v[14:15], 0
    s_waitcnt vmcnt(3)
    v_bitop3_b32 v78, v16, v18, s69 bitop3:0x7e
    v_mfma_f32_16x16x32_bf16 v[0:3], v[4:7], v[16:19], v[0:3]
    v_or_b32 v77, v77, v78
    v_mov_b64 v[16:17], 0
    v_mov_b64 v[18:19], 0
    s_waitcnt vmcnt(2)
    v_bitop3_b32 v78, v20, v22, s69 bitop3:0x7e
    v_mfma_f32_16x16x32_bf16 v[0:3], v[4:7], v[20:23], v[0:3]
    v_bitop3_b32 v77, v77, v78, 1 bitop3:0xa8
    v_cmp_ne_u32 vcc, 0, v77
    v_mov_b64 v[20:21], 0
    v_mov_b64 v[22:23], 0
    buffer_load_dwordx4 v[40:43], v65, s[4:7], s14 offen offset:0 nt
    buffer_load_dwordx4 v[60:63], v66, s[4:7], s14 offen offset:0 nt
    s_cmp_eq_u64 vcc, 0
    s_cselect_b64 s[42:43], -1, 0
    v_add_f32_dpp v0, v0, v0 row_ror:8 row_mask:0xf bank_mask:0xf
    v_add_f32_dpp v1, v1, v1 row_ror:8 row_mask:0xf bank_mask:0xf
    s_mov_b64 exec, s[42:43]
    v_cvt_pk_bf16_f32 v72, v0, v1
    v_bfi_b32 v72, v79, s70, v72
    buffer_store_dword v72, v75, s[4:7], s17 offen offset:0
    s_mov_b64 exec, -1
    s_cbranch_scc1 cf_f0_rx
    s_sub_u32 s31, s31, 1
    s_cbranch_scc0 cf_f0_spin
cf_f0_rx:
    v_mov_b64 v[0:1], 0
    v_mov_b64 v[2:3], 0
    v_mov_b64 v[4:5], 0
    v_mov_b64 v[6:7], 0
    s_branch cf_loop
cf_f1_xt:
    s_sub_u32 s37, s37, 1
    s_nop 2
    v_mov_b32 v79, v79
    s_nop 2
    v_mov_b32 v79, v79
    s_nop 2
    v_mov_b32 v79, v79
    s_nop 2
    v_mov_b32 v79, v79
    s_nop 2
    v_mov_b32 v79, v79
    s_nop 2
    v_mov_b32 v79, v79
    s_branch cf_f1_xtx
cf_f1_retry:
    s_sub_u32 s41, s30, s98
    s_mov_b32 s98, s30
    s_cmp_le_u32 s41, 3
    s_cselect_b32 s37, 1, 1
cf_f1_spin:
    buffer_load_dwordx4 v[8:11], v65, s[4:7], s18 offen nt
    buffer_load_dwordx4 v[12:15], v65, s[4:7], s19 offen nt
    buffer_load_dwordx4 v[16:19], v65, s[4:7], s20 offen nt
    buffer_load_dwordx4 v[20:23], v65, s[4:7], s21 offen nt
    s_nop 2
    v_mov_b32 v79, v79
    s_nop 2
    v_mov_b32 v79, v79
    s_nop 2
    v_mov_b32 v79, v79
    buffer_load_dwordx4 v[40:43], v65, s[4:7], s14 offen offset:0 nt
    buffer_load_dwordx4 v[60:63], v66, s[4:7], s14 offen offset:0 nt
    s_waitcnt vmcnt(5)
    v_bitop3_b32 v77, v8, v10, s69 bitop3:0x7e
    v_mfma_f32_16x16x32_bf16 v[0:3], v[4:7], v[8:11], 0
    v_mov_b64 v[8:9], 0
    v_mov_b64 v[10:11], 0
    s_waitcnt vmcnt(4)
    v_bitop3_b32 v78, v12, v14, s69 bitop3:0x7e
    v_mfma_f32_16x16x32_bf16 v[0:3], v[4:7], v[12:15], v[0:3]
    v_or_b32 v77, v77, v78
    v_mov_b64 v[12:13], 0
    v_mov_b64 v[14:15], 0
    s_waitcnt vmcnt(3)
    v_bitop3_b32 v78, v16, v18, s69 bitop3:0x7e
    v_mfma_f32_16x16x32_bf16 v[0:3], v[4:7], v[16:19], v[0:3]
    v_or_b32 v77, v77, v78
    v_mov_b64 v[16:17], 0
    v_mov_b64 v[18:19], 0
    s_waitcnt vmcnt(2)
    v_bitop3_b32 v78, v20, v22, s69 bitop3:0x7e
    v_mfma_f32_16x16x32_bf16 v[0:3], v[4:7], v[20:23], v[0:3]
    v_bitop3_b32 v77, v77, v78, 1 bitop3:0xa8
    v_cmp_ne_u32 vcc, 0, v77
    v_mov_b64 v[20:21], 0
    v_mov_b64 v[22:23], 0
    buffer_load_dwordx4 v[40:43], v65, s[4:7], s14 offen offset:0 nt
    buffer_load_dwordx4 v[60:63], v66, s[4:7], s14 offen offset:0 nt
    s_cmp_eq_u64 vcc, 0
    s_cselect_b64 s[42:43], -1, 0
    v_add_f32_dpp v0, v0, v0 row_ror:8 row_mask:0xf bank_mask:0xf
    v_add_f32_dpp v1, v1, v1 row_ror:8 row_mask:0xf bank_mask:0xf
    s_mov_b64 exec, s[42:43]
    v_cvt_pk_bf16_f32 v72, v0, v1
    v_bfi_b32 v72, v79, s70, v72
    buffer_store_dword v72, v75, s[4:7], s17 offen offset:0
    s_mov_b64 exec, -1
    s_cbranch_scc1 cf_f1_rx
    s_sub_u32 s31, s31, 1
    s_cbranch_scc0 cf_f1_spin
cf_f1_rx:
    v_mov_b64 v[0:1], 0
    v_mov_b64 v[2:3], 0
    v_mov_b64 v[4:5], 0
    v_mov_b64 v[6:7], 0
    s_branch cf_loop
cf_f2_xt:
    s_sub_u32 s37, s37, 1
    s_nop 2
    v_mov_b32 v79, v79
    s_nop 2
    v_mov_b32 v79, v79
    s_nop 2
    v_mov_b32 v79, v79
    s_nop 2
    v_mov_b32 v79, v79
    s_nop 2
    v_mov_b32 v79, v79
    s_nop 2
    v_mov_b32 v79, v79
    s_branch cf_f2_xtx
cf_f2_retry:
    s_sub_u32 s41, s30, s98
    s_mov_b32 s98, s30
    s_cmp_le_u32 s41, 3
    s_cselect_b32 s37, 1, 1
cf_f2_spin:
    buffer_load_dwordx4 v[8:11], v65, s[4:7], s18 offen nt
    buffer_load_dwordx4 v[12:15], v65, s[4:7], s19 offen nt
    buffer_load_dwordx4 v[16:19], v65, s[4:7], s20 offen nt
    buffer_load_dwordx4 v[20:23], v65, s[4:7], s21 offen nt
    s_nop 2
    v_mov_b32 v79, v79
    s_nop 2
    v_mov_b32 v79, v79
    s_nop 2
    v_mov_b32 v79, v79
    buffer_load_dwordx4 v[40:43], v65, s[4:7], s14 offen offset:0 nt
    buffer_load_dwordx4 v[60:63], v66, s[4:7], s14 offen offset:0 nt
    s_waitcnt vmcnt(5)
    v_bitop3_b32 v77, v8, v10, s69 bitop3:0x7e
    v_mfma_f32_16x16x32_bf16 v[0:3], v[4:7], v[8:11], 0
    v_mov_b64 v[8:9], 0
    v_mov_b64 v[10:11], 0
    s_waitcnt vmcnt(4)
    v_bitop3_b32 v78, v12, v14, s69 bitop3:0x7e
    v_mfma_f32_16x16x32_bf16 v[0:3], v[4:7], v[12:15], v[0:3]
    v_or_b32 v77, v77, v78
    v_mov_b64 v[12:13], 0
    v_mov_b64 v[14:15], 0
    s_waitcnt vmcnt(3)
    v_bitop3_b32 v78, v16, v18, s69 bitop3:0x7e
    v_mfma_f32_16x16x32_bf16 v[0:3], v[4:7], v[16:19], v[0:3]
    v_or_b32 v77, v77, v78
    v_mov_b64 v[16:17], 0
    v_mov_b64 v[18:19], 0
    s_waitcnt vmcnt(2)
    v_bitop3_b32 v78, v20, v22, s69 bitop3:0x7e
    v_mfma_f32_16x16x32_bf16 v[0:3], v[4:7], v[20:23], v[0:3]
    v_bitop3_b32 v77, v77, v78, 1 bitop3:0xa8
    v_cmp_ne_u32 vcc, 0, v77
    v_mov_b64 v[20:21], 0
    v_mov_b64 v[22:23], 0
    buffer_load_dwordx4 v[40:43], v65, s[4:7], s14 offen offset:0 nt
    buffer_load_dwordx4 v[60:63], v66, s[4:7], s14 offen offset:0 nt
    s_cmp_eq_u64 vcc, 0
    s_cselect_b64 s[42:43], -1, 0
    v_add_f32_dpp v0, v0, v0 row_ror:4 row_mask:0xf bank_mask:0xf
    v_add_f32_dpp v1, v1, v1 row_ror:4 row_mask:0xf bank_mask:0xf
    s_nop 0
    v_add_f32_dpp v0, v0, v0 row_ror:8 row_mask:0xf bank_mask:0xf
    v_add_f32_dpp v1, v1, v1 row_ror:8 row_mask:0xf bank_mask:0xf
    s_mov_b64 exec, s[42:43]
    v_cvt_pk_bf16_f32 v72, v0, v1
    v_bfi_b32 v72, v79, s70, v72
    buffer_store_dword v72, v75, s[4:7], s17 offen offset:0
    buffer_store_dword v72, v75, s[4:7], s17 offen offset:1024
    buffer_store_dword v72, v75, s[4:7], s17 offen offset:2048
    buffer_store_dword v72, v75, s[4:7], s17 offen offset:3072
    s_mov_b64 exec, -1
    s_cbranch_scc1 cf_f2_rx
    s_sub_u32 s31, s31, 1
    s_cbranch_scc0 cf_f2_spin
cf_f2_rx:
    v_mov_b64 v[0:1], 0
    v_mov_b64 v[2:3], 0
    v_mov_b64 v[4:5], 0
    v_mov_b64 v[6:7], 0
    s_branch cf_loop
cf_spinB:
    s_waitcnt vmcnt(3)
cf_spinB_l:
    v_and_b32 v77, s36, v44
    v_cmp_ne_u32 vcc, s70, v77
    s_cbranch_vccz cf_spinB_x
    buffer_load_dwordx4 v[44:47], v65, s[4:7], s15 offen nt
    s_sub_u32 s31, s31, 16
    s_waitcnt vmcnt(0)
    s_cbranch_scc0 cf_spinB_l
cf_spinB_x:
    ds_write_b128 v65, v[44:47] offset:4096
    s_waitcnt lgkmcnt(0)
    s_branch cf_backB
cf_spin8:
    buffer_load_dwordx4 v[40:43], v65, s[4:7], s16 offen nt
cf_spin8_l:
    v_and_b32 v77, s36, v40
    v_cmp_ne_u32 vcc, s70, v77
    s_cbranch_vccz cf_spin8_x
    s_nop 1
    v_and_b32 v77, s36, v40
    v_cmp_ne_u32 vcc, s70, v77
    s_cbranch_vccz cf_spin8_x
    s_nop 1
    v_and_b32 v77, s36, v40
    v_cmp_ne_u32 vcc, s70, v77
    s_cbranch_vccz cf_spin8_x
    s_nop 1
    buffer_load_dwordx4 v[40:43], v65, s[4:7], s16 offen nt
    s_sub_u32 s31, s31, 16
    s_cbranch_scc0 cf_spin8_l
cf_spin8_x:
    s_branch cf_back8
cf_rare:
    s_mov_b64 exec, s[34:35]
    buffer_store_dwordx4 v[0:3], v65, s[4:7], s28 offen sc1
    s_mov_b64 exec, -1
    s_nop 3
    v_cvt_pk_bf16_f32 v52, v16, v17
    v_cvt_pk_bf16_f32 v53, v18, v19
    v_cvt_pk_bf16_f32 v54, v20, v21
    v_cvt_pk_bf16_f32 v55, v22, v23
    buffer_store_dwordx4 v[52:55], v65, s[4:7], s27 offen sc1
    s_add_u32 s28, s28, 131072
    s_add_u32 s27, s27, 131072
    s_cmp_eq_u32 s30, 63
    s_cbranch_scc1 cf_last
    s_branch cf_rare_x
cf_kvwait:
    s_mov_b32 s41, s97
    v_bfe_u32 v78, v65, 4, 3
    v_lshlrev_b32 v78, 7, v78
    v_mov_b32 v77, v76
    s_nop 1
    v_permlane32_swap_b32 v76, v77
    v_subrev_u32 v77, s95, v77
    v_cmp_lt_u32 vcc, 16, v77
    s_nop 1
    v_cndmask_b32 v77, v77, 0, vcc
    v_bfe_u32 v79, v78, 7, 2
    v_lshl_add_u32 v77, v77, 2, v79
    s_nop 1
    v_min_u32_dpp v77, v77, v77 row_ror:1 row_mask:0xf bank_mask:0xf
    s_nop 1
    v_min_u32_dpp v77, v77, v77 row_ror:2 row_mask:0xf bank_mask:0xf
    s_nop 1
    v_min_u32_dpp v77, v77, v77 row_ror:4 row_mask:0xf bank_mask:0xf
    s_nop 0
    v_readfirstlane_b32 s97, v77
    s_nop 0
    s_max_u32 s97, s97, s41
    s_add_u32 s40, s30, 3
    s_min_u32 s40, s40, 64
    s_cmp_le_u32 s40, s97
    s_cbranch_scc1 cf_kvw_x
    v_bfe_u32 v78, v65, 4, 3
    v_lshlrev_b32 v78, 7, v78
    s_mov_b32 s31, 4194304
cf_kvw:
    buffer_load_dword v77, v78, s[4:7], s96 offen sc1
    s_waitcnt vmcnt(0)
    v_subrev_u32 v77, s95, v77
    v_cmp_lt_u32 vcc, 16, v77
    s_nop 1
    v_cndmask_b32 v77, v77, 0, vcc
    v_bfe_u32 v79, v78, 7, 2
    v_lshl_add_u32 v77, v77, 2, v79
    s_nop 1
    v_min_u32_dpp v77, v77, v77 row_ror:1 row_mask:0xf bank_mask:0xf
    s_nop 1
    v_min_u32_dpp v77, v77, v77 row_ror:2 row_mask:0xf bank_mask:0xf
    s_nop 1
    v_min_u32_dpp v77, v77, v77 row_ror:4 row_mask:0xf bank_mask:0xf
    s_nop 0
    v_readfirstlane_b32 s97, v77
    s_sub_u32 s31, s31, 1
    s_cbranch_scc1 cf_kvw_x
    s_cmp_le_u32 s40, s97
    s_cbranch_scc1 cf_kvw_x
    s_sleep 2
    s_branch cf_kvw
cf_kvw_x:
    s_branch cf_kvok
cf_last:
    s_add_u32 s40, s95, 64
    v_mov_b32 v78, s40
    s_waitcnt vmcnt(0)
    s_barrier
    s_mov_b64 exec, s[100:101]
    buffer_store_dword v78, off, s[4:7], s29 sc1
    s_mov_b64 exec, -1
cf_end:
    s_endpgm
L_chain_safe:
    s_mov_b64 s[48:49], s[50:51]
    s_mov_b64 s[50:51], s[52:53]
    s_mov_b64 s[52:53], s[54:55]
    s_mov_b64 s[54:55], s[56:57]
    s_mov_b64 s[56:57], s[58:59]
    v_lshrrev_b32 v77, 6, v0
    s_nop 0
    v_readfirstlane_b32 s13, v77
    v_lshlrev_b32 v65, 4, v0
    v_and_b32 v48, 63, v0
    s_mov_b32 s10, 4718592
    s_mov_b32 s11, 0x20000
    v_lshrrev_b32 v49, 3, v48
    v_mul_u32_u24 v18, 1152, v49
    v_and_b32 v49, 7, v48
    v_lshl_add_u32 v18, v49, 4, v18
    s_mul_i32 s40, s12, 147456
    s_lshl_b32 s41, s13, 8
    s_add_u32 s40, s40, s41
    s_mov_b32 s42, s40
    s_xor_b32 s41, s13, 0
    s_mul_i32 s41, s41, 36864
    s_add_u32 s60, s41, s40
    s_xor_b32 s41, s13, 1
    s_mul_i32 s41, s41, 36864
    s_add_u32 s61, s41, s40
    s_xor_b32 s41, s13, 2
    s_mul_i32 s41, s41, 36864
    s_add_u32 s62, s41, s40
    s_xor_b32 s41, s13, 3
    s_mul_i32 s41, s41, 36864
    s_add_u32 s63, s41, s40
    s_lshl_b32 s43, s13, 12
    s_mov_b64 s[8:9], s[56:57]
    s_add_u32 m0, s43, 147456
    s_add_u32 s41, s60, 0
    buffer_load_dwordx4 v18, s[8:11], s41 offen offset:0 nt lds
    s_add_u32 s41, s60, 8192
    buffer_load_dwordx4 v18, s[8:11], s41 offen offset:1024 nt lds
    s_add_u32 s41, s60, 16384
    buffer_load_dwordx4 v18, s[8:11], s41 offen offset:2048 nt lds
    s_add_u32 s41, s60, 24576
    buffer_load_dwordx4 v18, s[8:11], s41 offen offset:3072 nt lds
    s_add_u32 m0, s43, 0
    s_add_u32 s41, s61, 0
    buffer_load_dwordx4 v18, s[8:11], s41 offen offset:0 nt lds
    s_add_u32 s41, s61, 8192
    buffer_load_dwordx4 v18, s[8:11], s41 offen offset:1024 nt lds
    s_add_u32 s41, s61, 16384
    buffer_load_dwordx4 v18, s[8:11], s41 offen offset:2048 nt lds
    s_add_u32 s41, s61, 24576
    buffer_load_dwordx4 v18, s[8:11], s41 offen offset:3072 nt lds
    s_add_u32 m0, s43, 36864
    s_add_u32 s41, s62, 0
    buffer_load_dwordx4 v18, s[8:11], s41 offen offset:0 nt lds
    s_add_u32 s41, s62, 8192
    buffer_load_dwordx4 v18, s[8:11], s41 offen offset:1024 nt lds
    s_add_u32 s41, s62, 16384
    buffer_load_dwordx4 v18, s[8:11], s41 offen offset:2048 nt lds
    s_add_u32 s41, s62, 24576
    buffer_load_dwordx4 v18, s[8:11], s41 offen offset:3072 nt lds
    s_add_u32 m0, s43, 73728
    s_add_u32 s41, s63, 0
    buffer_load_dwordx4 v18, s[8:11], s41 offen offset:0 nt lds
    s_add_u32 s41, s63, 8192
    buffer_load_dwordx4 v18, s[8:11], s41 offen offset:1024 nt lds
    s_add_u32 s41, s63, 16384
    buffer_load_dwordx4 v18, s[8:11], s41 offen offset:2048 nt lds
    s_add_u32 s41, s63, 24576
    buffer_load_dwordx4 v18, s[8:11], s41 offen offset:3072 nt lds
    v_lshrrev_b32 v49, 1, v48
    v_mul_u32_u24 v19, 1152, v49
    v_and_b32 v49, 1, v48
    v_lshl_add_u32 v19, v49, 4, v19
    s_mul_i32 s41, s13, 224
    s_sub_u32 s41, 1024, s41
    v_add_u32 v19, s41, v19
    v_lshrrev_b32 v49, 4, v48
    v_lshlrev_b32 v50, 2, v49
    v_and_b32 v51, 15, v48
    v_xor_b32 v51, v51, v50
    v_lshlrev_b32 v51, 4, v51
    v_lshl_add_u32 v16, v49, 15, v51
    v_lshrrev_b32 v50, 1, v49
    v_lshl_add_u32 v17, v50, 16, v51
    v_and_b32 v50, 1, v49
    v_lshl_add_u32 v17, v50, 13, v17
    s_lshl_b32 s40, s12, 8
    s_mul_i32 s58, s13, 1048576
    s_add_u32 s58, s58, s40
    s_lshr_b32 s41, s13, 1
    s_mul_i32 s59, s41, 262144
    s_and_b32 s41, s13, 1
    s_lshl_b32 s41, s41, 14
    s_add_u32 s59, s59, s41
    s_add_u32 s59, s59, s40
    s_add_u32 s59, s59, 4194304
    s_lshr_b32 s71, s52, 8
    s_add_u32 s71, s71, s12
    s_and_b32 s71, s71, 3
    v_bfe_u32 v50, v48, 2, 2
    v_xor_b32 v51, s13, v50
    v_lshlrev_b32 v20, 6, v51
    v_and_b32 v51, 3, v48
    v_lshl_add_u32 v20, v51, 4, v20
    v_lshrrev_b32 v23, 2, v48
    v_lshl_add_u32 v20, v23, 8, v20
    s_xor_b32 s41, s43, 0
    v_add_u32 v24, s41, v20
    s_xor_b32 s41, s43, 4096
    v_add_u32 v25, s41, v20
    s_xor_b32 s41, s43, 8192
    v_add_u32 v26, s41, v20
    s_xor_b32 s41, s43, 12288
    v_add_u32 v27, s41, v20
    v_and_b32 v23, 1, v50
    v_lshl_add_u32 v23, v49, 2, v23
    v_lshrrev_b32 v50, 1, v50
    v_lshlrev_b32 v21, 7, v23
    v_lshl_add_u32 v21, v50, 6, v21
    v_lshrrev_b32 v16, 1, v51
    v_lshl_add_u32 v21, v16, 5, v21
    v_and_b32 v16, 1, v51
    v_lshl_add_u32 v21, v16, 3, v21
    v_add_u32 v21, s43, v21
    v_lshlrev_b32 v22, 9, v50
    v_xor_b32 v22, v22, v21
    v_lshlrev_b32 v23, 5, v23
    v_lshl_add_u32 v23, v50, 10, v23
    v_lshl_add_u32 v23, v51, 3, v23
    v_add_u32 v23, s43, v23
    v_bfe_u32 v60, v65, 4, 6
    v_and_b32 v61, 15, v60
    v_lshrrev_b32 v62, 4, v60
    v_mov_b32 v64, 0x4444
    v_mov_b32 v77, 0xeeee
    v_cmp_lt_u32 vcc, 7, v61
    s_nop 1
    v_cndmask_b32 v64, v64, v77, vcc
    v_xor_b32 v66, 1024, v65
    v_xor_b32 v67, 2048, v65
    v_xor_b32 v68, 3072, v65
    v_and_b32 v69, 511, v65
    s_mul_i32 s96, s13, 36864
    s_add_u32 s96, s96, 16384
    v_lshlrev_b32 v70, 4, v60
    v_add_u32 v70, s96, v70
    v_lshrrev_b32 v79, 1, v69
    s_lshl_b32 s96, s13, 8
    s_add_u32 s96, s96, 14336
    s_lshl_b32 s33, s13, 10
    s_add_u32 s97, s33, 8192
    v_mov_b32 v77, s97
    v_mov_b32 v78, s96
    v_cmp_lt_u32 vcc, 31, v60
    s_nop 1
    v_cndmask_b32 v71, v77, v78, vcc
    v_add_u32 v71, v71, v79
    v_and_b32 v77, 7, v61
    v_lshrrev_b32 v78, 3, v61
    v_lshlrev_b32 v74, 4, v77
    v_lshl_add_u32 v73, v62, 7, v74
    v_lshl_add_u32 v73, v78, 3, v73
    s_lshl_b32 s96, s13, 9
    v_add_u32 v73, s96, v73
    v_lshrrev_b32 v74, 1, v74
    v_lshl_add_u32 v74, v78, 14, v74
    v_lshl_add_u32 v74, v62, 15, v74
    s_lshl_b32 s96, s13, 17
    v_add_u32 v74, s96, v74
    v_bfe_u32 v77, v61, 2, 1
    v_and_b32 v78, 3, v61
    s_cmp_lt_u32 s13, 2
    s_cselect_b64 vcc, -1, 0
    v_cndmask_b32 v77, 0, v77, vcc
    v_lshlrev_b32 v75, 7, v77
    v_lshl_add_u32 v75, v62, 4, v75
    v_lshl_add_u32 v75, v78, 2, v75
    v_lshlrev_b32 v58, 3, v77
    v_lshl_add_u32 v58, v78, 1, v58
    s_bfe_u32 s97, s12, 0x10001
    s_lshl_b32 s68, s97, 6
    s_lshl_b32 s97, s97, 2
    v_add_u32 v59, s97, v62
    s_bfe_u32 s96, s12, 0x10002
    s_and_b32 s40, s12, 1
    s_lshl_b32 s96, s96, 1
    s_add_u32 s96, s96, s40
    s_lshr_b32 s97, s12, 3
    s_lshl_b32 s98, s13, 2
    s_add_u32 s98, s98, s97
    s_lshl_b32 s98, s98, 2
    s_add_u32 s98, s98, s96
    s_lshl_b32 s98, s98, 8
    s_lshl_b32 s99, s13, 2
    s_add_u32 s99, s99, s96
    s_lshl_b32 s99, s99, 4
    s_lshl_b32 s41, s97, 1
    s_add_u32 s41, s41, s40
    s_lshl_b32 s41, s41, 7
    s_add_u32 s41, s41, 8192
    s_lshl_b32 s40, s40, 3
    s_add_u32 s40, s40, 512
    s_cmp_lt_u32 s13, 2
    s_cselect_b32 s96, 7, 4
    s_cselect_b32 s98, s98, s41
    s_cselect_b32 s99, s99, s40
    s_cselect_b32 s32, 1, 0
    s_add_u32 s68, s68, s98
    s_lshl_b32 s97, s97, s96
    s_add_u32 s99, s99, s97
    v_add_u32 v58, s99, v58
    s_and_b32 s97, s12, 4
    s_or_b32 s97, s97, s13
    s_cmp_eq_u32 s97, 2
    s_cselect_b32 s32, 2, s32
    s_mov_b32 s8, s48
    s_mov_b32 s9, s49
    s_mov_b32 s10, 9216
    v_mul_u32_u24 v77, 1152, v59
    v_lshl_add_u32 v77, v58, 1, v77
    buffer_load_dword v72, v77, s[8:11], 0 offen
    s_mov_b32 s10, 4718592
    s_waitcnt vmcnt(12) lgkmcnt(0)
    s_barrier
    s_cmp_eq_u32 s71, 1
    s_cbranch_scc1 cs_th0
    s_waitcnt vmcnt(6)
cs_th0:
    s_mov_b64 s[8:9], s[56:57]
    s_add_u32 m0, s43, 110592
    s_add_u32 s41, s42, 0
    buffer_load_dwordx4 v19, s[8:11], s41 offen offset:0 nt lds
    s_add_u32 s41, s42, 35840
    buffer_load_dwordx4 v19, s[8:11], s41 offen offset:1024 nt lds
    s_add_u32 s41, s42, 71680
    buffer_load_dwordx4 v19, s[8:11], s41 offen offset:2048 nt lds
    s_add_u32 s41, s42, 107520
    buffer_load_dwordx4 v19, s[8:11], s41 offen offset:3072 nt lds
    v_add_u32 v77, 147456, v22
    ds_read_b64_tr_b16 v[80:81], v77 offset:0
    ds_read_b64_tr_b16 v[82:83], v77 offset:256
    ds_read_b64_tr_b16 v[84:85], v77 offset:2048
    ds_read_b64_tr_b16 v[86:87], v77 offset:2304
    ds_read_b64_tr_b16 v[112:113], v77 offset:16
    ds_read_b64_tr_b16 v[114:115], v77 offset:272
    ds_read_b64_tr_b16 v[116:117], v77 offset:2064
    ds_read_b64_tr_b16 v[118:119], v77 offset:2320
    s_waitcnt vmcnt(12) lgkmcnt(0)
    s_barrier
    s_cmp_eq_u32 s71, 1
    s_cbranch_scc1 cs_th1
    s_waitcnt vmcnt(6)
cs_th1:
    s_mov_b64 s[8:9], s[52:53]
    s_add_u32 m0, s43, 147456
    s_add_u32 s41, s58, 0
    buffer_load_dwordx4 v17, s[8:11], s41 offen offset:0 nt lds
    s_add_u32 s41, s58, 31744
    buffer_load_dwordx4 v17, s[8:11], s41 offen offset:1024 nt lds
    s_add_u32 s41, s58, 129024
    buffer_load_dwordx4 v17, s[8:11], s41 offen offset:2048 nt lds
    s_add_u32 s41, s58, 160768
    buffer_load_dwordx4 v17, s[8:11], s41 offen offset:3072 nt lds
    v_add_u32 v77, 0, v21
    ds_read_b64_tr_b16 v[88:89], v77 offset:0
    ds_read_b64_tr_b16 v[90:91], v77 offset:256
    ds_read_b64_tr_b16 v[92:93], v77 offset:2048
    ds_read_b64_tr_b16 v[94:95], v77 offset:2304
    ds_read_b64_tr_b16 v[120:121], v77 offset:16
    ds_read_b64_tr_b16 v[122:123], v77 offset:272
    ds_read_b64_tr_b16 v[124:125], v77 offset:2064
    ds_read_b64_tr_b16 v[126:127], v77 offset:2320
    s_waitcnt vmcnt(12) lgkmcnt(0)
    s_barrier
    s_cmp_eq_u32 s71, 1
    s_cbranch_scc1 cs_th2
    s_waitcnt vmcnt(6)
cs_th2:
    s_add_u32 m0, s43, 0
    s_add_u32 s41, s58, 16384
    buffer_load_dwordx4 v17, s[8:11], s41 offen offset:0 nt lds
    s_add_u32 s41, s58, 48128
    buffer_load_dwordx4 v17, s[8:11], s41 offen offset:1024 nt lds
    s_add_u32 s41, s58, 145408
    buffer_load_dwordx4 v17, s[8:11], s41 offen offset:2048 nt lds
    s_add_u32 s41, s58, 177152
    buffer_load_dwordx4 v17, s[8:11], s41 offen offset:3072 nt lds
    v_add_u32 v77, 36864, v21
    ds_read_b64_tr_b16 v[96:97], v77 offset:0
    ds_read_b64_tr_b16 v[98:99], v77 offset:256
    ds_read_b64_tr_b16 v[100:101], v77 offset:2048
    ds_read_b64_tr_b16 v[102:103], v77 offset:2304
    ds_read_b64_tr_b16 v[128:129], v77 offset:16
    ds_read_b64_tr_b16 v[130:131], v77 offset:272
    ds_read_b64_tr_b16 v[132:133], v77 offset:2064
    ds_read_b64_tr_b16 v[134:135], v77 offset:2320
    s_waitcnt vmcnt(12) lgkmcnt(0)
    s_barrier
    s_cmp_eq_u32 s71, 1
    s_cbranch_scc1 cs_th3
    s_waitcnt vmcnt(6)
cs_th3:
    s_mov_b64 s[8:9], s[54:55]
    s_add_u32 m0, s43, 36864
    s_add_u32 s41, s58, 0
    buffer_load_dwordx4 v17, s[8:11], s41 offen offset:0 nt lds
    s_add_u32 s41, s58, 31744
    buffer_load_dwordx4 v17, s[8:11], s41 offen offset:1024 nt lds
    s_add_u32 s41, s58, 129024
    buffer_load_dwordx4 v17, s[8:11], s41 offen offset:2048 nt lds
    s_add_u32 s41, s58, 160768
    buffer_load_dwordx4 v17, s[8:11], s41 offen offset:3072 nt lds
    v_add_u32 v77, 73728, v21
    ds_read_b64_tr_b16 v[104:105], v77 offset:0
    ds_read_b64_tr_b16 v[106:107], v77 offset:256
    ds_read_b64_tr_b16 v[108:109], v77 offset:2048
    ds_read_b64_tr_b16 v[110:111], v77 offset:2304
    ds_read_b64_tr_b16 v[136:137], v77 offset:16
    ds_read_b64_tr_b16 v[138:139], v77 offset:272
    ds_read_b64_tr_b16 v[140:141], v77 offset:2064
    ds_read_b64_tr_b16 v[142:143], v77 offset:2320
    s_waitcnt vmcnt(12) lgkmcnt(0)
    s_barrier
    s_cmp_eq_u32 s71, 1
    s_cbranch_scc1 cs_th4
    s_waitcnt vmcnt(6)
cs_th4:
    s_add_u32 m0, s43, 73728
    s_add_u32 s41, s58, 16384
    buffer_load_dwordx4 v17, s[8:11], s41 offen offset:0 nt lds
    s_add_u32 s41, s58, 48128
    buffer_load_dwordx4 v17, s[8:11], s41 offen offset:1024 nt lds
    s_add_u32 s41, s58, 145408
    buffer_load_dwordx4 v17, s[8:11], s41 offen offset:2048 nt lds
    s_add_u32 s41, s58, 177152
    buffer_load_dwordx4 v17, s[8:11], s41 offen offset:3072 nt lds
    v_add_u32 v77, 110592, v23
    ds_read_b64_tr_b16 v[0:1], v77 offset:0
    ds_read_b64_tr_b16 v[2:3], v77 offset:64
    ds_read_b64_tr_b16 v[4:5], v77 offset:512
    ds_read_b64_tr_b16 v[6:7], v77 offset:576
    ds_read_b64_tr_b16 v[8:9], v77 offset:2048
    ds_read_b64_tr_b16 v[10:11], v77 offset:2112
    ds_read_b64_tr_b16 v[12:13], v77 offset:2560
    ds_read_b64_tr_b16 v[14:15], v77 offset:2624
    s_waitcnt vmcnt(12) lgkmcnt(0)
    s_barrier
    s_cmp_eq_u32 s71, 1
    s_cbranch_scc1 cs_th5
    s_waitcnt vmcnt(6)
cs_th5:
    s_mov_b64 s[8:9], s[50:51]
    s_add_u32 m0, s43, 110592
    s_add_u32 s41, s58, 0
    buffer_load_dwordx4 v17, s[8:11], s41 offen offset:0 nt lds
    s_add_u32 s41, s58, 31744
    buffer_load_dwordx4 v17, s[8:11], s41 offen offset:1024 nt lds
    s_add_u32 s41, s58, 129024
    buffer_load_dwordx4 v17, s[8:11], s41 offen offset:2048 nt lds
    s_add_u32 s41, s58, 160768
    buffer_load_dwordx4 v17, s[8:11], s41 offen offset:3072 nt lds
    s_cmp_eq_u32 s32, 0
    s_cbranch_scc1 cs_init_done
    v_mov_b32 v52, 1
    v_mov_b32 v53, 1
    v_mov_b32 v54, 1
    v_mov_b32 v55, 1
    v_mov_b32 v56, 0
    s_lshl_b32 s96, s12, 14
    s_add_u32 s96, s96, 68681728
    s_add_u32 s97, s96, 0
    buffer_store_dwordx4 v[52:55], v65, s[4:7], s97 offen sc1
    s_add_u32 s97, s96, 4096
    buffer_store_dwordx4 v[52:55], v65, s[4:7], s97 offen sc1
    s_add_u32 s97, s96, 8192
    buffer_store_dwordx4 v[52:55], v65, s[4:7], s97 offen sc1
    s_add_u32 s97, s96, 12288
    buffer_store_dwordx4 v[52:55], v65, s[4:7], s97 offen sc1
    s_add_u32 s96, s68, 67633152
    s_add_u32 s97, s96, 16384
    buffer_store_dword v56, v75, s[4:7], s96 offen offset:0 sc1
    buffer_store_dword v72, v75, s[4:7], s97 offen offset:0 sc1
    s_cmp_lg_u32 s32, 2
    s_cbranch_scc1 cs_init_done
    buffer_store_dword v56, v75, s[4:7], s96 offen offset:1024 sc1
    buffer_store_dword v72, v75, s[4:7], s97 offen offset:1024 sc1
    buffer_store_dword v56, v75, s[4:7], s96 offen offset:2048 sc1
    buffer_store_dword v72, v75, s[4:7], s97 offen offset:2048 sc1
    buffer_store_dword v56, v75, s[4:7], s96 offen offset:3072 sc1
    buffer_store_dword v72, v75, s[4:7], s97 offen offset:3072 sc1
cs_init_done:
    ds_write_b64 v70, v[0:1] offset:16384
    ds_write_b64 v70, v[2:3] offset:16392
    ds_write_b64 v70, v[4:5] offset:17408
    ds_write_b64 v70, v[6:7] offset:17416
    ds_write_b64 v70, v[8:9] offset:18432
    ds_write_b64 v70, v[10:11] offset:18440
    ds_write_b64 v70, v[12:13] offset:19456
    ds_write_b64 v70, v[14:15] offset:19464
    v_add_u32 v28, 147456, v24
    v_add_u32 v29, 147456, v25
    v_add_u32 v30, 147456, v26
    v_add_u32 v31, 147456, v27
    ds_read_b64_tr_b16 a[96:97], v28 offset:0
    ds_read_b64_tr_b16 a[104:105], v28 offset:8
    ds_read_b64_tr_b16 a[112:113], v29 offset:0
    ds_read_b64_tr_b16 a[120:121], v29 offset:8
    ds_read_b64_tr_b16 a[128:129], v30 offset:0
    ds_read_b64_tr_b16 a[136:137], v30 offset:8
    ds_read_b64_tr_b16 a[144:145], v31 offset:0
    ds_read_b64_tr_b16 v[32:33], v31 offset:8
    s_waitcnt vmcnt(12) lgkmcnt(0)
    s_barrier
    s_cmp_eq_u32 s71, 1
    s_cbranch_scc1 cs_th6
    s_waitcnt vmcnt(6)
cs_th6:
    s_add_u32 m0, s43, 147456
    s_add_u32 s41, s58, 16384
    buffer_load_dwordx4 v17, s[8:11], s41 offen offset:0 nt lds
    s_add_u32 s41, s58, 48128
    buffer_load_dwordx4 v17, s[8:11], s41 offen offset:1024 nt lds
    s_add_u32 s41, s58, 145408
    buffer_load_dwordx4 v17, s[8:11], s41 offen offset:2048 nt lds
    s_add_u32 s41, s58, 177152
    buffer_load_dwordx4 v17, s[8:11], s41 offen offset:3072 nt lds
    ds_write_b64 v70, v[32:33] offset:12288
    v_add_u32 v28, 0, v24
    v_add_u32 v29, 0, v25
    v_add_u32 v30, 0, v26
    v_add_u32 v31, 0, v27
    ds_read_b64_tr_b16 a[98:99], v28 offset:0
    ds_read_b64_tr_b16 a[106:107], v28 offset:8
    ds_read_b64_tr_b16 a[114:115], v29 offset:0
    ds_read_b64_tr_b16 a[122:123], v29 offset:8
    ds_read_b64_tr_b16 a[130:131], v30 offset:0
    ds_read_b64_tr_b16 a[138:139], v30 offset:8
    ds_read_b64_tr_b16 a[146:147], v31 offset:0
    ds_read_b64_tr_b16 v[0:1], v31 offset:8
    s_waitcnt vmcnt(12) lgkmcnt(0)
    s_barrier
    s_cmp_eq_u32 s71, 1
    s_cbranch_scc1 cs_th7
    s_waitcnt vmcnt(6)
cs_th7:
    s_mov_b64 s[8:9], s[52:53]
    s_add_u32 m0, s43, 0
    s_add_u32 s41, s58, 262144
    buffer_load_dwordx4 v17, s[8:11], s41 offen offset:0 nt lds
    s_add_u32 s41, s58, 293888
    buffer_load_dwordx4 v17, s[8:11], s41 offen offset:1024 nt lds
    s_add_u32 s41, s58, 391168
    buffer_load_dwordx4 v17, s[8:11], s41 offen offset:2048 nt lds
    s_add_u32 s41, s58, 422912
    buffer_load_dwordx4 v17, s[8:11], s41 offen offset:3072 nt lds
    ds_write_b64 v70, v[0:1] offset:12296
    v_add_u32 v28, 36864, v24
    v_add_u32 v29, 36864, v25
    v_add_u32 v30, 36864, v26
    v_add_u32 v31, 36864, v27
    ds_read_b64_tr_b16 a[232:233], v28 offset:0
    ds_read_b64_tr_b16 v[32:33], v28 offset:8
    ds_read_b64_tr_b16 a[240:241], v29 offset:0
    ds_read_b64_tr_b16 a[248:249], v29 offset:8
    ds_read_b64_tr_b16 v[144:145], v30 offset:0
    ds_read_b64_tr_b16 v[152:153], v30 offset:8
    ds_read_b64_tr_b16 v[160:161], v31 offset:0
    ds_read_b64_tr_b16 v[168:169], v31 offset:8
    s_waitcnt vmcnt(12) lgkmcnt(0)
    s_barrier
    s_cmp_eq_u32 s71, 1
    s_cbranch_scc1 cs_th8
    s_waitcnt vmcnt(6)
cs_th8:
    s_add_u32 m0, s43, 36864
    s_add_u32 s41, s58, 278528
    buffer_load_dwordx4 v17, s[8:11], s41 offen offset:0 nt lds
    s_add_u32 s41, s58, 310272
    buffer_load_dwordx4 v17, s[8:11], s41 offen offset:1024 nt lds
    s_add_u32 s41, s58, 407552
    buffer_load_dwordx4 v17, s[8:11], s41 offen offset:2048 nt lds
    s_add_u32 s41, s58, 439296
    buffer_load_dwordx4 v17, s[8:11], s41 offen offset:3072 nt lds
    ds_write_b64 v70, v[32:33] offset:8192
    v_add_u32 v28, 73728, v24
    v_add_u32 v29, 73728, v25
    v_add_u32 v30, 73728, v26
    v_add_u32 v31, 73728, v27
    ds_read_b64_tr_b16 a[234:235], v28 offset:0
    ds_read_b64_tr_b16 v[0:1], v28 offset:8
    ds_read_b64_tr_b16 a[242:243], v29 offset:0
    ds_read_b64_tr_b16 a[250:251], v29 offset:8
    ds_read_b64_tr_b16 v[146:147], v30 offset:0
    ds_read_b64_tr_b16 v[154:155], v30 offset:8
    ds_read_b64_tr_b16 v[162:163], v31 offset:0
    ds_read_b64_tr_b16 v[170:171], v31 offset:8
    s_waitcnt vmcnt(12) lgkmcnt(0)
    s_barrier
    s_cmp_eq_u32 s71, 1
    s_cbranch_scc1 cs_th9
    s_waitcnt vmcnt(6)
cs_th9:
    s_mov_b64 s[8:9], s[54:55]
    s_add_u32 m0, s43, 73728
    s_add_u32 s41, s58, 262144
    buffer_load_dwordx4 v17, s[8:11], s41 offen offset:0 nt lds
    s_add_u32 s41, s58, 293888
    buffer_load_dwordx4 v17, s[8:11], s41 offen offset:1024 nt lds
    s_add_u32 s41, s58, 391168
    buffer_load_dwordx4 v17, s[8:11], s41 offen offset:2048 nt lds
    s_add_u32 s41, s58, 422912
    buffer_load_dwordx4 v17, s[8:11], s41 offen offset:3072 nt lds
    ds_write_b64 v70, v[0:1] offset:8200
    v_add_u32 v28, 110592, v24
    v_add_u32 v29, 110592, v25
    v_add_u32 v30, 110592, v26
    v_add_u32 v31, 110592, v27
    ds_read_b64_tr_b16 v[32:33], v28 offset:0
    ds_read_b64_tr_b16 v[34:35], v28 offset:8
    ds_read_b64_tr_b16 v[36:37], v29 offset:0
    ds_read_b64_tr_b16 v[38:39], v29 offset:8
    ds_read_b64_tr_b16 a[0:1], v30 offset:0
    ds_read_b64_tr_b16 v[40:41], v30 offset:8
    ds_read_b64_tr_b16 a[8:9], v31 offset:0
    ds_read_b64_tr_b16 v[42:43], v31 offset:8
    s_waitcnt vmcnt(12) lgkmcnt(0)
    s_barrier
    s_cmp_eq_u32 s71, 1
    s_cbranch_scc1 cs_th10
    s_waitcnt vmcnt(6)
cs_th10:
    s_add_u32 m0, s43, 110592
    s_add_u32 s41, s58, 278528
    buffer_load_dwordx4 v17, s[8:11], s41 offen offset:0 nt lds
    s_add_u32 s41, s58, 310272
    buffer_load_dwordx4 v17, s[8:11], s41 offen offset:1024 nt lds
    s_add_u32 s41, s58, 407552
    buffer_load_dwordx4 v17, s[8:11], s41 offen offset:2048 nt lds
    s_add_u32 s41, s58, 439296
    buffer_load_dwordx4 v17, s[8:11], s41 offen offset:3072 nt lds
    ds_write_b64 v70, v[32:33] offset:0
    ds_write_b64 v70, v[34:35] offset:2048
    ds_write_b64 v70, v[36:37] offset:4096
    ds_write_b64 v70, v[38:39] offset:6144
    ds_write_b64 v70, v[40:41] offset:10240
    ds_write_b64 v70, v[42:43] offset:14336
    v_add_u32 v28, 147456, v24
    v_add_u32 v29, 147456, v25
    v_add_u32 v30, 147456, v26
    v_add_u32 v31, 147456, v27
    ds_read_b64_tr_b16 v[0:1], v28 offset:0
    ds_read_b64_tr_b16 v[2:3], v28 offset:8
    ds_read_b64_tr_b16 v[4:5], v29 offset:0
    ds_read_b64_tr_b16 v[6:7], v29 offset:8
    ds_read_b64_tr_b16 a[2:3], v30 offset:0
    ds_read_b64_tr_b16 v[8:9], v30 offset:8
    ds_read_b64_tr_b16 a[10:11], v31 offset:0
    ds_read_b64_tr_b16 v[10:11], v31 offset:8
    s_waitcnt vmcnt(12) lgkmcnt(0)
    s_barrier
    s_cmp_eq_u32 s71, 1
    s_cbranch_scc1 cs_th11
    s_waitcnt vmcnt(6)
cs_th11:
    s_mov_b64 s[8:9], s[50:51]
    s_add_u32 m0, s43, 147456
    s_add_u32 s41, s58, 262144
    buffer_load_dwordx4 v17, s[8:11], s41 offen offset:0 nt lds
    s_add_u32 s41, s58, 293888
    buffer_load_dwordx4 v17, s[8:11], s41 offen offset:1024 nt lds
    s_add_u32 s41, s58, 391168
    buffer_load_dwordx4 v17, s[8:11], s41 offen offset:2048 nt lds
    s_add_u32 s41, s58, 422912
    buffer_load_dwordx4 v17, s[8:11], s41 offen offset:3072 nt lds
    ds_write_b64 v70, v[0:1] offset:8
    ds_write_b64 v70, v[2:3] offset:2056
    ds_write_b64 v70, v[4:5] offset:4104
    ds_write_b64 v70, v[6:7] offset:6152
    ds_write_b64 v70, v[8:9] offset:10248
    ds_write_b64 v70, v[10:11] offset:14344
    v_add_u32 v28, 0, v24
    v_add_u32 v29, 0, v25
    v_add_u32 v30, 0, v26
    v_add_u32 v31, 0, v27
    ds_read_b64_tr_b16 a[100:101], v28 offset:0
    ds_read_b64_tr_b16 a[108:109], v28 offset:8
    ds_read_b64_tr_b16 a[116:117], v29 offset:0
    ds_read_b64_tr_b16 a[124:125], v29 offset:8
    ds_read_b64_tr_b16 a[132:133], v30 offset:0
    ds_read_b64_tr_b16 a[140:141], v30 offset:8
    ds_read_b64_tr_b16 a[148:149], v31 offset:0
    ds_read_b64_tr_b16 v[32:33], v31 offset:8
    s_waitcnt vmcnt(12) lgkmcnt(0)
    s_barrier
    s_cmp_eq_u32 s71, 1
    s_cbranch_scc1 cs_th12
    s_waitcnt vmcnt(6)
cs_th12:
    s_add_u32 m0, s43, 0
    s_add_u32 s41, s58, 278528
    buffer_load_dwordx4 v17, s[8:11], s41 offen offset:0 nt lds
    s_add_u32 s41, s58, 310272
    buffer_load_dwordx4 v17, s[8:11], s41 offen offset:1024 nt lds
    s_add_u32 s41, s58, 407552
    buffer_load_dwordx4 v17, s[8:11], s41 offen offset:2048 nt lds
    s_add_u32 s41, s58, 439296
    buffer_load_dwordx4 v17, s[8:11], s41 offen offset:3072 nt lds
    ds_write_b64 v70, v[32:33] offset:13312
    v_add_u32 v28, 36864, v24
    v_add_u32 v29, 36864, v25
    v_add_u32 v30, 36864, v26
    v_add_u32 v31, 36864, v27
    ds_read_b64_tr_b16 a[102:103], v28 offset:0
    ds_read_b64_tr_b16 a[110:111], v28 offset:8
    ds_read_b64_tr_b16 a[118:119], v29 offset:0
    ds_read_b64_tr_b16 a[126:127], v29 offset:8
    ds_read_b64_tr_b16 a[134:135], v30 offset:0
    ds_read_b64_tr_b16 a[142:143], v30 offset:8
    ds_read_b64_tr_b16 a[150:151], v31 offset:0
    ds_read_b64_tr_b16 v[0:1], v31 offset:8
    s_waitcnt vmcnt(12) lgkmcnt(0)
    s_barrier
    s_cmp_eq_u32 s71, 1
    s_cbranch_scc1 cs_th13
    s_waitcnt vmcnt(6)
cs_th13:
    s_mov_b64 s[8:9], s[52:53]
    s_add_u32 m0, s43, 36864
    s_add_u32 s41, s58, 524288
    buffer_load_dwordx4 v17, s[8:11], s41 offen offset:0 nt lds
    s_add_u32 s41, s58, 556032
    buffer_load_dwordx4 v17, s[8:11], s41 offen offset:1024 nt lds
    s_add_u32 s41, s58, 653312
    buffer_load_dwordx4 v17, s[8:11], s41 offen offset:2048 nt lds
    s_add_u32 s41, s58, 685056
    buffer_load_dwordx4 v17, s[8:11], s41 offen offset:3072 nt lds
    ds_write_b64 v70, v[0:1] offset:13320
    v_add_u32 v28, 73728, v24
    v_add_u32 v29, 73728, v25
    v_add_u32 v30, 73728, v26
    v_add_u32 v31, 73728, v27
    ds_read_b64_tr_b16 a[236:237], v28 offset:0
    ds_read_b64_tr_b16 v[32:33], v28 offset:8
    ds_read_b64_tr_b16 a[244:245], v29 offset:0
    ds_read_b64_tr_b16 a[252:253], v29 offset:8
    ds_read_b64_tr_b16 v[148:149], v30 offset:0
    ds_read_b64_tr_b16 v[156:157], v30 offset:8
    ds_read_b64_tr_b16 v[164:165], v31 offset:0
    ds_read_b64_tr_b16 v[172:173], v31 offset:8
    s_waitcnt vmcnt(12) lgkmcnt(0)
    s_barrier
    s_cmp_eq_u32 s71, 1
    s_cbranch_scc1 cs_th14
    s_waitcnt vmcnt(6)
cs_th14:
    s_add_u32 m0, s43, 73728
    s_add_u32 s41, s58, 540672
    buffer_load_dwordx4 v17, s[8:11], s41 offen offset:0 nt lds
    s_add_u32 s41, s58, 572416
    buffer_load_dwordx4 v17, s[8:11], s41 offen offset:1024 nt lds
    s_add_u32 s41, s58, 669696
    buffer_load_dwordx4 v17, s[8:11], s41 offen offset:2048 nt lds
    s_add_u32 s41, s58, 701440
    buffer_load_dwordx4 v17, s[8:11], s41 offen offset:3072 nt lds
    ds_write_b64 v70, v[32:33] offset:9216
    v_add_u32 v28, 110592, v24
    v_add_u32 v29, 110592, v25
    v_add_u32 v30, 110592, v26
    v_add_u32 v31, 110592, v27
    ds_read_b64_tr_b16 a[238:239], v28 offset:0
    ds_read_b64_tr_b16 v[0:1], v28 offset:8
    ds_read_b64_tr_b16 a[246:247], v29 offset:0
    ds_read_b64_tr_b16 a[254:255], v29 offset:8
    ds_read_b64_tr_b16 v[150:151], v30 offset:0
    ds_read_b64_tr_b16 v[158:159], v30 offset:8
    ds_read_b64_tr_b16 v[166:167], v31 offset:0
    ds_read_b64_tr_b16 v[174:175], v31 offset:8
    s_waitcnt vmcnt(12) lgkmcnt(0)
    s_barrier
    s_cmp_eq_u32 s71, 1
    s_cbranch_scc1 cs_th15
    s_waitcnt vmcnt(6)
cs_th15:
    s_mov_b64 s[8:9], s[54:55]
    s_add_u32 m0, s43, 110592
    s_add_u32 s41, s58, 524288
    buffer_load_dwordx4 v17, s[8:11], s41 offen offset:0 nt lds
    s_add_u32 s41, s58, 556032
    buffer_load_dwordx4 v17, s[8:11], s41 offen offset:1024 nt lds
    s_add_u32 s41, s58, 653312
    buffer_load_dwordx4 v17, s[8:11], s41 offen offset:2048 nt lds
    s_add_u32 s41, s58, 685056
    buffer_load_dwordx4 v17, s[8:11], s41 offen offset:3072 nt lds
    ds_write_b64 v70, v[0:1] offset:9224
    v_add_u32 v28, 147456, v24
    v_add_u32 v29, 147456, v25
    v_add_u32 v30, 147456, v26
    v_add_u32 v31, 147456, v27
    ds_read_b64_tr_b16 v[32:33], v28 offset:0
    ds_read_b64_tr_b16 v[34:35], v28 offset:8
    ds_read_b64_tr_b16 v[36:37], v29 offset:0
    ds_read_b64_tr_b16 v[38:39], v29 offset:8
    ds_read_b64_tr_b16 a[4:5], v30 offset:0
    ds_read_b64_tr_b16 v[40:41], v30 offset:8
    ds_read_b64_tr_b16 a[12:13], v31 offset:0
    ds_read_b64_tr_b16 v[42:43], v31 offset:8
    s_waitcnt vmcnt(12) lgkmcnt(0)
    s_barrier
    s_cmp_eq_u32 s71, 1
    s_cbranch_scc1 cs_th16
    s_waitcnt vmcnt(6)
cs_th16:
    s_add_u32 m0, s43, 147456
    s_add_u32 s41, s58, 540672
    buffer_load_dwordx4 v17, s[8:11], s41 offen offset:0 nt lds
    s_add_u32 s41, s58, 572416
    buffer_load_dwordx4 v17, s[8:11], s41 offen offset:1024 nt lds
    s_add_u32 s41, s58, 669696
    buffer_load_dwordx4 v17, s[8:11], s41 offen offset:2048 nt lds
    s_add_u32 s41, s58, 701440
    buffer_load_dwordx4 v17, s[8:11], s41 offen offset:3072 nt lds
    ds_write_b64 v70, v[32:33] offset:1024
    ds_write_b64 v70, v[34:35] offset:3072
    ds_write_b64 v70, v[36:37] offset:5120
    ds_write_b64 v70, v[38:39] offset:7168
    ds_write_b64 v70, v[40:41] offset:11264
    ds_write_b64 v70, v[42:43] offset:15360
    v_add_u32 v28, 0, v24
    v_add_u32 v29, 0, v25
    v_add_u32 v30, 0, v26
    v_add_u32 v31, 0, v27
    ds_read_b64_tr_b16 v[0:1], v28 offset:0
    ds_read_b64_tr_b16 v[2:3], v28 offset:8
    ds_read_b64_tr_b16 v[4:5], v29 offset:0
    ds_read_b64_tr_b16 v[6:7], v29 offset:8
    ds_read_b64_tr_b16 a[6:7], v30 offset:0
    ds_read_b64_tr_b16 v[8:9], v30 offset:8
    ds_read_b64_tr_b16 a[14:15], v31 offset:0
    ds_read_b64_tr_b16 v[10:11], v31 offset:8
    s_waitcnt vmcnt(12) lgkmcnt(0)
    s_barrier
    s_cmp_eq_u32 s71, 1
    s_cbranch_scc1 cs_th17
    s_waitcnt vmcnt(6)
cs_th17:
    s_mov_b64 s[8:9], s[50:51]
    s_add_u32 m0, s43, 0
    s_add_u32 s41, s58, 524288
    buffer_load_dwordx4 v17, s[8:11], s41 offen offset:0 nt lds
    s_add_u32 s41, s58, 556032
    buffer_load_dwordx4 v17, s[8:11], s41 offen offset:1024 nt lds
    s_add_u32 s41, s58, 653312
    buffer_load_dwordx4 v17, s[8:11], s41 offen offset:2048 nt lds
    s_add_u32 s41, s58, 685056
    buffer_load_dwordx4 v17, s[8:11], s41 offen offset:3072 nt lds
    ds_write_b64 v70, v[0:1] offset:1032
    ds_write_b64 v70, v[2:3] offset:3080
    ds_write_b64 v70, v[4:5] offset:5128
    ds_write_b64 v70, v[6:7] offset:7176
    ds_write_b64 v70, v[8:9] offset:11272
    ds_write_b64 v70, v[10:11] offset:15368
    v_add_u32 v28, 36864, v24
    v_add_u32 v29, 36864, v25
    v_add_u32 v30, 36864, v26
    v_add_u32 v31, 36864, v27
    ds_read_b64_tr_b16 a[152:153], v28 offset:0
    ds_read_b64_tr_b16 a[160:161], v28 offset:8
    ds_read_b64_tr_b16 a[168:169], v29 offset:0
    ds_read_b64_tr_b16 a[176:177], v29 offset:8
    ds_read_b64_tr_b16 a[184:185], v30 offset:0
    ds_read_b64_tr_b16 a[192:193], v30 offset:8
    ds_read_b64_tr_b16 a[200:201], v31 offset:0
    ds_read_b64_tr_b16 a[208:209], v31 offset:8
    s_waitcnt vmcnt(12) lgkmcnt(0)
    s_barrier
    s_cmp_eq_u32 s71, 1
    s_cbranch_scc1 cs_th18
    s_waitcnt vmcnt(6)
cs_th18:
    s_add_u32 m0, s43, 36864
    s_add_u32 s41, s58, 540672
    buffer_load_dwordx4 v17, s[8:11], s41 offen offset:0 nt lds
    s_add_u32 s41, s58, 572416
    buffer_load_dwordx4 v17, s[8:11], s41 offen offset:1024 nt lds
    s_add_u32 s41, s58, 669696
    buffer_load_dwordx4 v17, s[8:11], s41 offen offset:2048 nt lds
    s_add_u32 s41, s58, 701440
    buffer_load_dwordx4 v17, s[8:11], s41 offen offset:3072 nt lds
    v_add_u32 v28, 73728, v24
    v_add_u32 v29, 73728, v25
    v_add_u32 v30, 73728, v26
    v_add_u32 v31, 73728, v27
    ds_read_b64_tr_b16 a[154:155], v28 offset:0
    ds_read_b64_tr_b16 a[162:163], v28 offset:8
    ds_read_b64_tr_b16 a[170:171], v29 offset:0
    ds_read_b64_tr_b16 a[178:179], v29 offset:8
    ds_read_b64_tr_b16 a[186:187], v30 offset:0
    ds_read_b64_tr_b16 a[194:195], v30 offset:8
    ds_read_b64_tr_b16 a[202:203], v31 offset:0
    ds_read_b64_tr_b16 a[210:211], v31 offset:8
    s_waitcnt vmcnt(12) lgkmcnt(0)
    s_barrier
    s_cmp_eq_u32 s71, 1
    s_cbranch_scc1 cs_th19
    s_waitcnt vmcnt(6)
cs_th19:
    s_mov_b64 s[8:9], s[52:53]
    s_add_u32 m0, s43, 73728
    s_add_u32 s41, s58, 786432
    buffer_load_dwordx4 v17, s[8:11], s41 offen offset:0 nt lds
    s_add_u32 s41, s58, 818176
    buffer_load_dwordx4 v17, s[8:11], s41 offen offset:1024 nt lds
    s_add_u32 s41, s58, 915456
    buffer_load_dwordx4 v17, s[8:11], s41 offen offset:2048 nt lds
    s_add_u32 s41, s58, 947200
    buffer_load_dwordx4 v17, s[8:11], s41 offen offset:3072 nt lds
    v_add_u32 v28, 110592, v24
    v_add_u32 v29, 110592, v25
    v_add_u32 v30, 110592, v26
    v_add_u32 v31, 110592, v27
    ds_read_b64_tr_b16 v[176:177], v28 offset:0
    ds_read_b64_tr_b16 v[184:185], v28 offset:8
    ds_read_b64_tr_b16 v[192:193], v29 offset:0
    ds_read_b64_tr_b16 v[200:201], v29 offset:8
    ds_read_b64_tr_b16 v[208:209], v30 offset:0
    ds_read_b64_tr_b16 v[216:217], v30 offset:8
    ds_read_b64_tr_b16 v[224:225], v31 offset:0
    ds_read_b64_tr_b16 v[232:233], v31 offset:8
    s_waitcnt vmcnt(12) lgkmcnt(0)
    s_barrier
    s_cmp_eq_u32 s71, 1
    s_cbranch_scc1 cs_th20
    s_waitcnt vmcnt(6)
cs_th20:
    s_add_u32 m0, s43, 110592
    s_add_u32 s41, s58, 802816
    buffer_load_dwordx4 v17, s[8:11], s41 offen offset:0 nt lds
    s_add_u32 s41, s58, 834560
    buffer_load_dwordx4 v17, s[8:11], s41 offen offset:1024 nt lds
    s_add_u32 s41, s58, 931840
    buffer_load_dwordx4 v17, s[8:11], s41 offen offset:2048 nt lds
    s_add_u32 s41, s58, 963584
    buffer_load_dwordx4 v17, s[8:11], s41 offen offset:3072 nt lds
    v_add_u32 v28, 147456, v24
    v_add_u32 v29, 147456, v25
    v_add_u32 v30, 147456, v26
    v_add_u32 v31, 147456, v27
    ds_read_b64_tr_b16 v[178:179], v28 offset:0
    ds_read_b64_tr_b16 v[186:187], v28 offset:8
    ds_read_b64_tr_b16 v[194:195], v29 offset:0
    ds_read_b64_tr_b16 v[202:203], v29 offset:8
    ds_read_b64_tr_b16 v[210:211], v30 offset:0
    ds_read_b64_tr_b16 v[218:219], v30 offset:8
    ds_read_b64_tr_b16 v[226:227], v31 offset:0
    ds_read_b64_tr_b16 v[234:235], v31 offset:8
    s_waitcnt vmcnt(12) lgkmcnt(0)
    s_barrier
    s_cmp_eq_u32 s71, 1
    s_cbranch_scc1 cs_th21
    s_waitcnt vmcnt(6)
cs_th21:
    s_mov_b64 s[8:9], s[54:55]
    s_add_u32 m0, s43, 147456
    s_add_u32 s41, s58, 786432
    buffer_load_dwordx4 v17, s[8:11], s41 offen offset:0 nt lds
    s_add_u32 s41, s58, 818176
    buffer_load_dwordx4 v17, s[8:11], s41 offen offset:1024 nt lds
    s_add_u32 s41, s58, 915456
    buffer_load_dwordx4 v17, s[8:11], s41 offen offset:2048 nt lds
    s_add_u32 s41, s58, 947200
    buffer_load_dwordx4 v17, s[8:11], s41 offen offset:3072 nt lds
    v_add_u32 v28, 0, v24
    v_add_u32 v29, 0, v25
    v_add_u32 v30, 0, v26
    v_add_u32 v31, 0, v27
    ds_read_b64_tr_b16 a[16:17], v28 offset:0
    ds_read_b64_tr_b16 a[24:25], v28 offset:8
    ds_read_b64_tr_b16 a[32:33], v29 offset:0
    ds_read_b64_tr_b16 a[40:41], v29 offset:8
    ds_read_b64_tr_b16 a[48:49], v30 offset:0
    ds_read_b64_tr_b16 a[56:57], v30 offset:8
    ds_read_b64_tr_b16 a[64:65], v31 offset:0
    ds_read_b64_tr_b16 a[72:73], v31 offset:8
    s_waitcnt vmcnt(12) lgkmcnt(0)
    s_barrier
    s_cmp_eq_u32 s71, 1
    s_cbranch_scc1 cs_th22
    s_waitcnt vmcnt(6)
cs_th22:
    s_add_u32 m0, s43, 0
    s_add_u32 s41, s58, 802816
    buffer_load_dwordx4 v17, s[8:11], s41 offen offset:0 nt lds
    s_add_u32 s41, s58, 834560
    buffer_load_dwordx4 v17, s[8:11], s41 offen offset:1024 nt lds
    s_add_u32 s41, s58, 931840
    buffer_load_dwordx4 v17, s[8:11], s41 offen offset:2048 nt lds
    s_add_u32 s41, s58, 963584
    buffer_load_dwordx4 v17, s[8:11], s41 offen offset:3072 nt lds
    v_add_u32 v28, 36864, v24
    v_add_u32 v29, 36864, v25
    v_add_u32 v30, 36864, v26
    v_add_u32 v31, 36864, v27
    ds_read_b64_tr_b16 a[18:19], v28 offset:0
    ds_read_b64_tr_b16 a[26:27], v28 offset:8
    ds_read_b64_tr_b16 a[34:35], v29 offset:0
    ds_read_b64_tr_b16 a[42:43], v29 offset:8
    ds_read_b64_tr_b16 a[50:51], v30 offset:0
    ds_read_b64_tr_b16 a[58:59], v30 offset:8
    ds_read_b64_tr_b16 a[66:67], v31 offset:0
    ds_read_b64_tr_b16 a[74:75], v31 offset:8
    s_waitcnt vmcnt(12) lgkmcnt(0)
    s_barrier
    s_cmp_eq_u32 s71, 1
    s_cbranch_scc1 cs_th23
    s_waitcnt vmcnt(6)
cs_th23:
    s_mov_b64 s[8:9], s[50:51]
    s_add_u32 m0, s43, 36864
    s_add_u32 s41, s58, 786432
    buffer_load_dwordx4 v17, s[8:11], s41 offen offset:0 nt lds
    s_add_u32 s41, s58, 818176
    buffer_load_dwordx4 v17, s[8:11], s41 offen offset:1024 nt lds
    s_add_u32 s41, s58, 915456
    buffer_load_dwordx4 v17, s[8:11], s41 offen offset:2048 nt lds
    s_add_u32 s41, s58, 947200
    buffer_load_dwordx4 v17, s[8:11], s41 offen offset:3072 nt lds
    v_add_u32 v28, 73728, v24
    v_add_u32 v29, 73728, v25
    v_add_u32 v30, 73728, v26
    v_add_u32 v31, 73728, v27
    ds_read_b64_tr_b16 a[156:157], v28 offset:0
    ds_read_b64_tr_b16 a[164:165], v28 offset:8
    ds_read_b64_tr_b16 a[172:173], v29 offset:0
    ds_read_b64_tr_b16 a[180:181], v29 offset:8
    ds_read_b64_tr_b16 a[188:189], v30 offset:0
    ds_read_b64_tr_b16 a[196:197], v30 offset:8
    ds_read_b64_tr_b16 a[204:205], v31 offset:0
    ds_read_b64_tr_b16 a[212:213], v31 offset:8
    s_waitcnt vmcnt(12) lgkmcnt(0)
    s_barrier
    s_cmp_eq_u32 s71, 1
    s_cbranch_scc1 cs_th24
    s_waitcnt vmcnt(6)
cs_th24:
    s_add_u32 m0, s43, 73728
    s_add_u32 s41, s58, 802816
    buffer_load_dwordx4 v17, s[8:11], s41 offen offset:0 nt lds
    s_add_u32 s41, s58, 834560
    buffer_load_dwordx4 v17, s[8:11], s41 offen offset:1024 nt lds
    s_add_u32 s41, s58, 931840
    buffer_load_dwordx4 v17, s[8:11], s41 offen offset:2048 nt lds
    s_add_u32 s41, s58, 963584
    buffer_load_dwordx4 v17, s[8:11], s41 offen offset:3072 nt lds
    v_add_u32 v28, 110592, v24
    v_add_u32 v29, 110592, v25
    v_add_u32 v30, 110592, v26
    v_add_u32 v31, 110592, v27
    ds_read_b64_tr_b16 a[158:159], v28 offset:0
    ds_read_b64_tr_b16 a[166:167], v28 offset:8
    ds_read_b64_tr_b16 a[174:175], v29 offset:0
    ds_read_b64_tr_b16 a[182:183], v29 offset:8
    ds_read_b64_tr_b16 a[190:191], v30 offset:0
    ds_read_b64_tr_b16 a[198:199], v30 offset:8
    ds_read_b64_tr_b16 a[206:207], v31 offset:0
    ds_read_b64_tr_b16 a[214:215], v31 offset:8
    s_waitcnt vmcnt(12) lgkmcnt(0)
    s_barrier
    s_cmp_eq_u32 s71, 1
    s_cbranch_scc1 cs_th25
    s_waitcnt vmcnt(6)
cs_th25:
    s_mov_b64 s[8:9], s[52:53]
    s_add_u32 m0, s43, 110592
    s_add_u32 s41, s59, 0
    buffer_load_dwordx4 v17, s[8:11], s41 offen offset:0 nt lds
    s_add_u32 s41, s59, 31744
    buffer_load_dwordx4 v17, s[8:11], s41 offen offset:1024 nt lds
    s_add_u32 s41, s59, 129024
    buffer_load_dwordx4 v17, s[8:11], s41 offen offset:2048 nt lds
    s_add_u32 s41, s59, 160768
    buffer_load_dwordx4 v17, s[8:11], s41 offen offset:3072 nt lds
    v_add_u32 v28, 147456, v24
    v_add_u32 v29, 147456, v25
    v_add_u32 v30, 147456, v26
    v_add_u32 v31, 147456, v27
    ds_read_b64_tr_b16 v[180:181], v28 offset:0
    ds_read_b64_tr_b16 v[188:189], v28 offset:8
    ds_read_b64_tr_b16 v[196:197], v29 offset:0
    ds_read_b64_tr_b16 v[204:205], v29 offset:8
    ds_read_b64_tr_b16 v[212:213], v30 offset:0
    ds_read_b64_tr_b16 v[220:221], v30 offset:8
    ds_read_b64_tr_b16 v[228:229], v31 offset:0
    ds_read_b64_tr_b16 v[236:237], v31 offset:8
    s_waitcnt vmcnt(12) lgkmcnt(0)
    s_barrier
    s_cmp_eq_u32 s71, 1
    s_cbranch_scc1 cs_th26
    s_waitcnt vmcnt(6)
cs_th26:
    s_mov_b64 s[8:9], s[50:51]
    s_add_u32 m0, s43, 147456
    s_add_u32 s41, s59, 0
    buffer_load_dwordx4 v17, s[8:11], s41 offen offset:0 nt lds
    s_add_u32 s41, s59, 31744
    buffer_load_dwordx4 v17, s[8:11], s41 offen offset:1024 nt lds
    s_add_u32 s41, s59, 129024
    buffer_load_dwordx4 v17, s[8:11], s41 offen offset:2048 nt lds
    s_add_u32 s41, s59, 160768
    buffer_load_dwordx4 v17, s[8:11], s41 offen offset:3072 nt lds
    v_add_u32 v28, 0, v24
    v_add_u32 v29, 0, v25
    v_add_u32 v30, 0, v26
    v_add_u32 v31, 0, v27
    ds_read_b64_tr_b16 v[182:183], v28 offset:0
    ds_read_b64_tr_b16 v[190:191], v28 offset:8
    ds_read_b64_tr_b16 v[198:199], v29 offset:0
    ds_read_b64_tr_b16 v[206:207], v29 offset:8
    ds_read_b64_tr_b16 v[214:215], v30 offset:0
    ds_read_b64_tr_b16 v[222:223], v30 offset:8
    ds_read_b64_tr_b16 v[230:231], v31 offset:0
    ds_read_b64_tr_b16 v[238:239], v31 offset:8
    s_waitcnt vmcnt(12) lgkmcnt(0)
    s_barrier
    s_cmp_eq_u32 s71, 1
    s_cbranch_scc1 cs_th27
    s_waitcnt vmcnt(6)
cs_th27:
    s_mov_b64 s[8:9], s[54:55]
    s_add_u32 m0, s43, 0
    s_add_u32 s41, s59, 0
    buffer_load_dwordx4 v17, s[8:11], s41 offen offset:0 nt lds
    s_add_u32 s41, s59, 31744
    buffer_load_dwordx4 v17, s[8:11], s41 offen offset:1024 nt lds
    s_add_u32 s41, s59, 129024
    buffer_load_dwordx4 v17, s[8:11], s41 offen offset:2048 nt lds
    s_add_u32 s41, s59, 160768
    buffer_load_dwordx4 v17, s[8:11], s41 offen offset:3072 nt lds
    v_add_u32 v28, 36864, v24
    v_add_u32 v29, 36864, v25
    v_add_u32 v30, 36864, v26
    v_add_u32 v31, 36864, v27
    ds_read_b64_tr_b16 a[20:21], v28 offset:0
    ds_read_b64_tr_b16 a[28:29], v28 offset:8
    ds_read_b64_tr_b16 a[36:37], v29 offset:0
    ds_read_b64_tr_b16 a[44:45], v29 offset:8
    ds_read_b64_tr_b16 a[52:53], v30 offset:0
    ds_read_b64_tr_b16 a[60:61], v30 offset:8
    ds_read_b64_tr_b16 a[68:69], v31 offset:0
    ds_read_b64_tr_b16 a[76:77], v31 offset:8
    s_waitcnt vmcnt(12) lgkmcnt(0)
    s_barrier
    s_cmp_eq_u32 s71, 1
    s_cbranch_scc1 cs_th28
    s_waitcnt vmcnt(6)
cs_th28:
    s_mov_b64 s[8:9], s[56:57]
    s_add_u32 m0, s43, 36864
    s_add_u32 s41, s60, 128
    buffer_load_dwordx4 v18, s[8:11], s41 offen offset:0 nt lds
    s_add_u32 s41, s60, 8320
    buffer_load_dwordx4 v18, s[8:11], s41 offen offset:1024 nt lds
    s_add_u32 s41, s60, 16512
    buffer_load_dwordx4 v18, s[8:11], s41 offen offset:2048 nt lds
    s_add_u32 s41, s60, 24704
    buffer_load_dwordx4 v18, s[8:11], s41 offen offset:3072 nt lds
    v_add_u32 v28, 73728, v24
    v_add_u32 v29, 73728, v25
    v_add_u32 v30, 73728, v26
    v_add_u32 v31, 73728, v27
    ds_read_b64_tr_b16 a[22:23], v28 offset:0
    ds_read_b64_tr_b16 a[30:31], v28 offset:8
    ds_read_b64_tr_b16 a[38:39], v29 offset:0
    ds_read_b64_tr_b16 a[46:47], v29 offset:8
    ds_read_b64_tr_b16 a[54:55], v30 offset:0
    ds_read_b64_tr_b16 a[62:63], v30 offset:8
    ds_read_b64_tr_b16 a[70:71], v31 offset:0
    ds_read_b64_tr_b16 a[78:79], v31 offset:8
    s_waitcnt vmcnt(12) lgkmcnt(0)
    s_barrier
    s_cmp_eq_u32 s71, 1
    s_cbranch_scc1 cs_th29
    s_waitcnt vmcnt(6)
cs_th29:
    s_add_u32 m0, s43, 73728
    s_add_u32 s41, s61, 128
    buffer_load_dwordx4 v18, s[8:11], s41 offen offset:0 nt lds
    s_add_u32 s41, s61, 8320
    buffer_load_dwordx4 v18, s[8:11], s41 offen offset:1024 nt lds
    s_add_u32 s41, s61, 16512
    buffer_load_dwordx4 v18, s[8:11], s41 offen offset:2048 nt lds
    s_add_u32 s41, s61, 24704
    buffer_load_dwordx4 v18, s[8:11], s41 offen offset:3072 nt lds
    v_add_u32 v77, 110592, v20
    ds_read_b64_tr_b16 a[216:217], v77 offset:0
    ds_read_b64_tr_b16 a[218:219], v77 offset:4096
    ds_read_b64_tr_b16 a[220:221], v77 offset:8192
    ds_read_b64_tr_b16 a[222:223], v77 offset:12288
    ds_read_b64_tr_b16 a[224:225], v77 offset:8
    ds_read_b64_tr_b16 a[226:227], v77 offset:4104
    ds_read_b64_tr_b16 a[228:229], v77 offset:8200
    ds_read_b64_tr_b16 a[230:231], v77 offset:12296
    s_waitcnt vmcnt(12) lgkmcnt(0)
    s_barrier
    s_cmp_eq_u32 s71, 1
    s_cbranch_scc1 cs_th30
    s_waitcnt vmcnt(6)
cs_th30:
    s_add_u32 m0, s43, 110592
    s_add_u32 s41, s62, 128
    buffer_load_dwordx4 v18, s[8:11], s41 offen offset:0 nt lds
    s_add_u32 s41, s62, 8320
    buffer_load_dwordx4 v18, s[8:11], s41 offen offset:1024 nt lds
    s_add_u32 s41, s62, 16512
    buffer_load_dwordx4 v18, s[8:11], s41 offen offset:2048 nt lds
    s_add_u32 s41, s62, 24704
    buffer_load_dwordx4 v18, s[8:11], s41 offen offset:3072 nt lds
    v_add_u32 v77, 147456, v20
    ds_read_b64_tr_b16 a[80:81], v77 offset:0
    ds_read_b64_tr_b16 a[82:83], v77 offset:4096
    ds_read_b64_tr_b16 a[84:85], v77 offset:8192
    ds_read_b64_tr_b16 a[86:87], v77 offset:12288
    ds_read_b64_tr_b16 a[88:89], v77 offset:8
    ds_read_b64_tr_b16 a[90:91], v77 offset:4104
    ds_read_b64_tr_b16 a[92:93], v77 offset:8200
    ds_read_b64_tr_b16 a[94:95], v77 offset:12296
    s_waitcnt vmcnt(12) lgkmcnt(0)
    s_barrier
    s_cmp_eq_u32 s71, 1
    s_cbranch_scc1 cs_th31
    s_waitcnt vmcnt(6)
cs_th31:
    s_add_u32 m0, s43, 147456
    s_add_u32 s41, s63, 128
    buffer_load_dwordx4 v18, s[8:11], s41 offen offset:0 nt lds
    s_add_u32 s41, s63, 8320
    buffer_load_dwordx4 v18, s[8:11], s41 offen offset:1024 nt lds
    s_add_u32 s41, s63, 16512
    buffer_load_dwordx4 v18, s[8:11], s41 offen offset:2048 nt lds
    s_add_u32 s41, s63, 24704
    buffer_load_dwordx4 v18, s[8:11], s41 offen offset:3072 nt lds
    v_mov_b32 v78, v21
    v_mov_b32 v79, v22
    v_add_u32 v77, 0, v20
    ds_read_b64_tr_b16 v[240:241], v77 offset:0
    ds_read_b64_tr_b16 v[242:243], v77 offset:4096
    ds_read_b64_tr_b16 v[244:245], v77 offset:8192
    ds_read_b64_tr_b16 v[246:247], v77 offset:12288
    ds_read_b64_tr_b16 v[248:249], v77 offset:8
    ds_read_b64_tr_b16 v[250:251], v77 offset:4104
    ds_read_b64_tr_b16 v[252:253], v77 offset:8200
    ds_read_b64_tr_b16 v[254:255], v77 offset:12296
    s_waitcnt vmcnt(12) lgkmcnt(0)
    s_barrier
    v_bfe_u32 v60, v65, 4, 6
    v_and_b32 v61, 15, v60
    v_lshrrev_b32 v62, 4, v60
    v_mov_b32 v50, 0x3f80
    v_mov_b32 v51, 0x3f800000
    v_and_b32 v57, 1, v62
    v_lshlrev_b32 v57, 2, v57
    v_sub_u32 v57, v61, v57
    v_and_b32 v58, 3, v61
    v_lshlrev_b32 v58, 2, v58
    v_lshrrev_b32 v59, 2, v61
    v_add_u32 v58, v58, v59
    v_cmp_eq_u32 vcc, 0, v57
    s_nop 1
    v_cndmask_b32 v40, 0, v50, vcc
    v_cmp_eq_u32 vcc, 1, v57
    s_nop 1
    v_cndmask_b32 v40, v40, v51, vcc
    v_cmp_eq_u32 vcc, 0, v58
    s_nop 1
    v_cndmask_b32 v44, 0, v50, vcc
    v_cmp_eq_u32 vcc, 1, v58
    s_nop 1
    v_cndmask_b32 v44, v44, v51, vcc
    v_cmp_eq_u32 vcc, 2, v57
    s_nop 1
    v_cndmask_b32 v41, 0, v50, vcc
    v_cmp_eq_u32 vcc, 3, v57
    s_nop 1
    v_cndmask_b32 v41, v41, v51, vcc
    v_cmp_eq_u32 vcc, 2, v58
    s_nop 1
    v_cndmask_b32 v45, 0, v50, vcc
    v_cmp_eq_u32 vcc, 3, v58
    s_nop 1
    v_cndmask_b32 v45, v45, v51, vcc
    v_cmp_eq_u32 vcc, 8, v57
    s_nop 1
    v_cndmask_b32 v42, 0, v50, vcc
    v_cmp_eq_u32 vcc, 9, v57
    s_nop 1
    v_cndmask_b32 v42, v42, v51, vcc
    v_cmp_eq_u32 vcc, 4, v58
    s_nop 1
    v_cndmask_b32 v46, 0, v50, vcc
    v_cmp_eq_u32 vcc, 5, v58
    s_nop 1
    v_cndmask_b32 v46, v46, v51, vcc
    v_cmp_eq_u32 vcc, 10, v57
    s_nop 1
    v_cndmask_b32 v43, 0, v50, vcc
    v_cmp_eq_u32 vcc, 11, v57
    s_nop 1
    v_cndmask_b32 v43, v43, v51, vcc
    v_cmp_eq_u32 vcc, 6, v58
    s_nop 1
    v_cndmask_b32 v47, 0, v50, vcc
    v_cmp_eq_u32 vcc, 7, v58
    s_nop 1
    v_cndmask_b32 v47, v47, v51, vcc
    v_lshlrev_b32 v57, 4, v61
    ds_write_b128 v69, v[40:43] offset:15360
    ds_write_b128 v57, v[44:47] offset:15872
    v_add_u32 v77, 36864, v79
    s_waitcnt lgkmcnt(0)
    ds_read_b64_tr_b16 v[0:1], v77 offset:0
    ds_read_b64_tr_b16 v[2:3], v77 offset:256
    ds_read_b64_tr_b16 v[4:5], v77 offset:2048
    ds_read_b64_tr_b16 v[6:7], v77 offset:2304
    ds_read_b64_tr_b16 v[8:9], v77 offset:16
    ds_read_b64_tr_b16 v[10:11], v77 offset:272
    ds_read_b64_tr_b16 v[12:13], v77 offset:2064
    ds_read_b64_tr_b16 v[14:15], v77 offset:2320
    s_waitcnt vmcnt(8) lgkmcnt(0)
    s_barrier
    v_add_u32 v77, 73728, v78
    ds_read_b64_tr_b16 v[16:17], v77 offset:0
    ds_read_b64_tr_b16 v[18:19], v77 offset:256
    ds_read_b64_tr_b16 v[20:21], v77 offset:2048
    ds_read_b64_tr_b16 v[22:23], v77 offset:2304
    ds_read_b64_tr_b16 v[24:25], v77 offset:16
    ds_read_b64_tr_b16 v[26:27], v77 offset:272
    ds_read_b64_tr_b16 v[28:29], v77 offset:2064
    ds_read_b64_tr_b16 v[30:31], v77 offset:2320
    s_waitcnt vmcnt(4) lgkmcnt(0)
    s_barrier
    v_add_u32 v77, 110592, v78
    ds_read_b64_tr_b16 v[32:33], v77 offset:0
    ds_read_b64_tr_b16 v[34:35], v77 offset:256
    ds_read_b64_tr_b16 v[36:37], v77 offset:2048
    ds_read_b64_tr_b16 v[38:39], v77 offset:2304
    ds_read_b64_tr_b16 v[40:41], v77 offset:16
    ds_read_b64_tr_b16 v[42:43], v77 offset:272
    ds_read_b64_tr_b16 v[44:45], v77 offset:2064
    ds_read_b64_tr_b16 v[46:47], v77 offset:2320
    s_waitcnt vmcnt(0) lgkmcnt(0)
    s_barrier
    v_add_u32 v77, 147456, v78
    ds_read_b64_tr_b16 v[48:49], v77 offset:0
    ds_read_b64_tr_b16 v[50:51], v77 offset:256
    ds_read_b64_tr_b16 v[52:53], v77 offset:2048
    ds_read_b64_tr_b16 v[54:55], v77 offset:2304
    ds_read_b64_tr_b16 v[56:57], v77 offset:16
    ds_read_b64_tr_b16 v[58:59], v77 offset:272
    ds_read_b64_tr_b16 v[60:61], v77 offset:2064
    ds_read_b64_tr_b16 v[62:63], v77 offset:2320
    s_waitcnt lgkmcnt(0)
    s_barrier
    ds_write_b128 v70, v[0:3] offset:20480
    ds_write_b128 v70, v[4:7] offset:21504
    ds_write_b128 v70, v[8:11] offset:22528
    ds_write_b128 v70, v[12:15] offset:23552
    ds_write_b128 v70, v[16:19] offset:24576
    ds_write_b128 v70, v[20:23] offset:25600
    ds_write_b128 v70, v[24:27] offset:26624
    ds_write_b128 v70, v[28:31] offset:27648
    ds_write_b128 v70, v[32:35] offset:28672
    ds_write_b128 v70, v[36:39] offset:29696
    ds_write_b128 v70, v[40:43] offset:30720
    ds_write_b128 v70, v[44:47] offset:31744
    ds_write_b128 v70, v[48:51] offset:32768
    ds_write_b128 v70, v[52:55] offset:33792
    ds_write_b128 v70, v[56:59] offset:34816
    ds_write_b128 v70, v[60:63] offset:35840
    s_waitcnt vmcnt(0) lgkmcnt(0)
    s_barrier
    v_mov_b32 v2, 1
    s_cmp_lg_u32 s13, 0
    s_cbranch_scc1 cs_noarr
    s_mov_b64 exec, 1
    buffer_atomic_add v2, off, s[84:87], 0 offset:212
    s_mov_b32 s40, 16777216
    s_mov_b32 s42, 2
cs_startpoll:
    buffer_load_dword v3, off, s[84:87], 0 offset:212 sc1
    s_sub_u32 s40, s40, 1
    s_cbranch_scc1 cs_decide
    s_waitcnt vmcnt(0)
    v_readfirstlane_b32 s41, v3
    s_nop 1
    s_cmp_lt_u32 s41, 32
    s_cbranch_scc1 cs_startpoll
    s_mov_b32 s42, 1
cs_decide:
    s_mov_b64 exec, -1
cs_noarr:
    s_barrier
    s_mov_b32 s44, 0x3e0293ee
    s_mov_b32 s45, s44
    s_or_b32 s66, s44, 0x80000000
    s_mov_b32 s48, 0x3f003f00
    s_mov_b32 s49, 0
    s_mov_b32 s50, 0x3f803f80
    s_mov_b32 s51, 0x3f803f80
    s_mov_b32 s52, 512
    s_mov_b32 s53, 1024
    s_mov_b32 s54, 1536
    s_mov_b32 s30, 0
    s_mov_b32 s37, 0
    s_mov_b32 s98, -100
    s_lshl_b32 s47, s13, 9
    s_cmp_lg_u32 s32, 0
    s_cselect_b32 s71, s13, 3
    s_add_u32 s46, s71, 1
    s_lshr_b32 s46, s46, 1
    s_mov_b32 s14, 67649536
    s_mov_b32 s15, 67653632
    s_mov_b32 s16, 67657728
    s_mov_b32 s36, 0
    s_add_u32 s17, s68, 67633152
    s_mov_b32 s69, 0
    s_mov_b32 s70, 0
    s_mul_i32 s26, s12, 16384
    s_add_u32 s26, s26, 0
    s_mul_i32 s40, s13, 3072
    s_add_u32 s24, s26, s40
    s_add_u32 s26, s24, s33
    s_add_u32 s99, s26, 33030144
    s_lshl_b32 s96, s12, 7
    s_add_u32 s29, s96, 125845504
    s_lshr_b32 s96, s12, 1
    s_lshl_b32 s96, s96, 11
    s_add_u32 s96, s96, 126091776
    s_lshl_b32 s40, s12, 14
    s_add_u32 s40, s40, 68681728
    s_add_u32 s18, s40, 0
    s_add_u32 s19, s40, 4096
    s_add_u32 s20, s40, 8192
    s_add_u32 s21, s40, 12288
    s_lshr_b32 s40, s12, 3
    s_lshl_b32 s40, s40, 12
    s_and_b32 s41, s12, 7
    s_lshl_b32 s41, s41, 7
    s_add_u32 s40, s40, s41
    s_add_u32 s22, s40, 68681728
    s_add_u32 s23, s22, 1024
    s_add_u32 s25, s22, 2048
    s_mov_b32 s56, -65472
    s_cmp_lg_u32 s32, 0
    s_cselect_b64 s[38:39], -1, 0
    s_add_u32 s55, s68, 138412032
    s_cmp_eq_u32 s13, 3
    s_cselect_b64 s[100:101], 1, 0
    s_cselect_b64 s[38:39], 1, s[38:39]
    s_cselect_b32 s93, 64, 0
    s_cselect_b32 s67, 64, 0
    s_cselect_b32 s55, s29, s55
    s_cselect_b32 s57, 0, 9216
    s_mov_b32 s34, 0xff00ff00
    s_mov_b32 s35, 0xff00ff00
    s_lshl_b32 s28, s12, 12
    s_add_u32 s28, s28, 7340032
    s_add_u32 s27, s28, 77594624
    s_add_u32 s28, s28, 69206016
    s_mov_b64 exec, s[100:101]
    v_mov_b32 v72, s95
    s_mov_b64 exec, -1
    s_mov_b32 s40, 3
    v_bfe_u32 v78, v65, 4, 3
    v_lshlrev_b32 v78, 7, v78
    s_mov_b32 s31, 4194304
cs_kv0:
    buffer_load_dword v77, v78, s[4:7], s96 offen sc1
    s_waitcnt vmcnt(0)
    v_subrev_u32 v77, s95, v77
    v_cmp_lt_u32 vcc, 16, v77
    s_nop 1
    v_cndmask_b32 v77, v77, 0, vcc
    v_bfe_u32 v79, v78, 7, 2
    v_lshl_add_u32 v77, v77, 2, v79
    s_nop 1
    v_min_u32_dpp v77, v77, v77 row_ror:1 row_mask:0xf bank_mask:0xf
    s_nop 1
    v_min_u32_dpp v77, v77, v77 row_ror:2 row_mask:0xf bank_mask:0xf
    s_nop 1
    v_min_u32_dpp v77, v77, v77 row_ror:4 row_mask:0xf bank_mask:0xf
    s_nop 0
    v_readfirstlane_b32 s97, v77
    s_sub_u32 s31, s31, 1
    s_cbranch_scc1 cs_kv0_x
    s_cmp_le_u32 s40, s97
    s_cbranch_scc1 cs_kv0_x
    s_sleep 2
    s_branch cs_kv0
cs_kv0_x:
    s_add_u32 s40, s26, 0
    s_min_u32 s40, s40, s99
    s_sub_u32 s41, s96, s40
    v_bfe_u32 v77, v65, 4, 3
    v_lshl_add_u32 v77, v77, 7, s41
    v_lshlrev_b32 v78, 3, v69
    s_nop 0
    v_mov_b32_dpp v78, v77 quad_perm:[0,1,2,3] row_mask:0xc bank_mask:0xf
    buffer_load_dword v76, v78, s[4:7], s40 offen sc1
    s_add_u32 s40, s26, 524288
    s_min_u32 s40, s40, s99
    s_sub_u32 s41, s96, s40
    v_bfe_u32 v77, v65, 4, 3
    v_lshl_add_u32 v77, v77, 7, s41
    v_lshlrev_b32 v78, 3, v69
    s_nop 0
    v_mov_b32_dpp v78, v77 quad_perm:[0,1,2,3] row_mask:0xc bank_mask:0xf
    buffer_load_dword v76, v78, s[4:7], s40 offen sc1
cs_kvdone:
    v_mov_b64 v[0:1], 0
    v_mov_b64 v[2:3], 0
    v_mov_b64 v[4:5], 0
    v_mov_b64 v[6:7], 0
    v_mov_b64 v[8:9], 0
    v_mov_b64 v[10:11], 0
    v_mov_b64 v[12:13], 0
    v_mov_b64 v[14:15], 0
    v_mov_b64 v[16:17], 0
    v_mov_b64 v[18:19], 0
    v_mov_b64 v[20:21], 0
    v_mov_b64 v[22:23], 0
    ds_read_b128 v[44:47], v70 offset:0
    ds_read_b128 v[48:51], v70 offset:1024
    ds_read_b128 v[52:55], v70 offset:2048
    ds_read_b128 v[56:59], v70 offset:3072
    ds_read_b128 v[24:27], v70 offset:4096
    ds_read_b128 v[28:31], v70 offset:5120
    ds_read_b128 v[32:35], v70 offset:6144
    ds_read_b128 v[36:39], v70 offset:7168
    buffer_load_dwordx4 v[40:43], v65, s[4:7], s14 offen offset:0 sc1
    buffer_load_dwordx4 v[60:63], v66, s[4:7], s14 offen offset:0 sc1
    s_mov_b32 s31, 1048576
    s_waitcnt vmcnt(0) lgkmcnt(0)
    s_branch cs_goA
cs_loop:
    s_mov_b32 s31, 1048576
    s_mov_b32 s69, s70
    s_waitcnt lgkmcnt(0)
cs_cA:
    buffer_load_dwordx4 v[40:43], v65, s[4:7], s14 offen offset:0 sc1
    buffer_load_dwordx4 v[60:63], v66, s[4:7], s14 offen offset:0 sc1
cs_cA1:
    s_waitcnt vmcnt(0)
    v_bitop3_b32 v77, v40, v60, s70 bitop3:0x7e
    v_bitop3_b32 v77, v77, v41, s70 bitop3:0xf6
    v_bitop3_b32 v77, v77, v42, s70 bitop3:0xf6
    v_bitop3_b32 v77, v77, v43, s70 bitop3:0xf6
    v_bitop3_b32 v77, v77, v61, s70 bitop3:0xf6
    v_bitop3_b32 v77, v77, v62, s70 bitop3:0xf6
    v_bitop3_b32 v77, v77, v63, s70 bitop3:0xf6
    v_and_b32 v77, 1, v77
    v_cmp_ne_u32 vcc, 0, v77
    s_cbranch_vccz cs_goA
    s_nop 15
    s_nop 15
    s_nop 7
    buffer_load_dwordx4 v[40:43], v65, s[4:7], s14 offen offset:0 sc1
    buffer_load_dwordx4 v[60:63], v66, s[4:7], s14 offen offset:0 sc1
    s_waitcnt vmcnt(0)
    v_bitop3_b32 v77, v40, v60, s70 bitop3:0x7e
    v_bitop3_b32 v77, v77, v41, s70 bitop3:0xf6
    v_bitop3_b32 v77, v77, v42, s70 bitop3:0xf6
    v_bitop3_b32 v77, v77, v43, s70 bitop3:0xf6
    v_bitop3_b32 v77, v77, v61, s70 bitop3:0xf6
    v_bitop3_b32 v77, v77, v62, s70 bitop3:0xf6
    v_bitop3_b32 v77, v77, v63, s70 bitop3:0xf6
    v_and_b32 v77, 1, v77
    v_cmp_ne_u32 vcc, 0, v77
    s_cbranch_vccz cs_goA
    s_nop 15
    s_nop 15
    s_nop 7
    buffer_load_dwordx4 v[40:43], v65, s[4:7], s14 offen offset:0 sc1
    buffer_load_dwordx4 v[60:63], v66, s[4:7], s14 offen offset:0 sc1
    s_waitcnt vmcnt(0)
    v_bitop3_b32 v77, v40, v60, s70 bitop3:0x7e
    v_bitop3_b32 v77, v77, v41, s70 bitop3:0xf6
    v_bitop3_b32 v77, v77, v42, s70 bitop3:0xf6
    v_bitop3_b32 v77, v77, v43, s70 bitop3:0xf6
    v_bitop3_b32 v77, v77, v61, s70 bitop3:0xf6
    v_bitop3_b32 v77, v77, v62, s70 bitop3:0xf6
    v_bitop3_b32 v77, v77, v63, s70 bitop3:0xf6
    v_and_b32 v77, 1, v77
    v_cmp_ne_u32 vcc, 0, v77
    s_cbranch_vccz cs_goA
    s_nop 15
    s_nop 15
    s_nop 7
    buffer_load_dwordx4 v[40:43], v65, s[4:7], s14 offen offset:0 sc1
    buffer_load_dwordx4 v[60:63], v66, s[4:7], s14 offen offset:0 sc1
    s_waitcnt vmcnt(0)
    v_bitop3_b32 v77, v40, v60, s70 bitop3:0x7e
    v_bitop3_b32 v77, v77, v41, s70 bitop3:0xf6
    v_bitop3_b32 v77, v77, v42, s70 bitop3:0xf6
    v_bitop3_b32 v77, v77, v43, s70 bitop3:0xf6
    v_bitop3_b32 v77, v77, v61, s70 bitop3:0xf6
    v_bitop3_b32 v77, v77, v62, s70 bitop3:0xf6
    v_bitop3_b32 v77, v77, v63, s70 bitop3:0xf6
    v_and_b32 v77, 1, v77
    v_cmp_ne_u32 vcc, 0, v77
    s_cbranch_vccz cs_goA
    s_nop 15
    s_nop 15
    s_nop 7
    s_sub_u32 s31, s31, 64
    s_cbranch_scc0 cs_cA
cs_goA:
    ds_write_b128 v65, v[40:43] offset:0
    v_smfmac_f32_16x16x64_bf16 v[0:3], v[40:43], v[44:51], v64
    v_smfmac_f32_16x16x64_bf16 v[4:7], v[40:43], v[52:59], v64
    buffer_load_dwordx4 v[44:47], v65, s[4:7], s15 offen offset:0 sc1
    v_smfmac_f32_16x16x64_bf16 v[0:3], v[60:63], v[24:31], v64
    s_add_u32 s40, s26, 1048576
    s_min_u32 s40, s40, s99
    s_sub_u32 s41, s96, s40
    v_smfmac_f32_16x16x64_bf16 v[4:7], v[60:63], v[32:39], v64
    ds_read_b128 v[24:27], v70 offset:8192
    s_cmp_lt_u32 s97, s67
    s_cselect_b32 s42, -1, 0
    v_smfmac_f32_16x16x64_bf16 v[8:11], v[40:43], a[96:103], v64
    ds_read_b128 v[28:31], v70 offset:9216
    v_smfmac_f32_16x16x64_bf16 v[12:15], v[40:43], a[104:111], v64
    ds_read_b128 v[32:35], v70 offset:10240
    s_waitcnt lgkmcnt(3)
    s_barrier
    ds_read_b128 v[48:51], v67 offset:0
    v_smfmac_f32_16x16x64_bf16 v[8:11], v[60:63], a[112:119], v64
    ds_read_b128 v[36:39], v70 offset:11264
    v_bitop3_b32 v79, v73, -9, s54 bitop3:0x6a
    v_smfmac_f32_16x16x64_bf16 v[12:15], v[60:63], a[120:127], v64
    v_smfmac_f32_16x16x64_bf16 v[16:19], v[40:43], a[232:239], v64
    ds_read_b128 v[52:55], v68 offset:0
    s_waitcnt lgkmcnt(4)
    v_bfe_u32 v77, v65, 4, 3
    v_smfmac_f32_16x16x64_bf16 v[20:23], v[40:43], v[24:31], v64
    ds_read_b128 v[24:27], v70 offset:12288
    s_waitcnt lgkmcnt(3)
    v_smfmac_f32_16x16x64_bf16 v[0:3], v[48:51], a[0:7], v64
    ds_read_b128 v[28:31], v70 offset:13312
    s_waitcnt lgkmcnt(3)
    v_lshl_add_u32 v77, v77, 7, s41
    v_smfmac_f32_16x16x64_bf16 v[4:7], v[48:51], v[32:39], v64
    buffer_load_dwordx4 v[40:43], v65, s[4:7], s16 offen offset:0 sc1
    v_smfmac_f32_16x16x64_bf16 v[16:19], v[60:63], a[240:247], v64
    ds_read_b128 v[32:35], v70 offset:14336
    v_lshlrev_b32 v78, 3, v69
    v_smfmac_f32_16x16x64_bf16 v[20:23], v[60:63], a[248:255], v64
    ds_read_b128 v[36:39], v70 offset:15360
    v_smfmac_f32_16x16x64_bf16 v[8:11], v[48:51], a[128:135], v64
    s_waitcnt vmcnt(1)
    v_mov_b32_dpp v78, v77 quad_perm:[0,1,2,3] row_mask:0xc bank_mask:0xf
    v_smfmac_f32_16x16x64_bf16 v[12:15], v[48:51], a[136:143], v64
    buffer_load_dwordx4 v[58:61], v65, s[4:7], s24 offen offset:3072 sc1
    s_waitcnt lgkmcnt(2)
    v_bitop3_b32 v77, v44, v45, s70 bitop3:0x7e
    v_bitop3_b32 v77, v77, v46, s70 bitop3:0xf6
    v_bitop3_b32 v77, v77, v47, s70 bitop3:0xf6
    v_and_b32 v77, s36, v77
    v_smfmac_f32_16x16x64_bf16 v[12:15], v[52:55], v[24:31], v64
    ds_write_b128 v65, v[44:47] offset:4096
    v_smfmac_f32_16x16x64_bf16 v[0:3], v[52:55], a[8:15], v64
    v_cmp_ne_u32 vcc, 0, v77
    v_smfmac_f32_16x16x64_bf16 v[8:11], v[52:55], a[144:151], v64
    buffer_load_dwordx4 v[24:27], v65, s[4:7], s24 offen offset:0 sc1
    s_waitcnt lgkmcnt(1)
    v_smfmac_f32_16x16x64_bf16 v[4:7], v[52:55], v[32:39], v64
    s_cbranch_vccnz cs_spinB
cs_backB:
    v_smfmac_f32_16x16x64_bf16 v[16:19], v[44:47], v[176:183], v64
    s_waitcnt lgkmcnt(0)
    s_barrier
    ds_read_b128 v[48:51], v66 offset:4096
    v_smfmac_f32_16x16x64_bf16 v[12:15], v[44:47], a[160:167], v64
    buffer_load_dwordx4 v[28:31], v65, s[4:7], s24 offen offset:1024 sc1
    v_smfmac_f32_16x16x64_bf16 v[0:3], v[44:47], a[16:23], v64
    ds_read_b128 v[52:55], v67 offset:4096
    v_smfmac_f32_16x16x64_bf16 v[8:11], v[44:47], a[152:159], v64
    v_smfmac_f32_16x16x64_bf16 v[4:7], v[44:47], a[24:31], v64
    buffer_load_dwordx4 v[34:37], v65, s[4:7], s24 offen offset:2048 sc1
    s_waitcnt vmcnt(5)
    v_smfmac_f32_16x16x64_bf16 v[20:23], v[44:47], v[184:191], v64
    ds_read_b128 v[44:47], v68 offset:4096
    s_waitcnt lgkmcnt(2)
    v_smfmac_f32_16x16x64_bf16 v[0:3], v[48:51], a[32:39], v64
    s_mov_b32 exec_hi, s42
    buffer_load_dword v76, v78, s[4:7], s40 offen sc1
    s_mov_b32 exec_hi, -1
    v_smfmac_f32_16x16x64_bf16 v[8:11], v[48:51], a[168:175], v64
    v_smfmac_f32_16x16x64_bf16 v[4:7], v[48:51], a[40:47], v64
    s_waitcnt vmcnt(5)
    v_bitop3_b32 v77, v40, v41, s70 bitop3:0x7e
    v_bitop3_b32 v77, v77, v42, s70 bitop3:0xf6
    v_bitop3_b32 v77, v77, v43, s70 bitop3:0xf6
    v_and_b32 v77, s36, v77
    v_smfmac_f32_16x16x64_bf16 v[12:15], v[48:51], a[176:183], v64
    ds_read_b128 v[48:51], v69 offset:15360
    s_waitcnt lgkmcnt(1)
    v_cmp_ne_u32 vcc, 0, v77
    v_smfmac_f32_16x16x64_bf16 v[0:3], v[52:55], a[48:55], v64
    v_smfmac_f32_16x16x64_bf16 v[8:11], v[52:55], a[184:191], v64
    s_cbranch_vccnz cs_spin8
cs_back8:
    v_smfmac_f32_16x16x64_bf16 v[0:3], v[44:47], a[64:71], v64
    v_smfmac_f32_16x16x64_bf16 v[8:11], v[44:47], a[200:207], v64
    v_smfmac_f32_16x16x64_bf16 v[0:3], v[40:43], a[80:87], v64
    s_nop 1
    v_smfmac_f32_16x16x64_bf16 v[8:11], v[40:43], a[216:223], v64
    s_nop 1
    v_lshrrev_b32 v77, 1, v69
    v_smfmac_f32_16x16x64_bf16 v[4:7], v[52:55], a[56:63], v64
    s_nop 1
    v_cvt_pk_bf16_f32 v0, v0, v1
    v_smfmac_f32_16x16x64_bf16 v[12:15], v[52:55], a[192:199], v64
    s_nop 1
    v_cvt_pk_bf16_f32 v1, v2, v3
    v_smfmac_f32_16x16x64_bf16 v[4:7], v[44:47], a[72:79], v64
    s_nop 1
    v_cvt_pk_bf16_f32 v2, v8, v9
    v_smfmac_f32_16x16x64_bf16 v[12:15], v[44:47], a[208:215], v64
    s_nop 1
    v_cvt_pk_bf16_f32 v3, v10, v11
    v_smfmac_f32_16x16x64_bf16 v[4:7], v[40:43], a[88:95], v64
    s_waitcnt lgkmcnt(0)
    s_nop 0
    s_nop 0
    v_smfmac_f32_16x16x64_bf16 v[12:15], v[40:43], a[224:231], v64
    s_nop 2
    v_mfma_f32_16x16x32_bf16 v[8:11], v[0:3], v[48:51], 0
    s_nop 0
    v_cvt_pk_bf16_f32 v4, v4, v5
    v_cvt_pk_bf16_f32 v5, v6, v7
    s_nop 0
    v_cvt_pk_bf16_f32 v6, v12, v13
    v_cvt_pk_bf16_f32 v7, v14, v15
    s_nop 1
    v_mfma_f32_16x16x32_bf16 v[12:15], v[4:7], v[48:51], 0
    ds_read_b128 v[48:51], v66 offset:4096
    v_cvt_pk_bf16_f32 v0, v8, v9
    v_cvt_pk_bf16_f32 v1, v10, v11
    v_smfmac_f32_16x16x64_bf16 v[16:19], v[52:55], v[208:215], v64
    s_waitcnt vmcnt(2)
    s_nop 2
    v_cvt_pk_bf16_f32 v2, v12, v13
    v_cvt_pk_bf16_f32 v3, v14, v15
    s_nop 1
    v_mfma_f32_16x16x32_bf16 v[12:15], v[0:3], v[0:3], 0
    s_nop 1
    v_bitop3_b32 v78, v73, -9, s53 bitop3:0x6a
    v_mfma_f32_16x16x32_bf16 v[4:7], v[24:27], v[0:3], 0
    ds_read_b128 v[24:27], v67 offset:0
    s_nop 1
    v_mfma_f32_16x16x32_bf16 v[8:11], v[28:31], v[0:3], 0
    s_nop 0
    v_mov_b32_dpp v12, v14 row_ror:8 row_mask:0xf bank_mask:0xc
    v_mov_b32_dpp v13, v15 row_ror:8 row_mask:0xf bank_mask:0xc
    v_smfmac_f32_16x16x64_bf16 v[20:23], v[52:55], v[216:223], v64
    ds_write_b64 v71, v[12:13]
    ds_read_b128 v[52:55], v68 offset:0
    s_nop 1
    v_mov_b32_dpp v4, v8 row_ror:8 row_mask:0xf bank_mask:0xc
    v_mov_b32_dpp v5, v9 row_ror:8 row_mask:0xf bank_mask:0xc
    v_mov_b32_dpp v6, v10 row_ror:8 row_mask:0xf bank_mask:0xc
    v_mov_b32_dpp v7, v11 row_ror:8 row_mask:0xf bank_mask:0xc
    v_smfmac_f32_16x16x64_bf16 v[16:19], v[44:47], v[224:231], v64
    ds_write_b128 v65, v[4:7] offset:8192
    v_smfmac_f32_16x16x64_bf16 v[20:23], v[44:47], v[232:239], v64
    s_waitcnt lgkmcnt(3)
    v_smfmac_f32_16x16x64_bf16 v[16:19], v[24:27], v[144:151], v64
    s_waitcnt vmcnt(1)
    v_smfmac_f32_16x16x64_bf16 v[20:23], v[24:27], v[152:159], v64
    s_mov_b64 exec, s[38:39]
    buffer_store_dword v72, v75, s[4:7], s55 offen sc1
    s_mov_b64 exec, -1
    v_smfmac_f32_16x16x64_bf16 v[16:19], v[40:43], v[240:247], v64
    s_cmp_ge_u32 s30, 56
    s_waitcnt lgkmcnt(0)
    s_barrier
    ds_read_b128 v[8:11], v66 offset:8192
    v_smfmac_f32_16x16x64_bf16 v[20:23], v[40:43], v[248:255], v64
    ds_read_b128 v[12:15], v67 offset:8192
    v_smfmac_f32_16x16x64_bf16 v[16:19], v[48:51], v[192:199], v64
    ds_read_b128 v[44:47], v68 offset:8192
    v_smfmac_f32_16x16x64_bf16 v[20:23], v[48:51], v[200:207], v64
    ds_read_b64 v[24:25], v77 offset:14336
    ds_read_b64 v[26:27], v77 offset:14592
    v_smfmac_f32_16x16x64_bf16 v[16:19], v[52:55], v[160:167], v64
    ds_read_b64 v[28:29], v77 offset:14848
    ds_read_b64 v[30:31], v77 offset:15104
    v_bitop3_b32 v77, v73, -9, s52 bitop3:0x6a
    v_smfmac_f32_16x16x64_bf16 v[20:23], v[52:55], v[168:175], v64
    s_cbranch_scc1 cs_rare
cs_rare_x:
    ds_read_b128 v[48:51], v70 offset:22528
    ds_read_b128 v[52:55], v70 offset:23552
    s_waitcnt lgkmcnt(6)
    v_pk_add_f32 v[4:5], v[4:5], v[8:9]
    v_pk_add_f32 v[6:7], v[6:7], v[10:11]
    v_pk_add_f32 v[12:13], v[12:13], v[44:45]
    v_pk_add_f32 v[14:15], v[14:15], v[46:47]
    v_pk_add_f32 v[4:5], v[4:5], v[12:13]
    v_pk_add_f32 v[6:7], v[6:7], v[14:15]
    s_waitcnt lgkmcnt(2)
    v_pk_add_f32 v[24:25], v[24:25], v[26:27]
    v_pk_add_f32 v[28:29], v[28:29], v[30:31]
    v_max3_f32 v8, v4, v5, v6
    v_pk_add_f32 v[24:25], v[24:25], v[28:29]
    v_max_f32 v8, v8, v7
    v_max3_f32 v8, v8, v24, v25
    v_cvt_pk_bf16_f32 v32, v16, v17
    v_cvt_pk_bf16_f32 v38, v18, v19
    v_max_f32_dpp v8, v8, v8 row_ror:8 row_mask:0xf bank_mask:0xf
    v_mov_b32 v9, v8
    v_cvt_pk_bf16_f32 v56, v20, v21
    v_cvt_pk_bf16_f32 v62, v22, v23
    v_permlane32_swap_b32 v8, v9
    v_max_f32 v8, v8, v9
    v_mov_b32 v9, v8
    v_mov_b32 v11, 0
    v_mov_b32 v15, 0
    v_permlane16_swap_b32 v8, v9
    v_max_f32 v8, v8, v9
    v_mul_f32 v8, s66, v8
    v_pk_fma_f32 v[4:5], v[4:5], s[44:45], v[8:9] op_sel_hi:[1,1,0]
    v_pk_fma_f32 v[6:7], v[6:7], s[44:45], v[8:9] op_sel_hi:[1,1,0]
    v_pk_fma_f32 v[24:25], v[24:25], s[44:45], v[8:9] op_sel_hi:[1,1,0]
    v_exp_f32 v4, v4
    v_exp_f32 v5, v5
    v_exp_f32 v6, v6
    v_exp_f32 v7, v7
    v_exp_f32 v24, v24
    v_exp_f32 v25, v25
    v_cvt_pk_bf16_f32 v12, v4, v5
    v_cvt_pk_bf16_f32 v13, v6, v7
    v_cvt_pk_bf16_f32 v10, v24, v25
    v_cvt_pk_bf16_f32 v14, v24, v25
    v_mov_b64 v[0:1], s[48:49]
    v_mfma_f32_16x16x32_bf16 v[4:7], v[32:35], v[10:13], 0
    ds_read_b128 v[40:43], v70 offset:20480
    v_mov_b64 v[2:3], s[50:51]
    v_mfma_f32_16x16x32_bf16 v[24:27], v[36:39], v[12:15], 0
    ds_read_b128 v[44:47], v70 offset:21504
    v_mov_b64 v[8:9], 0
    v_mfma_f32_16x16x32_bf16 v[28:31], v[0:3], v[10:13], 0
    ds_read_b128 v[32:35], v70 offset:24576
    v_mov_b64 v[0:1], 0
    v_mfma_f32_16x16x32_bf16 v[16:19], v[56:59], v[10:13], 0
    ds_read_b128 v[36:39], v70 offset:25600
    v_mov_b64 v[2:3], 0
    v_mfma_f32_16x16x32_bf16 v[20:23], v[60:63], v[12:15], 0
    ds_read_b128 v[56:59], v70 offset:28672
    v_add_f32_dpp v4, v24, v4 row_ror:8 row_mask:0xf bank_mask:0xf
    v_add_f32_dpp v5, v25, v5 row_ror:8 row_mask:0xf bank_mask:0xf
    v_add_f32_dpp v6, v26, v6 row_ror:8 row_mask:0xf bank_mask:0xf
    v_add_f32_dpp v7, v27, v7 row_ror:8 row_mask:0xf bank_mask:0xf
    v_add_f32_dpp v29, v28, v28 row_ror:8 row_mask:0xf bank_mask:0xf
    v_rcp_f32 v28, v29
    v_mov_b64 v[10:11], 0
    v_add_f32_dpp v4, v16, v20 row_ror:8 row_mask:0xf bank_mask:0xc
    v_add_f32_dpp v5, v17, v21 row_ror:8 row_mask:0xf bank_mask:0xc
    v_add_f32_dpp v6, v18, v22 row_ror:8 row_mask:0xf bank_mask:0xc
    v_add_f32_dpp v7, v19, v23 row_ror:8 row_mask:0xf bank_mask:0xc
    v_pk_mul_f32 v[4:5], v[4:5], v[28:29] op_sel_hi:[1,0]
    v_pk_mul_f32 v[6:7], v[6:7], v[28:29] op_sel_hi:[1,0]
    v_cvt_pk_bf16_f32 v4, v4, v5
    v_cvt_pk_bf16_f32 v5, v6, v7
    ds_write_b64 v73, v[4:5] offset:12288
    v_mov_b32_dpp v6, v4 row_ror:8 row_mask:0xf bank_mask:0xf
    v_mov_b32_dpp v7, v5 row_ror:8 row_mask:0xf bank_mask:0xf
    v_mov_b64 v[12:13], 0
    v_mov_b64 v[14:15], 0
    v_smfmac_f32_16x16x64_bf16 v[8:11], v[4:7], v[80:87], v64
    s_waitcnt lgkmcnt(4)
    v_mov_b64 v[24:25], 0
    v_smfmac_f32_16x16x64_bf16 v[0:3], v[4:7], v[40:47], v64
    ds_read_b128 v[60:63], v70 offset:29696
    v_mov_b64 v[26:27], 0
    v_smfmac_f32_16x16x64_bf16 v[12:15], v[4:7], v[112:119], v64
    s_waitcnt lgkmcnt(1)
    s_barrier
    ds_read_b128 v[16:19], v77 offset:12288
    v_smfmac_f32_16x16x64_bf16 v[24:27], v[4:7], v[48:55], v64
    ds_read_b128 v[20:23], v78 offset:12288
    ds_read_b128 v[28:31], v79 offset:12288
    v_mov_b64 v[4:5], 0
    v_mov_b64 v[6:7], 0
    v_bfe_u32 v77, v74, 16, 1
    v_mad_i32_i24 v77, v77, s56, v74
    s_waitcnt lgkmcnt(2)
    v_smfmac_f32_16x16x64_bf16 v[8:11], v[16:19], v[88:95], v64
    ds_read_b128 v[40:43], v70 offset:32768
    s_waitcnt lgkmcnt(2)
    v_smfmac_f32_16x16x64_bf16 v[8:11], v[20:23], v[96:103], v64
    ds_read_b128 v[44:47], v70 offset:33792
    s_waitcnt lgkmcnt(2)
    v_smfmac_f32_16x16x64_bf16 v[8:11], v[28:31], v[104:111], v64
    ds_read_b128 v[48:51], v70 offset:26624
    s_nop 0
    v_and_b32 v72, 8, v73
    v_smfmac_f32_16x16x64_bf16 v[0:3], v[16:19], v[32:39], v64
    ds_read_b128 v[52:55], v70 offset:27648
    s_nop 0
    v_mad_u32_u24 v72, v72, 63, v73
    v_smfmac_f32_16x16x64_bf16 v[12:15], v[16:19], v[120:127], v64
    ds_read_b128 v[32:35], v70 offset:30720
    v_cvt_pk_bf16_f32 v8, v8, v9
    v_cvt_pk_bf16_f32 v9, v10, v11
    v_and_or_b32 v8, v8, -2, s69
    v_smfmac_f32_16x16x64_bf16 v[12:15], v[20:23], v[128:135], v64
    buffer_store_dwordx2 v[8:9], v74, s[4:7], s22 offen offset:0 sc1
    ds_read_b128 v[36:39], v70 offset:31744
    v_smfmac_f32_16x16x64_bf16 v[12:15], v[28:31], v[136:143], v64
    s_add_u32 s30, s30, 1
    s_xor_b32 s70, s70, 1
    v_subrev_u32 v72, s47, v72
    v_smfmac_f32_16x16x64_bf16 v[0:3], v[20:23], v[56:63], v64
    ds_read_b128 v[56:59], v70 offset:34816
    s_waitcnt lgkmcnt(3)
    s_nop 0
    v_smfmac_f32_16x16x64_bf16 v[0:3], v[28:31], v[40:47], v64
    ds_read_b128 v[60:63], v70 offset:35840
    v_cvt_pk_bf16_f32 v12, v12, v13
    v_cvt_pk_bf16_f32 v13, v14, v15
    v_and_or_b32 v12, v12, -2, s69
    v_smfmac_f32_16x16x64_bf16 v[24:27], v[16:19], v[48:55], v64
    buffer_store_dwordx2 v[12:13], v74, s[4:7], s22 offen offset:64 sc1
    s_waitcnt lgkmcnt(2)
    v_smfmac_f32_16x16x64_bf16 v[24:27], v[20:23], v[32:39], v64
    ds_read_b128 v[40:43], v70 offset:16384
    v_cvt_pk_bf16_f32 v0, v0, v1
    v_cvt_pk_bf16_f32 v1, v2, v3
    v_and_or_b32 v0, v0, -2, s69
    s_waitcnt lgkmcnt(1)
    v_smfmac_f32_16x16x64_bf16 v[24:27], v[28:31], v[56:63], v64
    buffer_store_dwordx2 v[0:1], v74, s[4:7], s23 offen offset:0 sc1
    ds_read_b128 v[44:47], v70 offset:17408
    ds_read_b128 v[8:11], v72 offset:12288
    ds_read_b128 v[48:51], v70 offset:18432
    ds_read_b128 v[52:55], v70 offset:19456
    ds_read_b128 v[12:15], v72 offset:13312
    s_cmp_lg_u32 s71, 0
    s_nop 0
    v_cvt_pk_bf16_f32 v24, v24, v25
    v_cvt_pk_bf16_f32 v25, v26, v27
    v_and_or_b32 v24, v24, -2, s69
    buffer_store_dwordx2 v[24:25], v74, s[4:7], s23 offen offset:64 sc1
    s_waitcnt lgkmcnt(3)
    v_smfmac_f32_16x16x64_bf16 v[4:7], v[8:11], v[40:47], v64
    s_waitcnt lgkmcnt(0)
    v_smfmac_f32_16x16x64_bf16 v[4:7], v[12:15], v[48:55], v64
    s_nop 7
    v_cvt_pk_bf16_f32 v4, v4, v5
    v_cvt_pk_bf16_f32 v5, v6, v7
    v_and_or_b32 v4, v4, -2, s69
    buffer_store_dwordx2 v[4:5], v77, s[4:7], s25 offen offset:0 sc1
    s_nop 0
    s_cbranch_scc1 cs_e1
    s_cmp_lg_u32 s37, 0
    s_cbranch_scc1 cs_f0_xt
cs_f0_xtx:
    s_nop 2
    v_mov_b32 v79, v79
    s_nop 2
    v_mov_b32 v79, v79
    s_nop 2
    v_mov_b32 v79, v79
    s_nop 2
    v_mov_b32 v79, v79
    s_nop 2
    v_mov_b32 v79, v79
    s_nop 2
    v_mov_b32 v79, v79
    s_nop 2
    v_mov_b32 v79, v79
    s_nop 2
    v_mov_b32 v79, v79
    s_nop 2
    v_mov_b32 v79, v79
    s_nop 2
    v_mov_b32 v79, v79
    s_nop 2
    v_mov_b32 v79, v79
    s_nop 2
    v_mov_b32 v79, v79
    s_nop 2
    v_mov_b32 v79, v79
    s_nop 2
    v_mov_b32 v79, v79
    s_nop 2
    v_mov_b32 v79, v79
    s_nop 2
    v_mov_b32 v79, v79
    s_nop 2
    v_mov_b32 v79, v79
    s_nop 2
    v_mov_b32 v79, v79
    s_nop 2
    v_mov_b32 v79, v79
    s_nop 2
    v_mov_b32 v79, v79
    s_nop 2
    v_mov_b32 v79, v79
    s_nop 2
    v_mov_b32 v79, v79
    s_nop 2
    v_mov_b32 v79, v79
    s_nop 2
    v_mov_b32 v79, v79
    s_nop 2
    v_mov_b32 v79, v79
    s_nop 2
    v_mov_b32 v79, v79
    s_nop 2
    v_mov_b32 v79, v79
    s_nop 2
    v_mov_b32 v79, v79
    s_nop 2
    v_mov_b32 v79, v79
    s_nop 2
    v_mov_b32 v79, v79
    s_nop 2
    v_mov_b32 v79, v79
    s_nop 2
    v_mov_b32 v79, v79
    s_nop 2
    v_mov_b32 v79, v79
    s_nop 2
    v_mov_b32 v79, v79
    s_nop 2
    v_mov_b32 v79, v79
    s_nop 2
    v_mov_b32 v79, v79
    s_nop 0
    v_mov_b32 v79, v79
    buffer_load_dwordx4 v[8:11], v65, s[4:7], s18 offen sc1
    buffer_load_dwordx4 v[12:15], v65, s[4:7], s19 offen sc1
    buffer_load_dwordx4 v[16:19], v65, s[4:7], s20 offen sc1
    buffer_load_dwordx4 v[20:23], v65, s[4:7], s21 offen sc1
    v_and_b32 v77, 255, v69
    ds_read_b128 v[4:7], v77 offset:15872
    ds_read_b128 v[44:47], v70 offset:0
    ds_read_b128 v[48:51], v70 offset:1024
    ds_read_b128 v[52:55], v70 offset:2048
    ds_read_b128 v[56:59], v70 offset:3072
    ds_read_b128 v[24:27], v70 offset:4096
    ds_read_b128 v[28:31], v70 offset:5120
    ds_read_b128 v[32:35], v70 offset:6144
    ds_read_b128 v[36:39], v70 offset:7168
    s_mov_b32 s31, 65536
    s_add_u32 s24, s24, 524288
    s_add_u32 s26, s26, 524288
    s_add_u32 s55, s55, s57
    s_mov_b32 s14, 67633152
    s_mov_b32 s15, 67637248
    s_mov_b32 s16, 67641344
    s_mov_b32 s36, 1
    v_mov_b32 v40, s69
    v_mov_b32 v60, s69
    v_mov_b32 v79, 1
    s_waitcnt lgkmcnt(0)
    s_waitcnt vmcnt(3)
    v_bitop3_b32 v77, v8, v10, s69 bitop3:0x7e
    v_mfma_f32_16x16x32_bf16 v[0:3], v[4:7], v[8:11], 0
    v_mov_b64 v[8:9], 0
    v_mov_b64 v[10:11], 0
    s_waitcnt vmcnt(2)
    v_bitop3_b32 v78, v12, v14, s69 bitop3:0x7e
    v_mfma_f32_16x16x32_bf16 v[0:3], v[4:7], v[12:15], v[0:3]
    v_or_b32 v77, v77, v78
    v_mov_b64 v[12:13], 0
    v_mov_b64 v[14:15], 0
    s_waitcnt vmcnt(1)
    v_bitop3_b32 v78, v16, v18, s69 bitop3:0x7e
    v_mfma_f32_16x16x32_bf16 v[0:3], v[4:7], v[16:19], v[0:3]
    v_or_b32 v77, v77, v78
    v_mov_b64 v[16:17], 0
    v_mov_b64 v[18:19], 0
    s_waitcnt vmcnt(0)
    v_bitop3_b32 v78, v20, v22, s69 bitop3:0x7e
    v_mfma_f32_16x16x32_bf16 v[0:3], v[4:7], v[20:23], v[0:3]
    v_bitop3_b32 v77, v77, v78, 1 bitop3:0xa8
    v_cmp_ne_u32 vcc, 0, v77
    v_mov_b64 v[20:21], 0
    v_mov_b64 v[22:23], 0
    s_cmp_eq_u64 vcc, 0
    s_cselect_b64 s[42:43], -1, 0
    s_nop 1
    v_add_f32_dpp v0, v0, v0 row_ror:8 row_mask:0xf bank_mask:0xf
    v_add_f32_dpp v1, v1, v1 row_ror:8 row_mask:0xf bank_mask:0xf
    s_mov_b64 exec, s[42:43]
    v_cvt_pk_bf16_f32 v72, v0, v1
    v_bfi_b32 v72, v79, s70, v72
    buffer_store_dword v72, v75, s[4:7], s17 offen offset:0 sc1
    s_mov_b64 exec, -1
    s_cbranch_scc0 cs_f0_retry
cs_f0_go:
    v_mov_b64 v[0:1], 0
    v_mov_b64 v[2:3], 0
    v_mov_b64 v[4:5], 0
    v_mov_b64 v[6:7], 0
    s_nop 2
    v_mov_b32 v79, v79
    s_nop 2
    v_mov_b32 v79, v79
    s_nop 2
    v_mov_b32 v79, v79
    s_nop 2
    v_mov_b32 v79, v79
    s_nop 2
    v_mov_b32 v79, v79
    s_nop 2
    v_mov_b32 v79, v79
    s_nop 2
    v_mov_b32 v79, v79
    s_nop 2
    v_mov_b32 v79, v79
    s_nop 2
    v_mov_b32 v79, v79
    s_nop 2
    v_mov_b32 v79, v79
    s_nop 2
    v_mov_b32 v79, v79
    s_nop 2
    v_mov_b32 v79, v79
    s_nop 2
    v_mov_b32 v79, v79
    s_nop 2
    v_mov_b32 v79, v79
    s_nop 2
    v_mov_b32 v79, v79
    s_nop 2
    v_mov_b32 v79, v79
    s_nop 2
    v_mov_b32 v79, v79
    s_nop 2
    v_mov_b32 v79, v79
    s_nop 2
    v_mov_b32 v79, v79
    s_nop 2
    v_mov_b32 v79, v79
    s_nop 2
    v_mov_b32 v79, v79
    s_nop 2
    v_mov_b32 v79, v79
    s_nop 2
    v_mov_b32 v79, v79
    s_nop 2
    v_mov_b32 v79, v79
    s_nop 2
    v_mov_b32 v79, v79
    s_branch cs_loop
cs_e1:
    s_cmp_lg_u32 s71, 2
    s_cbranch_scc1 cs_f1
    v_and_b32 v77, 255, v69
    ds_read_b128 v[4:7], v77 offset:15872
    ds_read_b128 v[44:47], v70 offset:0
    ds_read_b128 v[48:51], v70 offset:1024
    ds_read_b128 v[52:55], v70 offset:2048
    ds_read_b128 v[56:59], v70 offset:3072
    ds_read_b128 v[24:27], v70 offset:4096
    ds_read_b128 v[28:31], v70 offset:5120
    ds_read_b128 v[32:35], v70 offset:6144
    ds_read_b128 v[36:39], v70 offset:7168
    s_mov_b32 s31, 65536
    s_add_u32 s24, s24, 524288
    s_add_u32 s26, s26, 524288
    s_add_u32 s55, s55, s57
    s_mov_b32 s14, 67633152
    s_mov_b32 s15, 67637248
    s_mov_b32 s16, 67641344
    s_mov_b32 s36, 1
    v_mov_b32 v40, s69
    v_mov_b32 v60, s69
    v_mov_b32 v79, 1
    s_cmp_lg_u32 s37, 0
    s_cbranch_scc1 cs_f2_xt
cs_f2_xtx:
    s_nop 2
    v_mov_b32 v79, v79
    s_nop 2
    v_mov_b32 v79, v79
    s_nop 2
    v_mov_b32 v79, v79
    s_nop 2
    v_mov_b32 v79, v79
    s_nop 2
    v_mov_b32 v79, v79
    s_nop 2
    v_mov_b32 v79, v79
    s_nop 2
    v_mov_b32 v79, v79
    s_nop 2
    v_mov_b32 v79, v79
    s_nop 2
    v_mov_b32 v79, v79
    s_nop 2
    v_mov_b32 v79, v79
    s_nop 2
    v_mov_b32 v79, v79
    s_nop 2
    v_mov_b32 v79, v79
    s_nop 2
    v_mov_b32 v79, v79
    s_nop 2
    v_mov_b32 v79, v79
    s_nop 2
    v_mov_b32 v79, v79
    s_nop 2
    v_mov_b32 v79, v79
    s_nop 2
    v_mov_b32 v79, v79
    s_nop 2
    v_mov_b32 v79, v79
    s_nop 2
    v_mov_b32 v79, v79
    s_nop 2
    v_mov_b32 v79, v79
    s_nop 2
    v_mov_b32 v79, v79
    s_nop 2
    v_mov_b32 v79, v79
    s_nop 2
    v_mov_b32 v79, v79
    s_nop 2
    v_mov_b32 v79, v79
    s_nop 2
    v_mov_b32 v79, v79
    s_nop 2
    v_mov_b32 v79, v79
    s_nop 2
    v_mov_b32 v79, v79
    s_nop 2
    v_mov_b32 v79, v79
    s_nop 2
    v_mov_b32 v79, v79
    s_nop 2
    v_mov_b32 v79, v79
    s_nop 2
    v_mov_b32 v79, v79
    s_nop 2
    v_mov_b32 v79, v79
    s_nop 2
    v_mov_b32 v79, v79
    s_nop 2
    v_mov_b32 v79, v79
    s_nop 2
    v_mov_b32 v79, v79
    s_nop 2
    v_mov_b32 v79, v79
    s_nop 0
    v_mov_b32 v79, v79
    s_waitcnt vmcnt(0)
    buffer_load_dwordx4 v[8:11], v65, s[4:7], s18 offen sc1
    buffer_load_dwordx4 v[12:15], v65, s[4:7], s19 offen sc1
    buffer_load_dwordx4 v[16:19], v65, s[4:7], s20 offen sc1
    buffer_load_dwordx4 v[20:23], v65, s[4:7], s21 offen sc1
    s_nop 2
    v_mov_b32 v79, v79
    s_nop 2
    v_mov_b32 v79, v79
    s_nop 2
    v_mov_b32 v79, v79
    s_nop 2
    v_mov_b32 v79, v79
    s_nop 2
    v_mov_b32 v79, v79
    s_nop 2
    v_mov_b32 v79, v79
    s_nop 2
    v_mov_b32 v79, v79
    s_nop 2
    v_mov_b32 v79, v79
    s_nop 2
    v_mov_b32 v79, v79
    s_nop 2
    v_mov_b32 v79, v79
    buffer_load_dwordx4 v[40:43], v65, s[4:7], s14 offen offset:0 sc1
    buffer_load_dwordx4 v[60:63], v66, s[4:7], s14 offen offset:0 sc1
    s_waitcnt lgkmcnt(0)
    s_waitcnt vmcnt(5)
    v_bitop3_b32 v77, v8, v10, s69 bitop3:0x7e
    v_mfma_f32_16x16x32_bf16 v[0:3], v[4:7], v[8:11], 0
    v_mov_b64 v[8:9], 0
    v_mov_b64 v[10:11], 0
    s_waitcnt vmcnt(4)
    v_bitop3_b32 v78, v12, v14, s69 bitop3:0x7e
    v_mfma_f32_16x16x32_bf16 v[0:3], v[4:7], v[12:15], v[0:3]
    v_or_b32 v77, v77, v78
    v_mov_b64 v[12:13], 0
    v_mov_b64 v[14:15], 0
    s_waitcnt vmcnt(3)
    v_bitop3_b32 v78, v16, v18, s69 bitop3:0x7e
    v_mfma_f32_16x16x32_bf16 v[0:3], v[4:7], v[16:19], v[0:3]
    v_or_b32 v77, v77, v78
    v_mov_b64 v[16:17], 0
    v_mov_b64 v[18:19], 0
    s_waitcnt vmcnt(2)
    v_bitop3_b32 v78, v20, v22, s69 bitop3:0x7e
    v_mfma_f32_16x16x32_bf16 v[0:3], v[4:7], v[20:23], v[0:3]
    v_bitop3_b32 v77, v77, v78, 1 bitop3:0xa8
    v_cmp_ne_u32 vcc, 0, v77
    v_mov_b64 v[20:21], 0
    v_mov_b64 v[22:23], 0
    buffer_load_dwordx4 v[40:43], v65, s[4:7], s14 offen offset:0 sc1
    buffer_load_dwordx4 v[60:63], v66, s[4:7], s14 offen offset:0 sc1
    s_cmp_eq_u64 vcc, 0
    s_cselect_b64 s[42:43], -1, 0
    v_add_f32_dpp v0, v0, v0 row_ror:4 row_mask:0xf bank_mask:0xf
    v_add_f32_dpp v1, v1, v1 row_ror:4 row_mask:0xf bank_mask:0xf
    s_nop 0
    v_add_f32_dpp v0, v0, v0 row_ror:8 row_mask:0xf bank_mask:0xf
    v_add_f32_dpp v1, v1, v1 row_ror:8 row_mask:0xf bank_mask:0xf
    s_mov_b64 exec, s[42:43]
    v_cvt_pk_bf16_f32 v72, v0, v1
    v_bfi_b32 v72, v79, s70, v72
    buffer_store_dword v72, v75, s[4:7], s17 offen offset:0 sc1
    buffer_store_dword v72, v75, s[4:7], s17 offen offset:1024 sc1
    buffer_store_dword v72, v75, s[4:7], s17 offen offset:2048 sc1
    buffer_store_dword v72, v75, s[4:7], s17 offen offset:3072 sc1
    s_mov_b64 exec, -1
    s_cbranch_scc0 cs_f2_retry
cs_f2_go:
    v_mov_b64 v[0:1], 0
    v_mov_b64 v[2:3], 0
    v_mov_b64 v[4:5], 0
    v_mov_b64 v[6:7], 0
    s_nop 2
    v_mov_b32 v79, v79
    s_nop 2
    v_mov_b32 v79, v79
    s_nop 2
    v_mov_b32 v79, v79
    s_nop 2
    v_mov_b32 v79, v79
    s_nop 2
    v_mov_b32 v79, v79
    s_nop 2
    v_mov_b32 v79, v79
    s_nop 2
    v_mov_b32 v79, v79
    s_nop 2
    v_mov_b32 v79, v79
    s_nop 2
    v_mov_b32 v79, v79
    s_nop 2
    v_mov_b32 v79, v79
    s_nop 2
    v_mov_b32 v79, v79
    s_nop 2
    v_mov_b32 v79, v79
    s_nop 2
    v_mov_b32 v79, v79
    s_nop 2
    v_mov_b32 v79, v79
    s_nop 2
    v_mov_b32 v79, v79
    s_nop 2
    v_mov_b32 v79, v79
    s_nop 2
    v_mov_b32 v79, v79
    s_nop 2
    v_mov_b32 v79, v79
    s_nop 2
    v_mov_b32 v79, v79
    s_nop 2
    v_mov_b32 v79, v79
    s_nop 2
    v_mov_b32 v79, v79
    s_nop 2
    v_mov_b32 v79, v79
    s_nop 2
    v_mov_b32 v79, v79
    s_nop 2
    v_mov_b32 v79, v79
    s_nop 2
    v_mov_b32 v79, v79
    s_branch cs_loop
cs_f1:
    s_cmp_lg_u32 s32, 1
    s_cbranch_scc1 cs_f3
    v_and_b32 v77, 255, v69
    ds_read_b128 v[4:7], v77 offset:15872
    ds_read_b128 v[44:47], v70 offset:0
    ds_read_b128 v[48:51], v70 offset:1024
    ds_read_b128 v[52:55], v70 offset:2048
    ds_read_b128 v[56:59], v70 offset:3072
    ds_read_b128 v[24:27], v70 offset:4096
    ds_read_b128 v[28:31], v70 offset:5120
    ds_read_b128 v[32:35], v70 offset:6144
    ds_read_b128 v[36:39], v70 offset:7168
    s_mov_b32 s31, 65536
    s_add_u32 s24, s24, 524288
    s_add_u32 s26, s26, 524288
    s_add_u32 s55, s55, s57
    s_mov_b32 s14, 67633152
    s_mov_b32 s15, 67637248
    s_mov_b32 s16, 67641344
    s_mov_b32 s36, 1
    v_mov_b32 v40, s69
    v_mov_b32 v60, s69
    v_mov_b32 v79, 1
    s_cmp_lg_u32 s37, 0
    s_cbranch_scc1 cs_f1_xt
cs_f1_xtx:
    s_nop 2
    v_mov_b32 v79, v79
    s_nop 2
    v_mov_b32 v79, v79
    s_nop 2
    v_mov_b32 v79, v79
    s_nop 2
    v_mov_b32 v79, v79
    s_nop 2
    v_mov_b32 v79, v79
    s_nop 2
    v_mov_b32 v79, v79
    s_nop 2
    v_mov_b32 v79, v79
    s_nop 2
    v_mov_b32 v79, v79
    s_nop 2
    v_mov_b32 v79, v79
    s_nop 2
    v_mov_b32 v79, v79
    s_nop 2
    v_mov_b32 v79, v79
    s_nop 2
    v_mov_b32 v79, v79
    s_nop 2
    v_mov_b32 v79, v79
    s_nop 2
    v_mov_b32 v79, v79
    s_nop 2
    v_mov_b32 v79, v79
    s_nop 2
    v_mov_b32 v79, v79
    s_nop 2
    v_mov_b32 v79, v79
    s_nop 2
    v_mov_b32 v79, v79
    s_nop 2
    v_mov_b32 v79, v79
    s_nop 2
    v_mov_b32 v79, v79
    s_nop 2
    v_mov_b32 v79, v79
    s_nop 2
    v_mov_b32 v79, v79
    s_nop 2
    v_mov_b32 v79, v79
    s_nop 2
    v_mov_b32 v79, v79
    s_nop 2
    v_mov_b32 v79, v79
    s_nop 2
    v_mov_b32 v79, v79
    s_nop 2
    v_mov_b32 v79, v79
    s_nop 2
    v_mov_b32 v79, v79
    s_nop 2
    v_mov_b32 v79, v79
    s_nop 2
    v_mov_b32 v79, v79
    s_nop 2
    v_mov_b32 v79, v79
    s_nop 2
    v_mov_b32 v79, v79
    s_nop 2
    v_mov_b32 v79, v79
    s_nop 2
    v_mov_b32 v79, v79
    s_nop 2
    v_mov_b32 v79, v79
    s_nop 2
    v_mov_b32 v79, v79
    s_nop 0
    v_mov_b32 v79, v79
    s_waitcnt vmcnt(0)
    buffer_load_dwordx4 v[8:11], v65, s[4:7], s18 offen sc1
    buffer_load_dwordx4 v[12:15], v65, s[4:7], s19 offen sc1
    buffer_load_dwordx4 v[16:19], v65, s[4:7], s20 offen sc1
    buffer_load_dwordx4 v[20:23], v65, s[4:7], s21 offen sc1
    s_nop 2
    v_mov_b32 v79, v79
    s_nop 2
    v_mov_b32 v79, v79
    s_nop 2
    v_mov_b32 v79, v79
    s_nop 2
    v_mov_b32 v79, v79
    s_nop 2
    v_mov_b32 v79, v79
    s_nop 2
    v_mov_b32 v79, v79
    s_nop 2
    v_mov_b32 v79, v79
    s_nop 2
    v_mov_b32 v79, v79
    s_nop 2
    v_mov_b32 v79, v79
    s_nop 2
    v_mov_b32 v79, v79
    buffer_load_dwordx4 v[40:43], v65, s[4:7], s14 offen offset:0 sc1
    buffer_load_dwordx4 v[60:63], v66, s[4:7], s14 offen offset:0 sc1
    s_waitcnt lgkmcnt(0)
    s_waitcnt vmcnt(5)
    v_bitop3_b32 v77, v8, v10, s69 bitop3:0x7e
    v_mfma_f32_16x16x32_bf16 v[0:3], v[4:7], v[8:11], 0
    v_mov_b64 v[8:9], 0
    v_mov_b64 v[10:11], 0
    s_waitcnt vmcnt(4)
    v_bitop3_b32 v78, v12, v14, s69 bitop3:0x7e
    v_mfma_f32_16x16x32_bf16 v[0:3], v[4:7], v[12:15], v[0:3]
    v_or_b32 v77, v77, v78
    v_mov_b64 v[12:13], 0
    v_mov_b64 v[14:15], 0
    s_waitcnt vmcnt(3)
    v_bitop3_b32 v78, v16, v18, s69 bitop3:0x7e
    v_mfma_f32_16x16x32_bf16 v[0:3], v[4:7], v[16:19], v[0:3]
    v_or_b32 v77, v77, v78
    v_mov_b64 v[16:17], 0
    v_mov_b64 v[18:19], 0
    s_waitcnt vmcnt(2)
    v_bitop3_b32 v78, v20, v22, s69 bitop3:0x7e
    v_mfma_f32_16x16x32_bf16 v[0:3], v[4:7], v[20:23], v[0:3]
    v_bitop3_b32 v77, v77, v78, 1 bitop3:0xa8
    v_cmp_ne_u32 vcc, 0, v77
    v_mov_b64 v[20:21], 0
    v_mov_b64 v[22:23], 0
    buffer_load_dwordx4 v[40:43], v65, s[4:7], s14 offen offset:0 sc1
    buffer_load_dwordx4 v[60:63], v66, s[4:7], s14 offen offset:0 sc1
    s_cmp_eq_u64 vcc, 0
    s_cselect_b64 s[42:43], -1, 0
    v_add_f32_dpp v0, v0, v0 row_ror:8 row_mask:0xf bank_mask:0xf
    v_add_f32_dpp v1, v1, v1 row_ror:8 row_mask:0xf bank_mask:0xf
    s_mov_b64 exec, s[42:43]
    v_cvt_pk_bf16_f32 v72, v0, v1
    v_bfi_b32 v72, v79, s70, v72
    buffer_store_dword v72, v75, s[4:7], s17 offen offset:0 sc1
    s_mov_b64 exec, -1
    s_cbranch_scc0 cs_f1_retry
cs_f1_go:
    v_mov_b64 v[0:1], 0
    v_mov_b64 v[2:3], 0
    v_mov_b64 v[4:5], 0
    v_mov_b64 v[6:7], 0
    s_nop 2
    v_mov_b32 v79, v79
    s_nop 2
    v_mov_b32 v79, v79
    s_nop 2
    v_mov_b32 v79, v79
    s_nop 2
    v_mov_b32 v79, v79
    s_nop 2
    v_mov_b32 v79, v79
    s_nop 2
    v_mov_b32 v79, v79
    s_nop 2
    v_mov_b32 v79, v79
    s_nop 2
    v_mov_b32 v79, v79
    s_nop 2
    v_mov_b32 v79, v79
    s_nop 2
    v_mov_b32 v79, v79
    s_nop 2
    v_mov_b32 v79, v79
    s_nop 2
    v_mov_b32 v79, v79
    s_nop 2
    v_mov_b32 v79, v79
    s_nop 2
    v_mov_b32 v79, v79
    s_nop 2
    v_mov_b32 v79, v79
    s_nop 2
    v_mov_b32 v79, v79
    s_nop 2
    v_mov_b32 v79, v79
    s_nop 2
    v_mov_b32 v79, v79
    s_nop 2
    v_mov_b32 v79, v79
    s_nop 2
    v_mov_b32 v79, v79
    s_nop 2
    v_mov_b32 v79, v79
    s_nop 2
    v_mov_b32 v79, v79
    s_nop 2
    v_mov_b32 v79, v79
    s_nop 2
    v_mov_b32 v79, v79
    s_nop 2
    v_mov_b32 v79, v79
    s_branch cs_loop
cs_f3:
    v_and_b32 v77, 255, v69
    ds_read_b128 v[4:7], v77 offset:15872
    ds_read_b128 v[44:47], v70 offset:0
    ds_read_b128 v[48:51], v70 offset:1024
    ds_read_b128 v[52:55], v70 offset:2048
    ds_read_b128 v[56:59], v70 offset:3072
    ds_read_b128 v[24:27], v70 offset:4096
    ds_read_b128 v[28:31], v70 offset:5120
    ds_read_b128 v[32:35], v70 offset:6144
    ds_read_b128 v[36:39], v70 offset:7168
    s_mov_b32 s31, 65536
    s_add_u32 s24, s24, 524288
    s_add_u32 s26, s26, 524288
    s_add_u32 s55, s55, s57
    s_mov_b32 s14, 67633152
    s_mov_b32 s15, 67637248
    s_mov_b32 s16, 67641344
    s_mov_b32 s36, 1
    v_mov_b32 v40, s69
    v_mov_b32 v60, s69
    v_mov_b32 v79, 1
    s_add_u32 s40, s30, s95
    v_mov_b32 v72, s40
    s_waitcnt lgkmcnt(0)
    v_mov_b64 v[0:1], 0
    v_mov_b64 v[2:3], 0
    v_mov_b64 v[4:5], 0
    v_mov_b64 v[6:7], 0
    v_mov_b64 v[8:9], 0
    v_mov_b64 v[10:11], 0
    v_mov_b64 v[12:13], 0
    v_mov_b64 v[14:15], 0
    v_mov_b64 v[16:17], 0
    v_mov_b64 v[18:19], 0
    v_mov_b64 v[20:21], 0
    v_mov_b64 v[22:23], 0
    s_nop 2
    v_mov_b32 v79, v79
    s_nop 2
    v_mov_b32 v79, v79
    s_nop 2
    v_mov_b32 v79, v79
    s_nop 2
    v_mov_b32 v79, v79
    s_nop 2
    v_mov_b32 v79, v79
    s_nop 2
    v_mov_b32 v79, v79
    s_nop 2
    v_mov_b32 v79, v79
    s_nop 2
    v_mov_b32 v79, v79
    s_nop 2
    v_mov_b32 v79, v79
    s_nop 2
    v_mov_b32 v79, v79
    s_nop 2
    v_mov_b32 v79, v79
    s_nop 2
    v_mov_b32 v79, v79
    s_nop 2
    v_mov_b32 v79, v79
    s_nop 2
    v_mov_b32 v79, v79
    s_nop 2
    v_mov_b32 v79, v79
    s_nop 2
    v_mov_b32 v79, v79
    s_nop 2
    v_mov_b32 v79, v79
    s_nop 2
    v_mov_b32 v79, v79
    s_nop 2
    v_mov_b32 v79, v79
    s_nop 2
    v_mov_b32 v79, v79
    s_nop 2
    v_mov_b32 v79, v79
    s_nop 2
    v_mov_b32 v79, v79
    s_nop 2
    v_mov_b32 v79, v79
    s_nop 2
    v_mov_b32 v79, v79
    s_nop 2
    v_mov_b32 v79, v79
    s_nop 2
    v_mov_b32 v79, v79
    s_nop 2
    v_mov_b32 v79, v79
    s_nop 2
    v_mov_b32 v79, v79
    s_nop 2
    v_mov_b32 v79, v79
    s_nop 2
    v_mov_b32 v79, v79
    s_nop 2
    v_mov_b32 v79, v79
    s_nop 2
    v_mov_b32 v79, v79
    s_nop 2
    v_mov_b32 v79, v79
    s_nop 2
    v_mov_b32 v79, v79
    s_nop 2
    v_mov_b32 v79, v79
    s_nop 2
    v_mov_b32 v79, v79
    s_nop 2
    v_mov_b32 v79, v79
    s_nop 2
    v_mov_b32 v79, v79
    s_nop 2
    v_mov_b32 v79, v79
    s_nop 2
    v_mov_b32 v79, v79
    s_nop 2
    v_mov_b32 v79, v79
    s_nop 2
    v_mov_b32 v79, v79
    s_nop 2
    v_mov_b32 v79, v79
    s_nop 2
    v_mov_b32 v79, v79
    s_nop 2
    v_mov_b32 v79, v79
    s_nop 2
    v_mov_b32 v79, v79
    s_nop 2
    v_mov_b32 v79, v79
    s_nop 2
    v_mov_b32 v79, v79
    s_nop 2
    v_mov_b32 v79, v79
    s_nop 2
    v_mov_b32 v79, v79
    s_nop 2
    v_mov_b32 v79, v79
    s_nop 2
    v_mov_b32 v79, v79
    s_nop 2
    v_mov_b32 v79, v79
    s_nop 2
    v_mov_b32 v79, v79
    s_nop 2
    v_mov_b32 v79, v79
    s_nop 2
    v_mov_b32 v79, v79
    s_nop 2
    v_mov_b32 v79, v79
    s_nop 2
    v_mov_b32 v79, v79
    s_nop 2
    v_mov_b32 v79, v79
    s_nop 2
    v_mov_b32 v79, v79
    s_nop 2
    v_mov_b32 v79, v79
    s_nop 2
    v_mov_b32 v79, v79
    s_nop 2
    v_mov_b32 v79, v79
    s_nop 2
    v_mov_b32 v79, v79
    s_nop 2
    v_mov_b32 v79, v79
    s_waitcnt vmcnt(0)
    s_mov_b32 s40, s67
    s_add_u32 s67, s30, 5
    s_min_u32 s67, s67, s93
    s_cmp_lt_u32 s97, s40
    s_cbranch_scc1 cs_kvwait
    s_nop 2
    v_mov_b32 v79, v79
    s_nop 2
    v_mov_b32 v79, v79
    s_nop 2
    v_mov_b32 v79, v79
    s_nop 2
    v_mov_b32 v79, v79
    s_nop 2
    v_mov_b32 v79, v79
    s_nop 2
    v_mov_b32 v79, v79
    s_nop 2
    v_mov_b32 v79, v79
    s_nop 2
    v_mov_b32 v79, v79
cs_kvok:
    s_branch cs_loop
cs_f0_xt:
    s_sub_u32 s37, s37, 1
    s_nop 2
    v_mov_b32 v79, v79
    s_nop 2
    v_mov_b32 v79, v79
    s_nop 2
    v_mov_b32 v79, v79
    s_nop 2
    v_mov_b32 v79, v79
    s_nop 2
    v_mov_b32 v79, v79
    s_nop 2
    v_mov_b32 v79, v79
    s_branch cs_f0_xtx
cs_f0_retry:
    s_sub_u32 s41, s30, s98
    s_mov_b32 s98, s30
    s_cmp_le_u32 s41, 3
    s_cselect_b32 s37, 1, 1
cs_f0_spin:
    buffer_load_dwordx4 v[8:11], v65, s[4:7], s18 offen sc1
    buffer_load_dwordx4 v[12:15], v65, s[4:7], s19 offen sc1
    buffer_load_dwordx4 v[16:19], v65, s[4:7], s20 offen sc1
    buffer_load_dwordx4 v[20:23], v65, s[4:7], s21 offen sc1
    s_nop 2
    v_mov_b32 v79, v79
    s_nop 2
    v_mov_b32 v79, v79
    s_nop 2
    v_mov_b32 v79, v79
    buffer_load_dwordx4 v[40:43], v65, s[4:7], s14 offen offset:0 sc1
    buffer_load_dwordx4 v[60:63], v66, s[4:7], s14 offen offset:0 sc1
    s_waitcnt vmcnt(5)
    v_bitop3_b32 v77, v8, v10, s69 bitop3:0x7e
    v_mfma_f32_16x16x32_bf16 v[0:3], v[4:7], v[8:11], 0
    v_mov_b64 v[8:9], 0
    v_mov_b64 v[10:11], 0
    s_waitcnt vmcnt(4)
    v_bitop3_b32 v78, v12, v14, s69 bitop3:0x7e
    v_mfma_f32_16x16x32_bf16 v[0:3], v[4:7], v[12:15], v[0:3]
    v_or_b32 v77, v77, v78
    v_mov_b64 v[12:13], 0
    v_mov_b64 v[14:15], 0
    s_waitcnt vmcnt(3)
    v_bitop3_b32 v78, v16, v18, s69 bitop3:0x7e
    v_mfma_f32_16x16x32_bf16 v[0:3], v[4:7], v[16:19], v[0:3]
    v_or_b32 v77, v77, v78
    v_mov_b64 v[16:17], 0
    v_mov_b64 v[18:19], 0
    s_waitcnt vmcnt(2)
    v_bitop3_b32 v78, v20, v22, s69 bitop3:0x7e
    v_mfma_f32_16x16x32_bf16 v[0:3], v[4:7], v[20:23], v[0:3]
    v_bitop3_b32 v77, v77, v78, 1 bitop3:0xa8
    v_cmp_ne_u32 vcc, 0, v77
    v_mov_b64 v[20:21], 0
    v_mov_b64 v[22:23], 0
    buffer_load_dwordx4 v[40:43], v65, s[4:7], s14 offen offset:0 sc1
    buffer_load_dwordx4 v[60:63], v66, s[4:7], s14 offen offset:0 sc1
    s_cmp_eq_u64 vcc, 0
    s_cselect_b64 s[42:43], -1, 0
    v_add_f32_dpp v0, v0, v0 row_ror:8 row_mask:0xf bank_mask:0xf
    v_add_f32_dpp v1, v1, v1 row_ror:8 row_mask:0xf bank_mask:0xf
    s_mov_b64 exec, s[42:43]
    v_cvt_pk_bf16_f32 v72, v0, v1
    v_bfi_b32 v72, v79, s70, v72
    buffer_store_dword v72, v75, s[4:7], s17 offen offset:0 sc1
    s_mov_b64 exec, -1
    s_cbranch_scc1 cs_f0_rx
    s_sub_u32 s31, s31, 1
    s_cbranch_scc0 cs_f0_spin
cs_f0_rx:
    v_mov_b64 v[0:1], 0
    v_mov_b64 v[2:3], 0
    v_mov_b64 v[4:5], 0
    v_mov_b64 v[6:7], 0
    s_branch cs_loop
cs_f1_xt:
    s_sub_u32 s37, s37, 1
    s_nop 2
    v_mov_b32 v79, v79
    s_nop 2
    v_mov_b32 v79, v79
    s_nop 2
    v_mov_b32 v79, v79
    s_nop 2
    v_mov_b32 v79, v79
    s_nop 2
    v_mov_b32 v79, v79
    s_nop 2
    v_mov_b32 v79, v79
    s_branch cs_f1_xtx
cs_f1_retry:
    s_sub_u32 s41, s30, s98
    s_mov_b32 s98, s30
    s_cmp_le_u32 s41, 3
    s_cselect_b32 s37, 1, 1
cs_f1_spin:
    buffer_load_dwordx4 v[8:11], v65, s[4:7], s18 offen sc1
    buffer_load_dwordx4 v[12:15], v65, s[4:7], s19 offen sc1
    buffer_load_dwordx4 v[16:19], v65, s[4:7], s20 offen sc1
    buffer_load_dwordx4 v[20:23], v65, s[4:7], s21 offen sc1
    s_nop 2
    v_mov_b32 v79, v79
    s_nop 2
    v_mov_b32 v79, v79
    s_nop 2
    v_mov_b32 v79, v79
    buffer_load_dwordx4 v[40:43], v65, s[4:7], s14 offen offset:0 sc1
    buffer_load_dwordx4 v[60:63], v66, s[4:7], s14 offen offset:0 sc1
    s_waitcnt vmcnt(5)
    v_bitop3_b32 v77, v8, v10, s69 bitop3:0x7e
    v_mfma_f32_16x16x32_bf16 v[0:3], v[4:7], v[8:11], 0
    v_mov_b64 v[8:9], 0
    v_mov_b64 v[10:11], 0
    s_waitcnt vmcnt(4)
    v_bitop3_b32 v78, v12, v14, s69 bitop3:0x7e
    v_mfma_f32_16x16x32_bf16 v[0:3], v[4:7], v[12:15], v[0:3]
    v_or_b32 v77, v77, v78
    v_mov_b64 v[12:13], 0
    v_mov_b64 v[14:15], 0
    s_waitcnt vmcnt(3)
    v_bitop3_b32 v78, v16, v18, s69 bitop3:0x7e
    v_mfma_f32_16x16x32_bf16 v[0:3], v[4:7], v[16:19], v[0:3]
    v_or_b32 v77, v77, v78
    v_mov_b64 v[16:17], 0
    v_mov_b64 v[18:19], 0
    s_waitcnt vmcnt(2)
    v_bitop3_b32 v78, v20, v22, s69 bitop3:0x7e
    v_mfma_f32_16x16x32_bf16 v[0:3], v[4:7], v[20:23], v[0:3]
    v_bitop3_b32 v77, v77, v78, 1 bitop3:0xa8
    v_cmp_ne_u32 vcc, 0, v77
    v_mov_b64 v[20:21], 0
    v_mov_b64 v[22:23], 0
    buffer_load_dwordx4 v[40:43], v65, s[4:7], s14 offen offset:0 sc1
    buffer_load_dwordx4 v[60:63], v66, s[4:7], s14 offen offset:0 sc1
    s_cmp_eq_u64 vcc, 0
    s_cselect_b64 s[42:43], -1, 0
    v_add_f32_dpp v0, v0, v0 row_ror:8 row_mask:0xf bank_mask:0xf
    v_add_f32_dpp v1, v1, v1 row_ror:8 row_mask:0xf bank_mask:0xf
    s_mov_b64 exec, s[42:43]
    v_cvt_pk_bf16_f32 v72, v0, v1
    v_bfi_b32 v72, v79, s70, v72
    buffer_store_dword v72, v75, s[4:7], s17 offen offset:0 sc1
    s_mov_b64 exec, -1
    s_cbranch_scc1 cs_f1_rx
    s_sub_u32 s31, s31, 1
    s_cbranch_scc0 cs_f1_spin
cs_f1_rx:
    v_mov_b64 v[0:1], 0
    v_mov_b64 v[2:3], 0
    v_mov_b64 v[4:5], 0
    v_mov_b64 v[6:7], 0
    s_branch cs_loop
cs_f2_xt:
    s_sub_u32 s37, s37, 1
    s_nop 2
    v_mov_b32 v79, v79
    s_nop 2
    v_mov_b32 v79, v79
    s_nop 2
    v_mov_b32 v79, v79
    s_nop 2
    v_mov_b32 v79, v79
    s_nop 2
    v_mov_b32 v79, v79
    s_nop 2
    v_mov_b32 v79, v79
    s_branch cs_f2_xtx
cs_f2_retry:
    s_sub_u32 s41, s30, s98
    s_mov_b32 s98, s30
    s_cmp_le_u32 s41, 3
    s_cselect_b32 s37, 1, 1
cs_f2_spin:
    buffer_load_dwordx4 v[8:11], v65, s[4:7], s18 offen sc1
    buffer_load_dwordx4 v[12:15], v65, s[4:7], s19 offen sc1
    buffer_load_dwordx4 v[16:19], v65, s[4:7], s20 offen sc1
    buffer_load_dwordx4 v[20:23], v65, s[4:7], s21 offen sc1
    s_nop 2
    v_mov_b32 v79, v79
    s_nop 2
    v_mov_b32 v79, v79
    s_nop 2
    v_mov_b32 v79, v79
    buffer_load_dwordx4 v[40:43], v65, s[4:7], s14 offen offset:0 sc1
    buffer_load_dwordx4 v[60:63], v66, s[4:7], s14 offen offset:0 sc1
    s_waitcnt vmcnt(5)
    v_bitop3_b32 v77, v8, v10, s69 bitop3:0x7e
    v_mfma_f32_16x16x32_bf16 v[0:3], v[4:7], v[8:11], 0
    v_mov_b64 v[8:9], 0
    v_mov_b64 v[10:11], 0
    s_waitcnt vmcnt(4)
    v_bitop3_b32 v78, v12, v14, s69 bitop3:0x7e
    v_mfma_f32_16x16x32_bf16 v[0:3], v[4:7], v[12:15], v[0:3]
    v_or_b32 v77, v77, v78
    v_mov_b64 v[12:13], 0
    v_mov_b64 v[14:15], 0
    s_waitcnt vmcnt(3)
    v_bitop3_b32 v78, v16, v18, s69 bitop3:0x7e
    v_mfma_f32_16x16x32_bf16 v[0:3], v[4:7], v[16:19], v[0:3]
    v_or_b32 v77, v77, v78
    v_mov_b64 v[16:17], 0
    v_mov_b64 v[18:19], 0
    s_waitcnt vmcnt(2)
    v_bitop3_b32 v78, v20, v22, s69 bitop3:0x7e
    v_mfma_f32_16x16x32_bf16 v[0:3], v[4:7], v[20:23], v[0:3]
    v_bitop3_b32 v77, v77, v78, 1 bitop3:0xa8
    v_cmp_ne_u32 vcc, 0, v77
    v_mov_b64 v[20:21], 0
    v_mov_b64 v[22:23], 0
    buffer_load_dwordx4 v[40:43], v65, s[4:7], s14 offen offset:0 sc1
    buffer_load_dwordx4 v[60:63], v66, s[4:7], s14 offen offset:0 sc1
    s_cmp_eq_u64 vcc, 0
    s_cselect_b64 s[42:43], -1, 0
    v_add_f32_dpp v0, v0, v0 row_ror:4 row_mask:0xf bank_mask:0xf
    v_add_f32_dpp v1, v1, v1 row_ror:4 row_mask:0xf bank_mask:0xf
    s_nop 0
    v_add_f32_dpp v0, v0, v0 row_ror:8 row_mask:0xf bank_mask:0xf
    v_add_f32_dpp v1, v1, v1 row_ror:8 row_mask:0xf bank_mask:0xf
    s_mov_b64 exec, s[42:43]
    v_cvt_pk_bf16_f32 v72, v0, v1
    v_bfi_b32 v72, v79, s70, v72
    buffer_store_dword v72, v75, s[4:7], s17 offen offset:0 sc1
    buffer_store_dword v72, v75, s[4:7], s17 offen offset:1024 sc1
    buffer_store_dword v72, v75, s[4:7], s17 offen offset:2048 sc1
    buffer_store_dword v72, v75, s[4:7], s17 offen offset:3072 sc1
    s_mov_b64 exec, -1
    s_cbranch_scc1 cs_f2_rx
    s_sub_u32 s31, s31, 1
    s_cbranch_scc0 cs_f2_spin
cs_f2_rx:
    v_mov_b64 v[0:1], 0
    v_mov_b64 v[2:3], 0
    v_mov_b64 v[4:5], 0
    v_mov_b64 v[6:7], 0
    s_branch cs_loop
cs_spinB:
    s_waitcnt vmcnt(3)
cs_spinB_l:
    v_bitop3_b32 v77, v44, v45, s70 bitop3:0x7e
    v_bitop3_b32 v77, v77, v46, s70 bitop3:0xf6
    v_bitop3_b32 v77, v77, v47, s70 bitop3:0xf6
    v_and_b32 v77, s36, v77
    v_cmp_ne_u32 vcc, 0, v77
    s_cbranch_vccz cs_spinB_x
    buffer_load_dwordx4 v[44:47], v65, s[4:7], s15 offen sc1
    s_sub_u32 s31, s31, 16
    s_waitcnt vmcnt(0)
    s_cbranch_scc0 cs_spinB_l
cs_spinB_x:
    ds_write_b128 v65, v[44:47] offset:4096
    s_waitcnt lgkmcnt(0)
    s_branch cs_backB
cs_spin8:
    buffer_load_dwordx4 v[40:43], v65, s[4:7], s16 offen sc1
cs_spin8_l:
    s_waitcnt vmcnt(0)
    v_bitop3_b32 v77, v40, v41, s70 bitop3:0x7e
    v_bitop3_b32 v77, v77, v42, s70 bitop3:0xf6
    v_bitop3_b32 v77, v77, v43, s70 bitop3:0xf6
    v_and_b32 v77, s36, v77
    v_cmp_ne_u32 vcc, 0, v77
    s_cbranch_vccz cs_spin8_x
    s_nop 15
    s_nop 15
    s_nop 15
    s_nop 11
    buffer_load_dwordx4 v[40:43], v65, s[4:7], s16 offen sc1
    s_sub_u32 s31, s31, 16
    s_cbranch_scc0 cs_spin8_l
cs_spin8_x:
    s_branch cs_back8
cs_rare:
    s_mov_b64 exec, s[34:35]
    buffer_store_dwordx4 v[0:3], v65, s[4:7], s28 offen sc1
    s_mov_b64 exec, -1
    s_nop 3
    v_cvt_pk_bf16_f32 v52, v16, v17
    v_cvt_pk_bf16_f32 v53, v18, v19
    v_cvt_pk_bf16_f32 v54, v20, v21
    v_cvt_pk_bf16_f32 v55, v22, v23
    buffer_store_dwordx4 v[52:55], v65, s[4:7], s27 offen sc1
    s_add_u32 s28, s28, 131072
    s_add_u32 s27, s27, 131072
    s_cmp_eq_u32 s30, 63
    s_cbranch_scc1 cs_last
    s_branch cs_rare_x
cs_kvwait:
    s_mov_b32 s41, s97
    v_bfe_u32 v78, v65, 4, 3
    v_lshlrev_b32 v78, 7, v78
    v_mov_b32 v77, v76
    s_nop 1
    v_permlane32_swap_b32 v76, v77
    v_subrev_u32 v77, s95, v77
    v_cmp_lt_u32 vcc, 16, v77
    s_nop 1
    v_cndmask_b32 v77, v77, 0, vcc
    v_bfe_u32 v79, v78, 7, 2
    v_lshl_add_u32 v77, v77, 2, v79
    s_nop 1
    v_min_u32_dpp v77, v77, v77 row_ror:1 row_mask:0xf bank_mask:0xf
    s_nop 1
    v_min_u32_dpp v77, v77, v77 row_ror:2 row_mask:0xf bank_mask:0xf
    s_nop 1
    v_min_u32_dpp v77, v77, v77 row_ror:4 row_mask:0xf bank_mask:0xf
    s_nop 0
    v_readfirstlane_b32 s97, v77
    s_nop 0
    s_max_u32 s97, s97, s41
    s_add_u32 s40, s30, 3
    s_min_u32 s40, s40, 64
    s_cmp_le_u32 s40, s97
    s_cbranch_scc1 cs_kvw_x
    v_bfe_u32 v78, v65, 4, 3
    v_lshlrev_b32 v78, 7, v78
    s_mov_b32 s31, 4194304
cs_kvw:
    buffer_load_dword v77, v78, s[4:7], s96 offen sc1
    s_waitcnt vmcnt(0)
    v_subrev_u32 v77, s95, v77
    v_cmp_lt_u32 vcc, 16, v77
    s_nop 1
    v_cndmask_b32 v77, v77, 0, vcc
    v_bfe_u32 v79, v78, 7, 2
    v_lshl_add_u32 v77, v77, 2, v79
    s_nop 1
    v_min_u32_dpp v77, v77, v77 row_ror:1 row_mask:0xf bank_mask:0xf
    s_nop 1
    v_min_u32_dpp v77, v77, v77 row_ror:2 row_mask:0xf bank_mask:0xf
    s_nop 1
    v_min_u32_dpp v77, v77, v77 row_ror:4 row_mask:0xf bank_mask:0xf
    s_nop 0
    v_readfirstlane_b32 s97, v77
    s_sub_u32 s31, s31, 1
    s_cbranch_scc1 cs_kvw_x
    s_cmp_le_u32 s40, s97
    s_cbranch_scc1 cs_kvw_x
    s_sleep 2
    s_branch cs_kvw
cs_kvw_x:
    s_branch cs_kvok
cs_last:
    s_add_u32 s40, s95, 64
    v_mov_b32 v78, s40
    s_waitcnt vmcnt(0)
    s_barrier
    s_mov_b64 exec, s[100:101]
    buffer_store_dword v78, off, s[4:7], s29 sc1
    s_mov_b64 exec, -1
cs_end:
    s_endpgm
L_xform:
    v_and_b32 v1, 63, v0
    v_and_b32 v2, 15, v1
    v_lshrrev_b32 v3, 4, v1
    v_mov_b32 v7, 0x05040100
    v_mov_b32 v8, 0x07060302
    v_lshrrev_b32 v9, 6, v0
    v_lshlrev_b32 v9, 14, v9
    v_lshlrev_b32 v10, 4, v1
    v_add_u32 v11, v9, v10
    s_mov_b32 s10, 4718592
    s_mov_b32 s11, 0x20000
    s_mov_b64 s[8:9], s[58:59]
xf_f:
    s_sub_u32 s17, s16, 1504
    s_and_b32 s18, s17, 127
    s_lshr_b32 s17, s17, 7
    s_lshl_b32 s19, s17, 4
    v_add_u32 v6, s19, v2
    v_mul_u32_u24 v4, 9216, v3
    v_lshl_add_u32 v4, v6, 4, v4
    v_lshrrev_b32 v5, 2, v2
    v_lshlrev_b32 v5, 11, v5
    v_lshl_add_u32 v5, v3, 8, v5
    v_and_b32 v1, 3, v6
    v_lshl_add_u32 v5, v1, 6, v5
    v_add_u32 v5, v5, v9
    v_cmp_gt_u32 vcc, 72, v6
    s_nop 0
    s_mov_b64 exec, vcc
    s_mul_i32 s20, s18, 36864
    s_add_u32 s21, s20, 0
    buffer_load_dwordx4 v[12:15], v4, s[8:11], s21 offen
    s_add_u32 s21, s20, 1152
    buffer_load_dwordx4 v[16:19], v4, s[8:11], s21 offen
    s_add_u32 s21, s20, 2304
    buffer_load_dwordx4 v[20:23], v4, s[8:11], s21 offen
    s_add_u32 s21, s20, 3456
    buffer_load_dwordx4 v[24:27], v4, s[8:11], s21 offen
    s_add_u32 s21, s20, 4608
    buffer_load_dwordx4 v[28:31], v4, s[8:11], s21 offen
    s_add_u32 s21, s20, 5760
    buffer_load_dwordx4 v[32:35], v4, s[8:11], s21 offen
    s_add_u32 s21, s20, 6912
    buffer_load_dwordx4 v[36:39], v4, s[8:11], s21 offen
    s_add_u32 s21, s20, 8064
    buffer_load_dwordx4 v[40:43], v4, s[8:11], s21 offen
    s_lshl_b32 s20, s18, 11
    s_add_u32 s20, s20, 130023424
    s_waitcnt vmcnt(0)
    v_perm_b32 v76, v16, v12, v7
    v_perm_b32 v77, v24, v20, v7
    v_perm_b32 v78, v32, v28, v7
    v_perm_b32 v79, v40, v36, v7
    ds_write_b128 v5, v[76:79] offset:0
    v_perm_b32 v80, v17, v13, v7
    v_perm_b32 v81, v25, v21, v7
    v_perm_b32 v82, v33, v29, v7
    v_perm_b32 v83, v41, v37, v7
    ds_write_b128 v5, v[80:83] offset:16
    v_perm_b32 v84, v18, v14, v7
    v_perm_b32 v85, v26, v22, v7
    v_perm_b32 v86, v34, v30, v7
    v_perm_b32 v87, v42, v38, v7
    ds_write_b128 v5, v[84:87] offset:32
    v_perm_b32 v88, v19, v15, v7
    v_perm_b32 v89, v27, v23, v7
    v_perm_b32 v90, v35, v31, v7
    v_perm_b32 v91, v43, v39, v7
    ds_write_b128 v5, v[88:91] offset:48
    v_perm_b32 v92, v16, v12, v8
    v_perm_b32 v93, v24, v20, v8
    v_perm_b32 v94, v32, v28, v8
    v_perm_b32 v95, v40, v36, v8
    ds_write_b128 v5, v[92:95] offset:1024
    v_perm_b32 v96, v17, v13, v8
    v_perm_b32 v97, v25, v21, v8
    v_perm_b32 v98, v33, v29, v8
    v_perm_b32 v99, v41, v37, v8
    ds_write_b128 v5, v[96:99] offset:1040
    v_perm_b32 v100, v18, v14, v8
    v_perm_b32 v101, v26, v22, v8
    v_perm_b32 v102, v34, v30, v8
    v_perm_b32 v103, v42, v38, v8
    ds_write_b128 v5, v[100:103] offset:1056
    v_perm_b32 v104, v19, v15, v8
    v_perm_b32 v105, v27, v23, v8
    v_perm_b32 v106, v35, v31, v8
    v_perm_b32 v107, v43, v39, v8
    ds_write_b128 v5, v[104:107] offset:1072
    s_mov_b64 exec, -1
    s_lshl_b32 s21, s17, 20
    s_add_u32 s20, s20, s21
    s_waitcnt lgkmcnt(0)
    ds_read_b128 v[76:79], v11 offset:0
    ds_read_b128 v[80:83], v11 offset:1024
    ds_read_b128 v[84:87], v11 offset:2048
    ds_read_b128 v[88:91], v11 offset:3072
    ds_read_b128 v[92:95], v11 offset:4096
    ds_read_b128 v[96:99], v11 offset:5120
    ds_read_b128 v[100:103], v11 offset:6144
    ds_read_b128 v[104:107], v11 offset:7168
    s_add_u32 s19, s20, 0
    s_waitcnt lgkmcnt(7)
    buffer_store_dwordx4 v[76:79], v10, s[4:7], s19 offen sc1
    s_add_u32 s19, s20, 1024
    s_waitcnt lgkmcnt(6)
    buffer_store_dwordx4 v[80:83], v10, s[4:7], s19 offen sc1
    s_add_u32 s19, s20, 262144
    s_waitcnt lgkmcnt(5)
    buffer_store_dwordx4 v[84:87], v10, s[4:7], s19 offen sc1
    s_add_u32 s19, s20, 263168
    s_waitcnt lgkmcnt(4)
    buffer_store_dwordx4 v[88:91], v10, s[4:7], s19 offen sc1
    s_add_u32 s19, s20, 524288
    s_waitcnt lgkmcnt(3)
    buffer_store_dwordx4 v[92:95], v10, s[4:7], s19 offen sc1
    s_add_u32 s19, s20, 525312
    s_waitcnt lgkmcnt(2)
    buffer_store_dwordx4 v[96:99], v10, s[4:7], s19 offen sc1
    s_add_u32 s19, s20, 786432
    s_waitcnt lgkmcnt(1)
    buffer_store_dwordx4 v[100:103], v10, s[4:7], s19 offen sc1
    s_add_u32 s19, s20, 787456
    s_waitcnt lgkmcnt(0)
    buffer_store_dwordx4 v[104:107], v10, s[4:7], s19 offen sc1
xf_done:
    s_nop 1
    s_setpc_b64 s[46:47]
L_helper:
    s_load_dwordx16 s[64:79], s[0:1], 64
    s_waitcnt lgkmcnt(0)
    s_mov_b32 s93, 1000
    s_mov_b32 s95, 0
    s_cmp_lg_u32 s3, 2
    s_cbranch_scc1 L_qkv_next
    s_mov_b32 s37, 24
    v_mov_b32 v250, 1
    v_mov_b32 v251, 163832
    v_cmp_eq_u32 vcc, 0, v0
    s_nop 0
    s_and_saveexec_b64 s[38:39], vcc
    s_cbranch_execz tk3
    buffer_atomic_add v250, off, s[84:87], s37 sc0
    s_waitcnt vmcnt(0)
    ds_write_b32 v251, v250
    s_waitcnt lgkmcnt(0)
tk3:
    s_mov_b64 exec, -1
    s_barrier
    ds_read_b32 v252, v251
    s_waitcnt lgkmcnt(0)
    v_readfirstlane_b32 s36, v252
    s_barrier
    s_nop 3
    s_cmp_ge_u32 s36, 32
    s_cbranch_scc1 L_qkv_next
    s_mov_b32 s93, 0
    s_cmp_eq_u32 s36, 0
    s_cbranch_scc1 L_relay
    s_branch L_wf_next
L_qkv_next:
    s_sub_u32 s46, s3, 2
    s_cmp_lt_u32 s3, 2
    s_cselect_b32 s46, s3, s46
    s_cmp_lt_u32 s46, 6
    s_cselect_b32 s46, s46, 0
    s_mov_b32 s47, 6
L_qq:
    s_lshl_b32 s40, s46, 2
    s_add_u32 s40, s40, 32
    s_mov_b32 s37, s40
    v_mov_b32 v250, 1
    v_mov_b32 v251, 163832
    v_cmp_eq_u32 vcc, 0, v0
    s_nop 0
    s_and_saveexec_b64 s[38:39], vcc
    s_cbranch_execz tk4
    buffer_atomic_add v250, off, s[84:87], s37 sc0
    s_waitcnt vmcnt(0)
    ds_write_b32 v251, v250
    s_waitcnt lgkmcnt(0)
tk4:
    s_mov_b64 exec, -1
    s_barrier
    ds_read_b32 v252, v251
    s_waitcnt lgkmcnt(0)
    v_readfirstlane_b32 s36, v252
    s_barrier
    s_nop 3
    s_or_b32 s37, s36, s32
    s_cbranch_scc1 L_non
    s_memrealtime s[90:91]
    s_waitcnt lgkmcnt(0)
    s_lshl_b32 s90, s90, 8
    s_or_b32 s90, s90, 1
    v_mov_b32 v250, s90
    v_mov_b32 v251, 0
    s_mov_b64 exec, 1
    buffer_atomic_cmpswap v[250:251], off, s[84:87], 0 offset:216
    s_mov_b64 exec, -1
L_non:
    s_cmp_lt_u32 s36, 32
    s_cbranch_scc1 L_qkv
    s_add_u32 s46, s46, 1
    s_cmp_lt_u32 s46, 6
    s_cselect_b32 s46, s46, 0
    s_sub_u32 s47, s47, 1
    s_cmp_lg_u32 s47, 0
    s_cbranch_scc1 L_qq
    s_mov_b32 s37, 4
    v_mov_b32 v250, 1
    v_mov_b32 v251, 163832
    v_cmp_eq_u32 vcc, 0, v0
    s_nop 0
    s_and_saveexec_b64 s[38:39], vcc
    s_cbranch_execz tk5
    buffer_atomic_add v250, off, s[84:87], s37 sc0
    s_waitcnt vmcnt(0)
    ds_write_b32 v251, v250
    s_waitcnt lgkmcnt(0)
tk5:
    s_mov_b64 exec, -1
    s_barrier
    ds_read_b32 v252, v251
    s_waitcnt lgkmcnt(0)
    v_readfirstlane_b32 s45, v252
    s_barrier
    s_nop 3
    s_cmp_lg_u32 s95, 0
    s_cbranch_scc1 L_hn
    s_mov_b32 s88, 4194304
gn6:
    buffer_load_dword v250, off, s[84:87], 0 offset:216 sc1
    s_waitcnt vmcnt(0)
    v_readfirstlane_b32 s95, v250
    s_sub_u32 s88, s88, 1
    s_cbranch_scc1 gn6x
    s_cmp_eq_u32 s95, 0
    s_cbranch_scc1 gn6
gn6x:
L_hn:
    s_cmp_lg_u32 s45, 0
    s_cbranch_scc1 L_phase2
    s_mov_b32 s37, 24
    v_mov_b32 v250, 1
    v_mov_b32 v251, 163832
    v_cmp_eq_u32 vcc, 0, v0
    s_nop 0
    s_and_saveexec_b64 s[38:39], vcc
    s_cbranch_execz tk7
    buffer_atomic_add v250, off, s[84:87], s37 sc0
    s_waitcnt vmcnt(0)
    ds_write_b32 v251, v250
    s_waitcnt lgkmcnt(0)
tk7:
    s_mov_b64 exec, -1
    s_barrier
    ds_read_b32 v252, v251
    s_waitcnt lgkmcnt(0)
    v_readfirstlane_b32 s36, v252
    s_barrier
    s_nop 3
    s_cmp_lg_u32 s36, 0
    s_cbranch_scc1 L_phase2
L_relay:
    s_cmp_lg_u32 s32, 0
    s_cbranch_scc1 L_exit
    s_sleep 100
    s_mov_b32 s88, 4194304
gn8:
    buffer_load_dword v250, off, s[84:87], 0 offset:216 sc1
    s_waitcnt vmcnt(0)
    v_readfirstlane_b32 s95, v250
    s_sub_u32 s88, s88, 1
    s_cbranch_scc1 gn8x
    s_cmp_eq_u32 s95, 0
    s_cbranch_scc1 gn8
gn8x:
    v_and_b32 v3, 31, v0
    v_lshlrev_b32 v3, 7, v3
    s_mov_b32 s17, 0
    s_mov_b32 s23, 125845504
    s_mov_b32 s24, 125853696
    s_mov_b32 s21, 16777216
rl_rwait:
    buffer_load_dword v4, v3, s[4:7], s23 offen sc1
    s_waitcnt vmcnt(0)
    v_subrev_u32 v4, s95, v4
    v_cmp_lt_u32 vcc, 64, v4
    s_nop 1
    v_cndmask_b32 v4, v4, 0, vcc
    s_nop 1
    v_min_u32_dpp v4, v4, v4 row_ror:1 row_mask:0xf bank_mask:0xf
    s_nop 1
    v_min_u32_dpp v4, v4, v4 row_ror:2 row_mask:0xf bank_mask:0xf
    s_nop 1
    v_min_u32_dpp v4, v4, v4 row_ror:4 row_mask:0xf bank_mask:0xf
    s_nop 1
    v_min_u32_dpp v4, v4, v4 row_ror:8 row_mask:0xf bank_mask:0xf
    s_nop 0
    v_readlane_b32 s16, v4, 0
    v_readlane_b32 s22, v4, 16
    s_nop 0
    s_min_u32 s16, s16, s22
    s_sub_u32 s21, s21, 1
    s_cbranch_scc1 rl_x
    s_cmp_gt_u32 s16, s17
    s_cbranch_scc1 rl_rpub
    s_sleep 2
    s_branch rl_rwait
rl_rpub:
    s_mov_b32 s17, s16
    s_add_u32 s22, s16, s95
    v_mov_b32 v4, s22
    s_mov_b64 exec, 1
    buffer_store_dword v4, off, s[4:7], s24 sc1
    s_mov_b64 exec, -1
    s_cmp_lt_u32 s16, 64
    s_cbranch_scc1 rl_rwait
rl_x:
    s_endpgm
L_qkv:
    s_and_b32 s37, s36, 3
    s_lshr_b32 s36, s36, 2
    s_lshl_b32 s40, s46, 3
    s_add_u32 s36, s36, s40
    s_lshr_b32 s40, s36, 4
    s_and_b32 s36, s36, 15
    s_lshl_b32 s41, s37, 1
    s_add_u32 s41, s41, s40
    s_add_u32 s37, s37, 8
    s_cmp_eq_u32 s40, 2
    s_cselect_b32 s41, s37, s41
    s_lshl_b32 s41, s41, 4
    s_add_u32 s36, s36, s41
    s_sub_u32 s33, s36, 32
    s_and_b32 s17, s36, 15
    s_lshl_b32 s17, s17, 1
    s_lshr_b32 s36, s36, 4
    s_and_b32 s16, s36, 1
    s_add_u32 s16, s16, 1
    s_lshr_b32 s19, s36, 1
    s_and_b32 s37, s36, 3
    s_cmp_ge_u32 s36, 8
    s_cselect_b32 s16, 0, s16
    s_cselect_b32 s19, s37, s19
    v_lshrrev_b32 v4, 6, v0
    s_nop 0
    v_readfirstlane_b32 s18, v4
    v_lshlrev_b32 v7, 4, v0
    s_cmp_eq_u32 s16, 1
    s_cselect_b64 s[12:13], s[54:55], s[52:53]
    s_cmp_eq_u32 s16, 2
    s_cselect_b64 s[12:13], s[56:57], s[12:13]
    s_mov_b32 s14, 4718592
    s_mov_b32 s15, 0x20000
    v_bfe_u32 v4, v0, 5, 1
    v_lshlrev_b32 v5, 2, v4
    v_and_b32 v8, 31, v0
    v_xor_b32 v8, v8, v5
    v_lshlrev_b32 v8, 4, v8
    v_lshl_add_u32 v8, v4, 13, v8
    v_xor_b32 v9, 128, v8
    s_lshl_b32 s21, s17, 8
    s_lshl_b32 s42, s18, 16
    s_add_u32 s42, s42, s21
    s_lshl_b32 s44, s18, 12
    s_barrier
    s_add_u32 m0, s44, 73728
    s_add_u32 s22, s42, 0
    buffer_load_dwordx4 v8, s[12:15], s22 offen offset:0 lds
    s_add_u32 s22, s42, 15360
    buffer_load_dwordx4 v9, s[12:15], s22 offen offset:1024 lds
    s_add_u32 s22, s42, 30720
    buffer_load_dwordx4 v8, s[12:15], s22 offen offset:2048 lds
    s_add_u32 s22, s42, 46080
    buffer_load_dwordx4 v9, s[12:15], s22 offen offset:3072 lds
    s_add_u32 m0, s44, 90112
    s_add_u32 s22, s42, 1048576
    buffer_load_dwordx4 v8, s[12:15], s22 offen offset:0 lds
    s_add_u32 s22, s42, 1063936
    buffer_load_dwordx4 v9, s[12:15], s22 offen offset:1024 lds
    s_add_u32 s22, s42, 1079296
    buffer_load_dwordx4 v8, s[12:15], s22 offen offset:2048 lds
    s_add_u32 s22, s42, 1094656
    buffer_load_dwordx4 v9, s[12:15], s22 offen offset:3072 lds
    s_add_u32 m0, s44, 106496
    s_add_u32 s22, s42, 2097152
    buffer_load_dwordx4 v8, s[12:15], s22 offen offset:0 lds
    s_add_u32 s22, s42, 2112512
    buffer_load_dwordx4 v9, s[12:15], s22 offen offset:1024 lds
    s_add_u32 s22, s42, 2127872
    buffer_load_dwordx4 v8, s[12:15], s22 offen offset:2048 lds
    s_add_u32 s22, s42, 2143232
    buffer_load_dwordx4 v9, s[12:15], s22 offen offset:3072 lds
    s_add_u32 m0, s44, 122880
    s_add_u32 s22, s42, 3145728
    buffer_load_dwordx4 v8, s[12:15], s22 offen offset:0 lds
    s_add_u32 s22, s42, 3161088
    buffer_load_dwordx4 v9, s[12:15], s22 offen offset:1024 lds
    s_add_u32 s22, s42, 3176448
    buffer_load_dwordx4 v8, s[12:15], s22 offen offset:2048 lds
    s_add_u32 s22, s42, 3191808
    buffer_load_dwordx4 v9, s[12:15], s22 offen offset:3072 lds
    v_bfe_u32 v4, v0, 2, 2
    v_xor_b32 v5, s18, v4
    v_lshlrev_b32 v10, 6, v5
    v_lshl_add_u32 v10, v4, 9, v10
    v_and_b32 v4, 3, v0
    v_lshl_add_u32 v10, v4, 4, v10
    v_bfe_u32 v4, v0, 4, 2
    v_lshl_add_u32 v10, v4, 12, v10
    v_add_u32 v10, 73728, v10
    v_add_u32 v11, 49152, v10
    v_and_b32 v4, 63, v0
    v_and_b32 v5, 15, v4
    v_lshrrev_b32 v3, 4, v4
    v_lshrrev_b32 v2, 2, v5
    v_xor_b32 v3, v3, v2
    v_lshl_add_u32 v3, v5, 2, v3
    v_lshlrev_b32 v1, 4, v3
    v_lshrrev_b32 v5, 2, v4
    v_lshrrev_b32 v3, 4, v4
    v_and_b32 v4, 3, v4
    v_xor_b32 v4, v4, v3
    v_lshlrev_b32 v3, 3, v3
    v_and_b32 v5, 3, v5
    v_add_u32 v3, v3, v5
    v_mul_u32_u24 v2, 1152, v3
    v_lshl_add_u32 v2, v4, 4, v2
    s_mov_b32 s8, s48
    s_mov_b32 s9, s49
    s_mov_b32 s10, 2359296
    s_mov_b32 s11, 0x20000
    s_lshr_b32 s22, s18, 1
    s_mul_i32 s24, s22, 4608
    s_mul_i32 s25, s22, 18432
    s_and_b32 s22, s18, 1
    s_mul_i32 s23, s22, 576
    s_add_u32 s24, s24, s23
    s_mul_i32 s25, s18, 9216
    s_mul_i32 s22, s19, 36864
    s_add_u32 s24, s24, s22
    s_mov_b32 s20, 64
    s_lshl_b32 s22, s19, 5
    s_add_u32 s22, s22, s17
    s_mul_i32 s26, s19, 524288
    s_mul_i32 s23, s17, 16384
    s_add_u32 s26, s26, s23
    s_mul_i32 s23, s18, 3072
    s_add_u32 s26, s26, s23
    s_lshl_b32 s23, s16, 11
    s_add_u32 s26, s26, s23
    s_add_u32 s26, s26, -2048
    s_lshl_b32 s22, s22, 13
    s_add_u32 s22, s22, 33554432
    s_cmp_eq_u32 s16, 0
    s_cselect_b32 s26, s22, s26
    s_cselect_b32 s40, 4096, 64
    s_mov_b32 s41, 524288
    s_mov_b32 s30, 16384
    s_cselect_b32 s41, 262144, s41
    s_cselect_b32 s30, 8192, s30
    s_max_u32 s40, s40, 1024
    s_lshl_b32 s29, s17, 10
    s_lshl_b32 s22, s16, 9
    s_add_u32 s29, s29, s22
    s_lshl_b32 s22, s19, 7
    s_add_u32 s29, s29, s22
    s_add_u32 s29, s29, 126091264
    s_mov_b32 s27, 0
    s_add_u32 s23, s27, s25
    s_add_u32 m0, s23, 0
    s_nop 0
    buffer_load_dwordx4 v2, s[8:11], s24 offen offset:0 lds
    s_add_u32 m0, s23, 960
    s_nop 0
    buffer_load_dwordx4 v2, s[8:11], s24 offen offset:64 lds
    s_add_u32 m0, s23, 1920
    s_nop 0
    buffer_load_dwordx4 v2, s[8:11], s24 offen offset:128 lds
    s_add_u32 m0, s23, 2880
    s_nop 0
    buffer_load_dwordx4 v2, s[8:11], s24 offen offset:192 lds
    s_add_u32 m0, s23, 3840
    s_nop 0
    buffer_load_dwordx4 v2, s[8:11], s24 offen offset:256 lds
    s_add_u32 m0, s23, 4800
    s_nop 0
    buffer_load_dwordx4 v2, s[8:11], s24 offen offset:320 lds
    s_add_u32 m0, s23, 5760
    s_nop 0
    buffer_load_dwordx4 v2, s[8:11], s24 offen offset:384 lds
    s_add_u32 m0, s23, 6720
    s_nop 0
    buffer_load_dwordx4 v2, s[8:11], s24 offen offset:448 lds
    s_add_u32 m0, s23, 7680
    s_nop 0
    buffer_load_dwordx4 v2, s[8:11], s24 offen offset:512 lds
    s_add_u32 s24, s24, 147456
    s_waitcnt vmcnt(21) lgkmcnt(0)
    s_barrier
    s_add_u32 m0, s44, 139264
    s_add_u32 s22, s42, 262144
    buffer_load_dwordx4 v8, s[12:15], s22 offen offset:0 lds
    s_add_u32 s22, s42, 277504
    buffer_load_dwordx4 v9, s[12:15], s22 offen offset:1024 lds
    s_add_u32 s22, s42, 292864
    buffer_load_dwordx4 v8, s[12:15], s22 offen offset:2048 lds
    s_add_u32 s22, s42, 308224
    buffer_load_dwordx4 v9, s[12:15], s22 offen offset:3072 lds
    ds_read_b64_tr_b16 v[64:65], v10 offset:0
    ds_read_b64_tr_b16 v[66:67], v10 offset:2048
    ds_read_b64_tr_b16 v[136:137], v10 offset:8
    ds_read_b64_tr_b16 v[138:139], v10 offset:2056
    ds_read_b64_tr_b16 a[0:1], v10 offset:256
    ds_read_b64_tr_b16 a[2:3], v10 offset:2304
    ds_read_b64_tr_b16 a[72:73], v10 offset:264
    ds_read_b64_tr_b16 a[74:75], v10 offset:2312
    s_waitcnt vmcnt(21) lgkmcnt(0)
    s_barrier
    s_add_u32 m0, s44, 73728
    s_add_u32 s22, s42, 1310720
    buffer_load_dwordx4 v8, s[12:15], s22 offen offset:0 lds
    s_add_u32 s22, s42, 1326080
    buffer_load_dwordx4 v9, s[12:15], s22 offen offset:1024 lds
    s_add_u32 s22, s42, 1341440
    buffer_load_dwordx4 v8, s[12:15], s22 offen offset:2048 lds
    s_add_u32 s22, s42, 1356800
    buffer_load_dwordx4 v9, s[12:15], s22 offen offset:3072 lds
    ds_read_b64_tr_b16 v[80:81], v10 offset:16384
    ds_read_b64_tr_b16 v[82:83], v10 offset:18432
    ds_read_b64_tr_b16 v[152:153], v10 offset:16392
    ds_read_b64_tr_b16 v[154:155], v10 offset:18440
    ds_read_b64_tr_b16 a[16:17], v10 offset:16640
    ds_read_b64_tr_b16 a[18:19], v10 offset:18688
    ds_read_b64_tr_b16 a[88:89], v10 offset:16648
    ds_read_b64_tr_b16 a[90:91], v10 offset:18696
    s_waitcnt vmcnt(21) lgkmcnt(0)
    s_barrier
    s_add_u32 m0, s44, 90112
    s_add_u32 s22, s42, 2359296
    buffer_load_dwordx4 v8, s[12:15], s22 offen offset:0 lds
    s_add_u32 s22, s42, 2374656
    buffer_load_dwordx4 v9, s[12:15], s22 offen offset:1024 lds
    s_add_u32 s22, s42, 2390016
    buffer_load_dwordx4 v8, s[12:15], s22 offen offset:2048 lds
    s_add_u32 s22, s42, 2405376
    buffer_load_dwordx4 v9, s[12:15], s22 offen offset:3072 lds
    ds_read_b64_tr_b16 v[96:97], v10 offset:32768
    ds_read_b64_tr_b16 v[98:99], v10 offset:34816
    ds_read_b64_tr_b16 v[168:169], v10 offset:32776
    ds_read_b64_tr_b16 v[170:171], v10 offset:34824
    ds_read_b64_tr_b16 a[32:33], v10 offset:33024
    ds_read_b64_tr_b16 a[34:35], v10 offset:35072
    ds_read_b64_tr_b16 a[104:105], v10 offset:33032
    ds_read_b64_tr_b16 a[106:107], v10 offset:35080
    s_waitcnt vmcnt(21) lgkmcnt(0)
    s_barrier
    s_add_u32 m0, s44, 106496
    s_add_u32 s22, s42, 3407872
    buffer_load_dwordx4 v8, s[12:15], s22 offen offset:0 lds
    s_add_u32 s22, s42, 3423232
    buffer_load_dwordx4 v9, s[12:15], s22 offen offset:1024 lds
    s_add_u32 s22, s42, 3438592
    buffer_load_dwordx4 v8, s[12:15], s22 offen offset:2048 lds
    s_add_u32 s22, s42, 3453952
    buffer_load_dwordx4 v9, s[12:15], s22 offen offset:3072 lds
    ds_read_b64_tr_b16 v[112:113], v11 offset:0
    ds_read_b64_tr_b16 v[114:115], v11 offset:2048
    ds_read_b64_tr_b16 v[184:185], v11 offset:8
    ds_read_b64_tr_b16 v[186:187], v11 offset:2056
    ds_read_b64_tr_b16 a[48:49], v11 offset:256
    ds_read_b64_tr_b16 a[50:51], v11 offset:2304
    ds_read_b64_tr_b16 a[120:121], v11 offset:264
    ds_read_b64_tr_b16 a[122:123], v11 offset:2312
    s_waitcnt vmcnt(12) lgkmcnt(0)
    s_barrier
    s_add_u32 m0, s44, 122880
    s_add_u32 s22, s42, 524288
    buffer_load_dwordx4 v8, s[12:15], s22 offen offset:0 lds
    s_add_u32 s22, s42, 539648
    buffer_load_dwordx4 v9, s[12:15], s22 offen offset:1024 lds
    s_add_u32 s22, s42, 555008
    buffer_load_dwordx4 v8, s[12:15], s22 offen offset:2048 lds
    s_add_u32 s22, s42, 570368
    buffer_load_dwordx4 v9, s[12:15], s22 offen offset:3072 lds
    ds_read_b64_tr_b16 v[68:69], v11 offset:16384
    ds_read_b64_tr_b16 v[70:71], v11 offset:18432
    ds_read_b64_tr_b16 v[140:141], v11 offset:16392
    ds_read_b64_tr_b16 v[142:143], v11 offset:18440
    ds_read_b64_tr_b16 a[4:5], v11 offset:16640
    ds_read_b64_tr_b16 a[6:7], v11 offset:18688
    ds_read_b64_tr_b16 a[76:77], v11 offset:16648
    ds_read_b64_tr_b16 a[78:79], v11 offset:18696
    s_waitcnt vmcnt(12) lgkmcnt(0)
    s_barrier
    s_add_u32 m0, s44, 139264
    s_add_u32 s22, s42, 1572864
    buffer_load_dwordx4 v8, s[12:15], s22 offen offset:0 lds
    s_add_u32 s22, s42, 1588224
    buffer_load_dwordx4 v9, s[12:15], s22 offen offset:1024 lds
    s_add_u32 s22, s42, 1603584
    buffer_load_dwordx4 v8, s[12:15], s22 offen offset:2048 lds
    s_add_u32 s22, s42, 1618944
    buffer_load_dwordx4 v9, s[12:15], s22 offen offset:3072 lds
    ds_read_b64_tr_b16 v[84:85], v10 offset:0
    ds_read_b64_tr_b16 v[86:87], v10 offset:2048
    ds_read_b64_tr_b16 v[156:157], v10 offset:8
    ds_read_b64_tr_b16 v[158:159], v10 offset:2056
    ds_read_b64_tr_b16 a[20:21], v10 offset:256
    ds_read_b64_tr_b16 a[22:23], v10 offset:2304
    ds_read_b64_tr_b16 a[92:93], v10 offset:264
    ds_read_b64_tr_b16 a[94:95], v10 offset:2312
    s_waitcnt vmcnt(12) lgkmcnt(0)
    s_barrier
    s_add_u32 m0, s44, 73728
    s_add_u32 s22, s42, 2621440
    buffer_load_dwordx4 v8, s[12:15], s22 offen offset:0 lds
    s_add_u32 s22, s42, 2636800
    buffer_load_dwordx4 v9, s[12:15], s22 offen offset:1024 lds
    s_add_u32 s22, s42, 2652160
    buffer_load_dwordx4 v8, s[12:15], s22 offen offset:2048 lds
    s_add_u32 s22, s42, 2667520
    buffer_load_dwordx4 v9, s[12:15], s22 offen offset:3072 lds
    ds_read_b64_tr_b16 v[100:101], v10 offset:16384
    ds_read_b64_tr_b16 v[102:103], v10 offset:18432
    ds_read_b64_tr_b16 v[172:173], v10 offset:16392
    ds_read_b64_tr_b16 v[174:175], v10 offset:18440
    ds_read_b64_tr_b16 a[36:37], v10 offset:16640
    ds_read_b64_tr_b16 a[38:39], v10 offset:18688
    ds_read_b64_tr_b16 a[108:109], v10 offset:16648
    ds_read_b64_tr_b16 a[110:111], v10 offset:18696
    s_waitcnt vmcnt(12) lgkmcnt(0)
    s_barrier
    s_add_u32 m0, s44, 90112
    s_add_u32 s22, s42, 3670016
    buffer_load_dwordx4 v8, s[12:15], s22 offen offset:0 lds
    s_add_u32 s22, s42, 3685376
    buffer_load_dwordx4 v9, s[12:15], s22 offen offset:1024 lds
    s_add_u32 s22, s42, 3700736
    buffer_load_dwordx4 v8, s[12:15], s22 offen offset:2048 lds
    s_add_u32 s22, s42, 3716096
    buffer_load_dwordx4 v9, s[12:15], s22 offen offset:3072 lds
    ds_read_b64_tr_b16 v[116:117], v10 offset:32768
    ds_read_b64_tr_b16 v[118:119], v10 offset:34816
    ds_read_b64_tr_b16 v[188:189], v10 offset:32776
    ds_read_b64_tr_b16 v[190:191], v10 offset:34824
    ds_read_b64_tr_b16 a[52:53], v10 offset:33024
    ds_read_b64_tr_b16 a[54:55], v10 offset:35072
    ds_read_b64_tr_b16 a[124:125], v10 offset:33032
    ds_read_b64_tr_b16 a[126:127], v10 offset:35080
    s_waitcnt vmcnt(12) lgkmcnt(0)
    s_barrier
    s_add_u32 m0, s44, 106496
    s_add_u32 s22, s42, 786432
    buffer_load_dwordx4 v8, s[12:15], s22 offen offset:0 lds
    s_add_u32 s22, s42, 801792
    buffer_load_dwordx4 v9, s[12:15], s22 offen offset:1024 lds
    s_add_u32 s22, s42, 817152
    buffer_load_dwordx4 v8, s[12:15], s22 offen offset:2048 lds
    s_add_u32 s22, s42, 832512
    buffer_load_dwordx4 v9, s[12:15], s22 offen offset:3072 lds
    ds_read_b64_tr_b16 v[72:73], v11 offset:0
    ds_read_b64_tr_b16 v[74:75], v11 offset:2048
    ds_read_b64_tr_b16 v[144:145], v11 offset:8
    ds_read_b64_tr_b16 v[146:147], v11 offset:2056
    ds_read_b64_tr_b16 a[8:9], v11 offset:256
    ds_read_b64_tr_b16 a[10:11], v11 offset:2304
    ds_read_b64_tr_b16 a[80:81], v11 offset:264
    ds_read_b64_tr_b16 a[82:83], v11 offset:2312
    s_waitcnt vmcnt(12) lgkmcnt(0)
    s_barrier
    s_add_u32 m0, s44, 122880
    s_add_u32 s22, s42, 1835008
    buffer_load_dwordx4 v8, s[12:15], s22 offen offset:0 lds
    s_add_u32 s22, s42, 1850368
    buffer_load_dwordx4 v9, s[12:15], s22 offen offset:1024 lds
    s_add_u32 s22, s42, 1865728
    buffer_load_dwordx4 v8, s[12:15], s22 offen offset:2048 lds
    s_add_u32 s22, s42, 1881088
    buffer_load_dwordx4 v9, s[12:15], s22 offen offset:3072 lds
    ds_read_b64_tr_b16 v[88:89], v11 offset:16384
    ds_read_b64_tr_b16 v[90:91], v11 offset:18432
    ds_read_b64_tr_b16 v[160:161], v11 offset:16392
    ds_read_b64_tr_b16 v[162:163], v11 offset:18440
    ds_read_b64_tr_b16 a[24:25], v11 offset:16640
    ds_read_b64_tr_b16 a[26:27], v11 offset:18688
    ds_read_b64_tr_b16 a[96:97], v11 offset:16648
    ds_read_b64_tr_b16 a[98:99], v11 offset:18696
    s_waitcnt vmcnt(12) lgkmcnt(0)
    s_barrier
    s_add_u32 m0, s44, 139264
    s_add_u32 s22, s42, 2883584
    buffer_load_dwordx4 v8, s[12:15], s22 offen offset:0 lds
    s_add_u32 s22, s42, 2898944
    buffer_load_dwordx4 v9, s[12:15], s22 offen offset:1024 lds
    s_add_u32 s22, s42, 2914304
    buffer_load_dwordx4 v8, s[12:15], s22 offen offset:2048 lds
    s_add_u32 s22, s42, 2929664
    buffer_load_dwordx4 v9, s[12:15], s22 offen offset:3072 lds
    ds_read_b64_tr_b16 v[104:105], v10 offset:0
    ds_read_b64_tr_b16 v[106:107], v10 offset:2048
    ds_read_b64_tr_b16 v[176:177], v10 offset:8
    ds_read_b64_tr_b16 v[178:179], v10 offset:2056
    ds_read_b64_tr_b16 a[40:41], v10 offset:256
    ds_read_b64_tr_b16 a[42:43], v10 offset:2304
    ds_read_b64_tr_b16 a[112:113], v10 offset:264
    ds_read_b64_tr_b16 a[114:115], v10 offset:2312
    s_waitcnt vmcnt(12) lgkmcnt(0)
    s_barrier
    s_add_u32 m0, s44, 73728
    s_add_u32 s22, s42, 3932160
    buffer_load_dwordx4 v8, s[12:15], s22 offen offset:0 lds
    s_add_u32 s22, s42, 3947520
    buffer_load_dwordx4 v9, s[12:15], s22 offen offset:1024 lds
    s_add_u32 s22, s42, 3962880
    buffer_load_dwordx4 v8, s[12:15], s22 offen offset:2048 lds
    s_add_u32 s22, s42, 3978240
    buffer_load_dwordx4 v9, s[12:15], s22 offen offset:3072 lds
    ds_read_b64_tr_b16 v[120:121], v10 offset:16384
    ds_read_b64_tr_b16 v[122:123], v10 offset:18432
    ds_read_b64_tr_b16 v[192:193], v10 offset:16392
    ds_read_b64_tr_b16 v[194:195], v10 offset:18440
    ds_read_b64_tr_b16 a[56:57], v10 offset:16640
    ds_read_b64_tr_b16 a[58:59], v10 offset:18688
    ds_read_b64_tr_b16 a[128:129], v10 offset:16648
    ds_read_b64_tr_b16 a[130:131], v10 offset:18696
    s_waitcnt vmcnt(12) lgkmcnt(0)
    s_barrier
    s_add_u32 m0, s44, 90112
    s_add_u32 s22, s42, 4194304
    buffer_load_dwordx4 v8, s[12:15], s22 offen offset:0 lds
    s_add_u32 s22, s42, 4209664
    buffer_load_dwordx4 v9, s[12:15], s22 offen offset:1024 lds
    s_add_u32 s22, s42, 4225024
    buffer_load_dwordx4 v8, s[12:15], s22 offen offset:2048 lds
    s_add_u32 s22, s42, 4240384
    buffer_load_dwordx4 v9, s[12:15], s22 offen offset:3072 lds
    ds_read_b64_tr_b16 v[76:77], v10 offset:32768
    ds_read_b64_tr_b16 v[78:79], v10 offset:34816
    ds_read_b64_tr_b16 v[148:149], v10 offset:32776
    ds_read_b64_tr_b16 v[150:151], v10 offset:34824
    ds_read_b64_tr_b16 a[12:13], v10 offset:33024
    ds_read_b64_tr_b16 a[14:15], v10 offset:35072
    ds_read_b64_tr_b16 a[84:85], v10 offset:33032
    ds_read_b64_tr_b16 a[86:87], v10 offset:35080
    s_waitcnt vmcnt(12) lgkmcnt(0)
    s_barrier
    s_add_u32 m0, s44, 106496
    s_add_u32 s22, s42, 4456448
    buffer_load_dwordx4 v8, s[12:15], s22 offen offset:0 lds
    s_add_u32 s22, s42, 4471808
    buffer_load_dwordx4 v9, s[12:15], s22 offen offset:1024 lds
    s_add_u32 s22, s42, 4487168
    buffer_load_dwordx4 v8, s[12:15], s22 offen offset:2048 lds
    s_add_u32 s22, s42, 4502528
    buffer_load_dwordx4 v9, s[12:15], s22 offen offset:3072 lds
    ds_read_b64_tr_b16 v[92:93], v11 offset:0
    ds_read_b64_tr_b16 v[94:95], v11 offset:2048
    ds_read_b64_tr_b16 v[164:165], v11 offset:8
    ds_read_b64_tr_b16 v[166:167], v11 offset:2056
    ds_read_b64_tr_b16 a[28:29], v11 offset:256
    ds_read_b64_tr_b16 a[30:31], v11 offset:2304
    ds_read_b64_tr_b16 a[100:101], v11 offset:264
    ds_read_b64_tr_b16 a[102:103], v11 offset:2312
    s_waitcnt vmcnt(12) lgkmcnt(0)
    s_barrier
    s_mov_b32 s27, 36864
    s_add_u32 s23, s27, s25
    s_add_u32 m0, s23, 0
    s_nop 0
    buffer_load_dwordx4 v2, s[8:11], s24 offen offset:0 lds
    s_add_u32 m0, s23, 960
    s_nop 0
    buffer_load_dwordx4 v2, s[8:11], s24 offen offset:64 lds
    s_add_u32 m0, s23, 1920
    s_nop 0
    buffer_load_dwordx4 v2, s[8:11], s24 offen offset:128 lds
    s_add_u32 m0, s23, 2880
    s_nop 0
    buffer_load_dwordx4 v2, s[8:11], s24 offen offset:192 lds
    s_add_u32 m0, s23, 3840
    s_nop 0
    buffer_load_dwordx4 v2, s[8:11], s24 offen offset:256 lds
    s_add_u32 m0, s23, 4800
    s_nop 0
    buffer_load_dwordx4 v2, s[8:11], s24 offen offset:320 lds
    s_add_u32 m0, s23, 5760
    s_nop 0
    buffer_load_dwordx4 v2, s[8:11], s24 offen offset:384 lds
    s_add_u32 m0, s23, 6720
    s_nop 0
    buffer_load_dwordx4 v2, s[8:11], s24 offen offset:448 lds
    s_add_u32 m0, s23, 7680
    s_nop 0
    buffer_load_dwordx4 v2, s[8:11], s24 offen offset:512 lds
    s_add_u32 s24, s24, 147456
    ds_read_b64_tr_b16 v[108:109], v11 offset:16384
    ds_read_b64_tr_b16 v[110:111], v11 offset:18432
    ds_read_b64_tr_b16 v[180:181], v11 offset:16392
    ds_read_b64_tr_b16 v[182:183], v11 offset:18440
    ds_read_b64_tr_b16 a[44:45], v11 offset:16640
    ds_read_b64_tr_b16 a[46:47], v11 offset:18688
    ds_read_b64_tr_b16 a[116:117], v11 offset:16648
    ds_read_b64_tr_b16 a[118:119], v11 offset:18696
    s_waitcnt vmcnt(17) lgkmcnt(0)
    s_barrier
    ds_read_b64_tr_b16 v[124:125], v10 offset:0
    ds_read_b64_tr_b16 v[126:127], v10 offset:2048
    ds_read_b64_tr_b16 v[196:197], v10 offset:8
    ds_read_b64_tr_b16 v[198:199], v10 offset:2056
    ds_read_b64_tr_b16 a[60:61], v10 offset:256
    ds_read_b64_tr_b16 a[62:63], v10 offset:2304
    ds_read_b64_tr_b16 a[132:133], v10 offset:264
    ds_read_b64_tr_b16 a[134:135], v10 offset:2312
    s_waitcnt vmcnt(13) lgkmcnt(0)
    s_barrier
    ds_read_b64_tr_b16 v[128:129], v10 offset:16384
    ds_read_b64_tr_b16 v[130:131], v10 offset:18432
    ds_read_b64_tr_b16 v[200:201], v10 offset:16392
    ds_read_b64_tr_b16 v[202:203], v10 offset:18440
    ds_read_b64_tr_b16 a[64:65], v10 offset:16640
    ds_read_b64_tr_b16 a[66:67], v10 offset:18688
    ds_read_b64_tr_b16 a[136:137], v10 offset:16648
    ds_read_b64_tr_b16 a[138:139], v10 offset:18696
    s_waitcnt vmcnt(9) lgkmcnt(0)
    s_barrier
    ds_read_b64_tr_b16 v[132:133], v10 offset:32768
    ds_read_b64_tr_b16 v[134:135], v10 offset:34816
    ds_read_b64_tr_b16 v[204:205], v10 offset:32776
    ds_read_b64_tr_b16 v[206:207], v10 offset:34824
    ds_read_b64_tr_b16 a[68:69], v10 offset:33024
    ds_read_b64_tr_b16 a[70:71], v10 offset:35072
    ds_read_b64_tr_b16 a[140:141], v10 offset:33032
    ds_read_b64_tr_b16 a[142:143], v10 offset:35080
    s_mov_b32 s88, 4194304
gn9:
    buffer_load_dword v250, off, s[84:87], 0 offset:216 sc1
    s_waitcnt vmcnt(0)
    v_readfirstlane_b32 s95, v250
    s_sub_u32 s88, s88, 1
    s_cbranch_scc1 gn9x
    s_cmp_eq_u32 s95, 0
    s_cbranch_scc1 gn9
gn9x:
    s_waitcnt lgkmcnt(0)
    s_mov_b32 s45, 0
    s_mov_b32 s27, 0
    s_mov_b64 s[36:37], 0
    s_mov_b32 s12, 0
    s_mov_b32 s13, s40
    s_mov_b32 s14, s30
    s_add_u32 s15, s14, s40
    s_lshl_b32 s41, s41, 2
    s_sub_u32 s26, s26, s41
    v_mov_b32 v3, v1
    s_waitcnt vmcnt(0)
    s_barrier
    ds_read_b128 v[32:35], v3 offset:0
    ds_read_b128 v[36:39], v3 offset:18432
    ds_read_b128 v[40:43], v3 offset:1024
    ds_read_b128 v[44:47], v3 offset:19456
    s_cmp_eq_u32 s18, 0
    s_cselect_b32 s34, 1, 0
    s_mov_b32 s35, 0
    s_cmp_eq_u32 s16, 2
    s_cbranch_scc1 qk_vloop
qk_loop:
    s_barrier
    s_add_u32 s22, s27, 73728
    s_sub_u32 s21, s22, 110592
    s_cselect_b32 s22, s22, s21
    s_waitcnt lgkmcnt(2)
    v_mfma_f32_16x16x32_bf16 v[208:211], v[64:67], v[32:35], 0
    ds_read_b128 v[48:51], v3 offset:2048
    v_mfma_f32_16x16x32_bf16 v[212:215], v[136:139], v[32:35], 0
    ds_read_b128 v[52:55], v3 offset:20480
    v_mfma_f32_16x16x32_bf16 v[216:219], v[64:67], v[36:39], 0
    v_mfma_f32_16x16x32_bf16 v[220:223], v[136:139], v[36:39], 0
    v_mfma_f32_16x16x32_bf16 v[224:227], a[0:3], v[32:35], 0
    v_mfma_f32_16x16x32_bf16 v[228:231], a[72:75], v[32:35], 0
    v_mfma_f32_16x16x32_bf16 v[232:235], a[0:3], v[36:39], 0
    v_mfma_f32_16x16x32_bf16 v[236:239], a[72:75], v[36:39], 0
    s_waitcnt lgkmcnt(2)
    v_mfma_f32_16x16x32_bf16 v[208:211], v[68:71], v[40:43], v[208:211]
    ds_read_b128 v[32:35], v3 offset:3072
    v_mfma_f32_16x16x32_bf16 v[212:215], v[140:143], v[40:43], v[212:215]
    ds_read_b128 v[36:39], v3 offset:21504
    v_mfma_f32_16x16x32_bf16 v[216:219], v[68:71], v[44:47], v[216:219]
    s_add_u32 s23, s22, s25
    s_add_u32 m0, s23, 0
    s_nop 0
    buffer_load_dwordx4 v2, s[8:11], s24 offen offset:0 lds
    v_mfma_f32_16x16x32_bf16 v[220:223], v[140:143], v[44:47], v[220:223]
    v_mfma_f32_16x16x32_bf16 v[224:227], a[4:7], v[40:43], v[224:227]
    v_mfma_f32_16x16x32_bf16 v[228:231], a[76:79], v[40:43], v[228:231]
    v_mfma_f32_16x16x32_bf16 v[232:235], a[4:7], v[44:47], v[232:235]
    s_add_u32 m0, s23, 960
    s_nop 0
    buffer_load_dwordx4 v2, s[8:11], s24 offen offset:64 lds
    v_mfma_f32_16x16x32_bf16 v[236:239], a[76:79], v[44:47], v[236:239]
    s_waitcnt lgkmcnt(2)
    v_mfma_f32_16x16x32_bf16 v[208:211], v[72:75], v[48:51], v[208:211]
    ds_read_b128 v[40:43], v3 offset:4096
    v_mfma_f32_16x16x32_bf16 v[212:215], v[144:147], v[48:51], v[212:215]
    ds_read_b128 v[44:47], v3 offset:22528
    v_mfma_f32_16x16x32_bf16 v[216:219], v[72:75], v[52:55], v[216:219]
    s_add_u32 m0, s23, 1920
    s_nop 0
    buffer_load_dwordx4 v2, s[8:11], s24 offen offset:128 lds
    v_mfma_f32_16x16x32_bf16 v[220:223], v[144:147], v[52:55], v[220:223]
    v_mfma_f32_16x16x32_bf16 v[224:227], a[8:11], v[48:51], v[224:227]
    v_mfma_f32_16x16x32_bf16 v[228:231], a[80:83], v[48:51], v[228:231]
    v_mfma_f32_16x16x32_bf16 v[232:235], a[8:11], v[52:55], v[232:235]
    s_add_u32 m0, s23, 2880
    s_nop 0
    buffer_load_dwordx4 v2, s[8:11], s24 offen offset:192 lds
    v_mfma_f32_16x16x32_bf16 v[236:239], a[80:83], v[52:55], v[236:239]
    s_waitcnt lgkmcnt(2)
    v_mfma_f32_16x16x32_bf16 v[208:211], v[76:79], v[32:35], v[208:211]
    ds_read_b128 v[48:51], v3 offset:5120
    v_mfma_f32_16x16x32_bf16 v[212:215], v[148:151], v[32:35], v[212:215]
    ds_read_b128 v[52:55], v3 offset:23552
    v_mfma_f32_16x16x32_bf16 v[216:219], v[76:79], v[36:39], v[216:219]
    s_add_u32 m0, s23, 3840
    s_nop 0
    buffer_load_dwordx4 v2, s[8:11], s24 offen offset:256 lds
    v_mfma_f32_16x16x32_bf16 v[220:223], v[148:151], v[36:39], v[220:223]
    v_mfma_f32_16x16x32_bf16 v[224:227], a[12:15], v[32:35], v[224:227]
    v_mfma_f32_16x16x32_bf16 v[228:231], a[84:87], v[32:35], v[228:231]
    v_mfma_f32_16x16x32_bf16 v[232:235], a[12:15], v[36:39], v[232:235]
    s_add_u32 m0, s23, 4800
    s_nop 0
    buffer_load_dwordx4 v2, s[8:11], s24 offen offset:320 lds
    v_mfma_f32_16x16x32_bf16 v[236:239], a[84:87], v[36:39], v[236:239]
    s_waitcnt lgkmcnt(2)
    v_mfma_f32_16x16x32_bf16 v[208:211], v[80:83], v[40:43], v[208:211]
    ds_read_b128 v[32:35], v3 offset:6144
    v_mfma_f32_16x16x32_bf16 v[212:215], v[152:155], v[40:43], v[212:215]
    ds_read_b128 v[36:39], v3 offset:24576
    v_mfma_f32_16x16x32_bf16 v[216:219], v[80:83], v[44:47], v[216:219]
    s_add_u32 m0, s23, 5760
    s_nop 0
    buffer_load_dwordx4 v2, s[8:11], s24 offen offset:384 lds
    v_mfma_f32_16x16x32_bf16 v[220:223], v[152:155], v[44:47], v[220:223]
    v_mfma_f32_16x16x32_bf16 v[224:227], a[16:19], v[40:43], v[224:227]
    v_mfma_f32_16x16x32_bf16 v[228:231], a[88:91], v[40:43], v[228:231]
    v_mfma_f32_16x16x32_bf16 v[232:235], a[16:19], v[44:47], v[232:235]
    s_add_u32 m0, s23, 6720
    s_nop 0
    buffer_load_dwordx4 v2, s[8:11], s24 offen offset:448 lds
    v_mfma_f32_16x16x32_bf16 v[236:239], a[88:91], v[44:47], v[236:239]
    s_waitcnt lgkmcnt(2)
    v_mfma_f32_16x16x32_bf16 v[208:211], v[84:87], v[48:51], v[208:211]
    ds_read_b128 v[40:43], v3 offset:7168
    v_mfma_f32_16x16x32_bf16 v[212:215], v[156:159], v[48:51], v[212:215]
    ds_read_b128 v[44:47], v3 offset:25600
    v_mfma_f32_16x16x32_bf16 v[216:219], v[84:87], v[52:55], v[216:219]
    s_add_u32 m0, s23, 7680
    s_nop 0
    buffer_load_dwordx4 v2, s[8:11], s24 offen offset:512 lds
    s_add_u32 s24, s24, 147456
    v_mfma_f32_16x16x32_bf16 v[220:223], v[156:159], v[52:55], v[220:223]
    v_mfma_f32_16x16x32_bf16 v[224:227], a[20:23], v[48:51], v[224:227]
    v_mfma_f32_16x16x32_bf16 v[228:231], a[92:95], v[48:51], v[228:231]
    v_mfma_f32_16x16x32_bf16 v[232:235], a[20:23], v[52:55], v[232:235]
    v_mfma_f32_16x16x32_bf16 v[236:239], a[92:95], v[52:55], v[236:239]
    s_waitcnt lgkmcnt(2)
    v_mfma_f32_16x16x32_bf16 v[208:211], v[88:91], v[32:35], v[208:211]
    ds_read_b128 v[48:51], v3 offset:8192
    v_mfma_f32_16x16x32_bf16 v[212:215], v[160:163], v[32:35], v[212:215]
    ds_read_b128 v[52:55], v3 offset:26624
    v_mfma_f32_16x16x32_bf16 v[216:219], v[88:91], v[36:39], v[216:219]
    v_mfma_f32_16x16x32_bf16 v[220:223], v[160:163], v[36:39], v[220:223]
    v_mfma_f32_16x16x32_bf16 v[224:227], a[24:27], v[32:35], v[224:227]
    v_mfma_f32_16x16x32_bf16 v[228:231], a[96:99], v[32:35], v[228:231]
    v_mfma_f32_16x16x32_bf16 v[232:235], a[24:27], v[36:39], v[232:235]
    v_mfma_f32_16x16x32_bf16 v[236:239], a[96:99], v[36:39], v[236:239]
    s_waitcnt lgkmcnt(2)
    v_mfma_f32_16x16x32_bf16 v[208:211], v[92:95], v[40:43], v[208:211]
    ds_read_b128 v[32:35], v3 offset:9216
    v_mfma_f32_16x16x32_bf16 v[212:215], v[164:167], v[40:43], v[212:215]
    ds_read_b128 v[36:39], v3 offset:27648
    v_mfma_f32_16x16x32_bf16 v[216:219], v[92:95], v[44:47], v[216:219]
    s_add_u32 s23, s45, s95
    v_mov_b32 v4, s23
    s_mov_b64 exec, s[34:35]
    buffer_store_dword v4, off, s[4:7], s29 sc1
    s_mov_b64 exec, -1
    v_mfma_f32_16x16x32_bf16 v[220:223], v[164:167], v[44:47], v[220:223]
    v_mfma_f32_16x16x32_bf16 v[224:227], a[28:31], v[40:43], v[224:227]
    v_mfma_f32_16x16x32_bf16 v[228:231], a[100:103], v[40:43], v[228:231]
    v_mfma_f32_16x16x32_bf16 v[232:235], a[28:31], v[44:47], v[232:235]
    v_mfma_f32_16x16x32_bf16 v[236:239], a[100:103], v[44:47], v[236:239]
    s_waitcnt lgkmcnt(2)
    v_mfma_f32_16x16x32_bf16 v[208:211], v[96:99], v[48:51], v[208:211]
    ds_read_b128 v[40:43], v3 offset:10240
    v_mfma_f32_16x16x32_bf16 v[212:215], v[168:171], v[48:51], v[212:215]
    ds_read_b128 v[44:47], v3 offset:28672
    v_mfma_f32_16x16x32_bf16 v[216:219], v[96:99], v[52:55], v[216:219]
    s_cmp_lt_u32 s19, 60
    s_cbranch_scc1 lt10
    buffer_load_dwordx4 v[244:247], off, s[84:87], 0 offset:16 sc1
    buffer_load_dwordx4 v[240:243], off, s[84:87], 0 offset:32 sc1
    buffer_load_dwordx2 v[252:253], off, s[84:87], 0 offset:48 sc1
lt10:
    s_lshr_b32 s46, s19, 2
    s_cmp_eq_u32 s16, 0
    s_cselect_b32 s46, 0, s46
    s_cmp_lg_u32 s46, 2
    s_cbranch_scc1 lp10
    v_mov_b32 v244, -1
    v_mov_b32 v245, -1
    v_mov_b32 v246, -1
    v_mov_b32 v247, -1
    s_lshl_b32 s46, s19, 5
    s_add_u32 s46, s46, s17
    s_lshl_b32 s46, s46, 12
    s_mul_i32 s47, s16, 8388608
    s_add_u32 s46, s46, s47
    s_add_u32 s47, s46, 67108864
    buffer_store_dwordx4 v[244:247], v7, s[4:7], s47 offen sc1
    s_add_u32 s47, s46, 67112960
    buffer_store_dwordx4 v[244:247], v7, s[4:7], s47 offen sc1
    s_add_u32 s47, s46, 67633152
    buffer_store_dwordx4 v[244:247], v7, s[4:7], s47 offen sc1
    s_add_u32 s47, s46, 67637248
    buffer_store_dwordx4 v[244:247], v7, s[4:7], s47 offen sc1
lp10:
    s_lshl_b32 s46, s16, 6
    s_or_b32 s46, s46, s19
    s_or_b32 s47, s46, 1
    s_cmp_lg_u32 s47, 11
    s_cbranch_scc1 lq10
    v_mov_b32 v244, -1
    v_mov_b32 v245, -1
    v_mov_b32 v246, -1
    v_mov_b32 v247, -1
    s_lshl_b32 s46, s46, 18
    s_lshl_b32 s47, s17, 12
    s_add_u32 s46, s46, s47
    s_add_u32 s47, s46, 63963136
    buffer_store_dwordx4 v[244:247], v7, s[4:7], s47 offen sc1
    s_add_u32 s47, s46, 63967232
    buffer_store_dwordx4 v[244:247], v7, s[4:7], s47 offen sc1
    s_add_u32 s47, s46, 64094208
    buffer_store_dwordx4 v[244:247], v7, s[4:7], s47 offen sc1
    s_add_u32 s47, s46, 64098304
    buffer_store_dwordx4 v[244:247], v7, s[4:7], s47 offen sc1
lq10:
    v_mfma_f32_16x16x32_bf16 v[220:223], v[168:171], v[52:55], v[220:223]
    v_mfma_f32_16x16x32_bf16 v[224:227], a[32:35], v[48:51], v[224:227]
    v_mfma_f32_16x16x32_bf16 v[228:231], a[104:107], v[48:51], v[228:231]
    v_mfma_f32_16x16x32_bf16 v[232:235], a[32:35], v[52:55], v[232:235]
    v_mfma_f32_16x16x32_bf16 v[236:239], a[104:107], v[52:55], v[236:239]
    s_waitcnt lgkmcnt(2)
    v_mfma_f32_16x16x32_bf16 v[208:211], v[100:103], v[32:35], v[208:211]
    ds_read_b128 v[48:51], v3 offset:11264
    v_mfma_f32_16x16x32_bf16 v[212:215], v[172:175], v[32:35], v[212:215]
    ds_read_b128 v[52:55], v3 offset:29696
    v_mfma_f32_16x16x32_bf16 v[216:219], v[100:103], v[36:39], v[216:219]
    v_mfma_f32_16x16x32_bf16 v[220:223], v[172:175], v[36:39], v[220:223]
    v_mfma_f32_16x16x32_bf16 v[224:227], a[36:39], v[32:35], v[224:227]
    v_mfma_f32_16x16x32_bf16 v[228:231], a[108:111], v[32:35], v[228:231]
    v_mfma_f32_16x16x32_bf16 v[232:235], a[36:39], v[36:39], v[232:235]
    v_mfma_f32_16x16x32_bf16 v[236:239], a[108:111], v[36:39], v[236:239]
    s_waitcnt lgkmcnt(2)
    v_mfma_f32_16x16x32_bf16 v[208:211], v[104:107], v[40:43], v[208:211]
    ds_read_b128 v[32:35], v3 offset:12288
    v_mfma_f32_16x16x32_bf16 v[212:215], v[176:179], v[40:43], v[212:215]
    ds_read_b128 v[36:39], v3 offset:30720
    v_mfma_f32_16x16x32_bf16 v[216:219], v[104:107], v[44:47], v[216:219]
    v_mfma_f32_16x16x32_bf16 v[220:223], v[176:179], v[44:47], v[220:223]
    v_mfma_f32_16x16x32_bf16 v[224:227], a[40:43], v[40:43], v[224:227]
    v_mfma_f32_16x16x32_bf16 v[228:231], a[112:115], v[40:43], v[228:231]
    v_mfma_f32_16x16x32_bf16 v[232:235], a[40:43], v[44:47], v[232:235]
    v_mfma_f32_16x16x32_bf16 v[236:239], a[112:115], v[44:47], v[236:239]
    s_waitcnt lgkmcnt(2)
    v_mfma_f32_16x16x32_bf16 v[208:211], v[108:111], v[48:51], v[208:211]
    ds_read_b128 v[40:43], v3 offset:13312
    v_mfma_f32_16x16x32_bf16 v[212:215], v[180:183], v[48:51], v[212:215]
    ds_read_b128 v[44:47], v3 offset:31744
    v_mfma_f32_16x16x32_bf16 v[216:219], v[108:111], v[52:55], v[216:219]
    v_mfma_f32_16x16x32_bf16 v[220:223], v[180:183], v[52:55], v[220:223]
    v_mfma_f32_16x16x32_bf16 v[224:227], a[44:47], v[48:51], v[224:227]
    v_mfma_f32_16x16x32_bf16 v[228:231], a[116:119], v[48:51], v[228:231]
    v_mfma_f32_16x16x32_bf16 v[232:235], a[44:47], v[52:55], v[232:235]
    v_mfma_f32_16x16x32_bf16 v[236:239], a[116:119], v[52:55], v[236:239]
    s_waitcnt lgkmcnt(2)
    v_mfma_f32_16x16x32_bf16 v[208:211], v[112:115], v[32:35], v[208:211]
    ds_read_b128 v[48:51], v3 offset:14336
    v_mfma_f32_16x16x32_bf16 v[212:215], v[184:187], v[32:35], v[212:215]
    ds_read_b128 v[52:55], v3 offset:32768
    v_mfma_f32_16x16x32_bf16 v[216:219], v[112:115], v[36:39], v[216:219]
    v_mfma_f32_16x16x32_bf16 v[220:223], v[184:187], v[36:39], v[220:223]
    v_mfma_f32_16x16x32_bf16 v[224:227], a[48:51], v[32:35], v[224:227]
    v_mfma_f32_16x16x32_bf16 v[228:231], a[120:123], v[32:35], v[228:231]
    v_mfma_f32_16x16x32_bf16 v[232:235], a[48:51], v[36:39], v[232:235]
    v_mfma_f32_16x16x32_bf16 v[236:239], a[120:123], v[36:39], v[236:239]
    s_waitcnt lgkmcnt(2)
    v_mfma_f32_16x16x32_bf16 v[208:211], v[116:119], v[40:43], v[208:211]
    ds_read_b128 v[32:35], v3 offset:15360
    v_mfma_f32_16x16x32_bf16 v[212:215], v[188:191], v[40:43], v[212:215]
    ds_read_b128 v[36:39], v3 offset:33792
    v_mfma_f32_16x16x32_bf16 v[216:219], v[116:119], v[44:47], v[216:219]
    v_mfma_f32_16x16x32_bf16 v[220:223], v[188:191], v[44:47], v[220:223]
    v_mfma_f32_16x16x32_bf16 v[224:227], a[52:55], v[40:43], v[224:227]
    v_mfma_f32_16x16x32_bf16 v[228:231], a[124:127], v[40:43], v[228:231]
    v_mfma_f32_16x16x32_bf16 v[232:235], a[52:55], v[44:47], v[232:235]
    v_mfma_f32_16x16x32_bf16 v[236:239], a[124:127], v[44:47], v[236:239]
    s_waitcnt lgkmcnt(2)
    v_mfma_f32_16x16x32_bf16 v[208:211], v[120:123], v[48:51], v[208:211]
    ds_read_b128 v[40:43], v3 offset:16384
    v_mfma_f32_16x16x32_bf16 v[212:215], v[192:195], v[48:51], v[212:215]
    ds_read_b128 v[44:47], v3 offset:34816
    v_mfma_f32_16x16x32_bf16 v[216:219], v[120:123], v[52:55], v[216:219]
    v_mfma_f32_16x16x32_bf16 v[220:223], v[192:195], v[52:55], v[220:223]
    v_mfma_f32_16x16x32_bf16 v[224:227], a[56:59], v[48:51], v[224:227]
    v_mfma_f32_16x16x32_bf16 v[228:231], a[128:131], v[48:51], v[228:231]
    v_mfma_f32_16x16x32_bf16 v[232:235], a[56:59], v[52:55], v[232:235]
    v_mfma_f32_16x16x32_bf16 v[236:239], a[128:131], v[52:55], v[236:239]
    s_waitcnt lgkmcnt(2)
    v_mfma_f32_16x16x32_bf16 v[208:211], v[124:127], v[32:35], v[208:211]
    ds_read_b128 v[48:51], v3 offset:17408
    v_mfma_f32_16x16x32_bf16 v[212:215], v[196:199], v[32:35], v[212:215]
    ds_read_b128 v[52:55], v3 offset:35840
    v_mfma_f32_16x16x32_bf16 v[216:219], v[124:127], v[36:39], v[216:219]
    v_mfma_f32_16x16x32_bf16 v[220:223], v[196:199], v[36:39], v[220:223]
    v_mfma_f32_16x16x32_bf16 v[224:227], a[60:63], v[32:35], v[224:227]
    s_add_u32 s27, s27, 36864
    s_cmp_eq_u32 s27, 110592
    s_cselect_b32 s27, 0, s27
    v_add_u32 v3, s27, v1
    v_mfma_f32_16x16x32_bf16 v[228:231], a[132:135], v[32:35], v[228:231]
    v_mfma_f32_16x16x32_bf16 v[232:235], a[60:63], v[36:39], v[232:235]
    v_mfma_f32_16x16x32_bf16 v[236:239], a[132:135], v[36:39], v[236:239]
    s_waitcnt lgkmcnt(2)
    v_mfma_f32_16x16x32_bf16 v[208:211], v[128:131], v[40:43], v[208:211]
    ds_read_b128 v[32:35], v3 offset:0
    v_mfma_f32_16x16x32_bf16 v[212:215], v[200:203], v[40:43], v[212:215]
    ds_read_b128 v[36:39], v3 offset:18432
    v_mfma_f32_16x16x32_bf16 v[216:219], v[128:131], v[44:47], v[216:219]
    v_mfma_f32_16x16x32_bf16 v[220:223], v[200:203], v[44:47], v[220:223]
    v_mfma_f32_16x16x32_bf16 v[224:227], a[64:67], v[40:43], v[224:227]
    v_mfma_f32_16x16x32_bf16 v[228:231], a[136:139], v[40:43], v[228:231]
    v_mfma_f32_16x16x32_bf16 v[232:235], a[64:67], v[44:47], v[232:235]
    v_mfma_f32_16x16x32_bf16 v[236:239], a[136:139], v[44:47], v[236:239]
    s_waitcnt lgkmcnt(2)
    v_mfma_f32_16x16x32_bf16 v[208:211], v[132:135], v[48:51], v[208:211]
    ds_read_b128 v[40:43], v3 offset:1024
    v_mfma_f32_16x16x32_bf16 v[212:215], v[204:207], v[48:51], v[212:215]
    ds_read_b128 v[44:47], v3 offset:19456
    v_mfma_f32_16x16x32_bf16 v[216:219], v[132:135], v[52:55], v[216:219]
    v_mfma_f32_16x16x32_bf16 v[220:223], v[204:207], v[52:55], v[220:223]
    v_mfma_f32_16x16x32_bf16 v[224:227], a[68:71], v[48:51], v[224:227]
    v_mfma_f32_16x16x32_bf16 v[228:231], a[140:143], v[48:51], v[228:231]
    v_mfma_f32_16x16x32_bf16 v[232:235], a[68:71], v[52:55], v[232:235]
    v_mfma_f32_16x16x32_bf16 v[236:239], a[140:143], v[52:55], v[236:239]
    s_add_u32 s26, s26, s41
    s_waitcnt vmcnt(0)
    v_cvt_pk_bf16_f32 v8, v208, v209
    v_cvt_pk_bf16_f32 v9, v210, v211
    v_cvt_pk_bf16_f32 v10, v212, v213
    v_cvt_pk_bf16_f32 v11, v214, v215
    v_cvt_pk_bf16_f32 v12, v216, v217
    v_cvt_pk_bf16_f32 v13, v218, v219
    v_cvt_pk_bf16_f32 v14, v220, v221
    v_cvt_pk_bf16_f32 v15, v222, v223
    v_cvt_pk_bf16_f32 v16, v224, v225
    v_cvt_pk_bf16_f32 v17, v226, v227
    v_cvt_pk_bf16_f32 v18, v228, v229
    v_cvt_pk_bf16_f32 v19, v230, v231
    v_cvt_pk_bf16_f32 v20, v232, v233
    v_cvt_pk_bf16_f32 v21, v234, v235
    v_cvt_pk_bf16_f32 v22, v236, v237
    v_cvt_pk_bf16_f32 v23, v238, v239
    s_mov_b64 s[36:37], -1
    s_add_u32 s28, s26, s12
    buffer_store_dwordx4 v[8:11], v7, s[4:7], s28 offen sc1
    s_add_u32 s28, s26, s13
    buffer_store_dwordx4 v[12:15], v7, s[4:7], s28 offen sc1
    s_add_u32 s28, s26, s14
    buffer_store_dwordx4 v[16:19], v7, s[4:7], s28 offen sc1
    s_add_u32 s28, s26, s15
    buffer_store_dwordx4 v[20:23], v7, s[4:7], s28 offen sc1
    s_lshr_b32 s45, s19, 2
    s_cbranch_scc1 qk_loop_nf
    s_mov_b32 s45, 1
    s_mov_b64 s[36:37], 0
    s_waitcnt vmcnt(0)
    s_barrier
    s_add_u32 s23, s45, s95
    v_mov_b32 v4, s23
    s_mov_b64 exec, s[34:35]
    buffer_store_dword v4, off, s[4:7], s29 sc1
    s_mov_b64 exec, -1
qk_loop_nf:
    s_add_u32 s19, s19, 4
    s_cmp_lt_u32 s19, s20
    s_cbranch_scc1 qk_loop
    s_branch qk_done
qk_vloop:
    s_barrier
    s_add_u32 s22, s27, 73728
    s_sub_u32 s21, s22, 110592
    s_cselect_b32 s22, s22, s21
    s_waitcnt lgkmcnt(2)
    v_mfma_f32_16x16x32_bf16 v[208:211], v[32:35], v[64:67], 0
    ds_read_b128 v[48:51], v3 offset:2048
    v_mfma_f32_16x16x32_bf16 v[212:215], v[32:35], v[136:139], 0
    ds_read_b128 v[52:55], v3 offset:20480
    v_mfma_f32_16x16x32_bf16 v[216:219], v[36:39], v[64:67], 0
    v_mfma_f32_16x16x32_bf16 v[220:223], v[36:39], v[136:139], 0
    v_mfma_f32_16x16x32_bf16 v[224:227], v[32:35], a[0:3], 0
    v_mfma_f32_16x16x32_bf16 v[228:231], v[32:35], a[72:75], 0
    v_mfma_f32_16x16x32_bf16 v[232:235], v[36:39], a[0:3], 0
    v_mfma_f32_16x16x32_bf16 v[236:239], v[36:39], a[72:75], 0
    s_waitcnt lgkmcnt(2)
    v_mfma_f32_16x16x32_bf16 v[208:211], v[40:43], v[68:71], v[208:211]
    ds_read_b128 v[32:35], v3 offset:3072
    v_mfma_f32_16x16x32_bf16 v[212:215], v[40:43], v[140:143], v[212:215]
    ds_read_b128 v[36:39], v3 offset:21504
    v_mfma_f32_16x16x32_bf16 v[216:219], v[44:47], v[68:71], v[216:219]
    s_add_u32 s23, s22, s25
    s_add_u32 m0, s23, 0
    s_nop 0
    buffer_load_dwordx4 v2, s[8:11], s24 offen offset:0 lds
    v_mfma_f32_16x16x32_bf16 v[220:223], v[44:47], v[140:143], v[220:223]
    v_mfma_f32_16x16x32_bf16 v[224:227], v[40:43], a[4:7], v[224:227]
    v_mfma_f32_16x16x32_bf16 v[228:231], v[40:43], a[76:79], v[228:231]
    v_mfma_f32_16x16x32_bf16 v[232:235], v[44:47], a[4:7], v[232:235]
    s_add_u32 m0, s23, 960
    s_nop 0
    buffer_load_dwordx4 v2, s[8:11], s24 offen offset:64 lds
    v_mfma_f32_16x16x32_bf16 v[236:239], v[44:47], a[76:79], v[236:239]
    s_waitcnt lgkmcnt(2)
    v_mfma_f32_16x16x32_bf16 v[208:211], v[48:51], v[72:75], v[208:211]
    ds_read_b128 v[40:43], v3 offset:4096
    v_mfma_f32_16x16x32_bf16 v[212:215], v[48:51], v[144:147], v[212:215]
    ds_read_b128 v[44:47], v3 offset:22528
    v_mfma_f32_16x16x32_bf16 v[216:219], v[52:55], v[72:75], v[216:219]
    s_add_u32 m0, s23, 1920
    s_nop 0
    buffer_load_dwordx4 v2, s[8:11], s24 offen offset:128 lds
    v_mfma_f32_16x16x32_bf16 v[220:223], v[52:55], v[144:147], v[220:223]
    v_mfma_f32_16x16x32_bf16 v[224:227], v[48:51], a[8:11], v[224:227]
    v_mfma_f32_16x16x32_bf16 v[228:231], v[48:51], a[80:83], v[228:231]
    v_mfma_f32_16x16x32_bf16 v[232:235], v[52:55], a[8:11], v[232:235]
    s_add_u32 m0, s23, 2880
    s_nop 0
    buffer_load_dwordx4 v2, s[8:11], s24 offen offset:192 lds
    v_mfma_f32_16x16x32_bf16 v[236:239], v[52:55], a[80:83], v[236:239]
    s_waitcnt lgkmcnt(2)
    v_mfma_f32_16x16x32_bf16 v[208:211], v[32:35], v[76:79], v[208:211]
    ds_read_b128 v[48:51], v3 offset:5120
    v_mfma_f32_16x16x32_bf16 v[212:215], v[32:35], v[148:151], v[212:215]
    ds_read_b128 v[52:55], v3 offset:23552
    v_mfma_f32_16x16x32_bf16 v[216:219], v[36:39], v[76:79], v[216:219]
    s_add_u32 m0, s23, 3840
    s_nop 0
    buffer_load_dwordx4 v2, s[8:11], s24 offen offset:256 lds
    v_mfma_f32_16x16x32_bf16 v[220:223], v[36:39], v[148:151], v[220:223]
    v_mfma_f32_16x16x32_bf16 v[224:227], v[32:35], a[12:15], v[224:227]
    v_mfma_f32_16x16x32_bf16 v[228:231], v[32:35], a[84:87], v[228:231]
    v_mfma_f32_16x16x32_bf16 v[232:235], v[36:39], a[12:15], v[232:235]
    s_add_u32 m0, s23, 4800
    s_nop 0
    buffer_load_dwordx4 v2, s[8:11], s24 offen offset:320 lds
    v_mfma_f32_16x16x32_bf16 v[236:239], v[36:39], a[84:87], v[236:239]
    s_waitcnt lgkmcnt(2)
    v_mfma_f32_16x16x32_bf16 v[208:211], v[40:43], v[80:83], v[208:211]
    ds_read_b128 v[32:35], v3 offset:6144
    v_mfma_f32_16x16x32_bf16 v[212:215], v[40:43], v[152:155], v[212:215]
    ds_read_b128 v[36:39], v3 offset:24576
    v_mfma_f32_16x16x32_bf16 v[216:219], v[44:47], v[80:83], v[216:219]
    s_add_u32 m0, s23, 5760
    s_nop 0
    buffer_load_dwordx4 v2, s[8:11], s24 offen offset:384 lds
    v_mfma_f32_16x16x32_bf16 v[220:223], v[44:47], v[152:155], v[220:223]
    v_mfma_f32_16x16x32_bf16 v[224:227], v[40:43], a[16:19], v[224:227]
    v_mfma_f32_16x16x32_bf16 v[228:231], v[40:43], a[88:91], v[228:231]
    v_mfma_f32_16x16x32_bf16 v[232:235], v[44:47], a[16:19], v[232:235]
    s_add_u32 m0, s23, 6720
    s_nop 0
    buffer_load_dwordx4 v2, s[8:11], s24 offen offset:448 lds
    v_mfma_f32_16x16x32_bf16 v[236:239], v[44:47], a[88:91], v[236:239]
    s_waitcnt lgkmcnt(2)
    v_mfma_f32_16x16x32_bf16 v[208:211], v[48:51], v[84:87], v[208:211]
    ds_read_b128 v[40:43], v3 offset:7168
    v_mfma_f32_16x16x32_bf16 v[212:215], v[48:51], v[156:159], v[212:215]
    ds_read_b128 v[44:47], v3 offset:25600
    v_mfma_f32_16x16x32_bf16 v[216:219], v[52:55], v[84:87], v[216:219]
    s_add_u32 m0, s23, 7680
    s_nop 0
    buffer_load_dwordx4 v2, s[8:11], s24 offen offset:512 lds
    s_add_u32 s24, s24, 147456
    v_mfma_f32_16x16x32_bf16 v[220:223], v[52:55], v[156:159], v[220:223]
    v_mfma_f32_16x16x32_bf16 v[224:227], v[48:51], a[20:23], v[224:227]
    v_mfma_f32_16x16x32_bf16 v[228:231], v[48:51], a[92:95], v[228:231]
    v_mfma_f32_16x16x32_bf16 v[232:235], v[52:55], a[20:23], v[232:235]
    v_mfma_f32_16x16x32_bf16 v[236:239], v[52:55], a[92:95], v[236:239]
    s_waitcnt lgkmcnt(2)
    v_mfma_f32_16x16x32_bf16 v[208:211], v[32:35], v[88:91], v[208:211]
    ds_read_b128 v[48:51], v3 offset:8192
    v_mfma_f32_16x16x32_bf16 v[212:215], v[32:35], v[160:163], v[212:215]
    ds_read_b128 v[52:55], v3 offset:26624
    v_mfma_f32_16x16x32_bf16 v[216:219], v[36:39], v[88:91], v[216:219]
    v_mfma_f32_16x16x32_bf16 v[220:223], v[36:39], v[160:163], v[220:223]
    v_mfma_f32_16x16x32_bf16 v[224:227], v[32:35], a[24:27], v[224:227]
    v_mfma_f32_16x16x32_bf16 v[228:231], v[32:35], a[96:99], v[228:231]
    v_mfma_f32_16x16x32_bf16 v[232:235], v[36:39], a[24:27], v[232:235]
    v_mfma_f32_16x16x32_bf16 v[236:239], v[36:39], a[96:99], v[236:239]
    s_waitcnt lgkmcnt(2)
    v_mfma_f32_16x16x32_bf16 v[208:211], v[40:43], v[92:95], v[208:211]
    ds_read_b128 v[32:35], v3 offset:9216
    v_mfma_f32_16x16x32_bf16 v[212:215], v[40:43], v[164:167], v[212:215]
    ds_read_b128 v[36:39], v3 offset:27648
    v_mfma_f32_16x16x32_bf16 v[216:219], v[44:47], v[92:95], v[216:219]
    s_add_u32 s23, s45, s95
    v_mov_b32 v4, s23
    s_mov_b64 exec, s[34:35]
    buffer_store_dword v4, off, s[4:7], s29 sc1
    s_mov_b64 exec, -1
    v_mfma_f32_16x16x32_bf16 v[220:223], v[44:47], v[164:167], v[220:223]
    v_mfma_f32_16x16x32_bf16 v[224:227], v[40:43], a[28:31], v[224:227]
    v_mfma_f32_16x16x32_bf16 v[228:231], v[40:43], a[100:103], v[228:231]
    v_mfma_f32_16x16x32_bf16 v[232:235], v[44:47], a[28:31], v[232:235]
    v_mfma_f32_16x16x32_bf16 v[236:239], v[44:47], a[100:103], v[236:239]
    s_waitcnt lgkmcnt(2)
    v_mfma_f32_16x16x32_bf16 v[208:211], v[48:51], v[96:99], v[208:211]
    ds_read_b128 v[40:43], v3 offset:10240
    v_mfma_f32_16x16x32_bf16 v[212:215], v[48:51], v[168:171], v[212:215]
    ds_read_b128 v[44:47], v3 offset:28672
    v_mfma_f32_16x16x32_bf16 v[216:219], v[52:55], v[96:99], v[216:219]
    s_cmp_lt_u32 s19, 60
    s_cbranch_scc1 lt11
    buffer_load_dwordx4 v[244:247], off, s[84:87], 0 offset:16 sc1
    buffer_load_dwordx4 v[240:243], off, s[84:87], 0 offset:32 sc1
    buffer_load_dwordx2 v[252:253], off, s[84:87], 0 offset:48 sc1
lt11:
    s_lshr_b32 s46, s19, 2
    s_cmp_eq_u32 s16, 0
    s_cselect_b32 s46, 0, s46
    s_cmp_lg_u32 s46, 2
    s_cbranch_scc1 lp11
    v_mov_b32 v244, -1
    v_mov_b32 v245, -1
    v_mov_b32 v246, -1
    v_mov_b32 v247, -1
    s_lshl_b32 s46, s19, 5
    s_add_u32 s46, s46, s17
    s_lshl_b32 s46, s46, 12
    s_mul_i32 s47, s16, 8388608
    s_add_u32 s46, s46, s47
    s_add_u32 s47, s46, 67108864
    buffer_store_dwordx4 v[244:247], v7, s[4:7], s47 offen sc1
    s_add_u32 s47, s46, 67112960
    buffer_store_dwordx4 v[244:247], v7, s[4:7], s47 offen sc1
    s_add_u32 s47, s46, 67633152
    buffer_store_dwordx4 v[244:247], v7, s[4:7], s47 offen sc1
    s_add_u32 s47, s46, 67637248
    buffer_store_dwordx4 v[244:247], v7, s[4:7], s47 offen sc1
lp11:
    s_lshl_b32 s46, s16, 6
    s_or_b32 s46, s46, s19
    s_or_b32 s47, s46, 1
    s_cmp_lg_u32 s47, 11
    s_cbranch_scc1 lq11
    v_mov_b32 v244, -1
    v_mov_b32 v245, -1
    v_mov_b32 v246, -1
    v_mov_b32 v247, -1
    s_lshl_b32 s46, s46, 18
    s_lshl_b32 s47, s17, 12
    s_add_u32 s46, s46, s47
    s_add_u32 s47, s46, 63963136
    buffer_store_dwordx4 v[244:247], v7, s[4:7], s47 offen sc1
    s_add_u32 s47, s46, 63967232
    buffer_store_dwordx4 v[244:247], v7, s[4:7], s47 offen sc1
    s_add_u32 s47, s46, 64094208
    buffer_store_dwordx4 v[244:247], v7, s[4:7], s47 offen sc1
    s_add_u32 s47, s46, 64098304
    buffer_store_dwordx4 v[244:247], v7, s[4:7], s47 offen sc1
lq11:
    v_mfma_f32_16x16x32_bf16 v[220:223], v[52:55], v[168:171], v[220:223]
    v_mfma_f32_16x16x32_bf16 v[224:227], v[48:51], a[32:35], v[224:227]
    v_mfma_f32_16x16x32_bf16 v[228:231], v[48:51], a[104:107], v[228:231]
    v_mfma_f32_16x16x32_bf16 v[232:235], v[52:55], a[32:35], v[232:235]
    v_mfma_f32_16x16x32_bf16 v[236:239], v[52:55], a[104:107], v[236:239]
    s_waitcnt lgkmcnt(2)
    v_mfma_f32_16x16x32_bf16 v[208:211], v[32:35], v[100:103], v[208:211]
    ds_read_b128 v[48:51], v3 offset:11264
    v_mfma_f32_16x16x32_bf16 v[212:215], v[32:35], v[172:175], v[212:215]
    ds_read_b128 v[52:55], v3 offset:29696
    v_mfma_f32_16x16x32_bf16 v[216:219], v[36:39], v[100:103], v[216:219]
    v_mfma_f32_16x16x32_bf16 v[220:223], v[36:39], v[172:175], v[220:223]
    v_mfma_f32_16x16x32_bf16 v[224:227], v[32:35], a[36:39], v[224:227]
    v_mfma_f32_16x16x32_bf16 v[228:231], v[32:35], a[108:111], v[228:231]
    v_mfma_f32_16x16x32_bf16 v[232:235], v[36:39], a[36:39], v[232:235]
    v_mfma_f32_16x16x32_bf16 v[236:239], v[36:39], a[108:111], v[236:239]
    s_waitcnt lgkmcnt(2)
    v_mfma_f32_16x16x32_bf16 v[208:211], v[40:43], v[104:107], v[208:211]
    ds_read_b128 v[32:35], v3 offset:12288
    v_mfma_f32_16x16x32_bf16 v[212:215], v[40:43], v[176:179], v[212:215]
    ds_read_b128 v[36:39], v3 offset:30720
    v_mfma_f32_16x16x32_bf16 v[216:219], v[44:47], v[104:107], v[216:219]
    v_mfma_f32_16x16x32_bf16 v[220:223], v[44:47], v[176:179], v[220:223]
    v_mfma_f32_16x16x32_bf16 v[224:227], v[40:43], a[40:43], v[224:227]
    v_mfma_f32_16x16x32_bf16 v[228:231], v[40:43], a[112:115], v[228:231]
    v_mfma_f32_16x16x32_bf16 v[232:235], v[44:47], a[40:43], v[232:235]
    v_mfma_f32_16x16x32_bf16 v[236:239], v[44:47], a[112:115], v[236:239]
    s_waitcnt lgkmcnt(2)
    v_mfma_f32_16x16x32_bf16 v[208:211], v[48:51], v[108:111], v[208:211]
    ds_read_b128 v[40:43], v3 offset:13312
    v_mfma_f32_16x16x32_bf16 v[212:215], v[48:51], v[180:183], v[212:215]
    ds_read_b128 v[44:47], v3 offset:31744
    v_mfma_f32_16x16x32_bf16 v[216:219], v[52:55], v[108:111], v[216:219]
    v_mfma_f32_16x16x32_bf16 v[220:223], v[52:55], v[180:183], v[220:223]
    v_mfma_f32_16x16x32_bf16 v[224:227], v[48:51], a[44:47], v[224:227]
    v_mfma_f32_16x16x32_bf16 v[228:231], v[48:51], a[116:119], v[228:231]
    v_mfma_f32_16x16x32_bf16 v[232:235], v[52:55], a[44:47], v[232:235]
    v_mfma_f32_16x16x32_bf16 v[236:239], v[52:55], a[116:119], v[236:239]
    s_waitcnt lgkmcnt(2)
    v_mfma_f32_16x16x32_bf16 v[208:211], v[32:35], v[112:115], v[208:211]
    ds_read_b128 v[48:51], v3 offset:14336
    v_mfma_f32_16x16x32_bf16 v[212:215], v[32:35], v[184:187], v[212:215]
    ds_read_b128 v[52:55], v3 offset:32768
    v_mfma_f32_16x16x32_bf16 v[216:219], v[36:39], v[112:115], v[216:219]
    v_mfma_f32_16x16x32_bf16 v[220:223], v[36:39], v[184:187], v[220:223]
    v_mfma_f32_16x16x32_bf16 v[224:227], v[32:35], a[48:51], v[224:227]
    v_mfma_f32_16x16x32_bf16 v[228:231], v[32:35], a[120:123], v[228:231]
    v_mfma_f32_16x16x32_bf16 v[232:235], v[36:39], a[48:51], v[232:235]
    v_mfma_f32_16x16x32_bf16 v[236:239], v[36:39], a[120:123], v[236:239]
    s_waitcnt lgkmcnt(2)
    v_mfma_f32_16x16x32_bf16 v[208:211], v[40:43], v[116:119], v[208:211]
    ds_read_b128 v[32:35], v3 offset:15360
    v_mfma_f32_16x16x32_bf16 v[212:215], v[40:43], v[188:191], v[212:215]
    ds_read_b128 v[36:39], v3 offset:33792
    v_mfma_f32_16x16x32_bf16 v[216:219], v[44:47], v[116:119], v[216:219]
    v_mfma_f32_16x16x32_bf16 v[220:223], v[44:47], v[188:191], v[220:223]
    v_mfma_f32_16x16x32_bf16 v[224:227], v[40:43], a[52:55], v[224:227]
    v_mfma_f32_16x16x32_bf16 v[228:231], v[40:43], a[124:127], v[228:231]
    v_mfma_f32_16x16x32_bf16 v[232:235], v[44:47], a[52:55], v[232:235]
    v_mfma_f32_16x16x32_bf16 v[236:239], v[44:47], a[124:127], v[236:239]
    s_waitcnt lgkmcnt(2)
    v_mfma_f32_16x16x32_bf16 v[208:211], v[48:51], v[120:123], v[208:211]
    ds_read_b128 v[40:43], v3 offset:16384
    v_mfma_f32_16x16x32_bf16 v[212:215], v[48:51], v[192:195], v[212:215]
    ds_read_b128 v[44:47], v3 offset:34816
    v_mfma_f32_16x16x32_bf16 v[216:219], v[52:55], v[120:123], v[216:219]
    v_mfma_f32_16x16x32_bf16 v[220:223], v[52:55], v[192:195], v[220:223]
    v_mfma_f32_16x16x32_bf16 v[224:227], v[48:51], a[56:59], v[224:227]
    v_mfma_f32_16x16x32_bf16 v[228:231], v[48:51], a[128:131], v[228:231]
    v_mfma_f32_16x16x32_bf16 v[232:235], v[52:55], a[56:59], v[232:235]
    v_mfma_f32_16x16x32_bf16 v[236:239], v[52:55], a[128:131], v[236:239]
    s_waitcnt lgkmcnt(2)
    v_mfma_f32_16x16x32_bf16 v[208:211], v[32:35], v[124:127], v[208:211]
    ds_read_b128 v[48:51], v3 offset:17408
    v_mfma_f32_16x16x32_bf16 v[212:215], v[32:35], v[196:199], v[212:215]
    ds_read_b128 v[52:55], v3 offset:35840
    v_mfma_f32_16x16x32_bf16 v[216:219], v[36:39], v[124:127], v[216:219]
    v_mfma_f32_16x16x32_bf16 v[220:223], v[36:39], v[196:199], v[220:223]
    v_mfma_f32_16x16x32_bf16 v[224:227], v[32:35], a[60:63], v[224:227]
    s_add_u32 s27, s27, 36864
    s_cmp_eq_u32 s27, 110592
    s_cselect_b32 s27, 0, s27
    v_add_u32 v3, s27, v1
    v_mfma_f32_16x16x32_bf16 v[228:231], v[32:35], a[132:135], v[228:231]
    v_mfma_f32_16x16x32_bf16 v[232:235], v[36:39], a[60:63], v[232:235]
    v_mfma_f32_16x16x32_bf16 v[236:239], v[36:39], a[132:135], v[236:239]
    s_waitcnt lgkmcnt(2)
    v_mfma_f32_16x16x32_bf16 v[208:211], v[40:43], v[128:131], v[208:211]
    ds_read_b128 v[32:35], v3 offset:0
    v_mfma_f32_16x16x32_bf16 v[212:215], v[40:43], v[200:203], v[212:215]
    ds_read_b128 v[36:39], v3 offset:18432
    v_mfma_f32_16x16x32_bf16 v[216:219], v[44:47], v[128:131], v[216:219]
    v_mfma_f32_16x16x32_bf16 v[220:223], v[44:47], v[200:203], v[220:223]
    v_mfma_f32_16x16x32_bf16 v[224:227], v[40:43], a[64:67], v[224:227]
    v_mfma_f32_16x16x32_bf16 v[228:231], v[40:43], a[136:139], v[228:231]
    v_mfma_f32_16x16x32_bf16 v[232:235], v[44:47], a[64:67], v[232:235]
    v_mfma_f32_16x16x32_bf16 v[236:239], v[44:47], a[136:139], v[236:239]
    s_waitcnt lgkmcnt(2)
    v_mfma_f32_16x16x32_bf16 v[208:211], v[48:51], v[132:135], v[208:211]
    ds_read_b128 v[40:43], v3 offset:1024
    v_mfma_f32_16x16x32_bf16 v[212:215], v[48:51], v[204:207], v[212:215]
    ds_read_b128 v[44:47], v3 offset:19456
    v_mfma_f32_16x16x32_bf16 v[216:219], v[52:55], v[132:135], v[216:219]
    v_mfma_f32_16x16x32_bf16 v[220:223], v[52:55], v[204:207], v[220:223]
    v_mfma_f32_16x16x32_bf16 v[224:227], v[48:51], a[68:71], v[224:227]
    v_mfma_f32_16x16x32_bf16 v[228:231], v[48:51], a[140:143], v[228:231]
    v_mfma_f32_16x16x32_bf16 v[232:235], v[52:55], a[68:71], v[232:235]
    v_mfma_f32_16x16x32_bf16 v[236:239], v[52:55], a[140:143], v[236:239]
    s_add_u32 s26, s26, s41
    s_waitcnt vmcnt(0)
    v_cvt_pk_bf16_f32 v8, v208, v209
    v_cvt_pk_bf16_f32 v9, v210, v211
    v_cvt_pk_bf16_f32 v10, v216, v217
    v_cvt_pk_bf16_f32 v11, v218, v219
    v_cvt_pk_bf16_f32 v12, v212, v213
    v_cvt_pk_bf16_f32 v13, v214, v215
    v_cvt_pk_bf16_f32 v14, v220, v221
    v_cvt_pk_bf16_f32 v15, v222, v223
    v_cvt_pk_bf16_f32 v16, v224, v225
    v_cvt_pk_bf16_f32 v17, v226, v227
    v_cvt_pk_bf16_f32 v18, v232, v233
    v_cvt_pk_bf16_f32 v19, v234, v235
    v_cvt_pk_bf16_f32 v20, v228, v229
    v_cvt_pk_bf16_f32 v21, v230, v231
    v_cvt_pk_bf16_f32 v22, v236, v237
    v_cvt_pk_bf16_f32 v23, v238, v239
    s_mov_b64 s[36:37], -1
    s_add_u32 s28, s26, s12
    buffer_store_dwordx4 v[8:11], v7, s[4:7], s28 offen sc1
    s_add_u32 s28, s26, s13
    buffer_store_dwordx4 v[12:15], v7, s[4:7], s28 offen sc1
    s_add_u32 s28, s26, s14
    buffer_store_dwordx4 v[16:19], v7, s[4:7], s28 offen sc1
    s_add_u32 s28, s26, s15
    buffer_store_dwordx4 v[20:23], v7, s[4:7], s28 offen sc1
    s_lshr_b32 s45, s19, 2
    s_cbranch_scc1 qk_vloop_nf
    s_mov_b32 s45, 1
    s_mov_b64 s[36:37], 0
    s_waitcnt vmcnt(0)
    s_barrier
    s_add_u32 s23, s45, s95
    v_mov_b32 v4, s23
    s_mov_b64 exec, s[34:35]
    buffer_store_dword v4, off, s[4:7], s29 sc1
    s_mov_b64 exec, -1
qk_vloop_nf:
    s_add_u32 s19, s19, 4
    s_cmp_lt_u32 s19, s20
    s_cbranch_scc1 qk_vloop
qk_done:
    s_waitcnt vmcnt(0) lgkmcnt(0)
    s_barrier
    s_mov_b32 s45, 16
    s_add_u32 s23, s45, s95
    v_mov_b32 v4, s23
    s_mov_b64 exec, s[34:35]
    buffer_store_dword v4, off, s[4:7], s29 sc1
    s_mov_b64 exec, -1
    s_cmp_lt_i32 s33, 0
    s_cbranch_scc1 L_memkv
    v_max3_u32 v248, v240, v241, v242
    v_max3_u32 v248, v248, v243, v252
    v_max_u32 v248, v248, v253
    v_min3_u32 v240, v240, v241, v242
    v_min3_u32 v240, v240, v243, v252
    v_min_u32 v240, v240, v253
    v_lshl_add_u32 v248, v248, 16, v240
    v_readfirstlane_b32 s40, v245
    v_readfirstlane_b32 s41, v246
    v_readfirstlane_b32 s42, v247
    v_readfirstlane_b32 s43, v248
    s_cmp_ge_u32 s40, 160
    s_cselect_b32 s43, s43, 0
    s_cmp_ge_u32 s41, 1
    s_cselect_b32 s43, s43, 0
    s_cmp_eq_u32 s42, 1
    s_cselect_b32 s43, s43, 0
    s_cmp_eq_u32 s93, 1000
    s_cselect_b32 s43, s43, 0
    s_mov_b32 s93, 999
    v_mov_b32 v250, s43
    v_mov_b32 v251, 163832
    s_mov_b64 exec, s[34:35]
    ds_write_b32 v251, v250
    s_mov_b64 exec, -1
    s_waitcnt lgkmcnt(0)
    s_barrier
    ds_read_b32 v252, v251
    s_waitcnt lgkmcnt(0)
    v_readfirstlane_b32 s43, v252
    s_barrier
    s_cmp_lg_u32 s43, 2097184
    s_cbranch_scc1 L_qkv_next
    s_mov_b32 s45, s33
    s_mov_b32 s93, 500
    s_branch L_phase2b
L_memkv:
    v_and_b32 v4, 63, v0
    v_and_b32 v2, 7, v4
    v_lshrrev_b32 v5, 4, v4
    v_lshl_add_u32 v2, v5, 3, v2
    v_lshlrev_b32 v2, 4, v2
    v_bfe_u32 v3, v4, 3, 1
    v_mul_u32_u24 v5, 9216, v3
    v_add_u32 v2, v2, v5
    v_mov_b32 v240, 0x05040100
    v_mov_b32 v241, 0x07060302
    v_lshrrev_b32 v5, 5, v4
    v_and_b32 v1, 0xdff, v7
    s_cmp_eq_u32 s16, 2
    s_cbranch_scc1 mk_isv
    v_mov_b32 v5, v3
    v_or_b32 v1, 128, v7
mk_isv:
    v_lshl_add_u32 v1, v5, 17, v1
    s_mov_b32 s28, 0
    s_mov_b32 s19, 2
    s_mov_b32 s24, 138412032
    s_lshl_b32 s26, s17, 12
    s_mov_b32 s21, 69206016
    s_cmp_eq_u32 s16, 2
    s_cselect_b32 s21, 77594624, s21
    s_add_u32 s26, s26, s21
    s_lshl_b32 s29, s17, 10
    s_lshl_b32 s21, s16, 7
    s_add_u32 s29, s29, s21
    s_add_u32 s29, s29, 126092672
mk_loop:
    s_cmp_lg_u32 s18, 0
    s_cbranch_scc1 mk_go
    s_cmp_le_u32 s19, s28
    s_cbranch_scc1 mk_go
    s_mov_b32 s23, 125853696
    s_mov_b32 s21, 4194304
mk_wait:
    buffer_load_dword v4, off, s[4:7], s23 sc1
    s_sub_u32 s21, s21, 1
    s_cbranch_scc1 mk_go
    s_waitcnt vmcnt(0)
    v_readfirstlane_b32 s28, v4
    s_nop 0
    s_sub_u32 s28, s28, s95
    s_cmp_gt_u32 s28, 64
    s_cselect_b32 s28, 0, s28
    s_cmp_le_u32 s19, s28
    s_cbranch_scc1 mk_go
    s_sleep 4
    s_branch mk_wait
mk_go:
    s_barrier
    s_add_u32 s21, s24, 4096
    s_add_u32 s23, s24, 8192
    buffer_load_dwordx4 v[24:27], v2, s[4:7], s24 offen offset:0 sc1
    buffer_load_dwordx4 v[28:31], v2, s[4:7], s24 offen offset:512 sc1
    buffer_load_dwordx4 v[32:35], v2, s[4:7], s21 offen offset:0 sc1
    buffer_load_dwordx4 v[36:39], v2, s[4:7], s21 offen offset:512 sc1
    buffer_load_dwordx4 v[40:43], v2, s[4:7], s24 offen offset:1024 sc1
    buffer_load_dwordx4 v[44:47], v2, s[4:7], s24 offen offset:1536 sc1
    buffer_load_dwordx4 v[48:51], v2, s[4:7], s21 offen offset:1024 sc1
    buffer_load_dwordx4 v[52:55], v2, s[4:7], s21 offen offset:1536 sc1
    buffer_load_dwordx4 v[56:59], v2, s[4:7], s24 offen offset:2048 sc1
    buffer_load_dwordx4 v[60:63], v2, s[4:7], s24 offen offset:2560 sc1
    buffer_load_dwordx4 v[208:211], v2, s[4:7], s21 offen offset:2048 sc1
    buffer_load_dwordx4 v[212:215], v2, s[4:7], s21 offen offset:2560 sc1
    buffer_load_dwordx4 v[216:219], v2, s[4:7], s24 offen offset:3072 sc1
    buffer_load_dwordx4 v[220:223], v2, s[4:7], s24 offen offset:3584 sc1
    buffer_load_dwordx4 v[224:227], v2, s[4:7], s21 offen offset:3072 sc1
    buffer_load_dwordx4 v[228:231], v2, s[4:7], s21 offen offset:3584 sc1
    buffer_load_dwordx4 v[232:235], v2, s[4:7], s23 offen offset:0 sc1
    buffer_load_dwordx4 v[236:239], v2, s[4:7], s23 offen offset:512 sc1
    s_add_u32 s24, s24, 18432
    s_cmp_eq_u32 s16, 2
    s_cbranch_scc1 mk_v
    s_waitcnt vmcnt(17)
    s_waitcnt vmcnt(16)
    v_mfma_f32_16x16x32_bf16 v[8:11], v[64:67], v[24:27], 0
    v_mfma_f32_16x16x32_bf16 v[12:15], v[136:139], v[24:27], 0
    v_mfma_f32_16x16x32_bf16 v[16:19], a[0:3], v[24:27], 0
    v_mfma_f32_16x16x32_bf16 v[20:23], a[72:75], v[24:27], 0
    s_waitcnt vmcnt(15)
    v_mfma_f32_16x16x32_bf16 v[8:11], v[68:71], v[28:31], v[8:11]
    v_mfma_f32_16x16x32_bf16 v[12:15], v[140:143], v[28:31], v[12:15]
    v_mfma_f32_16x16x32_bf16 v[16:19], a[4:7], v[28:31], v[16:19]
    v_mfma_f32_16x16x32_bf16 v[20:23], a[76:79], v[28:31], v[20:23]
    s_waitcnt vmcnt(14)
    v_mfma_f32_16x16x32_bf16 v[8:11], v[72:75], v[32:35], v[8:11]
    v_mfma_f32_16x16x32_bf16 v[12:15], v[144:147], v[32:35], v[12:15]
    v_mfma_f32_16x16x32_bf16 v[16:19], a[8:11], v[32:35], v[16:19]
    v_mfma_f32_16x16x32_bf16 v[20:23], a[80:83], v[32:35], v[20:23]
    s_waitcnt vmcnt(13)
    v_mfma_f32_16x16x32_bf16 v[8:11], v[76:79], v[36:39], v[8:11]
    v_mfma_f32_16x16x32_bf16 v[12:15], v[148:151], v[36:39], v[12:15]
    v_mfma_f32_16x16x32_bf16 v[16:19], a[12:15], v[36:39], v[16:19]
    v_mfma_f32_16x16x32_bf16 v[20:23], a[84:87], v[36:39], v[20:23]
    s_waitcnt vmcnt(12)
    v_mfma_f32_16x16x32_bf16 v[8:11], v[80:83], v[40:43], v[8:11]
    v_mfma_f32_16x16x32_bf16 v[12:15], v[152:155], v[40:43], v[12:15]
    v_mfma_f32_16x16x32_bf16 v[16:19], a[16:19], v[40:43], v[16:19]
    v_mfma_f32_16x16x32_bf16 v[20:23], a[88:91], v[40:43], v[20:23]
    s_waitcnt vmcnt(11)
    v_mfma_f32_16x16x32_bf16 v[8:11], v[84:87], v[44:47], v[8:11]
    v_mfma_f32_16x16x32_bf16 v[12:15], v[156:159], v[44:47], v[12:15]
    v_mfma_f32_16x16x32_bf16 v[16:19], a[20:23], v[44:47], v[16:19]
    v_mfma_f32_16x16x32_bf16 v[20:23], a[92:95], v[44:47], v[20:23]
    s_waitcnt vmcnt(10)
    v_mfma_f32_16x16x32_bf16 v[8:11], v[88:91], v[48:51], v[8:11]
    v_mfma_f32_16x16x32_bf16 v[12:15], v[160:163], v[48:51], v[12:15]
    v_mfma_f32_16x16x32_bf16 v[16:19], a[24:27], v[48:51], v[16:19]
    v_mfma_f32_16x16x32_bf16 v[20:23], a[96:99], v[48:51], v[20:23]
    s_waitcnt vmcnt(9)
    v_mfma_f32_16x16x32_bf16 v[8:11], v[92:95], v[52:55], v[8:11]
    v_mfma_f32_16x16x32_bf16 v[12:15], v[164:167], v[52:55], v[12:15]
    v_mfma_f32_16x16x32_bf16 v[16:19], a[28:31], v[52:55], v[16:19]
    v_mfma_f32_16x16x32_bf16 v[20:23], a[100:103], v[52:55], v[20:23]
    s_waitcnt vmcnt(8)
    v_mfma_f32_16x16x32_bf16 v[8:11], v[96:99], v[56:59], v[8:11]
    v_mfma_f32_16x16x32_bf16 v[12:15], v[168:171], v[56:59], v[12:15]
    v_mfma_f32_16x16x32_bf16 v[16:19], a[32:35], v[56:59], v[16:19]
    v_mfma_f32_16x16x32_bf16 v[20:23], a[104:107], v[56:59], v[20:23]
    s_waitcnt vmcnt(7)
    v_mfma_f32_16x16x32_bf16 v[8:11], v[100:103], v[60:63], v[8:11]
    v_mfma_f32_16x16x32_bf16 v[12:15], v[172:175], v[60:63], v[12:15]
    v_mfma_f32_16x16x32_bf16 v[16:19], a[36:39], v[60:63], v[16:19]
    v_mfma_f32_16x16x32_bf16 v[20:23], a[108:111], v[60:63], v[20:23]
    s_waitcnt vmcnt(6)
    v_mfma_f32_16x16x32_bf16 v[8:11], v[104:107], v[208:211], v[8:11]
    v_mfma_f32_16x16x32_bf16 v[12:15], v[176:179], v[208:211], v[12:15]
    v_mfma_f32_16x16x32_bf16 v[16:19], a[40:43], v[208:211], v[16:19]
    v_mfma_f32_16x16x32_bf16 v[20:23], a[112:115], v[208:211], v[20:23]
    s_waitcnt vmcnt(5)
    v_mfma_f32_16x16x32_bf16 v[8:11], v[108:111], v[212:215], v[8:11]
    v_mfma_f32_16x16x32_bf16 v[12:15], v[180:183], v[212:215], v[12:15]
    v_mfma_f32_16x16x32_bf16 v[16:19], a[44:47], v[212:215], v[16:19]
    v_mfma_f32_16x16x32_bf16 v[20:23], a[116:119], v[212:215], v[20:23]
    s_waitcnt vmcnt(4)
    v_mfma_f32_16x16x32_bf16 v[8:11], v[112:115], v[216:219], v[8:11]
    v_mfma_f32_16x16x32_bf16 v[12:15], v[184:187], v[216:219], v[12:15]
    v_mfma_f32_16x16x32_bf16 v[16:19], a[48:51], v[216:219], v[16:19]
    v_mfma_f32_16x16x32_bf16 v[20:23], a[120:123], v[216:219], v[20:23]
    s_waitcnt vmcnt(3)
    v_mfma_f32_16x16x32_bf16 v[8:11], v[116:119], v[220:223], v[8:11]
    v_mfma_f32_16x16x32_bf16 v[12:15], v[188:191], v[220:223], v[12:15]
    v_mfma_f32_16x16x32_bf16 v[16:19], a[52:55], v[220:223], v[16:19]
    v_mfma_f32_16x16x32_bf16 v[20:23], a[124:127], v[220:223], v[20:23]
    s_waitcnt vmcnt(2)
    v_mfma_f32_16x16x32_bf16 v[8:11], v[120:123], v[224:227], v[8:11]
    v_mfma_f32_16x16x32_bf16 v[12:15], v[192:195], v[224:227], v[12:15]
    v_mfma_f32_16x16x32_bf16 v[16:19], a[56:59], v[224:227], v[16:19]
    v_mfma_f32_16x16x32_bf16 v[20:23], a[128:131], v[224:227], v[20:23]
    s_waitcnt vmcnt(1)
    v_mfma_f32_16x16x32_bf16 v[8:11], v[124:127], v[228:231], v[8:11]
    v_mfma_f32_16x16x32_bf16 v[12:15], v[196:199], v[228:231], v[12:15]
    v_mfma_f32_16x16x32_bf16 v[16:19], a[60:63], v[228:231], v[16:19]
    v_mfma_f32_16x16x32_bf16 v[20:23], a[132:135], v[228:231], v[20:23]
    s_waitcnt vmcnt(0)
    v_mfma_f32_16x16x32_bf16 v[8:11], v[128:131], v[232:235], v[8:11]
    v_mfma_f32_16x16x32_bf16 v[12:15], v[200:203], v[232:235], v[12:15]
    v_mfma_f32_16x16x32_bf16 v[16:19], a[64:67], v[232:235], v[16:19]
    v_mfma_f32_16x16x32_bf16 v[20:23], a[136:139], v[232:235], v[20:23]
    v_mfma_f32_16x16x32_bf16 v[8:11], v[132:135], v[236:239], v[8:11]
    v_mfma_f32_16x16x32_bf16 v[12:15], v[204:207], v[236:239], v[12:15]
    v_mfma_f32_16x16x32_bf16 v[16:19], a[68:71], v[236:239], v[16:19]
    v_mfma_f32_16x16x32_bf16 v[20:23], a[140:143], v[236:239], v[20:23]
    s_nop 7
    s_branch mk_st
mk_v:
    s_waitcnt vmcnt(17)
    s_waitcnt vmcnt(16)
    v_mfma_f32_16x16x32_bf16 v[8:11], v[24:27], v[64:67], 0
    v_mfma_f32_16x16x32_bf16 v[12:15], v[24:27], v[136:139], 0
    v_mfma_f32_16x16x32_bf16 v[16:19], v[24:27], a[0:3], 0
    v_mfma_f32_16x16x32_bf16 v[20:23], v[24:27], a[72:75], 0
    s_waitcnt vmcnt(15)
    v_mfma_f32_16x16x32_bf16 v[8:11], v[28:31], v[68:71], v[8:11]
    v_mfma_f32_16x16x32_bf16 v[12:15], v[28:31], v[140:143], v[12:15]
    v_mfma_f32_16x16x32_bf16 v[16:19], v[28:31], a[4:7], v[16:19]
    v_mfma_f32_16x16x32_bf16 v[20:23], v[28:31], a[76:79], v[20:23]
    s_waitcnt vmcnt(14)
    v_mfma_f32_16x16x32_bf16 v[8:11], v[32:35], v[72:75], v[8:11]
    v_mfma_f32_16x16x32_bf16 v[12:15], v[32:35], v[144:147], v[12:15]
    v_mfma_f32_16x16x32_bf16 v[16:19], v[32:35], a[8:11], v[16:19]
    v_mfma_f32_16x16x32_bf16 v[20:23], v[32:35], a[80:83], v[20:23]
    s_waitcnt vmcnt(13)
    v_mfma_f32_16x16x32_bf16 v[8:11], v[36:39], v[76:79], v[8:11]
    v_mfma_f32_16x16x32_bf16 v[12:15], v[36:39], v[148:151], v[12:15]
    v_mfma_f32_16x16x32_bf16 v[16:19], v[36:39], a[12:15], v[16:19]
    v_mfma_f32_16x16x32_bf16 v[20:23], v[36:39], a[84:87], v[20:23]
    s_waitcnt vmcnt(12)
    v_mfma_f32_16x16x32_bf16 v[8:11], v[40:43], v[80:83], v[8:11]
    v_mfma_f32_16x16x32_bf16 v[12:15], v[40:43], v[152:155], v[12:15]
    v_mfma_f32_16x16x32_bf16 v[16:19], v[40:43], a[16:19], v[16:19]
    v_mfma_f32_16x16x32_bf16 v[20:23], v[40:43], a[88:91], v[20:23]
    s_waitcnt vmcnt(11)
    v_mfma_f32_16x16x32_bf16 v[8:11], v[44:47], v[84:87], v[8:11]
    v_mfma_f32_16x16x32_bf16 v[12:15], v[44:47], v[156:159], v[12:15]
    v_mfma_f32_16x16x32_bf16 v[16:19], v[44:47], a[20:23], v[16:19]
    v_mfma_f32_16x16x32_bf16 v[20:23], v[44:47], a[92:95], v[20:23]
    s_waitcnt vmcnt(10)
    v_mfma_f32_16x16x32_bf16 v[8:11], v[48:51], v[88:91], v[8:11]
    v_mfma_f32_16x16x32_bf16 v[12:15], v[48:51], v[160:163], v[12:15]
    v_mfma_f32_16x16x32_bf16 v[16:19], v[48:51], a[24:27], v[16:19]
    v_mfma_f32_16x16x32_bf16 v[20:23], v[48:51], a[96:99], v[20:23]
    s_waitcnt vmcnt(9)
    v_mfma_f32_16x16x32_bf16 v[8:11], v[52:55], v[92:95], v[8:11]
    v_mfma_f32_16x16x32_bf16 v[12:15], v[52:55], v[164:167], v[12:15]
    v_mfma_f32_16x16x32_bf16 v[16:19], v[52:55], a[28:31], v[16:19]
    v_mfma_f32_16x16x32_bf16 v[20:23], v[52:55], a[100:103], v[20:23]
    s_waitcnt vmcnt(8)
    v_mfma_f32_16x16x32_bf16 v[8:11], v[56:59], v[96:99], v[8:11]
    v_mfma_f32_16x16x32_bf16 v[12:15], v[56:59], v[168:171], v[12:15]
    v_mfma_f32_16x16x32_bf16 v[16:19], v[56:59], a[32:35], v[16:19]
    v_mfma_f32_16x16x32_bf16 v[20:23], v[56:59], a[104:107], v[20:23]
    s_waitcnt vmcnt(7)
    v_mfma_f32_16x16x32_bf16 v[8:11], v[60:63], v[100:103], v[8:11]
    v_mfma_f32_16x16x32_bf16 v[12:15], v[60:63], v[172:175], v[12:15]
    v_mfma_f32_16x16x32_bf16 v[16:19], v[60:63], a[36:39], v[16:19]
    v_mfma_f32_16x16x32_bf16 v[20:23], v[60:63], a[108:111], v[20:23]
    s_waitcnt vmcnt(6)
    v_mfma_f32_16x16x32_bf16 v[8:11], v[208:211], v[104:107], v[8:11]
    v_mfma_f32_16x16x32_bf16 v[12:15], v[208:211], v[176:179], v[12:15]
    v_mfma_f32_16x16x32_bf16 v[16:19], v[208:211], a[40:43], v[16:19]
    v_mfma_f32_16x16x32_bf16 v[20:23], v[208:211], a[112:115], v[20:23]
    s_waitcnt vmcnt(5)
    v_mfma_f32_16x16x32_bf16 v[8:11], v[212:215], v[108:111], v[8:11]
    v_mfma_f32_16x16x32_bf16 v[12:15], v[212:215], v[180:183], v[12:15]
    v_mfma_f32_16x16x32_bf16 v[16:19], v[212:215], a[44:47], v[16:19]
    v_mfma_f32_16x16x32_bf16 v[20:23], v[212:215], a[116:119], v[20:23]
    s_waitcnt vmcnt(4)
    v_mfma_f32_16x16x32_bf16 v[8:11], v[216:219], v[112:115], v[8:11]
    v_mfma_f32_16x16x32_bf16 v[12:15], v[216:219], v[184:187], v[12:15]
    v_mfma_f32_16x16x32_bf16 v[16:19], v[216:219], a[48:51], v[16:19]
    v_mfma_f32_16x16x32_bf16 v[20:23], v[216:219], a[120:123], v[20:23]
    s_waitcnt vmcnt(3)
    v_mfma_f32_16x16x32_bf16 v[8:11], v[220:223], v[116:119], v[8:11]
    v_mfma_f32_16x16x32_bf16 v[12:15], v[220:223], v[188:191], v[12:15]
    v_mfma_f32_16x16x32_bf16 v[16:19], v[220:223], a[52:55], v[16:19]
    v_mfma_f32_16x16x32_bf16 v[20:23], v[220:223], a[124:127], v[20:23]
    s_waitcnt vmcnt(2)
    v_mfma_f32_16x16x32_bf16 v[8:11], v[224:227], v[120:123], v[8:11]
    v_mfma_f32_16x16x32_bf16 v[12:15], v[224:227], v[192:195], v[12:15]
    v_mfma_f32_16x16x32_bf16 v[16:19], v[224:227], a[56:59], v[16:19]
    v_mfma_f32_16x16x32_bf16 v[20:23], v[224:227], a[128:131], v[20:23]
    s_waitcnt vmcnt(1)
    v_mfma_f32_16x16x32_bf16 v[8:11], v[228:231], v[124:127], v[8:11]
    v_mfma_f32_16x16x32_bf16 v[12:15], v[228:231], v[196:199], v[12:15]
    v_mfma_f32_16x16x32_bf16 v[16:19], v[228:231], a[60:63], v[16:19]
    v_mfma_f32_16x16x32_bf16 v[20:23], v[228:231], a[132:135], v[20:23]
    s_waitcnt vmcnt(0)
    v_mfma_f32_16x16x32_bf16 v[8:11], v[232:235], v[128:131], v[8:11]
    v_mfma_f32_16x16x32_bf16 v[12:15], v[232:235], v[200:203], v[12:15]
    v_mfma_f32_16x16x32_bf16 v[16:19], v[232:235], a[64:67], v[16:19]
    v_mfma_f32_16x16x32_bf16 v[20:23], v[232:235], a[136:139], v[20:23]
    v_mfma_f32_16x16x32_bf16 v[8:11], v[236:239], v[132:135], v[8:11]
    v_mfma_f32_16x16x32_bf16 v[12:15], v[236:239], v[204:207], v[12:15]
    v_mfma_f32_16x16x32_bf16 v[16:19], v[236:239], a[68:71], v[16:19]
    v_mfma_f32_16x16x32_bf16 v[20:23], v[236:239], a[140:143], v[20:23]
    s_nop 4
    v_pk_mul_f32 v[8:9], v[8:9], 0.5 op_sel_hi:[1,0]
    v_pk_mul_f32 v[10:11], v[10:11], 0.5 op_sel_hi:[1,0]
    v_pk_mul_f32 v[12:13], v[12:13], 0.5 op_sel_hi:[1,0]
    v_pk_mul_f32 v[14:15], v[14:15], 0.5 op_sel_hi:[1,0]
    v_pk_mul_f32 v[16:17], v[16:17], 0.5 op_sel_hi:[1,0]
    v_pk_mul_f32 v[18:19], v[18:19], 0.5 op_sel_hi:[1,0]
    v_pk_mul_f32 v[20:21], v[20:21], 0.5 op_sel_hi:[1,0]
    v_pk_mul_f32 v[22:23], v[22:23], 0.5 op_sel_hi:[1,0]
mk_st:
    s_nop 1
    v_cvt_pk_bf16_f32 v24, v8, v9
    v_cvt_pk_bf16_f32 v25, v10, v11
    v_cvt_pk_bf16_f32 v26, v12, v13
    v_cvt_pk_bf16_f32 v27, v14, v15
    v_cvt_pk_bf16_f32 v28, v16, v17
    v_cvt_pk_bf16_f32 v29, v18, v19
    v_cvt_pk_bf16_f32 v30, v20, v21
    v_cvt_pk_bf16_f32 v31, v22, v23
    s_add_u32 s21, s26, 4096
    buffer_store_dwordx4 v[24:27], v1, s[4:7], s26 offen sc1
    buffer_store_dwordx4 v[28:31], v1, s[4:7], s21 offen sc1
    s_add_u32 s22, s19, s95
    s_waitcnt vmcnt(0)
    s_barrier
    v_mov_b32 v4, s22
    s_mov_b64 exec, s[34:35]
    buffer_store_dword v4, off, s[4:7], s29 sc1
    s_mov_b64 exec, -1
    s_add_u32 s19, s19, 2
    s_add_u32 s26, s26, 262144
    s_cmp_le_u32 s19, 56
    s_cbranch_scc1 mk_loop
    s_mov_b32 s45, 0
    s_cmp_lg_u32 s93, 1000
    s_cbranch_scc1 L_wf_next
    s_mov_b32 s45, 2
    s_mov_b32 s8, s76
    s_mov_b32 s9, s77
    s_mov_b32 s10, 4718592
    s_mov_b32 s11, 0x20000
    s_branch L_att_next
L_ssm_next:
    s_sub_u32 s93, s93, 1
    s_cbranch_scc1 L_exit
    s_sub_u32 s46, s3, 2
    s_cmp_lt_u32 s3, 2
    s_cselect_b32 s46, s3, s46
    s_cmp_lt_u32 s46, 6
    s_cselect_b32 s46, s46, 0
    s_cmp_gt_u32 s93, 500
    s_cselect_b32 s47, 6, 1
    s_cmp_le_u32 s45, 1
    s_cselect_b32 s47, 6, s47
L_sq:
    s_lshl_b32 s40, s46, 2
    s_add_u32 s40, s40, 56
    s_mov_b32 s37, s40
    v_mov_b32 v250, 1
    v_mov_b32 v251, 163832
    v_cmp_eq_u32 vcc, 0, v0
    s_nop 0
    s_and_saveexec_b64 s[38:39], vcc
    s_cbranch_execz tk12
    buffer_atomic_add v250, off, s[84:87], s37 sc0
    s_waitcnt vmcnt(0)
    ds_write_b32 v251, v250
    s_waitcnt lgkmcnt(0)
tk12:
    s_mov_b64 exec, -1
    s_barrier
    ds_read_b32 v252, v251
    s_waitcnt lgkmcnt(0)
    v_readfirstlane_b32 s20, v252
    s_barrier
    s_nop 3
    s_cmp_lt_u32 s20, 12
    s_cbranch_scc1 L_sgo
    s_add_u32 s46, s46, 1
    s_cmp_lt_u32 s46, 6
    s_cselect_b32 s46, s46, 0
    s_sub_u32 s47, s47, 1
    s_cmp_lg_u32 s47, 0
    s_cbranch_scc1 L_sq
    s_branch L_ssm_done
L_sgo:
    s_mul_i32 s46, s46, 12
    s_add_u32 s20, s20, s46
    s_lshl_b32 s20, s20, 3
    v_lshrrev_b32 v5, 6, v0
    s_nop 0
    v_readfirstlane_b32 s21, v5
    v_and_b32 v1, 63, v0
    v_and_b32 v2, 15, v1
    v_lshrrev_b32 v3, 4, v1
    v_lshlrev_b32 v4, 14, v5
    s_mov_b32 s8, s62
    s_mov_b32 s9, s63
    s_mov_b32 s10, 2359296
    s_mov_b32 s11, 0x20000
    s_mov_b32 s16, s76
    s_mov_b32 s17, s77
    s_mov_b32 s18, 4718592
    s_mov_b32 s19, 0x20000
    s_add_u32 s22, s20, s21
    s_lshl_b32 s23, s22, 8
    v_lshlrev_b32 v6, 3, v2
    v_lshl_add_u32 v6, v3, 1, v6
    s_mov_b32 s12, s64
    s_mov_b32 s13, s65
    s_mov_b32 s14, 147456
    s_mov_b32 s15, 0x20000
    buffer_load_ushort v8, v6, s[12:15], s23 offen offset:0
    buffer_load_ushort v12, v6, s[12:15], s23 offen offset:128
    buffer_load_ushort v16, v6, s[12:15], s23 offen offset:1024
    buffer_load_ushort v20, v6, s[12:15], s23 offen offset:1152
    s_mov_b32 s12, s66
    s_mov_b32 s13, s67
    s_mov_b32 s14, 147456
    s_mov_b32 s15, 0x20000
    buffer_load_ushort v9, v6, s[12:15], s23 offen offset:0
    buffer_load_ushort v13, v6, s[12:15], s23 offen offset:128
    buffer_load_ushort v17, v6, s[12:15], s23 offen offset:1024
    buffer_load_ushort v21, v6, s[12:15], s23 offen offset:1152
    s_mov_b32 s12, s68
    s_mov_b32 s13, s69
    s_mov_b32 s14, 147456
    s_mov_b32 s15, 0x20000
    buffer_load_ushort v10, v6, s[12:15], s23 offen offset:0
    buffer_load_ushort v14, v6, s[12:15], s23 offen offset:128
    buffer_load_ushort v18, v6, s[12:15], s23 offen offset:1024
    buffer_load_ushort v22, v6, s[12:15], s23 offen offset:1152
    s_mov_b32 s12, s70
    s_mov_b32 s13, s71
    s_mov_b32 s14, 147456
    s_mov_b32 s15, 0x20000
    buffer_load_ushort v11, v6, s[12:15], s23 offen offset:0
    buffer_load_ushort v15, v6, s[12:15], s23 offen offset:128
    buffer_load_ushort v19, v6, s[12:15], s23 offen offset:1024
    buffer_load_ushort v23, v6, s[12:15], s23 offen offset:1152
    s_mov_b32 s12, s72
    s_mov_b32 s13, s73
    s_mov_b32 s14, 1152
    s_mov_b32 s15, 0x20000
    s_lshl_b32 s23, s22, 1
    buffer_load_ushort v24, off, s[12:15], s23
    buffer_load_ushort v25, off, s[12:15], s23 offset:8
    v_mul_u32_u24 v5, 9216, v0
    s_lshl_b32 s22, s20, 1
    s_add_u32 s23, s22, 0
    buffer_load_dwordx4 v[208:211], v5, s[8:11], s23 offen
    s_add_u32 s23, s22, 1152
    buffer_load_dwordx4 v[212:215], v5, s[8:11], s23 offen
    s_add_u32 s23, s22, 2304
    buffer_load_dwordx4 v[216:219], v5, s[8:11], s23 offen
    s_add_u32 s23, s22, 3456
    buffer_load_dwordx4 v[220:223], v5, s[8:11], s23 offen
    s_add_u32 s23, s22, 4608
    buffer_load_dwordx4 v[224:227], v5, s[8:11], s23 offen
    s_add_u32 s23, s22, 5760
    buffer_load_dwordx4 v[228:231], v5, s[8:11], s23 offen
    s_add_u32 s23, s22, 6912
    buffer_load_dwordx4 v[232:235], v5, s[8:11], s23 offen
    s_add_u32 s23, s22, 8064
    buffer_load_dwordx4 v[236:239], v5, s[8:11], s23 offen
    s_mov_b32 s26, 0x3fb8aa3b
    s_mov_b32 s27, 0x3e22f983
    s_mov_b32 s28, 0
    v_cvt_f32_u32 v26, v2
    v_mul_f32 v27, 0x41800000, v26
    s_waitcnt vmcnt(8)
    s_nop 0
ss_pass:
    v_mov_b32 v36, 0
    v_mov_b32 v37, 0
    v_lshl_add_u32 v6, v1, 3, v4
    ds_write_b64 v6, v[36:37] offset:0
    v_lshlrev_b32 v38, 16, v24
    v_mul_f32 v38, s26, v38
    v_exp_f32 v38, v38
    s_nop 0
    v_cvt_pk_bf16_f32 v38, v38, v38
    v_and_b32 v38, 0xffff0000, v38
    v_add_f32 v39, v38, v38
    v_lshlrev_b32 v28, 16, v8
    v_mul_f32 v28, s26, v28
    v_exp_f32 v28, v28
    s_nop 0
    v_cvt_pk_bf16_f32 v28, v28, v28
    v_and_b32 v28, 0xffff0000, v28
    v_mul_f32 v28, v28, v38
    v_mul_f32 v28, s26, v28
    v_sub_f32 v28, 0, v28
    v_lshlrev_b32 v29, 16, v9
    v_mul_f32 v29, v29, v38
    v_mul_f32 v29, s27, v29
    v_lshlrev_b32 v30, 16, v10
    v_mul_f32 v30, v30, v39
    v_lshlrev_b32 v31, 16, v11
    v_mul_f32 v31, v31, v39
    v_lshlrev_b32 v32, 16, v12
    v_mul_f32 v32, s26, v32
    v_exp_f32 v32, v32
    s_nop 0
    v_cvt_pk_bf16_f32 v32, v32, v32
    v_and_b32 v32, 0xffff0000, v32
    v_mul_f32 v32, v32, v38
    v_mul_f32 v32, s26, v32
    v_sub_f32 v32, 0, v32
    v_lshlrev_b32 v33, 16, v13
    v_mul_f32 v33, v33, v38
    v_mul_f32 v33, s27, v33
    v_lshlrev_b32 v34, 16, v14
    v_mul_f32 v34, v34, v39
    v_lshlrev_b32 v35, 16, v15
    v_mul_f32 v35, v35, v39
    v_mov_b64 v[48:49], 0
    v_mov_b64 v[50:51], 0
    v_mov_b64 v[52:53], 0
    v_mov_b64 v[54:55], 0
    v_mov_b64 v[56:57], 0
    v_mov_b64 v[58:59], 0
    v_mov_b64 v[60:61], 0
    v_mov_b64 v[62:63], 0
    s_mov_b32 s25, 0
    s_nop 0
ss_kg:
    v_mov_b64_dpp v[64:65], v[28:29] row_newbcast:0 row_mask:0xf bank_mask:0xf
    v_mov_b64_dpp v[66:67], v[30:31] row_newbcast:0 row_mask:0xf bank_mask:0xf
    v_pk_mul_f32 v[94:95], v[64:65], v[26:27] op_sel_hi:[1,0]
    v_pk_mul_f32 v[96:97], v[64:65], v[26:27] op_sel:[0,1] op_sel_hi:[1,1]
    v_fract_f32 v95, v95
    v_fract_f32 v97, v97
    v_exp_f32 v94, v94
    v_exp_f32 v96, v96
    v_cos_f32 v68, v95
    v_sin_f32 v69, v95
    v_cos_f32 v76, v97
    v_sin_f32 v77, v97
    v_pk_mul_f32 v[68:69], v[68:69], v[94:95] op_sel_hi:[1,0]
    v_pk_mul_f32 v[76:77], v[76:77], v[96:97] op_sel_hi:[1,0]
    v_pk_mul_f32 v[92:93], v[76:77], v[76:77] op_sel:[1,1] op_sel_hi:[0,1]
    v_pk_fma_f32 v[78:79], v[76:77], v[76:77], v[92:93] op_sel:[0,0,0] op_sel_hi:[0,1,1] neg_lo:[0,0,1]
    v_pk_mul_f32 v[94:95], v[68:69], v[68:69] op_sel:[1,1] op_sel_hi:[0,1]
    v_pk_fma_f32 v[70:71], v[68:69], v[68:69], v[94:95] op_sel:[0,0,0] op_sel_hi:[0,1,1] neg_lo:[0,0,1]
    v_pk_mul_f32 v[92:93], v[78:79], v[78:79] op_sel:[1,1] op_sel_hi:[0,1]
    v_pk_fma_f32 v[80:81], v[78:79], v[78:79], v[92:93] op_sel:[0,0,0] op_sel_hi:[0,1,1] neg_lo:[0,0,1]
    v_pk_mul_f32 v[94:95], v[70:71], v[70:71] op_sel:[1,1] op_sel_hi:[0,1]
    v_pk_fma_f32 v[72:73], v[70:71], v[70:71], v[94:95] op_sel:[0,0,0] op_sel_hi:[0,1,1] neg_lo:[0,0,1]
    v_pk_mul_f32 v[92:93], v[80:81], v[80:81] op_sel:[1,1] op_sel_hi:[0,1]
    v_pk_fma_f32 v[82:83], v[80:81], v[80:81], v[92:93] op_sel:[0,0,0] op_sel_hi:[0,1,1] neg_lo:[0,0,1]
    v_pk_mul_f32 v[94:95], v[72:73], v[72:73] op_sel:[1,1] op_sel_hi:[0,1]
    v_pk_fma_f32 v[74:75], v[72:73], v[72:73], v[94:95] op_sel:[0,0,0] op_sel_hi:[0,1,1] neg_lo:[0,0,1]
    v_pk_mul_f32 v[92:93], v[82:83], v[82:83] op_sel:[1,1] op_sel_hi:[0,1]
    v_pk_fma_f32 v[84:85], v[82:83], v[82:83], v[92:93] op_sel:[0,0,0] op_sel_hi:[0,1,1] neg_lo:[0,0,1]
    v_pk_mul_f32 v[94:95], v[66:67], v[76:77] op_sel:[1,1] op_sel_hi:[1,0]
    v_pk_fma_f32 v[86:87], v[66:67], v[76:77], v[94:95] op_sel:[0,0,0] op_sel_hi:[0,1,1] neg_lo:[0,0,1] neg_hi:[1,0,1]
    v_mov_b32_dpp v80, v78 row_ror:8 row_mask:0xf bank_mask:0x3
    v_mov_b32_dpp v81, v79 row_ror:8 row_mask:0xf bank_mask:0x3
    v_mov_b32_dpp v82, v84 row_ror:8 row_mask:0xf bank_mask:0x3
    v_mov_b32_dpp v83, v85 row_ror:8 row_mask:0xf bank_mask:0x3
    v_pk_mul_f32 v[92:93], v[66:67], v[80:81] op_sel:[1,1] op_sel_hi:[1,0]
    v_pk_fma_f32 v[88:89], v[66:67], v[80:81], v[92:93] op_sel:[0,0,0] op_sel_hi:[0,1,1] neg_lo:[0,0,1] neg_hi:[1,0,1]
    v_pk_mul_f32 v[94:95], v[66:67], v[82:83] op_sel:[1,1] op_sel_hi:[1,0]
    v_pk_fma_f32 v[90:91], v[66:67], v[82:83], v[94:95] op_sel:[0,0,0] op_sel_hi:[0,1,1] neg_lo:[0,0,1] neg_hi:[1,0,1]
    v_mfma_f32_16x16x4_f32 v[48:51], v86, v68, v[48:51]
    v_mfma_f32_16x16x4_f32 v[52:55], v88, v70, v[52:55]
    v_mfma_f32_16x16x4_f32 v[56:59], v88, v72, v[56:59]
    v_mfma_f32_16x16x4_f32 v[60:63], v90, v74, v[60:63]
    v_mfma_f32_16x16x4_f32 v[48:51], v87, v69, v[48:51]
    v_mfma_f32_16x16x4_f32 v[52:55], v89, v71, v[52:55]
    v_mfma_f32_16x16x4_f32 v[56:59], v89, v73, v[56:59]
    v_mfma_f32_16x16x4_f32 v[60:63], v91, v75, v[60:63]
    v_mov_b64_dpp v[64:65], v[28:29] row_newbcast:1 row_mask:0xf bank_mask:0xf
    v_mov_b64_dpp v[66:67], v[30:31] row_newbcast:1 row_mask:0xf bank_mask:0xf
    v_pk_mul_f32 v[94:95], v[64:65], v[26:27] op_sel_hi:[1,0]
    v_pk_mul_f32 v[96:97], v[64:65], v[26:27] op_sel:[0,1] op_sel_hi:[1,1]
    v_fract_f32 v95, v95
    v_fract_f32 v97, v97
    v_exp_f32 v94, v94
    v_exp_f32 v96, v96
    v_cos_f32 v68, v95
    v_sin_f32 v69, v95
    v_cos_f32 v76, v97
    v_sin_f32 v77, v97
    v_pk_mul_f32 v[68:69], v[68:69], v[94:95] op_sel_hi:[1,0]
    v_pk_mul_f32 v[76:77], v[76:77], v[96:97] op_sel_hi:[1,0]
    v_pk_mul_f32 v[92:93], v[76:77], v[76:77] op_sel:[1,1] op_sel_hi:[0,1]
    v_pk_fma_f32 v[78:79], v[76:77], v[76:77], v[92:93] op_sel:[0,0,0] op_sel_hi:[0,1,1] neg_lo:[0,0,1]
    v_pk_mul_f32 v[94:95], v[68:69], v[68:69] op_sel:[1,1] op_sel_hi:[0,1]
    v_pk_fma_f32 v[70:71], v[68:69], v[68:69], v[94:95] op_sel:[0,0,0] op_sel_hi:[0,1,1] neg_lo:[0,0,1]
    v_pk_mul_f32 v[92:93], v[78:79], v[78:79] op_sel:[1,1] op_sel_hi:[0,1]
    v_pk_fma_f32 v[80:81], v[78:79], v[78:79], v[92:93] op_sel:[0,0,0] op_sel_hi:[0,1,1] neg_lo:[0,0,1]
    v_pk_mul_f32 v[94:95], v[70:71], v[70:71] op_sel:[1,1] op_sel_hi:[0,1]
    v_pk_fma_f32 v[72:73], v[70:71], v[70:71], v[94:95] op_sel:[0,0,0] op_sel_hi:[0,1,1] neg_lo:[0,0,1]
    v_pk_mul_f32 v[92:93], v[80:81], v[80:81] op_sel:[1,1] op_sel_hi:[0,1]
    v_pk_fma_f32 v[82:83], v[80:81], v[80:81], v[92:93] op_sel:[0,0,0] op_sel_hi:[0,1,1] neg_lo:[0,0,1]
    v_pk_mul_f32 v[94:95], v[72:73], v[72:73] op_sel:[1,1] op_sel_hi:[0,1]
    v_pk_fma_f32 v[74:75], v[72:73], v[72:73], v[94:95] op_sel:[0,0,0] op_sel_hi:[0,1,1] neg_lo:[0,0,1]
    v_pk_mul_f32 v[92:93], v[82:83], v[82:83] op_sel:[1,1] op_sel_hi:[0,1]
    v_pk_fma_f32 v[84:85], v[82:83], v[82:83], v[92:93] op_sel:[0,0,0] op_sel_hi:[0,1,1] neg_lo:[0,0,1]
    v_pk_mul_f32 v[94:95], v[66:67], v[76:77] op_sel:[1,1] op_sel_hi:[1,0]
    v_pk_fma_f32 v[86:87], v[66:67], v[76:77], v[94:95] op_sel:[0,0,0] op_sel_hi:[0,1,1] neg_lo:[0,0,1] neg_hi:[1,0,1]
    v_mov_b32_dpp v80, v78 row_ror:8 row_mask:0xf bank_mask:0x3
    v_mov_b32_dpp v81, v79 row_ror:8 row_mask:0xf bank_mask:0x3
    v_mov_b32_dpp v82, v84 row_ror:8 row_mask:0xf bank_mask:0x3
    v_mov_b32_dpp v83, v85 row_ror:8 row_mask:0xf bank_mask:0x3
    v_pk_mul_f32 v[92:93], v[66:67], v[80:81] op_sel:[1,1] op_sel_hi:[1,0]
    v_pk_fma_f32 v[88:89], v[66:67], v[80:81], v[92:93] op_sel:[0,0,0] op_sel_hi:[0,1,1] neg_lo:[0,0,1] neg_hi:[1,0,1]
    v_pk_mul_f32 v[94:95], v[66:67], v[82:83] op_sel:[1,1] op_sel_hi:[1,0]
    v_pk_fma_f32 v[90:91], v[66:67], v[82:83], v[94:95] op_sel:[0,0,0] op_sel_hi:[0,1,1] neg_lo:[0,0,1] neg_hi:[1,0,1]
    v_mfma_f32_16x16x4_f32 v[48:51], v86, v68, v[48:51]
    v_mfma_f32_16x16x4_f32 v[52:55], v88, v70, v[52:55]
    v_mfma_f32_16x16x4_f32 v[56:59], v88, v72, v[56:59]
    v_mfma_f32_16x16x4_f32 v[60:63], v90, v74, v[60:63]
    v_mfma_f32_16x16x4_f32 v[48:51], v87, v69, v[48:51]
    v_mfma_f32_16x16x4_f32 v[52:55], v89, v71, v[52:55]
    v_mfma_f32_16x16x4_f32 v[56:59], v89, v73, v[56:59]
    v_mfma_f32_16x16x4_f32 v[60:63], v91, v75, v[60:63]
    v_mov_b64_dpp v[64:65], v[28:29] row_newbcast:2 row_mask:0xf bank_mask:0xf
    v_mov_b64_dpp v[66:67], v[30:31] row_newbcast:2 row_mask:0xf bank_mask:0xf
    v_pk_mul_f32 v[94:95], v[64:65], v[26:27] op_sel_hi:[1,0]
    v_pk_mul_f32 v[96:97], v[64:65], v[26:27] op_sel:[0,1] op_sel_hi:[1,1]
    v_fract_f32 v95, v95
    v_fract_f32 v97, v97
    v_exp_f32 v94, v94
    v_exp_f32 v96, v96
    v_cos_f32 v68, v95
    v_sin_f32 v69, v95
    v_cos_f32 v76, v97
    v_sin_f32 v77, v97
    v_pk_mul_f32 v[68:69], v[68:69], v[94:95] op_sel_hi:[1,0]
    v_pk_mul_f32 v[76:77], v[76:77], v[96:97] op_sel_hi:[1,0]
    v_pk_mul_f32 v[92:93], v[76:77], v[76:77] op_sel:[1,1] op_sel_hi:[0,1]
    v_pk_fma_f32 v[78:79], v[76:77], v[76:77], v[92:93] op_sel:[0,0,0] op_sel_hi:[0,1,1] neg_lo:[0,0,1]
    v_pk_mul_f32 v[94:95], v[68:69], v[68:69] op_sel:[1,1] op_sel_hi:[0,1]
    v_pk_fma_f32 v[70:71], v[68:69], v[68:69], v[94:95] op_sel:[0,0,0] op_sel_hi:[0,1,1] neg_lo:[0,0,1]
    v_pk_mul_f32 v[92:93], v[78:79], v[78:79] op_sel:[1,1] op_sel_hi:[0,1]
    v_pk_fma_f32 v[80:81], v[78:79], v[78:79], v[92:93] op_sel:[0,0,0] op_sel_hi:[0,1,1] neg_lo:[0,0,1]
    v_pk_mul_f32 v[94:95], v[70:71], v[70:71] op_sel:[1,1] op_sel_hi:[0,1]
    v_pk_fma_f32 v[72:73], v[70:71], v[70:71], v[94:95] op_sel:[0,0,0] op_sel_hi:[0,1,1] neg_lo:[0,0,1]
    v_pk_mul_f32 v[92:93], v[80:81], v[80:81] op_sel:[1,1] op_sel_hi:[0,1]
    v_pk_fma_f32 v[82:83], v[80:81], v[80:81], v[92:93] op_sel:[0,0,0] op_sel_hi:[0,1,1] neg_lo:[0,0,1]
    v_pk_mul_f32 v[94:95], v[72:73], v[72:73] op_sel:[1,1] op_sel_hi:[0,1]
    v_pk_fma_f32 v[74:75], v[72:73], v[72:73], v[94:95] op_sel:[0,0,0] op_sel_hi:[0,1,1] neg_lo:[0,0,1]
    v_pk_mul_f32 v[92:93], v[82:83], v[82:83] op_sel:[1,1] op_sel_hi:[0,1]
    v_pk_fma_f32 v[84:85], v[82:83], v[82:83], v[92:93] op_sel:[0,0,0] op_sel_hi:[0,1,1] neg_lo:[0,0,1]
    v_pk_mul_f32 v[94:95], v[66:67], v[76:77] op_sel:[1,1] op_sel_hi:[1,0]
    v_pk_fma_f32 v[86:87], v[66:67], v[76:77], v[94:95] op_sel:[0,0,0] op_sel_hi:[0,1,1] neg_lo:[0,0,1] neg_hi:[1,0,1]
    v_mov_b32_dpp v80, v78 row_ror:8 row_mask:0xf bank_mask:0x3
    v_mov_b32_dpp v81, v79 row_ror:8 row_mask:0xf bank_mask:0x3
    v_mov_b32_dpp v82, v84 row_ror:8 row_mask:0xf bank_mask:0x3
    v_mov_b32_dpp v83, v85 row_ror:8 row_mask:0xf bank_mask:0x3
    v_pk_mul_f32 v[92:93], v[66:67], v[80:81] op_sel:[1,1] op_sel_hi:[1,0]
    v_pk_fma_f32 v[88:89], v[66:67], v[80:81], v[92:93] op_sel:[0,0,0] op_sel_hi:[0,1,1] neg_lo:[0,0,1] neg_hi:[1,0,1]
    v_pk_mul_f32 v[94:95], v[66:67], v[82:83] op_sel:[1,1] op_sel_hi:[1,0]
    v_pk_fma_f32 v[90:91], v[66:67], v[82:83], v[94:95] op_sel:[0,0,0] op_sel_hi:[0,1,1] neg_lo:[0,0,1] neg_hi:[1,0,1]
    v_mfma_f32_16x16x4_f32 v[48:51], v86, v68, v[48:51]
    v_mfma_f32_16x16x4_f32 v[52:55], v88, v70, v[52:55]
    v_mfma_f32_16x16x4_f32 v[56:59], v88, v72, v[56:59]
    v_mfma_f32_16x16x4_f32 v[60:63], v90, v74, v[60:63]
    v_mfma_f32_16x16x4_f32 v[48:51], v87, v69, v[48:51]
    v_mfma_f32_16x16x4_f32 v[52:55], v89, v71, v[52:55]
    v_mfma_f32_16x16x4_f32 v[56:59], v89, v73, v[56:59]
    v_mfma_f32_16x16x4_f32 v[60:63], v91, v75, v[60:63]
    v_mov_b64_dpp v[64:65], v[28:29] row_newbcast:3 row_mask:0xf bank_mask:0xf
    v_mov_b64_dpp v[66:67], v[30:31] row_newbcast:3 row_mask:0xf bank_mask:0xf
    v_pk_mul_f32 v[94:95], v[64:65], v[26:27] op_sel_hi:[1,0]
    v_pk_mul_f32 v[96:97], v[64:65], v[26:27] op_sel:[0,1] op_sel_hi:[1,1]
    v_fract_f32 v95, v95
    v_fract_f32 v97, v97
    v_exp_f32 v94, v94
    v_exp_f32 v96, v96
    v_cos_f32 v68, v95
    v_sin_f32 v69, v95
    v_cos_f32 v76, v97
    v_sin_f32 v77, v97
    v_pk_mul_f32 v[68:69], v[68:69], v[94:95] op_sel_hi:[1,0]
    v_pk_mul_f32 v[76:77], v[76:77], v[96:97] op_sel_hi:[1,0]
    v_pk_mul_f32 v[92:93], v[76:77], v[76:77] op_sel:[1,1] op_sel_hi:[0,1]
    v_pk_fma_f32 v[78:79], v[76:77], v[76:77], v[92:93] op_sel:[0,0,0] op_sel_hi:[0,1,1] neg_lo:[0,0,1]
    v_pk_mul_f32 v[94:95], v[68:69], v[68:69] op_sel:[1,1] op_sel_hi:[0,1]
    v_pk_fma_f32 v[70:71], v[68:69], v[68:69], v[94:95] op_sel:[0,0,0] op_sel_hi:[0,1,1] neg_lo:[0,0,1]
    v_pk_mul_f32 v[92:93], v[78:79], v[78:79] op_sel:[1,1] op_sel_hi:[0,1]
    v_pk_fma_f32 v[80:81], v[78:79], v[78:79], v[92:93] op_sel:[0,0,0] op_sel_hi:[0,1,1] neg_lo:[0,0,1]
    v_pk_mul_f32 v[94:95], v[70:71], v[70:71] op_sel:[1,1] op_sel_hi:[0,1]
    v_pk_fma_f32 v[72:73], v[70:71], v[70:71], v[94:95] op_sel:[0,0,0] op_sel_hi:[0,1,1] neg_lo:[0,0,1]
    v_pk_mul_f32 v[92:93], v[80:81], v[80:81] op_sel:[1,1] op_sel_hi:[0,1]
    v_pk_fma_f32 v[82:83], v[80:81], v[80:81], v[92:93] op_sel:[0,0,0] op_sel_hi:[0,1,1] neg_lo:[0,0,1]
    v_pk_mul_f32 v[94:95], v[72:73], v[72:73] op_sel:[1,1] op_sel_hi:[0,1]
    v_pk_fma_f32 v[74:75], v[72:73], v[72:73], v[94:95] op_sel:[0,0,0] op_sel_hi:[0,1,1] neg_lo:[0,0,1]
    v_pk_mul_f32 v[92:93], v[82:83], v[82:83] op_sel:[1,1] op_sel_hi:[0,1]
    v_pk_fma_f32 v[84:85], v[82:83], v[82:83], v[92:93] op_sel:[0,0,0] op_sel_hi:[0,1,1] neg_lo:[0,0,1]
    v_pk_mul_f32 v[94:95], v[66:67], v[76:77] op_sel:[1,1] op_sel_hi:[1,0]
    v_pk_fma_f32 v[86:87], v[66:67], v[76:77], v[94:95] op_sel:[0,0,0] op_sel_hi:[0,1,1] neg_lo:[0,0,1] neg_hi:[1,0,1]
    v_mov_b32_dpp v80, v78 row_ror:8 row_mask:0xf bank_mask:0x3
    v_mov_b32_dpp v81, v79 row_ror:8 row_mask:0xf bank_mask:0x3
    v_mov_b32_dpp v82, v84 row_ror:8 row_mask:0xf bank_mask:0x3
    v_mov_b32_dpp v83, v85 row_ror:8 row_mask:0xf bank_mask:0x3
    v_pk_mul_f32 v[92:93], v[66:67], v[80:81] op_sel:[1,1] op_sel_hi:[1,0]
    v_pk_fma_f32 v[88:89], v[66:67], v[80:81], v[92:93] op_sel:[0,0,0] op_sel_hi:[0,1,1] neg_lo:[0,0,1] neg_hi:[1,0,1]
    v_pk_mul_f32 v[94:95], v[66:67], v[82:83] op_sel:[1,1] op_sel_hi:[1,0]
    v_pk_fma_f32 v[90:91], v[66:67], v[82:83], v[94:95] op_sel:[0,0,0] op_sel_hi:[0,1,1] neg_lo:[0,0,1] neg_hi:[1,0,1]
    v_mfma_f32_16x16x4_f32 v[48:51], v86, v68, v[48:51]
    v_mfma_f32_16x16x4_f32 v[52:55], v88, v70, v[52:55]
    v_mfma_f32_16x16x4_f32 v[56:59], v88, v72, v[56:59]
    v_mfma_f32_16x16x4_f32 v[60:63], v90, v74, v[60:63]
    v_mfma_f32_16x16x4_f32 v[48:51], v87, v69, v[48:51]
    v_mfma_f32_16x16x4_f32 v[52:55], v89, v71, v[52:55]
    v_mfma_f32_16x16x4_f32 v[56:59], v89, v73, v[56:59]
    v_mfma_f32_16x16x4_f32 v[60:63], v91, v75, v[60:63]
    v_mov_b64_dpp v[64:65], v[28:29] row_newbcast:4 row_mask:0xf bank_mask:0xf
    v_mov_b64_dpp v[66:67], v[30:31] row_newbcast:4 row_mask:0xf bank_mask:0xf
    v_pk_mul_f32 v[94:95], v[64:65], v[26:27] op_sel_hi:[1,0]
    v_pk_mul_f32 v[96:97], v[64:65], v[26:27] op_sel:[0,1] op_sel_hi:[1,1]
    v_fract_f32 v95, v95
    v_fract_f32 v97, v97
    v_exp_f32 v94, v94
    v_exp_f32 v96, v96
    v_cos_f32 v68, v95
    v_sin_f32 v69, v95
    v_cos_f32 v76, v97
    v_sin_f32 v77, v97
    v_pk_mul_f32 v[68:69], v[68:69], v[94:95] op_sel_hi:[1,0]
    v_pk_mul_f32 v[76:77], v[76:77], v[96:97] op_sel_hi:[1,0]
    v_pk_mul_f32 v[92:93], v[76:77], v[76:77] op_sel:[1,1] op_sel_hi:[0,1]
    v_pk_fma_f32 v[78:79], v[76:77], v[76:77], v[92:93] op_sel:[0,0,0] op_sel_hi:[0,1,1] neg_lo:[0,0,1]
    v_pk_mul_f32 v[94:95], v[68:69], v[68:69] op_sel:[1,1] op_sel_hi:[0,1]
    v_pk_fma_f32 v[70:71], v[68:69], v[68:69], v[94:95] op_sel:[0,0,0] op_sel_hi:[0,1,1] neg_lo:[0,0,1]
    v_pk_mul_f32 v[92:93], v[78:79], v[78:79] op_sel:[1,1] op_sel_hi:[0,1]
    v_pk_fma_f32 v[80:81], v[78:79], v[78:79], v[92:93] op_sel:[0,0,0] op_sel_hi:[0,1,1] neg_lo:[0,0,1]
    v_pk_mul_f32 v[94:95], v[70:71], v[70:71] op_sel:[1,1] op_sel_hi:[0,1]
    v_pk_fma_f32 v[72:73], v[70:71], v[70:71], v[94:95] op_sel:[0,0,0] op_sel_hi:[0,1,1] neg_lo:[0,0,1]
    v_pk_mul_f32 v[92:93], v[80:81], v[80:81] op_sel:[1,1] op_sel_hi:[0,1]
    v_pk_fma_f32 v[82:83], v[80:81], v[80:81], v[92:93] op_sel:[0,0,0] op_sel_hi:[0,1,1] neg_lo:[0,0,1]
    v_pk_mul_f32 v[94:95], v[72:73], v[72:73] op_sel:[1,1] op_sel_hi:[0,1]
    v_pk_fma_f32 v[74:75], v[72:73], v[72:73], v[94:95] op_sel:[0,0,0] op_sel_hi:[0,1,1] neg_lo:[0,0,1]
    v_pk_mul_f32 v[92:93], v[82:83], v[82:83] op_sel:[1,1] op_sel_hi:[0,1]
    v_pk_fma_f32 v[84:85], v[82:83], v[82:83], v[92:93] op_sel:[0,0,0] op_sel_hi:[0,1,1] neg_lo:[0,0,1]
    v_pk_mul_f32 v[94:95], v[66:67], v[76:77] op_sel:[1,1] op_sel_hi:[1,0]
    v_pk_fma_f32 v[86:87], v[66:67], v[76:77], v[94:95] op_sel:[0,0,0] op_sel_hi:[0,1,1] neg_lo:[0,0,1] neg_hi:[1,0,1]
    v_mov_b32_dpp v80, v78 row_ror:8 row_mask:0xf bank_mask:0x3
    v_mov_b32_dpp v81, v79 row_ror:8 row_mask:0xf bank_mask:0x3
    v_mov_b32_dpp v82, v84 row_ror:8 row_mask:0xf bank_mask:0x3
    v_mov_b32_dpp v83, v85 row_ror:8 row_mask:0xf bank_mask:0x3
    v_pk_mul_f32 v[92:93], v[66:67], v[80:81] op_sel:[1,1] op_sel_hi:[1,0]
    v_pk_fma_f32 v[88:89], v[66:67], v[80:81], v[92:93] op_sel:[0,0,0] op_sel_hi:[0,1,1] neg_lo:[0,0,1] neg_hi:[1,0,1]
    v_pk_mul_f32 v[94:95], v[66:67], v[82:83] op_sel:[1,1] op_sel_hi:[1,0]
    v_pk_fma_f32 v[90:91], v[66:67], v[82:83], v[94:95] op_sel:[0,0,0] op_sel_hi:[0,1,1] neg_lo:[0,0,1] neg_hi:[1,0,1]
    v_mfma_f32_16x16x4_f32 v[48:51], v86, v68, v[48:51]
    v_mfma_f32_16x16x4_f32 v[52:55], v88, v70, v[52:55]
    v_mfma_f32_16x16x4_f32 v[56:59], v88, v72, v[56:59]
    v_mfma_f32_16x16x4_f32 v[60:63], v90, v74, v[60:63]
    v_mfma_f32_16x16x4_f32 v[48:51], v87, v69, v[48:51]
    v_mfma_f32_16x16x4_f32 v[52:55], v89, v71, v[52:55]
    v_mfma_f32_16x16x4_f32 v[56:59], v89, v73, v[56:59]
    v_mfma_f32_16x16x4_f32 v[60:63], v91, v75, v[60:63]
    v_mov_b64_dpp v[64:65], v[28:29] row_newbcast:5 row_mask:0xf bank_mask:0xf
    v_mov_b64_dpp v[66:67], v[30:31] row_newbcast:5 row_mask:0xf bank_mask:0xf
    v_pk_mul_f32 v[94:95], v[64:65], v[26:27] op_sel_hi:[1,0]
    v_pk_mul_f32 v[96:97], v[64:65], v[26:27] op_sel:[0,1] op_sel_hi:[1,1]
    v_fract_f32 v95, v95
    v_fract_f32 v97, v97
    v_exp_f32 v94, v94
    v_exp_f32 v96, v96
    v_cos_f32 v68, v95
    v_sin_f32 v69, v95
    v_cos_f32 v76, v97
    v_sin_f32 v77, v97
    v_pk_mul_f32 v[68:69], v[68:69], v[94:95] op_sel_hi:[1,0]
    v_pk_mul_f32 v[76:77], v[76:77], v[96:97] op_sel_hi:[1,0]
    v_pk_mul_f32 v[92:93], v[76:77], v[76:77] op_sel:[1,1] op_sel_hi:[0,1]
    v_pk_fma_f32 v[78:79], v[76:77], v[76:77], v[92:93] op_sel:[0,0,0] op_sel_hi:[0,1,1] neg_lo:[0,0,1]
    v_pk_mul_f32 v[94:95], v[68:69], v[68:69] op_sel:[1,1] op_sel_hi:[0,1]
    v_pk_fma_f32 v[70:71], v[68:69], v[68:69], v[94:95] op_sel:[0,0,0] op_sel_hi:[0,1,1] neg_lo:[0,0,1]
    v_pk_mul_f32 v[92:93], v[78:79], v[78:79] op_sel:[1,1] op_sel_hi:[0,1]
    v_pk_fma_f32 v[80:81], v[78:79], v[78:79], v[92:93] op_sel:[0,0,0] op_sel_hi:[0,1,1] neg_lo:[0,0,1]
    v_pk_mul_f32 v[94:95], v[70:71], v[70:71] op_sel:[1,1] op_sel_hi:[0,1]
    v_pk_fma_f32 v[72:73], v[70:71], v[70:71], v[94:95] op_sel:[0,0,0] op_sel_hi:[0,1,1] neg_lo:[0,0,1]
    v_pk_mul_f32 v[92:93], v[80:81], v[80:81] op_sel:[1,1] op_sel_hi:[0,1]
    v_pk_fma_f32 v[82:83], v[80:81], v[80:81], v[92:93] op_sel:[0,0,0] op_sel_hi:[0,1,1] neg_lo:[0,0,1]
    v_pk_mul_f32 v[94:95], v[72:73], v[72:73] op_sel:[1,1] op_sel_hi:[0,1]
    v_pk_fma_f32 v[74:75], v[72:73], v[72:73], v[94:95] op_sel:[0,0,0] op_sel_hi:[0,1,1] neg_lo:[0,0,1]
    v_pk_mul_f32 v[92:93], v[82:83], v[82:83] op_sel:[1,1] op_sel_hi:[0,1]
    v_pk_fma_f32 v[84:85], v[82:83], v[82:83], v[92:93] op_sel:[0,0,0] op_sel_hi:[0,1,1] neg_lo:[0,0,1]
    v_pk_mul_f32 v[94:95], v[66:67], v[76:77] op_sel:[1,1] op_sel_hi:[1,0]
    v_pk_fma_f32 v[86:87], v[66:67], v[76:77], v[94:95] op_sel:[0,0,0] op_sel_hi:[0,1,1] neg_lo:[0,0,1] neg_hi:[1,0,1]
    v_mov_b32_dpp v80, v78 row_ror:8 row_mask:0xf bank_mask:0x3
    v_mov_b32_dpp v81, v79 row_ror:8 row_mask:0xf bank_mask:0x3
    v_mov_b32_dpp v82, v84 row_ror:8 row_mask:0xf bank_mask:0x3
    v_mov_b32_dpp v83, v85 row_ror:8 row_mask:0xf bank_mask:0x3
    v_pk_mul_f32 v[92:93], v[66:67], v[80:81] op_sel:[1,1] op_sel_hi:[1,0]
    v_pk_fma_f32 v[88:89], v[66:67], v[80:81], v[92:93] op_sel:[0,0,0] op_sel_hi:[0,1,1] neg_lo:[0,0,1] neg_hi:[1,0,1]
    v_pk_mul_f32 v[94:95], v[66:67], v[82:83] op_sel:[1,1] op_sel_hi:[1,0]
    v_pk_fma_f32 v[90:91], v[66:67], v[82:83], v[94:95] op_sel:[0,0,0] op_sel_hi:[0,1,1] neg_lo:[0,0,1] neg_hi:[1,0,1]
    v_mfma_f32_16x16x4_f32 v[48:51], v86, v68, v[48:51]
    v_mfma_f32_16x16x4_f32 v[52:55], v88, v70, v[52:55]
    v_mfma_f32_16x16x4_f32 v[56:59], v88, v72, v[56:59]
    v_mfma_f32_16x16x4_f32 v[60:63], v90, v74, v[60:63]
    v_mfma_f32_16x16x4_f32 v[48:51], v87, v69, v[48:51]
    v_mfma_f32_16x16x4_f32 v[52:55], v89, v71, v[52:55]
    v_mfma_f32_16x16x4_f32 v[56:59], v89, v73, v[56:59]
    v_mfma_f32_16x16x4_f32 v[60:63], v91, v75, v[60:63]
    v_mov_b64_dpp v[64:65], v[28:29] row_newbcast:6 row_mask:0xf bank_mask:0xf
    v_mov_b64_dpp v[66:67], v[30:31] row_newbcast:6 row_mask:0xf bank_mask:0xf
    v_pk_mul_f32 v[94:95], v[64:65], v[26:27] op_sel_hi:[1,0]
    v_pk_mul_f32 v[96:97], v[64:65], v[26:27] op_sel:[0,1] op_sel_hi:[1,1]
    v_fract_f32 v95, v95
    v_fract_f32 v97, v97
    v_exp_f32 v94, v94
    v_exp_f32 v96, v96
    v_cos_f32 v68, v95
    v_sin_f32 v69, v95
    v_cos_f32 v76, v97
    v_sin_f32 v77, v97
    v_pk_mul_f32 v[68:69], v[68:69], v[94:95] op_sel_hi:[1,0]
    v_pk_mul_f32 v[76:77], v[76:77], v[96:97] op_sel_hi:[1,0]
    v_pk_mul_f32 v[92:93], v[76:77], v[76:77] op_sel:[1,1] op_sel_hi:[0,1]
    v_pk_fma_f32 v[78:79], v[76:77], v[76:77], v[92:93] op_sel:[0,0,0] op_sel_hi:[0,1,1] neg_lo:[0,0,1]
    v_pk_mul_f32 v[94:95], v[68:69], v[68:69] op_sel:[1,1] op_sel_hi:[0,1]
    v_pk_fma_f32 v[70:71], v[68:69], v[68:69], v[94:95] op_sel:[0,0,0] op_sel_hi:[0,1,1] neg_lo:[0,0,1]
    v_pk_mul_f32 v[92:93], v[78:79], v[78:79] op_sel:[1,1] op_sel_hi:[0,1]
    v_pk_fma_f32 v[80:81], v[78:79], v[78:79], v[92:93] op_sel:[0,0,0] op_sel_hi:[0,1,1] neg_lo:[0,0,1]
    v_pk_mul_f32 v[94:95], v[70:71], v[70:71] op_sel:[1,1] op_sel_hi:[0,1]
    v_pk_fma_f32 v[72:73], v[70:71], v[70:71], v[94:95] op_sel:[0,0,0] op_sel_hi:[0,1,1] neg_lo:[0,0,1]
    v_pk_mul_f32 v[92:93], v[80:81], v[80:81] op_sel:[1,1] op_sel_hi:[0,1]
    v_pk_fma_f32 v[82:83], v[80:81], v[80:81], v[92:93] op_sel:[0,0,0] op_sel_hi:[0,1,1] neg_lo:[0,0,1]
    v_pk_mul_f32 v[94:95], v[72:73], v[72:73] op_sel:[1,1] op_sel_hi:[0,1]
    v_pk_fma_f32 v[74:75], v[72:73], v[72:73], v[94:95] op_sel:[0,0,0] op_sel_hi:[0,1,1] neg_lo:[0,0,1]
    v_pk_mul_f32 v[92:93], v[82:83], v[82:83] op_sel:[1,1] op_sel_hi:[0,1]
    v_pk_fma_f32 v[84:85], v[82:83], v[82:83], v[92:93] op_sel:[0,0,0] op_sel_hi:[0,1,1] neg_lo:[0,0,1]
    v_pk_mul_f32 v[94:95], v[66:67], v[76:77] op_sel:[1,1] op_sel_hi:[1,0]
    v_pk_fma_f32 v[86:87], v[66:67], v[76:77], v[94:95] op_sel:[0,0,0] op_sel_hi:[0,1,1] neg_lo:[0,0,1] neg_hi:[1,0,1]
    v_mov_b32_dpp v80, v78 row_ror:8 row_mask:0xf bank_mask:0x3
    v_mov_b32_dpp v81, v79 row_ror:8 row_mask:0xf bank_mask:0x3
    v_mov_b32_dpp v82, v84 row_ror:8 row_mask:0xf bank_mask:0x3
    v_mov_b32_dpp v83, v85 row_ror:8 row_mask:0xf bank_mask:0x3
    v_pk_mul_f32 v[92:93], v[66:67], v[80:81] op_sel:[1,1] op_sel_hi:[1,0]
    v_pk_fma_f32 v[88:89], v[66:67], v[80:81], v[92:93] op_sel:[0,0,0] op_sel_hi:[0,1,1] neg_lo:[0,0,1] neg_hi:[1,0,1]
    v_pk_mul_f32 v[94:95], v[66:67], v[82:83] op_sel:[1,1] op_sel_hi:[1,0]
    v_pk_fma_f32 v[90:91], v[66:67], v[82:83], v[94:95] op_sel:[0,0,0] op_sel_hi:[0,1,1] neg_lo:[0,0,1] neg_hi:[1,0,1]
    v_mfma_f32_16x16x4_f32 v[48:51], v86, v68, v[48:51]
    v_mfma_f32_16x16x4_f32 v[52:55], v88, v70, v[52:55]
    v_mfma_f32_16x16x4_f32 v[56:59], v88, v72, v[56:59]
    v_mfma_f32_16x16x4_f32 v[60:63], v90, v74, v[60:63]
    v_mfma_f32_16x16x4_f32 v[48:51], v87, v69, v[48:51]
    v_mfma_f32_16x16x4_f32 v[52:55], v89, v71, v[52:55]
    v_mfma_f32_16x16x4_f32 v[56:59], v89, v73, v[56:59]
    v_mfma_f32_16x16x4_f32 v[60:63], v91, v75, v[60:63]
    v_mov_b64_dpp v[64:65], v[28:29] row_newbcast:7 row_mask:0xf bank_mask:0xf
    v_mov_b64_dpp v[66:67], v[30:31] row_newbcast:7 row_mask:0xf bank_mask:0xf
    v_pk_mul_f32 v[94:95], v[64:65], v[26:27] op_sel_hi:[1,0]
    v_pk_mul_f32 v[96:97], v[64:65], v[26:27] op_sel:[0,1] op_sel_hi:[1,1]
    v_fract_f32 v95, v95
    v_fract_f32 v97, v97
    v_exp_f32 v94, v94
    v_exp_f32 v96, v96
    v_cos_f32 v68, v95
    v_sin_f32 v69, v95
    v_cos_f32 v76, v97
    v_sin_f32 v77, v97
    v_pk_mul_f32 v[68:69], v[68:69], v[94:95] op_sel_hi:[1,0]
    v_pk_mul_f32 v[76:77], v[76:77], v[96:97] op_sel_hi:[1,0]
    v_pk_mul_f32 v[92:93], v[76:77], v[76:77] op_sel:[1,1] op_sel_hi:[0,1]
    v_pk_fma_f32 v[78:79], v[76:77], v[76:77], v[92:93] op_sel:[0,0,0] op_sel_hi:[0,1,1] neg_lo:[0,0,1]
    v_pk_mul_f32 v[94:95], v[68:69], v[68:69] op_sel:[1,1] op_sel_hi:[0,1]
    v_pk_fma_f32 v[70:71], v[68:69], v[68:69], v[94:95] op_sel:[0,0,0] op_sel_hi:[0,1,1] neg_lo:[0,0,1]
    v_pk_mul_f32 v[92:93], v[78:79], v[78:79] op_sel:[1,1] op_sel_hi:[0,1]
    v_pk_fma_f32 v[80:81], v[78:79], v[78:79], v[92:93] op_sel:[0,0,0] op_sel_hi:[0,1,1] neg_lo:[0,0,1]
    v_pk_mul_f32 v[94:95], v[70:71], v[70:71] op_sel:[1,1] op_sel_hi:[0,1]
    v_pk_fma_f32 v[72:73], v[70:71], v[70:71], v[94:95] op_sel:[0,0,0] op_sel_hi:[0,1,1] neg_lo:[0,0,1]
    v_pk_mul_f32 v[92:93], v[80:81], v[80:81] op_sel:[1,1] op_sel_hi:[0,1]
    v_pk_fma_f32 v[82:83], v[80:81], v[80:81], v[92:93] op_sel:[0,0,0] op_sel_hi:[0,1,1] neg_lo:[0,0,1]
    v_pk_mul_f32 v[94:95], v[72:73], v[72:73] op_sel:[1,1] op_sel_hi:[0,1]
    v_pk_fma_f32 v[74:75], v[72:73], v[72:73], v[94:95] op_sel:[0,0,0] op_sel_hi:[0,1,1] neg_lo:[0,0,1]
    v_pk_mul_f32 v[92:93], v[82:83], v[82:83] op_sel:[1,1] op_sel_hi:[0,1]
    v_pk_fma_f32 v[84:85], v[82:83], v[82:83], v[92:93] op_sel:[0,0,0] op_sel_hi:[0,1,1] neg_lo:[0,0,1]
    v_pk_mul_f32 v[94:95], v[66:67], v[76:77] op_sel:[1,1] op_sel_hi:[1,0]
    v_pk_fma_f32 v[86:87], v[66:67], v[76:77], v[94:95] op_sel:[0,0,0] op_sel_hi:[0,1,1] neg_lo:[0,0,1] neg_hi:[1,0,1]
    v_mov_b32_dpp v80, v78 row_ror:8 row_mask:0xf bank_mask:0x3
    v_mov_b32_dpp v81, v79 row_ror:8 row_mask:0xf bank_mask:0x3
    v_mov_b32_dpp v82, v84 row_ror:8 row_mask:0xf bank_mask:0x3
    v_mov_b32_dpp v83, v85 row_ror:8 row_mask:0xf bank_mask:0x3
    v_pk_mul_f32 v[92:93], v[66:67], v[80:81] op_sel:[1,1] op_sel_hi:[1,0]
    v_pk_fma_f32 v[88:89], v[66:67], v[80:81], v[92:93] op_sel:[0,0,0] op_sel_hi:[0,1,1] neg_lo:[0,0,1] neg_hi:[1,0,1]
    v_pk_mul_f32 v[94:95], v[66:67], v[82:83] op_sel:[1,1] op_sel_hi:[1,0]
    v_pk_fma_f32 v[90:91], v[66:67], v[82:83], v[94:95] op_sel:[0,0,0] op_sel_hi:[0,1,1] neg_lo:[0,0,1] neg_hi:[1,0,1]
    v_mfma_f32_16x16x4_f32 v[48:51], v86, v68, v[48:51]
    v_mfma_f32_16x16x4_f32 v[52:55], v88, v70, v[52:55]
    v_mfma_f32_16x16x4_f32 v[56:59], v88, v72, v[56:59]
    v_mfma_f32_16x16x4_f32 v[60:63], v90, v74, v[60:63]
    v_mfma_f32_16x16x4_f32 v[48:51], v87, v69, v[48:51]
    v_mfma_f32_16x16x4_f32 v[52:55], v89, v71, v[52:55]
    v_mfma_f32_16x16x4_f32 v[56:59], v89, v73, v[56:59]
    v_mfma_f32_16x16x4_f32 v[60:63], v91, v75, v[60:63]
    v_mov_b64_dpp v[64:65], v[28:29] row_newbcast:8 row_mask:0xf bank_mask:0xf
    v_mov_b64_dpp v[66:67], v[30:31] row_newbcast:8 row_mask:0xf bank_mask:0xf
    v_pk_mul_f32 v[94:95], v[64:65], v[26:27] op_sel_hi:[1,0]
    v_pk_mul_f32 v[96:97], v[64:65], v[26:27] op_sel:[0,1] op_sel_hi:[1,1]
    v_fract_f32 v95, v95
    v_fract_f32 v97, v97
    v_exp_f32 v94, v94
    v_exp_f32 v96, v96
    v_cos_f32 v68, v95
    v_sin_f32 v69, v95
    v_cos_f32 v76, v97
    v_sin_f32 v77, v97
    v_pk_mul_f32 v[68:69], v[68:69], v[94:95] op_sel_hi:[1,0]
    v_pk_mul_f32 v[76:77], v[76:77], v[96:97] op_sel_hi:[1,0]
    v_pk_mul_f32 v[92:93], v[76:77], v[76:77] op_sel:[1,1] op_sel_hi:[0,1]
    v_pk_fma_f32 v[78:79], v[76:77], v[76:77], v[92:93] op_sel:[0,0,0] op_sel_hi:[0,1,1] neg_lo:[0,0,1]
    v_pk_mul_f32 v[94:95], v[68:69], v[68:69] op_sel:[1,1] op_sel_hi:[0,1]
    v_pk_fma_f32 v[70:71], v[68:69], v[68:69], v[94:95] op_sel:[0,0,0] op_sel_hi:[0,1,1] neg_lo:[0,0,1]
    v_pk_mul_f32 v[92:93], v[78:79], v[78:79] op_sel:[1,1] op_sel_hi:[0,1]
    v_pk_fma_f32 v[80:81], v[78:79], v[78:79], v[92:93] op_sel:[0,0,0] op_sel_hi:[0,1,1] neg_lo:[0,0,1]
    v_pk_mul_f32 v[94:95], v[70:71], v[70:71] op_sel:[1,1] op_sel_hi:[0,1]
    v_pk_fma_f32 v[72:73], v[70:71], v[70:71], v[94:95] op_sel:[0,0,0] op_sel_hi:[0,1,1] neg_lo:[0,0,1]
    v_pk_mul_f32 v[92:93], v[80:81], v[80:81] op_sel:[1,1] op_sel_hi:[0,1]
    v_pk_fma_f32 v[82:83], v[80:81], v[80:81], v[92:93] op_sel:[0,0,0] op_sel_hi:[0,1,1] neg_lo:[0,0,1]
    v_pk_mul_f32 v[94:95], v[72:73], v[72:73] op_sel:[1,1] op_sel_hi:[0,1]
    v_pk_fma_f32 v[74:75], v[72:73], v[72:73], v[94:95] op_sel:[0,0,0] op_sel_hi:[0,1,1] neg_lo:[0,0,1]
    v_pk_mul_f32 v[92:93], v[82:83], v[82:83] op_sel:[1,1] op_sel_hi:[0,1]
    v_pk_fma_f32 v[84:85], v[82:83], v[82:83], v[92:93] op_sel:[0,0,0] op_sel_hi:[0,1,1] neg_lo:[0,0,1]
    v_pk_mul_f32 v[94:95], v[66:67], v[76:77] op_sel:[1,1] op_sel_hi:[1,0]
    v_pk_fma_f32 v[86:87], v[66:67], v[76:77], v[94:95] op_sel:[0,0,0] op_sel_hi:[0,1,1] neg_lo:[0,0,1] neg_hi:[1,0,1]
    v_mov_b32_dpp v80, v78 row_ror:8 row_mask:0xf bank_mask:0x3
    v_mov_b32_dpp v81, v79 row_ror:8 row_mask:0xf bank_mask:0x3
    v_mov_b32_dpp v82, v84 row_ror:8 row_mask:0xf bank_mask:0x3
    v_mov_b32_dpp v83, v85 row_ror:8 row_mask:0xf bank_mask:0x3
    v_pk_mul_f32 v[92:93], v[66:67], v[80:81] op_sel:[1,1] op_sel_hi:[1,0]
    v_pk_fma_f32 v[88:89], v[66:67], v[80:81], v[92:93] op_sel:[0,0,0] op_sel_hi:[0,1,1] neg_lo:[0,0,1] neg_hi:[1,0,1]
    v_pk_mul_f32 v[94:95], v[66:67], v[82:83] op_sel:[1,1] op_sel_hi:[1,0]
    v_pk_fma_f32 v[90:91], v[66:67], v[82:83], v[94:95] op_sel:[0,0,0] op_sel_hi:[0,1,1] neg_lo:[0,0,1] neg_hi:[1,0,1]
    v_mfma_f32_16x16x4_f32 v[48:51], v86, v68, v[48:51]
    v_mfma_f32_16x16x4_f32 v[52:55], v88, v70, v[52:55]
    v_mfma_f32_16x16x4_f32 v[56:59], v88, v72, v[56:59]
    v_mfma_f32_16x16x4_f32 v[60:63], v90, v74, v[60:63]
    v_mfma_f32_16x16x4_f32 v[48:51], v87, v69, v[48:51]
    v_mfma_f32_16x16x4_f32 v[52:55], v89, v71, v[52:55]
    v_mfma_f32_16x16x4_f32 v[56:59], v89, v73, v[56:59]
    v_mfma_f32_16x16x4_f32 v[60:63], v91, v75, v[60:63]
    v_mov_b64_dpp v[64:65], v[28:29] row_newbcast:9 row_mask:0xf bank_mask:0xf
    v_mov_b64_dpp v[66:67], v[30:31] row_newbcast:9 row_mask:0xf bank_mask:0xf
    v_pk_mul_f32 v[94:95], v[64:65], v[26:27] op_sel_hi:[1,0]
    v_pk_mul_f32 v[96:97], v[64:65], v[26:27] op_sel:[0,1] op_sel_hi:[1,1]
    v_fract_f32 v95, v95
    v_fract_f32 v97, v97
    v_exp_f32 v94, v94
    v_exp_f32 v96, v96
    v_cos_f32 v68, v95
    v_sin_f32 v69, v95
    v_cos_f32 v76, v97
    v_sin_f32 v77, v97
    v_pk_mul_f32 v[68:69], v[68:69], v[94:95] op_sel_hi:[1,0]
    v_pk_mul_f32 v[76:77], v[76:77], v[96:97] op_sel_hi:[1,0]
    v_pk_mul_f32 v[92:93], v[76:77], v[76:77] op_sel:[1,1] op_sel_hi:[0,1]
    v_pk_fma_f32 v[78:79], v[76:77], v[76:77], v[92:93] op_sel:[0,0,0] op_sel_hi:[0,1,1] neg_lo:[0,0,1]
    v_pk_mul_f32 v[94:95], v[68:69], v[68:69] op_sel:[1,1] op_sel_hi:[0,1]
    v_pk_fma_f32 v[70:71], v[68:69], v[68:69], v[94:95] op_sel:[0,0,0] op_sel_hi:[0,1,1] neg_lo:[0,0,1]
    v_pk_mul_f32 v[92:93], v[78:79], v[78:79] op_sel:[1,1] op_sel_hi:[0,1]
    v_pk_fma_f32 v[80:81], v[78:79], v[78:79], v[92:93] op_sel:[0,0,0] op_sel_hi:[0,1,1] neg_lo:[0,0,1]
    v_pk_mul_f32 v[94:95], v[70:71], v[70:71] op_sel:[1,1] op_sel_hi:[0,1]
    v_pk_fma_f32 v[72:73], v[70:71], v[70:71], v[94:95] op_sel:[0,0,0] op_sel_hi:[0,1,1] neg_lo:[0,0,1]
    v_pk_mul_f32 v[92:93], v[80:81], v[80:81] op_sel:[1,1] op_sel_hi:[0,1]
    v_pk_fma_f32 v[82:83], v[80:81], v[80:81], v[92:93] op_sel:[0,0,0] op_sel_hi:[0,1,1] neg_lo:[0,0,1]
    v_pk_mul_f32 v[94:95], v[72:73], v[72:73] op_sel:[1,1] op_sel_hi:[0,1]
    v_pk_fma_f32 v[74:75], v[72:73], v[72:73], v[94:95] op_sel:[0,0,0] op_sel_hi:[0,1,1] neg_lo:[0,0,1]
    v_pk_mul_f32 v[92:93], v[82:83], v[82:83] op_sel:[1,1] op_sel_hi:[0,1]
    v_pk_fma_f32 v[84:85], v[82:83], v[82:83], v[92:93] op_sel:[0,0,0] op_sel_hi:[0,1,1] neg_lo:[0,0,1]
    v_pk_mul_f32 v[94:95], v[66:67], v[76:77] op_sel:[1,1] op_sel_hi:[1,0]
    v_pk_fma_f32 v[86:87], v[66:67], v[76:77], v[94:95] op_sel:[0,0,0] op_sel_hi:[0,1,1] neg_lo:[0,0,1] neg_hi:[1,0,1]
    v_mov_b32_dpp v80, v78 row_ror:8 row_mask:0xf bank_mask:0x3
    v_mov_b32_dpp v81, v79 row_ror:8 row_mask:0xf bank_mask:0x3
    v_mov_b32_dpp v82, v84 row_ror:8 row_mask:0xf bank_mask:0x3
    v_mov_b32_dpp v83, v85 row_ror:8 row_mask:0xf bank_mask:0x3
    v_pk_mul_f32 v[92:93], v[66:67], v[80:81] op_sel:[1,1] op_sel_hi:[1,0]
    v_pk_fma_f32 v[88:89], v[66:67], v[80:81], v[92:93] op_sel:[0,0,0] op_sel_hi:[0,1,1] neg_lo:[0,0,1] neg_hi:[1,0,1]
    v_pk_mul_f32 v[94:95], v[66:67], v[82:83] op_sel:[1,1] op_sel_hi:[1,0]
    v_pk_fma_f32 v[90:91], v[66:67], v[82:83], v[94:95] op_sel:[0,0,0] op_sel_hi:[0,1,1] neg_lo:[0,0,1] neg_hi:[1,0,1]
    v_mfma_f32_16x16x4_f32 v[48:51], v86, v68, v[48:51]
    v_mfma_f32_16x16x4_f32 v[52:55], v88, v70, v[52:55]
    v_mfma_f32_16x16x4_f32 v[56:59], v88, v72, v[56:59]
    v_mfma_f32_16x16x4_f32 v[60:63], v90, v74, v[60:63]
    v_mfma_f32_16x16x4_f32 v[48:51], v87, v69, v[48:51]
    v_mfma_f32_16x16x4_f32 v[52:55], v89, v71, v[52:55]
    v_mfma_f32_16x16x4_f32 v[56:59], v89, v73, v[56:59]
    v_mfma_f32_16x16x4_f32 v[60:63], v91, v75, v[60:63]
    v_mov_b64_dpp v[64:65], v[28:29] row_newbcast:10 row_mask:0xf bank_mask:0xf
    v_mov_b64_dpp v[66:67], v[30:31] row_newbcast:10 row_mask:0xf bank_mask:0xf
    v_pk_mul_f32 v[94:95], v[64:65], v[26:27] op_sel_hi:[1,0]
    v_pk_mul_f32 v[96:97], v[64:65], v[26:27] op_sel:[0,1] op_sel_hi:[1,1]
    v_fract_f32 v95, v95
    v_fract_f32 v97, v97
    v_exp_f32 v94, v94
    v_exp_f32 v96, v96
    v_cos_f32 v68, v95
    v_sin_f32 v69, v95
    v_cos_f32 v76, v97
    v_sin_f32 v77, v97
    v_pk_mul_f32 v[68:69], v[68:69], v[94:95] op_sel_hi:[1,0]
    v_pk_mul_f32 v[76:77], v[76:77], v[96:97] op_sel_hi:[1,0]
    v_pk_mul_f32 v[92:93], v[76:77], v[76:77] op_sel:[1,1] op_sel_hi:[0,1]
    v_pk_fma_f32 v[78:79], v[76:77], v[76:77], v[92:93] op_sel:[0,0,0] op_sel_hi:[0,1,1] neg_lo:[0,0,1]
    v_pk_mul_f32 v[94:95], v[68:69], v[68:69] op_sel:[1,1] op_sel_hi:[0,1]
    v_pk_fma_f32 v[70:71], v[68:69], v[68:69], v[94:95] op_sel:[0,0,0] op_sel_hi:[0,1,1] neg_lo:[0,0,1]
    v_pk_mul_f32 v[92:93], v[78:79], v[78:79] op_sel:[1,1] op_sel_hi:[0,1]
    v_pk_fma_f32 v[80:81], v[78:79], v[78:79], v[92:93] op_sel:[0,0,0] op_sel_hi:[0,1,1] neg_lo:[0,0,1]
    v_pk_mul_f32 v[94:95], v[70:71], v[70:71] op_sel:[1,1] op_sel_hi:[0,1]
    v_pk_fma_f32 v[72:73], v[70:71], v[70:71], v[94:95] op_sel:[0,0,0] op_sel_hi:[0,1,1] neg_lo:[0,0,1]
    v_pk_mul_f32 v[92:93], v[80:81], v[80:81] op_sel:[1,1] op_sel_hi:[0,1]
    v_pk_fma_f32 v[82:83], v[80:81], v[80:81], v[92:93] op_sel:[0,0,0] op_sel_hi:[0,1,1] neg_lo:[0,0,1]
    v_pk_mul_f32 v[94:95], v[72:73], v[72:73] op_sel:[1,1] op_sel_hi:[0,1]
    v_pk_fma_f32 v[74:75], v[72:73], v[72:73], v[94:95] op_sel:[0,0,0] op_sel_hi:[0,1,1] neg_lo:[0,0,1]
    v_pk_mul_f32 v[92:93], v[82:83], v[82:83] op_sel:[1,1] op_sel_hi:[0,1]
    v_pk_fma_f32 v[84:85], v[82:83], v[82:83], v[92:93] op_sel:[0,0,0] op_sel_hi:[0,1,1] neg_lo:[0,0,1]
    v_pk_mul_f32 v[94:95], v[66:67], v[76:77] op_sel:[1,1] op_sel_hi:[1,0]
    v_pk_fma_f32 v[86:87], v[66:67], v[76:77], v[94:95] op_sel:[0,0,0] op_sel_hi:[0,1,1] neg_lo:[0,0,1] neg_hi:[1,0,1]
    v_mov_b32_dpp v80, v78 row_ror:8 row_mask:0xf bank_mask:0x3
    v_mov_b32_dpp v81, v79 row_ror:8 row_mask:0xf bank_mask:0x3
    v_mov_b32_dpp v82, v84 row_ror:8 row_mask:0xf bank_mask:0x3
    v_mov_b32_dpp v83, v85 row_ror:8 row_mask:0xf bank_mask:0x3
    v_pk_mul_f32 v[92:93], v[66:67], v[80:81] op_sel:[1,1] op_sel_hi:[1,0]
    v_pk_fma_f32 v[88:89], v[66:67], v[80:81], v[92:93] op_sel:[0,0,0] op_sel_hi:[0,1,1] neg_lo:[0,0,1] neg_hi:[1,0,1]
    v_pk_mul_f32 v[94:95], v[66:67], v[82:83] op_sel:[1,1] op_sel_hi:[1,0]
    v_pk_fma_f32 v[90:91], v[66:67], v[82:83], v[94:95] op_sel:[0,0,0] op_sel_hi:[0,1,1] neg_lo:[0,0,1] neg_hi:[1,0,1]
    v_mfma_f32_16x16x4_f32 v[48:51], v86, v68, v[48:51]
    v_mfma_f32_16x16x4_f32 v[52:55], v88, v70, v[52:55]
    v_mfma_f32_16x16x4_f32 v[56:59], v88, v72, v[56:59]
    v_mfma_f32_16x16x4_f32 v[60:63], v90, v74, v[60:63]
    v_mfma_f32_16x16x4_f32 v[48:51], v87, v69, v[48:51]
    v_mfma_f32_16x16x4_f32 v[52:55], v89, v71, v[52:55]
    v_mfma_f32_16x16x4_f32 v[56:59], v89, v73, v[56:59]
    v_mfma_f32_16x16x4_f32 v[60:63], v91, v75, v[60:63]
    v_mov_b64_dpp v[64:65], v[28:29] row_newbcast:11 row_mask:0xf bank_mask:0xf
    v_mov_b64_dpp v[66:67], v[30:31] row_newbcast:11 row_mask:0xf bank_mask:0xf
    v_pk_mul_f32 v[94:95], v[64:65], v[26:27] op_sel_hi:[1,0]
    v_pk_mul_f32 v[96:97], v[64:65], v[26:27] op_sel:[0,1] op_sel_hi:[1,1]
    v_fract_f32 v95, v95
    v_fract_f32 v97, v97
    v_exp_f32 v94, v94
    v_exp_f32 v96, v96
    v_cos_f32 v68, v95
    v_sin_f32 v69, v95
    v_cos_f32 v76, v97
    v_sin_f32 v77, v97
    v_pk_mul_f32 v[68:69], v[68:69], v[94:95] op_sel_hi:[1,0]
    v_pk_mul_f32 v[76:77], v[76:77], v[96:97] op_sel_hi:[1,0]
    v_pk_mul_f32 v[92:93], v[76:77], v[76:77] op_sel:[1,1] op_sel_hi:[0,1]
    v_pk_fma_f32 v[78:79], v[76:77], v[76:77], v[92:93] op_sel:[0,0,0] op_sel_hi:[0,1,1] neg_lo:[0,0,1]
    v_pk_mul_f32 v[94:95], v[68:69], v[68:69] op_sel:[1,1] op_sel_hi:[0,1]
    v_pk_fma_f32 v[70:71], v[68:69], v[68:69], v[94:95] op_sel:[0,0,0] op_sel_hi:[0,1,1] neg_lo:[0,0,1]
    v_pk_mul_f32 v[92:93], v[78:79], v[78:79] op_sel:[1,1] op_sel_hi:[0,1]
    v_pk_fma_f32 v[80:81], v[78:79], v[78:79], v[92:93] op_sel:[0,0,0] op_sel_hi:[0,1,1] neg_lo:[0,0,1]
    v_pk_mul_f32 v[94:95], v[70:71], v[70:71] op_sel:[1,1] op_sel_hi:[0,1]
    v_pk_fma_f32 v[72:73], v[70:71], v[70:71], v[94:95] op_sel:[0,0,0] op_sel_hi:[0,1,1] neg_lo:[0,0,1]
    v_pk_mul_f32 v[92:93], v[80:81], v[80:81] op_sel:[1,1] op_sel_hi:[0,1]
    v_pk_fma_f32 v[82:83], v[80:81], v[80:81], v[92:93] op_sel:[0,0,0] op_sel_hi:[0,1,1] neg_lo:[0,0,1]
    v_pk_mul_f32 v[94:95], v[72:73], v[72:73] op_sel:[1,1] op_sel_hi:[0,1]
    v_pk_fma_f32 v[74:75], v[72:73], v[72:73], v[94:95] op_sel:[0,0,0] op_sel_hi:[0,1,1] neg_lo:[0,0,1]
    v_pk_mul_f32 v[92:93], v[82:83], v[82:83] op_sel:[1,1] op_sel_hi:[0,1]
    v_pk_fma_f32 v[84:85], v[82:83], v[82:83], v[92:93] op_sel:[0,0,0] op_sel_hi:[0,1,1] neg_lo:[0,0,1]
    v_pk_mul_f32 v[94:95], v[66:67], v[76:77] op_sel:[1,1] op_sel_hi:[1,0]
    v_pk_fma_f32 v[86:87], v[66:67], v[76:77], v[94:95] op_sel:[0,0,0] op_sel_hi:[0,1,1] neg_lo:[0,0,1] neg_hi:[1,0,1]
    v_mov_b32_dpp v80, v78 row_ror:8 row_mask:0xf bank_mask:0x3
    v_mov_b32_dpp v81, v79 row_ror:8 row_mask:0xf bank_mask:0x3
    v_mov_b32_dpp v82, v84 row_ror:8 row_mask:0xf bank_mask:0x3
    v_mov_b32_dpp v83, v85 row_ror:8 row_mask:0xf bank_mask:0x3
    v_pk_mul_f32 v[92:93], v[66:67], v[80:81] op_sel:[1,1] op_sel_hi:[1,0]
    v_pk_fma_f32 v[88:89], v[66:67], v[80:81], v[92:93] op_sel:[0,0,0] op_sel_hi:[0,1,1] neg_lo:[0,0,1] neg_hi:[1,0,1]
    v_pk_mul_f32 v[94:95], v[66:67], v[82:83] op_sel:[1,1] op_sel_hi:[1,0]
    v_pk_fma_f32 v[90:91], v[66:67], v[82:83], v[94:95] op_sel:[0,0,0] op_sel_hi:[0,1,1] neg_lo:[0,0,1] neg_hi:[1,0,1]
    v_mfma_f32_16x16x4_f32 v[48:51], v86, v68, v[48:51]
    v_mfma_f32_16x16x4_f32 v[52:55], v88, v70, v[52:55]
    v_mfma_f32_16x16x4_f32 v[56:59], v88, v72, v[56:59]
    v_mfma_f32_16x16x4_f32 v[60:63], v90, v74, v[60:63]
    v_mfma_f32_16x16x4_f32 v[48:51], v87, v69, v[48:51]
    v_mfma_f32_16x16x4_f32 v[52:55], v89, v71, v[52:55]
    v_mfma_f32_16x16x4_f32 v[56:59], v89, v73, v[56:59]
    v_mfma_f32_16x16x4_f32 v[60:63], v91, v75, v[60:63]
    v_mov_b64_dpp v[64:65], v[28:29] row_newbcast:12 row_mask:0xf bank_mask:0xf
    v_mov_b64_dpp v[66:67], v[30:31] row_newbcast:12 row_mask:0xf bank_mask:0xf
    v_pk_mul_f32 v[94:95], v[64:65], v[26:27] op_sel_hi:[1,0]
    v_pk_mul_f32 v[96:97], v[64:65], v[26:27] op_sel:[0,1] op_sel_hi:[1,1]
    v_fract_f32 v95, v95
    v_fract_f32 v97, v97
    v_exp_f32 v94, v94
    v_exp_f32 v96, v96
    v_cos_f32 v68, v95
    v_sin_f32 v69, v95
    v_cos_f32 v76, v97
    v_sin_f32 v77, v97
    v_pk_mul_f32 v[68:69], v[68:69], v[94:95] op_sel_hi:[1,0]
    v_pk_mul_f32 v[76:77], v[76:77], v[96:97] op_sel_hi:[1,0]
    v_pk_mul_f32 v[92:93], v[76:77], v[76:77] op_sel:[1,1] op_sel_hi:[0,1]
    v_pk_fma_f32 v[78:79], v[76:77], v[76:77], v[92:93] op_sel:[0,0,0] op_sel_hi:[0,1,1] neg_lo:[0,0,1]
    v_pk_mul_f32 v[94:95], v[68:69], v[68:69] op_sel:[1,1] op_sel_hi:[0,1]
    v_pk_fma_f32 v[70:71], v[68:69], v[68:69], v[94:95] op_sel:[0,0,0] op_sel_hi:[0,1,1] neg_lo:[0,0,1]
    v_pk_mul_f32 v[92:93], v[78:79], v[78:79] op_sel:[1,1] op_sel_hi:[0,1]
    v_pk_fma_f32 v[80:81], v[78:79], v[78:79], v[92:93] op_sel:[0,0,0] op_sel_hi:[0,1,1] neg_lo:[0,0,1]
    v_pk_mul_f32 v[94:95], v[70:71], v[70:71] op_sel:[1,1] op_sel_hi:[0,1]
    v_pk_fma_f32 v[72:73], v[70:71], v[70:71], v[94:95] op_sel:[0,0,0] op_sel_hi:[0,1,1] neg_lo:[0,0,1]
    v_pk_mul_f32 v[92:93], v[80:81], v[80:81] op_sel:[1,1] op_sel_hi:[0,1]
    v_pk_fma_f32 v[82:83], v[80:81], v[80:81], v[92:93] op_sel:[0,0,0] op_sel_hi:[0,1,1] neg_lo:[0,0,1]
    v_pk_mul_f32 v[94:95], v[72:73], v[72:73] op_sel:[1,1] op_sel_hi:[0,1]
    v_pk_fma_f32 v[74:75], v[72:73], v[72:73], v[94:95] op_sel:[0,0,0] op_sel_hi:[0,1,1] neg_lo:[0,0,1]
    v_pk_mul_f32 v[92:93], v[82:83], v[82:83] op_sel:[1,1] op_sel_hi:[0,1]
    v_pk_fma_f32 v[84:85], v[82:83], v[82:83], v[92:93] op_sel:[0,0,0] op_sel_hi:[0,1,1] neg_lo:[0,0,1]
    v_pk_mul_f32 v[94:95], v[66:67], v[76:77] op_sel:[1,1] op_sel_hi:[1,0]
    v_pk_fma_f32 v[86:87], v[66:67], v[76:77], v[94:95] op_sel:[0,0,0] op_sel_hi:[0,1,1] neg_lo:[0,0,1] neg_hi:[1,0,1]
    v_mov_b32_dpp v80, v78 row_ror:8 row_mask:0xf bank_mask:0x3
    v_mov_b32_dpp v81, v79 row_ror:8 row_mask:0xf bank_mask:0x3
    v_mov_b32_dpp v82, v84 row_ror:8 row_mask:0xf bank_mask:0x3
    v_mov_b32_dpp v83, v85 row_ror:8 row_mask:0xf bank_mask:0x3
    v_pk_mul_f32 v[92:93], v[66:67], v[80:81] op_sel:[1,1] op_sel_hi:[1,0]
    v_pk_fma_f32 v[88:89], v[66:67], v[80:81], v[92:93] op_sel:[0,0,0] op_sel_hi:[0,1,1] neg_lo:[0,0,1] neg_hi:[1,0,1]
    v_pk_mul_f32 v[94:95], v[66:67], v[82:83] op_sel:[1,1] op_sel_hi:[1,0]
    v_pk_fma_f32 v[90:91], v[66:67], v[82:83], v[94:95] op_sel:[0,0,0] op_sel_hi:[0,1,1] neg_lo:[0,0,1] neg_hi:[1,0,1]
    v_mfma_f32_16x16x4_f32 v[48:51], v86, v68, v[48:51]
    v_mfma_f32_16x16x4_f32 v[52:55], v88, v70, v[52:55]
    v_mfma_f32_16x16x4_f32 v[56:59], v88, v72, v[56:59]
    v_mfma_f32_16x16x4_f32 v[60:63], v90, v74, v[60:63]
    v_mfma_f32_16x16x4_f32 v[48:51], v87, v69, v[48:51]
    v_mfma_f32_16x16x4_f32 v[52:55], v89, v71, v[52:55]
    v_mfma_f32_16x16x4_f32 v[56:59], v89, v73, v[56:59]
    v_mfma_f32_16x16x4_f32 v[60:63], v91, v75, v[60:63]
    v_mov_b64_dpp v[64:65], v[28:29] row_newbcast:13 row_mask:0xf bank_mask:0xf
    v_mov_b64_dpp v[66:67], v[30:31] row_newbcast:13 row_mask:0xf bank_mask:0xf
    v_pk_mul_f32 v[94:95], v[64:65], v[26:27] op_sel_hi:[1,0]
    v_pk_mul_f32 v[96:97], v[64:65], v[26:27] op_sel:[0,1] op_sel_hi:[1,1]
    v_fract_f32 v95, v95
    v_fract_f32 v97, v97
    v_exp_f32 v94, v94
    v_exp_f32 v96, v96
    v_cos_f32 v68, v95
    v_sin_f32 v69, v95
    v_cos_f32 v76, v97
    v_sin_f32 v77, v97
    v_pk_mul_f32 v[68:69], v[68:69], v[94:95] op_sel_hi:[1,0]
    v_pk_mul_f32 v[76:77], v[76:77], v[96:97] op_sel_hi:[1,0]
    v_pk_mul_f32 v[92:93], v[76:77], v[76:77] op_sel:[1,1] op_sel_hi:[0,1]
    v_pk_fma_f32 v[78:79], v[76:77], v[76:77], v[92:93] op_sel:[0,0,0] op_sel_hi:[0,1,1] neg_lo:[0,0,1]
    v_pk_mul_f32 v[94:95], v[68:69], v[68:69] op_sel:[1,1] op_sel_hi:[0,1]
    v_pk_fma_f32 v[70:71], v[68:69], v[68:69], v[94:95] op_sel:[0,0,0] op_sel_hi:[0,1,1] neg_lo:[0,0,1]
    v_pk_mul_f32 v[92:93], v[78:79], v[78:79] op_sel:[1,1] op_sel_hi:[0,1]
    v_pk_fma_f32 v[80:81], v[78:79], v[78:79], v[92:93] op_sel:[0,0,0] op_sel_hi:[0,1,1] neg_lo:[0,0,1]
    v_pk_mul_f32 v[94:95], v[70:71], v[70:71] op_sel:[1,1] op_sel_hi:[0,1]
    v_pk_fma_f32 v[72:73], v[70:71], v[70:71], v[94:95] op_sel:[0,0,0] op_sel_hi:[0,1,1] neg_lo:[0,0,1]
    v_pk_mul_f32 v[92:93], v[80:81], v[80:81] op_sel:[1,1] op_sel_hi:[0,1]
    v_pk_fma_f32 v[82:83], v[80:81], v[80:81], v[92:93] op_sel:[0,0,0] op_sel_hi:[0,1,1] neg_lo:[0,0,1]
    v_pk_mul_f32 v[94:95], v[72:73], v[72:73] op_sel:[1,1] op_sel_hi:[0,1]
    v_pk_fma_f32 v[74:75], v[72:73], v[72:73], v[94:95] op_sel:[0,0,0] op_sel_hi:[0,1,1] neg_lo:[0,0,1]
    v_pk_mul_f32 v[92:93], v[82:83], v[82:83] op_sel:[1,1] op_sel_hi:[0,1]
    v_pk_fma_f32 v[84:85], v[82:83], v[82:83], v[92:93] op_sel:[0,0,0] op_sel_hi:[0,1,1] neg_lo:[0,0,1]
    v_pk_mul_f32 v[94:95], v[66:67], v[76:77] op_sel:[1,1] op_sel_hi:[1,0]
    v_pk_fma_f32 v[86:87], v[66:67], v[76:77], v[94:95] op_sel:[0,0,0] op_sel_hi:[0,1,1] neg_lo:[0,0,1] neg_hi:[1,0,1]
    v_mov_b32_dpp v80, v78 row_ror:8 row_mask:0xf bank_mask:0x3
    v_mov_b32_dpp v81, v79 row_ror:8 row_mask:0xf bank_mask:0x3
    v_mov_b32_dpp v82, v84 row_ror:8 row_mask:0xf bank_mask:0x3
    v_mov_b32_dpp v83, v85 row_ror:8 row_mask:0xf bank_mask:0x3
    v_pk_mul_f32 v[92:93], v[66:67], v[80:81] op_sel:[1,1] op_sel_hi:[1,0]
    v_pk_fma_f32 v[88:89], v[66:67], v[80:81], v[92:93] op_sel:[0,0,0] op_sel_hi:[0,1,1] neg_lo:[0,0,1] neg_hi:[1,0,1]
    v_pk_mul_f32 v[94:95], v[66:67], v[82:83] op_sel:[1,1] op_sel_hi:[1,0]
    v_pk_fma_f32 v[90:91], v[66:67], v[82:83], v[94:95] op_sel:[0,0,0] op_sel_hi:[0,1,1] neg_lo:[0,0,1] neg_hi:[1,0,1]
    v_mfma_f32_16x16x4_f32 v[48:51], v86, v68, v[48:51]
    v_mfma_f32_16x16x4_f32 v[52:55], v88, v70, v[52:55]
    v_mfma_f32_16x16x4_f32 v[56:59], v88, v72, v[56:59]
    v_mfma_f32_16x16x4_f32 v[60:63], v90, v74, v[60:63]
    v_mfma_f32_16x16x4_f32 v[48:51], v87, v69, v[48:51]
    v_mfma_f32_16x16x4_f32 v[52:55], v89, v71, v[52:55]
    v_mfma_f32_16x16x4_f32 v[56:59], v89, v73, v[56:59]
    v_mfma_f32_16x16x4_f32 v[60:63], v91, v75, v[60:63]
    v_mov_b64_dpp v[64:65], v[28:29] row_newbcast:14 row_mask:0xf bank_mask:0xf
    v_mov_b64_dpp v[66:67], v[30:31] row_newbcast:14 row_mask:0xf bank_mask:0xf
    v_pk_mul_f32 v[94:95], v[64:65], v[26:27] op_sel_hi:[1,0]
    v_pk_mul_f32 v[96:97], v[64:65], v[26:27] op_sel:[0,1] op_sel_hi:[1,1]
    v_fract_f32 v95, v95
    v_fract_f32 v97, v97
    v_exp_f32 v94, v94
    v_exp_f32 v96, v96
    v_cos_f32 v68, v95
    v_sin_f32 v69, v95
    v_cos_f32 v76, v97
    v_sin_f32 v77, v97
    v_pk_mul_f32 v[68:69], v[68:69], v[94:95] op_sel_hi:[1,0]
    v_pk_mul_f32 v[76:77], v[76:77], v[96:97] op_sel_hi:[1,0]
    v_pk_mul_f32 v[92:93], v[76:77], v[76:77] op_sel:[1,1] op_sel_hi:[0,1]
    v_pk_fma_f32 v[78:79], v[76:77], v[76:77], v[92:93] op_sel:[0,0,0] op_sel_hi:[0,1,1] neg_lo:[0,0,1]
    v_pk_mul_f32 v[94:95], v[68:69], v[68:69] op_sel:[1,1] op_sel_hi:[0,1]
    v_pk_fma_f32 v[70:71], v[68:69], v[68:69], v[94:95] op_sel:[0,0,0] op_sel_hi:[0,1,1] neg_lo:[0,0,1]
    v_pk_mul_f32 v[92:93], v[78:79], v[78:79] op_sel:[1,1] op_sel_hi:[0,1]
    v_pk_fma_f32 v[80:81], v[78:79], v[78:79], v[92:93] op_sel:[0,0,0] op_sel_hi:[0,1,1] neg_lo:[0,0,1]
    v_pk_mul_f32 v[94:95], v[70:71], v[70:71] op_sel:[1,1] op_sel_hi:[0,1]
    v_pk_fma_f32 v[72:73], v[70:71], v[70:71], v[94:95] op_sel:[0,0,0] op_sel_hi:[0,1,1] neg_lo:[0,0,1]
    v_pk_mul_f32 v[92:93], v[80:81], v[80:81] op_sel:[1,1] op_sel_hi:[0,1]
    v_pk_fma_f32 v[82:83], v[80:81], v[80:81], v[92:93] op_sel:[0,0,0] op_sel_hi:[0,1,1] neg_lo:[0,0,1]
    v_pk_mul_f32 v[94:95], v[72:73], v[72:73] op_sel:[1,1] op_sel_hi:[0,1]
    v_pk_fma_f32 v[74:75], v[72:73], v[72:73], v[94:95] op_sel:[0,0,0] op_sel_hi:[0,1,1] neg_lo:[0,0,1]
    v_pk_mul_f32 v[92:93], v[82:83], v[82:83] op_sel:[1,1] op_sel_hi:[0,1]
    v_pk_fma_f32 v[84:85], v[82:83], v[82:83], v[92:93] op_sel:[0,0,0] op_sel_hi:[0,1,1] neg_lo:[0,0,1]
    v_pk_mul_f32 v[94:95], v[66:67], v[76:77] op_sel:[1,1] op_sel_hi:[1,0]
    v_pk_fma_f32 v[86:87], v[66:67], v[76:77], v[94:95] op_sel:[0,0,0] op_sel_hi:[0,1,1] neg_lo:[0,0,1] neg_hi:[1,0,1]
    v_mov_b32_dpp v80, v78 row_ror:8 row_mask:0xf bank_mask:0x3
    v_mov_b32_dpp v81, v79 row_ror:8 row_mask:0xf bank_mask:0x3
    v_mov_b32_dpp v82, v84 row_ror:8 row_mask:0xf bank_mask:0x3
    v_mov_b32_dpp v83, v85 row_ror:8 row_mask:0xf bank_mask:0x3
    v_pk_mul_f32 v[92:93], v[66:67], v[80:81] op_sel:[1,1] op_sel_hi:[1,0]
    v_pk_fma_f32 v[88:89], v[66:67], v[80:81], v[92:93] op_sel:[0,0,0] op_sel_hi:[0,1,1] neg_lo:[0,0,1] neg_hi:[1,0,1]
    v_pk_mul_f32 v[94:95], v[66:67], v[82:83] op_sel:[1,1] op_sel_hi:[1,0]
    v_pk_fma_f32 v[90:91], v[66:67], v[82:83], v[94:95] op_sel:[0,0,0] op_sel_hi:[0,1,1] neg_lo:[0,0,1] neg_hi:[1,0,1]
    v_mfma_f32_16x16x4_f32 v[48:51], v86, v68, v[48:51]
    v_mfma_f32_16x16x4_f32 v[52:55], v88, v70, v[52:55]
    v_mfma_f32_16x16x4_f32 v[56:59], v88, v72, v[56:59]
    v_mfma_f32_16x16x4_f32 v[60:63], v90, v74, v[60:63]
    v_mfma_f32_16x16x4_f32 v[48:51], v87, v69, v[48:51]
    v_mfma_f32_16x16x4_f32 v[52:55], v89, v71, v[52:55]
    v_mfma_f32_16x16x4_f32 v[56:59], v89, v73, v[56:59]
    v_mfma_f32_16x16x4_f32 v[60:63], v91, v75, v[60:63]
    v_mov_b64_dpp v[64:65], v[28:29] row_newbcast:15 row_mask:0xf bank_mask:0xf
    v_mov_b64_dpp v[66:67], v[30:31] row_newbcast:15 row_mask:0xf bank_mask:0xf
    v_pk_mul_f32 v[94:95], v[64:65], v[26:27] op_sel_hi:[1,0]
    v_pk_mul_f32 v[96:97], v[64:65], v[26:27] op_sel:[0,1] op_sel_hi:[1,1]
    v_fract_f32 v95, v95
    v_fract_f32 v97, v97
    v_exp_f32 v94, v94
    v_exp_f32 v96, v96
    v_cos_f32 v68, v95
    v_sin_f32 v69, v95
    v_cos_f32 v76, v97
    v_sin_f32 v77, v97
    v_pk_mul_f32 v[68:69], v[68:69], v[94:95] op_sel_hi:[1,0]
    v_pk_mul_f32 v[76:77], v[76:77], v[96:97] op_sel_hi:[1,0]
    v_pk_mul_f32 v[92:93], v[76:77], v[76:77] op_sel:[1,1] op_sel_hi:[0,1]
    v_pk_fma_f32 v[78:79], v[76:77], v[76:77], v[92:93] op_sel:[0,0,0] op_sel_hi:[0,1,1] neg_lo:[0,0,1]
    v_pk_mul_f32 v[94:95], v[68:69], v[68:69] op_sel:[1,1] op_sel_hi:[0,1]
    v_pk_fma_f32 v[70:71], v[68:69], v[68:69], v[94:95] op_sel:[0,0,0] op_sel_hi:[0,1,1] neg_lo:[0,0,1]
    v_pk_mul_f32 v[92:93], v[78:79], v[78:79] op_sel:[1,1] op_sel_hi:[0,1]
    v_pk_fma_f32 v[80:81], v[78:79], v[78:79], v[92:93] op_sel:[0,0,0] op_sel_hi:[0,1,1] neg_lo:[0,0,1]
    v_pk_mul_f32 v[94:95], v[70:71], v[70:71] op_sel:[1,1] op_sel_hi:[0,1]
    v_pk_fma_f32 v[72:73], v[70:71], v[70:71], v[94:95] op_sel:[0,0,0] op_sel_hi:[0,1,1] neg_lo:[0,0,1]
    v_pk_mul_f32 v[92:93], v[80:81], v[80:81] op_sel:[1,1] op_sel_hi:[0,1]
    v_pk_fma_f32 v[82:83], v[80:81], v[80:81], v[92:93] op_sel:[0,0,0] op_sel_hi:[0,1,1] neg_lo:[0,0,1]
    v_pk_mul_f32 v[94:95], v[72:73], v[72:73] op_sel:[1,1] op_sel_hi:[0,1]
    v_pk_fma_f32 v[74:75], v[72:73], v[72:73], v[94:95] op_sel:[0,0,0] op_sel_hi:[0,1,1] neg_lo:[0,0,1]
    v_pk_mul_f32 v[92:93], v[82:83], v[82:83] op_sel:[1,1] op_sel_hi:[0,1]
    v_pk_fma_f32 v[84:85], v[82:83], v[82:83], v[92:93] op_sel:[0,0,0] op_sel_hi:[0,1,1] neg_lo:[0,0,1]
    v_pk_mul_f32 v[94:95], v[66:67], v[76:77] op_sel:[1,1] op_sel_hi:[1,0]
    v_pk_fma_f32 v[86:87], v[66:67], v[76:77], v[94:95] op_sel:[0,0,0] op_sel_hi:[0,1,1] neg_lo:[0,0,1] neg_hi:[1,0,1]
    v_mov_b32_dpp v80, v78 row_ror:8 row_mask:0xf bank_mask:0x3
    v_mov_b32_dpp v81, v79 row_ror:8 row_mask:0xf bank_mask:0x3
    v_mov_b32_dpp v82, v84 row_ror:8 row_mask:0xf bank_mask:0x3
    v_mov_b32_dpp v83, v85 row_ror:8 row_mask:0xf bank_mask:0x3
    v_pk_mul_f32 v[92:93], v[66:67], v[80:81] op_sel:[1,1] op_sel_hi:[1,0]
    v_pk_fma_f32 v[88:89], v[66:67], v[80:81], v[92:93] op_sel:[0,0,0] op_sel_hi:[0,1,1] neg_lo:[0,0,1] neg_hi:[1,0,1]
    v_pk_mul_f32 v[94:95], v[66:67], v[82:83] op_sel:[1,1] op_sel_hi:[1,0]
    v_pk_fma_f32 v[90:91], v[66:67], v[82:83], v[94:95] op_sel:[0,0,0] op_sel_hi:[0,1,1] neg_lo:[0,0,1] neg_hi:[1,0,1]
    v_mfma_f32_16x16x4_f32 v[48:51], v86, v68, v[48:51]
    v_mfma_f32_16x16x4_f32 v[52:55], v88, v70, v[52:55]
    v_mfma_f32_16x16x4_f32 v[56:59], v88, v72, v[56:59]
    v_mfma_f32_16x16x4_f32 v[60:63], v90, v74, v[60:63]
    v_mfma_f32_16x16x4_f32 v[48:51], v87, v69, v[48:51]
    v_mfma_f32_16x16x4_f32 v[52:55], v89, v71, v[52:55]
    v_mfma_f32_16x16x4_f32 v[56:59], v89, v73, v[56:59]
    v_mfma_f32_16x16x4_f32 v[60:63], v91, v75, v[60:63]
    v_mov_b64 v[28:29], v[32:33]
    v_mov_b64 v[30:31], v[34:35]
    s_add_u32 s25, s25, 1
    s_cmp_lt_u32 s25, 2
    s_cbranch_scc1 ss_kg
    s_cmp_lg_u32 s28, 0
    s_cbranch_scc1 ss_nostage
    s_waitcnt vmcnt(0)
    v_mov_b32 v36, 0x05040100
    v_mov_b32 v37, 0x07060302
    v_lshlrev_b32 v6, 4, v0
    v_add_u32 v7, 65536, v6
    v_perm_b32 v40, v212, v208, v36
    v_perm_b32 v41, v220, v216, v36
    v_perm_b32 v42, v228, v224, v36
    v_perm_b32 v43, v236, v232, v36
    ds_write_b128 v6, v[40:43] offset:512
    v_perm_b32 v44, v212, v208, v37
    v_perm_b32 v45, v220, v216, v37
    v_perm_b32 v46, v228, v224, v37
    v_perm_b32 v47, v236, v232, v37
    ds_write_b128 v6, v[44:47] offset:16896
    v_perm_b32 v40, v213, v209, v36
    v_perm_b32 v41, v221, v217, v36
    v_perm_b32 v42, v229, v225, v36
    v_perm_b32 v43, v237, v233, v36
    ds_write_b128 v6, v[40:43] offset:33280
    v_perm_b32 v44, v213, v209, v37
    v_perm_b32 v45, v221, v217, v37
    v_perm_b32 v46, v229, v225, v37
    v_perm_b32 v47, v237, v233, v37
    ds_write_b128 v6, v[44:47] offset:49664
    v_perm_b32 v40, v214, v210, v36
    v_perm_b32 v41, v222, v218, v36
    v_perm_b32 v42, v230, v226, v36
    v_perm_b32 v43, v238, v234, v36
    ds_write_b128 v7, v[40:43] offset:512
    v_perm_b32 v44, v214, v210, v37
    v_perm_b32 v45, v222, v218, v37
    v_perm_b32 v46, v230, v226, v37
    v_perm_b32 v47, v238, v234, v37
    ds_write_b128 v7, v[44:47] offset:16896
    v_perm_b32 v40, v215, v211, v36
    v_perm_b32 v41, v223, v219, v36
    v_perm_b32 v42, v231, v227, v36
    v_perm_b32 v43, v239, v235, v36
    ds_write_b128 v7, v[40:43] offset:33280
    v_perm_b32 v44, v215, v211, v37
    v_perm_b32 v45, v223, v219, v37
    v_perm_b32 v46, v231, v227, v37
    v_perm_b32 v47, v239, v235, v37
    ds_write_b128 v7, v[44:47] offset:49664
ss_nostage:
    s_nop 11
    v_lshlrev_b32 v5, 8, v3
    v_lshl_add_u32 v5, v2, 2, v5
    v_add_u32 v5, v5, v4
    ds_write_b32 v5, v48 offset:4608
    ds_write_b32 v5, v49 offset:4672
    ds_write_b32 v5, v50 offset:4736
    ds_write_b32 v5, v51 offset:4800
    s_mov_b32 exec_hi, 0
    ds_write_b32 v5, v52 offset:5632
    ds_write_b32 v5, v53 offset:5696
    ds_write_b32 v5, v54 offset:5760
    ds_write_b32 v5, v55 offset:5824
    s_not_b64 exec, exec
    ds_write_b32 v5, v56 offset:5632
    ds_write_b32 v5, v57 offset:5696
    ds_write_b32 v5, v58 offset:5760
    ds_write_b32 v5, v59 offset:5824
    ds_write_b32 v5, v60 offset:6144
    ds_write_b32 v5, v61 offset:6208
    ds_write_b32 v5, v62 offset:6272
    ds_write_b32 v5, v63 offset:6336
    s_mov_b64 exec, 3
    v_cmp_eq_u32 vcc, 0, v2
    s_nop 1
    v_cndmask_b32 v6, 0, v60, vcc
    ds_write_b32 v5, v6 offset:7168
    s_mov_b64 exec, -1
    s_waitcnt lgkmcnt(0)
    v_lshlrev_b32 v7, 1, v1
    v_sub_u32 v7, 2065, v7
    v_lshl_add_u32 v64, v1, 2, v4
    v_mov_b32 v65, 641
    s_mov_b32 s25, 9
    s_mov_b32 s22, 256
    s_mov_b32 s23, 2048
ss_exp:
    v_subrev_u32 v66, 0, v7
    v_cvt_f32_u32 v72, v66
    v_cmp_gt_u32 vcc, s22, v66
    v_cvt_pk_bf16_f32 v72, v72, 0
    v_subrev_u32 v72, 0x4280, v72
    v_cndmask_b32 v72, v72, v66, vcc
    v_cmp_gt_u32 vcc, s23, v66
    s_nop 1
    v_cndmask_b32 v72, v65, v72, vcc
    v_lshl_add_u32 v72, v72, 2, v4
    v_subrev_u32 v67, 1, v7
    v_cvt_f32_u32 v73, v67
    v_cmp_gt_u32 vcc, s22, v67
    v_cvt_pk_bf16_f32 v73, v73, 0
    v_subrev_u32 v73, 0x4280, v73
    v_cndmask_b32 v73, v73, v67, vcc
    v_cmp_gt_u32 vcc, s23, v67
    ds_read_b32 v78, v72 offset:4608
    s_nop 0
    v_cndmask_b32 v73, v65, v73, vcc
    v_lshl_add_u32 v73, v73, 2, v4
    v_subrev_u32 v68, 2, v7
    v_cvt_f32_u32 v74, v68
    v_cmp_gt_u32 vcc, s22, v68
    v_cvt_pk_bf16_f32 v74, v74, 0
    v_subrev_u32 v74, 0x4280, v74
    v_cndmask_b32 v74, v74, v68, vcc
    v_cmp_gt_u32 vcc, s23, v68
    ds_read_b32 v79, v73 offset:4608
    s_nop 0
    v_cndmask_b32 v74, v65, v74, vcc
    v_lshl_add_u32 v74, v74, 2, v4
    v_subrev_u32 v69, 128, v7
    v_cvt_f32_u32 v75, v69
    v_cmp_gt_u32 vcc, s22, v69
    v_cvt_pk_bf16_f32 v75, v75, 0
    v_subrev_u32 v75, 0x4280, v75
    v_cndmask_b32 v75, v75, v69, vcc
    v_cmp_gt_u32 vcc, s23, v69
    ds_read_b32 v80, v74 offset:4608
    s_nop 0
    v_cndmask_b32 v75, v65, v75, vcc
    v_lshl_add_u32 v75, v75, 2, v4
    v_subrev_u32 v70, 129, v7
    v_cvt_f32_u32 v76, v70
    v_cmp_gt_u32 vcc, s22, v70
    v_cvt_pk_bf16_f32 v76, v76, 0
    v_subrev_u32 v76, 0x4280, v76
    v_cndmask_b32 v76, v76, v70, vcc
    v_cmp_gt_u32 vcc, s23, v70
    ds_read_b32 v81, v75 offset:4608
    s_nop 0
    v_cndmask_b32 v76, v65, v76, vcc
    v_lshl_add_u32 v76, v76, 2, v4
    v_subrev_u32 v71, 130, v7
    v_cvt_f32_u32 v77, v71
    v_cmp_gt_u32 vcc, s22, v71
    v_cvt_pk_bf16_f32 v77, v77, 0
    v_subrev_u32 v77, 0x4280, v77
    v_cndmask_b32 v77, v77, v71, vcc
    v_cmp_gt_u32 vcc, s23, v71
    ds_read_b32 v82, v76 offset:4608
    s_nop 0
    v_cndmask_b32 v77, v65, v77, vcc
    v_lshl_add_u32 v77, v77, 2, v4
    ds_read_b32 v83, v77 offset:4608
    v_subrev_u32 v7, 256, v7
    s_sub_u32 s25, s25, 1
    s_waitcnt lgkmcnt(0)
    v_cvt_pk_bf16_f32 v84, v79, v80
    v_cvt_pk_bf16_f32 v85, v78, v79
    v_cvt_pk_bf16_f32 v86, v82, v83
    v_cvt_pk_bf16_f32 v87, v81, v82
    ds_write_b32 v64, v84 offset:7424
    ds_write_b32 v64, v85 offset:11776
    s_cmp_eq_u32 s25, 0
    s_cbranch_scc1 ss_expx
    ds_write_b32 v64, v86 offset:7680
    ds_write_b32 v64, v87 offset:12032
    v_add_u32 v64, 512, v64
    s_nop 1
    s_branch ss_exp
ss_expx:
    s_waitcnt lgkmcnt(0)
    s_barrier
    v_and_b32 v5, 1, v2
    v_mul_u32_u24 v36, 4352, v5
    v_sub_u32 v5, v5, v2
    v_lshl_add_u32 v5, v3, 3, v5
    v_lshl_add_u32 v36, v5, 1, v36
    v_add_u32 v36, 11072, v36
    v_add_u32 v36, v36, v4
    v_subrev_u32 v37, 512, v36
    v_subrev_u32 v38, 1024, v36
    v_subrev_u32 v39, 1536, v36
    v_subrev_u32 v40, 2048, v36
    v_subrev_u32 v41, 2560, v36
    v_subrev_u32 v42, 3072, v36
    v_subrev_u32 v43, 3584, v36
    v_lshlrev_b32 v44, 5, v2
    v_lshl_add_u32 v44, v3, 4, v44
    v_add_u32 v44, 32, v44
    v_add_u32 v44, v44, v4
    ds_read_b128 v[112:115], v44 offset:448
    ds_read2_b32 v[80:81], v36 offset0:112 offset1:113
    ds_read2_b32 v[82:83], v36 offset0:114 offset1:115
    ds_read_b128 v[116:119], v44 offset:960
    ds_read2_b32 v[84:85], v37 offset0:112 offset1:113
    ds_read2_b32 v[86:87], v37 offset0:114 offset1:115
    ds_read_b128 v[120:123], v44 offset:1472
    ds_read2_b32 v[88:89], v38 offset0:112 offset1:113
    ds_read2_b32 v[90:91], v38 offset0:114 offset1:115
    ds_read_b128 v[124:127], v44 offset:1984
    ds_read2_b32 v[92:93], v39 offset0:112 offset1:113
    ds_read2_b32 v[94:95], v39 offset0:114 offset1:115
    ds_read_b128 v[128:131], v44 offset:2496
    ds_read2_b32 v[96:97], v40 offset0:112 offset1:113
    ds_read2_b32 v[98:99], v40 offset0:114 offset1:115
    ds_read_b128 v[132:135], v44 offset:3008
    ds_read2_b32 v[100:101], v41 offset0:112 offset1:113
    ds_read2_b32 v[102:103], v41 offset0:114 offset1:115
    ds_read_b128 v[136:139], v44 offset:3520
    ds_read2_b32 v[104:105], v42 offset0:112 offset1:113
    ds_read2_b32 v[106:107], v42 offset0:114 offset1:115
    ds_read_b128 v[140:143], v44 offset:4032
    ds_read2_b32 v[108:109], v43 offset0:112 offset1:113
    ds_read2_b32 v[110:111], v43 offset0:114 offset1:115
    s_waitcnt lgkmcnt(0)
    v_mfma_f32_16x16x32_bf16 v[48:51], v[80:83], v[112:115], 0
    ds_read_b128 v[176:179], v44 offset:384
    v_mfma_f32_16x16x32_bf16 v[52:55], v[80:83], v[116:119], 0
    ds_read2_b32 v[144:145], v36 offset0:96 offset1:97
    v_mfma_f32_16x16x32_bf16 v[56:59], v[80:83], v[120:123], 0
    ds_read2_b32 v[146:147], v36 offset0:98 offset1:99
    v_mfma_f32_16x16x32_bf16 v[60:63], v[80:83], v[124:127], 0
    ds_read_b128 v[180:183], v44 offset:896
    v_mfma_f32_16x16x32_bf16 v[64:67], v[80:83], v[128:131], 0
    ds_read2_b32 v[148:149], v37 offset0:96 offset1:97
    v_mfma_f32_16x16x32_bf16 v[68:71], v[80:83], v[132:135], 0
    ds_read2_b32 v[150:151], v37 offset0:98 offset1:99
    v_mfma_f32_16x16x32_bf16 v[72:75], v[80:83], v[136:139], 0
    ds_read_b128 v[184:187], v44 offset:1408
    v_mfma_f32_16x16x32_bf16 v[76:79], v[80:83], v[140:143], 0
    ds_read2_b32 v[152:153], v38 offset0:96 offset1:97
    v_mfma_f32_16x16x32_bf16 v[52:55], v[84:87], v[112:115], v[52:55]
    ds_read2_b32 v[154:155], v38 offset0:98 offset1:99
    v_mfma_f32_16x16x32_bf16 v[56:59], v[84:87], v[116:119], v[56:59]
    ds_read_b128 v[188:191], v44 offset:1920
    v_mfma_f32_16x16x32_bf16 v[60:63], v[84:87], v[120:123], v[60:63]
    ds_read2_b32 v[156:157], v39 offset0:96 offset1:97
    v_mfma_f32_16x16x32_bf16 v[64:67], v[84:87], v[124:127], v[64:67]
    ds_read2_b32 v[158:159], v39 offset0:98 offset1:99
    v_mfma_f32_16x16x32_bf16 v[68:71], v[84:87], v[128:131], v[68:71]
    ds_read_b128 v[192:195], v44 offset:2432
    v_mfma_f32_16x16x32_bf16 v[72:75], v[84:87], v[132:135], v[72:75]
    ds_read2_b32 v[160:161], v40 offset0:96 offset1:97
    v_mfma_f32_16x16x32_bf16 v[76:79], v[84:87], v[136:139], v[76:79]
    ds_read2_b32 v[162:163], v40 offset0:98 offset1:99
    v_mfma_f32_16x16x32_bf16 v[56:59], v[88:91], v[112:115], v[56:59]
    ds_read_b128 v[196:199], v44 offset:2944
    v_mfma_f32_16x16x32_bf16 v[60:63], v[88:91], v[116:119], v[60:63]
    ds_read2_b32 v[164:165], v41 offset0:96 offset1:97
    v_mfma_f32_16x16x32_bf16 v[64:67], v[88:91], v[120:123], v[64:67]
    ds_read2_b32 v[166:167], v41 offset0:98 offset1:99
    v_mfma_f32_16x16x32_bf16 v[68:71], v[88:91], v[124:127], v[68:71]
    ds_read_b128 v[200:203], v44 offset:3456
    v_mfma_f32_16x16x32_bf16 v[72:75], v[88:91], v[128:131], v[72:75]
    ds_read2_b32 v[168:169], v42 offset0:96 offset1:97
    v_mfma_f32_16x16x32_bf16 v[76:79], v[88:91], v[132:135], v[76:79]
    ds_read2_b32 v[170:171], v42 offset0:98 offset1:99
    v_mfma_f32_16x16x32_bf16 v[60:63], v[92:95], v[112:115], v[60:63]
    ds_read_b128 v[204:207], v44 offset:3968
    v_mfma_f32_16x16x32_bf16 v[64:67], v[92:95], v[116:119], v[64:67]
    ds_read2_b32 v[172:173], v43 offset0:96 offset1:97
    v_mfma_f32_16x16x32_bf16 v[68:71], v[92:95], v[120:123], v[68:71]
    ds_read2_b32 v[174:175], v43 offset0:98 offset1:99
    v_mfma_f32_16x16x32_bf16 v[72:75], v[92:95], v[124:127], v[72:75]
    v_mfma_f32_16x16x32_bf16 v[76:79], v[92:95], v[128:131], v[76:79]
    v_mfma_f32_16x16x32_bf16 v[64:67], v[96:99], v[112:115], v[64:67]
    v_mfma_f32_16x16x32_bf16 v[68:71], v[96:99], v[116:119], v[68:71]
    v_mfma_f32_16x16x32_bf16 v[72:75], v[96:99], v[120:123], v[72:75]
    v_mfma_f32_16x16x32_bf16 v[76:79], v[96:99], v[124:127], v[76:79]
    v_mfma_f32_16x16x32_bf16 v[68:71], v[100:103], v[112:115], v[68:71]
    v_mfma_f32_16x16x32_bf16 v[72:75], v[100:103], v[116:119], v[72:75]
    v_mfma_f32_16x16x32_bf16 v[76:79], v[100:103], v[120:123], v[76:79]
    v_mfma_f32_16x16x32_bf16 v[72:75], v[104:107], v[112:115], v[72:75]
    v_mfma_f32_16x16x32_bf16 v[76:79], v[104:107], v[116:119], v[76:79]
    v_mfma_f32_16x16x32_bf16 v[76:79], v[108:111], v[112:115], v[76:79]
    s_waitcnt lgkmcnt(0)
    v_mfma_f32_16x16x32_bf16 v[48:51], v[144:147], v[176:179], v[48:51]
    ds_read_b128 v[112:115], v44 offset:320
    v_mfma_f32_16x16x32_bf16 v[52:55], v[144:147], v[180:183], v[52:55]
    ds_read2_b32 v[80:81], v36 offset0:80 offset1:81
    v_mfma_f32_16x16x32_bf16 v[56:59], v[144:147], v[184:187], v[56:59]
    ds_read2_b32 v[82:83], v36 offset0:82 offset1:83
    v_mfma_f32_16x16x32_bf16 v[60:63], v[144:147], v[188:191], v[60:63]
    ds_read_b128 v[116:119], v44 offset:832
    v_mfma_f32_16x16x32_bf16 v[64:67], v[144:147], v[192:195], v[64:67]
    ds_read2_b32 v[84:85], v37 offset0:80 offset1:81
    v_mfma_f32_16x16x32_bf16 v[68:71], v[144:147], v[196:199], v[68:71]
    ds_read2_b32 v[86:87], v37 offset0:82 offset1:83
    v_mfma_f32_16x16x32_bf16 v[72:75], v[144:147], v[200:203], v[72:75]
    ds_read_b128 v[120:123], v44 offset:1344
    v_mfma_f32_16x16x32_bf16 v[76:79], v[144:147], v[204:207], v[76:79]
    ds_read2_b32 v[88:89], v38 offset0:80 offset1:81
    v_mfma_f32_16x16x32_bf16 v[52:55], v[148:151], v[176:179], v[52:55]
    ds_read2_b32 v[90:91], v38 offset0:82 offset1:83
    v_mfma_f32_16x16x32_bf16 v[56:59], v[148:151], v[180:183], v[56:59]
    ds_read_b128 v[124:127], v44 offset:1856
    v_mfma_f32_16x16x32_bf16 v[60:63], v[148:151], v[184:187], v[60:63]
    ds_read2_b32 v[92:93], v39 offset0:80 offset1:81
    v_mfma_f32_16x16x32_bf16 v[64:67], v[148:151], v[188:191], v[64:67]
    ds_read2_b32 v[94:95], v39 offset0:82 offset1:83
    v_mfma_f32_16x16x32_bf16 v[68:71], v[148:151], v[192:195], v[68:71]
    ds_read_b128 v[128:131], v44 offset:2368
    v_mfma_f32_16x16x32_bf16 v[72:75], v[148:151], v[196:199], v[72:75]
    ds_read2_b32 v[96:97], v40 offset0:80 offset1:81
    v_mfma_f32_16x16x32_bf16 v[76:79], v[148:151], v[200:203], v[76:79]
    ds_read2_b32 v[98:99], v40 offset0:82 offset1:83
    v_mfma_f32_16x16x32_bf16 v[56:59], v[152:155], v[176:179], v[56:59]
    ds_read_b128 v[132:135], v44 offset:2880
    v_mfma_f32_16x16x32_bf16 v[60:63], v[152:155], v[180:183], v[60:63]
    ds_read2_b32 v[100:101], v41 offset0:80 offset1:81
    v_mfma_f32_16x16x32_bf16 v[64:67], v[152:155], v[184:187], v[64:67]
    ds_read2_b32 v[102:103], v41 offset0:82 offset1:83
    v_mfma_f32_16x16x32_bf16 v[68:71], v[152:155], v[188:191], v[68:71]
    ds_read_b128 v[136:139], v44 offset:3392
    v_mfma_f32_16x16x32_bf16 v[72:75], v[152:155], v[192:195], v[72:75]
    ds_read2_b32 v[104:105], v42 offset0:80 offset1:81
    v_mfma_f32_16x16x32_bf16 v[76:79], v[152:155], v[196:199], v[76:79]
    ds_read2_b32 v[106:107], v42 offset0:82 offset1:83
    v_mfma_f32_16x16x32_bf16 v[60:63], v[156:159], v[176:179], v[60:63]
    ds_read_b128 v[140:143], v44 offset:3904
    v_mfma_f32_16x16x32_bf16 v[64:67], v[156:159], v[180:183], v[64:67]
    ds_read2_b32 v[108:109], v43 offset0:80 offset1:81
    v_mfma_f32_16x16x32_bf16 v[68:71], v[156:159], v[184:187], v[68:71]
    ds_read2_b32 v[110:111], v43 offset0:82 offset1:83
    v_mfma_f32_16x16x32_bf16 v[72:75], v[156:159], v[188:191], v[72:75]
    v_mfma_f32_16x16x32_bf16 v[76:79], v[156:159], v[192:195], v[76:79]
    v_mfma_f32_16x16x32_bf16 v[64:67], v[160:163], v[176:179], v[64:67]
    v_mfma_f32_16x16x32_bf16 v[68:71], v[160:163], v[180:183], v[68:71]
    v_mfma_f32_16x16x32_bf16 v[72:75], v[160:163], v[184:187], v[72:75]
    v_mfma_f32_16x16x32_bf16 v[76:79], v[160:163], v[188:191], v[76:79]
    v_mfma_f32_16x16x32_bf16 v[68:71], v[164:167], v[176:179], v[68:71]
    v_mfma_f32_16x16x32_bf16 v[72:75], v[164:167], v[180:183], v[72:75]
    v_mfma_f32_16x16x32_bf16 v[76:79], v[164:167], v[184:187], v[76:79]
    v_mfma_f32_16x16x32_bf16 v[72:75], v[168:171], v[176:179], v[72:75]
    v_mfma_f32_16x16x32_bf16 v[76:79], v[168:171], v[180:183], v[76:79]
    v_mfma_f32_16x16x32_bf16 v[76:79], v[172:175], v[176:179], v[76:79]
    s_waitcnt lgkmcnt(0)
    v_mfma_f32_16x16x32_bf16 v[48:51], v[80:83], v[112:115], v[48:51]
    ds_read_b128 v[176:179], v44 offset:256
    v_mfma_f32_16x16x32_bf16 v[52:55], v[80:83], v[116:119], v[52:55]
    ds_read2_b32 v[144:145], v36 offset0:64 offset1:65
    v_mfma_f32_16x16x32_bf16 v[56:59], v[80:83], v[120:123], v[56:59]
    ds_read2_b32 v[146:147], v36 offset0:66 offset1:67
    v_mfma_f32_16x16x32_bf16 v[60:63], v[80:83], v[124:127], v[60:63]
    ds_read_b128 v[180:183], v44 offset:768
    v_mfma_f32_16x16x32_bf16 v[64:67], v[80:83], v[128:131], v[64:67]
    ds_read2_b32 v[148:149], v37 offset0:64 offset1:65
    v_mfma_f32_16x16x32_bf16 v[68:71], v[80:83], v[132:135], v[68:71]
    ds_read2_b32 v[150:151], v37 offset0:66 offset1:67
    v_mfma_f32_16x16x32_bf16 v[72:75], v[80:83], v[136:139], v[72:75]
    ds_read_b128 v[184:187], v44 offset:1280
    v_mfma_f32_16x16x32_bf16 v[76:79], v[80:83], v[140:143], v[76:79]
    ds_read2_b32 v[152:153], v38 offset0:64 offset1:65
    v_mfma_f32_16x16x32_bf16 v[52:55], v[84:87], v[112:115], v[52:55]
    ds_read2_b32 v[154:155], v38 offset0:66 offset1:67
    v_mfma_f32_16x16x32_bf16 v[56:59], v[84:87], v[116:119], v[56:59]
    ds_read_b128 v[188:191], v44 offset:1792
    v_mfma_f32_16x16x32_bf16 v[60:63], v[84:87], v[120:123], v[60:63]
    ds_read2_b32 v[156:157], v39 offset0:64 offset1:65
    v_mfma_f32_16x16x32_bf16 v[64:67], v[84:87], v[124:127], v[64:67]
    ds_read2_b32 v[158:159], v39 offset0:66 offset1:67
    v_mfma_f32_16x16x32_bf16 v[68:71], v[84:87], v[128:131], v[68:71]
    ds_read_b128 v[192:195], v44 offset:2304
    v_mfma_f32_16x16x32_bf16 v[72:75], v[84:87], v[132:135], v[72:75]
    ds_read2_b32 v[160:161], v40 offset0:64 offset1:65
    v_mfma_f32_16x16x32_bf16 v[76:79], v[84:87], v[136:139], v[76:79]
    ds_read2_b32 v[162:163], v40 offset0:66 offset1:67
    v_mfma_f32_16x16x32_bf16 v[56:59], v[88:91], v[112:115], v[56:59]
    ds_read_b128 v[196:199], v44 offset:2816
    v_mfma_f32_16x16x32_bf16 v[60:63], v[88:91], v[116:119], v[60:63]
    ds_read2_b32 v[164:165], v41 offset0:64 offset1:65
    v_mfma_f32_16x16x32_bf16 v[64:67], v[88:91], v[120:123], v[64:67]
    ds_read2_b32 v[166:167], v41 offset0:66 offset1:67
    v_mfma_f32_16x16x32_bf16 v[68:71], v[88:91], v[124:127], v[68:71]
    ds_read_b128 v[200:203], v44 offset:3328
    v_mfma_f32_16x16x32_bf16 v[72:75], v[88:91], v[128:131], v[72:75]
    ds_read2_b32 v[168:169], v42 offset0:64 offset1:65
    v_mfma_f32_16x16x32_bf16 v[76:79], v[88:91], v[132:135], v[76:79]
    ds_read2_b32 v[170:171], v42 offset0:66 offset1:67
    v_mfma_f32_16x16x32_bf16 v[60:63], v[92:95], v[112:115], v[60:63]
    ds_read_b128 v[204:207], v44 offset:3840
    v_mfma_f32_16x16x32_bf16 v[64:67], v[92:95], v[116:119], v[64:67]
    ds_read2_b32 v[172:173], v43 offset0:64 offset1:65
    v_mfma_f32_16x16x32_bf16 v[68:71], v[92:95], v[120:123], v[68:71]
    ds_read2_b32 v[174:175], v43 offset0:66 offset1:67
    v_mfma_f32_16x16x32_bf16 v[72:75], v[92:95], v[124:127], v[72:75]
    v_mfma_f32_16x16x32_bf16 v[76:79], v[92:95], v[128:131], v[76:79]
    v_mfma_f32_16x16x32_bf16 v[64:67], v[96:99], v[112:115], v[64:67]
    v_mfma_f32_16x16x32_bf16 v[68:71], v[96:99], v[116:119], v[68:71]
    v_mfma_f32_16x16x32_bf16 v[72:75], v[96:99], v[120:123], v[72:75]
    v_mfma_f32_16x16x32_bf16 v[76:79], v[96:99], v[124:127], v[76:79]
    v_mfma_f32_16x16x32_bf16 v[68:71], v[100:103], v[112:115], v[68:71]
    v_mfma_f32_16x16x32_bf16 v[72:75], v[100:103], v[116:119], v[72:75]
    v_mfma_f32_16x16x32_bf16 v[76:79], v[100:103], v[120:123], v[76:79]
    v_mfma_f32_16x16x32_bf16 v[72:75], v[104:107], v[112:115], v[72:75]
    v_mfma_f32_16x16x32_bf16 v[76:79], v[104:107], v[116:119], v[76:79]
    v_mfma_f32_16x16x32_bf16 v[76:79], v[108:111], v[112:115], v[76:79]
    s_waitcnt lgkmcnt(0)
    v_mfma_f32_16x16x32_bf16 v[48:51], v[144:147], v[176:179], v[48:51]
    ds_read_b128 v[112:115], v44 offset:192
    v_mfma_f32_16x16x32_bf16 v[52:55], v[144:147], v[180:183], v[52:55]
    ds_read2_b32 v[80:81], v36 offset0:48 offset1:49
    v_mfma_f32_16x16x32_bf16 v[56:59], v[144:147], v[184:187], v[56:59]
    ds_read2_b32 v[82:83], v36 offset0:50 offset1:51
    v_mfma_f32_16x16x32_bf16 v[60:63], v[144:147], v[188:191], v[60:63]
    ds_read_b128 v[116:119], v44 offset:704
    v_mfma_f32_16x16x32_bf16 v[64:67], v[144:147], v[192:195], v[64:67]
    ds_read2_b32 v[84:85], v37 offset0:48 offset1:49
    v_mfma_f32_16x16x32_bf16 v[68:71], v[144:147], v[196:199], v[68:71]
    ds_read2_b32 v[86:87], v37 offset0:50 offset1:51
    v_mfma_f32_16x16x32_bf16 v[72:75], v[144:147], v[200:203], v[72:75]
    ds_read_b128 v[120:123], v44 offset:1216
    v_mfma_f32_16x16x32_bf16 v[76:79], v[144:147], v[204:207], v[76:79]
    ds_read2_b32 v[88:89], v38 offset0:48 offset1:49
    v_mfma_f32_16x16x32_bf16 v[52:55], v[148:151], v[176:179], v[52:55]
    ds_read2_b32 v[90:91], v38 offset0:50 offset1:51
    v_mfma_f32_16x16x32_bf16 v[56:59], v[148:151], v[180:183], v[56:59]
    ds_read_b128 v[124:127], v44 offset:1728
    v_mfma_f32_16x16x32_bf16 v[60:63], v[148:151], v[184:187], v[60:63]
    ds_read2_b32 v[92:93], v39 offset0:48 offset1:49
    v_mfma_f32_16x16x32_bf16 v[64:67], v[148:151], v[188:191], v[64:67]
    ds_read2_b32 v[94:95], v39 offset0:50 offset1:51
    v_mfma_f32_16x16x32_bf16 v[68:71], v[148:151], v[192:195], v[68:71]
    ds_read_b128 v[128:131], v44 offset:2240
    v_mfma_f32_16x16x32_bf16 v[72:75], v[148:151], v[196:199], v[72:75]
    ds_read2_b32 v[96:97], v40 offset0:48 offset1:49
    v_mfma_f32_16x16x32_bf16 v[76:79], v[148:151], v[200:203], v[76:79]
    ds_read2_b32 v[98:99], v40 offset0:50 offset1:51
    v_mfma_f32_16x16x32_bf16 v[56:59], v[152:155], v[176:179], v[56:59]
    ds_read_b128 v[132:135], v44 offset:2752
    v_mfma_f32_16x16x32_bf16 v[60:63], v[152:155], v[180:183], v[60:63]
    ds_read2_b32 v[100:101], v41 offset0:48 offset1:49
    v_mfma_f32_16x16x32_bf16 v[64:67], v[152:155], v[184:187], v[64:67]
    ds_read2_b32 v[102:103], v41 offset0:50 offset1:51
    v_mfma_f32_16x16x32_bf16 v[68:71], v[152:155], v[188:191], v[68:71]
    ds_read_b128 v[136:139], v44 offset:3264
    v_mfma_f32_16x16x32_bf16 v[72:75], v[152:155], v[192:195], v[72:75]
    ds_read2_b32 v[104:105], v42 offset0:48 offset1:49
    v_mfma_f32_16x16x32_bf16 v[76:79], v[152:155], v[196:199], v[76:79]
    ds_read2_b32 v[106:107], v42 offset0:50 offset1:51
    v_mfma_f32_16x16x32_bf16 v[60:63], v[156:159], v[176:179], v[60:63]
    ds_read_b128 v[140:143], v44 offset:3776
    v_mfma_f32_16x16x32_bf16 v[64:67], v[156:159], v[180:183], v[64:67]
    ds_read2_b32 v[108:109], v43 offset0:48 offset1:49
    v_mfma_f32_16x16x32_bf16 v[68:71], v[156:159], v[184:187], v[68:71]
    ds_read2_b32 v[110:111], v43 offset0:50 offset1:51
    v_mfma_f32_16x16x32_bf16 v[72:75], v[156:159], v[188:191], v[72:75]
    v_mfma_f32_16x16x32_bf16 v[76:79], v[156:159], v[192:195], v[76:79]
    v_mfma_f32_16x16x32_bf16 v[64:67], v[160:163], v[176:179], v[64:67]
    v_mfma_f32_16x16x32_bf16 v[68:71], v[160:163], v[180:183], v[68:71]
    v_mfma_f32_16x16x32_bf16 v[72:75], v[160:163], v[184:187], v[72:75]
    v_mfma_f32_16x16x32_bf16 v[76:79], v[160:163], v[188:191], v[76:79]
    v_mfma_f32_16x16x32_bf16 v[68:71], v[164:167], v[176:179], v[68:71]
    v_mfma_f32_16x16x32_bf16 v[72:75], v[164:167], v[180:183], v[72:75]
    v_mfma_f32_16x16x32_bf16 v[76:79], v[164:167], v[184:187], v[76:79]
    v_mfma_f32_16x16x32_bf16 v[72:75], v[168:171], v[176:179], v[72:75]
    v_mfma_f32_16x16x32_bf16 v[76:79], v[168:171], v[180:183], v[76:79]
    v_mfma_f32_16x16x32_bf16 v[76:79], v[172:175], v[176:179], v[76:79]
    s_waitcnt lgkmcnt(0)
    v_mfma_f32_16x16x32_bf16 v[48:51], v[80:83], v[112:115], v[48:51]
    ds_read_b128 v[176:179], v44 offset:128
    v_mfma_f32_16x16x32_bf16 v[52:55], v[80:83], v[116:119], v[52:55]
    ds_read2_b32 v[144:145], v36 offset0:32 offset1:33
    v_mfma_f32_16x16x32_bf16 v[56:59], v[80:83], v[120:123], v[56:59]
    ds_read2_b32 v[146:147], v36 offset0:34 offset1:35
    v_mfma_f32_16x16x32_bf16 v[60:63], v[80:83], v[124:127], v[60:63]
    ds_read_b128 v[180:183], v44 offset:640
    v_mfma_f32_16x16x32_bf16 v[64:67], v[80:83], v[128:131], v[64:67]
    ds_read2_b32 v[148:149], v37 offset0:32 offset1:33
    v_mfma_f32_16x16x32_bf16 v[68:71], v[80:83], v[132:135], v[68:71]
    ds_read2_b32 v[150:151], v37 offset0:34 offset1:35
    v_mfma_f32_16x16x32_bf16 v[72:75], v[80:83], v[136:139], v[72:75]
    ds_read_b128 v[184:187], v44 offset:1152
    v_mfma_f32_16x16x32_bf16 v[76:79], v[80:83], v[140:143], v[76:79]
    ds_read2_b32 v[152:153], v38 offset0:32 offset1:33
    v_mfma_f32_16x16x32_bf16 v[52:55], v[84:87], v[112:115], v[52:55]
    ds_read2_b32 v[154:155], v38 offset0:34 offset1:35
    v_mfma_f32_16x16x32_bf16 v[56:59], v[84:87], v[116:119], v[56:59]
    ds_read_b128 v[188:191], v44 offset:1664
    v_mfma_f32_16x16x32_bf16 v[60:63], v[84:87], v[120:123], v[60:63]
    ds_read2_b32 v[156:157], v39 offset0:32 offset1:33
    v_mfma_f32_16x16x32_bf16 v[64:67], v[84:87], v[124:127], v[64:67]
    ds_read2_b32 v[158:159], v39 offset0:34 offset1:35
    v_mfma_f32_16x16x32_bf16 v[68:71], v[84:87], v[128:131], v[68:71]
    ds_read_b128 v[192:195], v44 offset:2176
    v_mfma_f32_16x16x32_bf16 v[72:75], v[84:87], v[132:135], v[72:75]
    ds_read2_b32 v[160:161], v40 offset0:32 offset1:33
    v_mfma_f32_16x16x32_bf16 v[76:79], v[84:87], v[136:139], v[76:79]
    ds_read2_b32 v[162:163], v40 offset0:34 offset1:35
    v_mfma_f32_16x16x32_bf16 v[56:59], v[88:91], v[112:115], v[56:59]
    ds_read_b128 v[196:199], v44 offset:2688
    v_mfma_f32_16x16x32_bf16 v[60:63], v[88:91], v[116:119], v[60:63]
    ds_read2_b32 v[164:165], v41 offset0:32 offset1:33
    v_mfma_f32_16x16x32_bf16 v[64:67], v[88:91], v[120:123], v[64:67]
    ds_read2_b32 v[166:167], v41 offset0:34 offset1:35
    v_mfma_f32_16x16x32_bf16 v[68:71], v[88:91], v[124:127], v[68:71]
    ds_read_b128 v[200:203], v44 offset:3200
    v_mfma_f32_16x16x32_bf16 v[72:75], v[88:91], v[128:131], v[72:75]
    ds_read2_b32 v[168:169], v42 offset0:32 offset1:33
    v_mfma_f32_16x16x32_bf16 v[76:79], v[88:91], v[132:135], v[76:79]
    ds_read2_b32 v[170:171], v42 offset0:34 offset1:35
    v_mfma_f32_16x16x32_bf16 v[60:63], v[92:95], v[112:115], v[60:63]
    ds_read_b128 v[204:207], v44 offset:3712
    v_mfma_f32_16x16x32_bf16 v[64:67], v[92:95], v[116:119], v[64:67]
    ds_read2_b32 v[172:173], v43 offset0:32 offset1:33
    v_mfma_f32_16x16x32_bf16 v[68:71], v[92:95], v[120:123], v[68:71]
    ds_read2_b32 v[174:175], v43 offset0:34 offset1:35
    v_mfma_f32_16x16x32_bf16 v[72:75], v[92:95], v[124:127], v[72:75]
    v_mfma_f32_16x16x32_bf16 v[76:79], v[92:95], v[128:131], v[76:79]
    v_mfma_f32_16x16x32_bf16 v[64:67], v[96:99], v[112:115], v[64:67]
    v_mfma_f32_16x16x32_bf16 v[68:71], v[96:99], v[116:119], v[68:71]
    v_mfma_f32_16x16x32_bf16 v[72:75], v[96:99], v[120:123], v[72:75]
    v_mfma_f32_16x16x32_bf16 v[76:79], v[96:99], v[124:127], v[76:79]
    v_mfma_f32_16x16x32_bf16 v[68:71], v[100:103], v[112:115], v[68:71]
    v_mfma_f32_16x16x32_bf16 v[72:75], v[100:103], v[116:119], v[72:75]
    v_mfma_f32_16x16x32_bf16 v[76:79], v[100:103], v[120:123], v[76:79]
    v_mfma_f32_16x16x32_bf16 v[72:75], v[104:107], v[112:115], v[72:75]
    v_mfma_f32_16x16x32_bf16 v[76:79], v[104:107], v[116:119], v[76:79]
    v_mfma_f32_16x16x32_bf16 v[76:79], v[108:111], v[112:115], v[76:79]
    s_waitcnt lgkmcnt(0)
    v_mfma_f32_16x16x32_bf16 v[48:51], v[144:147], v[176:179], v[48:51]
    ds_read_b128 v[112:115], v44 offset:64
    v_mfma_f32_16x16x32_bf16 v[52:55], v[144:147], v[180:183], v[52:55]
    ds_read2_b32 v[80:81], v36 offset0:16 offset1:17
    v_mfma_f32_16x16x32_bf16 v[56:59], v[144:147], v[184:187], v[56:59]
    ds_read2_b32 v[82:83], v36 offset0:18 offset1:19
    v_mfma_f32_16x16x32_bf16 v[60:63], v[144:147], v[188:191], v[60:63]
    ds_read_b128 v[116:119], v44 offset:576
    v_mfma_f32_16x16x32_bf16 v[64:67], v[144:147], v[192:195], v[64:67]
    ds_read2_b32 v[84:85], v37 offset0:16 offset1:17
    v_mfma_f32_16x16x32_bf16 v[68:71], v[144:147], v[196:199], v[68:71]
    ds_read2_b32 v[86:87], v37 offset0:18 offset1:19
    v_mfma_f32_16x16x32_bf16 v[72:75], v[144:147], v[200:203], v[72:75]
    ds_read_b128 v[120:123], v44 offset:1088
    v_mfma_f32_16x16x32_bf16 v[76:79], v[144:147], v[204:207], v[76:79]
    ds_read2_b32 v[88:89], v38 offset0:16 offset1:17
    v_mfma_f32_16x16x32_bf16 v[52:55], v[148:151], v[176:179], v[52:55]
    ds_read2_b32 v[90:91], v38 offset0:18 offset1:19
    v_mfma_f32_16x16x32_bf16 v[56:59], v[148:151], v[180:183], v[56:59]
    ds_read_b128 v[124:127], v44 offset:1600
    v_mfma_f32_16x16x32_bf16 v[60:63], v[148:151], v[184:187], v[60:63]
    ds_read2_b32 v[92:93], v39 offset0:16 offset1:17
    v_mfma_f32_16x16x32_bf16 v[64:67], v[148:151], v[188:191], v[64:67]
    ds_read2_b32 v[94:95], v39 offset0:18 offset1:19
    v_mfma_f32_16x16x32_bf16 v[68:71], v[148:151], v[192:195], v[68:71]
    ds_read_b128 v[128:131], v44 offset:2112
    v_mfma_f32_16x16x32_bf16 v[72:75], v[148:151], v[196:199], v[72:75]
    ds_read2_b32 v[96:97], v40 offset0:16 offset1:17
    v_mfma_f32_16x16x32_bf16 v[76:79], v[148:151], v[200:203], v[76:79]
    ds_read2_b32 v[98:99], v40 offset0:18 offset1:19
    v_mfma_f32_16x16x32_bf16 v[56:59], v[152:155], v[176:179], v[56:59]
    ds_read_b128 v[132:135], v44 offset:2624
    v_mfma_f32_16x16x32_bf16 v[60:63], v[152:155], v[180:183], v[60:63]
    ds_read2_b32 v[100:101], v41 offset0:16 offset1:17
    v_mfma_f32_16x16x32_bf16 v[64:67], v[152:155], v[184:187], v[64:67]
    ds_read2_b32 v[102:103], v41 offset0:18 offset1:19
    v_mfma_f32_16x16x32_bf16 v[68:71], v[152:155], v[188:191], v[68:71]
    ds_read_b128 v[136:139], v44 offset:3136
    v_mfma_f32_16x16x32_bf16 v[72:75], v[152:155], v[192:195], v[72:75]
    ds_read2_b32 v[104:105], v42 offset0:16 offset1:17
    v_mfma_f32_16x16x32_bf16 v[76:79], v[152:155], v[196:199], v[76:79]
    ds_read2_b32 v[106:107], v42 offset0:18 offset1:19
    v_mfma_f32_16x16x32_bf16 v[60:63], v[156:159], v[176:179], v[60:63]
    ds_read_b128 v[140:143], v44 offset:3648
    v_mfma_f32_16x16x32_bf16 v[64:67], v[156:159], v[180:183], v[64:67]
    ds_read2_b32 v[108:109], v43 offset0:16 offset1:17
    v_mfma_f32_16x16x32_bf16 v[68:71], v[156:159], v[184:187], v[68:71]
    ds_read2_b32 v[110:111], v43 offset0:18 offset1:19
    v_mfma_f32_16x16x32_bf16 v[72:75], v[156:159], v[188:191], v[72:75]
    v_mfma_f32_16x16x32_bf16 v[76:79], v[156:159], v[192:195], v[76:79]
    v_mfma_f32_16x16x32_bf16 v[64:67], v[160:163], v[176:179], v[64:67]
    v_mfma_f32_16x16x32_bf16 v[68:71], v[160:163], v[180:183], v[68:71]
    v_mfma_f32_16x16x32_bf16 v[72:75], v[160:163], v[184:187], v[72:75]
    v_mfma_f32_16x16x32_bf16 v[76:79], v[160:163], v[188:191], v[76:79]
    v_mfma_f32_16x16x32_bf16 v[68:71], v[164:167], v[176:179], v[68:71]
    v_mfma_f32_16x16x32_bf16 v[72:75], v[164:167], v[180:183], v[72:75]
    v_mfma_f32_16x16x32_bf16 v[76:79], v[164:167], v[184:187], v[76:79]
    v_mfma_f32_16x16x32_bf16 v[72:75], v[168:171], v[176:179], v[72:75]
    v_mfma_f32_16x16x32_bf16 v[76:79], v[168:171], v[180:183], v[76:79]
    v_mfma_f32_16x16x32_bf16 v[76:79], v[172:175], v[176:179], v[76:79]
    s_waitcnt lgkmcnt(0)
    v_mfma_f32_16x16x32_bf16 v[48:51], v[80:83], v[112:115], v[48:51]
    ds_read_b128 v[176:179], v44 offset:0
    v_mfma_f32_16x16x32_bf16 v[52:55], v[80:83], v[116:119], v[52:55]
    ds_read2_b32 v[144:145], v36 offset0:0 offset1:1
    v_mfma_f32_16x16x32_bf16 v[56:59], v[80:83], v[120:123], v[56:59]
    ds_read2_b32 v[146:147], v36 offset0:2 offset1:3
    v_mfma_f32_16x16x32_bf16 v[60:63], v[80:83], v[124:127], v[60:63]
    ds_read_b128 v[180:183], v44 offset:512
    v_mfma_f32_16x16x32_bf16 v[64:67], v[80:83], v[128:131], v[64:67]
    ds_read2_b32 v[148:149], v37 offset0:0 offset1:1
    v_mfma_f32_16x16x32_bf16 v[68:71], v[80:83], v[132:135], v[68:71]
    ds_read2_b32 v[150:151], v37 offset0:2 offset1:3
    v_mfma_f32_16x16x32_bf16 v[72:75], v[80:83], v[136:139], v[72:75]
    ds_read_b128 v[184:187], v44 offset:1024
    v_mfma_f32_16x16x32_bf16 v[76:79], v[80:83], v[140:143], v[76:79]
    ds_read2_b32 v[152:153], v38 offset0:0 offset1:1
    v_mfma_f32_16x16x32_bf16 v[52:55], v[84:87], v[112:115], v[52:55]
    ds_read2_b32 v[154:155], v38 offset0:2 offset1:3
    v_mfma_f32_16x16x32_bf16 v[56:59], v[84:87], v[116:119], v[56:59]
    ds_read_b128 v[188:191], v44 offset:1536
    v_mfma_f32_16x16x32_bf16 v[60:63], v[84:87], v[120:123], v[60:63]
    ds_read2_b32 v[156:157], v39 offset0:0 offset1:1
    v_mfma_f32_16x16x32_bf16 v[64:67], v[84:87], v[124:127], v[64:67]
    ds_read2_b32 v[158:159], v39 offset0:2 offset1:3
    v_mfma_f32_16x16x32_bf16 v[68:71], v[84:87], v[128:131], v[68:71]
    ds_read_b128 v[192:195], v44 offset:2048
    v_mfma_f32_16x16x32_bf16 v[72:75], v[84:87], v[132:135], v[72:75]
    ds_read2_b32 v[160:161], v40 offset0:0 offset1:1
    v_mfma_f32_16x16x32_bf16 v[76:79], v[84:87], v[136:139], v[76:79]
    ds_read2_b32 v[162:163], v40 offset0:2 offset1:3
    v_mfma_f32_16x16x32_bf16 v[56:59], v[88:91], v[112:115], v[56:59]
    ds_read_b128 v[196:199], v44 offset:2560
    v_mfma_f32_16x16x32_bf16 v[60:63], v[88:91], v[116:119], v[60:63]
    ds_read2_b32 v[164:165], v41 offset0:0 offset1:1
    v_mfma_f32_16x16x32_bf16 v[64:67], v[88:91], v[120:123], v[64:67]
    ds_read2_b32 v[166:167], v41 offset0:2 offset1:3
    v_mfma_f32_16x16x32_bf16 v[68:71], v[88:91], v[124:127], v[68:71]
    ds_read_b128 v[200:203], v44 offset:3072
    v_mfma_f32_16x16x32_bf16 v[72:75], v[88:91], v[128:131], v[72:75]
    ds_read2_b32 v[168:169], v42 offset0:0 offset1:1
    v_mfma_f32_16x16x32_bf16 v[76:79], v[88:91], v[132:135], v[76:79]
    ds_read2_b32 v[170:171], v42 offset0:2 offset1:3
    v_mfma_f32_16x16x32_bf16 v[60:63], v[92:95], v[112:115], v[60:63]
    ds_read_b128 v[204:207], v44 offset:3584
    v_mfma_f32_16x16x32_bf16 v[64:67], v[92:95], v[116:119], v[64:67]
    ds_read2_b32 v[172:173], v43 offset0:0 offset1:1
    v_mfma_f32_16x16x32_bf16 v[68:71], v[92:95], v[120:123], v[68:71]
    ds_read2_b32 v[174:175], v43 offset0:2 offset1:3
    v_mfma_f32_16x16x32_bf16 v[72:75], v[92:95], v[124:127], v[72:75]
    v_mfma_f32_16x16x32_bf16 v[76:79], v[92:95], v[128:131], v[76:79]
    v_mfma_f32_16x16x32_bf16 v[64:67], v[96:99], v[112:115], v[64:67]
    v_mfma_f32_16x16x32_bf16 v[68:71], v[96:99], v[116:119], v[68:71]
    v_mfma_f32_16x16x32_bf16 v[72:75], v[96:99], v[120:123], v[72:75]
    v_mfma_f32_16x16x32_bf16 v[76:79], v[96:99], v[124:127], v[76:79]
    v_mfma_f32_16x16x32_bf16 v[68:71], v[100:103], v[112:115], v[68:71]
    v_mfma_f32_16x16x32_bf16 v[72:75], v[100:103], v[116:119], v[72:75]
    v_mfma_f32_16x16x32_bf16 v[76:79], v[100:103], v[120:123], v[76:79]
    v_mfma_f32_16x16x32_bf16 v[72:75], v[104:107], v[112:115], v[72:75]
    v_mfma_f32_16x16x32_bf16 v[76:79], v[104:107], v[116:119], v[76:79]
    v_mfma_f32_16x16x32_bf16 v[76:79], v[108:111], v[112:115], v[76:79]
    s_waitcnt lgkmcnt(0)
    v_mfma_f32_16x16x32_bf16 v[48:51], v[144:147], v[176:179], v[48:51]
    v_mfma_f32_16x16x32_bf16 v[52:55], v[144:147], v[180:183], v[52:55]
    v_mfma_f32_16x16x32_bf16 v[56:59], v[144:147], v[184:187], v[56:59]
    v_mfma_f32_16x16x32_bf16 v[60:63], v[144:147], v[188:191], v[60:63]
    v_mfma_f32_16x16x32_bf16 v[64:67], v[144:147], v[192:195], v[64:67]
    v_mfma_f32_16x16x32_bf16 v[68:71], v[144:147], v[196:199], v[68:71]
    v_mfma_f32_16x16x32_bf16 v[72:75], v[144:147], v[200:203], v[72:75]
    v_mfma_f32_16x16x32_bf16 v[76:79], v[144:147], v[204:207], v[76:79]
    v_mfma_f32_16x16x32_bf16 v[52:55], v[148:151], v[176:179], v[52:55]
    v_mfma_f32_16x16x32_bf16 v[56:59], v[148:151], v[180:183], v[56:59]
    v_mfma_f32_16x16x32_bf16 v[60:63], v[148:151], v[184:187], v[60:63]
    v_mfma_f32_16x16x32_bf16 v[64:67], v[148:151], v[188:191], v[64:67]
    v_mfma_f32_16x16x32_bf16 v[68:71], v[148:151], v[192:195], v[68:71]
    v_mfma_f32_16x16x32_bf16 v[72:75], v[148:151], v[196:199], v[72:75]
    v_mfma_f32_16x16x32_bf16 v[76:79], v[148:151], v[200:203], v[76:79]
    v_mfma_f32_16x16x32_bf16 v[56:59], v[152:155], v[176:179], v[56:59]
    v_mfma_f32_16x16x32_bf16 v[60:63], v[152:155], v[180:183], v[60:63]
    v_mfma_f32_16x16x32_bf16 v[64:67], v[152:155], v[184:187], v[64:67]
    v_mfma_f32_16x16x32_bf16 v[68:71], v[152:155], v[188:191], v[68:71]
    v_mfma_f32_16x16x32_bf16 v[72:75], v[152:155], v[192:195], v[72:75]
    v_mfma_f32_16x16x32_bf16 v[76:79], v[152:155], v[196:199], v[76:79]
    v_mfma_f32_16x16x32_bf16 v[60:63], v[156:159], v[176:179], v[60:63]
    v_mfma_f32_16x16x32_bf16 v[64:67], v[156:159], v[180:183], v[64:67]
    v_mfma_f32_16x16x32_bf16 v[68:71], v[156:159], v[184:187], v[68:71]
    v_mfma_f32_16x16x32_bf16 v[72:75], v[156:159], v[188:191], v[72:75]
    v_mfma_f32_16x16x32_bf16 v[76:79], v[156:159], v[192:195], v[76:79]
    v_mfma_f32_16x16x32_bf16 v[64:67], v[160:163], v[176:179], v[64:67]
    v_mfma_f32_16x16x32_bf16 v[68:71], v[160:163], v[180:183], v[68:71]
    v_mfma_f32_16x16x32_bf16 v[72:75], v[160:163], v[184:187], v[72:75]
    v_mfma_f32_16x16x32_bf16 v[76:79], v[160:163], v[188:191], v[76:79]
    v_mfma_f32_16x16x32_bf16 v[68:71], v[164:167], v[176:179], v[68:71]
    v_mfma_f32_16x16x32_bf16 v[72:75], v[164:167], v[180:183], v[72:75]
    v_mfma_f32_16x16x32_bf16 v[76:79], v[164:167], v[184:187], v[76:79]
    v_mfma_f32_16x16x32_bf16 v[72:75], v[168:171], v[176:179], v[72:75]
    v_mfma_f32_16x16x32_bf16 v[76:79], v[168:171], v[180:183], v[76:79]
    v_mfma_f32_16x16x32_bf16 v[76:79], v[172:175], v[176:179], v[76:79]
    s_nop 7
    v_lshlrev_b32 v5, 6, v2
    v_lshl_add_u32 v5, v3, 4, v5
    v_add_u32 v5, v5, v4
    ds_write_b128 v5, v[48:51] offset:7424
    ds_write_b128 v5, v[52:55] offset:8448
    ds_write_b128 v5, v[56:59] offset:9472
    ds_write_b128 v5, v[60:63] offset:10496
    ds_write_b128 v5, v[64:67] offset:11520
    ds_write_b128 v5, v[68:71] offset:12544
    ds_write_b128 v5, v[72:75] offset:13568
    ds_write_b128 v5, v[76:79] offset:14592
    v_mov_b64 v[8:9], v[16:17]
    v_mov_b64 v[10:11], v[18:19]
    v_mov_b64 v[12:13], v[20:21]
    v_mov_b64 v[14:15], v[22:23]
    v_mov_b32 v24, v25
    v_add_u32 v4, 65536, v4
    s_add_u32 s28, s28, 1
    s_cmp_lt_u32 s28, 2
    s_waitcnt lgkmcnt(0)
    s_cbranch_scc1 ss_pass
    s_mov_b32 s12, s74
    s_mov_b32 s13, s75
    s_mov_b32 s14, 1152
    s_mov_b32 s15, 0x20000
    s_lshl_b32 s23, s20, 1
    buffer_load_dwordx4 v[8:11], off, s[12:15], s23
    s_barrier
    v_lshlrev_b32 v5, 5, v0
    v_add_u32 v7, 65536, v5
    ds_read_b128 v[64:67], v5 offset:7424
    ds_read_b128 v[68:71], v5 offset:7440
    ds_read_b128 v[72:75], v5 offset:23808
    ds_read_b128 v[76:79], v5 offset:23824
    ds_read_b128 v[80:83], v5 offset:40192
    ds_read_b128 v[84:87], v5 offset:40208
    ds_read_b128 v[88:91], v5 offset:56576
    ds_read_b128 v[92:95], v5 offset:56592
    ds_read_b128 v[96:99], v7 offset:7424
    ds_read_b128 v[100:103], v7 offset:7440
    ds_read_b128 v[104:107], v7 offset:23808
    ds_read_b128 v[108:111], v7 offset:23824
    ds_read_b128 v[112:115], v7 offset:40192
    ds_read_b128 v[116:119], v7 offset:40208
    ds_read_b128 v[120:123], v7 offset:56576
    ds_read_b128 v[124:127], v7 offset:56592
    s_waitcnt vmcnt(0)
    v_lshlrev_b32 v12, 16, v8
    v_and_b32 v13, 0xffff0000, v8
    v_lshlrev_b32 v14, 16, v9
    v_and_b32 v15, 0xffff0000, v9
    v_lshlrev_b32 v16, 16, v10
    v_and_b32 v17, 0xffff0000, v10
    v_lshlrev_b32 v18, 16, v11
    v_and_b32 v19, 0xffff0000, v11
    v_mul_u32_u24 v5, 18432, v0
    s_lshl_b32 s22, s20, 1
    s_add_u32 s22, s22, 1152
    s_waitcnt lgkmcnt(0)
    v_lshlrev_b32 v6, 16, v208
    v_fmac_f32 v64, v6, v12
    v_and_b32 v6, 0xffff0000, v208
    v_fmac_f32 v72, v6, v13
    v_lshlrev_b32 v6, 16, v209
    v_fmac_f32 v80, v6, v14
    v_and_b32 v6, 0xffff0000, v209
    v_fmac_f32 v88, v6, v15
    v_lshlrev_b32 v6, 16, v210
    v_fmac_f32 v96, v6, v16
    v_and_b32 v6, 0xffff0000, v210
    v_fmac_f32 v104, v6, v17
    v_lshlrev_b32 v6, 16, v211
    v_fmac_f32 v112, v6, v18
    v_and_b32 v6, 0xffff0000, v211
    v_fmac_f32 v120, v6, v19
    v_cvt_pk_bf16_f32 v208, v64, v72
    v_cvt_pk_bf16_f32 v209, v80, v88
    v_cvt_pk_bf16_f32 v210, v96, v104
    v_cvt_pk_bf16_f32 v211, v112, v120
    s_add_u32 s23, s22, 0
    buffer_store_dwordx4 v[208:211], v5, s[16:19], s23 offen
    v_lshlrev_b32 v6, 16, v212
    v_fmac_f32 v65, v6, v12
    v_and_b32 v6, 0xffff0000, v212
    v_fmac_f32 v73, v6, v13
    v_lshlrev_b32 v6, 16, v213
    v_fmac_f32 v81, v6, v14
    v_and_b32 v6, 0xffff0000, v213
    v_fmac_f32 v89, v6, v15
    v_lshlrev_b32 v6, 16, v214
    v_fmac_f32 v97, v6, v16
    v_and_b32 v6, 0xffff0000, v214
    v_fmac_f32 v105, v6, v17
    v_lshlrev_b32 v6, 16, v215
    v_fmac_f32 v113, v6, v18
    v_and_b32 v6, 0xffff0000, v215
    v_fmac_f32 v121, v6, v19
    v_cvt_pk_bf16_f32 v212, v65, v73
    v_cvt_pk_bf16_f32 v213, v81, v89
    v_cvt_pk_bf16_f32 v214, v97, v105
    v_cvt_pk_bf16_f32 v215, v113, v121
    s_add_u32 s23, s22, 2304
    buffer_store_dwordx4 v[212:215], v5, s[16:19], s23 offen
    v_lshlrev_b32 v6, 16, v216
    v_fmac_f32 v66, v6, v12
    v_and_b32 v6, 0xffff0000, v216
    v_fmac_f32 v74, v6, v13
    v_lshlrev_b32 v6, 16, v217
    v_fmac_f32 v82, v6, v14
    v_and_b32 v6, 0xffff0000, v217
    v_fmac_f32 v90, v6, v15
    v_lshlrev_b32 v6, 16, v218
    v_fmac_f32 v98, v6, v16
    v_and_b32 v6, 0xffff0000, v218
    v_fmac_f32 v106, v6, v17
    v_lshlrev_b32 v6, 16, v219
    v_fmac_f32 v114, v6, v18
    v_and_b32 v6, 0xffff0000, v219
    v_fmac_f32 v122, v6, v19
    v_cvt_pk_bf16_f32 v216, v66, v74
    v_cvt_pk_bf16_f32 v217, v82, v90
    v_cvt_pk_bf16_f32 v218, v98, v106
    v_cvt_pk_bf16_f32 v219, v114, v122
    s_add_u32 s23, s22, 4608
    buffer_store_dwordx4 v[216:219], v5, s[16:19], s23 offen
    v_lshlrev_b32 v6, 16, v220
    v_fmac_f32 v67, v6, v12
    v_and_b32 v6, 0xffff0000, v220
    v_fmac_f32 v75, v6, v13
    v_lshlrev_b32 v6, 16, v221
    v_fmac_f32 v83, v6, v14
    v_and_b32 v6, 0xffff0000, v221
    v_fmac_f32 v91, v6, v15
    v_lshlrev_b32 v6, 16, v222
    v_fmac_f32 v99, v6, v16
    v_and_b32 v6, 0xffff0000, v222
    v_fmac_f32 v107, v6, v17
    v_lshlrev_b32 v6, 16, v223
    v_fmac_f32 v115, v6, v18
    v_and_b32 v6, 0xffff0000, v223
    v_fmac_f32 v123, v6, v19
    v_cvt_pk_bf16_f32 v220, v67, v75
    v_cvt_pk_bf16_f32 v221, v83, v91
    v_cvt_pk_bf16_f32 v222, v99, v107
    v_cvt_pk_bf16_f32 v223, v115, v123
    s_add_u32 s23, s22, 6912
    buffer_store_dwordx4 v[220:223], v5, s[16:19], s23 offen
    v_lshlrev_b32 v6, 16, v224
    v_fmac_f32 v68, v6, v12
    v_and_b32 v6, 0xffff0000, v224
    v_fmac_f32 v76, v6, v13
    v_lshlrev_b32 v6, 16, v225
    v_fmac_f32 v84, v6, v14
    v_and_b32 v6, 0xffff0000, v225
    v_fmac_f32 v92, v6, v15
    v_lshlrev_b32 v6, 16, v226
    v_fmac_f32 v100, v6, v16
    v_and_b32 v6, 0xffff0000, v226
    v_fmac_f32 v108, v6, v17
    v_lshlrev_b32 v6, 16, v227
    v_fmac_f32 v116, v6, v18
    v_and_b32 v6, 0xffff0000, v227
    v_fmac_f32 v124, v6, v19
    v_cvt_pk_bf16_f32 v224, v68, v76
    v_cvt_pk_bf16_f32 v225, v84, v92
    v_cvt_pk_bf16_f32 v226, v100, v108
    v_cvt_pk_bf16_f32 v227, v116, v124
    s_add_u32 s23, s22, 9216
    buffer_store_dwordx4 v[224:227], v5, s[16:19], s23 offen
    v_lshlrev_b32 v6, 16, v228
    v_fmac_f32 v69, v6, v12
    v_and_b32 v6, 0xffff0000, v228
    v_fmac_f32 v77, v6, v13
    v_lshlrev_b32 v6, 16, v229
    v_fmac_f32 v85, v6, v14
    v_and_b32 v6, 0xffff0000, v229
    v_fmac_f32 v93, v6, v15
    v_lshlrev_b32 v6, 16, v230
    v_fmac_f32 v101, v6, v16
    v_and_b32 v6, 0xffff0000, v230
    v_fmac_f32 v109, v6, v17
    v_lshlrev_b32 v6, 16, v231
    v_fmac_f32 v117, v6, v18
    v_and_b32 v6, 0xffff0000, v231
    v_fmac_f32 v125, v6, v19
    v_cvt_pk_bf16_f32 v228, v69, v77
    v_cvt_pk_bf16_f32 v229, v85, v93
    v_cvt_pk_bf16_f32 v230, v101, v109
    v_cvt_pk_bf16_f32 v231, v117, v125
    s_add_u32 s23, s22, 11520
    buffer_store_dwordx4 v[228:231], v5, s[16:19], s23 offen
    v_lshlrev_b32 v6, 16, v232
    v_fmac_f32 v70, v6, v12
    v_and_b32 v6, 0xffff0000, v232
    v_fmac_f32 v78, v6, v13
    v_lshlrev_b32 v6, 16, v233
    v_fmac_f32 v86, v6, v14
    v_and_b32 v6, 0xffff0000, v233
    v_fmac_f32 v94, v6, v15
    v_lshlrev_b32 v6, 16, v234
    v_fmac_f32 v102, v6, v16
    v_and_b32 v6, 0xffff0000, v234
    v_fmac_f32 v110, v6, v17
    v_lshlrev_b32 v6, 16, v235
    v_fmac_f32 v118, v6, v18
    v_and_b32 v6, 0xffff0000, v235
    v_fmac_f32 v126, v6, v19
    v_cvt_pk_bf16_f32 v232, v70, v78
    v_cvt_pk_bf16_f32 v233, v86, v94
    v_cvt_pk_bf16_f32 v234, v102, v110
    v_cvt_pk_bf16_f32 v235, v118, v126
    s_add_u32 s23, s22, 13824
    buffer_store_dwordx4 v[232:235], v5, s[16:19], s23 offen
    v_lshlrev_b32 v6, 16, v236
    v_fmac_f32 v71, v6, v12
    v_and_b32 v6, 0xffff0000, v236
    v_fmac_f32 v79, v6, v13
    v_lshlrev_b32 v6, 16, v237
    v_fmac_f32 v87, v6, v14
    v_and_b32 v6, 0xffff0000, v237
    v_fmac_f32 v95, v6, v15
    v_lshlrev_b32 v6, 16, v238
    v_fmac_f32 v103, v6, v16
    v_and_b32 v6, 0xffff0000, v238
    v_fmac_f32 v111, v6, v17
    v_lshlrev_b32 v6, 16, v239
    v_fmac_f32 v119, v6, v18
    v_and_b32 v6, 0xffff0000, v239
    v_fmac_f32 v127, v6, v19
    v_cvt_pk_bf16_f32 v236, v71, v79
    v_cvt_pk_bf16_f32 v237, v87, v95
    v_cvt_pk_bf16_f32 v238, v103, v111
    v_cvt_pk_bf16_f32 v239, v119, v127
    s_add_u32 s23, s22, 16128
    buffer_store_dwordx4 v[236:239], v5, s[16:19], s23 offen
    s_branch L_ssm_next
L_ssm_done:
    s_cmp_lt_u32 s93, 100
    s_cbranch_scc1 L_exit
    s_mov_b32 s8, s76
    s_mov_b32 s9, s77
    s_mov_b32 s10, 4718592
    s_mov_b32 s11, 0x20000
    s_cmp_le_u32 s45, 1
    s_cbranch_scc1 L_att_next
    s_branch L_op_nextcb
L_wf_next:
    s_mov_b32 s37, 20
    v_mov_b32 v250, 1
    v_mov_b32 v251, 163832
    v_cmp_eq_u32 vcc, 0, v0
    s_nop 0
    s_and_saveexec_b64 s[38:39], vcc
    s_cbranch_execz tk13
    buffer_atomic_add v250, off, s[84:87], s37 sc0
    s_waitcnt vmcnt(0)
    ds_write_b32 v251, v250
    s_waitcnt lgkmcnt(0)
tk13:
    s_mov_b64 exec, -1
    s_barrier
    ds_read_b32 v252, v251
    s_waitcnt lgkmcnt(0)
    v_readfirstlane_b32 s33, v252
    s_barrier
    s_nop 3
    s_cmp_ge_u32 s33, 160
    s_cbranch_scc1 L_ssm_next
    s_lshl_b32 s16, s33, 2
    s_add_u32 s16, s16, s32
    s_add_u32 s16, s16, 1504
    s_call_b64 s[46:47], L_xform
    s_cmp_lg_u32 s95, 0
    s_cbranch_scc1 L_wfn
    s_mov_b32 s88, 4194304
gn14:
    buffer_load_dword v250, off, s[84:87], 0 offset:216 sc1
    s_waitcnt vmcnt(0)
    v_readfirstlane_b32 s95, v250
    s_sub_u32 s88, s88, 1
    s_cbranch_scc1 gn14x
    s_cmp_eq_u32 s95, 0
    s_cbranch_scc1 gn14
gn14x:
L_wfn:
    s_lshl_b32 s40, s33, 2
    s_add_u32 s40, s40, 125841408
    s_waitcnt vmcnt(0)
    s_barrier
    v_mov_b32 v250, s95
    v_cmp_eq_u32 vcc, 0, v0
    s_nop 0
    s_and_saveexec_b64 s[38:39], vcc
    s_cbranch_execz fs15
    buffer_store_dword v250, off, s[4:7], s40 sc1
fs15:
    s_mov_b64 exec, -1
    s_branch L_wf_next
L_phase2:
    s_mov_b32 s40, 524288
mc2_w:
    buffer_load_dword v250, off, s[84:87], 0 offset:28 sc1
    s_waitcnt vmcnt(0)
    v_readfirstlane_b32 s41, v250
    s_nop 0
    s_cmp_lg_u32 s41, 0
    s_cbranch_scc1 mc2_known
    s_sub_u32 s40, s40, 1
    s_cbranch_scc1 mc2_force
    s_sleep 2
    s_branch mc2_w
mc2_force:
    v_mov_b32 v250, 2
    v_mov_b32 v251, 0
    s_mov_b64 exec, 1
    buffer_atomic_cmpswap v[250:251], off, s[84:87], 0 offset:28
    s_mov_b64 exec, -1
    s_waitcnt vmcnt(0)
    s_mov_b32 s40, 524288
    s_branch mc2_w
mc2_known:
    s_cmp_eq_u32 s41, 1
    s_cbranch_scc1 L_phase2b
    s_mov_b32 s37, 208
    v_mov_b32 v250, 1
    v_mov_b32 v251, 163832
    v_cmp_eq_u32 vcc, 0, v0
    s_nop 0
    s_and_saveexec_b64 s[38:39], vcc
    s_cbranch_execz tk16
    buffer_atomic_add v250, off, s[84:87], s37 sc0
    s_waitcnt vmcnt(0)
    ds_write_b32 v251, v250
    s_waitcnt lgkmcnt(0)
tk16:
    s_mov_b64 exec, -1
    s_barrier
    ds_read_b32 v252, v251
    s_waitcnt lgkmcnt(0)
    v_readfirstlane_b32 s12, v252
    s_barrier
    s_nop 3
    s_cmp_lt_u32 s12, 32
    s_cbranch_scc1 L_chain_safe
    s_sub_u32 s45, s12, 32
L_phase2b:
    s_mov_b32 s8, s76
    s_mov_b32 s9, s77
    s_mov_b32 s10, 4718592
    s_mov_b32 s11, 0x20000
    s_and_b32 s36, s45, 15
    s_bitcmp1_b32 42315, s36
    s_cbranch_scc0 L_nots
    s_cmp_eq_u32 s93, 500
    s_cbranch_scc1 L_ssm_next
    s_branch L_wf_next
L_nots:
    s_bitcmp1_b32 18576, s36
    s_cbranch_scc0 L_att_next
    s_bfm_b32 s37, s36, 0
    s_and_b32 s37, s37, 18576
    s_bcnt1_i32_b32 s37, s37
    s_lshr_b32 s40, s45, 4
    s_mul_i32 s40, s40, 4
    s_add_u32 s33, s40, s37
L_op_mod:
    s_mul_hi_u32 s41, s33, 0x0e38e38f
    s_mul_i32 s41, s41, 18
    s_sub_u32 s33, s33, s41
    s_branch L_op_start
L_att_next:
    s_mov_b32 s37, 16
    v_mov_b32 v250, 1
    v_mov_b32 v251, 163832
    v_cmp_eq_u32 vcc, 0, v0
    s_nop 0
    s_and_saveexec_b64 s[38:39], vcc
    s_cbranch_execz tk17
    buffer_atomic_add v250, off, s[84:87], s37 sc0
    s_waitcnt vmcnt(0)
    ds_write_b32 v251, v250
    s_waitcnt lgkmcnt(0)
tk17:
    s_mov_b64 exec, -1
    s_barrier
    ds_read_b32 v252, v251
    s_waitcnt lgkmcnt(0)
    v_readfirstlane_b32 s34, v252
    s_barrier
    s_nop 3
    s_cmp_ge_u32 s34, 512
    s_cbranch_scc1 L_op_nextcb
    s_lshr_b32 s16, s34, 3
    s_and_b32 s17, s34, 7
    s_lshl_b32 s17, s17, 2
    s_add_u32 s17, s17, s32
    s_lshr_b32 s36, s17, 1
    s_lshl_b32 s36, s36, 11
    s_add_u32 s36, s36, 126091264
    s_lshr_b32 s41, s16, 2
    s_add_u32 s41, s41, s95
    s_add_u32 s41, s41, 1
    v_and_b32 v1, 3, v0
    v_min_u32 v1, 2, v1
    v_lshlrev_b32 v2, 9, v1
    s_and_b32 s37, s16, 3
    s_lshl_b32 s37, s37, 7
    v_add_u32 v2, s37, v2
    s_mov_b32 s40, 4194304
L_aw1:
    buffer_load_dword v3, v2, s[4:7], s36 offen sc1
    s_sub_u32 s40, s40, 1
    s_cbranch_scc1 L_aw1_go
    s_waitcnt vmcnt(0)
    v_subrev_u32 v3, s41, v3
    v_cmp_lt_u32 vcc, 64, v3
    s_cbranch_vccz L_aw1_go
    s_sleep 4
    s_branch L_aw1
L_aw1_go:
    v_and_b32 v5, 63, v0
    v_lshlrev_b32 v1, 4, v5
    s_cmp_ge_u32 s16, 56
    s_cselect_b32 s18, -1, 511
    v_and_b32 v2, s18, v1
    v_or_b32 v3, 128, v1
    v_lshrrev_b32 v4, 4, v5
    v_bfe_u32 v6, v5, 2, 2
    v_sub_u32 v4, v6, v4
    v_lshlrev_b32 v4, 3, v4
    v_and_b32 v6, 3, v5
    v_add_u32 v4, v4, v6
    v_mov_b32 v6, 0xf149f2ca
    s_mov_b32 s22, 0x3e0293ee
    s_lshl_b32 s18, s16, 5
    s_add_u32 s18, s18, s17
    s_lshl_b32 s19, s18, 13
    s_add_u32 s20, s19, 33554432
    buffer_load_dwordx4 v[8:11], v1, s[4:7], s20 offen offset:0 sc1
    s_add_u32 s20, s19, 33554432
    buffer_load_dwordx4 v[12:15], v1, s[4:7], s20 offen offset:1024 sc1
    s_add_u32 s20, s19, 33554432
    buffer_load_dwordx4 v[16:19], v1, s[4:7], s20 offen offset:2048 sc1
    s_add_u32 s20, s19, 33554432
    buffer_load_dwordx4 v[20:23], v1, s[4:7], s20 offen offset:3072 sc1
    s_add_u32 s20, s19, 33558528
    buffer_load_dwordx4 v[24:27], v1, s[4:7], s20 offen offset:0 sc1
    s_add_u32 s20, s19, 33558528
    buffer_load_dwordx4 v[28:31], v1, s[4:7], s20 offen offset:1024 sc1
    s_add_u32 s20, s19, 33558528
    buffer_load_dwordx4 v[32:35], v1, s[4:7], s20 offen offset:2048 sc1
    s_add_u32 s20, s19, 33558528
    buffer_load_dwordx4 v[36:39], v1, s[4:7], s20 offen offset:3072 sc1
    s_mul_i32 s21, s16, 524288
    s_mul_i32 s20, s17, 16384
    s_add_u32 s21, s21, s20
    s_add_u32 s20, s21, 0
    buffer_load_dwordx4 v[40:43], v1, s[4:7], s20 offen offset:0 sc1
    s_add_u32 s20, s21, 4096
    buffer_load_dwordx4 v[44:47], v1, s[4:7], s20 offen offset:0 sc1
    s_add_u32 s20, s21, 8192
    buffer_load_dwordx4 v[48:51], v1, s[4:7], s20 offen offset:0 sc1
    s_add_u32 s20, s21, 12288
    buffer_load_dwordx4 v[52:55], v1, s[4:7], s20 offen offset:0 sc1
    s_add_u32 s20, s21, 0
    buffer_load_dwordx4 v[56:59], v1, s[4:7], s20 offen offset:1024 sc1
    s_add_u32 s20, s21, 4096
    buffer_load_dwordx4 v[60:63], v1, s[4:7], s20 offen offset:1024 sc1
    s_add_u32 s20, s21, 8192
    buffer_load_dwordx4 v[64:67], v1, s[4:7], s20 offen offset:1024 sc1
    s_add_u32 s20, s21, 12288
    buffer_load_dwordx4 v[68:71], v1, s[4:7], s20 offen offset:1024 sc1
    s_add_u32 s20, s21, 0
    buffer_load_dwordx4 v[88:91], v1, s[4:7], s20 offen offset:2048 sc1
    s_add_u32 s20, s21, 4096
    buffer_load_dwordx4 v[92:95], v1, s[4:7], s20 offen offset:2048 sc1
    s_add_u32 s20, s21, 8192
    buffer_load_dwordx4 v[96:99], v1, s[4:7], s20 offen offset:2048 sc1
    s_add_u32 s20, s21, 12288
    buffer_load_dwordx4 v[100:103], v1, s[4:7], s20 offen offset:2048 sc1
    s_add_u32 s20, s21, 0
    buffer_load_dwordx4 v[104:107], v1, s[4:7], s20 offen offset:3072 sc1
    s_add_u32 s20, s21, 4096
    buffer_load_dwordx4 v[108:111], v1, s[4:7], s20 offen offset:3072 sc1
    s_add_u32 s20, s21, 8192
    buffer_load_dwordx4 v[112:115], v1, s[4:7], s20 offen offset:3072 sc1
    s_add_u32 s20, s21, 12288
    buffer_load_dwordx4 v[116:119], v1, s[4:7], s20 offen offset:3072 sc1
    v_mov_b32 v172, 0x3f803f80
    v_mov_b32 v173, 0x3f803f80
    v_mov_b32 v174, 0x3f803f80
    v_mov_b32 v175, 0x3f803f80
    v_mov_b32 v176, 0x3f003f00
    v_mov_b32 v177, 0x3f003f00
    s_waitcnt vmcnt(8)
    v_mfma_f32_16x16x32_bf16 v[136:139], v[40:43], v[8:11], 0
    v_mfma_f32_16x16x32_bf16 v[140:143], v[56:59], v[8:11], 0
    v_mfma_f32_16x16x32_bf16 v[148:151], v[40:43], v[24:27], 0
    v_mfma_f32_16x16x32_bf16 v[152:155], v[56:59], v[24:27], 0
    v_mfma_f32_16x16x32_bf16 v[136:139], v[44:47], v[12:15], v[136:139]
    v_mfma_f32_16x16x32_bf16 v[140:143], v[60:63], v[12:15], v[140:143]
    v_mfma_f32_16x16x32_bf16 v[148:151], v[44:47], v[28:31], v[148:151]
    v_mfma_f32_16x16x32_bf16 v[152:155], v[60:63], v[28:31], v[152:155]
    v_mfma_f32_16x16x32_bf16 v[136:139], v[48:51], v[16:19], v[136:139]
    v_mfma_f32_16x16x32_bf16 v[140:143], v[64:67], v[16:19], v[140:143]
    v_mfma_f32_16x16x32_bf16 v[148:151], v[48:51], v[32:35], v[148:151]
    v_mfma_f32_16x16x32_bf16 v[152:155], v[64:67], v[32:35], v[152:155]
    v_mfma_f32_16x16x32_bf16 v[136:139], v[52:55], v[20:23], v[136:139]
    v_mfma_f32_16x16x32_bf16 v[140:143], v[68:71], v[20:23], v[140:143]
    v_mfma_f32_16x16x32_bf16 v[148:151], v[52:55], v[36:39], v[148:151]
    v_mfma_f32_16x16x32_bf16 v[152:155], v[68:71], v[36:39], v[152:155]
    v_cmp_le_i32 vcc, 0, v4
    s_nop 3
    v_cndmask_b32 v136, v6, v136, vcc
    v_cmp_le_i32 vcc, 1, v4
    s_nop 1
    v_cndmask_b32 v137, v6, v137, vcc
    v_cmp_le_i32 vcc, 2, v4
    s_nop 1
    v_cndmask_b32 v138, v6, v138, vcc
    v_cmp_le_i32 vcc, 3, v4
    s_nop 1
    v_cndmask_b32 v139, v6, v139, vcc
    v_cmp_le_i32 vcc, 4, v4
    s_nop 1
    v_cndmask_b32 v140, v6, v140, vcc
    v_cmp_le_i32 vcc, 5, v4
    s_nop 1
    v_cndmask_b32 v141, v6, v141, vcc
    v_cmp_le_i32 vcc, 6, v4
    s_nop 1
    v_cndmask_b32 v142, v6, v142, vcc
    v_cmp_le_i32 vcc, 7, v4
    s_nop 1
    v_cndmask_b32 v143, v6, v143, vcc
    v_cmp_le_i32 vcc, -4, v4
    s_nop 1
    v_cndmask_b32 v148, v6, v148, vcc
    v_cmp_le_i32 vcc, -3, v4
    s_nop 1
    v_cndmask_b32 v149, v6, v149, vcc
    v_cmp_le_i32 vcc, -2, v4
    s_nop 1
    v_cndmask_b32 v150, v6, v150, vcc
    v_cmp_le_i32 vcc, -1, v4
    s_nop 1
    v_cndmask_b32 v151, v6, v151, vcc
    v_cmp_le_i32 vcc, 0, v4
    s_nop 1
    v_cndmask_b32 v152, v6, v152, vcc
    v_cmp_le_i32 vcc, 1, v4
    s_nop 1
    v_cndmask_b32 v153, v6, v153, vcc
    v_cmp_le_i32 vcc, 2, v4
    s_nop 1
    v_cndmask_b32 v154, v6, v154, vcc
    v_cmp_le_i32 vcc, 3, v4
    s_nop 1
    v_cndmask_b32 v155, v6, v155, vcc
    s_nop 1
    v_and_b32 v198, 1, v0
    v_lshlrev_b32 v198, 7, v198
    v_add_u32 v198, 1536, v198
    s_add_u32 s41, s16, s95
    s_add_u32 s41, s41, 1
    s_cmp_lt_u32 s16, 56
    s_cbranch_scc1 L_amk
    s_lshl_b32 s36, s17, 7
    s_add_u32 s36, s36, 125845504
    v_mov_b32 v198, 0
    s_sub_u32 s41, s41, 1
    s_mov_b32 s44, 8
L_amk:
    s_sub_u32 s43, s41, s95
    s_sub_u32 s43, s43, 1
    s_mov_b32 s88, 65536
    s_mov_b32 s89, 125853696
cw18:
    buffer_load_dword v199, off, s[4:7], s89 sc1
    s_waitcnt vmcnt(0)
    v_readfirstlane_b32 s42, v199
    s_nop 0
    s_sub_u32 s42, s42, s95
    s_cmp_gt_u32 s42, 64
    s_cselect_b32 s42, 0, s42
    s_add_u32 s42, s42, 1
    s_cmp_ge_u32 s42, s43
    s_cbranch_scc1 cw18x
    s_sub_u32 s88, s88, 1
    s_cbranch_scc1 cw18x
    s_sub_u32 s42, s43, s42
    s_min_u32 s42, s42, 6
cw18s:
    s_sleep 24
    s_sub_u32 s42, s42, 1
    s_cmp_lg_u32 s42, 0
    s_cbranch_scc1 cw18s
    s_branch cw18
cw18x:
    s_mov_b32 s40, 4194304
L_aw2:
    buffer_load_dword v199, v198, s[4:7], s36 offen sc1
    s_sub_u32 s40, s40, 1
    s_cbranch_scc1 L_aw2_go
    s_waitcnt vmcnt(0)
    v_subrev_u32 v199, s41, v199
    v_cmp_lt_u32 vcc, 64, v199
    s_cbranch_vccz L_aw2_go
    s_sleep 1
    s_branch L_aw2
L_aw2_go:
at_ldm:
    s_lshl_b32 s20, s18, 12
    s_add_u32 s20, s20, 69206016
    buffer_load_dwordx4 v[72:75], v3, s[4:7], s20 offen offset:0 sc1
    buffer_load_dwordx4 v[76:79], v3, s[4:7], s20 offen offset:1024 sc1
    buffer_load_dwordx4 v[80:83], v3, s[4:7], s20 offen offset:2048 sc1
    buffer_load_dwordx4 v[84:87], v3, s[4:7], s20 offen offset:3072 sc1
    s_lshl_b32 s20, s18, 12
    s_add_u32 s20, s20, 77594624
    buffer_load_dwordx4 v[120:123], v2, s[4:7], s20 offen offset:0 sc1
    buffer_load_dwordx4 v[124:127], v2, s[4:7], s20 offen offset:1024 sc1
    buffer_load_dwordx4 v[128:131], v2, s[4:7], s20 offen offset:2048 sc1
    buffer_load_dwordx4 v[132:135], v2, s[4:7], s20 offen offset:3072 sc1
    s_cmp_lt_u32 s16, 56
    s_cbranch_scc1 at_ok
    s_waitcnt vmcnt(0)
    v_max_u32 v196, v72, v73
    v_max3_u32 v196, v196, v74, v75
    v_max3_u32 v196, v196, v76, v77
    v_max3_u32 v196, v196, v78, v79
    v_max3_u32 v196, v196, v80, v81
    v_max3_u32 v196, v196, v82, v83
    v_max3_u32 v196, v196, v84, v85
    v_max3_u32 v196, v196, v86, v87
    v_max3_u32 v196, v196, v120, v121
    v_max3_u32 v196, v196, v122, v123
    v_max3_u32 v196, v196, v124, v125
    v_max3_u32 v196, v196, v126, v127
    v_max3_u32 v196, v196, v128, v129
    v_max3_u32 v196, v196, v130, v131
    v_max3_u32 v196, v196, v132, v133
    v_max3_u32 v196, v196, v134, v135
    v_cmp_eq_u32 vcc, -1, v196
    s_cbranch_vccz at_ok
    s_sub_u32 s44, s44, 1
    s_cbranch_scc1 at_ok
    s_cmp_lg_u32 s44, 0
    s_cbranch_scc1 at_ldm
    s_add_u32 s41, s41, 1
    s_mov_b32 s40, 4194304
L_aw3:
    buffer_load_dword v199, v198, s[4:7], s36 offen sc1
    s_sub_u32 s40, s40, 1
    s_cbranch_scc1 L_aw3_go
    s_waitcnt vmcnt(0)
    v_subrev_u32 v199, s41, v199
    v_cmp_lt_u32 vcc, 64, v199
    s_cbranch_vccz L_aw3_go
    s_sleep 1
    s_branch L_aw3
L_aw3_go:
    s_branch at_ldm
at_ok:
    s_waitcnt vmcnt(4)
    v_mfma_f32_16x16x32_bf16 v[144:147], v[72:75], v[8:11], 0
    v_mfma_f32_16x16x32_bf16 v[156:159], v[72:75], v[24:27], 0
    v_mfma_f32_16x16x32_bf16 v[144:147], v[76:79], v[12:15], v[144:147]
    v_mfma_f32_16x16x32_bf16 v[156:159], v[76:79], v[28:31], v[156:159]
    v_mfma_f32_16x16x32_bf16 v[144:147], v[80:83], v[16:19], v[144:147]
    v_mfma_f32_16x16x32_bf16 v[156:159], v[80:83], v[32:35], v[156:159]
    v_mfma_f32_16x16x32_bf16 v[144:147], v[84:87], v[20:23], v[144:147]
    v_mfma_f32_16x16x32_bf16 v[156:159], v[84:87], v[36:39], v[156:159]
    v_max3_f32 v196, v136, v137, v138
    v_max3_f32 v197, v139, v140, v141
    v_max3_f32 v196, v196, v142, v143
    s_nop 3
    v_max3_f32 v197, v197, v144, v145
    v_max3_f32 v196, v196, v146, v147
    v_max_f32 v196, v196, v197
    v_mov_b32 v197, v196
    s_nop 1
    v_permlane32_swap_b32 v196, v197
    v_max_f32 v196, v196, v197
    v_mov_b32 v197, v196
    s_nop 1
    v_permlane16_swap_b32 v196, v197
    v_max_f32 v196, v196, v197
    v_mul_f32 v196, s22, v196
    v_pk_fma_f32 v[136:137], v[136:137], s[22:23], v[196:197] op_sel_hi:[1,0,0] neg_lo:[0,0,1] neg_hi:[0,0,1]
    v_pk_fma_f32 v[138:139], v[138:139], s[22:23], v[196:197] op_sel_hi:[1,0,0] neg_lo:[0,0,1] neg_hi:[0,0,1]
    v_pk_fma_f32 v[140:141], v[140:141], s[22:23], v[196:197] op_sel_hi:[1,0,0] neg_lo:[0,0,1] neg_hi:[0,0,1]
    v_pk_fma_f32 v[142:143], v[142:143], s[22:23], v[196:197] op_sel_hi:[1,0,0] neg_lo:[0,0,1] neg_hi:[0,0,1]
    v_pk_fma_f32 v[144:145], v[144:145], s[22:23], v[196:197] op_sel_hi:[1,0,0] neg_lo:[0,0,1] neg_hi:[0,0,1]
    v_pk_fma_f32 v[146:147], v[146:147], s[22:23], v[196:197] op_sel_hi:[1,0,0] neg_lo:[0,0,1] neg_hi:[0,0,1]
    v_exp_f32 v136, v136
    v_exp_f32 v137, v137
    v_exp_f32 v138, v138
    v_exp_f32 v139, v139
    v_exp_f32 v140, v140
    v_exp_f32 v141, v141
    v_exp_f32 v142, v142
    v_exp_f32 v143, v143
    v_exp_f32 v144, v144
    v_exp_f32 v145, v145
    v_exp_f32 v146, v146
    v_exp_f32 v147, v147
    v_cvt_pk_bf16_f32 v160, v136, v137
    v_cvt_pk_bf16_f32 v161, v138, v139
    v_cvt_pk_bf16_f32 v162, v140, v141
    v_cvt_pk_bf16_f32 v163, v142, v143
    v_cvt_pk_bf16_f32 v164, v144, v145
    v_cvt_pk_bf16_f32 v165, v146, v147
    v_max3_f32 v196, v148, v149, v150
    v_max3_f32 v197, v151, v152, v153
    v_max3_f32 v196, v196, v154, v155
    v_max3_f32 v197, v197, v156, v157
    v_max3_f32 v196, v196, v158, v159
    v_max_f32 v196, v196, v197
    v_mov_b32 v197, v196
    s_nop 1
    v_permlane32_swap_b32 v196, v197
    v_max_f32 v196, v196, v197
    v_mov_b32 v197, v196
    s_nop 1
    v_permlane16_swap_b32 v196, v197
    v_max_f32 v196, v196, v197
    v_mul_f32 v196, s22, v196
    v_pk_fma_f32 v[148:149], v[148:149], s[22:23], v[196:197] op_sel_hi:[1,0,0] neg_lo:[0,0,1] neg_hi:[0,0,1]
    v_pk_fma_f32 v[150:151], v[150:151], s[22:23], v[196:197] op_sel_hi:[1,0,0] neg_lo:[0,0,1] neg_hi:[0,0,1]
    v_pk_fma_f32 v[152:153], v[152:153], s[22:23], v[196:197] op_sel_hi:[1,0,0] neg_lo:[0,0,1] neg_hi:[0,0,1]
    v_pk_fma_f32 v[154:155], v[154:155], s[22:23], v[196:197] op_sel_hi:[1,0,0] neg_lo:[0,0,1] neg_hi:[0,0,1]
    v_pk_fma_f32 v[156:157], v[156:157], s[22:23], v[196:197] op_sel_hi:[1,0,0] neg_lo:[0,0,1] neg_hi:[0,0,1]
    v_pk_fma_f32 v[158:159], v[158:159], s[22:23], v[196:197] op_sel_hi:[1,0,0] neg_lo:[0,0,1] neg_hi:[0,0,1]
    v_exp_f32 v148, v148
    v_exp_f32 v149, v149
    v_exp_f32 v150, v150
    v_exp_f32 v151, v151
    v_exp_f32 v152, v152
    v_exp_f32 v153, v153
    v_exp_f32 v154, v154
    v_exp_f32 v155, v155
    v_exp_f32 v156, v156
    v_exp_f32 v157, v157
    v_exp_f32 v158, v158
    v_exp_f32 v159, v159
    v_cvt_pk_bf16_f32 v166, v148, v149
    v_cvt_pk_bf16_f32 v167, v150, v151
    v_cvt_pk_bf16_f32 v168, v152, v153
    v_cvt_pk_bf16_f32 v169, v154, v155
    v_cvt_pk_bf16_f32 v170, v156, v157
    v_cvt_pk_bf16_f32 v171, v158, v159
    v_mfma_f32_16x16x32_bf16 v[180:183], v[172:175], v[160:163], 0
    v_mfma_f32_16x16x32_bf16 v[184:187], v[172:175], v[166:169], 0
    s_nop 4
    v_mfma_f32_16x16x16_bf16 v[180:183], v[176:177], v[164:165], v[180:183]
    v_mfma_f32_16x16x16_bf16 v[184:187], v[176:177], v[170:171], v[184:187]
    s_nop 6
    v_rcp_f32 v180, v180
    v_rcp_f32 v184, v184
    s_waitcnt vmcnt(0)
    s_lshl_b32 s18, s16, 18
    s_lshl_b32 s19, s17, 12
    s_add_u32 s18, s18, s19
    s_add_u32 s18, s18, 50331648
    s_add_u32 s19, s18, 131072
    v_mfma_f32_16x16x32_bf16 v[8:11], v[88:91], v[160:163], 0
    v_mfma_f32_16x16x32_bf16 v[12:15], v[104:107], v[160:163], 0
    v_mfma_f32_16x16x32_bf16 v[16:19], v[88:91], v[166:169], 0
    v_mfma_f32_16x16x32_bf16 v[20:23], v[104:107], v[166:169], 0
    v_mfma_f32_16x16x32_bf16 v[24:27], v[92:95], v[160:163], 0
    v_mfma_f32_16x16x32_bf16 v[28:31], v[108:111], v[160:163], 0
    v_mfma_f32_16x16x32_bf16 v[32:35], v[92:95], v[166:169], 0
    v_mfma_f32_16x16x32_bf16 v[36:39], v[108:111], v[166:169], 0
    v_mfma_f32_16x16x32_bf16 v[40:43], v[96:99], v[160:163], 0
    v_mfma_f32_16x16x32_bf16 v[44:47], v[112:115], v[160:163], 0
    v_mfma_f32_16x16x32_bf16 v[48:51], v[96:99], v[166:169], 0
    v_mfma_f32_16x16x32_bf16 v[52:55], v[112:115], v[166:169], 0
    v_mfma_f32_16x16x32_bf16 v[56:59], v[100:103], v[160:163], 0
    v_mfma_f32_16x16x32_bf16 v[60:63], v[116:119], v[160:163], 0
    v_mfma_f32_16x16x32_bf16 v[64:67], v[100:103], v[166:169], 0
    v_mfma_f32_16x16x32_bf16 v[68:71], v[116:119], v[166:169], 0
    v_mfma_f32_16x16x16_bf16 v[8:11], v[120:121], v[164:165], v[8:11]
    v_mfma_f32_16x16x16_bf16 v[12:15], v[122:123], v[164:165], v[12:15]
    v_mfma_f32_16x16x16_bf16 v[16:19], v[120:121], v[170:171], v[16:19]
    v_mfma_f32_16x16x16_bf16 v[20:23], v[122:123], v[170:171], v[20:23]
    v_mfma_f32_16x16x16_bf16 v[24:27], v[124:125], v[164:165], v[24:27]
    v_mfma_f32_16x16x16_bf16 v[28:31], v[126:127], v[164:165], v[28:31]
    v_mfma_f32_16x16x16_bf16 v[32:35], v[124:125], v[170:171], v[32:35]
    v_mfma_f32_16x16x16_bf16 v[36:39], v[126:127], v[170:171], v[36:39]
    v_mfma_f32_16x16x16_bf16 v[40:43], v[128:129], v[164:165], v[40:43]
    v_mfma_f32_16x16x16_bf16 v[44:47], v[130:131], v[164:165], v[44:47]
    v_mfma_f32_16x16x16_bf16 v[48:51], v[128:129], v[170:171], v[48:51]
    v_mfma_f32_16x16x16_bf16 v[52:55], v[130:131], v[170:171], v[52:55]
    v_mfma_f32_16x16x16_bf16 v[56:59], v[132:133], v[164:165], v[56:59]
    v_mfma_f32_16x16x16_bf16 v[60:63], v[134:135], v[164:165], v[60:63]
    v_mfma_f32_16x16x16_bf16 v[64:67], v[132:133], v[170:171], v[64:67]
    v_mfma_f32_16x16x16_bf16 v[68:71], v[134:135], v[170:171], v[68:71]
    v_pk_mul_f32 v[8:9], v[8:9], v[180:181] op_sel_hi:[1,0]
    v_pk_mul_f32 v[10:11], v[10:11], v[180:181] op_sel_hi:[1,0]
    v_pk_mul_f32 v[12:13], v[12:13], v[180:181] op_sel_hi:[1,0]
    v_pk_mul_f32 v[14:15], v[14:15], v[180:181] op_sel_hi:[1,0]
    v_cvt_pk_bf16_f32 v8, v8, v9
    v_cvt_pk_bf16_f32 v9, v10, v11
    v_cvt_pk_bf16_f32 v10, v12, v13
    v_cvt_pk_bf16_f32 v11, v14, v15
    buffer_store_dwordx4 v[8:11], v1, s[4:7], s18 offen offset:0 sc1
    v_pk_mul_f32 v[16:17], v[16:17], v[184:185] op_sel_hi:[1,0]
    v_pk_mul_f32 v[18:19], v[18:19], v[184:185] op_sel_hi:[1,0]
    v_pk_mul_f32 v[20:21], v[20:21], v[184:185] op_sel_hi:[1,0]
    v_pk_mul_f32 v[22:23], v[22:23], v[184:185] op_sel_hi:[1,0]
    v_cvt_pk_bf16_f32 v16, v16, v17
    v_cvt_pk_bf16_f32 v17, v18, v19
    v_cvt_pk_bf16_f32 v18, v20, v21
    v_cvt_pk_bf16_f32 v19, v22, v23
    buffer_store_dwordx4 v[16:19], v1, s[4:7], s19 offen offset:0 sc1
    v_pk_mul_f32 v[24:25], v[24:25], v[180:181] op_sel_hi:[1,0]
    v_pk_mul_f32 v[26:27], v[26:27], v[180:181] op_sel_hi:[1,0]
    v_pk_mul_f32 v[28:29], v[28:29], v[180:181] op_sel_hi:[1,0]
    v_pk_mul_f32 v[30:31], v[30:31], v[180:181] op_sel_hi:[1,0]
    v_cvt_pk_bf16_f32 v24, v24, v25
    v_cvt_pk_bf16_f32 v25, v26, v27
    v_cvt_pk_bf16_f32 v26, v28, v29
    v_cvt_pk_bf16_f32 v27, v30, v31
    buffer_store_dwordx4 v[24:27], v1, s[4:7], s18 offen offset:1024 sc1
    v_pk_mul_f32 v[32:33], v[32:33], v[184:185] op_sel_hi:[1,0]
    v_pk_mul_f32 v[34:35], v[34:35], v[184:185] op_sel_hi:[1,0]
    v_pk_mul_f32 v[36:37], v[36:37], v[184:185] op_sel_hi:[1,0]
    v_pk_mul_f32 v[38:39], v[38:39], v[184:185] op_sel_hi:[1,0]
    v_cvt_pk_bf16_f32 v32, v32, v33
    v_cvt_pk_bf16_f32 v33, v34, v35
    v_cvt_pk_bf16_f32 v34, v36, v37
    v_cvt_pk_bf16_f32 v35, v38, v39
    buffer_store_dwordx4 v[32:35], v1, s[4:7], s19 offen offset:1024 sc1
    v_pk_mul_f32 v[40:41], v[40:41], v[180:181] op_sel_hi:[1,0]
    v_pk_mul_f32 v[42:43], v[42:43], v[180:181] op_sel_hi:[1,0]
    v_pk_mul_f32 v[44:45], v[44:45], v[180:181] op_sel_hi:[1,0]
    v_pk_mul_f32 v[46:47], v[46:47], v[180:181] op_sel_hi:[1,0]
    v_cvt_pk_bf16_f32 v40, v40, v41
    v_cvt_pk_bf16_f32 v41, v42, v43
    v_cvt_pk_bf16_f32 v42, v44, v45
    v_cvt_pk_bf16_f32 v43, v46, v47
    buffer_store_dwordx4 v[40:43], v1, s[4:7], s18 offen offset:2048 sc1
    v_pk_mul_f32 v[48:49], v[48:49], v[184:185] op_sel_hi:[1,0]
    v_pk_mul_f32 v[50:51], v[50:51], v[184:185] op_sel_hi:[1,0]
    v_pk_mul_f32 v[52:53], v[52:53], v[184:185] op_sel_hi:[1,0]
    v_pk_mul_f32 v[54:55], v[54:55], v[184:185] op_sel_hi:[1,0]
    v_cvt_pk_bf16_f32 v48, v48, v49
    v_cvt_pk_bf16_f32 v49, v50, v51
    v_cvt_pk_bf16_f32 v50, v52, v53
    v_cvt_pk_bf16_f32 v51, v54, v55
    buffer_store_dwordx4 v[48:51], v1, s[4:7], s19 offen offset:2048 sc1
    v_pk_mul_f32 v[56:57], v[56:57], v[180:181] op_sel_hi:[1,0]
    v_pk_mul_f32 v[58:59], v[58:59], v[180:181] op_sel_hi:[1,0]
    v_pk_mul_f32 v[60:61], v[60:61], v[180:181] op_sel_hi:[1,0]
    v_pk_mul_f32 v[62:63], v[62:63], v[180:181] op_sel_hi:[1,0]
    v_cvt_pk_bf16_f32 v56, v56, v57
    v_cvt_pk_bf16_f32 v57, v58, v59
    v_cvt_pk_bf16_f32 v58, v60, v61
    v_cvt_pk_bf16_f32 v59, v62, v63
    buffer_store_dwordx4 v[56:59], v1, s[4:7], s18 offen offset:3072 sc1
    v_pk_mul_f32 v[64:65], v[64:65], v[184:185] op_sel_hi:[1,0]
    v_pk_mul_f32 v[66:67], v[66:67], v[184:185] op_sel_hi:[1,0]
    v_pk_mul_f32 v[68:69], v[68:69], v[184:185] op_sel_hi:[1,0]
    v_pk_mul_f32 v[70:71], v[70:71], v[184:185] op_sel_hi:[1,0]
    v_cvt_pk_bf16_f32 v64, v64, v65
    v_cvt_pk_bf16_f32 v65, v66, v67
    v_cvt_pk_bf16_f32 v66, v68, v69
    v_cvt_pk_bf16_f32 v67, v70, v71
    buffer_store_dwordx4 v[64:67], v1, s[4:7], s19 offen offset:3072 sc1
    s_lshr_b32 s40, s34, 1
    s_lshl_b32 s40, s40, 7
    s_and_b32 s41, s34, 1
    s_lshl_b32 s41, s41, 2
    s_add_u32 s40, s40, s41
    s_add_u32 s40, s40, 125894656
    s_cmp_lt_u32 s16, 62
    s_cbranch_scc1 L_noef
    s_lshr_b32 s42, s34, 1
    s_mul_i32 s42, s42, 4096
    s_add_u32 s41, s41, s42
    s_add_u32 s41, s41, 124944384
    s_barrier
    s_cmp_lg_u32 s32, 0
    s_cbranch_scc1 L_noef
    v_mov_b32 v250, s95
    v_lshlrev_b32 v251, 7, v0
    s_mov_b64 exec, 262143
    buffer_store_dword v250, v251, s[4:7], s41 offen sc1
    s_mov_b64 exec, -1
L_noef:
    s_waitcnt vmcnt(0)
    s_barrier
    v_mov_b32 v250, s95
    v_cmp_eq_u32 vcc, 0, v0
    s_nop 0
    s_and_saveexec_b64 s[38:39], vcc
    s_cbranch_execz fs19
    buffer_store_dword v250, off, s[4:7], s40 sc1
fs19:
    s_mov_b64 exec, -1
    s_branch L_att_next
L_op_start:
    s_lshl_b32 s35, s33, 2
    s_add_u32 s35, s35, 136
    s_lshr_b32 s89, s33, 2
    s_lshl_b32 s89, s89, 7
    s_add_u32 s89, s89, 125841408
    v_mbcnt_lo_u32_b32 v2, -1, 0
    v_mbcnt_hi_u32_b32 v2, -1, v2
    v_min_u32 v2, 31, v2
    v_lshlrev_b32 v2, 2, v2
    s_mov_b32 s88, 4194304
fw20:
    buffer_load_dword v3, v2, s[4:7], s89 offen offset:0 sc1
    s_sub_u32 s88, s88, 1
    s_cbranch_scc1 fw20x
    s_waitcnt vmcnt(0)
    v_cmp_ne_u32 vcc, s95, v3
    s_cbranch_vccz fw20x
    s_sleep 4
    s_branch fw20
fw20x:
    v_and_b32 v1, 63, v0
    v_lshlrev_b32 v1, 4, v1
    s_lshl_b32 s18, s33, 18
    s_lshl_b32 s19, s32, 16
    s_add_u32 s18, s18, s19
    s_add_u32 s18, s18, 130023424
    buffer_load_dwordx4 a[0:3], v1, s[4:7], s18 offen offset:0 sc1
    s_waitcnt vmcnt(6)
    buffer_load_dwordx4 a[4:7], v1, s[4:7], s18 offen offset:1024 sc1
    s_waitcnt vmcnt(6)
    buffer_load_dwordx4 a[8:11], v1, s[4:7], s18 offen offset:2048 sc1
    s_waitcnt vmcnt(6)
    buffer_load_dwordx4 a[12:15], v1, s[4:7], s18 offen offset:3072 sc1
    s_waitcnt vmcnt(6)
    s_add_u32 s18, s18, 4096
    buffer_load_dwordx4 a[16:19], v1, s[4:7], s18 offen offset:0 sc1
    s_waitcnt vmcnt(6)
    buffer_load_dwordx4 a[20:23], v1, s[4:7], s18 offen offset:1024 sc1
    s_waitcnt vmcnt(6)
    buffer_load_dwordx4 a[24:27], v1, s[4:7], s18 offen offset:2048 sc1
    s_waitcnt vmcnt(6)
    buffer_load_dwordx4 a[28:31], v1, s[4:7], s18 offen offset:3072 sc1
    s_waitcnt vmcnt(6)
    s_add_u32 s18, s18, 4096
    buffer_load_dwordx4 a[32:35], v1, s[4:7], s18 offen offset:0 sc1
    s_waitcnt vmcnt(6)
    buffer_load_dwordx4 a[36:39], v1, s[4:7], s18 offen offset:1024 sc1
    s_waitcnt vmcnt(6)
    buffer_load_dwordx4 a[40:43], v1, s[4:7], s18 offen offset:2048 sc1
    s_waitcnt vmcnt(6)
    buffer_load_dwordx4 a[44:47], v1, s[4:7], s18 offen offset:3072 sc1
    s_waitcnt vmcnt(6)
    s_add_u32 s18, s18, 4096
    buffer_load_dwordx4 a[48:51], v1, s[4:7], s18 offen offset:0 sc1
    s_waitcnt vmcnt(6)
    buffer_load_dwordx4 a[52:55], v1, s[4:7], s18 offen offset:1024 sc1
    s_waitcnt vmcnt(6)
    buffer_load_dwordx4 a[56:59], v1, s[4:7], s18 offen offset:2048 sc1
    s_waitcnt vmcnt(6)
    buffer_load_dwordx4 a[60:63], v1, s[4:7], s18 offen offset:3072 sc1
    s_waitcnt vmcnt(6)
    s_add_u32 s18, s18, 4096
    buffer_load_dwordx4 a[64:67], v1, s[4:7], s18 offen offset:0 sc1
    s_waitcnt vmcnt(6)
    buffer_load_dwordx4 a[68:71], v1, s[4:7], s18 offen offset:1024 sc1
    s_waitcnt vmcnt(6)
    buffer_load_dwordx4 a[72:75], v1, s[4:7], s18 offen offset:2048 sc1
    s_waitcnt vmcnt(6)
    buffer_load_dwordx4 a[76:79], v1, s[4:7], s18 offen offset:3072 sc1
    s_waitcnt vmcnt(6)
    s_add_u32 s18, s18, 4096
    buffer_load_dwordx4 a[80:83], v1, s[4:7], s18 offen offset:0 sc1
    s_waitcnt vmcnt(6)
    buffer_load_dwordx4 a[84:87], v1, s[4:7], s18 offen offset:1024 sc1
    s_waitcnt vmcnt(6)
    buffer_load_dwordx4 a[88:91], v1, s[4:7], s18 offen offset:2048 sc1
    s_waitcnt vmcnt(6)
    buffer_load_dwordx4 a[92:95], v1, s[4:7], s18 offen offset:3072 sc1
    s_waitcnt vmcnt(6)
    s_add_u32 s18, s18, 4096
    buffer_load_dwordx4 a[96:99], v1, s[4:7], s18 offen offset:0 sc1
    s_waitcnt vmcnt(6)
    buffer_load_dwordx4 a[100:103], v1, s[4:7], s18 offen offset:1024 sc1
    s_waitcnt vmcnt(6)
    buffer_load_dwordx4 a[104:107], v1, s[4:7], s18 offen offset:2048 sc1
    s_waitcnt vmcnt(6)
    buffer_load_dwordx4 a[108:111], v1, s[4:7], s18 offen offset:3072 sc1
    s_waitcnt vmcnt(6)
    s_add_u32 s18, s18, 4096
    buffer_load_dwordx4 a[112:115], v1, s[4:7], s18 offen offset:0 sc1
    s_waitcnt vmcnt(6)
    buffer_load_dwordx4 a[116:119], v1, s[4:7], s18 offen offset:1024 sc1
    s_waitcnt vmcnt(6)
    buffer_load_dwordx4 a[120:123], v1, s[4:7], s18 offen offset:2048 sc1
    s_waitcnt vmcnt(6)
    buffer_load_dwordx4 a[124:127], v1, s[4:7], s18 offen offset:3072 sc1
    s_waitcnt vmcnt(6)
    s_add_u32 s18, s18, 4096
    buffer_load_dwordx4 a[128:131], v1, s[4:7], s18 offen offset:0 sc1
    s_waitcnt vmcnt(6)
    buffer_load_dwordx4 a[132:135], v1, s[4:7], s18 offen offset:1024 sc1
    s_waitcnt vmcnt(6)
    buffer_load_dwordx4 a[136:139], v1, s[4:7], s18 offen offset:2048 sc1
    s_waitcnt vmcnt(6)
    buffer_load_dwordx4 a[140:143], v1, s[4:7], s18 offen offset:3072 sc1
    s_waitcnt vmcnt(6)
    s_add_u32 s18, s18, 4096
    buffer_load_dwordx4 a[144:147], v1, s[4:7], s18 offen offset:0 sc1
    s_waitcnt vmcnt(6)
    buffer_load_dwordx4 a[148:151], v1, s[4:7], s18 offen offset:1024 sc1
    s_waitcnt vmcnt(6)
    buffer_load_dwordx4 a[152:155], v1, s[4:7], s18 offen offset:2048 sc1
    s_waitcnt vmcnt(6)
    buffer_load_dwordx4 a[156:159], v1, s[4:7], s18 offen offset:3072 sc1
    s_waitcnt vmcnt(6)
    s_add_u32 s18, s18, 4096
    buffer_load_dwordx4 a[160:163], v1, s[4:7], s18 offen offset:0 sc1
    s_waitcnt vmcnt(6)
    buffer_load_dwordx4 a[164:167], v1, s[4:7], s18 offen offset:1024 sc1
    s_waitcnt vmcnt(6)
    buffer_load_dwordx4 a[168:171], v1, s[4:7], s18 offen offset:2048 sc1
    s_waitcnt vmcnt(6)
    buffer_load_dwordx4 a[172:175], v1, s[4:7], s18 offen offset:3072 sc1
    s_waitcnt vmcnt(6)
    s_add_u32 s18, s18, 4096
    buffer_load_dwordx4 a[176:179], v1, s[4:7], s18 offen offset:0 sc1
    s_waitcnt vmcnt(6)
    buffer_load_dwordx4 a[180:183], v1, s[4:7], s18 offen offset:1024 sc1
    s_waitcnt vmcnt(6)
    buffer_load_dwordx4 a[184:187], v1, s[4:7], s18 offen offset:2048 sc1
    s_waitcnt vmcnt(6)
    buffer_load_dwordx4 a[188:191], v1, s[4:7], s18 offen offset:3072 sc1
    s_waitcnt vmcnt(6)
    s_add_u32 s18, s18, 4096
    buffer_load_dwordx4 a[192:195], v1, s[4:7], s18 offen offset:0 sc1
    s_waitcnt vmcnt(6)
    buffer_load_dwordx4 a[196:199], v1, s[4:7], s18 offen offset:1024 sc1
    s_waitcnt vmcnt(6)
    buffer_load_dwordx4 a[200:203], v1, s[4:7], s18 offen offset:2048 sc1
    s_waitcnt vmcnt(6)
    buffer_load_dwordx4 a[204:207], v1, s[4:7], s18 offen offset:3072 sc1
    s_waitcnt vmcnt(6)
    s_add_u32 s18, s18, 4096
    buffer_load_dwordx4 a[208:211], v1, s[4:7], s18 offen offset:0 sc1
    s_waitcnt vmcnt(6)
    buffer_load_dwordx4 a[212:215], v1, s[4:7], s18 offen offset:1024 sc1
    s_waitcnt vmcnt(6)
    buffer_load_dwordx4 a[216:219], v1, s[4:7], s18 offen offset:2048 sc1
    s_waitcnt vmcnt(6)
    buffer_load_dwordx4 a[220:223], v1, s[4:7], s18 offen offset:3072 sc1
    s_waitcnt vmcnt(6)
    s_add_u32 s18, s18, 4096
    buffer_load_dwordx4 a[224:227], v1, s[4:7], s18 offen offset:0 sc1
    s_waitcnt vmcnt(6)
    buffer_load_dwordx4 a[228:231], v1, s[4:7], s18 offen offset:1024 sc1
    s_waitcnt vmcnt(6)
    buffer_load_dwordx4 a[232:235], v1, s[4:7], s18 offen offset:2048 sc1
    s_waitcnt vmcnt(6)
    buffer_load_dwordx4 a[236:239], v1, s[4:7], s18 offen offset:3072 sc1
    s_waitcnt vmcnt(6)
    s_add_u32 s18, s18, 4096
    buffer_load_dwordx4 a[240:243], v1, s[4:7], s18 offen offset:0 sc1
    s_waitcnt vmcnt(6)
    buffer_load_dwordx4 a[244:247], v1, s[4:7], s18 offen offset:1024 sc1
    s_waitcnt vmcnt(6)
    buffer_load_dwordx4 a[248:251], v1, s[4:7], s18 offen offset:2048 sc1
    s_waitcnt vmcnt(6)
    buffer_load_dwordx4 a[252:255], v1, s[4:7], s18 offen offset:3072 sc1
    s_waitcnt vmcnt(6)
    s_waitcnt vmcnt(0)
    s_mov_b32 s44, 0
    s_mov_b32 s37, s35
    v_mov_b32 v250, 1
    v_mov_b32 v251, 163832
    v_cmp_eq_u32 vcc, 0, v0
    s_nop 0
    s_and_saveexec_b64 s[38:39], vcc
    s_cbranch_execz tk21
    buffer_atomic_add v250, off, s[84:87], s37 sc0
    s_waitcnt vmcnt(0)
    ds_write_b32 v251, v250
    s_waitcnt lgkmcnt(0)
tk21:
    s_mov_b64 exec, -1
    s_barrier
    ds_read_b32 v252, v251
    s_waitcnt lgkmcnt(0)
    v_readfirstlane_b32 s16, v252
    s_barrier
    s_nop 3
    s_cmp_ge_u32 s16, 68
    s_cbranch_scc1 L_op_nextcb
L_op_seg:
    s_min_u32 s43, s16, 60
    s_add_u32 s16, s16, s43
    s_cmp_lt_u32 s16, 120
    s_cbranch_scc1 L_op_nr
    s_add_u32 s43, s16, 6
    s_sub_u32 s16, s16, 2
    s_cmp_lt_u32 s16, 120
    s_cselect_b32 s16, s43, s16
L_op_nr:
    s_lshr_b32 s43, s16, 1
    s_add_u32 s43, s43, 2
    s_min_u32 s43, s43, 63
    s_lshl_b32 s94, s33, 7
    s_add_u32 s94, s94, s16
    s_mov_b32 s88, 65536
    s_mov_b32 s89, 125853696
cw22:
    buffer_load_dword v3, off, s[4:7], s89 sc1
    s_waitcnt vmcnt(0)
    v_readfirstlane_b32 s42, v3
    s_nop 0
    s_sub_u32 s42, s42, s95
    s_cmp_gt_u32 s42, 64
    s_cselect_b32 s42, 0, s42
    s_add_u32 s42, s42, 1
    s_cmp_ge_u32 s42, s43
    s_cbranch_scc1 cw22x
    s_sub_u32 s88, s88, 1
    s_cbranch_scc1 cw22x
    s_sub_u32 s42, s43, s42
    s_min_u32 s42, s42, 6
cw22s:
    s_sleep 24
    s_sub_u32 s42, s42, 1
    s_cmp_lg_u32 s42, 0
    s_cbranch_scc1 cw22s
    s_branch cw22
cw22x:
    s_lshr_b32 s89, s16, 1
    s_lshl_b32 s89, s89, 2
    s_add_u32 s89, s89, s32
    s_lshl_b32 s89, s89, 7
    s_add_u32 s89, s89, 125894656
    s_sub_u32 s47, s89, 125894656
    s_lshl_b32 s47, s47, 5
    s_lshl_b32 s46, s33, 7
    s_add_u32 s47, s47, s46
    s_add_u32 s47, s47, 124944384
    s_cmp_ge_u32 s16, 124
    s_cselect_b32 s46, 8, 0
    s_cselect_b32 s47, s47, s89
    v_mbcnt_lo_u32_b32 v2, -1, 0
    v_mbcnt_hi_u32_b32 v2, -1, v2
    v_min_u32 v2, 1, v2
    v_lshlrev_b32 v2, 2, v2
    s_mov_b32 s88, 4194304
fw23:
    buffer_load_dword v3, v2, s[4:7], s47 offen offset:0 sc1
    s_sub_u32 s88, s88, 1
    s_cbranch_scc1 fw23x
    s_waitcnt vmcnt(0)
    v_cmp_ne_u32 vcc, s95, v3
    s_cbranch_vccz fw23x
    s_sleep 1
    s_branch fw23
fw23x:
    v_mov_b32 v250, 1
    v_lshrrev_b32 v252, 2, v1
    v_min_u32 v252, 68, v252
    s_cmp_lg_u32 s32, 0
    s_cbranch_scc1 L_op_na
    s_mov_b64 exec, 1
    buffer_atomic_add v250, off, s[84:87], s35 sc0
    s_mov_b64 exec, -1
    s_cmp_lg_u32 s44, 0
    s_cbranch_scc1 L_op_na
    buffer_load_dword v253, v252, s[84:87], 0 offen offset:136 sc1
L_op_na:
    s_cmp_ge_u32 s16, 120
    s_cbranch_scc1 L_op_one
o2_again:
    s_lshl_b32 s18, s16, 17
    s_lshl_b32 s19, s32, 15
    s_add_u32 s18, s18, s19
    s_add_u32 s18, s18, 50331648
    buffer_load_dwordx4 v[24:27], v1, s[4:7], s18 offen offset:0 sc1
    buffer_load_dwordx4 v[28:31], v1, s[4:7], s18 offen offset:1024 sc1
    buffer_load_dwordx4 v[32:35], v1, s[4:7], s18 offen offset:2048 sc1
    buffer_load_dwordx4 v[36:39], v1, s[4:7], s18 offen offset:3072 sc1
    s_add_u32 s18, s18, 4096
    buffer_load_dwordx4 v[40:43], v1, s[4:7], s18 offen offset:0 sc1
    buffer_load_dwordx4 v[44:47], v1, s[4:7], s18 offen offset:1024 sc1
    buffer_load_dwordx4 v[48:51], v1, s[4:7], s18 offen offset:2048 sc1
    buffer_load_dwordx4 v[52:55], v1, s[4:7], s18 offen offset:3072 sc1
    s_add_u32 s18, s18, 4096
    buffer_load_dwordx4 v[56:59], v1, s[4:7], s18 offen offset:0 sc1
    buffer_load_dwordx4 v[60:63], v1, s[4:7], s18 offen offset:1024 sc1
    buffer_load_dwordx4 v[64:67], v1, s[4:7], s18 offen offset:2048 sc1
    buffer_load_dwordx4 v[68:71], v1, s[4:7], s18 offen offset:3072 sc1
    s_add_u32 s18, s18, 4096
    buffer_load_dwordx4 v[72:75], v1, s[4:7], s18 offen offset:0 sc1
    buffer_load_dwordx4 v[76:79], v1, s[4:7], s18 offen offset:1024 sc1
    buffer_load_dwordx4 v[80:83], v1, s[4:7], s18 offen offset:2048 sc1
    buffer_load_dwordx4 v[84:87], v1, s[4:7], s18 offen offset:3072 sc1
    s_add_u32 s18, s18, 4096
    buffer_load_dwordx4 v[88:91], v1, s[4:7], s18 offen offset:0 sc1
    buffer_load_dwordx4 v[92:95], v1, s[4:7], s18 offen offset:1024 sc1
    buffer_load_dwordx4 v[96:99], v1, s[4:7], s18 offen offset:2048 sc1
    buffer_load_dwordx4 v[100:103], v1, s[4:7], s18 offen offset:3072 sc1
    s_add_u32 s18, s18, 4096
    buffer_load_dwordx4 v[104:107], v1, s[4:7], s18 offen offset:0 sc1
    buffer_load_dwordx4 v[108:111], v1, s[4:7], s18 offen offset:1024 sc1
    buffer_load_dwordx4 v[112:115], v1, s[4:7], s18 offen offset:2048 sc1
    buffer_load_dwordx4 v[116:119], v1, s[4:7], s18 offen offset:3072 sc1
    s_add_u32 s18, s18, 4096
    buffer_load_dwordx4 v[120:123], v1, s[4:7], s18 offen offset:0 sc1
    buffer_load_dwordx4 v[124:127], v1, s[4:7], s18 offen offset:1024 sc1
    buffer_load_dwordx4 v[128:131], v1, s[4:7], s18 offen offset:2048 sc1
    buffer_load_dwordx4 v[132:135], v1, s[4:7], s18 offen offset:3072 sc1
    s_add_u32 s18, s18, 4096
    buffer_load_dwordx4 v[136:139], v1, s[4:7], s18 offen offset:0 sc1
    buffer_load_dwordx4 v[140:143], v1, s[4:7], s18 offen offset:1024 sc1
    buffer_load_dwordx4 v[144:147], v1, s[4:7], s18 offen offset:2048 sc1
    buffer_load_dwordx4 v[148:151], v1, s[4:7], s18 offen offset:3072 sc1
    s_add_u32 s18, s18, 102400
    buffer_load_dwordx4 v[152:155], v1, s[4:7], s18 offen offset:0 sc1
    buffer_load_dwordx4 v[156:159], v1, s[4:7], s18 offen offset:1024 sc1
    buffer_load_dwordx4 v[160:163], v1, s[4:7], s18 offen offset:2048 sc1
    buffer_load_dwordx4 v[164:167], v1, s[4:7], s18 offen offset:3072 sc1
    s_add_u32 s18, s18, 4096
    buffer_load_dwordx4 v[168:171], v1, s[4:7], s18 offen offset:0 sc1
    buffer_load_dwordx4 v[172:175], v1, s[4:7], s18 offen offset:1024 sc1
    buffer_load_dwordx4 v[176:179], v1, s[4:7], s18 offen offset:2048 sc1
    buffer_load_dwordx4 v[180:183], v1, s[4:7], s18 offen offset:3072 sc1
    s_add_u32 s18, s18, 4096
    buffer_load_dwordx4 v[184:187], v1, s[4:7], s18 offen offset:0 sc1
    buffer_load_dwordx4 v[188:191], v1, s[4:7], s18 offen offset:1024 sc1
    buffer_load_dwordx4 v[192:195], v1, s[4:7], s18 offen offset:2048 sc1
    buffer_load_dwordx4 v[196:199], v1, s[4:7], s18 offen offset:3072 sc1
    s_add_u32 s18, s18, 4096
    buffer_load_dwordx4 v[200:203], v1, s[4:7], s18 offen offset:0 sc1
    buffer_load_dwordx4 v[204:207], v1, s[4:7], s18 offen offset:1024 sc1
    buffer_load_dwordx4 v[208:211], v1, s[4:7], s18 offen offset:2048 sc1
    buffer_load_dwordx4 v[212:215], v1, s[4:7], s18 offen offset:3072 sc1
    s_add_u32 s18, s18, 4096
    buffer_load_dwordx4 v[216:219], v1, s[4:7], s18 offen offset:0 sc1
    buffer_load_dwordx4 v[220:223], v1, s[4:7], s18 offen offset:1024 sc1
    buffer_load_dwordx4 v[224:227], v1, s[4:7], s18 offen offset:2048 sc1
    buffer_load_dwordx4 v[228:231], v1, s[4:7], s18 offen offset:3072 sc1
    s_add_u32 s18, s18, 4096
    buffer_load_dwordx4 v[232:235], v1, s[4:7], s18 offen offset:0 sc1
    buffer_load_dwordx4 v[236:239], v1, s[4:7], s18 offen offset:1024 sc1
    buffer_load_dwordx4 v[240:243], v1, s[4:7], s18 offen offset:2048 sc1
    buffer_load_dwordx4 v[244:247], v1, s[4:7], s18 offen offset:3072 sc1
    v_lshlrev_b32 v2, 4, v0
    v_and_b32 v3, 3072, v2
    v_lshl_add_u32 v2, v3, 1, v1
    s_waitcnt vmcnt(55)
    v_mfma_f32_16x16x32_bf16 v[8:11], a[0:3], v[24:27], 0
    v_mfma_f32_16x16x32_bf16 v[12:15], a[4:7], v[24:27], 0
    s_add_u32 s18, s18, 4096
    buffer_load_dwordx4 v[24:27], v1, s[4:7], s18 offen offset:0 sc1
    s_waitcnt vmcnt(55)
    v_mfma_f32_16x16x32_bf16 v[8:11], a[8:11], v[28:31], v[8:11]
    v_mfma_f32_16x16x32_bf16 v[12:15], a[12:15], v[28:31], v[12:15]
    buffer_load_dwordx4 v[28:31], v1, s[4:7], s18 offen offset:1024 sc1
    s_waitcnt vmcnt(55)
    v_mfma_f32_16x16x32_bf16 v[8:11], a[16:19], v[32:35], v[8:11]
    v_mfma_f32_16x16x32_bf16 v[12:15], a[20:23], v[32:35], v[12:15]
    buffer_load_dwordx4 v[32:35], v1, s[4:7], s18 offen offset:2048 sc1
    s_waitcnt vmcnt(55)
    v_mfma_f32_16x16x32_bf16 v[8:11], a[24:27], v[36:39], v[8:11]
    v_mfma_f32_16x16x32_bf16 v[12:15], a[28:31], v[36:39], v[12:15]
    buffer_load_dwordx4 v[36:39], v1, s[4:7], s18 offen offset:3072 sc1
    s_waitcnt vmcnt(55)
    v_mfma_f32_16x16x32_bf16 v[8:11], a[32:35], v[40:43], v[8:11]
    v_mfma_f32_16x16x32_bf16 v[12:15], a[36:39], v[40:43], v[12:15]
    s_add_u32 s18, s18, 4096
    buffer_load_dwordx4 v[40:43], v1, s[4:7], s18 offen offset:0 sc1
    s_waitcnt vmcnt(55)
    v_mfma_f32_16x16x32_bf16 v[8:11], a[40:43], v[44:47], v[8:11]
    v_mfma_f32_16x16x32_bf16 v[12:15], a[44:47], v[44:47], v[12:15]
    buffer_load_dwordx4 v[44:47], v1, s[4:7], s18 offen offset:1024 sc1
    s_waitcnt vmcnt(55)
    v_mfma_f32_16x16x32_bf16 v[8:11], a[48:51], v[48:51], v[8:11]
    v_mfma_f32_16x16x32_bf16 v[12:15], a[52:55], v[48:51], v[12:15]
    buffer_load_dwordx4 v[48:51], v1, s[4:7], s18 offen offset:2048 sc1
    s_waitcnt vmcnt(55)
    v_mfma_f32_16x16x32_bf16 v[8:11], a[56:59], v[52:55], v[8:11]
    v_mfma_f32_16x16x32_bf16 v[12:15], a[60:63], v[52:55], v[12:15]
    buffer_load_dwordx4 v[52:55], v1, s[4:7], s18 offen offset:3072 sc1
    s_waitcnt vmcnt(55)
    v_mfma_f32_16x16x32_bf16 v[8:11], a[64:67], v[56:59], v[8:11]
    v_mfma_f32_16x16x32_bf16 v[12:15], a[68:71], v[56:59], v[12:15]
    s_waitcnt vmcnt(54)
    v_mfma_f32_16x16x32_bf16 v[8:11], a[72:75], v[60:63], v[8:11]
    v_mfma_f32_16x16x32_bf16 v[12:15], a[76:79], v[60:63], v[12:15]
    s_waitcnt vmcnt(53)
    v_mfma_f32_16x16x32_bf16 v[8:11], a[80:83], v[64:67], v[8:11]
    v_mfma_f32_16x16x32_bf16 v[12:15], a[84:87], v[64:67], v[12:15]
    s_waitcnt vmcnt(52)
    v_mfma_f32_16x16x32_bf16 v[8:11], a[88:91], v[68:71], v[8:11]
    v_mfma_f32_16x16x32_bf16 v[12:15], a[92:95], v[68:71], v[12:15]
    s_waitcnt vmcnt(51)
    v_mfma_f32_16x16x32_bf16 v[8:11], a[96:99], v[72:75], v[8:11]
    v_mfma_f32_16x16x32_bf16 v[12:15], a[100:103], v[72:75], v[12:15]
    s_waitcnt vmcnt(50)
    v_mfma_f32_16x16x32_bf16 v[8:11], a[104:107], v[76:79], v[8:11]
    v_mfma_f32_16x16x32_bf16 v[12:15], a[108:111], v[76:79], v[12:15]
    s_waitcnt vmcnt(49)
    v_mfma_f32_16x16x32_bf16 v[8:11], a[112:115], v[80:83], v[8:11]
    v_mfma_f32_16x16x32_bf16 v[12:15], a[116:119], v[80:83], v[12:15]
    s_waitcnt vmcnt(48)
    v_mfma_f32_16x16x32_bf16 v[8:11], a[120:123], v[84:87], v[8:11]
    v_mfma_f32_16x16x32_bf16 v[12:15], a[124:127], v[84:87], v[12:15]
    s_waitcnt vmcnt(47)
    v_mfma_f32_16x16x32_bf16 v[8:11], a[128:131], v[88:91], v[8:11]
    v_mfma_f32_16x16x32_bf16 v[12:15], a[132:135], v[88:91], v[12:15]
    s_waitcnt vmcnt(46)
    v_mfma_f32_16x16x32_bf16 v[8:11], a[136:139], v[92:95], v[8:11]
    v_mfma_f32_16x16x32_bf16 v[12:15], a[140:143], v[92:95], v[12:15]
    s_waitcnt vmcnt(45)
    v_mfma_f32_16x16x32_bf16 v[8:11], a[144:147], v[96:99], v[8:11]
    v_mfma_f32_16x16x32_bf16 v[12:15], a[148:151], v[96:99], v[12:15]
    s_waitcnt vmcnt(44)
    v_mfma_f32_16x16x32_bf16 v[8:11], a[152:155], v[100:103], v[8:11]
    v_mfma_f32_16x16x32_bf16 v[12:15], a[156:159], v[100:103], v[12:15]
    s_waitcnt vmcnt(43)
    v_mfma_f32_16x16x32_bf16 v[8:11], a[160:163], v[104:107], v[8:11]
    v_mfma_f32_16x16x32_bf16 v[12:15], a[164:167], v[104:107], v[12:15]
    s_waitcnt vmcnt(42)
    v_mfma_f32_16x16x32_bf16 v[8:11], a[168:171], v[108:111], v[8:11]
    v_mfma_f32_16x16x32_bf16 v[12:15], a[172:175], v[108:111], v[12:15]
    s_waitcnt vmcnt(41)
    v_mfma_f32_16x16x32_bf16 v[8:11], a[176:179], v[112:115], v[8:11]
    v_mfma_f32_16x16x32_bf16 v[12:15], a[180:183], v[112:115], v[12:15]
    s_waitcnt vmcnt(40)
    v_mfma_f32_16x16x32_bf16 v[8:11], a[184:187], v[116:119], v[8:11]
    v_mfma_f32_16x16x32_bf16 v[12:15], a[188:191], v[116:119], v[12:15]
    s_waitcnt vmcnt(39)
    v_mfma_f32_16x16x32_bf16 v[8:11], a[192:195], v[120:123], v[8:11]
    v_mfma_f32_16x16x32_bf16 v[12:15], a[196:199], v[120:123], v[12:15]
    s_waitcnt vmcnt(38)
    v_mfma_f32_16x16x32_bf16 v[8:11], a[200:203], v[124:127], v[8:11]
    v_mfma_f32_16x16x32_bf16 v[12:15], a[204:207], v[124:127], v[12:15]
    s_waitcnt vmcnt(37)
    v_mfma_f32_16x16x32_bf16 v[8:11], a[208:211], v[128:131], v[8:11]
    v_mfma_f32_16x16x32_bf16 v[12:15], a[212:215], v[128:131], v[12:15]
    s_waitcnt vmcnt(36)
    v_mfma_f32_16x16x32_bf16 v[8:11], a[216:219], v[132:135], v[8:11]
    v_mfma_f32_16x16x32_bf16 v[12:15], a[220:223], v[132:135], v[12:15]
    s_waitcnt vmcnt(35)
    v_mfma_f32_16x16x32_bf16 v[8:11], a[224:227], v[136:139], v[8:11]
    v_mfma_f32_16x16x32_bf16 v[12:15], a[228:231], v[136:139], v[12:15]
    s_waitcnt vmcnt(34)
    v_mfma_f32_16x16x32_bf16 v[8:11], a[232:235], v[140:143], v[8:11]
    v_mfma_f32_16x16x32_bf16 v[12:15], a[236:239], v[140:143], v[12:15]
    s_waitcnt vmcnt(33)
    v_mfma_f32_16x16x32_bf16 v[8:11], a[240:243], v[144:147], v[8:11]
    v_mfma_f32_16x16x32_bf16 v[12:15], a[244:247], v[144:147], v[12:15]
    s_waitcnt vmcnt(32)
    v_mfma_f32_16x16x32_bf16 v[8:11], a[248:251], v[148:151], v[8:11]
    v_mfma_f32_16x16x32_bf16 v[12:15], a[252:255], v[148:151], v[12:15]
    s_waitcnt vmcnt(31)
    v_mfma_f32_16x16x32_bf16 v[16:19], a[0:3], v[152:155], 0
    v_mfma_f32_16x16x32_bf16 v[20:23], a[4:7], v[152:155], 0
    s_waitcnt vmcnt(30)
    v_mfma_f32_16x16x32_bf16 v[16:19], a[8:11], v[156:159], v[16:19]
    v_mfma_f32_16x16x32_bf16 v[20:23], a[12:15], v[156:159], v[20:23]
    s_waitcnt vmcnt(29)
    v_mfma_f32_16x16x32_bf16 v[16:19], a[16:19], v[160:163], v[16:19]
    v_mfma_f32_16x16x32_bf16 v[20:23], a[20:23], v[160:163], v[20:23]
    s_waitcnt vmcnt(28)
    v_mfma_f32_16x16x32_bf16 v[16:19], a[24:27], v[164:167], v[16:19]
    v_mfma_f32_16x16x32_bf16 v[20:23], a[28:31], v[164:167], v[20:23]
    s_waitcnt vmcnt(27)
    v_mfma_f32_16x16x32_bf16 v[16:19], a[32:35], v[168:171], v[16:19]
    v_mfma_f32_16x16x32_bf16 v[20:23], a[36:39], v[168:171], v[20:23]
    s_waitcnt vmcnt(26)
    v_mfma_f32_16x16x32_bf16 v[16:19], a[40:43], v[172:175], v[16:19]
    v_mfma_f32_16x16x32_bf16 v[20:23], a[44:47], v[172:175], v[20:23]
    s_waitcnt vmcnt(25)
    v_mfma_f32_16x16x32_bf16 v[16:19], a[48:51], v[176:179], v[16:19]
    v_mfma_f32_16x16x32_bf16 v[20:23], a[52:55], v[176:179], v[20:23]
    s_waitcnt vmcnt(24)
    v_mfma_f32_16x16x32_bf16 v[16:19], a[56:59], v[180:183], v[16:19]
    v_mfma_f32_16x16x32_bf16 v[20:23], a[60:63], v[180:183], v[20:23]
    s_waitcnt vmcnt(23)
    v_mfma_f32_16x16x32_bf16 v[16:19], a[64:67], v[184:187], v[16:19]
    v_mfma_f32_16x16x32_bf16 v[20:23], a[68:71], v[184:187], v[20:23]
    s_waitcnt vmcnt(22)
    v_mfma_f32_16x16x32_bf16 v[16:19], a[72:75], v[188:191], v[16:19]
    v_mfma_f32_16x16x32_bf16 v[20:23], a[76:79], v[188:191], v[20:23]
    s_waitcnt vmcnt(21)
    v_mfma_f32_16x16x32_bf16 v[16:19], a[80:83], v[192:195], v[16:19]
    v_mfma_f32_16x16x32_bf16 v[20:23], a[84:87], v[192:195], v[20:23]
    s_waitcnt vmcnt(20)
    v_mfma_f32_16x16x32_bf16 v[16:19], a[88:91], v[196:199], v[16:19]
    v_mfma_f32_16x16x32_bf16 v[20:23], a[92:95], v[196:199], v[20:23]
    s_waitcnt vmcnt(19)
    v_mfma_f32_16x16x32_bf16 v[16:19], a[96:99], v[200:203], v[16:19]
    v_mfma_f32_16x16x32_bf16 v[20:23], a[100:103], v[200:203], v[20:23]
    s_waitcnt vmcnt(18)
    v_mfma_f32_16x16x32_bf16 v[16:19], a[104:107], v[204:207], v[16:19]
    v_mfma_f32_16x16x32_bf16 v[20:23], a[108:111], v[204:207], v[20:23]
    s_waitcnt vmcnt(17)
    v_mfma_f32_16x16x32_bf16 v[16:19], a[112:115], v[208:211], v[16:19]
    v_mfma_f32_16x16x32_bf16 v[20:23], a[116:119], v[208:211], v[20:23]
    s_waitcnt vmcnt(16)
    v_mfma_f32_16x16x32_bf16 v[16:19], a[120:123], v[212:215], v[16:19]
    v_mfma_f32_16x16x32_bf16 v[20:23], a[124:127], v[212:215], v[20:23]
    s_waitcnt vmcnt(15)
    v_mfma_f32_16x16x32_bf16 v[16:19], a[128:131], v[216:219], v[16:19]
    v_mfma_f32_16x16x32_bf16 v[20:23], a[132:135], v[216:219], v[20:23]
    s_waitcnt vmcnt(14)
    v_mfma_f32_16x16x32_bf16 v[16:19], a[136:139], v[220:223], v[16:19]
    v_mfma_f32_16x16x32_bf16 v[20:23], a[140:143], v[220:223], v[20:23]
    s_waitcnt vmcnt(13)
    v_mfma_f32_16x16x32_bf16 v[16:19], a[144:147], v[224:227], v[16:19]
    v_mfma_f32_16x16x32_bf16 v[20:23], a[148:151], v[224:227], v[20:23]
    s_waitcnt vmcnt(12)
    v_mfma_f32_16x16x32_bf16 v[16:19], a[152:155], v[228:231], v[16:19]
    v_mfma_f32_16x16x32_bf16 v[20:23], a[156:159], v[228:231], v[20:23]
    s_waitcnt vmcnt(11)
    v_mfma_f32_16x16x32_bf16 v[16:19], a[160:163], v[232:235], v[16:19]
    v_mfma_f32_16x16x32_bf16 v[20:23], a[164:167], v[232:235], v[20:23]
    s_waitcnt vmcnt(10)
    v_mfma_f32_16x16x32_bf16 v[16:19], a[168:171], v[236:239], v[16:19]
    v_mfma_f32_16x16x32_bf16 v[20:23], a[172:175], v[236:239], v[20:23]
    s_waitcnt vmcnt(9)
    v_mfma_f32_16x16x32_bf16 v[16:19], a[176:179], v[240:243], v[16:19]
    v_mfma_f32_16x16x32_bf16 v[20:23], a[180:183], v[240:243], v[20:23]
    s_waitcnt vmcnt(8)
    v_mfma_f32_16x16x32_bf16 v[16:19], a[184:187], v[244:247], v[16:19]
    v_mfma_f32_16x16x32_bf16 v[20:23], a[188:191], v[244:247], v[20:23]
    s_waitcnt vmcnt(7)
    v_mfma_f32_16x16x32_bf16 v[16:19], a[192:195], v[24:27], v[16:19]
    v_mfma_f32_16x16x32_bf16 v[20:23], a[196:199], v[24:27], v[20:23]
    s_waitcnt vmcnt(6)
    v_mfma_f32_16x16x32_bf16 v[16:19], a[200:203], v[28:31], v[16:19]
    v_mfma_f32_16x16x32_bf16 v[20:23], a[204:207], v[28:31], v[20:23]
    s_waitcnt vmcnt(5)
    v_mfma_f32_16x16x32_bf16 v[16:19], a[208:211], v[32:35], v[16:19]
    v_mfma_f32_16x16x32_bf16 v[20:23], a[212:215], v[32:35], v[20:23]
    s_waitcnt vmcnt(4)
    v_mfma_f32_16x16x32_bf16 v[16:19], a[216:219], v[36:39], v[16:19]
    v_mfma_f32_16x16x32_bf16 v[20:23], a[220:223], v[36:39], v[20:23]
    s_waitcnt vmcnt(3)
    v_mfma_f32_16x16x32_bf16 v[16:19], a[224:227], v[40:43], v[16:19]
    v_mfma_f32_16x16x32_bf16 v[20:23], a[228:231], v[40:43], v[20:23]
    s_waitcnt vmcnt(2)
    v_mfma_f32_16x16x32_bf16 v[16:19], a[232:235], v[44:47], v[16:19]
    v_mfma_f32_16x16x32_bf16 v[20:23], a[236:239], v[44:47], v[20:23]
    s_waitcnt vmcnt(1)
    v_mfma_f32_16x16x32_bf16 v[16:19], a[240:243], v[48:51], v[16:19]
    v_mfma_f32_16x16x32_bf16 v[20:23], a[244:247], v[48:51], v[20:23]
    s_waitcnt vmcnt(0)
    v_mfma_f32_16x16x32_bf16 v[16:19], a[248:251], v[52:55], v[16:19]
    v_mfma_f32_16x16x32_bf16 v[20:23], a[252:255], v[52:55], v[20:23]
    ds_write_b128 v2, v[8:11] offset:0
    ds_write_b128 v2, v[12:15] offset:1024
    s_nop 4
    ds_write_b128 v2, v[16:19] offset:8192
    ds_write_b128 v2, v[20:23] offset:9216
    s_cmp_lg_u32 s32, 0
    s_cbranch_scc1 o2_nb
    v_cmp_eq_u32 vcc, 0, v253
    s_nop 0
    s_cmp_eq_u64 vcc, 0
    s_cselect_b32 s44, 65536, 0
    v_or_b32 v250, s44, v250
    v_mov_b32 v251, 163832
    s_mov_b64 exec, 1
    ds_write_b32 v251, v250
    s_mov_b64 exec, -1
o2_nb:
    s_waitcnt lgkmcnt(0)
    s_barrier
    s_cmp_gt_u32 s32, 1
    s_cbranch_scc1 o2_skip
    s_lshl_b32 s18, s32, 13
    v_add_u32 v2, s18, v1
    ds_read_b128 v[24:27], v2 offset:0
    ds_read_b128 v[28:31], v2 offset:1024
    ds_read_b128 v[32:35], v2 offset:2048
    ds_read_b128 v[36:39], v2 offset:3072
    ds_read_b128 v[40:43], v2 offset:4096
    ds_read_b128 v[44:47], v2 offset:5120
    ds_read_b128 v[48:51], v2 offset:6144
    ds_read_b128 v[52:55], v2 offset:7168
    v_lshrrev_b32 v3, 4, v1
    v_bfe_u32 v4, v3, 2, 2
    v_lshlrev_b32 v4, 3, v4
    v_and_b32 v2, 3, v3
    v_add_u32 v4, v4, v2
    v_mul_u32_u24 v4, 2304, v4
    v_lshrrev_b32 v3, 4, v3
    v_lshl_add_u32 v4, v3, 4, v4
    s_add_u32 s20, s16, s32
    s_lshr_b32 s18, s20, 1
    s_lshl_b32 s18, s18, 3
    s_and_b32 s19, s20, 1
    s_add_u32 s18, s18, s19
    s_mul_i32 s18, s18, 9216
    s_lshl_b32 s19, s33, 6
    s_add_u32 s18, s18, s19
    s_waitcnt lgkmcnt(0)
    v_pk_add_f32 v[24:25], v[24:25], v[32:33]
    v_pk_add_f32 v[40:41], v[40:41], v[48:49]
    v_pk_add_f32 v[24:25], v[24:25], v[40:41]
    v_pk_add_f32 v[26:27], v[26:27], v[34:35]
    v_pk_add_f32 v[42:43], v[42:43], v[50:51]
    v_pk_add_f32 v[26:27], v[26:27], v[42:43]
    v_pk_add_f32 v[28:29], v[28:29], v[36:37]
    v_pk_add_f32 v[44:45], v[44:45], v[52:53]
    v_pk_add_f32 v[28:29], v[28:29], v[44:45]
    v_pk_add_f32 v[30:31], v[30:31], v[38:39]
    v_pk_add_f32 v[46:47], v[46:47], v[54:55]
    v_pk_add_f32 v[30:31], v[30:31], v[46:47]
    v_cvt_pk_bf16_f32 v8, v24, v28
    v_cvt_pk_bf16_f32 v9, v25, v29
    v_cvt_pk_bf16_f32 v10, v26, v30
    v_cvt_pk_bf16_f32 v11, v27, v31
    buffer_store_dwordx4 v[8:11], v4, s[8:11], s18 offen
o2_skip:
    s_nop 1
    s_branch L_op_fin
L_op_one:
o1_again:
    s_lshl_b32 s18, s16, 17
    s_lshl_b32 s19, s32, 15
    s_add_u32 s18, s18, s19
    s_add_u32 s18, s18, 50331648
    buffer_load_dwordx4 v[24:27], v1, s[4:7], s18 offen offset:0 sc1
    buffer_load_dwordx4 v[28:31], v1, s[4:7], s18 offen offset:1024 sc1
    buffer_load_dwordx4 v[32:35], v1, s[4:7], s18 offen offset:2048 sc1
    buffer_load_dwordx4 v[36:39], v1, s[4:7], s18 offen offset:3072 sc1
    s_add_u32 s18, s18, 4096
    buffer_load_dwordx4 v[40:43], v1, s[4:7], s18 offen offset:0 sc1
    buffer_load_dwordx4 v[44:47], v1, s[4:7], s18 offen offset:1024 sc1
    buffer_load_dwordx4 v[48:51], v1, s[4:7], s18 offen offset:2048 sc1
    buffer_load_dwordx4 v[52:55], v1, s[4:7], s18 offen offset:3072 sc1
    s_add_u32 s18, s18, 4096
    buffer_load_dwordx4 v[56:59], v1, s[4:7], s18 offen offset:0 sc1
    buffer_load_dwordx4 v[60:63], v1, s[4:7], s18 offen offset:1024 sc1
    buffer_load_dwordx4 v[64:67], v1, s[4:7], s18 offen offset:2048 sc1
    buffer_load_dwordx4 v[68:71], v1, s[4:7], s18 offen offset:3072 sc1
    s_add_u32 s18, s18, 4096
    buffer_load_dwordx4 v[72:75], v1, s[4:7], s18 offen offset:0 sc1
    buffer_load_dwordx4 v[76:79], v1, s[4:7], s18 offen offset:1024 sc1
    buffer_load_dwordx4 v[80:83], v1, s[4:7], s18 offen offset:2048 sc1
    buffer_load_dwordx4 v[84:87], v1, s[4:7], s18 offen offset:3072 sc1
    s_add_u32 s18, s18, 4096
    buffer_load_dwordx4 v[88:91], v1, s[4:7], s18 offen offset:0 sc1
    buffer_load_dwordx4 v[92:95], v1, s[4:7], s18 offen offset:1024 sc1
    buffer_load_dwordx4 v[96:99], v1, s[4:7], s18 offen offset:2048 sc1
    buffer_load_dwordx4 v[100:103], v1, s[4:7], s18 offen offset:3072 sc1
    s_add_u32 s18, s18, 4096
    buffer_load_dwordx4 v[104:107], v1, s[4:7], s18 offen offset:0 sc1
    buffer_load_dwordx4 v[108:111], v1, s[4:7], s18 offen offset:1024 sc1
    buffer_load_dwordx4 v[112:115], v1, s[4:7], s18 offen offset:2048 sc1
    buffer_load_dwordx4 v[116:119], v1, s[4:7], s18 offen offset:3072 sc1
    s_add_u32 s18, s18, 4096
    buffer_load_dwordx4 v[120:123], v1, s[4:7], s18 offen offset:0 sc1
    buffer_load_dwordx4 v[124:127], v1, s[4:7], s18 offen offset:1024 sc1
    buffer_load_dwordx4 v[128:131], v1, s[4:7], s18 offen offset:2048 sc1
    buffer_load_dwordx4 v[132:135], v1, s[4:7], s18 offen offset:3072 sc1
    s_add_u32 s18, s18, 4096
    buffer_load_dwordx4 v[136:139], v1, s[4:7], s18 offen offset:0 sc1
    buffer_load_dwordx4 v[140:143], v1, s[4:7], s18 offen offset:1024 sc1
    buffer_load_dwordx4 v[144:147], v1, s[4:7], s18 offen offset:2048 sc1
    buffer_load_dwordx4 v[148:151], v1, s[4:7], s18 offen offset:3072 sc1
    v_lshlrev_b32 v2, 4, v0
    v_and_b32 v3, 3072, v2
    v_lshl_add_u32 v2, v3, 1, v1
    s_waitcnt vmcnt(31)
    v_mfma_f32_16x16x32_bf16 v[8:11], a[0:3], v[24:27], 0
    v_max_u32 v6, v24, v25
    v_mfma_f32_16x16x32_bf16 v[12:15], a[4:7], v[24:27], 0
    v_max3_u32 v6, v6, v26, v27
    s_waitcnt vmcnt(30)
    v_mfma_f32_16x16x32_bf16 v[8:11], a[8:11], v[28:31], v[8:11]
    v_max3_u32 v6, v6, v28, v29
    v_mfma_f32_16x16x32_bf16 v[12:15], a[12:15], v[28:31], v[12:15]
    v_max3_u32 v6, v6, v30, v31
    s_waitcnt vmcnt(29)
    v_mfma_f32_16x16x32_bf16 v[8:11], a[16:19], v[32:35], v[8:11]
    v_max3_u32 v6, v6, v32, v33
    v_mfma_f32_16x16x32_bf16 v[12:15], a[20:23], v[32:35], v[12:15]
    v_max3_u32 v6, v6, v34, v35
    s_waitcnt vmcnt(28)
    v_mfma_f32_16x16x32_bf16 v[8:11], a[24:27], v[36:39], v[8:11]
    v_max3_u32 v6, v6, v36, v37
    v_mfma_f32_16x16x32_bf16 v[12:15], a[28:31], v[36:39], v[12:15]
    v_max3_u32 v6, v6, v38, v39
    s_waitcnt vmcnt(27)
    v_mfma_f32_16x16x32_bf16 v[8:11], a[32:35], v[40:43], v[8:11]
    v_max3_u32 v6, v6, v40, v41
    v_mfma_f32_16x16x32_bf16 v[12:15], a[36:39], v[40:43], v[12:15]
    v_max3_u32 v6, v6, v42, v43
    s_waitcnt vmcnt(26)
    v_mfma_f32_16x16x32_bf16 v[8:11], a[40:43], v[44:47], v[8:11]
    v_max3_u32 v6, v6, v44, v45
    v_mfma_f32_16x16x32_bf16 v[12:15], a[44:47], v[44:47], v[12:15]
    v_max3_u32 v6, v6, v46, v47
    s_waitcnt vmcnt(25)
    v_mfma_f32_16x16x32_bf16 v[8:11], a[48:51], v[48:51], v[8:11]
    v_max3_u32 v6, v6, v48, v49
    v_mfma_f32_16x16x32_bf16 v[12:15], a[52:55], v[48:51], v[12:15]
    v_max3_u32 v6, v6, v50, v51
    s_waitcnt vmcnt(24)
    v_mfma_f32_16x16x32_bf16 v[8:11], a[56:59], v[52:55], v[8:11]
    v_max3_u32 v6, v6, v52, v53
    v_mfma_f32_16x16x32_bf16 v[12:15], a[60:63], v[52:55], v[12:15]
    v_max3_u32 v6, v6, v54, v55
    s_waitcnt vmcnt(23)
    v_mfma_f32_16x16x32_bf16 v[8:11], a[64:67], v[56:59], v[8:11]
    v_max3_u32 v6, v6, v56, v57
    v_mfma_f32_16x16x32_bf16 v[12:15], a[68:71], v[56:59], v[12:15]
    v_max3_u32 v6, v6, v58, v59
    s_waitcnt vmcnt(22)
    v_mfma_f32_16x16x32_bf16 v[8:11], a[72:75], v[60:63], v[8:11]
    v_max3_u32 v6, v6, v60, v61
    v_mfma_f32_16x16x32_bf16 v[12:15], a[76:79], v[60:63], v[12:15]
    v_max3_u32 v6, v6, v62, v63
    s_waitcnt vmcnt(21)
    v_mfma_f32_16x16x32_bf16 v[8:11], a[80:83], v[64:67], v[8:11]
    v_max3_u32 v6, v6, v64, v65
    v_mfma_f32_16x16x32_bf16 v[12:15], a[84:87], v[64:67], v[12:15]
    v_max3_u32 v6, v6, v66, v67
    s_waitcnt vmcnt(20)
    v_mfma_f32_16x16x32_bf16 v[8:11], a[88:91], v[68:71], v[8:11]
    v_max3_u32 v6, v6, v68, v69
    v_mfma_f32_16x16x32_bf16 v[12:15], a[92:95], v[68:71], v[12:15]
    v_max3_u32 v6, v6, v70, v71
    s_waitcnt vmcnt(19)
    v_mfma_f32_16x16x32_bf16 v[8:11], a[96:99], v[72:75], v[8:11]
    v_max3_u32 v6, v6, v72, v73
    v_mfma_f32_16x16x32_bf16 v[12:15], a[100:103], v[72:75], v[12:15]
    v_max3_u32 v6, v6, v74, v75
    s_waitcnt vmcnt(18)
    v_mfma_f32_16x16x32_bf16 v[8:11], a[104:107], v[76:79], v[8:11]
    v_max3_u32 v6, v6, v76, v77
    v_mfma_f32_16x16x32_bf16 v[12:15], a[108:111], v[76:79], v[12:15]
    v_max3_u32 v6, v6, v78, v79
    s_waitcnt vmcnt(17)
    v_mfma_f32_16x16x32_bf16 v[8:11], a[112:115], v[80:83], v[8:11]
    v_max3_u32 v6, v6, v80, v81
    v_mfma_f32_16x16x32_bf16 v[12:15], a[116:119], v[80:83], v[12:15]
    v_max3_u32 v6, v6, v82, v83
    s_waitcnt vmcnt(16)
    v_mfma_f32_16x16x32_bf16 v[8:11], a[120:123], v[84:87], v[8:11]
    v_max3_u32 v6, v6, v84, v85
    v_mfma_f32_16x16x32_bf16 v[12:15], a[124:127], v[84:87], v[12:15]
    v_max3_u32 v6, v6, v86, v87
    s_waitcnt vmcnt(15)
    v_mfma_f32_16x16x32_bf16 v[8:11], a[128:131], v[88:91], v[8:11]
    v_max3_u32 v6, v6, v88, v89
    v_mfma_f32_16x16x32_bf16 v[12:15], a[132:135], v[88:91], v[12:15]
    v_max3_u32 v6, v6, v90, v91
    s_waitcnt vmcnt(14)
    v_mfma_f32_16x16x32_bf16 v[8:11], a[136:139], v[92:95], v[8:11]
    v_max3_u32 v6, v6, v92, v93
    v_mfma_f32_16x16x32_bf16 v[12:15], a[140:143], v[92:95], v[12:15]
    v_max3_u32 v6, v6, v94, v95
    s_waitcnt vmcnt(13)
    v_mfma_f32_16x16x32_bf16 v[8:11], a[144:147], v[96:99], v[8:11]
    v_max3_u32 v6, v6, v96, v97
    v_mfma_f32_16x16x32_bf16 v[12:15], a[148:151], v[96:99], v[12:15]
    v_max3_u32 v6, v6, v98, v99
    s_waitcnt vmcnt(12)
    v_mfma_f32_16x16x32_bf16 v[8:11], a[152:155], v[100:103], v[8:11]
    v_max3_u32 v6, v6, v100, v101
    v_mfma_f32_16x16x32_bf16 v[12:15], a[156:159], v[100:103], v[12:15]
    v_max3_u32 v6, v6, v102, v103
    s_waitcnt vmcnt(11)
    v_mfma_f32_16x16x32_bf16 v[8:11], a[160:163], v[104:107], v[8:11]
    v_max3_u32 v6, v6, v104, v105
    v_mfma_f32_16x16x32_bf16 v[12:15], a[164:167], v[104:107], v[12:15]
    v_max3_u32 v6, v6, v106, v107
    s_waitcnt vmcnt(10)
    v_mfma_f32_16x16x32_bf16 v[8:11], a[168:171], v[108:111], v[8:11]
    v_max3_u32 v6, v6, v108, v109
    v_mfma_f32_16x16x32_bf16 v[12:15], a[172:175], v[108:111], v[12:15]
    v_max3_u32 v6, v6, v110, v111
    s_waitcnt vmcnt(9)
    v_mfma_f32_16x16x32_bf16 v[8:11], a[176:179], v[112:115], v[8:11]
    v_max3_u32 v6, v6, v112, v113
    v_mfma_f32_16x16x32_bf16 v[12:15], a[180:183], v[112:115], v[12:15]
    v_max3_u32 v6, v6, v114, v115
    s_waitcnt vmcnt(8)
    v_mfma_f32_16x16x32_bf16 v[8:11], a[184:187], v[116:119], v[8:11]
    v_max3_u32 v6, v6, v116, v117
    v_mfma_f32_16x16x32_bf16 v[12:15], a[188:191], v[116:119], v[12:15]
    v_max3_u32 v6, v6, v118, v119
    s_waitcnt vmcnt(7)
    v_mfma_f32_16x16x32_bf16 v[8:11], a[192:195], v[120:123], v[8:11]
    v_max3_u32 v6, v6, v120, v121
    v_mfma_f32_16x16x32_bf16 v[12:15], a[196:199], v[120:123], v[12:15]
    v_max3_u32 v6, v6, v122, v123
    s_waitcnt vmcnt(6)
    v_mfma_f32_16x16x32_bf16 v[8:11], a[200:203], v[124:127], v[8:11]
    v_max3_u32 v6, v6, v124, v125
    v_mfma_f32_16x16x32_bf16 v[12:15], a[204:207], v[124:127], v[12:15]
    v_max3_u32 v6, v6, v126, v127
    s_waitcnt vmcnt(5)
    v_mfma_f32_16x16x32_bf16 v[8:11], a[208:211], v[128:131], v[8:11]
    v_max3_u32 v6, v6, v128, v129
    v_mfma_f32_16x16x32_bf16 v[12:15], a[212:215], v[128:131], v[12:15]
    v_max3_u32 v6, v6, v130, v131
    s_waitcnt vmcnt(4)
    v_mfma_f32_16x16x32_bf16 v[8:11], a[216:219], v[132:135], v[8:11]
    v_max3_u32 v6, v6, v132, v133
    v_mfma_f32_16x16x32_bf16 v[12:15], a[220:223], v[132:135], v[12:15]
    v_max3_u32 v6, v6, v134, v135
    s_waitcnt vmcnt(3)
    v_mfma_f32_16x16x32_bf16 v[8:11], a[224:227], v[136:139], v[8:11]
    v_max3_u32 v6, v6, v136, v137
    v_mfma_f32_16x16x32_bf16 v[12:15], a[228:231], v[136:139], v[12:15]
    v_max3_u32 v6, v6, v138, v139
    s_waitcnt vmcnt(2)
    v_mfma_f32_16x16x32_bf16 v[8:11], a[232:235], v[140:143], v[8:11]
    v_max3_u32 v6, v6, v140, v141
    v_mfma_f32_16x16x32_bf16 v[12:15], a[236:239], v[140:143], v[12:15]
    v_max3_u32 v6, v6, v142, v143
    s_waitcnt vmcnt(1)
    v_mfma_f32_16x16x32_bf16 v[8:11], a[240:243], v[144:147], v[8:11]
    v_max3_u32 v6, v6, v144, v145
    v_mfma_f32_16x16x32_bf16 v[12:15], a[244:247], v[144:147], v[12:15]
    v_max3_u32 v6, v6, v146, v147
    s_waitcnt vmcnt(0)
    v_mfma_f32_16x16x32_bf16 v[8:11], a[248:251], v[148:151], v[8:11]
    v_max3_u32 v6, v6, v148, v149
    v_mfma_f32_16x16x32_bf16 v[12:15], a[252:255], v[148:151], v[12:15]
    v_max3_u32 v6, v6, v150, v151
    v_cmp_eq_u32 vcc, -1, v6
    s_cbranch_vccz o1_ok
    s_cmp_eq_u32 s46, 0
    s_cbranch_scc1 o1_ok
    s_mov_b32 s46, 0
    s_nop 1
    v_mbcnt_lo_u32_b32 v2, -1, 0
    v_mbcnt_hi_u32_b32 v2, -1, v2
    v_min_u32 v2, 1, v2
    v_lshlrev_b32 v2, 2, v2
    s_mov_b32 s88, 4194304
fw24:
    buffer_load_dword v3, v2, s[4:7], s89 offen offset:0 sc1
    s_sub_u32 s88, s88, 1
    s_cbranch_scc1 fw24x
    s_waitcnt vmcnt(0)
    v_cmp_ne_u32 vcc, s95, v3
    s_cbranch_vccz fw24x
    s_sleep 1
    s_branch fw24
fw24x:
    s_branch o1_again
o1_ok:
    s_nop 7
    ds_write_b128 v2, v[8:11] offset:0
    ds_write_b128 v2, v[12:15] offset:1024
    s_cmp_lg_u32 s32, 0
    s_cbranch_scc1 o1_nb
    v_cmp_eq_u32 vcc, 0, v253
    s_nop 0
    s_cmp_eq_u64 vcc, 0
    s_cselect_b32 s44, 65536, 0
    v_or_b32 v250, s44, v250
    v_mov_b32 v251, 163832
    s_mov_b64 exec, 1
    ds_write_b32 v251, v250
    s_mov_b64 exec, -1
o1_nb:
    s_waitcnt lgkmcnt(0)
    s_barrier
    s_cmp_gt_u32 s32, 0
    s_cbranch_scc1 o1_skip
    s_lshl_b32 s18, s32, 13
    v_add_u32 v2, s18, v1
    ds_read_b128 v[24:27], v2 offset:0
    ds_read_b128 v[28:31], v2 offset:1024
    ds_read_b128 v[32:35], v2 offset:2048
    ds_read_b128 v[36:39], v2 offset:3072
    ds_read_b128 v[40:43], v2 offset:4096
    ds_read_b128 v[44:47], v2 offset:5120
    ds_read_b128 v[48:51], v2 offset:6144
    ds_read_b128 v[52:55], v2 offset:7168
    v_lshrrev_b32 v3, 4, v1
    v_bfe_u32 v4, v3, 2, 2
    v_lshlrev_b32 v4, 3, v4
    v_and_b32 v2, 3, v3
    v_add_u32 v4, v4, v2
    v_mul_u32_u24 v4, 2304, v4
    v_lshrrev_b32 v3, 4, v3
    v_lshl_add_u32 v4, v3, 4, v4
    s_add_u32 s20, s16, s32
    s_lshr_b32 s18, s20, 1
    s_lshl_b32 s18, s18, 3
    s_and_b32 s19, s20, 1
    s_add_u32 s18, s18, s19
    s_mul_i32 s18, s18, 9216
    s_lshl_b32 s19, s33, 6
    s_add_u32 s18, s18, s19
    s_waitcnt lgkmcnt(0)
    v_pk_add_f32 v[24:25], v[24:25], v[32:33]
    v_pk_add_f32 v[40:41], v[40:41], v[48:49]
    v_pk_add_f32 v[24:25], v[24:25], v[40:41]
    v_pk_add_f32 v[26:27], v[26:27], v[34:35]
    v_pk_add_f32 v[42:43], v[42:43], v[50:51]
    v_pk_add_f32 v[26:27], v[26:27], v[42:43]
    v_pk_add_f32 v[28:29], v[28:29], v[36:37]
    v_pk_add_f32 v[44:45], v[44:45], v[52:53]
    v_pk_add_f32 v[28:29], v[28:29], v[44:45]
    v_pk_add_f32 v[30:31], v[30:31], v[38:39]
    v_pk_add_f32 v[46:47], v[46:47], v[54:55]
    v_pk_add_f32 v[30:31], v[30:31], v[46:47]
    v_cvt_pk_bf16_f32 v8, v24, v28
    v_cvt_pk_bf16_f32 v9, v25, v29
    v_cvt_pk_bf16_f32 v10, v26, v30
    v_cvt_pk_bf16_f32 v11, v27, v31
    buffer_store_dwordx4 v[8:11], v4, s[8:11], s18 offen
o1_skip:
    s_nop 1
L_op_fin:
    v_mov_b32 v251, 163832
    ds_read_b32 v252, v251
    s_waitcnt lgkmcnt(0)
    v_readfirstlane_b32 s40, v252
    s_nop 1
    s_cmp_ge_u32 s40, 65604
    s_cbranch_scc1 L_done
    s_barrier
    s_and_b32 s16, s40, 0xffff
    s_cmp_lt_u32 s16, 68
    s_cbranch_scc1 L_op_seg
L_op_nextcb:
    s_mov_b32 s40, -1
    s_cmp_lg_u32 s32, 0
    s_cbranch_scc1 L_op_dec
    v_and_b32 v1, 63, v0
    v_min_u32 v1, 17, v1
    v_lshlrev_b32 v2, 2, v1
    buffer_load_dword v3, v2, s[84:87], 0 offen offset:136 sc1
    s_waitcnt vmcnt(0)
    v_cmp_gt_u32 vcc, 52, v3
    s_nop 0
    s_and_b32 s40, vcc_lo, 262143
    s_lshl_b32 s41, s40, 18
    s_lshr_b32 s43, s40, 14
    s_or_b32 s42, s40, s41
    s_and_b32 s36, s45, 15
    s_bfm_b32 s37, s36, 0
    s_and_b32 s37, s37, 42315
    s_bcnt1_i32_b32 s37, s37
    s_lshr_b32 s36, s45, 4
    s_mul_i32 s36, s36, 8
    s_add_u32 s36, s36, s37
    s_add_u32 s36, s36, 38
    s_mul_hi_u32 s41, s36, 0x0e38e38f
    s_mul_i32 s41, s41, 18
    s_sub_u32 s41, s36, s41
    s_lshr_b64 s[42:43], s[42:43], s41
    s_ff1_i32_b64 s40, s[42:43]
    s_cmp_lt_i32 s40, 0
    s_cbranch_scc1 L_op_dec
    s_add_u32 s40, s40, s41
    s_sub_u32 s41, s40, 18
    s_cselect_b32 s40, s40, s41
L_op_dec:
    v_mov_b32 v250, s40
    v_mov_b32 v251, 163832
    s_cmp_lg_u32 s32, 0
    s_cbranch_scc1 L_op_nw
    ds_write_b32 v251, v250
    s_waitcnt lgkmcnt(0)
L_op_nw:
    s_barrier
    ds_read_b32 v252, v251
    s_waitcnt lgkmcnt(0)
    v_readfirstlane_b32 s33, v252
    s_barrier
    s_nop 1
    s_cmp_lt_u32 s33, 18
    s_cbranch_scc1 L_op_start
L_done:
L_exit:
    s_endpgm
.section .rodata,"a"
.p2align 6
.amdhsa_kernel concat_heads__memory_aug_recurrent_mem_tr__ssm_conv_s4d__prompt_kernel
  .amdhsa_next_free_vgpr 512
  .amdhsa_next_free_sgpr 102
  .amdhsa_accum_offset 256
  .amdhsa_group_segment_fixed_size 0
  .amdhsa_kernarg_size 136
  .amdhsa_user_sgpr_count 2
  .amdhsa_user_sgpr_kernarg_segment_ptr 1
  .amdhsa_system_sgpr_workgroup_id_x 1
.end_amdhsa_kernel
.text
```
